```python
import torch

def _softmax(x, axis=-1):
    return torch.softmax(x, dim=axis)

def _gelu(x):
    return torch.nn.functional.gelu(x, approximate='tanh')

def _silu(x):
    return torch.nn.functional.silu(x)

def _sigmoid(x):
    return torch.sigmoid(x)

def _layernorm(x, axis=-1, eps=1e-05):
    m = x.mean(dim=axis, keepdim=True)
    v = x.var(dim=axis, keepdim=True, unbiased=False)
    return (x - m) / torch.sqrt(v + eps)

def _scatter_add(tgt, idx, src, axis=0):
    return tgt.clone().index_add_(axis, idx, src)

def _segment_sum(src, seg, n):
    out = torch.zeros((n,) + src.shape[1:], dtype=src.dtype)
    return out.index_add_(0, seg, src)

def _pad(x, pw):
    flat = tuple((v for pair in reversed(pw) for v in pair))
    return torch.nn.functional.pad(x, flat)
kernel_name = 'concat_heads__ssm_conv_s4d__memory_aug_recurrent_mem_tr__prompt'

def setup_inputs():

    _w = lambda a: (lambda t: t.to(torch.bfloat16) if t.is_floating_point() else t)(torch.as_tensor(a))

    def _A_setup():
        Bsz, L, D, N = (1, 2048, 448, 256)
        return {'u': _w((lambda *s: torch.randn(*s, dtype=torch.bfloat16) * 0.05)(Bsz, L, D)), 'log_A_real': _w((lambda *s: torch.randn(*s, dtype=torch.bfloat16) * 6.4)(D, N) * 0.5), 'A_imag': _w((lambda *s: torch.randn(*s, dtype=torch.bfloat16) * 0.05)(D, N) * 3.14), 'C_real': _w((lambda *s: torch.randn(*s, dtype=torch.bfloat16) * 0.2)(D, N) / N ** 0.5), 'C_imag': _w((lambda *s: torch.randn(*s, dtype=torch.bfloat16) * 0.2)(D, N) / N ** 0.5), 'log_dt': _w((lambda *s: torch.randn(*s, dtype=torch.bfloat16) * 0.05)(D) * 0.5 - 4.0), 'D_skip': _w((lambda *s: torch.randn(*s, dtype=torch.bfloat16) * 0.05)(D))}
    _A_in = _A_setup()

    def _B_setup():
        B, S, Dm = (1, 2048, 448)
        H, Dh = (16, 256)
        M, seg = (8, 32)
        seg = min(seg, S)
        S = S // seg * seg
        return {'x': _w((lambda *s: torch.randn(*s, dtype=torch.bfloat16) * 0.05)(B, S, Dm)), 'mem0': _w((lambda *s: torch.randn(*s, dtype=torch.bfloat16) * 0.4)(B, M, Dm)), 'Wq': _w((lambda *s: torch.randn(*s, dtype=torch.bfloat16) * 6.4)(Dm, H, Dh) * Dm ** (-0.5)), 'Wk': _w((lambda *s: torch.randn(*s, dtype=torch.bfloat16) * 6.4)(Dm, H, Dh) * Dm ** (-0.5)), 'Wv': _w((lambda *s: torch.randn(*s, dtype=torch.bfloat16) * 0.4)(Dm, H, Dh) * Dm ** (-0.5)), 'Wo': _w((lambda *s: torch.randn(*s, dtype=torch.bfloat16) * 0.4)(H, Dh, Dm) * (H * Dh) ** (-0.5)), 'seg_len': seg}
    _B_in = _B_setup()
    return {'A_u': _A_in['u'], 'A_log_A_real': _A_in['log_A_real'], 'A_A_imag': _A_in['A_imag'], 'A_C_real': _A_in['C_real'], 'A_C_imag': _A_in['C_imag'], 'A_log_dt': _A_in['log_dt'], 'A_D_skip': _A_in['D_skip'], 'B_x': _B_in['x'], 'B_mem0': _B_in['mem0'], 'B_Wq': _B_in['Wq'], 'B_Wk': _B_in['Wk'], 'B_Wv': _B_in['Wv'], 'B_Wo': _B_in['Wo'], 'B_seg_len': _B_in['seg_len']}

def reference(A_u, A_log_A_real, A_A_imag, A_C_real, A_C_imag, A_log_dt, A_D_skip, B_x, B_mem0, B_Wq, B_Wk, B_Wv, B_Wo, B_seg_len):

    def _A_ref(u, log_A_real, A_imag, C_real, C_imag, log_dt, D_skip):
        L = u.shape[1]
        dt = torch.exp(log_dt)
        A = -torch.exp(log_A_real) + 1j * A_imag
        C = (C_real + 1j * C_imag) * dt[:, None]
        pos = (lambda x, dt: x.to(dt))(torch.arange(L), log_dt.dtype)
        P = torch.exp((A * dt[:, None])[:, :, None] * pos[None, None, :])
        K = 2.0 * torch.einsum('dn,dnl->dl', C, P).real
        L2 = 2 * L
        u_t = (lambda x, *d: x.permute(*d))(u, 0, 2, 1)
        Kf = (lambda x, *a, **k: torch.fft.rfft(x.float(), *a, **k))(K, L2)
        Uf = (lambda x, *a, **k: torch.fft.rfft(x.float(), *a, **k))(u_t, L2)
        y = (lambda x, *a, **k: torch.fft.irfft(x, *a, **k).to(torch.bfloat16))(Uf * Kf[None, :, :], L2)[:, :, :L]
        y = (lambda x, *d: x.permute(*d))(y, 0, 2, 1)
        return y + u * D_skip[None, None, :]

    def _B_ref(x, mem0, Wq, Wk, Wv, Wo, seg_len):
        B, S, Dm = x.shape
        H, Dh = (Wq.shape[1], Wq.shape[2])
        M = mem0.shape[1]
        scale = Dh ** (-0.5)
        n_seg = S // seg_len
        L = M + seg_len
        idx = torch.arange(L)
        mask = (idx[:, None] < M) | (idx[:, None] >= idx[None, :])
        mem = mem0
        outs = []
        for s in range(n_seg):
            xs = x[:, s * seg_len:(s + 1) * seg_len, :].clone()
            h = torch.concatenate([mem, xs], axis=1)
            q = torch.einsum('btd,dhe->bhte', h, Wq)
            k = torch.einsum('btd,dhe->bhte', h, Wk)
            v = torch.einsum('btd,dhe->bhte', h, Wv)
            scores = torch.einsum('bhqe,bhke->bhqk', q, k) * scale
            scores = torch.where(mask[None, None], scores, -1000000000.0)
            p = _softmax(scores, axis=-1)
            o = torch.einsum('bhqk,bhke->bhqe', p, v)
            o = torch.einsum('bhte,hed->btd', o, Wo)
            mem = o[:, :M, :].clone()
            outs.append(o[:, M:, :])
        return torch.concatenate(outs, axis=1)
    a = _A_ref(A_u, A_log_A_real, A_A_imag, A_C_real, A_C_imag, A_log_dt, A_D_skip)
    b = _B_ref(B_x, B_mem0, B_Wq, B_Wk, B_Wv, B_Wo, B_seg_len)
    return torch.concatenate([a, b], axis=-1)
```

```asm
; @launch kernel=prep_kernel grid=(256,1,1) block=(256,1,1) lds=163840
; @launch kernel=main_kernel grid=(256,1,1) block=(256,1,1) lds=163840
.amdgcn_target "amdgcn-amd-amdhsa--gfx950"
.text
.globl prep_kernel
.p2align 8
.type prep_kernel,@function
prep_kernel:
  s_cmp_ge_u32 s2, 256
  s_cbranch_scc1 pr_end
  s_load_dwordx2 s[6:7], s[0:1], 128
  s_getpc_b64 s[98:99]
pf_prep_kernel_1:
  s_sub_u32 s98, s98, pf_prep_kernel_1-prep_kernel
  s_subb_u32 s99, s99, 0
  v_lshlrev_b32 v200, 7, v0
  v_min_u32 v201, pr_end-prep_kernel-4, v200
  global_load_dword v202, v201, s[98:99]
  v_add_u32 v200, 32768, v200
  v_lshrrev_b32 v1, 6, v0
  s_nop 0
  v_readfirstlane_b32 s16, v1
  v_and_b32 v1, 63, v0
  v_lshlrev_b32 v2, 4, v1
  v_lshrrev_b32 v3, 4, v1
  v_and_b32 v4, 15, v1
  s_waitcnt lgkmcnt(0)
  s_mov_b32 s8, s6
  s_and_b32 s9, s7, 0xffff
  s_mov_b32 s10, 268435456
  s_mov_b32 s11, 0x20000
  s_cmp_ge_u32 s2, 224
  s_cbranch_scc1 pr_x
  s_load_dwordx4 s[40:43], s[0:1], 72
  s_load_dwordx4 s[44:47], s[0:1], 88
  s_mov_b32 s28, s16
  s_and_b32 s20, s2, 7
  s_lshr_b32 s21, s2, 3
  s_mul_i32 s22, s21, 37
  s_lshr_b32 s22, s22, 8
  s_mul_i32 s23, s22, 7
  s_sub_u32 s18, s21, s23
  s_lshl_b32 s20, s20, 2
  s_add_u32 s20, s20, s22
  s_lshr_b32 s19, s20, 4
  s_and_b32 s17, s20, 15
  s_waitcnt lgkmcnt(0)
  s_cmp_eq_u32 s19, 0
  s_cselect_b32 s52, s40, s44
  s_cselect_b32 s53, s41, s45
  s_cselect_b32 s54, s42, s46
  s_cselect_b32 s55, s43, s47
  s_cselect_b32 s24, 1035512379, 1.0
  s_mov_b32 s60, s52
  s_and_b32 s61, s53, 0xffff
  s_mov_b32 s62, 3670016
  s_mov_b32 s63, 0x20000
  s_mov_b32 s56, s54
  s_and_b32 s57, s55, 0xffff
  s_mov_b32 s58, 3670016
  s_mov_b32 s59, 0x20000
  s_mul_i32 s20, s18, 256
  v_mov_b32 v6, 255
  v_min_u32 v5, v0, v6
  v_add_u32 v5, s20, v5
  v_mov_b32 v6, 1791
  v_min_u32 v5, v5, v6
  v_lshrrev_b32 v6, 2, v5
  v_and_b32 v5, 3, v5
  v_lshlrev_b32 v5, 7, v5
  v_lshl_add_u32 v5, v6, 13, v5
  s_lshl_b32 s20, s17, 9
  buffer_load_dword v203, v5, s[60:63], s20 offen
  v_lshrrev_b32 v5, 5, v1
  v_and_b32 v6, 31, v1
  v_add_u32 v7, 0, v5
  v_and_b32 v8, 3, v7
  v_or_b32 v8, 0, v8
  v_xor_b32 v8, v6, v8
  v_lshlrev_b32 v8, 4, v8
  v_lshl_add_u32 v16, v7, 13, v8
  v_add_u32 v7, 2, v5
  v_and_b32 v8, 3, v7
  v_or_b32 v8, 0, v8
  v_xor_b32 v8, v6, v8
  v_lshlrev_b32 v8, 4, v8
  v_lshl_add_u32 v17, v7, 13, v8
  v_add_u32 v7, 4, v5
  v_and_b32 v8, 3, v7
  v_or_b32 v8, 0, v8
  v_xor_b32 v8, v6, v8
  v_lshlrev_b32 v8, 4, v8
  v_lshl_add_u32 v18, v7, 13, v8
  v_add_u32 v7, 6, v5
  v_and_b32 v8, 3, v7
  v_or_b32 v8, 0, v8
  v_xor_b32 v8, v6, v8
  v_lshlrev_b32 v8, 4, v8
  v_lshl_add_u32 v19, v7, 13, v8
  v_add_u32 v7, 8, v5
  v_and_b32 v8, 3, v7
  v_or_b32 v8, 4, v8
  v_xor_b32 v8, v6, v8
  v_lshlrev_b32 v8, 4, v8
  v_lshl_add_u32 v20, v7, 13, v8
  v_add_u32 v7, 10, v5
  v_and_b32 v8, 3, v7
  v_or_b32 v8, 4, v8
  v_xor_b32 v8, v6, v8
  v_lshlrev_b32 v8, 4, v8
  v_lshl_add_u32 v21, v7, 13, v8
  v_add_u32 v7, 12, v5
  v_and_b32 v8, 3, v7
  v_or_b32 v8, 4, v8
  v_xor_b32 v8, v6, v8
  v_lshlrev_b32 v8, 4, v8
  v_lshl_add_u32 v22, v7, 13, v8
  v_add_u32 v7, 14, v5
  v_and_b32 v8, 3, v7
  v_or_b32 v8, 4, v8
  v_xor_b32 v8, v6, v8
  v_lshlrev_b32 v8, 4, v8
  v_lshl_add_u32 v23, v7, 13, v8
  v_add_u32 v7, 16, v5
  v_and_b32 v8, 3, v7
  v_or_b32 v8, 8, v8
  v_xor_b32 v8, v6, v8
  v_lshlrev_b32 v8, 4, v8
  v_lshl_add_u32 v24, v7, 13, v8
  v_add_u32 v7, 18, v5
  v_and_b32 v8, 3, v7
  v_or_b32 v8, 8, v8
  v_xor_b32 v8, v6, v8
  v_lshlrev_b32 v8, 4, v8
  v_lshl_add_u32 v25, v7, 13, v8
  v_add_u32 v7, 20, v5
  v_and_b32 v8, 3, v7
  v_or_b32 v8, 8, v8
  v_xor_b32 v8, v6, v8
  v_lshlrev_b32 v8, 4, v8
  v_lshl_add_u32 v26, v7, 13, v8
  v_add_u32 v7, 22, v5
  v_and_b32 v8, 3, v7
  v_or_b32 v8, 8, v8
  v_xor_b32 v8, v6, v8
  v_lshlrev_b32 v8, 4, v8
  v_lshl_add_u32 v27, v7, 13, v8
  v_add_u32 v7, 24, v5
  v_and_b32 v8, 3, v7
  v_or_b32 v8, 12, v8
  v_xor_b32 v8, v6, v8
  v_lshlrev_b32 v8, 4, v8
  v_lshl_add_u32 v28, v7, 13, v8
  v_add_u32 v7, 26, v5
  v_and_b32 v8, 3, v7
  v_or_b32 v8, 12, v8
  v_xor_b32 v8, v6, v8
  v_lshlrev_b32 v8, 4, v8
  v_lshl_add_u32 v29, v7, 13, v8
  v_add_u32 v7, 28, v5
  v_and_b32 v8, 3, v7
  v_or_b32 v8, 12, v8
  v_xor_b32 v8, v6, v8
  v_lshlrev_b32 v8, 4, v8
  v_lshl_add_u32 v30, v7, 13, v8
  v_add_u32 v7, 30, v5
  v_and_b32 v8, 3, v7
  v_or_b32 v8, 12, v8
  v_xor_b32 v8, v6, v8
  v_lshlrev_b32 v8, 4, v8
  v_lshl_add_u32 v31, v7, 13, v8
  s_lshl_b32 s25, s16, 15
  s_add_u32 s25, s25, 32768
  s_lshl_b32 s26, s17, 9
  s_cmp_eq_u32 s19, 0
  s_cbranch_scc0 pw_pr_stB
  s_lshl_b32 s27, s18, 19
  s_add_u32 s27, s27, s26
  s_lshl_b32 s29, s16, 4
  v_add_u32 v7, 0, v5
  v_xor_b32 v8, v6, v7
  v_lshlrev_b32 v8, 4, v8
  v_add_u32 v7, s29, v7
  v_lshl_add_u32 v8, v7, 13, v8
  s_lshl_b32 s30, s16, 13
  s_add_u32 m0, s30, 0
  s_nop 0
  buffer_load_dwordx4 v8, s[56:59], s27 offen lds
  v_add_u32 v7, 2, v5
  v_xor_b32 v8, v6, v7
  v_lshlrev_b32 v8, 4, v8
  v_add_u32 v7, s29, v7
  v_lshl_add_u32 v8, v7, 13, v8
  s_lshl_b32 s30, s16, 13
  s_add_u32 m0, s30, 1024
  s_nop 0
  buffer_load_dwordx4 v8, s[56:59], s27 offen lds
  v_add_u32 v7, 4, v5
  v_xor_b32 v8, v6, v7
  v_lshlrev_b32 v8, 4, v8
  v_add_u32 v7, s29, v7
  v_lshl_add_u32 v8, v7, 13, v8
  s_lshl_b32 s30, s16, 13
  s_add_u32 m0, s30, 2048
  s_nop 0
  buffer_load_dwordx4 v8, s[56:59], s27 offen lds
  v_add_u32 v7, 6, v5
  v_xor_b32 v8, v6, v7
  v_lshlrev_b32 v8, 4, v8
  v_add_u32 v7, s29, v7
  v_lshl_add_u32 v8, v7, 13, v8
  s_lshl_b32 s30, s16, 13
  s_add_u32 m0, s30, 3072
  s_nop 0
  buffer_load_dwordx4 v8, s[56:59], s27 offen lds
  v_add_u32 v7, 8, v5
  v_xor_b32 v8, v6, v7
  v_lshlrev_b32 v8, 4, v8
  v_add_u32 v7, s29, v7
  v_lshl_add_u32 v8, v7, 13, v8
  s_lshl_b32 s30, s16, 13
  s_add_u32 m0, s30, 4096
  s_nop 0
  buffer_load_dwordx4 v8, s[56:59], s27 offen lds
  v_add_u32 v7, 10, v5
  v_xor_b32 v8, v6, v7
  v_lshlrev_b32 v8, 4, v8
  v_add_u32 v7, s29, v7
  v_lshl_add_u32 v8, v7, 13, v8
  s_lshl_b32 s30, s16, 13
  s_add_u32 m0, s30, 5120
  s_nop 0
  buffer_load_dwordx4 v8, s[56:59], s27 offen lds
  v_add_u32 v7, 12, v5
  v_xor_b32 v8, v6, v7
  v_lshlrev_b32 v8, 4, v8
  v_add_u32 v7, s29, v7
  v_lshl_add_u32 v8, v7, 13, v8
  s_lshl_b32 s30, s16, 13
  s_add_u32 m0, s30, 6144
  s_nop 0
  buffer_load_dwordx4 v8, s[56:59], s27 offen lds
  v_add_u32 v7, 14, v5
  v_xor_b32 v8, v6, v7
  v_lshlrev_b32 v8, 4, v8
  v_add_u32 v7, s29, v7
  v_lshl_add_u32 v8, v7, 13, v8
  s_lshl_b32 s30, s16, 13
  s_add_u32 m0, s30, 7168
  s_nop 0
  buffer_load_dwordx4 v8, s[56:59], s27 offen lds
  s_waitcnt vmcnt(0)
  s_barrier
  s_min_u32 s27, s28, 13
  s_lshl_b32 s27, s27, 18
  s_add_u32 s27, s27, s26
  s_add_u32 m0, s25, 0
  s_nop 0
  buffer_load_dwordx4 v16, s[60:63], s27 offen lds
  s_add_u32 m0, s25, 1024
  s_nop 0
  buffer_load_dwordx4 v17, s[60:63], s27 offen lds
  s_add_u32 m0, s25, 2048
  s_nop 0
  buffer_load_dwordx4 v18, s[60:63], s27 offen lds
  s_add_u32 m0, s25, 3072
  s_nop 0
  buffer_load_dwordx4 v19, s[60:63], s27 offen lds
  s_add_u32 m0, s25, 4096
  s_nop 0
  buffer_load_dwordx4 v20, s[60:63], s27 offen lds
  s_add_u32 m0, s25, 5120
  s_nop 0
  buffer_load_dwordx4 v21, s[60:63], s27 offen lds
  s_add_u32 m0, s25, 6144
  s_nop 0
  buffer_load_dwordx4 v22, s[60:63], s27 offen lds
  s_add_u32 m0, s25, 7168
  s_nop 0
  buffer_load_dwordx4 v23, s[60:63], s27 offen lds
  s_add_u32 m0, s25, 8192
  s_nop 0
  buffer_load_dwordx4 v24, s[60:63], s27 offen lds
  s_add_u32 m0, s25, 9216
  s_nop 0
  buffer_load_dwordx4 v25, s[60:63], s27 offen lds
  s_add_u32 m0, s25, 10240
  s_nop 0
  buffer_load_dwordx4 v26, s[60:63], s27 offen lds
  s_add_u32 m0, s25, 11264
  s_nop 0
  buffer_load_dwordx4 v27, s[60:63], s27 offen lds
  s_add_u32 m0, s25, 12288
  s_nop 0
  buffer_load_dwordx4 v28, s[60:63], s27 offen lds
  s_add_u32 m0, s25, 13312
  s_nop 0
  buffer_load_dwordx4 v29, s[60:63], s27 offen lds
  s_add_u32 m0, s25, 14336
  s_nop 0
  buffer_load_dwordx4 v30, s[60:63], s27 offen lds
  s_add_u32 m0, s25, 15360
  s_nop 0
  buffer_load_dwordx4 v31, s[60:63], s27 offen lds
  s_add_u32 s29, s28, 4
  s_min_u32 s27, s29, 13
  s_lshl_b32 s27, s27, 18
  s_add_u32 s27, s27, s26
  s_add_u32 m0, s25, 16384
  s_nop 0
  buffer_load_dwordx4 v16, s[60:63], s27 offen lds
  s_add_u32 m0, s25, 17408
  s_nop 0
  buffer_load_dwordx4 v17, s[60:63], s27 offen lds
  s_add_u32 m0, s25, 18432
  s_nop 0
  buffer_load_dwordx4 v18, s[60:63], s27 offen lds
  s_add_u32 m0, s25, 19456
  s_nop 0
  buffer_load_dwordx4 v19, s[60:63], s27 offen lds
  s_add_u32 m0, s25, 20480
  s_nop 0
  buffer_load_dwordx4 v20, s[60:63], s27 offen lds
  s_add_u32 m0, s25, 21504
  s_nop 0
  buffer_load_dwordx4 v21, s[60:63], s27 offen lds
  s_add_u32 m0, s25, 22528
  s_nop 0
  buffer_load_dwordx4 v22, s[60:63], s27 offen lds
  s_add_u32 m0, s25, 23552
  s_nop 0
  buffer_load_dwordx4 v23, s[60:63], s27 offen lds
  s_add_u32 m0, s25, 24576
  s_nop 0
  buffer_load_dwordx4 v24, s[60:63], s27 offen lds
  s_add_u32 m0, s25, 25600
  s_nop 0
  buffer_load_dwordx4 v25, s[60:63], s27 offen lds
  s_add_u32 m0, s25, 26624
  s_nop 0
  buffer_load_dwordx4 v26, s[60:63], s27 offen lds
  s_add_u32 m0, s25, 27648
  s_nop 0
  buffer_load_dwordx4 v27, s[60:63], s27 offen lds
  s_add_u32 m0, s25, 28672
  s_nop 0
  buffer_load_dwordx4 v28, s[60:63], s27 offen lds
  s_add_u32 m0, s25, 29696
  s_nop 0
  buffer_load_dwordx4 v29, s[60:63], s27 offen lds
  s_add_u32 m0, s25, 30720
  s_nop 0
  buffer_load_dwordx4 v30, s[60:63], s27 offen lds
  s_add_u32 m0, s25, 31744
  s_nop 0
  buffer_load_dwordx4 v31, s[60:63], s27 offen lds
  v_lshrrev_b32 v7, 2, v4
  v_lshlrev_b32 v7, 4, v7
  v_and_b32 v8, 2, v4
  v_lshl_add_u32 v7, v8, 1, v7
  v_and_b32 v8, 1, v4
  v_add_u32 v7, v7, v8
  v_add_u32 v7, 0, v7
  v_and_b32 v9, 15, v7
  v_or_b32 v10, 0, v3
  v_xor_b32 v10, v10, v9
  v_lshlrev_b32 v10, 4, v10
  v_lshl_add_u32 v10, v7, 9, v10
  ds_read_b128 v[128:131], v10 offset:0
  ds_read_b128 v[144:147], v10 offset:256
  v_or_b32 v10, 4, v3
  v_xor_b32 v10, v10, v9
  v_lshlrev_b32 v10, 4, v10
  v_lshl_add_u32 v10, v7, 9, v10
  ds_read_b128 v[132:135], v10 offset:0
  ds_read_b128 v[148:151], v10 offset:256
  v_or_b32 v10, 8, v3
  v_xor_b32 v10, v10, v9
  v_lshlrev_b32 v10, 4, v10
  v_lshl_add_u32 v10, v7, 9, v10
  ds_read_b128 v[136:139], v10 offset:0
  ds_read_b128 v[152:155], v10 offset:256
  v_or_b32 v10, 12, v3
  v_xor_b32 v10, v10, v9
  v_lshlrev_b32 v10, 4, v10
  v_lshl_add_u32 v10, v7, 9, v10
  ds_read_b128 v[140:143], v10 offset:0
  ds_read_b128 v[156:159], v10 offset:256
  s_waitcnt lgkmcnt(0)
  s_mul_i32 s30, s17, 401408
  s_mul_i32 s31, s18, 57344
  s_add_u32 s30, s30, s31
  s_add_u32 s30, s30, 0
  v_add_u32 v12, s30, v2
  v_lshrrev_b32 v7, 2, v4
  v_lshlrev_b32 v7, 4, v7
  v_and_b32 v8, 2, v4
  v_lshl_add_u32 v7, v8, 1, v7
  v_and_b32 v8, 1, v4
  v_add_u32 v7, v7, v8
  v_add_u32 v7, 2, v7
  v_and_b32 v9, 15, v7
  v_or_b32 v10, 0, v3
  v_xor_b32 v10, v10, v9
  v_lshlrev_b32 v10, 4, v10
  v_lshl_add_u32 v10, v7, 9, v10
  ds_read_b128 v[160:163], v10 offset:0
  ds_read_b128 v[176:179], v10 offset:256
  v_or_b32 v10, 4, v3
  v_xor_b32 v10, v10, v9
  v_lshlrev_b32 v10, 4, v10
  v_lshl_add_u32 v10, v7, 9, v10
  ds_read_b128 v[164:167], v10 offset:0
  ds_read_b128 v[180:183], v10 offset:256
  v_or_b32 v10, 8, v3
  v_xor_b32 v10, v10, v9
  v_lshlrev_b32 v10, 4, v10
  v_lshl_add_u32 v10, v7, 9, v10
  ds_read_b128 v[168:171], v10 offset:0
  ds_read_b128 v[184:187], v10 offset:256
  v_or_b32 v10, 12, v3
  v_xor_b32 v10, v10, v9
  v_lshlrev_b32 v10, 4, v10
  v_lshl_add_u32 v10, v7, 9, v10
  ds_read_b128 v[172:175], v10 offset:0
  ds_read_b128 v[188:191], v10 offset:256
  s_waitcnt lgkmcnt(0)
  s_mul_i32 s30, s17, 401408
  s_mul_i32 s31, s18, 57344
  s_add_u32 s30, s30, s31
  s_add_u32 s30, s30, 14336
  v_add_u32 v13, s30, v2
  v_lshrrev_b32 v7, 2, v4
  v_lshlrev_b32 v7, 4, v7
  v_and_b32 v8, 2, v4
  v_lshl_add_u32 v7, v8, 1, v7
  v_and_b32 v8, 1, v4
  v_add_u32 v7, v7, v8
  v_add_u32 v7, 8, v7
  v_and_b32 v9, 15, v7
  v_or_b32 v10, 0, v3
  v_xor_b32 v10, v10, v9
  v_lshlrev_b32 v10, 4, v10
  v_lshl_add_u32 v10, v7, 9, v10
  ds_read_b128 v[192:195], v10 offset:0
  ds_read_b128 v[208:211], v10 offset:256
  v_or_b32 v10, 4, v3
  v_xor_b32 v10, v10, v9
  v_lshlrev_b32 v10, 4, v10
  v_lshl_add_u32 v10, v7, 9, v10
  ds_read_b128 v[196:199], v10 offset:0
  ds_read_b128 v[212:215], v10 offset:256
  v_or_b32 v10, 8, v3
  v_xor_b32 v10, v10, v9
  v_lshlrev_b32 v10, 4, v10
  v_lshl_add_u32 v10, v7, 9, v10
  ds_read_b128 v[200:203], v10 offset:0
  ds_read_b128 v[216:219], v10 offset:256
  v_or_b32 v10, 12, v3
  v_xor_b32 v10, v10, v9
  v_lshlrev_b32 v10, 4, v10
  v_lshl_add_u32 v10, v7, 9, v10
  ds_read_b128 v[204:207], v10 offset:0
  ds_read_b128 v[220:223], v10 offset:256
  s_waitcnt lgkmcnt(0)
  s_mul_i32 s30, s17, 401408
  s_mul_i32 s31, s18, 57344
  s_add_u32 s30, s30, s31
  s_add_u32 s30, s30, 28672
  v_add_u32 v14, s30, v2
  v_lshrrev_b32 v7, 2, v4
  v_lshlrev_b32 v7, 4, v7
  v_and_b32 v8, 2, v4
  v_lshl_add_u32 v7, v8, 1, v7
  v_and_b32 v8, 1, v4
  v_add_u32 v7, v7, v8
  v_add_u32 v7, 10, v7
  v_and_b32 v9, 15, v7
  v_or_b32 v10, 0, v3
  v_xor_b32 v10, v10, v9
  v_lshlrev_b32 v10, 4, v10
  v_lshl_add_u32 v10, v7, 9, v10
  ds_read_b128 v[224:227], v10 offset:0
  ds_read_b128 v[240:243], v10 offset:256
  v_or_b32 v10, 4, v3
  v_xor_b32 v10, v10, v9
  v_lshlrev_b32 v10, 4, v10
  v_lshl_add_u32 v10, v7, 9, v10
  ds_read_b128 v[228:231], v10 offset:0
  ds_read_b128 v[244:247], v10 offset:256
  v_or_b32 v10, 8, v3
  v_xor_b32 v10, v10, v9
  v_lshlrev_b32 v10, 4, v10
  v_lshl_add_u32 v10, v7, 9, v10
  ds_read_b128 v[232:235], v10 offset:0
  ds_read_b128 v[248:251], v10 offset:256
  v_or_b32 v10, 12, v3
  v_xor_b32 v10, v10, v9
  v_lshlrev_b32 v10, 4, v10
  v_lshl_add_u32 v10, v7, 9, v10
  ds_read_b128 v[236:239], v10 offset:0
  ds_read_b128 v[252:255], v10 offset:256
  s_waitcnt lgkmcnt(0)
  s_mul_i32 s30, s17, 401408
  s_mul_i32 s31, s18, 57344
  s_add_u32 s30, s30, s31
  s_add_u32 s30, s30, 43008
  v_add_u32 v15, s30, v2
  s_branch pw_pr_main
pw_pr_stB:
  s_mul_i32 s27, s17, 229376
  s_lshl_b32 s30, s18, 7
  s_add_u32 s27, s27, s30
  v_lshrrev_b32 v7, 3, v1
  v_and_b32 v8, 7, v1
  s_lshl_b32 s29, s16, 6
  v_add_u32 v7, s29, v7
  v_mul_u32_u24 v7, 896, v7
  v_lshl_add_u32 v7, v8, 4, v7
  s_lshl_b32 s30, s16, 13
  s_add_u32 m0, s30, 0
  s_add_u32 s31, s27, 0
  buffer_load_dwordx4 v7, s[56:59], s31 offen lds
  s_lshl_b32 s30, s16, 13
  s_add_u32 m0, s30, 1024
  s_add_u32 s31, s27, 7168
  buffer_load_dwordx4 v7, s[56:59], s31 offen lds
  s_lshl_b32 s30, s16, 13
  s_add_u32 m0, s30, 2048
  s_add_u32 s31, s27, 14336
  buffer_load_dwordx4 v7, s[56:59], s31 offen lds
  s_lshl_b32 s30, s16, 13
  s_add_u32 m0, s30, 3072
  s_add_u32 s31, s27, 21504
  buffer_load_dwordx4 v7, s[56:59], s31 offen lds
  s_lshl_b32 s30, s16, 13
  s_add_u32 m0, s30, 4096
  s_add_u32 s31, s27, 28672
  buffer_load_dwordx4 v7, s[56:59], s31 offen lds
  s_lshl_b32 s30, s16, 13
  s_add_u32 m0, s30, 5120
  s_add_u32 s31, s27, 35840
  buffer_load_dwordx4 v7, s[56:59], s31 offen lds
  s_lshl_b32 s30, s16, 13
  s_add_u32 m0, s30, 6144
  s_add_u32 s31, s27, 43008
  buffer_load_dwordx4 v7, s[56:59], s31 offen lds
  s_lshl_b32 s30, s16, 13
  s_add_u32 m0, s30, 7168
  s_add_u32 s31, s27, 50176
  buffer_load_dwordx4 v7, s[56:59], s31 offen lds
  s_waitcnt vmcnt(0)
  s_barrier
  s_min_u32 s27, s28, 13
  s_lshl_b32 s27, s27, 18
  s_add_u32 s27, s27, s26
  s_add_u32 m0, s25, 0
  s_nop 0
  buffer_load_dwordx4 v16, s[60:63], s27 offen lds
  s_add_u32 m0, s25, 1024
  s_nop 0
  buffer_load_dwordx4 v17, s[60:63], s27 offen lds
  s_add_u32 m0, s25, 2048
  s_nop 0
  buffer_load_dwordx4 v18, s[60:63], s27 offen lds
  s_add_u32 m0, s25, 3072
  s_nop 0
  buffer_load_dwordx4 v19, s[60:63], s27 offen lds
  s_add_u32 m0, s25, 4096
  s_nop 0
  buffer_load_dwordx4 v20, s[60:63], s27 offen lds
  s_add_u32 m0, s25, 5120
  s_nop 0
  buffer_load_dwordx4 v21, s[60:63], s27 offen lds
  s_add_u32 m0, s25, 6144
  s_nop 0
  buffer_load_dwordx4 v22, s[60:63], s27 offen lds
  s_add_u32 m0, s25, 7168
  s_nop 0
  buffer_load_dwordx4 v23, s[60:63], s27 offen lds
  s_add_u32 m0, s25, 8192
  s_nop 0
  buffer_load_dwordx4 v24, s[60:63], s27 offen lds
  s_add_u32 m0, s25, 9216
  s_nop 0
  buffer_load_dwordx4 v25, s[60:63], s27 offen lds
  s_add_u32 m0, s25, 10240
  s_nop 0
  buffer_load_dwordx4 v26, s[60:63], s27 offen lds
  s_add_u32 m0, s25, 11264
  s_nop 0
  buffer_load_dwordx4 v27, s[60:63], s27 offen lds
  s_add_u32 m0, s25, 12288
  s_nop 0
  buffer_load_dwordx4 v28, s[60:63], s27 offen lds
  s_add_u32 m0, s25, 13312
  s_nop 0
  buffer_load_dwordx4 v29, s[60:63], s27 offen lds
  s_add_u32 m0, s25, 14336
  s_nop 0
  buffer_load_dwordx4 v30, s[60:63], s27 offen lds
  s_add_u32 m0, s25, 15360
  s_nop 0
  buffer_load_dwordx4 v31, s[60:63], s27 offen lds
  s_add_u32 s29, s28, 4
  s_min_u32 s27, s29, 13
  s_lshl_b32 s27, s27, 18
  s_add_u32 s27, s27, s26
  s_add_u32 m0, s25, 16384
  s_nop 0
  buffer_load_dwordx4 v16, s[60:63], s27 offen lds
  s_add_u32 m0, s25, 17408
  s_nop 0
  buffer_load_dwordx4 v17, s[60:63], s27 offen lds
  s_add_u32 m0, s25, 18432
  s_nop 0
  buffer_load_dwordx4 v18, s[60:63], s27 offen lds
  s_add_u32 m0, s25, 19456
  s_nop 0
  buffer_load_dwordx4 v19, s[60:63], s27 offen lds
  s_add_u32 m0, s25, 20480
  s_nop 0
  buffer_load_dwordx4 v20, s[60:63], s27 offen lds
  s_add_u32 m0, s25, 21504
  s_nop 0
  buffer_load_dwordx4 v21, s[60:63], s27 offen lds
  s_add_u32 m0, s25, 22528
  s_nop 0
  buffer_load_dwordx4 v22, s[60:63], s27 offen lds
  s_add_u32 m0, s25, 23552
  s_nop 0
  buffer_load_dwordx4 v23, s[60:63], s27 offen lds
  s_add_u32 m0, s25, 24576
  s_nop 0
  buffer_load_dwordx4 v24, s[60:63], s27 offen lds
  s_add_u32 m0, s25, 25600
  s_nop 0
  buffer_load_dwordx4 v25, s[60:63], s27 offen lds
  s_add_u32 m0, s25, 26624
  s_nop 0
  buffer_load_dwordx4 v26, s[60:63], s27 offen lds
  s_add_u32 m0, s25, 27648
  s_nop 0
  buffer_load_dwordx4 v27, s[60:63], s27 offen lds
  s_add_u32 m0, s25, 28672
  s_nop 0
  buffer_load_dwordx4 v28, s[60:63], s27 offen lds
  s_add_u32 m0, s25, 29696
  s_nop 0
  buffer_load_dwordx4 v29, s[60:63], s27 offen lds
  s_add_u32 m0, s25, 30720
  s_nop 0
  buffer_load_dwordx4 v30, s[60:63], s27 offen lds
  s_add_u32 m0, s25, 31744
  s_nop 0
  buffer_load_dwordx4 v31, s[60:63], s27 offen lds
  v_lshrrev_b32 v7, 2, v4
  v_lshl_add_u32 v7, v3, 3, v7
  v_lshlrev_b32 v7, 7, v7
  v_and_b32 v8, 3, v4
  v_lshl_add_u32 v7, v8, 3, v7
  ds_read_b64_tr_b16 v[128:129], v7 offset:0
  ds_read_b64_tr_b16 v[130:131], v7 offset:512
  ds_read_b64_tr_b16 v[132:133], v7 offset:4096
  ds_read_b64_tr_b16 v[134:135], v7 offset:4608
  ds_read_b64_tr_b16 v[136:137], v7 offset:8192
  ds_read_b64_tr_b16 v[138:139], v7 offset:8704
  ds_read_b64_tr_b16 v[140:141], v7 offset:12288
  ds_read_b64_tr_b16 v[142:143], v7 offset:12800
  s_waitcnt lgkmcnt(0)
  ds_read_b64_tr_b16 v[144:145], v7 offset:16384
  ds_read_b64_tr_b16 v[146:147], v7 offset:16896
  ds_read_b64_tr_b16 v[148:149], v7 offset:20480
  ds_read_b64_tr_b16 v[150:151], v7 offset:20992
  ds_read_b64_tr_b16 v[152:153], v7 offset:24576
  ds_read_b64_tr_b16 v[154:155], v7 offset:25088
  ds_read_b64_tr_b16 v[156:157], v7 offset:28672
  ds_read_b64_tr_b16 v[158:159], v7 offset:29184
  s_waitcnt lgkmcnt(0)
  s_lshl_b32 s30, s18, 6
  s_add_u32 s30, s30, 0
  v_add_u32 v8, s30, v4
  v_subrev_u32 v9, 256, v8
  v_mul_u32_u24 v11, 171, v9
  v_lshrrev_b32 v11, 11, v11
  v_mul_u32_u24 v33, 12, v11
  v_sub_u32 v33, v9, v33
  v_add_u32 v33, 16, v33
  v_lshrrev_b32 v10, 4, v8
  v_cmp_gt_i32 vcc, 0, v9
  s_nop 1
  v_cndmask_b32 v10, v11, v10, vcc
  v_cndmask_b32 v32, v33, v4, vcc
  s_mul_i32 s30, s17, 28
  v_add_u32 v32, s30, v32
  v_lshrrev_b32 v33, 4, v32
  v_and_b32 v32, 15, v32
  s_mov_b32 s30, 401408
  v_mul_lo_u32 v10, v10, s30
  v_mul_u32_u24 v33, 14336, v33
  v_add_u32 v10, v10, v33
  v_lshl_add_u32 v10, v3, 8, v10
  v_lshl_add_u32 v10, v32, 4, v10
  v_add_u32 v12, 6422528, v10
  ds_read_b64_tr_b16 v[160:161], v7 offset:32
  ds_read_b64_tr_b16 v[162:163], v7 offset:544
  ds_read_b64_tr_b16 v[164:165], v7 offset:4128
  ds_read_b64_tr_b16 v[166:167], v7 offset:4640
  ds_read_b64_tr_b16 v[168:169], v7 offset:8224
  ds_read_b64_tr_b16 v[170:171], v7 offset:8736
  ds_read_b64_tr_b16 v[172:173], v7 offset:12320
  ds_read_b64_tr_b16 v[174:175], v7 offset:12832
  s_waitcnt lgkmcnt(0)
  ds_read_b64_tr_b16 v[176:177], v7 offset:16416
  ds_read_b64_tr_b16 v[178:179], v7 offset:16928
  ds_read_b64_tr_b16 v[180:181], v7 offset:20512
  ds_read_b64_tr_b16 v[182:183], v7 offset:21024
  ds_read_b64_tr_b16 v[184:185], v7 offset:24608
  ds_read_b64_tr_b16 v[186:187], v7 offset:25120
  ds_read_b64_tr_b16 v[188:189], v7 offset:28704
  ds_read_b64_tr_b16 v[190:191], v7 offset:29216
  s_waitcnt lgkmcnt(0)
  s_lshl_b32 s30, s18, 6
  s_add_u32 s30, s30, 16
  v_add_u32 v8, s30, v4
  v_subrev_u32 v9, 256, v8
  v_mul_u32_u24 v11, 171, v9
  v_lshrrev_b32 v11, 11, v11
  v_mul_u32_u24 v33, 12, v11
  v_sub_u32 v33, v9, v33
  v_add_u32 v33, 16, v33
  v_lshrrev_b32 v10, 4, v8
  v_cmp_gt_i32 vcc, 0, v9
  s_nop 1
  v_cndmask_b32 v10, v11, v10, vcc
  v_cndmask_b32 v32, v33, v4, vcc
  s_mul_i32 s30, s17, 28
  v_add_u32 v32, s30, v32
  v_lshrrev_b32 v33, 4, v32
  v_and_b32 v32, 15, v32
  s_mov_b32 s30, 401408
  v_mul_lo_u32 v10, v10, s30
  v_mul_u32_u24 v33, 14336, v33
  v_add_u32 v10, v10, v33
  v_lshl_add_u32 v10, v3, 8, v10
  v_lshl_add_u32 v10, v32, 4, v10
  v_add_u32 v13, 6422528, v10
  ds_read_b64_tr_b16 v[192:193], v7 offset:64
  ds_read_b64_tr_b16 v[194:195], v7 offset:576
  ds_read_b64_tr_b16 v[196:197], v7 offset:4160
  ds_read_b64_tr_b16 v[198:199], v7 offset:4672
  ds_read_b64_tr_b16 v[200:201], v7 offset:8256
  ds_read_b64_tr_b16 v[202:203], v7 offset:8768
  ds_read_b64_tr_b16 v[204:205], v7 offset:12352
  ds_read_b64_tr_b16 v[206:207], v7 offset:12864
  s_waitcnt lgkmcnt(0)
  ds_read_b64_tr_b16 v[208:209], v7 offset:16448
  ds_read_b64_tr_b16 v[210:211], v7 offset:16960
  ds_read_b64_tr_b16 v[212:213], v7 offset:20544
  ds_read_b64_tr_b16 v[214:215], v7 offset:21056
  ds_read_b64_tr_b16 v[216:217], v7 offset:24640
  ds_read_b64_tr_b16 v[218:219], v7 offset:25152
  ds_read_b64_tr_b16 v[220:221], v7 offset:28736
  ds_read_b64_tr_b16 v[222:223], v7 offset:29248
  s_waitcnt lgkmcnt(0)
  s_lshl_b32 s30, s18, 6
  s_add_u32 s30, s30, 32
  v_add_u32 v8, s30, v4
  v_subrev_u32 v9, 256, v8
  v_mul_u32_u24 v11, 171, v9
  v_lshrrev_b32 v11, 11, v11
  v_mul_u32_u24 v33, 12, v11
  v_sub_u32 v33, v9, v33
  v_add_u32 v33, 16, v33
  v_lshrrev_b32 v10, 4, v8
  v_cmp_gt_i32 vcc, 0, v9
  s_nop 1
  v_cndmask_b32 v10, v11, v10, vcc
  v_cndmask_b32 v32, v33, v4, vcc
  s_mul_i32 s30, s17, 28
  v_add_u32 v32, s30, v32
  v_lshrrev_b32 v33, 4, v32
  v_and_b32 v32, 15, v32
  s_mov_b32 s30, 401408
  v_mul_lo_u32 v10, v10, s30
  v_mul_u32_u24 v33, 14336, v33
  v_add_u32 v10, v10, v33
  v_lshl_add_u32 v10, v3, 8, v10
  v_lshl_add_u32 v10, v32, 4, v10
  v_add_u32 v14, 6422528, v10
  ds_read_b64_tr_b16 v[224:225], v7 offset:96
  ds_read_b64_tr_b16 v[226:227], v7 offset:608
  ds_read_b64_tr_b16 v[228:229], v7 offset:4192
  ds_read_b64_tr_b16 v[230:231], v7 offset:4704
  ds_read_b64_tr_b16 v[232:233], v7 offset:8288
  ds_read_b64_tr_b16 v[234:235], v7 offset:8800
  ds_read_b64_tr_b16 v[236:237], v7 offset:12384
  ds_read_b64_tr_b16 v[238:239], v7 offset:12896
  s_waitcnt lgkmcnt(0)
  ds_read_b64_tr_b16 v[240:241], v7 offset:16480
  ds_read_b64_tr_b16 v[242:243], v7 offset:16992
  ds_read_b64_tr_b16 v[244:245], v7 offset:20576
  ds_read_b64_tr_b16 v[246:247], v7 offset:21088
  ds_read_b64_tr_b16 v[248:249], v7 offset:24672
  ds_read_b64_tr_b16 v[250:251], v7 offset:25184
  ds_read_b64_tr_b16 v[252:253], v7 offset:28768
  ds_read_b64_tr_b16 v[254:255], v7 offset:29280
  s_waitcnt lgkmcnt(0)
  s_lshl_b32 s30, s18, 6
  s_add_u32 s30, s30, 48
  v_add_u32 v8, s30, v4
  v_subrev_u32 v9, 256, v8
  v_mul_u32_u24 v11, 171, v9
  v_lshrrev_b32 v11, 11, v11
  v_mul_u32_u24 v33, 12, v11
  v_sub_u32 v33, v9, v33
  v_add_u32 v33, 16, v33
  v_lshrrev_b32 v10, 4, v8
  v_cmp_gt_i32 vcc, 0, v9
  s_nop 1
  v_cndmask_b32 v10, v11, v10, vcc
  v_cndmask_b32 v32, v33, v4, vcc
  s_mul_i32 s30, s17, 28
  v_add_u32 v32, s30, v32
  v_lshrrev_b32 v33, 4, v32
  v_and_b32 v32, 15, v32
  s_mov_b32 s30, 401408
  v_mul_lo_u32 v10, v10, s30
  v_mul_u32_u24 v33, 14336, v33
  v_add_u32 v10, v10, v33
  v_lshl_add_u32 v10, v3, 8, v10
  v_lshl_add_u32 v10, v32, 4, v10
  v_add_u32 v15, 6422528, v10
pw_pr_main:
  v_lshrrev_b32 v7, 2, v4
  v_lshlrev_b32 v7, 3, v7
  v_and_b32 v8, 3, v4
  v_add_u32 v7, v7, v8
  v_or_b32 v10, 0, v3
  v_xor_b32 v10, v10, v4
  v_lshlrev_b32 v10, 4, v10
  v_lshl_add_u32 v10, v7, 9, v10
  v_add_u32 v32, s25, v10
  v_or_b32 v10, 4, v3
  v_xor_b32 v10, v10, v4
  v_lshlrev_b32 v10, 4, v10
  v_lshl_add_u32 v10, v7, 9, v10
  v_add_u32 v33, s25, v10
  v_or_b32 v10, 8, v3
  v_xor_b32 v10, v10, v4
  v_lshlrev_b32 v10, 4, v10
  v_lshl_add_u32 v10, v7, 9, v10
  v_add_u32 v34, s25, v10
  v_or_b32 v10, 12, v3
  v_xor_b32 v10, v10, v4
  v_lshlrev_b32 v10, 4, v10
  v_lshl_add_u32 v10, v7, 9, v10
  v_add_u32 v35, s25, v10
  s_waitcnt vmcnt(16) lgkmcnt(0)
  ds_read_b128 v[36:39], v32 offset:0
  ds_read_b128 v[40:43], v33 offset:0
  ds_read_b128 v[44:47], v34 offset:0
  ds_read_b128 v[48:51], v35 offset:0
  ds_read_b128 v[52:55], v32 offset:256
  ds_read_b128 v[56:59], v33 offset:256
  ds_read_b128 v[60:63], v34 offset:256
  ds_read_b128 v[64:67], v35 offset:256
  s_waitcnt lgkmcnt(7)
  v_mfma_f32_16x16x32_bf16 v[96:99], v[36:39], v[128:131], 0
  v_mfma_f32_16x16x32_bf16 v[100:103], v[36:39], v[160:163], 0
  v_mfma_f32_16x16x32_bf16 v[104:107], v[36:39], v[192:195], 0
  v_mfma_f32_16x16x32_bf16 v[108:111], v[36:39], v[224:227], 0
  s_waitcnt lgkmcnt(6)
  v_mfma_f32_16x16x32_bf16 v[96:99], v[40:43], v[132:135], v[96:99]
  v_mfma_f32_16x16x32_bf16 v[100:103], v[40:43], v[164:167], v[100:103]
  v_mfma_f32_16x16x32_bf16 v[104:107], v[40:43], v[196:199], v[104:107]
  v_mfma_f32_16x16x32_bf16 v[108:111], v[40:43], v[228:231], v[108:111]
  s_waitcnt lgkmcnt(5)
  v_mfma_f32_16x16x32_bf16 v[96:99], v[44:47], v[136:139], v[96:99]
  v_mfma_f32_16x16x32_bf16 v[100:103], v[44:47], v[168:171], v[100:103]
  v_mfma_f32_16x16x32_bf16 v[104:107], v[44:47], v[200:203], v[104:107]
  v_mfma_f32_16x16x32_bf16 v[108:111], v[44:47], v[232:235], v[108:111]
  s_waitcnt lgkmcnt(4)
  v_mfma_f32_16x16x32_bf16 v[96:99], v[48:51], v[140:143], v[96:99]
  v_mfma_f32_16x16x32_bf16 v[100:103], v[48:51], v[172:175], v[100:103]
  v_mfma_f32_16x16x32_bf16 v[104:107], v[48:51], v[204:207], v[104:107]
  v_mfma_f32_16x16x32_bf16 v[108:111], v[48:51], v[236:239], v[108:111]
  s_waitcnt lgkmcnt(3)
  v_mfma_f32_16x16x32_bf16 v[96:99], v[52:55], v[144:147], v[96:99]
  v_mfma_f32_16x16x32_bf16 v[100:103], v[52:55], v[176:179], v[100:103]
  v_mfma_f32_16x16x32_bf16 v[104:107], v[52:55], v[208:211], v[104:107]
  v_mfma_f32_16x16x32_bf16 v[108:111], v[52:55], v[240:243], v[108:111]
  s_waitcnt lgkmcnt(2)
  v_mfma_f32_16x16x32_bf16 v[96:99], v[56:59], v[148:151], v[96:99]
  v_mfma_f32_16x16x32_bf16 v[100:103], v[56:59], v[180:183], v[100:103]
  v_mfma_f32_16x16x32_bf16 v[104:107], v[56:59], v[212:215], v[104:107]
  v_mfma_f32_16x16x32_bf16 v[108:111], v[56:59], v[244:247], v[108:111]
  s_waitcnt lgkmcnt(1)
  v_mfma_f32_16x16x32_bf16 v[96:99], v[60:63], v[152:155], v[96:99]
  v_mfma_f32_16x16x32_bf16 v[100:103], v[60:63], v[184:187], v[100:103]
  v_mfma_f32_16x16x32_bf16 v[104:107], v[60:63], v[216:219], v[104:107]
  v_mfma_f32_16x16x32_bf16 v[108:111], v[60:63], v[248:251], v[108:111]
  s_waitcnt lgkmcnt(0)
  v_mfma_f32_16x16x32_bf16 v[96:99], v[64:67], v[156:159], v[96:99]
  v_mfma_f32_16x16x32_bf16 v[100:103], v[64:67], v[188:191], v[100:103]
  v_mfma_f32_16x16x32_bf16 v[104:107], v[64:67], v[220:223], v[104:107]
  v_mfma_f32_16x16x32_bf16 v[108:111], v[64:67], v[252:255], v[108:111]
  ds_read_b128 v[36:39], v32 offset:2048
  ds_read_b128 v[40:43], v33 offset:2048
  ds_read_b128 v[44:47], v34 offset:2048
  ds_read_b128 v[48:51], v35 offset:2048
  ds_read_b128 v[52:55], v32 offset:2304
  ds_read_b128 v[56:59], v33 offset:2304
  ds_read_b128 v[60:63], v34 offset:2304
  ds_read_b128 v[64:67], v35 offset:2304
  s_waitcnt lgkmcnt(7)
  v_mfma_f32_16x16x32_bf16 v[112:115], v[36:39], v[128:131], 0
  v_mfma_f32_16x16x32_bf16 v[116:119], v[36:39], v[160:163], 0
  v_mfma_f32_16x16x32_bf16 v[120:123], v[36:39], v[192:195], 0
  v_mfma_f32_16x16x32_bf16 v[124:127], v[36:39], v[224:227], 0
  s_waitcnt lgkmcnt(6)
  v_mfma_f32_16x16x32_bf16 v[112:115], v[40:43], v[132:135], v[112:115]
  v_mfma_f32_16x16x32_bf16 v[116:119], v[40:43], v[164:167], v[116:119]
  v_mfma_f32_16x16x32_bf16 v[120:123], v[40:43], v[196:199], v[120:123]
  v_mfma_f32_16x16x32_bf16 v[124:127], v[40:43], v[228:231], v[124:127]
  s_waitcnt lgkmcnt(5)
  v_mfma_f32_16x16x32_bf16 v[112:115], v[44:47], v[136:139], v[112:115]
  v_mfma_f32_16x16x32_bf16 v[116:119], v[44:47], v[168:171], v[116:119]
  v_mfma_f32_16x16x32_bf16 v[120:123], v[44:47], v[200:203], v[120:123]
  v_mfma_f32_16x16x32_bf16 v[124:127], v[44:47], v[232:235], v[124:127]
  s_waitcnt lgkmcnt(4)
  v_mfma_f32_16x16x32_bf16 v[112:115], v[48:51], v[140:143], v[112:115]
  v_mfma_f32_16x16x32_bf16 v[116:119], v[48:51], v[172:175], v[116:119]
  v_mfma_f32_16x16x32_bf16 v[120:123], v[48:51], v[204:207], v[120:123]
  v_mfma_f32_16x16x32_bf16 v[124:127], v[48:51], v[236:239], v[124:127]
  s_waitcnt lgkmcnt(3)
  v_mfma_f32_16x16x32_bf16 v[112:115], v[52:55], v[144:147], v[112:115]
  v_mfma_f32_16x16x32_bf16 v[116:119], v[52:55], v[176:179], v[116:119]
  v_mfma_f32_16x16x32_bf16 v[120:123], v[52:55], v[208:211], v[120:123]
  v_mfma_f32_16x16x32_bf16 v[124:127], v[52:55], v[240:243], v[124:127]
  s_waitcnt lgkmcnt(2)
  v_mfma_f32_16x16x32_bf16 v[112:115], v[56:59], v[148:151], v[112:115]
  v_mfma_f32_16x16x32_bf16 v[116:119], v[56:59], v[180:183], v[116:119]
  v_mfma_f32_16x16x32_bf16 v[120:123], v[56:59], v[212:215], v[120:123]
  v_mfma_f32_16x16x32_bf16 v[124:127], v[56:59], v[244:247], v[124:127]
  s_waitcnt lgkmcnt(1)
  v_mfma_f32_16x16x32_bf16 v[112:115], v[60:63], v[152:155], v[112:115]
  v_mfma_f32_16x16x32_bf16 v[116:119], v[60:63], v[184:187], v[116:119]
  v_mfma_f32_16x16x32_bf16 v[120:123], v[60:63], v[216:219], v[120:123]
  v_mfma_f32_16x16x32_bf16 v[124:127], v[60:63], v[248:251], v[124:127]
  s_waitcnt lgkmcnt(0)
  s_add_u32 s29, s28, 8
  s_min_u32 s27, s29, 13
  s_lshl_b32 s27, s27, 18
  s_add_u32 s27, s27, s26
  s_add_u32 m0, s25, 0
  s_nop 0
  buffer_load_dwordx4 v16, s[60:63], s27 offen lds
  s_add_u32 m0, s25, 1024
  s_nop 0
  buffer_load_dwordx4 v17, s[60:63], s27 offen lds
  s_add_u32 m0, s25, 2048
  s_nop 0
  buffer_load_dwordx4 v18, s[60:63], s27 offen lds
  s_add_u32 m0, s25, 3072
  s_nop 0
  buffer_load_dwordx4 v19, s[60:63], s27 offen lds
  s_add_u32 m0, s25, 4096
  s_nop 0
  buffer_load_dwordx4 v20, s[60:63], s27 offen lds
  s_add_u32 m0, s25, 5120
  s_nop 0
  buffer_load_dwordx4 v21, s[60:63], s27 offen lds
  s_add_u32 m0, s25, 6144
  s_nop 0
  buffer_load_dwordx4 v22, s[60:63], s27 offen lds
  s_add_u32 m0, s25, 7168
  s_nop 0
  buffer_load_dwordx4 v23, s[60:63], s27 offen lds
  s_add_u32 m0, s25, 8192
  s_nop 0
  buffer_load_dwordx4 v24, s[60:63], s27 offen lds
  s_add_u32 m0, s25, 9216
  s_nop 0
  buffer_load_dwordx4 v25, s[60:63], s27 offen lds
  s_add_u32 m0, s25, 10240
  s_nop 0
  buffer_load_dwordx4 v26, s[60:63], s27 offen lds
  s_add_u32 m0, s25, 11264
  s_nop 0
  buffer_load_dwordx4 v27, s[60:63], s27 offen lds
  s_add_u32 m0, s25, 12288
  s_nop 0
  buffer_load_dwordx4 v28, s[60:63], s27 offen lds
  s_add_u32 m0, s25, 13312
  s_nop 0
  buffer_load_dwordx4 v29, s[60:63], s27 offen lds
  s_add_u32 m0, s25, 14336
  s_nop 0
  buffer_load_dwordx4 v30, s[60:63], s27 offen lds
  s_add_u32 m0, s25, 15360
  s_nop 0
  buffer_load_dwordx4 v31, s[60:63], s27 offen lds
  v_mfma_f32_16x16x32_bf16 v[112:115], v[64:67], v[156:159], v[112:115]
  v_mfma_f32_16x16x32_bf16 v[116:119], v[64:67], v[188:191], v[116:119]
  v_mfma_f32_16x16x32_bf16 v[120:123], v[64:67], v[220:223], v[120:123]
  v_mfma_f32_16x16x32_bf16 v[124:127], v[64:67], v[252:255], v[124:127]
  s_lshl_b32 s30, s28, 10
  v_mul_f32 v96, s24, v96
  v_mul_f32 v97, s24, v97
  v_mul_f32 v98, s24, v98
  v_mul_f32 v99, s24, v99
  v_cvt_pk_bf16_f32 v68, v96, v97
  v_cvt_pk_bf16_f32 v69, v98, v99
  v_mul_f32 v112, s24, v112
  v_mul_f32 v113, s24, v113
  v_mul_f32 v114, s24, v114
  v_mul_f32 v115, s24, v115
  v_cvt_pk_bf16_f32 v70, v112, v113
  v_cvt_pk_bf16_f32 v71, v114, v115
  buffer_store_dwordx4 v[68:71], v12, s[8:11], s30 offen
  v_mul_f32 v100, s24, v100
  v_mul_f32 v101, s24, v101
  v_mul_f32 v102, s24, v102
  v_mul_f32 v103, s24, v103
  v_cvt_pk_bf16_f32 v72, v100, v101
  v_cvt_pk_bf16_f32 v73, v102, v103
  v_mul_f32 v116, s24, v116
  v_mul_f32 v117, s24, v117
  v_mul_f32 v118, s24, v118
  v_mul_f32 v119, s24, v119
  v_cvt_pk_bf16_f32 v74, v116, v117
  v_cvt_pk_bf16_f32 v75, v118, v119
  buffer_store_dwordx4 v[72:75], v13, s[8:11], s30 offen
  v_mul_f32 v104, s24, v104
  v_mul_f32 v105, s24, v105
  v_mul_f32 v106, s24, v106
  v_mul_f32 v107, s24, v107
  v_cvt_pk_bf16_f32 v76, v104, v105
  v_cvt_pk_bf16_f32 v77, v106, v107
  v_mul_f32 v120, s24, v120
  v_mul_f32 v121, s24, v121
  v_mul_f32 v122, s24, v122
  v_mul_f32 v123, s24, v123
  v_cvt_pk_bf16_f32 v78, v120, v121
  v_cvt_pk_bf16_f32 v79, v122, v123
  buffer_store_dwordx4 v[76:79], v14, s[8:11], s30 offen
  v_mul_f32 v108, s24, v108
  v_mul_f32 v109, s24, v109
  v_mul_f32 v110, s24, v110
  v_mul_f32 v111, s24, v111
  v_cvt_pk_bf16_f32 v80, v108, v109
  v_cvt_pk_bf16_f32 v81, v110, v111
  v_mul_f32 v124, s24, v124
  v_mul_f32 v125, s24, v125
  v_mul_f32 v126, s24, v126
  v_mul_f32 v127, s24, v127
  v_cvt_pk_bf16_f32 v82, v124, v125
  v_cvt_pk_bf16_f32 v83, v126, v127
  buffer_store_dwordx4 v[80:83], v15, s[8:11], s30 offen
  s_add_u32 s28, s28, 4
  s_waitcnt vmcnt(20) lgkmcnt(0)
  ds_read_b128 v[36:39], v32 offset:16384
  ds_read_b128 v[40:43], v33 offset:16384
  ds_read_b128 v[44:47], v34 offset:16384
  ds_read_b128 v[48:51], v35 offset:16384
  ds_read_b128 v[52:55], v32 offset:16640
  ds_read_b128 v[56:59], v33 offset:16640
  ds_read_b128 v[60:63], v34 offset:16640
  ds_read_b128 v[64:67], v35 offset:16640
  s_waitcnt lgkmcnt(7)
  v_mfma_f32_16x16x32_bf16 v[96:99], v[36:39], v[128:131], 0
  v_mfma_f32_16x16x32_bf16 v[100:103], v[36:39], v[160:163], 0
  v_mfma_f32_16x16x32_bf16 v[104:107], v[36:39], v[192:195], 0
  v_mfma_f32_16x16x32_bf16 v[108:111], v[36:39], v[224:227], 0
  s_waitcnt lgkmcnt(6)
  v_mfma_f32_16x16x32_bf16 v[96:99], v[40:43], v[132:135], v[96:99]
  v_mfma_f32_16x16x32_bf16 v[100:103], v[40:43], v[164:167], v[100:103]
  v_mfma_f32_16x16x32_bf16 v[104:107], v[40:43], v[196:199], v[104:107]
  v_mfma_f32_16x16x32_bf16 v[108:111], v[40:43], v[228:231], v[108:111]
  s_waitcnt lgkmcnt(5)
  v_mfma_f32_16x16x32_bf16 v[96:99], v[44:47], v[136:139], v[96:99]
  v_mfma_f32_16x16x32_bf16 v[100:103], v[44:47], v[168:171], v[100:103]
  v_mfma_f32_16x16x32_bf16 v[104:107], v[44:47], v[200:203], v[104:107]
  v_mfma_f32_16x16x32_bf16 v[108:111], v[44:47], v[232:235], v[108:111]
  s_waitcnt lgkmcnt(4)
  v_mfma_f32_16x16x32_bf16 v[96:99], v[48:51], v[140:143], v[96:99]
  v_mfma_f32_16x16x32_bf16 v[100:103], v[48:51], v[172:175], v[100:103]
  v_mfma_f32_16x16x32_bf16 v[104:107], v[48:51], v[204:207], v[104:107]
  v_mfma_f32_16x16x32_bf16 v[108:111], v[48:51], v[236:239], v[108:111]
  s_waitcnt lgkmcnt(3)
  v_mfma_f32_16x16x32_bf16 v[96:99], v[52:55], v[144:147], v[96:99]
  v_mfma_f32_16x16x32_bf16 v[100:103], v[52:55], v[176:179], v[100:103]
  v_mfma_f32_16x16x32_bf16 v[104:107], v[52:55], v[208:211], v[104:107]
  v_mfma_f32_16x16x32_bf16 v[108:111], v[52:55], v[240:243], v[108:111]
  s_waitcnt lgkmcnt(2)
  v_mfma_f32_16x16x32_bf16 v[96:99], v[56:59], v[148:151], v[96:99]
  v_mfma_f32_16x16x32_bf16 v[100:103], v[56:59], v[180:183], v[100:103]
  v_mfma_f32_16x16x32_bf16 v[104:107], v[56:59], v[212:215], v[104:107]
  v_mfma_f32_16x16x32_bf16 v[108:111], v[56:59], v[244:247], v[108:111]
  s_waitcnt lgkmcnt(1)
  v_mfma_f32_16x16x32_bf16 v[96:99], v[60:63], v[152:155], v[96:99]
  v_mfma_f32_16x16x32_bf16 v[100:103], v[60:63], v[184:187], v[100:103]
  v_mfma_f32_16x16x32_bf16 v[104:107], v[60:63], v[216:219], v[104:107]
  v_mfma_f32_16x16x32_bf16 v[108:111], v[60:63], v[248:251], v[108:111]
  s_waitcnt lgkmcnt(0)
  v_mfma_f32_16x16x32_bf16 v[96:99], v[64:67], v[156:159], v[96:99]
  v_mfma_f32_16x16x32_bf16 v[100:103], v[64:67], v[188:191], v[100:103]
  v_mfma_f32_16x16x32_bf16 v[104:107], v[64:67], v[220:223], v[104:107]
  v_mfma_f32_16x16x32_bf16 v[108:111], v[64:67], v[252:255], v[108:111]
  ds_read_b128 v[36:39], v32 offset:18432
  ds_read_b128 v[40:43], v33 offset:18432
  ds_read_b128 v[44:47], v34 offset:18432
  ds_read_b128 v[48:51], v35 offset:18432
  ds_read_b128 v[52:55], v32 offset:18688
  ds_read_b128 v[56:59], v33 offset:18688
  ds_read_b128 v[60:63], v34 offset:18688
  ds_read_b128 v[64:67], v35 offset:18688
  s_waitcnt lgkmcnt(7)
  v_mfma_f32_16x16x32_bf16 v[112:115], v[36:39], v[128:131], 0
  v_mfma_f32_16x16x32_bf16 v[116:119], v[36:39], v[160:163], 0
  v_mfma_f32_16x16x32_bf16 v[120:123], v[36:39], v[192:195], 0
  v_mfma_f32_16x16x32_bf16 v[124:127], v[36:39], v[224:227], 0
  s_waitcnt lgkmcnt(6)
  v_mfma_f32_16x16x32_bf16 v[112:115], v[40:43], v[132:135], v[112:115]
  v_mfma_f32_16x16x32_bf16 v[116:119], v[40:43], v[164:167], v[116:119]
  v_mfma_f32_16x16x32_bf16 v[120:123], v[40:43], v[196:199], v[120:123]
  v_mfma_f32_16x16x32_bf16 v[124:127], v[40:43], v[228:231], v[124:127]
  s_waitcnt lgkmcnt(5)
  v_mfma_f32_16x16x32_bf16 v[112:115], v[44:47], v[136:139], v[112:115]
  v_mfma_f32_16x16x32_bf16 v[116:119], v[44:47], v[168:171], v[116:119]
  v_mfma_f32_16x16x32_bf16 v[120:123], v[44:47], v[200:203], v[120:123]
  v_mfma_f32_16x16x32_bf16 v[124:127], v[44:47], v[232:235], v[124:127]
  s_waitcnt lgkmcnt(4)
  v_mfma_f32_16x16x32_bf16 v[112:115], v[48:51], v[140:143], v[112:115]
  v_mfma_f32_16x16x32_bf16 v[116:119], v[48:51], v[172:175], v[116:119]
  v_mfma_f32_16x16x32_bf16 v[120:123], v[48:51], v[204:207], v[120:123]
  v_mfma_f32_16x16x32_bf16 v[124:127], v[48:51], v[236:239], v[124:127]
  s_waitcnt lgkmcnt(3)
  v_mfma_f32_16x16x32_bf16 v[112:115], v[52:55], v[144:147], v[112:115]
  v_mfma_f32_16x16x32_bf16 v[116:119], v[52:55], v[176:179], v[116:119]
  v_mfma_f32_16x16x32_bf16 v[120:123], v[52:55], v[208:211], v[120:123]
  v_mfma_f32_16x16x32_bf16 v[124:127], v[52:55], v[240:243], v[124:127]
  s_waitcnt lgkmcnt(2)
  v_mfma_f32_16x16x32_bf16 v[112:115], v[56:59], v[148:151], v[112:115]
  v_mfma_f32_16x16x32_bf16 v[116:119], v[56:59], v[180:183], v[116:119]
  v_mfma_f32_16x16x32_bf16 v[120:123], v[56:59], v[212:215], v[120:123]
  v_mfma_f32_16x16x32_bf16 v[124:127], v[56:59], v[244:247], v[124:127]
  s_waitcnt lgkmcnt(1)
  v_mfma_f32_16x16x32_bf16 v[112:115], v[60:63], v[152:155], v[112:115]
  v_mfma_f32_16x16x32_bf16 v[116:119], v[60:63], v[184:187], v[116:119]
  v_mfma_f32_16x16x32_bf16 v[120:123], v[60:63], v[216:219], v[120:123]
  v_mfma_f32_16x16x32_bf16 v[124:127], v[60:63], v[248:251], v[124:127]
  s_waitcnt lgkmcnt(0)
  s_add_u32 s29, s28, 8
  s_min_u32 s27, s29, 13
  s_lshl_b32 s27, s27, 18
  s_add_u32 s27, s27, s26
  s_add_u32 m0, s25, 16384
  s_nop 0
  buffer_load_dwordx4 v16, s[60:63], s27 offen lds
  s_add_u32 m0, s25, 17408
  s_nop 0
  buffer_load_dwordx4 v17, s[60:63], s27 offen lds
  s_add_u32 m0, s25, 18432
  s_nop 0
  buffer_load_dwordx4 v18, s[60:63], s27 offen lds
  s_add_u32 m0, s25, 19456
  s_nop 0
  buffer_load_dwordx4 v19, s[60:63], s27 offen lds
  s_add_u32 m0, s25, 20480
  s_nop 0
  buffer_load_dwordx4 v20, s[60:63], s27 offen lds
  s_add_u32 m0, s25, 21504
  s_nop 0
  buffer_load_dwordx4 v21, s[60:63], s27 offen lds
  s_add_u32 m0, s25, 22528
  s_nop 0
  buffer_load_dwordx4 v22, s[60:63], s27 offen lds
  s_add_u32 m0, s25, 23552
  s_nop 0
  buffer_load_dwordx4 v23, s[60:63], s27 offen lds
  s_add_u32 m0, s25, 24576
  s_nop 0
  buffer_load_dwordx4 v24, s[60:63], s27 offen lds
  s_add_u32 m0, s25, 25600
  s_nop 0
  buffer_load_dwordx4 v25, s[60:63], s27 offen lds
  s_add_u32 m0, s25, 26624
  s_nop 0
  buffer_load_dwordx4 v26, s[60:63], s27 offen lds
  s_add_u32 m0, s25, 27648
  s_nop 0
  buffer_load_dwordx4 v27, s[60:63], s27 offen lds
  s_add_u32 m0, s25, 28672
  s_nop 0
  buffer_load_dwordx4 v28, s[60:63], s27 offen lds
  s_add_u32 m0, s25, 29696
  s_nop 0
  buffer_load_dwordx4 v29, s[60:63], s27 offen lds
  s_add_u32 m0, s25, 30720
  s_nop 0
  buffer_load_dwordx4 v30, s[60:63], s27 offen lds
  s_add_u32 m0, s25, 31744
  s_nop 0
  buffer_load_dwordx4 v31, s[60:63], s27 offen lds
  v_mfma_f32_16x16x32_bf16 v[112:115], v[64:67], v[156:159], v[112:115]
  v_mfma_f32_16x16x32_bf16 v[116:119], v[64:67], v[188:191], v[116:119]
  v_mfma_f32_16x16x32_bf16 v[120:123], v[64:67], v[220:223], v[120:123]
  v_mfma_f32_16x16x32_bf16 v[124:127], v[64:67], v[252:255], v[124:127]
  s_lshl_b32 s30, s28, 10
  v_mul_f32 v96, s24, v96
  v_mul_f32 v97, s24, v97
  v_mul_f32 v98, s24, v98
  v_mul_f32 v99, s24, v99
  v_cvt_pk_bf16_f32 v68, v96, v97
  v_cvt_pk_bf16_f32 v69, v98, v99
  v_mul_f32 v112, s24, v112
  v_mul_f32 v113, s24, v113
  v_mul_f32 v114, s24, v114
  v_mul_f32 v115, s24, v115
  v_cvt_pk_bf16_f32 v70, v112, v113
  v_cvt_pk_bf16_f32 v71, v114, v115
  buffer_store_dwordx4 v[68:71], v12, s[8:11], s30 offen
  v_mul_f32 v100, s24, v100
  v_mul_f32 v101, s24, v101
  v_mul_f32 v102, s24, v102
  v_mul_f32 v103, s24, v103
  v_cvt_pk_bf16_f32 v72, v100, v101
  v_cvt_pk_bf16_f32 v73, v102, v103
  v_mul_f32 v116, s24, v116
  v_mul_f32 v117, s24, v117
  v_mul_f32 v118, s24, v118
  v_mul_f32 v119, s24, v119
  v_cvt_pk_bf16_f32 v74, v116, v117
  v_cvt_pk_bf16_f32 v75, v118, v119
  buffer_store_dwordx4 v[72:75], v13, s[8:11], s30 offen
  v_mul_f32 v104, s24, v104
  v_mul_f32 v105, s24, v105
  v_mul_f32 v106, s24, v106
  v_mul_f32 v107, s24, v107
  v_cvt_pk_bf16_f32 v76, v104, v105
  v_cvt_pk_bf16_f32 v77, v106, v107
  v_mul_f32 v120, s24, v120
  v_mul_f32 v121, s24, v121
  v_mul_f32 v122, s24, v122
  v_mul_f32 v123, s24, v123
  v_cvt_pk_bf16_f32 v78, v120, v121
  v_cvt_pk_bf16_f32 v79, v122, v123
  buffer_store_dwordx4 v[76:79], v14, s[8:11], s30 offen
  v_mul_f32 v108, s24, v108
  v_mul_f32 v109, s24, v109
  v_mul_f32 v110, s24, v110
  v_mul_f32 v111, s24, v111
  v_cvt_pk_bf16_f32 v80, v108, v109
  v_cvt_pk_bf16_f32 v81, v110, v111
  v_mul_f32 v124, s24, v124
  v_mul_f32 v125, s24, v125
  v_mul_f32 v126, s24, v126
  v_mul_f32 v127, s24, v127
  v_cvt_pk_bf16_f32 v82, v124, v125
  v_cvt_pk_bf16_f32 v83, v126, v127
  buffer_store_dwordx4 v[80:83], v15, s[8:11], s30 offen
  s_add_u32 s28, s28, 4
  s_waitcnt vmcnt(24) lgkmcnt(0)
  ds_read_b128 v[36:39], v32 offset:0
  ds_read_b128 v[40:43], v33 offset:0
  ds_read_b128 v[44:47], v34 offset:0
  ds_read_b128 v[48:51], v35 offset:0
  ds_read_b128 v[52:55], v32 offset:256
  ds_read_b128 v[56:59], v33 offset:256
  ds_read_b128 v[60:63], v34 offset:256
  ds_read_b128 v[64:67], v35 offset:256
  s_waitcnt lgkmcnt(7)
  v_mfma_f32_16x16x32_bf16 v[96:99], v[36:39], v[128:131], 0
  v_mfma_f32_16x16x32_bf16 v[100:103], v[36:39], v[160:163], 0
  v_mfma_f32_16x16x32_bf16 v[104:107], v[36:39], v[192:195], 0
  v_mfma_f32_16x16x32_bf16 v[108:111], v[36:39], v[224:227], 0
  s_waitcnt lgkmcnt(6)
  v_mfma_f32_16x16x32_bf16 v[96:99], v[40:43], v[132:135], v[96:99]
  v_mfma_f32_16x16x32_bf16 v[100:103], v[40:43], v[164:167], v[100:103]
  v_mfma_f32_16x16x32_bf16 v[104:107], v[40:43], v[196:199], v[104:107]
  v_mfma_f32_16x16x32_bf16 v[108:111], v[40:43], v[228:231], v[108:111]
  s_waitcnt lgkmcnt(5)
  v_mfma_f32_16x16x32_bf16 v[96:99], v[44:47], v[136:139], v[96:99]
  v_mfma_f32_16x16x32_bf16 v[100:103], v[44:47], v[168:171], v[100:103]
  v_mfma_f32_16x16x32_bf16 v[104:107], v[44:47], v[200:203], v[104:107]
  v_mfma_f32_16x16x32_bf16 v[108:111], v[44:47], v[232:235], v[108:111]
  s_waitcnt lgkmcnt(4)
  v_mfma_f32_16x16x32_bf16 v[96:99], v[48:51], v[140:143], v[96:99]
  v_mfma_f32_16x16x32_bf16 v[100:103], v[48:51], v[172:175], v[100:103]
  v_mfma_f32_16x16x32_bf16 v[104:107], v[48:51], v[204:207], v[104:107]
  v_mfma_f32_16x16x32_bf16 v[108:111], v[48:51], v[236:239], v[108:111]
  s_waitcnt lgkmcnt(3)
  v_mfma_f32_16x16x32_bf16 v[96:99], v[52:55], v[144:147], v[96:99]
  v_mfma_f32_16x16x32_bf16 v[100:103], v[52:55], v[176:179], v[100:103]
  v_mfma_f32_16x16x32_bf16 v[104:107], v[52:55], v[208:211], v[104:107]
  v_mfma_f32_16x16x32_bf16 v[108:111], v[52:55], v[240:243], v[108:111]
  s_waitcnt lgkmcnt(2)
  v_mfma_f32_16x16x32_bf16 v[96:99], v[56:59], v[148:151], v[96:99]
  v_mfma_f32_16x16x32_bf16 v[100:103], v[56:59], v[180:183], v[100:103]
  v_mfma_f32_16x16x32_bf16 v[104:107], v[56:59], v[212:215], v[104:107]
  v_mfma_f32_16x16x32_bf16 v[108:111], v[56:59], v[244:247], v[108:111]
  s_waitcnt lgkmcnt(1)
  v_mfma_f32_16x16x32_bf16 v[96:99], v[60:63], v[152:155], v[96:99]
  v_mfma_f32_16x16x32_bf16 v[100:103], v[60:63], v[184:187], v[100:103]
  v_mfma_f32_16x16x32_bf16 v[104:107], v[60:63], v[216:219], v[104:107]
  v_mfma_f32_16x16x32_bf16 v[108:111], v[60:63], v[248:251], v[108:111]
  s_waitcnt lgkmcnt(0)
  v_mfma_f32_16x16x32_bf16 v[96:99], v[64:67], v[156:159], v[96:99]
  v_mfma_f32_16x16x32_bf16 v[100:103], v[64:67], v[188:191], v[100:103]
  v_mfma_f32_16x16x32_bf16 v[104:107], v[64:67], v[220:223], v[104:107]
  v_mfma_f32_16x16x32_bf16 v[108:111], v[64:67], v[252:255], v[108:111]
  ds_read_b128 v[36:39], v32 offset:2048
  ds_read_b128 v[40:43], v33 offset:2048
  ds_read_b128 v[44:47], v34 offset:2048
  ds_read_b128 v[48:51], v35 offset:2048
  ds_read_b128 v[52:55], v32 offset:2304
  ds_read_b128 v[56:59], v33 offset:2304
  ds_read_b128 v[60:63], v34 offset:2304
  ds_read_b128 v[64:67], v35 offset:2304
  s_waitcnt lgkmcnt(7)
  v_mfma_f32_16x16x32_bf16 v[112:115], v[36:39], v[128:131], 0
  v_mfma_f32_16x16x32_bf16 v[116:119], v[36:39], v[160:163], 0
  v_mfma_f32_16x16x32_bf16 v[120:123], v[36:39], v[192:195], 0
  v_mfma_f32_16x16x32_bf16 v[124:127], v[36:39], v[224:227], 0
  s_waitcnt lgkmcnt(6)
  v_mfma_f32_16x16x32_bf16 v[112:115], v[40:43], v[132:135], v[112:115]
  v_mfma_f32_16x16x32_bf16 v[116:119], v[40:43], v[164:167], v[116:119]
  v_mfma_f32_16x16x32_bf16 v[120:123], v[40:43], v[196:199], v[120:123]
  v_mfma_f32_16x16x32_bf16 v[124:127], v[40:43], v[228:231], v[124:127]
  s_waitcnt lgkmcnt(5)
  v_mfma_f32_16x16x32_bf16 v[112:115], v[44:47], v[136:139], v[112:115]
  v_mfma_f32_16x16x32_bf16 v[116:119], v[44:47], v[168:171], v[116:119]
  v_mfma_f32_16x16x32_bf16 v[120:123], v[44:47], v[200:203], v[120:123]
  v_mfma_f32_16x16x32_bf16 v[124:127], v[44:47], v[232:235], v[124:127]
  s_waitcnt lgkmcnt(4)
  v_mfma_f32_16x16x32_bf16 v[112:115], v[48:51], v[140:143], v[112:115]
  v_mfma_f32_16x16x32_bf16 v[116:119], v[48:51], v[172:175], v[116:119]
  v_mfma_f32_16x16x32_bf16 v[120:123], v[48:51], v[204:207], v[120:123]
  v_mfma_f32_16x16x32_bf16 v[124:127], v[48:51], v[236:239], v[124:127]
  s_waitcnt lgkmcnt(3)
  v_mfma_f32_16x16x32_bf16 v[112:115], v[52:55], v[144:147], v[112:115]
  v_mfma_f32_16x16x32_bf16 v[116:119], v[52:55], v[176:179], v[116:119]
  v_mfma_f32_16x16x32_bf16 v[120:123], v[52:55], v[208:211], v[120:123]
  v_mfma_f32_16x16x32_bf16 v[124:127], v[52:55], v[240:243], v[124:127]
  s_waitcnt lgkmcnt(2)
  v_mfma_f32_16x16x32_bf16 v[112:115], v[56:59], v[148:151], v[112:115]
  v_mfma_f32_16x16x32_bf16 v[116:119], v[56:59], v[180:183], v[116:119]
  v_mfma_f32_16x16x32_bf16 v[120:123], v[56:59], v[212:215], v[120:123]
  v_mfma_f32_16x16x32_bf16 v[124:127], v[56:59], v[244:247], v[124:127]
  s_waitcnt lgkmcnt(1)
  v_mfma_f32_16x16x32_bf16 v[112:115], v[60:63], v[152:155], v[112:115]
  v_mfma_f32_16x16x32_bf16 v[116:119], v[60:63], v[184:187], v[116:119]
  v_mfma_f32_16x16x32_bf16 v[120:123], v[60:63], v[216:219], v[120:123]
  v_mfma_f32_16x16x32_bf16 v[124:127], v[60:63], v[248:251], v[124:127]
  s_waitcnt lgkmcnt(0)
  v_mfma_f32_16x16x32_bf16 v[112:115], v[64:67], v[156:159], v[112:115]
  v_mfma_f32_16x16x32_bf16 v[116:119], v[64:67], v[188:191], v[116:119]
  v_mfma_f32_16x16x32_bf16 v[120:123], v[64:67], v[220:223], v[120:123]
  v_mfma_f32_16x16x32_bf16 v[124:127], v[64:67], v[252:255], v[124:127]
  s_lshl_b32 s30, s28, 10
  v_mul_f32 v96, s24, v96
  v_mul_f32 v97, s24, v97
  v_mul_f32 v98, s24, v98
  v_mul_f32 v99, s24, v99
  v_cvt_pk_bf16_f32 v68, v96, v97
  v_cvt_pk_bf16_f32 v69, v98, v99
  v_mul_f32 v112, s24, v112
  v_mul_f32 v113, s24, v113
  v_mul_f32 v114, s24, v114
  v_mul_f32 v115, s24, v115
  v_cvt_pk_bf16_f32 v70, v112, v113
  v_cvt_pk_bf16_f32 v71, v114, v115
  buffer_store_dwordx4 v[68:71], v12, s[8:11], s30 offen
  v_mul_f32 v100, s24, v100
  v_mul_f32 v101, s24, v101
  v_mul_f32 v102, s24, v102
  v_mul_f32 v103, s24, v103
  v_cvt_pk_bf16_f32 v72, v100, v101
  v_cvt_pk_bf16_f32 v73, v102, v103
  v_mul_f32 v116, s24, v116
  v_mul_f32 v117, s24, v117
  v_mul_f32 v118, s24, v118
  v_mul_f32 v119, s24, v119
  v_cvt_pk_bf16_f32 v74, v116, v117
  v_cvt_pk_bf16_f32 v75, v118, v119
  buffer_store_dwordx4 v[72:75], v13, s[8:11], s30 offen
  v_mul_f32 v104, s24, v104
  v_mul_f32 v105, s24, v105
  v_mul_f32 v106, s24, v106
  v_mul_f32 v107, s24, v107
  v_cvt_pk_bf16_f32 v76, v104, v105
  v_cvt_pk_bf16_f32 v77, v106, v107
  v_mul_f32 v120, s24, v120
  v_mul_f32 v121, s24, v121
  v_mul_f32 v122, s24, v122
  v_mul_f32 v123, s24, v123
  v_cvt_pk_bf16_f32 v78, v120, v121
  v_cvt_pk_bf16_f32 v79, v122, v123
  buffer_store_dwordx4 v[76:79], v14, s[8:11], s30 offen
  v_mul_f32 v108, s24, v108
  v_mul_f32 v109, s24, v109
  v_mul_f32 v110, s24, v110
  v_mul_f32 v111, s24, v111
  v_cvt_pk_bf16_f32 v80, v108, v109
  v_cvt_pk_bf16_f32 v81, v110, v111
  v_mul_f32 v124, s24, v124
  v_mul_f32 v125, s24, v125
  v_mul_f32 v126, s24, v126
  v_mul_f32 v127, s24, v127
  v_cvt_pk_bf16_f32 v82, v124, v125
  v_cvt_pk_bf16_f32 v83, v126, v127
  buffer_store_dwordx4 v[80:83], v15, s[8:11], s30 offen
  s_add_u32 s28, s28, 4
  s_cmp_lt_u32 s28, 14
  s_cbranch_scc0 pw_wend
  s_waitcnt vmcnt(4) lgkmcnt(0)
  ds_read_b128 v[36:39], v32 offset:16384
  ds_read_b128 v[40:43], v33 offset:16384
  ds_read_b128 v[44:47], v34 offset:16384
  ds_read_b128 v[48:51], v35 offset:16384
  ds_read_b128 v[52:55], v32 offset:16640
  ds_read_b128 v[56:59], v33 offset:16640
  ds_read_b128 v[60:63], v34 offset:16640
  ds_read_b128 v[64:67], v35 offset:16640
  s_waitcnt lgkmcnt(7)
  v_mfma_f32_16x16x32_bf16 v[96:99], v[36:39], v[128:131], 0
  v_mfma_f32_16x16x32_bf16 v[100:103], v[36:39], v[160:163], 0
  v_mfma_f32_16x16x32_bf16 v[104:107], v[36:39], v[192:195], 0
  v_mfma_f32_16x16x32_bf16 v[108:111], v[36:39], v[224:227], 0
  s_waitcnt lgkmcnt(6)
  v_mfma_f32_16x16x32_bf16 v[96:99], v[40:43], v[132:135], v[96:99]
  v_mfma_f32_16x16x32_bf16 v[100:103], v[40:43], v[164:167], v[100:103]
  v_mfma_f32_16x16x32_bf16 v[104:107], v[40:43], v[196:199], v[104:107]
  v_mfma_f32_16x16x32_bf16 v[108:111], v[40:43], v[228:231], v[108:111]
  s_waitcnt lgkmcnt(5)
  v_mfma_f32_16x16x32_bf16 v[96:99], v[44:47], v[136:139], v[96:99]
  v_mfma_f32_16x16x32_bf16 v[100:103], v[44:47], v[168:171], v[100:103]
  v_mfma_f32_16x16x32_bf16 v[104:107], v[44:47], v[200:203], v[104:107]
  v_mfma_f32_16x16x32_bf16 v[108:111], v[44:47], v[232:235], v[108:111]
  s_waitcnt lgkmcnt(4)
  v_mfma_f32_16x16x32_bf16 v[96:99], v[48:51], v[140:143], v[96:99]
  v_mfma_f32_16x16x32_bf16 v[100:103], v[48:51], v[172:175], v[100:103]
  v_mfma_f32_16x16x32_bf16 v[104:107], v[48:51], v[204:207], v[104:107]
  v_mfma_f32_16x16x32_bf16 v[108:111], v[48:51], v[236:239], v[108:111]
  s_waitcnt lgkmcnt(3)
  v_mfma_f32_16x16x32_bf16 v[96:99], v[52:55], v[144:147], v[96:99]
  v_mfma_f32_16x16x32_bf16 v[100:103], v[52:55], v[176:179], v[100:103]
  v_mfma_f32_16x16x32_bf16 v[104:107], v[52:55], v[208:211], v[104:107]
  v_mfma_f32_16x16x32_bf16 v[108:111], v[52:55], v[240:243], v[108:111]
  s_waitcnt lgkmcnt(2)
  v_mfma_f32_16x16x32_bf16 v[96:99], v[56:59], v[148:151], v[96:99]
  v_mfma_f32_16x16x32_bf16 v[100:103], v[56:59], v[180:183], v[100:103]
  v_mfma_f32_16x16x32_bf16 v[104:107], v[56:59], v[212:215], v[104:107]
  v_mfma_f32_16x16x32_bf16 v[108:111], v[56:59], v[244:247], v[108:111]
  s_waitcnt lgkmcnt(1)
  v_mfma_f32_16x16x32_bf16 v[96:99], v[60:63], v[152:155], v[96:99]
  v_mfma_f32_16x16x32_bf16 v[100:103], v[60:63], v[184:187], v[100:103]
  v_mfma_f32_16x16x32_bf16 v[104:107], v[60:63], v[216:219], v[104:107]
  v_mfma_f32_16x16x32_bf16 v[108:111], v[60:63], v[248:251], v[108:111]
  s_waitcnt lgkmcnt(0)
  v_mfma_f32_16x16x32_bf16 v[96:99], v[64:67], v[156:159], v[96:99]
  v_mfma_f32_16x16x32_bf16 v[100:103], v[64:67], v[188:191], v[100:103]
  v_mfma_f32_16x16x32_bf16 v[104:107], v[64:67], v[220:223], v[104:107]
  v_mfma_f32_16x16x32_bf16 v[108:111], v[64:67], v[252:255], v[108:111]
  ds_read_b128 v[36:39], v32 offset:18432
  ds_read_b128 v[40:43], v33 offset:18432
  ds_read_b128 v[44:47], v34 offset:18432
  ds_read_b128 v[48:51], v35 offset:18432
  ds_read_b128 v[52:55], v32 offset:18688
  ds_read_b128 v[56:59], v33 offset:18688
  ds_read_b128 v[60:63], v34 offset:18688
  ds_read_b128 v[64:67], v35 offset:18688
  s_waitcnt lgkmcnt(7)
  v_mfma_f32_16x16x32_bf16 v[112:115], v[36:39], v[128:131], 0
  v_mfma_f32_16x16x32_bf16 v[116:119], v[36:39], v[160:163], 0
  v_mfma_f32_16x16x32_bf16 v[120:123], v[36:39], v[192:195], 0
  v_mfma_f32_16x16x32_bf16 v[124:127], v[36:39], v[224:227], 0
  s_waitcnt lgkmcnt(6)
  v_mfma_f32_16x16x32_bf16 v[112:115], v[40:43], v[132:135], v[112:115]
  v_mfma_f32_16x16x32_bf16 v[116:119], v[40:43], v[164:167], v[116:119]
  v_mfma_f32_16x16x32_bf16 v[120:123], v[40:43], v[196:199], v[120:123]
  v_mfma_f32_16x16x32_bf16 v[124:127], v[40:43], v[228:231], v[124:127]
  s_waitcnt lgkmcnt(5)
  v_mfma_f32_16x16x32_bf16 v[112:115], v[44:47], v[136:139], v[112:115]
  v_mfma_f32_16x16x32_bf16 v[116:119], v[44:47], v[168:171], v[116:119]
  v_mfma_f32_16x16x32_bf16 v[120:123], v[44:47], v[200:203], v[120:123]
  v_mfma_f32_16x16x32_bf16 v[124:127], v[44:47], v[232:235], v[124:127]
  s_waitcnt lgkmcnt(4)
  v_mfma_f32_16x16x32_bf16 v[112:115], v[48:51], v[140:143], v[112:115]
  v_mfma_f32_16x16x32_bf16 v[116:119], v[48:51], v[172:175], v[116:119]
  v_mfma_f32_16x16x32_bf16 v[120:123], v[48:51], v[204:207], v[120:123]
  v_mfma_f32_16x16x32_bf16 v[124:127], v[48:51], v[236:239], v[124:127]
  s_waitcnt lgkmcnt(3)
  v_mfma_f32_16x16x32_bf16 v[112:115], v[52:55], v[144:147], v[112:115]
  v_mfma_f32_16x16x32_bf16 v[116:119], v[52:55], v[176:179], v[116:119]
  v_mfma_f32_16x16x32_bf16 v[120:123], v[52:55], v[208:211], v[120:123]
  v_mfma_f32_16x16x32_bf16 v[124:127], v[52:55], v[240:243], v[124:127]
  s_waitcnt lgkmcnt(2)
  v_mfma_f32_16x16x32_bf16 v[112:115], v[56:59], v[148:151], v[112:115]
  v_mfma_f32_16x16x32_bf16 v[116:119], v[56:59], v[180:183], v[116:119]
  v_mfma_f32_16x16x32_bf16 v[120:123], v[56:59], v[212:215], v[120:123]
  v_mfma_f32_16x16x32_bf16 v[124:127], v[56:59], v[244:247], v[124:127]
  s_waitcnt lgkmcnt(1)
  v_mfma_f32_16x16x32_bf16 v[112:115], v[60:63], v[152:155], v[112:115]
  v_mfma_f32_16x16x32_bf16 v[116:119], v[60:63], v[184:187], v[116:119]
  v_mfma_f32_16x16x32_bf16 v[120:123], v[60:63], v[216:219], v[120:123]
  v_mfma_f32_16x16x32_bf16 v[124:127], v[60:63], v[248:251], v[124:127]
  s_waitcnt lgkmcnt(0)
  v_mfma_f32_16x16x32_bf16 v[112:115], v[64:67], v[156:159], v[112:115]
  v_mfma_f32_16x16x32_bf16 v[116:119], v[64:67], v[188:191], v[116:119]
  v_mfma_f32_16x16x32_bf16 v[120:123], v[64:67], v[220:223], v[120:123]
  v_mfma_f32_16x16x32_bf16 v[124:127], v[64:67], v[252:255], v[124:127]
  s_lshl_b32 s30, s28, 10
  v_mul_f32 v96, s24, v96
  v_mul_f32 v97, s24, v97
  v_mul_f32 v98, s24, v98
  v_mul_f32 v99, s24, v99
  v_cvt_pk_bf16_f32 v68, v96, v97
  v_cvt_pk_bf16_f32 v69, v98, v99
  v_mul_f32 v112, s24, v112
  v_mul_f32 v113, s24, v113
  v_mul_f32 v114, s24, v114
  v_mul_f32 v115, s24, v115
  v_cvt_pk_bf16_f32 v70, v112, v113
  v_cvt_pk_bf16_f32 v71, v114, v115
  buffer_store_dwordx4 v[68:71], v12, s[8:11], s30 offen
  v_mul_f32 v100, s24, v100
  v_mul_f32 v101, s24, v101
  v_mul_f32 v102, s24, v102
  v_mul_f32 v103, s24, v103
  v_cvt_pk_bf16_f32 v72, v100, v101
  v_cvt_pk_bf16_f32 v73, v102, v103
  v_mul_f32 v116, s24, v116
  v_mul_f32 v117, s24, v117
  v_mul_f32 v118, s24, v118
  v_mul_f32 v119, s24, v119
  v_cvt_pk_bf16_f32 v74, v116, v117
  v_cvt_pk_bf16_f32 v75, v118, v119
  buffer_store_dwordx4 v[72:75], v13, s[8:11], s30 offen
  v_mul_f32 v104, s24, v104
  v_mul_f32 v105, s24, v105
  v_mul_f32 v106, s24, v106
  v_mul_f32 v107, s24, v107
  v_cvt_pk_bf16_f32 v76, v104, v105
  v_cvt_pk_bf16_f32 v77, v106, v107
  v_mul_f32 v120, s24, v120
  v_mul_f32 v121, s24, v121
  v_mul_f32 v122, s24, v122
  v_mul_f32 v123, s24, v123
  v_cvt_pk_bf16_f32 v78, v120, v121
  v_cvt_pk_bf16_f32 v79, v122, v123
  buffer_store_dwordx4 v[76:79], v14, s[8:11], s30 offen
  v_mul_f32 v108, s24, v108
  v_mul_f32 v109, s24, v109
  v_mul_f32 v110, s24, v110
  v_mul_f32 v111, s24, v111
  v_cvt_pk_bf16_f32 v80, v108, v109
  v_cvt_pk_bf16_f32 v81, v110, v111
  v_mul_f32 v124, s24, v124
  v_mul_f32 v125, s24, v125
  v_mul_f32 v126, s24, v126
  v_mul_f32 v127, s24, v127
  v_cvt_pk_bf16_f32 v82, v124, v125
  v_cvt_pk_bf16_f32 v83, v126, v127
  buffer_store_dwordx4 v[80:83], v15, s[8:11], s30 offen
  s_add_u32 s28, s28, 4
pw_wend:
  s_branch pr_end
pr_x:
  s_sub_u32 s3, s2, 224
  s_load_dwordx4 s[48:51], s[0:1], 56
  s_waitcnt lgkmcnt(0)
  s_mov_b32 s60, s48
  s_and_b32 s61, s49, 0xffff
  s_mov_b32 s62, 1835008
  s_mov_b32 s63, 0x20000
  s_mov_b32 s56, s50
  s_and_b32 s57, s51, 0xffff
  s_mov_b32 s58, 7168
  s_mov_b32 s59, 0x20000
  s_lshl_b32 s20, s3, 8
  v_add_u32 v5, s20, v0
  s_mov_b32 s21, 0x924925
  s_mov_b32 s21, 599187
  s_mov_b32 s22, 153391872
  v_mov_b32 v6, v5
  v_lshlrev_b32 v9, 5, v6
  buffer_load_dwordx4 v[64:67], v9, s[60:63], 0 offen
  buffer_load_dwordx4 v[68:71], v9, s[60:63], 0 offen offset:16
  v_add_u32 v6, 8192, v5
  v_lshlrev_b32 v9, 5, v6
  buffer_load_dwordx4 v[72:75], v9, s[60:63], 0 offen
  buffer_load_dwordx4 v[76:79], v9, s[60:63], 0 offen offset:16
  v_add_u32 v6, 16384, v5
  v_lshlrev_b32 v9, 5, v6
  buffer_load_dwordx4 v[80:83], v9, s[60:63], 0 offen
  buffer_load_dwordx4 v[84:87], v9, s[60:63], 0 offen offset:16
  v_add_u32 v6, 24576, v5
  v_lshlrev_b32 v9, 5, v6
  buffer_load_dwordx4 v[88:91], v9, s[60:63], 0 offen
  buffer_load_dwordx4 v[92:95], v9, s[60:63], 0 offen offset:16
  v_add_u32 v6, 32768, v5
  v_lshlrev_b32 v9, 5, v6
  buffer_load_dwordx4 v[96:99], v9, s[60:63], 0 offen
  buffer_load_dwordx4 v[100:103], v9, s[60:63], 0 offen offset:16
  v_add_u32 v6, 40960, v5
  v_lshlrev_b32 v9, 5, v6
  buffer_load_dwordx4 v[104:107], v9, s[60:63], 0 offen
  buffer_load_dwordx4 v[108:111], v9, s[60:63], 0 offen offset:16
  v_add_u32 v6, 49152, v5
  v_lshlrev_b32 v9, 5, v6
  buffer_load_dwordx4 v[112:115], v9, s[60:63], 0 offen
  buffer_load_dwordx4 v[116:119], v9, s[60:63], 0 offen offset:16
  v_mov_b32 v6, v5
  v_lshlrev_b32 v9, 5, v6
  buffer_load_dwordx4 v[120:123], v9, s[56:59], 0 offen
  buffer_load_dwordx4 v[124:127], v9, s[56:59], 0 offen offset:16
  s_mov_b32 s23, 75235328
  v_add_u32 v6, 448, v5
  v_subrev_u32 v7, 2208, v6
  v_mov_b32 v48, -1
  v_mov_b32 v9, 0
  v_cmp_gt_u32 vcc, 384, v7
  s_nop 1
  v_cndmask_b32 v48, v48, v9, vcc
  v_mov_b32 v49, v48
  v_mov_b32 v50, v48
  v_mov_b32 v51, v48
  v_lshlrev_b32 v8, 4, v6
  v_mov_b32 v7, 2592
  v_cmp_lt_u32 vcc, v6, v7
  s_and_saveexec_b64 s[30:31], vcc
  s_cbranch_execz px_np0
  buffer_store_dwordx4 v[48:51], v8, s[8:11], s23 offen
px_np0:
  s_mov_b64 exec, -1
  s_nop 1
  s_mov_b32 s23, 87543808
  v_add_u32 v6, 448, v5
  v_mov_b32 v48, -1
  v_mov_b32 v9, 0
  v_mov_b32 v7, 28672
  v_cmp_ge_u32 vcc, v6, v7
  s_nop 1
  v_cndmask_b32 v48, v48, v9, vcc
  v_mov_b32 v49, v48
  v_mov_b32 v50, v48
  v_mov_b32 v51, v48
  v_lshlrev_b32 v8, 4, v6
  v_mov_b32 v7, 29936
  v_cmp_lt_u32 vcc, v6, v7
  s_and_saveexec_b64 s[30:31], vcc
  s_cbranch_execz px_nq0
  buffer_store_dwordx4 v[48:51], v8, s[8:11], s23 offen
px_nq0:
  s_mov_b64 exec, -1
  s_nop 1
  v_add_u32 v6, 8640, v5
  v_mov_b32 v48, -1
  v_mov_b32 v9, 0
  v_mov_b32 v7, 28672
  v_cmp_ge_u32 vcc, v6, v7
  s_nop 1
  v_cndmask_b32 v48, v48, v9, vcc
  v_mov_b32 v49, v48
  v_mov_b32 v50, v48
  v_mov_b32 v51, v48
  v_lshlrev_b32 v8, 4, v6
  v_mov_b32 v7, 29936
  v_cmp_lt_u32 vcc, v6, v7
  s_and_saveexec_b64 s[30:31], vcc
  s_cbranch_execz px_nq1
  buffer_store_dwordx4 v[48:51], v8, s[8:11], s23 offen
px_nq1:
  s_mov_b64 exec, -1
  s_nop 1
  v_add_u32 v6, 16832, v5
  v_mov_b32 v48, -1
  v_mov_b32 v9, 0
  v_mov_b32 v7, 28672
  v_cmp_ge_u32 vcc, v6, v7
  s_nop 1
  v_cndmask_b32 v48, v48, v9, vcc
  v_mov_b32 v49, v48
  v_mov_b32 v50, v48
  v_mov_b32 v51, v48
  v_lshlrev_b32 v8, 4, v6
  v_mov_b32 v7, 29936
  v_cmp_lt_u32 vcc, v6, v7
  s_and_saveexec_b64 s[30:31], vcc
  s_cbranch_execz px_nq2
  buffer_store_dwordx4 v[48:51], v8, s[8:11], s23 offen
px_nq2:
  s_mov_b64 exec, -1
  s_nop 1
  v_add_u32 v6, 25024, v5
  v_mov_b32 v48, -1
  v_mov_b32 v9, 0
  v_mov_b32 v7, 28672
  v_cmp_ge_u32 vcc, v6, v7
  s_nop 1
  v_cndmask_b32 v48, v48, v9, vcc
  v_mov_b32 v49, v48
  v_mov_b32 v50, v48
  v_mov_b32 v51, v48
  v_lshlrev_b32 v8, 4, v6
  v_mov_b32 v7, 29936
  v_cmp_lt_u32 vcc, v6, v7
  s_and_saveexec_b64 s[30:31], vcc
  s_cbranch_execz px_nq3
  buffer_store_dwordx4 v[48:51], v8, s[8:11], s23 offen
px_nq3:
  s_mov_b64 exec, -1
  s_nop 1
  v_mov_b32 v6, v5
  v_mul_hi_u32 v7, v6, s22
  v_mul_u32_u24 v8, 28, v7
  v_sub_u32 v8, v6, v8
  v_lshrrev_b32 v10, 4, v7
  v_and_b32 v11, 15, v7
  v_lshrrev_b32 v12, 2, v8
  v_and_b32 v13, 3, v8
  v_lshrrev_b32 v14, 1, v8
  v_mad_u32_u24 v14, v10, 14, v14
  v_lshlrev_b32 v14, 10, v14
  v_and_b32 v15, 1, v8
  v_lshl_add_u32 v14, v15, 9, v14
  v_lshl_add_u32 v14, v11, 4, v14
  v_mad_u32_u24 v15, v10, 7, v12
  v_lshlrev_b32 v15, 11, v15
  v_lshl_add_u32 v15, v13, 8, v15
  v_lshl_add_u32 v15, v11, 4, v15
  s_waitcnt vmcnt(0)
  v_mov_b32 v16, v64
  v_mov_b32 v20, v65
  v_mov_b32 v17, v66
  v_mov_b32 v21, v67
  v_mov_b32 v18, v68
  v_mov_b32 v22, v69
  v_mov_b32 v19, v70
  v_mov_b32 v23, v71
  s_mov_b32 s23, 71565312
  buffer_store_dwordx4 v[64:67], v14, s[8:11], s23 offen
  buffer_store_dwordx4 v[68:71], v14, s[8:11], s23 offen offset:256
  s_mov_b32 s23, 73400320
  buffer_store_dwordx4 v[16:19], v15, s[8:11], s23 offen
  buffer_store_dwordx4 v[20:23], v15, s[8:11], s23 offen offset:1024
  v_add_u32 v6, 8192, v5
  v_mul_hi_u32 v7, v6, s22
  v_mul_u32_u24 v8, 28, v7
  v_sub_u32 v8, v6, v8
  v_lshrrev_b32 v10, 4, v7
  v_and_b32 v11, 15, v7
  v_lshrrev_b32 v12, 2, v8
  v_and_b32 v13, 3, v8
  v_lshrrev_b32 v14, 1, v8
  v_mad_u32_u24 v14, v10, 14, v14
  v_lshlrev_b32 v14, 10, v14
  v_and_b32 v15, 1, v8
  v_lshl_add_u32 v14, v15, 9, v14
  v_lshl_add_u32 v14, v11, 4, v14
  v_mad_u32_u24 v15, v10, 7, v12
  v_lshlrev_b32 v15, 11, v15
  v_lshl_add_u32 v15, v13, 8, v15
  v_lshl_add_u32 v15, v11, 4, v15
  v_mov_b32 v24, v72
  v_mov_b32 v28, v73
  v_mov_b32 v25, v74
  v_mov_b32 v29, v75
  v_mov_b32 v26, v76
  v_mov_b32 v30, v77
  v_mov_b32 v27, v78
  v_mov_b32 v31, v79
  s_mov_b32 s23, 71565312
  buffer_store_dwordx4 v[72:75], v14, s[8:11], s23 offen
  buffer_store_dwordx4 v[76:79], v14, s[8:11], s23 offen offset:256
  s_mov_b32 s23, 73400320
  buffer_store_dwordx4 v[24:27], v15, s[8:11], s23 offen
  buffer_store_dwordx4 v[28:31], v15, s[8:11], s23 offen offset:1024
  v_add_u32 v6, 16384, v5
  v_mul_hi_u32 v7, v6, s22
  v_mul_u32_u24 v8, 28, v7
  v_sub_u32 v8, v6, v8
  v_lshrrev_b32 v10, 4, v7
  v_and_b32 v11, 15, v7
  v_lshrrev_b32 v12, 2, v8
  v_and_b32 v13, 3, v8
  v_lshrrev_b32 v14, 1, v8
  v_mad_u32_u24 v14, v10, 14, v14
  v_lshlrev_b32 v14, 10, v14
  v_and_b32 v15, 1, v8
  v_lshl_add_u32 v14, v15, 9, v14
  v_lshl_add_u32 v14, v11, 4, v14
  v_mad_u32_u24 v15, v10, 7, v12
  v_lshlrev_b32 v15, 11, v15
  v_lshl_add_u32 v15, v13, 8, v15
  v_lshl_add_u32 v15, v11, 4, v15
  v_mov_b32 v32, v80
  v_mov_b32 v36, v81
  v_mov_b32 v33, v82
  v_mov_b32 v37, v83
  v_mov_b32 v34, v84
  v_mov_b32 v38, v85
  v_mov_b32 v35, v86
  v_mov_b32 v39, v87
  s_mov_b32 s23, 71565312
  buffer_store_dwordx4 v[80:83], v14, s[8:11], s23 offen
  buffer_store_dwordx4 v[84:87], v14, s[8:11], s23 offen offset:256
  s_mov_b32 s23, 73400320
  buffer_store_dwordx4 v[32:35], v15, s[8:11], s23 offen
  buffer_store_dwordx4 v[36:39], v15, s[8:11], s23 offen offset:1024
  v_add_u32 v6, 24576, v5
  v_mul_hi_u32 v7, v6, s22
  v_mul_u32_u24 v8, 28, v7
  v_sub_u32 v8, v6, v8
  v_lshrrev_b32 v10, 4, v7
  v_and_b32 v11, 15, v7
  v_lshrrev_b32 v12, 2, v8
  v_and_b32 v13, 3, v8
  v_lshrrev_b32 v14, 1, v8
  v_mad_u32_u24 v14, v10, 14, v14
  v_lshlrev_b32 v14, 10, v14
  v_and_b32 v15, 1, v8
  v_lshl_add_u32 v14, v15, 9, v14
  v_lshl_add_u32 v14, v11, 4, v14
  v_mad_u32_u24 v15, v10, 7, v12
  v_lshlrev_b32 v15, 11, v15
  v_lshl_add_u32 v15, v13, 8, v15
  v_lshl_add_u32 v15, v11, 4, v15
  v_mov_b32 v40, v88
  v_mov_b32 v44, v89
  v_mov_b32 v41, v90
  v_mov_b32 v45, v91
  v_mov_b32 v42, v92
  v_mov_b32 v46, v93
  v_mov_b32 v43, v94
  v_mov_b32 v47, v95
  s_mov_b32 s23, 71565312
  buffer_store_dwordx4 v[88:91], v14, s[8:11], s23 offen
  buffer_store_dwordx4 v[92:95], v14, s[8:11], s23 offen offset:256
  s_mov_b32 s23, 73400320
  buffer_store_dwordx4 v[40:43], v15, s[8:11], s23 offen
  buffer_store_dwordx4 v[44:47], v15, s[8:11], s23 offen offset:1024
  v_add_u32 v6, 32768, v5
  v_mul_hi_u32 v7, v6, s22
  v_mul_u32_u24 v8, 28, v7
  v_sub_u32 v8, v6, v8
  v_lshrrev_b32 v10, 4, v7
  v_and_b32 v11, 15, v7
  v_lshrrev_b32 v12, 2, v8
  v_and_b32 v13, 3, v8
  v_lshrrev_b32 v14, 1, v8
  v_mad_u32_u24 v14, v10, 14, v14
  v_lshlrev_b32 v14, 10, v14
  v_and_b32 v15, 1, v8
  v_lshl_add_u32 v14, v15, 9, v14
  v_lshl_add_u32 v14, v11, 4, v14
  v_mad_u32_u24 v15, v10, 7, v12
  v_lshlrev_b32 v15, 11, v15
  v_lshl_add_u32 v15, v13, 8, v15
  v_lshl_add_u32 v15, v11, 4, v15
  v_mov_b32 v16, v96
  v_mov_b32 v20, v97
  v_mov_b32 v17, v98
  v_mov_b32 v21, v99
  v_mov_b32 v18, v100
  v_mov_b32 v22, v101
  v_mov_b32 v19, v102
  v_mov_b32 v23, v103
  s_mov_b32 s23, 71565312
  buffer_store_dwordx4 v[96:99], v14, s[8:11], s23 offen
  buffer_store_dwordx4 v[100:103], v14, s[8:11], s23 offen offset:256
  s_mov_b32 s23, 73400320
  buffer_store_dwordx4 v[16:19], v15, s[8:11], s23 offen
  buffer_store_dwordx4 v[20:23], v15, s[8:11], s23 offen offset:1024
  v_add_u32 v6, 40960, v5
  v_mul_hi_u32 v7, v6, s22
  v_mul_u32_u24 v8, 28, v7
  v_sub_u32 v8, v6, v8
  v_lshrrev_b32 v10, 4, v7
  v_and_b32 v11, 15, v7
  v_lshrrev_b32 v12, 2, v8
  v_and_b32 v13, 3, v8
  v_lshrrev_b32 v14, 1, v8
  v_mad_u32_u24 v14, v10, 14, v14
  v_lshlrev_b32 v14, 10, v14
  v_and_b32 v15, 1, v8
  v_lshl_add_u32 v14, v15, 9, v14
  v_lshl_add_u32 v14, v11, 4, v14
  v_mad_u32_u24 v15, v10, 7, v12
  v_lshlrev_b32 v15, 11, v15
  v_lshl_add_u32 v15, v13, 8, v15
  v_lshl_add_u32 v15, v11, 4, v15
  v_mov_b32 v24, v104
  v_mov_b32 v28, v105
  v_mov_b32 v25, v106
  v_mov_b32 v29, v107
  v_mov_b32 v26, v108
  v_mov_b32 v30, v109
  v_mov_b32 v27, v110
  v_mov_b32 v31, v111
  s_mov_b32 s23, 71565312
  buffer_store_dwordx4 v[104:107], v14, s[8:11], s23 offen
  buffer_store_dwordx4 v[108:111], v14, s[8:11], s23 offen offset:256
  s_mov_b32 s23, 73400320
  buffer_store_dwordx4 v[24:27], v15, s[8:11], s23 offen
  buffer_store_dwordx4 v[28:31], v15, s[8:11], s23 offen offset:1024
  v_add_u32 v6, 49152, v5
  v_mul_hi_u32 v7, v6, s22
  v_mul_u32_u24 v8, 28, v7
  v_sub_u32 v8, v6, v8
  v_lshrrev_b32 v10, 4, v7
  v_and_b32 v11, 15, v7
  v_lshrrev_b32 v12, 2, v8
  v_and_b32 v13, 3, v8
  v_lshrrev_b32 v14, 1, v8
  v_mad_u32_u24 v14, v10, 14, v14
  v_lshlrev_b32 v14, 10, v14
  v_and_b32 v15, 1, v8
  v_lshl_add_u32 v14, v15, 9, v14
  v_lshl_add_u32 v14, v11, 4, v14
  v_mad_u32_u24 v15, v10, 7, v12
  v_lshlrev_b32 v15, 11, v15
  v_lshl_add_u32 v15, v13, 8, v15
  v_lshl_add_u32 v15, v11, 4, v15
  v_mov_b32 v32, v112
  v_mov_b32 v36, v113
  v_mov_b32 v33, v114
  v_mov_b32 v37, v115
  v_mov_b32 v34, v116
  v_mov_b32 v38, v117
  v_mov_b32 v35, v118
  v_mov_b32 v39, v119
  s_mov_b32 s23, 71565312
  buffer_store_dwordx4 v[112:115], v14, s[8:11], s23 offen
  buffer_store_dwordx4 v[116:119], v14, s[8:11], s23 offen offset:256
  s_mov_b32 s23, 73400320
  buffer_store_dwordx4 v[32:35], v15, s[8:11], s23 offen
  buffer_store_dwordx4 v[36:39], v15, s[8:11], s23 offen offset:1024
  v_mov_b32 v6, v5
  v_mov_b32 v7, 224
  v_cmp_lt_u32 vcc, v5, v7
  s_and_saveexec_b64 s[30:31], vcc
  s_cbranch_execz px_nomem
  v_mul_hi_u32 v7, v6, s22
  v_mul_u32_u24 v8, 28, v7
  v_sub_u32 v8, v6, v8
  v_lshrrev_b32 v10, 4, v7
  v_and_b32 v11, 15, v7
  v_lshrrev_b32 v12, 2, v8
  v_and_b32 v13, 3, v8
  v_lshlrev_b32 v15, 10, v12
  v_lshl_add_u32 v15, v13, 8, v15
  v_lshl_add_u32 v15, v11, 4, v15
  v_mov_b32 v40, v120
  v_mov_b32 v44, v121
  v_mov_b32 v41, v122
  v_mov_b32 v45, v123
  v_mov_b32 v42, v124
  v_mov_b32 v46, v125
  v_mov_b32 v43, v126
  v_mov_b32 v47, v127
  s_mov_b32 s23, 75235328
  buffer_store_dwordx4 v[40:43], v15, s[8:11], s23 offen
  buffer_store_dwordx4 v[44:47], v15, s[8:11], s23 offen offset:128
  s_mov_b32 s23, 87543808
  buffer_store_dwordx4 v[40:43], v15, s[8:11], s23 offen
  buffer_store_dwordx4 v[44:47], v15, s[8:11], s23 offen offset:128
px_nomem:
  s_mov_b64 exec, -1
pr_end:
  s_endpgm

.globl main_kernel
.p2align 8
.type main_kernel,@function
main_kernel:
  s_cmp_ge_u32 s2, 256
  s_cbranch_scc1 ch_end
  s_load_dwordx2 s[4:5], s[0:1], 120
  s_load_dwordx2 s[6:7], s[0:1], 128
  s_getpc_b64 s[98:99]
pf_main_kernel_1:
  s_sub_u32 s98, s98, pf_main_kernel_1-main_kernel
  s_subb_u32 s99, s99, 0
  v_lshlrev_b32 v60, 7, v0
  v_min_u32 v61, ch_end-main_kernel-4, v60
  global_load_dword v62, v61, s[98:99]
  v_add_u32 v60, 32768, v60
  v_min_u32 v61, ch_end-main_kernel-4, v60
  global_load_dword v62, v61, s[98:99]
  v_add_u32 v60, 32768, v60
  v_min_u32 v61, ch_end-main_kernel-4, v60
  global_load_dword v62, v61, s[98:99]
  v_add_u32 v60, 32768, v60
  v_min_u32 v61, ch_end-main_kernel-4, v60
  global_load_dword v62, v61, s[98:99]
  v_add_u32 v60, 32768, v60
  s_getreg_b32 s3, hwreg(HW_REG_XCC_ID)
  s_and_b32 s3, s3, 15
  v_lshrrev_b32 v1, 6, v0
  s_nop 0
  v_readfirstlane_b32 s16, v1
  s_waitcnt lgkmcnt(0)
  s_mov_b32 s8, s6
  s_and_b32 s9, s7, 0xffff
  s_mov_b32 s10, 0x10000000
  s_mov_b32 s11, 0x20000
  s_mov_b32 s12, s4
  s_and_b32 s13, s5, 0xffff
  s_mov_b32 s14, 256
  s_mov_b32 s15, 0x20000
  s_cmp_lg_u32 s3, 0
  s_cbranch_scc1 ch_worker
  v_mov_b32 v4, 1
  s_mov_b32 s18, 0
ch_take:
  v_mov_b32 v5, 0
  v_mov_b32 v6, 160000
  s_barrier
  s_cmp_lg_u32 s16, 0
  s_cbranch_scc1 ch_el1
  s_mov_b64 exec, 1
  buffer_atomic_add v4, v5, s[12:15], 0 offen sc0
  s_waitcnt vmcnt(0)
  ds_write_b32 v6, v4
  s_waitcnt lgkmcnt(0)
  s_mov_b64 exec, -1
ch_el1:
  s_barrier
  ds_read_b32 v4, v6
  s_waitcnt lgkmcnt(0)
  v_readfirstlane_b32 s17, v4
  s_and_b32 s17, s17, 0xffff
  s_cmp_lt_u32 s17, 32
  s_cbranch_scc1 ch_role
  s_cmp_eq_u32 s18, 0
  s_cbranch_scc1 ch_worker
  s_branch ch_end
ch_role:
  v_and_b32 v1, 63, v0
  v_lshlrev_b32 v2, 4, v1
  v_lshrrev_b32 v116, 4, v1
  v_and_b32 v117, 15, v1
  v_mov_b32 v3, 0x4444
  v_mov_b32 v118, 0xeeee
  v_cmp_lt_u32 vcc, 7, v117
  s_nop 1
  v_cndmask_b32 v3, v3, v118, vcc
  s_mov_b32 s19, 0
  s_mov_b32 s18, 1
  s_mov_b32 s20, 75235328
  s_mov_b32 s21, 75252992
  s_mov_b32 s23, 75239424
  s_lshr_b32 s89, s17, 4
  s_lshl_b32 s89, s89, 2
  s_add_u32 s89, s89, s16
  s_and_b32 s17, s17, 15
  s_cmp_eq_u32 s89, 0
  s_cbranch_scc1 ch_init0
  s_cmp_eq_u32 s89, 1
  s_cbranch_scc1 ch_init1
  s_cmp_eq_u32 s89, 2
  s_cbranch_scc1 ch_init2
  s_cmp_eq_u32 s89, 3
  s_cbranch_scc1 ch_init3
  s_cmp_eq_u32 s89, 4
  s_cbranch_scc1 ch_init4
  s_cmp_eq_u32 s89, 5
  s_cbranch_scc1 ch_init5
  s_cmp_eq_u32 s89, 6
  s_cbranch_scc1 ch_init6
  s_cmp_eq_u32 s89, 7
  s_cbranch_scc1 ch_init7
  s_branch ch_end
ch_init0:
  s_mul_i32 s31, s17, 401408
  s_add_u32 s31, s31, 0
  s_add_u32 s22, s31, 0
  buffer_load_dwordx4 a[0:3], v2, s[8:11], s22 offen offset:0
  buffer_load_dwordx4 a[4:7], v2, s[8:11], s22 offen offset:1024
  buffer_load_dwordx4 a[8:11], v2, s[8:11], s22 offen offset:2048
  buffer_load_dwordx4 a[12:15], v2, s[8:11], s22 offen offset:3072
  s_add_u32 s22, s31, 4096
  buffer_load_dwordx4 a[16:19], v2, s[8:11], s22 offen offset:0
  buffer_load_dwordx4 a[20:23], v2, s[8:11], s22 offen offset:1024
  buffer_load_dwordx4 a[24:27], v2, s[8:11], s22 offen offset:2048
  buffer_load_dwordx4 a[28:31], v2, s[8:11], s22 offen offset:3072
  s_add_u32 s22, s31, 8192
  buffer_load_dwordx4 a[32:35], v2, s[8:11], s22 offen offset:0
  buffer_load_dwordx4 a[36:39], v2, s[8:11], s22 offen offset:1024
  buffer_load_dwordx4 a[40:43], v2, s[8:11], s22 offen offset:2048
  buffer_load_dwordx4 a[44:47], v2, s[8:11], s22 offen offset:3072
  s_add_u32 s22, s31, 12288
  buffer_load_dwordx4 a[48:51], v2, s[8:11], s22 offen offset:0
  buffer_load_dwordx4 a[52:55], v2, s[8:11], s22 offen offset:1024
  buffer_load_dwordx4 a[56:59], v2, s[8:11], s22 offen offset:2048
  buffer_load_dwordx4 a[60:63], v2, s[8:11], s22 offen offset:3072
  s_add_u32 s22, s31, 16384
  buffer_load_dwordx4 a[64:67], v2, s[8:11], s22 offen offset:0
  buffer_load_dwordx4 a[68:71], v2, s[8:11], s22 offen offset:1024
  buffer_load_dwordx4 a[72:75], v2, s[8:11], s22 offen offset:2048
  buffer_load_dwordx4 a[76:79], v2, s[8:11], s22 offen offset:3072
  s_add_u32 s22, s31, 20480
  buffer_load_dwordx4 a[80:83], v2, s[8:11], s22 offen offset:0
  buffer_load_dwordx4 a[84:87], v2, s[8:11], s22 offen offset:1024
  buffer_load_dwordx4 a[88:91], v2, s[8:11], s22 offen offset:2048
  buffer_load_dwordx4 a[92:95], v2, s[8:11], s22 offen offset:3072
  s_add_u32 s22, s31, 24576
  buffer_load_dwordx4 a[96:99], v2, s[8:11], s22 offen offset:0
  buffer_load_dwordx4 a[100:103], v2, s[8:11], s22 offen offset:1024
  buffer_load_dwordx4 a[104:107], v2, s[8:11], s22 offen offset:2048
  buffer_load_dwordx4 a[108:111], v2, s[8:11], s22 offen offset:3072
  s_add_u32 s22, s31, 28672
  buffer_load_dwordx4 a[112:115], v2, s[8:11], s22 offen offset:0
  buffer_load_dwordx4 a[116:119], v2, s[8:11], s22 offen offset:1024
  buffer_load_dwordx4 a[120:123], v2, s[8:11], s22 offen offset:2048
  buffer_load_dwordx4 a[124:127], v2, s[8:11], s22 offen offset:3072
  s_waitcnt vmcnt(24)
  s_add_u32 s22, s31, 32768
  buffer_load_dwordx4 a[128:131], v2, s[8:11], s22 offen offset:0
  buffer_load_dwordx4 a[132:135], v2, s[8:11], s22 offen offset:1024
  buffer_load_dwordx4 a[136:139], v2, s[8:11], s22 offen offset:2048
  buffer_load_dwordx4 a[140:143], v2, s[8:11], s22 offen offset:3072
  s_add_u32 s22, s31, 36864
  buffer_load_dwordx4 a[144:147], v2, s[8:11], s22 offen offset:0
  buffer_load_dwordx4 a[148:151], v2, s[8:11], s22 offen offset:1024
  buffer_load_dwordx4 a[152:155], v2, s[8:11], s22 offen offset:2048
  buffer_load_dwordx4 a[156:159], v2, s[8:11], s22 offen offset:3072
  s_add_u32 s22, s31, 40960
  buffer_load_dwordx4 a[160:163], v2, s[8:11], s22 offen offset:0
  buffer_load_dwordx4 a[164:167], v2, s[8:11], s22 offen offset:1024
  buffer_load_dwordx4 a[168:171], v2, s[8:11], s22 offen offset:2048
  buffer_load_dwordx4 a[172:175], v2, s[8:11], s22 offen offset:3072
  s_add_u32 s22, s31, 45056
  buffer_load_dwordx4 a[176:179], v2, s[8:11], s22 offen offset:0
  buffer_load_dwordx4 a[180:183], v2, s[8:11], s22 offen offset:1024
  buffer_load_dwordx4 a[184:187], v2, s[8:11], s22 offen offset:2048
  buffer_load_dwordx4 a[188:191], v2, s[8:11], s22 offen offset:3072
  s_add_u32 s22, s31, 49152
  buffer_load_dwordx4 a[192:195], v2, s[8:11], s22 offen offset:0
  buffer_load_dwordx4 a[196:199], v2, s[8:11], s22 offen offset:1024
  buffer_load_dwordx4 a[200:203], v2, s[8:11], s22 offen offset:2048
  buffer_load_dwordx4 a[204:207], v2, s[8:11], s22 offen offset:3072
  s_add_u32 s22, s31, 53248
  buffer_load_dwordx4 a[208:211], v2, s[8:11], s22 offen offset:0
  buffer_load_dwordx4 a[212:215], v2, s[8:11], s22 offen offset:1024
  buffer_load_dwordx4 a[216:219], v2, s[8:11], s22 offen offset:2048
  buffer_load_dwordx4 a[220:223], v2, s[8:11], s22 offen offset:3072
  s_add_u32 s22, s31, 229376
  buffer_load_dwordx4 a[224:227], v2, s[8:11], s22 offen offset:0
  buffer_load_dwordx4 a[228:231], v2, s[8:11], s22 offen offset:1024
  buffer_load_dwordx4 a[232:235], v2, s[8:11], s22 offen offset:2048
  buffer_load_dwordx4 a[236:239], v2, s[8:11], s22 offen offset:3072
  s_add_u32 s22, s31, 233472
  buffer_load_dwordx4 a[240:243], v2, s[8:11], s22 offen offset:0
  buffer_load_dwordx4 a[244:247], v2, s[8:11], s22 offen offset:1024
  buffer_load_dwordx4 a[248:251], v2, s[8:11], s22 offen offset:2048
  buffer_load_dwordx4 a[252:255], v2, s[8:11], s22 offen offset:3072
  s_waitcnt vmcnt(24)
  s_add_u32 s22, s31, 237568
  buffer_load_dwordx4 v[120:123], v2, s[8:11], s22 offen offset:0
  buffer_load_dwordx4 v[124:127], v2, s[8:11], s22 offen offset:1024
  buffer_load_dwordx4 v[128:131], v2, s[8:11], s22 offen offset:2048
  buffer_load_dwordx4 v[132:135], v2, s[8:11], s22 offen offset:3072
  s_add_u32 s22, s31, 241664
  buffer_load_dwordx4 v[136:139], v2, s[8:11], s22 offen offset:0
  buffer_load_dwordx4 v[140:143], v2, s[8:11], s22 offen offset:1024
  buffer_load_dwordx4 v[144:147], v2, s[8:11], s22 offen offset:2048
  buffer_load_dwordx4 v[148:151], v2, s[8:11], s22 offen offset:3072
  s_add_u32 s22, s31, 245760
  buffer_load_dwordx4 v[152:155], v2, s[8:11], s22 offen offset:0
  buffer_load_dwordx4 v[156:159], v2, s[8:11], s22 offen offset:1024
  buffer_load_dwordx4 v[160:163], v2, s[8:11], s22 offen offset:2048
  buffer_load_dwordx4 v[164:167], v2, s[8:11], s22 offen offset:3072
  s_add_u32 s22, s31, 249856
  buffer_load_dwordx4 v[168:171], v2, s[8:11], s22 offen offset:0
  buffer_load_dwordx4 v[172:175], v2, s[8:11], s22 offen offset:1024
  buffer_load_dwordx4 v[176:179], v2, s[8:11], s22 offen offset:2048
  buffer_load_dwordx4 v[180:183], v2, s[8:11], s22 offen offset:3072
  s_add_u32 s22, s31, 253952
  buffer_load_dwordx4 v[184:187], v2, s[8:11], s22 offen offset:0
  buffer_load_dwordx4 v[188:191], v2, s[8:11], s22 offen offset:1024
  buffer_load_dwordx4 v[192:195], v2, s[8:11], s22 offen offset:2048
  buffer_load_dwordx4 v[196:199], v2, s[8:11], s22 offen offset:3072
  s_add_u32 s22, s31, 372736
  buffer_load_dwordx4 v[200:203], v2, s[8:11], s22 offen offset:0
  buffer_load_dwordx4 v[204:207], v2, s[8:11], s22 offen offset:1024
  buffer_load_dwordx4 v[208:211], v2, s[8:11], s22 offen offset:2048
  buffer_load_dwordx4 v[212:215], v2, s[8:11], s22 offen offset:3072
  s_add_u32 s22, s31, 376832
  buffer_load_dwordx4 v[216:219], v2, s[8:11], s22 offen offset:0
  buffer_load_dwordx4 v[220:223], v2, s[8:11], s22 offen offset:1024
  buffer_load_dwordx4 v[224:227], v2, s[8:11], s22 offen offset:2048
  buffer_load_dwordx4 v[228:231], v2, s[8:11], s22 offen offset:3072
  s_add_u32 s22, s31, 380928
  buffer_load_dwordx4 v[232:235], v2, s[8:11], s22 offen offset:0
  buffer_load_dwordx4 v[236:239], v2, s[8:11], s22 offen offset:1024
  buffer_load_dwordx4 v[240:243], v2, s[8:11], s22 offen offset:2048
  buffer_load_dwordx4 v[244:247], v2, s[8:11], s22 offen offset:3072
  s_waitcnt vmcnt(24)
  s_add_u32 s22, s31, 385024
  buffer_load_dwordx4 v[248:251], v2, s[8:11], s22 offen offset:0
  buffer_load_dwordx4 v[252:255], v2, s[8:11], s22 offen offset:1024
  s_mov_b32 s24, 71565312
  s_mov_b32 s26, 71579648
  v_and_b32 v64, 7, v117
  v_and_b32 v65, 1, v116
  v_lshlrev_b32 v65, 2, v65
  v_sub_u32 v64, v64, v65
  v_lshrrev_b32 v65, 3, v117
  v_lshl_add_u32 v66, v65, 2, v64
  v_cmp_gt_u32 vcc, 4, v64
  v_mov_b32 v67, 99
  s_nop 0
  v_cndmask_b32 v66, v67, v66, vcc
  v_mov_b32 v68, 0x3f80
  v_mov_b32 v69, 0x3f800000
  v_mov_b32 v4, 0
  v_cmp_eq_u32 vcc, 0, v66
  s_nop 1
  v_cndmask_b32 v4, v4, v68, vcc
  v_cmp_eq_u32 vcc, 1, v66
  s_nop 1
  v_cndmask_b32 v4, v4, v69, vcc
  v_mov_b32 v5, 0
  v_cmp_eq_u32 vcc, 2, v66
  s_nop 1
  v_cndmask_b32 v5, v5, v68, vcc
  v_cmp_eq_u32 vcc, 3, v66
  s_nop 1
  v_cndmask_b32 v5, v5, v69, vcc
  v_mov_b32 v6, 0
  v_cmp_eq_u32 vcc, 4, v66
  s_nop 1
  v_cndmask_b32 v6, v6, v68, vcc
  v_cmp_eq_u32 vcc, 5, v66
  s_nop 1
  v_cndmask_b32 v6, v6, v69, vcc
  v_mov_b32 v7, 0
  v_cmp_eq_u32 vcc, 6, v66
  s_nop 1
  v_cndmask_b32 v7, v7, v68, vcc
  v_cmp_eq_u32 vcc, 7, v66
  s_nop 1
  v_cndmask_b32 v7, v7, v69, vcc
  v_lshrrev_b32 v64, 1, v116
  v_lshrrev_b32 v65, 3, v117
  v_and_b32 v66, 1, v116
  v_and_b32 v68, 7, v117
  v_lshlrev_b32 v67, 8, v65
  v_lshl_add_u32 v67, v68, 5, v67
  v_lshl_add_u32 v67, v66, 4, v67
  v_add_u32 v69, 4096, v67
  v_add_u32 v70, 6400, v67
  v_cmp_eq_u32 vcc, v64, v65
  s_nop 1
  v_cndmask_b32 v113, v70, v69, vcc
  v_lshlrev_b32 v67, 9, v64
  v_lshl_add_u32 v67, v117, 4, v67
  v_lshl_add_u32 v67, v66, 3, v67
  v_add_u32 v114, 0, v67
  v_mul_u32_u24 v67, 1088, v65
  v_lshl_add_u32 v67, v116, 5, v67
  v_lshl_add_u32 v67, v68, 2, v67
  v_add_u32 v115, 4096, v67
  v_and_b32 v69, 1, v117
  v_lshlrev_b32 v67, 7, v69
  v_lshl_add_u32 v67, v116, 4, v67
  v_lshl_add_u32 v67, v65, 8, v67
  v_bfe_u32 v69, v117, 1, 2
  v_lshl_add_u32 v67, v69, 2, v67
  s_lshl_b32 s22, s17, 9
  s_add_u32 s22, s22, 9216
  v_add_u32 v72, s22, v67
  v_bfe_u32 v69, v117, 1, 1
  v_lshlrev_b32 v67, 7, v69
  v_lshl_add_u32 v67, v116, 4, v67
  v_and_b32 v69, 4, v117
  v_add_u32 v67, v67, v69
  s_lshr_b32 s22, s17, 1
  s_lshl_b32 s22, s22, 8
  s_and_b32 s27, s17, 1
  s_lshl_b32 s27, s27, 3
  s_add_u32 s22, s22, s27
  s_add_u32 s22, s22, 7168
  v_add_u32 v67, s22, v67
  v_and_b32 v69, 9, v117
  v_mov_b32 v70, 0x40000000
  v_cmp_eq_u32 vcc, 0, v69
  s_nop 1
  v_cndmask_b32 v118, v70, v67, vcc
  v_mov_b32 v119, -1
  v_and_b32 v0, 15, v1
  s_and_b32 s22, s17, 3
  s_lshl_b32 s22, s22, 7
  s_add_u32 s22, s22, 75272704
  v_lshl_add_u32 v0, v0, 2, s22
  v_xor_b32 v69, 256, v2
  v_mul_i32_i24 v70, -4096, v66
  v_add_u32 v69, v69, v70
  v_add_u32 v117, 12288, v69
  v_mov_b32 v1, v72
  v_mov_b32 v36, 0
  v_mov_b32 v37, 0
  v_mov_b32 v38, 0
  v_mov_b32 v39, 0
  v_mov_b32 v40, 0
  v_mov_b32 v41, 0
  v_mov_b32 v42, 0
  v_mov_b32 v43, 0
  v_mov_b32 v44, 0
  v_mov_b32 v45, 0
  v_mov_b32 v46, 0
  v_mov_b32 v47, 0
  v_mov_b32 v48, 0
  v_mov_b32 v49, 0
  v_mov_b32 v50, 0
  v_mov_b32 v51, 0
  v_mov_b32 v52, 0
  v_mov_b32 v53, 0
  v_mov_b32 v54, 0
  v_mov_b32 v55, 0
  v_mov_b32 v56, 0
  v_mov_b32 v57, 0
  v_mov_b32 v58, 0
  v_mov_b32 v59, 0
  v_mov_b32 v60, 0
  v_mov_b32 v61, 0
  v_mov_b32 v62, 0
  v_mov_b32 v63, 0
  v_mov_b32 v64, 0
  v_mov_b32 v65, 0
  v_mov_b32 v66, 0
  v_mov_b32 v67, 0
  v_mov_b32 v68, 0
  v_mov_b32 v69, 0
  v_mov_b32 v70, 0
  v_mov_b32 v71, 0
  v_mov_b32 v72, 0
  v_mov_b32 v73, 0
  v_mov_b32 v74, 0
  v_mov_b32 v75, 0
  v_mov_b32 v76, 0
  v_mov_b32 v77, 0
  v_mov_b32 v78, 0
  v_mov_b32 v79, 0
  buffer_load_dwordx4 v[80:83], v117, s[8:11], s24 offen offset:0
  buffer_load_dwordx4 v[84:87], v117, s[8:11], s24 offen offset:1024
  s_mov_b32 s30, 0
  v_mov_b32 v8, 0
ch_md0:
  buffer_load_dword v9, v8, s[12:15], 0 offen sc1
  s_waitcnt vmcnt(0) lgkmcnt(0)
  v_readfirstlane_b32 s22, v9
  s_and_b32 s31, s22, 0xffff
  s_cmp_ge_u32 s31, 32
  s_cbranch_scc1 ch_go0
  s_sleep 2
  s_add_u32 s30, s30, 1
  s_cmp_lt_u32 s30, 3200000
  s_cbranch_scc1 ch_md0
  s_branch ch_end
ch_go0:
  s_mov_b32 s31, 0
  s_lshr_b32 s22, s22, 16
  s_cmp_lg_u32 s22, 0
  s_cbranch_scc1 cB_sc0_loop
  s_branch cA_sc0_loop
ch_init1:
  s_mul_i32 s31, s17, 401408
  s_add_u32 s31, s31, 0
  s_add_u32 s22, s31, 57344
  buffer_load_dwordx4 a[0:3], v2, s[8:11], s22 offen offset:0
  buffer_load_dwordx4 a[4:7], v2, s[8:11], s22 offen offset:1024
  buffer_load_dwordx4 a[8:11], v2, s[8:11], s22 offen offset:2048
  buffer_load_dwordx4 a[12:15], v2, s[8:11], s22 offen offset:3072
  s_add_u32 s22, s31, 61440
  buffer_load_dwordx4 a[16:19], v2, s[8:11], s22 offen offset:0
  buffer_load_dwordx4 a[20:23], v2, s[8:11], s22 offen offset:1024
  buffer_load_dwordx4 a[24:27], v2, s[8:11], s22 offen offset:2048
  buffer_load_dwordx4 a[28:31], v2, s[8:11], s22 offen offset:3072
  s_add_u32 s22, s31, 65536
  buffer_load_dwordx4 a[32:35], v2, s[8:11], s22 offen offset:0
  buffer_load_dwordx4 a[36:39], v2, s[8:11], s22 offen offset:1024
  buffer_load_dwordx4 a[40:43], v2, s[8:11], s22 offen offset:2048
  buffer_load_dwordx4 a[44:47], v2, s[8:11], s22 offen offset:3072
  s_add_u32 s22, s31, 69632
  buffer_load_dwordx4 a[48:51], v2, s[8:11], s22 offen offset:0
  buffer_load_dwordx4 a[52:55], v2, s[8:11], s22 offen offset:1024
  buffer_load_dwordx4 a[56:59], v2, s[8:11], s22 offen offset:2048
  buffer_load_dwordx4 a[60:63], v2, s[8:11], s22 offen offset:3072
  s_add_u32 s22, s31, 73728
  buffer_load_dwordx4 a[64:67], v2, s[8:11], s22 offen offset:0
  buffer_load_dwordx4 a[68:71], v2, s[8:11], s22 offen offset:1024
  buffer_load_dwordx4 a[72:75], v2, s[8:11], s22 offen offset:2048
  buffer_load_dwordx4 a[76:79], v2, s[8:11], s22 offen offset:3072
  s_add_u32 s22, s31, 77824
  buffer_load_dwordx4 a[80:83], v2, s[8:11], s22 offen offset:0
  buffer_load_dwordx4 a[84:87], v2, s[8:11], s22 offen offset:1024
  buffer_load_dwordx4 a[88:91], v2, s[8:11], s22 offen offset:2048
  buffer_load_dwordx4 a[92:95], v2, s[8:11], s22 offen offset:3072
  s_add_u32 s22, s31, 81920
  buffer_load_dwordx4 a[96:99], v2, s[8:11], s22 offen offset:0
  buffer_load_dwordx4 a[100:103], v2, s[8:11], s22 offen offset:1024
  buffer_load_dwordx4 a[104:107], v2, s[8:11], s22 offen offset:2048
  buffer_load_dwordx4 a[108:111], v2, s[8:11], s22 offen offset:3072
  s_add_u32 s22, s31, 86016
  buffer_load_dwordx4 a[112:115], v2, s[8:11], s22 offen offset:0
  buffer_load_dwordx4 a[116:119], v2, s[8:11], s22 offen offset:1024
  buffer_load_dwordx4 a[120:123], v2, s[8:11], s22 offen offset:2048
  buffer_load_dwordx4 a[124:127], v2, s[8:11], s22 offen offset:3072
  s_waitcnt vmcnt(24)
  s_add_u32 s22, s31, 90112
  buffer_load_dwordx4 a[128:131], v2, s[8:11], s22 offen offset:0
  buffer_load_dwordx4 a[132:135], v2, s[8:11], s22 offen offset:1024
  buffer_load_dwordx4 a[136:139], v2, s[8:11], s22 offen offset:2048
  buffer_load_dwordx4 a[140:143], v2, s[8:11], s22 offen offset:3072
  s_add_u32 s22, s31, 94208
  buffer_load_dwordx4 a[144:147], v2, s[8:11], s22 offen offset:0
  buffer_load_dwordx4 a[148:151], v2, s[8:11], s22 offen offset:1024
  buffer_load_dwordx4 a[152:155], v2, s[8:11], s22 offen offset:2048
  buffer_load_dwordx4 a[156:159], v2, s[8:11], s22 offen offset:3072
  s_add_u32 s22, s31, 98304
  buffer_load_dwordx4 a[160:163], v2, s[8:11], s22 offen offset:0
  buffer_load_dwordx4 a[164:167], v2, s[8:11], s22 offen offset:1024
  buffer_load_dwordx4 a[168:171], v2, s[8:11], s22 offen offset:2048
  buffer_load_dwordx4 a[172:175], v2, s[8:11], s22 offen offset:3072
  s_add_u32 s22, s31, 102400
  buffer_load_dwordx4 a[176:179], v2, s[8:11], s22 offen offset:0
  buffer_load_dwordx4 a[180:183], v2, s[8:11], s22 offen offset:1024
  buffer_load_dwordx4 a[184:187], v2, s[8:11], s22 offen offset:2048
  buffer_load_dwordx4 a[188:191], v2, s[8:11], s22 offen offset:3072
  s_add_u32 s22, s31, 106496
  buffer_load_dwordx4 a[192:195], v2, s[8:11], s22 offen offset:0
  buffer_load_dwordx4 a[196:199], v2, s[8:11], s22 offen offset:1024
  buffer_load_dwordx4 a[200:203], v2, s[8:11], s22 offen offset:2048
  buffer_load_dwordx4 a[204:207], v2, s[8:11], s22 offen offset:3072
  s_add_u32 s22, s31, 110592
  buffer_load_dwordx4 a[208:211], v2, s[8:11], s22 offen offset:0
  buffer_load_dwordx4 a[212:215], v2, s[8:11], s22 offen offset:1024
  buffer_load_dwordx4 a[216:219], v2, s[8:11], s22 offen offset:2048
  buffer_load_dwordx4 a[220:223], v2, s[8:11], s22 offen offset:3072
  s_add_u32 s22, s31, 258048
  buffer_load_dwordx4 a[224:227], v2, s[8:11], s22 offen offset:0
  buffer_load_dwordx4 a[228:231], v2, s[8:11], s22 offen offset:1024
  buffer_load_dwordx4 a[232:235], v2, s[8:11], s22 offen offset:2048
  buffer_load_dwordx4 a[236:239], v2, s[8:11], s22 offen offset:3072
  s_add_u32 s22, s31, 262144
  buffer_load_dwordx4 a[240:243], v2, s[8:11], s22 offen offset:0
  buffer_load_dwordx4 a[244:247], v2, s[8:11], s22 offen offset:1024
  buffer_load_dwordx4 a[248:251], v2, s[8:11], s22 offen offset:2048
  buffer_load_dwordx4 a[252:255], v2, s[8:11], s22 offen offset:3072
  s_waitcnt vmcnt(24)
  s_add_u32 s22, s31, 266240
  buffer_load_dwordx4 v[120:123], v2, s[8:11], s22 offen offset:0
  buffer_load_dwordx4 v[124:127], v2, s[8:11], s22 offen offset:1024
  buffer_load_dwordx4 v[128:131], v2, s[8:11], s22 offen offset:2048
  buffer_load_dwordx4 v[132:135], v2, s[8:11], s22 offen offset:3072
  s_add_u32 s22, s31, 270336
  buffer_load_dwordx4 v[136:139], v2, s[8:11], s22 offen offset:0
  buffer_load_dwordx4 v[140:143], v2, s[8:11], s22 offen offset:1024
  buffer_load_dwordx4 v[144:147], v2, s[8:11], s22 offen offset:2048
  buffer_load_dwordx4 v[148:151], v2, s[8:11], s22 offen offset:3072
  s_add_u32 s22, s31, 274432
  buffer_load_dwordx4 v[152:155], v2, s[8:11], s22 offen offset:0
  buffer_load_dwordx4 v[156:159], v2, s[8:11], s22 offen offset:1024
  buffer_load_dwordx4 v[160:163], v2, s[8:11], s22 offen offset:2048
  buffer_load_dwordx4 v[164:167], v2, s[8:11], s22 offen offset:3072
  s_add_u32 s22, s31, 278528
  buffer_load_dwordx4 v[168:171], v2, s[8:11], s22 offen offset:0
  buffer_load_dwordx4 v[172:175], v2, s[8:11], s22 offen offset:1024
  buffer_load_dwordx4 v[176:179], v2, s[8:11], s22 offen offset:2048
  buffer_load_dwordx4 v[180:183], v2, s[8:11], s22 offen offset:3072
  s_add_u32 s22, s31, 282624
  buffer_load_dwordx4 v[184:187], v2, s[8:11], s22 offen offset:0
  buffer_load_dwordx4 v[188:191], v2, s[8:11], s22 offen offset:1024
  buffer_load_dwordx4 v[192:195], v2, s[8:11], s22 offen offset:2048
  buffer_load_dwordx4 v[196:199], v2, s[8:11], s22 offen offset:3072
  s_add_u32 s22, s31, 344064
  buffer_load_dwordx4 v[200:203], v2, s[8:11], s22 offen offset:0
  buffer_load_dwordx4 v[204:207], v2, s[8:11], s22 offen offset:1024
  buffer_load_dwordx4 v[208:211], v2, s[8:11], s22 offen offset:2048
  buffer_load_dwordx4 v[212:215], v2, s[8:11], s22 offen offset:3072
  s_add_u32 s22, s31, 348160
  buffer_load_dwordx4 v[216:219], v2, s[8:11], s22 offen offset:0
  buffer_load_dwordx4 v[220:223], v2, s[8:11], s22 offen offset:1024
  buffer_load_dwordx4 v[224:227], v2, s[8:11], s22 offen offset:2048
  buffer_load_dwordx4 v[228:231], v2, s[8:11], s22 offen offset:3072
  s_add_u32 s22, s31, 352256
  buffer_load_dwordx4 v[232:235], v2, s[8:11], s22 offen offset:0
  buffer_load_dwordx4 v[236:239], v2, s[8:11], s22 offen offset:1024
  buffer_load_dwordx4 v[240:243], v2, s[8:11], s22 offen offset:2048
  buffer_load_dwordx4 v[244:247], v2, s[8:11], s22 offen offset:3072
  s_waitcnt vmcnt(24)
  s_add_u32 s22, s31, 356352
  buffer_load_dwordx4 v[248:251], v2, s[8:11], s22 offen offset:0
  buffer_load_dwordx4 v[252:255], v2, s[8:11], s22 offen offset:1024
  s_mov_b32 s24, 71567360
  s_mov_b32 s26, 71581696
  v_and_b32 v64, 7, v117
  v_and_b32 v65, 1, v116
  v_lshlrev_b32 v65, 2, v65
  v_sub_u32 v64, v64, v65
  v_lshrrev_b32 v65, 3, v117
  v_lshl_add_u32 v66, v65, 2, v64
  v_cmp_gt_u32 vcc, 4, v64
  v_mov_b32 v67, 99
  s_nop 0
  v_cndmask_b32 v66, v67, v66, vcc
  v_mov_b32 v68, 0x3f80
  v_mov_b32 v69, 0x3f800000
  v_mov_b32 v4, 0
  v_cmp_eq_u32 vcc, 0, v66
  s_nop 1
  v_cndmask_b32 v4, v4, v68, vcc
  v_cmp_eq_u32 vcc, 1, v66
  s_nop 1
  v_cndmask_b32 v4, v4, v69, vcc
  v_mov_b32 v5, 0
  v_cmp_eq_u32 vcc, 2, v66
  s_nop 1
  v_cndmask_b32 v5, v5, v68, vcc
  v_cmp_eq_u32 vcc, 3, v66
  s_nop 1
  v_cndmask_b32 v5, v5, v69, vcc
  v_mov_b32 v6, 0
  v_cmp_eq_u32 vcc, 4, v66
  s_nop 1
  v_cndmask_b32 v6, v6, v68, vcc
  v_cmp_eq_u32 vcc, 5, v66
  s_nop 1
  v_cndmask_b32 v6, v6, v69, vcc
  v_mov_b32 v7, 0
  v_cmp_eq_u32 vcc, 6, v66
  s_nop 1
  v_cndmask_b32 v7, v7, v68, vcc
  v_cmp_eq_u32 vcc, 7, v66
  s_nop 1
  v_cndmask_b32 v7, v7, v69, vcc
  v_lshrrev_b32 v64, 1, v116
  v_lshrrev_b32 v65, 3, v117
  v_and_b32 v66, 1, v116
  v_and_b32 v68, 7, v117
  v_lshlrev_b32 v67, 8, v65
  v_lshl_add_u32 v67, v68, 5, v67
  v_lshl_add_u32 v67, v66, 4, v67
  v_add_u32 v69, 4608, v67
  v_add_u32 v70, 6400, v67
  v_cmp_eq_u32 vcc, v64, v65
  s_nop 1
  v_cndmask_b32 v113, v70, v69, vcc
  v_lshlrev_b32 v67, 9, v64
  v_lshl_add_u32 v67, v117, 4, v67
  v_lshl_add_u32 v67, v66, 3, v67
  v_add_u32 v114, 256, v67
  v_mul_u32_u24 v67, 1088, v65
  v_lshl_add_u32 v67, v116, 5, v67
  v_lshl_add_u32 v67, v68, 2, v67
  v_add_u32 v115, 4224, v67
  v_and_b32 v69, 1, v117
  v_lshlrev_b32 v67, 7, v69
  v_lshl_add_u32 v67, v116, 4, v67
  v_lshl_add_u32 v67, v65, 8, v67
  v_bfe_u32 v69, v117, 1, 2
  v_lshl_add_u32 v67, v69, 2, v67
  s_lshl_b32 s22, s17, 9
  s_add_u32 s22, s22, 9280
  v_add_u32 v72, s22, v67
  v_bfe_u32 v69, v117, 1, 1
  v_lshlrev_b32 v67, 7, v69
  v_lshl_add_u32 v67, v116, 4, v67
  v_and_b32 v69, 4, v117
  v_add_u32 v67, v67, v69
  s_lshr_b32 s22, s17, 1
  s_lshl_b32 s22, s22, 8
  s_and_b32 s27, s17, 1
  s_lshl_b32 s27, s27, 3
  s_add_u32 s22, s22, s27
  s_add_u32 s22, s22, 7232
  v_add_u32 v67, s22, v67
  v_and_b32 v69, 9, v117
  v_mov_b32 v70, 0x40000000
  v_cmp_eq_u32 vcc, 0, v69
  s_nop 1
  v_cndmask_b32 v118, v70, v67, vcc
  v_mov_b32 v119, -1
  v_and_b32 v0, 15, v1
  s_and_b32 s22, s17, 3
  s_lshl_b32 s22, s22, 7
  s_add_u32 s22, s22, 75272704
  v_lshl_add_u32 v0, v0, 2, s22
  v_xor_b32 v69, 256, v2
  v_mul_i32_i24 v70, 4096, v66
  v_add_u32 v69, v69, v70
  v_add_u32 v117, 6144, v69
  v_mov_b32 v1, v72
  v_mov_b32 v36, 0
  v_mov_b32 v37, 0
  v_mov_b32 v38, 0
  v_mov_b32 v39, 0
  v_mov_b32 v40, 0
  v_mov_b32 v41, 0
  v_mov_b32 v42, 0
  v_mov_b32 v43, 0
  v_mov_b32 v44, 0
  v_mov_b32 v45, 0
  v_mov_b32 v46, 0
  v_mov_b32 v47, 0
  v_mov_b32 v48, 0
  v_mov_b32 v49, 0
  v_mov_b32 v50, 0
  v_mov_b32 v51, 0
  v_mov_b32 v52, 0
  v_mov_b32 v53, 0
  v_mov_b32 v54, 0
  v_mov_b32 v55, 0
  v_mov_b32 v56, 0
  v_mov_b32 v57, 0
  v_mov_b32 v58, 0
  v_mov_b32 v59, 0
  v_mov_b32 v60, 0
  v_mov_b32 v61, 0
  v_mov_b32 v62, 0
  v_mov_b32 v63, 0
  v_mov_b32 v64, 0
  v_mov_b32 v65, 0
  v_mov_b32 v66, 0
  v_mov_b32 v67, 0
  v_mov_b32 v68, 0
  v_mov_b32 v69, 0
  v_mov_b32 v70, 0
  v_mov_b32 v71, 0
  v_mov_b32 v72, 0
  v_mov_b32 v73, 0
  v_mov_b32 v74, 0
  v_mov_b32 v75, 0
  v_mov_b32 v76, 0
  v_mov_b32 v77, 0
  v_mov_b32 v78, 0
  v_mov_b32 v79, 0
  buffer_load_dwordx4 v[80:83], v117, s[8:11], s24 offen offset:0
  buffer_load_dwordx4 v[84:87], v117, s[8:11], s24 offen offset:1024
  s_mov_b32 s30, 0
  v_mov_b32 v8, 0
ch_md1:
  buffer_load_dword v9, v8, s[12:15], 0 offen sc1
  s_waitcnt vmcnt(0) lgkmcnt(0)
  v_readfirstlane_b32 s22, v9
  s_and_b32 s31, s22, 0xffff
  s_cmp_ge_u32 s31, 32
  s_cbranch_scc1 ch_go1
  s_sleep 2
  s_add_u32 s30, s30, 1
  s_cmp_lt_u32 s30, 3200000
  s_cbranch_scc1 ch_md1
  s_branch ch_end
ch_go1:
  s_mov_b32 s31, 0
  s_lshr_b32 s22, s22, 16
  s_cmp_lg_u32 s22, 0
  s_cbranch_scc1 cB_sc1_loop
  s_branch cA_sc1_loop
ch_init2:
  s_mul_i32 s31, s17, 401408
  s_add_u32 s31, s31, 0
  s_add_u32 s22, s31, 114688
  buffer_load_dwordx4 a[0:3], v2, s[8:11], s22 offen offset:0
  buffer_load_dwordx4 a[4:7], v2, s[8:11], s22 offen offset:1024
  buffer_load_dwordx4 a[8:11], v2, s[8:11], s22 offen offset:2048
  buffer_load_dwordx4 a[12:15], v2, s[8:11], s22 offen offset:3072
  s_add_u32 s22, s31, 118784
  buffer_load_dwordx4 a[16:19], v2, s[8:11], s22 offen offset:0
  buffer_load_dwordx4 a[20:23], v2, s[8:11], s22 offen offset:1024
  buffer_load_dwordx4 a[24:27], v2, s[8:11], s22 offen offset:2048
  buffer_load_dwordx4 a[28:31], v2, s[8:11], s22 offen offset:3072
  s_add_u32 s22, s31, 122880
  buffer_load_dwordx4 a[32:35], v2, s[8:11], s22 offen offset:0
  buffer_load_dwordx4 a[36:39], v2, s[8:11], s22 offen offset:1024
  buffer_load_dwordx4 a[40:43], v2, s[8:11], s22 offen offset:2048
  buffer_load_dwordx4 a[44:47], v2, s[8:11], s22 offen offset:3072
  s_add_u32 s22, s31, 126976
  buffer_load_dwordx4 a[48:51], v2, s[8:11], s22 offen offset:0
  buffer_load_dwordx4 a[52:55], v2, s[8:11], s22 offen offset:1024
  buffer_load_dwordx4 a[56:59], v2, s[8:11], s22 offen offset:2048
  buffer_load_dwordx4 a[60:63], v2, s[8:11], s22 offen offset:3072
  s_add_u32 s22, s31, 131072
  buffer_load_dwordx4 a[64:67], v2, s[8:11], s22 offen offset:0
  buffer_load_dwordx4 a[68:71], v2, s[8:11], s22 offen offset:1024
  buffer_load_dwordx4 a[72:75], v2, s[8:11], s22 offen offset:2048
  buffer_load_dwordx4 a[76:79], v2, s[8:11], s22 offen offset:3072
  s_add_u32 s22, s31, 135168
  buffer_load_dwordx4 a[80:83], v2, s[8:11], s22 offen offset:0
  buffer_load_dwordx4 a[84:87], v2, s[8:11], s22 offen offset:1024
  buffer_load_dwordx4 a[88:91], v2, s[8:11], s22 offen offset:2048
  buffer_load_dwordx4 a[92:95], v2, s[8:11], s22 offen offset:3072
  s_add_u32 s22, s31, 139264
  buffer_load_dwordx4 a[96:99], v2, s[8:11], s22 offen offset:0
  buffer_load_dwordx4 a[100:103], v2, s[8:11], s22 offen offset:1024
  buffer_load_dwordx4 a[104:107], v2, s[8:11], s22 offen offset:2048
  buffer_load_dwordx4 a[108:111], v2, s[8:11], s22 offen offset:3072
  s_add_u32 s22, s31, 143360
  buffer_load_dwordx4 a[112:115], v2, s[8:11], s22 offen offset:0
  buffer_load_dwordx4 a[116:119], v2, s[8:11], s22 offen offset:1024
  buffer_load_dwordx4 a[120:123], v2, s[8:11], s22 offen offset:2048
  buffer_load_dwordx4 a[124:127], v2, s[8:11], s22 offen offset:3072
  s_waitcnt vmcnt(24)
  s_add_u32 s22, s31, 147456
  buffer_load_dwordx4 a[128:131], v2, s[8:11], s22 offen offset:0
  buffer_load_dwordx4 a[132:135], v2, s[8:11], s22 offen offset:1024
  buffer_load_dwordx4 a[136:139], v2, s[8:11], s22 offen offset:2048
  buffer_load_dwordx4 a[140:143], v2, s[8:11], s22 offen offset:3072
  s_add_u32 s22, s31, 151552
  buffer_load_dwordx4 a[144:147], v2, s[8:11], s22 offen offset:0
  buffer_load_dwordx4 a[148:151], v2, s[8:11], s22 offen offset:1024
  buffer_load_dwordx4 a[152:155], v2, s[8:11], s22 offen offset:2048
  buffer_load_dwordx4 a[156:159], v2, s[8:11], s22 offen offset:3072
  s_add_u32 s22, s31, 155648
  buffer_load_dwordx4 a[160:163], v2, s[8:11], s22 offen offset:0
  buffer_load_dwordx4 a[164:167], v2, s[8:11], s22 offen offset:1024
  buffer_load_dwordx4 a[168:171], v2, s[8:11], s22 offen offset:2048
  buffer_load_dwordx4 a[172:175], v2, s[8:11], s22 offen offset:3072
  s_add_u32 s22, s31, 159744
  buffer_load_dwordx4 a[176:179], v2, s[8:11], s22 offen offset:0
  buffer_load_dwordx4 a[180:183], v2, s[8:11], s22 offen offset:1024
  buffer_load_dwordx4 a[184:187], v2, s[8:11], s22 offen offset:2048
  buffer_load_dwordx4 a[188:191], v2, s[8:11], s22 offen offset:3072
  s_add_u32 s22, s31, 163840
  buffer_load_dwordx4 a[192:195], v2, s[8:11], s22 offen offset:0
  buffer_load_dwordx4 a[196:199], v2, s[8:11], s22 offen offset:1024
  buffer_load_dwordx4 a[200:203], v2, s[8:11], s22 offen offset:2048
  buffer_load_dwordx4 a[204:207], v2, s[8:11], s22 offen offset:3072
  s_add_u32 s22, s31, 167936
  buffer_load_dwordx4 a[208:211], v2, s[8:11], s22 offen offset:0
  buffer_load_dwordx4 a[212:215], v2, s[8:11], s22 offen offset:1024
  buffer_load_dwordx4 a[216:219], v2, s[8:11], s22 offen offset:2048
  buffer_load_dwordx4 a[220:223], v2, s[8:11], s22 offen offset:3072
  s_add_u32 s22, s31, 286720
  buffer_load_dwordx4 a[224:227], v2, s[8:11], s22 offen offset:0
  buffer_load_dwordx4 a[228:231], v2, s[8:11], s22 offen offset:1024
  buffer_load_dwordx4 a[232:235], v2, s[8:11], s22 offen offset:2048
  buffer_load_dwordx4 a[236:239], v2, s[8:11], s22 offen offset:3072
  s_add_u32 s22, s31, 290816
  buffer_load_dwordx4 a[240:243], v2, s[8:11], s22 offen offset:0
  buffer_load_dwordx4 a[244:247], v2, s[8:11], s22 offen offset:1024
  buffer_load_dwordx4 a[248:251], v2, s[8:11], s22 offen offset:2048
  buffer_load_dwordx4 a[252:255], v2, s[8:11], s22 offen offset:3072
  s_waitcnt vmcnt(24)
  s_add_u32 s22, s31, 294912
  buffer_load_dwordx4 v[120:123], v2, s[8:11], s22 offen offset:0
  buffer_load_dwordx4 v[124:127], v2, s[8:11], s22 offen offset:1024
  buffer_load_dwordx4 v[128:131], v2, s[8:11], s22 offen offset:2048
  buffer_load_dwordx4 v[132:135], v2, s[8:11], s22 offen offset:3072
  s_add_u32 s22, s31, 299008
  buffer_load_dwordx4 v[136:139], v2, s[8:11], s22 offen offset:0
  buffer_load_dwordx4 v[140:143], v2, s[8:11], s22 offen offset:1024
  buffer_load_dwordx4 v[144:147], v2, s[8:11], s22 offen offset:2048
  buffer_load_dwordx4 v[148:151], v2, s[8:11], s22 offen offset:3072
  s_add_u32 s22, s31, 303104
  buffer_load_dwordx4 v[152:155], v2, s[8:11], s22 offen offset:0
  buffer_load_dwordx4 v[156:159], v2, s[8:11], s22 offen offset:1024
  buffer_load_dwordx4 v[160:163], v2, s[8:11], s22 offen offset:2048
  buffer_load_dwordx4 v[164:167], v2, s[8:11], s22 offen offset:3072
  s_add_u32 s22, s31, 307200
  buffer_load_dwordx4 v[168:171], v2, s[8:11], s22 offen offset:0
  buffer_load_dwordx4 v[172:175], v2, s[8:11], s22 offen offset:1024
  buffer_load_dwordx4 v[176:179], v2, s[8:11], s22 offen offset:2048
  buffer_load_dwordx4 v[180:183], v2, s[8:11], s22 offen offset:3072
  s_add_u32 s22, s31, 311296
  buffer_load_dwordx4 v[184:187], v2, s[8:11], s22 offen offset:0
  buffer_load_dwordx4 v[188:191], v2, s[8:11], s22 offen offset:1024
  buffer_load_dwordx4 v[192:195], v2, s[8:11], s22 offen offset:2048
  buffer_load_dwordx4 v[196:199], v2, s[8:11], s22 offen offset:3072
  s_add_u32 s22, s31, 385024
  buffer_load_dwordx4 v[200:203], v2, s[8:11], s22 offen offset:2048
  buffer_load_dwordx4 v[204:207], v2, s[8:11], s22 offen offset:3072
  s_add_u32 s22, s31, 389120
  buffer_load_dwordx4 v[208:211], v2, s[8:11], s22 offen offset:0
  buffer_load_dwordx4 v[212:215], v2, s[8:11], s22 offen offset:1024
  buffer_load_dwordx4 v[216:219], v2, s[8:11], s22 offen offset:2048
  buffer_load_dwordx4 v[220:223], v2, s[8:11], s22 offen offset:3072
  s_add_u32 s22, s31, 393216
  buffer_load_dwordx4 v[224:227], v2, s[8:11], s22 offen offset:0
  buffer_load_dwordx4 v[228:231], v2, s[8:11], s22 offen offset:1024
  buffer_load_dwordx4 v[232:235], v2, s[8:11], s22 offen offset:2048
  buffer_load_dwordx4 v[236:239], v2, s[8:11], s22 offen offset:3072
  s_add_u32 s22, s31, 397312
  buffer_load_dwordx4 v[240:243], v2, s[8:11], s22 offen offset:0
  buffer_load_dwordx4 v[244:247], v2, s[8:11], s22 offen offset:1024
  s_waitcnt vmcnt(24)
  buffer_load_dwordx4 v[248:251], v2, s[8:11], s22 offen offset:2048
  buffer_load_dwordx4 v[252:255], v2, s[8:11], s22 offen offset:3072
  s_mov_b32 s24, 71569408
  s_mov_b32 s26, 71583744
  v_and_b32 v64, 7, v117
  v_and_b32 v65, 1, v116
  v_lshlrev_b32 v65, 2, v65
  v_sub_u32 v64, v64, v65
  v_lshrrev_b32 v65, 3, v117
  v_lshl_add_u32 v66, v65, 2, v64
  v_cmp_gt_u32 vcc, 4, v64
  v_mov_b32 v67, 99
  s_nop 0
  v_cndmask_b32 v66, v67, v66, vcc
  v_mov_b32 v68, 0x3f80
  v_mov_b32 v69, 0x3f800000
  v_mov_b32 v4, 0
  v_cmp_eq_u32 vcc, 0, v66
  s_nop 1
  v_cndmask_b32 v4, v4, v68, vcc
  v_cmp_eq_u32 vcc, 1, v66
  s_nop 1
  v_cndmask_b32 v4, v4, v69, vcc
  v_mov_b32 v5, 0
  v_cmp_eq_u32 vcc, 2, v66
  s_nop 1
  v_cndmask_b32 v5, v5, v68, vcc
  v_cmp_eq_u32 vcc, 3, v66
  s_nop 1
  v_cndmask_b32 v5, v5, v69, vcc
  v_mov_b32 v6, 0
  v_cmp_eq_u32 vcc, 4, v66
  s_nop 1
  v_cndmask_b32 v6, v6, v68, vcc
  v_cmp_eq_u32 vcc, 5, v66
  s_nop 1
  v_cndmask_b32 v6, v6, v69, vcc
  v_mov_b32 v7, 0
  v_cmp_eq_u32 vcc, 6, v66
  s_nop 1
  v_cndmask_b32 v7, v7, v68, vcc
  v_cmp_eq_u32 vcc, 7, v66
  s_nop 1
  v_cndmask_b32 v7, v7, v69, vcc
  v_lshrrev_b32 v64, 1, v116
  v_lshrrev_b32 v65, 3, v117
  v_and_b32 v66, 1, v116
  v_and_b32 v68, 7, v117
  v_lshlrev_b32 v67, 8, v65
  v_lshl_add_u32 v67, v68, 5, v67
  v_lshl_add_u32 v67, v66, 4, v67
  v_add_u32 v69, 5184, v67
  v_add_u32 v70, 6400, v67
  v_cmp_eq_u32 vcc, v64, v65
  s_nop 1
  v_cndmask_b32 v113, v70, v69, vcc
  s_lshl_b32 s22, s17, 2
  s_add_u32 s22, s22, 75270656
  v_lshl_add_u32 v67, v1, 7, s22
  v_mov_b32 v70, 0x40000000
  v_cmp_gt_u32 vcc, 4, v1
  s_nop 1
  v_cndmask_b32 v72, v70, v67, vcc
  v_mov_b32 v119, 1
  v_and_b32 v0, 15, v1
  s_and_b32 s22, s17, 3
  s_lshl_b32 s22, s22, 7
  s_add_u32 s22, s22, 75272704
  v_lshl_add_u32 v0, v0, 2, s22
  v_xor_b32 v69, 256, v2
  v_mul_i32_i24 v70, -2048, v66
  v_add_u32 v69, v69, v70
  v_add_u32 v117, 8192, v69
  v_min_u32 v116, 0, v1
  v_lshlrev_b32 v116, 7, v116
  s_mul_i32 s35, s17, 1835008
  s_add_u32 s35, s35, 42262528
  v_mov_b32 v1, v72
  v_mov_b32 v36, 0
  v_mov_b32 v37, 0
  v_mov_b32 v38, 0
  v_mov_b32 v39, 0
  v_mov_b32 v40, 0
  v_mov_b32 v41, 0
  v_mov_b32 v42, 0
  v_mov_b32 v43, 0
  v_mov_b32 v44, 0
  v_mov_b32 v45, 0
  v_mov_b32 v46, 0
  v_mov_b32 v47, 0
  v_mov_b32 v48, 0
  v_mov_b32 v49, 0
  v_mov_b32 v50, 0
  v_mov_b32 v51, 0
  v_mov_b32 v52, 0
  v_mov_b32 v53, 0
  v_mov_b32 v54, 0
  v_mov_b32 v55, 0
  v_mov_b32 v56, 0
  v_mov_b32 v57, 0
  v_mov_b32 v58, 0
  v_mov_b32 v59, 0
  v_mov_b32 v60, 0
  v_mov_b32 v61, 0
  v_mov_b32 v62, 0
  v_mov_b32 v63, 0
  v_mov_b32 v64, 0
  v_mov_b32 v65, 0
  v_mov_b32 v66, 0
  v_mov_b32 v67, 0
  v_mov_b32 v68, 0
  v_mov_b32 v69, 0
  v_mov_b32 v70, 0
  v_mov_b32 v71, 0
  v_mov_b32 v72, 0
  v_mov_b32 v73, 0
  v_mov_b32 v74, 0
  v_mov_b32 v75, 0
  v_mov_b32 v76, 0
  v_mov_b32 v77, 0
  v_mov_b32 v78, 0
  v_mov_b32 v79, 0
  buffer_load_dwordx4 v[80:83], v117, s[8:11], s24 offen offset:0
  buffer_load_dwordx4 v[84:87], v117, s[8:11], s24 offen offset:1024
  s_mov_b32 s30, 0
  v_mov_b32 v8, 0
ch_md2:
  buffer_load_dword v9, v8, s[12:15], 0 offen sc1
  s_waitcnt vmcnt(0) lgkmcnt(0)
  v_readfirstlane_b32 s22, v9
  s_and_b32 s31, s22, 0xffff
  s_cmp_ge_u32 s31, 32
  s_cbranch_scc1 ch_go2
  s_sleep 2
  s_add_u32 s30, s30, 1
  s_cmp_lt_u32 s30, 3200000
  s_cbranch_scc1 ch_md2
  s_branch ch_end
ch_go2:
  s_mov_b32 s31, 0
  s_lshr_b32 s22, s22, 16
  s_cmp_lg_u32 s22, 0
  s_cbranch_scc1 cB_sc2_loop
  s_branch cA_sc2_loop
ch_init3:
  s_mul_i32 s31, s17, 401408
  s_add_u32 s31, s31, 0
  s_mov_b32 s22, 75235328
  v_add_u32 v64, 0, v1
  v_min_u32 v64, 323, v64
  v_lshlrev_b32 v64, 7, v64
  buffer_load_dword v65, v64, s[8:11], s22 offen sc1
  v_add_u32 v64, 64, v1
  v_min_u32 v64, 323, v64
  v_lshlrev_b32 v64, 7, v64
  buffer_load_dword v65, v64, s[8:11], s22 offen sc1
  v_add_u32 v64, 128, v1
  v_min_u32 v64, 323, v64
  v_lshlrev_b32 v64, 7, v64
  buffer_load_dword v65, v64, s[8:11], s22 offen sc1
  v_add_u32 v64, 192, v1
  v_min_u32 v64, 323, v64
  v_lshlrev_b32 v64, 7, v64
  buffer_load_dword v65, v64, s[8:11], s22 offen sc1
  v_add_u32 v64, 256, v1
  v_min_u32 v64, 323, v64
  v_lshlrev_b32 v64, 7, v64
  buffer_load_dword v65, v64, s[8:11], s22 offen sc1
  v_add_u32 v64, 320, v1
  v_min_u32 v64, 323, v64
  v_lshlrev_b32 v64, 7, v64
  buffer_load_dword v65, v64, s[8:11], s22 offen sc1
  s_add_u32 s22, s31, 172032
  buffer_load_dwordx4 a[0:3], v2, s[8:11], s22 offen offset:0
  buffer_load_dwordx4 a[4:7], v2, s[8:11], s22 offen offset:1024
  buffer_load_dwordx4 a[8:11], v2, s[8:11], s22 offen offset:2048
  buffer_load_dwordx4 a[12:15], v2, s[8:11], s22 offen offset:3072
  s_add_u32 s22, s31, 176128
  buffer_load_dwordx4 a[16:19], v2, s[8:11], s22 offen offset:0
  buffer_load_dwordx4 a[20:23], v2, s[8:11], s22 offen offset:1024
  buffer_load_dwordx4 a[24:27], v2, s[8:11], s22 offen offset:2048
  buffer_load_dwordx4 a[28:31], v2, s[8:11], s22 offen offset:3072
  s_add_u32 s22, s31, 180224
  buffer_load_dwordx4 a[32:35], v2, s[8:11], s22 offen offset:0
  buffer_load_dwordx4 a[36:39], v2, s[8:11], s22 offen offset:1024
  buffer_load_dwordx4 a[40:43], v2, s[8:11], s22 offen offset:2048
  buffer_load_dwordx4 a[44:47], v2, s[8:11], s22 offen offset:3072
  s_add_u32 s22, s31, 184320
  buffer_load_dwordx4 a[48:51], v2, s[8:11], s22 offen offset:0
  buffer_load_dwordx4 a[52:55], v2, s[8:11], s22 offen offset:1024
  buffer_load_dwordx4 a[56:59], v2, s[8:11], s22 offen offset:2048
  buffer_load_dwordx4 a[60:63], v2, s[8:11], s22 offen offset:3072
  s_add_u32 s22, s31, 188416
  buffer_load_dwordx4 a[64:67], v2, s[8:11], s22 offen offset:0
  buffer_load_dwordx4 a[68:71], v2, s[8:11], s22 offen offset:1024
  buffer_load_dwordx4 a[72:75], v2, s[8:11], s22 offen offset:2048
  buffer_load_dwordx4 a[76:79], v2, s[8:11], s22 offen offset:3072
  s_add_u32 s22, s31, 192512
  buffer_load_dwordx4 a[80:83], v2, s[8:11], s22 offen offset:0
  buffer_load_dwordx4 a[84:87], v2, s[8:11], s22 offen offset:1024
  buffer_load_dwordx4 a[88:91], v2, s[8:11], s22 offen offset:2048
  buffer_load_dwordx4 a[92:95], v2, s[8:11], s22 offen offset:3072
  s_add_u32 s22, s31, 196608
  buffer_load_dwordx4 a[96:99], v2, s[8:11], s22 offen offset:0
  buffer_load_dwordx4 a[100:103], v2, s[8:11], s22 offen offset:1024
  buffer_load_dwordx4 a[104:107], v2, s[8:11], s22 offen offset:2048
  buffer_load_dwordx4 a[108:111], v2, s[8:11], s22 offen offset:3072
  s_add_u32 s22, s31, 200704
  buffer_load_dwordx4 a[112:115], v2, s[8:11], s22 offen offset:0
  buffer_load_dwordx4 a[116:119], v2, s[8:11], s22 offen offset:1024
  buffer_load_dwordx4 a[120:123], v2, s[8:11], s22 offen offset:2048
  buffer_load_dwordx4 a[124:127], v2, s[8:11], s22 offen offset:3072
  s_waitcnt vmcnt(24)
  s_add_u32 s22, s31, 204800
  buffer_load_dwordx4 a[128:131], v2, s[8:11], s22 offen offset:0
  buffer_load_dwordx4 a[132:135], v2, s[8:11], s22 offen offset:1024
  buffer_load_dwordx4 a[136:139], v2, s[8:11], s22 offen offset:2048
  buffer_load_dwordx4 a[140:143], v2, s[8:11], s22 offen offset:3072
  s_add_u32 s22, s31, 208896
  buffer_load_dwordx4 a[144:147], v2, s[8:11], s22 offen offset:0
  buffer_load_dwordx4 a[148:151], v2, s[8:11], s22 offen offset:1024
  buffer_load_dwordx4 a[152:155], v2, s[8:11], s22 offen offset:2048
  buffer_load_dwordx4 a[156:159], v2, s[8:11], s22 offen offset:3072
  s_add_u32 s22, s31, 212992
  buffer_load_dwordx4 a[160:163], v2, s[8:11], s22 offen offset:0
  buffer_load_dwordx4 a[164:167], v2, s[8:11], s22 offen offset:1024
  buffer_load_dwordx4 a[168:171], v2, s[8:11], s22 offen offset:2048
  buffer_load_dwordx4 a[172:175], v2, s[8:11], s22 offen offset:3072
  s_add_u32 s22, s31, 217088
  buffer_load_dwordx4 a[176:179], v2, s[8:11], s22 offen offset:0
  buffer_load_dwordx4 a[180:183], v2, s[8:11], s22 offen offset:1024
  buffer_load_dwordx4 a[184:187], v2, s[8:11], s22 offen offset:2048
  buffer_load_dwordx4 a[188:191], v2, s[8:11], s22 offen offset:3072
  s_add_u32 s22, s31, 221184
  buffer_load_dwordx4 a[192:195], v2, s[8:11], s22 offen offset:0
  buffer_load_dwordx4 a[196:199], v2, s[8:11], s22 offen offset:1024
  buffer_load_dwordx4 a[200:203], v2, s[8:11], s22 offen offset:2048
  buffer_load_dwordx4 a[204:207], v2, s[8:11], s22 offen offset:3072
  s_add_u32 s22, s31, 225280
  buffer_load_dwordx4 a[208:211], v2, s[8:11], s22 offen offset:0
  buffer_load_dwordx4 a[212:215], v2, s[8:11], s22 offen offset:1024
  buffer_load_dwordx4 a[216:219], v2, s[8:11], s22 offen offset:2048
  buffer_load_dwordx4 a[220:223], v2, s[8:11], s22 offen offset:3072
  s_add_u32 s22, s31, 315392
  buffer_load_dwordx4 a[224:227], v2, s[8:11], s22 offen offset:0
  buffer_load_dwordx4 a[228:231], v2, s[8:11], s22 offen offset:1024
  buffer_load_dwordx4 a[232:235], v2, s[8:11], s22 offen offset:2048
  buffer_load_dwordx4 a[236:239], v2, s[8:11], s22 offen offset:3072
  s_add_u32 s22, s31, 319488
  buffer_load_dwordx4 a[240:243], v2, s[8:11], s22 offen offset:0
  buffer_load_dwordx4 a[244:247], v2, s[8:11], s22 offen offset:1024
  buffer_load_dwordx4 a[248:251], v2, s[8:11], s22 offen offset:2048
  buffer_load_dwordx4 a[252:255], v2, s[8:11], s22 offen offset:3072
  s_waitcnt vmcnt(24)
  s_add_u32 s22, s31, 323584
  buffer_load_dwordx4 v[120:123], v2, s[8:11], s22 offen offset:0
  buffer_load_dwordx4 v[124:127], v2, s[8:11], s22 offen offset:1024
  buffer_load_dwordx4 v[128:131], v2, s[8:11], s22 offen offset:2048
  buffer_load_dwordx4 v[132:135], v2, s[8:11], s22 offen offset:3072
  s_add_u32 s22, s31, 327680
  buffer_load_dwordx4 v[136:139], v2, s[8:11], s22 offen offset:0
  buffer_load_dwordx4 v[140:143], v2, s[8:11], s22 offen offset:1024
  buffer_load_dwordx4 v[144:147], v2, s[8:11], s22 offen offset:2048
  buffer_load_dwordx4 v[148:151], v2, s[8:11], s22 offen offset:3072
  s_add_u32 s22, s31, 331776
  buffer_load_dwordx4 v[152:155], v2, s[8:11], s22 offen offset:0
  buffer_load_dwordx4 v[156:159], v2, s[8:11], s22 offen offset:1024
  buffer_load_dwordx4 v[160:163], v2, s[8:11], s22 offen offset:2048
  buffer_load_dwordx4 v[164:167], v2, s[8:11], s22 offen offset:3072
  s_add_u32 s22, s31, 335872
  buffer_load_dwordx4 v[168:171], v2, s[8:11], s22 offen offset:0
  buffer_load_dwordx4 v[172:175], v2, s[8:11], s22 offen offset:1024
  buffer_load_dwordx4 v[176:179], v2, s[8:11], s22 offen offset:2048
  buffer_load_dwordx4 v[180:183], v2, s[8:11], s22 offen offset:3072
  s_add_u32 s22, s31, 339968
  buffer_load_dwordx4 v[184:187], v2, s[8:11], s22 offen offset:0
  buffer_load_dwordx4 v[188:191], v2, s[8:11], s22 offen offset:1024
  buffer_load_dwordx4 v[192:195], v2, s[8:11], s22 offen offset:2048
  buffer_load_dwordx4 v[196:199], v2, s[8:11], s22 offen offset:3072
  s_add_u32 s22, s31, 356352
  buffer_load_dwordx4 v[200:203], v2, s[8:11], s22 offen offset:2048
  buffer_load_dwordx4 v[204:207], v2, s[8:11], s22 offen offset:3072
  s_add_u32 s22, s31, 360448
  buffer_load_dwordx4 v[208:211], v2, s[8:11], s22 offen offset:0
  buffer_load_dwordx4 v[212:215], v2, s[8:11], s22 offen offset:1024
  buffer_load_dwordx4 v[216:219], v2, s[8:11], s22 offen offset:2048
  buffer_load_dwordx4 v[220:223], v2, s[8:11], s22 offen offset:3072
  s_add_u32 s22, s31, 364544
  buffer_load_dwordx4 v[224:227], v2, s[8:11], s22 offen offset:0
  buffer_load_dwordx4 v[228:231], v2, s[8:11], s22 offen offset:1024
  buffer_load_dwordx4 v[232:235], v2, s[8:11], s22 offen offset:2048
  buffer_load_dwordx4 v[236:239], v2, s[8:11], s22 offen offset:3072
  s_add_u32 s22, s31, 368640
  buffer_load_dwordx4 v[240:243], v2, s[8:11], s22 offen offset:0
  buffer_load_dwordx4 v[244:247], v2, s[8:11], s22 offen offset:1024
  s_waitcnt vmcnt(24)
  buffer_load_dwordx4 v[248:251], v2, s[8:11], s22 offen offset:2048
  buffer_load_dwordx4 v[252:255], v2, s[8:11], s22 offen offset:3072
  s_mov_b32 s24, 71571456
  s_mov_b32 s26, 71585792
  v_and_b32 v64, 7, v117
  v_and_b32 v65, 1, v116
  v_lshlrev_b32 v65, 2, v65
  v_sub_u32 v64, v64, v65
  v_lshrrev_b32 v65, 3, v117
  v_lshl_add_u32 v66, v65, 2, v64
  v_cmp_gt_u32 vcc, 4, v64
  v_mov_b32 v67, 99
  s_nop 0
  v_cndmask_b32 v66, v67, v66, vcc
  v_mov_b32 v68, 0x3f80
  v_mov_b32 v69, 0x3f800000
  v_mov_b32 v4, 0
  v_cmp_eq_u32 vcc, 0, v66
  s_nop 1
  v_cndmask_b32 v4, v4, v68, vcc
  v_cmp_eq_u32 vcc, 1, v66
  s_nop 1
  v_cndmask_b32 v4, v4, v69, vcc
  v_mov_b32 v5, 0
  v_cmp_eq_u32 vcc, 2, v66
  s_nop 1
  v_cndmask_b32 v5, v5, v68, vcc
  v_cmp_eq_u32 vcc, 3, v66
  s_nop 1
  v_cndmask_b32 v5, v5, v69, vcc
  v_mov_b32 v6, 0
  v_cmp_eq_u32 vcc, 4, v66
  s_nop 1
  v_cndmask_b32 v6, v6, v68, vcc
  v_cmp_eq_u32 vcc, 5, v66
  s_nop 1
  v_cndmask_b32 v6, v6, v69, vcc
  v_mov_b32 v7, 0
  v_cmp_eq_u32 vcc, 6, v66
  s_nop 1
  v_cndmask_b32 v7, v7, v68, vcc
  v_cmp_eq_u32 vcc, 7, v66
  s_nop 1
  v_cndmask_b32 v7, v7, v69, vcc
  v_lshrrev_b32 v64, 1, v116
  v_lshrrev_b32 v65, 3, v117
  v_and_b32 v66, 1, v116
  v_and_b32 v68, 7, v117
  v_lshlrev_b32 v67, 8, v65
  v_lshl_add_u32 v67, v68, 5, v67
  v_lshl_add_u32 v67, v66, 4, v67
  v_add_u32 v69, 5696, v67
  v_add_u32 v70, 6400, v67
  v_cmp_eq_u32 vcc, v64, v65
  s_nop 1
  v_cndmask_b32 v113, v70, v69, vcc
  v_and_b32 v0, 15, v1
  s_and_b32 s22, s17, 3
  s_lshl_b32 s22, s22, 7
  s_add_u32 s22, s22, 75272704
  v_lshl_add_u32 v0, v0, 2, s22
  v_xor_b32 v69, 256, v2
  v_mul_i32_i24 v70, 2048, v66
  v_add_u32 v69, v69, v70
  v_add_u32 v117, 4096, v69
  v_min_u32 v116, 0, v1
  v_lshlrev_b32 v116, 7, v116
  s_mul_i32 s35, s17, 1835008
  s_add_u32 s35, s35, 42262528
  v_mov_b32 v36, 0
  v_mov_b32 v37, 0
  v_mov_b32 v38, 0
  v_mov_b32 v39, 0
  v_mov_b32 v40, 0
  v_mov_b32 v41, 0
  v_mov_b32 v42, 0
  v_mov_b32 v43, 0
  v_mov_b32 v44, 0
  v_mov_b32 v45, 0
  v_mov_b32 v46, 0
  v_mov_b32 v47, 0
  v_mov_b32 v48, 0
  v_mov_b32 v49, 0
  v_mov_b32 v50, 0
  v_mov_b32 v51, 0
  v_mov_b32 v52, 0
  v_mov_b32 v53, 0
  v_mov_b32 v54, 0
  v_mov_b32 v55, 0
  v_mov_b32 v56, 0
  v_mov_b32 v57, 0
  v_mov_b32 v58, 0
  v_mov_b32 v59, 0
  v_mov_b32 v60, 0
  v_mov_b32 v61, 0
  v_mov_b32 v62, 0
  v_mov_b32 v63, 0
  v_mov_b32 v64, 0
  v_mov_b32 v65, 0
  v_mov_b32 v66, 0
  v_mov_b32 v67, 0
  v_mov_b32 v68, 0
  v_mov_b32 v69, 0
  v_mov_b32 v70, 0
  v_mov_b32 v71, 0
  v_mov_b32 v72, 0
  v_mov_b32 v73, 0
  v_mov_b32 v74, 0
  v_mov_b32 v75, 0
  v_mov_b32 v76, 0
  v_mov_b32 v77, 0
  v_mov_b32 v78, 0
  v_mov_b32 v79, 0
  buffer_load_dwordx4 v[80:83], v117, s[8:11], s24 offen offset:0
  buffer_load_dwordx4 v[84:87], v117, s[8:11], s24 offen offset:1024
  s_mov_b32 s30, 0
  v_mov_b32 v8, 0
ch_md3:
  buffer_load_dword v9, v8, s[12:15], 0 offen sc1
  s_waitcnt vmcnt(0) lgkmcnt(0)
  v_readfirstlane_b32 s22, v9
  s_and_b32 s31, s22, 0xffff
  s_cmp_ge_u32 s31, 32
  s_cbranch_scc1 ch_go3
  s_sleep 2
  s_add_u32 s30, s30, 1
  s_cmp_lt_u32 s30, 3200000
  s_cbranch_scc1 ch_md3
  s_branch ch_end
ch_go3:
  s_mov_b32 s31, 0
  s_lshr_b32 s22, s22, 16
  s_cmp_lg_u32 s22, 0
  s_cbranch_scc1 cB_sc3_loop
  s_branch cA_sc3_loop
ch_init4:
  s_mul_i32 s31, s17, 401408
  s_add_u32 s31, s31, 6422528
  s_add_u32 s22, s31, 0
  buffer_load_dwordx4 a[0:3], v2, s[8:11], s22 offen offset:0
  buffer_load_dwordx4 a[4:7], v2, s[8:11], s22 offen offset:1024
  buffer_load_dwordx4 a[8:11], v2, s[8:11], s22 offen offset:2048
  buffer_load_dwordx4 a[12:15], v2, s[8:11], s22 offen offset:3072
  s_add_u32 s22, s31, 4096
  buffer_load_dwordx4 a[16:19], v2, s[8:11], s22 offen offset:0
  buffer_load_dwordx4 a[20:23], v2, s[8:11], s22 offen offset:1024
  buffer_load_dwordx4 a[24:27], v2, s[8:11], s22 offen offset:2048
  buffer_load_dwordx4 a[28:31], v2, s[8:11], s22 offen offset:3072
  s_add_u32 s22, s31, 8192
  buffer_load_dwordx4 a[32:35], v2, s[8:11], s22 offen offset:0
  buffer_load_dwordx4 a[36:39], v2, s[8:11], s22 offen offset:1024
  buffer_load_dwordx4 a[40:43], v2, s[8:11], s22 offen offset:2048
  buffer_load_dwordx4 a[44:47], v2, s[8:11], s22 offen offset:3072
  s_add_u32 s22, s31, 12288
  buffer_load_dwordx4 a[48:51], v2, s[8:11], s22 offen offset:0
  buffer_load_dwordx4 a[52:55], v2, s[8:11], s22 offen offset:1024
  buffer_load_dwordx4 a[56:59], v2, s[8:11], s22 offen offset:2048
  buffer_load_dwordx4 a[60:63], v2, s[8:11], s22 offen offset:3072
  s_add_u32 s22, s31, 16384
  buffer_load_dwordx4 a[64:67], v2, s[8:11], s22 offen offset:0
  buffer_load_dwordx4 a[68:71], v2, s[8:11], s22 offen offset:1024
  buffer_load_dwordx4 a[72:75], v2, s[8:11], s22 offen offset:2048
  buffer_load_dwordx4 a[76:79], v2, s[8:11], s22 offen offset:3072
  s_add_u32 s22, s31, 20480
  buffer_load_dwordx4 a[80:83], v2, s[8:11], s22 offen offset:0
  buffer_load_dwordx4 a[84:87], v2, s[8:11], s22 offen offset:1024
  buffer_load_dwordx4 a[88:91], v2, s[8:11], s22 offen offset:2048
  buffer_load_dwordx4 a[92:95], v2, s[8:11], s22 offen offset:3072
  s_add_u32 s22, s31, 24576
  buffer_load_dwordx4 a[96:99], v2, s[8:11], s22 offen offset:0
  buffer_load_dwordx4 a[100:103], v2, s[8:11], s22 offen offset:1024
  buffer_load_dwordx4 a[104:107], v2, s[8:11], s22 offen offset:2048
  buffer_load_dwordx4 a[108:111], v2, s[8:11], s22 offen offset:3072
  s_add_u32 s22, s31, 28672
  buffer_load_dwordx4 a[112:115], v2, s[8:11], s22 offen offset:0
  buffer_load_dwordx4 a[116:119], v2, s[8:11], s22 offen offset:1024
  buffer_load_dwordx4 a[120:123], v2, s[8:11], s22 offen offset:2048
  buffer_load_dwordx4 a[124:127], v2, s[8:11], s22 offen offset:3072
  s_waitcnt vmcnt(24)
  s_add_u32 s22, s31, 32768
  buffer_load_dwordx4 a[128:131], v2, s[8:11], s22 offen offset:0
  buffer_load_dwordx4 a[132:135], v2, s[8:11], s22 offen offset:1024
  buffer_load_dwordx4 a[136:139], v2, s[8:11], s22 offen offset:2048
  buffer_load_dwordx4 a[140:143], v2, s[8:11], s22 offen offset:3072
  s_add_u32 s22, s31, 36864
  buffer_load_dwordx4 a[144:147], v2, s[8:11], s22 offen offset:0
  buffer_load_dwordx4 a[148:151], v2, s[8:11], s22 offen offset:1024
  buffer_load_dwordx4 a[152:155], v2, s[8:11], s22 offen offset:2048
  buffer_load_dwordx4 a[156:159], v2, s[8:11], s22 offen offset:3072
  s_add_u32 s22, s31, 40960
  buffer_load_dwordx4 a[160:163], v2, s[8:11], s22 offen offset:0
  buffer_load_dwordx4 a[164:167], v2, s[8:11], s22 offen offset:1024
  buffer_load_dwordx4 a[168:171], v2, s[8:11], s22 offen offset:2048
  buffer_load_dwordx4 a[172:175], v2, s[8:11], s22 offen offset:3072
  s_add_u32 s22, s31, 45056
  buffer_load_dwordx4 a[176:179], v2, s[8:11], s22 offen offset:0
  buffer_load_dwordx4 a[180:183], v2, s[8:11], s22 offen offset:1024
  buffer_load_dwordx4 a[184:187], v2, s[8:11], s22 offen offset:2048
  buffer_load_dwordx4 a[188:191], v2, s[8:11], s22 offen offset:3072
  s_add_u32 s22, s31, 49152
  buffer_load_dwordx4 a[192:195], v2, s[8:11], s22 offen offset:0
  buffer_load_dwordx4 a[196:199], v2, s[8:11], s22 offen offset:1024
  buffer_load_dwordx4 a[200:203], v2, s[8:11], s22 offen offset:2048
  buffer_load_dwordx4 a[204:207], v2, s[8:11], s22 offen offset:3072
  s_add_u32 s22, s31, 53248
  buffer_load_dwordx4 a[208:211], v2, s[8:11], s22 offen offset:0
  buffer_load_dwordx4 a[212:215], v2, s[8:11], s22 offen offset:1024
  buffer_load_dwordx4 a[216:219], v2, s[8:11], s22 offen offset:2048
  buffer_load_dwordx4 a[220:223], v2, s[8:11], s22 offen offset:3072
  s_add_u32 s22, s31, 57344
  buffer_load_dwordx4 a[224:227], v2, s[8:11], s22 offen offset:0
  buffer_load_dwordx4 a[228:231], v2, s[8:11], s22 offen offset:1024
  buffer_load_dwordx4 a[232:235], v2, s[8:11], s22 offen offset:2048
  buffer_load_dwordx4 a[236:239], v2, s[8:11], s22 offen offset:3072
  s_add_u32 s22, s31, 61440
  buffer_load_dwordx4 a[240:243], v2, s[8:11], s22 offen offset:0
  buffer_load_dwordx4 a[244:247], v2, s[8:11], s22 offen offset:1024
  buffer_load_dwordx4 a[248:251], v2, s[8:11], s22 offen offset:2048
  buffer_load_dwordx4 a[252:255], v2, s[8:11], s22 offen offset:3072
  s_waitcnt vmcnt(24)
  s_add_u32 s22, s31, 65536
  buffer_load_dwordx4 v[176:179], v2, s[8:11], s22 offen offset:0
  buffer_load_dwordx4 v[180:183], v2, s[8:11], s22 offen offset:1024
  buffer_load_dwordx4 v[184:187], v2, s[8:11], s22 offen offset:2048
  buffer_load_dwordx4 v[188:191], v2, s[8:11], s22 offen offset:3072
  s_add_u32 s22, s31, 69632
  buffer_load_dwordx4 v[192:195], v2, s[8:11], s22 offen offset:0
  buffer_load_dwordx4 v[196:199], v2, s[8:11], s22 offen offset:1024
  buffer_load_dwordx4 v[200:203], v2, s[8:11], s22 offen offset:2048
  buffer_load_dwordx4 v[204:207], v2, s[8:11], s22 offen offset:3072
  s_add_u32 s22, s31, 73728
  buffer_load_dwordx4 v[208:211], v2, s[8:11], s22 offen offset:0
  buffer_load_dwordx4 v[212:215], v2, s[8:11], s22 offen offset:1024
  buffer_load_dwordx4 v[216:219], v2, s[8:11], s22 offen offset:2048
  buffer_load_dwordx4 v[220:223], v2, s[8:11], s22 offen offset:3072
  s_add_u32 s22, s31, 77824
  buffer_load_dwordx4 v[224:227], v2, s[8:11], s22 offen offset:0
  buffer_load_dwordx4 v[228:231], v2, s[8:11], s22 offen offset:1024
  buffer_load_dwordx4 v[232:235], v2, s[8:11], s22 offen offset:2048
  buffer_load_dwordx4 v[236:239], v2, s[8:11], s22 offen offset:3072
  s_add_u32 s22, s31, 81920
  buffer_load_dwordx4 v[240:243], v2, s[8:11], s22 offen offset:0
  buffer_load_dwordx4 v[244:247], v2, s[8:11], s22 offen offset:1024
  buffer_load_dwordx4 v[248:251], v2, s[8:11], s22 offen offset:2048
  buffer_load_dwordx4 v[252:255], v2, s[8:11], s22 offen offset:3072
  s_mov_b32 m0, 16384
  s_add_u32 s22, s31, 86016
  buffer_load_dwordx4 v2, s[8:11], s22 offen offset:0 lds
  buffer_load_dwordx4 v2, s[8:11], s22 offen offset:1024 lds
  buffer_load_dwordx4 v2, s[8:11], s22 offen offset:2048 lds
  buffer_load_dwordx4 v2, s[8:11], s22 offen offset:3072 lds
  s_mov_b32 m0, 20480
  s_add_u32 s22, s31, 90112
  buffer_load_dwordx4 v2, s[8:11], s22 offen offset:0 lds
  buffer_load_dwordx4 v2, s[8:11], s22 offen offset:1024 lds
  buffer_load_dwordx4 v2, s[8:11], s22 offen offset:2048 lds
  buffer_load_dwordx4 v2, s[8:11], s22 offen offset:3072 lds
  s_mov_b32 m0, 24576
  s_add_u32 s22, s31, 94208
  buffer_load_dwordx4 v2, s[8:11], s22 offen offset:0 lds
  buffer_load_dwordx4 v2, s[8:11], s22 offen offset:1024 lds
  buffer_load_dwordx4 v2, s[8:11], s22 offen offset:2048 lds
  buffer_load_dwordx4 v2, s[8:11], s22 offen offset:3072 lds
  s_mov_b32 m0, 28672
  s_add_u32 s22, s31, 98304
  buffer_load_dwordx4 v2, s[8:11], s22 offen offset:0 lds
  buffer_load_dwordx4 v2, s[8:11], s22 offen offset:1024 lds
  v_mov_b32 v72, v116
  v_mov_b32 v73, v117
  v_lshrrev_b32 v65, 1, v72
  v_and_b32 v66, 1, v72
  v_mov_b32 v36, 0
  v_mov_b32 v37, 0
  v_mov_b32 v38, 0
  v_mov_b32 v39, 0
  v_mov_b32 v40, 0
  v_mov_b32 v41, 0
  v_mov_b32 v42, 0
  v_mov_b32 v43, 0
  v_mov_b32 v44, 0
  v_mov_b32 v45, 0
  v_mov_b32 v46, 0
  v_mov_b32 v47, 0
  v_mov_b32 v48, 0
  v_mov_b32 v49, 0
  v_mov_b32 v50, 0
  v_mov_b32 v51, 0
  v_mov_b32 v52, 0
  v_mov_b32 v53, 0
  v_mov_b32 v54, 0
  v_mov_b32 v55, 0
  v_mov_b32 v56, 0
  v_mov_b32 v57, 0
  v_mov_b32 v58, 0
  v_mov_b32 v59, 0
  v_mov_b32 v60, 0
  v_mov_b32 v61, 0
  v_mov_b32 v62, 0
  v_mov_b32 v63, 0
  v_lshlrev_b32 v75, 2, v65
  v_lshl_add_u32 v75, v66, 3, v75
  v_add_u32 v67, 0, v73
  v_mul_u32_u24 v68, 2341, v67
  v_lshrrev_b32 v68, 16, v68
  v_mul_u32_u24 v69, 28, v68
  v_sub_u32 v69, v67, v69
  v_lshrrev_b32 v70, 4, v69
  v_and_b32 v69, 15, v69
  v_lshlrev_b32 v71, 12, v70
  v_lshl_add_u32 v71, v68, 8, v71
  v_lshl_add_u32 v71, v69, 4, v71
  v_add_u32 v152, v71, v75
  v_add_u32 v67, 16, v73
  v_mul_u32_u24 v68, 2341, v67
  v_lshrrev_b32 v68, 16, v68
  v_mul_u32_u24 v69, 28, v68
  v_sub_u32 v69, v67, v69
  v_lshrrev_b32 v70, 4, v69
  v_and_b32 v69, 15, v69
  v_lshlrev_b32 v71, 12, v70
  v_lshl_add_u32 v71, v68, 8, v71
  v_lshl_add_u32 v71, v69, 4, v71
  v_add_u32 v153, v71, v75
  v_add_u32 v67, 32, v73
  v_mul_u32_u24 v68, 2341, v67
  v_lshrrev_b32 v68, 16, v68
  v_mul_u32_u24 v69, 28, v68
  v_sub_u32 v69, v67, v69
  v_lshrrev_b32 v70, 4, v69
  v_and_b32 v69, 15, v69
  v_lshlrev_b32 v71, 12, v70
  v_lshl_add_u32 v71, v68, 8, v71
  v_lshl_add_u32 v71, v69, 4, v71
  v_add_u32 v154, v71, v75
  v_add_u32 v67, 48, v73
  v_mul_u32_u24 v68, 2341, v67
  v_lshrrev_b32 v68, 16, v68
  v_mul_u32_u24 v69, 28, v68
  v_sub_u32 v69, v67, v69
  v_lshrrev_b32 v70, 4, v69
  v_and_b32 v69, 15, v69
  v_lshlrev_b32 v71, 12, v70
  v_lshl_add_u32 v71, v68, 8, v71
  v_lshl_add_u32 v71, v69, 4, v71
  v_add_u32 v155, v71, v75
  v_add_u32 v67, 64, v73
  v_mul_u32_u24 v68, 2341, v67
  v_lshrrev_b32 v68, 16, v68
  v_mul_u32_u24 v69, 28, v68
  v_sub_u32 v69, v67, v69
  v_lshrrev_b32 v70, 4, v69
  v_and_b32 v69, 15, v69
  v_lshlrev_b32 v71, 12, v70
  v_lshl_add_u32 v71, v68, 8, v71
  v_lshl_add_u32 v71, v69, 4, v71
  v_add_u32 v156, v71, v75
  v_add_u32 v67, 80, v73
  v_mul_u32_u24 v68, 2341, v67
  v_lshrrev_b32 v68, 16, v68
  v_mul_u32_u24 v69, 28, v68
  v_sub_u32 v69, v67, v69
  v_lshrrev_b32 v70, 4, v69
  v_and_b32 v69, 15, v69
  v_lshlrev_b32 v71, 12, v70
  v_lshl_add_u32 v71, v68, 8, v71
  v_lshl_add_u32 v71, v69, 4, v71
  v_add_u32 v157, v71, v75
  v_add_u32 v67, 96, v73
  v_mul_u32_u24 v68, 2341, v67
  v_lshrrev_b32 v68, 16, v68
  v_mul_u32_u24 v69, 28, v68
  v_sub_u32 v69, v67, v69
  v_lshrrev_b32 v70, 4, v69
  v_and_b32 v69, 15, v69
  v_lshlrev_b32 v71, 12, v70
  v_lshl_add_u32 v71, v68, 8, v71
  v_lshl_add_u32 v71, v69, 4, v71
  v_add_u32 v158, v71, v75
  v_mov_b32 v74, 0x40000000
  v_mov_b32 v76, 0
  v_mov_b32 v77, 0
  v_mov_b32 v78, 0
  v_mov_b32 v79, 0
  ds_write_b128 v2, v[76:79] offset:0
  ds_write_b128 v2, v[76:79] offset:1024
  ds_write_b128 v2, v[76:79] offset:2048
  ds_write_b128 v2, v[76:79] offset:3072
  s_and_b32 s22, s17, 3
  s_lshl_b32 s22, s22, 7
  s_add_u32 s22, s22, 75270656
  v_lshl_add_u32 v4, v73, 2, s22
  v_and_b32 v64, 1, v73
  v_mov_b32 v5, 0x05040100
  v_mov_b32 v65, 0x03020706
  v_cmp_eq_u32 vcc, 1, v64
  s_nop 1
  v_cndmask_b32 v5, v5, v65, vcc
  s_lshl_b32 s22, s17, 2
  s_add_u32 s22, s22, 75274752
  v_lshl_add_u32 v7, v1, 7, s22
  v_cmp_gt_u32 vcc, 4, v1
  s_nop 1
  v_cndmask_b32 v7, v74, v7, vcc
  v_mov_b32 v6, v2
  v_lshl_add_u32 v64, v66, 2, v64
  v_and_b32 v65, 2, v72
  v_add_u32 v64, v64, v65
  s_mul_i32 s22, s17, 16
  v_add_u32 v75, s22, v73
  v_lshrrev_b32 v68, 4, v75
  v_lshlrev_b32 v68, 8, v68
  v_bfe_u32 v69, v75, 1, 1
  v_lshl_add_u32 v68, v69, 7, v68
  v_lshl_add_u32 v68, v64, 4, v68
  v_and_b32 v69, 12, v75
  v_add_u32 v1, v68, v69
  s_mul_i32 s22, s17, 1835008
  s_add_u32 s25, s22, 42205184
  v_mov_b32 v162, -1
  s_mov_b32 s38, 0x40000000
  v_add_u32 v0, 16384, v2
  s_lshl_b32 s27, s17, 2
  s_add_u32 s27, s27, 88002560
  s_mov_b32 s30, 0
ch_vw4:
  buffer_load_dword v9, off, s[8:11], s27 sc1
  s_waitcnt vmcnt(0)
  v_cmp_ne_u32 vcc, 56, v9
  s_cbranch_vccz ch_vw4_d
  s_sleep 2
  s_add_u32 s30, s30, 1
  s_cmp_lt_u32 s30, 400000
  s_cbranch_scc1 ch_vw4
  s_branch cA_abort
ch_vw4_d:
  s_mov_b32 s30, 0
  v_mov_b32 v8, 0
ch_md4:
  buffer_load_dword v9, v8, s[12:15], 0 offen sc1
  s_waitcnt vmcnt(0) lgkmcnt(0)
  v_readfirstlane_b32 s22, v9
  s_and_b32 s31, s22, 0xffff
  s_cmp_ge_u32 s31, 32
  s_cbranch_scc1 ch_go4
  s_sleep 2
  s_add_u32 s30, s30, 1
  s_cmp_lt_u32 s30, 3200000
  s_cbranch_scc1 ch_md4
  s_branch ch_end
ch_go4:
  s_mov_b32 s31, 0
  s_lshr_b32 s22, s22, 16
  s_cmp_lg_u32 s22, 0
  s_cbranch_scc1 cB_va0_loop
  s_branch cA_va0_loop
ch_init5:
  s_mul_i32 s31, s17, 401408
  s_add_u32 s31, s31, 6522880
  s_add_u32 s22, s31, 0
  buffer_load_dwordx4 a[0:3], v2, s[8:11], s22 offen offset:0
  buffer_load_dwordx4 a[4:7], v2, s[8:11], s22 offen offset:1024
  buffer_load_dwordx4 a[8:11], v2, s[8:11], s22 offen offset:2048
  buffer_load_dwordx4 a[12:15], v2, s[8:11], s22 offen offset:3072
  s_add_u32 s22, s31, 4096
  buffer_load_dwordx4 a[16:19], v2, s[8:11], s22 offen offset:0
  buffer_load_dwordx4 a[20:23], v2, s[8:11], s22 offen offset:1024
  buffer_load_dwordx4 a[24:27], v2, s[8:11], s22 offen offset:2048
  buffer_load_dwordx4 a[28:31], v2, s[8:11], s22 offen offset:3072
  s_add_u32 s22, s31, 8192
  buffer_load_dwordx4 a[32:35], v2, s[8:11], s22 offen offset:0
  buffer_load_dwordx4 a[36:39], v2, s[8:11], s22 offen offset:1024
  buffer_load_dwordx4 a[40:43], v2, s[8:11], s22 offen offset:2048
  buffer_load_dwordx4 a[44:47], v2, s[8:11], s22 offen offset:3072
  s_add_u32 s22, s31, 12288
  buffer_load_dwordx4 a[48:51], v2, s[8:11], s22 offen offset:0
  buffer_load_dwordx4 a[52:55], v2, s[8:11], s22 offen offset:1024
  buffer_load_dwordx4 a[56:59], v2, s[8:11], s22 offen offset:2048
  buffer_load_dwordx4 a[60:63], v2, s[8:11], s22 offen offset:3072
  s_add_u32 s22, s31, 16384
  buffer_load_dwordx4 a[64:67], v2, s[8:11], s22 offen offset:0
  buffer_load_dwordx4 a[68:71], v2, s[8:11], s22 offen offset:1024
  buffer_load_dwordx4 a[72:75], v2, s[8:11], s22 offen offset:2048
  buffer_load_dwordx4 a[76:79], v2, s[8:11], s22 offen offset:3072
  s_add_u32 s22, s31, 20480
  buffer_load_dwordx4 a[80:83], v2, s[8:11], s22 offen offset:0
  buffer_load_dwordx4 a[84:87], v2, s[8:11], s22 offen offset:1024
  buffer_load_dwordx4 a[88:91], v2, s[8:11], s22 offen offset:2048
  buffer_load_dwordx4 a[92:95], v2, s[8:11], s22 offen offset:3072
  s_add_u32 s22, s31, 24576
  buffer_load_dwordx4 a[96:99], v2, s[8:11], s22 offen offset:0
  buffer_load_dwordx4 a[100:103], v2, s[8:11], s22 offen offset:1024
  buffer_load_dwordx4 a[104:107], v2, s[8:11], s22 offen offset:2048
  buffer_load_dwordx4 a[108:111], v2, s[8:11], s22 offen offset:3072
  s_add_u32 s22, s31, 28672
  buffer_load_dwordx4 a[112:115], v2, s[8:11], s22 offen offset:0
  buffer_load_dwordx4 a[116:119], v2, s[8:11], s22 offen offset:1024
  buffer_load_dwordx4 a[120:123], v2, s[8:11], s22 offen offset:2048
  buffer_load_dwordx4 a[124:127], v2, s[8:11], s22 offen offset:3072
  s_waitcnt vmcnt(24)
  s_add_u32 s22, s31, 32768
  buffer_load_dwordx4 a[128:131], v2, s[8:11], s22 offen offset:0
  buffer_load_dwordx4 a[132:135], v2, s[8:11], s22 offen offset:1024
  buffer_load_dwordx4 a[136:139], v2, s[8:11], s22 offen offset:2048
  buffer_load_dwordx4 a[140:143], v2, s[8:11], s22 offen offset:3072
  s_add_u32 s22, s31, 36864
  buffer_load_dwordx4 a[144:147], v2, s[8:11], s22 offen offset:0
  buffer_load_dwordx4 a[148:151], v2, s[8:11], s22 offen offset:1024
  buffer_load_dwordx4 a[152:155], v2, s[8:11], s22 offen offset:2048
  buffer_load_dwordx4 a[156:159], v2, s[8:11], s22 offen offset:3072
  s_add_u32 s22, s31, 40960
  buffer_load_dwordx4 a[160:163], v2, s[8:11], s22 offen offset:0
  buffer_load_dwordx4 a[164:167], v2, s[8:11], s22 offen offset:1024
  buffer_load_dwordx4 a[168:171], v2, s[8:11], s22 offen offset:2048
  buffer_load_dwordx4 a[172:175], v2, s[8:11], s22 offen offset:3072
  s_add_u32 s22, s31, 45056
  buffer_load_dwordx4 a[176:179], v2, s[8:11], s22 offen offset:0
  buffer_load_dwordx4 a[180:183], v2, s[8:11], s22 offen offset:1024
  buffer_load_dwordx4 a[184:187], v2, s[8:11], s22 offen offset:2048
  buffer_load_dwordx4 a[188:191], v2, s[8:11], s22 offen offset:3072
  s_add_u32 s22, s31, 49152
  buffer_load_dwordx4 a[192:195], v2, s[8:11], s22 offen offset:0
  buffer_load_dwordx4 a[196:199], v2, s[8:11], s22 offen offset:1024
  buffer_load_dwordx4 a[200:203], v2, s[8:11], s22 offen offset:2048
  buffer_load_dwordx4 a[204:207], v2, s[8:11], s22 offen offset:3072
  s_add_u32 s22, s31, 53248
  buffer_load_dwordx4 a[208:211], v2, s[8:11], s22 offen offset:0
  buffer_load_dwordx4 a[212:215], v2, s[8:11], s22 offen offset:1024
  buffer_load_dwordx4 a[216:219], v2, s[8:11], s22 offen offset:2048
  buffer_load_dwordx4 a[220:223], v2, s[8:11], s22 offen offset:3072
  s_add_u32 s22, s31, 57344
  buffer_load_dwordx4 a[224:227], v2, s[8:11], s22 offen offset:0
  buffer_load_dwordx4 a[228:231], v2, s[8:11], s22 offen offset:1024
  buffer_load_dwordx4 a[232:235], v2, s[8:11], s22 offen offset:2048
  buffer_load_dwordx4 a[236:239], v2, s[8:11], s22 offen offset:3072
  s_add_u32 s22, s31, 61440
  buffer_load_dwordx4 a[240:243], v2, s[8:11], s22 offen offset:0
  buffer_load_dwordx4 a[244:247], v2, s[8:11], s22 offen offset:1024
  buffer_load_dwordx4 a[248:251], v2, s[8:11], s22 offen offset:2048
  buffer_load_dwordx4 a[252:255], v2, s[8:11], s22 offen offset:3072
  s_waitcnt vmcnt(24)
  s_add_u32 s22, s31, 65536
  buffer_load_dwordx4 v[176:179], v2, s[8:11], s22 offen offset:0
  buffer_load_dwordx4 v[180:183], v2, s[8:11], s22 offen offset:1024
  buffer_load_dwordx4 v[184:187], v2, s[8:11], s22 offen offset:2048
  buffer_load_dwordx4 v[188:191], v2, s[8:11], s22 offen offset:3072
  s_add_u32 s22, s31, 69632
  buffer_load_dwordx4 v[192:195], v2, s[8:11], s22 offen offset:0
  buffer_load_dwordx4 v[196:199], v2, s[8:11], s22 offen offset:1024
  buffer_load_dwordx4 v[200:203], v2, s[8:11], s22 offen offset:2048
  buffer_load_dwordx4 v[204:207], v2, s[8:11], s22 offen offset:3072
  s_add_u32 s22, s31, 73728
  buffer_load_dwordx4 v[208:211], v2, s[8:11], s22 offen offset:0
  buffer_load_dwordx4 v[212:215], v2, s[8:11], s22 offen offset:1024
  buffer_load_dwordx4 v[216:219], v2, s[8:11], s22 offen offset:2048
  buffer_load_dwordx4 v[220:223], v2, s[8:11], s22 offen offset:3072
  s_add_u32 s22, s31, 77824
  buffer_load_dwordx4 v[224:227], v2, s[8:11], s22 offen offset:0
  buffer_load_dwordx4 v[228:231], v2, s[8:11], s22 offen offset:1024
  buffer_load_dwordx4 v[232:235], v2, s[8:11], s22 offen offset:2048
  buffer_load_dwordx4 v[236:239], v2, s[8:11], s22 offen offset:3072
  s_add_u32 s22, s31, 81920
  buffer_load_dwordx4 v[240:243], v2, s[8:11], s22 offen offset:0
  buffer_load_dwordx4 v[244:247], v2, s[8:11], s22 offen offset:1024
  buffer_load_dwordx4 v[248:251], v2, s[8:11], s22 offen offset:2048
  buffer_load_dwordx4 v[252:255], v2, s[8:11], s22 offen offset:3072
  s_mov_b32 m0, 30720
  s_add_u32 s22, s31, 86016
  buffer_load_dwordx4 v2, s[8:11], s22 offen offset:0 lds
  buffer_load_dwordx4 v2, s[8:11], s22 offen offset:1024 lds
  buffer_load_dwordx4 v2, s[8:11], s22 offen offset:2048 lds
  buffer_load_dwordx4 v2, s[8:11], s22 offen offset:3072 lds
  s_mov_b32 m0, 34816
  s_add_u32 s22, s31, 90112
  buffer_load_dwordx4 v2, s[8:11], s22 offen offset:0 lds
  buffer_load_dwordx4 v2, s[8:11], s22 offen offset:1024 lds
  buffer_load_dwordx4 v2, s[8:11], s22 offen offset:2048 lds
  buffer_load_dwordx4 v2, s[8:11], s22 offen offset:3072 lds
  s_mov_b32 m0, 38912
  s_add_u32 s22, s31, 94208
  buffer_load_dwordx4 v2, s[8:11], s22 offen offset:0 lds
  buffer_load_dwordx4 v2, s[8:11], s22 offen offset:1024 lds
  buffer_load_dwordx4 v2, s[8:11], s22 offen offset:2048 lds
  buffer_load_dwordx4 v2, s[8:11], s22 offen offset:3072 lds
  s_mov_b32 m0, 43008
  s_add_u32 s22, s31, 98304
  buffer_load_dwordx4 v2, s[8:11], s22 offen offset:0 lds
  buffer_load_dwordx4 v2, s[8:11], s22 offen offset:1024 lds
  v_mov_b32 v72, v116
  v_mov_b32 v73, v117
  v_lshrrev_b32 v65, 1, v72
  v_and_b32 v66, 1, v72
  v_mov_b32 v36, 0
  v_mov_b32 v37, 0
  v_mov_b32 v38, 0
  v_mov_b32 v39, 0
  v_mov_b32 v40, 0
  v_mov_b32 v41, 0
  v_mov_b32 v42, 0
  v_mov_b32 v43, 0
  v_mov_b32 v44, 0
  v_mov_b32 v45, 0
  v_mov_b32 v46, 0
  v_mov_b32 v47, 0
  v_mov_b32 v48, 0
  v_mov_b32 v49, 0
  v_mov_b32 v50, 0
  v_mov_b32 v51, 0
  v_mov_b32 v52, 0
  v_mov_b32 v53, 0
  v_mov_b32 v54, 0
  v_mov_b32 v55, 0
  v_mov_b32 v56, 0
  v_mov_b32 v57, 0
  v_mov_b32 v58, 0
  v_mov_b32 v59, 0
  v_mov_b32 v60, 0
  v_mov_b32 v61, 0
  v_mov_b32 v62, 0
  v_mov_b32 v63, 0
  v_lshlrev_b32 v75, 2, v65
  v_lshl_add_u32 v75, v66, 3, v75
  v_add_u32 v67, 112, v73
  v_mul_u32_u24 v68, 2341, v67
  v_lshrrev_b32 v68, 16, v68
  v_mul_u32_u24 v69, 28, v68
  v_sub_u32 v69, v67, v69
  v_lshrrev_b32 v70, 4, v69
  v_and_b32 v69, 15, v69
  v_lshlrev_b32 v71, 12, v70
  v_lshl_add_u32 v71, v68, 8, v71
  v_lshl_add_u32 v71, v69, 4, v71
  v_add_u32 v152, v71, v75
  v_add_u32 v67, 128, v73
  v_mul_u32_u24 v68, 2341, v67
  v_lshrrev_b32 v68, 16, v68
  v_mul_u32_u24 v69, 28, v68
  v_sub_u32 v69, v67, v69
  v_lshrrev_b32 v70, 4, v69
  v_and_b32 v69, 15, v69
  v_lshlrev_b32 v71, 12, v70
  v_lshl_add_u32 v71, v68, 8, v71
  v_lshl_add_u32 v71, v69, 4, v71
  v_add_u32 v153, v71, v75
  v_add_u32 v67, 144, v73
  v_mul_u32_u24 v68, 2341, v67
  v_lshrrev_b32 v68, 16, v68
  v_mul_u32_u24 v69, 28, v68
  v_sub_u32 v69, v67, v69
  v_lshrrev_b32 v70, 4, v69
  v_and_b32 v69, 15, v69
  v_lshlrev_b32 v71, 12, v70
  v_lshl_add_u32 v71, v68, 8, v71
  v_lshl_add_u32 v71, v69, 4, v71
  v_add_u32 v154, v71, v75
  v_add_u32 v67, 160, v73
  v_mul_u32_u24 v68, 2341, v67
  v_lshrrev_b32 v68, 16, v68
  v_mul_u32_u24 v69, 28, v68
  v_sub_u32 v69, v67, v69
  v_lshrrev_b32 v70, 4, v69
  v_and_b32 v69, 15, v69
  v_lshlrev_b32 v71, 12, v70
  v_lshl_add_u32 v71, v68, 8, v71
  v_lshl_add_u32 v71, v69, 4, v71
  v_add_u32 v155, v71, v75
  v_add_u32 v67, 176, v73
  v_mul_u32_u24 v68, 2341, v67
  v_lshrrev_b32 v68, 16, v68
  v_mul_u32_u24 v69, 28, v68
  v_sub_u32 v69, v67, v69
  v_lshrrev_b32 v70, 4, v69
  v_and_b32 v69, 15, v69
  v_lshlrev_b32 v71, 12, v70
  v_lshl_add_u32 v71, v68, 8, v71
  v_lshl_add_u32 v71, v69, 4, v71
  v_add_u32 v156, v71, v75
  v_add_u32 v67, 192, v73
  v_mul_u32_u24 v68, 2341, v67
  v_lshrrev_b32 v68, 16, v68
  v_mul_u32_u24 v69, 28, v68
  v_sub_u32 v69, v67, v69
  v_lshrrev_b32 v70, 4, v69
  v_and_b32 v69, 15, v69
  v_lshlrev_b32 v71, 12, v70
  v_lshl_add_u32 v71, v68, 8, v71
  v_lshl_add_u32 v71, v69, 4, v71
  v_add_u32 v157, v71, v75
  v_add_u32 v67, 208, v73
  v_mul_u32_u24 v68, 2341, v67
  v_lshrrev_b32 v68, 16, v68
  v_mul_u32_u24 v69, 28, v68
  v_sub_u32 v69, v67, v69
  v_lshrrev_b32 v70, 4, v69
  v_and_b32 v69, 15, v69
  v_lshlrev_b32 v71, 12, v70
  v_lshl_add_u32 v71, v68, 8, v71
  v_lshl_add_u32 v71, v69, 4, v71
  v_add_u32 v158, v71, v75
  v_mov_b32 v74, 0x40000000
  v_mov_b32 v76, 0
  v_mov_b32 v77, 0
  v_mov_b32 v78, 0
  v_mov_b32 v79, 0
  ds_write_b128 v2, v[76:79] offset:4096
  ds_write_b128 v2, v[76:79] offset:5120
  ds_write_b128 v2, v[76:79] offset:6144
  ds_write_b128 v2, v[76:79] offset:7168
  s_and_b32 s22, s17, 3
  s_lshl_b32 s22, s22, 7
  s_add_u32 s22, s22, 75270656
  v_lshl_add_u32 v4, v73, 2, s22
  v_and_b32 v64, 1, v73
  v_mov_b32 v5, 0x05040100
  v_mov_b32 v65, 0x03020706
  v_cmp_eq_u32 vcc, 1, v64
  s_nop 1
  v_cndmask_b32 v5, v5, v65, vcc
  s_lshl_b32 s22, s17, 2
  s_add_u32 s22, s22, 75274752
  v_lshl_add_u32 v7, v1, 7, s22
  v_cmp_gt_u32 vcc, 4, v1
  s_nop 1
  v_cndmask_b32 v7, v74, v7, vcc
  v_min_u32 v65, 11, v73
  v_mad_u32_u24 v65, v72, 12, v65
  v_lshlrev_b32 v6, 4, v65
  v_add_u32 v6, 1024, v6
  v_lshl_add_u32 v64, v66, 2, v64
  v_and_b32 v65, 2, v72
  v_add_u32 v64, v64, v65
  s_mul_i32 s22, s17, 12
  s_add_u32 s22, s22, 256
  v_add_u32 v75, s22, v73
  v_lshrrev_b32 v68, 4, v75
  v_lshlrev_b32 v68, 8, v68
  v_bfe_u32 v69, v75, 1, 1
  v_lshl_add_u32 v68, v69, 7, v68
  v_lshl_add_u32 v68, v64, 4, v68
  v_and_b32 v69, 12, v75
  v_add_u32 v1, v68, v69
  v_cmp_gt_u32 vcc, 12, v73
  s_nop 1
  v_cndmask_b32 v1, v74, v1, vcc
  s_mul_i32 s22, s17, 1835008
  s_add_u32 s25, s22, 42205184
  v_mov_b32 v162, -1
  s_mov_b32 s38, 0x40000000
  v_add_u32 v0, 30720, v2
  s_mov_b32 s30, 0
  v_mov_b32 v8, 0
ch_md5:
  buffer_load_dword v9, v8, s[12:15], 0 offen sc1
  s_waitcnt vmcnt(0) lgkmcnt(0)
  v_readfirstlane_b32 s22, v9
  s_and_b32 s31, s22, 0xffff
  s_cmp_ge_u32 s31, 32
  s_cbranch_scc1 ch_go5
  s_sleep 2
  s_add_u32 s30, s30, 1
  s_cmp_lt_u32 s30, 3200000
  s_cbranch_scc1 ch_md5
  s_branch ch_end
ch_go5:
  s_mov_b32 s31, 0
  s_lshr_b32 s22, s22, 16
  s_cmp_lg_u32 s22, 0
  s_cbranch_scc1 cB_va1_loop
  s_branch cA_va1_loop
ch_init6:
  s_mul_i32 s31, s17, 401408
  s_add_u32 s31, s31, 6623232
  s_add_u32 s22, s31, 0
  buffer_load_dwordx4 a[0:3], v2, s[8:11], s22 offen offset:0
  buffer_load_dwordx4 a[4:7], v2, s[8:11], s22 offen offset:1024
  buffer_load_dwordx4 a[8:11], v2, s[8:11], s22 offen offset:2048
  buffer_load_dwordx4 a[12:15], v2, s[8:11], s22 offen offset:3072
  s_add_u32 s22, s31, 4096
  buffer_load_dwordx4 a[16:19], v2, s[8:11], s22 offen offset:0
  buffer_load_dwordx4 a[20:23], v2, s[8:11], s22 offen offset:1024
  buffer_load_dwordx4 a[24:27], v2, s[8:11], s22 offen offset:2048
  buffer_load_dwordx4 a[28:31], v2, s[8:11], s22 offen offset:3072
  s_add_u32 s22, s31, 8192
  buffer_load_dwordx4 a[32:35], v2, s[8:11], s22 offen offset:0
  buffer_load_dwordx4 a[36:39], v2, s[8:11], s22 offen offset:1024
  buffer_load_dwordx4 a[40:43], v2, s[8:11], s22 offen offset:2048
  buffer_load_dwordx4 a[44:47], v2, s[8:11], s22 offen offset:3072
  s_add_u32 s22, s31, 12288
  buffer_load_dwordx4 a[48:51], v2, s[8:11], s22 offen offset:0
  buffer_load_dwordx4 a[52:55], v2, s[8:11], s22 offen offset:1024
  buffer_load_dwordx4 a[56:59], v2, s[8:11], s22 offen offset:2048
  buffer_load_dwordx4 a[60:63], v2, s[8:11], s22 offen offset:3072
  s_add_u32 s22, s31, 16384
  buffer_load_dwordx4 a[64:67], v2, s[8:11], s22 offen offset:0
  buffer_load_dwordx4 a[68:71], v2, s[8:11], s22 offen offset:1024
  buffer_load_dwordx4 a[72:75], v2, s[8:11], s22 offen offset:2048
  buffer_load_dwordx4 a[76:79], v2, s[8:11], s22 offen offset:3072
  s_add_u32 s22, s31, 20480
  buffer_load_dwordx4 a[80:83], v2, s[8:11], s22 offen offset:0
  buffer_load_dwordx4 a[84:87], v2, s[8:11], s22 offen offset:1024
  buffer_load_dwordx4 a[88:91], v2, s[8:11], s22 offen offset:2048
  buffer_load_dwordx4 a[92:95], v2, s[8:11], s22 offen offset:3072
  s_add_u32 s22, s31, 24576
  buffer_load_dwordx4 a[96:99], v2, s[8:11], s22 offen offset:0
  buffer_load_dwordx4 a[100:103], v2, s[8:11], s22 offen offset:1024
  buffer_load_dwordx4 a[104:107], v2, s[8:11], s22 offen offset:2048
  buffer_load_dwordx4 a[108:111], v2, s[8:11], s22 offen offset:3072
  s_add_u32 s22, s31, 28672
  buffer_load_dwordx4 a[112:115], v2, s[8:11], s22 offen offset:0
  buffer_load_dwordx4 a[116:119], v2, s[8:11], s22 offen offset:1024
  buffer_load_dwordx4 a[120:123], v2, s[8:11], s22 offen offset:2048
  buffer_load_dwordx4 a[124:127], v2, s[8:11], s22 offen offset:3072
  s_waitcnt vmcnt(24)
  s_add_u32 s22, s31, 32768
  buffer_load_dwordx4 a[128:131], v2, s[8:11], s22 offen offset:0
  buffer_load_dwordx4 a[132:135], v2, s[8:11], s22 offen offset:1024
  buffer_load_dwordx4 a[136:139], v2, s[8:11], s22 offen offset:2048
  buffer_load_dwordx4 a[140:143], v2, s[8:11], s22 offen offset:3072
  s_add_u32 s22, s31, 36864
  buffer_load_dwordx4 a[144:147], v2, s[8:11], s22 offen offset:0
  buffer_load_dwordx4 a[148:151], v2, s[8:11], s22 offen offset:1024
  buffer_load_dwordx4 a[152:155], v2, s[8:11], s22 offen offset:2048
  buffer_load_dwordx4 a[156:159], v2, s[8:11], s22 offen offset:3072
  s_add_u32 s22, s31, 40960
  buffer_load_dwordx4 a[160:163], v2, s[8:11], s22 offen offset:0
  buffer_load_dwordx4 a[164:167], v2, s[8:11], s22 offen offset:1024
  buffer_load_dwordx4 a[168:171], v2, s[8:11], s22 offen offset:2048
  buffer_load_dwordx4 a[172:175], v2, s[8:11], s22 offen offset:3072
  s_add_u32 s22, s31, 45056
  buffer_load_dwordx4 a[176:179], v2, s[8:11], s22 offen offset:0
  buffer_load_dwordx4 a[180:183], v2, s[8:11], s22 offen offset:1024
  buffer_load_dwordx4 a[184:187], v2, s[8:11], s22 offen offset:2048
  buffer_load_dwordx4 a[188:191], v2, s[8:11], s22 offen offset:3072
  s_add_u32 s22, s31, 49152
  buffer_load_dwordx4 a[192:195], v2, s[8:11], s22 offen offset:0
  buffer_load_dwordx4 a[196:199], v2, s[8:11], s22 offen offset:1024
  buffer_load_dwordx4 a[200:203], v2, s[8:11], s22 offen offset:2048
  buffer_load_dwordx4 a[204:207], v2, s[8:11], s22 offen offset:3072
  s_add_u32 s22, s31, 53248
  buffer_load_dwordx4 a[208:211], v2, s[8:11], s22 offen offset:0
  buffer_load_dwordx4 a[212:215], v2, s[8:11], s22 offen offset:1024
  buffer_load_dwordx4 a[216:219], v2, s[8:11], s22 offen offset:2048
  buffer_load_dwordx4 a[220:223], v2, s[8:11], s22 offen offset:3072
  s_add_u32 s22, s31, 57344
  buffer_load_dwordx4 a[224:227], v2, s[8:11], s22 offen offset:0
  buffer_load_dwordx4 a[228:231], v2, s[8:11], s22 offen offset:1024
  buffer_load_dwordx4 a[232:235], v2, s[8:11], s22 offen offset:2048
  buffer_load_dwordx4 a[236:239], v2, s[8:11], s22 offen offset:3072
  s_add_u32 s22, s31, 61440
  buffer_load_dwordx4 a[240:243], v2, s[8:11], s22 offen offset:0
  buffer_load_dwordx4 a[244:247], v2, s[8:11], s22 offen offset:1024
  buffer_load_dwordx4 a[248:251], v2, s[8:11], s22 offen offset:2048
  buffer_load_dwordx4 a[252:255], v2, s[8:11], s22 offen offset:3072
  s_waitcnt vmcnt(24)
  s_add_u32 s22, s31, 65536
  buffer_load_dwordx4 v[120:123], v2, s[8:11], s22 offen offset:0
  buffer_load_dwordx4 v[124:127], v2, s[8:11], s22 offen offset:1024
  buffer_load_dwordx4 v[128:131], v2, s[8:11], s22 offen offset:2048
  buffer_load_dwordx4 v[132:135], v2, s[8:11], s22 offen offset:3072
  s_add_u32 s22, s31, 69632
  buffer_load_dwordx4 v[136:139], v2, s[8:11], s22 offen offset:0
  buffer_load_dwordx4 v[140:143], v2, s[8:11], s22 offen offset:1024
  buffer_load_dwordx4 v[144:147], v2, s[8:11], s22 offen offset:2048
  buffer_load_dwordx4 v[148:151], v2, s[8:11], s22 offen offset:3072
  s_add_u32 s22, s31, 73728
  buffer_load_dwordx4 v[152:155], v2, s[8:11], s22 offen offset:0
  buffer_load_dwordx4 v[156:159], v2, s[8:11], s22 offen offset:1024
  buffer_load_dwordx4 v[160:163], v2, s[8:11], s22 offen offset:2048
  buffer_load_dwordx4 v[164:167], v2, s[8:11], s22 offen offset:3072
  s_add_u32 s22, s31, 77824
  buffer_load_dwordx4 v[168:171], v2, s[8:11], s22 offen offset:0
  buffer_load_dwordx4 v[172:175], v2, s[8:11], s22 offen offset:1024
  buffer_load_dwordx4 v[176:179], v2, s[8:11], s22 offen offset:2048
  buffer_load_dwordx4 v[180:183], v2, s[8:11], s22 offen offset:3072
  s_add_u32 s22, s31, 81920
  buffer_load_dwordx4 v[184:187], v2, s[8:11], s22 offen offset:0
  buffer_load_dwordx4 v[188:191], v2, s[8:11], s22 offen offset:1024
  buffer_load_dwordx4 v[192:195], v2, s[8:11], s22 offen offset:2048
  buffer_load_dwordx4 v[196:199], v2, s[8:11], s22 offen offset:3072
  s_add_u32 s22, s31, 86016
  buffer_load_dwordx4 v[200:203], v2, s[8:11], s22 offen offset:0
  buffer_load_dwordx4 v[204:207], v2, s[8:11], s22 offen offset:1024
  buffer_load_dwordx4 v[208:211], v2, s[8:11], s22 offen offset:2048
  buffer_load_dwordx4 v[212:215], v2, s[8:11], s22 offen offset:3072
  s_add_u32 s22, s31, 90112
  buffer_load_dwordx4 v[216:219], v2, s[8:11], s22 offen offset:0
  buffer_load_dwordx4 v[220:223], v2, s[8:11], s22 offen offset:1024
  buffer_load_dwordx4 v[224:227], v2, s[8:11], s22 offen offset:2048
  buffer_load_dwordx4 v[228:231], v2, s[8:11], s22 offen offset:3072
  s_add_u32 s22, s31, 94208
  buffer_load_dwordx4 v[232:235], v2, s[8:11], s22 offen offset:0
  buffer_load_dwordx4 v[236:239], v2, s[8:11], s22 offen offset:1024
  buffer_load_dwordx4 v[240:243], v2, s[8:11], s22 offen offset:2048
  buffer_load_dwordx4 v[244:247], v2, s[8:11], s22 offen offset:3072
  s_waitcnt vmcnt(24)
  s_add_u32 s22, s31, 98304
  buffer_load_dwordx4 v[248:251], v2, s[8:11], s22 offen offset:0
  buffer_load_dwordx4 v[252:255], v2, s[8:11], s22 offen offset:1024
  v_mov_b32 v72, v116
  v_mov_b32 v73, v117
  v_lshrrev_b32 v65, 1, v72
  v_and_b32 v66, 1, v72
  v_mov_b32 v36, 0
  v_mov_b32 v37, 0
  v_mov_b32 v38, 0
  v_mov_b32 v39, 0
  v_mov_b32 v40, 0
  v_mov_b32 v41, 0
  v_mov_b32 v42, 0
  v_mov_b32 v43, 0
  v_mov_b32 v44, 0
  v_mov_b32 v45, 0
  v_mov_b32 v46, 0
  v_mov_b32 v47, 0
  v_mov_b32 v48, 0
  v_mov_b32 v49, 0
  v_mov_b32 v50, 0
  v_mov_b32 v51, 0
  v_mov_b32 v52, 0
  v_mov_b32 v53, 0
  v_mov_b32 v54, 0
  v_mov_b32 v55, 0
  v_mov_b32 v56, 0
  v_mov_b32 v57, 0
  v_mov_b32 v58, 0
  v_mov_b32 v59, 0
  v_mov_b32 v60, 0
  v_mov_b32 v61, 0
  v_mov_b32 v62, 0
  v_mov_b32 v63, 0
  v_lshlrev_b32 v75, 2, v65
  v_lshl_add_u32 v75, v66, 3, v75
  v_add_u32 v67, 224, v73
  v_mul_u32_u24 v68, 2341, v67
  v_lshrrev_b32 v68, 16, v68
  v_mul_u32_u24 v69, 28, v68
  v_sub_u32 v69, v67, v69
  v_lshrrev_b32 v70, 4, v69
  v_and_b32 v69, 15, v69
  v_lshlrev_b32 v71, 12, v70
  v_lshl_add_u32 v71, v68, 8, v71
  v_lshl_add_u32 v71, v69, 4, v71
  v_add_u32 v104, v71, v75
  v_add_u32 v67, 240, v73
  v_mul_u32_u24 v68, 2341, v67
  v_lshrrev_b32 v68, 16, v68
  v_mul_u32_u24 v69, 28, v68
  v_sub_u32 v69, v67, v69
  v_lshrrev_b32 v70, 4, v69
  v_and_b32 v69, 15, v69
  v_lshlrev_b32 v71, 12, v70
  v_lshl_add_u32 v71, v68, 8, v71
  v_lshl_add_u32 v71, v69, 4, v71
  v_add_u32 v105, v71, v75
  v_add_u32 v67, 256, v73
  v_mul_u32_u24 v68, 2341, v67
  v_lshrrev_b32 v68, 16, v68
  v_mul_u32_u24 v69, 28, v68
  v_sub_u32 v69, v67, v69
  v_lshrrev_b32 v70, 4, v69
  v_and_b32 v69, 15, v69
  v_lshlrev_b32 v71, 12, v70
  v_lshl_add_u32 v71, v68, 8, v71
  v_lshl_add_u32 v71, v69, 4, v71
  v_add_u32 v106, v71, v75
  v_add_u32 v67, 272, v73
  v_mul_u32_u24 v68, 2341, v67
  v_lshrrev_b32 v68, 16, v68
  v_mul_u32_u24 v69, 28, v68
  v_sub_u32 v69, v67, v69
  v_lshrrev_b32 v70, 4, v69
  v_and_b32 v69, 15, v69
  v_lshlrev_b32 v71, 12, v70
  v_lshl_add_u32 v71, v68, 8, v71
  v_lshl_add_u32 v71, v69, 4, v71
  v_add_u32 v107, v71, v75
  v_add_u32 v67, 288, v73
  v_mul_u32_u24 v68, 2341, v67
  v_lshrrev_b32 v68, 16, v68
  v_mul_u32_u24 v69, 28, v68
  v_sub_u32 v69, v67, v69
  v_lshrrev_b32 v70, 4, v69
  v_and_b32 v69, 15, v69
  v_lshlrev_b32 v71, 12, v70
  v_lshl_add_u32 v71, v68, 8, v71
  v_lshl_add_u32 v71, v69, 4, v71
  v_add_u32 v108, v71, v75
  v_add_u32 v67, 304, v73
  v_mul_u32_u24 v68, 2341, v67
  v_lshrrev_b32 v68, 16, v68
  v_mul_u32_u24 v69, 28, v68
  v_sub_u32 v69, v67, v69
  v_lshrrev_b32 v70, 4, v69
  v_and_b32 v69, 15, v69
  v_lshlrev_b32 v71, 12, v70
  v_lshl_add_u32 v71, v68, 8, v71
  v_lshl_add_u32 v71, v69, 4, v71
  v_add_u32 v109, v71, v75
  v_add_u32 v67, 320, v73
  v_mul_u32_u24 v68, 2341, v67
  v_lshrrev_b32 v68, 16, v68
  v_mul_u32_u24 v69, 28, v68
  v_sub_u32 v69, v67, v69
  v_lshrrev_b32 v70, 4, v69
  v_and_b32 v69, 15, v69
  v_lshlrev_b32 v71, 12, v70
  v_lshl_add_u32 v71, v68, 8, v71
  v_lshl_add_u32 v71, v69, 4, v71
  v_add_u32 v110, v71, v75
  v_mov_b32 v74, 0x40000000
  v_and_b32 v119, 15, v1
  s_and_b32 s22, s17, 3
  s_lshl_b32 s22, s22, 7
  s_add_u32 s22, s22, 75274752
  v_lshl_add_u32 v119, v119, 2, s22
  s_lshl_b32 s22, s17, 2
  s_add_u32 s22, s22, 75272704
  v_lshl_add_u32 v118, v1, 7, s22
  v_cmp_gt_u32 vcc, 4, v1
  s_nop 1
  v_cndmask_b32 v118, v74, v118, vcc
  s_lshl_b32 s35, s17, 2
  s_add_u32 s35, s35, 88002560
  v_min_u32 v116, 13, v1
  s_mul_i32 s22, s17, 14
  v_add_u32 v116, s22, v116
  v_lshlrev_b32 v116, 7, v116
  s_mov_b32 s39, 71593984
  s_mov_b32 s39, 71622656
  s_mov_b32 s30, 0
  v_mov_b32 v8, 0
ch_md6:
  buffer_load_dword v9, v8, s[12:15], 0 offen sc1
  s_waitcnt vmcnt(0) lgkmcnt(0)
  v_readfirstlane_b32 s22, v9
  s_and_b32 s31, s22, 0xffff
  s_cmp_ge_u32 s31, 32
  s_cbranch_scc1 ch_go6
  s_sleep 2
  s_add_u32 s30, s30, 1
  s_cmp_lt_u32 s30, 3200000
  s_cbranch_scc1 ch_md6
  s_branch ch_end
ch_go6:
  s_mov_b32 s31, 0
  s_lshr_b32 s22, s22, 16
  s_cmp_lg_u32 s22, 0
  s_cbranch_scc1 cB_va2_loop
  s_branch cA_va2_loop
ch_init7:
  s_mul_i32 s31, s17, 401408
  s_add_u32 s31, s31, 6723584
  s_add_u32 s22, s31, 0
  buffer_load_dwordx4 a[0:3], v2, s[8:11], s22 offen offset:0
  buffer_load_dwordx4 a[4:7], v2, s[8:11], s22 offen offset:1024
  buffer_load_dwordx4 a[8:11], v2, s[8:11], s22 offen offset:2048
  buffer_load_dwordx4 a[12:15], v2, s[8:11], s22 offen offset:3072
  s_add_u32 s22, s31, 4096
  buffer_load_dwordx4 a[16:19], v2, s[8:11], s22 offen offset:0
  buffer_load_dwordx4 a[20:23], v2, s[8:11], s22 offen offset:1024
  buffer_load_dwordx4 a[24:27], v2, s[8:11], s22 offen offset:2048
  buffer_load_dwordx4 a[28:31], v2, s[8:11], s22 offen offset:3072
  s_add_u32 s22, s31, 8192
  buffer_load_dwordx4 a[32:35], v2, s[8:11], s22 offen offset:0
  buffer_load_dwordx4 a[36:39], v2, s[8:11], s22 offen offset:1024
  buffer_load_dwordx4 a[40:43], v2, s[8:11], s22 offen offset:2048
  buffer_load_dwordx4 a[44:47], v2, s[8:11], s22 offen offset:3072
  s_add_u32 s22, s31, 12288
  buffer_load_dwordx4 a[48:51], v2, s[8:11], s22 offen offset:0
  buffer_load_dwordx4 a[52:55], v2, s[8:11], s22 offen offset:1024
  buffer_load_dwordx4 a[56:59], v2, s[8:11], s22 offen offset:2048
  buffer_load_dwordx4 a[60:63], v2, s[8:11], s22 offen offset:3072
  s_add_u32 s22, s31, 16384
  buffer_load_dwordx4 a[64:67], v2, s[8:11], s22 offen offset:0
  buffer_load_dwordx4 a[68:71], v2, s[8:11], s22 offen offset:1024
  buffer_load_dwordx4 a[72:75], v2, s[8:11], s22 offen offset:2048
  buffer_load_dwordx4 a[76:79], v2, s[8:11], s22 offen offset:3072
  s_add_u32 s22, s31, 20480
  buffer_load_dwordx4 a[80:83], v2, s[8:11], s22 offen offset:0
  buffer_load_dwordx4 a[84:87], v2, s[8:11], s22 offen offset:1024
  buffer_load_dwordx4 a[88:91], v2, s[8:11], s22 offen offset:2048
  buffer_load_dwordx4 a[92:95], v2, s[8:11], s22 offen offset:3072
  s_add_u32 s22, s31, 24576
  buffer_load_dwordx4 a[96:99], v2, s[8:11], s22 offen offset:0
  buffer_load_dwordx4 a[100:103], v2, s[8:11], s22 offen offset:1024
  buffer_load_dwordx4 a[104:107], v2, s[8:11], s22 offen offset:2048
  buffer_load_dwordx4 a[108:111], v2, s[8:11], s22 offen offset:3072
  s_add_u32 s22, s31, 28672
  buffer_load_dwordx4 a[112:115], v2, s[8:11], s22 offen offset:0
  buffer_load_dwordx4 a[116:119], v2, s[8:11], s22 offen offset:1024
  buffer_load_dwordx4 a[120:123], v2, s[8:11], s22 offen offset:2048
  buffer_load_dwordx4 a[124:127], v2, s[8:11], s22 offen offset:3072
  s_waitcnt vmcnt(24)
  s_add_u32 s22, s31, 32768
  buffer_load_dwordx4 a[128:131], v2, s[8:11], s22 offen offset:0
  buffer_load_dwordx4 a[132:135], v2, s[8:11], s22 offen offset:1024
  buffer_load_dwordx4 a[136:139], v2, s[8:11], s22 offen offset:2048
  buffer_load_dwordx4 a[140:143], v2, s[8:11], s22 offen offset:3072
  s_add_u32 s22, s31, 36864
  buffer_load_dwordx4 a[144:147], v2, s[8:11], s22 offen offset:0
  buffer_load_dwordx4 a[148:151], v2, s[8:11], s22 offen offset:1024
  buffer_load_dwordx4 a[152:155], v2, s[8:11], s22 offen offset:2048
  buffer_load_dwordx4 a[156:159], v2, s[8:11], s22 offen offset:3072
  s_add_u32 s22, s31, 40960
  buffer_load_dwordx4 a[160:163], v2, s[8:11], s22 offen offset:0
  buffer_load_dwordx4 a[164:167], v2, s[8:11], s22 offen offset:1024
  buffer_load_dwordx4 a[168:171], v2, s[8:11], s22 offen offset:2048
  buffer_load_dwordx4 a[172:175], v2, s[8:11], s22 offen offset:3072
  s_add_u32 s22, s31, 45056
  buffer_load_dwordx4 a[176:179], v2, s[8:11], s22 offen offset:0
  buffer_load_dwordx4 a[180:183], v2, s[8:11], s22 offen offset:1024
  buffer_load_dwordx4 a[184:187], v2, s[8:11], s22 offen offset:2048
  buffer_load_dwordx4 a[188:191], v2, s[8:11], s22 offen offset:3072
  s_add_u32 s22, s31, 49152
  buffer_load_dwordx4 a[192:195], v2, s[8:11], s22 offen offset:0
  buffer_load_dwordx4 a[196:199], v2, s[8:11], s22 offen offset:1024
  buffer_load_dwordx4 a[200:203], v2, s[8:11], s22 offen offset:2048
  buffer_load_dwordx4 a[204:207], v2, s[8:11], s22 offen offset:3072
  s_add_u32 s22, s31, 53248
  buffer_load_dwordx4 a[208:211], v2, s[8:11], s22 offen offset:0
  buffer_load_dwordx4 a[212:215], v2, s[8:11], s22 offen offset:1024
  buffer_load_dwordx4 a[216:219], v2, s[8:11], s22 offen offset:2048
  buffer_load_dwordx4 a[220:223], v2, s[8:11], s22 offen offset:3072
  s_add_u32 s22, s31, 57344
  buffer_load_dwordx4 a[224:227], v2, s[8:11], s22 offen offset:0
  buffer_load_dwordx4 a[228:231], v2, s[8:11], s22 offen offset:1024
  buffer_load_dwordx4 a[232:235], v2, s[8:11], s22 offen offset:2048
  buffer_load_dwordx4 a[236:239], v2, s[8:11], s22 offen offset:3072
  s_add_u32 s22, s31, 61440
  buffer_load_dwordx4 a[240:243], v2, s[8:11], s22 offen offset:0
  buffer_load_dwordx4 a[244:247], v2, s[8:11], s22 offen offset:1024
  buffer_load_dwordx4 a[248:251], v2, s[8:11], s22 offen offset:2048
  buffer_load_dwordx4 a[252:255], v2, s[8:11], s22 offen offset:3072
  s_waitcnt vmcnt(24)
  s_add_u32 s22, s31, 65536
  buffer_load_dwordx4 v[120:123], v2, s[8:11], s22 offen offset:0
  buffer_load_dwordx4 v[124:127], v2, s[8:11], s22 offen offset:1024
  buffer_load_dwordx4 v[128:131], v2, s[8:11], s22 offen offset:2048
  buffer_load_dwordx4 v[132:135], v2, s[8:11], s22 offen offset:3072
  s_add_u32 s22, s31, 69632
  buffer_load_dwordx4 v[136:139], v2, s[8:11], s22 offen offset:0
  buffer_load_dwordx4 v[140:143], v2, s[8:11], s22 offen offset:1024
  buffer_load_dwordx4 v[144:147], v2, s[8:11], s22 offen offset:2048
  buffer_load_dwordx4 v[148:151], v2, s[8:11], s22 offen offset:3072
  s_add_u32 s22, s31, 73728
  buffer_load_dwordx4 v[152:155], v2, s[8:11], s22 offen offset:0
  buffer_load_dwordx4 v[156:159], v2, s[8:11], s22 offen offset:1024
  buffer_load_dwordx4 v[160:163], v2, s[8:11], s22 offen offset:2048
  buffer_load_dwordx4 v[164:167], v2, s[8:11], s22 offen offset:3072
  s_add_u32 s22, s31, 77824
  buffer_load_dwordx4 v[168:171], v2, s[8:11], s22 offen offset:0
  buffer_load_dwordx4 v[172:175], v2, s[8:11], s22 offen offset:1024
  buffer_load_dwordx4 v[176:179], v2, s[8:11], s22 offen offset:2048
  buffer_load_dwordx4 v[180:183], v2, s[8:11], s22 offen offset:3072
  s_add_u32 s22, s31, 81920
  buffer_load_dwordx4 v[184:187], v2, s[8:11], s22 offen offset:0
  buffer_load_dwordx4 v[188:191], v2, s[8:11], s22 offen offset:1024
  buffer_load_dwordx4 v[192:195], v2, s[8:11], s22 offen offset:2048
  buffer_load_dwordx4 v[196:199], v2, s[8:11], s22 offen offset:3072
  s_add_u32 s22, s31, 86016
  buffer_load_dwordx4 v[200:203], v2, s[8:11], s22 offen offset:0
  buffer_load_dwordx4 v[204:207], v2, s[8:11], s22 offen offset:1024
  buffer_load_dwordx4 v[208:211], v2, s[8:11], s22 offen offset:2048
  buffer_load_dwordx4 v[212:215], v2, s[8:11], s22 offen offset:3072
  s_add_u32 s22, s31, 90112
  buffer_load_dwordx4 v[216:219], v2, s[8:11], s22 offen offset:0
  buffer_load_dwordx4 v[220:223], v2, s[8:11], s22 offen offset:1024
  buffer_load_dwordx4 v[224:227], v2, s[8:11], s22 offen offset:2048
  buffer_load_dwordx4 v[228:231], v2, s[8:11], s22 offen offset:3072
  s_add_u32 s22, s31, 94208
  buffer_load_dwordx4 v[232:235], v2, s[8:11], s22 offen offset:0
  buffer_load_dwordx4 v[236:239], v2, s[8:11], s22 offen offset:1024
  buffer_load_dwordx4 v[240:243], v2, s[8:11], s22 offen offset:2048
  buffer_load_dwordx4 v[244:247], v2, s[8:11], s22 offen offset:3072
  s_waitcnt vmcnt(24)
  s_add_u32 s22, s31, 98304
  buffer_load_dwordx4 v[248:251], v2, s[8:11], s22 offen offset:0
  buffer_load_dwordx4 v[252:255], v2, s[8:11], s22 offen offset:1024
  v_mov_b32 v72, v116
  v_mov_b32 v73, v117
  v_lshrrev_b32 v65, 1, v72
  v_and_b32 v66, 1, v72
  v_mov_b32 v36, 0
  v_mov_b32 v37, 0
  v_mov_b32 v38, 0
  v_mov_b32 v39, 0
  v_mov_b32 v40, 0
  v_mov_b32 v41, 0
  v_mov_b32 v42, 0
  v_mov_b32 v43, 0
  v_mov_b32 v44, 0
  v_mov_b32 v45, 0
  v_mov_b32 v46, 0
  v_mov_b32 v47, 0
  v_mov_b32 v48, 0
  v_mov_b32 v49, 0
  v_mov_b32 v50, 0
  v_mov_b32 v51, 0
  v_mov_b32 v52, 0
  v_mov_b32 v53, 0
  v_mov_b32 v54, 0
  v_mov_b32 v55, 0
  v_mov_b32 v56, 0
  v_mov_b32 v57, 0
  v_mov_b32 v58, 0
  v_mov_b32 v59, 0
  v_mov_b32 v60, 0
  v_mov_b32 v61, 0
  v_mov_b32 v62, 0
  v_mov_b32 v63, 0
  v_lshlrev_b32 v75, 2, v65
  v_lshl_add_u32 v75, v66, 3, v75
  v_add_u32 v67, 336, v73
  v_mul_u32_u24 v68, 2341, v67
  v_lshrrev_b32 v68, 16, v68
  v_mul_u32_u24 v69, 28, v68
  v_sub_u32 v69, v67, v69
  v_lshrrev_b32 v70, 4, v69
  v_and_b32 v69, 15, v69
  v_lshlrev_b32 v71, 12, v70
  v_lshl_add_u32 v71, v68, 8, v71
  v_lshl_add_u32 v71, v69, 4, v71
  v_add_u32 v104, v71, v75
  v_add_u32 v67, 352, v73
  v_mul_u32_u24 v68, 2341, v67
  v_lshrrev_b32 v68, 16, v68
  v_mul_u32_u24 v69, 28, v68
  v_sub_u32 v69, v67, v69
  v_lshrrev_b32 v70, 4, v69
  v_and_b32 v69, 15, v69
  v_lshlrev_b32 v71, 12, v70
  v_lshl_add_u32 v71, v68, 8, v71
  v_lshl_add_u32 v71, v69, 4, v71
  v_add_u32 v105, v71, v75
  v_add_u32 v67, 368, v73
  v_mul_u32_u24 v68, 2341, v67
  v_lshrrev_b32 v68, 16, v68
  v_mul_u32_u24 v69, 28, v68
  v_sub_u32 v69, v67, v69
  v_lshrrev_b32 v70, 4, v69
  v_and_b32 v69, 15, v69
  v_lshlrev_b32 v71, 12, v70
  v_lshl_add_u32 v71, v68, 8, v71
  v_lshl_add_u32 v71, v69, 4, v71
  v_add_u32 v106, v71, v75
  v_add_u32 v67, 384, v73
  v_mul_u32_u24 v68, 2341, v67
  v_lshrrev_b32 v68, 16, v68
  v_mul_u32_u24 v69, 28, v68
  v_sub_u32 v69, v67, v69
  v_lshrrev_b32 v70, 4, v69
  v_and_b32 v69, 15, v69
  v_lshlrev_b32 v71, 12, v70
  v_lshl_add_u32 v71, v68, 8, v71
  v_lshl_add_u32 v71, v69, 4, v71
  v_add_u32 v107, v71, v75
  v_add_u32 v67, 400, v73
  v_mul_u32_u24 v68, 2341, v67
  v_lshrrev_b32 v68, 16, v68
  v_mul_u32_u24 v69, 28, v68
  v_sub_u32 v69, v67, v69
  v_lshrrev_b32 v70, 4, v69
  v_and_b32 v69, 15, v69
  v_lshlrev_b32 v71, 12, v70
  v_lshl_add_u32 v71, v68, 8, v71
  v_lshl_add_u32 v71, v69, 4, v71
  v_add_u32 v108, v71, v75
  v_add_u32 v67, 416, v73
  v_mul_u32_u24 v68, 2341, v67
  v_lshrrev_b32 v68, 16, v68
  v_mul_u32_u24 v69, 28, v68
  v_sub_u32 v69, v67, v69
  v_lshrrev_b32 v70, 4, v69
  v_and_b32 v69, 15, v69
  v_lshlrev_b32 v71, 12, v70
  v_lshl_add_u32 v71, v68, 8, v71
  v_lshl_add_u32 v71, v69, 4, v71
  v_add_u32 v109, v71, v75
  v_add_u32 v67, 432, v73
  v_mul_u32_u24 v68, 2341, v67
  v_lshrrev_b32 v68, 16, v68
  v_mul_u32_u24 v69, 28, v68
  v_sub_u32 v69, v67, v69
  v_lshrrev_b32 v70, 4, v69
  v_and_b32 v69, 15, v69
  v_lshlrev_b32 v71, 12, v70
  v_lshl_add_u32 v71, v68, 8, v71
  v_lshl_add_u32 v71, v69, 4, v71
  v_add_u32 v110, v71, v75
  v_mov_b32 v74, 0x40000000
  v_and_b32 v119, 15, v1
  s_and_b32 s22, s17, 3
  s_lshl_b32 s22, s22, 7
  s_add_u32 s22, s22, 75274752
  v_lshl_add_u32 v119, v119, 2, s22
  s_lshl_b32 s22, s17, 2
  s_add_u32 s22, s22, 75272704
  v_lshl_add_u32 v118, v1, 7, s22
  v_cmp_gt_u32 vcc, 4, v1
  s_nop 1
  v_cndmask_b32 v118, v74, v118, vcc
  s_lshl_b32 s35, s17, 2
  s_add_u32 s35, s35, 88002560
  v_min_u32 v116, 13, v1
  s_mul_i32 s22, s17, 14
  v_add_u32 v116, s22, v116
  v_lshlrev_b32 v116, 7, v116
  s_mov_b32 s39, 71593984
  buffer_load_dword v100, v116, s[8:11], s39 offen sc1
  s_mov_b32 s39, 71622656
  s_mov_b32 s30, 0
  v_mov_b32 v8, 0
ch_md7:
  buffer_load_dword v9, v8, s[12:15], 0 offen sc1
  s_waitcnt vmcnt(0) lgkmcnt(0)
  v_readfirstlane_b32 s22, v9
  s_and_b32 s31, s22, 0xffff
  s_cmp_ge_u32 s31, 32
  s_cbranch_scc1 ch_go7
  s_sleep 2
  s_add_u32 s30, s30, 1
  s_cmp_lt_u32 s30, 3200000
  s_cbranch_scc1 ch_md7
  s_branch ch_end
ch_go7:
  s_mov_b32 s31, 0
  s_lshr_b32 s22, s22, 16
  s_cmp_lg_u32 s22, 0
  s_cbranch_scc1 cB_va3_loop
  s_branch cA_va3_loop
.p2align 6
cA_sc0_loop:
  s_mov_b32 s30, 0
  s_mov_b32 s62, 0
  s_setprio 3
  s_sleep 6
  buffer_load_dword v76, v0, s[8:11], 0 offen sc1
  buffer_load_dword v77, v0, s[8:11], 0 offen sc1
  buffer_load_dword v78, v0, s[8:11], 0 offen sc1
cA_sc0_fp_l:
  s_waitcnt vmcnt(2)
  v_cmp_gt_u32 vcc, s19, v76
  s_cbranch_vccz cA_sc0_fp_d
  buffer_load_dword v76, v0, s[8:11], 0 offen sc1
  s_waitcnt vmcnt(2)
  v_cmp_gt_u32 vcc, s19, v77
  s_cbranch_vccz cA_sc0_fp_d
  buffer_load_dword v77, v0, s[8:11], 0 offen sc1
  s_waitcnt vmcnt(2)
  v_cmp_gt_u32 vcc, s19, v78
  s_cbranch_vccz cA_sc0_fp_d
  buffer_load_dword v78, v0, s[8:11], 0 offen sc1
  s_add_u32 s30, s30, 1
  s_cmp_lt_u32 s30, 400000
  s_cbranch_scc1 cA_sc0_fp_l
  s_branch cA_abort
cA_sc0_fp_d:
  buffer_load_dwordx4 v[8:11], v2, s[8:11], s20 offen offset:0 sc1
  s_barrier
  s_setprio 2
  buffer_load_dwordx4 v[12:15], v2, s[8:11], s20 offen offset:1024 sc1
  s_setprio 1
  buffer_load_dwordx4 v[16:19], v2, s[8:11], s20 offen offset:2048 sc1
  s_setprio 0
  buffer_load_dwordx4 v[20:23], v2, s[8:11], s20 offen offset:3072 sc1
cA_sc0_go:
  s_waitcnt vmcnt(3)
  v_smfmac_f32_16x16x64_bf16 v[36:39], v[8:11], a[0:7], v3
  buffer_load_dwordx4 v[32:35], v2, s[8:11], s23 offen offset:0 sc1
  v_cmp_eq_u32 vcc, -1, v8
  v_smfmac_f32_16x16x64_bf16 v[40:43], v[8:11], a[56:63], v3
  v_smfmac_f32_16x16x64_bf16 v[44:47], v[8:11], a[112:119], v3
  buffer_load_dwordx4 v[24:27], v2, s[8:11], s23 offen offset:1024 sc1
  s_cbranch_vccnz cA_sc0_r0
  v_smfmac_f32_16x16x64_bf16 v[48:51], v[8:11], a[168:175], v3
  v_smfmac_f32_16x16x64_bf16 v[52:55], v[8:11], a[224:231], v3
  s_waitcnt vmcnt(4)
  v_cmp_eq_u32 vcc, -1, v12
  v_smfmac_f32_16x16x64_bf16 v[56:59], v[8:11], v[144:151], v3
  buffer_load_dwordx4 v[28:31], v2, s[8:11], s23 offen offset:2048 sc1
  v_smfmac_f32_16x16x64_bf16 v[60:63], v[8:11], v[200:207], v3
  s_cbranch_vccnz cA_sc0_r1
cA_sc0_c1:
  v_smfmac_f32_16x16x64_bf16 v[36:39], v[12:15], a[8:15], v3
  v_smfmac_f32_16x16x64_bf16 v[40:43], v[12:15], a[64:71], v3
  v_smfmac_f32_16x16x64_bf16 v[44:47], v[12:15], a[120:127], v3
  v_smfmac_f32_16x16x64_bf16 v[48:51], v[12:15], a[176:183], v3
  v_smfmac_f32_16x16x64_bf16 v[52:55], v[12:15], a[232:239], v3
  s_waitcnt vmcnt(4)
  v_cmp_eq_u32 vcc, -1, v16
  v_smfmac_f32_16x16x64_bf16 v[56:59], v[12:15], v[152:159], v3
  buffer_load_dwordx4 v[88:91], v117, s[8:11], s26 offen offset:0
  v_smfmac_f32_16x16x64_bf16 v[60:63], v[12:15], v[208:215], v3
  s_cbranch_vccnz cA_sc0_r2
cA_sc0_c2:
  v_smfmac_f32_16x16x64_bf16 v[36:39], v[16:19], a[16:23], v3
  v_smfmac_f32_16x16x64_bf16 v[40:43], v[16:19], a[72:79], v3
  v_smfmac_f32_16x16x64_bf16 v[44:47], v[16:19], a[128:135], v3
  buffer_load_dwordx4 v[92:95], v117, s[8:11], s26 offen offset:1024
  v_smfmac_f32_16x16x64_bf16 v[48:51], v[16:19], a[184:191], v3
  v_smfmac_f32_16x16x64_bf16 v[52:55], v[16:19], a[240:247], v3
  s_waitcnt vmcnt(5)
  v_cmp_eq_u32 vcc, -1, v20
  v_smfmac_f32_16x16x64_bf16 v[56:59], v[16:19], v[160:167], v3
  v_smfmac_f32_16x16x64_bf16 v[60:63], v[16:19], v[216:223], v3
  buffer_load_dwordx4 v[96:99], v2, s[8:11], s24 offen offset:0
  s_cbranch_vccnz cA_sc0_r3
cA_sc0_c3:
  v_smfmac_f32_16x16x64_bf16 v[36:39], v[20:23], a[24:31], v3
  v_smfmac_f32_16x16x64_bf16 v[40:43], v[20:23], a[80:87], v3
  s_waitcnt vmcnt(3)
  v_max3_u32 v66, v24, v27, v28
  v_smfmac_f32_16x16x64_bf16 v[44:47], v[20:23], a[136:143], v3
  v_max3_u32 v66, v66, v31, v32
  v_smfmac_f32_16x16x64_bf16 v[48:51], v[20:23], a[192:199], v3
  buffer_load_dwordx4 v[100:103], v2, s[8:11], s24 offen offset:1024
  v_max_u32 v66, v66, v35
  v_smfmac_f32_16x16x64_bf16 v[52:55], v[20:23], a[248:255], v3
  v_cmp_eq_u32 vcc, -1, v66
  v_smfmac_f32_16x16x64_bf16 v[56:59], v[20:23], v[168:175], v3
  v_smfmac_f32_16x16x64_bf16 v[60:63], v[20:23], v[224:231], v3
  s_cbranch_vccnz cA_sc0_r4
cA_sc0_c4:
  v_smfmac_f32_16x16x64_bf16 v[60:63], v[32:35], v[232:239], v3
  buffer_load_dwordx4 v[104:107], v2, s[8:11], s26 offen offset:0
  v_smfmac_f32_16x16x64_bf16 v[60:63], v[24:27], v[240:247], v3
  v_smfmac_f32_16x16x64_bf16 v[60:63], v[28:31], v[248:255], v3
  v_smfmac_f32_16x16x64_bf16 v[52:55], v[32:35], v[120:127], v3
  v_smfmac_f32_16x16x64_bf16 v[52:55], v[24:27], v[128:135], v3
  buffer_load_dwordx4 v[108:111], v2, s[8:11], s26 offen offset:1024
  v_smfmac_f32_16x16x64_bf16 v[52:55], v[28:31], v[136:143], v3
  v_cvt_pk_bf16_f32 v63, v62, v63
  v_smfmac_f32_16x16x64_bf16 v[56:59], v[32:35], v[176:183], v3
  v_cvt_pk_bf16_f32 v62, v60, v61
  v_smfmac_f32_16x16x64_bf16 v[56:59], v[24:27], v[184:191], v3
  v_mfma_f32_16x16x32_bf16 v[12:15], v[62:65], v[4:7], 0
  v_cvt_pk_bf16_f32 v55, v54, v55
  v_smfmac_f32_16x16x64_bf16 v[56:59], v[28:31], v[192:199], v3
  v_cvt_pk_bf16_f32 v54, v52, v53
  v_smfmac_f32_16x16x64_bf16 v[36:39], v[32:35], a[32:39], v3
  s_nop 1
  v_cvt_pk_bf16_f32 v76, v12, v13
  v_smfmac_f32_16x16x64_bf16 v[36:39], v[24:27], a[40:47], v3
  v_cvt_pk_bf16_f32 v77, v14, v15
  v_smfmac_f32_16x16x64_bf16 v[36:39], v[28:31], a[48:55], v3
  v_cvt_pk_bf16_f32 v56, v56, v57
  v_smfmac_f32_16x16x64_bf16 v[40:43], v[32:35], a[88:95], v3
  v_cvt_pk_bf16_f32 v57, v58, v59
  v_smfmac_f32_16x16x64_bf16 v[40:43], v[24:27], a[96:103], v3
  v_mfma_f32_16x16x32_bf16 v[16:19], v[54:57], v[4:7], 0
  v_cvt_pk_bf16_f32 v39, v38, v39
  v_smfmac_f32_16x16x64_bf16 v[40:43], v[28:31], a[104:111], v3
  v_cvt_pk_bf16_f32 v38, v36, v37
  v_smfmac_f32_16x16x64_bf16 v[44:47], v[32:35], a[144:151], v3
  s_nop 1
  v_cvt_pk_bf16_f32 v78, v16, v17
  v_smfmac_f32_16x16x64_bf16 v[44:47], v[24:27], a[152:159], v3
  v_cvt_pk_bf16_f32 v79, v18, v19
  v_smfmac_f32_16x16x64_bf16 v[44:47], v[28:31], a[160:167], v3
  v_cvt_pk_bf16_f32 v40, v40, v41
  v_smfmac_f32_16x16x64_bf16 v[48:51], v[32:35], a[200:207], v3
  v_cvt_pk_bf16_f32 v41, v42, v43
  v_smfmac_f32_16x16x64_bf16 v[48:51], v[24:27], a[208:215], v3
  v_smfmac_f32_16x16x64_bf16 v[48:51], v[28:31], a[216:223], v3
  s_waitcnt vmcnt(4)
  v_cvt_pk_bf16_f32 v47, v46, v47
  v_smfmac_f32_16x16x64_bf16 v[68:71], v[76:79], v[80:87], v3
  v_cvt_pk_bf16_f32 v46, v44, v45
  v_mfma_f32_16x16x32_bf16 v[12:15], v[38:41], v[4:7], 0
  s_nop 1
  v_cvt_pk_bf16_f32 v48, v48, v49
  v_cvt_pk_bf16_f32 v49, v50, v51
  s_nop 1
  v_mfma_f32_16x16x32_bf16 v[16:19], v[46:49], v[4:7], 0
  v_smfmac_f32_16x16x64_bf16 v[72:75], v[76:79], v[88:95], v3
  v_cvt_pk_bf16_f32 v20, v12, v13
  v_mfma_f32_16x16x32_bf16 v[52:55], v[30:33], v[76:79], 0
  s_waitcnt vmcnt(0)
  v_cvt_pk_bf16_f32 v21, v14, v15
  v_cvt_pk_bf16_f32 v22, v16, v17
  v_cvt_pk_bf16_f32 v23, v18, v19
  s_nop 1
  v_smfmac_f32_16x16x64_bf16 v[68:71], v[20:23], v[96:103], v3
  v_mfma_f32_16x16x32_bf16 v[52:55], v[8:11], v[20:23], v[52:55]
  v_smfmac_f32_16x16x64_bf16 v[72:75], v[20:23], v[104:111], v3
  s_nop 1
  v_permlane32_swap_b32 v68, v70
  v_permlane32_swap_b32 v69, v71
  v_add_f32 v56, v68, v70
  v_add_f32 v58, v69, v71
  ds_write_b128 v113, v[52:55]
  s_nop 0
  v_permlane32_swap_b32 v72, v74
  v_permlane32_swap_b32 v73, v75
  v_add_f32 v57, v72, v74
  v_add_f32 v59, v73, v75
  ds_write_b128 v2, v[56:59] offset:0
  v_cmp_u_f32 vcc, v57, v59
  v_mov_b32 v36, 0
  v_mov_b32 v37, 0
  v_mov_b32 v38, 0
  v_mov_b32 v39, 0
  s_cbranch_vccnz cA_sc0_retry
cA_sc0_cont:
  s_add_u32 s24, s24, 28672
  s_add_u32 s26, s26, 28672
  buffer_load_dwordx4 v[80:83], v117, s[8:11], s24 offen offset:0
  buffer_load_dwordx4 v[84:87], v117, s[8:11], s24 offen offset:1024
  v_mov_b32 v40, 0
  v_mov_b32 v41, 0
  v_mov_b32 v42, 0
  v_mov_b32 v43, 0
  v_mov_b32 v44, 0
  v_mov_b32 v45, 0
  v_mov_b32 v46, 0
  v_mov_b32 v47, 0
  v_mov_b32 v48, 0
  v_mov_b32 v49, 0
  v_mov_b32 v50, 0
  v_mov_b32 v51, 0
  s_waitcnt lgkmcnt(0)
  s_barrier
  ds_read_b64 v[8:9], v114 offset:0
  ds_read_b64 v[10:11], v114 offset:1024
  ds_read_b64 v[12:13], v114 offset:2048
  ds_read_b64 v[14:15], v114 offset:3072
  ds_read2_b32 v[16:17], v115 offset0:0 offset1:64
  ds_read2_b32 v[18:19], v115 offset0:128 offset1:192
  s_waitcnt lgkmcnt(0)
  v_pk_add_f32 v[16:17], v[16:17], v[18:19]
  v_pk_add_f32 v[8:9], v[8:9], v[10:11]
  v_pk_add_f32 v[12:13], v[12:13], v[14:15]
  v_add_f32 v20, v16, v17
  v_pk_add_f32 v[8:9], v[8:9], v[12:13]
  v_max_f32 v22, v8, v9
  v_add_f32_dpp v20, v20, v20 row_ror:8 row_mask:0xf bank_mask:0xf
  s_nop 0
  v_max_f32_dpp v22, v22, v22 row_ror:8 row_mask:0xf bank_mask:0xf
  v_max_f32 v22, v22, v20
  s_nop 1
  v_max_f32_dpp v22, v22, v22 quad_perm:[1,0,3,2] row_mask:0xf bank_mask:0xf
  s_nop 1
  v_max_f32_dpp v22, v22, v22 quad_perm:[2,3,0,1] row_mask:0xf bank_mask:0xf
  s_nop 1
  v_max_f32_dpp v22, v22, v22 row_half_mirror row_mask:0xf bank_mask:0xf
  v_pk_add_f32 v[8:9], v[8:9], v[22:23] op_sel_hi:[1,0] neg_lo:[0,1] neg_hi:[0,1]
  v_sub_f32 v20, v20, v22
  v_exp_f32 v8, v8
  v_exp_f32 v9, v9
  v_exp_f32 v20, v20
  v_add_f32 v24, v8, v9
  v_fmac_f32 v24, 0.5, v20
  v_mov_b32_dpp v21, v20 quad_perm:[1,0,3,2] row_mask:0xf bank_mask:0xf
  s_nop 0
  v_add_f32_dpp v24, v24, v24 quad_perm:[1,0,3,2] row_mask:0xf bank_mask:0xf
  s_nop 1
  v_add_f32_dpp v24, v24, v24 quad_perm:[2,3,0,1] row_mask:0xf bank_mask:0xf
  s_nop 1
  v_add_f32_dpp v24, v24, v24 row_half_mirror row_mask:0xf bank_mask:0xf
  s_nop 1
  v_add_f32_dpp v24, v24, v24 row_ror:8 row_mask:0xf bank_mask:0xf
  v_rcp_f32 v24, v24
  s_nop 0
  v_pk_mul_f32 v[8:9], v[8:9], v[24:25] op_sel_hi:[1,0]
  v_pk_mul_f32 v[20:21], v[20:21], v[24:25] op_sel_hi:[1,0]
  v_cvt_pk_bf16_f32 v8, v8, v9
  v_cvt_pk_bf16_f32 v20, v20, v21
  v_min_u32 v8, -2, v8
  buffer_store_dword v8, v1, s[8:11], s20 offen
  v_min_u32 v20, -2, v20
  buffer_store_dword v20, v118, s[8:11], s20 offen
  buffer_store_dword v119, v1, s[8:11], s21 offen
  buffer_store_dword v119, v118, s[8:11], s21 offen
  v_mov_b32 v60, 0
  v_mov_b32 v61, 0
  v_mov_b32 v62, 0
  v_mov_b32 v63, 0
  v_mov_b32 v68, 0
  v_mov_b32 v69, 0
  v_mov_b32 v70, 0
  v_mov_b32 v71, 0
  v_mov_b32 v72, 0
  v_mov_b32 v73, 0
  v_mov_b32 v74, 0
  v_mov_b32 v75, 0
  v_mov_b32 v52, 0
  v_mov_b32 v53, 0
  v_mov_b32 v54, 0
  v_mov_b32 v55, 0
  v_mov_b32 v56, 0
  v_mov_b32 v57, 0
  v_mov_b32 v58, 0
  v_mov_b32 v59, 0
  s_mov_b32 s19, s18
  s_add_u32 s18, s18, 1
  s_mov_b32 s22, s20
  s_mov_b32 s20, s21
  s_mov_b32 s21, s22
  s_add_u32 s23, s20, 4096
  s_cmp_lt_u32 s19, 63
  s_cbranch_scc1 cA_sc0_loop
  s_branch cA_done
cA_sc0_r0:
  s_add_u32 s31, s31, 1
  buffer_load_dwordx4 v[8:11], v2, s[8:11], s20 offen offset:0 sc1
  s_waitcnt vmcnt(0)
  v_cmp_eq_u32 vcc, -1, v8
  v_mov_b32 v36, 0
  v_mov_b32 v37, 0
  v_mov_b32 v38, 0
  v_mov_b32 v39, 0
  v_mov_b32 v40, 0
  v_mov_b32 v41, 0
  v_mov_b32 v42, 0
  v_mov_b32 v43, 0
  v_mov_b32 v44, 0
  v_mov_b32 v45, 0
  v_mov_b32 v46, 0
  v_mov_b32 v47, 0
  v_mov_b32 v48, 0
  v_mov_b32 v49, 0
  v_mov_b32 v50, 0
  v_mov_b32 v51, 0
  s_nop 1
  s_cbranch_vccz cA_sc0_go
  s_add_u32 s30, s30, 1
  s_cmp_lt_u32 s30, 400000
  s_cbranch_scc1 cA_sc0_r0
  s_branch cA_abort
cA_sc0_r1:
  s_add_u32 s31, s31, 1
  buffer_load_dwordx4 v[12:15], v2, s[8:11], s20 offen offset:1024 sc1
  s_waitcnt vmcnt(0)
  v_cmp_eq_u32 vcc, -1, v12
  s_nop 4
  s_cbranch_vccz cA_sc0_c1
  s_add_u32 s30, s30, 1
  s_cmp_lt_u32 s30, 400000
  s_cbranch_scc1 cA_sc0_r1
  s_branch cA_abort
cA_sc0_r2:
  s_add_u32 s31, s31, 1
  buffer_load_dwordx4 v[16:19], v2, s[8:11], s20 offen offset:2048 sc1
  s_waitcnt vmcnt(0)
  v_cmp_eq_u32 vcc, -1, v16
  s_nop 4
  s_cbranch_vccz cA_sc0_c2
  s_add_u32 s30, s30, 1
  s_cmp_lt_u32 s30, 400000
  s_cbranch_scc1 cA_sc0_r2
  s_branch cA_abort
cA_sc0_r3:
  s_add_u32 s31, s31, 1
  buffer_load_dwordx4 v[20:23], v2, s[8:11], s20 offen offset:3072 sc1
  s_waitcnt vmcnt(0)
  v_cmp_eq_u32 vcc, -1, v20
  s_nop 4
  s_cbranch_vccz cA_sc0_c3
  s_add_u32 s30, s30, 1
  s_cmp_lt_u32 s30, 400000
  s_cbranch_scc1 cA_sc0_r3
  s_branch cA_abort
cA_sc0_r4:
  s_add_u32 s31, s31, 1
  buffer_load_dwordx4 v[32:35], v2, s[8:11], s23 offen offset:0 sc1
  buffer_load_dwordx4 v[24:27], v2, s[8:11], s23 offen offset:1024 sc1
  buffer_load_dwordx4 v[28:31], v2, s[8:11], s23 offen offset:2048 sc1
  s_waitcnt vmcnt(0)
  v_max3_u32 v66, v24, v27, v28
  v_max3_u32 v66, v66, v31, v32
  v_max_u32 v66, v66, v35
  v_cmp_eq_u32 vcc, -1, v66
  s_nop 4
  s_cbranch_vccz cA_sc0_c4
  s_add_u32 s30, s30, 1
  s_cmp_lt_u32 s30, 400000
  s_cbranch_scc1 cA_sc0_r4
  s_branch cA_abort
cA_sc0_retry:
  s_cmp_lg_u32 s62, 0
  s_cbranch_scc1 cA_sc0_cont
  s_waitcnt vmcnt(0) lgkmcnt(0)
cA_sc0_rv:
  buffer_load_dwordx4 v[8:11], v2, s[8:11], s20 offen offset:0 sc1
  buffer_load_dwordx4 v[12:15], v2, s[8:11], s20 offen offset:1024 sc1
  buffer_load_dwordx4 v[16:19], v2, s[8:11], s20 offen offset:2048 sc1
  buffer_load_dwordx4 v[20:23], v2, s[8:11], s20 offen offset:3072 sc1
  buffer_load_dwordx4 v[32:35], v2, s[8:11], s23 offen offset:0 sc1
  buffer_load_dwordx4 v[24:27], v2, s[8:11], s23 offen offset:1024 sc1
  buffer_load_dwordx4 v[28:31], v2, s[8:11], s23 offen offset:2048 sc1
  s_waitcnt vmcnt(0)
  v_pk_max_u16 v66, v8, v9
  v_pk_max_u16 v66, v66, v10
  v_pk_max_u16 v66, v66, v11
  v_pk_max_u16 v66, v66, v12
  v_pk_max_u16 v66, v66, v13
  v_pk_max_u16 v66, v66, v14
  v_pk_max_u16 v66, v66, v15
  v_pk_max_u16 v66, v66, v16
  v_pk_max_u16 v66, v66, v17
  v_pk_max_u16 v66, v66, v18
  v_pk_max_u16 v66, v66, v19
  v_pk_max_u16 v66, v66, v20
  v_pk_max_u16 v66, v66, v21
  v_pk_max_u16 v66, v66, v22
  v_pk_max_u16 v66, v66, v23
  v_pk_max_u16 v66, v66, v24
  v_pk_max_u16 v66, v66, v25
  v_pk_max_u16 v66, v66, v26
  v_pk_max_u16 v66, v66, v27
  v_pk_max_u16 v66, v66, v28
  v_pk_max_u16 v66, v66, v29
  v_pk_max_u16 v66, v66, v30
  v_pk_max_u16 v66, v66, v31
  v_pk_max_u16 v66, v66, v32
  v_pk_max_u16 v66, v66, v33
  v_pk_max_u16 v66, v66, v34
  v_pk_max_u16 v66, v66, v35
  v_lshlrev_b32 v67, 16, v66
  v_max_u32 v66, v66, v67
  v_cmp_le_u32 vcc, 0xffff0000, v66
  s_cbranch_vccz cA_sc0_rk
  s_add_u32 s30, s30, 1
  s_cmp_lt_u32 s30, 400000
  s_cbranch_scc1 cA_sc0_rv
  s_branch cA_abort
cA_sc0_rk:
  s_mov_b32 s62, 1
  v_mov_b32 v36, 0
  v_mov_b32 v37, 0
  v_mov_b32 v38, 0
  v_mov_b32 v39, 0
  v_mov_b32 v40, 0
  v_mov_b32 v41, 0
  v_mov_b32 v42, 0
  v_mov_b32 v43, 0
  v_mov_b32 v44, 0
  v_mov_b32 v45, 0
  v_mov_b32 v46, 0
  v_mov_b32 v47, 0
  v_mov_b32 v48, 0
  v_mov_b32 v49, 0
  v_mov_b32 v50, 0
  v_mov_b32 v51, 0
  v_mov_b32 v60, 0
  v_mov_b32 v61, 0
  v_mov_b32 v62, 0
  v_mov_b32 v63, 0
  v_mov_b32 v68, 0
  v_mov_b32 v69, 0
  v_mov_b32 v70, 0
  v_mov_b32 v71, 0
  v_mov_b32 v72, 0
  v_mov_b32 v73, 0
  v_mov_b32 v74, 0
  v_mov_b32 v75, 0
  v_mov_b32 v52, 0
  v_mov_b32 v53, 0
  v_mov_b32 v54, 0
  v_mov_b32 v55, 0
  v_mov_b32 v56, 0
  v_mov_b32 v57, 0
  v_mov_b32 v58, 0
  v_mov_b32 v59, 0
  s_add_u32 s31, s31, 0x100
  s_nop 0
  s_branch cA_sc0_go
.p2align 6
cA_sc1_loop:
  s_mov_b32 s30, 0
  s_mov_b32 s62, 0
  s_setprio 3
  s_barrier
  buffer_load_dwordx4 v[8:11], v2, s[8:11], s20 offen offset:0 sc1
  s_setprio 2
  buffer_load_dwordx4 v[12:15], v2, s[8:11], s20 offen offset:1024 sc1
  s_setprio 1
  buffer_load_dwordx4 v[16:19], v2, s[8:11], s20 offen offset:2048 sc1
  s_setprio 0
  buffer_load_dwordx4 v[20:23], v2, s[8:11], s20 offen offset:3072 sc1
cA_sc1_go:
  s_waitcnt vmcnt(3)
  v_smfmac_f32_16x16x64_bf16 v[36:39], v[8:11], a[0:7], v3
  buffer_load_dwordx4 v[28:31], v2, s[8:11], s23 offen offset:0 sc1
  v_cmp_eq_u32 vcc, -1, v8
  v_smfmac_f32_16x16x64_bf16 v[40:43], v[8:11], a[56:63], v3
  v_smfmac_f32_16x16x64_bf16 v[44:47], v[8:11], a[112:119], v3
  buffer_load_dwordx4 v[24:27], v2, s[8:11], s23 offen offset:1024 sc1
  s_cbranch_vccnz cA_sc1_r0
  v_smfmac_f32_16x16x64_bf16 v[48:51], v[8:11], a[168:175], v3
  v_smfmac_f32_16x16x64_bf16 v[52:55], v[8:11], a[224:231], v3
  s_waitcnt vmcnt(4)
  v_cmp_eq_u32 vcc, -1, v12
  v_smfmac_f32_16x16x64_bf16 v[56:59], v[8:11], v[144:151], v3
  buffer_load_dwordx4 v[32:35], v2, s[8:11], s23 offen offset:2048 sc1
  v_smfmac_f32_16x16x64_bf16 v[60:63], v[8:11], v[200:207], v3
  s_cbranch_vccnz cA_sc1_r1
cA_sc1_c1:
  v_smfmac_f32_16x16x64_bf16 v[36:39], v[12:15], a[8:15], v3
  v_smfmac_f32_16x16x64_bf16 v[40:43], v[12:15], a[64:71], v3
  v_smfmac_f32_16x16x64_bf16 v[44:47], v[12:15], a[120:127], v3
  v_smfmac_f32_16x16x64_bf16 v[48:51], v[12:15], a[176:183], v3
  v_smfmac_f32_16x16x64_bf16 v[52:55], v[12:15], a[232:239], v3
  s_waitcnt vmcnt(4)
  v_cmp_eq_u32 vcc, -1, v16
  v_smfmac_f32_16x16x64_bf16 v[56:59], v[12:15], v[152:159], v3
  buffer_load_dwordx4 v[88:91], v117, s[8:11], s26 offen offset:0
  v_smfmac_f32_16x16x64_bf16 v[60:63], v[12:15], v[208:215], v3
  s_cbranch_vccnz cA_sc1_r2
cA_sc1_c2:
  v_smfmac_f32_16x16x64_bf16 v[36:39], v[16:19], a[16:23], v3
  v_smfmac_f32_16x16x64_bf16 v[40:43], v[16:19], a[72:79], v3
  v_smfmac_f32_16x16x64_bf16 v[44:47], v[16:19], a[128:135], v3
  buffer_load_dwordx4 v[92:95], v117, s[8:11], s26 offen offset:1024
  v_smfmac_f32_16x16x64_bf16 v[48:51], v[16:19], a[184:191], v3
  v_smfmac_f32_16x16x64_bf16 v[52:55], v[16:19], a[240:247], v3
  s_waitcnt vmcnt(5)
  v_cmp_eq_u32 vcc, -1, v20
  v_smfmac_f32_16x16x64_bf16 v[56:59], v[16:19], v[160:167], v3
  v_smfmac_f32_16x16x64_bf16 v[60:63], v[16:19], v[216:223], v3
  buffer_load_dwordx4 v[96:99], v2, s[8:11], s24 offen offset:0
  s_cbranch_vccnz cA_sc1_r3
cA_sc1_c3:
  v_smfmac_f32_16x16x64_bf16 v[36:39], v[20:23], a[24:31], v3
  v_smfmac_f32_16x16x64_bf16 v[40:43], v[20:23], a[80:87], v3
  s_waitcnt vmcnt(3)
  v_max3_u32 v66, v24, v27, v28
  v_smfmac_f32_16x16x64_bf16 v[44:47], v[20:23], a[136:143], v3
  v_max3_u32 v66, v66, v31, v32
  v_smfmac_f32_16x16x64_bf16 v[48:51], v[20:23], a[192:199], v3
  buffer_load_dwordx4 v[100:103], v2, s[8:11], s24 offen offset:1024
  v_max_u32 v66, v66, v35
  v_smfmac_f32_16x16x64_bf16 v[52:55], v[20:23], a[248:255], v3
  v_cmp_eq_u32 vcc, -1, v66
  v_smfmac_f32_16x16x64_bf16 v[56:59], v[20:23], v[168:175], v3
  v_smfmac_f32_16x16x64_bf16 v[60:63], v[20:23], v[224:231], v3
  s_cbranch_vccnz cA_sc1_r4
cA_sc1_c4:
  v_smfmac_f32_16x16x64_bf16 v[60:63], v[28:31], v[232:239], v3
  buffer_load_dwordx4 v[104:107], v2, s[8:11], s26 offen offset:0
  v_smfmac_f32_16x16x64_bf16 v[60:63], v[24:27], v[240:247], v3
  v_smfmac_f32_16x16x64_bf16 v[60:63], v[32:35], v[248:255], v3
  v_smfmac_f32_16x16x64_bf16 v[52:55], v[28:31], v[120:127], v3
  v_smfmac_f32_16x16x64_bf16 v[52:55], v[24:27], v[128:135], v3
  buffer_load_dwordx4 v[108:111], v2, s[8:11], s26 offen offset:1024
  v_smfmac_f32_16x16x64_bf16 v[52:55], v[32:35], v[136:143], v3
  v_cvt_pk_bf16_f32 v63, v62, v63
  v_smfmac_f32_16x16x64_bf16 v[56:59], v[28:31], v[176:183], v3
  v_cvt_pk_bf16_f32 v62, v60, v61
  v_smfmac_f32_16x16x64_bf16 v[56:59], v[24:27], v[184:191], v3
  v_mfma_f32_16x16x32_bf16 v[8:11], v[62:65], v[4:7], 0
  v_cvt_pk_bf16_f32 v55, v54, v55
  v_smfmac_f32_16x16x64_bf16 v[56:59], v[32:35], v[192:199], v3
  v_cvt_pk_bf16_f32 v54, v52, v53
  v_smfmac_f32_16x16x64_bf16 v[36:39], v[28:31], a[32:39], v3
  s_nop 1
  v_cvt_pk_bf16_f32 v78, v8, v9
  v_smfmac_f32_16x16x64_bf16 v[36:39], v[24:27], a[40:47], v3
  v_cvt_pk_bf16_f32 v79, v10, v11
  v_smfmac_f32_16x16x64_bf16 v[36:39], v[32:35], a[48:55], v3
  v_cvt_pk_bf16_f32 v56, v56, v57
  v_smfmac_f32_16x16x64_bf16 v[40:43], v[28:31], a[88:95], v3
  v_cvt_pk_bf16_f32 v57, v58, v59
  v_smfmac_f32_16x16x64_bf16 v[40:43], v[24:27], a[96:103], v3
  v_mfma_f32_16x16x32_bf16 v[16:19], v[54:57], v[4:7], 0
  v_cvt_pk_bf16_f32 v39, v38, v39
  v_smfmac_f32_16x16x64_bf16 v[40:43], v[32:35], a[104:111], v3
  v_cvt_pk_bf16_f32 v38, v36, v37
  v_smfmac_f32_16x16x64_bf16 v[44:47], v[28:31], a[144:151], v3
  s_nop 1
  v_cvt_pk_bf16_f32 v76, v16, v17
  v_smfmac_f32_16x16x64_bf16 v[44:47], v[24:27], a[152:159], v3
  v_cvt_pk_bf16_f32 v77, v18, v19
  v_smfmac_f32_16x16x64_bf16 v[44:47], v[32:35], a[160:167], v3
  v_cvt_pk_bf16_f32 v40, v40, v41
  v_smfmac_f32_16x16x64_bf16 v[48:51], v[28:31], a[200:207], v3
  v_cvt_pk_bf16_f32 v41, v42, v43
  v_smfmac_f32_16x16x64_bf16 v[48:51], v[24:27], a[208:215], v3
  v_smfmac_f32_16x16x64_bf16 v[48:51], v[32:35], a[216:223], v3
  s_waitcnt vmcnt(4)
  v_cvt_pk_bf16_f32 v47, v46, v47
  v_smfmac_f32_16x16x64_bf16 v[68:71], v[76:79], v[80:87], v3
  v_cvt_pk_bf16_f32 v46, v44, v45
  v_mfma_f32_16x16x32_bf16 v[8:11], v[38:41], v[4:7], 0
  s_nop 1
  v_cvt_pk_bf16_f32 v48, v48, v49
  v_cvt_pk_bf16_f32 v49, v50, v51
  s_nop 1
  v_mfma_f32_16x16x32_bf16 v[16:19], v[46:49], v[4:7], 0
  v_smfmac_f32_16x16x64_bf16 v[72:75], v[76:79], v[88:95], v3
  v_cvt_pk_bf16_f32 v20, v8, v9
  v_mfma_f32_16x16x32_bf16 v[52:55], v[30:33], v[76:79], 0
  s_waitcnt vmcnt(0)
  v_cvt_pk_bf16_f32 v21, v10, v11
  v_cvt_pk_bf16_f32 v22, v16, v17
  v_cvt_pk_bf16_f32 v23, v18, v19
  s_nop 1
  v_smfmac_f32_16x16x64_bf16 v[68:71], v[20:23], v[96:103], v3
  v_mfma_f32_16x16x32_bf16 v[52:55], v[12:15], v[20:23], v[52:55]
  v_smfmac_f32_16x16x64_bf16 v[72:75], v[20:23], v[104:111], v3
  s_nop 1
  v_permlane32_swap_b32 v68, v70
  v_permlane32_swap_b32 v69, v71
  v_add_f32 v56, v68, v70
  v_add_f32 v58, v69, v71
  ds_write_b128 v113, v[52:55]
  s_nop 0
  v_permlane32_swap_b32 v72, v74
  v_permlane32_swap_b32 v73, v75
  v_add_f32 v57, v72, v74
  v_add_f32 v59, v73, v75
  ds_write_b128 v2, v[56:59] offset:1024
  v_cmp_u_f32 vcc, v57, v59
  v_mov_b32 v36, 0
  v_mov_b32 v37, 0
  v_mov_b32 v38, 0
  v_mov_b32 v39, 0
  s_cbranch_vccnz cA_sc1_retry
cA_sc1_cont:
  s_add_u32 s24, s24, 28672
  s_add_u32 s26, s26, 28672
  buffer_load_dwordx4 v[80:83], v117, s[8:11], s24 offen offset:0
  buffer_load_dwordx4 v[84:87], v117, s[8:11], s24 offen offset:1024
  v_mov_b32 v40, 0
  v_mov_b32 v41, 0
  v_mov_b32 v42, 0
  v_mov_b32 v43, 0
  v_mov_b32 v44, 0
  v_mov_b32 v45, 0
  v_mov_b32 v46, 0
  v_mov_b32 v47, 0
  v_mov_b32 v48, 0
  v_mov_b32 v49, 0
  v_mov_b32 v50, 0
  v_mov_b32 v51, 0
  s_waitcnt lgkmcnt(0)
  s_barrier
  ds_read_b64 v[8:9], v114 offset:0
  ds_read_b64 v[10:11], v114 offset:1024
  ds_read_b64 v[12:13], v114 offset:2048
  ds_read_b64 v[14:15], v114 offset:3072
  ds_read2_b32 v[16:17], v115 offset0:0 offset1:64
  ds_read2_b32 v[18:19], v115 offset0:128 offset1:192
  s_waitcnt lgkmcnt(0)
  v_pk_add_f32 v[16:17], v[16:17], v[18:19]
  v_pk_add_f32 v[8:9], v[8:9], v[10:11]
  v_pk_add_f32 v[12:13], v[12:13], v[14:15]
  v_add_f32 v20, v16, v17
  v_pk_add_f32 v[8:9], v[8:9], v[12:13]
  v_max_f32 v22, v8, v9
  v_add_f32_dpp v20, v20, v20 row_ror:8 row_mask:0xf bank_mask:0xf
  s_nop 0
  v_max_f32_dpp v22, v22, v22 row_ror:8 row_mask:0xf bank_mask:0xf
  v_max_f32 v22, v22, v20
  s_nop 1
  v_max_f32_dpp v22, v22, v22 quad_perm:[1,0,3,2] row_mask:0xf bank_mask:0xf
  s_nop 1
  v_max_f32_dpp v22, v22, v22 quad_perm:[2,3,0,1] row_mask:0xf bank_mask:0xf
  s_nop 1
  v_max_f32_dpp v22, v22, v22 row_half_mirror row_mask:0xf bank_mask:0xf
  v_pk_add_f32 v[8:9], v[8:9], v[22:23] op_sel_hi:[1,0] neg_lo:[0,1] neg_hi:[0,1]
  v_sub_f32 v20, v20, v22
  v_exp_f32 v8, v8
  v_exp_f32 v9, v9
  v_exp_f32 v20, v20
  v_add_f32 v24, v8, v9
  v_fmac_f32 v24, 0.5, v20
  v_mov_b32_dpp v21, v20 quad_perm:[1,0,3,2] row_mask:0xf bank_mask:0xf
  s_nop 0
  v_add_f32_dpp v24, v24, v24 quad_perm:[1,0,3,2] row_mask:0xf bank_mask:0xf
  s_nop 1
  v_add_f32_dpp v24, v24, v24 quad_perm:[2,3,0,1] row_mask:0xf bank_mask:0xf
  s_nop 1
  v_add_f32_dpp v24, v24, v24 row_half_mirror row_mask:0xf bank_mask:0xf
  s_nop 1
  v_add_f32_dpp v24, v24, v24 row_ror:8 row_mask:0xf bank_mask:0xf
  v_rcp_f32 v24, v24
  s_nop 0
  v_pk_mul_f32 v[8:9], v[8:9], v[24:25] op_sel_hi:[1,0]
  v_pk_mul_f32 v[20:21], v[20:21], v[24:25] op_sel_hi:[1,0]
  v_cvt_pk_bf16_f32 v8, v8, v9
  v_cvt_pk_bf16_f32 v20, v20, v21
  v_min_u32 v8, -2, v8
  buffer_store_dword v8, v1, s[8:11], s20 offen
  v_min_u32 v20, -2, v20
  buffer_store_dword v20, v118, s[8:11], s20 offen
  buffer_store_dword v119, v1, s[8:11], s21 offen
  buffer_store_dword v119, v118, s[8:11], s21 offen
  v_mov_b32 v60, 0
  v_mov_b32 v61, 0
  v_mov_b32 v62, 0
  v_mov_b32 v63, 0
  v_mov_b32 v68, 0
  v_mov_b32 v69, 0
  v_mov_b32 v70, 0
  v_mov_b32 v71, 0
  v_mov_b32 v72, 0
  v_mov_b32 v73, 0
  v_mov_b32 v74, 0
  v_mov_b32 v75, 0
  v_mov_b32 v52, 0
  v_mov_b32 v53, 0
  v_mov_b32 v54, 0
  v_mov_b32 v55, 0
  v_mov_b32 v56, 0
  v_mov_b32 v57, 0
  v_mov_b32 v58, 0
  v_mov_b32 v59, 0
  s_mov_b32 s19, s18
  s_add_u32 s18, s18, 1
  s_mov_b32 s22, s20
  s_mov_b32 s20, s21
  s_mov_b32 s21, s22
  s_add_u32 s23, s20, 4096
  s_cmp_lt_u32 s19, 63
  s_cbranch_scc1 cA_sc1_loop
  s_branch cA_done
cA_sc1_r0:
  s_add_u32 s31, s31, 1
  buffer_load_dwordx4 v[8:11], v2, s[8:11], s20 offen offset:0 sc1
  s_waitcnt vmcnt(0)
  v_cmp_eq_u32 vcc, -1, v8
  v_mov_b32 v36, 0
  v_mov_b32 v37, 0
  v_mov_b32 v38, 0
  v_mov_b32 v39, 0
  v_mov_b32 v40, 0
  v_mov_b32 v41, 0
  v_mov_b32 v42, 0
  v_mov_b32 v43, 0
  v_mov_b32 v44, 0
  v_mov_b32 v45, 0
  v_mov_b32 v46, 0
  v_mov_b32 v47, 0
  v_mov_b32 v48, 0
  v_mov_b32 v49, 0
  v_mov_b32 v50, 0
  v_mov_b32 v51, 0
  s_nop 1
  s_cbranch_vccz cA_sc1_go
  s_add_u32 s30, s30, 1
  s_cmp_lt_u32 s30, 400000
  s_cbranch_scc1 cA_sc1_r0
  s_branch cA_abort
cA_sc1_r1:
  s_add_u32 s31, s31, 1
  buffer_load_dwordx4 v[12:15], v2, s[8:11], s20 offen offset:1024 sc1
  s_waitcnt vmcnt(0)
  v_cmp_eq_u32 vcc, -1, v12
  s_nop 4
  s_cbranch_vccz cA_sc1_c1
  s_add_u32 s30, s30, 1
  s_cmp_lt_u32 s30, 400000
  s_cbranch_scc1 cA_sc1_r1
  s_branch cA_abort
cA_sc1_r2:
  s_add_u32 s31, s31, 1
  buffer_load_dwordx4 v[16:19], v2, s[8:11], s20 offen offset:2048 sc1
  s_waitcnt vmcnt(0)
  v_cmp_eq_u32 vcc, -1, v16
  s_nop 4
  s_cbranch_vccz cA_sc1_c2
  s_add_u32 s30, s30, 1
  s_cmp_lt_u32 s30, 400000
  s_cbranch_scc1 cA_sc1_r2
  s_branch cA_abort
cA_sc1_r3:
  s_add_u32 s31, s31, 1
  buffer_load_dwordx4 v[20:23], v2, s[8:11], s20 offen offset:3072 sc1
  s_waitcnt vmcnt(0)
  v_cmp_eq_u32 vcc, -1, v20
  s_nop 4
  s_cbranch_vccz cA_sc1_c3
  s_add_u32 s30, s30, 1
  s_cmp_lt_u32 s30, 400000
  s_cbranch_scc1 cA_sc1_r3
  s_branch cA_abort
cA_sc1_r4:
  s_add_u32 s31, s31, 1
  buffer_load_dwordx4 v[28:31], v2, s[8:11], s23 offen offset:0 sc1
  buffer_load_dwordx4 v[24:27], v2, s[8:11], s23 offen offset:1024 sc1
  buffer_load_dwordx4 v[32:35], v2, s[8:11], s23 offen offset:2048 sc1
  s_waitcnt vmcnt(0)
  v_max3_u32 v66, v24, v27, v28
  v_max3_u32 v66, v66, v31, v32
  v_max_u32 v66, v66, v35
  v_cmp_eq_u32 vcc, -1, v66
  s_nop 4
  s_cbranch_vccz cA_sc1_c4
  s_add_u32 s30, s30, 1
  s_cmp_lt_u32 s30, 400000
  s_cbranch_scc1 cA_sc1_r4
  s_branch cA_abort
cA_sc1_retry:
  s_cmp_lg_u32 s62, 0
  s_cbranch_scc1 cA_sc1_cont
  s_waitcnt vmcnt(0) lgkmcnt(0)
cA_sc1_rv:
  buffer_load_dwordx4 v[8:11], v2, s[8:11], s20 offen offset:0 sc1
  buffer_load_dwordx4 v[12:15], v2, s[8:11], s20 offen offset:1024 sc1
  buffer_load_dwordx4 v[16:19], v2, s[8:11], s20 offen offset:2048 sc1
  buffer_load_dwordx4 v[20:23], v2, s[8:11], s20 offen offset:3072 sc1
  buffer_load_dwordx4 v[28:31], v2, s[8:11], s23 offen offset:0 sc1
  buffer_load_dwordx4 v[24:27], v2, s[8:11], s23 offen offset:1024 sc1
  buffer_load_dwordx4 v[32:35], v2, s[8:11], s23 offen offset:2048 sc1
  s_waitcnt vmcnt(0)
  v_pk_max_u16 v66, v8, v9
  v_pk_max_u16 v66, v66, v10
  v_pk_max_u16 v66, v66, v11
  v_pk_max_u16 v66, v66, v12
  v_pk_max_u16 v66, v66, v13
  v_pk_max_u16 v66, v66, v14
  v_pk_max_u16 v66, v66, v15
  v_pk_max_u16 v66, v66, v16
  v_pk_max_u16 v66, v66, v17
  v_pk_max_u16 v66, v66, v18
  v_pk_max_u16 v66, v66, v19
  v_pk_max_u16 v66, v66, v20
  v_pk_max_u16 v66, v66, v21
  v_pk_max_u16 v66, v66, v22
  v_pk_max_u16 v66, v66, v23
  v_pk_max_u16 v66, v66, v24
  v_pk_max_u16 v66, v66, v25
  v_pk_max_u16 v66, v66, v26
  v_pk_max_u16 v66, v66, v27
  v_pk_max_u16 v66, v66, v28
  v_pk_max_u16 v66, v66, v29
  v_pk_max_u16 v66, v66, v30
  v_pk_max_u16 v66, v66, v31
  v_pk_max_u16 v66, v66, v32
  v_pk_max_u16 v66, v66, v33
  v_pk_max_u16 v66, v66, v34
  v_pk_max_u16 v66, v66, v35
  v_lshlrev_b32 v67, 16, v66
  v_max_u32 v66, v66, v67
  v_cmp_le_u32 vcc, 0xffff0000, v66
  s_cbranch_vccz cA_sc1_rk
  s_add_u32 s30, s30, 1
  s_cmp_lt_u32 s30, 400000
  s_cbranch_scc1 cA_sc1_rv
  s_branch cA_abort
cA_sc1_rk:
  s_mov_b32 s62, 1
  v_mov_b32 v36, 0
  v_mov_b32 v37, 0
  v_mov_b32 v38, 0
  v_mov_b32 v39, 0
  v_mov_b32 v40, 0
  v_mov_b32 v41, 0
  v_mov_b32 v42, 0
  v_mov_b32 v43, 0
  v_mov_b32 v44, 0
  v_mov_b32 v45, 0
  v_mov_b32 v46, 0
  v_mov_b32 v47, 0
  v_mov_b32 v48, 0
  v_mov_b32 v49, 0
  v_mov_b32 v50, 0
  v_mov_b32 v51, 0
  v_mov_b32 v60, 0
  v_mov_b32 v61, 0
  v_mov_b32 v62, 0
  v_mov_b32 v63, 0
  v_mov_b32 v68, 0
  v_mov_b32 v69, 0
  v_mov_b32 v70, 0
  v_mov_b32 v71, 0
  v_mov_b32 v72, 0
  v_mov_b32 v73, 0
  v_mov_b32 v74, 0
  v_mov_b32 v75, 0
  v_mov_b32 v52, 0
  v_mov_b32 v53, 0
  v_mov_b32 v54, 0
  v_mov_b32 v55, 0
  v_mov_b32 v56, 0
  v_mov_b32 v57, 0
  v_mov_b32 v58, 0
  v_mov_b32 v59, 0
  s_add_u32 s31, s31, 0x100
  s_nop 0
  s_branch cA_sc1_go
.p2align 6
cA_sc2_loop:
  s_mov_b32 s30, 0
  s_mov_b32 s62, 0
  s_setprio 3
  s_barrier
  buffer_load_dwordx4 v[8:11], v2, s[8:11], s20 offen offset:0 sc1
  s_setprio 2
  buffer_load_dwordx4 v[12:15], v2, s[8:11], s20 offen offset:1024 sc1
  s_setprio 1
  buffer_load_dwordx4 v[16:19], v2, s[8:11], s20 offen offset:2048 sc1
  s_setprio 0
  buffer_load_dwordx4 v[20:23], v2, s[8:11], s20 offen offset:3072 sc1
cA_sc2_go:
  s_waitcnt vmcnt(3)
  v_smfmac_f32_16x16x64_bf16 v[36:39], v[8:11], a[0:7], v3
  buffer_load_dwordx4 v[24:27], v2, s[8:11], s23 offen offset:0 sc1
  v_cmp_eq_u32 vcc, -1, v8
  v_smfmac_f32_16x16x64_bf16 v[40:43], v[8:11], a[56:63], v3
  v_smfmac_f32_16x16x64_bf16 v[44:47], v[8:11], a[112:119], v3
  buffer_load_dwordx4 v[32:35], v2, s[8:11], s23 offen offset:1024 sc1
  s_cbranch_vccnz cA_sc2_r0
  v_smfmac_f32_16x16x64_bf16 v[48:51], v[8:11], a[168:175], v3
  v_smfmac_f32_16x16x64_bf16 v[52:55], v[8:11], a[224:231], v3
  s_waitcnt vmcnt(4)
  v_cmp_eq_u32 vcc, -1, v12
  v_smfmac_f32_16x16x64_bf16 v[56:59], v[8:11], v[144:151], v3
  buffer_load_dwordx4 v[28:31], v2, s[8:11], s23 offen offset:2048 sc1
  v_smfmac_f32_16x16x64_bf16 v[62:65], v[8:11], v[200:207], v3
  s_cbranch_vccnz cA_sc2_r1
cA_sc2_c1:
  v_smfmac_f32_16x16x64_bf16 v[36:39], v[12:15], a[8:15], v3
  v_smfmac_f32_16x16x64_bf16 v[40:43], v[12:15], a[64:71], v3
  v_smfmac_f32_16x16x64_bf16 v[44:47], v[12:15], a[120:127], v3
  v_smfmac_f32_16x16x64_bf16 v[48:51], v[12:15], a[176:183], v3
  v_smfmac_f32_16x16x64_bf16 v[52:55], v[12:15], a[232:239], v3
  s_waitcnt vmcnt(4)
  v_cmp_eq_u32 vcc, -1, v16
  v_smfmac_f32_16x16x64_bf16 v[56:59], v[12:15], v[152:159], v3
  buffer_load_dwordx4 v[88:91], v117, s[8:11], s26 offen offset:0
  v_smfmac_f32_16x16x64_bf16 v[62:65], v[12:15], v[208:215], v3
  s_cbranch_vccnz cA_sc2_r2
cA_sc2_c2:
  v_smfmac_f32_16x16x64_bf16 v[36:39], v[16:19], a[16:23], v3
  v_smfmac_f32_16x16x64_bf16 v[40:43], v[16:19], a[72:79], v3
  v_smfmac_f32_16x16x64_bf16 v[44:47], v[16:19], a[128:135], v3
  buffer_load_dwordx4 v[92:95], v117, s[8:11], s26 offen offset:1024
  v_smfmac_f32_16x16x64_bf16 v[48:51], v[16:19], a[184:191], v3
  v_smfmac_f32_16x16x64_bf16 v[52:55], v[16:19], a[240:247], v3
  s_waitcnt vmcnt(5)
  v_cmp_eq_u32 vcc, -1, v20
  v_smfmac_f32_16x16x64_bf16 v[56:59], v[16:19], v[160:167], v3
  v_smfmac_f32_16x16x64_bf16 v[62:65], v[16:19], v[216:223], v3
  buffer_load_dwordx4 v[96:99], v2, s[8:11], s24 offen offset:0
  s_cbranch_vccnz cA_sc2_r3
cA_sc2_c3:
  v_smfmac_f32_16x16x64_bf16 v[36:39], v[20:23], a[24:31], v3
  v_smfmac_f32_16x16x64_bf16 v[40:43], v[20:23], a[80:87], v3
  s_waitcnt vmcnt(3)
  v_max3_u32 v66, v24, v27, v28
  v_smfmac_f32_16x16x64_bf16 v[44:47], v[20:23], a[136:143], v3
  v_max3_u32 v66, v66, v31, v32
  v_smfmac_f32_16x16x64_bf16 v[48:51], v[20:23], a[192:199], v3
  buffer_load_dwordx4 v[100:103], v2, s[8:11], s24 offen offset:1024
  v_max_u32 v66, v66, v35
  v_smfmac_f32_16x16x64_bf16 v[52:55], v[20:23], a[248:255], v3
  v_cmp_eq_u32 vcc, -1, v66
  v_smfmac_f32_16x16x64_bf16 v[56:59], v[20:23], v[168:175], v3
  v_smfmac_f32_16x16x64_bf16 v[62:65], v[20:23], v[224:231], v3
  s_cbranch_vccnz cA_sc2_r4
cA_sc2_c4:
  v_smfmac_f32_16x16x64_bf16 v[62:65], v[24:27], v[232:239], v3
  buffer_load_dwordx4 v[104:107], v2, s[8:11], s26 offen offset:0
  v_smfmac_f32_16x16x64_bf16 v[62:65], v[32:35], v[240:247], v3
  v_smfmac_f32_16x16x64_bf16 v[62:65], v[28:31], v[248:255], v3
  v_smfmac_f32_16x16x64_bf16 v[52:55], v[24:27], v[120:127], v3
  v_smfmac_f32_16x16x64_bf16 v[52:55], v[32:35], v[128:135], v3
  buffer_load_dwordx4 v[108:111], v2, s[8:11], s26 offen offset:1024
  v_smfmac_f32_16x16x64_bf16 v[52:55], v[28:31], v[136:143], v3
  v_cvt_pk_bf16_f32 v62, v62, v63
  v_smfmac_f32_16x16x64_bf16 v[56:59], v[24:27], v[176:183], v3
  v_cvt_pk_bf16_f32 v63, v64, v65
  v_smfmac_f32_16x16x64_bf16 v[56:59], v[32:35], v[184:191], v3
  v_mfma_f32_16x16x32_bf16 v[8:11], v[60:63], v[4:7], 0
  v_cvt_pk_bf16_f32 v55, v54, v55
  v_smfmac_f32_16x16x64_bf16 v[56:59], v[28:31], v[192:199], v3
  v_cvt_pk_bf16_f32 v54, v52, v53
  v_smfmac_f32_16x16x64_bf16 v[36:39], v[24:27], a[32:39], v3
  s_nop 1
  v_cvt_pk_bf16_f32 v76, v8, v9
  v_smfmac_f32_16x16x64_bf16 v[36:39], v[32:35], a[40:47], v3
  v_cvt_pk_bf16_f32 v77, v10, v11
  v_smfmac_f32_16x16x64_bf16 v[36:39], v[28:31], a[48:55], v3
  v_cvt_pk_bf16_f32 v56, v56, v57
  v_smfmac_f32_16x16x64_bf16 v[40:43], v[24:27], a[88:95], v3
  v_cvt_pk_bf16_f32 v57, v58, v59
  v_smfmac_f32_16x16x64_bf16 v[40:43], v[32:35], a[96:103], v3
  v_mfma_f32_16x16x32_bf16 v[12:15], v[54:57], v[4:7], 0
  v_cvt_pk_bf16_f32 v39, v38, v39
  v_smfmac_f32_16x16x64_bf16 v[40:43], v[28:31], a[104:111], v3
  v_cvt_pk_bf16_f32 v38, v36, v37
  v_smfmac_f32_16x16x64_bf16 v[44:47], v[24:27], a[144:151], v3
  s_nop 1
  v_cvt_pk_bf16_f32 v78, v12, v13
  v_smfmac_f32_16x16x64_bf16 v[44:47], v[32:35], a[152:159], v3
  v_cvt_pk_bf16_f32 v79, v14, v15
  v_smfmac_f32_16x16x64_bf16 v[44:47], v[28:31], a[160:167], v3
  v_cvt_pk_bf16_f32 v40, v40, v41
  v_smfmac_f32_16x16x64_bf16 v[48:51], v[24:27], a[200:207], v3
  v_cvt_pk_bf16_f32 v41, v42, v43
  v_smfmac_f32_16x16x64_bf16 v[48:51], v[32:35], a[208:215], v3
  v_smfmac_f32_16x16x64_bf16 v[48:51], v[28:31], a[216:223], v3
  s_waitcnt vmcnt(4)
  v_cvt_pk_bf16_f32 v47, v46, v47
  v_smfmac_f32_16x16x64_bf16 v[68:71], v[76:79], v[80:87], v3
  v_cvt_pk_bf16_f32 v46, v44, v45
  v_mfma_f32_16x16x32_bf16 v[8:11], v[38:41], v[4:7], 0
  s_nop 1
  v_cvt_pk_bf16_f32 v48, v48, v49
  v_cvt_pk_bf16_f32 v49, v50, v51
  s_nop 1
  v_mfma_f32_16x16x32_bf16 v[12:15], v[46:49], v[4:7], 0
  v_smfmac_f32_16x16x64_bf16 v[72:75], v[76:79], v[88:95], v3
  v_cvt_pk_bf16_f32 v20, v8, v9
  v_mfma_f32_16x16x32_bf16 v[52:55], v[30:33], v[76:79], 0
  s_waitcnt vmcnt(0)
  v_cvt_pk_bf16_f32 v21, v10, v11
  v_cvt_pk_bf16_f32 v22, v12, v13
  v_cvt_pk_bf16_f32 v23, v14, v15
  s_nop 1
  v_smfmac_f32_16x16x64_bf16 v[68:71], v[20:23], v[96:103], v3
  v_mfma_f32_16x16x32_bf16 v[52:55], v[16:19], v[20:23], v[52:55]
  v_smfmac_f32_16x16x64_bf16 v[72:75], v[20:23], v[104:111], v3
  s_nop 1
  v_permlane32_swap_b32 v68, v70
  v_permlane32_swap_b32 v69, v71
  v_add_f32 v56, v68, v70
  v_add_f32 v58, v69, v71
  ds_write_b128 v113, v[52:55]
  s_nop 0
  v_permlane32_swap_b32 v72, v74
  v_permlane32_swap_b32 v73, v75
  v_add_f32 v57, v72, v74
  v_add_f32 v59, v73, v75
  ds_write_b128 v2, v[56:59] offset:2048
  v_cmp_u_f32 vcc, v57, v59
  v_mov_b32 v36, 0
  v_mov_b32 v37, 0
  v_mov_b32 v38, 0
  v_mov_b32 v39, 0
  s_cbranch_vccnz cA_sc2_retry
cA_sc2_cont:
  s_add_u32 s24, s24, 28672
  s_add_u32 s26, s26, 28672
  buffer_load_dwordx4 v[80:83], v117, s[8:11], s24 offen offset:0
  buffer_load_dwordx4 v[84:87], v117, s[8:11], s24 offen offset:1024
  v_mov_b32 v40, 0
  v_mov_b32 v41, 0
  v_mov_b32 v42, 0
  v_mov_b32 v43, 0
  v_mov_b32 v44, 0
  v_mov_b32 v45, 0
  v_mov_b32 v46, 0
  v_mov_b32 v47, 0
  v_mov_b32 v48, 0
  v_mov_b32 v49, 0
  v_mov_b32 v50, 0
  v_mov_b32 v51, 0
  s_waitcnt lgkmcnt(0)
  s_barrier
  v_mov_b32 v62, 0
  v_mov_b32 v63, 0
  v_mov_b32 v64, 0
  v_mov_b32 v65, 0
  v_mov_b32 v68, 0
  v_mov_b32 v69, 0
  v_mov_b32 v70, 0
  v_mov_b32 v71, 0
  v_mov_b32 v72, 0
  v_mov_b32 v73, 0
  v_mov_b32 v74, 0
  v_mov_b32 v75, 0
  v_mov_b32 v52, 0
  v_mov_b32 v53, 0
  v_mov_b32 v54, 0
  v_mov_b32 v55, 0
  v_mov_b32 v56, 0
  v_mov_b32 v57, 0
  v_mov_b32 v58, 0
  v_mov_b32 v59, 0
  v_mov_b32 v66, 0
  v_mov_b32 v66, 0
  v_mov_b32 v66, 0
  v_mov_b32 v66, 0
  v_mov_b32 v66, 0
  v_mov_b32 v66, 0
  v_mov_b32 v66, 0
  v_mov_b32 v66, 0
  v_mov_b32 v66, 0
  v_mov_b32 v66, 0
  buffer_store_dword v119, v1, s[8:11], 0 offen
  s_mov_b32 s19, s18
  s_add_u32 s18, s18, 1
  s_mov_b32 s22, s20
  s_mov_b32 s20, s21
  s_mov_b32 s21, s22
  s_add_u32 s23, s20, 4096
  v_mov_b32 v119, s18
  s_cmp_lt_u32 s19, 63
  s_nop 0
  s_cbranch_scc1 cA_sc2_loop
  s_branch cA_done
cA_sc2_r0:
  s_add_u32 s31, s31, 1
  buffer_load_dwordx4 v[8:11], v2, s[8:11], s20 offen offset:0 sc1
  s_waitcnt vmcnt(0)
  v_cmp_eq_u32 vcc, -1, v8
  v_mov_b32 v36, 0
  v_mov_b32 v37, 0
  v_mov_b32 v38, 0
  v_mov_b32 v39, 0
  v_mov_b32 v40, 0
  v_mov_b32 v41, 0
  v_mov_b32 v42, 0
  v_mov_b32 v43, 0
  v_mov_b32 v44, 0
  v_mov_b32 v45, 0
  v_mov_b32 v46, 0
  v_mov_b32 v47, 0
  v_mov_b32 v48, 0
  v_mov_b32 v49, 0
  v_mov_b32 v50, 0
  v_mov_b32 v51, 0
  s_nop 1
  s_cbranch_vccz cA_sc2_go
  s_add_u32 s30, s30, 1
  s_cmp_lt_u32 s30, 400000
  s_cbranch_scc1 cA_sc2_r0
  s_branch cA_abort
cA_sc2_r1:
  s_add_u32 s31, s31, 1
  buffer_load_dwordx4 v[12:15], v2, s[8:11], s20 offen offset:1024 sc1
  s_waitcnt vmcnt(0)
  v_cmp_eq_u32 vcc, -1, v12
  s_nop 4
  s_cbranch_vccz cA_sc2_c1
  s_add_u32 s30, s30, 1
  s_cmp_lt_u32 s30, 400000
  s_cbranch_scc1 cA_sc2_r1
  s_branch cA_abort
cA_sc2_r2:
  s_add_u32 s31, s31, 1
  buffer_load_dwordx4 v[16:19], v2, s[8:11], s20 offen offset:2048 sc1
  s_waitcnt vmcnt(0)
  v_cmp_eq_u32 vcc, -1, v16
  s_nop 4
  s_cbranch_vccz cA_sc2_c2
  s_add_u32 s30, s30, 1
  s_cmp_lt_u32 s30, 400000
  s_cbranch_scc1 cA_sc2_r2
  s_branch cA_abort
cA_sc2_r3:
  s_add_u32 s31, s31, 1
  buffer_load_dwordx4 v[20:23], v2, s[8:11], s20 offen offset:3072 sc1
  s_waitcnt vmcnt(0)
  v_cmp_eq_u32 vcc, -1, v20
  s_nop 4
  s_cbranch_vccz cA_sc2_c3
  s_add_u32 s30, s30, 1
  s_cmp_lt_u32 s30, 400000
  s_cbranch_scc1 cA_sc2_r3
  s_branch cA_abort
cA_sc2_r4:
  s_add_u32 s31, s31, 1
  buffer_load_dwordx4 v[24:27], v2, s[8:11], s23 offen offset:0 sc1
  buffer_load_dwordx4 v[32:35], v2, s[8:11], s23 offen offset:1024 sc1
  buffer_load_dwordx4 v[28:31], v2, s[8:11], s23 offen offset:2048 sc1
  s_waitcnt vmcnt(0)
  v_max3_u32 v66, v24, v27, v28
  v_max3_u32 v66, v66, v31, v32
  v_max_u32 v66, v66, v35
  v_cmp_eq_u32 vcc, -1, v66
  s_nop 4
  s_cbranch_vccz cA_sc2_c4
  s_add_u32 s30, s30, 1
  s_cmp_lt_u32 s30, 400000
  s_cbranch_scc1 cA_sc2_r4
  s_branch cA_abort
cA_sc2_retry:
  s_cmp_lg_u32 s62, 0
  s_cbranch_scc1 cA_sc2_cont
  s_waitcnt vmcnt(0) lgkmcnt(0)
cA_sc2_rv:
  buffer_load_dwordx4 v[8:11], v2, s[8:11], s20 offen offset:0 sc1
  buffer_load_dwordx4 v[12:15], v2, s[8:11], s20 offen offset:1024 sc1
  buffer_load_dwordx4 v[16:19], v2, s[8:11], s20 offen offset:2048 sc1
  buffer_load_dwordx4 v[20:23], v2, s[8:11], s20 offen offset:3072 sc1
  buffer_load_dwordx4 v[24:27], v2, s[8:11], s23 offen offset:0 sc1
  buffer_load_dwordx4 v[32:35], v2, s[8:11], s23 offen offset:1024 sc1
  buffer_load_dwordx4 v[28:31], v2, s[8:11], s23 offen offset:2048 sc1
  s_waitcnt vmcnt(0)
  v_pk_max_u16 v66, v8, v9
  v_pk_max_u16 v66, v66, v10
  v_pk_max_u16 v66, v66, v11
  v_pk_max_u16 v66, v66, v12
  v_pk_max_u16 v66, v66, v13
  v_pk_max_u16 v66, v66, v14
  v_pk_max_u16 v66, v66, v15
  v_pk_max_u16 v66, v66, v16
  v_pk_max_u16 v66, v66, v17
  v_pk_max_u16 v66, v66, v18
  v_pk_max_u16 v66, v66, v19
  v_pk_max_u16 v66, v66, v20
  v_pk_max_u16 v66, v66, v21
  v_pk_max_u16 v66, v66, v22
  v_pk_max_u16 v66, v66, v23
  v_pk_max_u16 v66, v66, v24
  v_pk_max_u16 v66, v66, v25
  v_pk_max_u16 v66, v66, v26
  v_pk_max_u16 v66, v66, v27
  v_pk_max_u16 v66, v66, v28
  v_pk_max_u16 v66, v66, v29
  v_pk_max_u16 v66, v66, v30
  v_pk_max_u16 v66, v66, v31
  v_pk_max_u16 v66, v66, v32
  v_pk_max_u16 v66, v66, v33
  v_pk_max_u16 v66, v66, v34
  v_pk_max_u16 v66, v66, v35
  v_lshlrev_b32 v67, 16, v66
  v_max_u32 v66, v66, v67
  v_cmp_le_u32 vcc, 0xffff0000, v66
  s_cbranch_vccz cA_sc2_rk
  s_add_u32 s30, s30, 1
  s_cmp_lt_u32 s30, 400000
  s_cbranch_scc1 cA_sc2_rv
  s_branch cA_abort
cA_sc2_rk:
  s_mov_b32 s62, 1
  v_mov_b32 v36, 0
  v_mov_b32 v37, 0
  v_mov_b32 v38, 0
  v_mov_b32 v39, 0
  v_mov_b32 v40, 0
  v_mov_b32 v41, 0
  v_mov_b32 v42, 0
  v_mov_b32 v43, 0
  v_mov_b32 v44, 0
  v_mov_b32 v45, 0
  v_mov_b32 v46, 0
  v_mov_b32 v47, 0
  v_mov_b32 v48, 0
  v_mov_b32 v49, 0
  v_mov_b32 v50, 0
  v_mov_b32 v51, 0
  v_mov_b32 v62, 0
  v_mov_b32 v63, 0
  v_mov_b32 v64, 0
  v_mov_b32 v65, 0
  v_mov_b32 v68, 0
  v_mov_b32 v69, 0
  v_mov_b32 v70, 0
  v_mov_b32 v71, 0
  v_mov_b32 v72, 0
  v_mov_b32 v73, 0
  v_mov_b32 v74, 0
  v_mov_b32 v75, 0
  v_mov_b32 v52, 0
  v_mov_b32 v53, 0
  v_mov_b32 v54, 0
  v_mov_b32 v55, 0
  v_mov_b32 v56, 0
  v_mov_b32 v57, 0
  v_mov_b32 v58, 0
  v_mov_b32 v59, 0
  s_add_u32 s31, s31, 0x100
  s_nop 0
  s_branch cA_sc2_go
.p2align 6
cA_sc3_loop:
  s_mov_b32 s30, 0
  s_mov_b32 s62, 0
  s_setprio 3
  s_barrier
  buffer_load_dwordx4 v[8:11], v2, s[8:11], s20 offen offset:0 sc1
  s_setprio 2
  buffer_load_dwordx4 v[12:15], v2, s[8:11], s20 offen offset:1024 sc1
  s_setprio 1
  buffer_load_dwordx4 v[16:19], v2, s[8:11], s20 offen offset:2048 sc1
  s_setprio 0
  buffer_load_dwordx4 v[20:23], v2, s[8:11], s20 offen offset:3072 sc1
cA_sc3_go:
  s_waitcnt vmcnt(3)
  v_smfmac_f32_16x16x64_bf16 v[36:39], v[8:11], a[0:7], v3
  buffer_load_dwordx4 v[24:27], v2, s[8:11], s23 offen offset:0 sc1
  v_cmp_eq_u32 vcc, -1, v8
  v_smfmac_f32_16x16x64_bf16 v[40:43], v[8:11], a[56:63], v3
  v_smfmac_f32_16x16x64_bf16 v[44:47], v[8:11], a[112:119], v3
  buffer_load_dwordx4 v[28:31], v2, s[8:11], s23 offen offset:1024 sc1
  s_cbranch_vccnz cA_sc3_r0
  v_smfmac_f32_16x16x64_bf16 v[48:51], v[8:11], a[168:175], v3
  v_smfmac_f32_16x16x64_bf16 v[52:55], v[8:11], a[224:231], v3
  s_waitcnt vmcnt(4)
  v_cmp_eq_u32 vcc, -1, v12
  v_smfmac_f32_16x16x64_bf16 v[56:59], v[8:11], v[144:151], v3
  buffer_load_dwordx4 v[32:35], v2, s[8:11], s23 offen offset:2048 sc1
  v_smfmac_f32_16x16x64_bf16 v[62:65], v[8:11], v[200:207], v3
  s_cbranch_vccnz cA_sc3_r1
cA_sc3_c1:
  v_smfmac_f32_16x16x64_bf16 v[36:39], v[12:15], a[8:15], v3
  v_smfmac_f32_16x16x64_bf16 v[40:43], v[12:15], a[64:71], v3
  v_smfmac_f32_16x16x64_bf16 v[44:47], v[12:15], a[120:127], v3
  v_smfmac_f32_16x16x64_bf16 v[48:51], v[12:15], a[176:183], v3
  v_smfmac_f32_16x16x64_bf16 v[52:55], v[12:15], a[232:239], v3
  s_waitcnt vmcnt(4)
  v_cmp_eq_u32 vcc, -1, v16
  v_smfmac_f32_16x16x64_bf16 v[56:59], v[12:15], v[152:159], v3
  buffer_load_dwordx4 v[88:91], v117, s[8:11], s26 offen offset:0
  v_smfmac_f32_16x16x64_bf16 v[62:65], v[12:15], v[208:215], v3
  s_cbranch_vccnz cA_sc3_r2
cA_sc3_c2:
  v_smfmac_f32_16x16x64_bf16 v[36:39], v[16:19], a[16:23], v3
  v_smfmac_f32_16x16x64_bf16 v[40:43], v[16:19], a[72:79], v3
  v_smfmac_f32_16x16x64_bf16 v[44:47], v[16:19], a[128:135], v3
  buffer_load_dwordx4 v[92:95], v117, s[8:11], s26 offen offset:1024
  v_smfmac_f32_16x16x64_bf16 v[48:51], v[16:19], a[184:191], v3
  v_smfmac_f32_16x16x64_bf16 v[52:55], v[16:19], a[240:247], v3
  s_waitcnt vmcnt(5)
  v_cmp_eq_u32 vcc, -1, v20
  v_smfmac_f32_16x16x64_bf16 v[56:59], v[16:19], v[160:167], v3
  v_smfmac_f32_16x16x64_bf16 v[62:65], v[16:19], v[216:223], v3
  buffer_load_dwordx4 v[96:99], v2, s[8:11], s24 offen offset:0
  s_cbranch_vccnz cA_sc3_r3
cA_sc3_c3:
  v_smfmac_f32_16x16x64_bf16 v[36:39], v[20:23], a[24:31], v3
  v_smfmac_f32_16x16x64_bf16 v[40:43], v[20:23], a[80:87], v3
  s_waitcnt vmcnt(3)
  v_max3_u32 v66, v24, v27, v28
  v_smfmac_f32_16x16x64_bf16 v[44:47], v[20:23], a[136:143], v3
  v_max3_u32 v66, v66, v31, v32
  v_smfmac_f32_16x16x64_bf16 v[48:51], v[20:23], a[192:199], v3
  buffer_load_dwordx4 v[100:103], v2, s[8:11], s24 offen offset:1024
  v_max_u32 v66, v66, v35
  v_smfmac_f32_16x16x64_bf16 v[52:55], v[20:23], a[248:255], v3
  v_cmp_eq_u32 vcc, -1, v66
  v_smfmac_f32_16x16x64_bf16 v[56:59], v[20:23], v[168:175], v3
  v_smfmac_f32_16x16x64_bf16 v[62:65], v[20:23], v[224:231], v3
  s_cbranch_vccnz cA_sc3_r4
cA_sc3_c4:
  v_smfmac_f32_16x16x64_bf16 v[62:65], v[24:27], v[232:239], v3
  buffer_load_dwordx4 v[104:107], v2, s[8:11], s26 offen offset:0
  v_smfmac_f32_16x16x64_bf16 v[62:65], v[28:31], v[240:247], v3
  v_smfmac_f32_16x16x64_bf16 v[62:65], v[32:35], v[248:255], v3
  v_smfmac_f32_16x16x64_bf16 v[52:55], v[24:27], v[120:127], v3
  v_smfmac_f32_16x16x64_bf16 v[52:55], v[28:31], v[128:135], v3
  buffer_load_dwordx4 v[108:111], v2, s[8:11], s26 offen offset:1024
  v_smfmac_f32_16x16x64_bf16 v[52:55], v[32:35], v[136:143], v3
  v_cvt_pk_bf16_f32 v62, v62, v63
  v_smfmac_f32_16x16x64_bf16 v[56:59], v[24:27], v[176:183], v3
  v_cvt_pk_bf16_f32 v63, v64, v65
  v_smfmac_f32_16x16x64_bf16 v[56:59], v[28:31], v[184:191], v3
  v_mfma_f32_16x16x32_bf16 v[8:11], v[60:63], v[4:7], 0
  v_cvt_pk_bf16_f32 v55, v54, v55
  v_smfmac_f32_16x16x64_bf16 v[56:59], v[32:35], v[192:199], v3
  v_cvt_pk_bf16_f32 v54, v52, v53
  v_smfmac_f32_16x16x64_bf16 v[36:39], v[24:27], a[32:39], v3
  s_nop 1
  v_cvt_pk_bf16_f32 v78, v8, v9
  v_smfmac_f32_16x16x64_bf16 v[36:39], v[28:31], a[40:47], v3
  v_cvt_pk_bf16_f32 v79, v10, v11
  v_smfmac_f32_16x16x64_bf16 v[36:39], v[32:35], a[48:55], v3
  v_cvt_pk_bf16_f32 v56, v56, v57
  v_smfmac_f32_16x16x64_bf16 v[40:43], v[24:27], a[88:95], v3
  v_cvt_pk_bf16_f32 v57, v58, v59
  v_smfmac_f32_16x16x64_bf16 v[40:43], v[28:31], a[96:103], v3
  v_mfma_f32_16x16x32_bf16 v[12:15], v[54:57], v[4:7], 0
  v_cvt_pk_bf16_f32 v39, v38, v39
  v_smfmac_f32_16x16x64_bf16 v[40:43], v[32:35], a[104:111], v3
  v_cvt_pk_bf16_f32 v38, v36, v37
  v_smfmac_f32_16x16x64_bf16 v[44:47], v[24:27], a[144:151], v3
  s_nop 1
  v_cvt_pk_bf16_f32 v76, v12, v13
  v_smfmac_f32_16x16x64_bf16 v[44:47], v[28:31], a[152:159], v3
  v_cvt_pk_bf16_f32 v77, v14, v15
  v_smfmac_f32_16x16x64_bf16 v[44:47], v[32:35], a[160:167], v3
  v_cvt_pk_bf16_f32 v40, v40, v41
  v_smfmac_f32_16x16x64_bf16 v[48:51], v[24:27], a[200:207], v3
  v_cvt_pk_bf16_f32 v41, v42, v43
  v_smfmac_f32_16x16x64_bf16 v[48:51], v[28:31], a[208:215], v3
  v_smfmac_f32_16x16x64_bf16 v[48:51], v[32:35], a[216:223], v3
  s_waitcnt vmcnt(4)
  v_cvt_pk_bf16_f32 v47, v46, v47
  v_smfmac_f32_16x16x64_bf16 v[68:71], v[76:79], v[80:87], v3
  v_cvt_pk_bf16_f32 v46, v44, v45
  v_mfma_f32_16x16x32_bf16 v[8:11], v[38:41], v[4:7], 0
  s_nop 1
  v_cvt_pk_bf16_f32 v48, v48, v49
  v_cvt_pk_bf16_f32 v49, v50, v51
  s_nop 1
  v_mfma_f32_16x16x32_bf16 v[12:15], v[46:49], v[4:7], 0
  v_smfmac_f32_16x16x64_bf16 v[72:75], v[76:79], v[88:95], v3
  v_cvt_pk_bf16_f32 v16, v8, v9
  v_mfma_f32_16x16x32_bf16 v[52:55], v[30:33], v[76:79], 0
  s_waitcnt vmcnt(0)
  v_cvt_pk_bf16_f32 v17, v10, v11
  v_cvt_pk_bf16_f32 v18, v12, v13
  v_cvt_pk_bf16_f32 v19, v14, v15
  s_nop 1
  v_smfmac_f32_16x16x64_bf16 v[68:71], v[16:19], v[96:103], v3
  v_mfma_f32_16x16x32_bf16 v[52:55], v[20:23], v[16:19], v[52:55]
  v_smfmac_f32_16x16x64_bf16 v[72:75], v[16:19], v[104:111], v3
  s_nop 1
  v_permlane32_swap_b32 v68, v70
  v_permlane32_swap_b32 v69, v71
  v_add_f32 v56, v68, v70
  v_add_f32 v58, v69, v71
  ds_write_b128 v113, v[52:55]
  s_nop 0
  v_permlane32_swap_b32 v72, v74
  v_permlane32_swap_b32 v73, v75
  v_add_f32 v57, v72, v74
  v_add_f32 v59, v73, v75
  ds_write_b128 v2, v[56:59] offset:3072
  v_cmp_u_f32 vcc, v57, v59
  v_mov_b32 v36, 0
  v_mov_b32 v37, 0
  v_mov_b32 v38, 0
  v_mov_b32 v39, 0
  s_cbranch_vccnz cA_sc3_retry
cA_sc3_cont:
  s_add_u32 s24, s24, 28672
  s_add_u32 s26, s26, 28672
  buffer_load_dwordx4 v[80:83], v117, s[8:11], s24 offen offset:0
  buffer_load_dwordx4 v[84:87], v117, s[8:11], s24 offen offset:1024
  v_mov_b32 v40, 0
  v_mov_b32 v41, 0
  v_mov_b32 v42, 0
  v_mov_b32 v43, 0
  v_mov_b32 v44, 0
  v_mov_b32 v45, 0
  v_mov_b32 v46, 0
  v_mov_b32 v47, 0
  v_mov_b32 v48, 0
  v_mov_b32 v49, 0
  v_mov_b32 v50, 0
  v_mov_b32 v51, 0
  s_waitcnt lgkmcnt(0)
  s_barrier
  v_mov_b32 v62, 0
  v_mov_b32 v63, 0
  v_mov_b32 v64, 0
  v_mov_b32 v65, 0
  v_mov_b32 v68, 0
  v_mov_b32 v69, 0
  v_mov_b32 v70, 0
  v_mov_b32 v71, 0
  v_mov_b32 v72, 0
  v_mov_b32 v73, 0
  v_mov_b32 v74, 0
  v_mov_b32 v75, 0
  v_mov_b32 v52, 0
  v_mov_b32 v53, 0
  v_mov_b32 v54, 0
  v_mov_b32 v55, 0
  v_mov_b32 v56, 0
  v_mov_b32 v57, 0
  v_mov_b32 v58, 0
  v_mov_b32 v59, 0
  s_mov_b32 s19, s18
  s_add_u32 s18, s18, 1
  s_mov_b32 s22, s20
  s_mov_b32 s20, s21
  s_mov_b32 s21, s22
  s_add_u32 s23, s20, 4096
  s_cmp_lt_u32 s19, 63
  s_cbranch_scc1 cA_sc3_loop
  s_branch cA_done
cA_sc3_r0:
  s_add_u32 s31, s31, 1
  buffer_load_dwordx4 v[8:11], v2, s[8:11], s20 offen offset:0 sc1
  s_waitcnt vmcnt(0)
  v_cmp_eq_u32 vcc, -1, v8
  v_mov_b32 v36, 0
  v_mov_b32 v37, 0
  v_mov_b32 v38, 0
  v_mov_b32 v39, 0
  v_mov_b32 v40, 0
  v_mov_b32 v41, 0
  v_mov_b32 v42, 0
  v_mov_b32 v43, 0
  v_mov_b32 v44, 0
  v_mov_b32 v45, 0
  v_mov_b32 v46, 0
  v_mov_b32 v47, 0
  v_mov_b32 v48, 0
  v_mov_b32 v49, 0
  v_mov_b32 v50, 0
  v_mov_b32 v51, 0
  s_nop 1
  s_cbranch_vccz cA_sc3_go
  s_add_u32 s30, s30, 1
  s_cmp_lt_u32 s30, 400000
  s_cbranch_scc1 cA_sc3_r0
  s_branch cA_abort
cA_sc3_r1:
  s_add_u32 s31, s31, 1
  buffer_load_dwordx4 v[12:15], v2, s[8:11], s20 offen offset:1024 sc1
  s_waitcnt vmcnt(0)
  v_cmp_eq_u32 vcc, -1, v12
  s_nop 4
  s_cbranch_vccz cA_sc3_c1
  s_add_u32 s30, s30, 1
  s_cmp_lt_u32 s30, 400000
  s_cbranch_scc1 cA_sc3_r1
  s_branch cA_abort
cA_sc3_r2:
  s_add_u32 s31, s31, 1
  buffer_load_dwordx4 v[16:19], v2, s[8:11], s20 offen offset:2048 sc1
  s_waitcnt vmcnt(0)
  v_cmp_eq_u32 vcc, -1, v16
  s_nop 4
  s_cbranch_vccz cA_sc3_c2
  s_add_u32 s30, s30, 1
  s_cmp_lt_u32 s30, 400000
  s_cbranch_scc1 cA_sc3_r2
  s_branch cA_abort
cA_sc3_r3:
  s_add_u32 s31, s31, 1
  buffer_load_dwordx4 v[20:23], v2, s[8:11], s20 offen offset:3072 sc1
  s_waitcnt vmcnt(0)
  v_cmp_eq_u32 vcc, -1, v20
  s_nop 4
  s_cbranch_vccz cA_sc3_c3
  s_add_u32 s30, s30, 1
  s_cmp_lt_u32 s30, 400000
  s_cbranch_scc1 cA_sc3_r3
  s_branch cA_abort
cA_sc3_r4:
  s_add_u32 s31, s31, 1
  buffer_load_dwordx4 v[24:27], v2, s[8:11], s23 offen offset:0 sc1
  buffer_load_dwordx4 v[28:31], v2, s[8:11], s23 offen offset:1024 sc1
  buffer_load_dwordx4 v[32:35], v2, s[8:11], s23 offen offset:2048 sc1
  s_waitcnt vmcnt(0)
  v_max3_u32 v66, v24, v27, v28
  v_max3_u32 v66, v66, v31, v32
  v_max_u32 v66, v66, v35
  v_cmp_eq_u32 vcc, -1, v66
  s_nop 4
  s_cbranch_vccz cA_sc3_c4
  s_add_u32 s30, s30, 1
  s_cmp_lt_u32 s30, 400000
  s_cbranch_scc1 cA_sc3_r4
  s_branch cA_abort
cA_sc3_retry:
  s_cmp_lg_u32 s62, 0
  s_cbranch_scc1 cA_sc3_cont
  s_waitcnt vmcnt(0) lgkmcnt(0)
cA_sc3_rv:
  buffer_load_dwordx4 v[8:11], v2, s[8:11], s20 offen offset:0 sc1
  buffer_load_dwordx4 v[12:15], v2, s[8:11], s20 offen offset:1024 sc1
  buffer_load_dwordx4 v[16:19], v2, s[8:11], s20 offen offset:2048 sc1
  buffer_load_dwordx4 v[20:23], v2, s[8:11], s20 offen offset:3072 sc1
  buffer_load_dwordx4 v[24:27], v2, s[8:11], s23 offen offset:0 sc1
  buffer_load_dwordx4 v[28:31], v2, s[8:11], s23 offen offset:1024 sc1
  buffer_load_dwordx4 v[32:35], v2, s[8:11], s23 offen offset:2048 sc1
  s_waitcnt vmcnt(0)
  v_pk_max_u16 v66, v8, v9
  v_pk_max_u16 v66, v66, v10
  v_pk_max_u16 v66, v66, v11
  v_pk_max_u16 v66, v66, v12
  v_pk_max_u16 v66, v66, v13
  v_pk_max_u16 v66, v66, v14
  v_pk_max_u16 v66, v66, v15
  v_pk_max_u16 v66, v66, v16
  v_pk_max_u16 v66, v66, v17
  v_pk_max_u16 v66, v66, v18
  v_pk_max_u16 v66, v66, v19
  v_pk_max_u16 v66, v66, v20
  v_pk_max_u16 v66, v66, v21
  v_pk_max_u16 v66, v66, v22
  v_pk_max_u16 v66, v66, v23
  v_pk_max_u16 v66, v66, v24
  v_pk_max_u16 v66, v66, v25
  v_pk_max_u16 v66, v66, v26
  v_pk_max_u16 v66, v66, v27
  v_pk_max_u16 v66, v66, v28
  v_pk_max_u16 v66, v66, v29
  v_pk_max_u16 v66, v66, v30
  v_pk_max_u16 v66, v66, v31
  v_pk_max_u16 v66, v66, v32
  v_pk_max_u16 v66, v66, v33
  v_pk_max_u16 v66, v66, v34
  v_pk_max_u16 v66, v66, v35
  v_lshlrev_b32 v67, 16, v66
  v_max_u32 v66, v66, v67
  v_cmp_le_u32 vcc, 0xffff0000, v66
  s_cbranch_vccz cA_sc3_rk
  s_add_u32 s30, s30, 1
  s_cmp_lt_u32 s30, 400000
  s_cbranch_scc1 cA_sc3_rv
  s_branch cA_abort
cA_sc3_rk:
  s_mov_b32 s62, 1
  v_mov_b32 v36, 0
  v_mov_b32 v37, 0
  v_mov_b32 v38, 0
  v_mov_b32 v39, 0
  v_mov_b32 v40, 0
  v_mov_b32 v41, 0
  v_mov_b32 v42, 0
  v_mov_b32 v43, 0
  v_mov_b32 v44, 0
  v_mov_b32 v45, 0
  v_mov_b32 v46, 0
  v_mov_b32 v47, 0
  v_mov_b32 v48, 0
  v_mov_b32 v49, 0
  v_mov_b32 v50, 0
  v_mov_b32 v51, 0
  v_mov_b32 v62, 0
  v_mov_b32 v63, 0
  v_mov_b32 v64, 0
  v_mov_b32 v65, 0
  v_mov_b32 v68, 0
  v_mov_b32 v69, 0
  v_mov_b32 v70, 0
  v_mov_b32 v71, 0
  v_mov_b32 v72, 0
  v_mov_b32 v73, 0
  v_mov_b32 v74, 0
  v_mov_b32 v75, 0
  v_mov_b32 v52, 0
  v_mov_b32 v53, 0
  v_mov_b32 v54, 0
  v_mov_b32 v55, 0
  v_mov_b32 v56, 0
  v_mov_b32 v57, 0
  v_mov_b32 v58, 0
  v_mov_b32 v59, 0
  s_add_u32 s31, s31, 0x100
  s_nop 0
  s_branch cA_sc3_go
.p2align 6
cA_va0_loop:
  s_mov_b32 s30, 0
  s_barrier
  buffer_load_dwordx4 v[24:27], v2, s[8:11], s23 offen offset:0 sc1
  buffer_load_dwordx4 v[28:31], v2, s[8:11], s23 offen offset:1024 sc1
  s_barrier
  buffer_store_dword v160, v1, s[8:11], s38 offen sc1
  s_add_u32 s22, s25, 0
  buffer_load_dwordx4 v[80:83], v6, s[8:11], s22 offen offset:0 sc1
  buffer_load_dwordx4 v[84:87], v6, s[8:11], s22 offen offset:1792 sc1
  s_add_u32 s22, s25, 3584
  buffer_load_dwordx4 v[88:91], v6, s[8:11], s22 offen offset:0 sc1
  buffer_load_dwordx4 v[92:95], v6, s[8:11], s22 offen offset:1792 sc1
  s_add_u32 s22, s25, 7168
  buffer_load_dwordx4 v[96:99], v6, s[8:11], s22 offen offset:0 sc1
  buffer_load_dwordx4 v[100:103], v6, s[8:11], s22 offen offset:1792 sc1
  s_add_u32 s22, s25, 10752
  buffer_load_dwordx4 v[104:107], v6, s[8:11], s22 offen offset:0 sc1
  buffer_load_dwordx4 v[108:111], v6, s[8:11], s22 offen offset:1792 sc1
  s_add_u32 s22, s25, 14336
  buffer_load_dwordx4 v[112:115], v6, s[8:11], s22 offen offset:0 sc1
  buffer_load_dwordx4 v[116:119], v6, s[8:11], s22 offen offset:1792 sc1
  s_add_u32 s22, s25, 17920
  buffer_load_dwordx4 v[120:123], v6, s[8:11], s22 offen offset:0 sc1
  buffer_load_dwordx4 v[124:127], v6, s[8:11], s22 offen offset:1792 sc1
  s_add_u32 s22, s25, 21504
  buffer_load_dwordx4 v[128:131], v6, s[8:11], s22 offen offset:0 sc1
  buffer_load_dwordx4 v[132:135], v6, s[8:11], s22 offen offset:1792 sc1
  s_add_u32 s22, s25, 25088
  buffer_load_dwordx4 v[136:139], v6, s[8:11], s22 offen offset:0 sc1
  buffer_load_dwordx4 v[140:143], v6, s[8:11], s22 offen offset:1792 sc1
  s_mul_i32 s38, s18, 7168
  s_add_u32 s38, s38, 87543808
  s_waitcnt vmcnt(17)
  ds_write_b128 v2, v[24:27] offset:12288
  ds_write_b128 v2, v[28:31] offset:13312
  v_smfmac_f32_16x16x64_bf16 v[36:39], v[24:27], a[32:39], v3
  v_smfmac_f32_16x16x64_bf16 v[40:43], v[24:27], a[88:95], v3
  v_smfmac_f32_16x16x64_bf16 v[44:47], v[24:27], a[144:151], v3
  v_smfmac_f32_16x16x64_bf16 v[48:51], v[24:27], a[200:207], v3
  v_smfmac_f32_16x16x64_bf16 v[52:55], v[24:27], v[176:183], v3
  s_waitcnt lgkmcnt(0)
  s_barrier
  ds_read_b128 v[8:11], v2 offset:8192
  ds_read_b128 v[12:15], v2 offset:9216
  ds_read_b128 v[16:19], v2 offset:10240
  ds_read_b128 v[20:23], v2 offset:11264
  ds_read_b128 v[32:35], v2 offset:14336
  v_smfmac_f32_16x16x64_bf16 v[56:59], v[24:27], v[232:239], v3
  v_smfmac_f32_16x16x64_bf16 v[36:39], v[28:31], a[40:47], v3
  v_smfmac_f32_16x16x64_bf16 v[40:43], v[28:31], a[96:103], v3
  v_smfmac_f32_16x16x64_bf16 v[44:47], v[28:31], a[152:159], v3
  v_smfmac_f32_16x16x64_bf16 v[48:51], v[28:31], a[208:215], v3
  v_smfmac_f32_16x16x64_bf16 v[52:55], v[28:31], v[184:191], v3
  ds_read_b128 v[64:67], v0 offset:0
  ds_read_b128 v[68:71], v0 offset:1024
  v_smfmac_f32_16x16x64_bf16 v[56:59], v[28:31], v[240:247], v3
  s_waitcnt lgkmcnt(6)
  ds_read_b128 v[72:75], v0 offset:2048
  ds_read_b128 v[76:79], v0 offset:3072
  v_smfmac_f32_16x16x64_bf16 v[36:39], v[8:11], a[0:7], v3
  s_waitcnt lgkmcnt(7)
  v_smfmac_f32_16x16x64_bf16 v[36:39], v[12:15], a[8:15], v3
  s_waitcnt lgkmcnt(6)
  v_smfmac_f32_16x16x64_bf16 v[36:39], v[16:19], a[16:23], v3
  s_waitcnt lgkmcnt(2)
  v_smfmac_f32_16x16x64_bf16 v[60:63], v[8:11], v[64:71], v3
  s_waitcnt lgkmcnt(5)
  ds_read_b128 v[144:147], v0 offset:4096
  ds_read_b128 v[148:151], v0 offset:5120
  v_smfmac_f32_16x16x64_bf16 v[36:39], v[20:23], a[24:31], v3
  s_waitcnt lgkmcnt(6)
  v_smfmac_f32_16x16x64_bf16 v[36:39], v[32:35], a[48:55], v3
  v_smfmac_f32_16x16x64_bf16 v[40:43], v[8:11], a[56:63], v3
  s_waitcnt lgkmcnt(2)
  v_smfmac_f32_16x16x64_bf16 v[60:63], v[12:15], v[72:79], v3
  ds_read_b128 v[64:67], v0 offset:6144
  ds_read_b128 v[68:71], v0 offset:7168
  v_smfmac_f32_16x16x64_bf16 v[40:43], v[12:15], a[64:71], v3
  v_permlane32_swap_b32 v36, v38
  v_smfmac_f32_16x16x64_bf16 v[40:43], v[16:19], a[72:79], v3
  v_permlane32_swap_b32 v37, v39
  v_smfmac_f32_16x16x64_bf16 v[40:43], v[20:23], a[80:87], v3
  s_waitcnt lgkmcnt(2)
  v_add_f32 v36, v36, v38
  v_smfmac_f32_16x16x64_bf16 v[60:63], v[16:19], v[144:151], v3
  ds_read_b128 v[72:75], v0 offset:8192
  ds_read_b128 v[76:79], v0 offset:9216
  v_add_f32 v37, v37, v39
  v_smfmac_f32_16x16x64_bf16 v[40:43], v[32:35], a[104:111], v3
  v_cmp_u_f32 vcc, v36, v37
  v_smfmac_f32_16x16x64_bf16 v[44:47], v[8:11], a[112:119], v3
  v_cvt_pk_bf16_f32 v38, v36, v37
  v_smfmac_f32_16x16x64_bf16 v[44:47], v[12:15], a[120:127], v3
  ds_write_b32 v152, v38
  s_waitcnt lgkmcnt(3)
  s_cbranch_vccnz cA_va0_slow
  v_permlane32_swap_b32 v40, v42
  v_smfmac_f32_16x16x64_bf16 v[60:63], v[20:23], v[64:71], v3
  ds_read_b128 v[144:147], v0 offset:10240
  ds_read_b128 v[148:151], v0 offset:11264
  v_permlane32_swap_b32 v41, v43
  v_smfmac_f32_16x16x64_bf16 v[44:47], v[16:19], a[128:135], v3
  buffer_store_dword v162, v1, s[8:11], s21 offen
  v_add_f32 v40, v40, v42
  v_smfmac_f32_16x16x64_bf16 v[44:47], v[20:23], a[136:143], v3
  v_add_f32 v41, v41, v43
  v_smfmac_f32_16x16x64_bf16 v[44:47], v[32:35], a[160:167], v3
  s_waitcnt lgkmcnt(3)
  v_cvt_pk_bf16_f32 v42, v40, v41
  v_smfmac_f32_16x16x64_bf16 v[60:63], v[24:27], v[72:79], v3
  ds_write_b32 v153, v42
  ds_read_b128 v[64:67], v0 offset:12288
  ds_read_b128 v[68:71], v0 offset:13312
  v_smfmac_f32_16x16x64_bf16 v[48:51], v[8:11], a[168:175], v3
  s_nop 0
  v_permlane32_swap_b32 v44, v46
  v_smfmac_f32_16x16x64_bf16 v[48:51], v[12:15], a[176:183], v3
  v_permlane32_swap_b32 v45, v47
  v_smfmac_f32_16x16x64_bf16 v[48:51], v[16:19], a[184:191], v3
  s_waitcnt lgkmcnt(3)
  v_add_f32 v44, v44, v46
  v_smfmac_f32_16x16x64_bf16 v[60:63], v[28:31], v[144:151], v3
  v_add_f32 v45, v45, v47
  v_smfmac_f32_16x16x64_bf16 v[48:51], v[20:23], a[192:199], v3
  v_cvt_pk_bf16_f32 v46, v44, v45
  v_smfmac_f32_16x16x64_bf16 v[48:51], v[32:35], a[216:223], v3
  ds_write_b32 v154, v46
  v_smfmac_f32_16x16x64_bf16 v[52:55], v[8:11], a[224:231], v3
  s_waitcnt lgkmcnt(1)
  v_smfmac_f32_16x16x64_bf16 v[60:63], v[32:35], v[64:71], v3
  v_smfmac_f32_16x16x64_bf16 v[52:55], v[12:15], a[232:239], v3
  v_permlane32_swap_b32 v48, v50
  v_smfmac_f32_16x16x64_bf16 v[52:55], v[16:19], a[240:247], v3
  v_permlane32_swap_b32 v49, v51
  v_smfmac_f32_16x16x64_bf16 v[52:55], v[20:23], a[248:255], v3
  v_add_f32 v48, v48, v50
  v_smfmac_f32_16x16x64_bf16 v[52:55], v[32:35], v[192:199], v3
  v_add_f32 v49, v49, v51
  v_smfmac_f32_16x16x64_bf16 v[56:59], v[8:11], v[200:207], v3
  v_cvt_pk_bf16_f32 v50, v48, v49
  v_smfmac_f32_16x16x64_bf16 v[56:59], v[12:15], v[208:215], v3
  ds_write_b32 v155, v50
  v_permlane32_swap_b32 v60, v62
  v_smfmac_f32_16x16x64_bf16 v[56:59], v[16:19], v[216:223], v3
  v_permlane32_swap_b32 v61, v63
  v_smfmac_f32_16x16x64_bf16 v[56:59], v[20:23], v[224:231], v3
  v_add_f32 v60, v60, v62
  v_smfmac_f32_16x16x64_bf16 v[56:59], v[32:35], v[248:255], v3
  v_add_f32 v61, v61, v63
  v_cvt_pk_bf16_f32 v62, v60, v61
  ds_write_b32 v158, v62
  v_permlane32_swap_b32 v52, v54
  v_permlane32_swap_b32 v53, v55
  v_add_f32 v52, v52, v54
  v_add_f32 v53, v53, v55
  v_cvt_pk_bf16_f32 v54, v52, v53
  ds_write_b32 v156, v54
  v_permlane32_swap_b32 v56, v58
  v_permlane32_swap_b32 v57, v59
  v_add_f32 v56, v56, v58
  v_add_f32 v57, v57, v59
  v_cvt_pk_bf16_f32 v58, v56, v57
  ds_write_b32 v157, v58
cA_va0_t2d:
  s_add_u32 s22, s20, 9216
  s_add_u32 s34, s20, 13312
  s_add_u32 s36, s20, 7168
  s_mov_b32 s37, 0
  v_mov_b32 v48, 0
  v_mov_b32 v49, 0
  v_mov_b32 v50, 0
  v_mov_b32 v51, 0
  v_mov_b32 v163, s18
  s_waitcnt lgkmcnt(0)
  s_setprio 3
  buffer_load_dword v52, v4, s[8:11], 0 offen sc1
  buffer_load_dword v53, v4, s[8:11], 0 offen sc1
  buffer_load_dword v54, v4, s[8:11], 0 offen sc1
cA_va0_fw_l:
  s_waitcnt vmcnt(2)
  v_cmp_gt_u32 vcc, s18, v52
  s_cbranch_vccz cA_va0_fw_d
  buffer_load_dword v52, v4, s[8:11], 0 offen sc1
  s_waitcnt vmcnt(2)
  v_cmp_gt_u32 vcc, s18, v53
  s_cbranch_vccz cA_va0_fw_d
  buffer_load_dword v53, v4, s[8:11], 0 offen sc1
  s_waitcnt vmcnt(2)
  v_cmp_gt_u32 vcc, s18, v54
  s_cbranch_vccz cA_va0_fw_d
  buffer_load_dword v54, v4, s[8:11], 0 offen sc1
  s_add_u32 s30, s30, 1
  s_cmp_lt_u32 s30, 400000
  s_cbranch_scc1 cA_va0_fw_l
  s_branch cA_abort
cA_va0_fw_d:
  buffer_load_dwordx4 v[8:11], v2, s[8:11], s22 offen offset:0 sc1
  buffer_load_dwordx4 v[12:15], v2, s[8:11], s22 offen offset:1024 sc1
  buffer_load_dwordx4 v[16:19], v2, s[8:11], s22 offen offset:2048 sc1
  buffer_load_dwordx4 v[20:23], v2, s[8:11], s22 offen offset:3072 sc1
  buffer_load_dwordx4 v[24:27], v2, s[8:11], s34 offen offset:0 sc1
  buffer_load_dwordx4 v[28:31], v2, s[8:11], s34 offen offset:1024 sc1
  buffer_load_dwordx4 v[32:35], v2, s[8:11], s34 offen offset:2048 sc1
  buffer_load_dwordx4 v[36:39], v2, s[8:11], s34 offen offset:3072 sc1
  buffer_load_dwordx4 v[40:43], v2, s[8:11], s36 offen offset:0 sc1
  buffer_load_dwordx4 v[44:47], v2, s[8:11], s36 offen offset:1024 sc1
  s_barrier
  ds_read_b128 v[64:67], v2 offset:0
  ds_read_b128 v[68:71], v2 offset:1024
  ds_read_b128 v[72:75], v2 offset:2048
  ds_read_b128 v[76:79], v2 offset:3072
cA_va0_lp:
  s_waitcnt vmcnt(9)
  v_smfmac_f32_16x16x64_bf16 v[48:51], v[8:11], v[80:87], v3
  s_waitcnt vmcnt(8)
  v_smfmac_f32_16x16x64_bf16 v[48:51], v[12:15], v[88:95], v3
  s_waitcnt vmcnt(7)
  v_smfmac_f32_16x16x64_bf16 v[48:51], v[16:19], v[96:103], v3
  s_waitcnt vmcnt(6)
  v_smfmac_f32_16x16x64_bf16 v[48:51], v[20:23], v[104:111], v3
  s_waitcnt vmcnt(5)
  v_smfmac_f32_16x16x64_bf16 v[48:51], v[24:27], v[112:119], v3
  s_waitcnt vmcnt(4)
  v_smfmac_f32_16x16x64_bf16 v[48:51], v[28:31], v[120:127], v3
  s_waitcnt vmcnt(3)
  v_smfmac_f32_16x16x64_bf16 v[48:51], v[32:35], v[128:135], v3
  s_waitcnt vmcnt(2)
  v_smfmac_f32_16x16x64_bf16 v[48:51], v[36:39], v[136:143], v3
  s_waitcnt vmcnt(1) lgkmcnt(0)
  v_smfmac_f32_16x16x64_bf16 v[48:51], v[40:43], v[64:71], v3
  s_waitcnt vmcnt(0)
  v_smfmac_f32_16x16x64_bf16 v[48:51], v[44:47], v[72:79], v3
  s_nop 7
  v_permlane32_swap_b32 v48, v50
  v_permlane32_swap_b32 v49, v51
  v_add_f32 v48, v48, v50
  v_add_f32 v49, v49, v51
  v_cvt_pk_bf16_f32 v160, v48, v49
  v_cmp_u_f32 vcc, v48, v49
  s_nop 0
  v_mov_b32_dpp v161, v160 quad_perm:[1,0,3,2] row_mask:0xf bank_mask:0xf
  v_perm_b32 v160, v161, v160, v5
  v_min_u32 v160, -2, v160
  s_cbranch_vccnz cA_va0_rp
cA_va0_cont:
  buffer_store_dword v160, v1, s[8:11], s21 offen
  s_setprio 0
  s_cmp_lg_u32 s19, 62
  s_cbranch_scc1 cA_va0_nl
  buffer_store_dword v160, v1, s[8:11], s38 offen sc1
  s_branch cA_done
cA_va0_nl:
  s_add_u32 s25, s25, 28672
  v_mov_b32 v36, 0
  v_mov_b32 v37, 0
  v_mov_b32 v38, 0
  v_mov_b32 v39, 0
  v_mov_b32 v40, 0
  v_mov_b32 v41, 0
  v_mov_b32 v42, 0
  v_mov_b32 v43, 0
  v_mov_b32 v44, 0
  v_mov_b32 v45, 0
  v_mov_b32 v46, 0
  v_mov_b32 v47, 0
  v_mov_b32 v48, 0
  v_mov_b32 v49, 0
  v_mov_b32 v50, 0
  v_mov_b32 v51, 0
  v_mov_b32 v52, 0
  v_mov_b32 v53, 0
  v_mov_b32 v54, 0
  v_mov_b32 v55, 0
  v_mov_b32 v56, 0
  v_mov_b32 v57, 0
  v_mov_b32 v58, 0
  v_mov_b32 v59, 0
  v_mov_b32 v60, 0
  v_mov_b32 v61, 0
  v_mov_b32 v62, 0
  v_mov_b32 v63, 0
  s_mov_b32 s19, s18
  s_add_u32 s18, s18, 1
  s_mov_b32 s22, s20
  s_mov_b32 s20, s21
  s_mov_b32 s21, s22
  s_add_u32 s23, s20, 4096
  s_branch cA_va0_loop
cA_va0_slow:
  s_waitcnt lgkmcnt(0)
cA_va0_sl1:
  s_add_u32 s31, s31, 0x1000000
  buffer_load_dwordx4 v[8:11], v2, s[8:11], s20 offen offset:0 sc1
  buffer_load_dwordx4 v[12:15], v2, s[8:11], s20 offen offset:1024 sc1
  buffer_load_dwordx4 v[16:19], v2, s[8:11], s20 offen offset:2048 sc1
  buffer_load_dwordx4 v[20:23], v2, s[8:11], s20 offen offset:3072 sc1
  buffer_load_dwordx4 v[24:27], v2, s[8:11], s23 offen offset:0 sc1
  buffer_load_dwordx4 v[28:31], v2, s[8:11], s23 offen offset:1024 sc1
  buffer_load_dwordx4 v[32:35], v2, s[8:11], s23 offen offset:2048 sc1
  s_waitcnt vmcnt(0)
  v_max3_u32 v36, v8, v9, v10
  v_max3_u32 v36, v36, v11, v12
  v_max3_u32 v36, v36, v13, v14
  v_max3_u32 v36, v36, v15, v16
  v_max3_u32 v36, v36, v17, v18
  v_max3_u32 v36, v36, v19, v20
  v_max3_u32 v36, v36, v21, v22
  v_max3_u32 v36, v36, v23, v24
  v_max3_u32 v36, v36, v25, v26
  v_max3_u32 v36, v36, v27, v28
  v_max3_u32 v36, v36, v29, v30
  v_max3_u32 v36, v36, v31, v32
  v_max3_u32 v36, v36, v33, v34
  v_max_u32 v36, v36, v35
  v_cmp_eq_u32 vcc, -1, v36
  s_cbranch_vccz cA_va0_sl2
  s_add_u32 s30, s30, 1
  s_cmp_lt_u32 s30, 400000
  s_cbranch_scc1 cA_va0_sl1
  s_branch cA_abort
cA_va0_sl2:
  v_mov_b32 v36, 0
  v_mov_b32 v37, 0
  v_mov_b32 v38, 0
  v_mov_b32 v39, 0
  v_mov_b32 v40, 0
  v_mov_b32 v41, 0
  v_mov_b32 v42, 0
  v_mov_b32 v43, 0
  v_mov_b32 v44, 0
  v_mov_b32 v45, 0
  v_mov_b32 v46, 0
  v_mov_b32 v47, 0
  v_mov_b32 v48, 0
  v_mov_b32 v49, 0
  v_mov_b32 v50, 0
  v_mov_b32 v51, 0
  v_mov_b32 v52, 0
  v_mov_b32 v53, 0
  v_mov_b32 v54, 0
  v_mov_b32 v55, 0
  v_mov_b32 v56, 0
  v_mov_b32 v57, 0
  v_mov_b32 v58, 0
  v_mov_b32 v59, 0
  v_mov_b32 v60, 0
  v_mov_b32 v61, 0
  v_mov_b32 v62, 0
  v_mov_b32 v63, 0
  buffer_store_dword v162, v1, s[8:11], s21 offen
  ds_read_b128 v[64:67], v0 offset:0
  ds_read_b128 v[68:71], v0 offset:1024
  v_smfmac_f32_16x16x64_bf16 v[36:39], v[8:11], a[0:7], v3
  v_smfmac_f32_16x16x64_bf16 v[40:43], v[8:11], a[56:63], v3
  v_smfmac_f32_16x16x64_bf16 v[44:47], v[8:11], a[112:119], v3
  v_smfmac_f32_16x16x64_bf16 v[48:51], v[8:11], a[168:175], v3
  v_smfmac_f32_16x16x64_bf16 v[52:55], v[8:11], a[224:231], v3
  v_smfmac_f32_16x16x64_bf16 v[56:59], v[8:11], v[200:207], v3
  s_waitcnt lgkmcnt(0)
  v_smfmac_f32_16x16x64_bf16 v[60:63], v[8:11], v[64:71], v3
  ds_read_b128 v[72:75], v0 offset:2048
  ds_read_b128 v[76:79], v0 offset:3072
  v_smfmac_f32_16x16x64_bf16 v[36:39], v[12:15], a[8:15], v3
  v_smfmac_f32_16x16x64_bf16 v[40:43], v[12:15], a[64:71], v3
  v_smfmac_f32_16x16x64_bf16 v[44:47], v[12:15], a[120:127], v3
  v_smfmac_f32_16x16x64_bf16 v[48:51], v[12:15], a[176:183], v3
  v_smfmac_f32_16x16x64_bf16 v[52:55], v[12:15], a[232:239], v3
  v_smfmac_f32_16x16x64_bf16 v[56:59], v[12:15], v[208:215], v3
  s_waitcnt lgkmcnt(0)
  v_smfmac_f32_16x16x64_bf16 v[60:63], v[12:15], v[72:79], v3
  ds_read_b128 v[144:147], v0 offset:4096
  ds_read_b128 v[148:151], v0 offset:5120
  v_smfmac_f32_16x16x64_bf16 v[36:39], v[16:19], a[16:23], v3
  v_smfmac_f32_16x16x64_bf16 v[40:43], v[16:19], a[72:79], v3
  v_smfmac_f32_16x16x64_bf16 v[44:47], v[16:19], a[128:135], v3
  v_smfmac_f32_16x16x64_bf16 v[48:51], v[16:19], a[184:191], v3
  v_smfmac_f32_16x16x64_bf16 v[52:55], v[16:19], a[240:247], v3
  v_smfmac_f32_16x16x64_bf16 v[56:59], v[16:19], v[216:223], v3
  s_waitcnt lgkmcnt(0)
  v_smfmac_f32_16x16x64_bf16 v[60:63], v[16:19], v[144:151], v3
  ds_read_b128 v[64:67], v0 offset:6144
  ds_read_b128 v[68:71], v0 offset:7168
  v_smfmac_f32_16x16x64_bf16 v[36:39], v[20:23], a[24:31], v3
  v_smfmac_f32_16x16x64_bf16 v[40:43], v[20:23], a[80:87], v3
  v_smfmac_f32_16x16x64_bf16 v[44:47], v[20:23], a[136:143], v3
  v_smfmac_f32_16x16x64_bf16 v[48:51], v[20:23], a[192:199], v3
  v_smfmac_f32_16x16x64_bf16 v[52:55], v[20:23], a[248:255], v3
  v_smfmac_f32_16x16x64_bf16 v[56:59], v[20:23], v[224:231], v3
  s_waitcnt lgkmcnt(0)
  v_smfmac_f32_16x16x64_bf16 v[60:63], v[20:23], v[64:71], v3
  ds_read_b128 v[72:75], v0 offset:8192
  ds_read_b128 v[76:79], v0 offset:9216
  v_smfmac_f32_16x16x64_bf16 v[36:39], v[24:27], a[32:39], v3
  v_smfmac_f32_16x16x64_bf16 v[40:43], v[24:27], a[88:95], v3
  v_smfmac_f32_16x16x64_bf16 v[44:47], v[24:27], a[144:151], v3
  v_smfmac_f32_16x16x64_bf16 v[48:51], v[24:27], a[200:207], v3
  v_smfmac_f32_16x16x64_bf16 v[52:55], v[24:27], v[176:183], v3
  v_smfmac_f32_16x16x64_bf16 v[56:59], v[24:27], v[232:239], v3
  s_waitcnt lgkmcnt(0)
  v_smfmac_f32_16x16x64_bf16 v[60:63], v[24:27], v[72:79], v3
  ds_read_b128 v[144:147], v0 offset:10240
  ds_read_b128 v[148:151], v0 offset:11264
  v_smfmac_f32_16x16x64_bf16 v[36:39], v[28:31], a[40:47], v3
  v_smfmac_f32_16x16x64_bf16 v[40:43], v[28:31], a[96:103], v3
  v_smfmac_f32_16x16x64_bf16 v[44:47], v[28:31], a[152:159], v3
  v_smfmac_f32_16x16x64_bf16 v[48:51], v[28:31], a[208:215], v3
  v_smfmac_f32_16x16x64_bf16 v[52:55], v[28:31], v[184:191], v3
  v_smfmac_f32_16x16x64_bf16 v[56:59], v[28:31], v[240:247], v3
  s_waitcnt lgkmcnt(0)
  v_smfmac_f32_16x16x64_bf16 v[60:63], v[28:31], v[144:151], v3
  ds_read_b128 v[64:67], v0 offset:12288
  ds_read_b128 v[68:71], v0 offset:13312
  v_smfmac_f32_16x16x64_bf16 v[36:39], v[32:35], a[48:55], v3
  v_smfmac_f32_16x16x64_bf16 v[40:43], v[32:35], a[104:111], v3
  v_smfmac_f32_16x16x64_bf16 v[44:47], v[32:35], a[160:167], v3
  v_smfmac_f32_16x16x64_bf16 v[48:51], v[32:35], a[216:223], v3
  v_smfmac_f32_16x16x64_bf16 v[52:55], v[32:35], v[192:199], v3
  v_smfmac_f32_16x16x64_bf16 v[56:59], v[32:35], v[248:255], v3
  s_waitcnt lgkmcnt(0)
  v_smfmac_f32_16x16x64_bf16 v[60:63], v[32:35], v[64:71], v3
  v_permlane32_swap_b32 v36, v38
  v_permlane32_swap_b32 v37, v39
  v_add_f32 v36, v36, v38
  v_add_f32 v37, v37, v39
  v_cvt_pk_bf16_f32 v38, v36, v37
  ds_write_b32 v152, v38
  v_permlane32_swap_b32 v40, v42
  v_permlane32_swap_b32 v41, v43
  v_add_f32 v40, v40, v42
  v_add_f32 v41, v41, v43
  v_cvt_pk_bf16_f32 v42, v40, v41
  ds_write_b32 v153, v42
  v_permlane32_swap_b32 v44, v46
  v_permlane32_swap_b32 v45, v47
  v_add_f32 v44, v44, v46
  v_add_f32 v45, v45, v47
  v_cvt_pk_bf16_f32 v46, v44, v45
  ds_write_b32 v154, v46
  v_permlane32_swap_b32 v48, v50
  v_permlane32_swap_b32 v49, v51
  v_add_f32 v48, v48, v50
  v_add_f32 v49, v49, v51
  v_cvt_pk_bf16_f32 v50, v48, v49
  ds_write_b32 v155, v50
  v_permlane32_swap_b32 v52, v54
  v_permlane32_swap_b32 v53, v55
  v_add_f32 v52, v52, v54
  v_add_f32 v53, v53, v55
  v_cvt_pk_bf16_f32 v54, v52, v53
  ds_write_b32 v156, v54
  v_permlane32_swap_b32 v56, v58
  v_permlane32_swap_b32 v57, v59
  v_add_f32 v56, v56, v58
  v_add_f32 v57, v57, v59
  v_cvt_pk_bf16_f32 v58, v56, v57
  ds_write_b32 v157, v58
  v_permlane32_swap_b32 v60, v62
  v_permlane32_swap_b32 v61, v63
  v_add_f32 v60, v60, v62
  v_add_f32 v61, v61, v63
  v_cvt_pk_bf16_f32 v62, v60, v61
  ds_write_b32 v158, v62
  s_branch cA_va0_t2d
cA_va0_rp:
  s_cmp_lg_u32 s37, 0
  s_cbranch_scc1 cA_va0_cont
cA_va0_rv:
  s_add_u32 s31, s31, 0x10000
  buffer_load_dwordx4 v[8:11], v2, s[8:11], s22 offen offset:0 sc1
  buffer_load_dwordx4 v[12:15], v2, s[8:11], s22 offen offset:1024 sc1
  buffer_load_dwordx4 v[16:19], v2, s[8:11], s22 offen offset:2048 sc1
  buffer_load_dwordx4 v[20:23], v2, s[8:11], s22 offen offset:3072 sc1
  buffer_load_dwordx4 v[24:27], v2, s[8:11], s34 offen offset:0 sc1
  buffer_load_dwordx4 v[28:31], v2, s[8:11], s34 offen offset:1024 sc1
  buffer_load_dwordx4 v[32:35], v2, s[8:11], s34 offen offset:2048 sc1
  buffer_load_dwordx4 v[36:39], v2, s[8:11], s34 offen offset:3072 sc1
  buffer_load_dwordx4 v[40:43], v2, s[8:11], s36 offen offset:0 sc1
  buffer_load_dwordx4 v[44:47], v2, s[8:11], s36 offen offset:1024 sc1
  s_waitcnt vmcnt(0)
  v_max3_u32 v52, v8, v9, v10
  v_max3_u32 v52, v52, v11, v12
  v_max3_u32 v52, v52, v13, v14
  v_max3_u32 v52, v52, v15, v16
  v_max3_u32 v52, v52, v17, v18
  v_max3_u32 v52, v52, v19, v20
  v_max3_u32 v52, v52, v21, v22
  v_max3_u32 v52, v52, v23, v24
  v_max3_u32 v52, v52, v25, v26
  v_max3_u32 v52, v52, v27, v28
  v_max3_u32 v52, v52, v29, v30
  v_max3_u32 v52, v52, v31, v32
  v_max3_u32 v52, v52, v33, v34
  v_max3_u32 v52, v52, v35, v36
  v_max3_u32 v52, v52, v37, v38
  v_max3_u32 v52, v52, v39, v40
  v_max3_u32 v52, v52, v41, v42
  v_max3_u32 v52, v52, v43, v44
  v_max3_u32 v52, v52, v45, v46
  v_max_u32 v52, v52, v47
  v_cmp_eq_u32 vcc, -1, v52
  s_mov_b32 s37, 1
  v_mov_b32 v48, 0
  v_mov_b32 v49, 0
  v_mov_b32 v50, 0
  v_mov_b32 v51, 0
  s_nop 1
  s_cbranch_vccz cA_va0_lp
  s_add_u32 s30, s30, 1
  s_cmp_lt_u32 s30, 400000
  s_cbranch_scc1 cA_va0_rv
  s_branch cA_abort
.p2align 6
cA_va1_loop:
  s_mov_b32 s30, 0
  s_barrier
  buffer_load_dwordx4 v[28:31], v2, s[8:11], s23 offen offset:1024 sc1
  buffer_load_dwordx4 v[32:35], v2, s[8:11], s23 offen offset:2048 sc1
  s_barrier
  buffer_store_dword v160, v1, s[8:11], s38 offen sc1
  s_add_u32 s22, s25, 0
  buffer_load_dwordx4 v[80:83], v6, s[8:11], s22 offen offset:0 sc1
  buffer_load_dwordx4 v[84:87], v6, s[8:11], s22 offen offset:1792 sc1
  s_add_u32 s22, s25, 3584
  buffer_load_dwordx4 v[88:91], v6, s[8:11], s22 offen offset:0 sc1
  buffer_load_dwordx4 v[92:95], v6, s[8:11], s22 offen offset:1792 sc1
  s_add_u32 s22, s25, 7168
  buffer_load_dwordx4 v[96:99], v6, s[8:11], s22 offen offset:0 sc1
  buffer_load_dwordx4 v[100:103], v6, s[8:11], s22 offen offset:1792 sc1
  s_add_u32 s22, s25, 10752
  buffer_load_dwordx4 v[104:107], v6, s[8:11], s22 offen offset:0 sc1
  buffer_load_dwordx4 v[108:111], v6, s[8:11], s22 offen offset:1792 sc1
  s_add_u32 s22, s25, 14336
  buffer_load_dwordx4 v[112:115], v6, s[8:11], s22 offen offset:0 sc1
  buffer_load_dwordx4 v[116:119], v6, s[8:11], s22 offen offset:1792 sc1
  s_add_u32 s22, s25, 17920
  buffer_load_dwordx4 v[120:123], v6, s[8:11], s22 offen offset:0 sc1
  buffer_load_dwordx4 v[124:127], v6, s[8:11], s22 offen offset:1792 sc1
  s_add_u32 s22, s25, 21504
  buffer_load_dwordx4 v[128:131], v6, s[8:11], s22 offen offset:0 sc1
  buffer_load_dwordx4 v[132:135], v6, s[8:11], s22 offen offset:1792 sc1
  s_add_u32 s22, s25, 25088
  buffer_load_dwordx4 v[136:139], v6, s[8:11], s22 offen offset:0 sc1
  buffer_load_dwordx4 v[140:143], v6, s[8:11], s22 offen offset:1792 sc1
  s_mul_i32 s38, s18, 7168
  s_add_u32 s38, s38, 87543808
  s_waitcnt vmcnt(17)
  ds_write_b128 v2, v[32:35] offset:14336
  v_smfmac_f32_16x16x64_bf16 v[36:39], v[28:31], a[40:47], v3
  v_smfmac_f32_16x16x64_bf16 v[40:43], v[28:31], a[96:103], v3
  v_smfmac_f32_16x16x64_bf16 v[44:47], v[28:31], a[152:159], v3
  v_smfmac_f32_16x16x64_bf16 v[48:51], v[28:31], a[208:215], v3
  v_smfmac_f32_16x16x64_bf16 v[52:55], v[28:31], v[184:191], v3
  s_waitcnt lgkmcnt(0)
  s_barrier
  ds_read_b128 v[8:11], v2 offset:8192
  ds_read_b128 v[12:15], v2 offset:9216
  ds_read_b128 v[16:19], v2 offset:10240
  ds_read_b128 v[20:23], v2 offset:11264
  ds_read_b128 v[24:27], v2 offset:12288
  v_smfmac_f32_16x16x64_bf16 v[56:59], v[28:31], v[240:247], v3
  v_smfmac_f32_16x16x64_bf16 v[36:39], v[32:35], a[48:55], v3
  v_smfmac_f32_16x16x64_bf16 v[40:43], v[32:35], a[104:111], v3
  v_smfmac_f32_16x16x64_bf16 v[44:47], v[32:35], a[160:167], v3
  v_smfmac_f32_16x16x64_bf16 v[48:51], v[32:35], a[216:223], v3
  v_smfmac_f32_16x16x64_bf16 v[52:55], v[32:35], v[192:199], v3
  ds_read_b128 v[64:67], v0 offset:0
  ds_read_b128 v[68:71], v0 offset:1024
  v_smfmac_f32_16x16x64_bf16 v[56:59], v[32:35], v[248:255], v3
  s_waitcnt lgkmcnt(6)
  ds_read_b128 v[72:75], v0 offset:2048
  ds_read_b128 v[76:79], v0 offset:3072
  v_smfmac_f32_16x16x64_bf16 v[36:39], v[8:11], a[0:7], v3
  s_waitcnt lgkmcnt(7)
  v_smfmac_f32_16x16x64_bf16 v[36:39], v[12:15], a[8:15], v3
  s_waitcnt lgkmcnt(6)
  v_smfmac_f32_16x16x64_bf16 v[36:39], v[16:19], a[16:23], v3
  s_waitcnt lgkmcnt(2)
  v_smfmac_f32_16x16x64_bf16 v[60:63], v[8:11], v[64:71], v3
  s_waitcnt lgkmcnt(5)
  ds_read_b128 v[144:147], v0 offset:4096
  ds_read_b128 v[148:151], v0 offset:5120
  v_smfmac_f32_16x16x64_bf16 v[36:39], v[20:23], a[24:31], v3
  s_waitcnt lgkmcnt(6)
  v_smfmac_f32_16x16x64_bf16 v[36:39], v[24:27], a[32:39], v3
  v_smfmac_f32_16x16x64_bf16 v[40:43], v[8:11], a[56:63], v3
  s_waitcnt lgkmcnt(2)
  v_smfmac_f32_16x16x64_bf16 v[60:63], v[12:15], v[72:79], v3
  ds_read_b128 v[64:67], v0 offset:6144
  ds_read_b128 v[68:71], v0 offset:7168
  v_smfmac_f32_16x16x64_bf16 v[40:43], v[12:15], a[64:71], v3
  v_permlane32_swap_b32 v36, v38
  v_smfmac_f32_16x16x64_bf16 v[40:43], v[16:19], a[72:79], v3
  v_permlane32_swap_b32 v37, v39
  v_smfmac_f32_16x16x64_bf16 v[40:43], v[20:23], a[80:87], v3
  s_waitcnt lgkmcnt(2)
  v_add_f32 v36, v36, v38
  v_smfmac_f32_16x16x64_bf16 v[60:63], v[16:19], v[144:151], v3
  ds_read_b128 v[72:75], v0 offset:8192
  ds_read_b128 v[76:79], v0 offset:9216
  v_add_f32 v37, v37, v39
  v_smfmac_f32_16x16x64_bf16 v[40:43], v[24:27], a[88:95], v3
  v_cmp_u_f32 vcc, v36, v37
  v_smfmac_f32_16x16x64_bf16 v[44:47], v[8:11], a[112:119], v3
  v_cvt_pk_bf16_f32 v38, v36, v37
  v_smfmac_f32_16x16x64_bf16 v[44:47], v[12:15], a[120:127], v3
  ds_write_b32 v152, v38
  s_waitcnt lgkmcnt(3)
  s_cbranch_vccnz cA_va1_slow
  v_permlane32_swap_b32 v40, v42
  v_smfmac_f32_16x16x64_bf16 v[60:63], v[20:23], v[64:71], v3
  ds_read_b128 v[144:147], v0 offset:10240
  ds_read_b128 v[148:151], v0 offset:11264
  v_permlane32_swap_b32 v41, v43
  v_smfmac_f32_16x16x64_bf16 v[44:47], v[16:19], a[128:135], v3
  buffer_store_dword v162, v1, s[8:11], s21 offen
  v_add_f32 v40, v40, v42
  v_smfmac_f32_16x16x64_bf16 v[44:47], v[20:23], a[136:143], v3
  v_add_f32 v41, v41, v43
  v_smfmac_f32_16x16x64_bf16 v[44:47], v[24:27], a[144:151], v3
  s_waitcnt lgkmcnt(3)
  v_cvt_pk_bf16_f32 v42, v40, v41
  v_smfmac_f32_16x16x64_bf16 v[60:63], v[24:27], v[72:79], v3
  ds_write_b32 v153, v42
  ds_read_b128 v[64:67], v0 offset:12288
  ds_read_b128 v[68:71], v0 offset:13312
  v_smfmac_f32_16x16x64_bf16 v[48:51], v[8:11], a[168:175], v3
  s_nop 0
  v_permlane32_swap_b32 v44, v46
  v_smfmac_f32_16x16x64_bf16 v[48:51], v[12:15], a[176:183], v3
  v_permlane32_swap_b32 v45, v47
  v_smfmac_f32_16x16x64_bf16 v[48:51], v[16:19], a[184:191], v3
  s_waitcnt lgkmcnt(3)
  v_add_f32 v44, v44, v46
  v_smfmac_f32_16x16x64_bf16 v[60:63], v[28:31], v[144:151], v3
  v_add_f32 v45, v45, v47
  v_smfmac_f32_16x16x64_bf16 v[48:51], v[20:23], a[192:199], v3
  v_cvt_pk_bf16_f32 v46, v44, v45
  v_smfmac_f32_16x16x64_bf16 v[48:51], v[24:27], a[200:207], v3
  ds_write_b32 v154, v46
  v_smfmac_f32_16x16x64_bf16 v[52:55], v[8:11], a[224:231], v3
  s_waitcnt lgkmcnt(1)
  v_smfmac_f32_16x16x64_bf16 v[60:63], v[32:35], v[64:71], v3
  v_smfmac_f32_16x16x64_bf16 v[52:55], v[12:15], a[232:239], v3
  v_permlane32_swap_b32 v48, v50
  v_smfmac_f32_16x16x64_bf16 v[52:55], v[16:19], a[240:247], v3
  v_permlane32_swap_b32 v49, v51
  v_smfmac_f32_16x16x64_bf16 v[52:55], v[20:23], a[248:255], v3
  v_add_f32 v48, v48, v50
  v_smfmac_f32_16x16x64_bf16 v[52:55], v[24:27], v[176:183], v3
  v_add_f32 v49, v49, v51
  v_smfmac_f32_16x16x64_bf16 v[56:59], v[8:11], v[200:207], v3
  v_cvt_pk_bf16_f32 v50, v48, v49
  v_smfmac_f32_16x16x64_bf16 v[56:59], v[12:15], v[208:215], v3
  ds_write_b32 v155, v50
  v_permlane32_swap_b32 v60, v62
  v_smfmac_f32_16x16x64_bf16 v[56:59], v[16:19], v[216:223], v3
  v_permlane32_swap_b32 v61, v63
  v_smfmac_f32_16x16x64_bf16 v[56:59], v[20:23], v[224:231], v3
  v_add_f32 v60, v60, v62
  v_smfmac_f32_16x16x64_bf16 v[56:59], v[24:27], v[232:239], v3
  v_add_f32 v61, v61, v63
  v_cvt_pk_bf16_f32 v62, v60, v61
  ds_write_b32 v158, v62
  v_permlane32_swap_b32 v52, v54
  v_permlane32_swap_b32 v53, v55
  v_add_f32 v52, v52, v54
  v_add_f32 v53, v53, v55
  v_cvt_pk_bf16_f32 v54, v52, v53
  ds_write_b32 v156, v54
  v_permlane32_swap_b32 v56, v58
  v_permlane32_swap_b32 v57, v59
  v_add_f32 v56, v56, v58
  v_add_f32 v57, v57, v59
  v_cvt_pk_bf16_f32 v58, v56, v57
  ds_write_b32 v157, v58
cA_va1_t2d:
  s_add_u32 s22, s20, 9216
  s_add_u32 s34, s20, 13312
  s_add_u32 s36, s20, 7168
  s_mov_b32 s37, 0
  v_mov_b32 v48, 0
  v_mov_b32 v49, 0
  v_mov_b32 v50, 0
  v_mov_b32 v51, 0
  v_mov_b32 v163, s18
  s_waitcnt lgkmcnt(0)
  s_barrier
  buffer_load_dwordx4 v[8:11], v2, s[8:11], s22 offen offset:0 sc1
  buffer_load_dwordx4 v[12:15], v2, s[8:11], s22 offen offset:1024 sc1
  buffer_load_dwordx4 v[16:19], v2, s[8:11], s22 offen offset:2048 sc1
  buffer_load_dwordx4 v[20:23], v2, s[8:11], s22 offen offset:3072 sc1
  buffer_load_dwordx4 v[24:27], v2, s[8:11], s34 offen offset:0 sc1
  buffer_load_dwordx4 v[28:31], v2, s[8:11], s34 offen offset:1024 sc1
  buffer_load_dwordx4 v[32:35], v2, s[8:11], s34 offen offset:2048 sc1
  buffer_load_dwordx4 v[36:39], v2, s[8:11], s34 offen offset:3072 sc1
  buffer_load_dwordx4 v[40:43], v2, s[8:11], s36 offen offset:0 sc1
  buffer_load_dwordx4 v[44:47], v2, s[8:11], s36 offen offset:1024 sc1
  ds_read_b128 v[64:67], v2 offset:4096
  ds_read_b128 v[68:71], v2 offset:5120
  ds_read_b128 v[72:75], v2 offset:6144
  ds_read_b128 v[76:79], v2 offset:7168
cA_va1_lp:
  s_waitcnt vmcnt(9)
  v_smfmac_f32_16x16x64_bf16 v[48:51], v[8:11], v[80:87], v3
  s_waitcnt vmcnt(8)
  v_smfmac_f32_16x16x64_bf16 v[48:51], v[12:15], v[88:95], v3
  s_waitcnt vmcnt(7)
  v_smfmac_f32_16x16x64_bf16 v[48:51], v[16:19], v[96:103], v3
  v_max3_u32 v55, v8, v12, v16
  s_waitcnt vmcnt(6)
  v_smfmac_f32_16x16x64_bf16 v[48:51], v[20:23], v[104:111], v3
  v_max_u32 v55, v55, v20
  v_cmp_eq_u32 vcc, -1, v55
  s_waitcnt vmcnt(5)
  v_smfmac_f32_16x16x64_bf16 v[48:51], v[24:27], v[112:119], v3
  s_waitcnt vmcnt(4)
  v_smfmac_f32_16x16x64_bf16 v[48:51], v[28:31], v[120:127], v3
  s_cbranch_vccnz cA_va1_rv
  buffer_store_dword v163, v7, s[8:11], 0 offen
  s_waitcnt vmcnt(4)
  v_smfmac_f32_16x16x64_bf16 v[48:51], v[32:35], v[128:135], v3
  s_waitcnt vmcnt(3)
  v_smfmac_f32_16x16x64_bf16 v[48:51], v[36:39], v[136:143], v3
  s_waitcnt vmcnt(2) lgkmcnt(0)
  v_smfmac_f32_16x16x64_bf16 v[48:51], v[40:43], v[64:71], v3
  s_waitcnt vmcnt(1)
  v_smfmac_f32_16x16x64_bf16 v[48:51], v[44:47], v[72:79], v3
  s_nop 7
  v_permlane32_swap_b32 v48, v50
  v_permlane32_swap_b32 v49, v51
  v_add_f32 v48, v48, v50
  v_add_f32 v49, v49, v51
  v_cvt_pk_bf16_f32 v160, v48, v49
  v_cmp_u_f32 vcc, v48, v49
  s_nop 0
  v_mov_b32_dpp v161, v160 quad_perm:[1,0,3,2] row_mask:0xf bank_mask:0xf
  v_perm_b32 v160, v161, v160, v5
  v_min_u32 v160, -2, v160
  s_cbranch_vccnz cA_va1_rp
cA_va1_cont:
  buffer_store_dword v160, v1, s[8:11], s21 offen
  s_cmp_lg_u32 s19, 62
  s_cbranch_scc1 cA_va1_nl
  buffer_store_dword v160, v1, s[8:11], s38 offen sc1
  s_branch cA_done
cA_va1_nl:
  s_add_u32 s25, s25, 28672
  v_mov_b32 v36, 0
  v_mov_b32 v37, 0
  v_mov_b32 v38, 0
  v_mov_b32 v39, 0
  v_mov_b32 v40, 0
  v_mov_b32 v41, 0
  v_mov_b32 v42, 0
  v_mov_b32 v43, 0
  v_mov_b32 v44, 0
  v_mov_b32 v45, 0
  v_mov_b32 v46, 0
  v_mov_b32 v47, 0
  v_mov_b32 v48, 0
  v_mov_b32 v49, 0
  v_mov_b32 v50, 0
  v_mov_b32 v51, 0
  v_mov_b32 v52, 0
  v_mov_b32 v53, 0
  v_mov_b32 v54, 0
  v_mov_b32 v55, 0
  v_mov_b32 v56, 0
  v_mov_b32 v57, 0
  v_mov_b32 v58, 0
  v_mov_b32 v59, 0
  v_mov_b32 v60, 0
  v_mov_b32 v61, 0
  v_mov_b32 v62, 0
  v_mov_b32 v63, 0
  s_mov_b32 s19, s18
  s_add_u32 s18, s18, 1
  s_mov_b32 s22, s20
  s_mov_b32 s20, s21
  s_mov_b32 s21, s22
  s_add_u32 s23, s20, 4096
  s_branch cA_va1_loop
cA_va1_slow:
  s_waitcnt lgkmcnt(0)
cA_va1_sl1:
  s_add_u32 s31, s31, 0x1000000
  buffer_load_dwordx4 v[8:11], v2, s[8:11], s20 offen offset:0 sc1
  buffer_load_dwordx4 v[12:15], v2, s[8:11], s20 offen offset:1024 sc1
  buffer_load_dwordx4 v[16:19], v2, s[8:11], s20 offen offset:2048 sc1
  buffer_load_dwordx4 v[20:23], v2, s[8:11], s20 offen offset:3072 sc1
  buffer_load_dwordx4 v[24:27], v2, s[8:11], s23 offen offset:0 sc1
  buffer_load_dwordx4 v[28:31], v2, s[8:11], s23 offen offset:1024 sc1
  buffer_load_dwordx4 v[32:35], v2, s[8:11], s23 offen offset:2048 sc1
  s_waitcnt vmcnt(0)
  v_max3_u32 v36, v8, v9, v10
  v_max3_u32 v36, v36, v11, v12
  v_max3_u32 v36, v36, v13, v14
  v_max3_u32 v36, v36, v15, v16
  v_max3_u32 v36, v36, v17, v18
  v_max3_u32 v36, v36, v19, v20
  v_max3_u32 v36, v36, v21, v22
  v_max3_u32 v36, v36, v23, v24
  v_max3_u32 v36, v36, v25, v26
  v_max3_u32 v36, v36, v27, v28
  v_max3_u32 v36, v36, v29, v30
  v_max3_u32 v36, v36, v31, v32
  v_max3_u32 v36, v36, v33, v34
  v_max_u32 v36, v36, v35
  v_cmp_eq_u32 vcc, -1, v36
  s_cbranch_vccz cA_va1_sl2
  s_add_u32 s30, s30, 1
  s_cmp_lt_u32 s30, 400000
  s_cbranch_scc1 cA_va1_sl1
  s_branch cA_abort
cA_va1_sl2:
  v_mov_b32 v36, 0
  v_mov_b32 v37, 0
  v_mov_b32 v38, 0
  v_mov_b32 v39, 0
  v_mov_b32 v40, 0
  v_mov_b32 v41, 0
  v_mov_b32 v42, 0
  v_mov_b32 v43, 0
  v_mov_b32 v44, 0
  v_mov_b32 v45, 0
  v_mov_b32 v46, 0
  v_mov_b32 v47, 0
  v_mov_b32 v48, 0
  v_mov_b32 v49, 0
  v_mov_b32 v50, 0
  v_mov_b32 v51, 0
  v_mov_b32 v52, 0
  v_mov_b32 v53, 0
  v_mov_b32 v54, 0
  v_mov_b32 v55, 0
  v_mov_b32 v56, 0
  v_mov_b32 v57, 0
  v_mov_b32 v58, 0
  v_mov_b32 v59, 0
  v_mov_b32 v60, 0
  v_mov_b32 v61, 0
  v_mov_b32 v62, 0
  v_mov_b32 v63, 0
  buffer_store_dword v162, v1, s[8:11], s21 offen
  ds_read_b128 v[64:67], v0 offset:0
  ds_read_b128 v[68:71], v0 offset:1024
  v_smfmac_f32_16x16x64_bf16 v[36:39], v[8:11], a[0:7], v3
  v_smfmac_f32_16x16x64_bf16 v[40:43], v[8:11], a[56:63], v3
  v_smfmac_f32_16x16x64_bf16 v[44:47], v[8:11], a[112:119], v3
  v_smfmac_f32_16x16x64_bf16 v[48:51], v[8:11], a[168:175], v3
  v_smfmac_f32_16x16x64_bf16 v[52:55], v[8:11], a[224:231], v3
  v_smfmac_f32_16x16x64_bf16 v[56:59], v[8:11], v[200:207], v3
  s_waitcnt lgkmcnt(0)
  v_smfmac_f32_16x16x64_bf16 v[60:63], v[8:11], v[64:71], v3
  ds_read_b128 v[72:75], v0 offset:2048
  ds_read_b128 v[76:79], v0 offset:3072
  v_smfmac_f32_16x16x64_bf16 v[36:39], v[12:15], a[8:15], v3
  v_smfmac_f32_16x16x64_bf16 v[40:43], v[12:15], a[64:71], v3
  v_smfmac_f32_16x16x64_bf16 v[44:47], v[12:15], a[120:127], v3
  v_smfmac_f32_16x16x64_bf16 v[48:51], v[12:15], a[176:183], v3
  v_smfmac_f32_16x16x64_bf16 v[52:55], v[12:15], a[232:239], v3
  v_smfmac_f32_16x16x64_bf16 v[56:59], v[12:15], v[208:215], v3
  s_waitcnt lgkmcnt(0)
  v_smfmac_f32_16x16x64_bf16 v[60:63], v[12:15], v[72:79], v3
  ds_read_b128 v[144:147], v0 offset:4096
  ds_read_b128 v[148:151], v0 offset:5120
  v_smfmac_f32_16x16x64_bf16 v[36:39], v[16:19], a[16:23], v3
  v_smfmac_f32_16x16x64_bf16 v[40:43], v[16:19], a[72:79], v3
  v_smfmac_f32_16x16x64_bf16 v[44:47], v[16:19], a[128:135], v3
  v_smfmac_f32_16x16x64_bf16 v[48:51], v[16:19], a[184:191], v3
  v_smfmac_f32_16x16x64_bf16 v[52:55], v[16:19], a[240:247], v3
  v_smfmac_f32_16x16x64_bf16 v[56:59], v[16:19], v[216:223], v3
  s_waitcnt lgkmcnt(0)
  v_smfmac_f32_16x16x64_bf16 v[60:63], v[16:19], v[144:151], v3
  ds_read_b128 v[64:67], v0 offset:6144
  ds_read_b128 v[68:71], v0 offset:7168
  v_smfmac_f32_16x16x64_bf16 v[36:39], v[20:23], a[24:31], v3
  v_smfmac_f32_16x16x64_bf16 v[40:43], v[20:23], a[80:87], v3
  v_smfmac_f32_16x16x64_bf16 v[44:47], v[20:23], a[136:143], v3
  v_smfmac_f32_16x16x64_bf16 v[48:51], v[20:23], a[192:199], v3
  v_smfmac_f32_16x16x64_bf16 v[52:55], v[20:23], a[248:255], v3
  v_smfmac_f32_16x16x64_bf16 v[56:59], v[20:23], v[224:231], v3
  s_waitcnt lgkmcnt(0)
  v_smfmac_f32_16x16x64_bf16 v[60:63], v[20:23], v[64:71], v3
  ds_read_b128 v[72:75], v0 offset:8192
  ds_read_b128 v[76:79], v0 offset:9216
  v_smfmac_f32_16x16x64_bf16 v[36:39], v[24:27], a[32:39], v3
  v_smfmac_f32_16x16x64_bf16 v[40:43], v[24:27], a[88:95], v3
  v_smfmac_f32_16x16x64_bf16 v[44:47], v[24:27], a[144:151], v3
  v_smfmac_f32_16x16x64_bf16 v[48:51], v[24:27], a[200:207], v3
  v_smfmac_f32_16x16x64_bf16 v[52:55], v[24:27], v[176:183], v3
  v_smfmac_f32_16x16x64_bf16 v[56:59], v[24:27], v[232:239], v3
  s_waitcnt lgkmcnt(0)
  v_smfmac_f32_16x16x64_bf16 v[60:63], v[24:27], v[72:79], v3
  ds_read_b128 v[144:147], v0 offset:10240
  ds_read_b128 v[148:151], v0 offset:11264
  v_smfmac_f32_16x16x64_bf16 v[36:39], v[28:31], a[40:47], v3
  v_smfmac_f32_16x16x64_bf16 v[40:43], v[28:31], a[96:103], v3
  v_smfmac_f32_16x16x64_bf16 v[44:47], v[28:31], a[152:159], v3
  v_smfmac_f32_16x16x64_bf16 v[48:51], v[28:31], a[208:215], v3
  v_smfmac_f32_16x16x64_bf16 v[52:55], v[28:31], v[184:191], v3
  v_smfmac_f32_16x16x64_bf16 v[56:59], v[28:31], v[240:247], v3
  s_waitcnt lgkmcnt(0)
  v_smfmac_f32_16x16x64_bf16 v[60:63], v[28:31], v[144:151], v3
  ds_read_b128 v[64:67], v0 offset:12288
  ds_read_b128 v[68:71], v0 offset:13312
  v_smfmac_f32_16x16x64_bf16 v[36:39], v[32:35], a[48:55], v3
  v_smfmac_f32_16x16x64_bf16 v[40:43], v[32:35], a[104:111], v3
  v_smfmac_f32_16x16x64_bf16 v[44:47], v[32:35], a[160:167], v3
  v_smfmac_f32_16x16x64_bf16 v[48:51], v[32:35], a[216:223], v3
  v_smfmac_f32_16x16x64_bf16 v[52:55], v[32:35], v[192:199], v3
  v_smfmac_f32_16x16x64_bf16 v[56:59], v[32:35], v[248:255], v3
  s_waitcnt lgkmcnt(0)
  v_smfmac_f32_16x16x64_bf16 v[60:63], v[32:35], v[64:71], v3
  v_permlane32_swap_b32 v36, v38
  v_permlane32_swap_b32 v37, v39
  v_add_f32 v36, v36, v38
  v_add_f32 v37, v37, v39
  v_cvt_pk_bf16_f32 v38, v36, v37
  ds_write_b32 v152, v38
  v_permlane32_swap_b32 v40, v42
  v_permlane32_swap_b32 v41, v43
  v_add_f32 v40, v40, v42
  v_add_f32 v41, v41, v43
  v_cvt_pk_bf16_f32 v42, v40, v41
  ds_write_b32 v153, v42
  v_permlane32_swap_b32 v44, v46
  v_permlane32_swap_b32 v45, v47
  v_add_f32 v44, v44, v46
  v_add_f32 v45, v45, v47
  v_cvt_pk_bf16_f32 v46, v44, v45
  ds_write_b32 v154, v46
  v_permlane32_swap_b32 v48, v50
  v_permlane32_swap_b32 v49, v51
  v_add_f32 v48, v48, v50
  v_add_f32 v49, v49, v51
  v_cvt_pk_bf16_f32 v50, v48, v49
  ds_write_b32 v155, v50
  v_permlane32_swap_b32 v52, v54
  v_permlane32_swap_b32 v53, v55
  v_add_f32 v52, v52, v54
  v_add_f32 v53, v53, v55
  v_cvt_pk_bf16_f32 v54, v52, v53
  ds_write_b32 v156, v54
  v_permlane32_swap_b32 v56, v58
  v_permlane32_swap_b32 v57, v59
  v_add_f32 v56, v56, v58
  v_add_f32 v57, v57, v59
  v_cvt_pk_bf16_f32 v58, v56, v57
  ds_write_b32 v157, v58
  v_permlane32_swap_b32 v60, v62
  v_permlane32_swap_b32 v61, v63
  v_add_f32 v60, v60, v62
  v_add_f32 v61, v61, v63
  v_cvt_pk_bf16_f32 v62, v60, v61
  ds_write_b32 v158, v62
  s_branch cA_va1_t2d
cA_va1_rp:
  s_cmp_lg_u32 s37, 0
  s_cbranch_scc1 cA_va1_cont
cA_va1_rv:
  s_add_u32 s31, s31, 0x10000
  buffer_load_dwordx4 v[8:11], v2, s[8:11], s22 offen offset:0 sc1
  buffer_load_dwordx4 v[12:15], v2, s[8:11], s22 offen offset:1024 sc1
  buffer_load_dwordx4 v[16:19], v2, s[8:11], s22 offen offset:2048 sc1
  buffer_load_dwordx4 v[20:23], v2, s[8:11], s22 offen offset:3072 sc1
  buffer_load_dwordx4 v[24:27], v2, s[8:11], s34 offen offset:0 sc1
  buffer_load_dwordx4 v[28:31], v2, s[8:11], s34 offen offset:1024 sc1
  buffer_load_dwordx4 v[32:35], v2, s[8:11], s34 offen offset:2048 sc1
  buffer_load_dwordx4 v[36:39], v2, s[8:11], s34 offen offset:3072 sc1
  buffer_load_dwordx4 v[40:43], v2, s[8:11], s36 offen offset:0 sc1
  buffer_load_dwordx4 v[44:47], v2, s[8:11], s36 offen offset:1024 sc1
  s_waitcnt vmcnt(0)
  v_max3_u32 v52, v8, v9, v10
  v_max3_u32 v52, v52, v11, v12
  v_max3_u32 v52, v52, v13, v14
  v_max3_u32 v52, v52, v15, v16
  v_max3_u32 v52, v52, v17, v18
  v_max3_u32 v52, v52, v19, v20
  v_max3_u32 v52, v52, v21, v22
  v_max3_u32 v52, v52, v23, v24
  v_max3_u32 v52, v52, v25, v26
  v_max3_u32 v52, v52, v27, v28
  v_max3_u32 v52, v52, v29, v30
  v_max3_u32 v52, v52, v31, v32
  v_max3_u32 v52, v52, v33, v34
  v_max3_u32 v52, v52, v35, v36
  v_max3_u32 v52, v52, v37, v38
  v_max3_u32 v52, v52, v39, v40
  v_max3_u32 v52, v52, v41, v42
  v_max3_u32 v52, v52, v43, v44
  v_max3_u32 v52, v52, v45, v46
  v_max_u32 v52, v52, v47
  v_cmp_eq_u32 vcc, -1, v52
  s_mov_b32 s37, 1
  v_mov_b32 v48, 0
  v_mov_b32 v49, 0
  v_mov_b32 v50, 0
  v_mov_b32 v51, 0
  s_nop 1
  s_cbranch_vccz cA_va1_lp
  s_add_u32 s30, s30, 1
  s_cmp_lt_u32 s30, 400000
  s_cbranch_scc1 cA_va1_rv
  s_branch cA_abort
.p2align 6
cA_va2_loop:
  s_mov_b32 s30, 0
  buffer_load_dword v100, v119, s[8:11], 0 offen sc1
  buffer_load_dword v101, v119, s[8:11], 0 offen sc1
  buffer_load_dword v102, v119, s[8:11], 0 offen sc1
cA_va2_fp_l:
  s_waitcnt vmcnt(2)
  v_cmp_gt_u32 vcc, s19, v100
  s_cbranch_vccz cA_va2_fp_d
  buffer_load_dword v100, v119, s[8:11], 0 offen sc1
  s_waitcnt vmcnt(2)
  v_cmp_gt_u32 vcc, s19, v101
  s_cbranch_vccz cA_va2_fp_d
  buffer_load_dword v101, v119, s[8:11], 0 offen sc1
  s_waitcnt vmcnt(2)
  v_cmp_gt_u32 vcc, s19, v102
  s_cbranch_vccz cA_va2_fp_d
  buffer_load_dword v102, v119, s[8:11], 0 offen sc1
  s_add_u32 s30, s30, 1
  s_cmp_lt_u32 s30, 400000
  s_cbranch_scc1 cA_va2_fp_l
  s_branch cA_abort
cA_va2_fp_d:
  buffer_load_dwordx4 v[8:11], v2, s[8:11], s20 offen offset:0 sc1
  buffer_load_dwordx4 v[12:15], v2, s[8:11], s20 offen offset:1024 sc1
  s_barrier
  s_barrier
  s_waitcnt vmcnt(0)
  ds_write_b128 v2, v[8:11] offset:8192
  ds_write_b128 v2, v[12:15] offset:9216
  v_smfmac_f32_16x16x64_bf16 v[36:39], v[8:11], a[0:7], v3
  v_smfmac_f32_16x16x64_bf16 v[40:43], v[8:11], a[56:63], v3
  v_smfmac_f32_16x16x64_bf16 v[44:47], v[8:11], a[112:119], v3
  v_smfmac_f32_16x16x64_bf16 v[48:51], v[8:11], a[168:175], v3
  v_smfmac_f32_16x16x64_bf16 v[52:55], v[8:11], a[224:231], v3
  s_waitcnt lgkmcnt(0)
  s_barrier
  ds_read_b128 v[16:19], v2 offset:10240
  ds_read_b128 v[20:23], v2 offset:11264
  ds_read_b128 v[24:27], v2 offset:12288
  ds_read_b128 v[28:31], v2 offset:13312
  ds_read_b128 v[32:35], v2 offset:14336
  v_smfmac_f32_16x16x64_bf16 v[56:59], v[8:11], v[144:151], v3
  v_smfmac_f32_16x16x64_bf16 v[60:63], v[8:11], v[200:207], v3
  v_smfmac_f32_16x16x64_bf16 v[36:39], v[12:15], a[8:15], v3
  v_smfmac_f32_16x16x64_bf16 v[40:43], v[12:15], a[64:71], v3
  v_smfmac_f32_16x16x64_bf16 v[44:47], v[12:15], a[120:127], v3
  v_smfmac_f32_16x16x64_bf16 v[48:51], v[12:15], a[176:183], v3
  v_smfmac_f32_16x16x64_bf16 v[52:55], v[12:15], a[232:239], v3
  v_smfmac_f32_16x16x64_bf16 v[56:59], v[12:15], v[152:159], v3
  v_smfmac_f32_16x16x64_bf16 v[60:63], v[12:15], v[208:215], v3
  s_waitcnt lgkmcnt(4)
  v_smfmac_f32_16x16x64_bf16 v[36:39], v[16:19], a[16:23], v3
  s_waitcnt lgkmcnt(3)
  v_smfmac_f32_16x16x64_bf16 v[36:39], v[20:23], a[24:31], v3
  s_waitcnt lgkmcnt(2)
  v_smfmac_f32_16x16x64_bf16 v[36:39], v[24:27], a[32:39], v3
  s_waitcnt lgkmcnt(1)
  v_smfmac_f32_16x16x64_bf16 v[36:39], v[28:31], a[40:47], v3
  s_waitcnt lgkmcnt(0)
  v_smfmac_f32_16x16x64_bf16 v[36:39], v[32:35], a[48:55], v3
  v_smfmac_f32_16x16x64_bf16 v[40:43], v[16:19], a[72:79], v3
  v_smfmac_f32_16x16x64_bf16 v[40:43], v[20:23], a[80:87], v3
  v_smfmac_f32_16x16x64_bf16 v[40:43], v[24:27], a[88:95], v3
  v_permlane32_swap_b32 v36, v38
  v_smfmac_f32_16x16x64_bf16 v[40:43], v[28:31], a[96:103], v3
  v_permlane32_swap_b32 v37, v39
  v_smfmac_f32_16x16x64_bf16 v[40:43], v[32:35], a[104:111], v3
  v_add_f32 v36, v36, v38
  v_smfmac_f32_16x16x64_bf16 v[44:47], v[16:19], a[128:135], v3
  v_add_f32 v37, v37, v39
  v_smfmac_f32_16x16x64_bf16 v[44:47], v[20:23], a[136:143], v3
  v_cmp_u_f32 vcc, v36, v37
  v_smfmac_f32_16x16x64_bf16 v[44:47], v[24:27], a[144:151], v3
  v_cvt_pk_bf16_f32 v38, v36, v37
  v_smfmac_f32_16x16x64_bf16 v[44:47], v[28:31], a[152:159], v3
  ds_write_b32 v104, v38
  s_cbranch_vccnz cA_va2_slow
  v_permlane32_swap_b32 v40, v42
  v_smfmac_f32_16x16x64_bf16 v[44:47], v[32:35], a[160:167], v3
  v_permlane32_swap_b32 v41, v43
  v_smfmac_f32_16x16x64_bf16 v[48:51], v[16:19], a[184:191], v3
  v_add_f32 v40, v40, v42
  v_smfmac_f32_16x16x64_bf16 v[48:51], v[20:23], a[192:199], v3
  v_add_f32 v41, v41, v43
  v_smfmac_f32_16x16x64_bf16 v[48:51], v[24:27], a[200:207], v3
  v_cvt_pk_bf16_f32 v42, v40, v41
  v_smfmac_f32_16x16x64_bf16 v[48:51], v[28:31], a[208:215], v3
  ds_write_b32 v105, v42
  v_permlane32_swap_b32 v44, v46
  v_smfmac_f32_16x16x64_bf16 v[48:51], v[32:35], a[216:223], v3
  v_permlane32_swap_b32 v45, v47
  v_smfmac_f32_16x16x64_bf16 v[52:55], v[16:19], a[240:247], v3
  v_add_f32 v44, v44, v46
  v_smfmac_f32_16x16x64_bf16 v[52:55], v[20:23], a[248:255], v3
  v_add_f32 v45, v45, v47
  v_smfmac_f32_16x16x64_bf16 v[52:55], v[24:27], v[120:127], v3
  v_cvt_pk_bf16_f32 v46, v44, v45
  v_smfmac_f32_16x16x64_bf16 v[52:55], v[28:31], v[128:135], v3
  ds_write_b32 v106, v46
  v_permlane32_swap_b32 v48, v50
  v_smfmac_f32_16x16x64_bf16 v[52:55], v[32:35], v[136:143], v3
  v_permlane32_swap_b32 v49, v51
  v_smfmac_f32_16x16x64_bf16 v[56:59], v[16:19], v[160:167], v3
  v_add_f32 v48, v48, v50
  v_smfmac_f32_16x16x64_bf16 v[56:59], v[20:23], v[168:175], v3
  v_add_f32 v49, v49, v51
  v_smfmac_f32_16x16x64_bf16 v[56:59], v[24:27], v[176:183], v3
  v_cvt_pk_bf16_f32 v50, v48, v49
  v_smfmac_f32_16x16x64_bf16 v[56:59], v[28:31], v[184:191], v3
  ds_write_b32 v107, v50
  v_permlane32_swap_b32 v52, v54
  v_smfmac_f32_16x16x64_bf16 v[56:59], v[32:35], v[192:199], v3
  v_permlane32_swap_b32 v53, v55
  v_smfmac_f32_16x16x64_bf16 v[60:63], v[16:19], v[216:223], v3
  v_add_f32 v52, v52, v54
  v_smfmac_f32_16x16x64_bf16 v[60:63], v[20:23], v[224:231], v3
  v_add_f32 v53, v53, v55
  v_smfmac_f32_16x16x64_bf16 v[60:63], v[24:27], v[232:239], v3
  v_cvt_pk_bf16_f32 v54, v52, v53
  v_smfmac_f32_16x16x64_bf16 v[60:63], v[28:31], v[240:247], v3
  ds_write_b32 v108, v54
  v_permlane32_swap_b32 v56, v58
  v_smfmac_f32_16x16x64_bf16 v[60:63], v[32:35], v[248:255], v3
  v_permlane32_swap_b32 v57, v59
  v_add_f32 v56, v56, v58
  v_add_f32 v57, v57, v59
  v_cvt_pk_bf16_f32 v58, v56, v57
  ds_write_b32 v109, v58
  s_nop 2
  v_permlane32_swap_b32 v60, v62
  v_permlane32_swap_b32 v61, v63
  v_add_f32 v60, v60, v62
  v_add_f32 v61, v61, v63
  v_cvt_pk_bf16_f32 v62, v60, v61
  ds_write_b32 v110, v62
cA_va2_t2d:
  v_mov_b32 v117, s18
  s_waitcnt lgkmcnt(0)
  s_barrier
  s_cmp_eq_u32 s19, 62
  s_cbranch_scc1 cA_done
  s_sleep 1
  v_mov_b32 v36, 0
  v_mov_b32 v37, 0
  v_mov_b32 v38, 0
  v_mov_b32 v39, 0
  v_mov_b32 v40, 0
  v_mov_b32 v41, 0
  v_mov_b32 v42, 0
  v_mov_b32 v43, 0
  v_mov_b32 v44, 0
  v_mov_b32 v45, 0
  v_mov_b32 v46, 0
  v_mov_b32 v47, 0
  v_mov_b32 v48, 0
  v_mov_b32 v49, 0
  v_mov_b32 v50, 0
  v_mov_b32 v51, 0
  v_mov_b32 v52, 0
  v_mov_b32 v53, 0
  v_mov_b32 v54, 0
  v_mov_b32 v55, 0
  v_mov_b32 v56, 0
  v_mov_b32 v57, 0
  v_mov_b32 v58, 0
  v_mov_b32 v59, 0
  v_mov_b32 v60, 0
  v_mov_b32 v61, 0
  v_mov_b32 v62, 0
  v_mov_b32 v63, 0
  s_sleep 3
  s_mov_b32 s19, s18
  s_add_u32 s18, s18, 1
  s_mov_b32 s22, s20
  s_mov_b32 s20, s21
  s_mov_b32 s21, s22
  s_add_u32 s23, s20, 4096
  s_branch cA_va2_loop
cA_va2_slow:
  s_waitcnt lgkmcnt(0)
cA_va2_sl1:
  s_add_u32 s31, s31, 0x1000000
  buffer_load_dwordx4 v[8:11], v2, s[8:11], s20 offen offset:0 sc1
  buffer_load_dwordx4 v[12:15], v2, s[8:11], s20 offen offset:1024 sc1
  buffer_load_dwordx4 v[16:19], v2, s[8:11], s20 offen offset:2048 sc1
  buffer_load_dwordx4 v[20:23], v2, s[8:11], s20 offen offset:3072 sc1
  buffer_load_dwordx4 v[24:27], v2, s[8:11], s23 offen offset:0 sc1
  buffer_load_dwordx4 v[28:31], v2, s[8:11], s23 offen offset:1024 sc1
  buffer_load_dwordx4 v[32:35], v2, s[8:11], s23 offen offset:2048 sc1
  s_waitcnt vmcnt(0)
  v_max3_u32 v36, v8, v9, v10
  v_max3_u32 v36, v36, v11, v12
  v_max3_u32 v36, v36, v13, v14
  v_max3_u32 v36, v36, v15, v16
  v_max3_u32 v36, v36, v17, v18
  v_max3_u32 v36, v36, v19, v20
  v_max3_u32 v36, v36, v21, v22
  v_max3_u32 v36, v36, v23, v24
  v_max3_u32 v36, v36, v25, v26
  v_max3_u32 v36, v36, v27, v28
  v_max3_u32 v36, v36, v29, v30
  v_max3_u32 v36, v36, v31, v32
  v_max3_u32 v36, v36, v33, v34
  v_max_u32 v36, v36, v35
  v_cmp_eq_u32 vcc, -1, v36
  s_cbranch_vccz cA_va2_sl2
  s_add_u32 s30, s30, 1
  s_cmp_lt_u32 s30, 400000
  s_cbranch_scc1 cA_va2_sl1
  s_branch cA_abort
cA_va2_sl2:
  v_mov_b32 v36, 0
  v_mov_b32 v37, 0
  v_mov_b32 v38, 0
  v_mov_b32 v39, 0
  v_mov_b32 v40, 0
  v_mov_b32 v41, 0
  v_mov_b32 v42, 0
  v_mov_b32 v43, 0
  v_mov_b32 v44, 0
  v_mov_b32 v45, 0
  v_mov_b32 v46, 0
  v_mov_b32 v47, 0
  v_mov_b32 v48, 0
  v_mov_b32 v49, 0
  v_mov_b32 v50, 0
  v_mov_b32 v51, 0
  v_mov_b32 v52, 0
  v_mov_b32 v53, 0
  v_mov_b32 v54, 0
  v_mov_b32 v55, 0
  v_mov_b32 v56, 0
  v_mov_b32 v57, 0
  v_mov_b32 v58, 0
  v_mov_b32 v59, 0
  v_mov_b32 v60, 0
  v_mov_b32 v61, 0
  v_mov_b32 v62, 0
  v_mov_b32 v63, 0
  v_smfmac_f32_16x16x64_bf16 v[36:39], v[8:11], a[0:7], v3
  v_smfmac_f32_16x16x64_bf16 v[40:43], v[8:11], a[56:63], v3
  v_smfmac_f32_16x16x64_bf16 v[44:47], v[8:11], a[112:119], v3
  v_smfmac_f32_16x16x64_bf16 v[48:51], v[8:11], a[168:175], v3
  v_smfmac_f32_16x16x64_bf16 v[52:55], v[8:11], a[224:231], v3
  v_smfmac_f32_16x16x64_bf16 v[56:59], v[8:11], v[144:151], v3
  v_smfmac_f32_16x16x64_bf16 v[60:63], v[8:11], v[200:207], v3
  v_smfmac_f32_16x16x64_bf16 v[36:39], v[12:15], a[8:15], v3
  v_smfmac_f32_16x16x64_bf16 v[40:43], v[12:15], a[64:71], v3
  v_smfmac_f32_16x16x64_bf16 v[44:47], v[12:15], a[120:127], v3
  v_smfmac_f32_16x16x64_bf16 v[48:51], v[12:15], a[176:183], v3
  v_smfmac_f32_16x16x64_bf16 v[52:55], v[12:15], a[232:239], v3
  v_smfmac_f32_16x16x64_bf16 v[56:59], v[12:15], v[152:159], v3
  v_smfmac_f32_16x16x64_bf16 v[60:63], v[12:15], v[208:215], v3
  v_smfmac_f32_16x16x64_bf16 v[36:39], v[16:19], a[16:23], v3
  v_smfmac_f32_16x16x64_bf16 v[40:43], v[16:19], a[72:79], v3
  v_smfmac_f32_16x16x64_bf16 v[44:47], v[16:19], a[128:135], v3
  v_smfmac_f32_16x16x64_bf16 v[48:51], v[16:19], a[184:191], v3
  v_smfmac_f32_16x16x64_bf16 v[52:55], v[16:19], a[240:247], v3
  v_smfmac_f32_16x16x64_bf16 v[56:59], v[16:19], v[160:167], v3
  v_smfmac_f32_16x16x64_bf16 v[60:63], v[16:19], v[216:223], v3
  v_smfmac_f32_16x16x64_bf16 v[36:39], v[20:23], a[24:31], v3
  v_smfmac_f32_16x16x64_bf16 v[40:43], v[20:23], a[80:87], v3
  v_smfmac_f32_16x16x64_bf16 v[44:47], v[20:23], a[136:143], v3
  v_smfmac_f32_16x16x64_bf16 v[48:51], v[20:23], a[192:199], v3
  v_smfmac_f32_16x16x64_bf16 v[52:55], v[20:23], a[248:255], v3
  v_smfmac_f32_16x16x64_bf16 v[56:59], v[20:23], v[168:175], v3
  v_smfmac_f32_16x16x64_bf16 v[60:63], v[20:23], v[224:231], v3
  v_smfmac_f32_16x16x64_bf16 v[36:39], v[24:27], a[32:39], v3
  v_smfmac_f32_16x16x64_bf16 v[40:43], v[24:27], a[88:95], v3
  v_smfmac_f32_16x16x64_bf16 v[44:47], v[24:27], a[144:151], v3
  v_smfmac_f32_16x16x64_bf16 v[48:51], v[24:27], a[200:207], v3
  v_smfmac_f32_16x16x64_bf16 v[52:55], v[24:27], v[120:127], v3
  v_smfmac_f32_16x16x64_bf16 v[56:59], v[24:27], v[176:183], v3
  v_smfmac_f32_16x16x64_bf16 v[60:63], v[24:27], v[232:239], v3
  v_smfmac_f32_16x16x64_bf16 v[36:39], v[28:31], a[40:47], v3
  v_smfmac_f32_16x16x64_bf16 v[40:43], v[28:31], a[96:103], v3
  v_smfmac_f32_16x16x64_bf16 v[44:47], v[28:31], a[152:159], v3
  v_smfmac_f32_16x16x64_bf16 v[48:51], v[28:31], a[208:215], v3
  v_smfmac_f32_16x16x64_bf16 v[52:55], v[28:31], v[128:135], v3
  v_smfmac_f32_16x16x64_bf16 v[56:59], v[28:31], v[184:191], v3
  v_smfmac_f32_16x16x64_bf16 v[60:63], v[28:31], v[240:247], v3
  v_smfmac_f32_16x16x64_bf16 v[36:39], v[32:35], a[48:55], v3
  v_smfmac_f32_16x16x64_bf16 v[40:43], v[32:35], a[104:111], v3
  v_smfmac_f32_16x16x64_bf16 v[44:47], v[32:35], a[160:167], v3
  v_smfmac_f32_16x16x64_bf16 v[48:51], v[32:35], a[216:223], v3
  v_smfmac_f32_16x16x64_bf16 v[52:55], v[32:35], v[136:143], v3
  v_smfmac_f32_16x16x64_bf16 v[56:59], v[32:35], v[192:199], v3
  v_smfmac_f32_16x16x64_bf16 v[60:63], v[32:35], v[248:255], v3
  v_permlane32_swap_b32 v36, v38
  v_permlane32_swap_b32 v37, v39
  v_add_f32 v36, v36, v38
  v_add_f32 v37, v37, v39
  v_cvt_pk_bf16_f32 v38, v36, v37
  ds_write_b32 v104, v38
  v_permlane32_swap_b32 v40, v42
  v_permlane32_swap_b32 v41, v43
  v_add_f32 v40, v40, v42
  v_add_f32 v41, v41, v43
  v_cvt_pk_bf16_f32 v42, v40, v41
  ds_write_b32 v105, v42
  v_permlane32_swap_b32 v44, v46
  v_permlane32_swap_b32 v45, v47
  v_add_f32 v44, v44, v46
  v_add_f32 v45, v45, v47
  v_cvt_pk_bf16_f32 v46, v44, v45
  ds_write_b32 v106, v46
  v_permlane32_swap_b32 v48, v50
  v_permlane32_swap_b32 v49, v51
  v_add_f32 v48, v48, v50
  v_add_f32 v49, v49, v51
  v_cvt_pk_bf16_f32 v50, v48, v49
  ds_write_b32 v107, v50
  v_permlane32_swap_b32 v52, v54
  v_permlane32_swap_b32 v53, v55
  v_add_f32 v52, v52, v54
  v_add_f32 v53, v53, v55
  v_cvt_pk_bf16_f32 v54, v52, v53
  ds_write_b32 v108, v54
  v_permlane32_swap_b32 v56, v58
  v_permlane32_swap_b32 v57, v59
  v_add_f32 v56, v56, v58
  v_add_f32 v57, v57, v59
  v_cvt_pk_bf16_f32 v58, v56, v57
  ds_write_b32 v109, v58
  v_permlane32_swap_b32 v60, v62
  v_permlane32_swap_b32 v61, v63
  v_add_f32 v60, v60, v62
  v_add_f32 v61, v61, v63
  v_cvt_pk_bf16_f32 v62, v60, v61
  ds_write_b32 v110, v62
  s_branch cA_va2_t2d
.p2align 6
cA_va3_loop:
  s_mov_b32 s30, 0
  s_barrier
  buffer_load_dwordx4 v[16:19], v2, s[8:11], s20 offen offset:2048 sc1
  buffer_load_dwordx4 v[20:23], v2, s[8:11], s20 offen offset:3072 sc1
  s_barrier
  buffer_load_dword v100, v116, s[8:11], s39 offen sc1
  s_add_u32 s27, s19, 2
  s_min_u32 s27, s27, 63
  s_lshr_b32 s27, s27, 3
  s_lshl_b32 s27, s27, 6
  s_add_u32 s27, s27, s35
  buffer_load_dword v101, off, s[8:11], s27 sc1
  s_add_u32 s39, s39, 28672
  s_waitcnt vmcnt(2)
  ds_write_b128 v2, v[16:19] offset:10240
  ds_write_b128 v2, v[20:23] offset:11264
  v_smfmac_f32_16x16x64_bf16 v[36:39], v[16:19], a[16:23], v3
  v_smfmac_f32_16x16x64_bf16 v[40:43], v[16:19], a[72:79], v3
  v_smfmac_f32_16x16x64_bf16 v[44:47], v[16:19], a[128:135], v3
  v_smfmac_f32_16x16x64_bf16 v[48:51], v[16:19], a[184:191], v3
  v_smfmac_f32_16x16x64_bf16 v[52:55], v[16:19], a[240:247], v3
  s_waitcnt lgkmcnt(0)
  s_barrier
  ds_read_b128 v[8:11], v2 offset:8192
  ds_read_b128 v[12:15], v2 offset:9216
  ds_read_b128 v[24:27], v2 offset:12288
  ds_read_b128 v[28:31], v2 offset:13312
  ds_read_b128 v[32:35], v2 offset:14336
  v_smfmac_f32_16x16x64_bf16 v[56:59], v[16:19], v[160:167], v3
  v_smfmac_f32_16x16x64_bf16 v[60:63], v[16:19], v[216:223], v3
  v_smfmac_f32_16x16x64_bf16 v[36:39], v[20:23], a[24:31], v3
  v_smfmac_f32_16x16x64_bf16 v[40:43], v[20:23], a[80:87], v3
  v_smfmac_f32_16x16x64_bf16 v[44:47], v[20:23], a[136:143], v3
  v_smfmac_f32_16x16x64_bf16 v[48:51], v[20:23], a[192:199], v3
  v_smfmac_f32_16x16x64_bf16 v[52:55], v[20:23], a[248:255], v3
  v_smfmac_f32_16x16x64_bf16 v[56:59], v[20:23], v[168:175], v3
  v_smfmac_f32_16x16x64_bf16 v[60:63], v[20:23], v[224:231], v3
  s_waitcnt lgkmcnt(4)
  v_smfmac_f32_16x16x64_bf16 v[36:39], v[8:11], a[0:7], v3
  s_waitcnt lgkmcnt(3)
  v_smfmac_f32_16x16x64_bf16 v[36:39], v[12:15], a[8:15], v3
  s_waitcnt lgkmcnt(2)
  v_smfmac_f32_16x16x64_bf16 v[36:39], v[24:27], a[32:39], v3
  s_waitcnt lgkmcnt(1)
  v_smfmac_f32_16x16x64_bf16 v[36:39], v[28:31], a[40:47], v3
  s_waitcnt lgkmcnt(0)
  v_smfmac_f32_16x16x64_bf16 v[36:39], v[32:35], a[48:55], v3
  v_smfmac_f32_16x16x64_bf16 v[40:43], v[8:11], a[56:63], v3
  v_smfmac_f32_16x16x64_bf16 v[40:43], v[12:15], a[64:71], v3
  v_smfmac_f32_16x16x64_bf16 v[40:43], v[24:27], a[88:95], v3
  v_permlane32_swap_b32 v36, v38
  v_smfmac_f32_16x16x64_bf16 v[40:43], v[28:31], a[96:103], v3
  v_permlane32_swap_b32 v37, v39
  v_smfmac_f32_16x16x64_bf16 v[40:43], v[32:35], a[104:111], v3
  v_add_f32 v36, v36, v38
  v_smfmac_f32_16x16x64_bf16 v[44:47], v[8:11], a[112:119], v3
  v_add_f32 v37, v37, v39
  v_smfmac_f32_16x16x64_bf16 v[44:47], v[12:15], a[120:127], v3
  v_cmp_u_f32 vcc, v36, v37
  v_smfmac_f32_16x16x64_bf16 v[44:47], v[24:27], a[144:151], v3
  v_cvt_pk_bf16_f32 v38, v36, v37
  v_smfmac_f32_16x16x64_bf16 v[44:47], v[28:31], a[152:159], v3
  ds_write_b32 v104, v38
  s_cbranch_vccnz cA_va3_slow
  v_permlane32_swap_b32 v40, v42
  v_smfmac_f32_16x16x64_bf16 v[44:47], v[32:35], a[160:167], v3
  v_permlane32_swap_b32 v41, v43
  v_smfmac_f32_16x16x64_bf16 v[48:51], v[8:11], a[168:175], v3
  v_add_f32 v40, v40, v42
  v_smfmac_f32_16x16x64_bf16 v[48:51], v[12:15], a[176:183], v3
  v_add_f32 v41, v41, v43
  v_smfmac_f32_16x16x64_bf16 v[48:51], v[24:27], a[200:207], v3
  v_cvt_pk_bf16_f32 v42, v40, v41
  v_smfmac_f32_16x16x64_bf16 v[48:51], v[28:31], a[208:215], v3
  ds_write_b32 v105, v42
  v_permlane32_swap_b32 v44, v46
  v_smfmac_f32_16x16x64_bf16 v[48:51], v[32:35], a[216:223], v3
  v_permlane32_swap_b32 v45, v47
  v_smfmac_f32_16x16x64_bf16 v[52:55], v[8:11], a[224:231], v3
  v_add_f32 v44, v44, v46
  v_smfmac_f32_16x16x64_bf16 v[52:55], v[12:15], a[232:239], v3
  v_add_f32 v45, v45, v47
  v_smfmac_f32_16x16x64_bf16 v[52:55], v[24:27], v[120:127], v3
  v_cvt_pk_bf16_f32 v46, v44, v45
  v_smfmac_f32_16x16x64_bf16 v[52:55], v[28:31], v[128:135], v3
  ds_write_b32 v106, v46
  v_permlane32_swap_b32 v48, v50
  v_smfmac_f32_16x16x64_bf16 v[52:55], v[32:35], v[136:143], v3
  v_permlane32_swap_b32 v49, v51
  v_smfmac_f32_16x16x64_bf16 v[56:59], v[8:11], v[144:151], v3
  v_add_f32 v48, v48, v50
  v_smfmac_f32_16x16x64_bf16 v[56:59], v[12:15], v[152:159], v3
  v_add_f32 v49, v49, v51
  v_smfmac_f32_16x16x64_bf16 v[56:59], v[24:27], v[176:183], v3
  v_cvt_pk_bf16_f32 v50, v48, v49
  v_smfmac_f32_16x16x64_bf16 v[56:59], v[28:31], v[184:191], v3
  ds_write_b32 v107, v50
  v_permlane32_swap_b32 v52, v54
  v_smfmac_f32_16x16x64_bf16 v[56:59], v[32:35], v[192:199], v3
  v_permlane32_swap_b32 v53, v55
  v_smfmac_f32_16x16x64_bf16 v[60:63], v[8:11], v[200:207], v3
  v_add_f32 v52, v52, v54
  v_smfmac_f32_16x16x64_bf16 v[60:63], v[12:15], v[208:215], v3
  v_add_f32 v53, v53, v55
  v_smfmac_f32_16x16x64_bf16 v[60:63], v[24:27], v[232:239], v3
  v_cvt_pk_bf16_f32 v54, v52, v53
  v_smfmac_f32_16x16x64_bf16 v[60:63], v[28:31], v[240:247], v3
  ds_write_b32 v108, v54
  v_permlane32_swap_b32 v56, v58
  v_smfmac_f32_16x16x64_bf16 v[60:63], v[32:35], v[248:255], v3
  v_permlane32_swap_b32 v57, v59
  v_add_f32 v56, v56, v58
  v_add_f32 v57, v57, v59
  v_cvt_pk_bf16_f32 v58, v56, v57
  ds_write_b32 v109, v58
  s_nop 2
  v_permlane32_swap_b32 v60, v62
  v_permlane32_swap_b32 v61, v63
  v_add_f32 v60, v60, v62
  v_add_f32 v61, v61, v63
  v_cvt_pk_bf16_f32 v62, v60, v61
  ds_write_b32 v110, v62
cA_va3_t2d:
  v_mov_b32 v117, s18
cA_va3_vow:
  s_waitcnt vmcnt(0)
  v_cmp_ne_u32 vcc, 56, v101
  s_cbranch_vccnz cA_va3_vor
  s_waitcnt lgkmcnt(0)
  s_barrier
  v_mov_b32 v36, 0
  v_mov_b32 v37, 0
  v_mov_b32 v38, 0
  v_mov_b32 v39, 0
  v_mov_b32 v40, 0
  v_mov_b32 v41, 0
  v_mov_b32 v42, 0
  v_mov_b32 v43, 0
  buffer_store_dword v117, v118, s[8:11], 0 offen
  s_cmp_eq_u32 s19, 62
  s_cbranch_scc1 cA_done
  v_mov_b32 v44, 0
  v_mov_b32 v45, 0
  v_mov_b32 v46, 0
  v_mov_b32 v47, 0
  v_mov_b32 v48, 0
  v_mov_b32 v49, 0
  v_mov_b32 v50, 0
  v_mov_b32 v51, 0
  v_mov_b32 v52, 0
  v_mov_b32 v53, 0
  v_mov_b32 v54, 0
  v_mov_b32 v55, 0
  v_mov_b32 v56, 0
  v_mov_b32 v57, 0
  v_mov_b32 v58, 0
  v_mov_b32 v59, 0
  v_mov_b32 v60, 0
  v_mov_b32 v61, 0
  v_mov_b32 v62, 0
  v_mov_b32 v63, 0
  s_mov_b32 s19, s18
  s_add_u32 s18, s18, 1
  s_mov_b32 s22, s20
  s_mov_b32 s20, s21
  s_mov_b32 s21, s22
  s_add_u32 s23, s20, 4096
  s_branch cA_va3_loop
cA_va3_slow:
  s_waitcnt lgkmcnt(0)
cA_va3_sl1:
  s_add_u32 s31, s31, 0x1000000
  buffer_load_dwordx4 v[8:11], v2, s[8:11], s20 offen offset:0 sc1
  buffer_load_dwordx4 v[12:15], v2, s[8:11], s20 offen offset:1024 sc1
  buffer_load_dwordx4 v[16:19], v2, s[8:11], s20 offen offset:2048 sc1
  buffer_load_dwordx4 v[20:23], v2, s[8:11], s20 offen offset:3072 sc1
  buffer_load_dwordx4 v[24:27], v2, s[8:11], s23 offen offset:0 sc1
  buffer_load_dwordx4 v[28:31], v2, s[8:11], s23 offen offset:1024 sc1
  buffer_load_dwordx4 v[32:35], v2, s[8:11], s23 offen offset:2048 sc1
  s_waitcnt vmcnt(0)
  v_max3_u32 v36, v8, v9, v10
  v_max3_u32 v36, v36, v11, v12
  v_max3_u32 v36, v36, v13, v14
  v_max3_u32 v36, v36, v15, v16
  v_max3_u32 v36, v36, v17, v18
  v_max3_u32 v36, v36, v19, v20
  v_max3_u32 v36, v36, v21, v22
  v_max3_u32 v36, v36, v23, v24
  v_max3_u32 v36, v36, v25, v26
  v_max3_u32 v36, v36, v27, v28
  v_max3_u32 v36, v36, v29, v30
  v_max3_u32 v36, v36, v31, v32
  v_max3_u32 v36, v36, v33, v34
  v_max_u32 v36, v36, v35
  v_cmp_eq_u32 vcc, -1, v36
  s_cbranch_vccz cA_va3_sl2
  s_add_u32 s30, s30, 1
  s_cmp_lt_u32 s30, 400000
  s_cbranch_scc1 cA_va3_sl1
  s_branch cA_abort
cA_va3_sl2:
  v_mov_b32 v36, 0
  v_mov_b32 v37, 0
  v_mov_b32 v38, 0
  v_mov_b32 v39, 0
  v_mov_b32 v40, 0
  v_mov_b32 v41, 0
  v_mov_b32 v42, 0
  v_mov_b32 v43, 0
  v_mov_b32 v44, 0
  v_mov_b32 v45, 0
  v_mov_b32 v46, 0
  v_mov_b32 v47, 0
  v_mov_b32 v48, 0
  v_mov_b32 v49, 0
  v_mov_b32 v50, 0
  v_mov_b32 v51, 0
  v_mov_b32 v52, 0
  v_mov_b32 v53, 0
  v_mov_b32 v54, 0
  v_mov_b32 v55, 0
  v_mov_b32 v56, 0
  v_mov_b32 v57, 0
  v_mov_b32 v58, 0
  v_mov_b32 v59, 0
  v_mov_b32 v60, 0
  v_mov_b32 v61, 0
  v_mov_b32 v62, 0
  v_mov_b32 v63, 0
  v_smfmac_f32_16x16x64_bf16 v[36:39], v[8:11], a[0:7], v3
  v_smfmac_f32_16x16x64_bf16 v[40:43], v[8:11], a[56:63], v3
  v_smfmac_f32_16x16x64_bf16 v[44:47], v[8:11], a[112:119], v3
  v_smfmac_f32_16x16x64_bf16 v[48:51], v[8:11], a[168:175], v3
  v_smfmac_f32_16x16x64_bf16 v[52:55], v[8:11], a[224:231], v3
  v_smfmac_f32_16x16x64_bf16 v[56:59], v[8:11], v[144:151], v3
  v_smfmac_f32_16x16x64_bf16 v[60:63], v[8:11], v[200:207], v3
  v_smfmac_f32_16x16x64_bf16 v[36:39], v[12:15], a[8:15], v3
  v_smfmac_f32_16x16x64_bf16 v[40:43], v[12:15], a[64:71], v3
  v_smfmac_f32_16x16x64_bf16 v[44:47], v[12:15], a[120:127], v3
  v_smfmac_f32_16x16x64_bf16 v[48:51], v[12:15], a[176:183], v3
  v_smfmac_f32_16x16x64_bf16 v[52:55], v[12:15], a[232:239], v3
  v_smfmac_f32_16x16x64_bf16 v[56:59], v[12:15], v[152:159], v3
  v_smfmac_f32_16x16x64_bf16 v[60:63], v[12:15], v[208:215], v3
  v_smfmac_f32_16x16x64_bf16 v[36:39], v[16:19], a[16:23], v3
  v_smfmac_f32_16x16x64_bf16 v[40:43], v[16:19], a[72:79], v3
  v_smfmac_f32_16x16x64_bf16 v[44:47], v[16:19], a[128:135], v3
  v_smfmac_f32_16x16x64_bf16 v[48:51], v[16:19], a[184:191], v3
  v_smfmac_f32_16x16x64_bf16 v[52:55], v[16:19], a[240:247], v3
  v_smfmac_f32_16x16x64_bf16 v[56:59], v[16:19], v[160:167], v3
  v_smfmac_f32_16x16x64_bf16 v[60:63], v[16:19], v[216:223], v3
  v_smfmac_f32_16x16x64_bf16 v[36:39], v[20:23], a[24:31], v3
  v_smfmac_f32_16x16x64_bf16 v[40:43], v[20:23], a[80:87], v3
  v_smfmac_f32_16x16x64_bf16 v[44:47], v[20:23], a[136:143], v3
  v_smfmac_f32_16x16x64_bf16 v[48:51], v[20:23], a[192:199], v3
  v_smfmac_f32_16x16x64_bf16 v[52:55], v[20:23], a[248:255], v3
  v_smfmac_f32_16x16x64_bf16 v[56:59], v[20:23], v[168:175], v3
  v_smfmac_f32_16x16x64_bf16 v[60:63], v[20:23], v[224:231], v3
  v_smfmac_f32_16x16x64_bf16 v[36:39], v[24:27], a[32:39], v3
  v_smfmac_f32_16x16x64_bf16 v[40:43], v[24:27], a[88:95], v3
  v_smfmac_f32_16x16x64_bf16 v[44:47], v[24:27], a[144:151], v3
  v_smfmac_f32_16x16x64_bf16 v[48:51], v[24:27], a[200:207], v3
  v_smfmac_f32_16x16x64_bf16 v[52:55], v[24:27], v[120:127], v3
  v_smfmac_f32_16x16x64_bf16 v[56:59], v[24:27], v[176:183], v3
  v_smfmac_f32_16x16x64_bf16 v[60:63], v[24:27], v[232:239], v3
  v_smfmac_f32_16x16x64_bf16 v[36:39], v[28:31], a[40:47], v3
  v_smfmac_f32_16x16x64_bf16 v[40:43], v[28:31], a[96:103], v3
  v_smfmac_f32_16x16x64_bf16 v[44:47], v[28:31], a[152:159], v3
  v_smfmac_f32_16x16x64_bf16 v[48:51], v[28:31], a[208:215], v3
  v_smfmac_f32_16x16x64_bf16 v[52:55], v[28:31], v[128:135], v3
  v_smfmac_f32_16x16x64_bf16 v[56:59], v[28:31], v[184:191], v3
  v_smfmac_f32_16x16x64_bf16 v[60:63], v[28:31], v[240:247], v3
  v_smfmac_f32_16x16x64_bf16 v[36:39], v[32:35], a[48:55], v3
  v_smfmac_f32_16x16x64_bf16 v[40:43], v[32:35], a[104:111], v3
  v_smfmac_f32_16x16x64_bf16 v[44:47], v[32:35], a[160:167], v3
  v_smfmac_f32_16x16x64_bf16 v[48:51], v[32:35], a[216:223], v3
  v_smfmac_f32_16x16x64_bf16 v[52:55], v[32:35], v[136:143], v3
  v_smfmac_f32_16x16x64_bf16 v[56:59], v[32:35], v[192:199], v3
  v_smfmac_f32_16x16x64_bf16 v[60:63], v[32:35], v[248:255], v3
  v_permlane32_swap_b32 v36, v38
  v_permlane32_swap_b32 v37, v39
  v_add_f32 v36, v36, v38
  v_add_f32 v37, v37, v39
  v_cvt_pk_bf16_f32 v38, v36, v37
  ds_write_b32 v104, v38
  v_permlane32_swap_b32 v40, v42
  v_permlane32_swap_b32 v41, v43
  v_add_f32 v40, v40, v42
  v_add_f32 v41, v41, v43
  v_cvt_pk_bf16_f32 v42, v40, v41
  ds_write_b32 v105, v42
  v_permlane32_swap_b32 v44, v46
  v_permlane32_swap_b32 v45, v47
  v_add_f32 v44, v44, v46
  v_add_f32 v45, v45, v47
  v_cvt_pk_bf16_f32 v46, v44, v45
  ds_write_b32 v106, v46
  v_permlane32_swap_b32 v48, v50
  v_permlane32_swap_b32 v49, v51
  v_add_f32 v48, v48, v50
  v_add_f32 v49, v49, v51
  v_cvt_pk_bf16_f32 v50, v48, v49
  ds_write_b32 v107, v50
  v_permlane32_swap_b32 v52, v54
  v_permlane32_swap_b32 v53, v55
  v_add_f32 v52, v52, v54
  v_add_f32 v53, v53, v55
  v_cvt_pk_bf16_f32 v54, v52, v53
  ds_write_b32 v108, v54
  v_permlane32_swap_b32 v56, v58
  v_permlane32_swap_b32 v57, v59
  v_add_f32 v56, v56, v58
  v_add_f32 v57, v57, v59
  v_cvt_pk_bf16_f32 v58, v56, v57
  ds_write_b32 v109, v58
  v_permlane32_swap_b32 v60, v62
  v_permlane32_swap_b32 v61, v63
  v_add_f32 v60, v60, v62
  v_add_f32 v61, v61, v63
  v_cvt_pk_bf16_f32 v62, v60, v61
  ds_write_b32 v110, v62
  s_branch cA_va3_t2d
cA_va3_vor:
  s_sleep 2
  buffer_load_dword v101, off, s[8:11], s27 sc1
  s_add_u32 s30, s30, 1
  s_cmp_lt_u32 s30, 400000
  s_cbranch_scc1 cA_va3_vow
  s_branch cA_abort
cA_abort:
  v_mov_b32 v4, 0xdead
  v_mov_b32 v5, 16
  buffer_store_dword v4, v5, s[12:15], 0 offen
  s_branch ch_end
cA_done:
  s_branch ch_end
.p2align 6
cB_sc0_loop:
  s_mov_b32 s30, 0
  s_mov_b32 s62, 0
  s_setprio 3
  s_sleep 6
  buffer_load_dword v76, v0, s[8:11], 0 offen sc1
  buffer_load_dword v77, v0, s[8:11], 0 offen sc1
  buffer_load_dword v78, v0, s[8:11], 0 offen sc1
cB_sc0_fp_l:
  s_waitcnt vmcnt(2)
  v_cmp_gt_u32 vcc, s19, v76
  s_cbranch_vccz cB_sc0_fp_d
  buffer_load_dword v76, v0, s[8:11], 0 offen sc1
  s_waitcnt vmcnt(2)
  v_cmp_gt_u32 vcc, s19, v77
  s_cbranch_vccz cB_sc0_fp_d
  buffer_load_dword v77, v0, s[8:11], 0 offen sc1
  s_waitcnt vmcnt(2)
  v_cmp_gt_u32 vcc, s19, v78
  s_cbranch_vccz cB_sc0_fp_d
  buffer_load_dword v78, v0, s[8:11], 0 offen sc1
  s_add_u32 s30, s30, 1
  s_cmp_lt_u32 s30, 400000
  s_cbranch_scc1 cB_sc0_fp_l
  s_branch cB_abort
cB_sc0_fp_d:
  buffer_load_dwordx4 v[8:11], v2, s[8:11], s20 offen offset:0 sc1
  s_barrier
  s_setprio 2
  buffer_load_dwordx4 v[12:15], v2, s[8:11], s20 offen offset:1024 sc1
  s_setprio 1
  buffer_load_dwordx4 v[16:19], v2, s[8:11], s20 offen offset:2048 sc1
  s_setprio 0
  buffer_load_dwordx4 v[20:23], v2, s[8:11], s20 offen offset:3072 sc1
cB_sc0_go:
  s_waitcnt vmcnt(3)
  v_smfmac_f32_16x16x64_bf16 v[36:39], v[8:11], a[0:7], v3
  buffer_load_dwordx4 v[32:35], v2, s[8:11], s23 offen offset:0 sc1
  v_cmp_eq_u32 vcc, -1, v8
  v_smfmac_f32_16x16x64_bf16 v[40:43], v[8:11], a[56:63], v3
  v_smfmac_f32_16x16x64_bf16 v[44:47], v[8:11], a[112:119], v3
  buffer_load_dwordx4 v[24:27], v2, s[8:11], s23 offen offset:1024 sc1
  s_cbranch_vccnz cB_sc0_r0
  v_smfmac_f32_16x16x64_bf16 v[48:51], v[8:11], a[168:175], v3
  v_smfmac_f32_16x16x64_bf16 v[52:55], v[8:11], a[224:231], v3
  s_waitcnt vmcnt(4)
  v_cmp_eq_u32 vcc, -1, v12
  v_smfmac_f32_16x16x64_bf16 v[56:59], v[8:11], v[144:151], v3
  buffer_load_dwordx4 v[28:31], v2, s[8:11], s23 offen offset:2048 sc1
  v_smfmac_f32_16x16x64_bf16 v[60:63], v[8:11], v[200:207], v3
  s_cbranch_vccnz cB_sc0_r1
cB_sc0_c1:
  v_smfmac_f32_16x16x64_bf16 v[36:39], v[12:15], a[8:15], v3
  v_smfmac_f32_16x16x64_bf16 v[40:43], v[12:15], a[64:71], v3
  v_smfmac_f32_16x16x64_bf16 v[44:47], v[12:15], a[120:127], v3
  v_smfmac_f32_16x16x64_bf16 v[48:51], v[12:15], a[176:183], v3
  v_smfmac_f32_16x16x64_bf16 v[52:55], v[12:15], a[232:239], v3
  s_waitcnt vmcnt(4)
  v_cmp_eq_u32 vcc, -1, v16
  v_smfmac_f32_16x16x64_bf16 v[56:59], v[12:15], v[152:159], v3
  buffer_load_dwordx4 v[88:91], v117, s[8:11], s26 offen offset:0
  v_smfmac_f32_16x16x64_bf16 v[60:63], v[12:15], v[208:215], v3
  s_cbranch_vccnz cB_sc0_r2
cB_sc0_c2:
  v_smfmac_f32_16x16x64_bf16 v[36:39], v[16:19], a[16:23], v3
  v_smfmac_f32_16x16x64_bf16 v[40:43], v[16:19], a[72:79], v3
  v_smfmac_f32_16x16x64_bf16 v[44:47], v[16:19], a[128:135], v3
  buffer_load_dwordx4 v[92:95], v117, s[8:11], s26 offen offset:1024
  v_smfmac_f32_16x16x64_bf16 v[48:51], v[16:19], a[184:191], v3
  v_smfmac_f32_16x16x64_bf16 v[52:55], v[16:19], a[240:247], v3
  s_waitcnt vmcnt(5)
  v_cmp_eq_u32 vcc, -1, v20
  v_smfmac_f32_16x16x64_bf16 v[56:59], v[16:19], v[160:167], v3
  v_smfmac_f32_16x16x64_bf16 v[60:63], v[16:19], v[216:223], v3
  buffer_load_dwordx4 v[96:99], v2, s[8:11], s24 offen offset:0
  s_cbranch_vccnz cB_sc0_r3
cB_sc0_c3:
  v_smfmac_f32_16x16x64_bf16 v[36:39], v[20:23], a[24:31], v3
  v_smfmac_f32_16x16x64_bf16 v[40:43], v[20:23], a[80:87], v3
  s_waitcnt vmcnt(3)
  v_max3_u32 v66, v24, v27, v28
  v_smfmac_f32_16x16x64_bf16 v[44:47], v[20:23], a[136:143], v3
  v_max3_u32 v66, v66, v31, v32
  v_smfmac_f32_16x16x64_bf16 v[48:51], v[20:23], a[192:199], v3
  buffer_load_dwordx4 v[100:103], v2, s[8:11], s24 offen offset:1024
  v_max_u32 v66, v66, v35
  v_smfmac_f32_16x16x64_bf16 v[52:55], v[20:23], a[248:255], v3
  v_cmp_eq_u32 vcc, -1, v66
  v_smfmac_f32_16x16x64_bf16 v[56:59], v[20:23], v[168:175], v3
  v_smfmac_f32_16x16x64_bf16 v[60:63], v[20:23], v[224:231], v3
  s_cbranch_vccnz cB_sc0_r4
cB_sc0_c4:
  v_smfmac_f32_16x16x64_bf16 v[60:63], v[32:35], v[232:239], v3
  buffer_load_dwordx4 v[104:107], v2, s[8:11], s26 offen offset:0
  v_smfmac_f32_16x16x64_bf16 v[60:63], v[24:27], v[240:247], v3
  v_smfmac_f32_16x16x64_bf16 v[60:63], v[28:31], v[248:255], v3
  v_smfmac_f32_16x16x64_bf16 v[52:55], v[32:35], v[120:127], v3
  v_smfmac_f32_16x16x64_bf16 v[52:55], v[24:27], v[128:135], v3
  buffer_load_dwordx4 v[108:111], v2, s[8:11], s26 offen offset:1024
  v_smfmac_f32_16x16x64_bf16 v[52:55], v[28:31], v[136:143], v3
  v_cvt_pk_bf16_f32 v63, v62, v63
  v_smfmac_f32_16x16x64_bf16 v[56:59], v[32:35], v[176:183], v3
  v_cvt_pk_bf16_f32 v62, v60, v61
  v_smfmac_f32_16x16x64_bf16 v[56:59], v[24:27], v[184:191], v3
  v_mfma_f32_16x16x32_bf16 v[12:15], v[62:65], v[4:7], 0
  v_cvt_pk_bf16_f32 v55, v54, v55
  v_smfmac_f32_16x16x64_bf16 v[56:59], v[28:31], v[192:199], v3
  v_cvt_pk_bf16_f32 v54, v52, v53
  v_smfmac_f32_16x16x64_bf16 v[36:39], v[32:35], a[32:39], v3
  s_nop 1
  v_cvt_pk_bf16_f32 v76, v12, v13
  v_smfmac_f32_16x16x64_bf16 v[36:39], v[24:27], a[40:47], v3
  v_cvt_pk_bf16_f32 v77, v14, v15
  v_smfmac_f32_16x16x64_bf16 v[36:39], v[28:31], a[48:55], v3
  v_cvt_pk_bf16_f32 v56, v56, v57
  v_smfmac_f32_16x16x64_bf16 v[40:43], v[32:35], a[88:95], v3
  v_cvt_pk_bf16_f32 v57, v58, v59
  v_smfmac_f32_16x16x64_bf16 v[40:43], v[24:27], a[96:103], v3
  v_mfma_f32_16x16x32_bf16 v[16:19], v[54:57], v[4:7], 0
  v_cvt_pk_bf16_f32 v39, v38, v39
  v_smfmac_f32_16x16x64_bf16 v[40:43], v[28:31], a[104:111], v3
  v_cvt_pk_bf16_f32 v38, v36, v37
  v_smfmac_f32_16x16x64_bf16 v[44:47], v[32:35], a[144:151], v3
  s_nop 1
  v_cvt_pk_bf16_f32 v78, v16, v17
  v_smfmac_f32_16x16x64_bf16 v[44:47], v[24:27], a[152:159], v3
  v_cvt_pk_bf16_f32 v79, v18, v19
  v_smfmac_f32_16x16x64_bf16 v[44:47], v[28:31], a[160:167], v3
  v_cvt_pk_bf16_f32 v40, v40, v41
  v_smfmac_f32_16x16x64_bf16 v[48:51], v[32:35], a[200:207], v3
  v_cvt_pk_bf16_f32 v41, v42, v43
  v_smfmac_f32_16x16x64_bf16 v[48:51], v[24:27], a[208:215], v3
  v_smfmac_f32_16x16x64_bf16 v[48:51], v[28:31], a[216:223], v3
  s_waitcnt vmcnt(4)
  v_cvt_pk_bf16_f32 v47, v46, v47
  v_smfmac_f32_16x16x64_bf16 v[68:71], v[76:79], v[80:87], v3
  v_cvt_pk_bf16_f32 v46, v44, v45
  v_mfma_f32_16x16x32_bf16 v[12:15], v[38:41], v[4:7], 0
  s_nop 1
  v_cvt_pk_bf16_f32 v48, v48, v49
  v_cvt_pk_bf16_f32 v49, v50, v51
  s_nop 1
  v_mfma_f32_16x16x32_bf16 v[16:19], v[46:49], v[4:7], 0
  v_smfmac_f32_16x16x64_bf16 v[72:75], v[76:79], v[88:95], v3
  v_cvt_pk_bf16_f32 v20, v12, v13
  v_mfma_f32_16x16x32_bf16 v[52:55], v[30:33], v[76:79], 0
  s_waitcnt vmcnt(0)
  v_cvt_pk_bf16_f32 v21, v14, v15
  v_cvt_pk_bf16_f32 v22, v16, v17
  v_cvt_pk_bf16_f32 v23, v18, v19
  s_nop 1
  v_smfmac_f32_16x16x64_bf16 v[68:71], v[20:23], v[96:103], v3
  v_mfma_f32_16x16x32_bf16 v[52:55], v[8:11], v[20:23], v[52:55]
  v_smfmac_f32_16x16x64_bf16 v[72:75], v[20:23], v[104:111], v3
  s_nop 1
  v_permlane32_swap_b32 v68, v70
  v_permlane32_swap_b32 v69, v71
  v_add_f32 v56, v68, v70
  v_add_f32 v58, v69, v71
  ds_write_b128 v113, v[52:55]
  s_nop 0
  v_permlane32_swap_b32 v72, v74
  v_permlane32_swap_b32 v73, v75
  v_add_f32 v57, v72, v74
  v_add_f32 v59, v73, v75
  ds_write_b128 v2, v[56:59] offset:0
  v_cmp_u_f32 vcc, v57, v59
  v_mov_b32 v36, 0
  v_mov_b32 v37, 0
  v_mov_b32 v38, 0
  v_mov_b32 v39, 0
  s_cbranch_vccnz cB_sc0_retry
cB_sc0_cont:
  s_add_u32 s24, s24, 28672
  s_add_u32 s26, s26, 28672
  buffer_load_dwordx4 v[80:83], v117, s[8:11], s24 offen offset:0
  buffer_load_dwordx4 v[84:87], v117, s[8:11], s24 offen offset:1024
  v_mov_b32 v40, 0
  v_mov_b32 v41, 0
  v_mov_b32 v42, 0
  v_mov_b32 v43, 0
  v_mov_b32 v44, 0
  v_mov_b32 v45, 0
  v_mov_b32 v46, 0
  v_mov_b32 v47, 0
  v_mov_b32 v48, 0
  v_mov_b32 v49, 0
  v_mov_b32 v50, 0
  v_mov_b32 v51, 0
  s_waitcnt lgkmcnt(0)
  s_barrier
  ds_read_b64 v[8:9], v114 offset:0
  ds_read_b64 v[10:11], v114 offset:1024
  ds_read_b64 v[12:13], v114 offset:2048
  ds_read_b64 v[14:15], v114 offset:3072
  ds_read2_b32 v[16:17], v115 offset0:0 offset1:64
  ds_read2_b32 v[18:19], v115 offset0:128 offset1:192
  s_waitcnt lgkmcnt(0)
  v_pk_add_f32 v[16:17], v[16:17], v[18:19]
  v_pk_add_f32 v[8:9], v[8:9], v[10:11]
  v_pk_add_f32 v[12:13], v[12:13], v[14:15]
  v_add_f32 v20, v16, v17
  v_pk_add_f32 v[8:9], v[8:9], v[12:13]
  v_max_f32 v22, v8, v9
  v_add_f32_dpp v20, v20, v20 row_ror:8 row_mask:0xf bank_mask:0xf
  s_nop 0
  v_max_f32_dpp v22, v22, v22 row_ror:8 row_mask:0xf bank_mask:0xf
  v_max_f32 v22, v22, v20
  s_nop 1
  v_max_f32_dpp v22, v22, v22 quad_perm:[1,0,3,2] row_mask:0xf bank_mask:0xf
  s_nop 1
  v_max_f32_dpp v22, v22, v22 quad_perm:[2,3,0,1] row_mask:0xf bank_mask:0xf
  s_nop 1
  v_max_f32_dpp v22, v22, v22 row_half_mirror row_mask:0xf bank_mask:0xf
  v_pk_add_f32 v[8:9], v[8:9], v[22:23] op_sel_hi:[1,0] neg_lo:[0,1] neg_hi:[0,1]
  v_sub_f32 v20, v20, v22
  v_exp_f32 v8, v8
  v_exp_f32 v9, v9
  v_exp_f32 v20, v20
  v_add_f32 v24, v8, v9
  v_fmac_f32 v24, 0.5, v20
  v_mov_b32_dpp v21, v20 quad_perm:[1,0,3,2] row_mask:0xf bank_mask:0xf
  s_nop 0
  v_add_f32_dpp v24, v24, v24 quad_perm:[1,0,3,2] row_mask:0xf bank_mask:0xf
  s_nop 1
  v_add_f32_dpp v24, v24, v24 quad_perm:[2,3,0,1] row_mask:0xf bank_mask:0xf
  s_nop 1
  v_add_f32_dpp v24, v24, v24 row_half_mirror row_mask:0xf bank_mask:0xf
  s_nop 1
  v_add_f32_dpp v24, v24, v24 row_ror:8 row_mask:0xf bank_mask:0xf
  v_rcp_f32 v24, v24
  s_nop 0
  v_pk_mul_f32 v[8:9], v[8:9], v[24:25] op_sel_hi:[1,0]
  v_pk_mul_f32 v[20:21], v[20:21], v[24:25] op_sel_hi:[1,0]
  v_cvt_pk_bf16_f32 v8, v8, v9
  v_cvt_pk_bf16_f32 v20, v20, v21
  v_min_u32 v8, -2, v8
  buffer_store_dword v8, v1, s[8:11], s20 offen sc1
  v_min_u32 v20, -2, v20
  buffer_store_dword v20, v118, s[8:11], s20 offen sc1
  buffer_store_dword v119, v1, s[8:11], s21 offen sc1
  buffer_store_dword v119, v118, s[8:11], s21 offen sc1
  v_mov_b32 v60, 0
  v_mov_b32 v61, 0
  v_mov_b32 v62, 0
  v_mov_b32 v63, 0
  v_mov_b32 v68, 0
  v_mov_b32 v69, 0
  v_mov_b32 v70, 0
  v_mov_b32 v71, 0
  v_mov_b32 v72, 0
  v_mov_b32 v73, 0
  v_mov_b32 v74, 0
  v_mov_b32 v75, 0
  v_mov_b32 v52, 0
  v_mov_b32 v53, 0
  v_mov_b32 v54, 0
  v_mov_b32 v55, 0
  v_mov_b32 v56, 0
  v_mov_b32 v57, 0
  v_mov_b32 v58, 0
  v_mov_b32 v59, 0
  s_mov_b32 s19, s18
  s_add_u32 s18, s18, 1
  s_mov_b32 s22, s20
  s_mov_b32 s20, s21
  s_mov_b32 s21, s22
  s_add_u32 s23, s20, 4096
  s_cmp_lt_u32 s19, 63
  s_cbranch_scc1 cB_sc0_loop
  s_branch cB_done
cB_sc0_r0:
  s_add_u32 s31, s31, 1
  buffer_load_dwordx4 v[8:11], v2, s[8:11], s20 offen offset:0 sc1
  s_waitcnt vmcnt(0)
  v_cmp_eq_u32 vcc, -1, v8
  v_mov_b32 v36, 0
  v_mov_b32 v37, 0
  v_mov_b32 v38, 0
  v_mov_b32 v39, 0
  v_mov_b32 v40, 0
  v_mov_b32 v41, 0
  v_mov_b32 v42, 0
  v_mov_b32 v43, 0
  v_mov_b32 v44, 0
  v_mov_b32 v45, 0
  v_mov_b32 v46, 0
  v_mov_b32 v47, 0
  v_mov_b32 v48, 0
  v_mov_b32 v49, 0
  v_mov_b32 v50, 0
  v_mov_b32 v51, 0
  s_nop 1
  s_cbranch_vccz cB_sc0_go
  s_add_u32 s30, s30, 1
  s_cmp_lt_u32 s30, 400000
  s_cbranch_scc1 cB_sc0_r0
  s_branch cB_abort
cB_sc0_r1:
  s_add_u32 s31, s31, 1
  buffer_load_dwordx4 v[12:15], v2, s[8:11], s20 offen offset:1024 sc1
  s_waitcnt vmcnt(0)
  v_cmp_eq_u32 vcc, -1, v12
  s_nop 4
  s_cbranch_vccz cB_sc0_c1
  s_add_u32 s30, s30, 1
  s_cmp_lt_u32 s30, 400000
  s_cbranch_scc1 cB_sc0_r1
  s_branch cB_abort
cB_sc0_r2:
  s_add_u32 s31, s31, 1
  buffer_load_dwordx4 v[16:19], v2, s[8:11], s20 offen offset:2048 sc1
  s_waitcnt vmcnt(0)
  v_cmp_eq_u32 vcc, -1, v16
  s_nop 4
  s_cbranch_vccz cB_sc0_c2
  s_add_u32 s30, s30, 1
  s_cmp_lt_u32 s30, 400000
  s_cbranch_scc1 cB_sc0_r2
  s_branch cB_abort
cB_sc0_r3:
  s_add_u32 s31, s31, 1
  buffer_load_dwordx4 v[20:23], v2, s[8:11], s20 offen offset:3072 sc1
  s_waitcnt vmcnt(0)
  v_cmp_eq_u32 vcc, -1, v20
  s_nop 4
  s_cbranch_vccz cB_sc0_c3
  s_add_u32 s30, s30, 1
  s_cmp_lt_u32 s30, 400000
  s_cbranch_scc1 cB_sc0_r3
  s_branch cB_abort
cB_sc0_r4:
  s_add_u32 s31, s31, 1
  buffer_load_dwordx4 v[32:35], v2, s[8:11], s23 offen offset:0 sc1
  buffer_load_dwordx4 v[24:27], v2, s[8:11], s23 offen offset:1024 sc1
  buffer_load_dwordx4 v[28:31], v2, s[8:11], s23 offen offset:2048 sc1
  s_waitcnt vmcnt(0)
  v_max3_u32 v66, v24, v27, v28
  v_max3_u32 v66, v66, v31, v32
  v_max_u32 v66, v66, v35
  v_cmp_eq_u32 vcc, -1, v66
  s_nop 4
  s_cbranch_vccz cB_sc0_c4
  s_add_u32 s30, s30, 1
  s_cmp_lt_u32 s30, 400000
  s_cbranch_scc1 cB_sc0_r4
  s_branch cB_abort
cB_sc0_retry:
  s_cmp_lg_u32 s62, 0
  s_cbranch_scc1 cB_sc0_cont
  s_waitcnt vmcnt(0) lgkmcnt(0)
cB_sc0_rv:
  buffer_load_dwordx4 v[8:11], v2, s[8:11], s20 offen offset:0 sc1
  buffer_load_dwordx4 v[12:15], v2, s[8:11], s20 offen offset:1024 sc1
  buffer_load_dwordx4 v[16:19], v2, s[8:11], s20 offen offset:2048 sc1
  buffer_load_dwordx4 v[20:23], v2, s[8:11], s20 offen offset:3072 sc1
  buffer_load_dwordx4 v[32:35], v2, s[8:11], s23 offen offset:0 sc1
  buffer_load_dwordx4 v[24:27], v2, s[8:11], s23 offen offset:1024 sc1
  buffer_load_dwordx4 v[28:31], v2, s[8:11], s23 offen offset:2048 sc1
  s_waitcnt vmcnt(0)
  v_pk_max_u16 v66, v8, v9
  v_pk_max_u16 v66, v66, v10
  v_pk_max_u16 v66, v66, v11
  v_pk_max_u16 v66, v66, v12
  v_pk_max_u16 v66, v66, v13
  v_pk_max_u16 v66, v66, v14
  v_pk_max_u16 v66, v66, v15
  v_pk_max_u16 v66, v66, v16
  v_pk_max_u16 v66, v66, v17
  v_pk_max_u16 v66, v66, v18
  v_pk_max_u16 v66, v66, v19
  v_pk_max_u16 v66, v66, v20
  v_pk_max_u16 v66, v66, v21
  v_pk_max_u16 v66, v66, v22
  v_pk_max_u16 v66, v66, v23
  v_pk_max_u16 v66, v66, v24
  v_pk_max_u16 v66, v66, v25
  v_pk_max_u16 v66, v66, v26
  v_pk_max_u16 v66, v66, v27
  v_pk_max_u16 v66, v66, v28
  v_pk_max_u16 v66, v66, v29
  v_pk_max_u16 v66, v66, v30
  v_pk_max_u16 v66, v66, v31
  v_pk_max_u16 v66, v66, v32
  v_pk_max_u16 v66, v66, v33
  v_pk_max_u16 v66, v66, v34
  v_pk_max_u16 v66, v66, v35
  v_lshlrev_b32 v67, 16, v66
  v_max_u32 v66, v66, v67
  v_cmp_le_u32 vcc, 0xffff0000, v66
  s_cbranch_vccz cB_sc0_rk
  s_add_u32 s30, s30, 1
  s_cmp_lt_u32 s30, 400000
  s_cbranch_scc1 cB_sc0_rv
  s_branch cB_abort
cB_sc0_rk:
  s_mov_b32 s62, 1
  v_mov_b32 v36, 0
  v_mov_b32 v37, 0
  v_mov_b32 v38, 0
  v_mov_b32 v39, 0
  v_mov_b32 v40, 0
  v_mov_b32 v41, 0
  v_mov_b32 v42, 0
  v_mov_b32 v43, 0
  v_mov_b32 v44, 0
  v_mov_b32 v45, 0
  v_mov_b32 v46, 0
  v_mov_b32 v47, 0
  v_mov_b32 v48, 0
  v_mov_b32 v49, 0
  v_mov_b32 v50, 0
  v_mov_b32 v51, 0
  v_mov_b32 v60, 0
  v_mov_b32 v61, 0
  v_mov_b32 v62, 0
  v_mov_b32 v63, 0
  v_mov_b32 v68, 0
  v_mov_b32 v69, 0
  v_mov_b32 v70, 0
  v_mov_b32 v71, 0
  v_mov_b32 v72, 0
  v_mov_b32 v73, 0
  v_mov_b32 v74, 0
  v_mov_b32 v75, 0
  v_mov_b32 v52, 0
  v_mov_b32 v53, 0
  v_mov_b32 v54, 0
  v_mov_b32 v55, 0
  v_mov_b32 v56, 0
  v_mov_b32 v57, 0
  v_mov_b32 v58, 0
  v_mov_b32 v59, 0
  s_add_u32 s31, s31, 0x100
  s_nop 0
  s_branch cB_sc0_go
.p2align 6
cB_sc1_loop:
  s_mov_b32 s30, 0
  s_mov_b32 s62, 0
  s_setprio 3
  s_barrier
  buffer_load_dwordx4 v[8:11], v2, s[8:11], s20 offen offset:0 sc1
  s_setprio 2
  buffer_load_dwordx4 v[12:15], v2, s[8:11], s20 offen offset:1024 sc1
  s_setprio 1
  buffer_load_dwordx4 v[16:19], v2, s[8:11], s20 offen offset:2048 sc1
  s_setprio 0
  buffer_load_dwordx4 v[20:23], v2, s[8:11], s20 offen offset:3072 sc1
cB_sc1_go:
  s_waitcnt vmcnt(3)
  v_smfmac_f32_16x16x64_bf16 v[36:39], v[8:11], a[0:7], v3
  buffer_load_dwordx4 v[28:31], v2, s[8:11], s23 offen offset:0 sc1
  v_cmp_eq_u32 vcc, -1, v8
  v_smfmac_f32_16x16x64_bf16 v[40:43], v[8:11], a[56:63], v3
  v_smfmac_f32_16x16x64_bf16 v[44:47], v[8:11], a[112:119], v3
  buffer_load_dwordx4 v[24:27], v2, s[8:11], s23 offen offset:1024 sc1
  s_cbranch_vccnz cB_sc1_r0
  v_smfmac_f32_16x16x64_bf16 v[48:51], v[8:11], a[168:175], v3
  v_smfmac_f32_16x16x64_bf16 v[52:55], v[8:11], a[224:231], v3
  s_waitcnt vmcnt(4)
  v_cmp_eq_u32 vcc, -1, v12
  v_smfmac_f32_16x16x64_bf16 v[56:59], v[8:11], v[144:151], v3
  buffer_load_dwordx4 v[32:35], v2, s[8:11], s23 offen offset:2048 sc1
  v_smfmac_f32_16x16x64_bf16 v[60:63], v[8:11], v[200:207], v3
  s_cbranch_vccnz cB_sc1_r1
cB_sc1_c1:
  v_smfmac_f32_16x16x64_bf16 v[36:39], v[12:15], a[8:15], v3
  v_smfmac_f32_16x16x64_bf16 v[40:43], v[12:15], a[64:71], v3
  v_smfmac_f32_16x16x64_bf16 v[44:47], v[12:15], a[120:127], v3
  v_smfmac_f32_16x16x64_bf16 v[48:51], v[12:15], a[176:183], v3
  v_smfmac_f32_16x16x64_bf16 v[52:55], v[12:15], a[232:239], v3
  s_waitcnt vmcnt(4)
  v_cmp_eq_u32 vcc, -1, v16
  v_smfmac_f32_16x16x64_bf16 v[56:59], v[12:15], v[152:159], v3
  buffer_load_dwordx4 v[88:91], v117, s[8:11], s26 offen offset:0
  v_smfmac_f32_16x16x64_bf16 v[60:63], v[12:15], v[208:215], v3
  s_cbranch_vccnz cB_sc1_r2
cB_sc1_c2:
  v_smfmac_f32_16x16x64_bf16 v[36:39], v[16:19], a[16:23], v3
  v_smfmac_f32_16x16x64_bf16 v[40:43], v[16:19], a[72:79], v3
  v_smfmac_f32_16x16x64_bf16 v[44:47], v[16:19], a[128:135], v3
  buffer_load_dwordx4 v[92:95], v117, s[8:11], s26 offen offset:1024
  v_smfmac_f32_16x16x64_bf16 v[48:51], v[16:19], a[184:191], v3
  v_smfmac_f32_16x16x64_bf16 v[52:55], v[16:19], a[240:247], v3
  s_waitcnt vmcnt(5)
  v_cmp_eq_u32 vcc, -1, v20
  v_smfmac_f32_16x16x64_bf16 v[56:59], v[16:19], v[160:167], v3
  v_smfmac_f32_16x16x64_bf16 v[60:63], v[16:19], v[216:223], v3
  buffer_load_dwordx4 v[96:99], v2, s[8:11], s24 offen offset:0
  s_cbranch_vccnz cB_sc1_r3
cB_sc1_c3:
  v_smfmac_f32_16x16x64_bf16 v[36:39], v[20:23], a[24:31], v3
  v_smfmac_f32_16x16x64_bf16 v[40:43], v[20:23], a[80:87], v3
  s_waitcnt vmcnt(3)
  v_max3_u32 v66, v24, v27, v28
  v_smfmac_f32_16x16x64_bf16 v[44:47], v[20:23], a[136:143], v3
  v_max3_u32 v66, v66, v31, v32
  v_smfmac_f32_16x16x64_bf16 v[48:51], v[20:23], a[192:199], v3
  buffer_load_dwordx4 v[100:103], v2, s[8:11], s24 offen offset:1024
  v_max_u32 v66, v66, v35
  v_smfmac_f32_16x16x64_bf16 v[52:55], v[20:23], a[248:255], v3
  v_cmp_eq_u32 vcc, -1, v66
  v_smfmac_f32_16x16x64_bf16 v[56:59], v[20:23], v[168:175], v3
  v_smfmac_f32_16x16x64_bf16 v[60:63], v[20:23], v[224:231], v3
  s_cbranch_vccnz cB_sc1_r4
cB_sc1_c4:
  v_smfmac_f32_16x16x64_bf16 v[60:63], v[28:31], v[232:239], v3
  buffer_load_dwordx4 v[104:107], v2, s[8:11], s26 offen offset:0
  v_smfmac_f32_16x16x64_bf16 v[60:63], v[24:27], v[240:247], v3
  v_smfmac_f32_16x16x64_bf16 v[60:63], v[32:35], v[248:255], v3
  v_smfmac_f32_16x16x64_bf16 v[52:55], v[28:31], v[120:127], v3
  v_smfmac_f32_16x16x64_bf16 v[52:55], v[24:27], v[128:135], v3
  buffer_load_dwordx4 v[108:111], v2, s[8:11], s26 offen offset:1024
  v_smfmac_f32_16x16x64_bf16 v[52:55], v[32:35], v[136:143], v3
  v_cvt_pk_bf16_f32 v63, v62, v63
  v_smfmac_f32_16x16x64_bf16 v[56:59], v[28:31], v[176:183], v3
  v_cvt_pk_bf16_f32 v62, v60, v61
  v_smfmac_f32_16x16x64_bf16 v[56:59], v[24:27], v[184:191], v3
  v_mfma_f32_16x16x32_bf16 v[8:11], v[62:65], v[4:7], 0
  v_cvt_pk_bf16_f32 v55, v54, v55
  v_smfmac_f32_16x16x64_bf16 v[56:59], v[32:35], v[192:199], v3
  v_cvt_pk_bf16_f32 v54, v52, v53
  v_smfmac_f32_16x16x64_bf16 v[36:39], v[28:31], a[32:39], v3
  s_nop 1
  v_cvt_pk_bf16_f32 v78, v8, v9
  v_smfmac_f32_16x16x64_bf16 v[36:39], v[24:27], a[40:47], v3
  v_cvt_pk_bf16_f32 v79, v10, v11
  v_smfmac_f32_16x16x64_bf16 v[36:39], v[32:35], a[48:55], v3
  v_cvt_pk_bf16_f32 v56, v56, v57
  v_smfmac_f32_16x16x64_bf16 v[40:43], v[28:31], a[88:95], v3
  v_cvt_pk_bf16_f32 v57, v58, v59
  v_smfmac_f32_16x16x64_bf16 v[40:43], v[24:27], a[96:103], v3
  v_mfma_f32_16x16x32_bf16 v[16:19], v[54:57], v[4:7], 0
  v_cvt_pk_bf16_f32 v39, v38, v39
  v_smfmac_f32_16x16x64_bf16 v[40:43], v[32:35], a[104:111], v3
  v_cvt_pk_bf16_f32 v38, v36, v37
  v_smfmac_f32_16x16x64_bf16 v[44:47], v[28:31], a[144:151], v3
  s_nop 1
  v_cvt_pk_bf16_f32 v76, v16, v17
  v_smfmac_f32_16x16x64_bf16 v[44:47], v[24:27], a[152:159], v3
  v_cvt_pk_bf16_f32 v77, v18, v19
  v_smfmac_f32_16x16x64_bf16 v[44:47], v[32:35], a[160:167], v3
  v_cvt_pk_bf16_f32 v40, v40, v41
  v_smfmac_f32_16x16x64_bf16 v[48:51], v[28:31], a[200:207], v3
  v_cvt_pk_bf16_f32 v41, v42, v43
  v_smfmac_f32_16x16x64_bf16 v[48:51], v[24:27], a[208:215], v3
  v_smfmac_f32_16x16x64_bf16 v[48:51], v[32:35], a[216:223], v3
  s_waitcnt vmcnt(4)
  v_cvt_pk_bf16_f32 v47, v46, v47
  v_smfmac_f32_16x16x64_bf16 v[68:71], v[76:79], v[80:87], v3
  v_cvt_pk_bf16_f32 v46, v44, v45
  v_mfma_f32_16x16x32_bf16 v[8:11], v[38:41], v[4:7], 0
  s_nop 1
  v_cvt_pk_bf16_f32 v48, v48, v49
  v_cvt_pk_bf16_f32 v49, v50, v51
  s_nop 1
  v_mfma_f32_16x16x32_bf16 v[16:19], v[46:49], v[4:7], 0
  v_smfmac_f32_16x16x64_bf16 v[72:75], v[76:79], v[88:95], v3
  v_cvt_pk_bf16_f32 v20, v8, v9
  v_mfma_f32_16x16x32_bf16 v[52:55], v[30:33], v[76:79], 0
  s_waitcnt vmcnt(0)
  v_cvt_pk_bf16_f32 v21, v10, v11
  v_cvt_pk_bf16_f32 v22, v16, v17
  v_cvt_pk_bf16_f32 v23, v18, v19
  s_nop 1
  v_smfmac_f32_16x16x64_bf16 v[68:71], v[20:23], v[96:103], v3
  v_mfma_f32_16x16x32_bf16 v[52:55], v[12:15], v[20:23], v[52:55]
  v_smfmac_f32_16x16x64_bf16 v[72:75], v[20:23], v[104:111], v3
  s_nop 1
  v_permlane32_swap_b32 v68, v70
  v_permlane32_swap_b32 v69, v71
  v_add_f32 v56, v68, v70
  v_add_f32 v58, v69, v71
  ds_write_b128 v113, v[52:55]
  s_nop 0
  v_permlane32_swap_b32 v72, v74
  v_permlane32_swap_b32 v73, v75
  v_add_f32 v57, v72, v74
  v_add_f32 v59, v73, v75
  ds_write_b128 v2, v[56:59] offset:1024
  v_cmp_u_f32 vcc, v57, v59
  v_mov_b32 v36, 0
  v_mov_b32 v37, 0
  v_mov_b32 v38, 0
  v_mov_b32 v39, 0
  s_cbranch_vccnz cB_sc1_retry
cB_sc1_cont:
  s_add_u32 s24, s24, 28672
  s_add_u32 s26, s26, 28672
  buffer_load_dwordx4 v[80:83], v117, s[8:11], s24 offen offset:0
  buffer_load_dwordx4 v[84:87], v117, s[8:11], s24 offen offset:1024
  v_mov_b32 v40, 0
  v_mov_b32 v41, 0
  v_mov_b32 v42, 0
  v_mov_b32 v43, 0
  v_mov_b32 v44, 0
  v_mov_b32 v45, 0
  v_mov_b32 v46, 0
  v_mov_b32 v47, 0
  v_mov_b32 v48, 0
  v_mov_b32 v49, 0
  v_mov_b32 v50, 0
  v_mov_b32 v51, 0
  s_waitcnt lgkmcnt(0)
  s_barrier
  ds_read_b64 v[8:9], v114 offset:0
  ds_read_b64 v[10:11], v114 offset:1024
  ds_read_b64 v[12:13], v114 offset:2048
  ds_read_b64 v[14:15], v114 offset:3072
  ds_read2_b32 v[16:17], v115 offset0:0 offset1:64
  ds_read2_b32 v[18:19], v115 offset0:128 offset1:192
  s_waitcnt lgkmcnt(0)
  v_pk_add_f32 v[16:17], v[16:17], v[18:19]
  v_pk_add_f32 v[8:9], v[8:9], v[10:11]
  v_pk_add_f32 v[12:13], v[12:13], v[14:15]
  v_add_f32 v20, v16, v17
  v_pk_add_f32 v[8:9], v[8:9], v[12:13]
  v_max_f32 v22, v8, v9
  v_add_f32_dpp v20, v20, v20 row_ror:8 row_mask:0xf bank_mask:0xf
  s_nop 0
  v_max_f32_dpp v22, v22, v22 row_ror:8 row_mask:0xf bank_mask:0xf
  v_max_f32 v22, v22, v20
  s_nop 1
  v_max_f32_dpp v22, v22, v22 quad_perm:[1,0,3,2] row_mask:0xf bank_mask:0xf
  s_nop 1
  v_max_f32_dpp v22, v22, v22 quad_perm:[2,3,0,1] row_mask:0xf bank_mask:0xf
  s_nop 1
  v_max_f32_dpp v22, v22, v22 row_half_mirror row_mask:0xf bank_mask:0xf
  v_pk_add_f32 v[8:9], v[8:9], v[22:23] op_sel_hi:[1,0] neg_lo:[0,1] neg_hi:[0,1]
  v_sub_f32 v20, v20, v22
  v_exp_f32 v8, v8
  v_exp_f32 v9, v9
  v_exp_f32 v20, v20
  v_add_f32 v24, v8, v9
  v_fmac_f32 v24, 0.5, v20
  v_mov_b32_dpp v21, v20 quad_perm:[1,0,3,2] row_mask:0xf bank_mask:0xf
  s_nop 0
  v_add_f32_dpp v24, v24, v24 quad_perm:[1,0,3,2] row_mask:0xf bank_mask:0xf
  s_nop 1
  v_add_f32_dpp v24, v24, v24 quad_perm:[2,3,0,1] row_mask:0xf bank_mask:0xf
  s_nop 1
  v_add_f32_dpp v24, v24, v24 row_half_mirror row_mask:0xf bank_mask:0xf
  s_nop 1
  v_add_f32_dpp v24, v24, v24 row_ror:8 row_mask:0xf bank_mask:0xf
  v_rcp_f32 v24, v24
  s_nop 0
  v_pk_mul_f32 v[8:9], v[8:9], v[24:25] op_sel_hi:[1,0]
  v_pk_mul_f32 v[20:21], v[20:21], v[24:25] op_sel_hi:[1,0]
  v_cvt_pk_bf16_f32 v8, v8, v9
  v_cvt_pk_bf16_f32 v20, v20, v21
  v_min_u32 v8, -2, v8
  buffer_store_dword v8, v1, s[8:11], s20 offen sc1
  v_min_u32 v20, -2, v20
  buffer_store_dword v20, v118, s[8:11], s20 offen sc1
  buffer_store_dword v119, v1, s[8:11], s21 offen sc1
  buffer_store_dword v119, v118, s[8:11], s21 offen sc1
  v_mov_b32 v60, 0
  v_mov_b32 v61, 0
  v_mov_b32 v62, 0
  v_mov_b32 v63, 0
  v_mov_b32 v68, 0
  v_mov_b32 v69, 0
  v_mov_b32 v70, 0
  v_mov_b32 v71, 0
  v_mov_b32 v72, 0
  v_mov_b32 v73, 0
  v_mov_b32 v74, 0
  v_mov_b32 v75, 0
  v_mov_b32 v52, 0
  v_mov_b32 v53, 0
  v_mov_b32 v54, 0
  v_mov_b32 v55, 0
  v_mov_b32 v56, 0
  v_mov_b32 v57, 0
  v_mov_b32 v58, 0
  v_mov_b32 v59, 0
  s_mov_b32 s19, s18
  s_add_u32 s18, s18, 1
  s_mov_b32 s22, s20
  s_mov_b32 s20, s21
  s_mov_b32 s21, s22
  s_add_u32 s23, s20, 4096
  s_cmp_lt_u32 s19, 63
  s_cbranch_scc1 cB_sc1_loop
  s_branch cB_done
cB_sc1_r0:
  s_add_u32 s31, s31, 1
  buffer_load_dwordx4 v[8:11], v2, s[8:11], s20 offen offset:0 sc1
  s_waitcnt vmcnt(0)
  v_cmp_eq_u32 vcc, -1, v8
  v_mov_b32 v36, 0
  v_mov_b32 v37, 0
  v_mov_b32 v38, 0
  v_mov_b32 v39, 0
  v_mov_b32 v40, 0
  v_mov_b32 v41, 0
  v_mov_b32 v42, 0
  v_mov_b32 v43, 0
  v_mov_b32 v44, 0
  v_mov_b32 v45, 0
  v_mov_b32 v46, 0
  v_mov_b32 v47, 0
  v_mov_b32 v48, 0
  v_mov_b32 v49, 0
  v_mov_b32 v50, 0
  v_mov_b32 v51, 0
  s_nop 1
  s_cbranch_vccz cB_sc1_go
  s_add_u32 s30, s30, 1
  s_cmp_lt_u32 s30, 400000
  s_cbranch_scc1 cB_sc1_r0
  s_branch cB_abort
cB_sc1_r1:
  s_add_u32 s31, s31, 1
  buffer_load_dwordx4 v[12:15], v2, s[8:11], s20 offen offset:1024 sc1
  s_waitcnt vmcnt(0)
  v_cmp_eq_u32 vcc, -1, v12
  s_nop 4
  s_cbranch_vccz cB_sc1_c1
  s_add_u32 s30, s30, 1
  s_cmp_lt_u32 s30, 400000
  s_cbranch_scc1 cB_sc1_r1
  s_branch cB_abort
cB_sc1_r2:
  s_add_u32 s31, s31, 1
  buffer_load_dwordx4 v[16:19], v2, s[8:11], s20 offen offset:2048 sc1
  s_waitcnt vmcnt(0)
  v_cmp_eq_u32 vcc, -1, v16
  s_nop 4
  s_cbranch_vccz cB_sc1_c2
  s_add_u32 s30, s30, 1
  s_cmp_lt_u32 s30, 400000
  s_cbranch_scc1 cB_sc1_r2
  s_branch cB_abort
cB_sc1_r3:
  s_add_u32 s31, s31, 1
  buffer_load_dwordx4 v[20:23], v2, s[8:11], s20 offen offset:3072 sc1
  s_waitcnt vmcnt(0)
  v_cmp_eq_u32 vcc, -1, v20
  s_nop 4
  s_cbranch_vccz cB_sc1_c3
  s_add_u32 s30, s30, 1
  s_cmp_lt_u32 s30, 400000
  s_cbranch_scc1 cB_sc1_r3
  s_branch cB_abort
cB_sc1_r4:
  s_add_u32 s31, s31, 1
  buffer_load_dwordx4 v[28:31], v2, s[8:11], s23 offen offset:0 sc1
  buffer_load_dwordx4 v[24:27], v2, s[8:11], s23 offen offset:1024 sc1
  buffer_load_dwordx4 v[32:35], v2, s[8:11], s23 offen offset:2048 sc1
  s_waitcnt vmcnt(0)
  v_max3_u32 v66, v24, v27, v28
  v_max3_u32 v66, v66, v31, v32
  v_max_u32 v66, v66, v35
  v_cmp_eq_u32 vcc, -1, v66
  s_nop 4
  s_cbranch_vccz cB_sc1_c4
  s_add_u32 s30, s30, 1
  s_cmp_lt_u32 s30, 400000
  s_cbranch_scc1 cB_sc1_r4
  s_branch cB_abort
cB_sc1_retry:
  s_cmp_lg_u32 s62, 0
  s_cbranch_scc1 cB_sc1_cont
  s_waitcnt vmcnt(0) lgkmcnt(0)
cB_sc1_rv:
  buffer_load_dwordx4 v[8:11], v2, s[8:11], s20 offen offset:0 sc1
  buffer_load_dwordx4 v[12:15], v2, s[8:11], s20 offen offset:1024 sc1
  buffer_load_dwordx4 v[16:19], v2, s[8:11], s20 offen offset:2048 sc1
  buffer_load_dwordx4 v[20:23], v2, s[8:11], s20 offen offset:3072 sc1
  buffer_load_dwordx4 v[28:31], v2, s[8:11], s23 offen offset:0 sc1
  buffer_load_dwordx4 v[24:27], v2, s[8:11], s23 offen offset:1024 sc1
  buffer_load_dwordx4 v[32:35], v2, s[8:11], s23 offen offset:2048 sc1
  s_waitcnt vmcnt(0)
  v_pk_max_u16 v66, v8, v9
  v_pk_max_u16 v66, v66, v10
  v_pk_max_u16 v66, v66, v11
  v_pk_max_u16 v66, v66, v12
  v_pk_max_u16 v66, v66, v13
  v_pk_max_u16 v66, v66, v14
  v_pk_max_u16 v66, v66, v15
  v_pk_max_u16 v66, v66, v16
  v_pk_max_u16 v66, v66, v17
  v_pk_max_u16 v66, v66, v18
  v_pk_max_u16 v66, v66, v19
  v_pk_max_u16 v66, v66, v20
  v_pk_max_u16 v66, v66, v21
  v_pk_max_u16 v66, v66, v22
  v_pk_max_u16 v66, v66, v23
  v_pk_max_u16 v66, v66, v24
  v_pk_max_u16 v66, v66, v25
  v_pk_max_u16 v66, v66, v26
  v_pk_max_u16 v66, v66, v27
  v_pk_max_u16 v66, v66, v28
  v_pk_max_u16 v66, v66, v29
  v_pk_max_u16 v66, v66, v30
  v_pk_max_u16 v66, v66, v31
  v_pk_max_u16 v66, v66, v32
  v_pk_max_u16 v66, v66, v33
  v_pk_max_u16 v66, v66, v34
  v_pk_max_u16 v66, v66, v35
  v_lshlrev_b32 v67, 16, v66
  v_max_u32 v66, v66, v67
  v_cmp_le_u32 vcc, 0xffff0000, v66
  s_cbranch_vccz cB_sc1_rk
  s_add_u32 s30, s30, 1
  s_cmp_lt_u32 s30, 400000
  s_cbranch_scc1 cB_sc1_rv
  s_branch cB_abort
cB_sc1_rk:
  s_mov_b32 s62, 1
  v_mov_b32 v36, 0
  v_mov_b32 v37, 0
  v_mov_b32 v38, 0
  v_mov_b32 v39, 0
  v_mov_b32 v40, 0
  v_mov_b32 v41, 0
  v_mov_b32 v42, 0
  v_mov_b32 v43, 0
  v_mov_b32 v44, 0
  v_mov_b32 v45, 0
  v_mov_b32 v46, 0
  v_mov_b32 v47, 0
  v_mov_b32 v48, 0
  v_mov_b32 v49, 0
  v_mov_b32 v50, 0
  v_mov_b32 v51, 0
  v_mov_b32 v60, 0
  v_mov_b32 v61, 0
  v_mov_b32 v62, 0
  v_mov_b32 v63, 0
  v_mov_b32 v68, 0
  v_mov_b32 v69, 0
  v_mov_b32 v70, 0
  v_mov_b32 v71, 0
  v_mov_b32 v72, 0
  v_mov_b32 v73, 0
  v_mov_b32 v74, 0
  v_mov_b32 v75, 0
  v_mov_b32 v52, 0
  v_mov_b32 v53, 0
  v_mov_b32 v54, 0
  v_mov_b32 v55, 0
  v_mov_b32 v56, 0
  v_mov_b32 v57, 0
  v_mov_b32 v58, 0
  v_mov_b32 v59, 0
  s_add_u32 s31, s31, 0x100
  s_nop 0
  s_branch cB_sc1_go
.p2align 6
cB_sc2_loop:
  s_mov_b32 s30, 0
  s_mov_b32 s62, 0
  s_setprio 3
  s_barrier
  buffer_load_dwordx4 v[8:11], v2, s[8:11], s20 offen offset:0 sc1
  s_setprio 2
  buffer_load_dwordx4 v[12:15], v2, s[8:11], s20 offen offset:1024 sc1
  s_setprio 1
  buffer_load_dwordx4 v[16:19], v2, s[8:11], s20 offen offset:2048 sc1
  s_setprio 0
  buffer_load_dwordx4 v[20:23], v2, s[8:11], s20 offen offset:3072 sc1
cB_sc2_go:
  s_waitcnt vmcnt(3)
  v_smfmac_f32_16x16x64_bf16 v[36:39], v[8:11], a[0:7], v3
  buffer_load_dwordx4 v[24:27], v2, s[8:11], s23 offen offset:0 sc1
  v_cmp_eq_u32 vcc, -1, v8
  v_smfmac_f32_16x16x64_bf16 v[40:43], v[8:11], a[56:63], v3
  v_smfmac_f32_16x16x64_bf16 v[44:47], v[8:11], a[112:119], v3
  buffer_load_dwordx4 v[32:35], v2, s[8:11], s23 offen offset:1024 sc1
  s_cbranch_vccnz cB_sc2_r0
  v_smfmac_f32_16x16x64_bf16 v[48:51], v[8:11], a[168:175], v3
  v_smfmac_f32_16x16x64_bf16 v[52:55], v[8:11], a[224:231], v3
  s_waitcnt vmcnt(4)
  v_cmp_eq_u32 vcc, -1, v12
  v_smfmac_f32_16x16x64_bf16 v[56:59], v[8:11], v[144:151], v3
  buffer_load_dwordx4 v[28:31], v2, s[8:11], s23 offen offset:2048 sc1
  v_smfmac_f32_16x16x64_bf16 v[62:65], v[8:11], v[200:207], v3
  s_cbranch_vccnz cB_sc2_r1
cB_sc2_c1:
  v_smfmac_f32_16x16x64_bf16 v[36:39], v[12:15], a[8:15], v3
  v_smfmac_f32_16x16x64_bf16 v[40:43], v[12:15], a[64:71], v3
  v_smfmac_f32_16x16x64_bf16 v[44:47], v[12:15], a[120:127], v3
  v_smfmac_f32_16x16x64_bf16 v[48:51], v[12:15], a[176:183], v3
  v_smfmac_f32_16x16x64_bf16 v[52:55], v[12:15], a[232:239], v3
  s_waitcnt vmcnt(4)
  v_cmp_eq_u32 vcc, -1, v16
  v_smfmac_f32_16x16x64_bf16 v[56:59], v[12:15], v[152:159], v3
  buffer_load_dwordx4 v[88:91], v117, s[8:11], s26 offen offset:0
  v_smfmac_f32_16x16x64_bf16 v[62:65], v[12:15], v[208:215], v3
  s_cbranch_vccnz cB_sc2_r2
cB_sc2_c2:
  v_smfmac_f32_16x16x64_bf16 v[36:39], v[16:19], a[16:23], v3
  v_smfmac_f32_16x16x64_bf16 v[40:43], v[16:19], a[72:79], v3
  v_smfmac_f32_16x16x64_bf16 v[44:47], v[16:19], a[128:135], v3
  buffer_load_dwordx4 v[92:95], v117, s[8:11], s26 offen offset:1024
  v_smfmac_f32_16x16x64_bf16 v[48:51], v[16:19], a[184:191], v3
  v_smfmac_f32_16x16x64_bf16 v[52:55], v[16:19], a[240:247], v3
  s_waitcnt vmcnt(5)
  v_cmp_eq_u32 vcc, -1, v20
  v_smfmac_f32_16x16x64_bf16 v[56:59], v[16:19], v[160:167], v3
  v_smfmac_f32_16x16x64_bf16 v[62:65], v[16:19], v[216:223], v3
  buffer_load_dwordx4 v[96:99], v2, s[8:11], s24 offen offset:0
  s_cbranch_vccnz cB_sc2_r3
cB_sc2_c3:
  v_smfmac_f32_16x16x64_bf16 v[36:39], v[20:23], a[24:31], v3
  v_smfmac_f32_16x16x64_bf16 v[40:43], v[20:23], a[80:87], v3
  s_waitcnt vmcnt(3)
  v_max3_u32 v66, v24, v27, v28
  v_smfmac_f32_16x16x64_bf16 v[44:47], v[20:23], a[136:143], v3
  v_max3_u32 v66, v66, v31, v32
  v_smfmac_f32_16x16x64_bf16 v[48:51], v[20:23], a[192:199], v3
  buffer_load_dwordx4 v[100:103], v2, s[8:11], s24 offen offset:1024
  v_max_u32 v66, v66, v35
  v_smfmac_f32_16x16x64_bf16 v[52:55], v[20:23], a[248:255], v3
  v_cmp_eq_u32 vcc, -1, v66
  v_smfmac_f32_16x16x64_bf16 v[56:59], v[20:23], v[168:175], v3
  v_smfmac_f32_16x16x64_bf16 v[62:65], v[20:23], v[224:231], v3
  s_cbranch_vccnz cB_sc2_r4
cB_sc2_c4:
  v_smfmac_f32_16x16x64_bf16 v[62:65], v[24:27], v[232:239], v3
  buffer_load_dwordx4 v[104:107], v2, s[8:11], s26 offen offset:0
  v_smfmac_f32_16x16x64_bf16 v[62:65], v[32:35], v[240:247], v3
  v_smfmac_f32_16x16x64_bf16 v[62:65], v[28:31], v[248:255], v3
  v_smfmac_f32_16x16x64_bf16 v[52:55], v[24:27], v[120:127], v3
  v_smfmac_f32_16x16x64_bf16 v[52:55], v[32:35], v[128:135], v3
  buffer_load_dwordx4 v[108:111], v2, s[8:11], s26 offen offset:1024
  v_smfmac_f32_16x16x64_bf16 v[52:55], v[28:31], v[136:143], v3
  v_cvt_pk_bf16_f32 v62, v62, v63
  v_smfmac_f32_16x16x64_bf16 v[56:59], v[24:27], v[176:183], v3
  v_cvt_pk_bf16_f32 v63, v64, v65
  v_smfmac_f32_16x16x64_bf16 v[56:59], v[32:35], v[184:191], v3
  v_mfma_f32_16x16x32_bf16 v[8:11], v[60:63], v[4:7], 0
  v_cvt_pk_bf16_f32 v55, v54, v55
  v_smfmac_f32_16x16x64_bf16 v[56:59], v[28:31], v[192:199], v3
  v_cvt_pk_bf16_f32 v54, v52, v53
  v_smfmac_f32_16x16x64_bf16 v[36:39], v[24:27], a[32:39], v3
  s_nop 1
  v_cvt_pk_bf16_f32 v76, v8, v9
  v_smfmac_f32_16x16x64_bf16 v[36:39], v[32:35], a[40:47], v3
  v_cvt_pk_bf16_f32 v77, v10, v11
  v_smfmac_f32_16x16x64_bf16 v[36:39], v[28:31], a[48:55], v3
  v_cvt_pk_bf16_f32 v56, v56, v57
  v_smfmac_f32_16x16x64_bf16 v[40:43], v[24:27], a[88:95], v3
  v_cvt_pk_bf16_f32 v57, v58, v59
  v_smfmac_f32_16x16x64_bf16 v[40:43], v[32:35], a[96:103], v3
  v_mfma_f32_16x16x32_bf16 v[12:15], v[54:57], v[4:7], 0
  v_cvt_pk_bf16_f32 v39, v38, v39
  v_smfmac_f32_16x16x64_bf16 v[40:43], v[28:31], a[104:111], v3
  v_cvt_pk_bf16_f32 v38, v36, v37
  v_smfmac_f32_16x16x64_bf16 v[44:47], v[24:27], a[144:151], v3
  s_nop 1
  v_cvt_pk_bf16_f32 v78, v12, v13
  v_smfmac_f32_16x16x64_bf16 v[44:47], v[32:35], a[152:159], v3
  v_cvt_pk_bf16_f32 v79, v14, v15
  v_smfmac_f32_16x16x64_bf16 v[44:47], v[28:31], a[160:167], v3
  v_cvt_pk_bf16_f32 v40, v40, v41
  v_smfmac_f32_16x16x64_bf16 v[48:51], v[24:27], a[200:207], v3
  v_cvt_pk_bf16_f32 v41, v42, v43
  v_smfmac_f32_16x16x64_bf16 v[48:51], v[32:35], a[208:215], v3
  v_smfmac_f32_16x16x64_bf16 v[48:51], v[28:31], a[216:223], v3
  s_waitcnt vmcnt(4)
  v_cvt_pk_bf16_f32 v47, v46, v47
  v_smfmac_f32_16x16x64_bf16 v[68:71], v[76:79], v[80:87], v3
  v_cvt_pk_bf16_f32 v46, v44, v45
  v_mfma_f32_16x16x32_bf16 v[8:11], v[38:41], v[4:7], 0
  s_nop 1
  v_cvt_pk_bf16_f32 v48, v48, v49
  v_cvt_pk_bf16_f32 v49, v50, v51
  s_nop 1
  v_mfma_f32_16x16x32_bf16 v[12:15], v[46:49], v[4:7], 0
  v_smfmac_f32_16x16x64_bf16 v[72:75], v[76:79], v[88:95], v3
  v_cvt_pk_bf16_f32 v20, v8, v9
  v_mfma_f32_16x16x32_bf16 v[52:55], v[30:33], v[76:79], 0
  s_waitcnt vmcnt(0)
  v_cvt_pk_bf16_f32 v21, v10, v11
  v_cvt_pk_bf16_f32 v22, v12, v13
  v_cvt_pk_bf16_f32 v23, v14, v15
  s_nop 1
  v_smfmac_f32_16x16x64_bf16 v[68:71], v[20:23], v[96:103], v3
  v_mfma_f32_16x16x32_bf16 v[52:55], v[16:19], v[20:23], v[52:55]
  v_smfmac_f32_16x16x64_bf16 v[72:75], v[20:23], v[104:111], v3
  s_nop 1
  v_permlane32_swap_b32 v68, v70
  v_permlane32_swap_b32 v69, v71
  v_add_f32 v56, v68, v70
  v_add_f32 v58, v69, v71
  ds_write_b128 v113, v[52:55]
  s_nop 0
  v_permlane32_swap_b32 v72, v74
  v_permlane32_swap_b32 v73, v75
  v_add_f32 v57, v72, v74
  v_add_f32 v59, v73, v75
  ds_write_b128 v2, v[56:59] offset:2048
  v_cmp_u_f32 vcc, v57, v59
  v_mov_b32 v36, 0
  v_mov_b32 v37, 0
  v_mov_b32 v38, 0
  v_mov_b32 v39, 0
  s_cbranch_vccnz cB_sc2_retry
cB_sc2_cont:
  s_add_u32 s24, s24, 28672
  s_add_u32 s26, s26, 28672
  buffer_load_dwordx4 v[80:83], v117, s[8:11], s24 offen offset:0
  buffer_load_dwordx4 v[84:87], v117, s[8:11], s24 offen offset:1024
  v_mov_b32 v40, 0
  v_mov_b32 v41, 0
  v_mov_b32 v42, 0
  v_mov_b32 v43, 0
  v_mov_b32 v44, 0
  v_mov_b32 v45, 0
  v_mov_b32 v46, 0
  v_mov_b32 v47, 0
  v_mov_b32 v48, 0
  v_mov_b32 v49, 0
  v_mov_b32 v50, 0
  v_mov_b32 v51, 0
  s_waitcnt lgkmcnt(0)
  s_barrier
  v_mov_b32 v62, 0
  v_mov_b32 v63, 0
  v_mov_b32 v64, 0
  v_mov_b32 v65, 0
  v_mov_b32 v68, 0
  v_mov_b32 v69, 0
  v_mov_b32 v70, 0
  v_mov_b32 v71, 0
  v_mov_b32 v72, 0
  v_mov_b32 v73, 0
  v_mov_b32 v74, 0
  v_mov_b32 v75, 0
  v_mov_b32 v52, 0
  v_mov_b32 v53, 0
  v_mov_b32 v54, 0
  v_mov_b32 v55, 0
  v_mov_b32 v56, 0
  v_mov_b32 v57, 0
  v_mov_b32 v58, 0
  v_mov_b32 v59, 0
  v_mov_b32 v66, 0
  v_mov_b32 v66, 0
  v_mov_b32 v66, 0
  v_mov_b32 v66, 0
  v_mov_b32 v66, 0
  v_mov_b32 v66, 0
  v_mov_b32 v66, 0
  v_mov_b32 v66, 0
  v_mov_b32 v66, 0
  v_mov_b32 v66, 0
  buffer_store_dword v119, v1, s[8:11], 0 offen sc1
  s_mov_b32 s19, s18
  s_add_u32 s18, s18, 1
  s_mov_b32 s22, s20
  s_mov_b32 s20, s21
  s_mov_b32 s21, s22
  s_add_u32 s23, s20, 4096
  v_mov_b32 v119, s18
  s_cmp_lt_u32 s19, 63
  s_nop 0
  s_cbranch_scc1 cB_sc2_loop
  s_branch cB_done
cB_sc2_r0:
  s_add_u32 s31, s31, 1
  buffer_load_dwordx4 v[8:11], v2, s[8:11], s20 offen offset:0 sc1
  s_waitcnt vmcnt(0)
  v_cmp_eq_u32 vcc, -1, v8
  v_mov_b32 v36, 0
  v_mov_b32 v37, 0
  v_mov_b32 v38, 0
  v_mov_b32 v39, 0
  v_mov_b32 v40, 0
  v_mov_b32 v41, 0
  v_mov_b32 v42, 0
  v_mov_b32 v43, 0
  v_mov_b32 v44, 0
  v_mov_b32 v45, 0
  v_mov_b32 v46, 0
  v_mov_b32 v47, 0
  v_mov_b32 v48, 0
  v_mov_b32 v49, 0
  v_mov_b32 v50, 0
  v_mov_b32 v51, 0
  s_nop 1
  s_cbranch_vccz cB_sc2_go
  s_add_u32 s30, s30, 1
  s_cmp_lt_u32 s30, 400000
  s_cbranch_scc1 cB_sc2_r0
  s_branch cB_abort
cB_sc2_r1:
  s_add_u32 s31, s31, 1
  buffer_load_dwordx4 v[12:15], v2, s[8:11], s20 offen offset:1024 sc1
  s_waitcnt vmcnt(0)
  v_cmp_eq_u32 vcc, -1, v12
  s_nop 4
  s_cbranch_vccz cB_sc2_c1
  s_add_u32 s30, s30, 1
  s_cmp_lt_u32 s30, 400000
  s_cbranch_scc1 cB_sc2_r1
  s_branch cB_abort
cB_sc2_r2:
  s_add_u32 s31, s31, 1
  buffer_load_dwordx4 v[16:19], v2, s[8:11], s20 offen offset:2048 sc1
  s_waitcnt vmcnt(0)
  v_cmp_eq_u32 vcc, -1, v16
  s_nop 4
  s_cbranch_vccz cB_sc2_c2
  s_add_u32 s30, s30, 1
  s_cmp_lt_u32 s30, 400000
  s_cbranch_scc1 cB_sc2_r2
  s_branch cB_abort
cB_sc2_r3:
  s_add_u32 s31, s31, 1
  buffer_load_dwordx4 v[20:23], v2, s[8:11], s20 offen offset:3072 sc1
  s_waitcnt vmcnt(0)
  v_cmp_eq_u32 vcc, -1, v20
  s_nop 4
  s_cbranch_vccz cB_sc2_c3
  s_add_u32 s30, s30, 1
  s_cmp_lt_u32 s30, 400000
  s_cbranch_scc1 cB_sc2_r3
  s_branch cB_abort
cB_sc2_r4:
  s_add_u32 s31, s31, 1
  buffer_load_dwordx4 v[24:27], v2, s[8:11], s23 offen offset:0 sc1
  buffer_load_dwordx4 v[32:35], v2, s[8:11], s23 offen offset:1024 sc1
  buffer_load_dwordx4 v[28:31], v2, s[8:11], s23 offen offset:2048 sc1
  s_waitcnt vmcnt(0)
  v_max3_u32 v66, v24, v27, v28
  v_max3_u32 v66, v66, v31, v32
  v_max_u32 v66, v66, v35
  v_cmp_eq_u32 vcc, -1, v66
  s_nop 4
  s_cbranch_vccz cB_sc2_c4
  s_add_u32 s30, s30, 1
  s_cmp_lt_u32 s30, 400000
  s_cbranch_scc1 cB_sc2_r4
  s_branch cB_abort
cB_sc2_retry:
  s_cmp_lg_u32 s62, 0
  s_cbranch_scc1 cB_sc2_cont
  s_waitcnt vmcnt(0) lgkmcnt(0)
cB_sc2_rv:
  buffer_load_dwordx4 v[8:11], v2, s[8:11], s20 offen offset:0 sc1
  buffer_load_dwordx4 v[12:15], v2, s[8:11], s20 offen offset:1024 sc1
  buffer_load_dwordx4 v[16:19], v2, s[8:11], s20 offen offset:2048 sc1
  buffer_load_dwordx4 v[20:23], v2, s[8:11], s20 offen offset:3072 sc1
  buffer_load_dwordx4 v[24:27], v2, s[8:11], s23 offen offset:0 sc1
  buffer_load_dwordx4 v[32:35], v2, s[8:11], s23 offen offset:1024 sc1
  buffer_load_dwordx4 v[28:31], v2, s[8:11], s23 offen offset:2048 sc1
  s_waitcnt vmcnt(0)
  v_pk_max_u16 v66, v8, v9
  v_pk_max_u16 v66, v66, v10
  v_pk_max_u16 v66, v66, v11
  v_pk_max_u16 v66, v66, v12
  v_pk_max_u16 v66, v66, v13
  v_pk_max_u16 v66, v66, v14
  v_pk_max_u16 v66, v66, v15
  v_pk_max_u16 v66, v66, v16
  v_pk_max_u16 v66, v66, v17
  v_pk_max_u16 v66, v66, v18
  v_pk_max_u16 v66, v66, v19
  v_pk_max_u16 v66, v66, v20
  v_pk_max_u16 v66, v66, v21
  v_pk_max_u16 v66, v66, v22
  v_pk_max_u16 v66, v66, v23
  v_pk_max_u16 v66, v66, v24
  v_pk_max_u16 v66, v66, v25
  v_pk_max_u16 v66, v66, v26
  v_pk_max_u16 v66, v66, v27
  v_pk_max_u16 v66, v66, v28
  v_pk_max_u16 v66, v66, v29
  v_pk_max_u16 v66, v66, v30
  v_pk_max_u16 v66, v66, v31
  v_pk_max_u16 v66, v66, v32
  v_pk_max_u16 v66, v66, v33
  v_pk_max_u16 v66, v66, v34
  v_pk_max_u16 v66, v66, v35
  v_lshlrev_b32 v67, 16, v66
  v_max_u32 v66, v66, v67
  v_cmp_le_u32 vcc, 0xffff0000, v66
  s_cbranch_vccz cB_sc2_rk
  s_add_u32 s30, s30, 1
  s_cmp_lt_u32 s30, 400000
  s_cbranch_scc1 cB_sc2_rv
  s_branch cB_abort
cB_sc2_rk:
  s_mov_b32 s62, 1
  v_mov_b32 v36, 0
  v_mov_b32 v37, 0
  v_mov_b32 v38, 0
  v_mov_b32 v39, 0
  v_mov_b32 v40, 0
  v_mov_b32 v41, 0
  v_mov_b32 v42, 0
  v_mov_b32 v43, 0
  v_mov_b32 v44, 0
  v_mov_b32 v45, 0
  v_mov_b32 v46, 0
  v_mov_b32 v47, 0
  v_mov_b32 v48, 0
  v_mov_b32 v49, 0
  v_mov_b32 v50, 0
  v_mov_b32 v51, 0
  v_mov_b32 v62, 0
  v_mov_b32 v63, 0
  v_mov_b32 v64, 0
  v_mov_b32 v65, 0
  v_mov_b32 v68, 0
  v_mov_b32 v69, 0
  v_mov_b32 v70, 0
  v_mov_b32 v71, 0
  v_mov_b32 v72, 0
  v_mov_b32 v73, 0
  v_mov_b32 v74, 0
  v_mov_b32 v75, 0
  v_mov_b32 v52, 0
  v_mov_b32 v53, 0
  v_mov_b32 v54, 0
  v_mov_b32 v55, 0
  v_mov_b32 v56, 0
  v_mov_b32 v57, 0
  v_mov_b32 v58, 0
  v_mov_b32 v59, 0
  s_add_u32 s31, s31, 0x100
  s_nop 0
  s_branch cB_sc2_go
.p2align 6
cB_sc3_loop:
  s_mov_b32 s30, 0
  s_mov_b32 s62, 0
  s_setprio 3
  s_barrier
  buffer_load_dwordx4 v[8:11], v2, s[8:11], s20 offen offset:0 sc1
  s_setprio 2
  buffer_load_dwordx4 v[12:15], v2, s[8:11], s20 offen offset:1024 sc1
  s_setprio 1
  buffer_load_dwordx4 v[16:19], v2, s[8:11], s20 offen offset:2048 sc1
  s_setprio 0
  buffer_load_dwordx4 v[20:23], v2, s[8:11], s20 offen offset:3072 sc1
cB_sc3_go:
  s_waitcnt vmcnt(3)
  v_smfmac_f32_16x16x64_bf16 v[36:39], v[8:11], a[0:7], v3
  buffer_load_dwordx4 v[24:27], v2, s[8:11], s23 offen offset:0 sc1
  v_cmp_eq_u32 vcc, -1, v8
  v_smfmac_f32_16x16x64_bf16 v[40:43], v[8:11], a[56:63], v3
  v_smfmac_f32_16x16x64_bf16 v[44:47], v[8:11], a[112:119], v3
  buffer_load_dwordx4 v[28:31], v2, s[8:11], s23 offen offset:1024 sc1
  s_cbranch_vccnz cB_sc3_r0
  v_smfmac_f32_16x16x64_bf16 v[48:51], v[8:11], a[168:175], v3
  v_smfmac_f32_16x16x64_bf16 v[52:55], v[8:11], a[224:231], v3
  s_waitcnt vmcnt(4)
  v_cmp_eq_u32 vcc, -1, v12
  v_smfmac_f32_16x16x64_bf16 v[56:59], v[8:11], v[144:151], v3
  buffer_load_dwordx4 v[32:35], v2, s[8:11], s23 offen offset:2048 sc1
  v_smfmac_f32_16x16x64_bf16 v[62:65], v[8:11], v[200:207], v3
  s_cbranch_vccnz cB_sc3_r1
cB_sc3_c1:
  v_smfmac_f32_16x16x64_bf16 v[36:39], v[12:15], a[8:15], v3
  v_smfmac_f32_16x16x64_bf16 v[40:43], v[12:15], a[64:71], v3
  v_smfmac_f32_16x16x64_bf16 v[44:47], v[12:15], a[120:127], v3
  v_smfmac_f32_16x16x64_bf16 v[48:51], v[12:15], a[176:183], v3
  v_smfmac_f32_16x16x64_bf16 v[52:55], v[12:15], a[232:239], v3
  s_waitcnt vmcnt(4)
  v_cmp_eq_u32 vcc, -1, v16
  v_smfmac_f32_16x16x64_bf16 v[56:59], v[12:15], v[152:159], v3
  buffer_load_dwordx4 v[88:91], v117, s[8:11], s26 offen offset:0
  v_smfmac_f32_16x16x64_bf16 v[62:65], v[12:15], v[208:215], v3
  s_cbranch_vccnz cB_sc3_r2
cB_sc3_c2:
  v_smfmac_f32_16x16x64_bf16 v[36:39], v[16:19], a[16:23], v3
  v_smfmac_f32_16x16x64_bf16 v[40:43], v[16:19], a[72:79], v3
  v_smfmac_f32_16x16x64_bf16 v[44:47], v[16:19], a[128:135], v3
  buffer_load_dwordx4 v[92:95], v117, s[8:11], s26 offen offset:1024
  v_smfmac_f32_16x16x64_bf16 v[48:51], v[16:19], a[184:191], v3
  v_smfmac_f32_16x16x64_bf16 v[52:55], v[16:19], a[240:247], v3
  s_waitcnt vmcnt(5)
  v_cmp_eq_u32 vcc, -1, v20
  v_smfmac_f32_16x16x64_bf16 v[56:59], v[16:19], v[160:167], v3
  v_smfmac_f32_16x16x64_bf16 v[62:65], v[16:19], v[216:223], v3
  buffer_load_dwordx4 v[96:99], v2, s[8:11], s24 offen offset:0
  s_cbranch_vccnz cB_sc3_r3
cB_sc3_c3:
  v_smfmac_f32_16x16x64_bf16 v[36:39], v[20:23], a[24:31], v3
  v_smfmac_f32_16x16x64_bf16 v[40:43], v[20:23], a[80:87], v3
  s_waitcnt vmcnt(3)
  v_max3_u32 v66, v24, v27, v28
  v_smfmac_f32_16x16x64_bf16 v[44:47], v[20:23], a[136:143], v3
  v_max3_u32 v66, v66, v31, v32
  v_smfmac_f32_16x16x64_bf16 v[48:51], v[20:23], a[192:199], v3
  buffer_load_dwordx4 v[100:103], v2, s[8:11], s24 offen offset:1024
  v_max_u32 v66, v66, v35
  v_smfmac_f32_16x16x64_bf16 v[52:55], v[20:23], a[248:255], v3
  v_cmp_eq_u32 vcc, -1, v66
  v_smfmac_f32_16x16x64_bf16 v[56:59], v[20:23], v[168:175], v3
  v_smfmac_f32_16x16x64_bf16 v[62:65], v[20:23], v[224:231], v3
  s_cbranch_vccnz cB_sc3_r4
cB_sc3_c4:
  v_smfmac_f32_16x16x64_bf16 v[62:65], v[24:27], v[232:239], v3
  buffer_load_dwordx4 v[104:107], v2, s[8:11], s26 offen offset:0
  v_smfmac_f32_16x16x64_bf16 v[62:65], v[28:31], v[240:247], v3
  v_smfmac_f32_16x16x64_bf16 v[62:65], v[32:35], v[248:255], v3
  v_smfmac_f32_16x16x64_bf16 v[52:55], v[24:27], v[120:127], v3
  v_smfmac_f32_16x16x64_bf16 v[52:55], v[28:31], v[128:135], v3
  buffer_load_dwordx4 v[108:111], v2, s[8:11], s26 offen offset:1024
  v_smfmac_f32_16x16x64_bf16 v[52:55], v[32:35], v[136:143], v3
  v_cvt_pk_bf16_f32 v62, v62, v63
  v_smfmac_f32_16x16x64_bf16 v[56:59], v[24:27], v[176:183], v3
  v_cvt_pk_bf16_f32 v63, v64, v65
  v_smfmac_f32_16x16x64_bf16 v[56:59], v[28:31], v[184:191], v3
  v_mfma_f32_16x16x32_bf16 v[8:11], v[60:63], v[4:7], 0
  v_cvt_pk_bf16_f32 v55, v54, v55
  v_smfmac_f32_16x16x64_bf16 v[56:59], v[32:35], v[192:199], v3
  v_cvt_pk_bf16_f32 v54, v52, v53
  v_smfmac_f32_16x16x64_bf16 v[36:39], v[24:27], a[32:39], v3
  s_nop 1
  v_cvt_pk_bf16_f32 v78, v8, v9
  v_smfmac_f32_16x16x64_bf16 v[36:39], v[28:31], a[40:47], v3
  v_cvt_pk_bf16_f32 v79, v10, v11
  v_smfmac_f32_16x16x64_bf16 v[36:39], v[32:35], a[48:55], v3
  v_cvt_pk_bf16_f32 v56, v56, v57
  v_smfmac_f32_16x16x64_bf16 v[40:43], v[24:27], a[88:95], v3
  v_cvt_pk_bf16_f32 v57, v58, v59
  v_smfmac_f32_16x16x64_bf16 v[40:43], v[28:31], a[96:103], v3
  v_mfma_f32_16x16x32_bf16 v[12:15], v[54:57], v[4:7], 0
  v_cvt_pk_bf16_f32 v39, v38, v39
  v_smfmac_f32_16x16x64_bf16 v[40:43], v[32:35], a[104:111], v3
  v_cvt_pk_bf16_f32 v38, v36, v37
  v_smfmac_f32_16x16x64_bf16 v[44:47], v[24:27], a[144:151], v3
  s_nop 1
  v_cvt_pk_bf16_f32 v76, v12, v13
  v_smfmac_f32_16x16x64_bf16 v[44:47], v[28:31], a[152:159], v3
  v_cvt_pk_bf16_f32 v77, v14, v15
  v_smfmac_f32_16x16x64_bf16 v[44:47], v[32:35], a[160:167], v3
  v_cvt_pk_bf16_f32 v40, v40, v41
  v_smfmac_f32_16x16x64_bf16 v[48:51], v[24:27], a[200:207], v3
  v_cvt_pk_bf16_f32 v41, v42, v43
  v_smfmac_f32_16x16x64_bf16 v[48:51], v[28:31], a[208:215], v3
  v_smfmac_f32_16x16x64_bf16 v[48:51], v[32:35], a[216:223], v3
  s_waitcnt vmcnt(4)
  v_cvt_pk_bf16_f32 v47, v46, v47
  v_smfmac_f32_16x16x64_bf16 v[68:71], v[76:79], v[80:87], v3
  v_cvt_pk_bf16_f32 v46, v44, v45
  v_mfma_f32_16x16x32_bf16 v[8:11], v[38:41], v[4:7], 0
  s_nop 1
  v_cvt_pk_bf16_f32 v48, v48, v49
  v_cvt_pk_bf16_f32 v49, v50, v51
  s_nop 1
  v_mfma_f32_16x16x32_bf16 v[12:15], v[46:49], v[4:7], 0
  v_smfmac_f32_16x16x64_bf16 v[72:75], v[76:79], v[88:95], v3
  v_cvt_pk_bf16_f32 v16, v8, v9
  v_mfma_f32_16x16x32_bf16 v[52:55], v[30:33], v[76:79], 0
  s_waitcnt vmcnt(0)
  v_cvt_pk_bf16_f32 v17, v10, v11
  v_cvt_pk_bf16_f32 v18, v12, v13
  v_cvt_pk_bf16_f32 v19, v14, v15
  s_nop 1
  v_smfmac_f32_16x16x64_bf16 v[68:71], v[16:19], v[96:103], v3
  v_mfma_f32_16x16x32_bf16 v[52:55], v[20:23], v[16:19], v[52:55]
  v_smfmac_f32_16x16x64_bf16 v[72:75], v[16:19], v[104:111], v3
  s_nop 1
  v_permlane32_swap_b32 v68, v70
  v_permlane32_swap_b32 v69, v71
  v_add_f32 v56, v68, v70
  v_add_f32 v58, v69, v71
  ds_write_b128 v113, v[52:55]
  s_nop 0
  v_permlane32_swap_b32 v72, v74
  v_permlane32_swap_b32 v73, v75
  v_add_f32 v57, v72, v74
  v_add_f32 v59, v73, v75
  ds_write_b128 v2, v[56:59] offset:3072
  v_cmp_u_f32 vcc, v57, v59
  v_mov_b32 v36, 0
  v_mov_b32 v37, 0
  v_mov_b32 v38, 0
  v_mov_b32 v39, 0
  s_cbranch_vccnz cB_sc3_retry
cB_sc3_cont:
  s_add_u32 s24, s24, 28672
  s_add_u32 s26, s26, 28672
  buffer_load_dwordx4 v[80:83], v117, s[8:11], s24 offen offset:0
  buffer_load_dwordx4 v[84:87], v117, s[8:11], s24 offen offset:1024
  v_mov_b32 v40, 0
  v_mov_b32 v41, 0
  v_mov_b32 v42, 0
  v_mov_b32 v43, 0
  v_mov_b32 v44, 0
  v_mov_b32 v45, 0
  v_mov_b32 v46, 0
  v_mov_b32 v47, 0
  v_mov_b32 v48, 0
  v_mov_b32 v49, 0
  v_mov_b32 v50, 0
  v_mov_b32 v51, 0
  s_waitcnt lgkmcnt(0)
  s_barrier
  v_mov_b32 v62, 0
  v_mov_b32 v63, 0
  v_mov_b32 v64, 0
  v_mov_b32 v65, 0
  v_mov_b32 v68, 0
  v_mov_b32 v69, 0
  v_mov_b32 v70, 0
  v_mov_b32 v71, 0
  v_mov_b32 v72, 0
  v_mov_b32 v73, 0
  v_mov_b32 v74, 0
  v_mov_b32 v75, 0
  v_mov_b32 v52, 0
  v_mov_b32 v53, 0
  v_mov_b32 v54, 0
  v_mov_b32 v55, 0
  v_mov_b32 v56, 0
  v_mov_b32 v57, 0
  v_mov_b32 v58, 0
  v_mov_b32 v59, 0
  s_mov_b32 s19, s18
  s_add_u32 s18, s18, 1
  s_mov_b32 s22, s20
  s_mov_b32 s20, s21
  s_mov_b32 s21, s22
  s_add_u32 s23, s20, 4096
  s_cmp_lt_u32 s19, 63
  s_cbranch_scc1 cB_sc3_loop
  s_branch cB_done
cB_sc3_r0:
  s_add_u32 s31, s31, 1
  buffer_load_dwordx4 v[8:11], v2, s[8:11], s20 offen offset:0 sc1
  s_waitcnt vmcnt(0)
  v_cmp_eq_u32 vcc, -1, v8
  v_mov_b32 v36, 0
  v_mov_b32 v37, 0
  v_mov_b32 v38, 0
  v_mov_b32 v39, 0
  v_mov_b32 v40, 0
  v_mov_b32 v41, 0
  v_mov_b32 v42, 0
  v_mov_b32 v43, 0
  v_mov_b32 v44, 0
  v_mov_b32 v45, 0
  v_mov_b32 v46, 0
  v_mov_b32 v47, 0
  v_mov_b32 v48, 0
  v_mov_b32 v49, 0
  v_mov_b32 v50, 0
  v_mov_b32 v51, 0
  s_nop 1
  s_cbranch_vccz cB_sc3_go
  s_add_u32 s30, s30, 1
  s_cmp_lt_u32 s30, 400000
  s_cbranch_scc1 cB_sc3_r0
  s_branch cB_abort
cB_sc3_r1:
  s_add_u32 s31, s31, 1
  buffer_load_dwordx4 v[12:15], v2, s[8:11], s20 offen offset:1024 sc1
  s_waitcnt vmcnt(0)
  v_cmp_eq_u32 vcc, -1, v12
  s_nop 4
  s_cbranch_vccz cB_sc3_c1
  s_add_u32 s30, s30, 1
  s_cmp_lt_u32 s30, 400000
  s_cbranch_scc1 cB_sc3_r1
  s_branch cB_abort
cB_sc3_r2:
  s_add_u32 s31, s31, 1
  buffer_load_dwordx4 v[16:19], v2, s[8:11], s20 offen offset:2048 sc1
  s_waitcnt vmcnt(0)
  v_cmp_eq_u32 vcc, -1, v16
  s_nop 4
  s_cbranch_vccz cB_sc3_c2
  s_add_u32 s30, s30, 1
  s_cmp_lt_u32 s30, 400000
  s_cbranch_scc1 cB_sc3_r2
  s_branch cB_abort
cB_sc3_r3:
  s_add_u32 s31, s31, 1
  buffer_load_dwordx4 v[20:23], v2, s[8:11], s20 offen offset:3072 sc1
  s_waitcnt vmcnt(0)
  v_cmp_eq_u32 vcc, -1, v20
  s_nop 4
  s_cbranch_vccz cB_sc3_c3
  s_add_u32 s30, s30, 1
  s_cmp_lt_u32 s30, 400000
  s_cbranch_scc1 cB_sc3_r3
  s_branch cB_abort
cB_sc3_r4:
  s_add_u32 s31, s31, 1
  buffer_load_dwordx4 v[24:27], v2, s[8:11], s23 offen offset:0 sc1
  buffer_load_dwordx4 v[28:31], v2, s[8:11], s23 offen offset:1024 sc1
  buffer_load_dwordx4 v[32:35], v2, s[8:11], s23 offen offset:2048 sc1
  s_waitcnt vmcnt(0)
  v_max3_u32 v66, v24, v27, v28
  v_max3_u32 v66, v66, v31, v32
  v_max_u32 v66, v66, v35
  v_cmp_eq_u32 vcc, -1, v66
  s_nop 4
  s_cbranch_vccz cB_sc3_c4
  s_add_u32 s30, s30, 1
  s_cmp_lt_u32 s30, 400000
  s_cbranch_scc1 cB_sc3_r4
  s_branch cB_abort
cB_sc3_retry:
  s_cmp_lg_u32 s62, 0
  s_cbranch_scc1 cB_sc3_cont
  s_waitcnt vmcnt(0) lgkmcnt(0)
cB_sc3_rv:
  buffer_load_dwordx4 v[8:11], v2, s[8:11], s20 offen offset:0 sc1
  buffer_load_dwordx4 v[12:15], v2, s[8:11], s20 offen offset:1024 sc1
  buffer_load_dwordx4 v[16:19], v2, s[8:11], s20 offen offset:2048 sc1
  buffer_load_dwordx4 v[20:23], v2, s[8:11], s20 offen offset:3072 sc1
  buffer_load_dwordx4 v[24:27], v2, s[8:11], s23 offen offset:0 sc1
  buffer_load_dwordx4 v[28:31], v2, s[8:11], s23 offen offset:1024 sc1
  buffer_load_dwordx4 v[32:35], v2, s[8:11], s23 offen offset:2048 sc1
  s_waitcnt vmcnt(0)
  v_pk_max_u16 v66, v8, v9
  v_pk_max_u16 v66, v66, v10
  v_pk_max_u16 v66, v66, v11
  v_pk_max_u16 v66, v66, v12
  v_pk_max_u16 v66, v66, v13
  v_pk_max_u16 v66, v66, v14
  v_pk_max_u16 v66, v66, v15
  v_pk_max_u16 v66, v66, v16
  v_pk_max_u16 v66, v66, v17
  v_pk_max_u16 v66, v66, v18
  v_pk_max_u16 v66, v66, v19
  v_pk_max_u16 v66, v66, v20
  v_pk_max_u16 v66, v66, v21
  v_pk_max_u16 v66, v66, v22
  v_pk_max_u16 v66, v66, v23
  v_pk_max_u16 v66, v66, v24
  v_pk_max_u16 v66, v66, v25
  v_pk_max_u16 v66, v66, v26
  v_pk_max_u16 v66, v66, v27
  v_pk_max_u16 v66, v66, v28
  v_pk_max_u16 v66, v66, v29
  v_pk_max_u16 v66, v66, v30
  v_pk_max_u16 v66, v66, v31
  v_pk_max_u16 v66, v66, v32
  v_pk_max_u16 v66, v66, v33
  v_pk_max_u16 v66, v66, v34
  v_pk_max_u16 v66, v66, v35
  v_lshlrev_b32 v67, 16, v66
  v_max_u32 v66, v66, v67
  v_cmp_le_u32 vcc, 0xffff0000, v66
  s_cbranch_vccz cB_sc3_rk
  s_add_u32 s30, s30, 1
  s_cmp_lt_u32 s30, 400000
  s_cbranch_scc1 cB_sc3_rv
  s_branch cB_abort
cB_sc3_rk:
  s_mov_b32 s62, 1
  v_mov_b32 v36, 0
  v_mov_b32 v37, 0
  v_mov_b32 v38, 0
  v_mov_b32 v39, 0
  v_mov_b32 v40, 0
  v_mov_b32 v41, 0
  v_mov_b32 v42, 0
  v_mov_b32 v43, 0
  v_mov_b32 v44, 0
  v_mov_b32 v45, 0
  v_mov_b32 v46, 0
  v_mov_b32 v47, 0
  v_mov_b32 v48, 0
  v_mov_b32 v49, 0
  v_mov_b32 v50, 0
  v_mov_b32 v51, 0
  v_mov_b32 v62, 0
  v_mov_b32 v63, 0
  v_mov_b32 v64, 0
  v_mov_b32 v65, 0
  v_mov_b32 v68, 0
  v_mov_b32 v69, 0
  v_mov_b32 v70, 0
  v_mov_b32 v71, 0
  v_mov_b32 v72, 0
  v_mov_b32 v73, 0
  v_mov_b32 v74, 0
  v_mov_b32 v75, 0
  v_mov_b32 v52, 0
  v_mov_b32 v53, 0
  v_mov_b32 v54, 0
  v_mov_b32 v55, 0
  v_mov_b32 v56, 0
  v_mov_b32 v57, 0
  v_mov_b32 v58, 0
  v_mov_b32 v59, 0
  s_add_u32 s31, s31, 0x100
  s_nop 0
  s_branch cB_sc3_go
.p2align 6
cB_va0_loop:
  s_mov_b32 s30, 0
  s_barrier
  buffer_load_dwordx4 v[24:27], v2, s[8:11], s23 offen offset:0 sc1
  buffer_load_dwordx4 v[28:31], v2, s[8:11], s23 offen offset:1024 sc1
  s_barrier
  buffer_store_dword v160, v1, s[8:11], s38 offen sc1
  s_add_u32 s22, s25, 0
  buffer_load_dwordx4 v[80:83], v6, s[8:11], s22 offen offset:0 sc1
  buffer_load_dwordx4 v[84:87], v6, s[8:11], s22 offen offset:1792 sc1
  s_add_u32 s22, s25, 3584
  buffer_load_dwordx4 v[88:91], v6, s[8:11], s22 offen offset:0 sc1
  buffer_load_dwordx4 v[92:95], v6, s[8:11], s22 offen offset:1792 sc1
  s_add_u32 s22, s25, 7168
  buffer_load_dwordx4 v[96:99], v6, s[8:11], s22 offen offset:0 sc1
  buffer_load_dwordx4 v[100:103], v6, s[8:11], s22 offen offset:1792 sc1
  s_add_u32 s22, s25, 10752
  buffer_load_dwordx4 v[104:107], v6, s[8:11], s22 offen offset:0 sc1
  buffer_load_dwordx4 v[108:111], v6, s[8:11], s22 offen offset:1792 sc1
  s_add_u32 s22, s25, 14336
  buffer_load_dwordx4 v[112:115], v6, s[8:11], s22 offen offset:0 sc1
  buffer_load_dwordx4 v[116:119], v6, s[8:11], s22 offen offset:1792 sc1
  s_add_u32 s22, s25, 17920
  buffer_load_dwordx4 v[120:123], v6, s[8:11], s22 offen offset:0 sc1
  buffer_load_dwordx4 v[124:127], v6, s[8:11], s22 offen offset:1792 sc1
  s_add_u32 s22, s25, 21504
  buffer_load_dwordx4 v[128:131], v6, s[8:11], s22 offen offset:0 sc1
  buffer_load_dwordx4 v[132:135], v6, s[8:11], s22 offen offset:1792 sc1
  s_add_u32 s22, s25, 25088
  buffer_load_dwordx4 v[136:139], v6, s[8:11], s22 offen offset:0 sc1
  buffer_load_dwordx4 v[140:143], v6, s[8:11], s22 offen offset:1792 sc1
  s_mul_i32 s38, s18, 7168
  s_add_u32 s38, s38, 87543808
  s_waitcnt vmcnt(17)
  ds_write_b128 v2, v[24:27] offset:12288
  ds_write_b128 v2, v[28:31] offset:13312
  v_smfmac_f32_16x16x64_bf16 v[36:39], v[24:27], a[32:39], v3
  v_smfmac_f32_16x16x64_bf16 v[40:43], v[24:27], a[88:95], v3
  v_smfmac_f32_16x16x64_bf16 v[44:47], v[24:27], a[144:151], v3
  v_smfmac_f32_16x16x64_bf16 v[48:51], v[24:27], a[200:207], v3
  v_smfmac_f32_16x16x64_bf16 v[52:55], v[24:27], v[176:183], v3
  s_waitcnt lgkmcnt(0)
  s_barrier
  ds_read_b128 v[8:11], v2 offset:8192
  ds_read_b128 v[12:15], v2 offset:9216
  ds_read_b128 v[16:19], v2 offset:10240
  ds_read_b128 v[20:23], v2 offset:11264
  ds_read_b128 v[32:35], v2 offset:14336
  v_smfmac_f32_16x16x64_bf16 v[56:59], v[24:27], v[232:239], v3
  v_smfmac_f32_16x16x64_bf16 v[36:39], v[28:31], a[40:47], v3
  v_smfmac_f32_16x16x64_bf16 v[40:43], v[28:31], a[96:103], v3
  v_smfmac_f32_16x16x64_bf16 v[44:47], v[28:31], a[152:159], v3
  v_smfmac_f32_16x16x64_bf16 v[48:51], v[28:31], a[208:215], v3
  v_smfmac_f32_16x16x64_bf16 v[52:55], v[28:31], v[184:191], v3
  ds_read_b128 v[64:67], v0 offset:0
  ds_read_b128 v[68:71], v0 offset:1024
  v_smfmac_f32_16x16x64_bf16 v[56:59], v[28:31], v[240:247], v3
  s_waitcnt lgkmcnt(6)
  ds_read_b128 v[72:75], v0 offset:2048
  ds_read_b128 v[76:79], v0 offset:3072
  v_smfmac_f32_16x16x64_bf16 v[36:39], v[8:11], a[0:7], v3
  s_waitcnt lgkmcnt(7)
  v_smfmac_f32_16x16x64_bf16 v[36:39], v[12:15], a[8:15], v3
  s_waitcnt lgkmcnt(6)
  v_smfmac_f32_16x16x64_bf16 v[36:39], v[16:19], a[16:23], v3
  s_waitcnt lgkmcnt(2)
  v_smfmac_f32_16x16x64_bf16 v[60:63], v[8:11], v[64:71], v3
  s_waitcnt lgkmcnt(5)
  ds_read_b128 v[144:147], v0 offset:4096
  ds_read_b128 v[148:151], v0 offset:5120
  v_smfmac_f32_16x16x64_bf16 v[36:39], v[20:23], a[24:31], v3
  s_waitcnt lgkmcnt(6)
  v_smfmac_f32_16x16x64_bf16 v[36:39], v[32:35], a[48:55], v3
  v_smfmac_f32_16x16x64_bf16 v[40:43], v[8:11], a[56:63], v3
  s_waitcnt lgkmcnt(2)
  v_smfmac_f32_16x16x64_bf16 v[60:63], v[12:15], v[72:79], v3
  ds_read_b128 v[64:67], v0 offset:6144
  ds_read_b128 v[68:71], v0 offset:7168
  v_smfmac_f32_16x16x64_bf16 v[40:43], v[12:15], a[64:71], v3
  v_permlane32_swap_b32 v36, v38
  v_smfmac_f32_16x16x64_bf16 v[40:43], v[16:19], a[72:79], v3
  v_permlane32_swap_b32 v37, v39
  v_smfmac_f32_16x16x64_bf16 v[40:43], v[20:23], a[80:87], v3
  s_waitcnt lgkmcnt(2)
  v_add_f32 v36, v36, v38
  v_smfmac_f32_16x16x64_bf16 v[60:63], v[16:19], v[144:151], v3
  ds_read_b128 v[72:75], v0 offset:8192
  ds_read_b128 v[76:79], v0 offset:9216
  v_add_f32 v37, v37, v39
  v_smfmac_f32_16x16x64_bf16 v[40:43], v[32:35], a[104:111], v3
  v_cmp_u_f32 vcc, v36, v37
  v_smfmac_f32_16x16x64_bf16 v[44:47], v[8:11], a[112:119], v3
  v_cvt_pk_bf16_f32 v38, v36, v37
  v_smfmac_f32_16x16x64_bf16 v[44:47], v[12:15], a[120:127], v3
  ds_write_b32 v152, v38
  s_waitcnt lgkmcnt(3)
  s_cbranch_vccnz cB_va0_slow
  v_permlane32_swap_b32 v40, v42
  v_smfmac_f32_16x16x64_bf16 v[60:63], v[20:23], v[64:71], v3
  ds_read_b128 v[144:147], v0 offset:10240
  ds_read_b128 v[148:151], v0 offset:11264
  v_permlane32_swap_b32 v41, v43
  v_smfmac_f32_16x16x64_bf16 v[44:47], v[16:19], a[128:135], v3
  buffer_store_dword v162, v1, s[8:11], s21 offen sc1
  v_add_f32 v40, v40, v42
  v_smfmac_f32_16x16x64_bf16 v[44:47], v[20:23], a[136:143], v3
  v_add_f32 v41, v41, v43
  v_smfmac_f32_16x16x64_bf16 v[44:47], v[32:35], a[160:167], v3
  s_waitcnt lgkmcnt(3)
  v_cvt_pk_bf16_f32 v42, v40, v41
  v_smfmac_f32_16x16x64_bf16 v[60:63], v[24:27], v[72:79], v3
  ds_write_b32 v153, v42
  ds_read_b128 v[64:67], v0 offset:12288
  ds_read_b128 v[68:71], v0 offset:13312
  v_smfmac_f32_16x16x64_bf16 v[48:51], v[8:11], a[168:175], v3
  s_nop 0
  v_permlane32_swap_b32 v44, v46
  v_smfmac_f32_16x16x64_bf16 v[48:51], v[12:15], a[176:183], v3
  v_permlane32_swap_b32 v45, v47
  v_smfmac_f32_16x16x64_bf16 v[48:51], v[16:19], a[184:191], v3
  s_waitcnt lgkmcnt(3)
  v_add_f32 v44, v44, v46
  v_smfmac_f32_16x16x64_bf16 v[60:63], v[28:31], v[144:151], v3
  v_add_f32 v45, v45, v47
  v_smfmac_f32_16x16x64_bf16 v[48:51], v[20:23], a[192:199], v3
  v_cvt_pk_bf16_f32 v46, v44, v45
  v_smfmac_f32_16x16x64_bf16 v[48:51], v[32:35], a[216:223], v3
  ds_write_b32 v154, v46
  v_smfmac_f32_16x16x64_bf16 v[52:55], v[8:11], a[224:231], v3
  s_waitcnt lgkmcnt(1)
  v_smfmac_f32_16x16x64_bf16 v[60:63], v[32:35], v[64:71], v3
  v_smfmac_f32_16x16x64_bf16 v[52:55], v[12:15], a[232:239], v3
  v_permlane32_swap_b32 v48, v50
  v_smfmac_f32_16x16x64_bf16 v[52:55], v[16:19], a[240:247], v3
  v_permlane32_swap_b32 v49, v51
  v_smfmac_f32_16x16x64_bf16 v[52:55], v[20:23], a[248:255], v3
  v_add_f32 v48, v48, v50
  v_smfmac_f32_16x16x64_bf16 v[52:55], v[32:35], v[192:199], v3
  v_add_f32 v49, v49, v51
  v_smfmac_f32_16x16x64_bf16 v[56:59], v[8:11], v[200:207], v3
  v_cvt_pk_bf16_f32 v50, v48, v49
  v_smfmac_f32_16x16x64_bf16 v[56:59], v[12:15], v[208:215], v3
  ds_write_b32 v155, v50
  v_permlane32_swap_b32 v60, v62
  v_smfmac_f32_16x16x64_bf16 v[56:59], v[16:19], v[216:223], v3
  v_permlane32_swap_b32 v61, v63
  v_smfmac_f32_16x16x64_bf16 v[56:59], v[20:23], v[224:231], v3
  v_add_f32 v60, v60, v62
  v_smfmac_f32_16x16x64_bf16 v[56:59], v[32:35], v[248:255], v3
  v_add_f32 v61, v61, v63
  v_cvt_pk_bf16_f32 v62, v60, v61
  ds_write_b32 v158, v62
  v_permlane32_swap_b32 v52, v54
  v_permlane32_swap_b32 v53, v55
  v_add_f32 v52, v52, v54
  v_add_f32 v53, v53, v55
  v_cvt_pk_bf16_f32 v54, v52, v53
  ds_write_b32 v156, v54
  v_permlane32_swap_b32 v56, v58
  v_permlane32_swap_b32 v57, v59
  v_add_f32 v56, v56, v58
  v_add_f32 v57, v57, v59
  v_cvt_pk_bf16_f32 v58, v56, v57
  ds_write_b32 v157, v58
cB_va0_t2d:
  s_add_u32 s22, s20, 9216
  s_add_u32 s34, s20, 13312
  s_add_u32 s36, s20, 7168
  s_mov_b32 s37, 0
  v_mov_b32 v48, 0
  v_mov_b32 v49, 0
  v_mov_b32 v50, 0
  v_mov_b32 v51, 0
  v_mov_b32 v163, s18
  s_waitcnt lgkmcnt(0)
  s_setprio 3
  buffer_load_dword v52, v4, s[8:11], 0 offen sc1
  buffer_load_dword v53, v4, s[8:11], 0 offen sc1
  buffer_load_dword v54, v4, s[8:11], 0 offen sc1
cB_va0_fw_l:
  s_waitcnt vmcnt(2)
  v_cmp_gt_u32 vcc, s18, v52
  s_cbranch_vccz cB_va0_fw_d
  buffer_load_dword v52, v4, s[8:11], 0 offen sc1
  s_waitcnt vmcnt(2)
  v_cmp_gt_u32 vcc, s18, v53
  s_cbranch_vccz cB_va0_fw_d
  buffer_load_dword v53, v4, s[8:11], 0 offen sc1
  s_waitcnt vmcnt(2)
  v_cmp_gt_u32 vcc, s18, v54
  s_cbranch_vccz cB_va0_fw_d
  buffer_load_dword v54, v4, s[8:11], 0 offen sc1
  s_add_u32 s30, s30, 1
  s_cmp_lt_u32 s30, 400000
  s_cbranch_scc1 cB_va0_fw_l
  s_branch cB_abort
cB_va0_fw_d:
  buffer_load_dwordx4 v[8:11], v2, s[8:11], s22 offen offset:0 sc1
  buffer_load_dwordx4 v[12:15], v2, s[8:11], s22 offen offset:1024 sc1
  buffer_load_dwordx4 v[16:19], v2, s[8:11], s22 offen offset:2048 sc1
  buffer_load_dwordx4 v[20:23], v2, s[8:11], s22 offen offset:3072 sc1
  buffer_load_dwordx4 v[24:27], v2, s[8:11], s34 offen offset:0 sc1
  buffer_load_dwordx4 v[28:31], v2, s[8:11], s34 offen offset:1024 sc1
  buffer_load_dwordx4 v[32:35], v2, s[8:11], s34 offen offset:2048 sc1
  buffer_load_dwordx4 v[36:39], v2, s[8:11], s34 offen offset:3072 sc1
  buffer_load_dwordx4 v[40:43], v2, s[8:11], s36 offen offset:0 sc1
  buffer_load_dwordx4 v[44:47], v2, s[8:11], s36 offen offset:1024 sc1
  s_barrier
  ds_read_b128 v[64:67], v2 offset:0
  ds_read_b128 v[68:71], v2 offset:1024
  ds_read_b128 v[72:75], v2 offset:2048
  ds_read_b128 v[76:79], v2 offset:3072
cB_va0_lp:
  s_waitcnt vmcnt(9)
  v_smfmac_f32_16x16x64_bf16 v[48:51], v[8:11], v[80:87], v3
  s_waitcnt vmcnt(8)
  v_smfmac_f32_16x16x64_bf16 v[48:51], v[12:15], v[88:95], v3
  s_waitcnt vmcnt(7)
  v_smfmac_f32_16x16x64_bf16 v[48:51], v[16:19], v[96:103], v3
  s_waitcnt vmcnt(6)
  v_smfmac_f32_16x16x64_bf16 v[48:51], v[20:23], v[104:111], v3
  s_waitcnt vmcnt(5)
  v_smfmac_f32_16x16x64_bf16 v[48:51], v[24:27], v[112:119], v3
  s_waitcnt vmcnt(4)
  v_smfmac_f32_16x16x64_bf16 v[48:51], v[28:31], v[120:127], v3
  s_waitcnt vmcnt(3)
  v_smfmac_f32_16x16x64_bf16 v[48:51], v[32:35], v[128:135], v3
  s_waitcnt vmcnt(2)
  v_smfmac_f32_16x16x64_bf16 v[48:51], v[36:39], v[136:143], v3
  s_waitcnt vmcnt(1) lgkmcnt(0)
  v_smfmac_f32_16x16x64_bf16 v[48:51], v[40:43], v[64:71], v3
  s_waitcnt vmcnt(0)
  v_smfmac_f32_16x16x64_bf16 v[48:51], v[44:47], v[72:79], v3
  s_nop 7
  v_permlane32_swap_b32 v48, v50
  v_permlane32_swap_b32 v49, v51
  v_add_f32 v48, v48, v50
  v_add_f32 v49, v49, v51
  v_cvt_pk_bf16_f32 v160, v48, v49
  v_cmp_u_f32 vcc, v48, v49
  s_nop 0
  v_mov_b32_dpp v161, v160 quad_perm:[1,0,3,2] row_mask:0xf bank_mask:0xf
  v_perm_b32 v160, v161, v160, v5
  v_min_u32 v160, -2, v160
  s_cbranch_vccnz cB_va0_rp
cB_va0_cont:
  buffer_store_dword v160, v1, s[8:11], s21 offen sc1
  s_setprio 0
  s_cmp_lg_u32 s19, 62
  s_cbranch_scc1 cB_va0_nl
  buffer_store_dword v160, v1, s[8:11], s38 offen sc1
  s_branch cB_done
cB_va0_nl:
  s_add_u32 s25, s25, 28672
  v_mov_b32 v36, 0
  v_mov_b32 v37, 0
  v_mov_b32 v38, 0
  v_mov_b32 v39, 0
  v_mov_b32 v40, 0
  v_mov_b32 v41, 0
  v_mov_b32 v42, 0
  v_mov_b32 v43, 0
  v_mov_b32 v44, 0
  v_mov_b32 v45, 0
  v_mov_b32 v46, 0
  v_mov_b32 v47, 0
  v_mov_b32 v48, 0
  v_mov_b32 v49, 0
  v_mov_b32 v50, 0
  v_mov_b32 v51, 0
  v_mov_b32 v52, 0
  v_mov_b32 v53, 0
  v_mov_b32 v54, 0
  v_mov_b32 v55, 0
  v_mov_b32 v56, 0
  v_mov_b32 v57, 0
  v_mov_b32 v58, 0
  v_mov_b32 v59, 0
  v_mov_b32 v60, 0
  v_mov_b32 v61, 0
  v_mov_b32 v62, 0
  v_mov_b32 v63, 0
  s_mov_b32 s19, s18
  s_add_u32 s18, s18, 1
  s_mov_b32 s22, s20
  s_mov_b32 s20, s21
  s_mov_b32 s21, s22
  s_add_u32 s23, s20, 4096
  s_branch cB_va0_loop
cB_va0_slow:
  s_waitcnt lgkmcnt(0)
cB_va0_sl1:
  s_add_u32 s31, s31, 0x1000000
  buffer_load_dwordx4 v[8:11], v2, s[8:11], s20 offen offset:0 sc1
  buffer_load_dwordx4 v[12:15], v2, s[8:11], s20 offen offset:1024 sc1
  buffer_load_dwordx4 v[16:19], v2, s[8:11], s20 offen offset:2048 sc1
  buffer_load_dwordx4 v[20:23], v2, s[8:11], s20 offen offset:3072 sc1
  buffer_load_dwordx4 v[24:27], v2, s[8:11], s23 offen offset:0 sc1
  buffer_load_dwordx4 v[28:31], v2, s[8:11], s23 offen offset:1024 sc1
  buffer_load_dwordx4 v[32:35], v2, s[8:11], s23 offen offset:2048 sc1
  s_waitcnt vmcnt(0)
  v_max3_u32 v36, v8, v9, v10
  v_max3_u32 v36, v36, v11, v12
  v_max3_u32 v36, v36, v13, v14
  v_max3_u32 v36, v36, v15, v16
  v_max3_u32 v36, v36, v17, v18
  v_max3_u32 v36, v36, v19, v20
  v_max3_u32 v36, v36, v21, v22
  v_max3_u32 v36, v36, v23, v24
  v_max3_u32 v36, v36, v25, v26
  v_max3_u32 v36, v36, v27, v28
  v_max3_u32 v36, v36, v29, v30
  v_max3_u32 v36, v36, v31, v32
  v_max3_u32 v36, v36, v33, v34
  v_max_u32 v36, v36, v35
  v_cmp_eq_u32 vcc, -1, v36
  s_cbranch_vccz cB_va0_sl2
  s_add_u32 s30, s30, 1
  s_cmp_lt_u32 s30, 400000
  s_cbranch_scc1 cB_va0_sl1
  s_branch cB_abort
cB_va0_sl2:
  v_mov_b32 v36, 0
  v_mov_b32 v37, 0
  v_mov_b32 v38, 0
  v_mov_b32 v39, 0
  v_mov_b32 v40, 0
  v_mov_b32 v41, 0
  v_mov_b32 v42, 0
  v_mov_b32 v43, 0
  v_mov_b32 v44, 0
  v_mov_b32 v45, 0
  v_mov_b32 v46, 0
  v_mov_b32 v47, 0
  v_mov_b32 v48, 0
  v_mov_b32 v49, 0
  v_mov_b32 v50, 0
  v_mov_b32 v51, 0
  v_mov_b32 v52, 0
  v_mov_b32 v53, 0
  v_mov_b32 v54, 0
  v_mov_b32 v55, 0
  v_mov_b32 v56, 0
  v_mov_b32 v57, 0
  v_mov_b32 v58, 0
  v_mov_b32 v59, 0
  v_mov_b32 v60, 0
  v_mov_b32 v61, 0
  v_mov_b32 v62, 0
  v_mov_b32 v63, 0
  buffer_store_dword v162, v1, s[8:11], s21 offen sc1
  ds_read_b128 v[64:67], v0 offset:0
  ds_read_b128 v[68:71], v0 offset:1024
  v_smfmac_f32_16x16x64_bf16 v[36:39], v[8:11], a[0:7], v3
  v_smfmac_f32_16x16x64_bf16 v[40:43], v[8:11], a[56:63], v3
  v_smfmac_f32_16x16x64_bf16 v[44:47], v[8:11], a[112:119], v3
  v_smfmac_f32_16x16x64_bf16 v[48:51], v[8:11], a[168:175], v3
  v_smfmac_f32_16x16x64_bf16 v[52:55], v[8:11], a[224:231], v3
  v_smfmac_f32_16x16x64_bf16 v[56:59], v[8:11], v[200:207], v3
  s_waitcnt lgkmcnt(0)
  v_smfmac_f32_16x16x64_bf16 v[60:63], v[8:11], v[64:71], v3
  ds_read_b128 v[72:75], v0 offset:2048
  ds_read_b128 v[76:79], v0 offset:3072
  v_smfmac_f32_16x16x64_bf16 v[36:39], v[12:15], a[8:15], v3
  v_smfmac_f32_16x16x64_bf16 v[40:43], v[12:15], a[64:71], v3
  v_smfmac_f32_16x16x64_bf16 v[44:47], v[12:15], a[120:127], v3
  v_smfmac_f32_16x16x64_bf16 v[48:51], v[12:15], a[176:183], v3
  v_smfmac_f32_16x16x64_bf16 v[52:55], v[12:15], a[232:239], v3
  v_smfmac_f32_16x16x64_bf16 v[56:59], v[12:15], v[208:215], v3
  s_waitcnt lgkmcnt(0)
  v_smfmac_f32_16x16x64_bf16 v[60:63], v[12:15], v[72:79], v3
  ds_read_b128 v[144:147], v0 offset:4096
  ds_read_b128 v[148:151], v0 offset:5120
  v_smfmac_f32_16x16x64_bf16 v[36:39], v[16:19], a[16:23], v3
  v_smfmac_f32_16x16x64_bf16 v[40:43], v[16:19], a[72:79], v3
  v_smfmac_f32_16x16x64_bf16 v[44:47], v[16:19], a[128:135], v3
  v_smfmac_f32_16x16x64_bf16 v[48:51], v[16:19], a[184:191], v3
  v_smfmac_f32_16x16x64_bf16 v[52:55], v[16:19], a[240:247], v3
  v_smfmac_f32_16x16x64_bf16 v[56:59], v[16:19], v[216:223], v3
  s_waitcnt lgkmcnt(0)
  v_smfmac_f32_16x16x64_bf16 v[60:63], v[16:19], v[144:151], v3
  ds_read_b128 v[64:67], v0 offset:6144
  ds_read_b128 v[68:71], v0 offset:7168
  v_smfmac_f32_16x16x64_bf16 v[36:39], v[20:23], a[24:31], v3
  v_smfmac_f32_16x16x64_bf16 v[40:43], v[20:23], a[80:87], v3
  v_smfmac_f32_16x16x64_bf16 v[44:47], v[20:23], a[136:143], v3
  v_smfmac_f32_16x16x64_bf16 v[48:51], v[20:23], a[192:199], v3
  v_smfmac_f32_16x16x64_bf16 v[52:55], v[20:23], a[248:255], v3
  v_smfmac_f32_16x16x64_bf16 v[56:59], v[20:23], v[224:231], v3
  s_waitcnt lgkmcnt(0)
  v_smfmac_f32_16x16x64_bf16 v[60:63], v[20:23], v[64:71], v3
  ds_read_b128 v[72:75], v0 offset:8192
  ds_read_b128 v[76:79], v0 offset:9216
  v_smfmac_f32_16x16x64_bf16 v[36:39], v[24:27], a[32:39], v3
  v_smfmac_f32_16x16x64_bf16 v[40:43], v[24:27], a[88:95], v3
  v_smfmac_f32_16x16x64_bf16 v[44:47], v[24:27], a[144:151], v3
  v_smfmac_f32_16x16x64_bf16 v[48:51], v[24:27], a[200:207], v3
  v_smfmac_f32_16x16x64_bf16 v[52:55], v[24:27], v[176:183], v3
  v_smfmac_f32_16x16x64_bf16 v[56:59], v[24:27], v[232:239], v3
  s_waitcnt lgkmcnt(0)
  v_smfmac_f32_16x16x64_bf16 v[60:63], v[24:27], v[72:79], v3
  ds_read_b128 v[144:147], v0 offset:10240
  ds_read_b128 v[148:151], v0 offset:11264
  v_smfmac_f32_16x16x64_bf16 v[36:39], v[28:31], a[40:47], v3
  v_smfmac_f32_16x16x64_bf16 v[40:43], v[28:31], a[96:103], v3
  v_smfmac_f32_16x16x64_bf16 v[44:47], v[28:31], a[152:159], v3
  v_smfmac_f32_16x16x64_bf16 v[48:51], v[28:31], a[208:215], v3
  v_smfmac_f32_16x16x64_bf16 v[52:55], v[28:31], v[184:191], v3
  v_smfmac_f32_16x16x64_bf16 v[56:59], v[28:31], v[240:247], v3
  s_waitcnt lgkmcnt(0)
  v_smfmac_f32_16x16x64_bf16 v[60:63], v[28:31], v[144:151], v3
  ds_read_b128 v[64:67], v0 offset:12288
  ds_read_b128 v[68:71], v0 offset:13312
  v_smfmac_f32_16x16x64_bf16 v[36:39], v[32:35], a[48:55], v3
  v_smfmac_f32_16x16x64_bf16 v[40:43], v[32:35], a[104:111], v3
  v_smfmac_f32_16x16x64_bf16 v[44:47], v[32:35], a[160:167], v3
  v_smfmac_f32_16x16x64_bf16 v[48:51], v[32:35], a[216:223], v3
  v_smfmac_f32_16x16x64_bf16 v[52:55], v[32:35], v[192:199], v3
  v_smfmac_f32_16x16x64_bf16 v[56:59], v[32:35], v[248:255], v3
  s_waitcnt lgkmcnt(0)
  v_smfmac_f32_16x16x64_bf16 v[60:63], v[32:35], v[64:71], v3
  v_permlane32_swap_b32 v36, v38
  v_permlane32_swap_b32 v37, v39
  v_add_f32 v36, v36, v38
  v_add_f32 v37, v37, v39
  v_cvt_pk_bf16_f32 v38, v36, v37
  ds_write_b32 v152, v38
  v_permlane32_swap_b32 v40, v42
  v_permlane32_swap_b32 v41, v43
  v_add_f32 v40, v40, v42
  v_add_f32 v41, v41, v43
  v_cvt_pk_bf16_f32 v42, v40, v41
  ds_write_b32 v153, v42
  v_permlane32_swap_b32 v44, v46
  v_permlane32_swap_b32 v45, v47
  v_add_f32 v44, v44, v46
  v_add_f32 v45, v45, v47
  v_cvt_pk_bf16_f32 v46, v44, v45
  ds_write_b32 v154, v46
  v_permlane32_swap_b32 v48, v50
  v_permlane32_swap_b32 v49, v51
  v_add_f32 v48, v48, v50
  v_add_f32 v49, v49, v51
  v_cvt_pk_bf16_f32 v50, v48, v49
  ds_write_b32 v155, v50
  v_permlane32_swap_b32 v52, v54
  v_permlane32_swap_b32 v53, v55
  v_add_f32 v52, v52, v54
  v_add_f32 v53, v53, v55
  v_cvt_pk_bf16_f32 v54, v52, v53
  ds_write_b32 v156, v54
  v_permlane32_swap_b32 v56, v58
  v_permlane32_swap_b32 v57, v59
  v_add_f32 v56, v56, v58
  v_add_f32 v57, v57, v59
  v_cvt_pk_bf16_f32 v58, v56, v57
  ds_write_b32 v157, v58
  v_permlane32_swap_b32 v60, v62
  v_permlane32_swap_b32 v61, v63
  v_add_f32 v60, v60, v62
  v_add_f32 v61, v61, v63
  v_cvt_pk_bf16_f32 v62, v60, v61
  ds_write_b32 v158, v62
  s_branch cB_va0_t2d
cB_va0_rp:
  s_cmp_lg_u32 s37, 0
  s_cbranch_scc1 cB_va0_cont
cB_va0_rv:
  s_add_u32 s31, s31, 0x10000
  buffer_load_dwordx4 v[8:11], v2, s[8:11], s22 offen offset:0 sc1
  buffer_load_dwordx4 v[12:15], v2, s[8:11], s22 offen offset:1024 sc1
  buffer_load_dwordx4 v[16:19], v2, s[8:11], s22 offen offset:2048 sc1
  buffer_load_dwordx4 v[20:23], v2, s[8:11], s22 offen offset:3072 sc1
  buffer_load_dwordx4 v[24:27], v2, s[8:11], s34 offen offset:0 sc1
  buffer_load_dwordx4 v[28:31], v2, s[8:11], s34 offen offset:1024 sc1
  buffer_load_dwordx4 v[32:35], v2, s[8:11], s34 offen offset:2048 sc1
  buffer_load_dwordx4 v[36:39], v2, s[8:11], s34 offen offset:3072 sc1
  buffer_load_dwordx4 v[40:43], v2, s[8:11], s36 offen offset:0 sc1
  buffer_load_dwordx4 v[44:47], v2, s[8:11], s36 offen offset:1024 sc1
  s_waitcnt vmcnt(0)
  v_max3_u32 v52, v8, v9, v10
  v_max3_u32 v52, v52, v11, v12
  v_max3_u32 v52, v52, v13, v14
  v_max3_u32 v52, v52, v15, v16
  v_max3_u32 v52, v52, v17, v18
  v_max3_u32 v52, v52, v19, v20
  v_max3_u32 v52, v52, v21, v22
  v_max3_u32 v52, v52, v23, v24
  v_max3_u32 v52, v52, v25, v26
  v_max3_u32 v52, v52, v27, v28
  v_max3_u32 v52, v52, v29, v30
  v_max3_u32 v52, v52, v31, v32
  v_max3_u32 v52, v52, v33, v34
  v_max3_u32 v52, v52, v35, v36
  v_max3_u32 v52, v52, v37, v38
  v_max3_u32 v52, v52, v39, v40
  v_max3_u32 v52, v52, v41, v42
  v_max3_u32 v52, v52, v43, v44
  v_max3_u32 v52, v52, v45, v46
  v_max_u32 v52, v52, v47
  v_cmp_eq_u32 vcc, -1, v52
  s_mov_b32 s37, 1
  v_mov_b32 v48, 0
  v_mov_b32 v49, 0
  v_mov_b32 v50, 0
  v_mov_b32 v51, 0
  s_nop 1
  s_cbranch_vccz cB_va0_lp
  s_add_u32 s30, s30, 1
  s_cmp_lt_u32 s30, 400000
  s_cbranch_scc1 cB_va0_rv
  s_branch cB_abort
.p2align 6
cB_va1_loop:
  s_mov_b32 s30, 0
  s_barrier
  buffer_load_dwordx4 v[28:31], v2, s[8:11], s23 offen offset:1024 sc1
  buffer_load_dwordx4 v[32:35], v2, s[8:11], s23 offen offset:2048 sc1
  s_barrier
  buffer_store_dword v160, v1, s[8:11], s38 offen sc1
  s_add_u32 s22, s25, 0
  buffer_load_dwordx4 v[80:83], v6, s[8:11], s22 offen offset:0 sc1
  buffer_load_dwordx4 v[84:87], v6, s[8:11], s22 offen offset:1792 sc1
  s_add_u32 s22, s25, 3584
  buffer_load_dwordx4 v[88:91], v6, s[8:11], s22 offen offset:0 sc1
  buffer_load_dwordx4 v[92:95], v6, s[8:11], s22 offen offset:1792 sc1
  s_add_u32 s22, s25, 7168
  buffer_load_dwordx4 v[96:99], v6, s[8:11], s22 offen offset:0 sc1
  buffer_load_dwordx4 v[100:103], v6, s[8:11], s22 offen offset:1792 sc1
  s_add_u32 s22, s25, 10752
  buffer_load_dwordx4 v[104:107], v6, s[8:11], s22 offen offset:0 sc1
  buffer_load_dwordx4 v[108:111], v6, s[8:11], s22 offen offset:1792 sc1
  s_add_u32 s22, s25, 14336
  buffer_load_dwordx4 v[112:115], v6, s[8:11], s22 offen offset:0 sc1
  buffer_load_dwordx4 v[116:119], v6, s[8:11], s22 offen offset:1792 sc1
  s_add_u32 s22, s25, 17920
  buffer_load_dwordx4 v[120:123], v6, s[8:11], s22 offen offset:0 sc1
  buffer_load_dwordx4 v[124:127], v6, s[8:11], s22 offen offset:1792 sc1
  s_add_u32 s22, s25, 21504
  buffer_load_dwordx4 v[128:131], v6, s[8:11], s22 offen offset:0 sc1
  buffer_load_dwordx4 v[132:135], v6, s[8:11], s22 offen offset:1792 sc1
  s_add_u32 s22, s25, 25088
  buffer_load_dwordx4 v[136:139], v6, s[8:11], s22 offen offset:0 sc1
  buffer_load_dwordx4 v[140:143], v6, s[8:11], s22 offen offset:1792 sc1
  s_mul_i32 s38, s18, 7168
  s_add_u32 s38, s38, 87543808
  s_waitcnt vmcnt(17)
  ds_write_b128 v2, v[32:35] offset:14336
  v_smfmac_f32_16x16x64_bf16 v[36:39], v[28:31], a[40:47], v3
  v_smfmac_f32_16x16x64_bf16 v[40:43], v[28:31], a[96:103], v3
  v_smfmac_f32_16x16x64_bf16 v[44:47], v[28:31], a[152:159], v3
  v_smfmac_f32_16x16x64_bf16 v[48:51], v[28:31], a[208:215], v3
  v_smfmac_f32_16x16x64_bf16 v[52:55], v[28:31], v[184:191], v3
  s_waitcnt lgkmcnt(0)
  s_barrier
  ds_read_b128 v[8:11], v2 offset:8192
  ds_read_b128 v[12:15], v2 offset:9216
  ds_read_b128 v[16:19], v2 offset:10240
  ds_read_b128 v[20:23], v2 offset:11264
  ds_read_b128 v[24:27], v2 offset:12288
  v_smfmac_f32_16x16x64_bf16 v[56:59], v[28:31], v[240:247], v3
  v_smfmac_f32_16x16x64_bf16 v[36:39], v[32:35], a[48:55], v3
  v_smfmac_f32_16x16x64_bf16 v[40:43], v[32:35], a[104:111], v3
  v_smfmac_f32_16x16x64_bf16 v[44:47], v[32:35], a[160:167], v3
  v_smfmac_f32_16x16x64_bf16 v[48:51], v[32:35], a[216:223], v3
  v_smfmac_f32_16x16x64_bf16 v[52:55], v[32:35], v[192:199], v3
  ds_read_b128 v[64:67], v0 offset:0
  ds_read_b128 v[68:71], v0 offset:1024
  v_smfmac_f32_16x16x64_bf16 v[56:59], v[32:35], v[248:255], v3
  s_waitcnt lgkmcnt(6)
  ds_read_b128 v[72:75], v0 offset:2048
  ds_read_b128 v[76:79], v0 offset:3072
  v_smfmac_f32_16x16x64_bf16 v[36:39], v[8:11], a[0:7], v3
  s_waitcnt lgkmcnt(7)
  v_smfmac_f32_16x16x64_bf16 v[36:39], v[12:15], a[8:15], v3
  s_waitcnt lgkmcnt(6)
  v_smfmac_f32_16x16x64_bf16 v[36:39], v[16:19], a[16:23], v3
  s_waitcnt lgkmcnt(2)
  v_smfmac_f32_16x16x64_bf16 v[60:63], v[8:11], v[64:71], v3
  s_waitcnt lgkmcnt(5)
  ds_read_b128 v[144:147], v0 offset:4096
  ds_read_b128 v[148:151], v0 offset:5120
  v_smfmac_f32_16x16x64_bf16 v[36:39], v[20:23], a[24:31], v3
  s_waitcnt lgkmcnt(6)
  v_smfmac_f32_16x16x64_bf16 v[36:39], v[24:27], a[32:39], v3
  v_smfmac_f32_16x16x64_bf16 v[40:43], v[8:11], a[56:63], v3
  s_waitcnt lgkmcnt(2)
  v_smfmac_f32_16x16x64_bf16 v[60:63], v[12:15], v[72:79], v3
  ds_read_b128 v[64:67], v0 offset:6144
  ds_read_b128 v[68:71], v0 offset:7168
  v_smfmac_f32_16x16x64_bf16 v[40:43], v[12:15], a[64:71], v3
  v_permlane32_swap_b32 v36, v38
  v_smfmac_f32_16x16x64_bf16 v[40:43], v[16:19], a[72:79], v3
  v_permlane32_swap_b32 v37, v39
  v_smfmac_f32_16x16x64_bf16 v[40:43], v[20:23], a[80:87], v3
  s_waitcnt lgkmcnt(2)
  v_add_f32 v36, v36, v38
  v_smfmac_f32_16x16x64_bf16 v[60:63], v[16:19], v[144:151], v3
  ds_read_b128 v[72:75], v0 offset:8192
  ds_read_b128 v[76:79], v0 offset:9216
  v_add_f32 v37, v37, v39
  v_smfmac_f32_16x16x64_bf16 v[40:43], v[24:27], a[88:95], v3
  v_cmp_u_f32 vcc, v36, v37
  v_smfmac_f32_16x16x64_bf16 v[44:47], v[8:11], a[112:119], v3
  v_cvt_pk_bf16_f32 v38, v36, v37
  v_smfmac_f32_16x16x64_bf16 v[44:47], v[12:15], a[120:127], v3
  ds_write_b32 v152, v38
  s_waitcnt lgkmcnt(3)
  s_cbranch_vccnz cB_va1_slow
  v_permlane32_swap_b32 v40, v42
  v_smfmac_f32_16x16x64_bf16 v[60:63], v[20:23], v[64:71], v3
  ds_read_b128 v[144:147], v0 offset:10240
  ds_read_b128 v[148:151], v0 offset:11264
  v_permlane32_swap_b32 v41, v43
  v_smfmac_f32_16x16x64_bf16 v[44:47], v[16:19], a[128:135], v3
  buffer_store_dword v162, v1, s[8:11], s21 offen sc1
  v_add_f32 v40, v40, v42
  v_smfmac_f32_16x16x64_bf16 v[44:47], v[20:23], a[136:143], v3
  v_add_f32 v41, v41, v43
  v_smfmac_f32_16x16x64_bf16 v[44:47], v[24:27], a[144:151], v3
  s_waitcnt lgkmcnt(3)
  v_cvt_pk_bf16_f32 v42, v40, v41
  v_smfmac_f32_16x16x64_bf16 v[60:63], v[24:27], v[72:79], v3
  ds_write_b32 v153, v42
  ds_read_b128 v[64:67], v0 offset:12288
  ds_read_b128 v[68:71], v0 offset:13312
  v_smfmac_f32_16x16x64_bf16 v[48:51], v[8:11], a[168:175], v3
  s_nop 0
  v_permlane32_swap_b32 v44, v46
  v_smfmac_f32_16x16x64_bf16 v[48:51], v[12:15], a[176:183], v3
  v_permlane32_swap_b32 v45, v47
  v_smfmac_f32_16x16x64_bf16 v[48:51], v[16:19], a[184:191], v3
  s_waitcnt lgkmcnt(3)
  v_add_f32 v44, v44, v46
  v_smfmac_f32_16x16x64_bf16 v[60:63], v[28:31], v[144:151], v3
  v_add_f32 v45, v45, v47
  v_smfmac_f32_16x16x64_bf16 v[48:51], v[20:23], a[192:199], v3
  v_cvt_pk_bf16_f32 v46, v44, v45
  v_smfmac_f32_16x16x64_bf16 v[48:51], v[24:27], a[200:207], v3
  ds_write_b32 v154, v46
  v_smfmac_f32_16x16x64_bf16 v[52:55], v[8:11], a[224:231], v3
  s_waitcnt lgkmcnt(1)
  v_smfmac_f32_16x16x64_bf16 v[60:63], v[32:35], v[64:71], v3
  v_smfmac_f32_16x16x64_bf16 v[52:55], v[12:15], a[232:239], v3
  v_permlane32_swap_b32 v48, v50
  v_smfmac_f32_16x16x64_bf16 v[52:55], v[16:19], a[240:247], v3
  v_permlane32_swap_b32 v49, v51
  v_smfmac_f32_16x16x64_bf16 v[52:55], v[20:23], a[248:255], v3
  v_add_f32 v48, v48, v50
  v_smfmac_f32_16x16x64_bf16 v[52:55], v[24:27], v[176:183], v3
  v_add_f32 v49, v49, v51
  v_smfmac_f32_16x16x64_bf16 v[56:59], v[8:11], v[200:207], v3
  v_cvt_pk_bf16_f32 v50, v48, v49
  v_smfmac_f32_16x16x64_bf16 v[56:59], v[12:15], v[208:215], v3
  ds_write_b32 v155, v50
  v_permlane32_swap_b32 v60, v62
  v_smfmac_f32_16x16x64_bf16 v[56:59], v[16:19], v[216:223], v3
  v_permlane32_swap_b32 v61, v63
  v_smfmac_f32_16x16x64_bf16 v[56:59], v[20:23], v[224:231], v3
  v_add_f32 v60, v60, v62
  v_smfmac_f32_16x16x64_bf16 v[56:59], v[24:27], v[232:239], v3
  v_add_f32 v61, v61, v63
  v_cvt_pk_bf16_f32 v62, v60, v61
  ds_write_b32 v158, v62
  v_permlane32_swap_b32 v52, v54
  v_permlane32_swap_b32 v53, v55
  v_add_f32 v52, v52, v54
  v_add_f32 v53, v53, v55
  v_cvt_pk_bf16_f32 v54, v52, v53
  ds_write_b32 v156, v54
  v_permlane32_swap_b32 v56, v58
  v_permlane32_swap_b32 v57, v59
  v_add_f32 v56, v56, v58
  v_add_f32 v57, v57, v59
  v_cvt_pk_bf16_f32 v58, v56, v57
  ds_write_b32 v157, v58
cB_va1_t2d:
  s_add_u32 s22, s20, 9216
  s_add_u32 s34, s20, 13312
  s_add_u32 s36, s20, 7168
  s_mov_b32 s37, 0
  v_mov_b32 v48, 0
  v_mov_b32 v49, 0
  v_mov_b32 v50, 0
  v_mov_b32 v51, 0
  v_mov_b32 v163, s18
  s_waitcnt lgkmcnt(0)
  s_barrier
  buffer_load_dwordx4 v[8:11], v2, s[8:11], s22 offen offset:0 sc1
  buffer_load_dwordx4 v[12:15], v2, s[8:11], s22 offen offset:1024 sc1
  buffer_load_dwordx4 v[16:19], v2, s[8:11], s22 offen offset:2048 sc1
  buffer_load_dwordx4 v[20:23], v2, s[8:11], s22 offen offset:3072 sc1
  buffer_load_dwordx4 v[24:27], v2, s[8:11], s34 offen offset:0 sc1
  buffer_load_dwordx4 v[28:31], v2, s[8:11], s34 offen offset:1024 sc1
  buffer_load_dwordx4 v[32:35], v2, s[8:11], s34 offen offset:2048 sc1
  buffer_load_dwordx4 v[36:39], v2, s[8:11], s34 offen offset:3072 sc1
  buffer_load_dwordx4 v[40:43], v2, s[8:11], s36 offen offset:0 sc1
  buffer_load_dwordx4 v[44:47], v2, s[8:11], s36 offen offset:1024 sc1
  ds_read_b128 v[64:67], v2 offset:4096
  ds_read_b128 v[68:71], v2 offset:5120
  ds_read_b128 v[72:75], v2 offset:6144
  ds_read_b128 v[76:79], v2 offset:7168
cB_va1_lp:
  s_waitcnt vmcnt(9)
  v_smfmac_f32_16x16x64_bf16 v[48:51], v[8:11], v[80:87], v3
  s_waitcnt vmcnt(8)
  v_smfmac_f32_16x16x64_bf16 v[48:51], v[12:15], v[88:95], v3
  s_waitcnt vmcnt(7)
  v_smfmac_f32_16x16x64_bf16 v[48:51], v[16:19], v[96:103], v3
  v_max3_u32 v55, v8, v12, v16
  s_waitcnt vmcnt(6)
  v_smfmac_f32_16x16x64_bf16 v[48:51], v[20:23], v[104:111], v3
  v_max_u32 v55, v55, v20
  v_cmp_eq_u32 vcc, -1, v55
  s_waitcnt vmcnt(5)
  v_smfmac_f32_16x16x64_bf16 v[48:51], v[24:27], v[112:119], v3
  s_waitcnt vmcnt(4)
  v_smfmac_f32_16x16x64_bf16 v[48:51], v[28:31], v[120:127], v3
  s_cbranch_vccnz cB_va1_rv
  buffer_store_dword v163, v7, s[8:11], 0 offen sc1
  s_waitcnt vmcnt(4)
  v_smfmac_f32_16x16x64_bf16 v[48:51], v[32:35], v[128:135], v3
  s_waitcnt vmcnt(3)
  v_smfmac_f32_16x16x64_bf16 v[48:51], v[36:39], v[136:143], v3
  s_waitcnt vmcnt(2) lgkmcnt(0)
  v_smfmac_f32_16x16x64_bf16 v[48:51], v[40:43], v[64:71], v3
  s_waitcnt vmcnt(1)
  v_smfmac_f32_16x16x64_bf16 v[48:51], v[44:47], v[72:79], v3
  s_nop 7
  v_permlane32_swap_b32 v48, v50
  v_permlane32_swap_b32 v49, v51
  v_add_f32 v48, v48, v50
  v_add_f32 v49, v49, v51
  v_cvt_pk_bf16_f32 v160, v48, v49
  v_cmp_u_f32 vcc, v48, v49
  s_nop 0
  v_mov_b32_dpp v161, v160 quad_perm:[1,0,3,2] row_mask:0xf bank_mask:0xf
  v_perm_b32 v160, v161, v160, v5
  v_min_u32 v160, -2, v160
  s_cbranch_vccnz cB_va1_rp
cB_va1_cont:
  buffer_store_dword v160, v1, s[8:11], s21 offen sc1
  s_cmp_lg_u32 s19, 62
  s_cbranch_scc1 cB_va1_nl
  buffer_store_dword v160, v1, s[8:11], s38 offen sc1
  s_branch cB_done
cB_va1_nl:
  s_add_u32 s25, s25, 28672
  v_mov_b32 v36, 0
  v_mov_b32 v37, 0
  v_mov_b32 v38, 0
  v_mov_b32 v39, 0
  v_mov_b32 v40, 0
  v_mov_b32 v41, 0
  v_mov_b32 v42, 0
  v_mov_b32 v43, 0
  v_mov_b32 v44, 0
  v_mov_b32 v45, 0
  v_mov_b32 v46, 0
  v_mov_b32 v47, 0
  v_mov_b32 v48, 0
  v_mov_b32 v49, 0
  v_mov_b32 v50, 0
  v_mov_b32 v51, 0
  v_mov_b32 v52, 0
  v_mov_b32 v53, 0
  v_mov_b32 v54, 0
  v_mov_b32 v55, 0
  v_mov_b32 v56, 0
  v_mov_b32 v57, 0
  v_mov_b32 v58, 0
  v_mov_b32 v59, 0
  v_mov_b32 v60, 0
  v_mov_b32 v61, 0
  v_mov_b32 v62, 0
  v_mov_b32 v63, 0
  s_mov_b32 s19, s18
  s_add_u32 s18, s18, 1
  s_mov_b32 s22, s20
  s_mov_b32 s20, s21
  s_mov_b32 s21, s22
  s_add_u32 s23, s20, 4096
  s_branch cB_va1_loop
cB_va1_slow:
  s_waitcnt lgkmcnt(0)
cB_va1_sl1:
  s_add_u32 s31, s31, 0x1000000
  buffer_load_dwordx4 v[8:11], v2, s[8:11], s20 offen offset:0 sc1
  buffer_load_dwordx4 v[12:15], v2, s[8:11], s20 offen offset:1024 sc1
  buffer_load_dwordx4 v[16:19], v2, s[8:11], s20 offen offset:2048 sc1
  buffer_load_dwordx4 v[20:23], v2, s[8:11], s20 offen offset:3072 sc1
  buffer_load_dwordx4 v[24:27], v2, s[8:11], s23 offen offset:0 sc1
  buffer_load_dwordx4 v[28:31], v2, s[8:11], s23 offen offset:1024 sc1
  buffer_load_dwordx4 v[32:35], v2, s[8:11], s23 offen offset:2048 sc1
  s_waitcnt vmcnt(0)
  v_max3_u32 v36, v8, v9, v10
  v_max3_u32 v36, v36, v11, v12
  v_max3_u32 v36, v36, v13, v14
  v_max3_u32 v36, v36, v15, v16
  v_max3_u32 v36, v36, v17, v18
  v_max3_u32 v36, v36, v19, v20
  v_max3_u32 v36, v36, v21, v22
  v_max3_u32 v36, v36, v23, v24
  v_max3_u32 v36, v36, v25, v26
  v_max3_u32 v36, v36, v27, v28
  v_max3_u32 v36, v36, v29, v30
  v_max3_u32 v36, v36, v31, v32
  v_max3_u32 v36, v36, v33, v34
  v_max_u32 v36, v36, v35
  v_cmp_eq_u32 vcc, -1, v36
  s_cbranch_vccz cB_va1_sl2
  s_add_u32 s30, s30, 1
  s_cmp_lt_u32 s30, 400000
  s_cbranch_scc1 cB_va1_sl1
  s_branch cB_abort
cB_va1_sl2:
  v_mov_b32 v36, 0
  v_mov_b32 v37, 0
  v_mov_b32 v38, 0
  v_mov_b32 v39, 0
  v_mov_b32 v40, 0
  v_mov_b32 v41, 0
  v_mov_b32 v42, 0
  v_mov_b32 v43, 0
  v_mov_b32 v44, 0
  v_mov_b32 v45, 0
  v_mov_b32 v46, 0
  v_mov_b32 v47, 0
  v_mov_b32 v48, 0
  v_mov_b32 v49, 0
  v_mov_b32 v50, 0
  v_mov_b32 v51, 0
  v_mov_b32 v52, 0
  v_mov_b32 v53, 0
  v_mov_b32 v54, 0
  v_mov_b32 v55, 0
  v_mov_b32 v56, 0
  v_mov_b32 v57, 0
  v_mov_b32 v58, 0
  v_mov_b32 v59, 0
  v_mov_b32 v60, 0
  v_mov_b32 v61, 0
  v_mov_b32 v62, 0
  v_mov_b32 v63, 0
  buffer_store_dword v162, v1, s[8:11], s21 offen sc1
  ds_read_b128 v[64:67], v0 offset:0
  ds_read_b128 v[68:71], v0 offset:1024
  v_smfmac_f32_16x16x64_bf16 v[36:39], v[8:11], a[0:7], v3
  v_smfmac_f32_16x16x64_bf16 v[40:43], v[8:11], a[56:63], v3
  v_smfmac_f32_16x16x64_bf16 v[44:47], v[8:11], a[112:119], v3
  v_smfmac_f32_16x16x64_bf16 v[48:51], v[8:11], a[168:175], v3
  v_smfmac_f32_16x16x64_bf16 v[52:55], v[8:11], a[224:231], v3
  v_smfmac_f32_16x16x64_bf16 v[56:59], v[8:11], v[200:207], v3
  s_waitcnt lgkmcnt(0)
  v_smfmac_f32_16x16x64_bf16 v[60:63], v[8:11], v[64:71], v3
  ds_read_b128 v[72:75], v0 offset:2048
  ds_read_b128 v[76:79], v0 offset:3072
  v_smfmac_f32_16x16x64_bf16 v[36:39], v[12:15], a[8:15], v3
  v_smfmac_f32_16x16x64_bf16 v[40:43], v[12:15], a[64:71], v3
  v_smfmac_f32_16x16x64_bf16 v[44:47], v[12:15], a[120:127], v3
  v_smfmac_f32_16x16x64_bf16 v[48:51], v[12:15], a[176:183], v3
  v_smfmac_f32_16x16x64_bf16 v[52:55], v[12:15], a[232:239], v3
  v_smfmac_f32_16x16x64_bf16 v[56:59], v[12:15], v[208:215], v3
  s_waitcnt lgkmcnt(0)
  v_smfmac_f32_16x16x64_bf16 v[60:63], v[12:15], v[72:79], v3
  ds_read_b128 v[144:147], v0 offset:4096
  ds_read_b128 v[148:151], v0 offset:5120
  v_smfmac_f32_16x16x64_bf16 v[36:39], v[16:19], a[16:23], v3
  v_smfmac_f32_16x16x64_bf16 v[40:43], v[16:19], a[72:79], v3
  v_smfmac_f32_16x16x64_bf16 v[44:47], v[16:19], a[128:135], v3
  v_smfmac_f32_16x16x64_bf16 v[48:51], v[16:19], a[184:191], v3
  v_smfmac_f32_16x16x64_bf16 v[52:55], v[16:19], a[240:247], v3
  v_smfmac_f32_16x16x64_bf16 v[56:59], v[16:19], v[216:223], v3
  s_waitcnt lgkmcnt(0)
  v_smfmac_f32_16x16x64_bf16 v[60:63], v[16:19], v[144:151], v3
  ds_read_b128 v[64:67], v0 offset:6144
  ds_read_b128 v[68:71], v0 offset:7168
  v_smfmac_f32_16x16x64_bf16 v[36:39], v[20:23], a[24:31], v3
  v_smfmac_f32_16x16x64_bf16 v[40:43], v[20:23], a[80:87], v3
  v_smfmac_f32_16x16x64_bf16 v[44:47], v[20:23], a[136:143], v3
  v_smfmac_f32_16x16x64_bf16 v[48:51], v[20:23], a[192:199], v3
  v_smfmac_f32_16x16x64_bf16 v[52:55], v[20:23], a[248:255], v3
  v_smfmac_f32_16x16x64_bf16 v[56:59], v[20:23], v[224:231], v3
  s_waitcnt lgkmcnt(0)
  v_smfmac_f32_16x16x64_bf16 v[60:63], v[20:23], v[64:71], v3
  ds_read_b128 v[72:75], v0 offset:8192
  ds_read_b128 v[76:79], v0 offset:9216
  v_smfmac_f32_16x16x64_bf16 v[36:39], v[24:27], a[32:39], v3
  v_smfmac_f32_16x16x64_bf16 v[40:43], v[24:27], a[88:95], v3
  v_smfmac_f32_16x16x64_bf16 v[44:47], v[24:27], a[144:151], v3
  v_smfmac_f32_16x16x64_bf16 v[48:51], v[24:27], a[200:207], v3
  v_smfmac_f32_16x16x64_bf16 v[52:55], v[24:27], v[176:183], v3
  v_smfmac_f32_16x16x64_bf16 v[56:59], v[24:27], v[232:239], v3
  s_waitcnt lgkmcnt(0)
  v_smfmac_f32_16x16x64_bf16 v[60:63], v[24:27], v[72:79], v3
  ds_read_b128 v[144:147], v0 offset:10240
  ds_read_b128 v[148:151], v0 offset:11264
  v_smfmac_f32_16x16x64_bf16 v[36:39], v[28:31], a[40:47], v3
  v_smfmac_f32_16x16x64_bf16 v[40:43], v[28:31], a[96:103], v3
  v_smfmac_f32_16x16x64_bf16 v[44:47], v[28:31], a[152:159], v3
  v_smfmac_f32_16x16x64_bf16 v[48:51], v[28:31], a[208:215], v3
  v_smfmac_f32_16x16x64_bf16 v[52:55], v[28:31], v[184:191], v3
  v_smfmac_f32_16x16x64_bf16 v[56:59], v[28:31], v[240:247], v3
  s_waitcnt lgkmcnt(0)
  v_smfmac_f32_16x16x64_bf16 v[60:63], v[28:31], v[144:151], v3
  ds_read_b128 v[64:67], v0 offset:12288
  ds_read_b128 v[68:71], v0 offset:13312
  v_smfmac_f32_16x16x64_bf16 v[36:39], v[32:35], a[48:55], v3
  v_smfmac_f32_16x16x64_bf16 v[40:43], v[32:35], a[104:111], v3
  v_smfmac_f32_16x16x64_bf16 v[44:47], v[32:35], a[160:167], v3
  v_smfmac_f32_16x16x64_bf16 v[48:51], v[32:35], a[216:223], v3
  v_smfmac_f32_16x16x64_bf16 v[52:55], v[32:35], v[192:199], v3
  v_smfmac_f32_16x16x64_bf16 v[56:59], v[32:35], v[248:255], v3
  s_waitcnt lgkmcnt(0)
  v_smfmac_f32_16x16x64_bf16 v[60:63], v[32:35], v[64:71], v3
  v_permlane32_swap_b32 v36, v38
  v_permlane32_swap_b32 v37, v39
  v_add_f32 v36, v36, v38
  v_add_f32 v37, v37, v39
  v_cvt_pk_bf16_f32 v38, v36, v37
  ds_write_b32 v152, v38
  v_permlane32_swap_b32 v40, v42
  v_permlane32_swap_b32 v41, v43
  v_add_f32 v40, v40, v42
  v_add_f32 v41, v41, v43
  v_cvt_pk_bf16_f32 v42, v40, v41
  ds_write_b32 v153, v42
  v_permlane32_swap_b32 v44, v46
  v_permlane32_swap_b32 v45, v47
  v_add_f32 v44, v44, v46
  v_add_f32 v45, v45, v47
  v_cvt_pk_bf16_f32 v46, v44, v45
  ds_write_b32 v154, v46
  v_permlane32_swap_b32 v48, v50
  v_permlane32_swap_b32 v49, v51
  v_add_f32 v48, v48, v50
  v_add_f32 v49, v49, v51
  v_cvt_pk_bf16_f32 v50, v48, v49
  ds_write_b32 v155, v50
  v_permlane32_swap_b32 v52, v54
  v_permlane32_swap_b32 v53, v55
  v_add_f32 v52, v52, v54
  v_add_f32 v53, v53, v55
  v_cvt_pk_bf16_f32 v54, v52, v53
  ds_write_b32 v156, v54
  v_permlane32_swap_b32 v56, v58
  v_permlane32_swap_b32 v57, v59
  v_add_f32 v56, v56, v58
  v_add_f32 v57, v57, v59
  v_cvt_pk_bf16_f32 v58, v56, v57
  ds_write_b32 v157, v58
  v_permlane32_swap_b32 v60, v62
  v_permlane32_swap_b32 v61, v63
  v_add_f32 v60, v60, v62
  v_add_f32 v61, v61, v63
  v_cvt_pk_bf16_f32 v62, v60, v61
  ds_write_b32 v158, v62
  s_branch cB_va1_t2d
cB_va1_rp:
  s_cmp_lg_u32 s37, 0
  s_cbranch_scc1 cB_va1_cont
cB_va1_rv:
  s_add_u32 s31, s31, 0x10000
  buffer_load_dwordx4 v[8:11], v2, s[8:11], s22 offen offset:0 sc1
  buffer_load_dwordx4 v[12:15], v2, s[8:11], s22 offen offset:1024 sc1
  buffer_load_dwordx4 v[16:19], v2, s[8:11], s22 offen offset:2048 sc1
  buffer_load_dwordx4 v[20:23], v2, s[8:11], s22 offen offset:3072 sc1
  buffer_load_dwordx4 v[24:27], v2, s[8:11], s34 offen offset:0 sc1
  buffer_load_dwordx4 v[28:31], v2, s[8:11], s34 offen offset:1024 sc1
  buffer_load_dwordx4 v[32:35], v2, s[8:11], s34 offen offset:2048 sc1
  buffer_load_dwordx4 v[36:39], v2, s[8:11], s34 offen offset:3072 sc1
  buffer_load_dwordx4 v[40:43], v2, s[8:11], s36 offen offset:0 sc1
  buffer_load_dwordx4 v[44:47], v2, s[8:11], s36 offen offset:1024 sc1
  s_waitcnt vmcnt(0)
  v_max3_u32 v52, v8, v9, v10
  v_max3_u32 v52, v52, v11, v12
  v_max3_u32 v52, v52, v13, v14
  v_max3_u32 v52, v52, v15, v16
  v_max3_u32 v52, v52, v17, v18
  v_max3_u32 v52, v52, v19, v20
  v_max3_u32 v52, v52, v21, v22
  v_max3_u32 v52, v52, v23, v24
  v_max3_u32 v52, v52, v25, v26
  v_max3_u32 v52, v52, v27, v28
  v_max3_u32 v52, v52, v29, v30
  v_max3_u32 v52, v52, v31, v32
  v_max3_u32 v52, v52, v33, v34
  v_max3_u32 v52, v52, v35, v36
  v_max3_u32 v52, v52, v37, v38
  v_max3_u32 v52, v52, v39, v40
  v_max3_u32 v52, v52, v41, v42
  v_max3_u32 v52, v52, v43, v44
  v_max3_u32 v52, v52, v45, v46
  v_max_u32 v52, v52, v47
  v_cmp_eq_u32 vcc, -1, v52
  s_mov_b32 s37, 1
  v_mov_b32 v48, 0
  v_mov_b32 v49, 0
  v_mov_b32 v50, 0
  v_mov_b32 v51, 0
  s_nop 1
  s_cbranch_vccz cB_va1_lp
  s_add_u32 s30, s30, 1
  s_cmp_lt_u32 s30, 400000
  s_cbranch_scc1 cB_va1_rv
  s_branch cB_abort
.p2align 6
cB_va2_loop:
  s_mov_b32 s30, 0
  buffer_load_dword v100, v119, s[8:11], 0 offen sc1
  buffer_load_dword v101, v119, s[8:11], 0 offen sc1
  buffer_load_dword v102, v119, s[8:11], 0 offen sc1
cB_va2_fp_l:
  s_waitcnt vmcnt(2)
  v_cmp_gt_u32 vcc, s19, v100
  s_cbranch_vccz cB_va2_fp_d
  buffer_load_dword v100, v119, s[8:11], 0 offen sc1
  s_waitcnt vmcnt(2)
  v_cmp_gt_u32 vcc, s19, v101
  s_cbranch_vccz cB_va2_fp_d
  buffer_load_dword v101, v119, s[8:11], 0 offen sc1
  s_waitcnt vmcnt(2)
  v_cmp_gt_u32 vcc, s19, v102
  s_cbranch_vccz cB_va2_fp_d
  buffer_load_dword v102, v119, s[8:11], 0 offen sc1
  s_add_u32 s30, s30, 1
  s_cmp_lt_u32 s30, 400000
  s_cbranch_scc1 cB_va2_fp_l
  s_branch cB_abort
cB_va2_fp_d:
  buffer_load_dwordx4 v[8:11], v2, s[8:11], s20 offen offset:0 sc1
  buffer_load_dwordx4 v[12:15], v2, s[8:11], s20 offen offset:1024 sc1
  s_barrier
  s_barrier
  s_waitcnt vmcnt(0)
  ds_write_b128 v2, v[8:11] offset:8192
  ds_write_b128 v2, v[12:15] offset:9216
  v_smfmac_f32_16x16x64_bf16 v[36:39], v[8:11], a[0:7], v3
  v_smfmac_f32_16x16x64_bf16 v[40:43], v[8:11], a[56:63], v3
  v_smfmac_f32_16x16x64_bf16 v[44:47], v[8:11], a[112:119], v3
  v_smfmac_f32_16x16x64_bf16 v[48:51], v[8:11], a[168:175], v3
  v_smfmac_f32_16x16x64_bf16 v[52:55], v[8:11], a[224:231], v3
  s_waitcnt lgkmcnt(0)
  s_barrier
  ds_read_b128 v[16:19], v2 offset:10240
  ds_read_b128 v[20:23], v2 offset:11264
  ds_read_b128 v[24:27], v2 offset:12288
  ds_read_b128 v[28:31], v2 offset:13312
  ds_read_b128 v[32:35], v2 offset:14336
  v_smfmac_f32_16x16x64_bf16 v[56:59], v[8:11], v[144:151], v3
  v_smfmac_f32_16x16x64_bf16 v[60:63], v[8:11], v[200:207], v3
  v_smfmac_f32_16x16x64_bf16 v[36:39], v[12:15], a[8:15], v3
  v_smfmac_f32_16x16x64_bf16 v[40:43], v[12:15], a[64:71], v3
  v_smfmac_f32_16x16x64_bf16 v[44:47], v[12:15], a[120:127], v3
  v_smfmac_f32_16x16x64_bf16 v[48:51], v[12:15], a[176:183], v3
  v_smfmac_f32_16x16x64_bf16 v[52:55], v[12:15], a[232:239], v3
  v_smfmac_f32_16x16x64_bf16 v[56:59], v[12:15], v[152:159], v3
  v_smfmac_f32_16x16x64_bf16 v[60:63], v[12:15], v[208:215], v3
  s_waitcnt lgkmcnt(4)
  v_smfmac_f32_16x16x64_bf16 v[36:39], v[16:19], a[16:23], v3
  s_waitcnt lgkmcnt(3)
  v_smfmac_f32_16x16x64_bf16 v[36:39], v[20:23], a[24:31], v3
  s_waitcnt lgkmcnt(2)
  v_smfmac_f32_16x16x64_bf16 v[36:39], v[24:27], a[32:39], v3
  s_waitcnt lgkmcnt(1)
  v_smfmac_f32_16x16x64_bf16 v[36:39], v[28:31], a[40:47], v3
  s_waitcnt lgkmcnt(0)
  v_smfmac_f32_16x16x64_bf16 v[36:39], v[32:35], a[48:55], v3
  v_smfmac_f32_16x16x64_bf16 v[40:43], v[16:19], a[72:79], v3
  v_smfmac_f32_16x16x64_bf16 v[40:43], v[20:23], a[80:87], v3
  v_smfmac_f32_16x16x64_bf16 v[40:43], v[24:27], a[88:95], v3
  v_permlane32_swap_b32 v36, v38
  v_smfmac_f32_16x16x64_bf16 v[40:43], v[28:31], a[96:103], v3
  v_permlane32_swap_b32 v37, v39
  v_smfmac_f32_16x16x64_bf16 v[40:43], v[32:35], a[104:111], v3
  v_add_f32 v36, v36, v38
  v_smfmac_f32_16x16x64_bf16 v[44:47], v[16:19], a[128:135], v3
  v_add_f32 v37, v37, v39
  v_smfmac_f32_16x16x64_bf16 v[44:47], v[20:23], a[136:143], v3
  v_cmp_u_f32 vcc, v36, v37
  v_smfmac_f32_16x16x64_bf16 v[44:47], v[24:27], a[144:151], v3
  v_cvt_pk_bf16_f32 v38, v36, v37
  v_smfmac_f32_16x16x64_bf16 v[44:47], v[28:31], a[152:159], v3
  ds_write_b32 v104, v38
  s_cbranch_vccnz cB_va2_slow
  v_permlane32_swap_b32 v40, v42
  v_smfmac_f32_16x16x64_bf16 v[44:47], v[32:35], a[160:167], v3
  v_permlane32_swap_b32 v41, v43
  v_smfmac_f32_16x16x64_bf16 v[48:51], v[16:19], a[184:191], v3
  v_add_f32 v40, v40, v42
  v_smfmac_f32_16x16x64_bf16 v[48:51], v[20:23], a[192:199], v3
  v_add_f32 v41, v41, v43
  v_smfmac_f32_16x16x64_bf16 v[48:51], v[24:27], a[200:207], v3
  v_cvt_pk_bf16_f32 v42, v40, v41
  v_smfmac_f32_16x16x64_bf16 v[48:51], v[28:31], a[208:215], v3
  ds_write_b32 v105, v42
  v_permlane32_swap_b32 v44, v46
  v_smfmac_f32_16x16x64_bf16 v[48:51], v[32:35], a[216:223], v3
  v_permlane32_swap_b32 v45, v47
  v_smfmac_f32_16x16x64_bf16 v[52:55], v[16:19], a[240:247], v3
  v_add_f32 v44, v44, v46
  v_smfmac_f32_16x16x64_bf16 v[52:55], v[20:23], a[248:255], v3
  v_add_f32 v45, v45, v47
  v_smfmac_f32_16x16x64_bf16 v[52:55], v[24:27], v[120:127], v3
  v_cvt_pk_bf16_f32 v46, v44, v45
  v_smfmac_f32_16x16x64_bf16 v[52:55], v[28:31], v[128:135], v3
  ds_write_b32 v106, v46
  v_permlane32_swap_b32 v48, v50
  v_smfmac_f32_16x16x64_bf16 v[52:55], v[32:35], v[136:143], v3
  v_permlane32_swap_b32 v49, v51
  v_smfmac_f32_16x16x64_bf16 v[56:59], v[16:19], v[160:167], v3
  v_add_f32 v48, v48, v50
  v_smfmac_f32_16x16x64_bf16 v[56:59], v[20:23], v[168:175], v3
  v_add_f32 v49, v49, v51
  v_smfmac_f32_16x16x64_bf16 v[56:59], v[24:27], v[176:183], v3
  v_cvt_pk_bf16_f32 v50, v48, v49
  v_smfmac_f32_16x16x64_bf16 v[56:59], v[28:31], v[184:191], v3
  ds_write_b32 v107, v50
  v_permlane32_swap_b32 v52, v54
  v_smfmac_f32_16x16x64_bf16 v[56:59], v[32:35], v[192:199], v3
  v_permlane32_swap_b32 v53, v55
  v_smfmac_f32_16x16x64_bf16 v[60:63], v[16:19], v[216:223], v3
  v_add_f32 v52, v52, v54
  v_smfmac_f32_16x16x64_bf16 v[60:63], v[20:23], v[224:231], v3
  v_add_f32 v53, v53, v55
  v_smfmac_f32_16x16x64_bf16 v[60:63], v[24:27], v[232:239], v3
  v_cvt_pk_bf16_f32 v54, v52, v53
  v_smfmac_f32_16x16x64_bf16 v[60:63], v[28:31], v[240:247], v3
  ds_write_b32 v108, v54
  v_permlane32_swap_b32 v56, v58
  v_smfmac_f32_16x16x64_bf16 v[60:63], v[32:35], v[248:255], v3
  v_permlane32_swap_b32 v57, v59
  v_add_f32 v56, v56, v58
  v_add_f32 v57, v57, v59
  v_cvt_pk_bf16_f32 v58, v56, v57
  ds_write_b32 v109, v58
  s_nop 2
  v_permlane32_swap_b32 v60, v62
  v_permlane32_swap_b32 v61, v63
  v_add_f32 v60, v60, v62
  v_add_f32 v61, v61, v63
  v_cvt_pk_bf16_f32 v62, v60, v61
  ds_write_b32 v110, v62
cB_va2_t2d:
  v_mov_b32 v117, s18
  s_waitcnt lgkmcnt(0)
  s_barrier
  s_cmp_eq_u32 s19, 62
  s_cbranch_scc1 cB_done
  s_sleep 1
  v_mov_b32 v36, 0
  v_mov_b32 v37, 0
  v_mov_b32 v38, 0
  v_mov_b32 v39, 0
  v_mov_b32 v40, 0
  v_mov_b32 v41, 0
  v_mov_b32 v42, 0
  v_mov_b32 v43, 0
  v_mov_b32 v44, 0
  v_mov_b32 v45, 0
  v_mov_b32 v46, 0
  v_mov_b32 v47, 0
  v_mov_b32 v48, 0
  v_mov_b32 v49, 0
  v_mov_b32 v50, 0
  v_mov_b32 v51, 0
  v_mov_b32 v52, 0
  v_mov_b32 v53, 0
  v_mov_b32 v54, 0
  v_mov_b32 v55, 0
  v_mov_b32 v56, 0
  v_mov_b32 v57, 0
  v_mov_b32 v58, 0
  v_mov_b32 v59, 0
  v_mov_b32 v60, 0
  v_mov_b32 v61, 0
  v_mov_b32 v62, 0
  v_mov_b32 v63, 0
  s_sleep 3
  s_mov_b32 s19, s18
  s_add_u32 s18, s18, 1
  s_mov_b32 s22, s20
  s_mov_b32 s20, s21
  s_mov_b32 s21, s22
  s_add_u32 s23, s20, 4096
  s_branch cB_va2_loop
cB_va2_slow:
  s_waitcnt lgkmcnt(0)
cB_va2_sl1:
  s_add_u32 s31, s31, 0x1000000
  buffer_load_dwordx4 v[8:11], v2, s[8:11], s20 offen offset:0 sc1
  buffer_load_dwordx4 v[12:15], v2, s[8:11], s20 offen offset:1024 sc1
  buffer_load_dwordx4 v[16:19], v2, s[8:11], s20 offen offset:2048 sc1
  buffer_load_dwordx4 v[20:23], v2, s[8:11], s20 offen offset:3072 sc1
  buffer_load_dwordx4 v[24:27], v2, s[8:11], s23 offen offset:0 sc1
  buffer_load_dwordx4 v[28:31], v2, s[8:11], s23 offen offset:1024 sc1
  buffer_load_dwordx4 v[32:35], v2, s[8:11], s23 offen offset:2048 sc1
  s_waitcnt vmcnt(0)
  v_max3_u32 v36, v8, v9, v10
  v_max3_u32 v36, v36, v11, v12
  v_max3_u32 v36, v36, v13, v14
  v_max3_u32 v36, v36, v15, v16
  v_max3_u32 v36, v36, v17, v18
  v_max3_u32 v36, v36, v19, v20
  v_max3_u32 v36, v36, v21, v22
  v_max3_u32 v36, v36, v23, v24
  v_max3_u32 v36, v36, v25, v26
  v_max3_u32 v36, v36, v27, v28
  v_max3_u32 v36, v36, v29, v30
  v_max3_u32 v36, v36, v31, v32
  v_max3_u32 v36, v36, v33, v34
  v_max_u32 v36, v36, v35
  v_cmp_eq_u32 vcc, -1, v36
  s_cbranch_vccz cB_va2_sl2
  s_add_u32 s30, s30, 1
  s_cmp_lt_u32 s30, 400000
  s_cbranch_scc1 cB_va2_sl1
  s_branch cB_abort
cB_va2_sl2:
  v_mov_b32 v36, 0
  v_mov_b32 v37, 0
  v_mov_b32 v38, 0
  v_mov_b32 v39, 0
  v_mov_b32 v40, 0
  v_mov_b32 v41, 0
  v_mov_b32 v42, 0
  v_mov_b32 v43, 0
  v_mov_b32 v44, 0
  v_mov_b32 v45, 0
  v_mov_b32 v46, 0
  v_mov_b32 v47, 0
  v_mov_b32 v48, 0
  v_mov_b32 v49, 0
  v_mov_b32 v50, 0
  v_mov_b32 v51, 0
  v_mov_b32 v52, 0
  v_mov_b32 v53, 0
  v_mov_b32 v54, 0
  v_mov_b32 v55, 0
  v_mov_b32 v56, 0
  v_mov_b32 v57, 0
  v_mov_b32 v58, 0
  v_mov_b32 v59, 0
  v_mov_b32 v60, 0
  v_mov_b32 v61, 0
  v_mov_b32 v62, 0
  v_mov_b32 v63, 0
  v_smfmac_f32_16x16x64_bf16 v[36:39], v[8:11], a[0:7], v3
  v_smfmac_f32_16x16x64_bf16 v[40:43], v[8:11], a[56:63], v3
  v_smfmac_f32_16x16x64_bf16 v[44:47], v[8:11], a[112:119], v3
  v_smfmac_f32_16x16x64_bf16 v[48:51], v[8:11], a[168:175], v3
  v_smfmac_f32_16x16x64_bf16 v[52:55], v[8:11], a[224:231], v3
  v_smfmac_f32_16x16x64_bf16 v[56:59], v[8:11], v[144:151], v3
  v_smfmac_f32_16x16x64_bf16 v[60:63], v[8:11], v[200:207], v3
  v_smfmac_f32_16x16x64_bf16 v[36:39], v[12:15], a[8:15], v3
  v_smfmac_f32_16x16x64_bf16 v[40:43], v[12:15], a[64:71], v3
  v_smfmac_f32_16x16x64_bf16 v[44:47], v[12:15], a[120:127], v3
  v_smfmac_f32_16x16x64_bf16 v[48:51], v[12:15], a[176:183], v3
  v_smfmac_f32_16x16x64_bf16 v[52:55], v[12:15], a[232:239], v3
  v_smfmac_f32_16x16x64_bf16 v[56:59], v[12:15], v[152:159], v3
  v_smfmac_f32_16x16x64_bf16 v[60:63], v[12:15], v[208:215], v3
  v_smfmac_f32_16x16x64_bf16 v[36:39], v[16:19], a[16:23], v3
  v_smfmac_f32_16x16x64_bf16 v[40:43], v[16:19], a[72:79], v3
  v_smfmac_f32_16x16x64_bf16 v[44:47], v[16:19], a[128:135], v3
  v_smfmac_f32_16x16x64_bf16 v[48:51], v[16:19], a[184:191], v3
  v_smfmac_f32_16x16x64_bf16 v[52:55], v[16:19], a[240:247], v3
  v_smfmac_f32_16x16x64_bf16 v[56:59], v[16:19], v[160:167], v3
  v_smfmac_f32_16x16x64_bf16 v[60:63], v[16:19], v[216:223], v3
  v_smfmac_f32_16x16x64_bf16 v[36:39], v[20:23], a[24:31], v3
  v_smfmac_f32_16x16x64_bf16 v[40:43], v[20:23], a[80:87], v3
  v_smfmac_f32_16x16x64_bf16 v[44:47], v[20:23], a[136:143], v3
  v_smfmac_f32_16x16x64_bf16 v[48:51], v[20:23], a[192:199], v3
  v_smfmac_f32_16x16x64_bf16 v[52:55], v[20:23], a[248:255], v3
  v_smfmac_f32_16x16x64_bf16 v[56:59], v[20:23], v[168:175], v3
  v_smfmac_f32_16x16x64_bf16 v[60:63], v[20:23], v[224:231], v3
  v_smfmac_f32_16x16x64_bf16 v[36:39], v[24:27], a[32:39], v3
  v_smfmac_f32_16x16x64_bf16 v[40:43], v[24:27], a[88:95], v3
  v_smfmac_f32_16x16x64_bf16 v[44:47], v[24:27], a[144:151], v3
  v_smfmac_f32_16x16x64_bf16 v[48:51], v[24:27], a[200:207], v3
  v_smfmac_f32_16x16x64_bf16 v[52:55], v[24:27], v[120:127], v3
  v_smfmac_f32_16x16x64_bf16 v[56:59], v[24:27], v[176:183], v3
  v_smfmac_f32_16x16x64_bf16 v[60:63], v[24:27], v[232:239], v3
  v_smfmac_f32_16x16x64_bf16 v[36:39], v[28:31], a[40:47], v3
  v_smfmac_f32_16x16x64_bf16 v[40:43], v[28:31], a[96:103], v3
  v_smfmac_f32_16x16x64_bf16 v[44:47], v[28:31], a[152:159], v3
  v_smfmac_f32_16x16x64_bf16 v[48:51], v[28:31], a[208:215], v3
  v_smfmac_f32_16x16x64_bf16 v[52:55], v[28:31], v[128:135], v3
  v_smfmac_f32_16x16x64_bf16 v[56:59], v[28:31], v[184:191], v3
  v_smfmac_f32_16x16x64_bf16 v[60:63], v[28:31], v[240:247], v3
  v_smfmac_f32_16x16x64_bf16 v[36:39], v[32:35], a[48:55], v3
  v_smfmac_f32_16x16x64_bf16 v[40:43], v[32:35], a[104:111], v3
  v_smfmac_f32_16x16x64_bf16 v[44:47], v[32:35], a[160:167], v3
  v_smfmac_f32_16x16x64_bf16 v[48:51], v[32:35], a[216:223], v3
  v_smfmac_f32_16x16x64_bf16 v[52:55], v[32:35], v[136:143], v3
  v_smfmac_f32_16x16x64_bf16 v[56:59], v[32:35], v[192:199], v3
  v_smfmac_f32_16x16x64_bf16 v[60:63], v[32:35], v[248:255], v3
  v_permlane32_swap_b32 v36, v38
  v_permlane32_swap_b32 v37, v39
  v_add_f32 v36, v36, v38
  v_add_f32 v37, v37, v39
  v_cvt_pk_bf16_f32 v38, v36, v37
  ds_write_b32 v104, v38
  v_permlane32_swap_b32 v40, v42
  v_permlane32_swap_b32 v41, v43
  v_add_f32 v40, v40, v42
  v_add_f32 v41, v41, v43
  v_cvt_pk_bf16_f32 v42, v40, v41
  ds_write_b32 v105, v42
  v_permlane32_swap_b32 v44, v46
  v_permlane32_swap_b32 v45, v47
  v_add_f32 v44, v44, v46
  v_add_f32 v45, v45, v47
  v_cvt_pk_bf16_f32 v46, v44, v45
  ds_write_b32 v106, v46
  v_permlane32_swap_b32 v48, v50
  v_permlane32_swap_b32 v49, v51
  v_add_f32 v48, v48, v50
  v_add_f32 v49, v49, v51
  v_cvt_pk_bf16_f32 v50, v48, v49
  ds_write_b32 v107, v50
  v_permlane32_swap_b32 v52, v54
  v_permlane32_swap_b32 v53, v55
  v_add_f32 v52, v52, v54
  v_add_f32 v53, v53, v55
  v_cvt_pk_bf16_f32 v54, v52, v53
  ds_write_b32 v108, v54
  v_permlane32_swap_b32 v56, v58
  v_permlane32_swap_b32 v57, v59
  v_add_f32 v56, v56, v58
  v_add_f32 v57, v57, v59
  v_cvt_pk_bf16_f32 v58, v56, v57
  ds_write_b32 v109, v58
  v_permlane32_swap_b32 v60, v62
  v_permlane32_swap_b32 v61, v63
  v_add_f32 v60, v60, v62
  v_add_f32 v61, v61, v63
  v_cvt_pk_bf16_f32 v62, v60, v61
  ds_write_b32 v110, v62
  s_branch cB_va2_t2d
.p2align 6
cB_va3_loop:
  s_mov_b32 s30, 0
  s_barrier
  buffer_load_dwordx4 v[16:19], v2, s[8:11], s20 offen offset:2048 sc1
  buffer_load_dwordx4 v[20:23], v2, s[8:11], s20 offen offset:3072 sc1
  s_barrier
  buffer_load_dword v100, v116, s[8:11], s39 offen sc1
  s_add_u32 s27, s19, 2
  s_min_u32 s27, s27, 63
  s_lshr_b32 s27, s27, 3
  s_lshl_b32 s27, s27, 6
  s_add_u32 s27, s27, s35
  buffer_load_dword v101, off, s[8:11], s27 sc1
  s_add_u32 s39, s39, 28672
  s_waitcnt vmcnt(2)
  ds_write_b128 v2, v[16:19] offset:10240
  ds_write_b128 v2, v[20:23] offset:11264
  v_smfmac_f32_16x16x64_bf16 v[36:39], v[16:19], a[16:23], v3
  v_smfmac_f32_16x16x64_bf16 v[40:43], v[16:19], a[72:79], v3
  v_smfmac_f32_16x16x64_bf16 v[44:47], v[16:19], a[128:135], v3
  v_smfmac_f32_16x16x64_bf16 v[48:51], v[16:19], a[184:191], v3
  v_smfmac_f32_16x16x64_bf16 v[52:55], v[16:19], a[240:247], v3
  s_waitcnt lgkmcnt(0)
  s_barrier
  ds_read_b128 v[8:11], v2 offset:8192
  ds_read_b128 v[12:15], v2 offset:9216
  ds_read_b128 v[24:27], v2 offset:12288
  ds_read_b128 v[28:31], v2 offset:13312
  ds_read_b128 v[32:35], v2 offset:14336
  v_smfmac_f32_16x16x64_bf16 v[56:59], v[16:19], v[160:167], v3
  v_smfmac_f32_16x16x64_bf16 v[60:63], v[16:19], v[216:223], v3
  v_smfmac_f32_16x16x64_bf16 v[36:39], v[20:23], a[24:31], v3
  v_smfmac_f32_16x16x64_bf16 v[40:43], v[20:23], a[80:87], v3
  v_smfmac_f32_16x16x64_bf16 v[44:47], v[20:23], a[136:143], v3
  v_smfmac_f32_16x16x64_bf16 v[48:51], v[20:23], a[192:199], v3
  v_smfmac_f32_16x16x64_bf16 v[52:55], v[20:23], a[248:255], v3
  v_smfmac_f32_16x16x64_bf16 v[56:59], v[20:23], v[168:175], v3
  v_smfmac_f32_16x16x64_bf16 v[60:63], v[20:23], v[224:231], v3
  s_waitcnt lgkmcnt(4)
  v_smfmac_f32_16x16x64_bf16 v[36:39], v[8:11], a[0:7], v3
  s_waitcnt lgkmcnt(3)
  v_smfmac_f32_16x16x64_bf16 v[36:39], v[12:15], a[8:15], v3
  s_waitcnt lgkmcnt(2)
  v_smfmac_f32_16x16x64_bf16 v[36:39], v[24:27], a[32:39], v3
  s_waitcnt lgkmcnt(1)
  v_smfmac_f32_16x16x64_bf16 v[36:39], v[28:31], a[40:47], v3
  s_waitcnt lgkmcnt(0)
  v_smfmac_f32_16x16x64_bf16 v[36:39], v[32:35], a[48:55], v3
  v_smfmac_f32_16x16x64_bf16 v[40:43], v[8:11], a[56:63], v3
  v_smfmac_f32_16x16x64_bf16 v[40:43], v[12:15], a[64:71], v3
  v_smfmac_f32_16x16x64_bf16 v[40:43], v[24:27], a[88:95], v3
  v_permlane32_swap_b32 v36, v38
  v_smfmac_f32_16x16x64_bf16 v[40:43], v[28:31], a[96:103], v3
  v_permlane32_swap_b32 v37, v39
  v_smfmac_f32_16x16x64_bf16 v[40:43], v[32:35], a[104:111], v3
  v_add_f32 v36, v36, v38
  v_smfmac_f32_16x16x64_bf16 v[44:47], v[8:11], a[112:119], v3
  v_add_f32 v37, v37, v39
  v_smfmac_f32_16x16x64_bf16 v[44:47], v[12:15], a[120:127], v3
  v_cmp_u_f32 vcc, v36, v37
  v_smfmac_f32_16x16x64_bf16 v[44:47], v[24:27], a[144:151], v3
  v_cvt_pk_bf16_f32 v38, v36, v37
  v_smfmac_f32_16x16x64_bf16 v[44:47], v[28:31], a[152:159], v3
  ds_write_b32 v104, v38
  s_cbranch_vccnz cB_va3_slow
  v_permlane32_swap_b32 v40, v42
  v_smfmac_f32_16x16x64_bf16 v[44:47], v[32:35], a[160:167], v3
  v_permlane32_swap_b32 v41, v43
  v_smfmac_f32_16x16x64_bf16 v[48:51], v[8:11], a[168:175], v3
  v_add_f32 v40, v40, v42
  v_smfmac_f32_16x16x64_bf16 v[48:51], v[12:15], a[176:183], v3
  v_add_f32 v41, v41, v43
  v_smfmac_f32_16x16x64_bf16 v[48:51], v[24:27], a[200:207], v3
  v_cvt_pk_bf16_f32 v42, v40, v41
  v_smfmac_f32_16x16x64_bf16 v[48:51], v[28:31], a[208:215], v3
  ds_write_b32 v105, v42
  v_permlane32_swap_b32 v44, v46
  v_smfmac_f32_16x16x64_bf16 v[48:51], v[32:35], a[216:223], v3
  v_permlane32_swap_b32 v45, v47
  v_smfmac_f32_16x16x64_bf16 v[52:55], v[8:11], a[224:231], v3
  v_add_f32 v44, v44, v46
  v_smfmac_f32_16x16x64_bf16 v[52:55], v[12:15], a[232:239], v3
  v_add_f32 v45, v45, v47
  v_smfmac_f32_16x16x64_bf16 v[52:55], v[24:27], v[120:127], v3
  v_cvt_pk_bf16_f32 v46, v44, v45
  v_smfmac_f32_16x16x64_bf16 v[52:55], v[28:31], v[128:135], v3
  ds_write_b32 v106, v46
  v_permlane32_swap_b32 v48, v50
  v_smfmac_f32_16x16x64_bf16 v[52:55], v[32:35], v[136:143], v3
  v_permlane32_swap_b32 v49, v51
  v_smfmac_f32_16x16x64_bf16 v[56:59], v[8:11], v[144:151], v3
  v_add_f32 v48, v48, v50
  v_smfmac_f32_16x16x64_bf16 v[56:59], v[12:15], v[152:159], v3
  v_add_f32 v49, v49, v51
  v_smfmac_f32_16x16x64_bf16 v[56:59], v[24:27], v[176:183], v3
  v_cvt_pk_bf16_f32 v50, v48, v49
  v_smfmac_f32_16x16x64_bf16 v[56:59], v[28:31], v[184:191], v3
  ds_write_b32 v107, v50
  v_permlane32_swap_b32 v52, v54
  v_smfmac_f32_16x16x64_bf16 v[56:59], v[32:35], v[192:199], v3
  v_permlane32_swap_b32 v53, v55
  v_smfmac_f32_16x16x64_bf16 v[60:63], v[8:11], v[200:207], v3
  v_add_f32 v52, v52, v54
  v_smfmac_f32_16x16x64_bf16 v[60:63], v[12:15], v[208:215], v3
  v_add_f32 v53, v53, v55
  v_smfmac_f32_16x16x64_bf16 v[60:63], v[24:27], v[232:239], v3
  v_cvt_pk_bf16_f32 v54, v52, v53
  v_smfmac_f32_16x16x64_bf16 v[60:63], v[28:31], v[240:247], v3
  ds_write_b32 v108, v54
  v_permlane32_swap_b32 v56, v58
  v_smfmac_f32_16x16x64_bf16 v[60:63], v[32:35], v[248:255], v3
  v_permlane32_swap_b32 v57, v59
  v_add_f32 v56, v56, v58
  v_add_f32 v57, v57, v59
  v_cvt_pk_bf16_f32 v58, v56, v57
  ds_write_b32 v109, v58
  s_nop 2
  v_permlane32_swap_b32 v60, v62
  v_permlane32_swap_b32 v61, v63
  v_add_f32 v60, v60, v62
  v_add_f32 v61, v61, v63
  v_cvt_pk_bf16_f32 v62, v60, v61
  ds_write_b32 v110, v62
cB_va3_t2d:
  v_mov_b32 v117, s18
cB_va3_vow:
  s_waitcnt vmcnt(0)
  v_cmp_ne_u32 vcc, 56, v101
  s_cbranch_vccnz cB_va3_vor
  s_waitcnt lgkmcnt(0)
  s_barrier
  v_mov_b32 v36, 0
  v_mov_b32 v37, 0
  v_mov_b32 v38, 0
  v_mov_b32 v39, 0
  v_mov_b32 v40, 0
  v_mov_b32 v41, 0
  v_mov_b32 v42, 0
  v_mov_b32 v43, 0
  buffer_store_dword v117, v118, s[8:11], 0 offen sc1
  s_cmp_eq_u32 s19, 62
  s_cbranch_scc1 cB_done
  v_mov_b32 v44, 0
  v_mov_b32 v45, 0
  v_mov_b32 v46, 0
  v_mov_b32 v47, 0
  v_mov_b32 v48, 0
  v_mov_b32 v49, 0
  v_mov_b32 v50, 0
  v_mov_b32 v51, 0
  v_mov_b32 v52, 0
  v_mov_b32 v53, 0
  v_mov_b32 v54, 0
  v_mov_b32 v55, 0
  v_mov_b32 v56, 0
  v_mov_b32 v57, 0
  v_mov_b32 v58, 0
  v_mov_b32 v59, 0
  v_mov_b32 v60, 0
  v_mov_b32 v61, 0
  v_mov_b32 v62, 0
  v_mov_b32 v63, 0
  s_mov_b32 s19, s18
  s_add_u32 s18, s18, 1
  s_mov_b32 s22, s20
  s_mov_b32 s20, s21
  s_mov_b32 s21, s22
  s_add_u32 s23, s20, 4096
  s_branch cB_va3_loop
cB_va3_slow:
  s_waitcnt lgkmcnt(0)
cB_va3_sl1:
  s_add_u32 s31, s31, 0x1000000
  buffer_load_dwordx4 v[8:11], v2, s[8:11], s20 offen offset:0 sc1
  buffer_load_dwordx4 v[12:15], v2, s[8:11], s20 offen offset:1024 sc1
  buffer_load_dwordx4 v[16:19], v2, s[8:11], s20 offen offset:2048 sc1
  buffer_load_dwordx4 v[20:23], v2, s[8:11], s20 offen offset:3072 sc1
  buffer_load_dwordx4 v[24:27], v2, s[8:11], s23 offen offset:0 sc1
  buffer_load_dwordx4 v[28:31], v2, s[8:11], s23 offen offset:1024 sc1
  buffer_load_dwordx4 v[32:35], v2, s[8:11], s23 offen offset:2048 sc1
  s_waitcnt vmcnt(0)
  v_max3_u32 v36, v8, v9, v10
  v_max3_u32 v36, v36, v11, v12
  v_max3_u32 v36, v36, v13, v14
  v_max3_u32 v36, v36, v15, v16
  v_max3_u32 v36, v36, v17, v18
  v_max3_u32 v36, v36, v19, v20
  v_max3_u32 v36, v36, v21, v22
  v_max3_u32 v36, v36, v23, v24
  v_max3_u32 v36, v36, v25, v26
  v_max3_u32 v36, v36, v27, v28
  v_max3_u32 v36, v36, v29, v30
  v_max3_u32 v36, v36, v31, v32
  v_max3_u32 v36, v36, v33, v34
  v_max_u32 v36, v36, v35
  v_cmp_eq_u32 vcc, -1, v36
  s_cbranch_vccz cB_va3_sl2
  s_add_u32 s30, s30, 1
  s_cmp_lt_u32 s30, 400000
  s_cbranch_scc1 cB_va3_sl1
  s_branch cB_abort
cB_va3_sl2:
  v_mov_b32 v36, 0
  v_mov_b32 v37, 0
  v_mov_b32 v38, 0
  v_mov_b32 v39, 0
  v_mov_b32 v40, 0
  v_mov_b32 v41, 0
  v_mov_b32 v42, 0
  v_mov_b32 v43, 0
  v_mov_b32 v44, 0
  v_mov_b32 v45, 0
  v_mov_b32 v46, 0
  v_mov_b32 v47, 0
  v_mov_b32 v48, 0
  v_mov_b32 v49, 0
  v_mov_b32 v50, 0
  v_mov_b32 v51, 0
  v_mov_b32 v52, 0
  v_mov_b32 v53, 0
  v_mov_b32 v54, 0
  v_mov_b32 v55, 0
  v_mov_b32 v56, 0
  v_mov_b32 v57, 0
  v_mov_b32 v58, 0
  v_mov_b32 v59, 0
  v_mov_b32 v60, 0
  v_mov_b32 v61, 0
  v_mov_b32 v62, 0
  v_mov_b32 v63, 0
  v_smfmac_f32_16x16x64_bf16 v[36:39], v[8:11], a[0:7], v3
  v_smfmac_f32_16x16x64_bf16 v[40:43], v[8:11], a[56:63], v3
  v_smfmac_f32_16x16x64_bf16 v[44:47], v[8:11], a[112:119], v3
  v_smfmac_f32_16x16x64_bf16 v[48:51], v[8:11], a[168:175], v3
  v_smfmac_f32_16x16x64_bf16 v[52:55], v[8:11], a[224:231], v3
  v_smfmac_f32_16x16x64_bf16 v[56:59], v[8:11], v[144:151], v3
  v_smfmac_f32_16x16x64_bf16 v[60:63], v[8:11], v[200:207], v3
  v_smfmac_f32_16x16x64_bf16 v[36:39], v[12:15], a[8:15], v3
  v_smfmac_f32_16x16x64_bf16 v[40:43], v[12:15], a[64:71], v3
  v_smfmac_f32_16x16x64_bf16 v[44:47], v[12:15], a[120:127], v3
  v_smfmac_f32_16x16x64_bf16 v[48:51], v[12:15], a[176:183], v3
  v_smfmac_f32_16x16x64_bf16 v[52:55], v[12:15], a[232:239], v3
  v_smfmac_f32_16x16x64_bf16 v[56:59], v[12:15], v[152:159], v3
  v_smfmac_f32_16x16x64_bf16 v[60:63], v[12:15], v[208:215], v3
  v_smfmac_f32_16x16x64_bf16 v[36:39], v[16:19], a[16:23], v3
  v_smfmac_f32_16x16x64_bf16 v[40:43], v[16:19], a[72:79], v3
  v_smfmac_f32_16x16x64_bf16 v[44:47], v[16:19], a[128:135], v3
  v_smfmac_f32_16x16x64_bf16 v[48:51], v[16:19], a[184:191], v3
  v_smfmac_f32_16x16x64_bf16 v[52:55], v[16:19], a[240:247], v3
  v_smfmac_f32_16x16x64_bf16 v[56:59], v[16:19], v[160:167], v3
  v_smfmac_f32_16x16x64_bf16 v[60:63], v[16:19], v[216:223], v3
  v_smfmac_f32_16x16x64_bf16 v[36:39], v[20:23], a[24:31], v3
  v_smfmac_f32_16x16x64_bf16 v[40:43], v[20:23], a[80:87], v3
  v_smfmac_f32_16x16x64_bf16 v[44:47], v[20:23], a[136:143], v3
  v_smfmac_f32_16x16x64_bf16 v[48:51], v[20:23], a[192:199], v3
  v_smfmac_f32_16x16x64_bf16 v[52:55], v[20:23], a[248:255], v3
  v_smfmac_f32_16x16x64_bf16 v[56:59], v[20:23], v[168:175], v3
  v_smfmac_f32_16x16x64_bf16 v[60:63], v[20:23], v[224:231], v3
  v_smfmac_f32_16x16x64_bf16 v[36:39], v[24:27], a[32:39], v3
  v_smfmac_f32_16x16x64_bf16 v[40:43], v[24:27], a[88:95], v3
  v_smfmac_f32_16x16x64_bf16 v[44:47], v[24:27], a[144:151], v3
  v_smfmac_f32_16x16x64_bf16 v[48:51], v[24:27], a[200:207], v3
  v_smfmac_f32_16x16x64_bf16 v[52:55], v[24:27], v[120:127], v3
  v_smfmac_f32_16x16x64_bf16 v[56:59], v[24:27], v[176:183], v3
  v_smfmac_f32_16x16x64_bf16 v[60:63], v[24:27], v[232:239], v3
  v_smfmac_f32_16x16x64_bf16 v[36:39], v[28:31], a[40:47], v3
  v_smfmac_f32_16x16x64_bf16 v[40:43], v[28:31], a[96:103], v3
  v_smfmac_f32_16x16x64_bf16 v[44:47], v[28:31], a[152:159], v3
  v_smfmac_f32_16x16x64_bf16 v[48:51], v[28:31], a[208:215], v3
  v_smfmac_f32_16x16x64_bf16 v[52:55], v[28:31], v[128:135], v3
  v_smfmac_f32_16x16x64_bf16 v[56:59], v[28:31], v[184:191], v3
  v_smfmac_f32_16x16x64_bf16 v[60:63], v[28:31], v[240:247], v3
  v_smfmac_f32_16x16x64_bf16 v[36:39], v[32:35], a[48:55], v3
  v_smfmac_f32_16x16x64_bf16 v[40:43], v[32:35], a[104:111], v3
  v_smfmac_f32_16x16x64_bf16 v[44:47], v[32:35], a[160:167], v3
  v_smfmac_f32_16x16x64_bf16 v[48:51], v[32:35], a[216:223], v3
  v_smfmac_f32_16x16x64_bf16 v[52:55], v[32:35], v[136:143], v3
  v_smfmac_f32_16x16x64_bf16 v[56:59], v[32:35], v[192:199], v3
  v_smfmac_f32_16x16x64_bf16 v[60:63], v[32:35], v[248:255], v3
  v_permlane32_swap_b32 v36, v38
  v_permlane32_swap_b32 v37, v39
  v_add_f32 v36, v36, v38
  v_add_f32 v37, v37, v39
  v_cvt_pk_bf16_f32 v38, v36, v37
  ds_write_b32 v104, v38
  v_permlane32_swap_b32 v40, v42
  v_permlane32_swap_b32 v41, v43
  v_add_f32 v40, v40, v42
  v_add_f32 v41, v41, v43
  v_cvt_pk_bf16_f32 v42, v40, v41
  ds_write_b32 v105, v42
  v_permlane32_swap_b32 v44, v46
  v_permlane32_swap_b32 v45, v47
  v_add_f32 v44, v44, v46
  v_add_f32 v45, v45, v47
  v_cvt_pk_bf16_f32 v46, v44, v45
  ds_write_b32 v106, v46
  v_permlane32_swap_b32 v48, v50
  v_permlane32_swap_b32 v49, v51
  v_add_f32 v48, v48, v50
  v_add_f32 v49, v49, v51
  v_cvt_pk_bf16_f32 v50, v48, v49
  ds_write_b32 v107, v50
  v_permlane32_swap_b32 v52, v54
  v_permlane32_swap_b32 v53, v55
  v_add_f32 v52, v52, v54
  v_add_f32 v53, v53, v55
  v_cvt_pk_bf16_f32 v54, v52, v53
  ds_write_b32 v108, v54
  v_permlane32_swap_b32 v56, v58
  v_permlane32_swap_b32 v57, v59
  v_add_f32 v56, v56, v58
  v_add_f32 v57, v57, v59
  v_cvt_pk_bf16_f32 v58, v56, v57
  ds_write_b32 v109, v58
  v_permlane32_swap_b32 v60, v62
  v_permlane32_swap_b32 v61, v63
  v_add_f32 v60, v60, v62
  v_add_f32 v61, v61, v63
  v_cvt_pk_bf16_f32 v62, v60, v61
  ds_write_b32 v110, v62
  s_branch cB_va3_t2d
cB_va3_vor:
  s_sleep 2
  buffer_load_dword v101, off, s[8:11], s27 sc1
  s_add_u32 s30, s30, 1
  s_cmp_lt_u32 s30, 400000
  s_cbranch_scc1 cB_va3_vow
  s_branch cB_abort
cB_abort:
  v_mov_b32 v4, 0xdead
  v_mov_b32 v5, 16
  buffer_store_dword v4, v5, s[12:15], 0 offen
  s_branch ch_end
cB_done:
  s_branch ch_end
ch_worker:
  s_load_dwordx2 s[36:37], s[0:1], 112
  s_waitcnt lgkmcnt(0)
  s_mov_b32 s92, s36
  s_and_b32 s93, s37, 0xffff
  s_mov_b32 s94, 3670016
  s_mov_b32 s95, 0x20000
  s_mov_b32 s96, 0
  s_cmp_lg_u32 s16, 0
  s_cbranch_scc1 ask_2
  v_mov_b32 v250, 1
  v_mov_b32 v251, 88020352
  s_mov_b64 exec, 1
  buffer_atomic_add v250, v251, s[8:11], 0 offen sc0
  s_mov_b64 exec, -1
ask_2:
  s_branch wk_next
wk_loop:
  s_waitcnt vmcnt(0) lgkmcnt(0)
  s_cmp_eq_u32 s96, 1
  s_cbranch_scc1 wk_ask
  s_mov_b32 s96, 1
  s_mov_b32 s30, 0
  v_mov_b32 v36, 0
ch_chk:
  buffer_load_dword v37, v36, s[12:15], 0 offen sc1
  s_waitcnt vmcnt(0)
  v_readfirstlane_b32 s22, v37
  s_and_b32 s22, s22, 0xffff
  s_cmp_ge_u32 s22, 32
  s_cbranch_scc1 ch_go_end
  s_sleep 16
  s_add_u32 s30, s30, 1
  s_cmp_lt_u32 s30, 64
  s_cbranch_scc1 ch_chk
ch_go_end:
  v_mov_b32 v6, 160016
  v_mov_b32 v4, s22
  s_cmp_lg_u32 s16, 0
  s_cbranch_scc1 ch_dec
  ds_write_b32 v6, v4
  s_waitcnt lgkmcnt(0)
ch_dec:
  s_barrier
  ds_read_b32 v4, v6
  s_waitcnt lgkmcnt(0)
  v_readfirstlane_b32 s22, v4
  s_cmp_ge_u32 s22, 32
  s_cbranch_scc1 wk_ask
  v_mov_b32 v4, 0x10001
  s_mov_b32 s18, 0
  s_branch ch_take
wk_ask:
  v_readfirstlane_b32 s22, v250
  s_cmp_ge_u32 s22, 1104
  s_cbranch_scc1 wk_next
  s_cmp_lg_u32 s16, 0
  s_cbranch_scc1 ask_3
  v_mov_b32 v250, 1
  v_mov_b32 v251, 88020352
  s_mov_b64 exec, 1
  buffer_atomic_add v250, v251, s[8:11], 0 offen sc0
  s_mov_b64 exec, -1
ask_3:
wk_next:
  v_mov_b32 v6, 160000
  s_waitcnt vmcnt(0)
  s_barrier
  s_cmp_lg_u32 s16, 0
  s_cbranch_scc1 wk_n1
  s_mov_b64 exec, 1
  ds_write_b32 v6, v250
  s_mov_b64 exec, -1
  s_waitcnt lgkmcnt(0)
wk_n1:
  s_barrier
  ds_read_b32 v4, v6
  s_waitcnt lgkmcnt(0)
  v_readfirstlane_b32 s3, v4
wk_have:
  s_cmp_ge_u32 s3, 1104
  s_cbranch_scc1 wk_done
  v_mov_b32 v250, 0
  v_mov_b32 v251, 88020352
  v_and_b32 v1, 63, v0
  v_lshlrev_b32 v2, 4, v1
  v_lshrrev_b32 v3, 4, v1
  v_and_b32 v4, 15, v1
  s_cmp_ge_u32 s3, 592
  s_cbranch_scc1 wk_tok
  s_cmp_ge_u32 s3, 480
  s_cbranch_scc1 wk_s4d
  s_cmp_ge_u32 s3, 256
  s_cbranch_scc1 wk_full
  s_cmp_ge_u32 s3, 224
  s_cbranch_scc1 wk_srv
  s_cmp_ge_u32 s3, 112
  s_cselect_b32 s18, 1, 0
  s_cselect_b32 s20, 112, 0
  s_sub_u32 s20, s3, s20
  s_and_b32 s17, s20, 15
  s_add_u32 s17, s17, 16
  s_lshr_b32 s34, s20, 4
  s_lshl_b32 s34, s34, 1
  s_add_u32 s35, s34, 2
  s_branch wk_gemm
wk_full:
  s_sub_u32 s20, s3, 224
  s_and_b32 s17, s20, 15
  s_lshr_b32 s18, s20, 4
  s_cmp_lt_u32 s18, 8
  s_cselect_b32 s21, 16, 0
  s_add_u32 s17, s17, s21
  s_and_b32 s18, s18, 7
  s_mov_b32 s34, 0
  s_mov_b32 s35, 14
wk_gemm:
  s_lshl_b32 s20, s18, 4
  s_lshl_b32 s21, s16, 2
  s_add_u32 s20, s20, s21
  s_mul_i32 s21, s20, 14336
  s_add_u32 s21, s21, 71565312
  s_add_u32 s22, s21, 0
  buffer_load_dwordx4 a[0:3], v2, s[8:11], s22 offen offset:0
  buffer_load_dwordx4 a[4:7], v2, s[8:11], s22 offen offset:1024
  buffer_load_dwordx4 a[8:11], v2, s[8:11], s22 offen offset:2048
  buffer_load_dwordx4 a[12:15], v2, s[8:11], s22 offen offset:3072
  s_add_u32 s22, s21, 4096
  buffer_load_dwordx4 a[16:19], v2, s[8:11], s22 offen offset:0
  buffer_load_dwordx4 a[20:23], v2, s[8:11], s22 offen offset:1024
  buffer_load_dwordx4 a[24:27], v2, s[8:11], s22 offen offset:2048
  buffer_load_dwordx4 a[28:31], v2, s[8:11], s22 offen offset:3072
  s_add_u32 s22, s21, 8192
  buffer_load_dwordx4 a[32:35], v2, s[8:11], s22 offen offset:0
  buffer_load_dwordx4 a[36:39], v2, s[8:11], s22 offen offset:1024
  buffer_load_dwordx4 a[40:43], v2, s[8:11], s22 offen offset:2048
  buffer_load_dwordx4 a[44:47], v2, s[8:11], s22 offen offset:3072
  s_add_u32 s22, s21, 12288
  buffer_load_dwordx4 a[48:51], v2, s[8:11], s22 offen offset:0
  buffer_load_dwordx4 a[52:55], v2, s[8:11], s22 offen offset:1024
  buffer_load_dwordx4 a[56:59], v2, s[8:11], s22 offen offset:2048
  buffer_load_dwordx4 a[60:63], v2, s[8:11], s22 offen offset:3072
  s_add_u32 s22, s21, 16384
  buffer_load_dwordx4 a[64:67], v2, s[8:11], s22 offen offset:0
  buffer_load_dwordx4 a[68:71], v2, s[8:11], s22 offen offset:1024
  buffer_load_dwordx4 a[72:75], v2, s[8:11], s22 offen offset:2048
  buffer_load_dwordx4 a[76:79], v2, s[8:11], s22 offen offset:3072
  s_add_u32 s22, s21, 20480
  buffer_load_dwordx4 a[80:83], v2, s[8:11], s22 offen offset:0
  buffer_load_dwordx4 a[84:87], v2, s[8:11], s22 offen offset:1024
  buffer_load_dwordx4 a[88:91], v2, s[8:11], s22 offen offset:2048
  buffer_load_dwordx4 a[92:95], v2, s[8:11], s22 offen offset:3072
  s_add_u32 s22, s21, 24576
  buffer_load_dwordx4 a[96:99], v2, s[8:11], s22 offen offset:0
  buffer_load_dwordx4 a[100:103], v2, s[8:11], s22 offen offset:1024
  buffer_load_dwordx4 a[104:107], v2, s[8:11], s22 offen offset:2048
  buffer_load_dwordx4 a[108:111], v2, s[8:11], s22 offen offset:3072
  s_add_u32 s22, s21, 28672
  buffer_load_dwordx4 a[112:115], v2, s[8:11], s22 offen offset:0
  buffer_load_dwordx4 a[116:119], v2, s[8:11], s22 offen offset:1024
  buffer_load_dwordx4 a[120:123], v2, s[8:11], s22 offen offset:2048
  buffer_load_dwordx4 a[124:127], v2, s[8:11], s22 offen offset:3072
  s_add_u32 s22, s21, 32768
  buffer_load_dwordx4 a[128:131], v2, s[8:11], s22 offen offset:0
  buffer_load_dwordx4 a[132:135], v2, s[8:11], s22 offen offset:1024
  buffer_load_dwordx4 a[136:139], v2, s[8:11], s22 offen offset:2048
  buffer_load_dwordx4 a[140:143], v2, s[8:11], s22 offen offset:3072
  s_add_u32 s22, s21, 36864
  buffer_load_dwordx4 a[144:147], v2, s[8:11], s22 offen offset:0
  buffer_load_dwordx4 a[148:151], v2, s[8:11], s22 offen offset:1024
  buffer_load_dwordx4 a[152:155], v2, s[8:11], s22 offen offset:2048
  buffer_load_dwordx4 a[156:159], v2, s[8:11], s22 offen offset:3072
  s_add_u32 s22, s21, 40960
  buffer_load_dwordx4 a[160:163], v2, s[8:11], s22 offen offset:0
  buffer_load_dwordx4 a[164:167], v2, s[8:11], s22 offen offset:1024
  buffer_load_dwordx4 a[168:171], v2, s[8:11], s22 offen offset:2048
  buffer_load_dwordx4 a[172:175], v2, s[8:11], s22 offen offset:3072
  s_add_u32 s22, s21, 45056
  buffer_load_dwordx4 a[176:179], v2, s[8:11], s22 offen offset:0
  buffer_load_dwordx4 a[180:183], v2, s[8:11], s22 offen offset:1024
  buffer_load_dwordx4 a[184:187], v2, s[8:11], s22 offen offset:2048
  buffer_load_dwordx4 a[188:191], v2, s[8:11], s22 offen offset:3072
  s_add_u32 s22, s21, 49152
  buffer_load_dwordx4 a[192:195], v2, s[8:11], s22 offen offset:0
  buffer_load_dwordx4 a[196:199], v2, s[8:11], s22 offen offset:1024
  buffer_load_dwordx4 a[200:203], v2, s[8:11], s22 offen offset:2048
  buffer_load_dwordx4 a[204:207], v2, s[8:11], s22 offen offset:3072
  s_add_u32 s22, s21, 53248
  buffer_load_dwordx4 a[208:211], v2, s[8:11], s22 offen offset:0
  buffer_load_dwordx4 a[212:215], v2, s[8:11], s22 offen offset:1024
  buffer_load_dwordx4 a[216:219], v2, s[8:11], s22 offen offset:2048
  buffer_load_dwordx4 a[220:223], v2, s[8:11], s22 offen offset:3072
  s_waitcnt vmcnt(40)
  s_mul_i32 s23, s17, 401408
  s_and_b32 s22, s16, 1
  s_mul_i32 s22, s22, 7168
  s_add_u32 s23, s23, s22
  s_add_u32 s23, s23, 0
  s_lshr_b32 s22, s16, 1
  s_mul_i32 s22, s22, 14336
  s_add_u32 s23, s23, s22
  s_mul_i32 s27, s16, 7168
  s_lshr_b32 s28, s20, 1
  s_cmp_lt_u32 s17, 16
  s_cbranch_scc0 wg_vo
  s_add_u32 s23, s23, s22
  s_lshl_b32 s29, s28, 4
  s_add_u32 s29, s29, s17
  s_mul_i32 s29, s29, 28672
  s_add_u32 s29, s29, 12845056
  s_mov_b32 s31, 0
  s_lshr_b32 s24, s34, 1
  s_lshl_b32 s24, s24, 2
  s_and_b32 s25, s34, 1
  s_add_u32 s24, s24, s25
  s_mul_i32 s24, s24, 14336
  s_add_u32 s24, s24, s23
  s_add_u32 m0, s31, s27
  s_nop 0
  buffer_load_dwordx4 v2, s[8:11], s24 offen offset:0  lds
  buffer_load_dwordx4 v2, s[8:11], s24 offen offset:1024  lds
  buffer_load_dwordx4 v2, s[8:11], s24 offen offset:2048  lds
  buffer_load_dwordx4 v2, s[8:11], s24 offen offset:3072  lds
  s_add_u32 m0, m0, 4096
  s_add_u32 s24, s24, 4096
  buffer_load_dwordx4 v2, s[8:11], s24 offen offset:0  lds
  buffer_load_dwordx4 v2, s[8:11], s24 offen offset:1024  lds
  buffer_load_dwordx4 v2, s[8:11], s24 offen offset:2048  lds
  s_add_u32 s30, s34, 1
  s_mov_b32 s31, 28672
  s_lshr_b32 s24, s30, 1
  s_lshl_b32 s24, s24, 2
  s_and_b32 s25, s30, 1
  s_add_u32 s24, s24, s25
  s_mul_i32 s24, s24, 14336
  s_add_u32 s24, s24, s23
  s_add_u32 m0, s31, s27
  s_nop 0
  buffer_load_dwordx4 v2, s[8:11], s24 offen offset:0  lds
  buffer_load_dwordx4 v2, s[8:11], s24 offen offset:1024  lds
  buffer_load_dwordx4 v2, s[8:11], s24 offen offset:2048  lds
  buffer_load_dwordx4 v2, s[8:11], s24 offen offset:3072  lds
  s_add_u32 m0, m0, 4096
  s_add_u32 s24, s24, 4096
  buffer_load_dwordx4 v2, s[8:11], s24 offen offset:0  lds
  buffer_load_dwordx4 v2, s[8:11], s24 offen offset:1024  lds
  buffer_load_dwordx4 v2, s[8:11], s24 offen offset:2048  lds
  s_mov_b32 s19, s34
  s_mov_b32 s32, 0
  s_mov_b32 s33, 57344
  s_waitcnt vmcnt(7)
  s_branch wg_f_in
wg_f_loop:
  s_waitcnt vmcnt(11)
wg_f_in:
  s_barrier
  s_add_u32 s30, s19, 2
  s_min_u32 s30, s30, 13
  s_lshr_b32 s24, s30, 1
  s_lshl_b32 s24, s24, 2
  s_and_b32 s25, s30, 1
  s_add_u32 s24, s24, s25
  s_mul_i32 s24, s24, 14336
  s_add_u32 s24, s24, s23
  s_add_u32 m0, s33, s27
  s_nop 0
  buffer_load_dwordx4 v2, s[8:11], s24 offen offset:0  lds
  buffer_load_dwordx4 v2, s[8:11], s24 offen offset:1024  lds
  buffer_load_dwordx4 v2, s[8:11], s24 offen offset:2048  lds
  buffer_load_dwordx4 v2, s[8:11], s24 offen offset:3072  lds
  s_add_u32 m0, m0, 4096
  s_add_u32 s24, s24, 4096
  buffer_load_dwordx4 v2, s[8:11], s24 offen offset:0  lds
  buffer_load_dwordx4 v2, s[8:11], s24 offen offset:1024  lds
  buffer_load_dwordx4 v2, s[8:11], s24 offen offset:2048  lds
  v_add_u32 v5, s32, v2
  ds_read_b128 v[8:11], v5 offset:0
  ds_read_b128 v[12:15], v5 offset:14336
  ds_read_b128 v[16:19], v5 offset:1024
  ds_read_b128 v[20:23], v5 offset:15360
  ds_read_b128 v[24:27], v5 offset:2048
  ds_read_b128 v[28:31], v5 offset:16384
  ds_read_b128 v[32:35], v5 offset:3072
  s_waitcnt lgkmcnt(6)
  v_mfma_f32_16x16x32_bf16 v[40:43], v[8:11], a[0:3], 0
  v_mfma_f32_16x16x32_bf16 v[44:47], v[8:11], a[56:59], 0
  v_mfma_f32_16x16x32_bf16 v[48:51], v[8:11], a[112:115], 0
  v_mfma_f32_16x16x32_bf16 v[52:55], v[8:11], a[168:171], 0
  ds_read_b128 v[36:39], v5 offset:17408
  s_waitcnt lgkmcnt(6)
  v_mfma_f32_16x16x32_bf16 v[56:59], v[12:15], a[0:3], 0
  v_mfma_f32_16x16x32_bf16 v[60:63], v[12:15], a[56:59], 0
  v_mfma_f32_16x16x32_bf16 v[64:67], v[12:15], a[112:115], 0
  v_mfma_f32_16x16x32_bf16 v[68:71], v[12:15], a[168:171], 0
  ds_read_b128 v[8:11], v5 offset:4096
  s_waitcnt lgkmcnt(6)
  v_mfma_f32_16x16x32_bf16 v[40:43], v[16:19], a[4:7], v[40:43]
  v_mfma_f32_16x16x32_bf16 v[44:47], v[16:19], a[60:63], v[44:47]
  v_mfma_f32_16x16x32_bf16 v[48:51], v[16:19], a[116:119], v[48:51]
  v_mfma_f32_16x16x32_bf16 v[52:55], v[16:19], a[172:175], v[52:55]
  ds_read_b128 v[12:15], v5 offset:18432
  s_waitcnt lgkmcnt(6)
  v_mfma_f32_16x16x32_bf16 v[56:59], v[20:23], a[4:7], v[56:59]
  v_mfma_f32_16x16x32_bf16 v[60:63], v[20:23], a[60:63], v[60:63]
  v_mfma_f32_16x16x32_bf16 v[64:67], v[20:23], a[116:119], v[64:67]
  v_mfma_f32_16x16x32_bf16 v[68:71], v[20:23], a[172:175], v[68:71]
  ds_read_b128 v[16:19], v5 offset:5120
  s_waitcnt lgkmcnt(6)
  v_mfma_f32_16x16x32_bf16 v[40:43], v[24:27], a[8:11], v[40:43]
  v_mfma_f32_16x16x32_bf16 v[44:47], v[24:27], a[64:67], v[44:47]
  v_mfma_f32_16x16x32_bf16 v[48:51], v[24:27], a[120:123], v[48:51]
  v_mfma_f32_16x16x32_bf16 v[52:55], v[24:27], a[176:179], v[52:55]
  ds_read_b128 v[20:23], v5 offset:19456
  s_waitcnt lgkmcnt(6)
  v_mfma_f32_16x16x32_bf16 v[56:59], v[28:31], a[8:11], v[56:59]
  v_mfma_f32_16x16x32_bf16 v[60:63], v[28:31], a[64:67], v[60:63]
  v_mfma_f32_16x16x32_bf16 v[64:67], v[28:31], a[120:123], v[64:67]
  v_mfma_f32_16x16x32_bf16 v[68:71], v[28:31], a[176:179], v[68:71]
  ds_read_b128 v[24:27], v5 offset:6144
  s_waitcnt lgkmcnt(6)
  v_mfma_f32_16x16x32_bf16 v[40:43], v[32:35], a[12:15], v[40:43]
  v_mfma_f32_16x16x32_bf16 v[44:47], v[32:35], a[68:71], v[44:47]
  v_mfma_f32_16x16x32_bf16 v[48:51], v[32:35], a[124:127], v[48:51]
  v_mfma_f32_16x16x32_bf16 v[52:55], v[32:35], a[180:183], v[52:55]
  ds_read_b128 v[28:31], v5 offset:20480
  s_waitcnt lgkmcnt(6)
  v_mfma_f32_16x16x32_bf16 v[56:59], v[36:39], a[12:15], v[56:59]
  v_mfma_f32_16x16x32_bf16 v[60:63], v[36:39], a[68:71], v[60:63]
  v_mfma_f32_16x16x32_bf16 v[64:67], v[36:39], a[124:127], v[64:67]
  v_mfma_f32_16x16x32_bf16 v[68:71], v[36:39], a[180:183], v[68:71]
  ds_read_b128 v[32:35], v5 offset:7168
  s_waitcnt lgkmcnt(6)
  v_mfma_f32_16x16x32_bf16 v[40:43], v[8:11], a[16:19], v[40:43]
  v_mfma_f32_16x16x32_bf16 v[44:47], v[8:11], a[72:75], v[44:47]
  v_mfma_f32_16x16x32_bf16 v[48:51], v[8:11], a[128:131], v[48:51]
  v_mfma_f32_16x16x32_bf16 v[52:55], v[8:11], a[184:187], v[52:55]
  ds_read_b128 v[36:39], v5 offset:21504
  s_waitcnt lgkmcnt(6)
  v_mfma_f32_16x16x32_bf16 v[56:59], v[12:15], a[16:19], v[56:59]
  v_mfma_f32_16x16x32_bf16 v[60:63], v[12:15], a[72:75], v[60:63]
  v_mfma_f32_16x16x32_bf16 v[64:67], v[12:15], a[128:131], v[64:67]
  v_mfma_f32_16x16x32_bf16 v[68:71], v[12:15], a[184:187], v[68:71]
  ds_read_b128 v[8:11], v5 offset:8192
  s_waitcnt lgkmcnt(6)
  v_mfma_f32_16x16x32_bf16 v[40:43], v[16:19], a[20:23], v[40:43]
  v_mfma_f32_16x16x32_bf16 v[44:47], v[16:19], a[76:79], v[44:47]
  v_mfma_f32_16x16x32_bf16 v[48:51], v[16:19], a[132:135], v[48:51]
  v_mfma_f32_16x16x32_bf16 v[52:55], v[16:19], a[188:191], v[52:55]
  ds_read_b128 v[12:15], v5 offset:22528
  s_waitcnt lgkmcnt(6)
  v_mfma_f32_16x16x32_bf16 v[56:59], v[20:23], a[20:23], v[56:59]
  v_mfma_f32_16x16x32_bf16 v[60:63], v[20:23], a[76:79], v[60:63]
  v_mfma_f32_16x16x32_bf16 v[64:67], v[20:23], a[132:135], v[64:67]
  v_mfma_f32_16x16x32_bf16 v[68:71], v[20:23], a[188:191], v[68:71]
  ds_read_b128 v[16:19], v5 offset:9216
  s_waitcnt lgkmcnt(6)
  v_mfma_f32_16x16x32_bf16 v[40:43], v[24:27], a[24:27], v[40:43]
  v_mfma_f32_16x16x32_bf16 v[44:47], v[24:27], a[80:83], v[44:47]
  v_mfma_f32_16x16x32_bf16 v[48:51], v[24:27], a[136:139], v[48:51]
  v_mfma_f32_16x16x32_bf16 v[52:55], v[24:27], a[192:195], v[52:55]
  ds_read_b128 v[20:23], v5 offset:23552
  s_waitcnt lgkmcnt(6)
  v_mfma_f32_16x16x32_bf16 v[56:59], v[28:31], a[24:27], v[56:59]
  v_mfma_f32_16x16x32_bf16 v[60:63], v[28:31], a[80:83], v[60:63]
  v_mfma_f32_16x16x32_bf16 v[64:67], v[28:31], a[136:139], v[64:67]
  v_mfma_f32_16x16x32_bf16 v[68:71], v[28:31], a[192:195], v[68:71]
  ds_read_b128 v[24:27], v5 offset:10240
  s_waitcnt lgkmcnt(6)
  v_mfma_f32_16x16x32_bf16 v[40:43], v[32:35], a[28:31], v[40:43]
  v_mfma_f32_16x16x32_bf16 v[44:47], v[32:35], a[84:87], v[44:47]
  v_mfma_f32_16x16x32_bf16 v[48:51], v[32:35], a[140:143], v[48:51]
  v_mfma_f32_16x16x32_bf16 v[52:55], v[32:35], a[196:199], v[52:55]
  ds_read_b128 v[28:31], v5 offset:24576
  s_waitcnt lgkmcnt(6)
  v_mfma_f32_16x16x32_bf16 v[56:59], v[36:39], a[28:31], v[56:59]
  v_mfma_f32_16x16x32_bf16 v[60:63], v[36:39], a[84:87], v[60:63]
  v_mfma_f32_16x16x32_bf16 v[64:67], v[36:39], a[140:143], v[64:67]
  v_mfma_f32_16x16x32_bf16 v[68:71], v[36:39], a[196:199], v[68:71]
  ds_read_b128 v[32:35], v5 offset:11264
  s_waitcnt lgkmcnt(6)
  v_mfma_f32_16x16x32_bf16 v[40:43], v[8:11], a[32:35], v[40:43]
  v_mfma_f32_16x16x32_bf16 v[44:47], v[8:11], a[88:91], v[44:47]
  v_mfma_f32_16x16x32_bf16 v[48:51], v[8:11], a[144:147], v[48:51]
  v_mfma_f32_16x16x32_bf16 v[52:55], v[8:11], a[200:203], v[52:55]
  ds_read_b128 v[36:39], v5 offset:25600
  s_waitcnt lgkmcnt(6)
  v_mfma_f32_16x16x32_bf16 v[56:59], v[12:15], a[32:35], v[56:59]
  v_mfma_f32_16x16x32_bf16 v[60:63], v[12:15], a[88:91], v[60:63]
  v_mfma_f32_16x16x32_bf16 v[64:67], v[12:15], a[144:147], v[64:67]
  v_mfma_f32_16x16x32_bf16 v[68:71], v[12:15], a[200:203], v[68:71]
  ds_read_b128 v[8:11], v5 offset:12288
  s_waitcnt lgkmcnt(6)
  v_mfma_f32_16x16x32_bf16 v[40:43], v[16:19], a[36:39], v[40:43]
  v_mfma_f32_16x16x32_bf16 v[44:47], v[16:19], a[92:95], v[44:47]
  v_mfma_f32_16x16x32_bf16 v[48:51], v[16:19], a[148:151], v[48:51]
  v_mfma_f32_16x16x32_bf16 v[52:55], v[16:19], a[204:207], v[52:55]
  ds_read_b128 v[12:15], v5 offset:26624
  s_waitcnt lgkmcnt(6)
  v_mfma_f32_16x16x32_bf16 v[56:59], v[20:23], a[36:39], v[56:59]
  v_mfma_f32_16x16x32_bf16 v[60:63], v[20:23], a[92:95], v[60:63]
  v_mfma_f32_16x16x32_bf16 v[64:67], v[20:23], a[148:151], v[64:67]
  v_mfma_f32_16x16x32_bf16 v[68:71], v[20:23], a[204:207], v[68:71]
  ds_read_b128 v[16:19], v5 offset:13312
  s_waitcnt lgkmcnt(6)
  v_mfma_f32_16x16x32_bf16 v[40:43], v[24:27], a[40:43], v[40:43]
  v_mfma_f32_16x16x32_bf16 v[44:47], v[24:27], a[96:99], v[44:47]
  v_mfma_f32_16x16x32_bf16 v[48:51], v[24:27], a[152:155], v[48:51]
  v_mfma_f32_16x16x32_bf16 v[52:55], v[24:27], a[208:211], v[52:55]
  ds_read_b128 v[20:23], v5 offset:27648
  s_waitcnt lgkmcnt(6)
  v_mfma_f32_16x16x32_bf16 v[56:59], v[28:31], a[40:43], v[56:59]
  v_mfma_f32_16x16x32_bf16 v[60:63], v[28:31], a[96:99], v[60:63]
  v_mfma_f32_16x16x32_bf16 v[64:67], v[28:31], a[152:155], v[64:67]
  v_mfma_f32_16x16x32_bf16 v[68:71], v[28:31], a[208:211], v[68:71]
  s_waitcnt lgkmcnt(5)
  v_mfma_f32_16x16x32_bf16 v[40:43], v[32:35], a[44:47], v[40:43]
  v_mfma_f32_16x16x32_bf16 v[44:47], v[32:35], a[100:103], v[44:47]
  v_mfma_f32_16x16x32_bf16 v[48:51], v[32:35], a[156:159], v[48:51]
  v_mfma_f32_16x16x32_bf16 v[52:55], v[32:35], a[212:215], v[52:55]
  s_waitcnt lgkmcnt(4)
  v_mfma_f32_16x16x32_bf16 v[56:59], v[36:39], a[44:47], v[56:59]
  v_mfma_f32_16x16x32_bf16 v[60:63], v[36:39], a[100:103], v[60:63]
  v_mfma_f32_16x16x32_bf16 v[64:67], v[36:39], a[156:159], v[64:67]
  v_mfma_f32_16x16x32_bf16 v[68:71], v[36:39], a[212:215], v[68:71]
  s_waitcnt lgkmcnt(3)
  v_mfma_f32_16x16x32_bf16 v[40:43], v[8:11], a[48:51], v[40:43]
  v_mfma_f32_16x16x32_bf16 v[44:47], v[8:11], a[104:107], v[44:47]
  v_mfma_f32_16x16x32_bf16 v[48:51], v[8:11], a[160:163], v[48:51]
  v_mfma_f32_16x16x32_bf16 v[52:55], v[8:11], a[216:219], v[52:55]
  s_waitcnt lgkmcnt(2)
  v_mfma_f32_16x16x32_bf16 v[56:59], v[12:15], a[48:51], v[56:59]
  v_mfma_f32_16x16x32_bf16 v[60:63], v[12:15], a[104:107], v[60:63]
  v_mfma_f32_16x16x32_bf16 v[64:67], v[12:15], a[160:163], v[64:67]
  v_mfma_f32_16x16x32_bf16 v[68:71], v[12:15], a[216:219], v[68:71]
  s_waitcnt lgkmcnt(1)
  v_mfma_f32_16x16x32_bf16 v[40:43], v[16:19], a[52:55], v[40:43]
  v_mfma_f32_16x16x32_bf16 v[44:47], v[16:19], a[108:111], v[44:47]
  v_mfma_f32_16x16x32_bf16 v[48:51], v[16:19], a[164:167], v[48:51]
  v_mfma_f32_16x16x32_bf16 v[52:55], v[16:19], a[220:223], v[52:55]
  s_waitcnt lgkmcnt(0)
  v_mfma_f32_16x16x32_bf16 v[56:59], v[20:23], a[52:55], v[56:59]
  v_mfma_f32_16x16x32_bf16 v[60:63], v[20:23], a[108:111], v[60:63]
  v_mfma_f32_16x16x32_bf16 v[64:67], v[20:23], a[164:167], v[64:67]
  v_mfma_f32_16x16x32_bf16 v[68:71], v[20:23], a[220:223], v[68:71]
  s_lshl_b32 s24, s19, 10
  s_add_u32 s24, s24, s29
  v_cvt_pk_bf16_f32 v72, v40, v41
  v_cvt_pk_bf16_f32 v73, v42, v43
  v_cvt_pk_bf16_f32 v74, v56, v57
  v_cvt_pk_bf16_f32 v75, v58, v59
  s_add_u32 s25, s24, 0
  buffer_store_dwordx4 v[72:75], v2, s[8:11], s25 offen sc1
  v_cvt_pk_bf16_f32 v76, v44, v45
  v_cvt_pk_bf16_f32 v77, v46, v47
  v_cvt_pk_bf16_f32 v78, v60, v61
  v_cvt_pk_bf16_f32 v79, v62, v63
  s_add_u32 s25, s24, 14336
  buffer_store_dwordx4 v[76:79], v2, s[8:11], s25 offen sc1
  v_cvt_pk_bf16_f32 v80, v48, v49
  v_cvt_pk_bf16_f32 v81, v50, v51
  v_cvt_pk_bf16_f32 v82, v64, v65
  v_cvt_pk_bf16_f32 v83, v66, v67
  s_add_u32 s25, s24, 458752
  buffer_store_dwordx4 v[80:83], v2, s[8:11], s25 offen sc1
  v_cvt_pk_bf16_f32 v84, v52, v53
  v_cvt_pk_bf16_f32 v85, v54, v55
  v_cvt_pk_bf16_f32 v86, v68, v69
  v_cvt_pk_bf16_f32 v87, v70, v71
  s_add_u32 s25, s24, 473088
  buffer_store_dwordx4 v[84:87], v2, s[8:11], s25 offen sc1
  s_mov_b32 s33, s32
  s_add_u32 s32, s32, 28672
  s_cmp_eq_u32 s32, 86016
  s_cselect_b32 s32, 0, s32
  s_add_u32 s19, s19, 1
  s_cmp_lt_u32 s19, s35
  s_cbranch_scc1 wg_f_loop
  s_branch wg_done
wg_vo:
  s_sub_u32 s29, s17, 16
  s_lshl_b32 s29, s29, 6
  s_add_u32 s29, s29, s28
  s_mul_i32 s29, s29, 28672
  s_add_u32 s29, s29, 42205184
  v_lshlrev_b32 v6, 4, v3
  v_mul_u32_u24 v7, 12, v3
  v_add_u32 v7, 48, v7
  s_mov_b32 s31, 0
  s_lshl_b32 s24, s34, 1
  s_mul_i32 s24, s24, 14336
  s_add_u32 s24, s24, s23
  s_add_u32 m0, s31, s27
  s_nop 0
  buffer_load_dwordx4 v2, s[8:11], s24 offen offset:0  lds
  buffer_load_dwordx4 v2, s[8:11], s24 offen offset:1024  lds
  buffer_load_dwordx4 v2, s[8:11], s24 offen offset:2048  lds
  buffer_load_dwordx4 v2, s[8:11], s24 offen offset:3072  lds
  s_add_u32 m0, m0, 4096
  s_add_u32 s24, s24, 4096
  buffer_load_dwordx4 v2, s[8:11], s24 offen offset:0  lds
  buffer_load_dwordx4 v2, s[8:11], s24 offen offset:1024  lds
  buffer_load_dwordx4 v2, s[8:11], s24 offen offset:2048  lds
  s_add_u32 s30, s34, 1
  s_mov_b32 s31, 28672
  s_lshl_b32 s24, s30, 1
  s_mul_i32 s24, s24, 14336
  s_add_u32 s24, s24, s23
  s_add_u32 m0, s31, s27
  s_nop 0
  buffer_load_dwordx4 v2, s[8:11], s24 offen offset:0  lds
  buffer_load_dwordx4 v2, s[8:11], s24 offen offset:1024  lds
  buffer_load_dwordx4 v2, s[8:11], s24 offen offset:2048  lds
  buffer_load_dwordx4 v2, s[8:11], s24 offen offset:3072  lds
  s_add_u32 m0, m0, 4096
  s_add_u32 s24, s24, 4096
  buffer_load_dwordx4 v2, s[8:11], s24 offen offset:0  lds
  buffer_load_dwordx4 v2, s[8:11], s24 offen offset:1024  lds
  buffer_load_dwordx4 v2, s[8:11], s24 offen offset:2048  lds
  s_mov_b32 s19, s34
  s_mov_b32 s32, 0
  s_mov_b32 s33, 57344
  s_waitcnt vmcnt(7)
  s_branch wg_vo_in
wg_vo_loop:
  s_waitcnt vmcnt(11)
wg_vo_in:
  s_barrier
  s_add_u32 s30, s19, 2
  s_min_u32 s30, s30, 13
  s_lshl_b32 s24, s30, 1
  s_mul_i32 s24, s24, 14336
  s_add_u32 s24, s24, s23
  s_add_u32 m0, s33, s27
  s_nop 0
  buffer_load_dwordx4 v2, s[8:11], s24 offen offset:0  lds
  buffer_load_dwordx4 v2, s[8:11], s24 offen offset:1024  lds
  buffer_load_dwordx4 v2, s[8:11], s24 offen offset:2048  lds
  buffer_load_dwordx4 v2, s[8:11], s24 offen offset:3072  lds
  s_add_u32 m0, m0, 4096
  s_add_u32 s24, s24, 4096
  buffer_load_dwordx4 v2, s[8:11], s24 offen offset:0  lds
  buffer_load_dwordx4 v2, s[8:11], s24 offen offset:1024  lds
  buffer_load_dwordx4 v2, s[8:11], s24 offen offset:2048  lds
  v_add_u32 v5, s32, v2
  ds_read_b128 v[8:11], v5 offset:0
  ds_read_b128 v[12:15], v5 offset:14336
  ds_read_b128 v[16:19], v5 offset:1024
  ds_read_b128 v[20:23], v5 offset:15360
  ds_read_b128 v[24:27], v5 offset:2048
  ds_read_b128 v[28:31], v5 offset:16384
  ds_read_b128 v[32:35], v5 offset:3072
  s_waitcnt lgkmcnt(6)
  v_mfma_f32_16x16x32_bf16 v[40:43], a[0:3], v[8:11], 0
  v_mfma_f32_16x16x32_bf16 v[44:47], a[56:59], v[8:11], 0
  v_mfma_f32_16x16x32_bf16 v[48:51], a[112:115], v[8:11], 0
  v_mfma_f32_16x16x32_bf16 v[52:55], a[168:171], v[8:11], 0
  ds_read_b128 v[36:39], v5 offset:17408
  s_waitcnt lgkmcnt(6)
  v_mfma_f32_16x16x32_bf16 v[56:59], a[0:3], v[12:15], 0
  v_mfma_f32_16x16x32_bf16 v[60:63], a[56:59], v[12:15], 0
  v_mfma_f32_16x16x32_bf16 v[64:67], a[112:115], v[12:15], 0
  v_mfma_f32_16x16x32_bf16 v[68:71], a[168:171], v[12:15], 0
  ds_read_b128 v[8:11], v5 offset:4096
  s_waitcnt lgkmcnt(6)
  v_mfma_f32_16x16x32_bf16 v[40:43], a[4:7], v[16:19], v[40:43]
  v_mfma_f32_16x16x32_bf16 v[44:47], a[60:63], v[16:19], v[44:47]
  v_mfma_f32_16x16x32_bf16 v[48:51], a[116:119], v[16:19], v[48:51]
  v_mfma_f32_16x16x32_bf16 v[52:55], a[172:175], v[16:19], v[52:55]
  ds_read_b128 v[12:15], v5 offset:18432
  s_waitcnt lgkmcnt(6)
  v_mfma_f32_16x16x32_bf16 v[56:59], a[4:7], v[20:23], v[56:59]
  v_mfma_f32_16x16x32_bf16 v[60:63], a[60:63], v[20:23], v[60:63]
  v_mfma_f32_16x16x32_bf16 v[64:67], a[116:119], v[20:23], v[64:67]
  v_mfma_f32_16x16x32_bf16 v[68:71], a[172:175], v[20:23], v[68:71]
  ds_read_b128 v[16:19], v5 offset:5120
  s_waitcnt lgkmcnt(6)
  v_mfma_f32_16x16x32_bf16 v[40:43], a[8:11], v[24:27], v[40:43]
  v_mfma_f32_16x16x32_bf16 v[44:47], a[64:67], v[24:27], v[44:47]
  v_mfma_f32_16x16x32_bf16 v[48:51], a[120:123], v[24:27], v[48:51]
  v_mfma_f32_16x16x32_bf16 v[52:55], a[176:179], v[24:27], v[52:55]
  ds_read_b128 v[20:23], v5 offset:19456
  s_waitcnt lgkmcnt(6)
  v_mfma_f32_16x16x32_bf16 v[56:59], a[8:11], v[28:31], v[56:59]
  v_mfma_f32_16x16x32_bf16 v[60:63], a[64:67], v[28:31], v[60:63]
  v_mfma_f32_16x16x32_bf16 v[64:67], a[120:123], v[28:31], v[64:67]
  v_mfma_f32_16x16x32_bf16 v[68:71], a[176:179], v[28:31], v[68:71]
  ds_read_b128 v[24:27], v5 offset:6144
  s_waitcnt lgkmcnt(6)
  v_mfma_f32_16x16x32_bf16 v[40:43], a[12:15], v[32:35], v[40:43]
  v_mfma_f32_16x16x32_bf16 v[44:47], a[68:71], v[32:35], v[44:47]
  v_mfma_f32_16x16x32_bf16 v[48:51], a[124:127], v[32:35], v[48:51]
  v_mfma_f32_16x16x32_bf16 v[52:55], a[180:183], v[32:35], v[52:55]
  ds_read_b128 v[28:31], v5 offset:20480
  s_waitcnt lgkmcnt(6)
  v_mfma_f32_16x16x32_bf16 v[56:59], a[12:15], v[36:39], v[56:59]
  v_mfma_f32_16x16x32_bf16 v[60:63], a[68:71], v[36:39], v[60:63]
  v_mfma_f32_16x16x32_bf16 v[64:67], a[124:127], v[36:39], v[64:67]
  v_mfma_f32_16x16x32_bf16 v[68:71], a[180:183], v[36:39], v[68:71]
  ds_read_b128 v[32:35], v5 offset:7168
  s_waitcnt lgkmcnt(6)
  v_mfma_f32_16x16x32_bf16 v[40:43], a[16:19], v[8:11], v[40:43]
  v_mfma_f32_16x16x32_bf16 v[44:47], a[72:75], v[8:11], v[44:47]
  v_mfma_f32_16x16x32_bf16 v[48:51], a[128:131], v[8:11], v[48:51]
  v_mfma_f32_16x16x32_bf16 v[52:55], a[184:187], v[8:11], v[52:55]
  ds_read_b128 v[36:39], v5 offset:21504
  s_waitcnt lgkmcnt(6)
  v_mfma_f32_16x16x32_bf16 v[56:59], a[16:19], v[12:15], v[56:59]
  v_mfma_f32_16x16x32_bf16 v[60:63], a[72:75], v[12:15], v[60:63]
  v_mfma_f32_16x16x32_bf16 v[64:67], a[128:131], v[12:15], v[64:67]
  v_mfma_f32_16x16x32_bf16 v[68:71], a[184:187], v[12:15], v[68:71]
  ds_read_b128 v[8:11], v5 offset:8192
  s_waitcnt lgkmcnt(6)
  v_mfma_f32_16x16x32_bf16 v[40:43], a[20:23], v[16:19], v[40:43]
  v_mfma_f32_16x16x32_bf16 v[44:47], a[76:79], v[16:19], v[44:47]
  v_mfma_f32_16x16x32_bf16 v[48:51], a[132:135], v[16:19], v[48:51]
  v_mfma_f32_16x16x32_bf16 v[52:55], a[188:191], v[16:19], v[52:55]
  ds_read_b128 v[12:15], v5 offset:22528
  s_waitcnt lgkmcnt(6)
  v_mfma_f32_16x16x32_bf16 v[56:59], a[20:23], v[20:23], v[56:59]
  v_mfma_f32_16x16x32_bf16 v[60:63], a[76:79], v[20:23], v[60:63]
  v_mfma_f32_16x16x32_bf16 v[64:67], a[132:135], v[20:23], v[64:67]
  v_mfma_f32_16x16x32_bf16 v[68:71], a[188:191], v[20:23], v[68:71]
  ds_read_b128 v[16:19], v5 offset:9216
  s_waitcnt lgkmcnt(6)
  v_mfma_f32_16x16x32_bf16 v[40:43], a[24:27], v[24:27], v[40:43]
  v_mfma_f32_16x16x32_bf16 v[44:47], a[80:83], v[24:27], v[44:47]
  v_mfma_f32_16x16x32_bf16 v[48:51], a[136:139], v[24:27], v[48:51]
  v_mfma_f32_16x16x32_bf16 v[52:55], a[192:195], v[24:27], v[52:55]
  ds_read_b128 v[20:23], v5 offset:23552
  s_waitcnt lgkmcnt(6)
  v_mfma_f32_16x16x32_bf16 v[56:59], a[24:27], v[28:31], v[56:59]
  v_mfma_f32_16x16x32_bf16 v[60:63], a[80:83], v[28:31], v[60:63]
  v_mfma_f32_16x16x32_bf16 v[64:67], a[136:139], v[28:31], v[64:67]
  v_mfma_f32_16x16x32_bf16 v[68:71], a[192:195], v[28:31], v[68:71]
  ds_read_b128 v[24:27], v5 offset:10240
  s_waitcnt lgkmcnt(6)
  v_mfma_f32_16x16x32_bf16 v[40:43], a[28:31], v[32:35], v[40:43]
  v_mfma_f32_16x16x32_bf16 v[44:47], a[84:87], v[32:35], v[44:47]
  v_mfma_f32_16x16x32_bf16 v[48:51], a[140:143], v[32:35], v[48:51]
  v_mfma_f32_16x16x32_bf16 v[52:55], a[196:199], v[32:35], v[52:55]
  ds_read_b128 v[28:31], v5 offset:24576
  s_waitcnt lgkmcnt(6)
  v_mfma_f32_16x16x32_bf16 v[56:59], a[28:31], v[36:39], v[56:59]
  v_mfma_f32_16x16x32_bf16 v[60:63], a[84:87], v[36:39], v[60:63]
  v_mfma_f32_16x16x32_bf16 v[64:67], a[140:143], v[36:39], v[64:67]
  v_mfma_f32_16x16x32_bf16 v[68:71], a[196:199], v[36:39], v[68:71]
  ds_read_b128 v[32:35], v5 offset:11264
  s_waitcnt lgkmcnt(6)
  v_mfma_f32_16x16x32_bf16 v[40:43], a[32:35], v[8:11], v[40:43]
  v_mfma_f32_16x16x32_bf16 v[44:47], a[88:91], v[8:11], v[44:47]
  v_mfma_f32_16x16x32_bf16 v[48:51], a[144:147], v[8:11], v[48:51]
  v_mfma_f32_16x16x32_bf16 v[52:55], a[200:203], v[8:11], v[52:55]
  ds_read_b128 v[36:39], v5 offset:25600
  s_waitcnt lgkmcnt(6)
  v_mfma_f32_16x16x32_bf16 v[56:59], a[32:35], v[12:15], v[56:59]
  v_mfma_f32_16x16x32_bf16 v[60:63], a[88:91], v[12:15], v[60:63]
  v_mfma_f32_16x16x32_bf16 v[64:67], a[144:147], v[12:15], v[64:67]
  v_mfma_f32_16x16x32_bf16 v[68:71], a[200:203], v[12:15], v[68:71]
  ds_read_b128 v[8:11], v5 offset:12288
  s_waitcnt lgkmcnt(6)
  v_mfma_f32_16x16x32_bf16 v[40:43], a[36:39], v[16:19], v[40:43]
  v_mfma_f32_16x16x32_bf16 v[44:47], a[92:95], v[16:19], v[44:47]
  v_mfma_f32_16x16x32_bf16 v[48:51], a[148:151], v[16:19], v[48:51]
  v_mfma_f32_16x16x32_bf16 v[52:55], a[204:207], v[16:19], v[52:55]
  ds_read_b128 v[12:15], v5 offset:26624
  s_waitcnt lgkmcnt(6)
  v_mfma_f32_16x16x32_bf16 v[56:59], a[36:39], v[20:23], v[56:59]
  v_mfma_f32_16x16x32_bf16 v[60:63], a[92:95], v[20:23], v[60:63]
  v_mfma_f32_16x16x32_bf16 v[64:67], a[148:151], v[20:23], v[64:67]
  v_mfma_f32_16x16x32_bf16 v[68:71], a[204:207], v[20:23], v[68:71]
  ds_read_b128 v[16:19], v5 offset:13312
  s_waitcnt lgkmcnt(6)
  v_mfma_f32_16x16x32_bf16 v[40:43], a[40:43], v[24:27], v[40:43]
  v_mfma_f32_16x16x32_bf16 v[44:47], a[96:99], v[24:27], v[44:47]
  v_mfma_f32_16x16x32_bf16 v[48:51], a[152:155], v[24:27], v[48:51]
  v_mfma_f32_16x16x32_bf16 v[52:55], a[208:211], v[24:27], v[52:55]
  ds_read_b128 v[20:23], v5 offset:27648
  s_waitcnt lgkmcnt(6)
  v_mfma_f32_16x16x32_bf16 v[56:59], a[40:43], v[28:31], v[56:59]
  v_mfma_f32_16x16x32_bf16 v[60:63], a[96:99], v[28:31], v[60:63]
  v_mfma_f32_16x16x32_bf16 v[64:67], a[152:155], v[28:31], v[64:67]
  v_mfma_f32_16x16x32_bf16 v[68:71], a[208:211], v[28:31], v[68:71]
  s_waitcnt lgkmcnt(5)
  v_mfma_f32_16x16x32_bf16 v[40:43], a[44:47], v[32:35], v[40:43]
  v_mfma_f32_16x16x32_bf16 v[44:47], a[100:103], v[32:35], v[44:47]
  v_mfma_f32_16x16x32_bf16 v[48:51], a[156:159], v[32:35], v[48:51]
  v_mfma_f32_16x16x32_bf16 v[52:55], a[212:215], v[32:35], v[52:55]
  s_waitcnt lgkmcnt(4)
  v_mfma_f32_16x16x32_bf16 v[56:59], a[44:47], v[36:39], v[56:59]
  v_mfma_f32_16x16x32_bf16 v[60:63], a[100:103], v[36:39], v[60:63]
  v_mfma_f32_16x16x32_bf16 v[64:67], a[156:159], v[36:39], v[64:67]
  v_mfma_f32_16x16x32_bf16 v[68:71], a[212:215], v[36:39], v[68:71]
  s_waitcnt lgkmcnt(3)
  v_mfma_f32_16x16x32_bf16 v[40:43], a[48:51], v[8:11], v[40:43]
  v_mfma_f32_16x16x32_bf16 v[44:47], a[104:107], v[8:11], v[44:47]
  v_mfma_f32_16x16x32_bf16 v[48:51], a[160:163], v[8:11], v[48:51]
  v_mfma_f32_16x16x32_bf16 v[52:55], a[216:219], v[8:11], v[52:55]
  s_waitcnt lgkmcnt(2)
  v_mfma_f32_16x16x32_bf16 v[56:59], a[48:51], v[12:15], v[56:59]
  v_mfma_f32_16x16x32_bf16 v[60:63], a[104:107], v[12:15], v[60:63]
  v_mfma_f32_16x16x32_bf16 v[64:67], a[160:163], v[12:15], v[64:67]
  v_mfma_f32_16x16x32_bf16 v[68:71], a[216:219], v[12:15], v[68:71]
  s_waitcnt lgkmcnt(1)
  v_mfma_f32_16x16x32_bf16 v[40:43], a[52:55], v[16:19], v[40:43]
  v_mfma_f32_16x16x32_bf16 v[44:47], a[108:111], v[16:19], v[44:47]
  v_mfma_f32_16x16x32_bf16 v[48:51], a[164:167], v[16:19], v[48:51]
  v_mfma_f32_16x16x32_bf16 v[52:55], a[220:223], v[16:19], v[52:55]
  s_waitcnt lgkmcnt(0)
  v_mfma_f32_16x16x32_bf16 v[56:59], a[52:55], v[20:23], v[56:59]
  v_mfma_f32_16x16x32_bf16 v[60:63], a[108:111], v[20:23], v[60:63]
  v_mfma_f32_16x16x32_bf16 v[64:67], a[164:167], v[20:23], v[64:67]
  v_mfma_f32_16x16x32_bf16 v[68:71], a[220:223], v[20:23], v[68:71]
  s_add_u32 s25, s29, 28672
  s_lshl_b32 s24, s19, 5
  s_add_u32 s24, s24, 0
  v_add_u32 v88, s24, v4
  v_mul_u32_u24 v89, 2341, v88
  v_lshrrev_b32 v89, 16, v89
  v_mul_u32_u24 v92, 28, v89
  v_sub_u32 v92, v88, v92
  v_cmp_gt_u32 vcc, 16, v92
  v_mul_u32_u24 v89, 84, v89
  s_nop 0
  v_cndmask_b32 v92, v7, v6, vcc
  v_add3_u32 v88, v88, v89, v92
  v_lshlrev_b32 v90, 4, v88
  v_cvt_pk_bf16_f32 v72, v40, v44
  v_cvt_pk_bf16_f32 v73, v41, v45
  v_cvt_pk_bf16_f32 v74, v42, v46
  v_cvt_pk_bf16_f32 v75, v43, v47
  buffer_store_dwordx4 v[72:75], v90, s[8:11], s29 offen sc1
  v_cvt_pk_bf16_f32 v76, v48, v52
  v_cvt_pk_bf16_f32 v77, v49, v53
  v_cvt_pk_bf16_f32 v78, v50, v54
  v_cvt_pk_bf16_f32 v79, v51, v55
  buffer_store_dwordx4 v[76:79], v90, s[8:11], s25 offen sc1
  s_lshl_b32 s24, s19, 5
  s_add_u32 s24, s24, 16
  v_add_u32 v88, s24, v4
  v_mul_u32_u24 v89, 2341, v88
  v_lshrrev_b32 v89, 16, v89
  v_mul_u32_u24 v92, 28, v89
  v_sub_u32 v92, v88, v92
  v_cmp_gt_u32 vcc, 16, v92
  v_mul_u32_u24 v89, 84, v89
  s_nop 0
  v_cndmask_b32 v92, v7, v6, vcc
  v_add3_u32 v88, v88, v89, v92
  v_lshlrev_b32 v91, 4, v88
  v_cvt_pk_bf16_f32 v80, v56, v60
  v_cvt_pk_bf16_f32 v81, v57, v61
  v_cvt_pk_bf16_f32 v82, v58, v62
  v_cvt_pk_bf16_f32 v83, v59, v63
  buffer_store_dwordx4 v[80:83], v91, s[8:11], s29 offen sc1
  v_cvt_pk_bf16_f32 v84, v64, v68
  v_cvt_pk_bf16_f32 v85, v65, v69
  v_cvt_pk_bf16_f32 v86, v66, v70
  v_cvt_pk_bf16_f32 v87, v67, v71
  buffer_store_dwordx4 v[84:87], v91, s[8:11], s25 offen sc1
  s_mov_b32 s33, s32
  s_add_u32 s32, s32, 28672
  s_cmp_eq_u32 s32, 86016
  s_cselect_b32 s32, 0, s32
  s_add_u32 s19, s19, 1
  s_cmp_lt_u32 s19, s35
  s_cbranch_scc1 wg_vo_loop
  s_branch wg_done
wg_done:
  s_lshl_b32 s20, s18, 4
  s_and_b32 s21, s17, 15
  s_add_u32 s20, s20, s21
  s_lshl_b32 s20, s20, 2
  s_cmp_lt_u32 s17, 16
  s_cselect_b32 s21, 512, 0
  s_add_u32 s20, s20, s21
  s_add_u32 s20, s20, 88002560
  s_sub_u32 s21, s35, s34
  v_mov_b32 v5, s21
  v_mov_b32 v6, 0
  s_waitcnt vmcnt(0)
  s_mov_b64 exec, 1
  buffer_atomic_add v5, v6, s[8:11], s20 offen
  s_mov_b64 exec, -1
  s_branch wk_loop
wk_srv:
  s_and_b32 s18, s3, 15
  s_lshr_b32 s19, s3, 4
  s_and_b32 s19, s19, 1
  s_mul_i32 s20, s18, 401408
  s_mul_i32 s21, s16, 100352
  s_add_u32 s20, s20, s21
  s_add_u32 s20, s20, 6422528
  s_add_u32 s22, s20, 0
  buffer_load_dwordx4 a[0:3], v2, s[8:11], s22 offen offset:0
  buffer_load_dwordx4 a[4:7], v2, s[8:11], s22 offen offset:1024
  buffer_load_dwordx4 a[8:11], v2, s[8:11], s22 offen offset:2048
  buffer_load_dwordx4 a[12:15], v2, s[8:11], s22 offen offset:3072
  s_add_u32 s22, s20, 4096
  buffer_load_dwordx4 a[16:19], v2, s[8:11], s22 offen offset:0
  buffer_load_dwordx4 a[20:23], v2, s[8:11], s22 offen offset:1024
  buffer_load_dwordx4 a[24:27], v2, s[8:11], s22 offen offset:2048
  buffer_load_dwordx4 a[28:31], v2, s[8:11], s22 offen offset:3072
  s_add_u32 s22, s20, 8192
  buffer_load_dwordx4 a[32:35], v2, s[8:11], s22 offen offset:0
  buffer_load_dwordx4 a[36:39], v2, s[8:11], s22 offen offset:1024
  buffer_load_dwordx4 a[40:43], v2, s[8:11], s22 offen offset:2048
  buffer_load_dwordx4 a[44:47], v2, s[8:11], s22 offen offset:3072
  s_add_u32 s22, s20, 12288
  buffer_load_dwordx4 a[48:51], v2, s[8:11], s22 offen offset:0
  buffer_load_dwordx4 a[52:55], v2, s[8:11], s22 offen offset:1024
  buffer_load_dwordx4 a[56:59], v2, s[8:11], s22 offen offset:2048
  buffer_load_dwordx4 a[60:63], v2, s[8:11], s22 offen offset:3072
  s_add_u32 s22, s20, 16384
  buffer_load_dwordx4 a[64:67], v2, s[8:11], s22 offen offset:0
  buffer_load_dwordx4 a[68:71], v2, s[8:11], s22 offen offset:1024
  buffer_load_dwordx4 a[72:75], v2, s[8:11], s22 offen offset:2048
  buffer_load_dwordx4 a[76:79], v2, s[8:11], s22 offen offset:3072
  s_add_u32 s22, s20, 20480
  buffer_load_dwordx4 a[80:83], v2, s[8:11], s22 offen offset:0
  buffer_load_dwordx4 a[84:87], v2, s[8:11], s22 offen offset:1024
  buffer_load_dwordx4 a[88:91], v2, s[8:11], s22 offen offset:2048
  buffer_load_dwordx4 a[92:95], v2, s[8:11], s22 offen offset:3072
  s_add_u32 s22, s20, 24576
  buffer_load_dwordx4 a[96:99], v2, s[8:11], s22 offen offset:0
  buffer_load_dwordx4 a[100:103], v2, s[8:11], s22 offen offset:1024
  buffer_load_dwordx4 a[104:107], v2, s[8:11], s22 offen offset:2048
  buffer_load_dwordx4 a[108:111], v2, s[8:11], s22 offen offset:3072
  s_add_u32 s22, s20, 28672
  buffer_load_dwordx4 a[112:115], v2, s[8:11], s22 offen offset:0
  buffer_load_dwordx4 a[116:119], v2, s[8:11], s22 offen offset:1024
  buffer_load_dwordx4 a[120:123], v2, s[8:11], s22 offen offset:2048
  buffer_load_dwordx4 a[124:127], v2, s[8:11], s22 offen offset:3072
  s_waitcnt vmcnt(24)
  s_add_u32 s22, s20, 32768
  buffer_load_dwordx4 a[128:131], v2, s[8:11], s22 offen offset:0
  buffer_load_dwordx4 a[132:135], v2, s[8:11], s22 offen offset:1024
  buffer_load_dwordx4 a[136:139], v2, s[8:11], s22 offen offset:2048
  buffer_load_dwordx4 a[140:143], v2, s[8:11], s22 offen offset:3072
  s_add_u32 s22, s20, 36864
  buffer_load_dwordx4 a[144:147], v2, s[8:11], s22 offen offset:0
  buffer_load_dwordx4 a[148:151], v2, s[8:11], s22 offen offset:1024
  buffer_load_dwordx4 a[152:155], v2, s[8:11], s22 offen offset:2048
  buffer_load_dwordx4 a[156:159], v2, s[8:11], s22 offen offset:3072
  s_add_u32 s22, s20, 40960
  buffer_load_dwordx4 a[160:163], v2, s[8:11], s22 offen offset:0
  buffer_load_dwordx4 a[164:167], v2, s[8:11], s22 offen offset:1024
  buffer_load_dwordx4 a[168:171], v2, s[8:11], s22 offen offset:2048
  buffer_load_dwordx4 a[172:175], v2, s[8:11], s22 offen offset:3072
  s_add_u32 s22, s20, 45056
  buffer_load_dwordx4 a[176:179], v2, s[8:11], s22 offen offset:0
  buffer_load_dwordx4 a[180:183], v2, s[8:11], s22 offen offset:1024
  buffer_load_dwordx4 a[184:187], v2, s[8:11], s22 offen offset:2048
  buffer_load_dwordx4 a[188:191], v2, s[8:11], s22 offen offset:3072
  s_add_u32 s22, s20, 49152
  buffer_load_dwordx4 a[192:195], v2, s[8:11], s22 offen offset:0
  buffer_load_dwordx4 a[196:199], v2, s[8:11], s22 offen offset:1024
  buffer_load_dwordx4 a[200:203], v2, s[8:11], s22 offen offset:2048
  buffer_load_dwordx4 a[204:207], v2, s[8:11], s22 offen offset:3072
  s_add_u32 s22, s20, 53248
  buffer_load_dwordx4 a[208:211], v2, s[8:11], s22 offen offset:0
  buffer_load_dwordx4 a[212:215], v2, s[8:11], s22 offen offset:1024
  buffer_load_dwordx4 a[216:219], v2, s[8:11], s22 offen offset:2048
  buffer_load_dwordx4 a[220:223], v2, s[8:11], s22 offen offset:3072
  s_add_u32 s22, s20, 57344
  buffer_load_dwordx4 a[224:227], v2, s[8:11], s22 offen offset:0
  buffer_load_dwordx4 a[228:231], v2, s[8:11], s22 offen offset:1024
  buffer_load_dwordx4 a[232:235], v2, s[8:11], s22 offen offset:2048
  buffer_load_dwordx4 a[236:239], v2, s[8:11], s22 offen offset:3072
  s_add_u32 s22, s20, 61440
  buffer_load_dwordx4 a[240:243], v2, s[8:11], s22 offen offset:0
  buffer_load_dwordx4 a[244:247], v2, s[8:11], s22 offen offset:1024
  buffer_load_dwordx4 a[248:251], v2, s[8:11], s22 offen offset:2048
  buffer_load_dwordx4 a[252:255], v2, s[8:11], s22 offen offset:3072
  s_waitcnt vmcnt(24)
  s_add_u32 s22, s20, 65536
  buffer_load_dwordx4 v[120:123], v2, s[8:11], s22 offen offset:0
  buffer_load_dwordx4 v[124:127], v2, s[8:11], s22 offen offset:1024
  buffer_load_dwordx4 v[128:131], v2, s[8:11], s22 offen offset:2048
  buffer_load_dwordx4 v[132:135], v2, s[8:11], s22 offen offset:3072
  s_add_u32 s22, s20, 69632
  buffer_load_dwordx4 v[136:139], v2, s[8:11], s22 offen offset:0
  buffer_load_dwordx4 v[140:143], v2, s[8:11], s22 offen offset:1024
  buffer_load_dwordx4 v[144:147], v2, s[8:11], s22 offen offset:2048
  buffer_load_dwordx4 v[148:151], v2, s[8:11], s22 offen offset:3072
  s_add_u32 s22, s20, 73728
  buffer_load_dwordx4 v[152:155], v2, s[8:11], s22 offen offset:0
  buffer_load_dwordx4 v[156:159], v2, s[8:11], s22 offen offset:1024
  buffer_load_dwordx4 v[160:163], v2, s[8:11], s22 offen offset:2048
  buffer_load_dwordx4 v[164:167], v2, s[8:11], s22 offen offset:3072
  s_add_u32 s22, s20, 77824
  buffer_load_dwordx4 v[168:171], v2, s[8:11], s22 offen offset:0
  buffer_load_dwordx4 v[172:175], v2, s[8:11], s22 offen offset:1024
  buffer_load_dwordx4 v[176:179], v2, s[8:11], s22 offen offset:2048
  buffer_load_dwordx4 v[180:183], v2, s[8:11], s22 offen offset:3072
  s_add_u32 s22, s20, 81920
  buffer_load_dwordx4 v[184:187], v2, s[8:11], s22 offen offset:0
  buffer_load_dwordx4 v[188:191], v2, s[8:11], s22 offen offset:1024
  buffer_load_dwordx4 v[192:195], v2, s[8:11], s22 offen offset:2048
  buffer_load_dwordx4 v[196:199], v2, s[8:11], s22 offen offset:3072
  s_add_u32 s22, s20, 86016
  buffer_load_dwordx4 v[200:203], v2, s[8:11], s22 offen offset:0
  buffer_load_dwordx4 v[204:207], v2, s[8:11], s22 offen offset:1024
  buffer_load_dwordx4 v[208:211], v2, s[8:11], s22 offen offset:2048
  buffer_load_dwordx4 v[212:215], v2, s[8:11], s22 offen offset:3072
  s_add_u32 s22, s20, 90112
  buffer_load_dwordx4 v[216:219], v2, s[8:11], s22 offen offset:0
  buffer_load_dwordx4 v[220:223], v2, s[8:11], s22 offen offset:1024
  buffer_load_dwordx4 v[224:227], v2, s[8:11], s22 offen offset:2048
  buffer_load_dwordx4 v[228:231], v2, s[8:11], s22 offen offset:3072
  s_add_u32 s22, s20, 94208
  buffer_load_dwordx4 v[232:235], v2, s[8:11], s22 offen offset:0
  buffer_load_dwordx4 v[236:239], v2, s[8:11], s22 offen offset:1024
  buffer_load_dwordx4 v[240:243], v2, s[8:11], s22 offen offset:2048
  buffer_load_dwordx4 v[244:247], v2, s[8:11], s22 offen offset:3072
  s_waitcnt vmcnt(24)
  s_add_u32 s22, s20, 98304
  buffer_load_dwordx4 v[248:251], v2, s[8:11], s22 offen offset:0
  buffer_load_dwordx4 v[252:255], v2, s[8:11], s22 offen offset:1024
  v_mov_b32 v5, 0x4444
  v_mov_b32 v6, 0xeeee
  v_cmp_lt_u32 vcc, 7, v4
  s_nop 1
  v_cndmask_b32 v5, v5, v6, vcc
  s_lshl_b32 s23, s16, 11
  v_lshrrev_b32 v80, 1, v3
  v_and_b32 v81, 1, v3
  v_add_u32 v82, 0, v80
  v_lshl_add_u32 v82, v82, 4, v4
  v_mul_u32_u24 v83, 2341, v82
  v_lshrrev_b32 v83, 16, v83
  v_mul_u32_u24 v84, 28, v83
  v_sub_u32 v84, v82, v84
  v_lshrrev_b32 v85, 4, v84
  v_and_b32 v84, 15, v84
  v_lshlrev_b32 v86, 10, v85
  v_lshl_add_u32 v86, v83, 8, v86
  v_lshl_add_u32 v86, v84, 4, v86
  v_lshl_add_u32 v86, v81, 3, v86
  v_add_u32 v72, s23, v86
  v_add_u32 v82, 2, v80
  v_lshl_add_u32 v82, v82, 4, v4
  v_mul_u32_u24 v83, 2341, v82
  v_lshrrev_b32 v83, 16, v83
  v_mul_u32_u24 v84, 28, v83
  v_sub_u32 v84, v82, v84
  v_lshrrev_b32 v85, 4, v84
  v_and_b32 v84, 15, v84
  v_lshlrev_b32 v86, 10, v85
  v_lshl_add_u32 v86, v83, 8, v86
  v_lshl_add_u32 v86, v84, 4, v86
  v_lshl_add_u32 v86, v81, 3, v86
  v_add_u32 v73, s23, v86
  v_add_u32 v82, 4, v80
  v_lshl_add_u32 v82, v82, 4, v4
  v_mul_u32_u24 v83, 2341, v82
  v_lshrrev_b32 v83, 16, v83
  v_mul_u32_u24 v84, 28, v83
  v_sub_u32 v84, v82, v84
  v_lshrrev_b32 v85, 4, v84
  v_and_b32 v84, 15, v84
  v_lshlrev_b32 v86, 10, v85
  v_lshl_add_u32 v86, v83, 8, v86
  v_lshl_add_u32 v86, v84, 4, v86
  v_lshl_add_u32 v86, v81, 3, v86
  v_add_u32 v74, s23, v86
  v_mov_b32 v82, 6
  v_lshl_add_u32 v82, v82, 4, v4
  v_mul_u32_u24 v83, 2341, v82
  v_lshrrev_b32 v83, 16, v83
  v_mul_u32_u24 v84, 28, v83
  v_sub_u32 v84, v82, v84
  v_lshrrev_b32 v85, 4, v84
  v_and_b32 v84, 15, v84
  v_lshlrev_b32 v86, 10, v85
  v_lshl_add_u32 v86, v83, 8, v86
  v_lshl_add_u32 v86, v84, 4, v86
  v_lshl_add_u32 v86, v81, 3, v86
  v_add_u32 v75, s23, v86
  v_add_u32 v76, s23, v2
  s_mul_i32 s27, s18, 448
  v_mov_b32 v77, s27
  v_mov_b32 v78, 1
  s_mov_b32 s17, s19
  s_mul_i32 s24, s19, 7168
  s_add_u32 s24, s24, 87543808
  s_mul_i32 s25, s18, 65
  s_add_u32 s25, s25, s19
  s_lshl_b32 s25, s25, 13
  s_add_u32 s25, s25, s23
  s_add_u32 s25, s25, 76410880
  s_lshl_b32 s26, s18, 6
  s_add_u32 s26, s26, s19
  s_lshl_b32 s26, s26, 4
  s_lshl_b32 s27, s16, 2
  s_add_u32 s26, s26, s27
  s_add_u32 s26, s26, 88003840
ws_loop:
  v_mov_b32 v36, 0
  v_mov_b32 v37, 0
  v_mov_b32 v38, 0
  v_mov_b32 v39, 0
  v_mov_b32 v40, 0
  v_mov_b32 v41, 0
  v_mov_b32 v42, 0
  v_mov_b32 v43, 0
  v_mov_b32 v44, 0
  v_mov_b32 v45, 0
  v_mov_b32 v46, 0
  v_mov_b32 v47, 0
  v_mov_b32 v48, 0
  v_mov_b32 v49, 0
  v_mov_b32 v50, 0
  v_mov_b32 v51, 0
  v_mov_b32 v52, 0
  v_mov_b32 v53, 0
  v_mov_b32 v54, 0
  v_mov_b32 v55, 0
  v_mov_b32 v56, 0
  v_mov_b32 v57, 0
  v_mov_b32 v58, 0
  v_mov_b32 v59, 0
  v_mov_b32 v60, 0
  v_mov_b32 v61, 0
  v_mov_b32 v62, 0
  v_mov_b32 v63, 0
  s_mov_b32 s30, 0
  s_branch ws_fl
ws_pm:
  buffer_load_dword v79, v77, s[8:11], s24 offen sc1
  s_waitcnt vmcnt(0)
  v_cmp_eq_u32 vcc, -1, v79
  s_cbranch_vccnz ws_pr
ws_fl:
  s_add_u32 s22, s24, 4096
  buffer_load_dwordx4 v[8:11], v2, s[8:11], s24 offen offset:0 sc1
  buffer_load_dwordx4 v[12:15], v2, s[8:11], s24 offen offset:1024 sc1
  buffer_load_dwordx4 v[16:19], v2, s[8:11], s24 offen offset:2048 sc1
  buffer_load_dwordx4 v[20:23], v2, s[8:11], s24 offen offset:3072 sc1
  buffer_load_dwordx4 v[24:27], v2, s[8:11], s22 offen offset:0 sc1
  buffer_load_dwordx4 v[28:31], v2, s[8:11], s22 offen offset:1024 sc1
  buffer_load_dwordx4 v[32:35], v2, s[8:11], s22 offen offset:2048 sc1
  s_waitcnt vmcnt(0)
  v_max_u32 v79, v8, v9
  v_max3_u32 v79, v79, v10, v11
  v_max3_u32 v79, v79, v12, v13
  v_max3_u32 v79, v79, v14, v15
  v_max3_u32 v79, v79, v16, v17
  v_max3_u32 v79, v79, v18, v19
  v_max3_u32 v79, v79, v20, v21
  v_max3_u32 v79, v79, v22, v23
  v_max3_u32 v79, v79, v24, v25
  v_max3_u32 v79, v79, v26, v27
  v_max3_u32 v79, v79, v28, v29
  v_max3_u32 v79, v79, v30, v31
  v_max3_u32 v79, v79, v32, v33
  v_max3_u32 v79, v79, v34, v35
  v_cmp_eq_u32 vcc, -1, v79
  s_cbranch_vccz ws_pk
ws_pr:
  s_sleep 6
  s_add_u32 s30, s30, 1
  s_cmp_lt_u32 s30, 2000000
  s_cbranch_scc1 ws_pm
  s_branch cA_abort
ws_pk:
  v_smfmac_f32_16x16x64_bf16 v[36:39], v[8:11], a[0:7], v5
  v_smfmac_f32_16x16x64_bf16 v[36:39], v[12:15], a[8:15], v5
  v_smfmac_f32_16x16x64_bf16 v[36:39], v[16:19], a[16:23], v5
  v_smfmac_f32_16x16x64_bf16 v[36:39], v[20:23], a[24:31], v5
  v_smfmac_f32_16x16x64_bf16 v[36:39], v[24:27], a[32:39], v5
  v_smfmac_f32_16x16x64_bf16 v[36:39], v[28:31], a[40:47], v5
  v_smfmac_f32_16x16x64_bf16 v[36:39], v[32:35], a[48:55], v5
  v_smfmac_f32_16x16x64_bf16 v[40:43], v[8:11], a[56:63], v5
  v_smfmac_f32_16x16x64_bf16 v[40:43], v[12:15], a[64:71], v5
  v_smfmac_f32_16x16x64_bf16 v[40:43], v[16:19], a[72:79], v5
  v_smfmac_f32_16x16x64_bf16 v[40:43], v[20:23], a[80:87], v5
  v_smfmac_f32_16x16x64_bf16 v[40:43], v[24:27], a[88:95], v5
  v_smfmac_f32_16x16x64_bf16 v[40:43], v[28:31], a[96:103], v5
  v_smfmac_f32_16x16x64_bf16 v[40:43], v[32:35], a[104:111], v5
  v_smfmac_f32_16x16x64_bf16 v[44:47], v[8:11], a[112:119], v5
  v_smfmac_f32_16x16x64_bf16 v[44:47], v[12:15], a[120:127], v5
  v_smfmac_f32_16x16x64_bf16 v[44:47], v[16:19], a[128:135], v5
  v_smfmac_f32_16x16x64_bf16 v[44:47], v[20:23], a[136:143], v5
  v_smfmac_f32_16x16x64_bf16 v[44:47], v[24:27], a[144:151], v5
  v_smfmac_f32_16x16x64_bf16 v[44:47], v[28:31], a[152:159], v5
  v_smfmac_f32_16x16x64_bf16 v[44:47], v[32:35], a[160:167], v5
  v_smfmac_f32_16x16x64_bf16 v[48:51], v[8:11], a[168:175], v5
  v_smfmac_f32_16x16x64_bf16 v[48:51], v[12:15], a[176:183], v5
  v_smfmac_f32_16x16x64_bf16 v[48:51], v[16:19], a[184:191], v5
  v_smfmac_f32_16x16x64_bf16 v[48:51], v[20:23], a[192:199], v5
  v_smfmac_f32_16x16x64_bf16 v[48:51], v[24:27], a[200:207], v5
  v_smfmac_f32_16x16x64_bf16 v[48:51], v[28:31], a[208:215], v5
  v_smfmac_f32_16x16x64_bf16 v[48:51], v[32:35], a[216:223], v5
  v_smfmac_f32_16x16x64_bf16 v[52:55], v[8:11], a[224:231], v5
  v_smfmac_f32_16x16x64_bf16 v[52:55], v[12:15], a[232:239], v5
  v_smfmac_f32_16x16x64_bf16 v[52:55], v[16:19], a[240:247], v5
  v_smfmac_f32_16x16x64_bf16 v[52:55], v[20:23], a[248:255], v5
  v_smfmac_f32_16x16x64_bf16 v[52:55], v[24:27], v[120:127], v5
  v_smfmac_f32_16x16x64_bf16 v[52:55], v[28:31], v[128:135], v5
  v_smfmac_f32_16x16x64_bf16 v[52:55], v[32:35], v[136:143], v5
  v_smfmac_f32_16x16x64_bf16 v[56:59], v[8:11], v[144:151], v5
  v_smfmac_f32_16x16x64_bf16 v[56:59], v[12:15], v[152:159], v5
  v_smfmac_f32_16x16x64_bf16 v[56:59], v[16:19], v[160:167], v5
  v_smfmac_f32_16x16x64_bf16 v[56:59], v[20:23], v[168:175], v5
  v_smfmac_f32_16x16x64_bf16 v[56:59], v[24:27], v[176:183], v5
  v_smfmac_f32_16x16x64_bf16 v[56:59], v[28:31], v[184:191], v5
  v_smfmac_f32_16x16x64_bf16 v[56:59], v[32:35], v[192:199], v5
  v_smfmac_f32_16x16x64_bf16 v[60:63], v[8:11], v[200:207], v5
  v_smfmac_f32_16x16x64_bf16 v[60:63], v[12:15], v[208:215], v5
  v_smfmac_f32_16x16x64_bf16 v[60:63], v[16:19], v[216:223], v5
  v_smfmac_f32_16x16x64_bf16 v[60:63], v[20:23], v[224:231], v5
  v_smfmac_f32_16x16x64_bf16 v[60:63], v[24:27], v[232:239], v5
  v_smfmac_f32_16x16x64_bf16 v[60:63], v[28:31], v[240:247], v5
  v_smfmac_f32_16x16x64_bf16 v[60:63], v[32:35], v[248:255], v5
  v_permlane32_swap_b32 v36, v40
  v_permlane32_swap_b32 v37, v41
  v_permlane32_swap_b32 v38, v42
  v_permlane32_swap_b32 v39, v43
  v_add_f32 v36, v36, v40
  v_add_f32 v37, v37, v41
  v_add_f32 v38, v38, v42
  v_add_f32 v39, v39, v43
  v_cvt_pk_bf16_f32 v40, v36, v37
  v_cvt_pk_bf16_f32 v41, v38, v39
  ds_write_b64 v72, v[40:41]
  v_permlane32_swap_b32 v44, v48
  v_permlane32_swap_b32 v45, v49
  v_permlane32_swap_b32 v46, v50
  v_permlane32_swap_b32 v47, v51
  v_add_f32 v44, v44, v48
  v_add_f32 v45, v45, v49
  v_add_f32 v46, v46, v50
  v_add_f32 v47, v47, v51
  v_cvt_pk_bf16_f32 v48, v44, v45
  v_cvt_pk_bf16_f32 v49, v46, v47
  ds_write_b64 v73, v[48:49]
  v_permlane32_swap_b32 v52, v56
  v_permlane32_swap_b32 v53, v57
  v_permlane32_swap_b32 v54, v58
  v_permlane32_swap_b32 v55, v59
  v_add_f32 v52, v52, v56
  v_add_f32 v53, v53, v57
  v_add_f32 v54, v54, v58
  v_add_f32 v55, v55, v59
  v_cvt_pk_bf16_f32 v56, v52, v53
  v_cvt_pk_bf16_f32 v57, v54, v55
  ds_write_b64 v74, v[56:57]
  v_mov_b32 v64, v60
  v_mov_b32 v65, v61
  v_mov_b32 v66, v62
  v_mov_b32 v67, v63
  v_permlane32_swap_b32 v60, v64
  v_permlane32_swap_b32 v61, v65
  v_permlane32_swap_b32 v62, v66
  v_permlane32_swap_b32 v63, v67
  v_add_f32 v60, v60, v64
  v_add_f32 v61, v61, v65
  v_add_f32 v62, v62, v66
  v_add_f32 v63, v63, v67
  v_cvt_pk_bf16_f32 v64, v60, v61
  v_cvt_pk_bf16_f32 v65, v62, v63
  ds_write_b64 v75, v[64:65]
  s_waitcnt lgkmcnt(0)
  ds_read_b128 v[64:67], v76
  ds_read_b128 v[68:71], v76 offset:1024
  s_waitcnt lgkmcnt(0)
  buffer_store_dwordx4 v[64:67], v2, s[8:11], s25 offen sc1
  buffer_store_dwordx4 v[68:71], v2, s[8:11], s25 offen offset:1024 sc1
  s_waitcnt vmcnt(0)
  s_mov_b64 exec, 1
  buffer_store_dword v78, v2, s[8:11], s26 offen sc1
  s_mov_b64 exec, -1
  s_add_u32 s24, s24, 14336
  s_add_u32 s25, s25, 16384
  s_add_u32 s26, s26, 32
  s_add_u32 s17, s17, 2
  s_cmp_lt_u32 s17, 64
  s_cbranch_scc1 ws_loop
  v_mov_b32 v250, 0
  s_branch wk_loop
wk_s4d:
  s_sub_u32 s3, s3, 480
  s_load_dwordx8 s[40:47], s[0:1], 0
  s_load_dwordx4 s[48:51], s[0:1], 32
  s_load_dwordx2 s[52:53], s[0:1], 48
  s_load_dwordx2 s[54:55], s[0:1], 112
  v_lshrrev_b32 v1, 6, v0
  s_nop 0
  v_readfirstlane_b32 s16, v1
  v_and_b32 v1, 63, v0
  v_lshrrev_b32 v3, 4, v1
  v_and_b32 v4, 15, v1
  s_mul_i32 s17, s16, 24576
  s_waitcnt lgkmcnt(0)
  s_mov_b32 s60, s40
  s_and_b32 s61, s41, 0xffff
  s_mov_b32 s62, 1835008
  s_mov_b32 s63, 0x20000
  s_mov_b32 s64, s42
  s_and_b32 s65, s43, 0xffff
  s_mov_b32 s66, 229376
  s_mov_b32 s67, 0x20000
  s_mov_b32 s68, s44
  s_and_b32 s69, s45, 0xffff
  s_mov_b32 s70, 229376
  s_mov_b32 s71, 0x20000
  s_mov_b32 s72, s46
  s_and_b32 s73, s47, 0xffff
  s_mov_b32 s74, 229376
  s_mov_b32 s75, 0x20000
  s_mov_b32 s76, s48
  s_and_b32 s77, s49, 0xffff
  s_mov_b32 s78, 229376
  s_mov_b32 s79, 0x20000
  s_mov_b32 s80, s50
  s_and_b32 s81, s51, 0xffff
  s_mov_b32 s82, 896
  s_mov_b32 s83, 0x20000
  s_mov_b32 s84, s52
  s_and_b32 s85, s53, 0xffff
  s_mov_b32 s86, 896
  s_mov_b32 s87, 0x20000
  s_mov_b32 s88, s54
  s_and_b32 s89, s55, 0xffff
  s_mov_b32 s90, 3670016
  s_mov_b32 s91, 0x20000
  v_lshlrev_b32 v5, 5, v1
  v_sub_u32 v5, 2047, v5
  s_add_u32 s18, s17, 13056
  v_subrev_u32 v6, 0, v5
  v_max_i32 v7, 0, v6
  v_cvt_f32_u32 v7, v7
  v_cvt_pk_bf16_f32 v8, v7, v7
  v_and_b32 v7, 0xffff0000, v8
  v_lshrrev_b32 v8, 23, v7
  v_subrev_u32 v8, 134, v8
  v_max_i32 v8, 0, v8
  v_cvt_u32_f32 v7, v7
  v_lshrrev_b32 v7, v8, v7
  v_lshl_add_u32 v7, v8, 8, v7
  v_lshl_add_u32 v200, v7, 2, s18
  v_subrev_u32 v6, 1, v5
  v_max_i32 v7, 0, v6
  v_cvt_f32_u32 v7, v7
  v_cvt_pk_bf16_f32 v8, v7, v7
  v_and_b32 v7, 0xffff0000, v8
  v_lshrrev_b32 v8, 23, v7
  v_subrev_u32 v8, 134, v8
  v_max_i32 v8, 0, v8
  v_cvt_u32_f32 v7, v7
  v_lshrrev_b32 v7, v8, v7
  v_lshl_add_u32 v7, v8, 8, v7
  v_lshl_add_u32 v201, v7, 2, s18
  v_subrev_u32 v6, 2, v5
  v_max_i32 v7, 0, v6
  v_cvt_f32_u32 v7, v7
  v_cvt_pk_bf16_f32 v8, v7, v7
  v_and_b32 v7, 0xffff0000, v8
  v_lshrrev_b32 v8, 23, v7
  v_subrev_u32 v8, 134, v8
  v_max_i32 v8, 0, v8
  v_cvt_u32_f32 v7, v7
  v_lshrrev_b32 v7, v8, v7
  v_lshl_add_u32 v7, v8, 8, v7
  v_lshl_add_u32 v202, v7, 2, s18
  v_subrev_u32 v6, 3, v5
  v_max_i32 v7, 0, v6
  v_cvt_f32_u32 v7, v7
  v_cvt_pk_bf16_f32 v8, v7, v7
  v_and_b32 v7, 0xffff0000, v8
  v_lshrrev_b32 v8, 23, v7
  v_subrev_u32 v8, 134, v8
  v_max_i32 v8, 0, v8
  v_cvt_u32_f32 v7, v7
  v_lshrrev_b32 v7, v8, v7
  v_lshl_add_u32 v7, v8, 8, v7
  v_lshl_add_u32 v203, v7, 2, s18
  v_subrev_u32 v6, 4, v5
  v_max_i32 v7, 0, v6
  v_cvt_f32_u32 v7, v7
  v_cvt_pk_bf16_f32 v8, v7, v7
  v_and_b32 v7, 0xffff0000, v8
  v_lshrrev_b32 v8, 23, v7
  v_subrev_u32 v8, 134, v8
  v_max_i32 v8, 0, v8
  v_cvt_u32_f32 v7, v7
  v_lshrrev_b32 v7, v8, v7
  v_lshl_add_u32 v7, v8, 8, v7
  v_lshl_add_u32 v204, v7, 2, s18
  v_subrev_u32 v6, 5, v5
  v_max_i32 v7, 0, v6
  v_cvt_f32_u32 v7, v7
  v_cvt_pk_bf16_f32 v8, v7, v7
  v_and_b32 v7, 0xffff0000, v8
  v_lshrrev_b32 v8, 23, v7
  v_subrev_u32 v8, 134, v8
  v_max_i32 v8, 0, v8
  v_cvt_u32_f32 v7, v7
  v_lshrrev_b32 v7, v8, v7
  v_lshl_add_u32 v7, v8, 8, v7
  v_lshl_add_u32 v205, v7, 2, s18
  v_subrev_u32 v6, 6, v5
  v_max_i32 v7, 0, v6
  v_cvt_f32_u32 v7, v7
  v_cvt_pk_bf16_f32 v8, v7, v7
  v_and_b32 v7, 0xffff0000, v8
  v_lshrrev_b32 v8, 23, v7
  v_subrev_u32 v8, 134, v8
  v_max_i32 v8, 0, v8
  v_cvt_u32_f32 v7, v7
  v_lshrrev_b32 v7, v8, v7
  v_lshl_add_u32 v7, v8, 8, v7
  v_lshl_add_u32 v206, v7, 2, s18
  v_subrev_u32 v6, 7, v5
  v_max_i32 v7, 0, v6
  v_cvt_f32_u32 v7, v7
  v_cvt_pk_bf16_f32 v8, v7, v7
  v_and_b32 v7, 0xffff0000, v8
  v_lshrrev_b32 v8, 23, v7
  v_subrev_u32 v8, 134, v8
  v_max_i32 v8, 0, v8
  v_cvt_u32_f32 v7, v7
  v_lshrrev_b32 v7, v8, v7
  v_lshl_add_u32 v7, v8, 8, v7
  v_lshl_add_u32 v207, v7, 2, s18
  v_subrev_u32 v6, 8, v5
  v_max_i32 v7, 0, v6
  v_cvt_f32_u32 v7, v7
  v_cvt_pk_bf16_f32 v8, v7, v7
  v_and_b32 v7, 0xffff0000, v8
  v_lshrrev_b32 v8, 23, v7
  v_subrev_u32 v8, 134, v8
  v_max_i32 v8, 0, v8
  v_cvt_u32_f32 v7, v7
  v_lshrrev_b32 v7, v8, v7
  v_lshl_add_u32 v7, v8, 8, v7
  v_lshl_add_u32 v208, v7, 2, s18
  v_subrev_u32 v6, 9, v5
  v_max_i32 v7, 0, v6
  v_cvt_f32_u32 v7, v7
  v_cvt_pk_bf16_f32 v8, v7, v7
  v_and_b32 v7, 0xffff0000, v8
  v_lshrrev_b32 v8, 23, v7
  v_subrev_u32 v8, 134, v8
  v_max_i32 v8, 0, v8
  v_cvt_u32_f32 v7, v7
  v_lshrrev_b32 v7, v8, v7
  v_lshl_add_u32 v7, v8, 8, v7
  v_lshl_add_u32 v209, v7, 2, s18
  v_subrev_u32 v6, 10, v5
  v_max_i32 v7, 0, v6
  v_cvt_f32_u32 v7, v7
  v_cvt_pk_bf16_f32 v8, v7, v7
  v_and_b32 v7, 0xffff0000, v8
  v_lshrrev_b32 v8, 23, v7
  v_subrev_u32 v8, 134, v8
  v_max_i32 v8, 0, v8
  v_cvt_u32_f32 v7, v7
  v_lshrrev_b32 v7, v8, v7
  v_lshl_add_u32 v7, v8, 8, v7
  v_lshl_add_u32 v210, v7, 2, s18
  v_subrev_u32 v6, 11, v5
  v_max_i32 v7, 0, v6
  v_cvt_f32_u32 v7, v7
  v_cvt_pk_bf16_f32 v8, v7, v7
  v_and_b32 v7, 0xffff0000, v8
  v_lshrrev_b32 v8, 23, v7
  v_subrev_u32 v8, 134, v8
  v_max_i32 v8, 0, v8
  v_cvt_u32_f32 v7, v7
  v_lshrrev_b32 v7, v8, v7
  v_lshl_add_u32 v7, v8, 8, v7
  v_lshl_add_u32 v211, v7, 2, s18
  v_subrev_u32 v6, 12, v5
  v_max_i32 v7, 0, v6
  v_cvt_f32_u32 v7, v7
  v_cvt_pk_bf16_f32 v8, v7, v7
  v_and_b32 v7, 0xffff0000, v8
  v_lshrrev_b32 v8, 23, v7
  v_subrev_u32 v8, 134, v8
  v_max_i32 v8, 0, v8
  v_cvt_u32_f32 v7, v7
  v_lshrrev_b32 v7, v8, v7
  v_lshl_add_u32 v7, v8, 8, v7
  v_lshl_add_u32 v212, v7, 2, s18
  v_subrev_u32 v6, 13, v5
  v_max_i32 v7, 0, v6
  v_cvt_f32_u32 v7, v7
  v_cvt_pk_bf16_f32 v8, v7, v7
  v_and_b32 v7, 0xffff0000, v8
  v_lshrrev_b32 v8, 23, v7
  v_subrev_u32 v8, 134, v8
  v_max_i32 v8, 0, v8
  v_cvt_u32_f32 v7, v7
  v_lshrrev_b32 v7, v8, v7
  v_lshl_add_u32 v7, v8, 8, v7
  v_lshl_add_u32 v213, v7, 2, s18
  v_subrev_u32 v6, 14, v5
  v_max_i32 v7, 0, v6
  v_cvt_f32_u32 v7, v7
  v_cvt_pk_bf16_f32 v8, v7, v7
  v_and_b32 v7, 0xffff0000, v8
  v_lshrrev_b32 v8, 23, v7
  v_subrev_u32 v8, 134, v8
  v_max_i32 v8, 0, v8
  v_cvt_u32_f32 v7, v7
  v_lshrrev_b32 v7, v8, v7
  v_lshl_add_u32 v7, v8, 8, v7
  v_lshl_add_u32 v214, v7, 2, s18
  v_subrev_u32 v6, 15, v5
  v_max_i32 v7, 0, v6
  v_cvt_f32_u32 v7, v7
  v_cvt_pk_bf16_f32 v8, v7, v7
  v_and_b32 v7, 0xffff0000, v8
  v_lshrrev_b32 v8, 23, v7
  v_subrev_u32 v8, 134, v8
  v_max_i32 v8, 0, v8
  v_cvt_u32_f32 v7, v7
  v_lshrrev_b32 v7, v8, v7
  v_lshl_add_u32 v7, v8, 8, v7
  v_lshl_add_u32 v215, v7, 2, s18
  v_subrev_u32 v6, 16, v5
  v_max_i32 v7, 0, v6
  v_cvt_f32_u32 v7, v7
  v_cvt_pk_bf16_f32 v8, v7, v7
  v_and_b32 v7, 0xffff0000, v8
  v_lshrrev_b32 v8, 23, v7
  v_subrev_u32 v8, 134, v8
  v_max_i32 v8, 0, v8
  v_cvt_u32_f32 v7, v7
  v_lshrrev_b32 v7, v8, v7
  v_lshl_add_u32 v7, v8, 8, v7
  v_lshl_add_u32 v216, v7, 2, s18
  v_subrev_u32 v6, 17, v5
  v_max_i32 v7, 0, v6
  v_cvt_f32_u32 v7, v7
  v_cvt_pk_bf16_f32 v8, v7, v7
  v_and_b32 v7, 0xffff0000, v8
  v_lshrrev_b32 v8, 23, v7
  v_subrev_u32 v8, 134, v8
  v_max_i32 v8, 0, v8
  v_cvt_u32_f32 v7, v7
  v_lshrrev_b32 v7, v8, v7
  v_lshl_add_u32 v7, v8, 8, v7
  v_lshl_add_u32 v217, v7, 2, s18
  v_subrev_u32 v6, 18, v5
  v_max_i32 v7, 0, v6
  v_cvt_f32_u32 v7, v7
  v_cvt_pk_bf16_f32 v8, v7, v7
  v_and_b32 v7, 0xffff0000, v8
  v_lshrrev_b32 v8, 23, v7
  v_subrev_u32 v8, 134, v8
  v_max_i32 v8, 0, v8
  v_cvt_u32_f32 v7, v7
  v_lshrrev_b32 v7, v8, v7
  v_lshl_add_u32 v7, v8, 8, v7
  v_lshl_add_u32 v218, v7, 2, s18
  v_subrev_u32 v6, 19, v5
  v_max_i32 v7, 0, v6
  v_cvt_f32_u32 v7, v7
  v_cvt_pk_bf16_f32 v8, v7, v7
  v_and_b32 v7, 0xffff0000, v8
  v_lshrrev_b32 v8, 23, v7
  v_subrev_u32 v8, 134, v8
  v_max_i32 v8, 0, v8
  v_cvt_u32_f32 v7, v7
  v_lshrrev_b32 v7, v8, v7
  v_lshl_add_u32 v7, v8, 8, v7
  v_lshl_add_u32 v219, v7, 2, s18
  v_subrev_u32 v6, 20, v5
  v_max_i32 v7, 0, v6
  v_cvt_f32_u32 v7, v7
  v_cvt_pk_bf16_f32 v8, v7, v7
  v_and_b32 v7, 0xffff0000, v8
  v_lshrrev_b32 v8, 23, v7
  v_subrev_u32 v8, 134, v8
  v_max_i32 v8, 0, v8
  v_cvt_u32_f32 v7, v7
  v_lshrrev_b32 v7, v8, v7
  v_lshl_add_u32 v7, v8, 8, v7
  v_lshl_add_u32 v220, v7, 2, s18
  v_subrev_u32 v6, 21, v5
  v_max_i32 v7, 0, v6
  v_cvt_f32_u32 v7, v7
  v_cvt_pk_bf16_f32 v8, v7, v7
  v_and_b32 v7, 0xffff0000, v8
  v_lshrrev_b32 v8, 23, v7
  v_subrev_u32 v8, 134, v8
  v_max_i32 v8, 0, v8
  v_cvt_u32_f32 v7, v7
  v_lshrrev_b32 v7, v8, v7
  v_lshl_add_u32 v7, v8, 8, v7
  v_lshl_add_u32 v221, v7, 2, s18
  v_subrev_u32 v6, 22, v5
  v_max_i32 v7, 0, v6
  v_cvt_f32_u32 v7, v7
  v_cvt_pk_bf16_f32 v8, v7, v7
  v_and_b32 v7, 0xffff0000, v8
  v_lshrrev_b32 v8, 23, v7
  v_subrev_u32 v8, 134, v8
  v_max_i32 v8, 0, v8
  v_cvt_u32_f32 v7, v7
  v_lshrrev_b32 v7, v8, v7
  v_lshl_add_u32 v7, v8, 8, v7
  v_lshl_add_u32 v222, v7, 2, s18
  v_subrev_u32 v6, 23, v5
  v_max_i32 v7, 0, v6
  v_cvt_f32_u32 v7, v7
  v_cvt_pk_bf16_f32 v8, v7, v7
  v_and_b32 v7, 0xffff0000, v8
  v_lshrrev_b32 v8, 23, v7
  v_subrev_u32 v8, 134, v8
  v_max_i32 v8, 0, v8
  v_cvt_u32_f32 v7, v7
  v_lshrrev_b32 v7, v8, v7
  v_lshl_add_u32 v7, v8, 8, v7
  v_lshl_add_u32 v223, v7, 2, s18
  v_subrev_u32 v6, 24, v5
  v_max_i32 v7, 0, v6
  v_cvt_f32_u32 v7, v7
  v_cvt_pk_bf16_f32 v8, v7, v7
  v_and_b32 v7, 0xffff0000, v8
  v_lshrrev_b32 v8, 23, v7
  v_subrev_u32 v8, 134, v8
  v_max_i32 v8, 0, v8
  v_cvt_u32_f32 v7, v7
  v_lshrrev_b32 v7, v8, v7
  v_lshl_add_u32 v7, v8, 8, v7
  v_lshl_add_u32 v224, v7, 2, s18
  v_subrev_u32 v6, 25, v5
  v_max_i32 v7, 0, v6
  v_cvt_f32_u32 v7, v7
  v_cvt_pk_bf16_f32 v8, v7, v7
  v_and_b32 v7, 0xffff0000, v8
  v_lshrrev_b32 v8, 23, v7
  v_subrev_u32 v8, 134, v8
  v_max_i32 v8, 0, v8
  v_cvt_u32_f32 v7, v7
  v_lshrrev_b32 v7, v8, v7
  v_lshl_add_u32 v7, v8, 8, v7
  v_lshl_add_u32 v225, v7, 2, s18
  v_subrev_u32 v6, 26, v5
  v_max_i32 v7, 0, v6
  v_cvt_f32_u32 v7, v7
  v_cvt_pk_bf16_f32 v8, v7, v7
  v_and_b32 v7, 0xffff0000, v8
  v_lshrrev_b32 v8, 23, v7
  v_subrev_u32 v8, 134, v8
  v_max_i32 v8, 0, v8
  v_cvt_u32_f32 v7, v7
  v_lshrrev_b32 v7, v8, v7
  v_lshl_add_u32 v7, v8, 8, v7
  v_lshl_add_u32 v226, v7, 2, s18
  v_subrev_u32 v6, 27, v5
  v_max_i32 v7, 0, v6
  v_cvt_f32_u32 v7, v7
  v_cvt_pk_bf16_f32 v8, v7, v7
  v_and_b32 v7, 0xffff0000, v8
  v_lshrrev_b32 v8, 23, v7
  v_subrev_u32 v8, 134, v8
  v_max_i32 v8, 0, v8
  v_cvt_u32_f32 v7, v7
  v_lshrrev_b32 v7, v8, v7
  v_lshl_add_u32 v7, v8, 8, v7
  v_lshl_add_u32 v227, v7, 2, s18
  v_subrev_u32 v6, 28, v5
  v_max_i32 v7, 0, v6
  v_cvt_f32_u32 v7, v7
  v_cvt_pk_bf16_f32 v8, v7, v7
  v_and_b32 v7, 0xffff0000, v8
  v_lshrrev_b32 v8, 23, v7
  v_subrev_u32 v8, 134, v8
  v_max_i32 v8, 0, v8
  v_cvt_u32_f32 v7, v7
  v_lshrrev_b32 v7, v8, v7
  v_lshl_add_u32 v7, v8, 8, v7
  v_lshl_add_u32 v228, v7, 2, s18
  v_subrev_u32 v6, 29, v5
  v_max_i32 v7, 0, v6
  v_cvt_f32_u32 v7, v7
  v_cvt_pk_bf16_f32 v8, v7, v7
  v_and_b32 v7, 0xffff0000, v8
  v_lshrrev_b32 v8, 23, v7
  v_subrev_u32 v8, 134, v8
  v_max_i32 v8, 0, v8
  v_cvt_u32_f32 v7, v7
  v_lshrrev_b32 v7, v8, v7
  v_lshl_add_u32 v7, v8, 8, v7
  v_lshl_add_u32 v229, v7, 2, s18
  v_subrev_u32 v6, 30, v5
  v_max_i32 v7, 0, v6
  v_cvt_f32_u32 v7, v7
  v_cvt_pk_bf16_f32 v8, v7, v7
  v_and_b32 v7, 0xffff0000, v8
  v_lshrrev_b32 v8, 23, v7
  v_subrev_u32 v8, 134, v8
  v_max_i32 v8, 0, v8
  v_cvt_u32_f32 v7, v7
  v_lshrrev_b32 v7, v8, v7
  v_lshl_add_u32 v7, v8, 8, v7
  v_lshl_add_u32 v230, v7, 2, s18
  v_subrev_u32 v6, 31, v5
  v_max_i32 v7, 0, v6
  v_cvt_f32_u32 v7, v7
  v_cvt_pk_bf16_f32 v8, v7, v7
  v_and_b32 v7, 0xffff0000, v8
  v_lshrrev_b32 v8, 23, v7
  v_subrev_u32 v8, 134, v8
  v_max_i32 v8, 0, v8
  v_cvt_u32_f32 v7, v7
  v_lshrrev_b32 v7, v8, v7
  v_lshl_add_u32 v7, v8, 8, v7
  v_lshl_add_u32 v231, v7, 2, s18
  v_subrev_u32 v6, 32, v5
  v_max_i32 v7, 0, v6
  v_cvt_f32_u32 v7, v7
  v_cvt_pk_bf16_f32 v8, v7, v7
  v_and_b32 v7, 0xffff0000, v8
  v_lshrrev_b32 v8, 23, v7
  v_subrev_u32 v8, 134, v8
  v_max_i32 v8, 0, v8
  v_cvt_u32_f32 v7, v7
  v_lshrrev_b32 v7, v8, v7
  v_lshl_add_u32 v7, v8, 8, v7
  v_mov_b32 v8, 1280
  v_cmp_gt_i32 vcc, 0, v6
  s_nop 1
  v_cndmask_b32 v7, v7, v8, vcc
  v_lshl_add_u32 v232, v7, 2, s18
  v_mov_b32 v8, 0
  v_mov_b32 v9, 0
  v_lshlrev_b32 v5, 3, v1
  v_add_u32 v5, s17, v5
  ds_write_b64 v5, v[8:9]
  v_and_b32 v6, 15, v1
  v_lshlrev_b32 v6, 3, v6
  v_add_u32 v6, s17, v6
  ds_write_b64 v6, v[8:9] offset:8704
  ds_write_b64 v6, v[8:9] offset:12928
  v_mov_b32 v6, s17
  ds_write_b64 v6, v[8:9] offset:18176
  s_lshl_b32 s19, s3, 2
  s_add_u32 s20, s19, s16
  s_lshl_b32 s21, s3, 3
  v_mul_u32_u24 v5, 3584, v0
  s_add_u32 s22, s21, 0
  buffer_load_dwordx2 v[8:9], v5, s[60:63], s22 offen offset:0
  buffer_load_dwordx2 v[10:11], v5, s[60:63], s22 offen offset:896
  buffer_load_dwordx2 v[12:13], v5, s[60:63], s22 offen offset:1792
  buffer_load_dwordx2 v[14:15], v5, s[60:63], s22 offen offset:2688
  s_add_u32 s22, s21, 917504
  buffer_load_dwordx2 v[16:17], v5, s[60:63], s22 offen offset:0
  buffer_load_dwordx2 v[18:19], v5, s[60:63], s22 offen offset:896
  buffer_load_dwordx2 v[20:21], v5, s[60:63], s22 offen offset:1792
  buffer_load_dwordx2 v[22:23], v5, s[60:63], s22 offen offset:2688
  s_lshl_b32 s22, s20, 9
  v_lshlrev_b32 v6, 3, v1
  buffer_load_dwordx2 v[24:25], v6, s[64:67], s22 offen
  buffer_load_dwordx2 v[26:27], v6, s[68:71], s22 offen
  buffer_load_dwordx2 v[28:29], v6, s[72:75], s22 offen
  buffer_load_dwordx2 v[30:31], v6, s[76:79], s22 offen
  s_lshl_b32 s22, s20, 1
  v_mov_b32 v7, 0
  buffer_load_ushort v32, v7, s[80:83], s22 offen
  buffer_load_ushort v33, v7, s[84:87], s22 offen
  s_mov_b32 s24, 0x05040100
  s_mov_b32 s25, 0x07060302
  s_barrier
  s_waitcnt vmcnt(6)
  v_lshlrev_b32 v6, 3, v0
  v_perm_b32 v34, v10, v8, s24
  v_perm_b32 v35, v14, v12, s24
  v_add_u32 v36, 512, v6
  ds_write_b64 v36, v[34:35]
  v_perm_b32 v34, v10, v8, s25
  v_perm_b32 v35, v14, v12, s25
  v_add_u32 v36, 25088, v6
  ds_write_b64 v36, v[34:35]
  v_perm_b32 v34, v11, v9, s24
  v_perm_b32 v35, v15, v13, s24
  v_add_u32 v36, 49664, v6
  ds_write_b64 v36, v[34:35]
  v_perm_b32 v34, v11, v9, s25
  v_perm_b32 v35, v15, v13, s25
  v_add_u32 v36, 74240, v6
  ds_write_b64 v36, v[34:35]
  v_perm_b32 v34, v18, v16, s24
  v_perm_b32 v35, v22, v20, s24
  v_add_u32 v36, 2560, v6
  ds_write_b64 v36, v[34:35]
  v_perm_b32 v34, v18, v16, s25
  v_perm_b32 v35, v22, v20, s25
  v_add_u32 v36, 27136, v6
  ds_write_b64 v36, v[34:35]
  v_perm_b32 v34, v19, v17, s24
  v_perm_b32 v35, v23, v21, s24
  v_add_u32 v36, 51712, v6
  ds_write_b64 v36, v[34:35]
  v_perm_b32 v34, v19, v17, s25
  v_perm_b32 v35, v23, v21, s25
  v_add_u32 v36, 76288, v6
  ds_write_b64 v36, v[34:35]
  s_waitcnt vmcnt(0)
  s_mov_b32 s26, 1069066811
  s_mov_b32 s27, 1042479491
  v_lshlrev_b32 v32, 16, v32
  v_lshlrev_b32 v33, 16, v33
  v_mul_f32 v32, s26, v32
  v_exp_f32 v32, v32
  s_nop 0
  v_cvt_pk_bf16_f32 v34, v32, v32
  v_and_b32 v32, 0xffff0000, v34
  v_lshlrev_b32 v37, 6, v1
  v_add_u32 v37, s17, v37
  v_lshlrev_b32 v40, 16, v24
  v_lshlrev_b32 v41, 16, v26
  v_lshlrev_b32 v42, 16, v28
  v_lshlrev_b32 v43, 16, v30
  v_mul_f32 v40, s26, v40
  v_exp_f32 v40, v40
  s_nop 0
  v_cvt_pk_bf16_f32 v34, v40, v40
  v_and_b32 v40, 0xffff0000, v34
  v_mul_f32 v40, v40, v32
  v_mul_f32 v40, s26, v40
  v_sub_f32 v40, 0, v40
  v_mul_f32 v41, v41, v32
  v_mul_f32 v41, s27, v41
  v_mul_f32 v42, v42, v32
  v_mul_f32 v43, v43, v32
  v_add_f32 v42, v42, v42
  v_add_f32 v43, v43, v43
  ds_write_b128 v37, v[40:43] offset:18240
  v_and_b32 v40, 0xffff0000, v24
  v_and_b32 v41, 0xffff0000, v26
  v_and_b32 v42, 0xffff0000, v28
  v_and_b32 v43, 0xffff0000, v30
  v_mul_f32 v40, s26, v40
  v_exp_f32 v40, v40
  s_nop 0
  v_cvt_pk_bf16_f32 v34, v40, v40
  v_and_b32 v40, 0xffff0000, v34
  v_mul_f32 v40, v40, v32
  v_mul_f32 v40, s26, v40
  v_sub_f32 v40, 0, v40
  v_mul_f32 v41, v41, v32
  v_mul_f32 v41, s27, v41
  v_mul_f32 v42, v42, v32
  v_mul_f32 v43, v43, v32
  v_add_f32 v42, v42, v42
  v_add_f32 v43, v43, v43
  ds_write_b128 v37, v[40:43] offset:18256
  v_lshlrev_b32 v40, 16, v25
  v_lshlrev_b32 v41, 16, v27
  v_lshlrev_b32 v42, 16, v29
  v_lshlrev_b32 v43, 16, v31
  v_mul_f32 v40, s26, v40
  v_exp_f32 v40, v40
  s_nop 0
  v_cvt_pk_bf16_f32 v34, v40, v40
  v_and_b32 v40, 0xffff0000, v34
  v_mul_f32 v40, v40, v32
  v_mul_f32 v40, s26, v40
  v_sub_f32 v40, 0, v40
  v_mul_f32 v41, v41, v32
  v_mul_f32 v41, s27, v41
  v_mul_f32 v42, v42, v32
  v_mul_f32 v43, v43, v32
  v_add_f32 v42, v42, v42
  v_add_f32 v43, v43, v43
  ds_write_b128 v37, v[40:43] offset:18272
  v_and_b32 v40, 0xffff0000, v25
  v_and_b32 v41, 0xffff0000, v27
  v_and_b32 v42, 0xffff0000, v29
  v_and_b32 v43, 0xffff0000, v31
  v_mul_f32 v40, s26, v40
  v_exp_f32 v40, v40
  s_nop 0
  v_cvt_pk_bf16_f32 v34, v40, v40
  v_and_b32 v40, 0xffff0000, v34
  v_mul_f32 v40, v40, v32
  v_mul_f32 v40, s26, v40
  v_sub_f32 v40, 0, v40
  v_mul_f32 v41, v41, v32
  v_mul_f32 v41, s27, v41
  v_mul_f32 v42, v42, v32
  v_mul_f32 v43, v43, v32
  v_add_f32 v42, v42, v42
  v_add_f32 v43, v43, v43
  ds_write_b128 v37, v[40:43] offset:18288
  v_cvt_f32_u32 v44, v4
  v_lshlrev_b32 v45, 4, v4
  v_cvt_f32_u32 v45, v45
  v_lshlrev_b32 v46, 4, v3
  v_add_u32 v46, s17, v46
  v_mov_b32 v48, 0
  v_mov_b32 v49, 0
  v_mov_b32 v50, 0
  v_mov_b32 v51, 0
  v_mov_b32 v52, 0
  v_mov_b32 v53, 0
  v_mov_b32 v54, 0
  v_mov_b32 v55, 0
  v_mov_b32 v56, 0
  v_mov_b32 v57, 0
  v_mov_b32 v58, 0
  v_mov_b32 v59, 0
  v_mov_b32 v60, 0
  v_mov_b32 v61, 0
  v_mov_b32 v62, 0
  v_mov_b32 v63, 0
  v_mov_b32 v64, 0
  v_mov_b32 v65, 0
  v_mov_b32 v66, 0
  v_mov_b32 v67, 0
  s_mov_b32 s28, 0
  s_waitcnt lgkmcnt(0)
  ds_read_b128 v[68:71], v46 offset:18240
wk_kl:
  s_waitcnt lgkmcnt(0)
  v_mov_b32 v72, v68
  v_mov_b32 v73, v69
  v_mov_b32 v74, v70
  v_mov_b32 v75, v71
  v_add_u32 v46, 64, v46
  ds_read_b128 v[68:71], v46 offset:18240
  v_mul_f32 v80, v72, v45
  v_mul_f32 v81, v73, v45
  v_exp_f32 v80, v80
  v_fract_f32 v81, v81
  v_cos_f32 v76, v81
  v_sin_f32 v77, v81
  v_mul_f32 v76, v76, v80
  v_mul_f32 v77, v77, v80
  v_mul_f32 v80, v72, v44
  v_mul_f32 v81, v73, v44
  v_exp_f32 v80, v80
  v_fract_f32 v81, v81
  v_cos_f32 v78, v81
  v_sin_f32 v79, v81
  v_mul_f32 v78, v78, v80
  v_mul_f32 v79, v79, v80
  v_mul_f32 v82, v74, v76
  v_mul_f32 v83, v74, v77
  v_fma_f32 v82, -v75, v77, v82
  v_fma_f32 v83, -v75, v76, -v83
  v_mul_f32 v86, v76, v76
  v_mul_f32 v87, v76, v77
  v_fma_f32 v86, -v77, v77, v86
  v_add_f32 v87, v87, v87
  v_mfma_f32_16x16x4_f32 v[48:51], v82, v78, v[48:51]
  v_mul_f32 v88, v78, v78
  v_mul_f32 v89, v78, v79
  v_fma_f32 v88, -v79, v79, v88
  v_add_f32 v89, v89, v89
  v_mfma_f32_16x16x4_f32 v[48:51], v83, v79, v[48:51]
  v_mul_f32 v84, v74, v86
  v_mul_f32 v85, v74, v87
  v_fma_f32 v84, -v75, v87, v84
  v_fma_f32 v85, -v75, v86, -v85
  v_mul_f32 v76, v86, v86
  v_mul_f32 v77, v86, v87
  v_fma_f32 v76, -v87, v87, v76
  v_add_f32 v77, v77, v77
  v_mfma_f32_16x16x4_f32 v[52:55], v84, v88, v[52:55]
  v_mul_f32 v78, v88, v88
  v_mul_f32 v79, v88, v89
  v_fma_f32 v78, -v89, v89, v78
  v_add_f32 v79, v79, v79
  v_mfma_f32_16x16x4_f32 v[52:55], v85, v89, v[52:55]
  v_mul_f32 v82, v74, v76
  v_mul_f32 v83, v74, v77
  v_fma_f32 v82, -v75, v77, v82
  v_fma_f32 v83, -v75, v76, -v83
  v_mul_f32 v86, v76, v76
  v_mul_f32 v87, v76, v77
  v_fma_f32 v86, -v77, v77, v86
  v_add_f32 v87, v87, v87
  v_mfma_f32_16x16x4_f32 v[56:59], v82, v78, v[56:59]
  v_mul_f32 v88, v78, v78
  v_mul_f32 v89, v78, v79
  v_fma_f32 v88, -v79, v79, v88
  v_add_f32 v89, v89, v89
  v_mfma_f32_16x16x4_f32 v[56:59], v83, v79, v[56:59]
  v_mul_f32 v84, v74, v86
  v_mul_f32 v85, v74, v87
  v_fma_f32 v84, -v75, v87, v84
  v_fma_f32 v85, -v75, v86, -v85
  v_mul_f32 v76, v86, v86
  v_mul_f32 v77, v86, v87
  v_fma_f32 v76, -v87, v87, v76
  v_add_f32 v77, v77, v77
  v_mfma_f32_16x16x4_f32 v[60:63], v84, v88, v[60:63]
  v_mfma_f32_16x16x4_f32 v[60:63], v85, v89, v[60:63]
  v_mul_f32 v82, v74, v76
  v_fma_f32 v82, -v75, v77, v82
  s_nop 1
  v_mfma_f32_16x16x4_f32 v[64:67], v82, v88, v[64:67]
  s_add_u32 s28, s28, 1
  s_cmp_lt_u32 s28, 64
  s_cbranch_scc1 wk_kl
  s_nop 15
  s_nop 3
  v_lshlrev_b32 v46, 8, v3
  v_lshl_add_u32 v46, v4, 2, v46
  v_add_u32 v46, s17, v46
  ds_write_b32 v46, v48 offset:13056
  ds_write_b32 v46, v49 offset:13120
  ds_write_b32 v46, v50 offset:13184
  ds_write_b32 v46, v51 offset:13248
  s_waitcnt lgkmcnt(8)
  ds_write_b32 v46, v52 offset:14080
  ds_write_b32 v46, v53 offset:14144
  ds_write_b32 v46, v54 offset:14208
  ds_write_b32 v46, v55 offset:14272
  s_waitcnt lgkmcnt(8)
  ds_write_b32 v46, v56 offset:15104
  ds_write_b32 v46, v57 offset:15168
  ds_write_b32 v46, v58 offset:15232
  ds_write_b32 v46, v59 offset:15296
  s_waitcnt lgkmcnt(8)
  ds_write_b32 v46, v60 offset:16128
  ds_write_b32 v46, v61 offset:16192
  ds_write_b32 v46, v62 offset:16256
  ds_write_b32 v46, v63 offset:16320
  s_waitcnt lgkmcnt(8)
  ds_write_b32 v46, v64 offset:17152
  ds_write_b32 v46, v65 offset:17216
  ds_write_b32 v46, v66 offset:17280
  ds_write_b32 v46, v67 offset:17344
  s_waitcnt lgkmcnt(8)
  s_waitcnt lgkmcnt(0)
  ds_read_b32 v48, v200
  ds_read_b32 v49, v201
  ds_read_b32 v50, v202
  ds_read_b32 v51, v203
  ds_read_b32 v52, v204
  ds_read_b32 v53, v205
  ds_read_b32 v54, v206
  ds_read_b32 v55, v207
  s_waitcnt lgkmcnt(4)
  ds_read_b32 v56, v208
  ds_read_b32 v57, v209
  ds_read_b32 v58, v210
  ds_read_b32 v59, v211
  ds_read_b32 v60, v212
  ds_read_b32 v61, v213
  ds_read_b32 v62, v214
  ds_read_b32 v63, v215
  s_waitcnt lgkmcnt(4)
  ds_read_b32 v64, v216
  ds_read_b32 v65, v217
  ds_read_b32 v66, v218
  ds_read_b32 v67, v219
  ds_read_b32 v68, v220
  ds_read_b32 v69, v221
  ds_read_b32 v70, v222
  ds_read_b32 v71, v223
  s_waitcnt lgkmcnt(4)
  ds_read_b32 v72, v224
  ds_read_b32 v73, v225
  ds_read_b32 v74, v226
  ds_read_b32 v75, v227
  ds_read_b32 v76, v228
  ds_read_b32 v77, v229
  ds_read_b32 v78, v230
  ds_read_b32 v79, v231
  s_waitcnt lgkmcnt(4)
  ds_read_b32 v80, v232
  s_waitcnt lgkmcnt(0)
  v_lshlrev_b32 v46, 6, v1
  v_add_u32 v46, s17, v46
  v_cvt_pk_bf16_f32 v84, v48, v49
  v_cvt_pk_bf16_f32 v88, v49, v50
  v_cvt_pk_bf16_f32 v85, v50, v51
  v_cvt_pk_bf16_f32 v89, v51, v52
  v_cvt_pk_bf16_f32 v86, v52, v53
  v_cvt_pk_bf16_f32 v90, v53, v54
  v_cvt_pk_bf16_f32 v87, v54, v55
  v_cvt_pk_bf16_f32 v91, v55, v56
  ds_write_b128 v46, v[84:87] offset:4608
  ds_write_b128 v46, v[88:91] offset:8832
  s_waitcnt lgkmcnt(0)
  v_cvt_pk_bf16_f32 v84, v56, v57
  v_cvt_pk_bf16_f32 v88, v57, v58
  v_cvt_pk_bf16_f32 v85, v58, v59
  v_cvt_pk_bf16_f32 v89, v59, v60
  v_cvt_pk_bf16_f32 v86, v60, v61
  v_cvt_pk_bf16_f32 v90, v61, v62
  v_cvt_pk_bf16_f32 v87, v62, v63
  v_cvt_pk_bf16_f32 v91, v63, v64
  ds_write_b128 v46, v[84:87] offset:4624
  ds_write_b128 v46, v[88:91] offset:8848
  s_waitcnt lgkmcnt(0)
  v_cvt_pk_bf16_f32 v84, v64, v65
  v_cvt_pk_bf16_f32 v88, v65, v66
  v_cvt_pk_bf16_f32 v85, v66, v67
  v_cvt_pk_bf16_f32 v89, v67, v68
  v_cvt_pk_bf16_f32 v86, v68, v69
  v_cvt_pk_bf16_f32 v90, v69, v70
  v_cvt_pk_bf16_f32 v87, v70, v71
  v_cvt_pk_bf16_f32 v91, v71, v72
  ds_write_b128 v46, v[84:87] offset:4640
  ds_write_b128 v46, v[88:91] offset:8864
  s_waitcnt lgkmcnt(0)
  v_cvt_pk_bf16_f32 v84, v72, v73
  v_cvt_pk_bf16_f32 v88, v73, v74
  v_cvt_pk_bf16_f32 v85, v74, v75
  v_cvt_pk_bf16_f32 v89, v75, v76
  v_cvt_pk_bf16_f32 v86, v76, v77
  v_cvt_pk_bf16_f32 v90, v77, v78
  v_cvt_pk_bf16_f32 v87, v78, v79
  v_cvt_pk_bf16_f32 v91, v79, v80
  ds_write_b128 v46, v[84:87] offset:4656
  ds_write_b128 v46, v[88:91] offset:8880
  s_waitcnt lgkmcnt(0)
  s_barrier
  v_lshrrev_b32 v47, 1, v3
  v_sub_u32 v46, v4, v47
  v_add_u32 v46, 1, v46
  v_lshlrev_b32 v46, 5, v46
  v_and_b32 v48, 1, v3
  v_lshl_add_u32 v46, v48, 4, v46
  v_add_u32 v46, s17, v46
  ds_read_b128 a[0:3], v46 offset:32
  ds_read_b128 a[4:7], v46 offset:96
  ds_read_b128 a[8:11], v46 offset:160
  ds_read_b128 a[12:15], v46 offset:224
  ds_read_b128 a[16:19], v46 offset:288
  ds_read_b128 a[20:23], v46 offset:352
  ds_read_b128 a[24:27], v46 offset:416
  ds_read_b128 a[28:31], v46 offset:480
  s_waitcnt lgkmcnt(4)
  ds_read_b128 a[32:35], v46 offset:544
  ds_read_b128 a[36:39], v46 offset:608
  ds_read_b128 a[40:43], v46 offset:672
  ds_read_b128 a[44:47], v46 offset:736
  ds_read_b128 a[48:51], v46 offset:800
  ds_read_b128 a[52:55], v46 offset:864
  ds_read_b128 a[56:59], v46 offset:928
  ds_read_b128 a[60:63], v46 offset:992
  s_waitcnt lgkmcnt(4)
  ds_read_b128 a[64:67], v46 offset:1056
  ds_read_b128 a[68:71], v46 offset:1120
  ds_read_b128 a[72:75], v46 offset:1184
  ds_read_b128 a[76:79], v46 offset:1248
  ds_read_b128 a[80:83], v46 offset:1312
  ds_read_b128 a[84:87], v46 offset:1376
  ds_read_b128 a[88:91], v46 offset:1440
  ds_read_b128 a[92:95], v46 offset:1504
  s_waitcnt lgkmcnt(4)
  ds_read_b128 a[96:99], v46 offset:1568
  ds_read_b128 a[100:103], v46 offset:1632
  ds_read_b128 a[104:107], v46 offset:1696
  ds_read_b128 a[108:111], v46 offset:1760
  ds_read_b128 a[112:115], v46 offset:1824
  ds_read_b128 a[116:119], v46 offset:1888
  ds_read_b128 a[120:123], v46 offset:1952
  ds_read_b128 a[124:127], v46 offset:2016
  s_waitcnt lgkmcnt(4)
  ds_read_b128 a[128:131], v46 offset:2080
  ds_read_b128 a[132:135], v46 offset:2144
  ds_read_b128 a[136:139], v46 offset:2208
  ds_read_b128 a[140:143], v46 offset:2272
  ds_read_b128 a[144:147], v46 offset:2336
  ds_read_b128 a[148:151], v46 offset:2400
  ds_read_b128 a[152:155], v46 offset:2464
  ds_read_b128 a[156:159], v46 offset:2528
  s_waitcnt lgkmcnt(4)
  ds_read_b128 a[160:163], v46 offset:2592
  ds_read_b128 a[164:167], v46 offset:2656
  ds_read_b128 a[168:171], v46 offset:2720
  ds_read_b128 a[172:175], v46 offset:2784
  ds_read_b128 a[176:179], v46 offset:2848
  ds_read_b128 a[180:183], v46 offset:2912
  ds_read_b128 a[184:187], v46 offset:2976
  ds_read_b128 a[188:191], v46 offset:3040
  s_waitcnt lgkmcnt(4)
  ds_read_b128 a[192:195], v46 offset:3104
  ds_read_b128 a[196:199], v46 offset:3168
  ds_read_b128 a[200:203], v46 offset:3232
  ds_read_b128 a[204:207], v46 offset:3296
  ds_read_b128 a[208:211], v46 offset:3360
  ds_read_b128 a[212:215], v46 offset:3424
  ds_read_b128 a[216:219], v46 offset:3488
  ds_read_b128 a[220:223], v46 offset:3552
  s_waitcnt lgkmcnt(4)
  ds_read_b128 a[224:227], v46 offset:3616
  ds_read_b128 a[228:231], v46 offset:3680
  ds_read_b128 a[232:235], v46 offset:3744
  ds_read_b128 a[236:239], v46 offset:3808
  ds_read_b128 a[240:243], v46 offset:3872
  ds_read_b128 a[244:247], v46 offset:3936
  ds_read_b128 a[248:251], v46 offset:4000
  ds_read_b128 a[252:255], v46 offset:4064
  s_waitcnt lgkmcnt(4)
  v_lshlrev_b32 v49, 4, v47
  v_add_u32 v49, v49, v4
  v_sub_u32 v49, 2047, v49
  v_lshl_add_u32 v49, v48, 3, v49
  v_and_b32 v50, 1, v49
  v_lshrrev_b32 v49, 1, v49
  v_lshlrev_b32 v49, 2, v49
  v_mul_u32_u24 v50, 4224, v50
  v_add3_u32 v49, v49, v50, s17
  v_add_u32 v49, 4608, v49
  v_subrev_u32 v52, 896, v49
  v_subrev_u32 v53, 1856, v49
  v_subrev_u32 v54, 2816, v49
  v_subrev_u32 v55, 3776, v49
  v_subrev_u32 v56, 4736, v49
  s_waitcnt lgkmcnt(0)
  ds_read2_b32 v[92:93], v52 offset0:224 offset1:225
  ds_read2_b32 v[94:95], v52 offset0:226 offset1:227
  ds_read2_b32 v[96:97], v52 offset0:208 offset1:209
  ds_read2_b32 v[98:99], v52 offset0:210 offset1:211
  ds_read2_b32 v[100:101], v52 offset0:192 offset1:193
  ds_read2_b32 v[102:103], v52 offset0:194 offset1:195
  ds_read2_b32 v[104:105], v52 offset0:176 offset1:177
  ds_read2_b32 v[106:107], v52 offset0:178 offset1:179
  s_waitcnt lgkmcnt(6)
  v_mfma_f32_16x16x32_bf16 v[60:63], v[92:95], a[28:31], 0
  v_mfma_f32_16x16x32_bf16 v[64:67], v[92:95], a[60:63], 0
  v_mfma_f32_16x16x32_bf16 v[68:71], v[92:95], a[92:95], 0
  v_mfma_f32_16x16x32_bf16 v[72:75], v[92:95], a[124:127], 0
  v_mfma_f32_16x16x32_bf16 v[76:79], v[92:95], a[156:159], 0
  v_mfma_f32_16x16x32_bf16 v[80:83], v[92:95], a[188:191], 0
  v_mfma_f32_16x16x32_bf16 v[84:87], v[92:95], a[220:223], 0
  v_mfma_f32_16x16x32_bf16 v[88:91], v[92:95], a[252:255], 0
  ds_read2_b32 v[92:93], v52 offset0:160 offset1:161
  ds_read2_b32 v[94:95], v52 offset0:162 offset1:163
  s_waitcnt lgkmcnt(6)
  v_mfma_f32_16x16x32_bf16 v[60:63], v[96:99], a[24:27], v[60:63]
  v_mfma_f32_16x16x32_bf16 v[64:67], v[96:99], a[56:59], v[64:67]
  v_mfma_f32_16x16x32_bf16 v[68:71], v[96:99], a[88:91], v[68:71]
  v_mfma_f32_16x16x32_bf16 v[72:75], v[96:99], a[120:123], v[72:75]
  v_mfma_f32_16x16x32_bf16 v[76:79], v[96:99], a[152:155], v[76:79]
  v_mfma_f32_16x16x32_bf16 v[80:83], v[96:99], a[184:187], v[80:83]
  v_mfma_f32_16x16x32_bf16 v[84:87], v[96:99], a[216:219], v[84:87]
  v_mfma_f32_16x16x32_bf16 v[88:91], v[96:99], a[248:251], v[88:91]
  ds_read2_b32 v[96:97], v52 offset0:144 offset1:145
  ds_read2_b32 v[98:99], v52 offset0:146 offset1:147
  s_waitcnt lgkmcnt(6)
  v_mfma_f32_16x16x32_bf16 v[60:63], v[100:103], a[20:23], v[60:63]
  v_mfma_f32_16x16x32_bf16 v[64:67], v[100:103], a[52:55], v[64:67]
  v_mfma_f32_16x16x32_bf16 v[68:71], v[100:103], a[84:87], v[68:71]
  v_mfma_f32_16x16x32_bf16 v[72:75], v[100:103], a[116:119], v[72:75]
  v_mfma_f32_16x16x32_bf16 v[76:79], v[100:103], a[148:151], v[76:79]
  v_mfma_f32_16x16x32_bf16 v[80:83], v[100:103], a[180:183], v[80:83]
  v_mfma_f32_16x16x32_bf16 v[84:87], v[100:103], a[212:215], v[84:87]
  v_mfma_f32_16x16x32_bf16 v[88:91], v[100:103], a[244:247], v[88:91]
  ds_read2_b32 v[100:101], v52 offset0:128 offset1:129
  ds_read2_b32 v[102:103], v52 offset0:130 offset1:131
  s_waitcnt lgkmcnt(6)
  v_mfma_f32_16x16x32_bf16 v[60:63], v[104:107], a[16:19], v[60:63]
  v_mfma_f32_16x16x32_bf16 v[64:67], v[104:107], a[48:51], v[64:67]
  v_mfma_f32_16x16x32_bf16 v[68:71], v[104:107], a[80:83], v[68:71]
  v_mfma_f32_16x16x32_bf16 v[72:75], v[104:107], a[112:115], v[72:75]
  v_mfma_f32_16x16x32_bf16 v[76:79], v[104:107], a[144:147], v[76:79]
  v_mfma_f32_16x16x32_bf16 v[80:83], v[104:107], a[176:179], v[80:83]
  v_mfma_f32_16x16x32_bf16 v[84:87], v[104:107], a[208:211], v[84:87]
  v_mfma_f32_16x16x32_bf16 v[88:91], v[104:107], a[240:243], v[88:91]
  ds_read2_b32 v[104:105], v52 offset0:112 offset1:113
  ds_read2_b32 v[106:107], v52 offset0:114 offset1:115
  s_waitcnt lgkmcnt(6)
  v_mfma_f32_16x16x32_bf16 v[60:63], v[92:95], a[12:15], v[60:63]
  v_mfma_f32_16x16x32_bf16 v[64:67], v[92:95], a[44:47], v[64:67]
  v_mfma_f32_16x16x32_bf16 v[68:71], v[92:95], a[76:79], v[68:71]
  v_mfma_f32_16x16x32_bf16 v[72:75], v[92:95], a[108:111], v[72:75]
  v_mfma_f32_16x16x32_bf16 v[76:79], v[92:95], a[140:143], v[76:79]
  v_mfma_f32_16x16x32_bf16 v[80:83], v[92:95], a[172:175], v[80:83]
  v_mfma_f32_16x16x32_bf16 v[84:87], v[92:95], a[204:207], v[84:87]
  v_mfma_f32_16x16x32_bf16 v[88:91], v[92:95], a[236:239], v[88:91]
  ds_read2_b32 v[92:93], v52 offset0:96 offset1:97
  ds_read2_b32 v[94:95], v52 offset0:98 offset1:99
  s_waitcnt lgkmcnt(6)
  v_mfma_f32_16x16x32_bf16 v[60:63], v[96:99], a[8:11], v[60:63]
  v_mfma_f32_16x16x32_bf16 v[64:67], v[96:99], a[40:43], v[64:67]
  v_mfma_f32_16x16x32_bf16 v[68:71], v[96:99], a[72:75], v[68:71]
  v_mfma_f32_16x16x32_bf16 v[72:75], v[96:99], a[104:107], v[72:75]
  v_mfma_f32_16x16x32_bf16 v[76:79], v[96:99], a[136:139], v[76:79]
  v_mfma_f32_16x16x32_bf16 v[80:83], v[96:99], a[168:171], v[80:83]
  v_mfma_f32_16x16x32_bf16 v[84:87], v[96:99], a[200:203], v[84:87]
  v_mfma_f32_16x16x32_bf16 v[88:91], v[96:99], a[232:235], v[88:91]
  ds_read2_b32 v[96:97], v52 offset0:80 offset1:81
  ds_read2_b32 v[98:99], v52 offset0:82 offset1:83
  s_waitcnt lgkmcnt(6)
  v_mfma_f32_16x16x32_bf16 v[60:63], v[100:103], a[4:7], v[60:63]
  v_mfma_f32_16x16x32_bf16 v[64:67], v[100:103], a[36:39], v[64:67]
  v_mfma_f32_16x16x32_bf16 v[68:71], v[100:103], a[68:71], v[68:71]
  v_mfma_f32_16x16x32_bf16 v[72:75], v[100:103], a[100:103], v[72:75]
  v_mfma_f32_16x16x32_bf16 v[76:79], v[100:103], a[132:135], v[76:79]
  v_mfma_f32_16x16x32_bf16 v[80:83], v[100:103], a[164:167], v[80:83]
  v_mfma_f32_16x16x32_bf16 v[84:87], v[100:103], a[196:199], v[84:87]
  v_mfma_f32_16x16x32_bf16 v[88:91], v[100:103], a[228:231], v[88:91]
  ds_read2_b32 v[100:101], v52 offset0:64 offset1:65
  ds_read2_b32 v[102:103], v52 offset0:66 offset1:67
  s_waitcnt lgkmcnt(6)
  v_mfma_f32_16x16x32_bf16 v[60:63], v[104:107], a[0:3], v[60:63]
  v_mfma_f32_16x16x32_bf16 v[64:67], v[104:107], a[32:35], v[64:67]
  v_mfma_f32_16x16x32_bf16 v[68:71], v[104:107], a[64:67], v[68:71]
  v_mfma_f32_16x16x32_bf16 v[72:75], v[104:107], a[96:99], v[72:75]
  v_mfma_f32_16x16x32_bf16 v[76:79], v[104:107], a[128:131], v[76:79]
  v_mfma_f32_16x16x32_bf16 v[80:83], v[104:107], a[160:163], v[80:83]
  v_mfma_f32_16x16x32_bf16 v[84:87], v[104:107], a[192:195], v[84:87]
  v_mfma_f32_16x16x32_bf16 v[88:91], v[104:107], a[224:227], v[88:91]
  ds_read2_b32 v[104:105], v52 offset0:48 offset1:49
  ds_read2_b32 v[106:107], v52 offset0:50 offset1:51
  s_waitcnt lgkmcnt(6)
  v_mfma_f32_16x16x32_bf16 v[64:67], v[92:95], a[28:31], v[64:67]
  v_mfma_f32_16x16x32_bf16 v[68:71], v[92:95], a[60:63], v[68:71]
  v_mfma_f32_16x16x32_bf16 v[72:75], v[92:95], a[92:95], v[72:75]
  v_mfma_f32_16x16x32_bf16 v[76:79], v[92:95], a[124:127], v[76:79]
  v_mfma_f32_16x16x32_bf16 v[80:83], v[92:95], a[156:159], v[80:83]
  v_mfma_f32_16x16x32_bf16 v[84:87], v[92:95], a[188:191], v[84:87]
  v_mfma_f32_16x16x32_bf16 v[88:91], v[92:95], a[220:223], v[88:91]
  ds_read2_b32 v[92:93], v52 offset0:32 offset1:33
  ds_read2_b32 v[94:95], v52 offset0:34 offset1:35
  s_waitcnt lgkmcnt(6)
  v_mfma_f32_16x16x32_bf16 v[64:67], v[96:99], a[24:27], v[64:67]
  v_mfma_f32_16x16x32_bf16 v[68:71], v[96:99], a[56:59], v[68:71]
  v_mfma_f32_16x16x32_bf16 v[72:75], v[96:99], a[88:91], v[72:75]
  v_mfma_f32_16x16x32_bf16 v[76:79], v[96:99], a[120:123], v[76:79]
  v_mfma_f32_16x16x32_bf16 v[80:83], v[96:99], a[152:155], v[80:83]
  v_mfma_f32_16x16x32_bf16 v[84:87], v[96:99], a[184:187], v[84:87]
  v_mfma_f32_16x16x32_bf16 v[88:91], v[96:99], a[216:219], v[88:91]
  ds_read2_b32 v[96:97], v52 offset0:16 offset1:17
  ds_read2_b32 v[98:99], v52 offset0:18 offset1:19
  s_waitcnt lgkmcnt(6)
  v_mfma_f32_16x16x32_bf16 v[64:67], v[100:103], a[20:23], v[64:67]
  v_mfma_f32_16x16x32_bf16 v[68:71], v[100:103], a[52:55], v[68:71]
  v_mfma_f32_16x16x32_bf16 v[72:75], v[100:103], a[84:87], v[72:75]
  v_mfma_f32_16x16x32_bf16 v[76:79], v[100:103], a[116:119], v[76:79]
  v_mfma_f32_16x16x32_bf16 v[80:83], v[100:103], a[148:151], v[80:83]
  v_mfma_f32_16x16x32_bf16 v[84:87], v[100:103], a[180:183], v[84:87]
  v_mfma_f32_16x16x32_bf16 v[88:91], v[100:103], a[212:215], v[88:91]
  ds_read2_b32 v[100:101], v52 offset0:0 offset1:1
  ds_read2_b32 v[102:103], v52 offset0:2 offset1:3
  s_waitcnt lgkmcnt(6)
  v_mfma_f32_16x16x32_bf16 v[64:67], v[104:107], a[16:19], v[64:67]
  v_mfma_f32_16x16x32_bf16 v[68:71], v[104:107], a[48:51], v[68:71]
  v_mfma_f32_16x16x32_bf16 v[72:75], v[104:107], a[80:83], v[72:75]
  v_mfma_f32_16x16x32_bf16 v[76:79], v[104:107], a[112:115], v[76:79]
  v_mfma_f32_16x16x32_bf16 v[80:83], v[104:107], a[144:147], v[80:83]
  v_mfma_f32_16x16x32_bf16 v[84:87], v[104:107], a[176:179], v[84:87]
  v_mfma_f32_16x16x32_bf16 v[88:91], v[104:107], a[208:211], v[88:91]
  ds_read2_b32 v[104:105], v53 offset0:224 offset1:225
  ds_read2_b32 v[106:107], v53 offset0:226 offset1:227
  s_waitcnt lgkmcnt(6)
  v_mfma_f32_16x16x32_bf16 v[64:67], v[92:95], a[12:15], v[64:67]
  v_mfma_f32_16x16x32_bf16 v[68:71], v[92:95], a[44:47], v[68:71]
  v_mfma_f32_16x16x32_bf16 v[72:75], v[92:95], a[76:79], v[72:75]
  v_mfma_f32_16x16x32_bf16 v[76:79], v[92:95], a[108:111], v[76:79]
  v_mfma_f32_16x16x32_bf16 v[80:83], v[92:95], a[140:143], v[80:83]
  v_mfma_f32_16x16x32_bf16 v[84:87], v[92:95], a[172:175], v[84:87]
  v_mfma_f32_16x16x32_bf16 v[88:91], v[92:95], a[204:207], v[88:91]
  ds_read2_b32 v[92:93], v53 offset0:208 offset1:209
  ds_read2_b32 v[94:95], v53 offset0:210 offset1:211
  s_waitcnt lgkmcnt(6)
  v_mfma_f32_16x16x32_bf16 v[64:67], v[96:99], a[8:11], v[64:67]
  v_mfma_f32_16x16x32_bf16 v[68:71], v[96:99], a[40:43], v[68:71]
  v_mfma_f32_16x16x32_bf16 v[72:75], v[96:99], a[72:75], v[72:75]
  v_mfma_f32_16x16x32_bf16 v[76:79], v[96:99], a[104:107], v[76:79]
  v_mfma_f32_16x16x32_bf16 v[80:83], v[96:99], a[136:139], v[80:83]
  v_mfma_f32_16x16x32_bf16 v[84:87], v[96:99], a[168:171], v[84:87]
  v_mfma_f32_16x16x32_bf16 v[88:91], v[96:99], a[200:203], v[88:91]
  ds_read2_b32 v[96:97], v53 offset0:192 offset1:193
  ds_read2_b32 v[98:99], v53 offset0:194 offset1:195
  s_waitcnt lgkmcnt(6)
  v_mfma_f32_16x16x32_bf16 v[64:67], v[100:103], a[4:7], v[64:67]
  v_mfma_f32_16x16x32_bf16 v[68:71], v[100:103], a[36:39], v[68:71]
  v_mfma_f32_16x16x32_bf16 v[72:75], v[100:103], a[68:71], v[72:75]
  v_mfma_f32_16x16x32_bf16 v[76:79], v[100:103], a[100:103], v[76:79]
  v_mfma_f32_16x16x32_bf16 v[80:83], v[100:103], a[132:135], v[80:83]
  v_mfma_f32_16x16x32_bf16 v[84:87], v[100:103], a[164:167], v[84:87]
  v_mfma_f32_16x16x32_bf16 v[88:91], v[100:103], a[196:199], v[88:91]
  ds_read2_b32 v[100:101], v53 offset0:176 offset1:177
  ds_read2_b32 v[102:103], v53 offset0:178 offset1:179
  s_waitcnt lgkmcnt(6)
  v_mfma_f32_16x16x32_bf16 v[64:67], v[104:107], a[0:3], v[64:67]
  v_mfma_f32_16x16x32_bf16 v[68:71], v[104:107], a[32:35], v[68:71]
  v_mfma_f32_16x16x32_bf16 v[72:75], v[104:107], a[64:67], v[72:75]
  v_mfma_f32_16x16x32_bf16 v[76:79], v[104:107], a[96:99], v[76:79]
  v_mfma_f32_16x16x32_bf16 v[80:83], v[104:107], a[128:131], v[80:83]
  v_mfma_f32_16x16x32_bf16 v[84:87], v[104:107], a[160:163], v[84:87]
  v_mfma_f32_16x16x32_bf16 v[88:91], v[104:107], a[192:195], v[88:91]
  ds_read2_b32 v[104:105], v53 offset0:160 offset1:161
  ds_read2_b32 v[106:107], v53 offset0:162 offset1:163
  s_waitcnt lgkmcnt(6)
  v_mfma_f32_16x16x32_bf16 v[68:71], v[92:95], a[28:31], v[68:71]
  v_mfma_f32_16x16x32_bf16 v[72:75], v[92:95], a[60:63], v[72:75]
  v_mfma_f32_16x16x32_bf16 v[76:79], v[92:95], a[92:95], v[76:79]
  v_mfma_f32_16x16x32_bf16 v[80:83], v[92:95], a[124:127], v[80:83]
  v_mfma_f32_16x16x32_bf16 v[84:87], v[92:95], a[156:159], v[84:87]
  v_mfma_f32_16x16x32_bf16 v[88:91], v[92:95], a[188:191], v[88:91]
  ds_read2_b32 v[92:93], v53 offset0:144 offset1:145
  ds_read2_b32 v[94:95], v53 offset0:146 offset1:147
  s_waitcnt lgkmcnt(6)
  v_mfma_f32_16x16x32_bf16 v[68:71], v[96:99], a[24:27], v[68:71]
  v_mfma_f32_16x16x32_bf16 v[72:75], v[96:99], a[56:59], v[72:75]
  v_mfma_f32_16x16x32_bf16 v[76:79], v[96:99], a[88:91], v[76:79]
  v_mfma_f32_16x16x32_bf16 v[80:83], v[96:99], a[120:123], v[80:83]
  v_mfma_f32_16x16x32_bf16 v[84:87], v[96:99], a[152:155], v[84:87]
  v_mfma_f32_16x16x32_bf16 v[88:91], v[96:99], a[184:187], v[88:91]
  ds_read2_b32 v[96:97], v53 offset0:128 offset1:129
  ds_read2_b32 v[98:99], v53 offset0:130 offset1:131
  s_waitcnt lgkmcnt(6)
  v_mfma_f32_16x16x32_bf16 v[68:71], v[100:103], a[20:23], v[68:71]
  v_mfma_f32_16x16x32_bf16 v[72:75], v[100:103], a[52:55], v[72:75]
  v_mfma_f32_16x16x32_bf16 v[76:79], v[100:103], a[84:87], v[76:79]
  v_mfma_f32_16x16x32_bf16 v[80:83], v[100:103], a[116:119], v[80:83]
  v_mfma_f32_16x16x32_bf16 v[84:87], v[100:103], a[148:151], v[84:87]
  v_mfma_f32_16x16x32_bf16 v[88:91], v[100:103], a[180:183], v[88:91]
  ds_read2_b32 v[100:101], v53 offset0:112 offset1:113
  ds_read2_b32 v[102:103], v53 offset0:114 offset1:115
  s_waitcnt lgkmcnt(6)
  v_mfma_f32_16x16x32_bf16 v[68:71], v[104:107], a[16:19], v[68:71]
  v_mfma_f32_16x16x32_bf16 v[72:75], v[104:107], a[48:51], v[72:75]
  v_mfma_f32_16x16x32_bf16 v[76:79], v[104:107], a[80:83], v[76:79]
  v_mfma_f32_16x16x32_bf16 v[80:83], v[104:107], a[112:115], v[80:83]
  v_mfma_f32_16x16x32_bf16 v[84:87], v[104:107], a[144:147], v[84:87]
  v_mfma_f32_16x16x32_bf16 v[88:91], v[104:107], a[176:179], v[88:91]
  ds_read2_b32 v[104:105], v53 offset0:96 offset1:97
  ds_read2_b32 v[106:107], v53 offset0:98 offset1:99
  s_waitcnt lgkmcnt(6)
  v_mfma_f32_16x16x32_bf16 v[68:71], v[92:95], a[12:15], v[68:71]
  v_mfma_f32_16x16x32_bf16 v[72:75], v[92:95], a[44:47], v[72:75]
  v_mfma_f32_16x16x32_bf16 v[76:79], v[92:95], a[76:79], v[76:79]
  v_mfma_f32_16x16x32_bf16 v[80:83], v[92:95], a[108:111], v[80:83]
  v_mfma_f32_16x16x32_bf16 v[84:87], v[92:95], a[140:143], v[84:87]
  v_mfma_f32_16x16x32_bf16 v[88:91], v[92:95], a[172:175], v[88:91]
  ds_read2_b32 v[92:93], v53 offset0:80 offset1:81
  ds_read2_b32 v[94:95], v53 offset0:82 offset1:83
  s_waitcnt lgkmcnt(6)
  v_mfma_f32_16x16x32_bf16 v[68:71], v[96:99], a[8:11], v[68:71]
  v_mfma_f32_16x16x32_bf16 v[72:75], v[96:99], a[40:43], v[72:75]
  v_mfma_f32_16x16x32_bf16 v[76:79], v[96:99], a[72:75], v[76:79]
  v_mfma_f32_16x16x32_bf16 v[80:83], v[96:99], a[104:107], v[80:83]
  v_mfma_f32_16x16x32_bf16 v[84:87], v[96:99], a[136:139], v[84:87]
  v_mfma_f32_16x16x32_bf16 v[88:91], v[96:99], a[168:171], v[88:91]
  ds_read2_b32 v[96:97], v53 offset0:64 offset1:65
  ds_read2_b32 v[98:99], v53 offset0:66 offset1:67
  s_waitcnt lgkmcnt(6)
  v_mfma_f32_16x16x32_bf16 v[68:71], v[100:103], a[4:7], v[68:71]
  v_mfma_f32_16x16x32_bf16 v[72:75], v[100:103], a[36:39], v[72:75]
  v_mfma_f32_16x16x32_bf16 v[76:79], v[100:103], a[68:71], v[76:79]
  v_mfma_f32_16x16x32_bf16 v[80:83], v[100:103], a[100:103], v[80:83]
  v_mfma_f32_16x16x32_bf16 v[84:87], v[100:103], a[132:135], v[84:87]
  v_mfma_f32_16x16x32_bf16 v[88:91], v[100:103], a[164:167], v[88:91]
  ds_read2_b32 v[100:101], v53 offset0:48 offset1:49
  ds_read2_b32 v[102:103], v53 offset0:50 offset1:51
  s_waitcnt lgkmcnt(6)
  v_mfma_f32_16x16x32_bf16 v[68:71], v[104:107], a[0:3], v[68:71]
  v_mfma_f32_16x16x32_bf16 v[72:75], v[104:107], a[32:35], v[72:75]
  v_mfma_f32_16x16x32_bf16 v[76:79], v[104:107], a[64:67], v[76:79]
  v_mfma_f32_16x16x32_bf16 v[80:83], v[104:107], a[96:99], v[80:83]
  v_mfma_f32_16x16x32_bf16 v[84:87], v[104:107], a[128:131], v[84:87]
  v_mfma_f32_16x16x32_bf16 v[88:91], v[104:107], a[160:163], v[88:91]
  ds_read2_b32 v[104:105], v53 offset0:32 offset1:33
  ds_read2_b32 v[106:107], v53 offset0:34 offset1:35
  s_waitcnt lgkmcnt(6)
  v_mfma_f32_16x16x32_bf16 v[72:75], v[92:95], a[28:31], v[72:75]
  v_mfma_f32_16x16x32_bf16 v[76:79], v[92:95], a[60:63], v[76:79]
  v_mfma_f32_16x16x32_bf16 v[80:83], v[92:95], a[92:95], v[80:83]
  v_mfma_f32_16x16x32_bf16 v[84:87], v[92:95], a[124:127], v[84:87]
  v_mfma_f32_16x16x32_bf16 v[88:91], v[92:95], a[156:159], v[88:91]
  ds_read2_b32 v[92:93], v53 offset0:16 offset1:17
  ds_read2_b32 v[94:95], v53 offset0:18 offset1:19
  s_waitcnt lgkmcnt(6)
  v_mfma_f32_16x16x32_bf16 v[72:75], v[96:99], a[24:27], v[72:75]
  v_mfma_f32_16x16x32_bf16 v[76:79], v[96:99], a[56:59], v[76:79]
  v_mfma_f32_16x16x32_bf16 v[80:83], v[96:99], a[88:91], v[80:83]
  v_mfma_f32_16x16x32_bf16 v[84:87], v[96:99], a[120:123], v[84:87]
  v_mfma_f32_16x16x32_bf16 v[88:91], v[96:99], a[152:155], v[88:91]
  ds_read2_b32 v[96:97], v53 offset0:0 offset1:1
  ds_read2_b32 v[98:99], v53 offset0:2 offset1:3
  s_waitcnt lgkmcnt(6)
  v_mfma_f32_16x16x32_bf16 v[72:75], v[100:103], a[20:23], v[72:75]
  v_mfma_f32_16x16x32_bf16 v[76:79], v[100:103], a[52:55], v[76:79]
  v_mfma_f32_16x16x32_bf16 v[80:83], v[100:103], a[84:87], v[80:83]
  v_mfma_f32_16x16x32_bf16 v[84:87], v[100:103], a[116:119], v[84:87]
  v_mfma_f32_16x16x32_bf16 v[88:91], v[100:103], a[148:151], v[88:91]
  ds_read2_b32 v[100:101], v54 offset0:224 offset1:225
  ds_read2_b32 v[102:103], v54 offset0:226 offset1:227
  s_waitcnt lgkmcnt(6)
  v_mfma_f32_16x16x32_bf16 v[72:75], v[104:107], a[16:19], v[72:75]
  v_mfma_f32_16x16x32_bf16 v[76:79], v[104:107], a[48:51], v[76:79]
  v_mfma_f32_16x16x32_bf16 v[80:83], v[104:107], a[80:83], v[80:83]
  v_mfma_f32_16x16x32_bf16 v[84:87], v[104:107], a[112:115], v[84:87]
  v_mfma_f32_16x16x32_bf16 v[88:91], v[104:107], a[144:147], v[88:91]
  ds_read2_b32 v[104:105], v54 offset0:208 offset1:209
  ds_read2_b32 v[106:107], v54 offset0:210 offset1:211
  s_waitcnt lgkmcnt(6)
  v_mfma_f32_16x16x32_bf16 v[72:75], v[92:95], a[12:15], v[72:75]
  v_mfma_f32_16x16x32_bf16 v[76:79], v[92:95], a[44:47], v[76:79]
  v_mfma_f32_16x16x32_bf16 v[80:83], v[92:95], a[76:79], v[80:83]
  v_mfma_f32_16x16x32_bf16 v[84:87], v[92:95], a[108:111], v[84:87]
  v_mfma_f32_16x16x32_bf16 v[88:91], v[92:95], a[140:143], v[88:91]
  ds_read2_b32 v[92:93], v54 offset0:192 offset1:193
  ds_read2_b32 v[94:95], v54 offset0:194 offset1:195
  s_waitcnt lgkmcnt(6)
  v_mfma_f32_16x16x32_bf16 v[72:75], v[96:99], a[8:11], v[72:75]
  v_mfma_f32_16x16x32_bf16 v[76:79], v[96:99], a[40:43], v[76:79]
  v_mfma_f32_16x16x32_bf16 v[80:83], v[96:99], a[72:75], v[80:83]
  v_mfma_f32_16x16x32_bf16 v[84:87], v[96:99], a[104:107], v[84:87]
  v_mfma_f32_16x16x32_bf16 v[88:91], v[96:99], a[136:139], v[88:91]
  ds_read2_b32 v[96:97], v54 offset0:176 offset1:177
  ds_read2_b32 v[98:99], v54 offset0:178 offset1:179
  s_waitcnt lgkmcnt(6)
  v_mfma_f32_16x16x32_bf16 v[72:75], v[100:103], a[4:7], v[72:75]
  v_mfma_f32_16x16x32_bf16 v[76:79], v[100:103], a[36:39], v[76:79]
  v_mfma_f32_16x16x32_bf16 v[80:83], v[100:103], a[68:71], v[80:83]
  v_mfma_f32_16x16x32_bf16 v[84:87], v[100:103], a[100:103], v[84:87]
  v_mfma_f32_16x16x32_bf16 v[88:91], v[100:103], a[132:135], v[88:91]
  ds_read2_b32 v[100:101], v54 offset0:160 offset1:161
  ds_read2_b32 v[102:103], v54 offset0:162 offset1:163
  s_waitcnt lgkmcnt(6)
  v_mfma_f32_16x16x32_bf16 v[72:75], v[104:107], a[0:3], v[72:75]
  v_mfma_f32_16x16x32_bf16 v[76:79], v[104:107], a[32:35], v[76:79]
  v_mfma_f32_16x16x32_bf16 v[80:83], v[104:107], a[64:67], v[80:83]
  v_mfma_f32_16x16x32_bf16 v[84:87], v[104:107], a[96:99], v[84:87]
  v_mfma_f32_16x16x32_bf16 v[88:91], v[104:107], a[128:131], v[88:91]
  ds_read2_b32 v[104:105], v54 offset0:144 offset1:145
  ds_read2_b32 v[106:107], v54 offset0:146 offset1:147
  s_waitcnt lgkmcnt(6)
  v_mfma_f32_16x16x32_bf16 v[76:79], v[92:95], a[28:31], v[76:79]
  v_mfma_f32_16x16x32_bf16 v[80:83], v[92:95], a[60:63], v[80:83]
  v_mfma_f32_16x16x32_bf16 v[84:87], v[92:95], a[92:95], v[84:87]
  v_mfma_f32_16x16x32_bf16 v[88:91], v[92:95], a[124:127], v[88:91]
  ds_read2_b32 v[92:93], v54 offset0:128 offset1:129
  ds_read2_b32 v[94:95], v54 offset0:130 offset1:131
  s_waitcnt lgkmcnt(6)
  v_mfma_f32_16x16x32_bf16 v[76:79], v[96:99], a[24:27], v[76:79]
  v_mfma_f32_16x16x32_bf16 v[80:83], v[96:99], a[56:59], v[80:83]
  v_mfma_f32_16x16x32_bf16 v[84:87], v[96:99], a[88:91], v[84:87]
  v_mfma_f32_16x16x32_bf16 v[88:91], v[96:99], a[120:123], v[88:91]
  ds_read2_b32 v[96:97], v54 offset0:112 offset1:113
  ds_read2_b32 v[98:99], v54 offset0:114 offset1:115
  s_waitcnt lgkmcnt(6)
  v_mfma_f32_16x16x32_bf16 v[76:79], v[100:103], a[20:23], v[76:79]
  v_mfma_f32_16x16x32_bf16 v[80:83], v[100:103], a[52:55], v[80:83]
  v_mfma_f32_16x16x32_bf16 v[84:87], v[100:103], a[84:87], v[84:87]
  v_mfma_f32_16x16x32_bf16 v[88:91], v[100:103], a[116:119], v[88:91]
  ds_read2_b32 v[100:101], v54 offset0:96 offset1:97
  ds_read2_b32 v[102:103], v54 offset0:98 offset1:99
  s_waitcnt lgkmcnt(6)
  v_mfma_f32_16x16x32_bf16 v[76:79], v[104:107], a[16:19], v[76:79]
  v_mfma_f32_16x16x32_bf16 v[80:83], v[104:107], a[48:51], v[80:83]
  v_mfma_f32_16x16x32_bf16 v[84:87], v[104:107], a[80:83], v[84:87]
  v_mfma_f32_16x16x32_bf16 v[88:91], v[104:107], a[112:115], v[88:91]
  ds_read2_b32 v[104:105], v54 offset0:80 offset1:81
  ds_read2_b32 v[106:107], v54 offset0:82 offset1:83
  s_waitcnt lgkmcnt(6)
  v_mfma_f32_16x16x32_bf16 v[76:79], v[92:95], a[12:15], v[76:79]
  v_mfma_f32_16x16x32_bf16 v[80:83], v[92:95], a[44:47], v[80:83]
  v_mfma_f32_16x16x32_bf16 v[84:87], v[92:95], a[76:79], v[84:87]
  v_mfma_f32_16x16x32_bf16 v[88:91], v[92:95], a[108:111], v[88:91]
  ds_read2_b32 v[92:93], v54 offset0:64 offset1:65
  ds_read2_b32 v[94:95], v54 offset0:66 offset1:67
  s_waitcnt lgkmcnt(6)
  v_mfma_f32_16x16x32_bf16 v[76:79], v[96:99], a[8:11], v[76:79]
  v_mfma_f32_16x16x32_bf16 v[80:83], v[96:99], a[40:43], v[80:83]
  v_mfma_f32_16x16x32_bf16 v[84:87], v[96:99], a[72:75], v[84:87]
  v_mfma_f32_16x16x32_bf16 v[88:91], v[96:99], a[104:107], v[88:91]
  ds_read2_b32 v[96:97], v54 offset0:48 offset1:49
  ds_read2_b32 v[98:99], v54 offset0:50 offset1:51
  s_waitcnt lgkmcnt(6)
  v_mfma_f32_16x16x32_bf16 v[76:79], v[100:103], a[4:7], v[76:79]
  v_mfma_f32_16x16x32_bf16 v[80:83], v[100:103], a[36:39], v[80:83]
  v_mfma_f32_16x16x32_bf16 v[84:87], v[100:103], a[68:71], v[84:87]
  v_mfma_f32_16x16x32_bf16 v[88:91], v[100:103], a[100:103], v[88:91]
  ds_read2_b32 v[100:101], v54 offset0:32 offset1:33
  ds_read2_b32 v[102:103], v54 offset0:34 offset1:35
  s_waitcnt lgkmcnt(6)
  v_mfma_f32_16x16x32_bf16 v[76:79], v[104:107], a[0:3], v[76:79]
  v_mfma_f32_16x16x32_bf16 v[80:83], v[104:107], a[32:35], v[80:83]
  v_mfma_f32_16x16x32_bf16 v[84:87], v[104:107], a[64:67], v[84:87]
  v_mfma_f32_16x16x32_bf16 v[88:91], v[104:107], a[96:99], v[88:91]
  ds_read2_b32 v[104:105], v54 offset0:16 offset1:17
  ds_read2_b32 v[106:107], v54 offset0:18 offset1:19
  s_waitcnt lgkmcnt(6)
  v_mfma_f32_16x16x32_bf16 v[80:83], v[92:95], a[28:31], v[80:83]
  v_mfma_f32_16x16x32_bf16 v[84:87], v[92:95], a[60:63], v[84:87]
  v_mfma_f32_16x16x32_bf16 v[88:91], v[92:95], a[92:95], v[88:91]
  ds_read2_b32 v[92:93], v54 offset0:0 offset1:1
  ds_read2_b32 v[94:95], v54 offset0:2 offset1:3
  s_waitcnt lgkmcnt(6)
  v_mfma_f32_16x16x32_bf16 v[80:83], v[96:99], a[24:27], v[80:83]
  v_mfma_f32_16x16x32_bf16 v[84:87], v[96:99], a[56:59], v[84:87]
  v_mfma_f32_16x16x32_bf16 v[88:91], v[96:99], a[88:91], v[88:91]
  ds_read2_b32 v[96:97], v55 offset0:224 offset1:225
  ds_read2_b32 v[98:99], v55 offset0:226 offset1:227
  s_waitcnt lgkmcnt(6)
  v_mfma_f32_16x16x32_bf16 v[80:83], v[100:103], a[20:23], v[80:83]
  v_mfma_f32_16x16x32_bf16 v[84:87], v[100:103], a[52:55], v[84:87]
  v_mfma_f32_16x16x32_bf16 v[88:91], v[100:103], a[84:87], v[88:91]
  ds_read2_b32 v[100:101], v55 offset0:208 offset1:209
  ds_read2_b32 v[102:103], v55 offset0:210 offset1:211
  s_waitcnt lgkmcnt(6)
  v_mfma_f32_16x16x32_bf16 v[80:83], v[104:107], a[16:19], v[80:83]
  v_mfma_f32_16x16x32_bf16 v[84:87], v[104:107], a[48:51], v[84:87]
  v_mfma_f32_16x16x32_bf16 v[88:91], v[104:107], a[80:83], v[88:91]
  ds_read2_b32 v[104:105], v55 offset0:192 offset1:193
  ds_read2_b32 v[106:107], v55 offset0:194 offset1:195
  s_waitcnt lgkmcnt(6)
  v_mfma_f32_16x16x32_bf16 v[80:83], v[92:95], a[12:15], v[80:83]
  v_mfma_f32_16x16x32_bf16 v[84:87], v[92:95], a[44:47], v[84:87]
  v_mfma_f32_16x16x32_bf16 v[88:91], v[92:95], a[76:79], v[88:91]
  ds_read2_b32 v[92:93], v55 offset0:176 offset1:177
  ds_read2_b32 v[94:95], v55 offset0:178 offset1:179
  s_waitcnt lgkmcnt(6)
  v_mfma_f32_16x16x32_bf16 v[80:83], v[96:99], a[8:11], v[80:83]
  v_mfma_f32_16x16x32_bf16 v[84:87], v[96:99], a[40:43], v[84:87]
  v_mfma_f32_16x16x32_bf16 v[88:91], v[96:99], a[72:75], v[88:91]
  ds_read2_b32 v[96:97], v55 offset0:160 offset1:161
  ds_read2_b32 v[98:99], v55 offset0:162 offset1:163
  s_waitcnt lgkmcnt(6)
  v_mfma_f32_16x16x32_bf16 v[80:83], v[100:103], a[4:7], v[80:83]
  v_mfma_f32_16x16x32_bf16 v[84:87], v[100:103], a[36:39], v[84:87]
  v_mfma_f32_16x16x32_bf16 v[88:91], v[100:103], a[68:71], v[88:91]
  ds_read2_b32 v[100:101], v55 offset0:144 offset1:145
  ds_read2_b32 v[102:103], v55 offset0:146 offset1:147
  s_waitcnt lgkmcnt(6)
  v_mfma_f32_16x16x32_bf16 v[80:83], v[104:107], a[0:3], v[80:83]
  v_mfma_f32_16x16x32_bf16 v[84:87], v[104:107], a[32:35], v[84:87]
  v_mfma_f32_16x16x32_bf16 v[88:91], v[104:107], a[64:67], v[88:91]
  ds_read2_b32 v[104:105], v55 offset0:128 offset1:129
  ds_read2_b32 v[106:107], v55 offset0:130 offset1:131
  s_waitcnt lgkmcnt(6)
  v_mfma_f32_16x16x32_bf16 v[84:87], v[92:95], a[28:31], v[84:87]
  v_mfma_f32_16x16x32_bf16 v[88:91], v[92:95], a[60:63], v[88:91]
  ds_read2_b32 v[92:93], v55 offset0:112 offset1:113
  ds_read2_b32 v[94:95], v55 offset0:114 offset1:115
  s_waitcnt lgkmcnt(6)
  v_mfma_f32_16x16x32_bf16 v[84:87], v[96:99], a[24:27], v[84:87]
  v_mfma_f32_16x16x32_bf16 v[88:91], v[96:99], a[56:59], v[88:91]
  ds_read2_b32 v[96:97], v55 offset0:96 offset1:97
  ds_read2_b32 v[98:99], v55 offset0:98 offset1:99
  s_waitcnt lgkmcnt(6)
  v_mfma_f32_16x16x32_bf16 v[84:87], v[100:103], a[20:23], v[84:87]
  v_mfma_f32_16x16x32_bf16 v[88:91], v[100:103], a[52:55], v[88:91]
  ds_read2_b32 v[100:101], v55 offset0:80 offset1:81
  ds_read2_b32 v[102:103], v55 offset0:82 offset1:83
  s_waitcnt lgkmcnt(6)
  v_mfma_f32_16x16x32_bf16 v[84:87], v[104:107], a[16:19], v[84:87]
  v_mfma_f32_16x16x32_bf16 v[88:91], v[104:107], a[48:51], v[88:91]
  ds_read2_b32 v[104:105], v55 offset0:64 offset1:65
  ds_read2_b32 v[106:107], v55 offset0:66 offset1:67
  s_waitcnt lgkmcnt(6)
  v_mfma_f32_16x16x32_bf16 v[84:87], v[92:95], a[12:15], v[84:87]
  v_mfma_f32_16x16x32_bf16 v[88:91], v[92:95], a[44:47], v[88:91]
  ds_read2_b32 v[92:93], v55 offset0:48 offset1:49
  ds_read2_b32 v[94:95], v55 offset0:50 offset1:51
  s_waitcnt lgkmcnt(6)
  v_mfma_f32_16x16x32_bf16 v[84:87], v[96:99], a[8:11], v[84:87]
  v_mfma_f32_16x16x32_bf16 v[88:91], v[96:99], a[40:43], v[88:91]
  ds_read2_b32 v[96:97], v55 offset0:32 offset1:33
  ds_read2_b32 v[98:99], v55 offset0:34 offset1:35
  s_waitcnt lgkmcnt(6)
  v_mfma_f32_16x16x32_bf16 v[84:87], v[100:103], a[4:7], v[84:87]
  v_mfma_f32_16x16x32_bf16 v[88:91], v[100:103], a[36:39], v[88:91]
  ds_read2_b32 v[100:101], v55 offset0:16 offset1:17
  ds_read2_b32 v[102:103], v55 offset0:18 offset1:19
  s_waitcnt lgkmcnt(6)
  v_mfma_f32_16x16x32_bf16 v[84:87], v[104:107], a[0:3], v[84:87]
  v_mfma_f32_16x16x32_bf16 v[88:91], v[104:107], a[32:35], v[88:91]
  ds_read2_b32 v[104:105], v55 offset0:0 offset1:1
  ds_read2_b32 v[106:107], v55 offset0:2 offset1:3
  s_waitcnt lgkmcnt(6)
  v_mfma_f32_16x16x32_bf16 v[88:91], v[92:95], a[28:31], v[88:91]
  ds_read2_b32 v[92:93], v56 offset0:224 offset1:225
  ds_read2_b32 v[94:95], v56 offset0:226 offset1:227
  s_waitcnt lgkmcnt(6)
  v_mfma_f32_16x16x32_bf16 v[88:91], v[96:99], a[24:27], v[88:91]
  ds_read2_b32 v[96:97], v56 offset0:208 offset1:209
  ds_read2_b32 v[98:99], v56 offset0:210 offset1:211
  s_waitcnt lgkmcnt(6)
  v_mfma_f32_16x16x32_bf16 v[88:91], v[100:103], a[20:23], v[88:91]
  ds_read2_b32 v[100:101], v56 offset0:192 offset1:193
  ds_read2_b32 v[102:103], v56 offset0:194 offset1:195
  s_waitcnt lgkmcnt(6)
  v_mfma_f32_16x16x32_bf16 v[88:91], v[104:107], a[16:19], v[88:91]
  ds_read2_b32 v[104:105], v56 offset0:176 offset1:177
  ds_read2_b32 v[106:107], v56 offset0:178 offset1:179
  s_waitcnt lgkmcnt(6)
  v_mfma_f32_16x16x32_bf16 v[88:91], v[92:95], a[12:15], v[88:91]
  s_waitcnt lgkmcnt(4)
  v_mfma_f32_16x16x32_bf16 v[88:91], v[96:99], a[8:11], v[88:91]
  s_waitcnt lgkmcnt(2)
  v_mfma_f32_16x16x32_bf16 v[88:91], v[100:103], a[4:7], v[88:91]
  s_waitcnt lgkmcnt(0)
  v_mfma_f32_16x16x32_bf16 v[88:91], v[104:107], a[0:3], v[88:91]
  v_lshlrev_b32 v46, 5, v4
  v_lshl_add_u32 v46, v3, 3, v46
  v_add_u32 v46, s17, v46
  ds_read_b64 v[108:109], v46 offset:512
  ds_read_b64 v[110:111], v46 offset:1024
  ds_read_b64 v[112:113], v46 offset:1536
  ds_read_b64 v[114:115], v46 offset:2048
  ds_read_b64 v[116:117], v46 offset:2560
  ds_read_b64 v[118:119], v46 offset:3072
  ds_read_b64 v[120:121], v46 offset:3584
  ds_read_b64 v[122:123], v46 offset:4096
  s_waitcnt lgkmcnt(0)
  v_lshlrev_b32 v124, 16, v108
  v_and_b32 v125, 0xffff0000, v108
  v_lshlrev_b32 v126, 16, v109
  v_and_b32 v127, 0xffff0000, v109
  v_mul_f32 v124, v124, v33
  v_mul_f32 v125, v125, v33
  v_mul_f32 v126, v126, v33
  v_mul_f32 v127, v127, v33
  v_cvt_pk_bf16_f32 v128, v124, v125
  v_cvt_pk_bf16_f32 v129, v126, v127
  v_cvt_pk_bf16_f32 v130, v60, v61
  v_cvt_pk_bf16_f32 v131, v62, v63
  v_lshlrev_b32 v124, 16, v128
  v_and_b32 v125, 0xffff0000, v128
  v_lshlrev_b32 v132, 16, v130
  v_and_b32 v133, 0xffff0000, v130
  v_lshlrev_b32 v126, 16, v129
  v_and_b32 v127, 0xffff0000, v129
  v_lshlrev_b32 v134, 16, v131
  v_and_b32 v135, 0xffff0000, v131
  v_add_f32 v124, v124, v132
  v_add_f32 v125, v125, v133
  v_add_f32 v126, v126, v134
  v_add_f32 v127, v127, v135
  v_cvt_pk_bf16_f32 v108, v124, v125
  v_cvt_pk_bf16_f32 v109, v126, v127
  ds_write_b64 v46, v[108:109] offset:512
  v_lshlrev_b32 v124, 16, v110
  v_and_b32 v125, 0xffff0000, v110
  v_lshlrev_b32 v126, 16, v111
  v_and_b32 v127, 0xffff0000, v111
  v_mul_f32 v124, v124, v33
  v_mul_f32 v125, v125, v33
  v_mul_f32 v126, v126, v33
  v_mul_f32 v127, v127, v33
  v_cvt_pk_bf16_f32 v128, v124, v125
  v_cvt_pk_bf16_f32 v129, v126, v127
  v_cvt_pk_bf16_f32 v130, v64, v65
  v_cvt_pk_bf16_f32 v131, v66, v67
  v_lshlrev_b32 v124, 16, v128
  v_and_b32 v125, 0xffff0000, v128
  v_lshlrev_b32 v132, 16, v130
  v_and_b32 v133, 0xffff0000, v130
  v_lshlrev_b32 v126, 16, v129
  v_and_b32 v127, 0xffff0000, v129
  v_lshlrev_b32 v134, 16, v131
  v_and_b32 v135, 0xffff0000, v131
  v_add_f32 v124, v124, v132
  v_add_f32 v125, v125, v133
  v_add_f32 v126, v126, v134
  v_add_f32 v127, v127, v135
  v_cvt_pk_bf16_f32 v110, v124, v125
  v_cvt_pk_bf16_f32 v111, v126, v127
  ds_write_b64 v46, v[110:111] offset:1024
  v_lshlrev_b32 v124, 16, v112
  v_and_b32 v125, 0xffff0000, v112
  v_lshlrev_b32 v126, 16, v113
  v_and_b32 v127, 0xffff0000, v113
  v_mul_f32 v124, v124, v33
  v_mul_f32 v125, v125, v33
  v_mul_f32 v126, v126, v33
  v_mul_f32 v127, v127, v33
  v_cvt_pk_bf16_f32 v128, v124, v125
  v_cvt_pk_bf16_f32 v129, v126, v127
  v_cvt_pk_bf16_f32 v130, v68, v69
  v_cvt_pk_bf16_f32 v131, v70, v71
  v_lshlrev_b32 v124, 16, v128
  v_and_b32 v125, 0xffff0000, v128
  v_lshlrev_b32 v132, 16, v130
  v_and_b32 v133, 0xffff0000, v130
  v_lshlrev_b32 v126, 16, v129
  v_and_b32 v127, 0xffff0000, v129
  v_lshlrev_b32 v134, 16, v131
  v_and_b32 v135, 0xffff0000, v131
  v_add_f32 v124, v124, v132
  v_add_f32 v125, v125, v133
  v_add_f32 v126, v126, v134
  v_add_f32 v127, v127, v135
  v_cvt_pk_bf16_f32 v112, v124, v125
  v_cvt_pk_bf16_f32 v113, v126, v127
  ds_write_b64 v46, v[112:113] offset:1536
  v_lshlrev_b32 v124, 16, v114
  v_and_b32 v125, 0xffff0000, v114
  v_lshlrev_b32 v126, 16, v115
  v_and_b32 v127, 0xffff0000, v115
  v_mul_f32 v124, v124, v33
  v_mul_f32 v125, v125, v33
  v_mul_f32 v126, v126, v33
  v_mul_f32 v127, v127, v33
  v_cvt_pk_bf16_f32 v128, v124, v125
  v_cvt_pk_bf16_f32 v129, v126, v127
  v_cvt_pk_bf16_f32 v130, v72, v73
  v_cvt_pk_bf16_f32 v131, v74, v75
  v_lshlrev_b32 v124, 16, v128
  v_and_b32 v125, 0xffff0000, v128
  v_lshlrev_b32 v132, 16, v130
  v_and_b32 v133, 0xffff0000, v130
  v_lshlrev_b32 v126, 16, v129
  v_and_b32 v127, 0xffff0000, v129
  v_lshlrev_b32 v134, 16, v131
  v_and_b32 v135, 0xffff0000, v131
  v_add_f32 v124, v124, v132
  v_add_f32 v125, v125, v133
  v_add_f32 v126, v126, v134
  v_add_f32 v127, v127, v135
  v_cvt_pk_bf16_f32 v114, v124, v125
  v_cvt_pk_bf16_f32 v115, v126, v127
  ds_write_b64 v46, v[114:115] offset:2048
  v_lshlrev_b32 v124, 16, v116
  v_and_b32 v125, 0xffff0000, v116
  v_lshlrev_b32 v126, 16, v117
  v_and_b32 v127, 0xffff0000, v117
  v_mul_f32 v124, v124, v33
  v_mul_f32 v125, v125, v33
  v_mul_f32 v126, v126, v33
  v_mul_f32 v127, v127, v33
  v_cvt_pk_bf16_f32 v128, v124, v125
  v_cvt_pk_bf16_f32 v129, v126, v127
  v_cvt_pk_bf16_f32 v130, v76, v77
  v_cvt_pk_bf16_f32 v131, v78, v79
  v_lshlrev_b32 v124, 16, v128
  v_and_b32 v125, 0xffff0000, v128
  v_lshlrev_b32 v132, 16, v130
  v_and_b32 v133, 0xffff0000, v130
  v_lshlrev_b32 v126, 16, v129
  v_and_b32 v127, 0xffff0000, v129
  v_lshlrev_b32 v134, 16, v131
  v_and_b32 v135, 0xffff0000, v131
  v_add_f32 v124, v124, v132
  v_add_f32 v125, v125, v133
  v_add_f32 v126, v126, v134
  v_add_f32 v127, v127, v135
  v_cvt_pk_bf16_f32 v116, v124, v125
  v_cvt_pk_bf16_f32 v117, v126, v127
  ds_write_b64 v46, v[116:117] offset:2560
  v_lshlrev_b32 v124, 16, v118
  v_and_b32 v125, 0xffff0000, v118
  v_lshlrev_b32 v126, 16, v119
  v_and_b32 v127, 0xffff0000, v119
  v_mul_f32 v124, v124, v33
  v_mul_f32 v125, v125, v33
  v_mul_f32 v126, v126, v33
  v_mul_f32 v127, v127, v33
  v_cvt_pk_bf16_f32 v128, v124, v125
  v_cvt_pk_bf16_f32 v129, v126, v127
  v_cvt_pk_bf16_f32 v130, v80, v81
  v_cvt_pk_bf16_f32 v131, v82, v83
  v_lshlrev_b32 v124, 16, v128
  v_and_b32 v125, 0xffff0000, v128
  v_lshlrev_b32 v132, 16, v130
  v_and_b32 v133, 0xffff0000, v130
  v_lshlrev_b32 v126, 16, v129
  v_and_b32 v127, 0xffff0000, v129
  v_lshlrev_b32 v134, 16, v131
  v_and_b32 v135, 0xffff0000, v131
  v_add_f32 v124, v124, v132
  v_add_f32 v125, v125, v133
  v_add_f32 v126, v126, v134
  v_add_f32 v127, v127, v135
  v_cvt_pk_bf16_f32 v118, v124, v125
  v_cvt_pk_bf16_f32 v119, v126, v127
  ds_write_b64 v46, v[118:119] offset:3072
  v_lshlrev_b32 v124, 16, v120
  v_and_b32 v125, 0xffff0000, v120
  v_lshlrev_b32 v126, 16, v121
  v_and_b32 v127, 0xffff0000, v121
  v_mul_f32 v124, v124, v33
  v_mul_f32 v125, v125, v33
  v_mul_f32 v126, v126, v33
  v_mul_f32 v127, v127, v33
  v_cvt_pk_bf16_f32 v128, v124, v125
  v_cvt_pk_bf16_f32 v129, v126, v127
  v_cvt_pk_bf16_f32 v130, v84, v85
  v_cvt_pk_bf16_f32 v131, v86, v87
  v_lshlrev_b32 v124, 16, v128
  v_and_b32 v125, 0xffff0000, v128
  v_lshlrev_b32 v132, 16, v130
  v_and_b32 v133, 0xffff0000, v130
  v_lshlrev_b32 v126, 16, v129
  v_and_b32 v127, 0xffff0000, v129
  v_lshlrev_b32 v134, 16, v131
  v_and_b32 v135, 0xffff0000, v131
  v_add_f32 v124, v124, v132
  v_add_f32 v125, v125, v133
  v_add_f32 v126, v126, v134
  v_add_f32 v127, v127, v135
  v_cvt_pk_bf16_f32 v120, v124, v125
  v_cvt_pk_bf16_f32 v121, v126, v127
  ds_write_b64 v46, v[120:121] offset:3584
  v_lshlrev_b32 v124, 16, v122
  v_and_b32 v125, 0xffff0000, v122
  v_lshlrev_b32 v126, 16, v123
  v_and_b32 v127, 0xffff0000, v123
  v_mul_f32 v124, v124, v33
  v_mul_f32 v125, v125, v33
  v_mul_f32 v126, v126, v33
  v_mul_f32 v127, v127, v33
  v_cvt_pk_bf16_f32 v128, v124, v125
  v_cvt_pk_bf16_f32 v129, v126, v127
  v_cvt_pk_bf16_f32 v130, v88, v89
  v_cvt_pk_bf16_f32 v131, v90, v91
  v_lshlrev_b32 v124, 16, v128
  v_and_b32 v125, 0xffff0000, v128
  v_lshlrev_b32 v132, 16, v130
  v_and_b32 v133, 0xffff0000, v130
  v_lshlrev_b32 v126, 16, v129
  v_and_b32 v127, 0xffff0000, v129
  v_lshlrev_b32 v134, 16, v131
  v_and_b32 v135, 0xffff0000, v131
  v_add_f32 v124, v124, v132
  v_add_f32 v125, v125, v133
  v_add_f32 v126, v126, v134
  v_add_f32 v127, v127, v135
  v_cvt_pk_bf16_f32 v122, v124, v125
  v_cvt_pk_bf16_f32 v123, v126, v127
  ds_write_b64 v46, v[122:123] offset:4096
  s_waitcnt lgkmcnt(0)
  s_barrier
  v_lshlrev_b32 v6, 3, v0
  v_mul_u32_u24 v5, 7168, v0
  v_add_u32 v36, 512, v6
  ds_read_b64 v[8:9], v36
  v_add_u32 v36, 25088, v6
  ds_read_b64 v[10:11], v36
  v_add_u32 v36, 49664, v6
  ds_read_b64 v[12:13], v36
  v_add_u32 v36, 74240, v6
  ds_read_b64 v[14:15], v36
  s_waitcnt lgkmcnt(0)
  s_add_u32 s22, s21, 0
  s_add_u32 s23, s22, 3584
  v_perm_b32 v16, v10, v8, s24
  v_perm_b32 v17, v14, v12, s24
  buffer_store_dwordx2 v[16:17], v5, s[88:91], s22 offen offset:0
  v_perm_b32 v18, v10, v8, s25
  v_perm_b32 v19, v14, v12, s25
  buffer_store_dwordx2 v[18:19], v5, s[88:91], s22 offen offset:1792
  v_perm_b32 v20, v11, v9, s24
  v_perm_b32 v21, v15, v13, s24
  buffer_store_dwordx2 v[20:21], v5, s[88:91], s23 offen offset:0
  v_perm_b32 v22, v11, v9, s25
  v_perm_b32 v23, v15, v13, s25
  buffer_store_dwordx2 v[22:23], v5, s[88:91], s23 offen offset:1792
  v_add_u32 v36, 2560, v6
  ds_read_b64 v[8:9], v36
  v_add_u32 v36, 27136, v6
  ds_read_b64 v[10:11], v36
  v_add_u32 v36, 51712, v6
  ds_read_b64 v[12:13], v36
  v_add_u32 v36, 76288, v6
  ds_read_b64 v[14:15], v36
  s_waitcnt lgkmcnt(0)
  s_add_u32 s22, s21, 1835008
  s_add_u32 s23, s22, 3584
  v_perm_b32 v24, v10, v8, s24
  v_perm_b32 v25, v14, v12, s24
  buffer_store_dwordx2 v[24:25], v5, s[88:91], s22 offen offset:0
  v_perm_b32 v26, v10, v8, s25
  v_perm_b32 v27, v14, v12, s25
  buffer_store_dwordx2 v[26:27], v5, s[88:91], s22 offen offset:1792
  v_perm_b32 v28, v11, v9, s24
  v_perm_b32 v29, v15, v13, s24
  buffer_store_dwordx2 v[28:29], v5, s[88:91], s23 offen offset:0
  v_perm_b32 v30, v11, v9, s25
  v_perm_b32 v31, v15, v13, s25
  buffer_store_dwordx2 v[30:31], v5, s[88:91], s23 offen offset:1792
  s_branch wk_loop
wk_tok:
  s_sub_u32 s3, s3, 592
  s_cmp_ge_u32 s3, 512
  s_cbranch_scc1 wk_done
  s_lshr_b32 s17, s3, 3
  s_and_b32 s18, s3, 3
  s_bitcmp1_b32 s3, 2
  s_cbranch_scc1 wk_toko
  s_lshl_b32 s20, s18, 2
  s_add_u32 s20, s20, s16
  s_lshl_b32 s21, s17, 4
  s_add_u32 s21, s21, s20
  s_mul_i32 s21, s21, 28672
  s_add_u32 s21, s21, 12845056
  s_mul_i32 s23, s17, 28672
  s_add_u32 s23, s23, 73400320
  s_mul_i32 s24, s17, 7168
  s_add_u32 s24, s24, 87543808
  s_lshr_b32 s25, s17, 3
  s_lshl_b32 s25, s25, 4
  s_add_u32 s25, s25, s20
  s_lshl_b32 s25, s25, 2
  s_add_u32 s25, s25, 88003072
  v_mov_b32 v60, 0
  s_mov_b32 s30, 0
wp_wf:
  buffer_load_dword v61, v60, s[8:11], s25 offen sc1
  s_waitcnt vmcnt(0)
  v_cmp_ne_u32 vcc, 56, v61
  s_cbranch_vccz wp_wf_ok
  s_sleep 4
  s_cmp_ge_u32 s17, 56
  s_cbranch_scc1 wp_wf_bo
  s_sleep 127
wp_wf_bo:
  s_add_u32 s30, s30, 1
  s_cmp_lt_u32 s30, 2000000
  s_cbranch_scc1 wp_wf
  s_branch wp_abort
wp_wf_ok:
  s_add_u32 s22, s21, 0
  buffer_load_dwordx4 a[0:3], v2, s[8:11], s22 offen offset:0 sc1
  buffer_load_dwordx4 a[4:7], v2, s[8:11], s22 offen offset:1024 sc1
  buffer_load_dwordx4 a[8:11], v2, s[8:11], s22 offen offset:2048 sc1
  buffer_load_dwordx4 a[12:15], v2, s[8:11], s22 offen offset:3072 sc1
  s_add_u32 s22, s21, 4096
  buffer_load_dwordx4 a[16:19], v2, s[8:11], s22 offen offset:0 sc1
  buffer_load_dwordx4 a[20:23], v2, s[8:11], s22 offen offset:1024 sc1
  buffer_load_dwordx4 a[24:27], v2, s[8:11], s22 offen offset:2048 sc1
  buffer_load_dwordx4 a[28:31], v2, s[8:11], s22 offen offset:3072 sc1
  s_add_u32 s22, s21, 8192
  buffer_load_dwordx4 a[32:35], v2, s[8:11], s22 offen offset:0 sc1
  buffer_load_dwordx4 a[36:39], v2, s[8:11], s22 offen offset:1024 sc1
  buffer_load_dwordx4 a[40:43], v2, s[8:11], s22 offen offset:2048 sc1
  buffer_load_dwordx4 a[44:47], v2, s[8:11], s22 offen offset:3072 sc1
  s_add_u32 s22, s21, 12288
  buffer_load_dwordx4 a[48:51], v2, s[8:11], s22 offen offset:0 sc1
  buffer_load_dwordx4 a[52:55], v2, s[8:11], s22 offen offset:1024 sc1
  buffer_load_dwordx4 a[56:59], v2, s[8:11], s22 offen offset:2048 sc1
  buffer_load_dwordx4 a[60:63], v2, s[8:11], s22 offen offset:3072 sc1
  s_add_u32 s22, s21, 16384
  buffer_load_dwordx4 a[64:67], v2, s[8:11], s22 offen offset:0 sc1
  buffer_load_dwordx4 a[68:71], v2, s[8:11], s22 offen offset:1024 sc1
  buffer_load_dwordx4 a[72:75], v2, s[8:11], s22 offen offset:2048 sc1
  buffer_load_dwordx4 a[76:79], v2, s[8:11], s22 offen offset:3072 sc1
  s_add_u32 s22, s21, 20480
  buffer_load_dwordx4 a[80:83], v2, s[8:11], s22 offen offset:0 sc1
  buffer_load_dwordx4 a[84:87], v2, s[8:11], s22 offen offset:1024 sc1
  buffer_load_dwordx4 a[88:91], v2, s[8:11], s22 offen offset:2048 sc1
  buffer_load_dwordx4 a[92:95], v2, s[8:11], s22 offen offset:3072 sc1
  s_add_u32 s22, s21, 24576
  buffer_load_dwordx4 a[96:99], v2, s[8:11], s22 offen offset:0 sc1
  buffer_load_dwordx4 a[100:103], v2, s[8:11], s22 offen offset:1024 sc1
  buffer_load_dwordx4 a[104:107], v2, s[8:11], s22 offen offset:2048 sc1
  buffer_load_dwordx4 a[108:111], v2, s[8:11], s22 offen offset:3072 sc1
  s_add_u32 s22, s23, 0
  buffer_load_dwordx4 a[112:115], v2, s[8:11], s22 offen offset:0
  buffer_load_dwordx4 a[116:119], v2, s[8:11], s22 offen offset:1024
  buffer_load_dwordx4 a[120:123], v2, s[8:11], s22 offen offset:2048
  buffer_load_dwordx4 a[124:127], v2, s[8:11], s22 offen offset:3072
  s_add_u32 s22, s23, 4096
  buffer_load_dwordx4 a[128:131], v2, s[8:11], s22 offen offset:0
  buffer_load_dwordx4 a[132:135], v2, s[8:11], s22 offen offset:1024
  buffer_load_dwordx4 a[136:139], v2, s[8:11], s22 offen offset:2048
  buffer_load_dwordx4 a[140:143], v2, s[8:11], s22 offen offset:3072
  s_add_u32 s22, s23, 8192
  buffer_load_dwordx4 a[144:147], v2, s[8:11], s22 offen offset:0
  buffer_load_dwordx4 a[148:151], v2, s[8:11], s22 offen offset:1024
  buffer_load_dwordx4 a[152:155], v2, s[8:11], s22 offen offset:2048
  buffer_load_dwordx4 a[156:159], v2, s[8:11], s22 offen offset:3072
  s_add_u32 s22, s23, 12288
  buffer_load_dwordx4 a[160:163], v2, s[8:11], s22 offen offset:0
  buffer_load_dwordx4 a[164:167], v2, s[8:11], s22 offen offset:1024
  buffer_load_dwordx4 a[168:171], v2, s[8:11], s22 offen offset:2048
  buffer_load_dwordx4 a[172:175], v2, s[8:11], s22 offen offset:3072
  s_add_u32 s22, s23, 16384
  buffer_load_dwordx4 a[176:179], v2, s[8:11], s22 offen offset:0
  buffer_load_dwordx4 a[180:183], v2, s[8:11], s22 offen offset:1024
  buffer_load_dwordx4 a[184:187], v2, s[8:11], s22 offen offset:2048
  buffer_load_dwordx4 a[188:191], v2, s[8:11], s22 offen offset:3072
  s_add_u32 s22, s23, 20480
  buffer_load_dwordx4 a[192:195], v2, s[8:11], s22 offen offset:0
  buffer_load_dwordx4 a[196:199], v2, s[8:11], s22 offen offset:1024
  buffer_load_dwordx4 a[200:203], v2, s[8:11], s22 offen offset:2048
  buffer_load_dwordx4 a[204:207], v2, s[8:11], s22 offen offset:3072
  s_add_u32 s22, s23, 24576
  buffer_load_dwordx4 a[208:211], v2, s[8:11], s22 offen offset:0
  buffer_load_dwordx4 a[212:215], v2, s[8:11], s22 offen offset:1024
  buffer_load_dwordx4 a[216:219], v2, s[8:11], s22 offen offset:2048
  buffer_load_dwordx4 a[220:223], v2, s[8:11], s22 offen offset:3072
  v_lshl_add_u32 v5, v3, 2, 0
  v_cmp_le_u32 s[40:41], v5, v4
  v_lshl_add_u32 v5, v3, 2, 1
  v_cmp_le_u32 s[42:43], v5, v4
  v_lshl_add_u32 v5, v3, 2, 2
  v_cmp_le_u32 s[44:45], v5, v4
  v_lshl_add_u32 v5, v3, 2, 3
  v_cmp_le_u32 s[46:47], v5, v4
  v_cmp_gt_u32 s[48:49], 2, v3
  v_mov_b32 v6, 0xff800000
  s_waitcnt vmcnt(0)
  v_mfma_f32_16x16x32_bf16 v[8:11], a[112:115], a[0:3], 0
  v_mfma_f32_16x16x32_bf16 v[12:15], a[112:115], a[56:59], 0
  v_mfma_f32_16x16x32_bf16 v[16:19], a[168:171], a[56:59], 0
  v_mfma_f32_16x16x32_bf16 v[8:11], a[116:119], a[4:7], v[8:11]
  v_mfma_f32_16x16x32_bf16 v[12:15], a[116:119], a[60:63], v[12:15]
  v_mfma_f32_16x16x32_bf16 v[16:19], a[172:175], a[60:63], v[16:19]
  v_mfma_f32_16x16x32_bf16 v[8:11], a[120:123], a[8:11], v[8:11]
  v_mfma_f32_16x16x32_bf16 v[12:15], a[120:123], a[64:67], v[12:15]
  v_mfma_f32_16x16x32_bf16 v[16:19], a[176:179], a[64:67], v[16:19]
  v_mfma_f32_16x16x32_bf16 v[8:11], a[124:127], a[12:15], v[8:11]
  v_mfma_f32_16x16x32_bf16 v[12:15], a[124:127], a[68:71], v[12:15]
  v_mfma_f32_16x16x32_bf16 v[16:19], a[180:183], a[68:71], v[16:19]
  v_mfma_f32_16x16x32_bf16 v[8:11], a[128:131], a[16:19], v[8:11]
  v_mfma_f32_16x16x32_bf16 v[12:15], a[128:131], a[72:75], v[12:15]
  v_mfma_f32_16x16x32_bf16 v[16:19], a[184:187], a[72:75], v[16:19]
  v_mfma_f32_16x16x32_bf16 v[8:11], a[132:135], a[20:23], v[8:11]
  v_mfma_f32_16x16x32_bf16 v[12:15], a[132:135], a[76:79], v[12:15]
  v_mfma_f32_16x16x32_bf16 v[16:19], a[188:191], a[76:79], v[16:19]
  v_mfma_f32_16x16x32_bf16 v[8:11], a[136:139], a[24:27], v[8:11]
  v_mfma_f32_16x16x32_bf16 v[12:15], a[136:139], a[80:83], v[12:15]
  v_mfma_f32_16x16x32_bf16 v[16:19], a[192:195], a[80:83], v[16:19]
  v_mfma_f32_16x16x32_bf16 v[8:11], a[140:143], a[28:31], v[8:11]
  v_mfma_f32_16x16x32_bf16 v[12:15], a[140:143], a[84:87], v[12:15]
  v_mfma_f32_16x16x32_bf16 v[16:19], a[196:199], a[84:87], v[16:19]
  v_mfma_f32_16x16x32_bf16 v[8:11], a[144:147], a[32:35], v[8:11]
  v_mfma_f32_16x16x32_bf16 v[12:15], a[144:147], a[88:91], v[12:15]
  v_mfma_f32_16x16x32_bf16 v[16:19], a[200:203], a[88:91], v[16:19]
  v_mfma_f32_16x16x32_bf16 v[8:11], a[148:151], a[36:39], v[8:11]
  v_mfma_f32_16x16x32_bf16 v[12:15], a[148:151], a[92:95], v[12:15]
  v_mfma_f32_16x16x32_bf16 v[16:19], a[204:207], a[92:95], v[16:19]
  v_mfma_f32_16x16x32_bf16 v[8:11], a[152:155], a[40:43], v[8:11]
  v_mfma_f32_16x16x32_bf16 v[12:15], a[152:155], a[96:99], v[12:15]
  v_mfma_f32_16x16x32_bf16 v[16:19], a[208:211], a[96:99], v[16:19]
  v_mfma_f32_16x16x32_bf16 v[8:11], a[156:159], a[44:47], v[8:11]
  v_mfma_f32_16x16x32_bf16 v[12:15], a[156:159], a[100:103], v[12:15]
  v_mfma_f32_16x16x32_bf16 v[16:19], a[212:215], a[100:103], v[16:19]
  v_mfma_f32_16x16x32_bf16 v[8:11], a[160:163], a[48:51], v[8:11]
  v_mfma_f32_16x16x32_bf16 v[12:15], a[160:163], a[104:107], v[12:15]
  v_mfma_f32_16x16x32_bf16 v[16:19], a[216:219], a[104:107], v[16:19]
  v_mfma_f32_16x16x32_bf16 v[8:11], a[164:167], a[52:55], v[8:11]
  v_mfma_f32_16x16x32_bf16 v[12:15], a[164:167], a[108:111], v[12:15]
  v_mfma_f32_16x16x32_bf16 v[16:19], a[220:223], a[108:111], v[16:19]
  s_mul_i32 s22, s20, 448
  v_mov_b32 v62, s22
  s_mov_b32 s30, 0
wp_pm:
  s_cmp_ge_u32 s17, 64
  s_cbranch_scc1 wp_pf
  buffer_load_dword v61, v62, s[8:11], s24 offen sc1
  s_waitcnt vmcnt(0)
  v_cmp_eq_u32 vcc, -1, v61
  s_cbranch_vccnz wp_pr
wp_pf:
  s_add_u32 s22, s24, 4096
  buffer_load_dwordx4 v[64:67], v2, s[8:11], s24 offen offset:0 sc1
  buffer_load_dwordx4 v[68:71], v2, s[8:11], s24 offen offset:1024 sc1
  buffer_load_dwordx4 v[72:75], v2, s[8:11], s24 offen offset:2048 sc1
  buffer_load_dwordx4 v[76:79], v2, s[8:11], s24 offen offset:3072 sc1
  buffer_load_dwordx4 v[80:83], v2, s[8:11], s22 offen offset:0 sc1
  buffer_load_dwordx4 v[84:87], v2, s[8:11], s22 offen offset:1024 sc1
  buffer_load_dwordx4 v[88:91], v2, s[8:11], s22 offen offset:2048 sc1
  s_waitcnt vmcnt(0)
  v_max_u32 v61, v64, v65
  v_max3_u32 v61, v61, v66, v67
  v_max3_u32 v61, v61, v68, v69
  v_max3_u32 v61, v61, v70, v71
  v_max3_u32 v61, v61, v72, v73
  v_max3_u32 v61, v61, v74, v75
  v_max3_u32 v61, v61, v76, v77
  v_max3_u32 v61, v61, v78, v79
  v_max3_u32 v61, v61, v80, v81
  v_max3_u32 v61, v61, v82, v83
  v_max3_u32 v61, v61, v84, v85
  v_max3_u32 v61, v61, v86, v87
  v_max3_u32 v61, v61, v88, v89
  v_max3_u32 v61, v61, v90, v91
  v_cmp_eq_u32 vcc, -1, v61
  s_cbranch_vccz wp_pk
wp_pr:
  s_sleep 4
  s_cmp_ge_u32 s17, 56
  s_cbranch_scc1 wp_pm_bo
  s_sleep 127
wp_pm_bo:
  s_add_u32 s30, s30, 1
  s_cmp_lt_u32 s30, 2000000
  s_cbranch_scc1 wp_pm
  s_branch wp_abort
wp_pk:
  buffer_load_dword v250, v251, s[8:11], 0 offen sc1
  v_mfma_f32_16x16x32_bf16 v[20:23], v[64:67], a[0:3], 0
  v_mfma_f32_16x16x32_bf16 v[24:27], v[64:67], a[4:7], 0
  v_mfma_f32_16x16x32_bf16 v[28:31], v[64:67], a[56:59], 0
  v_mfma_f32_16x16x32_bf16 v[32:35], v[64:67], a[60:63], 0
  v_mfma_f32_16x16x32_bf16 v[20:23], v[68:71], a[8:11], v[20:23]
  v_mfma_f32_16x16x32_bf16 v[24:27], v[68:71], a[12:15], v[24:27]
  v_mfma_f32_16x16x32_bf16 v[28:31], v[68:71], a[64:67], v[28:31]
  v_mfma_f32_16x16x32_bf16 v[32:35], v[68:71], a[68:71], v[32:35]
  v_mfma_f32_16x16x32_bf16 v[20:23], v[72:75], a[16:19], v[20:23]
  v_mfma_f32_16x16x32_bf16 v[24:27], v[72:75], a[20:23], v[24:27]
  v_mfma_f32_16x16x32_bf16 v[28:31], v[72:75], a[72:75], v[28:31]
  v_mfma_f32_16x16x32_bf16 v[32:35], v[72:75], a[76:79], v[32:35]
  v_mfma_f32_16x16x32_bf16 v[20:23], v[76:79], a[24:27], v[20:23]
  v_mfma_f32_16x16x32_bf16 v[24:27], v[76:79], a[28:31], v[24:27]
  v_mfma_f32_16x16x32_bf16 v[28:31], v[76:79], a[80:83], v[28:31]
  v_mfma_f32_16x16x32_bf16 v[32:35], v[76:79], a[84:87], v[32:35]
  v_mfma_f32_16x16x32_bf16 v[20:23], v[80:83], a[32:35], v[20:23]
  v_mfma_f32_16x16x32_bf16 v[24:27], v[80:83], a[36:39], v[24:27]
  v_mfma_f32_16x16x32_bf16 v[28:31], v[80:83], a[88:91], v[28:31]
  v_mfma_f32_16x16x32_bf16 v[32:35], v[80:83], a[92:95], v[32:35]
  v_mfma_f32_16x16x32_bf16 v[20:23], v[84:87], a[40:43], v[20:23]
  v_mfma_f32_16x16x32_bf16 v[24:27], v[84:87], a[44:47], v[24:27]
  v_mfma_f32_16x16x32_bf16 v[28:31], v[84:87], a[96:99], v[28:31]
  v_mfma_f32_16x16x32_bf16 v[32:35], v[84:87], a[100:103], v[32:35]
  v_mfma_f32_16x16x32_bf16 v[20:23], v[88:91], a[48:51], v[20:23]
  v_mfma_f32_16x16x32_bf16 v[24:27], v[88:91], a[52:55], v[24:27]
  v_mfma_f32_16x16x32_bf16 v[28:31], v[88:91], a[104:107], v[28:31]
  v_mfma_f32_16x16x32_bf16 v[32:35], v[88:91], a[108:111], v[32:35]
  s_lshl_b32 s25, s17, 1
  s_mul_i32 s25, s25, 20480
  s_add_u32 s25, s25, 84922368
  s_lshl_b32 s26, s20, 10
  s_add_u32 s26, s26, s25
  s_lshl_b32 s27, s18, 10
  s_add_u32 s27, s27, s25
  s_lshr_b32 s28, s16, 1
  s_lshl_b32 s28, s28, 3
  s_add_u32 s27, s27, s28
  s_add_u32 s27, s27, 16384
  s_and_b32 s28, s16, 1
  s_cmp_eq_u32 s28, 0
  s_cselect_b32 s50, -1, 0
  s_cselect_b32 s51, 0, -1
  v_cndmask_b32 v8, v6, v8, s[40:41]
  v_cndmask_b32 v9, v6, v9, s[42:43]
  v_cndmask_b32 v10, v6, v10, s[44:45]
  v_cndmask_b32 v11, v6, v11, s[46:47]
  v_cndmask_b32 v20, v24, v20, s[48:49]
  v_cndmask_b32 v21, v25, v21, s[48:49]
  v_cndmask_b32 v22, v26, v22, s[48:49]
  v_cndmask_b32 v23, v27, v23, s[48:49]
  v_mov_b32 v24, v20
  v_mov_b32 v25, v21
  v_mov_b32 v26, v22
  v_mov_b32 v27, v23
  v_permlane32_swap_b32 v20, v24
  v_permlane32_swap_b32 v21, v25
  v_permlane32_swap_b32 v22, v26
  v_permlane32_swap_b32 v23, v27
  v_add_f32 v20, v20, v24
  v_add_f32 v21, v21, v25
  v_add_f32 v22, v22, v26
  v_add_f32 v23, v23, v27
  v_max3_f32 v40, v8, v9, v10
  v_max3_f32 v40, v40, v11, v20
  v_max3_f32 v40, v40, v21, v22
  v_max_f32 v40, v40, v23
  v_mov_b32 v41, v40
  s_nop 1
  v_permlane16_swap_b32 v40, v41
  v_max_f32 v40, v40, v41
  v_mov_b32 v41, v40
  s_nop 1
  v_permlane32_swap_b32 v40, v41
  v_max_f32 v40, v40, v41
  v_sub_f32 v8, v8, v40
  v_sub_f32 v9, v9, v40
  v_sub_f32 v10, v10, v40
  v_sub_f32 v11, v11, v40
  v_sub_f32 v20, v20, v40
  v_sub_f32 v21, v21, v40
  v_sub_f32 v22, v22, v40
  v_sub_f32 v23, v23, v40
  v_exp_f32 v8, v8
  v_exp_f32 v9, v9
  v_exp_f32 v10, v10
  v_exp_f32 v11, v11
  v_exp_f32 v20, v20
  v_exp_f32 v21, v21
  v_exp_f32 v22, v22
  v_exp_f32 v23, v23
  v_add_f32 v42, v20, v21
  v_add_f32 v43, v22, v23
  v_add_f32 v42, v42, v43
  v_mul_f32 v42, 0.5, v42
  v_add_f32 v42, v42, v8
  v_add_f32 v42, v42, v9
  v_add_f32 v42, v42, v10
  v_add_f32 v42, v42, v11
  v_mov_b32 v41, v42
  s_nop 1
  v_permlane16_swap_b32 v42, v41
  v_add_f32 v42, v42, v41
  v_mov_b32 v41, v42
  s_nop 1
  v_permlane32_swap_b32 v42, v41
  v_add_f32 v42, v42, v41
  v_rcp_f32 v42, v42
  s_nop 0
  v_mul_f32 v8, v8, v42
  v_mul_f32 v9, v9, v42
  v_mul_f32 v10, v10, v42
  v_mul_f32 v11, v11, v42
  v_mul_f32 v20, v20, v42
  v_mul_f32 v21, v21, v42
  v_mul_f32 v22, v22, v42
  v_mul_f32 v23, v23, v42
  v_cvt_pk_bf16_f32 v44, v8, 0
  v_cvt_pk_bf16_f32 v45, v9, 0
  v_cvt_pk_bf16_f32 v46, v10, 0
  v_cvt_pk_bf16_f32 v47, v11, 0
  v_cvt_pk_bf16_f32 v48, v20, v21
  v_cvt_pk_bf16_f32 v49, v22, v23
  buffer_store_dwordx4 v[44:47], v2, s[8:11], s26 offen sc1
  s_mov_b64 exec, s[50:51]
  buffer_store_dwordx2 v[48:49], v2, s[8:11], s27 offen sc1
  s_mov_b64 exec, -1
  s_add_u32 s26, s26, 20480
  s_add_u32 s27, s27, 20480
  v_cndmask_b32 v16, v6, v16, s[40:41]
  v_cndmask_b32 v17, v6, v17, s[42:43]
  v_cndmask_b32 v18, v6, v18, s[44:45]
  v_cndmask_b32 v19, v6, v19, s[46:47]
  v_cndmask_b32 v28, v32, v28, s[48:49]
  v_cndmask_b32 v29, v33, v29, s[48:49]
  v_cndmask_b32 v30, v34, v30, s[48:49]
  v_cndmask_b32 v31, v35, v31, s[48:49]
  v_mov_b32 v32, v28
  v_mov_b32 v33, v29
  v_mov_b32 v34, v30
  v_mov_b32 v35, v31
  v_permlane32_swap_b32 v28, v32
  v_permlane32_swap_b32 v29, v33
  v_permlane32_swap_b32 v30, v34
  v_permlane32_swap_b32 v31, v35
  v_add_f32 v28, v28, v32
  v_add_f32 v29, v29, v33
  v_add_f32 v30, v30, v34
  v_add_f32 v31, v31, v35
  v_max3_f32 v40, v12, v13, v14
  v_max3_f32 v40, v40, v15, v16
  v_max3_f32 v40, v40, v17, v18
  v_max3_f32 v40, v40, v19, v28
  v_max3_f32 v40, v40, v29, v30
  v_max_f32 v40, v40, v31
  v_mov_b32 v41, v40
  s_nop 1
  v_permlane16_swap_b32 v40, v41
  v_max_f32 v40, v40, v41
  v_mov_b32 v41, v40
  s_nop 1
  v_permlane32_swap_b32 v40, v41
  v_max_f32 v40, v40, v41
  v_sub_f32 v12, v12, v40
  v_sub_f32 v13, v13, v40
  v_sub_f32 v14, v14, v40
  v_sub_f32 v15, v15, v40
  v_sub_f32 v16, v16, v40
  v_sub_f32 v17, v17, v40
  v_sub_f32 v18, v18, v40
  v_sub_f32 v19, v19, v40
  v_sub_f32 v28, v28, v40
  v_sub_f32 v29, v29, v40
  v_sub_f32 v30, v30, v40
  v_sub_f32 v31, v31, v40
  v_exp_f32 v12, v12
  v_exp_f32 v13, v13
  v_exp_f32 v14, v14
  v_exp_f32 v15, v15
  v_exp_f32 v16, v16
  v_exp_f32 v17, v17
  v_exp_f32 v18, v18
  v_exp_f32 v19, v19
  v_exp_f32 v28, v28
  v_exp_f32 v29, v29
  v_exp_f32 v30, v30
  v_exp_f32 v31, v31
  v_add_f32 v42, v28, v29
  v_add_f32 v43, v30, v31
  v_add_f32 v42, v42, v43
  v_mul_f32 v42, 0.5, v42
  v_add_f32 v42, v42, v12
  v_add_f32 v42, v42, v13
  v_add_f32 v42, v42, v14
  v_add_f32 v42, v42, v15
  v_add_f32 v42, v42, v16
  v_add_f32 v42, v42, v17
  v_add_f32 v42, v42, v18
  v_add_f32 v42, v42, v19
  v_mov_b32 v41, v42
  s_nop 1
  v_permlane16_swap_b32 v42, v41
  v_add_f32 v42, v42, v41
  v_mov_b32 v41, v42
  s_nop 1
  v_permlane32_swap_b32 v42, v41
  v_add_f32 v42, v42, v41
  v_rcp_f32 v42, v42
  s_nop 0
  v_mul_f32 v12, v12, v42
  v_mul_f32 v13, v13, v42
  v_mul_f32 v14, v14, v42
  v_mul_f32 v15, v15, v42
  v_mul_f32 v16, v16, v42
  v_mul_f32 v17, v17, v42
  v_mul_f32 v18, v18, v42
  v_mul_f32 v19, v19, v42
  v_mul_f32 v28, v28, v42
  v_mul_f32 v29, v29, v42
  v_mul_f32 v30, v30, v42
  v_mul_f32 v31, v31, v42
  v_cvt_pk_bf16_f32 v52, v12, v16
  v_cvt_pk_bf16_f32 v53, v13, v17
  v_cvt_pk_bf16_f32 v54, v14, v18
  v_cvt_pk_bf16_f32 v55, v15, v19
  v_cvt_pk_bf16_f32 v56, v28, v29
  v_cvt_pk_bf16_f32 v57, v30, v31
  buffer_store_dwordx4 v[52:55], v2, s[8:11], s26 offen sc1
  s_mov_b64 exec, s[50:51]
  buffer_store_dwordx2 v[56:57], v2, s[8:11], s27 offen sc1
  s_mov_b64 exec, -1
  s_lshl_b32 s25, s17, 2
  s_add_u32 s25, s25, 88003584
  v_mov_b32 v5, 1
  v_mov_b32 v6, 0
  s_waitcnt vmcnt(0)
  s_mov_b64 exec, 1
  buffer_atomic_add v5, v6, s[8:11], s25 offen
  s_mov_b64 exec, -1
  s_branch wk_loop
wk_toko:
  s_lshl_b32 s20, s18, 2
  s_add_u32 s20, s20, s16
  s_mul_i32 s24, s20, 65
  s_add_u32 s24, s24, s17
  s_lshl_b32 s24, s24, 13
  s_add_u32 s24, s24, 76410880
  s_lshl_b32 s21, s20, 6
  s_add_u32 s21, s21, s17
  s_mul_i32 s21, s21, 28672
  s_add_u32 s21, s21, 42205184
  s_lshl_b32 s25, s17, 1
  s_mul_i32 s25, s25, 20480
  s_add_u32 s25, s25, 84922368
  v_mov_b32 v5, v2
  v_min_u32 v6, 11, v4
  v_mad_u32_u24 v6, v3, 12, v6
  v_lshlrev_b32 v6, 4, v6
  v_add_u32 v6, 1024, v6
  v_lshrrev_b32 v8, 1, v3
  v_lshl_add_u32 v8, v8, 4, v4
  v_lshlrev_b32 v8, 4, v8
  v_and_b32 v9, 1, v3
  v_lshl_add_u32 v7, v9, 3, v8
  s_lshr_b32 s26, s17, 3
  s_lshl_b32 s26, s26, 4
  s_add_u32 s26, s26, s20
  s_lshl_b32 s26, s26, 2
  s_add_u32 s26, s26, 88002560
  v_mov_b32 v60, 0
  s_mov_b32 s30, 0
wo_wv:
  buffer_load_dword v61, v60, s[8:11], s26 offen sc1
  s_waitcnt vmcnt(0)
  v_cmp_ne_u32 vcc, 56, v61
  s_cbranch_vccz wo_wv_ok
  s_sleep 4
  s_cmp_ge_u32 s17, 56
  s_cbranch_scc1 wo_wv_bo
  s_sleep 127
wo_wv_bo:
  s_add_u32 s30, s30, 1
  s_cmp_lt_u32 s30, 2000000
  s_cbranch_scc1 wo_wv
  s_branch wo_abort
wo_wv_ok:
  s_add_u32 s22, s21, 0
  buffer_load_dwordx4 a[0:3], v5, s[8:11], s22 offen offset:0 sc1
  buffer_load_dwordx4 a[4:7], v6, s[8:11], s22 offen offset:0 sc1
  buffer_load_dwordx4 a[8:11], v5, s[8:11], s22 offen offset:1792 sc1
  buffer_load_dwordx4 a[12:15], v6, s[8:11], s22 offen offset:1792 sc1
  s_add_u32 s22, s21, 3584
  buffer_load_dwordx4 a[16:19], v5, s[8:11], s22 offen offset:0 sc1
  buffer_load_dwordx4 a[20:23], v6, s[8:11], s22 offen offset:0 sc1
  buffer_load_dwordx4 a[24:27], v5, s[8:11], s22 offen offset:1792 sc1
  buffer_load_dwordx4 a[28:31], v6, s[8:11], s22 offen offset:1792 sc1
  s_add_u32 s22, s21, 7168
  buffer_load_dwordx4 a[32:35], v5, s[8:11], s22 offen offset:0 sc1
  buffer_load_dwordx4 a[36:39], v6, s[8:11], s22 offen offset:0 sc1
  buffer_load_dwordx4 a[40:43], v5, s[8:11], s22 offen offset:1792 sc1
  buffer_load_dwordx4 a[44:47], v6, s[8:11], s22 offen offset:1792 sc1
  s_add_u32 s22, s21, 10752
  buffer_load_dwordx4 a[48:51], v5, s[8:11], s22 offen offset:0 sc1
  buffer_load_dwordx4 a[52:55], v6, s[8:11], s22 offen offset:0 sc1
  buffer_load_dwordx4 a[56:59], v5, s[8:11], s22 offen offset:1792 sc1
  buffer_load_dwordx4 a[60:63], v6, s[8:11], s22 offen offset:1792 sc1
  s_add_u32 s22, s21, 14336
  buffer_load_dwordx4 a[64:67], v5, s[8:11], s22 offen offset:0 sc1
  buffer_load_dwordx4 a[68:71], v6, s[8:11], s22 offen offset:0 sc1
  buffer_load_dwordx4 a[72:75], v5, s[8:11], s22 offen offset:1792 sc1
  buffer_load_dwordx4 a[76:79], v6, s[8:11], s22 offen offset:1792 sc1
  s_add_u32 s22, s21, 17920
  buffer_load_dwordx4 a[80:83], v5, s[8:11], s22 offen offset:0 sc1
  buffer_load_dwordx4 a[84:87], v6, s[8:11], s22 offen offset:0 sc1
  buffer_load_dwordx4 a[88:91], v5, s[8:11], s22 offen offset:1792 sc1
  buffer_load_dwordx4 a[92:95], v6, s[8:11], s22 offen offset:1792 sc1
  s_add_u32 s22, s21, 21504
  buffer_load_dwordx4 a[96:99], v5, s[8:11], s22 offen offset:0 sc1
  buffer_load_dwordx4 a[100:103], v6, s[8:11], s22 offen offset:0 sc1
  buffer_load_dwordx4 a[104:107], v5, s[8:11], s22 offen offset:1792 sc1
  buffer_load_dwordx4 a[108:111], v6, s[8:11], s22 offen offset:1792 sc1
  s_add_u32 s22, s21, 25088
  buffer_load_dwordx4 a[112:115], v5, s[8:11], s22 offen offset:0 sc1
  buffer_load_dwordx4 a[116:119], v6, s[8:11], s22 offen offset:0 sc1
  buffer_load_dwordx4 a[120:123], v5, s[8:11], s22 offen offset:1792 sc1
  buffer_load_dwordx4 a[124:127], v6, s[8:11], s22 offen offset:1792 sc1
  s_lshl_b32 s26, s20, 6
  s_add_u32 s26, s26, s17
  s_lshl_b32 s26, s26, 4
  s_add_u32 s26, s26, 88003840
  v_lshlrev_b32 v60, 2, v3
  s_mov_b32 s30, 0
wo_wt:
  buffer_load_dword v61, v60, s[8:11], s26 offen sc1
  s_waitcnt vmcnt(0)
  v_cmp_ne_u32 vcc, 1, v61
  s_cbranch_vccz wo_wt_ok
  s_sleep 4
  s_cmp_ge_u32 s17, 56
  s_cbranch_scc1 wo_wt_bo
  s_sleep 127
wo_wt_bo:
  s_add_u32 s30, s30, 1
  s_cmp_lt_u32 s30, 2000000
  s_cbranch_scc1 wo_wt
  s_branch wo_abort
wo_wt_ok:
  s_add_u32 s22, s24, 0
  buffer_load_dwordx2 v[28:29], v7, s[8:11], s22 offen offset:0 sc1
  buffer_load_dwordx2 v[30:31], v7, s[8:11], s22 offen offset:512 sc1
  buffer_load_dwordx2 v[32:33], v7, s[8:11], s22 offen offset:1024 sc1
  buffer_load_dwordx2 v[34:35], v7, s[8:11], s22 offen offset:1536 sc1
  buffer_load_dwordx2 v[36:37], v7, s[8:11], s22 offen offset:2048 sc1
  buffer_load_dwordx2 v[38:39], v7, s[8:11], s22 offen offset:2560 sc1
  buffer_load_dwordx2 v[40:41], v7, s[8:11], s22 offen offset:3072 sc1
  buffer_load_dwordx2 v[42:43], v7, s[8:11], s22 offen offset:3584 sc1
  s_add_u32 s22, s24, 4096
  buffer_load_dwordx2 v[44:45], v7, s[8:11], s22 offen offset:0 sc1
  buffer_load_dwordx2 v[46:47], v7, s[8:11], s22 offen offset:512 sc1
  buffer_load_dwordx2 v[48:49], v7, s[8:11], s22 offen offset:1024 sc1
  buffer_load_dwordx2 v[50:51], v7, s[8:11], s22 offen offset:1536 sc1
  buffer_load_dwordx2 v[52:53], v7, s[8:11], s22 offen offset:2048 sc1
  buffer_load_dwordx2 v[54:55], v7, s[8:11], s22 offen offset:2560 sc1
  buffer_load_dwordx2 v[56:57], v7, s[8:11], s22 offen offset:3072 sc1
  buffer_load_dwordx2 v[58:59], v7, s[8:11], s22 offen offset:3584 sc1
  s_lshl_b32 s26, s17, 2
  s_add_u32 s26, s26, 88003584
  v_mov_b32 v60, 0
  s_mov_b32 s30, 0
wo_wp:
  buffer_load_dword v61, v60, s[8:11], s26 offen sc1
  s_waitcnt vmcnt(0)
  v_cmp_ne_u32 vcc, 16, v61
  s_cbranch_vccz wo_wp_ok
  s_sleep 2
  s_cmp_ge_u32 s17, 56
  s_cbranch_scc1 wo_wp_bo
  s_sleep 127
wo_wp_bo:
  s_add_u32 s30, s30, 1
  s_cmp_lt_u32 s30, 2000000
  s_cbranch_scc1 wo_wp
  s_branch wo_abort
wo_wp_ok:
  buffer_load_dword v250, v251, s[8:11], 0 offen sc1
  s_add_u32 s26, s25, 0
  s_add_u32 s27, s25, 20480
  buffer_load_dwordx4 a[128:131], v2, s[8:11], s26 offen offset:0 sc1
  buffer_load_dwordx4 a[132:135], v2, s[8:11], s27 offen offset:0 sc1
  buffer_load_dwordx4 a[136:139], v2, s[8:11], s26 offen offset:1024 sc1
  buffer_load_dwordx4 a[140:143], v2, s[8:11], s27 offen offset:1024 sc1
  buffer_load_dwordx4 a[144:147], v2, s[8:11], s26 offen offset:2048 sc1
  buffer_load_dwordx4 a[148:151], v2, s[8:11], s27 offen offset:2048 sc1
  buffer_load_dwordx4 a[152:155], v2, s[8:11], s26 offen offset:3072 sc1
  buffer_load_dwordx4 a[156:159], v2, s[8:11], s27 offen offset:3072 sc1
  s_add_u32 s26, s25, 4096
  s_add_u32 s27, s25, 24576
  buffer_load_dwordx4 a[160:163], v2, s[8:11], s26 offen offset:0 sc1
  buffer_load_dwordx4 a[164:167], v2, s[8:11], s27 offen offset:0 sc1
  buffer_load_dwordx4 a[168:171], v2, s[8:11], s26 offen offset:1024 sc1
  buffer_load_dwordx4 a[172:175], v2, s[8:11], s27 offen offset:1024 sc1
  buffer_load_dwordx4 a[176:179], v2, s[8:11], s26 offen offset:2048 sc1
  buffer_load_dwordx4 a[180:183], v2, s[8:11], s27 offen offset:2048 sc1
  buffer_load_dwordx4 a[184:187], v2, s[8:11], s26 offen offset:3072 sc1
  buffer_load_dwordx4 a[188:191], v2, s[8:11], s27 offen offset:3072 sc1
  s_add_u32 s26, s25, 8192
  s_add_u32 s27, s25, 28672
  buffer_load_dwordx4 a[192:195], v2, s[8:11], s26 offen offset:0 sc1
  buffer_load_dwordx4 a[196:199], v2, s[8:11], s27 offen offset:0 sc1
  buffer_load_dwordx4 a[200:203], v2, s[8:11], s26 offen offset:1024 sc1
  buffer_load_dwordx4 a[204:207], v2, s[8:11], s27 offen offset:1024 sc1
  buffer_load_dwordx4 a[208:211], v2, s[8:11], s26 offen offset:2048 sc1
  buffer_load_dwordx4 a[212:215], v2, s[8:11], s27 offen offset:2048 sc1
  buffer_load_dwordx4 a[216:219], v2, s[8:11], s26 offen offset:3072 sc1
  buffer_load_dwordx4 a[220:223], v2, s[8:11], s27 offen offset:3072 sc1
  s_add_u32 s26, s25, 12288
  s_add_u32 s27, s25, 32768
  buffer_load_dwordx4 a[224:227], v2, s[8:11], s26 offen offset:0 sc1
  buffer_load_dwordx4 a[228:231], v2, s[8:11], s27 offen offset:0 sc1
  buffer_load_dwordx4 a[232:235], v2, s[8:11], s26 offen offset:1024 sc1
  buffer_load_dwordx4 a[236:239], v2, s[8:11], s27 offen offset:1024 sc1
  buffer_load_dwordx4 a[240:243], v2, s[8:11], s26 offen offset:2048 sc1
  buffer_load_dwordx4 a[244:247], v2, s[8:11], s27 offen offset:2048 sc1
  buffer_load_dwordx4 a[248:251], v2, s[8:11], s26 offen offset:3072 sc1
  buffer_load_dwordx4 a[252:255], v2, s[8:11], s27 offen offset:3072 sc1
  s_add_u32 s26, s25, 16384
  s_add_u32 s27, s25, 36864
  buffer_load_dwordx4 v[64:67], v2, s[8:11], s26 offen offset:0 sc1
  buffer_load_dwordx4 v[68:71], v2, s[8:11], s27 offen offset:0 sc1
  buffer_load_dwordx4 v[72:75], v2, s[8:11], s26 offen offset:1024 sc1
  buffer_load_dwordx4 v[76:79], v2, s[8:11], s27 offen offset:1024 sc1
  buffer_load_dwordx4 v[80:83], v2, s[8:11], s26 offen offset:2048 sc1
  buffer_load_dwordx4 v[84:87], v2, s[8:11], s27 offen offset:2048 sc1
  buffer_load_dwordx4 v[88:91], v2, s[8:11], s26 offen offset:3072 sc1
  buffer_load_dwordx4 v[92:95], v2, s[8:11], s27 offen offset:3072 sc1
  s_waitcnt vmcnt(38)
  v_mfma_f32_16x16x32_bf16 v[12:15], a[0:3], a[128:131], 0
  v_mfma_f32_16x16x32_bf16 v[16:19], a[0:3], a[132:135], 0
  v_mfma_f32_16x16x32_bf16 v[20:23], a[4:7], a[128:131], 0
  v_mfma_f32_16x16x32_bf16 v[24:27], a[4:7], a[132:135], 0
  s_waitcnt vmcnt(36)
  v_mfma_f32_16x16x32_bf16 v[12:15], a[8:11], a[136:139], v[12:15]
  v_mfma_f32_16x16x32_bf16 v[16:19], a[8:11], a[140:143], v[16:19]
  v_mfma_f32_16x16x32_bf16 v[20:23], a[12:15], a[136:139], v[20:23]
  v_mfma_f32_16x16x32_bf16 v[24:27], a[12:15], a[140:143], v[24:27]
  s_waitcnt vmcnt(34)
  v_mfma_f32_16x16x32_bf16 v[12:15], a[16:19], a[144:147], v[12:15]
  v_mfma_f32_16x16x32_bf16 v[16:19], a[16:19], a[148:151], v[16:19]
  v_mfma_f32_16x16x32_bf16 v[20:23], a[20:23], a[144:147], v[20:23]
  v_mfma_f32_16x16x32_bf16 v[24:27], a[20:23], a[148:151], v[24:27]
  s_waitcnt vmcnt(32)
  v_mfma_f32_16x16x32_bf16 v[12:15], a[24:27], a[152:155], v[12:15]
  v_mfma_f32_16x16x32_bf16 v[16:19], a[24:27], a[156:159], v[16:19]
  v_mfma_f32_16x16x32_bf16 v[20:23], a[28:31], a[152:155], v[20:23]
  v_mfma_f32_16x16x32_bf16 v[24:27], a[28:31], a[156:159], v[24:27]
  s_waitcnt vmcnt(30)
  v_mfma_f32_16x16x32_bf16 v[12:15], a[32:35], a[160:163], v[12:15]
  v_mfma_f32_16x16x32_bf16 v[16:19], a[32:35], a[164:167], v[16:19]
  v_mfma_f32_16x16x32_bf16 v[20:23], a[36:39], a[160:163], v[20:23]
  v_mfma_f32_16x16x32_bf16 v[24:27], a[36:39], a[164:167], v[24:27]
  s_waitcnt vmcnt(28)
  v_mfma_f32_16x16x32_bf16 v[12:15], a[40:43], a[168:171], v[12:15]
  v_mfma_f32_16x16x32_bf16 v[16:19], a[40:43], a[172:175], v[16:19]
  v_mfma_f32_16x16x32_bf16 v[20:23], a[44:47], a[168:171], v[20:23]
  v_mfma_f32_16x16x32_bf16 v[24:27], a[44:47], a[172:175], v[24:27]
  s_waitcnt vmcnt(26)
  v_mfma_f32_16x16x32_bf16 v[12:15], a[48:51], a[176:179], v[12:15]
  v_mfma_f32_16x16x32_bf16 v[16:19], a[48:51], a[180:183], v[16:19]
  v_mfma_f32_16x16x32_bf16 v[20:23], a[52:55], a[176:179], v[20:23]
  v_mfma_f32_16x16x32_bf16 v[24:27], a[52:55], a[180:183], v[24:27]
  s_waitcnt vmcnt(24)
  v_mfma_f32_16x16x32_bf16 v[12:15], a[56:59], a[184:187], v[12:15]
  v_mfma_f32_16x16x32_bf16 v[16:19], a[56:59], a[188:191], v[16:19]
  v_mfma_f32_16x16x32_bf16 v[20:23], a[60:63], a[184:187], v[20:23]
  v_mfma_f32_16x16x32_bf16 v[24:27], a[60:63], a[188:191], v[24:27]
  s_waitcnt vmcnt(22)
  v_mfma_f32_16x16x32_bf16 v[12:15], a[64:67], a[192:195], v[12:15]
  v_mfma_f32_16x16x32_bf16 v[16:19], a[64:67], a[196:199], v[16:19]
  v_mfma_f32_16x16x32_bf16 v[20:23], a[68:71], a[192:195], v[20:23]
  v_mfma_f32_16x16x32_bf16 v[24:27], a[68:71], a[196:199], v[24:27]
  s_waitcnt vmcnt(20)
  v_mfma_f32_16x16x32_bf16 v[12:15], a[72:75], a[200:203], v[12:15]
  v_mfma_f32_16x16x32_bf16 v[16:19], a[72:75], a[204:207], v[16:19]
  v_mfma_f32_16x16x32_bf16 v[20:23], a[76:79], a[200:203], v[20:23]
  v_mfma_f32_16x16x32_bf16 v[24:27], a[76:79], a[204:207], v[24:27]
  s_waitcnt vmcnt(18)
  v_mfma_f32_16x16x32_bf16 v[12:15], a[80:83], a[208:211], v[12:15]
  v_mfma_f32_16x16x32_bf16 v[16:19], a[80:83], a[212:215], v[16:19]
  v_mfma_f32_16x16x32_bf16 v[20:23], a[84:87], a[208:211], v[20:23]
  v_mfma_f32_16x16x32_bf16 v[24:27], a[84:87], a[212:215], v[24:27]
  s_waitcnt vmcnt(16)
  v_mfma_f32_16x16x32_bf16 v[12:15], a[88:91], a[216:219], v[12:15]
  v_mfma_f32_16x16x32_bf16 v[16:19], a[88:91], a[220:223], v[16:19]
  v_mfma_f32_16x16x32_bf16 v[20:23], a[92:95], a[216:219], v[20:23]
  v_mfma_f32_16x16x32_bf16 v[24:27], a[92:95], a[220:223], v[24:27]
  s_waitcnt vmcnt(14)
  v_mfma_f32_16x16x32_bf16 v[12:15], a[96:99], a[224:227], v[12:15]
  v_mfma_f32_16x16x32_bf16 v[16:19], a[96:99], a[228:231], v[16:19]
  v_mfma_f32_16x16x32_bf16 v[20:23], a[100:103], a[224:227], v[20:23]
  v_mfma_f32_16x16x32_bf16 v[24:27], a[100:103], a[228:231], v[24:27]
  s_waitcnt vmcnt(12)
  v_mfma_f32_16x16x32_bf16 v[12:15], a[104:107], a[232:235], v[12:15]
  v_mfma_f32_16x16x32_bf16 v[16:19], a[104:107], a[236:239], v[16:19]
  v_mfma_f32_16x16x32_bf16 v[20:23], a[108:111], a[232:235], v[20:23]
  v_mfma_f32_16x16x32_bf16 v[24:27], a[108:111], a[236:239], v[24:27]
  s_waitcnt vmcnt(10)
  v_mfma_f32_16x16x32_bf16 v[12:15], a[112:115], a[240:243], v[12:15]
  v_mfma_f32_16x16x32_bf16 v[16:19], a[112:115], a[244:247], v[16:19]
  v_mfma_f32_16x16x32_bf16 v[20:23], a[116:119], a[240:243], v[20:23]
  v_mfma_f32_16x16x32_bf16 v[24:27], a[116:119], a[244:247], v[24:27]
  s_waitcnt vmcnt(8)
  v_mfma_f32_16x16x32_bf16 v[12:15], a[120:123], a[248:251], v[12:15]
  v_mfma_f32_16x16x32_bf16 v[16:19], a[120:123], a[252:255], v[16:19]
  v_mfma_f32_16x16x32_bf16 v[20:23], a[124:127], a[248:251], v[20:23]
  v_mfma_f32_16x16x32_bf16 v[24:27], a[124:127], a[252:255], v[24:27]
  s_waitcnt vmcnt(0)
  v_mfma_f32_16x16x32_bf16 v[12:15], v[28:31], v[64:67], v[12:15]
  v_mfma_f32_16x16x32_bf16 v[16:19], v[28:31], v[68:71], v[16:19]
  v_mfma_f32_16x16x32_bf16 v[20:23], v[32:35], v[64:67], v[20:23]
  v_mfma_f32_16x16x32_bf16 v[24:27], v[32:35], v[68:71], v[24:27]
  v_mfma_f32_16x16x32_bf16 v[12:15], v[36:39], v[72:75], v[12:15]
  v_mfma_f32_16x16x32_bf16 v[16:19], v[36:39], v[76:79], v[16:19]
  v_mfma_f32_16x16x32_bf16 v[20:23], v[40:43], v[72:75], v[20:23]
  v_mfma_f32_16x16x32_bf16 v[24:27], v[40:43], v[76:79], v[24:27]
  v_mfma_f32_16x16x32_bf16 v[12:15], v[44:47], v[80:83], v[12:15]
  v_mfma_f32_16x16x32_bf16 v[16:19], v[44:47], v[84:87], v[16:19]
  v_mfma_f32_16x16x32_bf16 v[20:23], v[48:51], v[80:83], v[20:23]
  v_mfma_f32_16x16x32_bf16 v[24:27], v[48:51], v[84:87], v[24:27]
  v_mfma_f32_16x16x32_bf16 v[12:15], v[52:55], v[88:91], v[12:15]
  v_mfma_f32_16x16x32_bf16 v[16:19], v[52:55], v[92:95], v[16:19]
  v_mfma_f32_16x16x32_bf16 v[20:23], v[56:59], v[88:91], v[20:23]
  v_mfma_f32_16x16x32_bf16 v[24:27], v[56:59], v[92:95], v[24:27]
  v_mul_u32_u24 v9, 1792, v4
  v_lshl_add_u32 v9, v3, 3, v9
  s_lshl_b32 s22, s20, 5
  v_add_u32 v8, s22, v9
  s_mul_i32 s22, s20, 24
  s_add_u32 s22, s22, 512
  v_add_u32 v9, s22, v9
  v_mov_b32 v10, 0x40000000
  v_cmp_eq_u32 vcc, 3, v3
  s_nop 1
  v_cndmask_b32 v9, v9, v10, vcc
  s_mul_i32 s26, s17, 57344
  s_add_u32 s26, s26, 896
  s_add_u32 s27, s26, 28672
  v_cvt_pk_bf16_f32 v96, v12, v13
  v_cvt_pk_bf16_f32 v97, v14, v15
  buffer_store_dwordx2 v[96:97], v8, s[92:95], s26 offen
  v_cvt_pk_bf16_f32 v98, v20, v21
  v_cvt_pk_bf16_f32 v99, v22, v23
  buffer_store_dwordx2 v[98:99], v9, s[92:95], s26 offen
  v_cvt_pk_bf16_f32 v100, v16, v17
  v_cvt_pk_bf16_f32 v101, v18, v19
  buffer_store_dwordx2 v[100:101], v8, s[92:95], s27 offen
  v_cvt_pk_bf16_f32 v102, v24, v25
  v_cvt_pk_bf16_f32 v103, v26, v27
  buffer_store_dwordx2 v[102:103], v9, s[92:95], s27 offen
  s_branch wk_loop
wp_abort:
wo_abort:
  s_branch cA_abort
wk_done:
ch_end:
  s_endpgm

.section .rodata,"a"
.p2align 6
.amdhsa_kernel prep_kernel
  .amdhsa_next_free_vgpr 272
  .amdhsa_next_free_sgpr 102
  .amdhsa_accum_offset 256
  .amdhsa_group_segment_fixed_size 0
  .amdhsa_kernarg_size 136
  .amdhsa_user_sgpr_count 2
  .amdhsa_user_sgpr_kernarg_segment_ptr 1
  .amdhsa_system_sgpr_workgroup_id_x 1
.end_amdhsa_kernel
.p2align 6
.amdhsa_kernel main_kernel
  .amdhsa_next_free_vgpr 512
  .amdhsa_next_free_sgpr 102
  .amdhsa_accum_offset 256
  .amdhsa_group_segment_fixed_size 0
  .amdhsa_kernarg_size 136
  .amdhsa_user_sgpr_count 2
  .amdhsa_user_sgpr_kernarg_segment_ptr 1
  .amdhsa_system_sgpr_workgroup_id_x 1
.end_amdhsa_kernel
```

```asm
; @launch kernel=main_kernel grid=(256,1,1) block=(256,1,1) lds=163840
.amdgcn_target "amdgcn-amd-amdhsa--gfx950"
.text
.globl main_kernel
.p2align 8
.type main_kernel,@function
main_kernel:
  s_cmp_ge_u32 s2, 256
  s_cbranch_scc1 ch_end
  s_load_dwordx2 s[4:5], s[0:1], 120
  s_load_dwordx2 s[6:7], s[0:1], 128
  s_load_dwordx8 s[40:47], s[0:1], 72
  s_load_dwordx4 s[48:51], s[0:1], 56
  s_getpc_b64 s[98:99]
pf_main_kernel_1:
  s_sub_u32 s98, s98, pf_main_kernel_1-main_kernel
  s_subb_u32 s99, s99, 0
  v_lshlrev_b32 v60, 7, v0
  v_min_u32 v61, ch_end-main_kernel-4, v60
  global_load_dword v62, v61, s[98:99]
  v_add_u32 v60, 32768, v60
  v_min_u32 v61, ch_end-main_kernel-4, v60
  global_load_dword v62, v61, s[98:99]
  v_add_u32 v60, 32768, v60
  v_min_u32 v61, ch_end-main_kernel-4, v60
  global_load_dword v62, v61, s[98:99]
  v_add_u32 v60, 32768, v60
  v_min_u32 v61, ch_end-main_kernel-4, v60
  global_load_dword v62, v61, s[98:99]
  v_add_u32 v60, 32768, v60
  s_mov_b32 s32, 0
  s_getreg_b32 s3, hwreg(HW_REG_XCC_ID)
  s_and_b32 s3, s3, 15
  v_lshrrev_b32 v1, 6, v0
  s_nop 0
  v_readfirstlane_b32 s16, v1
  s_waitcnt lgkmcnt(0)
  s_mov_b32 s8, s6
  s_and_b32 s9, s7, 0xffff
  s_mov_b32 s10, 0x10000000
  s_mov_b32 s11, 0x20000
  s_mov_b32 s12, s4
  s_and_b32 s13, s5, 0xffff
  s_mov_b32 s14, 256
  s_mov_b32 s15, 0x20000
  v_mov_b32 v252, 0x40000000
  v_cmp_eq_u32 vcc, 0, v0
  s_nop 1
  v_cndmask_b32 v252, v252, v0, vcc
  s_cmp_lg_u32 s3, 0
  s_cbranch_scc1 ch_worker
  s_cmp_lg_u32 s16, 0
  s_cbranch_scc1 ch_worker
  v_mov_b32 v249, 1
  s_mov_b64 exec, 1
  buffer_atomic_add v249, v252, s[12:15], 0 offen sc0
  s_mov_b64 exec, -1
  s_branch ch_worker
  s_cmp_lg_u32 s3, 0
  s_cbranch_scc1 ch_worker
  v_mov_b32 v4, 1
  s_mov_b32 s18, 0
ch_take:
  v_mov_b32 v5, 0
  v_mov_b32 v6, 160000
  s_barrier
  s_cmp_lg_u32 s16, 0
  s_cbranch_scc1 ch_el1
  s_mov_b64 exec, 1
  buffer_atomic_add v4, v5, s[12:15], 0 offen sc0
  s_waitcnt vmcnt(0)
  ds_write_b32 v6, v4
  s_waitcnt lgkmcnt(0)
  s_mov_b64 exec, -1
ch_el1:
  s_barrier
  ds_read_b32 v4, v6
  s_waitcnt lgkmcnt(0)
  v_readfirstlane_b32 s17, v4
  s_and_b32 s17, s17, 0xffff
  s_cmp_lt_u32 s17, 32
  s_cbranch_scc1 ch_role
  v_and_b32 v1, 63, v0
  v_lshlrev_b32 v2, 4, v1
  v_lshrrev_b32 v3, 4, v1
  v_and_b32 v4, 15, v1
  s_branch wp_all
  s_cmp_eq_u32 s18, 0
  s_cbranch_scc1 ch_worker
  s_branch ch_end
ch_role:
  s_mov_b32 s91, s17
ch_role2:
  s_mov_b32 s17, s91
  v_and_b32 v1, 63, v0
  v_lshlrev_b32 v2, 4, v1
  v_lshrrev_b32 v116, 4, v1
  v_and_b32 v117, 15, v1
  v_mov_b32 v3, 0x4444
  v_mov_b32 v118, 0xeeee
  v_cmp_lt_u32 vcc, 7, v117
  s_nop 1
  v_cndmask_b32 v3, v3, v118, vcc
  s_mov_b32 s19, 0
  s_mov_b32 s18, 1
  s_mov_b32 s20, 75235328
  s_mov_b32 s21, 75252992
  s_mov_b32 s23, 75239424
  s_lshr_b32 s89, s17, 4
  s_lshl_b32 s89, s89, 2
  s_add_u32 s89, s89, s16
  s_and_b32 s17, s17, 15
  s_cmp_eq_u32 s89, 0
  s_cbranch_scc1 ch_init0
  s_cmp_eq_u32 s89, 1
  s_cbranch_scc1 ch_init1
  s_cmp_eq_u32 s89, 2
  s_cbranch_scc1 ch_init2
  s_cmp_eq_u32 s89, 3
  s_cbranch_scc1 ch_init3
  s_cmp_eq_u32 s89, 4
  s_cbranch_scc1 ch_init4
  s_cmp_eq_u32 s89, 5
  s_cbranch_scc1 ch_init5
  s_cmp_eq_u32 s89, 6
  s_cbranch_scc1 ch_init6
  s_cmp_eq_u32 s89, 7
  s_cbranch_scc1 ch_init7
  s_branch ch_end
ch_init0:
  s_mul_i32 s31, s17, 401408
  s_add_u32 s31, s31, 0
  s_mov_b32 s30, 0
ch_wr0:
  buffer_load_dword v65, off, s[12:15], 0 offset:132 sc1
  s_waitcnt vmcnt(0)
  v_cmp_ne_u32 vcc, 1, v65
  s_cbranch_vccz ch_wr0_ok
  s_sleep 8
  s_add_u32 s30, s30, 1
  s_cmp_lt_u32 s30, 400000
  s_cbranch_scc1 ch_wr0
  s_branch cA_abort
ch_wr0_ok:
  s_lshl_b32 s27, s17, 7
  s_add_u32 s27, s27, 88062464
  s_mov_b32 s28, 129
  s_mov_b32 s30, 0
ch_wa0:
  buffer_load_dword v65, off, s[8:11], s27  sc1
  s_waitcnt vmcnt(0)
  v_and_b32 v66, s28, v65
  v_cmp_ne_u32 vcc, s28, v66
  s_cbranch_vccz ch_wa0_ok
  s_sleep 3
  s_add_u32 s30, s30, 1
  s_cmp_lt_u32 s30, 400000
  s_cbranch_scc1 ch_wa0
  s_branch cA_abort
ch_wa0_ok:
  v_readfirstlane_b32 s29, v65
  s_add_u32 s22, s31, 0
  buffer_load_dwordx4 a[0:3], v2, s[8:11], s22 offen offset:0 sc1
  buffer_load_dwordx4 a[4:7], v2, s[8:11], s22 offen offset:1024 sc1
  buffer_load_dwordx4 a[8:11], v2, s[8:11], s22 offen offset:2048 sc1
  buffer_load_dwordx4 a[12:15], v2, s[8:11], s22 offen offset:3072 sc1
  s_add_u32 s22, s31, 4096
  buffer_load_dwordx4 a[16:19], v2, s[8:11], s22 offen offset:0 sc1
  buffer_load_dwordx4 a[20:23], v2, s[8:11], s22 offen offset:1024 sc1
  buffer_load_dwordx4 a[24:27], v2, s[8:11], s22 offen offset:2048 sc1
  buffer_load_dwordx4 a[28:31], v2, s[8:11], s22 offen offset:3072 sc1
  s_add_u32 s22, s31, 8192
  buffer_load_dwordx4 a[32:35], v2, s[8:11], s22 offen offset:0 sc1
  buffer_load_dwordx4 a[36:39], v2, s[8:11], s22 offen offset:1024 sc1
  buffer_load_dwordx4 a[40:43], v2, s[8:11], s22 offen offset:2048 sc1
  buffer_load_dwordx4 a[44:47], v2, s[8:11], s22 offen offset:3072 sc1
  s_add_u32 s22, s31, 12288
  buffer_load_dwordx4 a[48:51], v2, s[8:11], s22 offen offset:0 sc1
  buffer_load_dwordx4 a[52:55], v2, s[8:11], s22 offen offset:1024 sc1
  buffer_load_dwordx4 a[56:59], v2, s[8:11], s22 offen offset:2048 sc1
  buffer_load_dwordx4 a[60:63], v2, s[8:11], s22 offen offset:3072 sc1
  s_add_u32 s22, s31, 16384
  buffer_load_dwordx4 a[64:67], v2, s[8:11], s22 offen offset:0 sc1
  buffer_load_dwordx4 a[68:71], v2, s[8:11], s22 offen offset:1024 sc1
  buffer_load_dwordx4 a[72:75], v2, s[8:11], s22 offen offset:2048 sc1
  buffer_load_dwordx4 a[76:79], v2, s[8:11], s22 offen offset:3072 sc1
  s_add_u32 s22, s31, 20480
  buffer_load_dwordx4 a[80:83], v2, s[8:11], s22 offen offset:0 sc1
  buffer_load_dwordx4 a[84:87], v2, s[8:11], s22 offen offset:1024 sc1
  buffer_load_dwordx4 a[88:91], v2, s[8:11], s22 offen offset:2048 sc1
  buffer_load_dwordx4 a[92:95], v2, s[8:11], s22 offen offset:3072 sc1
  s_add_u32 s22, s31, 24576
  buffer_load_dwordx4 a[96:99], v2, s[8:11], s22 offen offset:0 sc1
  buffer_load_dwordx4 a[100:103], v2, s[8:11], s22 offen offset:1024 sc1
  buffer_load_dwordx4 a[104:107], v2, s[8:11], s22 offen offset:2048 sc1
  buffer_load_dwordx4 a[108:111], v2, s[8:11], s22 offen offset:3072 sc1
  s_add_u32 s22, s31, 28672
  buffer_load_dwordx4 a[112:115], v2, s[8:11], s22 offen offset:0 sc1
  buffer_load_dwordx4 a[116:119], v2, s[8:11], s22 offen offset:1024 sc1
  buffer_load_dwordx4 a[120:123], v2, s[8:11], s22 offen offset:2048 sc1
  buffer_load_dwordx4 a[124:127], v2, s[8:11], s22 offen offset:3072 sc1
  s_waitcnt vmcnt(24)
  s_add_u32 s22, s31, 32768
  buffer_load_dwordx4 a[128:131], v2, s[8:11], s22 offen offset:0 sc1
  buffer_load_dwordx4 a[132:135], v2, s[8:11], s22 offen offset:1024 sc1
  buffer_load_dwordx4 a[136:139], v2, s[8:11], s22 offen offset:2048 sc1
  buffer_load_dwordx4 a[140:143], v2, s[8:11], s22 offen offset:3072 sc1
  s_add_u32 s22, s31, 36864
  buffer_load_dwordx4 a[144:147], v2, s[8:11], s22 offen offset:0 sc1
  buffer_load_dwordx4 a[148:151], v2, s[8:11], s22 offen offset:1024 sc1
  buffer_load_dwordx4 a[152:155], v2, s[8:11], s22 offen offset:2048 sc1
  buffer_load_dwordx4 a[156:159], v2, s[8:11], s22 offen offset:3072 sc1
  s_add_u32 s22, s31, 40960
  buffer_load_dwordx4 a[160:163], v2, s[8:11], s22 offen offset:0 sc1
  buffer_load_dwordx4 a[164:167], v2, s[8:11], s22 offen offset:1024 sc1
  buffer_load_dwordx4 a[168:171], v2, s[8:11], s22 offen offset:2048 sc1
  buffer_load_dwordx4 a[172:175], v2, s[8:11], s22 offen offset:3072 sc1
  s_add_u32 s22, s31, 45056
  buffer_load_dwordx4 a[176:179], v2, s[8:11], s22 offen offset:0 sc1
  buffer_load_dwordx4 a[180:183], v2, s[8:11], s22 offen offset:1024 sc1
  buffer_load_dwordx4 a[184:187], v2, s[8:11], s22 offen offset:2048 sc1
  buffer_load_dwordx4 a[188:191], v2, s[8:11], s22 offen offset:3072 sc1
  s_add_u32 s22, s31, 49152
  buffer_load_dwordx4 a[192:195], v2, s[8:11], s22 offen offset:0 sc1
  buffer_load_dwordx4 a[196:199], v2, s[8:11], s22 offen offset:1024 sc1
  buffer_load_dwordx4 a[200:203], v2, s[8:11], s22 offen offset:2048 sc1
  buffer_load_dwordx4 a[204:207], v2, s[8:11], s22 offen offset:3072 sc1
  s_add_u32 s22, s31, 53248
  buffer_load_dwordx4 a[208:211], v2, s[8:11], s22 offen offset:0 sc1
  buffer_load_dwordx4 a[212:215], v2, s[8:11], s22 offen offset:1024 sc1
  buffer_load_dwordx4 a[216:219], v2, s[8:11], s22 offen offset:2048 sc1
  buffer_load_dwordx4 a[220:223], v2, s[8:11], s22 offen offset:3072 sc1
  s_and_b32 s29, s29, 10320
  s_cmp_eq_u32 s29, 10320
  s_cbranch_scc1 ch_wb0_ok
  s_lshl_b32 s27, s17, 7
  s_add_u32 s27, s27, 88062464
  s_mov_b32 s28, 10320
  s_mov_b32 s30, 0
ch_wb0:
  buffer_load_dword v65, off, s[8:11], s27  sc1
  s_waitcnt vmcnt(0)
  v_and_b32 v66, s28, v65
  v_cmp_ne_u32 vcc, s28, v66
  s_cbranch_vccz ch_wb0_ok
  s_sleep 3
  s_add_u32 s30, s30, 1
  s_cmp_lt_u32 s30, 400000
  s_cbranch_scc1 ch_wb0
  s_branch cA_abort
ch_wb0_ok:
  s_waitcnt vmcnt(28)
  s_add_u32 s22, s31, 229376
  buffer_load_dwordx4 a[224:227], v2, s[8:11], s22 offen offset:0 sc1
  buffer_load_dwordx4 a[228:231], v2, s[8:11], s22 offen offset:1024 sc1
  buffer_load_dwordx4 a[232:235], v2, s[8:11], s22 offen offset:2048 sc1
  buffer_load_dwordx4 a[236:239], v2, s[8:11], s22 offen offset:3072 sc1
  s_add_u32 s22, s31, 233472
  buffer_load_dwordx4 a[240:243], v2, s[8:11], s22 offen offset:0 sc1
  buffer_load_dwordx4 a[244:247], v2, s[8:11], s22 offen offset:1024 sc1
  buffer_load_dwordx4 a[248:251], v2, s[8:11], s22 offen offset:2048 sc1
  buffer_load_dwordx4 a[252:255], v2, s[8:11], s22 offen offset:3072 sc1
  s_add_u32 s22, s31, 237568
  buffer_load_dwordx4 v[120:123], v2, s[8:11], s22 offen offset:0 sc1
  buffer_load_dwordx4 v[124:127], v2, s[8:11], s22 offen offset:1024 sc1
  buffer_load_dwordx4 v[128:131], v2, s[8:11], s22 offen offset:2048 sc1
  buffer_load_dwordx4 v[132:135], v2, s[8:11], s22 offen offset:3072 sc1
  s_add_u32 s22, s31, 241664
  buffer_load_dwordx4 v[136:139], v2, s[8:11], s22 offen offset:0 sc1
  buffer_load_dwordx4 v[140:143], v2, s[8:11], s22 offen offset:1024 sc1
  buffer_load_dwordx4 v[144:147], v2, s[8:11], s22 offen offset:2048 sc1
  buffer_load_dwordx4 v[148:151], v2, s[8:11], s22 offen offset:3072 sc1
  s_add_u32 s22, s31, 245760
  buffer_load_dwordx4 v[152:155], v2, s[8:11], s22 offen offset:0 sc1
  buffer_load_dwordx4 v[156:159], v2, s[8:11], s22 offen offset:1024 sc1
  buffer_load_dwordx4 v[160:163], v2, s[8:11], s22 offen offset:2048 sc1
  buffer_load_dwordx4 v[164:167], v2, s[8:11], s22 offen offset:3072 sc1
  s_add_u32 s22, s31, 249856
  buffer_load_dwordx4 v[168:171], v2, s[8:11], s22 offen offset:0 sc1
  buffer_load_dwordx4 v[172:175], v2, s[8:11], s22 offen offset:1024 sc1
  buffer_load_dwordx4 v[176:179], v2, s[8:11], s22 offen offset:2048 sc1
  buffer_load_dwordx4 v[180:183], v2, s[8:11], s22 offen offset:3072 sc1
  s_add_u32 s22, s31, 253952
  buffer_load_dwordx4 v[184:187], v2, s[8:11], s22 offen offset:0 sc1
  buffer_load_dwordx4 v[188:191], v2, s[8:11], s22 offen offset:1024 sc1
  buffer_load_dwordx4 v[192:195], v2, s[8:11], s22 offen offset:2048 sc1
  buffer_load_dwordx4 v[196:199], v2, s[8:11], s22 offen offset:3072 sc1
  s_add_u32 s22, s31, 372736
  buffer_load_dwordx4 v[200:203], v2, s[8:11], s22 offen offset:0 sc1
  buffer_load_dwordx4 v[204:207], v2, s[8:11], s22 offen offset:1024 sc1
  buffer_load_dwordx4 v[208:211], v2, s[8:11], s22 offen offset:2048 sc1
  buffer_load_dwordx4 v[212:215], v2, s[8:11], s22 offen offset:3072 sc1
  s_waitcnt vmcnt(24)
  s_add_u32 s22, s31, 376832
  buffer_load_dwordx4 v[216:219], v2, s[8:11], s22 offen offset:0 sc1
  buffer_load_dwordx4 v[220:223], v2, s[8:11], s22 offen offset:1024 sc1
  buffer_load_dwordx4 v[224:227], v2, s[8:11], s22 offen offset:2048 sc1
  buffer_load_dwordx4 v[228:231], v2, s[8:11], s22 offen offset:3072 sc1
  s_add_u32 s22, s31, 380928
  buffer_load_dwordx4 v[232:235], v2, s[8:11], s22 offen offset:0 sc1
  buffer_load_dwordx4 v[236:239], v2, s[8:11], s22 offen offset:1024 sc1
  buffer_load_dwordx4 v[240:243], v2, s[8:11], s22 offen offset:2048 sc1
  buffer_load_dwordx4 v[244:247], v2, s[8:11], s22 offen offset:3072 sc1
  s_add_u32 s22, s31, 385024
  buffer_load_dwordx4 v[248:251], v2, s[8:11], s22 offen offset:0 sc1
  buffer_load_dwordx4 v[252:255], v2, s[8:11], s22 offen offset:1024 sc1
  s_mov_b32 s27, 88064512
  s_mov_b32 s28, 0xffff
  s_mov_b32 s30, 0
ch_wx0:
  buffer_load_dword v65, off, s[8:11], s27  sc1
  s_waitcnt vmcnt(0)
  v_and_b32 v66, s28, v65
  v_cmp_ne_u32 vcc, s28, v66
  s_cbranch_vccz ch_wx0_ok
  s_sleep 8
  s_add_u32 s30, s30, 1
  s_cmp_lt_u32 s30, 400000
  s_cbranch_scc1 ch_wx0
  s_branch cA_abort
ch_wx0_ok:
  s_mov_b32 s24, 71565312
  s_mov_b32 s26, 71579648
  v_and_b32 v64, 7, v117
  v_and_b32 v65, 1, v116
  v_lshlrev_b32 v65, 2, v65
  v_sub_u32 v64, v64, v65
  v_lshrrev_b32 v65, 3, v117
  v_lshl_add_u32 v66, v65, 2, v64
  v_cmp_gt_u32 vcc, 4, v64
  v_mov_b32 v67, 99
  s_nop 0
  v_cndmask_b32 v66, v67, v66, vcc
  v_mov_b32 v68, 0x3f80
  v_mov_b32 v69, 0x3f800000
  v_mov_b32 v4, 0
  v_cmp_eq_u32 vcc, 0, v66
  s_nop 1
  v_cndmask_b32 v4, v4, v68, vcc
  v_cmp_eq_u32 vcc, 1, v66
  s_nop 1
  v_cndmask_b32 v4, v4, v69, vcc
  v_mov_b32 v5, 0
  v_cmp_eq_u32 vcc, 2, v66
  s_nop 1
  v_cndmask_b32 v5, v5, v68, vcc
  v_cmp_eq_u32 vcc, 3, v66
  s_nop 1
  v_cndmask_b32 v5, v5, v69, vcc
  v_mov_b32 v6, 0
  v_cmp_eq_u32 vcc, 4, v66
  s_nop 1
  v_cndmask_b32 v6, v6, v68, vcc
  v_cmp_eq_u32 vcc, 5, v66
  s_nop 1
  v_cndmask_b32 v6, v6, v69, vcc
  v_mov_b32 v7, 0
  v_cmp_eq_u32 vcc, 6, v66
  s_nop 1
  v_cndmask_b32 v7, v7, v68, vcc
  v_cmp_eq_u32 vcc, 7, v66
  s_nop 1
  v_cndmask_b32 v7, v7, v69, vcc
  v_lshrrev_b32 v64, 1, v116
  v_lshrrev_b32 v65, 3, v117
  v_and_b32 v66, 1, v116
  v_and_b32 v68, 7, v117
  v_lshlrev_b32 v67, 8, v65
  v_lshl_add_u32 v67, v68, 5, v67
  v_lshl_add_u32 v67, v66, 4, v67
  v_add_u32 v69, 4096, v67
  v_add_u32 v70, 6400, v67
  v_cmp_eq_u32 vcc, v64, v65
  s_nop 1
  v_cndmask_b32 v113, v70, v69, vcc
  v_lshlrev_b32 v67, 9, v64
  v_lshl_add_u32 v67, v117, 4, v67
  v_lshl_add_u32 v67, v66, 3, v67
  v_add_u32 v114, 0, v67
  v_mul_u32_u24 v67, 1088, v65
  v_lshl_add_u32 v67, v116, 5, v67
  v_lshl_add_u32 v67, v68, 2, v67
  v_add_u32 v115, 4096, v67
  v_and_b32 v69, 1, v117
  v_lshlrev_b32 v67, 7, v69
  v_lshl_add_u32 v67, v116, 4, v67
  v_lshl_add_u32 v67, v65, 8, v67
  v_bfe_u32 v69, v117, 1, 2
  v_lshl_add_u32 v67, v69, 2, v67
  s_lshl_b32 s22, s17, 9
  s_add_u32 s22, s22, 9216
  v_add_u32 v72, s22, v67
  v_bfe_u32 v69, v117, 1, 1
  v_lshlrev_b32 v67, 7, v69
  v_lshl_add_u32 v67, v116, 4, v67
  v_and_b32 v69, 4, v117
  v_add_u32 v67, v67, v69
  s_lshr_b32 s22, s17, 1
  s_lshl_b32 s22, s22, 8
  s_and_b32 s27, s17, 1
  s_lshl_b32 s27, s27, 3
  s_add_u32 s22, s22, s27
  s_add_u32 s22, s22, 7168
  v_add_u32 v67, s22, v67
  v_and_b32 v69, 9, v117
  v_mov_b32 v70, 0x40000000
  v_cmp_eq_u32 vcc, 0, v69
  s_nop 1
  v_cndmask_b32 v118, v70, v67, vcc
  v_mov_b32 v119, -1
  v_and_b32 v0, 15, v1
  s_and_b32 s22, s17, 3
  s_lshl_b32 s22, s22, 7
  s_add_u32 s22, s22, 75272704
  v_lshl_add_u32 v0, v0, 2, s22
  v_xor_b32 v69, 256, v2
  v_mul_i32_i24 v70, -4096, v66
  v_add_u32 v69, v69, v70
  v_add_u32 v117, 12288, v69
  v_mov_b32 v1, v72
  v_mov_b32 v36, 0
  v_mov_b32 v37, 0
  v_mov_b32 v38, 0
  v_mov_b32 v39, 0
  v_mov_b32 v40, 0
  v_mov_b32 v41, 0
  v_mov_b32 v42, 0
  v_mov_b32 v43, 0
  v_mov_b32 v44, 0
  v_mov_b32 v45, 0
  v_mov_b32 v46, 0
  v_mov_b32 v47, 0
  v_mov_b32 v48, 0
  v_mov_b32 v49, 0
  v_mov_b32 v50, 0
  v_mov_b32 v51, 0
  v_mov_b32 v52, 0
  v_mov_b32 v53, 0
  v_mov_b32 v54, 0
  v_mov_b32 v55, 0
  v_mov_b32 v56, 0
  v_mov_b32 v57, 0
  v_mov_b32 v58, 0
  v_mov_b32 v59, 0
  v_mov_b32 v60, 0
  v_mov_b32 v61, 0
  v_mov_b32 v62, 0
  v_mov_b32 v63, 0
  v_mov_b32 v64, 0
  v_mov_b32 v65, 0
  v_mov_b32 v66, 0
  v_mov_b32 v67, 0
  v_mov_b32 v68, 0
  v_mov_b32 v69, 0
  v_mov_b32 v70, 0
  v_mov_b32 v71, 0
  v_mov_b32 v72, 0
  v_mov_b32 v73, 0
  v_mov_b32 v74, 0
  v_mov_b32 v75, 0
  v_mov_b32 v76, 0
  v_mov_b32 v77, 0
  v_mov_b32 v78, 0
  v_mov_b32 v79, 0
  buffer_load_dwordx4 v[80:83], v117, s[8:11], s24 offen offset:0 sc1
  buffer_load_dwordx4 v[84:87], v117, s[8:11], s24 offen offset:1024 sc1
  s_mov_b32 s30, 0
  v_mov_b32 v8, 0
ch_md0:
  buffer_load_dword v9, v8, s[12:15], 0 offen sc1
  s_waitcnt vmcnt(0) lgkmcnt(0)
  v_readfirstlane_b32 s22, v9
  s_and_b32 s31, s22, 0xffff
  s_cmp_ge_u32 s31, 32
  s_cbranch_scc1 ch_go0
  s_sleep 2
  s_add_u32 s30, s30, 1
  s_cmp_lt_u32 s30, 3200000
  s_cbranch_scc1 ch_md0
  s_branch ch_end
ch_go0:
  s_mov_b32 s31, 0
  s_lshr_b32 s22, s22, 16
  s_cmp_lg_u32 s22, 0
  s_cbranch_scc1 cB_sc0_loop
  s_branch cA_sc0_loop
ch_init1:
  s_mul_i32 s31, s17, 401408
  s_add_u32 s31, s31, 0
  s_mov_b32 s30, 0
ch_wr1:
  buffer_load_dword v65, off, s[12:15], 0 offset:132 sc1
  s_waitcnt vmcnt(0)
  v_cmp_ne_u32 vcc, 1, v65
  s_cbranch_vccz ch_wr1_ok
  s_sleep 8
  s_add_u32 s30, s30, 1
  s_cmp_lt_u32 s30, 400000
  s_cbranch_scc1 ch_wr1
  s_branch cA_abort
ch_wr1_ok:
  s_lshl_b32 s27, s17, 7
  s_add_u32 s27, s27, 88062464
  s_mov_b32 s28, 258
  s_mov_b32 s30, 0
ch_wa1:
  buffer_load_dword v65, off, s[8:11], s27  sc1
  s_waitcnt vmcnt(0)
  v_and_b32 v66, s28, v65
  v_cmp_ne_u32 vcc, s28, v66
  s_cbranch_vccz ch_wa1_ok
  s_sleep 3
  s_add_u32 s30, s30, 1
  s_cmp_lt_u32 s30, 400000
  s_cbranch_scc1 ch_wa1
  s_branch cA_abort
ch_wa1_ok:
  v_readfirstlane_b32 s29, v65
  s_add_u32 s22, s31, 57344
  buffer_load_dwordx4 a[0:3], v2, s[8:11], s22 offen offset:0 sc1
  buffer_load_dwordx4 a[4:7], v2, s[8:11], s22 offen offset:1024 sc1
  buffer_load_dwordx4 a[8:11], v2, s[8:11], s22 offen offset:2048 sc1
  buffer_load_dwordx4 a[12:15], v2, s[8:11], s22 offen offset:3072 sc1
  s_add_u32 s22, s31, 61440
  buffer_load_dwordx4 a[16:19], v2, s[8:11], s22 offen offset:0 sc1
  buffer_load_dwordx4 a[20:23], v2, s[8:11], s22 offen offset:1024 sc1
  buffer_load_dwordx4 a[24:27], v2, s[8:11], s22 offen offset:2048 sc1
  buffer_load_dwordx4 a[28:31], v2, s[8:11], s22 offen offset:3072 sc1
  s_add_u32 s22, s31, 65536
  buffer_load_dwordx4 a[32:35], v2, s[8:11], s22 offen offset:0 sc1
  buffer_load_dwordx4 a[36:39], v2, s[8:11], s22 offen offset:1024 sc1
  buffer_load_dwordx4 a[40:43], v2, s[8:11], s22 offen offset:2048 sc1
  buffer_load_dwordx4 a[44:47], v2, s[8:11], s22 offen offset:3072 sc1
  s_add_u32 s22, s31, 69632
  buffer_load_dwordx4 a[48:51], v2, s[8:11], s22 offen offset:0 sc1
  buffer_load_dwordx4 a[52:55], v2, s[8:11], s22 offen offset:1024 sc1
  buffer_load_dwordx4 a[56:59], v2, s[8:11], s22 offen offset:2048 sc1
  buffer_load_dwordx4 a[60:63], v2, s[8:11], s22 offen offset:3072 sc1
  s_add_u32 s22, s31, 73728
  buffer_load_dwordx4 a[64:67], v2, s[8:11], s22 offen offset:0 sc1
  buffer_load_dwordx4 a[68:71], v2, s[8:11], s22 offen offset:1024 sc1
  buffer_load_dwordx4 a[72:75], v2, s[8:11], s22 offen offset:2048 sc1
  buffer_load_dwordx4 a[76:79], v2, s[8:11], s22 offen offset:3072 sc1
  s_add_u32 s22, s31, 77824
  buffer_load_dwordx4 a[80:83], v2, s[8:11], s22 offen offset:0 sc1
  buffer_load_dwordx4 a[84:87], v2, s[8:11], s22 offen offset:1024 sc1
  buffer_load_dwordx4 a[88:91], v2, s[8:11], s22 offen offset:2048 sc1
  buffer_load_dwordx4 a[92:95], v2, s[8:11], s22 offen offset:3072 sc1
  s_add_u32 s22, s31, 81920
  buffer_load_dwordx4 a[96:99], v2, s[8:11], s22 offen offset:0 sc1
  buffer_load_dwordx4 a[100:103], v2, s[8:11], s22 offen offset:1024 sc1
  buffer_load_dwordx4 a[104:107], v2, s[8:11], s22 offen offset:2048 sc1
  buffer_load_dwordx4 a[108:111], v2, s[8:11], s22 offen offset:3072 sc1
  s_add_u32 s22, s31, 86016
  buffer_load_dwordx4 a[112:115], v2, s[8:11], s22 offen offset:0 sc1
  buffer_load_dwordx4 a[116:119], v2, s[8:11], s22 offen offset:1024 sc1
  buffer_load_dwordx4 a[120:123], v2, s[8:11], s22 offen offset:2048 sc1
  buffer_load_dwordx4 a[124:127], v2, s[8:11], s22 offen offset:3072 sc1
  s_waitcnt vmcnt(24)
  s_add_u32 s22, s31, 90112
  buffer_load_dwordx4 a[128:131], v2, s[8:11], s22 offen offset:0 sc1
  buffer_load_dwordx4 a[132:135], v2, s[8:11], s22 offen offset:1024 sc1
  buffer_load_dwordx4 a[136:139], v2, s[8:11], s22 offen offset:2048 sc1
  buffer_load_dwordx4 a[140:143], v2, s[8:11], s22 offen offset:3072 sc1
  s_add_u32 s22, s31, 94208
  buffer_load_dwordx4 a[144:147], v2, s[8:11], s22 offen offset:0 sc1
  buffer_load_dwordx4 a[148:151], v2, s[8:11], s22 offen offset:1024 sc1
  buffer_load_dwordx4 a[152:155], v2, s[8:11], s22 offen offset:2048 sc1
  buffer_load_dwordx4 a[156:159], v2, s[8:11], s22 offen offset:3072 sc1
  s_add_u32 s22, s31, 98304
  buffer_load_dwordx4 a[160:163], v2, s[8:11], s22 offen offset:0 sc1
  buffer_load_dwordx4 a[164:167], v2, s[8:11], s22 offen offset:1024 sc1
  buffer_load_dwordx4 a[168:171], v2, s[8:11], s22 offen offset:2048 sc1
  buffer_load_dwordx4 a[172:175], v2, s[8:11], s22 offen offset:3072 sc1
  s_add_u32 s22, s31, 102400
  buffer_load_dwordx4 a[176:179], v2, s[8:11], s22 offen offset:0 sc1
  buffer_load_dwordx4 a[180:183], v2, s[8:11], s22 offen offset:1024 sc1
  buffer_load_dwordx4 a[184:187], v2, s[8:11], s22 offen offset:2048 sc1
  buffer_load_dwordx4 a[188:191], v2, s[8:11], s22 offen offset:3072 sc1
  s_add_u32 s22, s31, 106496
  buffer_load_dwordx4 a[192:195], v2, s[8:11], s22 offen offset:0 sc1
  buffer_load_dwordx4 a[196:199], v2, s[8:11], s22 offen offset:1024 sc1
  buffer_load_dwordx4 a[200:203], v2, s[8:11], s22 offen offset:2048 sc1
  buffer_load_dwordx4 a[204:207], v2, s[8:11], s22 offen offset:3072 sc1
  s_add_u32 s22, s31, 110592
  buffer_load_dwordx4 a[208:211], v2, s[8:11], s22 offen offset:0 sc1
  buffer_load_dwordx4 a[212:215], v2, s[8:11], s22 offen offset:1024 sc1
  buffer_load_dwordx4 a[216:219], v2, s[8:11], s22 offen offset:2048 sc1
  buffer_load_dwordx4 a[220:223], v2, s[8:11], s22 offen offset:3072 sc1
  s_and_b32 s29, s29, 10320
  s_cmp_eq_u32 s29, 10320
  s_cbranch_scc1 ch_wb1_ok
  s_lshl_b32 s27, s17, 7
  s_add_u32 s27, s27, 88062464
  s_mov_b32 s28, 10320
  s_mov_b32 s30, 0
ch_wb1:
  buffer_load_dword v65, off, s[8:11], s27  sc1
  s_waitcnt vmcnt(0)
  v_and_b32 v66, s28, v65
  v_cmp_ne_u32 vcc, s28, v66
  s_cbranch_vccz ch_wb1_ok
  s_sleep 3
  s_add_u32 s30, s30, 1
  s_cmp_lt_u32 s30, 400000
  s_cbranch_scc1 ch_wb1
  s_branch cA_abort
ch_wb1_ok:
  s_waitcnt vmcnt(28)
  s_add_u32 s22, s31, 258048
  buffer_load_dwordx4 a[224:227], v2, s[8:11], s22 offen offset:0 sc1
  buffer_load_dwordx4 a[228:231], v2, s[8:11], s22 offen offset:1024 sc1
  buffer_load_dwordx4 a[232:235], v2, s[8:11], s22 offen offset:2048 sc1
  buffer_load_dwordx4 a[236:239], v2, s[8:11], s22 offen offset:3072 sc1
  s_add_u32 s22, s31, 262144
  buffer_load_dwordx4 a[240:243], v2, s[8:11], s22 offen offset:0 sc1
  buffer_load_dwordx4 a[244:247], v2, s[8:11], s22 offen offset:1024 sc1
  buffer_load_dwordx4 a[248:251], v2, s[8:11], s22 offen offset:2048 sc1
  buffer_load_dwordx4 a[252:255], v2, s[8:11], s22 offen offset:3072 sc1
  s_add_u32 s22, s31, 266240
  buffer_load_dwordx4 v[120:123], v2, s[8:11], s22 offen offset:0 sc1
  buffer_load_dwordx4 v[124:127], v2, s[8:11], s22 offen offset:1024 sc1
  buffer_load_dwordx4 v[128:131], v2, s[8:11], s22 offen offset:2048 sc1
  buffer_load_dwordx4 v[132:135], v2, s[8:11], s22 offen offset:3072 sc1
  s_add_u32 s22, s31, 270336
  buffer_load_dwordx4 v[136:139], v2, s[8:11], s22 offen offset:0 sc1
  buffer_load_dwordx4 v[140:143], v2, s[8:11], s22 offen offset:1024 sc1
  buffer_load_dwordx4 v[144:147], v2, s[8:11], s22 offen offset:2048 sc1
  buffer_load_dwordx4 v[148:151], v2, s[8:11], s22 offen offset:3072 sc1
  s_add_u32 s22, s31, 274432
  buffer_load_dwordx4 v[152:155], v2, s[8:11], s22 offen offset:0 sc1
  buffer_load_dwordx4 v[156:159], v2, s[8:11], s22 offen offset:1024 sc1
  buffer_load_dwordx4 v[160:163], v2, s[8:11], s22 offen offset:2048 sc1
  buffer_load_dwordx4 v[164:167], v2, s[8:11], s22 offen offset:3072 sc1
  s_add_u32 s22, s31, 278528
  buffer_load_dwordx4 v[168:171], v2, s[8:11], s22 offen offset:0 sc1
  buffer_load_dwordx4 v[172:175], v2, s[8:11], s22 offen offset:1024 sc1
  buffer_load_dwordx4 v[176:179], v2, s[8:11], s22 offen offset:2048 sc1
  buffer_load_dwordx4 v[180:183], v2, s[8:11], s22 offen offset:3072 sc1
  s_add_u32 s22, s31, 282624
  buffer_load_dwordx4 v[184:187], v2, s[8:11], s22 offen offset:0 sc1
  buffer_load_dwordx4 v[188:191], v2, s[8:11], s22 offen offset:1024 sc1
  buffer_load_dwordx4 v[192:195], v2, s[8:11], s22 offen offset:2048 sc1
  buffer_load_dwordx4 v[196:199], v2, s[8:11], s22 offen offset:3072 sc1
  s_add_u32 s22, s31, 344064
  buffer_load_dwordx4 v[200:203], v2, s[8:11], s22 offen offset:0 sc1
  buffer_load_dwordx4 v[204:207], v2, s[8:11], s22 offen offset:1024 sc1
  buffer_load_dwordx4 v[208:211], v2, s[8:11], s22 offen offset:2048 sc1
  buffer_load_dwordx4 v[212:215], v2, s[8:11], s22 offen offset:3072 sc1
  s_waitcnt vmcnt(24)
  s_add_u32 s22, s31, 348160
  buffer_load_dwordx4 v[216:219], v2, s[8:11], s22 offen offset:0 sc1
  buffer_load_dwordx4 v[220:223], v2, s[8:11], s22 offen offset:1024 sc1
  buffer_load_dwordx4 v[224:227], v2, s[8:11], s22 offen offset:2048 sc1
  buffer_load_dwordx4 v[228:231], v2, s[8:11], s22 offen offset:3072 sc1
  s_add_u32 s22, s31, 352256
  buffer_load_dwordx4 v[232:235], v2, s[8:11], s22 offen offset:0 sc1
  buffer_load_dwordx4 v[236:239], v2, s[8:11], s22 offen offset:1024 sc1
  buffer_load_dwordx4 v[240:243], v2, s[8:11], s22 offen offset:2048 sc1
  buffer_load_dwordx4 v[244:247], v2, s[8:11], s22 offen offset:3072 sc1
  s_add_u32 s22, s31, 356352
  buffer_load_dwordx4 v[248:251], v2, s[8:11], s22 offen offset:0 sc1
  buffer_load_dwordx4 v[252:255], v2, s[8:11], s22 offen offset:1024 sc1
  s_mov_b32 s27, 88064512
  s_mov_b32 s28, 0xffff
  s_mov_b32 s30, 0
ch_wx1:
  buffer_load_dword v65, off, s[8:11], s27  sc1
  s_waitcnt vmcnt(0)
  v_and_b32 v66, s28, v65
  v_cmp_ne_u32 vcc, s28, v66
  s_cbranch_vccz ch_wx1_ok
  s_sleep 8
  s_add_u32 s30, s30, 1
  s_cmp_lt_u32 s30, 400000
  s_cbranch_scc1 ch_wx1
  s_branch cA_abort
ch_wx1_ok:
  s_mov_b32 s24, 71567360
  s_mov_b32 s26, 71581696
  v_and_b32 v64, 7, v117
  v_and_b32 v65, 1, v116
  v_lshlrev_b32 v65, 2, v65
  v_sub_u32 v64, v64, v65
  v_lshrrev_b32 v65, 3, v117
  v_lshl_add_u32 v66, v65, 2, v64
  v_cmp_gt_u32 vcc, 4, v64
  v_mov_b32 v67, 99
  s_nop 0
  v_cndmask_b32 v66, v67, v66, vcc
  v_mov_b32 v68, 0x3f80
  v_mov_b32 v69, 0x3f800000
  v_mov_b32 v4, 0
  v_cmp_eq_u32 vcc, 0, v66
  s_nop 1
  v_cndmask_b32 v4, v4, v68, vcc
  v_cmp_eq_u32 vcc, 1, v66
  s_nop 1
  v_cndmask_b32 v4, v4, v69, vcc
  v_mov_b32 v5, 0
  v_cmp_eq_u32 vcc, 2, v66
  s_nop 1
  v_cndmask_b32 v5, v5, v68, vcc
  v_cmp_eq_u32 vcc, 3, v66
  s_nop 1
  v_cndmask_b32 v5, v5, v69, vcc
  v_mov_b32 v6, 0
  v_cmp_eq_u32 vcc, 4, v66
  s_nop 1
  v_cndmask_b32 v6, v6, v68, vcc
  v_cmp_eq_u32 vcc, 5, v66
  s_nop 1
  v_cndmask_b32 v6, v6, v69, vcc
  v_mov_b32 v7, 0
  v_cmp_eq_u32 vcc, 6, v66
  s_nop 1
  v_cndmask_b32 v7, v7, v68, vcc
  v_cmp_eq_u32 vcc, 7, v66
  s_nop 1
  v_cndmask_b32 v7, v7, v69, vcc
  v_lshrrev_b32 v64, 1, v116
  v_lshrrev_b32 v65, 3, v117
  v_and_b32 v66, 1, v116
  v_and_b32 v68, 7, v117
  v_lshlrev_b32 v67, 8, v65
  v_lshl_add_u32 v67, v68, 5, v67
  v_lshl_add_u32 v67, v66, 4, v67
  v_add_u32 v69, 4608, v67
  v_add_u32 v70, 6400, v67
  v_cmp_eq_u32 vcc, v64, v65
  s_nop 1
  v_cndmask_b32 v113, v70, v69, vcc
  v_lshlrev_b32 v67, 9, v64
  v_lshl_add_u32 v67, v117, 4, v67
  v_lshl_add_u32 v67, v66, 3, v67
  v_add_u32 v114, 256, v67
  v_mul_u32_u24 v67, 1088, v65
  v_lshl_add_u32 v67, v116, 5, v67
  v_lshl_add_u32 v67, v68, 2, v67
  v_add_u32 v115, 4224, v67
  v_and_b32 v69, 1, v117
  v_lshlrev_b32 v67, 7, v69
  v_lshl_add_u32 v67, v116, 4, v67
  v_lshl_add_u32 v67, v65, 8, v67
  v_bfe_u32 v69, v117, 1, 2
  v_lshl_add_u32 v67, v69, 2, v67
  s_lshl_b32 s22, s17, 9
  s_add_u32 s22, s22, 9280
  v_add_u32 v72, s22, v67
  v_bfe_u32 v69, v117, 1, 1
  v_lshlrev_b32 v67, 7, v69
  v_lshl_add_u32 v67, v116, 4, v67
  v_and_b32 v69, 4, v117
  v_add_u32 v67, v67, v69
  s_lshr_b32 s22, s17, 1
  s_lshl_b32 s22, s22, 8
  s_and_b32 s27, s17, 1
  s_lshl_b32 s27, s27, 3
  s_add_u32 s22, s22, s27
  s_add_u32 s22, s22, 7232
  v_add_u32 v67, s22, v67
  v_and_b32 v69, 9, v117
  v_mov_b32 v70, 0x40000000
  v_cmp_eq_u32 vcc, 0, v69
  s_nop 1
  v_cndmask_b32 v118, v70, v67, vcc
  v_mov_b32 v119, -1
  v_and_b32 v0, 15, v1
  s_and_b32 s22, s17, 3
  s_lshl_b32 s22, s22, 7
  s_add_u32 s22, s22, 75272704
  v_lshl_add_u32 v0, v0, 2, s22
  v_xor_b32 v69, 256, v2
  v_mul_i32_i24 v70, 4096, v66
  v_add_u32 v69, v69, v70
  v_add_u32 v117, 6144, v69
  v_mov_b32 v1, v72
  v_mov_b32 v36, 0
  v_mov_b32 v37, 0
  v_mov_b32 v38, 0
  v_mov_b32 v39, 0
  v_mov_b32 v40, 0
  v_mov_b32 v41, 0
  v_mov_b32 v42, 0
  v_mov_b32 v43, 0
  v_mov_b32 v44, 0
  v_mov_b32 v45, 0
  v_mov_b32 v46, 0
  v_mov_b32 v47, 0
  v_mov_b32 v48, 0
  v_mov_b32 v49, 0
  v_mov_b32 v50, 0
  v_mov_b32 v51, 0
  v_mov_b32 v52, 0
  v_mov_b32 v53, 0
  v_mov_b32 v54, 0
  v_mov_b32 v55, 0
  v_mov_b32 v56, 0
  v_mov_b32 v57, 0
  v_mov_b32 v58, 0
  v_mov_b32 v59, 0
  v_mov_b32 v60, 0
  v_mov_b32 v61, 0
  v_mov_b32 v62, 0
  v_mov_b32 v63, 0
  v_mov_b32 v64, 0
  v_mov_b32 v65, 0
  v_mov_b32 v66, 0
  v_mov_b32 v67, 0
  v_mov_b32 v68, 0
  v_mov_b32 v69, 0
  v_mov_b32 v70, 0
  v_mov_b32 v71, 0
  v_mov_b32 v72, 0
  v_mov_b32 v73, 0
  v_mov_b32 v74, 0
  v_mov_b32 v75, 0
  v_mov_b32 v76, 0
  v_mov_b32 v77, 0
  v_mov_b32 v78, 0
  v_mov_b32 v79, 0
  buffer_load_dwordx4 v[80:83], v117, s[8:11], s24 offen offset:0 sc1
  buffer_load_dwordx4 v[84:87], v117, s[8:11], s24 offen offset:1024 sc1
  s_mov_b32 s30, 0
  v_mov_b32 v8, 0
ch_md1:
  buffer_load_dword v9, v8, s[12:15], 0 offen sc1
  s_waitcnt vmcnt(0) lgkmcnt(0)
  v_readfirstlane_b32 s22, v9
  s_and_b32 s31, s22, 0xffff
  s_cmp_ge_u32 s31, 32
  s_cbranch_scc1 ch_go1
  s_sleep 2
  s_add_u32 s30, s30, 1
  s_cmp_lt_u32 s30, 3200000
  s_cbranch_scc1 ch_md1
  s_branch ch_end
ch_go1:
  s_mov_b32 s31, 0
  s_lshr_b32 s22, s22, 16
  s_cmp_lg_u32 s22, 0
  s_cbranch_scc1 cB_sc1_loop
  s_branch cA_sc1_loop
ch_init2:
  s_mul_i32 s31, s17, 401408
  s_add_u32 s31, s31, 0
  s_mov_b32 s30, 0
ch_wr2:
  buffer_load_dword v65, off, s[12:15], 0 offset:132 sc1
  s_waitcnt vmcnt(0)
  v_cmp_ne_u32 vcc, 1, v65
  s_cbranch_vccz ch_wr2_ok
  s_sleep 8
  s_add_u32 s30, s30, 1
  s_cmp_lt_u32 s30, 400000
  s_cbranch_scc1 ch_wr2
  s_branch cA_abort
ch_wr2_ok:
  s_lshl_b32 s27, s17, 7
  s_add_u32 s27, s27, 88062464
  s_mov_b32 s28, 516
  s_mov_b32 s30, 0
ch_wa2:
  buffer_load_dword v65, off, s[8:11], s27  sc1
  s_waitcnt vmcnt(0)
  v_and_b32 v66, s28, v65
  v_cmp_ne_u32 vcc, s28, v66
  s_cbranch_vccz ch_wa2_ok
  s_sleep 3
  s_add_u32 s30, s30, 1
  s_cmp_lt_u32 s30, 400000
  s_cbranch_scc1 ch_wa2
  s_branch cA_abort
ch_wa2_ok:
  v_readfirstlane_b32 s29, v65
  s_add_u32 s22, s31, 114688
  buffer_load_dwordx4 a[0:3], v2, s[8:11], s22 offen offset:0 sc1
  buffer_load_dwordx4 a[4:7], v2, s[8:11], s22 offen offset:1024 sc1
  buffer_load_dwordx4 a[8:11], v2, s[8:11], s22 offen offset:2048 sc1
  buffer_load_dwordx4 a[12:15], v2, s[8:11], s22 offen offset:3072 sc1
  s_add_u32 s22, s31, 118784
  buffer_load_dwordx4 a[16:19], v2, s[8:11], s22 offen offset:0 sc1
  buffer_load_dwordx4 a[20:23], v2, s[8:11], s22 offen offset:1024 sc1
  buffer_load_dwordx4 a[24:27], v2, s[8:11], s22 offen offset:2048 sc1
  buffer_load_dwordx4 a[28:31], v2, s[8:11], s22 offen offset:3072 sc1
  s_add_u32 s22, s31, 122880
  buffer_load_dwordx4 a[32:35], v2, s[8:11], s22 offen offset:0 sc1
  buffer_load_dwordx4 a[36:39], v2, s[8:11], s22 offen offset:1024 sc1
  buffer_load_dwordx4 a[40:43], v2, s[8:11], s22 offen offset:2048 sc1
  buffer_load_dwordx4 a[44:47], v2, s[8:11], s22 offen offset:3072 sc1
  s_add_u32 s22, s31, 126976
  buffer_load_dwordx4 a[48:51], v2, s[8:11], s22 offen offset:0 sc1
  buffer_load_dwordx4 a[52:55], v2, s[8:11], s22 offen offset:1024 sc1
  buffer_load_dwordx4 a[56:59], v2, s[8:11], s22 offen offset:2048 sc1
  buffer_load_dwordx4 a[60:63], v2, s[8:11], s22 offen offset:3072 sc1
  s_add_u32 s22, s31, 131072
  buffer_load_dwordx4 a[64:67], v2, s[8:11], s22 offen offset:0 sc1
  buffer_load_dwordx4 a[68:71], v2, s[8:11], s22 offen offset:1024 sc1
  buffer_load_dwordx4 a[72:75], v2, s[8:11], s22 offen offset:2048 sc1
  buffer_load_dwordx4 a[76:79], v2, s[8:11], s22 offen offset:3072 sc1
  s_add_u32 s22, s31, 135168
  buffer_load_dwordx4 a[80:83], v2, s[8:11], s22 offen offset:0 sc1
  buffer_load_dwordx4 a[84:87], v2, s[8:11], s22 offen offset:1024 sc1
  buffer_load_dwordx4 a[88:91], v2, s[8:11], s22 offen offset:2048 sc1
  buffer_load_dwordx4 a[92:95], v2, s[8:11], s22 offen offset:3072 sc1
  s_add_u32 s22, s31, 139264
  buffer_load_dwordx4 a[96:99], v2, s[8:11], s22 offen offset:0 sc1
  buffer_load_dwordx4 a[100:103], v2, s[8:11], s22 offen offset:1024 sc1
  buffer_load_dwordx4 a[104:107], v2, s[8:11], s22 offen offset:2048 sc1
  buffer_load_dwordx4 a[108:111], v2, s[8:11], s22 offen offset:3072 sc1
  s_add_u32 s22, s31, 143360
  buffer_load_dwordx4 a[112:115], v2, s[8:11], s22 offen offset:0 sc1
  buffer_load_dwordx4 a[116:119], v2, s[8:11], s22 offen offset:1024 sc1
  buffer_load_dwordx4 a[120:123], v2, s[8:11], s22 offen offset:2048 sc1
  buffer_load_dwordx4 a[124:127], v2, s[8:11], s22 offen offset:3072 sc1
  s_waitcnt vmcnt(24)
  s_add_u32 s22, s31, 147456
  buffer_load_dwordx4 a[128:131], v2, s[8:11], s22 offen offset:0 sc1
  buffer_load_dwordx4 a[132:135], v2, s[8:11], s22 offen offset:1024 sc1
  buffer_load_dwordx4 a[136:139], v2, s[8:11], s22 offen offset:2048 sc1
  buffer_load_dwordx4 a[140:143], v2, s[8:11], s22 offen offset:3072 sc1
  s_add_u32 s22, s31, 151552
  buffer_load_dwordx4 a[144:147], v2, s[8:11], s22 offen offset:0 sc1
  buffer_load_dwordx4 a[148:151], v2, s[8:11], s22 offen offset:1024 sc1
  buffer_load_dwordx4 a[152:155], v2, s[8:11], s22 offen offset:2048 sc1
  buffer_load_dwordx4 a[156:159], v2, s[8:11], s22 offen offset:3072 sc1
  s_add_u32 s22, s31, 155648
  buffer_load_dwordx4 a[160:163], v2, s[8:11], s22 offen offset:0 sc1
  buffer_load_dwordx4 a[164:167], v2, s[8:11], s22 offen offset:1024 sc1
  buffer_load_dwordx4 a[168:171], v2, s[8:11], s22 offen offset:2048 sc1
  buffer_load_dwordx4 a[172:175], v2, s[8:11], s22 offen offset:3072 sc1
  s_add_u32 s22, s31, 159744
  buffer_load_dwordx4 a[176:179], v2, s[8:11], s22 offen offset:0 sc1
  buffer_load_dwordx4 a[180:183], v2, s[8:11], s22 offen offset:1024 sc1
  buffer_load_dwordx4 a[184:187], v2, s[8:11], s22 offen offset:2048 sc1
  buffer_load_dwordx4 a[188:191], v2, s[8:11], s22 offen offset:3072 sc1
  s_add_u32 s22, s31, 163840
  buffer_load_dwordx4 a[192:195], v2, s[8:11], s22 offen offset:0 sc1
  buffer_load_dwordx4 a[196:199], v2, s[8:11], s22 offen offset:1024 sc1
  buffer_load_dwordx4 a[200:203], v2, s[8:11], s22 offen offset:2048 sc1
  buffer_load_dwordx4 a[204:207], v2, s[8:11], s22 offen offset:3072 sc1
  s_add_u32 s22, s31, 167936
  buffer_load_dwordx4 a[208:211], v2, s[8:11], s22 offen offset:0 sc1
  buffer_load_dwordx4 a[212:215], v2, s[8:11], s22 offen offset:1024 sc1
  buffer_load_dwordx4 a[216:219], v2, s[8:11], s22 offen offset:2048 sc1
  buffer_load_dwordx4 a[220:223], v2, s[8:11], s22 offen offset:3072 sc1
  s_and_b32 s29, s29, 12384
  s_cmp_eq_u32 s29, 12384
  s_cbranch_scc1 ch_wb2_ok
  s_lshl_b32 s27, s17, 7
  s_add_u32 s27, s27, 88062464
  s_mov_b32 s28, 12384
  s_mov_b32 s30, 0
ch_wb2:
  buffer_load_dword v65, off, s[8:11], s27  sc1
  s_waitcnt vmcnt(0)
  v_and_b32 v66, s28, v65
  v_cmp_ne_u32 vcc, s28, v66
  s_cbranch_vccz ch_wb2_ok
  s_sleep 3
  s_add_u32 s30, s30, 1
  s_cmp_lt_u32 s30, 400000
  s_cbranch_scc1 ch_wb2
  s_branch cA_abort
ch_wb2_ok:
  s_waitcnt vmcnt(28)
  s_add_u32 s22, s31, 286720
  buffer_load_dwordx4 a[224:227], v2, s[8:11], s22 offen offset:0 sc1
  buffer_load_dwordx4 a[228:231], v2, s[8:11], s22 offen offset:1024 sc1
  buffer_load_dwordx4 a[232:235], v2, s[8:11], s22 offen offset:2048 sc1
  buffer_load_dwordx4 a[236:239], v2, s[8:11], s22 offen offset:3072 sc1
  s_add_u32 s22, s31, 290816
  buffer_load_dwordx4 a[240:243], v2, s[8:11], s22 offen offset:0 sc1
  buffer_load_dwordx4 a[244:247], v2, s[8:11], s22 offen offset:1024 sc1
  buffer_load_dwordx4 a[248:251], v2, s[8:11], s22 offen offset:2048 sc1
  buffer_load_dwordx4 a[252:255], v2, s[8:11], s22 offen offset:3072 sc1
  s_add_u32 s22, s31, 294912
  buffer_load_dwordx4 v[120:123], v2, s[8:11], s22 offen offset:0 sc1
  buffer_load_dwordx4 v[124:127], v2, s[8:11], s22 offen offset:1024 sc1
  buffer_load_dwordx4 v[128:131], v2, s[8:11], s22 offen offset:2048 sc1
  buffer_load_dwordx4 v[132:135], v2, s[8:11], s22 offen offset:3072 sc1
  s_add_u32 s22, s31, 299008
  buffer_load_dwordx4 v[136:139], v2, s[8:11], s22 offen offset:0 sc1
  buffer_load_dwordx4 v[140:143], v2, s[8:11], s22 offen offset:1024 sc1
  buffer_load_dwordx4 v[144:147], v2, s[8:11], s22 offen offset:2048 sc1
  buffer_load_dwordx4 v[148:151], v2, s[8:11], s22 offen offset:3072 sc1
  s_add_u32 s22, s31, 303104
  buffer_load_dwordx4 v[152:155], v2, s[8:11], s22 offen offset:0 sc1
  buffer_load_dwordx4 v[156:159], v2, s[8:11], s22 offen offset:1024 sc1
  buffer_load_dwordx4 v[160:163], v2, s[8:11], s22 offen offset:2048 sc1
  buffer_load_dwordx4 v[164:167], v2, s[8:11], s22 offen offset:3072 sc1
  s_add_u32 s22, s31, 307200
  buffer_load_dwordx4 v[168:171], v2, s[8:11], s22 offen offset:0 sc1
  buffer_load_dwordx4 v[172:175], v2, s[8:11], s22 offen offset:1024 sc1
  buffer_load_dwordx4 v[176:179], v2, s[8:11], s22 offen offset:2048 sc1
  buffer_load_dwordx4 v[180:183], v2, s[8:11], s22 offen offset:3072 sc1
  s_add_u32 s22, s31, 311296
  buffer_load_dwordx4 v[184:187], v2, s[8:11], s22 offen offset:0 sc1
  buffer_load_dwordx4 v[188:191], v2, s[8:11], s22 offen offset:1024 sc1
  buffer_load_dwordx4 v[192:195], v2, s[8:11], s22 offen offset:2048 sc1
  buffer_load_dwordx4 v[196:199], v2, s[8:11], s22 offen offset:3072 sc1
  s_add_u32 s22, s31, 385024
  buffer_load_dwordx4 v[200:203], v2, s[8:11], s22 offen offset:2048 sc1
  buffer_load_dwordx4 v[204:207], v2, s[8:11], s22 offen offset:3072 sc1
  s_add_u32 s22, s31, 389120
  buffer_load_dwordx4 v[208:211], v2, s[8:11], s22 offen offset:0 sc1
  buffer_load_dwordx4 v[212:215], v2, s[8:11], s22 offen offset:1024 sc1
  s_waitcnt vmcnt(24)
  buffer_load_dwordx4 v[216:219], v2, s[8:11], s22 offen offset:2048 sc1
  buffer_load_dwordx4 v[220:223], v2, s[8:11], s22 offen offset:3072 sc1
  s_add_u32 s22, s31, 393216
  buffer_load_dwordx4 v[224:227], v2, s[8:11], s22 offen offset:0 sc1
  buffer_load_dwordx4 v[228:231], v2, s[8:11], s22 offen offset:1024 sc1
  buffer_load_dwordx4 v[232:235], v2, s[8:11], s22 offen offset:2048 sc1
  buffer_load_dwordx4 v[236:239], v2, s[8:11], s22 offen offset:3072 sc1
  s_add_u32 s22, s31, 397312
  buffer_load_dwordx4 v[240:243], v2, s[8:11], s22 offen offset:0 sc1
  buffer_load_dwordx4 v[244:247], v2, s[8:11], s22 offen offset:1024 sc1
  buffer_load_dwordx4 v[248:251], v2, s[8:11], s22 offen offset:2048 sc1
  buffer_load_dwordx4 v[252:255], v2, s[8:11], s22 offen offset:3072 sc1
  s_mov_b32 s27, 88064512
  s_mov_b32 s28, 0xffff
  s_mov_b32 s30, 0
ch_wx2:
  buffer_load_dword v65, off, s[8:11], s27  sc1
  s_waitcnt vmcnt(0)
  v_and_b32 v66, s28, v65
  v_cmp_ne_u32 vcc, s28, v66
  s_cbranch_vccz ch_wx2_ok
  s_sleep 8
  s_add_u32 s30, s30, 1
  s_cmp_lt_u32 s30, 400000
  s_cbranch_scc1 ch_wx2
  s_branch cA_abort
ch_wx2_ok:
  s_mov_b32 s24, 71569408
  s_mov_b32 s26, 71583744
  v_and_b32 v64, 7, v117
  v_and_b32 v65, 1, v116
  v_lshlrev_b32 v65, 2, v65
  v_sub_u32 v64, v64, v65
  v_lshrrev_b32 v65, 3, v117
  v_lshl_add_u32 v66, v65, 2, v64
  v_cmp_gt_u32 vcc, 4, v64
  v_mov_b32 v67, 99
  s_nop 0
  v_cndmask_b32 v66, v67, v66, vcc
  v_mov_b32 v68, 0x3f80
  v_mov_b32 v69, 0x3f800000
  v_mov_b32 v4, 0
  v_cmp_eq_u32 vcc, 0, v66
  s_nop 1
  v_cndmask_b32 v4, v4, v68, vcc
  v_cmp_eq_u32 vcc, 1, v66
  s_nop 1
  v_cndmask_b32 v4, v4, v69, vcc
  v_mov_b32 v5, 0
  v_cmp_eq_u32 vcc, 2, v66
  s_nop 1
  v_cndmask_b32 v5, v5, v68, vcc
  v_cmp_eq_u32 vcc, 3, v66
  s_nop 1
  v_cndmask_b32 v5, v5, v69, vcc
  v_mov_b32 v6, 0
  v_cmp_eq_u32 vcc, 4, v66
  s_nop 1
  v_cndmask_b32 v6, v6, v68, vcc
  v_cmp_eq_u32 vcc, 5, v66
  s_nop 1
  v_cndmask_b32 v6, v6, v69, vcc
  v_mov_b32 v7, 0
  v_cmp_eq_u32 vcc, 6, v66
  s_nop 1
  v_cndmask_b32 v7, v7, v68, vcc
  v_cmp_eq_u32 vcc, 7, v66
  s_nop 1
  v_cndmask_b32 v7, v7, v69, vcc
  v_lshrrev_b32 v64, 1, v116
  v_lshrrev_b32 v65, 3, v117
  v_and_b32 v66, 1, v116
  v_and_b32 v68, 7, v117
  v_lshlrev_b32 v67, 8, v65
  v_lshl_add_u32 v67, v68, 5, v67
  v_lshl_add_u32 v67, v66, 4, v67
  v_add_u32 v69, 5184, v67
  v_add_u32 v70, 6400, v67
  v_cmp_eq_u32 vcc, v64, v65
  s_nop 1
  v_cndmask_b32 v113, v70, v69, vcc
  s_lshl_b32 s22, s17, 2
  s_add_u32 s22, s22, 75270656
  v_lshl_add_u32 v67, v1, 7, s22
  v_mov_b32 v70, 0x40000000
  v_cmp_gt_u32 vcc, 4, v1
  s_nop 1
  v_cndmask_b32 v72, v70, v67, vcc
  v_mov_b32 v119, 1
  v_and_b32 v0, 15, v1
  s_and_b32 s22, s17, 3
  s_lshl_b32 s22, s22, 7
  s_add_u32 s22, s22, 75272704
  v_lshl_add_u32 v0, v0, 2, s22
  v_xor_b32 v69, 256, v2
  v_mul_i32_i24 v70, -2048, v66
  v_add_u32 v69, v69, v70
  v_add_u32 v117, 8192, v69
  v_min_u32 v116, 0, v1
  v_lshlrev_b32 v116, 7, v116
  s_mul_i32 s35, s17, 1835008
  s_add_u32 s35, s35, 42262528
  v_mov_b32 v1, v72
  v_mov_b32 v36, 0
  v_mov_b32 v37, 0
  v_mov_b32 v38, 0
  v_mov_b32 v39, 0
  v_mov_b32 v40, 0
  v_mov_b32 v41, 0
  v_mov_b32 v42, 0
  v_mov_b32 v43, 0
  v_mov_b32 v44, 0
  v_mov_b32 v45, 0
  v_mov_b32 v46, 0
  v_mov_b32 v47, 0
  v_mov_b32 v48, 0
  v_mov_b32 v49, 0
  v_mov_b32 v50, 0
  v_mov_b32 v51, 0
  v_mov_b32 v52, 0
  v_mov_b32 v53, 0
  v_mov_b32 v54, 0
  v_mov_b32 v55, 0
  v_mov_b32 v56, 0
  v_mov_b32 v57, 0
  v_mov_b32 v58, 0
  v_mov_b32 v59, 0
  v_mov_b32 v60, 0
  v_mov_b32 v61, 0
  v_mov_b32 v62, 0
  v_mov_b32 v63, 0
  v_mov_b32 v64, 0
  v_mov_b32 v65, 0
  v_mov_b32 v66, 0
  v_mov_b32 v67, 0
  v_mov_b32 v68, 0
  v_mov_b32 v69, 0
  v_mov_b32 v70, 0
  v_mov_b32 v71, 0
  v_mov_b32 v72, 0
  v_mov_b32 v73, 0
  v_mov_b32 v74, 0
  v_mov_b32 v75, 0
  v_mov_b32 v76, 0
  v_mov_b32 v77, 0
  v_mov_b32 v78, 0
  v_mov_b32 v79, 0
  buffer_load_dwordx4 v[80:83], v117, s[8:11], s24 offen offset:0 sc1
  buffer_load_dwordx4 v[84:87], v117, s[8:11], s24 offen offset:1024 sc1
  s_mov_b32 s30, 0
  v_mov_b32 v8, 0
ch_md2:
  buffer_load_dword v9, v8, s[12:15], 0 offen sc1
  s_waitcnt vmcnt(0) lgkmcnt(0)
  v_readfirstlane_b32 s22, v9
  s_and_b32 s31, s22, 0xffff
  s_cmp_ge_u32 s31, 32
  s_cbranch_scc1 ch_go2
  s_sleep 2
  s_add_u32 s30, s30, 1
  s_cmp_lt_u32 s30, 3200000
  s_cbranch_scc1 ch_md2
  s_branch ch_end
ch_go2:
  s_mov_b32 s31, 0
  s_lshr_b32 s22, s22, 16
  s_cmp_lg_u32 s22, 0
  s_cbranch_scc1 cB_sc2_loop
  s_branch cA_sc2_loop
ch_init3:
  s_mul_i32 s31, s17, 401408
  s_add_u32 s31, s31, 0
  s_mov_b32 s30, 0
ch_wr3:
  buffer_load_dword v65, off, s[12:15], 0 offset:132 sc1
  s_waitcnt vmcnt(0)
  v_cmp_ne_u32 vcc, 1, v65
  s_cbranch_vccz ch_wr3_ok
  s_sleep 8
  s_add_u32 s30, s30, 1
  s_cmp_lt_u32 s30, 400000
  s_cbranch_scc1 ch_wr3
  s_branch cA_abort
ch_wr3_ok:
  s_mov_b32 s22, 75235328
  v_add_u32 v64, 0, v1
  v_min_u32 v64, 323, v64
  v_lshlrev_b32 v64, 7, v64
  buffer_load_dword v65, v64, s[8:11], s22 offen sc1
  v_add_u32 v64, 64, v1
  v_min_u32 v64, 323, v64
  v_lshlrev_b32 v64, 7, v64
  buffer_load_dword v65, v64, s[8:11], s22 offen sc1
  v_add_u32 v64, 128, v1
  v_min_u32 v64, 323, v64
  v_lshlrev_b32 v64, 7, v64
  buffer_load_dword v65, v64, s[8:11], s22 offen sc1
  v_add_u32 v64, 192, v1
  v_min_u32 v64, 323, v64
  v_lshlrev_b32 v64, 7, v64
  buffer_load_dword v65, v64, s[8:11], s22 offen sc1
  v_add_u32 v64, 256, v1
  v_min_u32 v64, 323, v64
  v_lshlrev_b32 v64, 7, v64
  buffer_load_dword v65, v64, s[8:11], s22 offen sc1
  v_add_u32 v64, 320, v1
  v_min_u32 v64, 323, v64
  v_lshlrev_b32 v64, 7, v64
  buffer_load_dword v65, v64, s[8:11], s22 offen sc1
  s_lshl_b32 s27, s17, 7
  s_add_u32 s27, s27, 88062464
  s_mov_b32 s28, 1032
  s_mov_b32 s30, 0
ch_wa3:
  buffer_load_dword v65, off, s[8:11], s27  sc1
  s_waitcnt vmcnt(0)
  v_and_b32 v66, s28, v65
  v_cmp_ne_u32 vcc, s28, v66
  s_cbranch_vccz ch_wa3_ok
  s_sleep 3
  s_add_u32 s30, s30, 1
  s_cmp_lt_u32 s30, 400000
  s_cbranch_scc1 ch_wa3
  s_branch cA_abort
ch_wa3_ok:
  v_readfirstlane_b32 s29, v65
  s_add_u32 s22, s31, 172032
  buffer_load_dwordx4 a[0:3], v2, s[8:11], s22 offen offset:0 sc1
  buffer_load_dwordx4 a[4:7], v2, s[8:11], s22 offen offset:1024 sc1
  buffer_load_dwordx4 a[8:11], v2, s[8:11], s22 offen offset:2048 sc1
  buffer_load_dwordx4 a[12:15], v2, s[8:11], s22 offen offset:3072 sc1
  s_add_u32 s22, s31, 176128
  buffer_load_dwordx4 a[16:19], v2, s[8:11], s22 offen offset:0 sc1
  buffer_load_dwordx4 a[20:23], v2, s[8:11], s22 offen offset:1024 sc1
  buffer_load_dwordx4 a[24:27], v2, s[8:11], s22 offen offset:2048 sc1
  buffer_load_dwordx4 a[28:31], v2, s[8:11], s22 offen offset:3072 sc1
  s_add_u32 s22, s31, 180224
  buffer_load_dwordx4 a[32:35], v2, s[8:11], s22 offen offset:0 sc1
  buffer_load_dwordx4 a[36:39], v2, s[8:11], s22 offen offset:1024 sc1
  buffer_load_dwordx4 a[40:43], v2, s[8:11], s22 offen offset:2048 sc1
  buffer_load_dwordx4 a[44:47], v2, s[8:11], s22 offen offset:3072 sc1
  s_add_u32 s22, s31, 184320
  buffer_load_dwordx4 a[48:51], v2, s[8:11], s22 offen offset:0 sc1
  buffer_load_dwordx4 a[52:55], v2, s[8:11], s22 offen offset:1024 sc1
  buffer_load_dwordx4 a[56:59], v2, s[8:11], s22 offen offset:2048 sc1
  buffer_load_dwordx4 a[60:63], v2, s[8:11], s22 offen offset:3072 sc1
  s_add_u32 s22, s31, 188416
  buffer_load_dwordx4 a[64:67], v2, s[8:11], s22 offen offset:0 sc1
  buffer_load_dwordx4 a[68:71], v2, s[8:11], s22 offen offset:1024 sc1
  buffer_load_dwordx4 a[72:75], v2, s[8:11], s22 offen offset:2048 sc1
  buffer_load_dwordx4 a[76:79], v2, s[8:11], s22 offen offset:3072 sc1
  s_add_u32 s22, s31, 192512
  buffer_load_dwordx4 a[80:83], v2, s[8:11], s22 offen offset:0 sc1
  buffer_load_dwordx4 a[84:87], v2, s[8:11], s22 offen offset:1024 sc1
  buffer_load_dwordx4 a[88:91], v2, s[8:11], s22 offen offset:2048 sc1
  buffer_load_dwordx4 a[92:95], v2, s[8:11], s22 offen offset:3072 sc1
  s_add_u32 s22, s31, 196608
  buffer_load_dwordx4 a[96:99], v2, s[8:11], s22 offen offset:0 sc1
  buffer_load_dwordx4 a[100:103], v2, s[8:11], s22 offen offset:1024 sc1
  buffer_load_dwordx4 a[104:107], v2, s[8:11], s22 offen offset:2048 sc1
  buffer_load_dwordx4 a[108:111], v2, s[8:11], s22 offen offset:3072 sc1
  s_add_u32 s22, s31, 200704
  buffer_load_dwordx4 a[112:115], v2, s[8:11], s22 offen offset:0 sc1
  buffer_load_dwordx4 a[116:119], v2, s[8:11], s22 offen offset:1024 sc1
  buffer_load_dwordx4 a[120:123], v2, s[8:11], s22 offen offset:2048 sc1
  buffer_load_dwordx4 a[124:127], v2, s[8:11], s22 offen offset:3072 sc1
  s_waitcnt vmcnt(24)
  s_add_u32 s22, s31, 204800
  buffer_load_dwordx4 a[128:131], v2, s[8:11], s22 offen offset:0 sc1
  buffer_load_dwordx4 a[132:135], v2, s[8:11], s22 offen offset:1024 sc1
  buffer_load_dwordx4 a[136:139], v2, s[8:11], s22 offen offset:2048 sc1
  buffer_load_dwordx4 a[140:143], v2, s[8:11], s22 offen offset:3072 sc1
  s_add_u32 s22, s31, 208896
  buffer_load_dwordx4 a[144:147], v2, s[8:11], s22 offen offset:0 sc1
  buffer_load_dwordx4 a[148:151], v2, s[8:11], s22 offen offset:1024 sc1
  buffer_load_dwordx4 a[152:155], v2, s[8:11], s22 offen offset:2048 sc1
  buffer_load_dwordx4 a[156:159], v2, s[8:11], s22 offen offset:3072 sc1
  s_add_u32 s22, s31, 212992
  buffer_load_dwordx4 a[160:163], v2, s[8:11], s22 offen offset:0 sc1
  buffer_load_dwordx4 a[164:167], v2, s[8:11], s22 offen offset:1024 sc1
  buffer_load_dwordx4 a[168:171], v2, s[8:11], s22 offen offset:2048 sc1
  buffer_load_dwordx4 a[172:175], v2, s[8:11], s22 offen offset:3072 sc1
  s_add_u32 s22, s31, 217088
  buffer_load_dwordx4 a[176:179], v2, s[8:11], s22 offen offset:0 sc1
  buffer_load_dwordx4 a[180:183], v2, s[8:11], s22 offen offset:1024 sc1
  buffer_load_dwordx4 a[184:187], v2, s[8:11], s22 offen offset:2048 sc1
  buffer_load_dwordx4 a[188:191], v2, s[8:11], s22 offen offset:3072 sc1
  s_add_u32 s22, s31, 221184
  buffer_load_dwordx4 a[192:195], v2, s[8:11], s22 offen offset:0 sc1
  buffer_load_dwordx4 a[196:199], v2, s[8:11], s22 offen offset:1024 sc1
  buffer_load_dwordx4 a[200:203], v2, s[8:11], s22 offen offset:2048 sc1
  buffer_load_dwordx4 a[204:207], v2, s[8:11], s22 offen offset:3072 sc1
  s_add_u32 s22, s31, 225280
  buffer_load_dwordx4 a[208:211], v2, s[8:11], s22 offen offset:0 sc1
  buffer_load_dwordx4 a[212:215], v2, s[8:11], s22 offen offset:1024 sc1
  buffer_load_dwordx4 a[216:219], v2, s[8:11], s22 offen offset:2048 sc1
  buffer_load_dwordx4 a[220:223], v2, s[8:11], s22 offen offset:3072 sc1
  s_and_b32 s29, s29, 12384
  s_cmp_eq_u32 s29, 12384
  s_cbranch_scc1 ch_wb3_ok
  s_lshl_b32 s27, s17, 7
  s_add_u32 s27, s27, 88062464
  s_mov_b32 s28, 12384
  s_mov_b32 s30, 0
ch_wb3:
  buffer_load_dword v65, off, s[8:11], s27  sc1
  s_waitcnt vmcnt(0)
  v_and_b32 v66, s28, v65
  v_cmp_ne_u32 vcc, s28, v66
  s_cbranch_vccz ch_wb3_ok
  s_sleep 3
  s_add_u32 s30, s30, 1
  s_cmp_lt_u32 s30, 400000
  s_cbranch_scc1 ch_wb3
  s_branch cA_abort
ch_wb3_ok:
  s_waitcnt vmcnt(28)
  s_add_u32 s22, s31, 315392
  buffer_load_dwordx4 a[224:227], v2, s[8:11], s22 offen offset:0 sc1
  buffer_load_dwordx4 a[228:231], v2, s[8:11], s22 offen offset:1024 sc1
  buffer_load_dwordx4 a[232:235], v2, s[8:11], s22 offen offset:2048 sc1
  buffer_load_dwordx4 a[236:239], v2, s[8:11], s22 offen offset:3072 sc1
  s_add_u32 s22, s31, 319488
  buffer_load_dwordx4 a[240:243], v2, s[8:11], s22 offen offset:0 sc1
  buffer_load_dwordx4 a[244:247], v2, s[8:11], s22 offen offset:1024 sc1
  buffer_load_dwordx4 a[248:251], v2, s[8:11], s22 offen offset:2048 sc1
  buffer_load_dwordx4 a[252:255], v2, s[8:11], s22 offen offset:3072 sc1
  s_add_u32 s22, s31, 323584
  buffer_load_dwordx4 v[120:123], v2, s[8:11], s22 offen offset:0 sc1
  buffer_load_dwordx4 v[124:127], v2, s[8:11], s22 offen offset:1024 sc1
  buffer_load_dwordx4 v[128:131], v2, s[8:11], s22 offen offset:2048 sc1
  buffer_load_dwordx4 v[132:135], v2, s[8:11], s22 offen offset:3072 sc1
  s_add_u32 s22, s31, 327680
  buffer_load_dwordx4 v[136:139], v2, s[8:11], s22 offen offset:0 sc1
  buffer_load_dwordx4 v[140:143], v2, s[8:11], s22 offen offset:1024 sc1
  buffer_load_dwordx4 v[144:147], v2, s[8:11], s22 offen offset:2048 sc1
  buffer_load_dwordx4 v[148:151], v2, s[8:11], s22 offen offset:3072 sc1
  s_add_u32 s22, s31, 331776
  buffer_load_dwordx4 v[152:155], v2, s[8:11], s22 offen offset:0 sc1
  buffer_load_dwordx4 v[156:159], v2, s[8:11], s22 offen offset:1024 sc1
  buffer_load_dwordx4 v[160:163], v2, s[8:11], s22 offen offset:2048 sc1
  buffer_load_dwordx4 v[164:167], v2, s[8:11], s22 offen offset:3072 sc1
  s_add_u32 s22, s31, 335872
  buffer_load_dwordx4 v[168:171], v2, s[8:11], s22 offen offset:0 sc1
  buffer_load_dwordx4 v[172:175], v2, s[8:11], s22 offen offset:1024 sc1
  buffer_load_dwordx4 v[176:179], v2, s[8:11], s22 offen offset:2048 sc1
  buffer_load_dwordx4 v[180:183], v2, s[8:11], s22 offen offset:3072 sc1
  s_add_u32 s22, s31, 339968
  buffer_load_dwordx4 v[184:187], v2, s[8:11], s22 offen offset:0 sc1
  buffer_load_dwordx4 v[188:191], v2, s[8:11], s22 offen offset:1024 sc1
  buffer_load_dwordx4 v[192:195], v2, s[8:11], s22 offen offset:2048 sc1
  buffer_load_dwordx4 v[196:199], v2, s[8:11], s22 offen offset:3072 sc1
  s_add_u32 s22, s31, 356352
  buffer_load_dwordx4 v[200:203], v2, s[8:11], s22 offen offset:2048 sc1
  buffer_load_dwordx4 v[204:207], v2, s[8:11], s22 offen offset:3072 sc1
  s_add_u32 s22, s31, 360448
  buffer_load_dwordx4 v[208:211], v2, s[8:11], s22 offen offset:0 sc1
  buffer_load_dwordx4 v[212:215], v2, s[8:11], s22 offen offset:1024 sc1
  s_waitcnt vmcnt(24)
  buffer_load_dwordx4 v[216:219], v2, s[8:11], s22 offen offset:2048 sc1
  buffer_load_dwordx4 v[220:223], v2, s[8:11], s22 offen offset:3072 sc1
  s_add_u32 s22, s31, 364544
  buffer_load_dwordx4 v[224:227], v2, s[8:11], s22 offen offset:0 sc1
  buffer_load_dwordx4 v[228:231], v2, s[8:11], s22 offen offset:1024 sc1
  buffer_load_dwordx4 v[232:235], v2, s[8:11], s22 offen offset:2048 sc1
  buffer_load_dwordx4 v[236:239], v2, s[8:11], s22 offen offset:3072 sc1
  s_add_u32 s22, s31, 368640
  buffer_load_dwordx4 v[240:243], v2, s[8:11], s22 offen offset:0 sc1
  buffer_load_dwordx4 v[244:247], v2, s[8:11], s22 offen offset:1024 sc1
  buffer_load_dwordx4 v[248:251], v2, s[8:11], s22 offen offset:2048 sc1
  buffer_load_dwordx4 v[252:255], v2, s[8:11], s22 offen offset:3072 sc1
  s_mov_b32 s27, 88064512
  s_mov_b32 s28, 0xffff
  s_mov_b32 s30, 0
ch_wx3:
  buffer_load_dword v65, off, s[8:11], s27  sc1
  s_waitcnt vmcnt(0)
  v_and_b32 v66, s28, v65
  v_cmp_ne_u32 vcc, s28, v66
  s_cbranch_vccz ch_wx3_ok
  s_sleep 8
  s_add_u32 s30, s30, 1
  s_cmp_lt_u32 s30, 400000
  s_cbranch_scc1 ch_wx3
  s_branch cA_abort
ch_wx3_ok:
  s_mov_b32 s24, 71571456
  s_mov_b32 s26, 71585792
  v_and_b32 v64, 7, v117
  v_and_b32 v65, 1, v116
  v_lshlrev_b32 v65, 2, v65
  v_sub_u32 v64, v64, v65
  v_lshrrev_b32 v65, 3, v117
  v_lshl_add_u32 v66, v65, 2, v64
  v_cmp_gt_u32 vcc, 4, v64
  v_mov_b32 v67, 99
  s_nop 0
  v_cndmask_b32 v66, v67, v66, vcc
  v_mov_b32 v68, 0x3f80
  v_mov_b32 v69, 0x3f800000
  v_mov_b32 v4, 0
  v_cmp_eq_u32 vcc, 0, v66
  s_nop 1
  v_cndmask_b32 v4, v4, v68, vcc
  v_cmp_eq_u32 vcc, 1, v66
  s_nop 1
  v_cndmask_b32 v4, v4, v69, vcc
  v_mov_b32 v5, 0
  v_cmp_eq_u32 vcc, 2, v66
  s_nop 1
  v_cndmask_b32 v5, v5, v68, vcc
  v_cmp_eq_u32 vcc, 3, v66
  s_nop 1
  v_cndmask_b32 v5, v5, v69, vcc
  v_mov_b32 v6, 0
  v_cmp_eq_u32 vcc, 4, v66
  s_nop 1
  v_cndmask_b32 v6, v6, v68, vcc
  v_cmp_eq_u32 vcc, 5, v66
  s_nop 1
  v_cndmask_b32 v6, v6, v69, vcc
  v_mov_b32 v7, 0
  v_cmp_eq_u32 vcc, 6, v66
  s_nop 1
  v_cndmask_b32 v7, v7, v68, vcc
  v_cmp_eq_u32 vcc, 7, v66
  s_nop 1
  v_cndmask_b32 v7, v7, v69, vcc
  v_lshrrev_b32 v64, 1, v116
  v_lshrrev_b32 v65, 3, v117
  v_and_b32 v66, 1, v116
  v_and_b32 v68, 7, v117
  v_lshlrev_b32 v67, 8, v65
  v_lshl_add_u32 v67, v68, 5, v67
  v_lshl_add_u32 v67, v66, 4, v67
  v_add_u32 v69, 5696, v67
  v_add_u32 v70, 6400, v67
  v_cmp_eq_u32 vcc, v64, v65
  s_nop 1
  v_cndmask_b32 v113, v70, v69, vcc
  v_and_b32 v0, 15, v1
  s_and_b32 s22, s17, 3
  s_lshl_b32 s22, s22, 7
  s_add_u32 s22, s22, 75272704
  v_lshl_add_u32 v0, v0, 2, s22
  v_xor_b32 v69, 256, v2
  v_mul_i32_i24 v70, 2048, v66
  v_add_u32 v69, v69, v70
  v_add_u32 v117, 4096, v69
  v_min_u32 v116, 0, v1
  v_lshlrev_b32 v116, 7, v116
  s_mul_i32 s35, s17, 1835008
  s_add_u32 s35, s35, 42262528
  v_mov_b32 v36, 0
  v_mov_b32 v37, 0
  v_mov_b32 v38, 0
  v_mov_b32 v39, 0
  v_mov_b32 v40, 0
  v_mov_b32 v41, 0
  v_mov_b32 v42, 0
  v_mov_b32 v43, 0
  v_mov_b32 v44, 0
  v_mov_b32 v45, 0
  v_mov_b32 v46, 0
  v_mov_b32 v47, 0
  v_mov_b32 v48, 0
  v_mov_b32 v49, 0
  v_mov_b32 v50, 0
  v_mov_b32 v51, 0
  v_mov_b32 v52, 0
  v_mov_b32 v53, 0
  v_mov_b32 v54, 0
  v_mov_b32 v55, 0
  v_mov_b32 v56, 0
  v_mov_b32 v57, 0
  v_mov_b32 v58, 0
  v_mov_b32 v59, 0
  v_mov_b32 v60, 0
  v_mov_b32 v61, 0
  v_mov_b32 v62, 0
  v_mov_b32 v63, 0
  v_mov_b32 v64, 0
  v_mov_b32 v65, 0
  v_mov_b32 v66, 0
  v_mov_b32 v67, 0
  v_mov_b32 v68, 0
  v_mov_b32 v69, 0
  v_mov_b32 v70, 0
  v_mov_b32 v71, 0
  v_mov_b32 v72, 0
  v_mov_b32 v73, 0
  v_mov_b32 v74, 0
  v_mov_b32 v75, 0
  v_mov_b32 v76, 0
  v_mov_b32 v77, 0
  v_mov_b32 v78, 0
  v_mov_b32 v79, 0
  buffer_load_dwordx4 v[80:83], v117, s[8:11], s24 offen offset:0 sc1
  buffer_load_dwordx4 v[84:87], v117, s[8:11], s24 offen offset:1024 sc1
  s_mov_b32 s30, 0
  v_mov_b32 v8, 0
ch_md3:
  buffer_load_dword v9, v8, s[12:15], 0 offen sc1
  s_waitcnt vmcnt(0) lgkmcnt(0)
  v_readfirstlane_b32 s22, v9
  s_and_b32 s31, s22, 0xffff
  s_cmp_ge_u32 s31, 32
  s_cbranch_scc1 ch_go3
  s_sleep 2
  s_add_u32 s30, s30, 1
  s_cmp_lt_u32 s30, 3200000
  s_cbranch_scc1 ch_md3
  s_branch ch_end
ch_go3:
  s_mov_b32 s31, 0
  s_lshr_b32 s22, s22, 16
  s_cmp_lg_u32 s22, 0
  s_cbranch_scc1 cB_sc3_loop
  s_branch cA_sc3_loop
ch_init4:
  s_mul_i32 s31, s17, 401408
  s_add_u32 s31, s31, 6422528
  s_mov_b32 s30, 0
ch_wr4:
  buffer_load_dword v65, off, s[12:15], 0 offset:128 sc1
  s_waitcnt vmcnt(0)
  v_cmp_ne_u32 vcc, 1, v65
  s_cbranch_vccz ch_wr4_ok
  s_sleep 8
  s_add_u32 s30, s30, 1
  s_cmp_lt_u32 s30, 400000
  s_cbranch_scc1 ch_wr4
  s_branch cA_abort
ch_wr4_ok:
  s_lshr_b32 s22, s17, 2
  s_lshl_b32 s28, 0x81, s22
  s_mul_i32 s27, s17, 12
  s_add_u32 s22, s27, 256
  s_lshr_b32 s22, s22, 6
  s_lshl_b32 s22, 0x81, s22
  s_or_b32 s28, s28, s22
  s_add_u32 s22, s27, 267
  s_lshr_b32 s22, s22, 6
  s_lshl_b32 s22, 0x81, s22
  s_or_b32 s28, s28, s22
  v_lshlrev_b32 v64, 7, v116
  s_mov_b32 s27, 88060416
  s_mov_b32 s30, 0
ch_ww4:
  buffer_load_dword v65, v64, s[8:11], s27 offen sc1
  s_waitcnt vmcnt(0)
  v_and_b32 v66, s28, v65
  v_cmp_ne_u32 vcc, s28, v66
  s_cbranch_vccz ch_ww4_ok
  s_sleep 3
  s_add_u32 s30, s30, 1
  s_cmp_lt_u32 s30, 400000
  s_cbranch_scc1 ch_ww4
  s_branch cA_abort
ch_ww4_ok:
  s_add_u32 s22, s31, 0
  buffer_load_dwordx4 a[0:3], v2, s[8:11], s22 offen offset:0 sc1
  buffer_load_dwordx4 a[4:7], v2, s[8:11], s22 offen offset:1024 sc1
  buffer_load_dwordx4 a[8:11], v2, s[8:11], s22 offen offset:2048 sc1
  buffer_load_dwordx4 a[12:15], v2, s[8:11], s22 offen offset:3072 sc1
  s_add_u32 s22, s31, 4096
  buffer_load_dwordx4 a[16:19], v2, s[8:11], s22 offen offset:0 sc1
  buffer_load_dwordx4 a[20:23], v2, s[8:11], s22 offen offset:1024 sc1
  buffer_load_dwordx4 a[24:27], v2, s[8:11], s22 offen offset:2048 sc1
  buffer_load_dwordx4 a[28:31], v2, s[8:11], s22 offen offset:3072 sc1
  s_add_u32 s22, s31, 8192
  buffer_load_dwordx4 a[32:35], v2, s[8:11], s22 offen offset:0 sc1
  buffer_load_dwordx4 a[36:39], v2, s[8:11], s22 offen offset:1024 sc1
  buffer_load_dwordx4 a[40:43], v2, s[8:11], s22 offen offset:2048 sc1
  buffer_load_dwordx4 a[44:47], v2, s[8:11], s22 offen offset:3072 sc1
  s_add_u32 s22, s31, 12288
  buffer_load_dwordx4 a[48:51], v2, s[8:11], s22 offen offset:0 sc1
  buffer_load_dwordx4 a[52:55], v2, s[8:11], s22 offen offset:1024 sc1
  buffer_load_dwordx4 a[56:59], v2, s[8:11], s22 offen offset:2048 sc1
  buffer_load_dwordx4 a[60:63], v2, s[8:11], s22 offen offset:3072 sc1
  s_add_u32 s22, s31, 16384
  buffer_load_dwordx4 a[64:67], v2, s[8:11], s22 offen offset:0 sc1
  buffer_load_dwordx4 a[68:71], v2, s[8:11], s22 offen offset:1024 sc1
  buffer_load_dwordx4 a[72:75], v2, s[8:11], s22 offen offset:2048 sc1
  buffer_load_dwordx4 a[76:79], v2, s[8:11], s22 offen offset:3072 sc1
  s_add_u32 s22, s31, 20480
  buffer_load_dwordx4 a[80:83], v2, s[8:11], s22 offen offset:0 sc1
  buffer_load_dwordx4 a[84:87], v2, s[8:11], s22 offen offset:1024 sc1
  buffer_load_dwordx4 a[88:91], v2, s[8:11], s22 offen offset:2048 sc1
  buffer_load_dwordx4 a[92:95], v2, s[8:11], s22 offen offset:3072 sc1
  s_add_u32 s22, s31, 24576
  buffer_load_dwordx4 a[96:99], v2, s[8:11], s22 offen offset:0 sc1
  buffer_load_dwordx4 a[100:103], v2, s[8:11], s22 offen offset:1024 sc1
  buffer_load_dwordx4 a[104:107], v2, s[8:11], s22 offen offset:2048 sc1
  buffer_load_dwordx4 a[108:111], v2, s[8:11], s22 offen offset:3072 sc1
  s_add_u32 s22, s31, 28672
  buffer_load_dwordx4 a[112:115], v2, s[8:11], s22 offen offset:0 sc1
  buffer_load_dwordx4 a[116:119], v2, s[8:11], s22 offen offset:1024 sc1
  buffer_load_dwordx4 a[120:123], v2, s[8:11], s22 offen offset:2048 sc1
  buffer_load_dwordx4 a[124:127], v2, s[8:11], s22 offen offset:3072 sc1
  s_waitcnt vmcnt(24)
  s_add_u32 s22, s31, 32768
  buffer_load_dwordx4 a[128:131], v2, s[8:11], s22 offen offset:0 sc1
  buffer_load_dwordx4 a[132:135], v2, s[8:11], s22 offen offset:1024 sc1
  buffer_load_dwordx4 a[136:139], v2, s[8:11], s22 offen offset:2048 sc1
  buffer_load_dwordx4 a[140:143], v2, s[8:11], s22 offen offset:3072 sc1
  s_add_u32 s22, s31, 36864
  buffer_load_dwordx4 a[144:147], v2, s[8:11], s22 offen offset:0 sc1
  buffer_load_dwordx4 a[148:151], v2, s[8:11], s22 offen offset:1024 sc1
  buffer_load_dwordx4 a[152:155], v2, s[8:11], s22 offen offset:2048 sc1
  buffer_load_dwordx4 a[156:159], v2, s[8:11], s22 offen offset:3072 sc1
  s_add_u32 s22, s31, 40960
  buffer_load_dwordx4 a[160:163], v2, s[8:11], s22 offen offset:0 sc1
  buffer_load_dwordx4 a[164:167], v2, s[8:11], s22 offen offset:1024 sc1
  buffer_load_dwordx4 a[168:171], v2, s[8:11], s22 offen offset:2048 sc1
  buffer_load_dwordx4 a[172:175], v2, s[8:11], s22 offen offset:3072 sc1
  s_add_u32 s22, s31, 45056
  buffer_load_dwordx4 a[176:179], v2, s[8:11], s22 offen offset:0 sc1
  buffer_load_dwordx4 a[180:183], v2, s[8:11], s22 offen offset:1024 sc1
  buffer_load_dwordx4 a[184:187], v2, s[8:11], s22 offen offset:2048 sc1
  buffer_load_dwordx4 a[188:191], v2, s[8:11], s22 offen offset:3072 sc1
  s_add_u32 s22, s31, 49152
  buffer_load_dwordx4 a[192:195], v2, s[8:11], s22 offen offset:0 sc1
  buffer_load_dwordx4 a[196:199], v2, s[8:11], s22 offen offset:1024 sc1
  buffer_load_dwordx4 a[200:203], v2, s[8:11], s22 offen offset:2048 sc1
  buffer_load_dwordx4 a[204:207], v2, s[8:11], s22 offen offset:3072 sc1
  s_add_u32 s22, s31, 53248
  buffer_load_dwordx4 a[208:211], v2, s[8:11], s22 offen offset:0 sc1
  buffer_load_dwordx4 a[212:215], v2, s[8:11], s22 offen offset:1024 sc1
  buffer_load_dwordx4 a[216:219], v2, s[8:11], s22 offen offset:2048 sc1
  buffer_load_dwordx4 a[220:223], v2, s[8:11], s22 offen offset:3072 sc1
  s_add_u32 s22, s31, 57344
  buffer_load_dwordx4 a[224:227], v2, s[8:11], s22 offen offset:0 sc1
  buffer_load_dwordx4 a[228:231], v2, s[8:11], s22 offen offset:1024 sc1
  buffer_load_dwordx4 a[232:235], v2, s[8:11], s22 offen offset:2048 sc1
  buffer_load_dwordx4 a[236:239], v2, s[8:11], s22 offen offset:3072 sc1
  s_add_u32 s22, s31, 61440
  buffer_load_dwordx4 a[240:243], v2, s[8:11], s22 offen offset:0 sc1
  buffer_load_dwordx4 a[244:247], v2, s[8:11], s22 offen offset:1024 sc1
  buffer_load_dwordx4 a[248:251], v2, s[8:11], s22 offen offset:2048 sc1
  buffer_load_dwordx4 a[252:255], v2, s[8:11], s22 offen offset:3072 sc1
  s_waitcnt vmcnt(24)
  s_add_u32 s22, s31, 65536
  buffer_load_dwordx4 v[176:179], v2, s[8:11], s22 offen offset:0 sc1
  buffer_load_dwordx4 v[180:183], v2, s[8:11], s22 offen offset:1024 sc1
  buffer_load_dwordx4 v[184:187], v2, s[8:11], s22 offen offset:2048 sc1
  buffer_load_dwordx4 v[188:191], v2, s[8:11], s22 offen offset:3072 sc1
  s_add_u32 s22, s31, 69632
  buffer_load_dwordx4 v[192:195], v2, s[8:11], s22 offen offset:0 sc1
  buffer_load_dwordx4 v[196:199], v2, s[8:11], s22 offen offset:1024 sc1
  buffer_load_dwordx4 v[200:203], v2, s[8:11], s22 offen offset:2048 sc1
  buffer_load_dwordx4 v[204:207], v2, s[8:11], s22 offen offset:3072 sc1
  s_add_u32 s22, s31, 73728
  buffer_load_dwordx4 v[208:211], v2, s[8:11], s22 offen offset:0 sc1
  buffer_load_dwordx4 v[212:215], v2, s[8:11], s22 offen offset:1024 sc1
  buffer_load_dwordx4 v[216:219], v2, s[8:11], s22 offen offset:2048 sc1
  buffer_load_dwordx4 v[220:223], v2, s[8:11], s22 offen offset:3072 sc1
  s_add_u32 s22, s31, 77824
  buffer_load_dwordx4 v[224:227], v2, s[8:11], s22 offen offset:0 sc1
  buffer_load_dwordx4 v[228:231], v2, s[8:11], s22 offen offset:1024 sc1
  buffer_load_dwordx4 v[232:235], v2, s[8:11], s22 offen offset:2048 sc1
  buffer_load_dwordx4 v[236:239], v2, s[8:11], s22 offen offset:3072 sc1
  s_add_u32 s22, s31, 81920
  buffer_load_dwordx4 v[240:243], v2, s[8:11], s22 offen offset:0 sc1
  buffer_load_dwordx4 v[244:247], v2, s[8:11], s22 offen offset:1024 sc1
  buffer_load_dwordx4 v[248:251], v2, s[8:11], s22 offen offset:2048 sc1
  buffer_load_dwordx4 v[252:255], v2, s[8:11], s22 offen offset:3072 sc1
  s_mov_b32 m0, 16384
  s_add_u32 s22, s31, 86016
  buffer_load_dwordx4 v2, s[8:11], s22 offen offset:0 sc1 lds
  buffer_load_dwordx4 v2, s[8:11], s22 offen offset:1024 sc1 lds
  buffer_load_dwordx4 v2, s[8:11], s22 offen offset:2048 sc1 lds
  buffer_load_dwordx4 v2, s[8:11], s22 offen offset:3072 sc1 lds
  s_mov_b32 m0, 20480
  s_add_u32 s22, s31, 90112
  buffer_load_dwordx4 v2, s[8:11], s22 offen offset:0 sc1 lds
  buffer_load_dwordx4 v2, s[8:11], s22 offen offset:1024 sc1 lds
  buffer_load_dwordx4 v2, s[8:11], s22 offen offset:2048 sc1 lds
  buffer_load_dwordx4 v2, s[8:11], s22 offen offset:3072 sc1 lds
  s_mov_b32 m0, 24576
  s_add_u32 s22, s31, 94208
  buffer_load_dwordx4 v2, s[8:11], s22 offen offset:0 sc1 lds
  buffer_load_dwordx4 v2, s[8:11], s22 offen offset:1024 sc1 lds
  buffer_load_dwordx4 v2, s[8:11], s22 offen offset:2048 sc1 lds
  buffer_load_dwordx4 v2, s[8:11], s22 offen offset:3072 sc1 lds
  s_mov_b32 m0, 28672
  s_add_u32 s22, s31, 98304
  buffer_load_dwordx4 v2, s[8:11], s22 offen offset:0 sc1 lds
  buffer_load_dwordx4 v2, s[8:11], s22 offen offset:1024 sc1 lds
  v_mov_b32 v72, v116
  v_mov_b32 v73, v117
  v_lshrrev_b32 v65, 1, v72
  v_and_b32 v66, 1, v72
  v_mov_b32 v36, 0
  v_mov_b32 v37, 0
  v_mov_b32 v38, 0
  v_mov_b32 v39, 0
  v_mov_b32 v40, 0
  v_mov_b32 v41, 0
  v_mov_b32 v42, 0
  v_mov_b32 v43, 0
  v_mov_b32 v44, 0
  v_mov_b32 v45, 0
  v_mov_b32 v46, 0
  v_mov_b32 v47, 0
  v_mov_b32 v48, 0
  v_mov_b32 v49, 0
  v_mov_b32 v50, 0
  v_mov_b32 v51, 0
  v_mov_b32 v52, 0
  v_mov_b32 v53, 0
  v_mov_b32 v54, 0
  v_mov_b32 v55, 0
  v_mov_b32 v56, 0
  v_mov_b32 v57, 0
  v_mov_b32 v58, 0
  v_mov_b32 v59, 0
  v_mov_b32 v60, 0
  v_mov_b32 v61, 0
  v_mov_b32 v62, 0
  v_mov_b32 v63, 0
  v_lshlrev_b32 v75, 2, v65
  v_lshl_add_u32 v75, v66, 3, v75
  v_add_u32 v67, 0, v73
  v_mul_u32_u24 v68, 2341, v67
  v_lshrrev_b32 v68, 16, v68
  v_mul_u32_u24 v69, 28, v68
  v_sub_u32 v69, v67, v69
  v_lshrrev_b32 v70, 4, v69
  v_and_b32 v69, 15, v69
  v_lshlrev_b32 v71, 12, v70
  v_lshl_add_u32 v71, v68, 8, v71
  v_lshl_add_u32 v71, v69, 4, v71
  v_add_u32 v152, v71, v75
  v_add_u32 v67, 16, v73
  v_mul_u32_u24 v68, 2341, v67
  v_lshrrev_b32 v68, 16, v68
  v_mul_u32_u24 v69, 28, v68
  v_sub_u32 v69, v67, v69
  v_lshrrev_b32 v70, 4, v69
  v_and_b32 v69, 15, v69
  v_lshlrev_b32 v71, 12, v70
  v_lshl_add_u32 v71, v68, 8, v71
  v_lshl_add_u32 v71, v69, 4, v71
  v_add_u32 v153, v71, v75
  v_add_u32 v67, 32, v73
  v_mul_u32_u24 v68, 2341, v67
  v_lshrrev_b32 v68, 16, v68
  v_mul_u32_u24 v69, 28, v68
  v_sub_u32 v69, v67, v69
  v_lshrrev_b32 v70, 4, v69
  v_and_b32 v69, 15, v69
  v_lshlrev_b32 v71, 12, v70
  v_lshl_add_u32 v71, v68, 8, v71
  v_lshl_add_u32 v71, v69, 4, v71
  v_add_u32 v154, v71, v75
  v_add_u32 v67, 48, v73
  v_mul_u32_u24 v68, 2341, v67
  v_lshrrev_b32 v68, 16, v68
  v_mul_u32_u24 v69, 28, v68
  v_sub_u32 v69, v67, v69
  v_lshrrev_b32 v70, 4, v69
  v_and_b32 v69, 15, v69
  v_lshlrev_b32 v71, 12, v70
  v_lshl_add_u32 v71, v68, 8, v71
  v_lshl_add_u32 v71, v69, 4, v71
  v_add_u32 v155, v71, v75
  v_add_u32 v67, 64, v73
  v_mul_u32_u24 v68, 2341, v67
  v_lshrrev_b32 v68, 16, v68
  v_mul_u32_u24 v69, 28, v68
  v_sub_u32 v69, v67, v69
  v_lshrrev_b32 v70, 4, v69
  v_and_b32 v69, 15, v69
  v_lshlrev_b32 v71, 12, v70
  v_lshl_add_u32 v71, v68, 8, v71
  v_lshl_add_u32 v71, v69, 4, v71
  v_add_u32 v156, v71, v75
  v_add_u32 v67, 80, v73
  v_mul_u32_u24 v68, 2341, v67
  v_lshrrev_b32 v68, 16, v68
  v_mul_u32_u24 v69, 28, v68
  v_sub_u32 v69, v67, v69
  v_lshrrev_b32 v70, 4, v69
  v_and_b32 v69, 15, v69
  v_lshlrev_b32 v71, 12, v70
  v_lshl_add_u32 v71, v68, 8, v71
  v_lshl_add_u32 v71, v69, 4, v71
  v_add_u32 v157, v71, v75
  v_add_u32 v67, 96, v73
  v_mul_u32_u24 v68, 2341, v67
  v_lshrrev_b32 v68, 16, v68
  v_mul_u32_u24 v69, 28, v68
  v_sub_u32 v69, v67, v69
  v_lshrrev_b32 v70, 4, v69
  v_and_b32 v69, 15, v69
  v_lshlrev_b32 v71, 12, v70
  v_lshl_add_u32 v71, v68, 8, v71
  v_lshl_add_u32 v71, v69, 4, v71
  v_add_u32 v158, v71, v75
  v_mov_b32 v74, 0x40000000
  v_mov_b32 v76, 0
  v_mov_b32 v77, 0
  v_mov_b32 v78, 0
  v_mov_b32 v79, 0
  ds_write_b128 v2, v[76:79] offset:0
  ds_write_b128 v2, v[76:79] offset:1024
  ds_write_b128 v2, v[76:79] offset:2048
  ds_write_b128 v2, v[76:79] offset:3072
  s_and_b32 s22, s17, 3
  s_lshl_b32 s22, s22, 7
  s_add_u32 s22, s22, 75270656
  v_lshl_add_u32 v4, v73, 2, s22
  v_and_b32 v64, 1, v73
  v_mov_b32 v5, 0x05040100
  v_mov_b32 v65, 0x03020706
  v_cmp_eq_u32 vcc, 1, v64
  s_nop 1
  v_cndmask_b32 v5, v5, v65, vcc
  s_lshl_b32 s22, s17, 2
  s_add_u32 s22, s22, 75274752
  v_lshl_add_u32 v7, v1, 7, s22
  v_cmp_gt_u32 vcc, 4, v1
  s_nop 1
  v_cndmask_b32 v7, v74, v7, vcc
  v_mov_b32 v6, v2
  v_lshl_add_u32 v64, v66, 2, v64
  v_and_b32 v65, 2, v72
  v_add_u32 v64, v64, v65
  s_mul_i32 s22, s17, 16
  v_add_u32 v75, s22, v73
  v_lshrrev_b32 v68, 4, v75
  v_lshlrev_b32 v68, 8, v68
  v_bfe_u32 v69, v75, 1, 1
  v_lshl_add_u32 v68, v69, 7, v68
  v_lshl_add_u32 v68, v64, 4, v68
  v_and_b32 v69, 12, v75
  v_add_u32 v1, v68, v69
  s_mul_i32 s22, s17, 1835008
  s_add_u32 s25, s22, 42205184
  v_mov_b32 v162, -1
  s_mov_b32 s38, 0x40000000
  v_add_u32 v0, 16384, v2
  s_mov_b32 s30, 0
  v_mov_b32 v8, 0
ch_md4:
  buffer_load_dword v9, v8, s[12:15], 0 offen sc1
  s_waitcnt vmcnt(0) lgkmcnt(0)
  v_readfirstlane_b32 s22, v9
  s_and_b32 s31, s22, 0xffff
  s_cmp_ge_u32 s31, 32
  s_cbranch_scc1 ch_go4
  s_sleep 2
  s_add_u32 s30, s30, 1
  s_cmp_lt_u32 s30, 3200000
  s_cbranch_scc1 ch_md4
  s_branch ch_end
ch_go4:
  s_mov_b32 s31, 0
  s_lshr_b32 s22, s22, 16
  s_cmp_lg_u32 s22, 0
  s_cbranch_scc1 cB_va0_loop
  s_branch cA_va0_loop
ch_init5:
  s_mul_i32 s31, s17, 401408
  s_add_u32 s31, s31, 6522880
  s_mov_b32 s30, 0
ch_wr5:
  buffer_load_dword v65, off, s[12:15], 0 offset:128 sc1
  s_waitcnt vmcnt(0)
  v_cmp_ne_u32 vcc, 1, v65
  s_cbranch_vccz ch_wr5_ok
  s_sleep 8
  s_add_u32 s30, s30, 1
  s_cmp_lt_u32 s30, 400000
  s_cbranch_scc1 ch_wr5
  s_branch cA_abort
ch_wr5_ok:
  s_lshr_b32 s22, s17, 2
  s_lshl_b32 s28, 0x81, s22
  s_mul_i32 s27, s17, 12
  s_add_u32 s22, s27, 256
  s_lshr_b32 s22, s22, 6
  s_lshl_b32 s22, 0x81, s22
  s_or_b32 s28, s28, s22
  s_add_u32 s22, s27, 267
  s_lshr_b32 s22, s22, 6
  s_lshl_b32 s22, 0x81, s22
  s_or_b32 s28, s28, s22
  v_lshlrev_b32 v64, 7, v116
  s_mov_b32 s27, 88060928
  s_mov_b32 s30, 0
ch_ww5:
  buffer_load_dword v65, v64, s[8:11], s27 offen sc1
  s_waitcnt vmcnt(0)
  v_and_b32 v66, s28, v65
  v_cmp_ne_u32 vcc, s28, v66
  s_cbranch_vccz ch_ww5_ok
  s_sleep 3
  s_add_u32 s30, s30, 1
  s_cmp_lt_u32 s30, 400000
  s_cbranch_scc1 ch_ww5
  s_branch cA_abort
ch_ww5_ok:
  s_add_u32 s22, s31, 0
  buffer_load_dwordx4 a[0:3], v2, s[8:11], s22 offen offset:0 sc1
  buffer_load_dwordx4 a[4:7], v2, s[8:11], s22 offen offset:1024 sc1
  buffer_load_dwordx4 a[8:11], v2, s[8:11], s22 offen offset:2048 sc1
  buffer_load_dwordx4 a[12:15], v2, s[8:11], s22 offen offset:3072 sc1
  s_add_u32 s22, s31, 4096
  buffer_load_dwordx4 a[16:19], v2, s[8:11], s22 offen offset:0 sc1
  buffer_load_dwordx4 a[20:23], v2, s[8:11], s22 offen offset:1024 sc1
  buffer_load_dwordx4 a[24:27], v2, s[8:11], s22 offen offset:2048 sc1
  buffer_load_dwordx4 a[28:31], v2, s[8:11], s22 offen offset:3072 sc1
  s_add_u32 s22, s31, 8192
  buffer_load_dwordx4 a[32:35], v2, s[8:11], s22 offen offset:0 sc1
  buffer_load_dwordx4 a[36:39], v2, s[8:11], s22 offen offset:1024 sc1
  buffer_load_dwordx4 a[40:43], v2, s[8:11], s22 offen offset:2048 sc1
  buffer_load_dwordx4 a[44:47], v2, s[8:11], s22 offen offset:3072 sc1
  s_add_u32 s22, s31, 12288
  buffer_load_dwordx4 a[48:51], v2, s[8:11], s22 offen offset:0 sc1
  buffer_load_dwordx4 a[52:55], v2, s[8:11], s22 offen offset:1024 sc1
  buffer_load_dwordx4 a[56:59], v2, s[8:11], s22 offen offset:2048 sc1
  buffer_load_dwordx4 a[60:63], v2, s[8:11], s22 offen offset:3072 sc1
  s_add_u32 s22, s31, 16384
  buffer_load_dwordx4 a[64:67], v2, s[8:11], s22 offen offset:0 sc1
  buffer_load_dwordx4 a[68:71], v2, s[8:11], s22 offen offset:1024 sc1
  buffer_load_dwordx4 a[72:75], v2, s[8:11], s22 offen offset:2048 sc1
  buffer_load_dwordx4 a[76:79], v2, s[8:11], s22 offen offset:3072 sc1
  s_add_u32 s22, s31, 20480
  buffer_load_dwordx4 a[80:83], v2, s[8:11], s22 offen offset:0 sc1
  buffer_load_dwordx4 a[84:87], v2, s[8:11], s22 offen offset:1024 sc1
  buffer_load_dwordx4 a[88:91], v2, s[8:11], s22 offen offset:2048 sc1
  buffer_load_dwordx4 a[92:95], v2, s[8:11], s22 offen offset:3072 sc1
  s_add_u32 s22, s31, 24576
  buffer_load_dwordx4 a[96:99], v2, s[8:11], s22 offen offset:0 sc1
  buffer_load_dwordx4 a[100:103], v2, s[8:11], s22 offen offset:1024 sc1
  buffer_load_dwordx4 a[104:107], v2, s[8:11], s22 offen offset:2048 sc1
  buffer_load_dwordx4 a[108:111], v2, s[8:11], s22 offen offset:3072 sc1
  s_add_u32 s22, s31, 28672
  buffer_load_dwordx4 a[112:115], v2, s[8:11], s22 offen offset:0 sc1
  buffer_load_dwordx4 a[116:119], v2, s[8:11], s22 offen offset:1024 sc1
  buffer_load_dwordx4 a[120:123], v2, s[8:11], s22 offen offset:2048 sc1
  buffer_load_dwordx4 a[124:127], v2, s[8:11], s22 offen offset:3072 sc1
  s_waitcnt vmcnt(24)
  s_add_u32 s22, s31, 32768
  buffer_load_dwordx4 a[128:131], v2, s[8:11], s22 offen offset:0 sc1
  buffer_load_dwordx4 a[132:135], v2, s[8:11], s22 offen offset:1024 sc1
  buffer_load_dwordx4 a[136:139], v2, s[8:11], s22 offen offset:2048 sc1
  buffer_load_dwordx4 a[140:143], v2, s[8:11], s22 offen offset:3072 sc1
  s_add_u32 s22, s31, 36864
  buffer_load_dwordx4 a[144:147], v2, s[8:11], s22 offen offset:0 sc1
  buffer_load_dwordx4 a[148:151], v2, s[8:11], s22 offen offset:1024 sc1
  buffer_load_dwordx4 a[152:155], v2, s[8:11], s22 offen offset:2048 sc1
  buffer_load_dwordx4 a[156:159], v2, s[8:11], s22 offen offset:3072 sc1
  s_add_u32 s22, s31, 40960
  buffer_load_dwordx4 a[160:163], v2, s[8:11], s22 offen offset:0 sc1
  buffer_load_dwordx4 a[164:167], v2, s[8:11], s22 offen offset:1024 sc1
  buffer_load_dwordx4 a[168:171], v2, s[8:11], s22 offen offset:2048 sc1
  buffer_load_dwordx4 a[172:175], v2, s[8:11], s22 offen offset:3072 sc1
  s_add_u32 s22, s31, 45056
  buffer_load_dwordx4 a[176:179], v2, s[8:11], s22 offen offset:0 sc1
  buffer_load_dwordx4 a[180:183], v2, s[8:11], s22 offen offset:1024 sc1
  buffer_load_dwordx4 a[184:187], v2, s[8:11], s22 offen offset:2048 sc1
  buffer_load_dwordx4 a[188:191], v2, s[8:11], s22 offen offset:3072 sc1
  s_add_u32 s22, s31, 49152
  buffer_load_dwordx4 a[192:195], v2, s[8:11], s22 offen offset:0 sc1
  buffer_load_dwordx4 a[196:199], v2, s[8:11], s22 offen offset:1024 sc1
  buffer_load_dwordx4 a[200:203], v2, s[8:11], s22 offen offset:2048 sc1
  buffer_load_dwordx4 a[204:207], v2, s[8:11], s22 offen offset:3072 sc1
  s_add_u32 s22, s31, 53248
  buffer_load_dwordx4 a[208:211], v2, s[8:11], s22 offen offset:0 sc1
  buffer_load_dwordx4 a[212:215], v2, s[8:11], s22 offen offset:1024 sc1
  buffer_load_dwordx4 a[216:219], v2, s[8:11], s22 offen offset:2048 sc1
  buffer_load_dwordx4 a[220:223], v2, s[8:11], s22 offen offset:3072 sc1
  s_add_u32 s22, s31, 57344
  buffer_load_dwordx4 a[224:227], v2, s[8:11], s22 offen offset:0 sc1
  buffer_load_dwordx4 a[228:231], v2, s[8:11], s22 offen offset:1024 sc1
  buffer_load_dwordx4 a[232:235], v2, s[8:11], s22 offen offset:2048 sc1
  buffer_load_dwordx4 a[236:239], v2, s[8:11], s22 offen offset:3072 sc1
  s_add_u32 s22, s31, 61440
  buffer_load_dwordx4 a[240:243], v2, s[8:11], s22 offen offset:0 sc1
  buffer_load_dwordx4 a[244:247], v2, s[8:11], s22 offen offset:1024 sc1
  buffer_load_dwordx4 a[248:251], v2, s[8:11], s22 offen offset:2048 sc1
  buffer_load_dwordx4 a[252:255], v2, s[8:11], s22 offen offset:3072 sc1
  s_waitcnt vmcnt(24)
  s_add_u32 s22, s31, 65536
  buffer_load_dwordx4 v[176:179], v2, s[8:11], s22 offen offset:0 sc1
  buffer_load_dwordx4 v[180:183], v2, s[8:11], s22 offen offset:1024 sc1
  buffer_load_dwordx4 v[184:187], v2, s[8:11], s22 offen offset:2048 sc1
  buffer_load_dwordx4 v[188:191], v2, s[8:11], s22 offen offset:3072 sc1
  s_add_u32 s22, s31, 69632
  buffer_load_dwordx4 v[192:195], v2, s[8:11], s22 offen offset:0 sc1
  buffer_load_dwordx4 v[196:199], v2, s[8:11], s22 offen offset:1024 sc1
  buffer_load_dwordx4 v[200:203], v2, s[8:11], s22 offen offset:2048 sc1
  buffer_load_dwordx4 v[204:207], v2, s[8:11], s22 offen offset:3072 sc1
  s_add_u32 s22, s31, 73728
  buffer_load_dwordx4 v[208:211], v2, s[8:11], s22 offen offset:0 sc1
  buffer_load_dwordx4 v[212:215], v2, s[8:11], s22 offen offset:1024 sc1
  buffer_load_dwordx4 v[216:219], v2, s[8:11], s22 offen offset:2048 sc1
  buffer_load_dwordx4 v[220:223], v2, s[8:11], s22 offen offset:3072 sc1
  s_add_u32 s22, s31, 77824
  buffer_load_dwordx4 v[224:227], v2, s[8:11], s22 offen offset:0 sc1
  buffer_load_dwordx4 v[228:231], v2, s[8:11], s22 offen offset:1024 sc1
  buffer_load_dwordx4 v[232:235], v2, s[8:11], s22 offen offset:2048 sc1
  buffer_load_dwordx4 v[236:239], v2, s[8:11], s22 offen offset:3072 sc1
  s_add_u32 s22, s31, 81920
  buffer_load_dwordx4 v[240:243], v2, s[8:11], s22 offen offset:0 sc1
  buffer_load_dwordx4 v[244:247], v2, s[8:11], s22 offen offset:1024 sc1
  buffer_load_dwordx4 v[248:251], v2, s[8:11], s22 offen offset:2048 sc1
  buffer_load_dwordx4 v[252:255], v2, s[8:11], s22 offen offset:3072 sc1
  s_mov_b32 m0, 30720
  s_add_u32 s22, s31, 86016
  buffer_load_dwordx4 v2, s[8:11], s22 offen offset:0 sc1 lds
  buffer_load_dwordx4 v2, s[8:11], s22 offen offset:1024 sc1 lds
  buffer_load_dwordx4 v2, s[8:11], s22 offen offset:2048 sc1 lds
  buffer_load_dwordx4 v2, s[8:11], s22 offen offset:3072 sc1 lds
  s_mov_b32 m0, 34816
  s_add_u32 s22, s31, 90112
  buffer_load_dwordx4 v2, s[8:11], s22 offen offset:0 sc1 lds
  buffer_load_dwordx4 v2, s[8:11], s22 offen offset:1024 sc1 lds
  buffer_load_dwordx4 v2, s[8:11], s22 offen offset:2048 sc1 lds
  buffer_load_dwordx4 v2, s[8:11], s22 offen offset:3072 sc1 lds
  s_mov_b32 m0, 38912
  s_add_u32 s22, s31, 94208
  buffer_load_dwordx4 v2, s[8:11], s22 offen offset:0 sc1 lds
  buffer_load_dwordx4 v2, s[8:11], s22 offen offset:1024 sc1 lds
  buffer_load_dwordx4 v2, s[8:11], s22 offen offset:2048 sc1 lds
  buffer_load_dwordx4 v2, s[8:11], s22 offen offset:3072 sc1 lds
  s_mov_b32 m0, 43008
  s_add_u32 s22, s31, 98304
  buffer_load_dwordx4 v2, s[8:11], s22 offen offset:0 sc1 lds
  buffer_load_dwordx4 v2, s[8:11], s22 offen offset:1024 sc1 lds
  v_mov_b32 v72, v116
  v_mov_b32 v73, v117
  v_lshrrev_b32 v65, 1, v72
  v_and_b32 v66, 1, v72
  v_mov_b32 v36, 0
  v_mov_b32 v37, 0
  v_mov_b32 v38, 0
  v_mov_b32 v39, 0
  v_mov_b32 v40, 0
  v_mov_b32 v41, 0
  v_mov_b32 v42, 0
  v_mov_b32 v43, 0
  v_mov_b32 v44, 0
  v_mov_b32 v45, 0
  v_mov_b32 v46, 0
  v_mov_b32 v47, 0
  v_mov_b32 v48, 0
  v_mov_b32 v49, 0
  v_mov_b32 v50, 0
  v_mov_b32 v51, 0
  v_mov_b32 v52, 0
  v_mov_b32 v53, 0
  v_mov_b32 v54, 0
  v_mov_b32 v55, 0
  v_mov_b32 v56, 0
  v_mov_b32 v57, 0
  v_mov_b32 v58, 0
  v_mov_b32 v59, 0
  v_mov_b32 v60, 0
  v_mov_b32 v61, 0
  v_mov_b32 v62, 0
  v_mov_b32 v63, 0
  v_lshlrev_b32 v75, 2, v65
  v_lshl_add_u32 v75, v66, 3, v75
  v_add_u32 v67, 112, v73
  v_mul_u32_u24 v68, 2341, v67
  v_lshrrev_b32 v68, 16, v68
  v_mul_u32_u24 v69, 28, v68
  v_sub_u32 v69, v67, v69
  v_lshrrev_b32 v70, 4, v69
  v_and_b32 v69, 15, v69
  v_lshlrev_b32 v71, 12, v70
  v_lshl_add_u32 v71, v68, 8, v71
  v_lshl_add_u32 v71, v69, 4, v71
  v_add_u32 v152, v71, v75
  v_add_u32 v67, 128, v73
  v_mul_u32_u24 v68, 2341, v67
  v_lshrrev_b32 v68, 16, v68
  v_mul_u32_u24 v69, 28, v68
  v_sub_u32 v69, v67, v69
  v_lshrrev_b32 v70, 4, v69
  v_and_b32 v69, 15, v69
  v_lshlrev_b32 v71, 12, v70
  v_lshl_add_u32 v71, v68, 8, v71
  v_lshl_add_u32 v71, v69, 4, v71
  v_add_u32 v153, v71, v75
  v_add_u32 v67, 144, v73
  v_mul_u32_u24 v68, 2341, v67
  v_lshrrev_b32 v68, 16, v68
  v_mul_u32_u24 v69, 28, v68
  v_sub_u32 v69, v67, v69
  v_lshrrev_b32 v70, 4, v69
  v_and_b32 v69, 15, v69
  v_lshlrev_b32 v71, 12, v70
  v_lshl_add_u32 v71, v68, 8, v71
  v_lshl_add_u32 v71, v69, 4, v71
  v_add_u32 v154, v71, v75
  v_add_u32 v67, 160, v73
  v_mul_u32_u24 v68, 2341, v67
  v_lshrrev_b32 v68, 16, v68
  v_mul_u32_u24 v69, 28, v68
  v_sub_u32 v69, v67, v69
  v_lshrrev_b32 v70, 4, v69
  v_and_b32 v69, 15, v69
  v_lshlrev_b32 v71, 12, v70
  v_lshl_add_u32 v71, v68, 8, v71
  v_lshl_add_u32 v71, v69, 4, v71
  v_add_u32 v155, v71, v75
  v_add_u32 v67, 176, v73
  v_mul_u32_u24 v68, 2341, v67
  v_lshrrev_b32 v68, 16, v68
  v_mul_u32_u24 v69, 28, v68
  v_sub_u32 v69, v67, v69
  v_lshrrev_b32 v70, 4, v69
  v_and_b32 v69, 15, v69
  v_lshlrev_b32 v71, 12, v70
  v_lshl_add_u32 v71, v68, 8, v71
  v_lshl_add_u32 v71, v69, 4, v71
  v_add_u32 v156, v71, v75
  v_add_u32 v67, 192, v73
  v_mul_u32_u24 v68, 2341, v67
  v_lshrrev_b32 v68, 16, v68
  v_mul_u32_u24 v69, 28, v68
  v_sub_u32 v69, v67, v69
  v_lshrrev_b32 v70, 4, v69
  v_and_b32 v69, 15, v69
  v_lshlrev_b32 v71, 12, v70
  v_lshl_add_u32 v71, v68, 8, v71
  v_lshl_add_u32 v71, v69, 4, v71
  v_add_u32 v157, v71, v75
  v_add_u32 v67, 208, v73
  v_mul_u32_u24 v68, 2341, v67
  v_lshrrev_b32 v68, 16, v68
  v_mul_u32_u24 v69, 28, v68
  v_sub_u32 v69, v67, v69
  v_lshrrev_b32 v70, 4, v69
  v_and_b32 v69, 15, v69
  v_lshlrev_b32 v71, 12, v70
  v_lshl_add_u32 v71, v68, 8, v71
  v_lshl_add_u32 v71, v69, 4, v71
  v_add_u32 v158, v71, v75
  v_mov_b32 v74, 0x40000000
  v_mov_b32 v76, 0
  v_mov_b32 v77, 0
  v_mov_b32 v78, 0
  v_mov_b32 v79, 0
  ds_write_b128 v2, v[76:79] offset:4096
  ds_write_b128 v2, v[76:79] offset:5120
  ds_write_b128 v2, v[76:79] offset:6144
  ds_write_b128 v2, v[76:79] offset:7168
  s_and_b32 s22, s17, 3
  s_lshl_b32 s22, s22, 7
  s_add_u32 s22, s22, 75270656
  v_lshl_add_u32 v4, v73, 2, s22
  v_and_b32 v64, 1, v73
  v_mov_b32 v5, 0x05040100
  v_mov_b32 v65, 0x03020706
  v_cmp_eq_u32 vcc, 1, v64
  s_nop 1
  v_cndmask_b32 v5, v5, v65, vcc
  s_lshl_b32 s22, s17, 2
  s_add_u32 s22, s22, 75274752
  v_lshl_add_u32 v7, v1, 7, s22
  v_cmp_gt_u32 vcc, 4, v1
  s_nop 1
  v_cndmask_b32 v7, v74, v7, vcc
  v_min_u32 v65, 11, v73
  v_mad_u32_u24 v65, v72, 12, v65
  v_lshlrev_b32 v6, 4, v65
  v_add_u32 v6, 1024, v6
  v_lshl_add_u32 v64, v66, 2, v64
  v_and_b32 v65, 2, v72
  v_add_u32 v64, v64, v65
  s_mul_i32 s22, s17, 12
  s_add_u32 s22, s22, 256
  v_add_u32 v75, s22, v73
  v_lshrrev_b32 v68, 4, v75
  v_lshlrev_b32 v68, 8, v68
  v_bfe_u32 v69, v75, 1, 1
  v_lshl_add_u32 v68, v69, 7, v68
  v_lshl_add_u32 v68, v64, 4, v68
  v_and_b32 v69, 12, v75
  v_add_u32 v1, v68, v69
  v_cmp_gt_u32 vcc, 12, v73
  s_nop 1
  v_cndmask_b32 v1, v74, v1, vcc
  s_mul_i32 s22, s17, 1835008
  s_add_u32 s25, s22, 42205184
  v_mov_b32 v162, -1
  s_mov_b32 s38, 0x40000000
  v_add_u32 v0, 30720, v2
  s_mov_b32 s30, 0
  v_mov_b32 v8, 0
ch_md5:
  buffer_load_dword v9, v8, s[12:15], 0 offen sc1
  s_waitcnt vmcnt(0) lgkmcnt(0)
  v_readfirstlane_b32 s22, v9
  s_and_b32 s31, s22, 0xffff
  s_cmp_ge_u32 s31, 32
  s_cbranch_scc1 ch_go5
  s_sleep 2
  s_add_u32 s30, s30, 1
  s_cmp_lt_u32 s30, 3200000
  s_cbranch_scc1 ch_md5
  s_branch ch_end
ch_go5:
  s_mov_b32 s31, 0
  s_lshr_b32 s22, s22, 16
  s_cmp_lg_u32 s22, 0
  s_cbranch_scc1 cB_va1_loop
  s_branch cA_va1_loop
ch_init6:
  s_mul_i32 s31, s17, 401408
  s_add_u32 s31, s31, 6623232
  s_mov_b32 s30, 0
ch_wr6:
  buffer_load_dword v65, off, s[12:15], 0 offset:128 sc1
  s_waitcnt vmcnt(0)
  v_cmp_ne_u32 vcc, 1, v65
  s_cbranch_vccz ch_wr6_ok
  s_sleep 8
  s_add_u32 s30, s30, 1
  s_cmp_lt_u32 s30, 400000
  s_cbranch_scc1 ch_wr6
  s_branch cA_abort
ch_wr6_ok:
  s_lshr_b32 s22, s17, 2
  s_lshl_b32 s28, 0x81, s22
  s_mul_i32 s27, s17, 12
  s_add_u32 s22, s27, 256
  s_lshr_b32 s22, s22, 6
  s_lshl_b32 s22, 0x81, s22
  s_or_b32 s28, s28, s22
  s_add_u32 s22, s27, 267
  s_lshr_b32 s22, s22, 6
  s_lshl_b32 s22, 0x81, s22
  s_or_b32 s28, s28, s22
  v_lshlrev_b32 v64, 7, v116
  s_mov_b32 s27, 88061440
  s_mov_b32 s30, 0
ch_ww6:
  buffer_load_dword v65, v64, s[8:11], s27 offen sc1
  s_waitcnt vmcnt(0)
  v_and_b32 v66, s28, v65
  v_cmp_ne_u32 vcc, s28, v66
  s_cbranch_vccz ch_ww6_ok
  s_sleep 3
  s_add_u32 s30, s30, 1
  s_cmp_lt_u32 s30, 400000
  s_cbranch_scc1 ch_ww6
  s_branch cA_abort
ch_ww6_ok:
  s_add_u32 s22, s31, 0
  buffer_load_dwordx4 a[0:3], v2, s[8:11], s22 offen offset:0 sc1
  buffer_load_dwordx4 a[4:7], v2, s[8:11], s22 offen offset:1024 sc1
  buffer_load_dwordx4 a[8:11], v2, s[8:11], s22 offen offset:2048 sc1
  buffer_load_dwordx4 a[12:15], v2, s[8:11], s22 offen offset:3072 sc1
  s_add_u32 s22, s31, 4096
  buffer_load_dwordx4 a[16:19], v2, s[8:11], s22 offen offset:0 sc1
  buffer_load_dwordx4 a[20:23], v2, s[8:11], s22 offen offset:1024 sc1
  buffer_load_dwordx4 a[24:27], v2, s[8:11], s22 offen offset:2048 sc1
  buffer_load_dwordx4 a[28:31], v2, s[8:11], s22 offen offset:3072 sc1
  s_add_u32 s22, s31, 8192
  buffer_load_dwordx4 a[32:35], v2, s[8:11], s22 offen offset:0 sc1
  buffer_load_dwordx4 a[36:39], v2, s[8:11], s22 offen offset:1024 sc1
  buffer_load_dwordx4 a[40:43], v2, s[8:11], s22 offen offset:2048 sc1
  buffer_load_dwordx4 a[44:47], v2, s[8:11], s22 offen offset:3072 sc1
  s_add_u32 s22, s31, 12288
  buffer_load_dwordx4 a[48:51], v2, s[8:11], s22 offen offset:0 sc1
  buffer_load_dwordx4 a[52:55], v2, s[8:11], s22 offen offset:1024 sc1
  buffer_load_dwordx4 a[56:59], v2, s[8:11], s22 offen offset:2048 sc1
  buffer_load_dwordx4 a[60:63], v2, s[8:11], s22 offen offset:3072 sc1
  s_add_u32 s22, s31, 16384
  buffer_load_dwordx4 a[64:67], v2, s[8:11], s22 offen offset:0 sc1
  buffer_load_dwordx4 a[68:71], v2, s[8:11], s22 offen offset:1024 sc1
  buffer_load_dwordx4 a[72:75], v2, s[8:11], s22 offen offset:2048 sc1
  buffer_load_dwordx4 a[76:79], v2, s[8:11], s22 offen offset:3072 sc1
  s_add_u32 s22, s31, 20480
  buffer_load_dwordx4 a[80:83], v2, s[8:11], s22 offen offset:0 sc1
  buffer_load_dwordx4 a[84:87], v2, s[8:11], s22 offen offset:1024 sc1
  buffer_load_dwordx4 a[88:91], v2, s[8:11], s22 offen offset:2048 sc1
  buffer_load_dwordx4 a[92:95], v2, s[8:11], s22 offen offset:3072 sc1
  s_add_u32 s22, s31, 24576
  buffer_load_dwordx4 a[96:99], v2, s[8:11], s22 offen offset:0 sc1
  buffer_load_dwordx4 a[100:103], v2, s[8:11], s22 offen offset:1024 sc1
  buffer_load_dwordx4 a[104:107], v2, s[8:11], s22 offen offset:2048 sc1
  buffer_load_dwordx4 a[108:111], v2, s[8:11], s22 offen offset:3072 sc1
  s_add_u32 s22, s31, 28672
  buffer_load_dwordx4 a[112:115], v2, s[8:11], s22 offen offset:0 sc1
  buffer_load_dwordx4 a[116:119], v2, s[8:11], s22 offen offset:1024 sc1
  buffer_load_dwordx4 a[120:123], v2, s[8:11], s22 offen offset:2048 sc1
  buffer_load_dwordx4 a[124:127], v2, s[8:11], s22 offen offset:3072 sc1
  s_waitcnt vmcnt(24)
  s_add_u32 s22, s31, 32768
  buffer_load_dwordx4 a[128:131], v2, s[8:11], s22 offen offset:0 sc1
  buffer_load_dwordx4 a[132:135], v2, s[8:11], s22 offen offset:1024 sc1
  buffer_load_dwordx4 a[136:139], v2, s[8:11], s22 offen offset:2048 sc1
  buffer_load_dwordx4 a[140:143], v2, s[8:11], s22 offen offset:3072 sc1
  s_add_u32 s22, s31, 36864
  buffer_load_dwordx4 a[144:147], v2, s[8:11], s22 offen offset:0 sc1
  buffer_load_dwordx4 a[148:151], v2, s[8:11], s22 offen offset:1024 sc1
  buffer_load_dwordx4 a[152:155], v2, s[8:11], s22 offen offset:2048 sc1
  buffer_load_dwordx4 a[156:159], v2, s[8:11], s22 offen offset:3072 sc1
  s_add_u32 s22, s31, 40960
  buffer_load_dwordx4 a[160:163], v2, s[8:11], s22 offen offset:0 sc1
  buffer_load_dwordx4 a[164:167], v2, s[8:11], s22 offen offset:1024 sc1
  buffer_load_dwordx4 a[168:171], v2, s[8:11], s22 offen offset:2048 sc1
  buffer_load_dwordx4 a[172:175], v2, s[8:11], s22 offen offset:3072 sc1
  s_add_u32 s22, s31, 45056
  buffer_load_dwordx4 a[176:179], v2, s[8:11], s22 offen offset:0 sc1
  buffer_load_dwordx4 a[180:183], v2, s[8:11], s22 offen offset:1024 sc1
  buffer_load_dwordx4 a[184:187], v2, s[8:11], s22 offen offset:2048 sc1
  buffer_load_dwordx4 a[188:191], v2, s[8:11], s22 offen offset:3072 sc1
  s_add_u32 s22, s31, 49152
  buffer_load_dwordx4 a[192:195], v2, s[8:11], s22 offen offset:0 sc1
  buffer_load_dwordx4 a[196:199], v2, s[8:11], s22 offen offset:1024 sc1
  buffer_load_dwordx4 a[200:203], v2, s[8:11], s22 offen offset:2048 sc1
  buffer_load_dwordx4 a[204:207], v2, s[8:11], s22 offen offset:3072 sc1
  s_add_u32 s22, s31, 53248
  buffer_load_dwordx4 a[208:211], v2, s[8:11], s22 offen offset:0 sc1
  buffer_load_dwordx4 a[212:215], v2, s[8:11], s22 offen offset:1024 sc1
  buffer_load_dwordx4 a[216:219], v2, s[8:11], s22 offen offset:2048 sc1
  buffer_load_dwordx4 a[220:223], v2, s[8:11], s22 offen offset:3072 sc1
  s_add_u32 s22, s31, 57344
  buffer_load_dwordx4 a[224:227], v2, s[8:11], s22 offen offset:0 sc1
  buffer_load_dwordx4 a[228:231], v2, s[8:11], s22 offen offset:1024 sc1
  buffer_load_dwordx4 a[232:235], v2, s[8:11], s22 offen offset:2048 sc1
  buffer_load_dwordx4 a[236:239], v2, s[8:11], s22 offen offset:3072 sc1
  s_add_u32 s22, s31, 61440
  buffer_load_dwordx4 a[240:243], v2, s[8:11], s22 offen offset:0 sc1
  buffer_load_dwordx4 a[244:247], v2, s[8:11], s22 offen offset:1024 sc1
  buffer_load_dwordx4 a[248:251], v2, s[8:11], s22 offen offset:2048 sc1
  buffer_load_dwordx4 a[252:255], v2, s[8:11], s22 offen offset:3072 sc1
  s_waitcnt vmcnt(24)
  s_add_u32 s22, s31, 65536
  buffer_load_dwordx4 v[120:123], v2, s[8:11], s22 offen offset:0 sc1
  buffer_load_dwordx4 v[124:127], v2, s[8:11], s22 offen offset:1024 sc1
  buffer_load_dwordx4 v[128:131], v2, s[8:11], s22 offen offset:2048 sc1
  buffer_load_dwordx4 v[132:135], v2, s[8:11], s22 offen offset:3072 sc1
  s_add_u32 s22, s31, 69632
  buffer_load_dwordx4 v[136:139], v2, s[8:11], s22 offen offset:0 sc1
  buffer_load_dwordx4 v[140:143], v2, s[8:11], s22 offen offset:1024 sc1
  buffer_load_dwordx4 v[144:147], v2, s[8:11], s22 offen offset:2048 sc1
  buffer_load_dwordx4 v[148:151], v2, s[8:11], s22 offen offset:3072 sc1
  s_add_u32 s22, s31, 73728
  buffer_load_dwordx4 v[152:155], v2, s[8:11], s22 offen offset:0 sc1
  buffer_load_dwordx4 v[156:159], v2, s[8:11], s22 offen offset:1024 sc1
  buffer_load_dwordx4 v[160:163], v2, s[8:11], s22 offen offset:2048 sc1
  buffer_load_dwordx4 v[164:167], v2, s[8:11], s22 offen offset:3072 sc1
  s_add_u32 s22, s31, 77824
  buffer_load_dwordx4 v[168:171], v2, s[8:11], s22 offen offset:0 sc1
  buffer_load_dwordx4 v[172:175], v2, s[8:11], s22 offen offset:1024 sc1
  buffer_load_dwordx4 v[176:179], v2, s[8:11], s22 offen offset:2048 sc1
  buffer_load_dwordx4 v[180:183], v2, s[8:11], s22 offen offset:3072 sc1
  s_add_u32 s22, s31, 81920
  buffer_load_dwordx4 v[184:187], v2, s[8:11], s22 offen offset:0 sc1
  buffer_load_dwordx4 v[188:191], v2, s[8:11], s22 offen offset:1024 sc1
  buffer_load_dwordx4 v[192:195], v2, s[8:11], s22 offen offset:2048 sc1
  buffer_load_dwordx4 v[196:199], v2, s[8:11], s22 offen offset:3072 sc1
  s_add_u32 s22, s31, 86016
  buffer_load_dwordx4 v[200:203], v2, s[8:11], s22 offen offset:0 sc1
  buffer_load_dwordx4 v[204:207], v2, s[8:11], s22 offen offset:1024 sc1
  buffer_load_dwordx4 v[208:211], v2, s[8:11], s22 offen offset:2048 sc1
  buffer_load_dwordx4 v[212:215], v2, s[8:11], s22 offen offset:3072 sc1
  s_add_u32 s22, s31, 90112
  buffer_load_dwordx4 v[216:219], v2, s[8:11], s22 offen offset:0 sc1
  buffer_load_dwordx4 v[220:223], v2, s[8:11], s22 offen offset:1024 sc1
  buffer_load_dwordx4 v[224:227], v2, s[8:11], s22 offen offset:2048 sc1
  buffer_load_dwordx4 v[228:231], v2, s[8:11], s22 offen offset:3072 sc1
  s_add_u32 s22, s31, 94208
  buffer_load_dwordx4 v[232:235], v2, s[8:11], s22 offen offset:0 sc1
  buffer_load_dwordx4 v[236:239], v2, s[8:11], s22 offen offset:1024 sc1
  buffer_load_dwordx4 v[240:243], v2, s[8:11], s22 offen offset:2048 sc1
  buffer_load_dwordx4 v[244:247], v2, s[8:11], s22 offen offset:3072 sc1
  s_waitcnt vmcnt(24)
  s_add_u32 s22, s31, 98304
  buffer_load_dwordx4 v[248:251], v2, s[8:11], s22 offen offset:0 sc1
  buffer_load_dwordx4 v[252:255], v2, s[8:11], s22 offen offset:1024 sc1
  v_mov_b32 v72, v116
  v_mov_b32 v73, v117
  v_lshrrev_b32 v65, 1, v72
  v_and_b32 v66, 1, v72
  v_mov_b32 v36, 0
  v_mov_b32 v37, 0
  v_mov_b32 v38, 0
  v_mov_b32 v39, 0
  v_mov_b32 v40, 0
  v_mov_b32 v41, 0
  v_mov_b32 v42, 0
  v_mov_b32 v43, 0
  v_mov_b32 v44, 0
  v_mov_b32 v45, 0
  v_mov_b32 v46, 0
  v_mov_b32 v47, 0
  v_mov_b32 v48, 0
  v_mov_b32 v49, 0
  v_mov_b32 v50, 0
  v_mov_b32 v51, 0
  v_mov_b32 v52, 0
  v_mov_b32 v53, 0
  v_mov_b32 v54, 0
  v_mov_b32 v55, 0
  v_mov_b32 v56, 0
  v_mov_b32 v57, 0
  v_mov_b32 v58, 0
  v_mov_b32 v59, 0
  v_mov_b32 v60, 0
  v_mov_b32 v61, 0
  v_mov_b32 v62, 0
  v_mov_b32 v63, 0
  v_lshlrev_b32 v75, 2, v65
  v_lshl_add_u32 v75, v66, 3, v75
  v_add_u32 v67, 224, v73
  v_mul_u32_u24 v68, 2341, v67
  v_lshrrev_b32 v68, 16, v68
  v_mul_u32_u24 v69, 28, v68
  v_sub_u32 v69, v67, v69
  v_lshrrev_b32 v70, 4, v69
  v_and_b32 v69, 15, v69
  v_lshlrev_b32 v71, 12, v70
  v_lshl_add_u32 v71, v68, 8, v71
  v_lshl_add_u32 v71, v69, 4, v71
  v_add_u32 v104, v71, v75
  v_add_u32 v67, 240, v73
  v_mul_u32_u24 v68, 2341, v67
  v_lshrrev_b32 v68, 16, v68
  v_mul_u32_u24 v69, 28, v68
  v_sub_u32 v69, v67, v69
  v_lshrrev_b32 v70, 4, v69
  v_and_b32 v69, 15, v69
  v_lshlrev_b32 v71, 12, v70
  v_lshl_add_u32 v71, v68, 8, v71
  v_lshl_add_u32 v71, v69, 4, v71
  v_add_u32 v105, v71, v75
  v_add_u32 v67, 256, v73
  v_mul_u32_u24 v68, 2341, v67
  v_lshrrev_b32 v68, 16, v68
  v_mul_u32_u24 v69, 28, v68
  v_sub_u32 v69, v67, v69
  v_lshrrev_b32 v70, 4, v69
  v_and_b32 v69, 15, v69
  v_lshlrev_b32 v71, 12, v70
  v_lshl_add_u32 v71, v68, 8, v71
  v_lshl_add_u32 v71, v69, 4, v71
  v_add_u32 v106, v71, v75
  v_add_u32 v67, 272, v73
  v_mul_u32_u24 v68, 2341, v67
  v_lshrrev_b32 v68, 16, v68
  v_mul_u32_u24 v69, 28, v68
  v_sub_u32 v69, v67, v69
  v_lshrrev_b32 v70, 4, v69
  v_and_b32 v69, 15, v69
  v_lshlrev_b32 v71, 12, v70
  v_lshl_add_u32 v71, v68, 8, v71
  v_lshl_add_u32 v71, v69, 4, v71
  v_add_u32 v107, v71, v75
  v_add_u32 v67, 288, v73
  v_mul_u32_u24 v68, 2341, v67
  v_lshrrev_b32 v68, 16, v68
  v_mul_u32_u24 v69, 28, v68
  v_sub_u32 v69, v67, v69
  v_lshrrev_b32 v70, 4, v69
  v_and_b32 v69, 15, v69
  v_lshlrev_b32 v71, 12, v70
  v_lshl_add_u32 v71, v68, 8, v71
  v_lshl_add_u32 v71, v69, 4, v71
  v_add_u32 v108, v71, v75
  v_add_u32 v67, 304, v73
  v_mul_u32_u24 v68, 2341, v67
  v_lshrrev_b32 v68, 16, v68
  v_mul_u32_u24 v69, 28, v68
  v_sub_u32 v69, v67, v69
  v_lshrrev_b32 v70, 4, v69
  v_and_b32 v69, 15, v69
  v_lshlrev_b32 v71, 12, v70
  v_lshl_add_u32 v71, v68, 8, v71
  v_lshl_add_u32 v71, v69, 4, v71
  v_add_u32 v109, v71, v75
  v_add_u32 v67, 320, v73
  v_mul_u32_u24 v68, 2341, v67
  v_lshrrev_b32 v68, 16, v68
  v_mul_u32_u24 v69, 28, v68
  v_sub_u32 v69, v67, v69
  v_lshrrev_b32 v70, 4, v69
  v_and_b32 v69, 15, v69
  v_lshlrev_b32 v71, 12, v70
  v_lshl_add_u32 v71, v68, 8, v71
  v_lshl_add_u32 v71, v69, 4, v71
  v_add_u32 v110, v71, v75
  v_mov_b32 v74, 0x40000000
  v_and_b32 v119, 15, v1
  s_and_b32 s22, s17, 3
  s_lshl_b32 s22, s22, 7
  s_add_u32 s22, s22, 75274752
  v_lshl_add_u32 v119, v119, 2, s22
  s_lshl_b32 s22, s17, 2
  s_add_u32 s22, s22, 75272704
  v_lshl_add_u32 v118, v1, 7, s22
  v_cmp_gt_u32 vcc, 4, v1
  s_nop 1
  v_cndmask_b32 v118, v74, v118, vcc
  s_lshl_b32 s35, s17, 7
  s_add_u32 s35, s35, 88002560
  v_min_u32 v116, 13, v1
  s_mul_i32 s22, s17, 14
  v_add_u32 v116, s22, v116
  v_lshlrev_b32 v116, 7, v116
  s_mov_b32 s39, 71593984
  s_mov_b32 s39, 71622656
  s_mov_b32 s30, 0
ch_vw6i:
  buffer_load_dword v9, off, s[12:15], 0 offset:132 sc1
  s_waitcnt vmcnt(0)
  v_cmp_ne_u32 vcc, 1, v9
  s_cbranch_vccz ch_vw6i_ok
  s_sleep 8
  s_add_u32 s30, s30, 1
  s_cmp_lt_u32 s30, 400000
  s_cbranch_scc1 ch_vw6i
  s_branch cA_abort
ch_vw6i_ok:
  s_lshl_b32 s27, s17, 7
  s_add_u32 s27, s27, 88002560
  s_mov_b32 s30, 0
ch_vw6:
  buffer_load_dword v9, off, s[8:11], s27 sc1
  s_waitcnt vmcnt(0)
  v_cmp_ne_u32 vcc, 56, v9
  s_cbranch_vccz ch_vw6_d
  s_sleep 2
  s_add_u32 s30, s30, 1
  s_cmp_lt_u32 s30, 400000
  s_cbranch_scc1 ch_vw6
  s_branch cA_abort
ch_vw6_d:
  s_mov_b32 s30, 0
  v_mov_b32 v8, 0
ch_md6:
  buffer_load_dword v9, v8, s[12:15], 0 offen sc1
  s_waitcnt vmcnt(0) lgkmcnt(0)
  v_readfirstlane_b32 s22, v9
  s_and_b32 s31, s22, 0xffff
  s_cmp_ge_u32 s31, 32
  s_cbranch_scc1 ch_go6
  s_sleep 2
  s_add_u32 s30, s30, 1
  s_cmp_lt_u32 s30, 3200000
  s_cbranch_scc1 ch_md6
  s_branch ch_end
ch_go6:
  s_mov_b32 s31, 0
  s_lshr_b32 s22, s22, 16
  s_cmp_lg_u32 s22, 0
  s_cbranch_scc1 cB_va2_loop
  s_branch cA_va2_loop
ch_init7:
  s_mul_i32 s31, s17, 401408
  s_add_u32 s31, s31, 6723584
  s_mov_b32 s30, 0
ch_wr7:
  buffer_load_dword v65, off, s[12:15], 0 offset:128 sc1
  s_waitcnt vmcnt(0)
  v_cmp_ne_u32 vcc, 1, v65
  s_cbranch_vccz ch_wr7_ok
  s_sleep 8
  s_add_u32 s30, s30, 1
  s_cmp_lt_u32 s30, 400000
  s_cbranch_scc1 ch_wr7
  s_branch cA_abort
ch_wr7_ok:
  s_lshr_b32 s22, s17, 2
  s_lshl_b32 s28, 0x81, s22
  s_mul_i32 s27, s17, 12
  s_add_u32 s22, s27, 256
  s_lshr_b32 s22, s22, 6
  s_lshl_b32 s22, 0x81, s22
  s_or_b32 s28, s28, s22
  s_add_u32 s22, s27, 267
  s_lshr_b32 s22, s22, 6
  s_lshl_b32 s22, 0x81, s22
  s_or_b32 s28, s28, s22
  v_lshlrev_b32 v64, 7, v116
  s_mov_b32 s27, 88061952
  s_mov_b32 s30, 0
ch_ww7:
  buffer_load_dword v65, v64, s[8:11], s27 offen sc1
  s_waitcnt vmcnt(0)
  v_and_b32 v66, s28, v65
  v_cmp_ne_u32 vcc, s28, v66
  s_cbranch_vccz ch_ww7_ok
  s_sleep 3
  s_add_u32 s30, s30, 1
  s_cmp_lt_u32 s30, 400000
  s_cbranch_scc1 ch_ww7
  s_branch cA_abort
ch_ww7_ok:
  s_add_u32 s22, s31, 0
  buffer_load_dwordx4 a[0:3], v2, s[8:11], s22 offen offset:0 sc1
  buffer_load_dwordx4 a[4:7], v2, s[8:11], s22 offen offset:1024 sc1
  buffer_load_dwordx4 a[8:11], v2, s[8:11], s22 offen offset:2048 sc1
  buffer_load_dwordx4 a[12:15], v2, s[8:11], s22 offen offset:3072 sc1
  s_add_u32 s22, s31, 4096
  buffer_load_dwordx4 a[16:19], v2, s[8:11], s22 offen offset:0 sc1
  buffer_load_dwordx4 a[20:23], v2, s[8:11], s22 offen offset:1024 sc1
  buffer_load_dwordx4 a[24:27], v2, s[8:11], s22 offen offset:2048 sc1
  buffer_load_dwordx4 a[28:31], v2, s[8:11], s22 offen offset:3072 sc1
  s_add_u32 s22, s31, 8192
  buffer_load_dwordx4 a[32:35], v2, s[8:11], s22 offen offset:0 sc1
  buffer_load_dwordx4 a[36:39], v2, s[8:11], s22 offen offset:1024 sc1
  buffer_load_dwordx4 a[40:43], v2, s[8:11], s22 offen offset:2048 sc1
  buffer_load_dwordx4 a[44:47], v2, s[8:11], s22 offen offset:3072 sc1
  s_add_u32 s22, s31, 12288
  buffer_load_dwordx4 a[48:51], v2, s[8:11], s22 offen offset:0 sc1
  buffer_load_dwordx4 a[52:55], v2, s[8:11], s22 offen offset:1024 sc1
  buffer_load_dwordx4 a[56:59], v2, s[8:11], s22 offen offset:2048 sc1
  buffer_load_dwordx4 a[60:63], v2, s[8:11], s22 offen offset:3072 sc1
  s_add_u32 s22, s31, 16384
  buffer_load_dwordx4 a[64:67], v2, s[8:11], s22 offen offset:0 sc1
  buffer_load_dwordx4 a[68:71], v2, s[8:11], s22 offen offset:1024 sc1
  buffer_load_dwordx4 a[72:75], v2, s[8:11], s22 offen offset:2048 sc1
  buffer_load_dwordx4 a[76:79], v2, s[8:11], s22 offen offset:3072 sc1
  s_add_u32 s22, s31, 20480
  buffer_load_dwordx4 a[80:83], v2, s[8:11], s22 offen offset:0 sc1
  buffer_load_dwordx4 a[84:87], v2, s[8:11], s22 offen offset:1024 sc1
  buffer_load_dwordx4 a[88:91], v2, s[8:11], s22 offen offset:2048 sc1
  buffer_load_dwordx4 a[92:95], v2, s[8:11], s22 offen offset:3072 sc1
  s_add_u32 s22, s31, 24576
  buffer_load_dwordx4 a[96:99], v2, s[8:11], s22 offen offset:0 sc1
  buffer_load_dwordx4 a[100:103], v2, s[8:11], s22 offen offset:1024 sc1
  buffer_load_dwordx4 a[104:107], v2, s[8:11], s22 offen offset:2048 sc1
  buffer_load_dwordx4 a[108:111], v2, s[8:11], s22 offen offset:3072 sc1
  s_add_u32 s22, s31, 28672
  buffer_load_dwordx4 a[112:115], v2, s[8:11], s22 offen offset:0 sc1
  buffer_load_dwordx4 a[116:119], v2, s[8:11], s22 offen offset:1024 sc1
  buffer_load_dwordx4 a[120:123], v2, s[8:11], s22 offen offset:2048 sc1
  buffer_load_dwordx4 a[124:127], v2, s[8:11], s22 offen offset:3072 sc1
  s_waitcnt vmcnt(24)
  s_add_u32 s22, s31, 32768
  buffer_load_dwordx4 a[128:131], v2, s[8:11], s22 offen offset:0 sc1
  buffer_load_dwordx4 a[132:135], v2, s[8:11], s22 offen offset:1024 sc1
  buffer_load_dwordx4 a[136:139], v2, s[8:11], s22 offen offset:2048 sc1
  buffer_load_dwordx4 a[140:143], v2, s[8:11], s22 offen offset:3072 sc1
  s_add_u32 s22, s31, 36864
  buffer_load_dwordx4 a[144:147], v2, s[8:11], s22 offen offset:0 sc1
  buffer_load_dwordx4 a[148:151], v2, s[8:11], s22 offen offset:1024 sc1
  buffer_load_dwordx4 a[152:155], v2, s[8:11], s22 offen offset:2048 sc1
  buffer_load_dwordx4 a[156:159], v2, s[8:11], s22 offen offset:3072 sc1
  s_add_u32 s22, s31, 40960
  buffer_load_dwordx4 a[160:163], v2, s[8:11], s22 offen offset:0 sc1
  buffer_load_dwordx4 a[164:167], v2, s[8:11], s22 offen offset:1024 sc1
  buffer_load_dwordx4 a[168:171], v2, s[8:11], s22 offen offset:2048 sc1
  buffer_load_dwordx4 a[172:175], v2, s[8:11], s22 offen offset:3072 sc1
  s_add_u32 s22, s31, 45056
  buffer_load_dwordx4 a[176:179], v2, s[8:11], s22 offen offset:0 sc1
  buffer_load_dwordx4 a[180:183], v2, s[8:11], s22 offen offset:1024 sc1
  buffer_load_dwordx4 a[184:187], v2, s[8:11], s22 offen offset:2048 sc1
  buffer_load_dwordx4 a[188:191], v2, s[8:11], s22 offen offset:3072 sc1
  s_add_u32 s22, s31, 49152
  buffer_load_dwordx4 a[192:195], v2, s[8:11], s22 offen offset:0 sc1
  buffer_load_dwordx4 a[196:199], v2, s[8:11], s22 offen offset:1024 sc1
  buffer_load_dwordx4 a[200:203], v2, s[8:11], s22 offen offset:2048 sc1
  buffer_load_dwordx4 a[204:207], v2, s[8:11], s22 offen offset:3072 sc1
  s_add_u32 s22, s31, 53248
  buffer_load_dwordx4 a[208:211], v2, s[8:11], s22 offen offset:0 sc1
  buffer_load_dwordx4 a[212:215], v2, s[8:11], s22 offen offset:1024 sc1
  buffer_load_dwordx4 a[216:219], v2, s[8:11], s22 offen offset:2048 sc1
  buffer_load_dwordx4 a[220:223], v2, s[8:11], s22 offen offset:3072 sc1
  s_add_u32 s22, s31, 57344
  buffer_load_dwordx4 a[224:227], v2, s[8:11], s22 offen offset:0 sc1
  buffer_load_dwordx4 a[228:231], v2, s[8:11], s22 offen offset:1024 sc1
  buffer_load_dwordx4 a[232:235], v2, s[8:11], s22 offen offset:2048 sc1
  buffer_load_dwordx4 a[236:239], v2, s[8:11], s22 offen offset:3072 sc1
  s_add_u32 s22, s31, 61440
  buffer_load_dwordx4 a[240:243], v2, s[8:11], s22 offen offset:0 sc1
  buffer_load_dwordx4 a[244:247], v2, s[8:11], s22 offen offset:1024 sc1
  buffer_load_dwordx4 a[248:251], v2, s[8:11], s22 offen offset:2048 sc1
  buffer_load_dwordx4 a[252:255], v2, s[8:11], s22 offen offset:3072 sc1
  s_waitcnt vmcnt(24)
  s_add_u32 s22, s31, 65536
  buffer_load_dwordx4 v[120:123], v2, s[8:11], s22 offen offset:0 sc1
  buffer_load_dwordx4 v[124:127], v2, s[8:11], s22 offen offset:1024 sc1
  buffer_load_dwordx4 v[128:131], v2, s[8:11], s22 offen offset:2048 sc1
  buffer_load_dwordx4 v[132:135], v2, s[8:11], s22 offen offset:3072 sc1
  s_add_u32 s22, s31, 69632
  buffer_load_dwordx4 v[136:139], v2, s[8:11], s22 offen offset:0 sc1
  buffer_load_dwordx4 v[140:143], v2, s[8:11], s22 offen offset:1024 sc1
  buffer_load_dwordx4 v[144:147], v2, s[8:11], s22 offen offset:2048 sc1
  buffer_load_dwordx4 v[148:151], v2, s[8:11], s22 offen offset:3072 sc1
  s_add_u32 s22, s31, 73728
  buffer_load_dwordx4 v[152:155], v2, s[8:11], s22 offen offset:0 sc1
  buffer_load_dwordx4 v[156:159], v2, s[8:11], s22 offen offset:1024 sc1
  buffer_load_dwordx4 v[160:163], v2, s[8:11], s22 offen offset:2048 sc1
  buffer_load_dwordx4 v[164:167], v2, s[8:11], s22 offen offset:3072 sc1
  s_add_u32 s22, s31, 77824
  buffer_load_dwordx4 v[168:171], v2, s[8:11], s22 offen offset:0 sc1
  buffer_load_dwordx4 v[172:175], v2, s[8:11], s22 offen offset:1024 sc1
  buffer_load_dwordx4 v[176:179], v2, s[8:11], s22 offen offset:2048 sc1
  buffer_load_dwordx4 v[180:183], v2, s[8:11], s22 offen offset:3072 sc1
  s_add_u32 s22, s31, 81920
  buffer_load_dwordx4 v[184:187], v2, s[8:11], s22 offen offset:0 sc1
  buffer_load_dwordx4 v[188:191], v2, s[8:11], s22 offen offset:1024 sc1
  buffer_load_dwordx4 v[192:195], v2, s[8:11], s22 offen offset:2048 sc1
  buffer_load_dwordx4 v[196:199], v2, s[8:11], s22 offen offset:3072 sc1
  s_add_u32 s22, s31, 86016
  buffer_load_dwordx4 v[200:203], v2, s[8:11], s22 offen offset:0 sc1
  buffer_load_dwordx4 v[204:207], v2, s[8:11], s22 offen offset:1024 sc1
  buffer_load_dwordx4 v[208:211], v2, s[8:11], s22 offen offset:2048 sc1
  buffer_load_dwordx4 v[212:215], v2, s[8:11], s22 offen offset:3072 sc1
  s_add_u32 s22, s31, 90112
  buffer_load_dwordx4 v[216:219], v2, s[8:11], s22 offen offset:0 sc1
  buffer_load_dwordx4 v[220:223], v2, s[8:11], s22 offen offset:1024 sc1
  buffer_load_dwordx4 v[224:227], v2, s[8:11], s22 offen offset:2048 sc1
  buffer_load_dwordx4 v[228:231], v2, s[8:11], s22 offen offset:3072 sc1
  s_add_u32 s22, s31, 94208
  buffer_load_dwordx4 v[232:235], v2, s[8:11], s22 offen offset:0 sc1
  buffer_load_dwordx4 v[236:239], v2, s[8:11], s22 offen offset:1024 sc1
  buffer_load_dwordx4 v[240:243], v2, s[8:11], s22 offen offset:2048 sc1
  buffer_load_dwordx4 v[244:247], v2, s[8:11], s22 offen offset:3072 sc1
  s_waitcnt vmcnt(24)
  s_add_u32 s22, s31, 98304
  buffer_load_dwordx4 v[248:251], v2, s[8:11], s22 offen offset:0 sc1
  buffer_load_dwordx4 v[252:255], v2, s[8:11], s22 offen offset:1024 sc1
  v_mov_b32 v72, v116
  v_mov_b32 v73, v117
  v_lshrrev_b32 v65, 1, v72
  v_and_b32 v66, 1, v72
  v_mov_b32 v36, 0
  v_mov_b32 v37, 0
  v_mov_b32 v38, 0
  v_mov_b32 v39, 0
  v_mov_b32 v40, 0
  v_mov_b32 v41, 0
  v_mov_b32 v42, 0
  v_mov_b32 v43, 0
  v_mov_b32 v44, 0
  v_mov_b32 v45, 0
  v_mov_b32 v46, 0
  v_mov_b32 v47, 0
  v_mov_b32 v48, 0
  v_mov_b32 v49, 0
  v_mov_b32 v50, 0
  v_mov_b32 v51, 0
  v_mov_b32 v52, 0
  v_mov_b32 v53, 0
  v_mov_b32 v54, 0
  v_mov_b32 v55, 0
  v_mov_b32 v56, 0
  v_mov_b32 v57, 0
  v_mov_b32 v58, 0
  v_mov_b32 v59, 0
  v_mov_b32 v60, 0
  v_mov_b32 v61, 0
  v_mov_b32 v62, 0
  v_mov_b32 v63, 0
  v_lshlrev_b32 v75, 2, v65
  v_lshl_add_u32 v75, v66, 3, v75
  v_add_u32 v67, 336, v73
  v_mul_u32_u24 v68, 2341, v67
  v_lshrrev_b32 v68, 16, v68
  v_mul_u32_u24 v69, 28, v68
  v_sub_u32 v69, v67, v69
  v_lshrrev_b32 v70, 4, v69
  v_and_b32 v69, 15, v69
  v_lshlrev_b32 v71, 12, v70
  v_lshl_add_u32 v71, v68, 8, v71
  v_lshl_add_u32 v71, v69, 4, v71
  v_add_u32 v104, v71, v75
  v_add_u32 v67, 352, v73
  v_mul_u32_u24 v68, 2341, v67
  v_lshrrev_b32 v68, 16, v68
  v_mul_u32_u24 v69, 28, v68
  v_sub_u32 v69, v67, v69
  v_lshrrev_b32 v70, 4, v69
  v_and_b32 v69, 15, v69
  v_lshlrev_b32 v71, 12, v70
  v_lshl_add_u32 v71, v68, 8, v71
  v_lshl_add_u32 v71, v69, 4, v71
  v_add_u32 v105, v71, v75
  v_add_u32 v67, 368, v73
  v_mul_u32_u24 v68, 2341, v67
  v_lshrrev_b32 v68, 16, v68
  v_mul_u32_u24 v69, 28, v68
  v_sub_u32 v69, v67, v69
  v_lshrrev_b32 v70, 4, v69
  v_and_b32 v69, 15, v69
  v_lshlrev_b32 v71, 12, v70
  v_lshl_add_u32 v71, v68, 8, v71
  v_lshl_add_u32 v71, v69, 4, v71
  v_add_u32 v106, v71, v75
  v_add_u32 v67, 384, v73
  v_mul_u32_u24 v68, 2341, v67
  v_lshrrev_b32 v68, 16, v68
  v_mul_u32_u24 v69, 28, v68
  v_sub_u32 v69, v67, v69
  v_lshrrev_b32 v70, 4, v69
  v_and_b32 v69, 15, v69
  v_lshlrev_b32 v71, 12, v70
  v_lshl_add_u32 v71, v68, 8, v71
  v_lshl_add_u32 v71, v69, 4, v71
  v_add_u32 v107, v71, v75
  v_add_u32 v67, 400, v73
  v_mul_u32_u24 v68, 2341, v67
  v_lshrrev_b32 v68, 16, v68
  v_mul_u32_u24 v69, 28, v68
  v_sub_u32 v69, v67, v69
  v_lshrrev_b32 v70, 4, v69
  v_and_b32 v69, 15, v69
  v_lshlrev_b32 v71, 12, v70
  v_lshl_add_u32 v71, v68, 8, v71
  v_lshl_add_u32 v71, v69, 4, v71
  v_add_u32 v108, v71, v75
  v_add_u32 v67, 416, v73
  v_mul_u32_u24 v68, 2341, v67
  v_lshrrev_b32 v68, 16, v68
  v_mul_u32_u24 v69, 28, v68
  v_sub_u32 v69, v67, v69
  v_lshrrev_b32 v70, 4, v69
  v_and_b32 v69, 15, v69
  v_lshlrev_b32 v71, 12, v70
  v_lshl_add_u32 v71, v68, 8, v71
  v_lshl_add_u32 v71, v69, 4, v71
  v_add_u32 v109, v71, v75
  v_add_u32 v67, 432, v73
  v_mul_u32_u24 v68, 2341, v67
  v_lshrrev_b32 v68, 16, v68
  v_mul_u32_u24 v69, 28, v68
  v_sub_u32 v69, v67, v69
  v_lshrrev_b32 v70, 4, v69
  v_and_b32 v69, 15, v69
  v_lshlrev_b32 v71, 12, v70
  v_lshl_add_u32 v71, v68, 8, v71
  v_lshl_add_u32 v71, v69, 4, v71
  v_add_u32 v110, v71, v75
  v_mov_b32 v74, 0x40000000
  v_and_b32 v119, 15, v1
  s_and_b32 s22, s17, 3
  s_lshl_b32 s22, s22, 7
  s_add_u32 s22, s22, 75274752
  v_lshl_add_u32 v119, v119, 2, s22
  s_lshl_b32 s22, s17, 2
  s_add_u32 s22, s22, 75272704
  v_lshl_add_u32 v118, v1, 7, s22
  v_cmp_gt_u32 vcc, 4, v1
  s_nop 1
  v_cndmask_b32 v118, v74, v118, vcc
  s_lshl_b32 s35, s17, 7
  s_add_u32 s35, s35, 88002560
  v_min_u32 v116, 13, v1
  s_mul_i32 s22, s17, 14
  v_add_u32 v116, s22, v116
  v_lshlrev_b32 v116, 7, v116
  s_mov_b32 s39, 71593984
  s_mov_b32 s30, 0
ch_vw7i:
  buffer_load_dword v9, off, s[12:15], 0 offset:132 sc1
  s_waitcnt vmcnt(0)
  v_cmp_ne_u32 vcc, 1, v9
  s_cbranch_vccz ch_vw7i_ok
  s_sleep 8
  s_add_u32 s30, s30, 1
  s_cmp_lt_u32 s30, 400000
  s_cbranch_scc1 ch_vw7i
  s_branch cA_abort
ch_vw7i_ok:
  s_lshl_b32 s27, s17, 7
  s_add_u32 s27, s27, 88002560
  s_mov_b32 s30, 0
ch_vw7:
  buffer_load_dword v9, off, s[8:11], s27 sc1
  s_waitcnt vmcnt(0)
  v_cmp_ne_u32 vcc, 56, v9
  s_cbranch_vccz ch_vw7_d
  s_sleep 2
  s_add_u32 s30, s30, 1
  s_cmp_lt_u32 s30, 400000
  s_cbranch_scc1 ch_vw7
  s_branch cA_abort
ch_vw7_d:
  buffer_load_dword v100, v116, s[8:11], s39 offen sc1
  s_mov_b32 s39, 71622656
  s_mov_b32 s30, 0
  v_mov_b32 v8, 0
ch_md7:
  buffer_load_dword v9, v8, s[12:15], 0 offen sc1
  s_waitcnt vmcnt(0) lgkmcnt(0)
  v_readfirstlane_b32 s22, v9
  s_and_b32 s31, s22, 0xffff
  s_cmp_ge_u32 s31, 32
  s_cbranch_scc1 ch_go7
  s_sleep 2
  s_add_u32 s30, s30, 1
  s_cmp_lt_u32 s30, 3200000
  s_cbranch_scc1 ch_md7
  s_branch ch_end
ch_go7:
  s_mov_b32 s31, 0
  s_lshr_b32 s22, s22, 16
  s_cmp_lg_u32 s22, 0
  s_cbranch_scc1 cB_va3_loop
  s_branch cA_va3_loop
.p2align 6
cA_sc0_loop:
  s_mov_b32 s30, 0
  s_mov_b32 s62, 0
  s_setprio 3
  s_sleep 6
  buffer_load_dword v76, v0, s[8:11], 0 offen sc1
  buffer_load_dword v77, v0, s[8:11], 0 offen sc1
  buffer_load_dword v78, v0, s[8:11], 0 offen sc1
cA_sc0_fp_l:
  s_waitcnt vmcnt(2)
  v_cmp_gt_u32 vcc, s19, v76
  s_cbranch_vccz cA_sc0_fp_d
  buffer_load_dword v76, v0, s[8:11], 0 offen sc1
  s_waitcnt vmcnt(2)
  v_cmp_gt_u32 vcc, s19, v77
  s_cbranch_vccz cA_sc0_fp_d
  buffer_load_dword v77, v0, s[8:11], 0 offen sc1
  s_waitcnt vmcnt(2)
  v_cmp_gt_u32 vcc, s19, v78
  s_cbranch_vccz cA_sc0_fp_d
  buffer_load_dword v78, v0, s[8:11], 0 offen sc1
  s_add_u32 s30, s30, 1
  s_cmp_lt_u32 s30, 400000
  s_cbranch_scc1 cA_sc0_fp_l
  s_branch cA_abort
cA_sc0_fp_d:
  buffer_load_dwordx4 v[8:11], v2, s[8:11], s20 offen offset:0 sc1
  s_barrier
  s_setprio 2
  buffer_load_dwordx4 v[12:15], v2, s[8:11], s20 offen offset:1024 sc1
  s_setprio 1
  buffer_load_dwordx4 v[16:19], v2, s[8:11], s20 offen offset:2048 sc1
  s_setprio 0
  buffer_load_dwordx4 v[20:23], v2, s[8:11], s20 offen offset:3072 sc1
cA_sc0_go:
  s_waitcnt vmcnt(3)
  v_smfmac_f32_16x16x64_bf16 v[36:39], v[8:11], a[0:7], v3
  buffer_load_dwordx4 v[32:35], v2, s[8:11], s23 offen offset:0 sc1
  v_cmp_eq_u32 vcc, -1, v8
  v_smfmac_f32_16x16x64_bf16 v[40:43], v[8:11], a[56:63], v3
  v_smfmac_f32_16x16x64_bf16 v[44:47], v[8:11], a[112:119], v3
  buffer_load_dwordx4 v[24:27], v2, s[8:11], s23 offen offset:1024 sc1
  s_cbranch_vccnz cA_sc0_r0
  v_smfmac_f32_16x16x64_bf16 v[48:51], v[8:11], a[168:175], v3
  v_smfmac_f32_16x16x64_bf16 v[52:55], v[8:11], a[224:231], v3
  s_waitcnt vmcnt(4)
  v_cmp_eq_u32 vcc, -1, v12
  v_smfmac_f32_16x16x64_bf16 v[56:59], v[8:11], v[144:151], v3
  buffer_load_dwordx4 v[28:31], v2, s[8:11], s23 offen offset:2048 sc1
  v_smfmac_f32_16x16x64_bf16 v[60:63], v[8:11], v[200:207], v3
  s_cbranch_vccnz cA_sc0_r1
cA_sc0_c1:
  v_smfmac_f32_16x16x64_bf16 v[36:39], v[12:15], a[8:15], v3
  v_smfmac_f32_16x16x64_bf16 v[40:43], v[12:15], a[64:71], v3
  v_smfmac_f32_16x16x64_bf16 v[44:47], v[12:15], a[120:127], v3
  v_smfmac_f32_16x16x64_bf16 v[48:51], v[12:15], a[176:183], v3
  v_smfmac_f32_16x16x64_bf16 v[52:55], v[12:15], a[232:239], v3
  s_waitcnt vmcnt(4)
  v_cmp_eq_u32 vcc, -1, v16
  v_smfmac_f32_16x16x64_bf16 v[56:59], v[12:15], v[152:159], v3
  buffer_load_dwordx4 v[88:91], v117, s[8:11], s26 offen offset:0 sc1
  v_smfmac_f32_16x16x64_bf16 v[60:63], v[12:15], v[208:215], v3
  s_cbranch_vccnz cA_sc0_r2
cA_sc0_c2:
  v_smfmac_f32_16x16x64_bf16 v[36:39], v[16:19], a[16:23], v3
  v_smfmac_f32_16x16x64_bf16 v[40:43], v[16:19], a[72:79], v3
  v_smfmac_f32_16x16x64_bf16 v[44:47], v[16:19], a[128:135], v3
  buffer_load_dwordx4 v[92:95], v117, s[8:11], s26 offen offset:1024 sc1
  v_smfmac_f32_16x16x64_bf16 v[48:51], v[16:19], a[184:191], v3
  v_smfmac_f32_16x16x64_bf16 v[52:55], v[16:19], a[240:247], v3
  s_waitcnt vmcnt(5)
  v_cmp_eq_u32 vcc, -1, v20
  v_smfmac_f32_16x16x64_bf16 v[56:59], v[16:19], v[160:167], v3
  v_smfmac_f32_16x16x64_bf16 v[60:63], v[16:19], v[216:223], v3
  buffer_load_dwordx4 v[96:99], v2, s[8:11], s24 offen offset:0 sc1
  s_cbranch_vccnz cA_sc0_r3
cA_sc0_c3:
  v_smfmac_f32_16x16x64_bf16 v[36:39], v[20:23], a[24:31], v3
  v_smfmac_f32_16x16x64_bf16 v[40:43], v[20:23], a[80:87], v3
  s_waitcnt vmcnt(3)
  v_max3_u32 v66, v24, v27, v28
  v_smfmac_f32_16x16x64_bf16 v[44:47], v[20:23], a[136:143], v3
  v_max3_u32 v66, v66, v31, v32
  v_smfmac_f32_16x16x64_bf16 v[48:51], v[20:23], a[192:199], v3
  buffer_load_dwordx4 v[100:103], v2, s[8:11], s24 offen offset:1024 sc1
  v_max_u32 v66, v66, v35
  v_smfmac_f32_16x16x64_bf16 v[52:55], v[20:23], a[248:255], v3
  v_cmp_eq_u32 vcc, -1, v66
  v_smfmac_f32_16x16x64_bf16 v[56:59], v[20:23], v[168:175], v3
  v_smfmac_f32_16x16x64_bf16 v[60:63], v[20:23], v[224:231], v3
  s_cbranch_vccnz cA_sc0_r4
cA_sc0_c4:
  v_smfmac_f32_16x16x64_bf16 v[60:63], v[32:35], v[232:239], v3
  buffer_load_dwordx4 v[104:107], v2, s[8:11], s26 offen offset:0 sc1
  v_smfmac_f32_16x16x64_bf16 v[60:63], v[24:27], v[240:247], v3
  v_smfmac_f32_16x16x64_bf16 v[60:63], v[28:31], v[248:255], v3
  v_smfmac_f32_16x16x64_bf16 v[52:55], v[32:35], v[120:127], v3
  v_smfmac_f32_16x16x64_bf16 v[52:55], v[24:27], v[128:135], v3
  buffer_load_dwordx4 v[108:111], v2, s[8:11], s26 offen offset:1024 sc1
  v_smfmac_f32_16x16x64_bf16 v[52:55], v[28:31], v[136:143], v3
  v_cvt_pk_bf16_f32 v63, v62, v63
  v_smfmac_f32_16x16x64_bf16 v[56:59], v[32:35], v[176:183], v3
  v_cvt_pk_bf16_f32 v62, v60, v61
  v_smfmac_f32_16x16x64_bf16 v[56:59], v[24:27], v[184:191], v3
  v_mfma_f32_16x16x32_bf16 v[12:15], v[62:65], v[4:7], 0
  v_cvt_pk_bf16_f32 v55, v54, v55
  v_smfmac_f32_16x16x64_bf16 v[56:59], v[28:31], v[192:199], v3
  v_cvt_pk_bf16_f32 v54, v52, v53
  v_smfmac_f32_16x16x64_bf16 v[36:39], v[32:35], a[32:39], v3
  s_nop 1
  v_cvt_pk_bf16_f32 v76, v12, v13
  v_smfmac_f32_16x16x64_bf16 v[36:39], v[24:27], a[40:47], v3
  v_cvt_pk_bf16_f32 v77, v14, v15
  v_smfmac_f32_16x16x64_bf16 v[36:39], v[28:31], a[48:55], v3
  v_cvt_pk_bf16_f32 v56, v56, v57
  v_smfmac_f32_16x16x64_bf16 v[40:43], v[32:35], a[88:95], v3
  v_cvt_pk_bf16_f32 v57, v58, v59
  v_smfmac_f32_16x16x64_bf16 v[40:43], v[24:27], a[96:103], v3
  v_mfma_f32_16x16x32_bf16 v[16:19], v[54:57], v[4:7], 0
  v_cvt_pk_bf16_f32 v39, v38, v39
  v_smfmac_f32_16x16x64_bf16 v[40:43], v[28:31], a[104:111], v3
  v_cvt_pk_bf16_f32 v38, v36, v37
  v_smfmac_f32_16x16x64_bf16 v[44:47], v[32:35], a[144:151], v3
  s_nop 1
  v_cvt_pk_bf16_f32 v78, v16, v17
  v_smfmac_f32_16x16x64_bf16 v[44:47], v[24:27], a[152:159], v3
  v_cvt_pk_bf16_f32 v79, v18, v19
  v_smfmac_f32_16x16x64_bf16 v[44:47], v[28:31], a[160:167], v3
  v_cvt_pk_bf16_f32 v40, v40, v41
  v_smfmac_f32_16x16x64_bf16 v[48:51], v[32:35], a[200:207], v3
  v_cvt_pk_bf16_f32 v41, v42, v43
  v_smfmac_f32_16x16x64_bf16 v[48:51], v[24:27], a[208:215], v3
  v_smfmac_f32_16x16x64_bf16 v[48:51], v[28:31], a[216:223], v3
  s_waitcnt vmcnt(4)
  v_cvt_pk_bf16_f32 v47, v46, v47
  v_smfmac_f32_16x16x64_bf16 v[68:71], v[76:79], v[80:87], v3
  v_cvt_pk_bf16_f32 v46, v44, v45
  v_mfma_f32_16x16x32_bf16 v[12:15], v[38:41], v[4:7], 0
  s_nop 1
  v_cvt_pk_bf16_f32 v48, v48, v49
  v_cvt_pk_bf16_f32 v49, v50, v51
  s_nop 1
  v_mfma_f32_16x16x32_bf16 v[16:19], v[46:49], v[4:7], 0
  v_smfmac_f32_16x16x64_bf16 v[72:75], v[76:79], v[88:95], v3
  v_cvt_pk_bf16_f32 v20, v12, v13
  v_mfma_f32_16x16x32_bf16 v[52:55], v[30:33], v[76:79], 0
  s_waitcnt vmcnt(0)
  v_cvt_pk_bf16_f32 v21, v14, v15
  v_cvt_pk_bf16_f32 v22, v16, v17
  v_cvt_pk_bf16_f32 v23, v18, v19
  s_nop 1
  v_smfmac_f32_16x16x64_bf16 v[68:71], v[20:23], v[96:103], v3
  v_mfma_f32_16x16x32_bf16 v[52:55], v[8:11], v[20:23], v[52:55]
  v_smfmac_f32_16x16x64_bf16 v[72:75], v[20:23], v[104:111], v3
  s_nop 1
  v_permlane32_swap_b32 v68, v70
  v_permlane32_swap_b32 v69, v71
  v_add_f32 v56, v68, v70
  v_add_f32 v58, v69, v71
  ds_write_b128 v113, v[52:55]
  s_nop 0
  v_permlane32_swap_b32 v72, v74
  v_permlane32_swap_b32 v73, v75
  v_add_f32 v57, v72, v74
  v_add_f32 v59, v73, v75
  ds_write_b128 v2, v[56:59] offset:0
  v_cmp_u_f32 vcc, v57, v59
  v_mov_b32 v36, 0
  v_mov_b32 v37, 0
  v_mov_b32 v38, 0
  v_mov_b32 v39, 0
  s_cbranch_vccnz cA_sc0_retry
cA_sc0_cont:
  s_add_u32 s24, s24, 28672
  s_add_u32 s26, s26, 28672
  buffer_load_dwordx4 v[80:83], v117, s[8:11], s24 offen offset:0 sc1
  buffer_load_dwordx4 v[84:87], v117, s[8:11], s24 offen offset:1024 sc1
  v_mov_b32 v40, 0
  v_mov_b32 v41, 0
  v_mov_b32 v42, 0
  v_mov_b32 v43, 0
  v_mov_b32 v44, 0
  v_mov_b32 v45, 0
  v_mov_b32 v46, 0
  v_mov_b32 v47, 0
  v_mov_b32 v48, 0
  v_mov_b32 v49, 0
  v_mov_b32 v50, 0
  v_mov_b32 v51, 0
  s_waitcnt lgkmcnt(0)
  s_barrier
  ds_read_b64 v[8:9], v114 offset:0
  ds_read_b64 v[10:11], v114 offset:1024
  ds_read_b64 v[12:13], v114 offset:2048
  ds_read_b64 v[14:15], v114 offset:3072
  ds_read2_b32 v[16:17], v115 offset0:0 offset1:64
  ds_read2_b32 v[18:19], v115 offset0:128 offset1:192
  s_waitcnt lgkmcnt(0)
  v_pk_add_f32 v[16:17], v[16:17], v[18:19]
  v_pk_add_f32 v[8:9], v[8:9], v[10:11]
  v_pk_add_f32 v[12:13], v[12:13], v[14:15]
  v_add_f32 v20, v16, v17
  v_pk_add_f32 v[8:9], v[8:9], v[12:13]
  v_max_f32 v22, v8, v9
  v_add_f32_dpp v20, v20, v20 row_ror:8 row_mask:0xf bank_mask:0xf
  s_nop 0
  v_max_f32_dpp v22, v22, v22 row_ror:8 row_mask:0xf bank_mask:0xf
  v_max_f32 v22, v22, v20
  s_nop 1
  v_max_f32_dpp v22, v22, v22 quad_perm:[1,0,3,2] row_mask:0xf bank_mask:0xf
  s_nop 1
  v_max_f32_dpp v22, v22, v22 quad_perm:[2,3,0,1] row_mask:0xf bank_mask:0xf
  s_nop 1
  v_max_f32_dpp v22, v22, v22 row_half_mirror row_mask:0xf bank_mask:0xf
  v_pk_add_f32 v[8:9], v[8:9], v[22:23] op_sel_hi:[1,0] neg_lo:[0,1] neg_hi:[0,1]
  v_sub_f32 v20, v20, v22
  v_exp_f32 v8, v8
  v_exp_f32 v9, v9
  v_exp_f32 v20, v20
  v_add_f32 v24, v8, v9
  v_fmac_f32 v24, 0.5, v20
  v_mov_b32_dpp v21, v20 quad_perm:[1,0,3,2] row_mask:0xf bank_mask:0xf
  s_nop 0
  v_add_f32_dpp v24, v24, v24 quad_perm:[1,0,3,2] row_mask:0xf bank_mask:0xf
  s_nop 1
  v_add_f32_dpp v24, v24, v24 quad_perm:[2,3,0,1] row_mask:0xf bank_mask:0xf
  s_nop 1
  v_add_f32_dpp v24, v24, v24 row_half_mirror row_mask:0xf bank_mask:0xf
  s_nop 1
  v_add_f32_dpp v24, v24, v24 row_ror:8 row_mask:0xf bank_mask:0xf
  v_rcp_f32 v24, v24
  s_nop 0
  v_pk_mul_f32 v[8:9], v[8:9], v[24:25] op_sel_hi:[1,0]
  v_pk_mul_f32 v[20:21], v[20:21], v[24:25] op_sel_hi:[1,0]
  v_cvt_pk_bf16_f32 v8, v8, v9
  v_cvt_pk_bf16_f32 v20, v20, v21
  v_min_u32 v8, -2, v8
  buffer_store_dword v8, v1, s[8:11], s20 offen
  v_min_u32 v20, -2, v20
  buffer_store_dword v20, v118, s[8:11], s20 offen
  buffer_store_dword v119, v1, s[8:11], s21 offen
  buffer_store_dword v119, v118, s[8:11], s21 offen
  v_mov_b32 v60, 0
  v_mov_b32 v61, 0
  v_mov_b32 v62, 0
  v_mov_b32 v63, 0
  v_mov_b32 v68, 0
  v_mov_b32 v69, 0
  v_mov_b32 v70, 0
  v_mov_b32 v71, 0
  v_mov_b32 v72, 0
  v_mov_b32 v73, 0
  v_mov_b32 v74, 0
  v_mov_b32 v75, 0
  v_mov_b32 v52, 0
  v_mov_b32 v53, 0
  v_mov_b32 v54, 0
  v_mov_b32 v55, 0
  v_mov_b32 v56, 0
  v_mov_b32 v57, 0
  v_mov_b32 v58, 0
  v_mov_b32 v59, 0
  s_mov_b32 s19, s18
  s_add_u32 s18, s18, 1
  s_mov_b32 s22, s20
  s_mov_b32 s20, s21
  s_mov_b32 s21, s22
  s_add_u32 s23, s20, 4096
  s_cmp_lt_u32 s19, 63
  s_cbranch_scc1 cA_sc0_loop
  s_branch cA_done
cA_sc0_r0:
  s_add_u32 s31, s31, 1
  buffer_load_dwordx4 v[8:11], v2, s[8:11], s20 offen offset:0 sc1
  s_waitcnt vmcnt(0)
  v_cmp_eq_u32 vcc, -1, v8
  v_mov_b32 v36, 0
  v_mov_b32 v37, 0
  v_mov_b32 v38, 0
  v_mov_b32 v39, 0
  v_mov_b32 v40, 0
  v_mov_b32 v41, 0
  v_mov_b32 v42, 0
  v_mov_b32 v43, 0
  v_mov_b32 v44, 0
  v_mov_b32 v45, 0
  v_mov_b32 v46, 0
  v_mov_b32 v47, 0
  v_mov_b32 v48, 0
  v_mov_b32 v49, 0
  v_mov_b32 v50, 0
  v_mov_b32 v51, 0
  s_nop 1
  s_cbranch_vccz cA_sc0_go
  s_add_u32 s30, s30, 1
  s_cmp_lt_u32 s30, 400000
  s_cbranch_scc1 cA_sc0_r0
  s_branch cA_abort
cA_sc0_r1:
  s_add_u32 s31, s31, 1
  buffer_load_dwordx4 v[12:15], v2, s[8:11], s20 offen offset:1024 sc1
  s_waitcnt vmcnt(0)
  v_cmp_eq_u32 vcc, -1, v12
  s_nop 4
  s_cbranch_vccz cA_sc0_c1
  s_add_u32 s30, s30, 1
  s_cmp_lt_u32 s30, 400000
  s_cbranch_scc1 cA_sc0_r1
  s_branch cA_abort
cA_sc0_r2:
  s_add_u32 s31, s31, 1
  buffer_load_dwordx4 v[16:19], v2, s[8:11], s20 offen offset:2048 sc1
  s_waitcnt vmcnt(0)
  v_cmp_eq_u32 vcc, -1, v16
  s_nop 4
  s_cbranch_vccz cA_sc0_c2
  s_add_u32 s30, s30, 1
  s_cmp_lt_u32 s30, 400000
  s_cbranch_scc1 cA_sc0_r2
  s_branch cA_abort
cA_sc0_r3:
  s_add_u32 s31, s31, 1
  buffer_load_dwordx4 v[20:23], v2, s[8:11], s20 offen offset:3072 sc1
  s_waitcnt vmcnt(0)
  v_cmp_eq_u32 vcc, -1, v20
  s_nop 4
  s_cbranch_vccz cA_sc0_c3
  s_add_u32 s30, s30, 1
  s_cmp_lt_u32 s30, 400000
  s_cbranch_scc1 cA_sc0_r3
  s_branch cA_abort
cA_sc0_r4:
  s_add_u32 s31, s31, 1
  buffer_load_dwordx4 v[32:35], v2, s[8:11], s23 offen offset:0 sc1
  buffer_load_dwordx4 v[24:27], v2, s[8:11], s23 offen offset:1024 sc1
  buffer_load_dwordx4 v[28:31], v2, s[8:11], s23 offen offset:2048 sc1
  s_waitcnt vmcnt(0)
  v_max3_u32 v66, v24, v27, v28
  v_max3_u32 v66, v66, v31, v32
  v_max_u32 v66, v66, v35
  v_cmp_eq_u32 vcc, -1, v66
  s_nop 4
  s_cbranch_vccz cA_sc0_c4
  s_add_u32 s30, s30, 1
  s_cmp_lt_u32 s30, 400000
  s_cbranch_scc1 cA_sc0_r4
  s_branch cA_abort
cA_sc0_retry:
  s_cmp_lg_u32 s62, 0
  s_cbranch_scc1 cA_sc0_cont
  s_waitcnt vmcnt(0) lgkmcnt(0)
cA_sc0_rv:
  buffer_load_dwordx4 v[8:11], v2, s[8:11], s20 offen offset:0 sc1
  buffer_load_dwordx4 v[12:15], v2, s[8:11], s20 offen offset:1024 sc1
  buffer_load_dwordx4 v[16:19], v2, s[8:11], s20 offen offset:2048 sc1
  buffer_load_dwordx4 v[20:23], v2, s[8:11], s20 offen offset:3072 sc1
  buffer_load_dwordx4 v[32:35], v2, s[8:11], s23 offen offset:0 sc1
  buffer_load_dwordx4 v[24:27], v2, s[8:11], s23 offen offset:1024 sc1
  buffer_load_dwordx4 v[28:31], v2, s[8:11], s23 offen offset:2048 sc1
  s_waitcnt vmcnt(0)
  v_pk_max_u16 v66, v8, v9
  v_pk_max_u16 v66, v66, v10
  v_pk_max_u16 v66, v66, v11
  v_pk_max_u16 v66, v66, v12
  v_pk_max_u16 v66, v66, v13
  v_pk_max_u16 v66, v66, v14
  v_pk_max_u16 v66, v66, v15
  v_pk_max_u16 v66, v66, v16
  v_pk_max_u16 v66, v66, v17
  v_pk_max_u16 v66, v66, v18
  v_pk_max_u16 v66, v66, v19
  v_pk_max_u16 v66, v66, v20
  v_pk_max_u16 v66, v66, v21
  v_pk_max_u16 v66, v66, v22
  v_pk_max_u16 v66, v66, v23
  v_pk_max_u16 v66, v66, v24
  v_pk_max_u16 v66, v66, v25
  v_pk_max_u16 v66, v66, v26
  v_pk_max_u16 v66, v66, v27
  v_pk_max_u16 v66, v66, v28
  v_pk_max_u16 v66, v66, v29
  v_pk_max_u16 v66, v66, v30
  v_pk_max_u16 v66, v66, v31
  v_pk_max_u16 v66, v66, v32
  v_pk_max_u16 v66, v66, v33
  v_pk_max_u16 v66, v66, v34
  v_pk_max_u16 v66, v66, v35
  v_lshlrev_b32 v67, 16, v66
  v_max_u32 v66, v66, v67
  v_cmp_le_u32 vcc, 0xffff0000, v66
  s_cbranch_vccz cA_sc0_rk
  s_add_u32 s30, s30, 1
  s_cmp_lt_u32 s30, 400000
  s_cbranch_scc1 cA_sc0_rv
  s_branch cA_abort
cA_sc0_rk:
  s_mov_b32 s62, 1
  v_mov_b32 v36, 0
  v_mov_b32 v37, 0
  v_mov_b32 v38, 0
  v_mov_b32 v39, 0
  v_mov_b32 v40, 0
  v_mov_b32 v41, 0
  v_mov_b32 v42, 0
  v_mov_b32 v43, 0
  v_mov_b32 v44, 0
  v_mov_b32 v45, 0
  v_mov_b32 v46, 0
  v_mov_b32 v47, 0
  v_mov_b32 v48, 0
  v_mov_b32 v49, 0
  v_mov_b32 v50, 0
  v_mov_b32 v51, 0
  v_mov_b32 v60, 0
  v_mov_b32 v61, 0
  v_mov_b32 v62, 0
  v_mov_b32 v63, 0
  v_mov_b32 v68, 0
  v_mov_b32 v69, 0
  v_mov_b32 v70, 0
  v_mov_b32 v71, 0
  v_mov_b32 v72, 0
  v_mov_b32 v73, 0
  v_mov_b32 v74, 0
  v_mov_b32 v75, 0
  v_mov_b32 v52, 0
  v_mov_b32 v53, 0
  v_mov_b32 v54, 0
  v_mov_b32 v55, 0
  v_mov_b32 v56, 0
  v_mov_b32 v57, 0
  v_mov_b32 v58, 0
  v_mov_b32 v59, 0
  s_add_u32 s31, s31, 0x100
  s_nop 0
  s_branch cA_sc0_go
.p2align 6
cA_sc1_loop:
  s_mov_b32 s30, 0
  s_mov_b32 s62, 0
  s_setprio 3
  s_barrier
  buffer_load_dwordx4 v[8:11], v2, s[8:11], s20 offen offset:0 sc1
  s_setprio 2
  buffer_load_dwordx4 v[12:15], v2, s[8:11], s20 offen offset:1024 sc1
  s_setprio 1
  buffer_load_dwordx4 v[16:19], v2, s[8:11], s20 offen offset:2048 sc1
  s_setprio 0
  buffer_load_dwordx4 v[20:23], v2, s[8:11], s20 offen offset:3072 sc1
cA_sc1_go:
  s_waitcnt vmcnt(3)
  v_smfmac_f32_16x16x64_bf16 v[36:39], v[8:11], a[0:7], v3
  buffer_load_dwordx4 v[28:31], v2, s[8:11], s23 offen offset:0 sc1
  v_cmp_eq_u32 vcc, -1, v8
  v_smfmac_f32_16x16x64_bf16 v[40:43], v[8:11], a[56:63], v3
  v_smfmac_f32_16x16x64_bf16 v[44:47], v[8:11], a[112:119], v3
  buffer_load_dwordx4 v[24:27], v2, s[8:11], s23 offen offset:1024 sc1
  s_cbranch_vccnz cA_sc1_r0
  v_smfmac_f32_16x16x64_bf16 v[48:51], v[8:11], a[168:175], v3
  v_smfmac_f32_16x16x64_bf16 v[52:55], v[8:11], a[224:231], v3
  s_waitcnt vmcnt(4)
  v_cmp_eq_u32 vcc, -1, v12
  v_smfmac_f32_16x16x64_bf16 v[56:59], v[8:11], v[144:151], v3
  buffer_load_dwordx4 v[32:35], v2, s[8:11], s23 offen offset:2048 sc1
  v_smfmac_f32_16x16x64_bf16 v[60:63], v[8:11], v[200:207], v3
  s_cbranch_vccnz cA_sc1_r1
cA_sc1_c1:
  v_smfmac_f32_16x16x64_bf16 v[36:39], v[12:15], a[8:15], v3
  v_smfmac_f32_16x16x64_bf16 v[40:43], v[12:15], a[64:71], v3
  v_smfmac_f32_16x16x64_bf16 v[44:47], v[12:15], a[120:127], v3
  v_smfmac_f32_16x16x64_bf16 v[48:51], v[12:15], a[176:183], v3
  v_smfmac_f32_16x16x64_bf16 v[52:55], v[12:15], a[232:239], v3
  s_waitcnt vmcnt(4)
  v_cmp_eq_u32 vcc, -1, v16
  v_smfmac_f32_16x16x64_bf16 v[56:59], v[12:15], v[152:159], v3
  buffer_load_dwordx4 v[88:91], v117, s[8:11], s26 offen offset:0 sc1
  v_smfmac_f32_16x16x64_bf16 v[60:63], v[12:15], v[208:215], v3
  s_cbranch_vccnz cA_sc1_r2
cA_sc1_c2:
  v_smfmac_f32_16x16x64_bf16 v[36:39], v[16:19], a[16:23], v3
  v_smfmac_f32_16x16x64_bf16 v[40:43], v[16:19], a[72:79], v3
  v_smfmac_f32_16x16x64_bf16 v[44:47], v[16:19], a[128:135], v3
  buffer_load_dwordx4 v[92:95], v117, s[8:11], s26 offen offset:1024 sc1
  v_smfmac_f32_16x16x64_bf16 v[48:51], v[16:19], a[184:191], v3
  v_smfmac_f32_16x16x64_bf16 v[52:55], v[16:19], a[240:247], v3
  s_waitcnt vmcnt(5)
  v_cmp_eq_u32 vcc, -1, v20
  v_smfmac_f32_16x16x64_bf16 v[56:59], v[16:19], v[160:167], v3
  v_smfmac_f32_16x16x64_bf16 v[60:63], v[16:19], v[216:223], v3
  buffer_load_dwordx4 v[96:99], v2, s[8:11], s24 offen offset:0 sc1
  s_cbranch_vccnz cA_sc1_r3
cA_sc1_c3:
  v_smfmac_f32_16x16x64_bf16 v[36:39], v[20:23], a[24:31], v3
  v_smfmac_f32_16x16x64_bf16 v[40:43], v[20:23], a[80:87], v3
  s_waitcnt vmcnt(3)
  v_max3_u32 v66, v24, v27, v28
  v_smfmac_f32_16x16x64_bf16 v[44:47], v[20:23], a[136:143], v3
  v_max3_u32 v66, v66, v31, v32
  v_smfmac_f32_16x16x64_bf16 v[48:51], v[20:23], a[192:199], v3
  buffer_load_dwordx4 v[100:103], v2, s[8:11], s24 offen offset:1024 sc1
  v_max_u32 v66, v66, v35
  v_smfmac_f32_16x16x64_bf16 v[52:55], v[20:23], a[248:255], v3
  v_cmp_eq_u32 vcc, -1, v66
  v_smfmac_f32_16x16x64_bf16 v[56:59], v[20:23], v[168:175], v3
  v_smfmac_f32_16x16x64_bf16 v[60:63], v[20:23], v[224:231], v3
  s_cbranch_vccnz cA_sc1_r4
cA_sc1_c4:
  v_smfmac_f32_16x16x64_bf16 v[60:63], v[28:31], v[232:239], v3
  buffer_load_dwordx4 v[104:107], v2, s[8:11], s26 offen offset:0 sc1
  v_smfmac_f32_16x16x64_bf16 v[60:63], v[24:27], v[240:247], v3
  v_smfmac_f32_16x16x64_bf16 v[60:63], v[32:35], v[248:255], v3
  v_smfmac_f32_16x16x64_bf16 v[52:55], v[28:31], v[120:127], v3
  v_smfmac_f32_16x16x64_bf16 v[52:55], v[24:27], v[128:135], v3
  buffer_load_dwordx4 v[108:111], v2, s[8:11], s26 offen offset:1024 sc1
  v_smfmac_f32_16x16x64_bf16 v[52:55], v[32:35], v[136:143], v3
  v_cvt_pk_bf16_f32 v63, v62, v63
  v_smfmac_f32_16x16x64_bf16 v[56:59], v[28:31], v[176:183], v3
  v_cvt_pk_bf16_f32 v62, v60, v61
  v_smfmac_f32_16x16x64_bf16 v[56:59], v[24:27], v[184:191], v3
  v_mfma_f32_16x16x32_bf16 v[8:11], v[62:65], v[4:7], 0
  v_cvt_pk_bf16_f32 v55, v54, v55
  v_smfmac_f32_16x16x64_bf16 v[56:59], v[32:35], v[192:199], v3
  v_cvt_pk_bf16_f32 v54, v52, v53
  v_smfmac_f32_16x16x64_bf16 v[36:39], v[28:31], a[32:39], v3
  s_nop 1
  v_cvt_pk_bf16_f32 v78, v8, v9
  v_smfmac_f32_16x16x64_bf16 v[36:39], v[24:27], a[40:47], v3
  v_cvt_pk_bf16_f32 v79, v10, v11
  v_smfmac_f32_16x16x64_bf16 v[36:39], v[32:35], a[48:55], v3
  v_cvt_pk_bf16_f32 v56, v56, v57
  v_smfmac_f32_16x16x64_bf16 v[40:43], v[28:31], a[88:95], v3
  v_cvt_pk_bf16_f32 v57, v58, v59
  v_smfmac_f32_16x16x64_bf16 v[40:43], v[24:27], a[96:103], v3
  v_mfma_f32_16x16x32_bf16 v[16:19], v[54:57], v[4:7], 0
  v_cvt_pk_bf16_f32 v39, v38, v39
  v_smfmac_f32_16x16x64_bf16 v[40:43], v[32:35], a[104:111], v3
  v_cvt_pk_bf16_f32 v38, v36, v37
  v_smfmac_f32_16x16x64_bf16 v[44:47], v[28:31], a[144:151], v3
  s_nop 1
  v_cvt_pk_bf16_f32 v76, v16, v17
  v_smfmac_f32_16x16x64_bf16 v[44:47], v[24:27], a[152:159], v3
  v_cvt_pk_bf16_f32 v77, v18, v19
  v_smfmac_f32_16x16x64_bf16 v[44:47], v[32:35], a[160:167], v3
  v_cvt_pk_bf16_f32 v40, v40, v41
  v_smfmac_f32_16x16x64_bf16 v[48:51], v[28:31], a[200:207], v3
  v_cvt_pk_bf16_f32 v41, v42, v43
  v_smfmac_f32_16x16x64_bf16 v[48:51], v[24:27], a[208:215], v3
  v_smfmac_f32_16x16x64_bf16 v[48:51], v[32:35], a[216:223], v3
  s_waitcnt vmcnt(4)
  v_cvt_pk_bf16_f32 v47, v46, v47
  v_smfmac_f32_16x16x64_bf16 v[68:71], v[76:79], v[80:87], v3
  v_cvt_pk_bf16_f32 v46, v44, v45
  v_mfma_f32_16x16x32_bf16 v[8:11], v[38:41], v[4:7], 0
  s_nop 1
  v_cvt_pk_bf16_f32 v48, v48, v49
  v_cvt_pk_bf16_f32 v49, v50, v51
  s_nop 1
  v_mfma_f32_16x16x32_bf16 v[16:19], v[46:49], v[4:7], 0
  v_smfmac_f32_16x16x64_bf16 v[72:75], v[76:79], v[88:95], v3
  v_cvt_pk_bf16_f32 v20, v8, v9
  v_mfma_f32_16x16x32_bf16 v[52:55], v[30:33], v[76:79], 0
  s_waitcnt vmcnt(0)
  v_cvt_pk_bf16_f32 v21, v10, v11
  v_cvt_pk_bf16_f32 v22, v16, v17
  v_cvt_pk_bf16_f32 v23, v18, v19
  s_nop 1
  v_smfmac_f32_16x16x64_bf16 v[68:71], v[20:23], v[96:103], v3
  v_mfma_f32_16x16x32_bf16 v[52:55], v[12:15], v[20:23], v[52:55]
  v_smfmac_f32_16x16x64_bf16 v[72:75], v[20:23], v[104:111], v3
  s_nop 1
  v_permlane32_swap_b32 v68, v70
  v_permlane32_swap_b32 v69, v71
  v_add_f32 v56, v68, v70
  v_add_f32 v58, v69, v71
  ds_write_b128 v113, v[52:55]
  s_nop 0
  v_permlane32_swap_b32 v72, v74
  v_permlane32_swap_b32 v73, v75
  v_add_f32 v57, v72, v74
  v_add_f32 v59, v73, v75
  ds_write_b128 v2, v[56:59] offset:1024
  v_cmp_u_f32 vcc, v57, v59
  v_mov_b32 v36, 0
  v_mov_b32 v37, 0
  v_mov_b32 v38, 0
  v_mov_b32 v39, 0
  s_cbranch_vccnz cA_sc1_retry
cA_sc1_cont:
  s_add_u32 s24, s24, 28672
  s_add_u32 s26, s26, 28672
  buffer_load_dwordx4 v[80:83], v117, s[8:11], s24 offen offset:0 sc1
  buffer_load_dwordx4 v[84:87], v117, s[8:11], s24 offen offset:1024 sc1
  v_mov_b32 v40, 0
  v_mov_b32 v41, 0
  v_mov_b32 v42, 0
  v_mov_b32 v43, 0
  v_mov_b32 v44, 0
  v_mov_b32 v45, 0
  v_mov_b32 v46, 0
  v_mov_b32 v47, 0
  v_mov_b32 v48, 0
  v_mov_b32 v49, 0
  v_mov_b32 v50, 0
  v_mov_b32 v51, 0
  s_waitcnt lgkmcnt(0)
  s_barrier
  ds_read_b64 v[8:9], v114 offset:0
  ds_read_b64 v[10:11], v114 offset:1024
  ds_read_b64 v[12:13], v114 offset:2048
  ds_read_b64 v[14:15], v114 offset:3072
  ds_read2_b32 v[16:17], v115 offset0:0 offset1:64
  ds_read2_b32 v[18:19], v115 offset0:128 offset1:192
  s_waitcnt lgkmcnt(0)
  v_pk_add_f32 v[16:17], v[16:17], v[18:19]
  v_pk_add_f32 v[8:9], v[8:9], v[10:11]
  v_pk_add_f32 v[12:13], v[12:13], v[14:15]
  v_add_f32 v20, v16, v17
  v_pk_add_f32 v[8:9], v[8:9], v[12:13]
  v_max_f32 v22, v8, v9
  v_add_f32_dpp v20, v20, v20 row_ror:8 row_mask:0xf bank_mask:0xf
  s_nop 0
  v_max_f32_dpp v22, v22, v22 row_ror:8 row_mask:0xf bank_mask:0xf
  v_max_f32 v22, v22, v20
  s_nop 1
  v_max_f32_dpp v22, v22, v22 quad_perm:[1,0,3,2] row_mask:0xf bank_mask:0xf
  s_nop 1
  v_max_f32_dpp v22, v22, v22 quad_perm:[2,3,0,1] row_mask:0xf bank_mask:0xf
  s_nop 1
  v_max_f32_dpp v22, v22, v22 row_half_mirror row_mask:0xf bank_mask:0xf
  v_pk_add_f32 v[8:9], v[8:9], v[22:23] op_sel_hi:[1,0] neg_lo:[0,1] neg_hi:[0,1]
  v_sub_f32 v20, v20, v22
  v_exp_f32 v8, v8
  v_exp_f32 v9, v9
  v_exp_f32 v20, v20
  v_add_f32 v24, v8, v9
  v_fmac_f32 v24, 0.5, v20
  v_mov_b32_dpp v21, v20 quad_perm:[1,0,3,2] row_mask:0xf bank_mask:0xf
  s_nop 0
  v_add_f32_dpp v24, v24, v24 quad_perm:[1,0,3,2] row_mask:0xf bank_mask:0xf
  s_nop 1
  v_add_f32_dpp v24, v24, v24 quad_perm:[2,3,0,1] row_mask:0xf bank_mask:0xf
  s_nop 1
  v_add_f32_dpp v24, v24, v24 row_half_mirror row_mask:0xf bank_mask:0xf
  s_nop 1
  v_add_f32_dpp v24, v24, v24 row_ror:8 row_mask:0xf bank_mask:0xf
  v_rcp_f32 v24, v24
  s_nop 0
  v_pk_mul_f32 v[8:9], v[8:9], v[24:25] op_sel_hi:[1,0]
  v_pk_mul_f32 v[20:21], v[20:21], v[24:25] op_sel_hi:[1,0]
  v_cvt_pk_bf16_f32 v8, v8, v9
  v_cvt_pk_bf16_f32 v20, v20, v21
  v_min_u32 v8, -2, v8
  buffer_store_dword v8, v1, s[8:11], s20 offen
  v_min_u32 v20, -2, v20
  buffer_store_dword v20, v118, s[8:11], s20 offen
  buffer_store_dword v119, v1, s[8:11], s21 offen
  buffer_store_dword v119, v118, s[8:11], s21 offen
  v_mov_b32 v60, 0
  v_mov_b32 v61, 0
  v_mov_b32 v62, 0
  v_mov_b32 v63, 0
  v_mov_b32 v68, 0
  v_mov_b32 v69, 0
  v_mov_b32 v70, 0
  v_mov_b32 v71, 0
  v_mov_b32 v72, 0
  v_mov_b32 v73, 0
  v_mov_b32 v74, 0
  v_mov_b32 v75, 0
  v_mov_b32 v52, 0
  v_mov_b32 v53, 0
  v_mov_b32 v54, 0
  v_mov_b32 v55, 0
  v_mov_b32 v56, 0
  v_mov_b32 v57, 0
  v_mov_b32 v58, 0
  v_mov_b32 v59, 0
  s_mov_b32 s19, s18
  s_add_u32 s18, s18, 1
  s_mov_b32 s22, s20
  s_mov_b32 s20, s21
  s_mov_b32 s21, s22
  s_add_u32 s23, s20, 4096
  s_cmp_lt_u32 s19, 63
  s_cbranch_scc1 cA_sc1_loop
  s_branch cA_done
cA_sc1_r0:
  s_add_u32 s31, s31, 1
  buffer_load_dwordx4 v[8:11], v2, s[8:11], s20 offen offset:0 sc1
  s_waitcnt vmcnt(0)
  v_cmp_eq_u32 vcc, -1, v8
  v_mov_b32 v36, 0
  v_mov_b32 v37, 0
  v_mov_b32 v38, 0
  v_mov_b32 v39, 0
  v_mov_b32 v40, 0
  v_mov_b32 v41, 0
  v_mov_b32 v42, 0
  v_mov_b32 v43, 0
  v_mov_b32 v44, 0
  v_mov_b32 v45, 0
  v_mov_b32 v46, 0
  v_mov_b32 v47, 0
  v_mov_b32 v48, 0
  v_mov_b32 v49, 0
  v_mov_b32 v50, 0
  v_mov_b32 v51, 0
  s_nop 1
  s_cbranch_vccz cA_sc1_go
  s_add_u32 s30, s30, 1
  s_cmp_lt_u32 s30, 400000
  s_cbranch_scc1 cA_sc1_r0
  s_branch cA_abort
cA_sc1_r1:
  s_add_u32 s31, s31, 1
  buffer_load_dwordx4 v[12:15], v2, s[8:11], s20 offen offset:1024 sc1
  s_waitcnt vmcnt(0)
  v_cmp_eq_u32 vcc, -1, v12
  s_nop 4
  s_cbranch_vccz cA_sc1_c1
  s_add_u32 s30, s30, 1
  s_cmp_lt_u32 s30, 400000
  s_cbranch_scc1 cA_sc1_r1
  s_branch cA_abort
cA_sc1_r2:
  s_add_u32 s31, s31, 1
  buffer_load_dwordx4 v[16:19], v2, s[8:11], s20 offen offset:2048 sc1
  s_waitcnt vmcnt(0)
  v_cmp_eq_u32 vcc, -1, v16
  s_nop 4
  s_cbranch_vccz cA_sc1_c2
  s_add_u32 s30, s30, 1
  s_cmp_lt_u32 s30, 400000
  s_cbranch_scc1 cA_sc1_r2
  s_branch cA_abort
cA_sc1_r3:
  s_add_u32 s31, s31, 1
  buffer_load_dwordx4 v[20:23], v2, s[8:11], s20 offen offset:3072 sc1
  s_waitcnt vmcnt(0)
  v_cmp_eq_u32 vcc, -1, v20
  s_nop 4
  s_cbranch_vccz cA_sc1_c3
  s_add_u32 s30, s30, 1
  s_cmp_lt_u32 s30, 400000
  s_cbranch_scc1 cA_sc1_r3
  s_branch cA_abort
cA_sc1_r4:
  s_add_u32 s31, s31, 1
  buffer_load_dwordx4 v[28:31], v2, s[8:11], s23 offen offset:0 sc1
  buffer_load_dwordx4 v[24:27], v2, s[8:11], s23 offen offset:1024 sc1
  buffer_load_dwordx4 v[32:35], v2, s[8:11], s23 offen offset:2048 sc1
  s_waitcnt vmcnt(0)
  v_max3_u32 v66, v24, v27, v28
  v_max3_u32 v66, v66, v31, v32
  v_max_u32 v66, v66, v35
  v_cmp_eq_u32 vcc, -1, v66
  s_nop 4
  s_cbranch_vccz cA_sc1_c4
  s_add_u32 s30, s30, 1
  s_cmp_lt_u32 s30, 400000
  s_cbranch_scc1 cA_sc1_r4
  s_branch cA_abort
cA_sc1_retry:
  s_cmp_lg_u32 s62, 0
  s_cbranch_scc1 cA_sc1_cont
  s_waitcnt vmcnt(0) lgkmcnt(0)
cA_sc1_rv:
  buffer_load_dwordx4 v[8:11], v2, s[8:11], s20 offen offset:0 sc1
  buffer_load_dwordx4 v[12:15], v2, s[8:11], s20 offen offset:1024 sc1
  buffer_load_dwordx4 v[16:19], v2, s[8:11], s20 offen offset:2048 sc1
  buffer_load_dwordx4 v[20:23], v2, s[8:11], s20 offen offset:3072 sc1
  buffer_load_dwordx4 v[28:31], v2, s[8:11], s23 offen offset:0 sc1
  buffer_load_dwordx4 v[24:27], v2, s[8:11], s23 offen offset:1024 sc1
  buffer_load_dwordx4 v[32:35], v2, s[8:11], s23 offen offset:2048 sc1
  s_waitcnt vmcnt(0)
  v_pk_max_u16 v66, v8, v9
  v_pk_max_u16 v66, v66, v10
  v_pk_max_u16 v66, v66, v11
  v_pk_max_u16 v66, v66, v12
  v_pk_max_u16 v66, v66, v13
  v_pk_max_u16 v66, v66, v14
  v_pk_max_u16 v66, v66, v15
  v_pk_max_u16 v66, v66, v16
  v_pk_max_u16 v66, v66, v17
  v_pk_max_u16 v66, v66, v18
  v_pk_max_u16 v66, v66, v19
  v_pk_max_u16 v66, v66, v20
  v_pk_max_u16 v66, v66, v21
  v_pk_max_u16 v66, v66, v22
  v_pk_max_u16 v66, v66, v23
  v_pk_max_u16 v66, v66, v24
  v_pk_max_u16 v66, v66, v25
  v_pk_max_u16 v66, v66, v26
  v_pk_max_u16 v66, v66, v27
  v_pk_max_u16 v66, v66, v28
  v_pk_max_u16 v66, v66, v29
  v_pk_max_u16 v66, v66, v30
  v_pk_max_u16 v66, v66, v31
  v_pk_max_u16 v66, v66, v32
  v_pk_max_u16 v66, v66, v33
  v_pk_max_u16 v66, v66, v34
  v_pk_max_u16 v66, v66, v35
  v_lshlrev_b32 v67, 16, v66
  v_max_u32 v66, v66, v67
  v_cmp_le_u32 vcc, 0xffff0000, v66
  s_cbranch_vccz cA_sc1_rk
  s_add_u32 s30, s30, 1
  s_cmp_lt_u32 s30, 400000
  s_cbranch_scc1 cA_sc1_rv
  s_branch cA_abort
cA_sc1_rk:
  s_mov_b32 s62, 1
  v_mov_b32 v36, 0
  v_mov_b32 v37, 0
  v_mov_b32 v38, 0
  v_mov_b32 v39, 0
  v_mov_b32 v40, 0
  v_mov_b32 v41, 0
  v_mov_b32 v42, 0
  v_mov_b32 v43, 0
  v_mov_b32 v44, 0
  v_mov_b32 v45, 0
  v_mov_b32 v46, 0
  v_mov_b32 v47, 0
  v_mov_b32 v48, 0
  v_mov_b32 v49, 0
  v_mov_b32 v50, 0
  v_mov_b32 v51, 0
  v_mov_b32 v60, 0
  v_mov_b32 v61, 0
  v_mov_b32 v62, 0
  v_mov_b32 v63, 0
  v_mov_b32 v68, 0
  v_mov_b32 v69, 0
  v_mov_b32 v70, 0
  v_mov_b32 v71, 0
  v_mov_b32 v72, 0
  v_mov_b32 v73, 0
  v_mov_b32 v74, 0
  v_mov_b32 v75, 0
  v_mov_b32 v52, 0
  v_mov_b32 v53, 0
  v_mov_b32 v54, 0
  v_mov_b32 v55, 0
  v_mov_b32 v56, 0
  v_mov_b32 v57, 0
  v_mov_b32 v58, 0
  v_mov_b32 v59, 0
  s_add_u32 s31, s31, 0x100
  s_nop 0
  s_branch cA_sc1_go
.p2align 6
cA_sc2_loop:
  s_mov_b32 s30, 0
  s_mov_b32 s62, 0
  s_setprio 3
  s_barrier
  buffer_load_dwordx4 v[8:11], v2, s[8:11], s20 offen offset:0 sc1
  s_setprio 2
  buffer_load_dwordx4 v[12:15], v2, s[8:11], s20 offen offset:1024 sc1
  s_setprio 1
  buffer_load_dwordx4 v[16:19], v2, s[8:11], s20 offen offset:2048 sc1
  s_setprio 0
  buffer_load_dwordx4 v[20:23], v2, s[8:11], s20 offen offset:3072 sc1
cA_sc2_go:
  s_waitcnt vmcnt(3)
  v_smfmac_f32_16x16x64_bf16 v[36:39], v[8:11], a[0:7], v3
  buffer_load_dwordx4 v[24:27], v2, s[8:11], s23 offen offset:0 sc1
  v_cmp_eq_u32 vcc, -1, v8
  v_smfmac_f32_16x16x64_bf16 v[40:43], v[8:11], a[56:63], v3
  v_smfmac_f32_16x16x64_bf16 v[44:47], v[8:11], a[112:119], v3
  buffer_load_dwordx4 v[32:35], v2, s[8:11], s23 offen offset:1024 sc1
  s_cbranch_vccnz cA_sc2_r0
  v_smfmac_f32_16x16x64_bf16 v[48:51], v[8:11], a[168:175], v3
  v_smfmac_f32_16x16x64_bf16 v[52:55], v[8:11], a[224:231], v3
  s_waitcnt vmcnt(4)
  v_cmp_eq_u32 vcc, -1, v12
  v_smfmac_f32_16x16x64_bf16 v[56:59], v[8:11], v[144:151], v3
  buffer_load_dwordx4 v[28:31], v2, s[8:11], s23 offen offset:2048 sc1
  v_smfmac_f32_16x16x64_bf16 v[62:65], v[8:11], v[200:207], v3
  s_cbranch_vccnz cA_sc2_r1
cA_sc2_c1:
  v_smfmac_f32_16x16x64_bf16 v[36:39], v[12:15], a[8:15], v3
  v_smfmac_f32_16x16x64_bf16 v[40:43], v[12:15], a[64:71], v3
  v_smfmac_f32_16x16x64_bf16 v[44:47], v[12:15], a[120:127], v3
  v_smfmac_f32_16x16x64_bf16 v[48:51], v[12:15], a[176:183], v3
  v_smfmac_f32_16x16x64_bf16 v[52:55], v[12:15], a[232:239], v3
  s_waitcnt vmcnt(4)
  v_cmp_eq_u32 vcc, -1, v16
  v_smfmac_f32_16x16x64_bf16 v[56:59], v[12:15], v[152:159], v3
  buffer_load_dwordx4 v[88:91], v117, s[8:11], s26 offen offset:0 sc1
  v_smfmac_f32_16x16x64_bf16 v[62:65], v[12:15], v[208:215], v3
  s_cbranch_vccnz cA_sc2_r2
cA_sc2_c2:
  v_smfmac_f32_16x16x64_bf16 v[36:39], v[16:19], a[16:23], v3
  v_smfmac_f32_16x16x64_bf16 v[40:43], v[16:19], a[72:79], v3
  v_smfmac_f32_16x16x64_bf16 v[44:47], v[16:19], a[128:135], v3
  buffer_load_dwordx4 v[92:95], v117, s[8:11], s26 offen offset:1024 sc1
  v_smfmac_f32_16x16x64_bf16 v[48:51], v[16:19], a[184:191], v3
  v_smfmac_f32_16x16x64_bf16 v[52:55], v[16:19], a[240:247], v3
  s_waitcnt vmcnt(5)
  v_cmp_eq_u32 vcc, -1, v20
  v_smfmac_f32_16x16x64_bf16 v[56:59], v[16:19], v[160:167], v3
  v_smfmac_f32_16x16x64_bf16 v[62:65], v[16:19], v[216:223], v3
  buffer_load_dwordx4 v[96:99], v2, s[8:11], s24 offen offset:0 sc1
  s_cbranch_vccnz cA_sc2_r3
cA_sc2_c3:
  v_smfmac_f32_16x16x64_bf16 v[36:39], v[20:23], a[24:31], v3
  v_smfmac_f32_16x16x64_bf16 v[40:43], v[20:23], a[80:87], v3
  s_waitcnt vmcnt(3)
  v_max3_u32 v66, v24, v27, v28
  v_smfmac_f32_16x16x64_bf16 v[44:47], v[20:23], a[136:143], v3
  v_max3_u32 v66, v66, v31, v32
  v_smfmac_f32_16x16x64_bf16 v[48:51], v[20:23], a[192:199], v3
  buffer_load_dwordx4 v[100:103], v2, s[8:11], s24 offen offset:1024 sc1
  v_max_u32 v66, v66, v35
  v_smfmac_f32_16x16x64_bf16 v[52:55], v[20:23], a[248:255], v3
  v_cmp_eq_u32 vcc, -1, v66
  v_smfmac_f32_16x16x64_bf16 v[56:59], v[20:23], v[168:175], v3
  v_smfmac_f32_16x16x64_bf16 v[62:65], v[20:23], v[224:231], v3
  s_cbranch_vccnz cA_sc2_r4
cA_sc2_c4:
  v_smfmac_f32_16x16x64_bf16 v[62:65], v[24:27], v[232:239], v3
  buffer_load_dwordx4 v[104:107], v2, s[8:11], s26 offen offset:0 sc1
  v_smfmac_f32_16x16x64_bf16 v[62:65], v[32:35], v[240:247], v3
  v_smfmac_f32_16x16x64_bf16 v[62:65], v[28:31], v[248:255], v3
  v_smfmac_f32_16x16x64_bf16 v[52:55], v[24:27], v[120:127], v3
  v_smfmac_f32_16x16x64_bf16 v[52:55], v[32:35], v[128:135], v3
  buffer_load_dwordx4 v[108:111], v2, s[8:11], s26 offen offset:1024 sc1
  v_smfmac_f32_16x16x64_bf16 v[52:55], v[28:31], v[136:143], v3
  v_cvt_pk_bf16_f32 v62, v62, v63
  v_smfmac_f32_16x16x64_bf16 v[56:59], v[24:27], v[176:183], v3
  v_cvt_pk_bf16_f32 v63, v64, v65
  v_smfmac_f32_16x16x64_bf16 v[56:59], v[32:35], v[184:191], v3
  v_mfma_f32_16x16x32_bf16 v[8:11], v[60:63], v[4:7], 0
  v_cvt_pk_bf16_f32 v55, v54, v55
  v_smfmac_f32_16x16x64_bf16 v[56:59], v[28:31], v[192:199], v3
  v_cvt_pk_bf16_f32 v54, v52, v53
  v_smfmac_f32_16x16x64_bf16 v[36:39], v[24:27], a[32:39], v3
  s_nop 1
  v_cvt_pk_bf16_f32 v76, v8, v9
  v_smfmac_f32_16x16x64_bf16 v[36:39], v[32:35], a[40:47], v3
  v_cvt_pk_bf16_f32 v77, v10, v11
  v_smfmac_f32_16x16x64_bf16 v[36:39], v[28:31], a[48:55], v3
  v_cvt_pk_bf16_f32 v56, v56, v57
  v_smfmac_f32_16x16x64_bf16 v[40:43], v[24:27], a[88:95], v3
  v_cvt_pk_bf16_f32 v57, v58, v59
  v_smfmac_f32_16x16x64_bf16 v[40:43], v[32:35], a[96:103], v3
  v_mfma_f32_16x16x32_bf16 v[12:15], v[54:57], v[4:7], 0
  v_cvt_pk_bf16_f32 v39, v38, v39
  v_smfmac_f32_16x16x64_bf16 v[40:43], v[28:31], a[104:111], v3
  v_cvt_pk_bf16_f32 v38, v36, v37
  v_smfmac_f32_16x16x64_bf16 v[44:47], v[24:27], a[144:151], v3
  s_nop 1
  v_cvt_pk_bf16_f32 v78, v12, v13
  v_smfmac_f32_16x16x64_bf16 v[44:47], v[32:35], a[152:159], v3
  v_cvt_pk_bf16_f32 v79, v14, v15
  v_smfmac_f32_16x16x64_bf16 v[44:47], v[28:31], a[160:167], v3
  v_cvt_pk_bf16_f32 v40, v40, v41
  v_smfmac_f32_16x16x64_bf16 v[48:51], v[24:27], a[200:207], v3
  v_cvt_pk_bf16_f32 v41, v42, v43
  v_smfmac_f32_16x16x64_bf16 v[48:51], v[32:35], a[208:215], v3
  v_smfmac_f32_16x16x64_bf16 v[48:51], v[28:31], a[216:223], v3
  s_waitcnt vmcnt(4)
  v_cvt_pk_bf16_f32 v47, v46, v47
  v_smfmac_f32_16x16x64_bf16 v[68:71], v[76:79], v[80:87], v3
  v_cvt_pk_bf16_f32 v46, v44, v45
  v_mfma_f32_16x16x32_bf16 v[8:11], v[38:41], v[4:7], 0
  s_nop 1
  v_cvt_pk_bf16_f32 v48, v48, v49
  v_cvt_pk_bf16_f32 v49, v50, v51
  s_nop 1
  v_mfma_f32_16x16x32_bf16 v[12:15], v[46:49], v[4:7], 0
  v_smfmac_f32_16x16x64_bf16 v[72:75], v[76:79], v[88:95], v3
  v_cvt_pk_bf16_f32 v20, v8, v9
  v_mfma_f32_16x16x32_bf16 v[52:55], v[30:33], v[76:79], 0
  s_waitcnt vmcnt(0)
  v_cvt_pk_bf16_f32 v21, v10, v11
  v_cvt_pk_bf16_f32 v22, v12, v13
  v_cvt_pk_bf16_f32 v23, v14, v15
  s_nop 1
  v_smfmac_f32_16x16x64_bf16 v[68:71], v[20:23], v[96:103], v3
  v_mfma_f32_16x16x32_bf16 v[52:55], v[16:19], v[20:23], v[52:55]
  v_smfmac_f32_16x16x64_bf16 v[72:75], v[20:23], v[104:111], v3
  s_nop 1
  v_permlane32_swap_b32 v68, v70
  v_permlane32_swap_b32 v69, v71
  v_add_f32 v56, v68, v70
  v_add_f32 v58, v69, v71
  ds_write_b128 v113, v[52:55]
  s_nop 0
  v_permlane32_swap_b32 v72, v74
  v_permlane32_swap_b32 v73, v75
  v_add_f32 v57, v72, v74
  v_add_f32 v59, v73, v75
  ds_write_b128 v2, v[56:59] offset:2048
  v_cmp_u_f32 vcc, v57, v59
  v_mov_b32 v36, 0
  v_mov_b32 v37, 0
  v_mov_b32 v38, 0
  v_mov_b32 v39, 0
  s_cbranch_vccnz cA_sc2_retry
cA_sc2_cont:
  s_add_u32 s24, s24, 28672
  s_add_u32 s26, s26, 28672
  buffer_load_dwordx4 v[80:83], v117, s[8:11], s24 offen offset:0 sc1
  buffer_load_dwordx4 v[84:87], v117, s[8:11], s24 offen offset:1024 sc1
  v_mov_b32 v40, 0
  v_mov_b32 v41, 0
  v_mov_b32 v42, 0
  v_mov_b32 v43, 0
  v_mov_b32 v44, 0
  v_mov_b32 v45, 0
  v_mov_b32 v46, 0
  v_mov_b32 v47, 0
  v_mov_b32 v48, 0
  v_mov_b32 v49, 0
  v_mov_b32 v50, 0
  v_mov_b32 v51, 0
  s_waitcnt lgkmcnt(0)
  s_barrier
  v_mov_b32 v62, 0
  v_mov_b32 v63, 0
  v_mov_b32 v64, 0
  v_mov_b32 v65, 0
  v_mov_b32 v68, 0
  v_mov_b32 v69, 0
  v_mov_b32 v70, 0
  v_mov_b32 v71, 0
  v_mov_b32 v72, 0
  v_mov_b32 v73, 0
  v_mov_b32 v74, 0
  v_mov_b32 v75, 0
  v_mov_b32 v52, 0
  v_mov_b32 v53, 0
  v_mov_b32 v54, 0
  v_mov_b32 v55, 0
  v_mov_b32 v56, 0
  v_mov_b32 v57, 0
  v_mov_b32 v58, 0
  v_mov_b32 v59, 0
  v_mov_b32 v66, 0
  v_mov_b32 v66, 0
  v_mov_b32 v66, 0
  v_mov_b32 v66, 0
  v_mov_b32 v66, 0
  v_mov_b32 v66, 0
  v_mov_b32 v66, 0
  v_mov_b32 v66, 0
  v_mov_b32 v66, 0
  v_mov_b32 v66, 0
  buffer_store_dword v119, v1, s[8:11], 0 offen
  s_mov_b32 s19, s18
  s_add_u32 s18, s18, 1
  s_mov_b32 s22, s20
  s_mov_b32 s20, s21
  s_mov_b32 s21, s22
  s_add_u32 s23, s20, 4096
  v_mov_b32 v119, s18
  s_cmp_lt_u32 s19, 63
  s_nop 0
  s_cbranch_scc1 cA_sc2_loop
  s_branch cA_done
cA_sc2_r0:
  s_add_u32 s31, s31, 1
  buffer_load_dwordx4 v[8:11], v2, s[8:11], s20 offen offset:0 sc1
  s_waitcnt vmcnt(0)
  v_cmp_eq_u32 vcc, -1, v8
  v_mov_b32 v36, 0
  v_mov_b32 v37, 0
  v_mov_b32 v38, 0
  v_mov_b32 v39, 0
  v_mov_b32 v40, 0
  v_mov_b32 v41, 0
  v_mov_b32 v42, 0
  v_mov_b32 v43, 0
  v_mov_b32 v44, 0
  v_mov_b32 v45, 0
  v_mov_b32 v46, 0
  v_mov_b32 v47, 0
  v_mov_b32 v48, 0
  v_mov_b32 v49, 0
  v_mov_b32 v50, 0
  v_mov_b32 v51, 0
  s_nop 1
  s_cbranch_vccz cA_sc2_go
  s_add_u32 s30, s30, 1
  s_cmp_lt_u32 s30, 400000
  s_cbranch_scc1 cA_sc2_r0
  s_branch cA_abort
cA_sc2_r1:
  s_add_u32 s31, s31, 1
  buffer_load_dwordx4 v[12:15], v2, s[8:11], s20 offen offset:1024 sc1
  s_waitcnt vmcnt(0)
  v_cmp_eq_u32 vcc, -1, v12
  s_nop 4
  s_cbranch_vccz cA_sc2_c1
  s_add_u32 s30, s30, 1
  s_cmp_lt_u32 s30, 400000
  s_cbranch_scc1 cA_sc2_r1
  s_branch cA_abort
cA_sc2_r2:
  s_add_u32 s31, s31, 1
  buffer_load_dwordx4 v[16:19], v2, s[8:11], s20 offen offset:2048 sc1
  s_waitcnt vmcnt(0)
  v_cmp_eq_u32 vcc, -1, v16
  s_nop 4
  s_cbranch_vccz cA_sc2_c2
  s_add_u32 s30, s30, 1
  s_cmp_lt_u32 s30, 400000
  s_cbranch_scc1 cA_sc2_r2
  s_branch cA_abort
cA_sc2_r3:
  s_add_u32 s31, s31, 1
  buffer_load_dwordx4 v[20:23], v2, s[8:11], s20 offen offset:3072 sc1
  s_waitcnt vmcnt(0)
  v_cmp_eq_u32 vcc, -1, v20
  s_nop 4
  s_cbranch_vccz cA_sc2_c3
  s_add_u32 s30, s30, 1
  s_cmp_lt_u32 s30, 400000
  s_cbranch_scc1 cA_sc2_r3
  s_branch cA_abort
cA_sc2_r4:
  s_add_u32 s31, s31, 1
  buffer_load_dwordx4 v[24:27], v2, s[8:11], s23 offen offset:0 sc1
  buffer_load_dwordx4 v[32:35], v2, s[8:11], s23 offen offset:1024 sc1
  buffer_load_dwordx4 v[28:31], v2, s[8:11], s23 offen offset:2048 sc1
  s_waitcnt vmcnt(0)
  v_max3_u32 v66, v24, v27, v28
  v_max3_u32 v66, v66, v31, v32
  v_max_u32 v66, v66, v35
  v_cmp_eq_u32 vcc, -1, v66
  s_nop 4
  s_cbranch_vccz cA_sc2_c4
  s_add_u32 s30, s30, 1
  s_cmp_lt_u32 s30, 400000
  s_cbranch_scc1 cA_sc2_r4
  s_branch cA_abort
cA_sc2_retry:
  s_cmp_lg_u32 s62, 0
  s_cbranch_scc1 cA_sc2_cont
  s_waitcnt vmcnt(0) lgkmcnt(0)
cA_sc2_rv:
  buffer_load_dwordx4 v[8:11], v2, s[8:11], s20 offen offset:0 sc1
  buffer_load_dwordx4 v[12:15], v2, s[8:11], s20 offen offset:1024 sc1
  buffer_load_dwordx4 v[16:19], v2, s[8:11], s20 offen offset:2048 sc1
  buffer_load_dwordx4 v[20:23], v2, s[8:11], s20 offen offset:3072 sc1
  buffer_load_dwordx4 v[24:27], v2, s[8:11], s23 offen offset:0 sc1
  buffer_load_dwordx4 v[32:35], v2, s[8:11], s23 offen offset:1024 sc1
  buffer_load_dwordx4 v[28:31], v2, s[8:11], s23 offen offset:2048 sc1
  s_waitcnt vmcnt(0)
  v_pk_max_u16 v66, v8, v9
  v_pk_max_u16 v66, v66, v10
  v_pk_max_u16 v66, v66, v11
  v_pk_max_u16 v66, v66, v12
  v_pk_max_u16 v66, v66, v13
  v_pk_max_u16 v66, v66, v14
  v_pk_max_u16 v66, v66, v15
  v_pk_max_u16 v66, v66, v16
  v_pk_max_u16 v66, v66, v17
  v_pk_max_u16 v66, v66, v18
  v_pk_max_u16 v66, v66, v19
  v_pk_max_u16 v66, v66, v20
  v_pk_max_u16 v66, v66, v21
  v_pk_max_u16 v66, v66, v22
  v_pk_max_u16 v66, v66, v23
  v_pk_max_u16 v66, v66, v24
  v_pk_max_u16 v66, v66, v25
  v_pk_max_u16 v66, v66, v26
  v_pk_max_u16 v66, v66, v27
  v_pk_max_u16 v66, v66, v28
  v_pk_max_u16 v66, v66, v29
  v_pk_max_u16 v66, v66, v30
  v_pk_max_u16 v66, v66, v31
  v_pk_max_u16 v66, v66, v32
  v_pk_max_u16 v66, v66, v33
  v_pk_max_u16 v66, v66, v34
  v_pk_max_u16 v66, v66, v35
  v_lshlrev_b32 v67, 16, v66
  v_max_u32 v66, v66, v67
  v_cmp_le_u32 vcc, 0xffff0000, v66
  s_cbranch_vccz cA_sc2_rk
  s_add_u32 s30, s30, 1
  s_cmp_lt_u32 s30, 400000
  s_cbranch_scc1 cA_sc2_rv
  s_branch cA_abort
cA_sc2_rk:
  s_mov_b32 s62, 1
  v_mov_b32 v36, 0
  v_mov_b32 v37, 0
  v_mov_b32 v38, 0
  v_mov_b32 v39, 0
  v_mov_b32 v40, 0
  v_mov_b32 v41, 0
  v_mov_b32 v42, 0
  v_mov_b32 v43, 0
  v_mov_b32 v44, 0
  v_mov_b32 v45, 0
  v_mov_b32 v46, 0
  v_mov_b32 v47, 0
  v_mov_b32 v48, 0
  v_mov_b32 v49, 0
  v_mov_b32 v50, 0
  v_mov_b32 v51, 0
  v_mov_b32 v62, 0
  v_mov_b32 v63, 0
  v_mov_b32 v64, 0
  v_mov_b32 v65, 0
  v_mov_b32 v68, 0
  v_mov_b32 v69, 0
  v_mov_b32 v70, 0
  v_mov_b32 v71, 0
  v_mov_b32 v72, 0
  v_mov_b32 v73, 0
  v_mov_b32 v74, 0
  v_mov_b32 v75, 0
  v_mov_b32 v52, 0
  v_mov_b32 v53, 0
  v_mov_b32 v54, 0
  v_mov_b32 v55, 0
  v_mov_b32 v56, 0
  v_mov_b32 v57, 0
  v_mov_b32 v58, 0
  v_mov_b32 v59, 0
  s_add_u32 s31, s31, 0x100
  s_nop 0
  s_branch cA_sc2_go
.p2align 6
cA_sc3_loop:
  s_mov_b32 s30, 0
  s_mov_b32 s62, 0
  s_setprio 3
  s_barrier
  buffer_load_dwordx4 v[8:11], v2, s[8:11], s20 offen offset:0 sc1
  s_setprio 2
  buffer_load_dwordx4 v[12:15], v2, s[8:11], s20 offen offset:1024 sc1
  s_setprio 1
  buffer_load_dwordx4 v[16:19], v2, s[8:11], s20 offen offset:2048 sc1
  s_setprio 0
  buffer_load_dwordx4 v[20:23], v2, s[8:11], s20 offen offset:3072 sc1
cA_sc3_go:
  s_waitcnt vmcnt(3)
  v_smfmac_f32_16x16x64_bf16 v[36:39], v[8:11], a[0:7], v3
  buffer_load_dwordx4 v[24:27], v2, s[8:11], s23 offen offset:0 sc1
  v_cmp_eq_u32 vcc, -1, v8
  v_smfmac_f32_16x16x64_bf16 v[40:43], v[8:11], a[56:63], v3
  v_smfmac_f32_16x16x64_bf16 v[44:47], v[8:11], a[112:119], v3
  buffer_load_dwordx4 v[28:31], v2, s[8:11], s23 offen offset:1024 sc1
  s_cbranch_vccnz cA_sc3_r0
  v_smfmac_f32_16x16x64_bf16 v[48:51], v[8:11], a[168:175], v3
  v_smfmac_f32_16x16x64_bf16 v[52:55], v[8:11], a[224:231], v3
  s_waitcnt vmcnt(4)
  v_cmp_eq_u32 vcc, -1, v12
  v_smfmac_f32_16x16x64_bf16 v[56:59], v[8:11], v[144:151], v3
  buffer_load_dwordx4 v[32:35], v2, s[8:11], s23 offen offset:2048 sc1
  v_smfmac_f32_16x16x64_bf16 v[62:65], v[8:11], v[200:207], v3
  s_cbranch_vccnz cA_sc3_r1
cA_sc3_c1:
  v_smfmac_f32_16x16x64_bf16 v[36:39], v[12:15], a[8:15], v3
  v_smfmac_f32_16x16x64_bf16 v[40:43], v[12:15], a[64:71], v3
  v_smfmac_f32_16x16x64_bf16 v[44:47], v[12:15], a[120:127], v3
  v_smfmac_f32_16x16x64_bf16 v[48:51], v[12:15], a[176:183], v3
  v_smfmac_f32_16x16x64_bf16 v[52:55], v[12:15], a[232:239], v3
  s_waitcnt vmcnt(4)
  v_cmp_eq_u32 vcc, -1, v16
  v_smfmac_f32_16x16x64_bf16 v[56:59], v[12:15], v[152:159], v3
  buffer_load_dwordx4 v[88:91], v117, s[8:11], s26 offen offset:0 sc1
  v_smfmac_f32_16x16x64_bf16 v[62:65], v[12:15], v[208:215], v3
  s_cbranch_vccnz cA_sc3_r2
cA_sc3_c2:
  v_smfmac_f32_16x16x64_bf16 v[36:39], v[16:19], a[16:23], v3
  v_smfmac_f32_16x16x64_bf16 v[40:43], v[16:19], a[72:79], v3
  v_smfmac_f32_16x16x64_bf16 v[44:47], v[16:19], a[128:135], v3
  buffer_load_dwordx4 v[92:95], v117, s[8:11], s26 offen offset:1024 sc1
  v_smfmac_f32_16x16x64_bf16 v[48:51], v[16:19], a[184:191], v3
  v_smfmac_f32_16x16x64_bf16 v[52:55], v[16:19], a[240:247], v3
  s_waitcnt vmcnt(5)
  v_cmp_eq_u32 vcc, -1, v20
  v_smfmac_f32_16x16x64_bf16 v[56:59], v[16:19], v[160:167], v3
  v_smfmac_f32_16x16x64_bf16 v[62:65], v[16:19], v[216:223], v3
  buffer_load_dwordx4 v[96:99], v2, s[8:11], s24 offen offset:0 sc1
  s_cbranch_vccnz cA_sc3_r3
cA_sc3_c3:
  v_smfmac_f32_16x16x64_bf16 v[36:39], v[20:23], a[24:31], v3
  v_smfmac_f32_16x16x64_bf16 v[40:43], v[20:23], a[80:87], v3
  s_waitcnt vmcnt(3)
  v_max3_u32 v66, v24, v27, v28
  v_smfmac_f32_16x16x64_bf16 v[44:47], v[20:23], a[136:143], v3
  v_max3_u32 v66, v66, v31, v32
  v_smfmac_f32_16x16x64_bf16 v[48:51], v[20:23], a[192:199], v3
  buffer_load_dwordx4 v[100:103], v2, s[8:11], s24 offen offset:1024 sc1
  v_max_u32 v66, v66, v35
  v_smfmac_f32_16x16x64_bf16 v[52:55], v[20:23], a[248:255], v3
  v_cmp_eq_u32 vcc, -1, v66
  v_smfmac_f32_16x16x64_bf16 v[56:59], v[20:23], v[168:175], v3
  v_smfmac_f32_16x16x64_bf16 v[62:65], v[20:23], v[224:231], v3
  s_cbranch_vccnz cA_sc3_r4
cA_sc3_c4:
  v_smfmac_f32_16x16x64_bf16 v[62:65], v[24:27], v[232:239], v3
  buffer_load_dwordx4 v[104:107], v2, s[8:11], s26 offen offset:0 sc1
  v_smfmac_f32_16x16x64_bf16 v[62:65], v[28:31], v[240:247], v3
  v_smfmac_f32_16x16x64_bf16 v[62:65], v[32:35], v[248:255], v3
  v_smfmac_f32_16x16x64_bf16 v[52:55], v[24:27], v[120:127], v3
  v_smfmac_f32_16x16x64_bf16 v[52:55], v[28:31], v[128:135], v3
  buffer_load_dwordx4 v[108:111], v2, s[8:11], s26 offen offset:1024 sc1
  v_smfmac_f32_16x16x64_bf16 v[52:55], v[32:35], v[136:143], v3
  v_cvt_pk_bf16_f32 v62, v62, v63
  v_smfmac_f32_16x16x64_bf16 v[56:59], v[24:27], v[176:183], v3
  v_cvt_pk_bf16_f32 v63, v64, v65
  v_smfmac_f32_16x16x64_bf16 v[56:59], v[28:31], v[184:191], v3
  v_mfma_f32_16x16x32_bf16 v[8:11], v[60:63], v[4:7], 0
  v_cvt_pk_bf16_f32 v55, v54, v55
  v_smfmac_f32_16x16x64_bf16 v[56:59], v[32:35], v[192:199], v3
  v_cvt_pk_bf16_f32 v54, v52, v53
  v_smfmac_f32_16x16x64_bf16 v[36:39], v[24:27], a[32:39], v3
  s_nop 1
  v_cvt_pk_bf16_f32 v78, v8, v9
  v_smfmac_f32_16x16x64_bf16 v[36:39], v[28:31], a[40:47], v3
  v_cvt_pk_bf16_f32 v79, v10, v11
  v_smfmac_f32_16x16x64_bf16 v[36:39], v[32:35], a[48:55], v3
  v_cvt_pk_bf16_f32 v56, v56, v57
  v_smfmac_f32_16x16x64_bf16 v[40:43], v[24:27], a[88:95], v3
  v_cvt_pk_bf16_f32 v57, v58, v59
  v_smfmac_f32_16x16x64_bf16 v[40:43], v[28:31], a[96:103], v3
  v_mfma_f32_16x16x32_bf16 v[12:15], v[54:57], v[4:7], 0
  v_cvt_pk_bf16_f32 v39, v38, v39
  v_smfmac_f32_16x16x64_bf16 v[40:43], v[32:35], a[104:111], v3
  v_cvt_pk_bf16_f32 v38, v36, v37
  v_smfmac_f32_16x16x64_bf16 v[44:47], v[24:27], a[144:151], v3
  s_nop 1
  v_cvt_pk_bf16_f32 v76, v12, v13
  v_smfmac_f32_16x16x64_bf16 v[44:47], v[28:31], a[152:159], v3
  v_cvt_pk_bf16_f32 v77, v14, v15
  v_smfmac_f32_16x16x64_bf16 v[44:47], v[32:35], a[160:167], v3
  v_cvt_pk_bf16_f32 v40, v40, v41
  v_smfmac_f32_16x16x64_bf16 v[48:51], v[24:27], a[200:207], v3
  v_cvt_pk_bf16_f32 v41, v42, v43
  v_smfmac_f32_16x16x64_bf16 v[48:51], v[28:31], a[208:215], v3
  v_smfmac_f32_16x16x64_bf16 v[48:51], v[32:35], a[216:223], v3
  s_waitcnt vmcnt(4)
  v_cvt_pk_bf16_f32 v47, v46, v47
  v_smfmac_f32_16x16x64_bf16 v[68:71], v[76:79], v[80:87], v3
  v_cvt_pk_bf16_f32 v46, v44, v45
  v_mfma_f32_16x16x32_bf16 v[8:11], v[38:41], v[4:7], 0
  s_nop 1
  v_cvt_pk_bf16_f32 v48, v48, v49
  v_cvt_pk_bf16_f32 v49, v50, v51
  s_nop 1
  v_mfma_f32_16x16x32_bf16 v[12:15], v[46:49], v[4:7], 0
  v_smfmac_f32_16x16x64_bf16 v[72:75], v[76:79], v[88:95], v3
  v_cvt_pk_bf16_f32 v16, v8, v9
  v_mfma_f32_16x16x32_bf16 v[52:55], v[30:33], v[76:79], 0
  s_waitcnt vmcnt(0)
  v_cvt_pk_bf16_f32 v17, v10, v11
  v_cvt_pk_bf16_f32 v18, v12, v13
  v_cvt_pk_bf16_f32 v19, v14, v15
  s_nop 1
  v_smfmac_f32_16x16x64_bf16 v[68:71], v[16:19], v[96:103], v3
  v_mfma_f32_16x16x32_bf16 v[52:55], v[20:23], v[16:19], v[52:55]
  v_smfmac_f32_16x16x64_bf16 v[72:75], v[16:19], v[104:111], v3
  s_nop 1
  v_permlane32_swap_b32 v68, v70
  v_permlane32_swap_b32 v69, v71
  v_add_f32 v56, v68, v70
  v_add_f32 v58, v69, v71
  ds_write_b128 v113, v[52:55]
  s_nop 0
  v_permlane32_swap_b32 v72, v74
  v_permlane32_swap_b32 v73, v75
  v_add_f32 v57, v72, v74
  v_add_f32 v59, v73, v75
  ds_write_b128 v2, v[56:59] offset:3072
  v_cmp_u_f32 vcc, v57, v59
  v_mov_b32 v36, 0
  v_mov_b32 v37, 0
  v_mov_b32 v38, 0
  v_mov_b32 v39, 0
  s_cbranch_vccnz cA_sc3_retry
cA_sc3_cont:
  s_add_u32 s24, s24, 28672
  s_add_u32 s26, s26, 28672
  buffer_load_dwordx4 v[80:83], v117, s[8:11], s24 offen offset:0 sc1
  buffer_load_dwordx4 v[84:87], v117, s[8:11], s24 offen offset:1024 sc1
  v_mov_b32 v40, 0
  v_mov_b32 v41, 0
  v_mov_b32 v42, 0
  v_mov_b32 v43, 0
  v_mov_b32 v44, 0
  v_mov_b32 v45, 0
  v_mov_b32 v46, 0
  v_mov_b32 v47, 0
  v_mov_b32 v48, 0
  v_mov_b32 v49, 0
  v_mov_b32 v50, 0
  v_mov_b32 v51, 0
  s_waitcnt lgkmcnt(0)
  s_barrier
  v_mov_b32 v62, 0
  v_mov_b32 v63, 0
  v_mov_b32 v64, 0
  v_mov_b32 v65, 0
  v_mov_b32 v68, 0
  v_mov_b32 v69, 0
  v_mov_b32 v70, 0
  v_mov_b32 v71, 0
  v_mov_b32 v72, 0
  v_mov_b32 v73, 0
  v_mov_b32 v74, 0
  v_mov_b32 v75, 0
  v_mov_b32 v52, 0
  v_mov_b32 v53, 0
  v_mov_b32 v54, 0
  v_mov_b32 v55, 0
  v_mov_b32 v56, 0
  v_mov_b32 v57, 0
  v_mov_b32 v58, 0
  v_mov_b32 v59, 0
  s_mov_b32 s19, s18
  s_add_u32 s18, s18, 1
  s_mov_b32 s22, s20
  s_mov_b32 s20, s21
  s_mov_b32 s21, s22
  s_add_u32 s23, s20, 4096
  s_cmp_lt_u32 s19, 63
  s_cbranch_scc1 cA_sc3_loop
  s_branch cA_done
cA_sc3_r0:
  s_add_u32 s31, s31, 1
  buffer_load_dwordx4 v[8:11], v2, s[8:11], s20 offen offset:0 sc1
  s_waitcnt vmcnt(0)
  v_cmp_eq_u32 vcc, -1, v8
  v_mov_b32 v36, 0
  v_mov_b32 v37, 0
  v_mov_b32 v38, 0
  v_mov_b32 v39, 0
  v_mov_b32 v40, 0
  v_mov_b32 v41, 0
  v_mov_b32 v42, 0
  v_mov_b32 v43, 0
  v_mov_b32 v44, 0
  v_mov_b32 v45, 0
  v_mov_b32 v46, 0
  v_mov_b32 v47, 0
  v_mov_b32 v48, 0
  v_mov_b32 v49, 0
  v_mov_b32 v50, 0
  v_mov_b32 v51, 0
  s_nop 1
  s_cbranch_vccz cA_sc3_go
  s_add_u32 s30, s30, 1
  s_cmp_lt_u32 s30, 400000
  s_cbranch_scc1 cA_sc3_r0
  s_branch cA_abort
cA_sc3_r1:
  s_add_u32 s31, s31, 1
  buffer_load_dwordx4 v[12:15], v2, s[8:11], s20 offen offset:1024 sc1
  s_waitcnt vmcnt(0)
  v_cmp_eq_u32 vcc, -1, v12
  s_nop 4
  s_cbranch_vccz cA_sc3_c1
  s_add_u32 s30, s30, 1
  s_cmp_lt_u32 s30, 400000
  s_cbranch_scc1 cA_sc3_r1
  s_branch cA_abort
cA_sc3_r2:
  s_add_u32 s31, s31, 1
  buffer_load_dwordx4 v[16:19], v2, s[8:11], s20 offen offset:2048 sc1
  s_waitcnt vmcnt(0)
  v_cmp_eq_u32 vcc, -1, v16
  s_nop 4
  s_cbranch_vccz cA_sc3_c2
  s_add_u32 s30, s30, 1
  s_cmp_lt_u32 s30, 400000
  s_cbranch_scc1 cA_sc3_r2
  s_branch cA_abort
cA_sc3_r3:
  s_add_u32 s31, s31, 1
  buffer_load_dwordx4 v[20:23], v2, s[8:11], s20 offen offset:3072 sc1
  s_waitcnt vmcnt(0)
  v_cmp_eq_u32 vcc, -1, v20
  s_nop 4
  s_cbranch_vccz cA_sc3_c3
  s_add_u32 s30, s30, 1
  s_cmp_lt_u32 s30, 400000
  s_cbranch_scc1 cA_sc3_r3
  s_branch cA_abort
cA_sc3_r4:
  s_add_u32 s31, s31, 1
  buffer_load_dwordx4 v[24:27], v2, s[8:11], s23 offen offset:0 sc1
  buffer_load_dwordx4 v[28:31], v2, s[8:11], s23 offen offset:1024 sc1
  buffer_load_dwordx4 v[32:35], v2, s[8:11], s23 offen offset:2048 sc1
  s_waitcnt vmcnt(0)
  v_max3_u32 v66, v24, v27, v28
  v_max3_u32 v66, v66, v31, v32
  v_max_u32 v66, v66, v35
  v_cmp_eq_u32 vcc, -1, v66
  s_nop 4
  s_cbranch_vccz cA_sc3_c4
  s_add_u32 s30, s30, 1
  s_cmp_lt_u32 s30, 400000
  s_cbranch_scc1 cA_sc3_r4
  s_branch cA_abort
cA_sc3_retry:
  s_cmp_lg_u32 s62, 0
  s_cbranch_scc1 cA_sc3_cont
  s_waitcnt vmcnt(0) lgkmcnt(0)
cA_sc3_rv:
  buffer_load_dwordx4 v[8:11], v2, s[8:11], s20 offen offset:0 sc1
  buffer_load_dwordx4 v[12:15], v2, s[8:11], s20 offen offset:1024 sc1
  buffer_load_dwordx4 v[16:19], v2, s[8:11], s20 offen offset:2048 sc1
  buffer_load_dwordx4 v[20:23], v2, s[8:11], s20 offen offset:3072 sc1
  buffer_load_dwordx4 v[24:27], v2, s[8:11], s23 offen offset:0 sc1
  buffer_load_dwordx4 v[28:31], v2, s[8:11], s23 offen offset:1024 sc1
  buffer_load_dwordx4 v[32:35], v2, s[8:11], s23 offen offset:2048 sc1
  s_waitcnt vmcnt(0)
  v_pk_max_u16 v66, v8, v9
  v_pk_max_u16 v66, v66, v10
  v_pk_max_u16 v66, v66, v11
  v_pk_max_u16 v66, v66, v12
  v_pk_max_u16 v66, v66, v13
  v_pk_max_u16 v66, v66, v14
  v_pk_max_u16 v66, v66, v15
  v_pk_max_u16 v66, v66, v16
  v_pk_max_u16 v66, v66, v17
  v_pk_max_u16 v66, v66, v18
  v_pk_max_u16 v66, v66, v19
  v_pk_max_u16 v66, v66, v20
  v_pk_max_u16 v66, v66, v21
  v_pk_max_u16 v66, v66, v22
  v_pk_max_u16 v66, v66, v23
  v_pk_max_u16 v66, v66, v24
  v_pk_max_u16 v66, v66, v25
  v_pk_max_u16 v66, v66, v26
  v_pk_max_u16 v66, v66, v27
  v_pk_max_u16 v66, v66, v28
  v_pk_max_u16 v66, v66, v29
  v_pk_max_u16 v66, v66, v30
  v_pk_max_u16 v66, v66, v31
  v_pk_max_u16 v66, v66, v32
  v_pk_max_u16 v66, v66, v33
  v_pk_max_u16 v66, v66, v34
  v_pk_max_u16 v66, v66, v35
  v_lshlrev_b32 v67, 16, v66
  v_max_u32 v66, v66, v67
  v_cmp_le_u32 vcc, 0xffff0000, v66
  s_cbranch_vccz cA_sc3_rk
  s_add_u32 s30, s30, 1
  s_cmp_lt_u32 s30, 400000
  s_cbranch_scc1 cA_sc3_rv
  s_branch cA_abort
cA_sc3_rk:
  s_mov_b32 s62, 1
  v_mov_b32 v36, 0
  v_mov_b32 v37, 0
  v_mov_b32 v38, 0
  v_mov_b32 v39, 0
  v_mov_b32 v40, 0
  v_mov_b32 v41, 0
  v_mov_b32 v42, 0
  v_mov_b32 v43, 0
  v_mov_b32 v44, 0
  v_mov_b32 v45, 0
  v_mov_b32 v46, 0
  v_mov_b32 v47, 0
  v_mov_b32 v48, 0
  v_mov_b32 v49, 0
  v_mov_b32 v50, 0
  v_mov_b32 v51, 0
  v_mov_b32 v62, 0
  v_mov_b32 v63, 0
  v_mov_b32 v64, 0
  v_mov_b32 v65, 0
  v_mov_b32 v68, 0
  v_mov_b32 v69, 0
  v_mov_b32 v70, 0
  v_mov_b32 v71, 0
  v_mov_b32 v72, 0
  v_mov_b32 v73, 0
  v_mov_b32 v74, 0
  v_mov_b32 v75, 0
  v_mov_b32 v52, 0
  v_mov_b32 v53, 0
  v_mov_b32 v54, 0
  v_mov_b32 v55, 0
  v_mov_b32 v56, 0
  v_mov_b32 v57, 0
  v_mov_b32 v58, 0
  v_mov_b32 v59, 0
  s_add_u32 s31, s31, 0x100
  s_nop 0
  s_branch cA_sc3_go
.p2align 6
cA_va0_loop:
  s_mov_b32 s30, 0
  s_barrier
  buffer_load_dwordx4 v[24:27], v2, s[8:11], s23 offen offset:0 sc1
  buffer_load_dwordx4 v[28:31], v2, s[8:11], s23 offen offset:1024 sc1
  s_barrier
  buffer_store_dword v160, v1, s[8:11], s38 offen sc1
  s_add_u32 s22, s25, 0
  buffer_load_dwordx4 v[80:83], v6, s[8:11], s22 offen offset:0 sc1
  buffer_load_dwordx4 v[84:87], v6, s[8:11], s22 offen offset:1792 sc1
  s_add_u32 s22, s25, 3584
  buffer_load_dwordx4 v[88:91], v6, s[8:11], s22 offen offset:0 sc1
  buffer_load_dwordx4 v[92:95], v6, s[8:11], s22 offen offset:1792 sc1
  s_add_u32 s22, s25, 7168
  buffer_load_dwordx4 v[96:99], v6, s[8:11], s22 offen offset:0 sc1
  buffer_load_dwordx4 v[100:103], v6, s[8:11], s22 offen offset:1792 sc1
  s_add_u32 s22, s25, 10752
  buffer_load_dwordx4 v[104:107], v6, s[8:11], s22 offen offset:0 sc1
  buffer_load_dwordx4 v[108:111], v6, s[8:11], s22 offen offset:1792 sc1
  s_add_u32 s22, s25, 14336
  buffer_load_dwordx4 v[112:115], v6, s[8:11], s22 offen offset:0 sc1
  buffer_load_dwordx4 v[116:119], v6, s[8:11], s22 offen offset:1792 sc1
  s_add_u32 s22, s25, 17920
  buffer_load_dwordx4 v[120:123], v6, s[8:11], s22 offen offset:0 sc1
  buffer_load_dwordx4 v[124:127], v6, s[8:11], s22 offen offset:1792 sc1
  s_add_u32 s22, s25, 21504
  buffer_load_dwordx4 v[128:131], v6, s[8:11], s22 offen offset:0 sc1
  buffer_load_dwordx4 v[132:135], v6, s[8:11], s22 offen offset:1792 sc1
  s_add_u32 s22, s25, 25088
  buffer_load_dwordx4 v[136:139], v6, s[8:11], s22 offen offset:0 sc1
  buffer_load_dwordx4 v[140:143], v6, s[8:11], s22 offen offset:1792 sc1
  s_mul_i32 s38, s18, 7168
  s_add_u32 s38, s38, 87543808
  s_waitcnt vmcnt(17)
  ds_write_b128 v2, v[24:27] offset:12288
  ds_write_b128 v2, v[28:31] offset:13312
  v_smfmac_f32_16x16x64_bf16 v[36:39], v[24:27], a[32:39], v3
  v_smfmac_f32_16x16x64_bf16 v[40:43], v[24:27], a[88:95], v3
  v_smfmac_f32_16x16x64_bf16 v[44:47], v[24:27], a[144:151], v3
  v_smfmac_f32_16x16x64_bf16 v[48:51], v[24:27], a[200:207], v3
  v_smfmac_f32_16x16x64_bf16 v[52:55], v[24:27], v[176:183], v3
  s_waitcnt lgkmcnt(0)
  s_barrier
  ds_read_b128 v[8:11], v2 offset:8192
  ds_read_b128 v[12:15], v2 offset:9216
  ds_read_b128 v[16:19], v2 offset:10240
  ds_read_b128 v[20:23], v2 offset:11264
  ds_read_b128 v[32:35], v2 offset:14336
  v_smfmac_f32_16x16x64_bf16 v[56:59], v[24:27], v[232:239], v3
  v_smfmac_f32_16x16x64_bf16 v[36:39], v[28:31], a[40:47], v3
  v_smfmac_f32_16x16x64_bf16 v[40:43], v[28:31], a[96:103], v3
  v_smfmac_f32_16x16x64_bf16 v[44:47], v[28:31], a[152:159], v3
  v_smfmac_f32_16x16x64_bf16 v[48:51], v[28:31], a[208:215], v3
  v_smfmac_f32_16x16x64_bf16 v[52:55], v[28:31], v[184:191], v3
  ds_read_b128 v[64:67], v0 offset:0
  ds_read_b128 v[68:71], v0 offset:1024
  v_smfmac_f32_16x16x64_bf16 v[56:59], v[28:31], v[240:247], v3
  s_waitcnt lgkmcnt(6)
  ds_read_b128 v[72:75], v0 offset:2048
  ds_read_b128 v[76:79], v0 offset:3072
  v_smfmac_f32_16x16x64_bf16 v[36:39], v[8:11], a[0:7], v3
  s_waitcnt lgkmcnt(7)
  v_smfmac_f32_16x16x64_bf16 v[36:39], v[12:15], a[8:15], v3
  s_waitcnt lgkmcnt(6)
  v_smfmac_f32_16x16x64_bf16 v[36:39], v[16:19], a[16:23], v3
  s_waitcnt lgkmcnt(2)
  v_smfmac_f32_16x16x64_bf16 v[60:63], v[8:11], v[64:71], v3
  s_waitcnt lgkmcnt(5)
  ds_read_b128 v[144:147], v0 offset:4096
  ds_read_b128 v[148:151], v0 offset:5120
  v_smfmac_f32_16x16x64_bf16 v[36:39], v[20:23], a[24:31], v3
  s_waitcnt lgkmcnt(6)
  v_smfmac_f32_16x16x64_bf16 v[36:39], v[32:35], a[48:55], v3
  v_smfmac_f32_16x16x64_bf16 v[40:43], v[8:11], a[56:63], v3
  s_waitcnt lgkmcnt(2)
  v_smfmac_f32_16x16x64_bf16 v[60:63], v[12:15], v[72:79], v3
  ds_read_b128 v[64:67], v0 offset:6144
  ds_read_b128 v[68:71], v0 offset:7168
  v_smfmac_f32_16x16x64_bf16 v[40:43], v[12:15], a[64:71], v3
  v_permlane32_swap_b32 v36, v38
  v_smfmac_f32_16x16x64_bf16 v[40:43], v[16:19], a[72:79], v3
  v_permlane32_swap_b32 v37, v39
  v_smfmac_f32_16x16x64_bf16 v[40:43], v[20:23], a[80:87], v3
  s_waitcnt lgkmcnt(2)
  v_add_f32 v36, v36, v38
  v_smfmac_f32_16x16x64_bf16 v[60:63], v[16:19], v[144:151], v3
  ds_read_b128 v[72:75], v0 offset:8192
  ds_read_b128 v[76:79], v0 offset:9216
  v_add_f32 v37, v37, v39
  v_smfmac_f32_16x16x64_bf16 v[40:43], v[32:35], a[104:111], v3
  v_cmp_u_f32 vcc, v36, v37
  v_smfmac_f32_16x16x64_bf16 v[44:47], v[8:11], a[112:119], v3
  v_cvt_pk_bf16_f32 v38, v36, v37
  v_smfmac_f32_16x16x64_bf16 v[44:47], v[12:15], a[120:127], v3
  ds_write_b32 v152, v38
  s_waitcnt lgkmcnt(3)
  s_cbranch_vccnz cA_va0_slow
  v_permlane32_swap_b32 v40, v42
  v_smfmac_f32_16x16x64_bf16 v[60:63], v[20:23], v[64:71], v3
  ds_read_b128 v[144:147], v0 offset:10240
  ds_read_b128 v[148:151], v0 offset:11264
  v_permlane32_swap_b32 v41, v43
  v_smfmac_f32_16x16x64_bf16 v[44:47], v[16:19], a[128:135], v3
  buffer_store_dword v162, v1, s[8:11], s21 offen
  v_add_f32 v40, v40, v42
  v_smfmac_f32_16x16x64_bf16 v[44:47], v[20:23], a[136:143], v3
  v_add_f32 v41, v41, v43
  v_smfmac_f32_16x16x64_bf16 v[44:47], v[32:35], a[160:167], v3
  s_waitcnt lgkmcnt(3)
  v_cvt_pk_bf16_f32 v42, v40, v41
  v_smfmac_f32_16x16x64_bf16 v[60:63], v[24:27], v[72:79], v3
  ds_write_b32 v153, v42
  ds_read_b128 v[64:67], v0 offset:12288
  ds_read_b128 v[68:71], v0 offset:13312
  v_smfmac_f32_16x16x64_bf16 v[48:51], v[8:11], a[168:175], v3
  s_nop 0
  v_permlane32_swap_b32 v44, v46
  v_smfmac_f32_16x16x64_bf16 v[48:51], v[12:15], a[176:183], v3
  v_permlane32_swap_b32 v45, v47
  v_smfmac_f32_16x16x64_bf16 v[48:51], v[16:19], a[184:191], v3
  s_waitcnt lgkmcnt(3)
  v_add_f32 v44, v44, v46
  v_smfmac_f32_16x16x64_bf16 v[60:63], v[28:31], v[144:151], v3
  v_add_f32 v45, v45, v47
  v_smfmac_f32_16x16x64_bf16 v[48:51], v[20:23], a[192:199], v3
  v_cvt_pk_bf16_f32 v46, v44, v45
  v_smfmac_f32_16x16x64_bf16 v[48:51], v[32:35], a[216:223], v3
  ds_write_b32 v154, v46
  v_smfmac_f32_16x16x64_bf16 v[52:55], v[8:11], a[224:231], v3
  s_waitcnt lgkmcnt(1)
  v_smfmac_f32_16x16x64_bf16 v[60:63], v[32:35], v[64:71], v3
  v_smfmac_f32_16x16x64_bf16 v[52:55], v[12:15], a[232:239], v3
  v_permlane32_swap_b32 v48, v50
  v_smfmac_f32_16x16x64_bf16 v[52:55], v[16:19], a[240:247], v3
  v_permlane32_swap_b32 v49, v51
  v_smfmac_f32_16x16x64_bf16 v[52:55], v[20:23], a[248:255], v3
  v_add_f32 v48, v48, v50
  v_smfmac_f32_16x16x64_bf16 v[52:55], v[32:35], v[192:199], v3
  v_add_f32 v49, v49, v51
  v_smfmac_f32_16x16x64_bf16 v[56:59], v[8:11], v[200:207], v3
  v_cvt_pk_bf16_f32 v50, v48, v49
  v_smfmac_f32_16x16x64_bf16 v[56:59], v[12:15], v[208:215], v3
  ds_write_b32 v155, v50
  v_permlane32_swap_b32 v60, v62
  v_smfmac_f32_16x16x64_bf16 v[56:59], v[16:19], v[216:223], v3
  v_permlane32_swap_b32 v61, v63
  v_smfmac_f32_16x16x64_bf16 v[56:59], v[20:23], v[224:231], v3
  v_add_f32 v60, v60, v62
  v_smfmac_f32_16x16x64_bf16 v[56:59], v[32:35], v[248:255], v3
  v_add_f32 v61, v61, v63
  v_cvt_pk_bf16_f32 v62, v60, v61
  ds_write_b32 v158, v62
  v_permlane32_swap_b32 v52, v54
  v_permlane32_swap_b32 v53, v55
  v_add_f32 v52, v52, v54
  v_add_f32 v53, v53, v55
  v_cvt_pk_bf16_f32 v54, v52, v53
  ds_write_b32 v156, v54
  v_permlane32_swap_b32 v56, v58
  v_permlane32_swap_b32 v57, v59
  v_add_f32 v56, v56, v58
  v_add_f32 v57, v57, v59
  v_cvt_pk_bf16_f32 v58, v56, v57
  ds_write_b32 v157, v58
cA_va0_t2d:
  s_add_u32 s22, s20, 9216
  s_add_u32 s34, s20, 13312
  s_add_u32 s36, s20, 7168
  s_mov_b32 s37, 0
  v_mov_b32 v48, 0
  v_mov_b32 v49, 0
  v_mov_b32 v50, 0
  v_mov_b32 v51, 0
  v_mov_b32 v163, s18
  s_waitcnt lgkmcnt(0)
  s_setprio 3
  buffer_load_dword v52, v4, s[8:11], 0 offen sc1
  buffer_load_dword v53, v4, s[8:11], 0 offen sc1
  buffer_load_dword v54, v4, s[8:11], 0 offen sc1
cA_va0_fw_l:
  s_waitcnt vmcnt(2)
  v_cmp_gt_u32 vcc, s18, v52
  s_cbranch_vccz cA_va0_fw_d
  buffer_load_dword v52, v4, s[8:11], 0 offen sc1
  s_waitcnt vmcnt(2)
  v_cmp_gt_u32 vcc, s18, v53
  s_cbranch_vccz cA_va0_fw_d
  buffer_load_dword v53, v4, s[8:11], 0 offen sc1
  s_waitcnt vmcnt(2)
  v_cmp_gt_u32 vcc, s18, v54
  s_cbranch_vccz cA_va0_fw_d
  buffer_load_dword v54, v4, s[8:11], 0 offen sc1
  s_add_u32 s30, s30, 1
  s_cmp_lt_u32 s30, 400000
  s_cbranch_scc1 cA_va0_fw_l
  s_branch cA_abort
cA_va0_fw_d:
  buffer_load_dwordx4 v[8:11], v2, s[8:11], s22 offen offset:0 sc1
  buffer_load_dwordx4 v[12:15], v2, s[8:11], s22 offen offset:1024 sc1
  buffer_load_dwordx4 v[16:19], v2, s[8:11], s22 offen offset:2048 sc1
  buffer_load_dwordx4 v[20:23], v2, s[8:11], s22 offen offset:3072 sc1
  buffer_load_dwordx4 v[24:27], v2, s[8:11], s34 offen offset:0 sc1
  buffer_load_dwordx4 v[28:31], v2, s[8:11], s34 offen offset:1024 sc1
  buffer_load_dwordx4 v[32:35], v2, s[8:11], s34 offen offset:2048 sc1
  buffer_load_dwordx4 v[36:39], v2, s[8:11], s34 offen offset:3072 sc1
  buffer_load_dwordx4 v[40:43], v2, s[8:11], s36 offen offset:0 sc1
  buffer_load_dwordx4 v[44:47], v2, s[8:11], s36 offen offset:1024 sc1
  s_barrier
  ds_read_b128 v[64:67], v2 offset:0
  ds_read_b128 v[68:71], v2 offset:1024
  ds_read_b128 v[72:75], v2 offset:2048
  ds_read_b128 v[76:79], v2 offset:3072
cA_va0_lp:
  s_waitcnt vmcnt(9)
  v_smfmac_f32_16x16x64_bf16 v[48:51], v[8:11], v[80:87], v3
  s_waitcnt vmcnt(8)
  v_smfmac_f32_16x16x64_bf16 v[48:51], v[12:15], v[88:95], v3
  s_waitcnt vmcnt(7)
  v_smfmac_f32_16x16x64_bf16 v[48:51], v[16:19], v[96:103], v3
  s_waitcnt vmcnt(6)
  v_smfmac_f32_16x16x64_bf16 v[48:51], v[20:23], v[104:111], v3
  s_waitcnt vmcnt(5)
  v_smfmac_f32_16x16x64_bf16 v[48:51], v[24:27], v[112:119], v3
  s_waitcnt vmcnt(4)
  v_smfmac_f32_16x16x64_bf16 v[48:51], v[28:31], v[120:127], v3
  s_waitcnt vmcnt(3)
  v_smfmac_f32_16x16x64_bf16 v[48:51], v[32:35], v[128:135], v3
  s_waitcnt vmcnt(2)
  v_smfmac_f32_16x16x64_bf16 v[48:51], v[36:39], v[136:143], v3
  s_waitcnt vmcnt(1) lgkmcnt(0)
  v_smfmac_f32_16x16x64_bf16 v[48:51], v[40:43], v[64:71], v3
  s_waitcnt vmcnt(0)
  v_smfmac_f32_16x16x64_bf16 v[48:51], v[44:47], v[72:79], v3
  s_nop 7
  v_permlane32_swap_b32 v48, v50
  v_permlane32_swap_b32 v49, v51
  v_add_f32 v48, v48, v50
  v_add_f32 v49, v49, v51
  v_cvt_pk_bf16_f32 v160, v48, v49
  v_cmp_u_f32 vcc, v48, v49
  s_nop 0
  v_mov_b32_dpp v161, v160 quad_perm:[1,0,3,2] row_mask:0xf bank_mask:0xf
  v_perm_b32 v160, v161, v160, v5
  v_min_u32 v160, -2, v160
  s_cbranch_vccnz cA_va0_rp
cA_va0_cont:
  buffer_store_dword v160, v1, s[8:11], s21 offen
  s_setprio 0
  s_cmp_lg_u32 s19, 62
  s_cbranch_scc1 cA_va0_nl
  buffer_store_dword v160, v1, s[8:11], s38 offen sc1
  s_branch cA_done
cA_va0_nl:
  s_add_u32 s25, s25, 28672
  v_mov_b32 v36, 0
  v_mov_b32 v37, 0
  v_mov_b32 v38, 0
  v_mov_b32 v39, 0
  v_mov_b32 v40, 0
  v_mov_b32 v41, 0
  v_mov_b32 v42, 0
  v_mov_b32 v43, 0
  v_mov_b32 v44, 0
  v_mov_b32 v45, 0
  v_mov_b32 v46, 0
  v_mov_b32 v47, 0
  v_mov_b32 v48, 0
  v_mov_b32 v49, 0
  v_mov_b32 v50, 0
  v_mov_b32 v51, 0
  v_mov_b32 v52, 0
  v_mov_b32 v53, 0
  v_mov_b32 v54, 0
  v_mov_b32 v55, 0
  v_mov_b32 v56, 0
  v_mov_b32 v57, 0
  v_mov_b32 v58, 0
  v_mov_b32 v59, 0
  v_mov_b32 v60, 0
  v_mov_b32 v61, 0
  v_mov_b32 v62, 0
  v_mov_b32 v63, 0
  s_mov_b32 s19, s18
  s_add_u32 s18, s18, 1
  s_mov_b32 s22, s20
  s_mov_b32 s20, s21
  s_mov_b32 s21, s22
  s_add_u32 s23, s20, 4096
  s_branch cA_va0_loop
cA_va0_slow:
  s_waitcnt lgkmcnt(0)
cA_va0_sl1:
  s_add_u32 s31, s31, 0x1000000
  buffer_load_dwordx4 v[8:11], v2, s[8:11], s20 offen offset:0 sc1
  buffer_load_dwordx4 v[12:15], v2, s[8:11], s20 offen offset:1024 sc1
  buffer_load_dwordx4 v[16:19], v2, s[8:11], s20 offen offset:2048 sc1
  buffer_load_dwordx4 v[20:23], v2, s[8:11], s20 offen offset:3072 sc1
  buffer_load_dwordx4 v[24:27], v2, s[8:11], s23 offen offset:0 sc1
  buffer_load_dwordx4 v[28:31], v2, s[8:11], s23 offen offset:1024 sc1
  buffer_load_dwordx4 v[32:35], v2, s[8:11], s23 offen offset:2048 sc1
  s_waitcnt vmcnt(0)
  v_max3_u32 v36, v8, v9, v10
  v_max3_u32 v36, v36, v11, v12
  v_max3_u32 v36, v36, v13, v14
  v_max3_u32 v36, v36, v15, v16
  v_max3_u32 v36, v36, v17, v18
  v_max3_u32 v36, v36, v19, v20
  v_max3_u32 v36, v36, v21, v22
  v_max3_u32 v36, v36, v23, v24
  v_max3_u32 v36, v36, v25, v26
  v_max3_u32 v36, v36, v27, v28
  v_max3_u32 v36, v36, v29, v30
  v_max3_u32 v36, v36, v31, v32
  v_max3_u32 v36, v36, v33, v34
  v_max_u32 v36, v36, v35
  v_cmp_eq_u32 vcc, -1, v36
  s_cbranch_vccz cA_va0_sl2
  s_add_u32 s30, s30, 1
  s_cmp_lt_u32 s30, 400000
  s_cbranch_scc1 cA_va0_sl1
  s_branch cA_abort
cA_va0_sl2:
  v_mov_b32 v36, 0
  v_mov_b32 v37, 0
  v_mov_b32 v38, 0
  v_mov_b32 v39, 0
  v_mov_b32 v40, 0
  v_mov_b32 v41, 0
  v_mov_b32 v42, 0
  v_mov_b32 v43, 0
  v_mov_b32 v44, 0
  v_mov_b32 v45, 0
  v_mov_b32 v46, 0
  v_mov_b32 v47, 0
  v_mov_b32 v48, 0
  v_mov_b32 v49, 0
  v_mov_b32 v50, 0
  v_mov_b32 v51, 0
  v_mov_b32 v52, 0
  v_mov_b32 v53, 0
  v_mov_b32 v54, 0
  v_mov_b32 v55, 0
  v_mov_b32 v56, 0
  v_mov_b32 v57, 0
  v_mov_b32 v58, 0
  v_mov_b32 v59, 0
  v_mov_b32 v60, 0
  v_mov_b32 v61, 0
  v_mov_b32 v62, 0
  v_mov_b32 v63, 0
  buffer_store_dword v162, v1, s[8:11], s21 offen
  ds_read_b128 v[64:67], v0 offset:0
  ds_read_b128 v[68:71], v0 offset:1024
  v_smfmac_f32_16x16x64_bf16 v[36:39], v[8:11], a[0:7], v3
  v_smfmac_f32_16x16x64_bf16 v[40:43], v[8:11], a[56:63], v3
  v_smfmac_f32_16x16x64_bf16 v[44:47], v[8:11], a[112:119], v3
  v_smfmac_f32_16x16x64_bf16 v[48:51], v[8:11], a[168:175], v3
  v_smfmac_f32_16x16x64_bf16 v[52:55], v[8:11], a[224:231], v3
  v_smfmac_f32_16x16x64_bf16 v[56:59], v[8:11], v[200:207], v3
  s_waitcnt lgkmcnt(0)
  v_smfmac_f32_16x16x64_bf16 v[60:63], v[8:11], v[64:71], v3
  ds_read_b128 v[72:75], v0 offset:2048
  ds_read_b128 v[76:79], v0 offset:3072
  v_smfmac_f32_16x16x64_bf16 v[36:39], v[12:15], a[8:15], v3
  v_smfmac_f32_16x16x64_bf16 v[40:43], v[12:15], a[64:71], v3
  v_smfmac_f32_16x16x64_bf16 v[44:47], v[12:15], a[120:127], v3
  v_smfmac_f32_16x16x64_bf16 v[48:51], v[12:15], a[176:183], v3
  v_smfmac_f32_16x16x64_bf16 v[52:55], v[12:15], a[232:239], v3
  v_smfmac_f32_16x16x64_bf16 v[56:59], v[12:15], v[208:215], v3
  s_waitcnt lgkmcnt(0)
  v_smfmac_f32_16x16x64_bf16 v[60:63], v[12:15], v[72:79], v3
  ds_read_b128 v[144:147], v0 offset:4096
  ds_read_b128 v[148:151], v0 offset:5120
  v_smfmac_f32_16x16x64_bf16 v[36:39], v[16:19], a[16:23], v3
  v_smfmac_f32_16x16x64_bf16 v[40:43], v[16:19], a[72:79], v3
  v_smfmac_f32_16x16x64_bf16 v[44:47], v[16:19], a[128:135], v3
  v_smfmac_f32_16x16x64_bf16 v[48:51], v[16:19], a[184:191], v3
  v_smfmac_f32_16x16x64_bf16 v[52:55], v[16:19], a[240:247], v3
  v_smfmac_f32_16x16x64_bf16 v[56:59], v[16:19], v[216:223], v3
  s_waitcnt lgkmcnt(0)
  v_smfmac_f32_16x16x64_bf16 v[60:63], v[16:19], v[144:151], v3
  ds_read_b128 v[64:67], v0 offset:6144
  ds_read_b128 v[68:71], v0 offset:7168
  v_smfmac_f32_16x16x64_bf16 v[36:39], v[20:23], a[24:31], v3
  v_smfmac_f32_16x16x64_bf16 v[40:43], v[20:23], a[80:87], v3
  v_smfmac_f32_16x16x64_bf16 v[44:47], v[20:23], a[136:143], v3
  v_smfmac_f32_16x16x64_bf16 v[48:51], v[20:23], a[192:199], v3
  v_smfmac_f32_16x16x64_bf16 v[52:55], v[20:23], a[248:255], v3
  v_smfmac_f32_16x16x64_bf16 v[56:59], v[20:23], v[224:231], v3
  s_waitcnt lgkmcnt(0)
  v_smfmac_f32_16x16x64_bf16 v[60:63], v[20:23], v[64:71], v3
  ds_read_b128 v[72:75], v0 offset:8192
  ds_read_b128 v[76:79], v0 offset:9216
  v_smfmac_f32_16x16x64_bf16 v[36:39], v[24:27], a[32:39], v3
  v_smfmac_f32_16x16x64_bf16 v[40:43], v[24:27], a[88:95], v3
  v_smfmac_f32_16x16x64_bf16 v[44:47], v[24:27], a[144:151], v3
  v_smfmac_f32_16x16x64_bf16 v[48:51], v[24:27], a[200:207], v3
  v_smfmac_f32_16x16x64_bf16 v[52:55], v[24:27], v[176:183], v3
  v_smfmac_f32_16x16x64_bf16 v[56:59], v[24:27], v[232:239], v3
  s_waitcnt lgkmcnt(0)
  v_smfmac_f32_16x16x64_bf16 v[60:63], v[24:27], v[72:79], v3
  ds_read_b128 v[144:147], v0 offset:10240
  ds_read_b128 v[148:151], v0 offset:11264
  v_smfmac_f32_16x16x64_bf16 v[36:39], v[28:31], a[40:47], v3
  v_smfmac_f32_16x16x64_bf16 v[40:43], v[28:31], a[96:103], v3
  v_smfmac_f32_16x16x64_bf16 v[44:47], v[28:31], a[152:159], v3
  v_smfmac_f32_16x16x64_bf16 v[48:51], v[28:31], a[208:215], v3
  v_smfmac_f32_16x16x64_bf16 v[52:55], v[28:31], v[184:191], v3
  v_smfmac_f32_16x16x64_bf16 v[56:59], v[28:31], v[240:247], v3
  s_waitcnt lgkmcnt(0)
  v_smfmac_f32_16x16x64_bf16 v[60:63], v[28:31], v[144:151], v3
  ds_read_b128 v[64:67], v0 offset:12288
  ds_read_b128 v[68:71], v0 offset:13312
  v_smfmac_f32_16x16x64_bf16 v[36:39], v[32:35], a[48:55], v3
  v_smfmac_f32_16x16x64_bf16 v[40:43], v[32:35], a[104:111], v3
  v_smfmac_f32_16x16x64_bf16 v[44:47], v[32:35], a[160:167], v3
  v_smfmac_f32_16x16x64_bf16 v[48:51], v[32:35], a[216:223], v3
  v_smfmac_f32_16x16x64_bf16 v[52:55], v[32:35], v[192:199], v3
  v_smfmac_f32_16x16x64_bf16 v[56:59], v[32:35], v[248:255], v3
  s_waitcnt lgkmcnt(0)
  v_smfmac_f32_16x16x64_bf16 v[60:63], v[32:35], v[64:71], v3
  v_permlane32_swap_b32 v36, v38
  v_permlane32_swap_b32 v37, v39
  v_add_f32 v36, v36, v38
  v_add_f32 v37, v37, v39
  v_cvt_pk_bf16_f32 v38, v36, v37
  ds_write_b32 v152, v38
  v_permlane32_swap_b32 v40, v42
  v_permlane32_swap_b32 v41, v43
  v_add_f32 v40, v40, v42
  v_add_f32 v41, v41, v43
  v_cvt_pk_bf16_f32 v42, v40, v41
  ds_write_b32 v153, v42
  v_permlane32_swap_b32 v44, v46
  v_permlane32_swap_b32 v45, v47
  v_add_f32 v44, v44, v46
  v_add_f32 v45, v45, v47
  v_cvt_pk_bf16_f32 v46, v44, v45
  ds_write_b32 v154, v46
  v_permlane32_swap_b32 v48, v50
  v_permlane32_swap_b32 v49, v51
  v_add_f32 v48, v48, v50
  v_add_f32 v49, v49, v51
  v_cvt_pk_bf16_f32 v50, v48, v49
  ds_write_b32 v155, v50
  v_permlane32_swap_b32 v52, v54
  v_permlane32_swap_b32 v53, v55
  v_add_f32 v52, v52, v54
  v_add_f32 v53, v53, v55
  v_cvt_pk_bf16_f32 v54, v52, v53
  ds_write_b32 v156, v54
  v_permlane32_swap_b32 v56, v58
  v_permlane32_swap_b32 v57, v59
  v_add_f32 v56, v56, v58
  v_add_f32 v57, v57, v59
  v_cvt_pk_bf16_f32 v58, v56, v57
  ds_write_b32 v157, v58
  v_permlane32_swap_b32 v60, v62
  v_permlane32_swap_b32 v61, v63
  v_add_f32 v60, v60, v62
  v_add_f32 v61, v61, v63
  v_cvt_pk_bf16_f32 v62, v60, v61
  ds_write_b32 v158, v62
  s_branch cA_va0_t2d
cA_va0_rp:
  s_cmp_lg_u32 s37, 0
  s_cbranch_scc1 cA_va0_cont
cA_va0_rv:
  s_add_u32 s31, s31, 0x10000
  buffer_load_dwordx4 v[8:11], v2, s[8:11], s22 offen offset:0 sc1
  buffer_load_dwordx4 v[12:15], v2, s[8:11], s22 offen offset:1024 sc1
  buffer_load_dwordx4 v[16:19], v2, s[8:11], s22 offen offset:2048 sc1
  buffer_load_dwordx4 v[20:23], v2, s[8:11], s22 offen offset:3072 sc1
  buffer_load_dwordx4 v[24:27], v2, s[8:11], s34 offen offset:0 sc1
  buffer_load_dwordx4 v[28:31], v2, s[8:11], s34 offen offset:1024 sc1
  buffer_load_dwordx4 v[32:35], v2, s[8:11], s34 offen offset:2048 sc1
  buffer_load_dwordx4 v[36:39], v2, s[8:11], s34 offen offset:3072 sc1
  buffer_load_dwordx4 v[40:43], v2, s[8:11], s36 offen offset:0 sc1
  buffer_load_dwordx4 v[44:47], v2, s[8:11], s36 offen offset:1024 sc1
  s_waitcnt vmcnt(0)
  v_max3_u32 v52, v8, v9, v10
  v_max3_u32 v52, v52, v11, v12
  v_max3_u32 v52, v52, v13, v14
  v_max3_u32 v52, v52, v15, v16
  v_max3_u32 v52, v52, v17, v18
  v_max3_u32 v52, v52, v19, v20
  v_max3_u32 v52, v52, v21, v22
  v_max3_u32 v52, v52, v23, v24
  v_max3_u32 v52, v52, v25, v26
  v_max3_u32 v52, v52, v27, v28
  v_max3_u32 v52, v52, v29, v30
  v_max3_u32 v52, v52, v31, v32
  v_max3_u32 v52, v52, v33, v34
  v_max3_u32 v52, v52, v35, v36
  v_max3_u32 v52, v52, v37, v38
  v_max3_u32 v52, v52, v39, v40
  v_max3_u32 v52, v52, v41, v42
  v_max3_u32 v52, v52, v43, v44
  v_max3_u32 v52, v52, v45, v46
  v_max_u32 v52, v52, v47
  v_cmp_eq_u32 vcc, -1, v52
  s_mov_b32 s37, 1
  v_mov_b32 v48, 0
  v_mov_b32 v49, 0
  v_mov_b32 v50, 0
  v_mov_b32 v51, 0
  s_nop 1
  s_cbranch_vccz cA_va0_lp
  s_add_u32 s30, s30, 1
  s_cmp_lt_u32 s30, 400000
  s_cbranch_scc1 cA_va0_rv
  s_branch cA_abort
.p2align 6
cA_va1_loop:
  s_mov_b32 s30, 0
  s_barrier
  buffer_load_dwordx4 v[28:31], v2, s[8:11], s23 offen offset:1024 sc1
  buffer_load_dwordx4 v[32:35], v2, s[8:11], s23 offen offset:2048 sc1
  s_barrier
  buffer_store_dword v160, v1, s[8:11], s38 offen sc1
  s_add_u32 s22, s25, 0
  buffer_load_dwordx4 v[80:83], v6, s[8:11], s22 offen offset:0 sc1
  buffer_load_dwordx4 v[84:87], v6, s[8:11], s22 offen offset:1792 sc1
  s_add_u32 s22, s25, 3584
  buffer_load_dwordx4 v[88:91], v6, s[8:11], s22 offen offset:0 sc1
  buffer_load_dwordx4 v[92:95], v6, s[8:11], s22 offen offset:1792 sc1
  s_add_u32 s22, s25, 7168
  buffer_load_dwordx4 v[96:99], v6, s[8:11], s22 offen offset:0 sc1
  buffer_load_dwordx4 v[100:103], v6, s[8:11], s22 offen offset:1792 sc1
  s_add_u32 s22, s25, 10752
  buffer_load_dwordx4 v[104:107], v6, s[8:11], s22 offen offset:0 sc1
  buffer_load_dwordx4 v[108:111], v6, s[8:11], s22 offen offset:1792 sc1
  s_add_u32 s22, s25, 14336
  buffer_load_dwordx4 v[112:115], v6, s[8:11], s22 offen offset:0 sc1
  buffer_load_dwordx4 v[116:119], v6, s[8:11], s22 offen offset:1792 sc1
  s_add_u32 s22, s25, 17920
  buffer_load_dwordx4 v[120:123], v6, s[8:11], s22 offen offset:0 sc1
  buffer_load_dwordx4 v[124:127], v6, s[8:11], s22 offen offset:1792 sc1
  s_add_u32 s22, s25, 21504
  buffer_load_dwordx4 v[128:131], v6, s[8:11], s22 offen offset:0 sc1
  buffer_load_dwordx4 v[132:135], v6, s[8:11], s22 offen offset:1792 sc1
  s_add_u32 s22, s25, 25088
  buffer_load_dwordx4 v[136:139], v6, s[8:11], s22 offen offset:0 sc1
  buffer_load_dwordx4 v[140:143], v6, s[8:11], s22 offen offset:1792 sc1
  s_mul_i32 s38, s18, 7168
  s_add_u32 s38, s38, 87543808
  s_waitcnt vmcnt(17)
  ds_write_b128 v2, v[32:35] offset:14336
  v_smfmac_f32_16x16x64_bf16 v[36:39], v[28:31], a[40:47], v3
  v_smfmac_f32_16x16x64_bf16 v[40:43], v[28:31], a[96:103], v3
  v_smfmac_f32_16x16x64_bf16 v[44:47], v[28:31], a[152:159], v3
  v_smfmac_f32_16x16x64_bf16 v[48:51], v[28:31], a[208:215], v3
  v_smfmac_f32_16x16x64_bf16 v[52:55], v[28:31], v[184:191], v3
  s_waitcnt lgkmcnt(0)
  s_barrier
  ds_read_b128 v[8:11], v2 offset:8192
  ds_read_b128 v[12:15], v2 offset:9216
  ds_read_b128 v[16:19], v2 offset:10240
  ds_read_b128 v[20:23], v2 offset:11264
  ds_read_b128 v[24:27], v2 offset:12288
  v_smfmac_f32_16x16x64_bf16 v[56:59], v[28:31], v[240:247], v3
  v_smfmac_f32_16x16x64_bf16 v[36:39], v[32:35], a[48:55], v3
  v_smfmac_f32_16x16x64_bf16 v[40:43], v[32:35], a[104:111], v3
  v_smfmac_f32_16x16x64_bf16 v[44:47], v[32:35], a[160:167], v3
  v_smfmac_f32_16x16x64_bf16 v[48:51], v[32:35], a[216:223], v3
  v_smfmac_f32_16x16x64_bf16 v[52:55], v[32:35], v[192:199], v3
  ds_read_b128 v[64:67], v0 offset:0
  ds_read_b128 v[68:71], v0 offset:1024
  v_smfmac_f32_16x16x64_bf16 v[56:59], v[32:35], v[248:255], v3
  s_waitcnt lgkmcnt(6)
  ds_read_b128 v[72:75], v0 offset:2048
  ds_read_b128 v[76:79], v0 offset:3072
  v_smfmac_f32_16x16x64_bf16 v[36:39], v[8:11], a[0:7], v3
  s_waitcnt lgkmcnt(7)
  v_smfmac_f32_16x16x64_bf16 v[36:39], v[12:15], a[8:15], v3
  s_waitcnt lgkmcnt(6)
  v_smfmac_f32_16x16x64_bf16 v[36:39], v[16:19], a[16:23], v3
  s_waitcnt lgkmcnt(2)
  v_smfmac_f32_16x16x64_bf16 v[60:63], v[8:11], v[64:71], v3
  s_waitcnt lgkmcnt(5)
  ds_read_b128 v[144:147], v0 offset:4096
  ds_read_b128 v[148:151], v0 offset:5120
  v_smfmac_f32_16x16x64_bf16 v[36:39], v[20:23], a[24:31], v3
  s_waitcnt lgkmcnt(6)
  v_smfmac_f32_16x16x64_bf16 v[36:39], v[24:27], a[32:39], v3
  v_smfmac_f32_16x16x64_bf16 v[40:43], v[8:11], a[56:63], v3
  s_waitcnt lgkmcnt(2)
  v_smfmac_f32_16x16x64_bf16 v[60:63], v[12:15], v[72:79], v3
  ds_read_b128 v[64:67], v0 offset:6144
  ds_read_b128 v[68:71], v0 offset:7168
  v_smfmac_f32_16x16x64_bf16 v[40:43], v[12:15], a[64:71], v3
  v_permlane32_swap_b32 v36, v38
  v_smfmac_f32_16x16x64_bf16 v[40:43], v[16:19], a[72:79], v3
  v_permlane32_swap_b32 v37, v39
  v_smfmac_f32_16x16x64_bf16 v[40:43], v[20:23], a[80:87], v3
  s_waitcnt lgkmcnt(2)
  v_add_f32 v36, v36, v38
  v_smfmac_f32_16x16x64_bf16 v[60:63], v[16:19], v[144:151], v3
  ds_read_b128 v[72:75], v0 offset:8192
  ds_read_b128 v[76:79], v0 offset:9216
  v_add_f32 v37, v37, v39
  v_smfmac_f32_16x16x64_bf16 v[40:43], v[24:27], a[88:95], v3
  v_cmp_u_f32 vcc, v36, v37
  v_smfmac_f32_16x16x64_bf16 v[44:47], v[8:11], a[112:119], v3
  v_cvt_pk_bf16_f32 v38, v36, v37
  v_smfmac_f32_16x16x64_bf16 v[44:47], v[12:15], a[120:127], v3
  ds_write_b32 v152, v38
  s_waitcnt lgkmcnt(3)
  s_cbranch_vccnz cA_va1_slow
  v_permlane32_swap_b32 v40, v42
  v_smfmac_f32_16x16x64_bf16 v[60:63], v[20:23], v[64:71], v3
  ds_read_b128 v[144:147], v0 offset:10240
  ds_read_b128 v[148:151], v0 offset:11264
  v_permlane32_swap_b32 v41, v43
  v_smfmac_f32_16x16x64_bf16 v[44:47], v[16:19], a[128:135], v3
  buffer_store_dword v162, v1, s[8:11], s21 offen
  v_add_f32 v40, v40, v42
  v_smfmac_f32_16x16x64_bf16 v[44:47], v[20:23], a[136:143], v3
  v_add_f32 v41, v41, v43
  v_smfmac_f32_16x16x64_bf16 v[44:47], v[24:27], a[144:151], v3
  s_waitcnt lgkmcnt(3)
  v_cvt_pk_bf16_f32 v42, v40, v41
  v_smfmac_f32_16x16x64_bf16 v[60:63], v[24:27], v[72:79], v3
  ds_write_b32 v153, v42
  ds_read_b128 v[64:67], v0 offset:12288
  ds_read_b128 v[68:71], v0 offset:13312
  v_smfmac_f32_16x16x64_bf16 v[48:51], v[8:11], a[168:175], v3
  s_nop 0
  v_permlane32_swap_b32 v44, v46
  v_smfmac_f32_16x16x64_bf16 v[48:51], v[12:15], a[176:183], v3
  v_permlane32_swap_b32 v45, v47
  v_smfmac_f32_16x16x64_bf16 v[48:51], v[16:19], a[184:191], v3
  s_waitcnt lgkmcnt(3)
  v_add_f32 v44, v44, v46
  v_smfmac_f32_16x16x64_bf16 v[60:63], v[28:31], v[144:151], v3
  v_add_f32 v45, v45, v47
  v_smfmac_f32_16x16x64_bf16 v[48:51], v[20:23], a[192:199], v3
  v_cvt_pk_bf16_f32 v46, v44, v45
  v_smfmac_f32_16x16x64_bf16 v[48:51], v[24:27], a[200:207], v3
  ds_write_b32 v154, v46
  v_smfmac_f32_16x16x64_bf16 v[52:55], v[8:11], a[224:231], v3
  s_waitcnt lgkmcnt(1)
  v_smfmac_f32_16x16x64_bf16 v[60:63], v[32:35], v[64:71], v3
  v_smfmac_f32_16x16x64_bf16 v[52:55], v[12:15], a[232:239], v3
  v_permlane32_swap_b32 v48, v50
  v_smfmac_f32_16x16x64_bf16 v[52:55], v[16:19], a[240:247], v3
  v_permlane32_swap_b32 v49, v51
  v_smfmac_f32_16x16x64_bf16 v[52:55], v[20:23], a[248:255], v3
  v_add_f32 v48, v48, v50
  v_smfmac_f32_16x16x64_bf16 v[52:55], v[24:27], v[176:183], v3
  v_add_f32 v49, v49, v51
  v_smfmac_f32_16x16x64_bf16 v[56:59], v[8:11], v[200:207], v3
  v_cvt_pk_bf16_f32 v50, v48, v49
  v_smfmac_f32_16x16x64_bf16 v[56:59], v[12:15], v[208:215], v3
  ds_write_b32 v155, v50
  v_permlane32_swap_b32 v60, v62
  v_smfmac_f32_16x16x64_bf16 v[56:59], v[16:19], v[216:223], v3
  v_permlane32_swap_b32 v61, v63
  v_smfmac_f32_16x16x64_bf16 v[56:59], v[20:23], v[224:231], v3
  v_add_f32 v60, v60, v62
  v_smfmac_f32_16x16x64_bf16 v[56:59], v[24:27], v[232:239], v3
  v_add_f32 v61, v61, v63
  v_cvt_pk_bf16_f32 v62, v60, v61
  ds_write_b32 v158, v62
  v_permlane32_swap_b32 v52, v54
  v_permlane32_swap_b32 v53, v55
  v_add_f32 v52, v52, v54
  v_add_f32 v53, v53, v55
  v_cvt_pk_bf16_f32 v54, v52, v53
  ds_write_b32 v156, v54
  v_permlane32_swap_b32 v56, v58
  v_permlane32_swap_b32 v57, v59
  v_add_f32 v56, v56, v58
  v_add_f32 v57, v57, v59
  v_cvt_pk_bf16_f32 v58, v56, v57
  ds_write_b32 v157, v58
cA_va1_t2d:
  s_add_u32 s22, s20, 9216
  s_add_u32 s34, s20, 13312
  s_add_u32 s36, s20, 7168
  s_mov_b32 s37, 0
  v_mov_b32 v48, 0
  v_mov_b32 v49, 0
  v_mov_b32 v50, 0
  v_mov_b32 v51, 0
  v_mov_b32 v163, s18
  s_waitcnt lgkmcnt(0)
  s_barrier
  buffer_load_dwordx4 v[8:11], v2, s[8:11], s22 offen offset:0 sc1
  buffer_load_dwordx4 v[12:15], v2, s[8:11], s22 offen offset:1024 sc1
  buffer_load_dwordx4 v[16:19], v2, s[8:11], s22 offen offset:2048 sc1
  buffer_load_dwordx4 v[20:23], v2, s[8:11], s22 offen offset:3072 sc1
  buffer_load_dwordx4 v[24:27], v2, s[8:11], s34 offen offset:0 sc1
  buffer_load_dwordx4 v[28:31], v2, s[8:11], s34 offen offset:1024 sc1
  buffer_load_dwordx4 v[32:35], v2, s[8:11], s34 offen offset:2048 sc1
  buffer_load_dwordx4 v[36:39], v2, s[8:11], s34 offen offset:3072 sc1
  buffer_load_dwordx4 v[40:43], v2, s[8:11], s36 offen offset:0 sc1
  buffer_load_dwordx4 v[44:47], v2, s[8:11], s36 offen offset:1024 sc1
  ds_read_b128 v[64:67], v2 offset:4096
  ds_read_b128 v[68:71], v2 offset:5120
  ds_read_b128 v[72:75], v2 offset:6144
  ds_read_b128 v[76:79], v2 offset:7168
cA_va1_lp:
  s_waitcnt vmcnt(9)
  v_smfmac_f32_16x16x64_bf16 v[48:51], v[8:11], v[80:87], v3
  s_waitcnt vmcnt(8)
  v_smfmac_f32_16x16x64_bf16 v[48:51], v[12:15], v[88:95], v3
  s_waitcnt vmcnt(7)
  v_smfmac_f32_16x16x64_bf16 v[48:51], v[16:19], v[96:103], v3
  v_max3_u32 v55, v8, v12, v16
  s_waitcnt vmcnt(6)
  v_smfmac_f32_16x16x64_bf16 v[48:51], v[20:23], v[104:111], v3
  v_max_u32 v55, v55, v20
  v_cmp_eq_u32 vcc, -1, v55
  s_waitcnt vmcnt(5)
  v_smfmac_f32_16x16x64_bf16 v[48:51], v[24:27], v[112:119], v3
  s_waitcnt vmcnt(4)
  v_smfmac_f32_16x16x64_bf16 v[48:51], v[28:31], v[120:127], v3
  s_cbranch_vccnz cA_va1_rv
  buffer_store_dword v163, v7, s[8:11], 0 offen
  s_waitcnt vmcnt(4)
  v_smfmac_f32_16x16x64_bf16 v[48:51], v[32:35], v[128:135], v3
  s_waitcnt vmcnt(3)
  v_smfmac_f32_16x16x64_bf16 v[48:51], v[36:39], v[136:143], v3
  s_waitcnt vmcnt(2) lgkmcnt(0)
  v_smfmac_f32_16x16x64_bf16 v[48:51], v[40:43], v[64:71], v3
  s_waitcnt vmcnt(1)
  v_smfmac_f32_16x16x64_bf16 v[48:51], v[44:47], v[72:79], v3
  s_nop 7
  v_permlane32_swap_b32 v48, v50
  v_permlane32_swap_b32 v49, v51
  v_add_f32 v48, v48, v50
  v_add_f32 v49, v49, v51
  v_cvt_pk_bf16_f32 v160, v48, v49
  v_cmp_u_f32 vcc, v48, v49
  s_nop 0
  v_mov_b32_dpp v161, v160 quad_perm:[1,0,3,2] row_mask:0xf bank_mask:0xf
  v_perm_b32 v160, v161, v160, v5
  v_min_u32 v160, -2, v160
  s_cbranch_vccnz cA_va1_rp
cA_va1_cont:
  buffer_store_dword v160, v1, s[8:11], s21 offen
  s_cmp_lg_u32 s19, 62
  s_cbranch_scc1 cA_va1_nl
  buffer_store_dword v160, v1, s[8:11], s38 offen sc1
  s_branch cA_done
cA_va1_nl:
  s_add_u32 s25, s25, 28672
  v_mov_b32 v36, 0
  v_mov_b32 v37, 0
  v_mov_b32 v38, 0
  v_mov_b32 v39, 0
  v_mov_b32 v40, 0
  v_mov_b32 v41, 0
  v_mov_b32 v42, 0
  v_mov_b32 v43, 0
  v_mov_b32 v44, 0
  v_mov_b32 v45, 0
  v_mov_b32 v46, 0
  v_mov_b32 v47, 0
  v_mov_b32 v48, 0
  v_mov_b32 v49, 0
  v_mov_b32 v50, 0
  v_mov_b32 v51, 0
  v_mov_b32 v52, 0
  v_mov_b32 v53, 0
  v_mov_b32 v54, 0
  v_mov_b32 v55, 0
  v_mov_b32 v56, 0
  v_mov_b32 v57, 0
  v_mov_b32 v58, 0
  v_mov_b32 v59, 0
  v_mov_b32 v60, 0
  v_mov_b32 v61, 0
  v_mov_b32 v62, 0
  v_mov_b32 v63, 0
  s_mov_b32 s19, s18
  s_add_u32 s18, s18, 1
  s_mov_b32 s22, s20
  s_mov_b32 s20, s21
  s_mov_b32 s21, s22
  s_add_u32 s23, s20, 4096
  s_branch cA_va1_loop
cA_va1_slow:
  s_waitcnt lgkmcnt(0)
cA_va1_sl1:
  s_add_u32 s31, s31, 0x1000000
  buffer_load_dwordx4 v[8:11], v2, s[8:11], s20 offen offset:0 sc1
  buffer_load_dwordx4 v[12:15], v2, s[8:11], s20 offen offset:1024 sc1
  buffer_load_dwordx4 v[16:19], v2, s[8:11], s20 offen offset:2048 sc1
  buffer_load_dwordx4 v[20:23], v2, s[8:11], s20 offen offset:3072 sc1
  buffer_load_dwordx4 v[24:27], v2, s[8:11], s23 offen offset:0 sc1
  buffer_load_dwordx4 v[28:31], v2, s[8:11], s23 offen offset:1024 sc1
  buffer_load_dwordx4 v[32:35], v2, s[8:11], s23 offen offset:2048 sc1
  s_waitcnt vmcnt(0)
  v_max3_u32 v36, v8, v9, v10
  v_max3_u32 v36, v36, v11, v12
  v_max3_u32 v36, v36, v13, v14
  v_max3_u32 v36, v36, v15, v16
  v_max3_u32 v36, v36, v17, v18
  v_max3_u32 v36, v36, v19, v20
  v_max3_u32 v36, v36, v21, v22
  v_max3_u32 v36, v36, v23, v24
  v_max3_u32 v36, v36, v25, v26
  v_max3_u32 v36, v36, v27, v28
  v_max3_u32 v36, v36, v29, v30
  v_max3_u32 v36, v36, v31, v32
  v_max3_u32 v36, v36, v33, v34
  v_max_u32 v36, v36, v35
  v_cmp_eq_u32 vcc, -1, v36
  s_cbranch_vccz cA_va1_sl2
  s_add_u32 s30, s30, 1
  s_cmp_lt_u32 s30, 400000
  s_cbranch_scc1 cA_va1_sl1
  s_branch cA_abort
cA_va1_sl2:
  v_mov_b32 v36, 0
  v_mov_b32 v37, 0
  v_mov_b32 v38, 0
  v_mov_b32 v39, 0
  v_mov_b32 v40, 0
  v_mov_b32 v41, 0
  v_mov_b32 v42, 0
  v_mov_b32 v43, 0
  v_mov_b32 v44, 0
  v_mov_b32 v45, 0
  v_mov_b32 v46, 0
  v_mov_b32 v47, 0
  v_mov_b32 v48, 0
  v_mov_b32 v49, 0
  v_mov_b32 v50, 0
  v_mov_b32 v51, 0
  v_mov_b32 v52, 0
  v_mov_b32 v53, 0
  v_mov_b32 v54, 0
  v_mov_b32 v55, 0
  v_mov_b32 v56, 0
  v_mov_b32 v57, 0
  v_mov_b32 v58, 0
  v_mov_b32 v59, 0
  v_mov_b32 v60, 0
  v_mov_b32 v61, 0
  v_mov_b32 v62, 0
  v_mov_b32 v63, 0
  buffer_store_dword v162, v1, s[8:11], s21 offen
  ds_read_b128 v[64:67], v0 offset:0
  ds_read_b128 v[68:71], v0 offset:1024
  v_smfmac_f32_16x16x64_bf16 v[36:39], v[8:11], a[0:7], v3
  v_smfmac_f32_16x16x64_bf16 v[40:43], v[8:11], a[56:63], v3
  v_smfmac_f32_16x16x64_bf16 v[44:47], v[8:11], a[112:119], v3
  v_smfmac_f32_16x16x64_bf16 v[48:51], v[8:11], a[168:175], v3
  v_smfmac_f32_16x16x64_bf16 v[52:55], v[8:11], a[224:231], v3
  v_smfmac_f32_16x16x64_bf16 v[56:59], v[8:11], v[200:207], v3
  s_waitcnt lgkmcnt(0)
  v_smfmac_f32_16x16x64_bf16 v[60:63], v[8:11], v[64:71], v3
  ds_read_b128 v[72:75], v0 offset:2048
  ds_read_b128 v[76:79], v0 offset:3072
  v_smfmac_f32_16x16x64_bf16 v[36:39], v[12:15], a[8:15], v3
  v_smfmac_f32_16x16x64_bf16 v[40:43], v[12:15], a[64:71], v3
  v_smfmac_f32_16x16x64_bf16 v[44:47], v[12:15], a[120:127], v3
  v_smfmac_f32_16x16x64_bf16 v[48:51], v[12:15], a[176:183], v3
  v_smfmac_f32_16x16x64_bf16 v[52:55], v[12:15], a[232:239], v3
  v_smfmac_f32_16x16x64_bf16 v[56:59], v[12:15], v[208:215], v3
  s_waitcnt lgkmcnt(0)
  v_smfmac_f32_16x16x64_bf16 v[60:63], v[12:15], v[72:79], v3
  ds_read_b128 v[144:147], v0 offset:4096
  ds_read_b128 v[148:151], v0 offset:5120
  v_smfmac_f32_16x16x64_bf16 v[36:39], v[16:19], a[16:23], v3
  v_smfmac_f32_16x16x64_bf16 v[40:43], v[16:19], a[72:79], v3
  v_smfmac_f32_16x16x64_bf16 v[44:47], v[16:19], a[128:135], v3
  v_smfmac_f32_16x16x64_bf16 v[48:51], v[16:19], a[184:191], v3
  v_smfmac_f32_16x16x64_bf16 v[52:55], v[16:19], a[240:247], v3
  v_smfmac_f32_16x16x64_bf16 v[56:59], v[16:19], v[216:223], v3
  s_waitcnt lgkmcnt(0)
  v_smfmac_f32_16x16x64_bf16 v[60:63], v[16:19], v[144:151], v3
  ds_read_b128 v[64:67], v0 offset:6144
  ds_read_b128 v[68:71], v0 offset:7168
  v_smfmac_f32_16x16x64_bf16 v[36:39], v[20:23], a[24:31], v3
  v_smfmac_f32_16x16x64_bf16 v[40:43], v[20:23], a[80:87], v3
  v_smfmac_f32_16x16x64_bf16 v[44:47], v[20:23], a[136:143], v3
  v_smfmac_f32_16x16x64_bf16 v[48:51], v[20:23], a[192:199], v3
  v_smfmac_f32_16x16x64_bf16 v[52:55], v[20:23], a[248:255], v3
  v_smfmac_f32_16x16x64_bf16 v[56:59], v[20:23], v[224:231], v3
  s_waitcnt lgkmcnt(0)
  v_smfmac_f32_16x16x64_bf16 v[60:63], v[20:23], v[64:71], v3
  ds_read_b128 v[72:75], v0 offset:8192
  ds_read_b128 v[76:79], v0 offset:9216
  v_smfmac_f32_16x16x64_bf16 v[36:39], v[24:27], a[32:39], v3
  v_smfmac_f32_16x16x64_bf16 v[40:43], v[24:27], a[88:95], v3
  v_smfmac_f32_16x16x64_bf16 v[44:47], v[24:27], a[144:151], v3
  v_smfmac_f32_16x16x64_bf16 v[48:51], v[24:27], a[200:207], v3
  v_smfmac_f32_16x16x64_bf16 v[52:55], v[24:27], v[176:183], v3
  v_smfmac_f32_16x16x64_bf16 v[56:59], v[24:27], v[232:239], v3
  s_waitcnt lgkmcnt(0)
  v_smfmac_f32_16x16x64_bf16 v[60:63], v[24:27], v[72:79], v3
  ds_read_b128 v[144:147], v0 offset:10240
  ds_read_b128 v[148:151], v0 offset:11264
  v_smfmac_f32_16x16x64_bf16 v[36:39], v[28:31], a[40:47], v3
  v_smfmac_f32_16x16x64_bf16 v[40:43], v[28:31], a[96:103], v3
  v_smfmac_f32_16x16x64_bf16 v[44:47], v[28:31], a[152:159], v3
  v_smfmac_f32_16x16x64_bf16 v[48:51], v[28:31], a[208:215], v3
  v_smfmac_f32_16x16x64_bf16 v[52:55], v[28:31], v[184:191], v3
  v_smfmac_f32_16x16x64_bf16 v[56:59], v[28:31], v[240:247], v3
  s_waitcnt lgkmcnt(0)
  v_smfmac_f32_16x16x64_bf16 v[60:63], v[28:31], v[144:151], v3
  ds_read_b128 v[64:67], v0 offset:12288
  ds_read_b128 v[68:71], v0 offset:13312
  v_smfmac_f32_16x16x64_bf16 v[36:39], v[32:35], a[48:55], v3
  v_smfmac_f32_16x16x64_bf16 v[40:43], v[32:35], a[104:111], v3
  v_smfmac_f32_16x16x64_bf16 v[44:47], v[32:35], a[160:167], v3
  v_smfmac_f32_16x16x64_bf16 v[48:51], v[32:35], a[216:223], v3
  v_smfmac_f32_16x16x64_bf16 v[52:55], v[32:35], v[192:199], v3
  v_smfmac_f32_16x16x64_bf16 v[56:59], v[32:35], v[248:255], v3
  s_waitcnt lgkmcnt(0)
  v_smfmac_f32_16x16x64_bf16 v[60:63], v[32:35], v[64:71], v3
  v_permlane32_swap_b32 v36, v38
  v_permlane32_swap_b32 v37, v39
  v_add_f32 v36, v36, v38
  v_add_f32 v37, v37, v39
  v_cvt_pk_bf16_f32 v38, v36, v37
  ds_write_b32 v152, v38
  v_permlane32_swap_b32 v40, v42
  v_permlane32_swap_b32 v41, v43
  v_add_f32 v40, v40, v42
  v_add_f32 v41, v41, v43
  v_cvt_pk_bf16_f32 v42, v40, v41
  ds_write_b32 v153, v42
  v_permlane32_swap_b32 v44, v46
  v_permlane32_swap_b32 v45, v47
  v_add_f32 v44, v44, v46
  v_add_f32 v45, v45, v47
  v_cvt_pk_bf16_f32 v46, v44, v45
  ds_write_b32 v154, v46
  v_permlane32_swap_b32 v48, v50
  v_permlane32_swap_b32 v49, v51
  v_add_f32 v48, v48, v50
  v_add_f32 v49, v49, v51
  v_cvt_pk_bf16_f32 v50, v48, v49
  ds_write_b32 v155, v50
  v_permlane32_swap_b32 v52, v54
  v_permlane32_swap_b32 v53, v55
  v_add_f32 v52, v52, v54
  v_add_f32 v53, v53, v55
  v_cvt_pk_bf16_f32 v54, v52, v53
  ds_write_b32 v156, v54
  v_permlane32_swap_b32 v56, v58
  v_permlane32_swap_b32 v57, v59
  v_add_f32 v56, v56, v58
  v_add_f32 v57, v57, v59
  v_cvt_pk_bf16_f32 v58, v56, v57
  ds_write_b32 v157, v58
  v_permlane32_swap_b32 v60, v62
  v_permlane32_swap_b32 v61, v63
  v_add_f32 v60, v60, v62
  v_add_f32 v61, v61, v63
  v_cvt_pk_bf16_f32 v62, v60, v61
  ds_write_b32 v158, v62
  s_branch cA_va1_t2d
cA_va1_rp:
  s_cmp_lg_u32 s37, 0
  s_cbranch_scc1 cA_va1_cont
cA_va1_rv:
  s_add_u32 s31, s31, 0x10000
  buffer_load_dwordx4 v[8:11], v2, s[8:11], s22 offen offset:0 sc1
  buffer_load_dwordx4 v[12:15], v2, s[8:11], s22 offen offset:1024 sc1
  buffer_load_dwordx4 v[16:19], v2, s[8:11], s22 offen offset:2048 sc1
  buffer_load_dwordx4 v[20:23], v2, s[8:11], s22 offen offset:3072 sc1
  buffer_load_dwordx4 v[24:27], v2, s[8:11], s34 offen offset:0 sc1
  buffer_load_dwordx4 v[28:31], v2, s[8:11], s34 offen offset:1024 sc1
  buffer_load_dwordx4 v[32:35], v2, s[8:11], s34 offen offset:2048 sc1
  buffer_load_dwordx4 v[36:39], v2, s[8:11], s34 offen offset:3072 sc1
  buffer_load_dwordx4 v[40:43], v2, s[8:11], s36 offen offset:0 sc1
  buffer_load_dwordx4 v[44:47], v2, s[8:11], s36 offen offset:1024 sc1
  s_waitcnt vmcnt(0)
  v_max3_u32 v52, v8, v9, v10
  v_max3_u32 v52, v52, v11, v12
  v_max3_u32 v52, v52, v13, v14
  v_max3_u32 v52, v52, v15, v16
  v_max3_u32 v52, v52, v17, v18
  v_max3_u32 v52, v52, v19, v20
  v_max3_u32 v52, v52, v21, v22
  v_max3_u32 v52, v52, v23, v24
  v_max3_u32 v52, v52, v25, v26
  v_max3_u32 v52, v52, v27, v28
  v_max3_u32 v52, v52, v29, v30
  v_max3_u32 v52, v52, v31, v32
  v_max3_u32 v52, v52, v33, v34
  v_max3_u32 v52, v52, v35, v36
  v_max3_u32 v52, v52, v37, v38
  v_max3_u32 v52, v52, v39, v40
  v_max3_u32 v52, v52, v41, v42
  v_max3_u32 v52, v52, v43, v44
  v_max3_u32 v52, v52, v45, v46
  v_max_u32 v52, v52, v47
  v_cmp_eq_u32 vcc, -1, v52
  s_mov_b32 s37, 1
  v_mov_b32 v48, 0
  v_mov_b32 v49, 0
  v_mov_b32 v50, 0
  v_mov_b32 v51, 0
  s_nop 1
  s_cbranch_vccz cA_va1_lp
  s_add_u32 s30, s30, 1
  s_cmp_lt_u32 s30, 400000
  s_cbranch_scc1 cA_va1_rv
  s_branch cA_abort
.p2align 6
cA_va2_loop:
  s_mov_b32 s30, 0
  buffer_load_dword v100, v119, s[8:11], 0 offen sc1
  buffer_load_dword v101, v119, s[8:11], 0 offen sc1
  buffer_load_dword v102, v119, s[8:11], 0 offen sc1
cA_va2_fp_l:
  s_waitcnt vmcnt(2)
  v_cmp_gt_u32 vcc, s19, v100
  s_cbranch_vccz cA_va2_fp_d
  buffer_load_dword v100, v119, s[8:11], 0 offen sc1
  s_waitcnt vmcnt(2)
  v_cmp_gt_u32 vcc, s19, v101
  s_cbranch_vccz cA_va2_fp_d
  buffer_load_dword v101, v119, s[8:11], 0 offen sc1
  s_waitcnt vmcnt(2)
  v_cmp_gt_u32 vcc, s19, v102
  s_cbranch_vccz cA_va2_fp_d
  buffer_load_dword v102, v119, s[8:11], 0 offen sc1
  s_add_u32 s30, s30, 1
  s_cmp_lt_u32 s30, 400000
  s_cbranch_scc1 cA_va2_fp_l
  s_branch cA_abort
cA_va2_fp_d:
  buffer_load_dwordx4 v[8:11], v2, s[8:11], s20 offen offset:0 sc1
  buffer_load_dwordx4 v[12:15], v2, s[8:11], s20 offen offset:1024 sc1
  s_barrier
  s_barrier
  s_waitcnt vmcnt(0)
  ds_write_b128 v2, v[8:11] offset:8192
  ds_write_b128 v2, v[12:15] offset:9216
  v_smfmac_f32_16x16x64_bf16 v[36:39], v[8:11], a[0:7], v3
  v_smfmac_f32_16x16x64_bf16 v[40:43], v[8:11], a[56:63], v3
  v_smfmac_f32_16x16x64_bf16 v[44:47], v[8:11], a[112:119], v3
  v_smfmac_f32_16x16x64_bf16 v[48:51], v[8:11], a[168:175], v3
  v_smfmac_f32_16x16x64_bf16 v[52:55], v[8:11], a[224:231], v3
  s_waitcnt lgkmcnt(0)
  s_barrier
  ds_read_b128 v[16:19], v2 offset:10240
  ds_read_b128 v[20:23], v2 offset:11264
  ds_read_b128 v[24:27], v2 offset:12288
  ds_read_b128 v[28:31], v2 offset:13312
  ds_read_b128 v[32:35], v2 offset:14336
  v_smfmac_f32_16x16x64_bf16 v[56:59], v[8:11], v[144:151], v3
  v_smfmac_f32_16x16x64_bf16 v[60:63], v[8:11], v[200:207], v3
  v_smfmac_f32_16x16x64_bf16 v[36:39], v[12:15], a[8:15], v3
  v_smfmac_f32_16x16x64_bf16 v[40:43], v[12:15], a[64:71], v3
  v_smfmac_f32_16x16x64_bf16 v[44:47], v[12:15], a[120:127], v3
  v_smfmac_f32_16x16x64_bf16 v[48:51], v[12:15], a[176:183], v3
  v_smfmac_f32_16x16x64_bf16 v[52:55], v[12:15], a[232:239], v3
  v_smfmac_f32_16x16x64_bf16 v[56:59], v[12:15], v[152:159], v3
  v_smfmac_f32_16x16x64_bf16 v[60:63], v[12:15], v[208:215], v3
  s_waitcnt lgkmcnt(4)
  v_smfmac_f32_16x16x64_bf16 v[36:39], v[16:19], a[16:23], v3
  s_waitcnt lgkmcnt(3)
  v_smfmac_f32_16x16x64_bf16 v[36:39], v[20:23], a[24:31], v3
  s_waitcnt lgkmcnt(2)
  v_smfmac_f32_16x16x64_bf16 v[36:39], v[24:27], a[32:39], v3
  s_waitcnt lgkmcnt(1)
  v_smfmac_f32_16x16x64_bf16 v[36:39], v[28:31], a[40:47], v3
  s_waitcnt lgkmcnt(0)
  v_smfmac_f32_16x16x64_bf16 v[36:39], v[32:35], a[48:55], v3
  v_smfmac_f32_16x16x64_bf16 v[40:43], v[16:19], a[72:79], v3
  v_smfmac_f32_16x16x64_bf16 v[40:43], v[20:23], a[80:87], v3
  v_smfmac_f32_16x16x64_bf16 v[40:43], v[24:27], a[88:95], v3
  v_permlane32_swap_b32 v36, v38
  v_smfmac_f32_16x16x64_bf16 v[40:43], v[28:31], a[96:103], v3
  v_permlane32_swap_b32 v37, v39
  v_smfmac_f32_16x16x64_bf16 v[40:43], v[32:35], a[104:111], v3
  v_add_f32 v36, v36, v38
  v_smfmac_f32_16x16x64_bf16 v[44:47], v[16:19], a[128:135], v3
  v_add_f32 v37, v37, v39
  v_smfmac_f32_16x16x64_bf16 v[44:47], v[20:23], a[136:143], v3
  v_cmp_u_f32 vcc, v36, v37
  v_smfmac_f32_16x16x64_bf16 v[44:47], v[24:27], a[144:151], v3
  v_cvt_pk_bf16_f32 v38, v36, v37
  v_smfmac_f32_16x16x64_bf16 v[44:47], v[28:31], a[152:159], v3
  ds_write_b32 v104, v38
  s_cbranch_vccnz cA_va2_slow
  v_permlane32_swap_b32 v40, v42
  v_smfmac_f32_16x16x64_bf16 v[44:47], v[32:35], a[160:167], v3
  v_permlane32_swap_b32 v41, v43
  v_smfmac_f32_16x16x64_bf16 v[48:51], v[16:19], a[184:191], v3
  v_add_f32 v40, v40, v42
  v_smfmac_f32_16x16x64_bf16 v[48:51], v[20:23], a[192:199], v3
  v_add_f32 v41, v41, v43
  v_smfmac_f32_16x16x64_bf16 v[48:51], v[24:27], a[200:207], v3
  v_cvt_pk_bf16_f32 v42, v40, v41
  v_smfmac_f32_16x16x64_bf16 v[48:51], v[28:31], a[208:215], v3
  ds_write_b32 v105, v42
  v_permlane32_swap_b32 v44, v46
  v_smfmac_f32_16x16x64_bf16 v[48:51], v[32:35], a[216:223], v3
  v_permlane32_swap_b32 v45, v47
  v_smfmac_f32_16x16x64_bf16 v[52:55], v[16:19], a[240:247], v3
  v_add_f32 v44, v44, v46
  v_smfmac_f32_16x16x64_bf16 v[52:55], v[20:23], a[248:255], v3
  v_add_f32 v45, v45, v47
  v_smfmac_f32_16x16x64_bf16 v[52:55], v[24:27], v[120:127], v3
  v_cvt_pk_bf16_f32 v46, v44, v45
  v_smfmac_f32_16x16x64_bf16 v[52:55], v[28:31], v[128:135], v3
  ds_write_b32 v106, v46
  v_permlane32_swap_b32 v48, v50
  v_smfmac_f32_16x16x64_bf16 v[52:55], v[32:35], v[136:143], v3
  v_permlane32_swap_b32 v49, v51
  v_smfmac_f32_16x16x64_bf16 v[56:59], v[16:19], v[160:167], v3
  v_add_f32 v48, v48, v50
  v_smfmac_f32_16x16x64_bf16 v[56:59], v[20:23], v[168:175], v3
  v_add_f32 v49, v49, v51
  v_smfmac_f32_16x16x64_bf16 v[56:59], v[24:27], v[176:183], v3
  v_cvt_pk_bf16_f32 v50, v48, v49
  v_smfmac_f32_16x16x64_bf16 v[56:59], v[28:31], v[184:191], v3
  ds_write_b32 v107, v50
  v_permlane32_swap_b32 v52, v54
  v_smfmac_f32_16x16x64_bf16 v[56:59], v[32:35], v[192:199], v3
  v_permlane32_swap_b32 v53, v55
  v_smfmac_f32_16x16x64_bf16 v[60:63], v[16:19], v[216:223], v3
  v_add_f32 v52, v52, v54
  v_smfmac_f32_16x16x64_bf16 v[60:63], v[20:23], v[224:231], v3
  v_add_f32 v53, v53, v55
  v_smfmac_f32_16x16x64_bf16 v[60:63], v[24:27], v[232:239], v3
  v_cvt_pk_bf16_f32 v54, v52, v53
  v_smfmac_f32_16x16x64_bf16 v[60:63], v[28:31], v[240:247], v3
  ds_write_b32 v108, v54
  v_permlane32_swap_b32 v56, v58
  v_smfmac_f32_16x16x64_bf16 v[60:63], v[32:35], v[248:255], v3
  v_permlane32_swap_b32 v57, v59
  v_add_f32 v56, v56, v58
  v_add_f32 v57, v57, v59
  v_cvt_pk_bf16_f32 v58, v56, v57
  ds_write_b32 v109, v58
  s_nop 2
  v_permlane32_swap_b32 v60, v62
  v_permlane32_swap_b32 v61, v63
  v_add_f32 v60, v60, v62
  v_add_f32 v61, v61, v63
  v_cvt_pk_bf16_f32 v62, v60, v61
  ds_write_b32 v110, v62
cA_va2_t2d:
  v_mov_b32 v117, s18
  s_waitcnt lgkmcnt(0)
  s_barrier
  s_cmp_eq_u32 s19, 62
  s_cbranch_scc1 cA_done
  s_sleep 1
  v_mov_b32 v36, 0
  v_mov_b32 v37, 0
  v_mov_b32 v38, 0
  v_mov_b32 v39, 0
  v_mov_b32 v40, 0
  v_mov_b32 v41, 0
  v_mov_b32 v42, 0
  v_mov_b32 v43, 0
  v_mov_b32 v44, 0
  v_mov_b32 v45, 0
  v_mov_b32 v46, 0
  v_mov_b32 v47, 0
  v_mov_b32 v48, 0
  v_mov_b32 v49, 0
  v_mov_b32 v50, 0
  v_mov_b32 v51, 0
  v_mov_b32 v52, 0
  v_mov_b32 v53, 0
  v_mov_b32 v54, 0
  v_mov_b32 v55, 0
  v_mov_b32 v56, 0
  v_mov_b32 v57, 0
  v_mov_b32 v58, 0
  v_mov_b32 v59, 0
  v_mov_b32 v60, 0
  v_mov_b32 v61, 0
  v_mov_b32 v62, 0
  v_mov_b32 v63, 0
  s_sleep 3
  s_mov_b32 s19, s18
  s_add_u32 s18, s18, 1
  s_mov_b32 s22, s20
  s_mov_b32 s20, s21
  s_mov_b32 s21, s22
  s_add_u32 s23, s20, 4096
  s_branch cA_va2_loop
cA_va2_slow:
  s_waitcnt lgkmcnt(0)
cA_va2_sl1:
  s_add_u32 s31, s31, 0x1000000
  buffer_load_dwordx4 v[8:11], v2, s[8:11], s20 offen offset:0 sc1
  buffer_load_dwordx4 v[12:15], v2, s[8:11], s20 offen offset:1024 sc1
  buffer_load_dwordx4 v[16:19], v2, s[8:11], s20 offen offset:2048 sc1
  buffer_load_dwordx4 v[20:23], v2, s[8:11], s20 offen offset:3072 sc1
  buffer_load_dwordx4 v[24:27], v2, s[8:11], s23 offen offset:0 sc1
  buffer_load_dwordx4 v[28:31], v2, s[8:11], s23 offen offset:1024 sc1
  buffer_load_dwordx4 v[32:35], v2, s[8:11], s23 offen offset:2048 sc1
  s_waitcnt vmcnt(0)
  v_max3_u32 v36, v8, v9, v10
  v_max3_u32 v36, v36, v11, v12
  v_max3_u32 v36, v36, v13, v14
  v_max3_u32 v36, v36, v15, v16
  v_max3_u32 v36, v36, v17, v18
  v_max3_u32 v36, v36, v19, v20
  v_max3_u32 v36, v36, v21, v22
  v_max3_u32 v36, v36, v23, v24
  v_max3_u32 v36, v36, v25, v26
  v_max3_u32 v36, v36, v27, v28
  v_max3_u32 v36, v36, v29, v30
  v_max3_u32 v36, v36, v31, v32
  v_max3_u32 v36, v36, v33, v34
  v_max_u32 v36, v36, v35
  v_cmp_eq_u32 vcc, -1, v36
  s_cbranch_vccz cA_va2_sl2
  s_add_u32 s30, s30, 1
  s_cmp_lt_u32 s30, 400000
  s_cbranch_scc1 cA_va2_sl1
  s_branch cA_abort
cA_va2_sl2:
  v_mov_b32 v36, 0
  v_mov_b32 v37, 0
  v_mov_b32 v38, 0
  v_mov_b32 v39, 0
  v_mov_b32 v40, 0
  v_mov_b32 v41, 0
  v_mov_b32 v42, 0
  v_mov_b32 v43, 0
  v_mov_b32 v44, 0
  v_mov_b32 v45, 0
  v_mov_b32 v46, 0
  v_mov_b32 v47, 0
  v_mov_b32 v48, 0
  v_mov_b32 v49, 0
  v_mov_b32 v50, 0
  v_mov_b32 v51, 0
  v_mov_b32 v52, 0
  v_mov_b32 v53, 0
  v_mov_b32 v54, 0
  v_mov_b32 v55, 0
  v_mov_b32 v56, 0
  v_mov_b32 v57, 0
  v_mov_b32 v58, 0
  v_mov_b32 v59, 0
  v_mov_b32 v60, 0
  v_mov_b32 v61, 0
  v_mov_b32 v62, 0
  v_mov_b32 v63, 0
  v_smfmac_f32_16x16x64_bf16 v[36:39], v[8:11], a[0:7], v3
  v_smfmac_f32_16x16x64_bf16 v[40:43], v[8:11], a[56:63], v3
  v_smfmac_f32_16x16x64_bf16 v[44:47], v[8:11], a[112:119], v3
  v_smfmac_f32_16x16x64_bf16 v[48:51], v[8:11], a[168:175], v3
  v_smfmac_f32_16x16x64_bf16 v[52:55], v[8:11], a[224:231], v3
  v_smfmac_f32_16x16x64_bf16 v[56:59], v[8:11], v[144:151], v3
  v_smfmac_f32_16x16x64_bf16 v[60:63], v[8:11], v[200:207], v3
  v_smfmac_f32_16x16x64_bf16 v[36:39], v[12:15], a[8:15], v3
  v_smfmac_f32_16x16x64_bf16 v[40:43], v[12:15], a[64:71], v3
  v_smfmac_f32_16x16x64_bf16 v[44:47], v[12:15], a[120:127], v3
  v_smfmac_f32_16x16x64_bf16 v[48:51], v[12:15], a[176:183], v3
  v_smfmac_f32_16x16x64_bf16 v[52:55], v[12:15], a[232:239], v3
  v_smfmac_f32_16x16x64_bf16 v[56:59], v[12:15], v[152:159], v3
  v_smfmac_f32_16x16x64_bf16 v[60:63], v[12:15], v[208:215], v3
  v_smfmac_f32_16x16x64_bf16 v[36:39], v[16:19], a[16:23], v3
  v_smfmac_f32_16x16x64_bf16 v[40:43], v[16:19], a[72:79], v3
  v_smfmac_f32_16x16x64_bf16 v[44:47], v[16:19], a[128:135], v3
  v_smfmac_f32_16x16x64_bf16 v[48:51], v[16:19], a[184:191], v3
  v_smfmac_f32_16x16x64_bf16 v[52:55], v[16:19], a[240:247], v3
  v_smfmac_f32_16x16x64_bf16 v[56:59], v[16:19], v[160:167], v3
  v_smfmac_f32_16x16x64_bf16 v[60:63], v[16:19], v[216:223], v3
  v_smfmac_f32_16x16x64_bf16 v[36:39], v[20:23], a[24:31], v3
  v_smfmac_f32_16x16x64_bf16 v[40:43], v[20:23], a[80:87], v3
  v_smfmac_f32_16x16x64_bf16 v[44:47], v[20:23], a[136:143], v3
  v_smfmac_f32_16x16x64_bf16 v[48:51], v[20:23], a[192:199], v3
  v_smfmac_f32_16x16x64_bf16 v[52:55], v[20:23], a[248:255], v3
  v_smfmac_f32_16x16x64_bf16 v[56:59], v[20:23], v[168:175], v3
  v_smfmac_f32_16x16x64_bf16 v[60:63], v[20:23], v[224:231], v3
  v_smfmac_f32_16x16x64_bf16 v[36:39], v[24:27], a[32:39], v3
  v_smfmac_f32_16x16x64_bf16 v[40:43], v[24:27], a[88:95], v3
  v_smfmac_f32_16x16x64_bf16 v[44:47], v[24:27], a[144:151], v3
  v_smfmac_f32_16x16x64_bf16 v[48:51], v[24:27], a[200:207], v3
  v_smfmac_f32_16x16x64_bf16 v[52:55], v[24:27], v[120:127], v3
  v_smfmac_f32_16x16x64_bf16 v[56:59], v[24:27], v[176:183], v3
  v_smfmac_f32_16x16x64_bf16 v[60:63], v[24:27], v[232:239], v3
  v_smfmac_f32_16x16x64_bf16 v[36:39], v[28:31], a[40:47], v3
  v_smfmac_f32_16x16x64_bf16 v[40:43], v[28:31], a[96:103], v3
  v_smfmac_f32_16x16x64_bf16 v[44:47], v[28:31], a[152:159], v3
  v_smfmac_f32_16x16x64_bf16 v[48:51], v[28:31], a[208:215], v3
  v_smfmac_f32_16x16x64_bf16 v[52:55], v[28:31], v[128:135], v3
  v_smfmac_f32_16x16x64_bf16 v[56:59], v[28:31], v[184:191], v3
  v_smfmac_f32_16x16x64_bf16 v[60:63], v[28:31], v[240:247], v3
  v_smfmac_f32_16x16x64_bf16 v[36:39], v[32:35], a[48:55], v3
  v_smfmac_f32_16x16x64_bf16 v[40:43], v[32:35], a[104:111], v3
  v_smfmac_f32_16x16x64_bf16 v[44:47], v[32:35], a[160:167], v3
  v_smfmac_f32_16x16x64_bf16 v[48:51], v[32:35], a[216:223], v3
  v_smfmac_f32_16x16x64_bf16 v[52:55], v[32:35], v[136:143], v3
  v_smfmac_f32_16x16x64_bf16 v[56:59], v[32:35], v[192:199], v3
  v_smfmac_f32_16x16x64_bf16 v[60:63], v[32:35], v[248:255], v3
  v_permlane32_swap_b32 v36, v38
  v_permlane32_swap_b32 v37, v39
  v_add_f32 v36, v36, v38
  v_add_f32 v37, v37, v39
  v_cvt_pk_bf16_f32 v38, v36, v37
  ds_write_b32 v104, v38
  v_permlane32_swap_b32 v40, v42
  v_permlane32_swap_b32 v41, v43
  v_add_f32 v40, v40, v42
  v_add_f32 v41, v41, v43
  v_cvt_pk_bf16_f32 v42, v40, v41
  ds_write_b32 v105, v42
  v_permlane32_swap_b32 v44, v46
  v_permlane32_swap_b32 v45, v47
  v_add_f32 v44, v44, v46
  v_add_f32 v45, v45, v47
  v_cvt_pk_bf16_f32 v46, v44, v45
  ds_write_b32 v106, v46
  v_permlane32_swap_b32 v48, v50
  v_permlane32_swap_b32 v49, v51
  v_add_f32 v48, v48, v50
  v_add_f32 v49, v49, v51
  v_cvt_pk_bf16_f32 v50, v48, v49
  ds_write_b32 v107, v50
  v_permlane32_swap_b32 v52, v54
  v_permlane32_swap_b32 v53, v55
  v_add_f32 v52, v52, v54
  v_add_f32 v53, v53, v55
  v_cvt_pk_bf16_f32 v54, v52, v53
  ds_write_b32 v108, v54
  v_permlane32_swap_b32 v56, v58
  v_permlane32_swap_b32 v57, v59
  v_add_f32 v56, v56, v58
  v_add_f32 v57, v57, v59
  v_cvt_pk_bf16_f32 v58, v56, v57
  ds_write_b32 v109, v58
  v_permlane32_swap_b32 v60, v62
  v_permlane32_swap_b32 v61, v63
  v_add_f32 v60, v60, v62
  v_add_f32 v61, v61, v63
  v_cvt_pk_bf16_f32 v62, v60, v61
  ds_write_b32 v110, v62
  s_branch cA_va2_t2d
.p2align 6
cA_va3_loop:
  s_mov_b32 s30, 0
  s_barrier
  buffer_load_dwordx4 v[16:19], v2, s[8:11], s20 offen offset:2048 sc1
  buffer_load_dwordx4 v[20:23], v2, s[8:11], s20 offen offset:3072 sc1
  s_barrier
  buffer_load_dword v100, v116, s[8:11], s39 offen sc1
  s_add_u32 s27, s19, 2
  s_min_u32 s27, s27, 63
  s_lshr_b32 s27, s27, 3
  s_lshl_b32 s27, s27, 11
  s_add_u32 s27, s27, s35
  buffer_load_dword v101, off, s[8:11], s27 sc1
  s_add_u32 s39, s39, 28672
  s_waitcnt vmcnt(2)
  ds_write_b128 v2, v[16:19] offset:10240
  ds_write_b128 v2, v[20:23] offset:11264
  v_smfmac_f32_16x16x64_bf16 v[36:39], v[16:19], a[16:23], v3
  v_smfmac_f32_16x16x64_bf16 v[40:43], v[16:19], a[72:79], v3
  v_smfmac_f32_16x16x64_bf16 v[44:47], v[16:19], a[128:135], v3
  v_smfmac_f32_16x16x64_bf16 v[48:51], v[16:19], a[184:191], v3
  v_smfmac_f32_16x16x64_bf16 v[52:55], v[16:19], a[240:247], v3
  s_waitcnt lgkmcnt(0)
  s_barrier
  ds_read_b128 v[8:11], v2 offset:8192
  ds_read_b128 v[12:15], v2 offset:9216
  ds_read_b128 v[24:27], v2 offset:12288
  ds_read_b128 v[28:31], v2 offset:13312
  ds_read_b128 v[32:35], v2 offset:14336
  v_smfmac_f32_16x16x64_bf16 v[56:59], v[16:19], v[160:167], v3
  v_smfmac_f32_16x16x64_bf16 v[60:63], v[16:19], v[216:223], v3
  v_smfmac_f32_16x16x64_bf16 v[36:39], v[20:23], a[24:31], v3
  v_smfmac_f32_16x16x64_bf16 v[40:43], v[20:23], a[80:87], v3
  v_smfmac_f32_16x16x64_bf16 v[44:47], v[20:23], a[136:143], v3
  v_smfmac_f32_16x16x64_bf16 v[48:51], v[20:23], a[192:199], v3
  v_smfmac_f32_16x16x64_bf16 v[52:55], v[20:23], a[248:255], v3
  v_smfmac_f32_16x16x64_bf16 v[56:59], v[20:23], v[168:175], v3
  v_smfmac_f32_16x16x64_bf16 v[60:63], v[20:23], v[224:231], v3
  s_waitcnt lgkmcnt(4)
  v_smfmac_f32_16x16x64_bf16 v[36:39], v[8:11], a[0:7], v3
  s_waitcnt lgkmcnt(3)
  v_smfmac_f32_16x16x64_bf16 v[36:39], v[12:15], a[8:15], v3
  s_waitcnt lgkmcnt(2)
  v_smfmac_f32_16x16x64_bf16 v[36:39], v[24:27], a[32:39], v3
  s_waitcnt lgkmcnt(1)
  v_smfmac_f32_16x16x64_bf16 v[36:39], v[28:31], a[40:47], v3
  s_waitcnt lgkmcnt(0)
  v_smfmac_f32_16x16x64_bf16 v[36:39], v[32:35], a[48:55], v3
  v_smfmac_f32_16x16x64_bf16 v[40:43], v[8:11], a[56:63], v3
  v_smfmac_f32_16x16x64_bf16 v[40:43], v[12:15], a[64:71], v3
  v_smfmac_f32_16x16x64_bf16 v[40:43], v[24:27], a[88:95], v3
  v_permlane32_swap_b32 v36, v38
  v_smfmac_f32_16x16x64_bf16 v[40:43], v[28:31], a[96:103], v3
  v_permlane32_swap_b32 v37, v39
  v_smfmac_f32_16x16x64_bf16 v[40:43], v[32:35], a[104:111], v3
  v_add_f32 v36, v36, v38
  v_smfmac_f32_16x16x64_bf16 v[44:47], v[8:11], a[112:119], v3
  v_add_f32 v37, v37, v39
  v_smfmac_f32_16x16x64_bf16 v[44:47], v[12:15], a[120:127], v3
  v_cmp_u_f32 vcc, v36, v37
  v_smfmac_f32_16x16x64_bf16 v[44:47], v[24:27], a[144:151], v3
  v_cvt_pk_bf16_f32 v38, v36, v37
  v_smfmac_f32_16x16x64_bf16 v[44:47], v[28:31], a[152:159], v3
  ds_write_b32 v104, v38
  s_cbranch_vccnz cA_va3_slow
  v_permlane32_swap_b32 v40, v42
  v_smfmac_f32_16x16x64_bf16 v[44:47], v[32:35], a[160:167], v3
  v_permlane32_swap_b32 v41, v43
  v_smfmac_f32_16x16x64_bf16 v[48:51], v[8:11], a[168:175], v3
  v_add_f32 v40, v40, v42
  v_smfmac_f32_16x16x64_bf16 v[48:51], v[12:15], a[176:183], v3
  v_add_f32 v41, v41, v43
  v_smfmac_f32_16x16x64_bf16 v[48:51], v[24:27], a[200:207], v3
  v_cvt_pk_bf16_f32 v42, v40, v41
  v_smfmac_f32_16x16x64_bf16 v[48:51], v[28:31], a[208:215], v3
  ds_write_b32 v105, v42
  v_permlane32_swap_b32 v44, v46
  v_smfmac_f32_16x16x64_bf16 v[48:51], v[32:35], a[216:223], v3
  v_permlane32_swap_b32 v45, v47
  v_smfmac_f32_16x16x64_bf16 v[52:55], v[8:11], a[224:231], v3
  v_add_f32 v44, v44, v46
  v_smfmac_f32_16x16x64_bf16 v[52:55], v[12:15], a[232:239], v3
  v_add_f32 v45, v45, v47
  v_smfmac_f32_16x16x64_bf16 v[52:55], v[24:27], v[120:127], v3
  v_cvt_pk_bf16_f32 v46, v44, v45
  v_smfmac_f32_16x16x64_bf16 v[52:55], v[28:31], v[128:135], v3
  ds_write_b32 v106, v46
  v_permlane32_swap_b32 v48, v50
  v_smfmac_f32_16x16x64_bf16 v[52:55], v[32:35], v[136:143], v3
  v_permlane32_swap_b32 v49, v51
  v_smfmac_f32_16x16x64_bf16 v[56:59], v[8:11], v[144:151], v3
  v_add_f32 v48, v48, v50
  v_smfmac_f32_16x16x64_bf16 v[56:59], v[12:15], v[152:159], v3
  v_add_f32 v49, v49, v51
  v_smfmac_f32_16x16x64_bf16 v[56:59], v[24:27], v[176:183], v3
  v_cvt_pk_bf16_f32 v50, v48, v49
  v_smfmac_f32_16x16x64_bf16 v[56:59], v[28:31], v[184:191], v3
  ds_write_b32 v107, v50
  v_permlane32_swap_b32 v52, v54
  v_smfmac_f32_16x16x64_bf16 v[56:59], v[32:35], v[192:199], v3
  v_permlane32_swap_b32 v53, v55
  v_smfmac_f32_16x16x64_bf16 v[60:63], v[8:11], v[200:207], v3
  v_add_f32 v52, v52, v54
  v_smfmac_f32_16x16x64_bf16 v[60:63], v[12:15], v[208:215], v3
  v_add_f32 v53, v53, v55
  v_smfmac_f32_16x16x64_bf16 v[60:63], v[24:27], v[232:239], v3
  v_cvt_pk_bf16_f32 v54, v52, v53
  v_smfmac_f32_16x16x64_bf16 v[60:63], v[28:31], v[240:247], v3
  ds_write_b32 v108, v54
  v_permlane32_swap_b32 v56, v58
  v_smfmac_f32_16x16x64_bf16 v[60:63], v[32:35], v[248:255], v3
  v_permlane32_swap_b32 v57, v59
  v_add_f32 v56, v56, v58
  v_add_f32 v57, v57, v59
  v_cvt_pk_bf16_f32 v58, v56, v57
  ds_write_b32 v109, v58
  s_nop 2
  v_permlane32_swap_b32 v60, v62
  v_permlane32_swap_b32 v61, v63
  v_add_f32 v60, v60, v62
  v_add_f32 v61, v61, v63
  v_cvt_pk_bf16_f32 v62, v60, v61
  ds_write_b32 v110, v62
cA_va3_t2d:
  v_mov_b32 v117, s18
cA_va3_vow:
  s_waitcnt vmcnt(0)
  v_cmp_ne_u32 vcc, 56, v101
  s_cbranch_vccnz cA_va3_vor
  s_waitcnt lgkmcnt(0)
  s_barrier
  v_mov_b32 v36, 0
  v_mov_b32 v37, 0
  v_mov_b32 v38, 0
  v_mov_b32 v39, 0
  v_mov_b32 v40, 0
  v_mov_b32 v41, 0
  v_mov_b32 v42, 0
  v_mov_b32 v43, 0
  buffer_store_dword v117, v118, s[8:11], 0 offen
  s_cmp_eq_u32 s19, 62
  s_cbranch_scc1 cA_done
  v_mov_b32 v44, 0
  v_mov_b32 v45, 0
  v_mov_b32 v46, 0
  v_mov_b32 v47, 0
  v_mov_b32 v48, 0
  v_mov_b32 v49, 0
  v_mov_b32 v50, 0
  v_mov_b32 v51, 0
  v_mov_b32 v52, 0
  v_mov_b32 v53, 0
  v_mov_b32 v54, 0
  v_mov_b32 v55, 0
  v_mov_b32 v56, 0
  v_mov_b32 v57, 0
  v_mov_b32 v58, 0
  v_mov_b32 v59, 0
  v_mov_b32 v60, 0
  v_mov_b32 v61, 0
  v_mov_b32 v62, 0
  v_mov_b32 v63, 0
  s_mov_b32 s19, s18
  s_add_u32 s18, s18, 1
  s_mov_b32 s22, s20
  s_mov_b32 s20, s21
  s_mov_b32 s21, s22
  s_add_u32 s23, s20, 4096
  s_branch cA_va3_loop
cA_va3_slow:
  s_waitcnt lgkmcnt(0)
cA_va3_sl1:
  s_add_u32 s31, s31, 0x1000000
  buffer_load_dwordx4 v[8:11], v2, s[8:11], s20 offen offset:0 sc1
  buffer_load_dwordx4 v[12:15], v2, s[8:11], s20 offen offset:1024 sc1
  buffer_load_dwordx4 v[16:19], v2, s[8:11], s20 offen offset:2048 sc1
  buffer_load_dwordx4 v[20:23], v2, s[8:11], s20 offen offset:3072 sc1
  buffer_load_dwordx4 v[24:27], v2, s[8:11], s23 offen offset:0 sc1
  buffer_load_dwordx4 v[28:31], v2, s[8:11], s23 offen offset:1024 sc1
  buffer_load_dwordx4 v[32:35], v2, s[8:11], s23 offen offset:2048 sc1
  s_waitcnt vmcnt(0)
  v_max3_u32 v36, v8, v9, v10
  v_max3_u32 v36, v36, v11, v12
  v_max3_u32 v36, v36, v13, v14
  v_max3_u32 v36, v36, v15, v16
  v_max3_u32 v36, v36, v17, v18
  v_max3_u32 v36, v36, v19, v20
  v_max3_u32 v36, v36, v21, v22
  v_max3_u32 v36, v36, v23, v24
  v_max3_u32 v36, v36, v25, v26
  v_max3_u32 v36, v36, v27, v28
  v_max3_u32 v36, v36, v29, v30
  v_max3_u32 v36, v36, v31, v32
  v_max3_u32 v36, v36, v33, v34
  v_max_u32 v36, v36, v35
  v_cmp_eq_u32 vcc, -1, v36
  s_cbranch_vccz cA_va3_sl2
  s_add_u32 s30, s30, 1
  s_cmp_lt_u32 s30, 400000
  s_cbranch_scc1 cA_va3_sl1
  s_branch cA_abort
cA_va3_sl2:
  v_mov_b32 v36, 0
  v_mov_b32 v37, 0
  v_mov_b32 v38, 0
  v_mov_b32 v39, 0
  v_mov_b32 v40, 0
  v_mov_b32 v41, 0
  v_mov_b32 v42, 0
  v_mov_b32 v43, 0
  v_mov_b32 v44, 0
  v_mov_b32 v45, 0
  v_mov_b32 v46, 0
  v_mov_b32 v47, 0
  v_mov_b32 v48, 0
  v_mov_b32 v49, 0
  v_mov_b32 v50, 0
  v_mov_b32 v51, 0
  v_mov_b32 v52, 0
  v_mov_b32 v53, 0
  v_mov_b32 v54, 0
  v_mov_b32 v55, 0
  v_mov_b32 v56, 0
  v_mov_b32 v57, 0
  v_mov_b32 v58, 0
  v_mov_b32 v59, 0
  v_mov_b32 v60, 0
  v_mov_b32 v61, 0
  v_mov_b32 v62, 0
  v_mov_b32 v63, 0
  v_smfmac_f32_16x16x64_bf16 v[36:39], v[8:11], a[0:7], v3
  v_smfmac_f32_16x16x64_bf16 v[40:43], v[8:11], a[56:63], v3
  v_smfmac_f32_16x16x64_bf16 v[44:47], v[8:11], a[112:119], v3
  v_smfmac_f32_16x16x64_bf16 v[48:51], v[8:11], a[168:175], v3
  v_smfmac_f32_16x16x64_bf16 v[52:55], v[8:11], a[224:231], v3
  v_smfmac_f32_16x16x64_bf16 v[56:59], v[8:11], v[144:151], v3
  v_smfmac_f32_16x16x64_bf16 v[60:63], v[8:11], v[200:207], v3
  v_smfmac_f32_16x16x64_bf16 v[36:39], v[12:15], a[8:15], v3
  v_smfmac_f32_16x16x64_bf16 v[40:43], v[12:15], a[64:71], v3
  v_smfmac_f32_16x16x64_bf16 v[44:47], v[12:15], a[120:127], v3
  v_smfmac_f32_16x16x64_bf16 v[48:51], v[12:15], a[176:183], v3
  v_smfmac_f32_16x16x64_bf16 v[52:55], v[12:15], a[232:239], v3
  v_smfmac_f32_16x16x64_bf16 v[56:59], v[12:15], v[152:159], v3
  v_smfmac_f32_16x16x64_bf16 v[60:63], v[12:15], v[208:215], v3
  v_smfmac_f32_16x16x64_bf16 v[36:39], v[16:19], a[16:23], v3
  v_smfmac_f32_16x16x64_bf16 v[40:43], v[16:19], a[72:79], v3
  v_smfmac_f32_16x16x64_bf16 v[44:47], v[16:19], a[128:135], v3
  v_smfmac_f32_16x16x64_bf16 v[48:51], v[16:19], a[184:191], v3
  v_smfmac_f32_16x16x64_bf16 v[52:55], v[16:19], a[240:247], v3
  v_smfmac_f32_16x16x64_bf16 v[56:59], v[16:19], v[160:167], v3
  v_smfmac_f32_16x16x64_bf16 v[60:63], v[16:19], v[216:223], v3
  v_smfmac_f32_16x16x64_bf16 v[36:39], v[20:23], a[24:31], v3
  v_smfmac_f32_16x16x64_bf16 v[40:43], v[20:23], a[80:87], v3
  v_smfmac_f32_16x16x64_bf16 v[44:47], v[20:23], a[136:143], v3
  v_smfmac_f32_16x16x64_bf16 v[48:51], v[20:23], a[192:199], v3
  v_smfmac_f32_16x16x64_bf16 v[52:55], v[20:23], a[248:255], v3
  v_smfmac_f32_16x16x64_bf16 v[56:59], v[20:23], v[168:175], v3
  v_smfmac_f32_16x16x64_bf16 v[60:63], v[20:23], v[224:231], v3
  v_smfmac_f32_16x16x64_bf16 v[36:39], v[24:27], a[32:39], v3
  v_smfmac_f32_16x16x64_bf16 v[40:43], v[24:27], a[88:95], v3
  v_smfmac_f32_16x16x64_bf16 v[44:47], v[24:27], a[144:151], v3
  v_smfmac_f32_16x16x64_bf16 v[48:51], v[24:27], a[200:207], v3
  v_smfmac_f32_16x16x64_bf16 v[52:55], v[24:27], v[120:127], v3
  v_smfmac_f32_16x16x64_bf16 v[56:59], v[24:27], v[176:183], v3
  v_smfmac_f32_16x16x64_bf16 v[60:63], v[24:27], v[232:239], v3
  v_smfmac_f32_16x16x64_bf16 v[36:39], v[28:31], a[40:47], v3
  v_smfmac_f32_16x16x64_bf16 v[40:43], v[28:31], a[96:103], v3
  v_smfmac_f32_16x16x64_bf16 v[44:47], v[28:31], a[152:159], v3
  v_smfmac_f32_16x16x64_bf16 v[48:51], v[28:31], a[208:215], v3
  v_smfmac_f32_16x16x64_bf16 v[52:55], v[28:31], v[128:135], v3
  v_smfmac_f32_16x16x64_bf16 v[56:59], v[28:31], v[184:191], v3
  v_smfmac_f32_16x16x64_bf16 v[60:63], v[28:31], v[240:247], v3
  v_smfmac_f32_16x16x64_bf16 v[36:39], v[32:35], a[48:55], v3
  v_smfmac_f32_16x16x64_bf16 v[40:43], v[32:35], a[104:111], v3
  v_smfmac_f32_16x16x64_bf16 v[44:47], v[32:35], a[160:167], v3
  v_smfmac_f32_16x16x64_bf16 v[48:51], v[32:35], a[216:223], v3
  v_smfmac_f32_16x16x64_bf16 v[52:55], v[32:35], v[136:143], v3
  v_smfmac_f32_16x16x64_bf16 v[56:59], v[32:35], v[192:199], v3
  v_smfmac_f32_16x16x64_bf16 v[60:63], v[32:35], v[248:255], v3
  v_permlane32_swap_b32 v36, v38
  v_permlane32_swap_b32 v37, v39
  v_add_f32 v36, v36, v38
  v_add_f32 v37, v37, v39
  v_cvt_pk_bf16_f32 v38, v36, v37
  ds_write_b32 v104, v38
  v_permlane32_swap_b32 v40, v42
  v_permlane32_swap_b32 v41, v43
  v_add_f32 v40, v40, v42
  v_add_f32 v41, v41, v43
  v_cvt_pk_bf16_f32 v42, v40, v41
  ds_write_b32 v105, v42
  v_permlane32_swap_b32 v44, v46
  v_permlane32_swap_b32 v45, v47
  v_add_f32 v44, v44, v46
  v_add_f32 v45, v45, v47
  v_cvt_pk_bf16_f32 v46, v44, v45
  ds_write_b32 v106, v46
  v_permlane32_swap_b32 v48, v50
  v_permlane32_swap_b32 v49, v51
  v_add_f32 v48, v48, v50
  v_add_f32 v49, v49, v51
  v_cvt_pk_bf16_f32 v50, v48, v49
  ds_write_b32 v107, v50
  v_permlane32_swap_b32 v52, v54
  v_permlane32_swap_b32 v53, v55
  v_add_f32 v52, v52, v54
  v_add_f32 v53, v53, v55
  v_cvt_pk_bf16_f32 v54, v52, v53
  ds_write_b32 v108, v54
  v_permlane32_swap_b32 v56, v58
  v_permlane32_swap_b32 v57, v59
  v_add_f32 v56, v56, v58
  v_add_f32 v57, v57, v59
  v_cvt_pk_bf16_f32 v58, v56, v57
  ds_write_b32 v109, v58
  v_permlane32_swap_b32 v60, v62
  v_permlane32_swap_b32 v61, v63
  v_add_f32 v60, v60, v62
  v_add_f32 v61, v61, v63
  v_cvt_pk_bf16_f32 v62, v60, v61
  ds_write_b32 v110, v62
  s_branch cA_va3_t2d
cA_va3_vor:
  s_sleep 2
  buffer_load_dword v101, off, s[8:11], s27 sc1
  s_add_u32 s30, s30, 1
  s_cmp_lt_u32 s30, 400000
  s_cbranch_scc1 cA_va3_vow
  s_branch cA_abort
cA_abort:
  v_mov_b32 v4, 0xdead
  v_mov_b32 v5, 16
  buffer_store_dword v4, v5, s[12:15], 0 offen
  s_branch ch_end
cA_done:
  s_branch ch_end
.p2align 6
cB_sc0_loop:
  s_mov_b32 s30, 0
  s_mov_b32 s62, 0
  s_setprio 3
  s_sleep 6
  buffer_load_dword v76, v0, s[8:11], 0 offen sc1
  buffer_load_dword v77, v0, s[8:11], 0 offen sc1
  buffer_load_dword v78, v0, s[8:11], 0 offen sc1
cB_sc0_fp_l:
  s_waitcnt vmcnt(2)
  v_cmp_gt_u32 vcc, s19, v76
  s_cbranch_vccz cB_sc0_fp_d
  buffer_load_dword v76, v0, s[8:11], 0 offen sc1
  s_waitcnt vmcnt(2)
  v_cmp_gt_u32 vcc, s19, v77
  s_cbranch_vccz cB_sc0_fp_d
  buffer_load_dword v77, v0, s[8:11], 0 offen sc1
  s_waitcnt vmcnt(2)
  v_cmp_gt_u32 vcc, s19, v78
  s_cbranch_vccz cB_sc0_fp_d
  buffer_load_dword v78, v0, s[8:11], 0 offen sc1
  s_add_u32 s30, s30, 1
  s_cmp_lt_u32 s30, 400000
  s_cbranch_scc1 cB_sc0_fp_l
  s_branch cB_abort
cB_sc0_fp_d:
  buffer_load_dwordx4 v[8:11], v2, s[8:11], s20 offen offset:0 sc1
  s_barrier
  s_setprio 2
  buffer_load_dwordx4 v[12:15], v2, s[8:11], s20 offen offset:1024 sc1
  s_setprio 1
  buffer_load_dwordx4 v[16:19], v2, s[8:11], s20 offen offset:2048 sc1
  s_setprio 0
  buffer_load_dwordx4 v[20:23], v2, s[8:11], s20 offen offset:3072 sc1
cB_sc0_go:
  s_waitcnt vmcnt(3)
  v_smfmac_f32_16x16x64_bf16 v[36:39], v[8:11], a[0:7], v3
  buffer_load_dwordx4 v[32:35], v2, s[8:11], s23 offen offset:0 sc1
  v_cmp_eq_u32 vcc, -1, v8
  v_smfmac_f32_16x16x64_bf16 v[40:43], v[8:11], a[56:63], v3
  v_smfmac_f32_16x16x64_bf16 v[44:47], v[8:11], a[112:119], v3
  buffer_load_dwordx4 v[24:27], v2, s[8:11], s23 offen offset:1024 sc1
  s_cbranch_vccnz cB_sc0_r0
  v_smfmac_f32_16x16x64_bf16 v[48:51], v[8:11], a[168:175], v3
  v_smfmac_f32_16x16x64_bf16 v[52:55], v[8:11], a[224:231], v3
  s_waitcnt vmcnt(4)
  v_cmp_eq_u32 vcc, -1, v12
  v_smfmac_f32_16x16x64_bf16 v[56:59], v[8:11], v[144:151], v3
  buffer_load_dwordx4 v[28:31], v2, s[8:11], s23 offen offset:2048 sc1
  v_smfmac_f32_16x16x64_bf16 v[60:63], v[8:11], v[200:207], v3
  s_cbranch_vccnz cB_sc0_r1
cB_sc0_c1:
  v_smfmac_f32_16x16x64_bf16 v[36:39], v[12:15], a[8:15], v3
  v_smfmac_f32_16x16x64_bf16 v[40:43], v[12:15], a[64:71], v3
  v_smfmac_f32_16x16x64_bf16 v[44:47], v[12:15], a[120:127], v3
  v_smfmac_f32_16x16x64_bf16 v[48:51], v[12:15], a[176:183], v3
  v_smfmac_f32_16x16x64_bf16 v[52:55], v[12:15], a[232:239], v3
  s_waitcnt vmcnt(4)
  v_cmp_eq_u32 vcc, -1, v16
  v_smfmac_f32_16x16x64_bf16 v[56:59], v[12:15], v[152:159], v3
  buffer_load_dwordx4 v[88:91], v117, s[8:11], s26 offen offset:0 sc1
  v_smfmac_f32_16x16x64_bf16 v[60:63], v[12:15], v[208:215], v3
  s_cbranch_vccnz cB_sc0_r2
cB_sc0_c2:
  v_smfmac_f32_16x16x64_bf16 v[36:39], v[16:19], a[16:23], v3
  v_smfmac_f32_16x16x64_bf16 v[40:43], v[16:19], a[72:79], v3
  v_smfmac_f32_16x16x64_bf16 v[44:47], v[16:19], a[128:135], v3
  buffer_load_dwordx4 v[92:95], v117, s[8:11], s26 offen offset:1024 sc1
  v_smfmac_f32_16x16x64_bf16 v[48:51], v[16:19], a[184:191], v3
  v_smfmac_f32_16x16x64_bf16 v[52:55], v[16:19], a[240:247], v3
  s_waitcnt vmcnt(5)
  v_cmp_eq_u32 vcc, -1, v20
  v_smfmac_f32_16x16x64_bf16 v[56:59], v[16:19], v[160:167], v3
  v_smfmac_f32_16x16x64_bf16 v[60:63], v[16:19], v[216:223], v3
  buffer_load_dwordx4 v[96:99], v2, s[8:11], s24 offen offset:0 sc1
  s_cbranch_vccnz cB_sc0_r3
cB_sc0_c3:
  v_smfmac_f32_16x16x64_bf16 v[36:39], v[20:23], a[24:31], v3
  v_smfmac_f32_16x16x64_bf16 v[40:43], v[20:23], a[80:87], v3
  s_waitcnt vmcnt(3)
  v_max3_u32 v66, v24, v27, v28
  v_smfmac_f32_16x16x64_bf16 v[44:47], v[20:23], a[136:143], v3
  v_max3_u32 v66, v66, v31, v32
  v_smfmac_f32_16x16x64_bf16 v[48:51], v[20:23], a[192:199], v3
  buffer_load_dwordx4 v[100:103], v2, s[8:11], s24 offen offset:1024 sc1
  v_max_u32 v66, v66, v35
  v_smfmac_f32_16x16x64_bf16 v[52:55], v[20:23], a[248:255], v3
  v_cmp_eq_u32 vcc, -1, v66
  v_smfmac_f32_16x16x64_bf16 v[56:59], v[20:23], v[168:175], v3
  v_smfmac_f32_16x16x64_bf16 v[60:63], v[20:23], v[224:231], v3
  s_cbranch_vccnz cB_sc0_r4
cB_sc0_c4:
  v_smfmac_f32_16x16x64_bf16 v[60:63], v[32:35], v[232:239], v3
  buffer_load_dwordx4 v[104:107], v2, s[8:11], s26 offen offset:0 sc1
  v_smfmac_f32_16x16x64_bf16 v[60:63], v[24:27], v[240:247], v3
  v_smfmac_f32_16x16x64_bf16 v[60:63], v[28:31], v[248:255], v3
  v_smfmac_f32_16x16x64_bf16 v[52:55], v[32:35], v[120:127], v3
  v_smfmac_f32_16x16x64_bf16 v[52:55], v[24:27], v[128:135], v3
  buffer_load_dwordx4 v[108:111], v2, s[8:11], s26 offen offset:1024 sc1
  v_smfmac_f32_16x16x64_bf16 v[52:55], v[28:31], v[136:143], v3
  v_cvt_pk_bf16_f32 v63, v62, v63
  v_smfmac_f32_16x16x64_bf16 v[56:59], v[32:35], v[176:183], v3
  v_cvt_pk_bf16_f32 v62, v60, v61
  v_smfmac_f32_16x16x64_bf16 v[56:59], v[24:27], v[184:191], v3
  v_mfma_f32_16x16x32_bf16 v[12:15], v[62:65], v[4:7], 0
  v_cvt_pk_bf16_f32 v55, v54, v55
  v_smfmac_f32_16x16x64_bf16 v[56:59], v[28:31], v[192:199], v3
  v_cvt_pk_bf16_f32 v54, v52, v53
  v_smfmac_f32_16x16x64_bf16 v[36:39], v[32:35], a[32:39], v3
  s_nop 1
  v_cvt_pk_bf16_f32 v76, v12, v13
  v_smfmac_f32_16x16x64_bf16 v[36:39], v[24:27], a[40:47], v3
  v_cvt_pk_bf16_f32 v77, v14, v15
  v_smfmac_f32_16x16x64_bf16 v[36:39], v[28:31], a[48:55], v3
  v_cvt_pk_bf16_f32 v56, v56, v57
  v_smfmac_f32_16x16x64_bf16 v[40:43], v[32:35], a[88:95], v3
  v_cvt_pk_bf16_f32 v57, v58, v59
  v_smfmac_f32_16x16x64_bf16 v[40:43], v[24:27], a[96:103], v3
  v_mfma_f32_16x16x32_bf16 v[16:19], v[54:57], v[4:7], 0
  v_cvt_pk_bf16_f32 v39, v38, v39
  v_smfmac_f32_16x16x64_bf16 v[40:43], v[28:31], a[104:111], v3
  v_cvt_pk_bf16_f32 v38, v36, v37
  v_smfmac_f32_16x16x64_bf16 v[44:47], v[32:35], a[144:151], v3
  s_nop 1
  v_cvt_pk_bf16_f32 v78, v16, v17
  v_smfmac_f32_16x16x64_bf16 v[44:47], v[24:27], a[152:159], v3
  v_cvt_pk_bf16_f32 v79, v18, v19
  v_smfmac_f32_16x16x64_bf16 v[44:47], v[28:31], a[160:167], v3
  v_cvt_pk_bf16_f32 v40, v40, v41
  v_smfmac_f32_16x16x64_bf16 v[48:51], v[32:35], a[200:207], v3
  v_cvt_pk_bf16_f32 v41, v42, v43
  v_smfmac_f32_16x16x64_bf16 v[48:51], v[24:27], a[208:215], v3
  v_smfmac_f32_16x16x64_bf16 v[48:51], v[28:31], a[216:223], v3
  s_waitcnt vmcnt(4)
  v_cvt_pk_bf16_f32 v47, v46, v47
  v_smfmac_f32_16x16x64_bf16 v[68:71], v[76:79], v[80:87], v3
  v_cvt_pk_bf16_f32 v46, v44, v45
  v_mfma_f32_16x16x32_bf16 v[12:15], v[38:41], v[4:7], 0
  s_nop 1
  v_cvt_pk_bf16_f32 v48, v48, v49
  v_cvt_pk_bf16_f32 v49, v50, v51
  s_nop 1
  v_mfma_f32_16x16x32_bf16 v[16:19], v[46:49], v[4:7], 0
  v_smfmac_f32_16x16x64_bf16 v[72:75], v[76:79], v[88:95], v3
  v_cvt_pk_bf16_f32 v20, v12, v13
  v_mfma_f32_16x16x32_bf16 v[52:55], v[30:33], v[76:79], 0
  s_waitcnt vmcnt(0)
  v_cvt_pk_bf16_f32 v21, v14, v15
  v_cvt_pk_bf16_f32 v22, v16, v17
  v_cvt_pk_bf16_f32 v23, v18, v19
  s_nop 1
  v_smfmac_f32_16x16x64_bf16 v[68:71], v[20:23], v[96:103], v3
  v_mfma_f32_16x16x32_bf16 v[52:55], v[8:11], v[20:23], v[52:55]
  v_smfmac_f32_16x16x64_bf16 v[72:75], v[20:23], v[104:111], v3
  s_nop 1
  v_permlane32_swap_b32 v68, v70
  v_permlane32_swap_b32 v69, v71
  v_add_f32 v56, v68, v70
  v_add_f32 v58, v69, v71
  ds_write_b128 v113, v[52:55]
  s_nop 0
  v_permlane32_swap_b32 v72, v74
  v_permlane32_swap_b32 v73, v75
  v_add_f32 v57, v72, v74
  v_add_f32 v59, v73, v75
  ds_write_b128 v2, v[56:59] offset:0
  v_cmp_u_f32 vcc, v57, v59
  v_mov_b32 v36, 0
  v_mov_b32 v37, 0
  v_mov_b32 v38, 0
  v_mov_b32 v39, 0
  s_cbranch_vccnz cB_sc0_retry
cB_sc0_cont:
  s_add_u32 s24, s24, 28672
  s_add_u32 s26, s26, 28672
  buffer_load_dwordx4 v[80:83], v117, s[8:11], s24 offen offset:0 sc1
  buffer_load_dwordx4 v[84:87], v117, s[8:11], s24 offen offset:1024 sc1
  v_mov_b32 v40, 0
  v_mov_b32 v41, 0
  v_mov_b32 v42, 0
  v_mov_b32 v43, 0
  v_mov_b32 v44, 0
  v_mov_b32 v45, 0
  v_mov_b32 v46, 0
  v_mov_b32 v47, 0
  v_mov_b32 v48, 0
  v_mov_b32 v49, 0
  v_mov_b32 v50, 0
  v_mov_b32 v51, 0
  s_waitcnt lgkmcnt(0)
  s_barrier
  ds_read_b64 v[8:9], v114 offset:0
  ds_read_b64 v[10:11], v114 offset:1024
  ds_read_b64 v[12:13], v114 offset:2048
  ds_read_b64 v[14:15], v114 offset:3072
  ds_read2_b32 v[16:17], v115 offset0:0 offset1:64
  ds_read2_b32 v[18:19], v115 offset0:128 offset1:192
  s_waitcnt lgkmcnt(0)
  v_pk_add_f32 v[16:17], v[16:17], v[18:19]
  v_pk_add_f32 v[8:9], v[8:9], v[10:11]
  v_pk_add_f32 v[12:13], v[12:13], v[14:15]
  v_add_f32 v20, v16, v17
  v_pk_add_f32 v[8:9], v[8:9], v[12:13]
  v_max_f32 v22, v8, v9
  v_add_f32_dpp v20, v20, v20 row_ror:8 row_mask:0xf bank_mask:0xf
  s_nop 0
  v_max_f32_dpp v22, v22, v22 row_ror:8 row_mask:0xf bank_mask:0xf
  v_max_f32 v22, v22, v20
  s_nop 1
  v_max_f32_dpp v22, v22, v22 quad_perm:[1,0,3,2] row_mask:0xf bank_mask:0xf
  s_nop 1
  v_max_f32_dpp v22, v22, v22 quad_perm:[2,3,0,1] row_mask:0xf bank_mask:0xf
  s_nop 1
  v_max_f32_dpp v22, v22, v22 row_half_mirror row_mask:0xf bank_mask:0xf
  v_pk_add_f32 v[8:9], v[8:9], v[22:23] op_sel_hi:[1,0] neg_lo:[0,1] neg_hi:[0,1]
  v_sub_f32 v20, v20, v22
  v_exp_f32 v8, v8
  v_exp_f32 v9, v9
  v_exp_f32 v20, v20
  v_add_f32 v24, v8, v9
  v_fmac_f32 v24, 0.5, v20
  v_mov_b32_dpp v21, v20 quad_perm:[1,0,3,2] row_mask:0xf bank_mask:0xf
  s_nop 0
  v_add_f32_dpp v24, v24, v24 quad_perm:[1,0,3,2] row_mask:0xf bank_mask:0xf
  s_nop 1
  v_add_f32_dpp v24, v24, v24 quad_perm:[2,3,0,1] row_mask:0xf bank_mask:0xf
  s_nop 1
  v_add_f32_dpp v24, v24, v24 row_half_mirror row_mask:0xf bank_mask:0xf
  s_nop 1
  v_add_f32_dpp v24, v24, v24 row_ror:8 row_mask:0xf bank_mask:0xf
  v_rcp_f32 v24, v24
  s_nop 0
  v_pk_mul_f32 v[8:9], v[8:9], v[24:25] op_sel_hi:[1,0]
  v_pk_mul_f32 v[20:21], v[20:21], v[24:25] op_sel_hi:[1,0]
  v_cvt_pk_bf16_f32 v8, v8, v9
  v_cvt_pk_bf16_f32 v20, v20, v21
  v_min_u32 v8, -2, v8
  buffer_store_dword v8, v1, s[8:11], s20 offen sc1
  v_min_u32 v20, -2, v20
  buffer_store_dword v20, v118, s[8:11], s20 offen sc1
  buffer_store_dword v119, v1, s[8:11], s21 offen sc1
  buffer_store_dword v119, v118, s[8:11], s21 offen sc1
  v_mov_b32 v60, 0
  v_mov_b32 v61, 0
  v_mov_b32 v62, 0
  v_mov_b32 v63, 0
  v_mov_b32 v68, 0
  v_mov_b32 v69, 0
  v_mov_b32 v70, 0
  v_mov_b32 v71, 0
  v_mov_b32 v72, 0
  v_mov_b32 v73, 0
  v_mov_b32 v74, 0
  v_mov_b32 v75, 0
  v_mov_b32 v52, 0
  v_mov_b32 v53, 0
  v_mov_b32 v54, 0
  v_mov_b32 v55, 0
  v_mov_b32 v56, 0
  v_mov_b32 v57, 0
  v_mov_b32 v58, 0
  v_mov_b32 v59, 0
  s_mov_b32 s19, s18
  s_add_u32 s18, s18, 1
  s_mov_b32 s22, s20
  s_mov_b32 s20, s21
  s_mov_b32 s21, s22
  s_add_u32 s23, s20, 4096
  s_cmp_lt_u32 s19, 63
  s_cbranch_scc1 cB_sc0_loop
  s_branch cB_done
cB_sc0_r0:
  s_add_u32 s31, s31, 1
  buffer_load_dwordx4 v[8:11], v2, s[8:11], s20 offen offset:0 sc1
  s_waitcnt vmcnt(0)
  v_cmp_eq_u32 vcc, -1, v8
  v_mov_b32 v36, 0
  v_mov_b32 v37, 0
  v_mov_b32 v38, 0
  v_mov_b32 v39, 0
  v_mov_b32 v40, 0
  v_mov_b32 v41, 0
  v_mov_b32 v42, 0
  v_mov_b32 v43, 0
  v_mov_b32 v44, 0
  v_mov_b32 v45, 0
  v_mov_b32 v46, 0
  v_mov_b32 v47, 0
  v_mov_b32 v48, 0
  v_mov_b32 v49, 0
  v_mov_b32 v50, 0
  v_mov_b32 v51, 0
  s_nop 1
  s_cbranch_vccz cB_sc0_go
  s_add_u32 s30, s30, 1
  s_cmp_lt_u32 s30, 400000
  s_cbranch_scc1 cB_sc0_r0
  s_branch cB_abort
cB_sc0_r1:
  s_add_u32 s31, s31, 1
  buffer_load_dwordx4 v[12:15], v2, s[8:11], s20 offen offset:1024 sc1
  s_waitcnt vmcnt(0)
  v_cmp_eq_u32 vcc, -1, v12
  s_nop 4
  s_cbranch_vccz cB_sc0_c1
  s_add_u32 s30, s30, 1
  s_cmp_lt_u32 s30, 400000
  s_cbranch_scc1 cB_sc0_r1
  s_branch cB_abort
cB_sc0_r2:
  s_add_u32 s31, s31, 1
  buffer_load_dwordx4 v[16:19], v2, s[8:11], s20 offen offset:2048 sc1
  s_waitcnt vmcnt(0)
  v_cmp_eq_u32 vcc, -1, v16
  s_nop 4
  s_cbranch_vccz cB_sc0_c2
  s_add_u32 s30, s30, 1
  s_cmp_lt_u32 s30, 400000
  s_cbranch_scc1 cB_sc0_r2
  s_branch cB_abort
cB_sc0_r3:
  s_add_u32 s31, s31, 1
  buffer_load_dwordx4 v[20:23], v2, s[8:11], s20 offen offset:3072 sc1
  s_waitcnt vmcnt(0)
  v_cmp_eq_u32 vcc, -1, v20
  s_nop 4
  s_cbranch_vccz cB_sc0_c3
  s_add_u32 s30, s30, 1
  s_cmp_lt_u32 s30, 400000
  s_cbranch_scc1 cB_sc0_r3
  s_branch cB_abort
cB_sc0_r4:
  s_add_u32 s31, s31, 1
  buffer_load_dwordx4 v[32:35], v2, s[8:11], s23 offen offset:0 sc1
  buffer_load_dwordx4 v[24:27], v2, s[8:11], s23 offen offset:1024 sc1
  buffer_load_dwordx4 v[28:31], v2, s[8:11], s23 offen offset:2048 sc1
  s_waitcnt vmcnt(0)
  v_max3_u32 v66, v24, v27, v28
  v_max3_u32 v66, v66, v31, v32
  v_max_u32 v66, v66, v35
  v_cmp_eq_u32 vcc, -1, v66
  s_nop 4
  s_cbranch_vccz cB_sc0_c4
  s_add_u32 s30, s30, 1
  s_cmp_lt_u32 s30, 400000
  s_cbranch_scc1 cB_sc0_r4
  s_branch cB_abort
cB_sc0_retry:
  s_cmp_lg_u32 s62, 0
  s_cbranch_scc1 cB_sc0_cont
  s_waitcnt vmcnt(0) lgkmcnt(0)
cB_sc0_rv:
  buffer_load_dwordx4 v[8:11], v2, s[8:11], s20 offen offset:0 sc1
  buffer_load_dwordx4 v[12:15], v2, s[8:11], s20 offen offset:1024 sc1
  buffer_load_dwordx4 v[16:19], v2, s[8:11], s20 offen offset:2048 sc1
  buffer_load_dwordx4 v[20:23], v2, s[8:11], s20 offen offset:3072 sc1
  buffer_load_dwordx4 v[32:35], v2, s[8:11], s23 offen offset:0 sc1
  buffer_load_dwordx4 v[24:27], v2, s[8:11], s23 offen offset:1024 sc1
  buffer_load_dwordx4 v[28:31], v2, s[8:11], s23 offen offset:2048 sc1
  s_waitcnt vmcnt(0)
  v_pk_max_u16 v66, v8, v9
  v_pk_max_u16 v66, v66, v10
  v_pk_max_u16 v66, v66, v11
  v_pk_max_u16 v66, v66, v12
  v_pk_max_u16 v66, v66, v13
  v_pk_max_u16 v66, v66, v14
  v_pk_max_u16 v66, v66, v15
  v_pk_max_u16 v66, v66, v16
  v_pk_max_u16 v66, v66, v17
  v_pk_max_u16 v66, v66, v18
  v_pk_max_u16 v66, v66, v19
  v_pk_max_u16 v66, v66, v20
  v_pk_max_u16 v66, v66, v21
  v_pk_max_u16 v66, v66, v22
  v_pk_max_u16 v66, v66, v23
  v_pk_max_u16 v66, v66, v24
  v_pk_max_u16 v66, v66, v25
  v_pk_max_u16 v66, v66, v26
  v_pk_max_u16 v66, v66, v27
  v_pk_max_u16 v66, v66, v28
  v_pk_max_u16 v66, v66, v29
  v_pk_max_u16 v66, v66, v30
  v_pk_max_u16 v66, v66, v31
  v_pk_max_u16 v66, v66, v32
  v_pk_max_u16 v66, v66, v33
  v_pk_max_u16 v66, v66, v34
  v_pk_max_u16 v66, v66, v35
  v_lshlrev_b32 v67, 16, v66
  v_max_u32 v66, v66, v67
  v_cmp_le_u32 vcc, 0xffff0000, v66
  s_cbranch_vccz cB_sc0_rk
  s_add_u32 s30, s30, 1
  s_cmp_lt_u32 s30, 400000
  s_cbranch_scc1 cB_sc0_rv
  s_branch cB_abort
cB_sc0_rk:
  s_mov_b32 s62, 1
  v_mov_b32 v36, 0
  v_mov_b32 v37, 0
  v_mov_b32 v38, 0
  v_mov_b32 v39, 0
  v_mov_b32 v40, 0
  v_mov_b32 v41, 0
  v_mov_b32 v42, 0
  v_mov_b32 v43, 0
  v_mov_b32 v44, 0
  v_mov_b32 v45, 0
  v_mov_b32 v46, 0
  v_mov_b32 v47, 0
  v_mov_b32 v48, 0
  v_mov_b32 v49, 0
  v_mov_b32 v50, 0
  v_mov_b32 v51, 0
  v_mov_b32 v60, 0
  v_mov_b32 v61, 0
  v_mov_b32 v62, 0
  v_mov_b32 v63, 0
  v_mov_b32 v68, 0
  v_mov_b32 v69, 0
  v_mov_b32 v70, 0
  v_mov_b32 v71, 0
  v_mov_b32 v72, 0
  v_mov_b32 v73, 0
  v_mov_b32 v74, 0
  v_mov_b32 v75, 0
  v_mov_b32 v52, 0
  v_mov_b32 v53, 0
  v_mov_b32 v54, 0
  v_mov_b32 v55, 0
  v_mov_b32 v56, 0
  v_mov_b32 v57, 0
  v_mov_b32 v58, 0
  v_mov_b32 v59, 0
  s_add_u32 s31, s31, 0x100
  s_nop 0
  s_branch cB_sc0_go
.p2align 6
cB_sc1_loop:
  s_mov_b32 s30, 0
  s_mov_b32 s62, 0
  s_setprio 3
  s_barrier
  buffer_load_dwordx4 v[8:11], v2, s[8:11], s20 offen offset:0 sc1
  s_setprio 2
  buffer_load_dwordx4 v[12:15], v2, s[8:11], s20 offen offset:1024 sc1
  s_setprio 1
  buffer_load_dwordx4 v[16:19], v2, s[8:11], s20 offen offset:2048 sc1
  s_setprio 0
  buffer_load_dwordx4 v[20:23], v2, s[8:11], s20 offen offset:3072 sc1
cB_sc1_go:
  s_waitcnt vmcnt(3)
  v_smfmac_f32_16x16x64_bf16 v[36:39], v[8:11], a[0:7], v3
  buffer_load_dwordx4 v[28:31], v2, s[8:11], s23 offen offset:0 sc1
  v_cmp_eq_u32 vcc, -1, v8
  v_smfmac_f32_16x16x64_bf16 v[40:43], v[8:11], a[56:63], v3
  v_smfmac_f32_16x16x64_bf16 v[44:47], v[8:11], a[112:119], v3
  buffer_load_dwordx4 v[24:27], v2, s[8:11], s23 offen offset:1024 sc1
  s_cbranch_vccnz cB_sc1_r0
  v_smfmac_f32_16x16x64_bf16 v[48:51], v[8:11], a[168:175], v3
  v_smfmac_f32_16x16x64_bf16 v[52:55], v[8:11], a[224:231], v3
  s_waitcnt vmcnt(4)
  v_cmp_eq_u32 vcc, -1, v12
  v_smfmac_f32_16x16x64_bf16 v[56:59], v[8:11], v[144:151], v3
  buffer_load_dwordx4 v[32:35], v2, s[8:11], s23 offen offset:2048 sc1
  v_smfmac_f32_16x16x64_bf16 v[60:63], v[8:11], v[200:207], v3
  s_cbranch_vccnz cB_sc1_r1
cB_sc1_c1:
  v_smfmac_f32_16x16x64_bf16 v[36:39], v[12:15], a[8:15], v3
  v_smfmac_f32_16x16x64_bf16 v[40:43], v[12:15], a[64:71], v3
  v_smfmac_f32_16x16x64_bf16 v[44:47], v[12:15], a[120:127], v3
  v_smfmac_f32_16x16x64_bf16 v[48:51], v[12:15], a[176:183], v3
  v_smfmac_f32_16x16x64_bf16 v[52:55], v[12:15], a[232:239], v3
  s_waitcnt vmcnt(4)
  v_cmp_eq_u32 vcc, -1, v16
  v_smfmac_f32_16x16x64_bf16 v[56:59], v[12:15], v[152:159], v3
  buffer_load_dwordx4 v[88:91], v117, s[8:11], s26 offen offset:0 sc1
  v_smfmac_f32_16x16x64_bf16 v[60:63], v[12:15], v[208:215], v3
  s_cbranch_vccnz cB_sc1_r2
cB_sc1_c2:
  v_smfmac_f32_16x16x64_bf16 v[36:39], v[16:19], a[16:23], v3
  v_smfmac_f32_16x16x64_bf16 v[40:43], v[16:19], a[72:79], v3
  v_smfmac_f32_16x16x64_bf16 v[44:47], v[16:19], a[128:135], v3
  buffer_load_dwordx4 v[92:95], v117, s[8:11], s26 offen offset:1024 sc1
  v_smfmac_f32_16x16x64_bf16 v[48:51], v[16:19], a[184:191], v3
  v_smfmac_f32_16x16x64_bf16 v[52:55], v[16:19], a[240:247], v3
  s_waitcnt vmcnt(5)
  v_cmp_eq_u32 vcc, -1, v20
  v_smfmac_f32_16x16x64_bf16 v[56:59], v[16:19], v[160:167], v3
  v_smfmac_f32_16x16x64_bf16 v[60:63], v[16:19], v[216:223], v3
  buffer_load_dwordx4 v[96:99], v2, s[8:11], s24 offen offset:0 sc1
  s_cbranch_vccnz cB_sc1_r3
cB_sc1_c3:
  v_smfmac_f32_16x16x64_bf16 v[36:39], v[20:23], a[24:31], v3
  v_smfmac_f32_16x16x64_bf16 v[40:43], v[20:23], a[80:87], v3
  s_waitcnt vmcnt(3)
  v_max3_u32 v66, v24, v27, v28
  v_smfmac_f32_16x16x64_bf16 v[44:47], v[20:23], a[136:143], v3
  v_max3_u32 v66, v66, v31, v32
  v_smfmac_f32_16x16x64_bf16 v[48:51], v[20:23], a[192:199], v3
  buffer_load_dwordx4 v[100:103], v2, s[8:11], s24 offen offset:1024 sc1
  v_max_u32 v66, v66, v35
  v_smfmac_f32_16x16x64_bf16 v[52:55], v[20:23], a[248:255], v3
  v_cmp_eq_u32 vcc, -1, v66
  v_smfmac_f32_16x16x64_bf16 v[56:59], v[20:23], v[168:175], v3
  v_smfmac_f32_16x16x64_bf16 v[60:63], v[20:23], v[224:231], v3
  s_cbranch_vccnz cB_sc1_r4
cB_sc1_c4:
  v_smfmac_f32_16x16x64_bf16 v[60:63], v[28:31], v[232:239], v3
  buffer_load_dwordx4 v[104:107], v2, s[8:11], s26 offen offset:0 sc1
  v_smfmac_f32_16x16x64_bf16 v[60:63], v[24:27], v[240:247], v3
  v_smfmac_f32_16x16x64_bf16 v[60:63], v[32:35], v[248:255], v3
  v_smfmac_f32_16x16x64_bf16 v[52:55], v[28:31], v[120:127], v3
  v_smfmac_f32_16x16x64_bf16 v[52:55], v[24:27], v[128:135], v3
  buffer_load_dwordx4 v[108:111], v2, s[8:11], s26 offen offset:1024 sc1
  v_smfmac_f32_16x16x64_bf16 v[52:55], v[32:35], v[136:143], v3
  v_cvt_pk_bf16_f32 v63, v62, v63
  v_smfmac_f32_16x16x64_bf16 v[56:59], v[28:31], v[176:183], v3
  v_cvt_pk_bf16_f32 v62, v60, v61
  v_smfmac_f32_16x16x64_bf16 v[56:59], v[24:27], v[184:191], v3
  v_mfma_f32_16x16x32_bf16 v[8:11], v[62:65], v[4:7], 0
  v_cvt_pk_bf16_f32 v55, v54, v55
  v_smfmac_f32_16x16x64_bf16 v[56:59], v[32:35], v[192:199], v3
  v_cvt_pk_bf16_f32 v54, v52, v53
  v_smfmac_f32_16x16x64_bf16 v[36:39], v[28:31], a[32:39], v3
  s_nop 1
  v_cvt_pk_bf16_f32 v78, v8, v9
  v_smfmac_f32_16x16x64_bf16 v[36:39], v[24:27], a[40:47], v3
  v_cvt_pk_bf16_f32 v79, v10, v11
  v_smfmac_f32_16x16x64_bf16 v[36:39], v[32:35], a[48:55], v3
  v_cvt_pk_bf16_f32 v56, v56, v57
  v_smfmac_f32_16x16x64_bf16 v[40:43], v[28:31], a[88:95], v3
  v_cvt_pk_bf16_f32 v57, v58, v59
  v_smfmac_f32_16x16x64_bf16 v[40:43], v[24:27], a[96:103], v3
  v_mfma_f32_16x16x32_bf16 v[16:19], v[54:57], v[4:7], 0
  v_cvt_pk_bf16_f32 v39, v38, v39
  v_smfmac_f32_16x16x64_bf16 v[40:43], v[32:35], a[104:111], v3
  v_cvt_pk_bf16_f32 v38, v36, v37
  v_smfmac_f32_16x16x64_bf16 v[44:47], v[28:31], a[144:151], v3
  s_nop 1
  v_cvt_pk_bf16_f32 v76, v16, v17
  v_smfmac_f32_16x16x64_bf16 v[44:47], v[24:27], a[152:159], v3
  v_cvt_pk_bf16_f32 v77, v18, v19
  v_smfmac_f32_16x16x64_bf16 v[44:47], v[32:35], a[160:167], v3
  v_cvt_pk_bf16_f32 v40, v40, v41
  v_smfmac_f32_16x16x64_bf16 v[48:51], v[28:31], a[200:207], v3
  v_cvt_pk_bf16_f32 v41, v42, v43
  v_smfmac_f32_16x16x64_bf16 v[48:51], v[24:27], a[208:215], v3
  v_smfmac_f32_16x16x64_bf16 v[48:51], v[32:35], a[216:223], v3
  s_waitcnt vmcnt(4)
  v_cvt_pk_bf16_f32 v47, v46, v47
  v_smfmac_f32_16x16x64_bf16 v[68:71], v[76:79], v[80:87], v3
  v_cvt_pk_bf16_f32 v46, v44, v45
  v_mfma_f32_16x16x32_bf16 v[8:11], v[38:41], v[4:7], 0
  s_nop 1
  v_cvt_pk_bf16_f32 v48, v48, v49
  v_cvt_pk_bf16_f32 v49, v50, v51
  s_nop 1
  v_mfma_f32_16x16x32_bf16 v[16:19], v[46:49], v[4:7], 0
  v_smfmac_f32_16x16x64_bf16 v[72:75], v[76:79], v[88:95], v3
  v_cvt_pk_bf16_f32 v20, v8, v9
  v_mfma_f32_16x16x32_bf16 v[52:55], v[30:33], v[76:79], 0
  s_waitcnt vmcnt(0)
  v_cvt_pk_bf16_f32 v21, v10, v11
  v_cvt_pk_bf16_f32 v22, v16, v17
  v_cvt_pk_bf16_f32 v23, v18, v19
  s_nop 1
  v_smfmac_f32_16x16x64_bf16 v[68:71], v[20:23], v[96:103], v3
  v_mfma_f32_16x16x32_bf16 v[52:55], v[12:15], v[20:23], v[52:55]
  v_smfmac_f32_16x16x64_bf16 v[72:75], v[20:23], v[104:111], v3
  s_nop 1
  v_permlane32_swap_b32 v68, v70
  v_permlane32_swap_b32 v69, v71
  v_add_f32 v56, v68, v70
  v_add_f32 v58, v69, v71
  ds_write_b128 v113, v[52:55]
  s_nop 0
  v_permlane32_swap_b32 v72, v74
  v_permlane32_swap_b32 v73, v75
  v_add_f32 v57, v72, v74
  v_add_f32 v59, v73, v75
  ds_write_b128 v2, v[56:59] offset:1024
  v_cmp_u_f32 vcc, v57, v59
  v_mov_b32 v36, 0
  v_mov_b32 v37, 0
  v_mov_b32 v38, 0
  v_mov_b32 v39, 0
  s_cbranch_vccnz cB_sc1_retry
cB_sc1_cont:
  s_add_u32 s24, s24, 28672
  s_add_u32 s26, s26, 28672
  buffer_load_dwordx4 v[80:83], v117, s[8:11], s24 offen offset:0 sc1
  buffer_load_dwordx4 v[84:87], v117, s[8:11], s24 offen offset:1024 sc1
  v_mov_b32 v40, 0
  v_mov_b32 v41, 0
  v_mov_b32 v42, 0
  v_mov_b32 v43, 0
  v_mov_b32 v44, 0
  v_mov_b32 v45, 0
  v_mov_b32 v46, 0
  v_mov_b32 v47, 0
  v_mov_b32 v48, 0
  v_mov_b32 v49, 0
  v_mov_b32 v50, 0
  v_mov_b32 v51, 0
  s_waitcnt lgkmcnt(0)
  s_barrier
  ds_read_b64 v[8:9], v114 offset:0
  ds_read_b64 v[10:11], v114 offset:1024
  ds_read_b64 v[12:13], v114 offset:2048
  ds_read_b64 v[14:15], v114 offset:3072
  ds_read2_b32 v[16:17], v115 offset0:0 offset1:64
  ds_read2_b32 v[18:19], v115 offset0:128 offset1:192
  s_waitcnt lgkmcnt(0)
  v_pk_add_f32 v[16:17], v[16:17], v[18:19]
  v_pk_add_f32 v[8:9], v[8:9], v[10:11]
  v_pk_add_f32 v[12:13], v[12:13], v[14:15]
  v_add_f32 v20, v16, v17
  v_pk_add_f32 v[8:9], v[8:9], v[12:13]
  v_max_f32 v22, v8, v9
  v_add_f32_dpp v20, v20, v20 row_ror:8 row_mask:0xf bank_mask:0xf
  s_nop 0
  v_max_f32_dpp v22, v22, v22 row_ror:8 row_mask:0xf bank_mask:0xf
  v_max_f32 v22, v22, v20
  s_nop 1
  v_max_f32_dpp v22, v22, v22 quad_perm:[1,0,3,2] row_mask:0xf bank_mask:0xf
  s_nop 1
  v_max_f32_dpp v22, v22, v22 quad_perm:[2,3,0,1] row_mask:0xf bank_mask:0xf
  s_nop 1
  v_max_f32_dpp v22, v22, v22 row_half_mirror row_mask:0xf bank_mask:0xf
  v_pk_add_f32 v[8:9], v[8:9], v[22:23] op_sel_hi:[1,0] neg_lo:[0,1] neg_hi:[0,1]
  v_sub_f32 v20, v20, v22
  v_exp_f32 v8, v8
  v_exp_f32 v9, v9
  v_exp_f32 v20, v20
  v_add_f32 v24, v8, v9
  v_fmac_f32 v24, 0.5, v20
  v_mov_b32_dpp v21, v20 quad_perm:[1,0,3,2] row_mask:0xf bank_mask:0xf
  s_nop 0
  v_add_f32_dpp v24, v24, v24 quad_perm:[1,0,3,2] row_mask:0xf bank_mask:0xf
  s_nop 1
  v_add_f32_dpp v24, v24, v24 quad_perm:[2,3,0,1] row_mask:0xf bank_mask:0xf
  s_nop 1
  v_add_f32_dpp v24, v24, v24 row_half_mirror row_mask:0xf bank_mask:0xf
  s_nop 1
  v_add_f32_dpp v24, v24, v24 row_ror:8 row_mask:0xf bank_mask:0xf
  v_rcp_f32 v24, v24
  s_nop 0
  v_pk_mul_f32 v[8:9], v[8:9], v[24:25] op_sel_hi:[1,0]
  v_pk_mul_f32 v[20:21], v[20:21], v[24:25] op_sel_hi:[1,0]
  v_cvt_pk_bf16_f32 v8, v8, v9
  v_cvt_pk_bf16_f32 v20, v20, v21
  v_min_u32 v8, -2, v8
  buffer_store_dword v8, v1, s[8:11], s20 offen sc1
  v_min_u32 v20, -2, v20
  buffer_store_dword v20, v118, s[8:11], s20 offen sc1
  buffer_store_dword v119, v1, s[8:11], s21 offen sc1
  buffer_store_dword v119, v118, s[8:11], s21 offen sc1
  v_mov_b32 v60, 0
  v_mov_b32 v61, 0
  v_mov_b32 v62, 0
  v_mov_b32 v63, 0
  v_mov_b32 v68, 0
  v_mov_b32 v69, 0
  v_mov_b32 v70, 0
  v_mov_b32 v71, 0
  v_mov_b32 v72, 0
  v_mov_b32 v73, 0
  v_mov_b32 v74, 0
  v_mov_b32 v75, 0
  v_mov_b32 v52, 0
  v_mov_b32 v53, 0
  v_mov_b32 v54, 0
  v_mov_b32 v55, 0
  v_mov_b32 v56, 0
  v_mov_b32 v57, 0
  v_mov_b32 v58, 0
  v_mov_b32 v59, 0
  s_mov_b32 s19, s18
  s_add_u32 s18, s18, 1
  s_mov_b32 s22, s20
  s_mov_b32 s20, s21
  s_mov_b32 s21, s22
  s_add_u32 s23, s20, 4096
  s_cmp_lt_u32 s19, 63
  s_cbranch_scc1 cB_sc1_loop
  s_branch cB_done
cB_sc1_r0:
  s_add_u32 s31, s31, 1
  buffer_load_dwordx4 v[8:11], v2, s[8:11], s20 offen offset:0 sc1
  s_waitcnt vmcnt(0)
  v_cmp_eq_u32 vcc, -1, v8
  v_mov_b32 v36, 0
  v_mov_b32 v37, 0
  v_mov_b32 v38, 0
  v_mov_b32 v39, 0
  v_mov_b32 v40, 0
  v_mov_b32 v41, 0
  v_mov_b32 v42, 0
  v_mov_b32 v43, 0
  v_mov_b32 v44, 0
  v_mov_b32 v45, 0
  v_mov_b32 v46, 0
  v_mov_b32 v47, 0
  v_mov_b32 v48, 0
  v_mov_b32 v49, 0
  v_mov_b32 v50, 0
  v_mov_b32 v51, 0
  s_nop 1
  s_cbranch_vccz cB_sc1_go
  s_add_u32 s30, s30, 1
  s_cmp_lt_u32 s30, 400000
  s_cbranch_scc1 cB_sc1_r0
  s_branch cB_abort
cB_sc1_r1:
  s_add_u32 s31, s31, 1
  buffer_load_dwordx4 v[12:15], v2, s[8:11], s20 offen offset:1024 sc1
  s_waitcnt vmcnt(0)
  v_cmp_eq_u32 vcc, -1, v12
  s_nop 4
  s_cbranch_vccz cB_sc1_c1
  s_add_u32 s30, s30, 1
  s_cmp_lt_u32 s30, 400000
  s_cbranch_scc1 cB_sc1_r1
  s_branch cB_abort
cB_sc1_r2:
  s_add_u32 s31, s31, 1
  buffer_load_dwordx4 v[16:19], v2, s[8:11], s20 offen offset:2048 sc1
  s_waitcnt vmcnt(0)
  v_cmp_eq_u32 vcc, -1, v16
  s_nop 4
  s_cbranch_vccz cB_sc1_c2
  s_add_u32 s30, s30, 1
  s_cmp_lt_u32 s30, 400000
  s_cbranch_scc1 cB_sc1_r2
  s_branch cB_abort
cB_sc1_r3:
  s_add_u32 s31, s31, 1
  buffer_load_dwordx4 v[20:23], v2, s[8:11], s20 offen offset:3072 sc1
  s_waitcnt vmcnt(0)
  v_cmp_eq_u32 vcc, -1, v20
  s_nop 4
  s_cbranch_vccz cB_sc1_c3
  s_add_u32 s30, s30, 1
  s_cmp_lt_u32 s30, 400000
  s_cbranch_scc1 cB_sc1_r3
  s_branch cB_abort
cB_sc1_r4:
  s_add_u32 s31, s31, 1
  buffer_load_dwordx4 v[28:31], v2, s[8:11], s23 offen offset:0 sc1
  buffer_load_dwordx4 v[24:27], v2, s[8:11], s23 offen offset:1024 sc1
  buffer_load_dwordx4 v[32:35], v2, s[8:11], s23 offen offset:2048 sc1
  s_waitcnt vmcnt(0)
  v_max3_u32 v66, v24, v27, v28
  v_max3_u32 v66, v66, v31, v32
  v_max_u32 v66, v66, v35
  v_cmp_eq_u32 vcc, -1, v66
  s_nop 4
  s_cbranch_vccz cB_sc1_c4
  s_add_u32 s30, s30, 1
  s_cmp_lt_u32 s30, 400000
  s_cbranch_scc1 cB_sc1_r4
  s_branch cB_abort
cB_sc1_retry:
  s_cmp_lg_u32 s62, 0
  s_cbranch_scc1 cB_sc1_cont
  s_waitcnt vmcnt(0) lgkmcnt(0)
cB_sc1_rv:
  buffer_load_dwordx4 v[8:11], v2, s[8:11], s20 offen offset:0 sc1
  buffer_load_dwordx4 v[12:15], v2, s[8:11], s20 offen offset:1024 sc1
  buffer_load_dwordx4 v[16:19], v2, s[8:11], s20 offen offset:2048 sc1
  buffer_load_dwordx4 v[20:23], v2, s[8:11], s20 offen offset:3072 sc1
  buffer_load_dwordx4 v[28:31], v2, s[8:11], s23 offen offset:0 sc1
  buffer_load_dwordx4 v[24:27], v2, s[8:11], s23 offen offset:1024 sc1
  buffer_load_dwordx4 v[32:35], v2, s[8:11], s23 offen offset:2048 sc1
  s_waitcnt vmcnt(0)
  v_pk_max_u16 v66, v8, v9
  v_pk_max_u16 v66, v66, v10
  v_pk_max_u16 v66, v66, v11
  v_pk_max_u16 v66, v66, v12
  v_pk_max_u16 v66, v66, v13
  v_pk_max_u16 v66, v66, v14
  v_pk_max_u16 v66, v66, v15
  v_pk_max_u16 v66, v66, v16
  v_pk_max_u16 v66, v66, v17
  v_pk_max_u16 v66, v66, v18
  v_pk_max_u16 v66, v66, v19
  v_pk_max_u16 v66, v66, v20
  v_pk_max_u16 v66, v66, v21
  v_pk_max_u16 v66, v66, v22
  v_pk_max_u16 v66, v66, v23
  v_pk_max_u16 v66, v66, v24
  v_pk_max_u16 v66, v66, v25
  v_pk_max_u16 v66, v66, v26
  v_pk_max_u16 v66, v66, v27
  v_pk_max_u16 v66, v66, v28
  v_pk_max_u16 v66, v66, v29
  v_pk_max_u16 v66, v66, v30
  v_pk_max_u16 v66, v66, v31
  v_pk_max_u16 v66, v66, v32
  v_pk_max_u16 v66, v66, v33
  v_pk_max_u16 v66, v66, v34
  v_pk_max_u16 v66, v66, v35
  v_lshlrev_b32 v67, 16, v66
  v_max_u32 v66, v66, v67
  v_cmp_le_u32 vcc, 0xffff0000, v66
  s_cbranch_vccz cB_sc1_rk
  s_add_u32 s30, s30, 1
  s_cmp_lt_u32 s30, 400000
  s_cbranch_scc1 cB_sc1_rv
  s_branch cB_abort
cB_sc1_rk:
  s_mov_b32 s62, 1
  v_mov_b32 v36, 0
  v_mov_b32 v37, 0
  v_mov_b32 v38, 0
  v_mov_b32 v39, 0
  v_mov_b32 v40, 0
  v_mov_b32 v41, 0
  v_mov_b32 v42, 0
  v_mov_b32 v43, 0
  v_mov_b32 v44, 0
  v_mov_b32 v45, 0
  v_mov_b32 v46, 0
  v_mov_b32 v47, 0
  v_mov_b32 v48, 0
  v_mov_b32 v49, 0
  v_mov_b32 v50, 0
  v_mov_b32 v51, 0
  v_mov_b32 v60, 0
  v_mov_b32 v61, 0
  v_mov_b32 v62, 0
  v_mov_b32 v63, 0
  v_mov_b32 v68, 0
  v_mov_b32 v69, 0
  v_mov_b32 v70, 0
  v_mov_b32 v71, 0
  v_mov_b32 v72, 0
  v_mov_b32 v73, 0
  v_mov_b32 v74, 0
  v_mov_b32 v75, 0
  v_mov_b32 v52, 0
  v_mov_b32 v53, 0
  v_mov_b32 v54, 0
  v_mov_b32 v55, 0
  v_mov_b32 v56, 0
  v_mov_b32 v57, 0
  v_mov_b32 v58, 0
  v_mov_b32 v59, 0
  s_add_u32 s31, s31, 0x100
  s_nop 0
  s_branch cB_sc1_go
.p2align 6
cB_sc2_loop:
  s_mov_b32 s30, 0
  s_mov_b32 s62, 0
  s_setprio 3
  s_barrier
  buffer_load_dwordx4 v[8:11], v2, s[8:11], s20 offen offset:0 sc1
  s_setprio 2
  buffer_load_dwordx4 v[12:15], v2, s[8:11], s20 offen offset:1024 sc1
  s_setprio 1
  buffer_load_dwordx4 v[16:19], v2, s[8:11], s20 offen offset:2048 sc1
  s_setprio 0
  buffer_load_dwordx4 v[20:23], v2, s[8:11], s20 offen offset:3072 sc1
cB_sc2_go:
  s_waitcnt vmcnt(3)
  v_smfmac_f32_16x16x64_bf16 v[36:39], v[8:11], a[0:7], v3
  buffer_load_dwordx4 v[24:27], v2, s[8:11], s23 offen offset:0 sc1
  v_cmp_eq_u32 vcc, -1, v8
  v_smfmac_f32_16x16x64_bf16 v[40:43], v[8:11], a[56:63], v3
  v_smfmac_f32_16x16x64_bf16 v[44:47], v[8:11], a[112:119], v3
  buffer_load_dwordx4 v[32:35], v2, s[8:11], s23 offen offset:1024 sc1
  s_cbranch_vccnz cB_sc2_r0
  v_smfmac_f32_16x16x64_bf16 v[48:51], v[8:11], a[168:175], v3
  v_smfmac_f32_16x16x64_bf16 v[52:55], v[8:11], a[224:231], v3
  s_waitcnt vmcnt(4)
  v_cmp_eq_u32 vcc, -1, v12
  v_smfmac_f32_16x16x64_bf16 v[56:59], v[8:11], v[144:151], v3
  buffer_load_dwordx4 v[28:31], v2, s[8:11], s23 offen offset:2048 sc1
  v_smfmac_f32_16x16x64_bf16 v[62:65], v[8:11], v[200:207], v3
  s_cbranch_vccnz cB_sc2_r1
cB_sc2_c1:
  v_smfmac_f32_16x16x64_bf16 v[36:39], v[12:15], a[8:15], v3
  v_smfmac_f32_16x16x64_bf16 v[40:43], v[12:15], a[64:71], v3
  v_smfmac_f32_16x16x64_bf16 v[44:47], v[12:15], a[120:127], v3
  v_smfmac_f32_16x16x64_bf16 v[48:51], v[12:15], a[176:183], v3
  v_smfmac_f32_16x16x64_bf16 v[52:55], v[12:15], a[232:239], v3
  s_waitcnt vmcnt(4)
  v_cmp_eq_u32 vcc, -1, v16
  v_smfmac_f32_16x16x64_bf16 v[56:59], v[12:15], v[152:159], v3
  buffer_load_dwordx4 v[88:91], v117, s[8:11], s26 offen offset:0 sc1
  v_smfmac_f32_16x16x64_bf16 v[62:65], v[12:15], v[208:215], v3
  s_cbranch_vccnz cB_sc2_r2
cB_sc2_c2:
  v_smfmac_f32_16x16x64_bf16 v[36:39], v[16:19], a[16:23], v3
  v_smfmac_f32_16x16x64_bf16 v[40:43], v[16:19], a[72:79], v3
  v_smfmac_f32_16x16x64_bf16 v[44:47], v[16:19], a[128:135], v3
  buffer_load_dwordx4 v[92:95], v117, s[8:11], s26 offen offset:1024 sc1
  v_smfmac_f32_16x16x64_bf16 v[48:51], v[16:19], a[184:191], v3
  v_smfmac_f32_16x16x64_bf16 v[52:55], v[16:19], a[240:247], v3
  s_waitcnt vmcnt(5)
  v_cmp_eq_u32 vcc, -1, v20
  v_smfmac_f32_16x16x64_bf16 v[56:59], v[16:19], v[160:167], v3
  v_smfmac_f32_16x16x64_bf16 v[62:65], v[16:19], v[216:223], v3
  buffer_load_dwordx4 v[96:99], v2, s[8:11], s24 offen offset:0 sc1
  s_cbranch_vccnz cB_sc2_r3
cB_sc2_c3:
  v_smfmac_f32_16x16x64_bf16 v[36:39], v[20:23], a[24:31], v3
  v_smfmac_f32_16x16x64_bf16 v[40:43], v[20:23], a[80:87], v3
  s_waitcnt vmcnt(3)
  v_max3_u32 v66, v24, v27, v28
  v_smfmac_f32_16x16x64_bf16 v[44:47], v[20:23], a[136:143], v3
  v_max3_u32 v66, v66, v31, v32
  v_smfmac_f32_16x16x64_bf16 v[48:51], v[20:23], a[192:199], v3
  buffer_load_dwordx4 v[100:103], v2, s[8:11], s24 offen offset:1024 sc1
  v_max_u32 v66, v66, v35
  v_smfmac_f32_16x16x64_bf16 v[52:55], v[20:23], a[248:255], v3
  v_cmp_eq_u32 vcc, -1, v66
  v_smfmac_f32_16x16x64_bf16 v[56:59], v[20:23], v[168:175], v3
  v_smfmac_f32_16x16x64_bf16 v[62:65], v[20:23], v[224:231], v3
  s_cbranch_vccnz cB_sc2_r4
cB_sc2_c4:
  v_smfmac_f32_16x16x64_bf16 v[62:65], v[24:27], v[232:239], v3
  buffer_load_dwordx4 v[104:107], v2, s[8:11], s26 offen offset:0 sc1
  v_smfmac_f32_16x16x64_bf16 v[62:65], v[32:35], v[240:247], v3
  v_smfmac_f32_16x16x64_bf16 v[62:65], v[28:31], v[248:255], v3
  v_smfmac_f32_16x16x64_bf16 v[52:55], v[24:27], v[120:127], v3
  v_smfmac_f32_16x16x64_bf16 v[52:55], v[32:35], v[128:135], v3
  buffer_load_dwordx4 v[108:111], v2, s[8:11], s26 offen offset:1024 sc1
  v_smfmac_f32_16x16x64_bf16 v[52:55], v[28:31], v[136:143], v3
  v_cvt_pk_bf16_f32 v62, v62, v63
  v_smfmac_f32_16x16x64_bf16 v[56:59], v[24:27], v[176:183], v3
  v_cvt_pk_bf16_f32 v63, v64, v65
  v_smfmac_f32_16x16x64_bf16 v[56:59], v[32:35], v[184:191], v3
  v_mfma_f32_16x16x32_bf16 v[8:11], v[60:63], v[4:7], 0
  v_cvt_pk_bf16_f32 v55, v54, v55
  v_smfmac_f32_16x16x64_bf16 v[56:59], v[28:31], v[192:199], v3
  v_cvt_pk_bf16_f32 v54, v52, v53
  v_smfmac_f32_16x16x64_bf16 v[36:39], v[24:27], a[32:39], v3
  s_nop 1
  v_cvt_pk_bf16_f32 v76, v8, v9
  v_smfmac_f32_16x16x64_bf16 v[36:39], v[32:35], a[40:47], v3
  v_cvt_pk_bf16_f32 v77, v10, v11
  v_smfmac_f32_16x16x64_bf16 v[36:39], v[28:31], a[48:55], v3
  v_cvt_pk_bf16_f32 v56, v56, v57
  v_smfmac_f32_16x16x64_bf16 v[40:43], v[24:27], a[88:95], v3
  v_cvt_pk_bf16_f32 v57, v58, v59
  v_smfmac_f32_16x16x64_bf16 v[40:43], v[32:35], a[96:103], v3
  v_mfma_f32_16x16x32_bf16 v[12:15], v[54:57], v[4:7], 0
  v_cvt_pk_bf16_f32 v39, v38, v39
  v_smfmac_f32_16x16x64_bf16 v[40:43], v[28:31], a[104:111], v3
  v_cvt_pk_bf16_f32 v38, v36, v37
  v_smfmac_f32_16x16x64_bf16 v[44:47], v[24:27], a[144:151], v3
  s_nop 1
  v_cvt_pk_bf16_f32 v78, v12, v13
  v_smfmac_f32_16x16x64_bf16 v[44:47], v[32:35], a[152:159], v3
  v_cvt_pk_bf16_f32 v79, v14, v15
  v_smfmac_f32_16x16x64_bf16 v[44:47], v[28:31], a[160:167], v3
  v_cvt_pk_bf16_f32 v40, v40, v41
  v_smfmac_f32_16x16x64_bf16 v[48:51], v[24:27], a[200:207], v3
  v_cvt_pk_bf16_f32 v41, v42, v43
  v_smfmac_f32_16x16x64_bf16 v[48:51], v[32:35], a[208:215], v3
  v_smfmac_f32_16x16x64_bf16 v[48:51], v[28:31], a[216:223], v3
  s_waitcnt vmcnt(4)
  v_cvt_pk_bf16_f32 v47, v46, v47
  v_smfmac_f32_16x16x64_bf16 v[68:71], v[76:79], v[80:87], v3
  v_cvt_pk_bf16_f32 v46, v44, v45
  v_mfma_f32_16x16x32_bf16 v[8:11], v[38:41], v[4:7], 0
  s_nop 1
  v_cvt_pk_bf16_f32 v48, v48, v49
  v_cvt_pk_bf16_f32 v49, v50, v51
  s_nop 1
  v_mfma_f32_16x16x32_bf16 v[12:15], v[46:49], v[4:7], 0
  v_smfmac_f32_16x16x64_bf16 v[72:75], v[76:79], v[88:95], v3
  v_cvt_pk_bf16_f32 v20, v8, v9
  v_mfma_f32_16x16x32_bf16 v[52:55], v[30:33], v[76:79], 0
  s_waitcnt vmcnt(0)
  v_cvt_pk_bf16_f32 v21, v10, v11
  v_cvt_pk_bf16_f32 v22, v12, v13
  v_cvt_pk_bf16_f32 v23, v14, v15
  s_nop 1
  v_smfmac_f32_16x16x64_bf16 v[68:71], v[20:23], v[96:103], v3
  v_mfma_f32_16x16x32_bf16 v[52:55], v[16:19], v[20:23], v[52:55]
  v_smfmac_f32_16x16x64_bf16 v[72:75], v[20:23], v[104:111], v3
  s_nop 1
  v_permlane32_swap_b32 v68, v70
  v_permlane32_swap_b32 v69, v71
  v_add_f32 v56, v68, v70
  v_add_f32 v58, v69, v71
  ds_write_b128 v113, v[52:55]
  s_nop 0
  v_permlane32_swap_b32 v72, v74
  v_permlane32_swap_b32 v73, v75
  v_add_f32 v57, v72, v74
  v_add_f32 v59, v73, v75
  ds_write_b128 v2, v[56:59] offset:2048
  v_cmp_u_f32 vcc, v57, v59
  v_mov_b32 v36, 0
  v_mov_b32 v37, 0
  v_mov_b32 v38, 0
  v_mov_b32 v39, 0
  s_cbranch_vccnz cB_sc2_retry
cB_sc2_cont:
  s_add_u32 s24, s24, 28672
  s_add_u32 s26, s26, 28672
  buffer_load_dwordx4 v[80:83], v117, s[8:11], s24 offen offset:0 sc1
  buffer_load_dwordx4 v[84:87], v117, s[8:11], s24 offen offset:1024 sc1
  v_mov_b32 v40, 0
  v_mov_b32 v41, 0
  v_mov_b32 v42, 0
  v_mov_b32 v43, 0
  v_mov_b32 v44, 0
  v_mov_b32 v45, 0
  v_mov_b32 v46, 0
  v_mov_b32 v47, 0
  v_mov_b32 v48, 0
  v_mov_b32 v49, 0
  v_mov_b32 v50, 0
  v_mov_b32 v51, 0
  s_waitcnt lgkmcnt(0)
  s_barrier
  v_mov_b32 v62, 0
  v_mov_b32 v63, 0
  v_mov_b32 v64, 0
  v_mov_b32 v65, 0
  v_mov_b32 v68, 0
  v_mov_b32 v69, 0
  v_mov_b32 v70, 0
  v_mov_b32 v71, 0
  v_mov_b32 v72, 0
  v_mov_b32 v73, 0
  v_mov_b32 v74, 0
  v_mov_b32 v75, 0
  v_mov_b32 v52, 0
  v_mov_b32 v53, 0
  v_mov_b32 v54, 0
  v_mov_b32 v55, 0
  v_mov_b32 v56, 0
  v_mov_b32 v57, 0
  v_mov_b32 v58, 0
  v_mov_b32 v59, 0
  v_mov_b32 v66, 0
  v_mov_b32 v66, 0
  v_mov_b32 v66, 0
  v_mov_b32 v66, 0
  v_mov_b32 v66, 0
  v_mov_b32 v66, 0
  v_mov_b32 v66, 0
  v_mov_b32 v66, 0
  v_mov_b32 v66, 0
  v_mov_b32 v66, 0
  buffer_store_dword v119, v1, s[8:11], 0 offen sc1
  s_mov_b32 s19, s18
  s_add_u32 s18, s18, 1
  s_mov_b32 s22, s20
  s_mov_b32 s20, s21
  s_mov_b32 s21, s22
  s_add_u32 s23, s20, 4096
  v_mov_b32 v119, s18
  s_cmp_lt_u32 s19, 63
  s_nop 0
  s_cbranch_scc1 cB_sc2_loop
  s_branch cB_done
cB_sc2_r0:
  s_add_u32 s31, s31, 1
  buffer_load_dwordx4 v[8:11], v2, s[8:11], s20 offen offset:0 sc1
  s_waitcnt vmcnt(0)
  v_cmp_eq_u32 vcc, -1, v8
  v_mov_b32 v36, 0
  v_mov_b32 v37, 0
  v_mov_b32 v38, 0
  v_mov_b32 v39, 0
  v_mov_b32 v40, 0
  v_mov_b32 v41, 0
  v_mov_b32 v42, 0
  v_mov_b32 v43, 0
  v_mov_b32 v44, 0
  v_mov_b32 v45, 0
  v_mov_b32 v46, 0
  v_mov_b32 v47, 0
  v_mov_b32 v48, 0
  v_mov_b32 v49, 0
  v_mov_b32 v50, 0
  v_mov_b32 v51, 0
  s_nop 1
  s_cbranch_vccz cB_sc2_go
  s_add_u32 s30, s30, 1
  s_cmp_lt_u32 s30, 400000
  s_cbranch_scc1 cB_sc2_r0
  s_branch cB_abort
cB_sc2_r1:
  s_add_u32 s31, s31, 1
  buffer_load_dwordx4 v[12:15], v2, s[8:11], s20 offen offset:1024 sc1
  s_waitcnt vmcnt(0)
  v_cmp_eq_u32 vcc, -1, v12
  s_nop 4
  s_cbranch_vccz cB_sc2_c1
  s_add_u32 s30, s30, 1
  s_cmp_lt_u32 s30, 400000
  s_cbranch_scc1 cB_sc2_r1
  s_branch cB_abort
cB_sc2_r2:
  s_add_u32 s31, s31, 1
  buffer_load_dwordx4 v[16:19], v2, s[8:11], s20 offen offset:2048 sc1
  s_waitcnt vmcnt(0)
  v_cmp_eq_u32 vcc, -1, v16
  s_nop 4
  s_cbranch_vccz cB_sc2_c2
  s_add_u32 s30, s30, 1
  s_cmp_lt_u32 s30, 400000
  s_cbranch_scc1 cB_sc2_r2
  s_branch cB_abort
cB_sc2_r3:
  s_add_u32 s31, s31, 1
  buffer_load_dwordx4 v[20:23], v2, s[8:11], s20 offen offset:3072 sc1
  s_waitcnt vmcnt(0)
  v_cmp_eq_u32 vcc, -1, v20
  s_nop 4
  s_cbranch_vccz cB_sc2_c3
  s_add_u32 s30, s30, 1
  s_cmp_lt_u32 s30, 400000
  s_cbranch_scc1 cB_sc2_r3
  s_branch cB_abort
cB_sc2_r4:
  s_add_u32 s31, s31, 1
  buffer_load_dwordx4 v[24:27], v2, s[8:11], s23 offen offset:0 sc1
  buffer_load_dwordx4 v[32:35], v2, s[8:11], s23 offen offset:1024 sc1
  buffer_load_dwordx4 v[28:31], v2, s[8:11], s23 offen offset:2048 sc1
  s_waitcnt vmcnt(0)
  v_max3_u32 v66, v24, v27, v28
  v_max3_u32 v66, v66, v31, v32
  v_max_u32 v66, v66, v35
  v_cmp_eq_u32 vcc, -1, v66
  s_nop 4
  s_cbranch_vccz cB_sc2_c4
  s_add_u32 s30, s30, 1
  s_cmp_lt_u32 s30, 400000
  s_cbranch_scc1 cB_sc2_r4
  s_branch cB_abort
cB_sc2_retry:
  s_cmp_lg_u32 s62, 0
  s_cbranch_scc1 cB_sc2_cont
  s_waitcnt vmcnt(0) lgkmcnt(0)
cB_sc2_rv:
  buffer_load_dwordx4 v[8:11], v2, s[8:11], s20 offen offset:0 sc1
  buffer_load_dwordx4 v[12:15], v2, s[8:11], s20 offen offset:1024 sc1
  buffer_load_dwordx4 v[16:19], v2, s[8:11], s20 offen offset:2048 sc1
  buffer_load_dwordx4 v[20:23], v2, s[8:11], s20 offen offset:3072 sc1
  buffer_load_dwordx4 v[24:27], v2, s[8:11], s23 offen offset:0 sc1
  buffer_load_dwordx4 v[32:35], v2, s[8:11], s23 offen offset:1024 sc1
  buffer_load_dwordx4 v[28:31], v2, s[8:11], s23 offen offset:2048 sc1
  s_waitcnt vmcnt(0)
  v_pk_max_u16 v66, v8, v9
  v_pk_max_u16 v66, v66, v10
  v_pk_max_u16 v66, v66, v11
  v_pk_max_u16 v66, v66, v12
  v_pk_max_u16 v66, v66, v13
  v_pk_max_u16 v66, v66, v14
  v_pk_max_u16 v66, v66, v15
  v_pk_max_u16 v66, v66, v16
  v_pk_max_u16 v66, v66, v17
  v_pk_max_u16 v66, v66, v18
  v_pk_max_u16 v66, v66, v19
  v_pk_max_u16 v66, v66, v20
  v_pk_max_u16 v66, v66, v21
  v_pk_max_u16 v66, v66, v22
  v_pk_max_u16 v66, v66, v23
  v_pk_max_u16 v66, v66, v24
  v_pk_max_u16 v66, v66, v25
  v_pk_max_u16 v66, v66, v26
  v_pk_max_u16 v66, v66, v27
  v_pk_max_u16 v66, v66, v28
  v_pk_max_u16 v66, v66, v29
  v_pk_max_u16 v66, v66, v30
  v_pk_max_u16 v66, v66, v31
  v_pk_max_u16 v66, v66, v32
  v_pk_max_u16 v66, v66, v33
  v_pk_max_u16 v66, v66, v34
  v_pk_max_u16 v66, v66, v35
  v_lshlrev_b32 v67, 16, v66
  v_max_u32 v66, v66, v67
  v_cmp_le_u32 vcc, 0xffff0000, v66
  s_cbranch_vccz cB_sc2_rk
  s_add_u32 s30, s30, 1
  s_cmp_lt_u32 s30, 400000
  s_cbranch_scc1 cB_sc2_rv
  s_branch cB_abort
cB_sc2_rk:
  s_mov_b32 s62, 1
  v_mov_b32 v36, 0
  v_mov_b32 v37, 0
  v_mov_b32 v38, 0
  v_mov_b32 v39, 0
  v_mov_b32 v40, 0
  v_mov_b32 v41, 0
  v_mov_b32 v42, 0
  v_mov_b32 v43, 0
  v_mov_b32 v44, 0
  v_mov_b32 v45, 0
  v_mov_b32 v46, 0
  v_mov_b32 v47, 0
  v_mov_b32 v48, 0
  v_mov_b32 v49, 0
  v_mov_b32 v50, 0
  v_mov_b32 v51, 0
  v_mov_b32 v62, 0
  v_mov_b32 v63, 0
  v_mov_b32 v64, 0
  v_mov_b32 v65, 0
  v_mov_b32 v68, 0
  v_mov_b32 v69, 0
  v_mov_b32 v70, 0
  v_mov_b32 v71, 0
  v_mov_b32 v72, 0
  v_mov_b32 v73, 0
  v_mov_b32 v74, 0
  v_mov_b32 v75, 0
  v_mov_b32 v52, 0
  v_mov_b32 v53, 0
  v_mov_b32 v54, 0
  v_mov_b32 v55, 0
  v_mov_b32 v56, 0
  v_mov_b32 v57, 0
  v_mov_b32 v58, 0
  v_mov_b32 v59, 0
  s_add_u32 s31, s31, 0x100
  s_nop 0
  s_branch cB_sc2_go
.p2align 6
cB_sc3_loop:
  s_mov_b32 s30, 0
  s_mov_b32 s62, 0
  s_setprio 3
  s_barrier
  buffer_load_dwordx4 v[8:11], v2, s[8:11], s20 offen offset:0 sc1
  s_setprio 2
  buffer_load_dwordx4 v[12:15], v2, s[8:11], s20 offen offset:1024 sc1
  s_setprio 1
  buffer_load_dwordx4 v[16:19], v2, s[8:11], s20 offen offset:2048 sc1
  s_setprio 0
  buffer_load_dwordx4 v[20:23], v2, s[8:11], s20 offen offset:3072 sc1
cB_sc3_go:
  s_waitcnt vmcnt(3)
  v_smfmac_f32_16x16x64_bf16 v[36:39], v[8:11], a[0:7], v3
  buffer_load_dwordx4 v[24:27], v2, s[8:11], s23 offen offset:0 sc1
  v_cmp_eq_u32 vcc, -1, v8
  v_smfmac_f32_16x16x64_bf16 v[40:43], v[8:11], a[56:63], v3
  v_smfmac_f32_16x16x64_bf16 v[44:47], v[8:11], a[112:119], v3
  buffer_load_dwordx4 v[28:31], v2, s[8:11], s23 offen offset:1024 sc1
  s_cbranch_vccnz cB_sc3_r0
  v_smfmac_f32_16x16x64_bf16 v[48:51], v[8:11], a[168:175], v3
  v_smfmac_f32_16x16x64_bf16 v[52:55], v[8:11], a[224:231], v3
  s_waitcnt vmcnt(4)
  v_cmp_eq_u32 vcc, -1, v12
  v_smfmac_f32_16x16x64_bf16 v[56:59], v[8:11], v[144:151], v3
  buffer_load_dwordx4 v[32:35], v2, s[8:11], s23 offen offset:2048 sc1
  v_smfmac_f32_16x16x64_bf16 v[62:65], v[8:11], v[200:207], v3
  s_cbranch_vccnz cB_sc3_r1
cB_sc3_c1:
  v_smfmac_f32_16x16x64_bf16 v[36:39], v[12:15], a[8:15], v3
  v_smfmac_f32_16x16x64_bf16 v[40:43], v[12:15], a[64:71], v3
  v_smfmac_f32_16x16x64_bf16 v[44:47], v[12:15], a[120:127], v3
  v_smfmac_f32_16x16x64_bf16 v[48:51], v[12:15], a[176:183], v3
  v_smfmac_f32_16x16x64_bf16 v[52:55], v[12:15], a[232:239], v3
  s_waitcnt vmcnt(4)
  v_cmp_eq_u32 vcc, -1, v16
  v_smfmac_f32_16x16x64_bf16 v[56:59], v[12:15], v[152:159], v3
  buffer_load_dwordx4 v[88:91], v117, s[8:11], s26 offen offset:0 sc1
  v_smfmac_f32_16x16x64_bf16 v[62:65], v[12:15], v[208:215], v3
  s_cbranch_vccnz cB_sc3_r2
cB_sc3_c2:
  v_smfmac_f32_16x16x64_bf16 v[36:39], v[16:19], a[16:23], v3
  v_smfmac_f32_16x16x64_bf16 v[40:43], v[16:19], a[72:79], v3
  v_smfmac_f32_16x16x64_bf16 v[44:47], v[16:19], a[128:135], v3
  buffer_load_dwordx4 v[92:95], v117, s[8:11], s26 offen offset:1024 sc1
  v_smfmac_f32_16x16x64_bf16 v[48:51], v[16:19], a[184:191], v3
  v_smfmac_f32_16x16x64_bf16 v[52:55], v[16:19], a[240:247], v3
  s_waitcnt vmcnt(5)
  v_cmp_eq_u32 vcc, -1, v20
  v_smfmac_f32_16x16x64_bf16 v[56:59], v[16:19], v[160:167], v3
  v_smfmac_f32_16x16x64_bf16 v[62:65], v[16:19], v[216:223], v3
  buffer_load_dwordx4 v[96:99], v2, s[8:11], s24 offen offset:0 sc1
  s_cbranch_vccnz cB_sc3_r3
cB_sc3_c3:
  v_smfmac_f32_16x16x64_bf16 v[36:39], v[20:23], a[24:31], v3
  v_smfmac_f32_16x16x64_bf16 v[40:43], v[20:23], a[80:87], v3
  s_waitcnt vmcnt(3)
  v_max3_u32 v66, v24, v27, v28
  v_smfmac_f32_16x16x64_bf16 v[44:47], v[20:23], a[136:143], v3
  v_max3_u32 v66, v66, v31, v32
  v_smfmac_f32_16x16x64_bf16 v[48:51], v[20:23], a[192:199], v3
  buffer_load_dwordx4 v[100:103], v2, s[8:11], s24 offen offset:1024 sc1
  v_max_u32 v66, v66, v35
  v_smfmac_f32_16x16x64_bf16 v[52:55], v[20:23], a[248:255], v3
  v_cmp_eq_u32 vcc, -1, v66
  v_smfmac_f32_16x16x64_bf16 v[56:59], v[20:23], v[168:175], v3
  v_smfmac_f32_16x16x64_bf16 v[62:65], v[20:23], v[224:231], v3
  s_cbranch_vccnz cB_sc3_r4
cB_sc3_c4:
  v_smfmac_f32_16x16x64_bf16 v[62:65], v[24:27], v[232:239], v3
  buffer_load_dwordx4 v[104:107], v2, s[8:11], s26 offen offset:0 sc1
  v_smfmac_f32_16x16x64_bf16 v[62:65], v[28:31], v[240:247], v3
  v_smfmac_f32_16x16x64_bf16 v[62:65], v[32:35], v[248:255], v3
  v_smfmac_f32_16x16x64_bf16 v[52:55], v[24:27], v[120:127], v3
  v_smfmac_f32_16x16x64_bf16 v[52:55], v[28:31], v[128:135], v3
  buffer_load_dwordx4 v[108:111], v2, s[8:11], s26 offen offset:1024 sc1
  v_smfmac_f32_16x16x64_bf16 v[52:55], v[32:35], v[136:143], v3
  v_cvt_pk_bf16_f32 v62, v62, v63
  v_smfmac_f32_16x16x64_bf16 v[56:59], v[24:27], v[176:183], v3
  v_cvt_pk_bf16_f32 v63, v64, v65
  v_smfmac_f32_16x16x64_bf16 v[56:59], v[28:31], v[184:191], v3
  v_mfma_f32_16x16x32_bf16 v[8:11], v[60:63], v[4:7], 0
  v_cvt_pk_bf16_f32 v55, v54, v55
  v_smfmac_f32_16x16x64_bf16 v[56:59], v[32:35], v[192:199], v3
  v_cvt_pk_bf16_f32 v54, v52, v53
  v_smfmac_f32_16x16x64_bf16 v[36:39], v[24:27], a[32:39], v3
  s_nop 1
  v_cvt_pk_bf16_f32 v78, v8, v9
  v_smfmac_f32_16x16x64_bf16 v[36:39], v[28:31], a[40:47], v3
  v_cvt_pk_bf16_f32 v79, v10, v11
  v_smfmac_f32_16x16x64_bf16 v[36:39], v[32:35], a[48:55], v3
  v_cvt_pk_bf16_f32 v56, v56, v57
  v_smfmac_f32_16x16x64_bf16 v[40:43], v[24:27], a[88:95], v3
  v_cvt_pk_bf16_f32 v57, v58, v59
  v_smfmac_f32_16x16x64_bf16 v[40:43], v[28:31], a[96:103], v3
  v_mfma_f32_16x16x32_bf16 v[12:15], v[54:57], v[4:7], 0
  v_cvt_pk_bf16_f32 v39, v38, v39
  v_smfmac_f32_16x16x64_bf16 v[40:43], v[32:35], a[104:111], v3
  v_cvt_pk_bf16_f32 v38, v36, v37
  v_smfmac_f32_16x16x64_bf16 v[44:47], v[24:27], a[144:151], v3
  s_nop 1
  v_cvt_pk_bf16_f32 v76, v12, v13
  v_smfmac_f32_16x16x64_bf16 v[44:47], v[28:31], a[152:159], v3
  v_cvt_pk_bf16_f32 v77, v14, v15
  v_smfmac_f32_16x16x64_bf16 v[44:47], v[32:35], a[160:167], v3
  v_cvt_pk_bf16_f32 v40, v40, v41
  v_smfmac_f32_16x16x64_bf16 v[48:51], v[24:27], a[200:207], v3
  v_cvt_pk_bf16_f32 v41, v42, v43
  v_smfmac_f32_16x16x64_bf16 v[48:51], v[28:31], a[208:215], v3
  v_smfmac_f32_16x16x64_bf16 v[48:51], v[32:35], a[216:223], v3
  s_waitcnt vmcnt(4)
  v_cvt_pk_bf16_f32 v47, v46, v47
  v_smfmac_f32_16x16x64_bf16 v[68:71], v[76:79], v[80:87], v3
  v_cvt_pk_bf16_f32 v46, v44, v45
  v_mfma_f32_16x16x32_bf16 v[8:11], v[38:41], v[4:7], 0
  s_nop 1
  v_cvt_pk_bf16_f32 v48, v48, v49
  v_cvt_pk_bf16_f32 v49, v50, v51
  s_nop 1
  v_mfma_f32_16x16x32_bf16 v[12:15], v[46:49], v[4:7], 0
  v_smfmac_f32_16x16x64_bf16 v[72:75], v[76:79], v[88:95], v3
  v_cvt_pk_bf16_f32 v16, v8, v9
  v_mfma_f32_16x16x32_bf16 v[52:55], v[30:33], v[76:79], 0
  s_waitcnt vmcnt(0)
  v_cvt_pk_bf16_f32 v17, v10, v11
  v_cvt_pk_bf16_f32 v18, v12, v13
  v_cvt_pk_bf16_f32 v19, v14, v15
  s_nop 1
  v_smfmac_f32_16x16x64_bf16 v[68:71], v[16:19], v[96:103], v3
  v_mfma_f32_16x16x32_bf16 v[52:55], v[20:23], v[16:19], v[52:55]
  v_smfmac_f32_16x16x64_bf16 v[72:75], v[16:19], v[104:111], v3
  s_nop 1
  v_permlane32_swap_b32 v68, v70
  v_permlane32_swap_b32 v69, v71
  v_add_f32 v56, v68, v70
  v_add_f32 v58, v69, v71
  ds_write_b128 v113, v[52:55]
  s_nop 0
  v_permlane32_swap_b32 v72, v74
  v_permlane32_swap_b32 v73, v75
  v_add_f32 v57, v72, v74
  v_add_f32 v59, v73, v75
  ds_write_b128 v2, v[56:59] offset:3072
  v_cmp_u_f32 vcc, v57, v59
  v_mov_b32 v36, 0
  v_mov_b32 v37, 0
  v_mov_b32 v38, 0
  v_mov_b32 v39, 0
  s_cbranch_vccnz cB_sc3_retry
cB_sc3_cont:
  s_add_u32 s24, s24, 28672
  s_add_u32 s26, s26, 28672
  buffer_load_dwordx4 v[80:83], v117, s[8:11], s24 offen offset:0 sc1
  buffer_load_dwordx4 v[84:87], v117, s[8:11], s24 offen offset:1024 sc1
  v_mov_b32 v40, 0
  v_mov_b32 v41, 0
  v_mov_b32 v42, 0
  v_mov_b32 v43, 0
  v_mov_b32 v44, 0
  v_mov_b32 v45, 0
  v_mov_b32 v46, 0
  v_mov_b32 v47, 0
  v_mov_b32 v48, 0
  v_mov_b32 v49, 0
  v_mov_b32 v50, 0
  v_mov_b32 v51, 0
  s_waitcnt lgkmcnt(0)
  s_barrier
  v_mov_b32 v62, 0
  v_mov_b32 v63, 0
  v_mov_b32 v64, 0
  v_mov_b32 v65, 0
  v_mov_b32 v68, 0
  v_mov_b32 v69, 0
  v_mov_b32 v70, 0
  v_mov_b32 v71, 0
  v_mov_b32 v72, 0
  v_mov_b32 v73, 0
  v_mov_b32 v74, 0
  v_mov_b32 v75, 0
  v_mov_b32 v52, 0
  v_mov_b32 v53, 0
  v_mov_b32 v54, 0
  v_mov_b32 v55, 0
  v_mov_b32 v56, 0
  v_mov_b32 v57, 0
  v_mov_b32 v58, 0
  v_mov_b32 v59, 0
  s_mov_b32 s19, s18
  s_add_u32 s18, s18, 1
  s_mov_b32 s22, s20
  s_mov_b32 s20, s21
  s_mov_b32 s21, s22
  s_add_u32 s23, s20, 4096
  s_cmp_lt_u32 s19, 63
  s_cbranch_scc1 cB_sc3_loop
  s_branch cB_done
cB_sc3_r0:
  s_add_u32 s31, s31, 1
  buffer_load_dwordx4 v[8:11], v2, s[8:11], s20 offen offset:0 sc1
  s_waitcnt vmcnt(0)
  v_cmp_eq_u32 vcc, -1, v8
  v_mov_b32 v36, 0
  v_mov_b32 v37, 0
  v_mov_b32 v38, 0
  v_mov_b32 v39, 0
  v_mov_b32 v40, 0
  v_mov_b32 v41, 0
  v_mov_b32 v42, 0
  v_mov_b32 v43, 0
  v_mov_b32 v44, 0
  v_mov_b32 v45, 0
  v_mov_b32 v46, 0
  v_mov_b32 v47, 0
  v_mov_b32 v48, 0
  v_mov_b32 v49, 0
  v_mov_b32 v50, 0
  v_mov_b32 v51, 0
  s_nop 1
  s_cbranch_vccz cB_sc3_go
  s_add_u32 s30, s30, 1
  s_cmp_lt_u32 s30, 400000
  s_cbranch_scc1 cB_sc3_r0
  s_branch cB_abort
cB_sc3_r1:
  s_add_u32 s31, s31, 1
  buffer_load_dwordx4 v[12:15], v2, s[8:11], s20 offen offset:1024 sc1
  s_waitcnt vmcnt(0)
  v_cmp_eq_u32 vcc, -1, v12
  s_nop 4
  s_cbranch_vccz cB_sc3_c1
  s_add_u32 s30, s30, 1
  s_cmp_lt_u32 s30, 400000
  s_cbranch_scc1 cB_sc3_r1
  s_branch cB_abort
cB_sc3_r2:
  s_add_u32 s31, s31, 1
  buffer_load_dwordx4 v[16:19], v2, s[8:11], s20 offen offset:2048 sc1
  s_waitcnt vmcnt(0)
  v_cmp_eq_u32 vcc, -1, v16
  s_nop 4
  s_cbranch_vccz cB_sc3_c2
  s_add_u32 s30, s30, 1
  s_cmp_lt_u32 s30, 400000
  s_cbranch_scc1 cB_sc3_r2
  s_branch cB_abort
cB_sc3_r3:
  s_add_u32 s31, s31, 1
  buffer_load_dwordx4 v[20:23], v2, s[8:11], s20 offen offset:3072 sc1
  s_waitcnt vmcnt(0)
  v_cmp_eq_u32 vcc, -1, v20
  s_nop 4
  s_cbranch_vccz cB_sc3_c3
  s_add_u32 s30, s30, 1
  s_cmp_lt_u32 s30, 400000
  s_cbranch_scc1 cB_sc3_r3
  s_branch cB_abort
cB_sc3_r4:
  s_add_u32 s31, s31, 1
  buffer_load_dwordx4 v[24:27], v2, s[8:11], s23 offen offset:0 sc1
  buffer_load_dwordx4 v[28:31], v2, s[8:11], s23 offen offset:1024 sc1
  buffer_load_dwordx4 v[32:35], v2, s[8:11], s23 offen offset:2048 sc1
  s_waitcnt vmcnt(0)
  v_max3_u32 v66, v24, v27, v28
  v_max3_u32 v66, v66, v31, v32
  v_max_u32 v66, v66, v35
  v_cmp_eq_u32 vcc, -1, v66
  s_nop 4
  s_cbranch_vccz cB_sc3_c4
  s_add_u32 s30, s30, 1
  s_cmp_lt_u32 s30, 400000
  s_cbranch_scc1 cB_sc3_r4
  s_branch cB_abort
cB_sc3_retry:
  s_cmp_lg_u32 s62, 0
  s_cbranch_scc1 cB_sc3_cont
  s_waitcnt vmcnt(0) lgkmcnt(0)
cB_sc3_rv:
  buffer_load_dwordx4 v[8:11], v2, s[8:11], s20 offen offset:0 sc1
  buffer_load_dwordx4 v[12:15], v2, s[8:11], s20 offen offset:1024 sc1
  buffer_load_dwordx4 v[16:19], v2, s[8:11], s20 offen offset:2048 sc1
  buffer_load_dwordx4 v[20:23], v2, s[8:11], s20 offen offset:3072 sc1
  buffer_load_dwordx4 v[24:27], v2, s[8:11], s23 offen offset:0 sc1
  buffer_load_dwordx4 v[28:31], v2, s[8:11], s23 offen offset:1024 sc1
  buffer_load_dwordx4 v[32:35], v2, s[8:11], s23 offen offset:2048 sc1
  s_waitcnt vmcnt(0)
  v_pk_max_u16 v66, v8, v9
  v_pk_max_u16 v66, v66, v10
  v_pk_max_u16 v66, v66, v11
  v_pk_max_u16 v66, v66, v12
  v_pk_max_u16 v66, v66, v13
  v_pk_max_u16 v66, v66, v14
  v_pk_max_u16 v66, v66, v15
  v_pk_max_u16 v66, v66, v16
  v_pk_max_u16 v66, v66, v17
  v_pk_max_u16 v66, v66, v18
  v_pk_max_u16 v66, v66, v19
  v_pk_max_u16 v66, v66, v20
  v_pk_max_u16 v66, v66, v21
  v_pk_max_u16 v66, v66, v22
  v_pk_max_u16 v66, v66, v23
  v_pk_max_u16 v66, v66, v24
  v_pk_max_u16 v66, v66, v25
  v_pk_max_u16 v66, v66, v26
  v_pk_max_u16 v66, v66, v27
  v_pk_max_u16 v66, v66, v28
  v_pk_max_u16 v66, v66, v29
  v_pk_max_u16 v66, v66, v30
  v_pk_max_u16 v66, v66, v31
  v_pk_max_u16 v66, v66, v32
  v_pk_max_u16 v66, v66, v33
  v_pk_max_u16 v66, v66, v34
  v_pk_max_u16 v66, v66, v35
  v_lshlrev_b32 v67, 16, v66
  v_max_u32 v66, v66, v67
  v_cmp_le_u32 vcc, 0xffff0000, v66
  s_cbranch_vccz cB_sc3_rk
  s_add_u32 s30, s30, 1
  s_cmp_lt_u32 s30, 400000
  s_cbranch_scc1 cB_sc3_rv
  s_branch cB_abort
cB_sc3_rk:
  s_mov_b32 s62, 1
  v_mov_b32 v36, 0
  v_mov_b32 v37, 0
  v_mov_b32 v38, 0
  v_mov_b32 v39, 0
  v_mov_b32 v40, 0
  v_mov_b32 v41, 0
  v_mov_b32 v42, 0
  v_mov_b32 v43, 0
  v_mov_b32 v44, 0
  v_mov_b32 v45, 0
  v_mov_b32 v46, 0
  v_mov_b32 v47, 0
  v_mov_b32 v48, 0
  v_mov_b32 v49, 0
  v_mov_b32 v50, 0
  v_mov_b32 v51, 0
  v_mov_b32 v62, 0
  v_mov_b32 v63, 0
  v_mov_b32 v64, 0
  v_mov_b32 v65, 0
  v_mov_b32 v68, 0
  v_mov_b32 v69, 0
  v_mov_b32 v70, 0
  v_mov_b32 v71, 0
  v_mov_b32 v72, 0
  v_mov_b32 v73, 0
  v_mov_b32 v74, 0
  v_mov_b32 v75, 0
  v_mov_b32 v52, 0
  v_mov_b32 v53, 0
  v_mov_b32 v54, 0
  v_mov_b32 v55, 0
  v_mov_b32 v56, 0
  v_mov_b32 v57, 0
  v_mov_b32 v58, 0
  v_mov_b32 v59, 0
  s_add_u32 s31, s31, 0x100
  s_nop 0
  s_branch cB_sc3_go
.p2align 6
cB_va0_loop:
  s_mov_b32 s30, 0
  s_barrier
  buffer_load_dwordx4 v[24:27], v2, s[8:11], s23 offen offset:0 sc1
  buffer_load_dwordx4 v[28:31], v2, s[8:11], s23 offen offset:1024 sc1
  s_barrier
  buffer_store_dword v160, v1, s[8:11], s38 offen sc1
  s_add_u32 s22, s25, 0
  buffer_load_dwordx4 v[80:83], v6, s[8:11], s22 offen offset:0 sc1
  buffer_load_dwordx4 v[84:87], v6, s[8:11], s22 offen offset:1792 sc1
  s_add_u32 s22, s25, 3584
  buffer_load_dwordx4 v[88:91], v6, s[8:11], s22 offen offset:0 sc1
  buffer_load_dwordx4 v[92:95], v6, s[8:11], s22 offen offset:1792 sc1
  s_add_u32 s22, s25, 7168
  buffer_load_dwordx4 v[96:99], v6, s[8:11], s22 offen offset:0 sc1
  buffer_load_dwordx4 v[100:103], v6, s[8:11], s22 offen offset:1792 sc1
  s_add_u32 s22, s25, 10752
  buffer_load_dwordx4 v[104:107], v6, s[8:11], s22 offen offset:0 sc1
  buffer_load_dwordx4 v[108:111], v6, s[8:11], s22 offen offset:1792 sc1
  s_add_u32 s22, s25, 14336
  buffer_load_dwordx4 v[112:115], v6, s[8:11], s22 offen offset:0 sc1
  buffer_load_dwordx4 v[116:119], v6, s[8:11], s22 offen offset:1792 sc1
  s_add_u32 s22, s25, 17920
  buffer_load_dwordx4 v[120:123], v6, s[8:11], s22 offen offset:0 sc1
  buffer_load_dwordx4 v[124:127], v6, s[8:11], s22 offen offset:1792 sc1
  s_add_u32 s22, s25, 21504
  buffer_load_dwordx4 v[128:131], v6, s[8:11], s22 offen offset:0 sc1
  buffer_load_dwordx4 v[132:135], v6, s[8:11], s22 offen offset:1792 sc1
  s_add_u32 s22, s25, 25088
  buffer_load_dwordx4 v[136:139], v6, s[8:11], s22 offen offset:0 sc1
  buffer_load_dwordx4 v[140:143], v6, s[8:11], s22 offen offset:1792 sc1
  s_mul_i32 s38, s18, 7168
  s_add_u32 s38, s38, 87543808
  s_waitcnt vmcnt(17)
  ds_write_b128 v2, v[24:27] offset:12288
  ds_write_b128 v2, v[28:31] offset:13312
  v_smfmac_f32_16x16x64_bf16 v[36:39], v[24:27], a[32:39], v3
  v_smfmac_f32_16x16x64_bf16 v[40:43], v[24:27], a[88:95], v3
  v_smfmac_f32_16x16x64_bf16 v[44:47], v[24:27], a[144:151], v3
  v_smfmac_f32_16x16x64_bf16 v[48:51], v[24:27], a[200:207], v3
  v_smfmac_f32_16x16x64_bf16 v[52:55], v[24:27], v[176:183], v3
  s_waitcnt lgkmcnt(0)
  s_barrier
  ds_read_b128 v[8:11], v2 offset:8192
  ds_read_b128 v[12:15], v2 offset:9216
  ds_read_b128 v[16:19], v2 offset:10240
  ds_read_b128 v[20:23], v2 offset:11264
  ds_read_b128 v[32:35], v2 offset:14336
  v_smfmac_f32_16x16x64_bf16 v[56:59], v[24:27], v[232:239], v3
  v_smfmac_f32_16x16x64_bf16 v[36:39], v[28:31], a[40:47], v3
  v_smfmac_f32_16x16x64_bf16 v[40:43], v[28:31], a[96:103], v3
  v_smfmac_f32_16x16x64_bf16 v[44:47], v[28:31], a[152:159], v3
  v_smfmac_f32_16x16x64_bf16 v[48:51], v[28:31], a[208:215], v3
  v_smfmac_f32_16x16x64_bf16 v[52:55], v[28:31], v[184:191], v3
  ds_read_b128 v[64:67], v0 offset:0
  ds_read_b128 v[68:71], v0 offset:1024
  v_smfmac_f32_16x16x64_bf16 v[56:59], v[28:31], v[240:247], v3
  s_waitcnt lgkmcnt(6)
  ds_read_b128 v[72:75], v0 offset:2048
  ds_read_b128 v[76:79], v0 offset:3072
  v_smfmac_f32_16x16x64_bf16 v[36:39], v[8:11], a[0:7], v3
  s_waitcnt lgkmcnt(7)
  v_smfmac_f32_16x16x64_bf16 v[36:39], v[12:15], a[8:15], v3
  s_waitcnt lgkmcnt(6)
  v_smfmac_f32_16x16x64_bf16 v[36:39], v[16:19], a[16:23], v3
  s_waitcnt lgkmcnt(2)
  v_smfmac_f32_16x16x64_bf16 v[60:63], v[8:11], v[64:71], v3
  s_waitcnt lgkmcnt(5)
  ds_read_b128 v[144:147], v0 offset:4096
  ds_read_b128 v[148:151], v0 offset:5120
  v_smfmac_f32_16x16x64_bf16 v[36:39], v[20:23], a[24:31], v3
  s_waitcnt lgkmcnt(6)
  v_smfmac_f32_16x16x64_bf16 v[36:39], v[32:35], a[48:55], v3
  v_smfmac_f32_16x16x64_bf16 v[40:43], v[8:11], a[56:63], v3
  s_waitcnt lgkmcnt(2)
  v_smfmac_f32_16x16x64_bf16 v[60:63], v[12:15], v[72:79], v3
  ds_read_b128 v[64:67], v0 offset:6144
  ds_read_b128 v[68:71], v0 offset:7168
  v_smfmac_f32_16x16x64_bf16 v[40:43], v[12:15], a[64:71], v3
  v_permlane32_swap_b32 v36, v38
  v_smfmac_f32_16x16x64_bf16 v[40:43], v[16:19], a[72:79], v3
  v_permlane32_swap_b32 v37, v39
  v_smfmac_f32_16x16x64_bf16 v[40:43], v[20:23], a[80:87], v3
  s_waitcnt lgkmcnt(2)
  v_add_f32 v36, v36, v38
  v_smfmac_f32_16x16x64_bf16 v[60:63], v[16:19], v[144:151], v3
  ds_read_b128 v[72:75], v0 offset:8192
  ds_read_b128 v[76:79], v0 offset:9216
  v_add_f32 v37, v37, v39
  v_smfmac_f32_16x16x64_bf16 v[40:43], v[32:35], a[104:111], v3
  v_cmp_u_f32 vcc, v36, v37
  v_smfmac_f32_16x16x64_bf16 v[44:47], v[8:11], a[112:119], v3
  v_cvt_pk_bf16_f32 v38, v36, v37
  v_smfmac_f32_16x16x64_bf16 v[44:47], v[12:15], a[120:127], v3
  ds_write_b32 v152, v38
  s_waitcnt lgkmcnt(3)
  s_cbranch_vccnz cB_va0_slow
  v_permlane32_swap_b32 v40, v42
  v_smfmac_f32_16x16x64_bf16 v[60:63], v[20:23], v[64:71], v3
  ds_read_b128 v[144:147], v0 offset:10240
  ds_read_b128 v[148:151], v0 offset:11264
  v_permlane32_swap_b32 v41, v43
  v_smfmac_f32_16x16x64_bf16 v[44:47], v[16:19], a[128:135], v3
  buffer_store_dword v162, v1, s[8:11], s21 offen sc1
  v_add_f32 v40, v40, v42
  v_smfmac_f32_16x16x64_bf16 v[44:47], v[20:23], a[136:143], v3
  v_add_f32 v41, v41, v43
  v_smfmac_f32_16x16x64_bf16 v[44:47], v[32:35], a[160:167], v3
  s_waitcnt lgkmcnt(3)
  v_cvt_pk_bf16_f32 v42, v40, v41
  v_smfmac_f32_16x16x64_bf16 v[60:63], v[24:27], v[72:79], v3
  ds_write_b32 v153, v42
  ds_read_b128 v[64:67], v0 offset:12288
  ds_read_b128 v[68:71], v0 offset:13312
  v_smfmac_f32_16x16x64_bf16 v[48:51], v[8:11], a[168:175], v3
  s_nop 0
  v_permlane32_swap_b32 v44, v46
  v_smfmac_f32_16x16x64_bf16 v[48:51], v[12:15], a[176:183], v3
  v_permlane32_swap_b32 v45, v47
  v_smfmac_f32_16x16x64_bf16 v[48:51], v[16:19], a[184:191], v3
  s_waitcnt lgkmcnt(3)
  v_add_f32 v44, v44, v46
  v_smfmac_f32_16x16x64_bf16 v[60:63], v[28:31], v[144:151], v3
  v_add_f32 v45, v45, v47
  v_smfmac_f32_16x16x64_bf16 v[48:51], v[20:23], a[192:199], v3
  v_cvt_pk_bf16_f32 v46, v44, v45
  v_smfmac_f32_16x16x64_bf16 v[48:51], v[32:35], a[216:223], v3
  ds_write_b32 v154, v46
  v_smfmac_f32_16x16x64_bf16 v[52:55], v[8:11], a[224:231], v3
  s_waitcnt lgkmcnt(1)
  v_smfmac_f32_16x16x64_bf16 v[60:63], v[32:35], v[64:71], v3
  v_smfmac_f32_16x16x64_bf16 v[52:55], v[12:15], a[232:239], v3
  v_permlane32_swap_b32 v48, v50
  v_smfmac_f32_16x16x64_bf16 v[52:55], v[16:19], a[240:247], v3
  v_permlane32_swap_b32 v49, v51
  v_smfmac_f32_16x16x64_bf16 v[52:55], v[20:23], a[248:255], v3
  v_add_f32 v48, v48, v50
  v_smfmac_f32_16x16x64_bf16 v[52:55], v[32:35], v[192:199], v3
  v_add_f32 v49, v49, v51
  v_smfmac_f32_16x16x64_bf16 v[56:59], v[8:11], v[200:207], v3
  v_cvt_pk_bf16_f32 v50, v48, v49
  v_smfmac_f32_16x16x64_bf16 v[56:59], v[12:15], v[208:215], v3
  ds_write_b32 v155, v50
  v_permlane32_swap_b32 v60, v62
  v_smfmac_f32_16x16x64_bf16 v[56:59], v[16:19], v[216:223], v3
  v_permlane32_swap_b32 v61, v63
  v_smfmac_f32_16x16x64_bf16 v[56:59], v[20:23], v[224:231], v3
  v_add_f32 v60, v60, v62
  v_smfmac_f32_16x16x64_bf16 v[56:59], v[32:35], v[248:255], v3
  v_add_f32 v61, v61, v63
  v_cvt_pk_bf16_f32 v62, v60, v61
  ds_write_b32 v158, v62
  v_permlane32_swap_b32 v52, v54
  v_permlane32_swap_b32 v53, v55
  v_add_f32 v52, v52, v54
  v_add_f32 v53, v53, v55
  v_cvt_pk_bf16_f32 v54, v52, v53
  ds_write_b32 v156, v54
  v_permlane32_swap_b32 v56, v58
  v_permlane32_swap_b32 v57, v59
  v_add_f32 v56, v56, v58
  v_add_f32 v57, v57, v59
  v_cvt_pk_bf16_f32 v58, v56, v57
  ds_write_b32 v157, v58
cB_va0_t2d:
  s_add_u32 s22, s20, 9216
  s_add_u32 s34, s20, 13312
  s_add_u32 s36, s20, 7168
  s_mov_b32 s37, 0
  v_mov_b32 v48, 0
  v_mov_b32 v49, 0
  v_mov_b32 v50, 0
  v_mov_b32 v51, 0
  v_mov_b32 v163, s18
  s_waitcnt lgkmcnt(0)
  s_setprio 3
  buffer_load_dword v52, v4, s[8:11], 0 offen sc1
  buffer_load_dword v53, v4, s[8:11], 0 offen sc1
  buffer_load_dword v54, v4, s[8:11], 0 offen sc1
cB_va0_fw_l:
  s_waitcnt vmcnt(2)
  v_cmp_gt_u32 vcc, s18, v52
  s_cbranch_vccz cB_va0_fw_d
  buffer_load_dword v52, v4, s[8:11], 0 offen sc1
  s_waitcnt vmcnt(2)
  v_cmp_gt_u32 vcc, s18, v53
  s_cbranch_vccz cB_va0_fw_d
  buffer_load_dword v53, v4, s[8:11], 0 offen sc1
  s_waitcnt vmcnt(2)
  v_cmp_gt_u32 vcc, s18, v54
  s_cbranch_vccz cB_va0_fw_d
  buffer_load_dword v54, v4, s[8:11], 0 offen sc1
  s_add_u32 s30, s30, 1
  s_cmp_lt_u32 s30, 400000
  s_cbranch_scc1 cB_va0_fw_l
  s_branch cB_abort
cB_va0_fw_d:
  buffer_load_dwordx4 v[8:11], v2, s[8:11], s22 offen offset:0 sc1
  buffer_load_dwordx4 v[12:15], v2, s[8:11], s22 offen offset:1024 sc1
  buffer_load_dwordx4 v[16:19], v2, s[8:11], s22 offen offset:2048 sc1
  buffer_load_dwordx4 v[20:23], v2, s[8:11], s22 offen offset:3072 sc1
  buffer_load_dwordx4 v[24:27], v2, s[8:11], s34 offen offset:0 sc1
  buffer_load_dwordx4 v[28:31], v2, s[8:11], s34 offen offset:1024 sc1
  buffer_load_dwordx4 v[32:35], v2, s[8:11], s34 offen offset:2048 sc1
  buffer_load_dwordx4 v[36:39], v2, s[8:11], s34 offen offset:3072 sc1
  buffer_load_dwordx4 v[40:43], v2, s[8:11], s36 offen offset:0 sc1
  buffer_load_dwordx4 v[44:47], v2, s[8:11], s36 offen offset:1024 sc1
  s_barrier
  ds_read_b128 v[64:67], v2 offset:0
  ds_read_b128 v[68:71], v2 offset:1024
  ds_read_b128 v[72:75], v2 offset:2048
  ds_read_b128 v[76:79], v2 offset:3072
cB_va0_lp:
  s_waitcnt vmcnt(9)
  v_smfmac_f32_16x16x64_bf16 v[48:51], v[8:11], v[80:87], v3
  s_waitcnt vmcnt(8)
  v_smfmac_f32_16x16x64_bf16 v[48:51], v[12:15], v[88:95], v3
  s_waitcnt vmcnt(7)
  v_smfmac_f32_16x16x64_bf16 v[48:51], v[16:19], v[96:103], v3
  s_waitcnt vmcnt(6)
  v_smfmac_f32_16x16x64_bf16 v[48:51], v[20:23], v[104:111], v3
  s_waitcnt vmcnt(5)
  v_smfmac_f32_16x16x64_bf16 v[48:51], v[24:27], v[112:119], v3
  s_waitcnt vmcnt(4)
  v_smfmac_f32_16x16x64_bf16 v[48:51], v[28:31], v[120:127], v3
  s_waitcnt vmcnt(3)
  v_smfmac_f32_16x16x64_bf16 v[48:51], v[32:35], v[128:135], v3
  s_waitcnt vmcnt(2)
  v_smfmac_f32_16x16x64_bf16 v[48:51], v[36:39], v[136:143], v3
  s_waitcnt vmcnt(1) lgkmcnt(0)
  v_smfmac_f32_16x16x64_bf16 v[48:51], v[40:43], v[64:71], v3
  s_waitcnt vmcnt(0)
  v_smfmac_f32_16x16x64_bf16 v[48:51], v[44:47], v[72:79], v3
  s_nop 7
  v_permlane32_swap_b32 v48, v50
  v_permlane32_swap_b32 v49, v51
  v_add_f32 v48, v48, v50
  v_add_f32 v49, v49, v51
  v_cvt_pk_bf16_f32 v160, v48, v49
  v_cmp_u_f32 vcc, v48, v49
  s_nop 0
  v_mov_b32_dpp v161, v160 quad_perm:[1,0,3,2] row_mask:0xf bank_mask:0xf
  v_perm_b32 v160, v161, v160, v5
  v_min_u32 v160, -2, v160
  s_cbranch_vccnz cB_va0_rp
cB_va0_cont:
  buffer_store_dword v160, v1, s[8:11], s21 offen sc1
  s_setprio 0
  s_cmp_lg_u32 s19, 62
  s_cbranch_scc1 cB_va0_nl
  buffer_store_dword v160, v1, s[8:11], s38 offen sc1
  s_branch cB_done
cB_va0_nl:
  s_add_u32 s25, s25, 28672
  v_mov_b32 v36, 0
  v_mov_b32 v37, 0
  v_mov_b32 v38, 0
  v_mov_b32 v39, 0
  v_mov_b32 v40, 0
  v_mov_b32 v41, 0
  v_mov_b32 v42, 0
  v_mov_b32 v43, 0
  v_mov_b32 v44, 0
  v_mov_b32 v45, 0
  v_mov_b32 v46, 0
  v_mov_b32 v47, 0
  v_mov_b32 v48, 0
  v_mov_b32 v49, 0
  v_mov_b32 v50, 0
  v_mov_b32 v51, 0
  v_mov_b32 v52, 0
  v_mov_b32 v53, 0
  v_mov_b32 v54, 0
  v_mov_b32 v55, 0
  v_mov_b32 v56, 0
  v_mov_b32 v57, 0
  v_mov_b32 v58, 0
  v_mov_b32 v59, 0
  v_mov_b32 v60, 0
  v_mov_b32 v61, 0
  v_mov_b32 v62, 0
  v_mov_b32 v63, 0
  s_mov_b32 s19, s18
  s_add_u32 s18, s18, 1
  s_mov_b32 s22, s20
  s_mov_b32 s20, s21
  s_mov_b32 s21, s22
  s_add_u32 s23, s20, 4096
  s_branch cB_va0_loop
cB_va0_slow:
  s_waitcnt lgkmcnt(0)
cB_va0_sl1:
  s_add_u32 s31, s31, 0x1000000
  buffer_load_dwordx4 v[8:11], v2, s[8:11], s20 offen offset:0 sc1
  buffer_load_dwordx4 v[12:15], v2, s[8:11], s20 offen offset:1024 sc1
  buffer_load_dwordx4 v[16:19], v2, s[8:11], s20 offen offset:2048 sc1
  buffer_load_dwordx4 v[20:23], v2, s[8:11], s20 offen offset:3072 sc1
  buffer_load_dwordx4 v[24:27], v2, s[8:11], s23 offen offset:0 sc1
  buffer_load_dwordx4 v[28:31], v2, s[8:11], s23 offen offset:1024 sc1
  buffer_load_dwordx4 v[32:35], v2, s[8:11], s23 offen offset:2048 sc1
  s_waitcnt vmcnt(0)
  v_max3_u32 v36, v8, v9, v10
  v_max3_u32 v36, v36, v11, v12
  v_max3_u32 v36, v36, v13, v14
  v_max3_u32 v36, v36, v15, v16
  v_max3_u32 v36, v36, v17, v18
  v_max3_u32 v36, v36, v19, v20
  v_max3_u32 v36, v36, v21, v22
  v_max3_u32 v36, v36, v23, v24
  v_max3_u32 v36, v36, v25, v26
  v_max3_u32 v36, v36, v27, v28
  v_max3_u32 v36, v36, v29, v30
  v_max3_u32 v36, v36, v31, v32
  v_max3_u32 v36, v36, v33, v34
  v_max_u32 v36, v36, v35
  v_cmp_eq_u32 vcc, -1, v36
  s_cbranch_vccz cB_va0_sl2
  s_add_u32 s30, s30, 1
  s_cmp_lt_u32 s30, 400000
  s_cbranch_scc1 cB_va0_sl1
  s_branch cB_abort
cB_va0_sl2:
  v_mov_b32 v36, 0
  v_mov_b32 v37, 0
  v_mov_b32 v38, 0
  v_mov_b32 v39, 0
  v_mov_b32 v40, 0
  v_mov_b32 v41, 0
  v_mov_b32 v42, 0
  v_mov_b32 v43, 0
  v_mov_b32 v44, 0
  v_mov_b32 v45, 0
  v_mov_b32 v46, 0
  v_mov_b32 v47, 0
  v_mov_b32 v48, 0
  v_mov_b32 v49, 0
  v_mov_b32 v50, 0
  v_mov_b32 v51, 0
  v_mov_b32 v52, 0
  v_mov_b32 v53, 0
  v_mov_b32 v54, 0
  v_mov_b32 v55, 0
  v_mov_b32 v56, 0
  v_mov_b32 v57, 0
  v_mov_b32 v58, 0
  v_mov_b32 v59, 0
  v_mov_b32 v60, 0
  v_mov_b32 v61, 0
  v_mov_b32 v62, 0
  v_mov_b32 v63, 0
  buffer_store_dword v162, v1, s[8:11], s21 offen sc1
  ds_read_b128 v[64:67], v0 offset:0
  ds_read_b128 v[68:71], v0 offset:1024
  v_smfmac_f32_16x16x64_bf16 v[36:39], v[8:11], a[0:7], v3
  v_smfmac_f32_16x16x64_bf16 v[40:43], v[8:11], a[56:63], v3
  v_smfmac_f32_16x16x64_bf16 v[44:47], v[8:11], a[112:119], v3
  v_smfmac_f32_16x16x64_bf16 v[48:51], v[8:11], a[168:175], v3
  v_smfmac_f32_16x16x64_bf16 v[52:55], v[8:11], a[224:231], v3
  v_smfmac_f32_16x16x64_bf16 v[56:59], v[8:11], v[200:207], v3
  s_waitcnt lgkmcnt(0)
  v_smfmac_f32_16x16x64_bf16 v[60:63], v[8:11], v[64:71], v3
  ds_read_b128 v[72:75], v0 offset:2048
  ds_read_b128 v[76:79], v0 offset:3072
  v_smfmac_f32_16x16x64_bf16 v[36:39], v[12:15], a[8:15], v3
  v_smfmac_f32_16x16x64_bf16 v[40:43], v[12:15], a[64:71], v3
  v_smfmac_f32_16x16x64_bf16 v[44:47], v[12:15], a[120:127], v3
  v_smfmac_f32_16x16x64_bf16 v[48:51], v[12:15], a[176:183], v3
  v_smfmac_f32_16x16x64_bf16 v[52:55], v[12:15], a[232:239], v3
  v_smfmac_f32_16x16x64_bf16 v[56:59], v[12:15], v[208:215], v3
  s_waitcnt lgkmcnt(0)
  v_smfmac_f32_16x16x64_bf16 v[60:63], v[12:15], v[72:79], v3
  ds_read_b128 v[144:147], v0 offset:4096
  ds_read_b128 v[148:151], v0 offset:5120
  v_smfmac_f32_16x16x64_bf16 v[36:39], v[16:19], a[16:23], v3
  v_smfmac_f32_16x16x64_bf16 v[40:43], v[16:19], a[72:79], v3
  v_smfmac_f32_16x16x64_bf16 v[44:47], v[16:19], a[128:135], v3
  v_smfmac_f32_16x16x64_bf16 v[48:51], v[16:19], a[184:191], v3
  v_smfmac_f32_16x16x64_bf16 v[52:55], v[16:19], a[240:247], v3
  v_smfmac_f32_16x16x64_bf16 v[56:59], v[16:19], v[216:223], v3
  s_waitcnt lgkmcnt(0)
  v_smfmac_f32_16x16x64_bf16 v[60:63], v[16:19], v[144:151], v3
  ds_read_b128 v[64:67], v0 offset:6144
  ds_read_b128 v[68:71], v0 offset:7168
  v_smfmac_f32_16x16x64_bf16 v[36:39], v[20:23], a[24:31], v3
  v_smfmac_f32_16x16x64_bf16 v[40:43], v[20:23], a[80:87], v3
  v_smfmac_f32_16x16x64_bf16 v[44:47], v[20:23], a[136:143], v3
  v_smfmac_f32_16x16x64_bf16 v[48:51], v[20:23], a[192:199], v3
  v_smfmac_f32_16x16x64_bf16 v[52:55], v[20:23], a[248:255], v3
  v_smfmac_f32_16x16x64_bf16 v[56:59], v[20:23], v[224:231], v3
  s_waitcnt lgkmcnt(0)
  v_smfmac_f32_16x16x64_bf16 v[60:63], v[20:23], v[64:71], v3
  ds_read_b128 v[72:75], v0 offset:8192
  ds_read_b128 v[76:79], v0 offset:9216
  v_smfmac_f32_16x16x64_bf16 v[36:39], v[24:27], a[32:39], v3
  v_smfmac_f32_16x16x64_bf16 v[40:43], v[24:27], a[88:95], v3
  v_smfmac_f32_16x16x64_bf16 v[44:47], v[24:27], a[144:151], v3
  v_smfmac_f32_16x16x64_bf16 v[48:51], v[24:27], a[200:207], v3
  v_smfmac_f32_16x16x64_bf16 v[52:55], v[24:27], v[176:183], v3
  v_smfmac_f32_16x16x64_bf16 v[56:59], v[24:27], v[232:239], v3
  s_waitcnt lgkmcnt(0)
  v_smfmac_f32_16x16x64_bf16 v[60:63], v[24:27], v[72:79], v3
  ds_read_b128 v[144:147], v0 offset:10240
  ds_read_b128 v[148:151], v0 offset:11264
  v_smfmac_f32_16x16x64_bf16 v[36:39], v[28:31], a[40:47], v3
  v_smfmac_f32_16x16x64_bf16 v[40:43], v[28:31], a[96:103], v3
  v_smfmac_f32_16x16x64_bf16 v[44:47], v[28:31], a[152:159], v3
  v_smfmac_f32_16x16x64_bf16 v[48:51], v[28:31], a[208:215], v3
  v_smfmac_f32_16x16x64_bf16 v[52:55], v[28:31], v[184:191], v3
  v_smfmac_f32_16x16x64_bf16 v[56:59], v[28:31], v[240:247], v3
  s_waitcnt lgkmcnt(0)
  v_smfmac_f32_16x16x64_bf16 v[60:63], v[28:31], v[144:151], v3
  ds_read_b128 v[64:67], v0 offset:12288
  ds_read_b128 v[68:71], v0 offset:13312
  v_smfmac_f32_16x16x64_bf16 v[36:39], v[32:35], a[48:55], v3
  v_smfmac_f32_16x16x64_bf16 v[40:43], v[32:35], a[104:111], v3
  v_smfmac_f32_16x16x64_bf16 v[44:47], v[32:35], a[160:167], v3
  v_smfmac_f32_16x16x64_bf16 v[48:51], v[32:35], a[216:223], v3
  v_smfmac_f32_16x16x64_bf16 v[52:55], v[32:35], v[192:199], v3
  v_smfmac_f32_16x16x64_bf16 v[56:59], v[32:35], v[248:255], v3
  s_waitcnt lgkmcnt(0)
  v_smfmac_f32_16x16x64_bf16 v[60:63], v[32:35], v[64:71], v3
  v_permlane32_swap_b32 v36, v38
  v_permlane32_swap_b32 v37, v39
  v_add_f32 v36, v36, v38
  v_add_f32 v37, v37, v39
  v_cvt_pk_bf16_f32 v38, v36, v37
  ds_write_b32 v152, v38
  v_permlane32_swap_b32 v40, v42
  v_permlane32_swap_b32 v41, v43
  v_add_f32 v40, v40, v42
  v_add_f32 v41, v41, v43
  v_cvt_pk_bf16_f32 v42, v40, v41
  ds_write_b32 v153, v42
  v_permlane32_swap_b32 v44, v46
  v_permlane32_swap_b32 v45, v47
  v_add_f32 v44, v44, v46
  v_add_f32 v45, v45, v47
  v_cvt_pk_bf16_f32 v46, v44, v45
  ds_write_b32 v154, v46
  v_permlane32_swap_b32 v48, v50
  v_permlane32_swap_b32 v49, v51
  v_add_f32 v48, v48, v50
  v_add_f32 v49, v49, v51
  v_cvt_pk_bf16_f32 v50, v48, v49
  ds_write_b32 v155, v50
  v_permlane32_swap_b32 v52, v54
  v_permlane32_swap_b32 v53, v55
  v_add_f32 v52, v52, v54
  v_add_f32 v53, v53, v55
  v_cvt_pk_bf16_f32 v54, v52, v53
  ds_write_b32 v156, v54
  v_permlane32_swap_b32 v56, v58
  v_permlane32_swap_b32 v57, v59
  v_add_f32 v56, v56, v58
  v_add_f32 v57, v57, v59
  v_cvt_pk_bf16_f32 v58, v56, v57
  ds_write_b32 v157, v58
  v_permlane32_swap_b32 v60, v62
  v_permlane32_swap_b32 v61, v63
  v_add_f32 v60, v60, v62
  v_add_f32 v61, v61, v63
  v_cvt_pk_bf16_f32 v62, v60, v61
  ds_write_b32 v158, v62
  s_branch cB_va0_t2d
cB_va0_rp:
  s_cmp_lg_u32 s37, 0
  s_cbranch_scc1 cB_va0_cont
cB_va0_rv:
  s_add_u32 s31, s31, 0x10000
  buffer_load_dwordx4 v[8:11], v2, s[8:11], s22 offen offset:0 sc1
  buffer_load_dwordx4 v[12:15], v2, s[8:11], s22 offen offset:1024 sc1
  buffer_load_dwordx4 v[16:19], v2, s[8:11], s22 offen offset:2048 sc1
  buffer_load_dwordx4 v[20:23], v2, s[8:11], s22 offen offset:3072 sc1
  buffer_load_dwordx4 v[24:27], v2, s[8:11], s34 offen offset:0 sc1
  buffer_load_dwordx4 v[28:31], v2, s[8:11], s34 offen offset:1024 sc1
  buffer_load_dwordx4 v[32:35], v2, s[8:11], s34 offen offset:2048 sc1
  buffer_load_dwordx4 v[36:39], v2, s[8:11], s34 offen offset:3072 sc1
  buffer_load_dwordx4 v[40:43], v2, s[8:11], s36 offen offset:0 sc1
  buffer_load_dwordx4 v[44:47], v2, s[8:11], s36 offen offset:1024 sc1
  s_waitcnt vmcnt(0)
  v_max3_u32 v52, v8, v9, v10
  v_max3_u32 v52, v52, v11, v12
  v_max3_u32 v52, v52, v13, v14
  v_max3_u32 v52, v52, v15, v16
  v_max3_u32 v52, v52, v17, v18
  v_max3_u32 v52, v52, v19, v20
  v_max3_u32 v52, v52, v21, v22
  v_max3_u32 v52, v52, v23, v24
  v_max3_u32 v52, v52, v25, v26
  v_max3_u32 v52, v52, v27, v28
  v_max3_u32 v52, v52, v29, v30
  v_max3_u32 v52, v52, v31, v32
  v_max3_u32 v52, v52, v33, v34
  v_max3_u32 v52, v52, v35, v36
  v_max3_u32 v52, v52, v37, v38
  v_max3_u32 v52, v52, v39, v40
  v_max3_u32 v52, v52, v41, v42
  v_max3_u32 v52, v52, v43, v44
  v_max3_u32 v52, v52, v45, v46
  v_max_u32 v52, v52, v47
  v_cmp_eq_u32 vcc, -1, v52
  s_mov_b32 s37, 1
  v_mov_b32 v48, 0
  v_mov_b32 v49, 0
  v_mov_b32 v50, 0
  v_mov_b32 v51, 0
  s_nop 1
  s_cbranch_vccz cB_va0_lp
  s_add_u32 s30, s30, 1
  s_cmp_lt_u32 s30, 400000
  s_cbranch_scc1 cB_va0_rv
  s_branch cB_abort
.p2align 6
cB_va1_loop:
  s_mov_b32 s30, 0
  s_barrier
  buffer_load_dwordx4 v[28:31], v2, s[8:11], s23 offen offset:1024 sc1
  buffer_load_dwordx4 v[32:35], v2, s[8:11], s23 offen offset:2048 sc1
  s_barrier
  buffer_store_dword v160, v1, s[8:11], s38 offen sc1
  s_add_u32 s22, s25, 0
  buffer_load_dwordx4 v[80:83], v6, s[8:11], s22 offen offset:0 sc1
  buffer_load_dwordx4 v[84:87], v6, s[8:11], s22 offen offset:1792 sc1
  s_add_u32 s22, s25, 3584
  buffer_load_dwordx4 v[88:91], v6, s[8:11], s22 offen offset:0 sc1
  buffer_load_dwordx4 v[92:95], v6, s[8:11], s22 offen offset:1792 sc1
  s_add_u32 s22, s25, 7168
  buffer_load_dwordx4 v[96:99], v6, s[8:11], s22 offen offset:0 sc1
  buffer_load_dwordx4 v[100:103], v6, s[8:11], s22 offen offset:1792 sc1
  s_add_u32 s22, s25, 10752
  buffer_load_dwordx4 v[104:107], v6, s[8:11], s22 offen offset:0 sc1
  buffer_load_dwordx4 v[108:111], v6, s[8:11], s22 offen offset:1792 sc1
  s_add_u32 s22, s25, 14336
  buffer_load_dwordx4 v[112:115], v6, s[8:11], s22 offen offset:0 sc1
  buffer_load_dwordx4 v[116:119], v6, s[8:11], s22 offen offset:1792 sc1
  s_add_u32 s22, s25, 17920
  buffer_load_dwordx4 v[120:123], v6, s[8:11], s22 offen offset:0 sc1
  buffer_load_dwordx4 v[124:127], v6, s[8:11], s22 offen offset:1792 sc1
  s_add_u32 s22, s25, 21504
  buffer_load_dwordx4 v[128:131], v6, s[8:11], s22 offen offset:0 sc1
  buffer_load_dwordx4 v[132:135], v6, s[8:11], s22 offen offset:1792 sc1
  s_add_u32 s22, s25, 25088
  buffer_load_dwordx4 v[136:139], v6, s[8:11], s22 offen offset:0 sc1
  buffer_load_dwordx4 v[140:143], v6, s[8:11], s22 offen offset:1792 sc1
  s_mul_i32 s38, s18, 7168
  s_add_u32 s38, s38, 87543808
  s_waitcnt vmcnt(17)
  ds_write_b128 v2, v[32:35] offset:14336
  v_smfmac_f32_16x16x64_bf16 v[36:39], v[28:31], a[40:47], v3
  v_smfmac_f32_16x16x64_bf16 v[40:43], v[28:31], a[96:103], v3
  v_smfmac_f32_16x16x64_bf16 v[44:47], v[28:31], a[152:159], v3
  v_smfmac_f32_16x16x64_bf16 v[48:51], v[28:31], a[208:215], v3
  v_smfmac_f32_16x16x64_bf16 v[52:55], v[28:31], v[184:191], v3
  s_waitcnt lgkmcnt(0)
  s_barrier
  ds_read_b128 v[8:11], v2 offset:8192
  ds_read_b128 v[12:15], v2 offset:9216
  ds_read_b128 v[16:19], v2 offset:10240
  ds_read_b128 v[20:23], v2 offset:11264
  ds_read_b128 v[24:27], v2 offset:12288
  v_smfmac_f32_16x16x64_bf16 v[56:59], v[28:31], v[240:247], v3
  v_smfmac_f32_16x16x64_bf16 v[36:39], v[32:35], a[48:55], v3
  v_smfmac_f32_16x16x64_bf16 v[40:43], v[32:35], a[104:111], v3
  v_smfmac_f32_16x16x64_bf16 v[44:47], v[32:35], a[160:167], v3
  v_smfmac_f32_16x16x64_bf16 v[48:51], v[32:35], a[216:223], v3
  v_smfmac_f32_16x16x64_bf16 v[52:55], v[32:35], v[192:199], v3
  ds_read_b128 v[64:67], v0 offset:0
  ds_read_b128 v[68:71], v0 offset:1024
  v_smfmac_f32_16x16x64_bf16 v[56:59], v[32:35], v[248:255], v3
  s_waitcnt lgkmcnt(6)
  ds_read_b128 v[72:75], v0 offset:2048
  ds_read_b128 v[76:79], v0 offset:3072
  v_smfmac_f32_16x16x64_bf16 v[36:39], v[8:11], a[0:7], v3
  s_waitcnt lgkmcnt(7)
  v_smfmac_f32_16x16x64_bf16 v[36:39], v[12:15], a[8:15], v3
  s_waitcnt lgkmcnt(6)
  v_smfmac_f32_16x16x64_bf16 v[36:39], v[16:19], a[16:23], v3
  s_waitcnt lgkmcnt(2)
  v_smfmac_f32_16x16x64_bf16 v[60:63], v[8:11], v[64:71], v3
  s_waitcnt lgkmcnt(5)
  ds_read_b128 v[144:147], v0 offset:4096
  ds_read_b128 v[148:151], v0 offset:5120
  v_smfmac_f32_16x16x64_bf16 v[36:39], v[20:23], a[24:31], v3
  s_waitcnt lgkmcnt(6)
  v_smfmac_f32_16x16x64_bf16 v[36:39], v[24:27], a[32:39], v3
  v_smfmac_f32_16x16x64_bf16 v[40:43], v[8:11], a[56:63], v3
  s_waitcnt lgkmcnt(2)
  v_smfmac_f32_16x16x64_bf16 v[60:63], v[12:15], v[72:79], v3
  ds_read_b128 v[64:67], v0 offset:6144
  ds_read_b128 v[68:71], v0 offset:7168
  v_smfmac_f32_16x16x64_bf16 v[40:43], v[12:15], a[64:71], v3
  v_permlane32_swap_b32 v36, v38
  v_smfmac_f32_16x16x64_bf16 v[40:43], v[16:19], a[72:79], v3
  v_permlane32_swap_b32 v37, v39
  v_smfmac_f32_16x16x64_bf16 v[40:43], v[20:23], a[80:87], v3
  s_waitcnt lgkmcnt(2)
  v_add_f32 v36, v36, v38
  v_smfmac_f32_16x16x64_bf16 v[60:63], v[16:19], v[144:151], v3
  ds_read_b128 v[72:75], v0 offset:8192
  ds_read_b128 v[76:79], v0 offset:9216
  v_add_f32 v37, v37, v39
  v_smfmac_f32_16x16x64_bf16 v[40:43], v[24:27], a[88:95], v3
  v_cmp_u_f32 vcc, v36, v37
  v_smfmac_f32_16x16x64_bf16 v[44:47], v[8:11], a[112:119], v3
  v_cvt_pk_bf16_f32 v38, v36, v37
  v_smfmac_f32_16x16x64_bf16 v[44:47], v[12:15], a[120:127], v3
  ds_write_b32 v152, v38
  s_waitcnt lgkmcnt(3)
  s_cbranch_vccnz cB_va1_slow
  v_permlane32_swap_b32 v40, v42
  v_smfmac_f32_16x16x64_bf16 v[60:63], v[20:23], v[64:71], v3
  ds_read_b128 v[144:147], v0 offset:10240
  ds_read_b128 v[148:151], v0 offset:11264
  v_permlane32_swap_b32 v41, v43
  v_smfmac_f32_16x16x64_bf16 v[44:47], v[16:19], a[128:135], v3
  buffer_store_dword v162, v1, s[8:11], s21 offen sc1
  v_add_f32 v40, v40, v42
  v_smfmac_f32_16x16x64_bf16 v[44:47], v[20:23], a[136:143], v3
  v_add_f32 v41, v41, v43
  v_smfmac_f32_16x16x64_bf16 v[44:47], v[24:27], a[144:151], v3
  s_waitcnt lgkmcnt(3)
  v_cvt_pk_bf16_f32 v42, v40, v41
  v_smfmac_f32_16x16x64_bf16 v[60:63], v[24:27], v[72:79], v3
  ds_write_b32 v153, v42
  ds_read_b128 v[64:67], v0 offset:12288
  ds_read_b128 v[68:71], v0 offset:13312
  v_smfmac_f32_16x16x64_bf16 v[48:51], v[8:11], a[168:175], v3
  s_nop 0
  v_permlane32_swap_b32 v44, v46
  v_smfmac_f32_16x16x64_bf16 v[48:51], v[12:15], a[176:183], v3
  v_permlane32_swap_b32 v45, v47
  v_smfmac_f32_16x16x64_bf16 v[48:51], v[16:19], a[184:191], v3
  s_waitcnt lgkmcnt(3)
  v_add_f32 v44, v44, v46
  v_smfmac_f32_16x16x64_bf16 v[60:63], v[28:31], v[144:151], v3
  v_add_f32 v45, v45, v47
  v_smfmac_f32_16x16x64_bf16 v[48:51], v[20:23], a[192:199], v3
  v_cvt_pk_bf16_f32 v46, v44, v45
  v_smfmac_f32_16x16x64_bf16 v[48:51], v[24:27], a[200:207], v3
  ds_write_b32 v154, v46
  v_smfmac_f32_16x16x64_bf16 v[52:55], v[8:11], a[224:231], v3
  s_waitcnt lgkmcnt(1)
  v_smfmac_f32_16x16x64_bf16 v[60:63], v[32:35], v[64:71], v3
  v_smfmac_f32_16x16x64_bf16 v[52:55], v[12:15], a[232:239], v3
  v_permlane32_swap_b32 v48, v50
  v_smfmac_f32_16x16x64_bf16 v[52:55], v[16:19], a[240:247], v3
  v_permlane32_swap_b32 v49, v51
  v_smfmac_f32_16x16x64_bf16 v[52:55], v[20:23], a[248:255], v3
  v_add_f32 v48, v48, v50
  v_smfmac_f32_16x16x64_bf16 v[52:55], v[24:27], v[176:183], v3
  v_add_f32 v49, v49, v51
  v_smfmac_f32_16x16x64_bf16 v[56:59], v[8:11], v[200:207], v3
  v_cvt_pk_bf16_f32 v50, v48, v49
  v_smfmac_f32_16x16x64_bf16 v[56:59], v[12:15], v[208:215], v3
  ds_write_b32 v155, v50
  v_permlane32_swap_b32 v60, v62
  v_smfmac_f32_16x16x64_bf16 v[56:59], v[16:19], v[216:223], v3
  v_permlane32_swap_b32 v61, v63
  v_smfmac_f32_16x16x64_bf16 v[56:59], v[20:23], v[224:231], v3
  v_add_f32 v60, v60, v62
  v_smfmac_f32_16x16x64_bf16 v[56:59], v[24:27], v[232:239], v3
  v_add_f32 v61, v61, v63
  v_cvt_pk_bf16_f32 v62, v60, v61
  ds_write_b32 v158, v62
  v_permlane32_swap_b32 v52, v54
  v_permlane32_swap_b32 v53, v55
  v_add_f32 v52, v52, v54
  v_add_f32 v53, v53, v55
  v_cvt_pk_bf16_f32 v54, v52, v53
  ds_write_b32 v156, v54
  v_permlane32_swap_b32 v56, v58
  v_permlane32_swap_b32 v57, v59
  v_add_f32 v56, v56, v58
  v_add_f32 v57, v57, v59
  v_cvt_pk_bf16_f32 v58, v56, v57
  ds_write_b32 v157, v58
cB_va1_t2d:
  s_add_u32 s22, s20, 9216
  s_add_u32 s34, s20, 13312
  s_add_u32 s36, s20, 7168
  s_mov_b32 s37, 0
  v_mov_b32 v48, 0
  v_mov_b32 v49, 0
  v_mov_b32 v50, 0
  v_mov_b32 v51, 0
  v_mov_b32 v163, s18
  s_waitcnt lgkmcnt(0)
  s_barrier
  buffer_load_dwordx4 v[8:11], v2, s[8:11], s22 offen offset:0 sc1
  buffer_load_dwordx4 v[12:15], v2, s[8:11], s22 offen offset:1024 sc1
  buffer_load_dwordx4 v[16:19], v2, s[8:11], s22 offen offset:2048 sc1
  buffer_load_dwordx4 v[20:23], v2, s[8:11], s22 offen offset:3072 sc1
  buffer_load_dwordx4 v[24:27], v2, s[8:11], s34 offen offset:0 sc1
  buffer_load_dwordx4 v[28:31], v2, s[8:11], s34 offen offset:1024 sc1
  buffer_load_dwordx4 v[32:35], v2, s[8:11], s34 offen offset:2048 sc1
  buffer_load_dwordx4 v[36:39], v2, s[8:11], s34 offen offset:3072 sc1
  buffer_load_dwordx4 v[40:43], v2, s[8:11], s36 offen offset:0 sc1
  buffer_load_dwordx4 v[44:47], v2, s[8:11], s36 offen offset:1024 sc1
  ds_read_b128 v[64:67], v2 offset:4096
  ds_read_b128 v[68:71], v2 offset:5120
  ds_read_b128 v[72:75], v2 offset:6144
  ds_read_b128 v[76:79], v2 offset:7168
cB_va1_lp:
  s_waitcnt vmcnt(9)
  v_smfmac_f32_16x16x64_bf16 v[48:51], v[8:11], v[80:87], v3
  s_waitcnt vmcnt(8)
  v_smfmac_f32_16x16x64_bf16 v[48:51], v[12:15], v[88:95], v3
  s_waitcnt vmcnt(7)
  v_smfmac_f32_16x16x64_bf16 v[48:51], v[16:19], v[96:103], v3
  v_max3_u32 v55, v8, v12, v16
  s_waitcnt vmcnt(6)
  v_smfmac_f32_16x16x64_bf16 v[48:51], v[20:23], v[104:111], v3
  v_max_u32 v55, v55, v20
  v_cmp_eq_u32 vcc, -1, v55
  s_waitcnt vmcnt(5)
  v_smfmac_f32_16x16x64_bf16 v[48:51], v[24:27], v[112:119], v3
  s_waitcnt vmcnt(4)
  v_smfmac_f32_16x16x64_bf16 v[48:51], v[28:31], v[120:127], v3
  s_cbranch_vccnz cB_va1_rv
  buffer_store_dword v163, v7, s[8:11], 0 offen sc1
  s_waitcnt vmcnt(4)
  v_smfmac_f32_16x16x64_bf16 v[48:51], v[32:35], v[128:135], v3
  s_waitcnt vmcnt(3)
  v_smfmac_f32_16x16x64_bf16 v[48:51], v[36:39], v[136:143], v3
  s_waitcnt vmcnt(2) lgkmcnt(0)
  v_smfmac_f32_16x16x64_bf16 v[48:51], v[40:43], v[64:71], v3
  s_waitcnt vmcnt(1)
  v_smfmac_f32_16x16x64_bf16 v[48:51], v[44:47], v[72:79], v3
  s_nop 7
  v_permlane32_swap_b32 v48, v50
  v_permlane32_swap_b32 v49, v51
  v_add_f32 v48, v48, v50
  v_add_f32 v49, v49, v51
  v_cvt_pk_bf16_f32 v160, v48, v49
  v_cmp_u_f32 vcc, v48, v49
  s_nop 0
  v_mov_b32_dpp v161, v160 quad_perm:[1,0,3,2] row_mask:0xf bank_mask:0xf
  v_perm_b32 v160, v161, v160, v5
  v_min_u32 v160, -2, v160
  s_cbranch_vccnz cB_va1_rp
cB_va1_cont:
  buffer_store_dword v160, v1, s[8:11], s21 offen sc1
  s_cmp_lg_u32 s19, 62
  s_cbranch_scc1 cB_va1_nl
  buffer_store_dword v160, v1, s[8:11], s38 offen sc1
  s_branch cB_done
cB_va1_nl:
  s_add_u32 s25, s25, 28672
  v_mov_b32 v36, 0
  v_mov_b32 v37, 0
  v_mov_b32 v38, 0
  v_mov_b32 v39, 0
  v_mov_b32 v40, 0
  v_mov_b32 v41, 0
  v_mov_b32 v42, 0
  v_mov_b32 v43, 0
  v_mov_b32 v44, 0
  v_mov_b32 v45, 0
  v_mov_b32 v46, 0
  v_mov_b32 v47, 0
  v_mov_b32 v48, 0
  v_mov_b32 v49, 0
  v_mov_b32 v50, 0
  v_mov_b32 v51, 0
  v_mov_b32 v52, 0
  v_mov_b32 v53, 0
  v_mov_b32 v54, 0
  v_mov_b32 v55, 0
  v_mov_b32 v56, 0
  v_mov_b32 v57, 0
  v_mov_b32 v58, 0
  v_mov_b32 v59, 0
  v_mov_b32 v60, 0
  v_mov_b32 v61, 0
  v_mov_b32 v62, 0
  v_mov_b32 v63, 0
  s_mov_b32 s19, s18
  s_add_u32 s18, s18, 1
  s_mov_b32 s22, s20
  s_mov_b32 s20, s21
  s_mov_b32 s21, s22
  s_add_u32 s23, s20, 4096
  s_branch cB_va1_loop
cB_va1_slow:
  s_waitcnt lgkmcnt(0)
cB_va1_sl1:
  s_add_u32 s31, s31, 0x1000000
  buffer_load_dwordx4 v[8:11], v2, s[8:11], s20 offen offset:0 sc1
  buffer_load_dwordx4 v[12:15], v2, s[8:11], s20 offen offset:1024 sc1
  buffer_load_dwordx4 v[16:19], v2, s[8:11], s20 offen offset:2048 sc1
  buffer_load_dwordx4 v[20:23], v2, s[8:11], s20 offen offset:3072 sc1
  buffer_load_dwordx4 v[24:27], v2, s[8:11], s23 offen offset:0 sc1
  buffer_load_dwordx4 v[28:31], v2, s[8:11], s23 offen offset:1024 sc1
  buffer_load_dwordx4 v[32:35], v2, s[8:11], s23 offen offset:2048 sc1
  s_waitcnt vmcnt(0)
  v_max3_u32 v36, v8, v9, v10
  v_max3_u32 v36, v36, v11, v12
  v_max3_u32 v36, v36, v13, v14
  v_max3_u32 v36, v36, v15, v16
  v_max3_u32 v36, v36, v17, v18
  v_max3_u32 v36, v36, v19, v20
  v_max3_u32 v36, v36, v21, v22
  v_max3_u32 v36, v36, v23, v24
  v_max3_u32 v36, v36, v25, v26
  v_max3_u32 v36, v36, v27, v28
  v_max3_u32 v36, v36, v29, v30
  v_max3_u32 v36, v36, v31, v32
  v_max3_u32 v36, v36, v33, v34
  v_max_u32 v36, v36, v35
  v_cmp_eq_u32 vcc, -1, v36
  s_cbranch_vccz cB_va1_sl2
  s_add_u32 s30, s30, 1
  s_cmp_lt_u32 s30, 400000
  s_cbranch_scc1 cB_va1_sl1
  s_branch cB_abort
cB_va1_sl2:
  v_mov_b32 v36, 0
  v_mov_b32 v37, 0
  v_mov_b32 v38, 0
  v_mov_b32 v39, 0
  v_mov_b32 v40, 0
  v_mov_b32 v41, 0
  v_mov_b32 v42, 0
  v_mov_b32 v43, 0
  v_mov_b32 v44, 0
  v_mov_b32 v45, 0
  v_mov_b32 v46, 0
  v_mov_b32 v47, 0
  v_mov_b32 v48, 0
  v_mov_b32 v49, 0
  v_mov_b32 v50, 0
  v_mov_b32 v51, 0
  v_mov_b32 v52, 0
  v_mov_b32 v53, 0
  v_mov_b32 v54, 0
  v_mov_b32 v55, 0
  v_mov_b32 v56, 0
  v_mov_b32 v57, 0
  v_mov_b32 v58, 0
  v_mov_b32 v59, 0
  v_mov_b32 v60, 0
  v_mov_b32 v61, 0
  v_mov_b32 v62, 0
  v_mov_b32 v63, 0
  buffer_store_dword v162, v1, s[8:11], s21 offen sc1
  ds_read_b128 v[64:67], v0 offset:0
  ds_read_b128 v[68:71], v0 offset:1024
  v_smfmac_f32_16x16x64_bf16 v[36:39], v[8:11], a[0:7], v3
  v_smfmac_f32_16x16x64_bf16 v[40:43], v[8:11], a[56:63], v3
  v_smfmac_f32_16x16x64_bf16 v[44:47], v[8:11], a[112:119], v3
  v_smfmac_f32_16x16x64_bf16 v[48:51], v[8:11], a[168:175], v3
  v_smfmac_f32_16x16x64_bf16 v[52:55], v[8:11], a[224:231], v3
  v_smfmac_f32_16x16x64_bf16 v[56:59], v[8:11], v[200:207], v3
  s_waitcnt lgkmcnt(0)
  v_smfmac_f32_16x16x64_bf16 v[60:63], v[8:11], v[64:71], v3
  ds_read_b128 v[72:75], v0 offset:2048
  ds_read_b128 v[76:79], v0 offset:3072
  v_smfmac_f32_16x16x64_bf16 v[36:39], v[12:15], a[8:15], v3
  v_smfmac_f32_16x16x64_bf16 v[40:43], v[12:15], a[64:71], v3
  v_smfmac_f32_16x16x64_bf16 v[44:47], v[12:15], a[120:127], v3
  v_smfmac_f32_16x16x64_bf16 v[48:51], v[12:15], a[176:183], v3
  v_smfmac_f32_16x16x64_bf16 v[52:55], v[12:15], a[232:239], v3
  v_smfmac_f32_16x16x64_bf16 v[56:59], v[12:15], v[208:215], v3
  s_waitcnt lgkmcnt(0)
  v_smfmac_f32_16x16x64_bf16 v[60:63], v[12:15], v[72:79], v3
  ds_read_b128 v[144:147], v0 offset:4096
  ds_read_b128 v[148:151], v0 offset:5120
  v_smfmac_f32_16x16x64_bf16 v[36:39], v[16:19], a[16:23], v3
  v_smfmac_f32_16x16x64_bf16 v[40:43], v[16:19], a[72:79], v3
  v_smfmac_f32_16x16x64_bf16 v[44:47], v[16:19], a[128:135], v3
  v_smfmac_f32_16x16x64_bf16 v[48:51], v[16:19], a[184:191], v3
  v_smfmac_f32_16x16x64_bf16 v[52:55], v[16:19], a[240:247], v3
  v_smfmac_f32_16x16x64_bf16 v[56:59], v[16:19], v[216:223], v3
  s_waitcnt lgkmcnt(0)
  v_smfmac_f32_16x16x64_bf16 v[60:63], v[16:19], v[144:151], v3
  ds_read_b128 v[64:67], v0 offset:6144
  ds_read_b128 v[68:71], v0 offset:7168
  v_smfmac_f32_16x16x64_bf16 v[36:39], v[20:23], a[24:31], v3
  v_smfmac_f32_16x16x64_bf16 v[40:43], v[20:23], a[80:87], v3
  v_smfmac_f32_16x16x64_bf16 v[44:47], v[20:23], a[136:143], v3
  v_smfmac_f32_16x16x64_bf16 v[48:51], v[20:23], a[192:199], v3
  v_smfmac_f32_16x16x64_bf16 v[52:55], v[20:23], a[248:255], v3
  v_smfmac_f32_16x16x64_bf16 v[56:59], v[20:23], v[224:231], v3
  s_waitcnt lgkmcnt(0)
  v_smfmac_f32_16x16x64_bf16 v[60:63], v[20:23], v[64:71], v3
  ds_read_b128 v[72:75], v0 offset:8192
  ds_read_b128 v[76:79], v0 offset:9216
  v_smfmac_f32_16x16x64_bf16 v[36:39], v[24:27], a[32:39], v3
  v_smfmac_f32_16x16x64_bf16 v[40:43], v[24:27], a[88:95], v3
  v_smfmac_f32_16x16x64_bf16 v[44:47], v[24:27], a[144:151], v3
  v_smfmac_f32_16x16x64_bf16 v[48:51], v[24:27], a[200:207], v3
  v_smfmac_f32_16x16x64_bf16 v[52:55], v[24:27], v[176:183], v3
  v_smfmac_f32_16x16x64_bf16 v[56:59], v[24:27], v[232:239], v3
  s_waitcnt lgkmcnt(0)
  v_smfmac_f32_16x16x64_bf16 v[60:63], v[24:27], v[72:79], v3
  ds_read_b128 v[144:147], v0 offset:10240
  ds_read_b128 v[148:151], v0 offset:11264
  v_smfmac_f32_16x16x64_bf16 v[36:39], v[28:31], a[40:47], v3
  v_smfmac_f32_16x16x64_bf16 v[40:43], v[28:31], a[96:103], v3
  v_smfmac_f32_16x16x64_bf16 v[44:47], v[28:31], a[152:159], v3
  v_smfmac_f32_16x16x64_bf16 v[48:51], v[28:31], a[208:215], v3
  v_smfmac_f32_16x16x64_bf16 v[52:55], v[28:31], v[184:191], v3
  v_smfmac_f32_16x16x64_bf16 v[56:59], v[28:31], v[240:247], v3
  s_waitcnt lgkmcnt(0)
  v_smfmac_f32_16x16x64_bf16 v[60:63], v[28:31], v[144:151], v3
  ds_read_b128 v[64:67], v0 offset:12288
  ds_read_b128 v[68:71], v0 offset:13312
  v_smfmac_f32_16x16x64_bf16 v[36:39], v[32:35], a[48:55], v3
  v_smfmac_f32_16x16x64_bf16 v[40:43], v[32:35], a[104:111], v3
  v_smfmac_f32_16x16x64_bf16 v[44:47], v[32:35], a[160:167], v3
  v_smfmac_f32_16x16x64_bf16 v[48:51], v[32:35], a[216:223], v3
  v_smfmac_f32_16x16x64_bf16 v[52:55], v[32:35], v[192:199], v3
  v_smfmac_f32_16x16x64_bf16 v[56:59], v[32:35], v[248:255], v3
  s_waitcnt lgkmcnt(0)
  v_smfmac_f32_16x16x64_bf16 v[60:63], v[32:35], v[64:71], v3
  v_permlane32_swap_b32 v36, v38
  v_permlane32_swap_b32 v37, v39
  v_add_f32 v36, v36, v38
  v_add_f32 v37, v37, v39
  v_cvt_pk_bf16_f32 v38, v36, v37
  ds_write_b32 v152, v38
  v_permlane32_swap_b32 v40, v42
  v_permlane32_swap_b32 v41, v43
  v_add_f32 v40, v40, v42
  v_add_f32 v41, v41, v43
  v_cvt_pk_bf16_f32 v42, v40, v41
  ds_write_b32 v153, v42
  v_permlane32_swap_b32 v44, v46
  v_permlane32_swap_b32 v45, v47
  v_add_f32 v44, v44, v46
  v_add_f32 v45, v45, v47
  v_cvt_pk_bf16_f32 v46, v44, v45
  ds_write_b32 v154, v46
  v_permlane32_swap_b32 v48, v50
  v_permlane32_swap_b32 v49, v51
  v_add_f32 v48, v48, v50
  v_add_f32 v49, v49, v51
  v_cvt_pk_bf16_f32 v50, v48, v49
  ds_write_b32 v155, v50
  v_permlane32_swap_b32 v52, v54
  v_permlane32_swap_b32 v53, v55
  v_add_f32 v52, v52, v54
  v_add_f32 v53, v53, v55
  v_cvt_pk_bf16_f32 v54, v52, v53
  ds_write_b32 v156, v54
  v_permlane32_swap_b32 v56, v58
  v_permlane32_swap_b32 v57, v59
  v_add_f32 v56, v56, v58
  v_add_f32 v57, v57, v59
  v_cvt_pk_bf16_f32 v58, v56, v57
  ds_write_b32 v157, v58
  v_permlane32_swap_b32 v60, v62
  v_permlane32_swap_b32 v61, v63
  v_add_f32 v60, v60, v62
  v_add_f32 v61, v61, v63
  v_cvt_pk_bf16_f32 v62, v60, v61
  ds_write_b32 v158, v62
  s_branch cB_va1_t2d
cB_va1_rp:
  s_cmp_lg_u32 s37, 0
  s_cbranch_scc1 cB_va1_cont
cB_va1_rv:
  s_add_u32 s31, s31, 0x10000
  buffer_load_dwordx4 v[8:11], v2, s[8:11], s22 offen offset:0 sc1
  buffer_load_dwordx4 v[12:15], v2, s[8:11], s22 offen offset:1024 sc1
  buffer_load_dwordx4 v[16:19], v2, s[8:11], s22 offen offset:2048 sc1
  buffer_load_dwordx4 v[20:23], v2, s[8:11], s22 offen offset:3072 sc1
  buffer_load_dwordx4 v[24:27], v2, s[8:11], s34 offen offset:0 sc1
  buffer_load_dwordx4 v[28:31], v2, s[8:11], s34 offen offset:1024 sc1
  buffer_load_dwordx4 v[32:35], v2, s[8:11], s34 offen offset:2048 sc1
  buffer_load_dwordx4 v[36:39], v2, s[8:11], s34 offen offset:3072 sc1
  buffer_load_dwordx4 v[40:43], v2, s[8:11], s36 offen offset:0 sc1
  buffer_load_dwordx4 v[44:47], v2, s[8:11], s36 offen offset:1024 sc1
  s_waitcnt vmcnt(0)
  v_max3_u32 v52, v8, v9, v10
  v_max3_u32 v52, v52, v11, v12
  v_max3_u32 v52, v52, v13, v14
  v_max3_u32 v52, v52, v15, v16
  v_max3_u32 v52, v52, v17, v18
  v_max3_u32 v52, v52, v19, v20
  v_max3_u32 v52, v52, v21, v22
  v_max3_u32 v52, v52, v23, v24
  v_max3_u32 v52, v52, v25, v26
  v_max3_u32 v52, v52, v27, v28
  v_max3_u32 v52, v52, v29, v30
  v_max3_u32 v52, v52, v31, v32
  v_max3_u32 v52, v52, v33, v34
  v_max3_u32 v52, v52, v35, v36
  v_max3_u32 v52, v52, v37, v38
  v_max3_u32 v52, v52, v39, v40
  v_max3_u32 v52, v52, v41, v42
  v_max3_u32 v52, v52, v43, v44
  v_max3_u32 v52, v52, v45, v46
  v_max_u32 v52, v52, v47
  v_cmp_eq_u32 vcc, -1, v52
  s_mov_b32 s37, 1
  v_mov_b32 v48, 0
  v_mov_b32 v49, 0
  v_mov_b32 v50, 0
  v_mov_b32 v51, 0
  s_nop 1
  s_cbranch_vccz cB_va1_lp
  s_add_u32 s30, s30, 1
  s_cmp_lt_u32 s30, 400000
  s_cbranch_scc1 cB_va1_rv
  s_branch cB_abort
.p2align 6
cB_va2_loop:
  s_mov_b32 s30, 0
  buffer_load_dword v100, v119, s[8:11], 0 offen sc1
  buffer_load_dword v101, v119, s[8:11], 0 offen sc1
  buffer_load_dword v102, v119, s[8:11], 0 offen sc1
cB_va2_fp_l:
  s_waitcnt vmcnt(2)
  v_cmp_gt_u32 vcc, s19, v100
  s_cbranch_vccz cB_va2_fp_d
  buffer_load_dword v100, v119, s[8:11], 0 offen sc1
  s_waitcnt vmcnt(2)
  v_cmp_gt_u32 vcc, s19, v101
  s_cbranch_vccz cB_va2_fp_d
  buffer_load_dword v101, v119, s[8:11], 0 offen sc1
  s_waitcnt vmcnt(2)
  v_cmp_gt_u32 vcc, s19, v102
  s_cbranch_vccz cB_va2_fp_d
  buffer_load_dword v102, v119, s[8:11], 0 offen sc1
  s_add_u32 s30, s30, 1
  s_cmp_lt_u32 s30, 400000
  s_cbranch_scc1 cB_va2_fp_l
  s_branch cB_abort
cB_va2_fp_d:
  buffer_load_dwordx4 v[8:11], v2, s[8:11], s20 offen offset:0 sc1
  buffer_load_dwordx4 v[12:15], v2, s[8:11], s20 offen offset:1024 sc1
  s_barrier
  s_barrier
  s_waitcnt vmcnt(0)
  ds_write_b128 v2, v[8:11] offset:8192
  ds_write_b128 v2, v[12:15] offset:9216
  v_smfmac_f32_16x16x64_bf16 v[36:39], v[8:11], a[0:7], v3
  v_smfmac_f32_16x16x64_bf16 v[40:43], v[8:11], a[56:63], v3
  v_smfmac_f32_16x16x64_bf16 v[44:47], v[8:11], a[112:119], v3
  v_smfmac_f32_16x16x64_bf16 v[48:51], v[8:11], a[168:175], v3
  v_smfmac_f32_16x16x64_bf16 v[52:55], v[8:11], a[224:231], v3
  s_waitcnt lgkmcnt(0)
  s_barrier
  ds_read_b128 v[16:19], v2 offset:10240
  ds_read_b128 v[20:23], v2 offset:11264
  ds_read_b128 v[24:27], v2 offset:12288
  ds_read_b128 v[28:31], v2 offset:13312
  ds_read_b128 v[32:35], v2 offset:14336
  v_smfmac_f32_16x16x64_bf16 v[56:59], v[8:11], v[144:151], v3
  v_smfmac_f32_16x16x64_bf16 v[60:63], v[8:11], v[200:207], v3
  v_smfmac_f32_16x16x64_bf16 v[36:39], v[12:15], a[8:15], v3
  v_smfmac_f32_16x16x64_bf16 v[40:43], v[12:15], a[64:71], v3
  v_smfmac_f32_16x16x64_bf16 v[44:47], v[12:15], a[120:127], v3
  v_smfmac_f32_16x16x64_bf16 v[48:51], v[12:15], a[176:183], v3
  v_smfmac_f32_16x16x64_bf16 v[52:55], v[12:15], a[232:239], v3
  v_smfmac_f32_16x16x64_bf16 v[56:59], v[12:15], v[152:159], v3
  v_smfmac_f32_16x16x64_bf16 v[60:63], v[12:15], v[208:215], v3
  s_waitcnt lgkmcnt(4)
  v_smfmac_f32_16x16x64_bf16 v[36:39], v[16:19], a[16:23], v3
  s_waitcnt lgkmcnt(3)
  v_smfmac_f32_16x16x64_bf16 v[36:39], v[20:23], a[24:31], v3
  s_waitcnt lgkmcnt(2)
  v_smfmac_f32_16x16x64_bf16 v[36:39], v[24:27], a[32:39], v3
  s_waitcnt lgkmcnt(1)
  v_smfmac_f32_16x16x64_bf16 v[36:39], v[28:31], a[40:47], v3
  s_waitcnt lgkmcnt(0)
  v_smfmac_f32_16x16x64_bf16 v[36:39], v[32:35], a[48:55], v3
  v_smfmac_f32_16x16x64_bf16 v[40:43], v[16:19], a[72:79], v3
  v_smfmac_f32_16x16x64_bf16 v[40:43], v[20:23], a[80:87], v3
  v_smfmac_f32_16x16x64_bf16 v[40:43], v[24:27], a[88:95], v3
  v_permlane32_swap_b32 v36, v38
  v_smfmac_f32_16x16x64_bf16 v[40:43], v[28:31], a[96:103], v3
  v_permlane32_swap_b32 v37, v39
  v_smfmac_f32_16x16x64_bf16 v[40:43], v[32:35], a[104:111], v3
  v_add_f32 v36, v36, v38
  v_smfmac_f32_16x16x64_bf16 v[44:47], v[16:19], a[128:135], v3
  v_add_f32 v37, v37, v39
  v_smfmac_f32_16x16x64_bf16 v[44:47], v[20:23], a[136:143], v3
  v_cmp_u_f32 vcc, v36, v37
  v_smfmac_f32_16x16x64_bf16 v[44:47], v[24:27], a[144:151], v3
  v_cvt_pk_bf16_f32 v38, v36, v37
  v_smfmac_f32_16x16x64_bf16 v[44:47], v[28:31], a[152:159], v3
  ds_write_b32 v104, v38
  s_cbranch_vccnz cB_va2_slow
  v_permlane32_swap_b32 v40, v42
  v_smfmac_f32_16x16x64_bf16 v[44:47], v[32:35], a[160:167], v3
  v_permlane32_swap_b32 v41, v43
  v_smfmac_f32_16x16x64_bf16 v[48:51], v[16:19], a[184:191], v3
  v_add_f32 v40, v40, v42
  v_smfmac_f32_16x16x64_bf16 v[48:51], v[20:23], a[192:199], v3
  v_add_f32 v41, v41, v43
  v_smfmac_f32_16x16x64_bf16 v[48:51], v[24:27], a[200:207], v3
  v_cvt_pk_bf16_f32 v42, v40, v41
  v_smfmac_f32_16x16x64_bf16 v[48:51], v[28:31], a[208:215], v3
  ds_write_b32 v105, v42
  v_permlane32_swap_b32 v44, v46
  v_smfmac_f32_16x16x64_bf16 v[48:51], v[32:35], a[216:223], v3
  v_permlane32_swap_b32 v45, v47
  v_smfmac_f32_16x16x64_bf16 v[52:55], v[16:19], a[240:247], v3
  v_add_f32 v44, v44, v46
  v_smfmac_f32_16x16x64_bf16 v[52:55], v[20:23], a[248:255], v3
  v_add_f32 v45, v45, v47
  v_smfmac_f32_16x16x64_bf16 v[52:55], v[24:27], v[120:127], v3
  v_cvt_pk_bf16_f32 v46, v44, v45
  v_smfmac_f32_16x16x64_bf16 v[52:55], v[28:31], v[128:135], v3
  ds_write_b32 v106, v46
  v_permlane32_swap_b32 v48, v50
  v_smfmac_f32_16x16x64_bf16 v[52:55], v[32:35], v[136:143], v3
  v_permlane32_swap_b32 v49, v51
  v_smfmac_f32_16x16x64_bf16 v[56:59], v[16:19], v[160:167], v3
  v_add_f32 v48, v48, v50
  v_smfmac_f32_16x16x64_bf16 v[56:59], v[20:23], v[168:175], v3
  v_add_f32 v49, v49, v51
  v_smfmac_f32_16x16x64_bf16 v[56:59], v[24:27], v[176:183], v3
  v_cvt_pk_bf16_f32 v50, v48, v49
  v_smfmac_f32_16x16x64_bf16 v[56:59], v[28:31], v[184:191], v3
  ds_write_b32 v107, v50
  v_permlane32_swap_b32 v52, v54
  v_smfmac_f32_16x16x64_bf16 v[56:59], v[32:35], v[192:199], v3
  v_permlane32_swap_b32 v53, v55
  v_smfmac_f32_16x16x64_bf16 v[60:63], v[16:19], v[216:223], v3
  v_add_f32 v52, v52, v54
  v_smfmac_f32_16x16x64_bf16 v[60:63], v[20:23], v[224:231], v3
  v_add_f32 v53, v53, v55
  v_smfmac_f32_16x16x64_bf16 v[60:63], v[24:27], v[232:239], v3
  v_cvt_pk_bf16_f32 v54, v52, v53
  v_smfmac_f32_16x16x64_bf16 v[60:63], v[28:31], v[240:247], v3
  ds_write_b32 v108, v54
  v_permlane32_swap_b32 v56, v58
  v_smfmac_f32_16x16x64_bf16 v[60:63], v[32:35], v[248:255], v3
  v_permlane32_swap_b32 v57, v59
  v_add_f32 v56, v56, v58
  v_add_f32 v57, v57, v59
  v_cvt_pk_bf16_f32 v58, v56, v57
  ds_write_b32 v109, v58
  s_nop 2
  v_permlane32_swap_b32 v60, v62
  v_permlane32_swap_b32 v61, v63
  v_add_f32 v60, v60, v62
  v_add_f32 v61, v61, v63
  v_cvt_pk_bf16_f32 v62, v60, v61
  ds_write_b32 v110, v62
cB_va2_t2d:
  v_mov_b32 v117, s18
  s_waitcnt lgkmcnt(0)
  s_barrier
  s_cmp_eq_u32 s19, 62
  s_cbranch_scc1 cB_done
  s_sleep 1
  v_mov_b32 v36, 0
  v_mov_b32 v37, 0
  v_mov_b32 v38, 0
  v_mov_b32 v39, 0
  v_mov_b32 v40, 0
  v_mov_b32 v41, 0
  v_mov_b32 v42, 0
  v_mov_b32 v43, 0
  v_mov_b32 v44, 0
  v_mov_b32 v45, 0
  v_mov_b32 v46, 0
  v_mov_b32 v47, 0
  v_mov_b32 v48, 0
  v_mov_b32 v49, 0
  v_mov_b32 v50, 0
  v_mov_b32 v51, 0
  v_mov_b32 v52, 0
  v_mov_b32 v53, 0
  v_mov_b32 v54, 0
  v_mov_b32 v55, 0
  v_mov_b32 v56, 0
  v_mov_b32 v57, 0
  v_mov_b32 v58, 0
  v_mov_b32 v59, 0
  v_mov_b32 v60, 0
  v_mov_b32 v61, 0
  v_mov_b32 v62, 0
  v_mov_b32 v63, 0
  s_sleep 3
  s_mov_b32 s19, s18
  s_add_u32 s18, s18, 1
  s_mov_b32 s22, s20
  s_mov_b32 s20, s21
  s_mov_b32 s21, s22
  s_add_u32 s23, s20, 4096
  s_branch cB_va2_loop
cB_va2_slow:
  s_waitcnt lgkmcnt(0)
cB_va2_sl1:
  s_add_u32 s31, s31, 0x1000000
  buffer_load_dwordx4 v[8:11], v2, s[8:11], s20 offen offset:0 sc1
  buffer_load_dwordx4 v[12:15], v2, s[8:11], s20 offen offset:1024 sc1
  buffer_load_dwordx4 v[16:19], v2, s[8:11], s20 offen offset:2048 sc1
  buffer_load_dwordx4 v[20:23], v2, s[8:11], s20 offen offset:3072 sc1
  buffer_load_dwordx4 v[24:27], v2, s[8:11], s23 offen offset:0 sc1
  buffer_load_dwordx4 v[28:31], v2, s[8:11], s23 offen offset:1024 sc1
  buffer_load_dwordx4 v[32:35], v2, s[8:11], s23 offen offset:2048 sc1
  s_waitcnt vmcnt(0)
  v_max3_u32 v36, v8, v9, v10
  v_max3_u32 v36, v36, v11, v12
  v_max3_u32 v36, v36, v13, v14
  v_max3_u32 v36, v36, v15, v16
  v_max3_u32 v36, v36, v17, v18
  v_max3_u32 v36, v36, v19, v20
  v_max3_u32 v36, v36, v21, v22
  v_max3_u32 v36, v36, v23, v24
  v_max3_u32 v36, v36, v25, v26
  v_max3_u32 v36, v36, v27, v28
  v_max3_u32 v36, v36, v29, v30
  v_max3_u32 v36, v36, v31, v32
  v_max3_u32 v36, v36, v33, v34
  v_max_u32 v36, v36, v35
  v_cmp_eq_u32 vcc, -1, v36
  s_cbranch_vccz cB_va2_sl2
  s_add_u32 s30, s30, 1
  s_cmp_lt_u32 s30, 400000
  s_cbranch_scc1 cB_va2_sl1
  s_branch cB_abort
cB_va2_sl2:
  v_mov_b32 v36, 0
  v_mov_b32 v37, 0
  v_mov_b32 v38, 0
  v_mov_b32 v39, 0
  v_mov_b32 v40, 0
  v_mov_b32 v41, 0
  v_mov_b32 v42, 0
  v_mov_b32 v43, 0
  v_mov_b32 v44, 0
  v_mov_b32 v45, 0
  v_mov_b32 v46, 0
  v_mov_b32 v47, 0
  v_mov_b32 v48, 0
  v_mov_b32 v49, 0
  v_mov_b32 v50, 0
  v_mov_b32 v51, 0
  v_mov_b32 v52, 0
  v_mov_b32 v53, 0
  v_mov_b32 v54, 0
  v_mov_b32 v55, 0
  v_mov_b32 v56, 0
  v_mov_b32 v57, 0
  v_mov_b32 v58, 0
  v_mov_b32 v59, 0
  v_mov_b32 v60, 0
  v_mov_b32 v61, 0
  v_mov_b32 v62, 0
  v_mov_b32 v63, 0
  v_smfmac_f32_16x16x64_bf16 v[36:39], v[8:11], a[0:7], v3
  v_smfmac_f32_16x16x64_bf16 v[40:43], v[8:11], a[56:63], v3
  v_smfmac_f32_16x16x64_bf16 v[44:47], v[8:11], a[112:119], v3
  v_smfmac_f32_16x16x64_bf16 v[48:51], v[8:11], a[168:175], v3
  v_smfmac_f32_16x16x64_bf16 v[52:55], v[8:11], a[224:231], v3
  v_smfmac_f32_16x16x64_bf16 v[56:59], v[8:11], v[144:151], v3
  v_smfmac_f32_16x16x64_bf16 v[60:63], v[8:11], v[200:207], v3
  v_smfmac_f32_16x16x64_bf16 v[36:39], v[12:15], a[8:15], v3
  v_smfmac_f32_16x16x64_bf16 v[40:43], v[12:15], a[64:71], v3
  v_smfmac_f32_16x16x64_bf16 v[44:47], v[12:15], a[120:127], v3
  v_smfmac_f32_16x16x64_bf16 v[48:51], v[12:15], a[176:183], v3
  v_smfmac_f32_16x16x64_bf16 v[52:55], v[12:15], a[232:239], v3
  v_smfmac_f32_16x16x64_bf16 v[56:59], v[12:15], v[152:159], v3
  v_smfmac_f32_16x16x64_bf16 v[60:63], v[12:15], v[208:215], v3
  v_smfmac_f32_16x16x64_bf16 v[36:39], v[16:19], a[16:23], v3
  v_smfmac_f32_16x16x64_bf16 v[40:43], v[16:19], a[72:79], v3
  v_smfmac_f32_16x16x64_bf16 v[44:47], v[16:19], a[128:135], v3
  v_smfmac_f32_16x16x64_bf16 v[48:51], v[16:19], a[184:191], v3
  v_smfmac_f32_16x16x64_bf16 v[52:55], v[16:19], a[240:247], v3
  v_smfmac_f32_16x16x64_bf16 v[56:59], v[16:19], v[160:167], v3
  v_smfmac_f32_16x16x64_bf16 v[60:63], v[16:19], v[216:223], v3
  v_smfmac_f32_16x16x64_bf16 v[36:39], v[20:23], a[24:31], v3
  v_smfmac_f32_16x16x64_bf16 v[40:43], v[20:23], a[80:87], v3
  v_smfmac_f32_16x16x64_bf16 v[44:47], v[20:23], a[136:143], v3
  v_smfmac_f32_16x16x64_bf16 v[48:51], v[20:23], a[192:199], v3
  v_smfmac_f32_16x16x64_bf16 v[52:55], v[20:23], a[248:255], v3
  v_smfmac_f32_16x16x64_bf16 v[56:59], v[20:23], v[168:175], v3
  v_smfmac_f32_16x16x64_bf16 v[60:63], v[20:23], v[224:231], v3
  v_smfmac_f32_16x16x64_bf16 v[36:39], v[24:27], a[32:39], v3
  v_smfmac_f32_16x16x64_bf16 v[40:43], v[24:27], a[88:95], v3
  v_smfmac_f32_16x16x64_bf16 v[44:47], v[24:27], a[144:151], v3
  v_smfmac_f32_16x16x64_bf16 v[48:51], v[24:27], a[200:207], v3
  v_smfmac_f32_16x16x64_bf16 v[52:55], v[24:27], v[120:127], v3
  v_smfmac_f32_16x16x64_bf16 v[56:59], v[24:27], v[176:183], v3
  v_smfmac_f32_16x16x64_bf16 v[60:63], v[24:27], v[232:239], v3
  v_smfmac_f32_16x16x64_bf16 v[36:39], v[28:31], a[40:47], v3
  v_smfmac_f32_16x16x64_bf16 v[40:43], v[28:31], a[96:103], v3
  v_smfmac_f32_16x16x64_bf16 v[44:47], v[28:31], a[152:159], v3
  v_smfmac_f32_16x16x64_bf16 v[48:51], v[28:31], a[208:215], v3
  v_smfmac_f32_16x16x64_bf16 v[52:55], v[28:31], v[128:135], v3
  v_smfmac_f32_16x16x64_bf16 v[56:59], v[28:31], v[184:191], v3
  v_smfmac_f32_16x16x64_bf16 v[60:63], v[28:31], v[240:247], v3
  v_smfmac_f32_16x16x64_bf16 v[36:39], v[32:35], a[48:55], v3
  v_smfmac_f32_16x16x64_bf16 v[40:43], v[32:35], a[104:111], v3
  v_smfmac_f32_16x16x64_bf16 v[44:47], v[32:35], a[160:167], v3
  v_smfmac_f32_16x16x64_bf16 v[48:51], v[32:35], a[216:223], v3
  v_smfmac_f32_16x16x64_bf16 v[52:55], v[32:35], v[136:143], v3
  v_smfmac_f32_16x16x64_bf16 v[56:59], v[32:35], v[192:199], v3
  v_smfmac_f32_16x16x64_bf16 v[60:63], v[32:35], v[248:255], v3
  v_permlane32_swap_b32 v36, v38
  v_permlane32_swap_b32 v37, v39
  v_add_f32 v36, v36, v38
  v_add_f32 v37, v37, v39
  v_cvt_pk_bf16_f32 v38, v36, v37
  ds_write_b32 v104, v38
  v_permlane32_swap_b32 v40, v42
  v_permlane32_swap_b32 v41, v43
  v_add_f32 v40, v40, v42
  v_add_f32 v41, v41, v43
  v_cvt_pk_bf16_f32 v42, v40, v41
  ds_write_b32 v105, v42
  v_permlane32_swap_b32 v44, v46
  v_permlane32_swap_b32 v45, v47
  v_add_f32 v44, v44, v46
  v_add_f32 v45, v45, v47
  v_cvt_pk_bf16_f32 v46, v44, v45
  ds_write_b32 v106, v46
  v_permlane32_swap_b32 v48, v50
  v_permlane32_swap_b32 v49, v51
  v_add_f32 v48, v48, v50
  v_add_f32 v49, v49, v51
  v_cvt_pk_bf16_f32 v50, v48, v49
  ds_write_b32 v107, v50
  v_permlane32_swap_b32 v52, v54
  v_permlane32_swap_b32 v53, v55
  v_add_f32 v52, v52, v54
  v_add_f32 v53, v53, v55
  v_cvt_pk_bf16_f32 v54, v52, v53
  ds_write_b32 v108, v54
  v_permlane32_swap_b32 v56, v58
  v_permlane32_swap_b32 v57, v59
  v_add_f32 v56, v56, v58
  v_add_f32 v57, v57, v59
  v_cvt_pk_bf16_f32 v58, v56, v57
  ds_write_b32 v109, v58
  v_permlane32_swap_b32 v60, v62
  v_permlane32_swap_b32 v61, v63
  v_add_f32 v60, v60, v62
  v_add_f32 v61, v61, v63
  v_cvt_pk_bf16_f32 v62, v60, v61
  ds_write_b32 v110, v62
  s_branch cB_va2_t2d
.p2align 6
cB_va3_loop:
  s_mov_b32 s30, 0
  s_barrier
  buffer_load_dwordx4 v[16:19], v2, s[8:11], s20 offen offset:2048 sc1
  buffer_load_dwordx4 v[20:23], v2, s[8:11], s20 offen offset:3072 sc1
  s_barrier
  buffer_load_dword v100, v116, s[8:11], s39 offen sc1
  s_add_u32 s27, s19, 2
  s_min_u32 s27, s27, 63
  s_lshr_b32 s27, s27, 3
  s_lshl_b32 s27, s27, 11
  s_add_u32 s27, s27, s35
  buffer_load_dword v101, off, s[8:11], s27 sc1
  s_add_u32 s39, s39, 28672
  s_waitcnt vmcnt(2)
  ds_write_b128 v2, v[16:19] offset:10240
  ds_write_b128 v2, v[20:23] offset:11264
  v_smfmac_f32_16x16x64_bf16 v[36:39], v[16:19], a[16:23], v3
  v_smfmac_f32_16x16x64_bf16 v[40:43], v[16:19], a[72:79], v3
  v_smfmac_f32_16x16x64_bf16 v[44:47], v[16:19], a[128:135], v3
  v_smfmac_f32_16x16x64_bf16 v[48:51], v[16:19], a[184:191], v3
  v_smfmac_f32_16x16x64_bf16 v[52:55], v[16:19], a[240:247], v3
  s_waitcnt lgkmcnt(0)
  s_barrier
  ds_read_b128 v[8:11], v2 offset:8192
  ds_read_b128 v[12:15], v2 offset:9216
  ds_read_b128 v[24:27], v2 offset:12288
  ds_read_b128 v[28:31], v2 offset:13312
  ds_read_b128 v[32:35], v2 offset:14336
  v_smfmac_f32_16x16x64_bf16 v[56:59], v[16:19], v[160:167], v3
  v_smfmac_f32_16x16x64_bf16 v[60:63], v[16:19], v[216:223], v3
  v_smfmac_f32_16x16x64_bf16 v[36:39], v[20:23], a[24:31], v3
  v_smfmac_f32_16x16x64_bf16 v[40:43], v[20:23], a[80:87], v3
  v_smfmac_f32_16x16x64_bf16 v[44:47], v[20:23], a[136:143], v3
  v_smfmac_f32_16x16x64_bf16 v[48:51], v[20:23], a[192:199], v3
  v_smfmac_f32_16x16x64_bf16 v[52:55], v[20:23], a[248:255], v3
  v_smfmac_f32_16x16x64_bf16 v[56:59], v[20:23], v[168:175], v3
  v_smfmac_f32_16x16x64_bf16 v[60:63], v[20:23], v[224:231], v3
  s_waitcnt lgkmcnt(4)
  v_smfmac_f32_16x16x64_bf16 v[36:39], v[8:11], a[0:7], v3
  s_waitcnt lgkmcnt(3)
  v_smfmac_f32_16x16x64_bf16 v[36:39], v[12:15], a[8:15], v3
  s_waitcnt lgkmcnt(2)
  v_smfmac_f32_16x16x64_bf16 v[36:39], v[24:27], a[32:39], v3
  s_waitcnt lgkmcnt(1)
  v_smfmac_f32_16x16x64_bf16 v[36:39], v[28:31], a[40:47], v3
  s_waitcnt lgkmcnt(0)
  v_smfmac_f32_16x16x64_bf16 v[36:39], v[32:35], a[48:55], v3
  v_smfmac_f32_16x16x64_bf16 v[40:43], v[8:11], a[56:63], v3
  v_smfmac_f32_16x16x64_bf16 v[40:43], v[12:15], a[64:71], v3
  v_smfmac_f32_16x16x64_bf16 v[40:43], v[24:27], a[88:95], v3
  v_permlane32_swap_b32 v36, v38
  v_smfmac_f32_16x16x64_bf16 v[40:43], v[28:31], a[96:103], v3
  v_permlane32_swap_b32 v37, v39
  v_smfmac_f32_16x16x64_bf16 v[40:43], v[32:35], a[104:111], v3
  v_add_f32 v36, v36, v38
  v_smfmac_f32_16x16x64_bf16 v[44:47], v[8:11], a[112:119], v3
  v_add_f32 v37, v37, v39
  v_smfmac_f32_16x16x64_bf16 v[44:47], v[12:15], a[120:127], v3
  v_cmp_u_f32 vcc, v36, v37
  v_smfmac_f32_16x16x64_bf16 v[44:47], v[24:27], a[144:151], v3
  v_cvt_pk_bf16_f32 v38, v36, v37
  v_smfmac_f32_16x16x64_bf16 v[44:47], v[28:31], a[152:159], v3
  ds_write_b32 v104, v38
  s_cbranch_vccnz cB_va3_slow
  v_permlane32_swap_b32 v40, v42
  v_smfmac_f32_16x16x64_bf16 v[44:47], v[32:35], a[160:167], v3
  v_permlane32_swap_b32 v41, v43
  v_smfmac_f32_16x16x64_bf16 v[48:51], v[8:11], a[168:175], v3
  v_add_f32 v40, v40, v42
  v_smfmac_f32_16x16x64_bf16 v[48:51], v[12:15], a[176:183], v3
  v_add_f32 v41, v41, v43
  v_smfmac_f32_16x16x64_bf16 v[48:51], v[24:27], a[200:207], v3
  v_cvt_pk_bf16_f32 v42, v40, v41
  v_smfmac_f32_16x16x64_bf16 v[48:51], v[28:31], a[208:215], v3
  ds_write_b32 v105, v42
  v_permlane32_swap_b32 v44, v46
  v_smfmac_f32_16x16x64_bf16 v[48:51], v[32:35], a[216:223], v3
  v_permlane32_swap_b32 v45, v47
  v_smfmac_f32_16x16x64_bf16 v[52:55], v[8:11], a[224:231], v3
  v_add_f32 v44, v44, v46
  v_smfmac_f32_16x16x64_bf16 v[52:55], v[12:15], a[232:239], v3
  v_add_f32 v45, v45, v47
  v_smfmac_f32_16x16x64_bf16 v[52:55], v[24:27], v[120:127], v3
  v_cvt_pk_bf16_f32 v46, v44, v45
  v_smfmac_f32_16x16x64_bf16 v[52:55], v[28:31], v[128:135], v3
  ds_write_b32 v106, v46
  v_permlane32_swap_b32 v48, v50
  v_smfmac_f32_16x16x64_bf16 v[52:55], v[32:35], v[136:143], v3
  v_permlane32_swap_b32 v49, v51
  v_smfmac_f32_16x16x64_bf16 v[56:59], v[8:11], v[144:151], v3
  v_add_f32 v48, v48, v50
  v_smfmac_f32_16x16x64_bf16 v[56:59], v[12:15], v[152:159], v3
  v_add_f32 v49, v49, v51
  v_smfmac_f32_16x16x64_bf16 v[56:59], v[24:27], v[176:183], v3
  v_cvt_pk_bf16_f32 v50, v48, v49
  v_smfmac_f32_16x16x64_bf16 v[56:59], v[28:31], v[184:191], v3
  ds_write_b32 v107, v50
  v_permlane32_swap_b32 v52, v54
  v_smfmac_f32_16x16x64_bf16 v[56:59], v[32:35], v[192:199], v3
  v_permlane32_swap_b32 v53, v55
  v_smfmac_f32_16x16x64_bf16 v[60:63], v[8:11], v[200:207], v3
  v_add_f32 v52, v52, v54
  v_smfmac_f32_16x16x64_bf16 v[60:63], v[12:15], v[208:215], v3
  v_add_f32 v53, v53, v55
  v_smfmac_f32_16x16x64_bf16 v[60:63], v[24:27], v[232:239], v3
  v_cvt_pk_bf16_f32 v54, v52, v53
  v_smfmac_f32_16x16x64_bf16 v[60:63], v[28:31], v[240:247], v3
  ds_write_b32 v108, v54
  v_permlane32_swap_b32 v56, v58
  v_smfmac_f32_16x16x64_bf16 v[60:63], v[32:35], v[248:255], v3
  v_permlane32_swap_b32 v57, v59
  v_add_f32 v56, v56, v58
  v_add_f32 v57, v57, v59
  v_cvt_pk_bf16_f32 v58, v56, v57
  ds_write_b32 v109, v58
  s_nop 2
  v_permlane32_swap_b32 v60, v62
  v_permlane32_swap_b32 v61, v63
  v_add_f32 v60, v60, v62
  v_add_f32 v61, v61, v63
  v_cvt_pk_bf16_f32 v62, v60, v61
  ds_write_b32 v110, v62
cB_va3_t2d:
  v_mov_b32 v117, s18
cB_va3_vow:
  s_waitcnt vmcnt(0)
  v_cmp_ne_u32 vcc, 56, v101
  s_cbranch_vccnz cB_va3_vor
  s_waitcnt lgkmcnt(0)
  s_barrier
  v_mov_b32 v36, 0
  v_mov_b32 v37, 0
  v_mov_b32 v38, 0
  v_mov_b32 v39, 0
  v_mov_b32 v40, 0
  v_mov_b32 v41, 0
  v_mov_b32 v42, 0
  v_mov_b32 v43, 0
  buffer_store_dword v117, v118, s[8:11], 0 offen sc1
  s_cmp_eq_u32 s19, 62
  s_cbranch_scc1 cB_done
  v_mov_b32 v44, 0
  v_mov_b32 v45, 0
  v_mov_b32 v46, 0
  v_mov_b32 v47, 0
  v_mov_b32 v48, 0
  v_mov_b32 v49, 0
  v_mov_b32 v50, 0
  v_mov_b32 v51, 0
  v_mov_b32 v52, 0
  v_mov_b32 v53, 0
  v_mov_b32 v54, 0
  v_mov_b32 v55, 0
  v_mov_b32 v56, 0
  v_mov_b32 v57, 0
  v_mov_b32 v58, 0
  v_mov_b32 v59, 0
  v_mov_b32 v60, 0
  v_mov_b32 v61, 0
  v_mov_b32 v62, 0
  v_mov_b32 v63, 0
  s_mov_b32 s19, s18
  s_add_u32 s18, s18, 1
  s_mov_b32 s22, s20
  s_mov_b32 s20, s21
  s_mov_b32 s21, s22
  s_add_u32 s23, s20, 4096
  s_branch cB_va3_loop
cB_va3_slow:
  s_waitcnt lgkmcnt(0)
cB_va3_sl1:
  s_add_u32 s31, s31, 0x1000000
  buffer_load_dwordx4 v[8:11], v2, s[8:11], s20 offen offset:0 sc1
  buffer_load_dwordx4 v[12:15], v2, s[8:11], s20 offen offset:1024 sc1
  buffer_load_dwordx4 v[16:19], v2, s[8:11], s20 offen offset:2048 sc1
  buffer_load_dwordx4 v[20:23], v2, s[8:11], s20 offen offset:3072 sc1
  buffer_load_dwordx4 v[24:27], v2, s[8:11], s23 offen offset:0 sc1
  buffer_load_dwordx4 v[28:31], v2, s[8:11], s23 offen offset:1024 sc1
  buffer_load_dwordx4 v[32:35], v2, s[8:11], s23 offen offset:2048 sc1
  s_waitcnt vmcnt(0)
  v_max3_u32 v36, v8, v9, v10
  v_max3_u32 v36, v36, v11, v12
  v_max3_u32 v36, v36, v13, v14
  v_max3_u32 v36, v36, v15, v16
  v_max3_u32 v36, v36, v17, v18
  v_max3_u32 v36, v36, v19, v20
  v_max3_u32 v36, v36, v21, v22
  v_max3_u32 v36, v36, v23, v24
  v_max3_u32 v36, v36, v25, v26
  v_max3_u32 v36, v36, v27, v28
  v_max3_u32 v36, v36, v29, v30
  v_max3_u32 v36, v36, v31, v32
  v_max3_u32 v36, v36, v33, v34
  v_max_u32 v36, v36, v35
  v_cmp_eq_u32 vcc, -1, v36
  s_cbranch_vccz cB_va3_sl2
  s_add_u32 s30, s30, 1
  s_cmp_lt_u32 s30, 400000
  s_cbranch_scc1 cB_va3_sl1
  s_branch cB_abort
cB_va3_sl2:
  v_mov_b32 v36, 0
  v_mov_b32 v37, 0
  v_mov_b32 v38, 0
  v_mov_b32 v39, 0
  v_mov_b32 v40, 0
  v_mov_b32 v41, 0
  v_mov_b32 v42, 0
  v_mov_b32 v43, 0
  v_mov_b32 v44, 0
  v_mov_b32 v45, 0
  v_mov_b32 v46, 0
  v_mov_b32 v47, 0
  v_mov_b32 v48, 0
  v_mov_b32 v49, 0
  v_mov_b32 v50, 0
  v_mov_b32 v51, 0
  v_mov_b32 v52, 0
  v_mov_b32 v53, 0
  v_mov_b32 v54, 0
  v_mov_b32 v55, 0
  v_mov_b32 v56, 0
  v_mov_b32 v57, 0
  v_mov_b32 v58, 0
  v_mov_b32 v59, 0
  v_mov_b32 v60, 0
  v_mov_b32 v61, 0
  v_mov_b32 v62, 0
  v_mov_b32 v63, 0
  v_smfmac_f32_16x16x64_bf16 v[36:39], v[8:11], a[0:7], v3
  v_smfmac_f32_16x16x64_bf16 v[40:43], v[8:11], a[56:63], v3
  v_smfmac_f32_16x16x64_bf16 v[44:47], v[8:11], a[112:119], v3
  v_smfmac_f32_16x16x64_bf16 v[48:51], v[8:11], a[168:175], v3
  v_smfmac_f32_16x16x64_bf16 v[52:55], v[8:11], a[224:231], v3
  v_smfmac_f32_16x16x64_bf16 v[56:59], v[8:11], v[144:151], v3
  v_smfmac_f32_16x16x64_bf16 v[60:63], v[8:11], v[200:207], v3
  v_smfmac_f32_16x16x64_bf16 v[36:39], v[12:15], a[8:15], v3
  v_smfmac_f32_16x16x64_bf16 v[40:43], v[12:15], a[64:71], v3
  v_smfmac_f32_16x16x64_bf16 v[44:47], v[12:15], a[120:127], v3
  v_smfmac_f32_16x16x64_bf16 v[48:51], v[12:15], a[176:183], v3
  v_smfmac_f32_16x16x64_bf16 v[52:55], v[12:15], a[232:239], v3
  v_smfmac_f32_16x16x64_bf16 v[56:59], v[12:15], v[152:159], v3
  v_smfmac_f32_16x16x64_bf16 v[60:63], v[12:15], v[208:215], v3
  v_smfmac_f32_16x16x64_bf16 v[36:39], v[16:19], a[16:23], v3
  v_smfmac_f32_16x16x64_bf16 v[40:43], v[16:19], a[72:79], v3
  v_smfmac_f32_16x16x64_bf16 v[44:47], v[16:19], a[128:135], v3
  v_smfmac_f32_16x16x64_bf16 v[48:51], v[16:19], a[184:191], v3
  v_smfmac_f32_16x16x64_bf16 v[52:55], v[16:19], a[240:247], v3
  v_smfmac_f32_16x16x64_bf16 v[56:59], v[16:19], v[160:167], v3
  v_smfmac_f32_16x16x64_bf16 v[60:63], v[16:19], v[216:223], v3
  v_smfmac_f32_16x16x64_bf16 v[36:39], v[20:23], a[24:31], v3
  v_smfmac_f32_16x16x64_bf16 v[40:43], v[20:23], a[80:87], v3
  v_smfmac_f32_16x16x64_bf16 v[44:47], v[20:23], a[136:143], v3
  v_smfmac_f32_16x16x64_bf16 v[48:51], v[20:23], a[192:199], v3
  v_smfmac_f32_16x16x64_bf16 v[52:55], v[20:23], a[248:255], v3
  v_smfmac_f32_16x16x64_bf16 v[56:59], v[20:23], v[168:175], v3
  v_smfmac_f32_16x16x64_bf16 v[60:63], v[20:23], v[224:231], v3
  v_smfmac_f32_16x16x64_bf16 v[36:39], v[24:27], a[32:39], v3
  v_smfmac_f32_16x16x64_bf16 v[40:43], v[24:27], a[88:95], v3
  v_smfmac_f32_16x16x64_bf16 v[44:47], v[24:27], a[144:151], v3
  v_smfmac_f32_16x16x64_bf16 v[48:51], v[24:27], a[200:207], v3
  v_smfmac_f32_16x16x64_bf16 v[52:55], v[24:27], v[120:127], v3
  v_smfmac_f32_16x16x64_bf16 v[56:59], v[24:27], v[176:183], v3
  v_smfmac_f32_16x16x64_bf16 v[60:63], v[24:27], v[232:239], v3
  v_smfmac_f32_16x16x64_bf16 v[36:39], v[28:31], a[40:47], v3
  v_smfmac_f32_16x16x64_bf16 v[40:43], v[28:31], a[96:103], v3
  v_smfmac_f32_16x16x64_bf16 v[44:47], v[28:31], a[152:159], v3
  v_smfmac_f32_16x16x64_bf16 v[48:51], v[28:31], a[208:215], v3
  v_smfmac_f32_16x16x64_bf16 v[52:55], v[28:31], v[128:135], v3
  v_smfmac_f32_16x16x64_bf16 v[56:59], v[28:31], v[184:191], v3
  v_smfmac_f32_16x16x64_bf16 v[60:63], v[28:31], v[240:247], v3
  v_smfmac_f32_16x16x64_bf16 v[36:39], v[32:35], a[48:55], v3
  v_smfmac_f32_16x16x64_bf16 v[40:43], v[32:35], a[104:111], v3
  v_smfmac_f32_16x16x64_bf16 v[44:47], v[32:35], a[160:167], v3
  v_smfmac_f32_16x16x64_bf16 v[48:51], v[32:35], a[216:223], v3
  v_smfmac_f32_16x16x64_bf16 v[52:55], v[32:35], v[136:143], v3
  v_smfmac_f32_16x16x64_bf16 v[56:59], v[32:35], v[192:199], v3
  v_smfmac_f32_16x16x64_bf16 v[60:63], v[32:35], v[248:255], v3
  v_permlane32_swap_b32 v36, v38
  v_permlane32_swap_b32 v37, v39
  v_add_f32 v36, v36, v38
  v_add_f32 v37, v37, v39
  v_cvt_pk_bf16_f32 v38, v36, v37
  ds_write_b32 v104, v38
  v_permlane32_swap_b32 v40, v42
  v_permlane32_swap_b32 v41, v43
  v_add_f32 v40, v40, v42
  v_add_f32 v41, v41, v43
  v_cvt_pk_bf16_f32 v42, v40, v41
  ds_write_b32 v105, v42
  v_permlane32_swap_b32 v44, v46
  v_permlane32_swap_b32 v45, v47
  v_add_f32 v44, v44, v46
  v_add_f32 v45, v45, v47
  v_cvt_pk_bf16_f32 v46, v44, v45
  ds_write_b32 v106, v46
  v_permlane32_swap_b32 v48, v50
  v_permlane32_swap_b32 v49, v51
  v_add_f32 v48, v48, v50
  v_add_f32 v49, v49, v51
  v_cvt_pk_bf16_f32 v50, v48, v49
  ds_write_b32 v107, v50
  v_permlane32_swap_b32 v52, v54
  v_permlane32_swap_b32 v53, v55
  v_add_f32 v52, v52, v54
  v_add_f32 v53, v53, v55
  v_cvt_pk_bf16_f32 v54, v52, v53
  ds_write_b32 v108, v54
  v_permlane32_swap_b32 v56, v58
  v_permlane32_swap_b32 v57, v59
  v_add_f32 v56, v56, v58
  v_add_f32 v57, v57, v59
  v_cvt_pk_bf16_f32 v58, v56, v57
  ds_write_b32 v109, v58
  v_permlane32_swap_b32 v60, v62
  v_permlane32_swap_b32 v61, v63
  v_add_f32 v60, v60, v62
  v_add_f32 v61, v61, v63
  v_cvt_pk_bf16_f32 v62, v60, v61
  ds_write_b32 v110, v62
  s_branch cB_va3_t2d
cB_va3_vor:
  s_sleep 2
  buffer_load_dword v101, off, s[8:11], s27 sc1
  s_add_u32 s30, s30, 1
  s_cmp_lt_u32 s30, 400000
  s_cbranch_scc1 cB_va3_vow
  s_branch cB_abort
cB_abort:
  v_mov_b32 v4, 0xdead
  v_mov_b32 v5, 16
  buffer_store_dword v4, v5, s[12:15], 0 offen
  s_branch ch_end
cB_done:
  s_branch ch_end
ch_worker:
  s_sub_u32 s35, s3, 0
  s_and_b32 s35, s35, 7
  s_lshr_b32 s36, s2, 3
  s_mul_i32 s33, s35, 28
  s_add_u32 s33, s33, s36
  s_mov_b32 s97, 0
  s_mov_b32 s96, 0
  s_mov_b32 s37, 0
  s_mov_b32 s38, 0
  s_mov_b32 s39, 0xffff0000
  v_and_b32 v1, 63, v0
  v_lshlrev_b32 v2, 4, v1
  v_lshrrev_b32 v3, 4, v1
  v_and_b32 v4, 15, v1
  v_lshrrev_b32 v5, 5, v1
  v_and_b32 v6, 31, v1
  v_xor_b32 v8, v6, v5
  v_lshlrev_b32 v8, 4, v8
  v_lshl_add_u32 v16, v5, 13, v8
  v_xor_b32 v17, 32, v16
  v_xor_b32 v18, 64, v16
  v_xor_b32 v19, 96, v16
  v_xor_b32 v20, 128, v16
  v_xor_b32 v21, 160, v16
  v_xor_b32 v22, 192, v16
  v_xor_b32 v23, 224, v16
  s_cmp_lt_u32 s36, 28
  s_cbranch_scc1 wp_B
  s_cmp_eq_u32 s35, 0
  s_cbranch_scc1 wp_ini
  s_lshl_b32 s33, s35, 2
  s_add_u32 s33, s33, s36
  s_sub_u32 s33, s33, 32
  s_mul_i32 s17, s33, 4682
  s_lshr_b32 s17, s17, 16
  s_mul_i32 s23, s17, 14
  s_sub_u32 s19, s33, s23
  s_cmp_lt_u32 s19, 7
  s_cselect_b32 s18, 0, 7
  s_cselect_b32 s28, 0, 8
  s_sub_u32 s18, s19, s18
  s_add_u32 s28, s28, s16
  s_lshl_b32 s25, s16, 15
  s_add_u32 s25, s25, 32768
  s_lshl_b32 s26, s17, 9
  s_branch wp_A0
wp_ini:
  v_mov_b32 v4, 1
  v_mov_b32 v5, 4
  v_mov_b32 v6, 160000
  s_barrier
  s_cmp_lg_u32 s16, 0
  s_cbranch_scc1 wp_ic1
  s_mov_b64 exec, 1
  buffer_atomic_add v4, v5, s[12:15], 0 offen sc0
  s_waitcnt vmcnt(0)
  ds_write_b32 v6, v4
  s_waitcnt lgkmcnt(0)
  s_mov_b64 exec, -1
wp_ic1:
  s_barrier
  ds_read_b32 v4, v6
  s_waitcnt lgkmcnt(0)
  v_readfirstlane_b32 s33, v4
  v_and_b32 v1, 63, v0
  v_lshlrev_b32 v2, 4, v1
  v_lshrrev_b32 v3, 4, v1
  v_and_b32 v4, 15, v1
  s_cmp_ge_u32 s33, 4
  s_cbranch_scc1 wp_ini2
  v_mov_b32 v10, 0x40000000
  v_mov_b32 v5, 1
  v_mov_b32 v148, 0
  v_mov_b32 v149, 0
  v_mov_b32 v150, 0
  v_mov_b32 v151, 0
  v_mov_b32 v152, -1
  v_mov_b32 v153, -1
  v_mov_b32 v154, -1
  v_mov_b32 v155, -1
  v_lshlrev_b32 v8, 4, v0
  s_cmp_lg_u32 s33, 0
  s_cbranch_scc1 wp_ij_1
  s_mov_b32 s23, 88060416
  buffer_store_dwordx4 v[148:151], v8, s[8:11], s23 offen sc1
  s_mov_b32 s23, 88064512
  buffer_store_dwordx4 v[148:151], v8, s[8:11], s23 offen sc1
  s_waitcnt vmcnt(0)
  s_barrier
  buffer_store_dword v5, v252, s[12:15], 0 offen offset:128 sc1
wp_ij_1:
  s_mov_b32 s68, s50
  s_and_b32 s69, s51, 0xffff
  s_mov_b32 s70, 7168
  s_mov_b32 s71, 0x20000
  v_lshrrev_b32 v6, 3, v0
  v_min_u32 v6, 27, v6
  v_and_b32 v7, 7, v0
  v_mul_u32_u24 v9, 896, v7
  v_lshl_add_u32 v9, v6, 5, v9
  buffer_load_dwordx4 v[176:179], v9, s[68:71], 0 offen
  buffer_load_dwordx4 v[180:183], v9, s[68:71], 0 offen offset:16
  s_lshl_b32 s20, s33, 12
  v_add_u32 v8, s20, v8
  s_mov_b32 s23, 88002560
wp_ij_2:
  buffer_store_dwordx4 v[148:151], v8, s[8:11], s23 offen sc1
  s_add_u32 s23, s23, 16384
  s_cmp_lt_u32 s23, 88051712
  s_cbranch_scc1 wp_ij_2
  v_cmp_gt_u32 vcc, 8704, v8
  s_nop 1
  v_cndmask_b32 v9, v10, v8, vcc
  buffer_store_dwordx4 v[148:151], v9, s[8:11], s23 offen sc1
  s_mov_b32 s23, 75270656
  v_cmp_gt_u32 vcc, 6144, v8
  s_nop 1
  v_cndmask_b32 v9, v10, v8, vcc
  buffer_store_dwordx4 v[148:151], v9, s[8:11], s23 offen sc1
  s_mov_b32 s23, 75242496
wp_ij_3:
  buffer_store_dwordx4 v[152:155], v8, s[8:11], s23 offen sc1
  s_add_u32 s23, s23, 16384
  s_cmp_lt_u32 s23, 75258880
  s_cbranch_scc1 wp_ij_3
  v_cmp_gt_u32 vcc, 11776, v8
  s_nop 1
  v_cndmask_b32 v9, v10, v8, vcc
  buffer_store_dwordx4 v[152:155], v9, s[8:11], s23 offen sc1
  s_mov_b32 s23, 87550976
wp_ij_4:
  buffer_store_dwordx4 v[152:155], v8, s[8:11], s23 offen sc1
  s_add_u32 s23, s23, 16384
  s_cmp_lt_u32 s23, 87993344
  s_cbranch_scc1 wp_ij_4
  v_cmp_gt_u32 vcc, 9216, v8
  s_nop 1
  v_cndmask_b32 v9, v10, v8, vcc
  buffer_store_dwordx4 v[152:155], v9, s[8:11], s23 offen sc1
  s_cmp_lg_u32 s33, 1
  s_cbranch_scc1 wp_ij_nm
  v_lshrrev_b32 v6, 3, v0
  v_and_b32 v7, 7, v0
  v_lshlrev_b32 v8, 8, v6
  v_lshl_add_u32 v8, v7, 4, v8
  v_cmp_gt_u32 vcc, 28, v6
  s_nop 1
  v_cndmask_b32 v8, v10, v8, vcc
  s_waitcnt vmcnt(8)
  v_mov_b32 v184, v176
  v_mov_b32 v188, v177
  v_mov_b32 v185, v178
  v_mov_b32 v189, v179
  v_mov_b32 v186, v180
  v_mov_b32 v190, v181
  v_mov_b32 v187, v182
  v_mov_b32 v191, v183
  s_mov_b32 s23, 75235328
  buffer_store_dwordx4 v[184:187], v8, s[8:11], s23 offen sc1
  buffer_store_dwordx4 v[188:191], v8, s[8:11], s23 offen offset:128 sc1
  s_mov_b32 s23, 87543808
  buffer_store_dwordx4 v[184:187], v8, s[8:11], s23 offen sc1
  buffer_store_dwordx4 v[188:191], v8, s[8:11], s23 offen offset:128 sc1
wp_ij_nm:
  s_waitcnt vmcnt(0)
  s_barrier
  s_cmp_lg_u32 s16, 0
  s_cbranch_scc1 wp_ij_e
  v_mov_b32 v6, 1
  s_mov_b64 exec, 1
  buffer_atomic_add v6, v252, s[12:15], 0 offen offset:12 sc0
  s_waitcnt vmcnt(0)
  v_readfirstlane_b32 s20, v6
  s_cmp_lg_u32 s20, 3
  s_cbranch_scc1 wp_ij_e0
  buffer_store_dword v5, v252, s[12:15], 0 offen offset:132 sc1
wp_ij_e0:
  s_mov_b64 exec, -1
wp_ij_e:
wp_ini2:
  s_cmp_lg_u32 s97, 0
  s_cbranch_scc1 wp_all
  s_cmp_lg_u32 s3, 0
  s_cbranch_scc1 wp_all
  v_readfirstlane_b32 s91, v249
  v_mov_b32 v6, 160032
  s_nop 0
  v_mov_b32 v7, s91
  s_barrier
  s_cmp_lg_u32 s16, 0
  s_cbranch_scc1 uni_5
  ds_write_b32 v6, v7
  s_waitcnt lgkmcnt(0)
uni_5:
  s_barrier
  ds_read_b32 v7, v6
  s_waitcnt lgkmcnt(0)
  v_readfirstlane_b32 s91, v7
  s_and_b32 s91, s91, 0xffff
  s_cmp_lt_u32 s91, 32
  s_cbranch_scc1 ch_role2
  s_branch wp_all
wp_B:
  s_mul_i32 s17, s33, 4682
  s_lshr_b32 s17, s17, 16
  s_mul_i32 s23, s17, 14
  s_sub_u32 s19, s33, s23
  s_cmp_lt_u32 s19, 7
  s_cselect_b32 s18, 0, 7
  s_cselect_b32 s28, 0, 8
  s_sub_u32 s18, s19, s18
  s_add_u32 s28, s28, s16
  s_lshl_b32 s25, s16, 15
  s_add_u32 s25, s25, 32768
  s_lshl_b32 s26, s17, 9
  s_cmp_lt_u32 s19, 7
  s_cselect_b32 s64, s44, s46
  s_cselect_b32 s65, s45, s47
  s_cselect_b32 s27, 0, 7
  s_mov_b32 s68, s64
  s_and_b32 s69, s65, 0xffff
  s_mov_b32 s70, 3670016
  s_mov_b32 s71, 0x20000
  s_sub_u32 s31, s19, s27
  s_lshl_b32 s27, s31, 19
  s_add_u32 s27, s27, s26
  v_lshrrev_b32 v7, 2, v0
  v_and_b32 v8, 3, v0
  v_lshlrev_b32 v8, 7, v8
  v_lshl_add_u32 v9, v7, 13, v8
  s_mul_i32 s30, s17, 229376
  s_lshl_b32 s31, s31, 15
  s_add_u32 s30, s30, s31
  s_cmp_lt_u32 s19, 7
  s_cselect_b32 s27, s27, s30
  s_cselect_b64 vcc, -1, 0
  v_lshlrev_b32 v8, 7, v0
  v_cndmask_b32 v9, v8, v9, vcc
  buffer_load_dword v253, v9, s[68:71], s27 offen nt
  s_lshl_b32 s20, s33, 2
  s_add_u32 s20, s20, s16
  s_mul_i32 s21, s20, 9363
  s_lshr_b32 s21, s21, 16
  s_mul_i32 s22, s21, 7
  s_sub_u32 s22, s20, s22
  s_mul_i32 s21, s21, 14336
  s_lshl_b32 s20, s22, 7
  s_add_u32 s20, s20, s21
  s_lshl_b32 s22, s22, 11
  s_add_u32 s52, s21, s22
  s_mov_b32 s68, s48
  s_and_b32 s69, s49, 0xffff
  s_mov_b32 s70, 1835008
  s_mov_b32 s71, 0x20000
  v_mul_u32_u24 v7, 896, v4
  v_lshl_add_u32 v7, v3, 5, v7
  buffer_load_dwordx4 v[128:131], v7, s[68:71], s20 offen
  buffer_load_dwordx4 v[132:135], v7, s[68:71], s20 offen offset:16
  s_mov_b32 s60, s44
  s_and_b32 s61, s45, 0xffff
  s_mov_b32 s62, 3670016
  s_mov_b32 s63, 0x20000
  s_mov_b32 s56, s46
  s_and_b32 s57, s47, 0xffff
  s_mov_b32 s58, 3670016
  s_mov_b32 s59, 0x20000
  s_mul_i32 s27, s17, 229376
  s_lshl_b32 s30, s18, 7
  s_add_u32 s27, s27, s30
  s_mul_i32 s30, s16, 57344
  s_add_u32 s27, s27, s30
  v_lshrrev_b32 v7, 3, v1
  v_and_b32 v8, 7, v1
  v_and_b32 v9, 2, v7
  v_xor_b32 v8, v8, v9
  v_mul_u32_u24 v7, 896, v7
  v_lshl_add_u32 v24, v8, 4, v7
  v_xor_b32 v25, 64, v24
  s_lshl_b32 s30, s16, 13
  s_add_u32 m0, s30, 0
  s_nop 0
  buffer_load_dwordx4 v24, s[56:59], s27 offen nt lds
  s_add_u32 s27, s27, 7168
  s_add_u32 m0, s30, 1024
  s_nop 0
  buffer_load_dwordx4 v25, s[56:59], s27 offen nt lds
  s_add_u32 s27, s27, 7168
  s_add_u32 m0, s30, 2048
  s_nop 0
  buffer_load_dwordx4 v24, s[56:59], s27 offen nt lds
  s_add_u32 s27, s27, 7168
  s_add_u32 m0, s30, 3072
  s_nop 0
  buffer_load_dwordx4 v25, s[56:59], s27 offen nt lds
  s_add_u32 s27, s27, 7168
  s_add_u32 m0, s30, 4096
  s_nop 0
  buffer_load_dwordx4 v24, s[56:59], s27 offen nt lds
  s_add_u32 s27, s27, 7168
  s_add_u32 m0, s30, 5120
  s_nop 0
  buffer_load_dwordx4 v25, s[56:59], s27 offen nt lds
  s_add_u32 s27, s27, 7168
  s_add_u32 m0, s30, 6144
  s_nop 0
  buffer_load_dwordx4 v24, s[56:59], s27 offen nt lds
  s_add_u32 s27, s27, 7168
  s_add_u32 m0, s30, 7168
  s_nop 0
  buffer_load_dwordx4 v25, s[56:59], s27 offen nt lds
  s_add_u32 s27, s27, 7168
  s_add_u32 s27, s28, 0
  s_min_u32 s27, s27, 13
  s_lshl_b32 s27, s27, 18
  s_add_u32 s27, s27, s26
  s_add_u32 m0, s25, 0
  s_nop 0
  buffer_load_dwordx4 v16, s[60:63], s27 offen nt lds
  s_add_u32 s27, s27, 16384
  s_add_u32 m0, s25, 1024
  s_nop 0
  buffer_load_dwordx4 v17, s[60:63], s27 offen nt lds
  s_add_u32 s27, s27, 16384
  s_add_u32 m0, s25, 2048
  s_nop 0
  buffer_load_dwordx4 v16, s[60:63], s27 offen nt lds
  s_add_u32 s27, s27, 16384
  s_add_u32 m0, s25, 3072
  s_nop 0
  buffer_load_dwordx4 v17, s[60:63], s27 offen nt lds
  s_add_u32 s27, s27, 16384
  s_add_u32 m0, s25, 4096
  s_nop 0
  buffer_load_dwordx4 v18, s[60:63], s27 offen nt lds
  s_add_u32 s27, s27, 16384
  s_add_u32 m0, s25, 5120
  s_nop 0
  buffer_load_dwordx4 v19, s[60:63], s27 offen nt lds
  s_add_u32 s27, s27, 16384
  s_add_u32 m0, s25, 6144
  s_nop 0
  buffer_load_dwordx4 v18, s[60:63], s27 offen nt lds
  s_add_u32 s27, s27, 16384
  s_add_u32 m0, s25, 7168
  s_nop 0
  buffer_load_dwordx4 v19, s[60:63], s27 offen nt lds
  s_add_u32 s27, s27, 16384
  s_add_u32 m0, s25, 8192
  s_nop 0
  buffer_load_dwordx4 v20, s[60:63], s27 offen nt lds
  s_add_u32 s27, s27, 16384
  s_add_u32 m0, s25, 9216
  s_nop 0
  buffer_load_dwordx4 v21, s[60:63], s27 offen nt lds
  s_add_u32 s27, s27, 16384
  s_add_u32 m0, s25, 10240
  s_nop 0
  buffer_load_dwordx4 v20, s[60:63], s27 offen nt lds
  s_add_u32 s27, s27, 16384
  s_add_u32 m0, s25, 11264
  s_nop 0
  buffer_load_dwordx4 v21, s[60:63], s27 offen nt lds
  s_add_u32 s27, s27, 16384
  s_add_u32 m0, s25, 12288
  s_nop 0
  buffer_load_dwordx4 v22, s[60:63], s27 offen nt lds
  s_add_u32 s27, s27, 16384
  s_add_u32 m0, s25, 13312
  s_nop 0
  buffer_load_dwordx4 v23, s[60:63], s27 offen nt lds
  s_add_u32 s27, s27, 16384
  s_add_u32 m0, s25, 14336
  s_nop 0
  buffer_load_dwordx4 v22, s[60:63], s27 offen nt lds
  s_add_u32 s27, s27, 16384
  s_add_u32 m0, s25, 15360
  s_nop 0
  buffer_load_dwordx4 v23, s[60:63], s27 offen nt lds
  s_add_u32 s27, s27, 16384
  s_add_u32 s27, s28, 4
  s_min_u32 s27, s27, 13
  s_lshl_b32 s27, s27, 18
  s_add_u32 s27, s27, s26
  s_add_u32 m0, s25, 16384
  s_nop 0
  buffer_load_dwordx4 v16, s[60:63], s27 offen nt lds
  s_add_u32 s27, s27, 16384
  s_add_u32 m0, s25, 17408
  s_nop 0
  buffer_load_dwordx4 v17, s[60:63], s27 offen nt lds
  s_add_u32 s27, s27, 16384
  s_add_u32 m0, s25, 18432
  s_nop 0
  buffer_load_dwordx4 v16, s[60:63], s27 offen nt lds
  s_add_u32 s27, s27, 16384
  s_add_u32 m0, s25, 19456
  s_nop 0
  buffer_load_dwordx4 v17, s[60:63], s27 offen nt lds
  s_add_u32 s27, s27, 16384
  s_add_u32 m0, s25, 20480
  s_nop 0
  buffer_load_dwordx4 v18, s[60:63], s27 offen nt lds
  s_add_u32 s27, s27, 16384
  s_add_u32 m0, s25, 21504
  s_nop 0
  buffer_load_dwordx4 v19, s[60:63], s27 offen nt lds
  s_add_u32 s27, s27, 16384
  s_add_u32 m0, s25, 22528
  s_nop 0
  buffer_load_dwordx4 v18, s[60:63], s27 offen nt lds
  s_add_u32 s27, s27, 16384
  s_add_u32 m0, s25, 23552
  s_nop 0
  buffer_load_dwordx4 v19, s[60:63], s27 offen nt lds
  s_add_u32 s27, s27, 16384
  s_add_u32 m0, s25, 24576
  s_nop 0
  buffer_load_dwordx4 v20, s[60:63], s27 offen nt lds
  s_add_u32 s27, s27, 16384
  s_add_u32 m0, s25, 25600
  s_nop 0
  buffer_load_dwordx4 v21, s[60:63], s27 offen nt lds
  s_add_u32 s27, s27, 16384
  s_add_u32 m0, s25, 26624
  s_nop 0
  buffer_load_dwordx4 v20, s[60:63], s27 offen nt lds
  s_add_u32 s27, s27, 16384
  s_add_u32 m0, s25, 27648
  s_nop 0
  buffer_load_dwordx4 v21, s[60:63], s27 offen nt lds
  s_add_u32 s27, s27, 16384
  s_add_u32 m0, s25, 28672
  s_nop 0
  buffer_load_dwordx4 v22, s[60:63], s27 offen nt lds
  s_add_u32 s27, s27, 16384
  s_add_u32 m0, s25, 29696
  s_nop 0
  buffer_load_dwordx4 v23, s[60:63], s27 offen nt lds
  s_add_u32 s27, s27, 16384
  s_add_u32 m0, s25, 30720
  s_nop 0
  buffer_load_dwordx4 v22, s[60:63], s27 offen nt lds
  s_add_u32 s27, s27, 16384
  s_add_u32 m0, s25, 31744
  s_nop 0
  buffer_load_dwordx4 v23, s[60:63], s27 offen nt lds
  s_add_u32 s27, s27, 16384
  s_cmp_eq_u32 s35, 0
  s_cselect_b32 s34, 1, s97
  s_cmp_lt_u32 s19, 7
  s_cselect_b32 s64, s40, s42
  s_cselect_b32 s65, s41, s43
  s_cselect_b32 s27, 0, 7
  s_mov_b32 s68, s64
  s_and_b32 s69, s65, 0xffff
  s_mov_b32 s70, 3670016
  s_mov_b32 s71, 0x20000
  s_sub_u32 s31, s19, s27
  s_lshl_b32 s27, s31, 19
  s_add_u32 s27, s27, s26
  v_lshrrev_b32 v7, 2, v0
  v_and_b32 v8, 3, v0
  v_lshlrev_b32 v8, 7, v8
  v_lshl_add_u32 v9, v7, 13, v8
  s_cmp_lg_u32 s34, 0
  s_cselect_b32 s27, 0x40000000, s27
  buffer_load_dword v253, v9, s[68:71], s27 offen nt
  v_lshrrev_b32 v7, 2, v4
  v_lshlrev_b32 v7, 3, v7
  v_and_b32 v8, 3, v4
  v_add_u32 v7, v7, v8
  v_or_b32 v10, 0, v3
  v_xor_b32 v10, v10, v4
  v_lshlrev_b32 v10, 4, v10
  v_lshl_add_u32 v10, v7, 9, v10
  v_add_u32 v32, s25, v10
  v_or_b32 v10, 4, v3
  v_xor_b32 v10, v10, v4
  v_lshlrev_b32 v10, 4, v10
  v_lshl_add_u32 v10, v7, 9, v10
  v_add_u32 v33, s25, v10
  v_or_b32 v10, 8, v3
  v_xor_b32 v10, v10, v4
  v_lshlrev_b32 v10, 4, v10
  v_lshl_add_u32 v10, v7, 9, v10
  v_add_u32 v34, s25, v10
  v_or_b32 v10, 12, v3
  v_xor_b32 v10, v10, v4
  v_lshlrev_b32 v10, 4, v10
  v_lshl_add_u32 v10, v7, 9, v10
  v_add_u32 v35, s25, v10
  v_lshrrev_b32 v7, 2, v4
  v_lshl_add_u32 v7, v3, 3, v7
  v_lshlrev_b32 v7, 7, v7
  v_and_b32 v8, 3, v4
  v_lshl_add_u32 v7, v8, 3, v7
  v_lshrrev_b32 v8, 3, v4
  v_and_b32 v9, 1, v3
  v_lshl_add_u32 v8, v9, 1, v8
  v_lshl_add_u32 v40, v8, 5, v7
  s_lshl_b32 s30, s18, 6
  s_add_u32 s30, s30, 0
  v_add_u32 v8, s30, v4
  v_subrev_u32 v9, 256, v8
  v_mul_u32_u24 v11, 171, v9
  v_lshrrev_b32 v11, 11, v11
  v_mul_u32_u24 v38, 12, v11
  v_sub_u32 v38, v9, v38
  v_add_u32 v38, 16, v38
  v_lshrrev_b32 v10, 4, v8
  v_cmp_gt_i32 vcc, 0, v9
  s_nop 1
  v_cndmask_b32 v10, v11, v10, vcc
  v_cndmask_b32 v37, v38, v4, vcc
  s_mul_i32 s30, s17, 28
  v_add_u32 v37, s30, v37
  v_lshrrev_b32 v38, 4, v37
  v_and_b32 v37, 15, v37
  s_mov_b32 s30, 401408
  v_mul_lo_u32 v10, v10, s30
  v_mul_u32_u24 v38, 14336, v38
  v_add_u32 v10, v10, v38
  v_lshl_add_u32 v10, v3, 8, v10
  v_lshl_add_u32 v10, v37, 4, v10
  v_add_u32 v12, 6422528, v10
  v_xor_b32 v41, 32, v40
  s_lshl_b32 s30, s18, 6
  s_add_u32 s30, s30, 16
  v_add_u32 v8, s30, v4
  v_subrev_u32 v9, 256, v8
  v_mul_u32_u24 v11, 171, v9
  v_lshrrev_b32 v11, 11, v11
  v_mul_u32_u24 v38, 12, v11
  v_sub_u32 v38, v9, v38
  v_add_u32 v38, 16, v38
  v_lshrrev_b32 v10, 4, v8
  v_cmp_gt_i32 vcc, 0, v9
  s_nop 1
  v_cndmask_b32 v10, v11, v10, vcc
  v_cndmask_b32 v37, v38, v4, vcc
  s_mul_i32 s30, s17, 28
  v_add_u32 v37, s30, v37
  v_lshrrev_b32 v38, 4, v37
  v_and_b32 v37, 15, v37
  s_mov_b32 s30, 401408
  v_mul_lo_u32 v10, v10, s30
  v_mul_u32_u24 v38, 14336, v38
  v_add_u32 v10, v10, v38
  v_lshl_add_u32 v10, v3, 8, v10
  v_lshl_add_u32 v10, v37, 4, v10
  v_add_u32 v13, 6422528, v10
  v_xor_b32 v42, 64, v40
  s_lshl_b32 s30, s18, 6
  s_add_u32 s30, s30, 32
  v_add_u32 v8, s30, v4
  v_subrev_u32 v9, 256, v8
  v_mul_u32_u24 v11, 171, v9
  v_lshrrev_b32 v11, 11, v11
  v_mul_u32_u24 v38, 12, v11
  v_sub_u32 v38, v9, v38
  v_add_u32 v38, 16, v38
  v_lshrrev_b32 v10, 4, v8
  v_cmp_gt_i32 vcc, 0, v9
  s_nop 1
  v_cndmask_b32 v10, v11, v10, vcc
  v_cndmask_b32 v37, v38, v4, vcc
  s_mul_i32 s30, s17, 28
  v_add_u32 v37, s30, v37
  v_lshrrev_b32 v38, 4, v37
  v_and_b32 v37, 15, v37
  s_mov_b32 s30, 401408
  v_mul_lo_u32 v10, v10, s30
  v_mul_u32_u24 v38, 14336, v38
  v_add_u32 v10, v10, v38
  v_lshl_add_u32 v10, v3, 8, v10
  v_lshl_add_u32 v10, v37, 4, v10
  v_add_u32 v14, 6422528, v10
  v_xor_b32 v43, 96, v40
  s_lshl_b32 s30, s18, 6
  s_add_u32 s30, s30, 48
  v_add_u32 v8, s30, v4
  v_subrev_u32 v9, 256, v8
  v_mul_u32_u24 v11, 171, v9
  v_lshrrev_b32 v11, 11, v11
  v_mul_u32_u24 v38, 12, v11
  v_sub_u32 v38, v9, v38
  v_add_u32 v38, 16, v38
  v_lshrrev_b32 v10, 4, v8
  v_cmp_gt_i32 vcc, 0, v9
  s_nop 1
  v_cndmask_b32 v10, v11, v10, vcc
  v_cndmask_b32 v37, v38, v4, vcc
  s_mul_i32 s30, s17, 28
  v_add_u32 v37, s30, v37
  v_lshrrev_b32 v38, 4, v37
  v_and_b32 v37, 15, v37
  s_mov_b32 s30, 401408
  v_mul_lo_u32 v10, v10, s30
  v_mul_u32_u24 v38, 14336, v38
  v_add_u32 v10, v10, v38
  v_lshl_add_u32 v10, v3, 8, v10
  v_lshl_add_u32 v10, v37, 4, v10
  v_add_u32 v15, 6422528, v10
  s_lshl_b32 s29, s28, 10
  s_add_u32 s31, s29, 4096
  s_cmp_lt_u32 s28, 10
  s_cselect_b32 s31, s31, 0x40000000
  s_waitcnt vmcnt(1)
  s_barrier
  ds_read_b64_tr_b16 a[0:1], v40 offset:0
  ds_read_b64_tr_b16 a[2:3], v40 offset:512
  ds_read_b64_tr_b16 a[32:33], v41 offset:0
  ds_read_b64_tr_b16 a[34:35], v41 offset:512
  ds_read_b64_tr_b16 a[64:65], v42 offset:0
  ds_read_b64_tr_b16 a[66:67], v42 offset:512
  ds_read_b64_tr_b16 a[96:97], v43 offset:0
  ds_read_b64_tr_b16 a[98:99], v43 offset:512
  ds_read_b128 a[128:131], v32 offset:0
  ds_read_b128 a[160:163], v32 offset:2048
  ds_read_b128 a[192:195], v32 offset:16384
  ds_read_b128 a[224:227], v32 offset:18432
  v_lshlrev_b32 v144, 9, v3
  v_lshl_add_u32 v144, v4, 4, v144
  s_add_u32 s53, s52, 73400320
  s_add_u32 s52, s52, 71565312
  v_mov_b32 v136, v128
  v_mov_b32 v140, v129
  v_mov_b32 v137, v130
  v_mov_b32 v141, v131
  v_mov_b32 v138, v132
  v_mov_b32 v142, v133
  v_mov_b32 v139, v134
  v_mov_b32 v143, v135
  buffer_store_dwordx4 v[128:131], v144, s[8:11], s52 offen sc1
  buffer_store_dwordx4 v[132:135], v144, s[8:11], s52 offen offset:256 sc1
  buffer_store_dwordx4 v[136:139], v2, s[8:11], s53 offen sc1
  buffer_store_dwordx4 v[140:143], v2, s[8:11], s53 offen offset:1024 sc1
  s_waitcnt lgkmcnt(0)
  v_mfma_f32_16x16x32_bf16 v[64:67], a[128:131], a[0:3], 0
  ds_read_b64_tr_b16 a[4:5], v40 offset:4096
  ds_read_b64_tr_b16 a[6:7], v40 offset:4608
  v_mfma_f32_16x16x32_bf16 v[68:71], a[160:163], a[0:3], 0
  ds_read_b64_tr_b16 a[36:37], v41 offset:4096
  ds_read_b64_tr_b16 a[38:39], v41 offset:4608
  v_mfma_f32_16x16x32_bf16 v[72:75], a[128:131], a[32:35], 0
  ds_read_b64_tr_b16 a[68:69], v42 offset:4096
  ds_read_b64_tr_b16 a[70:71], v42 offset:4608
  v_mfma_f32_16x16x32_bf16 v[76:79], a[160:163], a[32:35], 0
  ds_read_b64_tr_b16 a[100:101], v43 offset:4096
  ds_read_b64_tr_b16 a[102:103], v43 offset:4608
  v_mfma_f32_16x16x32_bf16 v[80:83], a[128:131], a[64:67], 0
  ds_read_b128 a[132:135], v33 offset:0
  ds_read_b128 a[164:167], v33 offset:2048
  v_mfma_f32_16x16x32_bf16 v[84:87], a[160:163], a[64:67], 0
  ds_read_b128 a[196:199], v33 offset:16384
  ds_read_b128 a[228:231], v33 offset:18432
  v_mfma_f32_16x16x32_bf16 v[88:91], a[128:131], a[96:99], 0
  v_mfma_f32_16x16x32_bf16 v[92:95], a[160:163], a[96:99], 0
  v_mfma_f32_16x16x32_bf16 v[96:99], a[192:195], a[0:3], 0
  v_mfma_f32_16x16x32_bf16 v[100:103], a[224:227], a[0:3], 0
  v_mfma_f32_16x16x32_bf16 v[104:107], a[192:195], a[32:35], 0
  v_mfma_f32_16x16x32_bf16 v[108:111], a[224:227], a[32:35], 0
  v_mfma_f32_16x16x32_bf16 v[112:115], a[192:195], a[64:67], 0
  v_mfma_f32_16x16x32_bf16 v[116:119], a[224:227], a[64:67], 0
  v_mfma_f32_16x16x32_bf16 v[120:123], a[192:195], a[96:99], 0
  v_mfma_f32_16x16x32_bf16 v[124:127], a[224:227], a[96:99], 0
  s_waitcnt lgkmcnt(0)
  v_mfma_f32_16x16x32_bf16 v[64:67], a[132:135], a[4:7], v[64:67]
  ds_read_b64_tr_b16 a[8:9], v40 offset:8192
  ds_read_b64_tr_b16 a[10:11], v40 offset:8704
  v_mfma_f32_16x16x32_bf16 v[68:71], a[164:167], a[4:7], v[68:71]
  ds_read_b64_tr_b16 a[40:41], v41 offset:8192
  ds_read_b64_tr_b16 a[42:43], v41 offset:8704
  v_mfma_f32_16x16x32_bf16 v[72:75], a[132:135], a[36:39], v[72:75]
  ds_read_b64_tr_b16 a[72:73], v42 offset:8192
  ds_read_b64_tr_b16 a[74:75], v42 offset:8704
  v_mfma_f32_16x16x32_bf16 v[76:79], a[164:167], a[36:39], v[76:79]
  ds_read_b64_tr_b16 a[104:105], v43 offset:8192
  ds_read_b64_tr_b16 a[106:107], v43 offset:8704
  v_mfma_f32_16x16x32_bf16 v[80:83], a[132:135], a[68:71], v[80:83]
  ds_read_b128 a[136:139], v34 offset:0
  ds_read_b128 a[168:171], v34 offset:2048
  v_mfma_f32_16x16x32_bf16 v[84:87], a[164:167], a[68:71], v[84:87]
  ds_read_b128 a[200:203], v34 offset:16384
  ds_read_b128 a[232:235], v34 offset:18432
  v_mfma_f32_16x16x32_bf16 v[88:91], a[132:135], a[100:103], v[88:91]
  v_mfma_f32_16x16x32_bf16 v[92:95], a[164:167], a[100:103], v[92:95]
  v_mfma_f32_16x16x32_bf16 v[96:99], a[196:199], a[4:7], v[96:99]
  v_mfma_f32_16x16x32_bf16 v[100:103], a[228:231], a[4:7], v[100:103]
  v_mfma_f32_16x16x32_bf16 v[104:107], a[196:199], a[36:39], v[104:107]
  v_mfma_f32_16x16x32_bf16 v[108:111], a[228:231], a[36:39], v[108:111]
  v_mfma_f32_16x16x32_bf16 v[112:115], a[196:199], a[68:71], v[112:115]
  v_mfma_f32_16x16x32_bf16 v[116:119], a[228:231], a[68:71], v[116:119]
  v_mfma_f32_16x16x32_bf16 v[120:123], a[196:199], a[100:103], v[120:123]
  v_mfma_f32_16x16x32_bf16 v[124:127], a[228:231], a[100:103], v[124:127]
  s_waitcnt lgkmcnt(0)
  v_mfma_f32_16x16x32_bf16 v[64:67], a[136:139], a[8:11], v[64:67]
  ds_read_b64_tr_b16 a[12:13], v40 offset:12288
  ds_read_b64_tr_b16 a[14:15], v40 offset:12800
  v_mfma_f32_16x16x32_bf16 v[68:71], a[168:171], a[8:11], v[68:71]
  ds_read_b64_tr_b16 a[44:45], v41 offset:12288
  ds_read_b64_tr_b16 a[46:47], v41 offset:12800
  v_mfma_f32_16x16x32_bf16 v[72:75], a[136:139], a[40:43], v[72:75]
  ds_read_b64_tr_b16 a[76:77], v42 offset:12288
  ds_read_b64_tr_b16 a[78:79], v42 offset:12800
  v_mfma_f32_16x16x32_bf16 v[76:79], a[168:171], a[40:43], v[76:79]
  ds_read_b64_tr_b16 a[108:109], v43 offset:12288
  ds_read_b64_tr_b16 a[110:111], v43 offset:12800
  v_mfma_f32_16x16x32_bf16 v[80:83], a[136:139], a[72:75], v[80:83]
  ds_read_b128 a[140:143], v35 offset:0
  ds_read_b128 a[172:175], v35 offset:2048
  v_mfma_f32_16x16x32_bf16 v[84:87], a[168:171], a[72:75], v[84:87]
  ds_read_b128 a[204:207], v35 offset:16384
  ds_read_b128 a[236:239], v35 offset:18432
  v_mfma_f32_16x16x32_bf16 v[88:91], a[136:139], a[104:107], v[88:91]
  v_mfma_f32_16x16x32_bf16 v[92:95], a[168:171], a[104:107], v[92:95]
  v_mfma_f32_16x16x32_bf16 v[96:99], a[200:203], a[8:11], v[96:99]
  v_mfma_f32_16x16x32_bf16 v[100:103], a[232:235], a[8:11], v[100:103]
  v_mfma_f32_16x16x32_bf16 v[104:107], a[200:203], a[40:43], v[104:107]
  v_mfma_f32_16x16x32_bf16 v[108:111], a[232:235], a[40:43], v[108:111]
  v_mfma_f32_16x16x32_bf16 v[112:115], a[200:203], a[72:75], v[112:115]
  v_mfma_f32_16x16x32_bf16 v[116:119], a[232:235], a[72:75], v[116:119]
  v_mfma_f32_16x16x32_bf16 v[120:123], a[200:203], a[104:107], v[120:123]
  v_mfma_f32_16x16x32_bf16 v[124:127], a[232:235], a[104:107], v[124:127]
  s_waitcnt lgkmcnt(0)
  v_mfma_f32_16x16x32_bf16 v[64:67], a[140:143], a[12:15], v[64:67]
  ds_read_b64_tr_b16 a[16:17], v40 offset:16384
  ds_read_b64_tr_b16 a[18:19], v40 offset:16896
  v_mfma_f32_16x16x32_bf16 v[68:71], a[172:175], a[12:15], v[68:71]
  ds_read_b64_tr_b16 a[48:49], v41 offset:16384
  ds_read_b64_tr_b16 a[50:51], v41 offset:16896
  v_mfma_f32_16x16x32_bf16 v[72:75], a[140:143], a[44:47], v[72:75]
  ds_read_b64_tr_b16 a[80:81], v42 offset:16384
  ds_read_b64_tr_b16 a[82:83], v42 offset:16896
  v_mfma_f32_16x16x32_bf16 v[76:79], a[172:175], a[44:47], v[76:79]
  ds_read_b64_tr_b16 a[112:113], v43 offset:16384
  ds_read_b64_tr_b16 a[114:115], v43 offset:16896
  v_mfma_f32_16x16x32_bf16 v[80:83], a[140:143], a[76:79], v[80:83]
  ds_read_b128 a[144:147], v32 offset:256
  ds_read_b128 a[176:179], v32 offset:2304
  v_mfma_f32_16x16x32_bf16 v[84:87], a[172:175], a[76:79], v[84:87]
  ds_read_b128 a[208:211], v32 offset:16640
  ds_read_b128 a[240:243], v32 offset:18688
  v_mfma_f32_16x16x32_bf16 v[88:91], a[140:143], a[108:111], v[88:91]
  v_mfma_f32_16x16x32_bf16 v[92:95], a[172:175], a[108:111], v[92:95]
  v_mfma_f32_16x16x32_bf16 v[96:99], a[204:207], a[12:15], v[96:99]
  v_mfma_f32_16x16x32_bf16 v[100:103], a[236:239], a[12:15], v[100:103]
  v_mfma_f32_16x16x32_bf16 v[104:107], a[204:207], a[44:47], v[104:107]
  v_mfma_f32_16x16x32_bf16 v[108:111], a[236:239], a[44:47], v[108:111]
  v_mfma_f32_16x16x32_bf16 v[112:115], a[204:207], a[76:79], v[112:115]
  v_mfma_f32_16x16x32_bf16 v[116:119], a[236:239], a[76:79], v[116:119]
  v_mfma_f32_16x16x32_bf16 v[120:123], a[204:207], a[108:111], v[120:123]
  v_mfma_f32_16x16x32_bf16 v[124:127], a[236:239], a[108:111], v[124:127]
  s_waitcnt lgkmcnt(0)
  v_mfma_f32_16x16x32_bf16 v[64:67], a[144:147], a[16:19], v[64:67]
  ds_read_b64_tr_b16 a[20:21], v40 offset:20480
  ds_read_b64_tr_b16 a[22:23], v40 offset:20992
  v_mfma_f32_16x16x32_bf16 v[68:71], a[176:179], a[16:19], v[68:71]
  ds_read_b64_tr_b16 a[52:53], v41 offset:20480
  ds_read_b64_tr_b16 a[54:55], v41 offset:20992
  v_mfma_f32_16x16x32_bf16 v[72:75], a[144:147], a[48:51], v[72:75]
  ds_read_b64_tr_b16 a[84:85], v42 offset:20480
  ds_read_b64_tr_b16 a[86:87], v42 offset:20992
  v_mfma_f32_16x16x32_bf16 v[76:79], a[176:179], a[48:51], v[76:79]
  ds_read_b64_tr_b16 a[116:117], v43 offset:20480
  ds_read_b64_tr_b16 a[118:119], v43 offset:20992
  v_mfma_f32_16x16x32_bf16 v[80:83], a[144:147], a[80:83], v[80:83]
  ds_read_b128 a[148:151], v33 offset:256
  ds_read_b128 a[180:183], v33 offset:2304
  v_mfma_f32_16x16x32_bf16 v[84:87], a[176:179], a[80:83], v[84:87]
  ds_read_b128 a[212:215], v33 offset:16640
  ds_read_b128 a[244:247], v33 offset:18688
  v_mfma_f32_16x16x32_bf16 v[88:91], a[144:147], a[112:115], v[88:91]
  v_mfma_f32_16x16x32_bf16 v[92:95], a[176:179], a[112:115], v[92:95]
  v_mfma_f32_16x16x32_bf16 v[96:99], a[208:211], a[16:19], v[96:99]
  v_mfma_f32_16x16x32_bf16 v[100:103], a[240:243], a[16:19], v[100:103]
  v_mfma_f32_16x16x32_bf16 v[104:107], a[208:211], a[48:51], v[104:107]
  v_mfma_f32_16x16x32_bf16 v[108:111], a[240:243], a[48:51], v[108:111]
  v_mfma_f32_16x16x32_bf16 v[112:115], a[208:211], a[80:83], v[112:115]
  v_mfma_f32_16x16x32_bf16 v[116:119], a[240:243], a[80:83], v[116:119]
  v_mfma_f32_16x16x32_bf16 v[120:123], a[208:211], a[112:115], v[120:123]
  v_mfma_f32_16x16x32_bf16 v[124:127], a[240:243], a[112:115], v[124:127]
  s_waitcnt lgkmcnt(0)
  v_mfma_f32_16x16x32_bf16 v[64:67], a[148:151], a[20:23], v[64:67]
  ds_read_b64_tr_b16 a[24:25], v40 offset:24576
  ds_read_b64_tr_b16 a[26:27], v40 offset:25088
  v_mfma_f32_16x16x32_bf16 v[68:71], a[180:183], a[20:23], v[68:71]
  ds_read_b64_tr_b16 a[56:57], v41 offset:24576
  ds_read_b64_tr_b16 a[58:59], v41 offset:25088
  v_mfma_f32_16x16x32_bf16 v[72:75], a[148:151], a[52:55], v[72:75]
  ds_read_b64_tr_b16 a[88:89], v42 offset:24576
  ds_read_b64_tr_b16 a[90:91], v42 offset:25088
  v_mfma_f32_16x16x32_bf16 v[76:79], a[180:183], a[52:55], v[76:79]
  ds_read_b64_tr_b16 a[120:121], v43 offset:24576
  ds_read_b64_tr_b16 a[122:123], v43 offset:25088
  v_mfma_f32_16x16x32_bf16 v[80:83], a[148:151], a[84:87], v[80:83]
  ds_read_b128 a[152:155], v34 offset:256
  ds_read_b128 a[184:187], v34 offset:2304
  v_mfma_f32_16x16x32_bf16 v[84:87], a[180:183], a[84:87], v[84:87]
  ds_read_b128 a[216:219], v34 offset:16640
  ds_read_b128 a[248:251], v34 offset:18688
  v_mfma_f32_16x16x32_bf16 v[88:91], a[148:151], a[116:119], v[88:91]
  v_mfma_f32_16x16x32_bf16 v[92:95], a[180:183], a[116:119], v[92:95]
  v_mfma_f32_16x16x32_bf16 v[96:99], a[212:215], a[20:23], v[96:99]
  v_mfma_f32_16x16x32_bf16 v[100:103], a[244:247], a[20:23], v[100:103]
  v_mfma_f32_16x16x32_bf16 v[104:107], a[212:215], a[52:55], v[104:107]
  v_mfma_f32_16x16x32_bf16 v[108:111], a[244:247], a[52:55], v[108:111]
  v_mfma_f32_16x16x32_bf16 v[112:115], a[212:215], a[84:87], v[112:115]
  v_mfma_f32_16x16x32_bf16 v[116:119], a[244:247], a[84:87], v[116:119]
  v_mfma_f32_16x16x32_bf16 v[120:123], a[212:215], a[116:119], v[120:123]
  v_mfma_f32_16x16x32_bf16 v[124:127], a[244:247], a[116:119], v[124:127]
  s_waitcnt lgkmcnt(0)
  v_mfma_f32_16x16x32_bf16 v[64:67], a[152:155], a[24:27], v[64:67]
  ds_read_b64_tr_b16 a[28:29], v40 offset:28672
  ds_read_b64_tr_b16 a[30:31], v40 offset:29184
  v_mfma_f32_16x16x32_bf16 v[68:71], a[184:187], a[24:27], v[68:71]
  ds_read_b64_tr_b16 a[60:61], v41 offset:28672
  ds_read_b64_tr_b16 a[62:63], v41 offset:29184
  v_mfma_f32_16x16x32_bf16 v[72:75], a[152:155], a[56:59], v[72:75]
  ds_read_b64_tr_b16 a[92:93], v42 offset:28672
  ds_read_b64_tr_b16 a[94:95], v42 offset:29184
  v_mfma_f32_16x16x32_bf16 v[76:79], a[184:187], a[56:59], v[76:79]
  ds_read_b64_tr_b16 a[124:125], v43 offset:28672
  ds_read_b64_tr_b16 a[126:127], v43 offset:29184
  v_mfma_f32_16x16x32_bf16 v[80:83], a[152:155], a[88:91], v[80:83]
  ds_read_b128 a[156:159], v35 offset:256
  ds_read_b128 a[188:191], v35 offset:2304
  v_mfma_f32_16x16x32_bf16 v[84:87], a[184:187], a[88:91], v[84:87]
  ds_read_b128 a[220:223], v35 offset:16640
  ds_read_b128 a[252:255], v35 offset:18688
  v_mfma_f32_16x16x32_bf16 v[88:91], a[152:155], a[120:123], v[88:91]
  v_mfma_f32_16x16x32_bf16 v[92:95], a[184:187], a[120:123], v[92:95]
  v_mfma_f32_16x16x32_bf16 v[96:99], a[216:219], a[24:27], v[96:99]
  v_mfma_f32_16x16x32_bf16 v[100:103], a[248:251], a[24:27], v[100:103]
  v_mfma_f32_16x16x32_bf16 v[104:107], a[216:219], a[56:59], v[104:107]
  v_mfma_f32_16x16x32_bf16 v[108:111], a[248:251], a[56:59], v[108:111]
  v_mfma_f32_16x16x32_bf16 v[112:115], a[216:219], a[88:91], v[112:115]
  v_mfma_f32_16x16x32_bf16 v[116:119], a[248:251], a[88:91], v[116:119]
  v_mfma_f32_16x16x32_bf16 v[120:123], a[216:219], a[120:123], v[120:123]
  v_mfma_f32_16x16x32_bf16 v[124:127], a[248:251], a[120:123], v[124:127]
  s_waitcnt lgkmcnt(0)
  s_barrier
  buffer_load_dwordx2 v[254:255], v252, s[12:15], 0 offen offset:128 sc1
  v_mfma_f32_16x16x32_bf16 v[64:67], a[156:159], a[28:31], v[64:67]
  v_mfma_f32_16x16x32_bf16 v[68:71], a[188:191], a[28:31], v[68:71]
  v_mfma_f32_16x16x32_bf16 v[72:75], a[156:159], a[60:63], v[72:75]
  v_mfma_f32_16x16x32_bf16 v[76:79], a[188:191], a[60:63], v[76:79]
  v_mfma_f32_16x16x32_bf16 v[80:83], a[156:159], a[92:95], v[80:83]
  v_cvt_pk_bf16_f32 v64, v64, v65
  v_cvt_pk_bf16_f32 v65, v66, v67
  v_mfma_f32_16x16x32_bf16 v[84:87], a[188:191], a[92:95], v[84:87]
  v_cvt_pk_bf16_f32 v66, v68, v69
  v_cvt_pk_bf16_f32 v67, v70, v71
  v_mfma_f32_16x16x32_bf16 v[88:91], a[156:159], a[124:127], v[88:91]
  buffer_store_dwordx4 v[64:67], v12, s[8:11], s29 offen sc1
  v_cvt_pk_bf16_f32 v72, v72, v73
  v_mfma_f32_16x16x32_bf16 v[92:95], a[188:191], a[124:127], v[92:95]
  v_cvt_pk_bf16_f32 v73, v74, v75
  v_cvt_pk_bf16_f32 v74, v76, v77
  v_mfma_f32_16x16x32_bf16 v[96:99], a[220:223], a[28:31], v[96:99]
  v_cvt_pk_bf16_f32 v75, v78, v79
  buffer_store_dwordx4 v[72:75], v13, s[8:11], s29 offen sc1
  v_mfma_f32_16x16x32_bf16 v[100:103], a[252:255], a[28:31], v[100:103]
  v_cvt_pk_bf16_f32 v80, v80, v81
  v_cvt_pk_bf16_f32 v81, v82, v83
  v_mfma_f32_16x16x32_bf16 v[104:107], a[220:223], a[60:63], v[104:107]
  v_cvt_pk_bf16_f32 v82, v84, v85
  v_cvt_pk_bf16_f32 v83, v86, v87
  v_mfma_f32_16x16x32_bf16 v[108:111], a[252:255], a[60:63], v[108:111]
  buffer_store_dwordx4 v[80:83], v14, s[8:11], s29 offen sc1
  v_cvt_pk_bf16_f32 v88, v88, v89
  v_mfma_f32_16x16x32_bf16 v[112:115], a[220:223], a[92:95], v[112:115]
  v_cvt_pk_bf16_f32 v89, v90, v91
  v_cvt_pk_bf16_f32 v90, v92, v93
  v_mfma_f32_16x16x32_bf16 v[116:119], a[252:255], a[92:95], v[116:119]
  v_cvt_pk_bf16_f32 v91, v94, v95
  buffer_store_dwordx4 v[88:91], v15, s[8:11], s29 offen sc1
  v_mfma_f32_16x16x32_bf16 v[120:123], a[220:223], a[124:127], v[120:123]
  v_cvt_pk_bf16_f32 v96, v96, v97
  v_cvt_pk_bf16_f32 v97, v98, v99
  v_mfma_f32_16x16x32_bf16 v[124:127], a[252:255], a[124:127], v[124:127]
  v_cvt_pk_bf16_f32 v98, v100, v101
  v_cvt_pk_bf16_f32 v99, v102, v103
  buffer_store_dwordx4 v[96:99], v12, s[8:11], s31 offen sc1
  v_cvt_pk_bf16_f32 v104, v104, v105
  v_cvt_pk_bf16_f32 v105, v106, v107
  v_cvt_pk_bf16_f32 v106, v108, v109
  v_cvt_pk_bf16_f32 v107, v110, v111
  buffer_store_dwordx4 v[104:107], v13, s[8:11], s31 offen sc1
  v_cvt_pk_bf16_f32 v112, v112, v113
  v_cvt_pk_bf16_f32 v113, v114, v115
  v_cvt_pk_bf16_f32 v114, v116, v117
  v_cvt_pk_bf16_f32 v115, v118, v119
  buffer_store_dwordx4 v[112:115], v14, s[8:11], s31 offen sc1
  v_cvt_pk_bf16_f32 v120, v120, v121
  v_cvt_pk_bf16_f32 v121, v122, v123
  v_cvt_pk_bf16_f32 v122, v124, v125
  v_cvt_pk_bf16_f32 v123, v126, v127
  buffer_store_dwordx4 v[120:123], v15, s[8:11], s31 offen sc1
  s_cmp_lg_u32 s34, 0
  s_cbranch_scc1 wp_B2
  s_mov_b32 s60, s40
  s_and_b32 s61, s41, 0xffff
  s_mov_b32 s62, 3670016
  s_mov_b32 s63, 0x20000
  s_mov_b32 s56, s42
  s_and_b32 s57, s43, 0xffff
  s_mov_b32 s58, 3670016
  s_mov_b32 s59, 0x20000
  s_lshl_b32 s27, s18, 2
  s_add_u32 s27, s27, s16
  s_lshl_b32 s27, s27, 17
  s_add_u32 s27, s27, s26
  s_lshl_b32 s30, s16, 13
  s_add_u32 m0, s30, 0
  s_nop 0
  buffer_load_dwordx4 v16, s[56:59], s27 offen nt lds
  s_add_u32 s27, s27, 16384
  s_add_u32 m0, s30, 1024
  s_nop 0
  buffer_load_dwordx4 v17, s[56:59], s27 offen nt lds
  s_add_u32 s27, s27, 16384
  s_add_u32 m0, s30, 2048
  s_nop 0
  buffer_load_dwordx4 v18, s[56:59], s27 offen nt lds
  s_add_u32 s27, s27, 16384
  s_add_u32 m0, s30, 3072
  s_nop 0
  buffer_load_dwordx4 v19, s[56:59], s27 offen nt lds
  s_add_u32 s27, s27, 16384
  s_add_u32 m0, s30, 4096
  s_nop 0
  buffer_load_dwordx4 v20, s[56:59], s27 offen nt lds
  s_add_u32 s27, s27, 16384
  s_add_u32 m0, s30, 5120
  s_nop 0
  buffer_load_dwordx4 v21, s[56:59], s27 offen nt lds
  s_add_u32 s27, s27, 16384
  s_add_u32 m0, s30, 6144
  s_nop 0
  buffer_load_dwordx4 v22, s[56:59], s27 offen nt lds
  s_add_u32 s27, s27, 16384
  s_add_u32 m0, s30, 7168
  s_nop 0
  buffer_load_dwordx4 v23, s[56:59], s27 offen nt lds
  s_add_u32 s27, s27, 16384
  s_add_u32 s27, s28, 0
  s_min_u32 s27, s27, 13
  s_lshl_b32 s27, s27, 18
  s_add_u32 s27, s27, s26
  s_add_u32 m0, s25, 0
  s_nop 0
  buffer_load_dwordx4 v16, s[60:63], s27 offen nt lds
  s_add_u32 s27, s27, 16384
  s_add_u32 m0, s25, 1024
  s_nop 0
  buffer_load_dwordx4 v17, s[60:63], s27 offen nt lds
  s_add_u32 s27, s27, 16384
  s_add_u32 m0, s25, 2048
  s_nop 0
  buffer_load_dwordx4 v16, s[60:63], s27 offen nt lds
  s_add_u32 s27, s27, 16384
  s_add_u32 m0, s25, 3072
  s_nop 0
  buffer_load_dwordx4 v17, s[60:63], s27 offen nt lds
  s_add_u32 s27, s27, 16384
  s_waitcnt vmcnt(12)
  s_barrier
  s_cmp_lg_u32 s16, 0
  s_cbranch_scc1 wp_f1_f
  v_readfirstlane_b32 s20, v254
  s_cmp_eq_u32 s20, 1
  s_cbranch_scc1 wp_f1_w_ok
  s_mov_b32 s30, 0
wp_f1_w:
  buffer_load_dword v254, off, s[12:15], 0 offset:128 sc1
  s_waitcnt vmcnt(0)
  v_cmp_ne_u32 vcc, 1, v254
  s_cbranch_vccz wp_f1_w_ok
  s_sleep 8
  s_add_u32 s30, s30, 1
  s_cmp_lt_u32 s30, 16
  s_cbranch_scc1 wp_f1_w
  s_branch wp_f1_f
wp_f1_w_ok:
  s_lshl_b32 s20, s17, 7
  s_add_u32 s20, s20, 88060416
  s_lshl_b32 s21, 1, s19
  v_mov_b32 v248, s21
  s_mov_b64 exec, 1
  buffer_atomic_or v248, v252, s[8:11], s20 offen sc0
  s_mov_b64 exec, -1
  s_mov_b32 s37, s21
wp_f1_f:
  s_add_u32 m0, s25, 4096
  s_nop 0
  buffer_load_dwordx4 v18, s[60:63], s27 offen nt lds
  s_add_u32 s27, s27, 16384
  s_add_u32 m0, s25, 5120
  s_nop 0
  buffer_load_dwordx4 v19, s[60:63], s27 offen nt lds
  s_add_u32 s27, s27, 16384
  s_add_u32 m0, s25, 6144
  s_nop 0
  buffer_load_dwordx4 v18, s[60:63], s27 offen nt lds
  s_add_u32 s27, s27, 16384
  s_add_u32 m0, s25, 7168
  s_nop 0
  buffer_load_dwordx4 v19, s[60:63], s27 offen nt lds
  s_add_u32 s27, s27, 16384
  s_add_u32 m0, s25, 8192
  s_nop 0
  buffer_load_dwordx4 v20, s[60:63], s27 offen nt lds
  s_add_u32 s27, s27, 16384
  s_add_u32 m0, s25, 9216
  s_nop 0
  buffer_load_dwordx4 v21, s[60:63], s27 offen nt lds
  s_add_u32 s27, s27, 16384
  s_add_u32 m0, s25, 10240
  s_nop 0
  buffer_load_dwordx4 v20, s[60:63], s27 offen nt lds
  s_add_u32 s27, s27, 16384
  s_add_u32 m0, s25, 11264
  s_nop 0
  buffer_load_dwordx4 v21, s[60:63], s27 offen nt lds
  s_add_u32 s27, s27, 16384
  s_add_u32 m0, s25, 12288
  s_nop 0
  buffer_load_dwordx4 v22, s[60:63], s27 offen nt lds
  s_add_u32 s27, s27, 16384
  s_add_u32 m0, s25, 13312
  s_nop 0
  buffer_load_dwordx4 v23, s[60:63], s27 offen nt lds
  s_add_u32 s27, s27, 16384
  s_add_u32 m0, s25, 14336
  s_nop 0
  buffer_load_dwordx4 v22, s[60:63], s27 offen nt lds
  s_add_u32 s27, s27, 16384
  s_add_u32 m0, s25, 15360
  s_nop 0
  buffer_load_dwordx4 v23, s[60:63], s27 offen nt lds
  s_add_u32 s27, s27, 16384
  s_add_u32 s27, s28, 4
  s_min_u32 s27, s27, 13
  s_lshl_b32 s27, s27, 18
  s_add_u32 s27, s27, s26
  s_add_u32 m0, s25, 16384
  s_nop 0
  buffer_load_dwordx4 v16, s[60:63], s27 offen nt lds
  s_add_u32 s27, s27, 16384
  s_add_u32 m0, s25, 17408
  s_nop 0
  buffer_load_dwordx4 v17, s[60:63], s27 offen nt lds
  s_add_u32 s27, s27, 16384
  s_add_u32 m0, s25, 18432
  s_nop 0
  buffer_load_dwordx4 v16, s[60:63], s27 offen nt lds
  s_add_u32 s27, s27, 16384
  s_add_u32 m0, s25, 19456
  s_nop 0
  buffer_load_dwordx4 v17, s[60:63], s27 offen nt lds
  s_add_u32 s27, s27, 16384
  s_add_u32 m0, s25, 20480
  s_nop 0
  buffer_load_dwordx4 v18, s[60:63], s27 offen nt lds
  s_add_u32 s27, s27, 16384
  s_add_u32 m0, s25, 21504
  s_nop 0
  buffer_load_dwordx4 v19, s[60:63], s27 offen nt lds
  s_add_u32 s27, s27, 16384
  s_add_u32 m0, s25, 22528
  s_nop 0
  buffer_load_dwordx4 v18, s[60:63], s27 offen nt lds
  s_add_u32 s27, s27, 16384
  s_add_u32 m0, s25, 23552
  s_nop 0
  buffer_load_dwordx4 v19, s[60:63], s27 offen nt lds
  s_add_u32 s27, s27, 16384
  s_add_u32 m0, s25, 24576
  s_nop 0
  buffer_load_dwordx4 v20, s[60:63], s27 offen nt lds
  s_add_u32 s27, s27, 16384
  s_add_u32 m0, s25, 25600
  s_nop 0
  buffer_load_dwordx4 v21, s[60:63], s27 offen nt lds
  s_add_u32 s27, s27, 16384
  s_add_u32 m0, s25, 26624
  s_nop 0
  buffer_load_dwordx4 v20, s[60:63], s27 offen nt lds
  s_add_u32 s27, s27, 16384
  s_add_u32 m0, s25, 27648
  s_nop 0
  buffer_load_dwordx4 v21, s[60:63], s27 offen nt lds
  s_add_u32 s27, s27, 16384
  s_add_u32 m0, s25, 28672
  s_nop 0
  buffer_load_dwordx4 v22, s[60:63], s27 offen nt lds
  s_add_u32 s27, s27, 16384
  s_add_u32 m0, s25, 29696
  s_nop 0
  buffer_load_dwordx4 v23, s[60:63], s27 offen nt lds
  s_add_u32 s27, s27, 16384
  s_add_u32 m0, s25, 30720
  s_nop 0
  buffer_load_dwordx4 v22, s[60:63], s27 offen nt lds
  s_add_u32 s27, s27, 16384
  s_add_u32 m0, s25, 31744
  s_nop 0
  buffer_load_dwordx4 v23, s[60:63], s27 offen nt lds
  s_add_u32 s27, s27, 16384
  s_branch wp_A
wp_B2:
  s_waitcnt vmcnt(0)
  s_barrier
  s_cmp_lg_u32 s16, 0
  s_cbranch_scc1 wp_f2_f
  v_readfirstlane_b32 s20, v254
  s_cmp_eq_u32 s20, 1
  s_cbranch_scc1 wp_f2_w_ok
  s_mov_b32 s30, 0
wp_f2_w:
  buffer_load_dword v254, off, s[12:15], 0 offset:128 sc1
  s_waitcnt vmcnt(0)
  v_cmp_ne_u32 vcc, 1, v254
  s_cbranch_vccz wp_f2_w_ok
  s_sleep 8
  s_add_u32 s30, s30, 1
  s_cmp_lt_u32 s30, 16
  s_cbranch_scc1 wp_f2_w
  s_branch wp_f2_f
wp_f2_w_ok:
  s_lshl_b32 s20, s17, 7
  s_add_u32 s20, s20, 88060416
  s_lshl_b32 s21, 1, s19
  v_mov_b32 v248, s21
  s_mov_b64 exec, 1
  buffer_atomic_or v248, v252, s[8:11], s20 offen sc0
  s_mov_b64 exec, -1
  s_mov_b32 s37, s21
wp_f2_f:
  s_waitcnt vmcnt(0)
  v_readfirstlane_b32 s20, v248
  s_xor_b32 s20, s20, s37
  s_cmp_lg_u32 s20, 0x3fff
  s_cselect_b32 s20, 0, s37
  s_mov_b32 s37, 0
  s_cmp_eq_u32 s20, 0
  s_cbranch_scc1 wp_g2
  s_lshl_b32 s21, 1, s17
  v_mov_b32 v248, s21
  s_mov_b32 s20, 88064512
  s_mov_b64 exec, 1
  buffer_atomic_or v248, v252, s[8:11], s20 offen
  s_mov_b64 exec, -1
wp_g2:
  s_cmp_lg_u32 s97, 0
  s_cbranch_scc1 wp_rep
  s_branch wp_ini2
wp_A0:
  s_mov_b32 s60, s40
  s_and_b32 s61, s41, 0xffff
  s_mov_b32 s62, 3670016
  s_mov_b32 s63, 0x20000
  s_mov_b32 s56, s42
  s_and_b32 s57, s43, 0xffff
  s_mov_b32 s58, 3670016
  s_mov_b32 s59, 0x20000
  s_lshl_b32 s27, s18, 2
  s_add_u32 s27, s27, s16
  s_lshl_b32 s27, s27, 17
  s_add_u32 s27, s27, s26
  s_lshl_b32 s30, s16, 13
  s_add_u32 m0, s30, 0
  s_nop 0
  buffer_load_dwordx4 v16, s[56:59], s27 offen nt lds
  s_add_u32 s27, s27, 16384
  s_add_u32 m0, s30, 1024
  s_nop 0
  buffer_load_dwordx4 v17, s[56:59], s27 offen nt lds
  s_add_u32 s27, s27, 16384
  s_add_u32 m0, s30, 2048
  s_nop 0
  buffer_load_dwordx4 v18, s[56:59], s27 offen nt lds
  s_add_u32 s27, s27, 16384
  s_add_u32 m0, s30, 3072
  s_nop 0
  buffer_load_dwordx4 v19, s[56:59], s27 offen nt lds
  s_add_u32 s27, s27, 16384
  s_add_u32 m0, s30, 4096
  s_nop 0
  buffer_load_dwordx4 v20, s[56:59], s27 offen nt lds
  s_add_u32 s27, s27, 16384
  s_add_u32 m0, s30, 5120
  s_nop 0
  buffer_load_dwordx4 v21, s[56:59], s27 offen nt lds
  s_add_u32 s27, s27, 16384
  s_add_u32 m0, s30, 6144
  s_nop 0
  buffer_load_dwordx4 v22, s[56:59], s27 offen nt lds
  s_add_u32 s27, s27, 16384
  s_add_u32 m0, s30, 7168
  s_nop 0
  buffer_load_dwordx4 v23, s[56:59], s27 offen nt lds
  s_add_u32 s27, s27, 16384
  s_add_u32 s27, s28, 0
  s_min_u32 s27, s27, 13
  s_lshl_b32 s27, s27, 18
  s_add_u32 s27, s27, s26
  s_add_u32 m0, s25, 0
  s_nop 0
  buffer_load_dwordx4 v16, s[60:63], s27 offen nt lds
  s_add_u32 s27, s27, 16384
  s_add_u32 m0, s25, 1024
  s_nop 0
  buffer_load_dwordx4 v17, s[60:63], s27 offen nt lds
  s_add_u32 s27, s27, 16384
  s_add_u32 m0, s25, 2048
  s_nop 0
  buffer_load_dwordx4 v16, s[60:63], s27 offen nt lds
  s_add_u32 s27, s27, 16384
  s_add_u32 m0, s25, 3072
  s_nop 0
  buffer_load_dwordx4 v17, s[60:63], s27 offen nt lds
  s_add_u32 s27, s27, 16384
  s_add_u32 m0, s25, 4096
  s_nop 0
  buffer_load_dwordx4 v18, s[60:63], s27 offen nt lds
  s_add_u32 s27, s27, 16384
  s_add_u32 m0, s25, 5120
  s_nop 0
  buffer_load_dwordx4 v19, s[60:63], s27 offen nt lds
  s_add_u32 s27, s27, 16384
  s_add_u32 m0, s25, 6144
  s_nop 0
  buffer_load_dwordx4 v18, s[60:63], s27 offen nt lds
  s_add_u32 s27, s27, 16384
  s_add_u32 m0, s25, 7168
  s_nop 0
  buffer_load_dwordx4 v19, s[60:63], s27 offen nt lds
  s_add_u32 s27, s27, 16384
  s_add_u32 m0, s25, 8192
  s_nop 0
  buffer_load_dwordx4 v20, s[60:63], s27 offen nt lds
  s_add_u32 s27, s27, 16384
  s_add_u32 m0, s25, 9216
  s_nop 0
  buffer_load_dwordx4 v21, s[60:63], s27 offen nt lds
  s_add_u32 s27, s27, 16384
  s_add_u32 m0, s25, 10240
  s_nop 0
  buffer_load_dwordx4 v20, s[60:63], s27 offen nt lds
  s_add_u32 s27, s27, 16384
  s_add_u32 m0, s25, 11264
  s_nop 0
  buffer_load_dwordx4 v21, s[60:63], s27 offen nt lds
  s_add_u32 s27, s27, 16384
  s_add_u32 m0, s25, 12288
  s_nop 0
  buffer_load_dwordx4 v22, s[60:63], s27 offen nt lds
  s_add_u32 s27, s27, 16384
  s_add_u32 m0, s25, 13312
  s_nop 0
  buffer_load_dwordx4 v23, s[60:63], s27 offen nt lds
  s_add_u32 s27, s27, 16384
  s_add_u32 m0, s25, 14336
  s_nop 0
  buffer_load_dwordx4 v22, s[60:63], s27 offen nt lds
  s_add_u32 s27, s27, 16384
  s_add_u32 m0, s25, 15360
  s_nop 0
  buffer_load_dwordx4 v23, s[60:63], s27 offen nt lds
  s_add_u32 s27, s27, 16384
  s_add_u32 s27, s28, 4
  s_min_u32 s27, s27, 13
  s_lshl_b32 s27, s27, 18
  s_add_u32 s27, s27, s26
  s_add_u32 m0, s25, 16384
  s_nop 0
  buffer_load_dwordx4 v16, s[60:63], s27 offen nt lds
  s_add_u32 s27, s27, 16384
  s_add_u32 m0, s25, 17408
  s_nop 0
  buffer_load_dwordx4 v17, s[60:63], s27 offen nt lds
  s_add_u32 s27, s27, 16384
  s_add_u32 m0, s25, 18432
  s_nop 0
  buffer_load_dwordx4 v16, s[60:63], s27 offen nt lds
  s_add_u32 s27, s27, 16384
  s_add_u32 m0, s25, 19456
  s_nop 0
  buffer_load_dwordx4 v17, s[60:63], s27 offen nt lds
  s_add_u32 s27, s27, 16384
  s_add_u32 m0, s25, 20480
  s_nop 0
  buffer_load_dwordx4 v18, s[60:63], s27 offen nt lds
  s_add_u32 s27, s27, 16384
  s_add_u32 m0, s25, 21504
  s_nop 0
  buffer_load_dwordx4 v19, s[60:63], s27 offen nt lds
  s_add_u32 s27, s27, 16384
  s_add_u32 m0, s25, 22528
  s_nop 0
  buffer_load_dwordx4 v18, s[60:63], s27 offen nt lds
  s_add_u32 s27, s27, 16384
  s_add_u32 m0, s25, 23552
  s_nop 0
  buffer_load_dwordx4 v19, s[60:63], s27 offen nt lds
  s_add_u32 s27, s27, 16384
  s_add_u32 m0, s25, 24576
  s_nop 0
  buffer_load_dwordx4 v20, s[60:63], s27 offen nt lds
  s_add_u32 s27, s27, 16384
  s_add_u32 m0, s25, 25600
  s_nop 0
  buffer_load_dwordx4 v21, s[60:63], s27 offen nt lds
  s_add_u32 s27, s27, 16384
  s_add_u32 m0, s25, 26624
  s_nop 0
  buffer_load_dwordx4 v20, s[60:63], s27 offen nt lds
  s_add_u32 s27, s27, 16384
  s_add_u32 m0, s25, 27648
  s_nop 0
  buffer_load_dwordx4 v21, s[60:63], s27 offen nt lds
  s_add_u32 s27, s27, 16384
  s_add_u32 m0, s25, 28672
  s_nop 0
  buffer_load_dwordx4 v22, s[60:63], s27 offen nt lds
  s_add_u32 s27, s27, 16384
  s_add_u32 m0, s25, 29696
  s_nop 0
  buffer_load_dwordx4 v23, s[60:63], s27 offen nt lds
  s_add_u32 s27, s27, 16384
  s_add_u32 m0, s25, 30720
  s_nop 0
  buffer_load_dwordx4 v22, s[60:63], s27 offen nt lds
  s_add_u32 s27, s27, 16384
  s_add_u32 m0, s25, 31744
  s_nop 0
  buffer_load_dwordx4 v23, s[60:63], s27 offen nt lds
  s_add_u32 s27, s27, 16384
wp_A:
  v_lshrrev_b32 v7, 2, v4
  v_lshlrev_b32 v7, 3, v7
  v_and_b32 v8, 3, v4
  v_add_u32 v7, v7, v8
  v_or_b32 v10, 0, v3
  v_xor_b32 v10, v10, v4
  v_lshlrev_b32 v10, 4, v10
  v_lshl_add_u32 v10, v7, 9, v10
  v_add_u32 v32, s25, v10
  v_or_b32 v10, 4, v3
  v_xor_b32 v10, v10, v4
  v_lshlrev_b32 v10, 4, v10
  v_lshl_add_u32 v10, v7, 9, v10
  v_add_u32 v33, s25, v10
  v_or_b32 v10, 8, v3
  v_xor_b32 v10, v10, v4
  v_lshlrev_b32 v10, 4, v10
  v_lshl_add_u32 v10, v7, 9, v10
  v_add_u32 v34, s25, v10
  v_or_b32 v10, 12, v3
  v_xor_b32 v10, v10, v4
  v_lshlrev_b32 v10, 4, v10
  v_lshl_add_u32 v10, v7, 9, v10
  v_add_u32 v35, s25, v10
  v_lshrrev_b32 v7, 2, v4
  v_lshlrev_b32 v7, 4, v7
  v_and_b32 v8, 2, v4
  v_lshl_add_u32 v7, v8, 1, v7
  v_and_b32 v8, 1, v4
  v_add_u32 v7, v7, v8
  v_add_u32 v11, 0, v7
  v_and_b32 v9, 15, v11
  v_or_b32 v10, 0, v3
  v_xor_b32 v10, v10, v9
  v_lshlrev_b32 v10, 4, v10
  v_lshl_add_u32 v40, v11, 9, v10
  v_or_b32 v10, 4, v3
  v_xor_b32 v10, v10, v9
  v_lshlrev_b32 v10, 4, v10
  v_lshl_add_u32 v41, v11, 9, v10
  v_or_b32 v10, 8, v3
  v_xor_b32 v10, v10, v9
  v_lshlrev_b32 v10, 4, v10
  v_lshl_add_u32 v42, v11, 9, v10
  v_or_b32 v10, 12, v3
  v_xor_b32 v10, v10, v9
  v_lshlrev_b32 v10, 4, v10
  v_lshl_add_u32 v43, v11, 9, v10
  v_add_u32 v11, 2, v7
  v_and_b32 v9, 15, v11
  v_or_b32 v10, 0, v3
  v_xor_b32 v10, v10, v9
  v_lshlrev_b32 v10, 4, v10
  v_lshl_add_u32 v44, v11, 9, v10
  v_or_b32 v10, 4, v3
  v_xor_b32 v10, v10, v9
  v_lshlrev_b32 v10, 4, v10
  v_lshl_add_u32 v45, v11, 9, v10
  v_or_b32 v10, 8, v3
  v_xor_b32 v10, v10, v9
  v_lshlrev_b32 v10, 4, v10
  v_lshl_add_u32 v46, v11, 9, v10
  v_or_b32 v10, 12, v3
  v_xor_b32 v10, v10, v9
  v_lshlrev_b32 v10, 4, v10
  v_lshl_add_u32 v47, v11, 9, v10
  v_add_u32 v11, 8, v7
  v_and_b32 v9, 15, v11
  v_or_b32 v10, 0, v3
  v_xor_b32 v10, v10, v9
  v_lshlrev_b32 v10, 4, v10
  v_lshl_add_u32 v48, v11, 9, v10
  v_or_b32 v10, 4, v3
  v_xor_b32 v10, v10, v9
  v_lshlrev_b32 v10, 4, v10
  v_lshl_add_u32 v49, v11, 9, v10
  v_or_b32 v10, 8, v3
  v_xor_b32 v10, v10, v9
  v_lshlrev_b32 v10, 4, v10
  v_lshl_add_u32 v50, v11, 9, v10
  v_or_b32 v10, 12, v3
  v_xor_b32 v10, v10, v9
  v_lshlrev_b32 v10, 4, v10
  v_lshl_add_u32 v51, v11, 9, v10
  v_add_u32 v11, 10, v7
  v_and_b32 v9, 15, v11
  v_or_b32 v10, 0, v3
  v_xor_b32 v10, v10, v9
  v_lshlrev_b32 v10, 4, v10
  v_lshl_add_u32 v52, v11, 9, v10
  v_or_b32 v10, 4, v3
  v_xor_b32 v10, v10, v9
  v_lshlrev_b32 v10, 4, v10
  v_lshl_add_u32 v53, v11, 9, v10
  v_or_b32 v10, 8, v3
  v_xor_b32 v10, v10, v9
  v_lshlrev_b32 v10, 4, v10
  v_lshl_add_u32 v54, v11, 9, v10
  v_or_b32 v10, 12, v3
  v_xor_b32 v10, v10, v9
  v_lshlrev_b32 v10, 4, v10
  v_lshl_add_u32 v55, v11, 9, v10
  s_mul_i32 s30, s17, 401408
  s_mul_i32 s31, s18, 57344
  s_add_u32 s30, s30, s31
  s_add_u32 s30, s30, 0
  v_add_u32 v12, s30, v2
  s_add_u32 s30, s30, 14336
  v_add_u32 v13, s30, v2
  s_add_u32 s30, s30, 14336
  v_add_u32 v14, s30, v2
  s_add_u32 s30, s30, 14336
  v_add_u32 v15, s30, v2
  s_add_u32 s30, s30, 14336
  v_mov_b32 v36, 1035512379
  s_lshl_b32 s29, s28, 10
  s_add_u32 s31, s29, 4096
  s_cmp_lt_u32 s28, 10
  s_cselect_b32 s31, s31, 0x40000000
  s_waitcnt vmcnt(0)
  s_barrier
  ds_read_b128 a[0:3], v40 offset:0
  ds_read_b128 a[32:35], v44 offset:0
  ds_read_b128 a[64:67], v48 offset:0
  ds_read_b128 a[96:99], v52 offset:0
  ds_read_b128 a[128:131], v32 offset:0
  ds_read_b128 a[160:163], v32 offset:2048
  ds_read_b128 a[192:195], v32 offset:16384
  ds_read_b128 a[224:227], v32 offset:18432
  v_readfirstlane_b32 s20, v248
  s_xor_b32 s20, s20, s37
  s_cmp_lg_u32 s20, 0x3fff
  s_cselect_b32 s20, 0, s37
  s_mov_b32 s37, 0
  s_cmp_eq_u32 s20, 0
  s_cbranch_scc1 wp_g1
  s_lshl_b32 s21, 1, s17
  v_mov_b32 v248, s21
  s_mov_b32 s20, 88064512
  s_mov_b64 exec, 1
  buffer_atomic_or v248, v252, s[8:11], s20 offen
  s_mov_b64 exec, -1
wp_g1:
  s_waitcnt lgkmcnt(0)
  v_mfma_f32_16x16x32_bf16 v[64:67], a[128:131], a[0:3], 0
  ds_read_b128 a[4:7], v41 offset:0
  ds_read_b128 a[36:39], v45 offset:0
  v_mfma_f32_16x16x32_bf16 v[68:71], a[160:163], a[0:3], 0
  ds_read_b128 a[68:71], v49 offset:0
  ds_read_b128 a[100:103], v53 offset:0
  v_mfma_f32_16x16x32_bf16 v[72:75], a[128:131], a[32:35], 0
  ds_read_b128 a[132:135], v33 offset:0
  ds_read_b128 a[164:167], v33 offset:2048
  v_mfma_f32_16x16x32_bf16 v[76:79], a[160:163], a[32:35], 0
  ds_read_b128 a[196:199], v33 offset:16384
  ds_read_b128 a[228:231], v33 offset:18432
  v_mfma_f32_16x16x32_bf16 v[80:83], a[128:131], a[64:67], 0
  v_mfma_f32_16x16x32_bf16 v[84:87], a[160:163], a[64:67], 0
  v_mfma_f32_16x16x32_bf16 v[88:91], a[128:131], a[96:99], 0
  v_mfma_f32_16x16x32_bf16 v[92:95], a[160:163], a[96:99], 0
  v_mfma_f32_16x16x32_bf16 v[96:99], a[192:195], a[0:3], 0
  v_mfma_f32_16x16x32_bf16 v[100:103], a[224:227], a[0:3], 0
  v_mfma_f32_16x16x32_bf16 v[104:107], a[192:195], a[32:35], 0
  v_mfma_f32_16x16x32_bf16 v[108:111], a[224:227], a[32:35], 0
  v_mfma_f32_16x16x32_bf16 v[112:115], a[192:195], a[64:67], 0
  v_mfma_f32_16x16x32_bf16 v[116:119], a[224:227], a[64:67], 0
  v_mfma_f32_16x16x32_bf16 v[120:123], a[192:195], a[96:99], 0
  v_mfma_f32_16x16x32_bf16 v[124:127], a[224:227], a[96:99], 0
  s_waitcnt lgkmcnt(0)
  v_mfma_f32_16x16x32_bf16 v[64:67], a[132:135], a[4:7], v[64:67]
  ds_read_b128 a[8:11], v42 offset:0
  ds_read_b128 a[40:43], v46 offset:0
  v_mfma_f32_16x16x32_bf16 v[68:71], a[164:167], a[4:7], v[68:71]
  ds_read_b128 a[72:75], v50 offset:0
  ds_read_b128 a[104:107], v54 offset:0
  v_mfma_f32_16x16x32_bf16 v[72:75], a[132:135], a[36:39], v[72:75]
  ds_read_b128 a[136:139], v34 offset:0
  ds_read_b128 a[168:171], v34 offset:2048
  v_mfma_f32_16x16x32_bf16 v[76:79], a[164:167], a[36:39], v[76:79]
  ds_read_b128 a[200:203], v34 offset:16384
  ds_read_b128 a[232:235], v34 offset:18432
  v_mfma_f32_16x16x32_bf16 v[80:83], a[132:135], a[68:71], v[80:83]
  v_mfma_f32_16x16x32_bf16 v[84:87], a[164:167], a[68:71], v[84:87]
  v_mfma_f32_16x16x32_bf16 v[88:91], a[132:135], a[100:103], v[88:91]
  v_mfma_f32_16x16x32_bf16 v[92:95], a[164:167], a[100:103], v[92:95]
  v_mfma_f32_16x16x32_bf16 v[96:99], a[196:199], a[4:7], v[96:99]
  v_mfma_f32_16x16x32_bf16 v[100:103], a[228:231], a[4:7], v[100:103]
  v_mfma_f32_16x16x32_bf16 v[104:107], a[196:199], a[36:39], v[104:107]
  v_mfma_f32_16x16x32_bf16 v[108:111], a[228:231], a[36:39], v[108:111]
  v_mfma_f32_16x16x32_bf16 v[112:115], a[196:199], a[68:71], v[112:115]
  v_mfma_f32_16x16x32_bf16 v[116:119], a[228:231], a[68:71], v[116:119]
  v_mfma_f32_16x16x32_bf16 v[120:123], a[196:199], a[100:103], v[120:123]
  v_mfma_f32_16x16x32_bf16 v[124:127], a[228:231], a[100:103], v[124:127]
  s_waitcnt lgkmcnt(0)
  v_mfma_f32_16x16x32_bf16 v[64:67], a[136:139], a[8:11], v[64:67]
  ds_read_b128 a[12:15], v43 offset:0
  ds_read_b128 a[44:47], v47 offset:0
  v_mfma_f32_16x16x32_bf16 v[68:71], a[168:171], a[8:11], v[68:71]
  ds_read_b128 a[76:79], v51 offset:0
  ds_read_b128 a[108:111], v55 offset:0
  v_mfma_f32_16x16x32_bf16 v[72:75], a[136:139], a[40:43], v[72:75]
  ds_read_b128 a[140:143], v35 offset:0
  ds_read_b128 a[172:175], v35 offset:2048
  v_mfma_f32_16x16x32_bf16 v[76:79], a[168:171], a[40:43], v[76:79]
  ds_read_b128 a[204:207], v35 offset:16384
  ds_read_b128 a[236:239], v35 offset:18432
  v_mfma_f32_16x16x32_bf16 v[80:83], a[136:139], a[72:75], v[80:83]
  v_mfma_f32_16x16x32_bf16 v[84:87], a[168:171], a[72:75], v[84:87]
  v_mfma_f32_16x16x32_bf16 v[88:91], a[136:139], a[104:107], v[88:91]
  v_mfma_f32_16x16x32_bf16 v[92:95], a[168:171], a[104:107], v[92:95]
  v_mfma_f32_16x16x32_bf16 v[96:99], a[200:203], a[8:11], v[96:99]
  v_mfma_f32_16x16x32_bf16 v[100:103], a[232:235], a[8:11], v[100:103]
  v_mfma_f32_16x16x32_bf16 v[104:107], a[200:203], a[40:43], v[104:107]
  v_mfma_f32_16x16x32_bf16 v[108:111], a[232:235], a[40:43], v[108:111]
  v_mfma_f32_16x16x32_bf16 v[112:115], a[200:203], a[72:75], v[112:115]
  v_mfma_f32_16x16x32_bf16 v[116:119], a[232:235], a[72:75], v[116:119]
  v_mfma_f32_16x16x32_bf16 v[120:123], a[200:203], a[104:107], v[120:123]
  v_mfma_f32_16x16x32_bf16 v[124:127], a[232:235], a[104:107], v[124:127]
  s_waitcnt lgkmcnt(0)
  v_mfma_f32_16x16x32_bf16 v[64:67], a[140:143], a[12:15], v[64:67]
  ds_read_b128 a[16:19], v40 offset:256
  ds_read_b128 a[48:51], v44 offset:256
  v_mfma_f32_16x16x32_bf16 v[68:71], a[172:175], a[12:15], v[68:71]
  ds_read_b128 a[80:83], v48 offset:256
  ds_read_b128 a[112:115], v52 offset:256
  v_mfma_f32_16x16x32_bf16 v[72:75], a[140:143], a[44:47], v[72:75]
  ds_read_b128 a[144:147], v32 offset:256
  ds_read_b128 a[176:179], v32 offset:2304
  v_mfma_f32_16x16x32_bf16 v[76:79], a[172:175], a[44:47], v[76:79]
  ds_read_b128 a[208:211], v32 offset:16640
  ds_read_b128 a[240:243], v32 offset:18688
  v_mfma_f32_16x16x32_bf16 v[80:83], a[140:143], a[76:79], v[80:83]
  v_mfma_f32_16x16x32_bf16 v[84:87], a[172:175], a[76:79], v[84:87]
  v_mfma_f32_16x16x32_bf16 v[88:91], a[140:143], a[108:111], v[88:91]
  v_mfma_f32_16x16x32_bf16 v[92:95], a[172:175], a[108:111], v[92:95]
  v_mfma_f32_16x16x32_bf16 v[96:99], a[204:207], a[12:15], v[96:99]
  v_mfma_f32_16x16x32_bf16 v[100:103], a[236:239], a[12:15], v[100:103]
  v_mfma_f32_16x16x32_bf16 v[104:107], a[204:207], a[44:47], v[104:107]
  v_mfma_f32_16x16x32_bf16 v[108:111], a[236:239], a[44:47], v[108:111]
  v_mfma_f32_16x16x32_bf16 v[112:115], a[204:207], a[76:79], v[112:115]
  v_mfma_f32_16x16x32_bf16 v[116:119], a[236:239], a[76:79], v[116:119]
  v_mfma_f32_16x16x32_bf16 v[120:123], a[204:207], a[108:111], v[120:123]
  v_mfma_f32_16x16x32_bf16 v[124:127], a[236:239], a[108:111], v[124:127]
  s_waitcnt lgkmcnt(0)
  v_mfma_f32_16x16x32_bf16 v[64:67], a[144:147], a[16:19], v[64:67]
  ds_read_b128 a[20:23], v41 offset:256
  ds_read_b128 a[52:55], v45 offset:256
  v_mfma_f32_16x16x32_bf16 v[68:71], a[176:179], a[16:19], v[68:71]
  ds_read_b128 a[84:87], v49 offset:256
  ds_read_b128 a[116:119], v53 offset:256
  v_mfma_f32_16x16x32_bf16 v[72:75], a[144:147], a[48:51], v[72:75]
  ds_read_b128 a[148:151], v33 offset:256
  ds_read_b128 a[180:183], v33 offset:2304
  v_mfma_f32_16x16x32_bf16 v[76:79], a[176:179], a[48:51], v[76:79]
  ds_read_b128 a[212:215], v33 offset:16640
  ds_read_b128 a[244:247], v33 offset:18688
  v_mfma_f32_16x16x32_bf16 v[80:83], a[144:147], a[80:83], v[80:83]
  v_mfma_f32_16x16x32_bf16 v[84:87], a[176:179], a[80:83], v[84:87]
  v_mfma_f32_16x16x32_bf16 v[88:91], a[144:147], a[112:115], v[88:91]
  v_mfma_f32_16x16x32_bf16 v[92:95], a[176:179], a[112:115], v[92:95]
  v_mfma_f32_16x16x32_bf16 v[96:99], a[208:211], a[16:19], v[96:99]
  v_mfma_f32_16x16x32_bf16 v[100:103], a[240:243], a[16:19], v[100:103]
  v_mfma_f32_16x16x32_bf16 v[104:107], a[208:211], a[48:51], v[104:107]
  v_mfma_f32_16x16x32_bf16 v[108:111], a[240:243], a[48:51], v[108:111]
  v_mfma_f32_16x16x32_bf16 v[112:115], a[208:211], a[80:83], v[112:115]
  v_mfma_f32_16x16x32_bf16 v[116:119], a[240:243], a[80:83], v[116:119]
  v_mfma_f32_16x16x32_bf16 v[120:123], a[208:211], a[112:115], v[120:123]
  v_mfma_f32_16x16x32_bf16 v[124:127], a[240:243], a[112:115], v[124:127]
  s_waitcnt lgkmcnt(0)
  v_mfma_f32_16x16x32_bf16 v[64:67], a[148:151], a[20:23], v[64:67]
  ds_read_b128 a[24:27], v42 offset:256
  ds_read_b128 a[56:59], v46 offset:256
  v_mfma_f32_16x16x32_bf16 v[68:71], a[180:183], a[20:23], v[68:71]
  ds_read_b128 a[88:91], v50 offset:256
  ds_read_b128 a[120:123], v54 offset:256
  v_mfma_f32_16x16x32_bf16 v[72:75], a[148:151], a[52:55], v[72:75]
  ds_read_b128 a[152:155], v34 offset:256
  ds_read_b128 a[184:187], v34 offset:2304
  v_mfma_f32_16x16x32_bf16 v[76:79], a[180:183], a[52:55], v[76:79]
  ds_read_b128 a[216:219], v34 offset:16640
  ds_read_b128 a[248:251], v34 offset:18688
  v_mfma_f32_16x16x32_bf16 v[80:83], a[148:151], a[84:87], v[80:83]
  v_mfma_f32_16x16x32_bf16 v[84:87], a[180:183], a[84:87], v[84:87]
  v_mfma_f32_16x16x32_bf16 v[88:91], a[148:151], a[116:119], v[88:91]
  v_mfma_f32_16x16x32_bf16 v[92:95], a[180:183], a[116:119], v[92:95]
  v_mfma_f32_16x16x32_bf16 v[96:99], a[212:215], a[20:23], v[96:99]
  v_mfma_f32_16x16x32_bf16 v[100:103], a[244:247], a[20:23], v[100:103]
  v_mfma_f32_16x16x32_bf16 v[104:107], a[212:215], a[52:55], v[104:107]
  v_mfma_f32_16x16x32_bf16 v[108:111], a[244:247], a[52:55], v[108:111]
  v_mfma_f32_16x16x32_bf16 v[112:115], a[212:215], a[84:87], v[112:115]
  v_mfma_f32_16x16x32_bf16 v[116:119], a[244:247], a[84:87], v[116:119]
  v_mfma_f32_16x16x32_bf16 v[120:123], a[212:215], a[116:119], v[120:123]
  v_mfma_f32_16x16x32_bf16 v[124:127], a[244:247], a[116:119], v[124:127]
  s_waitcnt lgkmcnt(0)
  v_mfma_f32_16x16x32_bf16 v[64:67], a[152:155], a[24:27], v[64:67]
  ds_read_b128 a[28:31], v43 offset:256
  ds_read_b128 a[60:63], v47 offset:256
  v_mfma_f32_16x16x32_bf16 v[68:71], a[184:187], a[24:27], v[68:71]
  ds_read_b128 a[92:95], v51 offset:256
  ds_read_b128 a[124:127], v55 offset:256
  v_mfma_f32_16x16x32_bf16 v[72:75], a[152:155], a[56:59], v[72:75]
  ds_read_b128 a[156:159], v35 offset:256
  ds_read_b128 a[188:191], v35 offset:2304
  v_mfma_f32_16x16x32_bf16 v[76:79], a[184:187], a[56:59], v[76:79]
  ds_read_b128 a[220:223], v35 offset:16640
  ds_read_b128 a[252:255], v35 offset:18688
  v_mfma_f32_16x16x32_bf16 v[80:83], a[152:155], a[88:91], v[80:83]
  v_mfma_f32_16x16x32_bf16 v[84:87], a[184:187], a[88:91], v[84:87]
  v_mfma_f32_16x16x32_bf16 v[88:91], a[152:155], a[120:123], v[88:91]
  v_mfma_f32_16x16x32_bf16 v[92:95], a[184:187], a[120:123], v[92:95]
  v_mfma_f32_16x16x32_bf16 v[96:99], a[216:219], a[24:27], v[96:99]
  v_mfma_f32_16x16x32_bf16 v[100:103], a[248:251], a[24:27], v[100:103]
  v_mfma_f32_16x16x32_bf16 v[104:107], a[216:219], a[56:59], v[104:107]
  v_mfma_f32_16x16x32_bf16 v[108:111], a[248:251], a[56:59], v[108:111]
  v_mfma_f32_16x16x32_bf16 v[112:115], a[216:219], a[88:91], v[112:115]
  v_mfma_f32_16x16x32_bf16 v[116:119], a[248:251], a[88:91], v[116:119]
  v_mfma_f32_16x16x32_bf16 v[120:123], a[216:219], a[120:123], v[120:123]
  v_mfma_f32_16x16x32_bf16 v[124:127], a[248:251], a[120:123], v[124:127]
  s_waitcnt lgkmcnt(0)
  s_barrier
  buffer_load_dwordx2 v[254:255], v252, s[12:15], 0 offen offset:128 sc1
  buffer_load_dword v253, v252, s[12:15], 0 offen sc1
  v_mfma_f32_16x16x32_bf16 v[64:67], a[156:159], a[28:31], v[64:67]
  v_mfma_f32_16x16x32_bf16 v[68:71], a[188:191], a[28:31], v[68:71]
  v_mfma_f32_16x16x32_bf16 v[72:75], a[156:159], a[60:63], v[72:75]
  v_mfma_f32_16x16x32_bf16 v[76:79], a[188:191], a[60:63], v[76:79]
  v_mfma_f32_16x16x32_bf16 v[80:83], a[156:159], a[92:95], v[80:83]
  v_mul_f32 v64, v36, v64
  v_mul_f32 v65, v36, v65
  v_mfma_f32_16x16x32_bf16 v[84:87], a[188:191], a[92:95], v[84:87]
  v_mul_f32 v66, v36, v66
  v_mul_f32 v67, v36, v67
  v_mfma_f32_16x16x32_bf16 v[88:91], a[156:159], a[124:127], v[88:91]
  v_mul_f32 v68, v36, v68
  v_mul_f32 v69, v36, v69
  v_mfma_f32_16x16x32_bf16 v[92:95], a[188:191], a[124:127], v[92:95]
  v_mul_f32 v70, v36, v70
  v_mul_f32 v71, v36, v71
  v_mfma_f32_16x16x32_bf16 v[96:99], a[220:223], a[28:31], v[96:99]
  v_cvt_pk_bf16_f32 v64, v64, v65
  v_cvt_pk_bf16_f32 v65, v66, v67
  v_mfma_f32_16x16x32_bf16 v[100:103], a[252:255], a[28:31], v[100:103]
  v_cvt_pk_bf16_f32 v66, v68, v69
  v_cvt_pk_bf16_f32 v67, v70, v71
  v_mfma_f32_16x16x32_bf16 v[104:107], a[220:223], a[60:63], v[104:107]
  buffer_store_dwordx4 v[64:67], v12, s[8:11], s29 offen sc1
  v_mul_f32 v72, v36, v72
  v_mfma_f32_16x16x32_bf16 v[108:111], a[252:255], a[60:63], v[108:111]
  v_mul_f32 v73, v36, v73
  v_mul_f32 v74, v36, v74
  v_mfma_f32_16x16x32_bf16 v[112:115], a[220:223], a[92:95], v[112:115]
  v_mul_f32 v75, v36, v75
  v_mul_f32 v76, v36, v76
  v_mfma_f32_16x16x32_bf16 v[116:119], a[252:255], a[92:95], v[116:119]
  v_mul_f32 v77, v36, v77
  v_mul_f32 v78, v36, v78
  v_mfma_f32_16x16x32_bf16 v[120:123], a[220:223], a[124:127], v[120:123]
  v_mul_f32 v79, v36, v79
  v_cvt_pk_bf16_f32 v72, v72, v73
  v_mfma_f32_16x16x32_bf16 v[124:127], a[252:255], a[124:127], v[124:127]
  v_cvt_pk_bf16_f32 v73, v74, v75
  v_cvt_pk_bf16_f32 v74, v76, v77
  v_cvt_pk_bf16_f32 v75, v78, v79
  buffer_store_dwordx4 v[72:75], v13, s[8:11], s29 offen sc1
  v_mul_f32 v80, v36, v80
  v_mul_f32 v81, v36, v81
  v_mul_f32 v82, v36, v82
  v_mul_f32 v83, v36, v83
  v_mul_f32 v84, v36, v84
  v_mul_f32 v85, v36, v85
  v_mul_f32 v86, v36, v86
  v_mul_f32 v87, v36, v87
  v_cvt_pk_bf16_f32 v80, v80, v81
  v_cvt_pk_bf16_f32 v81, v82, v83
  v_cvt_pk_bf16_f32 v82, v84, v85
  v_cvt_pk_bf16_f32 v83, v86, v87
  buffer_store_dwordx4 v[80:83], v14, s[8:11], s29 offen sc1
  v_mul_f32 v88, v36, v88
  v_mul_f32 v89, v36, v89
  v_mul_f32 v90, v36, v90
  v_mul_f32 v91, v36, v91
  v_mul_f32 v92, v36, v92
  v_mul_f32 v93, v36, v93
  v_mul_f32 v94, v36, v94
  v_mul_f32 v95, v36, v95
  v_cvt_pk_bf16_f32 v88, v88, v89
  v_cvt_pk_bf16_f32 v89, v90, v91
  v_cvt_pk_bf16_f32 v90, v92, v93
  v_cvt_pk_bf16_f32 v91, v94, v95
  buffer_store_dwordx4 v[88:91], v15, s[8:11], s29 offen sc1
  v_mul_f32 v96, v36, v96
  v_mul_f32 v97, v36, v97
  v_mul_f32 v98, v36, v98
  v_mul_f32 v99, v36, v99
  v_mul_f32 v100, v36, v100
  v_mul_f32 v101, v36, v101
  v_mul_f32 v102, v36, v102
  v_mul_f32 v103, v36, v103
  v_cvt_pk_bf16_f32 v96, v96, v97
  v_cvt_pk_bf16_f32 v97, v98, v99
  v_cvt_pk_bf16_f32 v98, v100, v101
  v_cvt_pk_bf16_f32 v99, v102, v103
  buffer_store_dwordx4 v[96:99], v12, s[8:11], s31 offen sc1
  v_mul_f32 v104, v36, v104
  v_mul_f32 v105, v36, v105
  v_mul_f32 v106, v36, v106
  v_mul_f32 v107, v36, v107
  v_mul_f32 v108, v36, v108
  v_mul_f32 v109, v36, v109
  v_mul_f32 v110, v36, v110
  v_mul_f32 v111, v36, v111
  v_cvt_pk_bf16_f32 v104, v104, v105
  v_cvt_pk_bf16_f32 v105, v106, v107
  v_cvt_pk_bf16_f32 v106, v108, v109
  v_cvt_pk_bf16_f32 v107, v110, v111
  buffer_store_dwordx4 v[104:107], v13, s[8:11], s31 offen sc1
  v_mul_f32 v112, v36, v112
  v_mul_f32 v113, v36, v113
  v_mul_f32 v114, v36, v114
  v_mul_f32 v115, v36, v115
  v_mul_f32 v116, v36, v116
  v_mul_f32 v117, v36, v117
  v_mul_f32 v118, v36, v118
  v_mul_f32 v119, v36, v119
  v_cvt_pk_bf16_f32 v112, v112, v113
  v_cvt_pk_bf16_f32 v113, v114, v115
  v_cvt_pk_bf16_f32 v114, v116, v117
  v_cvt_pk_bf16_f32 v115, v118, v119
  buffer_store_dwordx4 v[112:115], v14, s[8:11], s31 offen sc1
  v_mul_f32 v120, v36, v120
  v_mul_f32 v121, v36, v121
  v_mul_f32 v122, v36, v122
  v_mul_f32 v123, v36, v123
  v_mul_f32 v124, v36, v124
  v_mul_f32 v125, v36, v125
  v_mul_f32 v126, v36, v126
  v_mul_f32 v127, v36, v127
  v_cvt_pk_bf16_f32 v120, v120, v121
  v_cvt_pk_bf16_f32 v121, v122, v123
  v_cvt_pk_bf16_f32 v122, v124, v125
  v_cvt_pk_bf16_f32 v123, v126, v127
  buffer_store_dwordx4 v[120:123], v15, s[8:11], s31 offen sc1
  s_waitcnt vmcnt(0)
  s_barrier
  s_cmp_lg_u32 s16, 0
  s_cbranch_scc1 wp_f3_f
  v_readfirstlane_b32 s20, v254
  s_cmp_eq_u32 s20, 1
  s_cbranch_scc1 wp_f3_w_ok
  s_mov_b32 s30, 0
wp_f3_w:
  buffer_load_dword v254, off, s[12:15], 0 offset:128 sc1
  s_waitcnt vmcnt(0)
  v_cmp_ne_u32 vcc, 1, v254
  s_cbranch_vccz wp_f3_w_ok
  s_sleep 8
  s_add_u32 s30, s30, 1
  s_cmp_lt_u32 s30, 16
  s_cbranch_scc1 wp_f3_w
  s_branch wp_f3_f
wp_f3_w_ok:
  s_lshl_b32 s20, s17, 7
  s_add_u32 s20, s20, 88062464
  s_lshl_b32 s21, 1, s19
  v_mov_b32 v248, s21
  s_mov_b64 exec, 1
  buffer_atomic_or v248, v252, s[8:11], s20 offen sc0
  s_mov_b64 exec, -1
  s_mov_b32 s38, s21
wp_f3_f:
  s_cmp_lg_u32 s97, 0
  s_cbranch_scc1 wp_all
  v_readfirstlane_b32 s20, v255
  v_readfirstlane_b32 s21, v253
  s_and_b32 s21, s21, 0xffe0
  s_cselect_b32 s96, s20, 0
  s_cmp_eq_u32 s96, 0
  s_cbranch_scc1 wp_all
  v_mov_b32 v250, 1
  s_mov_b32 s20, 88059904
  s_mov_b64 exec, 1
  buffer_atomic_add v250, v252, s[8:11], s20 offen sc0
  s_mov_b64 exec, -1
wp_all:
  v_mov_b32 v252, 0x40000000
  v_cmp_eq_u32 vcc, 0, v0
  s_nop 1
  v_cndmask_b32 v252, v252, v0, vcc
  s_mov_b32 s34, 0
  s_cmp_lg_u32 s16, 0
  s_cbranch_scc1 wp_w2
  s_mov_b32 s24, 88064512
  buffer_load_dword v66, off, s[8:11], s24 sc1
  s_waitcnt vmcnt(0)
  v_readfirstlane_b32 s20, v248
  s_xor_b32 s20, s20, s38
  s_cmp_lg_u32 s20, 0x3fff
  s_cselect_b32 s20, 0, s38
  s_mov_b32 s38, 0
  s_cmp_eq_u32 s20, 0
  s_cbranch_scc1 wp_g3
  s_lshl_b32 s21, 65536, s17
  v_mov_b32 v248, s21
  s_mov_b32 s20, 88064512
  s_mov_b64 exec, 1
  buffer_atomic_or v248, v252, s[8:11], s20 offen
  s_mov_b64 exec, -1
wp_g3:
  s_cmp_lg_u32 s96, 0
  s_cbranch_scc1 wp_v2
  s_mov_b32 s30, 0
wp_v:
  buffer_load_dwordx2 v[64:65], off, s[12:15], 0 sc1
  buffer_load_dword v66, off, s[12:15], 0 offset:132 sc1
  s_waitcnt vmcnt(0)
  v_and_b32 v68, 0xffe0, v64
  v_min_u32 v68, v68, v66
  v_cmp_ne_u32 vcc, 1, v68
  s_cbranch_vccz wp_v_ok
  s_sleep 16
  s_add_u32 s30, s30, 1
  s_cmp_lt_u32 s30, 30
  s_cbranch_scc1 wp_v
  s_branch wp_w1
wp_v_ok:
  buffer_load_dword v66, off, s[8:11], s24 sc1
  s_waitcnt vmcnt(0)
wp_v2:
  v_mov_b32 v64, 32
  v_mov_b32 v65, 4
  v_or_b32 v66, s39, v66
  v_cmp_ne_u32 vcc, -1, v66
  s_cbranch_vccz wp_w2
  s_cmp_eq_u32 s97, 2
  s_cbranch_scc1 wp_w1
  s_mov_b32 s30, 0
wp_w:
  buffer_load_dword v66, off, s[8:11], s24 sc1
  s_waitcnt vmcnt(0)
  v_or_b32 v66, s39, v66
  v_cmp_ne_u32 vcc, -1, v66
  s_cbranch_vccz wp_w_ok
  s_sleep 8
  s_add_u32 s30, s30, 1
  s_cmp_lt_u32 s30, 60
  s_cbranch_scc1 wp_w
  s_branch wp_w1
wp_w_ok:
  s_branch wp_w2
wp_w1:
  v_readfirstlane_b32 s20, v64
  v_readfirstlane_b32 s21, v65
  s_and_b32 s20, s20, 0xffff
  s_cmp_lt_u32 s20, 32
  s_cselect_b32 s34, 2, 1
  s_cmp_lt_u32 s21, 4
  s_cselect_b32 s34, 4, s34
  s_add_u32 s32, s32, 1
  s_cmp_lt_u32 s32, 4000
  s_cselect_b32 s34, s34, 3
wp_w2:
  v_mov_b32 v6, 160032
  v_mov_b32 v7, s34
  s_barrier
  s_cmp_lg_u32 s16, 0
  s_cbranch_scc1 uni_6
  ds_write_b32 v6, v7
  s_waitcnt lgkmcnt(0)
uni_6:
  s_barrier
  ds_read_b32 v7, v6
  s_waitcnt lgkmcnt(0)
  v_readfirstlane_b32 s34, v7
  s_cmp_eq_u32 s34, 0
  s_cbranch_scc1 wp_done
  s_mov_b32 s97, 1
  s_cmp_eq_u32 s34, 1
  s_cbranch_scc1 wp_rep
  s_cmp_eq_u32 s34, 3
  s_cbranch_scc1 cA_abort
  s_cmp_eq_u32 s34, 4
  s_cbranch_scc1 wp_ini
  v_mov_b32 v4, 0x10001
  s_branch ch_take
wp_rep:
  s_load_dwordx8 s[40:47], s[0:1], 72
  s_load_dwordx4 s[48:51], s[0:1], 56
  s_waitcnt vmcnt(0) lgkmcnt(0)
  v_mov_b32 v4, 1
  v_mov_b32 v5, 20
  v_mov_b32 v6, 160000
  s_barrier
  s_cmp_lg_u32 s16, 0
  s_cbranch_scc1 wp_el1
  s_mov_b64 exec, 1
  buffer_atomic_add v4, v5, s[12:15], 0 offen sc0
  s_waitcnt vmcnt(0)
  ds_write_b32 v6, v4
  s_waitcnt lgkmcnt(0)
  s_mov_b64 exec, -1
wp_el1:
  s_barrier
  ds_read_b32 v4, v6
  s_waitcnt lgkmcnt(0)
  v_readfirstlane_b32 s33, v4
  v_and_b32 v1, 63, v0
  v_lshlrev_b32 v2, 4, v1
  v_lshrrev_b32 v3, 4, v1
  v_and_b32 v4, 15, v1
  v_lshrrev_b32 v5, 5, v1
  v_and_b32 v6, 31, v1
  v_xor_b32 v8, v6, v5
  v_lshlrev_b32 v8, 4, v8
  v_lshl_add_u32 v16, v5, 13, v8
  v_xor_b32 v17, 32, v16
  v_xor_b32 v18, 64, v16
  v_xor_b32 v19, 96, v16
  v_xor_b32 v20, 128, v16
  v_xor_b32 v21, 160, v16
  v_xor_b32 v22, 192, v16
  v_xor_b32 v23, 224, v16
  s_and_b32 s33, s33, 511
  s_and_b32 s20, s33, 255
  s_cmp_ge_u32 s20, 224
  s_cselect_b32 s97, 1, 2
  s_cbranch_scc1 wp_all
  s_mul_i32 s17, s20, 4682
  s_lshr_b32 s17, s17, 16
  s_mul_i32 s23, s17, 14
  s_sub_u32 s19, s20, s23
  s_cmp_lt_u32 s19, 7
  s_cselect_b32 s18, 0, 7
  s_cselect_b32 s28, 0, 8
  s_sub_u32 s18, s19, s18
  s_add_u32 s28, s28, s16
  s_lshl_b32 s25, s16, 15
  s_add_u32 s25, s25, 32768
  s_lshl_b32 s26, s17, 9
  s_lshl_b32 s20, s17, 7
  s_lshr_b32 s21, s33, 8
  s_lshl_b32 s21, s21, 11
  s_add_u32 s20, s20, s21
  s_add_u32 s20, s20, 88060416
  buffer_load_dword v5, off, s[8:11], s20 sc1
  s_waitcnt vmcnt(0)
  v_readfirstlane_b32 s34, v5
  v_mov_b32 v6, 160032
  s_nop 0
  v_mov_b32 v7, s34
  s_barrier
  s_cmp_lg_u32 s16, 0
  s_cbranch_scc1 uni_7
  ds_write_b32 v6, v7
  s_waitcnt lgkmcnt(0)
uni_7:
  s_barrier
  ds_read_b32 v7, v6
  s_waitcnt lgkmcnt(0)
  v_readfirstlane_b32 s34, v7
  s_bitcmp1_b32 s34, s19
  s_cbranch_scc1 wp_rep
  s_barrier
  s_cmp_lt_u32 s33, 256
  s_cbranch_scc1 wp_B
  s_branch wp_A0
wp_done:
  s_load_dwordx2 s[36:37], s[0:1], 112
  s_waitcnt lgkmcnt(0)
  s_mov_b32 s92, s36
  s_and_b32 s93, s37, 0xffff
  s_mov_b32 s94, 3670016
  s_mov_b32 s95, 0x20000
  s_mov_b32 s97, s39
  s_cmp_lg_u32 s96, 0
  s_cbranch_scc1 wk_next
  s_cmp_lg_u32 s16, 0
  s_cbranch_scc1 ask_8
  v_mov_b32 v250, 1
  v_mov_b32 v251, 88059904
  s_mov_b64 exec, 1
  buffer_atomic_add v250, v251, s[8:11], 0 offen sc0
  s_mov_b64 exec, -1
ask_8:
  s_branch wk_next
wk_loop:
  s_waitcnt vmcnt(0) lgkmcnt(0)
wk_ask:
  v_readfirstlane_b32 s22, v250
  s_cmp_ge_u32 s22, 1248
  s_cbranch_scc1 wk_next
  s_cmp_lg_u32 s16, 0
  s_cbranch_scc1 ask_9
  v_mov_b32 v250, 1
  v_mov_b32 v251, 88059904
  s_mov_b64 exec, 1
  buffer_atomic_add v250, v251, s[8:11], 0 offen sc0
  s_mov_b64 exec, -1
ask_9:
wk_next:
  v_mov_b32 v6, 160000
  s_waitcnt vmcnt(0)
  s_barrier
  s_cmp_lg_u32 s16, 0
  s_cbranch_scc1 wk_n1
  s_mov_b64 exec, 1
  ds_write_b32 v6, v250
  s_mov_b64 exec, -1
  s_waitcnt lgkmcnt(0)
wk_n1:
  s_barrier
  ds_read_b32 v4, v6
  s_waitcnt lgkmcnt(0)
  v_readfirstlane_b32 s3, v4
  s_cmp_ge_u32 s3, 1248
  s_cbranch_scc1 wk_done
  v_mov_b32 v250, 0
  v_mov_b32 v251, 88059904
  v_and_b32 v1, 63, v0
  v_lshlrev_b32 v2, 4, v1
  v_lshrrev_b32 v3, 4, v1
  v_and_b32 v4, 15, v1
  s_cmp_ge_u32 s3, 224
  s_cbranch_scc1 wk_n0
  s_mov_b32 s18, 0
  s_and_b32 s17, s3, 15
  s_add_u32 s17, s17, 16
  s_lshr_b32 s34, s3, 4
  s_add_u32 s35, s34, 1
  s_branch wk_gemm
wk_n0:
  s_cmp_eq_u32 s97, 0
  s_cbranch_scc1 wk_n2
  v_mov_b32 v250, s3
  s_mov_b32 s96, 1
  s_mov_b32 s97, 1
  s_mov_b32 s39, 0
  s_mov_b32 s37, 0
  s_mov_b32 s38, 0
  s_mov_b32 s32, 0
  s_branch wp_all
wk_n2:
  s_cmp_ge_u32 s3, 736
  s_cbranch_scc1 wk_tok
  s_cmp_ge_u32 s3, 624
  s_cbranch_scc1 wk_s4d
  s_cmp_ge_u32 s3, 432
  s_cbranch_scc1 wk_full
  s_cmp_ge_u32 s3, 400
  s_cbranch_scc1 wk_srv
  s_and_b32 s17, s3, 15
  s_add_u32 s17, s17, 16
  s_cmp_ge_u32 s3, 336
  s_cbranch_scc1 wk_half
  s_mov_b32 s18, 1
  s_sub_u32 s34, s3, 224
  s_lshr_b32 s34, s34, 4
  s_lshl_b32 s34, s34, 1
  s_add_u32 s35, s34, 2
  s_branch wk_gemm
wk_half:
  s_sub_u32 s20, s3, 336
  s_lshr_b32 s18, s20, 5
  s_add_u32 s18, s18, 2
  s_bitcmp1_b32 s20, 4
  s_cselect_b32 s34, 7, 0
  s_add_u32 s35, s34, 7
  s_branch wk_gemm
wk_full:
  s_sub_u32 s20, s3, 368
  s_and_b32 s17, s20, 15
  s_lshr_b32 s18, s20, 4
  s_cmp_lt_u32 s18, 8
  s_cselect_b32 s21, 16, 0
  s_add_u32 s17, s17, s21
  s_and_b32 s18, s18, 7
  s_mov_b32 s34, 0
  s_mov_b32 s35, 14
wk_gemm:
  s_lshl_b32 s20, s18, 4
  s_lshl_b32 s21, s16, 2
  s_add_u32 s20, s20, s21
  s_mul_i32 s21, s20, 14336
  s_add_u32 s21, s21, 71565312
  s_add_u32 s22, s21, 0
  buffer_load_dwordx4 a[0:3], v2, s[8:11], s22 offen offset:0 sc1
  buffer_load_dwordx4 a[4:7], v2, s[8:11], s22 offen offset:1024 sc1
  buffer_load_dwordx4 a[8:11], v2, s[8:11], s22 offen offset:2048 sc1
  buffer_load_dwordx4 a[12:15], v2, s[8:11], s22 offen offset:3072 sc1
  s_add_u32 s22, s21, 4096
  buffer_load_dwordx4 a[16:19], v2, s[8:11], s22 offen offset:0 sc1
  buffer_load_dwordx4 a[20:23], v2, s[8:11], s22 offen offset:1024 sc1
  buffer_load_dwordx4 a[24:27], v2, s[8:11], s22 offen offset:2048 sc1
  buffer_load_dwordx4 a[28:31], v2, s[8:11], s22 offen offset:3072 sc1
  s_add_u32 s22, s21, 8192
  buffer_load_dwordx4 a[32:35], v2, s[8:11], s22 offen offset:0 sc1
  buffer_load_dwordx4 a[36:39], v2, s[8:11], s22 offen offset:1024 sc1
  buffer_load_dwordx4 a[40:43], v2, s[8:11], s22 offen offset:2048 sc1
  buffer_load_dwordx4 a[44:47], v2, s[8:11], s22 offen offset:3072 sc1
  s_add_u32 s22, s21, 12288
  buffer_load_dwordx4 a[48:51], v2, s[8:11], s22 offen offset:0 sc1
  buffer_load_dwordx4 a[52:55], v2, s[8:11], s22 offen offset:1024 sc1
  buffer_load_dwordx4 a[56:59], v2, s[8:11], s22 offen offset:2048 sc1
  buffer_load_dwordx4 a[60:63], v2, s[8:11], s22 offen offset:3072 sc1
  s_add_u32 s22, s21, 16384
  buffer_load_dwordx4 a[64:67], v2, s[8:11], s22 offen offset:0 sc1
  buffer_load_dwordx4 a[68:71], v2, s[8:11], s22 offen offset:1024 sc1
  buffer_load_dwordx4 a[72:75], v2, s[8:11], s22 offen offset:2048 sc1
  buffer_load_dwordx4 a[76:79], v2, s[8:11], s22 offen offset:3072 sc1
  s_add_u32 s22, s21, 20480
  buffer_load_dwordx4 a[80:83], v2, s[8:11], s22 offen offset:0 sc1
  buffer_load_dwordx4 a[84:87], v2, s[8:11], s22 offen offset:1024 sc1
  buffer_load_dwordx4 a[88:91], v2, s[8:11], s22 offen offset:2048 sc1
  buffer_load_dwordx4 a[92:95], v2, s[8:11], s22 offen offset:3072 sc1
  s_add_u32 s22, s21, 24576
  buffer_load_dwordx4 a[96:99], v2, s[8:11], s22 offen offset:0 sc1
  buffer_load_dwordx4 a[100:103], v2, s[8:11], s22 offen offset:1024 sc1
  buffer_load_dwordx4 a[104:107], v2, s[8:11], s22 offen offset:2048 sc1
  buffer_load_dwordx4 a[108:111], v2, s[8:11], s22 offen offset:3072 sc1
  s_add_u32 s22, s21, 28672
  buffer_load_dwordx4 a[112:115], v2, s[8:11], s22 offen offset:0 sc1
  buffer_load_dwordx4 a[116:119], v2, s[8:11], s22 offen offset:1024 sc1
  buffer_load_dwordx4 a[120:123], v2, s[8:11], s22 offen offset:2048 sc1
  buffer_load_dwordx4 a[124:127], v2, s[8:11], s22 offen offset:3072 sc1
  s_add_u32 s22, s21, 32768
  buffer_load_dwordx4 a[128:131], v2, s[8:11], s22 offen offset:0 sc1
  buffer_load_dwordx4 a[132:135], v2, s[8:11], s22 offen offset:1024 sc1
  buffer_load_dwordx4 a[136:139], v2, s[8:11], s22 offen offset:2048 sc1
  buffer_load_dwordx4 a[140:143], v2, s[8:11], s22 offen offset:3072 sc1
  s_add_u32 s22, s21, 36864
  buffer_load_dwordx4 a[144:147], v2, s[8:11], s22 offen offset:0 sc1
  buffer_load_dwordx4 a[148:151], v2, s[8:11], s22 offen offset:1024 sc1
  buffer_load_dwordx4 a[152:155], v2, s[8:11], s22 offen offset:2048 sc1
  buffer_load_dwordx4 a[156:159], v2, s[8:11], s22 offen offset:3072 sc1
  s_add_u32 s22, s21, 40960
  buffer_load_dwordx4 a[160:163], v2, s[8:11], s22 offen offset:0 sc1
  buffer_load_dwordx4 a[164:167], v2, s[8:11], s22 offen offset:1024 sc1
  buffer_load_dwordx4 a[168:171], v2, s[8:11], s22 offen offset:2048 sc1
  buffer_load_dwordx4 a[172:175], v2, s[8:11], s22 offen offset:3072 sc1
  s_add_u32 s22, s21, 45056
  buffer_load_dwordx4 a[176:179], v2, s[8:11], s22 offen offset:0 sc1
  buffer_load_dwordx4 a[180:183], v2, s[8:11], s22 offen offset:1024 sc1
  buffer_load_dwordx4 a[184:187], v2, s[8:11], s22 offen offset:2048 sc1
  buffer_load_dwordx4 a[188:191], v2, s[8:11], s22 offen offset:3072 sc1
  s_add_u32 s22, s21, 49152
  buffer_load_dwordx4 a[192:195], v2, s[8:11], s22 offen offset:0 sc1
  buffer_load_dwordx4 a[196:199], v2, s[8:11], s22 offen offset:1024 sc1
  buffer_load_dwordx4 a[200:203], v2, s[8:11], s22 offen offset:2048 sc1
  buffer_load_dwordx4 a[204:207], v2, s[8:11], s22 offen offset:3072 sc1
  s_add_u32 s22, s21, 53248
  buffer_load_dwordx4 a[208:211], v2, s[8:11], s22 offen offset:0 sc1
  buffer_load_dwordx4 a[212:215], v2, s[8:11], s22 offen offset:1024 sc1
  buffer_load_dwordx4 a[216:219], v2, s[8:11], s22 offen offset:2048 sc1
  buffer_load_dwordx4 a[220:223], v2, s[8:11], s22 offen offset:3072 sc1
  s_waitcnt vmcnt(40)
  s_mul_i32 s23, s17, 401408
  s_and_b32 s22, s16, 1
  s_mul_i32 s22, s22, 7168
  s_add_u32 s23, s23, s22
  s_add_u32 s23, s23, 0
  s_lshr_b32 s22, s16, 1
  s_mul_i32 s22, s22, 14336
  s_add_u32 s23, s23, s22
  s_mul_i32 s27, s16, 7168
  s_lshr_b32 s28, s20, 1
  s_cmp_lt_u32 s17, 16
  s_cbranch_scc0 wg_vo
  s_add_u32 s23, s23, s22
  s_lshl_b32 s29, s28, 4
  s_add_u32 s29, s29, s17
  s_mul_i32 s29, s29, 28672
  s_add_u32 s29, s29, 12845056
  s_mov_b32 s31, 0
  s_lshr_b32 s24, s34, 1
  s_lshl_b32 s24, s24, 2
  s_and_b32 s25, s34, 1
  s_add_u32 s24, s24, s25
  s_mul_i32 s24, s24, 14336
  s_add_u32 s24, s24, s23
  s_add_u32 m0, s31, s27
  s_nop 0
  buffer_load_dwordx4 v2, s[8:11], s24 offen offset:0 sc1 lds
  buffer_load_dwordx4 v2, s[8:11], s24 offen offset:1024 sc1 lds
  buffer_load_dwordx4 v2, s[8:11], s24 offen offset:2048 sc1 lds
  buffer_load_dwordx4 v2, s[8:11], s24 offen offset:3072 sc1 lds
  s_add_u32 m0, m0, 4096
  s_add_u32 s24, s24, 4096
  buffer_load_dwordx4 v2, s[8:11], s24 offen offset:0 sc1 lds
  buffer_load_dwordx4 v2, s[8:11], s24 offen offset:1024 sc1 lds
  buffer_load_dwordx4 v2, s[8:11], s24 offen offset:2048 sc1 lds
  s_sub_u32 s36, s35, 1
  s_add_u32 s30, s34, 1
  s_min_u32 s30, s30, s36
  s_mov_b32 s31, 28672
  s_lshr_b32 s24, s30, 1
  s_lshl_b32 s24, s24, 2
  s_and_b32 s25, s30, 1
  s_add_u32 s24, s24, s25
  s_mul_i32 s24, s24, 14336
  s_add_u32 s24, s24, s23
  s_add_u32 m0, s31, s27
  s_nop 0
  buffer_load_dwordx4 v2, s[8:11], s24 offen offset:0 sc1 lds
  buffer_load_dwordx4 v2, s[8:11], s24 offen offset:1024 sc1 lds
  buffer_load_dwordx4 v2, s[8:11], s24 offen offset:2048 sc1 lds
  buffer_load_dwordx4 v2, s[8:11], s24 offen offset:3072 sc1 lds
  s_add_u32 m0, m0, 4096
  s_add_u32 s24, s24, 4096
  buffer_load_dwordx4 v2, s[8:11], s24 offen offset:0 sc1 lds
  buffer_load_dwordx4 v2, s[8:11], s24 offen offset:1024 sc1 lds
  buffer_load_dwordx4 v2, s[8:11], s24 offen offset:2048 sc1 lds
  s_mov_b32 s19, s34
  s_mov_b32 s32, 0
  s_mov_b32 s33, 57344
  s_waitcnt vmcnt(7)
  s_branch wg_f_in
wg_f_loop:
  s_waitcnt vmcnt(11)
wg_f_in:
  s_barrier
  s_add_u32 s30, s19, 2
  s_min_u32 s30, s30, s36
  s_lshr_b32 s24, s30, 1
  s_lshl_b32 s24, s24, 2
  s_and_b32 s25, s30, 1
  s_add_u32 s24, s24, s25
  s_mul_i32 s24, s24, 14336
  s_add_u32 s24, s24, s23
  s_add_u32 m0, s33, s27
  s_nop 0
  buffer_load_dwordx4 v2, s[8:11], s24 offen offset:0 sc1 lds
  buffer_load_dwordx4 v2, s[8:11], s24 offen offset:1024 sc1 lds
  buffer_load_dwordx4 v2, s[8:11], s24 offen offset:2048 sc1 lds
  buffer_load_dwordx4 v2, s[8:11], s24 offen offset:3072 sc1 lds
  s_add_u32 m0, m0, 4096
  s_add_u32 s24, s24, 4096
  buffer_load_dwordx4 v2, s[8:11], s24 offen offset:0 sc1 lds
  buffer_load_dwordx4 v2, s[8:11], s24 offen offset:1024 sc1 lds
  buffer_load_dwordx4 v2, s[8:11], s24 offen offset:2048 sc1 lds
  v_add_u32 v5, s32, v2
  ds_read_b128 v[8:11], v5 offset:0
  ds_read_b128 v[12:15], v5 offset:14336
  ds_read_b128 v[16:19], v5 offset:1024
  ds_read_b128 v[20:23], v5 offset:15360
  ds_read_b128 v[24:27], v5 offset:2048
  ds_read_b128 v[28:31], v5 offset:16384
  ds_read_b128 v[32:35], v5 offset:3072
  s_waitcnt lgkmcnt(6)
  v_mfma_f32_16x16x32_bf16 v[40:43], v[8:11], a[0:3], 0
  v_mfma_f32_16x16x32_bf16 v[44:47], v[8:11], a[56:59], 0
  v_mfma_f32_16x16x32_bf16 v[48:51], v[8:11], a[112:115], 0
  v_mfma_f32_16x16x32_bf16 v[52:55], v[8:11], a[168:171], 0
  ds_read_b128 v[36:39], v5 offset:17408
  s_waitcnt lgkmcnt(6)
  v_mfma_f32_16x16x32_bf16 v[56:59], v[12:15], a[0:3], 0
  v_mfma_f32_16x16x32_bf16 v[60:63], v[12:15], a[56:59], 0
  v_mfma_f32_16x16x32_bf16 v[64:67], v[12:15], a[112:115], 0
  v_mfma_f32_16x16x32_bf16 v[68:71], v[12:15], a[168:171], 0
  ds_read_b128 v[8:11], v5 offset:4096
  s_waitcnt lgkmcnt(6)
  v_mfma_f32_16x16x32_bf16 v[40:43], v[16:19], a[4:7], v[40:43]
  v_mfma_f32_16x16x32_bf16 v[44:47], v[16:19], a[60:63], v[44:47]
  v_mfma_f32_16x16x32_bf16 v[48:51], v[16:19], a[116:119], v[48:51]
  v_mfma_f32_16x16x32_bf16 v[52:55], v[16:19], a[172:175], v[52:55]
  ds_read_b128 v[12:15], v5 offset:18432
  s_waitcnt lgkmcnt(6)
  v_mfma_f32_16x16x32_bf16 v[56:59], v[20:23], a[4:7], v[56:59]
  v_mfma_f32_16x16x32_bf16 v[60:63], v[20:23], a[60:63], v[60:63]
  v_mfma_f32_16x16x32_bf16 v[64:67], v[20:23], a[116:119], v[64:67]
  v_mfma_f32_16x16x32_bf16 v[68:71], v[20:23], a[172:175], v[68:71]
  ds_read_b128 v[16:19], v5 offset:5120
  s_waitcnt lgkmcnt(6)
  v_mfma_f32_16x16x32_bf16 v[40:43], v[24:27], a[8:11], v[40:43]
  v_mfma_f32_16x16x32_bf16 v[44:47], v[24:27], a[64:67], v[44:47]
  v_mfma_f32_16x16x32_bf16 v[48:51], v[24:27], a[120:123], v[48:51]
  v_mfma_f32_16x16x32_bf16 v[52:55], v[24:27], a[176:179], v[52:55]
  ds_read_b128 v[20:23], v5 offset:19456
  s_waitcnt lgkmcnt(6)
  v_mfma_f32_16x16x32_bf16 v[56:59], v[28:31], a[8:11], v[56:59]
  v_mfma_f32_16x16x32_bf16 v[60:63], v[28:31], a[64:67], v[60:63]
  v_mfma_f32_16x16x32_bf16 v[64:67], v[28:31], a[120:123], v[64:67]
  v_mfma_f32_16x16x32_bf16 v[68:71], v[28:31], a[176:179], v[68:71]
  ds_read_b128 v[24:27], v5 offset:6144
  s_waitcnt lgkmcnt(6)
  v_mfma_f32_16x16x32_bf16 v[40:43], v[32:35], a[12:15], v[40:43]
  v_mfma_f32_16x16x32_bf16 v[44:47], v[32:35], a[68:71], v[44:47]
  v_mfma_f32_16x16x32_bf16 v[48:51], v[32:35], a[124:127], v[48:51]
  v_mfma_f32_16x16x32_bf16 v[52:55], v[32:35], a[180:183], v[52:55]
  ds_read_b128 v[28:31], v5 offset:20480
  s_waitcnt lgkmcnt(6)
  v_mfma_f32_16x16x32_bf16 v[56:59], v[36:39], a[12:15], v[56:59]
  v_mfma_f32_16x16x32_bf16 v[60:63], v[36:39], a[68:71], v[60:63]
  v_mfma_f32_16x16x32_bf16 v[64:67], v[36:39], a[124:127], v[64:67]
  v_mfma_f32_16x16x32_bf16 v[68:71], v[36:39], a[180:183], v[68:71]
  ds_read_b128 v[32:35], v5 offset:7168
  s_waitcnt lgkmcnt(6)
  v_mfma_f32_16x16x32_bf16 v[40:43], v[8:11], a[16:19], v[40:43]
  v_mfma_f32_16x16x32_bf16 v[44:47], v[8:11], a[72:75], v[44:47]
  v_mfma_f32_16x16x32_bf16 v[48:51], v[8:11], a[128:131], v[48:51]
  v_mfma_f32_16x16x32_bf16 v[52:55], v[8:11], a[184:187], v[52:55]
  ds_read_b128 v[36:39], v5 offset:21504
  s_waitcnt lgkmcnt(6)
  v_mfma_f32_16x16x32_bf16 v[56:59], v[12:15], a[16:19], v[56:59]
  v_mfma_f32_16x16x32_bf16 v[60:63], v[12:15], a[72:75], v[60:63]
  v_mfma_f32_16x16x32_bf16 v[64:67], v[12:15], a[128:131], v[64:67]
  v_mfma_f32_16x16x32_bf16 v[68:71], v[12:15], a[184:187], v[68:71]
  ds_read_b128 v[8:11], v5 offset:8192
  s_waitcnt lgkmcnt(6)
  v_mfma_f32_16x16x32_bf16 v[40:43], v[16:19], a[20:23], v[40:43]
  v_mfma_f32_16x16x32_bf16 v[44:47], v[16:19], a[76:79], v[44:47]
  v_mfma_f32_16x16x32_bf16 v[48:51], v[16:19], a[132:135], v[48:51]
  v_mfma_f32_16x16x32_bf16 v[52:55], v[16:19], a[188:191], v[52:55]
  ds_read_b128 v[12:15], v5 offset:22528
  s_waitcnt lgkmcnt(6)
  v_mfma_f32_16x16x32_bf16 v[56:59], v[20:23], a[20:23], v[56:59]
  v_mfma_f32_16x16x32_bf16 v[60:63], v[20:23], a[76:79], v[60:63]
  v_mfma_f32_16x16x32_bf16 v[64:67], v[20:23], a[132:135], v[64:67]
  v_mfma_f32_16x16x32_bf16 v[68:71], v[20:23], a[188:191], v[68:71]
  ds_read_b128 v[16:19], v5 offset:9216
  s_waitcnt lgkmcnt(6)
  v_mfma_f32_16x16x32_bf16 v[40:43], v[24:27], a[24:27], v[40:43]
  v_mfma_f32_16x16x32_bf16 v[44:47], v[24:27], a[80:83], v[44:47]
  v_mfma_f32_16x16x32_bf16 v[48:51], v[24:27], a[136:139], v[48:51]
  v_mfma_f32_16x16x32_bf16 v[52:55], v[24:27], a[192:195], v[52:55]
  ds_read_b128 v[20:23], v5 offset:23552
  s_waitcnt lgkmcnt(6)
  v_mfma_f32_16x16x32_bf16 v[56:59], v[28:31], a[24:27], v[56:59]
  v_mfma_f32_16x16x32_bf16 v[60:63], v[28:31], a[80:83], v[60:63]
  v_mfma_f32_16x16x32_bf16 v[64:67], v[28:31], a[136:139], v[64:67]
  v_mfma_f32_16x16x32_bf16 v[68:71], v[28:31], a[192:195], v[68:71]
  ds_read_b128 v[24:27], v5 offset:10240
  s_waitcnt lgkmcnt(6)
  v_mfma_f32_16x16x32_bf16 v[40:43], v[32:35], a[28:31], v[40:43]
  v_mfma_f32_16x16x32_bf16 v[44:47], v[32:35], a[84:87], v[44:47]
  v_mfma_f32_16x16x32_bf16 v[48:51], v[32:35], a[140:143], v[48:51]
  v_mfma_f32_16x16x32_bf16 v[52:55], v[32:35], a[196:199], v[52:55]
  ds_read_b128 v[28:31], v5 offset:24576
  s_waitcnt lgkmcnt(6)
  v_mfma_f32_16x16x32_bf16 v[56:59], v[36:39], a[28:31], v[56:59]
  v_mfma_f32_16x16x32_bf16 v[60:63], v[36:39], a[84:87], v[60:63]
  v_mfma_f32_16x16x32_bf16 v[64:67], v[36:39], a[140:143], v[64:67]
  v_mfma_f32_16x16x32_bf16 v[68:71], v[36:39], a[196:199], v[68:71]
  ds_read_b128 v[32:35], v5 offset:11264
  s_waitcnt lgkmcnt(6)
  v_mfma_f32_16x16x32_bf16 v[40:43], v[8:11], a[32:35], v[40:43]
  v_mfma_f32_16x16x32_bf16 v[44:47], v[8:11], a[88:91], v[44:47]
  v_mfma_f32_16x16x32_bf16 v[48:51], v[8:11], a[144:147], v[48:51]
  v_mfma_f32_16x16x32_bf16 v[52:55], v[8:11], a[200:203], v[52:55]
  ds_read_b128 v[36:39], v5 offset:25600
  s_waitcnt lgkmcnt(6)
  v_mfma_f32_16x16x32_bf16 v[56:59], v[12:15], a[32:35], v[56:59]
  v_mfma_f32_16x16x32_bf16 v[60:63], v[12:15], a[88:91], v[60:63]
  v_mfma_f32_16x16x32_bf16 v[64:67], v[12:15], a[144:147], v[64:67]
  v_mfma_f32_16x16x32_bf16 v[68:71], v[12:15], a[200:203], v[68:71]
  ds_read_b128 v[8:11], v5 offset:12288
  s_waitcnt lgkmcnt(6)
  v_mfma_f32_16x16x32_bf16 v[40:43], v[16:19], a[36:39], v[40:43]
  v_mfma_f32_16x16x32_bf16 v[44:47], v[16:19], a[92:95], v[44:47]
  v_mfma_f32_16x16x32_bf16 v[48:51], v[16:19], a[148:151], v[48:51]
  v_mfma_f32_16x16x32_bf16 v[52:55], v[16:19], a[204:207], v[52:55]
  ds_read_b128 v[12:15], v5 offset:26624
  s_waitcnt lgkmcnt(6)
  v_mfma_f32_16x16x32_bf16 v[56:59], v[20:23], a[36:39], v[56:59]
  v_mfma_f32_16x16x32_bf16 v[60:63], v[20:23], a[92:95], v[60:63]
  v_mfma_f32_16x16x32_bf16 v[64:67], v[20:23], a[148:151], v[64:67]
  v_mfma_f32_16x16x32_bf16 v[68:71], v[20:23], a[204:207], v[68:71]
  ds_read_b128 v[16:19], v5 offset:13312
  s_waitcnt lgkmcnt(6)
  v_mfma_f32_16x16x32_bf16 v[40:43], v[24:27], a[40:43], v[40:43]
  v_mfma_f32_16x16x32_bf16 v[44:47], v[24:27], a[96:99], v[44:47]
  v_mfma_f32_16x16x32_bf16 v[48:51], v[24:27], a[152:155], v[48:51]
  v_mfma_f32_16x16x32_bf16 v[52:55], v[24:27], a[208:211], v[52:55]
  ds_read_b128 v[20:23], v5 offset:27648
  s_waitcnt lgkmcnt(6)
  v_mfma_f32_16x16x32_bf16 v[56:59], v[28:31], a[40:43], v[56:59]
  v_mfma_f32_16x16x32_bf16 v[60:63], v[28:31], a[96:99], v[60:63]
  v_mfma_f32_16x16x32_bf16 v[64:67], v[28:31], a[152:155], v[64:67]
  v_mfma_f32_16x16x32_bf16 v[68:71], v[28:31], a[208:211], v[68:71]
  s_waitcnt lgkmcnt(5)
  v_mfma_f32_16x16x32_bf16 v[40:43], v[32:35], a[44:47], v[40:43]
  v_mfma_f32_16x16x32_bf16 v[44:47], v[32:35], a[100:103], v[44:47]
  v_mfma_f32_16x16x32_bf16 v[48:51], v[32:35], a[156:159], v[48:51]
  v_mfma_f32_16x16x32_bf16 v[52:55], v[32:35], a[212:215], v[52:55]
  s_waitcnt lgkmcnt(4)
  v_mfma_f32_16x16x32_bf16 v[56:59], v[36:39], a[44:47], v[56:59]
  v_mfma_f32_16x16x32_bf16 v[60:63], v[36:39], a[100:103], v[60:63]
  v_mfma_f32_16x16x32_bf16 v[64:67], v[36:39], a[156:159], v[64:67]
  v_mfma_f32_16x16x32_bf16 v[68:71], v[36:39], a[212:215], v[68:71]
  s_waitcnt lgkmcnt(3)
  v_mfma_f32_16x16x32_bf16 v[40:43], v[8:11], a[48:51], v[40:43]
  v_mfma_f32_16x16x32_bf16 v[44:47], v[8:11], a[104:107], v[44:47]
  v_mfma_f32_16x16x32_bf16 v[48:51], v[8:11], a[160:163], v[48:51]
  v_mfma_f32_16x16x32_bf16 v[52:55], v[8:11], a[216:219], v[52:55]
  s_waitcnt lgkmcnt(2)
  v_mfma_f32_16x16x32_bf16 v[56:59], v[12:15], a[48:51], v[56:59]
  v_mfma_f32_16x16x32_bf16 v[60:63], v[12:15], a[104:107], v[60:63]
  v_mfma_f32_16x16x32_bf16 v[64:67], v[12:15], a[160:163], v[64:67]
  v_mfma_f32_16x16x32_bf16 v[68:71], v[12:15], a[216:219], v[68:71]
  s_waitcnt lgkmcnt(1)
  v_mfma_f32_16x16x32_bf16 v[40:43], v[16:19], a[52:55], v[40:43]
  v_mfma_f32_16x16x32_bf16 v[44:47], v[16:19], a[108:111], v[44:47]
  v_mfma_f32_16x16x32_bf16 v[48:51], v[16:19], a[164:167], v[48:51]
  v_mfma_f32_16x16x32_bf16 v[52:55], v[16:19], a[220:223], v[52:55]
  s_waitcnt lgkmcnt(0)
  v_mfma_f32_16x16x32_bf16 v[56:59], v[20:23], a[52:55], v[56:59]
  v_mfma_f32_16x16x32_bf16 v[60:63], v[20:23], a[108:111], v[60:63]
  v_mfma_f32_16x16x32_bf16 v[64:67], v[20:23], a[164:167], v[64:67]
  v_mfma_f32_16x16x32_bf16 v[68:71], v[20:23], a[220:223], v[68:71]
  s_lshl_b32 s24, s19, 10
  s_add_u32 s24, s24, s29
  v_cvt_pk_bf16_f32 v72, v40, v41
  v_cvt_pk_bf16_f32 v73, v42, v43
  v_cvt_pk_bf16_f32 v74, v56, v57
  v_cvt_pk_bf16_f32 v75, v58, v59
  s_add_u32 s25, s24, 0
  buffer_store_dwordx4 v[72:75], v2, s[8:11], s25 offen sc1
  v_cvt_pk_bf16_f32 v76, v44, v45
  v_cvt_pk_bf16_f32 v77, v46, v47
  v_cvt_pk_bf16_f32 v78, v60, v61
  v_cvt_pk_bf16_f32 v79, v62, v63
  s_add_u32 s25, s24, 14336
  buffer_store_dwordx4 v[76:79], v2, s[8:11], s25 offen sc1
  v_cvt_pk_bf16_f32 v80, v48, v49
  v_cvt_pk_bf16_f32 v81, v50, v51
  v_cvt_pk_bf16_f32 v82, v64, v65
  v_cvt_pk_bf16_f32 v83, v66, v67
  s_add_u32 s25, s24, 458752
  buffer_store_dwordx4 v[80:83], v2, s[8:11], s25 offen sc1
  v_cvt_pk_bf16_f32 v84, v52, v53
  v_cvt_pk_bf16_f32 v85, v54, v55
  v_cvt_pk_bf16_f32 v86, v68, v69
  v_cvt_pk_bf16_f32 v87, v70, v71
  s_add_u32 s25, s24, 473088
  buffer_store_dwordx4 v[84:87], v2, s[8:11], s25 offen sc1
  s_mov_b32 s33, s32
  s_add_u32 s32, s32, 28672
  s_cmp_eq_u32 s32, 86016
  s_cselect_b32 s32, 0, s32
  s_add_u32 s19, s19, 1
  s_cmp_lt_u32 s19, s35
  s_cbranch_scc1 wg_f_loop
  s_branch wg_done
wg_vo:
  s_sub_u32 s29, s17, 16
  s_lshl_b32 s29, s29, 6
  s_add_u32 s29, s29, s28
  s_mul_i32 s29, s29, 28672
  s_add_u32 s29, s29, 42205184
  v_lshlrev_b32 v6, 4, v3
  v_mul_u32_u24 v7, 12, v3
  v_add_u32 v7, 48, v7
  s_mov_b32 s31, 0
  s_lshl_b32 s24, s34, 1
  s_mul_i32 s24, s24, 14336
  s_add_u32 s24, s24, s23
  s_add_u32 m0, s31, s27
  s_nop 0
  buffer_load_dwordx4 v2, s[8:11], s24 offen offset:0 sc1 lds
  buffer_load_dwordx4 v2, s[8:11], s24 offen offset:1024 sc1 lds
  buffer_load_dwordx4 v2, s[8:11], s24 offen offset:2048 sc1 lds
  buffer_load_dwordx4 v2, s[8:11], s24 offen offset:3072 sc1 lds
  s_add_u32 m0, m0, 4096
  s_add_u32 s24, s24, 4096
  buffer_load_dwordx4 v2, s[8:11], s24 offen offset:0 sc1 lds
  buffer_load_dwordx4 v2, s[8:11], s24 offen offset:1024 sc1 lds
  buffer_load_dwordx4 v2, s[8:11], s24 offen offset:2048 sc1 lds
  s_sub_u32 s36, s35, 1
  s_add_u32 s30, s34, 1
  s_min_u32 s30, s30, s36
  s_mov_b32 s31, 28672
  s_lshl_b32 s24, s30, 1
  s_mul_i32 s24, s24, 14336
  s_add_u32 s24, s24, s23
  s_add_u32 m0, s31, s27
  s_nop 0
  buffer_load_dwordx4 v2, s[8:11], s24 offen offset:0 sc1 lds
  buffer_load_dwordx4 v2, s[8:11], s24 offen offset:1024 sc1 lds
  buffer_load_dwordx4 v2, s[8:11], s24 offen offset:2048 sc1 lds
  buffer_load_dwordx4 v2, s[8:11], s24 offen offset:3072 sc1 lds
  s_add_u32 m0, m0, 4096
  s_add_u32 s24, s24, 4096
  buffer_load_dwordx4 v2, s[8:11], s24 offen offset:0 sc1 lds
  buffer_load_dwordx4 v2, s[8:11], s24 offen offset:1024 sc1 lds
  buffer_load_dwordx4 v2, s[8:11], s24 offen offset:2048 sc1 lds
  s_mov_b32 s19, s34
  s_mov_b32 s32, 0
  s_mov_b32 s33, 57344
  s_waitcnt vmcnt(7)
  s_branch wg_vo_in
wg_vo_loop:
  s_waitcnt vmcnt(11)
wg_vo_in:
  s_barrier
  s_add_u32 s30, s19, 2
  s_min_u32 s30, s30, s36
  s_lshl_b32 s24, s30, 1
  s_mul_i32 s24, s24, 14336
  s_add_u32 s24, s24, s23
  s_add_u32 m0, s33, s27
  s_nop 0
  buffer_load_dwordx4 v2, s[8:11], s24 offen offset:0 sc1 lds
  buffer_load_dwordx4 v2, s[8:11], s24 offen offset:1024 sc1 lds
  buffer_load_dwordx4 v2, s[8:11], s24 offen offset:2048 sc1 lds
  buffer_load_dwordx4 v2, s[8:11], s24 offen offset:3072 sc1 lds
  s_add_u32 m0, m0, 4096
  s_add_u32 s24, s24, 4096
  buffer_load_dwordx4 v2, s[8:11], s24 offen offset:0 sc1 lds
  buffer_load_dwordx4 v2, s[8:11], s24 offen offset:1024 sc1 lds
  buffer_load_dwordx4 v2, s[8:11], s24 offen offset:2048 sc1 lds
  v_add_u32 v5, s32, v2
  ds_read_b128 v[8:11], v5 offset:0
  ds_read_b128 v[12:15], v5 offset:14336
  ds_read_b128 v[16:19], v5 offset:1024
  ds_read_b128 v[20:23], v5 offset:15360
  ds_read_b128 v[24:27], v5 offset:2048
  ds_read_b128 v[28:31], v5 offset:16384
  ds_read_b128 v[32:35], v5 offset:3072
  s_waitcnt lgkmcnt(6)
  v_mfma_f32_16x16x32_bf16 v[40:43], a[0:3], v[8:11], 0
  v_mfma_f32_16x16x32_bf16 v[44:47], a[56:59], v[8:11], 0
  v_mfma_f32_16x16x32_bf16 v[48:51], a[112:115], v[8:11], 0
  v_mfma_f32_16x16x32_bf16 v[52:55], a[168:171], v[8:11], 0
  ds_read_b128 v[36:39], v5 offset:17408
  s_waitcnt lgkmcnt(6)
  v_mfma_f32_16x16x32_bf16 v[56:59], a[0:3], v[12:15], 0
  v_mfma_f32_16x16x32_bf16 v[60:63], a[56:59], v[12:15], 0
  v_mfma_f32_16x16x32_bf16 v[64:67], a[112:115], v[12:15], 0
  v_mfma_f32_16x16x32_bf16 v[68:71], a[168:171], v[12:15], 0
  ds_read_b128 v[8:11], v5 offset:4096
  s_waitcnt lgkmcnt(6)
  v_mfma_f32_16x16x32_bf16 v[40:43], a[4:7], v[16:19], v[40:43]
  v_mfma_f32_16x16x32_bf16 v[44:47], a[60:63], v[16:19], v[44:47]
  v_mfma_f32_16x16x32_bf16 v[48:51], a[116:119], v[16:19], v[48:51]
  v_mfma_f32_16x16x32_bf16 v[52:55], a[172:175], v[16:19], v[52:55]
  ds_read_b128 v[12:15], v5 offset:18432
  s_waitcnt lgkmcnt(6)
  v_mfma_f32_16x16x32_bf16 v[56:59], a[4:7], v[20:23], v[56:59]
  v_mfma_f32_16x16x32_bf16 v[60:63], a[60:63], v[20:23], v[60:63]
  v_mfma_f32_16x16x32_bf16 v[64:67], a[116:119], v[20:23], v[64:67]
  v_mfma_f32_16x16x32_bf16 v[68:71], a[172:175], v[20:23], v[68:71]
  ds_read_b128 v[16:19], v5 offset:5120
  s_waitcnt lgkmcnt(6)
  v_mfma_f32_16x16x32_bf16 v[40:43], a[8:11], v[24:27], v[40:43]
  v_mfma_f32_16x16x32_bf16 v[44:47], a[64:67], v[24:27], v[44:47]
  v_mfma_f32_16x16x32_bf16 v[48:51], a[120:123], v[24:27], v[48:51]
  v_mfma_f32_16x16x32_bf16 v[52:55], a[176:179], v[24:27], v[52:55]
  ds_read_b128 v[20:23], v5 offset:19456
  s_waitcnt lgkmcnt(6)
  v_mfma_f32_16x16x32_bf16 v[56:59], a[8:11], v[28:31], v[56:59]
  v_mfma_f32_16x16x32_bf16 v[60:63], a[64:67], v[28:31], v[60:63]
  v_mfma_f32_16x16x32_bf16 v[64:67], a[120:123], v[28:31], v[64:67]
  v_mfma_f32_16x16x32_bf16 v[68:71], a[176:179], v[28:31], v[68:71]
  ds_read_b128 v[24:27], v5 offset:6144
  s_waitcnt lgkmcnt(6)
  v_mfma_f32_16x16x32_bf16 v[40:43], a[12:15], v[32:35], v[40:43]
  v_mfma_f32_16x16x32_bf16 v[44:47], a[68:71], v[32:35], v[44:47]
  v_mfma_f32_16x16x32_bf16 v[48:51], a[124:127], v[32:35], v[48:51]
  v_mfma_f32_16x16x32_bf16 v[52:55], a[180:183], v[32:35], v[52:55]
  ds_read_b128 v[28:31], v5 offset:20480
  s_waitcnt lgkmcnt(6)
  v_mfma_f32_16x16x32_bf16 v[56:59], a[12:15], v[36:39], v[56:59]
  v_mfma_f32_16x16x32_bf16 v[60:63], a[68:71], v[36:39], v[60:63]
  v_mfma_f32_16x16x32_bf16 v[64:67], a[124:127], v[36:39], v[64:67]
  v_mfma_f32_16x16x32_bf16 v[68:71], a[180:183], v[36:39], v[68:71]
  ds_read_b128 v[32:35], v5 offset:7168
  s_waitcnt lgkmcnt(6)
  v_mfma_f32_16x16x32_bf16 v[40:43], a[16:19], v[8:11], v[40:43]
  v_mfma_f32_16x16x32_bf16 v[44:47], a[72:75], v[8:11], v[44:47]
  v_mfma_f32_16x16x32_bf16 v[48:51], a[128:131], v[8:11], v[48:51]
  v_mfma_f32_16x16x32_bf16 v[52:55], a[184:187], v[8:11], v[52:55]
  ds_read_b128 v[36:39], v5 offset:21504
  s_waitcnt lgkmcnt(6)
  v_mfma_f32_16x16x32_bf16 v[56:59], a[16:19], v[12:15], v[56:59]
  v_mfma_f32_16x16x32_bf16 v[60:63], a[72:75], v[12:15], v[60:63]
  v_mfma_f32_16x16x32_bf16 v[64:67], a[128:131], v[12:15], v[64:67]
  v_mfma_f32_16x16x32_bf16 v[68:71], a[184:187], v[12:15], v[68:71]
  ds_read_b128 v[8:11], v5 offset:8192
  s_waitcnt lgkmcnt(6)
  v_mfma_f32_16x16x32_bf16 v[40:43], a[20:23], v[16:19], v[40:43]
  v_mfma_f32_16x16x32_bf16 v[44:47], a[76:79], v[16:19], v[44:47]
  v_mfma_f32_16x16x32_bf16 v[48:51], a[132:135], v[16:19], v[48:51]
  v_mfma_f32_16x16x32_bf16 v[52:55], a[188:191], v[16:19], v[52:55]
  ds_read_b128 v[12:15], v5 offset:22528
  s_waitcnt lgkmcnt(6)
  v_mfma_f32_16x16x32_bf16 v[56:59], a[20:23], v[20:23], v[56:59]
  v_mfma_f32_16x16x32_bf16 v[60:63], a[76:79], v[20:23], v[60:63]
  v_mfma_f32_16x16x32_bf16 v[64:67], a[132:135], v[20:23], v[64:67]
  v_mfma_f32_16x16x32_bf16 v[68:71], a[188:191], v[20:23], v[68:71]
  ds_read_b128 v[16:19], v5 offset:9216
  s_waitcnt lgkmcnt(6)
  v_mfma_f32_16x16x32_bf16 v[40:43], a[24:27], v[24:27], v[40:43]
  v_mfma_f32_16x16x32_bf16 v[44:47], a[80:83], v[24:27], v[44:47]
  v_mfma_f32_16x16x32_bf16 v[48:51], a[136:139], v[24:27], v[48:51]
  v_mfma_f32_16x16x32_bf16 v[52:55], a[192:195], v[24:27], v[52:55]
  ds_read_b128 v[20:23], v5 offset:23552
  s_waitcnt lgkmcnt(6)
  v_mfma_f32_16x16x32_bf16 v[56:59], a[24:27], v[28:31], v[56:59]
  v_mfma_f32_16x16x32_bf16 v[60:63], a[80:83], v[28:31], v[60:63]
  v_mfma_f32_16x16x32_bf16 v[64:67], a[136:139], v[28:31], v[64:67]
  v_mfma_f32_16x16x32_bf16 v[68:71], a[192:195], v[28:31], v[68:71]
  ds_read_b128 v[24:27], v5 offset:10240
  s_waitcnt lgkmcnt(6)
  v_mfma_f32_16x16x32_bf16 v[40:43], a[28:31], v[32:35], v[40:43]
  v_mfma_f32_16x16x32_bf16 v[44:47], a[84:87], v[32:35], v[44:47]
  v_mfma_f32_16x16x32_bf16 v[48:51], a[140:143], v[32:35], v[48:51]
  v_mfma_f32_16x16x32_bf16 v[52:55], a[196:199], v[32:35], v[52:55]
  ds_read_b128 v[28:31], v5 offset:24576
  s_waitcnt lgkmcnt(6)
  v_mfma_f32_16x16x32_bf16 v[56:59], a[28:31], v[36:39], v[56:59]
  v_mfma_f32_16x16x32_bf16 v[60:63], a[84:87], v[36:39], v[60:63]
  v_mfma_f32_16x16x32_bf16 v[64:67], a[140:143], v[36:39], v[64:67]
  v_mfma_f32_16x16x32_bf16 v[68:71], a[196:199], v[36:39], v[68:71]
  ds_read_b128 v[32:35], v5 offset:11264
  s_waitcnt lgkmcnt(6)
  v_mfma_f32_16x16x32_bf16 v[40:43], a[32:35], v[8:11], v[40:43]
  v_mfma_f32_16x16x32_bf16 v[44:47], a[88:91], v[8:11], v[44:47]
  v_mfma_f32_16x16x32_bf16 v[48:51], a[144:147], v[8:11], v[48:51]
  v_mfma_f32_16x16x32_bf16 v[52:55], a[200:203], v[8:11], v[52:55]
  ds_read_b128 v[36:39], v5 offset:25600
  s_waitcnt lgkmcnt(6)
  v_mfma_f32_16x16x32_bf16 v[56:59], a[32:35], v[12:15], v[56:59]
  v_mfma_f32_16x16x32_bf16 v[60:63], a[88:91], v[12:15], v[60:63]
  v_mfma_f32_16x16x32_bf16 v[64:67], a[144:147], v[12:15], v[64:67]
  v_mfma_f32_16x16x32_bf16 v[68:71], a[200:203], v[12:15], v[68:71]
  ds_read_b128 v[8:11], v5 offset:12288
  s_waitcnt lgkmcnt(6)
  v_mfma_f32_16x16x32_bf16 v[40:43], a[36:39], v[16:19], v[40:43]
  v_mfma_f32_16x16x32_bf16 v[44:47], a[92:95], v[16:19], v[44:47]
  v_mfma_f32_16x16x32_bf16 v[48:51], a[148:151], v[16:19], v[48:51]
  v_mfma_f32_16x16x32_bf16 v[52:55], a[204:207], v[16:19], v[52:55]
  ds_read_b128 v[12:15], v5 offset:26624
  s_waitcnt lgkmcnt(6)
  v_mfma_f32_16x16x32_bf16 v[56:59], a[36:39], v[20:23], v[56:59]
  v_mfma_f32_16x16x32_bf16 v[60:63], a[92:95], v[20:23], v[60:63]
  v_mfma_f32_16x16x32_bf16 v[64:67], a[148:151], v[20:23], v[64:67]
  v_mfma_f32_16x16x32_bf16 v[68:71], a[204:207], v[20:23], v[68:71]
  ds_read_b128 v[16:19], v5 offset:13312
  s_waitcnt lgkmcnt(6)
  v_mfma_f32_16x16x32_bf16 v[40:43], a[40:43], v[24:27], v[40:43]
  v_mfma_f32_16x16x32_bf16 v[44:47], a[96:99], v[24:27], v[44:47]
  v_mfma_f32_16x16x32_bf16 v[48:51], a[152:155], v[24:27], v[48:51]
  v_mfma_f32_16x16x32_bf16 v[52:55], a[208:211], v[24:27], v[52:55]
  ds_read_b128 v[20:23], v5 offset:27648
  s_waitcnt lgkmcnt(6)
  v_mfma_f32_16x16x32_bf16 v[56:59], a[40:43], v[28:31], v[56:59]
  v_mfma_f32_16x16x32_bf16 v[60:63], a[96:99], v[28:31], v[60:63]
  v_mfma_f32_16x16x32_bf16 v[64:67], a[152:155], v[28:31], v[64:67]
  v_mfma_f32_16x16x32_bf16 v[68:71], a[208:211], v[28:31], v[68:71]
  s_waitcnt lgkmcnt(5)
  v_mfma_f32_16x16x32_bf16 v[40:43], a[44:47], v[32:35], v[40:43]
  v_mfma_f32_16x16x32_bf16 v[44:47], a[100:103], v[32:35], v[44:47]
  v_mfma_f32_16x16x32_bf16 v[48:51], a[156:159], v[32:35], v[48:51]
  v_mfma_f32_16x16x32_bf16 v[52:55], a[212:215], v[32:35], v[52:55]
  s_waitcnt lgkmcnt(4)
  v_mfma_f32_16x16x32_bf16 v[56:59], a[44:47], v[36:39], v[56:59]
  v_mfma_f32_16x16x32_bf16 v[60:63], a[100:103], v[36:39], v[60:63]
  v_mfma_f32_16x16x32_bf16 v[64:67], a[156:159], v[36:39], v[64:67]
  v_mfma_f32_16x16x32_bf16 v[68:71], a[212:215], v[36:39], v[68:71]
  s_waitcnt lgkmcnt(3)
  v_mfma_f32_16x16x32_bf16 v[40:43], a[48:51], v[8:11], v[40:43]
  v_mfma_f32_16x16x32_bf16 v[44:47], a[104:107], v[8:11], v[44:47]
  v_mfma_f32_16x16x32_bf16 v[48:51], a[160:163], v[8:11], v[48:51]
  v_mfma_f32_16x16x32_bf16 v[52:55], a[216:219], v[8:11], v[52:55]
  s_waitcnt lgkmcnt(2)
  v_mfma_f32_16x16x32_bf16 v[56:59], a[48:51], v[12:15], v[56:59]
  v_mfma_f32_16x16x32_bf16 v[60:63], a[104:107], v[12:15], v[60:63]
  v_mfma_f32_16x16x32_bf16 v[64:67], a[160:163], v[12:15], v[64:67]
  v_mfma_f32_16x16x32_bf16 v[68:71], a[216:219], v[12:15], v[68:71]
  s_waitcnt lgkmcnt(1)
  v_mfma_f32_16x16x32_bf16 v[40:43], a[52:55], v[16:19], v[40:43]
  v_mfma_f32_16x16x32_bf16 v[44:47], a[108:111], v[16:19], v[44:47]
  v_mfma_f32_16x16x32_bf16 v[48:51], a[164:167], v[16:19], v[48:51]
  v_mfma_f32_16x16x32_bf16 v[52:55], a[220:223], v[16:19], v[52:55]
  s_waitcnt lgkmcnt(0)
  v_mfma_f32_16x16x32_bf16 v[56:59], a[52:55], v[20:23], v[56:59]
  v_mfma_f32_16x16x32_bf16 v[60:63], a[108:111], v[20:23], v[60:63]
  v_mfma_f32_16x16x32_bf16 v[64:67], a[164:167], v[20:23], v[64:67]
  v_mfma_f32_16x16x32_bf16 v[68:71], a[220:223], v[20:23], v[68:71]
  s_add_u32 s25, s29, 28672
  s_lshl_b32 s24, s19, 5
  s_add_u32 s24, s24, 0
  v_add_u32 v88, s24, v4
  v_mul_u32_u24 v89, 2341, v88
  v_lshrrev_b32 v89, 16, v89
  v_mul_u32_u24 v92, 28, v89
  v_sub_u32 v92, v88, v92
  v_cmp_gt_u32 vcc, 16, v92
  v_mul_u32_u24 v89, 84, v89
  s_nop 0
  v_cndmask_b32 v92, v7, v6, vcc
  v_add3_u32 v88, v88, v89, v92
  v_lshlrev_b32 v90, 4, v88
  v_cvt_pk_bf16_f32 v72, v40, v44
  v_cvt_pk_bf16_f32 v73, v41, v45
  v_cvt_pk_bf16_f32 v74, v42, v46
  v_cvt_pk_bf16_f32 v75, v43, v47
  buffer_store_dwordx4 v[72:75], v90, s[8:11], s29 offen sc1
  v_cvt_pk_bf16_f32 v76, v48, v52
  v_cvt_pk_bf16_f32 v77, v49, v53
  v_cvt_pk_bf16_f32 v78, v50, v54
  v_cvt_pk_bf16_f32 v79, v51, v55
  buffer_store_dwordx4 v[76:79], v90, s[8:11], s25 offen sc1
  s_lshl_b32 s24, s19, 5
  s_add_u32 s24, s24, 16
  v_add_u32 v88, s24, v4
  v_mul_u32_u24 v89, 2341, v88
  v_lshrrev_b32 v89, 16, v89
  v_mul_u32_u24 v92, 28, v89
  v_sub_u32 v92, v88, v92
  v_cmp_gt_u32 vcc, 16, v92
  v_mul_u32_u24 v89, 84, v89
  s_nop 0
  v_cndmask_b32 v92, v7, v6, vcc
  v_add3_u32 v88, v88, v89, v92
  v_lshlrev_b32 v91, 4, v88
  v_cvt_pk_bf16_f32 v80, v56, v60
  v_cvt_pk_bf16_f32 v81, v57, v61
  v_cvt_pk_bf16_f32 v82, v58, v62
  v_cvt_pk_bf16_f32 v83, v59, v63
  buffer_store_dwordx4 v[80:83], v91, s[8:11], s29 offen sc1
  v_cvt_pk_bf16_f32 v84, v64, v68
  v_cvt_pk_bf16_f32 v85, v65, v69
  v_cvt_pk_bf16_f32 v86, v66, v70
  v_cvt_pk_bf16_f32 v87, v67, v71
  buffer_store_dwordx4 v[84:87], v91, s[8:11], s25 offen sc1
  s_mov_b32 s33, s32
  s_add_u32 s32, s32, 28672
  s_cmp_eq_u32 s32, 86016
  s_cselect_b32 s32, 0, s32
  s_add_u32 s19, s19, 1
  s_cmp_lt_u32 s19, s35
  s_cbranch_scc1 wg_vo_loop
  s_branch wg_done
wg_done:
  s_lshl_b32 s20, s18, 4
  s_and_b32 s21, s17, 15
  s_add_u32 s20, s20, s21
  s_lshl_b32 s20, s20, 7
  s_cmp_lt_u32 s17, 16
  s_cselect_b32 s21, 16384, 0
  s_add_u32 s20, s20, s21
  s_add_u32 s20, s20, 88002560
  s_sub_u32 s21, s35, s34
  s_lshl_b32 s21, s21, 2
  v_mov_b32 v5, s21
  v_mov_b32 v6, 0
  s_waitcnt vmcnt(0)
  s_barrier
  s_cmp_lg_u32 s16, 0
  s_cbranch_scc1 wg_sg
  s_mov_b64 exec, 1
  buffer_atomic_add v5, v6, s[8:11], s20 offen
  s_mov_b64 exec, -1
wg_sg:
  s_branch wk_loop
wk_srv:
  s_and_b32 s18, s3, 15
  s_lshr_b32 s19, s3, 4
  s_and_b32 s19, s19, 1
  s_mul_i32 s20, s18, 401408
  s_mul_i32 s21, s16, 100352
  s_add_u32 s20, s20, s21
  s_add_u32 s20, s20, 6422528
  s_add_u32 s22, s20, 0
  buffer_load_dwordx4 a[0:3], v2, s[8:11], s22 offen offset:0 sc1
  buffer_load_dwordx4 a[4:7], v2, s[8:11], s22 offen offset:1024 sc1
  buffer_load_dwordx4 a[8:11], v2, s[8:11], s22 offen offset:2048 sc1
  buffer_load_dwordx4 a[12:15], v2, s[8:11], s22 offen offset:3072 sc1
  s_add_u32 s22, s20, 4096
  buffer_load_dwordx4 a[16:19], v2, s[8:11], s22 offen offset:0 sc1
  buffer_load_dwordx4 a[20:23], v2, s[8:11], s22 offen offset:1024 sc1
  buffer_load_dwordx4 a[24:27], v2, s[8:11], s22 offen offset:2048 sc1
  buffer_load_dwordx4 a[28:31], v2, s[8:11], s22 offen offset:3072 sc1
  s_add_u32 s22, s20, 8192
  buffer_load_dwordx4 a[32:35], v2, s[8:11], s22 offen offset:0 sc1
  buffer_load_dwordx4 a[36:39], v2, s[8:11], s22 offen offset:1024 sc1
  buffer_load_dwordx4 a[40:43], v2, s[8:11], s22 offen offset:2048 sc1
  buffer_load_dwordx4 a[44:47], v2, s[8:11], s22 offen offset:3072 sc1
  s_add_u32 s22, s20, 12288
  buffer_load_dwordx4 a[48:51], v2, s[8:11], s22 offen offset:0 sc1
  buffer_load_dwordx4 a[52:55], v2, s[8:11], s22 offen offset:1024 sc1
  buffer_load_dwordx4 a[56:59], v2, s[8:11], s22 offen offset:2048 sc1
  buffer_load_dwordx4 a[60:63], v2, s[8:11], s22 offen offset:3072 sc1
  s_add_u32 s22, s20, 16384
  buffer_load_dwordx4 a[64:67], v2, s[8:11], s22 offen offset:0 sc1
  buffer_load_dwordx4 a[68:71], v2, s[8:11], s22 offen offset:1024 sc1
  buffer_load_dwordx4 a[72:75], v2, s[8:11], s22 offen offset:2048 sc1
  buffer_load_dwordx4 a[76:79], v2, s[8:11], s22 offen offset:3072 sc1
  s_add_u32 s22, s20, 20480
  buffer_load_dwordx4 a[80:83], v2, s[8:11], s22 offen offset:0 sc1
  buffer_load_dwordx4 a[84:87], v2, s[8:11], s22 offen offset:1024 sc1
  buffer_load_dwordx4 a[88:91], v2, s[8:11], s22 offen offset:2048 sc1
  buffer_load_dwordx4 a[92:95], v2, s[8:11], s22 offen offset:3072 sc1
  s_add_u32 s22, s20, 24576
  buffer_load_dwordx4 a[96:99], v2, s[8:11], s22 offen offset:0 sc1
  buffer_load_dwordx4 a[100:103], v2, s[8:11], s22 offen offset:1024 sc1
  buffer_load_dwordx4 a[104:107], v2, s[8:11], s22 offen offset:2048 sc1
  buffer_load_dwordx4 a[108:111], v2, s[8:11], s22 offen offset:3072 sc1
  s_add_u32 s22, s20, 28672
  buffer_load_dwordx4 a[112:115], v2, s[8:11], s22 offen offset:0 sc1
  buffer_load_dwordx4 a[116:119], v2, s[8:11], s22 offen offset:1024 sc1
  buffer_load_dwordx4 a[120:123], v2, s[8:11], s22 offen offset:2048 sc1
  buffer_load_dwordx4 a[124:127], v2, s[8:11], s22 offen offset:3072 sc1
  s_waitcnt vmcnt(24)
  s_add_u32 s22, s20, 32768
  buffer_load_dwordx4 a[128:131], v2, s[8:11], s22 offen offset:0 sc1
  buffer_load_dwordx4 a[132:135], v2, s[8:11], s22 offen offset:1024 sc1
  buffer_load_dwordx4 a[136:139], v2, s[8:11], s22 offen offset:2048 sc1
  buffer_load_dwordx4 a[140:143], v2, s[8:11], s22 offen offset:3072 sc1
  s_add_u32 s22, s20, 36864
  buffer_load_dwordx4 a[144:147], v2, s[8:11], s22 offen offset:0 sc1
  buffer_load_dwordx4 a[148:151], v2, s[8:11], s22 offen offset:1024 sc1
  buffer_load_dwordx4 a[152:155], v2, s[8:11], s22 offen offset:2048 sc1
  buffer_load_dwordx4 a[156:159], v2, s[8:11], s22 offen offset:3072 sc1
  s_add_u32 s22, s20, 40960
  buffer_load_dwordx4 a[160:163], v2, s[8:11], s22 offen offset:0 sc1
  buffer_load_dwordx4 a[164:167], v2, s[8:11], s22 offen offset:1024 sc1
  buffer_load_dwordx4 a[168:171], v2, s[8:11], s22 offen offset:2048 sc1
  buffer_load_dwordx4 a[172:175], v2, s[8:11], s22 offen offset:3072 sc1
  s_add_u32 s22, s20, 45056
  buffer_load_dwordx4 a[176:179], v2, s[8:11], s22 offen offset:0 sc1
  buffer_load_dwordx4 a[180:183], v2, s[8:11], s22 offen offset:1024 sc1
  buffer_load_dwordx4 a[184:187], v2, s[8:11], s22 offen offset:2048 sc1
  buffer_load_dwordx4 a[188:191], v2, s[8:11], s22 offen offset:3072 sc1
  s_add_u32 s22, s20, 49152
  buffer_load_dwordx4 a[192:195], v2, s[8:11], s22 offen offset:0 sc1
  buffer_load_dwordx4 a[196:199], v2, s[8:11], s22 offen offset:1024 sc1
  buffer_load_dwordx4 a[200:203], v2, s[8:11], s22 offen offset:2048 sc1
  buffer_load_dwordx4 a[204:207], v2, s[8:11], s22 offen offset:3072 sc1
  s_add_u32 s22, s20, 53248
  buffer_load_dwordx4 a[208:211], v2, s[8:11], s22 offen offset:0 sc1
  buffer_load_dwordx4 a[212:215], v2, s[8:11], s22 offen offset:1024 sc1
  buffer_load_dwordx4 a[216:219], v2, s[8:11], s22 offen offset:2048 sc1
  buffer_load_dwordx4 a[220:223], v2, s[8:11], s22 offen offset:3072 sc1
  s_add_u32 s22, s20, 57344
  buffer_load_dwordx4 a[224:227], v2, s[8:11], s22 offen offset:0 sc1
  buffer_load_dwordx4 a[228:231], v2, s[8:11], s22 offen offset:1024 sc1
  buffer_load_dwordx4 a[232:235], v2, s[8:11], s22 offen offset:2048 sc1
  buffer_load_dwordx4 a[236:239], v2, s[8:11], s22 offen offset:3072 sc1
  s_add_u32 s22, s20, 61440
  buffer_load_dwordx4 a[240:243], v2, s[8:11], s22 offen offset:0 sc1
  buffer_load_dwordx4 a[244:247], v2, s[8:11], s22 offen offset:1024 sc1
  buffer_load_dwordx4 a[248:251], v2, s[8:11], s22 offen offset:2048 sc1
  buffer_load_dwordx4 a[252:255], v2, s[8:11], s22 offen offset:3072 sc1
  s_waitcnt vmcnt(24)
  s_add_u32 s22, s20, 65536
  buffer_load_dwordx4 v[120:123], v2, s[8:11], s22 offen offset:0 sc1
  buffer_load_dwordx4 v[124:127], v2, s[8:11], s22 offen offset:1024 sc1
  buffer_load_dwordx4 v[128:131], v2, s[8:11], s22 offen offset:2048 sc1
  buffer_load_dwordx4 v[132:135], v2, s[8:11], s22 offen offset:3072 sc1
  s_add_u32 s22, s20, 69632
  buffer_load_dwordx4 v[136:139], v2, s[8:11], s22 offen offset:0 sc1
  buffer_load_dwordx4 v[140:143], v2, s[8:11], s22 offen offset:1024 sc1
  buffer_load_dwordx4 v[144:147], v2, s[8:11], s22 offen offset:2048 sc1
  buffer_load_dwordx4 v[148:151], v2, s[8:11], s22 offen offset:3072 sc1
  s_add_u32 s22, s20, 73728
  buffer_load_dwordx4 v[152:155], v2, s[8:11], s22 offen offset:0 sc1
  buffer_load_dwordx4 v[156:159], v2, s[8:11], s22 offen offset:1024 sc1
  buffer_load_dwordx4 v[160:163], v2, s[8:11], s22 offen offset:2048 sc1
  buffer_load_dwordx4 v[164:167], v2, s[8:11], s22 offen offset:3072 sc1
  s_add_u32 s22, s20, 77824
  buffer_load_dwordx4 v[168:171], v2, s[8:11], s22 offen offset:0 sc1
  buffer_load_dwordx4 v[172:175], v2, s[8:11], s22 offen offset:1024 sc1
  buffer_load_dwordx4 v[176:179], v2, s[8:11], s22 offen offset:2048 sc1
  buffer_load_dwordx4 v[180:183], v2, s[8:11], s22 offen offset:3072 sc1
  s_add_u32 s22, s20, 81920
  buffer_load_dwordx4 v[184:187], v2, s[8:11], s22 offen offset:0 sc1
  buffer_load_dwordx4 v[188:191], v2, s[8:11], s22 offen offset:1024 sc1
  buffer_load_dwordx4 v[192:195], v2, s[8:11], s22 offen offset:2048 sc1
  buffer_load_dwordx4 v[196:199], v2, s[8:11], s22 offen offset:3072 sc1
  s_add_u32 s22, s20, 86016
  buffer_load_dwordx4 v[200:203], v2, s[8:11], s22 offen offset:0 sc1
  buffer_load_dwordx4 v[204:207], v2, s[8:11], s22 offen offset:1024 sc1
  buffer_load_dwordx4 v[208:211], v2, s[8:11], s22 offen offset:2048 sc1
  buffer_load_dwordx4 v[212:215], v2, s[8:11], s22 offen offset:3072 sc1
  s_add_u32 s22, s20, 90112
  buffer_load_dwordx4 v[216:219], v2, s[8:11], s22 offen offset:0 sc1
  buffer_load_dwordx4 v[220:223], v2, s[8:11], s22 offen offset:1024 sc1
  buffer_load_dwordx4 v[224:227], v2, s[8:11], s22 offen offset:2048 sc1
  buffer_load_dwordx4 v[228:231], v2, s[8:11], s22 offen offset:3072 sc1
  s_add_u32 s22, s20, 94208
  buffer_load_dwordx4 v[232:235], v2, s[8:11], s22 offen offset:0 sc1
  buffer_load_dwordx4 v[236:239], v2, s[8:11], s22 offen offset:1024 sc1
  buffer_load_dwordx4 v[240:243], v2, s[8:11], s22 offen offset:2048 sc1
  buffer_load_dwordx4 v[244:247], v2, s[8:11], s22 offen offset:3072 sc1
  s_waitcnt vmcnt(24)
  s_add_u32 s22, s20, 98304
  buffer_load_dwordx4 v[248:251], v2, s[8:11], s22 offen offset:0 sc1
  buffer_load_dwordx4 v[252:255], v2, s[8:11], s22 offen offset:1024 sc1
  v_mov_b32 v5, 0x4444
  v_mov_b32 v6, 0xeeee
  v_cmp_lt_u32 vcc, 7, v4
  s_nop 1
  v_cndmask_b32 v5, v5, v6, vcc
  s_lshl_b32 s23, s16, 11
  v_lshrrev_b32 v80, 1, v3
  v_and_b32 v81, 1, v3
  v_add_u32 v82, 0, v80
  v_lshl_add_u32 v82, v82, 4, v4
  v_mul_u32_u24 v83, 2341, v82
  v_lshrrev_b32 v83, 16, v83
  v_mul_u32_u24 v84, 28, v83
  v_sub_u32 v84, v82, v84
  v_lshrrev_b32 v85, 4, v84
  v_and_b32 v84, 15, v84
  v_lshlrev_b32 v86, 10, v85
  v_lshl_add_u32 v86, v83, 8, v86
  v_lshl_add_u32 v86, v84, 4, v86
  v_lshl_add_u32 v86, v81, 3, v86
  v_add_u32 v72, s23, v86
  v_add_u32 v82, 2, v80
  v_lshl_add_u32 v82, v82, 4, v4
  v_mul_u32_u24 v83, 2341, v82
  v_lshrrev_b32 v83, 16, v83
  v_mul_u32_u24 v84, 28, v83
  v_sub_u32 v84, v82, v84
  v_lshrrev_b32 v85, 4, v84
  v_and_b32 v84, 15, v84
  v_lshlrev_b32 v86, 10, v85
  v_lshl_add_u32 v86, v83, 8, v86
  v_lshl_add_u32 v86, v84, 4, v86
  v_lshl_add_u32 v86, v81, 3, v86
  v_add_u32 v73, s23, v86
  v_add_u32 v82, 4, v80
  v_lshl_add_u32 v82, v82, 4, v4
  v_mul_u32_u24 v83, 2341, v82
  v_lshrrev_b32 v83, 16, v83
  v_mul_u32_u24 v84, 28, v83
  v_sub_u32 v84, v82, v84
  v_lshrrev_b32 v85, 4, v84
  v_and_b32 v84, 15, v84
  v_lshlrev_b32 v86, 10, v85
  v_lshl_add_u32 v86, v83, 8, v86
  v_lshl_add_u32 v86, v84, 4, v86
  v_lshl_add_u32 v86, v81, 3, v86
  v_add_u32 v74, s23, v86
  v_mov_b32 v82, 6
  v_lshl_add_u32 v82, v82, 4, v4
  v_mul_u32_u24 v83, 2341, v82
  v_lshrrev_b32 v83, 16, v83
  v_mul_u32_u24 v84, 28, v83
  v_sub_u32 v84, v82, v84
  v_lshrrev_b32 v85, 4, v84
  v_and_b32 v84, 15, v84
  v_lshlrev_b32 v86, 10, v85
  v_lshl_add_u32 v86, v83, 8, v86
  v_lshl_add_u32 v86, v84, 4, v86
  v_lshl_add_u32 v86, v81, 3, v86
  v_add_u32 v75, s23, v86
  v_add_u32 v76, s23, v2
  s_mul_i32 s27, s18, 448
  v_mov_b32 v77, s27
  v_mov_b32 v78, 1
  s_mov_b32 s17, s19
  s_mul_i32 s24, s19, 7168
  s_add_u32 s24, s24, 87543808
  s_mul_i32 s25, s18, 65
  s_add_u32 s25, s25, s19
  s_lshl_b32 s25, s25, 13
  s_add_u32 s25, s25, s23
  s_add_u32 s25, s25, 76410880
  s_lshl_b32 s26, s18, 6
  s_add_u32 s26, s26, s19
  s_lshl_b32 s26, s26, 4
  s_lshl_b32 s27, s16, 2
  s_add_u32 s26, s26, s27
  s_add_u32 s26, s26, 88043520
ws_loop:
  v_mov_b32 v36, 0
  v_mov_b32 v37, 0
  v_mov_b32 v38, 0
  v_mov_b32 v39, 0
  v_mov_b32 v40, 0
  v_mov_b32 v41, 0
  v_mov_b32 v42, 0
  v_mov_b32 v43, 0
  v_mov_b32 v44, 0
  v_mov_b32 v45, 0
  v_mov_b32 v46, 0
  v_mov_b32 v47, 0
  v_mov_b32 v48, 0
  v_mov_b32 v49, 0
  v_mov_b32 v50, 0
  v_mov_b32 v51, 0
  v_mov_b32 v52, 0
  v_mov_b32 v53, 0
  v_mov_b32 v54, 0
  v_mov_b32 v55, 0
  v_mov_b32 v56, 0
  v_mov_b32 v57, 0
  v_mov_b32 v58, 0
  v_mov_b32 v59, 0
  v_mov_b32 v60, 0
  v_mov_b32 v61, 0
  v_mov_b32 v62, 0
  v_mov_b32 v63, 0
  s_mov_b32 s30, 0
  s_branch ws_fl
ws_pm:
  buffer_load_dword v79, v77, s[8:11], s24 offen sc1
  s_waitcnt vmcnt(0)
  v_cmp_eq_u32 vcc, -1, v79
  s_cbranch_vccnz ws_pr
ws_fl:
  s_add_u32 s22, s24, 4096
  buffer_load_dwordx4 v[8:11], v2, s[8:11], s24 offen offset:0 sc1
  buffer_load_dwordx4 v[12:15], v2, s[8:11], s24 offen offset:1024 sc1
  buffer_load_dwordx4 v[16:19], v2, s[8:11], s24 offen offset:2048 sc1
  buffer_load_dwordx4 v[20:23], v2, s[8:11], s24 offen offset:3072 sc1
  buffer_load_dwordx4 v[24:27], v2, s[8:11], s22 offen offset:0 sc1
  buffer_load_dwordx4 v[28:31], v2, s[8:11], s22 offen offset:1024 sc1
  buffer_load_dwordx4 v[32:35], v2, s[8:11], s22 offen offset:2048 sc1
  s_waitcnt vmcnt(0)
  v_max_u32 v79, v8, v9
  v_max3_u32 v79, v79, v10, v11
  v_max3_u32 v79, v79, v12, v13
  v_max3_u32 v79, v79, v14, v15
  v_max3_u32 v79, v79, v16, v17
  v_max3_u32 v79, v79, v18, v19
  v_max3_u32 v79, v79, v20, v21
  v_max3_u32 v79, v79, v22, v23
  v_max3_u32 v79, v79, v24, v25
  v_max3_u32 v79, v79, v26, v27
  v_max3_u32 v79, v79, v28, v29
  v_max3_u32 v79, v79, v30, v31
  v_max3_u32 v79, v79, v32, v33
  v_max3_u32 v79, v79, v34, v35
  v_cmp_eq_u32 vcc, -1, v79
  s_cbranch_vccz ws_pk
ws_pr:
  s_sleep 6
  s_add_u32 s30, s30, 1
  s_cmp_lt_u32 s30, 2000000
  s_cbranch_scc1 ws_pm
  s_branch cA_abort
ws_pk:
  v_smfmac_f32_16x16x64_bf16 v[36:39], v[8:11], a[0:7], v5
  v_smfmac_f32_16x16x64_bf16 v[36:39], v[12:15], a[8:15], v5
  v_smfmac_f32_16x16x64_bf16 v[36:39], v[16:19], a[16:23], v5
  v_smfmac_f32_16x16x64_bf16 v[36:39], v[20:23], a[24:31], v5
  v_smfmac_f32_16x16x64_bf16 v[36:39], v[24:27], a[32:39], v5
  v_smfmac_f32_16x16x64_bf16 v[36:39], v[28:31], a[40:47], v5
  v_smfmac_f32_16x16x64_bf16 v[36:39], v[32:35], a[48:55], v5
  v_smfmac_f32_16x16x64_bf16 v[40:43], v[8:11], a[56:63], v5
  v_smfmac_f32_16x16x64_bf16 v[40:43], v[12:15], a[64:71], v5
  v_smfmac_f32_16x16x64_bf16 v[40:43], v[16:19], a[72:79], v5
  v_smfmac_f32_16x16x64_bf16 v[40:43], v[20:23], a[80:87], v5
  v_smfmac_f32_16x16x64_bf16 v[40:43], v[24:27], a[88:95], v5
  v_smfmac_f32_16x16x64_bf16 v[40:43], v[28:31], a[96:103], v5
  v_smfmac_f32_16x16x64_bf16 v[40:43], v[32:35], a[104:111], v5
  v_smfmac_f32_16x16x64_bf16 v[44:47], v[8:11], a[112:119], v5
  v_smfmac_f32_16x16x64_bf16 v[44:47], v[12:15], a[120:127], v5
  v_smfmac_f32_16x16x64_bf16 v[44:47], v[16:19], a[128:135], v5
  v_smfmac_f32_16x16x64_bf16 v[44:47], v[20:23], a[136:143], v5
  v_smfmac_f32_16x16x64_bf16 v[44:47], v[24:27], a[144:151], v5
  v_smfmac_f32_16x16x64_bf16 v[44:47], v[28:31], a[152:159], v5
  v_smfmac_f32_16x16x64_bf16 v[44:47], v[32:35], a[160:167], v5
  v_smfmac_f32_16x16x64_bf16 v[48:51], v[8:11], a[168:175], v5
  v_smfmac_f32_16x16x64_bf16 v[48:51], v[12:15], a[176:183], v5
  v_smfmac_f32_16x16x64_bf16 v[48:51], v[16:19], a[184:191], v5
  v_smfmac_f32_16x16x64_bf16 v[48:51], v[20:23], a[192:199], v5
  v_smfmac_f32_16x16x64_bf16 v[48:51], v[24:27], a[200:207], v5
  v_smfmac_f32_16x16x64_bf16 v[48:51], v[28:31], a[208:215], v5
  v_smfmac_f32_16x16x64_bf16 v[48:51], v[32:35], a[216:223], v5
  v_smfmac_f32_16x16x64_bf16 v[52:55], v[8:11], a[224:231], v5
  v_smfmac_f32_16x16x64_bf16 v[52:55], v[12:15], a[232:239], v5
  v_smfmac_f32_16x16x64_bf16 v[52:55], v[16:19], a[240:247], v5
  v_smfmac_f32_16x16x64_bf16 v[52:55], v[20:23], a[248:255], v5
  v_smfmac_f32_16x16x64_bf16 v[52:55], v[24:27], v[120:127], v5
  v_smfmac_f32_16x16x64_bf16 v[52:55], v[28:31], v[128:135], v5
  v_smfmac_f32_16x16x64_bf16 v[52:55], v[32:35], v[136:143], v5
  v_smfmac_f32_16x16x64_bf16 v[56:59], v[8:11], v[144:151], v5
  v_smfmac_f32_16x16x64_bf16 v[56:59], v[12:15], v[152:159], v5
  v_smfmac_f32_16x16x64_bf16 v[56:59], v[16:19], v[160:167], v5
  v_smfmac_f32_16x16x64_bf16 v[56:59], v[20:23], v[168:175], v5
  v_smfmac_f32_16x16x64_bf16 v[56:59], v[24:27], v[176:183], v5
  v_smfmac_f32_16x16x64_bf16 v[56:59], v[28:31], v[184:191], v5
  v_smfmac_f32_16x16x64_bf16 v[56:59], v[32:35], v[192:199], v5
  v_smfmac_f32_16x16x64_bf16 v[60:63], v[8:11], v[200:207], v5
  v_smfmac_f32_16x16x64_bf16 v[60:63], v[12:15], v[208:215], v5
  v_smfmac_f32_16x16x64_bf16 v[60:63], v[16:19], v[216:223], v5
  v_smfmac_f32_16x16x64_bf16 v[60:63], v[20:23], v[224:231], v5
  v_smfmac_f32_16x16x64_bf16 v[60:63], v[24:27], v[232:239], v5
  v_smfmac_f32_16x16x64_bf16 v[60:63], v[28:31], v[240:247], v5
  v_smfmac_f32_16x16x64_bf16 v[60:63], v[32:35], v[248:255], v5
  v_permlane32_swap_b32 v36, v40
  v_permlane32_swap_b32 v37, v41
  v_permlane32_swap_b32 v38, v42
  v_permlane32_swap_b32 v39, v43
  v_add_f32 v36, v36, v40
  v_add_f32 v37, v37, v41
  v_add_f32 v38, v38, v42
  v_add_f32 v39, v39, v43
  v_cvt_pk_bf16_f32 v40, v36, v37
  v_cvt_pk_bf16_f32 v41, v38, v39
  ds_write_b64 v72, v[40:41]
  v_permlane32_swap_b32 v44, v48
  v_permlane32_swap_b32 v45, v49
  v_permlane32_swap_b32 v46, v50
  v_permlane32_swap_b32 v47, v51
  v_add_f32 v44, v44, v48
  v_add_f32 v45, v45, v49
  v_add_f32 v46, v46, v50
  v_add_f32 v47, v47, v51
  v_cvt_pk_bf16_f32 v48, v44, v45
  v_cvt_pk_bf16_f32 v49, v46, v47
  ds_write_b64 v73, v[48:49]
  v_permlane32_swap_b32 v52, v56
  v_permlane32_swap_b32 v53, v57
  v_permlane32_swap_b32 v54, v58
  v_permlane32_swap_b32 v55, v59
  v_add_f32 v52, v52, v56
  v_add_f32 v53, v53, v57
  v_add_f32 v54, v54, v58
  v_add_f32 v55, v55, v59
  v_cvt_pk_bf16_f32 v56, v52, v53
  v_cvt_pk_bf16_f32 v57, v54, v55
  ds_write_b64 v74, v[56:57]
  v_mov_b32 v64, v60
  v_mov_b32 v65, v61
  v_mov_b32 v66, v62
  v_mov_b32 v67, v63
  v_permlane32_swap_b32 v60, v64
  v_permlane32_swap_b32 v61, v65
  v_permlane32_swap_b32 v62, v66
  v_permlane32_swap_b32 v63, v67
  v_add_f32 v60, v60, v64
  v_add_f32 v61, v61, v65
  v_add_f32 v62, v62, v66
  v_add_f32 v63, v63, v67
  v_cvt_pk_bf16_f32 v64, v60, v61
  v_cvt_pk_bf16_f32 v65, v62, v63
  ds_write_b64 v75, v[64:65]
  s_waitcnt lgkmcnt(0)
  ds_read_b128 v[64:67], v76
  ds_read_b128 v[68:71], v76 offset:1024
  s_waitcnt lgkmcnt(0)
  buffer_store_dwordx4 v[64:67], v2, s[8:11], s25 offen sc1
  buffer_store_dwordx4 v[68:71], v2, s[8:11], s25 offen offset:1024 sc1
  s_waitcnt vmcnt(0)
  s_mov_b64 exec, 1
  buffer_store_dword v78, v2, s[8:11], s26 offen sc1
  s_mov_b64 exec, -1
  s_add_u32 s24, s24, 14336
  s_add_u32 s25, s25, 16384
  s_add_u32 s26, s26, 32
  s_add_u32 s17, s17, 2
  s_cmp_lt_u32 s17, 64
  s_cbranch_scc1 ws_loop
  v_mov_b32 v250, 0
  s_branch wk_loop
wk_s4d:
  s_sub_u32 s3, s3, 624
  s_load_dwordx8 s[40:47], s[0:1], 0
  s_load_dwordx4 s[48:51], s[0:1], 32
  s_load_dwordx2 s[52:53], s[0:1], 48
  s_load_dwordx2 s[54:55], s[0:1], 112
  v_lshrrev_b32 v1, 6, v0
  s_nop 0
  v_readfirstlane_b32 s16, v1
  v_and_b32 v1, 63, v0
  v_lshrrev_b32 v3, 4, v1
  v_and_b32 v4, 15, v1
  s_mul_i32 s17, s16, 24576
  s_waitcnt lgkmcnt(0)
  s_mov_b32 s60, s40
  s_and_b32 s61, s41, 0xffff
  s_mov_b32 s62, 1835008
  s_mov_b32 s63, 0x20000
  s_mov_b32 s64, s42
  s_and_b32 s65, s43, 0xffff
  s_mov_b32 s66, 229376
  s_mov_b32 s67, 0x20000
  s_mov_b32 s68, s44
  s_and_b32 s69, s45, 0xffff
  s_mov_b32 s70, 229376
  s_mov_b32 s71, 0x20000
  s_mov_b32 s72, s46
  s_and_b32 s73, s47, 0xffff
  s_mov_b32 s74, 229376
  s_mov_b32 s75, 0x20000
  s_mov_b32 s76, s48
  s_and_b32 s77, s49, 0xffff
  s_mov_b32 s78, 229376
  s_mov_b32 s79, 0x20000
  s_mov_b32 s80, s50
  s_and_b32 s81, s51, 0xffff
  s_mov_b32 s82, 896
  s_mov_b32 s83, 0x20000
  s_mov_b32 s84, s52
  s_and_b32 s85, s53, 0xffff
  s_mov_b32 s86, 896
  s_mov_b32 s87, 0x20000
  s_mov_b32 s88, s54
  s_and_b32 s89, s55, 0xffff
  s_mov_b32 s90, 3670016
  s_mov_b32 s91, 0x20000
  v_lshlrev_b32 v5, 5, v1
  v_sub_u32 v5, 2047, v5
  s_add_u32 s18, s17, 13056
  v_subrev_u32 v6, 0, v5
  v_max_i32 v7, 0, v6
  v_cvt_f32_u32 v7, v7
  v_cvt_pk_bf16_f32 v8, v7, v7
  v_and_b32 v7, 0xffff0000, v8
  v_lshrrev_b32 v8, 23, v7
  v_subrev_u32 v8, 134, v8
  v_max_i32 v8, 0, v8
  v_cvt_u32_f32 v7, v7
  v_lshrrev_b32 v7, v8, v7
  v_lshl_add_u32 v7, v8, 8, v7
  v_lshl_add_u32 v200, v7, 2, s18
  v_subrev_u32 v6, 1, v5
  v_max_i32 v7, 0, v6
  v_cvt_f32_u32 v7, v7
  v_cvt_pk_bf16_f32 v8, v7, v7
  v_and_b32 v7, 0xffff0000, v8
  v_lshrrev_b32 v8, 23, v7
  v_subrev_u32 v8, 134, v8
  v_max_i32 v8, 0, v8
  v_cvt_u32_f32 v7, v7
  v_lshrrev_b32 v7, v8, v7
  v_lshl_add_u32 v7, v8, 8, v7
  v_lshl_add_u32 v201, v7, 2, s18
  v_subrev_u32 v6, 2, v5
  v_max_i32 v7, 0, v6
  v_cvt_f32_u32 v7, v7
  v_cvt_pk_bf16_f32 v8, v7, v7
  v_and_b32 v7, 0xffff0000, v8
  v_lshrrev_b32 v8, 23, v7
  v_subrev_u32 v8, 134, v8
  v_max_i32 v8, 0, v8
  v_cvt_u32_f32 v7, v7
  v_lshrrev_b32 v7, v8, v7
  v_lshl_add_u32 v7, v8, 8, v7
  v_lshl_add_u32 v202, v7, 2, s18
  v_subrev_u32 v6, 3, v5
  v_max_i32 v7, 0, v6
  v_cvt_f32_u32 v7, v7
  v_cvt_pk_bf16_f32 v8, v7, v7
  v_and_b32 v7, 0xffff0000, v8
  v_lshrrev_b32 v8, 23, v7
  v_subrev_u32 v8, 134, v8
  v_max_i32 v8, 0, v8
  v_cvt_u32_f32 v7, v7
  v_lshrrev_b32 v7, v8, v7
  v_lshl_add_u32 v7, v8, 8, v7
  v_lshl_add_u32 v203, v7, 2, s18
  v_subrev_u32 v6, 4, v5
  v_max_i32 v7, 0, v6
  v_cvt_f32_u32 v7, v7
  v_cvt_pk_bf16_f32 v8, v7, v7
  v_and_b32 v7, 0xffff0000, v8
  v_lshrrev_b32 v8, 23, v7
  v_subrev_u32 v8, 134, v8
  v_max_i32 v8, 0, v8
  v_cvt_u32_f32 v7, v7
  v_lshrrev_b32 v7, v8, v7
  v_lshl_add_u32 v7, v8, 8, v7
  v_lshl_add_u32 v204, v7, 2, s18
  v_subrev_u32 v6, 5, v5
  v_max_i32 v7, 0, v6
  v_cvt_f32_u32 v7, v7
  v_cvt_pk_bf16_f32 v8, v7, v7
  v_and_b32 v7, 0xffff0000, v8
  v_lshrrev_b32 v8, 23, v7
  v_subrev_u32 v8, 134, v8
  v_max_i32 v8, 0, v8
  v_cvt_u32_f32 v7, v7
  v_lshrrev_b32 v7, v8, v7
  v_lshl_add_u32 v7, v8, 8, v7
  v_lshl_add_u32 v205, v7, 2, s18
  v_subrev_u32 v6, 6, v5
  v_max_i32 v7, 0, v6
  v_cvt_f32_u32 v7, v7
  v_cvt_pk_bf16_f32 v8, v7, v7
  v_and_b32 v7, 0xffff0000, v8
  v_lshrrev_b32 v8, 23, v7
  v_subrev_u32 v8, 134, v8
  v_max_i32 v8, 0, v8
  v_cvt_u32_f32 v7, v7
  v_lshrrev_b32 v7, v8, v7
  v_lshl_add_u32 v7, v8, 8, v7
  v_lshl_add_u32 v206, v7, 2, s18
  v_subrev_u32 v6, 7, v5
  v_max_i32 v7, 0, v6
  v_cvt_f32_u32 v7, v7
  v_cvt_pk_bf16_f32 v8, v7, v7
  v_and_b32 v7, 0xffff0000, v8
  v_lshrrev_b32 v8, 23, v7
  v_subrev_u32 v8, 134, v8
  v_max_i32 v8, 0, v8
  v_cvt_u32_f32 v7, v7
  v_lshrrev_b32 v7, v8, v7
  v_lshl_add_u32 v7, v8, 8, v7
  v_lshl_add_u32 v207, v7, 2, s18
  v_subrev_u32 v6, 8, v5
  v_max_i32 v7, 0, v6
  v_cvt_f32_u32 v7, v7
  v_cvt_pk_bf16_f32 v8, v7, v7
  v_and_b32 v7, 0xffff0000, v8
  v_lshrrev_b32 v8, 23, v7
  v_subrev_u32 v8, 134, v8
  v_max_i32 v8, 0, v8
  v_cvt_u32_f32 v7, v7
  v_lshrrev_b32 v7, v8, v7
  v_lshl_add_u32 v7, v8, 8, v7
  v_lshl_add_u32 v208, v7, 2, s18
  v_subrev_u32 v6, 9, v5
  v_max_i32 v7, 0, v6
  v_cvt_f32_u32 v7, v7
  v_cvt_pk_bf16_f32 v8, v7, v7
  v_and_b32 v7, 0xffff0000, v8
  v_lshrrev_b32 v8, 23, v7
  v_subrev_u32 v8, 134, v8
  v_max_i32 v8, 0, v8
  v_cvt_u32_f32 v7, v7
  v_lshrrev_b32 v7, v8, v7
  v_lshl_add_u32 v7, v8, 8, v7
  v_lshl_add_u32 v209, v7, 2, s18
  v_subrev_u32 v6, 10, v5
  v_max_i32 v7, 0, v6
  v_cvt_f32_u32 v7, v7
  v_cvt_pk_bf16_f32 v8, v7, v7
  v_and_b32 v7, 0xffff0000, v8
  v_lshrrev_b32 v8, 23, v7
  v_subrev_u32 v8, 134, v8
  v_max_i32 v8, 0, v8
  v_cvt_u32_f32 v7, v7
  v_lshrrev_b32 v7, v8, v7
  v_lshl_add_u32 v7, v8, 8, v7
  v_lshl_add_u32 v210, v7, 2, s18
  v_subrev_u32 v6, 11, v5
  v_max_i32 v7, 0, v6
  v_cvt_f32_u32 v7, v7
  v_cvt_pk_bf16_f32 v8, v7, v7
  v_and_b32 v7, 0xffff0000, v8
  v_lshrrev_b32 v8, 23, v7
  v_subrev_u32 v8, 134, v8
  v_max_i32 v8, 0, v8
  v_cvt_u32_f32 v7, v7
  v_lshrrev_b32 v7, v8, v7
  v_lshl_add_u32 v7, v8, 8, v7
  v_lshl_add_u32 v211, v7, 2, s18
  v_subrev_u32 v6, 12, v5
  v_max_i32 v7, 0, v6
  v_cvt_f32_u32 v7, v7
  v_cvt_pk_bf16_f32 v8, v7, v7
  v_and_b32 v7, 0xffff0000, v8
  v_lshrrev_b32 v8, 23, v7
  v_subrev_u32 v8, 134, v8
  v_max_i32 v8, 0, v8
  v_cvt_u32_f32 v7, v7
  v_lshrrev_b32 v7, v8, v7
  v_lshl_add_u32 v7, v8, 8, v7
  v_lshl_add_u32 v212, v7, 2, s18
  v_subrev_u32 v6, 13, v5
  v_max_i32 v7, 0, v6
  v_cvt_f32_u32 v7, v7
  v_cvt_pk_bf16_f32 v8, v7, v7
  v_and_b32 v7, 0xffff0000, v8
  v_lshrrev_b32 v8, 23, v7
  v_subrev_u32 v8, 134, v8
  v_max_i32 v8, 0, v8
  v_cvt_u32_f32 v7, v7
  v_lshrrev_b32 v7, v8, v7
  v_lshl_add_u32 v7, v8, 8, v7
  v_lshl_add_u32 v213, v7, 2, s18
  v_subrev_u32 v6, 14, v5
  v_max_i32 v7, 0, v6
  v_cvt_f32_u32 v7, v7
  v_cvt_pk_bf16_f32 v8, v7, v7
  v_and_b32 v7, 0xffff0000, v8
  v_lshrrev_b32 v8, 23, v7
  v_subrev_u32 v8, 134, v8
  v_max_i32 v8, 0, v8
  v_cvt_u32_f32 v7, v7
  v_lshrrev_b32 v7, v8, v7
  v_lshl_add_u32 v7, v8, 8, v7
  v_lshl_add_u32 v214, v7, 2, s18
  v_subrev_u32 v6, 15, v5
  v_max_i32 v7, 0, v6
  v_cvt_f32_u32 v7, v7
  v_cvt_pk_bf16_f32 v8, v7, v7
  v_and_b32 v7, 0xffff0000, v8
  v_lshrrev_b32 v8, 23, v7
  v_subrev_u32 v8, 134, v8
  v_max_i32 v8, 0, v8
  v_cvt_u32_f32 v7, v7
  v_lshrrev_b32 v7, v8, v7
  v_lshl_add_u32 v7, v8, 8, v7
  v_lshl_add_u32 v215, v7, 2, s18
  v_subrev_u32 v6, 16, v5
  v_max_i32 v7, 0, v6
  v_cvt_f32_u32 v7, v7
  v_cvt_pk_bf16_f32 v8, v7, v7
  v_and_b32 v7, 0xffff0000, v8
  v_lshrrev_b32 v8, 23, v7
  v_subrev_u32 v8, 134, v8
  v_max_i32 v8, 0, v8
  v_cvt_u32_f32 v7, v7
  v_lshrrev_b32 v7, v8, v7
  v_lshl_add_u32 v7, v8, 8, v7
  v_lshl_add_u32 v216, v7, 2, s18
  v_subrev_u32 v6, 17, v5
  v_max_i32 v7, 0, v6
  v_cvt_f32_u32 v7, v7
  v_cvt_pk_bf16_f32 v8, v7, v7
  v_and_b32 v7, 0xffff0000, v8
  v_lshrrev_b32 v8, 23, v7
  v_subrev_u32 v8, 134, v8
  v_max_i32 v8, 0, v8
  v_cvt_u32_f32 v7, v7
  v_lshrrev_b32 v7, v8, v7
  v_lshl_add_u32 v7, v8, 8, v7
  v_lshl_add_u32 v217, v7, 2, s18
  v_subrev_u32 v6, 18, v5
  v_max_i32 v7, 0, v6
  v_cvt_f32_u32 v7, v7
  v_cvt_pk_bf16_f32 v8, v7, v7
  v_and_b32 v7, 0xffff0000, v8
  v_lshrrev_b32 v8, 23, v7
  v_subrev_u32 v8, 134, v8
  v_max_i32 v8, 0, v8
  v_cvt_u32_f32 v7, v7
  v_lshrrev_b32 v7, v8, v7
  v_lshl_add_u32 v7, v8, 8, v7
  v_lshl_add_u32 v218, v7, 2, s18
  v_subrev_u32 v6, 19, v5
  v_max_i32 v7, 0, v6
  v_cvt_f32_u32 v7, v7
  v_cvt_pk_bf16_f32 v8, v7, v7
  v_and_b32 v7, 0xffff0000, v8
  v_lshrrev_b32 v8, 23, v7
  v_subrev_u32 v8, 134, v8
  v_max_i32 v8, 0, v8
  v_cvt_u32_f32 v7, v7
  v_lshrrev_b32 v7, v8, v7
  v_lshl_add_u32 v7, v8, 8, v7
  v_lshl_add_u32 v219, v7, 2, s18
  v_subrev_u32 v6, 20, v5
  v_max_i32 v7, 0, v6
  v_cvt_f32_u32 v7, v7
  v_cvt_pk_bf16_f32 v8, v7, v7
  v_and_b32 v7, 0xffff0000, v8
  v_lshrrev_b32 v8, 23, v7
  v_subrev_u32 v8, 134, v8
  v_max_i32 v8, 0, v8
  v_cvt_u32_f32 v7, v7
  v_lshrrev_b32 v7, v8, v7
  v_lshl_add_u32 v7, v8, 8, v7
  v_lshl_add_u32 v220, v7, 2, s18
  v_subrev_u32 v6, 21, v5
  v_max_i32 v7, 0, v6
  v_cvt_f32_u32 v7, v7
  v_cvt_pk_bf16_f32 v8, v7, v7
  v_and_b32 v7, 0xffff0000, v8
  v_lshrrev_b32 v8, 23, v7
  v_subrev_u32 v8, 134, v8
  v_max_i32 v8, 0, v8
  v_cvt_u32_f32 v7, v7
  v_lshrrev_b32 v7, v8, v7
  v_lshl_add_u32 v7, v8, 8, v7
  v_lshl_add_u32 v221, v7, 2, s18
  v_subrev_u32 v6, 22, v5
  v_max_i32 v7, 0, v6
  v_cvt_f32_u32 v7, v7
  v_cvt_pk_bf16_f32 v8, v7, v7
  v_and_b32 v7, 0xffff0000, v8
  v_lshrrev_b32 v8, 23, v7
  v_subrev_u32 v8, 134, v8
  v_max_i32 v8, 0, v8
  v_cvt_u32_f32 v7, v7
  v_lshrrev_b32 v7, v8, v7
  v_lshl_add_u32 v7, v8, 8, v7
  v_lshl_add_u32 v222, v7, 2, s18
  v_subrev_u32 v6, 23, v5
  v_max_i32 v7, 0, v6
  v_cvt_f32_u32 v7, v7
  v_cvt_pk_bf16_f32 v8, v7, v7
  v_and_b32 v7, 0xffff0000, v8
  v_lshrrev_b32 v8, 23, v7
  v_subrev_u32 v8, 134, v8
  v_max_i32 v8, 0, v8
  v_cvt_u32_f32 v7, v7
  v_lshrrev_b32 v7, v8, v7
  v_lshl_add_u32 v7, v8, 8, v7
  v_lshl_add_u32 v223, v7, 2, s18
  v_subrev_u32 v6, 24, v5
  v_max_i32 v7, 0, v6
  v_cvt_f32_u32 v7, v7
  v_cvt_pk_bf16_f32 v8, v7, v7
  v_and_b32 v7, 0xffff0000, v8
  v_lshrrev_b32 v8, 23, v7
  v_subrev_u32 v8, 134, v8
  v_max_i32 v8, 0, v8
  v_cvt_u32_f32 v7, v7
  v_lshrrev_b32 v7, v8, v7
  v_lshl_add_u32 v7, v8, 8, v7
  v_lshl_add_u32 v224, v7, 2, s18
  v_subrev_u32 v6, 25, v5
  v_max_i32 v7, 0, v6
  v_cvt_f32_u32 v7, v7
  v_cvt_pk_bf16_f32 v8, v7, v7
  v_and_b32 v7, 0xffff0000, v8
  v_lshrrev_b32 v8, 23, v7
  v_subrev_u32 v8, 134, v8
  v_max_i32 v8, 0, v8
  v_cvt_u32_f32 v7, v7
  v_lshrrev_b32 v7, v8, v7
  v_lshl_add_u32 v7, v8, 8, v7
  v_lshl_add_u32 v225, v7, 2, s18
  v_subrev_u32 v6, 26, v5
  v_max_i32 v7, 0, v6
  v_cvt_f32_u32 v7, v7
  v_cvt_pk_bf16_f32 v8, v7, v7
  v_and_b32 v7, 0xffff0000, v8
  v_lshrrev_b32 v8, 23, v7
  v_subrev_u32 v8, 134, v8
  v_max_i32 v8, 0, v8
  v_cvt_u32_f32 v7, v7
  v_lshrrev_b32 v7, v8, v7
  v_lshl_add_u32 v7, v8, 8, v7
  v_lshl_add_u32 v226, v7, 2, s18
  v_subrev_u32 v6, 27, v5
  v_max_i32 v7, 0, v6
  v_cvt_f32_u32 v7, v7
  v_cvt_pk_bf16_f32 v8, v7, v7
  v_and_b32 v7, 0xffff0000, v8
  v_lshrrev_b32 v8, 23, v7
  v_subrev_u32 v8, 134, v8
  v_max_i32 v8, 0, v8
  v_cvt_u32_f32 v7, v7
  v_lshrrev_b32 v7, v8, v7
  v_lshl_add_u32 v7, v8, 8, v7
  v_lshl_add_u32 v227, v7, 2, s18
  v_subrev_u32 v6, 28, v5
  v_max_i32 v7, 0, v6
  v_cvt_f32_u32 v7, v7
  v_cvt_pk_bf16_f32 v8, v7, v7
  v_and_b32 v7, 0xffff0000, v8
  v_lshrrev_b32 v8, 23, v7
  v_subrev_u32 v8, 134, v8
  v_max_i32 v8, 0, v8
  v_cvt_u32_f32 v7, v7
  v_lshrrev_b32 v7, v8, v7
  v_lshl_add_u32 v7, v8, 8, v7
  v_lshl_add_u32 v228, v7, 2, s18
  v_subrev_u32 v6, 29, v5
  v_max_i32 v7, 0, v6
  v_cvt_f32_u32 v7, v7
  v_cvt_pk_bf16_f32 v8, v7, v7
  v_and_b32 v7, 0xffff0000, v8
  v_lshrrev_b32 v8, 23, v7
  v_subrev_u32 v8, 134, v8
  v_max_i32 v8, 0, v8
  v_cvt_u32_f32 v7, v7
  v_lshrrev_b32 v7, v8, v7
  v_lshl_add_u32 v7, v8, 8, v7
  v_lshl_add_u32 v229, v7, 2, s18
  v_subrev_u32 v6, 30, v5
  v_max_i32 v7, 0, v6
  v_cvt_f32_u32 v7, v7
  v_cvt_pk_bf16_f32 v8, v7, v7
  v_and_b32 v7, 0xffff0000, v8
  v_lshrrev_b32 v8, 23, v7
  v_subrev_u32 v8, 134, v8
  v_max_i32 v8, 0, v8
  v_cvt_u32_f32 v7, v7
  v_lshrrev_b32 v7, v8, v7
  v_lshl_add_u32 v7, v8, 8, v7
  v_lshl_add_u32 v230, v7, 2, s18
  v_subrev_u32 v6, 31, v5
  v_max_i32 v7, 0, v6
  v_cvt_f32_u32 v7, v7
  v_cvt_pk_bf16_f32 v8, v7, v7
  v_and_b32 v7, 0xffff0000, v8
  v_lshrrev_b32 v8, 23, v7
  v_subrev_u32 v8, 134, v8
  v_max_i32 v8, 0, v8
  v_cvt_u32_f32 v7, v7
  v_lshrrev_b32 v7, v8, v7
  v_lshl_add_u32 v7, v8, 8, v7
  v_lshl_add_u32 v231, v7, 2, s18
  v_subrev_u32 v6, 32, v5
  v_max_i32 v7, 0, v6
  v_cvt_f32_u32 v7, v7
  v_cvt_pk_bf16_f32 v8, v7, v7
  v_and_b32 v7, 0xffff0000, v8
  v_lshrrev_b32 v8, 23, v7
  v_subrev_u32 v8, 134, v8
  v_max_i32 v8, 0, v8
  v_cvt_u32_f32 v7, v7
  v_lshrrev_b32 v7, v8, v7
  v_lshl_add_u32 v7, v8, 8, v7
  v_mov_b32 v8, 1280
  v_cmp_gt_i32 vcc, 0, v6
  s_nop 1
  v_cndmask_b32 v7, v7, v8, vcc
  v_lshl_add_u32 v232, v7, 2, s18
  v_mov_b32 v8, 0
  v_mov_b32 v9, 0
  v_lshlrev_b32 v5, 3, v1
  v_add_u32 v5, s17, v5
  ds_write_b64 v5, v[8:9]
  v_and_b32 v6, 15, v1
  v_lshlrev_b32 v6, 3, v6
  v_add_u32 v6, s17, v6
  ds_write_b64 v6, v[8:9] offset:8704
  ds_write_b64 v6, v[8:9] offset:12928
  v_mov_b32 v6, s17
  ds_write_b64 v6, v[8:9] offset:18176
  s_lshl_b32 s19, s3, 2
  s_add_u32 s20, s19, s16
  s_lshl_b32 s21, s3, 3
  v_mul_u32_u24 v5, 3584, v0
  s_add_u32 s22, s21, 0
  buffer_load_dwordx2 v[8:9], v5, s[60:63], s22 offen offset:0
  buffer_load_dwordx2 v[10:11], v5, s[60:63], s22 offen offset:896
  buffer_load_dwordx2 v[12:13], v5, s[60:63], s22 offen offset:1792
  buffer_load_dwordx2 v[14:15], v5, s[60:63], s22 offen offset:2688
  s_add_u32 s22, s21, 917504
  buffer_load_dwordx2 v[16:17], v5, s[60:63], s22 offen offset:0
  buffer_load_dwordx2 v[18:19], v5, s[60:63], s22 offen offset:896
  buffer_load_dwordx2 v[20:21], v5, s[60:63], s22 offen offset:1792
  buffer_load_dwordx2 v[22:23], v5, s[60:63], s22 offen offset:2688
  s_lshl_b32 s22, s20, 9
  v_lshlrev_b32 v6, 3, v1
  buffer_load_dwordx2 v[24:25], v6, s[64:67], s22 offen
  buffer_load_dwordx2 v[26:27], v6, s[68:71], s22 offen
  buffer_load_dwordx2 v[28:29], v6, s[72:75], s22 offen
  buffer_load_dwordx2 v[30:31], v6, s[76:79], s22 offen
  s_lshl_b32 s22, s20, 1
  v_mov_b32 v7, 0
  buffer_load_ushort v32, v7, s[80:83], s22 offen
  buffer_load_ushort v33, v7, s[84:87], s22 offen
  s_mov_b32 s24, 0x05040100
  s_mov_b32 s25, 0x07060302
  s_barrier
  s_waitcnt vmcnt(6)
  v_lshlrev_b32 v6, 3, v0
  v_perm_b32 v34, v10, v8, s24
  v_perm_b32 v35, v14, v12, s24
  v_add_u32 v36, 512, v6
  ds_write_b64 v36, v[34:35]
  v_perm_b32 v34, v10, v8, s25
  v_perm_b32 v35, v14, v12, s25
  v_add_u32 v36, 25088, v6
  ds_write_b64 v36, v[34:35]
  v_perm_b32 v34, v11, v9, s24
  v_perm_b32 v35, v15, v13, s24
  v_add_u32 v36, 49664, v6
  ds_write_b64 v36, v[34:35]
  v_perm_b32 v34, v11, v9, s25
  v_perm_b32 v35, v15, v13, s25
  v_add_u32 v36, 74240, v6
  ds_write_b64 v36, v[34:35]
  v_perm_b32 v34, v18, v16, s24
  v_perm_b32 v35, v22, v20, s24
  v_add_u32 v36, 2560, v6
  ds_write_b64 v36, v[34:35]
  v_perm_b32 v34, v18, v16, s25
  v_perm_b32 v35, v22, v20, s25
  v_add_u32 v36, 27136, v6
  ds_write_b64 v36, v[34:35]
  v_perm_b32 v34, v19, v17, s24
  v_perm_b32 v35, v23, v21, s24
  v_add_u32 v36, 51712, v6
  ds_write_b64 v36, v[34:35]
  v_perm_b32 v34, v19, v17, s25
  v_perm_b32 v35, v23, v21, s25
  v_add_u32 v36, 76288, v6
  ds_write_b64 v36, v[34:35]
  s_waitcnt vmcnt(0)
  s_mov_b32 s26, 1069066811
  s_mov_b32 s27, 1042479491
  v_lshlrev_b32 v32, 16, v32
  v_lshlrev_b32 v33, 16, v33
  v_mul_f32 v32, s26, v32
  v_exp_f32 v32, v32
  s_nop 0
  v_cvt_pk_bf16_f32 v34, v32, v32
  v_and_b32 v32, 0xffff0000, v34
  v_lshlrev_b32 v37, 6, v1
  v_add_u32 v37, s17, v37
  v_lshlrev_b32 v40, 16, v24
  v_lshlrev_b32 v41, 16, v26
  v_lshlrev_b32 v42, 16, v28
  v_lshlrev_b32 v43, 16, v30
  v_mul_f32 v40, s26, v40
  v_exp_f32 v40, v40
  s_nop 0
  v_cvt_pk_bf16_f32 v34, v40, v40
  v_and_b32 v40, 0xffff0000, v34
  v_mul_f32 v40, v40, v32
  v_mul_f32 v40, s26, v40
  v_sub_f32 v40, 0, v40
  v_mul_f32 v41, v41, v32
  v_mul_f32 v41, s27, v41
  v_mul_f32 v42, v42, v32
  v_mul_f32 v43, v43, v32
  v_add_f32 v42, v42, v42
  v_add_f32 v43, v43, v43
  ds_write_b128 v37, v[40:43] offset:18240
  v_and_b32 v40, 0xffff0000, v24
  v_and_b32 v41, 0xffff0000, v26
  v_and_b32 v42, 0xffff0000, v28
  v_and_b32 v43, 0xffff0000, v30
  v_mul_f32 v40, s26, v40
  v_exp_f32 v40, v40
  s_nop 0
  v_cvt_pk_bf16_f32 v34, v40, v40
  v_and_b32 v40, 0xffff0000, v34
  v_mul_f32 v40, v40, v32
  v_mul_f32 v40, s26, v40
  v_sub_f32 v40, 0, v40
  v_mul_f32 v41, v41, v32
  v_mul_f32 v41, s27, v41
  v_mul_f32 v42, v42, v32
  v_mul_f32 v43, v43, v32
  v_add_f32 v42, v42, v42
  v_add_f32 v43, v43, v43
  ds_write_b128 v37, v[40:43] offset:18256
  v_lshlrev_b32 v40, 16, v25
  v_lshlrev_b32 v41, 16, v27
  v_lshlrev_b32 v42, 16, v29
  v_lshlrev_b32 v43, 16, v31
  v_mul_f32 v40, s26, v40
  v_exp_f32 v40, v40
  s_nop 0
  v_cvt_pk_bf16_f32 v34, v40, v40
  v_and_b32 v40, 0xffff0000, v34
  v_mul_f32 v40, v40, v32
  v_mul_f32 v40, s26, v40
  v_sub_f32 v40, 0, v40
  v_mul_f32 v41, v41, v32
  v_mul_f32 v41, s27, v41
  v_mul_f32 v42, v42, v32
  v_mul_f32 v43, v43, v32
  v_add_f32 v42, v42, v42
  v_add_f32 v43, v43, v43
  ds_write_b128 v37, v[40:43] offset:18272
  v_and_b32 v40, 0xffff0000, v25
  v_and_b32 v41, 0xffff0000, v27
  v_and_b32 v42, 0xffff0000, v29
  v_and_b32 v43, 0xffff0000, v31
  v_mul_f32 v40, s26, v40
  v_exp_f32 v40, v40
  s_nop 0
  v_cvt_pk_bf16_f32 v34, v40, v40
  v_and_b32 v40, 0xffff0000, v34
  v_mul_f32 v40, v40, v32
  v_mul_f32 v40, s26, v40
  v_sub_f32 v40, 0, v40
  v_mul_f32 v41, v41, v32
  v_mul_f32 v41, s27, v41
  v_mul_f32 v42, v42, v32
  v_mul_f32 v43, v43, v32
  v_add_f32 v42, v42, v42
  v_add_f32 v43, v43, v43
  ds_write_b128 v37, v[40:43] offset:18288
  v_cvt_f32_u32 v44, v4
  v_lshlrev_b32 v45, 4, v4
  v_cvt_f32_u32 v45, v45
  v_lshlrev_b32 v46, 4, v3
  v_add_u32 v46, s17, v46
  v_mov_b32 v48, 0
  v_mov_b32 v49, 0
  v_mov_b32 v50, 0
  v_mov_b32 v51, 0
  v_mov_b32 v52, 0
  v_mov_b32 v53, 0
  v_mov_b32 v54, 0
  v_mov_b32 v55, 0
  v_mov_b32 v56, 0
  v_mov_b32 v57, 0
  v_mov_b32 v58, 0
  v_mov_b32 v59, 0
  v_mov_b32 v60, 0
  v_mov_b32 v61, 0
  v_mov_b32 v62, 0
  v_mov_b32 v63, 0
  v_mov_b32 v64, 0
  v_mov_b32 v65, 0
  v_mov_b32 v66, 0
  v_mov_b32 v67, 0
  s_mov_b32 s28, 0
  s_waitcnt lgkmcnt(0)
  ds_read_b128 v[68:71], v46 offset:18240
wk_kl:
  s_waitcnt lgkmcnt(0)
  v_mov_b32 v72, v68
  v_mov_b32 v73, v69
  v_mov_b32 v74, v70
  v_mov_b32 v75, v71
  v_add_u32 v46, 64, v46
  ds_read_b128 v[68:71], v46 offset:18240
  v_mul_f32 v80, v72, v45
  v_mul_f32 v81, v73, v45
  v_exp_f32 v80, v80
  v_fract_f32 v81, v81
  v_cos_f32 v76, v81
  v_sin_f32 v77, v81
  v_mul_f32 v76, v76, v80
  v_mul_f32 v77, v77, v80
  v_mul_f32 v80, v72, v44
  v_mul_f32 v81, v73, v44
  v_exp_f32 v80, v80
  v_fract_f32 v81, v81
  v_cos_f32 v78, v81
  v_sin_f32 v79, v81
  v_mul_f32 v78, v78, v80
  v_mul_f32 v79, v79, v80
  v_mul_f32 v82, v74, v76
  v_mul_f32 v83, v74, v77
  v_fma_f32 v82, -v75, v77, v82
  v_fma_f32 v83, -v75, v76, -v83
  v_mul_f32 v86, v76, v76
  v_mul_f32 v87, v76, v77
  v_fma_f32 v86, -v77, v77, v86
  v_add_f32 v87, v87, v87
  v_mfma_f32_16x16x4_f32 v[48:51], v82, v78, v[48:51]
  v_mul_f32 v88, v78, v78
  v_mul_f32 v89, v78, v79
  v_fma_f32 v88, -v79, v79, v88
  v_add_f32 v89, v89, v89
  v_mfma_f32_16x16x4_f32 v[48:51], v83, v79, v[48:51]
  v_mul_f32 v84, v74, v86
  v_mul_f32 v85, v74, v87
  v_fma_f32 v84, -v75, v87, v84
  v_fma_f32 v85, -v75, v86, -v85
  v_mul_f32 v76, v86, v86
  v_mul_f32 v77, v86, v87
  v_fma_f32 v76, -v87, v87, v76
  v_add_f32 v77, v77, v77
  v_mfma_f32_16x16x4_f32 v[52:55], v84, v88, v[52:55]
  v_mul_f32 v78, v88, v88
  v_mul_f32 v79, v88, v89
  v_fma_f32 v78, -v89, v89, v78
  v_add_f32 v79, v79, v79
  v_mfma_f32_16x16x4_f32 v[52:55], v85, v89, v[52:55]
  v_mul_f32 v82, v74, v76
  v_mul_f32 v83, v74, v77
  v_fma_f32 v82, -v75, v77, v82
  v_fma_f32 v83, -v75, v76, -v83
  v_mul_f32 v86, v76, v76
  v_mul_f32 v87, v76, v77
  v_fma_f32 v86, -v77, v77, v86
  v_add_f32 v87, v87, v87
  v_mfma_f32_16x16x4_f32 v[56:59], v82, v78, v[56:59]
  v_mul_f32 v88, v78, v78
  v_mul_f32 v89, v78, v79
  v_fma_f32 v88, -v79, v79, v88
  v_add_f32 v89, v89, v89
  v_mfma_f32_16x16x4_f32 v[56:59], v83, v79, v[56:59]
  v_mul_f32 v84, v74, v86
  v_mul_f32 v85, v74, v87
  v_fma_f32 v84, -v75, v87, v84
  v_fma_f32 v85, -v75, v86, -v85
  v_mul_f32 v76, v86, v86
  v_mul_f32 v77, v86, v87
  v_fma_f32 v76, -v87, v87, v76
  v_add_f32 v77, v77, v77
  v_mfma_f32_16x16x4_f32 v[60:63], v84, v88, v[60:63]
  v_mfma_f32_16x16x4_f32 v[60:63], v85, v89, v[60:63]
  v_mul_f32 v82, v74, v76
  v_fma_f32 v82, -v75, v77, v82
  s_nop 1
  v_mfma_f32_16x16x4_f32 v[64:67], v82, v88, v[64:67]
  s_add_u32 s28, s28, 1
  s_cmp_lt_u32 s28, 64
  s_cbranch_scc1 wk_kl
  s_nop 15
  s_nop 3
  v_lshlrev_b32 v46, 8, v3
  v_lshl_add_u32 v46, v4, 2, v46
  v_add_u32 v46, s17, v46
  ds_write_b32 v46, v48 offset:13056
  ds_write_b32 v46, v49 offset:13120
  ds_write_b32 v46, v50 offset:13184
  ds_write_b32 v46, v51 offset:13248
  s_waitcnt lgkmcnt(8)
  ds_write_b32 v46, v52 offset:14080
  ds_write_b32 v46, v53 offset:14144
  ds_write_b32 v46, v54 offset:14208
  ds_write_b32 v46, v55 offset:14272
  s_waitcnt lgkmcnt(8)
  ds_write_b32 v46, v56 offset:15104
  ds_write_b32 v46, v57 offset:15168
  ds_write_b32 v46, v58 offset:15232
  ds_write_b32 v46, v59 offset:15296
  s_waitcnt lgkmcnt(8)
  ds_write_b32 v46, v60 offset:16128
  ds_write_b32 v46, v61 offset:16192
  ds_write_b32 v46, v62 offset:16256
  ds_write_b32 v46, v63 offset:16320
  s_waitcnt lgkmcnt(8)
  ds_write_b32 v46, v64 offset:17152
  ds_write_b32 v46, v65 offset:17216
  ds_write_b32 v46, v66 offset:17280
  ds_write_b32 v46, v67 offset:17344
  s_waitcnt lgkmcnt(8)
  s_waitcnt lgkmcnt(0)
  ds_read_b32 v48, v200
  ds_read_b32 v49, v201
  ds_read_b32 v50, v202
  ds_read_b32 v51, v203
  ds_read_b32 v52, v204
  ds_read_b32 v53, v205
  ds_read_b32 v54, v206
  ds_read_b32 v55, v207
  s_waitcnt lgkmcnt(4)
  ds_read_b32 v56, v208
  ds_read_b32 v57, v209
  ds_read_b32 v58, v210
  ds_read_b32 v59, v211
  ds_read_b32 v60, v212
  ds_read_b32 v61, v213
  ds_read_b32 v62, v214
  ds_read_b32 v63, v215
  s_waitcnt lgkmcnt(4)
  ds_read_b32 v64, v216
  ds_read_b32 v65, v217
  ds_read_b32 v66, v218
  ds_read_b32 v67, v219
  ds_read_b32 v68, v220
  ds_read_b32 v69, v221
  ds_read_b32 v70, v222
  ds_read_b32 v71, v223
  s_waitcnt lgkmcnt(4)
  ds_read_b32 v72, v224
  ds_read_b32 v73, v225
  ds_read_b32 v74, v226
  ds_read_b32 v75, v227
  ds_read_b32 v76, v228
  ds_read_b32 v77, v229
  ds_read_b32 v78, v230
  ds_read_b32 v79, v231
  s_waitcnt lgkmcnt(4)
  ds_read_b32 v80, v232
  s_waitcnt lgkmcnt(0)
  v_lshlrev_b32 v46, 6, v1
  v_add_u32 v46, s17, v46
  v_cvt_pk_bf16_f32 v84, v48, v49
  v_cvt_pk_bf16_f32 v88, v49, v50
  v_cvt_pk_bf16_f32 v85, v50, v51
  v_cvt_pk_bf16_f32 v89, v51, v52
  v_cvt_pk_bf16_f32 v86, v52, v53
  v_cvt_pk_bf16_f32 v90, v53, v54
  v_cvt_pk_bf16_f32 v87, v54, v55
  v_cvt_pk_bf16_f32 v91, v55, v56
  ds_write_b128 v46, v[84:87] offset:4608
  ds_write_b128 v46, v[88:91] offset:8832
  s_waitcnt lgkmcnt(0)
  v_cvt_pk_bf16_f32 v84, v56, v57
  v_cvt_pk_bf16_f32 v88, v57, v58
  v_cvt_pk_bf16_f32 v85, v58, v59
  v_cvt_pk_bf16_f32 v89, v59, v60
  v_cvt_pk_bf16_f32 v86, v60, v61
  v_cvt_pk_bf16_f32 v90, v61, v62
  v_cvt_pk_bf16_f32 v87, v62, v63
  v_cvt_pk_bf16_f32 v91, v63, v64
  ds_write_b128 v46, v[84:87] offset:4624
  ds_write_b128 v46, v[88:91] offset:8848
  s_waitcnt lgkmcnt(0)
  v_cvt_pk_bf16_f32 v84, v64, v65
  v_cvt_pk_bf16_f32 v88, v65, v66
  v_cvt_pk_bf16_f32 v85, v66, v67
  v_cvt_pk_bf16_f32 v89, v67, v68
  v_cvt_pk_bf16_f32 v86, v68, v69
  v_cvt_pk_bf16_f32 v90, v69, v70
  v_cvt_pk_bf16_f32 v87, v70, v71
  v_cvt_pk_bf16_f32 v91, v71, v72
  ds_write_b128 v46, v[84:87] offset:4640
  ds_write_b128 v46, v[88:91] offset:8864
  s_waitcnt lgkmcnt(0)
  v_cvt_pk_bf16_f32 v84, v72, v73
  v_cvt_pk_bf16_f32 v88, v73, v74
  v_cvt_pk_bf16_f32 v85, v74, v75
  v_cvt_pk_bf16_f32 v89, v75, v76
  v_cvt_pk_bf16_f32 v86, v76, v77
  v_cvt_pk_bf16_f32 v90, v77, v78
  v_cvt_pk_bf16_f32 v87, v78, v79
  v_cvt_pk_bf16_f32 v91, v79, v80
  ds_write_b128 v46, v[84:87] offset:4656
  ds_write_b128 v46, v[88:91] offset:8880
  s_waitcnt lgkmcnt(0)
  s_barrier
  v_lshrrev_b32 v47, 1, v3
  v_sub_u32 v46, v4, v47
  v_add_u32 v46, 1, v46
  v_lshlrev_b32 v46, 5, v46
  v_and_b32 v48, 1, v3
  v_lshl_add_u32 v46, v48, 4, v46
  v_add_u32 v46, s17, v46
  ds_read_b128 a[0:3], v46 offset:32
  ds_read_b128 a[4:7], v46 offset:96
  ds_read_b128 a[8:11], v46 offset:160
  ds_read_b128 a[12:15], v46 offset:224
  ds_read_b128 a[16:19], v46 offset:288
  ds_read_b128 a[20:23], v46 offset:352
  ds_read_b128 a[24:27], v46 offset:416
  ds_read_b128 a[28:31], v46 offset:480
  s_waitcnt lgkmcnt(4)
  ds_read_b128 a[32:35], v46 offset:544
  ds_read_b128 a[36:39], v46 offset:608
  ds_read_b128 a[40:43], v46 offset:672
  ds_read_b128 a[44:47], v46 offset:736
  ds_read_b128 a[48:51], v46 offset:800
  ds_read_b128 a[52:55], v46 offset:864
  ds_read_b128 a[56:59], v46 offset:928
  ds_read_b128 a[60:63], v46 offset:992
  s_waitcnt lgkmcnt(4)
  ds_read_b128 a[64:67], v46 offset:1056
  ds_read_b128 a[68:71], v46 offset:1120
  ds_read_b128 a[72:75], v46 offset:1184
  ds_read_b128 a[76:79], v46 offset:1248
  ds_read_b128 a[80:83], v46 offset:1312
  ds_read_b128 a[84:87], v46 offset:1376
  ds_read_b128 a[88:91], v46 offset:1440
  ds_read_b128 a[92:95], v46 offset:1504
  s_waitcnt lgkmcnt(4)
  ds_read_b128 a[96:99], v46 offset:1568
  ds_read_b128 a[100:103], v46 offset:1632
  ds_read_b128 a[104:107], v46 offset:1696
  ds_read_b128 a[108:111], v46 offset:1760
  ds_read_b128 a[112:115], v46 offset:1824
  ds_read_b128 a[116:119], v46 offset:1888
  ds_read_b128 a[120:123], v46 offset:1952
  ds_read_b128 a[124:127], v46 offset:2016
  s_waitcnt lgkmcnt(4)
  ds_read_b128 a[128:131], v46 offset:2080
  ds_read_b128 a[132:135], v46 offset:2144
  ds_read_b128 a[136:139], v46 offset:2208
  ds_read_b128 a[140:143], v46 offset:2272
  ds_read_b128 a[144:147], v46 offset:2336
  ds_read_b128 a[148:151], v46 offset:2400
  ds_read_b128 a[152:155], v46 offset:2464
  ds_read_b128 a[156:159], v46 offset:2528
  s_waitcnt lgkmcnt(4)
  ds_read_b128 a[160:163], v46 offset:2592
  ds_read_b128 a[164:167], v46 offset:2656
  ds_read_b128 a[168:171], v46 offset:2720
  ds_read_b128 a[172:175], v46 offset:2784
  ds_read_b128 a[176:179], v46 offset:2848
  ds_read_b128 a[180:183], v46 offset:2912
  ds_read_b128 a[184:187], v46 offset:2976
  ds_read_b128 a[188:191], v46 offset:3040
  s_waitcnt lgkmcnt(4)
  ds_read_b128 a[192:195], v46 offset:3104
  ds_read_b128 a[196:199], v46 offset:3168
  ds_read_b128 a[200:203], v46 offset:3232
  ds_read_b128 a[204:207], v46 offset:3296
  ds_read_b128 a[208:211], v46 offset:3360
  ds_read_b128 a[212:215], v46 offset:3424
  ds_read_b128 a[216:219], v46 offset:3488
  ds_read_b128 a[220:223], v46 offset:3552
  s_waitcnt lgkmcnt(4)
  ds_read_b128 a[224:227], v46 offset:3616
  ds_read_b128 a[228:231], v46 offset:3680
  ds_read_b128 a[232:235], v46 offset:3744
  ds_read_b128 a[236:239], v46 offset:3808
  ds_read_b128 a[240:243], v46 offset:3872
  ds_read_b128 a[244:247], v46 offset:3936
  ds_read_b128 a[248:251], v46 offset:4000
  ds_read_b128 a[252:255], v46 offset:4064
  s_waitcnt lgkmcnt(4)
  v_lshlrev_b32 v49, 4, v47
  v_add_u32 v49, v49, v4
  v_sub_u32 v49, 2047, v49
  v_lshl_add_u32 v49, v48, 3, v49
  v_and_b32 v50, 1, v49
  v_lshrrev_b32 v49, 1, v49
  v_lshlrev_b32 v49, 2, v49
  v_mul_u32_u24 v50, 4224, v50
  v_add3_u32 v49, v49, v50, s17
  v_add_u32 v49, 4608, v49
  v_subrev_u32 v52, 896, v49
  v_subrev_u32 v53, 1856, v49
  v_subrev_u32 v54, 2816, v49
  v_subrev_u32 v55, 3776, v49
  v_subrev_u32 v56, 4736, v49
  s_waitcnt lgkmcnt(0)
  ds_read2_b32 v[92:93], v52 offset0:224 offset1:225
  ds_read2_b32 v[94:95], v52 offset0:226 offset1:227
  ds_read2_b32 v[96:97], v52 offset0:208 offset1:209
  ds_read2_b32 v[98:99], v52 offset0:210 offset1:211
  ds_read2_b32 v[100:101], v52 offset0:192 offset1:193
  ds_read2_b32 v[102:103], v52 offset0:194 offset1:195
  ds_read2_b32 v[104:105], v52 offset0:176 offset1:177
  ds_read2_b32 v[106:107], v52 offset0:178 offset1:179
  s_waitcnt lgkmcnt(6)
  v_mfma_f32_16x16x32_bf16 v[60:63], v[92:95], a[28:31], 0
  v_mfma_f32_16x16x32_bf16 v[64:67], v[92:95], a[60:63], 0
  v_mfma_f32_16x16x32_bf16 v[68:71], v[92:95], a[92:95], 0
  v_mfma_f32_16x16x32_bf16 v[72:75], v[92:95], a[124:127], 0
  v_mfma_f32_16x16x32_bf16 v[76:79], v[92:95], a[156:159], 0
  v_mfma_f32_16x16x32_bf16 v[80:83], v[92:95], a[188:191], 0
  v_mfma_f32_16x16x32_bf16 v[84:87], v[92:95], a[220:223], 0
  v_mfma_f32_16x16x32_bf16 v[88:91], v[92:95], a[252:255], 0
  ds_read2_b32 v[92:93], v52 offset0:160 offset1:161
  ds_read2_b32 v[94:95], v52 offset0:162 offset1:163
  s_waitcnt lgkmcnt(6)
  v_mfma_f32_16x16x32_bf16 v[60:63], v[96:99], a[24:27], v[60:63]
  v_mfma_f32_16x16x32_bf16 v[64:67], v[96:99], a[56:59], v[64:67]
  v_mfma_f32_16x16x32_bf16 v[68:71], v[96:99], a[88:91], v[68:71]
  v_mfma_f32_16x16x32_bf16 v[72:75], v[96:99], a[120:123], v[72:75]
  v_mfma_f32_16x16x32_bf16 v[76:79], v[96:99], a[152:155], v[76:79]
  v_mfma_f32_16x16x32_bf16 v[80:83], v[96:99], a[184:187], v[80:83]
  v_mfma_f32_16x16x32_bf16 v[84:87], v[96:99], a[216:219], v[84:87]
  v_mfma_f32_16x16x32_bf16 v[88:91], v[96:99], a[248:251], v[88:91]
  ds_read2_b32 v[96:97], v52 offset0:144 offset1:145
  ds_read2_b32 v[98:99], v52 offset0:146 offset1:147
  s_waitcnt lgkmcnt(6)
  v_mfma_f32_16x16x32_bf16 v[60:63], v[100:103], a[20:23], v[60:63]
  v_mfma_f32_16x16x32_bf16 v[64:67], v[100:103], a[52:55], v[64:67]
  v_mfma_f32_16x16x32_bf16 v[68:71], v[100:103], a[84:87], v[68:71]
  v_mfma_f32_16x16x32_bf16 v[72:75], v[100:103], a[116:119], v[72:75]
  v_mfma_f32_16x16x32_bf16 v[76:79], v[100:103], a[148:151], v[76:79]
  v_mfma_f32_16x16x32_bf16 v[80:83], v[100:103], a[180:183], v[80:83]
  v_mfma_f32_16x16x32_bf16 v[84:87], v[100:103], a[212:215], v[84:87]
  v_mfma_f32_16x16x32_bf16 v[88:91], v[100:103], a[244:247], v[88:91]
  ds_read2_b32 v[100:101], v52 offset0:128 offset1:129
  ds_read2_b32 v[102:103], v52 offset0:130 offset1:131
  s_waitcnt lgkmcnt(6)
  v_mfma_f32_16x16x32_bf16 v[60:63], v[104:107], a[16:19], v[60:63]
  v_mfma_f32_16x16x32_bf16 v[64:67], v[104:107], a[48:51], v[64:67]
  v_mfma_f32_16x16x32_bf16 v[68:71], v[104:107], a[80:83], v[68:71]
  v_mfma_f32_16x16x32_bf16 v[72:75], v[104:107], a[112:115], v[72:75]
  v_mfma_f32_16x16x32_bf16 v[76:79], v[104:107], a[144:147], v[76:79]
  v_mfma_f32_16x16x32_bf16 v[80:83], v[104:107], a[176:179], v[80:83]
  v_mfma_f32_16x16x32_bf16 v[84:87], v[104:107], a[208:211], v[84:87]
  v_mfma_f32_16x16x32_bf16 v[88:91], v[104:107], a[240:243], v[88:91]
  ds_read2_b32 v[104:105], v52 offset0:112 offset1:113
  ds_read2_b32 v[106:107], v52 offset0:114 offset1:115
  s_waitcnt lgkmcnt(6)
  v_mfma_f32_16x16x32_bf16 v[60:63], v[92:95], a[12:15], v[60:63]
  v_mfma_f32_16x16x32_bf16 v[64:67], v[92:95], a[44:47], v[64:67]
  v_mfma_f32_16x16x32_bf16 v[68:71], v[92:95], a[76:79], v[68:71]
  v_mfma_f32_16x16x32_bf16 v[72:75], v[92:95], a[108:111], v[72:75]
  v_mfma_f32_16x16x32_bf16 v[76:79], v[92:95], a[140:143], v[76:79]
  v_mfma_f32_16x16x32_bf16 v[80:83], v[92:95], a[172:175], v[80:83]
  v_mfma_f32_16x16x32_bf16 v[84:87], v[92:95], a[204:207], v[84:87]
  v_mfma_f32_16x16x32_bf16 v[88:91], v[92:95], a[236:239], v[88:91]
  ds_read2_b32 v[92:93], v52 offset0:96 offset1:97
  ds_read2_b32 v[94:95], v52 offset0:98 offset1:99
  s_waitcnt lgkmcnt(6)
  v_mfma_f32_16x16x32_bf16 v[60:63], v[96:99], a[8:11], v[60:63]
  v_mfma_f32_16x16x32_bf16 v[64:67], v[96:99], a[40:43], v[64:67]
  v_mfma_f32_16x16x32_bf16 v[68:71], v[96:99], a[72:75], v[68:71]
  v_mfma_f32_16x16x32_bf16 v[72:75], v[96:99], a[104:107], v[72:75]
  v_mfma_f32_16x16x32_bf16 v[76:79], v[96:99], a[136:139], v[76:79]
  v_mfma_f32_16x16x32_bf16 v[80:83], v[96:99], a[168:171], v[80:83]
  v_mfma_f32_16x16x32_bf16 v[84:87], v[96:99], a[200:203], v[84:87]
  v_mfma_f32_16x16x32_bf16 v[88:91], v[96:99], a[232:235], v[88:91]
  ds_read2_b32 v[96:97], v52 offset0:80 offset1:81
  ds_read2_b32 v[98:99], v52 offset0:82 offset1:83
  s_waitcnt lgkmcnt(6)
  v_mfma_f32_16x16x32_bf16 v[60:63], v[100:103], a[4:7], v[60:63]
  v_mfma_f32_16x16x32_bf16 v[64:67], v[100:103], a[36:39], v[64:67]
  v_mfma_f32_16x16x32_bf16 v[68:71], v[100:103], a[68:71], v[68:71]
  v_mfma_f32_16x16x32_bf16 v[72:75], v[100:103], a[100:103], v[72:75]
  v_mfma_f32_16x16x32_bf16 v[76:79], v[100:103], a[132:135], v[76:79]
  v_mfma_f32_16x16x32_bf16 v[80:83], v[100:103], a[164:167], v[80:83]
  v_mfma_f32_16x16x32_bf16 v[84:87], v[100:103], a[196:199], v[84:87]
  v_mfma_f32_16x16x32_bf16 v[88:91], v[100:103], a[228:231], v[88:91]
  ds_read2_b32 v[100:101], v52 offset0:64 offset1:65
  ds_read2_b32 v[102:103], v52 offset0:66 offset1:67
  s_waitcnt lgkmcnt(6)
  v_mfma_f32_16x16x32_bf16 v[60:63], v[104:107], a[0:3], v[60:63]
  v_mfma_f32_16x16x32_bf16 v[64:67], v[104:107], a[32:35], v[64:67]
  v_mfma_f32_16x16x32_bf16 v[68:71], v[104:107], a[64:67], v[68:71]
  v_mfma_f32_16x16x32_bf16 v[72:75], v[104:107], a[96:99], v[72:75]
  v_mfma_f32_16x16x32_bf16 v[76:79], v[104:107], a[128:131], v[76:79]
  v_mfma_f32_16x16x32_bf16 v[80:83], v[104:107], a[160:163], v[80:83]
  v_mfma_f32_16x16x32_bf16 v[84:87], v[104:107], a[192:195], v[84:87]
  v_mfma_f32_16x16x32_bf16 v[88:91], v[104:107], a[224:227], v[88:91]
  ds_read2_b32 v[104:105], v52 offset0:48 offset1:49
  ds_read2_b32 v[106:107], v52 offset0:50 offset1:51
  s_waitcnt lgkmcnt(6)
  v_mfma_f32_16x16x32_bf16 v[64:67], v[92:95], a[28:31], v[64:67]
  v_mfma_f32_16x16x32_bf16 v[68:71], v[92:95], a[60:63], v[68:71]
  v_mfma_f32_16x16x32_bf16 v[72:75], v[92:95], a[92:95], v[72:75]
  v_mfma_f32_16x16x32_bf16 v[76:79], v[92:95], a[124:127], v[76:79]
  v_mfma_f32_16x16x32_bf16 v[80:83], v[92:95], a[156:159], v[80:83]
  v_mfma_f32_16x16x32_bf16 v[84:87], v[92:95], a[188:191], v[84:87]
  v_mfma_f32_16x16x32_bf16 v[88:91], v[92:95], a[220:223], v[88:91]
  ds_read2_b32 v[92:93], v52 offset0:32 offset1:33
  ds_read2_b32 v[94:95], v52 offset0:34 offset1:35
  s_waitcnt lgkmcnt(6)
  v_mfma_f32_16x16x32_bf16 v[64:67], v[96:99], a[24:27], v[64:67]
  v_mfma_f32_16x16x32_bf16 v[68:71], v[96:99], a[56:59], v[68:71]
  v_mfma_f32_16x16x32_bf16 v[72:75], v[96:99], a[88:91], v[72:75]
  v_mfma_f32_16x16x32_bf16 v[76:79], v[96:99], a[120:123], v[76:79]
  v_mfma_f32_16x16x32_bf16 v[80:83], v[96:99], a[152:155], v[80:83]
  v_mfma_f32_16x16x32_bf16 v[84:87], v[96:99], a[184:187], v[84:87]
  v_mfma_f32_16x16x32_bf16 v[88:91], v[96:99], a[216:219], v[88:91]
  ds_read2_b32 v[96:97], v52 offset0:16 offset1:17
  ds_read2_b32 v[98:99], v52 offset0:18 offset1:19
  s_waitcnt lgkmcnt(6)
  v_mfma_f32_16x16x32_bf16 v[64:67], v[100:103], a[20:23], v[64:67]
  v_mfma_f32_16x16x32_bf16 v[68:71], v[100:103], a[52:55], v[68:71]
  v_mfma_f32_16x16x32_bf16 v[72:75], v[100:103], a[84:87], v[72:75]
  v_mfma_f32_16x16x32_bf16 v[76:79], v[100:103], a[116:119], v[76:79]
  v_mfma_f32_16x16x32_bf16 v[80:83], v[100:103], a[148:151], v[80:83]
  v_mfma_f32_16x16x32_bf16 v[84:87], v[100:103], a[180:183], v[84:87]
  v_mfma_f32_16x16x32_bf16 v[88:91], v[100:103], a[212:215], v[88:91]
  ds_read2_b32 v[100:101], v52 offset0:0 offset1:1
  ds_read2_b32 v[102:103], v52 offset0:2 offset1:3
  s_waitcnt lgkmcnt(6)
  v_mfma_f32_16x16x32_bf16 v[64:67], v[104:107], a[16:19], v[64:67]
  v_mfma_f32_16x16x32_bf16 v[68:71], v[104:107], a[48:51], v[68:71]
  v_mfma_f32_16x16x32_bf16 v[72:75], v[104:107], a[80:83], v[72:75]
  v_mfma_f32_16x16x32_bf16 v[76:79], v[104:107], a[112:115], v[76:79]
  v_mfma_f32_16x16x32_bf16 v[80:83], v[104:107], a[144:147], v[80:83]
  v_mfma_f32_16x16x32_bf16 v[84:87], v[104:107], a[176:179], v[84:87]
  v_mfma_f32_16x16x32_bf16 v[88:91], v[104:107], a[208:211], v[88:91]
  ds_read2_b32 v[104:105], v53 offset0:224 offset1:225
  ds_read2_b32 v[106:107], v53 offset0:226 offset1:227
  s_waitcnt lgkmcnt(6)
  v_mfma_f32_16x16x32_bf16 v[64:67], v[92:95], a[12:15], v[64:67]
  v_mfma_f32_16x16x32_bf16 v[68:71], v[92:95], a[44:47], v[68:71]
  v_mfma_f32_16x16x32_bf16 v[72:75], v[92:95], a[76:79], v[72:75]
  v_mfma_f32_16x16x32_bf16 v[76:79], v[92:95], a[108:111], v[76:79]
  v_mfma_f32_16x16x32_bf16 v[80:83], v[92:95], a[140:143], v[80:83]
  v_mfma_f32_16x16x32_bf16 v[84:87], v[92:95], a[172:175], v[84:87]
  v_mfma_f32_16x16x32_bf16 v[88:91], v[92:95], a[204:207], v[88:91]
  ds_read2_b32 v[92:93], v53 offset0:208 offset1:209
  ds_read2_b32 v[94:95], v53 offset0:210 offset1:211
  s_waitcnt lgkmcnt(6)
  v_mfma_f32_16x16x32_bf16 v[64:67], v[96:99], a[8:11], v[64:67]
  v_mfma_f32_16x16x32_bf16 v[68:71], v[96:99], a[40:43], v[68:71]
  v_mfma_f32_16x16x32_bf16 v[72:75], v[96:99], a[72:75], v[72:75]
  v_mfma_f32_16x16x32_bf16 v[76:79], v[96:99], a[104:107], v[76:79]
  v_mfma_f32_16x16x32_bf16 v[80:83], v[96:99], a[136:139], v[80:83]
  v_mfma_f32_16x16x32_bf16 v[84:87], v[96:99], a[168:171], v[84:87]
  v_mfma_f32_16x16x32_bf16 v[88:91], v[96:99], a[200:203], v[88:91]
  ds_read2_b32 v[96:97], v53 offset0:192 offset1:193
  ds_read2_b32 v[98:99], v53 offset0:194 offset1:195
  s_waitcnt lgkmcnt(6)
  v_mfma_f32_16x16x32_bf16 v[64:67], v[100:103], a[4:7], v[64:67]
  v_mfma_f32_16x16x32_bf16 v[68:71], v[100:103], a[36:39], v[68:71]
  v_mfma_f32_16x16x32_bf16 v[72:75], v[100:103], a[68:71], v[72:75]
  v_mfma_f32_16x16x32_bf16 v[76:79], v[100:103], a[100:103], v[76:79]
  v_mfma_f32_16x16x32_bf16 v[80:83], v[100:103], a[132:135], v[80:83]
  v_mfma_f32_16x16x32_bf16 v[84:87], v[100:103], a[164:167], v[84:87]
  v_mfma_f32_16x16x32_bf16 v[88:91], v[100:103], a[196:199], v[88:91]
  ds_read2_b32 v[100:101], v53 offset0:176 offset1:177
  ds_read2_b32 v[102:103], v53 offset0:178 offset1:179
  s_waitcnt lgkmcnt(6)
  v_mfma_f32_16x16x32_bf16 v[64:67], v[104:107], a[0:3], v[64:67]
  v_mfma_f32_16x16x32_bf16 v[68:71], v[104:107], a[32:35], v[68:71]
  v_mfma_f32_16x16x32_bf16 v[72:75], v[104:107], a[64:67], v[72:75]
  v_mfma_f32_16x16x32_bf16 v[76:79], v[104:107], a[96:99], v[76:79]
  v_mfma_f32_16x16x32_bf16 v[80:83], v[104:107], a[128:131], v[80:83]
  v_mfma_f32_16x16x32_bf16 v[84:87], v[104:107], a[160:163], v[84:87]
  v_mfma_f32_16x16x32_bf16 v[88:91], v[104:107], a[192:195], v[88:91]
  ds_read2_b32 v[104:105], v53 offset0:160 offset1:161
  ds_read2_b32 v[106:107], v53 offset0:162 offset1:163
  s_waitcnt lgkmcnt(6)
  v_mfma_f32_16x16x32_bf16 v[68:71], v[92:95], a[28:31], v[68:71]
  v_mfma_f32_16x16x32_bf16 v[72:75], v[92:95], a[60:63], v[72:75]
  v_mfma_f32_16x16x32_bf16 v[76:79], v[92:95], a[92:95], v[76:79]
  v_mfma_f32_16x16x32_bf16 v[80:83], v[92:95], a[124:127], v[80:83]
  v_mfma_f32_16x16x32_bf16 v[84:87], v[92:95], a[156:159], v[84:87]
  v_mfma_f32_16x16x32_bf16 v[88:91], v[92:95], a[188:191], v[88:91]
  ds_read2_b32 v[92:93], v53 offset0:144 offset1:145
  ds_read2_b32 v[94:95], v53 offset0:146 offset1:147
  s_waitcnt lgkmcnt(6)
  v_mfma_f32_16x16x32_bf16 v[68:71], v[96:99], a[24:27], v[68:71]
  v_mfma_f32_16x16x32_bf16 v[72:75], v[96:99], a[56:59], v[72:75]
  v_mfma_f32_16x16x32_bf16 v[76:79], v[96:99], a[88:91], v[76:79]
  v_mfma_f32_16x16x32_bf16 v[80:83], v[96:99], a[120:123], v[80:83]
  v_mfma_f32_16x16x32_bf16 v[84:87], v[96:99], a[152:155], v[84:87]
  v_mfma_f32_16x16x32_bf16 v[88:91], v[96:99], a[184:187], v[88:91]
  ds_read2_b32 v[96:97], v53 offset0:128 offset1:129
  ds_read2_b32 v[98:99], v53 offset0:130 offset1:131
  s_waitcnt lgkmcnt(6)
  v_mfma_f32_16x16x32_bf16 v[68:71], v[100:103], a[20:23], v[68:71]
  v_mfma_f32_16x16x32_bf16 v[72:75], v[100:103], a[52:55], v[72:75]
  v_mfma_f32_16x16x32_bf16 v[76:79], v[100:103], a[84:87], v[76:79]
  v_mfma_f32_16x16x32_bf16 v[80:83], v[100:103], a[116:119], v[80:83]
  v_mfma_f32_16x16x32_bf16 v[84:87], v[100:103], a[148:151], v[84:87]
  v_mfma_f32_16x16x32_bf16 v[88:91], v[100:103], a[180:183], v[88:91]
  ds_read2_b32 v[100:101], v53 offset0:112 offset1:113
  ds_read2_b32 v[102:103], v53 offset0:114 offset1:115
  s_waitcnt lgkmcnt(6)
  v_mfma_f32_16x16x32_bf16 v[68:71], v[104:107], a[16:19], v[68:71]
  v_mfma_f32_16x16x32_bf16 v[72:75], v[104:107], a[48:51], v[72:75]
  v_mfma_f32_16x16x32_bf16 v[76:79], v[104:107], a[80:83], v[76:79]
  v_mfma_f32_16x16x32_bf16 v[80:83], v[104:107], a[112:115], v[80:83]
  v_mfma_f32_16x16x32_bf16 v[84:87], v[104:107], a[144:147], v[84:87]
  v_mfma_f32_16x16x32_bf16 v[88:91], v[104:107], a[176:179], v[88:91]
  ds_read2_b32 v[104:105], v53 offset0:96 offset1:97
  ds_read2_b32 v[106:107], v53 offset0:98 offset1:99
  s_waitcnt lgkmcnt(6)
  v_mfma_f32_16x16x32_bf16 v[68:71], v[92:95], a[12:15], v[68:71]
  v_mfma_f32_16x16x32_bf16 v[72:75], v[92:95], a[44:47], v[72:75]
  v_mfma_f32_16x16x32_bf16 v[76:79], v[92:95], a[76:79], v[76:79]
  v_mfma_f32_16x16x32_bf16 v[80:83], v[92:95], a[108:111], v[80:83]
  v_mfma_f32_16x16x32_bf16 v[84:87], v[92:95], a[140:143], v[84:87]
  v_mfma_f32_16x16x32_bf16 v[88:91], v[92:95], a[172:175], v[88:91]
  ds_read2_b32 v[92:93], v53 offset0:80 offset1:81
  ds_read2_b32 v[94:95], v53 offset0:82 offset1:83
  s_waitcnt lgkmcnt(6)
  v_mfma_f32_16x16x32_bf16 v[68:71], v[96:99], a[8:11], v[68:71]
  v_mfma_f32_16x16x32_bf16 v[72:75], v[96:99], a[40:43], v[72:75]
  v_mfma_f32_16x16x32_bf16 v[76:79], v[96:99], a[72:75], v[76:79]
  v_mfma_f32_16x16x32_bf16 v[80:83], v[96:99], a[104:107], v[80:83]
  v_mfma_f32_16x16x32_bf16 v[84:87], v[96:99], a[136:139], v[84:87]
  v_mfma_f32_16x16x32_bf16 v[88:91], v[96:99], a[168:171], v[88:91]
  ds_read2_b32 v[96:97], v53 offset0:64 offset1:65
  ds_read2_b32 v[98:99], v53 offset0:66 offset1:67
  s_waitcnt lgkmcnt(6)
  v_mfma_f32_16x16x32_bf16 v[68:71], v[100:103], a[4:7], v[68:71]
  v_mfma_f32_16x16x32_bf16 v[72:75], v[100:103], a[36:39], v[72:75]
  v_mfma_f32_16x16x32_bf16 v[76:79], v[100:103], a[68:71], v[76:79]
  v_mfma_f32_16x16x32_bf16 v[80:83], v[100:103], a[100:103], v[80:83]
  v_mfma_f32_16x16x32_bf16 v[84:87], v[100:103], a[132:135], v[84:87]
  v_mfma_f32_16x16x32_bf16 v[88:91], v[100:103], a[164:167], v[88:91]
  ds_read2_b32 v[100:101], v53 offset0:48 offset1:49
  ds_read2_b32 v[102:103], v53 offset0:50 offset1:51
  s_waitcnt lgkmcnt(6)
  v_mfma_f32_16x16x32_bf16 v[68:71], v[104:107], a[0:3], v[68:71]
  v_mfma_f32_16x16x32_bf16 v[72:75], v[104:107], a[32:35], v[72:75]
  v_mfma_f32_16x16x32_bf16 v[76:79], v[104:107], a[64:67], v[76:79]
  v_mfma_f32_16x16x32_bf16 v[80:83], v[104:107], a[96:99], v[80:83]
  v_mfma_f32_16x16x32_bf16 v[84:87], v[104:107], a[128:131], v[84:87]
  v_mfma_f32_16x16x32_bf16 v[88:91], v[104:107], a[160:163], v[88:91]
  ds_read2_b32 v[104:105], v53 offset0:32 offset1:33
  ds_read2_b32 v[106:107], v53 offset0:34 offset1:35
  s_waitcnt lgkmcnt(6)
  v_mfma_f32_16x16x32_bf16 v[72:75], v[92:95], a[28:31], v[72:75]
  v_mfma_f32_16x16x32_bf16 v[76:79], v[92:95], a[60:63], v[76:79]
  v_mfma_f32_16x16x32_bf16 v[80:83], v[92:95], a[92:95], v[80:83]
  v_mfma_f32_16x16x32_bf16 v[84:87], v[92:95], a[124:127], v[84:87]
  v_mfma_f32_16x16x32_bf16 v[88:91], v[92:95], a[156:159], v[88:91]
  ds_read2_b32 v[92:93], v53 offset0:16 offset1:17
  ds_read2_b32 v[94:95], v53 offset0:18 offset1:19
  s_waitcnt lgkmcnt(6)
  v_mfma_f32_16x16x32_bf16 v[72:75], v[96:99], a[24:27], v[72:75]
  v_mfma_f32_16x16x32_bf16 v[76:79], v[96:99], a[56:59], v[76:79]
  v_mfma_f32_16x16x32_bf16 v[80:83], v[96:99], a[88:91], v[80:83]
  v_mfma_f32_16x16x32_bf16 v[84:87], v[96:99], a[120:123], v[84:87]
  v_mfma_f32_16x16x32_bf16 v[88:91], v[96:99], a[152:155], v[88:91]
  ds_read2_b32 v[96:97], v53 offset0:0 offset1:1
  ds_read2_b32 v[98:99], v53 offset0:2 offset1:3
  s_waitcnt lgkmcnt(6)
  v_mfma_f32_16x16x32_bf16 v[72:75], v[100:103], a[20:23], v[72:75]
  v_mfma_f32_16x16x32_bf16 v[76:79], v[100:103], a[52:55], v[76:79]
  v_mfma_f32_16x16x32_bf16 v[80:83], v[100:103], a[84:87], v[80:83]
  v_mfma_f32_16x16x32_bf16 v[84:87], v[100:103], a[116:119], v[84:87]
  v_mfma_f32_16x16x32_bf16 v[88:91], v[100:103], a[148:151], v[88:91]
  ds_read2_b32 v[100:101], v54 offset0:224 offset1:225
  ds_read2_b32 v[102:103], v54 offset0:226 offset1:227
  s_waitcnt lgkmcnt(6)
  v_mfma_f32_16x16x32_bf16 v[72:75], v[104:107], a[16:19], v[72:75]
  v_mfma_f32_16x16x32_bf16 v[76:79], v[104:107], a[48:51], v[76:79]
  v_mfma_f32_16x16x32_bf16 v[80:83], v[104:107], a[80:83], v[80:83]
  v_mfma_f32_16x16x32_bf16 v[84:87], v[104:107], a[112:115], v[84:87]
  v_mfma_f32_16x16x32_bf16 v[88:91], v[104:107], a[144:147], v[88:91]
  ds_read2_b32 v[104:105], v54 offset0:208 offset1:209
  ds_read2_b32 v[106:107], v54 offset0:210 offset1:211
  s_waitcnt lgkmcnt(6)
  v_mfma_f32_16x16x32_bf16 v[72:75], v[92:95], a[12:15], v[72:75]
  v_mfma_f32_16x16x32_bf16 v[76:79], v[92:95], a[44:47], v[76:79]
  v_mfma_f32_16x16x32_bf16 v[80:83], v[92:95], a[76:79], v[80:83]
  v_mfma_f32_16x16x32_bf16 v[84:87], v[92:95], a[108:111], v[84:87]
  v_mfma_f32_16x16x32_bf16 v[88:91], v[92:95], a[140:143], v[88:91]
  ds_read2_b32 v[92:93], v54 offset0:192 offset1:193
  ds_read2_b32 v[94:95], v54 offset0:194 offset1:195
  s_waitcnt lgkmcnt(6)
  v_mfma_f32_16x16x32_bf16 v[72:75], v[96:99], a[8:11], v[72:75]
  v_mfma_f32_16x16x32_bf16 v[76:79], v[96:99], a[40:43], v[76:79]
  v_mfma_f32_16x16x32_bf16 v[80:83], v[96:99], a[72:75], v[80:83]
  v_mfma_f32_16x16x32_bf16 v[84:87], v[96:99], a[104:107], v[84:87]
  v_mfma_f32_16x16x32_bf16 v[88:91], v[96:99], a[136:139], v[88:91]
  ds_read2_b32 v[96:97], v54 offset0:176 offset1:177
  ds_read2_b32 v[98:99], v54 offset0:178 offset1:179
  s_waitcnt lgkmcnt(6)
  v_mfma_f32_16x16x32_bf16 v[72:75], v[100:103], a[4:7], v[72:75]
  v_mfma_f32_16x16x32_bf16 v[76:79], v[100:103], a[36:39], v[76:79]
  v_mfma_f32_16x16x32_bf16 v[80:83], v[100:103], a[68:71], v[80:83]
  v_mfma_f32_16x16x32_bf16 v[84:87], v[100:103], a[100:103], v[84:87]
  v_mfma_f32_16x16x32_bf16 v[88:91], v[100:103], a[132:135], v[88:91]
  ds_read2_b32 v[100:101], v54 offset0:160 offset1:161
  ds_read2_b32 v[102:103], v54 offset0:162 offset1:163
  s_waitcnt lgkmcnt(6)
  v_mfma_f32_16x16x32_bf16 v[72:75], v[104:107], a[0:3], v[72:75]
  v_mfma_f32_16x16x32_bf16 v[76:79], v[104:107], a[32:35], v[76:79]
  v_mfma_f32_16x16x32_bf16 v[80:83], v[104:107], a[64:67], v[80:83]
  v_mfma_f32_16x16x32_bf16 v[84:87], v[104:107], a[96:99], v[84:87]
  v_mfma_f32_16x16x32_bf16 v[88:91], v[104:107], a[128:131], v[88:91]
  ds_read2_b32 v[104:105], v54 offset0:144 offset1:145
  ds_read2_b32 v[106:107], v54 offset0:146 offset1:147
  s_waitcnt lgkmcnt(6)
  v_mfma_f32_16x16x32_bf16 v[76:79], v[92:95], a[28:31], v[76:79]
  v_mfma_f32_16x16x32_bf16 v[80:83], v[92:95], a[60:63], v[80:83]
  v_mfma_f32_16x16x32_bf16 v[84:87], v[92:95], a[92:95], v[84:87]
  v_mfma_f32_16x16x32_bf16 v[88:91], v[92:95], a[124:127], v[88:91]
  ds_read2_b32 v[92:93], v54 offset0:128 offset1:129
  ds_read2_b32 v[94:95], v54 offset0:130 offset1:131
  s_waitcnt lgkmcnt(6)
  v_mfma_f32_16x16x32_bf16 v[76:79], v[96:99], a[24:27], v[76:79]
  v_mfma_f32_16x16x32_bf16 v[80:83], v[96:99], a[56:59], v[80:83]
  v_mfma_f32_16x16x32_bf16 v[84:87], v[96:99], a[88:91], v[84:87]
  v_mfma_f32_16x16x32_bf16 v[88:91], v[96:99], a[120:123], v[88:91]
  ds_read2_b32 v[96:97], v54 offset0:112 offset1:113
  ds_read2_b32 v[98:99], v54 offset0:114 offset1:115
  s_waitcnt lgkmcnt(6)
  v_mfma_f32_16x16x32_bf16 v[76:79], v[100:103], a[20:23], v[76:79]
  v_mfma_f32_16x16x32_bf16 v[80:83], v[100:103], a[52:55], v[80:83]
  v_mfma_f32_16x16x32_bf16 v[84:87], v[100:103], a[84:87], v[84:87]
  v_mfma_f32_16x16x32_bf16 v[88:91], v[100:103], a[116:119], v[88:91]
  ds_read2_b32 v[100:101], v54 offset0:96 offset1:97
  ds_read2_b32 v[102:103], v54 offset0:98 offset1:99
  s_waitcnt lgkmcnt(6)
  v_mfma_f32_16x16x32_bf16 v[76:79], v[104:107], a[16:19], v[76:79]
  v_mfma_f32_16x16x32_bf16 v[80:83], v[104:107], a[48:51], v[80:83]
  v_mfma_f32_16x16x32_bf16 v[84:87], v[104:107], a[80:83], v[84:87]
  v_mfma_f32_16x16x32_bf16 v[88:91], v[104:107], a[112:115], v[88:91]
  ds_read2_b32 v[104:105], v54 offset0:80 offset1:81
  ds_read2_b32 v[106:107], v54 offset0:82 offset1:83
  s_waitcnt lgkmcnt(6)
  v_mfma_f32_16x16x32_bf16 v[76:79], v[92:95], a[12:15], v[76:79]
  v_mfma_f32_16x16x32_bf16 v[80:83], v[92:95], a[44:47], v[80:83]
  v_mfma_f32_16x16x32_bf16 v[84:87], v[92:95], a[76:79], v[84:87]
  v_mfma_f32_16x16x32_bf16 v[88:91], v[92:95], a[108:111], v[88:91]
  ds_read2_b32 v[92:93], v54 offset0:64 offset1:65
  ds_read2_b32 v[94:95], v54 offset0:66 offset1:67
  s_waitcnt lgkmcnt(6)
  v_mfma_f32_16x16x32_bf16 v[76:79], v[96:99], a[8:11], v[76:79]
  v_mfma_f32_16x16x32_bf16 v[80:83], v[96:99], a[40:43], v[80:83]
  v_mfma_f32_16x16x32_bf16 v[84:87], v[96:99], a[72:75], v[84:87]
  v_mfma_f32_16x16x32_bf16 v[88:91], v[96:99], a[104:107], v[88:91]
  ds_read2_b32 v[96:97], v54 offset0:48 offset1:49
  ds_read2_b32 v[98:99], v54 offset0:50 offset1:51
  s_waitcnt lgkmcnt(6)
  v_mfma_f32_16x16x32_bf16 v[76:79], v[100:103], a[4:7], v[76:79]
  v_mfma_f32_16x16x32_bf16 v[80:83], v[100:103], a[36:39], v[80:83]
  v_mfma_f32_16x16x32_bf16 v[84:87], v[100:103], a[68:71], v[84:87]
  v_mfma_f32_16x16x32_bf16 v[88:91], v[100:103], a[100:103], v[88:91]
  ds_read2_b32 v[100:101], v54 offset0:32 offset1:33
  ds_read2_b32 v[102:103], v54 offset0:34 offset1:35
  s_waitcnt lgkmcnt(6)
  v_mfma_f32_16x16x32_bf16 v[76:79], v[104:107], a[0:3], v[76:79]
  v_mfma_f32_16x16x32_bf16 v[80:83], v[104:107], a[32:35], v[80:83]
  v_mfma_f32_16x16x32_bf16 v[84:87], v[104:107], a[64:67], v[84:87]
  v_mfma_f32_16x16x32_bf16 v[88:91], v[104:107], a[96:99], v[88:91]
  ds_read2_b32 v[104:105], v54 offset0:16 offset1:17
  ds_read2_b32 v[106:107], v54 offset0:18 offset1:19
  s_waitcnt lgkmcnt(6)
  v_mfma_f32_16x16x32_bf16 v[80:83], v[92:95], a[28:31], v[80:83]
  v_mfma_f32_16x16x32_bf16 v[84:87], v[92:95], a[60:63], v[84:87]
  v_mfma_f32_16x16x32_bf16 v[88:91], v[92:95], a[92:95], v[88:91]
  ds_read2_b32 v[92:93], v54 offset0:0 offset1:1
  ds_read2_b32 v[94:95], v54 offset0:2 offset1:3
  s_waitcnt lgkmcnt(6)
  v_mfma_f32_16x16x32_bf16 v[80:83], v[96:99], a[24:27], v[80:83]
  v_mfma_f32_16x16x32_bf16 v[84:87], v[96:99], a[56:59], v[84:87]
  v_mfma_f32_16x16x32_bf16 v[88:91], v[96:99], a[88:91], v[88:91]
  ds_read2_b32 v[96:97], v55 offset0:224 offset1:225
  ds_read2_b32 v[98:99], v55 offset0:226 offset1:227
  s_waitcnt lgkmcnt(6)
  v_mfma_f32_16x16x32_bf16 v[80:83], v[100:103], a[20:23], v[80:83]
  v_mfma_f32_16x16x32_bf16 v[84:87], v[100:103], a[52:55], v[84:87]
  v_mfma_f32_16x16x32_bf16 v[88:91], v[100:103], a[84:87], v[88:91]
  ds_read2_b32 v[100:101], v55 offset0:208 offset1:209
  ds_read2_b32 v[102:103], v55 offset0:210 offset1:211
  s_waitcnt lgkmcnt(6)
  v_mfma_f32_16x16x32_bf16 v[80:83], v[104:107], a[16:19], v[80:83]
  v_mfma_f32_16x16x32_bf16 v[84:87], v[104:107], a[48:51], v[84:87]
  v_mfma_f32_16x16x32_bf16 v[88:91], v[104:107], a[80:83], v[88:91]
  ds_read2_b32 v[104:105], v55 offset0:192 offset1:193
  ds_read2_b32 v[106:107], v55 offset0:194 offset1:195
  s_waitcnt lgkmcnt(6)
  v_mfma_f32_16x16x32_bf16 v[80:83], v[92:95], a[12:15], v[80:83]
  v_mfma_f32_16x16x32_bf16 v[84:87], v[92:95], a[44:47], v[84:87]
  v_mfma_f32_16x16x32_bf16 v[88:91], v[92:95], a[76:79], v[88:91]
  ds_read2_b32 v[92:93], v55 offset0:176 offset1:177
  ds_read2_b32 v[94:95], v55 offset0:178 offset1:179
  s_waitcnt lgkmcnt(6)
  v_mfma_f32_16x16x32_bf16 v[80:83], v[96:99], a[8:11], v[80:83]
  v_mfma_f32_16x16x32_bf16 v[84:87], v[96:99], a[40:43], v[84:87]
  v_mfma_f32_16x16x32_bf16 v[88:91], v[96:99], a[72:75], v[88:91]
  ds_read2_b32 v[96:97], v55 offset0:160 offset1:161
  ds_read2_b32 v[98:99], v55 offset0:162 offset1:163
  s_waitcnt lgkmcnt(6)
  v_mfma_f32_16x16x32_bf16 v[80:83], v[100:103], a[4:7], v[80:83]
  v_mfma_f32_16x16x32_bf16 v[84:87], v[100:103], a[36:39], v[84:87]
  v_mfma_f32_16x16x32_bf16 v[88:91], v[100:103], a[68:71], v[88:91]
  ds_read2_b32 v[100:101], v55 offset0:144 offset1:145
  ds_read2_b32 v[102:103], v55 offset0:146 offset1:147
  s_waitcnt lgkmcnt(6)
  v_mfma_f32_16x16x32_bf16 v[80:83], v[104:107], a[0:3], v[80:83]
  v_mfma_f32_16x16x32_bf16 v[84:87], v[104:107], a[32:35], v[84:87]
  v_mfma_f32_16x16x32_bf16 v[88:91], v[104:107], a[64:67], v[88:91]
  ds_read2_b32 v[104:105], v55 offset0:128 offset1:129
  ds_read2_b32 v[106:107], v55 offset0:130 offset1:131
  s_waitcnt lgkmcnt(6)
  v_mfma_f32_16x16x32_bf16 v[84:87], v[92:95], a[28:31], v[84:87]
  v_mfma_f32_16x16x32_bf16 v[88:91], v[92:95], a[60:63], v[88:91]
  ds_read2_b32 v[92:93], v55 offset0:112 offset1:113
  ds_read2_b32 v[94:95], v55 offset0:114 offset1:115
  s_waitcnt lgkmcnt(6)
  v_mfma_f32_16x16x32_bf16 v[84:87], v[96:99], a[24:27], v[84:87]
  v_mfma_f32_16x16x32_bf16 v[88:91], v[96:99], a[56:59], v[88:91]
  ds_read2_b32 v[96:97], v55 offset0:96 offset1:97
  ds_read2_b32 v[98:99], v55 offset0:98 offset1:99
  s_waitcnt lgkmcnt(6)
  v_mfma_f32_16x16x32_bf16 v[84:87], v[100:103], a[20:23], v[84:87]
  v_mfma_f32_16x16x32_bf16 v[88:91], v[100:103], a[52:55], v[88:91]
  ds_read2_b32 v[100:101], v55 offset0:80 offset1:81
  ds_read2_b32 v[102:103], v55 offset0:82 offset1:83
  s_waitcnt lgkmcnt(6)
  v_mfma_f32_16x16x32_bf16 v[84:87], v[104:107], a[16:19], v[84:87]
  v_mfma_f32_16x16x32_bf16 v[88:91], v[104:107], a[48:51], v[88:91]
  ds_read2_b32 v[104:105], v55 offset0:64 offset1:65
  ds_read2_b32 v[106:107], v55 offset0:66 offset1:67
  s_waitcnt lgkmcnt(6)
  v_mfma_f32_16x16x32_bf16 v[84:87], v[92:95], a[12:15], v[84:87]
  v_mfma_f32_16x16x32_bf16 v[88:91], v[92:95], a[44:47], v[88:91]
  ds_read2_b32 v[92:93], v55 offset0:48 offset1:49
  ds_read2_b32 v[94:95], v55 offset0:50 offset1:51
  s_waitcnt lgkmcnt(6)
  v_mfma_f32_16x16x32_bf16 v[84:87], v[96:99], a[8:11], v[84:87]
  v_mfma_f32_16x16x32_bf16 v[88:91], v[96:99], a[40:43], v[88:91]
  ds_read2_b32 v[96:97], v55 offset0:32 offset1:33
  ds_read2_b32 v[98:99], v55 offset0:34 offset1:35
  s_waitcnt lgkmcnt(6)
  v_mfma_f32_16x16x32_bf16 v[84:87], v[100:103], a[4:7], v[84:87]
  v_mfma_f32_16x16x32_bf16 v[88:91], v[100:103], a[36:39], v[88:91]
  ds_read2_b32 v[100:101], v55 offset0:16 offset1:17
  ds_read2_b32 v[102:103], v55 offset0:18 offset1:19
  s_waitcnt lgkmcnt(6)
  v_mfma_f32_16x16x32_bf16 v[84:87], v[104:107], a[0:3], v[84:87]
  v_mfma_f32_16x16x32_bf16 v[88:91], v[104:107], a[32:35], v[88:91]
  ds_read2_b32 v[104:105], v55 offset0:0 offset1:1
  ds_read2_b32 v[106:107], v55 offset0:2 offset1:3
  s_waitcnt lgkmcnt(6)
  v_mfma_f32_16x16x32_bf16 v[88:91], v[92:95], a[28:31], v[88:91]
  ds_read2_b32 v[92:93], v56 offset0:224 offset1:225
  ds_read2_b32 v[94:95], v56 offset0:226 offset1:227
  s_waitcnt lgkmcnt(6)
  v_mfma_f32_16x16x32_bf16 v[88:91], v[96:99], a[24:27], v[88:91]
  ds_read2_b32 v[96:97], v56 offset0:208 offset1:209
  ds_read2_b32 v[98:99], v56 offset0:210 offset1:211
  s_waitcnt lgkmcnt(6)
  v_mfma_f32_16x16x32_bf16 v[88:91], v[100:103], a[20:23], v[88:91]
  ds_read2_b32 v[100:101], v56 offset0:192 offset1:193
  ds_read2_b32 v[102:103], v56 offset0:194 offset1:195
  s_waitcnt lgkmcnt(6)
  v_mfma_f32_16x16x32_bf16 v[88:91], v[104:107], a[16:19], v[88:91]
  ds_read2_b32 v[104:105], v56 offset0:176 offset1:177
  ds_read2_b32 v[106:107], v56 offset0:178 offset1:179
  s_waitcnt lgkmcnt(6)
  v_mfma_f32_16x16x32_bf16 v[88:91], v[92:95], a[12:15], v[88:91]
  s_waitcnt lgkmcnt(4)
  v_mfma_f32_16x16x32_bf16 v[88:91], v[96:99], a[8:11], v[88:91]
  s_waitcnt lgkmcnt(2)
  v_mfma_f32_16x16x32_bf16 v[88:91], v[100:103], a[4:7], v[88:91]
  s_waitcnt lgkmcnt(0)
  v_mfma_f32_16x16x32_bf16 v[88:91], v[104:107], a[0:3], v[88:91]
  v_lshlrev_b32 v46, 5, v4
  v_lshl_add_u32 v46, v3, 3, v46
  v_add_u32 v46, s17, v46
  ds_read_b64 v[108:109], v46 offset:512
  ds_read_b64 v[110:111], v46 offset:1024
  ds_read_b64 v[112:113], v46 offset:1536
  ds_read_b64 v[114:115], v46 offset:2048
  ds_read_b64 v[116:117], v46 offset:2560
  ds_read_b64 v[118:119], v46 offset:3072
  ds_read_b64 v[120:121], v46 offset:3584
  ds_read_b64 v[122:123], v46 offset:4096
  s_waitcnt lgkmcnt(0)
  v_lshlrev_b32 v124, 16, v108
  v_and_b32 v125, 0xffff0000, v108
  v_lshlrev_b32 v126, 16, v109
  v_and_b32 v127, 0xffff0000, v109
  v_mul_f32 v124, v124, v33
  v_mul_f32 v125, v125, v33
  v_mul_f32 v126, v126, v33
  v_mul_f32 v127, v127, v33
  v_cvt_pk_bf16_f32 v128, v124, v125
  v_cvt_pk_bf16_f32 v129, v126, v127
  v_cvt_pk_bf16_f32 v130, v60, v61
  v_cvt_pk_bf16_f32 v131, v62, v63
  v_lshlrev_b32 v124, 16, v128
  v_and_b32 v125, 0xffff0000, v128
  v_lshlrev_b32 v132, 16, v130
  v_and_b32 v133, 0xffff0000, v130
  v_lshlrev_b32 v126, 16, v129
  v_and_b32 v127, 0xffff0000, v129
  v_lshlrev_b32 v134, 16, v131
  v_and_b32 v135, 0xffff0000, v131
  v_add_f32 v124, v124, v132
  v_add_f32 v125, v125, v133
  v_add_f32 v126, v126, v134
  v_add_f32 v127, v127, v135
  v_cvt_pk_bf16_f32 v108, v124, v125
  v_cvt_pk_bf16_f32 v109, v126, v127
  ds_write_b64 v46, v[108:109] offset:512
  v_lshlrev_b32 v124, 16, v110
  v_and_b32 v125, 0xffff0000, v110
  v_lshlrev_b32 v126, 16, v111
  v_and_b32 v127, 0xffff0000, v111
  v_mul_f32 v124, v124, v33
  v_mul_f32 v125, v125, v33
  v_mul_f32 v126, v126, v33
  v_mul_f32 v127, v127, v33
  v_cvt_pk_bf16_f32 v128, v124, v125
  v_cvt_pk_bf16_f32 v129, v126, v127
  v_cvt_pk_bf16_f32 v130, v64, v65
  v_cvt_pk_bf16_f32 v131, v66, v67
  v_lshlrev_b32 v124, 16, v128
  v_and_b32 v125, 0xffff0000, v128
  v_lshlrev_b32 v132, 16, v130
  v_and_b32 v133, 0xffff0000, v130
  v_lshlrev_b32 v126, 16, v129
  v_and_b32 v127, 0xffff0000, v129
  v_lshlrev_b32 v134, 16, v131
  v_and_b32 v135, 0xffff0000, v131
  v_add_f32 v124, v124, v132
  v_add_f32 v125, v125, v133
  v_add_f32 v126, v126, v134
  v_add_f32 v127, v127, v135
  v_cvt_pk_bf16_f32 v110, v124, v125
  v_cvt_pk_bf16_f32 v111, v126, v127
  ds_write_b64 v46, v[110:111] offset:1024
  v_lshlrev_b32 v124, 16, v112
  v_and_b32 v125, 0xffff0000, v112
  v_lshlrev_b32 v126, 16, v113
  v_and_b32 v127, 0xffff0000, v113
  v_mul_f32 v124, v124, v33
  v_mul_f32 v125, v125, v33
  v_mul_f32 v126, v126, v33
  v_mul_f32 v127, v127, v33
  v_cvt_pk_bf16_f32 v128, v124, v125
  v_cvt_pk_bf16_f32 v129, v126, v127
  v_cvt_pk_bf16_f32 v130, v68, v69
  v_cvt_pk_bf16_f32 v131, v70, v71
  v_lshlrev_b32 v124, 16, v128
  v_and_b32 v125, 0xffff0000, v128
  v_lshlrev_b32 v132, 16, v130
  v_and_b32 v133, 0xffff0000, v130
  v_lshlrev_b32 v126, 16, v129
  v_and_b32 v127, 0xffff0000, v129
  v_lshlrev_b32 v134, 16, v131
  v_and_b32 v135, 0xffff0000, v131
  v_add_f32 v124, v124, v132
  v_add_f32 v125, v125, v133
  v_add_f32 v126, v126, v134
  v_add_f32 v127, v127, v135
  v_cvt_pk_bf16_f32 v112, v124, v125
  v_cvt_pk_bf16_f32 v113, v126, v127
  ds_write_b64 v46, v[112:113] offset:1536
  v_lshlrev_b32 v124, 16, v114
  v_and_b32 v125, 0xffff0000, v114
  v_lshlrev_b32 v126, 16, v115
  v_and_b32 v127, 0xffff0000, v115
  v_mul_f32 v124, v124, v33
  v_mul_f32 v125, v125, v33
  v_mul_f32 v126, v126, v33
  v_mul_f32 v127, v127, v33
  v_cvt_pk_bf16_f32 v128, v124, v125
  v_cvt_pk_bf16_f32 v129, v126, v127
  v_cvt_pk_bf16_f32 v130, v72, v73
  v_cvt_pk_bf16_f32 v131, v74, v75
  v_lshlrev_b32 v124, 16, v128
  v_and_b32 v125, 0xffff0000, v128
  v_lshlrev_b32 v132, 16, v130
  v_and_b32 v133, 0xffff0000, v130
  v_lshlrev_b32 v126, 16, v129
  v_and_b32 v127, 0xffff0000, v129
  v_lshlrev_b32 v134, 16, v131
  v_and_b32 v135, 0xffff0000, v131
  v_add_f32 v124, v124, v132
  v_add_f32 v125, v125, v133
  v_add_f32 v126, v126, v134
  v_add_f32 v127, v127, v135
  v_cvt_pk_bf16_f32 v114, v124, v125
  v_cvt_pk_bf16_f32 v115, v126, v127
  ds_write_b64 v46, v[114:115] offset:2048
  v_lshlrev_b32 v124, 16, v116
  v_and_b32 v125, 0xffff0000, v116
  v_lshlrev_b32 v126, 16, v117
  v_and_b32 v127, 0xffff0000, v117
  v_mul_f32 v124, v124, v33
  v_mul_f32 v125, v125, v33
  v_mul_f32 v126, v126, v33
  v_mul_f32 v127, v127, v33
  v_cvt_pk_bf16_f32 v128, v124, v125
  v_cvt_pk_bf16_f32 v129, v126, v127
  v_cvt_pk_bf16_f32 v130, v76, v77
  v_cvt_pk_bf16_f32 v131, v78, v79
  v_lshlrev_b32 v124, 16, v128
  v_and_b32 v125, 0xffff0000, v128
  v_lshlrev_b32 v132, 16, v130
  v_and_b32 v133, 0xffff0000, v130
  v_lshlrev_b32 v126, 16, v129
  v_and_b32 v127, 0xffff0000, v129
  v_lshlrev_b32 v134, 16, v131
  v_and_b32 v135, 0xffff0000, v131
  v_add_f32 v124, v124, v132
  v_add_f32 v125, v125, v133
  v_add_f32 v126, v126, v134
  v_add_f32 v127, v127, v135
  v_cvt_pk_bf16_f32 v116, v124, v125
  v_cvt_pk_bf16_f32 v117, v126, v127
  ds_write_b64 v46, v[116:117] offset:2560
  v_lshlrev_b32 v124, 16, v118
  v_and_b32 v125, 0xffff0000, v118
  v_lshlrev_b32 v126, 16, v119
  v_and_b32 v127, 0xffff0000, v119
  v_mul_f32 v124, v124, v33
  v_mul_f32 v125, v125, v33
  v_mul_f32 v126, v126, v33
  v_mul_f32 v127, v127, v33
  v_cvt_pk_bf16_f32 v128, v124, v125
  v_cvt_pk_bf16_f32 v129, v126, v127
  v_cvt_pk_bf16_f32 v130, v80, v81
  v_cvt_pk_bf16_f32 v131, v82, v83
  v_lshlrev_b32 v124, 16, v128
  v_and_b32 v125, 0xffff0000, v128
  v_lshlrev_b32 v132, 16, v130
  v_and_b32 v133, 0xffff0000, v130
  v_lshlrev_b32 v126, 16, v129
  v_and_b32 v127, 0xffff0000, v129
  v_lshlrev_b32 v134, 16, v131
  v_and_b32 v135, 0xffff0000, v131
  v_add_f32 v124, v124, v132
  v_add_f32 v125, v125, v133
  v_add_f32 v126, v126, v134
  v_add_f32 v127, v127, v135
  v_cvt_pk_bf16_f32 v118, v124, v125
  v_cvt_pk_bf16_f32 v119, v126, v127
  ds_write_b64 v46, v[118:119] offset:3072
  v_lshlrev_b32 v124, 16, v120
  v_and_b32 v125, 0xffff0000, v120
  v_lshlrev_b32 v126, 16, v121
  v_and_b32 v127, 0xffff0000, v121
  v_mul_f32 v124, v124, v33
  v_mul_f32 v125, v125, v33
  v_mul_f32 v126, v126, v33
  v_mul_f32 v127, v127, v33
  v_cvt_pk_bf16_f32 v128, v124, v125
  v_cvt_pk_bf16_f32 v129, v126, v127
  v_cvt_pk_bf16_f32 v130, v84, v85
  v_cvt_pk_bf16_f32 v131, v86, v87
  v_lshlrev_b32 v124, 16, v128
  v_and_b32 v125, 0xffff0000, v128
  v_lshlrev_b32 v132, 16, v130
  v_and_b32 v133, 0xffff0000, v130
  v_lshlrev_b32 v126, 16, v129
  v_and_b32 v127, 0xffff0000, v129
  v_lshlrev_b32 v134, 16, v131
  v_and_b32 v135, 0xffff0000, v131
  v_add_f32 v124, v124, v132
  v_add_f32 v125, v125, v133
  v_add_f32 v126, v126, v134
  v_add_f32 v127, v127, v135
  v_cvt_pk_bf16_f32 v120, v124, v125
  v_cvt_pk_bf16_f32 v121, v126, v127
  ds_write_b64 v46, v[120:121] offset:3584
  v_lshlrev_b32 v124, 16, v122
  v_and_b32 v125, 0xffff0000, v122
  v_lshlrev_b32 v126, 16, v123
  v_and_b32 v127, 0xffff0000, v123
  v_mul_f32 v124, v124, v33
  v_mul_f32 v125, v125, v33
  v_mul_f32 v126, v126, v33
  v_mul_f32 v127, v127, v33
  v_cvt_pk_bf16_f32 v128, v124, v125
  v_cvt_pk_bf16_f32 v129, v126, v127
  v_cvt_pk_bf16_f32 v130, v88, v89
  v_cvt_pk_bf16_f32 v131, v90, v91
  v_lshlrev_b32 v124, 16, v128
  v_and_b32 v125, 0xffff0000, v128
  v_lshlrev_b32 v132, 16, v130
  v_and_b32 v133, 0xffff0000, v130
  v_lshlrev_b32 v126, 16, v129
  v_and_b32 v127, 0xffff0000, v129
  v_lshlrev_b32 v134, 16, v131
  v_and_b32 v135, 0xffff0000, v131
  v_add_f32 v124, v124, v132
  v_add_f32 v125, v125, v133
  v_add_f32 v126, v126, v134
  v_add_f32 v127, v127, v135
  v_cvt_pk_bf16_f32 v122, v124, v125
  v_cvt_pk_bf16_f32 v123, v126, v127
  ds_write_b64 v46, v[122:123] offset:4096
  s_waitcnt lgkmcnt(0)
  s_barrier
  v_lshlrev_b32 v6, 3, v0
  v_mul_u32_u24 v5, 7168, v0
  v_add_u32 v36, 512, v6
  ds_read_b64 v[8:9], v36
  v_add_u32 v36, 25088, v6
  ds_read_b64 v[10:11], v36
  v_add_u32 v36, 49664, v6
  ds_read_b64 v[12:13], v36
  v_add_u32 v36, 74240, v6
  ds_read_b64 v[14:15], v36
  s_waitcnt lgkmcnt(0)
  s_add_u32 s22, s21, 0
  s_add_u32 s23, s22, 3584
  v_perm_b32 v16, v10, v8, s24
  v_perm_b32 v17, v14, v12, s24
  buffer_store_dwordx2 v[16:17], v5, s[88:91], s22 offen offset:0
  v_perm_b32 v18, v10, v8, s25
  v_perm_b32 v19, v14, v12, s25
  buffer_store_dwordx2 v[18:19], v5, s[88:91], s22 offen offset:1792
  v_perm_b32 v20, v11, v9, s24
  v_perm_b32 v21, v15, v13, s24
  buffer_store_dwordx2 v[20:21], v5, s[88:91], s23 offen offset:0
  v_perm_b32 v22, v11, v9, s25
  v_perm_b32 v23, v15, v13, s25
  buffer_store_dwordx2 v[22:23], v5, s[88:91], s23 offen offset:1792
  v_add_u32 v36, 2560, v6
  ds_read_b64 v[8:9], v36
  v_add_u32 v36, 27136, v6
  ds_read_b64 v[10:11], v36
  v_add_u32 v36, 51712, v6
  ds_read_b64 v[12:13], v36
  v_add_u32 v36, 76288, v6
  ds_read_b64 v[14:15], v36
  s_waitcnt lgkmcnt(0)
  s_add_u32 s22, s21, 1835008
  s_add_u32 s23, s22, 3584
  v_perm_b32 v24, v10, v8, s24
  v_perm_b32 v25, v14, v12, s24
  buffer_store_dwordx2 v[24:25], v5, s[88:91], s22 offen offset:0
  v_perm_b32 v26, v10, v8, s25
  v_perm_b32 v27, v14, v12, s25
  buffer_store_dwordx2 v[26:27], v5, s[88:91], s22 offen offset:1792
  v_perm_b32 v28, v11, v9, s24
  v_perm_b32 v29, v15, v13, s24
  buffer_store_dwordx2 v[28:29], v5, s[88:91], s23 offen offset:0
  v_perm_b32 v30, v11, v9, s25
  v_perm_b32 v31, v15, v13, s25
  buffer_store_dwordx2 v[30:31], v5, s[88:91], s23 offen offset:1792
  s_branch wk_loop
wk_tok:
  s_sub_u32 s3, s3, 736
  s_cmp_ge_u32 s3, 512
  s_cbranch_scc1 wk_done
  s_lshr_b32 s17, s3, 3
  s_and_b32 s18, s3, 3
  s_bitcmp1_b32 s3, 2
  s_cbranch_scc1 wk_toko
  s_lshl_b32 s20, s18, 2
  s_add_u32 s20, s20, s16
  s_lshl_b32 s21, s17, 4
  s_add_u32 s21, s21, s20
  s_mul_i32 s21, s21, 28672
  s_add_u32 s21, s21, 12845056
  s_mul_i32 s23, s17, 28672
  s_add_u32 s23, s23, 73400320
  s_mul_i32 s24, s17, 7168
  s_add_u32 s24, s24, 87543808
  s_lshr_b32 s25, s17, 3
  s_lshl_b32 s25, s25, 4
  s_add_u32 s25, s25, s20
  s_lshl_b32 s25, s25, 7
  s_add_u32 s25, s25, 88018944
  v_mov_b32 v60, 0
  s_mov_b32 s30, 0
wp_wf:
  buffer_load_dword v61, v60, s[8:11], s25 offen sc1
  s_waitcnt vmcnt(0)
  v_cmp_ne_u32 vcc, 56, v61
  s_cbranch_vccz wp_wf_ok
  s_sleep 4
  s_cmp_ge_u32 s17, 56
  s_cbranch_scc1 wp_wf_bo
  s_sleep 127
wp_wf_bo:
  s_add_u32 s30, s30, 1
  s_cmp_lt_u32 s30, 2000000
  s_cbranch_scc1 wp_wf
  s_branch wp_abort
wp_wf_ok:
  s_add_u32 s22, s21, 0
  buffer_load_dwordx4 a[0:3], v2, s[8:11], s22 offen offset:0 sc1
  buffer_load_dwordx4 a[4:7], v2, s[8:11], s22 offen offset:1024 sc1
  buffer_load_dwordx4 a[8:11], v2, s[8:11], s22 offen offset:2048 sc1
  buffer_load_dwordx4 a[12:15], v2, s[8:11], s22 offen offset:3072 sc1
  s_add_u32 s22, s21, 4096
  buffer_load_dwordx4 a[16:19], v2, s[8:11], s22 offen offset:0 sc1
  buffer_load_dwordx4 a[20:23], v2, s[8:11], s22 offen offset:1024 sc1
  buffer_load_dwordx4 a[24:27], v2, s[8:11], s22 offen offset:2048 sc1
  buffer_load_dwordx4 a[28:31], v2, s[8:11], s22 offen offset:3072 sc1
  s_add_u32 s22, s21, 8192
  buffer_load_dwordx4 a[32:35], v2, s[8:11], s22 offen offset:0 sc1
  buffer_load_dwordx4 a[36:39], v2, s[8:11], s22 offen offset:1024 sc1
  buffer_load_dwordx4 a[40:43], v2, s[8:11], s22 offen offset:2048 sc1
  buffer_load_dwordx4 a[44:47], v2, s[8:11], s22 offen offset:3072 sc1
  s_add_u32 s22, s21, 12288
  buffer_load_dwordx4 a[48:51], v2, s[8:11], s22 offen offset:0 sc1
  buffer_load_dwordx4 a[52:55], v2, s[8:11], s22 offen offset:1024 sc1
  buffer_load_dwordx4 a[56:59], v2, s[8:11], s22 offen offset:2048 sc1
  buffer_load_dwordx4 a[60:63], v2, s[8:11], s22 offen offset:3072 sc1
  s_add_u32 s22, s21, 16384
  buffer_load_dwordx4 a[64:67], v2, s[8:11], s22 offen offset:0 sc1
  buffer_load_dwordx4 a[68:71], v2, s[8:11], s22 offen offset:1024 sc1
  buffer_load_dwordx4 a[72:75], v2, s[8:11], s22 offen offset:2048 sc1
  buffer_load_dwordx4 a[76:79], v2, s[8:11], s22 offen offset:3072 sc1
  s_add_u32 s22, s21, 20480
  buffer_load_dwordx4 a[80:83], v2, s[8:11], s22 offen offset:0 sc1
  buffer_load_dwordx4 a[84:87], v2, s[8:11], s22 offen offset:1024 sc1
  buffer_load_dwordx4 a[88:91], v2, s[8:11], s22 offen offset:2048 sc1
  buffer_load_dwordx4 a[92:95], v2, s[8:11], s22 offen offset:3072 sc1
  s_add_u32 s22, s21, 24576
  buffer_load_dwordx4 a[96:99], v2, s[8:11], s22 offen offset:0 sc1
  buffer_load_dwordx4 a[100:103], v2, s[8:11], s22 offen offset:1024 sc1
  buffer_load_dwordx4 a[104:107], v2, s[8:11], s22 offen offset:2048 sc1
  buffer_load_dwordx4 a[108:111], v2, s[8:11], s22 offen offset:3072 sc1
  s_add_u32 s22, s23, 0
  buffer_load_dwordx4 a[112:115], v2, s[8:11], s22 offen offset:0 sc1
  buffer_load_dwordx4 a[116:119], v2, s[8:11], s22 offen offset:1024 sc1
  buffer_load_dwordx4 a[120:123], v2, s[8:11], s22 offen offset:2048 sc1
  buffer_load_dwordx4 a[124:127], v2, s[8:11], s22 offen offset:3072 sc1
  s_add_u32 s22, s23, 4096
  buffer_load_dwordx4 a[128:131], v2, s[8:11], s22 offen offset:0 sc1
  buffer_load_dwordx4 a[132:135], v2, s[8:11], s22 offen offset:1024 sc1
  buffer_load_dwordx4 a[136:139], v2, s[8:11], s22 offen offset:2048 sc1
  buffer_load_dwordx4 a[140:143], v2, s[8:11], s22 offen offset:3072 sc1
  s_add_u32 s22, s23, 8192
  buffer_load_dwordx4 a[144:147], v2, s[8:11], s22 offen offset:0 sc1
  buffer_load_dwordx4 a[148:151], v2, s[8:11], s22 offen offset:1024 sc1
  buffer_load_dwordx4 a[152:155], v2, s[8:11], s22 offen offset:2048 sc1
  buffer_load_dwordx4 a[156:159], v2, s[8:11], s22 offen offset:3072 sc1
  s_add_u32 s22, s23, 12288
  buffer_load_dwordx4 a[160:163], v2, s[8:11], s22 offen offset:0 sc1
  buffer_load_dwordx4 a[164:167], v2, s[8:11], s22 offen offset:1024 sc1
  buffer_load_dwordx4 a[168:171], v2, s[8:11], s22 offen offset:2048 sc1
  buffer_load_dwordx4 a[172:175], v2, s[8:11], s22 offen offset:3072 sc1
  s_add_u32 s22, s23, 16384
  buffer_load_dwordx4 a[176:179], v2, s[8:11], s22 offen offset:0 sc1
  buffer_load_dwordx4 a[180:183], v2, s[8:11], s22 offen offset:1024 sc1
  buffer_load_dwordx4 a[184:187], v2, s[8:11], s22 offen offset:2048 sc1
  buffer_load_dwordx4 a[188:191], v2, s[8:11], s22 offen offset:3072 sc1
  s_add_u32 s22, s23, 20480
  buffer_load_dwordx4 a[192:195], v2, s[8:11], s22 offen offset:0 sc1
  buffer_load_dwordx4 a[196:199], v2, s[8:11], s22 offen offset:1024 sc1
  buffer_load_dwordx4 a[200:203], v2, s[8:11], s22 offen offset:2048 sc1
  buffer_load_dwordx4 a[204:207], v2, s[8:11], s22 offen offset:3072 sc1
  s_add_u32 s22, s23, 24576
  buffer_load_dwordx4 a[208:211], v2, s[8:11], s22 offen offset:0 sc1
  buffer_load_dwordx4 a[212:215], v2, s[8:11], s22 offen offset:1024 sc1
  buffer_load_dwordx4 a[216:219], v2, s[8:11], s22 offen offset:2048 sc1
  buffer_load_dwordx4 a[220:223], v2, s[8:11], s22 offen offset:3072 sc1
  v_lshl_add_u32 v5, v3, 2, 0
  v_cmp_le_u32 s[40:41], v5, v4
  v_lshl_add_u32 v5, v3, 2, 1
  v_cmp_le_u32 s[42:43], v5, v4
  v_lshl_add_u32 v5, v3, 2, 2
  v_cmp_le_u32 s[44:45], v5, v4
  v_lshl_add_u32 v5, v3, 2, 3
  v_cmp_le_u32 s[46:47], v5, v4
  v_cmp_gt_u32 s[48:49], 2, v3
  v_mov_b32 v6, 0xff800000
  s_waitcnt vmcnt(0)
  v_mfma_f32_16x16x32_bf16 v[8:11], a[112:115], a[0:3], 0
  v_mfma_f32_16x16x32_bf16 v[12:15], a[112:115], a[56:59], 0
  v_mfma_f32_16x16x32_bf16 v[16:19], a[168:171], a[56:59], 0
  v_mfma_f32_16x16x32_bf16 v[8:11], a[116:119], a[4:7], v[8:11]
  v_mfma_f32_16x16x32_bf16 v[12:15], a[116:119], a[60:63], v[12:15]
  v_mfma_f32_16x16x32_bf16 v[16:19], a[172:175], a[60:63], v[16:19]
  v_mfma_f32_16x16x32_bf16 v[8:11], a[120:123], a[8:11], v[8:11]
  v_mfma_f32_16x16x32_bf16 v[12:15], a[120:123], a[64:67], v[12:15]
  v_mfma_f32_16x16x32_bf16 v[16:19], a[176:179], a[64:67], v[16:19]
  v_mfma_f32_16x16x32_bf16 v[8:11], a[124:127], a[12:15], v[8:11]
  v_mfma_f32_16x16x32_bf16 v[12:15], a[124:127], a[68:71], v[12:15]
  v_mfma_f32_16x16x32_bf16 v[16:19], a[180:183], a[68:71], v[16:19]
  v_mfma_f32_16x16x32_bf16 v[8:11], a[128:131], a[16:19], v[8:11]
  v_mfma_f32_16x16x32_bf16 v[12:15], a[128:131], a[72:75], v[12:15]
  v_mfma_f32_16x16x32_bf16 v[16:19], a[184:187], a[72:75], v[16:19]
  v_mfma_f32_16x16x32_bf16 v[8:11], a[132:135], a[20:23], v[8:11]
  v_mfma_f32_16x16x32_bf16 v[12:15], a[132:135], a[76:79], v[12:15]
  v_mfma_f32_16x16x32_bf16 v[16:19], a[188:191], a[76:79], v[16:19]
  v_mfma_f32_16x16x32_bf16 v[8:11], a[136:139], a[24:27], v[8:11]
  v_mfma_f32_16x16x32_bf16 v[12:15], a[136:139], a[80:83], v[12:15]
  v_mfma_f32_16x16x32_bf16 v[16:19], a[192:195], a[80:83], v[16:19]
  v_mfma_f32_16x16x32_bf16 v[8:11], a[140:143], a[28:31], v[8:11]
  v_mfma_f32_16x16x32_bf16 v[12:15], a[140:143], a[84:87], v[12:15]
  v_mfma_f32_16x16x32_bf16 v[16:19], a[196:199], a[84:87], v[16:19]
  v_mfma_f32_16x16x32_bf16 v[8:11], a[144:147], a[32:35], v[8:11]
  v_mfma_f32_16x16x32_bf16 v[12:15], a[144:147], a[88:91], v[12:15]
  v_mfma_f32_16x16x32_bf16 v[16:19], a[200:203], a[88:91], v[16:19]
  v_mfma_f32_16x16x32_bf16 v[8:11], a[148:151], a[36:39], v[8:11]
  v_mfma_f32_16x16x32_bf16 v[12:15], a[148:151], a[92:95], v[12:15]
  v_mfma_f32_16x16x32_bf16 v[16:19], a[204:207], a[92:95], v[16:19]
  v_mfma_f32_16x16x32_bf16 v[8:11], a[152:155], a[40:43], v[8:11]
  v_mfma_f32_16x16x32_bf16 v[12:15], a[152:155], a[96:99], v[12:15]
  v_mfma_f32_16x16x32_bf16 v[16:19], a[208:211], a[96:99], v[16:19]
  v_mfma_f32_16x16x32_bf16 v[8:11], a[156:159], a[44:47], v[8:11]
  v_mfma_f32_16x16x32_bf16 v[12:15], a[156:159], a[100:103], v[12:15]
  v_mfma_f32_16x16x32_bf16 v[16:19], a[212:215], a[100:103], v[16:19]
  v_mfma_f32_16x16x32_bf16 v[8:11], a[160:163], a[48:51], v[8:11]
  v_mfma_f32_16x16x32_bf16 v[12:15], a[160:163], a[104:107], v[12:15]
  v_mfma_f32_16x16x32_bf16 v[16:19], a[216:219], a[104:107], v[16:19]
  v_mfma_f32_16x16x32_bf16 v[8:11], a[164:167], a[52:55], v[8:11]
  v_mfma_f32_16x16x32_bf16 v[12:15], a[164:167], a[108:111], v[12:15]
  v_mfma_f32_16x16x32_bf16 v[16:19], a[220:223], a[108:111], v[16:19]
  s_mul_i32 s22, s20, 448
  v_mov_b32 v62, s22
  s_mov_b32 s30, 0
wp_pm:
  s_cmp_ge_u32 s17, 64
  s_cbranch_scc1 wp_pf
  buffer_load_dword v61, v62, s[8:11], s24 offen sc1
  s_waitcnt vmcnt(0)
  v_cmp_eq_u32 vcc, -1, v61
  s_cbranch_vccnz wp_pr
wp_pf:
  s_add_u32 s22, s24, 4096
  buffer_load_dwordx4 v[64:67], v2, s[8:11], s24 offen offset:0 sc1
  buffer_load_dwordx4 v[68:71], v2, s[8:11], s24 offen offset:1024 sc1
  buffer_load_dwordx4 v[72:75], v2, s[8:11], s24 offen offset:2048 sc1
  buffer_load_dwordx4 v[76:79], v2, s[8:11], s24 offen offset:3072 sc1
  buffer_load_dwordx4 v[80:83], v2, s[8:11], s22 offen offset:0 sc1
  buffer_load_dwordx4 v[84:87], v2, s[8:11], s22 offen offset:1024 sc1
  buffer_load_dwordx4 v[88:91], v2, s[8:11], s22 offen offset:2048 sc1
  s_waitcnt vmcnt(0)
  v_max_u32 v61, v64, v65
  v_max3_u32 v61, v61, v66, v67
  v_max3_u32 v61, v61, v68, v69
  v_max3_u32 v61, v61, v70, v71
  v_max3_u32 v61, v61, v72, v73
  v_max3_u32 v61, v61, v74, v75
  v_max3_u32 v61, v61, v76, v77
  v_max3_u32 v61, v61, v78, v79
  v_max3_u32 v61, v61, v80, v81
  v_max3_u32 v61, v61, v82, v83
  v_max3_u32 v61, v61, v84, v85
  v_max3_u32 v61, v61, v86, v87
  v_max3_u32 v61, v61, v88, v89
  v_max3_u32 v61, v61, v90, v91
  v_cmp_eq_u32 vcc, -1, v61
  s_cbranch_vccz wp_pk
wp_pr:
  s_sleep 4
  s_cmp_ge_u32 s17, 56
  s_cbranch_scc1 wp_pm_bo
  s_sleep 127
wp_pm_bo:
  s_add_u32 s30, s30, 1
  s_cmp_lt_u32 s30, 2000000
  s_cbranch_scc1 wp_pm
  s_branch wp_abort
wp_pk:
  buffer_load_dword v250, v251, s[8:11], 0 offen sc1
  v_mfma_f32_16x16x32_bf16 v[20:23], v[64:67], a[0:3], 0
  v_mfma_f32_16x16x32_bf16 v[24:27], v[64:67], a[4:7], 0
  v_mfma_f32_16x16x32_bf16 v[28:31], v[64:67], a[56:59], 0
  v_mfma_f32_16x16x32_bf16 v[32:35], v[64:67], a[60:63], 0
  v_mfma_f32_16x16x32_bf16 v[20:23], v[68:71], a[8:11], v[20:23]
  v_mfma_f32_16x16x32_bf16 v[24:27], v[68:71], a[12:15], v[24:27]
  v_mfma_f32_16x16x32_bf16 v[28:31], v[68:71], a[64:67], v[28:31]
  v_mfma_f32_16x16x32_bf16 v[32:35], v[68:71], a[68:71], v[32:35]
  v_mfma_f32_16x16x32_bf16 v[20:23], v[72:75], a[16:19], v[20:23]
  v_mfma_f32_16x16x32_bf16 v[24:27], v[72:75], a[20:23], v[24:27]
  v_mfma_f32_16x16x32_bf16 v[28:31], v[72:75], a[72:75], v[28:31]
  v_mfma_f32_16x16x32_bf16 v[32:35], v[72:75], a[76:79], v[32:35]
  v_mfma_f32_16x16x32_bf16 v[20:23], v[76:79], a[24:27], v[20:23]
  v_mfma_f32_16x16x32_bf16 v[24:27], v[76:79], a[28:31], v[24:27]
  v_mfma_f32_16x16x32_bf16 v[28:31], v[76:79], a[80:83], v[28:31]
  v_mfma_f32_16x16x32_bf16 v[32:35], v[76:79], a[84:87], v[32:35]
  v_mfma_f32_16x16x32_bf16 v[20:23], v[80:83], a[32:35], v[20:23]
  v_mfma_f32_16x16x32_bf16 v[24:27], v[80:83], a[36:39], v[24:27]
  v_mfma_f32_16x16x32_bf16 v[28:31], v[80:83], a[88:91], v[28:31]
  v_mfma_f32_16x16x32_bf16 v[32:35], v[80:83], a[92:95], v[32:35]
  v_mfma_f32_16x16x32_bf16 v[20:23], v[84:87], a[40:43], v[20:23]
  v_mfma_f32_16x16x32_bf16 v[24:27], v[84:87], a[44:47], v[24:27]
  v_mfma_f32_16x16x32_bf16 v[28:31], v[84:87], a[96:99], v[28:31]
  v_mfma_f32_16x16x32_bf16 v[32:35], v[84:87], a[100:103], v[32:35]
  v_mfma_f32_16x16x32_bf16 v[20:23], v[88:91], a[48:51], v[20:23]
  v_mfma_f32_16x16x32_bf16 v[24:27], v[88:91], a[52:55], v[24:27]
  v_mfma_f32_16x16x32_bf16 v[28:31], v[88:91], a[104:107], v[28:31]
  v_mfma_f32_16x16x32_bf16 v[32:35], v[88:91], a[108:111], v[32:35]
  s_lshl_b32 s25, s17, 1
  s_mul_i32 s25, s25, 20480
  s_add_u32 s25, s25, 84922368
  s_lshl_b32 s26, s20, 10
  s_add_u32 s26, s26, s25
  s_lshl_b32 s27, s18, 10
  s_add_u32 s27, s27, s25
  s_lshr_b32 s28, s16, 1
  s_lshl_b32 s28, s28, 3
  s_add_u32 s27, s27, s28
  s_add_u32 s27, s27, 16384
  s_and_b32 s28, s16, 1
  s_cmp_eq_u32 s28, 0
  s_cselect_b32 s50, -1, 0
  s_cselect_b32 s51, 0, -1
  v_cndmask_b32 v8, v6, v8, s[40:41]
  v_cndmask_b32 v9, v6, v9, s[42:43]
  v_cndmask_b32 v10, v6, v10, s[44:45]
  v_cndmask_b32 v11, v6, v11, s[46:47]
  v_cndmask_b32 v20, v24, v20, s[48:49]
  v_cndmask_b32 v21, v25, v21, s[48:49]
  v_cndmask_b32 v22, v26, v22, s[48:49]
  v_cndmask_b32 v23, v27, v23, s[48:49]
  v_mov_b32 v24, v20
  v_mov_b32 v25, v21
  v_mov_b32 v26, v22
  v_mov_b32 v27, v23
  v_permlane32_swap_b32 v20, v24
  v_permlane32_swap_b32 v21, v25
  v_permlane32_swap_b32 v22, v26
  v_permlane32_swap_b32 v23, v27
  v_add_f32 v20, v20, v24
  v_add_f32 v21, v21, v25
  v_add_f32 v22, v22, v26
  v_add_f32 v23, v23, v27
  v_max3_f32 v40, v8, v9, v10
  v_max3_f32 v40, v40, v11, v20
  v_max3_f32 v40, v40, v21, v22
  v_max_f32 v40, v40, v23
  v_mov_b32 v41, v40
  s_nop 1
  v_permlane16_swap_b32 v40, v41
  v_max_f32 v40, v40, v41
  v_mov_b32 v41, v40
  s_nop 1
  v_permlane32_swap_b32 v40, v41
  v_max_f32 v40, v40, v41
  v_sub_f32 v8, v8, v40
  v_sub_f32 v9, v9, v40
  v_sub_f32 v10, v10, v40
  v_sub_f32 v11, v11, v40
  v_sub_f32 v20, v20, v40
  v_sub_f32 v21, v21, v40
  v_sub_f32 v22, v22, v40
  v_sub_f32 v23, v23, v40
  v_exp_f32 v8, v8
  v_exp_f32 v9, v9
  v_exp_f32 v10, v10
  v_exp_f32 v11, v11
  v_exp_f32 v20, v20
  v_exp_f32 v21, v21
  v_exp_f32 v22, v22
  v_exp_f32 v23, v23
  v_add_f32 v42, v20, v21
  v_add_f32 v43, v22, v23
  v_add_f32 v42, v42, v43
  v_mul_f32 v42, 0.5, v42
  v_add_f32 v42, v42, v8
  v_add_f32 v42, v42, v9
  v_add_f32 v42, v42, v10
  v_add_f32 v42, v42, v11
  v_mov_b32 v41, v42
  s_nop 1
  v_permlane16_swap_b32 v42, v41
  v_add_f32 v42, v42, v41
  v_mov_b32 v41, v42
  s_nop 1
  v_permlane32_swap_b32 v42, v41
  v_add_f32 v42, v42, v41
  v_rcp_f32 v42, v42
  s_nop 0
  v_mul_f32 v8, v8, v42
  v_mul_f32 v9, v9, v42
  v_mul_f32 v10, v10, v42
  v_mul_f32 v11, v11, v42
  v_mul_f32 v20, v20, v42
  v_mul_f32 v21, v21, v42
  v_mul_f32 v22, v22, v42
  v_mul_f32 v23, v23, v42
  v_cvt_pk_bf16_f32 v44, v8, 0
  v_cvt_pk_bf16_f32 v45, v9, 0
  v_cvt_pk_bf16_f32 v46, v10, 0
  v_cvt_pk_bf16_f32 v47, v11, 0
  v_cvt_pk_bf16_f32 v48, v20, v21
  v_cvt_pk_bf16_f32 v49, v22, v23
  buffer_store_dwordx4 v[44:47], v2, s[8:11], s26 offen sc1
  s_mov_b64 exec, s[50:51]
  buffer_store_dwordx2 v[48:49], v2, s[8:11], s27 offen sc1
  s_mov_b64 exec, -1
  s_add_u32 s26, s26, 20480
  s_add_u32 s27, s27, 20480
  v_cndmask_b32 v16, v6, v16, s[40:41]
  v_cndmask_b32 v17, v6, v17, s[42:43]
  v_cndmask_b32 v18, v6, v18, s[44:45]
  v_cndmask_b32 v19, v6, v19, s[46:47]
  v_cndmask_b32 v28, v32, v28, s[48:49]
  v_cndmask_b32 v29, v33, v29, s[48:49]
  v_cndmask_b32 v30, v34, v30, s[48:49]
  v_cndmask_b32 v31, v35, v31, s[48:49]
  v_mov_b32 v32, v28
  v_mov_b32 v33, v29
  v_mov_b32 v34, v30
  v_mov_b32 v35, v31
  v_permlane32_swap_b32 v28, v32
  v_permlane32_swap_b32 v29, v33
  v_permlane32_swap_b32 v30, v34
  v_permlane32_swap_b32 v31, v35
  v_add_f32 v28, v28, v32
  v_add_f32 v29, v29, v33
  v_add_f32 v30, v30, v34
  v_add_f32 v31, v31, v35
  v_max3_f32 v40, v12, v13, v14
  v_max3_f32 v40, v40, v15, v16
  v_max3_f32 v40, v40, v17, v18
  v_max3_f32 v40, v40, v19, v28
  v_max3_f32 v40, v40, v29, v30
  v_max_f32 v40, v40, v31
  v_mov_b32 v41, v40
  s_nop 1
  v_permlane16_swap_b32 v40, v41
  v_max_f32 v40, v40, v41
  v_mov_b32 v41, v40
  s_nop 1
  v_permlane32_swap_b32 v40, v41
  v_max_f32 v40, v40, v41
  v_sub_f32 v12, v12, v40
  v_sub_f32 v13, v13, v40
  v_sub_f32 v14, v14, v40
  v_sub_f32 v15, v15, v40
  v_sub_f32 v16, v16, v40
  v_sub_f32 v17, v17, v40
  v_sub_f32 v18, v18, v40
  v_sub_f32 v19, v19, v40
  v_sub_f32 v28, v28, v40
  v_sub_f32 v29, v29, v40
  v_sub_f32 v30, v30, v40
  v_sub_f32 v31, v31, v40
  v_exp_f32 v12, v12
  v_exp_f32 v13, v13
  v_exp_f32 v14, v14
  v_exp_f32 v15, v15
  v_exp_f32 v16, v16
  v_exp_f32 v17, v17
  v_exp_f32 v18, v18
  v_exp_f32 v19, v19
  v_exp_f32 v28, v28
  v_exp_f32 v29, v29
  v_exp_f32 v30, v30
  v_exp_f32 v31, v31
  v_add_f32 v42, v28, v29
  v_add_f32 v43, v30, v31
  v_add_f32 v42, v42, v43
  v_mul_f32 v42, 0.5, v42
  v_add_f32 v42, v42, v12
  v_add_f32 v42, v42, v13
  v_add_f32 v42, v42, v14
  v_add_f32 v42, v42, v15
  v_add_f32 v42, v42, v16
  v_add_f32 v42, v42, v17
  v_add_f32 v42, v42, v18
  v_add_f32 v42, v42, v19
  v_mov_b32 v41, v42
  s_nop 1
  v_permlane16_swap_b32 v42, v41
  v_add_f32 v42, v42, v41
  v_mov_b32 v41, v42
  s_nop 1
  v_permlane32_swap_b32 v42, v41
  v_add_f32 v42, v42, v41
  v_rcp_f32 v42, v42
  s_nop 0
  v_mul_f32 v12, v12, v42
  v_mul_f32 v13, v13, v42
  v_mul_f32 v14, v14, v42
  v_mul_f32 v15, v15, v42
  v_mul_f32 v16, v16, v42
  v_mul_f32 v17, v17, v42
  v_mul_f32 v18, v18, v42
  v_mul_f32 v19, v19, v42
  v_mul_f32 v28, v28, v42
  v_mul_f32 v29, v29, v42
  v_mul_f32 v30, v30, v42
  v_mul_f32 v31, v31, v42
  v_cvt_pk_bf16_f32 v52, v12, v16
  v_cvt_pk_bf16_f32 v53, v13, v17
  v_cvt_pk_bf16_f32 v54, v14, v18
  v_cvt_pk_bf16_f32 v55, v15, v19
  v_cvt_pk_bf16_f32 v56, v28, v29
  v_cvt_pk_bf16_f32 v57, v30, v31
  buffer_store_dwordx4 v[52:55], v2, s[8:11], s26 offen sc1
  s_mov_b64 exec, s[50:51]
  buffer_store_dwordx2 v[56:57], v2, s[8:11], s27 offen sc1
  s_mov_b64 exec, -1
  s_lshl_b32 s25, s17, 7
  s_add_u32 s25, s25, 88035328
  v_mov_b32 v5, 1
  v_mov_b32 v6, 0
  s_waitcnt vmcnt(0)
  s_mov_b64 exec, 1
  buffer_atomic_add v5, v6, s[8:11], s25 offen
  s_mov_b64 exec, -1
  s_branch wk_loop
wk_toko:
  s_lshl_b32 s20, s18, 2
  s_add_u32 s20, s20, s16
  s_mul_i32 s24, s20, 65
  s_add_u32 s24, s24, s17
  s_lshl_b32 s24, s24, 13
  s_add_u32 s24, s24, 76410880
  s_lshl_b32 s21, s20, 6
  s_add_u32 s21, s21, s17
  s_mul_i32 s21, s21, 28672
  s_add_u32 s21, s21, 42205184
  s_lshl_b32 s25, s17, 1
  s_mul_i32 s25, s25, 20480
  s_add_u32 s25, s25, 84922368
  v_mov_b32 v5, v2
  v_min_u32 v6, 11, v4
  v_mad_u32_u24 v6, v3, 12, v6
  v_lshlrev_b32 v6, 4, v6
  v_add_u32 v6, 1024, v6
  v_lshrrev_b32 v8, 1, v3
  v_lshl_add_u32 v8, v8, 4, v4
  v_lshlrev_b32 v8, 4, v8
  v_and_b32 v9, 1, v3
  v_lshl_add_u32 v7, v9, 3, v8
  s_lshr_b32 s26, s17, 3
  s_lshl_b32 s26, s26, 4
  s_add_u32 s26, s26, s20
  s_lshl_b32 s26, s26, 7
  s_add_u32 s26, s26, 88002560
  v_mov_b32 v60, 0
  s_mov_b32 s30, 0
wo_wv:
  buffer_load_dword v61, v60, s[8:11], s26 offen sc1
  s_waitcnt vmcnt(0)
  v_cmp_ne_u32 vcc, 56, v61
  s_cbranch_vccz wo_wv_ok
  s_sleep 4
  s_cmp_ge_u32 s17, 56
  s_cbranch_scc1 wo_wv_bo
  s_sleep 127
wo_wv_bo:
  s_add_u32 s30, s30, 1
  s_cmp_lt_u32 s30, 2000000
  s_cbranch_scc1 wo_wv
  s_branch wo_abort
wo_wv_ok:
  s_add_u32 s22, s21, 0
  buffer_load_dwordx4 a[0:3], v5, s[8:11], s22 offen offset:0 sc1
  buffer_load_dwordx4 a[4:7], v6, s[8:11], s22 offen offset:0 sc1
  buffer_load_dwordx4 a[8:11], v5, s[8:11], s22 offen offset:1792 sc1
  buffer_load_dwordx4 a[12:15], v6, s[8:11], s22 offen offset:1792 sc1
  s_add_u32 s22, s21, 3584
  buffer_load_dwordx4 a[16:19], v5, s[8:11], s22 offen offset:0 sc1
  buffer_load_dwordx4 a[20:23], v6, s[8:11], s22 offen offset:0 sc1
  buffer_load_dwordx4 a[24:27], v5, s[8:11], s22 offen offset:1792 sc1
  buffer_load_dwordx4 a[28:31], v6, s[8:11], s22 offen offset:1792 sc1
  s_add_u32 s22, s21, 7168
  buffer_load_dwordx4 a[32:35], v5, s[8:11], s22 offen offset:0 sc1
  buffer_load_dwordx4 a[36:39], v6, s[8:11], s22 offen offset:0 sc1
  buffer_load_dwordx4 a[40:43], v5, s[8:11], s22 offen offset:1792 sc1
  buffer_load_dwordx4 a[44:47], v6, s[8:11], s22 offen offset:1792 sc1
  s_add_u32 s22, s21, 10752
  buffer_load_dwordx4 a[48:51], v5, s[8:11], s22 offen offset:0 sc1
  buffer_load_dwordx4 a[52:55], v6, s[8:11], s22 offen offset:0 sc1
  buffer_load_dwordx4 a[56:59], v5, s[8:11], s22 offen offset:1792 sc1
  buffer_load_dwordx4 a[60:63], v6, s[8:11], s22 offen offset:1792 sc1
  s_add_u32 s22, s21, 14336
  buffer_load_dwordx4 a[64:67], v5, s[8:11], s22 offen offset:0 sc1
  buffer_load_dwordx4 a[68:71], v6, s[8:11], s22 offen offset:0 sc1
  buffer_load_dwordx4 a[72:75], v5, s[8:11], s22 offen offset:1792 sc1
  buffer_load_dwordx4 a[76:79], v6, s[8:11], s22 offen offset:1792 sc1
  s_add_u32 s22, s21, 17920
  buffer_load_dwordx4 a[80:83], v5, s[8:11], s22 offen offset:0 sc1
  buffer_load_dwordx4 a[84:87], v6, s[8:11], s22 offen offset:0 sc1
  buffer_load_dwordx4 a[88:91], v5, s[8:11], s22 offen offset:1792 sc1
  buffer_load_dwordx4 a[92:95], v6, s[8:11], s22 offen offset:1792 sc1
  s_add_u32 s22, s21, 21504
  buffer_load_dwordx4 a[96:99], v5, s[8:11], s22 offen offset:0 sc1
  buffer_load_dwordx4 a[100:103], v6, s[8:11], s22 offen offset:0 sc1
  buffer_load_dwordx4 a[104:107], v5, s[8:11], s22 offen offset:1792 sc1
  buffer_load_dwordx4 a[108:111], v6, s[8:11], s22 offen offset:1792 sc1
  s_add_u32 s22, s21, 25088
  buffer_load_dwordx4 a[112:115], v5, s[8:11], s22 offen offset:0 sc1
  buffer_load_dwordx4 a[116:119], v6, s[8:11], s22 offen offset:0 sc1
  buffer_load_dwordx4 a[120:123], v5, s[8:11], s22 offen offset:1792 sc1
  buffer_load_dwordx4 a[124:127], v6, s[8:11], s22 offen offset:1792 sc1
  s_lshl_b32 s26, s20, 6
  s_add_u32 s26, s26, s17
  s_lshl_b32 s26, s26, 4
  s_add_u32 s26, s26, 88043520
  v_lshlrev_b32 v60, 2, v3
  s_mov_b32 s30, 0
wo_wt:
  buffer_load_dword v61, v60, s[8:11], s26 offen sc1
  s_waitcnt vmcnt(0)
  v_cmp_ne_u32 vcc, 1, v61
  s_cbranch_vccz wo_wt_ok
  s_sleep 4
  s_cmp_ge_u32 s17, 56
  s_cbranch_scc1 wo_wt_bo
  s_sleep 127
wo_wt_bo:
  s_add_u32 s30, s30, 1
  s_cmp_lt_u32 s30, 2000000
  s_cbranch_scc1 wo_wt
  s_branch wo_abort
wo_wt_ok:
  s_add_u32 s22, s24, 0
  buffer_load_dwordx2 v[28:29], v7, s[8:11], s22 offen offset:0 sc1
  buffer_load_dwordx2 v[30:31], v7, s[8:11], s22 offen offset:512 sc1
  buffer_load_dwordx2 v[32:33], v7, s[8:11], s22 offen offset:1024 sc1
  buffer_load_dwordx2 v[34:35], v7, s[8:11], s22 offen offset:1536 sc1
  buffer_load_dwordx2 v[36:37], v7, s[8:11], s22 offen offset:2048 sc1
  buffer_load_dwordx2 v[38:39], v7, s[8:11], s22 offen offset:2560 sc1
  buffer_load_dwordx2 v[40:41], v7, s[8:11], s22 offen offset:3072 sc1
  buffer_load_dwordx2 v[42:43], v7, s[8:11], s22 offen offset:3584 sc1
  s_add_u32 s22, s24, 4096
  buffer_load_dwordx2 v[44:45], v7, s[8:11], s22 offen offset:0 sc1
  buffer_load_dwordx2 v[46:47], v7, s[8:11], s22 offen offset:512 sc1
  buffer_load_dwordx2 v[48:49], v7, s[8:11], s22 offen offset:1024 sc1
  buffer_load_dwordx2 v[50:51], v7, s[8:11], s22 offen offset:1536 sc1
  buffer_load_dwordx2 v[52:53], v7, s[8:11], s22 offen offset:2048 sc1
  buffer_load_dwordx2 v[54:55], v7, s[8:11], s22 offen offset:2560 sc1
  buffer_load_dwordx2 v[56:57], v7, s[8:11], s22 offen offset:3072 sc1
  buffer_load_dwordx2 v[58:59], v7, s[8:11], s22 offen offset:3584 sc1
  s_lshl_b32 s26, s17, 7
  s_add_u32 s26, s26, 88035328
  v_mov_b32 v60, 0
  s_mov_b32 s30, 0
wo_wp:
  buffer_load_dword v61, v60, s[8:11], s26 offen sc1
  s_waitcnt vmcnt(0)
  v_cmp_ne_u32 vcc, 16, v61
  s_cbranch_vccz wo_wp_ok
  s_sleep 2
  s_cmp_ge_u32 s17, 56
  s_cbranch_scc1 wo_wp_bo
  s_sleep 127
wo_wp_bo:
  s_add_u32 s30, s30, 1
  s_cmp_lt_u32 s30, 2000000
  s_cbranch_scc1 wo_wp
  s_branch wo_abort
wo_wp_ok:
  buffer_load_dword v250, v251, s[8:11], 0 offen sc1
  s_add_u32 s26, s25, 0
  s_add_u32 s27, s25, 20480
  buffer_load_dwordx4 a[128:131], v2, s[8:11], s26 offen offset:0 sc1
  buffer_load_dwordx4 a[132:135], v2, s[8:11], s27 offen offset:0 sc1
  buffer_load_dwordx4 a[136:139], v2, s[8:11], s26 offen offset:1024 sc1
  buffer_load_dwordx4 a[140:143], v2, s[8:11], s27 offen offset:1024 sc1
  buffer_load_dwordx4 a[144:147], v2, s[8:11], s26 offen offset:2048 sc1
  buffer_load_dwordx4 a[148:151], v2, s[8:11], s27 offen offset:2048 sc1
  buffer_load_dwordx4 a[152:155], v2, s[8:11], s26 offen offset:3072 sc1
  buffer_load_dwordx4 a[156:159], v2, s[8:11], s27 offen offset:3072 sc1
  s_add_u32 s26, s25, 4096
  s_add_u32 s27, s25, 24576
  buffer_load_dwordx4 a[160:163], v2, s[8:11], s26 offen offset:0 sc1
  buffer_load_dwordx4 a[164:167], v2, s[8:11], s27 offen offset:0 sc1
  buffer_load_dwordx4 a[168:171], v2, s[8:11], s26 offen offset:1024 sc1
  buffer_load_dwordx4 a[172:175], v2, s[8:11], s27 offen offset:1024 sc1
  buffer_load_dwordx4 a[176:179], v2, s[8:11], s26 offen offset:2048 sc1
  buffer_load_dwordx4 a[180:183], v2, s[8:11], s27 offen offset:2048 sc1
  buffer_load_dwordx4 a[184:187], v2, s[8:11], s26 offen offset:3072 sc1
  buffer_load_dwordx4 a[188:191], v2, s[8:11], s27 offen offset:3072 sc1
  s_add_u32 s26, s25, 8192
  s_add_u32 s27, s25, 28672
  buffer_load_dwordx4 a[192:195], v2, s[8:11], s26 offen offset:0 sc1
  buffer_load_dwordx4 a[196:199], v2, s[8:11], s27 offen offset:0 sc1
  buffer_load_dwordx4 a[200:203], v2, s[8:11], s26 offen offset:1024 sc1
  buffer_load_dwordx4 a[204:207], v2, s[8:11], s27 offen offset:1024 sc1
  buffer_load_dwordx4 a[208:211], v2, s[8:11], s26 offen offset:2048 sc1
  buffer_load_dwordx4 a[212:215], v2, s[8:11], s27 offen offset:2048 sc1
  buffer_load_dwordx4 a[216:219], v2, s[8:11], s26 offen offset:3072 sc1
  buffer_load_dwordx4 a[220:223], v2, s[8:11], s27 offen offset:3072 sc1
  s_add_u32 s26, s25, 12288
  s_add_u32 s27, s25, 32768
  buffer_load_dwordx4 a[224:227], v2, s[8:11], s26 offen offset:0 sc1
  buffer_load_dwordx4 a[228:231], v2, s[8:11], s27 offen offset:0 sc1
  buffer_load_dwordx4 a[232:235], v2, s[8:11], s26 offen offset:1024 sc1
  buffer_load_dwordx4 a[236:239], v2, s[8:11], s27 offen offset:1024 sc1
  buffer_load_dwordx4 a[240:243], v2, s[8:11], s26 offen offset:2048 sc1
  buffer_load_dwordx4 a[244:247], v2, s[8:11], s27 offen offset:2048 sc1
  buffer_load_dwordx4 a[248:251], v2, s[8:11], s26 offen offset:3072 sc1
  buffer_load_dwordx4 a[252:255], v2, s[8:11], s27 offen offset:3072 sc1
  s_add_u32 s26, s25, 16384
  s_add_u32 s27, s25, 36864
  buffer_load_dwordx4 v[64:67], v2, s[8:11], s26 offen offset:0 sc1
  buffer_load_dwordx4 v[68:71], v2, s[8:11], s27 offen offset:0 sc1
  buffer_load_dwordx4 v[72:75], v2, s[8:11], s26 offen offset:1024 sc1
  buffer_load_dwordx4 v[76:79], v2, s[8:11], s27 offen offset:1024 sc1
  buffer_load_dwordx4 v[80:83], v2, s[8:11], s26 offen offset:2048 sc1
  buffer_load_dwordx4 v[84:87], v2, s[8:11], s27 offen offset:2048 sc1
  buffer_load_dwordx4 v[88:91], v2, s[8:11], s26 offen offset:3072 sc1
  buffer_load_dwordx4 v[92:95], v2, s[8:11], s27 offen offset:3072 sc1
  s_waitcnt vmcnt(38)
  v_mfma_f32_16x16x32_bf16 v[12:15], a[0:3], a[128:131], 0
  v_mfma_f32_16x16x32_bf16 v[16:19], a[0:3], a[132:135], 0
  v_mfma_f32_16x16x32_bf16 v[20:23], a[4:7], a[128:131], 0
  v_mfma_f32_16x16x32_bf16 v[24:27], a[4:7], a[132:135], 0
  s_waitcnt vmcnt(36)
  v_mfma_f32_16x16x32_bf16 v[12:15], a[8:11], a[136:139], v[12:15]
  v_mfma_f32_16x16x32_bf16 v[16:19], a[8:11], a[140:143], v[16:19]
  v_mfma_f32_16x16x32_bf16 v[20:23], a[12:15], a[136:139], v[20:23]
  v_mfma_f32_16x16x32_bf16 v[24:27], a[12:15], a[140:143], v[24:27]
  s_waitcnt vmcnt(34)
  v_mfma_f32_16x16x32_bf16 v[12:15], a[16:19], a[144:147], v[12:15]
  v_mfma_f32_16x16x32_bf16 v[16:19], a[16:19], a[148:151], v[16:19]
  v_mfma_f32_16x16x32_bf16 v[20:23], a[20:23], a[144:147], v[20:23]
  v_mfma_f32_16x16x32_bf16 v[24:27], a[20:23], a[148:151], v[24:27]
  s_waitcnt vmcnt(32)
  v_mfma_f32_16x16x32_bf16 v[12:15], a[24:27], a[152:155], v[12:15]
  v_mfma_f32_16x16x32_bf16 v[16:19], a[24:27], a[156:159], v[16:19]
  v_mfma_f32_16x16x32_bf16 v[20:23], a[28:31], a[152:155], v[20:23]
  v_mfma_f32_16x16x32_bf16 v[24:27], a[28:31], a[156:159], v[24:27]
  s_waitcnt vmcnt(30)
  v_mfma_f32_16x16x32_bf16 v[12:15], a[32:35], a[160:163], v[12:15]
  v_mfma_f32_16x16x32_bf16 v[16:19], a[32:35], a[164:167], v[16:19]
  v_mfma_f32_16x16x32_bf16 v[20:23], a[36:39], a[160:163], v[20:23]
  v_mfma_f32_16x16x32_bf16 v[24:27], a[36:39], a[164:167], v[24:27]
  s_waitcnt vmcnt(28)
  v_mfma_f32_16x16x32_bf16 v[12:15], a[40:43], a[168:171], v[12:15]
  v_mfma_f32_16x16x32_bf16 v[16:19], a[40:43], a[172:175], v[16:19]
  v_mfma_f32_16x16x32_bf16 v[20:23], a[44:47], a[168:171], v[20:23]
  v_mfma_f32_16x16x32_bf16 v[24:27], a[44:47], a[172:175], v[24:27]
  s_waitcnt vmcnt(26)
  v_mfma_f32_16x16x32_bf16 v[12:15], a[48:51], a[176:179], v[12:15]
  v_mfma_f32_16x16x32_bf16 v[16:19], a[48:51], a[180:183], v[16:19]
  v_mfma_f32_16x16x32_bf16 v[20:23], a[52:55], a[176:179], v[20:23]
  v_mfma_f32_16x16x32_bf16 v[24:27], a[52:55], a[180:183], v[24:27]
  s_waitcnt vmcnt(24)
  v_mfma_f32_16x16x32_bf16 v[12:15], a[56:59], a[184:187], v[12:15]
  v_mfma_f32_16x16x32_bf16 v[16:19], a[56:59], a[188:191], v[16:19]
  v_mfma_f32_16x16x32_bf16 v[20:23], a[60:63], a[184:187], v[20:23]
  v_mfma_f32_16x16x32_bf16 v[24:27], a[60:63], a[188:191], v[24:27]
  s_waitcnt vmcnt(22)
  v_mfma_f32_16x16x32_bf16 v[12:15], a[64:67], a[192:195], v[12:15]
  v_mfma_f32_16x16x32_bf16 v[16:19], a[64:67], a[196:199], v[16:19]
  v_mfma_f32_16x16x32_bf16 v[20:23], a[68:71], a[192:195], v[20:23]
  v_mfma_f32_16x16x32_bf16 v[24:27], a[68:71], a[196:199], v[24:27]
  s_waitcnt vmcnt(20)
  v_mfma_f32_16x16x32_bf16 v[12:15], a[72:75], a[200:203], v[12:15]
  v_mfma_f32_16x16x32_bf16 v[16:19], a[72:75], a[204:207], v[16:19]
  v_mfma_f32_16x16x32_bf16 v[20:23], a[76:79], a[200:203], v[20:23]
  v_mfma_f32_16x16x32_bf16 v[24:27], a[76:79], a[204:207], v[24:27]
  s_waitcnt vmcnt(18)
  v_mfma_f32_16x16x32_bf16 v[12:15], a[80:83], a[208:211], v[12:15]
  v_mfma_f32_16x16x32_bf16 v[16:19], a[80:83], a[212:215], v[16:19]
  v_mfma_f32_16x16x32_bf16 v[20:23], a[84:87], a[208:211], v[20:23]
  v_mfma_f32_16x16x32_bf16 v[24:27], a[84:87], a[212:215], v[24:27]
  s_waitcnt vmcnt(16)
  v_mfma_f32_16x16x32_bf16 v[12:15], a[88:91], a[216:219], v[12:15]
  v_mfma_f32_16x16x32_bf16 v[16:19], a[88:91], a[220:223], v[16:19]
  v_mfma_f32_16x16x32_bf16 v[20:23], a[92:95], a[216:219], v[20:23]
  v_mfma_f32_16x16x32_bf16 v[24:27], a[92:95], a[220:223], v[24:27]
  s_waitcnt vmcnt(14)
  v_mfma_f32_16x16x32_bf16 v[12:15], a[96:99], a[224:227], v[12:15]
  v_mfma_f32_16x16x32_bf16 v[16:19], a[96:99], a[228:231], v[16:19]
  v_mfma_f32_16x16x32_bf16 v[20:23], a[100:103], a[224:227], v[20:23]
  v_mfma_f32_16x16x32_bf16 v[24:27], a[100:103], a[228:231], v[24:27]
  s_waitcnt vmcnt(12)
  v_mfma_f32_16x16x32_bf16 v[12:15], a[104:107], a[232:235], v[12:15]
  v_mfma_f32_16x16x32_bf16 v[16:19], a[104:107], a[236:239], v[16:19]
  v_mfma_f32_16x16x32_bf16 v[20:23], a[108:111], a[232:235], v[20:23]
  v_mfma_f32_16x16x32_bf16 v[24:27], a[108:111], a[236:239], v[24:27]
  s_waitcnt vmcnt(10)
  v_mfma_f32_16x16x32_bf16 v[12:15], a[112:115], a[240:243], v[12:15]
  v_mfma_f32_16x16x32_bf16 v[16:19], a[112:115], a[244:247], v[16:19]
  v_mfma_f32_16x16x32_bf16 v[20:23], a[116:119], a[240:243], v[20:23]
  v_mfma_f32_16x16x32_bf16 v[24:27], a[116:119], a[244:247], v[24:27]
  s_waitcnt vmcnt(8)
  v_mfma_f32_16x16x32_bf16 v[12:15], a[120:123], a[248:251], v[12:15]
  v_mfma_f32_16x16x32_bf16 v[16:19], a[120:123], a[252:255], v[16:19]
  v_mfma_f32_16x16x32_bf16 v[20:23], a[124:127], a[248:251], v[20:23]
  v_mfma_f32_16x16x32_bf16 v[24:27], a[124:127], a[252:255], v[24:27]
  s_waitcnt vmcnt(0)
  v_mfma_f32_16x16x32_bf16 v[12:15], v[28:31], v[64:67], v[12:15]
  v_mfma_f32_16x16x32_bf16 v[16:19], v[28:31], v[68:71], v[16:19]
  v_mfma_f32_16x16x32_bf16 v[20:23], v[32:35], v[64:67], v[20:23]
  v_mfma_f32_16x16x32_bf16 v[24:27], v[32:35], v[68:71], v[24:27]
  v_mfma_f32_16x16x32_bf16 v[12:15], v[36:39], v[72:75], v[12:15]
  v_mfma_f32_16x16x32_bf16 v[16:19], v[36:39], v[76:79], v[16:19]
  v_mfma_f32_16x16x32_bf16 v[20:23], v[40:43], v[72:75], v[20:23]
  v_mfma_f32_16x16x32_bf16 v[24:27], v[40:43], v[76:79], v[24:27]
  v_mfma_f32_16x16x32_bf16 v[12:15], v[44:47], v[80:83], v[12:15]
  v_mfma_f32_16x16x32_bf16 v[16:19], v[44:47], v[84:87], v[16:19]
  v_mfma_f32_16x16x32_bf16 v[20:23], v[48:51], v[80:83], v[20:23]
  v_mfma_f32_16x16x32_bf16 v[24:27], v[48:51], v[84:87], v[24:27]
  v_mfma_f32_16x16x32_bf16 v[12:15], v[52:55], v[88:91], v[12:15]
  v_mfma_f32_16x16x32_bf16 v[16:19], v[52:55], v[92:95], v[16:19]
  v_mfma_f32_16x16x32_bf16 v[20:23], v[56:59], v[88:91], v[20:23]
  v_mfma_f32_16x16x32_bf16 v[24:27], v[56:59], v[92:95], v[24:27]
  v_mul_u32_u24 v9, 1792, v4
  v_lshl_add_u32 v9, v3, 3, v9
  s_lshl_b32 s22, s20, 5
  v_add_u32 v8, s22, v9
  s_mul_i32 s22, s20, 24
  s_add_u32 s22, s22, 512
  v_add_u32 v9, s22, v9
  v_mov_b32 v10, 0x40000000
  v_cmp_eq_u32 vcc, 3, v3
  s_nop 1
  v_cndmask_b32 v9, v9, v10, vcc
  s_mul_i32 s26, s17, 57344
  s_add_u32 s26, s26, 896
  s_add_u32 s27, s26, 28672
  v_cvt_pk_bf16_f32 v96, v12, v13
  v_cvt_pk_bf16_f32 v97, v14, v15
  buffer_store_dwordx2 v[96:97], v8, s[92:95], s26 offen
  v_cvt_pk_bf16_f32 v98, v20, v21
  v_cvt_pk_bf16_f32 v99, v22, v23
  buffer_store_dwordx2 v[98:99], v9, s[92:95], s26 offen
  v_cvt_pk_bf16_f32 v100, v16, v17
  v_cvt_pk_bf16_f32 v101, v18, v19
  buffer_store_dwordx2 v[100:101], v8, s[92:95], s27 offen
  v_cvt_pk_bf16_f32 v102, v24, v25
  v_cvt_pk_bf16_f32 v103, v26, v27
  buffer_store_dwordx2 v[102:103], v9, s[92:95], s27 offen
  s_branch wk_loop
wp_abort:
wo_abort:
  s_branch cA_abort
wk_done:
ch_end:
  s_endpgm

.section .rodata,"a"
.p2align 6
.amdhsa_kernel main_kernel
  .amdhsa_next_free_vgpr 512
  .amdhsa_next_free_sgpr 102
  .amdhsa_accum_offset 256
  .amdhsa_group_segment_fixed_size 0
  .amdhsa_kernarg_size 136
  .amdhsa_user_sgpr_count 2
  .amdhsa_user_sgpr_kernarg_segment_ptr 1
  .amdhsa_system_sgpr_workgroup_id_x 1
.end_amdhsa_kernel
```

```asm
; @launch kernel=main_kernel grid=(256,1,1) block=(256,1,1) lds=163840
.amdgcn_target "amdgcn-amd-amdhsa--gfx950"
.text
.globl main_kernel
.p2align 8
.type main_kernel,@function
main_kernel:
  s_cmp_ge_u32 s2, 256
  s_cbranch_scc1 ch_end
  s_load_dwordx2 s[4:5], s[0:1], 120
  s_load_dwordx2 s[6:7], s[0:1], 128
  s_load_dwordx8 s[40:47], s[0:1], 72
  s_load_dwordx4 s[48:51], s[0:1], 56
  s_getpc_b64 s[98:99]
pf_main_kernel_1:
  s_sub_u32 s98, s98, pf_main_kernel_1-main_kernel
  s_subb_u32 s99, s99, 0
  v_lshlrev_b32 v60, 7, v0
  v_min_u32 v61, ch_end-main_kernel-4, v60
  global_load_dword v62, v61, s[98:99]
  v_add_u32 v60, 32768, v60
  v_min_u32 v61, ch_end-main_kernel-4, v60
  global_load_dword v62, v61, s[98:99]
  v_add_u32 v60, 32768, v60
  v_min_u32 v61, ch_end-main_kernel-4, v60
  global_load_dword v62, v61, s[98:99]
  v_add_u32 v60, 32768, v60
  v_min_u32 v61, ch_end-main_kernel-4, v60
  global_load_dword v62, v61, s[98:99]
  v_add_u32 v60, 32768, v60
  s_mov_b32 s32, 0
  s_getreg_b32 s3, hwreg(HW_REG_XCC_ID)
  s_and_b32 s3, s3, 15
  v_lshrrev_b32 v1, 6, v0
  s_nop 0
  v_readfirstlane_b32 s16, v1
  s_waitcnt lgkmcnt(0)
  s_mov_b32 s8, s6
  s_and_b32 s9, s7, 0xffff
  s_mov_b32 s10, 0x10000000
  s_mov_b32 s11, 0x20000
  s_mov_b32 s12, s4
  s_and_b32 s13, s5, 0xffff
  s_mov_b32 s14, 256
  s_mov_b32 s15, 0x20000
  v_mov_b32 v252, 0x40000000
  v_cmp_eq_u32 vcc, 0, v0
  s_nop 1
  v_cndmask_b32 v252, v252, v0, vcc
  s_cmp_lg_u32 s3, 0
  s_cbranch_scc1 ch_worker
  s_cmp_lg_u32 s16, 0
  s_cbranch_scc1 ch_worker
  v_mov_b32 v249, 1
  s_mov_b64 exec, 1
  buffer_atomic_add v249, v252, s[12:15], 0 offen sc0
  s_mov_b64 exec, -1
  s_branch ch_worker
  s_cmp_lg_u32 s3, 0
  s_cbranch_scc1 ch_worker
  v_mov_b32 v4, 1
  s_mov_b32 s18, 0
ch_take:
  v_mov_b32 v5, 0
  v_mov_b32 v6, 160000
  s_barrier
  s_cmp_lg_u32 s16, 0
  s_cbranch_scc1 ch_el1
  s_mov_b64 exec, 1
  buffer_atomic_add v4, v5, s[12:15], 0 offen sc0
  s_waitcnt vmcnt(0)
  ds_write_b32 v6, v4
  s_waitcnt lgkmcnt(0)
  s_mov_b64 exec, -1
ch_el1:
  s_barrier
  ds_read_b32 v4, v6
  s_waitcnt lgkmcnt(0)
  v_readfirstlane_b32 s17, v4
  s_and_b32 s17, s17, 0xffff
  s_cmp_lt_u32 s17, 32
  s_cbranch_scc1 ch_role
  v_and_b32 v1, 63, v0
  v_lshlrev_b32 v2, 4, v1
  v_lshrrev_b32 v3, 4, v1
  v_and_b32 v4, 15, v1
  s_branch wp_all
  s_cmp_eq_u32 s18, 0
  s_cbranch_scc1 ch_worker
  s_branch ch_end
ch_role:
  s_mov_b32 s91, s17
ch_role2:
  s_mov_b32 s17, s91
  v_and_b32 v1, 63, v0
  v_lshlrev_b32 v2, 4, v1
  v_lshrrev_b32 v116, 4, v1
  v_and_b32 v117, 15, v1
  v_mov_b32 v3, 0x4444
  v_mov_b32 v118, 0xeeee
  v_cmp_lt_u32 vcc, 7, v117
  s_nop 1
  v_cndmask_b32 v3, v3, v118, vcc
  s_mov_b32 s19, 0
  s_mov_b32 s18, 1
  s_mov_b32 s20, 75694080
  s_mov_b32 s21, 75711744
  s_mov_b32 s23, 75698176
  s_lshr_b32 s89, s17, 4
  s_lshl_b32 s89, s89, 2
  s_add_u32 s89, s89, s16
  s_and_b32 s17, s17, 15
  s_cmp_eq_u32 s89, 0
  s_cbranch_scc1 ch_init0
  s_cmp_eq_u32 s89, 1
  s_cbranch_scc1 ch_init1
  s_cmp_eq_u32 s89, 2
  s_cbranch_scc1 ch_init2
  s_cmp_eq_u32 s89, 3
  s_cbranch_scc1 ch_init3
  s_cmp_eq_u32 s89, 4
  s_cbranch_scc1 ch_init4
  s_cmp_eq_u32 s89, 5
  s_cbranch_scc1 ch_init5
  s_cmp_eq_u32 s89, 6
  s_cbranch_scc1 ch_init6
  s_cmp_eq_u32 s89, 7
  s_cbranch_scc1 ch_init7
  s_branch ch_end
ch_init0:
  s_mul_i32 s31, s17, 401408
  s_add_u32 s31, s31, 0
  s_mov_b32 s30, 0
ch_wr0:
  buffer_load_dword v65, off, s[12:15], 0 offset:132 sc1
  s_waitcnt vmcnt(0)
  v_cmp_ne_u32 vcc, 1, v65
  s_cbranch_vccz ch_wr0_ok
  s_sleep 8
  s_add_u32 s30, s30, 1
  s_cmp_lt_u32 s30, 400000
  s_cbranch_scc1 ch_wr0
  s_branch cA_abort
ch_wr0_ok:
  s_lshl_b32 s27, s17, 7
  s_add_u32 s27, s27, 88521216
  s_mov_b32 s28, 129
  s_mov_b32 s30, 0
ch_wa0:
  buffer_load_dword v65, off, s[8:11], s27  sc1
  s_waitcnt vmcnt(0)
  v_and_b32 v66, s28, v65
  v_cmp_ne_u32 vcc, s28, v66
  s_cbranch_vccz ch_wa0_ok
  s_sleep 3
  s_add_u32 s30, s30, 1
  s_cmp_lt_u32 s30, 400000
  s_cbranch_scc1 ch_wa0
  s_branch cA_abort
ch_wa0_ok:
  v_readfirstlane_b32 s29, v65
  s_add_u32 s22, s31, 0
  buffer_load_dwordx4 a[0:3], v2, s[8:11], s22 offen offset:0 sc1
  buffer_load_dwordx4 a[4:7], v2, s[8:11], s22 offen offset:1024 sc1
  buffer_load_dwordx4 a[8:11], v2, s[8:11], s22 offen offset:2048 sc1
  buffer_load_dwordx4 a[12:15], v2, s[8:11], s22 offen offset:3072 sc1
  s_add_u32 s22, s31, 4096
  buffer_load_dwordx4 a[16:19], v2, s[8:11], s22 offen offset:0 sc1
  buffer_load_dwordx4 a[20:23], v2, s[8:11], s22 offen offset:1024 sc1
  buffer_load_dwordx4 a[24:27], v2, s[8:11], s22 offen offset:2048 sc1
  buffer_load_dwordx4 a[28:31], v2, s[8:11], s22 offen offset:3072 sc1
  s_add_u32 s22, s31, 8192
  buffer_load_dwordx4 a[32:35], v2, s[8:11], s22 offen offset:0 sc1
  buffer_load_dwordx4 a[36:39], v2, s[8:11], s22 offen offset:1024 sc1
  buffer_load_dwordx4 a[40:43], v2, s[8:11], s22 offen offset:2048 sc1
  buffer_load_dwordx4 a[44:47], v2, s[8:11], s22 offen offset:3072 sc1
  s_add_u32 s22, s31, 12288
  buffer_load_dwordx4 a[48:51], v2, s[8:11], s22 offen offset:0 sc1
  buffer_load_dwordx4 a[52:55], v2, s[8:11], s22 offen offset:1024 sc1
  buffer_load_dwordx4 a[56:59], v2, s[8:11], s22 offen offset:2048 sc1
  buffer_load_dwordx4 a[60:63], v2, s[8:11], s22 offen offset:3072 sc1
  s_add_u32 s22, s31, 16384
  buffer_load_dwordx4 a[64:67], v2, s[8:11], s22 offen offset:0 sc1
  buffer_load_dwordx4 a[68:71], v2, s[8:11], s22 offen offset:1024 sc1
  buffer_load_dwordx4 a[72:75], v2, s[8:11], s22 offen offset:2048 sc1
  buffer_load_dwordx4 a[76:79], v2, s[8:11], s22 offen offset:3072 sc1
  s_add_u32 s22, s31, 20480
  buffer_load_dwordx4 a[80:83], v2, s[8:11], s22 offen offset:0 sc1
  buffer_load_dwordx4 a[84:87], v2, s[8:11], s22 offen offset:1024 sc1
  buffer_load_dwordx4 a[88:91], v2, s[8:11], s22 offen offset:2048 sc1
  buffer_load_dwordx4 a[92:95], v2, s[8:11], s22 offen offset:3072 sc1
  s_add_u32 s22, s31, 24576
  buffer_load_dwordx4 a[96:99], v2, s[8:11], s22 offen offset:0 sc1
  buffer_load_dwordx4 a[100:103], v2, s[8:11], s22 offen offset:1024 sc1
  buffer_load_dwordx4 a[104:107], v2, s[8:11], s22 offen offset:2048 sc1
  buffer_load_dwordx4 a[108:111], v2, s[8:11], s22 offen offset:3072 sc1
  s_add_u32 s22, s31, 28672
  buffer_load_dwordx4 a[112:115], v2, s[8:11], s22 offen offset:0 sc1
  buffer_load_dwordx4 a[116:119], v2, s[8:11], s22 offen offset:1024 sc1
  buffer_load_dwordx4 a[120:123], v2, s[8:11], s22 offen offset:2048 sc1
  buffer_load_dwordx4 a[124:127], v2, s[8:11], s22 offen offset:3072 sc1
  s_waitcnt vmcnt(24)
  s_add_u32 s22, s31, 32768
  buffer_load_dwordx4 a[128:131], v2, s[8:11], s22 offen offset:0 sc1
  buffer_load_dwordx4 a[132:135], v2, s[8:11], s22 offen offset:1024 sc1
  buffer_load_dwordx4 a[136:139], v2, s[8:11], s22 offen offset:2048 sc1
  buffer_load_dwordx4 a[140:143], v2, s[8:11], s22 offen offset:3072 sc1
  s_add_u32 s22, s31, 36864
  buffer_load_dwordx4 a[144:147], v2, s[8:11], s22 offen offset:0 sc1
  buffer_load_dwordx4 a[148:151], v2, s[8:11], s22 offen offset:1024 sc1
  buffer_load_dwordx4 a[152:155], v2, s[8:11], s22 offen offset:2048 sc1
  buffer_load_dwordx4 a[156:159], v2, s[8:11], s22 offen offset:3072 sc1
  s_add_u32 s22, s31, 40960
  buffer_load_dwordx4 a[160:163], v2, s[8:11], s22 offen offset:0 sc1
  buffer_load_dwordx4 a[164:167], v2, s[8:11], s22 offen offset:1024 sc1
  buffer_load_dwordx4 a[168:171], v2, s[8:11], s22 offen offset:2048 sc1
  buffer_load_dwordx4 a[172:175], v2, s[8:11], s22 offen offset:3072 sc1
  s_add_u32 s22, s31, 45056
  buffer_load_dwordx4 a[176:179], v2, s[8:11], s22 offen offset:0 sc1
  buffer_load_dwordx4 a[180:183], v2, s[8:11], s22 offen offset:1024 sc1
  buffer_load_dwordx4 a[184:187], v2, s[8:11], s22 offen offset:2048 sc1
  buffer_load_dwordx4 a[188:191], v2, s[8:11], s22 offen offset:3072 sc1
  s_add_u32 s22, s31, 49152
  buffer_load_dwordx4 a[192:195], v2, s[8:11], s22 offen offset:0 sc1
  buffer_load_dwordx4 a[196:199], v2, s[8:11], s22 offen offset:1024 sc1
  buffer_load_dwordx4 a[200:203], v2, s[8:11], s22 offen offset:2048 sc1
  buffer_load_dwordx4 a[204:207], v2, s[8:11], s22 offen offset:3072 sc1
  s_add_u32 s22, s31, 53248
  buffer_load_dwordx4 a[208:211], v2, s[8:11], s22 offen offset:0 sc1
  buffer_load_dwordx4 a[212:215], v2, s[8:11], s22 offen offset:1024 sc1
  buffer_load_dwordx4 a[216:219], v2, s[8:11], s22 offen offset:2048 sc1
  buffer_load_dwordx4 a[220:223], v2, s[8:11], s22 offen offset:3072 sc1
  s_and_b32 s29, s29, 10320
  s_cmp_eq_u32 s29, 10320
  s_cbranch_scc1 ch_wb0_ok
  s_lshl_b32 s27, s17, 7
  s_add_u32 s27, s27, 88521216
  s_mov_b32 s28, 10320
  s_mov_b32 s30, 0
ch_wb0:
  buffer_load_dword v65, off, s[8:11], s27  sc1
  s_waitcnt vmcnt(0)
  v_and_b32 v66, s28, v65
  v_cmp_ne_u32 vcc, s28, v66
  s_cbranch_vccz ch_wb0_ok
  s_sleep 3
  s_add_u32 s30, s30, 1
  s_cmp_lt_u32 s30, 400000
  s_cbranch_scc1 ch_wb0
  s_branch cA_abort
ch_wb0_ok:
  s_waitcnt vmcnt(28)
  s_add_u32 s22, s31, 229376
  buffer_load_dwordx4 a[224:227], v2, s[8:11], s22 offen offset:0 sc1
  buffer_load_dwordx4 a[228:231], v2, s[8:11], s22 offen offset:1024 sc1
  buffer_load_dwordx4 a[232:235], v2, s[8:11], s22 offen offset:2048 sc1
  buffer_load_dwordx4 a[236:239], v2, s[8:11], s22 offen offset:3072 sc1
  s_add_u32 s22, s31, 233472
  buffer_load_dwordx4 a[240:243], v2, s[8:11], s22 offen offset:0 sc1
  buffer_load_dwordx4 a[244:247], v2, s[8:11], s22 offen offset:1024 sc1
  buffer_load_dwordx4 a[248:251], v2, s[8:11], s22 offen offset:2048 sc1
  buffer_load_dwordx4 a[252:255], v2, s[8:11], s22 offen offset:3072 sc1
  s_add_u32 s22, s31, 237568
  buffer_load_dwordx4 v[120:123], v2, s[8:11], s22 offen offset:0 sc1
  buffer_load_dwordx4 v[124:127], v2, s[8:11], s22 offen offset:1024 sc1
  buffer_load_dwordx4 v[128:131], v2, s[8:11], s22 offen offset:2048 sc1
  buffer_load_dwordx4 v[132:135], v2, s[8:11], s22 offen offset:3072 sc1
  s_add_u32 s22, s31, 241664
  buffer_load_dwordx4 v[136:139], v2, s[8:11], s22 offen offset:0 sc1
  buffer_load_dwordx4 v[140:143], v2, s[8:11], s22 offen offset:1024 sc1
  buffer_load_dwordx4 v[144:147], v2, s[8:11], s22 offen offset:2048 sc1
  buffer_load_dwordx4 v[148:151], v2, s[8:11], s22 offen offset:3072 sc1
  s_add_u32 s22, s31, 245760
  buffer_load_dwordx4 v[152:155], v2, s[8:11], s22 offen offset:0 sc1
  buffer_load_dwordx4 v[156:159], v2, s[8:11], s22 offen offset:1024 sc1
  buffer_load_dwordx4 v[160:163], v2, s[8:11], s22 offen offset:2048 sc1
  buffer_load_dwordx4 v[164:167], v2, s[8:11], s22 offen offset:3072 sc1
  s_add_u32 s22, s31, 249856
  buffer_load_dwordx4 v[168:171], v2, s[8:11], s22 offen offset:0 sc1
  buffer_load_dwordx4 v[172:175], v2, s[8:11], s22 offen offset:1024 sc1
  buffer_load_dwordx4 v[176:179], v2, s[8:11], s22 offen offset:2048 sc1
  buffer_load_dwordx4 v[180:183], v2, s[8:11], s22 offen offset:3072 sc1
  s_add_u32 s22, s31, 253952
  buffer_load_dwordx4 v[184:187], v2, s[8:11], s22 offen offset:0 sc1
  buffer_load_dwordx4 v[188:191], v2, s[8:11], s22 offen offset:1024 sc1
  buffer_load_dwordx4 v[192:195], v2, s[8:11], s22 offen offset:2048 sc1
  buffer_load_dwordx4 v[196:199], v2, s[8:11], s22 offen offset:3072 sc1
  s_add_u32 s22, s31, 372736
  buffer_load_dwordx4 v[200:203], v2, s[8:11], s22 offen offset:0 sc1
  buffer_load_dwordx4 v[204:207], v2, s[8:11], s22 offen offset:1024 sc1
  buffer_load_dwordx4 v[208:211], v2, s[8:11], s22 offen offset:2048 sc1
  buffer_load_dwordx4 v[212:215], v2, s[8:11], s22 offen offset:3072 sc1
  s_waitcnt vmcnt(24)
  s_add_u32 s22, s31, 376832
  buffer_load_dwordx4 v[216:219], v2, s[8:11], s22 offen offset:0 sc1
  buffer_load_dwordx4 v[220:223], v2, s[8:11], s22 offen offset:1024 sc1
  buffer_load_dwordx4 v[224:227], v2, s[8:11], s22 offen offset:2048 sc1
  buffer_load_dwordx4 v[228:231], v2, s[8:11], s22 offen offset:3072 sc1
  s_add_u32 s22, s31, 380928
  buffer_load_dwordx4 v[232:235], v2, s[8:11], s22 offen offset:0 sc1
  buffer_load_dwordx4 v[236:239], v2, s[8:11], s22 offen offset:1024 sc1
  buffer_load_dwordx4 v[240:243], v2, s[8:11], s22 offen offset:2048 sc1
  buffer_load_dwordx4 v[244:247], v2, s[8:11], s22 offen offset:3072 sc1
  s_add_u32 s22, s31, 385024
  buffer_load_dwordx4 v[248:251], v2, s[8:11], s22 offen offset:0 sc1
  buffer_load_dwordx4 v[252:255], v2, s[8:11], s22 offen offset:1024 sc1
  s_mov_b32 s27, 88523264
  s_mov_b32 s28, 0xffff
  s_mov_b32 s30, 0
ch_wx0:
  buffer_load_dword v65, off, s[8:11], s27  sc1
  s_waitcnt vmcnt(0)
  v_and_b32 v66, s28, v65
  v_cmp_ne_u32 vcc, s28, v66
  s_cbranch_vccz ch_wx0_ok
  s_sleep 8
  s_add_u32 s30, s30, 1
  s_cmp_lt_u32 s30, 400000
  s_cbranch_scc1 ch_wx0
  s_branch cA_abort
ch_wx0_ok:
  s_mov_b32 s24, 72024064
  s_mov_b32 s26, 72038400
  v_and_b32 v64, 7, v117
  v_and_b32 v65, 1, v116
  v_lshlrev_b32 v65, 2, v65
  v_sub_u32 v64, v64, v65
  v_lshrrev_b32 v65, 3, v117
  v_lshl_add_u32 v66, v65, 2, v64
  v_cmp_gt_u32 vcc, 4, v64
  v_mov_b32 v67, 99
  s_nop 0
  v_cndmask_b32 v66, v67, v66, vcc
  v_mov_b32 v68, 0x3f80
  v_mov_b32 v69, 0x3f800000
  v_mov_b32 v4, 0
  v_cmp_eq_u32 vcc, 0, v66
  s_nop 1
  v_cndmask_b32 v4, v4, v68, vcc
  v_cmp_eq_u32 vcc, 1, v66
  s_nop 1
  v_cndmask_b32 v4, v4, v69, vcc
  v_mov_b32 v5, 0
  v_cmp_eq_u32 vcc, 2, v66
  s_nop 1
  v_cndmask_b32 v5, v5, v68, vcc
  v_cmp_eq_u32 vcc, 3, v66
  s_nop 1
  v_cndmask_b32 v5, v5, v69, vcc
  v_mov_b32 v6, 0
  v_cmp_eq_u32 vcc, 4, v66
  s_nop 1
  v_cndmask_b32 v6, v6, v68, vcc
  v_cmp_eq_u32 vcc, 5, v66
  s_nop 1
  v_cndmask_b32 v6, v6, v69, vcc
  v_mov_b32 v7, 0
  v_cmp_eq_u32 vcc, 6, v66
  s_nop 1
  v_cndmask_b32 v7, v7, v68, vcc
  v_cmp_eq_u32 vcc, 7, v66
  s_nop 1
  v_cndmask_b32 v7, v7, v69, vcc
  v_lshrrev_b32 v64, 1, v116
  v_lshrrev_b32 v65, 3, v117
  v_and_b32 v66, 1, v116
  v_and_b32 v68, 7, v117
  v_lshlrev_b32 v67, 8, v65
  v_lshl_add_u32 v67, v68, 5, v67
  v_lshl_add_u32 v67, v66, 4, v67
  v_add_u32 v69, 4096, v67
  v_add_u32 v70, 6400, v67
  v_cmp_eq_u32 vcc, v64, v65
  s_nop 1
  v_cndmask_b32 v113, v70, v69, vcc
  v_lshlrev_b32 v67, 9, v64
  v_lshl_add_u32 v67, v117, 4, v67
  v_lshl_add_u32 v67, v66, 3, v67
  v_add_u32 v114, 0, v67
  v_mul_u32_u24 v67, 1088, v65
  v_lshl_add_u32 v67, v116, 5, v67
  v_lshl_add_u32 v67, v68, 2, v67
  v_add_u32 v115, 4096, v67
  v_and_b32 v69, 1, v117
  v_lshlrev_b32 v67, 7, v69
  v_lshl_add_u32 v67, v116, 4, v67
  v_lshl_add_u32 v67, v65, 8, v67
  v_bfe_u32 v69, v117, 1, 2
  v_lshl_add_u32 v67, v69, 2, v67
  s_lshl_b32 s22, s17, 9
  s_add_u32 s22, s22, 9216
  v_add_u32 v72, s22, v67
  v_bfe_u32 v69, v117, 1, 1
  v_lshlrev_b32 v67, 7, v69
  v_lshl_add_u32 v67, v116, 4, v67
  v_and_b32 v69, 4, v117
  v_add_u32 v67, v67, v69
  s_lshr_b32 s22, s17, 1
  s_lshl_b32 s22, s22, 8
  s_and_b32 s27, s17, 1
  s_lshl_b32 s27, s27, 3
  s_add_u32 s22, s22, s27
  s_add_u32 s22, s22, 7168
  v_add_u32 v67, s22, v67
  v_and_b32 v69, 9, v117
  v_mov_b32 v70, 0x40000000
  v_cmp_eq_u32 vcc, 0, v69
  s_nop 1
  v_cndmask_b32 v118, v70, v67, vcc
  v_mov_b32 v119, -1
  v_and_b32 v0, 15, v1
  s_and_b32 s22, s17, 0
  s_lshl_b32 s22, s22, 7
  s_add_u32 s22, s22, 75731456
  v_lshl_add_u32 v0, v0, 2, s22
  v_xor_b32 v69, 256, v2
  v_mul_i32_i24 v70, -4096, v66
  v_add_u32 v69, v69, v70
  v_add_u32 v117, 12288, v69
  v_mov_b32 v116, v73
  s_mul_i32 s35, s17, 28672
  s_add_u32 s35, s35, 44040192
  v_mov_b32 v1, v72
  v_mov_b32 v36, 0
  v_mov_b32 v37, 0
  v_mov_b32 v38, 0
  v_mov_b32 v39, 0
  v_mov_b32 v40, 0
  v_mov_b32 v41, 0
  v_mov_b32 v42, 0
  v_mov_b32 v43, 0
  v_mov_b32 v44, 0
  v_mov_b32 v45, 0
  v_mov_b32 v46, 0
  v_mov_b32 v47, 0
  v_mov_b32 v48, 0
  v_mov_b32 v49, 0
  v_mov_b32 v50, 0
  v_mov_b32 v51, 0
  v_mov_b32 v52, 0
  v_mov_b32 v53, 0
  v_mov_b32 v54, 0
  v_mov_b32 v55, 0
  v_mov_b32 v56, 0
  v_mov_b32 v57, 0
  v_mov_b32 v58, 0
  v_mov_b32 v59, 0
  v_mov_b32 v60, 0
  v_mov_b32 v61, 0
  v_mov_b32 v62, 0
  v_mov_b32 v63, 0
  v_mov_b32 v64, 0
  v_mov_b32 v65, 0
  v_mov_b32 v66, 0
  v_mov_b32 v67, 0
  v_mov_b32 v68, 0
  v_mov_b32 v69, 0
  v_mov_b32 v70, 0
  v_mov_b32 v71, 0
  v_mov_b32 v72, 0
  v_mov_b32 v73, 0
  v_mov_b32 v74, 0
  v_mov_b32 v75, 0
  v_mov_b32 v76, 0
  v_mov_b32 v77, 0
  v_mov_b32 v78, 0
  v_mov_b32 v79, 0
  buffer_load_dwordx4 v[80:83], v117, s[8:11], s24 offen offset:0 sc1
  buffer_load_dwordx4 v[84:87], v117, s[8:11], s24 offen offset:1024 sc1
  s_mov_b32 s30, 0
  v_mov_b32 v8, 0
ch_md0:
  buffer_load_dword v9, v8, s[12:15], 0 offen sc1
  s_waitcnt vmcnt(0) lgkmcnt(0)
  v_readfirstlane_b32 s22, v9
  s_and_b32 s31, s22, 0xffff
  s_cmp_ge_u32 s31, 32
  s_cbranch_scc1 ch_go0
  s_sleep 2
  s_add_u32 s30, s30, 1
  s_cmp_lt_u32 s30, 3200000
  s_cbranch_scc1 ch_md0
  s_branch ch_end
ch_go0:
  s_mov_b32 s31, 0
  s_lshr_b32 s22, s22, 16
  s_cmp_lg_u32 s22, 0
  s_cbranch_scc1 cB_sc0_loop
  s_branch cA_sc0_loop
ch_init1:
  s_mul_i32 s31, s17, 401408
  s_add_u32 s31, s31, 0
  s_mov_b32 s30, 0
ch_wr1:
  buffer_load_dword v65, off, s[12:15], 0 offset:132 sc1
  s_waitcnt vmcnt(0)
  v_cmp_ne_u32 vcc, 1, v65
  s_cbranch_vccz ch_wr1_ok
  s_sleep 8
  s_add_u32 s30, s30, 1
  s_cmp_lt_u32 s30, 400000
  s_cbranch_scc1 ch_wr1
  s_branch cA_abort
ch_wr1_ok:
  s_lshl_b32 s27, s17, 7
  s_add_u32 s27, s27, 88521216
  s_mov_b32 s28, 258
  s_mov_b32 s30, 0
ch_wa1:
  buffer_load_dword v65, off, s[8:11], s27  sc1
  s_waitcnt vmcnt(0)
  v_and_b32 v66, s28, v65
  v_cmp_ne_u32 vcc, s28, v66
  s_cbranch_vccz ch_wa1_ok
  s_sleep 3
  s_add_u32 s30, s30, 1
  s_cmp_lt_u32 s30, 400000
  s_cbranch_scc1 ch_wa1
  s_branch cA_abort
ch_wa1_ok:
  v_readfirstlane_b32 s29, v65
  s_add_u32 s22, s31, 57344
  buffer_load_dwordx4 a[0:3], v2, s[8:11], s22 offen offset:0 sc1
  buffer_load_dwordx4 a[4:7], v2, s[8:11], s22 offen offset:1024 sc1
  buffer_load_dwordx4 a[8:11], v2, s[8:11], s22 offen offset:2048 sc1
  buffer_load_dwordx4 a[12:15], v2, s[8:11], s22 offen offset:3072 sc1
  s_add_u32 s22, s31, 61440
  buffer_load_dwordx4 a[16:19], v2, s[8:11], s22 offen offset:0 sc1
  buffer_load_dwordx4 a[20:23], v2, s[8:11], s22 offen offset:1024 sc1
  buffer_load_dwordx4 a[24:27], v2, s[8:11], s22 offen offset:2048 sc1
  buffer_load_dwordx4 a[28:31], v2, s[8:11], s22 offen offset:3072 sc1
  s_add_u32 s22, s31, 65536
  buffer_load_dwordx4 a[32:35], v2, s[8:11], s22 offen offset:0 sc1
  buffer_load_dwordx4 a[36:39], v2, s[8:11], s22 offen offset:1024 sc1
  buffer_load_dwordx4 a[40:43], v2, s[8:11], s22 offen offset:2048 sc1
  buffer_load_dwordx4 a[44:47], v2, s[8:11], s22 offen offset:3072 sc1
  s_add_u32 s22, s31, 69632
  buffer_load_dwordx4 a[48:51], v2, s[8:11], s22 offen offset:0 sc1
  buffer_load_dwordx4 a[52:55], v2, s[8:11], s22 offen offset:1024 sc1
  buffer_load_dwordx4 a[56:59], v2, s[8:11], s22 offen offset:2048 sc1
  buffer_load_dwordx4 a[60:63], v2, s[8:11], s22 offen offset:3072 sc1
  s_add_u32 s22, s31, 73728
  buffer_load_dwordx4 a[64:67], v2, s[8:11], s22 offen offset:0 sc1
  buffer_load_dwordx4 a[68:71], v2, s[8:11], s22 offen offset:1024 sc1
  buffer_load_dwordx4 a[72:75], v2, s[8:11], s22 offen offset:2048 sc1
  buffer_load_dwordx4 a[76:79], v2, s[8:11], s22 offen offset:3072 sc1
  s_add_u32 s22, s31, 77824
  buffer_load_dwordx4 a[80:83], v2, s[8:11], s22 offen offset:0 sc1
  buffer_load_dwordx4 a[84:87], v2, s[8:11], s22 offen offset:1024 sc1
  buffer_load_dwordx4 a[88:91], v2, s[8:11], s22 offen offset:2048 sc1
  buffer_load_dwordx4 a[92:95], v2, s[8:11], s22 offen offset:3072 sc1
  s_add_u32 s22, s31, 81920
  buffer_load_dwordx4 a[96:99], v2, s[8:11], s22 offen offset:0 sc1
  buffer_load_dwordx4 a[100:103], v2, s[8:11], s22 offen offset:1024 sc1
  buffer_load_dwordx4 a[104:107], v2, s[8:11], s22 offen offset:2048 sc1
  buffer_load_dwordx4 a[108:111], v2, s[8:11], s22 offen offset:3072 sc1
  s_add_u32 s22, s31, 86016
  buffer_load_dwordx4 a[112:115], v2, s[8:11], s22 offen offset:0 sc1
  buffer_load_dwordx4 a[116:119], v2, s[8:11], s22 offen offset:1024 sc1
  buffer_load_dwordx4 a[120:123], v2, s[8:11], s22 offen offset:2048 sc1
  buffer_load_dwordx4 a[124:127], v2, s[8:11], s22 offen offset:3072 sc1
  s_waitcnt vmcnt(24)
  s_add_u32 s22, s31, 90112
  buffer_load_dwordx4 a[128:131], v2, s[8:11], s22 offen offset:0 sc1
  buffer_load_dwordx4 a[132:135], v2, s[8:11], s22 offen offset:1024 sc1
  buffer_load_dwordx4 a[136:139], v2, s[8:11], s22 offen offset:2048 sc1
  buffer_load_dwordx4 a[140:143], v2, s[8:11], s22 offen offset:3072 sc1
  s_add_u32 s22, s31, 94208
  buffer_load_dwordx4 a[144:147], v2, s[8:11], s22 offen offset:0 sc1
  buffer_load_dwordx4 a[148:151], v2, s[8:11], s22 offen offset:1024 sc1
  buffer_load_dwordx4 a[152:155], v2, s[8:11], s22 offen offset:2048 sc1
  buffer_load_dwordx4 a[156:159], v2, s[8:11], s22 offen offset:3072 sc1
  s_add_u32 s22, s31, 98304
  buffer_load_dwordx4 a[160:163], v2, s[8:11], s22 offen offset:0 sc1
  buffer_load_dwordx4 a[164:167], v2, s[8:11], s22 offen offset:1024 sc1
  buffer_load_dwordx4 a[168:171], v2, s[8:11], s22 offen offset:2048 sc1
  buffer_load_dwordx4 a[172:175], v2, s[8:11], s22 offen offset:3072 sc1
  s_add_u32 s22, s31, 102400
  buffer_load_dwordx4 a[176:179], v2, s[8:11], s22 offen offset:0 sc1
  buffer_load_dwordx4 a[180:183], v2, s[8:11], s22 offen offset:1024 sc1
  buffer_load_dwordx4 a[184:187], v2, s[8:11], s22 offen offset:2048 sc1
  buffer_load_dwordx4 a[188:191], v2, s[8:11], s22 offen offset:3072 sc1
  s_add_u32 s22, s31, 106496
  buffer_load_dwordx4 a[192:195], v2, s[8:11], s22 offen offset:0 sc1
  buffer_load_dwordx4 a[196:199], v2, s[8:11], s22 offen offset:1024 sc1
  buffer_load_dwordx4 a[200:203], v2, s[8:11], s22 offen offset:2048 sc1
  buffer_load_dwordx4 a[204:207], v2, s[8:11], s22 offen offset:3072 sc1
  s_add_u32 s22, s31, 110592
  buffer_load_dwordx4 a[208:211], v2, s[8:11], s22 offen offset:0 sc1
  buffer_load_dwordx4 a[212:215], v2, s[8:11], s22 offen offset:1024 sc1
  buffer_load_dwordx4 a[216:219], v2, s[8:11], s22 offen offset:2048 sc1
  buffer_load_dwordx4 a[220:223], v2, s[8:11], s22 offen offset:3072 sc1
  s_and_b32 s29, s29, 10320
  s_cmp_eq_u32 s29, 10320
  s_cbranch_scc1 ch_wb1_ok
  s_lshl_b32 s27, s17, 7
  s_add_u32 s27, s27, 88521216
  s_mov_b32 s28, 10320
  s_mov_b32 s30, 0
ch_wb1:
  buffer_load_dword v65, off, s[8:11], s27  sc1
  s_waitcnt vmcnt(0)
  v_and_b32 v66, s28, v65
  v_cmp_ne_u32 vcc, s28, v66
  s_cbranch_vccz ch_wb1_ok
  s_sleep 3
  s_add_u32 s30, s30, 1
  s_cmp_lt_u32 s30, 400000
  s_cbranch_scc1 ch_wb1
  s_branch cA_abort
ch_wb1_ok:
  s_waitcnt vmcnt(28)
  s_add_u32 s22, s31, 258048
  buffer_load_dwordx4 a[224:227], v2, s[8:11], s22 offen offset:0 sc1
  buffer_load_dwordx4 a[228:231], v2, s[8:11], s22 offen offset:1024 sc1
  buffer_load_dwordx4 a[232:235], v2, s[8:11], s22 offen offset:2048 sc1
  buffer_load_dwordx4 a[236:239], v2, s[8:11], s22 offen offset:3072 sc1
  s_add_u32 s22, s31, 262144
  buffer_load_dwordx4 a[240:243], v2, s[8:11], s22 offen offset:0 sc1
  buffer_load_dwordx4 a[244:247], v2, s[8:11], s22 offen offset:1024 sc1
  buffer_load_dwordx4 a[248:251], v2, s[8:11], s22 offen offset:2048 sc1
  buffer_load_dwordx4 a[252:255], v2, s[8:11], s22 offen offset:3072 sc1
  s_add_u32 s22, s31, 266240
  buffer_load_dwordx4 v[120:123], v2, s[8:11], s22 offen offset:0 sc1
  buffer_load_dwordx4 v[124:127], v2, s[8:11], s22 offen offset:1024 sc1
  buffer_load_dwordx4 v[128:131], v2, s[8:11], s22 offen offset:2048 sc1
  buffer_load_dwordx4 v[132:135], v2, s[8:11], s22 offen offset:3072 sc1
  s_add_u32 s22, s31, 270336
  buffer_load_dwordx4 v[136:139], v2, s[8:11], s22 offen offset:0 sc1
  buffer_load_dwordx4 v[140:143], v2, s[8:11], s22 offen offset:1024 sc1
  buffer_load_dwordx4 v[144:147], v2, s[8:11], s22 offen offset:2048 sc1
  buffer_load_dwordx4 v[148:151], v2, s[8:11], s22 offen offset:3072 sc1
  s_add_u32 s22, s31, 274432
  buffer_load_dwordx4 v[152:155], v2, s[8:11], s22 offen offset:0 sc1
  buffer_load_dwordx4 v[156:159], v2, s[8:11], s22 offen offset:1024 sc1
  buffer_load_dwordx4 v[160:163], v2, s[8:11], s22 offen offset:2048 sc1
  buffer_load_dwordx4 v[164:167], v2, s[8:11], s22 offen offset:3072 sc1
  s_add_u32 s22, s31, 278528
  buffer_load_dwordx4 v[168:171], v2, s[8:11], s22 offen offset:0 sc1
  buffer_load_dwordx4 v[172:175], v2, s[8:11], s22 offen offset:1024 sc1
  buffer_load_dwordx4 v[176:179], v2, s[8:11], s22 offen offset:2048 sc1
  buffer_load_dwordx4 v[180:183], v2, s[8:11], s22 offen offset:3072 sc1
  s_add_u32 s22, s31, 282624
  buffer_load_dwordx4 v[184:187], v2, s[8:11], s22 offen offset:0 sc1
  buffer_load_dwordx4 v[188:191], v2, s[8:11], s22 offen offset:1024 sc1
  buffer_load_dwordx4 v[192:195], v2, s[8:11], s22 offen offset:2048 sc1
  buffer_load_dwordx4 v[196:199], v2, s[8:11], s22 offen offset:3072 sc1
  s_add_u32 s22, s31, 344064
  buffer_load_dwordx4 v[200:203], v2, s[8:11], s22 offen offset:0 sc1
  buffer_load_dwordx4 v[204:207], v2, s[8:11], s22 offen offset:1024 sc1
  buffer_load_dwordx4 v[208:211], v2, s[8:11], s22 offen offset:2048 sc1
  buffer_load_dwordx4 v[212:215], v2, s[8:11], s22 offen offset:3072 sc1
  s_waitcnt vmcnt(24)
  s_add_u32 s22, s31, 348160
  buffer_load_dwordx4 v[216:219], v2, s[8:11], s22 offen offset:0 sc1
  buffer_load_dwordx4 v[220:223], v2, s[8:11], s22 offen offset:1024 sc1
  buffer_load_dwordx4 v[224:227], v2, s[8:11], s22 offen offset:2048 sc1
  buffer_load_dwordx4 v[228:231], v2, s[8:11], s22 offen offset:3072 sc1
  s_add_u32 s22, s31, 352256
  buffer_load_dwordx4 v[232:235], v2, s[8:11], s22 offen offset:0 sc1
  buffer_load_dwordx4 v[236:239], v2, s[8:11], s22 offen offset:1024 sc1
  buffer_load_dwordx4 v[240:243], v2, s[8:11], s22 offen offset:2048 sc1
  buffer_load_dwordx4 v[244:247], v2, s[8:11], s22 offen offset:3072 sc1
  s_add_u32 s22, s31, 356352
  buffer_load_dwordx4 v[248:251], v2, s[8:11], s22 offen offset:0 sc1
  buffer_load_dwordx4 v[252:255], v2, s[8:11], s22 offen offset:1024 sc1
  s_mov_b32 s27, 88523264
  s_mov_b32 s28, 0xffff
  s_mov_b32 s30, 0
ch_wx1:
  buffer_load_dword v65, off, s[8:11], s27  sc1
  s_waitcnt vmcnt(0)
  v_and_b32 v66, s28, v65
  v_cmp_ne_u32 vcc, s28, v66
  s_cbranch_vccz ch_wx1_ok
  s_sleep 8
  s_add_u32 s30, s30, 1
  s_cmp_lt_u32 s30, 400000
  s_cbranch_scc1 ch_wx1
  s_branch cA_abort
ch_wx1_ok:
  s_mov_b32 s24, 72026112
  s_mov_b32 s26, 72040448
  v_and_b32 v64, 7, v117
  v_and_b32 v65, 1, v116
  v_lshlrev_b32 v65, 2, v65
  v_sub_u32 v64, v64, v65
  v_lshrrev_b32 v65, 3, v117
  v_lshl_add_u32 v66, v65, 2, v64
  v_cmp_gt_u32 vcc, 4, v64
  v_mov_b32 v67, 99
  s_nop 0
  v_cndmask_b32 v66, v67, v66, vcc
  v_mov_b32 v68, 0x3f80
  v_mov_b32 v69, 0x3f800000
  v_mov_b32 v4, 0
  v_cmp_eq_u32 vcc, 0, v66
  s_nop 1
  v_cndmask_b32 v4, v4, v68, vcc
  v_cmp_eq_u32 vcc, 1, v66
  s_nop 1
  v_cndmask_b32 v4, v4, v69, vcc
  v_mov_b32 v5, 0
  v_cmp_eq_u32 vcc, 2, v66
  s_nop 1
  v_cndmask_b32 v5, v5, v68, vcc
  v_cmp_eq_u32 vcc, 3, v66
  s_nop 1
  v_cndmask_b32 v5, v5, v69, vcc
  v_mov_b32 v6, 0
  v_cmp_eq_u32 vcc, 4, v66
  s_nop 1
  v_cndmask_b32 v6, v6, v68, vcc
  v_cmp_eq_u32 vcc, 5, v66
  s_nop 1
  v_cndmask_b32 v6, v6, v69, vcc
  v_mov_b32 v7, 0
  v_cmp_eq_u32 vcc, 6, v66
  s_nop 1
  v_cndmask_b32 v7, v7, v68, vcc
  v_cmp_eq_u32 vcc, 7, v66
  s_nop 1
  v_cndmask_b32 v7, v7, v69, vcc
  v_lshrrev_b32 v64, 1, v116
  v_lshrrev_b32 v65, 3, v117
  v_and_b32 v66, 1, v116
  v_and_b32 v68, 7, v117
  v_lshlrev_b32 v67, 8, v65
  v_lshl_add_u32 v67, v68, 5, v67
  v_lshl_add_u32 v67, v66, 4, v67
  v_add_u32 v69, 4608, v67
  v_add_u32 v70, 6400, v67
  v_cmp_eq_u32 vcc, v64, v65
  s_nop 1
  v_cndmask_b32 v113, v70, v69, vcc
  v_lshlrev_b32 v67, 9, v64
  v_lshl_add_u32 v67, v117, 4, v67
  v_lshl_add_u32 v67, v66, 3, v67
  v_add_u32 v114, 256, v67
  v_mul_u32_u24 v67, 1088, v65
  v_lshl_add_u32 v67, v116, 5, v67
  v_lshl_add_u32 v67, v68, 2, v67
  v_add_u32 v115, 4224, v67
  v_and_b32 v69, 1, v117
  v_lshlrev_b32 v67, 7, v69
  v_lshl_add_u32 v67, v116, 4, v67
  v_lshl_add_u32 v67, v65, 8, v67
  v_bfe_u32 v69, v117, 1, 2
  v_lshl_add_u32 v67, v69, 2, v67
  s_lshl_b32 s22, s17, 9
  s_add_u32 s22, s22, 9280
  v_add_u32 v72, s22, v67
  v_bfe_u32 v69, v117, 1, 1
  v_lshlrev_b32 v67, 7, v69
  v_lshl_add_u32 v67, v116, 4, v67
  v_and_b32 v69, 4, v117
  v_add_u32 v67, v67, v69
  s_lshr_b32 s22, s17, 1
  s_lshl_b32 s22, s22, 8
  s_and_b32 s27, s17, 1
  s_lshl_b32 s27, s27, 3
  s_add_u32 s22, s22, s27
  s_add_u32 s22, s22, 7232
  v_add_u32 v67, s22, v67
  v_and_b32 v69, 9, v117
  v_mov_b32 v70, 0x40000000
  v_cmp_eq_u32 vcc, 0, v69
  s_nop 1
  v_cndmask_b32 v118, v70, v67, vcc
  v_mov_b32 v119, -1
  s_lshl_b32 s22, s17, 2
  s_add_u32 s22, s22, 75729408
  v_lshl_add_u32 v67, v1, 7, s22
  v_mov_b32 v70, 0x40000000
  v_cmp_gt_u32 vcc, 1, v1
  s_nop 1
  v_cndmask_b32 v73, v70, v67, vcc
  v_mov_b32 v112, 1
  v_and_b32 v0, 15, v1
  s_and_b32 s22, s17, 0
  s_lshl_b32 s22, s22, 7
  s_add_u32 s22, s22, 75731456
  v_lshl_add_u32 v0, v0, 2, s22
  v_xor_b32 v69, 256, v2
  v_mul_i32_i24 v70, 4096, v66
  v_add_u32 v69, v69, v70
  v_add_u32 v117, 6144, v69
  v_mov_b32 v116, v73
  s_mul_i32 s35, s17, 28672
  s_add_u32 s35, s35, 44040192
  v_mov_b32 v1, v72
  v_mov_b32 v36, 0
  v_mov_b32 v37, 0
  v_mov_b32 v38, 0
  v_mov_b32 v39, 0
  v_mov_b32 v40, 0
  v_mov_b32 v41, 0
  v_mov_b32 v42, 0
  v_mov_b32 v43, 0
  v_mov_b32 v44, 0
  v_mov_b32 v45, 0
  v_mov_b32 v46, 0
  v_mov_b32 v47, 0
  v_mov_b32 v48, 0
  v_mov_b32 v49, 0
  v_mov_b32 v50, 0
  v_mov_b32 v51, 0
  v_mov_b32 v52, 0
  v_mov_b32 v53, 0
  v_mov_b32 v54, 0
  v_mov_b32 v55, 0
  v_mov_b32 v56, 0
  v_mov_b32 v57, 0
  v_mov_b32 v58, 0
  v_mov_b32 v59, 0
  v_mov_b32 v60, 0
  v_mov_b32 v61, 0
  v_mov_b32 v62, 0
  v_mov_b32 v63, 0
  v_mov_b32 v64, 0
  v_mov_b32 v65, 0
  v_mov_b32 v66, 0
  v_mov_b32 v67, 0
  v_mov_b32 v68, 0
  v_mov_b32 v69, 0
  v_mov_b32 v70, 0
  v_mov_b32 v71, 0
  v_mov_b32 v72, 0
  v_mov_b32 v73, 0
  v_mov_b32 v74, 0
  v_mov_b32 v75, 0
  v_mov_b32 v76, 0
  v_mov_b32 v77, 0
  v_mov_b32 v78, 0
  v_mov_b32 v79, 0
  buffer_load_dwordx4 v[80:83], v117, s[8:11], s24 offen offset:0 sc1
  buffer_load_dwordx4 v[84:87], v117, s[8:11], s24 offen offset:1024 sc1
  s_mov_b32 s30, 0
  v_mov_b32 v8, 0
ch_md1:
  buffer_load_dword v9, v8, s[12:15], 0 offen sc1
  s_waitcnt vmcnt(0) lgkmcnt(0)
  v_readfirstlane_b32 s22, v9
  s_and_b32 s31, s22, 0xffff
  s_cmp_ge_u32 s31, 32
  s_cbranch_scc1 ch_go1
  s_sleep 2
  s_add_u32 s30, s30, 1
  s_cmp_lt_u32 s30, 3200000
  s_cbranch_scc1 ch_md1
  s_branch ch_end
ch_go1:
  s_mov_b32 s31, 0
  s_lshr_b32 s22, s22, 16
  s_cmp_lg_u32 s22, 0
  s_cbranch_scc1 cB_sc1_loop
  s_branch cA_sc1_loop
ch_init2:
  s_mul_i32 s31, s17, 401408
  s_add_u32 s31, s31, 0
  s_mov_b32 s30, 0
ch_wr2:
  buffer_load_dword v65, off, s[12:15], 0 offset:132 sc1
  s_waitcnt vmcnt(0)
  v_cmp_ne_u32 vcc, 1, v65
  s_cbranch_vccz ch_wr2_ok
  s_sleep 8
  s_add_u32 s30, s30, 1
  s_cmp_lt_u32 s30, 400000
  s_cbranch_scc1 ch_wr2
  s_branch cA_abort
ch_wr2_ok:
  s_lshl_b32 s27, s17, 7
  s_add_u32 s27, s27, 88521216
  s_mov_b32 s28, 516
  s_mov_b32 s30, 0
ch_wa2:
  buffer_load_dword v65, off, s[8:11], s27  sc1
  s_waitcnt vmcnt(0)
  v_and_b32 v66, s28, v65
  v_cmp_ne_u32 vcc, s28, v66
  s_cbranch_vccz ch_wa2_ok
  s_sleep 3
  s_add_u32 s30, s30, 1
  s_cmp_lt_u32 s30, 400000
  s_cbranch_scc1 ch_wa2
  s_branch cA_abort
ch_wa2_ok:
  v_readfirstlane_b32 s29, v65
  s_add_u32 s22, s31, 114688
  buffer_load_dwordx4 a[0:3], v2, s[8:11], s22 offen offset:0 sc1
  buffer_load_dwordx4 a[4:7], v2, s[8:11], s22 offen offset:1024 sc1
  buffer_load_dwordx4 a[8:11], v2, s[8:11], s22 offen offset:2048 sc1
  buffer_load_dwordx4 a[12:15], v2, s[8:11], s22 offen offset:3072 sc1
  s_add_u32 s22, s31, 118784
  buffer_load_dwordx4 a[16:19], v2, s[8:11], s22 offen offset:0 sc1
  buffer_load_dwordx4 a[20:23], v2, s[8:11], s22 offen offset:1024 sc1
  buffer_load_dwordx4 a[24:27], v2, s[8:11], s22 offen offset:2048 sc1
  buffer_load_dwordx4 a[28:31], v2, s[8:11], s22 offen offset:3072 sc1
  s_add_u32 s22, s31, 122880
  buffer_load_dwordx4 a[32:35], v2, s[8:11], s22 offen offset:0 sc1
  buffer_load_dwordx4 a[36:39], v2, s[8:11], s22 offen offset:1024 sc1
  buffer_load_dwordx4 a[40:43], v2, s[8:11], s22 offen offset:2048 sc1
  buffer_load_dwordx4 a[44:47], v2, s[8:11], s22 offen offset:3072 sc1
  s_add_u32 s22, s31, 126976
  buffer_load_dwordx4 a[48:51], v2, s[8:11], s22 offen offset:0 sc1
  buffer_load_dwordx4 a[52:55], v2, s[8:11], s22 offen offset:1024 sc1
  buffer_load_dwordx4 a[56:59], v2, s[8:11], s22 offen offset:2048 sc1
  buffer_load_dwordx4 a[60:63], v2, s[8:11], s22 offen offset:3072 sc1
  s_add_u32 s22, s31, 131072
  buffer_load_dwordx4 a[64:67], v2, s[8:11], s22 offen offset:0 sc1
  buffer_load_dwordx4 a[68:71], v2, s[8:11], s22 offen offset:1024 sc1
  buffer_load_dwordx4 a[72:75], v2, s[8:11], s22 offen offset:2048 sc1
  buffer_load_dwordx4 a[76:79], v2, s[8:11], s22 offen offset:3072 sc1
  s_add_u32 s22, s31, 135168
  buffer_load_dwordx4 a[80:83], v2, s[8:11], s22 offen offset:0 sc1
  buffer_load_dwordx4 a[84:87], v2, s[8:11], s22 offen offset:1024 sc1
  buffer_load_dwordx4 a[88:91], v2, s[8:11], s22 offen offset:2048 sc1
  buffer_load_dwordx4 a[92:95], v2, s[8:11], s22 offen offset:3072 sc1
  s_add_u32 s22, s31, 139264
  buffer_load_dwordx4 a[96:99], v2, s[8:11], s22 offen offset:0 sc1
  buffer_load_dwordx4 a[100:103], v2, s[8:11], s22 offen offset:1024 sc1
  buffer_load_dwordx4 a[104:107], v2, s[8:11], s22 offen offset:2048 sc1
  buffer_load_dwordx4 a[108:111], v2, s[8:11], s22 offen offset:3072 sc1
  s_add_u32 s22, s31, 143360
  buffer_load_dwordx4 a[112:115], v2, s[8:11], s22 offen offset:0 sc1
  buffer_load_dwordx4 a[116:119], v2, s[8:11], s22 offen offset:1024 sc1
  buffer_load_dwordx4 a[120:123], v2, s[8:11], s22 offen offset:2048 sc1
  buffer_load_dwordx4 a[124:127], v2, s[8:11], s22 offen offset:3072 sc1
  s_waitcnt vmcnt(24)
  s_add_u32 s22, s31, 147456
  buffer_load_dwordx4 a[128:131], v2, s[8:11], s22 offen offset:0 sc1
  buffer_load_dwordx4 a[132:135], v2, s[8:11], s22 offen offset:1024 sc1
  buffer_load_dwordx4 a[136:139], v2, s[8:11], s22 offen offset:2048 sc1
  buffer_load_dwordx4 a[140:143], v2, s[8:11], s22 offen offset:3072 sc1
  s_add_u32 s22, s31, 151552
  buffer_load_dwordx4 a[144:147], v2, s[8:11], s22 offen offset:0 sc1
  buffer_load_dwordx4 a[148:151], v2, s[8:11], s22 offen offset:1024 sc1
  buffer_load_dwordx4 a[152:155], v2, s[8:11], s22 offen offset:2048 sc1
  buffer_load_dwordx4 a[156:159], v2, s[8:11], s22 offen offset:3072 sc1
  s_add_u32 s22, s31, 155648
  buffer_load_dwordx4 a[160:163], v2, s[8:11], s22 offen offset:0 sc1
  buffer_load_dwordx4 a[164:167], v2, s[8:11], s22 offen offset:1024 sc1
  buffer_load_dwordx4 a[168:171], v2, s[8:11], s22 offen offset:2048 sc1
  buffer_load_dwordx4 a[172:175], v2, s[8:11], s22 offen offset:3072 sc1
  s_add_u32 s22, s31, 159744
  buffer_load_dwordx4 a[176:179], v2, s[8:11], s22 offen offset:0 sc1
  buffer_load_dwordx4 a[180:183], v2, s[8:11], s22 offen offset:1024 sc1
  buffer_load_dwordx4 a[184:187], v2, s[8:11], s22 offen offset:2048 sc1
  buffer_load_dwordx4 a[188:191], v2, s[8:11], s22 offen offset:3072 sc1
  s_add_u32 s22, s31, 163840
  buffer_load_dwordx4 a[192:195], v2, s[8:11], s22 offen offset:0 sc1
  buffer_load_dwordx4 a[196:199], v2, s[8:11], s22 offen offset:1024 sc1
  buffer_load_dwordx4 a[200:203], v2, s[8:11], s22 offen offset:2048 sc1
  buffer_load_dwordx4 a[204:207], v2, s[8:11], s22 offen offset:3072 sc1
  s_add_u32 s22, s31, 167936
  buffer_load_dwordx4 a[208:211], v2, s[8:11], s22 offen offset:0 sc1
  buffer_load_dwordx4 a[212:215], v2, s[8:11], s22 offen offset:1024 sc1
  buffer_load_dwordx4 a[216:219], v2, s[8:11], s22 offen offset:2048 sc1
  buffer_load_dwordx4 a[220:223], v2, s[8:11], s22 offen offset:3072 sc1
  s_and_b32 s29, s29, 12384
  s_cmp_eq_u32 s29, 12384
  s_cbranch_scc1 ch_wb2_ok
  s_lshl_b32 s27, s17, 7
  s_add_u32 s27, s27, 88521216
  s_mov_b32 s28, 12384
  s_mov_b32 s30, 0
ch_wb2:
  buffer_load_dword v65, off, s[8:11], s27  sc1
  s_waitcnt vmcnt(0)
  v_and_b32 v66, s28, v65
  v_cmp_ne_u32 vcc, s28, v66
  s_cbranch_vccz ch_wb2_ok
  s_sleep 3
  s_add_u32 s30, s30, 1
  s_cmp_lt_u32 s30, 400000
  s_cbranch_scc1 ch_wb2
  s_branch cA_abort
ch_wb2_ok:
  s_waitcnt vmcnt(28)
  s_add_u32 s22, s31, 286720
  buffer_load_dwordx4 a[224:227], v2, s[8:11], s22 offen offset:0 sc1
  buffer_load_dwordx4 a[228:231], v2, s[8:11], s22 offen offset:1024 sc1
  buffer_load_dwordx4 a[232:235], v2, s[8:11], s22 offen offset:2048 sc1
  buffer_load_dwordx4 a[236:239], v2, s[8:11], s22 offen offset:3072 sc1
  s_add_u32 s22, s31, 290816
  buffer_load_dwordx4 a[240:243], v2, s[8:11], s22 offen offset:0 sc1
  buffer_load_dwordx4 a[244:247], v2, s[8:11], s22 offen offset:1024 sc1
  buffer_load_dwordx4 a[248:251], v2, s[8:11], s22 offen offset:2048 sc1
  buffer_load_dwordx4 a[252:255], v2, s[8:11], s22 offen offset:3072 sc1
  s_add_u32 s22, s31, 294912
  buffer_load_dwordx4 v[120:123], v2, s[8:11], s22 offen offset:0 sc1
  buffer_load_dwordx4 v[124:127], v2, s[8:11], s22 offen offset:1024 sc1
  buffer_load_dwordx4 v[128:131], v2, s[8:11], s22 offen offset:2048 sc1
  buffer_load_dwordx4 v[132:135], v2, s[8:11], s22 offen offset:3072 sc1
  s_add_u32 s22, s31, 299008
  buffer_load_dwordx4 v[136:139], v2, s[8:11], s22 offen offset:0 sc1
  buffer_load_dwordx4 v[140:143], v2, s[8:11], s22 offen offset:1024 sc1
  buffer_load_dwordx4 v[144:147], v2, s[8:11], s22 offen offset:2048 sc1
  buffer_load_dwordx4 v[148:151], v2, s[8:11], s22 offen offset:3072 sc1
  s_add_u32 s22, s31, 303104
  buffer_load_dwordx4 v[152:155], v2, s[8:11], s22 offen offset:0 sc1
  buffer_load_dwordx4 v[156:159], v2, s[8:11], s22 offen offset:1024 sc1
  buffer_load_dwordx4 v[160:163], v2, s[8:11], s22 offen offset:2048 sc1
  buffer_load_dwordx4 v[164:167], v2, s[8:11], s22 offen offset:3072 sc1
  s_add_u32 s22, s31, 307200
  buffer_load_dwordx4 v[168:171], v2, s[8:11], s22 offen offset:0 sc1
  buffer_load_dwordx4 v[172:175], v2, s[8:11], s22 offen offset:1024 sc1
  buffer_load_dwordx4 v[176:179], v2, s[8:11], s22 offen offset:2048 sc1
  buffer_load_dwordx4 v[180:183], v2, s[8:11], s22 offen offset:3072 sc1
  s_add_u32 s22, s31, 311296
  buffer_load_dwordx4 v[184:187], v2, s[8:11], s22 offen offset:0 sc1
  buffer_load_dwordx4 v[188:191], v2, s[8:11], s22 offen offset:1024 sc1
  buffer_load_dwordx4 v[192:195], v2, s[8:11], s22 offen offset:2048 sc1
  buffer_load_dwordx4 v[196:199], v2, s[8:11], s22 offen offset:3072 sc1
  s_add_u32 s22, s31, 385024
  buffer_load_dwordx4 v[200:203], v2, s[8:11], s22 offen offset:2048 sc1
  buffer_load_dwordx4 v[204:207], v2, s[8:11], s22 offen offset:3072 sc1
  s_add_u32 s22, s31, 389120
  buffer_load_dwordx4 v[208:211], v2, s[8:11], s22 offen offset:0 sc1
  buffer_load_dwordx4 v[212:215], v2, s[8:11], s22 offen offset:1024 sc1
  s_waitcnt vmcnt(24)
  buffer_load_dwordx4 v[216:219], v2, s[8:11], s22 offen offset:2048 sc1
  buffer_load_dwordx4 v[220:223], v2, s[8:11], s22 offen offset:3072 sc1
  s_add_u32 s22, s31, 393216
  buffer_load_dwordx4 v[224:227], v2, s[8:11], s22 offen offset:0 sc1
  buffer_load_dwordx4 v[228:231], v2, s[8:11], s22 offen offset:1024 sc1
  buffer_load_dwordx4 v[232:235], v2, s[8:11], s22 offen offset:2048 sc1
  buffer_load_dwordx4 v[236:239], v2, s[8:11], s22 offen offset:3072 sc1
  s_add_u32 s22, s31, 397312
  buffer_load_dwordx4 v[240:243], v2, s[8:11], s22 offen offset:0 sc1
  buffer_load_dwordx4 v[244:247], v2, s[8:11], s22 offen offset:1024 sc1
  buffer_load_dwordx4 v[248:251], v2, s[8:11], s22 offen offset:2048 sc1
  buffer_load_dwordx4 v[252:255], v2, s[8:11], s22 offen offset:3072 sc1
  s_mov_b32 s27, 88523264
  s_mov_b32 s28, 0xffff
  s_mov_b32 s30, 0
ch_wx2:
  buffer_load_dword v65, off, s[8:11], s27  sc1
  s_waitcnt vmcnt(0)
  v_and_b32 v66, s28, v65
  v_cmp_ne_u32 vcc, s28, v66
  s_cbranch_vccz ch_wx2_ok
  s_sleep 8
  s_add_u32 s30, s30, 1
  s_cmp_lt_u32 s30, 400000
  s_cbranch_scc1 ch_wx2
  s_branch cA_abort
ch_wx2_ok:
  s_mov_b32 s24, 72028160
  s_mov_b32 s26, 72042496
  v_and_b32 v64, 7, v117
  v_and_b32 v65, 1, v116
  v_lshlrev_b32 v65, 2, v65
  v_sub_u32 v64, v64, v65
  v_lshrrev_b32 v65, 3, v117
  v_lshl_add_u32 v66, v65, 2, v64
  v_cmp_gt_u32 vcc, 4, v64
  v_mov_b32 v67, 99
  s_nop 0
  v_cndmask_b32 v66, v67, v66, vcc
  v_mov_b32 v68, 0x3f80
  v_mov_b32 v69, 0x3f800000
  v_mov_b32 v4, 0
  v_cmp_eq_u32 vcc, 0, v66
  s_nop 1
  v_cndmask_b32 v4, v4, v68, vcc
  v_cmp_eq_u32 vcc, 1, v66
  s_nop 1
  v_cndmask_b32 v4, v4, v69, vcc
  v_mov_b32 v5, 0
  v_cmp_eq_u32 vcc, 2, v66
  s_nop 1
  v_cndmask_b32 v5, v5, v68, vcc
  v_cmp_eq_u32 vcc, 3, v66
  s_nop 1
  v_cndmask_b32 v5, v5, v69, vcc
  v_mov_b32 v6, 0
  v_cmp_eq_u32 vcc, 4, v66
  s_nop 1
  v_cndmask_b32 v6, v6, v68, vcc
  v_cmp_eq_u32 vcc, 5, v66
  s_nop 1
  v_cndmask_b32 v6, v6, v69, vcc
  v_mov_b32 v7, 0
  v_cmp_eq_u32 vcc, 6, v66
  s_nop 1
  v_cndmask_b32 v7, v7, v68, vcc
  v_cmp_eq_u32 vcc, 7, v66
  s_nop 1
  v_cndmask_b32 v7, v7, v69, vcc
  v_lshrrev_b32 v64, 1, v116
  v_lshrrev_b32 v65, 3, v117
  v_and_b32 v66, 1, v116
  v_and_b32 v68, 7, v117
  v_lshlrev_b32 v67, 8, v65
  v_lshl_add_u32 v67, v68, 5, v67
  v_lshl_add_u32 v67, v66, 4, v67
  v_add_u32 v69, 5184, v67
  v_add_u32 v70, 6400, v67
  v_cmp_eq_u32 vcc, v64, v65
  s_nop 1
  v_cndmask_b32 v113, v70, v69, vcc
  v_and_b32 v0, 15, v1
  s_and_b32 s22, s17, 0
  s_lshl_b32 s22, s22, 7
  s_add_u32 s22, s22, 75731456
  v_lshl_add_u32 v0, v0, 2, s22
  v_xor_b32 v69, 256, v2
  v_mul_i32_i24 v70, -2048, v66
  v_add_u32 v69, v69, v70
  v_add_u32 v117, 8192, v69
  v_mov_b32 v116, v73
  s_mul_i32 s35, s17, 28672
  s_add_u32 s35, s35, 44040192
  v_mov_b32 v36, 0
  v_mov_b32 v37, 0
  v_mov_b32 v38, 0
  v_mov_b32 v39, 0
  v_mov_b32 v40, 0
  v_mov_b32 v41, 0
  v_mov_b32 v42, 0
  v_mov_b32 v43, 0
  v_mov_b32 v44, 0
  v_mov_b32 v45, 0
  v_mov_b32 v46, 0
  v_mov_b32 v47, 0
  v_mov_b32 v48, 0
  v_mov_b32 v49, 0
  v_mov_b32 v50, 0
  v_mov_b32 v51, 0
  v_mov_b32 v52, 0
  v_mov_b32 v53, 0
  v_mov_b32 v54, 0
  v_mov_b32 v55, 0
  v_mov_b32 v56, 0
  v_mov_b32 v57, 0
  v_mov_b32 v58, 0
  v_mov_b32 v59, 0
  v_mov_b32 v60, 0
  v_mov_b32 v61, 0
  v_mov_b32 v62, 0
  v_mov_b32 v63, 0
  v_mov_b32 v64, 0
  v_mov_b32 v65, 0
  v_mov_b32 v66, 0
  v_mov_b32 v67, 0
  v_mov_b32 v68, 0
  v_mov_b32 v69, 0
  v_mov_b32 v70, 0
  v_mov_b32 v71, 0
  v_mov_b32 v72, 0
  v_mov_b32 v73, 0
  v_mov_b32 v74, 0
  v_mov_b32 v75, 0
  v_mov_b32 v76, 0
  v_mov_b32 v77, 0
  v_mov_b32 v78, 0
  v_mov_b32 v79, 0
  buffer_load_dwordx4 v[80:83], v117, s[8:11], s24 offen offset:0 sc1
  buffer_load_dwordx4 v[84:87], v117, s[8:11], s24 offen offset:1024 sc1
  s_mov_b32 s30, 0
  v_mov_b32 v8, 0
ch_md2:
  buffer_load_dword v9, v8, s[12:15], 0 offen sc1
  s_waitcnt vmcnt(0) lgkmcnt(0)
  v_readfirstlane_b32 s22, v9
  s_and_b32 s31, s22, 0xffff
  s_cmp_ge_u32 s31, 32
  s_cbranch_scc1 ch_go2
  s_sleep 2
  s_add_u32 s30, s30, 1
  s_cmp_lt_u32 s30, 3200000
  s_cbranch_scc1 ch_md2
  s_branch ch_end
ch_go2:
  s_mov_b32 s31, 0
  s_lshr_b32 s22, s22, 16
  s_cmp_lg_u32 s22, 0
  s_cbranch_scc1 cB_sc2_loop
  s_branch cA_sc2_loop
ch_init3:
  s_mul_i32 s31, s17, 401408
  s_add_u32 s31, s31, 0
  s_mov_b32 s30, 0
ch_wr3:
  buffer_load_dword v65, off, s[12:15], 0 offset:132 sc1
  s_waitcnt vmcnt(0)
  v_cmp_ne_u32 vcc, 1, v65
  s_cbranch_vccz ch_wr3_ok
  s_sleep 8
  s_add_u32 s30, s30, 1
  s_cmp_lt_u32 s30, 400000
  s_cbranch_scc1 ch_wr3
  s_branch cA_abort
ch_wr3_ok:
  s_lshl_b32 s27, s17, 7
  s_add_u32 s27, s27, 88521216
  s_mov_b32 s28, 1032
  s_mov_b32 s30, 0
ch_wa3:
  buffer_load_dword v65, off, s[8:11], s27  sc1
  s_waitcnt vmcnt(0)
  v_and_b32 v66, s28, v65
  v_cmp_ne_u32 vcc, s28, v66
  s_cbranch_vccz ch_wa3_ok
  s_sleep 3
  s_add_u32 s30, s30, 1
  s_cmp_lt_u32 s30, 400000
  s_cbranch_scc1 ch_wa3
  s_branch cA_abort
ch_wa3_ok:
  v_readfirstlane_b32 s29, v65
  s_add_u32 s22, s31, 172032
  buffer_load_dwordx4 a[0:3], v2, s[8:11], s22 offen offset:0 sc1
  buffer_load_dwordx4 a[4:7], v2, s[8:11], s22 offen offset:1024 sc1
  buffer_load_dwordx4 a[8:11], v2, s[8:11], s22 offen offset:2048 sc1
  buffer_load_dwordx4 a[12:15], v2, s[8:11], s22 offen offset:3072 sc1
  s_add_u32 s22, s31, 176128
  buffer_load_dwordx4 a[16:19], v2, s[8:11], s22 offen offset:0 sc1
  buffer_load_dwordx4 a[20:23], v2, s[8:11], s22 offen offset:1024 sc1
  buffer_load_dwordx4 a[24:27], v2, s[8:11], s22 offen offset:2048 sc1
  buffer_load_dwordx4 a[28:31], v2, s[8:11], s22 offen offset:3072 sc1
  s_add_u32 s22, s31, 180224
  buffer_load_dwordx4 a[32:35], v2, s[8:11], s22 offen offset:0 sc1
  buffer_load_dwordx4 a[36:39], v2, s[8:11], s22 offen offset:1024 sc1
  buffer_load_dwordx4 a[40:43], v2, s[8:11], s22 offen offset:2048 sc1
  buffer_load_dwordx4 a[44:47], v2, s[8:11], s22 offen offset:3072 sc1
  s_add_u32 s22, s31, 184320
  buffer_load_dwordx4 a[48:51], v2, s[8:11], s22 offen offset:0 sc1
  buffer_load_dwordx4 a[52:55], v2, s[8:11], s22 offen offset:1024 sc1
  buffer_load_dwordx4 a[56:59], v2, s[8:11], s22 offen offset:2048 sc1
  buffer_load_dwordx4 a[60:63], v2, s[8:11], s22 offen offset:3072 sc1
  s_add_u32 s22, s31, 188416
  buffer_load_dwordx4 a[64:67], v2, s[8:11], s22 offen offset:0 sc1
  buffer_load_dwordx4 a[68:71], v2, s[8:11], s22 offen offset:1024 sc1
  buffer_load_dwordx4 a[72:75], v2, s[8:11], s22 offen offset:2048 sc1
  buffer_load_dwordx4 a[76:79], v2, s[8:11], s22 offen offset:3072 sc1
  s_add_u32 s22, s31, 192512
  buffer_load_dwordx4 a[80:83], v2, s[8:11], s22 offen offset:0 sc1
  buffer_load_dwordx4 a[84:87], v2, s[8:11], s22 offen offset:1024 sc1
  buffer_load_dwordx4 a[88:91], v2, s[8:11], s22 offen offset:2048 sc1
  buffer_load_dwordx4 a[92:95], v2, s[8:11], s22 offen offset:3072 sc1
  s_add_u32 s22, s31, 196608
  buffer_load_dwordx4 a[96:99], v2, s[8:11], s22 offen offset:0 sc1
  buffer_load_dwordx4 a[100:103], v2, s[8:11], s22 offen offset:1024 sc1
  buffer_load_dwordx4 a[104:107], v2, s[8:11], s22 offen offset:2048 sc1
  buffer_load_dwordx4 a[108:111], v2, s[8:11], s22 offen offset:3072 sc1
  s_add_u32 s22, s31, 200704
  buffer_load_dwordx4 a[112:115], v2, s[8:11], s22 offen offset:0 sc1
  buffer_load_dwordx4 a[116:119], v2, s[8:11], s22 offen offset:1024 sc1
  buffer_load_dwordx4 a[120:123], v2, s[8:11], s22 offen offset:2048 sc1
  buffer_load_dwordx4 a[124:127], v2, s[8:11], s22 offen offset:3072 sc1
  s_waitcnt vmcnt(24)
  s_add_u32 s22, s31, 204800
  buffer_load_dwordx4 a[128:131], v2, s[8:11], s22 offen offset:0 sc1
  buffer_load_dwordx4 a[132:135], v2, s[8:11], s22 offen offset:1024 sc1
  buffer_load_dwordx4 a[136:139], v2, s[8:11], s22 offen offset:2048 sc1
  buffer_load_dwordx4 a[140:143], v2, s[8:11], s22 offen offset:3072 sc1
  s_add_u32 s22, s31, 208896
  buffer_load_dwordx4 a[144:147], v2, s[8:11], s22 offen offset:0 sc1
  buffer_load_dwordx4 a[148:151], v2, s[8:11], s22 offen offset:1024 sc1
  buffer_load_dwordx4 a[152:155], v2, s[8:11], s22 offen offset:2048 sc1
  buffer_load_dwordx4 a[156:159], v2, s[8:11], s22 offen offset:3072 sc1
  s_add_u32 s22, s31, 212992
  buffer_load_dwordx4 a[160:163], v2, s[8:11], s22 offen offset:0 sc1
  buffer_load_dwordx4 a[164:167], v2, s[8:11], s22 offen offset:1024 sc1
  buffer_load_dwordx4 a[168:171], v2, s[8:11], s22 offen offset:2048 sc1
  buffer_load_dwordx4 a[172:175], v2, s[8:11], s22 offen offset:3072 sc1
  s_add_u32 s22, s31, 217088
  buffer_load_dwordx4 a[176:179], v2, s[8:11], s22 offen offset:0 sc1
  buffer_load_dwordx4 a[180:183], v2, s[8:11], s22 offen offset:1024 sc1
  buffer_load_dwordx4 a[184:187], v2, s[8:11], s22 offen offset:2048 sc1
  buffer_load_dwordx4 a[188:191], v2, s[8:11], s22 offen offset:3072 sc1
  s_add_u32 s22, s31, 221184
  buffer_load_dwordx4 a[192:195], v2, s[8:11], s22 offen offset:0 sc1
  buffer_load_dwordx4 a[196:199], v2, s[8:11], s22 offen offset:1024 sc1
  buffer_load_dwordx4 a[200:203], v2, s[8:11], s22 offen offset:2048 sc1
  buffer_load_dwordx4 a[204:207], v2, s[8:11], s22 offen offset:3072 sc1
  s_add_u32 s22, s31, 225280
  buffer_load_dwordx4 a[208:211], v2, s[8:11], s22 offen offset:0 sc1
  buffer_load_dwordx4 a[212:215], v2, s[8:11], s22 offen offset:1024 sc1
  buffer_load_dwordx4 a[216:219], v2, s[8:11], s22 offen offset:2048 sc1
  buffer_load_dwordx4 a[220:223], v2, s[8:11], s22 offen offset:3072 sc1
  s_and_b32 s29, s29, 12384
  s_cmp_eq_u32 s29, 12384
  s_cbranch_scc1 ch_wb3_ok
  s_lshl_b32 s27, s17, 7
  s_add_u32 s27, s27, 88521216
  s_mov_b32 s28, 12384
  s_mov_b32 s30, 0
ch_wb3:
  buffer_load_dword v65, off, s[8:11], s27  sc1
  s_waitcnt vmcnt(0)
  v_and_b32 v66, s28, v65
  v_cmp_ne_u32 vcc, s28, v66
  s_cbranch_vccz ch_wb3_ok
  s_sleep 3
  s_add_u32 s30, s30, 1
  s_cmp_lt_u32 s30, 400000
  s_cbranch_scc1 ch_wb3
  s_branch cA_abort
ch_wb3_ok:
  s_waitcnt vmcnt(28)
  s_add_u32 s22, s31, 315392
  buffer_load_dwordx4 a[224:227], v2, s[8:11], s22 offen offset:0 sc1
  buffer_load_dwordx4 a[228:231], v2, s[8:11], s22 offen offset:1024 sc1
  buffer_load_dwordx4 a[232:235], v2, s[8:11], s22 offen offset:2048 sc1
  buffer_load_dwordx4 a[236:239], v2, s[8:11], s22 offen offset:3072 sc1
  s_add_u32 s22, s31, 319488
  buffer_load_dwordx4 a[240:243], v2, s[8:11], s22 offen offset:0 sc1
  buffer_load_dwordx4 a[244:247], v2, s[8:11], s22 offen offset:1024 sc1
  buffer_load_dwordx4 a[248:251], v2, s[8:11], s22 offen offset:2048 sc1
  buffer_load_dwordx4 a[252:255], v2, s[8:11], s22 offen offset:3072 sc1
  s_add_u32 s22, s31, 323584
  buffer_load_dwordx4 v[120:123], v2, s[8:11], s22 offen offset:0 sc1
  buffer_load_dwordx4 v[124:127], v2, s[8:11], s22 offen offset:1024 sc1
  buffer_load_dwordx4 v[128:131], v2, s[8:11], s22 offen offset:2048 sc1
  buffer_load_dwordx4 v[132:135], v2, s[8:11], s22 offen offset:3072 sc1
  s_add_u32 s22, s31, 327680
  buffer_load_dwordx4 v[136:139], v2, s[8:11], s22 offen offset:0 sc1
  buffer_load_dwordx4 v[140:143], v2, s[8:11], s22 offen offset:1024 sc1
  buffer_load_dwordx4 v[144:147], v2, s[8:11], s22 offen offset:2048 sc1
  buffer_load_dwordx4 v[148:151], v2, s[8:11], s22 offen offset:3072 sc1
  s_add_u32 s22, s31, 331776
  buffer_load_dwordx4 v[152:155], v2, s[8:11], s22 offen offset:0 sc1
  buffer_load_dwordx4 v[156:159], v2, s[8:11], s22 offen offset:1024 sc1
  buffer_load_dwordx4 v[160:163], v2, s[8:11], s22 offen offset:2048 sc1
  buffer_load_dwordx4 v[164:167], v2, s[8:11], s22 offen offset:3072 sc1
  s_add_u32 s22, s31, 335872
  buffer_load_dwordx4 v[168:171], v2, s[8:11], s22 offen offset:0 sc1
  buffer_load_dwordx4 v[172:175], v2, s[8:11], s22 offen offset:1024 sc1
  buffer_load_dwordx4 v[176:179], v2, s[8:11], s22 offen offset:2048 sc1
  buffer_load_dwordx4 v[180:183], v2, s[8:11], s22 offen offset:3072 sc1
  s_add_u32 s22, s31, 339968
  buffer_load_dwordx4 v[184:187], v2, s[8:11], s22 offen offset:0 sc1
  buffer_load_dwordx4 v[188:191], v2, s[8:11], s22 offen offset:1024 sc1
  buffer_load_dwordx4 v[192:195], v2, s[8:11], s22 offen offset:2048 sc1
  buffer_load_dwordx4 v[196:199], v2, s[8:11], s22 offen offset:3072 sc1
  s_add_u32 s22, s31, 356352
  buffer_load_dwordx4 v[200:203], v2, s[8:11], s22 offen offset:2048 sc1
  buffer_load_dwordx4 v[204:207], v2, s[8:11], s22 offen offset:3072 sc1
  s_add_u32 s22, s31, 360448
  buffer_load_dwordx4 v[208:211], v2, s[8:11], s22 offen offset:0 sc1
  buffer_load_dwordx4 v[212:215], v2, s[8:11], s22 offen offset:1024 sc1
  s_waitcnt vmcnt(24)
  buffer_load_dwordx4 v[216:219], v2, s[8:11], s22 offen offset:2048 sc1
  buffer_load_dwordx4 v[220:223], v2, s[8:11], s22 offen offset:3072 sc1
  s_add_u32 s22, s31, 364544
  buffer_load_dwordx4 v[224:227], v2, s[8:11], s22 offen offset:0 sc1
  buffer_load_dwordx4 v[228:231], v2, s[8:11], s22 offen offset:1024 sc1
  buffer_load_dwordx4 v[232:235], v2, s[8:11], s22 offen offset:2048 sc1
  buffer_load_dwordx4 v[236:239], v2, s[8:11], s22 offen offset:3072 sc1
  s_add_u32 s22, s31, 368640
  buffer_load_dwordx4 v[240:243], v2, s[8:11], s22 offen offset:0 sc1
  buffer_load_dwordx4 v[244:247], v2, s[8:11], s22 offen offset:1024 sc1
  buffer_load_dwordx4 v[248:251], v2, s[8:11], s22 offen offset:2048 sc1
  buffer_load_dwordx4 v[252:255], v2, s[8:11], s22 offen offset:3072 sc1
  s_mov_b32 s22, 75694080
  v_add_u32 v64, 0, v1
  v_min_u32 v64, 323, v64
  v_lshlrev_b32 v64, 7, v64
  buffer_load_dword v65, v64, s[8:11], s22 offen sc1
  v_add_u32 v64, 64, v1
  v_min_u32 v64, 323, v64
  v_lshlrev_b32 v64, 7, v64
  buffer_load_dword v65, v64, s[8:11], s22 offen sc1
  v_add_u32 v64, 128, v1
  v_min_u32 v64, 323, v64
  v_lshlrev_b32 v64, 7, v64
  buffer_load_dword v65, v64, s[8:11], s22 offen sc1
  v_add_u32 v64, 192, v1
  v_min_u32 v64, 323, v64
  v_lshlrev_b32 v64, 7, v64
  buffer_load_dword v65, v64, s[8:11], s22 offen sc1
  v_add_u32 v64, 256, v1
  v_min_u32 v64, 323, v64
  v_lshlrev_b32 v64, 7, v64
  buffer_load_dword v65, v64, s[8:11], s22 offen sc1
  v_add_u32 v64, 320, v1
  v_min_u32 v64, 323, v64
  v_lshlrev_b32 v64, 7, v64
  buffer_load_dword v65, v64, s[8:11], s22 offen sc1
  s_mov_b32 s27, 88523264
  s_mov_b32 s28, 0xffff
  s_mov_b32 s30, 0
ch_wx3:
  buffer_load_dword v65, off, s[8:11], s27  sc1
  s_waitcnt vmcnt(0)
  v_and_b32 v66, s28, v65
  v_cmp_ne_u32 vcc, s28, v66
  s_cbranch_vccz ch_wx3_ok
  s_sleep 8
  s_add_u32 s30, s30, 1
  s_cmp_lt_u32 s30, 400000
  s_cbranch_scc1 ch_wx3
  s_branch cA_abort
ch_wx3_ok:
  s_mov_b32 s24, 72030208
  s_mov_b32 s26, 72044544
  v_and_b32 v64, 7, v117
  v_and_b32 v65, 1, v116
  v_lshlrev_b32 v65, 2, v65
  v_sub_u32 v64, v64, v65
  v_lshrrev_b32 v65, 3, v117
  v_lshl_add_u32 v66, v65, 2, v64
  v_cmp_gt_u32 vcc, 4, v64
  v_mov_b32 v67, 99
  s_nop 0
  v_cndmask_b32 v66, v67, v66, vcc
  v_mov_b32 v68, 0x3f80
  v_mov_b32 v69, 0x3f800000
  v_mov_b32 v4, 0
  v_cmp_eq_u32 vcc, 0, v66
  s_nop 1
  v_cndmask_b32 v4, v4, v68, vcc
  v_cmp_eq_u32 vcc, 1, v66
  s_nop 1
  v_cndmask_b32 v4, v4, v69, vcc
  v_mov_b32 v5, 0
  v_cmp_eq_u32 vcc, 2, v66
  s_nop 1
  v_cndmask_b32 v5, v5, v68, vcc
  v_cmp_eq_u32 vcc, 3, v66
  s_nop 1
  v_cndmask_b32 v5, v5, v69, vcc
  v_mov_b32 v6, 0
  v_cmp_eq_u32 vcc, 4, v66
  s_nop 1
  v_cndmask_b32 v6, v6, v68, vcc
  v_cmp_eq_u32 vcc, 5, v66
  s_nop 1
  v_cndmask_b32 v6, v6, v69, vcc
  v_mov_b32 v7, 0
  v_cmp_eq_u32 vcc, 6, v66
  s_nop 1
  v_cndmask_b32 v7, v7, v68, vcc
  v_cmp_eq_u32 vcc, 7, v66
  s_nop 1
  v_cndmask_b32 v7, v7, v69, vcc
  v_lshrrev_b32 v64, 1, v116
  v_lshrrev_b32 v65, 3, v117
  v_and_b32 v66, 1, v116
  v_and_b32 v68, 7, v117
  v_lshlrev_b32 v67, 8, v65
  v_lshl_add_u32 v67, v68, 5, v67
  v_lshl_add_u32 v67, v66, 4, v67
  v_add_u32 v69, 5696, v67
  v_add_u32 v70, 6400, v67
  v_cmp_eq_u32 vcc, v64, v65
  s_nop 1
  v_cndmask_b32 v113, v70, v69, vcc
  v_and_b32 v0, 15, v1
  s_and_b32 s22, s17, 0
  s_lshl_b32 s22, s22, 7
  s_add_u32 s22, s22, 75731456
  v_lshl_add_u32 v0, v0, 2, s22
  v_xor_b32 v69, 256, v2
  v_mul_i32_i24 v70, 2048, v66
  v_add_u32 v69, v69, v70
  v_add_u32 v117, 4096, v69
  v_mov_b32 v116, v73
  s_mul_i32 s35, s17, 28672
  s_add_u32 s35, s35, 44040192
  v_mov_b32 v36, 0
  v_mov_b32 v37, 0
  v_mov_b32 v38, 0
  v_mov_b32 v39, 0
  v_mov_b32 v40, 0
  v_mov_b32 v41, 0
  v_mov_b32 v42, 0
  v_mov_b32 v43, 0
  v_mov_b32 v44, 0
  v_mov_b32 v45, 0
  v_mov_b32 v46, 0
  v_mov_b32 v47, 0
  v_mov_b32 v48, 0
  v_mov_b32 v49, 0
  v_mov_b32 v50, 0
  v_mov_b32 v51, 0
  v_mov_b32 v52, 0
  v_mov_b32 v53, 0
  v_mov_b32 v54, 0
  v_mov_b32 v55, 0
  v_mov_b32 v56, 0
  v_mov_b32 v57, 0
  v_mov_b32 v58, 0
  v_mov_b32 v59, 0
  v_mov_b32 v60, 0
  v_mov_b32 v61, 0
  v_mov_b32 v62, 0
  v_mov_b32 v63, 0
  v_mov_b32 v64, 0
  v_mov_b32 v65, 0
  v_mov_b32 v66, 0
  v_mov_b32 v67, 0
  v_mov_b32 v68, 0
  v_mov_b32 v69, 0
  v_mov_b32 v70, 0
  v_mov_b32 v71, 0
  v_mov_b32 v72, 0
  v_mov_b32 v73, 0
  v_mov_b32 v74, 0
  v_mov_b32 v75, 0
  v_mov_b32 v76, 0
  v_mov_b32 v77, 0
  v_mov_b32 v78, 0
  v_mov_b32 v79, 0
  buffer_load_dwordx4 v[80:83], v117, s[8:11], s24 offen offset:0 sc1
  buffer_load_dwordx4 v[84:87], v117, s[8:11], s24 offen offset:1024 sc1
  s_mov_b32 s30, 0
  v_mov_b32 v8, 0
ch_md3:
  buffer_load_dword v9, v8, s[12:15], 0 offen sc1
  s_waitcnt vmcnt(0) lgkmcnt(0)
  v_readfirstlane_b32 s22, v9
  s_and_b32 s31, s22, 0xffff
  s_cmp_ge_u32 s31, 32
  s_cbranch_scc1 ch_go3
  s_sleep 2
  s_add_u32 s30, s30, 1
  s_cmp_lt_u32 s30, 3200000
  s_cbranch_scc1 ch_md3
  s_branch ch_end
ch_go3:
  s_mov_b32 s31, 0
  s_lshr_b32 s22, s22, 16
  s_cmp_lg_u32 s22, 0
  s_cbranch_scc1 cB_sc3_loop
  s_branch cA_sc3_loop
ch_init4:
  s_mul_i32 s31, s17, 401408
  s_add_u32 s31, s31, 6422528
  s_mov_b32 s30, 0
ch_wr4:
  buffer_load_dword v65, off, s[12:15], 0 offset:128 sc1
  s_waitcnt vmcnt(0)
  v_cmp_ne_u32 vcc, 1, v65
  s_cbranch_vccz ch_wr4_ok
  s_sleep 8
  s_add_u32 s30, s30, 1
  s_cmp_lt_u32 s30, 400000
  s_cbranch_scc1 ch_wr4
  s_branch cA_abort
ch_wr4_ok:
  s_lshr_b32 s22, s17, 2
  s_lshl_b32 s28, 0x81, s22
  s_mul_i32 s27, s17, 12
  s_add_u32 s22, s27, 256
  s_lshr_b32 s22, s22, 6
  s_lshl_b32 s22, 0x81, s22
  s_or_b32 s28, s28, s22
  s_add_u32 s22, s27, 267
  s_lshr_b32 s22, s22, 6
  s_lshl_b32 s22, 0x81, s22
  s_or_b32 s28, s28, s22
  v_lshlrev_b32 v64, 7, v116
  s_mov_b32 s27, 88519168
  s_mov_b32 s30, 0
ch_ww4:
  buffer_load_dword v65, v64, s[8:11], s27 offen sc1
  s_waitcnt vmcnt(0)
  v_and_b32 v66, s28, v65
  v_cmp_ne_u32 vcc, s28, v66
  s_cbranch_vccz ch_ww4_ok
  s_sleep 3
  s_add_u32 s30, s30, 1
  s_cmp_lt_u32 s30, 400000
  s_cbranch_scc1 ch_ww4
  s_branch cA_abort
ch_ww4_ok:
  s_add_u32 s22, s31, 0
  buffer_load_dwordx4 a[0:3], v2, s[8:11], s22 offen offset:0 sc1
  buffer_load_dwordx4 a[4:7], v2, s[8:11], s22 offen offset:1024 sc1
  buffer_load_dwordx4 a[8:11], v2, s[8:11], s22 offen offset:2048 sc1
  buffer_load_dwordx4 a[12:15], v2, s[8:11], s22 offen offset:3072 sc1
  s_add_u32 s22, s31, 4096
  buffer_load_dwordx4 a[16:19], v2, s[8:11], s22 offen offset:0 sc1
  buffer_load_dwordx4 a[20:23], v2, s[8:11], s22 offen offset:1024 sc1
  buffer_load_dwordx4 a[24:27], v2, s[8:11], s22 offen offset:2048 sc1
  buffer_load_dwordx4 a[28:31], v2, s[8:11], s22 offen offset:3072 sc1
  s_add_u32 s22, s31, 8192
  buffer_load_dwordx4 a[32:35], v2, s[8:11], s22 offen offset:0 sc1
  buffer_load_dwordx4 a[36:39], v2, s[8:11], s22 offen offset:1024 sc1
  buffer_load_dwordx4 a[40:43], v2, s[8:11], s22 offen offset:2048 sc1
  buffer_load_dwordx4 a[44:47], v2, s[8:11], s22 offen offset:3072 sc1
  s_add_u32 s22, s31, 12288
  buffer_load_dwordx4 a[48:51], v2, s[8:11], s22 offen offset:0 sc1
  buffer_load_dwordx4 a[52:55], v2, s[8:11], s22 offen offset:1024 sc1
  buffer_load_dwordx4 a[56:59], v2, s[8:11], s22 offen offset:2048 sc1
  buffer_load_dwordx4 a[60:63], v2, s[8:11], s22 offen offset:3072 sc1
  s_add_u32 s22, s31, 16384
  buffer_load_dwordx4 a[64:67], v2, s[8:11], s22 offen offset:0 sc1
  buffer_load_dwordx4 a[68:71], v2, s[8:11], s22 offen offset:1024 sc1
  buffer_load_dwordx4 a[72:75], v2, s[8:11], s22 offen offset:2048 sc1
  buffer_load_dwordx4 a[76:79], v2, s[8:11], s22 offen offset:3072 sc1
  s_add_u32 s22, s31, 20480
  buffer_load_dwordx4 a[80:83], v2, s[8:11], s22 offen offset:0 sc1
  buffer_load_dwordx4 a[84:87], v2, s[8:11], s22 offen offset:1024 sc1
  buffer_load_dwordx4 a[88:91], v2, s[8:11], s22 offen offset:2048 sc1
  buffer_load_dwordx4 a[92:95], v2, s[8:11], s22 offen offset:3072 sc1
  s_add_u32 s22, s31, 24576
  buffer_load_dwordx4 a[96:99], v2, s[8:11], s22 offen offset:0 sc1
  buffer_load_dwordx4 a[100:103], v2, s[8:11], s22 offen offset:1024 sc1
  buffer_load_dwordx4 a[104:107], v2, s[8:11], s22 offen offset:2048 sc1
  buffer_load_dwordx4 a[108:111], v2, s[8:11], s22 offen offset:3072 sc1
  s_add_u32 s22, s31, 28672
  buffer_load_dwordx4 a[112:115], v2, s[8:11], s22 offen offset:0 sc1
  buffer_load_dwordx4 a[116:119], v2, s[8:11], s22 offen offset:1024 sc1
  buffer_load_dwordx4 a[120:123], v2, s[8:11], s22 offen offset:2048 sc1
  buffer_load_dwordx4 a[124:127], v2, s[8:11], s22 offen offset:3072 sc1
  s_waitcnt vmcnt(24)
  s_add_u32 s22, s31, 32768
  buffer_load_dwordx4 a[128:131], v2, s[8:11], s22 offen offset:0 sc1
  buffer_load_dwordx4 a[132:135], v2, s[8:11], s22 offen offset:1024 sc1
  buffer_load_dwordx4 a[136:139], v2, s[8:11], s22 offen offset:2048 sc1
  buffer_load_dwordx4 a[140:143], v2, s[8:11], s22 offen offset:3072 sc1
  s_add_u32 s22, s31, 36864
  buffer_load_dwordx4 a[144:147], v2, s[8:11], s22 offen offset:0 sc1
  buffer_load_dwordx4 a[148:151], v2, s[8:11], s22 offen offset:1024 sc1
  buffer_load_dwordx4 a[152:155], v2, s[8:11], s22 offen offset:2048 sc1
  buffer_load_dwordx4 a[156:159], v2, s[8:11], s22 offen offset:3072 sc1
  s_add_u32 s22, s31, 40960
  buffer_load_dwordx4 a[160:163], v2, s[8:11], s22 offen offset:0 sc1
  buffer_load_dwordx4 a[164:167], v2, s[8:11], s22 offen offset:1024 sc1
  buffer_load_dwordx4 a[168:171], v2, s[8:11], s22 offen offset:2048 sc1
  buffer_load_dwordx4 a[172:175], v2, s[8:11], s22 offen offset:3072 sc1
  s_add_u32 s22, s31, 45056
  buffer_load_dwordx4 a[176:179], v2, s[8:11], s22 offen offset:0 sc1
  buffer_load_dwordx4 a[180:183], v2, s[8:11], s22 offen offset:1024 sc1
  buffer_load_dwordx4 a[184:187], v2, s[8:11], s22 offen offset:2048 sc1
  buffer_load_dwordx4 a[188:191], v2, s[8:11], s22 offen offset:3072 sc1
  s_add_u32 s22, s31, 49152
  buffer_load_dwordx4 a[192:195], v2, s[8:11], s22 offen offset:0 sc1
  buffer_load_dwordx4 a[196:199], v2, s[8:11], s22 offen offset:1024 sc1
  buffer_load_dwordx4 a[200:203], v2, s[8:11], s22 offen offset:2048 sc1
  buffer_load_dwordx4 a[204:207], v2, s[8:11], s22 offen offset:3072 sc1
  s_add_u32 s22, s31, 53248
  buffer_load_dwordx4 a[208:211], v2, s[8:11], s22 offen offset:0 sc1
  buffer_load_dwordx4 a[212:215], v2, s[8:11], s22 offen offset:1024 sc1
  buffer_load_dwordx4 a[216:219], v2, s[8:11], s22 offen offset:2048 sc1
  buffer_load_dwordx4 a[220:223], v2, s[8:11], s22 offen offset:3072 sc1
  s_add_u32 s22, s31, 57344
  buffer_load_dwordx4 a[224:227], v2, s[8:11], s22 offen offset:0 sc1
  buffer_load_dwordx4 a[228:231], v2, s[8:11], s22 offen offset:1024 sc1
  buffer_load_dwordx4 a[232:235], v2, s[8:11], s22 offen offset:2048 sc1
  buffer_load_dwordx4 a[236:239], v2, s[8:11], s22 offen offset:3072 sc1
  s_add_u32 s22, s31, 61440
  buffer_load_dwordx4 a[240:243], v2, s[8:11], s22 offen offset:0 sc1
  buffer_load_dwordx4 a[244:247], v2, s[8:11], s22 offen offset:1024 sc1
  buffer_load_dwordx4 a[248:251], v2, s[8:11], s22 offen offset:2048 sc1
  buffer_load_dwordx4 a[252:255], v2, s[8:11], s22 offen offset:3072 sc1
  s_waitcnt vmcnt(24)
  s_add_u32 s22, s31, 65536
  buffer_load_dwordx4 v[176:179], v2, s[8:11], s22 offen offset:0 sc1
  buffer_load_dwordx4 v[180:183], v2, s[8:11], s22 offen offset:1024 sc1
  buffer_load_dwordx4 v[184:187], v2, s[8:11], s22 offen offset:2048 sc1
  buffer_load_dwordx4 v[188:191], v2, s[8:11], s22 offen offset:3072 sc1
  s_add_u32 s22, s31, 69632
  buffer_load_dwordx4 v[192:195], v2, s[8:11], s22 offen offset:0 sc1
  buffer_load_dwordx4 v[196:199], v2, s[8:11], s22 offen offset:1024 sc1
  buffer_load_dwordx4 v[200:203], v2, s[8:11], s22 offen offset:2048 sc1
  buffer_load_dwordx4 v[204:207], v2, s[8:11], s22 offen offset:3072 sc1
  s_add_u32 s22, s31, 73728
  buffer_load_dwordx4 v[208:211], v2, s[8:11], s22 offen offset:0 sc1
  buffer_load_dwordx4 v[212:215], v2, s[8:11], s22 offen offset:1024 sc1
  buffer_load_dwordx4 v[216:219], v2, s[8:11], s22 offen offset:2048 sc1
  buffer_load_dwordx4 v[220:223], v2, s[8:11], s22 offen offset:3072 sc1
  s_add_u32 s22, s31, 77824
  buffer_load_dwordx4 v[224:227], v2, s[8:11], s22 offen offset:0 sc1
  buffer_load_dwordx4 v[228:231], v2, s[8:11], s22 offen offset:1024 sc1
  buffer_load_dwordx4 v[232:235], v2, s[8:11], s22 offen offset:2048 sc1
  buffer_load_dwordx4 v[236:239], v2, s[8:11], s22 offen offset:3072 sc1
  s_add_u32 s22, s31, 81920
  buffer_load_dwordx4 v[240:243], v2, s[8:11], s22 offen offset:0 sc1
  buffer_load_dwordx4 v[244:247], v2, s[8:11], s22 offen offset:1024 sc1
  buffer_load_dwordx4 v[248:251], v2, s[8:11], s22 offen offset:2048 sc1
  buffer_load_dwordx4 v[252:255], v2, s[8:11], s22 offen offset:3072 sc1
  s_mov_b32 m0, 16384
  s_add_u32 s22, s31, 86016
  buffer_load_dwordx4 v2, s[8:11], s22 offen offset:0 sc1 lds
  buffer_load_dwordx4 v2, s[8:11], s22 offen offset:1024 sc1 lds
  buffer_load_dwordx4 v2, s[8:11], s22 offen offset:2048 sc1 lds
  buffer_load_dwordx4 v2, s[8:11], s22 offen offset:3072 sc1 lds
  s_mov_b32 m0, 20480
  s_add_u32 s22, s31, 90112
  buffer_load_dwordx4 v2, s[8:11], s22 offen offset:0 sc1 lds
  buffer_load_dwordx4 v2, s[8:11], s22 offen offset:1024 sc1 lds
  buffer_load_dwordx4 v2, s[8:11], s22 offen offset:2048 sc1 lds
  buffer_load_dwordx4 v2, s[8:11], s22 offen offset:3072 sc1 lds
  s_mov_b32 m0, 24576
  s_add_u32 s22, s31, 94208
  buffer_load_dwordx4 v2, s[8:11], s22 offen offset:0 sc1 lds
  buffer_load_dwordx4 v2, s[8:11], s22 offen offset:1024 sc1 lds
  buffer_load_dwordx4 v2, s[8:11], s22 offen offset:2048 sc1 lds
  buffer_load_dwordx4 v2, s[8:11], s22 offen offset:3072 sc1 lds
  s_mov_b32 m0, 28672
  s_add_u32 s22, s31, 98304
  buffer_load_dwordx4 v2, s[8:11], s22 offen offset:0 sc1 lds
  buffer_load_dwordx4 v2, s[8:11], s22 offen offset:1024 sc1 lds
  v_mov_b32 v72, v116
  v_mov_b32 v73, v117
  v_lshrrev_b32 v65, 1, v72
  v_and_b32 v66, 1, v72
  v_mov_b32 v36, 0
  v_mov_b32 v37, 0
  v_mov_b32 v38, 0
  v_mov_b32 v39, 0
  v_mov_b32 v40, 0
  v_mov_b32 v41, 0
  v_mov_b32 v42, 0
  v_mov_b32 v43, 0
  v_mov_b32 v44, 0
  v_mov_b32 v45, 0
  v_mov_b32 v46, 0
  v_mov_b32 v47, 0
  v_mov_b32 v48, 0
  v_mov_b32 v49, 0
  v_mov_b32 v50, 0
  v_mov_b32 v51, 0
  v_mov_b32 v52, 0
  v_mov_b32 v53, 0
  v_mov_b32 v54, 0
  v_mov_b32 v55, 0
  v_mov_b32 v56, 0
  v_mov_b32 v57, 0
  v_mov_b32 v58, 0
  v_mov_b32 v59, 0
  v_mov_b32 v60, 0
  v_mov_b32 v61, 0
  v_mov_b32 v62, 0
  v_mov_b32 v63, 0
  v_lshlrev_b32 v75, 2, v65
  v_lshl_add_u32 v75, v66, 3, v75
  v_add_u32 v67, 0, v73
  v_mul_u32_u24 v68, 2341, v67
  v_lshrrev_b32 v68, 16, v68
  v_mul_u32_u24 v69, 28, v68
  v_sub_u32 v69, v67, v69
  v_lshrrev_b32 v70, 4, v69
  v_and_b32 v69, 15, v69
  v_lshlrev_b32 v71, 12, v70
  v_lshl_add_u32 v71, v68, 8, v71
  v_lshl_add_u32 v71, v69, 4, v71
  v_add_u32 v152, v71, v75
  v_add_u32 v67, 16, v73
  v_mul_u32_u24 v68, 2341, v67
  v_lshrrev_b32 v68, 16, v68
  v_mul_u32_u24 v69, 28, v68
  v_sub_u32 v69, v67, v69
  v_lshrrev_b32 v70, 4, v69
  v_and_b32 v69, 15, v69
  v_lshlrev_b32 v71, 12, v70
  v_lshl_add_u32 v71, v68, 8, v71
  v_lshl_add_u32 v71, v69, 4, v71
  v_add_u32 v153, v71, v75
  v_add_u32 v67, 32, v73
  v_mul_u32_u24 v68, 2341, v67
  v_lshrrev_b32 v68, 16, v68
  v_mul_u32_u24 v69, 28, v68
  v_sub_u32 v69, v67, v69
  v_lshrrev_b32 v70, 4, v69
  v_and_b32 v69, 15, v69
  v_lshlrev_b32 v71, 12, v70
  v_lshl_add_u32 v71, v68, 8, v71
  v_lshl_add_u32 v71, v69, 4, v71
  v_add_u32 v154, v71, v75
  v_add_u32 v67, 48, v73
  v_mul_u32_u24 v68, 2341, v67
  v_lshrrev_b32 v68, 16, v68
  v_mul_u32_u24 v69, 28, v68
  v_sub_u32 v69, v67, v69
  v_lshrrev_b32 v70, 4, v69
  v_and_b32 v69, 15, v69
  v_lshlrev_b32 v71, 12, v70
  v_lshl_add_u32 v71, v68, 8, v71
  v_lshl_add_u32 v71, v69, 4, v71
  v_add_u32 v155, v71, v75
  v_add_u32 v67, 64, v73
  v_mul_u32_u24 v68, 2341, v67
  v_lshrrev_b32 v68, 16, v68
  v_mul_u32_u24 v69, 28, v68
  v_sub_u32 v69, v67, v69
  v_lshrrev_b32 v70, 4, v69
  v_and_b32 v69, 15, v69
  v_lshlrev_b32 v71, 12, v70
  v_lshl_add_u32 v71, v68, 8, v71
  v_lshl_add_u32 v71, v69, 4, v71
  v_add_u32 v156, v71, v75
  v_add_u32 v67, 80, v73
  v_mul_u32_u24 v68, 2341, v67
  v_lshrrev_b32 v68, 16, v68
  v_mul_u32_u24 v69, 28, v68
  v_sub_u32 v69, v67, v69
  v_lshrrev_b32 v70, 4, v69
  v_and_b32 v69, 15, v69
  v_lshlrev_b32 v71, 12, v70
  v_lshl_add_u32 v71, v68, 8, v71
  v_lshl_add_u32 v71, v69, 4, v71
  v_add_u32 v157, v71, v75
  v_add_u32 v67, 96, v73
  v_mul_u32_u24 v68, 2341, v67
  v_lshrrev_b32 v68, 16, v68
  v_mul_u32_u24 v69, 28, v68
  v_sub_u32 v69, v67, v69
  v_lshrrev_b32 v70, 4, v69
  v_and_b32 v69, 15, v69
  v_lshlrev_b32 v71, 12, v70
  v_lshl_add_u32 v71, v68, 8, v71
  v_lshl_add_u32 v71, v69, 4, v71
  v_add_u32 v158, v71, v75
  v_mov_b32 v74, 0x40000000
  v_mov_b32 v76, 0
  v_mov_b32 v77, 0
  v_mov_b32 v78, 0
  v_mov_b32 v79, 0
  ds_write_b128 v2, v[76:79] offset:0
  ds_write_b128 v2, v[76:79] offset:1024
  ds_write_b128 v2, v[76:79] offset:2048
  ds_write_b128 v2, v[76:79] offset:3072
  s_and_b32 s22, s17, 0
  s_lshl_b32 s22, s22, 7
  s_add_u32 s22, s22, 75729408
  v_lshl_add_u32 v4, v73, 2, s22
  v_and_b32 v64, 1, v73
  v_mov_b32 v5, 0x05040100
  v_mov_b32 v65, 0x03020706
  v_cmp_eq_u32 vcc, 1, v64
  s_nop 1
  v_cndmask_b32 v5, v5, v65, vcc
  s_lshl_b32 s22, s17, 2
  s_add_u32 s22, s22, 75733504
  v_lshl_add_u32 v7, v1, 7, s22
  v_cmp_gt_u32 vcc, 1, v1
  s_nop 1
  v_cndmask_b32 v7, v74, v7, vcc
  v_mov_b32 v6, v2
  v_lshl_add_u32 v64, v66, 2, v64
  v_and_b32 v65, 2, v72
  v_add_u32 v64, v64, v65
  s_mul_i32 s22, s17, 16
  v_add_u32 v75, s22, v73
  v_lshrrev_b32 v68, 4, v75
  v_lshlrev_b32 v68, 8, v68
  v_bfe_u32 v69, v75, 1, 1
  v_lshl_add_u32 v68, v69, 7, v68
  v_lshl_add_u32 v68, v64, 4, v68
  v_and_b32 v69, 12, v75
  v_add_u32 v1, v68, v69
  s_mul_i32 s22, s17, 28672
  s_add_u32 s25, s22, 42205184
  v_mov_b32 v162, -1
  s_mov_b32 s38, 0x40000000
  v_add_u32 v0, 16384, v2
  s_mov_b32 s30, 0
  v_mov_b32 v8, 0
ch_md4:
  buffer_load_dword v9, v8, s[12:15], 0 offen sc1
  s_waitcnt vmcnt(0) lgkmcnt(0)
  v_readfirstlane_b32 s22, v9
  s_and_b32 s31, s22, 0xffff
  s_cmp_ge_u32 s31, 32
  s_cbranch_scc1 ch_go4
  s_sleep 2
  s_add_u32 s30, s30, 1
  s_cmp_lt_u32 s30, 3200000
  s_cbranch_scc1 ch_md4
  s_branch ch_end
ch_go4:
  s_mov_b32 s31, 0
  s_lshr_b32 s22, s22, 16
  s_cmp_lg_u32 s22, 0
  s_cbranch_scc1 cB_va0_loop
  s_branch cA_va0_loop
ch_init5:
  s_mul_i32 s31, s17, 401408
  s_add_u32 s31, s31, 6522880
  s_mov_b32 s30, 0
ch_wr5:
  buffer_load_dword v65, off, s[12:15], 0 offset:128 sc1
  s_waitcnt vmcnt(0)
  v_cmp_ne_u32 vcc, 1, v65
  s_cbranch_vccz ch_wr5_ok
  s_sleep 8
  s_add_u32 s30, s30, 1
  s_cmp_lt_u32 s30, 400000
  s_cbranch_scc1 ch_wr5
  s_branch cA_abort
ch_wr5_ok:
  s_lshr_b32 s22, s17, 2
  s_lshl_b32 s28, 0x81, s22
  s_mul_i32 s27, s17, 12
  s_add_u32 s22, s27, 256
  s_lshr_b32 s22, s22, 6
  s_lshl_b32 s22, 0x81, s22
  s_or_b32 s28, s28, s22
  s_add_u32 s22, s27, 267
  s_lshr_b32 s22, s22, 6
  s_lshl_b32 s22, 0x81, s22
  s_or_b32 s28, s28, s22
  v_lshlrev_b32 v64, 7, v116
  s_mov_b32 s27, 88519680
  s_mov_b32 s30, 0
ch_ww5:
  buffer_load_dword v65, v64, s[8:11], s27 offen sc1
  s_waitcnt vmcnt(0)
  v_and_b32 v66, s28, v65
  v_cmp_ne_u32 vcc, s28, v66
  s_cbranch_vccz ch_ww5_ok
  s_sleep 3
  s_add_u32 s30, s30, 1
  s_cmp_lt_u32 s30, 400000
  s_cbranch_scc1 ch_ww5
  s_branch cA_abort
ch_ww5_ok:
  s_add_u32 s22, s31, 0
  buffer_load_dwordx4 a[0:3], v2, s[8:11], s22 offen offset:0 sc1
  buffer_load_dwordx4 a[4:7], v2, s[8:11], s22 offen offset:1024 sc1
  buffer_load_dwordx4 a[8:11], v2, s[8:11], s22 offen offset:2048 sc1
  buffer_load_dwordx4 a[12:15], v2, s[8:11], s22 offen offset:3072 sc1
  s_add_u32 s22, s31, 4096
  buffer_load_dwordx4 a[16:19], v2, s[8:11], s22 offen offset:0 sc1
  buffer_load_dwordx4 a[20:23], v2, s[8:11], s22 offen offset:1024 sc1
  buffer_load_dwordx4 a[24:27], v2, s[8:11], s22 offen offset:2048 sc1
  buffer_load_dwordx4 a[28:31], v2, s[8:11], s22 offen offset:3072 sc1
  s_add_u32 s22, s31, 8192
  buffer_load_dwordx4 a[32:35], v2, s[8:11], s22 offen offset:0 sc1
  buffer_load_dwordx4 a[36:39], v2, s[8:11], s22 offen offset:1024 sc1
  buffer_load_dwordx4 a[40:43], v2, s[8:11], s22 offen offset:2048 sc1
  buffer_load_dwordx4 a[44:47], v2, s[8:11], s22 offen offset:3072 sc1
  s_add_u32 s22, s31, 12288
  buffer_load_dwordx4 a[48:51], v2, s[8:11], s22 offen offset:0 sc1
  buffer_load_dwordx4 a[52:55], v2, s[8:11], s22 offen offset:1024 sc1
  buffer_load_dwordx4 a[56:59], v2, s[8:11], s22 offen offset:2048 sc1
  buffer_load_dwordx4 a[60:63], v2, s[8:11], s22 offen offset:3072 sc1
  s_add_u32 s22, s31, 16384
  buffer_load_dwordx4 a[64:67], v2, s[8:11], s22 offen offset:0 sc1
  buffer_load_dwordx4 a[68:71], v2, s[8:11], s22 offen offset:1024 sc1
  buffer_load_dwordx4 a[72:75], v2, s[8:11], s22 offen offset:2048 sc1
  buffer_load_dwordx4 a[76:79], v2, s[8:11], s22 offen offset:3072 sc1
  s_add_u32 s22, s31, 20480
  buffer_load_dwordx4 a[80:83], v2, s[8:11], s22 offen offset:0 sc1
  buffer_load_dwordx4 a[84:87], v2, s[8:11], s22 offen offset:1024 sc1
  buffer_load_dwordx4 a[88:91], v2, s[8:11], s22 offen offset:2048 sc1
  buffer_load_dwordx4 a[92:95], v2, s[8:11], s22 offen offset:3072 sc1
  s_add_u32 s22, s31, 24576
  buffer_load_dwordx4 a[96:99], v2, s[8:11], s22 offen offset:0 sc1
  buffer_load_dwordx4 a[100:103], v2, s[8:11], s22 offen offset:1024 sc1
  buffer_load_dwordx4 a[104:107], v2, s[8:11], s22 offen offset:2048 sc1
  buffer_load_dwordx4 a[108:111], v2, s[8:11], s22 offen offset:3072 sc1
  s_add_u32 s22, s31, 28672
  buffer_load_dwordx4 a[112:115], v2, s[8:11], s22 offen offset:0 sc1
  buffer_load_dwordx4 a[116:119], v2, s[8:11], s22 offen offset:1024 sc1
  buffer_load_dwordx4 a[120:123], v2, s[8:11], s22 offen offset:2048 sc1
  buffer_load_dwordx4 a[124:127], v2, s[8:11], s22 offen offset:3072 sc1
  s_waitcnt vmcnt(24)
  s_add_u32 s22, s31, 32768
  buffer_load_dwordx4 a[128:131], v2, s[8:11], s22 offen offset:0 sc1
  buffer_load_dwordx4 a[132:135], v2, s[8:11], s22 offen offset:1024 sc1
  buffer_load_dwordx4 a[136:139], v2, s[8:11], s22 offen offset:2048 sc1
  buffer_load_dwordx4 a[140:143], v2, s[8:11], s22 offen offset:3072 sc1
  s_add_u32 s22, s31, 36864
  buffer_load_dwordx4 a[144:147], v2, s[8:11], s22 offen offset:0 sc1
  buffer_load_dwordx4 a[148:151], v2, s[8:11], s22 offen offset:1024 sc1
  buffer_load_dwordx4 a[152:155], v2, s[8:11], s22 offen offset:2048 sc1
  buffer_load_dwordx4 a[156:159], v2, s[8:11], s22 offen offset:3072 sc1
  s_add_u32 s22, s31, 40960
  buffer_load_dwordx4 a[160:163], v2, s[8:11], s22 offen offset:0 sc1
  buffer_load_dwordx4 a[164:167], v2, s[8:11], s22 offen offset:1024 sc1
  buffer_load_dwordx4 a[168:171], v2, s[8:11], s22 offen offset:2048 sc1
  buffer_load_dwordx4 a[172:175], v2, s[8:11], s22 offen offset:3072 sc1
  s_add_u32 s22, s31, 45056
  buffer_load_dwordx4 a[176:179], v2, s[8:11], s22 offen offset:0 sc1
  buffer_load_dwordx4 a[180:183], v2, s[8:11], s22 offen offset:1024 sc1
  buffer_load_dwordx4 a[184:187], v2, s[8:11], s22 offen offset:2048 sc1
  buffer_load_dwordx4 a[188:191], v2, s[8:11], s22 offen offset:3072 sc1
  s_add_u32 s22, s31, 49152
  buffer_load_dwordx4 a[192:195], v2, s[8:11], s22 offen offset:0 sc1
  buffer_load_dwordx4 a[196:199], v2, s[8:11], s22 offen offset:1024 sc1
  buffer_load_dwordx4 a[200:203], v2, s[8:11], s22 offen offset:2048 sc1
  buffer_load_dwordx4 a[204:207], v2, s[8:11], s22 offen offset:3072 sc1
  s_add_u32 s22, s31, 53248
  buffer_load_dwordx4 a[208:211], v2, s[8:11], s22 offen offset:0 sc1
  buffer_load_dwordx4 a[212:215], v2, s[8:11], s22 offen offset:1024 sc1
  buffer_load_dwordx4 a[216:219], v2, s[8:11], s22 offen offset:2048 sc1
  buffer_load_dwordx4 a[220:223], v2, s[8:11], s22 offen offset:3072 sc1
  s_add_u32 s22, s31, 57344
  buffer_load_dwordx4 a[224:227], v2, s[8:11], s22 offen offset:0 sc1
  buffer_load_dwordx4 a[228:231], v2, s[8:11], s22 offen offset:1024 sc1
  buffer_load_dwordx4 a[232:235], v2, s[8:11], s22 offen offset:2048 sc1
  buffer_load_dwordx4 a[236:239], v2, s[8:11], s22 offen offset:3072 sc1
  s_add_u32 s22, s31, 61440
  buffer_load_dwordx4 a[240:243], v2, s[8:11], s22 offen offset:0 sc1
  buffer_load_dwordx4 a[244:247], v2, s[8:11], s22 offen offset:1024 sc1
  buffer_load_dwordx4 a[248:251], v2, s[8:11], s22 offen offset:2048 sc1
  buffer_load_dwordx4 a[252:255], v2, s[8:11], s22 offen offset:3072 sc1
  s_waitcnt vmcnt(24)
  s_add_u32 s22, s31, 65536
  buffer_load_dwordx4 v[176:179], v2, s[8:11], s22 offen offset:0 sc1
  buffer_load_dwordx4 v[180:183], v2, s[8:11], s22 offen offset:1024 sc1
  buffer_load_dwordx4 v[184:187], v2, s[8:11], s22 offen offset:2048 sc1
  buffer_load_dwordx4 v[188:191], v2, s[8:11], s22 offen offset:3072 sc1
  s_add_u32 s22, s31, 69632
  buffer_load_dwordx4 v[192:195], v2, s[8:11], s22 offen offset:0 sc1
  buffer_load_dwordx4 v[196:199], v2, s[8:11], s22 offen offset:1024 sc1
  buffer_load_dwordx4 v[200:203], v2, s[8:11], s22 offen offset:2048 sc1
  buffer_load_dwordx4 v[204:207], v2, s[8:11], s22 offen offset:3072 sc1
  s_add_u32 s22, s31, 73728
  buffer_load_dwordx4 v[208:211], v2, s[8:11], s22 offen offset:0 sc1
  buffer_load_dwordx4 v[212:215], v2, s[8:11], s22 offen offset:1024 sc1
  buffer_load_dwordx4 v[216:219], v2, s[8:11], s22 offen offset:2048 sc1
  buffer_load_dwordx4 v[220:223], v2, s[8:11], s22 offen offset:3072 sc1
  s_add_u32 s22, s31, 77824
  buffer_load_dwordx4 v[224:227], v2, s[8:11], s22 offen offset:0 sc1
  buffer_load_dwordx4 v[228:231], v2, s[8:11], s22 offen offset:1024 sc1
  buffer_load_dwordx4 v[232:235], v2, s[8:11], s22 offen offset:2048 sc1
  buffer_load_dwordx4 v[236:239], v2, s[8:11], s22 offen offset:3072 sc1
  s_add_u32 s22, s31, 81920
  buffer_load_dwordx4 v[240:243], v2, s[8:11], s22 offen offset:0 sc1
  buffer_load_dwordx4 v[244:247], v2, s[8:11], s22 offen offset:1024 sc1
  buffer_load_dwordx4 v[248:251], v2, s[8:11], s22 offen offset:2048 sc1
  buffer_load_dwordx4 v[252:255], v2, s[8:11], s22 offen offset:3072 sc1
  s_mov_b32 m0, 30720
  s_add_u32 s22, s31, 86016
  buffer_load_dwordx4 v2, s[8:11], s22 offen offset:0 sc1 lds
  buffer_load_dwordx4 v2, s[8:11], s22 offen offset:1024 sc1 lds
  buffer_load_dwordx4 v2, s[8:11], s22 offen offset:2048 sc1 lds
  buffer_load_dwordx4 v2, s[8:11], s22 offen offset:3072 sc1 lds
  s_mov_b32 m0, 34816
  s_add_u32 s22, s31, 90112
  buffer_load_dwordx4 v2, s[8:11], s22 offen offset:0 sc1 lds
  buffer_load_dwordx4 v2, s[8:11], s22 offen offset:1024 sc1 lds
  buffer_load_dwordx4 v2, s[8:11], s22 offen offset:2048 sc1 lds
  buffer_load_dwordx4 v2, s[8:11], s22 offen offset:3072 sc1 lds
  s_mov_b32 m0, 38912
  s_add_u32 s22, s31, 94208
  buffer_load_dwordx4 v2, s[8:11], s22 offen offset:0 sc1 lds
  buffer_load_dwordx4 v2, s[8:11], s22 offen offset:1024 sc1 lds
  buffer_load_dwordx4 v2, s[8:11], s22 offen offset:2048 sc1 lds
  buffer_load_dwordx4 v2, s[8:11], s22 offen offset:3072 sc1 lds
  s_mov_b32 m0, 43008
  s_add_u32 s22, s31, 98304
  buffer_load_dwordx4 v2, s[8:11], s22 offen offset:0 sc1 lds
  buffer_load_dwordx4 v2, s[8:11], s22 offen offset:1024 sc1 lds
  v_mov_b32 v72, v116
  v_mov_b32 v73, v117
  v_lshrrev_b32 v65, 1, v72
  v_and_b32 v66, 1, v72
  v_mov_b32 v36, 0
  v_mov_b32 v37, 0
  v_mov_b32 v38, 0
  v_mov_b32 v39, 0
  v_mov_b32 v40, 0
  v_mov_b32 v41, 0
  v_mov_b32 v42, 0
  v_mov_b32 v43, 0
  v_mov_b32 v44, 0
  v_mov_b32 v45, 0
  v_mov_b32 v46, 0
  v_mov_b32 v47, 0
  v_mov_b32 v48, 0
  v_mov_b32 v49, 0
  v_mov_b32 v50, 0
  v_mov_b32 v51, 0
  v_mov_b32 v52, 0
  v_mov_b32 v53, 0
  v_mov_b32 v54, 0
  v_mov_b32 v55, 0
  v_mov_b32 v56, 0
  v_mov_b32 v57, 0
  v_mov_b32 v58, 0
  v_mov_b32 v59, 0
  v_mov_b32 v60, 0
  v_mov_b32 v61, 0
  v_mov_b32 v62, 0
  v_mov_b32 v63, 0
  v_lshlrev_b32 v75, 2, v65
  v_lshl_add_u32 v75, v66, 3, v75
  v_add_u32 v67, 112, v73
  v_mul_u32_u24 v68, 2341, v67
  v_lshrrev_b32 v68, 16, v68
  v_mul_u32_u24 v69, 28, v68
  v_sub_u32 v69, v67, v69
  v_lshrrev_b32 v70, 4, v69
  v_and_b32 v69, 15, v69
  v_lshlrev_b32 v71, 12, v70
  v_lshl_add_u32 v71, v68, 8, v71
  v_lshl_add_u32 v71, v69, 4, v71
  v_add_u32 v152, v71, v75
  v_add_u32 v67, 128, v73
  v_mul_u32_u24 v68, 2341, v67
  v_lshrrev_b32 v68, 16, v68
  v_mul_u32_u24 v69, 28, v68
  v_sub_u32 v69, v67, v69
  v_lshrrev_b32 v70, 4, v69
  v_and_b32 v69, 15, v69
  v_lshlrev_b32 v71, 12, v70
  v_lshl_add_u32 v71, v68, 8, v71
  v_lshl_add_u32 v71, v69, 4, v71
  v_add_u32 v153, v71, v75
  v_add_u32 v67, 144, v73
  v_mul_u32_u24 v68, 2341, v67
  v_lshrrev_b32 v68, 16, v68
  v_mul_u32_u24 v69, 28, v68
  v_sub_u32 v69, v67, v69
  v_lshrrev_b32 v70, 4, v69
  v_and_b32 v69, 15, v69
  v_lshlrev_b32 v71, 12, v70
  v_lshl_add_u32 v71, v68, 8, v71
  v_lshl_add_u32 v71, v69, 4, v71
  v_add_u32 v154, v71, v75
  v_add_u32 v67, 160, v73
  v_mul_u32_u24 v68, 2341, v67
  v_lshrrev_b32 v68, 16, v68
  v_mul_u32_u24 v69, 28, v68
  v_sub_u32 v69, v67, v69
  v_lshrrev_b32 v70, 4, v69
  v_and_b32 v69, 15, v69
  v_lshlrev_b32 v71, 12, v70
  v_lshl_add_u32 v71, v68, 8, v71
  v_lshl_add_u32 v71, v69, 4, v71
  v_add_u32 v155, v71, v75
  v_add_u32 v67, 176, v73
  v_mul_u32_u24 v68, 2341, v67
  v_lshrrev_b32 v68, 16, v68
  v_mul_u32_u24 v69, 28, v68
  v_sub_u32 v69, v67, v69
  v_lshrrev_b32 v70, 4, v69
  v_and_b32 v69, 15, v69
  v_lshlrev_b32 v71, 12, v70
  v_lshl_add_u32 v71, v68, 8, v71
  v_lshl_add_u32 v71, v69, 4, v71
  v_add_u32 v156, v71, v75
  v_add_u32 v67, 192, v73
  v_mul_u32_u24 v68, 2341, v67
  v_lshrrev_b32 v68, 16, v68
  v_mul_u32_u24 v69, 28, v68
  v_sub_u32 v69, v67, v69
  v_lshrrev_b32 v70, 4, v69
  v_and_b32 v69, 15, v69
  v_lshlrev_b32 v71, 12, v70
  v_lshl_add_u32 v71, v68, 8, v71
  v_lshl_add_u32 v71, v69, 4, v71
  v_add_u32 v157, v71, v75
  v_add_u32 v67, 208, v73
  v_mul_u32_u24 v68, 2341, v67
  v_lshrrev_b32 v68, 16, v68
  v_mul_u32_u24 v69, 28, v68
  v_sub_u32 v69, v67, v69
  v_lshrrev_b32 v70, 4, v69
  v_and_b32 v69, 15, v69
  v_lshlrev_b32 v71, 12, v70
  v_lshl_add_u32 v71, v68, 8, v71
  v_lshl_add_u32 v71, v69, 4, v71
  v_add_u32 v158, v71, v75
  v_mov_b32 v74, 0x40000000
  v_mov_b32 v76, 0
  v_mov_b32 v77, 0
  v_mov_b32 v78, 0
  v_mov_b32 v79, 0
  ds_write_b128 v2, v[76:79] offset:4096
  ds_write_b128 v2, v[76:79] offset:5120
  ds_write_b128 v2, v[76:79] offset:6144
  ds_write_b128 v2, v[76:79] offset:7168
  s_and_b32 s22, s17, 0
  s_lshl_b32 s22, s22, 7
  s_add_u32 s22, s22, 75729408
  v_lshl_add_u32 v4, v73, 2, s22
  v_and_b32 v64, 1, v73
  v_mov_b32 v5, 0x05040100
  v_mov_b32 v65, 0x03020706
  v_cmp_eq_u32 vcc, 1, v64
  s_nop 1
  v_cndmask_b32 v5, v5, v65, vcc
  s_lshl_b32 s22, s17, 2
  s_add_u32 s22, s22, 75733504
  v_lshl_add_u32 v7, v1, 7, s22
  v_cmp_gt_u32 vcc, 1, v1
  s_nop 1
  v_cndmask_b32 v7, v74, v7, vcc
  v_min_u32 v65, 11, v73
  v_mad_u32_u24 v65, v72, 12, v65
  v_lshlrev_b32 v6, 4, v65
  v_add_u32 v6, 1024, v6
  v_lshl_add_u32 v64, v66, 2, v64
  v_and_b32 v65, 2, v72
  v_add_u32 v64, v64, v65
  s_mul_i32 s22, s17, 12
  s_add_u32 s22, s22, 256
  v_add_u32 v75, s22, v73
  v_lshrrev_b32 v68, 4, v75
  v_lshlrev_b32 v68, 8, v68
  v_bfe_u32 v69, v75, 1, 1
  v_lshl_add_u32 v68, v69, 7, v68
  v_lshl_add_u32 v68, v64, 4, v68
  v_and_b32 v69, 12, v75
  v_add_u32 v1, v68, v69
  v_cmp_gt_u32 vcc, 12, v73
  s_nop 1
  v_cndmask_b32 v1, v74, v1, vcc
  s_mul_i32 s22, s17, 28672
  s_add_u32 s25, s22, 42205184
  v_mov_b32 v162, -1
  s_mov_b32 s38, 0x40000000
  v_add_u32 v0, 30720, v2
  s_mov_b32 s30, 0
  v_mov_b32 v8, 0
ch_md5:
  buffer_load_dword v9, v8, s[12:15], 0 offen sc1
  s_waitcnt vmcnt(0) lgkmcnt(0)
  v_readfirstlane_b32 s22, v9
  s_and_b32 s31, s22, 0xffff
  s_cmp_ge_u32 s31, 32
  s_cbranch_scc1 ch_go5
  s_sleep 2
  s_add_u32 s30, s30, 1
  s_cmp_lt_u32 s30, 3200000
  s_cbranch_scc1 ch_md5
  s_branch ch_end
ch_go5:
  s_mov_b32 s31, 0
  s_lshr_b32 s22, s22, 16
  s_cmp_lg_u32 s22, 0
  s_cbranch_scc1 cB_va1_loop
  s_branch cA_va1_loop
ch_init6:
  s_mul_i32 s31, s17, 401408
  s_add_u32 s31, s31, 6623232
  s_mov_b32 s30, 0
ch_wr6:
  buffer_load_dword v65, off, s[12:15], 0 offset:128 sc1
  s_waitcnt vmcnt(0)
  v_cmp_ne_u32 vcc, 1, v65
  s_cbranch_vccz ch_wr6_ok
  s_sleep 8
  s_add_u32 s30, s30, 1
  s_cmp_lt_u32 s30, 400000
  s_cbranch_scc1 ch_wr6
  s_branch cA_abort
ch_wr6_ok:
  s_lshr_b32 s22, s17, 2
  s_lshl_b32 s28, 0x81, s22
  s_mul_i32 s27, s17, 12
  s_add_u32 s22, s27, 256
  s_lshr_b32 s22, s22, 6
  s_lshl_b32 s22, 0x81, s22
  s_or_b32 s28, s28, s22
  s_add_u32 s22, s27, 267
  s_lshr_b32 s22, s22, 6
  s_lshl_b32 s22, 0x81, s22
  s_or_b32 s28, s28, s22
  v_lshlrev_b32 v64, 7, v116
  s_mov_b32 s27, 88520192
  s_mov_b32 s30, 0
ch_ww6:
  buffer_load_dword v65, v64, s[8:11], s27 offen sc1
  s_waitcnt vmcnt(0)
  v_and_b32 v66, s28, v65
  v_cmp_ne_u32 vcc, s28, v66
  s_cbranch_vccz ch_ww6_ok
  s_sleep 3
  s_add_u32 s30, s30, 1
  s_cmp_lt_u32 s30, 400000
  s_cbranch_scc1 ch_ww6
  s_branch cA_abort
ch_ww6_ok:
  s_add_u32 s22, s31, 0
  buffer_load_dwordx4 a[0:3], v2, s[8:11], s22 offen offset:0 sc1
  buffer_load_dwordx4 a[4:7], v2, s[8:11], s22 offen offset:1024 sc1
  buffer_load_dwordx4 a[8:11], v2, s[8:11], s22 offen offset:2048 sc1
  buffer_load_dwordx4 a[12:15], v2, s[8:11], s22 offen offset:3072 sc1
  s_add_u32 s22, s31, 4096
  buffer_load_dwordx4 a[16:19], v2, s[8:11], s22 offen offset:0 sc1
  buffer_load_dwordx4 a[20:23], v2, s[8:11], s22 offen offset:1024 sc1
  buffer_load_dwordx4 a[24:27], v2, s[8:11], s22 offen offset:2048 sc1
  buffer_load_dwordx4 a[28:31], v2, s[8:11], s22 offen offset:3072 sc1
  s_add_u32 s22, s31, 8192
  buffer_load_dwordx4 a[32:35], v2, s[8:11], s22 offen offset:0 sc1
  buffer_load_dwordx4 a[36:39], v2, s[8:11], s22 offen offset:1024 sc1
  buffer_load_dwordx4 a[40:43], v2, s[8:11], s22 offen offset:2048 sc1
  buffer_load_dwordx4 a[44:47], v2, s[8:11], s22 offen offset:3072 sc1
  s_add_u32 s22, s31, 12288
  buffer_load_dwordx4 a[48:51], v2, s[8:11], s22 offen offset:0 sc1
  buffer_load_dwordx4 a[52:55], v2, s[8:11], s22 offen offset:1024 sc1
  buffer_load_dwordx4 a[56:59], v2, s[8:11], s22 offen offset:2048 sc1
  buffer_load_dwordx4 a[60:63], v2, s[8:11], s22 offen offset:3072 sc1
  s_add_u32 s22, s31, 16384
  buffer_load_dwordx4 a[64:67], v2, s[8:11], s22 offen offset:0 sc1
  buffer_load_dwordx4 a[68:71], v2, s[8:11], s22 offen offset:1024 sc1
  buffer_load_dwordx4 a[72:75], v2, s[8:11], s22 offen offset:2048 sc1
  buffer_load_dwordx4 a[76:79], v2, s[8:11], s22 offen offset:3072 sc1
  s_add_u32 s22, s31, 20480
  buffer_load_dwordx4 a[80:83], v2, s[8:11], s22 offen offset:0 sc1
  buffer_load_dwordx4 a[84:87], v2, s[8:11], s22 offen offset:1024 sc1
  buffer_load_dwordx4 a[88:91], v2, s[8:11], s22 offen offset:2048 sc1
  buffer_load_dwordx4 a[92:95], v2, s[8:11], s22 offen offset:3072 sc1
  s_add_u32 s22, s31, 24576
  buffer_load_dwordx4 a[96:99], v2, s[8:11], s22 offen offset:0 sc1
  buffer_load_dwordx4 a[100:103], v2, s[8:11], s22 offen offset:1024 sc1
  buffer_load_dwordx4 a[104:107], v2, s[8:11], s22 offen offset:2048 sc1
  buffer_load_dwordx4 a[108:111], v2, s[8:11], s22 offen offset:3072 sc1
  s_add_u32 s22, s31, 28672
  buffer_load_dwordx4 a[112:115], v2, s[8:11], s22 offen offset:0 sc1
  buffer_load_dwordx4 a[116:119], v2, s[8:11], s22 offen offset:1024 sc1
  buffer_load_dwordx4 a[120:123], v2, s[8:11], s22 offen offset:2048 sc1
  buffer_load_dwordx4 a[124:127], v2, s[8:11], s22 offen offset:3072 sc1
  s_waitcnt vmcnt(24)
  s_add_u32 s22, s31, 32768
  buffer_load_dwordx4 a[128:131], v2, s[8:11], s22 offen offset:0 sc1
  buffer_load_dwordx4 a[132:135], v2, s[8:11], s22 offen offset:1024 sc1
  buffer_load_dwordx4 a[136:139], v2, s[8:11], s22 offen offset:2048 sc1
  buffer_load_dwordx4 a[140:143], v2, s[8:11], s22 offen offset:3072 sc1
  s_add_u32 s22, s31, 36864
  buffer_load_dwordx4 a[144:147], v2, s[8:11], s22 offen offset:0 sc1
  buffer_load_dwordx4 a[148:151], v2, s[8:11], s22 offen offset:1024 sc1
  buffer_load_dwordx4 a[152:155], v2, s[8:11], s22 offen offset:2048 sc1
  buffer_load_dwordx4 a[156:159], v2, s[8:11], s22 offen offset:3072 sc1
  s_add_u32 s22, s31, 40960
  buffer_load_dwordx4 a[160:163], v2, s[8:11], s22 offen offset:0 sc1
  buffer_load_dwordx4 a[164:167], v2, s[8:11], s22 offen offset:1024 sc1
  buffer_load_dwordx4 a[168:171], v2, s[8:11], s22 offen offset:2048 sc1
  buffer_load_dwordx4 a[172:175], v2, s[8:11], s22 offen offset:3072 sc1
  s_add_u32 s22, s31, 45056
  buffer_load_dwordx4 a[176:179], v2, s[8:11], s22 offen offset:0 sc1
  buffer_load_dwordx4 a[180:183], v2, s[8:11], s22 offen offset:1024 sc1
  buffer_load_dwordx4 a[184:187], v2, s[8:11], s22 offen offset:2048 sc1
  buffer_load_dwordx4 a[188:191], v2, s[8:11], s22 offen offset:3072 sc1
  s_add_u32 s22, s31, 49152
  buffer_load_dwordx4 a[192:195], v2, s[8:11], s22 offen offset:0 sc1
  buffer_load_dwordx4 a[196:199], v2, s[8:11], s22 offen offset:1024 sc1
  buffer_load_dwordx4 a[200:203], v2, s[8:11], s22 offen offset:2048 sc1
  buffer_load_dwordx4 a[204:207], v2, s[8:11], s22 offen offset:3072 sc1
  s_add_u32 s22, s31, 53248
  buffer_load_dwordx4 a[208:211], v2, s[8:11], s22 offen offset:0 sc1
  buffer_load_dwordx4 a[212:215], v2, s[8:11], s22 offen offset:1024 sc1
  buffer_load_dwordx4 a[216:219], v2, s[8:11], s22 offen offset:2048 sc1
  buffer_load_dwordx4 a[220:223], v2, s[8:11], s22 offen offset:3072 sc1
  s_add_u32 s22, s31, 57344
  buffer_load_dwordx4 a[224:227], v2, s[8:11], s22 offen offset:0 sc1
  buffer_load_dwordx4 a[228:231], v2, s[8:11], s22 offen offset:1024 sc1
  buffer_load_dwordx4 a[232:235], v2, s[8:11], s22 offen offset:2048 sc1
  buffer_load_dwordx4 a[236:239], v2, s[8:11], s22 offen offset:3072 sc1
  s_add_u32 s22, s31, 61440
  buffer_load_dwordx4 a[240:243], v2, s[8:11], s22 offen offset:0 sc1
  buffer_load_dwordx4 a[244:247], v2, s[8:11], s22 offen offset:1024 sc1
  buffer_load_dwordx4 a[248:251], v2, s[8:11], s22 offen offset:2048 sc1
  buffer_load_dwordx4 a[252:255], v2, s[8:11], s22 offen offset:3072 sc1
  s_waitcnt vmcnt(24)
  s_add_u32 s22, s31, 65536
  buffer_load_dwordx4 v[120:123], v2, s[8:11], s22 offen offset:0 sc1
  buffer_load_dwordx4 v[124:127], v2, s[8:11], s22 offen offset:1024 sc1
  buffer_load_dwordx4 v[128:131], v2, s[8:11], s22 offen offset:2048 sc1
  buffer_load_dwordx4 v[132:135], v2, s[8:11], s22 offen offset:3072 sc1
  s_add_u32 s22, s31, 69632
  buffer_load_dwordx4 v[136:139], v2, s[8:11], s22 offen offset:0 sc1
  buffer_load_dwordx4 v[140:143], v2, s[8:11], s22 offen offset:1024 sc1
  buffer_load_dwordx4 v[144:147], v2, s[8:11], s22 offen offset:2048 sc1
  buffer_load_dwordx4 v[148:151], v2, s[8:11], s22 offen offset:3072 sc1
  s_add_u32 s22, s31, 73728
  buffer_load_dwordx4 v[152:155], v2, s[8:11], s22 offen offset:0 sc1
  buffer_load_dwordx4 v[156:159], v2, s[8:11], s22 offen offset:1024 sc1
  buffer_load_dwordx4 v[160:163], v2, s[8:11], s22 offen offset:2048 sc1
  buffer_load_dwordx4 v[164:167], v2, s[8:11], s22 offen offset:3072 sc1
  s_add_u32 s22, s31, 77824
  buffer_load_dwordx4 v[168:171], v2, s[8:11], s22 offen offset:0 sc1
  buffer_load_dwordx4 v[172:175], v2, s[8:11], s22 offen offset:1024 sc1
  buffer_load_dwordx4 v[176:179], v2, s[8:11], s22 offen offset:2048 sc1
  buffer_load_dwordx4 v[180:183], v2, s[8:11], s22 offen offset:3072 sc1
  s_add_u32 s22, s31, 81920
  buffer_load_dwordx4 v[184:187], v2, s[8:11], s22 offen offset:0 sc1
  buffer_load_dwordx4 v[188:191], v2, s[8:11], s22 offen offset:1024 sc1
  buffer_load_dwordx4 v[192:195], v2, s[8:11], s22 offen offset:2048 sc1
  buffer_load_dwordx4 v[196:199], v2, s[8:11], s22 offen offset:3072 sc1
  s_add_u32 s22, s31, 86016
  buffer_load_dwordx4 v[200:203], v2, s[8:11], s22 offen offset:0 sc1
  buffer_load_dwordx4 v[204:207], v2, s[8:11], s22 offen offset:1024 sc1
  buffer_load_dwordx4 v[208:211], v2, s[8:11], s22 offen offset:2048 sc1
  buffer_load_dwordx4 v[212:215], v2, s[8:11], s22 offen offset:3072 sc1
  s_add_u32 s22, s31, 90112
  buffer_load_dwordx4 v[216:219], v2, s[8:11], s22 offen offset:0 sc1
  buffer_load_dwordx4 v[220:223], v2, s[8:11], s22 offen offset:1024 sc1
  buffer_load_dwordx4 v[224:227], v2, s[8:11], s22 offen offset:2048 sc1
  buffer_load_dwordx4 v[228:231], v2, s[8:11], s22 offen offset:3072 sc1
  s_add_u32 s22, s31, 94208
  buffer_load_dwordx4 v[232:235], v2, s[8:11], s22 offen offset:0 sc1
  buffer_load_dwordx4 v[236:239], v2, s[8:11], s22 offen offset:1024 sc1
  buffer_load_dwordx4 v[240:243], v2, s[8:11], s22 offen offset:2048 sc1
  buffer_load_dwordx4 v[244:247], v2, s[8:11], s22 offen offset:3072 sc1
  s_waitcnt vmcnt(24)
  s_add_u32 s22, s31, 98304
  buffer_load_dwordx4 v[248:251], v2, s[8:11], s22 offen offset:0 sc1
  buffer_load_dwordx4 v[252:255], v2, s[8:11], s22 offen offset:1024 sc1
  v_mov_b32 v72, v116
  v_mov_b32 v73, v117
  v_lshrrev_b32 v65, 1, v72
  v_and_b32 v66, 1, v72
  v_mov_b32 v36, 0
  v_mov_b32 v37, 0
  v_mov_b32 v38, 0
  v_mov_b32 v39, 0
  v_mov_b32 v40, 0
  v_mov_b32 v41, 0
  v_mov_b32 v42, 0
  v_mov_b32 v43, 0
  v_mov_b32 v44, 0
  v_mov_b32 v45, 0
  v_mov_b32 v46, 0
  v_mov_b32 v47, 0
  v_mov_b32 v48, 0
  v_mov_b32 v49, 0
  v_mov_b32 v50, 0
  v_mov_b32 v51, 0
  v_mov_b32 v52, 0
  v_mov_b32 v53, 0
  v_mov_b32 v54, 0
  v_mov_b32 v55, 0
  v_mov_b32 v56, 0
  v_mov_b32 v57, 0
  v_mov_b32 v58, 0
  v_mov_b32 v59, 0
  v_mov_b32 v60, 0
  v_mov_b32 v61, 0
  v_mov_b32 v62, 0
  v_mov_b32 v63, 0
  v_lshlrev_b32 v75, 2, v65
  v_lshl_add_u32 v75, v66, 3, v75
  v_add_u32 v67, 224, v73
  v_mul_u32_u24 v68, 2341, v67
  v_lshrrev_b32 v68, 16, v68
  v_mul_u32_u24 v69, 28, v68
  v_sub_u32 v69, v67, v69
  v_lshrrev_b32 v70, 4, v69
  v_and_b32 v69, 15, v69
  v_lshlrev_b32 v71, 12, v70
  v_lshl_add_u32 v71, v68, 8, v71
  v_lshl_add_u32 v71, v69, 4, v71
  v_add_u32 v104, v71, v75
  v_add_u32 v67, 240, v73
  v_mul_u32_u24 v68, 2341, v67
  v_lshrrev_b32 v68, 16, v68
  v_mul_u32_u24 v69, 28, v68
  v_sub_u32 v69, v67, v69
  v_lshrrev_b32 v70, 4, v69
  v_and_b32 v69, 15, v69
  v_lshlrev_b32 v71, 12, v70
  v_lshl_add_u32 v71, v68, 8, v71
  v_lshl_add_u32 v71, v69, 4, v71
  v_add_u32 v105, v71, v75
  v_add_u32 v67, 256, v73
  v_mul_u32_u24 v68, 2341, v67
  v_lshrrev_b32 v68, 16, v68
  v_mul_u32_u24 v69, 28, v68
  v_sub_u32 v69, v67, v69
  v_lshrrev_b32 v70, 4, v69
  v_and_b32 v69, 15, v69
  v_lshlrev_b32 v71, 12, v70
  v_lshl_add_u32 v71, v68, 8, v71
  v_lshl_add_u32 v71, v69, 4, v71
  v_add_u32 v106, v71, v75
  v_add_u32 v67, 272, v73
  v_mul_u32_u24 v68, 2341, v67
  v_lshrrev_b32 v68, 16, v68
  v_mul_u32_u24 v69, 28, v68
  v_sub_u32 v69, v67, v69
  v_lshrrev_b32 v70, 4, v69
  v_and_b32 v69, 15, v69
  v_lshlrev_b32 v71, 12, v70
  v_lshl_add_u32 v71, v68, 8, v71
  v_lshl_add_u32 v71, v69, 4, v71
  v_add_u32 v107, v71, v75
  v_add_u32 v67, 288, v73
  v_mul_u32_u24 v68, 2341, v67
  v_lshrrev_b32 v68, 16, v68
  v_mul_u32_u24 v69, 28, v68
  v_sub_u32 v69, v67, v69
  v_lshrrev_b32 v70, 4, v69
  v_and_b32 v69, 15, v69
  v_lshlrev_b32 v71, 12, v70
  v_lshl_add_u32 v71, v68, 8, v71
  v_lshl_add_u32 v71, v69, 4, v71
  v_add_u32 v108, v71, v75
  v_add_u32 v67, 304, v73
  v_mul_u32_u24 v68, 2341, v67
  v_lshrrev_b32 v68, 16, v68
  v_mul_u32_u24 v69, 28, v68
  v_sub_u32 v69, v67, v69
  v_lshrrev_b32 v70, 4, v69
  v_and_b32 v69, 15, v69
  v_lshlrev_b32 v71, 12, v70
  v_lshl_add_u32 v71, v68, 8, v71
  v_lshl_add_u32 v71, v69, 4, v71
  v_add_u32 v109, v71, v75
  v_add_u32 v67, 320, v73
  v_mul_u32_u24 v68, 2341, v67
  v_lshrrev_b32 v68, 16, v68
  v_mul_u32_u24 v69, 28, v68
  v_sub_u32 v69, v67, v69
  v_lshrrev_b32 v70, 4, v69
  v_and_b32 v69, 15, v69
  v_lshlrev_b32 v71, 12, v70
  v_lshl_add_u32 v71, v68, 8, v71
  v_lshl_add_u32 v71, v69, 4, v71
  v_add_u32 v110, v71, v75
  v_mov_b32 v74, 0x40000000
  v_and_b32 v119, 15, v1
  s_and_b32 s22, s17, 0
  s_lshl_b32 s22, s22, 7
  s_add_u32 s22, s22, 75733504
  v_lshl_add_u32 v119, v119, 2, s22
  s_lshl_b32 s22, s17, 2
  s_add_u32 s22, s22, 75731456
  v_lshl_add_u32 v118, v1, 7, s22
  v_cmp_gt_u32 vcc, 1, v1
  s_nop 1
  v_cndmask_b32 v118, v74, v118, vcc
  s_lshl_b32 s35, s17, 7
  s_add_u32 s35, s35, 88461312
  s_mov_b32 s28, s35
  v_min_u32 v116, 13, v1
  s_mul_i32 s22, s17, 14
  v_add_u32 v116, s22, v116
  v_lshlrev_b32 v116, 7, v116
  s_mov_b32 s39, 72052736
  s_mov_b32 s39, 72081408
  s_mov_b32 s30, 0
ch_vw6i:
  buffer_load_dword v9, off, s[12:15], 0 offset:132 sc1
  s_waitcnt vmcnt(0)
  v_cmp_ne_u32 vcc, 1, v9
  s_cbranch_vccz ch_vw6i_ok
  s_sleep 8
  s_add_u32 s30, s30, 1
  s_cmp_lt_u32 s30, 400000
  s_cbranch_scc1 ch_vw6i
  s_branch cA_abort
ch_vw6i_ok:
  s_lshl_b32 s27, s17, 7
  s_add_u32 s27, s27, 88461312
  s_mov_b32 s30, 0
ch_vw6:
  buffer_load_dword v9, off, s[8:11], s27 sc1
  s_waitcnt vmcnt(0)
  v_cmp_ne_u32 vcc, 56, v9
  s_cbranch_vccz ch_vw6_d
  s_sleep 2
  s_add_u32 s30, s30, 1
  s_cmp_lt_u32 s30, 400000
  s_cbranch_scc1 ch_vw6
  s_branch cA_abort
ch_vw6_d:
  s_mov_b32 s30, 0
  v_mov_b32 v8, 0
ch_md6:
  buffer_load_dword v9, v8, s[12:15], 0 offen sc1
  s_waitcnt vmcnt(0) lgkmcnt(0)
  v_readfirstlane_b32 s22, v9
  s_and_b32 s31, s22, 0xffff
  s_cmp_ge_u32 s31, 32
  s_cbranch_scc1 ch_go6
  s_sleep 2
  s_add_u32 s30, s30, 1
  s_cmp_lt_u32 s30, 3200000
  s_cbranch_scc1 ch_md6
  s_branch ch_end
ch_go6:
  s_mov_b32 s31, 0
  s_lshr_b32 s22, s22, 16
  s_cmp_lg_u32 s22, 0
  s_cbranch_scc1 cB_va2_loop
  s_branch cA_va2_loop
ch_init7:
  s_mul_i32 s31, s17, 401408
  s_add_u32 s31, s31, 6723584
  s_mov_b32 s30, 0
ch_wr7:
  buffer_load_dword v65, off, s[12:15], 0 offset:128 sc1
  s_waitcnt vmcnt(0)
  v_cmp_ne_u32 vcc, 1, v65
  s_cbranch_vccz ch_wr7_ok
  s_sleep 8
  s_add_u32 s30, s30, 1
  s_cmp_lt_u32 s30, 400000
  s_cbranch_scc1 ch_wr7
  s_branch cA_abort
ch_wr7_ok:
  s_lshr_b32 s22, s17, 2
  s_lshl_b32 s28, 0x81, s22
  s_mul_i32 s27, s17, 12
  s_add_u32 s22, s27, 256
  s_lshr_b32 s22, s22, 6
  s_lshl_b32 s22, 0x81, s22
  s_or_b32 s28, s28, s22
  s_add_u32 s22, s27, 267
  s_lshr_b32 s22, s22, 6
  s_lshl_b32 s22, 0x81, s22
  s_or_b32 s28, s28, s22
  v_lshlrev_b32 v64, 7, v116
  s_mov_b32 s27, 88520704
  s_mov_b32 s30, 0
ch_ww7:
  buffer_load_dword v65, v64, s[8:11], s27 offen sc1
  s_waitcnt vmcnt(0)
  v_and_b32 v66, s28, v65
  v_cmp_ne_u32 vcc, s28, v66
  s_cbranch_vccz ch_ww7_ok
  s_sleep 3
  s_add_u32 s30, s30, 1
  s_cmp_lt_u32 s30, 400000
  s_cbranch_scc1 ch_ww7
  s_branch cA_abort
ch_ww7_ok:
  s_add_u32 s22, s31, 0
  buffer_load_dwordx4 a[0:3], v2, s[8:11], s22 offen offset:0 sc1
  buffer_load_dwordx4 a[4:7], v2, s[8:11], s22 offen offset:1024 sc1
  buffer_load_dwordx4 a[8:11], v2, s[8:11], s22 offen offset:2048 sc1
  buffer_load_dwordx4 a[12:15], v2, s[8:11], s22 offen offset:3072 sc1
  s_add_u32 s22, s31, 4096
  buffer_load_dwordx4 a[16:19], v2, s[8:11], s22 offen offset:0 sc1
  buffer_load_dwordx4 a[20:23], v2, s[8:11], s22 offen offset:1024 sc1
  buffer_load_dwordx4 a[24:27], v2, s[8:11], s22 offen offset:2048 sc1
  buffer_load_dwordx4 a[28:31], v2, s[8:11], s22 offen offset:3072 sc1
  s_add_u32 s22, s31, 8192
  buffer_load_dwordx4 a[32:35], v2, s[8:11], s22 offen offset:0 sc1
  buffer_load_dwordx4 a[36:39], v2, s[8:11], s22 offen offset:1024 sc1
  buffer_load_dwordx4 a[40:43], v2, s[8:11], s22 offen offset:2048 sc1
  buffer_load_dwordx4 a[44:47], v2, s[8:11], s22 offen offset:3072 sc1
  s_add_u32 s22, s31, 12288
  buffer_load_dwordx4 a[48:51], v2, s[8:11], s22 offen offset:0 sc1
  buffer_load_dwordx4 a[52:55], v2, s[8:11], s22 offen offset:1024 sc1
  buffer_load_dwordx4 a[56:59], v2, s[8:11], s22 offen offset:2048 sc1
  buffer_load_dwordx4 a[60:63], v2, s[8:11], s22 offen offset:3072 sc1
  s_add_u32 s22, s31, 16384
  buffer_load_dwordx4 a[64:67], v2, s[8:11], s22 offen offset:0 sc1
  buffer_load_dwordx4 a[68:71], v2, s[8:11], s22 offen offset:1024 sc1
  buffer_load_dwordx4 a[72:75], v2, s[8:11], s22 offen offset:2048 sc1
  buffer_load_dwordx4 a[76:79], v2, s[8:11], s22 offen offset:3072 sc1
  s_add_u32 s22, s31, 20480
  buffer_load_dwordx4 a[80:83], v2, s[8:11], s22 offen offset:0 sc1
  buffer_load_dwordx4 a[84:87], v2, s[8:11], s22 offen offset:1024 sc1
  buffer_load_dwordx4 a[88:91], v2, s[8:11], s22 offen offset:2048 sc1
  buffer_load_dwordx4 a[92:95], v2, s[8:11], s22 offen offset:3072 sc1
  s_add_u32 s22, s31, 24576
  buffer_load_dwordx4 a[96:99], v2, s[8:11], s22 offen offset:0 sc1
  buffer_load_dwordx4 a[100:103], v2, s[8:11], s22 offen offset:1024 sc1
  buffer_load_dwordx4 a[104:107], v2, s[8:11], s22 offen offset:2048 sc1
  buffer_load_dwordx4 a[108:111], v2, s[8:11], s22 offen offset:3072 sc1
  s_add_u32 s22, s31, 28672
  buffer_load_dwordx4 a[112:115], v2, s[8:11], s22 offen offset:0 sc1
  buffer_load_dwordx4 a[116:119], v2, s[8:11], s22 offen offset:1024 sc1
  buffer_load_dwordx4 a[120:123], v2, s[8:11], s22 offen offset:2048 sc1
  buffer_load_dwordx4 a[124:127], v2, s[8:11], s22 offen offset:3072 sc1
  s_waitcnt vmcnt(24)
  s_add_u32 s22, s31, 32768
  buffer_load_dwordx4 a[128:131], v2, s[8:11], s22 offen offset:0 sc1
  buffer_load_dwordx4 a[132:135], v2, s[8:11], s22 offen offset:1024 sc1
  buffer_load_dwordx4 a[136:139], v2, s[8:11], s22 offen offset:2048 sc1
  buffer_load_dwordx4 a[140:143], v2, s[8:11], s22 offen offset:3072 sc1
  s_add_u32 s22, s31, 36864
  buffer_load_dwordx4 a[144:147], v2, s[8:11], s22 offen offset:0 sc1
  buffer_load_dwordx4 a[148:151], v2, s[8:11], s22 offen offset:1024 sc1
  buffer_load_dwordx4 a[152:155], v2, s[8:11], s22 offen offset:2048 sc1
  buffer_load_dwordx4 a[156:159], v2, s[8:11], s22 offen offset:3072 sc1
  s_add_u32 s22, s31, 40960
  buffer_load_dwordx4 a[160:163], v2, s[8:11], s22 offen offset:0 sc1
  buffer_load_dwordx4 a[164:167], v2, s[8:11], s22 offen offset:1024 sc1
  buffer_load_dwordx4 a[168:171], v2, s[8:11], s22 offen offset:2048 sc1
  buffer_load_dwordx4 a[172:175], v2, s[8:11], s22 offen offset:3072 sc1
  s_add_u32 s22, s31, 45056
  buffer_load_dwordx4 a[176:179], v2, s[8:11], s22 offen offset:0 sc1
  buffer_load_dwordx4 a[180:183], v2, s[8:11], s22 offen offset:1024 sc1
  buffer_load_dwordx4 a[184:187], v2, s[8:11], s22 offen offset:2048 sc1
  buffer_load_dwordx4 a[188:191], v2, s[8:11], s22 offen offset:3072 sc1
  s_add_u32 s22, s31, 49152
  buffer_load_dwordx4 a[192:195], v2, s[8:11], s22 offen offset:0 sc1
  buffer_load_dwordx4 a[196:199], v2, s[8:11], s22 offen offset:1024 sc1
  buffer_load_dwordx4 a[200:203], v2, s[8:11], s22 offen offset:2048 sc1
  buffer_load_dwordx4 a[204:207], v2, s[8:11], s22 offen offset:3072 sc1
  s_add_u32 s22, s31, 53248
  buffer_load_dwordx4 a[208:211], v2, s[8:11], s22 offen offset:0 sc1
  buffer_load_dwordx4 a[212:215], v2, s[8:11], s22 offen offset:1024 sc1
  buffer_load_dwordx4 a[216:219], v2, s[8:11], s22 offen offset:2048 sc1
  buffer_load_dwordx4 a[220:223], v2, s[8:11], s22 offen offset:3072 sc1
  s_add_u32 s22, s31, 57344
  buffer_load_dwordx4 a[224:227], v2, s[8:11], s22 offen offset:0 sc1
  buffer_load_dwordx4 a[228:231], v2, s[8:11], s22 offen offset:1024 sc1
  buffer_load_dwordx4 a[232:235], v2, s[8:11], s22 offen offset:2048 sc1
  buffer_load_dwordx4 a[236:239], v2, s[8:11], s22 offen offset:3072 sc1
  s_add_u32 s22, s31, 61440
  buffer_load_dwordx4 a[240:243], v2, s[8:11], s22 offen offset:0 sc1
  buffer_load_dwordx4 a[244:247], v2, s[8:11], s22 offen offset:1024 sc1
  buffer_load_dwordx4 a[248:251], v2, s[8:11], s22 offen offset:2048 sc1
  buffer_load_dwordx4 a[252:255], v2, s[8:11], s22 offen offset:3072 sc1
  s_waitcnt vmcnt(24)
  s_add_u32 s22, s31, 65536
  buffer_load_dwordx4 v[120:123], v2, s[8:11], s22 offen offset:0 sc1
  buffer_load_dwordx4 v[124:127], v2, s[8:11], s22 offen offset:1024 sc1
  buffer_load_dwordx4 v[128:131], v2, s[8:11], s22 offen offset:2048 sc1
  buffer_load_dwordx4 v[132:135], v2, s[8:11], s22 offen offset:3072 sc1
  s_add_u32 s22, s31, 69632
  buffer_load_dwordx4 v[136:139], v2, s[8:11], s22 offen offset:0 sc1
  buffer_load_dwordx4 v[140:143], v2, s[8:11], s22 offen offset:1024 sc1
  buffer_load_dwordx4 v[144:147], v2, s[8:11], s22 offen offset:2048 sc1
  buffer_load_dwordx4 v[148:151], v2, s[8:11], s22 offen offset:3072 sc1
  s_add_u32 s22, s31, 73728
  buffer_load_dwordx4 v[152:155], v2, s[8:11], s22 offen offset:0 sc1
  buffer_load_dwordx4 v[156:159], v2, s[8:11], s22 offen offset:1024 sc1
  buffer_load_dwordx4 v[160:163], v2, s[8:11], s22 offen offset:2048 sc1
  buffer_load_dwordx4 v[164:167], v2, s[8:11], s22 offen offset:3072 sc1
  s_add_u32 s22, s31, 77824
  buffer_load_dwordx4 v[168:171], v2, s[8:11], s22 offen offset:0 sc1
  buffer_load_dwordx4 v[172:175], v2, s[8:11], s22 offen offset:1024 sc1
  buffer_load_dwordx4 v[176:179], v2, s[8:11], s22 offen offset:2048 sc1
  buffer_load_dwordx4 v[180:183], v2, s[8:11], s22 offen offset:3072 sc1
  s_add_u32 s22, s31, 81920
  buffer_load_dwordx4 v[184:187], v2, s[8:11], s22 offen offset:0 sc1
  buffer_load_dwordx4 v[188:191], v2, s[8:11], s22 offen offset:1024 sc1
  buffer_load_dwordx4 v[192:195], v2, s[8:11], s22 offen offset:2048 sc1
  buffer_load_dwordx4 v[196:199], v2, s[8:11], s22 offen offset:3072 sc1
  s_add_u32 s22, s31, 86016
  buffer_load_dwordx4 v[200:203], v2, s[8:11], s22 offen offset:0 sc1
  buffer_load_dwordx4 v[204:207], v2, s[8:11], s22 offen offset:1024 sc1
  buffer_load_dwordx4 v[208:211], v2, s[8:11], s22 offen offset:2048 sc1
  buffer_load_dwordx4 v[212:215], v2, s[8:11], s22 offen offset:3072 sc1
  s_add_u32 s22, s31, 90112
  buffer_load_dwordx4 v[216:219], v2, s[8:11], s22 offen offset:0 sc1
  buffer_load_dwordx4 v[220:223], v2, s[8:11], s22 offen offset:1024 sc1
  buffer_load_dwordx4 v[224:227], v2, s[8:11], s22 offen offset:2048 sc1
  buffer_load_dwordx4 v[228:231], v2, s[8:11], s22 offen offset:3072 sc1
  s_add_u32 s22, s31, 94208
  buffer_load_dwordx4 v[232:235], v2, s[8:11], s22 offen offset:0 sc1
  buffer_load_dwordx4 v[236:239], v2, s[8:11], s22 offen offset:1024 sc1
  buffer_load_dwordx4 v[240:243], v2, s[8:11], s22 offen offset:2048 sc1
  buffer_load_dwordx4 v[244:247], v2, s[8:11], s22 offen offset:3072 sc1
  s_waitcnt vmcnt(24)
  s_add_u32 s22, s31, 98304
  buffer_load_dwordx4 v[248:251], v2, s[8:11], s22 offen offset:0 sc1
  buffer_load_dwordx4 v[252:255], v2, s[8:11], s22 offen offset:1024 sc1
  v_mov_b32 v72, v116
  v_mov_b32 v73, v117
  v_lshrrev_b32 v65, 1, v72
  v_and_b32 v66, 1, v72
  v_mov_b32 v36, 0
  v_mov_b32 v37, 0
  v_mov_b32 v38, 0
  v_mov_b32 v39, 0
  v_mov_b32 v40, 0
  v_mov_b32 v41, 0
  v_mov_b32 v42, 0
  v_mov_b32 v43, 0
  v_mov_b32 v44, 0
  v_mov_b32 v45, 0
  v_mov_b32 v46, 0
  v_mov_b32 v47, 0
  v_mov_b32 v48, 0
  v_mov_b32 v49, 0
  v_mov_b32 v50, 0
  v_mov_b32 v51, 0
  v_mov_b32 v52, 0
  v_mov_b32 v53, 0
  v_mov_b32 v54, 0
  v_mov_b32 v55, 0
  v_mov_b32 v56, 0
  v_mov_b32 v57, 0
  v_mov_b32 v58, 0
  v_mov_b32 v59, 0
  v_mov_b32 v60, 0
  v_mov_b32 v61, 0
  v_mov_b32 v62, 0
  v_mov_b32 v63, 0
  v_lshlrev_b32 v75, 2, v65
  v_lshl_add_u32 v75, v66, 3, v75
  v_add_u32 v67, 336, v73
  v_mul_u32_u24 v68, 2341, v67
  v_lshrrev_b32 v68, 16, v68
  v_mul_u32_u24 v69, 28, v68
  v_sub_u32 v69, v67, v69
  v_lshrrev_b32 v70, 4, v69
  v_and_b32 v69, 15, v69
  v_lshlrev_b32 v71, 12, v70
  v_lshl_add_u32 v71, v68, 8, v71
  v_lshl_add_u32 v71, v69, 4, v71
  v_add_u32 v104, v71, v75
  v_add_u32 v67, 352, v73
  v_mul_u32_u24 v68, 2341, v67
  v_lshrrev_b32 v68, 16, v68
  v_mul_u32_u24 v69, 28, v68
  v_sub_u32 v69, v67, v69
  v_lshrrev_b32 v70, 4, v69
  v_and_b32 v69, 15, v69
  v_lshlrev_b32 v71, 12, v70
  v_lshl_add_u32 v71, v68, 8, v71
  v_lshl_add_u32 v71, v69, 4, v71
  v_add_u32 v105, v71, v75
  v_add_u32 v67, 368, v73
  v_mul_u32_u24 v68, 2341, v67
  v_lshrrev_b32 v68, 16, v68
  v_mul_u32_u24 v69, 28, v68
  v_sub_u32 v69, v67, v69
  v_lshrrev_b32 v70, 4, v69
  v_and_b32 v69, 15, v69
  v_lshlrev_b32 v71, 12, v70
  v_lshl_add_u32 v71, v68, 8, v71
  v_lshl_add_u32 v71, v69, 4, v71
  v_add_u32 v106, v71, v75
  v_add_u32 v67, 384, v73
  v_mul_u32_u24 v68, 2341, v67
  v_lshrrev_b32 v68, 16, v68
  v_mul_u32_u24 v69, 28, v68
  v_sub_u32 v69, v67, v69
  v_lshrrev_b32 v70, 4, v69
  v_and_b32 v69, 15, v69
  v_lshlrev_b32 v71, 12, v70
  v_lshl_add_u32 v71, v68, 8, v71
  v_lshl_add_u32 v71, v69, 4, v71
  v_add_u32 v107, v71, v75
  v_add_u32 v67, 400, v73
  v_mul_u32_u24 v68, 2341, v67
  v_lshrrev_b32 v68, 16, v68
  v_mul_u32_u24 v69, 28, v68
  v_sub_u32 v69, v67, v69
  v_lshrrev_b32 v70, 4, v69
  v_and_b32 v69, 15, v69
  v_lshlrev_b32 v71, 12, v70
  v_lshl_add_u32 v71, v68, 8, v71
  v_lshl_add_u32 v71, v69, 4, v71
  v_add_u32 v108, v71, v75
  v_add_u32 v67, 416, v73
  v_mul_u32_u24 v68, 2341, v67
  v_lshrrev_b32 v68, 16, v68
  v_mul_u32_u24 v69, 28, v68
  v_sub_u32 v69, v67, v69
  v_lshrrev_b32 v70, 4, v69
  v_and_b32 v69, 15, v69
  v_lshlrev_b32 v71, 12, v70
  v_lshl_add_u32 v71, v68, 8, v71
  v_lshl_add_u32 v71, v69, 4, v71
  v_add_u32 v109, v71, v75
  v_add_u32 v67, 432, v73
  v_mul_u32_u24 v68, 2341, v67
  v_lshrrev_b32 v68, 16, v68
  v_mul_u32_u24 v69, 28, v68
  v_sub_u32 v69, v67, v69
  v_lshrrev_b32 v70, 4, v69
  v_and_b32 v69, 15, v69
  v_lshlrev_b32 v71, 12, v70
  v_lshl_add_u32 v71, v68, 8, v71
  v_lshl_add_u32 v71, v69, 4, v71
  v_add_u32 v110, v71, v75
  v_mov_b32 v74, 0x40000000
  v_and_b32 v119, 15, v1
  s_and_b32 s22, s17, 0
  s_lshl_b32 s22, s22, 7
  s_add_u32 s22, s22, 75733504
  v_lshl_add_u32 v119, v119, 2, s22
  s_lshl_b32 s22, s17, 2
  s_add_u32 s22, s22, 75731456
  v_lshl_add_u32 v118, v1, 7, s22
  v_cmp_gt_u32 vcc, 1, v1
  s_nop 1
  v_cndmask_b32 v118, v74, v118, vcc
  s_lshl_b32 s35, s17, 7
  s_add_u32 s35, s35, 88461312
  s_mov_b32 s28, s35
  v_min_u32 v116, 13, v1
  s_mul_i32 s22, s17, 14
  v_add_u32 v116, s22, v116
  v_lshlrev_b32 v116, 7, v116
  s_mov_b32 s39, 72052736
  s_mov_b32 s30, 0
ch_vw7i:
  buffer_load_dword v9, off, s[12:15], 0 offset:132 sc1
  s_waitcnt vmcnt(0)
  v_cmp_ne_u32 vcc, 1, v9
  s_cbranch_vccz ch_vw7i_ok
  s_sleep 8
  s_add_u32 s30, s30, 1
  s_cmp_lt_u32 s30, 400000
  s_cbranch_scc1 ch_vw7i
  s_branch cA_abort
ch_vw7i_ok:
  s_lshl_b32 s27, s17, 7
  s_add_u32 s27, s27, 88461312
  s_mov_b32 s30, 0
ch_vw7:
  buffer_load_dword v9, off, s[8:11], s27 sc1
  s_waitcnt vmcnt(0)
  v_cmp_ne_u32 vcc, 56, v9
  s_cbranch_vccz ch_vw7_d
  s_sleep 2
  s_add_u32 s30, s30, 1
  s_cmp_lt_u32 s30, 400000
  s_cbranch_scc1 ch_vw7
  s_branch cA_abort
ch_vw7_d:
  buffer_load_dword v100, v116, s[8:11], s39 offen sc1
  s_mov_b32 s39, 72081408
  s_mov_b32 s30, 0
  v_mov_b32 v8, 0
ch_md7:
  buffer_load_dword v9, v8, s[12:15], 0 offen sc1
  s_waitcnt vmcnt(0) lgkmcnt(0)
  v_readfirstlane_b32 s22, v9
  s_and_b32 s31, s22, 0xffff
  s_cmp_ge_u32 s31, 32
  s_cbranch_scc1 ch_go7
  s_sleep 2
  s_add_u32 s30, s30, 1
  s_cmp_lt_u32 s30, 3200000
  s_cbranch_scc1 ch_md7
  s_branch ch_end
ch_go7:
  s_mov_b32 s31, 0
  s_lshr_b32 s22, s22, 16
  s_cmp_lg_u32 s22, 0
  s_cbranch_scc1 cB_va3_loop
  s_branch cA_va3_loop
.p2align 6
cA_sc0_loop:
  s_mov_b32 s30, 0
  s_mov_b32 s62, 0
  s_setprio 3
  s_sleep 6
  buffer_load_dword v76, v0, s[8:11], 0 offen sc1
  buffer_load_dword v77, v0, s[8:11], 0 offen sc1
  buffer_load_dword v78, v0, s[8:11], 0 offen sc1
  buffer_load_dword v79, v0, s[8:11], 0 offen sc1
cA_sc0_fp_l:
  s_waitcnt vmcnt(3)
  v_cmp_gt_u32 vcc, s19, v76
  s_cbranch_vccz cA_sc0_fp_d
  buffer_load_dword v76, v0, s[8:11], 0 offen sc1
  s_waitcnt vmcnt(3)
  v_cmp_gt_u32 vcc, s19, v77
  s_cbranch_vccz cA_sc0_fp_d
  buffer_load_dword v77, v0, s[8:11], 0 offen sc1
  s_waitcnt vmcnt(3)
  v_cmp_gt_u32 vcc, s19, v78
  s_cbranch_vccz cA_sc0_fp_d
  buffer_load_dword v78, v0, s[8:11], 0 offen sc1
  s_waitcnt vmcnt(3)
  v_cmp_gt_u32 vcc, s19, v79
  s_cbranch_vccz cA_sc0_fp_d
  buffer_load_dword v79, v0, s[8:11], 0 offen sc1
  s_add_u32 s30, s30, 1
  s_cmp_lt_u32 s30, 400000
  s_cbranch_scc1 cA_sc0_fp_l
  s_branch cA_abort
cA_sc0_fp_d:
  buffer_load_dwordx4 v[8:11], v2, s[8:11], s20 offen offset:0 sc1
  s_barrier
  s_setprio 2
  buffer_load_dwordx4 v[12:15], v2, s[8:11], s20 offen offset:1024 sc1
  s_setprio 1
  buffer_load_dwordx4 v[16:19], v2, s[8:11], s20 offen offset:2048 sc1
  s_setprio 0
  buffer_load_dwordx4 v[20:23], v2, s[8:11], s20 offen offset:3072 sc1
cA_sc0_go:
  s_waitcnt vmcnt(3)
  v_smfmac_f32_16x16x64_bf16 v[36:39], v[8:11], a[0:7], v3
  buffer_load_dwordx4 v[32:35], v2, s[8:11], s23 offen offset:0 sc1
  v_cmp_eq_u32 vcc, -1, v8
  v_smfmac_f32_16x16x64_bf16 v[40:43], v[8:11], a[56:63], v3
  v_smfmac_f32_16x16x64_bf16 v[44:47], v[8:11], a[112:119], v3
  buffer_load_dwordx4 v[24:27], v2, s[8:11], s23 offen offset:1024 sc1
  s_cbranch_vccnz cA_sc0_r0
  v_smfmac_f32_16x16x64_bf16 v[48:51], v[8:11], a[168:175], v3
  v_smfmac_f32_16x16x64_bf16 v[52:55], v[8:11], a[224:231], v3
  s_waitcnt vmcnt(4)
  v_cmp_eq_u32 vcc, -1, v12
  v_smfmac_f32_16x16x64_bf16 v[56:59], v[8:11], v[144:151], v3
  buffer_load_dwordx4 v[28:31], v2, s[8:11], s23 offen offset:2048 sc1
  v_smfmac_f32_16x16x64_bf16 v[60:63], v[8:11], v[200:207], v3
  s_cbranch_vccnz cA_sc0_r1
cA_sc0_c1:
  v_smfmac_f32_16x16x64_bf16 v[36:39], v[12:15], a[8:15], v3
  v_smfmac_f32_16x16x64_bf16 v[40:43], v[12:15], a[64:71], v3
  v_smfmac_f32_16x16x64_bf16 v[44:47], v[12:15], a[120:127], v3
  v_smfmac_f32_16x16x64_bf16 v[48:51], v[12:15], a[176:183], v3
  v_smfmac_f32_16x16x64_bf16 v[52:55], v[12:15], a[232:239], v3
  s_waitcnt vmcnt(4)
  v_cmp_eq_u32 vcc, -1, v16
  v_smfmac_f32_16x16x64_bf16 v[56:59], v[12:15], v[152:159], v3
  buffer_load_dwordx4 v[88:91], v117, s[8:11], s26 offen offset:0 sc1
  v_smfmac_f32_16x16x64_bf16 v[60:63], v[12:15], v[208:215], v3
  s_cbranch_vccnz cA_sc0_r2
cA_sc0_c2:
  v_smfmac_f32_16x16x64_bf16 v[36:39], v[16:19], a[16:23], v3
  v_smfmac_f32_16x16x64_bf16 v[40:43], v[16:19], a[72:79], v3
  v_smfmac_f32_16x16x64_bf16 v[44:47], v[16:19], a[128:135], v3
  buffer_load_dwordx4 v[92:95], v117, s[8:11], s26 offen offset:1024 sc1
  v_smfmac_f32_16x16x64_bf16 v[48:51], v[16:19], a[184:191], v3
  v_smfmac_f32_16x16x64_bf16 v[52:55], v[16:19], a[240:247], v3
  s_waitcnt vmcnt(5)
  v_cmp_eq_u32 vcc, -1, v20
  v_smfmac_f32_16x16x64_bf16 v[56:59], v[16:19], v[160:167], v3
  v_smfmac_f32_16x16x64_bf16 v[60:63], v[16:19], v[216:223], v3
  buffer_load_dwordx4 v[96:99], v2, s[8:11], s24 offen offset:0 sc1
  s_cbranch_vccnz cA_sc0_r3
cA_sc0_c3:
  v_smfmac_f32_16x16x64_bf16 v[36:39], v[20:23], a[24:31], v3
  v_smfmac_f32_16x16x64_bf16 v[40:43], v[20:23], a[80:87], v3
  s_waitcnt vmcnt(3)
  v_max3_u32 v66, v24, v27, v28
  v_smfmac_f32_16x16x64_bf16 v[44:47], v[20:23], a[136:143], v3
  v_max3_u32 v66, v66, v31, v32
  v_smfmac_f32_16x16x64_bf16 v[48:51], v[20:23], a[192:199], v3
  buffer_load_dwordx4 v[100:103], v2, s[8:11], s24 offen offset:1024 sc1
  v_max_u32 v66, v66, v35
  v_smfmac_f32_16x16x64_bf16 v[52:55], v[20:23], a[248:255], v3
  v_cmp_eq_u32 vcc, -1, v66
  v_smfmac_f32_16x16x64_bf16 v[56:59], v[20:23], v[168:175], v3
  v_smfmac_f32_16x16x64_bf16 v[60:63], v[20:23], v[224:231], v3
  s_cbranch_vccnz cA_sc0_r4
cA_sc0_c4:
  v_smfmac_f32_16x16x64_bf16 v[60:63], v[32:35], v[232:239], v3
  buffer_load_dwordx4 v[104:107], v2, s[8:11], s26 offen offset:0 sc1
  v_smfmac_f32_16x16x64_bf16 v[60:63], v[24:27], v[240:247], v3
  v_smfmac_f32_16x16x64_bf16 v[60:63], v[28:31], v[248:255], v3
  v_smfmac_f32_16x16x64_bf16 v[52:55], v[32:35], v[120:127], v3
  v_smfmac_f32_16x16x64_bf16 v[52:55], v[24:27], v[128:135], v3
  buffer_load_dwordx4 v[108:111], v2, s[8:11], s26 offen offset:1024 sc1
  v_smfmac_f32_16x16x64_bf16 v[52:55], v[28:31], v[136:143], v3
  v_cvt_pk_bf16_f32 v63, v62, v63
  v_smfmac_f32_16x16x64_bf16 v[56:59], v[32:35], v[176:183], v3
  v_cvt_pk_bf16_f32 v62, v60, v61
  v_smfmac_f32_16x16x64_bf16 v[56:59], v[24:27], v[184:191], v3
  v_mfma_f32_16x16x32_bf16 v[12:15], v[62:65], v[4:7], 0
  v_cvt_pk_bf16_f32 v55, v54, v55
  v_smfmac_f32_16x16x64_bf16 v[56:59], v[28:31], v[192:199], v3
  v_cvt_pk_bf16_f32 v54, v52, v53
  v_smfmac_f32_16x16x64_bf16 v[36:39], v[32:35], a[32:39], v3
  s_nop 1
  v_cvt_pk_bf16_f32 v76, v12, v13
  v_smfmac_f32_16x16x64_bf16 v[36:39], v[24:27], a[40:47], v3
  v_cvt_pk_bf16_f32 v77, v14, v15
  v_smfmac_f32_16x16x64_bf16 v[36:39], v[28:31], a[48:55], v3
  v_cvt_pk_bf16_f32 v56, v56, v57
  v_smfmac_f32_16x16x64_bf16 v[40:43], v[32:35], a[88:95], v3
  v_cvt_pk_bf16_f32 v57, v58, v59
  v_smfmac_f32_16x16x64_bf16 v[40:43], v[24:27], a[96:103], v3
  v_mfma_f32_16x16x32_bf16 v[16:19], v[54:57], v[4:7], 0
  v_cvt_pk_bf16_f32 v39, v38, v39
  v_smfmac_f32_16x16x64_bf16 v[40:43], v[28:31], a[104:111], v3
  v_cvt_pk_bf16_f32 v38, v36, v37
  v_smfmac_f32_16x16x64_bf16 v[44:47], v[32:35], a[144:151], v3
  s_nop 1
  v_cvt_pk_bf16_f32 v78, v16, v17
  v_smfmac_f32_16x16x64_bf16 v[44:47], v[24:27], a[152:159], v3
  v_cvt_pk_bf16_f32 v79, v18, v19
  v_smfmac_f32_16x16x64_bf16 v[44:47], v[28:31], a[160:167], v3
  v_cvt_pk_bf16_f32 v40, v40, v41
  v_smfmac_f32_16x16x64_bf16 v[48:51], v[32:35], a[200:207], v3
  v_cvt_pk_bf16_f32 v41, v42, v43
  v_smfmac_f32_16x16x64_bf16 v[48:51], v[24:27], a[208:215], v3
  v_smfmac_f32_16x16x64_bf16 v[48:51], v[28:31], a[216:223], v3
  s_waitcnt vmcnt(4)
  v_cvt_pk_bf16_f32 v47, v46, v47
  v_smfmac_f32_16x16x64_bf16 v[68:71], v[76:79], v[80:87], v3
  v_cvt_pk_bf16_f32 v46, v44, v45
  v_mfma_f32_16x16x32_bf16 v[12:15], v[38:41], v[4:7], 0
  s_nop 1
  v_cvt_pk_bf16_f32 v48, v48, v49
  v_cvt_pk_bf16_f32 v49, v50, v51
  s_nop 1
  v_mfma_f32_16x16x32_bf16 v[16:19], v[46:49], v[4:7], 0
  v_smfmac_f32_16x16x64_bf16 v[72:75], v[76:79], v[88:95], v3
  v_cvt_pk_bf16_f32 v20, v12, v13
  v_mfma_f32_16x16x32_bf16 v[52:55], v[30:33], v[76:79], 0
  s_waitcnt vmcnt(0)
  v_cvt_pk_bf16_f32 v21, v14, v15
  v_cvt_pk_bf16_f32 v22, v16, v17
  v_cvt_pk_bf16_f32 v23, v18, v19
  s_nop 1
  v_mfma_f32_16x16x32_bf16 v[52:55], v[8:11], v[20:23], v[52:55]
  v_smfmac_f32_16x16x64_bf16 v[68:71], v[20:23], v[96:103], v3
  v_smfmac_f32_16x16x64_bf16 v[72:75], v[20:23], v[104:111], v3
  s_nop 1
  ds_write_b128 v113, v[52:55]
  s_nop 1
  v_permlane32_swap_b32 v68, v70
  v_permlane32_swap_b32 v69, v71
  v_add_f32 v56, v68, v70
  v_add_f32 v58, v69, v71
  v_permlane32_swap_b32 v72, v74
  v_permlane32_swap_b32 v73, v75
  v_add_f32 v57, v72, v74
  v_add_f32 v59, v73, v75
  ds_write_b128 v2, v[56:59] offset:0
  v_cmp_u_f32 vcc, v57, v59
  v_mov_b32 v68, 0
  v_mov_b32 v69, 0
  v_mov_b32 v70, 0
  v_mov_b32 v71, 0
  s_cbranch_vccnz cA_sc0_retry
cA_sc0_cont:
  s_add_u32 s24, s24, 28672
  s_add_u32 s26, s26, 28672
  buffer_load_dwordx4 v[80:83], v117, s[8:11], s24 offen offset:0 sc1
  buffer_load_dwordx4 v[84:87], v117, s[8:11], s24 offen offset:1024 sc1
  v_mov_b32 v72, 0
  v_mov_b32 v73, 0
  v_mfma_f32_32x32x16_bf16 v[36:51], v[68:71], v[68:71], 0
  s_waitcnt lgkmcnt(0)
  s_barrier
  ds_read_b64 v[8:9], v114 offset:0
  ds_read_b64 v[10:11], v114 offset:1024
  ds_read_b64 v[12:13], v114 offset:2048
  ds_read_b64 v[14:15], v114 offset:3072
  ds_read2_b32 v[16:17], v115 offset0:0 offset1:64
  ds_read2_b32 v[18:19], v115 offset0:128 offset1:192
  v_mfma_f32_32x32x16_bf16 v[52:67], v[68:71], v[68:71], 0
  s_waitcnt lgkmcnt(0)
  v_pk_add_f32 v[16:17], v[16:17], v[18:19]
  v_pk_add_f32 v[8:9], v[8:9], v[10:11]
  v_pk_add_f32 v[12:13], v[12:13], v[14:15]
  v_add_f32 v20, v16, v17
  v_pk_add_f32 v[8:9], v[8:9], v[12:13]
  v_max_f32 v22, v8, v9
  v_add_f32_dpp v20, v20, v20 row_ror:8 row_mask:0xf bank_mask:0xf
  s_nop 0
  v_max_f32_dpp v22, v22, v22 row_ror:8 row_mask:0xf bank_mask:0xf
  v_max_f32 v22, v22, v20
  s_nop 1
  v_max_f32_dpp v22, v22, v22 quad_perm:[1,0,3,2] row_mask:0xf bank_mask:0xf
  s_nop 1
  v_max_f32_dpp v22, v22, v22 quad_perm:[2,3,0,1] row_mask:0xf bank_mask:0xf
  s_nop 1
  v_max_f32_dpp v22, v22, v22 row_half_mirror row_mask:0xf bank_mask:0xf
  v_pk_add_f32 v[8:9], v[8:9], v[22:23] op_sel_hi:[1,0] neg_lo:[0,1] neg_hi:[0,1]
  v_sub_f32 v20, v20, v22
  v_exp_f32 v8, v8
  v_exp_f32 v9, v9
  v_exp_f32 v20, v20
  v_add_f32 v24, v8, v9
  v_fmac_f32 v24, 0.5, v20
  v_mov_b32_dpp v21, v20 quad_perm:[1,0,3,2] row_mask:0xf bank_mask:0xf
  s_nop 0
  v_add_f32_dpp v24, v24, v24 quad_perm:[1,0,3,2] row_mask:0xf bank_mask:0xf
  s_nop 1
  v_add_f32_dpp v24, v24, v24 quad_perm:[2,3,0,1] row_mask:0xf bank_mask:0xf
  s_nop 1
  v_add_f32_dpp v24, v24, v24 row_half_mirror row_mask:0xf bank_mask:0xf
  s_nop 1
  v_add_f32_dpp v24, v24, v24 row_ror:8 row_mask:0xf bank_mask:0xf
  v_rcp_f32 v24, v24
  s_nop 0
  v_pk_mul_f32 v[8:9], v[8:9], v[24:25] op_sel_hi:[1,0]
  v_pk_mul_f32 v[20:21], v[20:21], v[24:25] op_sel_hi:[1,0]
  v_cvt_pk_bf16_f32 v8, v8, v9
  v_cvt_pk_bf16_f32 v20, v20, v21
  v_min_u32 v8, -2, v8
  buffer_store_dword v8, v1, s[8:11], s20 offen
  v_min_u32 v20, -2, v20
  buffer_store_dword v20, v118, s[8:11], s20 offen
  buffer_store_dword v119, v1, s[8:11], s21 offen
  buffer_store_dword v119, v118, s[8:11], s21 offen
  v_mov_b32 v74, 0
  v_mov_b32 v75, 0
  s_mov_b32 s19, s18
  s_add_u32 s18, s18, 1
  s_mov_b32 s22, s20
  s_mov_b32 s20, s21
  s_mov_b32 s21, s22
  s_add_u32 s23, s20, 4096
  s_cmp_lt_u32 s19, 63
  s_cbranch_scc1 cA_sc0_loop
  s_branch cA_done
cA_sc0_r0:
  s_add_u32 s31, s31, 1
  buffer_load_dwordx4 v[8:11], v2, s[8:11], s20 offen offset:0 sc1
  s_waitcnt vmcnt(0)
  v_cmp_eq_u32 vcc, -1, v8
  v_mov_b32 v36, 0
  v_mov_b32 v37, 0
  v_mov_b32 v38, 0
  v_mov_b32 v39, 0
  v_mov_b32 v40, 0
  v_mov_b32 v41, 0
  v_mov_b32 v42, 0
  v_mov_b32 v43, 0
  v_mov_b32 v44, 0
  v_mov_b32 v45, 0
  v_mov_b32 v46, 0
  v_mov_b32 v47, 0
  v_mov_b32 v48, 0
  v_mov_b32 v49, 0
  v_mov_b32 v50, 0
  v_mov_b32 v51, 0
  s_nop 1
  s_cbranch_vccz cA_sc0_go
  s_add_u32 s30, s30, 1
  s_cmp_lt_u32 s30, 400000
  s_cbranch_scc1 cA_sc0_r0
  s_branch cA_abort
cA_sc0_r1:
  s_add_u32 s31, s31, 1
  buffer_load_dwordx4 v[12:15], v2, s[8:11], s20 offen offset:1024 sc1
  s_waitcnt vmcnt(0)
  v_cmp_eq_u32 vcc, -1, v12
  s_nop 4
  s_cbranch_vccz cA_sc0_c1
  s_add_u32 s30, s30, 1
  s_cmp_lt_u32 s30, 400000
  s_cbranch_scc1 cA_sc0_r1
  s_branch cA_abort
cA_sc0_r2:
  s_add_u32 s31, s31, 1
  buffer_load_dwordx4 v[16:19], v2, s[8:11], s20 offen offset:2048 sc1
  s_waitcnt vmcnt(0)
  v_cmp_eq_u32 vcc, -1, v16
  s_nop 4
  s_cbranch_vccz cA_sc0_c2
  s_add_u32 s30, s30, 1
  s_cmp_lt_u32 s30, 400000
  s_cbranch_scc1 cA_sc0_r2
  s_branch cA_abort
cA_sc0_r3:
  s_add_u32 s31, s31, 1
  buffer_load_dwordx4 v[20:23], v2, s[8:11], s20 offen offset:3072 sc1
  s_waitcnt vmcnt(0)
  v_cmp_eq_u32 vcc, -1, v20
  s_nop 4
  s_cbranch_vccz cA_sc0_c3
  s_add_u32 s30, s30, 1
  s_cmp_lt_u32 s30, 400000
  s_cbranch_scc1 cA_sc0_r3
  s_branch cA_abort
cA_sc0_r4:
  s_add_u32 s31, s31, 1
  buffer_load_dwordx4 v[32:35], v2, s[8:11], s23 offen offset:0 sc1
  buffer_load_dwordx4 v[24:27], v2, s[8:11], s23 offen offset:1024 sc1
  buffer_load_dwordx4 v[28:31], v2, s[8:11], s23 offen offset:2048 sc1
  s_waitcnt vmcnt(0)
  v_max3_u32 v66, v24, v27, v28
  v_max3_u32 v66, v66, v31, v32
  v_max_u32 v66, v66, v35
  v_cmp_eq_u32 vcc, -1, v66
  s_nop 4
  s_cbranch_vccz cA_sc0_c4
  s_add_u32 s30, s30, 1
  s_cmp_lt_u32 s30, 400000
  s_cbranch_scc1 cA_sc0_r4
  s_branch cA_abort
cA_sc0_retry:
  s_cmp_lg_u32 s62, 0
  s_cbranch_scc1 cA_sc0_cont
  s_waitcnt vmcnt(0) lgkmcnt(0)
cA_sc0_rv:
  buffer_load_dwordx4 v[8:11], v2, s[8:11], s20 offen offset:0 sc1
  buffer_load_dwordx4 v[12:15], v2, s[8:11], s20 offen offset:1024 sc1
  buffer_load_dwordx4 v[16:19], v2, s[8:11], s20 offen offset:2048 sc1
  buffer_load_dwordx4 v[20:23], v2, s[8:11], s20 offen offset:3072 sc1
  buffer_load_dwordx4 v[32:35], v2, s[8:11], s23 offen offset:0 sc1
  buffer_load_dwordx4 v[24:27], v2, s[8:11], s23 offen offset:1024 sc1
  buffer_load_dwordx4 v[28:31], v2, s[8:11], s23 offen offset:2048 sc1
  s_waitcnt vmcnt(0)
  v_pk_max_u16 v66, v8, v9
  v_pk_max_u16 v66, v66, v10
  v_pk_max_u16 v66, v66, v11
  v_pk_max_u16 v66, v66, v12
  v_pk_max_u16 v66, v66, v13
  v_pk_max_u16 v66, v66, v14
  v_pk_max_u16 v66, v66, v15
  v_pk_max_u16 v66, v66, v16
  v_pk_max_u16 v66, v66, v17
  v_pk_max_u16 v66, v66, v18
  v_pk_max_u16 v66, v66, v19
  v_pk_max_u16 v66, v66, v20
  v_pk_max_u16 v66, v66, v21
  v_pk_max_u16 v66, v66, v22
  v_pk_max_u16 v66, v66, v23
  v_pk_max_u16 v66, v66, v24
  v_pk_max_u16 v66, v66, v25
  v_pk_max_u16 v66, v66, v26
  v_pk_max_u16 v66, v66, v27
  v_pk_max_u16 v66, v66, v28
  v_pk_max_u16 v66, v66, v29
  v_pk_max_u16 v66, v66, v30
  v_pk_max_u16 v66, v66, v31
  v_pk_max_u16 v66, v66, v32
  v_pk_max_u16 v66, v66, v33
  v_pk_max_u16 v66, v66, v34
  v_pk_max_u16 v66, v66, v35
  v_lshlrev_b32 v67, 16, v66
  v_max_u32 v66, v66, v67
  v_cmp_le_u32 vcc, 0xffff0000, v66
  s_cbranch_vccz cA_sc0_rk
  s_add_u32 s30, s30, 1
  s_cmp_lt_u32 s30, 400000
  s_cbranch_scc1 cA_sc0_rv
  s_branch cA_abort
cA_sc0_rk:
  s_mov_b32 s62, 1
  v_mov_b32 v36, 0
  v_mov_b32 v37, 0
  v_mov_b32 v38, 0
  v_mov_b32 v39, 0
  v_mov_b32 v40, 0
  v_mov_b32 v41, 0
  v_mov_b32 v42, 0
  v_mov_b32 v43, 0
  v_mov_b32 v44, 0
  v_mov_b32 v45, 0
  v_mov_b32 v46, 0
  v_mov_b32 v47, 0
  v_mov_b32 v48, 0
  v_mov_b32 v49, 0
  v_mov_b32 v50, 0
  v_mov_b32 v51, 0
  v_mov_b32 v60, 0
  v_mov_b32 v61, 0
  v_mov_b32 v62, 0
  v_mov_b32 v63, 0
  v_mov_b32 v68, 0
  v_mov_b32 v69, 0
  v_mov_b32 v70, 0
  v_mov_b32 v71, 0
  v_mov_b32 v72, 0
  v_mov_b32 v73, 0
  v_mov_b32 v74, 0
  v_mov_b32 v75, 0
  v_mov_b32 v52, 0
  v_mov_b32 v53, 0
  v_mov_b32 v54, 0
  v_mov_b32 v55, 0
  v_mov_b32 v56, 0
  v_mov_b32 v57, 0
  v_mov_b32 v58, 0
  v_mov_b32 v59, 0
  s_add_u32 s31, s31, 0x100
  s_nop 0
  s_branch cA_sc0_go
.p2align 6
cA_sc1_loop:
  s_mov_b32 s30, 0
  s_mov_b32 s62, 0
  s_setprio 3
  s_barrier
  buffer_load_dwordx4 v[8:11], v2, s[8:11], s20 offen offset:0 sc1
  s_setprio 2
  buffer_load_dwordx4 v[12:15], v2, s[8:11], s20 offen offset:1024 sc1
  s_setprio 1
  buffer_load_dwordx4 v[16:19], v2, s[8:11], s20 offen offset:2048 sc1
  s_setprio 0
  buffer_load_dwordx4 v[20:23], v2, s[8:11], s20 offen offset:3072 sc1
cA_sc1_go:
  s_waitcnt vmcnt(3)
  v_smfmac_f32_16x16x64_bf16 v[36:39], v[8:11], a[0:7], v3
  buffer_load_dwordx4 v[28:31], v2, s[8:11], s23 offen offset:0 sc1
  v_cmp_eq_u32 vcc, -1, v8
  v_smfmac_f32_16x16x64_bf16 v[40:43], v[8:11], a[56:63], v3
  v_smfmac_f32_16x16x64_bf16 v[44:47], v[8:11], a[112:119], v3
  buffer_load_dwordx4 v[24:27], v2, s[8:11], s23 offen offset:1024 sc1
  s_cbranch_vccnz cA_sc1_r0
  v_smfmac_f32_16x16x64_bf16 v[48:51], v[8:11], a[168:175], v3
  v_smfmac_f32_16x16x64_bf16 v[52:55], v[8:11], a[224:231], v3
  s_waitcnt vmcnt(4)
  v_cmp_eq_u32 vcc, -1, v12
  v_smfmac_f32_16x16x64_bf16 v[56:59], v[8:11], v[144:151], v3
  buffer_load_dwordx4 v[32:35], v2, s[8:11], s23 offen offset:2048 sc1
  v_smfmac_f32_16x16x64_bf16 v[60:63], v[8:11], v[200:207], v3
  s_cbranch_vccnz cA_sc1_r1
cA_sc1_c1:
  v_smfmac_f32_16x16x64_bf16 v[36:39], v[12:15], a[8:15], v3
  v_smfmac_f32_16x16x64_bf16 v[40:43], v[12:15], a[64:71], v3
  v_smfmac_f32_16x16x64_bf16 v[44:47], v[12:15], a[120:127], v3
  v_smfmac_f32_16x16x64_bf16 v[48:51], v[12:15], a[176:183], v3
  v_smfmac_f32_16x16x64_bf16 v[52:55], v[12:15], a[232:239], v3
  s_waitcnt vmcnt(4)
  v_cmp_eq_u32 vcc, -1, v16
  v_smfmac_f32_16x16x64_bf16 v[56:59], v[12:15], v[152:159], v3
  buffer_load_dwordx4 v[88:91], v117, s[8:11], s26 offen offset:0 sc1
  v_smfmac_f32_16x16x64_bf16 v[60:63], v[12:15], v[208:215], v3
  s_cbranch_vccnz cA_sc1_r2
cA_sc1_c2:
  v_smfmac_f32_16x16x64_bf16 v[36:39], v[16:19], a[16:23], v3
  v_smfmac_f32_16x16x64_bf16 v[40:43], v[16:19], a[72:79], v3
  v_smfmac_f32_16x16x64_bf16 v[44:47], v[16:19], a[128:135], v3
  buffer_load_dwordx4 v[92:95], v117, s[8:11], s26 offen offset:1024 sc1
  v_smfmac_f32_16x16x64_bf16 v[48:51], v[16:19], a[184:191], v3
  v_smfmac_f32_16x16x64_bf16 v[52:55], v[16:19], a[240:247], v3
  s_waitcnt vmcnt(5)
  v_cmp_eq_u32 vcc, -1, v20
  v_smfmac_f32_16x16x64_bf16 v[56:59], v[16:19], v[160:167], v3
  v_smfmac_f32_16x16x64_bf16 v[60:63], v[16:19], v[216:223], v3
  buffer_load_dwordx4 v[96:99], v2, s[8:11], s24 offen offset:0 sc1
  s_cbranch_vccnz cA_sc1_r3
cA_sc1_c3:
  v_smfmac_f32_16x16x64_bf16 v[36:39], v[20:23], a[24:31], v3
  v_smfmac_f32_16x16x64_bf16 v[40:43], v[20:23], a[80:87], v3
  s_waitcnt vmcnt(3)
  v_max3_u32 v66, v24, v27, v28
  v_smfmac_f32_16x16x64_bf16 v[44:47], v[20:23], a[136:143], v3
  v_max3_u32 v66, v66, v31, v32
  v_smfmac_f32_16x16x64_bf16 v[48:51], v[20:23], a[192:199], v3
  buffer_load_dwordx4 v[100:103], v2, s[8:11], s24 offen offset:1024 sc1
  v_max_u32 v66, v66, v35
  v_smfmac_f32_16x16x64_bf16 v[52:55], v[20:23], a[248:255], v3
  v_cmp_eq_u32 vcc, -1, v66
  v_smfmac_f32_16x16x64_bf16 v[56:59], v[20:23], v[168:175], v3
  v_smfmac_f32_16x16x64_bf16 v[60:63], v[20:23], v[224:231], v3
  s_cbranch_vccnz cA_sc1_r4
cA_sc1_c4:
  v_smfmac_f32_16x16x64_bf16 v[60:63], v[28:31], v[232:239], v3
  buffer_load_dwordx4 v[104:107], v2, s[8:11], s26 offen offset:0 sc1
  v_smfmac_f32_16x16x64_bf16 v[60:63], v[24:27], v[240:247], v3
  v_smfmac_f32_16x16x64_bf16 v[60:63], v[32:35], v[248:255], v3
  v_smfmac_f32_16x16x64_bf16 v[52:55], v[28:31], v[120:127], v3
  v_smfmac_f32_16x16x64_bf16 v[52:55], v[24:27], v[128:135], v3
  buffer_load_dwordx4 v[108:111], v2, s[8:11], s26 offen offset:1024 sc1
  v_smfmac_f32_16x16x64_bf16 v[52:55], v[32:35], v[136:143], v3
  v_cvt_pk_bf16_f32 v63, v62, v63
  v_smfmac_f32_16x16x64_bf16 v[56:59], v[28:31], v[176:183], v3
  v_cvt_pk_bf16_f32 v62, v60, v61
  v_smfmac_f32_16x16x64_bf16 v[56:59], v[24:27], v[184:191], v3
  v_mfma_f32_16x16x32_bf16 v[8:11], v[62:65], v[4:7], 0
  v_cvt_pk_bf16_f32 v55, v54, v55
  v_smfmac_f32_16x16x64_bf16 v[56:59], v[32:35], v[192:199], v3
  v_cvt_pk_bf16_f32 v54, v52, v53
  v_smfmac_f32_16x16x64_bf16 v[36:39], v[28:31], a[32:39], v3
  s_nop 1
  v_cvt_pk_bf16_f32 v78, v8, v9
  v_smfmac_f32_16x16x64_bf16 v[36:39], v[24:27], a[40:47], v3
  v_cvt_pk_bf16_f32 v79, v10, v11
  v_smfmac_f32_16x16x64_bf16 v[36:39], v[32:35], a[48:55], v3
  v_cvt_pk_bf16_f32 v56, v56, v57
  v_smfmac_f32_16x16x64_bf16 v[40:43], v[28:31], a[88:95], v3
  v_cvt_pk_bf16_f32 v57, v58, v59
  v_smfmac_f32_16x16x64_bf16 v[40:43], v[24:27], a[96:103], v3
  v_mfma_f32_16x16x32_bf16 v[16:19], v[54:57], v[4:7], 0
  v_cvt_pk_bf16_f32 v39, v38, v39
  v_smfmac_f32_16x16x64_bf16 v[40:43], v[32:35], a[104:111], v3
  v_cvt_pk_bf16_f32 v38, v36, v37
  v_smfmac_f32_16x16x64_bf16 v[44:47], v[28:31], a[144:151], v3
  s_nop 1
  v_cvt_pk_bf16_f32 v76, v16, v17
  v_smfmac_f32_16x16x64_bf16 v[44:47], v[24:27], a[152:159], v3
  v_cvt_pk_bf16_f32 v77, v18, v19
  v_smfmac_f32_16x16x64_bf16 v[44:47], v[32:35], a[160:167], v3
  v_cvt_pk_bf16_f32 v40, v40, v41
  v_smfmac_f32_16x16x64_bf16 v[48:51], v[28:31], a[200:207], v3
  v_cvt_pk_bf16_f32 v41, v42, v43
  v_smfmac_f32_16x16x64_bf16 v[48:51], v[24:27], a[208:215], v3
  v_smfmac_f32_16x16x64_bf16 v[48:51], v[32:35], a[216:223], v3
  s_waitcnt vmcnt(4)
  v_cvt_pk_bf16_f32 v47, v46, v47
  v_smfmac_f32_16x16x64_bf16 v[68:71], v[76:79], v[80:87], v3
  v_cvt_pk_bf16_f32 v46, v44, v45
  v_mfma_f32_16x16x32_bf16 v[8:11], v[38:41], v[4:7], 0
  s_nop 1
  v_cvt_pk_bf16_f32 v48, v48, v49
  v_cvt_pk_bf16_f32 v49, v50, v51
  s_nop 1
  v_mfma_f32_16x16x32_bf16 v[16:19], v[46:49], v[4:7], 0
  v_smfmac_f32_16x16x64_bf16 v[72:75], v[76:79], v[88:95], v3
  v_cvt_pk_bf16_f32 v20, v8, v9
  v_mfma_f32_16x16x32_bf16 v[52:55], v[30:33], v[76:79], 0
  s_waitcnt vmcnt(0)
  v_cvt_pk_bf16_f32 v21, v10, v11
  v_cvt_pk_bf16_f32 v22, v16, v17
  v_cvt_pk_bf16_f32 v23, v18, v19
  s_nop 1
  v_mfma_f32_16x16x32_bf16 v[52:55], v[12:15], v[20:23], v[52:55]
  v_smfmac_f32_16x16x64_bf16 v[68:71], v[20:23], v[96:103], v3
  v_smfmac_f32_16x16x64_bf16 v[72:75], v[20:23], v[104:111], v3
  s_nop 1
  ds_write_b128 v113, v[52:55]
  s_nop 1
  v_permlane32_swap_b32 v68, v70
  v_permlane32_swap_b32 v69, v71
  v_add_f32 v56, v68, v70
  v_add_f32 v58, v69, v71
  v_permlane32_swap_b32 v72, v74
  v_permlane32_swap_b32 v73, v75
  v_add_f32 v57, v72, v74
  v_add_f32 v59, v73, v75
  ds_write_b128 v2, v[56:59] offset:1024
  v_cmp_u_f32 vcc, v57, v59
  v_mov_b32 v68, 0
  v_mov_b32 v69, 0
  v_mov_b32 v70, 0
  v_mov_b32 v71, 0
  s_cbranch_vccnz cA_sc1_retry
cA_sc1_cont:
  s_add_u32 s24, s24, 28672
  s_add_u32 s26, s26, 28672
  buffer_load_dwordx4 v[80:83], v117, s[8:11], s24 offen offset:0 sc1
  buffer_load_dwordx4 v[84:87], v117, s[8:11], s24 offen offset:1024 sc1
  v_mov_b32 v72, 0
  v_mov_b32 v73, 0
  v_mfma_f32_32x32x16_bf16 v[36:51], v[68:71], v[68:71], 0
  s_waitcnt lgkmcnt(0)
  s_barrier
  ds_read_b64 v[8:9], v114 offset:0
  ds_read_b64 v[10:11], v114 offset:1024
  ds_read_b64 v[12:13], v114 offset:2048
  ds_read_b64 v[14:15], v114 offset:3072
  ds_read2_b32 v[16:17], v115 offset0:0 offset1:64
  ds_read2_b32 v[18:19], v115 offset0:128 offset1:192
  v_mfma_f32_32x32x16_bf16 v[52:67], v[68:71], v[68:71], 0
  s_waitcnt lgkmcnt(0)
  v_pk_add_f32 v[16:17], v[16:17], v[18:19]
  v_pk_add_f32 v[8:9], v[8:9], v[10:11]
  v_pk_add_f32 v[12:13], v[12:13], v[14:15]
  v_add_f32 v20, v16, v17
  v_pk_add_f32 v[8:9], v[8:9], v[12:13]
  v_max_f32 v22, v8, v9
  v_add_f32_dpp v20, v20, v20 row_ror:8 row_mask:0xf bank_mask:0xf
  s_nop 0
  v_max_f32_dpp v22, v22, v22 row_ror:8 row_mask:0xf bank_mask:0xf
  v_max_f32 v22, v22, v20
  s_nop 1
  v_max_f32_dpp v22, v22, v22 quad_perm:[1,0,3,2] row_mask:0xf bank_mask:0xf
  s_nop 1
  v_max_f32_dpp v22, v22, v22 quad_perm:[2,3,0,1] row_mask:0xf bank_mask:0xf
  s_nop 1
  v_max_f32_dpp v22, v22, v22 row_half_mirror row_mask:0xf bank_mask:0xf
  v_pk_add_f32 v[8:9], v[8:9], v[22:23] op_sel_hi:[1,0] neg_lo:[0,1] neg_hi:[0,1]
  v_sub_f32 v20, v20, v22
  v_exp_f32 v8, v8
  v_exp_f32 v9, v9
  v_exp_f32 v20, v20
  buffer_store_dword v112, v116, s[8:11], 0 offen
  v_add_f32 v24, v8, v9
  v_fmac_f32 v24, 0.5, v20
  v_mov_b32_dpp v21, v20 quad_perm:[1,0,3,2] row_mask:0xf bank_mask:0xf
  s_nop 0
  v_add_f32_dpp v24, v24, v24 quad_perm:[1,0,3,2] row_mask:0xf bank_mask:0xf
  s_nop 1
  v_add_f32_dpp v24, v24, v24 quad_perm:[2,3,0,1] row_mask:0xf bank_mask:0xf
  s_nop 1
  v_add_f32_dpp v24, v24, v24 row_half_mirror row_mask:0xf bank_mask:0xf
  s_nop 1
  v_add_f32_dpp v24, v24, v24 row_ror:8 row_mask:0xf bank_mask:0xf
  v_rcp_f32 v24, v24
  s_nop 0
  v_pk_mul_f32 v[8:9], v[8:9], v[24:25] op_sel_hi:[1,0]
  v_pk_mul_f32 v[20:21], v[20:21], v[24:25] op_sel_hi:[1,0]
  v_cvt_pk_bf16_f32 v8, v8, v9
  v_cvt_pk_bf16_f32 v20, v20, v21
  v_min_u32 v8, -2, v8
  buffer_store_dword v8, v1, s[8:11], s20 offen
  v_min_u32 v20, -2, v20
  buffer_store_dword v20, v118, s[8:11], s20 offen
  buffer_store_dword v119, v1, s[8:11], s21 offen
  buffer_store_dword v119, v118, s[8:11], s21 offen
  v_mov_b32 v74, 0
  v_mov_b32 v75, 0
  s_mov_b32 s19, s18
  s_add_u32 s18, s18, 1
  s_mov_b32 s22, s20
  s_mov_b32 s20, s21
  s_mov_b32 s21, s22
  s_add_u32 s23, s20, 4096
  v_mov_b32 v112, s18
  s_cmp_lt_u32 s19, 63
  s_nop 0
  s_cbranch_scc1 cA_sc1_loop
  s_branch cA_done
cA_sc1_r0:
  s_add_u32 s31, s31, 1
  buffer_load_dwordx4 v[8:11], v2, s[8:11], s20 offen offset:0 sc1
  s_waitcnt vmcnt(0)
  v_cmp_eq_u32 vcc, -1, v8
  v_mov_b32 v36, 0
  v_mov_b32 v37, 0
  v_mov_b32 v38, 0
  v_mov_b32 v39, 0
  v_mov_b32 v40, 0
  v_mov_b32 v41, 0
  v_mov_b32 v42, 0
  v_mov_b32 v43, 0
  v_mov_b32 v44, 0
  v_mov_b32 v45, 0
  v_mov_b32 v46, 0
  v_mov_b32 v47, 0
  v_mov_b32 v48, 0
  v_mov_b32 v49, 0
  v_mov_b32 v50, 0
  v_mov_b32 v51, 0
  s_nop 1
  s_cbranch_vccz cA_sc1_go
  s_add_u32 s30, s30, 1
  s_cmp_lt_u32 s30, 400000
  s_cbranch_scc1 cA_sc1_r0
  s_branch cA_abort
cA_sc1_r1:
  s_add_u32 s31, s31, 1
  buffer_load_dwordx4 v[12:15], v2, s[8:11], s20 offen offset:1024 sc1
  s_waitcnt vmcnt(0)
  v_cmp_eq_u32 vcc, -1, v12
  s_nop 4
  s_cbranch_vccz cA_sc1_c1
  s_add_u32 s30, s30, 1
  s_cmp_lt_u32 s30, 400000
  s_cbranch_scc1 cA_sc1_r1
  s_branch cA_abort
cA_sc1_r2:
  s_add_u32 s31, s31, 1
  buffer_load_dwordx4 v[16:19], v2, s[8:11], s20 offen offset:2048 sc1
  s_waitcnt vmcnt(0)
  v_cmp_eq_u32 vcc, -1, v16
  s_nop 4
  s_cbranch_vccz cA_sc1_c2
  s_add_u32 s30, s30, 1
  s_cmp_lt_u32 s30, 400000
  s_cbranch_scc1 cA_sc1_r2
  s_branch cA_abort
cA_sc1_r3:
  s_add_u32 s31, s31, 1
  buffer_load_dwordx4 v[20:23], v2, s[8:11], s20 offen offset:3072 sc1
  s_waitcnt vmcnt(0)
  v_cmp_eq_u32 vcc, -1, v20
  s_nop 4
  s_cbranch_vccz cA_sc1_c3
  s_add_u32 s30, s30, 1
  s_cmp_lt_u32 s30, 400000
  s_cbranch_scc1 cA_sc1_r3
  s_branch cA_abort
cA_sc1_r4:
  s_add_u32 s31, s31, 1
  buffer_load_dwordx4 v[28:31], v2, s[8:11], s23 offen offset:0 sc1
  buffer_load_dwordx4 v[24:27], v2, s[8:11], s23 offen offset:1024 sc1
  buffer_load_dwordx4 v[32:35], v2, s[8:11], s23 offen offset:2048 sc1
  s_waitcnt vmcnt(0)
  v_max3_u32 v66, v24, v27, v28
  v_max3_u32 v66, v66, v31, v32
  v_max_u32 v66, v66, v35
  v_cmp_eq_u32 vcc, -1, v66
  s_nop 4
  s_cbranch_vccz cA_sc1_c4
  s_add_u32 s30, s30, 1
  s_cmp_lt_u32 s30, 400000
  s_cbranch_scc1 cA_sc1_r4
  s_branch cA_abort
cA_sc1_retry:
  s_cmp_lg_u32 s62, 0
  s_cbranch_scc1 cA_sc1_cont
  s_waitcnt vmcnt(0) lgkmcnt(0)
cA_sc1_rv:
  buffer_load_dwordx4 v[8:11], v2, s[8:11], s20 offen offset:0 sc1
  buffer_load_dwordx4 v[12:15], v2, s[8:11], s20 offen offset:1024 sc1
  buffer_load_dwordx4 v[16:19], v2, s[8:11], s20 offen offset:2048 sc1
  buffer_load_dwordx4 v[20:23], v2, s[8:11], s20 offen offset:3072 sc1
  buffer_load_dwordx4 v[28:31], v2, s[8:11], s23 offen offset:0 sc1
  buffer_load_dwordx4 v[24:27], v2, s[8:11], s23 offen offset:1024 sc1
  buffer_load_dwordx4 v[32:35], v2, s[8:11], s23 offen offset:2048 sc1
  s_waitcnt vmcnt(0)
  v_pk_max_u16 v66, v8, v9
  v_pk_max_u16 v66, v66, v10
  v_pk_max_u16 v66, v66, v11
  v_pk_max_u16 v66, v66, v12
  v_pk_max_u16 v66, v66, v13
  v_pk_max_u16 v66, v66, v14
  v_pk_max_u16 v66, v66, v15
  v_pk_max_u16 v66, v66, v16
  v_pk_max_u16 v66, v66, v17
  v_pk_max_u16 v66, v66, v18
  v_pk_max_u16 v66, v66, v19
  v_pk_max_u16 v66, v66, v20
  v_pk_max_u16 v66, v66, v21
  v_pk_max_u16 v66, v66, v22
  v_pk_max_u16 v66, v66, v23
  v_pk_max_u16 v66, v66, v24
  v_pk_max_u16 v66, v66, v25
  v_pk_max_u16 v66, v66, v26
  v_pk_max_u16 v66, v66, v27
  v_pk_max_u16 v66, v66, v28
  v_pk_max_u16 v66, v66, v29
  v_pk_max_u16 v66, v66, v30
  v_pk_max_u16 v66, v66, v31
  v_pk_max_u16 v66, v66, v32
  v_pk_max_u16 v66, v66, v33
  v_pk_max_u16 v66, v66, v34
  v_pk_max_u16 v66, v66, v35
  v_lshlrev_b32 v67, 16, v66
  v_max_u32 v66, v66, v67
  v_cmp_le_u32 vcc, 0xffff0000, v66
  s_cbranch_vccz cA_sc1_rk
  s_add_u32 s30, s30, 1
  s_cmp_lt_u32 s30, 400000
  s_cbranch_scc1 cA_sc1_rv
  s_branch cA_abort
cA_sc1_rk:
  s_mov_b32 s62, 1
  v_mov_b32 v36, 0
  v_mov_b32 v37, 0
  v_mov_b32 v38, 0
  v_mov_b32 v39, 0
  v_mov_b32 v40, 0
  v_mov_b32 v41, 0
  v_mov_b32 v42, 0
  v_mov_b32 v43, 0
  v_mov_b32 v44, 0
  v_mov_b32 v45, 0
  v_mov_b32 v46, 0
  v_mov_b32 v47, 0
  v_mov_b32 v48, 0
  v_mov_b32 v49, 0
  v_mov_b32 v50, 0
  v_mov_b32 v51, 0
  v_mov_b32 v60, 0
  v_mov_b32 v61, 0
  v_mov_b32 v62, 0
  v_mov_b32 v63, 0
  v_mov_b32 v68, 0
  v_mov_b32 v69, 0
  v_mov_b32 v70, 0
  v_mov_b32 v71, 0
  v_mov_b32 v72, 0
  v_mov_b32 v73, 0
  v_mov_b32 v74, 0
  v_mov_b32 v75, 0
  v_mov_b32 v52, 0
  v_mov_b32 v53, 0
  v_mov_b32 v54, 0
  v_mov_b32 v55, 0
  v_mov_b32 v56, 0
  v_mov_b32 v57, 0
  v_mov_b32 v58, 0
  v_mov_b32 v59, 0
  s_add_u32 s31, s31, 0x100
  s_nop 0
  s_branch cA_sc1_go
.p2align 6
cA_sc2_loop:
  s_mov_b32 s30, 0
  s_mov_b32 s62, 0
  s_setprio 3
  s_barrier
  buffer_load_dwordx4 v[8:11], v2, s[8:11], s20 offen offset:0 sc1
  s_setprio 2
  buffer_load_dwordx4 v[12:15], v2, s[8:11], s20 offen offset:1024 sc1
  s_setprio 1
  buffer_load_dwordx4 v[16:19], v2, s[8:11], s20 offen offset:2048 sc1
  s_setprio 0
  buffer_load_dwordx4 v[20:23], v2, s[8:11], s20 offen offset:3072 sc1
cA_sc2_go:
  s_waitcnt vmcnt(3)
  v_smfmac_f32_16x16x64_bf16 v[36:39], v[8:11], a[0:7], v3
  buffer_load_dwordx4 v[24:27], v2, s[8:11], s23 offen offset:0 sc1
  v_cmp_eq_u32 vcc, -1, v8
  v_smfmac_f32_16x16x64_bf16 v[40:43], v[8:11], a[56:63], v3
  v_smfmac_f32_16x16x64_bf16 v[44:47], v[8:11], a[112:119], v3
  buffer_load_dwordx4 v[32:35], v2, s[8:11], s23 offen offset:1024 sc1
  s_cbranch_vccnz cA_sc2_r0
  v_smfmac_f32_16x16x64_bf16 v[48:51], v[8:11], a[168:175], v3
  v_smfmac_f32_16x16x64_bf16 v[52:55], v[8:11], a[224:231], v3
  s_waitcnt vmcnt(4)
  v_cmp_eq_u32 vcc, -1, v12
  v_smfmac_f32_16x16x64_bf16 v[56:59], v[8:11], v[144:151], v3
  buffer_load_dwordx4 v[28:31], v2, s[8:11], s23 offen offset:2048 sc1
  v_smfmac_f32_16x16x64_bf16 v[62:65], v[8:11], v[200:207], v3
  s_cbranch_vccnz cA_sc2_r1
cA_sc2_c1:
  v_smfmac_f32_16x16x64_bf16 v[36:39], v[12:15], a[8:15], v3
  v_smfmac_f32_16x16x64_bf16 v[40:43], v[12:15], a[64:71], v3
  v_smfmac_f32_16x16x64_bf16 v[44:47], v[12:15], a[120:127], v3
  v_smfmac_f32_16x16x64_bf16 v[48:51], v[12:15], a[176:183], v3
  v_smfmac_f32_16x16x64_bf16 v[52:55], v[12:15], a[232:239], v3
  s_waitcnt vmcnt(4)
  v_cmp_eq_u32 vcc, -1, v16
  v_smfmac_f32_16x16x64_bf16 v[56:59], v[12:15], v[152:159], v3
  buffer_load_dwordx4 v[88:91], v117, s[8:11], s26 offen offset:0 sc1
  v_smfmac_f32_16x16x64_bf16 v[62:65], v[12:15], v[208:215], v3
  s_cbranch_vccnz cA_sc2_r2
cA_sc2_c2:
  v_smfmac_f32_16x16x64_bf16 v[36:39], v[16:19], a[16:23], v3
  v_smfmac_f32_16x16x64_bf16 v[40:43], v[16:19], a[72:79], v3
  v_smfmac_f32_16x16x64_bf16 v[44:47], v[16:19], a[128:135], v3
  buffer_load_dwordx4 v[92:95], v117, s[8:11], s26 offen offset:1024 sc1
  v_smfmac_f32_16x16x64_bf16 v[48:51], v[16:19], a[184:191], v3
  v_smfmac_f32_16x16x64_bf16 v[52:55], v[16:19], a[240:247], v3
  s_waitcnt vmcnt(5)
  v_cmp_eq_u32 vcc, -1, v20
  v_smfmac_f32_16x16x64_bf16 v[56:59], v[16:19], v[160:167], v3
  v_smfmac_f32_16x16x64_bf16 v[62:65], v[16:19], v[216:223], v3
  buffer_load_dwordx4 v[96:99], v2, s[8:11], s24 offen offset:0 sc1
  s_cbranch_vccnz cA_sc2_r3
cA_sc2_c3:
  v_smfmac_f32_16x16x64_bf16 v[36:39], v[20:23], a[24:31], v3
  v_smfmac_f32_16x16x64_bf16 v[40:43], v[20:23], a[80:87], v3
  s_waitcnt vmcnt(3)
  v_max3_u32 v66, v24, v27, v28
  v_smfmac_f32_16x16x64_bf16 v[44:47], v[20:23], a[136:143], v3
  v_max3_u32 v66, v66, v31, v32
  v_smfmac_f32_16x16x64_bf16 v[48:51], v[20:23], a[192:199], v3
  buffer_load_dwordx4 v[100:103], v2, s[8:11], s24 offen offset:1024 sc1
  v_max_u32 v66, v66, v35
  v_smfmac_f32_16x16x64_bf16 v[52:55], v[20:23], a[248:255], v3
  v_cmp_eq_u32 vcc, -1, v66
  v_smfmac_f32_16x16x64_bf16 v[56:59], v[20:23], v[168:175], v3
  v_smfmac_f32_16x16x64_bf16 v[62:65], v[20:23], v[224:231], v3
  s_cbranch_vccnz cA_sc2_r4
cA_sc2_c4:
  v_smfmac_f32_16x16x64_bf16 v[62:65], v[24:27], v[232:239], v3
  buffer_load_dwordx4 v[104:107], v2, s[8:11], s26 offen offset:0 sc1
  v_smfmac_f32_16x16x64_bf16 v[62:65], v[32:35], v[240:247], v3
  v_smfmac_f32_16x16x64_bf16 v[62:65], v[28:31], v[248:255], v3
  v_smfmac_f32_16x16x64_bf16 v[52:55], v[24:27], v[120:127], v3
  v_smfmac_f32_16x16x64_bf16 v[52:55], v[32:35], v[128:135], v3
  buffer_load_dwordx4 v[108:111], v2, s[8:11], s26 offen offset:1024 sc1
  v_smfmac_f32_16x16x64_bf16 v[52:55], v[28:31], v[136:143], v3
  v_cvt_pk_bf16_f32 v62, v62, v63
  v_smfmac_f32_16x16x64_bf16 v[56:59], v[24:27], v[176:183], v3
  v_cvt_pk_bf16_f32 v63, v64, v65
  v_smfmac_f32_16x16x64_bf16 v[56:59], v[32:35], v[184:191], v3
  v_mfma_f32_16x16x32_bf16 v[8:11], v[60:63], v[4:7], 0
  v_cvt_pk_bf16_f32 v55, v54, v55
  v_smfmac_f32_16x16x64_bf16 v[56:59], v[28:31], v[192:199], v3
  v_cvt_pk_bf16_f32 v54, v52, v53
  v_smfmac_f32_16x16x64_bf16 v[36:39], v[24:27], a[32:39], v3
  s_nop 1
  v_cvt_pk_bf16_f32 v76, v8, v9
  v_smfmac_f32_16x16x64_bf16 v[36:39], v[32:35], a[40:47], v3
  v_cvt_pk_bf16_f32 v77, v10, v11
  v_smfmac_f32_16x16x64_bf16 v[36:39], v[28:31], a[48:55], v3
  v_cvt_pk_bf16_f32 v56, v56, v57
  v_smfmac_f32_16x16x64_bf16 v[40:43], v[24:27], a[88:95], v3
  v_cvt_pk_bf16_f32 v57, v58, v59
  v_smfmac_f32_16x16x64_bf16 v[40:43], v[32:35], a[96:103], v3
  v_mfma_f32_16x16x32_bf16 v[12:15], v[54:57], v[4:7], 0
  v_cvt_pk_bf16_f32 v39, v38, v39
  v_smfmac_f32_16x16x64_bf16 v[40:43], v[28:31], a[104:111], v3
  v_cvt_pk_bf16_f32 v38, v36, v37
  v_smfmac_f32_16x16x64_bf16 v[44:47], v[24:27], a[144:151], v3
  s_nop 1
  v_cvt_pk_bf16_f32 v78, v12, v13
  v_smfmac_f32_16x16x64_bf16 v[44:47], v[32:35], a[152:159], v3
  v_cvt_pk_bf16_f32 v79, v14, v15
  v_smfmac_f32_16x16x64_bf16 v[44:47], v[28:31], a[160:167], v3
  v_cvt_pk_bf16_f32 v40, v40, v41
  v_smfmac_f32_16x16x64_bf16 v[48:51], v[24:27], a[200:207], v3
  v_cvt_pk_bf16_f32 v41, v42, v43
  v_smfmac_f32_16x16x64_bf16 v[48:51], v[32:35], a[208:215], v3
  v_smfmac_f32_16x16x64_bf16 v[48:51], v[28:31], a[216:223], v3
  s_waitcnt vmcnt(4)
  v_cvt_pk_bf16_f32 v47, v46, v47
  v_smfmac_f32_16x16x64_bf16 v[68:71], v[76:79], v[80:87], v3
  v_cvt_pk_bf16_f32 v46, v44, v45
  v_mfma_f32_16x16x32_bf16 v[8:11], v[38:41], v[4:7], 0
  s_nop 1
  v_cvt_pk_bf16_f32 v48, v48, v49
  v_cvt_pk_bf16_f32 v49, v50, v51
  s_nop 1
  v_mfma_f32_16x16x32_bf16 v[12:15], v[46:49], v[4:7], 0
  v_smfmac_f32_16x16x64_bf16 v[72:75], v[76:79], v[88:95], v3
  v_cvt_pk_bf16_f32 v20, v8, v9
  v_mfma_f32_16x16x32_bf16 v[52:55], v[30:33], v[76:79], 0
  s_waitcnt vmcnt(0)
  v_cvt_pk_bf16_f32 v21, v10, v11
  v_cvt_pk_bf16_f32 v22, v12, v13
  v_cvt_pk_bf16_f32 v23, v14, v15
  s_nop 1
  v_mfma_f32_16x16x32_bf16 v[52:55], v[16:19], v[20:23], v[52:55]
  v_smfmac_f32_16x16x64_bf16 v[68:71], v[20:23], v[96:103], v3
  v_smfmac_f32_16x16x64_bf16 v[72:75], v[20:23], v[104:111], v3
  s_nop 1
  ds_write_b128 v113, v[52:55]
  s_nop 1
  v_permlane32_swap_b32 v68, v70
  v_permlane32_swap_b32 v69, v71
  v_add_f32 v56, v68, v70
  v_add_f32 v58, v69, v71
  v_permlane32_swap_b32 v72, v74
  v_permlane32_swap_b32 v73, v75
  v_add_f32 v57, v72, v74
  v_add_f32 v59, v73, v75
  ds_write_b128 v2, v[56:59] offset:2048
  v_cmp_u_f32 vcc, v57, v59
  v_mov_b32 v68, 0
  v_mov_b32 v69, 0
  v_mov_b32 v70, 0
  v_mov_b32 v71, 0
  s_cbranch_vccnz cA_sc2_retry
cA_sc2_cont:
  s_add_u32 s24, s24, 28672
  s_add_u32 s26, s26, 28672
  buffer_load_dwordx4 v[80:83], v117, s[8:11], s24 offen offset:0 sc1
  buffer_load_dwordx4 v[84:87], v117, s[8:11], s24 offen offset:1024 sc1
  v_mov_b32 v72, 0
  v_mov_b32 v73, 0
  v_mfma_f32_32x32x16_bf16 v[36:51], v[68:71], v[68:71], 0
  s_waitcnt lgkmcnt(0)
  s_barrier
  v_mfma_f32_32x32x16_bf16 v[52:67], v[68:71], v[68:71], 0
  s_buffer_load_dword s70, s[8:11], s35
  s_add_u32 s22, s24, 114688
  s_buffer_load_dword s71, s[8:11], s22
  s_mul_i32 s22, s18, 7168
  s_add_u32 s22, s22, 88024064
  s_buffer_load_dword s72, s[8:11], s22
  s_add_u32 s35, s35, 458752
  v_mov_b32 v74, 0
  v_mov_b32 v75, 0
  s_mov_b32 s19, s18
  s_add_u32 s18, s18, 1
  s_mov_b32 s22, s20
  s_mov_b32 s20, s21
  s_mov_b32 s21, s22
  s_add_u32 s23, s20, 4096
  s_cmp_lt_u32 s19, 63
  s_cbranch_scc1 cA_sc2_loop
  s_branch cA_done
cA_sc2_r0:
  s_add_u32 s31, s31, 1
  buffer_load_dwordx4 v[8:11], v2, s[8:11], s20 offen offset:0 sc1
  s_waitcnt vmcnt(0)
  v_cmp_eq_u32 vcc, -1, v8
  v_mov_b32 v36, 0
  v_mov_b32 v37, 0
  v_mov_b32 v38, 0
  v_mov_b32 v39, 0
  v_mov_b32 v40, 0
  v_mov_b32 v41, 0
  v_mov_b32 v42, 0
  v_mov_b32 v43, 0
  v_mov_b32 v44, 0
  v_mov_b32 v45, 0
  v_mov_b32 v46, 0
  v_mov_b32 v47, 0
  v_mov_b32 v48, 0
  v_mov_b32 v49, 0
  v_mov_b32 v50, 0
  v_mov_b32 v51, 0
  s_nop 1
  s_cbranch_vccz cA_sc2_go
  s_add_u32 s30, s30, 1
  s_cmp_lt_u32 s30, 400000
  s_cbranch_scc1 cA_sc2_r0
  s_branch cA_abort
cA_sc2_r1:
  s_add_u32 s31, s31, 1
  buffer_load_dwordx4 v[12:15], v2, s[8:11], s20 offen offset:1024 sc1
  s_waitcnt vmcnt(0)
  v_cmp_eq_u32 vcc, -1, v12
  s_nop 4
  s_cbranch_vccz cA_sc2_c1
  s_add_u32 s30, s30, 1
  s_cmp_lt_u32 s30, 400000
  s_cbranch_scc1 cA_sc2_r1
  s_branch cA_abort
cA_sc2_r2:
  s_add_u32 s31, s31, 1
  buffer_load_dwordx4 v[16:19], v2, s[8:11], s20 offen offset:2048 sc1
  s_waitcnt vmcnt(0)
  v_cmp_eq_u32 vcc, -1, v16
  s_nop 4
  s_cbranch_vccz cA_sc2_c2
  s_add_u32 s30, s30, 1
  s_cmp_lt_u32 s30, 400000
  s_cbranch_scc1 cA_sc2_r2
  s_branch cA_abort
cA_sc2_r3:
  s_add_u32 s31, s31, 1
  buffer_load_dwordx4 v[20:23], v2, s[8:11], s20 offen offset:3072 sc1
  s_waitcnt vmcnt(0)
  v_cmp_eq_u32 vcc, -1, v20
  s_nop 4
  s_cbranch_vccz cA_sc2_c3
  s_add_u32 s30, s30, 1
  s_cmp_lt_u32 s30, 400000
  s_cbranch_scc1 cA_sc2_r3
  s_branch cA_abort
cA_sc2_r4:
  s_add_u32 s31, s31, 1
  buffer_load_dwordx4 v[24:27], v2, s[8:11], s23 offen offset:0 sc1
  buffer_load_dwordx4 v[32:35], v2, s[8:11], s23 offen offset:1024 sc1
  buffer_load_dwordx4 v[28:31], v2, s[8:11], s23 offen offset:2048 sc1
  s_waitcnt vmcnt(0)
  v_max3_u32 v66, v24, v27, v28
  v_max3_u32 v66, v66, v31, v32
  v_max_u32 v66, v66, v35
  v_cmp_eq_u32 vcc, -1, v66
  s_nop 4
  s_cbranch_vccz cA_sc2_c4
  s_add_u32 s30, s30, 1
  s_cmp_lt_u32 s30, 400000
  s_cbranch_scc1 cA_sc2_r4
  s_branch cA_abort
cA_sc2_retry:
  s_cmp_lg_u32 s62, 0
  s_cbranch_scc1 cA_sc2_cont
  s_waitcnt vmcnt(0) lgkmcnt(0)
cA_sc2_rv:
  buffer_load_dwordx4 v[8:11], v2, s[8:11], s20 offen offset:0 sc1
  buffer_load_dwordx4 v[12:15], v2, s[8:11], s20 offen offset:1024 sc1
  buffer_load_dwordx4 v[16:19], v2, s[8:11], s20 offen offset:2048 sc1
  buffer_load_dwordx4 v[20:23], v2, s[8:11], s20 offen offset:3072 sc1
  buffer_load_dwordx4 v[24:27], v2, s[8:11], s23 offen offset:0 sc1
  buffer_load_dwordx4 v[32:35], v2, s[8:11], s23 offen offset:1024 sc1
  buffer_load_dwordx4 v[28:31], v2, s[8:11], s23 offen offset:2048 sc1
  s_waitcnt vmcnt(0)
  v_pk_max_u16 v66, v8, v9
  v_pk_max_u16 v66, v66, v10
  v_pk_max_u16 v66, v66, v11
  v_pk_max_u16 v66, v66, v12
  v_pk_max_u16 v66, v66, v13
  v_pk_max_u16 v66, v66, v14
  v_pk_max_u16 v66, v66, v15
  v_pk_max_u16 v66, v66, v16
  v_pk_max_u16 v66, v66, v17
  v_pk_max_u16 v66, v66, v18
  v_pk_max_u16 v66, v66, v19
  v_pk_max_u16 v66, v66, v20
  v_pk_max_u16 v66, v66, v21
  v_pk_max_u16 v66, v66, v22
  v_pk_max_u16 v66, v66, v23
  v_pk_max_u16 v66, v66, v24
  v_pk_max_u16 v66, v66, v25
  v_pk_max_u16 v66, v66, v26
  v_pk_max_u16 v66, v66, v27
  v_pk_max_u16 v66, v66, v28
  v_pk_max_u16 v66, v66, v29
  v_pk_max_u16 v66, v66, v30
  v_pk_max_u16 v66, v66, v31
  v_pk_max_u16 v66, v66, v32
  v_pk_max_u16 v66, v66, v33
  v_pk_max_u16 v66, v66, v34
  v_pk_max_u16 v66, v66, v35
  v_lshlrev_b32 v67, 16, v66
  v_max_u32 v66, v66, v67
  v_cmp_le_u32 vcc, 0xffff0000, v66
  s_cbranch_vccz cA_sc2_rk
  s_add_u32 s30, s30, 1
  s_cmp_lt_u32 s30, 400000
  s_cbranch_scc1 cA_sc2_rv
  s_branch cA_abort
cA_sc2_rk:
  s_mov_b32 s62, 1
  v_mov_b32 v36, 0
  v_mov_b32 v37, 0
  v_mov_b32 v38, 0
  v_mov_b32 v39, 0
  v_mov_b32 v40, 0
  v_mov_b32 v41, 0
  v_mov_b32 v42, 0
  v_mov_b32 v43, 0
  v_mov_b32 v44, 0
  v_mov_b32 v45, 0
  v_mov_b32 v46, 0
  v_mov_b32 v47, 0
  v_mov_b32 v48, 0
  v_mov_b32 v49, 0
  v_mov_b32 v50, 0
  v_mov_b32 v51, 0
  v_mov_b32 v62, 0
  v_mov_b32 v63, 0
  v_mov_b32 v64, 0
  v_mov_b32 v65, 0
  v_mov_b32 v68, 0
  v_mov_b32 v69, 0
  v_mov_b32 v70, 0
  v_mov_b32 v71, 0
  v_mov_b32 v72, 0
  v_mov_b32 v73, 0
  v_mov_b32 v74, 0
  v_mov_b32 v75, 0
  v_mov_b32 v52, 0
  v_mov_b32 v53, 0
  v_mov_b32 v54, 0
  v_mov_b32 v55, 0
  v_mov_b32 v56, 0
  v_mov_b32 v57, 0
  v_mov_b32 v58, 0
  v_mov_b32 v59, 0
  s_add_u32 s31, s31, 0x100
  s_nop 0
  s_branch cA_sc2_go
.p2align 6
cA_sc3_loop:
  s_mov_b32 s30, 0
  s_mov_b32 s62, 0
  s_setprio 3
  s_barrier
  buffer_load_dwordx4 v[8:11], v2, s[8:11], s20 offen offset:0 sc1
  s_setprio 2
  buffer_load_dwordx4 v[12:15], v2, s[8:11], s20 offen offset:1024 sc1
  s_setprio 1
  buffer_load_dwordx4 v[16:19], v2, s[8:11], s20 offen offset:2048 sc1
  s_setprio 0
  buffer_load_dwordx4 v[20:23], v2, s[8:11], s20 offen offset:3072 sc1
cA_sc3_go:
  s_waitcnt vmcnt(3)
  v_smfmac_f32_16x16x64_bf16 v[36:39], v[8:11], a[0:7], v3
  buffer_load_dwordx4 v[24:27], v2, s[8:11], s23 offen offset:0 sc1
  v_cmp_eq_u32 vcc, -1, v8
  v_smfmac_f32_16x16x64_bf16 v[40:43], v[8:11], a[56:63], v3
  v_smfmac_f32_16x16x64_bf16 v[44:47], v[8:11], a[112:119], v3
  buffer_load_dwordx4 v[28:31], v2, s[8:11], s23 offen offset:1024 sc1
  s_cbranch_vccnz cA_sc3_r0
  v_smfmac_f32_16x16x64_bf16 v[48:51], v[8:11], a[168:175], v3
  v_smfmac_f32_16x16x64_bf16 v[52:55], v[8:11], a[224:231], v3
  s_waitcnt vmcnt(4)
  v_cmp_eq_u32 vcc, -1, v12
  v_smfmac_f32_16x16x64_bf16 v[56:59], v[8:11], v[144:151], v3
  buffer_load_dwordx4 v[32:35], v2, s[8:11], s23 offen offset:2048 sc1
  v_smfmac_f32_16x16x64_bf16 v[62:65], v[8:11], v[200:207], v3
  s_cbranch_vccnz cA_sc3_r1
cA_sc3_c1:
  v_smfmac_f32_16x16x64_bf16 v[36:39], v[12:15], a[8:15], v3
  v_smfmac_f32_16x16x64_bf16 v[40:43], v[12:15], a[64:71], v3
  v_smfmac_f32_16x16x64_bf16 v[44:47], v[12:15], a[120:127], v3
  v_smfmac_f32_16x16x64_bf16 v[48:51], v[12:15], a[176:183], v3
  v_smfmac_f32_16x16x64_bf16 v[52:55], v[12:15], a[232:239], v3
  s_waitcnt vmcnt(4)
  v_cmp_eq_u32 vcc, -1, v16
  v_smfmac_f32_16x16x64_bf16 v[56:59], v[12:15], v[152:159], v3
  buffer_load_dwordx4 v[88:91], v117, s[8:11], s26 offen offset:0 sc1
  v_smfmac_f32_16x16x64_bf16 v[62:65], v[12:15], v[208:215], v3
  s_cbranch_vccnz cA_sc3_r2
cA_sc3_c2:
  v_smfmac_f32_16x16x64_bf16 v[36:39], v[16:19], a[16:23], v3
  v_smfmac_f32_16x16x64_bf16 v[40:43], v[16:19], a[72:79], v3
  v_smfmac_f32_16x16x64_bf16 v[44:47], v[16:19], a[128:135], v3
  buffer_load_dwordx4 v[92:95], v117, s[8:11], s26 offen offset:1024 sc1
  v_smfmac_f32_16x16x64_bf16 v[48:51], v[16:19], a[184:191], v3
  v_smfmac_f32_16x16x64_bf16 v[52:55], v[16:19], a[240:247], v3
  s_waitcnt vmcnt(5)
  v_cmp_eq_u32 vcc, -1, v20
  v_smfmac_f32_16x16x64_bf16 v[56:59], v[16:19], v[160:167], v3
  v_smfmac_f32_16x16x64_bf16 v[62:65], v[16:19], v[216:223], v3
  buffer_load_dwordx4 v[96:99], v2, s[8:11], s24 offen offset:0 sc1
  s_cbranch_vccnz cA_sc3_r3
cA_sc3_c3:
  v_smfmac_f32_16x16x64_bf16 v[36:39], v[20:23], a[24:31], v3
  v_smfmac_f32_16x16x64_bf16 v[40:43], v[20:23], a[80:87], v3
  s_waitcnt vmcnt(3)
  v_max3_u32 v66, v24, v27, v28
  v_smfmac_f32_16x16x64_bf16 v[44:47], v[20:23], a[136:143], v3
  v_max3_u32 v66, v66, v31, v32
  v_smfmac_f32_16x16x64_bf16 v[48:51], v[20:23], a[192:199], v3
  buffer_load_dwordx4 v[100:103], v2, s[8:11], s24 offen offset:1024 sc1
  v_max_u32 v66, v66, v35
  v_smfmac_f32_16x16x64_bf16 v[52:55], v[20:23], a[248:255], v3
  v_cmp_eq_u32 vcc, -1, v66
  v_smfmac_f32_16x16x64_bf16 v[56:59], v[20:23], v[168:175], v3
  v_smfmac_f32_16x16x64_bf16 v[62:65], v[20:23], v[224:231], v3
  s_cbranch_vccnz cA_sc3_r4
cA_sc3_c4:
  v_smfmac_f32_16x16x64_bf16 v[62:65], v[24:27], v[232:239], v3
  buffer_load_dwordx4 v[104:107], v2, s[8:11], s26 offen offset:0 sc1
  v_smfmac_f32_16x16x64_bf16 v[62:65], v[28:31], v[240:247], v3
  v_smfmac_f32_16x16x64_bf16 v[62:65], v[32:35], v[248:255], v3
  v_smfmac_f32_16x16x64_bf16 v[52:55], v[24:27], v[120:127], v3
  v_smfmac_f32_16x16x64_bf16 v[52:55], v[28:31], v[128:135], v3
  buffer_load_dwordx4 v[108:111], v2, s[8:11], s26 offen offset:1024 sc1
  v_smfmac_f32_16x16x64_bf16 v[52:55], v[32:35], v[136:143], v3
  v_cvt_pk_bf16_f32 v62, v62, v63
  v_smfmac_f32_16x16x64_bf16 v[56:59], v[24:27], v[176:183], v3
  v_cvt_pk_bf16_f32 v63, v64, v65
  v_smfmac_f32_16x16x64_bf16 v[56:59], v[28:31], v[184:191], v3
  v_mfma_f32_16x16x32_bf16 v[8:11], v[60:63], v[4:7], 0
  v_cvt_pk_bf16_f32 v55, v54, v55
  v_smfmac_f32_16x16x64_bf16 v[56:59], v[32:35], v[192:199], v3
  v_cvt_pk_bf16_f32 v54, v52, v53
  v_smfmac_f32_16x16x64_bf16 v[36:39], v[24:27], a[32:39], v3
  s_nop 1
  v_cvt_pk_bf16_f32 v78, v8, v9
  v_smfmac_f32_16x16x64_bf16 v[36:39], v[28:31], a[40:47], v3
  v_cvt_pk_bf16_f32 v79, v10, v11
  v_smfmac_f32_16x16x64_bf16 v[36:39], v[32:35], a[48:55], v3
  v_cvt_pk_bf16_f32 v56, v56, v57
  v_smfmac_f32_16x16x64_bf16 v[40:43], v[24:27], a[88:95], v3
  v_cvt_pk_bf16_f32 v57, v58, v59
  v_smfmac_f32_16x16x64_bf16 v[40:43], v[28:31], a[96:103], v3
  v_mfma_f32_16x16x32_bf16 v[12:15], v[54:57], v[4:7], 0
  v_cvt_pk_bf16_f32 v39, v38, v39
  v_smfmac_f32_16x16x64_bf16 v[40:43], v[32:35], a[104:111], v3
  v_cvt_pk_bf16_f32 v38, v36, v37
  v_smfmac_f32_16x16x64_bf16 v[44:47], v[24:27], a[144:151], v3
  s_nop 1
  v_cvt_pk_bf16_f32 v76, v12, v13
  v_smfmac_f32_16x16x64_bf16 v[44:47], v[28:31], a[152:159], v3
  v_cvt_pk_bf16_f32 v77, v14, v15
  v_smfmac_f32_16x16x64_bf16 v[44:47], v[32:35], a[160:167], v3
  v_cvt_pk_bf16_f32 v40, v40, v41
  v_smfmac_f32_16x16x64_bf16 v[48:51], v[24:27], a[200:207], v3
  v_cvt_pk_bf16_f32 v41, v42, v43
  v_smfmac_f32_16x16x64_bf16 v[48:51], v[28:31], a[208:215], v3
  v_smfmac_f32_16x16x64_bf16 v[48:51], v[32:35], a[216:223], v3
  s_waitcnt vmcnt(4)
  v_cvt_pk_bf16_f32 v47, v46, v47
  v_smfmac_f32_16x16x64_bf16 v[68:71], v[76:79], v[80:87], v3
  v_cvt_pk_bf16_f32 v46, v44, v45
  v_mfma_f32_16x16x32_bf16 v[8:11], v[38:41], v[4:7], 0
  s_nop 1
  v_cvt_pk_bf16_f32 v48, v48, v49
  v_cvt_pk_bf16_f32 v49, v50, v51
  s_nop 1
  v_mfma_f32_16x16x32_bf16 v[12:15], v[46:49], v[4:7], 0
  v_smfmac_f32_16x16x64_bf16 v[72:75], v[76:79], v[88:95], v3
  v_cvt_pk_bf16_f32 v16, v8, v9
  v_mfma_f32_16x16x32_bf16 v[52:55], v[30:33], v[76:79], 0
  s_waitcnt vmcnt(0)
  v_cvt_pk_bf16_f32 v17, v10, v11
  v_cvt_pk_bf16_f32 v18, v12, v13
  v_cvt_pk_bf16_f32 v19, v14, v15
  s_nop 1
  v_mfma_f32_16x16x32_bf16 v[52:55], v[20:23], v[16:19], v[52:55]
  v_smfmac_f32_16x16x64_bf16 v[68:71], v[16:19], v[96:103], v3
  v_smfmac_f32_16x16x64_bf16 v[72:75], v[16:19], v[104:111], v3
  s_nop 1
  ds_write_b128 v113, v[52:55]
  s_nop 1
  v_permlane32_swap_b32 v68, v70
  v_permlane32_swap_b32 v69, v71
  v_add_f32 v56, v68, v70
  v_add_f32 v58, v69, v71
  v_permlane32_swap_b32 v72, v74
  v_permlane32_swap_b32 v73, v75
  v_add_f32 v57, v72, v74
  v_add_f32 v59, v73, v75
  ds_write_b128 v2, v[56:59] offset:3072
  v_cmp_u_f32 vcc, v57, v59
  v_mov_b32 v68, 0
  v_mov_b32 v69, 0
  v_mov_b32 v70, 0
  v_mov_b32 v71, 0
  s_cbranch_vccnz cA_sc3_retry
cA_sc3_cont:
  s_add_u32 s24, s24, 28672
  s_add_u32 s26, s26, 28672
  buffer_load_dwordx4 v[80:83], v117, s[8:11], s24 offen offset:0 sc1
  buffer_load_dwordx4 v[84:87], v117, s[8:11], s24 offen offset:1024 sc1
  v_mov_b32 v72, 0
  v_mov_b32 v73, 0
  v_mfma_f32_16x16x32_bf16 v[62:65], v[68:71], v[68:71], 0
  s_waitcnt lgkmcnt(0)
  s_barrier
  v_mov_b32 v52, 0
  v_mov_b32 v53, 0
  v_mov_b32 v54, 0
  v_mov_b32 v55, 0
  v_mov_b32 v56, 0
  v_mov_b32 v57, 0
  v_mov_b32 v58, 0
  v_mov_b32 v59, 0
  v_mfma_f32_32x32x16_bf16 v[36:51], v[68:71], v[68:71], 0
  v_mov_b32 v74, 0
  v_mov_b32 v75, 0
  s_mov_b32 s19, s18
  s_add_u32 s18, s18, 1
  s_mov_b32 s22, s20
  s_mov_b32 s20, s21
  s_mov_b32 s21, s22
  s_add_u32 s23, s20, 4096
  s_cmp_lt_u32 s19, 63
  s_nop 2
  s_cbranch_scc1 cA_sc3_loop
  s_branch cA_done
cA_sc3_r0:
  s_add_u32 s31, s31, 1
  buffer_load_dwordx4 v[8:11], v2, s[8:11], s20 offen offset:0 sc1
  s_waitcnt vmcnt(0)
  v_cmp_eq_u32 vcc, -1, v8
  v_mov_b32 v36, 0
  v_mov_b32 v37, 0
  v_mov_b32 v38, 0
  v_mov_b32 v39, 0
  v_mov_b32 v40, 0
  v_mov_b32 v41, 0
  v_mov_b32 v42, 0
  v_mov_b32 v43, 0
  v_mov_b32 v44, 0
  v_mov_b32 v45, 0
  v_mov_b32 v46, 0
  v_mov_b32 v47, 0
  v_mov_b32 v48, 0
  v_mov_b32 v49, 0
  v_mov_b32 v50, 0
  v_mov_b32 v51, 0
  s_nop 1
  s_cbranch_vccz cA_sc3_go
  s_add_u32 s30, s30, 1
  s_cmp_lt_u32 s30, 400000
  s_cbranch_scc1 cA_sc3_r0
  s_branch cA_abort
cA_sc3_r1:
  s_add_u32 s31, s31, 1
  buffer_load_dwordx4 v[12:15], v2, s[8:11], s20 offen offset:1024 sc1
  s_waitcnt vmcnt(0)
  v_cmp_eq_u32 vcc, -1, v12
  s_nop 4
  s_cbranch_vccz cA_sc3_c1
  s_add_u32 s30, s30, 1
  s_cmp_lt_u32 s30, 400000
  s_cbranch_scc1 cA_sc3_r1
  s_branch cA_abort
cA_sc3_r2:
  s_add_u32 s31, s31, 1
  buffer_load_dwordx4 v[16:19], v2, s[8:11], s20 offen offset:2048 sc1
  s_waitcnt vmcnt(0)
  v_cmp_eq_u32 vcc, -1, v16
  s_nop 4
  s_cbranch_vccz cA_sc3_c2
  s_add_u32 s30, s30, 1
  s_cmp_lt_u32 s30, 400000
  s_cbranch_scc1 cA_sc3_r2
  s_branch cA_abort
cA_sc3_r3:
  s_add_u32 s31, s31, 1
  buffer_load_dwordx4 v[20:23], v2, s[8:11], s20 offen offset:3072 sc1
  s_waitcnt vmcnt(0)
  v_cmp_eq_u32 vcc, -1, v20
  s_nop 4
  s_cbranch_vccz cA_sc3_c3
  s_add_u32 s30, s30, 1
  s_cmp_lt_u32 s30, 400000
  s_cbranch_scc1 cA_sc3_r3
  s_branch cA_abort
cA_sc3_r4:
  s_add_u32 s31, s31, 1
  buffer_load_dwordx4 v[24:27], v2, s[8:11], s23 offen offset:0 sc1
  buffer_load_dwordx4 v[28:31], v2, s[8:11], s23 offen offset:1024 sc1
  buffer_load_dwordx4 v[32:35], v2, s[8:11], s23 offen offset:2048 sc1
  s_waitcnt vmcnt(0)
  v_max3_u32 v66, v24, v27, v28
  v_max3_u32 v66, v66, v31, v32
  v_max_u32 v66, v66, v35
  v_cmp_eq_u32 vcc, -1, v66
  s_nop 4
  s_cbranch_vccz cA_sc3_c4
  s_add_u32 s30, s30, 1
  s_cmp_lt_u32 s30, 400000
  s_cbranch_scc1 cA_sc3_r4
  s_branch cA_abort
cA_sc3_retry:
  s_cmp_lg_u32 s62, 0
  s_cbranch_scc1 cA_sc3_cont
  s_waitcnt vmcnt(0) lgkmcnt(0)
cA_sc3_rv:
  buffer_load_dwordx4 v[8:11], v2, s[8:11], s20 offen offset:0 sc1
  buffer_load_dwordx4 v[12:15], v2, s[8:11], s20 offen offset:1024 sc1
  buffer_load_dwordx4 v[16:19], v2, s[8:11], s20 offen offset:2048 sc1
  buffer_load_dwordx4 v[20:23], v2, s[8:11], s20 offen offset:3072 sc1
  buffer_load_dwordx4 v[24:27], v2, s[8:11], s23 offen offset:0 sc1
  buffer_load_dwordx4 v[28:31], v2, s[8:11], s23 offen offset:1024 sc1
  buffer_load_dwordx4 v[32:35], v2, s[8:11], s23 offen offset:2048 sc1
  s_waitcnt vmcnt(0)
  v_pk_max_u16 v66, v8, v9
  v_pk_max_u16 v66, v66, v10
  v_pk_max_u16 v66, v66, v11
  v_pk_max_u16 v66, v66, v12
  v_pk_max_u16 v66, v66, v13
  v_pk_max_u16 v66, v66, v14
  v_pk_max_u16 v66, v66, v15
  v_pk_max_u16 v66, v66, v16
  v_pk_max_u16 v66, v66, v17
  v_pk_max_u16 v66, v66, v18
  v_pk_max_u16 v66, v66, v19
  v_pk_max_u16 v66, v66, v20
  v_pk_max_u16 v66, v66, v21
  v_pk_max_u16 v66, v66, v22
  v_pk_max_u16 v66, v66, v23
  v_pk_max_u16 v66, v66, v24
  v_pk_max_u16 v66, v66, v25
  v_pk_max_u16 v66, v66, v26
  v_pk_max_u16 v66, v66, v27
  v_pk_max_u16 v66, v66, v28
  v_pk_max_u16 v66, v66, v29
  v_pk_max_u16 v66, v66, v30
  v_pk_max_u16 v66, v66, v31
  v_pk_max_u16 v66, v66, v32
  v_pk_max_u16 v66, v66, v33
  v_pk_max_u16 v66, v66, v34
  v_pk_max_u16 v66, v66, v35
  v_lshlrev_b32 v67, 16, v66
  v_max_u32 v66, v66, v67
  v_cmp_le_u32 vcc, 0xffff0000, v66
  s_cbranch_vccz cA_sc3_rk
  s_add_u32 s30, s30, 1
  s_cmp_lt_u32 s30, 400000
  s_cbranch_scc1 cA_sc3_rv
  s_branch cA_abort
cA_sc3_rk:
  s_mov_b32 s62, 1
  v_mov_b32 v36, 0
  v_mov_b32 v37, 0
  v_mov_b32 v38, 0
  v_mov_b32 v39, 0
  v_mov_b32 v40, 0
  v_mov_b32 v41, 0
  v_mov_b32 v42, 0
  v_mov_b32 v43, 0
  v_mov_b32 v44, 0
  v_mov_b32 v45, 0
  v_mov_b32 v46, 0
  v_mov_b32 v47, 0
  v_mov_b32 v48, 0
  v_mov_b32 v49, 0
  v_mov_b32 v50, 0
  v_mov_b32 v51, 0
  v_mov_b32 v62, 0
  v_mov_b32 v63, 0
  v_mov_b32 v64, 0
  v_mov_b32 v65, 0
  v_mov_b32 v68, 0
  v_mov_b32 v69, 0
  v_mov_b32 v70, 0
  v_mov_b32 v71, 0
  v_mov_b32 v72, 0
  v_mov_b32 v73, 0
  v_mov_b32 v74, 0
  v_mov_b32 v75, 0
  v_mov_b32 v52, 0
  v_mov_b32 v53, 0
  v_mov_b32 v54, 0
  v_mov_b32 v55, 0
  v_mov_b32 v56, 0
  v_mov_b32 v57, 0
  v_mov_b32 v58, 0
  v_mov_b32 v59, 0
  s_add_u32 s31, s31, 0x100
  s_nop 0
  s_branch cA_sc3_go
.p2align 6
cA_va0_loop:
  s_mov_b32 s30, 0
  s_barrier
  buffer_load_dwordx4 v[24:27], v2, s[8:11], s23 offen offset:0 sc1
  buffer_load_dwordx4 v[28:31], v2, s[8:11], s23 offen offset:1024 sc1
  s_barrier
  s_cmp_lt_u32 s19, 58
  s_cbranch_scc1 cA_va0_m1
  buffer_store_dword v160, v1, s[8:11], s38 offen sc1
  s_branch cA_va0_m2
cA_va0_m1:
  buffer_store_dword v160, v1, s[8:11], s38 offen nt
cA_va0_m2:
  s_add_u32 s22, s25, 0
  buffer_load_dwordx4 v[80:83], v6, s[8:11], s22 offen offset:0 sc1
  buffer_load_dwordx4 v[84:87], v6, s[8:11], s22 offen offset:1792 sc1
  s_add_u32 s22, s25, 3584
  buffer_load_dwordx4 v[88:91], v6, s[8:11], s22 offen offset:0 sc1
  buffer_load_dwordx4 v[92:95], v6, s[8:11], s22 offen offset:1792 sc1
  s_add_u32 s22, s25, 7168
  buffer_load_dwordx4 v[96:99], v6, s[8:11], s22 offen offset:0 sc1
  s_mul_i32 s38, s18, 7168
  s_add_u32 s38, s38, 88002560
  s_waitcnt vmcnt(6)
  ds_write_b128 v2, v[24:27] offset:12288
  ds_write_b128 v2, v[28:31] offset:13312
  v_smfmac_f32_16x16x64_bf16 v[36:39], v[24:27], a[32:39], v3
  buffer_load_dwordx4 v[100:103], v6, s[8:11], s22 offen offset:1792 sc1
  v_smfmac_f32_16x16x64_bf16 v[40:43], v[24:27], a[88:95], v3
  s_add_u32 s22, s25, 10752
  buffer_load_dwordx4 v[104:107], v6, s[8:11], s22 offen offset:0 sc1
  v_smfmac_f32_16x16x64_bf16 v[44:47], v[24:27], a[144:151], v3
  buffer_load_dwordx4 v[108:111], v6, s[8:11], s22 offen offset:1792 sc1
  v_smfmac_f32_16x16x64_bf16 v[48:51], v[24:27], a[200:207], v3
  s_add_u32 s22, s25, 14336
  buffer_load_dwordx4 v[112:115], v6, s[8:11], s22 offen offset:0 sc1
  v_smfmac_f32_16x16x64_bf16 v[52:55], v[24:27], v[176:183], v3
  s_waitcnt lgkmcnt(0)
  s_barrier
  ds_read_b128 v[8:11], v2 offset:8192
  ds_read_b128 v[12:15], v2 offset:9216
  ds_read_b128 v[16:19], v2 offset:10240
  ds_read_b128 v[20:23], v2 offset:11264
  ds_read_b128 v[32:35], v2 offset:14336
  buffer_load_dwordx4 v[116:119], v6, s[8:11], s22 offen offset:1792 sc1
  v_smfmac_f32_16x16x64_bf16 v[56:59], v[24:27], v[232:239], v3
  s_add_u32 s22, s25, 17920
  buffer_load_dwordx4 v[120:123], v6, s[8:11], s22 offen offset:0 sc1
  v_smfmac_f32_16x16x64_bf16 v[36:39], v[28:31], a[40:47], v3
  buffer_load_dwordx4 v[124:127], v6, s[8:11], s22 offen offset:1792 sc1
  v_smfmac_f32_16x16x64_bf16 v[40:43], v[28:31], a[96:103], v3
  s_add_u32 s22, s25, 21504
  buffer_load_dwordx4 v[128:131], v6, s[8:11], s22 offen offset:0 sc1
  v_smfmac_f32_16x16x64_bf16 v[44:47], v[28:31], a[152:159], v3
  buffer_load_dwordx4 v[132:135], v6, s[8:11], s22 offen offset:1792 sc1
  v_smfmac_f32_16x16x64_bf16 v[48:51], v[28:31], a[208:215], v3
  s_add_u32 s22, s25, 25088
  buffer_load_dwordx4 v[136:139], v6, s[8:11], s22 offen offset:0 sc1
  v_smfmac_f32_16x16x64_bf16 v[52:55], v[28:31], v[184:191], v3
  ds_read_b128 v[64:67], v0 offset:0
  ds_read_b128 v[68:71], v0 offset:1024
  buffer_load_dwordx4 v[140:143], v6, s[8:11], s22 offen offset:1792 sc1
  v_smfmac_f32_16x16x64_bf16 v[56:59], v[28:31], v[240:247], v3
  s_waitcnt lgkmcnt(6)
  ds_read_b128 v[72:75], v0 offset:2048
  ds_read_b128 v[76:79], v0 offset:3072
  v_smfmac_f32_16x16x64_bf16 v[36:39], v[8:11], a[0:7], v3
  s_waitcnt lgkmcnt(7)
  v_smfmac_f32_16x16x64_bf16 v[36:39], v[12:15], a[8:15], v3
  s_waitcnt lgkmcnt(6)
  v_smfmac_f32_16x16x64_bf16 v[36:39], v[16:19], a[16:23], v3
  s_waitcnt lgkmcnt(2)
  v_smfmac_f32_16x16x64_bf16 v[60:63], v[8:11], v[64:71], v3
  s_waitcnt lgkmcnt(5)
  ds_read_b128 v[144:147], v0 offset:4096
  ds_read_b128 v[148:151], v0 offset:5120
  v_smfmac_f32_16x16x64_bf16 v[36:39], v[20:23], a[24:31], v3
  s_waitcnt lgkmcnt(6)
  v_smfmac_f32_16x16x64_bf16 v[36:39], v[32:35], a[48:55], v3
  v_smfmac_f32_16x16x64_bf16 v[40:43], v[8:11], a[56:63], v3
  s_waitcnt lgkmcnt(2)
  v_smfmac_f32_16x16x64_bf16 v[60:63], v[12:15], v[72:79], v3
  ds_read_b128 v[64:67], v0 offset:6144
  ds_read_b128 v[68:71], v0 offset:7168
  v_smfmac_f32_16x16x64_bf16 v[40:43], v[12:15], a[64:71], v3
  v_permlane32_swap_b32 v36, v38
  v_smfmac_f32_16x16x64_bf16 v[40:43], v[16:19], a[72:79], v3
  v_permlane32_swap_b32 v37, v39
  v_smfmac_f32_16x16x64_bf16 v[40:43], v[20:23], a[80:87], v3
  s_waitcnt lgkmcnt(2)
  v_add_f32 v36, v36, v38
  v_smfmac_f32_16x16x64_bf16 v[60:63], v[16:19], v[144:151], v3
  ds_read_b128 v[72:75], v0 offset:8192
  ds_read_b128 v[76:79], v0 offset:9216
  v_add_f32 v37, v37, v39
  v_smfmac_f32_16x16x64_bf16 v[40:43], v[32:35], a[104:111], v3
  v_cmp_u_f32 vcc, v36, v37
  v_smfmac_f32_16x16x64_bf16 v[44:47], v[8:11], a[112:119], v3
  v_cvt_pk_bf16_f32 v38, v36, v37
  v_smfmac_f32_16x16x64_bf16 v[44:47], v[12:15], a[120:127], v3
  ds_write_b32 v152, v38
  s_waitcnt lgkmcnt(3)
  s_cbranch_vccnz cA_va0_slow
  v_permlane32_swap_b32 v40, v42
  v_smfmac_f32_16x16x64_bf16 v[60:63], v[20:23], v[64:71], v3
  ds_read_b128 v[144:147], v0 offset:10240
  ds_read_b128 v[148:151], v0 offset:11264
  v_permlane32_swap_b32 v41, v43
  v_smfmac_f32_16x16x64_bf16 v[44:47], v[16:19], a[128:135], v3
  buffer_store_dword v162, v1, s[8:11], s21 offen
  v_add_f32 v40, v40, v42
  v_smfmac_f32_16x16x64_bf16 v[44:47], v[20:23], a[136:143], v3
  v_add_f32 v41, v41, v43
  v_smfmac_f32_16x16x64_bf16 v[44:47], v[32:35], a[160:167], v3
  s_waitcnt lgkmcnt(3)
  v_cvt_pk_bf16_f32 v42, v40, v41
  v_smfmac_f32_16x16x64_bf16 v[60:63], v[24:27], v[72:79], v3
  ds_write_b32 v153, v42
  ds_read_b128 v[64:67], v0 offset:12288
  ds_read_b128 v[68:71], v0 offset:13312
  v_smfmac_f32_16x16x64_bf16 v[48:51], v[8:11], a[168:175], v3
  s_nop 0
  v_permlane32_swap_b32 v44, v46
  v_smfmac_f32_16x16x64_bf16 v[48:51], v[12:15], a[176:183], v3
  v_permlane32_swap_b32 v45, v47
  v_smfmac_f32_16x16x64_bf16 v[48:51], v[16:19], a[184:191], v3
  s_waitcnt lgkmcnt(3)
  v_add_f32 v44, v44, v46
  v_smfmac_f32_16x16x64_bf16 v[60:63], v[28:31], v[144:151], v3
  v_add_f32 v45, v45, v47
  v_smfmac_f32_16x16x64_bf16 v[48:51], v[20:23], a[192:199], v3
  v_cvt_pk_bf16_f32 v46, v44, v45
  v_smfmac_f32_16x16x64_bf16 v[48:51], v[32:35], a[216:223], v3
  ds_write_b32 v154, v46
  v_smfmac_f32_16x16x64_bf16 v[52:55], v[8:11], a[224:231], v3
  s_waitcnt lgkmcnt(1)
  v_smfmac_f32_16x16x64_bf16 v[60:63], v[32:35], v[64:71], v3
  v_smfmac_f32_16x16x64_bf16 v[52:55], v[12:15], a[232:239], v3
  v_permlane32_swap_b32 v48, v50
  v_smfmac_f32_16x16x64_bf16 v[52:55], v[16:19], a[240:247], v3
  v_permlane32_swap_b32 v49, v51
  v_smfmac_f32_16x16x64_bf16 v[52:55], v[20:23], a[248:255], v3
  v_add_f32 v48, v48, v50
  v_smfmac_f32_16x16x64_bf16 v[52:55], v[32:35], v[192:199], v3
  v_add_f32 v49, v49, v51
  v_smfmac_f32_16x16x64_bf16 v[56:59], v[8:11], v[200:207], v3
  v_cvt_pk_bf16_f32 v50, v48, v49
  v_smfmac_f32_16x16x64_bf16 v[56:59], v[12:15], v[208:215], v3
  ds_write_b32 v155, v50
  v_permlane32_swap_b32 v60, v62
  v_smfmac_f32_16x16x64_bf16 v[56:59], v[16:19], v[216:223], v3
  v_permlane32_swap_b32 v61, v63
  v_smfmac_f32_16x16x64_bf16 v[56:59], v[20:23], v[224:231], v3
  v_add_f32 v60, v60, v62
  v_smfmac_f32_16x16x64_bf16 v[56:59], v[32:35], v[248:255], v3
  v_add_f32 v61, v61, v63
  v_cvt_pk_bf16_f32 v62, v60, v61
  ds_write_b32 v158, v62
  v_permlane32_swap_b32 v52, v54
  v_permlane32_swap_b32 v53, v55
  v_add_f32 v52, v52, v54
  v_add_f32 v53, v53, v55
  v_cvt_pk_bf16_f32 v54, v52, v53
  ds_write_b32 v156, v54
  v_permlane32_swap_b32 v56, v58
  v_permlane32_swap_b32 v57, v59
  v_add_f32 v56, v56, v58
  v_add_f32 v57, v57, v59
  v_cvt_pk_bf16_f32 v58, v56, v57
  ds_write_b32 v157, v58
cA_va0_t2d:
  s_add_u32 s22, s20, 9216
  s_add_u32 s34, s20, 13312
  s_add_u32 s36, s20, 7168
  s_mov_b32 s37, 0
  v_mov_b32 v48, 0
  v_mov_b32 v49, 0
  v_mov_b32 v50, 0
  v_mov_b32 v51, 0
  v_mov_b32 v163, s18
  s_waitcnt lgkmcnt(0)
  s_setprio 3
  buffer_load_dword v52, v4, s[8:11], 0 offen sc1
  buffer_load_dword v53, v4, s[8:11], 0 offen sc1
  buffer_load_dword v54, v4, s[8:11], 0 offen sc1
  buffer_load_dword v55, v4, s[8:11], 0 offen sc1
cA_va0_fw_l:
  s_waitcnt vmcnt(3)
  v_cmp_gt_u32 vcc, s18, v52
  s_cbranch_vccz cA_va0_fw_d
  buffer_load_dword v52, v4, s[8:11], 0 offen sc1
  s_waitcnt vmcnt(3)
  v_cmp_gt_u32 vcc, s18, v53
  s_cbranch_vccz cA_va0_fw_d
  buffer_load_dword v53, v4, s[8:11], 0 offen sc1
  s_waitcnt vmcnt(3)
  v_cmp_gt_u32 vcc, s18, v54
  s_cbranch_vccz cA_va0_fw_d
  buffer_load_dword v54, v4, s[8:11], 0 offen sc1
  s_waitcnt vmcnt(3)
  v_cmp_gt_u32 vcc, s18, v55
  s_cbranch_vccz cA_va0_fw_d
  buffer_load_dword v55, v4, s[8:11], 0 offen sc1
  s_add_u32 s30, s30, 1
  s_cmp_lt_u32 s30, 400000
  s_cbranch_scc1 cA_va0_fw_l
  s_branch cA_abort
cA_va0_fw_d:
  buffer_load_dwordx4 v[8:11], v2, s[8:11], s22 offen offset:0 sc1
  buffer_load_dwordx4 v[12:15], v2, s[8:11], s22 offen offset:1024 sc1
  buffer_load_dwordx4 v[16:19], v2, s[8:11], s22 offen offset:2048 sc1
  buffer_load_dwordx4 v[20:23], v2, s[8:11], s22 offen offset:3072 sc1
  buffer_load_dwordx4 v[24:27], v2, s[8:11], s34 offen offset:0 sc1
  buffer_load_dwordx4 v[28:31], v2, s[8:11], s34 offen offset:1024 sc1
  buffer_load_dwordx4 v[32:35], v2, s[8:11], s34 offen offset:2048 sc1
  buffer_load_dwordx4 v[36:39], v2, s[8:11], s34 offen offset:3072 sc1
  buffer_load_dwordx4 v[40:43], v2, s[8:11], s36 offen offset:0 sc1
  buffer_load_dwordx4 v[44:47], v2, s[8:11], s36 offen offset:1024 sc1
  s_barrier
  ds_read_b128 v[64:67], v2 offset:0
  ds_read_b128 v[68:71], v2 offset:1024
  ds_read_b128 v[72:75], v2 offset:2048
  ds_read_b128 v[76:79], v2 offset:3072
cA_va0_lp:
  s_waitcnt vmcnt(9)
  v_smfmac_f32_16x16x64_bf16 v[48:51], v[8:11], v[80:87], v3
  s_waitcnt vmcnt(8)
  v_smfmac_f32_16x16x64_bf16 v[48:51], v[12:15], v[88:95], v3
  s_waitcnt vmcnt(7)
  v_smfmac_f32_16x16x64_bf16 v[48:51], v[16:19], v[96:103], v3
  s_waitcnt vmcnt(6)
  v_smfmac_f32_16x16x64_bf16 v[48:51], v[20:23], v[104:111], v3
  s_waitcnt vmcnt(5)
  v_smfmac_f32_16x16x64_bf16 v[48:51], v[24:27], v[112:119], v3
  s_waitcnt vmcnt(4)
  v_smfmac_f32_16x16x64_bf16 v[48:51], v[28:31], v[120:127], v3
  s_waitcnt vmcnt(3)
  v_smfmac_f32_16x16x64_bf16 v[48:51], v[32:35], v[128:135], v3
  s_waitcnt vmcnt(2)
  v_smfmac_f32_16x16x64_bf16 v[48:51], v[36:39], v[136:143], v3
  s_waitcnt vmcnt(1) lgkmcnt(0)
  v_smfmac_f32_16x16x64_bf16 v[48:51], v[40:43], v[64:71], v3
  s_waitcnt vmcnt(0)
  v_smfmac_f32_16x16x64_bf16 v[48:51], v[44:47], v[72:79], v3
  s_nop 7
  v_permlane32_swap_b32 v48, v50
  v_permlane32_swap_b32 v49, v51
  v_add_f32 v48, v48, v50
  v_add_f32 v49, v49, v51
  v_cvt_pk_bf16_f32 v160, v48, v49
  v_cmp_u_f32 vcc, v48, v49
  s_nop 0
  v_mov_b32_dpp v161, v160 quad_perm:[1,0,3,2] row_mask:0xf bank_mask:0xf
  v_perm_b32 v160, v161, v160, v5
  v_min_u32 v160, -2, v160
  s_cbranch_vccnz cA_va0_rp
cA_va0_cont:
  buffer_store_dword v160, v1, s[8:11], s21 offen
  s_setprio 0
  s_cmp_lg_u32 s19, 62
  s_cbranch_scc1 cA_va0_nl
  buffer_store_dword v160, v1, s[8:11], s38 offen sc1
  s_waitcnt vmcnt(0)
  buffer_wbl2 sc1
  s_branch cA_done
cA_va0_nl:
  s_add_u32 s25, s25, 458752
  v_mov_b32 v36, 0
  v_mov_b32 v37, 0
  v_mov_b32 v38, 0
  v_mov_b32 v39, 0
  v_mov_b32 v40, 0
  v_mov_b32 v41, 0
  v_mov_b32 v42, 0
  v_mov_b32 v43, 0
  v_mov_b32 v44, 0
  v_mov_b32 v45, 0
  v_mov_b32 v46, 0
  v_mov_b32 v47, 0
  v_mov_b32 v48, 0
  v_mov_b32 v49, 0
  v_mov_b32 v50, 0
  v_mov_b32 v51, 0
  v_mov_b32 v52, 0
  v_mov_b32 v53, 0
  v_mov_b32 v54, 0
  v_mov_b32 v55, 0
  v_mov_b32 v56, 0
  v_mov_b32 v57, 0
  v_mov_b32 v58, 0
  v_mov_b32 v59, 0
  v_mov_b32 v60, 0
  v_mov_b32 v61, 0
  v_mov_b32 v62, 0
  v_mov_b32 v63, 0
  s_mov_b32 s19, s18
  s_add_u32 s18, s18, 1
  s_mov_b32 s22, s20
  s_mov_b32 s20, s21
  s_mov_b32 s21, s22
  s_add_u32 s23, s20, 4096
  s_branch cA_va0_loop
cA_va0_slow:
  s_waitcnt lgkmcnt(0)
cA_va0_sl1:
  s_add_u32 s31, s31, 0x1000000
  buffer_load_dwordx4 v[8:11], v2, s[8:11], s20 offen offset:0 sc1
  buffer_load_dwordx4 v[12:15], v2, s[8:11], s20 offen offset:1024 sc1
  buffer_load_dwordx4 v[16:19], v2, s[8:11], s20 offen offset:2048 sc1
  buffer_load_dwordx4 v[20:23], v2, s[8:11], s20 offen offset:3072 sc1
  buffer_load_dwordx4 v[24:27], v2, s[8:11], s23 offen offset:0 sc1
  buffer_load_dwordx4 v[28:31], v2, s[8:11], s23 offen offset:1024 sc1
  buffer_load_dwordx4 v[32:35], v2, s[8:11], s23 offen offset:2048 sc1
  s_waitcnt vmcnt(0)
  v_max3_u32 v36, v8, v9, v10
  v_max3_u32 v36, v36, v11, v12
  v_max3_u32 v36, v36, v13, v14
  v_max3_u32 v36, v36, v15, v16
  v_max3_u32 v36, v36, v17, v18
  v_max3_u32 v36, v36, v19, v20
  v_max3_u32 v36, v36, v21, v22
  v_max3_u32 v36, v36, v23, v24
  v_max3_u32 v36, v36, v25, v26
  v_max3_u32 v36, v36, v27, v28
  v_max3_u32 v36, v36, v29, v30
  v_max3_u32 v36, v36, v31, v32
  v_max3_u32 v36, v36, v33, v34
  v_max_u32 v36, v36, v35
  v_cmp_eq_u32 vcc, -1, v36
  s_cbranch_vccz cA_va0_sl2
  s_add_u32 s30, s30, 1
  s_cmp_lt_u32 s30, 400000
  s_cbranch_scc1 cA_va0_sl1
  s_branch cA_abort
cA_va0_sl2:
  v_mov_b32 v36, 0
  v_mov_b32 v37, 0
  v_mov_b32 v38, 0
  v_mov_b32 v39, 0
  v_mov_b32 v40, 0
  v_mov_b32 v41, 0
  v_mov_b32 v42, 0
  v_mov_b32 v43, 0
  v_mov_b32 v44, 0
  v_mov_b32 v45, 0
  v_mov_b32 v46, 0
  v_mov_b32 v47, 0
  v_mov_b32 v48, 0
  v_mov_b32 v49, 0
  v_mov_b32 v50, 0
  v_mov_b32 v51, 0
  v_mov_b32 v52, 0
  v_mov_b32 v53, 0
  v_mov_b32 v54, 0
  v_mov_b32 v55, 0
  v_mov_b32 v56, 0
  v_mov_b32 v57, 0
  v_mov_b32 v58, 0
  v_mov_b32 v59, 0
  v_mov_b32 v60, 0
  v_mov_b32 v61, 0
  v_mov_b32 v62, 0
  v_mov_b32 v63, 0
  buffer_store_dword v162, v1, s[8:11], s21 offen
  ds_read_b128 v[64:67], v0 offset:0
  ds_read_b128 v[68:71], v0 offset:1024
  v_smfmac_f32_16x16x64_bf16 v[36:39], v[8:11], a[0:7], v3
  v_smfmac_f32_16x16x64_bf16 v[40:43], v[8:11], a[56:63], v3
  v_smfmac_f32_16x16x64_bf16 v[44:47], v[8:11], a[112:119], v3
  v_smfmac_f32_16x16x64_bf16 v[48:51], v[8:11], a[168:175], v3
  v_smfmac_f32_16x16x64_bf16 v[52:55], v[8:11], a[224:231], v3
  v_smfmac_f32_16x16x64_bf16 v[56:59], v[8:11], v[200:207], v3
  s_waitcnt lgkmcnt(0)
  v_smfmac_f32_16x16x64_bf16 v[60:63], v[8:11], v[64:71], v3
  ds_read_b128 v[72:75], v0 offset:2048
  ds_read_b128 v[76:79], v0 offset:3072
  v_smfmac_f32_16x16x64_bf16 v[36:39], v[12:15], a[8:15], v3
  v_smfmac_f32_16x16x64_bf16 v[40:43], v[12:15], a[64:71], v3
  v_smfmac_f32_16x16x64_bf16 v[44:47], v[12:15], a[120:127], v3
  v_smfmac_f32_16x16x64_bf16 v[48:51], v[12:15], a[176:183], v3
  v_smfmac_f32_16x16x64_bf16 v[52:55], v[12:15], a[232:239], v3
  v_smfmac_f32_16x16x64_bf16 v[56:59], v[12:15], v[208:215], v3
  s_waitcnt lgkmcnt(0)
  v_smfmac_f32_16x16x64_bf16 v[60:63], v[12:15], v[72:79], v3
  ds_read_b128 v[144:147], v0 offset:4096
  ds_read_b128 v[148:151], v0 offset:5120
  v_smfmac_f32_16x16x64_bf16 v[36:39], v[16:19], a[16:23], v3
  v_smfmac_f32_16x16x64_bf16 v[40:43], v[16:19], a[72:79], v3
  v_smfmac_f32_16x16x64_bf16 v[44:47], v[16:19], a[128:135], v3
  v_smfmac_f32_16x16x64_bf16 v[48:51], v[16:19], a[184:191], v3
  v_smfmac_f32_16x16x64_bf16 v[52:55], v[16:19], a[240:247], v3
  v_smfmac_f32_16x16x64_bf16 v[56:59], v[16:19], v[216:223], v3
  s_waitcnt lgkmcnt(0)
  v_smfmac_f32_16x16x64_bf16 v[60:63], v[16:19], v[144:151], v3
  ds_read_b128 v[64:67], v0 offset:6144
  ds_read_b128 v[68:71], v0 offset:7168
  v_smfmac_f32_16x16x64_bf16 v[36:39], v[20:23], a[24:31], v3
  v_smfmac_f32_16x16x64_bf16 v[40:43], v[20:23], a[80:87], v3
  v_smfmac_f32_16x16x64_bf16 v[44:47], v[20:23], a[136:143], v3
  v_smfmac_f32_16x16x64_bf16 v[48:51], v[20:23], a[192:199], v3
  v_smfmac_f32_16x16x64_bf16 v[52:55], v[20:23], a[248:255], v3
  v_smfmac_f32_16x16x64_bf16 v[56:59], v[20:23], v[224:231], v3
  s_waitcnt lgkmcnt(0)
  v_smfmac_f32_16x16x64_bf16 v[60:63], v[20:23], v[64:71], v3
  ds_read_b128 v[72:75], v0 offset:8192
  ds_read_b128 v[76:79], v0 offset:9216
  v_smfmac_f32_16x16x64_bf16 v[36:39], v[24:27], a[32:39], v3
  v_smfmac_f32_16x16x64_bf16 v[40:43], v[24:27], a[88:95], v3
  v_smfmac_f32_16x16x64_bf16 v[44:47], v[24:27], a[144:151], v3
  v_smfmac_f32_16x16x64_bf16 v[48:51], v[24:27], a[200:207], v3
  v_smfmac_f32_16x16x64_bf16 v[52:55], v[24:27], v[176:183], v3
  v_smfmac_f32_16x16x64_bf16 v[56:59], v[24:27], v[232:239], v3
  s_waitcnt lgkmcnt(0)
  v_smfmac_f32_16x16x64_bf16 v[60:63], v[24:27], v[72:79], v3
  ds_read_b128 v[144:147], v0 offset:10240
  ds_read_b128 v[148:151], v0 offset:11264
  v_smfmac_f32_16x16x64_bf16 v[36:39], v[28:31], a[40:47], v3
  v_smfmac_f32_16x16x64_bf16 v[40:43], v[28:31], a[96:103], v3
  v_smfmac_f32_16x16x64_bf16 v[44:47], v[28:31], a[152:159], v3
  v_smfmac_f32_16x16x64_bf16 v[48:51], v[28:31], a[208:215], v3
  v_smfmac_f32_16x16x64_bf16 v[52:55], v[28:31], v[184:191], v3
  v_smfmac_f32_16x16x64_bf16 v[56:59], v[28:31], v[240:247], v3
  s_waitcnt lgkmcnt(0)
  v_smfmac_f32_16x16x64_bf16 v[60:63], v[28:31], v[144:151], v3
  ds_read_b128 v[64:67], v0 offset:12288
  ds_read_b128 v[68:71], v0 offset:13312
  v_smfmac_f32_16x16x64_bf16 v[36:39], v[32:35], a[48:55], v3
  v_smfmac_f32_16x16x64_bf16 v[40:43], v[32:35], a[104:111], v3
  v_smfmac_f32_16x16x64_bf16 v[44:47], v[32:35], a[160:167], v3
  v_smfmac_f32_16x16x64_bf16 v[48:51], v[32:35], a[216:223], v3
  v_smfmac_f32_16x16x64_bf16 v[52:55], v[32:35], v[192:199], v3
  v_smfmac_f32_16x16x64_bf16 v[56:59], v[32:35], v[248:255], v3
  s_waitcnt lgkmcnt(0)
  v_smfmac_f32_16x16x64_bf16 v[60:63], v[32:35], v[64:71], v3
  v_permlane32_swap_b32 v36, v38
  v_permlane32_swap_b32 v37, v39
  v_add_f32 v36, v36, v38
  v_add_f32 v37, v37, v39
  v_cvt_pk_bf16_f32 v38, v36, v37
  ds_write_b32 v152, v38
  v_permlane32_swap_b32 v40, v42
  v_permlane32_swap_b32 v41, v43
  v_add_f32 v40, v40, v42
  v_add_f32 v41, v41, v43
  v_cvt_pk_bf16_f32 v42, v40, v41
  ds_write_b32 v153, v42
  v_permlane32_swap_b32 v44, v46
  v_permlane32_swap_b32 v45, v47
  v_add_f32 v44, v44, v46
  v_add_f32 v45, v45, v47
  v_cvt_pk_bf16_f32 v46, v44, v45
  ds_write_b32 v154, v46
  v_permlane32_swap_b32 v48, v50
  v_permlane32_swap_b32 v49, v51
  v_add_f32 v48, v48, v50
  v_add_f32 v49, v49, v51
  v_cvt_pk_bf16_f32 v50, v48, v49
  ds_write_b32 v155, v50
  v_permlane32_swap_b32 v52, v54
  v_permlane32_swap_b32 v53, v55
  v_add_f32 v52, v52, v54
  v_add_f32 v53, v53, v55
  v_cvt_pk_bf16_f32 v54, v52, v53
  ds_write_b32 v156, v54
  v_permlane32_swap_b32 v56, v58
  v_permlane32_swap_b32 v57, v59
  v_add_f32 v56, v56, v58
  v_add_f32 v57, v57, v59
  v_cvt_pk_bf16_f32 v58, v56, v57
  ds_write_b32 v157, v58
  v_permlane32_swap_b32 v60, v62
  v_permlane32_swap_b32 v61, v63
  v_add_f32 v60, v60, v62
  v_add_f32 v61, v61, v63
  v_cvt_pk_bf16_f32 v62, v60, v61
  ds_write_b32 v158, v62
  s_branch cA_va0_t2d
cA_va0_rp:
  s_cmp_lg_u32 s37, 0
  s_cbranch_scc1 cA_va0_cont
cA_va0_rv:
  s_add_u32 s31, s31, 0x10000
  buffer_load_dwordx4 v[8:11], v2, s[8:11], s22 offen offset:0 sc1
  buffer_load_dwordx4 v[12:15], v2, s[8:11], s22 offen offset:1024 sc1
  buffer_load_dwordx4 v[16:19], v2, s[8:11], s22 offen offset:2048 sc1
  buffer_load_dwordx4 v[20:23], v2, s[8:11], s22 offen offset:3072 sc1
  buffer_load_dwordx4 v[24:27], v2, s[8:11], s34 offen offset:0 sc1
  buffer_load_dwordx4 v[28:31], v2, s[8:11], s34 offen offset:1024 sc1
  buffer_load_dwordx4 v[32:35], v2, s[8:11], s34 offen offset:2048 sc1
  buffer_load_dwordx4 v[36:39], v2, s[8:11], s34 offen offset:3072 sc1
  buffer_load_dwordx4 v[40:43], v2, s[8:11], s36 offen offset:0 sc1
  buffer_load_dwordx4 v[44:47], v2, s[8:11], s36 offen offset:1024 sc1
  s_waitcnt vmcnt(0)
  v_max3_u32 v52, v8, v9, v10
  v_max3_u32 v52, v52, v11, v12
  v_max3_u32 v52, v52, v13, v14
  v_max3_u32 v52, v52, v15, v16
  v_max3_u32 v52, v52, v17, v18
  v_max3_u32 v52, v52, v19, v20
  v_max3_u32 v52, v52, v21, v22
  v_max3_u32 v52, v52, v23, v24
  v_max3_u32 v52, v52, v25, v26
  v_max3_u32 v52, v52, v27, v28
  v_max3_u32 v52, v52, v29, v30
  v_max3_u32 v52, v52, v31, v32
  v_max3_u32 v52, v52, v33, v34
  v_max3_u32 v52, v52, v35, v36
  v_max3_u32 v52, v52, v37, v38
  v_max3_u32 v52, v52, v39, v40
  v_max3_u32 v52, v52, v41, v42
  v_max3_u32 v52, v52, v43, v44
  v_max3_u32 v52, v52, v45, v46
  v_max_u32 v52, v52, v47
  v_cmp_eq_u32 vcc, -1, v52
  s_mov_b32 s37, 1
  v_mov_b32 v48, 0
  v_mov_b32 v49, 0
  v_mov_b32 v50, 0
  v_mov_b32 v51, 0
  s_nop 1
  s_cbranch_vccz cA_va0_lp
  s_add_u32 s30, s30, 1
  s_cmp_lt_u32 s30, 400000
  s_cbranch_scc1 cA_va0_rv
  s_branch cA_abort
.p2align 6
cA_va1_loop:
  s_mov_b32 s30, 0
  s_barrier
  buffer_load_dwordx4 v[28:31], v2, s[8:11], s23 offen offset:1024 sc1
  buffer_load_dwordx4 v[32:35], v2, s[8:11], s23 offen offset:2048 sc1
  s_barrier
  s_cmp_lt_u32 s19, 58
  s_cbranch_scc1 cA_va1_m1
  buffer_store_dword v160, v1, s[8:11], s38 offen sc1
  s_branch cA_va1_m2
cA_va1_m1:
  buffer_store_dword v160, v1, s[8:11], s38 offen nt
cA_va1_m2:
  s_add_u32 s22, s25, 0
  buffer_load_dwordx4 v[80:83], v6, s[8:11], s22 offen offset:0 sc1
  buffer_load_dwordx4 v[84:87], v6, s[8:11], s22 offen offset:1792 sc1
  s_add_u32 s22, s25, 3584
  buffer_load_dwordx4 v[88:91], v6, s[8:11], s22 offen offset:0 sc1
  buffer_load_dwordx4 v[92:95], v6, s[8:11], s22 offen offset:1792 sc1
  s_add_u32 s22, s25, 7168
  buffer_load_dwordx4 v[96:99], v6, s[8:11], s22 offen offset:0 sc1
  s_mul_i32 s38, s18, 7168
  s_add_u32 s38, s38, 88002560
  s_waitcnt vmcnt(6)
  ds_write_b128 v2, v[32:35] offset:14336
  v_smfmac_f32_16x16x64_bf16 v[36:39], v[28:31], a[40:47], v3
  buffer_load_dwordx4 v[100:103], v6, s[8:11], s22 offen offset:1792 sc1
  v_smfmac_f32_16x16x64_bf16 v[40:43], v[28:31], a[96:103], v3
  s_add_u32 s22, s25, 10752
  buffer_load_dwordx4 v[104:107], v6, s[8:11], s22 offen offset:0 sc1
  v_smfmac_f32_16x16x64_bf16 v[44:47], v[28:31], a[152:159], v3
  buffer_load_dwordx4 v[108:111], v6, s[8:11], s22 offen offset:1792 sc1
  v_smfmac_f32_16x16x64_bf16 v[48:51], v[28:31], a[208:215], v3
  s_add_u32 s22, s25, 14336
  buffer_load_dwordx4 v[112:115], v6, s[8:11], s22 offen offset:0 sc1
  v_smfmac_f32_16x16x64_bf16 v[52:55], v[28:31], v[184:191], v3
  s_waitcnt lgkmcnt(0)
  s_barrier
  ds_read_b128 v[8:11], v2 offset:8192
  ds_read_b128 v[12:15], v2 offset:9216
  ds_read_b128 v[16:19], v2 offset:10240
  ds_read_b128 v[20:23], v2 offset:11264
  ds_read_b128 v[24:27], v2 offset:12288
  buffer_load_dwordx4 v[116:119], v6, s[8:11], s22 offen offset:1792 sc1
  v_smfmac_f32_16x16x64_bf16 v[56:59], v[28:31], v[240:247], v3
  s_add_u32 s22, s25, 17920
  buffer_load_dwordx4 v[120:123], v6, s[8:11], s22 offen offset:0 sc1
  v_smfmac_f32_16x16x64_bf16 v[36:39], v[32:35], a[48:55], v3
  buffer_load_dwordx4 v[124:127], v6, s[8:11], s22 offen offset:1792 sc1
  v_smfmac_f32_16x16x64_bf16 v[40:43], v[32:35], a[104:111], v3
  s_add_u32 s22, s25, 21504
  buffer_load_dwordx4 v[128:131], v6, s[8:11], s22 offen offset:0 sc1
  v_smfmac_f32_16x16x64_bf16 v[44:47], v[32:35], a[160:167], v3
  buffer_load_dwordx4 v[132:135], v6, s[8:11], s22 offen offset:1792 sc1
  v_smfmac_f32_16x16x64_bf16 v[48:51], v[32:35], a[216:223], v3
  s_add_u32 s22, s25, 25088
  buffer_load_dwordx4 v[136:139], v6, s[8:11], s22 offen offset:0 sc1
  v_smfmac_f32_16x16x64_bf16 v[52:55], v[32:35], v[192:199], v3
  ds_read_b128 v[64:67], v0 offset:0
  ds_read_b128 v[68:71], v0 offset:1024
  buffer_load_dwordx4 v[140:143], v6, s[8:11], s22 offen offset:1792 sc1
  v_smfmac_f32_16x16x64_bf16 v[56:59], v[32:35], v[248:255], v3
  s_waitcnt lgkmcnt(6)
  ds_read_b128 v[72:75], v0 offset:2048
  ds_read_b128 v[76:79], v0 offset:3072
  v_smfmac_f32_16x16x64_bf16 v[36:39], v[8:11], a[0:7], v3
  s_waitcnt lgkmcnt(7)
  v_smfmac_f32_16x16x64_bf16 v[36:39], v[12:15], a[8:15], v3
  s_waitcnt lgkmcnt(6)
  v_smfmac_f32_16x16x64_bf16 v[36:39], v[16:19], a[16:23], v3
  s_waitcnt lgkmcnt(2)
  v_smfmac_f32_16x16x64_bf16 v[60:63], v[8:11], v[64:71], v3
  s_waitcnt lgkmcnt(5)
  ds_read_b128 v[144:147], v0 offset:4096
  ds_read_b128 v[148:151], v0 offset:5120
  v_smfmac_f32_16x16x64_bf16 v[36:39], v[20:23], a[24:31], v3
  s_waitcnt lgkmcnt(6)
  v_smfmac_f32_16x16x64_bf16 v[36:39], v[24:27], a[32:39], v3
  v_smfmac_f32_16x16x64_bf16 v[40:43], v[8:11], a[56:63], v3
  s_waitcnt lgkmcnt(2)
  v_smfmac_f32_16x16x64_bf16 v[60:63], v[12:15], v[72:79], v3
  ds_read_b128 v[64:67], v0 offset:6144
  ds_read_b128 v[68:71], v0 offset:7168
  v_smfmac_f32_16x16x64_bf16 v[40:43], v[12:15], a[64:71], v3
  v_permlane32_swap_b32 v36, v38
  v_smfmac_f32_16x16x64_bf16 v[40:43], v[16:19], a[72:79], v3
  v_permlane32_swap_b32 v37, v39
  v_smfmac_f32_16x16x64_bf16 v[40:43], v[20:23], a[80:87], v3
  s_waitcnt lgkmcnt(2)
  v_add_f32 v36, v36, v38
  v_smfmac_f32_16x16x64_bf16 v[60:63], v[16:19], v[144:151], v3
  ds_read_b128 v[72:75], v0 offset:8192
  ds_read_b128 v[76:79], v0 offset:9216
  v_add_f32 v37, v37, v39
  v_smfmac_f32_16x16x64_bf16 v[40:43], v[24:27], a[88:95], v3
  v_cmp_u_f32 vcc, v36, v37
  v_smfmac_f32_16x16x64_bf16 v[44:47], v[8:11], a[112:119], v3
  v_cvt_pk_bf16_f32 v38, v36, v37
  v_smfmac_f32_16x16x64_bf16 v[44:47], v[12:15], a[120:127], v3
  ds_write_b32 v152, v38
  s_waitcnt lgkmcnt(3)
  s_cbranch_vccnz cA_va1_slow
  v_permlane32_swap_b32 v40, v42
  v_smfmac_f32_16x16x64_bf16 v[60:63], v[20:23], v[64:71], v3
  ds_read_b128 v[144:147], v0 offset:10240
  ds_read_b128 v[148:151], v0 offset:11264
  v_permlane32_swap_b32 v41, v43
  v_smfmac_f32_16x16x64_bf16 v[44:47], v[16:19], a[128:135], v3
  buffer_store_dword v162, v1, s[8:11], s21 offen
  v_add_f32 v40, v40, v42
  v_smfmac_f32_16x16x64_bf16 v[44:47], v[20:23], a[136:143], v3
  v_add_f32 v41, v41, v43
  v_smfmac_f32_16x16x64_bf16 v[44:47], v[24:27], a[144:151], v3
  s_waitcnt lgkmcnt(3)
  v_cvt_pk_bf16_f32 v42, v40, v41
  v_smfmac_f32_16x16x64_bf16 v[60:63], v[24:27], v[72:79], v3
  ds_write_b32 v153, v42
  ds_read_b128 v[64:67], v0 offset:12288
  ds_read_b128 v[68:71], v0 offset:13312
  v_smfmac_f32_16x16x64_bf16 v[48:51], v[8:11], a[168:175], v3
  s_nop 0
  v_permlane32_swap_b32 v44, v46
  v_smfmac_f32_16x16x64_bf16 v[48:51], v[12:15], a[176:183], v3
  v_permlane32_swap_b32 v45, v47
  v_smfmac_f32_16x16x64_bf16 v[48:51], v[16:19], a[184:191], v3
  s_waitcnt lgkmcnt(3)
  v_add_f32 v44, v44, v46
  v_smfmac_f32_16x16x64_bf16 v[60:63], v[28:31], v[144:151], v3
  v_add_f32 v45, v45, v47
  v_smfmac_f32_16x16x64_bf16 v[48:51], v[20:23], a[192:199], v3
  v_cvt_pk_bf16_f32 v46, v44, v45
  v_smfmac_f32_16x16x64_bf16 v[48:51], v[24:27], a[200:207], v3
  ds_write_b32 v154, v46
  v_smfmac_f32_16x16x64_bf16 v[52:55], v[8:11], a[224:231], v3
  s_waitcnt lgkmcnt(1)
  v_smfmac_f32_16x16x64_bf16 v[60:63], v[32:35], v[64:71], v3
  v_smfmac_f32_16x16x64_bf16 v[52:55], v[12:15], a[232:239], v3
  v_permlane32_swap_b32 v48, v50
  v_smfmac_f32_16x16x64_bf16 v[52:55], v[16:19], a[240:247], v3
  v_permlane32_swap_b32 v49, v51
  v_smfmac_f32_16x16x64_bf16 v[52:55], v[20:23], a[248:255], v3
  v_add_f32 v48, v48, v50
  v_smfmac_f32_16x16x64_bf16 v[52:55], v[24:27], v[176:183], v3
  v_add_f32 v49, v49, v51
  v_smfmac_f32_16x16x64_bf16 v[56:59], v[8:11], v[200:207], v3
  v_cvt_pk_bf16_f32 v50, v48, v49
  v_smfmac_f32_16x16x64_bf16 v[56:59], v[12:15], v[208:215], v3
  ds_write_b32 v155, v50
  v_permlane32_swap_b32 v60, v62
  v_smfmac_f32_16x16x64_bf16 v[56:59], v[16:19], v[216:223], v3
  v_permlane32_swap_b32 v61, v63
  v_smfmac_f32_16x16x64_bf16 v[56:59], v[20:23], v[224:231], v3
  v_add_f32 v60, v60, v62
  v_smfmac_f32_16x16x64_bf16 v[56:59], v[24:27], v[232:239], v3
  v_add_f32 v61, v61, v63
  v_cvt_pk_bf16_f32 v62, v60, v61
  ds_write_b32 v158, v62
  v_permlane32_swap_b32 v52, v54
  v_permlane32_swap_b32 v53, v55
  v_add_f32 v52, v52, v54
  v_add_f32 v53, v53, v55
  v_cvt_pk_bf16_f32 v54, v52, v53
  ds_write_b32 v156, v54
  v_permlane32_swap_b32 v56, v58
  v_permlane32_swap_b32 v57, v59
  v_add_f32 v56, v56, v58
  v_add_f32 v57, v57, v59
  v_cvt_pk_bf16_f32 v58, v56, v57
  ds_write_b32 v157, v58
cA_va1_t2d:
  s_add_u32 s22, s20, 9216
  s_add_u32 s34, s20, 13312
  s_add_u32 s36, s20, 7168
  s_mov_b32 s37, 0
  v_mov_b32 v48, 0
  v_mov_b32 v49, 0
  v_mov_b32 v50, 0
  v_mov_b32 v51, 0
  v_mov_b32 v163, s18
  s_waitcnt lgkmcnt(0)
  s_barrier
  buffer_load_dwordx4 v[8:11], v2, s[8:11], s22 offen offset:0 sc1
  buffer_load_dwordx4 v[12:15], v2, s[8:11], s22 offen offset:1024 sc1
  buffer_load_dwordx4 v[16:19], v2, s[8:11], s22 offen offset:2048 sc1
  buffer_load_dwordx4 v[20:23], v2, s[8:11], s22 offen offset:3072 sc1
  buffer_load_dwordx4 v[24:27], v2, s[8:11], s34 offen offset:0 sc1
  buffer_load_dwordx4 v[28:31], v2, s[8:11], s34 offen offset:1024 sc1
  buffer_load_dwordx4 v[32:35], v2, s[8:11], s34 offen offset:2048 sc1
  buffer_load_dwordx4 v[36:39], v2, s[8:11], s34 offen offset:3072 sc1
  buffer_load_dwordx4 v[40:43], v2, s[8:11], s36 offen offset:0 sc1
  buffer_load_dwordx4 v[44:47], v2, s[8:11], s36 offen offset:1024 sc1
  ds_read_b128 v[64:67], v2 offset:4096
  ds_read_b128 v[68:71], v2 offset:5120
  ds_read_b128 v[72:75], v2 offset:6144
  ds_read_b128 v[76:79], v2 offset:7168
cA_va1_lp:
  s_waitcnt vmcnt(9)
  v_smfmac_f32_16x16x64_bf16 v[48:51], v[8:11], v[80:87], v3
  s_waitcnt vmcnt(8)
  v_smfmac_f32_16x16x64_bf16 v[48:51], v[12:15], v[88:95], v3
  s_waitcnt vmcnt(7)
  v_smfmac_f32_16x16x64_bf16 v[48:51], v[16:19], v[96:103], v3
  v_max3_u32 v55, v8, v12, v16
  s_waitcnt vmcnt(6)
  v_smfmac_f32_16x16x64_bf16 v[48:51], v[20:23], v[104:111], v3
  v_max_u32 v55, v55, v20
  v_cmp_eq_u32 vcc, -1, v55
  s_waitcnt vmcnt(5)
  v_smfmac_f32_16x16x64_bf16 v[48:51], v[24:27], v[112:119], v3
  s_waitcnt vmcnt(4)
  v_smfmac_f32_16x16x64_bf16 v[48:51], v[28:31], v[120:127], v3
  s_cbranch_vccnz cA_va1_rv
  buffer_store_dword v163, v7, s[8:11], 0 offen
  s_waitcnt vmcnt(4)
  v_smfmac_f32_16x16x64_bf16 v[48:51], v[32:35], v[128:135], v3
  s_waitcnt vmcnt(3)
  v_smfmac_f32_16x16x64_bf16 v[48:51], v[36:39], v[136:143], v3
  s_waitcnt vmcnt(2) lgkmcnt(0)
  v_smfmac_f32_16x16x64_bf16 v[48:51], v[40:43], v[64:71], v3
  s_waitcnt vmcnt(1)
  v_smfmac_f32_16x16x64_bf16 v[48:51], v[44:47], v[72:79], v3
  s_nop 7
  v_permlane32_swap_b32 v48, v50
  v_permlane32_swap_b32 v49, v51
  v_add_f32 v48, v48, v50
  v_add_f32 v49, v49, v51
  v_cvt_pk_bf16_f32 v160, v48, v49
  v_cmp_u_f32 vcc, v48, v49
  s_nop 0
  v_mov_b32_dpp v161, v160 quad_perm:[1,0,3,2] row_mask:0xf bank_mask:0xf
  v_perm_b32 v160, v161, v160, v5
  v_min_u32 v160, -2, v160
  s_cbranch_vccnz cA_va1_rp
cA_va1_cont:
  buffer_store_dword v160, v1, s[8:11], s21 offen
  s_cmp_lg_u32 s19, 62
  s_cbranch_scc1 cA_va1_nl
  buffer_store_dword v160, v1, s[8:11], s38 offen sc1
  s_waitcnt vmcnt(0)
  buffer_wbl2 sc1
  s_branch cA_done
cA_va1_nl:
  s_add_u32 s25, s25, 458752
  v_mov_b32 v36, 0
  v_mov_b32 v37, 0
  v_mov_b32 v38, 0
  v_mov_b32 v39, 0
  v_mov_b32 v40, 0
  v_mov_b32 v41, 0
  v_mov_b32 v42, 0
  v_mov_b32 v43, 0
  v_mov_b32 v44, 0
  v_mov_b32 v45, 0
  v_mov_b32 v46, 0
  v_mov_b32 v47, 0
  v_mov_b32 v48, 0
  v_mov_b32 v49, 0
  v_mov_b32 v50, 0
  v_mov_b32 v51, 0
  v_mov_b32 v52, 0
  v_mov_b32 v53, 0
  v_mov_b32 v54, 0
  v_mov_b32 v55, 0
  v_mov_b32 v56, 0
  v_mov_b32 v57, 0
  v_mov_b32 v58, 0
  v_mov_b32 v59, 0
  v_mov_b32 v60, 0
  v_mov_b32 v61, 0
  v_mov_b32 v62, 0
  v_mov_b32 v63, 0
  s_mov_b32 s19, s18
  s_add_u32 s18, s18, 1
  s_mov_b32 s22, s20
  s_mov_b32 s20, s21
  s_mov_b32 s21, s22
  s_add_u32 s23, s20, 4096
  s_branch cA_va1_loop
cA_va1_slow:
  s_waitcnt lgkmcnt(0)
cA_va1_sl1:
  s_add_u32 s31, s31, 0x1000000
  buffer_load_dwordx4 v[8:11], v2, s[8:11], s20 offen offset:0 sc1
  buffer_load_dwordx4 v[12:15], v2, s[8:11], s20 offen offset:1024 sc1
  buffer_load_dwordx4 v[16:19], v2, s[8:11], s20 offen offset:2048 sc1
  buffer_load_dwordx4 v[20:23], v2, s[8:11], s20 offen offset:3072 sc1
  buffer_load_dwordx4 v[24:27], v2, s[8:11], s23 offen offset:0 sc1
  buffer_load_dwordx4 v[28:31], v2, s[8:11], s23 offen offset:1024 sc1
  buffer_load_dwordx4 v[32:35], v2, s[8:11], s23 offen offset:2048 sc1
  s_waitcnt vmcnt(0)
  v_max3_u32 v36, v8, v9, v10
  v_max3_u32 v36, v36, v11, v12
  v_max3_u32 v36, v36, v13, v14
  v_max3_u32 v36, v36, v15, v16
  v_max3_u32 v36, v36, v17, v18
  v_max3_u32 v36, v36, v19, v20
  v_max3_u32 v36, v36, v21, v22
  v_max3_u32 v36, v36, v23, v24
  v_max3_u32 v36, v36, v25, v26
  v_max3_u32 v36, v36, v27, v28
  v_max3_u32 v36, v36, v29, v30
  v_max3_u32 v36, v36, v31, v32
  v_max3_u32 v36, v36, v33, v34
  v_max_u32 v36, v36, v35
  v_cmp_eq_u32 vcc, -1, v36
  s_cbranch_vccz cA_va1_sl2
  s_add_u32 s30, s30, 1
  s_cmp_lt_u32 s30, 400000
  s_cbranch_scc1 cA_va1_sl1
  s_branch cA_abort
cA_va1_sl2:
  v_mov_b32 v36, 0
  v_mov_b32 v37, 0
  v_mov_b32 v38, 0
  v_mov_b32 v39, 0
  v_mov_b32 v40, 0
  v_mov_b32 v41, 0
  v_mov_b32 v42, 0
  v_mov_b32 v43, 0
  v_mov_b32 v44, 0
  v_mov_b32 v45, 0
  v_mov_b32 v46, 0
  v_mov_b32 v47, 0
  v_mov_b32 v48, 0
  v_mov_b32 v49, 0
  v_mov_b32 v50, 0
  v_mov_b32 v51, 0
  v_mov_b32 v52, 0
  v_mov_b32 v53, 0
  v_mov_b32 v54, 0
  v_mov_b32 v55, 0
  v_mov_b32 v56, 0
  v_mov_b32 v57, 0
  v_mov_b32 v58, 0
  v_mov_b32 v59, 0
  v_mov_b32 v60, 0
  v_mov_b32 v61, 0
  v_mov_b32 v62, 0
  v_mov_b32 v63, 0
  buffer_store_dword v162, v1, s[8:11], s21 offen
  ds_read_b128 v[64:67], v0 offset:0
  ds_read_b128 v[68:71], v0 offset:1024
  v_smfmac_f32_16x16x64_bf16 v[36:39], v[8:11], a[0:7], v3
  v_smfmac_f32_16x16x64_bf16 v[40:43], v[8:11], a[56:63], v3
  v_smfmac_f32_16x16x64_bf16 v[44:47], v[8:11], a[112:119], v3
  v_smfmac_f32_16x16x64_bf16 v[48:51], v[8:11], a[168:175], v3
  v_smfmac_f32_16x16x64_bf16 v[52:55], v[8:11], a[224:231], v3
  v_smfmac_f32_16x16x64_bf16 v[56:59], v[8:11], v[200:207], v3
  s_waitcnt lgkmcnt(0)
  v_smfmac_f32_16x16x64_bf16 v[60:63], v[8:11], v[64:71], v3
  ds_read_b128 v[72:75], v0 offset:2048
  ds_read_b128 v[76:79], v0 offset:3072
  v_smfmac_f32_16x16x64_bf16 v[36:39], v[12:15], a[8:15], v3
  v_smfmac_f32_16x16x64_bf16 v[40:43], v[12:15], a[64:71], v3
  v_smfmac_f32_16x16x64_bf16 v[44:47], v[12:15], a[120:127], v3
  v_smfmac_f32_16x16x64_bf16 v[48:51], v[12:15], a[176:183], v3
  v_smfmac_f32_16x16x64_bf16 v[52:55], v[12:15], a[232:239], v3
  v_smfmac_f32_16x16x64_bf16 v[56:59], v[12:15], v[208:215], v3
  s_waitcnt lgkmcnt(0)
  v_smfmac_f32_16x16x64_bf16 v[60:63], v[12:15], v[72:79], v3
  ds_read_b128 v[144:147], v0 offset:4096
  ds_read_b128 v[148:151], v0 offset:5120
  v_smfmac_f32_16x16x64_bf16 v[36:39], v[16:19], a[16:23], v3
  v_smfmac_f32_16x16x64_bf16 v[40:43], v[16:19], a[72:79], v3
  v_smfmac_f32_16x16x64_bf16 v[44:47], v[16:19], a[128:135], v3
  v_smfmac_f32_16x16x64_bf16 v[48:51], v[16:19], a[184:191], v3
  v_smfmac_f32_16x16x64_bf16 v[52:55], v[16:19], a[240:247], v3
  v_smfmac_f32_16x16x64_bf16 v[56:59], v[16:19], v[216:223], v3
  s_waitcnt lgkmcnt(0)
  v_smfmac_f32_16x16x64_bf16 v[60:63], v[16:19], v[144:151], v3
  ds_read_b128 v[64:67], v0 offset:6144
  ds_read_b128 v[68:71], v0 offset:7168
  v_smfmac_f32_16x16x64_bf16 v[36:39], v[20:23], a[24:31], v3
  v_smfmac_f32_16x16x64_bf16 v[40:43], v[20:23], a[80:87], v3
  v_smfmac_f32_16x16x64_bf16 v[44:47], v[20:23], a[136:143], v3
  v_smfmac_f32_16x16x64_bf16 v[48:51], v[20:23], a[192:199], v3
  v_smfmac_f32_16x16x64_bf16 v[52:55], v[20:23], a[248:255], v3
  v_smfmac_f32_16x16x64_bf16 v[56:59], v[20:23], v[224:231], v3
  s_waitcnt lgkmcnt(0)
  v_smfmac_f32_16x16x64_bf16 v[60:63], v[20:23], v[64:71], v3
  ds_read_b128 v[72:75], v0 offset:8192
  ds_read_b128 v[76:79], v0 offset:9216
  v_smfmac_f32_16x16x64_bf16 v[36:39], v[24:27], a[32:39], v3
  v_smfmac_f32_16x16x64_bf16 v[40:43], v[24:27], a[88:95], v3
  v_smfmac_f32_16x16x64_bf16 v[44:47], v[24:27], a[144:151], v3
  v_smfmac_f32_16x16x64_bf16 v[48:51], v[24:27], a[200:207], v3
  v_smfmac_f32_16x16x64_bf16 v[52:55], v[24:27], v[176:183], v3
  v_smfmac_f32_16x16x64_bf16 v[56:59], v[24:27], v[232:239], v3
  s_waitcnt lgkmcnt(0)
  v_smfmac_f32_16x16x64_bf16 v[60:63], v[24:27], v[72:79], v3
  ds_read_b128 v[144:147], v0 offset:10240
  ds_read_b128 v[148:151], v0 offset:11264
  v_smfmac_f32_16x16x64_bf16 v[36:39], v[28:31], a[40:47], v3
  v_smfmac_f32_16x16x64_bf16 v[40:43], v[28:31], a[96:103], v3
  v_smfmac_f32_16x16x64_bf16 v[44:47], v[28:31], a[152:159], v3
  v_smfmac_f32_16x16x64_bf16 v[48:51], v[28:31], a[208:215], v3
  v_smfmac_f32_16x16x64_bf16 v[52:55], v[28:31], v[184:191], v3
  v_smfmac_f32_16x16x64_bf16 v[56:59], v[28:31], v[240:247], v3
  s_waitcnt lgkmcnt(0)
  v_smfmac_f32_16x16x64_bf16 v[60:63], v[28:31], v[144:151], v3
  ds_read_b128 v[64:67], v0 offset:12288
  ds_read_b128 v[68:71], v0 offset:13312
  v_smfmac_f32_16x16x64_bf16 v[36:39], v[32:35], a[48:55], v3
  v_smfmac_f32_16x16x64_bf16 v[40:43], v[32:35], a[104:111], v3
  v_smfmac_f32_16x16x64_bf16 v[44:47], v[32:35], a[160:167], v3
  v_smfmac_f32_16x16x64_bf16 v[48:51], v[32:35], a[216:223], v3
  v_smfmac_f32_16x16x64_bf16 v[52:55], v[32:35], v[192:199], v3
  v_smfmac_f32_16x16x64_bf16 v[56:59], v[32:35], v[248:255], v3
  s_waitcnt lgkmcnt(0)
  v_smfmac_f32_16x16x64_bf16 v[60:63], v[32:35], v[64:71], v3
  v_permlane32_swap_b32 v36, v38
  v_permlane32_swap_b32 v37, v39
  v_add_f32 v36, v36, v38
  v_add_f32 v37, v37, v39
  v_cvt_pk_bf16_f32 v38, v36, v37
  ds_write_b32 v152, v38
  v_permlane32_swap_b32 v40, v42
  v_permlane32_swap_b32 v41, v43
  v_add_f32 v40, v40, v42
  v_add_f32 v41, v41, v43
  v_cvt_pk_bf16_f32 v42, v40, v41
  ds_write_b32 v153, v42
  v_permlane32_swap_b32 v44, v46
  v_permlane32_swap_b32 v45, v47
  v_add_f32 v44, v44, v46
  v_add_f32 v45, v45, v47
  v_cvt_pk_bf16_f32 v46, v44, v45
  ds_write_b32 v154, v46
  v_permlane32_swap_b32 v48, v50
  v_permlane32_swap_b32 v49, v51
  v_add_f32 v48, v48, v50
  v_add_f32 v49, v49, v51
  v_cvt_pk_bf16_f32 v50, v48, v49
  ds_write_b32 v155, v50
  v_permlane32_swap_b32 v52, v54
  v_permlane32_swap_b32 v53, v55
  v_add_f32 v52, v52, v54
  v_add_f32 v53, v53, v55
  v_cvt_pk_bf16_f32 v54, v52, v53
  ds_write_b32 v156, v54
  v_permlane32_swap_b32 v56, v58
  v_permlane32_swap_b32 v57, v59
  v_add_f32 v56, v56, v58
  v_add_f32 v57, v57, v59
  v_cvt_pk_bf16_f32 v58, v56, v57
  ds_write_b32 v157, v58
  v_permlane32_swap_b32 v60, v62
  v_permlane32_swap_b32 v61, v63
  v_add_f32 v60, v60, v62
  v_add_f32 v61, v61, v63
  v_cvt_pk_bf16_f32 v62, v60, v61
  ds_write_b32 v158, v62
  s_branch cA_va1_t2d
cA_va1_rp:
  s_cmp_lg_u32 s37, 0
  s_cbranch_scc1 cA_va1_cont
cA_va1_rv:
  s_add_u32 s31, s31, 0x10000
  buffer_load_dwordx4 v[8:11], v2, s[8:11], s22 offen offset:0 sc1
  buffer_load_dwordx4 v[12:15], v2, s[8:11], s22 offen offset:1024 sc1
  buffer_load_dwordx4 v[16:19], v2, s[8:11], s22 offen offset:2048 sc1
  buffer_load_dwordx4 v[20:23], v2, s[8:11], s22 offen offset:3072 sc1
  buffer_load_dwordx4 v[24:27], v2, s[8:11], s34 offen offset:0 sc1
  buffer_load_dwordx4 v[28:31], v2, s[8:11], s34 offen offset:1024 sc1
  buffer_load_dwordx4 v[32:35], v2, s[8:11], s34 offen offset:2048 sc1
  buffer_load_dwordx4 v[36:39], v2, s[8:11], s34 offen offset:3072 sc1
  buffer_load_dwordx4 v[40:43], v2, s[8:11], s36 offen offset:0 sc1
  buffer_load_dwordx4 v[44:47], v2, s[8:11], s36 offen offset:1024 sc1
  s_waitcnt vmcnt(0)
  v_max3_u32 v52, v8, v9, v10
  v_max3_u32 v52, v52, v11, v12
  v_max3_u32 v52, v52, v13, v14
  v_max3_u32 v52, v52, v15, v16
  v_max3_u32 v52, v52, v17, v18
  v_max3_u32 v52, v52, v19, v20
  v_max3_u32 v52, v52, v21, v22
  v_max3_u32 v52, v52, v23, v24
  v_max3_u32 v52, v52, v25, v26
  v_max3_u32 v52, v52, v27, v28
  v_max3_u32 v52, v52, v29, v30
  v_max3_u32 v52, v52, v31, v32
  v_max3_u32 v52, v52, v33, v34
  v_max3_u32 v52, v52, v35, v36
  v_max3_u32 v52, v52, v37, v38
  v_max3_u32 v52, v52, v39, v40
  v_max3_u32 v52, v52, v41, v42
  v_max3_u32 v52, v52, v43, v44
  v_max3_u32 v52, v52, v45, v46
  v_max_u32 v52, v52, v47
  v_cmp_eq_u32 vcc, -1, v52
  s_mov_b32 s37, 1
  v_mov_b32 v48, 0
  v_mov_b32 v49, 0
  v_mov_b32 v50, 0
  v_mov_b32 v51, 0
  s_nop 1
  s_cbranch_vccz cA_va1_lp
  s_add_u32 s30, s30, 1
  s_cmp_lt_u32 s30, 400000
  s_cbranch_scc1 cA_va1_rv
  s_branch cA_abort
.p2align 6
cA_va2_loop:
  s_mov_b32 s30, 0
  buffer_load_dword v100, v119, s[8:11], 0 offen sc1
  buffer_load_dword v101, v119, s[8:11], 0 offen sc1
  buffer_load_dword v102, v119, s[8:11], 0 offen sc1
  buffer_load_dword v103, v119, s[8:11], 0 offen sc1
cA_va2_fp_l:
  s_waitcnt vmcnt(3)
  v_cmp_gt_u32 vcc, s19, v100
  s_cbranch_vccz cA_va2_fp_d
  buffer_load_dword v100, v119, s[8:11], 0 offen sc1
  s_waitcnt vmcnt(3)
  v_cmp_gt_u32 vcc, s19, v101
  s_cbranch_vccz cA_va2_fp_d
  buffer_load_dword v101, v119, s[8:11], 0 offen sc1
  s_waitcnt vmcnt(3)
  v_cmp_gt_u32 vcc, s19, v102
  s_cbranch_vccz cA_va2_fp_d
  buffer_load_dword v102, v119, s[8:11], 0 offen sc1
  s_waitcnt vmcnt(3)
  v_cmp_gt_u32 vcc, s19, v103
  s_cbranch_vccz cA_va2_fp_d
  buffer_load_dword v103, v119, s[8:11], 0 offen sc1
  s_add_u32 s30, s30, 1
  s_cmp_lt_u32 s30, 400000
  s_cbranch_scc1 cA_va2_fp_l
  s_branch cA_abort
cA_va2_fp_d:
  buffer_load_dwordx4 v[8:11], v2, s[8:11], s20 offen offset:0 sc1
  buffer_load_dwordx4 v[12:15], v2, s[8:11], s20 offen offset:1024 sc1
  s_barrier
  s_barrier
  s_waitcnt vmcnt(0)
  ds_write_b128 v2, v[8:11] offset:8192
  ds_write_b128 v2, v[12:15] offset:9216
  v_smfmac_f32_16x16x64_bf16 v[36:39], v[8:11], a[0:7], v3
  v_smfmac_f32_16x16x64_bf16 v[40:43], v[8:11], a[56:63], v3
  v_smfmac_f32_16x16x64_bf16 v[44:47], v[8:11], a[112:119], v3
  v_smfmac_f32_16x16x64_bf16 v[48:51], v[8:11], a[168:175], v3
  v_smfmac_f32_16x16x64_bf16 v[52:55], v[8:11], a[224:231], v3
  s_waitcnt lgkmcnt(0)
  s_barrier
  ds_read_b128 v[16:19], v2 offset:10240
  ds_read_b128 v[20:23], v2 offset:11264
  ds_read_b128 v[24:27], v2 offset:12288
  ds_read_b128 v[28:31], v2 offset:13312
  ds_read_b128 v[32:35], v2 offset:14336
  v_smfmac_f32_16x16x64_bf16 v[56:59], v[8:11], v[144:151], v3
  v_smfmac_f32_16x16x64_bf16 v[60:63], v[8:11], v[200:207], v3
  v_smfmac_f32_16x16x64_bf16 v[36:39], v[12:15], a[8:15], v3
  v_smfmac_f32_16x16x64_bf16 v[40:43], v[12:15], a[64:71], v3
  v_smfmac_f32_16x16x64_bf16 v[44:47], v[12:15], a[120:127], v3
  v_smfmac_f32_16x16x64_bf16 v[48:51], v[12:15], a[176:183], v3
  v_smfmac_f32_16x16x64_bf16 v[52:55], v[12:15], a[232:239], v3
  v_smfmac_f32_16x16x64_bf16 v[56:59], v[12:15], v[152:159], v3
  v_smfmac_f32_16x16x64_bf16 v[60:63], v[12:15], v[208:215], v3
  s_waitcnt lgkmcnt(4)
  v_smfmac_f32_16x16x64_bf16 v[36:39], v[16:19], a[16:23], v3
  s_waitcnt lgkmcnt(3)
  v_smfmac_f32_16x16x64_bf16 v[36:39], v[20:23], a[24:31], v3
  s_waitcnt lgkmcnt(2)
  v_smfmac_f32_16x16x64_bf16 v[36:39], v[24:27], a[32:39], v3
  s_waitcnt lgkmcnt(1)
  v_smfmac_f32_16x16x64_bf16 v[36:39], v[28:31], a[40:47], v3
  s_waitcnt lgkmcnt(0)
  v_smfmac_f32_16x16x64_bf16 v[36:39], v[32:35], a[48:55], v3
  v_smfmac_f32_16x16x64_bf16 v[40:43], v[16:19], a[72:79], v3
  v_smfmac_f32_16x16x64_bf16 v[40:43], v[20:23], a[80:87], v3
  v_smfmac_f32_16x16x64_bf16 v[40:43], v[24:27], a[88:95], v3
  v_permlane32_swap_b32 v36, v38
  v_smfmac_f32_16x16x64_bf16 v[40:43], v[28:31], a[96:103], v3
  v_permlane32_swap_b32 v37, v39
  v_smfmac_f32_16x16x64_bf16 v[40:43], v[32:35], a[104:111], v3
  v_add_f32 v36, v36, v38
  v_smfmac_f32_16x16x64_bf16 v[44:47], v[16:19], a[128:135], v3
  v_add_f32 v37, v37, v39
  v_smfmac_f32_16x16x64_bf16 v[44:47], v[20:23], a[136:143], v3
  v_cmp_u_f32 vcc, v36, v37
  v_smfmac_f32_16x16x64_bf16 v[44:47], v[24:27], a[144:151], v3
  v_cvt_pk_bf16_f32 v38, v36, v37
  v_smfmac_f32_16x16x64_bf16 v[44:47], v[28:31], a[152:159], v3
  ds_write_b32 v104, v38
  s_cbranch_vccnz cA_va2_slow
  v_permlane32_swap_b32 v40, v42
  v_smfmac_f32_16x16x64_bf16 v[44:47], v[32:35], a[160:167], v3
  v_permlane32_swap_b32 v41, v43
  v_smfmac_f32_16x16x64_bf16 v[48:51], v[16:19], a[184:191], v3
  v_add_f32 v40, v40, v42
  v_smfmac_f32_16x16x64_bf16 v[48:51], v[20:23], a[192:199], v3
  v_add_f32 v41, v41, v43
  v_smfmac_f32_16x16x64_bf16 v[48:51], v[24:27], a[200:207], v3
  v_cvt_pk_bf16_f32 v42, v40, v41
  v_smfmac_f32_16x16x64_bf16 v[48:51], v[28:31], a[208:215], v3
  ds_write_b32 v105, v42
  v_permlane32_swap_b32 v44, v46
  v_smfmac_f32_16x16x64_bf16 v[48:51], v[32:35], a[216:223], v3
  v_permlane32_swap_b32 v45, v47
  v_smfmac_f32_16x16x64_bf16 v[52:55], v[16:19], a[240:247], v3
  v_add_f32 v44, v44, v46
  v_smfmac_f32_16x16x64_bf16 v[52:55], v[20:23], a[248:255], v3
  v_add_f32 v45, v45, v47
  v_smfmac_f32_16x16x64_bf16 v[52:55], v[24:27], v[120:127], v3
  v_cvt_pk_bf16_f32 v46, v44, v45
  v_smfmac_f32_16x16x64_bf16 v[52:55], v[28:31], v[128:135], v3
  ds_write_b32 v106, v46
  v_permlane32_swap_b32 v48, v50
  v_smfmac_f32_16x16x64_bf16 v[52:55], v[32:35], v[136:143], v3
  v_permlane32_swap_b32 v49, v51
  v_smfmac_f32_16x16x64_bf16 v[56:59], v[16:19], v[160:167], v3
  v_add_f32 v48, v48, v50
  v_smfmac_f32_16x16x64_bf16 v[56:59], v[20:23], v[168:175], v3
  v_add_f32 v49, v49, v51
  v_smfmac_f32_16x16x64_bf16 v[56:59], v[24:27], v[176:183], v3
  v_cvt_pk_bf16_f32 v50, v48, v49
  v_smfmac_f32_16x16x64_bf16 v[56:59], v[28:31], v[184:191], v3
  ds_write_b32 v107, v50
  v_permlane32_swap_b32 v52, v54
  v_smfmac_f32_16x16x64_bf16 v[56:59], v[32:35], v[192:199], v3
  v_permlane32_swap_b32 v53, v55
  v_smfmac_f32_16x16x64_bf16 v[60:63], v[16:19], v[216:223], v3
  v_add_f32 v52, v52, v54
  v_smfmac_f32_16x16x64_bf16 v[60:63], v[20:23], v[224:231], v3
  v_add_f32 v53, v53, v55
  v_smfmac_f32_16x16x64_bf16 v[60:63], v[24:27], v[232:239], v3
  v_cvt_pk_bf16_f32 v54, v52, v53
  v_smfmac_f32_16x16x64_bf16 v[60:63], v[28:31], v[240:247], v3
  ds_write_b32 v108, v54
  v_permlane32_swap_b32 v56, v58
  v_smfmac_f32_16x16x64_bf16 v[60:63], v[32:35], v[248:255], v3
  v_permlane32_swap_b32 v57, v59
  v_add_f32 v56, v56, v58
  v_add_f32 v57, v57, v59
  v_cvt_pk_bf16_f32 v58, v56, v57
  ds_write_b32 v109, v58
  s_nop 2
  v_permlane32_swap_b32 v60, v62
  v_permlane32_swap_b32 v61, v63
  v_add_f32 v60, v60, v62
  v_add_f32 v61, v61, v63
  v_cvt_pk_bf16_f32 v62, v60, v61
  ds_write_b32 v110, v62
cA_va2_t2d:
  v_mov_b32 v117, s18
  s_waitcnt lgkmcnt(0)
  s_barrier
  s_cmp_eq_u32 s19, 62
  s_cbranch_scc1 cA_done
  s_sleep 1
  v_mov_b32 v36, 0
  v_mov_b32 v37, 0
  v_mov_b32 v38, 0
  v_mov_b32 v39, 0
  v_mov_b32 v40, 0
  v_mov_b32 v41, 0
  v_mov_b32 v42, 0
  v_mov_b32 v43, 0
  v_mov_b32 v44, 0
  v_mov_b32 v45, 0
  v_mov_b32 v46, 0
  v_mov_b32 v47, 0
  v_mov_b32 v48, 0
  v_mov_b32 v49, 0
  v_mov_b32 v50, 0
  v_mov_b32 v51, 0
  v_mov_b32 v52, 0
  v_mov_b32 v53, 0
  v_mov_b32 v54, 0
  v_mov_b32 v55, 0
  v_mov_b32 v56, 0
  v_mov_b32 v57, 0
  v_mov_b32 v58, 0
  v_mov_b32 v59, 0
  v_mov_b32 v60, 0
  v_mov_b32 v61, 0
  v_mov_b32 v62, 0
  v_mov_b32 v63, 0
  s_sleep 3
  s_mov_b32 s19, s18
  s_add_u32 s18, s18, 1
  s_mov_b32 s22, s20
  s_mov_b32 s20, s21
  s_mov_b32 s21, s22
  s_add_u32 s23, s20, 4096
  s_branch cA_va2_loop
cA_va2_slow:
  s_waitcnt lgkmcnt(0)
cA_va2_sl1:
  s_add_u32 s31, s31, 0x1000000
  buffer_load_dwordx4 v[8:11], v2, s[8:11], s20 offen offset:0 sc1
  buffer_load_dwordx4 v[12:15], v2, s[8:11], s20 offen offset:1024 sc1
  buffer_load_dwordx4 v[16:19], v2, s[8:11], s20 offen offset:2048 sc1
  buffer_load_dwordx4 v[20:23], v2, s[8:11], s20 offen offset:3072 sc1
  buffer_load_dwordx4 v[24:27], v2, s[8:11], s23 offen offset:0 sc1
  buffer_load_dwordx4 v[28:31], v2, s[8:11], s23 offen offset:1024 sc1
  buffer_load_dwordx4 v[32:35], v2, s[8:11], s23 offen offset:2048 sc1
  s_waitcnt vmcnt(0)
  v_max3_u32 v36, v8, v9, v10
  v_max3_u32 v36, v36, v11, v12
  v_max3_u32 v36, v36, v13, v14
  v_max3_u32 v36, v36, v15, v16
  v_max3_u32 v36, v36, v17, v18
  v_max3_u32 v36, v36, v19, v20
  v_max3_u32 v36, v36, v21, v22
  v_max3_u32 v36, v36, v23, v24
  v_max3_u32 v36, v36, v25, v26
  v_max3_u32 v36, v36, v27, v28
  v_max3_u32 v36, v36, v29, v30
  v_max3_u32 v36, v36, v31, v32
  v_max3_u32 v36, v36, v33, v34
  v_max_u32 v36, v36, v35
  v_cmp_eq_u32 vcc, -1, v36
  s_cbranch_vccz cA_va2_sl2
  s_add_u32 s30, s30, 1
  s_cmp_lt_u32 s30, 400000
  s_cbranch_scc1 cA_va2_sl1
  s_branch cA_abort
cA_va2_sl2:
  v_mov_b32 v36, 0
  v_mov_b32 v37, 0
  v_mov_b32 v38, 0
  v_mov_b32 v39, 0
  v_mov_b32 v40, 0
  v_mov_b32 v41, 0
  v_mov_b32 v42, 0
  v_mov_b32 v43, 0
  v_mov_b32 v44, 0
  v_mov_b32 v45, 0
  v_mov_b32 v46, 0
  v_mov_b32 v47, 0
  v_mov_b32 v48, 0
  v_mov_b32 v49, 0
  v_mov_b32 v50, 0
  v_mov_b32 v51, 0
  v_mov_b32 v52, 0
  v_mov_b32 v53, 0
  v_mov_b32 v54, 0
  v_mov_b32 v55, 0
  v_mov_b32 v56, 0
  v_mov_b32 v57, 0
  v_mov_b32 v58, 0
  v_mov_b32 v59, 0
  v_mov_b32 v60, 0
  v_mov_b32 v61, 0
  v_mov_b32 v62, 0
  v_mov_b32 v63, 0
  v_smfmac_f32_16x16x64_bf16 v[36:39], v[8:11], a[0:7], v3
  v_smfmac_f32_16x16x64_bf16 v[40:43], v[8:11], a[56:63], v3
  v_smfmac_f32_16x16x64_bf16 v[44:47], v[8:11], a[112:119], v3
  v_smfmac_f32_16x16x64_bf16 v[48:51], v[8:11], a[168:175], v3
  v_smfmac_f32_16x16x64_bf16 v[52:55], v[8:11], a[224:231], v3
  v_smfmac_f32_16x16x64_bf16 v[56:59], v[8:11], v[144:151], v3
  v_smfmac_f32_16x16x64_bf16 v[60:63], v[8:11], v[200:207], v3
  v_smfmac_f32_16x16x64_bf16 v[36:39], v[12:15], a[8:15], v3
  v_smfmac_f32_16x16x64_bf16 v[40:43], v[12:15], a[64:71], v3
  v_smfmac_f32_16x16x64_bf16 v[44:47], v[12:15], a[120:127], v3
  v_smfmac_f32_16x16x64_bf16 v[48:51], v[12:15], a[176:183], v3
  v_smfmac_f32_16x16x64_bf16 v[52:55], v[12:15], a[232:239], v3
  v_smfmac_f32_16x16x64_bf16 v[56:59], v[12:15], v[152:159], v3
  v_smfmac_f32_16x16x64_bf16 v[60:63], v[12:15], v[208:215], v3
  v_smfmac_f32_16x16x64_bf16 v[36:39], v[16:19], a[16:23], v3
  v_smfmac_f32_16x16x64_bf16 v[40:43], v[16:19], a[72:79], v3
  v_smfmac_f32_16x16x64_bf16 v[44:47], v[16:19], a[128:135], v3
  v_smfmac_f32_16x16x64_bf16 v[48:51], v[16:19], a[184:191], v3
  v_smfmac_f32_16x16x64_bf16 v[52:55], v[16:19], a[240:247], v3
  v_smfmac_f32_16x16x64_bf16 v[56:59], v[16:19], v[160:167], v3
  v_smfmac_f32_16x16x64_bf16 v[60:63], v[16:19], v[216:223], v3
  v_smfmac_f32_16x16x64_bf16 v[36:39], v[20:23], a[24:31], v3
  v_smfmac_f32_16x16x64_bf16 v[40:43], v[20:23], a[80:87], v3
  v_smfmac_f32_16x16x64_bf16 v[44:47], v[20:23], a[136:143], v3
  v_smfmac_f32_16x16x64_bf16 v[48:51], v[20:23], a[192:199], v3
  v_smfmac_f32_16x16x64_bf16 v[52:55], v[20:23], a[248:255], v3
  v_smfmac_f32_16x16x64_bf16 v[56:59], v[20:23], v[168:175], v3
  v_smfmac_f32_16x16x64_bf16 v[60:63], v[20:23], v[224:231], v3
  v_smfmac_f32_16x16x64_bf16 v[36:39], v[24:27], a[32:39], v3
  v_smfmac_f32_16x16x64_bf16 v[40:43], v[24:27], a[88:95], v3
  v_smfmac_f32_16x16x64_bf16 v[44:47], v[24:27], a[144:151], v3
  v_smfmac_f32_16x16x64_bf16 v[48:51], v[24:27], a[200:207], v3
  v_smfmac_f32_16x16x64_bf16 v[52:55], v[24:27], v[120:127], v3
  v_smfmac_f32_16x16x64_bf16 v[56:59], v[24:27], v[176:183], v3
  v_smfmac_f32_16x16x64_bf16 v[60:63], v[24:27], v[232:239], v3
  v_smfmac_f32_16x16x64_bf16 v[36:39], v[28:31], a[40:47], v3
  v_smfmac_f32_16x16x64_bf16 v[40:43], v[28:31], a[96:103], v3
  v_smfmac_f32_16x16x64_bf16 v[44:47], v[28:31], a[152:159], v3
  v_smfmac_f32_16x16x64_bf16 v[48:51], v[28:31], a[208:215], v3
  v_smfmac_f32_16x16x64_bf16 v[52:55], v[28:31], v[128:135], v3
  v_smfmac_f32_16x16x64_bf16 v[56:59], v[28:31], v[184:191], v3
  v_smfmac_f32_16x16x64_bf16 v[60:63], v[28:31], v[240:247], v3
  v_smfmac_f32_16x16x64_bf16 v[36:39], v[32:35], a[48:55], v3
  v_smfmac_f32_16x16x64_bf16 v[40:43], v[32:35], a[104:111], v3
  v_smfmac_f32_16x16x64_bf16 v[44:47], v[32:35], a[160:167], v3
  v_smfmac_f32_16x16x64_bf16 v[48:51], v[32:35], a[216:223], v3
  v_smfmac_f32_16x16x64_bf16 v[52:55], v[32:35], v[136:143], v3
  v_smfmac_f32_16x16x64_bf16 v[56:59], v[32:35], v[192:199], v3
  v_smfmac_f32_16x16x64_bf16 v[60:63], v[32:35], v[248:255], v3
  v_permlane32_swap_b32 v36, v38
  v_permlane32_swap_b32 v37, v39
  v_add_f32 v36, v36, v38
  v_add_f32 v37, v37, v39
  v_cvt_pk_bf16_f32 v38, v36, v37
  ds_write_b32 v104, v38
  v_permlane32_swap_b32 v40, v42
  v_permlane32_swap_b32 v41, v43
  v_add_f32 v40, v40, v42
  v_add_f32 v41, v41, v43
  v_cvt_pk_bf16_f32 v42, v40, v41
  ds_write_b32 v105, v42
  v_permlane32_swap_b32 v44, v46
  v_permlane32_swap_b32 v45, v47
  v_add_f32 v44, v44, v46
  v_add_f32 v45, v45, v47
  v_cvt_pk_bf16_f32 v46, v44, v45
  ds_write_b32 v106, v46
  v_permlane32_swap_b32 v48, v50
  v_permlane32_swap_b32 v49, v51
  v_add_f32 v48, v48, v50
  v_add_f32 v49, v49, v51
  v_cvt_pk_bf16_f32 v50, v48, v49
  ds_write_b32 v107, v50
  v_permlane32_swap_b32 v52, v54
  v_permlane32_swap_b32 v53, v55
  v_add_f32 v52, v52, v54
  v_add_f32 v53, v53, v55
  v_cvt_pk_bf16_f32 v54, v52, v53
  ds_write_b32 v108, v54
  v_permlane32_swap_b32 v56, v58
  v_permlane32_swap_b32 v57, v59
  v_add_f32 v56, v56, v58
  v_add_f32 v57, v57, v59
  v_cvt_pk_bf16_f32 v58, v56, v57
  ds_write_b32 v109, v58
  v_permlane32_swap_b32 v60, v62
  v_permlane32_swap_b32 v61, v63
  v_add_f32 v60, v60, v62
  v_add_f32 v61, v61, v63
  v_cvt_pk_bf16_f32 v62, v60, v61
  ds_write_b32 v110, v62
  s_branch cA_va2_t2d
.p2align 6
cA_va3_loop:
  s_mov_b32 s30, 0
  s_barrier
  buffer_load_dwordx4 v[16:19], v2, s[8:11], s20 offen offset:2048 sc1
  buffer_load_dwordx4 v[20:23], v2, s[8:11], s20 offen offset:3072 sc1
  s_barrier
  buffer_load_dword v100, v116, s[8:11], s39 offen sc1
  s_add_u32 s27, s19, 2
  s_min_u32 s27, s27, 63
  s_lshr_b32 s27, s27, 3
  s_lshl_b32 s27, s27, 11
  s_add_u32 s27, s27, s35
  s_cmp_eq_u32 s27, s28
  s_cselect_b32 s29, 75729408, s27
  buffer_load_dword v101, off, s[8:11], s29 sc1
  s_add_u32 s39, s39, 28672
  s_waitcnt vmcnt(2)
  ds_write_b128 v2, v[16:19] offset:10240
  ds_write_b128 v2, v[20:23] offset:11264
  v_smfmac_f32_16x16x64_bf16 v[36:39], v[16:19], a[16:23], v3
  v_smfmac_f32_16x16x64_bf16 v[40:43], v[16:19], a[72:79], v3
  v_smfmac_f32_16x16x64_bf16 v[44:47], v[16:19], a[128:135], v3
  v_smfmac_f32_16x16x64_bf16 v[48:51], v[16:19], a[184:191], v3
  v_smfmac_f32_16x16x64_bf16 v[52:55], v[16:19], a[240:247], v3
  s_waitcnt lgkmcnt(0)
  s_barrier
  ds_read_b128 v[8:11], v2 offset:8192
  ds_read_b128 v[12:15], v2 offset:9216
  ds_read_b128 v[24:27], v2 offset:12288
  ds_read_b128 v[28:31], v2 offset:13312
  ds_read_b128 v[32:35], v2 offset:14336
  v_smfmac_f32_16x16x64_bf16 v[56:59], v[16:19], v[160:167], v3
  v_smfmac_f32_16x16x64_bf16 v[60:63], v[16:19], v[216:223], v3
  v_smfmac_f32_16x16x64_bf16 v[36:39], v[20:23], a[24:31], v3
  v_smfmac_f32_16x16x64_bf16 v[40:43], v[20:23], a[80:87], v3
  v_smfmac_f32_16x16x64_bf16 v[44:47], v[20:23], a[136:143], v3
  v_smfmac_f32_16x16x64_bf16 v[48:51], v[20:23], a[192:199], v3
  v_smfmac_f32_16x16x64_bf16 v[52:55], v[20:23], a[248:255], v3
  v_smfmac_f32_16x16x64_bf16 v[56:59], v[20:23], v[168:175], v3
  v_smfmac_f32_16x16x64_bf16 v[60:63], v[20:23], v[224:231], v3
  s_waitcnt lgkmcnt(4)
  v_smfmac_f32_16x16x64_bf16 v[36:39], v[8:11], a[0:7], v3
  s_waitcnt lgkmcnt(3)
  v_smfmac_f32_16x16x64_bf16 v[36:39], v[12:15], a[8:15], v3
  s_waitcnt lgkmcnt(2)
  v_smfmac_f32_16x16x64_bf16 v[36:39], v[24:27], a[32:39], v3
  s_waitcnt lgkmcnt(1)
  v_smfmac_f32_16x16x64_bf16 v[36:39], v[28:31], a[40:47], v3
  s_waitcnt lgkmcnt(0)
  v_smfmac_f32_16x16x64_bf16 v[36:39], v[32:35], a[48:55], v3
  v_smfmac_f32_16x16x64_bf16 v[40:43], v[8:11], a[56:63], v3
  v_smfmac_f32_16x16x64_bf16 v[40:43], v[12:15], a[64:71], v3
  v_smfmac_f32_16x16x64_bf16 v[40:43], v[24:27], a[88:95], v3
  v_permlane32_swap_b32 v36, v38
  v_smfmac_f32_16x16x64_bf16 v[40:43], v[28:31], a[96:103], v3
  v_permlane32_swap_b32 v37, v39
  v_smfmac_f32_16x16x64_bf16 v[40:43], v[32:35], a[104:111], v3
  v_add_f32 v36, v36, v38
  v_smfmac_f32_16x16x64_bf16 v[44:47], v[8:11], a[112:119], v3
  v_add_f32 v37, v37, v39
  v_smfmac_f32_16x16x64_bf16 v[44:47], v[12:15], a[120:127], v3
  v_cmp_u_f32 vcc, v36, v37
  v_smfmac_f32_16x16x64_bf16 v[44:47], v[24:27], a[144:151], v3
  v_cvt_pk_bf16_f32 v38, v36, v37
  v_smfmac_f32_16x16x64_bf16 v[44:47], v[28:31], a[152:159], v3
  ds_write_b32 v104, v38
  s_cbranch_vccnz cA_va3_slow
  v_permlane32_swap_b32 v40, v42
  v_smfmac_f32_16x16x64_bf16 v[44:47], v[32:35], a[160:167], v3
  v_permlane32_swap_b32 v41, v43
  v_smfmac_f32_16x16x64_bf16 v[48:51], v[8:11], a[168:175], v3
  v_add_f32 v40, v40, v42
  v_smfmac_f32_16x16x64_bf16 v[48:51], v[12:15], a[176:183], v3
  v_add_f32 v41, v41, v43
  v_smfmac_f32_16x16x64_bf16 v[48:51], v[24:27], a[200:207], v3
  v_cvt_pk_bf16_f32 v42, v40, v41
  v_smfmac_f32_16x16x64_bf16 v[48:51], v[28:31], a[208:215], v3
  ds_write_b32 v105, v42
  v_permlane32_swap_b32 v44, v46
  v_smfmac_f32_16x16x64_bf16 v[48:51], v[32:35], a[216:223], v3
  v_permlane32_swap_b32 v45, v47
  v_smfmac_f32_16x16x64_bf16 v[52:55], v[8:11], a[224:231], v3
  v_add_f32 v44, v44, v46
  v_smfmac_f32_16x16x64_bf16 v[52:55], v[12:15], a[232:239], v3
  v_add_f32 v45, v45, v47
  v_smfmac_f32_16x16x64_bf16 v[52:55], v[24:27], v[120:127], v3
  v_cvt_pk_bf16_f32 v46, v44, v45
  v_smfmac_f32_16x16x64_bf16 v[52:55], v[28:31], v[128:135], v3
  ds_write_b32 v106, v46
  v_permlane32_swap_b32 v48, v50
  v_smfmac_f32_16x16x64_bf16 v[52:55], v[32:35], v[136:143], v3
  v_permlane32_swap_b32 v49, v51
  v_smfmac_f32_16x16x64_bf16 v[56:59], v[8:11], v[144:151], v3
  v_add_f32 v48, v48, v50
  v_smfmac_f32_16x16x64_bf16 v[56:59], v[12:15], v[152:159], v3
  v_add_f32 v49, v49, v51
  v_smfmac_f32_16x16x64_bf16 v[56:59], v[24:27], v[176:183], v3
  v_cvt_pk_bf16_f32 v50, v48, v49
  v_smfmac_f32_16x16x64_bf16 v[56:59], v[28:31], v[184:191], v3
  ds_write_b32 v107, v50
  v_permlane32_swap_b32 v52, v54
  v_smfmac_f32_16x16x64_bf16 v[56:59], v[32:35], v[192:199], v3
  v_permlane32_swap_b32 v53, v55
  v_smfmac_f32_16x16x64_bf16 v[60:63], v[8:11], v[200:207], v3
  v_add_f32 v52, v52, v54
  v_smfmac_f32_16x16x64_bf16 v[60:63], v[12:15], v[208:215], v3
  v_add_f32 v53, v53, v55
  v_smfmac_f32_16x16x64_bf16 v[60:63], v[24:27], v[232:239], v3
  v_cvt_pk_bf16_f32 v54, v52, v53
  v_smfmac_f32_16x16x64_bf16 v[60:63], v[28:31], v[240:247], v3
  ds_write_b32 v108, v54
  v_permlane32_swap_b32 v56, v58
  v_smfmac_f32_16x16x64_bf16 v[60:63], v[32:35], v[248:255], v3
  v_permlane32_swap_b32 v57, v59
  v_add_f32 v56, v56, v58
  v_add_f32 v57, v57, v59
  v_cvt_pk_bf16_f32 v58, v56, v57
  ds_write_b32 v109, v58
  s_nop 2
  v_permlane32_swap_b32 v60, v62
  v_permlane32_swap_b32 v61, v63
  v_add_f32 v60, v60, v62
  v_add_f32 v61, v61, v63
  v_cvt_pk_bf16_f32 v62, v60, v61
  ds_write_b32 v110, v62
cA_va3_t2d:
  v_mov_b32 v117, s18
  s_cmp_eq_u32 s27, s28
  s_cbranch_scc1 cA_va3_vok
cA_va3_vow:
  s_waitcnt vmcnt(0)
  v_cmp_ne_u32 vcc, 56, v101
  s_cbranch_vccnz cA_va3_vor
  s_mov_b32 s28, s27
cA_va3_vok:
  s_waitcnt lgkmcnt(0)
  s_setprio 3
  s_barrier
  v_mov_b32 v36, 0
  v_mov_b32 v37, 0
  v_mov_b32 v38, 0
  v_mov_b32 v39, 0
  buffer_store_dword v117, v118, s[8:11], 0 offen
  s_setprio 0
  s_cmp_eq_u32 s19, 62
  s_cbranch_scc1 cA_done
  v_mov_b32 v40, 0
  v_mov_b32 v41, 0
  v_mov_b32 v42, 0
  v_mov_b32 v43, 0
  v_mov_b32 v44, 0
  v_mov_b32 v45, 0
  v_mov_b32 v46, 0
  v_mov_b32 v47, 0
  v_mov_b32 v48, 0
  v_mov_b32 v49, 0
  v_mov_b32 v50, 0
  v_mov_b32 v51, 0
  v_mov_b32 v52, 0
  v_mov_b32 v53, 0
  v_mov_b32 v54, 0
  v_mov_b32 v55, 0
  v_mov_b32 v56, 0
  v_mov_b32 v57, 0
  v_mov_b32 v58, 0
  v_mov_b32 v59, 0
  v_mov_b32 v60, 0
  v_mov_b32 v61, 0
  v_mov_b32 v62, 0
  v_mov_b32 v63, 0
  s_mov_b32 s19, s18
  s_add_u32 s18, s18, 1
  s_mov_b32 s22, s20
  s_mov_b32 s20, s21
  s_mov_b32 s21, s22
  s_add_u32 s23, s20, 4096
  s_branch cA_va3_loop
cA_va3_slow:
  s_waitcnt lgkmcnt(0)
cA_va3_sl1:
  s_add_u32 s31, s31, 0x1000000
  buffer_load_dwordx4 v[8:11], v2, s[8:11], s20 offen offset:0 sc1
  buffer_load_dwordx4 v[12:15], v2, s[8:11], s20 offen offset:1024 sc1
  buffer_load_dwordx4 v[16:19], v2, s[8:11], s20 offen offset:2048 sc1
  buffer_load_dwordx4 v[20:23], v2, s[8:11], s20 offen offset:3072 sc1
  buffer_load_dwordx4 v[24:27], v2, s[8:11], s23 offen offset:0 sc1
  buffer_load_dwordx4 v[28:31], v2, s[8:11], s23 offen offset:1024 sc1
  buffer_load_dwordx4 v[32:35], v2, s[8:11], s23 offen offset:2048 sc1
  s_waitcnt vmcnt(0)
  v_max3_u32 v36, v8, v9, v10
  v_max3_u32 v36, v36, v11, v12
  v_max3_u32 v36, v36, v13, v14
  v_max3_u32 v36, v36, v15, v16
  v_max3_u32 v36, v36, v17, v18
  v_max3_u32 v36, v36, v19, v20
  v_max3_u32 v36, v36, v21, v22
  v_max3_u32 v36, v36, v23, v24
  v_max3_u32 v36, v36, v25, v26
  v_max3_u32 v36, v36, v27, v28
  v_max3_u32 v36, v36, v29, v30
  v_max3_u32 v36, v36, v31, v32
  v_max3_u32 v36, v36, v33, v34
  v_max_u32 v36, v36, v35
  v_cmp_eq_u32 vcc, -1, v36
  s_cbranch_vccz cA_va3_sl2
  s_add_u32 s30, s30, 1
  s_cmp_lt_u32 s30, 400000
  s_cbranch_scc1 cA_va3_sl1
  s_branch cA_abort
cA_va3_sl2:
  v_mov_b32 v36, 0
  v_mov_b32 v37, 0
  v_mov_b32 v38, 0
  v_mov_b32 v39, 0
  v_mov_b32 v40, 0
  v_mov_b32 v41, 0
  v_mov_b32 v42, 0
  v_mov_b32 v43, 0
  v_mov_b32 v44, 0
  v_mov_b32 v45, 0
  v_mov_b32 v46, 0
  v_mov_b32 v47, 0
  v_mov_b32 v48, 0
  v_mov_b32 v49, 0
  v_mov_b32 v50, 0
  v_mov_b32 v51, 0
  v_mov_b32 v52, 0
  v_mov_b32 v53, 0
  v_mov_b32 v54, 0
  v_mov_b32 v55, 0
  v_mov_b32 v56, 0
  v_mov_b32 v57, 0
  v_mov_b32 v58, 0
  v_mov_b32 v59, 0
  v_mov_b32 v60, 0
  v_mov_b32 v61, 0
  v_mov_b32 v62, 0
  v_mov_b32 v63, 0
  v_smfmac_f32_16x16x64_bf16 v[36:39], v[8:11], a[0:7], v3
  v_smfmac_f32_16x16x64_bf16 v[40:43], v[8:11], a[56:63], v3
  v_smfmac_f32_16x16x64_bf16 v[44:47], v[8:11], a[112:119], v3
  v_smfmac_f32_16x16x64_bf16 v[48:51], v[8:11], a[168:175], v3
  v_smfmac_f32_16x16x64_bf16 v[52:55], v[8:11], a[224:231], v3
  v_smfmac_f32_16x16x64_bf16 v[56:59], v[8:11], v[144:151], v3
  v_smfmac_f32_16x16x64_bf16 v[60:63], v[8:11], v[200:207], v3
  v_smfmac_f32_16x16x64_bf16 v[36:39], v[12:15], a[8:15], v3
  v_smfmac_f32_16x16x64_bf16 v[40:43], v[12:15], a[64:71], v3
  v_smfmac_f32_16x16x64_bf16 v[44:47], v[12:15], a[120:127], v3
  v_smfmac_f32_16x16x64_bf16 v[48:51], v[12:15], a[176:183], v3
  v_smfmac_f32_16x16x64_bf16 v[52:55], v[12:15], a[232:239], v3
  v_smfmac_f32_16x16x64_bf16 v[56:59], v[12:15], v[152:159], v3
  v_smfmac_f32_16x16x64_bf16 v[60:63], v[12:15], v[208:215], v3
  v_smfmac_f32_16x16x64_bf16 v[36:39], v[16:19], a[16:23], v3
  v_smfmac_f32_16x16x64_bf16 v[40:43], v[16:19], a[72:79], v3
  v_smfmac_f32_16x16x64_bf16 v[44:47], v[16:19], a[128:135], v3
  v_smfmac_f32_16x16x64_bf16 v[48:51], v[16:19], a[184:191], v3
  v_smfmac_f32_16x16x64_bf16 v[52:55], v[16:19], a[240:247], v3
  v_smfmac_f32_16x16x64_bf16 v[56:59], v[16:19], v[160:167], v3
  v_smfmac_f32_16x16x64_bf16 v[60:63], v[16:19], v[216:223], v3
  v_smfmac_f32_16x16x64_bf16 v[36:39], v[20:23], a[24:31], v3
  v_smfmac_f32_16x16x64_bf16 v[40:43], v[20:23], a[80:87], v3
  v_smfmac_f32_16x16x64_bf16 v[44:47], v[20:23], a[136:143], v3
  v_smfmac_f32_16x16x64_bf16 v[48:51], v[20:23], a[192:199], v3
  v_smfmac_f32_16x16x64_bf16 v[52:55], v[20:23], a[248:255], v3
  v_smfmac_f32_16x16x64_bf16 v[56:59], v[20:23], v[168:175], v3
  v_smfmac_f32_16x16x64_bf16 v[60:63], v[20:23], v[224:231], v3
  v_smfmac_f32_16x16x64_bf16 v[36:39], v[24:27], a[32:39], v3
  v_smfmac_f32_16x16x64_bf16 v[40:43], v[24:27], a[88:95], v3
  v_smfmac_f32_16x16x64_bf16 v[44:47], v[24:27], a[144:151], v3
  v_smfmac_f32_16x16x64_bf16 v[48:51], v[24:27], a[200:207], v3
  v_smfmac_f32_16x16x64_bf16 v[52:55], v[24:27], v[120:127], v3
  v_smfmac_f32_16x16x64_bf16 v[56:59], v[24:27], v[176:183], v3
  v_smfmac_f32_16x16x64_bf16 v[60:63], v[24:27], v[232:239], v3
  v_smfmac_f32_16x16x64_bf16 v[36:39], v[28:31], a[40:47], v3
  v_smfmac_f32_16x16x64_bf16 v[40:43], v[28:31], a[96:103], v3
  v_smfmac_f32_16x16x64_bf16 v[44:47], v[28:31], a[152:159], v3
  v_smfmac_f32_16x16x64_bf16 v[48:51], v[28:31], a[208:215], v3
  v_smfmac_f32_16x16x64_bf16 v[52:55], v[28:31], v[128:135], v3
  v_smfmac_f32_16x16x64_bf16 v[56:59], v[28:31], v[184:191], v3
  v_smfmac_f32_16x16x64_bf16 v[60:63], v[28:31], v[240:247], v3
  v_smfmac_f32_16x16x64_bf16 v[36:39], v[32:35], a[48:55], v3
  v_smfmac_f32_16x16x64_bf16 v[40:43], v[32:35], a[104:111], v3
  v_smfmac_f32_16x16x64_bf16 v[44:47], v[32:35], a[160:167], v3
  v_smfmac_f32_16x16x64_bf16 v[48:51], v[32:35], a[216:223], v3
  v_smfmac_f32_16x16x64_bf16 v[52:55], v[32:35], v[136:143], v3
  v_smfmac_f32_16x16x64_bf16 v[56:59], v[32:35], v[192:199], v3
  v_smfmac_f32_16x16x64_bf16 v[60:63], v[32:35], v[248:255], v3
  v_permlane32_swap_b32 v36, v38
  v_permlane32_swap_b32 v37, v39
  v_add_f32 v36, v36, v38
  v_add_f32 v37, v37, v39
  v_cvt_pk_bf16_f32 v38, v36, v37
  ds_write_b32 v104, v38
  v_permlane32_swap_b32 v40, v42
  v_permlane32_swap_b32 v41, v43
  v_add_f32 v40, v40, v42
  v_add_f32 v41, v41, v43
  v_cvt_pk_bf16_f32 v42, v40, v41
  ds_write_b32 v105, v42
  v_permlane32_swap_b32 v44, v46
  v_permlane32_swap_b32 v45, v47
  v_add_f32 v44, v44, v46
  v_add_f32 v45, v45, v47
  v_cvt_pk_bf16_f32 v46, v44, v45
  ds_write_b32 v106, v46
  v_permlane32_swap_b32 v48, v50
  v_permlane32_swap_b32 v49, v51
  v_add_f32 v48, v48, v50
  v_add_f32 v49, v49, v51
  v_cvt_pk_bf16_f32 v50, v48, v49
  ds_write_b32 v107, v50
  v_permlane32_swap_b32 v52, v54
  v_permlane32_swap_b32 v53, v55
  v_add_f32 v52, v52, v54
  v_add_f32 v53, v53, v55
  v_cvt_pk_bf16_f32 v54, v52, v53
  ds_write_b32 v108, v54
  v_permlane32_swap_b32 v56, v58
  v_permlane32_swap_b32 v57, v59
  v_add_f32 v56, v56, v58
  v_add_f32 v57, v57, v59
  v_cvt_pk_bf16_f32 v58, v56, v57
  ds_write_b32 v109, v58
  v_permlane32_swap_b32 v60, v62
  v_permlane32_swap_b32 v61, v63
  v_add_f32 v60, v60, v62
  v_add_f32 v61, v61, v63
  v_cvt_pk_bf16_f32 v62, v60, v61
  ds_write_b32 v110, v62
  s_branch cA_va3_t2d
cA_va3_vor:
  s_sleep 2
  buffer_load_dword v101, off, s[8:11], s27 sc1
  s_add_u32 s30, s30, 1
  s_cmp_lt_u32 s30, 400000
  s_cbranch_scc1 cA_va3_vow
  s_branch cA_abort
cA_abort:
  v_mov_b32 v4, 0xdead
  v_mov_b32 v5, 16
  buffer_store_dword v4, v5, s[12:15], 0 offen
  s_branch ch_end
cA_done:
  s_branch ch_end
.p2align 6
cB_sc0_loop:
  s_mov_b32 s30, 0
  s_mov_b32 s62, 0
  s_setprio 3
  s_sleep 6
  buffer_load_dword v76, v0, s[8:11], 0 offen sc1
  buffer_load_dword v77, v0, s[8:11], 0 offen sc1
  buffer_load_dword v78, v0, s[8:11], 0 offen sc1
  buffer_load_dword v79, v0, s[8:11], 0 offen sc1
cB_sc0_fp_l:
  s_waitcnt vmcnt(3)
  v_cmp_gt_u32 vcc, s19, v76
  s_cbranch_vccz cB_sc0_fp_d
  buffer_load_dword v76, v0, s[8:11], 0 offen sc1
  s_waitcnt vmcnt(3)
  v_cmp_gt_u32 vcc, s19, v77
  s_cbranch_vccz cB_sc0_fp_d
  buffer_load_dword v77, v0, s[8:11], 0 offen sc1
  s_waitcnt vmcnt(3)
  v_cmp_gt_u32 vcc, s19, v78
  s_cbranch_vccz cB_sc0_fp_d
  buffer_load_dword v78, v0, s[8:11], 0 offen sc1
  s_waitcnt vmcnt(3)
  v_cmp_gt_u32 vcc, s19, v79
  s_cbranch_vccz cB_sc0_fp_d
  buffer_load_dword v79, v0, s[8:11], 0 offen sc1
  s_add_u32 s30, s30, 1
  s_cmp_lt_u32 s30, 400000
  s_cbranch_scc1 cB_sc0_fp_l
  s_branch cB_abort
cB_sc0_fp_d:
  buffer_load_dwordx4 v[8:11], v2, s[8:11], s20 offen offset:0 sc1
  s_barrier
  s_setprio 2
  buffer_load_dwordx4 v[12:15], v2, s[8:11], s20 offen offset:1024 sc1
  s_setprio 1
  buffer_load_dwordx4 v[16:19], v2, s[8:11], s20 offen offset:2048 sc1
  s_setprio 0
  buffer_load_dwordx4 v[20:23], v2, s[8:11], s20 offen offset:3072 sc1
cB_sc0_go:
  s_waitcnt vmcnt(3)
  v_smfmac_f32_16x16x64_bf16 v[36:39], v[8:11], a[0:7], v3
  buffer_load_dwordx4 v[32:35], v2, s[8:11], s23 offen offset:0 sc1
  v_cmp_eq_u32 vcc, -1, v8
  v_smfmac_f32_16x16x64_bf16 v[40:43], v[8:11], a[56:63], v3
  v_smfmac_f32_16x16x64_bf16 v[44:47], v[8:11], a[112:119], v3
  buffer_load_dwordx4 v[24:27], v2, s[8:11], s23 offen offset:1024 sc1
  s_cbranch_vccnz cB_sc0_r0
  v_smfmac_f32_16x16x64_bf16 v[48:51], v[8:11], a[168:175], v3
  v_smfmac_f32_16x16x64_bf16 v[52:55], v[8:11], a[224:231], v3
  s_waitcnt vmcnt(4)
  v_cmp_eq_u32 vcc, -1, v12
  v_smfmac_f32_16x16x64_bf16 v[56:59], v[8:11], v[144:151], v3
  buffer_load_dwordx4 v[28:31], v2, s[8:11], s23 offen offset:2048 sc1
  v_smfmac_f32_16x16x64_bf16 v[60:63], v[8:11], v[200:207], v3
  s_cbranch_vccnz cB_sc0_r1
cB_sc0_c1:
  v_smfmac_f32_16x16x64_bf16 v[36:39], v[12:15], a[8:15], v3
  v_smfmac_f32_16x16x64_bf16 v[40:43], v[12:15], a[64:71], v3
  v_smfmac_f32_16x16x64_bf16 v[44:47], v[12:15], a[120:127], v3
  v_smfmac_f32_16x16x64_bf16 v[48:51], v[12:15], a[176:183], v3
  v_smfmac_f32_16x16x64_bf16 v[52:55], v[12:15], a[232:239], v3
  s_waitcnt vmcnt(4)
  v_cmp_eq_u32 vcc, -1, v16
  v_smfmac_f32_16x16x64_bf16 v[56:59], v[12:15], v[152:159], v3
  buffer_load_dwordx4 v[88:91], v117, s[8:11], s26 offen offset:0 sc1
  v_smfmac_f32_16x16x64_bf16 v[60:63], v[12:15], v[208:215], v3
  s_cbranch_vccnz cB_sc0_r2
cB_sc0_c2:
  v_smfmac_f32_16x16x64_bf16 v[36:39], v[16:19], a[16:23], v3
  v_smfmac_f32_16x16x64_bf16 v[40:43], v[16:19], a[72:79], v3
  v_smfmac_f32_16x16x64_bf16 v[44:47], v[16:19], a[128:135], v3
  buffer_load_dwordx4 v[92:95], v117, s[8:11], s26 offen offset:1024 sc1
  v_smfmac_f32_16x16x64_bf16 v[48:51], v[16:19], a[184:191], v3
  v_smfmac_f32_16x16x64_bf16 v[52:55], v[16:19], a[240:247], v3
  s_waitcnt vmcnt(5)
  v_cmp_eq_u32 vcc, -1, v20
  v_smfmac_f32_16x16x64_bf16 v[56:59], v[16:19], v[160:167], v3
  v_smfmac_f32_16x16x64_bf16 v[60:63], v[16:19], v[216:223], v3
  buffer_load_dwordx4 v[96:99], v2, s[8:11], s24 offen offset:0 sc1
  s_cbranch_vccnz cB_sc0_r3
cB_sc0_c3:
  v_smfmac_f32_16x16x64_bf16 v[36:39], v[20:23], a[24:31], v3
  v_smfmac_f32_16x16x64_bf16 v[40:43], v[20:23], a[80:87], v3
  s_waitcnt vmcnt(3)
  v_max3_u32 v66, v24, v27, v28
  v_smfmac_f32_16x16x64_bf16 v[44:47], v[20:23], a[136:143], v3
  v_max3_u32 v66, v66, v31, v32
  v_smfmac_f32_16x16x64_bf16 v[48:51], v[20:23], a[192:199], v3
  buffer_load_dwordx4 v[100:103], v2, s[8:11], s24 offen offset:1024 sc1
  v_max_u32 v66, v66, v35
  v_smfmac_f32_16x16x64_bf16 v[52:55], v[20:23], a[248:255], v3
  v_cmp_eq_u32 vcc, -1, v66
  v_smfmac_f32_16x16x64_bf16 v[56:59], v[20:23], v[168:175], v3
  v_smfmac_f32_16x16x64_bf16 v[60:63], v[20:23], v[224:231], v3
  s_cbranch_vccnz cB_sc0_r4
cB_sc0_c4:
  v_smfmac_f32_16x16x64_bf16 v[60:63], v[32:35], v[232:239], v3
  buffer_load_dwordx4 v[104:107], v2, s[8:11], s26 offen offset:0 sc1
  v_smfmac_f32_16x16x64_bf16 v[60:63], v[24:27], v[240:247], v3
  v_smfmac_f32_16x16x64_bf16 v[60:63], v[28:31], v[248:255], v3
  v_smfmac_f32_16x16x64_bf16 v[52:55], v[32:35], v[120:127], v3
  v_smfmac_f32_16x16x64_bf16 v[52:55], v[24:27], v[128:135], v3
  buffer_load_dwordx4 v[108:111], v2, s[8:11], s26 offen offset:1024 sc1
  v_smfmac_f32_16x16x64_bf16 v[52:55], v[28:31], v[136:143], v3
  v_cvt_pk_bf16_f32 v63, v62, v63
  v_smfmac_f32_16x16x64_bf16 v[56:59], v[32:35], v[176:183], v3
  v_cvt_pk_bf16_f32 v62, v60, v61
  v_smfmac_f32_16x16x64_bf16 v[56:59], v[24:27], v[184:191], v3
  v_mfma_f32_16x16x32_bf16 v[12:15], v[62:65], v[4:7], 0
  v_cvt_pk_bf16_f32 v55, v54, v55
  v_smfmac_f32_16x16x64_bf16 v[56:59], v[28:31], v[192:199], v3
  v_cvt_pk_bf16_f32 v54, v52, v53
  v_smfmac_f32_16x16x64_bf16 v[36:39], v[32:35], a[32:39], v3
  s_nop 1
  v_cvt_pk_bf16_f32 v76, v12, v13
  v_smfmac_f32_16x16x64_bf16 v[36:39], v[24:27], a[40:47], v3
  v_cvt_pk_bf16_f32 v77, v14, v15
  v_smfmac_f32_16x16x64_bf16 v[36:39], v[28:31], a[48:55], v3
  v_cvt_pk_bf16_f32 v56, v56, v57
  v_smfmac_f32_16x16x64_bf16 v[40:43], v[32:35], a[88:95], v3
  v_cvt_pk_bf16_f32 v57, v58, v59
  v_smfmac_f32_16x16x64_bf16 v[40:43], v[24:27], a[96:103], v3
  v_mfma_f32_16x16x32_bf16 v[16:19], v[54:57], v[4:7], 0
  v_cvt_pk_bf16_f32 v39, v38, v39
  v_smfmac_f32_16x16x64_bf16 v[40:43], v[28:31], a[104:111], v3
  v_cvt_pk_bf16_f32 v38, v36, v37
  v_smfmac_f32_16x16x64_bf16 v[44:47], v[32:35], a[144:151], v3
  s_nop 1
  v_cvt_pk_bf16_f32 v78, v16, v17
  v_smfmac_f32_16x16x64_bf16 v[44:47], v[24:27], a[152:159], v3
  v_cvt_pk_bf16_f32 v79, v18, v19
  v_smfmac_f32_16x16x64_bf16 v[44:47], v[28:31], a[160:167], v3
  v_cvt_pk_bf16_f32 v40, v40, v41
  v_smfmac_f32_16x16x64_bf16 v[48:51], v[32:35], a[200:207], v3
  v_cvt_pk_bf16_f32 v41, v42, v43
  v_smfmac_f32_16x16x64_bf16 v[48:51], v[24:27], a[208:215], v3
  v_smfmac_f32_16x16x64_bf16 v[48:51], v[28:31], a[216:223], v3
  s_waitcnt vmcnt(4)
  v_cvt_pk_bf16_f32 v47, v46, v47
  v_smfmac_f32_16x16x64_bf16 v[68:71], v[76:79], v[80:87], v3
  v_cvt_pk_bf16_f32 v46, v44, v45
  v_mfma_f32_16x16x32_bf16 v[12:15], v[38:41], v[4:7], 0
  s_nop 1
  v_cvt_pk_bf16_f32 v48, v48, v49
  v_cvt_pk_bf16_f32 v49, v50, v51
  s_nop 1
  v_mfma_f32_16x16x32_bf16 v[16:19], v[46:49], v[4:7], 0
  v_smfmac_f32_16x16x64_bf16 v[72:75], v[76:79], v[88:95], v3
  v_cvt_pk_bf16_f32 v20, v12, v13
  v_mfma_f32_16x16x32_bf16 v[52:55], v[30:33], v[76:79], 0
  s_waitcnt vmcnt(0)
  v_cvt_pk_bf16_f32 v21, v14, v15
  v_cvt_pk_bf16_f32 v22, v16, v17
  v_cvt_pk_bf16_f32 v23, v18, v19
  s_nop 1
  v_mfma_f32_16x16x32_bf16 v[52:55], v[8:11], v[20:23], v[52:55]
  v_smfmac_f32_16x16x64_bf16 v[68:71], v[20:23], v[96:103], v3
  v_smfmac_f32_16x16x64_bf16 v[72:75], v[20:23], v[104:111], v3
  s_nop 1
  ds_write_b128 v113, v[52:55]
  s_nop 1
  v_permlane32_swap_b32 v68, v70
  v_permlane32_swap_b32 v69, v71
  v_add_f32 v56, v68, v70
  v_add_f32 v58, v69, v71
  v_permlane32_swap_b32 v72, v74
  v_permlane32_swap_b32 v73, v75
  v_add_f32 v57, v72, v74
  v_add_f32 v59, v73, v75
  ds_write_b128 v2, v[56:59] offset:0
  v_cmp_u_f32 vcc, v57, v59
  v_mov_b32 v68, 0
  v_mov_b32 v69, 0
  v_mov_b32 v70, 0
  v_mov_b32 v71, 0
  s_cbranch_vccnz cB_sc0_retry
cB_sc0_cont:
  s_add_u32 s24, s24, 28672
  s_add_u32 s26, s26, 28672
  buffer_load_dwordx4 v[80:83], v117, s[8:11], s24 offen offset:0 sc1
  buffer_load_dwordx4 v[84:87], v117, s[8:11], s24 offen offset:1024 sc1
  v_mov_b32 v72, 0
  v_mov_b32 v73, 0
  v_mfma_f32_32x32x16_bf16 v[36:51], v[68:71], v[68:71], 0
  s_waitcnt lgkmcnt(0)
  s_barrier
  ds_read_b64 v[8:9], v114 offset:0
  ds_read_b64 v[10:11], v114 offset:1024
  ds_read_b64 v[12:13], v114 offset:2048
  ds_read_b64 v[14:15], v114 offset:3072
  ds_read2_b32 v[16:17], v115 offset0:0 offset1:64
  ds_read2_b32 v[18:19], v115 offset0:128 offset1:192
  v_mfma_f32_32x32x16_bf16 v[52:67], v[68:71], v[68:71], 0
  s_waitcnt lgkmcnt(0)
  v_pk_add_f32 v[16:17], v[16:17], v[18:19]
  v_pk_add_f32 v[8:9], v[8:9], v[10:11]
  v_pk_add_f32 v[12:13], v[12:13], v[14:15]
  v_add_f32 v20, v16, v17
  v_pk_add_f32 v[8:9], v[8:9], v[12:13]
  v_max_f32 v22, v8, v9
  v_add_f32_dpp v20, v20, v20 row_ror:8 row_mask:0xf bank_mask:0xf
  s_nop 0
  v_max_f32_dpp v22, v22, v22 row_ror:8 row_mask:0xf bank_mask:0xf
  v_max_f32 v22, v22, v20
  s_nop 1
  v_max_f32_dpp v22, v22, v22 quad_perm:[1,0,3,2] row_mask:0xf bank_mask:0xf
  s_nop 1
  v_max_f32_dpp v22, v22, v22 quad_perm:[2,3,0,1] row_mask:0xf bank_mask:0xf
  s_nop 1
  v_max_f32_dpp v22, v22, v22 row_half_mirror row_mask:0xf bank_mask:0xf
  v_pk_add_f32 v[8:9], v[8:9], v[22:23] op_sel_hi:[1,0] neg_lo:[0,1] neg_hi:[0,1]
  v_sub_f32 v20, v20, v22
  v_exp_f32 v8, v8
  v_exp_f32 v9, v9
  v_exp_f32 v20, v20
  v_add_f32 v24, v8, v9
  v_fmac_f32 v24, 0.5, v20
  v_mov_b32_dpp v21, v20 quad_perm:[1,0,3,2] row_mask:0xf bank_mask:0xf
  s_nop 0
  v_add_f32_dpp v24, v24, v24 quad_perm:[1,0,3,2] row_mask:0xf bank_mask:0xf
  s_nop 1
  v_add_f32_dpp v24, v24, v24 quad_perm:[2,3,0,1] row_mask:0xf bank_mask:0xf
  s_nop 1
  v_add_f32_dpp v24, v24, v24 row_half_mirror row_mask:0xf bank_mask:0xf
  s_nop 1
  v_add_f32_dpp v24, v24, v24 row_ror:8 row_mask:0xf bank_mask:0xf
  v_rcp_f32 v24, v24
  s_nop 0
  v_pk_mul_f32 v[8:9], v[8:9], v[24:25] op_sel_hi:[1,0]
  v_pk_mul_f32 v[20:21], v[20:21], v[24:25] op_sel_hi:[1,0]
  v_cvt_pk_bf16_f32 v8, v8, v9
  v_cvt_pk_bf16_f32 v20, v20, v21
  v_min_u32 v8, -2, v8
  buffer_store_dword v8, v1, s[8:11], s20 offen sc1
  v_min_u32 v20, -2, v20
  buffer_store_dword v20, v118, s[8:11], s20 offen sc1
  buffer_store_dword v119, v1, s[8:11], s21 offen sc1
  buffer_store_dword v119, v118, s[8:11], s21 offen sc1
  v_mov_b32 v74, 0
  v_mov_b32 v75, 0
  s_mov_b32 s19, s18
  s_add_u32 s18, s18, 1
  s_mov_b32 s22, s20
  s_mov_b32 s20, s21
  s_mov_b32 s21, s22
  s_add_u32 s23, s20, 4096
  s_cmp_lt_u32 s19, 63
  s_cbranch_scc1 cB_sc0_loop
  s_branch cB_done
cB_sc0_r0:
  s_add_u32 s31, s31, 1
  buffer_load_dwordx4 v[8:11], v2, s[8:11], s20 offen offset:0 sc1
  s_waitcnt vmcnt(0)
  v_cmp_eq_u32 vcc, -1, v8
  v_mov_b32 v36, 0
  v_mov_b32 v37, 0
  v_mov_b32 v38, 0
  v_mov_b32 v39, 0
  v_mov_b32 v40, 0
  v_mov_b32 v41, 0
  v_mov_b32 v42, 0
  v_mov_b32 v43, 0
  v_mov_b32 v44, 0
  v_mov_b32 v45, 0
  v_mov_b32 v46, 0
  v_mov_b32 v47, 0
  v_mov_b32 v48, 0
  v_mov_b32 v49, 0
  v_mov_b32 v50, 0
  v_mov_b32 v51, 0
  s_nop 1
  s_cbranch_vccz cB_sc0_go
  s_add_u32 s30, s30, 1
  s_cmp_lt_u32 s30, 400000
  s_cbranch_scc1 cB_sc0_r0
  s_branch cB_abort
cB_sc0_r1:
  s_add_u32 s31, s31, 1
  buffer_load_dwordx4 v[12:15], v2, s[8:11], s20 offen offset:1024 sc1
  s_waitcnt vmcnt(0)
  v_cmp_eq_u32 vcc, -1, v12
  s_nop 4
  s_cbranch_vccz cB_sc0_c1
  s_add_u32 s30, s30, 1
  s_cmp_lt_u32 s30, 400000
  s_cbranch_scc1 cB_sc0_r1
  s_branch cB_abort
cB_sc0_r2:
  s_add_u32 s31, s31, 1
  buffer_load_dwordx4 v[16:19], v2, s[8:11], s20 offen offset:2048 sc1
  s_waitcnt vmcnt(0)
  v_cmp_eq_u32 vcc, -1, v16
  s_nop 4
  s_cbranch_vccz cB_sc0_c2
  s_add_u32 s30, s30, 1
  s_cmp_lt_u32 s30, 400000
  s_cbranch_scc1 cB_sc0_r2
  s_branch cB_abort
cB_sc0_r3:
  s_add_u32 s31, s31, 1
  buffer_load_dwordx4 v[20:23], v2, s[8:11], s20 offen offset:3072 sc1
  s_waitcnt vmcnt(0)
  v_cmp_eq_u32 vcc, -1, v20
  s_nop 4
  s_cbranch_vccz cB_sc0_c3
  s_add_u32 s30, s30, 1
  s_cmp_lt_u32 s30, 400000
  s_cbranch_scc1 cB_sc0_r3
  s_branch cB_abort
cB_sc0_r4:
  s_add_u32 s31, s31, 1
  buffer_load_dwordx4 v[32:35], v2, s[8:11], s23 offen offset:0 sc1
  buffer_load_dwordx4 v[24:27], v2, s[8:11], s23 offen offset:1024 sc1
  buffer_load_dwordx4 v[28:31], v2, s[8:11], s23 offen offset:2048 sc1
  s_waitcnt vmcnt(0)
  v_max3_u32 v66, v24, v27, v28
  v_max3_u32 v66, v66, v31, v32
  v_max_u32 v66, v66, v35
  v_cmp_eq_u32 vcc, -1, v66
  s_nop 4
  s_cbranch_vccz cB_sc0_c4
  s_add_u32 s30, s30, 1
  s_cmp_lt_u32 s30, 400000
  s_cbranch_scc1 cB_sc0_r4
  s_branch cB_abort
cB_sc0_retry:
  s_cmp_lg_u32 s62, 0
  s_cbranch_scc1 cB_sc0_cont
  s_waitcnt vmcnt(0) lgkmcnt(0)
cB_sc0_rv:
  buffer_load_dwordx4 v[8:11], v2, s[8:11], s20 offen offset:0 sc1
  buffer_load_dwordx4 v[12:15], v2, s[8:11], s20 offen offset:1024 sc1
  buffer_load_dwordx4 v[16:19], v2, s[8:11], s20 offen offset:2048 sc1
  buffer_load_dwordx4 v[20:23], v2, s[8:11], s20 offen offset:3072 sc1
  buffer_load_dwordx4 v[32:35], v2, s[8:11], s23 offen offset:0 sc1
  buffer_load_dwordx4 v[24:27], v2, s[8:11], s23 offen offset:1024 sc1
  buffer_load_dwordx4 v[28:31], v2, s[8:11], s23 offen offset:2048 sc1
  s_waitcnt vmcnt(0)
  v_pk_max_u16 v66, v8, v9
  v_pk_max_u16 v66, v66, v10
  v_pk_max_u16 v66, v66, v11
  v_pk_max_u16 v66, v66, v12
  v_pk_max_u16 v66, v66, v13
  v_pk_max_u16 v66, v66, v14
  v_pk_max_u16 v66, v66, v15
  v_pk_max_u16 v66, v66, v16
  v_pk_max_u16 v66, v66, v17
  v_pk_max_u16 v66, v66, v18
  v_pk_max_u16 v66, v66, v19
  v_pk_max_u16 v66, v66, v20
  v_pk_max_u16 v66, v66, v21
  v_pk_max_u16 v66, v66, v22
  v_pk_max_u16 v66, v66, v23
  v_pk_max_u16 v66, v66, v24
  v_pk_max_u16 v66, v66, v25
  v_pk_max_u16 v66, v66, v26
  v_pk_max_u16 v66, v66, v27
  v_pk_max_u16 v66, v66, v28
  v_pk_max_u16 v66, v66, v29
  v_pk_max_u16 v66, v66, v30
  v_pk_max_u16 v66, v66, v31
  v_pk_max_u16 v66, v66, v32
  v_pk_max_u16 v66, v66, v33
  v_pk_max_u16 v66, v66, v34
  v_pk_max_u16 v66, v66, v35
  v_lshlrev_b32 v67, 16, v66
  v_max_u32 v66, v66, v67
  v_cmp_le_u32 vcc, 0xffff0000, v66
  s_cbranch_vccz cB_sc0_rk
  s_add_u32 s30, s30, 1
  s_cmp_lt_u32 s30, 400000
  s_cbranch_scc1 cB_sc0_rv
  s_branch cB_abort
cB_sc0_rk:
  s_mov_b32 s62, 1
  v_mov_b32 v36, 0
  v_mov_b32 v37, 0
  v_mov_b32 v38, 0
  v_mov_b32 v39, 0
  v_mov_b32 v40, 0
  v_mov_b32 v41, 0
  v_mov_b32 v42, 0
  v_mov_b32 v43, 0
  v_mov_b32 v44, 0
  v_mov_b32 v45, 0
  v_mov_b32 v46, 0
  v_mov_b32 v47, 0
  v_mov_b32 v48, 0
  v_mov_b32 v49, 0
  v_mov_b32 v50, 0
  v_mov_b32 v51, 0
  v_mov_b32 v60, 0
  v_mov_b32 v61, 0
  v_mov_b32 v62, 0
  v_mov_b32 v63, 0
  v_mov_b32 v68, 0
  v_mov_b32 v69, 0
  v_mov_b32 v70, 0
  v_mov_b32 v71, 0
  v_mov_b32 v72, 0
  v_mov_b32 v73, 0
  v_mov_b32 v74, 0
  v_mov_b32 v75, 0
  v_mov_b32 v52, 0
  v_mov_b32 v53, 0
  v_mov_b32 v54, 0
  v_mov_b32 v55, 0
  v_mov_b32 v56, 0
  v_mov_b32 v57, 0
  v_mov_b32 v58, 0
  v_mov_b32 v59, 0
  s_add_u32 s31, s31, 0x100
  s_nop 0
  s_branch cB_sc0_go
.p2align 6
cB_sc1_loop:
  s_mov_b32 s30, 0
  s_mov_b32 s62, 0
  s_setprio 3
  s_barrier
  buffer_load_dwordx4 v[8:11], v2, s[8:11], s20 offen offset:0 sc1
  s_setprio 2
  buffer_load_dwordx4 v[12:15], v2, s[8:11], s20 offen offset:1024 sc1
  s_setprio 1
  buffer_load_dwordx4 v[16:19], v2, s[8:11], s20 offen offset:2048 sc1
  s_setprio 0
  buffer_load_dwordx4 v[20:23], v2, s[8:11], s20 offen offset:3072 sc1
cB_sc1_go:
  s_waitcnt vmcnt(3)
  v_smfmac_f32_16x16x64_bf16 v[36:39], v[8:11], a[0:7], v3
  buffer_load_dwordx4 v[28:31], v2, s[8:11], s23 offen offset:0 sc1
  v_cmp_eq_u32 vcc, -1, v8
  v_smfmac_f32_16x16x64_bf16 v[40:43], v[8:11], a[56:63], v3
  v_smfmac_f32_16x16x64_bf16 v[44:47], v[8:11], a[112:119], v3
  buffer_load_dwordx4 v[24:27], v2, s[8:11], s23 offen offset:1024 sc1
  s_cbranch_vccnz cB_sc1_r0
  v_smfmac_f32_16x16x64_bf16 v[48:51], v[8:11], a[168:175], v3
  v_smfmac_f32_16x16x64_bf16 v[52:55], v[8:11], a[224:231], v3
  s_waitcnt vmcnt(4)
  v_cmp_eq_u32 vcc, -1, v12
  v_smfmac_f32_16x16x64_bf16 v[56:59], v[8:11], v[144:151], v3
  buffer_load_dwordx4 v[32:35], v2, s[8:11], s23 offen offset:2048 sc1
  v_smfmac_f32_16x16x64_bf16 v[60:63], v[8:11], v[200:207], v3
  s_cbranch_vccnz cB_sc1_r1
cB_sc1_c1:
  v_smfmac_f32_16x16x64_bf16 v[36:39], v[12:15], a[8:15], v3
  v_smfmac_f32_16x16x64_bf16 v[40:43], v[12:15], a[64:71], v3
  v_smfmac_f32_16x16x64_bf16 v[44:47], v[12:15], a[120:127], v3
  v_smfmac_f32_16x16x64_bf16 v[48:51], v[12:15], a[176:183], v3
  v_smfmac_f32_16x16x64_bf16 v[52:55], v[12:15], a[232:239], v3
  s_waitcnt vmcnt(4)
  v_cmp_eq_u32 vcc, -1, v16
  v_smfmac_f32_16x16x64_bf16 v[56:59], v[12:15], v[152:159], v3
  buffer_load_dwordx4 v[88:91], v117, s[8:11], s26 offen offset:0 sc1
  v_smfmac_f32_16x16x64_bf16 v[60:63], v[12:15], v[208:215], v3
  s_cbranch_vccnz cB_sc1_r2
cB_sc1_c2:
  v_smfmac_f32_16x16x64_bf16 v[36:39], v[16:19], a[16:23], v3
  v_smfmac_f32_16x16x64_bf16 v[40:43], v[16:19], a[72:79], v3
  v_smfmac_f32_16x16x64_bf16 v[44:47], v[16:19], a[128:135], v3
  buffer_load_dwordx4 v[92:95], v117, s[8:11], s26 offen offset:1024 sc1
  v_smfmac_f32_16x16x64_bf16 v[48:51], v[16:19], a[184:191], v3
  v_smfmac_f32_16x16x64_bf16 v[52:55], v[16:19], a[240:247], v3
  s_waitcnt vmcnt(5)
  v_cmp_eq_u32 vcc, -1, v20
  v_smfmac_f32_16x16x64_bf16 v[56:59], v[16:19], v[160:167], v3
  v_smfmac_f32_16x16x64_bf16 v[60:63], v[16:19], v[216:223], v3
  buffer_load_dwordx4 v[96:99], v2, s[8:11], s24 offen offset:0 sc1
  s_cbranch_vccnz cB_sc1_r3
cB_sc1_c3:
  v_smfmac_f32_16x16x64_bf16 v[36:39], v[20:23], a[24:31], v3
  v_smfmac_f32_16x16x64_bf16 v[40:43], v[20:23], a[80:87], v3
  s_waitcnt vmcnt(3)
  v_max3_u32 v66, v24, v27, v28
  v_smfmac_f32_16x16x64_bf16 v[44:47], v[20:23], a[136:143], v3
  v_max3_u32 v66, v66, v31, v32
  v_smfmac_f32_16x16x64_bf16 v[48:51], v[20:23], a[192:199], v3
  buffer_load_dwordx4 v[100:103], v2, s[8:11], s24 offen offset:1024 sc1
  v_max_u32 v66, v66, v35
  v_smfmac_f32_16x16x64_bf16 v[52:55], v[20:23], a[248:255], v3
  v_cmp_eq_u32 vcc, -1, v66
  v_smfmac_f32_16x16x64_bf16 v[56:59], v[20:23], v[168:175], v3
  v_smfmac_f32_16x16x64_bf16 v[60:63], v[20:23], v[224:231], v3
  s_cbranch_vccnz cB_sc1_r4
cB_sc1_c4:
  v_smfmac_f32_16x16x64_bf16 v[60:63], v[28:31], v[232:239], v3
  buffer_load_dwordx4 v[104:107], v2, s[8:11], s26 offen offset:0 sc1
  v_smfmac_f32_16x16x64_bf16 v[60:63], v[24:27], v[240:247], v3
  v_smfmac_f32_16x16x64_bf16 v[60:63], v[32:35], v[248:255], v3
  v_smfmac_f32_16x16x64_bf16 v[52:55], v[28:31], v[120:127], v3
  v_smfmac_f32_16x16x64_bf16 v[52:55], v[24:27], v[128:135], v3
  buffer_load_dwordx4 v[108:111], v2, s[8:11], s26 offen offset:1024 sc1
  v_smfmac_f32_16x16x64_bf16 v[52:55], v[32:35], v[136:143], v3
  v_cvt_pk_bf16_f32 v63, v62, v63
  v_smfmac_f32_16x16x64_bf16 v[56:59], v[28:31], v[176:183], v3
  v_cvt_pk_bf16_f32 v62, v60, v61
  v_smfmac_f32_16x16x64_bf16 v[56:59], v[24:27], v[184:191], v3
  v_mfma_f32_16x16x32_bf16 v[8:11], v[62:65], v[4:7], 0
  v_cvt_pk_bf16_f32 v55, v54, v55
  v_smfmac_f32_16x16x64_bf16 v[56:59], v[32:35], v[192:199], v3
  v_cvt_pk_bf16_f32 v54, v52, v53
  v_smfmac_f32_16x16x64_bf16 v[36:39], v[28:31], a[32:39], v3
  s_nop 1
  v_cvt_pk_bf16_f32 v78, v8, v9
  v_smfmac_f32_16x16x64_bf16 v[36:39], v[24:27], a[40:47], v3
  v_cvt_pk_bf16_f32 v79, v10, v11
  v_smfmac_f32_16x16x64_bf16 v[36:39], v[32:35], a[48:55], v3
  v_cvt_pk_bf16_f32 v56, v56, v57
  v_smfmac_f32_16x16x64_bf16 v[40:43], v[28:31], a[88:95], v3
  v_cvt_pk_bf16_f32 v57, v58, v59
  v_smfmac_f32_16x16x64_bf16 v[40:43], v[24:27], a[96:103], v3
  v_mfma_f32_16x16x32_bf16 v[16:19], v[54:57], v[4:7], 0
  v_cvt_pk_bf16_f32 v39, v38, v39
  v_smfmac_f32_16x16x64_bf16 v[40:43], v[32:35], a[104:111], v3
  v_cvt_pk_bf16_f32 v38, v36, v37
  v_smfmac_f32_16x16x64_bf16 v[44:47], v[28:31], a[144:151], v3
  s_nop 1
  v_cvt_pk_bf16_f32 v76, v16, v17
  v_smfmac_f32_16x16x64_bf16 v[44:47], v[24:27], a[152:159], v3
  v_cvt_pk_bf16_f32 v77, v18, v19
  v_smfmac_f32_16x16x64_bf16 v[44:47], v[32:35], a[160:167], v3
  v_cvt_pk_bf16_f32 v40, v40, v41
  v_smfmac_f32_16x16x64_bf16 v[48:51], v[28:31], a[200:207], v3
  v_cvt_pk_bf16_f32 v41, v42, v43
  v_smfmac_f32_16x16x64_bf16 v[48:51], v[24:27], a[208:215], v3
  v_smfmac_f32_16x16x64_bf16 v[48:51], v[32:35], a[216:223], v3
  s_waitcnt vmcnt(4)
  v_cvt_pk_bf16_f32 v47, v46, v47
  v_smfmac_f32_16x16x64_bf16 v[68:71], v[76:79], v[80:87], v3
  v_cvt_pk_bf16_f32 v46, v44, v45
  v_mfma_f32_16x16x32_bf16 v[8:11], v[38:41], v[4:7], 0
  s_nop 1
  v_cvt_pk_bf16_f32 v48, v48, v49
  v_cvt_pk_bf16_f32 v49, v50, v51
  s_nop 1
  v_mfma_f32_16x16x32_bf16 v[16:19], v[46:49], v[4:7], 0
  v_smfmac_f32_16x16x64_bf16 v[72:75], v[76:79], v[88:95], v3
  v_cvt_pk_bf16_f32 v20, v8, v9
  v_mfma_f32_16x16x32_bf16 v[52:55], v[30:33], v[76:79], 0
  s_waitcnt vmcnt(0)
  v_cvt_pk_bf16_f32 v21, v10, v11
  v_cvt_pk_bf16_f32 v22, v16, v17
  v_cvt_pk_bf16_f32 v23, v18, v19
  s_nop 1
  v_mfma_f32_16x16x32_bf16 v[52:55], v[12:15], v[20:23], v[52:55]
  v_smfmac_f32_16x16x64_bf16 v[68:71], v[20:23], v[96:103], v3
  v_smfmac_f32_16x16x64_bf16 v[72:75], v[20:23], v[104:111], v3
  s_nop 1
  ds_write_b128 v113, v[52:55]
  s_nop 1
  v_permlane32_swap_b32 v68, v70
  v_permlane32_swap_b32 v69, v71
  v_add_f32 v56, v68, v70
  v_add_f32 v58, v69, v71
  v_permlane32_swap_b32 v72, v74
  v_permlane32_swap_b32 v73, v75
  v_add_f32 v57, v72, v74
  v_add_f32 v59, v73, v75
  ds_write_b128 v2, v[56:59] offset:1024
  v_cmp_u_f32 vcc, v57, v59
  v_mov_b32 v68, 0
  v_mov_b32 v69, 0
  v_mov_b32 v70, 0
  v_mov_b32 v71, 0
  s_cbranch_vccnz cB_sc1_retry
cB_sc1_cont:
  s_add_u32 s24, s24, 28672
  s_add_u32 s26, s26, 28672
  buffer_load_dwordx4 v[80:83], v117, s[8:11], s24 offen offset:0 sc1
  buffer_load_dwordx4 v[84:87], v117, s[8:11], s24 offen offset:1024 sc1
  v_mov_b32 v72, 0
  v_mov_b32 v73, 0
  v_mfma_f32_32x32x16_bf16 v[36:51], v[68:71], v[68:71], 0
  s_waitcnt lgkmcnt(0)
  s_barrier
  ds_read_b64 v[8:9], v114 offset:0
  ds_read_b64 v[10:11], v114 offset:1024
  ds_read_b64 v[12:13], v114 offset:2048
  ds_read_b64 v[14:15], v114 offset:3072
  ds_read2_b32 v[16:17], v115 offset0:0 offset1:64
  ds_read2_b32 v[18:19], v115 offset0:128 offset1:192
  v_mfma_f32_32x32x16_bf16 v[52:67], v[68:71], v[68:71], 0
  s_waitcnt lgkmcnt(0)
  v_pk_add_f32 v[16:17], v[16:17], v[18:19]
  v_pk_add_f32 v[8:9], v[8:9], v[10:11]
  v_pk_add_f32 v[12:13], v[12:13], v[14:15]
  v_add_f32 v20, v16, v17
  v_pk_add_f32 v[8:9], v[8:9], v[12:13]
  v_max_f32 v22, v8, v9
  v_add_f32_dpp v20, v20, v20 row_ror:8 row_mask:0xf bank_mask:0xf
  s_nop 0
  v_max_f32_dpp v22, v22, v22 row_ror:8 row_mask:0xf bank_mask:0xf
  v_max_f32 v22, v22, v20
  s_nop 1
  v_max_f32_dpp v22, v22, v22 quad_perm:[1,0,3,2] row_mask:0xf bank_mask:0xf
  s_nop 1
  v_max_f32_dpp v22, v22, v22 quad_perm:[2,3,0,1] row_mask:0xf bank_mask:0xf
  s_nop 1
  v_max_f32_dpp v22, v22, v22 row_half_mirror row_mask:0xf bank_mask:0xf
  v_pk_add_f32 v[8:9], v[8:9], v[22:23] op_sel_hi:[1,0] neg_lo:[0,1] neg_hi:[0,1]
  v_sub_f32 v20, v20, v22
  v_exp_f32 v8, v8
  v_exp_f32 v9, v9
  v_exp_f32 v20, v20
  buffer_store_dword v112, v116, s[8:11], 0 offen sc1
  v_add_f32 v24, v8, v9
  v_fmac_f32 v24, 0.5, v20
  v_mov_b32_dpp v21, v20 quad_perm:[1,0,3,2] row_mask:0xf bank_mask:0xf
  s_nop 0
  v_add_f32_dpp v24, v24, v24 quad_perm:[1,0,3,2] row_mask:0xf bank_mask:0xf
  s_nop 1
  v_add_f32_dpp v24, v24, v24 quad_perm:[2,3,0,1] row_mask:0xf bank_mask:0xf
  s_nop 1
  v_add_f32_dpp v24, v24, v24 row_half_mirror row_mask:0xf bank_mask:0xf
  s_nop 1
  v_add_f32_dpp v24, v24, v24 row_ror:8 row_mask:0xf bank_mask:0xf
  v_rcp_f32 v24, v24
  s_nop 0
  v_pk_mul_f32 v[8:9], v[8:9], v[24:25] op_sel_hi:[1,0]
  v_pk_mul_f32 v[20:21], v[20:21], v[24:25] op_sel_hi:[1,0]
  v_cvt_pk_bf16_f32 v8, v8, v9
  v_cvt_pk_bf16_f32 v20, v20, v21
  v_min_u32 v8, -2, v8
  buffer_store_dword v8, v1, s[8:11], s20 offen sc1
  v_min_u32 v20, -2, v20
  buffer_store_dword v20, v118, s[8:11], s20 offen sc1
  buffer_store_dword v119, v1, s[8:11], s21 offen sc1
  buffer_store_dword v119, v118, s[8:11], s21 offen sc1
  v_mov_b32 v74, 0
  v_mov_b32 v75, 0
  s_mov_b32 s19, s18
  s_add_u32 s18, s18, 1
  s_mov_b32 s22, s20
  s_mov_b32 s20, s21
  s_mov_b32 s21, s22
  s_add_u32 s23, s20, 4096
  v_mov_b32 v112, s18
  s_cmp_lt_u32 s19, 63
  s_nop 0
  s_cbranch_scc1 cB_sc1_loop
  s_branch cB_done
cB_sc1_r0:
  s_add_u32 s31, s31, 1
  buffer_load_dwordx4 v[8:11], v2, s[8:11], s20 offen offset:0 sc1
  s_waitcnt vmcnt(0)
  v_cmp_eq_u32 vcc, -1, v8
  v_mov_b32 v36, 0
  v_mov_b32 v37, 0
  v_mov_b32 v38, 0
  v_mov_b32 v39, 0
  v_mov_b32 v40, 0
  v_mov_b32 v41, 0
  v_mov_b32 v42, 0
  v_mov_b32 v43, 0
  v_mov_b32 v44, 0
  v_mov_b32 v45, 0
  v_mov_b32 v46, 0
  v_mov_b32 v47, 0
  v_mov_b32 v48, 0
  v_mov_b32 v49, 0
  v_mov_b32 v50, 0
  v_mov_b32 v51, 0
  s_nop 1
  s_cbranch_vccz cB_sc1_go
  s_add_u32 s30, s30, 1
  s_cmp_lt_u32 s30, 400000
  s_cbranch_scc1 cB_sc1_r0
  s_branch cB_abort
cB_sc1_r1:
  s_add_u32 s31, s31, 1
  buffer_load_dwordx4 v[12:15], v2, s[8:11], s20 offen offset:1024 sc1
  s_waitcnt vmcnt(0)
  v_cmp_eq_u32 vcc, -1, v12
  s_nop 4
  s_cbranch_vccz cB_sc1_c1
  s_add_u32 s30, s30, 1
  s_cmp_lt_u32 s30, 400000
  s_cbranch_scc1 cB_sc1_r1
  s_branch cB_abort
cB_sc1_r2:
  s_add_u32 s31, s31, 1
  buffer_load_dwordx4 v[16:19], v2, s[8:11], s20 offen offset:2048 sc1
  s_waitcnt vmcnt(0)
  v_cmp_eq_u32 vcc, -1, v16
  s_nop 4
  s_cbranch_vccz cB_sc1_c2
  s_add_u32 s30, s30, 1
  s_cmp_lt_u32 s30, 400000
  s_cbranch_scc1 cB_sc1_r2
  s_branch cB_abort
cB_sc1_r3:
  s_add_u32 s31, s31, 1
  buffer_load_dwordx4 v[20:23], v2, s[8:11], s20 offen offset:3072 sc1
  s_waitcnt vmcnt(0)
  v_cmp_eq_u32 vcc, -1, v20
  s_nop 4
  s_cbranch_vccz cB_sc1_c3
  s_add_u32 s30, s30, 1
  s_cmp_lt_u32 s30, 400000
  s_cbranch_scc1 cB_sc1_r3
  s_branch cB_abort
cB_sc1_r4:
  s_add_u32 s31, s31, 1
  buffer_load_dwordx4 v[28:31], v2, s[8:11], s23 offen offset:0 sc1
  buffer_load_dwordx4 v[24:27], v2, s[8:11], s23 offen offset:1024 sc1
  buffer_load_dwordx4 v[32:35], v2, s[8:11], s23 offen offset:2048 sc1
  s_waitcnt vmcnt(0)
  v_max3_u32 v66, v24, v27, v28
  v_max3_u32 v66, v66, v31, v32
  v_max_u32 v66, v66, v35
  v_cmp_eq_u32 vcc, -1, v66
  s_nop 4
  s_cbranch_vccz cB_sc1_c4
  s_add_u32 s30, s30, 1
  s_cmp_lt_u32 s30, 400000
  s_cbranch_scc1 cB_sc1_r4
  s_branch cB_abort
cB_sc1_retry:
  s_cmp_lg_u32 s62, 0
  s_cbranch_scc1 cB_sc1_cont
  s_waitcnt vmcnt(0) lgkmcnt(0)
cB_sc1_rv:
  buffer_load_dwordx4 v[8:11], v2, s[8:11], s20 offen offset:0 sc1
  buffer_load_dwordx4 v[12:15], v2, s[8:11], s20 offen offset:1024 sc1
  buffer_load_dwordx4 v[16:19], v2, s[8:11], s20 offen offset:2048 sc1
  buffer_load_dwordx4 v[20:23], v2, s[8:11], s20 offen offset:3072 sc1
  buffer_load_dwordx4 v[28:31], v2, s[8:11], s23 offen offset:0 sc1
  buffer_load_dwordx4 v[24:27], v2, s[8:11], s23 offen offset:1024 sc1
  buffer_load_dwordx4 v[32:35], v2, s[8:11], s23 offen offset:2048 sc1
  s_waitcnt vmcnt(0)
  v_pk_max_u16 v66, v8, v9
  v_pk_max_u16 v66, v66, v10
  v_pk_max_u16 v66, v66, v11
  v_pk_max_u16 v66, v66, v12
  v_pk_max_u16 v66, v66, v13
  v_pk_max_u16 v66, v66, v14
  v_pk_max_u16 v66, v66, v15
  v_pk_max_u16 v66, v66, v16
  v_pk_max_u16 v66, v66, v17
  v_pk_max_u16 v66, v66, v18
  v_pk_max_u16 v66, v66, v19
  v_pk_max_u16 v66, v66, v20
  v_pk_max_u16 v66, v66, v21
  v_pk_max_u16 v66, v66, v22
  v_pk_max_u16 v66, v66, v23
  v_pk_max_u16 v66, v66, v24
  v_pk_max_u16 v66, v66, v25
  v_pk_max_u16 v66, v66, v26
  v_pk_max_u16 v66, v66, v27
  v_pk_max_u16 v66, v66, v28
  v_pk_max_u16 v66, v66, v29
  v_pk_max_u16 v66, v66, v30
  v_pk_max_u16 v66, v66, v31
  v_pk_max_u16 v66, v66, v32
  v_pk_max_u16 v66, v66, v33
  v_pk_max_u16 v66, v66, v34
  v_pk_max_u16 v66, v66, v35
  v_lshlrev_b32 v67, 16, v66
  v_max_u32 v66, v66, v67
  v_cmp_le_u32 vcc, 0xffff0000, v66
  s_cbranch_vccz cB_sc1_rk
  s_add_u32 s30, s30, 1
  s_cmp_lt_u32 s30, 400000
  s_cbranch_scc1 cB_sc1_rv
  s_branch cB_abort
cB_sc1_rk:
  s_mov_b32 s62, 1
  v_mov_b32 v36, 0
  v_mov_b32 v37, 0
  v_mov_b32 v38, 0
  v_mov_b32 v39, 0
  v_mov_b32 v40, 0
  v_mov_b32 v41, 0
  v_mov_b32 v42, 0
  v_mov_b32 v43, 0
  v_mov_b32 v44, 0
  v_mov_b32 v45, 0
  v_mov_b32 v46, 0
  v_mov_b32 v47, 0
  v_mov_b32 v48, 0
  v_mov_b32 v49, 0
  v_mov_b32 v50, 0
  v_mov_b32 v51, 0
  v_mov_b32 v60, 0
  v_mov_b32 v61, 0
  v_mov_b32 v62, 0
  v_mov_b32 v63, 0
  v_mov_b32 v68, 0
  v_mov_b32 v69, 0
  v_mov_b32 v70, 0
  v_mov_b32 v71, 0
  v_mov_b32 v72, 0
  v_mov_b32 v73, 0
  v_mov_b32 v74, 0
  v_mov_b32 v75, 0
  v_mov_b32 v52, 0
  v_mov_b32 v53, 0
  v_mov_b32 v54, 0
  v_mov_b32 v55, 0
  v_mov_b32 v56, 0
  v_mov_b32 v57, 0
  v_mov_b32 v58, 0
  v_mov_b32 v59, 0
  s_add_u32 s31, s31, 0x100
  s_nop 0
  s_branch cB_sc1_go
.p2align 6
cB_sc2_loop:
  s_mov_b32 s30, 0
  s_mov_b32 s62, 0
  s_setprio 3
  s_barrier
  buffer_load_dwordx4 v[8:11], v2, s[8:11], s20 offen offset:0 sc1
  s_setprio 2
  buffer_load_dwordx4 v[12:15], v2, s[8:11], s20 offen offset:1024 sc1
  s_setprio 1
  buffer_load_dwordx4 v[16:19], v2, s[8:11], s20 offen offset:2048 sc1
  s_setprio 0
  buffer_load_dwordx4 v[20:23], v2, s[8:11], s20 offen offset:3072 sc1
cB_sc2_go:
  s_waitcnt vmcnt(3)
  v_smfmac_f32_16x16x64_bf16 v[36:39], v[8:11], a[0:7], v3
  buffer_load_dwordx4 v[24:27], v2, s[8:11], s23 offen offset:0 sc1
  v_cmp_eq_u32 vcc, -1, v8
  v_smfmac_f32_16x16x64_bf16 v[40:43], v[8:11], a[56:63], v3
  v_smfmac_f32_16x16x64_bf16 v[44:47], v[8:11], a[112:119], v3
  buffer_load_dwordx4 v[32:35], v2, s[8:11], s23 offen offset:1024 sc1
  s_cbranch_vccnz cB_sc2_r0
  v_smfmac_f32_16x16x64_bf16 v[48:51], v[8:11], a[168:175], v3
  v_smfmac_f32_16x16x64_bf16 v[52:55], v[8:11], a[224:231], v3
  s_waitcnt vmcnt(4)
  v_cmp_eq_u32 vcc, -1, v12
  v_smfmac_f32_16x16x64_bf16 v[56:59], v[8:11], v[144:151], v3
  buffer_load_dwordx4 v[28:31], v2, s[8:11], s23 offen offset:2048 sc1
  v_smfmac_f32_16x16x64_bf16 v[62:65], v[8:11], v[200:207], v3
  s_cbranch_vccnz cB_sc2_r1
cB_sc2_c1:
  v_smfmac_f32_16x16x64_bf16 v[36:39], v[12:15], a[8:15], v3
  v_smfmac_f32_16x16x64_bf16 v[40:43], v[12:15], a[64:71], v3
  v_smfmac_f32_16x16x64_bf16 v[44:47], v[12:15], a[120:127], v3
  v_smfmac_f32_16x16x64_bf16 v[48:51], v[12:15], a[176:183], v3
  v_smfmac_f32_16x16x64_bf16 v[52:55], v[12:15], a[232:239], v3
  s_waitcnt vmcnt(4)
  v_cmp_eq_u32 vcc, -1, v16
  v_smfmac_f32_16x16x64_bf16 v[56:59], v[12:15], v[152:159], v3
  buffer_load_dwordx4 v[88:91], v117, s[8:11], s26 offen offset:0 sc1
  v_smfmac_f32_16x16x64_bf16 v[62:65], v[12:15], v[208:215], v3
  s_cbranch_vccnz cB_sc2_r2
cB_sc2_c2:
  v_smfmac_f32_16x16x64_bf16 v[36:39], v[16:19], a[16:23], v3
  v_smfmac_f32_16x16x64_bf16 v[40:43], v[16:19], a[72:79], v3
  v_smfmac_f32_16x16x64_bf16 v[44:47], v[16:19], a[128:135], v3
  buffer_load_dwordx4 v[92:95], v117, s[8:11], s26 offen offset:1024 sc1
  v_smfmac_f32_16x16x64_bf16 v[48:51], v[16:19], a[184:191], v3
  v_smfmac_f32_16x16x64_bf16 v[52:55], v[16:19], a[240:247], v3
  s_waitcnt vmcnt(5)
  v_cmp_eq_u32 vcc, -1, v20
  v_smfmac_f32_16x16x64_bf16 v[56:59], v[16:19], v[160:167], v3
  v_smfmac_f32_16x16x64_bf16 v[62:65], v[16:19], v[216:223], v3
  buffer_load_dwordx4 v[96:99], v2, s[8:11], s24 offen offset:0 sc1
  s_cbranch_vccnz cB_sc2_r3
cB_sc2_c3:
  v_smfmac_f32_16x16x64_bf16 v[36:39], v[20:23], a[24:31], v3
  v_smfmac_f32_16x16x64_bf16 v[40:43], v[20:23], a[80:87], v3
  s_waitcnt vmcnt(3)
  v_max3_u32 v66, v24, v27, v28
  v_smfmac_f32_16x16x64_bf16 v[44:47], v[20:23], a[136:143], v3
  v_max3_u32 v66, v66, v31, v32
  v_smfmac_f32_16x16x64_bf16 v[48:51], v[20:23], a[192:199], v3
  buffer_load_dwordx4 v[100:103], v2, s[8:11], s24 offen offset:1024 sc1
  v_max_u32 v66, v66, v35
  v_smfmac_f32_16x16x64_bf16 v[52:55], v[20:23], a[248:255], v3
  v_cmp_eq_u32 vcc, -1, v66
  v_smfmac_f32_16x16x64_bf16 v[56:59], v[20:23], v[168:175], v3
  v_smfmac_f32_16x16x64_bf16 v[62:65], v[20:23], v[224:231], v3
  s_cbranch_vccnz cB_sc2_r4
cB_sc2_c4:
  v_smfmac_f32_16x16x64_bf16 v[62:65], v[24:27], v[232:239], v3
  buffer_load_dwordx4 v[104:107], v2, s[8:11], s26 offen offset:0 sc1
  v_smfmac_f32_16x16x64_bf16 v[62:65], v[32:35], v[240:247], v3
  v_smfmac_f32_16x16x64_bf16 v[62:65], v[28:31], v[248:255], v3
  v_smfmac_f32_16x16x64_bf16 v[52:55], v[24:27], v[120:127], v3
  v_smfmac_f32_16x16x64_bf16 v[52:55], v[32:35], v[128:135], v3
  buffer_load_dwordx4 v[108:111], v2, s[8:11], s26 offen offset:1024 sc1
  v_smfmac_f32_16x16x64_bf16 v[52:55], v[28:31], v[136:143], v3
  v_cvt_pk_bf16_f32 v62, v62, v63
  v_smfmac_f32_16x16x64_bf16 v[56:59], v[24:27], v[176:183], v3
  v_cvt_pk_bf16_f32 v63, v64, v65
  v_smfmac_f32_16x16x64_bf16 v[56:59], v[32:35], v[184:191], v3
  v_mfma_f32_16x16x32_bf16 v[8:11], v[60:63], v[4:7], 0
  v_cvt_pk_bf16_f32 v55, v54, v55
  v_smfmac_f32_16x16x64_bf16 v[56:59], v[28:31], v[192:199], v3
  v_cvt_pk_bf16_f32 v54, v52, v53
  v_smfmac_f32_16x16x64_bf16 v[36:39], v[24:27], a[32:39], v3
  s_nop 1
  v_cvt_pk_bf16_f32 v76, v8, v9
  v_smfmac_f32_16x16x64_bf16 v[36:39], v[32:35], a[40:47], v3
  v_cvt_pk_bf16_f32 v77, v10, v11
  v_smfmac_f32_16x16x64_bf16 v[36:39], v[28:31], a[48:55], v3
  v_cvt_pk_bf16_f32 v56, v56, v57
  v_smfmac_f32_16x16x64_bf16 v[40:43], v[24:27], a[88:95], v3
  v_cvt_pk_bf16_f32 v57, v58, v59
  v_smfmac_f32_16x16x64_bf16 v[40:43], v[32:35], a[96:103], v3
  v_mfma_f32_16x16x32_bf16 v[12:15], v[54:57], v[4:7], 0
  v_cvt_pk_bf16_f32 v39, v38, v39
  v_smfmac_f32_16x16x64_bf16 v[40:43], v[28:31], a[104:111], v3
  v_cvt_pk_bf16_f32 v38, v36, v37
  v_smfmac_f32_16x16x64_bf16 v[44:47], v[24:27], a[144:151], v3
  s_nop 1
  v_cvt_pk_bf16_f32 v78, v12, v13
  v_smfmac_f32_16x16x64_bf16 v[44:47], v[32:35], a[152:159], v3
  v_cvt_pk_bf16_f32 v79, v14, v15
  v_smfmac_f32_16x16x64_bf16 v[44:47], v[28:31], a[160:167], v3
  v_cvt_pk_bf16_f32 v40, v40, v41
  v_smfmac_f32_16x16x64_bf16 v[48:51], v[24:27], a[200:207], v3
  v_cvt_pk_bf16_f32 v41, v42, v43
  v_smfmac_f32_16x16x64_bf16 v[48:51], v[32:35], a[208:215], v3
  v_smfmac_f32_16x16x64_bf16 v[48:51], v[28:31], a[216:223], v3
  s_waitcnt vmcnt(4)
  v_cvt_pk_bf16_f32 v47, v46, v47
  v_smfmac_f32_16x16x64_bf16 v[68:71], v[76:79], v[80:87], v3
  v_cvt_pk_bf16_f32 v46, v44, v45
  v_mfma_f32_16x16x32_bf16 v[8:11], v[38:41], v[4:7], 0
  s_nop 1
  v_cvt_pk_bf16_f32 v48, v48, v49
  v_cvt_pk_bf16_f32 v49, v50, v51
  s_nop 1
  v_mfma_f32_16x16x32_bf16 v[12:15], v[46:49], v[4:7], 0
  v_smfmac_f32_16x16x64_bf16 v[72:75], v[76:79], v[88:95], v3
  v_cvt_pk_bf16_f32 v20, v8, v9
  v_mfma_f32_16x16x32_bf16 v[52:55], v[30:33], v[76:79], 0
  s_waitcnt vmcnt(0)
  v_cvt_pk_bf16_f32 v21, v10, v11
  v_cvt_pk_bf16_f32 v22, v12, v13
  v_cvt_pk_bf16_f32 v23, v14, v15
  s_nop 1
  v_mfma_f32_16x16x32_bf16 v[52:55], v[16:19], v[20:23], v[52:55]
  v_smfmac_f32_16x16x64_bf16 v[68:71], v[20:23], v[96:103], v3
  v_smfmac_f32_16x16x64_bf16 v[72:75], v[20:23], v[104:111], v3
  s_nop 1
  ds_write_b128 v113, v[52:55]
  s_nop 1
  v_permlane32_swap_b32 v68, v70
  v_permlane32_swap_b32 v69, v71
  v_add_f32 v56, v68, v70
  v_add_f32 v58, v69, v71
  v_permlane32_swap_b32 v72, v74
  v_permlane32_swap_b32 v73, v75
  v_add_f32 v57, v72, v74
  v_add_f32 v59, v73, v75
  ds_write_b128 v2, v[56:59] offset:2048
  v_cmp_u_f32 vcc, v57, v59
  v_mov_b32 v68, 0
  v_mov_b32 v69, 0
  v_mov_b32 v70, 0
  v_mov_b32 v71, 0
  s_cbranch_vccnz cB_sc2_retry
cB_sc2_cont:
  s_add_u32 s24, s24, 28672
  s_add_u32 s26, s26, 28672
  buffer_load_dwordx4 v[80:83], v117, s[8:11], s24 offen offset:0 sc1
  buffer_load_dwordx4 v[84:87], v117, s[8:11], s24 offen offset:1024 sc1
  v_mov_b32 v72, 0
  v_mov_b32 v73, 0
  v_mfma_f32_32x32x16_bf16 v[36:51], v[68:71], v[68:71], 0
  s_waitcnt lgkmcnt(0)
  s_barrier
  v_mfma_f32_32x32x16_bf16 v[52:67], v[68:71], v[68:71], 0
  s_buffer_load_dword s70, s[8:11], s35
  s_add_u32 s22, s24, 114688
  s_buffer_load_dword s71, s[8:11], s22
  s_mul_i32 s22, s18, 7168
  s_add_u32 s22, s22, 88024064
  s_buffer_load_dword s72, s[8:11], s22
  s_add_u32 s35, s35, 458752
  v_mov_b32 v74, 0
  v_mov_b32 v75, 0
  s_mov_b32 s19, s18
  s_add_u32 s18, s18, 1
  s_mov_b32 s22, s20
  s_mov_b32 s20, s21
  s_mov_b32 s21, s22
  s_add_u32 s23, s20, 4096
  s_cmp_lt_u32 s19, 63
  s_cbranch_scc1 cB_sc2_loop
  s_branch cB_done
cB_sc2_r0:
  s_add_u32 s31, s31, 1
  buffer_load_dwordx4 v[8:11], v2, s[8:11], s20 offen offset:0 sc1
  s_waitcnt vmcnt(0)
  v_cmp_eq_u32 vcc, -1, v8
  v_mov_b32 v36, 0
  v_mov_b32 v37, 0
  v_mov_b32 v38, 0
  v_mov_b32 v39, 0
  v_mov_b32 v40, 0
  v_mov_b32 v41, 0
  v_mov_b32 v42, 0
  v_mov_b32 v43, 0
  v_mov_b32 v44, 0
  v_mov_b32 v45, 0
  v_mov_b32 v46, 0
  v_mov_b32 v47, 0
  v_mov_b32 v48, 0
  v_mov_b32 v49, 0
  v_mov_b32 v50, 0
  v_mov_b32 v51, 0
  s_nop 1
  s_cbranch_vccz cB_sc2_go
  s_add_u32 s30, s30, 1
  s_cmp_lt_u32 s30, 400000
  s_cbranch_scc1 cB_sc2_r0
  s_branch cB_abort
cB_sc2_r1:
  s_add_u32 s31, s31, 1
  buffer_load_dwordx4 v[12:15], v2, s[8:11], s20 offen offset:1024 sc1
  s_waitcnt vmcnt(0)
  v_cmp_eq_u32 vcc, -1, v12
  s_nop 4
  s_cbranch_vccz cB_sc2_c1
  s_add_u32 s30, s30, 1
  s_cmp_lt_u32 s30, 400000
  s_cbranch_scc1 cB_sc2_r1
  s_branch cB_abort
cB_sc2_r2:
  s_add_u32 s31, s31, 1
  buffer_load_dwordx4 v[16:19], v2, s[8:11], s20 offen offset:2048 sc1
  s_waitcnt vmcnt(0)
  v_cmp_eq_u32 vcc, -1, v16
  s_nop 4
  s_cbranch_vccz cB_sc2_c2
  s_add_u32 s30, s30, 1
  s_cmp_lt_u32 s30, 400000
  s_cbranch_scc1 cB_sc2_r2
  s_branch cB_abort
cB_sc2_r3:
  s_add_u32 s31, s31, 1
  buffer_load_dwordx4 v[20:23], v2, s[8:11], s20 offen offset:3072 sc1
  s_waitcnt vmcnt(0)
  v_cmp_eq_u32 vcc, -1, v20
  s_nop 4
  s_cbranch_vccz cB_sc2_c3
  s_add_u32 s30, s30, 1
  s_cmp_lt_u32 s30, 400000
  s_cbranch_scc1 cB_sc2_r3
  s_branch cB_abort
cB_sc2_r4:
  s_add_u32 s31, s31, 1
  buffer_load_dwordx4 v[24:27], v2, s[8:11], s23 offen offset:0 sc1
  buffer_load_dwordx4 v[32:35], v2, s[8:11], s23 offen offset:1024 sc1
  buffer_load_dwordx4 v[28:31], v2, s[8:11], s23 offen offset:2048 sc1
  s_waitcnt vmcnt(0)
  v_max3_u32 v66, v24, v27, v28
  v_max3_u32 v66, v66, v31, v32
  v_max_u32 v66, v66, v35
  v_cmp_eq_u32 vcc, -1, v66
  s_nop 4
  s_cbranch_vccz cB_sc2_c4
  s_add_u32 s30, s30, 1
  s_cmp_lt_u32 s30, 400000
  s_cbranch_scc1 cB_sc2_r4
  s_branch cB_abort
cB_sc2_retry:
  s_cmp_lg_u32 s62, 0
  s_cbranch_scc1 cB_sc2_cont
  s_waitcnt vmcnt(0) lgkmcnt(0)
cB_sc2_rv:
  buffer_load_dwordx4 v[8:11], v2, s[8:11], s20 offen offset:0 sc1
  buffer_load_dwordx4 v[12:15], v2, s[8:11], s20 offen offset:1024 sc1
  buffer_load_dwordx4 v[16:19], v2, s[8:11], s20 offen offset:2048 sc1
  buffer_load_dwordx4 v[20:23], v2, s[8:11], s20 offen offset:3072 sc1
  buffer_load_dwordx4 v[24:27], v2, s[8:11], s23 offen offset:0 sc1
  buffer_load_dwordx4 v[32:35], v2, s[8:11], s23 offen offset:1024 sc1
  buffer_load_dwordx4 v[28:31], v2, s[8:11], s23 offen offset:2048 sc1
  s_waitcnt vmcnt(0)
  v_pk_max_u16 v66, v8, v9
  v_pk_max_u16 v66, v66, v10
  v_pk_max_u16 v66, v66, v11
  v_pk_max_u16 v66, v66, v12
  v_pk_max_u16 v66, v66, v13
  v_pk_max_u16 v66, v66, v14
  v_pk_max_u16 v66, v66, v15
  v_pk_max_u16 v66, v66, v16
  v_pk_max_u16 v66, v66, v17
  v_pk_max_u16 v66, v66, v18
  v_pk_max_u16 v66, v66, v19
  v_pk_max_u16 v66, v66, v20
  v_pk_max_u16 v66, v66, v21
  v_pk_max_u16 v66, v66, v22
  v_pk_max_u16 v66, v66, v23
  v_pk_max_u16 v66, v66, v24
  v_pk_max_u16 v66, v66, v25
  v_pk_max_u16 v66, v66, v26
  v_pk_max_u16 v66, v66, v27
  v_pk_max_u16 v66, v66, v28
  v_pk_max_u16 v66, v66, v29
  v_pk_max_u16 v66, v66, v30
  v_pk_max_u16 v66, v66, v31
  v_pk_max_u16 v66, v66, v32
  v_pk_max_u16 v66, v66, v33
  v_pk_max_u16 v66, v66, v34
  v_pk_max_u16 v66, v66, v35
  v_lshlrev_b32 v67, 16, v66
  v_max_u32 v66, v66, v67
  v_cmp_le_u32 vcc, 0xffff0000, v66
  s_cbranch_vccz cB_sc2_rk
  s_add_u32 s30, s30, 1
  s_cmp_lt_u32 s30, 400000
  s_cbranch_scc1 cB_sc2_rv
  s_branch cB_abort
cB_sc2_rk:
  s_mov_b32 s62, 1
  v_mov_b32 v36, 0
  v_mov_b32 v37, 0
  v_mov_b32 v38, 0
  v_mov_b32 v39, 0
  v_mov_b32 v40, 0
  v_mov_b32 v41, 0
  v_mov_b32 v42, 0
  v_mov_b32 v43, 0
  v_mov_b32 v44, 0
  v_mov_b32 v45, 0
  v_mov_b32 v46, 0
  v_mov_b32 v47, 0
  v_mov_b32 v48, 0
  v_mov_b32 v49, 0
  v_mov_b32 v50, 0
  v_mov_b32 v51, 0
  v_mov_b32 v62, 0
  v_mov_b32 v63, 0
  v_mov_b32 v64, 0
  v_mov_b32 v65, 0
  v_mov_b32 v68, 0
  v_mov_b32 v69, 0
  v_mov_b32 v70, 0
  v_mov_b32 v71, 0
  v_mov_b32 v72, 0
  v_mov_b32 v73, 0
  v_mov_b32 v74, 0
  v_mov_b32 v75, 0
  v_mov_b32 v52, 0
  v_mov_b32 v53, 0
  v_mov_b32 v54, 0
  v_mov_b32 v55, 0
  v_mov_b32 v56, 0
  v_mov_b32 v57, 0
  v_mov_b32 v58, 0
  v_mov_b32 v59, 0
  s_add_u32 s31, s31, 0x100
  s_nop 0
  s_branch cB_sc2_go
.p2align 6
cB_sc3_loop:
  s_mov_b32 s30, 0
  s_mov_b32 s62, 0
  s_setprio 3
  s_barrier
  buffer_load_dwordx4 v[8:11], v2, s[8:11], s20 offen offset:0 sc1
  s_setprio 2
  buffer_load_dwordx4 v[12:15], v2, s[8:11], s20 offen offset:1024 sc1
  s_setprio 1
  buffer_load_dwordx4 v[16:19], v2, s[8:11], s20 offen offset:2048 sc1
  s_setprio 0
  buffer_load_dwordx4 v[20:23], v2, s[8:11], s20 offen offset:3072 sc1
cB_sc3_go:
  s_waitcnt vmcnt(3)
  v_smfmac_f32_16x16x64_bf16 v[36:39], v[8:11], a[0:7], v3
  buffer_load_dwordx4 v[24:27], v2, s[8:11], s23 offen offset:0 sc1
  v_cmp_eq_u32 vcc, -1, v8
  v_smfmac_f32_16x16x64_bf16 v[40:43], v[8:11], a[56:63], v3
  v_smfmac_f32_16x16x64_bf16 v[44:47], v[8:11], a[112:119], v3
  buffer_load_dwordx4 v[28:31], v2, s[8:11], s23 offen offset:1024 sc1
  s_cbranch_vccnz cB_sc3_r0
  v_smfmac_f32_16x16x64_bf16 v[48:51], v[8:11], a[168:175], v3
  v_smfmac_f32_16x16x64_bf16 v[52:55], v[8:11], a[224:231], v3
  s_waitcnt vmcnt(4)
  v_cmp_eq_u32 vcc, -1, v12
  v_smfmac_f32_16x16x64_bf16 v[56:59], v[8:11], v[144:151], v3
  buffer_load_dwordx4 v[32:35], v2, s[8:11], s23 offen offset:2048 sc1
  v_smfmac_f32_16x16x64_bf16 v[62:65], v[8:11], v[200:207], v3
  s_cbranch_vccnz cB_sc3_r1
cB_sc3_c1:
  v_smfmac_f32_16x16x64_bf16 v[36:39], v[12:15], a[8:15], v3
  v_smfmac_f32_16x16x64_bf16 v[40:43], v[12:15], a[64:71], v3
  v_smfmac_f32_16x16x64_bf16 v[44:47], v[12:15], a[120:127], v3
  v_smfmac_f32_16x16x64_bf16 v[48:51], v[12:15], a[176:183], v3
  v_smfmac_f32_16x16x64_bf16 v[52:55], v[12:15], a[232:239], v3
  s_waitcnt vmcnt(4)
  v_cmp_eq_u32 vcc, -1, v16
  v_smfmac_f32_16x16x64_bf16 v[56:59], v[12:15], v[152:159], v3
  buffer_load_dwordx4 v[88:91], v117, s[8:11], s26 offen offset:0 sc1
  v_smfmac_f32_16x16x64_bf16 v[62:65], v[12:15], v[208:215], v3
  s_cbranch_vccnz cB_sc3_r2
cB_sc3_c2:
  v_smfmac_f32_16x16x64_bf16 v[36:39], v[16:19], a[16:23], v3
  v_smfmac_f32_16x16x64_bf16 v[40:43], v[16:19], a[72:79], v3
  v_smfmac_f32_16x16x64_bf16 v[44:47], v[16:19], a[128:135], v3
  buffer_load_dwordx4 v[92:95], v117, s[8:11], s26 offen offset:1024 sc1
  v_smfmac_f32_16x16x64_bf16 v[48:51], v[16:19], a[184:191], v3
  v_smfmac_f32_16x16x64_bf16 v[52:55], v[16:19], a[240:247], v3
  s_waitcnt vmcnt(5)
  v_cmp_eq_u32 vcc, -1, v20
  v_smfmac_f32_16x16x64_bf16 v[56:59], v[16:19], v[160:167], v3
  v_smfmac_f32_16x16x64_bf16 v[62:65], v[16:19], v[216:223], v3
  buffer_load_dwordx4 v[96:99], v2, s[8:11], s24 offen offset:0 sc1
  s_cbranch_vccnz cB_sc3_r3
cB_sc3_c3:
  v_smfmac_f32_16x16x64_bf16 v[36:39], v[20:23], a[24:31], v3
  v_smfmac_f32_16x16x64_bf16 v[40:43], v[20:23], a[80:87], v3
  s_waitcnt vmcnt(3)
  v_max3_u32 v66, v24, v27, v28
  v_smfmac_f32_16x16x64_bf16 v[44:47], v[20:23], a[136:143], v3
  v_max3_u32 v66, v66, v31, v32
  v_smfmac_f32_16x16x64_bf16 v[48:51], v[20:23], a[192:199], v3
  buffer_load_dwordx4 v[100:103], v2, s[8:11], s24 offen offset:1024 sc1
  v_max_u32 v66, v66, v35
  v_smfmac_f32_16x16x64_bf16 v[52:55], v[20:23], a[248:255], v3
  v_cmp_eq_u32 vcc, -1, v66
  v_smfmac_f32_16x16x64_bf16 v[56:59], v[20:23], v[168:175], v3
  v_smfmac_f32_16x16x64_bf16 v[62:65], v[20:23], v[224:231], v3
  s_cbranch_vccnz cB_sc3_r4
cB_sc3_c4:
  v_smfmac_f32_16x16x64_bf16 v[62:65], v[24:27], v[232:239], v3
  buffer_load_dwordx4 v[104:107], v2, s[8:11], s26 offen offset:0 sc1
  v_smfmac_f32_16x16x64_bf16 v[62:65], v[28:31], v[240:247], v3
  v_smfmac_f32_16x16x64_bf16 v[62:65], v[32:35], v[248:255], v3
  v_smfmac_f32_16x16x64_bf16 v[52:55], v[24:27], v[120:127], v3
  v_smfmac_f32_16x16x64_bf16 v[52:55], v[28:31], v[128:135], v3
  buffer_load_dwordx4 v[108:111], v2, s[8:11], s26 offen offset:1024 sc1
  v_smfmac_f32_16x16x64_bf16 v[52:55], v[32:35], v[136:143], v3
  v_cvt_pk_bf16_f32 v62, v62, v63
  v_smfmac_f32_16x16x64_bf16 v[56:59], v[24:27], v[176:183], v3
  v_cvt_pk_bf16_f32 v63, v64, v65
  v_smfmac_f32_16x16x64_bf16 v[56:59], v[28:31], v[184:191], v3
  v_mfma_f32_16x16x32_bf16 v[8:11], v[60:63], v[4:7], 0
  v_cvt_pk_bf16_f32 v55, v54, v55
  v_smfmac_f32_16x16x64_bf16 v[56:59], v[32:35], v[192:199], v3
  v_cvt_pk_bf16_f32 v54, v52, v53
  v_smfmac_f32_16x16x64_bf16 v[36:39], v[24:27], a[32:39], v3
  s_nop 1
  v_cvt_pk_bf16_f32 v78, v8, v9
  v_smfmac_f32_16x16x64_bf16 v[36:39], v[28:31], a[40:47], v3
  v_cvt_pk_bf16_f32 v79, v10, v11
  v_smfmac_f32_16x16x64_bf16 v[36:39], v[32:35], a[48:55], v3
  v_cvt_pk_bf16_f32 v56, v56, v57
  v_smfmac_f32_16x16x64_bf16 v[40:43], v[24:27], a[88:95], v3
  v_cvt_pk_bf16_f32 v57, v58, v59
  v_smfmac_f32_16x16x64_bf16 v[40:43], v[28:31], a[96:103], v3
  v_mfma_f32_16x16x32_bf16 v[12:15], v[54:57], v[4:7], 0
  v_cvt_pk_bf16_f32 v39, v38, v39
  v_smfmac_f32_16x16x64_bf16 v[40:43], v[32:35], a[104:111], v3
  v_cvt_pk_bf16_f32 v38, v36, v37
  v_smfmac_f32_16x16x64_bf16 v[44:47], v[24:27], a[144:151], v3
  s_nop 1
  v_cvt_pk_bf16_f32 v76, v12, v13
  v_smfmac_f32_16x16x64_bf16 v[44:47], v[28:31], a[152:159], v3
  v_cvt_pk_bf16_f32 v77, v14, v15
  v_smfmac_f32_16x16x64_bf16 v[44:47], v[32:35], a[160:167], v3
  v_cvt_pk_bf16_f32 v40, v40, v41
  v_smfmac_f32_16x16x64_bf16 v[48:51], v[24:27], a[200:207], v3
  v_cvt_pk_bf16_f32 v41, v42, v43
  v_smfmac_f32_16x16x64_bf16 v[48:51], v[28:31], a[208:215], v3
  v_smfmac_f32_16x16x64_bf16 v[48:51], v[32:35], a[216:223], v3
  s_waitcnt vmcnt(4)
  v_cvt_pk_bf16_f32 v47, v46, v47
  v_smfmac_f32_16x16x64_bf16 v[68:71], v[76:79], v[80:87], v3
  v_cvt_pk_bf16_f32 v46, v44, v45
  v_mfma_f32_16x16x32_bf16 v[8:11], v[38:41], v[4:7], 0
  s_nop 1
  v_cvt_pk_bf16_f32 v48, v48, v49
  v_cvt_pk_bf16_f32 v49, v50, v51
  s_nop 1
  v_mfma_f32_16x16x32_bf16 v[12:15], v[46:49], v[4:7], 0
  v_smfmac_f32_16x16x64_bf16 v[72:75], v[76:79], v[88:95], v3
  v_cvt_pk_bf16_f32 v16, v8, v9
  v_mfma_f32_16x16x32_bf16 v[52:55], v[30:33], v[76:79], 0
  s_waitcnt vmcnt(0)
  v_cvt_pk_bf16_f32 v17, v10, v11
  v_cvt_pk_bf16_f32 v18, v12, v13
  v_cvt_pk_bf16_f32 v19, v14, v15
  s_nop 1
  v_mfma_f32_16x16x32_bf16 v[52:55], v[20:23], v[16:19], v[52:55]
  v_smfmac_f32_16x16x64_bf16 v[68:71], v[16:19], v[96:103], v3
  v_smfmac_f32_16x16x64_bf16 v[72:75], v[16:19], v[104:111], v3
  s_nop 1
  ds_write_b128 v113, v[52:55]
  s_nop 1
  v_permlane32_swap_b32 v68, v70
  v_permlane32_swap_b32 v69, v71
  v_add_f32 v56, v68, v70
  v_add_f32 v58, v69, v71
  v_permlane32_swap_b32 v72, v74
  v_permlane32_swap_b32 v73, v75
  v_add_f32 v57, v72, v74
  v_add_f32 v59, v73, v75
  ds_write_b128 v2, v[56:59] offset:3072
  v_cmp_u_f32 vcc, v57, v59
  v_mov_b32 v68, 0
  v_mov_b32 v69, 0
  v_mov_b32 v70, 0
  v_mov_b32 v71, 0
  s_cbranch_vccnz cB_sc3_retry
cB_sc3_cont:
  s_add_u32 s24, s24, 28672
  s_add_u32 s26, s26, 28672
  buffer_load_dwordx4 v[80:83], v117, s[8:11], s24 offen offset:0 sc1
  buffer_load_dwordx4 v[84:87], v117, s[8:11], s24 offen offset:1024 sc1
  v_mov_b32 v72, 0
  v_mov_b32 v73, 0
  v_mfma_f32_16x16x32_bf16 v[62:65], v[68:71], v[68:71], 0
  s_waitcnt lgkmcnt(0)
  s_barrier
  v_mov_b32 v52, 0
  v_mov_b32 v53, 0
  v_mov_b32 v54, 0
  v_mov_b32 v55, 0
  v_mov_b32 v56, 0
  v_mov_b32 v57, 0
  v_mov_b32 v58, 0
  v_mov_b32 v59, 0
  v_mfma_f32_32x32x16_bf16 v[36:51], v[68:71], v[68:71], 0
  v_mov_b32 v74, 0
  v_mov_b32 v75, 0
  s_mov_b32 s19, s18
  s_add_u32 s18, s18, 1
  s_mov_b32 s22, s20
  s_mov_b32 s20, s21
  s_mov_b32 s21, s22
  s_add_u32 s23, s20, 4096
  s_cmp_lt_u32 s19, 63
  s_nop 2
  s_cbranch_scc1 cB_sc3_loop
  s_branch cB_done
cB_sc3_r0:
  s_add_u32 s31, s31, 1
  buffer_load_dwordx4 v[8:11], v2, s[8:11], s20 offen offset:0 sc1
  s_waitcnt vmcnt(0)
  v_cmp_eq_u32 vcc, -1, v8
  v_mov_b32 v36, 0
  v_mov_b32 v37, 0
  v_mov_b32 v38, 0
  v_mov_b32 v39, 0
  v_mov_b32 v40, 0
  v_mov_b32 v41, 0
  v_mov_b32 v42, 0
  v_mov_b32 v43, 0
  v_mov_b32 v44, 0
  v_mov_b32 v45, 0
  v_mov_b32 v46, 0
  v_mov_b32 v47, 0
  v_mov_b32 v48, 0
  v_mov_b32 v49, 0
  v_mov_b32 v50, 0
  v_mov_b32 v51, 0
  s_nop 1
  s_cbranch_vccz cB_sc3_go
  s_add_u32 s30, s30, 1
  s_cmp_lt_u32 s30, 400000
  s_cbranch_scc1 cB_sc3_r0
  s_branch cB_abort
cB_sc3_r1:
  s_add_u32 s31, s31, 1
  buffer_load_dwordx4 v[12:15], v2, s[8:11], s20 offen offset:1024 sc1
  s_waitcnt vmcnt(0)
  v_cmp_eq_u32 vcc, -1, v12
  s_nop 4
  s_cbranch_vccz cB_sc3_c1
  s_add_u32 s30, s30, 1
  s_cmp_lt_u32 s30, 400000
  s_cbranch_scc1 cB_sc3_r1
  s_branch cB_abort
cB_sc3_r2:
  s_add_u32 s31, s31, 1
  buffer_load_dwordx4 v[16:19], v2, s[8:11], s20 offen offset:2048 sc1
  s_waitcnt vmcnt(0)
  v_cmp_eq_u32 vcc, -1, v16
  s_nop 4
  s_cbranch_vccz cB_sc3_c2
  s_add_u32 s30, s30, 1
  s_cmp_lt_u32 s30, 400000
  s_cbranch_scc1 cB_sc3_r2
  s_branch cB_abort
cB_sc3_r3:
  s_add_u32 s31, s31, 1
  buffer_load_dwordx4 v[20:23], v2, s[8:11], s20 offen offset:3072 sc1
  s_waitcnt vmcnt(0)
  v_cmp_eq_u32 vcc, -1, v20
  s_nop 4
  s_cbranch_vccz cB_sc3_c3
  s_add_u32 s30, s30, 1
  s_cmp_lt_u32 s30, 400000
  s_cbranch_scc1 cB_sc3_r3
  s_branch cB_abort
cB_sc3_r4:
  s_add_u32 s31, s31, 1
  buffer_load_dwordx4 v[24:27], v2, s[8:11], s23 offen offset:0 sc1
  buffer_load_dwordx4 v[28:31], v2, s[8:11], s23 offen offset:1024 sc1
  buffer_load_dwordx4 v[32:35], v2, s[8:11], s23 offen offset:2048 sc1
  s_waitcnt vmcnt(0)
  v_max3_u32 v66, v24, v27, v28
  v_max3_u32 v66, v66, v31, v32
  v_max_u32 v66, v66, v35
  v_cmp_eq_u32 vcc, -1, v66
  s_nop 4
  s_cbranch_vccz cB_sc3_c4
  s_add_u32 s30, s30, 1
  s_cmp_lt_u32 s30, 400000
  s_cbranch_scc1 cB_sc3_r4
  s_branch cB_abort
cB_sc3_retry:
  s_cmp_lg_u32 s62, 0
  s_cbranch_scc1 cB_sc3_cont
  s_waitcnt vmcnt(0) lgkmcnt(0)
cB_sc3_rv:
  buffer_load_dwordx4 v[8:11], v2, s[8:11], s20 offen offset:0 sc1
  buffer_load_dwordx4 v[12:15], v2, s[8:11], s20 offen offset:1024 sc1
  buffer_load_dwordx4 v[16:19], v2, s[8:11], s20 offen offset:2048 sc1
  buffer_load_dwordx4 v[20:23], v2, s[8:11], s20 offen offset:3072 sc1
  buffer_load_dwordx4 v[24:27], v2, s[8:11], s23 offen offset:0 sc1
  buffer_load_dwordx4 v[28:31], v2, s[8:11], s23 offen offset:1024 sc1
  buffer_load_dwordx4 v[32:35], v2, s[8:11], s23 offen offset:2048 sc1
  s_waitcnt vmcnt(0)
  v_pk_max_u16 v66, v8, v9
  v_pk_max_u16 v66, v66, v10
  v_pk_max_u16 v66, v66, v11
  v_pk_max_u16 v66, v66, v12
  v_pk_max_u16 v66, v66, v13
  v_pk_max_u16 v66, v66, v14
  v_pk_max_u16 v66, v66, v15
  v_pk_max_u16 v66, v66, v16
  v_pk_max_u16 v66, v66, v17
  v_pk_max_u16 v66, v66, v18
  v_pk_max_u16 v66, v66, v19
  v_pk_max_u16 v66, v66, v20
  v_pk_max_u16 v66, v66, v21
  v_pk_max_u16 v66, v66, v22
  v_pk_max_u16 v66, v66, v23
  v_pk_max_u16 v66, v66, v24
  v_pk_max_u16 v66, v66, v25
  v_pk_max_u16 v66, v66, v26
  v_pk_max_u16 v66, v66, v27
  v_pk_max_u16 v66, v66, v28
  v_pk_max_u16 v66, v66, v29
  v_pk_max_u16 v66, v66, v30
  v_pk_max_u16 v66, v66, v31
  v_pk_max_u16 v66, v66, v32
  v_pk_max_u16 v66, v66, v33
  v_pk_max_u16 v66, v66, v34
  v_pk_max_u16 v66, v66, v35
  v_lshlrev_b32 v67, 16, v66
  v_max_u32 v66, v66, v67
  v_cmp_le_u32 vcc, 0xffff0000, v66
  s_cbranch_vccz cB_sc3_rk
  s_add_u32 s30, s30, 1
  s_cmp_lt_u32 s30, 400000
  s_cbranch_scc1 cB_sc3_rv
  s_branch cB_abort
cB_sc3_rk:
  s_mov_b32 s62, 1
  v_mov_b32 v36, 0
  v_mov_b32 v37, 0
  v_mov_b32 v38, 0
  v_mov_b32 v39, 0
  v_mov_b32 v40, 0
  v_mov_b32 v41, 0
  v_mov_b32 v42, 0
  v_mov_b32 v43, 0
  v_mov_b32 v44, 0
  v_mov_b32 v45, 0
  v_mov_b32 v46, 0
  v_mov_b32 v47, 0
  v_mov_b32 v48, 0
  v_mov_b32 v49, 0
  v_mov_b32 v50, 0
  v_mov_b32 v51, 0
  v_mov_b32 v62, 0
  v_mov_b32 v63, 0
  v_mov_b32 v64, 0
  v_mov_b32 v65, 0
  v_mov_b32 v68, 0
  v_mov_b32 v69, 0
  v_mov_b32 v70, 0
  v_mov_b32 v71, 0
  v_mov_b32 v72, 0
  v_mov_b32 v73, 0
  v_mov_b32 v74, 0
  v_mov_b32 v75, 0
  v_mov_b32 v52, 0
  v_mov_b32 v53, 0
  v_mov_b32 v54, 0
  v_mov_b32 v55, 0
  v_mov_b32 v56, 0
  v_mov_b32 v57, 0
  v_mov_b32 v58, 0
  v_mov_b32 v59, 0
  s_add_u32 s31, s31, 0x100
  s_nop 0
  s_branch cB_sc3_go
.p2align 6
cB_va0_loop:
  s_mov_b32 s30, 0
  s_barrier
  buffer_load_dwordx4 v[24:27], v2, s[8:11], s23 offen offset:0 sc1
  buffer_load_dwordx4 v[28:31], v2, s[8:11], s23 offen offset:1024 sc1
  s_barrier
  buffer_store_dword v160, v1, s[8:11], s38 offen sc1
  s_add_u32 s22, s25, 0
  buffer_load_dwordx4 v[80:83], v6, s[8:11], s22 offen offset:0 sc1
  buffer_load_dwordx4 v[84:87], v6, s[8:11], s22 offen offset:1792 sc1
  s_add_u32 s22, s25, 3584
  buffer_load_dwordx4 v[88:91], v6, s[8:11], s22 offen offset:0 sc1
  buffer_load_dwordx4 v[92:95], v6, s[8:11], s22 offen offset:1792 sc1
  s_add_u32 s22, s25, 7168
  buffer_load_dwordx4 v[96:99], v6, s[8:11], s22 offen offset:0 sc1
  s_mul_i32 s38, s18, 7168
  s_add_u32 s38, s38, 88002560
  s_waitcnt vmcnt(6)
  ds_write_b128 v2, v[24:27] offset:12288
  ds_write_b128 v2, v[28:31] offset:13312
  v_smfmac_f32_16x16x64_bf16 v[36:39], v[24:27], a[32:39], v3
  buffer_load_dwordx4 v[100:103], v6, s[8:11], s22 offen offset:1792 sc1
  v_smfmac_f32_16x16x64_bf16 v[40:43], v[24:27], a[88:95], v3
  s_add_u32 s22, s25, 10752
  buffer_load_dwordx4 v[104:107], v6, s[8:11], s22 offen offset:0 sc1
  v_smfmac_f32_16x16x64_bf16 v[44:47], v[24:27], a[144:151], v3
  buffer_load_dwordx4 v[108:111], v6, s[8:11], s22 offen offset:1792 sc1
  v_smfmac_f32_16x16x64_bf16 v[48:51], v[24:27], a[200:207], v3
  s_add_u32 s22, s25, 14336
  buffer_load_dwordx4 v[112:115], v6, s[8:11], s22 offen offset:0 sc1
  v_smfmac_f32_16x16x64_bf16 v[52:55], v[24:27], v[176:183], v3
  s_waitcnt lgkmcnt(0)
  s_barrier
  ds_read_b128 v[8:11], v2 offset:8192
  ds_read_b128 v[12:15], v2 offset:9216
  ds_read_b128 v[16:19], v2 offset:10240
  ds_read_b128 v[20:23], v2 offset:11264
  ds_read_b128 v[32:35], v2 offset:14336
  buffer_load_dwordx4 v[116:119], v6, s[8:11], s22 offen offset:1792 sc1
  v_smfmac_f32_16x16x64_bf16 v[56:59], v[24:27], v[232:239], v3
  s_add_u32 s22, s25, 17920
  buffer_load_dwordx4 v[120:123], v6, s[8:11], s22 offen offset:0 sc1
  v_smfmac_f32_16x16x64_bf16 v[36:39], v[28:31], a[40:47], v3
  buffer_load_dwordx4 v[124:127], v6, s[8:11], s22 offen offset:1792 sc1
  v_smfmac_f32_16x16x64_bf16 v[40:43], v[28:31], a[96:103], v3
  s_add_u32 s22, s25, 21504
  buffer_load_dwordx4 v[128:131], v6, s[8:11], s22 offen offset:0 sc1
  v_smfmac_f32_16x16x64_bf16 v[44:47], v[28:31], a[152:159], v3
  buffer_load_dwordx4 v[132:135], v6, s[8:11], s22 offen offset:1792 sc1
  v_smfmac_f32_16x16x64_bf16 v[48:51], v[28:31], a[208:215], v3
  s_add_u32 s22, s25, 25088
  buffer_load_dwordx4 v[136:139], v6, s[8:11], s22 offen offset:0 sc1
  v_smfmac_f32_16x16x64_bf16 v[52:55], v[28:31], v[184:191], v3
  ds_read_b128 v[64:67], v0 offset:0
  ds_read_b128 v[68:71], v0 offset:1024
  buffer_load_dwordx4 v[140:143], v6, s[8:11], s22 offen offset:1792 sc1
  v_smfmac_f32_16x16x64_bf16 v[56:59], v[28:31], v[240:247], v3
  s_waitcnt lgkmcnt(6)
  ds_read_b128 v[72:75], v0 offset:2048
  ds_read_b128 v[76:79], v0 offset:3072
  v_smfmac_f32_16x16x64_bf16 v[36:39], v[8:11], a[0:7], v3
  s_waitcnt lgkmcnt(7)
  v_smfmac_f32_16x16x64_bf16 v[36:39], v[12:15], a[8:15], v3
  s_waitcnt lgkmcnt(6)
  v_smfmac_f32_16x16x64_bf16 v[36:39], v[16:19], a[16:23], v3
  s_waitcnt lgkmcnt(2)
  v_smfmac_f32_16x16x64_bf16 v[60:63], v[8:11], v[64:71], v3
  s_waitcnt lgkmcnt(5)
  ds_read_b128 v[144:147], v0 offset:4096
  ds_read_b128 v[148:151], v0 offset:5120
  v_smfmac_f32_16x16x64_bf16 v[36:39], v[20:23], a[24:31], v3
  s_waitcnt lgkmcnt(6)
  v_smfmac_f32_16x16x64_bf16 v[36:39], v[32:35], a[48:55], v3
  v_smfmac_f32_16x16x64_bf16 v[40:43], v[8:11], a[56:63], v3
  s_waitcnt lgkmcnt(2)
  v_smfmac_f32_16x16x64_bf16 v[60:63], v[12:15], v[72:79], v3
  ds_read_b128 v[64:67], v0 offset:6144
  ds_read_b128 v[68:71], v0 offset:7168
  v_smfmac_f32_16x16x64_bf16 v[40:43], v[12:15], a[64:71], v3
  v_permlane32_swap_b32 v36, v38
  v_smfmac_f32_16x16x64_bf16 v[40:43], v[16:19], a[72:79], v3
  v_permlane32_swap_b32 v37, v39
  v_smfmac_f32_16x16x64_bf16 v[40:43], v[20:23], a[80:87], v3
  s_waitcnt lgkmcnt(2)
  v_add_f32 v36, v36, v38
  v_smfmac_f32_16x16x64_bf16 v[60:63], v[16:19], v[144:151], v3
  ds_read_b128 v[72:75], v0 offset:8192
  ds_read_b128 v[76:79], v0 offset:9216
  v_add_f32 v37, v37, v39
  v_smfmac_f32_16x16x64_bf16 v[40:43], v[32:35], a[104:111], v3
  v_cmp_u_f32 vcc, v36, v37
  v_smfmac_f32_16x16x64_bf16 v[44:47], v[8:11], a[112:119], v3
  v_cvt_pk_bf16_f32 v38, v36, v37
  v_smfmac_f32_16x16x64_bf16 v[44:47], v[12:15], a[120:127], v3
  ds_write_b32 v152, v38
  s_waitcnt lgkmcnt(3)
  s_cbranch_vccnz cB_va0_slow
  v_permlane32_swap_b32 v40, v42
  v_smfmac_f32_16x16x64_bf16 v[60:63], v[20:23], v[64:71], v3
  ds_read_b128 v[144:147], v0 offset:10240
  ds_read_b128 v[148:151], v0 offset:11264
  v_permlane32_swap_b32 v41, v43
  v_smfmac_f32_16x16x64_bf16 v[44:47], v[16:19], a[128:135], v3
  buffer_store_dword v162, v1, s[8:11], s21 offen sc1
  v_add_f32 v40, v40, v42
  v_smfmac_f32_16x16x64_bf16 v[44:47], v[20:23], a[136:143], v3
  v_add_f32 v41, v41, v43
  v_smfmac_f32_16x16x64_bf16 v[44:47], v[32:35], a[160:167], v3
  s_waitcnt lgkmcnt(3)
  v_cvt_pk_bf16_f32 v42, v40, v41
  v_smfmac_f32_16x16x64_bf16 v[60:63], v[24:27], v[72:79], v3
  ds_write_b32 v153, v42
  ds_read_b128 v[64:67], v0 offset:12288
  ds_read_b128 v[68:71], v0 offset:13312
  v_smfmac_f32_16x16x64_bf16 v[48:51], v[8:11], a[168:175], v3
  s_nop 0
  v_permlane32_swap_b32 v44, v46
  v_smfmac_f32_16x16x64_bf16 v[48:51], v[12:15], a[176:183], v3
  v_permlane32_swap_b32 v45, v47
  v_smfmac_f32_16x16x64_bf16 v[48:51], v[16:19], a[184:191], v3
  s_waitcnt lgkmcnt(3)
  v_add_f32 v44, v44, v46
  v_smfmac_f32_16x16x64_bf16 v[60:63], v[28:31], v[144:151], v3
  v_add_f32 v45, v45, v47
  v_smfmac_f32_16x16x64_bf16 v[48:51], v[20:23], a[192:199], v3
  v_cvt_pk_bf16_f32 v46, v44, v45
  v_smfmac_f32_16x16x64_bf16 v[48:51], v[32:35], a[216:223], v3
  ds_write_b32 v154, v46
  v_smfmac_f32_16x16x64_bf16 v[52:55], v[8:11], a[224:231], v3
  s_waitcnt lgkmcnt(1)
  v_smfmac_f32_16x16x64_bf16 v[60:63], v[32:35], v[64:71], v3
  v_smfmac_f32_16x16x64_bf16 v[52:55], v[12:15], a[232:239], v3
  v_permlane32_swap_b32 v48, v50
  v_smfmac_f32_16x16x64_bf16 v[52:55], v[16:19], a[240:247], v3
  v_permlane32_swap_b32 v49, v51
  v_smfmac_f32_16x16x64_bf16 v[52:55], v[20:23], a[248:255], v3
  v_add_f32 v48, v48, v50
  v_smfmac_f32_16x16x64_bf16 v[52:55], v[32:35], v[192:199], v3
  v_add_f32 v49, v49, v51
  v_smfmac_f32_16x16x64_bf16 v[56:59], v[8:11], v[200:207], v3
  v_cvt_pk_bf16_f32 v50, v48, v49
  v_smfmac_f32_16x16x64_bf16 v[56:59], v[12:15], v[208:215], v3
  ds_write_b32 v155, v50
  v_permlane32_swap_b32 v60, v62
  v_smfmac_f32_16x16x64_bf16 v[56:59], v[16:19], v[216:223], v3
  v_permlane32_swap_b32 v61, v63
  v_smfmac_f32_16x16x64_bf16 v[56:59], v[20:23], v[224:231], v3
  v_add_f32 v60, v60, v62
  v_smfmac_f32_16x16x64_bf16 v[56:59], v[32:35], v[248:255], v3
  v_add_f32 v61, v61, v63
  v_cvt_pk_bf16_f32 v62, v60, v61
  ds_write_b32 v158, v62
  v_permlane32_swap_b32 v52, v54
  v_permlane32_swap_b32 v53, v55
  v_add_f32 v52, v52, v54
  v_add_f32 v53, v53, v55
  v_cvt_pk_bf16_f32 v54, v52, v53
  ds_write_b32 v156, v54
  v_permlane32_swap_b32 v56, v58
  v_permlane32_swap_b32 v57, v59
  v_add_f32 v56, v56, v58
  v_add_f32 v57, v57, v59
  v_cvt_pk_bf16_f32 v58, v56, v57
  ds_write_b32 v157, v58
cB_va0_t2d:
  s_add_u32 s22, s20, 9216
  s_add_u32 s34, s20, 13312
  s_add_u32 s36, s20, 7168
  s_mov_b32 s37, 0
  v_mov_b32 v48, 0
  v_mov_b32 v49, 0
  v_mov_b32 v50, 0
  v_mov_b32 v51, 0
  v_mov_b32 v163, s18
  s_waitcnt lgkmcnt(0)
  s_setprio 3
  buffer_load_dword v52, v4, s[8:11], 0 offen sc1
  buffer_load_dword v53, v4, s[8:11], 0 offen sc1
  buffer_load_dword v54, v4, s[8:11], 0 offen sc1
  buffer_load_dword v55, v4, s[8:11], 0 offen sc1
cB_va0_fw_l:
  s_waitcnt vmcnt(3)
  v_cmp_gt_u32 vcc, s18, v52
  s_cbranch_vccz cB_va0_fw_d
  buffer_load_dword v52, v4, s[8:11], 0 offen sc1
  s_waitcnt vmcnt(3)
  v_cmp_gt_u32 vcc, s18, v53
  s_cbranch_vccz cB_va0_fw_d
  buffer_load_dword v53, v4, s[8:11], 0 offen sc1
  s_waitcnt vmcnt(3)
  v_cmp_gt_u32 vcc, s18, v54
  s_cbranch_vccz cB_va0_fw_d
  buffer_load_dword v54, v4, s[8:11], 0 offen sc1
  s_waitcnt vmcnt(3)
  v_cmp_gt_u32 vcc, s18, v55
  s_cbranch_vccz cB_va0_fw_d
  buffer_load_dword v55, v4, s[8:11], 0 offen sc1
  s_add_u32 s30, s30, 1
  s_cmp_lt_u32 s30, 400000
  s_cbranch_scc1 cB_va0_fw_l
  s_branch cB_abort
cB_va0_fw_d:
  buffer_load_dwordx4 v[8:11], v2, s[8:11], s22 offen offset:0 sc1
  buffer_load_dwordx4 v[12:15], v2, s[8:11], s22 offen offset:1024 sc1
  buffer_load_dwordx4 v[16:19], v2, s[8:11], s22 offen offset:2048 sc1
  buffer_load_dwordx4 v[20:23], v2, s[8:11], s22 offen offset:3072 sc1
  buffer_load_dwordx4 v[24:27], v2, s[8:11], s34 offen offset:0 sc1
  buffer_load_dwordx4 v[28:31], v2, s[8:11], s34 offen offset:1024 sc1
  buffer_load_dwordx4 v[32:35], v2, s[8:11], s34 offen offset:2048 sc1
  buffer_load_dwordx4 v[36:39], v2, s[8:11], s34 offen offset:3072 sc1
  buffer_load_dwordx4 v[40:43], v2, s[8:11], s36 offen offset:0 sc1
  buffer_load_dwordx4 v[44:47], v2, s[8:11], s36 offen offset:1024 sc1
  s_barrier
  ds_read_b128 v[64:67], v2 offset:0
  ds_read_b128 v[68:71], v2 offset:1024
  ds_read_b128 v[72:75], v2 offset:2048
  ds_read_b128 v[76:79], v2 offset:3072
cB_va0_lp:
  s_waitcnt vmcnt(9)
  v_smfmac_f32_16x16x64_bf16 v[48:51], v[8:11], v[80:87], v3
  s_waitcnt vmcnt(8)
  v_smfmac_f32_16x16x64_bf16 v[48:51], v[12:15], v[88:95], v3
  s_waitcnt vmcnt(7)
  v_smfmac_f32_16x16x64_bf16 v[48:51], v[16:19], v[96:103], v3
  s_waitcnt vmcnt(6)
  v_smfmac_f32_16x16x64_bf16 v[48:51], v[20:23], v[104:111], v3
  s_waitcnt vmcnt(5)
  v_smfmac_f32_16x16x64_bf16 v[48:51], v[24:27], v[112:119], v3
  s_waitcnt vmcnt(4)
  v_smfmac_f32_16x16x64_bf16 v[48:51], v[28:31], v[120:127], v3
  s_waitcnt vmcnt(3)
  v_smfmac_f32_16x16x64_bf16 v[48:51], v[32:35], v[128:135], v3
  s_waitcnt vmcnt(2)
  v_smfmac_f32_16x16x64_bf16 v[48:51], v[36:39], v[136:143], v3
  s_waitcnt vmcnt(1) lgkmcnt(0)
  v_smfmac_f32_16x16x64_bf16 v[48:51], v[40:43], v[64:71], v3
  s_waitcnt vmcnt(0)
  v_smfmac_f32_16x16x64_bf16 v[48:51], v[44:47], v[72:79], v3
  s_nop 7
  v_permlane32_swap_b32 v48, v50
  v_permlane32_swap_b32 v49, v51
  v_add_f32 v48, v48, v50
  v_add_f32 v49, v49, v51
  v_cvt_pk_bf16_f32 v160, v48, v49
  v_cmp_u_f32 vcc, v48, v49
  s_nop 0
  v_mov_b32_dpp v161, v160 quad_perm:[1,0,3,2] row_mask:0xf bank_mask:0xf
  v_perm_b32 v160, v161, v160, v5
  v_min_u32 v160, -2, v160
  s_cbranch_vccnz cB_va0_rp
cB_va0_cont:
  buffer_store_dword v160, v1, s[8:11], s21 offen sc1
  s_setprio 0
  s_cmp_lg_u32 s19, 62
  s_cbranch_scc1 cB_va0_nl
  buffer_store_dword v160, v1, s[8:11], s38 offen sc1
  s_waitcnt vmcnt(0)
  buffer_wbl2 sc1
  s_branch cB_done
cB_va0_nl:
  s_add_u32 s25, s25, 458752
  v_mov_b32 v36, 0
  v_mov_b32 v37, 0
  v_mov_b32 v38, 0
  v_mov_b32 v39, 0
  v_mov_b32 v40, 0
  v_mov_b32 v41, 0
  v_mov_b32 v42, 0
  v_mov_b32 v43, 0
  v_mov_b32 v44, 0
  v_mov_b32 v45, 0
  v_mov_b32 v46, 0
  v_mov_b32 v47, 0
  v_mov_b32 v48, 0
  v_mov_b32 v49, 0
  v_mov_b32 v50, 0
  v_mov_b32 v51, 0
  v_mov_b32 v52, 0
  v_mov_b32 v53, 0
  v_mov_b32 v54, 0
  v_mov_b32 v55, 0
  v_mov_b32 v56, 0
  v_mov_b32 v57, 0
  v_mov_b32 v58, 0
  v_mov_b32 v59, 0
  v_mov_b32 v60, 0
  v_mov_b32 v61, 0
  v_mov_b32 v62, 0
  v_mov_b32 v63, 0
  s_mov_b32 s19, s18
  s_add_u32 s18, s18, 1
  s_mov_b32 s22, s20
  s_mov_b32 s20, s21
  s_mov_b32 s21, s22
  s_add_u32 s23, s20, 4096
  s_branch cB_va0_loop
cB_va0_slow:
  s_waitcnt lgkmcnt(0)
cB_va0_sl1:
  s_add_u32 s31, s31, 0x1000000
  buffer_load_dwordx4 v[8:11], v2, s[8:11], s20 offen offset:0 sc1
  buffer_load_dwordx4 v[12:15], v2, s[8:11], s20 offen offset:1024 sc1
  buffer_load_dwordx4 v[16:19], v2, s[8:11], s20 offen offset:2048 sc1
  buffer_load_dwordx4 v[20:23], v2, s[8:11], s20 offen offset:3072 sc1
  buffer_load_dwordx4 v[24:27], v2, s[8:11], s23 offen offset:0 sc1
  buffer_load_dwordx4 v[28:31], v2, s[8:11], s23 offen offset:1024 sc1
  buffer_load_dwordx4 v[32:35], v2, s[8:11], s23 offen offset:2048 sc1
  s_waitcnt vmcnt(0)
  v_max3_u32 v36, v8, v9, v10
  v_max3_u32 v36, v36, v11, v12
  v_max3_u32 v36, v36, v13, v14
  v_max3_u32 v36, v36, v15, v16
  v_max3_u32 v36, v36, v17, v18
  v_max3_u32 v36, v36, v19, v20
  v_max3_u32 v36, v36, v21, v22
  v_max3_u32 v36, v36, v23, v24
  v_max3_u32 v36, v36, v25, v26
  v_max3_u32 v36, v36, v27, v28
  v_max3_u32 v36, v36, v29, v30
  v_max3_u32 v36, v36, v31, v32
  v_max3_u32 v36, v36, v33, v34
  v_max_u32 v36, v36, v35
  v_cmp_eq_u32 vcc, -1, v36
  s_cbranch_vccz cB_va0_sl2
  s_add_u32 s30, s30, 1
  s_cmp_lt_u32 s30, 400000
  s_cbranch_scc1 cB_va0_sl1
  s_branch cB_abort
cB_va0_sl2:
  v_mov_b32 v36, 0
  v_mov_b32 v37, 0
  v_mov_b32 v38, 0
  v_mov_b32 v39, 0
  v_mov_b32 v40, 0
  v_mov_b32 v41, 0
  v_mov_b32 v42, 0
  v_mov_b32 v43, 0
  v_mov_b32 v44, 0
  v_mov_b32 v45, 0
  v_mov_b32 v46, 0
  v_mov_b32 v47, 0
  v_mov_b32 v48, 0
  v_mov_b32 v49, 0
  v_mov_b32 v50, 0
  v_mov_b32 v51, 0
  v_mov_b32 v52, 0
  v_mov_b32 v53, 0
  v_mov_b32 v54, 0
  v_mov_b32 v55, 0
  v_mov_b32 v56, 0
  v_mov_b32 v57, 0
  v_mov_b32 v58, 0
  v_mov_b32 v59, 0
  v_mov_b32 v60, 0
  v_mov_b32 v61, 0
  v_mov_b32 v62, 0
  v_mov_b32 v63, 0
  buffer_store_dword v162, v1, s[8:11], s21 offen sc1
  ds_read_b128 v[64:67], v0 offset:0
  ds_read_b128 v[68:71], v0 offset:1024
  v_smfmac_f32_16x16x64_bf16 v[36:39], v[8:11], a[0:7], v3
  v_smfmac_f32_16x16x64_bf16 v[40:43], v[8:11], a[56:63], v3
  v_smfmac_f32_16x16x64_bf16 v[44:47], v[8:11], a[112:119], v3
  v_smfmac_f32_16x16x64_bf16 v[48:51], v[8:11], a[168:175], v3
  v_smfmac_f32_16x16x64_bf16 v[52:55], v[8:11], a[224:231], v3
  v_smfmac_f32_16x16x64_bf16 v[56:59], v[8:11], v[200:207], v3
  s_waitcnt lgkmcnt(0)
  v_smfmac_f32_16x16x64_bf16 v[60:63], v[8:11], v[64:71], v3
  ds_read_b128 v[72:75], v0 offset:2048
  ds_read_b128 v[76:79], v0 offset:3072
  v_smfmac_f32_16x16x64_bf16 v[36:39], v[12:15], a[8:15], v3
  v_smfmac_f32_16x16x64_bf16 v[40:43], v[12:15], a[64:71], v3
  v_smfmac_f32_16x16x64_bf16 v[44:47], v[12:15], a[120:127], v3
  v_smfmac_f32_16x16x64_bf16 v[48:51], v[12:15], a[176:183], v3
  v_smfmac_f32_16x16x64_bf16 v[52:55], v[12:15], a[232:239], v3
  v_smfmac_f32_16x16x64_bf16 v[56:59], v[12:15], v[208:215], v3
  s_waitcnt lgkmcnt(0)
  v_smfmac_f32_16x16x64_bf16 v[60:63], v[12:15], v[72:79], v3
  ds_read_b128 v[144:147], v0 offset:4096
  ds_read_b128 v[148:151], v0 offset:5120
  v_smfmac_f32_16x16x64_bf16 v[36:39], v[16:19], a[16:23], v3
  v_smfmac_f32_16x16x64_bf16 v[40:43], v[16:19], a[72:79], v3
  v_smfmac_f32_16x16x64_bf16 v[44:47], v[16:19], a[128:135], v3
  v_smfmac_f32_16x16x64_bf16 v[48:51], v[16:19], a[184:191], v3
  v_smfmac_f32_16x16x64_bf16 v[52:55], v[16:19], a[240:247], v3
  v_smfmac_f32_16x16x64_bf16 v[56:59], v[16:19], v[216:223], v3
  s_waitcnt lgkmcnt(0)
  v_smfmac_f32_16x16x64_bf16 v[60:63], v[16:19], v[144:151], v3
  ds_read_b128 v[64:67], v0 offset:6144
  ds_read_b128 v[68:71], v0 offset:7168
  v_smfmac_f32_16x16x64_bf16 v[36:39], v[20:23], a[24:31], v3
  v_smfmac_f32_16x16x64_bf16 v[40:43], v[20:23], a[80:87], v3
  v_smfmac_f32_16x16x64_bf16 v[44:47], v[20:23], a[136:143], v3
  v_smfmac_f32_16x16x64_bf16 v[48:51], v[20:23], a[192:199], v3
  v_smfmac_f32_16x16x64_bf16 v[52:55], v[20:23], a[248:255], v3
  v_smfmac_f32_16x16x64_bf16 v[56:59], v[20:23], v[224:231], v3
  s_waitcnt lgkmcnt(0)
  v_smfmac_f32_16x16x64_bf16 v[60:63], v[20:23], v[64:71], v3
  ds_read_b128 v[72:75], v0 offset:8192
  ds_read_b128 v[76:79], v0 offset:9216
  v_smfmac_f32_16x16x64_bf16 v[36:39], v[24:27], a[32:39], v3
  v_smfmac_f32_16x16x64_bf16 v[40:43], v[24:27], a[88:95], v3
  v_smfmac_f32_16x16x64_bf16 v[44:47], v[24:27], a[144:151], v3
  v_smfmac_f32_16x16x64_bf16 v[48:51], v[24:27], a[200:207], v3
  v_smfmac_f32_16x16x64_bf16 v[52:55], v[24:27], v[176:183], v3
  v_smfmac_f32_16x16x64_bf16 v[56:59], v[24:27], v[232:239], v3
  s_waitcnt lgkmcnt(0)
  v_smfmac_f32_16x16x64_bf16 v[60:63], v[24:27], v[72:79], v3
  ds_read_b128 v[144:147], v0 offset:10240
  ds_read_b128 v[148:151], v0 offset:11264
  v_smfmac_f32_16x16x64_bf16 v[36:39], v[28:31], a[40:47], v3
  v_smfmac_f32_16x16x64_bf16 v[40:43], v[28:31], a[96:103], v3
  v_smfmac_f32_16x16x64_bf16 v[44:47], v[28:31], a[152:159], v3
  v_smfmac_f32_16x16x64_bf16 v[48:51], v[28:31], a[208:215], v3
  v_smfmac_f32_16x16x64_bf16 v[52:55], v[28:31], v[184:191], v3
  v_smfmac_f32_16x16x64_bf16 v[56:59], v[28:31], v[240:247], v3
  s_waitcnt lgkmcnt(0)
  v_smfmac_f32_16x16x64_bf16 v[60:63], v[28:31], v[144:151], v3
  ds_read_b128 v[64:67], v0 offset:12288
  ds_read_b128 v[68:71], v0 offset:13312
  v_smfmac_f32_16x16x64_bf16 v[36:39], v[32:35], a[48:55], v3
  v_smfmac_f32_16x16x64_bf16 v[40:43], v[32:35], a[104:111], v3
  v_smfmac_f32_16x16x64_bf16 v[44:47], v[32:35], a[160:167], v3
  v_smfmac_f32_16x16x64_bf16 v[48:51], v[32:35], a[216:223], v3
  v_smfmac_f32_16x16x64_bf16 v[52:55], v[32:35], v[192:199], v3
  v_smfmac_f32_16x16x64_bf16 v[56:59], v[32:35], v[248:255], v3
  s_waitcnt lgkmcnt(0)
  v_smfmac_f32_16x16x64_bf16 v[60:63], v[32:35], v[64:71], v3
  v_permlane32_swap_b32 v36, v38
  v_permlane32_swap_b32 v37, v39
  v_add_f32 v36, v36, v38
  v_add_f32 v37, v37, v39
  v_cvt_pk_bf16_f32 v38, v36, v37
  ds_write_b32 v152, v38
  v_permlane32_swap_b32 v40, v42
  v_permlane32_swap_b32 v41, v43
  v_add_f32 v40, v40, v42
  v_add_f32 v41, v41, v43
  v_cvt_pk_bf16_f32 v42, v40, v41
  ds_write_b32 v153, v42
  v_permlane32_swap_b32 v44, v46
  v_permlane32_swap_b32 v45, v47
  v_add_f32 v44, v44, v46
  v_add_f32 v45, v45, v47
  v_cvt_pk_bf16_f32 v46, v44, v45
  ds_write_b32 v154, v46
  v_permlane32_swap_b32 v48, v50
  v_permlane32_swap_b32 v49, v51
  v_add_f32 v48, v48, v50
  v_add_f32 v49, v49, v51
  v_cvt_pk_bf16_f32 v50, v48, v49
  ds_write_b32 v155, v50
  v_permlane32_swap_b32 v52, v54
  v_permlane32_swap_b32 v53, v55
  v_add_f32 v52, v52, v54
  v_add_f32 v53, v53, v55
  v_cvt_pk_bf16_f32 v54, v52, v53
  ds_write_b32 v156, v54
  v_permlane32_swap_b32 v56, v58
  v_permlane32_swap_b32 v57, v59
  v_add_f32 v56, v56, v58
  v_add_f32 v57, v57, v59
  v_cvt_pk_bf16_f32 v58, v56, v57
  ds_write_b32 v157, v58
  v_permlane32_swap_b32 v60, v62
  v_permlane32_swap_b32 v61, v63
  v_add_f32 v60, v60, v62
  v_add_f32 v61, v61, v63
  v_cvt_pk_bf16_f32 v62, v60, v61
  ds_write_b32 v158, v62
  s_branch cB_va0_t2d
cB_va0_rp:
  s_cmp_lg_u32 s37, 0
  s_cbranch_scc1 cB_va0_cont
cB_va0_rv:
  s_add_u32 s31, s31, 0x10000
  buffer_load_dwordx4 v[8:11], v2, s[8:11], s22 offen offset:0 sc1
  buffer_load_dwordx4 v[12:15], v2, s[8:11], s22 offen offset:1024 sc1
  buffer_load_dwordx4 v[16:19], v2, s[8:11], s22 offen offset:2048 sc1
  buffer_load_dwordx4 v[20:23], v2, s[8:11], s22 offen offset:3072 sc1
  buffer_load_dwordx4 v[24:27], v2, s[8:11], s34 offen offset:0 sc1
  buffer_load_dwordx4 v[28:31], v2, s[8:11], s34 offen offset:1024 sc1
  buffer_load_dwordx4 v[32:35], v2, s[8:11], s34 offen offset:2048 sc1
  buffer_load_dwordx4 v[36:39], v2, s[8:11], s34 offen offset:3072 sc1
  buffer_load_dwordx4 v[40:43], v2, s[8:11], s36 offen offset:0 sc1
  buffer_load_dwordx4 v[44:47], v2, s[8:11], s36 offen offset:1024 sc1
  s_waitcnt vmcnt(0)
  v_max3_u32 v52, v8, v9, v10
  v_max3_u32 v52, v52, v11, v12
  v_max3_u32 v52, v52, v13, v14
  v_max3_u32 v52, v52, v15, v16
  v_max3_u32 v52, v52, v17, v18
  v_max3_u32 v52, v52, v19, v20
  v_max3_u32 v52, v52, v21, v22
  v_max3_u32 v52, v52, v23, v24
  v_max3_u32 v52, v52, v25, v26
  v_max3_u32 v52, v52, v27, v28
  v_max3_u32 v52, v52, v29, v30
  v_max3_u32 v52, v52, v31, v32
  v_max3_u32 v52, v52, v33, v34
  v_max3_u32 v52, v52, v35, v36
  v_max3_u32 v52, v52, v37, v38
  v_max3_u32 v52, v52, v39, v40
  v_max3_u32 v52, v52, v41, v42
  v_max3_u32 v52, v52, v43, v44
  v_max3_u32 v52, v52, v45, v46
  v_max_u32 v52, v52, v47
  v_cmp_eq_u32 vcc, -1, v52
  s_mov_b32 s37, 1
  v_mov_b32 v48, 0
  v_mov_b32 v49, 0
  v_mov_b32 v50, 0
  v_mov_b32 v51, 0
  s_nop 1
  s_cbranch_vccz cB_va0_lp
  s_add_u32 s30, s30, 1
  s_cmp_lt_u32 s30, 400000
  s_cbranch_scc1 cB_va0_rv
  s_branch cB_abort
.p2align 6
cB_va1_loop:
  s_mov_b32 s30, 0
  s_barrier
  buffer_load_dwordx4 v[28:31], v2, s[8:11], s23 offen offset:1024 sc1
  buffer_load_dwordx4 v[32:35], v2, s[8:11], s23 offen offset:2048 sc1
  s_barrier
  buffer_store_dword v160, v1, s[8:11], s38 offen sc1
  s_add_u32 s22, s25, 0
  buffer_load_dwordx4 v[80:83], v6, s[8:11], s22 offen offset:0 sc1
  buffer_load_dwordx4 v[84:87], v6, s[8:11], s22 offen offset:1792 sc1
  s_add_u32 s22, s25, 3584
  buffer_load_dwordx4 v[88:91], v6, s[8:11], s22 offen offset:0 sc1
  buffer_load_dwordx4 v[92:95], v6, s[8:11], s22 offen offset:1792 sc1
  s_add_u32 s22, s25, 7168
  buffer_load_dwordx4 v[96:99], v6, s[8:11], s22 offen offset:0 sc1
  s_mul_i32 s38, s18, 7168
  s_add_u32 s38, s38, 88002560
  s_waitcnt vmcnt(6)
  ds_write_b128 v2, v[32:35] offset:14336
  v_smfmac_f32_16x16x64_bf16 v[36:39], v[28:31], a[40:47], v3
  buffer_load_dwordx4 v[100:103], v6, s[8:11], s22 offen offset:1792 sc1
  v_smfmac_f32_16x16x64_bf16 v[40:43], v[28:31], a[96:103], v3
  s_add_u32 s22, s25, 10752
  buffer_load_dwordx4 v[104:107], v6, s[8:11], s22 offen offset:0 sc1
  v_smfmac_f32_16x16x64_bf16 v[44:47], v[28:31], a[152:159], v3
  buffer_load_dwordx4 v[108:111], v6, s[8:11], s22 offen offset:1792 sc1
  v_smfmac_f32_16x16x64_bf16 v[48:51], v[28:31], a[208:215], v3
  s_add_u32 s22, s25, 14336
  buffer_load_dwordx4 v[112:115], v6, s[8:11], s22 offen offset:0 sc1
  v_smfmac_f32_16x16x64_bf16 v[52:55], v[28:31], v[184:191], v3
  s_waitcnt lgkmcnt(0)
  s_barrier
  ds_read_b128 v[8:11], v2 offset:8192
  ds_read_b128 v[12:15], v2 offset:9216
  ds_read_b128 v[16:19], v2 offset:10240
  ds_read_b128 v[20:23], v2 offset:11264
  ds_read_b128 v[24:27], v2 offset:12288
  buffer_load_dwordx4 v[116:119], v6, s[8:11], s22 offen offset:1792 sc1
  v_smfmac_f32_16x16x64_bf16 v[56:59], v[28:31], v[240:247], v3
  s_add_u32 s22, s25, 17920
  buffer_load_dwordx4 v[120:123], v6, s[8:11], s22 offen offset:0 sc1
  v_smfmac_f32_16x16x64_bf16 v[36:39], v[32:35], a[48:55], v3
  buffer_load_dwordx4 v[124:127], v6, s[8:11], s22 offen offset:1792 sc1
  v_smfmac_f32_16x16x64_bf16 v[40:43], v[32:35], a[104:111], v3
  s_add_u32 s22, s25, 21504
  buffer_load_dwordx4 v[128:131], v6, s[8:11], s22 offen offset:0 sc1
  v_smfmac_f32_16x16x64_bf16 v[44:47], v[32:35], a[160:167], v3
  buffer_load_dwordx4 v[132:135], v6, s[8:11], s22 offen offset:1792 sc1
  v_smfmac_f32_16x16x64_bf16 v[48:51], v[32:35], a[216:223], v3
  s_add_u32 s22, s25, 25088
  buffer_load_dwordx4 v[136:139], v6, s[8:11], s22 offen offset:0 sc1
  v_smfmac_f32_16x16x64_bf16 v[52:55], v[32:35], v[192:199], v3
  ds_read_b128 v[64:67], v0 offset:0
  ds_read_b128 v[68:71], v0 offset:1024
  buffer_load_dwordx4 v[140:143], v6, s[8:11], s22 offen offset:1792 sc1
  v_smfmac_f32_16x16x64_bf16 v[56:59], v[32:35], v[248:255], v3
  s_waitcnt lgkmcnt(6)
  ds_read_b128 v[72:75], v0 offset:2048
  ds_read_b128 v[76:79], v0 offset:3072
  v_smfmac_f32_16x16x64_bf16 v[36:39], v[8:11], a[0:7], v3
  s_waitcnt lgkmcnt(7)
  v_smfmac_f32_16x16x64_bf16 v[36:39], v[12:15], a[8:15], v3
  s_waitcnt lgkmcnt(6)
  v_smfmac_f32_16x16x64_bf16 v[36:39], v[16:19], a[16:23], v3
  s_waitcnt lgkmcnt(2)
  v_smfmac_f32_16x16x64_bf16 v[60:63], v[8:11], v[64:71], v3
  s_waitcnt lgkmcnt(5)
  ds_read_b128 v[144:147], v0 offset:4096
  ds_read_b128 v[148:151], v0 offset:5120
  v_smfmac_f32_16x16x64_bf16 v[36:39], v[20:23], a[24:31], v3
  s_waitcnt lgkmcnt(6)
  v_smfmac_f32_16x16x64_bf16 v[36:39], v[24:27], a[32:39], v3
  v_smfmac_f32_16x16x64_bf16 v[40:43], v[8:11], a[56:63], v3
  s_waitcnt lgkmcnt(2)
  v_smfmac_f32_16x16x64_bf16 v[60:63], v[12:15], v[72:79], v3
  ds_read_b128 v[64:67], v0 offset:6144
  ds_read_b128 v[68:71], v0 offset:7168
  v_smfmac_f32_16x16x64_bf16 v[40:43], v[12:15], a[64:71], v3
  v_permlane32_swap_b32 v36, v38
  v_smfmac_f32_16x16x64_bf16 v[40:43], v[16:19], a[72:79], v3
  v_permlane32_swap_b32 v37, v39
  v_smfmac_f32_16x16x64_bf16 v[40:43], v[20:23], a[80:87], v3
  s_waitcnt lgkmcnt(2)
  v_add_f32 v36, v36, v38
  v_smfmac_f32_16x16x64_bf16 v[60:63], v[16:19], v[144:151], v3
  ds_read_b128 v[72:75], v0 offset:8192
  ds_read_b128 v[76:79], v0 offset:9216
  v_add_f32 v37, v37, v39
  v_smfmac_f32_16x16x64_bf16 v[40:43], v[24:27], a[88:95], v3
  v_cmp_u_f32 vcc, v36, v37
  v_smfmac_f32_16x16x64_bf16 v[44:47], v[8:11], a[112:119], v3
  v_cvt_pk_bf16_f32 v38, v36, v37
  v_smfmac_f32_16x16x64_bf16 v[44:47], v[12:15], a[120:127], v3
  ds_write_b32 v152, v38
  s_waitcnt lgkmcnt(3)
  s_cbranch_vccnz cB_va1_slow
  v_permlane32_swap_b32 v40, v42
  v_smfmac_f32_16x16x64_bf16 v[60:63], v[20:23], v[64:71], v3
  ds_read_b128 v[144:147], v0 offset:10240
  ds_read_b128 v[148:151], v0 offset:11264
  v_permlane32_swap_b32 v41, v43
  v_smfmac_f32_16x16x64_bf16 v[44:47], v[16:19], a[128:135], v3
  buffer_store_dword v162, v1, s[8:11], s21 offen sc1
  v_add_f32 v40, v40, v42
  v_smfmac_f32_16x16x64_bf16 v[44:47], v[20:23], a[136:143], v3
  v_add_f32 v41, v41, v43
  v_smfmac_f32_16x16x64_bf16 v[44:47], v[24:27], a[144:151], v3
  s_waitcnt lgkmcnt(3)
  v_cvt_pk_bf16_f32 v42, v40, v41
  v_smfmac_f32_16x16x64_bf16 v[60:63], v[24:27], v[72:79], v3
  ds_write_b32 v153, v42
  ds_read_b128 v[64:67], v0 offset:12288
  ds_read_b128 v[68:71], v0 offset:13312
  v_smfmac_f32_16x16x64_bf16 v[48:51], v[8:11], a[168:175], v3
  s_nop 0
  v_permlane32_swap_b32 v44, v46
  v_smfmac_f32_16x16x64_bf16 v[48:51], v[12:15], a[176:183], v3
  v_permlane32_swap_b32 v45, v47
  v_smfmac_f32_16x16x64_bf16 v[48:51], v[16:19], a[184:191], v3
  s_waitcnt lgkmcnt(3)
  v_add_f32 v44, v44, v46
  v_smfmac_f32_16x16x64_bf16 v[60:63], v[28:31], v[144:151], v3
  v_add_f32 v45, v45, v47
  v_smfmac_f32_16x16x64_bf16 v[48:51], v[20:23], a[192:199], v3
  v_cvt_pk_bf16_f32 v46, v44, v45
  v_smfmac_f32_16x16x64_bf16 v[48:51], v[24:27], a[200:207], v3
  ds_write_b32 v154, v46
  v_smfmac_f32_16x16x64_bf16 v[52:55], v[8:11], a[224:231], v3
  s_waitcnt lgkmcnt(1)
  v_smfmac_f32_16x16x64_bf16 v[60:63], v[32:35], v[64:71], v3
  v_smfmac_f32_16x16x64_bf16 v[52:55], v[12:15], a[232:239], v3
  v_permlane32_swap_b32 v48, v50
  v_smfmac_f32_16x16x64_bf16 v[52:55], v[16:19], a[240:247], v3
  v_permlane32_swap_b32 v49, v51
  v_smfmac_f32_16x16x64_bf16 v[52:55], v[20:23], a[248:255], v3
  v_add_f32 v48, v48, v50
  v_smfmac_f32_16x16x64_bf16 v[52:55], v[24:27], v[176:183], v3
  v_add_f32 v49, v49, v51
  v_smfmac_f32_16x16x64_bf16 v[56:59], v[8:11], v[200:207], v3
  v_cvt_pk_bf16_f32 v50, v48, v49
  v_smfmac_f32_16x16x64_bf16 v[56:59], v[12:15], v[208:215], v3
  ds_write_b32 v155, v50
  v_permlane32_swap_b32 v60, v62
  v_smfmac_f32_16x16x64_bf16 v[56:59], v[16:19], v[216:223], v3
  v_permlane32_swap_b32 v61, v63
  v_smfmac_f32_16x16x64_bf16 v[56:59], v[20:23], v[224:231], v3
  v_add_f32 v60, v60, v62
  v_smfmac_f32_16x16x64_bf16 v[56:59], v[24:27], v[232:239], v3
  v_add_f32 v61, v61, v63
  v_cvt_pk_bf16_f32 v62, v60, v61
  ds_write_b32 v158, v62
  v_permlane32_swap_b32 v52, v54
  v_permlane32_swap_b32 v53, v55
  v_add_f32 v52, v52, v54
  v_add_f32 v53, v53, v55
  v_cvt_pk_bf16_f32 v54, v52, v53
  ds_write_b32 v156, v54
  v_permlane32_swap_b32 v56, v58
  v_permlane32_swap_b32 v57, v59
  v_add_f32 v56, v56, v58
  v_add_f32 v57, v57, v59
  v_cvt_pk_bf16_f32 v58, v56, v57
  ds_write_b32 v157, v58
cB_va1_t2d:
  s_add_u32 s22, s20, 9216
  s_add_u32 s34, s20, 13312
  s_add_u32 s36, s20, 7168
  s_mov_b32 s37, 0
  v_mov_b32 v48, 0
  v_mov_b32 v49, 0
  v_mov_b32 v50, 0
  v_mov_b32 v51, 0
  v_mov_b32 v163, s18
  s_waitcnt lgkmcnt(0)
  s_barrier
  buffer_load_dwordx4 v[8:11], v2, s[8:11], s22 offen offset:0 sc1
  buffer_load_dwordx4 v[12:15], v2, s[8:11], s22 offen offset:1024 sc1
  buffer_load_dwordx4 v[16:19], v2, s[8:11], s22 offen offset:2048 sc1
  buffer_load_dwordx4 v[20:23], v2, s[8:11], s22 offen offset:3072 sc1
  buffer_load_dwordx4 v[24:27], v2, s[8:11], s34 offen offset:0 sc1
  buffer_load_dwordx4 v[28:31], v2, s[8:11], s34 offen offset:1024 sc1
  buffer_load_dwordx4 v[32:35], v2, s[8:11], s34 offen offset:2048 sc1
  buffer_load_dwordx4 v[36:39], v2, s[8:11], s34 offen offset:3072 sc1
  buffer_load_dwordx4 v[40:43], v2, s[8:11], s36 offen offset:0 sc1
  buffer_load_dwordx4 v[44:47], v2, s[8:11], s36 offen offset:1024 sc1
  ds_read_b128 v[64:67], v2 offset:4096
  ds_read_b128 v[68:71], v2 offset:5120
  ds_read_b128 v[72:75], v2 offset:6144
  ds_read_b128 v[76:79], v2 offset:7168
cB_va1_lp:
  s_waitcnt vmcnt(9)
  v_smfmac_f32_16x16x64_bf16 v[48:51], v[8:11], v[80:87], v3
  s_waitcnt vmcnt(8)
  v_smfmac_f32_16x16x64_bf16 v[48:51], v[12:15], v[88:95], v3
  s_waitcnt vmcnt(7)
  v_smfmac_f32_16x16x64_bf16 v[48:51], v[16:19], v[96:103], v3
  v_max3_u32 v55, v8, v12, v16
  s_waitcnt vmcnt(6)
  v_smfmac_f32_16x16x64_bf16 v[48:51], v[20:23], v[104:111], v3
  v_max_u32 v55, v55, v20
  v_cmp_eq_u32 vcc, -1, v55
  s_waitcnt vmcnt(5)
  v_smfmac_f32_16x16x64_bf16 v[48:51], v[24:27], v[112:119], v3
  s_waitcnt vmcnt(4)
  v_smfmac_f32_16x16x64_bf16 v[48:51], v[28:31], v[120:127], v3
  s_cbranch_vccnz cB_va1_rv
  buffer_store_dword v163, v7, s[8:11], 0 offen sc1
  s_waitcnt vmcnt(4)
  v_smfmac_f32_16x16x64_bf16 v[48:51], v[32:35], v[128:135], v3
  s_waitcnt vmcnt(3)
  v_smfmac_f32_16x16x64_bf16 v[48:51], v[36:39], v[136:143], v3
  s_waitcnt vmcnt(2) lgkmcnt(0)
  v_smfmac_f32_16x16x64_bf16 v[48:51], v[40:43], v[64:71], v3
  s_waitcnt vmcnt(1)
  v_smfmac_f32_16x16x64_bf16 v[48:51], v[44:47], v[72:79], v3
  s_nop 7
  v_permlane32_swap_b32 v48, v50
  v_permlane32_swap_b32 v49, v51
  v_add_f32 v48, v48, v50
  v_add_f32 v49, v49, v51
  v_cvt_pk_bf16_f32 v160, v48, v49
  v_cmp_u_f32 vcc, v48, v49
  s_nop 0
  v_mov_b32_dpp v161, v160 quad_perm:[1,0,3,2] row_mask:0xf bank_mask:0xf
  v_perm_b32 v160, v161, v160, v5
  v_min_u32 v160, -2, v160
  s_cbranch_vccnz cB_va1_rp
cB_va1_cont:
  buffer_store_dword v160, v1, s[8:11], s21 offen sc1
  s_cmp_lg_u32 s19, 62
  s_cbranch_scc1 cB_va1_nl
  buffer_store_dword v160, v1, s[8:11], s38 offen sc1
  s_waitcnt vmcnt(0)
  buffer_wbl2 sc1
  s_branch cB_done
cB_va1_nl:
  s_add_u32 s25, s25, 458752
  v_mov_b32 v36, 0
  v_mov_b32 v37, 0
  v_mov_b32 v38, 0
  v_mov_b32 v39, 0
  v_mov_b32 v40, 0
  v_mov_b32 v41, 0
  v_mov_b32 v42, 0
  v_mov_b32 v43, 0
  v_mov_b32 v44, 0
  v_mov_b32 v45, 0
  v_mov_b32 v46, 0
  v_mov_b32 v47, 0
  v_mov_b32 v48, 0
  v_mov_b32 v49, 0
  v_mov_b32 v50, 0
  v_mov_b32 v51, 0
  v_mov_b32 v52, 0
  v_mov_b32 v53, 0
  v_mov_b32 v54, 0
  v_mov_b32 v55, 0
  v_mov_b32 v56, 0
  v_mov_b32 v57, 0
  v_mov_b32 v58, 0
  v_mov_b32 v59, 0
  v_mov_b32 v60, 0
  v_mov_b32 v61, 0
  v_mov_b32 v62, 0
  v_mov_b32 v63, 0
  s_mov_b32 s19, s18
  s_add_u32 s18, s18, 1
  s_mov_b32 s22, s20
  s_mov_b32 s20, s21
  s_mov_b32 s21, s22
  s_add_u32 s23, s20, 4096
  s_branch cB_va1_loop
cB_va1_slow:
  s_waitcnt lgkmcnt(0)
cB_va1_sl1:
  s_add_u32 s31, s31, 0x1000000
  buffer_load_dwordx4 v[8:11], v2, s[8:11], s20 offen offset:0 sc1
  buffer_load_dwordx4 v[12:15], v2, s[8:11], s20 offen offset:1024 sc1
  buffer_load_dwordx4 v[16:19], v2, s[8:11], s20 offen offset:2048 sc1
  buffer_load_dwordx4 v[20:23], v2, s[8:11], s20 offen offset:3072 sc1
  buffer_load_dwordx4 v[24:27], v2, s[8:11], s23 offen offset:0 sc1
  buffer_load_dwordx4 v[28:31], v2, s[8:11], s23 offen offset:1024 sc1
  buffer_load_dwordx4 v[32:35], v2, s[8:11], s23 offen offset:2048 sc1
  s_waitcnt vmcnt(0)
  v_max3_u32 v36, v8, v9, v10
  v_max3_u32 v36, v36, v11, v12
  v_max3_u32 v36, v36, v13, v14
  v_max3_u32 v36, v36, v15, v16
  v_max3_u32 v36, v36, v17, v18
  v_max3_u32 v36, v36, v19, v20
  v_max3_u32 v36, v36, v21, v22
  v_max3_u32 v36, v36, v23, v24
  v_max3_u32 v36, v36, v25, v26
  v_max3_u32 v36, v36, v27, v28
  v_max3_u32 v36, v36, v29, v30
  v_max3_u32 v36, v36, v31, v32
  v_max3_u32 v36, v36, v33, v34
  v_max_u32 v36, v36, v35
  v_cmp_eq_u32 vcc, -1, v36
  s_cbranch_vccz cB_va1_sl2
  s_add_u32 s30, s30, 1
  s_cmp_lt_u32 s30, 400000
  s_cbranch_scc1 cB_va1_sl1
  s_branch cB_abort
cB_va1_sl2:
  v_mov_b32 v36, 0
  v_mov_b32 v37, 0
  v_mov_b32 v38, 0
  v_mov_b32 v39, 0
  v_mov_b32 v40, 0
  v_mov_b32 v41, 0
  v_mov_b32 v42, 0
  v_mov_b32 v43, 0
  v_mov_b32 v44, 0
  v_mov_b32 v45, 0
  v_mov_b32 v46, 0
  v_mov_b32 v47, 0
  v_mov_b32 v48, 0
  v_mov_b32 v49, 0
  v_mov_b32 v50, 0
  v_mov_b32 v51, 0
  v_mov_b32 v52, 0
  v_mov_b32 v53, 0
  v_mov_b32 v54, 0
  v_mov_b32 v55, 0
  v_mov_b32 v56, 0
  v_mov_b32 v57, 0
  v_mov_b32 v58, 0
  v_mov_b32 v59, 0
  v_mov_b32 v60, 0
  v_mov_b32 v61, 0
  v_mov_b32 v62, 0
  v_mov_b32 v63, 0
  buffer_store_dword v162, v1, s[8:11], s21 offen sc1
  ds_read_b128 v[64:67], v0 offset:0
  ds_read_b128 v[68:71], v0 offset:1024
  v_smfmac_f32_16x16x64_bf16 v[36:39], v[8:11], a[0:7], v3
  v_smfmac_f32_16x16x64_bf16 v[40:43], v[8:11], a[56:63], v3
  v_smfmac_f32_16x16x64_bf16 v[44:47], v[8:11], a[112:119], v3
  v_smfmac_f32_16x16x64_bf16 v[48:51], v[8:11], a[168:175], v3
  v_smfmac_f32_16x16x64_bf16 v[52:55], v[8:11], a[224:231], v3
  v_smfmac_f32_16x16x64_bf16 v[56:59], v[8:11], v[200:207], v3
  s_waitcnt lgkmcnt(0)
  v_smfmac_f32_16x16x64_bf16 v[60:63], v[8:11], v[64:71], v3
  ds_read_b128 v[72:75], v0 offset:2048
  ds_read_b128 v[76:79], v0 offset:3072
  v_smfmac_f32_16x16x64_bf16 v[36:39], v[12:15], a[8:15], v3
  v_smfmac_f32_16x16x64_bf16 v[40:43], v[12:15], a[64:71], v3
  v_smfmac_f32_16x16x64_bf16 v[44:47], v[12:15], a[120:127], v3
  v_smfmac_f32_16x16x64_bf16 v[48:51], v[12:15], a[176:183], v3
  v_smfmac_f32_16x16x64_bf16 v[52:55], v[12:15], a[232:239], v3
  v_smfmac_f32_16x16x64_bf16 v[56:59], v[12:15], v[208:215], v3
  s_waitcnt lgkmcnt(0)
  v_smfmac_f32_16x16x64_bf16 v[60:63], v[12:15], v[72:79], v3
  ds_read_b128 v[144:147], v0 offset:4096
  ds_read_b128 v[148:151], v0 offset:5120
  v_smfmac_f32_16x16x64_bf16 v[36:39], v[16:19], a[16:23], v3
  v_smfmac_f32_16x16x64_bf16 v[40:43], v[16:19], a[72:79], v3
  v_smfmac_f32_16x16x64_bf16 v[44:47], v[16:19], a[128:135], v3
  v_smfmac_f32_16x16x64_bf16 v[48:51], v[16:19], a[184:191], v3
  v_smfmac_f32_16x16x64_bf16 v[52:55], v[16:19], a[240:247], v3
  v_smfmac_f32_16x16x64_bf16 v[56:59], v[16:19], v[216:223], v3
  s_waitcnt lgkmcnt(0)
  v_smfmac_f32_16x16x64_bf16 v[60:63], v[16:19], v[144:151], v3
  ds_read_b128 v[64:67], v0 offset:6144
  ds_read_b128 v[68:71], v0 offset:7168
  v_smfmac_f32_16x16x64_bf16 v[36:39], v[20:23], a[24:31], v3
  v_smfmac_f32_16x16x64_bf16 v[40:43], v[20:23], a[80:87], v3
  v_smfmac_f32_16x16x64_bf16 v[44:47], v[20:23], a[136:143], v3
  v_smfmac_f32_16x16x64_bf16 v[48:51], v[20:23], a[192:199], v3
  v_smfmac_f32_16x16x64_bf16 v[52:55], v[20:23], a[248:255], v3
  v_smfmac_f32_16x16x64_bf16 v[56:59], v[20:23], v[224:231], v3
  s_waitcnt lgkmcnt(0)
  v_smfmac_f32_16x16x64_bf16 v[60:63], v[20:23], v[64:71], v3
  ds_read_b128 v[72:75], v0 offset:8192
  ds_read_b128 v[76:79], v0 offset:9216
  v_smfmac_f32_16x16x64_bf16 v[36:39], v[24:27], a[32:39], v3
  v_smfmac_f32_16x16x64_bf16 v[40:43], v[24:27], a[88:95], v3
  v_smfmac_f32_16x16x64_bf16 v[44:47], v[24:27], a[144:151], v3
  v_smfmac_f32_16x16x64_bf16 v[48:51], v[24:27], a[200:207], v3
  v_smfmac_f32_16x16x64_bf16 v[52:55], v[24:27], v[176:183], v3
  v_smfmac_f32_16x16x64_bf16 v[56:59], v[24:27], v[232:239], v3
  s_waitcnt lgkmcnt(0)
  v_smfmac_f32_16x16x64_bf16 v[60:63], v[24:27], v[72:79], v3
  ds_read_b128 v[144:147], v0 offset:10240
  ds_read_b128 v[148:151], v0 offset:11264
  v_smfmac_f32_16x16x64_bf16 v[36:39], v[28:31], a[40:47], v3
  v_smfmac_f32_16x16x64_bf16 v[40:43], v[28:31], a[96:103], v3
  v_smfmac_f32_16x16x64_bf16 v[44:47], v[28:31], a[152:159], v3
  v_smfmac_f32_16x16x64_bf16 v[48:51], v[28:31], a[208:215], v3
  v_smfmac_f32_16x16x64_bf16 v[52:55], v[28:31], v[184:191], v3
  v_smfmac_f32_16x16x64_bf16 v[56:59], v[28:31], v[240:247], v3
  s_waitcnt lgkmcnt(0)
  v_smfmac_f32_16x16x64_bf16 v[60:63], v[28:31], v[144:151], v3
  ds_read_b128 v[64:67], v0 offset:12288
  ds_read_b128 v[68:71], v0 offset:13312
  v_smfmac_f32_16x16x64_bf16 v[36:39], v[32:35], a[48:55], v3
  v_smfmac_f32_16x16x64_bf16 v[40:43], v[32:35], a[104:111], v3
  v_smfmac_f32_16x16x64_bf16 v[44:47], v[32:35], a[160:167], v3
  v_smfmac_f32_16x16x64_bf16 v[48:51], v[32:35], a[216:223], v3
  v_smfmac_f32_16x16x64_bf16 v[52:55], v[32:35], v[192:199], v3
  v_smfmac_f32_16x16x64_bf16 v[56:59], v[32:35], v[248:255], v3
  s_waitcnt lgkmcnt(0)
  v_smfmac_f32_16x16x64_bf16 v[60:63], v[32:35], v[64:71], v3
  v_permlane32_swap_b32 v36, v38
  v_permlane32_swap_b32 v37, v39
  v_add_f32 v36, v36, v38
  v_add_f32 v37, v37, v39
  v_cvt_pk_bf16_f32 v38, v36, v37
  ds_write_b32 v152, v38
  v_permlane32_swap_b32 v40, v42
  v_permlane32_swap_b32 v41, v43
  v_add_f32 v40, v40, v42
  v_add_f32 v41, v41, v43
  v_cvt_pk_bf16_f32 v42, v40, v41
  ds_write_b32 v153, v42
  v_permlane32_swap_b32 v44, v46
  v_permlane32_swap_b32 v45, v47
  v_add_f32 v44, v44, v46
  v_add_f32 v45, v45, v47
  v_cvt_pk_bf16_f32 v46, v44, v45
  ds_write_b32 v154, v46
  v_permlane32_swap_b32 v48, v50
  v_permlane32_swap_b32 v49, v51
  v_add_f32 v48, v48, v50
  v_add_f32 v49, v49, v51
  v_cvt_pk_bf16_f32 v50, v48, v49
  ds_write_b32 v155, v50
  v_permlane32_swap_b32 v52, v54
  v_permlane32_swap_b32 v53, v55
  v_add_f32 v52, v52, v54
  v_add_f32 v53, v53, v55
  v_cvt_pk_bf16_f32 v54, v52, v53
  ds_write_b32 v156, v54
  v_permlane32_swap_b32 v56, v58
  v_permlane32_swap_b32 v57, v59
  v_add_f32 v56, v56, v58
  v_add_f32 v57, v57, v59
  v_cvt_pk_bf16_f32 v58, v56, v57
  ds_write_b32 v157, v58
  v_permlane32_swap_b32 v60, v62
  v_permlane32_swap_b32 v61, v63
  v_add_f32 v60, v60, v62
  v_add_f32 v61, v61, v63
  v_cvt_pk_bf16_f32 v62, v60, v61
  ds_write_b32 v158, v62
  s_branch cB_va1_t2d
cB_va1_rp:
  s_cmp_lg_u32 s37, 0
  s_cbranch_scc1 cB_va1_cont
cB_va1_rv:
  s_add_u32 s31, s31, 0x10000
  buffer_load_dwordx4 v[8:11], v2, s[8:11], s22 offen offset:0 sc1
  buffer_load_dwordx4 v[12:15], v2, s[8:11], s22 offen offset:1024 sc1
  buffer_load_dwordx4 v[16:19], v2, s[8:11], s22 offen offset:2048 sc1
  buffer_load_dwordx4 v[20:23], v2, s[8:11], s22 offen offset:3072 sc1
  buffer_load_dwordx4 v[24:27], v2, s[8:11], s34 offen offset:0 sc1
  buffer_load_dwordx4 v[28:31], v2, s[8:11], s34 offen offset:1024 sc1
  buffer_load_dwordx4 v[32:35], v2, s[8:11], s34 offen offset:2048 sc1
  buffer_load_dwordx4 v[36:39], v2, s[8:11], s34 offen offset:3072 sc1
  buffer_load_dwordx4 v[40:43], v2, s[8:11], s36 offen offset:0 sc1
  buffer_load_dwordx4 v[44:47], v2, s[8:11], s36 offen offset:1024 sc1
  s_waitcnt vmcnt(0)
  v_max3_u32 v52, v8, v9, v10
  v_max3_u32 v52, v52, v11, v12
  v_max3_u32 v52, v52, v13, v14
  v_max3_u32 v52, v52, v15, v16
  v_max3_u32 v52, v52, v17, v18
  v_max3_u32 v52, v52, v19, v20
  v_max3_u32 v52, v52, v21, v22
  v_max3_u32 v52, v52, v23, v24
  v_max3_u32 v52, v52, v25, v26
  v_max3_u32 v52, v52, v27, v28
  v_max3_u32 v52, v52, v29, v30
  v_max3_u32 v52, v52, v31, v32
  v_max3_u32 v52, v52, v33, v34
  v_max3_u32 v52, v52, v35, v36
  v_max3_u32 v52, v52, v37, v38
  v_max3_u32 v52, v52, v39, v40
  v_max3_u32 v52, v52, v41, v42
  v_max3_u32 v52, v52, v43, v44
  v_max3_u32 v52, v52, v45, v46
  v_max_u32 v52, v52, v47
  v_cmp_eq_u32 vcc, -1, v52
  s_mov_b32 s37, 1
  v_mov_b32 v48, 0
  v_mov_b32 v49, 0
  v_mov_b32 v50, 0
  v_mov_b32 v51, 0
  s_nop 1
  s_cbranch_vccz cB_va1_lp
  s_add_u32 s30, s30, 1
  s_cmp_lt_u32 s30, 400000
  s_cbranch_scc1 cB_va1_rv
  s_branch cB_abort
.p2align 6
cB_va2_loop:
  s_mov_b32 s30, 0
  buffer_load_dword v100, v119, s[8:11], 0 offen sc1
  buffer_load_dword v101, v119, s[8:11], 0 offen sc1
  buffer_load_dword v102, v119, s[8:11], 0 offen sc1
  buffer_load_dword v103, v119, s[8:11], 0 offen sc1
cB_va2_fp_l:
  s_waitcnt vmcnt(3)
  v_cmp_gt_u32 vcc, s19, v100
  s_cbranch_vccz cB_va2_fp_d
  buffer_load_dword v100, v119, s[8:11], 0 offen sc1
  s_waitcnt vmcnt(3)
  v_cmp_gt_u32 vcc, s19, v101
  s_cbranch_vccz cB_va2_fp_d
  buffer_load_dword v101, v119, s[8:11], 0 offen sc1
  s_waitcnt vmcnt(3)
  v_cmp_gt_u32 vcc, s19, v102
  s_cbranch_vccz cB_va2_fp_d
  buffer_load_dword v102, v119, s[8:11], 0 offen sc1
  s_waitcnt vmcnt(3)
  v_cmp_gt_u32 vcc, s19, v103
  s_cbranch_vccz cB_va2_fp_d
  buffer_load_dword v103, v119, s[8:11], 0 offen sc1
  s_add_u32 s30, s30, 1
  s_cmp_lt_u32 s30, 400000
  s_cbranch_scc1 cB_va2_fp_l
  s_branch cB_abort
cB_va2_fp_d:
  buffer_load_dwordx4 v[8:11], v2, s[8:11], s20 offen offset:0 sc1
  buffer_load_dwordx4 v[12:15], v2, s[8:11], s20 offen offset:1024 sc1
  s_barrier
  s_barrier
  s_waitcnt vmcnt(0)
  ds_write_b128 v2, v[8:11] offset:8192
  ds_write_b128 v2, v[12:15] offset:9216
  v_smfmac_f32_16x16x64_bf16 v[36:39], v[8:11], a[0:7], v3
  v_smfmac_f32_16x16x64_bf16 v[40:43], v[8:11], a[56:63], v3
  v_smfmac_f32_16x16x64_bf16 v[44:47], v[8:11], a[112:119], v3
  v_smfmac_f32_16x16x64_bf16 v[48:51], v[8:11], a[168:175], v3
  v_smfmac_f32_16x16x64_bf16 v[52:55], v[8:11], a[224:231], v3
  s_waitcnt lgkmcnt(0)
  s_barrier
  ds_read_b128 v[16:19], v2 offset:10240
  ds_read_b128 v[20:23], v2 offset:11264
  ds_read_b128 v[24:27], v2 offset:12288
  ds_read_b128 v[28:31], v2 offset:13312
  ds_read_b128 v[32:35], v2 offset:14336
  v_smfmac_f32_16x16x64_bf16 v[56:59], v[8:11], v[144:151], v3
  v_smfmac_f32_16x16x64_bf16 v[60:63], v[8:11], v[200:207], v3
  v_smfmac_f32_16x16x64_bf16 v[36:39], v[12:15], a[8:15], v3
  v_smfmac_f32_16x16x64_bf16 v[40:43], v[12:15], a[64:71], v3
  v_smfmac_f32_16x16x64_bf16 v[44:47], v[12:15], a[120:127], v3
  v_smfmac_f32_16x16x64_bf16 v[48:51], v[12:15], a[176:183], v3
  v_smfmac_f32_16x16x64_bf16 v[52:55], v[12:15], a[232:239], v3
  v_smfmac_f32_16x16x64_bf16 v[56:59], v[12:15], v[152:159], v3
  v_smfmac_f32_16x16x64_bf16 v[60:63], v[12:15], v[208:215], v3
  s_waitcnt lgkmcnt(4)
  v_smfmac_f32_16x16x64_bf16 v[36:39], v[16:19], a[16:23], v3
  s_waitcnt lgkmcnt(3)
  v_smfmac_f32_16x16x64_bf16 v[36:39], v[20:23], a[24:31], v3
  s_waitcnt lgkmcnt(2)
  v_smfmac_f32_16x16x64_bf16 v[36:39], v[24:27], a[32:39], v3
  s_waitcnt lgkmcnt(1)
  v_smfmac_f32_16x16x64_bf16 v[36:39], v[28:31], a[40:47], v3
  s_waitcnt lgkmcnt(0)
  v_smfmac_f32_16x16x64_bf16 v[36:39], v[32:35], a[48:55], v3
  v_smfmac_f32_16x16x64_bf16 v[40:43], v[16:19], a[72:79], v3
  v_smfmac_f32_16x16x64_bf16 v[40:43], v[20:23], a[80:87], v3
  v_smfmac_f32_16x16x64_bf16 v[40:43], v[24:27], a[88:95], v3
  v_permlane32_swap_b32 v36, v38
  v_smfmac_f32_16x16x64_bf16 v[40:43], v[28:31], a[96:103], v3
  v_permlane32_swap_b32 v37, v39
  v_smfmac_f32_16x16x64_bf16 v[40:43], v[32:35], a[104:111], v3
  v_add_f32 v36, v36, v38
  v_smfmac_f32_16x16x64_bf16 v[44:47], v[16:19], a[128:135], v3
  v_add_f32 v37, v37, v39
  v_smfmac_f32_16x16x64_bf16 v[44:47], v[20:23], a[136:143], v3
  v_cmp_u_f32 vcc, v36, v37
  v_smfmac_f32_16x16x64_bf16 v[44:47], v[24:27], a[144:151], v3
  v_cvt_pk_bf16_f32 v38, v36, v37
  v_smfmac_f32_16x16x64_bf16 v[44:47], v[28:31], a[152:159], v3
  ds_write_b32 v104, v38
  s_cbranch_vccnz cB_va2_slow
  v_permlane32_swap_b32 v40, v42
  v_smfmac_f32_16x16x64_bf16 v[44:47], v[32:35], a[160:167], v3
  v_permlane32_swap_b32 v41, v43
  v_smfmac_f32_16x16x64_bf16 v[48:51], v[16:19], a[184:191], v3
  v_add_f32 v40, v40, v42
  v_smfmac_f32_16x16x64_bf16 v[48:51], v[20:23], a[192:199], v3
  v_add_f32 v41, v41, v43
  v_smfmac_f32_16x16x64_bf16 v[48:51], v[24:27], a[200:207], v3
  v_cvt_pk_bf16_f32 v42, v40, v41
  v_smfmac_f32_16x16x64_bf16 v[48:51], v[28:31], a[208:215], v3
  ds_write_b32 v105, v42
  v_permlane32_swap_b32 v44, v46
  v_smfmac_f32_16x16x64_bf16 v[48:51], v[32:35], a[216:223], v3
  v_permlane32_swap_b32 v45, v47
  v_smfmac_f32_16x16x64_bf16 v[52:55], v[16:19], a[240:247], v3
  v_add_f32 v44, v44, v46
  v_smfmac_f32_16x16x64_bf16 v[52:55], v[20:23], a[248:255], v3
  v_add_f32 v45, v45, v47
  v_smfmac_f32_16x16x64_bf16 v[52:55], v[24:27], v[120:127], v3
  v_cvt_pk_bf16_f32 v46, v44, v45
  v_smfmac_f32_16x16x64_bf16 v[52:55], v[28:31], v[128:135], v3
  ds_write_b32 v106, v46
  v_permlane32_swap_b32 v48, v50
  v_smfmac_f32_16x16x64_bf16 v[52:55], v[32:35], v[136:143], v3
  v_permlane32_swap_b32 v49, v51
  v_smfmac_f32_16x16x64_bf16 v[56:59], v[16:19], v[160:167], v3
  v_add_f32 v48, v48, v50
  v_smfmac_f32_16x16x64_bf16 v[56:59], v[20:23], v[168:175], v3
  v_add_f32 v49, v49, v51
  v_smfmac_f32_16x16x64_bf16 v[56:59], v[24:27], v[176:183], v3
  v_cvt_pk_bf16_f32 v50, v48, v49
  v_smfmac_f32_16x16x64_bf16 v[56:59], v[28:31], v[184:191], v3
  ds_write_b32 v107, v50
  v_permlane32_swap_b32 v52, v54
  v_smfmac_f32_16x16x64_bf16 v[56:59], v[32:35], v[192:199], v3
  v_permlane32_swap_b32 v53, v55
  v_smfmac_f32_16x16x64_bf16 v[60:63], v[16:19], v[216:223], v3
  v_add_f32 v52, v52, v54
  v_smfmac_f32_16x16x64_bf16 v[60:63], v[20:23], v[224:231], v3
  v_add_f32 v53, v53, v55
  v_smfmac_f32_16x16x64_bf16 v[60:63], v[24:27], v[232:239], v3
  v_cvt_pk_bf16_f32 v54, v52, v53
  v_smfmac_f32_16x16x64_bf16 v[60:63], v[28:31], v[240:247], v3
  ds_write_b32 v108, v54
  v_permlane32_swap_b32 v56, v58
  v_smfmac_f32_16x16x64_bf16 v[60:63], v[32:35], v[248:255], v3
  v_permlane32_swap_b32 v57, v59
  v_add_f32 v56, v56, v58
  v_add_f32 v57, v57, v59
  v_cvt_pk_bf16_f32 v58, v56, v57
  ds_write_b32 v109, v58
  s_nop 2
  v_permlane32_swap_b32 v60, v62
  v_permlane32_swap_b32 v61, v63
  v_add_f32 v60, v60, v62
  v_add_f32 v61, v61, v63
  v_cvt_pk_bf16_f32 v62, v60, v61
  ds_write_b32 v110, v62
cB_va2_t2d:
  v_mov_b32 v117, s18
  s_waitcnt lgkmcnt(0)
  s_barrier
  s_cmp_eq_u32 s19, 62
  s_cbranch_scc1 cB_done
  s_sleep 1
  v_mov_b32 v36, 0
  v_mov_b32 v37, 0
  v_mov_b32 v38, 0
  v_mov_b32 v39, 0
  v_mov_b32 v40, 0
  v_mov_b32 v41, 0
  v_mov_b32 v42, 0
  v_mov_b32 v43, 0
  v_mov_b32 v44, 0
  v_mov_b32 v45, 0
  v_mov_b32 v46, 0
  v_mov_b32 v47, 0
  v_mov_b32 v48, 0
  v_mov_b32 v49, 0
  v_mov_b32 v50, 0
  v_mov_b32 v51, 0
  v_mov_b32 v52, 0
  v_mov_b32 v53, 0
  v_mov_b32 v54, 0
  v_mov_b32 v55, 0
  v_mov_b32 v56, 0
  v_mov_b32 v57, 0
  v_mov_b32 v58, 0
  v_mov_b32 v59, 0
  v_mov_b32 v60, 0
  v_mov_b32 v61, 0
  v_mov_b32 v62, 0
  v_mov_b32 v63, 0
  s_sleep 3
  s_mov_b32 s19, s18
  s_add_u32 s18, s18, 1
  s_mov_b32 s22, s20
  s_mov_b32 s20, s21
  s_mov_b32 s21, s22
  s_add_u32 s23, s20, 4096
  s_branch cB_va2_loop
cB_va2_slow:
  s_waitcnt lgkmcnt(0)
cB_va2_sl1:
  s_add_u32 s31, s31, 0x1000000
  buffer_load_dwordx4 v[8:11], v2, s[8:11], s20 offen offset:0 sc1
  buffer_load_dwordx4 v[12:15], v2, s[8:11], s20 offen offset:1024 sc1
  buffer_load_dwordx4 v[16:19], v2, s[8:11], s20 offen offset:2048 sc1
  buffer_load_dwordx4 v[20:23], v2, s[8:11], s20 offen offset:3072 sc1
  buffer_load_dwordx4 v[24:27], v2, s[8:11], s23 offen offset:0 sc1
  buffer_load_dwordx4 v[28:31], v2, s[8:11], s23 offen offset:1024 sc1
  buffer_load_dwordx4 v[32:35], v2, s[8:11], s23 offen offset:2048 sc1
  s_waitcnt vmcnt(0)
  v_max3_u32 v36, v8, v9, v10
  v_max3_u32 v36, v36, v11, v12
  v_max3_u32 v36, v36, v13, v14
  v_max3_u32 v36, v36, v15, v16
  v_max3_u32 v36, v36, v17, v18
  v_max3_u32 v36, v36, v19, v20
  v_max3_u32 v36, v36, v21, v22
  v_max3_u32 v36, v36, v23, v24
  v_max3_u32 v36, v36, v25, v26
  v_max3_u32 v36, v36, v27, v28
  v_max3_u32 v36, v36, v29, v30
  v_max3_u32 v36, v36, v31, v32
  v_max3_u32 v36, v36, v33, v34
  v_max_u32 v36, v36, v35
  v_cmp_eq_u32 vcc, -1, v36
  s_cbranch_vccz cB_va2_sl2
  s_add_u32 s30, s30, 1
  s_cmp_lt_u32 s30, 400000
  s_cbranch_scc1 cB_va2_sl1
  s_branch cB_abort
cB_va2_sl2:
  v_mov_b32 v36, 0
  v_mov_b32 v37, 0
  v_mov_b32 v38, 0
  v_mov_b32 v39, 0
  v_mov_b32 v40, 0
  v_mov_b32 v41, 0
  v_mov_b32 v42, 0
  v_mov_b32 v43, 0
  v_mov_b32 v44, 0
  v_mov_b32 v45, 0
  v_mov_b32 v46, 0
  v_mov_b32 v47, 0
  v_mov_b32 v48, 0
  v_mov_b32 v49, 0
  v_mov_b32 v50, 0
  v_mov_b32 v51, 0
  v_mov_b32 v52, 0
  v_mov_b32 v53, 0
  v_mov_b32 v54, 0
  v_mov_b32 v55, 0
  v_mov_b32 v56, 0
  v_mov_b32 v57, 0
  v_mov_b32 v58, 0
  v_mov_b32 v59, 0
  v_mov_b32 v60, 0
  v_mov_b32 v61, 0
  v_mov_b32 v62, 0
  v_mov_b32 v63, 0
  v_smfmac_f32_16x16x64_bf16 v[36:39], v[8:11], a[0:7], v3
  v_smfmac_f32_16x16x64_bf16 v[40:43], v[8:11], a[56:63], v3
  v_smfmac_f32_16x16x64_bf16 v[44:47], v[8:11], a[112:119], v3
  v_smfmac_f32_16x16x64_bf16 v[48:51], v[8:11], a[168:175], v3
  v_smfmac_f32_16x16x64_bf16 v[52:55], v[8:11], a[224:231], v3
  v_smfmac_f32_16x16x64_bf16 v[56:59], v[8:11], v[144:151], v3
  v_smfmac_f32_16x16x64_bf16 v[60:63], v[8:11], v[200:207], v3
  v_smfmac_f32_16x16x64_bf16 v[36:39], v[12:15], a[8:15], v3
  v_smfmac_f32_16x16x64_bf16 v[40:43], v[12:15], a[64:71], v3
  v_smfmac_f32_16x16x64_bf16 v[44:47], v[12:15], a[120:127], v3
  v_smfmac_f32_16x16x64_bf16 v[48:51], v[12:15], a[176:183], v3
  v_smfmac_f32_16x16x64_bf16 v[52:55], v[12:15], a[232:239], v3
  v_smfmac_f32_16x16x64_bf16 v[56:59], v[12:15], v[152:159], v3
  v_smfmac_f32_16x16x64_bf16 v[60:63], v[12:15], v[208:215], v3
  v_smfmac_f32_16x16x64_bf16 v[36:39], v[16:19], a[16:23], v3
  v_smfmac_f32_16x16x64_bf16 v[40:43], v[16:19], a[72:79], v3
  v_smfmac_f32_16x16x64_bf16 v[44:47], v[16:19], a[128:135], v3
  v_smfmac_f32_16x16x64_bf16 v[48:51], v[16:19], a[184:191], v3
  v_smfmac_f32_16x16x64_bf16 v[52:55], v[16:19], a[240:247], v3
  v_smfmac_f32_16x16x64_bf16 v[56:59], v[16:19], v[160:167], v3
  v_smfmac_f32_16x16x64_bf16 v[60:63], v[16:19], v[216:223], v3
  v_smfmac_f32_16x16x64_bf16 v[36:39], v[20:23], a[24:31], v3
  v_smfmac_f32_16x16x64_bf16 v[40:43], v[20:23], a[80:87], v3
  v_smfmac_f32_16x16x64_bf16 v[44:47], v[20:23], a[136:143], v3
  v_smfmac_f32_16x16x64_bf16 v[48:51], v[20:23], a[192:199], v3
  v_smfmac_f32_16x16x64_bf16 v[52:55], v[20:23], a[248:255], v3
  v_smfmac_f32_16x16x64_bf16 v[56:59], v[20:23], v[168:175], v3
  v_smfmac_f32_16x16x64_bf16 v[60:63], v[20:23], v[224:231], v3
  v_smfmac_f32_16x16x64_bf16 v[36:39], v[24:27], a[32:39], v3
  v_smfmac_f32_16x16x64_bf16 v[40:43], v[24:27], a[88:95], v3
  v_smfmac_f32_16x16x64_bf16 v[44:47], v[24:27], a[144:151], v3
  v_smfmac_f32_16x16x64_bf16 v[48:51], v[24:27], a[200:207], v3
  v_smfmac_f32_16x16x64_bf16 v[52:55], v[24:27], v[120:127], v3
  v_smfmac_f32_16x16x64_bf16 v[56:59], v[24:27], v[176:183], v3
  v_smfmac_f32_16x16x64_bf16 v[60:63], v[24:27], v[232:239], v3
  v_smfmac_f32_16x16x64_bf16 v[36:39], v[28:31], a[40:47], v3
  v_smfmac_f32_16x16x64_bf16 v[40:43], v[28:31], a[96:103], v3
  v_smfmac_f32_16x16x64_bf16 v[44:47], v[28:31], a[152:159], v3
  v_smfmac_f32_16x16x64_bf16 v[48:51], v[28:31], a[208:215], v3
  v_smfmac_f32_16x16x64_bf16 v[52:55], v[28:31], v[128:135], v3
  v_smfmac_f32_16x16x64_bf16 v[56:59], v[28:31], v[184:191], v3
  v_smfmac_f32_16x16x64_bf16 v[60:63], v[28:31], v[240:247], v3
  v_smfmac_f32_16x16x64_bf16 v[36:39], v[32:35], a[48:55], v3
  v_smfmac_f32_16x16x64_bf16 v[40:43], v[32:35], a[104:111], v3
  v_smfmac_f32_16x16x64_bf16 v[44:47], v[32:35], a[160:167], v3
  v_smfmac_f32_16x16x64_bf16 v[48:51], v[32:35], a[216:223], v3
  v_smfmac_f32_16x16x64_bf16 v[52:55], v[32:35], v[136:143], v3
  v_smfmac_f32_16x16x64_bf16 v[56:59], v[32:35], v[192:199], v3
  v_smfmac_f32_16x16x64_bf16 v[60:63], v[32:35], v[248:255], v3
  v_permlane32_swap_b32 v36, v38
  v_permlane32_swap_b32 v37, v39
  v_add_f32 v36, v36, v38
  v_add_f32 v37, v37, v39
  v_cvt_pk_bf16_f32 v38, v36, v37
  ds_write_b32 v104, v38
  v_permlane32_swap_b32 v40, v42
  v_permlane32_swap_b32 v41, v43
  v_add_f32 v40, v40, v42
  v_add_f32 v41, v41, v43
  v_cvt_pk_bf16_f32 v42, v40, v41
  ds_write_b32 v105, v42
  v_permlane32_swap_b32 v44, v46
  v_permlane32_swap_b32 v45, v47
  v_add_f32 v44, v44, v46
  v_add_f32 v45, v45, v47
  v_cvt_pk_bf16_f32 v46, v44, v45
  ds_write_b32 v106, v46
  v_permlane32_swap_b32 v48, v50
  v_permlane32_swap_b32 v49, v51
  v_add_f32 v48, v48, v50
  v_add_f32 v49, v49, v51
  v_cvt_pk_bf16_f32 v50, v48, v49
  ds_write_b32 v107, v50
  v_permlane32_swap_b32 v52, v54
  v_permlane32_swap_b32 v53, v55
  v_add_f32 v52, v52, v54
  v_add_f32 v53, v53, v55
  v_cvt_pk_bf16_f32 v54, v52, v53
  ds_write_b32 v108, v54
  v_permlane32_swap_b32 v56, v58
  v_permlane32_swap_b32 v57, v59
  v_add_f32 v56, v56, v58
  v_add_f32 v57, v57, v59
  v_cvt_pk_bf16_f32 v58, v56, v57
  ds_write_b32 v109, v58
  v_permlane32_swap_b32 v60, v62
  v_permlane32_swap_b32 v61, v63
  v_add_f32 v60, v60, v62
  v_add_f32 v61, v61, v63
  v_cvt_pk_bf16_f32 v62, v60, v61
  ds_write_b32 v110, v62
  s_branch cB_va2_t2d
.p2align 6
cB_va3_loop:
  s_mov_b32 s30, 0
  s_barrier
  buffer_load_dwordx4 v[16:19], v2, s[8:11], s20 offen offset:2048 sc1
  buffer_load_dwordx4 v[20:23], v2, s[8:11], s20 offen offset:3072 sc1
  s_barrier
  buffer_load_dword v100, v116, s[8:11], s39 offen sc1
  s_add_u32 s27, s19, 2
  s_min_u32 s27, s27, 63
  s_lshr_b32 s27, s27, 3
  s_lshl_b32 s27, s27, 11
  s_add_u32 s27, s27, s35
  s_cmp_eq_u32 s27, s28
  s_cselect_b32 s29, 75729408, s27
  buffer_load_dword v101, off, s[8:11], s29 sc1
  s_add_u32 s39, s39, 28672
  s_waitcnt vmcnt(2)
  ds_write_b128 v2, v[16:19] offset:10240
  ds_write_b128 v2, v[20:23] offset:11264
  v_smfmac_f32_16x16x64_bf16 v[36:39], v[16:19], a[16:23], v3
  v_smfmac_f32_16x16x64_bf16 v[40:43], v[16:19], a[72:79], v3
  v_smfmac_f32_16x16x64_bf16 v[44:47], v[16:19], a[128:135], v3
  v_smfmac_f32_16x16x64_bf16 v[48:51], v[16:19], a[184:191], v3
  v_smfmac_f32_16x16x64_bf16 v[52:55], v[16:19], a[240:247], v3
  s_waitcnt lgkmcnt(0)
  s_barrier
  ds_read_b128 v[8:11], v2 offset:8192
  ds_read_b128 v[12:15], v2 offset:9216
  ds_read_b128 v[24:27], v2 offset:12288
  ds_read_b128 v[28:31], v2 offset:13312
  ds_read_b128 v[32:35], v2 offset:14336
  v_smfmac_f32_16x16x64_bf16 v[56:59], v[16:19], v[160:167], v3
  v_smfmac_f32_16x16x64_bf16 v[60:63], v[16:19], v[216:223], v3
  v_smfmac_f32_16x16x64_bf16 v[36:39], v[20:23], a[24:31], v3
  v_smfmac_f32_16x16x64_bf16 v[40:43], v[20:23], a[80:87], v3
  v_smfmac_f32_16x16x64_bf16 v[44:47], v[20:23], a[136:143], v3
  v_smfmac_f32_16x16x64_bf16 v[48:51], v[20:23], a[192:199], v3
  v_smfmac_f32_16x16x64_bf16 v[52:55], v[20:23], a[248:255], v3
  v_smfmac_f32_16x16x64_bf16 v[56:59], v[20:23], v[168:175], v3
  v_smfmac_f32_16x16x64_bf16 v[60:63], v[20:23], v[224:231], v3
  s_waitcnt lgkmcnt(4)
  v_smfmac_f32_16x16x64_bf16 v[36:39], v[8:11], a[0:7], v3
  s_waitcnt lgkmcnt(3)
  v_smfmac_f32_16x16x64_bf16 v[36:39], v[12:15], a[8:15], v3
  s_waitcnt lgkmcnt(2)
  v_smfmac_f32_16x16x64_bf16 v[36:39], v[24:27], a[32:39], v3
  s_waitcnt lgkmcnt(1)
  v_smfmac_f32_16x16x64_bf16 v[36:39], v[28:31], a[40:47], v3
  s_waitcnt lgkmcnt(0)
  v_smfmac_f32_16x16x64_bf16 v[36:39], v[32:35], a[48:55], v3
  v_smfmac_f32_16x16x64_bf16 v[40:43], v[8:11], a[56:63], v3
  v_smfmac_f32_16x16x64_bf16 v[40:43], v[12:15], a[64:71], v3
  v_smfmac_f32_16x16x64_bf16 v[40:43], v[24:27], a[88:95], v3
  v_permlane32_swap_b32 v36, v38
  v_smfmac_f32_16x16x64_bf16 v[40:43], v[28:31], a[96:103], v3
  v_permlane32_swap_b32 v37, v39
  v_smfmac_f32_16x16x64_bf16 v[40:43], v[32:35], a[104:111], v3
  v_add_f32 v36, v36, v38
  v_smfmac_f32_16x16x64_bf16 v[44:47], v[8:11], a[112:119], v3
  v_add_f32 v37, v37, v39
  v_smfmac_f32_16x16x64_bf16 v[44:47], v[12:15], a[120:127], v3
  v_cmp_u_f32 vcc, v36, v37
  v_smfmac_f32_16x16x64_bf16 v[44:47], v[24:27], a[144:151], v3
  v_cvt_pk_bf16_f32 v38, v36, v37
  v_smfmac_f32_16x16x64_bf16 v[44:47], v[28:31], a[152:159], v3
  ds_write_b32 v104, v38
  s_cbranch_vccnz cB_va3_slow
  v_permlane32_swap_b32 v40, v42
  v_smfmac_f32_16x16x64_bf16 v[44:47], v[32:35], a[160:167], v3
  v_permlane32_swap_b32 v41, v43
  v_smfmac_f32_16x16x64_bf16 v[48:51], v[8:11], a[168:175], v3
  v_add_f32 v40, v40, v42
  v_smfmac_f32_16x16x64_bf16 v[48:51], v[12:15], a[176:183], v3
  v_add_f32 v41, v41, v43
  v_smfmac_f32_16x16x64_bf16 v[48:51], v[24:27], a[200:207], v3
  v_cvt_pk_bf16_f32 v42, v40, v41
  v_smfmac_f32_16x16x64_bf16 v[48:51], v[28:31], a[208:215], v3
  ds_write_b32 v105, v42
  v_permlane32_swap_b32 v44, v46
  v_smfmac_f32_16x16x64_bf16 v[48:51], v[32:35], a[216:223], v3
  v_permlane32_swap_b32 v45, v47
  v_smfmac_f32_16x16x64_bf16 v[52:55], v[8:11], a[224:231], v3
  v_add_f32 v44, v44, v46
  v_smfmac_f32_16x16x64_bf16 v[52:55], v[12:15], a[232:239], v3
  v_add_f32 v45, v45, v47
  v_smfmac_f32_16x16x64_bf16 v[52:55], v[24:27], v[120:127], v3
  v_cvt_pk_bf16_f32 v46, v44, v45
  v_smfmac_f32_16x16x64_bf16 v[52:55], v[28:31], v[128:135], v3
  ds_write_b32 v106, v46
  v_permlane32_swap_b32 v48, v50
  v_smfmac_f32_16x16x64_bf16 v[52:55], v[32:35], v[136:143], v3
  v_permlane32_swap_b32 v49, v51
  v_smfmac_f32_16x16x64_bf16 v[56:59], v[8:11], v[144:151], v3
  v_add_f32 v48, v48, v50
  v_smfmac_f32_16x16x64_bf16 v[56:59], v[12:15], v[152:159], v3
  v_add_f32 v49, v49, v51
  v_smfmac_f32_16x16x64_bf16 v[56:59], v[24:27], v[176:183], v3
  v_cvt_pk_bf16_f32 v50, v48, v49
  v_smfmac_f32_16x16x64_bf16 v[56:59], v[28:31], v[184:191], v3
  ds_write_b32 v107, v50
  v_permlane32_swap_b32 v52, v54
  v_smfmac_f32_16x16x64_bf16 v[56:59], v[32:35], v[192:199], v3
  v_permlane32_swap_b32 v53, v55
  v_smfmac_f32_16x16x64_bf16 v[60:63], v[8:11], v[200:207], v3
  v_add_f32 v52, v52, v54
  v_smfmac_f32_16x16x64_bf16 v[60:63], v[12:15], v[208:215], v3
  v_add_f32 v53, v53, v55
  v_smfmac_f32_16x16x64_bf16 v[60:63], v[24:27], v[232:239], v3
  v_cvt_pk_bf16_f32 v54, v52, v53
  v_smfmac_f32_16x16x64_bf16 v[60:63], v[28:31], v[240:247], v3
  ds_write_b32 v108, v54
  v_permlane32_swap_b32 v56, v58
  v_smfmac_f32_16x16x64_bf16 v[60:63], v[32:35], v[248:255], v3
  v_permlane32_swap_b32 v57, v59
  v_add_f32 v56, v56, v58
  v_add_f32 v57, v57, v59
  v_cvt_pk_bf16_f32 v58, v56, v57
  ds_write_b32 v109, v58
  s_nop 2
  v_permlane32_swap_b32 v60, v62
  v_permlane32_swap_b32 v61, v63
  v_add_f32 v60, v60, v62
  v_add_f32 v61, v61, v63
  v_cvt_pk_bf16_f32 v62, v60, v61
  ds_write_b32 v110, v62
cB_va3_t2d:
  v_mov_b32 v117, s18
  s_cmp_eq_u32 s27, s28
  s_cbranch_scc1 cB_va3_vok
cB_va3_vow:
  s_waitcnt vmcnt(0)
  v_cmp_ne_u32 vcc, 56, v101
  s_cbranch_vccnz cB_va3_vor
  s_mov_b32 s28, s27
cB_va3_vok:
  s_waitcnt lgkmcnt(0)
  s_setprio 3
  s_barrier
  v_mov_b32 v36, 0
  v_mov_b32 v37, 0
  v_mov_b32 v38, 0
  v_mov_b32 v39, 0
  buffer_store_dword v117, v118, s[8:11], 0 offen sc1
  s_setprio 0
  s_cmp_eq_u32 s19, 62
  s_cbranch_scc1 cB_done
  v_mov_b32 v40, 0
  v_mov_b32 v41, 0
  v_mov_b32 v42, 0
  v_mov_b32 v43, 0
  v_mov_b32 v44, 0
  v_mov_b32 v45, 0
  v_mov_b32 v46, 0
  v_mov_b32 v47, 0
  v_mov_b32 v48, 0
  v_mov_b32 v49, 0
  v_mov_b32 v50, 0
  v_mov_b32 v51, 0
  v_mov_b32 v52, 0
  v_mov_b32 v53, 0
  v_mov_b32 v54, 0
  v_mov_b32 v55, 0
  v_mov_b32 v56, 0
  v_mov_b32 v57, 0
  v_mov_b32 v58, 0
  v_mov_b32 v59, 0
  v_mov_b32 v60, 0
  v_mov_b32 v61, 0
  v_mov_b32 v62, 0
  v_mov_b32 v63, 0
  s_mov_b32 s19, s18
  s_add_u32 s18, s18, 1
  s_mov_b32 s22, s20
  s_mov_b32 s20, s21
  s_mov_b32 s21, s22
  s_add_u32 s23, s20, 4096
  s_branch cB_va3_loop
cB_va3_slow:
  s_waitcnt lgkmcnt(0)
cB_va3_sl1:
  s_add_u32 s31, s31, 0x1000000
  buffer_load_dwordx4 v[8:11], v2, s[8:11], s20 offen offset:0 sc1
  buffer_load_dwordx4 v[12:15], v2, s[8:11], s20 offen offset:1024 sc1
  buffer_load_dwordx4 v[16:19], v2, s[8:11], s20 offen offset:2048 sc1
  buffer_load_dwordx4 v[20:23], v2, s[8:11], s20 offen offset:3072 sc1
  buffer_load_dwordx4 v[24:27], v2, s[8:11], s23 offen offset:0 sc1
  buffer_load_dwordx4 v[28:31], v2, s[8:11], s23 offen offset:1024 sc1
  buffer_load_dwordx4 v[32:35], v2, s[8:11], s23 offen offset:2048 sc1
  s_waitcnt vmcnt(0)
  v_max3_u32 v36, v8, v9, v10
  v_max3_u32 v36, v36, v11, v12
  v_max3_u32 v36, v36, v13, v14
  v_max3_u32 v36, v36, v15, v16
  v_max3_u32 v36, v36, v17, v18
  v_max3_u32 v36, v36, v19, v20
  v_max3_u32 v36, v36, v21, v22
  v_max3_u32 v36, v36, v23, v24
  v_max3_u32 v36, v36, v25, v26
  v_max3_u32 v36, v36, v27, v28
  v_max3_u32 v36, v36, v29, v30
  v_max3_u32 v36, v36, v31, v32
  v_max3_u32 v36, v36, v33, v34
  v_max_u32 v36, v36, v35
  v_cmp_eq_u32 vcc, -1, v36
  s_cbranch_vccz cB_va3_sl2
  s_add_u32 s30, s30, 1
  s_cmp_lt_u32 s30, 400000
  s_cbranch_scc1 cB_va3_sl1
  s_branch cB_abort
cB_va3_sl2:
  v_mov_b32 v36, 0
  v_mov_b32 v37, 0
  v_mov_b32 v38, 0
  v_mov_b32 v39, 0
  v_mov_b32 v40, 0
  v_mov_b32 v41, 0
  v_mov_b32 v42, 0
  v_mov_b32 v43, 0
  v_mov_b32 v44, 0
  v_mov_b32 v45, 0
  v_mov_b32 v46, 0
  v_mov_b32 v47, 0
  v_mov_b32 v48, 0
  v_mov_b32 v49, 0
  v_mov_b32 v50, 0
  v_mov_b32 v51, 0
  v_mov_b32 v52, 0
  v_mov_b32 v53, 0
  v_mov_b32 v54, 0
  v_mov_b32 v55, 0
  v_mov_b32 v56, 0
  v_mov_b32 v57, 0
  v_mov_b32 v58, 0
  v_mov_b32 v59, 0
  v_mov_b32 v60, 0
  v_mov_b32 v61, 0
  v_mov_b32 v62, 0
  v_mov_b32 v63, 0
  v_smfmac_f32_16x16x64_bf16 v[36:39], v[8:11], a[0:7], v3
  v_smfmac_f32_16x16x64_bf16 v[40:43], v[8:11], a[56:63], v3
  v_smfmac_f32_16x16x64_bf16 v[44:47], v[8:11], a[112:119], v3
  v_smfmac_f32_16x16x64_bf16 v[48:51], v[8:11], a[168:175], v3
  v_smfmac_f32_16x16x64_bf16 v[52:55], v[8:11], a[224:231], v3
  v_smfmac_f32_16x16x64_bf16 v[56:59], v[8:11], v[144:151], v3
  v_smfmac_f32_16x16x64_bf16 v[60:63], v[8:11], v[200:207], v3
  v_smfmac_f32_16x16x64_bf16 v[36:39], v[12:15], a[8:15], v3
  v_smfmac_f32_16x16x64_bf16 v[40:43], v[12:15], a[64:71], v3
  v_smfmac_f32_16x16x64_bf16 v[44:47], v[12:15], a[120:127], v3
  v_smfmac_f32_16x16x64_bf16 v[48:51], v[12:15], a[176:183], v3
  v_smfmac_f32_16x16x64_bf16 v[52:55], v[12:15], a[232:239], v3
  v_smfmac_f32_16x16x64_bf16 v[56:59], v[12:15], v[152:159], v3
  v_smfmac_f32_16x16x64_bf16 v[60:63], v[12:15], v[208:215], v3
  v_smfmac_f32_16x16x64_bf16 v[36:39], v[16:19], a[16:23], v3
  v_smfmac_f32_16x16x64_bf16 v[40:43], v[16:19], a[72:79], v3
  v_smfmac_f32_16x16x64_bf16 v[44:47], v[16:19], a[128:135], v3
  v_smfmac_f32_16x16x64_bf16 v[48:51], v[16:19], a[184:191], v3
  v_smfmac_f32_16x16x64_bf16 v[52:55], v[16:19], a[240:247], v3
  v_smfmac_f32_16x16x64_bf16 v[56:59], v[16:19], v[160:167], v3
  v_smfmac_f32_16x16x64_bf16 v[60:63], v[16:19], v[216:223], v3
  v_smfmac_f32_16x16x64_bf16 v[36:39], v[20:23], a[24:31], v3
  v_smfmac_f32_16x16x64_bf16 v[40:43], v[20:23], a[80:87], v3
  v_smfmac_f32_16x16x64_bf16 v[44:47], v[20:23], a[136:143], v3
  v_smfmac_f32_16x16x64_bf16 v[48:51], v[20:23], a[192:199], v3
  v_smfmac_f32_16x16x64_bf16 v[52:55], v[20:23], a[248:255], v3
  v_smfmac_f32_16x16x64_bf16 v[56:59], v[20:23], v[168:175], v3
  v_smfmac_f32_16x16x64_bf16 v[60:63], v[20:23], v[224:231], v3
  v_smfmac_f32_16x16x64_bf16 v[36:39], v[24:27], a[32:39], v3
  v_smfmac_f32_16x16x64_bf16 v[40:43], v[24:27], a[88:95], v3
  v_smfmac_f32_16x16x64_bf16 v[44:47], v[24:27], a[144:151], v3
  v_smfmac_f32_16x16x64_bf16 v[48:51], v[24:27], a[200:207], v3
  v_smfmac_f32_16x16x64_bf16 v[52:55], v[24:27], v[120:127], v3
  v_smfmac_f32_16x16x64_bf16 v[56:59], v[24:27], v[176:183], v3
  v_smfmac_f32_16x16x64_bf16 v[60:63], v[24:27], v[232:239], v3
  v_smfmac_f32_16x16x64_bf16 v[36:39], v[28:31], a[40:47], v3
  v_smfmac_f32_16x16x64_bf16 v[40:43], v[28:31], a[96:103], v3
  v_smfmac_f32_16x16x64_bf16 v[44:47], v[28:31], a[152:159], v3
  v_smfmac_f32_16x16x64_bf16 v[48:51], v[28:31], a[208:215], v3
  v_smfmac_f32_16x16x64_bf16 v[52:55], v[28:31], v[128:135], v3
  v_smfmac_f32_16x16x64_bf16 v[56:59], v[28:31], v[184:191], v3
  v_smfmac_f32_16x16x64_bf16 v[60:63], v[28:31], v[240:247], v3
  v_smfmac_f32_16x16x64_bf16 v[36:39], v[32:35], a[48:55], v3
  v_smfmac_f32_16x16x64_bf16 v[40:43], v[32:35], a[104:111], v3
  v_smfmac_f32_16x16x64_bf16 v[44:47], v[32:35], a[160:167], v3
  v_smfmac_f32_16x16x64_bf16 v[48:51], v[32:35], a[216:223], v3
  v_smfmac_f32_16x16x64_bf16 v[52:55], v[32:35], v[136:143], v3
  v_smfmac_f32_16x16x64_bf16 v[56:59], v[32:35], v[192:199], v3
  v_smfmac_f32_16x16x64_bf16 v[60:63], v[32:35], v[248:255], v3
  v_permlane32_swap_b32 v36, v38
  v_permlane32_swap_b32 v37, v39
  v_add_f32 v36, v36, v38
  v_add_f32 v37, v37, v39
  v_cvt_pk_bf16_f32 v38, v36, v37
  ds_write_b32 v104, v38
  v_permlane32_swap_b32 v40, v42
  v_permlane32_swap_b32 v41, v43
  v_add_f32 v40, v40, v42
  v_add_f32 v41, v41, v43
  v_cvt_pk_bf16_f32 v42, v40, v41
  ds_write_b32 v105, v42
  v_permlane32_swap_b32 v44, v46
  v_permlane32_swap_b32 v45, v47
  v_add_f32 v44, v44, v46
  v_add_f32 v45, v45, v47
  v_cvt_pk_bf16_f32 v46, v44, v45
  ds_write_b32 v106, v46
  v_permlane32_swap_b32 v48, v50
  v_permlane32_swap_b32 v49, v51
  v_add_f32 v48, v48, v50
  v_add_f32 v49, v49, v51
  v_cvt_pk_bf16_f32 v50, v48, v49
  ds_write_b32 v107, v50
  v_permlane32_swap_b32 v52, v54
  v_permlane32_swap_b32 v53, v55
  v_add_f32 v52, v52, v54
  v_add_f32 v53, v53, v55
  v_cvt_pk_bf16_f32 v54, v52, v53
  ds_write_b32 v108, v54
  v_permlane32_swap_b32 v56, v58
  v_permlane32_swap_b32 v57, v59
  v_add_f32 v56, v56, v58
  v_add_f32 v57, v57, v59
  v_cvt_pk_bf16_f32 v58, v56, v57
  ds_write_b32 v109, v58
  v_permlane32_swap_b32 v60, v62
  v_permlane32_swap_b32 v61, v63
  v_add_f32 v60, v60, v62
  v_add_f32 v61, v61, v63
  v_cvt_pk_bf16_f32 v62, v60, v61
  ds_write_b32 v110, v62
  s_branch cB_va3_t2d
cB_va3_vor:
  s_sleep 2
  buffer_load_dword v101, off, s[8:11], s27 sc1
  s_add_u32 s30, s30, 1
  s_cmp_lt_u32 s30, 400000
  s_cbranch_scc1 cB_va3_vow
  s_branch cB_abort
cB_abort:
  v_mov_b32 v4, 0xdead
  v_mov_b32 v5, 16
  buffer_store_dword v4, v5, s[12:15], 0 offen
  s_branch ch_end
cB_done:
  s_branch ch_end
ch_worker:
  s_sub_u32 s35, s3, 0
  s_and_b32 s35, s35, 7
  s_lshr_b32 s36, s2, 3
  s_mul_i32 s33, s35, 28
  s_add_u32 s33, s33, s36
  s_mov_b32 s97, 0
  s_mov_b32 s96, 0
  s_mov_b32 s37, 0
  s_mov_b32 s38, 0
  s_mov_b32 s39, 0xffff0000
  v_and_b32 v1, 63, v0
  v_lshlrev_b32 v2, 4, v1
  v_lshrrev_b32 v3, 4, v1
  v_and_b32 v4, 15, v1
  v_lshrrev_b32 v5, 5, v1
  v_and_b32 v6, 31, v1
  v_xor_b32 v8, v6, v5
  v_lshlrev_b32 v8, 4, v8
  v_lshl_add_u32 v16, v5, 13, v8
  v_xor_b32 v17, 32, v16
  v_xor_b32 v18, 64, v16
  v_xor_b32 v19, 96, v16
  v_xor_b32 v20, 128, v16
  v_xor_b32 v21, 160, v16
  v_xor_b32 v22, 192, v16
  v_xor_b32 v23, 224, v16
  s_cmp_lt_u32 s36, 28
  s_cbranch_scc1 wp_B
  s_cmp_eq_u32 s35, 0
  s_cbranch_scc1 wp_ini
  s_lshl_b32 s33, s35, 2
  s_add_u32 s33, s33, s36
  s_sub_u32 s33, s33, 32
  s_mul_i32 s17, s33, 4682
  s_lshr_b32 s17, s17, 16
  s_mul_i32 s23, s17, 14
  s_sub_u32 s19, s33, s23
  s_cmp_lt_u32 s19, 7
  s_cselect_b32 s18, 0, 7
  s_cselect_b32 s28, 0, 8
  s_sub_u32 s18, s19, s18
  s_add_u32 s28, s28, s16
  s_lshl_b32 s25, s16, 15
  s_add_u32 s25, s25, 32768
  s_lshl_b32 s26, s17, 9
  s_branch wp_A0
wp_ini:
  v_mov_b32 v4, 1
  v_mov_b32 v5, 4
  v_mov_b32 v6, 160000
  s_barrier
  s_cmp_lg_u32 s16, 0
  s_cbranch_scc1 wp_ic1
  s_mov_b64 exec, 1
  buffer_atomic_add v4, v5, s[12:15], 0 offen sc0
  s_waitcnt vmcnt(0)
  ds_write_b32 v6, v4
  s_waitcnt lgkmcnt(0)
  s_mov_b64 exec, -1
wp_ic1:
  s_barrier
  ds_read_b32 v4, v6
  s_waitcnt lgkmcnt(0)
  v_readfirstlane_b32 s33, v4
  v_and_b32 v1, 63, v0
  v_lshlrev_b32 v2, 4, v1
  v_lshrrev_b32 v3, 4, v1
  v_and_b32 v4, 15, v1
  s_cmp_ge_u32 s33, 4
  s_cbranch_scc1 wp_ini2
  v_mov_b32 v10, 0x40000000
  v_mov_b32 v5, 1
  v_mov_b32 v148, 0
  v_mov_b32 v149, 0
  v_mov_b32 v150, 0
  v_mov_b32 v151, 0
  v_mov_b32 v152, -1
  v_mov_b32 v153, -1
  v_mov_b32 v154, -1
  v_mov_b32 v155, -1
  v_lshlrev_b32 v8, 4, v0
  s_cmp_lg_u32 s33, 0
  s_cbranch_scc1 wp_ij_1
  s_mov_b32 s23, 88519168
  buffer_store_dwordx4 v[148:151], v8, s[8:11], s23 offen sc1
  s_mov_b32 s23, 88523264
  buffer_store_dwordx4 v[148:151], v8, s[8:11], s23 offen sc1
  s_waitcnt vmcnt(0)
  s_barrier
  buffer_store_dword v5, v252, s[12:15], 0 offen offset:128 sc1
wp_ij_1:
  s_mov_b32 s68, s50
  s_and_b32 s69, s51, 0xffff
  s_mov_b32 s70, 7168
  s_mov_b32 s71, 0x20000
  v_lshrrev_b32 v6, 3, v0
  v_min_u32 v6, 27, v6
  v_and_b32 v7, 7, v0
  v_mul_u32_u24 v9, 896, v7
  v_lshl_add_u32 v9, v6, 5, v9
  buffer_load_dwordx4 v[176:179], v9, s[68:71], 0 offen
  buffer_load_dwordx4 v[180:183], v9, s[68:71], 0 offen offset:16
  s_lshl_b32 s20, s33, 12
  v_add_u32 v8, s20, v8
  s_mov_b32 s23, 88461312
wp_ijlp_2:
  buffer_store_dwordx4 v[148:151], v8, s[8:11], s23 offen sc1
  s_add_u32 s23, s23, 16384
  s_cmp_lt_u32 s23, 88510464
  s_cbranch_scc1 wp_ijlp_2
  v_cmp_gt_u32 vcc, 8704, v8
  s_nop 1
  v_cndmask_b32 v9, v10, v8, vcc
  buffer_store_dwordx4 v[148:151], v9, s[8:11], s23 offen sc1
  s_mov_b32 s23, 75729408
  v_cmp_gt_u32 vcc, 6144, v8
  s_nop 1
  v_cndmask_b32 v9, v10, v8, vcc
  buffer_store_dwordx4 v[148:151], v9, s[8:11], s23 offen sc1
  s_mov_b32 s23, 75701248
wp_ijlp_3:
  buffer_store_dwordx4 v[152:155], v8, s[8:11], s23 offen sc1
  s_add_u32 s23, s23, 16384
  s_cmp_lt_u32 s23, 75717632
  s_cbranch_scc1 wp_ijlp_3
  v_cmp_gt_u32 vcc, 11776, v8
  s_nop 1
  v_cndmask_b32 v9, v10, v8, vcc
  buffer_store_dwordx4 v[152:155], v9, s[8:11], s23 offen sc1
  s_mov_b32 s23, 88009728
wp_ijlp_4:
  buffer_store_dwordx4 v[152:155], v8, s[8:11], s23 offen sc1
  s_add_u32 s23, s23, 16384
  s_cmp_lt_u32 s23, 88452096
  s_cbranch_scc1 wp_ijlp_4
  v_cmp_gt_u32 vcc, 9216, v8
  s_nop 1
  v_cndmask_b32 v9, v10, v8, vcc
  buffer_store_dwordx4 v[152:155], v9, s[8:11], s23 offen sc1
  s_cmp_lg_u32 s33, 1
  s_cbranch_scc1 wp_ij_nm
  v_lshrrev_b32 v6, 3, v0
  v_and_b32 v7, 7, v0
  v_lshlrev_b32 v8, 8, v6
  v_lshl_add_u32 v8, v7, 4, v8
  v_cmp_gt_u32 vcc, 28, v6
  s_nop 1
  v_cndmask_b32 v8, v10, v8, vcc
  s_waitcnt vmcnt(8)
  v_mov_b32 v184, v176
  v_mov_b32 v188, v177
  v_mov_b32 v185, v178
  v_mov_b32 v189, v179
  v_mov_b32 v186, v180
  v_mov_b32 v190, v181
  v_mov_b32 v187, v182
  v_mov_b32 v191, v183
  s_mov_b32 s23, 75694080
  buffer_store_dwordx4 v[184:187], v8, s[8:11], s23 offen sc1
  buffer_store_dwordx4 v[188:191], v8, s[8:11], s23 offen offset:128 sc1
  s_mov_b32 s23, 88002560
  buffer_store_dwordx4 v[184:187], v8, s[8:11], s23 offen sc1
  buffer_store_dwordx4 v[188:191], v8, s[8:11], s23 offen offset:128 sc1
wp_ij_nm:
  s_waitcnt vmcnt(0)
  s_barrier
  s_cmp_lg_u32 s16, 0
  s_cbranch_scc1 wp_ij_e
  v_mov_b32 v6, 1
  s_mov_b64 exec, 1
  buffer_atomic_add v6, v252, s[12:15], 0 offen offset:12 sc0
  s_waitcnt vmcnt(0)
  v_readfirstlane_b32 s20, v6
  s_cmp_lg_u32 s20, 3
  s_cbranch_scc1 wp_ij_e0
  buffer_store_dword v5, v252, s[12:15], 0 offen offset:132 sc1
wp_ij_e0:
  s_mov_b64 exec, -1
wp_ij_e:
wp_ini2:
  s_cmp_lg_u32 s97, 0
  s_cbranch_scc1 wp_all
  s_cmp_lg_u32 s3, 0
  s_cbranch_scc1 wp_all
  v_readfirstlane_b32 s91, v249
  v_mov_b32 v6, 160032
  s_nop 0
  v_mov_b32 v7, s91
  s_barrier
  s_cmp_lg_u32 s16, 0
  s_cbranch_scc1 uni_5
  ds_write_b32 v6, v7
  s_waitcnt lgkmcnt(0)
uni_5:
  s_barrier
  ds_read_b32 v7, v6
  s_waitcnt lgkmcnt(0)
  v_readfirstlane_b32 s91, v7
  s_and_b32 s91, s91, 0xffff
  s_cmp_lt_u32 s91, 32
  s_cbranch_scc1 ch_role2
  s_branch wp_all
wp_B:
  s_mul_i32 s17, s33, 4682
  s_lshr_b32 s17, s17, 16
  s_mul_i32 s23, s17, 14
  s_sub_u32 s19, s33, s23
  s_cmp_lt_u32 s19, 7
  s_cselect_b32 s18, 0, 7
  s_cselect_b32 s28, 0, 8
  s_sub_u32 s18, s19, s18
  s_add_u32 s28, s28, s16
  s_lshl_b32 s25, s16, 15
  s_add_u32 s25, s25, 32768
  s_lshl_b32 s26, s17, 9
  s_cmp_lt_u32 s19, 7
  s_cselect_b32 s64, s44, s46
  s_cselect_b32 s65, s45, s47
  s_cselect_b32 s27, 0, 7
  s_mov_b32 s68, s64
  s_and_b32 s69, s65, 0xffff
  s_mov_b32 s70, 3670016
  s_mov_b32 s71, 0x20000
  s_sub_u32 s31, s19, s27
  s_lshl_b32 s27, s31, 19
  s_add_u32 s27, s27, s26
  v_lshrrev_b32 v7, 2, v0
  v_and_b32 v8, 3, v0
  v_lshlrev_b32 v8, 7, v8
  v_lshl_add_u32 v9, v7, 13, v8
  s_mul_i32 s30, s17, 229376
  s_lshl_b32 s31, s31, 15
  s_add_u32 s30, s30, s31
  s_cmp_lt_u32 s19, 7
  s_cselect_b32 s27, s27, s30
  s_cselect_b64 vcc, -1, 0
  v_lshlrev_b32 v8, 7, v0
  v_cndmask_b32 v9, v8, v9, vcc
  buffer_load_dword v253, v9, s[68:71], s27 offen nt
  s_lshl_b32 s20, s33, 2
  s_add_u32 s20, s20, s16
  s_mul_i32 s21, s20, 9363
  s_lshr_b32 s21, s21, 16
  s_mul_i32 s22, s21, 7
  s_sub_u32 s22, s20, s22
  s_mul_i32 s21, s21, 14336
  s_lshl_b32 s20, s22, 7
  s_add_u32 s20, s20, s21
  s_lshl_b32 s22, s22, 11
  s_add_u32 s52, s21, s22
  s_mov_b32 s68, s48
  s_and_b32 s69, s49, 0xffff
  s_mov_b32 s70, 1835008
  s_mov_b32 s71, 0x20000
  v_mul_u32_u24 v7, 896, v4
  v_lshl_add_u32 v7, v3, 5, v7
  buffer_load_dwordx4 v[128:131], v7, s[68:71], s20 offen
  buffer_load_dwordx4 v[132:135], v7, s[68:71], s20 offen offset:16
  s_mov_b32 s60, s44
  s_and_b32 s61, s45, 0xffff
  s_mov_b32 s62, 3670016
  s_mov_b32 s63, 0x20000
  s_mov_b32 s56, s46
  s_and_b32 s57, s47, 0xffff
  s_mov_b32 s58, 3670016
  s_mov_b32 s59, 0x20000
  s_mul_i32 s27, s17, 229376
  s_lshl_b32 s30, s18, 7
  s_add_u32 s27, s27, s30
  s_mul_i32 s30, s16, 57344
  s_add_u32 s27, s27, s30
  v_lshrrev_b32 v7, 3, v1
  v_and_b32 v8, 7, v1
  v_and_b32 v9, 2, v7
  v_xor_b32 v8, v8, v9
  v_mul_u32_u24 v7, 896, v7
  v_lshl_add_u32 v24, v8, 4, v7
  v_xor_b32 v25, 64, v24
  s_lshl_b32 s30, s16, 13
  s_add_u32 m0, s30, 0
  s_nop 0
  buffer_load_dwordx4 v24, s[56:59], s27 offen  lds
  s_add_u32 s27, s27, 7168
  s_add_u32 m0, s30, 1024
  s_nop 0
  buffer_load_dwordx4 v25, s[56:59], s27 offen  lds
  s_add_u32 s27, s27, 7168
  s_add_u32 m0, s30, 2048
  s_nop 0
  buffer_load_dwordx4 v24, s[56:59], s27 offen  lds
  s_add_u32 s27, s27, 7168
  s_add_u32 m0, s30, 3072
  s_nop 0
  buffer_load_dwordx4 v25, s[56:59], s27 offen  lds
  s_add_u32 s27, s27, 7168
  s_add_u32 m0, s30, 4096
  s_nop 0
  buffer_load_dwordx4 v24, s[56:59], s27 offen  lds
  s_add_u32 s27, s27, 7168
  s_add_u32 m0, s30, 5120
  s_nop 0
  buffer_load_dwordx4 v25, s[56:59], s27 offen  lds
  s_add_u32 s27, s27, 7168
  s_add_u32 m0, s30, 6144
  s_nop 0
  buffer_load_dwordx4 v24, s[56:59], s27 offen  lds
  s_add_u32 s27, s27, 7168
  s_add_u32 m0, s30, 7168
  s_nop 0
  buffer_load_dwordx4 v25, s[56:59], s27 offen  lds
  s_add_u32 s27, s27, 7168
  s_add_u32 s27, s28, 0
  s_min_u32 s27, s27, 13
  s_lshl_b32 s27, s27, 18
  s_add_u32 s27, s27, s26
  s_add_u32 m0, s25, 0
  s_nop 0
  buffer_load_dwordx4 v16, s[60:63], s27 offen  lds
  s_add_u32 s27, s27, 16384
  s_add_u32 m0, s25, 1024
  s_nop 0
  buffer_load_dwordx4 v17, s[60:63], s27 offen  lds
  s_add_u32 s27, s27, 16384
  s_add_u32 m0, s25, 2048
  s_nop 0
  buffer_load_dwordx4 v16, s[60:63], s27 offen  lds
  s_add_u32 s27, s27, 16384
  s_add_u32 m0, s25, 3072
  s_nop 0
  buffer_load_dwordx4 v17, s[60:63], s27 offen  lds
  s_add_u32 s27, s27, 16384
  s_add_u32 m0, s25, 4096
  s_nop 0
  buffer_load_dwordx4 v18, s[60:63], s27 offen  lds
  s_add_u32 s27, s27, 16384
  s_add_u32 m0, s25, 5120
  s_nop 0
  buffer_load_dwordx4 v19, s[60:63], s27 offen  lds
  s_add_u32 s27, s27, 16384
  s_add_u32 m0, s25, 6144
  s_nop 0
  buffer_load_dwordx4 v18, s[60:63], s27 offen  lds
  s_add_u32 s27, s27, 16384
  s_add_u32 m0, s25, 7168
  s_nop 0
  buffer_load_dwordx4 v19, s[60:63], s27 offen  lds
  s_add_u32 s27, s27, 16384
  s_add_u32 m0, s25, 8192
  s_nop 0
  buffer_load_dwordx4 v20, s[60:63], s27 offen  lds
  s_add_u32 s27, s27, 16384
  s_add_u32 m0, s25, 9216
  s_nop 0
  buffer_load_dwordx4 v21, s[60:63], s27 offen  lds
  s_add_u32 s27, s27, 16384
  s_add_u32 m0, s25, 10240
  s_nop 0
  buffer_load_dwordx4 v20, s[60:63], s27 offen  lds
  s_add_u32 s27, s27, 16384
  s_add_u32 m0, s25, 11264
  s_nop 0
  buffer_load_dwordx4 v21, s[60:63], s27 offen  lds
  s_add_u32 s27, s27, 16384
  s_add_u32 m0, s25, 12288
  s_nop 0
  buffer_load_dwordx4 v22, s[60:63], s27 offen  lds
  s_add_u32 s27, s27, 16384
  s_add_u32 m0, s25, 13312
  s_nop 0
  buffer_load_dwordx4 v23, s[60:63], s27 offen  lds
  s_add_u32 s27, s27, 16384
  s_add_u32 m0, s25, 14336
  s_nop 0
  buffer_load_dwordx4 v22, s[60:63], s27 offen  lds
  s_add_u32 s27, s27, 16384
  s_add_u32 m0, s25, 15360
  s_nop 0
  buffer_load_dwordx4 v23, s[60:63], s27 offen  lds
  s_add_u32 s27, s27, 16384
  s_add_u32 s27, s28, 4
  s_min_u32 s27, s27, 13
  s_lshl_b32 s27, s27, 18
  s_add_u32 s27, s27, s26
  s_add_u32 m0, s25, 16384
  s_nop 0
  buffer_load_dwordx4 v16, s[60:63], s27 offen  lds
  s_add_u32 s27, s27, 16384
  s_add_u32 m0, s25, 17408
  s_nop 0
  buffer_load_dwordx4 v17, s[60:63], s27 offen  lds
  s_add_u32 s27, s27, 16384
  s_add_u32 m0, s25, 18432
  s_nop 0
  buffer_load_dwordx4 v16, s[60:63], s27 offen  lds
  s_add_u32 s27, s27, 16384
  s_add_u32 m0, s25, 19456
  s_nop 0
  buffer_load_dwordx4 v17, s[60:63], s27 offen  lds
  s_add_u32 s27, s27, 16384
  s_add_u32 m0, s25, 20480
  s_nop 0
  buffer_load_dwordx4 v18, s[60:63], s27 offen  lds
  s_add_u32 s27, s27, 16384
  s_add_u32 m0, s25, 21504
  s_nop 0
  buffer_load_dwordx4 v19, s[60:63], s27 offen  lds
  s_add_u32 s27, s27, 16384
  s_add_u32 m0, s25, 22528
  s_nop 0
  buffer_load_dwordx4 v18, s[60:63], s27 offen  lds
  s_add_u32 s27, s27, 16384
  s_add_u32 m0, s25, 23552
  s_nop 0
  buffer_load_dwordx4 v19, s[60:63], s27 offen  lds
  s_add_u32 s27, s27, 16384
  s_add_u32 m0, s25, 24576
  s_nop 0
  buffer_load_dwordx4 v20, s[60:63], s27 offen  lds
  s_add_u32 s27, s27, 16384
  s_add_u32 m0, s25, 25600
  s_nop 0
  buffer_load_dwordx4 v21, s[60:63], s27 offen  lds
  s_add_u32 s27, s27, 16384
  s_add_u32 m0, s25, 26624
  s_nop 0
  buffer_load_dwordx4 v20, s[60:63], s27 offen  lds
  s_add_u32 s27, s27, 16384
  s_add_u32 m0, s25, 27648
  s_nop 0
  buffer_load_dwordx4 v21, s[60:63], s27 offen  lds
  s_add_u32 s27, s27, 16384
  s_add_u32 m0, s25, 28672
  s_nop 0
  buffer_load_dwordx4 v22, s[60:63], s27 offen  lds
  s_add_u32 s27, s27, 16384
  s_add_u32 m0, s25, 29696
  s_nop 0
  buffer_load_dwordx4 v23, s[60:63], s27 offen  lds
  s_add_u32 s27, s27, 16384
  s_add_u32 m0, s25, 30720
  s_nop 0
  buffer_load_dwordx4 v22, s[60:63], s27 offen  lds
  s_add_u32 s27, s27, 16384
  s_add_u32 m0, s25, 31744
  s_nop 0
  buffer_load_dwordx4 v23, s[60:63], s27 offen  lds
  s_add_u32 s27, s27, 16384
  s_cmp_eq_u32 s35, 0
  s_cselect_b32 s34, 1, s97
  s_cmp_lt_u32 s19, 7
  s_cselect_b32 s64, s40, s42
  s_cselect_b32 s65, s41, s43
  s_cselect_b32 s27, 0, 7
  s_mov_b32 s68, s64
  s_and_b32 s69, s65, 0xffff
  s_mov_b32 s70, 3670016
  s_mov_b32 s71, 0x20000
  s_sub_u32 s31, s19, s27
  s_lshl_b32 s27, s31, 19
  s_add_u32 s27, s27, s26
  v_lshrrev_b32 v7, 2, v0
  v_and_b32 v8, 3, v0
  v_lshlrev_b32 v8, 7, v8
  v_lshl_add_u32 v9, v7, 13, v8
  s_cmp_lg_u32 s34, 0
  s_cselect_b32 s27, 0x40000000, s27
  buffer_load_dword v253, v9, s[68:71], s27 offen nt
  v_lshrrev_b32 v7, 2, v4
  v_lshlrev_b32 v7, 3, v7
  v_and_b32 v8, 3, v4
  v_add_u32 v7, v7, v8
  v_or_b32 v10, 0, v3
  v_xor_b32 v10, v10, v4
  v_lshlrev_b32 v10, 4, v10
  v_lshl_add_u32 v10, v7, 9, v10
  v_add_u32 v32, s25, v10
  v_or_b32 v10, 4, v3
  v_xor_b32 v10, v10, v4
  v_lshlrev_b32 v10, 4, v10
  v_lshl_add_u32 v10, v7, 9, v10
  v_add_u32 v33, s25, v10
  v_or_b32 v10, 8, v3
  v_xor_b32 v10, v10, v4
  v_lshlrev_b32 v10, 4, v10
  v_lshl_add_u32 v10, v7, 9, v10
  v_add_u32 v34, s25, v10
  v_or_b32 v10, 12, v3
  v_xor_b32 v10, v10, v4
  v_lshlrev_b32 v10, 4, v10
  v_lshl_add_u32 v10, v7, 9, v10
  v_add_u32 v35, s25, v10
  v_lshrrev_b32 v7, 2, v4
  v_lshl_add_u32 v7, v3, 3, v7
  v_lshlrev_b32 v7, 7, v7
  v_and_b32 v8, 3, v4
  v_lshl_add_u32 v7, v8, 3, v7
  v_lshrrev_b32 v8, 3, v4
  v_and_b32 v9, 1, v3
  v_lshl_add_u32 v8, v9, 1, v8
  v_lshl_add_u32 v40, v8, 5, v7
  s_lshl_b32 s30, s18, 6
  s_add_u32 s30, s30, 0
  v_add_u32 v8, s30, v4
  v_subrev_u32 v9, 256, v8
  v_mul_u32_u24 v11, 171, v9
  v_lshrrev_b32 v11, 11, v11
  v_mul_u32_u24 v38, 12, v11
  v_sub_u32 v38, v9, v38
  v_add_u32 v38, 16, v38
  v_lshrrev_b32 v10, 4, v8
  v_cmp_gt_i32 vcc, 0, v9
  s_nop 1
  v_cndmask_b32 v10, v11, v10, vcc
  v_cndmask_b32 v37, v38, v4, vcc
  s_mul_i32 s30, s17, 28
  v_add_u32 v37, s30, v37
  v_lshrrev_b32 v38, 4, v37
  v_and_b32 v37, 15, v37
  s_mov_b32 s30, 401408
  v_mul_lo_u32 v10, v10, s30
  v_mul_u32_u24 v38, 14336, v38
  v_add_u32 v10, v10, v38
  v_lshl_add_u32 v10, v3, 8, v10
  v_lshl_add_u32 v10, v37, 4, v10
  v_add_u32 v12, 6422528, v10
  v_xor_b32 v41, 32, v40
  s_lshl_b32 s30, s18, 6
  s_add_u32 s30, s30, 16
  v_add_u32 v8, s30, v4
  v_subrev_u32 v9, 256, v8
  v_mul_u32_u24 v11, 171, v9
  v_lshrrev_b32 v11, 11, v11
  v_mul_u32_u24 v38, 12, v11
  v_sub_u32 v38, v9, v38
  v_add_u32 v38, 16, v38
  v_lshrrev_b32 v10, 4, v8
  v_cmp_gt_i32 vcc, 0, v9
  s_nop 1
  v_cndmask_b32 v10, v11, v10, vcc
  v_cndmask_b32 v37, v38, v4, vcc
  s_mul_i32 s30, s17, 28
  v_add_u32 v37, s30, v37
  v_lshrrev_b32 v38, 4, v37
  v_and_b32 v37, 15, v37
  s_mov_b32 s30, 401408
  v_mul_lo_u32 v10, v10, s30
  v_mul_u32_u24 v38, 14336, v38
  v_add_u32 v10, v10, v38
  v_lshl_add_u32 v10, v3, 8, v10
  v_lshl_add_u32 v10, v37, 4, v10
  v_add_u32 v13, 6422528, v10
  v_xor_b32 v42, 64, v40
  s_lshl_b32 s30, s18, 6
  s_add_u32 s30, s30, 32
  v_add_u32 v8, s30, v4
  v_subrev_u32 v9, 256, v8
  v_mul_u32_u24 v11, 171, v9
  v_lshrrev_b32 v11, 11, v11
  v_mul_u32_u24 v38, 12, v11
  v_sub_u32 v38, v9, v38
  v_add_u32 v38, 16, v38
  v_lshrrev_b32 v10, 4, v8
  v_cmp_gt_i32 vcc, 0, v9
  s_nop 1
  v_cndmask_b32 v10, v11, v10, vcc
  v_cndmask_b32 v37, v38, v4, vcc
  s_mul_i32 s30, s17, 28
  v_add_u32 v37, s30, v37
  v_lshrrev_b32 v38, 4, v37
  v_and_b32 v37, 15, v37
  s_mov_b32 s30, 401408
  v_mul_lo_u32 v10, v10, s30
  v_mul_u32_u24 v38, 14336, v38
  v_add_u32 v10, v10, v38
  v_lshl_add_u32 v10, v3, 8, v10
  v_lshl_add_u32 v10, v37, 4, v10
  v_add_u32 v14, 6422528, v10
  v_xor_b32 v43, 96, v40
  s_lshl_b32 s30, s18, 6
  s_add_u32 s30, s30, 48
  v_add_u32 v8, s30, v4
  v_subrev_u32 v9, 256, v8
  v_mul_u32_u24 v11, 171, v9
  v_lshrrev_b32 v11, 11, v11
  v_mul_u32_u24 v38, 12, v11
  v_sub_u32 v38, v9, v38
  v_add_u32 v38, 16, v38
  v_lshrrev_b32 v10, 4, v8
  v_cmp_gt_i32 vcc, 0, v9
  s_nop 1
  v_cndmask_b32 v10, v11, v10, vcc
  v_cndmask_b32 v37, v38, v4, vcc
  s_mul_i32 s30, s17, 28
  v_add_u32 v37, s30, v37
  v_lshrrev_b32 v38, 4, v37
  v_and_b32 v37, 15, v37
  s_mov_b32 s30, 401408
  v_mul_lo_u32 v10, v10, s30
  v_mul_u32_u24 v38, 14336, v38
  v_add_u32 v10, v10, v38
  v_lshl_add_u32 v10, v3, 8, v10
  v_lshl_add_u32 v10, v37, 4, v10
  v_add_u32 v15, 6422528, v10
  s_lshl_b32 s29, s28, 10
  s_add_u32 s31, s29, 4096
  s_cmp_lt_u32 s28, 10
  s_cselect_b32 s31, s31, 0x40000000
  s_waitcnt vmcnt(1)
  s_barrier
  ds_read_b64_tr_b16 a[0:1], v40 offset:0
  ds_read_b64_tr_b16 a[2:3], v40 offset:512
  ds_read_b64_tr_b16 a[32:33], v41 offset:0
  ds_read_b64_tr_b16 a[34:35], v41 offset:512
  ds_read_b64_tr_b16 a[64:65], v42 offset:0
  ds_read_b64_tr_b16 a[66:67], v42 offset:512
  ds_read_b64_tr_b16 a[96:97], v43 offset:0
  ds_read_b64_tr_b16 a[98:99], v43 offset:512
  ds_read_b128 a[128:131], v32 offset:0
  ds_read_b128 a[160:163], v32 offset:2048
  ds_read_b128 a[192:195], v32 offset:16384
  ds_read_b128 a[224:227], v32 offset:18432
  v_lshlrev_b32 v144, 9, v3
  v_lshl_add_u32 v144, v4, 4, v144
  s_add_u32 s53, s52, 73859072
  s_add_u32 s52, s52, 72024064
  v_mov_b32 v136, v128
  v_mov_b32 v140, v129
  v_mov_b32 v137, v130
  v_mov_b32 v141, v131
  v_mov_b32 v138, v132
  v_mov_b32 v142, v133
  v_mov_b32 v139, v134
  v_mov_b32 v143, v135
  buffer_store_dwordx4 v[128:131], v144, s[8:11], s52 offen sc1
  buffer_store_dwordx4 v[132:135], v144, s[8:11], s52 offen offset:256 sc1
  buffer_store_dwordx4 v[136:139], v2, s[8:11], s53 offen sc1
  buffer_store_dwordx4 v[140:143], v2, s[8:11], s53 offen offset:1024 sc1
  s_waitcnt lgkmcnt(0)
  v_mfma_f32_16x16x32_bf16 v[64:67], a[128:131], a[0:3], 0
  ds_read_b64_tr_b16 a[4:5], v40 offset:4096
  ds_read_b64_tr_b16 a[6:7], v40 offset:4608
  v_mfma_f32_16x16x32_bf16 v[68:71], a[160:163], a[0:3], 0
  ds_read_b64_tr_b16 a[36:37], v41 offset:4096
  ds_read_b64_tr_b16 a[38:39], v41 offset:4608
  v_mfma_f32_16x16x32_bf16 v[72:75], a[128:131], a[32:35], 0
  ds_read_b64_tr_b16 a[68:69], v42 offset:4096
  ds_read_b64_tr_b16 a[70:71], v42 offset:4608
  v_mfma_f32_16x16x32_bf16 v[76:79], a[160:163], a[32:35], 0
  ds_read_b64_tr_b16 a[100:101], v43 offset:4096
  ds_read_b64_tr_b16 a[102:103], v43 offset:4608
  v_mfma_f32_16x16x32_bf16 v[80:83], a[128:131], a[64:67], 0
  ds_read_b128 a[132:135], v33 offset:0
  ds_read_b128 a[164:167], v33 offset:2048
  v_mfma_f32_16x16x32_bf16 v[84:87], a[160:163], a[64:67], 0
  ds_read_b128 a[196:199], v33 offset:16384
  ds_read_b128 a[228:231], v33 offset:18432
  v_mfma_f32_16x16x32_bf16 v[88:91], a[128:131], a[96:99], 0
  v_mfma_f32_16x16x32_bf16 v[92:95], a[160:163], a[96:99], 0
  v_mfma_f32_16x16x32_bf16 v[96:99], a[192:195], a[0:3], 0
  v_mfma_f32_16x16x32_bf16 v[100:103], a[224:227], a[0:3], 0
  v_mfma_f32_16x16x32_bf16 v[104:107], a[192:195], a[32:35], 0
  v_mfma_f32_16x16x32_bf16 v[108:111], a[224:227], a[32:35], 0
  v_mfma_f32_16x16x32_bf16 v[112:115], a[192:195], a[64:67], 0
  v_mfma_f32_16x16x32_bf16 v[116:119], a[224:227], a[64:67], 0
  v_mfma_f32_16x16x32_bf16 v[120:123], a[192:195], a[96:99], 0
  v_mfma_f32_16x16x32_bf16 v[124:127], a[224:227], a[96:99], 0
  s_waitcnt lgkmcnt(0)
  v_mfma_f32_16x16x32_bf16 v[64:67], a[132:135], a[4:7], v[64:67]
  ds_read_b64_tr_b16 a[8:9], v40 offset:8192
  ds_read_b64_tr_b16 a[10:11], v40 offset:8704
  v_mfma_f32_16x16x32_bf16 v[68:71], a[164:167], a[4:7], v[68:71]
  ds_read_b64_tr_b16 a[40:41], v41 offset:8192
  ds_read_b64_tr_b16 a[42:43], v41 offset:8704
  v_mfma_f32_16x16x32_bf16 v[72:75], a[132:135], a[36:39], v[72:75]
  ds_read_b64_tr_b16 a[72:73], v42 offset:8192
  ds_read_b64_tr_b16 a[74:75], v42 offset:8704
  v_mfma_f32_16x16x32_bf16 v[76:79], a[164:167], a[36:39], v[76:79]
  ds_read_b64_tr_b16 a[104:105], v43 offset:8192
  ds_read_b64_tr_b16 a[106:107], v43 offset:8704
  v_mfma_f32_16x16x32_bf16 v[80:83], a[132:135], a[68:71], v[80:83]
  ds_read_b128 a[136:139], v34 offset:0
  ds_read_b128 a[168:171], v34 offset:2048
  v_mfma_f32_16x16x32_bf16 v[84:87], a[164:167], a[68:71], v[84:87]
  ds_read_b128 a[200:203], v34 offset:16384
  ds_read_b128 a[232:235], v34 offset:18432
  v_mfma_f32_16x16x32_bf16 v[88:91], a[132:135], a[100:103], v[88:91]
  v_mfma_f32_16x16x32_bf16 v[92:95], a[164:167], a[100:103], v[92:95]
  v_mfma_f32_16x16x32_bf16 v[96:99], a[196:199], a[4:7], v[96:99]
  v_mfma_f32_16x16x32_bf16 v[100:103], a[228:231], a[4:7], v[100:103]
  v_mfma_f32_16x16x32_bf16 v[104:107], a[196:199], a[36:39], v[104:107]
  v_mfma_f32_16x16x32_bf16 v[108:111], a[228:231], a[36:39], v[108:111]
  v_mfma_f32_16x16x32_bf16 v[112:115], a[196:199], a[68:71], v[112:115]
  v_mfma_f32_16x16x32_bf16 v[116:119], a[228:231], a[68:71], v[116:119]
  v_mfma_f32_16x16x32_bf16 v[120:123], a[196:199], a[100:103], v[120:123]
  v_mfma_f32_16x16x32_bf16 v[124:127], a[228:231], a[100:103], v[124:127]
  s_waitcnt lgkmcnt(0)
  v_mfma_f32_16x16x32_bf16 v[64:67], a[136:139], a[8:11], v[64:67]
  ds_read_b64_tr_b16 a[12:13], v40 offset:12288
  ds_read_b64_tr_b16 a[14:15], v40 offset:12800
  v_mfma_f32_16x16x32_bf16 v[68:71], a[168:171], a[8:11], v[68:71]
  ds_read_b64_tr_b16 a[44:45], v41 offset:12288
  ds_read_b64_tr_b16 a[46:47], v41 offset:12800
  v_mfma_f32_16x16x32_bf16 v[72:75], a[136:139], a[40:43], v[72:75]
  ds_read_b64_tr_b16 a[76:77], v42 offset:12288
  ds_read_b64_tr_b16 a[78:79], v42 offset:12800
  v_mfma_f32_16x16x32_bf16 v[76:79], a[168:171], a[40:43], v[76:79]
  ds_read_b64_tr_b16 a[108:109], v43 offset:12288
  ds_read_b64_tr_b16 a[110:111], v43 offset:12800
  v_mfma_f32_16x16x32_bf16 v[80:83], a[136:139], a[72:75], v[80:83]
  ds_read_b128 a[140:143], v35 offset:0
  ds_read_b128 a[172:175], v35 offset:2048
  v_mfma_f32_16x16x32_bf16 v[84:87], a[168:171], a[72:75], v[84:87]
  ds_read_b128 a[204:207], v35 offset:16384
  ds_read_b128 a[236:239], v35 offset:18432
  v_mfma_f32_16x16x32_bf16 v[88:91], a[136:139], a[104:107], v[88:91]
  v_mfma_f32_16x16x32_bf16 v[92:95], a[168:171], a[104:107], v[92:95]
  v_mfma_f32_16x16x32_bf16 v[96:99], a[200:203], a[8:11], v[96:99]
  v_mfma_f32_16x16x32_bf16 v[100:103], a[232:235], a[8:11], v[100:103]
  v_mfma_f32_16x16x32_bf16 v[104:107], a[200:203], a[40:43], v[104:107]
  v_mfma_f32_16x16x32_bf16 v[108:111], a[232:235], a[40:43], v[108:111]
  v_mfma_f32_16x16x32_bf16 v[112:115], a[200:203], a[72:75], v[112:115]
  v_mfma_f32_16x16x32_bf16 v[116:119], a[232:235], a[72:75], v[116:119]
  v_mfma_f32_16x16x32_bf16 v[120:123], a[200:203], a[104:107], v[120:123]
  v_mfma_f32_16x16x32_bf16 v[124:127], a[232:235], a[104:107], v[124:127]
  s_waitcnt lgkmcnt(0)
  v_mfma_f32_16x16x32_bf16 v[64:67], a[140:143], a[12:15], v[64:67]
  ds_read_b64_tr_b16 a[16:17], v40 offset:16384
  ds_read_b64_tr_b16 a[18:19], v40 offset:16896
  v_mfma_f32_16x16x32_bf16 v[68:71], a[172:175], a[12:15], v[68:71]
  ds_read_b64_tr_b16 a[48:49], v41 offset:16384
  ds_read_b64_tr_b16 a[50:51], v41 offset:16896
  v_mfma_f32_16x16x32_bf16 v[72:75], a[140:143], a[44:47], v[72:75]
  ds_read_b64_tr_b16 a[80:81], v42 offset:16384
  ds_read_b64_tr_b16 a[82:83], v42 offset:16896
  v_mfma_f32_16x16x32_bf16 v[76:79], a[172:175], a[44:47], v[76:79]
  ds_read_b64_tr_b16 a[112:113], v43 offset:16384
  ds_read_b64_tr_b16 a[114:115], v43 offset:16896
  v_mfma_f32_16x16x32_bf16 v[80:83], a[140:143], a[76:79], v[80:83]
  ds_read_b128 a[144:147], v32 offset:256
  ds_read_b128 a[176:179], v32 offset:2304
  v_mfma_f32_16x16x32_bf16 v[84:87], a[172:175], a[76:79], v[84:87]
  ds_read_b128 a[208:211], v32 offset:16640
  ds_read_b128 a[240:243], v32 offset:18688
  v_mfma_f32_16x16x32_bf16 v[88:91], a[140:143], a[108:111], v[88:91]
  v_mfma_f32_16x16x32_bf16 v[92:95], a[172:175], a[108:111], v[92:95]
  v_mfma_f32_16x16x32_bf16 v[96:99], a[204:207], a[12:15], v[96:99]
  v_mfma_f32_16x16x32_bf16 v[100:103], a[236:239], a[12:15], v[100:103]
  v_mfma_f32_16x16x32_bf16 v[104:107], a[204:207], a[44:47], v[104:107]
  v_mfma_f32_16x16x32_bf16 v[108:111], a[236:239], a[44:47], v[108:111]
  v_mfma_f32_16x16x32_bf16 v[112:115], a[204:207], a[76:79], v[112:115]
  v_mfma_f32_16x16x32_bf16 v[116:119], a[236:239], a[76:79], v[116:119]
  v_mfma_f32_16x16x32_bf16 v[120:123], a[204:207], a[108:111], v[120:123]
  v_mfma_f32_16x16x32_bf16 v[124:127], a[236:239], a[108:111], v[124:127]
  s_waitcnt lgkmcnt(0)
  v_mfma_f32_16x16x32_bf16 v[64:67], a[144:147], a[16:19], v[64:67]
  ds_read_b64_tr_b16 a[20:21], v40 offset:20480
  ds_read_b64_tr_b16 a[22:23], v40 offset:20992
  v_mfma_f32_16x16x32_bf16 v[68:71], a[176:179], a[16:19], v[68:71]
  ds_read_b64_tr_b16 a[52:53], v41 offset:20480
  ds_read_b64_tr_b16 a[54:55], v41 offset:20992
  v_mfma_f32_16x16x32_bf16 v[72:75], a[144:147], a[48:51], v[72:75]
  ds_read_b64_tr_b16 a[84:85], v42 offset:20480
  ds_read_b64_tr_b16 a[86:87], v42 offset:20992
  v_mfma_f32_16x16x32_bf16 v[76:79], a[176:179], a[48:51], v[76:79]
  ds_read_b64_tr_b16 a[116:117], v43 offset:20480
  ds_read_b64_tr_b16 a[118:119], v43 offset:20992
  v_mfma_f32_16x16x32_bf16 v[80:83], a[144:147], a[80:83], v[80:83]
  ds_read_b128 a[148:151], v33 offset:256
  ds_read_b128 a[180:183], v33 offset:2304
  v_mfma_f32_16x16x32_bf16 v[84:87], a[176:179], a[80:83], v[84:87]
  ds_read_b128 a[212:215], v33 offset:16640
  ds_read_b128 a[244:247], v33 offset:18688
  v_mfma_f32_16x16x32_bf16 v[88:91], a[144:147], a[112:115], v[88:91]
  v_mfma_f32_16x16x32_bf16 v[92:95], a[176:179], a[112:115], v[92:95]
  v_mfma_f32_16x16x32_bf16 v[96:99], a[208:211], a[16:19], v[96:99]
  v_mfma_f32_16x16x32_bf16 v[100:103], a[240:243], a[16:19], v[100:103]
  v_mfma_f32_16x16x32_bf16 v[104:107], a[208:211], a[48:51], v[104:107]
  v_mfma_f32_16x16x32_bf16 v[108:111], a[240:243], a[48:51], v[108:111]
  v_mfma_f32_16x16x32_bf16 v[112:115], a[208:211], a[80:83], v[112:115]
  v_mfma_f32_16x16x32_bf16 v[116:119], a[240:243], a[80:83], v[116:119]
  v_mfma_f32_16x16x32_bf16 v[120:123], a[208:211], a[112:115], v[120:123]
  v_mfma_f32_16x16x32_bf16 v[124:127], a[240:243], a[112:115], v[124:127]
  s_waitcnt lgkmcnt(0)
  v_mfma_f32_16x16x32_bf16 v[64:67], a[148:151], a[20:23], v[64:67]
  ds_read_b64_tr_b16 a[24:25], v40 offset:24576
  ds_read_b64_tr_b16 a[26:27], v40 offset:25088
  v_mfma_f32_16x16x32_bf16 v[68:71], a[180:183], a[20:23], v[68:71]
  ds_read_b64_tr_b16 a[56:57], v41 offset:24576
  ds_read_b64_tr_b16 a[58:59], v41 offset:25088
  v_mfma_f32_16x16x32_bf16 v[72:75], a[148:151], a[52:55], v[72:75]
  ds_read_b64_tr_b16 a[88:89], v42 offset:24576
  ds_read_b64_tr_b16 a[90:91], v42 offset:25088
  v_mfma_f32_16x16x32_bf16 v[76:79], a[180:183], a[52:55], v[76:79]
  ds_read_b64_tr_b16 a[120:121], v43 offset:24576
  ds_read_b64_tr_b16 a[122:123], v43 offset:25088
  v_mfma_f32_16x16x32_bf16 v[80:83], a[148:151], a[84:87], v[80:83]
  ds_read_b128 a[152:155], v34 offset:256
  ds_read_b128 a[184:187], v34 offset:2304
  v_mfma_f32_16x16x32_bf16 v[84:87], a[180:183], a[84:87], v[84:87]
  ds_read_b128 a[216:219], v34 offset:16640
  ds_read_b128 a[248:251], v34 offset:18688
  v_mfma_f32_16x16x32_bf16 v[88:91], a[148:151], a[116:119], v[88:91]
  v_mfma_f32_16x16x32_bf16 v[92:95], a[180:183], a[116:119], v[92:95]
  v_mfma_f32_16x16x32_bf16 v[96:99], a[212:215], a[20:23], v[96:99]
  v_mfma_f32_16x16x32_bf16 v[100:103], a[244:247], a[20:23], v[100:103]
  v_mfma_f32_16x16x32_bf16 v[104:107], a[212:215], a[52:55], v[104:107]
  v_mfma_f32_16x16x32_bf16 v[108:111], a[244:247], a[52:55], v[108:111]
  v_mfma_f32_16x16x32_bf16 v[112:115], a[212:215], a[84:87], v[112:115]
  v_mfma_f32_16x16x32_bf16 v[116:119], a[244:247], a[84:87], v[116:119]
  v_mfma_f32_16x16x32_bf16 v[120:123], a[212:215], a[116:119], v[120:123]
  v_mfma_f32_16x16x32_bf16 v[124:127], a[244:247], a[116:119], v[124:127]
  s_waitcnt lgkmcnt(0)
  v_mfma_f32_16x16x32_bf16 v[64:67], a[152:155], a[24:27], v[64:67]
  ds_read_b64_tr_b16 a[28:29], v40 offset:28672
  ds_read_b64_tr_b16 a[30:31], v40 offset:29184
  v_mfma_f32_16x16x32_bf16 v[68:71], a[184:187], a[24:27], v[68:71]
  ds_read_b64_tr_b16 a[60:61], v41 offset:28672
  ds_read_b64_tr_b16 a[62:63], v41 offset:29184
  v_mfma_f32_16x16x32_bf16 v[72:75], a[152:155], a[56:59], v[72:75]
  ds_read_b64_tr_b16 a[92:93], v42 offset:28672
  ds_read_b64_tr_b16 a[94:95], v42 offset:29184
  v_mfma_f32_16x16x32_bf16 v[76:79], a[184:187], a[56:59], v[76:79]
  ds_read_b64_tr_b16 a[124:125], v43 offset:28672
  ds_read_b64_tr_b16 a[126:127], v43 offset:29184
  v_mfma_f32_16x16x32_bf16 v[80:83], a[152:155], a[88:91], v[80:83]
  ds_read_b128 a[156:159], v35 offset:256
  ds_read_b128 a[188:191], v35 offset:2304
  v_mfma_f32_16x16x32_bf16 v[84:87], a[184:187], a[88:91], v[84:87]
  ds_read_b128 a[220:223], v35 offset:16640
  ds_read_b128 a[252:255], v35 offset:18688
  v_mfma_f32_16x16x32_bf16 v[88:91], a[152:155], a[120:123], v[88:91]
  v_mfma_f32_16x16x32_bf16 v[92:95], a[184:187], a[120:123], v[92:95]
  v_mfma_f32_16x16x32_bf16 v[96:99], a[216:219], a[24:27], v[96:99]
  v_mfma_f32_16x16x32_bf16 v[100:103], a[248:251], a[24:27], v[100:103]
  v_mfma_f32_16x16x32_bf16 v[104:107], a[216:219], a[56:59], v[104:107]
  v_mfma_f32_16x16x32_bf16 v[108:111], a[248:251], a[56:59], v[108:111]
  v_mfma_f32_16x16x32_bf16 v[112:115], a[216:219], a[88:91], v[112:115]
  v_mfma_f32_16x16x32_bf16 v[116:119], a[248:251], a[88:91], v[116:119]
  v_mfma_f32_16x16x32_bf16 v[120:123], a[216:219], a[120:123], v[120:123]
  v_mfma_f32_16x16x32_bf16 v[124:127], a[248:251], a[120:123], v[124:127]
  s_waitcnt lgkmcnt(0)
  s_barrier
  buffer_load_dwordx2 v[254:255], v252, s[12:15], 0 offen offset:128 sc1
  v_mfma_f32_16x16x32_bf16 v[64:67], a[156:159], a[28:31], v[64:67]
  v_mfma_f32_16x16x32_bf16 v[68:71], a[188:191], a[28:31], v[68:71]
  v_mfma_f32_16x16x32_bf16 v[72:75], a[156:159], a[60:63], v[72:75]
  v_mfma_f32_16x16x32_bf16 v[76:79], a[188:191], a[60:63], v[76:79]
  v_mfma_f32_16x16x32_bf16 v[80:83], a[156:159], a[92:95], v[80:83]
  v_cvt_pk_bf16_f32 v64, v64, v65
  v_cvt_pk_bf16_f32 v65, v66, v67
  v_mfma_f32_16x16x32_bf16 v[84:87], a[188:191], a[92:95], v[84:87]
  v_cvt_pk_bf16_f32 v66, v68, v69
  v_cvt_pk_bf16_f32 v67, v70, v71
  v_mfma_f32_16x16x32_bf16 v[88:91], a[156:159], a[124:127], v[88:91]
  buffer_store_dwordx4 v[64:67], v12, s[8:11], s29 offen sc1
  v_cvt_pk_bf16_f32 v72, v72, v73
  v_mfma_f32_16x16x32_bf16 v[92:95], a[188:191], a[124:127], v[92:95]
  v_cvt_pk_bf16_f32 v73, v74, v75
  v_cvt_pk_bf16_f32 v74, v76, v77
  v_mfma_f32_16x16x32_bf16 v[96:99], a[220:223], a[28:31], v[96:99]
  v_cvt_pk_bf16_f32 v75, v78, v79
  buffer_store_dwordx4 v[72:75], v13, s[8:11], s29 offen sc1
  v_mfma_f32_16x16x32_bf16 v[100:103], a[252:255], a[28:31], v[100:103]
  v_cvt_pk_bf16_f32 v80, v80, v81
  v_cvt_pk_bf16_f32 v81, v82, v83
  v_mfma_f32_16x16x32_bf16 v[104:107], a[220:223], a[60:63], v[104:107]
  v_cvt_pk_bf16_f32 v82, v84, v85
  v_cvt_pk_bf16_f32 v83, v86, v87
  v_mfma_f32_16x16x32_bf16 v[108:111], a[252:255], a[60:63], v[108:111]
  buffer_store_dwordx4 v[80:83], v14, s[8:11], s29 offen sc1
  v_cvt_pk_bf16_f32 v88, v88, v89
  v_mfma_f32_16x16x32_bf16 v[112:115], a[220:223], a[92:95], v[112:115]
  v_cvt_pk_bf16_f32 v89, v90, v91
  v_cvt_pk_bf16_f32 v90, v92, v93
  v_mfma_f32_16x16x32_bf16 v[116:119], a[252:255], a[92:95], v[116:119]
  v_cvt_pk_bf16_f32 v91, v94, v95
  buffer_store_dwordx4 v[88:91], v15, s[8:11], s29 offen sc1
  v_mfma_f32_16x16x32_bf16 v[120:123], a[220:223], a[124:127], v[120:123]
  v_cvt_pk_bf16_f32 v96, v96, v97
  v_cvt_pk_bf16_f32 v97, v98, v99
  v_mfma_f32_16x16x32_bf16 v[124:127], a[252:255], a[124:127], v[124:127]
  v_cvt_pk_bf16_f32 v98, v100, v101
  v_cvt_pk_bf16_f32 v99, v102, v103
  buffer_store_dwordx4 v[96:99], v12, s[8:11], s31 offen sc1
  v_cvt_pk_bf16_f32 v104, v104, v105
  v_cvt_pk_bf16_f32 v105, v106, v107
  v_cvt_pk_bf16_f32 v106, v108, v109
  v_cvt_pk_bf16_f32 v107, v110, v111
  buffer_store_dwordx4 v[104:107], v13, s[8:11], s31 offen sc1
  v_cvt_pk_bf16_f32 v112, v112, v113
  v_cvt_pk_bf16_f32 v113, v114, v115
  v_cvt_pk_bf16_f32 v114, v116, v117
  v_cvt_pk_bf16_f32 v115, v118, v119
  buffer_store_dwordx4 v[112:115], v14, s[8:11], s31 offen sc1
  v_cvt_pk_bf16_f32 v120, v120, v121
  v_cvt_pk_bf16_f32 v121, v122, v123
  v_cvt_pk_bf16_f32 v122, v124, v125
  v_cvt_pk_bf16_f32 v123, v126, v127
  buffer_store_dwordx4 v[120:123], v15, s[8:11], s31 offen sc1
  s_cmp_lg_u32 s34, 0
  s_cbranch_scc1 wp_B2
  s_mov_b32 s60, s40
  s_and_b32 s61, s41, 0xffff
  s_mov_b32 s62, 3670016
  s_mov_b32 s63, 0x20000
  s_mov_b32 s56, s42
  s_and_b32 s57, s43, 0xffff
  s_mov_b32 s58, 3670016
  s_mov_b32 s59, 0x20000
  s_lshl_b32 s27, s18, 2
  s_add_u32 s27, s27, s16
  s_lshl_b32 s27, s27, 17
  s_add_u32 s27, s27, s26
  s_lshl_b32 s30, s16, 13
  s_add_u32 m0, s30, 0
  s_nop 0
  buffer_load_dwordx4 v16, s[56:59], s27 offen  lds
  s_add_u32 s27, s27, 16384
  s_add_u32 m0, s30, 1024
  s_nop 0
  buffer_load_dwordx4 v17, s[56:59], s27 offen  lds
  s_add_u32 s27, s27, 16384
  s_add_u32 m0, s30, 2048
  s_nop 0
  buffer_load_dwordx4 v18, s[56:59], s27 offen  lds
  s_add_u32 s27, s27, 16384
  s_add_u32 m0, s30, 3072
  s_nop 0
  buffer_load_dwordx4 v19, s[56:59], s27 offen  lds
  s_add_u32 s27, s27, 16384
  s_add_u32 m0, s30, 4096
  s_nop 0
  buffer_load_dwordx4 v20, s[56:59], s27 offen  lds
  s_add_u32 s27, s27, 16384
  s_add_u32 m0, s30, 5120
  s_nop 0
  buffer_load_dwordx4 v21, s[56:59], s27 offen  lds
  s_add_u32 s27, s27, 16384
  s_add_u32 m0, s30, 6144
  s_nop 0
  buffer_load_dwordx4 v22, s[56:59], s27 offen  lds
  s_add_u32 s27, s27, 16384
  s_add_u32 m0, s30, 7168
  s_nop 0
  buffer_load_dwordx4 v23, s[56:59], s27 offen  lds
  s_add_u32 s27, s27, 16384
  s_add_u32 s27, s28, 0
  s_min_u32 s27, s27, 13
  s_lshl_b32 s27, s27, 18
  s_add_u32 s27, s27, s26
  s_add_u32 m0, s25, 0
  s_nop 0
  buffer_load_dwordx4 v16, s[60:63], s27 offen  lds
  s_add_u32 s27, s27, 16384
  s_add_u32 m0, s25, 1024
  s_nop 0
  buffer_load_dwordx4 v17, s[60:63], s27 offen  lds
  s_add_u32 s27, s27, 16384
  s_add_u32 m0, s25, 2048
  s_nop 0
  buffer_load_dwordx4 v16, s[60:63], s27 offen  lds
  s_add_u32 s27, s27, 16384
  s_add_u32 m0, s25, 3072
  s_nop 0
  buffer_load_dwordx4 v17, s[60:63], s27 offen  lds
  s_add_u32 s27, s27, 16384
  s_waitcnt vmcnt(12)
  s_barrier
  s_cmp_lg_u32 s16, 0
  s_cbranch_scc1 wp_f1_f
  v_readfirstlane_b32 s20, v254
  s_cmp_eq_u32 s20, 1
  s_cbranch_scc1 wp_f1_w_ok
  s_mov_b32 s30, 0
wp_f1_w:
  buffer_load_dword v254, off, s[12:15], 0 offset:128 sc1
  s_waitcnt vmcnt(0)
  v_cmp_ne_u32 vcc, 1, v254
  s_cbranch_vccz wp_f1_w_ok
  s_sleep 8
  s_add_u32 s30, s30, 1
  s_cmp_lt_u32 s30, 16
  s_cbranch_scc1 wp_f1_w
  s_branch wp_f1_f
wp_f1_w_ok:
  s_lshl_b32 s20, s17, 7
  s_add_u32 s20, s20, 88519168
  s_lshl_b32 s21, 1, s19
  v_mov_b32 v248, s21
  s_mov_b64 exec, 1
  buffer_atomic_or v248, v252, s[8:11], s20 offen sc0
  s_mov_b64 exec, -1
  s_mov_b32 s37, s21
wp_f1_f:
  s_add_u32 m0, s25, 4096
  s_nop 0
  buffer_load_dwordx4 v18, s[60:63], s27 offen  lds
  s_add_u32 s27, s27, 16384
  s_add_u32 m0, s25, 5120
  s_nop 0
  buffer_load_dwordx4 v19, s[60:63], s27 offen  lds
  s_add_u32 s27, s27, 16384
  s_add_u32 m0, s25, 6144
  s_nop 0
  buffer_load_dwordx4 v18, s[60:63], s27 offen  lds
  s_add_u32 s27, s27, 16384
  s_add_u32 m0, s25, 7168
  s_nop 0
  buffer_load_dwordx4 v19, s[60:63], s27 offen  lds
  s_add_u32 s27, s27, 16384
  s_add_u32 m0, s25, 8192
  s_nop 0
  buffer_load_dwordx4 v20, s[60:63], s27 offen  lds
  s_add_u32 s27, s27, 16384
  s_add_u32 m0, s25, 9216
  s_nop 0
  buffer_load_dwordx4 v21, s[60:63], s27 offen  lds
  s_add_u32 s27, s27, 16384
  s_add_u32 m0, s25, 10240
  s_nop 0
  buffer_load_dwordx4 v20, s[60:63], s27 offen  lds
  s_add_u32 s27, s27, 16384
  s_add_u32 m0, s25, 11264
  s_nop 0
  buffer_load_dwordx4 v21, s[60:63], s27 offen  lds
  s_add_u32 s27, s27, 16384
  s_add_u32 m0, s25, 12288
  s_nop 0
  buffer_load_dwordx4 v22, s[60:63], s27 offen  lds
  s_add_u32 s27, s27, 16384
  s_add_u32 m0, s25, 13312
  s_nop 0
  buffer_load_dwordx4 v23, s[60:63], s27 offen  lds
  s_add_u32 s27, s27, 16384
  s_add_u32 m0, s25, 14336
  s_nop 0
  buffer_load_dwordx4 v22, s[60:63], s27 offen  lds
  s_add_u32 s27, s27, 16384
  s_add_u32 m0, s25, 15360
  s_nop 0
  buffer_load_dwordx4 v23, s[60:63], s27 offen  lds
  s_add_u32 s27, s27, 16384
  s_add_u32 s27, s28, 4
  s_min_u32 s27, s27, 13
  s_lshl_b32 s27, s27, 18
  s_add_u32 s27, s27, s26
  s_add_u32 m0, s25, 16384
  s_nop 0
  buffer_load_dwordx4 v16, s[60:63], s27 offen  lds
  s_add_u32 s27, s27, 16384
  s_add_u32 m0, s25, 17408
  s_nop 0
  buffer_load_dwordx4 v17, s[60:63], s27 offen  lds
  s_add_u32 s27, s27, 16384
  s_add_u32 m0, s25, 18432
  s_nop 0
  buffer_load_dwordx4 v16, s[60:63], s27 offen  lds
  s_add_u32 s27, s27, 16384
  s_add_u32 m0, s25, 19456
  s_nop 0
  buffer_load_dwordx4 v17, s[60:63], s27 offen  lds
  s_add_u32 s27, s27, 16384
  s_add_u32 m0, s25, 20480
  s_nop 0
  buffer_load_dwordx4 v18, s[60:63], s27 offen  lds
  s_add_u32 s27, s27, 16384
  s_add_u32 m0, s25, 21504
  s_nop 0
  buffer_load_dwordx4 v19, s[60:63], s27 offen  lds
  s_add_u32 s27, s27, 16384
  s_add_u32 m0, s25, 22528
  s_nop 0
  buffer_load_dwordx4 v18, s[60:63], s27 offen  lds
  s_add_u32 s27, s27, 16384
  s_add_u32 m0, s25, 23552
  s_nop 0
  buffer_load_dwordx4 v19, s[60:63], s27 offen  lds
  s_add_u32 s27, s27, 16384
  s_add_u32 m0, s25, 24576
  s_nop 0
  buffer_load_dwordx4 v20, s[60:63], s27 offen  lds
  s_add_u32 s27, s27, 16384
  s_add_u32 m0, s25, 25600
  s_nop 0
  buffer_load_dwordx4 v21, s[60:63], s27 offen  lds
  s_add_u32 s27, s27, 16384
  s_add_u32 m0, s25, 26624
  s_nop 0
  buffer_load_dwordx4 v20, s[60:63], s27 offen  lds
  s_add_u32 s27, s27, 16384
  s_add_u32 m0, s25, 27648
  s_nop 0
  buffer_load_dwordx4 v21, s[60:63], s27 offen  lds
  s_add_u32 s27, s27, 16384
  s_add_u32 m0, s25, 28672
  s_nop 0
  buffer_load_dwordx4 v22, s[60:63], s27 offen  lds
  s_add_u32 s27, s27, 16384
  s_add_u32 m0, s25, 29696
  s_nop 0
  buffer_load_dwordx4 v23, s[60:63], s27 offen  lds
  s_add_u32 s27, s27, 16384
  s_add_u32 m0, s25, 30720
  s_nop 0
  buffer_load_dwordx4 v22, s[60:63], s27 offen  lds
  s_add_u32 s27, s27, 16384
  s_add_u32 m0, s25, 31744
  s_nop 0
  buffer_load_dwordx4 v23, s[60:63], s27 offen  lds
  s_add_u32 s27, s27, 16384
  s_branch wp_A
wp_B2:
  s_waitcnt vmcnt(0)
  s_barrier
  s_cmp_lg_u32 s16, 0
  s_cbranch_scc1 wp_f2_f
  v_readfirstlane_b32 s20, v254
  s_cmp_eq_u32 s20, 1
  s_cbranch_scc1 wp_f2_w_ok
  s_mov_b32 s30, 0
wp_f2_w:
  buffer_load_dword v254, off, s[12:15], 0 offset:128 sc1
  s_waitcnt vmcnt(0)
  v_cmp_ne_u32 vcc, 1, v254
  s_cbranch_vccz wp_f2_w_ok
  s_sleep 8
  s_add_u32 s30, s30, 1
  s_cmp_lt_u32 s30, 16
  s_cbranch_scc1 wp_f2_w
  s_branch wp_f2_f
wp_f2_w_ok:
  s_lshl_b32 s20, s17, 7
  s_add_u32 s20, s20, 88519168
  s_lshl_b32 s21, 1, s19
  v_mov_b32 v248, s21
  s_mov_b64 exec, 1
  buffer_atomic_or v248, v252, s[8:11], s20 offen sc0
  s_mov_b64 exec, -1
  s_mov_b32 s37, s21
wp_f2_f:
  s_waitcnt vmcnt(0)
  v_readfirstlane_b32 s20, v248
  s_xor_b32 s20, s20, s37
  s_cmp_lg_u32 s20, 0x3fff
  s_cselect_b32 s20, 0, s37
  s_mov_b32 s37, 0
  s_cmp_eq_u32 s20, 0
  s_cbranch_scc1 wp_g2
  s_lshl_b32 s21, 1, s17
  v_mov_b32 v248, s21
  s_mov_b32 s20, 88523264
  s_mov_b64 exec, 1
  buffer_atomic_or v248, v252, s[8:11], s20 offen
  s_mov_b64 exec, -1
wp_g2:
  s_cmp_lg_u32 s97, 0
  s_cbranch_scc1 wp_rep
  s_branch wp_ini2
wp_A0:
  s_mov_b32 s60, s40
  s_and_b32 s61, s41, 0xffff
  s_mov_b32 s62, 3670016
  s_mov_b32 s63, 0x20000
  s_mov_b32 s56, s42
  s_and_b32 s57, s43, 0xffff
  s_mov_b32 s58, 3670016
  s_mov_b32 s59, 0x20000
  s_lshl_b32 s27, s18, 2
  s_add_u32 s27, s27, s16
  s_lshl_b32 s27, s27, 17
  s_add_u32 s27, s27, s26
  s_lshl_b32 s30, s16, 13
  s_add_u32 m0, s30, 0
  s_nop 0
  buffer_load_dwordx4 v16, s[56:59], s27 offen  lds
  s_add_u32 s27, s27, 16384
  s_add_u32 m0, s30, 1024
  s_nop 0
  buffer_load_dwordx4 v17, s[56:59], s27 offen  lds
  s_add_u32 s27, s27, 16384
  s_add_u32 m0, s30, 2048
  s_nop 0
  buffer_load_dwordx4 v18, s[56:59], s27 offen  lds
  s_add_u32 s27, s27, 16384
  s_add_u32 m0, s30, 3072
  s_nop 0
  buffer_load_dwordx4 v19, s[56:59], s27 offen  lds
  s_add_u32 s27, s27, 16384
  s_add_u32 m0, s30, 4096
  s_nop 0
  buffer_load_dwordx4 v20, s[56:59], s27 offen  lds
  s_add_u32 s27, s27, 16384
  s_add_u32 m0, s30, 5120
  s_nop 0
  buffer_load_dwordx4 v21, s[56:59], s27 offen  lds
  s_add_u32 s27, s27, 16384
  s_add_u32 m0, s30, 6144
  s_nop 0
  buffer_load_dwordx4 v22, s[56:59], s27 offen  lds
  s_add_u32 s27, s27, 16384
  s_add_u32 m0, s30, 7168
  s_nop 0
  buffer_load_dwordx4 v23, s[56:59], s27 offen  lds
  s_add_u32 s27, s27, 16384
  s_add_u32 s27, s28, 0
  s_min_u32 s27, s27, 13
  s_lshl_b32 s27, s27, 18
  s_add_u32 s27, s27, s26
  s_add_u32 m0, s25, 0
  s_nop 0
  buffer_load_dwordx4 v16, s[60:63], s27 offen  lds
  s_add_u32 s27, s27, 16384
  s_add_u32 m0, s25, 1024
  s_nop 0
  buffer_load_dwordx4 v17, s[60:63], s27 offen  lds
  s_add_u32 s27, s27, 16384
  s_add_u32 m0, s25, 2048
  s_nop 0
  buffer_load_dwordx4 v16, s[60:63], s27 offen  lds
  s_add_u32 s27, s27, 16384
  s_add_u32 m0, s25, 3072
  s_nop 0
  buffer_load_dwordx4 v17, s[60:63], s27 offen  lds
  s_add_u32 s27, s27, 16384
  s_add_u32 m0, s25, 4096
  s_nop 0
  buffer_load_dwordx4 v18, s[60:63], s27 offen  lds
  s_add_u32 s27, s27, 16384
  s_add_u32 m0, s25, 5120
  s_nop 0
  buffer_load_dwordx4 v19, s[60:63], s27 offen  lds
  s_add_u32 s27, s27, 16384
  s_add_u32 m0, s25, 6144
  s_nop 0
  buffer_load_dwordx4 v18, s[60:63], s27 offen  lds
  s_add_u32 s27, s27, 16384
  s_add_u32 m0, s25, 7168
  s_nop 0
  buffer_load_dwordx4 v19, s[60:63], s27 offen  lds
  s_add_u32 s27, s27, 16384
  s_add_u32 m0, s25, 8192
  s_nop 0
  buffer_load_dwordx4 v20, s[60:63], s27 offen  lds
  s_add_u32 s27, s27, 16384
  s_add_u32 m0, s25, 9216
  s_nop 0
  buffer_load_dwordx4 v21, s[60:63], s27 offen  lds
  s_add_u32 s27, s27, 16384
  s_add_u32 m0, s25, 10240
  s_nop 0
  buffer_load_dwordx4 v20, s[60:63], s27 offen  lds
  s_add_u32 s27, s27, 16384
  s_add_u32 m0, s25, 11264
  s_nop 0
  buffer_load_dwordx4 v21, s[60:63], s27 offen  lds
  s_add_u32 s27, s27, 16384
  s_add_u32 m0, s25, 12288
  s_nop 0
  buffer_load_dwordx4 v22, s[60:63], s27 offen  lds
  s_add_u32 s27, s27, 16384
  s_add_u32 m0, s25, 13312
  s_nop 0
  buffer_load_dwordx4 v23, s[60:63], s27 offen  lds
  s_add_u32 s27, s27, 16384
  s_add_u32 m0, s25, 14336
  s_nop 0
  buffer_load_dwordx4 v22, s[60:63], s27 offen  lds
  s_add_u32 s27, s27, 16384
  s_add_u32 m0, s25, 15360
  s_nop 0
  buffer_load_dwordx4 v23, s[60:63], s27 offen  lds
  s_add_u32 s27, s27, 16384
  s_add_u32 s27, s28, 4
  s_min_u32 s27, s27, 13
  s_lshl_b32 s27, s27, 18
  s_add_u32 s27, s27, s26
  s_add_u32 m0, s25, 16384
  s_nop 0
  buffer_load_dwordx4 v16, s[60:63], s27 offen  lds
  s_add_u32 s27, s27, 16384
  s_add_u32 m0, s25, 17408
  s_nop 0
  buffer_load_dwordx4 v17, s[60:63], s27 offen  lds
  s_add_u32 s27, s27, 16384
  s_add_u32 m0, s25, 18432
  s_nop 0
  buffer_load_dwordx4 v16, s[60:63], s27 offen  lds
  s_add_u32 s27, s27, 16384
  s_add_u32 m0, s25, 19456
  s_nop 0
  buffer_load_dwordx4 v17, s[60:63], s27 offen  lds
  s_add_u32 s27, s27, 16384
  s_add_u32 m0, s25, 20480
  s_nop 0
  buffer_load_dwordx4 v18, s[60:63], s27 offen  lds
  s_add_u32 s27, s27, 16384
  s_add_u32 m0, s25, 21504
  s_nop 0
  buffer_load_dwordx4 v19, s[60:63], s27 offen  lds
  s_add_u32 s27, s27, 16384
  s_add_u32 m0, s25, 22528
  s_nop 0
  buffer_load_dwordx4 v18, s[60:63], s27 offen  lds
  s_add_u32 s27, s27, 16384
  s_add_u32 m0, s25, 23552
  s_nop 0
  buffer_load_dwordx4 v19, s[60:63], s27 offen  lds
  s_add_u32 s27, s27, 16384
  s_add_u32 m0, s25, 24576
  s_nop 0
  buffer_load_dwordx4 v20, s[60:63], s27 offen  lds
  s_add_u32 s27, s27, 16384
  s_add_u32 m0, s25, 25600
  s_nop 0
  buffer_load_dwordx4 v21, s[60:63], s27 offen  lds
  s_add_u32 s27, s27, 16384
  s_add_u32 m0, s25, 26624
  s_nop 0
  buffer_load_dwordx4 v20, s[60:63], s27 offen  lds
  s_add_u32 s27, s27, 16384
  s_add_u32 m0, s25, 27648
  s_nop 0
  buffer_load_dwordx4 v21, s[60:63], s27 offen  lds
  s_add_u32 s27, s27, 16384
  s_add_u32 m0, s25, 28672
  s_nop 0
  buffer_load_dwordx4 v22, s[60:63], s27 offen  lds
  s_add_u32 s27, s27, 16384
  s_add_u32 m0, s25, 29696
  s_nop 0
  buffer_load_dwordx4 v23, s[60:63], s27 offen  lds
  s_add_u32 s27, s27, 16384
  s_add_u32 m0, s25, 30720
  s_nop 0
  buffer_load_dwordx4 v22, s[60:63], s27 offen  lds
  s_add_u32 s27, s27, 16384
  s_add_u32 m0, s25, 31744
  s_nop 0
  buffer_load_dwordx4 v23, s[60:63], s27 offen  lds
  s_add_u32 s27, s27, 16384
wp_A:
  v_lshrrev_b32 v7, 2, v4
  v_lshlrev_b32 v7, 3, v7
  v_and_b32 v8, 3, v4
  v_add_u32 v7, v7, v8
  v_or_b32 v10, 0, v3
  v_xor_b32 v10, v10, v4
  v_lshlrev_b32 v10, 4, v10
  v_lshl_add_u32 v10, v7, 9, v10
  v_add_u32 v32, s25, v10
  v_or_b32 v10, 4, v3
  v_xor_b32 v10, v10, v4
  v_lshlrev_b32 v10, 4, v10
  v_lshl_add_u32 v10, v7, 9, v10
  v_add_u32 v33, s25, v10
  v_or_b32 v10, 8, v3
  v_xor_b32 v10, v10, v4
  v_lshlrev_b32 v10, 4, v10
  v_lshl_add_u32 v10, v7, 9, v10
  v_add_u32 v34, s25, v10
  v_or_b32 v10, 12, v3
  v_xor_b32 v10, v10, v4
  v_lshlrev_b32 v10, 4, v10
  v_lshl_add_u32 v10, v7, 9, v10
  v_add_u32 v35, s25, v10
  v_lshrrev_b32 v7, 2, v4
  v_lshlrev_b32 v7, 4, v7
  v_and_b32 v8, 2, v4
  v_lshl_add_u32 v7, v8, 1, v7
  v_and_b32 v8, 1, v4
  v_add_u32 v7, v7, v8
  v_add_u32 v11, 0, v7
  v_and_b32 v9, 15, v11
  v_or_b32 v10, 0, v3
  v_xor_b32 v10, v10, v9
  v_lshlrev_b32 v10, 4, v10
  v_lshl_add_u32 v40, v11, 9, v10
  v_or_b32 v10, 4, v3
  v_xor_b32 v10, v10, v9
  v_lshlrev_b32 v10, 4, v10
  v_lshl_add_u32 v41, v11, 9, v10
  v_or_b32 v10, 8, v3
  v_xor_b32 v10, v10, v9
  v_lshlrev_b32 v10, 4, v10
  v_lshl_add_u32 v42, v11, 9, v10
  v_or_b32 v10, 12, v3
  v_xor_b32 v10, v10, v9
  v_lshlrev_b32 v10, 4, v10
  v_lshl_add_u32 v43, v11, 9, v10
  v_add_u32 v11, 2, v7
  v_and_b32 v9, 15, v11
  v_or_b32 v10, 0, v3
  v_xor_b32 v10, v10, v9
  v_lshlrev_b32 v10, 4, v10
  v_lshl_add_u32 v44, v11, 9, v10
  v_or_b32 v10, 4, v3
  v_xor_b32 v10, v10, v9
  v_lshlrev_b32 v10, 4, v10
  v_lshl_add_u32 v45, v11, 9, v10
  v_or_b32 v10, 8, v3
  v_xor_b32 v10, v10, v9
  v_lshlrev_b32 v10, 4, v10
  v_lshl_add_u32 v46, v11, 9, v10
  v_or_b32 v10, 12, v3
  v_xor_b32 v10, v10, v9
  v_lshlrev_b32 v10, 4, v10
  v_lshl_add_u32 v47, v11, 9, v10
  v_add_u32 v11, 8, v7
  v_and_b32 v9, 15, v11
  v_or_b32 v10, 0, v3
  v_xor_b32 v10, v10, v9
  v_lshlrev_b32 v10, 4, v10
  v_lshl_add_u32 v48, v11, 9, v10
  v_or_b32 v10, 4, v3
  v_xor_b32 v10, v10, v9
  v_lshlrev_b32 v10, 4, v10
  v_lshl_add_u32 v49, v11, 9, v10
  v_or_b32 v10, 8, v3
  v_xor_b32 v10, v10, v9
  v_lshlrev_b32 v10, 4, v10
  v_lshl_add_u32 v50, v11, 9, v10
  v_or_b32 v10, 12, v3
  v_xor_b32 v10, v10, v9
  v_lshlrev_b32 v10, 4, v10
  v_lshl_add_u32 v51, v11, 9, v10
  v_add_u32 v11, 10, v7
  v_and_b32 v9, 15, v11
  v_or_b32 v10, 0, v3
  v_xor_b32 v10, v10, v9
  v_lshlrev_b32 v10, 4, v10
  v_lshl_add_u32 v52, v11, 9, v10
  v_or_b32 v10, 4, v3
  v_xor_b32 v10, v10, v9
  v_lshlrev_b32 v10, 4, v10
  v_lshl_add_u32 v53, v11, 9, v10
  v_or_b32 v10, 8, v3
  v_xor_b32 v10, v10, v9
  v_lshlrev_b32 v10, 4, v10
  v_lshl_add_u32 v54, v11, 9, v10
  v_or_b32 v10, 12, v3
  v_xor_b32 v10, v10, v9
  v_lshlrev_b32 v10, 4, v10
  v_lshl_add_u32 v55, v11, 9, v10
  s_mul_i32 s30, s17, 401408
  s_mul_i32 s31, s18, 57344
  s_add_u32 s30, s30, s31
  s_add_u32 s30, s30, 0
  v_add_u32 v12, s30, v2
  s_add_u32 s30, s30, 14336
  v_add_u32 v13, s30, v2
  s_add_u32 s30, s30, 14336
  v_add_u32 v14, s30, v2
  s_add_u32 s30, s30, 14336
  v_add_u32 v15, s30, v2
  s_add_u32 s30, s30, 14336
  v_mov_b32 v36, 1035512379
  s_lshl_b32 s29, s28, 10
  s_add_u32 s31, s29, 4096
  s_cmp_lt_u32 s28, 10
  s_cselect_b32 s31, s31, 0x40000000
  s_waitcnt vmcnt(0)
  s_barrier
  ds_read_b128 a[0:3], v40 offset:0
  ds_read_b128 a[32:35], v44 offset:0
  ds_read_b128 a[64:67], v48 offset:0
  ds_read_b128 a[96:99], v52 offset:0
  ds_read_b128 a[128:131], v32 offset:0
  ds_read_b128 a[160:163], v32 offset:2048
  ds_read_b128 a[192:195], v32 offset:16384
  ds_read_b128 a[224:227], v32 offset:18432
  v_readfirstlane_b32 s20, v248
  s_xor_b32 s20, s20, s37
  s_cmp_lg_u32 s20, 0x3fff
  s_cselect_b32 s20, 0, s37
  s_mov_b32 s37, 0
  s_cmp_eq_u32 s20, 0
  s_cbranch_scc1 wp_g1
  s_lshl_b32 s21, 1, s17
  v_mov_b32 v248, s21
  s_mov_b32 s20, 88523264
  s_mov_b64 exec, 1
  buffer_atomic_or v248, v252, s[8:11], s20 offen
  s_mov_b64 exec, -1
wp_g1:
  s_waitcnt lgkmcnt(0)
  v_mfma_f32_16x16x32_bf16 v[64:67], a[128:131], a[0:3], 0
  ds_read_b128 a[4:7], v41 offset:0
  ds_read_b128 a[36:39], v45 offset:0
  v_mfma_f32_16x16x32_bf16 v[68:71], a[160:163], a[0:3], 0
  ds_read_b128 a[68:71], v49 offset:0
  ds_read_b128 a[100:103], v53 offset:0
  v_mfma_f32_16x16x32_bf16 v[72:75], a[128:131], a[32:35], 0
  ds_read_b128 a[132:135], v33 offset:0
  ds_read_b128 a[164:167], v33 offset:2048
  v_mfma_f32_16x16x32_bf16 v[76:79], a[160:163], a[32:35], 0
  ds_read_b128 a[196:199], v33 offset:16384
  ds_read_b128 a[228:231], v33 offset:18432
  v_mfma_f32_16x16x32_bf16 v[80:83], a[128:131], a[64:67], 0
  v_mfma_f32_16x16x32_bf16 v[84:87], a[160:163], a[64:67], 0
  v_mfma_f32_16x16x32_bf16 v[88:91], a[128:131], a[96:99], 0
  v_mfma_f32_16x16x32_bf16 v[92:95], a[160:163], a[96:99], 0
  v_mfma_f32_16x16x32_bf16 v[96:99], a[192:195], a[0:3], 0
  v_mfma_f32_16x16x32_bf16 v[100:103], a[224:227], a[0:3], 0
  v_mfma_f32_16x16x32_bf16 v[104:107], a[192:195], a[32:35], 0
  v_mfma_f32_16x16x32_bf16 v[108:111], a[224:227], a[32:35], 0
  v_mfma_f32_16x16x32_bf16 v[112:115], a[192:195], a[64:67], 0
  v_mfma_f32_16x16x32_bf16 v[116:119], a[224:227], a[64:67], 0
  v_mfma_f32_16x16x32_bf16 v[120:123], a[192:195], a[96:99], 0
  v_mfma_f32_16x16x32_bf16 v[124:127], a[224:227], a[96:99], 0
  s_waitcnt lgkmcnt(0)
  v_mfma_f32_16x16x32_bf16 v[64:67], a[132:135], a[4:7], v[64:67]
  ds_read_b128 a[8:11], v42 offset:0
  ds_read_b128 a[40:43], v46 offset:0
  v_mfma_f32_16x16x32_bf16 v[68:71], a[164:167], a[4:7], v[68:71]
  ds_read_b128 a[72:75], v50 offset:0
  ds_read_b128 a[104:107], v54 offset:0
  v_mfma_f32_16x16x32_bf16 v[72:75], a[132:135], a[36:39], v[72:75]
  ds_read_b128 a[136:139], v34 offset:0
  ds_read_b128 a[168:171], v34 offset:2048
  v_mfma_f32_16x16x32_bf16 v[76:79], a[164:167], a[36:39], v[76:79]
  ds_read_b128 a[200:203], v34 offset:16384
  ds_read_b128 a[232:235], v34 offset:18432
  v_mfma_f32_16x16x32_bf16 v[80:83], a[132:135], a[68:71], v[80:83]
  v_mfma_f32_16x16x32_bf16 v[84:87], a[164:167], a[68:71], v[84:87]
  v_mfma_f32_16x16x32_bf16 v[88:91], a[132:135], a[100:103], v[88:91]
  v_mfma_f32_16x16x32_bf16 v[92:95], a[164:167], a[100:103], v[92:95]
  v_mfma_f32_16x16x32_bf16 v[96:99], a[196:199], a[4:7], v[96:99]
  v_mfma_f32_16x16x32_bf16 v[100:103], a[228:231], a[4:7], v[100:103]
  v_mfma_f32_16x16x32_bf16 v[104:107], a[196:199], a[36:39], v[104:107]
  v_mfma_f32_16x16x32_bf16 v[108:111], a[228:231], a[36:39], v[108:111]
  v_mfma_f32_16x16x32_bf16 v[112:115], a[196:199], a[68:71], v[112:115]
  v_mfma_f32_16x16x32_bf16 v[116:119], a[228:231], a[68:71], v[116:119]
  v_mfma_f32_16x16x32_bf16 v[120:123], a[196:199], a[100:103], v[120:123]
  v_mfma_f32_16x16x32_bf16 v[124:127], a[228:231], a[100:103], v[124:127]
  s_waitcnt lgkmcnt(0)
  v_mfma_f32_16x16x32_bf16 v[64:67], a[136:139], a[8:11], v[64:67]
  ds_read_b128 a[12:15], v43 offset:0
  ds_read_b128 a[44:47], v47 offset:0
  v_mfma_f32_16x16x32_bf16 v[68:71], a[168:171], a[8:11], v[68:71]
  ds_read_b128 a[76:79], v51 offset:0
  ds_read_b128 a[108:111], v55 offset:0
  v_mfma_f32_16x16x32_bf16 v[72:75], a[136:139], a[40:43], v[72:75]
  ds_read_b128 a[140:143], v35 offset:0
  ds_read_b128 a[172:175], v35 offset:2048
  v_mfma_f32_16x16x32_bf16 v[76:79], a[168:171], a[40:43], v[76:79]
  ds_read_b128 a[204:207], v35 offset:16384
  ds_read_b128 a[236:239], v35 offset:18432
  v_mfma_f32_16x16x32_bf16 v[80:83], a[136:139], a[72:75], v[80:83]
  v_mfma_f32_16x16x32_bf16 v[84:87], a[168:171], a[72:75], v[84:87]
  v_mfma_f32_16x16x32_bf16 v[88:91], a[136:139], a[104:107], v[88:91]
  v_mfma_f32_16x16x32_bf16 v[92:95], a[168:171], a[104:107], v[92:95]
  v_mfma_f32_16x16x32_bf16 v[96:99], a[200:203], a[8:11], v[96:99]
  v_mfma_f32_16x16x32_bf16 v[100:103], a[232:235], a[8:11], v[100:103]
  v_mfma_f32_16x16x32_bf16 v[104:107], a[200:203], a[40:43], v[104:107]
  v_mfma_f32_16x16x32_bf16 v[108:111], a[232:235], a[40:43], v[108:111]
  v_mfma_f32_16x16x32_bf16 v[112:115], a[200:203], a[72:75], v[112:115]
  v_mfma_f32_16x16x32_bf16 v[116:119], a[232:235], a[72:75], v[116:119]
  v_mfma_f32_16x16x32_bf16 v[120:123], a[200:203], a[104:107], v[120:123]
  v_mfma_f32_16x16x32_bf16 v[124:127], a[232:235], a[104:107], v[124:127]
  s_waitcnt lgkmcnt(0)
  v_mfma_f32_16x16x32_bf16 v[64:67], a[140:143], a[12:15], v[64:67]
  ds_read_b128 a[16:19], v40 offset:256
  ds_read_b128 a[48:51], v44 offset:256
  v_mfma_f32_16x16x32_bf16 v[68:71], a[172:175], a[12:15], v[68:71]
  ds_read_b128 a[80:83], v48 offset:256
  ds_read_b128 a[112:115], v52 offset:256
  v_mfma_f32_16x16x32_bf16 v[72:75], a[140:143], a[44:47], v[72:75]
  ds_read_b128 a[144:147], v32 offset:256
  ds_read_b128 a[176:179], v32 offset:2304
  v_mfma_f32_16x16x32_bf16 v[76:79], a[172:175], a[44:47], v[76:79]
  ds_read_b128 a[208:211], v32 offset:16640
  ds_read_b128 a[240:243], v32 offset:18688
  v_mfma_f32_16x16x32_bf16 v[80:83], a[140:143], a[76:79], v[80:83]
  v_mfma_f32_16x16x32_bf16 v[84:87], a[172:175], a[76:79], v[84:87]
  v_mfma_f32_16x16x32_bf16 v[88:91], a[140:143], a[108:111], v[88:91]
  v_mfma_f32_16x16x32_bf16 v[92:95], a[172:175], a[108:111], v[92:95]
  v_mfma_f32_16x16x32_bf16 v[96:99], a[204:207], a[12:15], v[96:99]
  v_mfma_f32_16x16x32_bf16 v[100:103], a[236:239], a[12:15], v[100:103]
  v_mfma_f32_16x16x32_bf16 v[104:107], a[204:207], a[44:47], v[104:107]
  v_mfma_f32_16x16x32_bf16 v[108:111], a[236:239], a[44:47], v[108:111]
  v_mfma_f32_16x16x32_bf16 v[112:115], a[204:207], a[76:79], v[112:115]
  v_mfma_f32_16x16x32_bf16 v[116:119], a[236:239], a[76:79], v[116:119]
  v_mfma_f32_16x16x32_bf16 v[120:123], a[204:207], a[108:111], v[120:123]
  v_mfma_f32_16x16x32_bf16 v[124:127], a[236:239], a[108:111], v[124:127]
  s_waitcnt lgkmcnt(0)
  v_mfma_f32_16x16x32_bf16 v[64:67], a[144:147], a[16:19], v[64:67]
  ds_read_b128 a[20:23], v41 offset:256
  ds_read_b128 a[52:55], v45 offset:256
  v_mfma_f32_16x16x32_bf16 v[68:71], a[176:179], a[16:19], v[68:71]
  ds_read_b128 a[84:87], v49 offset:256
  ds_read_b128 a[116:119], v53 offset:256
  v_mfma_f32_16x16x32_bf16 v[72:75], a[144:147], a[48:51], v[72:75]
  ds_read_b128 a[148:151], v33 offset:256
  ds_read_b128 a[180:183], v33 offset:2304
  v_mfma_f32_16x16x32_bf16 v[76:79], a[176:179], a[48:51], v[76:79]
  ds_read_b128 a[212:215], v33 offset:16640
  ds_read_b128 a[244:247], v33 offset:18688
  v_mfma_f32_16x16x32_bf16 v[80:83], a[144:147], a[80:83], v[80:83]
  v_mfma_f32_16x16x32_bf16 v[84:87], a[176:179], a[80:83], v[84:87]
  v_mfma_f32_16x16x32_bf16 v[88:91], a[144:147], a[112:115], v[88:91]
  v_mfma_f32_16x16x32_bf16 v[92:95], a[176:179], a[112:115], v[92:95]
  v_mfma_f32_16x16x32_bf16 v[96:99], a[208:211], a[16:19], v[96:99]
  v_mfma_f32_16x16x32_bf16 v[100:103], a[240:243], a[16:19], v[100:103]
  v_mfma_f32_16x16x32_bf16 v[104:107], a[208:211], a[48:51], v[104:107]
  v_mfma_f32_16x16x32_bf16 v[108:111], a[240:243], a[48:51], v[108:111]
  v_mfma_f32_16x16x32_bf16 v[112:115], a[208:211], a[80:83], v[112:115]
  v_mfma_f32_16x16x32_bf16 v[116:119], a[240:243], a[80:83], v[116:119]
  v_mfma_f32_16x16x32_bf16 v[120:123], a[208:211], a[112:115], v[120:123]
  v_mfma_f32_16x16x32_bf16 v[124:127], a[240:243], a[112:115], v[124:127]
  s_waitcnt lgkmcnt(0)
  v_mfma_f32_16x16x32_bf16 v[64:67], a[148:151], a[20:23], v[64:67]
  ds_read_b128 a[24:27], v42 offset:256
  ds_read_b128 a[56:59], v46 offset:256
  v_mfma_f32_16x16x32_bf16 v[68:71], a[180:183], a[20:23], v[68:71]
  ds_read_b128 a[88:91], v50 offset:256
  ds_read_b128 a[120:123], v54 offset:256
  v_mfma_f32_16x16x32_bf16 v[72:75], a[148:151], a[52:55], v[72:75]
  ds_read_b128 a[152:155], v34 offset:256
  ds_read_b128 a[184:187], v34 offset:2304
  v_mfma_f32_16x16x32_bf16 v[76:79], a[180:183], a[52:55], v[76:79]
  ds_read_b128 a[216:219], v34 offset:16640
  ds_read_b128 a[248:251], v34 offset:18688
  v_mfma_f32_16x16x32_bf16 v[80:83], a[148:151], a[84:87], v[80:83]
  v_mfma_f32_16x16x32_bf16 v[84:87], a[180:183], a[84:87], v[84:87]
  v_mfma_f32_16x16x32_bf16 v[88:91], a[148:151], a[116:119], v[88:91]
  v_mfma_f32_16x16x32_bf16 v[92:95], a[180:183], a[116:119], v[92:95]
  v_mfma_f32_16x16x32_bf16 v[96:99], a[212:215], a[20:23], v[96:99]
  v_mfma_f32_16x16x32_bf16 v[100:103], a[244:247], a[20:23], v[100:103]
  v_mfma_f32_16x16x32_bf16 v[104:107], a[212:215], a[52:55], v[104:107]
  v_mfma_f32_16x16x32_bf16 v[108:111], a[244:247], a[52:55], v[108:111]
  v_mfma_f32_16x16x32_bf16 v[112:115], a[212:215], a[84:87], v[112:115]
  v_mfma_f32_16x16x32_bf16 v[116:119], a[244:247], a[84:87], v[116:119]
  v_mfma_f32_16x16x32_bf16 v[120:123], a[212:215], a[116:119], v[120:123]
  v_mfma_f32_16x16x32_bf16 v[124:127], a[244:247], a[116:119], v[124:127]
  s_waitcnt lgkmcnt(0)
  v_mfma_f32_16x16x32_bf16 v[64:67], a[152:155], a[24:27], v[64:67]
  ds_read_b128 a[28:31], v43 offset:256
  ds_read_b128 a[60:63], v47 offset:256
  v_mfma_f32_16x16x32_bf16 v[68:71], a[184:187], a[24:27], v[68:71]
  ds_read_b128 a[92:95], v51 offset:256
  ds_read_b128 a[124:127], v55 offset:256
  v_mfma_f32_16x16x32_bf16 v[72:75], a[152:155], a[56:59], v[72:75]
  ds_read_b128 a[156:159], v35 offset:256
  ds_read_b128 a[188:191], v35 offset:2304
  v_mfma_f32_16x16x32_bf16 v[76:79], a[184:187], a[56:59], v[76:79]
  ds_read_b128 a[220:223], v35 offset:16640
  ds_read_b128 a[252:255], v35 offset:18688
  v_mfma_f32_16x16x32_bf16 v[80:83], a[152:155], a[88:91], v[80:83]
  v_mfma_f32_16x16x32_bf16 v[84:87], a[184:187], a[88:91], v[84:87]
  v_mfma_f32_16x16x32_bf16 v[88:91], a[152:155], a[120:123], v[88:91]
  v_mfma_f32_16x16x32_bf16 v[92:95], a[184:187], a[120:123], v[92:95]
  v_mfma_f32_16x16x32_bf16 v[96:99], a[216:219], a[24:27], v[96:99]
  v_mfma_f32_16x16x32_bf16 v[100:103], a[248:251], a[24:27], v[100:103]
  v_mfma_f32_16x16x32_bf16 v[104:107], a[216:219], a[56:59], v[104:107]
  v_mfma_f32_16x16x32_bf16 v[108:111], a[248:251], a[56:59], v[108:111]
  v_mfma_f32_16x16x32_bf16 v[112:115], a[216:219], a[88:91], v[112:115]
  v_mfma_f32_16x16x32_bf16 v[116:119], a[248:251], a[88:91], v[116:119]
  v_mfma_f32_16x16x32_bf16 v[120:123], a[216:219], a[120:123], v[120:123]
  v_mfma_f32_16x16x32_bf16 v[124:127], a[248:251], a[120:123], v[124:127]
  s_waitcnt lgkmcnt(0)
  s_barrier
  buffer_load_dwordx2 v[254:255], v252, s[12:15], 0 offen offset:128 sc1
  buffer_load_dword v253, v252, s[12:15], 0 offen sc1
  v_mfma_f32_16x16x32_bf16 v[64:67], a[156:159], a[28:31], v[64:67]
  v_mfma_f32_16x16x32_bf16 v[68:71], a[188:191], a[28:31], v[68:71]
  v_mfma_f32_16x16x32_bf16 v[72:75], a[156:159], a[60:63], v[72:75]
  v_mfma_f32_16x16x32_bf16 v[76:79], a[188:191], a[60:63], v[76:79]
  v_mfma_f32_16x16x32_bf16 v[80:83], a[156:159], a[92:95], v[80:83]
  v_mul_f32 v64, v36, v64
  v_mul_f32 v65, v36, v65
  v_mfma_f32_16x16x32_bf16 v[84:87], a[188:191], a[92:95], v[84:87]
  v_mul_f32 v66, v36, v66
  v_mul_f32 v67, v36, v67
  v_mfma_f32_16x16x32_bf16 v[88:91], a[156:159], a[124:127], v[88:91]
  v_mul_f32 v68, v36, v68
  v_mul_f32 v69, v36, v69
  v_mfma_f32_16x16x32_bf16 v[92:95], a[188:191], a[124:127], v[92:95]
  v_mul_f32 v70, v36, v70
  v_mul_f32 v71, v36, v71
  v_mfma_f32_16x16x32_bf16 v[96:99], a[220:223], a[28:31], v[96:99]
  v_cvt_pk_bf16_f32 v64, v64, v65
  v_cvt_pk_bf16_f32 v65, v66, v67
  v_mfma_f32_16x16x32_bf16 v[100:103], a[252:255], a[28:31], v[100:103]
  v_cvt_pk_bf16_f32 v66, v68, v69
  v_cvt_pk_bf16_f32 v67, v70, v71
  v_mfma_f32_16x16x32_bf16 v[104:107], a[220:223], a[60:63], v[104:107]
  buffer_store_dwordx4 v[64:67], v12, s[8:11], s29 offen sc1
  v_mul_f32 v72, v36, v72
  v_mfma_f32_16x16x32_bf16 v[108:111], a[252:255], a[60:63], v[108:111]
  v_mul_f32 v73, v36, v73
  v_mul_f32 v74, v36, v74
  v_mfma_f32_16x16x32_bf16 v[112:115], a[220:223], a[92:95], v[112:115]
  v_mul_f32 v75, v36, v75
  v_mul_f32 v76, v36, v76
  v_mfma_f32_16x16x32_bf16 v[116:119], a[252:255], a[92:95], v[116:119]
  v_mul_f32 v77, v36, v77
  v_mul_f32 v78, v36, v78
  v_mfma_f32_16x16x32_bf16 v[120:123], a[220:223], a[124:127], v[120:123]
  v_mul_f32 v79, v36, v79
  v_cvt_pk_bf16_f32 v72, v72, v73
  v_mfma_f32_16x16x32_bf16 v[124:127], a[252:255], a[124:127], v[124:127]
  v_cvt_pk_bf16_f32 v73, v74, v75
  v_cvt_pk_bf16_f32 v74, v76, v77
  v_cvt_pk_bf16_f32 v75, v78, v79
  buffer_store_dwordx4 v[72:75], v13, s[8:11], s29 offen sc1
  v_mul_f32 v80, v36, v80
  v_mul_f32 v81, v36, v81
  v_mul_f32 v82, v36, v82
  v_mul_f32 v83, v36, v83
  v_mul_f32 v84, v36, v84
  v_mul_f32 v85, v36, v85
  v_mul_f32 v86, v36, v86
  v_mul_f32 v87, v36, v87
  v_cvt_pk_bf16_f32 v80, v80, v81
  v_cvt_pk_bf16_f32 v81, v82, v83
  v_cvt_pk_bf16_f32 v82, v84, v85
  v_cvt_pk_bf16_f32 v83, v86, v87
  buffer_store_dwordx4 v[80:83], v14, s[8:11], s29 offen sc1
  v_mul_f32 v88, v36, v88
  v_mul_f32 v89, v36, v89
  v_mul_f32 v90, v36, v90
  v_mul_f32 v91, v36, v91
  v_mul_f32 v92, v36, v92
  v_mul_f32 v93, v36, v93
  v_mul_f32 v94, v36, v94
  v_mul_f32 v95, v36, v95
  v_cvt_pk_bf16_f32 v88, v88, v89
  v_cvt_pk_bf16_f32 v89, v90, v91
  v_cvt_pk_bf16_f32 v90, v92, v93
  v_cvt_pk_bf16_f32 v91, v94, v95
  buffer_store_dwordx4 v[88:91], v15, s[8:11], s29 offen sc1
  v_mul_f32 v96, v36, v96
  v_mul_f32 v97, v36, v97
  v_mul_f32 v98, v36, v98
  v_mul_f32 v99, v36, v99
  v_mul_f32 v100, v36, v100
  v_mul_f32 v101, v36, v101
  v_mul_f32 v102, v36, v102
  v_mul_f32 v103, v36, v103
  v_cvt_pk_bf16_f32 v96, v96, v97
  v_cvt_pk_bf16_f32 v97, v98, v99
  v_cvt_pk_bf16_f32 v98, v100, v101
  v_cvt_pk_bf16_f32 v99, v102, v103
  buffer_store_dwordx4 v[96:99], v12, s[8:11], s31 offen sc1
  v_mul_f32 v104, v36, v104
  v_mul_f32 v105, v36, v105
  v_mul_f32 v106, v36, v106
  v_mul_f32 v107, v36, v107
  v_mul_f32 v108, v36, v108
  v_mul_f32 v109, v36, v109
  v_mul_f32 v110, v36, v110
  v_mul_f32 v111, v36, v111
  v_cvt_pk_bf16_f32 v104, v104, v105
  v_cvt_pk_bf16_f32 v105, v106, v107
  v_cvt_pk_bf16_f32 v106, v108, v109
  v_cvt_pk_bf16_f32 v107, v110, v111
  buffer_store_dwordx4 v[104:107], v13, s[8:11], s31 offen sc1
  v_mul_f32 v112, v36, v112
  v_mul_f32 v113, v36, v113
  v_mul_f32 v114, v36, v114
  v_mul_f32 v115, v36, v115
  v_mul_f32 v116, v36, v116
  v_mul_f32 v117, v36, v117
  v_mul_f32 v118, v36, v118
  v_mul_f32 v119, v36, v119
  v_cvt_pk_bf16_f32 v112, v112, v113
  v_cvt_pk_bf16_f32 v113, v114, v115
  v_cvt_pk_bf16_f32 v114, v116, v117
  v_cvt_pk_bf16_f32 v115, v118, v119
  buffer_store_dwordx4 v[112:115], v14, s[8:11], s31 offen sc1
  v_mul_f32 v120, v36, v120
  v_mul_f32 v121, v36, v121
  v_mul_f32 v122, v36, v122
  v_mul_f32 v123, v36, v123
  v_mul_f32 v124, v36, v124
  v_mul_f32 v125, v36, v125
  v_mul_f32 v126, v36, v126
  v_mul_f32 v127, v36, v127
  v_cvt_pk_bf16_f32 v120, v120, v121
  v_cvt_pk_bf16_f32 v121, v122, v123
  v_cvt_pk_bf16_f32 v122, v124, v125
  v_cvt_pk_bf16_f32 v123, v126, v127
  buffer_store_dwordx4 v[120:123], v15, s[8:11], s31 offen sc1
  s_waitcnt vmcnt(0)
  s_barrier
  s_cmp_lg_u32 s16, 0
  s_cbranch_scc1 wp_f3_f
  v_readfirstlane_b32 s20, v254
  s_cmp_eq_u32 s20, 1
  s_cbranch_scc1 wp_f3_w_ok
  s_mov_b32 s30, 0
wp_f3_w:
  buffer_load_dword v254, off, s[12:15], 0 offset:128 sc1
  s_waitcnt vmcnt(0)
  v_cmp_ne_u32 vcc, 1, v254
  s_cbranch_vccz wp_f3_w_ok
  s_sleep 8
  s_add_u32 s30, s30, 1
  s_cmp_lt_u32 s30, 16
  s_cbranch_scc1 wp_f3_w
  s_branch wp_f3_f
wp_f3_w_ok:
  s_lshl_b32 s20, s17, 7
  s_add_u32 s20, s20, 88521216
  s_lshl_b32 s21, 1, s19
  v_mov_b32 v248, s21
  s_mov_b64 exec, 1
  buffer_atomic_or v248, v252, s[8:11], s20 offen sc0
  s_mov_b64 exec, -1
  s_mov_b32 s38, s21
wp_f3_f:
  s_cmp_lg_u32 s97, 0
  s_cbranch_scc1 wp_all
  v_readfirstlane_b32 s20, v255
  v_readfirstlane_b32 s21, v253
  s_and_b32 s21, s21, 0xffe0
  s_cselect_b32 s96, s20, 0
  s_cmp_eq_u32 s96, 0
  s_cbranch_scc1 wp_all
  v_mov_b32 v250, 1
  s_mov_b32 s20, 88518656
  s_mov_b64 exec, 1
  buffer_atomic_add v250, v252, s[8:11], s20 offen sc0
  s_mov_b64 exec, -1
wp_all:
  v_mov_b32 v252, 0x40000000
  v_cmp_eq_u32 vcc, 0, v0
  s_nop 1
  v_cndmask_b32 v252, v252, v0, vcc
  s_mov_b32 s34, 0
  s_cmp_lg_u32 s16, 0
  s_cbranch_scc1 wp_w2
  s_mov_b32 s24, 88523264
  buffer_load_dword v66, off, s[8:11], s24 sc1
  s_waitcnt vmcnt(0)
  v_readfirstlane_b32 s20, v248
  s_xor_b32 s20, s20, s38
  s_cmp_lg_u32 s20, 0x3fff
  s_cselect_b32 s20, 0, s38
  s_mov_b32 s38, 0
  s_cmp_eq_u32 s20, 0
  s_cbranch_scc1 wp_g3
  s_lshl_b32 s21, 65536, s17
  v_mov_b32 v248, s21
  s_mov_b32 s20, 88523264
  s_mov_b64 exec, 1
  buffer_atomic_or v248, v252, s[8:11], s20 offen
  s_mov_b64 exec, -1
wp_g3:
  s_cmp_lg_u32 s96, 0
  s_cbranch_scc1 wp_v2
  s_mov_b32 s30, 0
wp_v:
  buffer_load_dwordx2 v[64:65], off, s[12:15], 0 sc1
  buffer_load_dword v66, off, s[12:15], 0 offset:132 sc1
  s_waitcnt vmcnt(0)
  v_and_b32 v68, 0xffe0, v64
  v_min_u32 v68, v68, v66
  v_cmp_ne_u32 vcc, 1, v68
  s_cbranch_vccz wp_v_ok
  s_sleep 16
  s_add_u32 s30, s30, 1
  s_cmp_lt_u32 s30, 30
  s_cbranch_scc1 wp_v
  s_branch wp_w1
wp_v_ok:
  buffer_load_dword v66, off, s[8:11], s24 sc1
  s_waitcnt vmcnt(0)
wp_v2:
  v_mov_b32 v64, 32
  v_mov_b32 v65, 4
  v_or_b32 v66, s39, v66
  v_cmp_ne_u32 vcc, -1, v66
  s_cbranch_vccz wp_w2
  s_cmp_eq_u32 s97, 2
  s_cbranch_scc1 wp_w1
  s_mov_b32 s30, 0
wp_w:
  buffer_load_dword v66, off, s[8:11], s24 sc1
  s_waitcnt vmcnt(0)
  v_or_b32 v66, s39, v66
  v_cmp_ne_u32 vcc, -1, v66
  s_cbranch_vccz wp_w_ok
  s_sleep 8
  s_add_u32 s30, s30, 1
  s_cmp_lt_u32 s30, 60
  s_cbranch_scc1 wp_w
  s_branch wp_w1
wp_w_ok:
  s_branch wp_w2
wp_w1:
  v_readfirstlane_b32 s20, v64
  v_readfirstlane_b32 s21, v65
  s_and_b32 s20, s20, 0xffff
  s_cmp_lt_u32 s20, 32
  s_cselect_b32 s34, 2, 1
  s_cmp_lt_u32 s21, 4
  s_cselect_b32 s34, 4, s34
  s_add_u32 s32, s32, 1
  s_cmp_lt_u32 s32, 4000
  s_cselect_b32 s34, s34, 3
wp_w2:
  v_mov_b32 v6, 160032
  v_mov_b32 v7, s34
  s_barrier
  s_cmp_lg_u32 s16, 0
  s_cbranch_scc1 uni_6
  ds_write_b32 v6, v7
  s_waitcnt lgkmcnt(0)
uni_6:
  s_barrier
  ds_read_b32 v7, v6
  s_waitcnt lgkmcnt(0)
  v_readfirstlane_b32 s34, v7
  s_cmp_eq_u32 s34, 0
  s_cbranch_scc1 wp_done
  s_mov_b32 s97, 1
  s_cmp_eq_u32 s34, 1
  s_cbranch_scc1 wp_rep
  s_cmp_eq_u32 s34, 3
  s_cbranch_scc1 cA_abort
  s_cmp_eq_u32 s34, 4
  s_cbranch_scc1 wp_ini
  v_mov_b32 v4, 0x10001
  s_branch ch_take
wp_rep:
  s_load_dwordx8 s[40:47], s[0:1], 72
  s_load_dwordx4 s[48:51], s[0:1], 56
  s_waitcnt vmcnt(0) lgkmcnt(0)
  v_mov_b32 v4, 1
  v_mov_b32 v5, 20
  v_mov_b32 v6, 160000
  s_barrier
  s_cmp_lg_u32 s16, 0
  s_cbranch_scc1 wp_el1
  s_mov_b64 exec, 1
  buffer_atomic_add v4, v5, s[12:15], 0 offen sc0
  s_waitcnt vmcnt(0)
  ds_write_b32 v6, v4
  s_waitcnt lgkmcnt(0)
  s_mov_b64 exec, -1
wp_el1:
  s_barrier
  ds_read_b32 v4, v6
  s_waitcnt lgkmcnt(0)
  v_readfirstlane_b32 s33, v4
  v_and_b32 v1, 63, v0
  v_lshlrev_b32 v2, 4, v1
  v_lshrrev_b32 v3, 4, v1
  v_and_b32 v4, 15, v1
  v_lshrrev_b32 v5, 5, v1
  v_and_b32 v6, 31, v1
  v_xor_b32 v8, v6, v5
  v_lshlrev_b32 v8, 4, v8
  v_lshl_add_u32 v16, v5, 13, v8
  v_xor_b32 v17, 32, v16
  v_xor_b32 v18, 64, v16
  v_xor_b32 v19, 96, v16
  v_xor_b32 v20, 128, v16
  v_xor_b32 v21, 160, v16
  v_xor_b32 v22, 192, v16
  v_xor_b32 v23, 224, v16
  s_and_b32 s33, s33, 511
  s_and_b32 s20, s33, 255
  s_cmp_ge_u32 s20, 224
  s_cselect_b32 s97, 1, 2
  s_cbranch_scc1 wp_all
  s_mul_i32 s17, s20, 4682
  s_lshr_b32 s17, s17, 16
  s_mul_i32 s23, s17, 14
  s_sub_u32 s19, s20, s23
  s_cmp_lt_u32 s19, 7
  s_cselect_b32 s18, 0, 7
  s_cselect_b32 s28, 0, 8
  s_sub_u32 s18, s19, s18
  s_add_u32 s28, s28, s16
  s_lshl_b32 s25, s16, 15
  s_add_u32 s25, s25, 32768
  s_lshl_b32 s26, s17, 9
  s_lshl_b32 s20, s17, 7
  s_lshr_b32 s21, s33, 8
  s_lshl_b32 s21, s21, 11
  s_add_u32 s20, s20, s21
  s_add_u32 s20, s20, 88519168
  buffer_load_dword v5, off, s[8:11], s20 sc1
  s_waitcnt vmcnt(0)
  v_readfirstlane_b32 s34, v5
  v_mov_b32 v6, 160032
  s_nop 0
  v_mov_b32 v7, s34
  s_barrier
  s_cmp_lg_u32 s16, 0
  s_cbranch_scc1 uni_7
  ds_write_b32 v6, v7
  s_waitcnt lgkmcnt(0)
uni_7:
  s_barrier
  ds_read_b32 v7, v6
  s_waitcnt lgkmcnt(0)
  v_readfirstlane_b32 s34, v7
  s_bitcmp1_b32 s34, s19
  s_cbranch_scc1 wp_rep
  s_barrier
  s_cmp_lt_u32 s33, 256
  s_cbranch_scc1 wp_B
  s_branch wp_A0
wp_done:
  s_load_dwordx2 s[36:37], s[0:1], 112
  s_waitcnt lgkmcnt(0)
  s_mov_b32 s92, s36
  s_and_b32 s93, s37, 0xffff
  s_mov_b32 s94, 3670016
  s_mov_b32 s95, 0x20000
  s_mov_b32 s97, s39
  s_cmp_lg_u32 s96, 0
  s_cbranch_scc1 wk_next
  s_cmp_lg_u32 s16, 0
  s_cbranch_scc1 ask_8
  v_mov_b32 v250, 1
  v_mov_b32 v251, 88518656
  s_mov_b64 exec, 1
  buffer_atomic_add v250, v251, s[8:11], 0 offen sc0
  s_mov_b64 exec, -1
ask_8:
  s_branch wk_next
wk_loop:
  s_waitcnt vmcnt(0) lgkmcnt(0)
wk_ask:
  v_readfirstlane_b32 s22, v250
  s_cmp_ge_u32 s22, 1248
  s_cbranch_scc1 wk_next
  s_cmp_lg_u32 s16, 0
  s_cbranch_scc1 ask_9
  v_mov_b32 v250, 1
  v_mov_b32 v251, 88518656
  s_mov_b64 exec, 1
  buffer_atomic_add v250, v251, s[8:11], 0 offen sc0
  s_mov_b64 exec, -1
ask_9:
wk_next:
  v_mov_b32 v6, 160000
  s_waitcnt vmcnt(0)
  s_barrier
  s_cmp_lg_u32 s16, 0
  s_cbranch_scc1 wk_n1
  s_mov_b64 exec, 1
  ds_write_b32 v6, v250
  s_mov_b64 exec, -1
  s_waitcnt lgkmcnt(0)
wk_n1:
  s_barrier
  ds_read_b32 v4, v6
  s_waitcnt lgkmcnt(0)
  v_readfirstlane_b32 s3, v4
  s_cmp_ge_u32 s3, 1248
  s_cbranch_scc1 wk_done
  v_mov_b32 v250, 0
  v_mov_b32 v251, 88518656
  v_and_b32 v1, 63, v0
  v_lshlrev_b32 v2, 4, v1
  v_lshrrev_b32 v3, 4, v1
  v_and_b32 v4, 15, v1
  s_cmp_ge_u32 s3, 224
  s_cbranch_scc1 wk_n0
  s_mov_b32 s18, 0
  s_and_b32 s17, s3, 15
  s_add_u32 s17, s17, 16
  s_lshr_b32 s34, s3, 4
  s_add_u32 s35, s34, 1
  s_branch wk_gemm
wk_n0:
  s_cmp_eq_u32 s97, 0
  s_cbranch_scc1 wk_n2
  v_mov_b32 v250, s3
  s_mov_b32 s96, 1
  s_mov_b32 s97, 1
  s_mov_b32 s39, 0
  s_mov_b32 s37, 0
  s_mov_b32 s38, 0
  s_mov_b32 s32, 0
  s_branch wp_all
wk_n2:
  s_cmp_ge_u32 s3, 736
  s_cbranch_scc1 wk_tok
  s_cmp_ge_u32 s3, 624
  s_cbranch_scc1 wk_s4d
  s_cmp_ge_u32 s3, 432
  s_cbranch_scc1 wk_full
  s_cmp_ge_u32 s3, 400
  s_cbranch_scc1 wk_srv
  s_and_b32 s17, s3, 15
  s_add_u32 s17, s17, 16
  s_cmp_ge_u32 s3, 336
  s_cbranch_scc1 wk_half
  s_mov_b32 s18, 1
  s_sub_u32 s34, s3, 224
  s_lshr_b32 s34, s34, 4
  s_lshl_b32 s34, s34, 1
  s_add_u32 s35, s34, 2
  s_branch wk_gemm
wk_half:
  s_sub_u32 s20, s3, 336
  s_lshr_b32 s18, s20, 5
  s_add_u32 s18, s18, 2
  s_bitcmp1_b32 s20, 4
  s_cselect_b32 s34, 7, 0
  s_add_u32 s35, s34, 7
  s_branch wk_gemm
wk_full:
  s_sub_u32 s20, s3, 368
  s_and_b32 s17, s20, 15
  s_lshr_b32 s18, s20, 4
  s_cmp_lt_u32 s18, 8
  s_cselect_b32 s21, 16, 0
  s_add_u32 s17, s17, s21
  s_and_b32 s18, s18, 7
  s_mov_b32 s34, 0
  s_mov_b32 s35, 14
wk_gemm:
  s_lshl_b32 s20, s18, 4
  s_lshl_b32 s21, s16, 2
  s_add_u32 s20, s20, s21
  s_mul_i32 s21, s20, 14336
  s_add_u32 s21, s21, 72024064
  s_add_u32 s22, s21, 0
  buffer_load_dwordx4 a[0:3], v2, s[8:11], s22 offen offset:0 sc1
  buffer_load_dwordx4 a[4:7], v2, s[8:11], s22 offen offset:1024 sc1
  buffer_load_dwordx4 a[8:11], v2, s[8:11], s22 offen offset:2048 sc1
  buffer_load_dwordx4 a[12:15], v2, s[8:11], s22 offen offset:3072 sc1
  s_add_u32 s22, s21, 4096
  buffer_load_dwordx4 a[16:19], v2, s[8:11], s22 offen offset:0 sc1
  buffer_load_dwordx4 a[20:23], v2, s[8:11], s22 offen offset:1024 sc1
  buffer_load_dwordx4 a[24:27], v2, s[8:11], s22 offen offset:2048 sc1
  buffer_load_dwordx4 a[28:31], v2, s[8:11], s22 offen offset:3072 sc1
  s_add_u32 s22, s21, 8192
  buffer_load_dwordx4 a[32:35], v2, s[8:11], s22 offen offset:0 sc1
  buffer_load_dwordx4 a[36:39], v2, s[8:11], s22 offen offset:1024 sc1
  buffer_load_dwordx4 a[40:43], v2, s[8:11], s22 offen offset:2048 sc1
  buffer_load_dwordx4 a[44:47], v2, s[8:11], s22 offen offset:3072 sc1
  s_add_u32 s22, s21, 12288
  buffer_load_dwordx4 a[48:51], v2, s[8:11], s22 offen offset:0 sc1
  buffer_load_dwordx4 a[52:55], v2, s[8:11], s22 offen offset:1024 sc1
  buffer_load_dwordx4 a[56:59], v2, s[8:11], s22 offen offset:2048 sc1
  buffer_load_dwordx4 a[60:63], v2, s[8:11], s22 offen offset:3072 sc1
  s_add_u32 s22, s21, 16384
  buffer_load_dwordx4 a[64:67], v2, s[8:11], s22 offen offset:0 sc1
  buffer_load_dwordx4 a[68:71], v2, s[8:11], s22 offen offset:1024 sc1
  buffer_load_dwordx4 a[72:75], v2, s[8:11], s22 offen offset:2048 sc1
  buffer_load_dwordx4 a[76:79], v2, s[8:11], s22 offen offset:3072 sc1
  s_add_u32 s22, s21, 20480
  buffer_load_dwordx4 a[80:83], v2, s[8:11], s22 offen offset:0 sc1
  buffer_load_dwordx4 a[84:87], v2, s[8:11], s22 offen offset:1024 sc1
  buffer_load_dwordx4 a[88:91], v2, s[8:11], s22 offen offset:2048 sc1
  buffer_load_dwordx4 a[92:95], v2, s[8:11], s22 offen offset:3072 sc1
  s_add_u32 s22, s21, 24576
  buffer_load_dwordx4 a[96:99], v2, s[8:11], s22 offen offset:0 sc1
  buffer_load_dwordx4 a[100:103], v2, s[8:11], s22 offen offset:1024 sc1
  buffer_load_dwordx4 a[104:107], v2, s[8:11], s22 offen offset:2048 sc1
  buffer_load_dwordx4 a[108:111], v2, s[8:11], s22 offen offset:3072 sc1
  s_add_u32 s22, s21, 28672
  buffer_load_dwordx4 a[112:115], v2, s[8:11], s22 offen offset:0 sc1
  buffer_load_dwordx4 a[116:119], v2, s[8:11], s22 offen offset:1024 sc1
  buffer_load_dwordx4 a[120:123], v2, s[8:11], s22 offen offset:2048 sc1
  buffer_load_dwordx4 a[124:127], v2, s[8:11], s22 offen offset:3072 sc1
  s_add_u32 s22, s21, 32768
  buffer_load_dwordx4 a[128:131], v2, s[8:11], s22 offen offset:0 sc1
  buffer_load_dwordx4 a[132:135], v2, s[8:11], s22 offen offset:1024 sc1
  buffer_load_dwordx4 a[136:139], v2, s[8:11], s22 offen offset:2048 sc1
  buffer_load_dwordx4 a[140:143], v2, s[8:11], s22 offen offset:3072 sc1
  s_add_u32 s22, s21, 36864
  buffer_load_dwordx4 a[144:147], v2, s[8:11], s22 offen offset:0 sc1
  buffer_load_dwordx4 a[148:151], v2, s[8:11], s22 offen offset:1024 sc1
  buffer_load_dwordx4 a[152:155], v2, s[8:11], s22 offen offset:2048 sc1
  buffer_load_dwordx4 a[156:159], v2, s[8:11], s22 offen offset:3072 sc1
  s_add_u32 s22, s21, 40960
  buffer_load_dwordx4 a[160:163], v2, s[8:11], s22 offen offset:0 sc1
  buffer_load_dwordx4 a[164:167], v2, s[8:11], s22 offen offset:1024 sc1
  buffer_load_dwordx4 a[168:171], v2, s[8:11], s22 offen offset:2048 sc1
  buffer_load_dwordx4 a[172:175], v2, s[8:11], s22 offen offset:3072 sc1
  s_add_u32 s22, s21, 45056
  buffer_load_dwordx4 a[176:179], v2, s[8:11], s22 offen offset:0 sc1
  buffer_load_dwordx4 a[180:183], v2, s[8:11], s22 offen offset:1024 sc1
  buffer_load_dwordx4 a[184:187], v2, s[8:11], s22 offen offset:2048 sc1
  buffer_load_dwordx4 a[188:191], v2, s[8:11], s22 offen offset:3072 sc1
  s_add_u32 s22, s21, 49152
  buffer_load_dwordx4 a[192:195], v2, s[8:11], s22 offen offset:0 sc1
  buffer_load_dwordx4 a[196:199], v2, s[8:11], s22 offen offset:1024 sc1
  buffer_load_dwordx4 a[200:203], v2, s[8:11], s22 offen offset:2048 sc1
  buffer_load_dwordx4 a[204:207], v2, s[8:11], s22 offen offset:3072 sc1
  s_add_u32 s22, s21, 53248
  buffer_load_dwordx4 a[208:211], v2, s[8:11], s22 offen offset:0 sc1
  buffer_load_dwordx4 a[212:215], v2, s[8:11], s22 offen offset:1024 sc1
  buffer_load_dwordx4 a[216:219], v2, s[8:11], s22 offen offset:2048 sc1
  buffer_load_dwordx4 a[220:223], v2, s[8:11], s22 offen offset:3072 sc1
  s_waitcnt vmcnt(40)
  s_mul_i32 s23, s17, 401408
  s_and_b32 s22, s16, 1
  s_mul_i32 s22, s22, 7168
  s_add_u32 s23, s23, s22
  s_add_u32 s23, s23, 0
  s_lshr_b32 s22, s16, 1
  s_mul_i32 s22, s22, 14336
  s_add_u32 s23, s23, s22
  s_mul_i32 s27, s16, 7168
  s_lshr_b32 s28, s20, 1
  s_cmp_lt_u32 s17, 16
  s_cbranch_scc0 wg_vo
  s_add_u32 s23, s23, s22
  s_lshl_b32 s29, s28, 4
  s_add_u32 s29, s29, s17
  s_mul_i32 s29, s29, 28672
  s_add_u32 s29, s29, 12845056
  s_mov_b32 s31, 0
  s_lshr_b32 s24, s34, 1
  s_lshl_b32 s24, s24, 2
  s_and_b32 s25, s34, 1
  s_add_u32 s24, s24, s25
  s_mul_i32 s24, s24, 14336
  s_add_u32 s24, s24, s23
  s_add_u32 m0, s31, s27
  s_nop 0
  buffer_load_dwordx4 v2, s[8:11], s24 offen offset:0 sc1 lds
  buffer_load_dwordx4 v2, s[8:11], s24 offen offset:1024 sc1 lds
  buffer_load_dwordx4 v2, s[8:11], s24 offen offset:2048 sc1 lds
  buffer_load_dwordx4 v2, s[8:11], s24 offen offset:3072 sc1 lds
  s_add_u32 m0, m0, 4096
  s_add_u32 s24, s24, 4096
  buffer_load_dwordx4 v2, s[8:11], s24 offen offset:0 sc1 lds
  buffer_load_dwordx4 v2, s[8:11], s24 offen offset:1024 sc1 lds
  buffer_load_dwordx4 v2, s[8:11], s24 offen offset:2048 sc1 lds
  s_sub_u32 s36, s35, 1
  s_add_u32 s30, s34, 1
  s_min_u32 s30, s30, s36
  s_mov_b32 s31, 28672
  s_lshr_b32 s24, s30, 1
  s_lshl_b32 s24, s24, 2
  s_and_b32 s25, s30, 1
  s_add_u32 s24, s24, s25
  s_mul_i32 s24, s24, 14336
  s_add_u32 s24, s24, s23
  s_add_u32 m0, s31, s27
  s_nop 0
  buffer_load_dwordx4 v2, s[8:11], s24 offen offset:0 sc1 lds
  buffer_load_dwordx4 v2, s[8:11], s24 offen offset:1024 sc1 lds
  buffer_load_dwordx4 v2, s[8:11], s24 offen offset:2048 sc1 lds
  buffer_load_dwordx4 v2, s[8:11], s24 offen offset:3072 sc1 lds
  s_add_u32 m0, m0, 4096
  s_add_u32 s24, s24, 4096
  buffer_load_dwordx4 v2, s[8:11], s24 offen offset:0 sc1 lds
  buffer_load_dwordx4 v2, s[8:11], s24 offen offset:1024 sc1 lds
  buffer_load_dwordx4 v2, s[8:11], s24 offen offset:2048 sc1 lds
  s_mov_b32 s19, s34
  s_mov_b32 s32, 0
  s_mov_b32 s33, 57344
  s_waitcnt vmcnt(7)
  s_branch wg_f_in
wg_f_loop:
  s_waitcnt vmcnt(11)
wg_f_in:
  s_barrier
  s_add_u32 s30, s19, 2
  s_min_u32 s30, s30, s36
  s_lshr_b32 s24, s30, 1
  s_lshl_b32 s24, s24, 2
  s_and_b32 s25, s30, 1
  s_add_u32 s24, s24, s25
  s_mul_i32 s24, s24, 14336
  s_add_u32 s24, s24, s23
  s_add_u32 m0, s33, s27
  s_nop 0
  buffer_load_dwordx4 v2, s[8:11], s24 offen offset:0 sc1 lds
  buffer_load_dwordx4 v2, s[8:11], s24 offen offset:1024 sc1 lds
  buffer_load_dwordx4 v2, s[8:11], s24 offen offset:2048 sc1 lds
  buffer_load_dwordx4 v2, s[8:11], s24 offen offset:3072 sc1 lds
  s_add_u32 m0, m0, 4096
  s_add_u32 s24, s24, 4096
  buffer_load_dwordx4 v2, s[8:11], s24 offen offset:0 sc1 lds
  buffer_load_dwordx4 v2, s[8:11], s24 offen offset:1024 sc1 lds
  buffer_load_dwordx4 v2, s[8:11], s24 offen offset:2048 sc1 lds
  v_add_u32 v5, s32, v2
  ds_read_b128 v[8:11], v5 offset:0
  ds_read_b128 v[12:15], v5 offset:14336
  ds_read_b128 v[16:19], v5 offset:1024
  ds_read_b128 v[20:23], v5 offset:15360
  ds_read_b128 v[24:27], v5 offset:2048
  ds_read_b128 v[28:31], v5 offset:16384
  ds_read_b128 v[32:35], v5 offset:3072
  s_waitcnt lgkmcnt(6)
  v_mfma_f32_16x16x32_bf16 v[40:43], v[8:11], a[0:3], 0
  v_mfma_f32_16x16x32_bf16 v[44:47], v[8:11], a[56:59], 0
  v_mfma_f32_16x16x32_bf16 v[48:51], v[8:11], a[112:115], 0
  v_mfma_f32_16x16x32_bf16 v[52:55], v[8:11], a[168:171], 0
  ds_read_b128 v[36:39], v5 offset:17408
  s_waitcnt lgkmcnt(6)
  v_mfma_f32_16x16x32_bf16 v[56:59], v[12:15], a[0:3], 0
  v_mfma_f32_16x16x32_bf16 v[60:63], v[12:15], a[56:59], 0
  v_mfma_f32_16x16x32_bf16 v[64:67], v[12:15], a[112:115], 0
  v_mfma_f32_16x16x32_bf16 v[68:71], v[12:15], a[168:171], 0
  ds_read_b128 v[8:11], v5 offset:4096
  s_waitcnt lgkmcnt(6)
  v_mfma_f32_16x16x32_bf16 v[40:43], v[16:19], a[4:7], v[40:43]
  v_mfma_f32_16x16x32_bf16 v[44:47], v[16:19], a[60:63], v[44:47]
  v_mfma_f32_16x16x32_bf16 v[48:51], v[16:19], a[116:119], v[48:51]
  v_mfma_f32_16x16x32_bf16 v[52:55], v[16:19], a[172:175], v[52:55]
  ds_read_b128 v[12:15], v5 offset:18432
  s_waitcnt lgkmcnt(6)
  v_mfma_f32_16x16x32_bf16 v[56:59], v[20:23], a[4:7], v[56:59]
  v_mfma_f32_16x16x32_bf16 v[60:63], v[20:23], a[60:63], v[60:63]
  v_mfma_f32_16x16x32_bf16 v[64:67], v[20:23], a[116:119], v[64:67]
  v_mfma_f32_16x16x32_bf16 v[68:71], v[20:23], a[172:175], v[68:71]
  ds_read_b128 v[16:19], v5 offset:5120
  s_waitcnt lgkmcnt(6)
  v_mfma_f32_16x16x32_bf16 v[40:43], v[24:27], a[8:11], v[40:43]
  v_mfma_f32_16x16x32_bf16 v[44:47], v[24:27], a[64:67], v[44:47]
  v_mfma_f32_16x16x32_bf16 v[48:51], v[24:27], a[120:123], v[48:51]
  v_mfma_f32_16x16x32_bf16 v[52:55], v[24:27], a[176:179], v[52:55]
  ds_read_b128 v[20:23], v5 offset:19456
  s_waitcnt lgkmcnt(6)
  v_mfma_f32_16x16x32_bf16 v[56:59], v[28:31], a[8:11], v[56:59]
  v_mfma_f32_16x16x32_bf16 v[60:63], v[28:31], a[64:67], v[60:63]
  v_mfma_f32_16x16x32_bf16 v[64:67], v[28:31], a[120:123], v[64:67]
  v_mfma_f32_16x16x32_bf16 v[68:71], v[28:31], a[176:179], v[68:71]
  ds_read_b128 v[24:27], v5 offset:6144
  s_waitcnt lgkmcnt(6)
  v_mfma_f32_16x16x32_bf16 v[40:43], v[32:35], a[12:15], v[40:43]
  v_mfma_f32_16x16x32_bf16 v[44:47], v[32:35], a[68:71], v[44:47]
  v_mfma_f32_16x16x32_bf16 v[48:51], v[32:35], a[124:127], v[48:51]
  v_mfma_f32_16x16x32_bf16 v[52:55], v[32:35], a[180:183], v[52:55]
  ds_read_b128 v[28:31], v5 offset:20480
  s_waitcnt lgkmcnt(6)
  v_mfma_f32_16x16x32_bf16 v[56:59], v[36:39], a[12:15], v[56:59]
  v_mfma_f32_16x16x32_bf16 v[60:63], v[36:39], a[68:71], v[60:63]
  v_mfma_f32_16x16x32_bf16 v[64:67], v[36:39], a[124:127], v[64:67]
  v_mfma_f32_16x16x32_bf16 v[68:71], v[36:39], a[180:183], v[68:71]
  ds_read_b128 v[32:35], v5 offset:7168
  s_waitcnt lgkmcnt(6)
  v_mfma_f32_16x16x32_bf16 v[40:43], v[8:11], a[16:19], v[40:43]
  v_mfma_f32_16x16x32_bf16 v[44:47], v[8:11], a[72:75], v[44:47]
  v_mfma_f32_16x16x32_bf16 v[48:51], v[8:11], a[128:131], v[48:51]
  v_mfma_f32_16x16x32_bf16 v[52:55], v[8:11], a[184:187], v[52:55]
  ds_read_b128 v[36:39], v5 offset:21504
  s_waitcnt lgkmcnt(6)
  v_mfma_f32_16x16x32_bf16 v[56:59], v[12:15], a[16:19], v[56:59]
  v_mfma_f32_16x16x32_bf16 v[60:63], v[12:15], a[72:75], v[60:63]
  v_mfma_f32_16x16x32_bf16 v[64:67], v[12:15], a[128:131], v[64:67]
  v_mfma_f32_16x16x32_bf16 v[68:71], v[12:15], a[184:187], v[68:71]
  ds_read_b128 v[8:11], v5 offset:8192
  s_waitcnt lgkmcnt(6)
  v_mfma_f32_16x16x32_bf16 v[40:43], v[16:19], a[20:23], v[40:43]
  v_mfma_f32_16x16x32_bf16 v[44:47], v[16:19], a[76:79], v[44:47]
  v_mfma_f32_16x16x32_bf16 v[48:51], v[16:19], a[132:135], v[48:51]
  v_mfma_f32_16x16x32_bf16 v[52:55], v[16:19], a[188:191], v[52:55]
  ds_read_b128 v[12:15], v5 offset:22528
  s_waitcnt lgkmcnt(6)
  v_mfma_f32_16x16x32_bf16 v[56:59], v[20:23], a[20:23], v[56:59]
  v_mfma_f32_16x16x32_bf16 v[60:63], v[20:23], a[76:79], v[60:63]
  v_mfma_f32_16x16x32_bf16 v[64:67], v[20:23], a[132:135], v[64:67]
  v_mfma_f32_16x16x32_bf16 v[68:71], v[20:23], a[188:191], v[68:71]
  ds_read_b128 v[16:19], v5 offset:9216
  s_waitcnt lgkmcnt(6)
  v_mfma_f32_16x16x32_bf16 v[40:43], v[24:27], a[24:27], v[40:43]
  v_mfma_f32_16x16x32_bf16 v[44:47], v[24:27], a[80:83], v[44:47]
  v_mfma_f32_16x16x32_bf16 v[48:51], v[24:27], a[136:139], v[48:51]
  v_mfma_f32_16x16x32_bf16 v[52:55], v[24:27], a[192:195], v[52:55]
  ds_read_b128 v[20:23], v5 offset:23552
  s_waitcnt lgkmcnt(6)
  v_mfma_f32_16x16x32_bf16 v[56:59], v[28:31], a[24:27], v[56:59]
  v_mfma_f32_16x16x32_bf16 v[60:63], v[28:31], a[80:83], v[60:63]
  v_mfma_f32_16x16x32_bf16 v[64:67], v[28:31], a[136:139], v[64:67]
  v_mfma_f32_16x16x32_bf16 v[68:71], v[28:31], a[192:195], v[68:71]
  ds_read_b128 v[24:27], v5 offset:10240
  s_waitcnt lgkmcnt(6)
  v_mfma_f32_16x16x32_bf16 v[40:43], v[32:35], a[28:31], v[40:43]
  v_mfma_f32_16x16x32_bf16 v[44:47], v[32:35], a[84:87], v[44:47]
  v_mfma_f32_16x16x32_bf16 v[48:51], v[32:35], a[140:143], v[48:51]
  v_mfma_f32_16x16x32_bf16 v[52:55], v[32:35], a[196:199], v[52:55]
  ds_read_b128 v[28:31], v5 offset:24576
  s_waitcnt lgkmcnt(6)
  v_mfma_f32_16x16x32_bf16 v[56:59], v[36:39], a[28:31], v[56:59]
  v_mfma_f32_16x16x32_bf16 v[60:63], v[36:39], a[84:87], v[60:63]
  v_mfma_f32_16x16x32_bf16 v[64:67], v[36:39], a[140:143], v[64:67]
  v_mfma_f32_16x16x32_bf16 v[68:71], v[36:39], a[196:199], v[68:71]
  ds_read_b128 v[32:35], v5 offset:11264
  s_waitcnt lgkmcnt(6)
  v_mfma_f32_16x16x32_bf16 v[40:43], v[8:11], a[32:35], v[40:43]
  v_mfma_f32_16x16x32_bf16 v[44:47], v[8:11], a[88:91], v[44:47]
  v_mfma_f32_16x16x32_bf16 v[48:51], v[8:11], a[144:147], v[48:51]
  v_mfma_f32_16x16x32_bf16 v[52:55], v[8:11], a[200:203], v[52:55]
  ds_read_b128 v[36:39], v5 offset:25600
  s_waitcnt lgkmcnt(6)
  v_mfma_f32_16x16x32_bf16 v[56:59], v[12:15], a[32:35], v[56:59]
  v_mfma_f32_16x16x32_bf16 v[60:63], v[12:15], a[88:91], v[60:63]
  v_mfma_f32_16x16x32_bf16 v[64:67], v[12:15], a[144:147], v[64:67]
  v_mfma_f32_16x16x32_bf16 v[68:71], v[12:15], a[200:203], v[68:71]
  ds_read_b128 v[8:11], v5 offset:12288
  s_waitcnt lgkmcnt(6)
  v_mfma_f32_16x16x32_bf16 v[40:43], v[16:19], a[36:39], v[40:43]
  v_mfma_f32_16x16x32_bf16 v[44:47], v[16:19], a[92:95], v[44:47]
  v_mfma_f32_16x16x32_bf16 v[48:51], v[16:19], a[148:151], v[48:51]
  v_mfma_f32_16x16x32_bf16 v[52:55], v[16:19], a[204:207], v[52:55]
  ds_read_b128 v[12:15], v5 offset:26624
  s_waitcnt lgkmcnt(6)
  v_mfma_f32_16x16x32_bf16 v[56:59], v[20:23], a[36:39], v[56:59]
  v_mfma_f32_16x16x32_bf16 v[60:63], v[20:23], a[92:95], v[60:63]
  v_mfma_f32_16x16x32_bf16 v[64:67], v[20:23], a[148:151], v[64:67]
  v_mfma_f32_16x16x32_bf16 v[68:71], v[20:23], a[204:207], v[68:71]
  ds_read_b128 v[16:19], v5 offset:13312
  s_waitcnt lgkmcnt(6)
  v_mfma_f32_16x16x32_bf16 v[40:43], v[24:27], a[40:43], v[40:43]
  v_mfma_f32_16x16x32_bf16 v[44:47], v[24:27], a[96:99], v[44:47]
  v_mfma_f32_16x16x32_bf16 v[48:51], v[24:27], a[152:155], v[48:51]
  v_mfma_f32_16x16x32_bf16 v[52:55], v[24:27], a[208:211], v[52:55]
  ds_read_b128 v[20:23], v5 offset:27648
  s_waitcnt lgkmcnt(6)
  v_mfma_f32_16x16x32_bf16 v[56:59], v[28:31], a[40:43], v[56:59]
  v_mfma_f32_16x16x32_bf16 v[60:63], v[28:31], a[96:99], v[60:63]
  v_mfma_f32_16x16x32_bf16 v[64:67], v[28:31], a[152:155], v[64:67]
  v_mfma_f32_16x16x32_bf16 v[68:71], v[28:31], a[208:211], v[68:71]
  s_waitcnt lgkmcnt(5)
  v_mfma_f32_16x16x32_bf16 v[40:43], v[32:35], a[44:47], v[40:43]
  v_mfma_f32_16x16x32_bf16 v[44:47], v[32:35], a[100:103], v[44:47]
  v_mfma_f32_16x16x32_bf16 v[48:51], v[32:35], a[156:159], v[48:51]
  v_mfma_f32_16x16x32_bf16 v[52:55], v[32:35], a[212:215], v[52:55]
  s_waitcnt lgkmcnt(4)
  v_mfma_f32_16x16x32_bf16 v[56:59], v[36:39], a[44:47], v[56:59]
  v_mfma_f32_16x16x32_bf16 v[60:63], v[36:39], a[100:103], v[60:63]
  v_mfma_f32_16x16x32_bf16 v[64:67], v[36:39], a[156:159], v[64:67]
  v_mfma_f32_16x16x32_bf16 v[68:71], v[36:39], a[212:215], v[68:71]
  s_waitcnt lgkmcnt(3)
  v_mfma_f32_16x16x32_bf16 v[40:43], v[8:11], a[48:51], v[40:43]
  v_mfma_f32_16x16x32_bf16 v[44:47], v[8:11], a[104:107], v[44:47]
  v_mfma_f32_16x16x32_bf16 v[48:51], v[8:11], a[160:163], v[48:51]
  v_mfma_f32_16x16x32_bf16 v[52:55], v[8:11], a[216:219], v[52:55]
  s_waitcnt lgkmcnt(2)
  v_mfma_f32_16x16x32_bf16 v[56:59], v[12:15], a[48:51], v[56:59]
  v_mfma_f32_16x16x32_bf16 v[60:63], v[12:15], a[104:107], v[60:63]
  v_mfma_f32_16x16x32_bf16 v[64:67], v[12:15], a[160:163], v[64:67]
  v_mfma_f32_16x16x32_bf16 v[68:71], v[12:15], a[216:219], v[68:71]
  s_waitcnt lgkmcnt(1)
  v_mfma_f32_16x16x32_bf16 v[40:43], v[16:19], a[52:55], v[40:43]
  v_mfma_f32_16x16x32_bf16 v[44:47], v[16:19], a[108:111], v[44:47]
  v_mfma_f32_16x16x32_bf16 v[48:51], v[16:19], a[164:167], v[48:51]
  v_mfma_f32_16x16x32_bf16 v[52:55], v[16:19], a[220:223], v[52:55]
  s_waitcnt lgkmcnt(0)
  v_mfma_f32_16x16x32_bf16 v[56:59], v[20:23], a[52:55], v[56:59]
  v_mfma_f32_16x16x32_bf16 v[60:63], v[20:23], a[108:111], v[60:63]
  v_mfma_f32_16x16x32_bf16 v[64:67], v[20:23], a[164:167], v[64:67]
  v_mfma_f32_16x16x32_bf16 v[68:71], v[20:23], a[220:223], v[68:71]
  s_lshl_b32 s24, s19, 10
  s_add_u32 s24, s24, s29
  v_cvt_pk_bf16_f32 v72, v40, v41
  v_cvt_pk_bf16_f32 v73, v42, v43
  v_cvt_pk_bf16_f32 v74, v56, v57
  v_cvt_pk_bf16_f32 v75, v58, v59
  s_add_u32 s25, s24, 0
  buffer_store_dwordx4 v[72:75], v2, s[8:11], s25 offen sc1
  v_cvt_pk_bf16_f32 v76, v44, v45
  v_cvt_pk_bf16_f32 v77, v46, v47
  v_cvt_pk_bf16_f32 v78, v60, v61
  v_cvt_pk_bf16_f32 v79, v62, v63
  s_add_u32 s25, s24, 14336
  buffer_store_dwordx4 v[76:79], v2, s[8:11], s25 offen sc1
  v_cvt_pk_bf16_f32 v80, v48, v49
  v_cvt_pk_bf16_f32 v81, v50, v51
  v_cvt_pk_bf16_f32 v82, v64, v65
  v_cvt_pk_bf16_f32 v83, v66, v67
  s_add_u32 s25, s24, 458752
  buffer_store_dwordx4 v[80:83], v2, s[8:11], s25 offen sc1
  v_cvt_pk_bf16_f32 v84, v52, v53
  v_cvt_pk_bf16_f32 v85, v54, v55
  v_cvt_pk_bf16_f32 v86, v68, v69
  v_cvt_pk_bf16_f32 v87, v70, v71
  s_add_u32 s25, s24, 473088
  buffer_store_dwordx4 v[84:87], v2, s[8:11], s25 offen sc1
  s_mov_b32 s33, s32
  s_add_u32 s32, s32, 28672
  s_cmp_eq_u32 s32, 86016
  s_cselect_b32 s32, 0, s32
  s_add_u32 s19, s19, 1
  s_cmp_lt_u32 s19, s35
  s_cbranch_scc1 wg_f_loop
  s_branch wg_done
wg_vo:
  s_sub_u32 s29, s17, 16
  s_mul_i32 s29, s29, 28672
  s_mul_i32 s24, s28, 458752
  s_add_u32 s29, s29, s24
  s_add_u32 s29, s29, 42205184
  v_lshlrev_b32 v6, 4, v3
  v_mul_u32_u24 v7, 12, v3
  v_add_u32 v7, 48, v7
  s_mov_b32 s31, 0
  s_lshl_b32 s24, s34, 1
  s_mul_i32 s24, s24, 14336
  s_add_u32 s24, s24, s23
  s_add_u32 m0, s31, s27
  s_nop 0
  buffer_load_dwordx4 v2, s[8:11], s24 offen offset:0 sc1 lds
  buffer_load_dwordx4 v2, s[8:11], s24 offen offset:1024 sc1 lds
  buffer_load_dwordx4 v2, s[8:11], s24 offen offset:2048 sc1 lds
  buffer_load_dwordx4 v2, s[8:11], s24 offen offset:3072 sc1 lds
  s_add_u32 m0, m0, 4096
  s_add_u32 s24, s24, 4096
  buffer_load_dwordx4 v2, s[8:11], s24 offen offset:0 sc1 lds
  buffer_load_dwordx4 v2, s[8:11], s24 offen offset:1024 sc1 lds
  buffer_load_dwordx4 v2, s[8:11], s24 offen offset:2048 sc1 lds
  s_sub_u32 s36, s35, 1
  s_add_u32 s30, s34, 1
  s_min_u32 s30, s30, s36
  s_mov_b32 s31, 28672
  s_lshl_b32 s24, s30, 1
  s_mul_i32 s24, s24, 14336
  s_add_u32 s24, s24, s23
  s_add_u32 m0, s31, s27
  s_nop 0
  buffer_load_dwordx4 v2, s[8:11], s24 offen offset:0 sc1 lds
  buffer_load_dwordx4 v2, s[8:11], s24 offen offset:1024 sc1 lds
  buffer_load_dwordx4 v2, s[8:11], s24 offen offset:2048 sc1 lds
  buffer_load_dwordx4 v2, s[8:11], s24 offen offset:3072 sc1 lds
  s_add_u32 m0, m0, 4096
  s_add_u32 s24, s24, 4096
  buffer_load_dwordx4 v2, s[8:11], s24 offen offset:0 sc1 lds
  buffer_load_dwordx4 v2, s[8:11], s24 offen offset:1024 sc1 lds
  buffer_load_dwordx4 v2, s[8:11], s24 offen offset:2048 sc1 lds
  s_mov_b32 s19, s34
  s_mov_b32 s32, 0
  s_mov_b32 s33, 57344
  s_waitcnt vmcnt(7)
  s_branch wg_vo_in
wg_vo_loop:
  s_waitcnt vmcnt(11)
wg_vo_in:
  s_barrier
  s_add_u32 s30, s19, 2
  s_min_u32 s30, s30, s36
  s_lshl_b32 s24, s30, 1
  s_mul_i32 s24, s24, 14336
  s_add_u32 s24, s24, s23
  s_add_u32 m0, s33, s27
  s_nop 0
  buffer_load_dwordx4 v2, s[8:11], s24 offen offset:0 sc1 lds
  buffer_load_dwordx4 v2, s[8:11], s24 offen offset:1024 sc1 lds
  buffer_load_dwordx4 v2, s[8:11], s24 offen offset:2048 sc1 lds
  buffer_load_dwordx4 v2, s[8:11], s24 offen offset:3072 sc1 lds
  s_add_u32 m0, m0, 4096
  s_add_u32 s24, s24, 4096
  buffer_load_dwordx4 v2, s[8:11], s24 offen offset:0 sc1 lds
  buffer_load_dwordx4 v2, s[8:11], s24 offen offset:1024 sc1 lds
  buffer_load_dwordx4 v2, s[8:11], s24 offen offset:2048 sc1 lds
  v_add_u32 v5, s32, v2
  ds_read_b128 v[8:11], v5 offset:0
  ds_read_b128 v[12:15], v5 offset:14336
  ds_read_b128 v[16:19], v5 offset:1024
  ds_read_b128 v[20:23], v5 offset:15360
  ds_read_b128 v[24:27], v5 offset:2048
  ds_read_b128 v[28:31], v5 offset:16384
  ds_read_b128 v[32:35], v5 offset:3072
  s_waitcnt lgkmcnt(6)
  v_mfma_f32_16x16x32_bf16 v[40:43], a[0:3], v[8:11], 0
  v_mfma_f32_16x16x32_bf16 v[44:47], a[56:59], v[8:11], 0
  v_mfma_f32_16x16x32_bf16 v[48:51], a[112:115], v[8:11], 0
  v_mfma_f32_16x16x32_bf16 v[52:55], a[168:171], v[8:11], 0
  ds_read_b128 v[36:39], v5 offset:17408
  s_waitcnt lgkmcnt(6)
  v_mfma_f32_16x16x32_bf16 v[56:59], a[0:3], v[12:15], 0
  v_mfma_f32_16x16x32_bf16 v[60:63], a[56:59], v[12:15], 0
  v_mfma_f32_16x16x32_bf16 v[64:67], a[112:115], v[12:15], 0
  v_mfma_f32_16x16x32_bf16 v[68:71], a[168:171], v[12:15], 0
  ds_read_b128 v[8:11], v5 offset:4096
  s_waitcnt lgkmcnt(6)
  v_mfma_f32_16x16x32_bf16 v[40:43], a[4:7], v[16:19], v[40:43]
  v_mfma_f32_16x16x32_bf16 v[44:47], a[60:63], v[16:19], v[44:47]
  v_mfma_f32_16x16x32_bf16 v[48:51], a[116:119], v[16:19], v[48:51]
  v_mfma_f32_16x16x32_bf16 v[52:55], a[172:175], v[16:19], v[52:55]
  ds_read_b128 v[12:15], v5 offset:18432
  s_waitcnt lgkmcnt(6)
  v_mfma_f32_16x16x32_bf16 v[56:59], a[4:7], v[20:23], v[56:59]
  v_mfma_f32_16x16x32_bf16 v[60:63], a[60:63], v[20:23], v[60:63]
  v_mfma_f32_16x16x32_bf16 v[64:67], a[116:119], v[20:23], v[64:67]
  v_mfma_f32_16x16x32_bf16 v[68:71], a[172:175], v[20:23], v[68:71]
  ds_read_b128 v[16:19], v5 offset:5120
  s_waitcnt lgkmcnt(6)
  v_mfma_f32_16x16x32_bf16 v[40:43], a[8:11], v[24:27], v[40:43]
  v_mfma_f32_16x16x32_bf16 v[44:47], a[64:67], v[24:27], v[44:47]
  v_mfma_f32_16x16x32_bf16 v[48:51], a[120:123], v[24:27], v[48:51]
  v_mfma_f32_16x16x32_bf16 v[52:55], a[176:179], v[24:27], v[52:55]
  ds_read_b128 v[20:23], v5 offset:19456
  s_waitcnt lgkmcnt(6)
  v_mfma_f32_16x16x32_bf16 v[56:59], a[8:11], v[28:31], v[56:59]
  v_mfma_f32_16x16x32_bf16 v[60:63], a[64:67], v[28:31], v[60:63]
  v_mfma_f32_16x16x32_bf16 v[64:67], a[120:123], v[28:31], v[64:67]
  v_mfma_f32_16x16x32_bf16 v[68:71], a[176:179], v[28:31], v[68:71]
  ds_read_b128 v[24:27], v5 offset:6144
  s_waitcnt lgkmcnt(6)
  v_mfma_f32_16x16x32_bf16 v[40:43], a[12:15], v[32:35], v[40:43]
  v_mfma_f32_16x16x32_bf16 v[44:47], a[68:71], v[32:35], v[44:47]
  v_mfma_f32_16x16x32_bf16 v[48:51], a[124:127], v[32:35], v[48:51]
  v_mfma_f32_16x16x32_bf16 v[52:55], a[180:183], v[32:35], v[52:55]
  ds_read_b128 v[28:31], v5 offset:20480
  s_waitcnt lgkmcnt(6)
  v_mfma_f32_16x16x32_bf16 v[56:59], a[12:15], v[36:39], v[56:59]
  v_mfma_f32_16x16x32_bf16 v[60:63], a[68:71], v[36:39], v[60:63]
  v_mfma_f32_16x16x32_bf16 v[64:67], a[124:127], v[36:39], v[64:67]
  v_mfma_f32_16x16x32_bf16 v[68:71], a[180:183], v[36:39], v[68:71]
  ds_read_b128 v[32:35], v5 offset:7168
  s_waitcnt lgkmcnt(6)
  v_mfma_f32_16x16x32_bf16 v[40:43], a[16:19], v[8:11], v[40:43]
  v_mfma_f32_16x16x32_bf16 v[44:47], a[72:75], v[8:11], v[44:47]
  v_mfma_f32_16x16x32_bf16 v[48:51], a[128:131], v[8:11], v[48:51]
  v_mfma_f32_16x16x32_bf16 v[52:55], a[184:187], v[8:11], v[52:55]
  ds_read_b128 v[36:39], v5 offset:21504
  s_waitcnt lgkmcnt(6)
  v_mfma_f32_16x16x32_bf16 v[56:59], a[16:19], v[12:15], v[56:59]
  v_mfma_f32_16x16x32_bf16 v[60:63], a[72:75], v[12:15], v[60:63]
  v_mfma_f32_16x16x32_bf16 v[64:67], a[128:131], v[12:15], v[64:67]
  v_mfma_f32_16x16x32_bf16 v[68:71], a[184:187], v[12:15], v[68:71]
  ds_read_b128 v[8:11], v5 offset:8192
  s_waitcnt lgkmcnt(6)
  v_mfma_f32_16x16x32_bf16 v[40:43], a[20:23], v[16:19], v[40:43]
  v_mfma_f32_16x16x32_bf16 v[44:47], a[76:79], v[16:19], v[44:47]
  v_mfma_f32_16x16x32_bf16 v[48:51], a[132:135], v[16:19], v[48:51]
  v_mfma_f32_16x16x32_bf16 v[52:55], a[188:191], v[16:19], v[52:55]
  ds_read_b128 v[12:15], v5 offset:22528
  s_waitcnt lgkmcnt(6)
  v_mfma_f32_16x16x32_bf16 v[56:59], a[20:23], v[20:23], v[56:59]
  v_mfma_f32_16x16x32_bf16 v[60:63], a[76:79], v[20:23], v[60:63]
  v_mfma_f32_16x16x32_bf16 v[64:67], a[132:135], v[20:23], v[64:67]
  v_mfma_f32_16x16x32_bf16 v[68:71], a[188:191], v[20:23], v[68:71]
  ds_read_b128 v[16:19], v5 offset:9216
  s_waitcnt lgkmcnt(6)
  v_mfma_f32_16x16x32_bf16 v[40:43], a[24:27], v[24:27], v[40:43]
  v_mfma_f32_16x16x32_bf16 v[44:47], a[80:83], v[24:27], v[44:47]
  v_mfma_f32_16x16x32_bf16 v[48:51], a[136:139], v[24:27], v[48:51]
  v_mfma_f32_16x16x32_bf16 v[52:55], a[192:195], v[24:27], v[52:55]
  ds_read_b128 v[20:23], v5 offset:23552
  s_waitcnt lgkmcnt(6)
  v_mfma_f32_16x16x32_bf16 v[56:59], a[24:27], v[28:31], v[56:59]
  v_mfma_f32_16x16x32_bf16 v[60:63], a[80:83], v[28:31], v[60:63]
  v_mfma_f32_16x16x32_bf16 v[64:67], a[136:139], v[28:31], v[64:67]
  v_mfma_f32_16x16x32_bf16 v[68:71], a[192:195], v[28:31], v[68:71]
  ds_read_b128 v[24:27], v5 offset:10240
  s_waitcnt lgkmcnt(6)
  v_mfma_f32_16x16x32_bf16 v[40:43], a[28:31], v[32:35], v[40:43]
  v_mfma_f32_16x16x32_bf16 v[44:47], a[84:87], v[32:35], v[44:47]
  v_mfma_f32_16x16x32_bf16 v[48:51], a[140:143], v[32:35], v[48:51]
  v_mfma_f32_16x16x32_bf16 v[52:55], a[196:199], v[32:35], v[52:55]
  ds_read_b128 v[28:31], v5 offset:24576
  s_waitcnt lgkmcnt(6)
  v_mfma_f32_16x16x32_bf16 v[56:59], a[28:31], v[36:39], v[56:59]
  v_mfma_f32_16x16x32_bf16 v[60:63], a[84:87], v[36:39], v[60:63]
  v_mfma_f32_16x16x32_bf16 v[64:67], a[140:143], v[36:39], v[64:67]
  v_mfma_f32_16x16x32_bf16 v[68:71], a[196:199], v[36:39], v[68:71]
  ds_read_b128 v[32:35], v5 offset:11264
  s_waitcnt lgkmcnt(6)
  v_mfma_f32_16x16x32_bf16 v[40:43], a[32:35], v[8:11], v[40:43]
  v_mfma_f32_16x16x32_bf16 v[44:47], a[88:91], v[8:11], v[44:47]
  v_mfma_f32_16x16x32_bf16 v[48:51], a[144:147], v[8:11], v[48:51]
  v_mfma_f32_16x16x32_bf16 v[52:55], a[200:203], v[8:11], v[52:55]
  ds_read_b128 v[36:39], v5 offset:25600
  s_waitcnt lgkmcnt(6)
  v_mfma_f32_16x16x32_bf16 v[56:59], a[32:35], v[12:15], v[56:59]
  v_mfma_f32_16x16x32_bf16 v[60:63], a[88:91], v[12:15], v[60:63]
  v_mfma_f32_16x16x32_bf16 v[64:67], a[144:147], v[12:15], v[64:67]
  v_mfma_f32_16x16x32_bf16 v[68:71], a[200:203], v[12:15], v[68:71]
  ds_read_b128 v[8:11], v5 offset:12288
  s_waitcnt lgkmcnt(6)
  v_mfma_f32_16x16x32_bf16 v[40:43], a[36:39], v[16:19], v[40:43]
  v_mfma_f32_16x16x32_bf16 v[44:47], a[92:95], v[16:19], v[44:47]
  v_mfma_f32_16x16x32_bf16 v[48:51], a[148:151], v[16:19], v[48:51]
  v_mfma_f32_16x16x32_bf16 v[52:55], a[204:207], v[16:19], v[52:55]
  ds_read_b128 v[12:15], v5 offset:26624
  s_waitcnt lgkmcnt(6)
  v_mfma_f32_16x16x32_bf16 v[56:59], a[36:39], v[20:23], v[56:59]
  v_mfma_f32_16x16x32_bf16 v[60:63], a[92:95], v[20:23], v[60:63]
  v_mfma_f32_16x16x32_bf16 v[64:67], a[148:151], v[20:23], v[64:67]
  v_mfma_f32_16x16x32_bf16 v[68:71], a[204:207], v[20:23], v[68:71]
  ds_read_b128 v[16:19], v5 offset:13312
  s_waitcnt lgkmcnt(6)
  v_mfma_f32_16x16x32_bf16 v[40:43], a[40:43], v[24:27], v[40:43]
  v_mfma_f32_16x16x32_bf16 v[44:47], a[96:99], v[24:27], v[44:47]
  v_mfma_f32_16x16x32_bf16 v[48:51], a[152:155], v[24:27], v[48:51]
  v_mfma_f32_16x16x32_bf16 v[52:55], a[208:211], v[24:27], v[52:55]
  ds_read_b128 v[20:23], v5 offset:27648
  s_waitcnt lgkmcnt(6)
  v_mfma_f32_16x16x32_bf16 v[56:59], a[40:43], v[28:31], v[56:59]
  v_mfma_f32_16x16x32_bf16 v[60:63], a[96:99], v[28:31], v[60:63]
  v_mfma_f32_16x16x32_bf16 v[64:67], a[152:155], v[28:31], v[64:67]
  v_mfma_f32_16x16x32_bf16 v[68:71], a[208:211], v[28:31], v[68:71]
  s_waitcnt lgkmcnt(5)
  v_mfma_f32_16x16x32_bf16 v[40:43], a[44:47], v[32:35], v[40:43]
  v_mfma_f32_16x16x32_bf16 v[44:47], a[100:103], v[32:35], v[44:47]
  v_mfma_f32_16x16x32_bf16 v[48:51], a[156:159], v[32:35], v[48:51]
  v_mfma_f32_16x16x32_bf16 v[52:55], a[212:215], v[32:35], v[52:55]
  s_waitcnt lgkmcnt(4)
  v_mfma_f32_16x16x32_bf16 v[56:59], a[44:47], v[36:39], v[56:59]
  v_mfma_f32_16x16x32_bf16 v[60:63], a[100:103], v[36:39], v[60:63]
  v_mfma_f32_16x16x32_bf16 v[64:67], a[156:159], v[36:39], v[64:67]
  v_mfma_f32_16x16x32_bf16 v[68:71], a[212:215], v[36:39], v[68:71]
  s_waitcnt lgkmcnt(3)
  v_mfma_f32_16x16x32_bf16 v[40:43], a[48:51], v[8:11], v[40:43]
  v_mfma_f32_16x16x32_bf16 v[44:47], a[104:107], v[8:11], v[44:47]
  v_mfma_f32_16x16x32_bf16 v[48:51], a[160:163], v[8:11], v[48:51]
  v_mfma_f32_16x16x32_bf16 v[52:55], a[216:219], v[8:11], v[52:55]
  s_waitcnt lgkmcnt(2)
  v_mfma_f32_16x16x32_bf16 v[56:59], a[48:51], v[12:15], v[56:59]
  v_mfma_f32_16x16x32_bf16 v[60:63], a[104:107], v[12:15], v[60:63]
  v_mfma_f32_16x16x32_bf16 v[64:67], a[160:163], v[12:15], v[64:67]
  v_mfma_f32_16x16x32_bf16 v[68:71], a[216:219], v[12:15], v[68:71]
  s_waitcnt lgkmcnt(1)
  v_mfma_f32_16x16x32_bf16 v[40:43], a[52:55], v[16:19], v[40:43]
  v_mfma_f32_16x16x32_bf16 v[44:47], a[108:111], v[16:19], v[44:47]
  v_mfma_f32_16x16x32_bf16 v[48:51], a[164:167], v[16:19], v[48:51]
  v_mfma_f32_16x16x32_bf16 v[52:55], a[220:223], v[16:19], v[52:55]
  s_waitcnt lgkmcnt(0)
  v_mfma_f32_16x16x32_bf16 v[56:59], a[52:55], v[20:23], v[56:59]
  v_mfma_f32_16x16x32_bf16 v[60:63], a[108:111], v[20:23], v[60:63]
  v_mfma_f32_16x16x32_bf16 v[64:67], a[164:167], v[20:23], v[64:67]
  v_mfma_f32_16x16x32_bf16 v[68:71], a[220:223], v[20:23], v[68:71]
  s_add_u32 s25, s29, 458752
  s_lshl_b32 s24, s19, 5
  s_add_u32 s24, s24, 0
  v_add_u32 v88, s24, v4
  v_mul_u32_u24 v89, 2341, v88
  v_lshrrev_b32 v89, 16, v89
  v_mul_u32_u24 v92, 28, v89
  v_sub_u32 v92, v88, v92
  v_cmp_gt_u32 vcc, 16, v92
  v_mul_u32_u24 v89, 84, v89
  s_nop 0
  v_cndmask_b32 v92, v7, v6, vcc
  v_add3_u32 v88, v88, v89, v92
  v_lshlrev_b32 v90, 4, v88
  v_cvt_pk_bf16_f32 v72, v40, v44
  v_cvt_pk_bf16_f32 v73, v41, v45
  v_cvt_pk_bf16_f32 v74, v42, v46
  v_cvt_pk_bf16_f32 v75, v43, v47
  buffer_store_dwordx4 v[72:75], v90, s[8:11], s29 offen sc1
  v_cvt_pk_bf16_f32 v76, v48, v52
  v_cvt_pk_bf16_f32 v77, v49, v53
  v_cvt_pk_bf16_f32 v78, v50, v54
  v_cvt_pk_bf16_f32 v79, v51, v55
  buffer_store_dwordx4 v[76:79], v90, s[8:11], s25 offen sc1
  s_lshl_b32 s24, s19, 5
  s_add_u32 s24, s24, 16
  v_add_u32 v88, s24, v4
  v_mul_u32_u24 v89, 2341, v88
  v_lshrrev_b32 v89, 16, v89
  v_mul_u32_u24 v92, 28, v89
  v_sub_u32 v92, v88, v92
  v_cmp_gt_u32 vcc, 16, v92
  v_mul_u32_u24 v89, 84, v89
  s_nop 0
  v_cndmask_b32 v92, v7, v6, vcc
  v_add3_u32 v88, v88, v89, v92
  v_lshlrev_b32 v91, 4, v88
  v_cvt_pk_bf16_f32 v80, v56, v60
  v_cvt_pk_bf16_f32 v81, v57, v61
  v_cvt_pk_bf16_f32 v82, v58, v62
  v_cvt_pk_bf16_f32 v83, v59, v63
  buffer_store_dwordx4 v[80:83], v91, s[8:11], s29 offen sc1
  v_cvt_pk_bf16_f32 v84, v64, v68
  v_cvt_pk_bf16_f32 v85, v65, v69
  v_cvt_pk_bf16_f32 v86, v66, v70
  v_cvt_pk_bf16_f32 v87, v67, v71
  buffer_store_dwordx4 v[84:87], v91, s[8:11], s25 offen sc1
  s_mov_b32 s33, s32
  s_add_u32 s32, s32, 28672
  s_cmp_eq_u32 s32, 86016
  s_cselect_b32 s32, 0, s32
  s_add_u32 s19, s19, 1
  s_cmp_lt_u32 s19, s35
  s_cbranch_scc1 wg_vo_loop
  s_branch wg_done
wg_done:
  s_lshl_b32 s20, s18, 4
  s_and_b32 s21, s17, 15
  s_add_u32 s20, s20, s21
  s_lshl_b32 s20, s20, 7
  s_cmp_lt_u32 s17, 16
  s_cselect_b32 s21, 16384, 0
  s_add_u32 s20, s20, s21
  s_add_u32 s20, s20, 88461312
  s_sub_u32 s21, s35, s34
  s_lshl_b32 s21, s21, 2
  v_mov_b32 v5, s21
  v_mov_b32 v6, 0
  s_waitcnt vmcnt(0)
  s_barrier
  s_cmp_lg_u32 s16, 0
  s_cbranch_scc1 wg_sg
  s_mov_b64 exec, 1
  buffer_atomic_add v5, v6, s[8:11], s20 offen
  s_mov_b64 exec, -1
wg_sg:
  s_branch wk_loop
wk_srv:
  s_and_b32 s18, s3, 15
  s_lshr_b32 s19, s3, 4
  s_and_b32 s19, s19, 1
  s_mul_i32 s20, s18, 401408
  s_mul_i32 s21, s16, 100352
  s_add_u32 s20, s20, s21
  s_add_u32 s20, s20, 6422528
  s_add_u32 s22, s20, 0
  buffer_load_dwordx4 a[0:3], v2, s[8:11], s22 offen offset:0 sc1
  buffer_load_dwordx4 a[4:7], v2, s[8:11], s22 offen offset:1024 sc1
  buffer_load_dwordx4 a[8:11], v2, s[8:11], s22 offen offset:2048 sc1
  buffer_load_dwordx4 a[12:15], v2, s[8:11], s22 offen offset:3072 sc1
  s_add_u32 s22, s20, 4096
  buffer_load_dwordx4 a[16:19], v2, s[8:11], s22 offen offset:0 sc1
  buffer_load_dwordx4 a[20:23], v2, s[8:11], s22 offen offset:1024 sc1
  buffer_load_dwordx4 a[24:27], v2, s[8:11], s22 offen offset:2048 sc1
  buffer_load_dwordx4 a[28:31], v2, s[8:11], s22 offen offset:3072 sc1
  s_add_u32 s22, s20, 8192
  buffer_load_dwordx4 a[32:35], v2, s[8:11], s22 offen offset:0 sc1
  buffer_load_dwordx4 a[36:39], v2, s[8:11], s22 offen offset:1024 sc1
  buffer_load_dwordx4 a[40:43], v2, s[8:11], s22 offen offset:2048 sc1
  buffer_load_dwordx4 a[44:47], v2, s[8:11], s22 offen offset:3072 sc1
  s_add_u32 s22, s20, 12288
  buffer_load_dwordx4 a[48:51], v2, s[8:11], s22 offen offset:0 sc1
  buffer_load_dwordx4 a[52:55], v2, s[8:11], s22 offen offset:1024 sc1
  buffer_load_dwordx4 a[56:59], v2, s[8:11], s22 offen offset:2048 sc1
  buffer_load_dwordx4 a[60:63], v2, s[8:11], s22 offen offset:3072 sc1
  s_add_u32 s22, s20, 16384
  buffer_load_dwordx4 a[64:67], v2, s[8:11], s22 offen offset:0 sc1
  buffer_load_dwordx4 a[68:71], v2, s[8:11], s22 offen offset:1024 sc1
  buffer_load_dwordx4 a[72:75], v2, s[8:11], s22 offen offset:2048 sc1
  buffer_load_dwordx4 a[76:79], v2, s[8:11], s22 offen offset:3072 sc1
  s_add_u32 s22, s20, 20480
  buffer_load_dwordx4 a[80:83], v2, s[8:11], s22 offen offset:0 sc1
  buffer_load_dwordx4 a[84:87], v2, s[8:11], s22 offen offset:1024 sc1
  buffer_load_dwordx4 a[88:91], v2, s[8:11], s22 offen offset:2048 sc1
  buffer_load_dwordx4 a[92:95], v2, s[8:11], s22 offen offset:3072 sc1
  s_add_u32 s22, s20, 24576
  buffer_load_dwordx4 a[96:99], v2, s[8:11], s22 offen offset:0 sc1
  buffer_load_dwordx4 a[100:103], v2, s[8:11], s22 offen offset:1024 sc1
  buffer_load_dwordx4 a[104:107], v2, s[8:11], s22 offen offset:2048 sc1
  buffer_load_dwordx4 a[108:111], v2, s[8:11], s22 offen offset:3072 sc1
  s_add_u32 s22, s20, 28672
  buffer_load_dwordx4 a[112:115], v2, s[8:11], s22 offen offset:0 sc1
  buffer_load_dwordx4 a[116:119], v2, s[8:11], s22 offen offset:1024 sc1
  buffer_load_dwordx4 a[120:123], v2, s[8:11], s22 offen offset:2048 sc1
  buffer_load_dwordx4 a[124:127], v2, s[8:11], s22 offen offset:3072 sc1
  s_waitcnt vmcnt(24)
  s_add_u32 s22, s20, 32768
  buffer_load_dwordx4 a[128:131], v2, s[8:11], s22 offen offset:0 sc1
  buffer_load_dwordx4 a[132:135], v2, s[8:11], s22 offen offset:1024 sc1
  buffer_load_dwordx4 a[136:139], v2, s[8:11], s22 offen offset:2048 sc1
  buffer_load_dwordx4 a[140:143], v2, s[8:11], s22 offen offset:3072 sc1
  s_add_u32 s22, s20, 36864
  buffer_load_dwordx4 a[144:147], v2, s[8:11], s22 offen offset:0 sc1
  buffer_load_dwordx4 a[148:151], v2, s[8:11], s22 offen offset:1024 sc1
  buffer_load_dwordx4 a[152:155], v2, s[8:11], s22 offen offset:2048 sc1
  buffer_load_dwordx4 a[156:159], v2, s[8:11], s22 offen offset:3072 sc1
  s_add_u32 s22, s20, 40960
  buffer_load_dwordx4 a[160:163], v2, s[8:11], s22 offen offset:0 sc1
  buffer_load_dwordx4 a[164:167], v2, s[8:11], s22 offen offset:1024 sc1
  buffer_load_dwordx4 a[168:171], v2, s[8:11], s22 offen offset:2048 sc1
  buffer_load_dwordx4 a[172:175], v2, s[8:11], s22 offen offset:3072 sc1
  s_add_u32 s22, s20, 45056
  buffer_load_dwordx4 a[176:179], v2, s[8:11], s22 offen offset:0 sc1
  buffer_load_dwordx4 a[180:183], v2, s[8:11], s22 offen offset:1024 sc1
  buffer_load_dwordx4 a[184:187], v2, s[8:11], s22 offen offset:2048 sc1
  buffer_load_dwordx4 a[188:191], v2, s[8:11], s22 offen offset:3072 sc1
  s_add_u32 s22, s20, 49152
  buffer_load_dwordx4 a[192:195], v2, s[8:11], s22 offen offset:0 sc1
  buffer_load_dwordx4 a[196:199], v2, s[8:11], s22 offen offset:1024 sc1
  buffer_load_dwordx4 a[200:203], v2, s[8:11], s22 offen offset:2048 sc1
  buffer_load_dwordx4 a[204:207], v2, s[8:11], s22 offen offset:3072 sc1
  s_add_u32 s22, s20, 53248
  buffer_load_dwordx4 a[208:211], v2, s[8:11], s22 offen offset:0 sc1
  buffer_load_dwordx4 a[212:215], v2, s[8:11], s22 offen offset:1024 sc1
  buffer_load_dwordx4 a[216:219], v2, s[8:11], s22 offen offset:2048 sc1
  buffer_load_dwordx4 a[220:223], v2, s[8:11], s22 offen offset:3072 sc1
  s_add_u32 s22, s20, 57344
  buffer_load_dwordx4 a[224:227], v2, s[8:11], s22 offen offset:0 sc1
  buffer_load_dwordx4 a[228:231], v2, s[8:11], s22 offen offset:1024 sc1
  buffer_load_dwordx4 a[232:235], v2, s[8:11], s22 offen offset:2048 sc1
  buffer_load_dwordx4 a[236:239], v2, s[8:11], s22 offen offset:3072 sc1
  s_add_u32 s22, s20, 61440
  buffer_load_dwordx4 a[240:243], v2, s[8:11], s22 offen offset:0 sc1
  buffer_load_dwordx4 a[244:247], v2, s[8:11], s22 offen offset:1024 sc1
  buffer_load_dwordx4 a[248:251], v2, s[8:11], s22 offen offset:2048 sc1
  buffer_load_dwordx4 a[252:255], v2, s[8:11], s22 offen offset:3072 sc1
  s_waitcnt vmcnt(24)
  s_add_u32 s22, s20, 65536
  buffer_load_dwordx4 v[120:123], v2, s[8:11], s22 offen offset:0 sc1
  buffer_load_dwordx4 v[124:127], v2, s[8:11], s22 offen offset:1024 sc1
  buffer_load_dwordx4 v[128:131], v2, s[8:11], s22 offen offset:2048 sc1
  buffer_load_dwordx4 v[132:135], v2, s[8:11], s22 offen offset:3072 sc1
  s_add_u32 s22, s20, 69632
  buffer_load_dwordx4 v[136:139], v2, s[8:11], s22 offen offset:0 sc1
  buffer_load_dwordx4 v[140:143], v2, s[8:11], s22 offen offset:1024 sc1
  buffer_load_dwordx4 v[144:147], v2, s[8:11], s22 offen offset:2048 sc1
  buffer_load_dwordx4 v[148:151], v2, s[8:11], s22 offen offset:3072 sc1
  s_add_u32 s22, s20, 73728
  buffer_load_dwordx4 v[152:155], v2, s[8:11], s22 offen offset:0 sc1
  buffer_load_dwordx4 v[156:159], v2, s[8:11], s22 offen offset:1024 sc1
  buffer_load_dwordx4 v[160:163], v2, s[8:11], s22 offen offset:2048 sc1
  buffer_load_dwordx4 v[164:167], v2, s[8:11], s22 offen offset:3072 sc1
  s_add_u32 s22, s20, 77824
  buffer_load_dwordx4 v[168:171], v2, s[8:11], s22 offen offset:0 sc1
  buffer_load_dwordx4 v[172:175], v2, s[8:11], s22 offen offset:1024 sc1
  buffer_load_dwordx4 v[176:179], v2, s[8:11], s22 offen offset:2048 sc1
  buffer_load_dwordx4 v[180:183], v2, s[8:11], s22 offen offset:3072 sc1
  s_add_u32 s22, s20, 81920
  buffer_load_dwordx4 v[184:187], v2, s[8:11], s22 offen offset:0 sc1
  buffer_load_dwordx4 v[188:191], v2, s[8:11], s22 offen offset:1024 sc1
  buffer_load_dwordx4 v[192:195], v2, s[8:11], s22 offen offset:2048 sc1
  buffer_load_dwordx4 v[196:199], v2, s[8:11], s22 offen offset:3072 sc1
  s_add_u32 s22, s20, 86016
  buffer_load_dwordx4 v[200:203], v2, s[8:11], s22 offen offset:0 sc1
  buffer_load_dwordx4 v[204:207], v2, s[8:11], s22 offen offset:1024 sc1
  buffer_load_dwordx4 v[208:211], v2, s[8:11], s22 offen offset:2048 sc1
  buffer_load_dwordx4 v[212:215], v2, s[8:11], s22 offen offset:3072 sc1
  s_add_u32 s22, s20, 90112
  buffer_load_dwordx4 v[216:219], v2, s[8:11], s22 offen offset:0 sc1
  buffer_load_dwordx4 v[220:223], v2, s[8:11], s22 offen offset:1024 sc1
  buffer_load_dwordx4 v[224:227], v2, s[8:11], s22 offen offset:2048 sc1
  buffer_load_dwordx4 v[228:231], v2, s[8:11], s22 offen offset:3072 sc1
  s_add_u32 s22, s20, 94208
  buffer_load_dwordx4 v[232:235], v2, s[8:11], s22 offen offset:0 sc1
  buffer_load_dwordx4 v[236:239], v2, s[8:11], s22 offen offset:1024 sc1
  buffer_load_dwordx4 v[240:243], v2, s[8:11], s22 offen offset:2048 sc1
  buffer_load_dwordx4 v[244:247], v2, s[8:11], s22 offen offset:3072 sc1
  s_waitcnt vmcnt(24)
  s_add_u32 s22, s20, 98304
  buffer_load_dwordx4 v[248:251], v2, s[8:11], s22 offen offset:0 sc1
  buffer_load_dwordx4 v[252:255], v2, s[8:11], s22 offen offset:1024 sc1
  v_mov_b32 v5, 0x4444
  v_mov_b32 v6, 0xeeee
  v_cmp_lt_u32 vcc, 7, v4
  s_nop 1
  v_cndmask_b32 v5, v5, v6, vcc
  s_lshl_b32 s23, s16, 11
  v_lshrrev_b32 v80, 1, v3
  v_and_b32 v81, 1, v3
  v_add_u32 v82, 0, v80
  v_lshl_add_u32 v82, v82, 4, v4
  v_mul_u32_u24 v83, 2341, v82
  v_lshrrev_b32 v83, 16, v83
  v_mul_u32_u24 v84, 28, v83
  v_sub_u32 v84, v82, v84
  v_lshrrev_b32 v85, 4, v84
  v_and_b32 v84, 15, v84
  v_lshlrev_b32 v86, 10, v85
  v_lshl_add_u32 v86, v83, 8, v86
  v_lshl_add_u32 v86, v84, 4, v86
  v_lshl_add_u32 v86, v81, 3, v86
  v_add_u32 v72, s23, v86
  v_add_u32 v82, 2, v80
  v_lshl_add_u32 v82, v82, 4, v4
  v_mul_u32_u24 v83, 2341, v82
  v_lshrrev_b32 v83, 16, v83
  v_mul_u32_u24 v84, 28, v83
  v_sub_u32 v84, v82, v84
  v_lshrrev_b32 v85, 4, v84
  v_and_b32 v84, 15, v84
  v_lshlrev_b32 v86, 10, v85
  v_lshl_add_u32 v86, v83, 8, v86
  v_lshl_add_u32 v86, v84, 4, v86
  v_lshl_add_u32 v86, v81, 3, v86
  v_add_u32 v73, s23, v86
  v_add_u32 v82, 4, v80
  v_lshl_add_u32 v82, v82, 4, v4
  v_mul_u32_u24 v83, 2341, v82
  v_lshrrev_b32 v83, 16, v83
  v_mul_u32_u24 v84, 28, v83
  v_sub_u32 v84, v82, v84
  v_lshrrev_b32 v85, 4, v84
  v_and_b32 v84, 15, v84
  v_lshlrev_b32 v86, 10, v85
  v_lshl_add_u32 v86, v83, 8, v86
  v_lshl_add_u32 v86, v84, 4, v86
  v_lshl_add_u32 v86, v81, 3, v86
  v_add_u32 v74, s23, v86
  v_mov_b32 v82, 6
  v_lshl_add_u32 v82, v82, 4, v4
  v_mul_u32_u24 v83, 2341, v82
  v_lshrrev_b32 v83, 16, v83
  v_mul_u32_u24 v84, 28, v83
  v_sub_u32 v84, v82, v84
  v_lshrrev_b32 v85, 4, v84
  v_and_b32 v84, 15, v84
  v_lshlrev_b32 v86, 10, v85
  v_lshl_add_u32 v86, v83, 8, v86
  v_lshl_add_u32 v86, v84, 4, v86
  v_lshl_add_u32 v86, v81, 3, v86
  v_add_u32 v75, s23, v86
  v_add_u32 v76, s23, v2
  s_mul_i32 s27, s18, 448
  v_mov_b32 v77, s27
  v_mov_b32 v78, 1
  s_mov_b32 s17, s19
  s_mul_i32 s24, s19, 7168
  s_add_u32 s24, s24, 88002560
  s_mul_i32 s25, s18, 65
  s_add_u32 s25, s25, s19
  s_lshl_b32 s25, s25, 13
  s_add_u32 s25, s25, s23
  s_add_u32 s25, s25, 76869632
  s_lshl_b32 s26, s18, 6
  s_add_u32 s26, s26, s19
  s_lshl_b32 s26, s26, 4
  s_lshl_b32 s27, s16, 2
  s_add_u32 s26, s26, s27
  s_add_u32 s26, s26, 88502272
ws_loop:
  v_mov_b32 v36, 0
  v_mov_b32 v37, 0
  v_mov_b32 v38, 0
  v_mov_b32 v39, 0
  v_mov_b32 v40, 0
  v_mov_b32 v41, 0
  v_mov_b32 v42, 0
  v_mov_b32 v43, 0
  v_mov_b32 v44, 0
  v_mov_b32 v45, 0
  v_mov_b32 v46, 0
  v_mov_b32 v47, 0
  v_mov_b32 v48, 0
  v_mov_b32 v49, 0
  v_mov_b32 v50, 0
  v_mov_b32 v51, 0
  v_mov_b32 v52, 0
  v_mov_b32 v53, 0
  v_mov_b32 v54, 0
  v_mov_b32 v55, 0
  v_mov_b32 v56, 0
  v_mov_b32 v57, 0
  v_mov_b32 v58, 0
  v_mov_b32 v59, 0
  v_mov_b32 v60, 0
  v_mov_b32 v61, 0
  v_mov_b32 v62, 0
  v_mov_b32 v63, 0
  s_mov_b32 s30, 0
  s_branch ws_fl
ws_pm:
  buffer_load_dword v79, v77, s[8:11], s24 offen sc1
  s_waitcnt vmcnt(0)
  v_cmp_eq_u32 vcc, -1, v79
  s_cbranch_vccnz ws_pr
ws_fl:
  s_add_u32 s22, s24, 4096
  buffer_load_dwordx4 v[8:11], v2, s[8:11], s24 offen offset:0 sc1
  buffer_load_dwordx4 v[12:15], v2, s[8:11], s24 offen offset:1024 sc1
  buffer_load_dwordx4 v[16:19], v2, s[8:11], s24 offen offset:2048 sc1
  buffer_load_dwordx4 v[20:23], v2, s[8:11], s24 offen offset:3072 sc1
  buffer_load_dwordx4 v[24:27], v2, s[8:11], s22 offen offset:0 sc1
  buffer_load_dwordx4 v[28:31], v2, s[8:11], s22 offen offset:1024 sc1
  buffer_load_dwordx4 v[32:35], v2, s[8:11], s22 offen offset:2048 sc1
  s_waitcnt vmcnt(0)
  v_max_u32 v79, v8, v9
  v_max3_u32 v79, v79, v10, v11
  v_max3_u32 v79, v79, v12, v13
  v_max3_u32 v79, v79, v14, v15
  v_max3_u32 v79, v79, v16, v17
  v_max3_u32 v79, v79, v18, v19
  v_max3_u32 v79, v79, v20, v21
  v_max3_u32 v79, v79, v22, v23
  v_max3_u32 v79, v79, v24, v25
  v_max3_u32 v79, v79, v26, v27
  v_max3_u32 v79, v79, v28, v29
  v_max3_u32 v79, v79, v30, v31
  v_max3_u32 v79, v79, v32, v33
  v_max3_u32 v79, v79, v34, v35
  v_cmp_eq_u32 vcc, -1, v79
  s_cbranch_vccz ws_pk
ws_pr:
  s_sleep 6
  s_add_u32 s30, s30, 1
  s_cmp_lt_u32 s30, 2000000
  s_cbranch_scc1 ws_pm
  s_branch cA_abort
ws_pk:
  v_smfmac_f32_16x16x64_bf16 v[36:39], v[8:11], a[0:7], v5
  v_smfmac_f32_16x16x64_bf16 v[36:39], v[12:15], a[8:15], v5
  v_smfmac_f32_16x16x64_bf16 v[36:39], v[16:19], a[16:23], v5
  v_smfmac_f32_16x16x64_bf16 v[36:39], v[20:23], a[24:31], v5
  v_smfmac_f32_16x16x64_bf16 v[36:39], v[24:27], a[32:39], v5
  v_smfmac_f32_16x16x64_bf16 v[36:39], v[28:31], a[40:47], v5
  v_smfmac_f32_16x16x64_bf16 v[36:39], v[32:35], a[48:55], v5
  v_smfmac_f32_16x16x64_bf16 v[40:43], v[8:11], a[56:63], v5
  v_smfmac_f32_16x16x64_bf16 v[40:43], v[12:15], a[64:71], v5
  v_smfmac_f32_16x16x64_bf16 v[40:43], v[16:19], a[72:79], v5
  v_smfmac_f32_16x16x64_bf16 v[40:43], v[20:23], a[80:87], v5
  v_smfmac_f32_16x16x64_bf16 v[40:43], v[24:27], a[88:95], v5
  v_smfmac_f32_16x16x64_bf16 v[40:43], v[28:31], a[96:103], v5
  v_smfmac_f32_16x16x64_bf16 v[40:43], v[32:35], a[104:111], v5
  v_smfmac_f32_16x16x64_bf16 v[44:47], v[8:11], a[112:119], v5
  v_smfmac_f32_16x16x64_bf16 v[44:47], v[12:15], a[120:127], v5
  v_smfmac_f32_16x16x64_bf16 v[44:47], v[16:19], a[128:135], v5
  v_smfmac_f32_16x16x64_bf16 v[44:47], v[20:23], a[136:143], v5
  v_smfmac_f32_16x16x64_bf16 v[44:47], v[24:27], a[144:151], v5
  v_smfmac_f32_16x16x64_bf16 v[44:47], v[28:31], a[152:159], v5
  v_smfmac_f32_16x16x64_bf16 v[44:47], v[32:35], a[160:167], v5
  v_smfmac_f32_16x16x64_bf16 v[48:51], v[8:11], a[168:175], v5
  v_smfmac_f32_16x16x64_bf16 v[48:51], v[12:15], a[176:183], v5
  v_smfmac_f32_16x16x64_bf16 v[48:51], v[16:19], a[184:191], v5
  v_smfmac_f32_16x16x64_bf16 v[48:51], v[20:23], a[192:199], v5
  v_smfmac_f32_16x16x64_bf16 v[48:51], v[24:27], a[200:207], v5
  v_smfmac_f32_16x16x64_bf16 v[48:51], v[28:31], a[208:215], v5
  v_smfmac_f32_16x16x64_bf16 v[48:51], v[32:35], a[216:223], v5
  v_smfmac_f32_16x16x64_bf16 v[52:55], v[8:11], a[224:231], v5
  v_smfmac_f32_16x16x64_bf16 v[52:55], v[12:15], a[232:239], v5
  v_smfmac_f32_16x16x64_bf16 v[52:55], v[16:19], a[240:247], v5
  v_smfmac_f32_16x16x64_bf16 v[52:55], v[20:23], a[248:255], v5
  v_smfmac_f32_16x16x64_bf16 v[52:55], v[24:27], v[120:127], v5
  v_smfmac_f32_16x16x64_bf16 v[52:55], v[28:31], v[128:135], v5
  v_smfmac_f32_16x16x64_bf16 v[52:55], v[32:35], v[136:143], v5
  v_smfmac_f32_16x16x64_bf16 v[56:59], v[8:11], v[144:151], v5
  v_smfmac_f32_16x16x64_bf16 v[56:59], v[12:15], v[152:159], v5
  v_smfmac_f32_16x16x64_bf16 v[56:59], v[16:19], v[160:167], v5
  v_smfmac_f32_16x16x64_bf16 v[56:59], v[20:23], v[168:175], v5
  v_smfmac_f32_16x16x64_bf16 v[56:59], v[24:27], v[176:183], v5
  v_smfmac_f32_16x16x64_bf16 v[56:59], v[28:31], v[184:191], v5
  v_smfmac_f32_16x16x64_bf16 v[56:59], v[32:35], v[192:199], v5
  v_smfmac_f32_16x16x64_bf16 v[60:63], v[8:11], v[200:207], v5
  v_smfmac_f32_16x16x64_bf16 v[60:63], v[12:15], v[208:215], v5
  v_smfmac_f32_16x16x64_bf16 v[60:63], v[16:19], v[216:223], v5
  v_smfmac_f32_16x16x64_bf16 v[60:63], v[20:23], v[224:231], v5
  v_smfmac_f32_16x16x64_bf16 v[60:63], v[24:27], v[232:239], v5
  v_smfmac_f32_16x16x64_bf16 v[60:63], v[28:31], v[240:247], v5
  v_smfmac_f32_16x16x64_bf16 v[60:63], v[32:35], v[248:255], v5
  v_permlane32_swap_b32 v36, v40
  v_permlane32_swap_b32 v37, v41
  v_permlane32_swap_b32 v38, v42
  v_permlane32_swap_b32 v39, v43
  v_add_f32 v36, v36, v40
  v_add_f32 v37, v37, v41
  v_add_f32 v38, v38, v42
  v_add_f32 v39, v39, v43
  v_cvt_pk_bf16_f32 v40, v36, v37
  v_cvt_pk_bf16_f32 v41, v38, v39
  ds_write_b64 v72, v[40:41]
  v_permlane32_swap_b32 v44, v48
  v_permlane32_swap_b32 v45, v49
  v_permlane32_swap_b32 v46, v50
  v_permlane32_swap_b32 v47, v51
  v_add_f32 v44, v44, v48
  v_add_f32 v45, v45, v49
  v_add_f32 v46, v46, v50
  v_add_f32 v47, v47, v51
  v_cvt_pk_bf16_f32 v48, v44, v45
  v_cvt_pk_bf16_f32 v49, v46, v47
  ds_write_b64 v73, v[48:49]
  v_permlane32_swap_b32 v52, v56
  v_permlane32_swap_b32 v53, v57
  v_permlane32_swap_b32 v54, v58
  v_permlane32_swap_b32 v55, v59
  v_add_f32 v52, v52, v56
  v_add_f32 v53, v53, v57
  v_add_f32 v54, v54, v58
  v_add_f32 v55, v55, v59
  v_cvt_pk_bf16_f32 v56, v52, v53
  v_cvt_pk_bf16_f32 v57, v54, v55
  ds_write_b64 v74, v[56:57]
  v_mov_b32 v64, v60
  v_mov_b32 v65, v61
  v_mov_b32 v66, v62
  v_mov_b32 v67, v63
  v_permlane32_swap_b32 v60, v64
  v_permlane32_swap_b32 v61, v65
  v_permlane32_swap_b32 v62, v66
  v_permlane32_swap_b32 v63, v67
  v_add_f32 v60, v60, v64
  v_add_f32 v61, v61, v65
  v_add_f32 v62, v62, v66
  v_add_f32 v63, v63, v67
  v_cvt_pk_bf16_f32 v64, v60, v61
  v_cvt_pk_bf16_f32 v65, v62, v63
  ds_write_b64 v75, v[64:65]
  s_waitcnt lgkmcnt(0)
  ds_read_b128 v[64:67], v76
  ds_read_b128 v[68:71], v76 offset:1024
  s_waitcnt lgkmcnt(0)
  buffer_store_dwordx4 v[64:67], v2, s[8:11], s25 offen sc1
  buffer_store_dwordx4 v[68:71], v2, s[8:11], s25 offen offset:1024 sc1
  s_waitcnt vmcnt(0)
  s_mov_b64 exec, 1
  buffer_store_dword v78, v2, s[8:11], s26 offen sc1
  s_mov_b64 exec, -1
  s_add_u32 s24, s24, 14336
  s_add_u32 s25, s25, 16384
  s_add_u32 s26, s26, 32
  s_add_u32 s17, s17, 2
  s_cmp_lt_u32 s17, 64
  s_cbranch_scc1 ws_loop
  v_mov_b32 v250, 0
  s_branch wk_loop
wk_s4d:
  s_sub_u32 s3, s3, 624
  s_load_dwordx8 s[40:47], s[0:1], 0
  s_load_dwordx4 s[48:51], s[0:1], 32
  s_load_dwordx2 s[52:53], s[0:1], 48
  s_load_dwordx2 s[54:55], s[0:1], 112
  v_lshrrev_b32 v1, 6, v0
  s_nop 0
  v_readfirstlane_b32 s16, v1
  v_and_b32 v1, 63, v0
  v_lshrrev_b32 v3, 4, v1
  v_and_b32 v4, 15, v1
  s_mul_i32 s17, s16, 24576
  s_waitcnt lgkmcnt(0)
  s_mov_b32 s60, s40
  s_and_b32 s61, s41, 0xffff
  s_mov_b32 s62, 1835008
  s_mov_b32 s63, 0x20000
  s_mov_b32 s64, s42
  s_and_b32 s65, s43, 0xffff
  s_mov_b32 s66, 229376
  s_mov_b32 s67, 0x20000
  s_mov_b32 s68, s44
  s_and_b32 s69, s45, 0xffff
  s_mov_b32 s70, 229376
  s_mov_b32 s71, 0x20000
  s_mov_b32 s72, s46
  s_and_b32 s73, s47, 0xffff
  s_mov_b32 s74, 229376
  s_mov_b32 s75, 0x20000
  s_mov_b32 s76, s48
  s_and_b32 s77, s49, 0xffff
  s_mov_b32 s78, 229376
  s_mov_b32 s79, 0x20000
  s_mov_b32 s80, s50
  s_and_b32 s81, s51, 0xffff
  s_mov_b32 s82, 896
  s_mov_b32 s83, 0x20000
  s_mov_b32 s84, s52
  s_and_b32 s85, s53, 0xffff
  s_mov_b32 s86, 896
  s_mov_b32 s87, 0x20000
  s_mov_b32 s88, s54
  s_and_b32 s89, s55, 0xffff
  s_mov_b32 s90, 3670016
  s_mov_b32 s91, 0x20000
  v_lshlrev_b32 v5, 5, v1
  v_sub_u32 v5, 2047, v5
  s_add_u32 s18, s17, 13056
  v_subrev_u32 v6, 0, v5
  v_max_i32 v7, 0, v6
  v_cvt_f32_u32 v7, v7
  v_cvt_pk_bf16_f32 v8, v7, v7
  v_and_b32 v7, 0xffff0000, v8
  v_lshrrev_b32 v8, 23, v7
  v_subrev_u32 v8, 134, v8
  v_max_i32 v8, 0, v8
  v_cvt_u32_f32 v7, v7
  v_lshrrev_b32 v7, v8, v7
  v_lshl_add_u32 v7, v8, 8, v7
  v_lshl_add_u32 v200, v7, 2, s18
  v_subrev_u32 v6, 1, v5
  v_max_i32 v7, 0, v6
  v_cvt_f32_u32 v7, v7
  v_cvt_pk_bf16_f32 v8, v7, v7
  v_and_b32 v7, 0xffff0000, v8
  v_lshrrev_b32 v8, 23, v7
  v_subrev_u32 v8, 134, v8
  v_max_i32 v8, 0, v8
  v_cvt_u32_f32 v7, v7
  v_lshrrev_b32 v7, v8, v7
  v_lshl_add_u32 v7, v8, 8, v7
  v_lshl_add_u32 v201, v7, 2, s18
  v_subrev_u32 v6, 2, v5
  v_max_i32 v7, 0, v6
  v_cvt_f32_u32 v7, v7
  v_cvt_pk_bf16_f32 v8, v7, v7
  v_and_b32 v7, 0xffff0000, v8
  v_lshrrev_b32 v8, 23, v7
  v_subrev_u32 v8, 134, v8
  v_max_i32 v8, 0, v8
  v_cvt_u32_f32 v7, v7
  v_lshrrev_b32 v7, v8, v7
  v_lshl_add_u32 v7, v8, 8, v7
  v_lshl_add_u32 v202, v7, 2, s18
  v_subrev_u32 v6, 3, v5
  v_max_i32 v7, 0, v6
  v_cvt_f32_u32 v7, v7
  v_cvt_pk_bf16_f32 v8, v7, v7
  v_and_b32 v7, 0xffff0000, v8
  v_lshrrev_b32 v8, 23, v7
  v_subrev_u32 v8, 134, v8
  v_max_i32 v8, 0, v8
  v_cvt_u32_f32 v7, v7
  v_lshrrev_b32 v7, v8, v7
  v_lshl_add_u32 v7, v8, 8, v7
  v_lshl_add_u32 v203, v7, 2, s18
  v_subrev_u32 v6, 4, v5
  v_max_i32 v7, 0, v6
  v_cvt_f32_u32 v7, v7
  v_cvt_pk_bf16_f32 v8, v7, v7
  v_and_b32 v7, 0xffff0000, v8
  v_lshrrev_b32 v8, 23, v7
  v_subrev_u32 v8, 134, v8
  v_max_i32 v8, 0, v8
  v_cvt_u32_f32 v7, v7
  v_lshrrev_b32 v7, v8, v7
  v_lshl_add_u32 v7, v8, 8, v7
  v_lshl_add_u32 v204, v7, 2, s18
  v_subrev_u32 v6, 5, v5
  v_max_i32 v7, 0, v6
  v_cvt_f32_u32 v7, v7
  v_cvt_pk_bf16_f32 v8, v7, v7
  v_and_b32 v7, 0xffff0000, v8
  v_lshrrev_b32 v8, 23, v7
  v_subrev_u32 v8, 134, v8
  v_max_i32 v8, 0, v8
  v_cvt_u32_f32 v7, v7
  v_lshrrev_b32 v7, v8, v7
  v_lshl_add_u32 v7, v8, 8, v7
  v_lshl_add_u32 v205, v7, 2, s18
  v_subrev_u32 v6, 6, v5
  v_max_i32 v7, 0, v6
  v_cvt_f32_u32 v7, v7
  v_cvt_pk_bf16_f32 v8, v7, v7
  v_and_b32 v7, 0xffff0000, v8
  v_lshrrev_b32 v8, 23, v7
  v_subrev_u32 v8, 134, v8
  v_max_i32 v8, 0, v8
  v_cvt_u32_f32 v7, v7
  v_lshrrev_b32 v7, v8, v7
  v_lshl_add_u32 v7, v8, 8, v7
  v_lshl_add_u32 v206, v7, 2, s18
  v_subrev_u32 v6, 7, v5
  v_max_i32 v7, 0, v6
  v_cvt_f32_u32 v7, v7
  v_cvt_pk_bf16_f32 v8, v7, v7
  v_and_b32 v7, 0xffff0000, v8
  v_lshrrev_b32 v8, 23, v7
  v_subrev_u32 v8, 134, v8
  v_max_i32 v8, 0, v8
  v_cvt_u32_f32 v7, v7
  v_lshrrev_b32 v7, v8, v7
  v_lshl_add_u32 v7, v8, 8, v7
  v_lshl_add_u32 v207, v7, 2, s18
  v_subrev_u32 v6, 8, v5
  v_max_i32 v7, 0, v6
  v_cvt_f32_u32 v7, v7
  v_cvt_pk_bf16_f32 v8, v7, v7
  v_and_b32 v7, 0xffff0000, v8
  v_lshrrev_b32 v8, 23, v7
  v_subrev_u32 v8, 134, v8
  v_max_i32 v8, 0, v8
  v_cvt_u32_f32 v7, v7
  v_lshrrev_b32 v7, v8, v7
  v_lshl_add_u32 v7, v8, 8, v7
  v_lshl_add_u32 v208, v7, 2, s18
  v_subrev_u32 v6, 9, v5
  v_max_i32 v7, 0, v6
  v_cvt_f32_u32 v7, v7
  v_cvt_pk_bf16_f32 v8, v7, v7
  v_and_b32 v7, 0xffff0000, v8
  v_lshrrev_b32 v8, 23, v7
  v_subrev_u32 v8, 134, v8
  v_max_i32 v8, 0, v8
  v_cvt_u32_f32 v7, v7
  v_lshrrev_b32 v7, v8, v7
  v_lshl_add_u32 v7, v8, 8, v7
  v_lshl_add_u32 v209, v7, 2, s18
  v_subrev_u32 v6, 10, v5
  v_max_i32 v7, 0, v6
  v_cvt_f32_u32 v7, v7
  v_cvt_pk_bf16_f32 v8, v7, v7
  v_and_b32 v7, 0xffff0000, v8
  v_lshrrev_b32 v8, 23, v7
  v_subrev_u32 v8, 134, v8
  v_max_i32 v8, 0, v8
  v_cvt_u32_f32 v7, v7
  v_lshrrev_b32 v7, v8, v7
  v_lshl_add_u32 v7, v8, 8, v7
  v_lshl_add_u32 v210, v7, 2, s18
  v_subrev_u32 v6, 11, v5
  v_max_i32 v7, 0, v6
  v_cvt_f32_u32 v7, v7
  v_cvt_pk_bf16_f32 v8, v7, v7
  v_and_b32 v7, 0xffff0000, v8
  v_lshrrev_b32 v8, 23, v7
  v_subrev_u32 v8, 134, v8
  v_max_i32 v8, 0, v8
  v_cvt_u32_f32 v7, v7
  v_lshrrev_b32 v7, v8, v7
  v_lshl_add_u32 v7, v8, 8, v7
  v_lshl_add_u32 v211, v7, 2, s18
  v_subrev_u32 v6, 12, v5
  v_max_i32 v7, 0, v6
  v_cvt_f32_u32 v7, v7
  v_cvt_pk_bf16_f32 v8, v7, v7
  v_and_b32 v7, 0xffff0000, v8
  v_lshrrev_b32 v8, 23, v7
  v_subrev_u32 v8, 134, v8
  v_max_i32 v8, 0, v8
  v_cvt_u32_f32 v7, v7
  v_lshrrev_b32 v7, v8, v7
  v_lshl_add_u32 v7, v8, 8, v7
  v_lshl_add_u32 v212, v7, 2, s18
  v_subrev_u32 v6, 13, v5
  v_max_i32 v7, 0, v6
  v_cvt_f32_u32 v7, v7
  v_cvt_pk_bf16_f32 v8, v7, v7
  v_and_b32 v7, 0xffff0000, v8
  v_lshrrev_b32 v8, 23, v7
  v_subrev_u32 v8, 134, v8
  v_max_i32 v8, 0, v8
  v_cvt_u32_f32 v7, v7
  v_lshrrev_b32 v7, v8, v7
  v_lshl_add_u32 v7, v8, 8, v7
  v_lshl_add_u32 v213, v7, 2, s18
  v_subrev_u32 v6, 14, v5
  v_max_i32 v7, 0, v6
  v_cvt_f32_u32 v7, v7
  v_cvt_pk_bf16_f32 v8, v7, v7
  v_and_b32 v7, 0xffff0000, v8
  v_lshrrev_b32 v8, 23, v7
  v_subrev_u32 v8, 134, v8
  v_max_i32 v8, 0, v8
  v_cvt_u32_f32 v7, v7
  v_lshrrev_b32 v7, v8, v7
  v_lshl_add_u32 v7, v8, 8, v7
  v_lshl_add_u32 v214, v7, 2, s18
  v_subrev_u32 v6, 15, v5
  v_max_i32 v7, 0, v6
  v_cvt_f32_u32 v7, v7
  v_cvt_pk_bf16_f32 v8, v7, v7
  v_and_b32 v7, 0xffff0000, v8
  v_lshrrev_b32 v8, 23, v7
  v_subrev_u32 v8, 134, v8
  v_max_i32 v8, 0, v8
  v_cvt_u32_f32 v7, v7
  v_lshrrev_b32 v7, v8, v7
  v_lshl_add_u32 v7, v8, 8, v7
  v_lshl_add_u32 v215, v7, 2, s18
  v_subrev_u32 v6, 16, v5
  v_max_i32 v7, 0, v6
  v_cvt_f32_u32 v7, v7
  v_cvt_pk_bf16_f32 v8, v7, v7
  v_and_b32 v7, 0xffff0000, v8
  v_lshrrev_b32 v8, 23, v7
  v_subrev_u32 v8, 134, v8
  v_max_i32 v8, 0, v8
  v_cvt_u32_f32 v7, v7
  v_lshrrev_b32 v7, v8, v7
  v_lshl_add_u32 v7, v8, 8, v7
  v_lshl_add_u32 v216, v7, 2, s18
  v_subrev_u32 v6, 17, v5
  v_max_i32 v7, 0, v6
  v_cvt_f32_u32 v7, v7
  v_cvt_pk_bf16_f32 v8, v7, v7
  v_and_b32 v7, 0xffff0000, v8
  v_lshrrev_b32 v8, 23, v7
  v_subrev_u32 v8, 134, v8
  v_max_i32 v8, 0, v8
  v_cvt_u32_f32 v7, v7
  v_lshrrev_b32 v7, v8, v7
  v_lshl_add_u32 v7, v8, 8, v7
  v_lshl_add_u32 v217, v7, 2, s18
  v_subrev_u32 v6, 18, v5
  v_max_i32 v7, 0, v6
  v_cvt_f32_u32 v7, v7
  v_cvt_pk_bf16_f32 v8, v7, v7
  v_and_b32 v7, 0xffff0000, v8
  v_lshrrev_b32 v8, 23, v7
  v_subrev_u32 v8, 134, v8
  v_max_i32 v8, 0, v8
  v_cvt_u32_f32 v7, v7
  v_lshrrev_b32 v7, v8, v7
  v_lshl_add_u32 v7, v8, 8, v7
  v_lshl_add_u32 v218, v7, 2, s18
  v_subrev_u32 v6, 19, v5
  v_max_i32 v7, 0, v6
  v_cvt_f32_u32 v7, v7
  v_cvt_pk_bf16_f32 v8, v7, v7
  v_and_b32 v7, 0xffff0000, v8
  v_lshrrev_b32 v8, 23, v7
  v_subrev_u32 v8, 134, v8
  v_max_i32 v8, 0, v8
  v_cvt_u32_f32 v7, v7
  v_lshrrev_b32 v7, v8, v7
  v_lshl_add_u32 v7, v8, 8, v7
  v_lshl_add_u32 v219, v7, 2, s18
  v_subrev_u32 v6, 20, v5
  v_max_i32 v7, 0, v6
  v_cvt_f32_u32 v7, v7
  v_cvt_pk_bf16_f32 v8, v7, v7
  v_and_b32 v7, 0xffff0000, v8
  v_lshrrev_b32 v8, 23, v7
  v_subrev_u32 v8, 134, v8
  v_max_i32 v8, 0, v8
  v_cvt_u32_f32 v7, v7
  v_lshrrev_b32 v7, v8, v7
  v_lshl_add_u32 v7, v8, 8, v7
  v_lshl_add_u32 v220, v7, 2, s18
  v_subrev_u32 v6, 21, v5
  v_max_i32 v7, 0, v6
  v_cvt_f32_u32 v7, v7
  v_cvt_pk_bf16_f32 v8, v7, v7
  v_and_b32 v7, 0xffff0000, v8
  v_lshrrev_b32 v8, 23, v7
  v_subrev_u32 v8, 134, v8
  v_max_i32 v8, 0, v8
  v_cvt_u32_f32 v7, v7
  v_lshrrev_b32 v7, v8, v7
  v_lshl_add_u32 v7, v8, 8, v7
  v_lshl_add_u32 v221, v7, 2, s18
  v_subrev_u32 v6, 22, v5
  v_max_i32 v7, 0, v6
  v_cvt_f32_u32 v7, v7
  v_cvt_pk_bf16_f32 v8, v7, v7
  v_and_b32 v7, 0xffff0000, v8
  v_lshrrev_b32 v8, 23, v7
  v_subrev_u32 v8, 134, v8
  v_max_i32 v8, 0, v8
  v_cvt_u32_f32 v7, v7
  v_lshrrev_b32 v7, v8, v7
  v_lshl_add_u32 v7, v8, 8, v7
  v_lshl_add_u32 v222, v7, 2, s18
  v_subrev_u32 v6, 23, v5
  v_max_i32 v7, 0, v6
  v_cvt_f32_u32 v7, v7
  v_cvt_pk_bf16_f32 v8, v7, v7
  v_and_b32 v7, 0xffff0000, v8
  v_lshrrev_b32 v8, 23, v7
  v_subrev_u32 v8, 134, v8
  v_max_i32 v8, 0, v8
  v_cvt_u32_f32 v7, v7
  v_lshrrev_b32 v7, v8, v7
  v_lshl_add_u32 v7, v8, 8, v7
  v_lshl_add_u32 v223, v7, 2, s18
  v_subrev_u32 v6, 24, v5
  v_max_i32 v7, 0, v6
  v_cvt_f32_u32 v7, v7
  v_cvt_pk_bf16_f32 v8, v7, v7
  v_and_b32 v7, 0xffff0000, v8
  v_lshrrev_b32 v8, 23, v7
  v_subrev_u32 v8, 134, v8
  v_max_i32 v8, 0, v8
  v_cvt_u32_f32 v7, v7
  v_lshrrev_b32 v7, v8, v7
  v_lshl_add_u32 v7, v8, 8, v7
  v_lshl_add_u32 v224, v7, 2, s18
  v_subrev_u32 v6, 25, v5
  v_max_i32 v7, 0, v6
  v_cvt_f32_u32 v7, v7
  v_cvt_pk_bf16_f32 v8, v7, v7
  v_and_b32 v7, 0xffff0000, v8
  v_lshrrev_b32 v8, 23, v7
  v_subrev_u32 v8, 134, v8
  v_max_i32 v8, 0, v8
  v_cvt_u32_f32 v7, v7
  v_lshrrev_b32 v7, v8, v7
  v_lshl_add_u32 v7, v8, 8, v7
  v_lshl_add_u32 v225, v7, 2, s18
  v_subrev_u32 v6, 26, v5
  v_max_i32 v7, 0, v6
  v_cvt_f32_u32 v7, v7
  v_cvt_pk_bf16_f32 v8, v7, v7
  v_and_b32 v7, 0xffff0000, v8
  v_lshrrev_b32 v8, 23, v7
  v_subrev_u32 v8, 134, v8
  v_max_i32 v8, 0, v8
  v_cvt_u32_f32 v7, v7
  v_lshrrev_b32 v7, v8, v7
  v_lshl_add_u32 v7, v8, 8, v7
  v_lshl_add_u32 v226, v7, 2, s18
  v_subrev_u32 v6, 27, v5
  v_max_i32 v7, 0, v6
  v_cvt_f32_u32 v7, v7
  v_cvt_pk_bf16_f32 v8, v7, v7
  v_and_b32 v7, 0xffff0000, v8
  v_lshrrev_b32 v8, 23, v7
  v_subrev_u32 v8, 134, v8
  v_max_i32 v8, 0, v8
  v_cvt_u32_f32 v7, v7
  v_lshrrev_b32 v7, v8, v7
  v_lshl_add_u32 v7, v8, 8, v7
  v_lshl_add_u32 v227, v7, 2, s18
  v_subrev_u32 v6, 28, v5
  v_max_i32 v7, 0, v6
  v_cvt_f32_u32 v7, v7
  v_cvt_pk_bf16_f32 v8, v7, v7
  v_and_b32 v7, 0xffff0000, v8
  v_lshrrev_b32 v8, 23, v7
  v_subrev_u32 v8, 134, v8
  v_max_i32 v8, 0, v8
  v_cvt_u32_f32 v7, v7
  v_lshrrev_b32 v7, v8, v7
  v_lshl_add_u32 v7, v8, 8, v7
  v_lshl_add_u32 v228, v7, 2, s18
  v_subrev_u32 v6, 29, v5
  v_max_i32 v7, 0, v6
  v_cvt_f32_u32 v7, v7
  v_cvt_pk_bf16_f32 v8, v7, v7
  v_and_b32 v7, 0xffff0000, v8
  v_lshrrev_b32 v8, 23, v7
  v_subrev_u32 v8, 134, v8
  v_max_i32 v8, 0, v8
  v_cvt_u32_f32 v7, v7
  v_lshrrev_b32 v7, v8, v7
  v_lshl_add_u32 v7, v8, 8, v7
  v_lshl_add_u32 v229, v7, 2, s18
  v_subrev_u32 v6, 30, v5
  v_max_i32 v7, 0, v6
  v_cvt_f32_u32 v7, v7
  v_cvt_pk_bf16_f32 v8, v7, v7
  v_and_b32 v7, 0xffff0000, v8
  v_lshrrev_b32 v8, 23, v7
  v_subrev_u32 v8, 134, v8
  v_max_i32 v8, 0, v8
  v_cvt_u32_f32 v7, v7
  v_lshrrev_b32 v7, v8, v7
  v_lshl_add_u32 v7, v8, 8, v7
  v_lshl_add_u32 v230, v7, 2, s18
  v_subrev_u32 v6, 31, v5
  v_max_i32 v7, 0, v6
  v_cvt_f32_u32 v7, v7
  v_cvt_pk_bf16_f32 v8, v7, v7
  v_and_b32 v7, 0xffff0000, v8
  v_lshrrev_b32 v8, 23, v7
  v_subrev_u32 v8, 134, v8
  v_max_i32 v8, 0, v8
  v_cvt_u32_f32 v7, v7
  v_lshrrev_b32 v7, v8, v7
  v_lshl_add_u32 v7, v8, 8, v7
  v_lshl_add_u32 v231, v7, 2, s18
  v_subrev_u32 v6, 32, v5
  v_max_i32 v7, 0, v6
  v_cvt_f32_u32 v7, v7
  v_cvt_pk_bf16_f32 v8, v7, v7
  v_and_b32 v7, 0xffff0000, v8
  v_lshrrev_b32 v8, 23, v7
  v_subrev_u32 v8, 134, v8
  v_max_i32 v8, 0, v8
  v_cvt_u32_f32 v7, v7
  v_lshrrev_b32 v7, v8, v7
  v_lshl_add_u32 v7, v8, 8, v7
  v_mov_b32 v8, 1280
  v_cmp_gt_i32 vcc, 0, v6
  s_nop 1
  v_cndmask_b32 v7, v7, v8, vcc
  v_lshl_add_u32 v232, v7, 2, s18
  v_mov_b32 v8, 0
  v_mov_b32 v9, 0
  v_lshlrev_b32 v5, 3, v1
  v_add_u32 v5, s17, v5
  ds_write_b64 v5, v[8:9]
  v_and_b32 v6, 15, v1
  v_lshlrev_b32 v6, 3, v6
  v_add_u32 v6, s17, v6
  ds_write_b64 v6, v[8:9] offset:8704
  ds_write_b64 v6, v[8:9] offset:12928
  v_mov_b32 v6, s17
  ds_write_b64 v6, v[8:9] offset:18176
  s_lshl_b32 s19, s3, 2
  s_add_u32 s20, s19, s16
  s_lshl_b32 s21, s3, 3
  v_mul_u32_u24 v5, 3584, v0
  s_add_u32 s22, s21, 0
  buffer_load_dwordx2 v[8:9], v5, s[60:63], s22 offen offset:0
  buffer_load_dwordx2 v[10:11], v5, s[60:63], s22 offen offset:896
  buffer_load_dwordx2 v[12:13], v5, s[60:63], s22 offen offset:1792
  buffer_load_dwordx2 v[14:15], v5, s[60:63], s22 offen offset:2688
  s_add_u32 s22, s21, 917504
  buffer_load_dwordx2 v[16:17], v5, s[60:63], s22 offen offset:0
  buffer_load_dwordx2 v[18:19], v5, s[60:63], s22 offen offset:896
  buffer_load_dwordx2 v[20:21], v5, s[60:63], s22 offen offset:1792
  buffer_load_dwordx2 v[22:23], v5, s[60:63], s22 offen offset:2688
  s_lshl_b32 s22, s20, 9
  v_lshlrev_b32 v6, 3, v1
  buffer_load_dwordx2 v[24:25], v6, s[64:67], s22 offen
  buffer_load_dwordx2 v[26:27], v6, s[68:71], s22 offen
  buffer_load_dwordx2 v[28:29], v6, s[72:75], s22 offen
  buffer_load_dwordx2 v[30:31], v6, s[76:79], s22 offen
  s_lshl_b32 s22, s20, 1
  v_mov_b32 v7, 0
  buffer_load_ushort v32, v7, s[80:83], s22 offen
  buffer_load_ushort v33, v7, s[84:87], s22 offen
  s_mov_b32 s24, 0x05040100
  s_mov_b32 s25, 0x07060302
  s_barrier
  s_waitcnt vmcnt(6)
  v_lshlrev_b32 v6, 3, v0
  v_perm_b32 v34, v10, v8, s24
  v_perm_b32 v35, v14, v12, s24
  v_add_u32 v36, 512, v6
  ds_write_b64 v36, v[34:35]
  v_perm_b32 v34, v10, v8, s25
  v_perm_b32 v35, v14, v12, s25
  v_add_u32 v36, 25088, v6
  ds_write_b64 v36, v[34:35]
  v_perm_b32 v34, v11, v9, s24
  v_perm_b32 v35, v15, v13, s24
  v_add_u32 v36, 49664, v6
  ds_write_b64 v36, v[34:35]
  v_perm_b32 v34, v11, v9, s25
  v_perm_b32 v35, v15, v13, s25
  v_add_u32 v36, 74240, v6
  ds_write_b64 v36, v[34:35]
  v_perm_b32 v34, v18, v16, s24
  v_perm_b32 v35, v22, v20, s24
  v_add_u32 v36, 2560, v6
  ds_write_b64 v36, v[34:35]
  v_perm_b32 v34, v18, v16, s25
  v_perm_b32 v35, v22, v20, s25
  v_add_u32 v36, 27136, v6
  ds_write_b64 v36, v[34:35]
  v_perm_b32 v34, v19, v17, s24
  v_perm_b32 v35, v23, v21, s24
  v_add_u32 v36, 51712, v6
  ds_write_b64 v36, v[34:35]
  v_perm_b32 v34, v19, v17, s25
  v_perm_b32 v35, v23, v21, s25
  v_add_u32 v36, 76288, v6
  ds_write_b64 v36, v[34:35]
  s_waitcnt vmcnt(0)
  s_mov_b32 s26, 1069066811
  s_mov_b32 s27, 1042479491
  v_lshlrev_b32 v32, 16, v32
  v_lshlrev_b32 v33, 16, v33
  v_mul_f32 v32, s26, v32
  v_exp_f32 v32, v32
  s_nop 0
  v_cvt_pk_bf16_f32 v34, v32, v32
  v_and_b32 v32, 0xffff0000, v34
  v_lshlrev_b32 v37, 6, v1
  v_add_u32 v37, s17, v37
  v_lshlrev_b32 v40, 16, v24
  v_lshlrev_b32 v41, 16, v26
  v_lshlrev_b32 v42, 16, v28
  v_lshlrev_b32 v43, 16, v30
  v_mul_f32 v40, s26, v40
  v_exp_f32 v40, v40
  s_nop 0
  v_cvt_pk_bf16_f32 v34, v40, v40
  v_and_b32 v40, 0xffff0000, v34
  v_mul_f32 v40, v40, v32
  v_mul_f32 v40, s26, v40
  v_sub_f32 v40, 0, v40
  v_mul_f32 v41, v41, v32
  v_mul_f32 v41, s27, v41
  v_mul_f32 v42, v42, v32
  v_mul_f32 v43, v43, v32
  v_add_f32 v42, v42, v42
  v_add_f32 v43, v43, v43
  ds_write_b128 v37, v[40:43] offset:18240
  v_and_b32 v40, 0xffff0000, v24
  v_and_b32 v41, 0xffff0000, v26
  v_and_b32 v42, 0xffff0000, v28
  v_and_b32 v43, 0xffff0000, v30
  v_mul_f32 v40, s26, v40
  v_exp_f32 v40, v40
  s_nop 0
  v_cvt_pk_bf16_f32 v34, v40, v40
  v_and_b32 v40, 0xffff0000, v34
  v_mul_f32 v40, v40, v32
  v_mul_f32 v40, s26, v40
  v_sub_f32 v40, 0, v40
  v_mul_f32 v41, v41, v32
  v_mul_f32 v41, s27, v41
  v_mul_f32 v42, v42, v32
  v_mul_f32 v43, v43, v32
  v_add_f32 v42, v42, v42
  v_add_f32 v43, v43, v43
  ds_write_b128 v37, v[40:43] offset:18256
  v_lshlrev_b32 v40, 16, v25
  v_lshlrev_b32 v41, 16, v27
  v_lshlrev_b32 v42, 16, v29
  v_lshlrev_b32 v43, 16, v31
  v_mul_f32 v40, s26, v40
  v_exp_f32 v40, v40
  s_nop 0
  v_cvt_pk_bf16_f32 v34, v40, v40
  v_and_b32 v40, 0xffff0000, v34
  v_mul_f32 v40, v40, v32
  v_mul_f32 v40, s26, v40
  v_sub_f32 v40, 0, v40
  v_mul_f32 v41, v41, v32
  v_mul_f32 v41, s27, v41
  v_mul_f32 v42, v42, v32
  v_mul_f32 v43, v43, v32
  v_add_f32 v42, v42, v42
  v_add_f32 v43, v43, v43
  ds_write_b128 v37, v[40:43] offset:18272
  v_and_b32 v40, 0xffff0000, v25
  v_and_b32 v41, 0xffff0000, v27
  v_and_b32 v42, 0xffff0000, v29
  v_and_b32 v43, 0xffff0000, v31
  v_mul_f32 v40, s26, v40
  v_exp_f32 v40, v40
  s_nop 0
  v_cvt_pk_bf16_f32 v34, v40, v40
  v_and_b32 v40, 0xffff0000, v34
  v_mul_f32 v40, v40, v32
  v_mul_f32 v40, s26, v40
  v_sub_f32 v40, 0, v40
  v_mul_f32 v41, v41, v32
  v_mul_f32 v41, s27, v41
  v_mul_f32 v42, v42, v32
  v_mul_f32 v43, v43, v32
  v_add_f32 v42, v42, v42
  v_add_f32 v43, v43, v43
  ds_write_b128 v37, v[40:43] offset:18288
  v_cvt_f32_u32 v44, v4
  v_lshlrev_b32 v45, 4, v4
  v_cvt_f32_u32 v45, v45
  v_lshlrev_b32 v46, 4, v3
  v_add_u32 v46, s17, v46
  v_mov_b32 v48, 0
  v_mov_b32 v49, 0
  v_mov_b32 v50, 0
  v_mov_b32 v51, 0
  v_mov_b32 v52, 0
  v_mov_b32 v53, 0
  v_mov_b32 v54, 0
  v_mov_b32 v55, 0
  v_mov_b32 v56, 0
  v_mov_b32 v57, 0
  v_mov_b32 v58, 0
  v_mov_b32 v59, 0
  v_mov_b32 v60, 0
  v_mov_b32 v61, 0
  v_mov_b32 v62, 0
  v_mov_b32 v63, 0
  v_mov_b32 v64, 0
  v_mov_b32 v65, 0
  v_mov_b32 v66, 0
  v_mov_b32 v67, 0
  s_mov_b32 s28, 0
  s_waitcnt lgkmcnt(0)
  ds_read_b128 v[68:71], v46 offset:18240
wk_kl:
  s_waitcnt lgkmcnt(0)
  v_mov_b32 v72, v68
  v_mov_b32 v73, v69
  v_mov_b32 v74, v70
  v_mov_b32 v75, v71
  v_add_u32 v46, 64, v46
  ds_read_b128 v[68:71], v46 offset:18240
  v_mul_f32 v80, v72, v45
  v_mul_f32 v81, v73, v45
  v_exp_f32 v80, v80
  v_fract_f32 v81, v81
  v_cos_f32 v76, v81
  v_sin_f32 v77, v81
  v_mul_f32 v76, v76, v80
  v_mul_f32 v77, v77, v80
  v_mul_f32 v80, v72, v44
  v_mul_f32 v81, v73, v44
  v_exp_f32 v80, v80
  v_fract_f32 v81, v81
  v_cos_f32 v78, v81
  v_sin_f32 v79, v81
  v_mul_f32 v78, v78, v80
  v_mul_f32 v79, v79, v80
  v_mul_f32 v82, v74, v76
  v_mul_f32 v83, v74, v77
  v_fma_f32 v82, -v75, v77, v82
  v_fma_f32 v83, -v75, v76, -v83
  v_mul_f32 v86, v76, v76
  v_mul_f32 v87, v76, v77
  v_fma_f32 v86, -v77, v77, v86
  v_add_f32 v87, v87, v87
  v_mfma_f32_16x16x4_f32 v[48:51], v82, v78, v[48:51]
  v_mul_f32 v88, v78, v78
  v_mul_f32 v89, v78, v79
  v_fma_f32 v88, -v79, v79, v88
  v_add_f32 v89, v89, v89
  v_mfma_f32_16x16x4_f32 v[48:51], v83, v79, v[48:51]
  v_mul_f32 v84, v74, v86
  v_mul_f32 v85, v74, v87
  v_fma_f32 v84, -v75, v87, v84
  v_fma_f32 v85, -v75, v86, -v85
  v_mul_f32 v76, v86, v86
  v_mul_f32 v77, v86, v87
  v_fma_f32 v76, -v87, v87, v76
  v_add_f32 v77, v77, v77
  v_mfma_f32_16x16x4_f32 v[52:55], v84, v88, v[52:55]
  v_mul_f32 v78, v88, v88
  v_mul_f32 v79, v88, v89
  v_fma_f32 v78, -v89, v89, v78
  v_add_f32 v79, v79, v79
  v_mfma_f32_16x16x4_f32 v[52:55], v85, v89, v[52:55]
  v_mul_f32 v82, v74, v76
  v_mul_f32 v83, v74, v77
  v_fma_f32 v82, -v75, v77, v82
  v_fma_f32 v83, -v75, v76, -v83
  v_mul_f32 v86, v76, v76
  v_mul_f32 v87, v76, v77
  v_fma_f32 v86, -v77, v77, v86
  v_add_f32 v87, v87, v87
  v_mfma_f32_16x16x4_f32 v[56:59], v82, v78, v[56:59]
  v_mul_f32 v88, v78, v78
  v_mul_f32 v89, v78, v79
  v_fma_f32 v88, -v79, v79, v88
  v_add_f32 v89, v89, v89
  v_mfma_f32_16x16x4_f32 v[56:59], v83, v79, v[56:59]
  v_mul_f32 v84, v74, v86
  v_mul_f32 v85, v74, v87
  v_fma_f32 v84, -v75, v87, v84
  v_fma_f32 v85, -v75, v86, -v85
  v_mul_f32 v76, v86, v86
  v_mul_f32 v77, v86, v87
  v_fma_f32 v76, -v87, v87, v76
  v_add_f32 v77, v77, v77
  v_mfma_f32_16x16x4_f32 v[60:63], v84, v88, v[60:63]
  v_mfma_f32_16x16x4_f32 v[60:63], v85, v89, v[60:63]
  v_mul_f32 v82, v74, v76
  v_fma_f32 v82, -v75, v77, v82
  s_nop 1
  v_mfma_f32_16x16x4_f32 v[64:67], v82, v88, v[64:67]
  s_add_u32 s28, s28, 1
  s_cmp_lt_u32 s28, 64
  s_cbranch_scc1 wk_kl
  s_nop 15
  s_nop 3
  v_lshlrev_b32 v46, 8, v3
  v_lshl_add_u32 v46, v4, 2, v46
  v_add_u32 v46, s17, v46
  ds_write_b32 v46, v48 offset:13056
  ds_write_b32 v46, v49 offset:13120
  ds_write_b32 v46, v50 offset:13184
  ds_write_b32 v46, v51 offset:13248
  s_waitcnt lgkmcnt(8)
  ds_write_b32 v46, v52 offset:14080
  ds_write_b32 v46, v53 offset:14144
  ds_write_b32 v46, v54 offset:14208
  ds_write_b32 v46, v55 offset:14272
  s_waitcnt lgkmcnt(8)
  ds_write_b32 v46, v56 offset:15104
  ds_write_b32 v46, v57 offset:15168
  ds_write_b32 v46, v58 offset:15232
  ds_write_b32 v46, v59 offset:15296
  s_waitcnt lgkmcnt(8)
  ds_write_b32 v46, v60 offset:16128
  ds_write_b32 v46, v61 offset:16192
  ds_write_b32 v46, v62 offset:16256
  ds_write_b32 v46, v63 offset:16320
  s_waitcnt lgkmcnt(8)
  ds_write_b32 v46, v64 offset:17152
  ds_write_b32 v46, v65 offset:17216
  ds_write_b32 v46, v66 offset:17280
  ds_write_b32 v46, v67 offset:17344
  s_waitcnt lgkmcnt(8)
  s_waitcnt lgkmcnt(0)
  ds_read_b32 v48, v200
  ds_read_b32 v49, v201
  ds_read_b32 v50, v202
  ds_read_b32 v51, v203
  ds_read_b32 v52, v204
  ds_read_b32 v53, v205
  ds_read_b32 v54, v206
  ds_read_b32 v55, v207
  s_waitcnt lgkmcnt(4)
  ds_read_b32 v56, v208
  ds_read_b32 v57, v209
  ds_read_b32 v58, v210
  ds_read_b32 v59, v211
  ds_read_b32 v60, v212
  ds_read_b32 v61, v213
  ds_read_b32 v62, v214
  ds_read_b32 v63, v215
  s_waitcnt lgkmcnt(4)
  ds_read_b32 v64, v216
  ds_read_b32 v65, v217
  ds_read_b32 v66, v218
  ds_read_b32 v67, v219
  ds_read_b32 v68, v220
  ds_read_b32 v69, v221
  ds_read_b32 v70, v222
  ds_read_b32 v71, v223
  s_waitcnt lgkmcnt(4)
  ds_read_b32 v72, v224
  ds_read_b32 v73, v225
  ds_read_b32 v74, v226
  ds_read_b32 v75, v227
  ds_read_b32 v76, v228
  ds_read_b32 v77, v229
  ds_read_b32 v78, v230
  ds_read_b32 v79, v231
  s_waitcnt lgkmcnt(4)
  ds_read_b32 v80, v232
  s_waitcnt lgkmcnt(0)
  v_lshlrev_b32 v46, 6, v1
  v_add_u32 v46, s17, v46
  v_cvt_pk_bf16_f32 v84, v48, v49
  v_cvt_pk_bf16_f32 v88, v49, v50
  v_cvt_pk_bf16_f32 v85, v50, v51
  v_cvt_pk_bf16_f32 v89, v51, v52
  v_cvt_pk_bf16_f32 v86, v52, v53
  v_cvt_pk_bf16_f32 v90, v53, v54
  v_cvt_pk_bf16_f32 v87, v54, v55
  v_cvt_pk_bf16_f32 v91, v55, v56
  ds_write_b128 v46, v[84:87] offset:4608
  ds_write_b128 v46, v[88:91] offset:8832
  s_waitcnt lgkmcnt(0)
  v_cvt_pk_bf16_f32 v84, v56, v57
  v_cvt_pk_bf16_f32 v88, v57, v58
  v_cvt_pk_bf16_f32 v85, v58, v59
  v_cvt_pk_bf16_f32 v89, v59, v60
  v_cvt_pk_bf16_f32 v86, v60, v61
  v_cvt_pk_bf16_f32 v90, v61, v62
  v_cvt_pk_bf16_f32 v87, v62, v63
  v_cvt_pk_bf16_f32 v91, v63, v64
  ds_write_b128 v46, v[84:87] offset:4624
  ds_write_b128 v46, v[88:91] offset:8848
  s_waitcnt lgkmcnt(0)
  v_cvt_pk_bf16_f32 v84, v64, v65
  v_cvt_pk_bf16_f32 v88, v65, v66
  v_cvt_pk_bf16_f32 v85, v66, v67
  v_cvt_pk_bf16_f32 v89, v67, v68
  v_cvt_pk_bf16_f32 v86, v68, v69
  v_cvt_pk_bf16_f32 v90, v69, v70
  v_cvt_pk_bf16_f32 v87, v70, v71
  v_cvt_pk_bf16_f32 v91, v71, v72
  ds_write_b128 v46, v[84:87] offset:4640
  ds_write_b128 v46, v[88:91] offset:8864
  s_waitcnt lgkmcnt(0)
  v_cvt_pk_bf16_f32 v84, v72, v73
  v_cvt_pk_bf16_f32 v88, v73, v74
  v_cvt_pk_bf16_f32 v85, v74, v75
  v_cvt_pk_bf16_f32 v89, v75, v76
  v_cvt_pk_bf16_f32 v86, v76, v77
  v_cvt_pk_bf16_f32 v90, v77, v78
  v_cvt_pk_bf16_f32 v87, v78, v79
  v_cvt_pk_bf16_f32 v91, v79, v80
  ds_write_b128 v46, v[84:87] offset:4656
  ds_write_b128 v46, v[88:91] offset:8880
  s_waitcnt lgkmcnt(0)
  s_barrier
  v_lshrrev_b32 v47, 1, v3
  v_sub_u32 v46, v4, v47
  v_add_u32 v46, 1, v46
  v_lshlrev_b32 v46, 5, v46
  v_and_b32 v48, 1, v3
  v_lshl_add_u32 v46, v48, 4, v46
  v_add_u32 v46, s17, v46
  ds_read_b128 a[0:3], v46 offset:32
  ds_read_b128 a[4:7], v46 offset:96
  ds_read_b128 a[8:11], v46 offset:160
  ds_read_b128 a[12:15], v46 offset:224
  ds_read_b128 a[16:19], v46 offset:288
  ds_read_b128 a[20:23], v46 offset:352
  ds_read_b128 a[24:27], v46 offset:416
  ds_read_b128 a[28:31], v46 offset:480
  s_waitcnt lgkmcnt(4)
  ds_read_b128 a[32:35], v46 offset:544
  ds_read_b128 a[36:39], v46 offset:608
  ds_read_b128 a[40:43], v46 offset:672
  ds_read_b128 a[44:47], v46 offset:736
  ds_read_b128 a[48:51], v46 offset:800
  ds_read_b128 a[52:55], v46 offset:864
  ds_read_b128 a[56:59], v46 offset:928
  ds_read_b128 a[60:63], v46 offset:992
  s_waitcnt lgkmcnt(4)
  ds_read_b128 a[64:67], v46 offset:1056
  ds_read_b128 a[68:71], v46 offset:1120
  ds_read_b128 a[72:75], v46 offset:1184
  ds_read_b128 a[76:79], v46 offset:1248
  ds_read_b128 a[80:83], v46 offset:1312
  ds_read_b128 a[84:87], v46 offset:1376
  ds_read_b128 a[88:91], v46 offset:1440
  ds_read_b128 a[92:95], v46 offset:1504
  s_waitcnt lgkmcnt(4)
  ds_read_b128 a[96:99], v46 offset:1568
  ds_read_b128 a[100:103], v46 offset:1632
  ds_read_b128 a[104:107], v46 offset:1696
  ds_read_b128 a[108:111], v46 offset:1760
  ds_read_b128 a[112:115], v46 offset:1824
  ds_read_b128 a[116:119], v46 offset:1888
  ds_read_b128 a[120:123], v46 offset:1952
  ds_read_b128 a[124:127], v46 offset:2016
  s_waitcnt lgkmcnt(4)
  ds_read_b128 a[128:131], v46 offset:2080
  ds_read_b128 a[132:135], v46 offset:2144
  ds_read_b128 a[136:139], v46 offset:2208
  ds_read_b128 a[140:143], v46 offset:2272
  ds_read_b128 a[144:147], v46 offset:2336
  ds_read_b128 a[148:151], v46 offset:2400
  ds_read_b128 a[152:155], v46 offset:2464
  ds_read_b128 a[156:159], v46 offset:2528
  s_waitcnt lgkmcnt(4)
  ds_read_b128 a[160:163], v46 offset:2592
  ds_read_b128 a[164:167], v46 offset:2656
  ds_read_b128 a[168:171], v46 offset:2720
  ds_read_b128 a[172:175], v46 offset:2784
  ds_read_b128 a[176:179], v46 offset:2848
  ds_read_b128 a[180:183], v46 offset:2912
  ds_read_b128 a[184:187], v46 offset:2976
  ds_read_b128 a[188:191], v46 offset:3040
  s_waitcnt lgkmcnt(4)
  ds_read_b128 a[192:195], v46 offset:3104
  ds_read_b128 a[196:199], v46 offset:3168
  ds_read_b128 a[200:203], v46 offset:3232
  ds_read_b128 a[204:207], v46 offset:3296
  ds_read_b128 a[208:211], v46 offset:3360
  ds_read_b128 a[212:215], v46 offset:3424
  ds_read_b128 a[216:219], v46 offset:3488
  ds_read_b128 a[220:223], v46 offset:3552
  s_waitcnt lgkmcnt(4)
  ds_read_b128 a[224:227], v46 offset:3616
  ds_read_b128 a[228:231], v46 offset:3680
  ds_read_b128 a[232:235], v46 offset:3744
  ds_read_b128 a[236:239], v46 offset:3808
  ds_read_b128 a[240:243], v46 offset:3872
  ds_read_b128 a[244:247], v46 offset:3936
  ds_read_b128 a[248:251], v46 offset:4000
  ds_read_b128 a[252:255], v46 offset:4064
  s_waitcnt lgkmcnt(4)
  v_lshlrev_b32 v49, 4, v47
  v_add_u32 v49, v49, v4
  v_sub_u32 v49, 2047, v49
  v_lshl_add_u32 v49, v48, 3, v49
  v_and_b32 v50, 1, v49
  v_lshrrev_b32 v49, 1, v49
  v_lshlrev_b32 v49, 2, v49
  v_mul_u32_u24 v50, 4224, v50
  v_add3_u32 v49, v49, v50, s17
  v_add_u32 v49, 4608, v49
  v_subrev_u32 v52, 896, v49
  v_subrev_u32 v53, 1856, v49
  v_subrev_u32 v54, 2816, v49
  v_subrev_u32 v55, 3776, v49
  v_subrev_u32 v56, 4736, v49
  s_waitcnt lgkmcnt(0)
  ds_read2_b32 v[92:93], v52 offset0:224 offset1:225
  ds_read2_b32 v[94:95], v52 offset0:226 offset1:227
  ds_read2_b32 v[96:97], v52 offset0:208 offset1:209
  ds_read2_b32 v[98:99], v52 offset0:210 offset1:211
  ds_read2_b32 v[100:101], v52 offset0:192 offset1:193
  ds_read2_b32 v[102:103], v52 offset0:194 offset1:195
  ds_read2_b32 v[104:105], v52 offset0:176 offset1:177
  ds_read2_b32 v[106:107], v52 offset0:178 offset1:179
  s_waitcnt lgkmcnt(6)
  v_mfma_f32_16x16x32_bf16 v[60:63], v[92:95], a[28:31], 0
  v_mfma_f32_16x16x32_bf16 v[64:67], v[92:95], a[60:63], 0
  v_mfma_f32_16x16x32_bf16 v[68:71], v[92:95], a[92:95], 0
  v_mfma_f32_16x16x32_bf16 v[72:75], v[92:95], a[124:127], 0
  v_mfma_f32_16x16x32_bf16 v[76:79], v[92:95], a[156:159], 0
  v_mfma_f32_16x16x32_bf16 v[80:83], v[92:95], a[188:191], 0
  v_mfma_f32_16x16x32_bf16 v[84:87], v[92:95], a[220:223], 0
  v_mfma_f32_16x16x32_bf16 v[88:91], v[92:95], a[252:255], 0
  ds_read2_b32 v[92:93], v52 offset0:160 offset1:161
  ds_read2_b32 v[94:95], v52 offset0:162 offset1:163
  s_waitcnt lgkmcnt(6)
  v_mfma_f32_16x16x32_bf16 v[60:63], v[96:99], a[24:27], v[60:63]
  v_mfma_f32_16x16x32_bf16 v[64:67], v[96:99], a[56:59], v[64:67]
  v_mfma_f32_16x16x32_bf16 v[68:71], v[96:99], a[88:91], v[68:71]
  v_mfma_f32_16x16x32_bf16 v[72:75], v[96:99], a[120:123], v[72:75]
  v_mfma_f32_16x16x32_bf16 v[76:79], v[96:99], a[152:155], v[76:79]
  v_mfma_f32_16x16x32_bf16 v[80:83], v[96:99], a[184:187], v[80:83]
  v_mfma_f32_16x16x32_bf16 v[84:87], v[96:99], a[216:219], v[84:87]
  v_mfma_f32_16x16x32_bf16 v[88:91], v[96:99], a[248:251], v[88:91]
  ds_read2_b32 v[96:97], v52 offset0:144 offset1:145
  ds_read2_b32 v[98:99], v52 offset0:146 offset1:147
  s_waitcnt lgkmcnt(6)
  v_mfma_f32_16x16x32_bf16 v[60:63], v[100:103], a[20:23], v[60:63]
  v_mfma_f32_16x16x32_bf16 v[64:67], v[100:103], a[52:55], v[64:67]
  v_mfma_f32_16x16x32_bf16 v[68:71], v[100:103], a[84:87], v[68:71]
  v_mfma_f32_16x16x32_bf16 v[72:75], v[100:103], a[116:119], v[72:75]
  v_mfma_f32_16x16x32_bf16 v[76:79], v[100:103], a[148:151], v[76:79]
  v_mfma_f32_16x16x32_bf16 v[80:83], v[100:103], a[180:183], v[80:83]
  v_mfma_f32_16x16x32_bf16 v[84:87], v[100:103], a[212:215], v[84:87]
  v_mfma_f32_16x16x32_bf16 v[88:91], v[100:103], a[244:247], v[88:91]
  ds_read2_b32 v[100:101], v52 offset0:128 offset1:129
  ds_read2_b32 v[102:103], v52 offset0:130 offset1:131
  s_waitcnt lgkmcnt(6)
  v_mfma_f32_16x16x32_bf16 v[60:63], v[104:107], a[16:19], v[60:63]
  v_mfma_f32_16x16x32_bf16 v[64:67], v[104:107], a[48:51], v[64:67]
  v_mfma_f32_16x16x32_bf16 v[68:71], v[104:107], a[80:83], v[68:71]
  v_mfma_f32_16x16x32_bf16 v[72:75], v[104:107], a[112:115], v[72:75]
  v_mfma_f32_16x16x32_bf16 v[76:79], v[104:107], a[144:147], v[76:79]
  v_mfma_f32_16x16x32_bf16 v[80:83], v[104:107], a[176:179], v[80:83]
  v_mfma_f32_16x16x32_bf16 v[84:87], v[104:107], a[208:211], v[84:87]
  v_mfma_f32_16x16x32_bf16 v[88:91], v[104:107], a[240:243], v[88:91]
  ds_read2_b32 v[104:105], v52 offset0:112 offset1:113
  ds_read2_b32 v[106:107], v52 offset0:114 offset1:115
  s_waitcnt lgkmcnt(6)
  v_mfma_f32_16x16x32_bf16 v[60:63], v[92:95], a[12:15], v[60:63]
  v_mfma_f32_16x16x32_bf16 v[64:67], v[92:95], a[44:47], v[64:67]
  v_mfma_f32_16x16x32_bf16 v[68:71], v[92:95], a[76:79], v[68:71]
  v_mfma_f32_16x16x32_bf16 v[72:75], v[92:95], a[108:111], v[72:75]
  v_mfma_f32_16x16x32_bf16 v[76:79], v[92:95], a[140:143], v[76:79]
  v_mfma_f32_16x16x32_bf16 v[80:83], v[92:95], a[172:175], v[80:83]
  v_mfma_f32_16x16x32_bf16 v[84:87], v[92:95], a[204:207], v[84:87]
  v_mfma_f32_16x16x32_bf16 v[88:91], v[92:95], a[236:239], v[88:91]
  ds_read2_b32 v[92:93], v52 offset0:96 offset1:97
  ds_read2_b32 v[94:95], v52 offset0:98 offset1:99
  s_waitcnt lgkmcnt(6)
  v_mfma_f32_16x16x32_bf16 v[60:63], v[96:99], a[8:11], v[60:63]
  v_mfma_f32_16x16x32_bf16 v[64:67], v[96:99], a[40:43], v[64:67]
  v_mfma_f32_16x16x32_bf16 v[68:71], v[96:99], a[72:75], v[68:71]
  v_mfma_f32_16x16x32_bf16 v[72:75], v[96:99], a[104:107], v[72:75]
  v_mfma_f32_16x16x32_bf16 v[76:79], v[96:99], a[136:139], v[76:79]
  v_mfma_f32_16x16x32_bf16 v[80:83], v[96:99], a[168:171], v[80:83]
  v_mfma_f32_16x16x32_bf16 v[84:87], v[96:99], a[200:203], v[84:87]
  v_mfma_f32_16x16x32_bf16 v[88:91], v[96:99], a[232:235], v[88:91]
  ds_read2_b32 v[96:97], v52 offset0:80 offset1:81
  ds_read2_b32 v[98:99], v52 offset0:82 offset1:83
  s_waitcnt lgkmcnt(6)
  v_mfma_f32_16x16x32_bf16 v[60:63], v[100:103], a[4:7], v[60:63]
  v_mfma_f32_16x16x32_bf16 v[64:67], v[100:103], a[36:39], v[64:67]
  v_mfma_f32_16x16x32_bf16 v[68:71], v[100:103], a[68:71], v[68:71]
  v_mfma_f32_16x16x32_bf16 v[72:75], v[100:103], a[100:103], v[72:75]
  v_mfma_f32_16x16x32_bf16 v[76:79], v[100:103], a[132:135], v[76:79]
  v_mfma_f32_16x16x32_bf16 v[80:83], v[100:103], a[164:167], v[80:83]
  v_mfma_f32_16x16x32_bf16 v[84:87], v[100:103], a[196:199], v[84:87]
  v_mfma_f32_16x16x32_bf16 v[88:91], v[100:103], a[228:231], v[88:91]
  ds_read2_b32 v[100:101], v52 offset0:64 offset1:65
  ds_read2_b32 v[102:103], v52 offset0:66 offset1:67
  s_waitcnt lgkmcnt(6)
  v_mfma_f32_16x16x32_bf16 v[60:63], v[104:107], a[0:3], v[60:63]
  v_mfma_f32_16x16x32_bf16 v[64:67], v[104:107], a[32:35], v[64:67]
  v_mfma_f32_16x16x32_bf16 v[68:71], v[104:107], a[64:67], v[68:71]
  v_mfma_f32_16x16x32_bf16 v[72:75], v[104:107], a[96:99], v[72:75]
  v_mfma_f32_16x16x32_bf16 v[76:79], v[104:107], a[128:131], v[76:79]
  v_mfma_f32_16x16x32_bf16 v[80:83], v[104:107], a[160:163], v[80:83]
  v_mfma_f32_16x16x32_bf16 v[84:87], v[104:107], a[192:195], v[84:87]
  v_mfma_f32_16x16x32_bf16 v[88:91], v[104:107], a[224:227], v[88:91]
  ds_read2_b32 v[104:105], v52 offset0:48 offset1:49
  ds_read2_b32 v[106:107], v52 offset0:50 offset1:51
  s_waitcnt lgkmcnt(6)
  v_mfma_f32_16x16x32_bf16 v[64:67], v[92:95], a[28:31], v[64:67]
  v_mfma_f32_16x16x32_bf16 v[68:71], v[92:95], a[60:63], v[68:71]
  v_mfma_f32_16x16x32_bf16 v[72:75], v[92:95], a[92:95], v[72:75]
  v_mfma_f32_16x16x32_bf16 v[76:79], v[92:95], a[124:127], v[76:79]
  v_mfma_f32_16x16x32_bf16 v[80:83], v[92:95], a[156:159], v[80:83]
  v_mfma_f32_16x16x32_bf16 v[84:87], v[92:95], a[188:191], v[84:87]
  v_mfma_f32_16x16x32_bf16 v[88:91], v[92:95], a[220:223], v[88:91]
  ds_read2_b32 v[92:93], v52 offset0:32 offset1:33
  ds_read2_b32 v[94:95], v52 offset0:34 offset1:35
  s_waitcnt lgkmcnt(6)
  v_mfma_f32_16x16x32_bf16 v[64:67], v[96:99], a[24:27], v[64:67]
  v_mfma_f32_16x16x32_bf16 v[68:71], v[96:99], a[56:59], v[68:71]
  v_mfma_f32_16x16x32_bf16 v[72:75], v[96:99], a[88:91], v[72:75]
  v_mfma_f32_16x16x32_bf16 v[76:79], v[96:99], a[120:123], v[76:79]
  v_mfma_f32_16x16x32_bf16 v[80:83], v[96:99], a[152:155], v[80:83]
  v_mfma_f32_16x16x32_bf16 v[84:87], v[96:99], a[184:187], v[84:87]
  v_mfma_f32_16x16x32_bf16 v[88:91], v[96:99], a[216:219], v[88:91]
  ds_read2_b32 v[96:97], v52 offset0:16 offset1:17
  ds_read2_b32 v[98:99], v52 offset0:18 offset1:19
  s_waitcnt lgkmcnt(6)
  v_mfma_f32_16x16x32_bf16 v[64:67], v[100:103], a[20:23], v[64:67]
  v_mfma_f32_16x16x32_bf16 v[68:71], v[100:103], a[52:55], v[68:71]
  v_mfma_f32_16x16x32_bf16 v[72:75], v[100:103], a[84:87], v[72:75]
  v_mfma_f32_16x16x32_bf16 v[76:79], v[100:103], a[116:119], v[76:79]
  v_mfma_f32_16x16x32_bf16 v[80:83], v[100:103], a[148:151], v[80:83]
  v_mfma_f32_16x16x32_bf16 v[84:87], v[100:103], a[180:183], v[84:87]
  v_mfma_f32_16x16x32_bf16 v[88:91], v[100:103], a[212:215], v[88:91]
  ds_read2_b32 v[100:101], v52 offset0:0 offset1:1
  ds_read2_b32 v[102:103], v52 offset0:2 offset1:3
  s_waitcnt lgkmcnt(6)
  v_mfma_f32_16x16x32_bf16 v[64:67], v[104:107], a[16:19], v[64:67]
  v_mfma_f32_16x16x32_bf16 v[68:71], v[104:107], a[48:51], v[68:71]
  v_mfma_f32_16x16x32_bf16 v[72:75], v[104:107], a[80:83], v[72:75]
  v_mfma_f32_16x16x32_bf16 v[76:79], v[104:107], a[112:115], v[76:79]
  v_mfma_f32_16x16x32_bf16 v[80:83], v[104:107], a[144:147], v[80:83]
  v_mfma_f32_16x16x32_bf16 v[84:87], v[104:107], a[176:179], v[84:87]
  v_mfma_f32_16x16x32_bf16 v[88:91], v[104:107], a[208:211], v[88:91]
  ds_read2_b32 v[104:105], v53 offset0:224 offset1:225
  ds_read2_b32 v[106:107], v53 offset0:226 offset1:227
  s_waitcnt lgkmcnt(6)
  v_mfma_f32_16x16x32_bf16 v[64:67], v[92:95], a[12:15], v[64:67]
  v_mfma_f32_16x16x32_bf16 v[68:71], v[92:95], a[44:47], v[68:71]
  v_mfma_f32_16x16x32_bf16 v[72:75], v[92:95], a[76:79], v[72:75]
  v_mfma_f32_16x16x32_bf16 v[76:79], v[92:95], a[108:111], v[76:79]
  v_mfma_f32_16x16x32_bf16 v[80:83], v[92:95], a[140:143], v[80:83]
  v_mfma_f32_16x16x32_bf16 v[84:87], v[92:95], a[172:175], v[84:87]
  v_mfma_f32_16x16x32_bf16 v[88:91], v[92:95], a[204:207], v[88:91]
  ds_read2_b32 v[92:93], v53 offset0:208 offset1:209
  ds_read2_b32 v[94:95], v53 offset0:210 offset1:211
  s_waitcnt lgkmcnt(6)
  v_mfma_f32_16x16x32_bf16 v[64:67], v[96:99], a[8:11], v[64:67]
  v_mfma_f32_16x16x32_bf16 v[68:71], v[96:99], a[40:43], v[68:71]
  v_mfma_f32_16x16x32_bf16 v[72:75], v[96:99], a[72:75], v[72:75]
  v_mfma_f32_16x16x32_bf16 v[76:79], v[96:99], a[104:107], v[76:79]
  v_mfma_f32_16x16x32_bf16 v[80:83], v[96:99], a[136:139], v[80:83]
  v_mfma_f32_16x16x32_bf16 v[84:87], v[96:99], a[168:171], v[84:87]
  v_mfma_f32_16x16x32_bf16 v[88:91], v[96:99], a[200:203], v[88:91]
  ds_read2_b32 v[96:97], v53 offset0:192 offset1:193
  ds_read2_b32 v[98:99], v53 offset0:194 offset1:195
  s_waitcnt lgkmcnt(6)
  v_mfma_f32_16x16x32_bf16 v[64:67], v[100:103], a[4:7], v[64:67]
  v_mfma_f32_16x16x32_bf16 v[68:71], v[100:103], a[36:39], v[68:71]
  v_mfma_f32_16x16x32_bf16 v[72:75], v[100:103], a[68:71], v[72:75]
  v_mfma_f32_16x16x32_bf16 v[76:79], v[100:103], a[100:103], v[76:79]
  v_mfma_f32_16x16x32_bf16 v[80:83], v[100:103], a[132:135], v[80:83]
  v_mfma_f32_16x16x32_bf16 v[84:87], v[100:103], a[164:167], v[84:87]
  v_mfma_f32_16x16x32_bf16 v[88:91], v[100:103], a[196:199], v[88:91]
  ds_read2_b32 v[100:101], v53 offset0:176 offset1:177
  ds_read2_b32 v[102:103], v53 offset0:178 offset1:179
  s_waitcnt lgkmcnt(6)
  v_mfma_f32_16x16x32_bf16 v[64:67], v[104:107], a[0:3], v[64:67]
  v_mfma_f32_16x16x32_bf16 v[68:71], v[104:107], a[32:35], v[68:71]
  v_mfma_f32_16x16x32_bf16 v[72:75], v[104:107], a[64:67], v[72:75]
  v_mfma_f32_16x16x32_bf16 v[76:79], v[104:107], a[96:99], v[76:79]
  v_mfma_f32_16x16x32_bf16 v[80:83], v[104:107], a[128:131], v[80:83]
  v_mfma_f32_16x16x32_bf16 v[84:87], v[104:107], a[160:163], v[84:87]
  v_mfma_f32_16x16x32_bf16 v[88:91], v[104:107], a[192:195], v[88:91]
  ds_read2_b32 v[104:105], v53 offset0:160 offset1:161
  ds_read2_b32 v[106:107], v53 offset0:162 offset1:163
  s_waitcnt lgkmcnt(6)
  v_mfma_f32_16x16x32_bf16 v[68:71], v[92:95], a[28:31], v[68:71]
  v_mfma_f32_16x16x32_bf16 v[72:75], v[92:95], a[60:63], v[72:75]
  v_mfma_f32_16x16x32_bf16 v[76:79], v[92:95], a[92:95], v[76:79]
  v_mfma_f32_16x16x32_bf16 v[80:83], v[92:95], a[124:127], v[80:83]
  v_mfma_f32_16x16x32_bf16 v[84:87], v[92:95], a[156:159], v[84:87]
  v_mfma_f32_16x16x32_bf16 v[88:91], v[92:95], a[188:191], v[88:91]
  ds_read2_b32 v[92:93], v53 offset0:144 offset1:145
  ds_read2_b32 v[94:95], v53 offset0:146 offset1:147
  s_waitcnt lgkmcnt(6)
  v_mfma_f32_16x16x32_bf16 v[68:71], v[96:99], a[24:27], v[68:71]
  v_mfma_f32_16x16x32_bf16 v[72:75], v[96:99], a[56:59], v[72:75]
  v_mfma_f32_16x16x32_bf16 v[76:79], v[96:99], a[88:91], v[76:79]
  v_mfma_f32_16x16x32_bf16 v[80:83], v[96:99], a[120:123], v[80:83]
  v_mfma_f32_16x16x32_bf16 v[84:87], v[96:99], a[152:155], v[84:87]
  v_mfma_f32_16x16x32_bf16 v[88:91], v[96:99], a[184:187], v[88:91]
  ds_read2_b32 v[96:97], v53 offset0:128 offset1:129
  ds_read2_b32 v[98:99], v53 offset0:130 offset1:131
  s_waitcnt lgkmcnt(6)
  v_mfma_f32_16x16x32_bf16 v[68:71], v[100:103], a[20:23], v[68:71]
  v_mfma_f32_16x16x32_bf16 v[72:75], v[100:103], a[52:55], v[72:75]
  v_mfma_f32_16x16x32_bf16 v[76:79], v[100:103], a[84:87], v[76:79]
  v_mfma_f32_16x16x32_bf16 v[80:83], v[100:103], a[116:119], v[80:83]
  v_mfma_f32_16x16x32_bf16 v[84:87], v[100:103], a[148:151], v[84:87]
  v_mfma_f32_16x16x32_bf16 v[88:91], v[100:103], a[180:183], v[88:91]
  ds_read2_b32 v[100:101], v53 offset0:112 offset1:113
  ds_read2_b32 v[102:103], v53 offset0:114 offset1:115
  s_waitcnt lgkmcnt(6)
  v_mfma_f32_16x16x32_bf16 v[68:71], v[104:107], a[16:19], v[68:71]
  v_mfma_f32_16x16x32_bf16 v[72:75], v[104:107], a[48:51], v[72:75]
  v_mfma_f32_16x16x32_bf16 v[76:79], v[104:107], a[80:83], v[76:79]
  v_mfma_f32_16x16x32_bf16 v[80:83], v[104:107], a[112:115], v[80:83]
  v_mfma_f32_16x16x32_bf16 v[84:87], v[104:107], a[144:147], v[84:87]
  v_mfma_f32_16x16x32_bf16 v[88:91], v[104:107], a[176:179], v[88:91]
  ds_read2_b32 v[104:105], v53 offset0:96 offset1:97
  ds_read2_b32 v[106:107], v53 offset0:98 offset1:99
  s_waitcnt lgkmcnt(6)
  v_mfma_f32_16x16x32_bf16 v[68:71], v[92:95], a[12:15], v[68:71]
  v_mfma_f32_16x16x32_bf16 v[72:75], v[92:95], a[44:47], v[72:75]
  v_mfma_f32_16x16x32_bf16 v[76:79], v[92:95], a[76:79], v[76:79]
  v_mfma_f32_16x16x32_bf16 v[80:83], v[92:95], a[108:111], v[80:83]
  v_mfma_f32_16x16x32_bf16 v[84:87], v[92:95], a[140:143], v[84:87]
  v_mfma_f32_16x16x32_bf16 v[88:91], v[92:95], a[172:175], v[88:91]
  ds_read2_b32 v[92:93], v53 offset0:80 offset1:81
  ds_read2_b32 v[94:95], v53 offset0:82 offset1:83
  s_waitcnt lgkmcnt(6)
  v_mfma_f32_16x16x32_bf16 v[68:71], v[96:99], a[8:11], v[68:71]
  v_mfma_f32_16x16x32_bf16 v[72:75], v[96:99], a[40:43], v[72:75]
  v_mfma_f32_16x16x32_bf16 v[76:79], v[96:99], a[72:75], v[76:79]
  v_mfma_f32_16x16x32_bf16 v[80:83], v[96:99], a[104:107], v[80:83]
  v_mfma_f32_16x16x32_bf16 v[84:87], v[96:99], a[136:139], v[84:87]
  v_mfma_f32_16x16x32_bf16 v[88:91], v[96:99], a[168:171], v[88:91]
  ds_read2_b32 v[96:97], v53 offset0:64 offset1:65
  ds_read2_b32 v[98:99], v53 offset0:66 offset1:67
  s_waitcnt lgkmcnt(6)
  v_mfma_f32_16x16x32_bf16 v[68:71], v[100:103], a[4:7], v[68:71]
  v_mfma_f32_16x16x32_bf16 v[72:75], v[100:103], a[36:39], v[72:75]
  v_mfma_f32_16x16x32_bf16 v[76:79], v[100:103], a[68:71], v[76:79]
  v_mfma_f32_16x16x32_bf16 v[80:83], v[100:103], a[100:103], v[80:83]
  v_mfma_f32_16x16x32_bf16 v[84:87], v[100:103], a[132:135], v[84:87]
  v_mfma_f32_16x16x32_bf16 v[88:91], v[100:103], a[164:167], v[88:91]
  ds_read2_b32 v[100:101], v53 offset0:48 offset1:49
  ds_read2_b32 v[102:103], v53 offset0:50 offset1:51
  s_waitcnt lgkmcnt(6)
  v_mfma_f32_16x16x32_bf16 v[68:71], v[104:107], a[0:3], v[68:71]
  v_mfma_f32_16x16x32_bf16 v[72:75], v[104:107], a[32:35], v[72:75]
  v_mfma_f32_16x16x32_bf16 v[76:79], v[104:107], a[64:67], v[76:79]
  v_mfma_f32_16x16x32_bf16 v[80:83], v[104:107], a[96:99], v[80:83]
  v_mfma_f32_16x16x32_bf16 v[84:87], v[104:107], a[128:131], v[84:87]
  v_mfma_f32_16x16x32_bf16 v[88:91], v[104:107], a[160:163], v[88:91]
  ds_read2_b32 v[104:105], v53 offset0:32 offset1:33
  ds_read2_b32 v[106:107], v53 offset0:34 offset1:35
  s_waitcnt lgkmcnt(6)
  v_mfma_f32_16x16x32_bf16 v[72:75], v[92:95], a[28:31], v[72:75]
  v_mfma_f32_16x16x32_bf16 v[76:79], v[92:95], a[60:63], v[76:79]
  v_mfma_f32_16x16x32_bf16 v[80:83], v[92:95], a[92:95], v[80:83]
  v_mfma_f32_16x16x32_bf16 v[84:87], v[92:95], a[124:127], v[84:87]
  v_mfma_f32_16x16x32_bf16 v[88:91], v[92:95], a[156:159], v[88:91]
  ds_read2_b32 v[92:93], v53 offset0:16 offset1:17
  ds_read2_b32 v[94:95], v53 offset0:18 offset1:19
  s_waitcnt lgkmcnt(6)
  v_mfma_f32_16x16x32_bf16 v[72:75], v[96:99], a[24:27], v[72:75]
  v_mfma_f32_16x16x32_bf16 v[76:79], v[96:99], a[56:59], v[76:79]
  v_mfma_f32_16x16x32_bf16 v[80:83], v[96:99], a[88:91], v[80:83]
  v_mfma_f32_16x16x32_bf16 v[84:87], v[96:99], a[120:123], v[84:87]
  v_mfma_f32_16x16x32_bf16 v[88:91], v[96:99], a[152:155], v[88:91]
  ds_read2_b32 v[96:97], v53 offset0:0 offset1:1
  ds_read2_b32 v[98:99], v53 offset0:2 offset1:3
  s_waitcnt lgkmcnt(6)
  v_mfma_f32_16x16x32_bf16 v[72:75], v[100:103], a[20:23], v[72:75]
  v_mfma_f32_16x16x32_bf16 v[76:79], v[100:103], a[52:55], v[76:79]
  v_mfma_f32_16x16x32_bf16 v[80:83], v[100:103], a[84:87], v[80:83]
  v_mfma_f32_16x16x32_bf16 v[84:87], v[100:103], a[116:119], v[84:87]
  v_mfma_f32_16x16x32_bf16 v[88:91], v[100:103], a[148:151], v[88:91]
  ds_read2_b32 v[100:101], v54 offset0:224 offset1:225
  ds_read2_b32 v[102:103], v54 offset0:226 offset1:227
  s_waitcnt lgkmcnt(6)
  v_mfma_f32_16x16x32_bf16 v[72:75], v[104:107], a[16:19], v[72:75]
  v_mfma_f32_16x16x32_bf16 v[76:79], v[104:107], a[48:51], v[76:79]
  v_mfma_f32_16x16x32_bf16 v[80:83], v[104:107], a[80:83], v[80:83]
  v_mfma_f32_16x16x32_bf16 v[84:87], v[104:107], a[112:115], v[84:87]
  v_mfma_f32_16x16x32_bf16 v[88:91], v[104:107], a[144:147], v[88:91]
  ds_read2_b32 v[104:105], v54 offset0:208 offset1:209
  ds_read2_b32 v[106:107], v54 offset0:210 offset1:211
  s_waitcnt lgkmcnt(6)
  v_mfma_f32_16x16x32_bf16 v[72:75], v[92:95], a[12:15], v[72:75]
  v_mfma_f32_16x16x32_bf16 v[76:79], v[92:95], a[44:47], v[76:79]
  v_mfma_f32_16x16x32_bf16 v[80:83], v[92:95], a[76:79], v[80:83]
  v_mfma_f32_16x16x32_bf16 v[84:87], v[92:95], a[108:111], v[84:87]
  v_mfma_f32_16x16x32_bf16 v[88:91], v[92:95], a[140:143], v[88:91]
  ds_read2_b32 v[92:93], v54 offset0:192 offset1:193
  ds_read2_b32 v[94:95], v54 offset0:194 offset1:195
  s_waitcnt lgkmcnt(6)
  v_mfma_f32_16x16x32_bf16 v[72:75], v[96:99], a[8:11], v[72:75]
  v_mfma_f32_16x16x32_bf16 v[76:79], v[96:99], a[40:43], v[76:79]
  v_mfma_f32_16x16x32_bf16 v[80:83], v[96:99], a[72:75], v[80:83]
  v_mfma_f32_16x16x32_bf16 v[84:87], v[96:99], a[104:107], v[84:87]
  v_mfma_f32_16x16x32_bf16 v[88:91], v[96:99], a[136:139], v[88:91]
  ds_read2_b32 v[96:97], v54 offset0:176 offset1:177
  ds_read2_b32 v[98:99], v54 offset0:178 offset1:179
  s_waitcnt lgkmcnt(6)
  v_mfma_f32_16x16x32_bf16 v[72:75], v[100:103], a[4:7], v[72:75]
  v_mfma_f32_16x16x32_bf16 v[76:79], v[100:103], a[36:39], v[76:79]
  v_mfma_f32_16x16x32_bf16 v[80:83], v[100:103], a[68:71], v[80:83]
  v_mfma_f32_16x16x32_bf16 v[84:87], v[100:103], a[100:103], v[84:87]
  v_mfma_f32_16x16x32_bf16 v[88:91], v[100:103], a[132:135], v[88:91]
  ds_read2_b32 v[100:101], v54 offset0:160 offset1:161
  ds_read2_b32 v[102:103], v54 offset0:162 offset1:163
  s_waitcnt lgkmcnt(6)
  v_mfma_f32_16x16x32_bf16 v[72:75], v[104:107], a[0:3], v[72:75]
  v_mfma_f32_16x16x32_bf16 v[76:79], v[104:107], a[32:35], v[76:79]
  v_mfma_f32_16x16x32_bf16 v[80:83], v[104:107], a[64:67], v[80:83]
  v_mfma_f32_16x16x32_bf16 v[84:87], v[104:107], a[96:99], v[84:87]
  v_mfma_f32_16x16x32_bf16 v[88:91], v[104:107], a[128:131], v[88:91]
  ds_read2_b32 v[104:105], v54 offset0:144 offset1:145
  ds_read2_b32 v[106:107], v54 offset0:146 offset1:147
  s_waitcnt lgkmcnt(6)
  v_mfma_f32_16x16x32_bf16 v[76:79], v[92:95], a[28:31], v[76:79]
  v_mfma_f32_16x16x32_bf16 v[80:83], v[92:95], a[60:63], v[80:83]
  v_mfma_f32_16x16x32_bf16 v[84:87], v[92:95], a[92:95], v[84:87]
  v_mfma_f32_16x16x32_bf16 v[88:91], v[92:95], a[124:127], v[88:91]
  ds_read2_b32 v[92:93], v54 offset0:128 offset1:129
  ds_read2_b32 v[94:95], v54 offset0:130 offset1:131
  s_waitcnt lgkmcnt(6)
  v_mfma_f32_16x16x32_bf16 v[76:79], v[96:99], a[24:27], v[76:79]
  v_mfma_f32_16x16x32_bf16 v[80:83], v[96:99], a[56:59], v[80:83]
  v_mfma_f32_16x16x32_bf16 v[84:87], v[96:99], a[88:91], v[84:87]
  v_mfma_f32_16x16x32_bf16 v[88:91], v[96:99], a[120:123], v[88:91]
  ds_read2_b32 v[96:97], v54 offset0:112 offset1:113
  ds_read2_b32 v[98:99], v54 offset0:114 offset1:115
  s_waitcnt lgkmcnt(6)
  v_mfma_f32_16x16x32_bf16 v[76:79], v[100:103], a[20:23], v[76:79]
  v_mfma_f32_16x16x32_bf16 v[80:83], v[100:103], a[52:55], v[80:83]
  v_mfma_f32_16x16x32_bf16 v[84:87], v[100:103], a[84:87], v[84:87]
  v_mfma_f32_16x16x32_bf16 v[88:91], v[100:103], a[116:119], v[88:91]
  ds_read2_b32 v[100:101], v54 offset0:96 offset1:97
  ds_read2_b32 v[102:103], v54 offset0:98 offset1:99
  s_waitcnt lgkmcnt(6)
  v_mfma_f32_16x16x32_bf16 v[76:79], v[104:107], a[16:19], v[76:79]
  v_mfma_f32_16x16x32_bf16 v[80:83], v[104:107], a[48:51], v[80:83]
  v_mfma_f32_16x16x32_bf16 v[84:87], v[104:107], a[80:83], v[84:87]
  v_mfma_f32_16x16x32_bf16 v[88:91], v[104:107], a[112:115], v[88:91]
  ds_read2_b32 v[104:105], v54 offset0:80 offset1:81
  ds_read2_b32 v[106:107], v54 offset0:82 offset1:83
  s_waitcnt lgkmcnt(6)
  v_mfma_f32_16x16x32_bf16 v[76:79], v[92:95], a[12:15], v[76:79]
  v_mfma_f32_16x16x32_bf16 v[80:83], v[92:95], a[44:47], v[80:83]
  v_mfma_f32_16x16x32_bf16 v[84:87], v[92:95], a[76:79], v[84:87]
  v_mfma_f32_16x16x32_bf16 v[88:91], v[92:95], a[108:111], v[88:91]
  ds_read2_b32 v[92:93], v54 offset0:64 offset1:65
  ds_read2_b32 v[94:95], v54 offset0:66 offset1:67
  s_waitcnt lgkmcnt(6)
  v_mfma_f32_16x16x32_bf16 v[76:79], v[96:99], a[8:11], v[76:79]
  v_mfma_f32_16x16x32_bf16 v[80:83], v[96:99], a[40:43], v[80:83]
  v_mfma_f32_16x16x32_bf16 v[84:87], v[96:99], a[72:75], v[84:87]
  v_mfma_f32_16x16x32_bf16 v[88:91], v[96:99], a[104:107], v[88:91]
  ds_read2_b32 v[96:97], v54 offset0:48 offset1:49
  ds_read2_b32 v[98:99], v54 offset0:50 offset1:51
  s_waitcnt lgkmcnt(6)
  v_mfma_f32_16x16x32_bf16 v[76:79], v[100:103], a[4:7], v[76:79]
  v_mfma_f32_16x16x32_bf16 v[80:83], v[100:103], a[36:39], v[80:83]
  v_mfma_f32_16x16x32_bf16 v[84:87], v[100:103], a[68:71], v[84:87]
  v_mfma_f32_16x16x32_bf16 v[88:91], v[100:103], a[100:103], v[88:91]
  ds_read2_b32 v[100:101], v54 offset0:32 offset1:33
  ds_read2_b32 v[102:103], v54 offset0:34 offset1:35
  s_waitcnt lgkmcnt(6)
  v_mfma_f32_16x16x32_bf16 v[76:79], v[104:107], a[0:3], v[76:79]
  v_mfma_f32_16x16x32_bf16 v[80:83], v[104:107], a[32:35], v[80:83]
  v_mfma_f32_16x16x32_bf16 v[84:87], v[104:107], a[64:67], v[84:87]
  v_mfma_f32_16x16x32_bf16 v[88:91], v[104:107], a[96:99], v[88:91]
  ds_read2_b32 v[104:105], v54 offset0:16 offset1:17
  ds_read2_b32 v[106:107], v54 offset0:18 offset1:19
  s_waitcnt lgkmcnt(6)
  v_mfma_f32_16x16x32_bf16 v[80:83], v[92:95], a[28:31], v[80:83]
  v_mfma_f32_16x16x32_bf16 v[84:87], v[92:95], a[60:63], v[84:87]
  v_mfma_f32_16x16x32_bf16 v[88:91], v[92:95], a[92:95], v[88:91]
  ds_read2_b32 v[92:93], v54 offset0:0 offset1:1
  ds_read2_b32 v[94:95], v54 offset0:2 offset1:3
  s_waitcnt lgkmcnt(6)
  v_mfma_f32_16x16x32_bf16 v[80:83], v[96:99], a[24:27], v[80:83]
  v_mfma_f32_16x16x32_bf16 v[84:87], v[96:99], a[56:59], v[84:87]
  v_mfma_f32_16x16x32_bf16 v[88:91], v[96:99], a[88:91], v[88:91]
  ds_read2_b32 v[96:97], v55 offset0:224 offset1:225
  ds_read2_b32 v[98:99], v55 offset0:226 offset1:227
  s_waitcnt lgkmcnt(6)
  v_mfma_f32_16x16x32_bf16 v[80:83], v[100:103], a[20:23], v[80:83]
  v_mfma_f32_16x16x32_bf16 v[84:87], v[100:103], a[52:55], v[84:87]
  v_mfma_f32_16x16x32_bf16 v[88:91], v[100:103], a[84:87], v[88:91]
  ds_read2_b32 v[100:101], v55 offset0:208 offset1:209
  ds_read2_b32 v[102:103], v55 offset0:210 offset1:211
  s_waitcnt lgkmcnt(6)
  v_mfma_f32_16x16x32_bf16 v[80:83], v[104:107], a[16:19], v[80:83]
  v_mfma_f32_16x16x32_bf16 v[84:87], v[104:107], a[48:51], v[84:87]
  v_mfma_f32_16x16x32_bf16 v[88:91], v[104:107], a[80:83], v[88:91]
  ds_read2_b32 v[104:105], v55 offset0:192 offset1:193
  ds_read2_b32 v[106:107], v55 offset0:194 offset1:195
  s_waitcnt lgkmcnt(6)
  v_mfma_f32_16x16x32_bf16 v[80:83], v[92:95], a[12:15], v[80:83]
  v_mfma_f32_16x16x32_bf16 v[84:87], v[92:95], a[44:47], v[84:87]
  v_mfma_f32_16x16x32_bf16 v[88:91], v[92:95], a[76:79], v[88:91]
  ds_read2_b32 v[92:93], v55 offset0:176 offset1:177
  ds_read2_b32 v[94:95], v55 offset0:178 offset1:179
  s_waitcnt lgkmcnt(6)
  v_mfma_f32_16x16x32_bf16 v[80:83], v[96:99], a[8:11], v[80:83]
  v_mfma_f32_16x16x32_bf16 v[84:87], v[96:99], a[40:43], v[84:87]
  v_mfma_f32_16x16x32_bf16 v[88:91], v[96:99], a[72:75], v[88:91]
  ds_read2_b32 v[96:97], v55 offset0:160 offset1:161
  ds_read2_b32 v[98:99], v55 offset0:162 offset1:163
  s_waitcnt lgkmcnt(6)
  v_mfma_f32_16x16x32_bf16 v[80:83], v[100:103], a[4:7], v[80:83]
  v_mfma_f32_16x16x32_bf16 v[84:87], v[100:103], a[36:39], v[84:87]
  v_mfma_f32_16x16x32_bf16 v[88:91], v[100:103], a[68:71], v[88:91]
  ds_read2_b32 v[100:101], v55 offset0:144 offset1:145
  ds_read2_b32 v[102:103], v55 offset0:146 offset1:147
  s_waitcnt lgkmcnt(6)
  v_mfma_f32_16x16x32_bf16 v[80:83], v[104:107], a[0:3], v[80:83]
  v_mfma_f32_16x16x32_bf16 v[84:87], v[104:107], a[32:35], v[84:87]
  v_mfma_f32_16x16x32_bf16 v[88:91], v[104:107], a[64:67], v[88:91]
  ds_read2_b32 v[104:105], v55 offset0:128 offset1:129
  ds_read2_b32 v[106:107], v55 offset0:130 offset1:131
  s_waitcnt lgkmcnt(6)
  v_mfma_f32_16x16x32_bf16 v[84:87], v[92:95], a[28:31], v[84:87]
  v_mfma_f32_16x16x32_bf16 v[88:91], v[92:95], a[60:63], v[88:91]
  ds_read2_b32 v[92:93], v55 offset0:112 offset1:113
  ds_read2_b32 v[94:95], v55 offset0:114 offset1:115
  s_waitcnt lgkmcnt(6)
  v_mfma_f32_16x16x32_bf16 v[84:87], v[96:99], a[24:27], v[84:87]
  v_mfma_f32_16x16x32_bf16 v[88:91], v[96:99], a[56:59], v[88:91]
  ds_read2_b32 v[96:97], v55 offset0:96 offset1:97
  ds_read2_b32 v[98:99], v55 offset0:98 offset1:99
  s_waitcnt lgkmcnt(6)
  v_mfma_f32_16x16x32_bf16 v[84:87], v[100:103], a[20:23], v[84:87]
  v_mfma_f32_16x16x32_bf16 v[88:91], v[100:103], a[52:55], v[88:91]
  ds_read2_b32 v[100:101], v55 offset0:80 offset1:81
  ds_read2_b32 v[102:103], v55 offset0:82 offset1:83
  s_waitcnt lgkmcnt(6)
  v_mfma_f32_16x16x32_bf16 v[84:87], v[104:107], a[16:19], v[84:87]
  v_mfma_f32_16x16x32_bf16 v[88:91], v[104:107], a[48:51], v[88:91]
  ds_read2_b32 v[104:105], v55 offset0:64 offset1:65
  ds_read2_b32 v[106:107], v55 offset0:66 offset1:67
  s_waitcnt lgkmcnt(6)
  v_mfma_f32_16x16x32_bf16 v[84:87], v[92:95], a[12:15], v[84:87]
  v_mfma_f32_16x16x32_bf16 v[88:91], v[92:95], a[44:47], v[88:91]
  ds_read2_b32 v[92:93], v55 offset0:48 offset1:49
  ds_read2_b32 v[94:95], v55 offset0:50 offset1:51
  s_waitcnt lgkmcnt(6)
  v_mfma_f32_16x16x32_bf16 v[84:87], v[96:99], a[8:11], v[84:87]
  v_mfma_f32_16x16x32_bf16 v[88:91], v[96:99], a[40:43], v[88:91]
  ds_read2_b32 v[96:97], v55 offset0:32 offset1:33
  ds_read2_b32 v[98:99], v55 offset0:34 offset1:35
  s_waitcnt lgkmcnt(6)
  v_mfma_f32_16x16x32_bf16 v[84:87], v[100:103], a[4:7], v[84:87]
  v_mfma_f32_16x16x32_bf16 v[88:91], v[100:103], a[36:39], v[88:91]
  ds_read2_b32 v[100:101], v55 offset0:16 offset1:17
  ds_read2_b32 v[102:103], v55 offset0:18 offset1:19
  s_waitcnt lgkmcnt(6)
  v_mfma_f32_16x16x32_bf16 v[84:87], v[104:107], a[0:3], v[84:87]
  v_mfma_f32_16x16x32_bf16 v[88:91], v[104:107], a[32:35], v[88:91]
  ds_read2_b32 v[104:105], v55 offset0:0 offset1:1
  ds_read2_b32 v[106:107], v55 offset0:2 offset1:3
  s_waitcnt lgkmcnt(6)
  v_mfma_f32_16x16x32_bf16 v[88:91], v[92:95], a[28:31], v[88:91]
  ds_read2_b32 v[92:93], v56 offset0:224 offset1:225
  ds_read2_b32 v[94:95], v56 offset0:226 offset1:227
  s_waitcnt lgkmcnt(6)
  v_mfma_f32_16x16x32_bf16 v[88:91], v[96:99], a[24:27], v[88:91]
  ds_read2_b32 v[96:97], v56 offset0:208 offset1:209
  ds_read2_b32 v[98:99], v56 offset0:210 offset1:211
  s_waitcnt lgkmcnt(6)
  v_mfma_f32_16x16x32_bf16 v[88:91], v[100:103], a[20:23], v[88:91]
  ds_read2_b32 v[100:101], v56 offset0:192 offset1:193
  ds_read2_b32 v[102:103], v56 offset0:194 offset1:195
  s_waitcnt lgkmcnt(6)
  v_mfma_f32_16x16x32_bf16 v[88:91], v[104:107], a[16:19], v[88:91]
  ds_read2_b32 v[104:105], v56 offset0:176 offset1:177
  ds_read2_b32 v[106:107], v56 offset0:178 offset1:179
  s_waitcnt lgkmcnt(6)
  v_mfma_f32_16x16x32_bf16 v[88:91], v[92:95], a[12:15], v[88:91]
  s_waitcnt lgkmcnt(4)
  v_mfma_f32_16x16x32_bf16 v[88:91], v[96:99], a[8:11], v[88:91]
  s_waitcnt lgkmcnt(2)
  v_mfma_f32_16x16x32_bf16 v[88:91], v[100:103], a[4:7], v[88:91]
  s_waitcnt lgkmcnt(0)
  v_mfma_f32_16x16x32_bf16 v[88:91], v[104:107], a[0:3], v[88:91]
  v_lshlrev_b32 v46, 5, v4
  v_lshl_add_u32 v46, v3, 3, v46
  v_add_u32 v46, s17, v46
  ds_read_b64 v[108:109], v46 offset:512
  ds_read_b64 v[110:111], v46 offset:1024
  ds_read_b64 v[112:113], v46 offset:1536
  ds_read_b64 v[114:115], v46 offset:2048
  ds_read_b64 v[116:117], v46 offset:2560
  ds_read_b64 v[118:119], v46 offset:3072
  ds_read_b64 v[120:121], v46 offset:3584
  ds_read_b64 v[122:123], v46 offset:4096
  s_waitcnt lgkmcnt(0)
  v_lshlrev_b32 v124, 16, v108
  v_and_b32 v125, 0xffff0000, v108
  v_lshlrev_b32 v126, 16, v109
  v_and_b32 v127, 0xffff0000, v109
  v_mul_f32 v124, v124, v33
  v_mul_f32 v125, v125, v33
  v_mul_f32 v126, v126, v33
  v_mul_f32 v127, v127, v33
  v_cvt_pk_bf16_f32 v128, v124, v125
  v_cvt_pk_bf16_f32 v129, v126, v127
  v_cvt_pk_bf16_f32 v130, v60, v61
  v_cvt_pk_bf16_f32 v131, v62, v63
  v_lshlrev_b32 v124, 16, v128
  v_and_b32 v125, 0xffff0000, v128
  v_lshlrev_b32 v132, 16, v130
  v_and_b32 v133, 0xffff0000, v130
  v_lshlrev_b32 v126, 16, v129
  v_and_b32 v127, 0xffff0000, v129
  v_lshlrev_b32 v134, 16, v131
  v_and_b32 v135, 0xffff0000, v131
  v_add_f32 v124, v124, v132
  v_add_f32 v125, v125, v133
  v_add_f32 v126, v126, v134
  v_add_f32 v127, v127, v135
  v_cvt_pk_bf16_f32 v108, v124, v125
  v_cvt_pk_bf16_f32 v109, v126, v127
  ds_write_b64 v46, v[108:109] offset:512
  v_lshlrev_b32 v124, 16, v110
  v_and_b32 v125, 0xffff0000, v110
  v_lshlrev_b32 v126, 16, v111
  v_and_b32 v127, 0xffff0000, v111
  v_mul_f32 v124, v124, v33
  v_mul_f32 v125, v125, v33
  v_mul_f32 v126, v126, v33
  v_mul_f32 v127, v127, v33
  v_cvt_pk_bf16_f32 v128, v124, v125
  v_cvt_pk_bf16_f32 v129, v126, v127
  v_cvt_pk_bf16_f32 v130, v64, v65
  v_cvt_pk_bf16_f32 v131, v66, v67
  v_lshlrev_b32 v124, 16, v128
  v_and_b32 v125, 0xffff0000, v128
  v_lshlrev_b32 v132, 16, v130
  v_and_b32 v133, 0xffff0000, v130
  v_lshlrev_b32 v126, 16, v129
  v_and_b32 v127, 0xffff0000, v129
  v_lshlrev_b32 v134, 16, v131
  v_and_b32 v135, 0xffff0000, v131
  v_add_f32 v124, v124, v132
  v_add_f32 v125, v125, v133
  v_add_f32 v126, v126, v134
  v_add_f32 v127, v127, v135
  v_cvt_pk_bf16_f32 v110, v124, v125
  v_cvt_pk_bf16_f32 v111, v126, v127
  ds_write_b64 v46, v[110:111] offset:1024
  v_lshlrev_b32 v124, 16, v112
  v_and_b32 v125, 0xffff0000, v112
  v_lshlrev_b32 v126, 16, v113
  v_and_b32 v127, 0xffff0000, v113
  v_mul_f32 v124, v124, v33
  v_mul_f32 v125, v125, v33
  v_mul_f32 v126, v126, v33
  v_mul_f32 v127, v127, v33
  v_cvt_pk_bf16_f32 v128, v124, v125
  v_cvt_pk_bf16_f32 v129, v126, v127
  v_cvt_pk_bf16_f32 v130, v68, v69
  v_cvt_pk_bf16_f32 v131, v70, v71
  v_lshlrev_b32 v124, 16, v128
  v_and_b32 v125, 0xffff0000, v128
  v_lshlrev_b32 v132, 16, v130
  v_and_b32 v133, 0xffff0000, v130
  v_lshlrev_b32 v126, 16, v129
  v_and_b32 v127, 0xffff0000, v129
  v_lshlrev_b32 v134, 16, v131
  v_and_b32 v135, 0xffff0000, v131
  v_add_f32 v124, v124, v132
  v_add_f32 v125, v125, v133
  v_add_f32 v126, v126, v134
  v_add_f32 v127, v127, v135
  v_cvt_pk_bf16_f32 v112, v124, v125
  v_cvt_pk_bf16_f32 v113, v126, v127
  ds_write_b64 v46, v[112:113] offset:1536
  v_lshlrev_b32 v124, 16, v114
  v_and_b32 v125, 0xffff0000, v114
  v_lshlrev_b32 v126, 16, v115
  v_and_b32 v127, 0xffff0000, v115
  v_mul_f32 v124, v124, v33
  v_mul_f32 v125, v125, v33
  v_mul_f32 v126, v126, v33
  v_mul_f32 v127, v127, v33
  v_cvt_pk_bf16_f32 v128, v124, v125
  v_cvt_pk_bf16_f32 v129, v126, v127
  v_cvt_pk_bf16_f32 v130, v72, v73
  v_cvt_pk_bf16_f32 v131, v74, v75
  v_lshlrev_b32 v124, 16, v128
  v_and_b32 v125, 0xffff0000, v128
  v_lshlrev_b32 v132, 16, v130
  v_and_b32 v133, 0xffff0000, v130
  v_lshlrev_b32 v126, 16, v129
  v_and_b32 v127, 0xffff0000, v129
  v_lshlrev_b32 v134, 16, v131
  v_and_b32 v135, 0xffff0000, v131
  v_add_f32 v124, v124, v132
  v_add_f32 v125, v125, v133
  v_add_f32 v126, v126, v134
  v_add_f32 v127, v127, v135
  v_cvt_pk_bf16_f32 v114, v124, v125
  v_cvt_pk_bf16_f32 v115, v126, v127
  ds_write_b64 v46, v[114:115] offset:2048
  v_lshlrev_b32 v124, 16, v116
  v_and_b32 v125, 0xffff0000, v116
  v_lshlrev_b32 v126, 16, v117
  v_and_b32 v127, 0xffff0000, v117
  v_mul_f32 v124, v124, v33
  v_mul_f32 v125, v125, v33
  v_mul_f32 v126, v126, v33
  v_mul_f32 v127, v127, v33
  v_cvt_pk_bf16_f32 v128, v124, v125
  v_cvt_pk_bf16_f32 v129, v126, v127
  v_cvt_pk_bf16_f32 v130, v76, v77
  v_cvt_pk_bf16_f32 v131, v78, v79
  v_lshlrev_b32 v124, 16, v128
  v_and_b32 v125, 0xffff0000, v128
  v_lshlrev_b32 v132, 16, v130
  v_and_b32 v133, 0xffff0000, v130
  v_lshlrev_b32 v126, 16, v129
  v_and_b32 v127, 0xffff0000, v129
  v_lshlrev_b32 v134, 16, v131
  v_and_b32 v135, 0xffff0000, v131
  v_add_f32 v124, v124, v132
  v_add_f32 v125, v125, v133
  v_add_f32 v126, v126, v134
  v_add_f32 v127, v127, v135
  v_cvt_pk_bf16_f32 v116, v124, v125
  v_cvt_pk_bf16_f32 v117, v126, v127
  ds_write_b64 v46, v[116:117] offset:2560
  v_lshlrev_b32 v124, 16, v118
  v_and_b32 v125, 0xffff0000, v118
  v_lshlrev_b32 v126, 16, v119
  v_and_b32 v127, 0xffff0000, v119
  v_mul_f32 v124, v124, v33
  v_mul_f32 v125, v125, v33
  v_mul_f32 v126, v126, v33
  v_mul_f32 v127, v127, v33
  v_cvt_pk_bf16_f32 v128, v124, v125
  v_cvt_pk_bf16_f32 v129, v126, v127
  v_cvt_pk_bf16_f32 v130, v80, v81
  v_cvt_pk_bf16_f32 v131, v82, v83
  v_lshlrev_b32 v124, 16, v128
  v_and_b32 v125, 0xffff0000, v128
  v_lshlrev_b32 v132, 16, v130
  v_and_b32 v133, 0xffff0000, v130
  v_lshlrev_b32 v126, 16, v129
  v_and_b32 v127, 0xffff0000, v129
  v_lshlrev_b32 v134, 16, v131
  v_and_b32 v135, 0xffff0000, v131
  v_add_f32 v124, v124, v132
  v_add_f32 v125, v125, v133
  v_add_f32 v126, v126, v134
  v_add_f32 v127, v127, v135
  v_cvt_pk_bf16_f32 v118, v124, v125
  v_cvt_pk_bf16_f32 v119, v126, v127
  ds_write_b64 v46, v[118:119] offset:3072
  v_lshlrev_b32 v124, 16, v120
  v_and_b32 v125, 0xffff0000, v120
  v_lshlrev_b32 v126, 16, v121
  v_and_b32 v127, 0xffff0000, v121
  v_mul_f32 v124, v124, v33
  v_mul_f32 v125, v125, v33
  v_mul_f32 v126, v126, v33
  v_mul_f32 v127, v127, v33
  v_cvt_pk_bf16_f32 v128, v124, v125
  v_cvt_pk_bf16_f32 v129, v126, v127
  v_cvt_pk_bf16_f32 v130, v84, v85
  v_cvt_pk_bf16_f32 v131, v86, v87
  v_lshlrev_b32 v124, 16, v128
  v_and_b32 v125, 0xffff0000, v128
  v_lshlrev_b32 v132, 16, v130
  v_and_b32 v133, 0xffff0000, v130
  v_lshlrev_b32 v126, 16, v129
  v_and_b32 v127, 0xffff0000, v129
  v_lshlrev_b32 v134, 16, v131
  v_and_b32 v135, 0xffff0000, v131
  v_add_f32 v124, v124, v132
  v_add_f32 v125, v125, v133
  v_add_f32 v126, v126, v134
  v_add_f32 v127, v127, v135
  v_cvt_pk_bf16_f32 v120, v124, v125
  v_cvt_pk_bf16_f32 v121, v126, v127
  ds_write_b64 v46, v[120:121] offset:3584
  v_lshlrev_b32 v124, 16, v122
  v_and_b32 v125, 0xffff0000, v122
  v_lshlrev_b32 v126, 16, v123
  v_and_b32 v127, 0xffff0000, v123
  v_mul_f32 v124, v124, v33
  v_mul_f32 v125, v125, v33
  v_mul_f32 v126, v126, v33
  v_mul_f32 v127, v127, v33
  v_cvt_pk_bf16_f32 v128, v124, v125
  v_cvt_pk_bf16_f32 v129, v126, v127
  v_cvt_pk_bf16_f32 v130, v88, v89
  v_cvt_pk_bf16_f32 v131, v90, v91
  v_lshlrev_b32 v124, 16, v128
  v_and_b32 v125, 0xffff0000, v128
  v_lshlrev_b32 v132, 16, v130
  v_and_b32 v133, 0xffff0000, v130
  v_lshlrev_b32 v126, 16, v129
  v_and_b32 v127, 0xffff0000, v129
  v_lshlrev_b32 v134, 16, v131
  v_and_b32 v135, 0xffff0000, v131
  v_add_f32 v124, v124, v132
  v_add_f32 v125, v125, v133
  v_add_f32 v126, v126, v134
  v_add_f32 v127, v127, v135
  v_cvt_pk_bf16_f32 v122, v124, v125
  v_cvt_pk_bf16_f32 v123, v126, v127
  ds_write_b64 v46, v[122:123] offset:4096
  s_waitcnt lgkmcnt(0)
  s_barrier
  v_lshlrev_b32 v6, 3, v0
  v_mul_u32_u24 v5, 7168, v0
  v_add_u32 v36, 512, v6
  ds_read_b64 v[8:9], v36
  v_add_u32 v36, 25088, v6
  ds_read_b64 v[10:11], v36
  v_add_u32 v36, 49664, v6
  ds_read_b64 v[12:13], v36
  v_add_u32 v36, 74240, v6
  ds_read_b64 v[14:15], v36
  s_waitcnt lgkmcnt(0)
  s_add_u32 s22, s21, 0
  s_add_u32 s23, s22, 3584
  v_perm_b32 v16, v10, v8, s24
  v_perm_b32 v17, v14, v12, s24
  buffer_store_dwordx2 v[16:17], v5, s[88:91], s22 offen offset:0
  v_perm_b32 v18, v10, v8, s25
  v_perm_b32 v19, v14, v12, s25
  buffer_store_dwordx2 v[18:19], v5, s[88:91], s22 offen offset:1792
  v_perm_b32 v20, v11, v9, s24
  v_perm_b32 v21, v15, v13, s24
  buffer_store_dwordx2 v[20:21], v5, s[88:91], s23 offen offset:0
  v_perm_b32 v22, v11, v9, s25
  v_perm_b32 v23, v15, v13, s25
  buffer_store_dwordx2 v[22:23], v5, s[88:91], s23 offen offset:1792
  v_add_u32 v36, 2560, v6
  ds_read_b64 v[8:9], v36
  v_add_u32 v36, 27136, v6
  ds_read_b64 v[10:11], v36
  v_add_u32 v36, 51712, v6
  ds_read_b64 v[12:13], v36
  v_add_u32 v36, 76288, v6
  ds_read_b64 v[14:15], v36
  s_waitcnt lgkmcnt(0)
  s_add_u32 s22, s21, 1835008
  s_add_u32 s23, s22, 3584
  v_perm_b32 v24, v10, v8, s24
  v_perm_b32 v25, v14, v12, s24
  buffer_store_dwordx2 v[24:25], v5, s[88:91], s22 offen offset:0
  v_perm_b32 v26, v10, v8, s25
  v_perm_b32 v27, v14, v12, s25
  buffer_store_dwordx2 v[26:27], v5, s[88:91], s22 offen offset:1792
  v_perm_b32 v28, v11, v9, s24
  v_perm_b32 v29, v15, v13, s24
  buffer_store_dwordx2 v[28:29], v5, s[88:91], s23 offen offset:0
  v_perm_b32 v30, v11, v9, s25
  v_perm_b32 v31, v15, v13, s25
  buffer_store_dwordx2 v[30:31], v5, s[88:91], s23 offen offset:1792
  s_branch wk_loop
wk_tok:
  s_sub_u32 s3, s3, 736
  s_cmp_ge_u32 s3, 512
  s_cbranch_scc1 wk_done
  s_lshr_b32 s17, s3, 3
  s_and_b32 s18, s3, 3
  s_bitcmp1_b32 s3, 2
  s_cbranch_scc1 wk_toko
  s_lshl_b32 s20, s18, 2
  s_add_u32 s20, s20, s16
  s_lshl_b32 s21, s17, 4
  s_add_u32 s21, s21, s20
  s_mul_i32 s21, s21, 28672
  s_add_u32 s21, s21, 12845056
  s_mul_i32 s23, s17, 28672
  s_add_u32 s23, s23, 73859072
  s_mul_i32 s24, s17, 7168
  s_add_u32 s24, s24, 88002560
  s_lshr_b32 s25, s17, 3
  s_lshl_b32 s25, s25, 4
  s_add_u32 s25, s25, s20
  s_lshl_b32 s25, s25, 7
  s_add_u32 s25, s25, 88477696
  v_mov_b32 v60, 0
  s_mov_b32 s30, 0
wp_wf:
  buffer_load_dword v61, v60, s[8:11], s25 offen sc1
  s_waitcnt vmcnt(0)
  v_cmp_ne_u32 vcc, 56, v61
  s_cbranch_vccz wp_wf_ok
  s_sleep 4
  s_cmp_ge_u32 s17, 56
  s_cbranch_scc1 wp_wf_bo
  s_sleep 127
wp_wf_bo:
  s_add_u32 s30, s30, 1
  s_cmp_lt_u32 s30, 2000000
  s_cbranch_scc1 wp_wf
  s_branch wp_abort
wp_wf_ok:
  s_add_u32 s22, s21, 0
  buffer_load_dwordx4 a[0:3], v2, s[8:11], s22 offen offset:0 sc1
  buffer_load_dwordx4 a[4:7], v2, s[8:11], s22 offen offset:1024 sc1
  buffer_load_dwordx4 a[8:11], v2, s[8:11], s22 offen offset:2048 sc1
  buffer_load_dwordx4 a[12:15], v2, s[8:11], s22 offen offset:3072 sc1
  s_add_u32 s22, s21, 4096
  buffer_load_dwordx4 a[16:19], v2, s[8:11], s22 offen offset:0 sc1
  buffer_load_dwordx4 a[20:23], v2, s[8:11], s22 offen offset:1024 sc1
  buffer_load_dwordx4 a[24:27], v2, s[8:11], s22 offen offset:2048 sc1
  buffer_load_dwordx4 a[28:31], v2, s[8:11], s22 offen offset:3072 sc1
  s_add_u32 s22, s21, 8192
  buffer_load_dwordx4 a[32:35], v2, s[8:11], s22 offen offset:0 sc1
  buffer_load_dwordx4 a[36:39], v2, s[8:11], s22 offen offset:1024 sc1
  buffer_load_dwordx4 a[40:43], v2, s[8:11], s22 offen offset:2048 sc1
  buffer_load_dwordx4 a[44:47], v2, s[8:11], s22 offen offset:3072 sc1
  s_add_u32 s22, s21, 12288
  buffer_load_dwordx4 a[48:51], v2, s[8:11], s22 offen offset:0 sc1
  buffer_load_dwordx4 a[52:55], v2, s[8:11], s22 offen offset:1024 sc1
  buffer_load_dwordx4 a[56:59], v2, s[8:11], s22 offen offset:2048 sc1
  buffer_load_dwordx4 a[60:63], v2, s[8:11], s22 offen offset:3072 sc1
  s_add_u32 s22, s21, 16384
  buffer_load_dwordx4 a[64:67], v2, s[8:11], s22 offen offset:0 sc1
  buffer_load_dwordx4 a[68:71], v2, s[8:11], s22 offen offset:1024 sc1
  buffer_load_dwordx4 a[72:75], v2, s[8:11], s22 offen offset:2048 sc1
  buffer_load_dwordx4 a[76:79], v2, s[8:11], s22 offen offset:3072 sc1
  s_add_u32 s22, s21, 20480
  buffer_load_dwordx4 a[80:83], v2, s[8:11], s22 offen offset:0 sc1
  buffer_load_dwordx4 a[84:87], v2, s[8:11], s22 offen offset:1024 sc1
  buffer_load_dwordx4 a[88:91], v2, s[8:11], s22 offen offset:2048 sc1
  buffer_load_dwordx4 a[92:95], v2, s[8:11], s22 offen offset:3072 sc1
  s_add_u32 s22, s21, 24576
  buffer_load_dwordx4 a[96:99], v2, s[8:11], s22 offen offset:0 sc1
  buffer_load_dwordx4 a[100:103], v2, s[8:11], s22 offen offset:1024 sc1
  buffer_load_dwordx4 a[104:107], v2, s[8:11], s22 offen offset:2048 sc1
  buffer_load_dwordx4 a[108:111], v2, s[8:11], s22 offen offset:3072 sc1
  s_add_u32 s22, s23, 0
  buffer_load_dwordx4 a[112:115], v2, s[8:11], s22 offen offset:0 sc1
  buffer_load_dwordx4 a[116:119], v2, s[8:11], s22 offen offset:1024 sc1
  buffer_load_dwordx4 a[120:123], v2, s[8:11], s22 offen offset:2048 sc1
  buffer_load_dwordx4 a[124:127], v2, s[8:11], s22 offen offset:3072 sc1
  s_add_u32 s22, s23, 4096
  buffer_load_dwordx4 a[128:131], v2, s[8:11], s22 offen offset:0 sc1
  buffer_load_dwordx4 a[132:135], v2, s[8:11], s22 offen offset:1024 sc1
  buffer_load_dwordx4 a[136:139], v2, s[8:11], s22 offen offset:2048 sc1
  buffer_load_dwordx4 a[140:143], v2, s[8:11], s22 offen offset:3072 sc1
  s_add_u32 s22, s23, 8192
  buffer_load_dwordx4 a[144:147], v2, s[8:11], s22 offen offset:0 sc1
  buffer_load_dwordx4 a[148:151], v2, s[8:11], s22 offen offset:1024 sc1
  buffer_load_dwordx4 a[152:155], v2, s[8:11], s22 offen offset:2048 sc1
  buffer_load_dwordx4 a[156:159], v2, s[8:11], s22 offen offset:3072 sc1
  s_add_u32 s22, s23, 12288
  buffer_load_dwordx4 a[160:163], v2, s[8:11], s22 offen offset:0 sc1
  buffer_load_dwordx4 a[164:167], v2, s[8:11], s22 offen offset:1024 sc1
  buffer_load_dwordx4 a[168:171], v2, s[8:11], s22 offen offset:2048 sc1
  buffer_load_dwordx4 a[172:175], v2, s[8:11], s22 offen offset:3072 sc1
  s_add_u32 s22, s23, 16384
  buffer_load_dwordx4 a[176:179], v2, s[8:11], s22 offen offset:0 sc1
  buffer_load_dwordx4 a[180:183], v2, s[8:11], s22 offen offset:1024 sc1
  buffer_load_dwordx4 a[184:187], v2, s[8:11], s22 offen offset:2048 sc1
  buffer_load_dwordx4 a[188:191], v2, s[8:11], s22 offen offset:3072 sc1
  s_add_u32 s22, s23, 20480
  buffer_load_dwordx4 a[192:195], v2, s[8:11], s22 offen offset:0 sc1
  buffer_load_dwordx4 a[196:199], v2, s[8:11], s22 offen offset:1024 sc1
  buffer_load_dwordx4 a[200:203], v2, s[8:11], s22 offen offset:2048 sc1
  buffer_load_dwordx4 a[204:207], v2, s[8:11], s22 offen offset:3072 sc1
  s_add_u32 s22, s23, 24576
  buffer_load_dwordx4 a[208:211], v2, s[8:11], s22 offen offset:0 sc1
  buffer_load_dwordx4 a[212:215], v2, s[8:11], s22 offen offset:1024 sc1
  buffer_load_dwordx4 a[216:219], v2, s[8:11], s22 offen offset:2048 sc1
  buffer_load_dwordx4 a[220:223], v2, s[8:11], s22 offen offset:3072 sc1
  v_lshl_add_u32 v5, v3, 2, 0
  v_cmp_le_u32 s[40:41], v5, v4
  v_lshl_add_u32 v5, v3, 2, 1
  v_cmp_le_u32 s[42:43], v5, v4
  v_lshl_add_u32 v5, v3, 2, 2
  v_cmp_le_u32 s[44:45], v5, v4
  v_lshl_add_u32 v5, v3, 2, 3
  v_cmp_le_u32 s[46:47], v5, v4
  v_cmp_gt_u32 s[48:49], 2, v3
  v_mov_b32 v6, 0xff800000
  s_waitcnt vmcnt(0)
  v_mfma_f32_16x16x32_bf16 v[8:11], a[112:115], a[0:3], 0
  v_mfma_f32_16x16x32_bf16 v[12:15], a[112:115], a[56:59], 0
  v_mfma_f32_16x16x32_bf16 v[16:19], a[168:171], a[56:59], 0
  v_mfma_f32_16x16x32_bf16 v[8:11], a[116:119], a[4:7], v[8:11]
  v_mfma_f32_16x16x32_bf16 v[12:15], a[116:119], a[60:63], v[12:15]
  v_mfma_f32_16x16x32_bf16 v[16:19], a[172:175], a[60:63], v[16:19]
  v_mfma_f32_16x16x32_bf16 v[8:11], a[120:123], a[8:11], v[8:11]
  v_mfma_f32_16x16x32_bf16 v[12:15], a[120:123], a[64:67], v[12:15]
  v_mfma_f32_16x16x32_bf16 v[16:19], a[176:179], a[64:67], v[16:19]
  v_mfma_f32_16x16x32_bf16 v[8:11], a[124:127], a[12:15], v[8:11]
  v_mfma_f32_16x16x32_bf16 v[12:15], a[124:127], a[68:71], v[12:15]
  v_mfma_f32_16x16x32_bf16 v[16:19], a[180:183], a[68:71], v[16:19]
  v_mfma_f32_16x16x32_bf16 v[8:11], a[128:131], a[16:19], v[8:11]
  v_mfma_f32_16x16x32_bf16 v[12:15], a[128:131], a[72:75], v[12:15]
  v_mfma_f32_16x16x32_bf16 v[16:19], a[184:187], a[72:75], v[16:19]
  v_mfma_f32_16x16x32_bf16 v[8:11], a[132:135], a[20:23], v[8:11]
  v_mfma_f32_16x16x32_bf16 v[12:15], a[132:135], a[76:79], v[12:15]
  v_mfma_f32_16x16x32_bf16 v[16:19], a[188:191], a[76:79], v[16:19]
  v_mfma_f32_16x16x32_bf16 v[8:11], a[136:139], a[24:27], v[8:11]
  v_mfma_f32_16x16x32_bf16 v[12:15], a[136:139], a[80:83], v[12:15]
  v_mfma_f32_16x16x32_bf16 v[16:19], a[192:195], a[80:83], v[16:19]
  v_mfma_f32_16x16x32_bf16 v[8:11], a[140:143], a[28:31], v[8:11]
  v_mfma_f32_16x16x32_bf16 v[12:15], a[140:143], a[84:87], v[12:15]
  v_mfma_f32_16x16x32_bf16 v[16:19], a[196:199], a[84:87], v[16:19]
  v_mfma_f32_16x16x32_bf16 v[8:11], a[144:147], a[32:35], v[8:11]
  v_mfma_f32_16x16x32_bf16 v[12:15], a[144:147], a[88:91], v[12:15]
  v_mfma_f32_16x16x32_bf16 v[16:19], a[200:203], a[88:91], v[16:19]
  v_mfma_f32_16x16x32_bf16 v[8:11], a[148:151], a[36:39], v[8:11]
  v_mfma_f32_16x16x32_bf16 v[12:15], a[148:151], a[92:95], v[12:15]
  v_mfma_f32_16x16x32_bf16 v[16:19], a[204:207], a[92:95], v[16:19]
  v_mfma_f32_16x16x32_bf16 v[8:11], a[152:155], a[40:43], v[8:11]
  v_mfma_f32_16x16x32_bf16 v[12:15], a[152:155], a[96:99], v[12:15]
  v_mfma_f32_16x16x32_bf16 v[16:19], a[208:211], a[96:99], v[16:19]
  v_mfma_f32_16x16x32_bf16 v[8:11], a[156:159], a[44:47], v[8:11]
  v_mfma_f32_16x16x32_bf16 v[12:15], a[156:159], a[100:103], v[12:15]
  v_mfma_f32_16x16x32_bf16 v[16:19], a[212:215], a[100:103], v[16:19]
  v_mfma_f32_16x16x32_bf16 v[8:11], a[160:163], a[48:51], v[8:11]
  v_mfma_f32_16x16x32_bf16 v[12:15], a[160:163], a[104:107], v[12:15]
  v_mfma_f32_16x16x32_bf16 v[16:19], a[216:219], a[104:107], v[16:19]
  v_mfma_f32_16x16x32_bf16 v[8:11], a[164:167], a[52:55], v[8:11]
  v_mfma_f32_16x16x32_bf16 v[12:15], a[164:167], a[108:111], v[12:15]
  v_mfma_f32_16x16x32_bf16 v[16:19], a[220:223], a[108:111], v[16:19]
  s_mul_i32 s22, s20, 448
  v_mov_b32 v62, s22
  s_mov_b32 s30, 0
wp_pm:
  s_cmp_ge_u32 s17, 64
  s_cbranch_scc1 wp_pf
  buffer_load_dword v61, v62, s[8:11], s24 offen sc1
  s_waitcnt vmcnt(0)
  v_cmp_eq_u32 vcc, -1, v61
  s_cbranch_vccnz wp_pr
wp_pf:
  s_add_u32 s22, s24, 4096
  buffer_load_dwordx4 v[64:67], v2, s[8:11], s24 offen offset:0 sc1
  buffer_load_dwordx4 v[68:71], v2, s[8:11], s24 offen offset:1024 sc1
  buffer_load_dwordx4 v[72:75], v2, s[8:11], s24 offen offset:2048 sc1
  buffer_load_dwordx4 v[76:79], v2, s[8:11], s24 offen offset:3072 sc1
  buffer_load_dwordx4 v[80:83], v2, s[8:11], s22 offen offset:0 sc1
  buffer_load_dwordx4 v[84:87], v2, s[8:11], s22 offen offset:1024 sc1
  buffer_load_dwordx4 v[88:91], v2, s[8:11], s22 offen offset:2048 sc1
  s_waitcnt vmcnt(0)
  v_max_u32 v61, v64, v65
  v_max3_u32 v61, v61, v66, v67
  v_max3_u32 v61, v61, v68, v69
  v_max3_u32 v61, v61, v70, v71
  v_max3_u32 v61, v61, v72, v73
  v_max3_u32 v61, v61, v74, v75
  v_max3_u32 v61, v61, v76, v77
  v_max3_u32 v61, v61, v78, v79
  v_max3_u32 v61, v61, v80, v81
  v_max3_u32 v61, v61, v82, v83
  v_max3_u32 v61, v61, v84, v85
  v_max3_u32 v61, v61, v86, v87
  v_max3_u32 v61, v61, v88, v89
  v_max3_u32 v61, v61, v90, v91
  v_cmp_eq_u32 vcc, -1, v61
  s_cbranch_vccz wp_pk
wp_pr:
  s_sleep 4
  s_cmp_ge_u32 s17, 56
  s_cbranch_scc1 wp_pm_bo
  s_sleep 127
wp_pm_bo:
  s_add_u32 s30, s30, 1
  s_cmp_lt_u32 s30, 2000000
  s_cbranch_scc1 wp_pm
  s_branch wp_abort
wp_pk:
  buffer_load_dword v250, v251, s[8:11], 0 offen sc1
  v_mfma_f32_16x16x32_bf16 v[20:23], v[64:67], a[0:3], 0
  v_mfma_f32_16x16x32_bf16 v[24:27], v[64:67], a[4:7], 0
  v_mfma_f32_16x16x32_bf16 v[28:31], v[64:67], a[56:59], 0
  v_mfma_f32_16x16x32_bf16 v[32:35], v[64:67], a[60:63], 0
  v_mfma_f32_16x16x32_bf16 v[20:23], v[68:71], a[8:11], v[20:23]
  v_mfma_f32_16x16x32_bf16 v[24:27], v[68:71], a[12:15], v[24:27]
  v_mfma_f32_16x16x32_bf16 v[28:31], v[68:71], a[64:67], v[28:31]
  v_mfma_f32_16x16x32_bf16 v[32:35], v[68:71], a[68:71], v[32:35]
  v_mfma_f32_16x16x32_bf16 v[20:23], v[72:75], a[16:19], v[20:23]
  v_mfma_f32_16x16x32_bf16 v[24:27], v[72:75], a[20:23], v[24:27]
  v_mfma_f32_16x16x32_bf16 v[28:31], v[72:75], a[72:75], v[28:31]
  v_mfma_f32_16x16x32_bf16 v[32:35], v[72:75], a[76:79], v[32:35]
  v_mfma_f32_16x16x32_bf16 v[20:23], v[76:79], a[24:27], v[20:23]
  v_mfma_f32_16x16x32_bf16 v[24:27], v[76:79], a[28:31], v[24:27]
  v_mfma_f32_16x16x32_bf16 v[28:31], v[76:79], a[80:83], v[28:31]
  v_mfma_f32_16x16x32_bf16 v[32:35], v[76:79], a[84:87], v[32:35]
  v_mfma_f32_16x16x32_bf16 v[20:23], v[80:83], a[32:35], v[20:23]
  v_mfma_f32_16x16x32_bf16 v[24:27], v[80:83], a[36:39], v[24:27]
  v_mfma_f32_16x16x32_bf16 v[28:31], v[80:83], a[88:91], v[28:31]
  v_mfma_f32_16x16x32_bf16 v[32:35], v[80:83], a[92:95], v[32:35]
  v_mfma_f32_16x16x32_bf16 v[20:23], v[84:87], a[40:43], v[20:23]
  v_mfma_f32_16x16x32_bf16 v[24:27], v[84:87], a[44:47], v[24:27]
  v_mfma_f32_16x16x32_bf16 v[28:31], v[84:87], a[96:99], v[28:31]
  v_mfma_f32_16x16x32_bf16 v[32:35], v[84:87], a[100:103], v[32:35]
  v_mfma_f32_16x16x32_bf16 v[20:23], v[88:91], a[48:51], v[20:23]
  v_mfma_f32_16x16x32_bf16 v[24:27], v[88:91], a[52:55], v[24:27]
  v_mfma_f32_16x16x32_bf16 v[28:31], v[88:91], a[104:107], v[28:31]
  v_mfma_f32_16x16x32_bf16 v[32:35], v[88:91], a[108:111], v[32:35]
  s_lshl_b32 s25, s17, 1
  s_mul_i32 s25, s25, 20480
  s_add_u32 s25, s25, 85381120
  s_lshl_b32 s26, s20, 10
  s_add_u32 s26, s26, s25
  s_lshl_b32 s27, s18, 10
  s_add_u32 s27, s27, s25
  s_lshr_b32 s28, s16, 1
  s_lshl_b32 s28, s28, 3
  s_add_u32 s27, s27, s28
  s_add_u32 s27, s27, 16384
  s_and_b32 s28, s16, 1
  s_cmp_eq_u32 s28, 0
  s_cselect_b32 s50, -1, 0
  s_cselect_b32 s51, 0, -1
  v_cndmask_b32 v8, v6, v8, s[40:41]
  v_cndmask_b32 v9, v6, v9, s[42:43]
  v_cndmask_b32 v10, v6, v10, s[44:45]
  v_cndmask_b32 v11, v6, v11, s[46:47]
  v_cndmask_b32 v20, v24, v20, s[48:49]
  v_cndmask_b32 v21, v25, v21, s[48:49]
  v_cndmask_b32 v22, v26, v22, s[48:49]
  v_cndmask_b32 v23, v27, v23, s[48:49]
  v_mov_b32 v24, v20
  v_mov_b32 v25, v21
  v_mov_b32 v26, v22
  v_mov_b32 v27, v23
  v_permlane32_swap_b32 v20, v24
  v_permlane32_swap_b32 v21, v25
  v_permlane32_swap_b32 v22, v26
  v_permlane32_swap_b32 v23, v27
  v_add_f32 v20, v20, v24
  v_add_f32 v21, v21, v25
  v_add_f32 v22, v22, v26
  v_add_f32 v23, v23, v27
  v_max3_f32 v40, v8, v9, v10
  v_max3_f32 v40, v40, v11, v20
  v_max3_f32 v40, v40, v21, v22
  v_max_f32 v40, v40, v23
  v_mov_b32 v41, v40
  s_nop 1
  v_permlane16_swap_b32 v40, v41
  v_max_f32 v40, v40, v41
  v_mov_b32 v41, v40
  s_nop 1
  v_permlane32_swap_b32 v40, v41
  v_max_f32 v40, v40, v41
  v_sub_f32 v8, v8, v40
  v_sub_f32 v9, v9, v40
  v_sub_f32 v10, v10, v40
  v_sub_f32 v11, v11, v40
  v_sub_f32 v20, v20, v40
  v_sub_f32 v21, v21, v40
  v_sub_f32 v22, v22, v40
  v_sub_f32 v23, v23, v40
  v_exp_f32 v8, v8
  v_exp_f32 v9, v9
  v_exp_f32 v10, v10
  v_exp_f32 v11, v11
  v_exp_f32 v20, v20
  v_exp_f32 v21, v21
  v_exp_f32 v22, v22
  v_exp_f32 v23, v23
  v_add_f32 v42, v20, v21
  v_add_f32 v43, v22, v23
  v_add_f32 v42, v42, v43
  v_mul_f32 v42, 0.5, v42
  v_add_f32 v42, v42, v8
  v_add_f32 v42, v42, v9
  v_add_f32 v42, v42, v10
  v_add_f32 v42, v42, v11
  v_mov_b32 v41, v42
  s_nop 1
  v_permlane16_swap_b32 v42, v41
  v_add_f32 v42, v42, v41
  v_mov_b32 v41, v42
  s_nop 1
  v_permlane32_swap_b32 v42, v41
  v_add_f32 v42, v42, v41
  v_rcp_f32 v42, v42
  s_nop 0
  v_mul_f32 v8, v8, v42
  v_mul_f32 v9, v9, v42
  v_mul_f32 v10, v10, v42
  v_mul_f32 v11, v11, v42
  v_mul_f32 v20, v20, v42
  v_mul_f32 v21, v21, v42
  v_mul_f32 v22, v22, v42
  v_mul_f32 v23, v23, v42
  v_cvt_pk_bf16_f32 v44, v8, 0
  v_cvt_pk_bf16_f32 v45, v9, 0
  v_cvt_pk_bf16_f32 v46, v10, 0
  v_cvt_pk_bf16_f32 v47, v11, 0
  v_cvt_pk_bf16_f32 v48, v20, v21
  v_cvt_pk_bf16_f32 v49, v22, v23
  buffer_store_dwordx4 v[44:47], v2, s[8:11], s26 offen sc1
  s_mov_b64 exec, s[50:51]
  buffer_store_dwordx2 v[48:49], v2, s[8:11], s27 offen sc1
  s_mov_b64 exec, -1
  s_add_u32 s26, s26, 20480
  s_add_u32 s27, s27, 20480
  v_cndmask_b32 v16, v6, v16, s[40:41]
  v_cndmask_b32 v17, v6, v17, s[42:43]
  v_cndmask_b32 v18, v6, v18, s[44:45]
  v_cndmask_b32 v19, v6, v19, s[46:47]
  v_cndmask_b32 v28, v32, v28, s[48:49]
  v_cndmask_b32 v29, v33, v29, s[48:49]
  v_cndmask_b32 v30, v34, v30, s[48:49]
  v_cndmask_b32 v31, v35, v31, s[48:49]
  v_mov_b32 v32, v28
  v_mov_b32 v33, v29
  v_mov_b32 v34, v30
  v_mov_b32 v35, v31
  v_permlane32_swap_b32 v28, v32
  v_permlane32_swap_b32 v29, v33
  v_permlane32_swap_b32 v30, v34
  v_permlane32_swap_b32 v31, v35
  v_add_f32 v28, v28, v32
  v_add_f32 v29, v29, v33
  v_add_f32 v30, v30, v34
  v_add_f32 v31, v31, v35
  v_max3_f32 v40, v12, v13, v14
  v_max3_f32 v40, v40, v15, v16
  v_max3_f32 v40, v40, v17, v18
  v_max3_f32 v40, v40, v19, v28
  v_max3_f32 v40, v40, v29, v30
  v_max_f32 v40, v40, v31
  v_mov_b32 v41, v40
  s_nop 1
  v_permlane16_swap_b32 v40, v41
  v_max_f32 v40, v40, v41
  v_mov_b32 v41, v40
  s_nop 1
  v_permlane32_swap_b32 v40, v41
  v_max_f32 v40, v40, v41
  v_sub_f32 v12, v12, v40
  v_sub_f32 v13, v13, v40
  v_sub_f32 v14, v14, v40
  v_sub_f32 v15, v15, v40
  v_sub_f32 v16, v16, v40
  v_sub_f32 v17, v17, v40
  v_sub_f32 v18, v18, v40
  v_sub_f32 v19, v19, v40
  v_sub_f32 v28, v28, v40
  v_sub_f32 v29, v29, v40
  v_sub_f32 v30, v30, v40
  v_sub_f32 v31, v31, v40
  v_exp_f32 v12, v12
  v_exp_f32 v13, v13
  v_exp_f32 v14, v14
  v_exp_f32 v15, v15
  v_exp_f32 v16, v16
  v_exp_f32 v17, v17
  v_exp_f32 v18, v18
  v_exp_f32 v19, v19
  v_exp_f32 v28, v28
  v_exp_f32 v29, v29
  v_exp_f32 v30, v30
  v_exp_f32 v31, v31
  v_add_f32 v42, v28, v29
  v_add_f32 v43, v30, v31
  v_add_f32 v42, v42, v43
  v_mul_f32 v42, 0.5, v42
  v_add_f32 v42, v42, v12
  v_add_f32 v42, v42, v13
  v_add_f32 v42, v42, v14
  v_add_f32 v42, v42, v15
  v_add_f32 v42, v42, v16
  v_add_f32 v42, v42, v17
  v_add_f32 v42, v42, v18
  v_add_f32 v42, v42, v19
  v_mov_b32 v41, v42
  s_nop 1
  v_permlane16_swap_b32 v42, v41
  v_add_f32 v42, v42, v41
  v_mov_b32 v41, v42
  s_nop 1
  v_permlane32_swap_b32 v42, v41
  v_add_f32 v42, v42, v41
  v_rcp_f32 v42, v42
  s_nop 0
  v_mul_f32 v12, v12, v42
  v_mul_f32 v13, v13, v42
  v_mul_f32 v14, v14, v42
  v_mul_f32 v15, v15, v42
  v_mul_f32 v16, v16, v42
  v_mul_f32 v17, v17, v42
  v_mul_f32 v18, v18, v42
  v_mul_f32 v19, v19, v42
  v_mul_f32 v28, v28, v42
  v_mul_f32 v29, v29, v42
  v_mul_f32 v30, v30, v42
  v_mul_f32 v31, v31, v42
  v_cvt_pk_bf16_f32 v52, v12, v16
  v_cvt_pk_bf16_f32 v53, v13, v17
  v_cvt_pk_bf16_f32 v54, v14, v18
  v_cvt_pk_bf16_f32 v55, v15, v19
  v_cvt_pk_bf16_f32 v56, v28, v29
  v_cvt_pk_bf16_f32 v57, v30, v31
  buffer_store_dwordx4 v[52:55], v2, s[8:11], s26 offen sc1
  s_mov_b64 exec, s[50:51]
  buffer_store_dwordx2 v[56:57], v2, s[8:11], s27 offen sc1
  s_mov_b64 exec, -1
  s_lshl_b32 s25, s17, 7
  s_add_u32 s25, s25, 88494080
  v_mov_b32 v5, 1
  v_mov_b32 v6, 0
  s_waitcnt vmcnt(0)
  s_mov_b64 exec, 1
  buffer_atomic_add v5, v6, s[8:11], s25 offen
  s_mov_b64 exec, -1
  s_branch wk_loop
wk_toko:
  s_lshl_b32 s20, s18, 2
  s_add_u32 s20, s20, s16
  s_mul_i32 s24, s20, 65
  s_add_u32 s24, s24, s17
  s_lshl_b32 s24, s24, 13
  s_add_u32 s24, s24, 76869632
  s_mul_i32 s21, s20, 28672
  s_mul_i32 s22, s17, 458752
  s_add_u32 s21, s21, s22
  s_add_u32 s21, s21, 42205184
  s_lshl_b32 s25, s17, 1
  s_mul_i32 s25, s25, 20480
  s_add_u32 s25, s25, 85381120
  v_mov_b32 v5, v2
  v_min_u32 v6, 11, v4
  v_mad_u32_u24 v6, v3, 12, v6
  v_lshlrev_b32 v6, 4, v6
  v_add_u32 v6, 1024, v6
  v_lshrrev_b32 v8, 1, v3
  v_lshl_add_u32 v8, v8, 4, v4
  v_lshlrev_b32 v8, 4, v8
  v_and_b32 v9, 1, v3
  v_lshl_add_u32 v7, v9, 3, v8
  s_lshr_b32 s26, s17, 3
  s_lshl_b32 s26, s26, 4
  s_add_u32 s26, s26, s20
  s_lshl_b32 s26, s26, 7
  s_add_u32 s26, s26, 88461312
  v_mov_b32 v60, 0
  s_mov_b32 s30, 0
wo_wv:
  buffer_load_dword v61, v60, s[8:11], s26 offen sc1
  s_waitcnt vmcnt(0)
  v_cmp_ne_u32 vcc, 56, v61
  s_cbranch_vccz wo_wv_ok
  s_sleep 4
  s_cmp_ge_u32 s17, 56
  s_cbranch_scc1 wo_wv_bo
  s_sleep 127
wo_wv_bo:
  s_add_u32 s30, s30, 1
  s_cmp_lt_u32 s30, 2000000
  s_cbranch_scc1 wo_wv
  s_branch wo_abort
wo_wv_ok:
  s_add_u32 s22, s21, 0
  buffer_load_dwordx4 a[0:3], v5, s[8:11], s22 offen offset:0 sc1
  buffer_load_dwordx4 a[4:7], v6, s[8:11], s22 offen offset:0 sc1
  buffer_load_dwordx4 a[8:11], v5, s[8:11], s22 offen offset:1792 sc1
  buffer_load_dwordx4 a[12:15], v6, s[8:11], s22 offen offset:1792 sc1
  s_add_u32 s22, s21, 3584
  buffer_load_dwordx4 a[16:19], v5, s[8:11], s22 offen offset:0 sc1
  buffer_load_dwordx4 a[20:23], v6, s[8:11], s22 offen offset:0 sc1
  buffer_load_dwordx4 a[24:27], v5, s[8:11], s22 offen offset:1792 sc1
  buffer_load_dwordx4 a[28:31], v6, s[8:11], s22 offen offset:1792 sc1
  s_add_u32 s22, s21, 7168
  buffer_load_dwordx4 a[32:35], v5, s[8:11], s22 offen offset:0 sc1
  buffer_load_dwordx4 a[36:39], v6, s[8:11], s22 offen offset:0 sc1
  buffer_load_dwordx4 a[40:43], v5, s[8:11], s22 offen offset:1792 sc1
  buffer_load_dwordx4 a[44:47], v6, s[8:11], s22 offen offset:1792 sc1
  s_add_u32 s22, s21, 10752
  buffer_load_dwordx4 a[48:51], v5, s[8:11], s22 offen offset:0 sc1
  buffer_load_dwordx4 a[52:55], v6, s[8:11], s22 offen offset:0 sc1
  buffer_load_dwordx4 a[56:59], v5, s[8:11], s22 offen offset:1792 sc1
  buffer_load_dwordx4 a[60:63], v6, s[8:11], s22 offen offset:1792 sc1
  s_add_u32 s22, s21, 14336
  buffer_load_dwordx4 a[64:67], v5, s[8:11], s22 offen offset:0 sc1
  buffer_load_dwordx4 a[68:71], v6, s[8:11], s22 offen offset:0 sc1
  buffer_load_dwordx4 a[72:75], v5, s[8:11], s22 offen offset:1792 sc1
  buffer_load_dwordx4 a[76:79], v6, s[8:11], s22 offen offset:1792 sc1
  s_add_u32 s22, s21, 17920
  buffer_load_dwordx4 a[80:83], v5, s[8:11], s22 offen offset:0 sc1
  buffer_load_dwordx4 a[84:87], v6, s[8:11], s22 offen offset:0 sc1
  buffer_load_dwordx4 a[88:91], v5, s[8:11], s22 offen offset:1792 sc1
  buffer_load_dwordx4 a[92:95], v6, s[8:11], s22 offen offset:1792 sc1
  s_add_u32 s22, s21, 21504
  buffer_load_dwordx4 a[96:99], v5, s[8:11], s22 offen offset:0 sc1
  buffer_load_dwordx4 a[100:103], v6, s[8:11], s22 offen offset:0 sc1
  buffer_load_dwordx4 a[104:107], v5, s[8:11], s22 offen offset:1792 sc1
  buffer_load_dwordx4 a[108:111], v6, s[8:11], s22 offen offset:1792 sc1
  s_add_u32 s22, s21, 25088
  buffer_load_dwordx4 a[112:115], v5, s[8:11], s22 offen offset:0 sc1
  buffer_load_dwordx4 a[116:119], v6, s[8:11], s22 offen offset:0 sc1
  buffer_load_dwordx4 a[120:123], v5, s[8:11], s22 offen offset:1792 sc1
  buffer_load_dwordx4 a[124:127], v6, s[8:11], s22 offen offset:1792 sc1
  s_lshl_b32 s26, s20, 6
  s_add_u32 s26, s26, s17
  s_lshl_b32 s26, s26, 4
  s_add_u32 s26, s26, 88502272
  v_lshlrev_b32 v60, 2, v3
  s_mov_b32 s30, 0
wo_wt:
  buffer_load_dword v61, v60, s[8:11], s26 offen sc1
  s_waitcnt vmcnt(0)
  v_cmp_ne_u32 vcc, 1, v61
  s_cbranch_vccz wo_wt_ok
  s_sleep 4
  s_cmp_ge_u32 s17, 56
  s_cbranch_scc1 wo_wt_bo
  s_sleep 127
wo_wt_bo:
  s_add_u32 s30, s30, 1
  s_cmp_lt_u32 s30, 2000000
  s_cbranch_scc1 wo_wt
  s_branch wo_abort
wo_wt_ok:
  s_add_u32 s22, s24, 0
  buffer_load_dwordx2 v[28:29], v7, s[8:11], s22 offen offset:0 sc1
  buffer_load_dwordx2 v[30:31], v7, s[8:11], s22 offen offset:512 sc1
  buffer_load_dwordx2 v[32:33], v7, s[8:11], s22 offen offset:1024 sc1
  buffer_load_dwordx2 v[34:35], v7, s[8:11], s22 offen offset:1536 sc1
  buffer_load_dwordx2 v[36:37], v7, s[8:11], s22 offen offset:2048 sc1
  buffer_load_dwordx2 v[38:39], v7, s[8:11], s22 offen offset:2560 sc1
  buffer_load_dwordx2 v[40:41], v7, s[8:11], s22 offen offset:3072 sc1
  buffer_load_dwordx2 v[42:43], v7, s[8:11], s22 offen offset:3584 sc1
  s_add_u32 s22, s24, 4096
  buffer_load_dwordx2 v[44:45], v7, s[8:11], s22 offen offset:0 sc1
  buffer_load_dwordx2 v[46:47], v7, s[8:11], s22 offen offset:512 sc1
  buffer_load_dwordx2 v[48:49], v7, s[8:11], s22 offen offset:1024 sc1
  buffer_load_dwordx2 v[50:51], v7, s[8:11], s22 offen offset:1536 sc1
  buffer_load_dwordx2 v[52:53], v7, s[8:11], s22 offen offset:2048 sc1
  buffer_load_dwordx2 v[54:55], v7, s[8:11], s22 offen offset:2560 sc1
  buffer_load_dwordx2 v[56:57], v7, s[8:11], s22 offen offset:3072 sc1
  buffer_load_dwordx2 v[58:59], v7, s[8:11], s22 offen offset:3584 sc1
  s_lshl_b32 s26, s17, 7
  s_add_u32 s26, s26, 88494080
  v_mov_b32 v60, 0
  s_mov_b32 s30, 0
wo_wp:
  buffer_load_dword v61, v60, s[8:11], s26 offen sc1
  s_waitcnt vmcnt(0)
  v_cmp_ne_u32 vcc, 16, v61
  s_cbranch_vccz wo_wp_ok
  s_sleep 2
  s_cmp_ge_u32 s17, 56
  s_cbranch_scc1 wo_wp_bo
  s_sleep 127
wo_wp_bo:
  s_add_u32 s30, s30, 1
  s_cmp_lt_u32 s30, 2000000
  s_cbranch_scc1 wo_wp
  s_branch wo_abort
wo_wp_ok:
  buffer_load_dword v250, v251, s[8:11], 0 offen sc1
  s_add_u32 s26, s25, 0
  s_add_u32 s27, s25, 20480
  buffer_load_dwordx4 a[128:131], v2, s[8:11], s26 offen offset:0 sc1
  buffer_load_dwordx4 a[132:135], v2, s[8:11], s27 offen offset:0 sc1
  buffer_load_dwordx4 a[136:139], v2, s[8:11], s26 offen offset:1024 sc1
  buffer_load_dwordx4 a[140:143], v2, s[8:11], s27 offen offset:1024 sc1
  buffer_load_dwordx4 a[144:147], v2, s[8:11], s26 offen offset:2048 sc1
  buffer_load_dwordx4 a[148:151], v2, s[8:11], s27 offen offset:2048 sc1
  buffer_load_dwordx4 a[152:155], v2, s[8:11], s26 offen offset:3072 sc1
  buffer_load_dwordx4 a[156:159], v2, s[8:11], s27 offen offset:3072 sc1
  s_add_u32 s26, s25, 4096
  s_add_u32 s27, s25, 24576
  buffer_load_dwordx4 a[160:163], v2, s[8:11], s26 offen offset:0 sc1
  buffer_load_dwordx4 a[164:167], v2, s[8:11], s27 offen offset:0 sc1
  buffer_load_dwordx4 a[168:171], v2, s[8:11], s26 offen offset:1024 sc1
  buffer_load_dwordx4 a[172:175], v2, s[8:11], s27 offen offset:1024 sc1
  buffer_load_dwordx4 a[176:179], v2, s[8:11], s26 offen offset:2048 sc1
  buffer_load_dwordx4 a[180:183], v2, s[8:11], s27 offen offset:2048 sc1
  buffer_load_dwordx4 a[184:187], v2, s[8:11], s26 offen offset:3072 sc1
  buffer_load_dwordx4 a[188:191], v2, s[8:11], s27 offen offset:3072 sc1
  s_add_u32 s26, s25, 8192
  s_add_u32 s27, s25, 28672
  buffer_load_dwordx4 a[192:195], v2, s[8:11], s26 offen offset:0 sc1
  buffer_load_dwordx4 a[196:199], v2, s[8:11], s27 offen offset:0 sc1
  buffer_load_dwordx4 a[200:203], v2, s[8:11], s26 offen offset:1024 sc1
  buffer_load_dwordx4 a[204:207], v2, s[8:11], s27 offen offset:1024 sc1
  buffer_load_dwordx4 a[208:211], v2, s[8:11], s26 offen offset:2048 sc1
  buffer_load_dwordx4 a[212:215], v2, s[8:11], s27 offen offset:2048 sc1
  buffer_load_dwordx4 a[216:219], v2, s[8:11], s26 offen offset:3072 sc1
  buffer_load_dwordx4 a[220:223], v2, s[8:11], s27 offen offset:3072 sc1
  s_add_u32 s26, s25, 12288
  s_add_u32 s27, s25, 32768
  buffer_load_dwordx4 a[224:227], v2, s[8:11], s26 offen offset:0 sc1
  buffer_load_dwordx4 a[228:231], v2, s[8:11], s27 offen offset:0 sc1
  buffer_load_dwordx4 a[232:235], v2, s[8:11], s26 offen offset:1024 sc1
  buffer_load_dwordx4 a[236:239], v2, s[8:11], s27 offen offset:1024 sc1
  buffer_load_dwordx4 a[240:243], v2, s[8:11], s26 offen offset:2048 sc1
  buffer_load_dwordx4 a[244:247], v2, s[8:11], s27 offen offset:2048 sc1
  buffer_load_dwordx4 a[248:251], v2, s[8:11], s26 offen offset:3072 sc1
  buffer_load_dwordx4 a[252:255], v2, s[8:11], s27 offen offset:3072 sc1
  s_add_u32 s26, s25, 16384
  s_add_u32 s27, s25, 36864
  buffer_load_dwordx4 v[64:67], v2, s[8:11], s26 offen offset:0 sc1
  buffer_load_dwordx4 v[68:71], v2, s[8:11], s27 offen offset:0 sc1
  buffer_load_dwordx4 v[72:75], v2, s[8:11], s26 offen offset:1024 sc1
  buffer_load_dwordx4 v[76:79], v2, s[8:11], s27 offen offset:1024 sc1
  buffer_load_dwordx4 v[80:83], v2, s[8:11], s26 offen offset:2048 sc1
  buffer_load_dwordx4 v[84:87], v2, s[8:11], s27 offen offset:2048 sc1
  buffer_load_dwordx4 v[88:91], v2, s[8:11], s26 offen offset:3072 sc1
  buffer_load_dwordx4 v[92:95], v2, s[8:11], s27 offen offset:3072 sc1
  s_waitcnt vmcnt(38)
  v_mfma_f32_16x16x32_bf16 v[12:15], a[0:3], a[128:131], 0
  v_mfma_f32_16x16x32_bf16 v[16:19], a[0:3], a[132:135], 0
  v_mfma_f32_16x16x32_bf16 v[20:23], a[4:7], a[128:131], 0
  v_mfma_f32_16x16x32_bf16 v[24:27], a[4:7], a[132:135], 0
  s_waitcnt vmcnt(36)
  v_mfma_f32_16x16x32_bf16 v[12:15], a[8:11], a[136:139], v[12:15]
  v_mfma_f32_16x16x32_bf16 v[16:19], a[8:11], a[140:143], v[16:19]
  v_mfma_f32_16x16x32_bf16 v[20:23], a[12:15], a[136:139], v[20:23]
  v_mfma_f32_16x16x32_bf16 v[24:27], a[12:15], a[140:143], v[24:27]
  s_waitcnt vmcnt(34)
  v_mfma_f32_16x16x32_bf16 v[12:15], a[16:19], a[144:147], v[12:15]
  v_mfma_f32_16x16x32_bf16 v[16:19], a[16:19], a[148:151], v[16:19]
  v_mfma_f32_16x16x32_bf16 v[20:23], a[20:23], a[144:147], v[20:23]
  v_mfma_f32_16x16x32_bf16 v[24:27], a[20:23], a[148:151], v[24:27]
  s_waitcnt vmcnt(32)
  v_mfma_f32_16x16x32_bf16 v[12:15], a[24:27], a[152:155], v[12:15]
  v_mfma_f32_16x16x32_bf16 v[16:19], a[24:27], a[156:159], v[16:19]
  v_mfma_f32_16x16x32_bf16 v[20:23], a[28:31], a[152:155], v[20:23]
  v_mfma_f32_16x16x32_bf16 v[24:27], a[28:31], a[156:159], v[24:27]
  s_waitcnt vmcnt(30)
  v_mfma_f32_16x16x32_bf16 v[12:15], a[32:35], a[160:163], v[12:15]
  v_mfma_f32_16x16x32_bf16 v[16:19], a[32:35], a[164:167], v[16:19]
  v_mfma_f32_16x16x32_bf16 v[20:23], a[36:39], a[160:163], v[20:23]
  v_mfma_f32_16x16x32_bf16 v[24:27], a[36:39], a[164:167], v[24:27]
  s_waitcnt vmcnt(28)
  v_mfma_f32_16x16x32_bf16 v[12:15], a[40:43], a[168:171], v[12:15]
  v_mfma_f32_16x16x32_bf16 v[16:19], a[40:43], a[172:175], v[16:19]
  v_mfma_f32_16x16x32_bf16 v[20:23], a[44:47], a[168:171], v[20:23]
  v_mfma_f32_16x16x32_bf16 v[24:27], a[44:47], a[172:175], v[24:27]
  s_waitcnt vmcnt(26)
  v_mfma_f32_16x16x32_bf16 v[12:15], a[48:51], a[176:179], v[12:15]
  v_mfma_f32_16x16x32_bf16 v[16:19], a[48:51], a[180:183], v[16:19]
  v_mfma_f32_16x16x32_bf16 v[20:23], a[52:55], a[176:179], v[20:23]
  v_mfma_f32_16x16x32_bf16 v[24:27], a[52:55], a[180:183], v[24:27]
  s_waitcnt vmcnt(24)
  v_mfma_f32_16x16x32_bf16 v[12:15], a[56:59], a[184:187], v[12:15]
  v_mfma_f32_16x16x32_bf16 v[16:19], a[56:59], a[188:191], v[16:19]
  v_mfma_f32_16x16x32_bf16 v[20:23], a[60:63], a[184:187], v[20:23]
  v_mfma_f32_16x16x32_bf16 v[24:27], a[60:63], a[188:191], v[24:27]
  s_waitcnt vmcnt(22)
  v_mfma_f32_16x16x32_bf16 v[12:15], a[64:67], a[192:195], v[12:15]
  v_mfma_f32_16x16x32_bf16 v[16:19], a[64:67], a[196:199], v[16:19]
  v_mfma_f32_16x16x32_bf16 v[20:23], a[68:71], a[192:195], v[20:23]
  v_mfma_f32_16x16x32_bf16 v[24:27], a[68:71], a[196:199], v[24:27]
  s_waitcnt vmcnt(20)
  v_mfma_f32_16x16x32_bf16 v[12:15], a[72:75], a[200:203], v[12:15]
  v_mfma_f32_16x16x32_bf16 v[16:19], a[72:75], a[204:207], v[16:19]
  v_mfma_f32_16x16x32_bf16 v[20:23], a[76:79], a[200:203], v[20:23]
  v_mfma_f32_16x16x32_bf16 v[24:27], a[76:79], a[204:207], v[24:27]
  s_waitcnt vmcnt(18)
  v_mfma_f32_16x16x32_bf16 v[12:15], a[80:83], a[208:211], v[12:15]
  v_mfma_f32_16x16x32_bf16 v[16:19], a[80:83], a[212:215], v[16:19]
  v_mfma_f32_16x16x32_bf16 v[20:23], a[84:87], a[208:211], v[20:23]
  v_mfma_f32_16x16x32_bf16 v[24:27], a[84:87], a[212:215], v[24:27]
  s_waitcnt vmcnt(16)
  v_mfma_f32_16x16x32_bf16 v[12:15], a[88:91], a[216:219], v[12:15]
  v_mfma_f32_16x16x32_bf16 v[16:19], a[88:91], a[220:223], v[16:19]
  v_mfma_f32_16x16x32_bf16 v[20:23], a[92:95], a[216:219], v[20:23]
  v_mfma_f32_16x16x32_bf16 v[24:27], a[92:95], a[220:223], v[24:27]
  s_waitcnt vmcnt(14)
  v_mfma_f32_16x16x32_bf16 v[12:15], a[96:99], a[224:227], v[12:15]
  v_mfma_f32_16x16x32_bf16 v[16:19], a[96:99], a[228:231], v[16:19]
  v_mfma_f32_16x16x32_bf16 v[20:23], a[100:103], a[224:227], v[20:23]
  v_mfma_f32_16x16x32_bf16 v[24:27], a[100:103], a[228:231], v[24:27]
  s_waitcnt vmcnt(12)
  v_mfma_f32_16x16x32_bf16 v[12:15], a[104:107], a[232:235], v[12:15]
  v_mfma_f32_16x16x32_bf16 v[16:19], a[104:107], a[236:239], v[16:19]
  v_mfma_f32_16x16x32_bf16 v[20:23], a[108:111], a[232:235], v[20:23]
  v_mfma_f32_16x16x32_bf16 v[24:27], a[108:111], a[236:239], v[24:27]
  s_waitcnt vmcnt(10)
  v_mfma_f32_16x16x32_bf16 v[12:15], a[112:115], a[240:243], v[12:15]
  v_mfma_f32_16x16x32_bf16 v[16:19], a[112:115], a[244:247], v[16:19]
  v_mfma_f32_16x16x32_bf16 v[20:23], a[116:119], a[240:243], v[20:23]
  v_mfma_f32_16x16x32_bf16 v[24:27], a[116:119], a[244:247], v[24:27]
  s_waitcnt vmcnt(8)
  v_mfma_f32_16x16x32_bf16 v[12:15], a[120:123], a[248:251], v[12:15]
  v_mfma_f32_16x16x32_bf16 v[16:19], a[120:123], a[252:255], v[16:19]
  v_mfma_f32_16x16x32_bf16 v[20:23], a[124:127], a[248:251], v[20:23]
  v_mfma_f32_16x16x32_bf16 v[24:27], a[124:127], a[252:255], v[24:27]
  s_waitcnt vmcnt(0)
  v_mfma_f32_16x16x32_bf16 v[12:15], v[28:31], v[64:67], v[12:15]
  v_mfma_f32_16x16x32_bf16 v[16:19], v[28:31], v[68:71], v[16:19]
  v_mfma_f32_16x16x32_bf16 v[20:23], v[32:35], v[64:67], v[20:23]
  v_mfma_f32_16x16x32_bf16 v[24:27], v[32:35], v[68:71], v[24:27]
  v_mfma_f32_16x16x32_bf16 v[12:15], v[36:39], v[72:75], v[12:15]
  v_mfma_f32_16x16x32_bf16 v[16:19], v[36:39], v[76:79], v[16:19]
  v_mfma_f32_16x16x32_bf16 v[20:23], v[40:43], v[72:75], v[20:23]
  v_mfma_f32_16x16x32_bf16 v[24:27], v[40:43], v[76:79], v[24:27]
  v_mfma_f32_16x16x32_bf16 v[12:15], v[44:47], v[80:83], v[12:15]
  v_mfma_f32_16x16x32_bf16 v[16:19], v[44:47], v[84:87], v[16:19]
  v_mfma_f32_16x16x32_bf16 v[20:23], v[48:51], v[80:83], v[20:23]
  v_mfma_f32_16x16x32_bf16 v[24:27], v[48:51], v[84:87], v[24:27]
  v_mfma_f32_16x16x32_bf16 v[12:15], v[52:55], v[88:91], v[12:15]
  v_mfma_f32_16x16x32_bf16 v[16:19], v[52:55], v[92:95], v[16:19]
  v_mfma_f32_16x16x32_bf16 v[20:23], v[56:59], v[88:91], v[20:23]
  v_mfma_f32_16x16x32_bf16 v[24:27], v[56:59], v[92:95], v[24:27]
  v_mul_u32_u24 v9, 1792, v4
  v_lshl_add_u32 v9, v3, 3, v9
  s_lshl_b32 s22, s20, 5
  v_add_u32 v8, s22, v9
  s_mul_i32 s22, s20, 24
  s_add_u32 s22, s22, 512
  v_add_u32 v9, s22, v9
  v_mov_b32 v10, 0x40000000
  v_cmp_eq_u32 vcc, 3, v3
  s_nop 1
  v_cndmask_b32 v9, v9, v10, vcc
  s_mul_i32 s26, s17, 57344
  s_add_u32 s26, s26, 896
  s_add_u32 s27, s26, 28672
  v_cvt_pk_bf16_f32 v96, v12, v13
  v_cvt_pk_bf16_f32 v97, v14, v15
  buffer_store_dwordx2 v[96:97], v8, s[92:95], s26 offen
  v_cvt_pk_bf16_f32 v98, v20, v21
  v_cvt_pk_bf16_f32 v99, v22, v23
  buffer_store_dwordx2 v[98:99], v9, s[92:95], s26 offen
  v_cvt_pk_bf16_f32 v100, v16, v17
  v_cvt_pk_bf16_f32 v101, v18, v19
  buffer_store_dwordx2 v[100:101], v8, s[92:95], s27 offen
  v_cvt_pk_bf16_f32 v102, v24, v25
  v_cvt_pk_bf16_f32 v103, v26, v27
  buffer_store_dwordx2 v[102:103], v9, s[92:95], s27 offen
  s_branch wk_loop
wp_abort:
wo_abort:
  s_branch cA_abort
wk_done:
ch_end:
  s_endpgm

.section .rodata,"a"
.p2align 6
.amdhsa_kernel main_kernel
  .amdhsa_next_free_vgpr 512
  .amdhsa_next_free_sgpr 102
  .amdhsa_accum_offset 256
  .amdhsa_group_segment_fixed_size 0
  .amdhsa_kernarg_size 136
  .amdhsa_user_sgpr_count 2
  .amdhsa_user_sgpr_kernarg_segment_ptr 1
  .amdhsa_system_sgpr_workgroup_id_x 1
.end_amdhsa_kernel
```

```asm
; @launch kernel=main_kernel grid=(256,1,1) block=(256,1,1) lds=163840
.amdgcn_target "amdgcn-amd-amdhsa--gfx950"
.text
.globl main_kernel
.p2align 8
.type main_kernel,@function
main_kernel:
  s_cmp_ge_u32 s2, 256
  s_cbranch_scc1 ch_end
  s_load_dwordx2 s[4:5], s[0:1], 120
  s_load_dwordx2 s[6:7], s[0:1], 128
  s_load_dwordx8 s[40:47], s[0:1], 72
  s_load_dwordx4 s[48:51], s[0:1], 56
  s_getpc_b64 s[98:99]
pf_main_kernel_1:
  s_sub_u32 s98, s98, pf_main_kernel_1-main_kernel
  s_subb_u32 s99, s99, 0
  v_lshlrev_b32 v60, 7, v0
  v_min_u32 v61, ch_end-main_kernel-4, v60
  global_load_dword v62, v61, s[98:99]
  v_add_u32 v60, 32768, v60
  v_min_u32 v61, ch_end-main_kernel-4, v60
  global_load_dword v62, v61, s[98:99]
  v_add_u32 v60, 32768, v60
  v_min_u32 v61, ch_end-main_kernel-4, v60
  global_load_dword v62, v61, s[98:99]
  v_add_u32 v60, 32768, v60
  v_min_u32 v61, ch_end-main_kernel-4, v60
  global_load_dword v62, v61, s[98:99]
  v_add_u32 v60, 32768, v60
  s_mov_b32 s32, 0
  s_getreg_b32 s3, hwreg(HW_REG_XCC_ID)
  s_and_b32 s3, s3, 15
  v_lshrrev_b32 v1, 6, v0
  s_nop 0
  v_readfirstlane_b32 s16, v1
  s_waitcnt lgkmcnt(0)
  s_mov_b32 s8, s6
  s_and_b32 s9, s7, 0xffff
  s_mov_b32 s10, 0x10000000
  s_mov_b32 s11, 0x20000
  s_mov_b32 s12, s4
  s_and_b32 s13, s5, 0xffff
  s_mov_b32 s14, 256
  s_mov_b32 s15, 0x20000
  v_mov_b32 v252, 0x40000000
  v_cmp_eq_u32 vcc, 0, v0
  s_nop 1
  v_cndmask_b32 v252, v252, v0, vcc
  s_cmp_lg_u32 s3, 0
  s_cbranch_scc1 ch_worker
  s_cmp_lg_u32 s16, 0
  s_cbranch_scc1 ch_worker
  v_mov_b32 v249, 1
  s_mov_b64 exec, 1
  buffer_atomic_add v249, v252, s[12:15], 0 offen sc0
  s_mov_b64 exec, -1
  s_branch ch_worker
  s_cmp_lg_u32 s3, 0
  s_cbranch_scc1 ch_worker
  v_mov_b32 v4, 1
  s_mov_b32 s18, 0
ch_take:
  v_mov_b32 v5, 0
  v_mov_b32 v6, 160000
  s_barrier
  s_cmp_lg_u32 s16, 0
  s_cbranch_scc1 ch_el1
  s_mov_b64 exec, 1
  buffer_atomic_add v4, v5, s[12:15], 0 offen sc0
  s_waitcnt vmcnt(0)
  ds_write_b32 v6, v4
  s_waitcnt lgkmcnt(0)
  s_mov_b64 exec, -1
ch_el1:
  s_barrier
  ds_read_b32 v4, v6
  s_waitcnt lgkmcnt(0)
  v_readfirstlane_b32 s17, v4
  s_and_b32 s17, s17, 0xffff
  s_cmp_lt_u32 s17, 32
  s_cbranch_scc1 ch_role
  v_and_b32 v1, 63, v0
  v_lshlrev_b32 v2, 4, v1
  v_lshrrev_b32 v3, 4, v1
  v_and_b32 v4, 15, v1
  s_branch wp_all
  s_cmp_eq_u32 s18, 0
  s_cbranch_scc1 ch_worker
  s_branch ch_end
ch_role:
  s_mov_b32 s91, s17
ch_role2:
  s_mov_b32 s17, s91
  v_and_b32 v1, 63, v0
  v_lshlrev_b32 v2, 4, v1
  v_lshrrev_b32 v116, 4, v1
  v_and_b32 v117, 15, v1
  v_mov_b32 v3, 0x4444
  v_mov_b32 v118, 0xeeee
  v_cmp_lt_u32 vcc, 7, v117
  s_nop 1
  v_cndmask_b32 v3, v3, v118, vcc
  s_mov_b32 s19, 0
  s_mov_b32 s18, 1
  s_mov_b32 s20, 75694080
  s_mov_b32 s21, 75711744
  s_mov_b32 s23, 75698176
  s_lshr_b32 s89, s17, 4
  s_lshl_b32 s89, s89, 2
  s_add_u32 s89, s89, s16
  s_and_b32 s17, s17, 15
  s_cmp_eq_u32 s89, 0
  s_cbranch_scc1 ch_init0
  s_cmp_eq_u32 s89, 1
  s_cbranch_scc1 ch_init1
  s_cmp_eq_u32 s89, 2
  s_cbranch_scc1 ch_init2
  s_cmp_eq_u32 s89, 3
  s_cbranch_scc1 ch_init3
  s_cmp_eq_u32 s89, 4
  s_cbranch_scc1 ch_init4
  s_cmp_eq_u32 s89, 5
  s_cbranch_scc1 ch_init5
  s_cmp_eq_u32 s89, 6
  s_cbranch_scc1 ch_init6
  s_cmp_eq_u32 s89, 7
  s_cbranch_scc1 ch_init7
  s_branch ch_end
ch_init0:
  s_mul_i32 s31, s17, 401408
  s_add_u32 s31, s31, 0
  s_mov_b32 s30, 0
ch_wr0:
  buffer_load_dword v65, off, s[12:15], 0 offset:132 sc1
  s_waitcnt vmcnt(0)
  v_cmp_ne_u32 vcc, 1, v65
  s_cbranch_vccz ch_wr0_ok
  s_sleep 8
  s_add_u32 s30, s30, 1
  s_cmp_lt_u32 s30, 400000
  s_cbranch_scc1 ch_wr0
  s_branch cA_abort
ch_wr0_ok:
  s_lshl_b32 s27, s17, 7
  s_add_u32 s27, s27, 88521216
  s_mov_b32 s28, 129
  s_mov_b32 s30, 0
ch_wa0:
  buffer_load_dword v65, off, s[8:11], s27  sc1
  s_waitcnt vmcnt(0)
  v_and_b32 v66, s28, v65
  v_cmp_ne_u32 vcc, s28, v66
  s_cbranch_vccz ch_wa0_ok
  s_sleep 3
  s_add_u32 s30, s30, 1
  s_cmp_lt_u32 s30, 400000
  s_cbranch_scc1 ch_wa0
  s_branch cA_abort
ch_wa0_ok:
  v_readfirstlane_b32 s29, v65
  s_add_u32 s22, s31, 0
  buffer_load_dwordx4 a[0:3], v2, s[8:11], s22 offen offset:0 sc1
  buffer_load_dwordx4 a[4:7], v2, s[8:11], s22 offen offset:1024 sc1
  buffer_load_dwordx4 a[8:11], v2, s[8:11], s22 offen offset:2048 sc1
  buffer_load_dwordx4 a[12:15], v2, s[8:11], s22 offen offset:3072 sc1
  s_add_u32 s22, s31, 4096
  buffer_load_dwordx4 a[16:19], v2, s[8:11], s22 offen offset:0 sc1
  buffer_load_dwordx4 a[20:23], v2, s[8:11], s22 offen offset:1024 sc1
  buffer_load_dwordx4 a[24:27], v2, s[8:11], s22 offen offset:2048 sc1
  buffer_load_dwordx4 a[28:31], v2, s[8:11], s22 offen offset:3072 sc1
  s_add_u32 s22, s31, 8192
  buffer_load_dwordx4 a[32:35], v2, s[8:11], s22 offen offset:0 sc1
  buffer_load_dwordx4 a[36:39], v2, s[8:11], s22 offen offset:1024 sc1
  buffer_load_dwordx4 a[40:43], v2, s[8:11], s22 offen offset:2048 sc1
  buffer_load_dwordx4 a[44:47], v2, s[8:11], s22 offen offset:3072 sc1
  s_add_u32 s22, s31, 12288
  buffer_load_dwordx4 a[48:51], v2, s[8:11], s22 offen offset:0 sc1
  buffer_load_dwordx4 a[52:55], v2, s[8:11], s22 offen offset:1024 sc1
  buffer_load_dwordx4 a[56:59], v2, s[8:11], s22 offen offset:2048 sc1
  buffer_load_dwordx4 a[60:63], v2, s[8:11], s22 offen offset:3072 sc1
  s_add_u32 s22, s31, 16384
  buffer_load_dwordx4 a[64:67], v2, s[8:11], s22 offen offset:0 sc1
  buffer_load_dwordx4 a[68:71], v2, s[8:11], s22 offen offset:1024 sc1
  buffer_load_dwordx4 a[72:75], v2, s[8:11], s22 offen offset:2048 sc1
  buffer_load_dwordx4 a[76:79], v2, s[8:11], s22 offen offset:3072 sc1
  s_add_u32 s22, s31, 20480
  buffer_load_dwordx4 a[80:83], v2, s[8:11], s22 offen offset:0 sc1
  buffer_load_dwordx4 a[84:87], v2, s[8:11], s22 offen offset:1024 sc1
  buffer_load_dwordx4 a[88:91], v2, s[8:11], s22 offen offset:2048 sc1
  buffer_load_dwordx4 a[92:95], v2, s[8:11], s22 offen offset:3072 sc1
  s_add_u32 s22, s31, 24576
  buffer_load_dwordx4 a[96:99], v2, s[8:11], s22 offen offset:0 sc1
  buffer_load_dwordx4 a[100:103], v2, s[8:11], s22 offen offset:1024 sc1
  buffer_load_dwordx4 a[104:107], v2, s[8:11], s22 offen offset:2048 sc1
  buffer_load_dwordx4 a[108:111], v2, s[8:11], s22 offen offset:3072 sc1
  s_add_u32 s22, s31, 28672
  buffer_load_dwordx4 a[112:115], v2, s[8:11], s22 offen offset:0 sc1
  buffer_load_dwordx4 a[116:119], v2, s[8:11], s22 offen offset:1024 sc1
  buffer_load_dwordx4 a[120:123], v2, s[8:11], s22 offen offset:2048 sc1
  buffer_load_dwordx4 a[124:127], v2, s[8:11], s22 offen offset:3072 sc1
  s_waitcnt vmcnt(24)
  s_add_u32 s22, s31, 32768
  buffer_load_dwordx4 a[128:131], v2, s[8:11], s22 offen offset:0 sc1
  buffer_load_dwordx4 a[132:135], v2, s[8:11], s22 offen offset:1024 sc1
  buffer_load_dwordx4 a[136:139], v2, s[8:11], s22 offen offset:2048 sc1
  buffer_load_dwordx4 a[140:143], v2, s[8:11], s22 offen offset:3072 sc1
  s_add_u32 s22, s31, 36864
  buffer_load_dwordx4 a[144:147], v2, s[8:11], s22 offen offset:0 sc1
  buffer_load_dwordx4 a[148:151], v2, s[8:11], s22 offen offset:1024 sc1
  buffer_load_dwordx4 a[152:155], v2, s[8:11], s22 offen offset:2048 sc1
  buffer_load_dwordx4 a[156:159], v2, s[8:11], s22 offen offset:3072 sc1
  s_add_u32 s22, s31, 40960
  buffer_load_dwordx4 a[160:163], v2, s[8:11], s22 offen offset:0 sc1
  buffer_load_dwordx4 a[164:167], v2, s[8:11], s22 offen offset:1024 sc1
  buffer_load_dwordx4 a[168:171], v2, s[8:11], s22 offen offset:2048 sc1
  buffer_load_dwordx4 a[172:175], v2, s[8:11], s22 offen offset:3072 sc1
  s_add_u32 s22, s31, 45056
  buffer_load_dwordx4 a[176:179], v2, s[8:11], s22 offen offset:0 sc1
  buffer_load_dwordx4 a[180:183], v2, s[8:11], s22 offen offset:1024 sc1
  buffer_load_dwordx4 a[184:187], v2, s[8:11], s22 offen offset:2048 sc1
  buffer_load_dwordx4 a[188:191], v2, s[8:11], s22 offen offset:3072 sc1
  s_add_u32 s22, s31, 49152
  buffer_load_dwordx4 a[192:195], v2, s[8:11], s22 offen offset:0 sc1
  buffer_load_dwordx4 a[196:199], v2, s[8:11], s22 offen offset:1024 sc1
  buffer_load_dwordx4 a[200:203], v2, s[8:11], s22 offen offset:2048 sc1
  buffer_load_dwordx4 a[204:207], v2, s[8:11], s22 offen offset:3072 sc1
  s_add_u32 s22, s31, 53248
  buffer_load_dwordx4 a[208:211], v2, s[8:11], s22 offen offset:0 sc1
  buffer_load_dwordx4 a[212:215], v2, s[8:11], s22 offen offset:1024 sc1
  buffer_load_dwordx4 a[216:219], v2, s[8:11], s22 offen offset:2048 sc1
  buffer_load_dwordx4 a[220:223], v2, s[8:11], s22 offen offset:3072 sc1
  s_and_b32 s29, s29, 10320
  s_cmp_eq_u32 s29, 10320
  s_cbranch_scc1 ch_wb0_ok
  s_lshl_b32 s27, s17, 7
  s_add_u32 s27, s27, 88521216
  s_mov_b32 s28, 10320
  s_mov_b32 s30, 0
ch_wb0:
  buffer_load_dword v65, off, s[8:11], s27  sc1
  s_waitcnt vmcnt(0)
  v_and_b32 v66, s28, v65
  v_cmp_ne_u32 vcc, s28, v66
  s_cbranch_vccz ch_wb0_ok
  s_sleep 3
  s_add_u32 s30, s30, 1
  s_cmp_lt_u32 s30, 400000
  s_cbranch_scc1 ch_wb0
  s_branch cA_abort
ch_wb0_ok:
  s_waitcnt vmcnt(28)
  s_add_u32 s22, s31, 229376
  buffer_load_dwordx4 a[224:227], v2, s[8:11], s22 offen offset:0 sc1
  buffer_load_dwordx4 a[228:231], v2, s[8:11], s22 offen offset:1024 sc1
  buffer_load_dwordx4 a[232:235], v2, s[8:11], s22 offen offset:2048 sc1
  buffer_load_dwordx4 a[236:239], v2, s[8:11], s22 offen offset:3072 sc1
  s_add_u32 s22, s31, 233472
  buffer_load_dwordx4 a[240:243], v2, s[8:11], s22 offen offset:0 sc1
  buffer_load_dwordx4 a[244:247], v2, s[8:11], s22 offen offset:1024 sc1
  buffer_load_dwordx4 a[248:251], v2, s[8:11], s22 offen offset:2048 sc1
  buffer_load_dwordx4 a[252:255], v2, s[8:11], s22 offen offset:3072 sc1
  s_add_u32 s22, s31, 237568
  buffer_load_dwordx4 v[120:123], v2, s[8:11], s22 offen offset:0 sc1
  buffer_load_dwordx4 v[124:127], v2, s[8:11], s22 offen offset:1024 sc1
  buffer_load_dwordx4 v[128:131], v2, s[8:11], s22 offen offset:2048 sc1
  buffer_load_dwordx4 v[132:135], v2, s[8:11], s22 offen offset:3072 sc1
  s_add_u32 s22, s31, 241664
  buffer_load_dwordx4 v[136:139], v2, s[8:11], s22 offen offset:0 sc1
  buffer_load_dwordx4 v[140:143], v2, s[8:11], s22 offen offset:1024 sc1
  buffer_load_dwordx4 v[144:147], v2, s[8:11], s22 offen offset:2048 sc1
  buffer_load_dwordx4 v[148:151], v2, s[8:11], s22 offen offset:3072 sc1
  s_add_u32 s22, s31, 245760
  buffer_load_dwordx4 v[152:155], v2, s[8:11], s22 offen offset:0 sc1
  buffer_load_dwordx4 v[156:159], v2, s[8:11], s22 offen offset:1024 sc1
  buffer_load_dwordx4 v[160:163], v2, s[8:11], s22 offen offset:2048 sc1
  buffer_load_dwordx4 v[164:167], v2, s[8:11], s22 offen offset:3072 sc1
  s_add_u32 s22, s31, 249856
  buffer_load_dwordx4 v[168:171], v2, s[8:11], s22 offen offset:0 sc1
  buffer_load_dwordx4 v[172:175], v2, s[8:11], s22 offen offset:1024 sc1
  buffer_load_dwordx4 v[176:179], v2, s[8:11], s22 offen offset:2048 sc1
  buffer_load_dwordx4 v[180:183], v2, s[8:11], s22 offen offset:3072 sc1
  s_add_u32 s22, s31, 253952
  buffer_load_dwordx4 v[184:187], v2, s[8:11], s22 offen offset:0 sc1
  buffer_load_dwordx4 v[188:191], v2, s[8:11], s22 offen offset:1024 sc1
  buffer_load_dwordx4 v[192:195], v2, s[8:11], s22 offen offset:2048 sc1
  buffer_load_dwordx4 v[196:199], v2, s[8:11], s22 offen offset:3072 sc1
  s_add_u32 s22, s31, 372736
  buffer_load_dwordx4 v[200:203], v2, s[8:11], s22 offen offset:0 sc1
  buffer_load_dwordx4 v[204:207], v2, s[8:11], s22 offen offset:1024 sc1
  buffer_load_dwordx4 v[208:211], v2, s[8:11], s22 offen offset:2048 sc1
  buffer_load_dwordx4 v[212:215], v2, s[8:11], s22 offen offset:3072 sc1
  s_waitcnt vmcnt(24)
  s_add_u32 s22, s31, 376832
  buffer_load_dwordx4 v[216:219], v2, s[8:11], s22 offen offset:0 sc1
  buffer_load_dwordx4 v[220:223], v2, s[8:11], s22 offen offset:1024 sc1
  buffer_load_dwordx4 v[224:227], v2, s[8:11], s22 offen offset:2048 sc1
  buffer_load_dwordx4 v[228:231], v2, s[8:11], s22 offen offset:3072 sc1
  s_add_u32 s22, s31, 380928
  buffer_load_dwordx4 v[232:235], v2, s[8:11], s22 offen offset:0 sc1
  buffer_load_dwordx4 v[236:239], v2, s[8:11], s22 offen offset:1024 sc1
  buffer_load_dwordx4 v[240:243], v2, s[8:11], s22 offen offset:2048 sc1
  buffer_load_dwordx4 v[244:247], v2, s[8:11], s22 offen offset:3072 sc1
  s_add_u32 s22, s31, 385024
  buffer_load_dwordx4 v[248:251], v2, s[8:11], s22 offen offset:0 sc1
  buffer_load_dwordx4 v[252:255], v2, s[8:11], s22 offen offset:1024 sc1
  s_mov_b32 s27, 88523264
  s_mov_b32 s28, 0xffff
  s_mov_b32 s30, 0
ch_wx0:
  buffer_load_dword v65, off, s[8:11], s27  sc1
  s_waitcnt vmcnt(0)
  v_and_b32 v66, s28, v65
  v_cmp_ne_u32 vcc, s28, v66
  s_cbranch_vccz ch_wx0_ok
  s_sleep 8
  s_add_u32 s30, s30, 1
  s_cmp_lt_u32 s30, 400000
  s_cbranch_scc1 ch_wx0
  s_branch cA_abort
ch_wx0_ok:
  s_mov_b32 s24, 72024064
  s_mov_b32 s26, 72038400
  v_and_b32 v64, 7, v117
  v_and_b32 v65, 1, v116
  v_lshlrev_b32 v65, 2, v65
  v_sub_u32 v64, v64, v65
  v_lshrrev_b32 v65, 3, v117
  v_lshl_add_u32 v66, v65, 2, v64
  v_cmp_gt_u32 vcc, 4, v64
  v_mov_b32 v67, 99
  s_nop 0
  v_cndmask_b32 v66, v67, v66, vcc
  v_mov_b32 v68, 0x3f80
  v_mov_b32 v69, 0x3f800000
  v_mov_b32 v4, 0
  v_cmp_eq_u32 vcc, 0, v66
  s_nop 1
  v_cndmask_b32 v4, v4, v68, vcc
  v_cmp_eq_u32 vcc, 1, v66
  s_nop 1
  v_cndmask_b32 v4, v4, v69, vcc
  v_mov_b32 v5, 0
  v_cmp_eq_u32 vcc, 2, v66
  s_nop 1
  v_cndmask_b32 v5, v5, v68, vcc
  v_cmp_eq_u32 vcc, 3, v66
  s_nop 1
  v_cndmask_b32 v5, v5, v69, vcc
  v_mov_b32 v6, 0
  v_cmp_eq_u32 vcc, 4, v66
  s_nop 1
  v_cndmask_b32 v6, v6, v68, vcc
  v_cmp_eq_u32 vcc, 5, v66
  s_nop 1
  v_cndmask_b32 v6, v6, v69, vcc
  v_mov_b32 v7, 0
  v_cmp_eq_u32 vcc, 6, v66
  s_nop 1
  v_cndmask_b32 v7, v7, v68, vcc
  v_cmp_eq_u32 vcc, 7, v66
  s_nop 1
  v_cndmask_b32 v7, v7, v69, vcc
  v_lshrrev_b32 v64, 1, v116
  v_lshrrev_b32 v65, 3, v117
  v_and_b32 v66, 1, v116
  v_and_b32 v68, 7, v117
  v_lshlrev_b32 v67, 8, v65
  v_lshl_add_u32 v67, v68, 5, v67
  v_lshl_add_u32 v67, v66, 4, v67
  v_add_u32 v69, 4096, v67
  v_add_u32 v70, 6400, v67
  v_cmp_eq_u32 vcc, v64, v65
  s_nop 1
  v_cndmask_b32 v113, v70, v69, vcc
  v_lshlrev_b32 v67, 9, v64
  v_lshl_add_u32 v67, v117, 4, v67
  v_lshl_add_u32 v67, v66, 3, v67
  v_add_u32 v114, 0, v67
  v_mul_u32_u24 v67, 1088, v65
  v_lshl_add_u32 v67, v116, 5, v67
  v_lshl_add_u32 v67, v68, 2, v67
  v_add_u32 v115, 4096, v67
  v_and_b32 v69, 1, v117
  v_lshlrev_b32 v67, 7, v69
  v_lshl_add_u32 v67, v116, 4, v67
  v_lshl_add_u32 v67, v65, 8, v67
  v_bfe_u32 v69, v117, 1, 2
  v_lshl_add_u32 v67, v69, 2, v67
  s_lshl_b32 s22, s17, 9
  s_add_u32 s22, s22, 9216
  v_add_u32 v72, s22, v67
  v_bfe_u32 v69, v117, 1, 1
  v_lshlrev_b32 v67, 7, v69
  v_lshl_add_u32 v67, v116, 4, v67
  v_and_b32 v69, 4, v117
  v_add_u32 v67, v67, v69
  s_lshr_b32 s22, s17, 1
  s_lshl_b32 s22, s22, 8
  s_and_b32 s27, s17, 1
  s_lshl_b32 s27, s27, 3
  s_add_u32 s22, s22, s27
  s_add_u32 s22, s22, 7168
  v_add_u32 v67, s22, v67
  v_and_b32 v69, 9, v117
  v_mov_b32 v70, 0x40000000
  v_cmp_eq_u32 vcc, 0, v69
  s_nop 1
  v_cndmask_b32 v118, v70, v67, vcc
  v_mov_b32 v119, -1
  v_and_b32 v0, 15, v1
  s_and_b32 s22, s17, 0
  s_lshl_b32 s22, s22, 7
  s_add_u32 s22, s22, 75731456
  v_lshl_add_u32 v0, v0, 2, s22
  v_xor_b32 v69, 256, v2
  v_mul_i32_i24 v70, -4096, v66
  v_add_u32 v69, v69, v70
  v_add_u32 v117, 12288, v69
  v_mov_b32 v116, v73
  s_mul_i32 s35, s17, 28672
  s_add_u32 s35, s35, 44040192
  v_mov_b32 v1, v72
  v_mov_b32 v36, 0
  v_mov_b32 v37, 0
  v_mov_b32 v38, 0
  v_mov_b32 v39, 0
  v_mov_b32 v40, 0
  v_mov_b32 v41, 0
  v_mov_b32 v42, 0
  v_mov_b32 v43, 0
  v_mov_b32 v44, 0
  v_mov_b32 v45, 0
  v_mov_b32 v46, 0
  v_mov_b32 v47, 0
  v_mov_b32 v48, 0
  v_mov_b32 v49, 0
  v_mov_b32 v50, 0
  v_mov_b32 v51, 0
  v_mov_b32 v52, 0
  v_mov_b32 v53, 0
  v_mov_b32 v54, 0
  v_mov_b32 v55, 0
  v_mov_b32 v56, 0
  v_mov_b32 v57, 0
  v_mov_b32 v58, 0
  v_mov_b32 v59, 0
  v_mov_b32 v60, 0
  v_mov_b32 v61, 0
  v_mov_b32 v62, 0
  v_mov_b32 v63, 0
  v_mov_b32 v64, 0
  v_mov_b32 v65, 0
  v_mov_b32 v66, 0
  v_mov_b32 v67, 0
  v_mov_b32 v68, 0
  v_mov_b32 v69, 0
  v_mov_b32 v70, 0
  v_mov_b32 v71, 0
  v_mov_b32 v72, 0
  v_mov_b32 v73, 0
  v_mov_b32 v74, 0
  v_mov_b32 v75, 0
  v_mov_b32 v76, 0
  v_mov_b32 v77, 0
  v_mov_b32 v78, 0
  v_mov_b32 v79, 0
  buffer_load_dwordx4 v[80:83], v117, s[8:11], s24 offen offset:0 sc1
  buffer_load_dwordx4 v[84:87], v117, s[8:11], s24 offen offset:1024 sc1
  s_mov_b32 s30, 0
  v_mov_b32 v8, 0
ch_md0:
  buffer_load_dword v9, v8, s[12:15], 0 offen sc1
  s_waitcnt vmcnt(0) lgkmcnt(0)
  v_readfirstlane_b32 s22, v9
  s_and_b32 s31, s22, 0xffff
  s_cmp_ge_u32 s31, 32
  s_cbranch_scc1 ch_go0
  s_sleep 2
  s_add_u32 s30, s30, 1
  s_cmp_lt_u32 s30, 3200000
  s_cbranch_scc1 ch_md0
  s_branch ch_end
ch_go0:
  s_mov_b32 s31, 0
  s_lshr_b32 s22, s22, 16
  s_cmp_lg_u32 s22, 0
  s_cbranch_scc1 cB_sc0_loop
  s_branch cA_sc0_loop
ch_init1:
  s_mul_i32 s31, s17, 401408
  s_add_u32 s31, s31, 0
  s_mov_b32 s30, 0
ch_wr1:
  buffer_load_dword v65, off, s[12:15], 0 offset:132 sc1
  s_waitcnt vmcnt(0)
  v_cmp_ne_u32 vcc, 1, v65
  s_cbranch_vccz ch_wr1_ok
  s_sleep 8
  s_add_u32 s30, s30, 1
  s_cmp_lt_u32 s30, 400000
  s_cbranch_scc1 ch_wr1
  s_branch cA_abort
ch_wr1_ok:
  s_lshl_b32 s27, s17, 7
  s_add_u32 s27, s27, 88521216
  s_mov_b32 s28, 258
  s_mov_b32 s30, 0
ch_wa1:
  buffer_load_dword v65, off, s[8:11], s27  sc1
  s_waitcnt vmcnt(0)
  v_and_b32 v66, s28, v65
  v_cmp_ne_u32 vcc, s28, v66
  s_cbranch_vccz ch_wa1_ok
  s_sleep 3
  s_add_u32 s30, s30, 1
  s_cmp_lt_u32 s30, 400000
  s_cbranch_scc1 ch_wa1
  s_branch cA_abort
ch_wa1_ok:
  v_readfirstlane_b32 s29, v65
  s_add_u32 s22, s31, 57344
  buffer_load_dwordx4 a[0:3], v2, s[8:11], s22 offen offset:0 sc1
  buffer_load_dwordx4 a[4:7], v2, s[8:11], s22 offen offset:1024 sc1
  buffer_load_dwordx4 a[8:11], v2, s[8:11], s22 offen offset:2048 sc1
  buffer_load_dwordx4 a[12:15], v2, s[8:11], s22 offen offset:3072 sc1
  s_add_u32 s22, s31, 61440
  buffer_load_dwordx4 a[16:19], v2, s[8:11], s22 offen offset:0 sc1
  buffer_load_dwordx4 a[20:23], v2, s[8:11], s22 offen offset:1024 sc1
  buffer_load_dwordx4 a[24:27], v2, s[8:11], s22 offen offset:2048 sc1
  buffer_load_dwordx4 a[28:31], v2, s[8:11], s22 offen offset:3072 sc1
  s_add_u32 s22, s31, 65536
  buffer_load_dwordx4 a[32:35], v2, s[8:11], s22 offen offset:0 sc1
  buffer_load_dwordx4 a[36:39], v2, s[8:11], s22 offen offset:1024 sc1
  buffer_load_dwordx4 a[40:43], v2, s[8:11], s22 offen offset:2048 sc1
  buffer_load_dwordx4 a[44:47], v2, s[8:11], s22 offen offset:3072 sc1
  s_add_u32 s22, s31, 69632
  buffer_load_dwordx4 a[48:51], v2, s[8:11], s22 offen offset:0 sc1
  buffer_load_dwordx4 a[52:55], v2, s[8:11], s22 offen offset:1024 sc1
  buffer_load_dwordx4 a[56:59], v2, s[8:11], s22 offen offset:2048 sc1
  buffer_load_dwordx4 a[60:63], v2, s[8:11], s22 offen offset:3072 sc1
  s_add_u32 s22, s31, 73728
  buffer_load_dwordx4 a[64:67], v2, s[8:11], s22 offen offset:0 sc1
  buffer_load_dwordx4 a[68:71], v2, s[8:11], s22 offen offset:1024 sc1
  buffer_load_dwordx4 a[72:75], v2, s[8:11], s22 offen offset:2048 sc1
  buffer_load_dwordx4 a[76:79], v2, s[8:11], s22 offen offset:3072 sc1
  s_add_u32 s22, s31, 77824
  buffer_load_dwordx4 a[80:83], v2, s[8:11], s22 offen offset:0 sc1
  buffer_load_dwordx4 a[84:87], v2, s[8:11], s22 offen offset:1024 sc1
  buffer_load_dwordx4 a[88:91], v2, s[8:11], s22 offen offset:2048 sc1
  buffer_load_dwordx4 a[92:95], v2, s[8:11], s22 offen offset:3072 sc1
  s_add_u32 s22, s31, 81920
  buffer_load_dwordx4 a[96:99], v2, s[8:11], s22 offen offset:0 sc1
  buffer_load_dwordx4 a[100:103], v2, s[8:11], s22 offen offset:1024 sc1
  buffer_load_dwordx4 a[104:107], v2, s[8:11], s22 offen offset:2048 sc1
  buffer_load_dwordx4 a[108:111], v2, s[8:11], s22 offen offset:3072 sc1
  s_add_u32 s22, s31, 86016
  buffer_load_dwordx4 a[112:115], v2, s[8:11], s22 offen offset:0 sc1
  buffer_load_dwordx4 a[116:119], v2, s[8:11], s22 offen offset:1024 sc1
  buffer_load_dwordx4 a[120:123], v2, s[8:11], s22 offen offset:2048 sc1
  buffer_load_dwordx4 a[124:127], v2, s[8:11], s22 offen offset:3072 sc1
  s_waitcnt vmcnt(24)
  s_add_u32 s22, s31, 90112
  buffer_load_dwordx4 a[128:131], v2, s[8:11], s22 offen offset:0 sc1
  buffer_load_dwordx4 a[132:135], v2, s[8:11], s22 offen offset:1024 sc1
  buffer_load_dwordx4 a[136:139], v2, s[8:11], s22 offen offset:2048 sc1
  buffer_load_dwordx4 a[140:143], v2, s[8:11], s22 offen offset:3072 sc1
  s_add_u32 s22, s31, 94208
  buffer_load_dwordx4 a[144:147], v2, s[8:11], s22 offen offset:0 sc1
  buffer_load_dwordx4 a[148:151], v2, s[8:11], s22 offen offset:1024 sc1
  buffer_load_dwordx4 a[152:155], v2, s[8:11], s22 offen offset:2048 sc1
  buffer_load_dwordx4 a[156:159], v2, s[8:11], s22 offen offset:3072 sc1
  s_add_u32 s22, s31, 98304
  buffer_load_dwordx4 a[160:163], v2, s[8:11], s22 offen offset:0 sc1
  buffer_load_dwordx4 a[164:167], v2, s[8:11], s22 offen offset:1024 sc1
  buffer_load_dwordx4 a[168:171], v2, s[8:11], s22 offen offset:2048 sc1
  buffer_load_dwordx4 a[172:175], v2, s[8:11], s22 offen offset:3072 sc1
  s_add_u32 s22, s31, 102400
  buffer_load_dwordx4 a[176:179], v2, s[8:11], s22 offen offset:0 sc1
  buffer_load_dwordx4 a[180:183], v2, s[8:11], s22 offen offset:1024 sc1
  buffer_load_dwordx4 a[184:187], v2, s[8:11], s22 offen offset:2048 sc1
  buffer_load_dwordx4 a[188:191], v2, s[8:11], s22 offen offset:3072 sc1
  s_add_u32 s22, s31, 106496
  buffer_load_dwordx4 a[192:195], v2, s[8:11], s22 offen offset:0 sc1
  buffer_load_dwordx4 a[196:199], v2, s[8:11], s22 offen offset:1024 sc1
  buffer_load_dwordx4 a[200:203], v2, s[8:11], s22 offen offset:2048 sc1
  buffer_load_dwordx4 a[204:207], v2, s[8:11], s22 offen offset:3072 sc1
  s_add_u32 s22, s31, 110592
  buffer_load_dwordx4 a[208:211], v2, s[8:11], s22 offen offset:0 sc1
  buffer_load_dwordx4 a[212:215], v2, s[8:11], s22 offen offset:1024 sc1
  buffer_load_dwordx4 a[216:219], v2, s[8:11], s22 offen offset:2048 sc1
  buffer_load_dwordx4 a[220:223], v2, s[8:11], s22 offen offset:3072 sc1
  s_and_b32 s29, s29, 10320
  s_cmp_eq_u32 s29, 10320
  s_cbranch_scc1 ch_wb1_ok
  s_lshl_b32 s27, s17, 7
  s_add_u32 s27, s27, 88521216
  s_mov_b32 s28, 10320
  s_mov_b32 s30, 0
ch_wb1:
  buffer_load_dword v65, off, s[8:11], s27  sc1
  s_waitcnt vmcnt(0)
  v_and_b32 v66, s28, v65
  v_cmp_ne_u32 vcc, s28, v66
  s_cbranch_vccz ch_wb1_ok
  s_sleep 3
  s_add_u32 s30, s30, 1
  s_cmp_lt_u32 s30, 400000
  s_cbranch_scc1 ch_wb1
  s_branch cA_abort
ch_wb1_ok:
  s_waitcnt vmcnt(28)
  s_add_u32 s22, s31, 258048
  buffer_load_dwordx4 a[224:227], v2, s[8:11], s22 offen offset:0 sc1
  buffer_load_dwordx4 a[228:231], v2, s[8:11], s22 offen offset:1024 sc1
  buffer_load_dwordx4 a[232:235], v2, s[8:11], s22 offen offset:2048 sc1
  buffer_load_dwordx4 a[236:239], v2, s[8:11], s22 offen offset:3072 sc1
  s_add_u32 s22, s31, 262144
  buffer_load_dwordx4 a[240:243], v2, s[8:11], s22 offen offset:0 sc1
  buffer_load_dwordx4 a[244:247], v2, s[8:11], s22 offen offset:1024 sc1
  buffer_load_dwordx4 a[248:251], v2, s[8:11], s22 offen offset:2048 sc1
  buffer_load_dwordx4 a[252:255], v2, s[8:11], s22 offen offset:3072 sc1
  s_add_u32 s22, s31, 266240
  buffer_load_dwordx4 v[120:123], v2, s[8:11], s22 offen offset:0 sc1
  buffer_load_dwordx4 v[124:127], v2, s[8:11], s22 offen offset:1024 sc1
  buffer_load_dwordx4 v[128:131], v2, s[8:11], s22 offen offset:2048 sc1
  buffer_load_dwordx4 v[132:135], v2, s[8:11], s22 offen offset:3072 sc1
  s_add_u32 s22, s31, 270336
  buffer_load_dwordx4 v[136:139], v2, s[8:11], s22 offen offset:0 sc1
  buffer_load_dwordx4 v[140:143], v2, s[8:11], s22 offen offset:1024 sc1
  buffer_load_dwordx4 v[144:147], v2, s[8:11], s22 offen offset:2048 sc1
  buffer_load_dwordx4 v[148:151], v2, s[8:11], s22 offen offset:3072 sc1
  s_add_u32 s22, s31, 274432
  buffer_load_dwordx4 v[152:155], v2, s[8:11], s22 offen offset:0 sc1
  buffer_load_dwordx4 v[156:159], v2, s[8:11], s22 offen offset:1024 sc1
  buffer_load_dwordx4 v[160:163], v2, s[8:11], s22 offen offset:2048 sc1
  buffer_load_dwordx4 v[164:167], v2, s[8:11], s22 offen offset:3072 sc1
  s_add_u32 s22, s31, 278528
  buffer_load_dwordx4 v[168:171], v2, s[8:11], s22 offen offset:0 sc1
  buffer_load_dwordx4 v[172:175], v2, s[8:11], s22 offen offset:1024 sc1
  buffer_load_dwordx4 v[176:179], v2, s[8:11], s22 offen offset:2048 sc1
  buffer_load_dwordx4 v[180:183], v2, s[8:11], s22 offen offset:3072 sc1
  s_add_u32 s22, s31, 282624
  buffer_load_dwordx4 v[184:187], v2, s[8:11], s22 offen offset:0 sc1
  buffer_load_dwordx4 v[188:191], v2, s[8:11], s22 offen offset:1024 sc1
  buffer_load_dwordx4 v[192:195], v2, s[8:11], s22 offen offset:2048 sc1
  buffer_load_dwordx4 v[196:199], v2, s[8:11], s22 offen offset:3072 sc1
  s_add_u32 s22, s31, 344064
  buffer_load_dwordx4 v[200:203], v2, s[8:11], s22 offen offset:0 sc1
  buffer_load_dwordx4 v[204:207], v2, s[8:11], s22 offen offset:1024 sc1
  buffer_load_dwordx4 v[208:211], v2, s[8:11], s22 offen offset:2048 sc1
  buffer_load_dwordx4 v[212:215], v2, s[8:11], s22 offen offset:3072 sc1
  s_waitcnt vmcnt(24)
  s_add_u32 s22, s31, 348160
  buffer_load_dwordx4 v[216:219], v2, s[8:11], s22 offen offset:0 sc1
  buffer_load_dwordx4 v[220:223], v2, s[8:11], s22 offen offset:1024 sc1
  buffer_load_dwordx4 v[224:227], v2, s[8:11], s22 offen offset:2048 sc1
  buffer_load_dwordx4 v[228:231], v2, s[8:11], s22 offen offset:3072 sc1
  s_add_u32 s22, s31, 352256
  buffer_load_dwordx4 v[232:235], v2, s[8:11], s22 offen offset:0 sc1
  buffer_load_dwordx4 v[236:239], v2, s[8:11], s22 offen offset:1024 sc1
  buffer_load_dwordx4 v[240:243], v2, s[8:11], s22 offen offset:2048 sc1
  buffer_load_dwordx4 v[244:247], v2, s[8:11], s22 offen offset:3072 sc1
  s_add_u32 s22, s31, 356352
  buffer_load_dwordx4 v[248:251], v2, s[8:11], s22 offen offset:0 sc1
  buffer_load_dwordx4 v[252:255], v2, s[8:11], s22 offen offset:1024 sc1
  s_mov_b32 s27, 88523264
  s_mov_b32 s28, 0xffff
  s_mov_b32 s30, 0
ch_wx1:
  buffer_load_dword v65, off, s[8:11], s27  sc1
  s_waitcnt vmcnt(0)
  v_and_b32 v66, s28, v65
  v_cmp_ne_u32 vcc, s28, v66
  s_cbranch_vccz ch_wx1_ok
  s_sleep 8
  s_add_u32 s30, s30, 1
  s_cmp_lt_u32 s30, 400000
  s_cbranch_scc1 ch_wx1
  s_branch cA_abort
ch_wx1_ok:
  s_mov_b32 s24, 72026112
  s_mov_b32 s26, 72040448
  v_and_b32 v64, 7, v117
  v_and_b32 v65, 1, v116
  v_lshlrev_b32 v65, 2, v65
  v_sub_u32 v64, v64, v65
  v_lshrrev_b32 v65, 3, v117
  v_lshl_add_u32 v66, v65, 2, v64
  v_cmp_gt_u32 vcc, 4, v64
  v_mov_b32 v67, 99
  s_nop 0
  v_cndmask_b32 v66, v67, v66, vcc
  v_mov_b32 v68, 0x3f80
  v_mov_b32 v69, 0x3f800000
  v_mov_b32 v4, 0
  v_cmp_eq_u32 vcc, 0, v66
  s_nop 1
  v_cndmask_b32 v4, v4, v68, vcc
  v_cmp_eq_u32 vcc, 1, v66
  s_nop 1
  v_cndmask_b32 v4, v4, v69, vcc
  v_mov_b32 v5, 0
  v_cmp_eq_u32 vcc, 2, v66
  s_nop 1
  v_cndmask_b32 v5, v5, v68, vcc
  v_cmp_eq_u32 vcc, 3, v66
  s_nop 1
  v_cndmask_b32 v5, v5, v69, vcc
  v_mov_b32 v6, 0
  v_cmp_eq_u32 vcc, 4, v66
  s_nop 1
  v_cndmask_b32 v6, v6, v68, vcc
  v_cmp_eq_u32 vcc, 5, v66
  s_nop 1
  v_cndmask_b32 v6, v6, v69, vcc
  v_mov_b32 v7, 0
  v_cmp_eq_u32 vcc, 6, v66
  s_nop 1
  v_cndmask_b32 v7, v7, v68, vcc
  v_cmp_eq_u32 vcc, 7, v66
  s_nop 1
  v_cndmask_b32 v7, v7, v69, vcc
  v_lshrrev_b32 v64, 1, v116
  v_lshrrev_b32 v65, 3, v117
  v_and_b32 v66, 1, v116
  v_and_b32 v68, 7, v117
  v_lshlrev_b32 v67, 8, v65
  v_lshl_add_u32 v67, v68, 5, v67
  v_lshl_add_u32 v67, v66, 4, v67
  v_add_u32 v69, 4608, v67
  v_add_u32 v70, 6400, v67
  v_cmp_eq_u32 vcc, v64, v65
  s_nop 1
  v_cndmask_b32 v113, v70, v69, vcc
  v_lshlrev_b32 v67, 9, v64
  v_lshl_add_u32 v67, v117, 4, v67
  v_lshl_add_u32 v67, v66, 3, v67
  v_add_u32 v114, 256, v67
  v_mul_u32_u24 v67, 1088, v65
  v_lshl_add_u32 v67, v116, 5, v67
  v_lshl_add_u32 v67, v68, 2, v67
  v_add_u32 v115, 4224, v67
  v_and_b32 v69, 1, v117
  v_lshlrev_b32 v67, 7, v69
  v_lshl_add_u32 v67, v116, 4, v67
  v_lshl_add_u32 v67, v65, 8, v67
  v_bfe_u32 v69, v117, 1, 2
  v_lshl_add_u32 v67, v69, 2, v67
  s_lshl_b32 s22, s17, 9
  s_add_u32 s22, s22, 9280
  v_add_u32 v72, s22, v67
  v_bfe_u32 v69, v117, 1, 1
  v_lshlrev_b32 v67, 7, v69
  v_lshl_add_u32 v67, v116, 4, v67
  v_and_b32 v69, 4, v117
  v_add_u32 v67, v67, v69
  s_lshr_b32 s22, s17, 1
  s_lshl_b32 s22, s22, 8
  s_and_b32 s27, s17, 1
  s_lshl_b32 s27, s27, 3
  s_add_u32 s22, s22, s27
  s_add_u32 s22, s22, 7232
  v_add_u32 v67, s22, v67
  v_and_b32 v69, 9, v117
  v_mov_b32 v70, 0x40000000
  v_cmp_eq_u32 vcc, 0, v69
  s_nop 1
  v_cndmask_b32 v118, v70, v67, vcc
  v_mov_b32 v119, -1
  s_lshl_b32 s22, s17, 2
  s_add_u32 s22, s22, 75729408
  v_lshl_add_u32 v67, v1, 7, s22
  v_mov_b32 v70, 0x40000000
  v_cmp_gt_u32 vcc, 1, v1
  s_nop 1
  v_cndmask_b32 v73, v70, v67, vcc
  v_mov_b32 v112, 1
  v_and_b32 v0, 15, v1
  s_and_b32 s22, s17, 0
  s_lshl_b32 s22, s22, 7
  s_add_u32 s22, s22, 75731456
  v_lshl_add_u32 v0, v0, 2, s22
  v_xor_b32 v69, 256, v2
  v_mul_i32_i24 v70, 4096, v66
  v_add_u32 v69, v69, v70
  v_add_u32 v117, 6144, v69
  v_mov_b32 v116, v73
  s_mul_i32 s35, s17, 28672
  s_add_u32 s35, s35, 44040192
  v_mov_b32 v1, v72
  v_mov_b32 v36, 0
  v_mov_b32 v37, 0
  v_mov_b32 v38, 0
  v_mov_b32 v39, 0
  v_mov_b32 v40, 0
  v_mov_b32 v41, 0
  v_mov_b32 v42, 0
  v_mov_b32 v43, 0
  v_mov_b32 v44, 0
  v_mov_b32 v45, 0
  v_mov_b32 v46, 0
  v_mov_b32 v47, 0
  v_mov_b32 v48, 0
  v_mov_b32 v49, 0
  v_mov_b32 v50, 0
  v_mov_b32 v51, 0
  v_mov_b32 v52, 0
  v_mov_b32 v53, 0
  v_mov_b32 v54, 0
  v_mov_b32 v55, 0
  v_mov_b32 v56, 0
  v_mov_b32 v57, 0
  v_mov_b32 v58, 0
  v_mov_b32 v59, 0
  v_mov_b32 v60, 0
  v_mov_b32 v61, 0
  v_mov_b32 v62, 0
  v_mov_b32 v63, 0
  v_mov_b32 v64, 0
  v_mov_b32 v65, 0
  v_mov_b32 v66, 0
  v_mov_b32 v67, 0
  v_mov_b32 v68, 0
  v_mov_b32 v69, 0
  v_mov_b32 v70, 0
  v_mov_b32 v71, 0
  v_mov_b32 v72, 0
  v_mov_b32 v73, 0
  v_mov_b32 v74, 0
  v_mov_b32 v75, 0
  v_mov_b32 v76, 0
  v_mov_b32 v77, 0
  v_mov_b32 v78, 0
  v_mov_b32 v79, 0
  buffer_load_dwordx4 v[80:83], v117, s[8:11], s24 offen offset:0 sc1
  buffer_load_dwordx4 v[84:87], v117, s[8:11], s24 offen offset:1024 sc1
  s_mov_b32 s30, 0
  v_mov_b32 v8, 0
ch_md1:
  buffer_load_dword v9, v8, s[12:15], 0 offen sc1
  s_waitcnt vmcnt(0) lgkmcnt(0)
  v_readfirstlane_b32 s22, v9
  s_and_b32 s31, s22, 0xffff
  s_cmp_ge_u32 s31, 32
  s_cbranch_scc1 ch_go1
  s_sleep 2
  s_add_u32 s30, s30, 1
  s_cmp_lt_u32 s30, 3200000
  s_cbranch_scc1 ch_md1
  s_branch ch_end
ch_go1:
  s_mov_b32 s31, 0
  s_lshr_b32 s22, s22, 16
  s_cmp_lg_u32 s22, 0
  s_cbranch_scc1 cB_sc1_loop
  s_branch cA_sc1_loop
ch_init2:
  s_mul_i32 s31, s17, 401408
  s_add_u32 s31, s31, 0
  s_mov_b32 s30, 0
ch_wr2:
  buffer_load_dword v65, off, s[12:15], 0 offset:132 sc1
  s_waitcnt vmcnt(0)
  v_cmp_ne_u32 vcc, 1, v65
  s_cbranch_vccz ch_wr2_ok
  s_sleep 8
  s_add_u32 s30, s30, 1
  s_cmp_lt_u32 s30, 400000
  s_cbranch_scc1 ch_wr2
  s_branch cA_abort
ch_wr2_ok:
  s_lshl_b32 s27, s17, 7
  s_add_u32 s27, s27, 88521216
  s_mov_b32 s28, 516
  s_mov_b32 s30, 0
ch_wa2:
  buffer_load_dword v65, off, s[8:11], s27  sc1
  s_waitcnt vmcnt(0)
  v_and_b32 v66, s28, v65
  v_cmp_ne_u32 vcc, s28, v66
  s_cbranch_vccz ch_wa2_ok
  s_sleep 3
  s_add_u32 s30, s30, 1
  s_cmp_lt_u32 s30, 400000
  s_cbranch_scc1 ch_wa2
  s_branch cA_abort
ch_wa2_ok:
  v_readfirstlane_b32 s29, v65
  s_add_u32 s22, s31, 114688
  buffer_load_dwordx4 a[0:3], v2, s[8:11], s22 offen offset:0 sc1
  buffer_load_dwordx4 a[4:7], v2, s[8:11], s22 offen offset:1024 sc1
  buffer_load_dwordx4 a[8:11], v2, s[8:11], s22 offen offset:2048 sc1
  buffer_load_dwordx4 a[12:15], v2, s[8:11], s22 offen offset:3072 sc1
  s_add_u32 s22, s31, 118784
  buffer_load_dwordx4 a[16:19], v2, s[8:11], s22 offen offset:0 sc1
  buffer_load_dwordx4 a[20:23], v2, s[8:11], s22 offen offset:1024 sc1
  buffer_load_dwordx4 a[24:27], v2, s[8:11], s22 offen offset:2048 sc1
  buffer_load_dwordx4 a[28:31], v2, s[8:11], s22 offen offset:3072 sc1
  s_add_u32 s22, s31, 122880
  buffer_load_dwordx4 a[32:35], v2, s[8:11], s22 offen offset:0 sc1
  buffer_load_dwordx4 a[36:39], v2, s[8:11], s22 offen offset:1024 sc1
  buffer_load_dwordx4 a[40:43], v2, s[8:11], s22 offen offset:2048 sc1
  buffer_load_dwordx4 a[44:47], v2, s[8:11], s22 offen offset:3072 sc1
  s_add_u32 s22, s31, 126976
  buffer_load_dwordx4 a[48:51], v2, s[8:11], s22 offen offset:0 sc1
  buffer_load_dwordx4 a[52:55], v2, s[8:11], s22 offen offset:1024 sc1
  buffer_load_dwordx4 a[56:59], v2, s[8:11], s22 offen offset:2048 sc1
  buffer_load_dwordx4 a[60:63], v2, s[8:11], s22 offen offset:3072 sc1
  s_add_u32 s22, s31, 131072
  buffer_load_dwordx4 a[64:67], v2, s[8:11], s22 offen offset:0 sc1
  buffer_load_dwordx4 a[68:71], v2, s[8:11], s22 offen offset:1024 sc1
  buffer_load_dwordx4 a[72:75], v2, s[8:11], s22 offen offset:2048 sc1
  buffer_load_dwordx4 a[76:79], v2, s[8:11], s22 offen offset:3072 sc1
  s_add_u32 s22, s31, 135168
  buffer_load_dwordx4 a[80:83], v2, s[8:11], s22 offen offset:0 sc1
  buffer_load_dwordx4 a[84:87], v2, s[8:11], s22 offen offset:1024 sc1
  buffer_load_dwordx4 a[88:91], v2, s[8:11], s22 offen offset:2048 sc1
  buffer_load_dwordx4 a[92:95], v2, s[8:11], s22 offen offset:3072 sc1
  s_add_u32 s22, s31, 139264
  buffer_load_dwordx4 a[96:99], v2, s[8:11], s22 offen offset:0 sc1
  buffer_load_dwordx4 a[100:103], v2, s[8:11], s22 offen offset:1024 sc1
  buffer_load_dwordx4 a[104:107], v2, s[8:11], s22 offen offset:2048 sc1
  buffer_load_dwordx4 a[108:111], v2, s[8:11], s22 offen offset:3072 sc1
  s_add_u32 s22, s31, 143360
  buffer_load_dwordx4 a[112:115], v2, s[8:11], s22 offen offset:0 sc1
  buffer_load_dwordx4 a[116:119], v2, s[8:11], s22 offen offset:1024 sc1
  buffer_load_dwordx4 a[120:123], v2, s[8:11], s22 offen offset:2048 sc1
  buffer_load_dwordx4 a[124:127], v2, s[8:11], s22 offen offset:3072 sc1
  s_waitcnt vmcnt(24)
  s_add_u32 s22, s31, 147456
  buffer_load_dwordx4 a[128:131], v2, s[8:11], s22 offen offset:0 sc1
  buffer_load_dwordx4 a[132:135], v2, s[8:11], s22 offen offset:1024 sc1
  buffer_load_dwordx4 a[136:139], v2, s[8:11], s22 offen offset:2048 sc1
  buffer_load_dwordx4 a[140:143], v2, s[8:11], s22 offen offset:3072 sc1
  s_add_u32 s22, s31, 151552
  buffer_load_dwordx4 a[144:147], v2, s[8:11], s22 offen offset:0 sc1
  buffer_load_dwordx4 a[148:151], v2, s[8:11], s22 offen offset:1024 sc1
  buffer_load_dwordx4 a[152:155], v2, s[8:11], s22 offen offset:2048 sc1
  buffer_load_dwordx4 a[156:159], v2, s[8:11], s22 offen offset:3072 sc1
  s_add_u32 s22, s31, 155648
  buffer_load_dwordx4 a[160:163], v2, s[8:11], s22 offen offset:0 sc1
  buffer_load_dwordx4 a[164:167], v2, s[8:11], s22 offen offset:1024 sc1
  buffer_load_dwordx4 a[168:171], v2, s[8:11], s22 offen offset:2048 sc1
  buffer_load_dwordx4 a[172:175], v2, s[8:11], s22 offen offset:3072 sc1
  s_add_u32 s22, s31, 159744
  buffer_load_dwordx4 a[176:179], v2, s[8:11], s22 offen offset:0 sc1
  buffer_load_dwordx4 a[180:183], v2, s[8:11], s22 offen offset:1024 sc1
  buffer_load_dwordx4 a[184:187], v2, s[8:11], s22 offen offset:2048 sc1
  buffer_load_dwordx4 a[188:191], v2, s[8:11], s22 offen offset:3072 sc1
  s_add_u32 s22, s31, 163840
  buffer_load_dwordx4 a[192:195], v2, s[8:11], s22 offen offset:0 sc1
  buffer_load_dwordx4 a[196:199], v2, s[8:11], s22 offen offset:1024 sc1
  buffer_load_dwordx4 a[200:203], v2, s[8:11], s22 offen offset:2048 sc1
  buffer_load_dwordx4 a[204:207], v2, s[8:11], s22 offen offset:3072 sc1
  s_add_u32 s22, s31, 167936
  buffer_load_dwordx4 a[208:211], v2, s[8:11], s22 offen offset:0 sc1
  buffer_load_dwordx4 a[212:215], v2, s[8:11], s22 offen offset:1024 sc1
  buffer_load_dwordx4 a[216:219], v2, s[8:11], s22 offen offset:2048 sc1
  buffer_load_dwordx4 a[220:223], v2, s[8:11], s22 offen offset:3072 sc1
  s_and_b32 s29, s29, 12384
  s_cmp_eq_u32 s29, 12384
  s_cbranch_scc1 ch_wb2_ok
  s_lshl_b32 s27, s17, 7
  s_add_u32 s27, s27, 88521216
  s_mov_b32 s28, 12384
  s_mov_b32 s30, 0
ch_wb2:
  buffer_load_dword v65, off, s[8:11], s27  sc1
  s_waitcnt vmcnt(0)
  v_and_b32 v66, s28, v65
  v_cmp_ne_u32 vcc, s28, v66
  s_cbranch_vccz ch_wb2_ok
  s_sleep 3
  s_add_u32 s30, s30, 1
  s_cmp_lt_u32 s30, 400000
  s_cbranch_scc1 ch_wb2
  s_branch cA_abort
ch_wb2_ok:
  s_waitcnt vmcnt(28)
  s_add_u32 s22, s31, 286720
  buffer_load_dwordx4 a[224:227], v2, s[8:11], s22 offen offset:0 sc1
  buffer_load_dwordx4 a[228:231], v2, s[8:11], s22 offen offset:1024 sc1
  buffer_load_dwordx4 a[232:235], v2, s[8:11], s22 offen offset:2048 sc1
  buffer_load_dwordx4 a[236:239], v2, s[8:11], s22 offen offset:3072 sc1
  s_add_u32 s22, s31, 290816
  buffer_load_dwordx4 a[240:243], v2, s[8:11], s22 offen offset:0 sc1
  buffer_load_dwordx4 a[244:247], v2, s[8:11], s22 offen offset:1024 sc1
  buffer_load_dwordx4 a[248:251], v2, s[8:11], s22 offen offset:2048 sc1
  buffer_load_dwordx4 a[252:255], v2, s[8:11], s22 offen offset:3072 sc1
  s_add_u32 s22, s31, 294912
  buffer_load_dwordx4 v[120:123], v2, s[8:11], s22 offen offset:0 sc1
  buffer_load_dwordx4 v[124:127], v2, s[8:11], s22 offen offset:1024 sc1
  buffer_load_dwordx4 v[128:131], v2, s[8:11], s22 offen offset:2048 sc1
  buffer_load_dwordx4 v[132:135], v2, s[8:11], s22 offen offset:3072 sc1
  s_add_u32 s22, s31, 299008
  buffer_load_dwordx4 v[136:139], v2, s[8:11], s22 offen offset:0 sc1
  buffer_load_dwordx4 v[140:143], v2, s[8:11], s22 offen offset:1024 sc1
  buffer_load_dwordx4 v[144:147], v2, s[8:11], s22 offen offset:2048 sc1
  buffer_load_dwordx4 v[148:151], v2, s[8:11], s22 offen offset:3072 sc1
  s_add_u32 s22, s31, 303104
  buffer_load_dwordx4 v[152:155], v2, s[8:11], s22 offen offset:0 sc1
  buffer_load_dwordx4 v[156:159], v2, s[8:11], s22 offen offset:1024 sc1
  buffer_load_dwordx4 v[160:163], v2, s[8:11], s22 offen offset:2048 sc1
  buffer_load_dwordx4 v[164:167], v2, s[8:11], s22 offen offset:3072 sc1
  s_add_u32 s22, s31, 307200
  buffer_load_dwordx4 v[168:171], v2, s[8:11], s22 offen offset:0 sc1
  buffer_load_dwordx4 v[172:175], v2, s[8:11], s22 offen offset:1024 sc1
  buffer_load_dwordx4 v[176:179], v2, s[8:11], s22 offen offset:2048 sc1
  buffer_load_dwordx4 v[180:183], v2, s[8:11], s22 offen offset:3072 sc1
  s_add_u32 s22, s31, 311296
  buffer_load_dwordx4 v[184:187], v2, s[8:11], s22 offen offset:0 sc1
  buffer_load_dwordx4 v[188:191], v2, s[8:11], s22 offen offset:1024 sc1
  buffer_load_dwordx4 v[192:195], v2, s[8:11], s22 offen offset:2048 sc1
  buffer_load_dwordx4 v[196:199], v2, s[8:11], s22 offen offset:3072 sc1
  s_add_u32 s22, s31, 385024
  buffer_load_dwordx4 v[200:203], v2, s[8:11], s22 offen offset:2048 sc1
  buffer_load_dwordx4 v[204:207], v2, s[8:11], s22 offen offset:3072 sc1
  s_add_u32 s22, s31, 389120
  buffer_load_dwordx4 v[208:211], v2, s[8:11], s22 offen offset:0 sc1
  buffer_load_dwordx4 v[212:215], v2, s[8:11], s22 offen offset:1024 sc1
  s_waitcnt vmcnt(24)
  buffer_load_dwordx4 v[216:219], v2, s[8:11], s22 offen offset:2048 sc1
  buffer_load_dwordx4 v[220:223], v2, s[8:11], s22 offen offset:3072 sc1
  s_add_u32 s22, s31, 393216
  buffer_load_dwordx4 v[224:227], v2, s[8:11], s22 offen offset:0 sc1
  buffer_load_dwordx4 v[228:231], v2, s[8:11], s22 offen offset:1024 sc1
  buffer_load_dwordx4 v[232:235], v2, s[8:11], s22 offen offset:2048 sc1
  buffer_load_dwordx4 v[236:239], v2, s[8:11], s22 offen offset:3072 sc1
  s_add_u32 s22, s31, 397312
  buffer_load_dwordx4 v[240:243], v2, s[8:11], s22 offen offset:0 sc1
  buffer_load_dwordx4 v[244:247], v2, s[8:11], s22 offen offset:1024 sc1
  buffer_load_dwordx4 v[248:251], v2, s[8:11], s22 offen offset:2048 sc1
  buffer_load_dwordx4 v[252:255], v2, s[8:11], s22 offen offset:3072 sc1
  s_mov_b32 s27, 88523264
  s_mov_b32 s28, 0xffff
  s_mov_b32 s30, 0
ch_wx2:
  buffer_load_dword v65, off, s[8:11], s27  sc1
  s_waitcnt vmcnt(0)
  v_and_b32 v66, s28, v65
  v_cmp_ne_u32 vcc, s28, v66
  s_cbranch_vccz ch_wx2_ok
  s_sleep 8
  s_add_u32 s30, s30, 1
  s_cmp_lt_u32 s30, 400000
  s_cbranch_scc1 ch_wx2
  s_branch cA_abort
ch_wx2_ok:
  s_mov_b32 s24, 72028160
  s_mov_b32 s26, 72042496
  v_and_b32 v64, 7, v117
  v_and_b32 v65, 1, v116
  v_lshlrev_b32 v65, 2, v65
  v_sub_u32 v64, v64, v65
  v_lshrrev_b32 v65, 3, v117
  v_lshl_add_u32 v66, v65, 2, v64
  v_cmp_gt_u32 vcc, 4, v64
  v_mov_b32 v67, 99
  s_nop 0
  v_cndmask_b32 v66, v67, v66, vcc
  v_mov_b32 v68, 0x3f80
  v_mov_b32 v69, 0x3f800000
  v_mov_b32 v4, 0
  v_cmp_eq_u32 vcc, 0, v66
  s_nop 1
  v_cndmask_b32 v4, v4, v68, vcc
  v_cmp_eq_u32 vcc, 1, v66
  s_nop 1
  v_cndmask_b32 v4, v4, v69, vcc
  v_mov_b32 v5, 0
  v_cmp_eq_u32 vcc, 2, v66
  s_nop 1
  v_cndmask_b32 v5, v5, v68, vcc
  v_cmp_eq_u32 vcc, 3, v66
  s_nop 1
  v_cndmask_b32 v5, v5, v69, vcc
  v_mov_b32 v6, 0
  v_cmp_eq_u32 vcc, 4, v66
  s_nop 1
  v_cndmask_b32 v6, v6, v68, vcc
  v_cmp_eq_u32 vcc, 5, v66
  s_nop 1
  v_cndmask_b32 v6, v6, v69, vcc
  v_mov_b32 v7, 0
  v_cmp_eq_u32 vcc, 6, v66
  s_nop 1
  v_cndmask_b32 v7, v7, v68, vcc
  v_cmp_eq_u32 vcc, 7, v66
  s_nop 1
  v_cndmask_b32 v7, v7, v69, vcc
  v_lshrrev_b32 v64, 1, v116
  v_lshrrev_b32 v65, 3, v117
  v_and_b32 v66, 1, v116
  v_and_b32 v68, 7, v117
  v_lshlrev_b32 v67, 8, v65
  v_lshl_add_u32 v67, v68, 5, v67
  v_lshl_add_u32 v67, v66, 4, v67
  v_add_u32 v69, 5184, v67
  v_add_u32 v70, 6400, v67
  v_cmp_eq_u32 vcc, v64, v65
  s_nop 1
  v_cndmask_b32 v113, v70, v69, vcc
  v_and_b32 v0, 15, v1
  s_and_b32 s22, s17, 0
  s_lshl_b32 s22, s22, 7
  s_add_u32 s22, s22, 75731456
  v_lshl_add_u32 v0, v0, 2, s22
  v_xor_b32 v69, 256, v2
  v_mul_i32_i24 v70, -2048, v66
  v_add_u32 v69, v69, v70
  v_add_u32 v117, 8192, v69
  v_mov_b32 v116, v73
  s_mul_i32 s35, s17, 28672
  s_add_u32 s35, s35, 44040192
  v_mov_b32 v36, 0
  v_mov_b32 v37, 0
  v_mov_b32 v38, 0
  v_mov_b32 v39, 0
  v_mov_b32 v40, 0
  v_mov_b32 v41, 0
  v_mov_b32 v42, 0
  v_mov_b32 v43, 0
  v_mov_b32 v44, 0
  v_mov_b32 v45, 0
  v_mov_b32 v46, 0
  v_mov_b32 v47, 0
  v_mov_b32 v48, 0
  v_mov_b32 v49, 0
  v_mov_b32 v50, 0
  v_mov_b32 v51, 0
  v_mov_b32 v52, 0
  v_mov_b32 v53, 0
  v_mov_b32 v54, 0
  v_mov_b32 v55, 0
  v_mov_b32 v56, 0
  v_mov_b32 v57, 0
  v_mov_b32 v58, 0
  v_mov_b32 v59, 0
  v_mov_b32 v60, 0
  v_mov_b32 v61, 0
  v_mov_b32 v62, 0
  v_mov_b32 v63, 0
  v_mov_b32 v64, 0
  v_mov_b32 v65, 0
  v_mov_b32 v66, 0
  v_mov_b32 v67, 0
  v_mov_b32 v68, 0
  v_mov_b32 v69, 0
  v_mov_b32 v70, 0
  v_mov_b32 v71, 0
  v_mov_b32 v72, 0
  v_mov_b32 v73, 0
  v_mov_b32 v74, 0
  v_mov_b32 v75, 0
  v_mov_b32 v76, 0
  v_mov_b32 v77, 0
  v_mov_b32 v78, 0
  v_mov_b32 v79, 0
  buffer_load_dwordx4 v[80:83], v117, s[8:11], s24 offen offset:0 sc1
  buffer_load_dwordx4 v[84:87], v117, s[8:11], s24 offen offset:1024 sc1
  s_mov_b32 s30, 0
  v_mov_b32 v8, 0
ch_md2:
  buffer_load_dword v9, v8, s[12:15], 0 offen sc1
  s_waitcnt vmcnt(0) lgkmcnt(0)
  v_readfirstlane_b32 s22, v9
  s_and_b32 s31, s22, 0xffff
  s_cmp_ge_u32 s31, 32
  s_cbranch_scc1 ch_go2
  s_sleep 2
  s_add_u32 s30, s30, 1
  s_cmp_lt_u32 s30, 3200000
  s_cbranch_scc1 ch_md2
  s_branch ch_end
ch_go2:
  s_mov_b32 s31, 0
  s_lshr_b32 s22, s22, 16
  s_cmp_lg_u32 s22, 0
  s_cbranch_scc1 cB_sc2_loop
  s_branch cA_sc2_loop
ch_init3:
  s_mul_i32 s31, s17, 401408
  s_add_u32 s31, s31, 0
  s_mov_b32 s30, 0
ch_wr3:
  buffer_load_dword v65, off, s[12:15], 0 offset:132 sc1
  s_waitcnt vmcnt(0)
  v_cmp_ne_u32 vcc, 1, v65
  s_cbranch_vccz ch_wr3_ok
  s_sleep 8
  s_add_u32 s30, s30, 1
  s_cmp_lt_u32 s30, 400000
  s_cbranch_scc1 ch_wr3
  s_branch cA_abort
ch_wr3_ok:
  s_lshl_b32 s27, s17, 7
  s_add_u32 s27, s27, 88521216
  s_mov_b32 s28, 1032
  s_mov_b32 s30, 0
ch_wa3:
  buffer_load_dword v65, off, s[8:11], s27  sc1
  s_waitcnt vmcnt(0)
  v_and_b32 v66, s28, v65
  v_cmp_ne_u32 vcc, s28, v66
  s_cbranch_vccz ch_wa3_ok
  s_sleep 3
  s_add_u32 s30, s30, 1
  s_cmp_lt_u32 s30, 400000
  s_cbranch_scc1 ch_wa3
  s_branch cA_abort
ch_wa3_ok:
  v_readfirstlane_b32 s29, v65
  s_add_u32 s22, s31, 172032
  buffer_load_dwordx4 a[0:3], v2, s[8:11], s22 offen offset:0 sc1
  buffer_load_dwordx4 a[4:7], v2, s[8:11], s22 offen offset:1024 sc1
  buffer_load_dwordx4 a[8:11], v2, s[8:11], s22 offen offset:2048 sc1
  buffer_load_dwordx4 a[12:15], v2, s[8:11], s22 offen offset:3072 sc1
  s_add_u32 s22, s31, 176128
  buffer_load_dwordx4 a[16:19], v2, s[8:11], s22 offen offset:0 sc1
  buffer_load_dwordx4 a[20:23], v2, s[8:11], s22 offen offset:1024 sc1
  buffer_load_dwordx4 a[24:27], v2, s[8:11], s22 offen offset:2048 sc1
  buffer_load_dwordx4 a[28:31], v2, s[8:11], s22 offen offset:3072 sc1
  s_add_u32 s22, s31, 180224
  buffer_load_dwordx4 a[32:35], v2, s[8:11], s22 offen offset:0 sc1
  buffer_load_dwordx4 a[36:39], v2, s[8:11], s22 offen offset:1024 sc1
  buffer_load_dwordx4 a[40:43], v2, s[8:11], s22 offen offset:2048 sc1
  buffer_load_dwordx4 a[44:47], v2, s[8:11], s22 offen offset:3072 sc1
  s_add_u32 s22, s31, 184320
  buffer_load_dwordx4 a[48:51], v2, s[8:11], s22 offen offset:0 sc1
  buffer_load_dwordx4 a[52:55], v2, s[8:11], s22 offen offset:1024 sc1
  buffer_load_dwordx4 a[56:59], v2, s[8:11], s22 offen offset:2048 sc1
  buffer_load_dwordx4 a[60:63], v2, s[8:11], s22 offen offset:3072 sc1
  s_add_u32 s22, s31, 188416
  buffer_load_dwordx4 a[64:67], v2, s[8:11], s22 offen offset:0 sc1
  buffer_load_dwordx4 a[68:71], v2, s[8:11], s22 offen offset:1024 sc1
  buffer_load_dwordx4 a[72:75], v2, s[8:11], s22 offen offset:2048 sc1
  buffer_load_dwordx4 a[76:79], v2, s[8:11], s22 offen offset:3072 sc1
  s_add_u32 s22, s31, 192512
  buffer_load_dwordx4 a[80:83], v2, s[8:11], s22 offen offset:0 sc1
  buffer_load_dwordx4 a[84:87], v2, s[8:11], s22 offen offset:1024 sc1
  buffer_load_dwordx4 a[88:91], v2, s[8:11], s22 offen offset:2048 sc1
  buffer_load_dwordx4 a[92:95], v2, s[8:11], s22 offen offset:3072 sc1
  s_add_u32 s22, s31, 196608
  buffer_load_dwordx4 a[96:99], v2, s[8:11], s22 offen offset:0 sc1
  buffer_load_dwordx4 a[100:103], v2, s[8:11], s22 offen offset:1024 sc1
  buffer_load_dwordx4 a[104:107], v2, s[8:11], s22 offen offset:2048 sc1
  buffer_load_dwordx4 a[108:111], v2, s[8:11], s22 offen offset:3072 sc1
  s_add_u32 s22, s31, 200704
  buffer_load_dwordx4 a[112:115], v2, s[8:11], s22 offen offset:0 sc1
  buffer_load_dwordx4 a[116:119], v2, s[8:11], s22 offen offset:1024 sc1
  buffer_load_dwordx4 a[120:123], v2, s[8:11], s22 offen offset:2048 sc1
  buffer_load_dwordx4 a[124:127], v2, s[8:11], s22 offen offset:3072 sc1
  s_waitcnt vmcnt(24)
  s_add_u32 s22, s31, 204800
  buffer_load_dwordx4 a[128:131], v2, s[8:11], s22 offen offset:0 sc1
  buffer_load_dwordx4 a[132:135], v2, s[8:11], s22 offen offset:1024 sc1
  buffer_load_dwordx4 a[136:139], v2, s[8:11], s22 offen offset:2048 sc1
  buffer_load_dwordx4 a[140:143], v2, s[8:11], s22 offen offset:3072 sc1
  s_add_u32 s22, s31, 208896
  buffer_load_dwordx4 a[144:147], v2, s[8:11], s22 offen offset:0 sc1
  buffer_load_dwordx4 a[148:151], v2, s[8:11], s22 offen offset:1024 sc1
  buffer_load_dwordx4 a[152:155], v2, s[8:11], s22 offen offset:2048 sc1
  buffer_load_dwordx4 a[156:159], v2, s[8:11], s22 offen offset:3072 sc1
  s_add_u32 s22, s31, 212992
  buffer_load_dwordx4 a[160:163], v2, s[8:11], s22 offen offset:0 sc1
  buffer_load_dwordx4 a[164:167], v2, s[8:11], s22 offen offset:1024 sc1
  buffer_load_dwordx4 a[168:171], v2, s[8:11], s22 offen offset:2048 sc1
  buffer_load_dwordx4 a[172:175], v2, s[8:11], s22 offen offset:3072 sc1
  s_add_u32 s22, s31, 217088
  buffer_load_dwordx4 a[176:179], v2, s[8:11], s22 offen offset:0 sc1
  buffer_load_dwordx4 a[180:183], v2, s[8:11], s22 offen offset:1024 sc1
  buffer_load_dwordx4 a[184:187], v2, s[8:11], s22 offen offset:2048 sc1
  buffer_load_dwordx4 a[188:191], v2, s[8:11], s22 offen offset:3072 sc1
  s_add_u32 s22, s31, 221184
  buffer_load_dwordx4 a[192:195], v2, s[8:11], s22 offen offset:0 sc1
  buffer_load_dwordx4 a[196:199], v2, s[8:11], s22 offen offset:1024 sc1
  buffer_load_dwordx4 a[200:203], v2, s[8:11], s22 offen offset:2048 sc1
  buffer_load_dwordx4 a[204:207], v2, s[8:11], s22 offen offset:3072 sc1
  s_add_u32 s22, s31, 225280
  buffer_load_dwordx4 a[208:211], v2, s[8:11], s22 offen offset:0 sc1
  buffer_load_dwordx4 a[212:215], v2, s[8:11], s22 offen offset:1024 sc1
  buffer_load_dwordx4 a[216:219], v2, s[8:11], s22 offen offset:2048 sc1
  buffer_load_dwordx4 a[220:223], v2, s[8:11], s22 offen offset:3072 sc1
  s_and_b32 s29, s29, 12384
  s_cmp_eq_u32 s29, 12384
  s_cbranch_scc1 ch_wb3_ok
  s_lshl_b32 s27, s17, 7
  s_add_u32 s27, s27, 88521216
  s_mov_b32 s28, 12384
  s_mov_b32 s30, 0
ch_wb3:
  buffer_load_dword v65, off, s[8:11], s27  sc1
  s_waitcnt vmcnt(0)
  v_and_b32 v66, s28, v65
  v_cmp_ne_u32 vcc, s28, v66
  s_cbranch_vccz ch_wb3_ok
  s_sleep 3
  s_add_u32 s30, s30, 1
  s_cmp_lt_u32 s30, 400000
  s_cbranch_scc1 ch_wb3
  s_branch cA_abort
ch_wb3_ok:
  s_waitcnt vmcnt(28)
  s_add_u32 s22, s31, 315392
  buffer_load_dwordx4 a[224:227], v2, s[8:11], s22 offen offset:0 sc1
  buffer_load_dwordx4 a[228:231], v2, s[8:11], s22 offen offset:1024 sc1
  buffer_load_dwordx4 a[232:235], v2, s[8:11], s22 offen offset:2048 sc1
  buffer_load_dwordx4 a[236:239], v2, s[8:11], s22 offen offset:3072 sc1
  s_add_u32 s22, s31, 319488
  buffer_load_dwordx4 a[240:243], v2, s[8:11], s22 offen offset:0 sc1
  buffer_load_dwordx4 a[244:247], v2, s[8:11], s22 offen offset:1024 sc1
  buffer_load_dwordx4 a[248:251], v2, s[8:11], s22 offen offset:2048 sc1
  buffer_load_dwordx4 a[252:255], v2, s[8:11], s22 offen offset:3072 sc1
  s_add_u32 s22, s31, 323584
  buffer_load_dwordx4 v[120:123], v2, s[8:11], s22 offen offset:0 sc1
  buffer_load_dwordx4 v[124:127], v2, s[8:11], s22 offen offset:1024 sc1
  buffer_load_dwordx4 v[128:131], v2, s[8:11], s22 offen offset:2048 sc1
  buffer_load_dwordx4 v[132:135], v2, s[8:11], s22 offen offset:3072 sc1
  s_add_u32 s22, s31, 327680
  buffer_load_dwordx4 v[136:139], v2, s[8:11], s22 offen offset:0 sc1
  buffer_load_dwordx4 v[140:143], v2, s[8:11], s22 offen offset:1024 sc1
  buffer_load_dwordx4 v[144:147], v2, s[8:11], s22 offen offset:2048 sc1
  buffer_load_dwordx4 v[148:151], v2, s[8:11], s22 offen offset:3072 sc1
  s_add_u32 s22, s31, 331776
  buffer_load_dwordx4 v[152:155], v2, s[8:11], s22 offen offset:0 sc1
  buffer_load_dwordx4 v[156:159], v2, s[8:11], s22 offen offset:1024 sc1
  buffer_load_dwordx4 v[160:163], v2, s[8:11], s22 offen offset:2048 sc1
  buffer_load_dwordx4 v[164:167], v2, s[8:11], s22 offen offset:3072 sc1
  s_add_u32 s22, s31, 335872
  buffer_load_dwordx4 v[168:171], v2, s[8:11], s22 offen offset:0 sc1
  buffer_load_dwordx4 v[172:175], v2, s[8:11], s22 offen offset:1024 sc1
  buffer_load_dwordx4 v[176:179], v2, s[8:11], s22 offen offset:2048 sc1
  buffer_load_dwordx4 v[180:183], v2, s[8:11], s22 offen offset:3072 sc1
  s_add_u32 s22, s31, 339968
  buffer_load_dwordx4 v[184:187], v2, s[8:11], s22 offen offset:0 sc1
  buffer_load_dwordx4 v[188:191], v2, s[8:11], s22 offen offset:1024 sc1
  buffer_load_dwordx4 v[192:195], v2, s[8:11], s22 offen offset:2048 sc1
  buffer_load_dwordx4 v[196:199], v2, s[8:11], s22 offen offset:3072 sc1
  s_add_u32 s22, s31, 356352
  buffer_load_dwordx4 v[200:203], v2, s[8:11], s22 offen offset:2048 sc1
  buffer_load_dwordx4 v[204:207], v2, s[8:11], s22 offen offset:3072 sc1
  s_add_u32 s22, s31, 360448
  buffer_load_dwordx4 v[208:211], v2, s[8:11], s22 offen offset:0 sc1
  buffer_load_dwordx4 v[212:215], v2, s[8:11], s22 offen offset:1024 sc1
  s_waitcnt vmcnt(24)
  buffer_load_dwordx4 v[216:219], v2, s[8:11], s22 offen offset:2048 sc1
  buffer_load_dwordx4 v[220:223], v2, s[8:11], s22 offen offset:3072 sc1
  s_add_u32 s22, s31, 364544
  buffer_load_dwordx4 v[224:227], v2, s[8:11], s22 offen offset:0 sc1
  buffer_load_dwordx4 v[228:231], v2, s[8:11], s22 offen offset:1024 sc1
  buffer_load_dwordx4 v[232:235], v2, s[8:11], s22 offen offset:2048 sc1
  buffer_load_dwordx4 v[236:239], v2, s[8:11], s22 offen offset:3072 sc1
  s_add_u32 s22, s31, 368640
  buffer_load_dwordx4 v[240:243], v2, s[8:11], s22 offen offset:0 sc1
  buffer_load_dwordx4 v[244:247], v2, s[8:11], s22 offen offset:1024 sc1
  buffer_load_dwordx4 v[248:251], v2, s[8:11], s22 offen offset:2048 sc1
  buffer_load_dwordx4 v[252:255], v2, s[8:11], s22 offen offset:3072 sc1
  s_mov_b32 s22, 75694080
  v_add_u32 v64, 0, v1
  v_min_u32 v64, 323, v64
  v_lshlrev_b32 v64, 7, v64
  buffer_load_dword v65, v64, s[8:11], s22 offen sc1
  v_add_u32 v64, 64, v1
  v_min_u32 v64, 323, v64
  v_lshlrev_b32 v64, 7, v64
  buffer_load_dword v65, v64, s[8:11], s22 offen sc1
  v_add_u32 v64, 128, v1
  v_min_u32 v64, 323, v64
  v_lshlrev_b32 v64, 7, v64
  buffer_load_dword v65, v64, s[8:11], s22 offen sc1
  v_add_u32 v64, 192, v1
  v_min_u32 v64, 323, v64
  v_lshlrev_b32 v64, 7, v64
  buffer_load_dword v65, v64, s[8:11], s22 offen sc1
  v_add_u32 v64, 256, v1
  v_min_u32 v64, 323, v64
  v_lshlrev_b32 v64, 7, v64
  buffer_load_dword v65, v64, s[8:11], s22 offen sc1
  v_add_u32 v64, 320, v1
  v_min_u32 v64, 323, v64
  v_lshlrev_b32 v64, 7, v64
  buffer_load_dword v65, v64, s[8:11], s22 offen sc1
  s_mov_b32 s27, 88523264
  s_mov_b32 s28, 0xffff
  s_mov_b32 s30, 0
ch_wx3:
  buffer_load_dword v65, off, s[8:11], s27  sc1
  s_waitcnt vmcnt(0)
  v_and_b32 v66, s28, v65
  v_cmp_ne_u32 vcc, s28, v66
  s_cbranch_vccz ch_wx3_ok
  s_sleep 8
  s_add_u32 s30, s30, 1
  s_cmp_lt_u32 s30, 400000
  s_cbranch_scc1 ch_wx3
  s_branch cA_abort
ch_wx3_ok:
  s_mov_b32 s24, 72030208
  s_mov_b32 s26, 72044544
  v_and_b32 v64, 7, v117
  v_and_b32 v65, 1, v116
  v_lshlrev_b32 v65, 2, v65
  v_sub_u32 v64, v64, v65
  v_lshrrev_b32 v65, 3, v117
  v_lshl_add_u32 v66, v65, 2, v64
  v_cmp_gt_u32 vcc, 4, v64
  v_mov_b32 v67, 99
  s_nop 0
  v_cndmask_b32 v66, v67, v66, vcc
  v_mov_b32 v68, 0x3f80
  v_mov_b32 v69, 0x3f800000
  v_mov_b32 v4, 0
  v_cmp_eq_u32 vcc, 0, v66
  s_nop 1
  v_cndmask_b32 v4, v4, v68, vcc
  v_cmp_eq_u32 vcc, 1, v66
  s_nop 1
  v_cndmask_b32 v4, v4, v69, vcc
  v_mov_b32 v5, 0
  v_cmp_eq_u32 vcc, 2, v66
  s_nop 1
  v_cndmask_b32 v5, v5, v68, vcc
  v_cmp_eq_u32 vcc, 3, v66
  s_nop 1
  v_cndmask_b32 v5, v5, v69, vcc
  v_mov_b32 v6, 0
  v_cmp_eq_u32 vcc, 4, v66
  s_nop 1
  v_cndmask_b32 v6, v6, v68, vcc
  v_cmp_eq_u32 vcc, 5, v66
  s_nop 1
  v_cndmask_b32 v6, v6, v69, vcc
  v_mov_b32 v7, 0
  v_cmp_eq_u32 vcc, 6, v66
  s_nop 1
  v_cndmask_b32 v7, v7, v68, vcc
  v_cmp_eq_u32 vcc, 7, v66
  s_nop 1
  v_cndmask_b32 v7, v7, v69, vcc
  v_lshrrev_b32 v64, 1, v116
  v_lshrrev_b32 v65, 3, v117
  v_and_b32 v66, 1, v116
  v_and_b32 v68, 7, v117
  v_lshlrev_b32 v67, 8, v65
  v_lshl_add_u32 v67, v68, 5, v67
  v_lshl_add_u32 v67, v66, 4, v67
  v_add_u32 v69, 5696, v67
  v_add_u32 v70, 6400, v67
  v_cmp_eq_u32 vcc, v64, v65
  s_nop 1
  v_cndmask_b32 v113, v70, v69, vcc
  v_and_b32 v0, 15, v1
  s_and_b32 s22, s17, 0
  s_lshl_b32 s22, s22, 7
  s_add_u32 s22, s22, 75731456
  v_lshl_add_u32 v0, v0, 2, s22
  v_xor_b32 v69, 256, v2
  v_mul_i32_i24 v70, 2048, v66
  v_add_u32 v69, v69, v70
  v_add_u32 v117, 4096, v69
  v_mov_b32 v116, v73
  s_mul_i32 s35, s17, 28672
  s_add_u32 s35, s35, 44040192
  v_mov_b32 v36, 0
  v_mov_b32 v37, 0
  v_mov_b32 v38, 0
  v_mov_b32 v39, 0
  v_mov_b32 v40, 0
  v_mov_b32 v41, 0
  v_mov_b32 v42, 0
  v_mov_b32 v43, 0
  v_mov_b32 v44, 0
  v_mov_b32 v45, 0
  v_mov_b32 v46, 0
  v_mov_b32 v47, 0
  v_mov_b32 v48, 0
  v_mov_b32 v49, 0
  v_mov_b32 v50, 0
  v_mov_b32 v51, 0
  v_mov_b32 v52, 0
  v_mov_b32 v53, 0
  v_mov_b32 v54, 0
  v_mov_b32 v55, 0
  v_mov_b32 v56, 0
  v_mov_b32 v57, 0
  v_mov_b32 v58, 0
  v_mov_b32 v59, 0
  v_mov_b32 v60, 0
  v_mov_b32 v61, 0
  v_mov_b32 v62, 0
  v_mov_b32 v63, 0
  v_mov_b32 v64, 0
  v_mov_b32 v65, 0
  v_mov_b32 v66, 0
  v_mov_b32 v67, 0
  v_mov_b32 v68, 0
  v_mov_b32 v69, 0
  v_mov_b32 v70, 0
  v_mov_b32 v71, 0
  v_mov_b32 v72, 0
  v_mov_b32 v73, 0
  v_mov_b32 v74, 0
  v_mov_b32 v75, 0
  v_mov_b32 v76, 0
  v_mov_b32 v77, 0
  v_mov_b32 v78, 0
  v_mov_b32 v79, 0
  buffer_load_dwordx4 v[80:83], v117, s[8:11], s24 offen offset:0 sc1
  buffer_load_dwordx4 v[84:87], v117, s[8:11], s24 offen offset:1024 sc1
  s_mov_b32 s30, 0
  v_mov_b32 v8, 0
ch_md3:
  buffer_load_dword v9, v8, s[12:15], 0 offen sc1
  s_waitcnt vmcnt(0) lgkmcnt(0)
  v_readfirstlane_b32 s22, v9
  s_and_b32 s31, s22, 0xffff
  s_cmp_ge_u32 s31, 32
  s_cbranch_scc1 ch_go3
  s_sleep 2
  s_add_u32 s30, s30, 1
  s_cmp_lt_u32 s30, 3200000
  s_cbranch_scc1 ch_md3
  s_branch ch_end
ch_go3:
  s_mov_b32 s31, 0
  s_lshr_b32 s22, s22, 16
  s_cmp_lg_u32 s22, 0
  s_cbranch_scc1 cB_sc3_loop
  s_branch cA_sc3_loop
ch_init4:
  s_mul_i32 s31, s17, 401408
  s_add_u32 s31, s31, 6422528
  s_mov_b32 s30, 0
ch_wr4:
  buffer_load_dword v65, off, s[12:15], 0 offset:128 sc1
  s_waitcnt vmcnt(0)
  v_cmp_ne_u32 vcc, 1, v65
  s_cbranch_vccz ch_wr4_ok
  s_sleep 8
  s_add_u32 s30, s30, 1
  s_cmp_lt_u32 s30, 400000
  s_cbranch_scc1 ch_wr4
  s_branch cA_abort
ch_wr4_ok:
  s_lshr_b32 s22, s17, 2
  s_lshl_b32 s28, 0x81, s22
  s_mul_i32 s27, s17, 12
  s_add_u32 s22, s27, 256
  s_lshr_b32 s22, s22, 6
  s_lshl_b32 s22, 0x81, s22
  s_or_b32 s28, s28, s22
  s_add_u32 s22, s27, 267
  s_lshr_b32 s22, s22, 6
  s_lshl_b32 s22, 0x81, s22
  s_or_b32 s28, s28, s22
  v_lshlrev_b32 v64, 7, v116
  s_mov_b32 s27, 88519168
  s_mov_b32 s30, 0
ch_ww4:
  buffer_load_dword v65, v64, s[8:11], s27 offen sc1
  s_waitcnt vmcnt(0)
  v_and_b32 v66, s28, v65
  v_cmp_ne_u32 vcc, s28, v66
  s_cbranch_vccz ch_ww4_ok
  s_sleep 3
  s_add_u32 s30, s30, 1
  s_cmp_lt_u32 s30, 400000
  s_cbranch_scc1 ch_ww4
  s_branch cA_abort
ch_ww4_ok:
  s_add_u32 s22, s31, 0
  buffer_load_dwordx4 a[0:3], v2, s[8:11], s22 offen offset:0 sc1
  buffer_load_dwordx4 a[4:7], v2, s[8:11], s22 offen offset:1024 sc1
  buffer_load_dwordx4 a[8:11], v2, s[8:11], s22 offen offset:2048 sc1
  buffer_load_dwordx4 a[12:15], v2, s[8:11], s22 offen offset:3072 sc1
  s_add_u32 s22, s31, 4096
  buffer_load_dwordx4 a[16:19], v2, s[8:11], s22 offen offset:0 sc1
  buffer_load_dwordx4 a[20:23], v2, s[8:11], s22 offen offset:1024 sc1
  buffer_load_dwordx4 a[24:27], v2, s[8:11], s22 offen offset:2048 sc1
  buffer_load_dwordx4 a[28:31], v2, s[8:11], s22 offen offset:3072 sc1
  s_add_u32 s22, s31, 8192
  buffer_load_dwordx4 a[32:35], v2, s[8:11], s22 offen offset:0 sc1
  buffer_load_dwordx4 a[36:39], v2, s[8:11], s22 offen offset:1024 sc1
  buffer_load_dwordx4 a[40:43], v2, s[8:11], s22 offen offset:2048 sc1
  buffer_load_dwordx4 a[44:47], v2, s[8:11], s22 offen offset:3072 sc1
  s_add_u32 s22, s31, 12288
  buffer_load_dwordx4 a[48:51], v2, s[8:11], s22 offen offset:0 sc1
  buffer_load_dwordx4 a[52:55], v2, s[8:11], s22 offen offset:1024 sc1
  buffer_load_dwordx4 a[56:59], v2, s[8:11], s22 offen offset:2048 sc1
  buffer_load_dwordx4 a[60:63], v2, s[8:11], s22 offen offset:3072 sc1
  s_add_u32 s22, s31, 16384
  buffer_load_dwordx4 a[64:67], v2, s[8:11], s22 offen offset:0 sc1
  buffer_load_dwordx4 a[68:71], v2, s[8:11], s22 offen offset:1024 sc1
  buffer_load_dwordx4 a[72:75], v2, s[8:11], s22 offen offset:2048 sc1
  buffer_load_dwordx4 a[76:79], v2, s[8:11], s22 offen offset:3072 sc1
  s_add_u32 s22, s31, 20480
  buffer_load_dwordx4 a[80:83], v2, s[8:11], s22 offen offset:0 sc1
  buffer_load_dwordx4 a[84:87], v2, s[8:11], s22 offen offset:1024 sc1
  buffer_load_dwordx4 a[88:91], v2, s[8:11], s22 offen offset:2048 sc1
  buffer_load_dwordx4 a[92:95], v2, s[8:11], s22 offen offset:3072 sc1
  s_add_u32 s22, s31, 24576
  buffer_load_dwordx4 a[96:99], v2, s[8:11], s22 offen offset:0 sc1
  buffer_load_dwordx4 a[100:103], v2, s[8:11], s22 offen offset:1024 sc1
  buffer_load_dwordx4 a[104:107], v2, s[8:11], s22 offen offset:2048 sc1
  buffer_load_dwordx4 a[108:111], v2, s[8:11], s22 offen offset:3072 sc1
  s_add_u32 s22, s31, 28672
  buffer_load_dwordx4 a[112:115], v2, s[8:11], s22 offen offset:0 sc1
  buffer_load_dwordx4 a[116:119], v2, s[8:11], s22 offen offset:1024 sc1
  buffer_load_dwordx4 a[120:123], v2, s[8:11], s22 offen offset:2048 sc1
  buffer_load_dwordx4 a[124:127], v2, s[8:11], s22 offen offset:3072 sc1
  s_waitcnt vmcnt(24)
  s_add_u32 s22, s31, 32768
  buffer_load_dwordx4 a[128:131], v2, s[8:11], s22 offen offset:0 sc1
  buffer_load_dwordx4 a[132:135], v2, s[8:11], s22 offen offset:1024 sc1
  buffer_load_dwordx4 a[136:139], v2, s[8:11], s22 offen offset:2048 sc1
  buffer_load_dwordx4 a[140:143], v2, s[8:11], s22 offen offset:3072 sc1
  s_add_u32 s22, s31, 36864
  buffer_load_dwordx4 a[144:147], v2, s[8:11], s22 offen offset:0 sc1
  buffer_load_dwordx4 a[148:151], v2, s[8:11], s22 offen offset:1024 sc1
  buffer_load_dwordx4 a[152:155], v2, s[8:11], s22 offen offset:2048 sc1
  buffer_load_dwordx4 a[156:159], v2, s[8:11], s22 offen offset:3072 sc1
  s_add_u32 s22, s31, 40960
  buffer_load_dwordx4 a[160:163], v2, s[8:11], s22 offen offset:0 sc1
  buffer_load_dwordx4 a[164:167], v2, s[8:11], s22 offen offset:1024 sc1
  buffer_load_dwordx4 a[168:171], v2, s[8:11], s22 offen offset:2048 sc1
  buffer_load_dwordx4 a[172:175], v2, s[8:11], s22 offen offset:3072 sc1
  s_add_u32 s22, s31, 45056
  buffer_load_dwordx4 a[176:179], v2, s[8:11], s22 offen offset:0 sc1
  buffer_load_dwordx4 a[180:183], v2, s[8:11], s22 offen offset:1024 sc1
  buffer_load_dwordx4 a[184:187], v2, s[8:11], s22 offen offset:2048 sc1
  buffer_load_dwordx4 a[188:191], v2, s[8:11], s22 offen offset:3072 sc1
  s_add_u32 s22, s31, 49152
  buffer_load_dwordx4 a[192:195], v2, s[8:11], s22 offen offset:0 sc1
  buffer_load_dwordx4 a[196:199], v2, s[8:11], s22 offen offset:1024 sc1
  buffer_load_dwordx4 a[200:203], v2, s[8:11], s22 offen offset:2048 sc1
  buffer_load_dwordx4 a[204:207], v2, s[8:11], s22 offen offset:3072 sc1
  s_add_u32 s22, s31, 53248
  buffer_load_dwordx4 a[208:211], v2, s[8:11], s22 offen offset:0 sc1
  buffer_load_dwordx4 a[212:215], v2, s[8:11], s22 offen offset:1024 sc1
  buffer_load_dwordx4 a[216:219], v2, s[8:11], s22 offen offset:2048 sc1
  buffer_load_dwordx4 a[220:223], v2, s[8:11], s22 offen offset:3072 sc1
  s_add_u32 s22, s31, 57344
  buffer_load_dwordx4 a[224:227], v2, s[8:11], s22 offen offset:0 sc1
  buffer_load_dwordx4 a[228:231], v2, s[8:11], s22 offen offset:1024 sc1
  buffer_load_dwordx4 a[232:235], v2, s[8:11], s22 offen offset:2048 sc1
  buffer_load_dwordx4 a[236:239], v2, s[8:11], s22 offen offset:3072 sc1
  s_add_u32 s22, s31, 61440
  buffer_load_dwordx4 a[240:243], v2, s[8:11], s22 offen offset:0 sc1
  buffer_load_dwordx4 a[244:247], v2, s[8:11], s22 offen offset:1024 sc1
  buffer_load_dwordx4 a[248:251], v2, s[8:11], s22 offen offset:2048 sc1
  buffer_load_dwordx4 a[252:255], v2, s[8:11], s22 offen offset:3072 sc1
  s_waitcnt vmcnt(24)
  s_add_u32 s22, s31, 65536
  buffer_load_dwordx4 v[176:179], v2, s[8:11], s22 offen offset:0 sc1
  buffer_load_dwordx4 v[180:183], v2, s[8:11], s22 offen offset:1024 sc1
  buffer_load_dwordx4 v[184:187], v2, s[8:11], s22 offen offset:2048 sc1
  buffer_load_dwordx4 v[188:191], v2, s[8:11], s22 offen offset:3072 sc1
  s_add_u32 s22, s31, 69632
  buffer_load_dwordx4 v[192:195], v2, s[8:11], s22 offen offset:0 sc1
  buffer_load_dwordx4 v[196:199], v2, s[8:11], s22 offen offset:1024 sc1
  buffer_load_dwordx4 v[200:203], v2, s[8:11], s22 offen offset:2048 sc1
  buffer_load_dwordx4 v[204:207], v2, s[8:11], s22 offen offset:3072 sc1
  s_add_u32 s22, s31, 73728
  buffer_load_dwordx4 v[208:211], v2, s[8:11], s22 offen offset:0 sc1
  buffer_load_dwordx4 v[212:215], v2, s[8:11], s22 offen offset:1024 sc1
  buffer_load_dwordx4 v[216:219], v2, s[8:11], s22 offen offset:2048 sc1
  buffer_load_dwordx4 v[220:223], v2, s[8:11], s22 offen offset:3072 sc1
  s_add_u32 s22, s31, 77824
  buffer_load_dwordx4 v[224:227], v2, s[8:11], s22 offen offset:0 sc1
  buffer_load_dwordx4 v[228:231], v2, s[8:11], s22 offen offset:1024 sc1
  buffer_load_dwordx4 v[232:235], v2, s[8:11], s22 offen offset:2048 sc1
  buffer_load_dwordx4 v[236:239], v2, s[8:11], s22 offen offset:3072 sc1
  s_add_u32 s22, s31, 81920
  buffer_load_dwordx4 v[240:243], v2, s[8:11], s22 offen offset:0 sc1
  buffer_load_dwordx4 v[244:247], v2, s[8:11], s22 offen offset:1024 sc1
  buffer_load_dwordx4 v[248:251], v2, s[8:11], s22 offen offset:2048 sc1
  buffer_load_dwordx4 v[252:255], v2, s[8:11], s22 offen offset:3072 sc1
  s_mov_b32 m0, 16384
  s_add_u32 s22, s31, 86016
  buffer_load_dwordx4 v2, s[8:11], s22 offen offset:0 sc1 lds
  buffer_load_dwordx4 v2, s[8:11], s22 offen offset:1024 sc1 lds
  buffer_load_dwordx4 v2, s[8:11], s22 offen offset:2048 sc1 lds
  buffer_load_dwordx4 v2, s[8:11], s22 offen offset:3072 sc1 lds
  s_mov_b32 m0, 20480
  s_add_u32 s22, s31, 90112
  buffer_load_dwordx4 v2, s[8:11], s22 offen offset:0 sc1 lds
  buffer_load_dwordx4 v2, s[8:11], s22 offen offset:1024 sc1 lds
  buffer_load_dwordx4 v2, s[8:11], s22 offen offset:2048 sc1 lds
  buffer_load_dwordx4 v2, s[8:11], s22 offen offset:3072 sc1 lds
  s_mov_b32 m0, 24576
  s_add_u32 s22, s31, 94208
  buffer_load_dwordx4 v2, s[8:11], s22 offen offset:0 sc1 lds
  buffer_load_dwordx4 v2, s[8:11], s22 offen offset:1024 sc1 lds
  buffer_load_dwordx4 v2, s[8:11], s22 offen offset:2048 sc1 lds
  buffer_load_dwordx4 v2, s[8:11], s22 offen offset:3072 sc1 lds
  s_mov_b32 m0, 28672
  s_add_u32 s22, s31, 98304
  buffer_load_dwordx4 v2, s[8:11], s22 offen offset:0 sc1 lds
  buffer_load_dwordx4 v2, s[8:11], s22 offen offset:1024 sc1 lds
  v_mov_b32 v72, v116
  v_mov_b32 v73, v117
  v_lshrrev_b32 v65, 1, v72
  v_and_b32 v66, 1, v72
  v_mov_b32 v36, 0
  v_mov_b32 v37, 0
  v_mov_b32 v38, 0
  v_mov_b32 v39, 0
  v_mov_b32 v40, 0
  v_mov_b32 v41, 0
  v_mov_b32 v42, 0
  v_mov_b32 v43, 0
  v_mov_b32 v44, 0
  v_mov_b32 v45, 0
  v_mov_b32 v46, 0
  v_mov_b32 v47, 0
  v_mov_b32 v48, 0
  v_mov_b32 v49, 0
  v_mov_b32 v50, 0
  v_mov_b32 v51, 0
  v_mov_b32 v52, 0
  v_mov_b32 v53, 0
  v_mov_b32 v54, 0
  v_mov_b32 v55, 0
  v_mov_b32 v56, 0
  v_mov_b32 v57, 0
  v_mov_b32 v58, 0
  v_mov_b32 v59, 0
  v_mov_b32 v60, 0
  v_mov_b32 v61, 0
  v_mov_b32 v62, 0
  v_mov_b32 v63, 0
  v_lshlrev_b32 v75, 2, v65
  v_lshl_add_u32 v75, v66, 3, v75
  v_add_u32 v67, 0, v73
  v_mul_u32_u24 v68, 2341, v67
  v_lshrrev_b32 v68, 16, v68
  v_mul_u32_u24 v69, 28, v68
  v_sub_u32 v69, v67, v69
  v_lshrrev_b32 v70, 4, v69
  v_and_b32 v69, 15, v69
  v_lshlrev_b32 v71, 12, v70
  v_lshl_add_u32 v71, v68, 8, v71
  v_lshl_add_u32 v71, v69, 4, v71
  v_add_u32 v152, v71, v75
  v_add_u32 v67, 16, v73
  v_mul_u32_u24 v68, 2341, v67
  v_lshrrev_b32 v68, 16, v68
  v_mul_u32_u24 v69, 28, v68
  v_sub_u32 v69, v67, v69
  v_lshrrev_b32 v70, 4, v69
  v_and_b32 v69, 15, v69
  v_lshlrev_b32 v71, 12, v70
  v_lshl_add_u32 v71, v68, 8, v71
  v_lshl_add_u32 v71, v69, 4, v71
  v_add_u32 v153, v71, v75
  v_add_u32 v67, 32, v73
  v_mul_u32_u24 v68, 2341, v67
  v_lshrrev_b32 v68, 16, v68
  v_mul_u32_u24 v69, 28, v68
  v_sub_u32 v69, v67, v69
  v_lshrrev_b32 v70, 4, v69
  v_and_b32 v69, 15, v69
  v_lshlrev_b32 v71, 12, v70
  v_lshl_add_u32 v71, v68, 8, v71
  v_lshl_add_u32 v71, v69, 4, v71
  v_add_u32 v154, v71, v75
  v_add_u32 v67, 48, v73
  v_mul_u32_u24 v68, 2341, v67
  v_lshrrev_b32 v68, 16, v68
  v_mul_u32_u24 v69, 28, v68
  v_sub_u32 v69, v67, v69
  v_lshrrev_b32 v70, 4, v69
  v_and_b32 v69, 15, v69
  v_lshlrev_b32 v71, 12, v70
  v_lshl_add_u32 v71, v68, 8, v71
  v_lshl_add_u32 v71, v69, 4, v71
  v_add_u32 v155, v71, v75
  v_add_u32 v67, 64, v73
  v_mul_u32_u24 v68, 2341, v67
  v_lshrrev_b32 v68, 16, v68
  v_mul_u32_u24 v69, 28, v68
  v_sub_u32 v69, v67, v69
  v_lshrrev_b32 v70, 4, v69
  v_and_b32 v69, 15, v69
  v_lshlrev_b32 v71, 12, v70
  v_lshl_add_u32 v71, v68, 8, v71
  v_lshl_add_u32 v71, v69, 4, v71
  v_add_u32 v156, v71, v75
  v_add_u32 v67, 80, v73
  v_mul_u32_u24 v68, 2341, v67
  v_lshrrev_b32 v68, 16, v68
  v_mul_u32_u24 v69, 28, v68
  v_sub_u32 v69, v67, v69
  v_lshrrev_b32 v70, 4, v69
  v_and_b32 v69, 15, v69
  v_lshlrev_b32 v71, 12, v70
  v_lshl_add_u32 v71, v68, 8, v71
  v_lshl_add_u32 v71, v69, 4, v71
  v_add_u32 v157, v71, v75
  v_add_u32 v67, 96, v73
  v_mul_u32_u24 v68, 2341, v67
  v_lshrrev_b32 v68, 16, v68
  v_mul_u32_u24 v69, 28, v68
  v_sub_u32 v69, v67, v69
  v_lshrrev_b32 v70, 4, v69
  v_and_b32 v69, 15, v69
  v_lshlrev_b32 v71, 12, v70
  v_lshl_add_u32 v71, v68, 8, v71
  v_lshl_add_u32 v71, v69, 4, v71
  v_add_u32 v158, v71, v75
  v_mov_b32 v74, 0x40000000
  v_mov_b32 v76, 0
  v_mov_b32 v77, 0
  v_mov_b32 v78, 0
  v_mov_b32 v79, 0
  ds_write_b128 v2, v[76:79] offset:0
  ds_write_b128 v2, v[76:79] offset:1024
  ds_write_b128 v2, v[76:79] offset:2048
  ds_write_b128 v2, v[76:79] offset:3072
  s_and_b32 s22, s17, 0
  s_lshl_b32 s22, s22, 7
  s_add_u32 s22, s22, 75729408
  v_lshl_add_u32 v4, v73, 2, s22
  v_and_b32 v64, 1, v73
  v_mov_b32 v5, 0x05040100
  v_mov_b32 v65, 0x03020706
  v_cmp_eq_u32 vcc, 1, v64
  s_nop 1
  v_cndmask_b32 v5, v5, v65, vcc
  s_lshl_b32 s22, s17, 2
  s_add_u32 s22, s22, 75733504
  v_lshl_add_u32 v7, v1, 7, s22
  v_cmp_gt_u32 vcc, 1, v1
  s_nop 1
  v_cndmask_b32 v7, v74, v7, vcc
  v_mov_b32 v6, v2
  v_lshl_add_u32 v64, v66, 2, v64
  v_and_b32 v65, 2, v72
  v_add_u32 v64, v64, v65
  s_mul_i32 s22, s17, 16
  v_add_u32 v75, s22, v73
  v_lshrrev_b32 v68, 4, v75
  v_lshlrev_b32 v68, 8, v68
  v_bfe_u32 v69, v75, 1, 1
  v_lshl_add_u32 v68, v69, 7, v68
  v_lshl_add_u32 v68, v64, 4, v68
  v_and_b32 v69, 12, v75
  v_add_u32 v1, v68, v69
  s_mul_i32 s22, s17, 28672
  s_add_u32 s25, s22, 42205184
  s_and_b32 s27, s17, 0
  s_xor_b32 s22, s27, 0
  s_mul_i32 s80, s22, 7168
  s_lshl_b32 s22, s22, 11
  s_add_u32 s76, s22, 9216
  s_xor_b32 s22, s27, 1
  s_mul_i32 s81, s22, 7168
  s_lshl_b32 s22, s22, 11
  s_add_u32 s77, s22, 9216
  s_xor_b32 s22, s27, 2
  s_mul_i32 s82, s22, 7168
  s_lshl_b32 s22, s22, 11
  s_add_u32 s78, s22, 9216
  s_xor_b32 s22, s27, 3
  s_mul_i32 s83, s22, 7168
  s_lshl_b32 s22, s22, 11
  s_add_u32 s79, s22, 9216
  v_mov_b32 v162, -1
  s_mov_b32 s38, 0x40000000
  v_add_u32 v0, 16384, v2
  s_mov_b32 s30, 0
  v_mov_b32 v8, 0
ch_md4:
  buffer_load_dword v9, v8, s[12:15], 0 offen sc1
  s_waitcnt vmcnt(0) lgkmcnt(0)
  v_readfirstlane_b32 s22, v9
  s_and_b32 s31, s22, 0xffff
  s_cmp_ge_u32 s31, 32
  s_cbranch_scc1 ch_go4
  s_sleep 2
  s_add_u32 s30, s30, 1
  s_cmp_lt_u32 s30, 3200000
  s_cbranch_scc1 ch_md4
  s_branch ch_end
ch_go4:
  s_mov_b32 s31, 0
  s_lshr_b32 s22, s22, 16
  s_cmp_lg_u32 s22, 0
  s_cbranch_scc1 cB_va0_loop
  s_branch cA_va0_loop
ch_init5:
  s_mul_i32 s31, s17, 401408
  s_add_u32 s31, s31, 6522880
  s_mov_b32 s30, 0
ch_wr5:
  buffer_load_dword v65, off, s[12:15], 0 offset:128 sc1
  s_waitcnt vmcnt(0)
  v_cmp_ne_u32 vcc, 1, v65
  s_cbranch_vccz ch_wr5_ok
  s_sleep 8
  s_add_u32 s30, s30, 1
  s_cmp_lt_u32 s30, 400000
  s_cbranch_scc1 ch_wr5
  s_branch cA_abort
ch_wr5_ok:
  s_lshr_b32 s22, s17, 2
  s_lshl_b32 s28, 0x81, s22
  s_mul_i32 s27, s17, 12
  s_add_u32 s22, s27, 256
  s_lshr_b32 s22, s22, 6
  s_lshl_b32 s22, 0x81, s22
  s_or_b32 s28, s28, s22
  s_add_u32 s22, s27, 267
  s_lshr_b32 s22, s22, 6
  s_lshl_b32 s22, 0x81, s22
  s_or_b32 s28, s28, s22
  v_lshlrev_b32 v64, 7, v116
  s_mov_b32 s27, 88519680
  s_mov_b32 s30, 0
ch_ww5:
  buffer_load_dword v65, v64, s[8:11], s27 offen sc1
  s_waitcnt vmcnt(0)
  v_and_b32 v66, s28, v65
  v_cmp_ne_u32 vcc, s28, v66
  s_cbranch_vccz ch_ww5_ok
  s_sleep 3
  s_add_u32 s30, s30, 1
  s_cmp_lt_u32 s30, 400000
  s_cbranch_scc1 ch_ww5
  s_branch cA_abort
ch_ww5_ok:
  s_add_u32 s22, s31, 0
  buffer_load_dwordx4 a[0:3], v2, s[8:11], s22 offen offset:0 sc1
  buffer_load_dwordx4 a[4:7], v2, s[8:11], s22 offen offset:1024 sc1
  buffer_load_dwordx4 a[8:11], v2, s[8:11], s22 offen offset:2048 sc1
  buffer_load_dwordx4 a[12:15], v2, s[8:11], s22 offen offset:3072 sc1
  s_add_u32 s22, s31, 4096
  buffer_load_dwordx4 a[16:19], v2, s[8:11], s22 offen offset:0 sc1
  buffer_load_dwordx4 a[20:23], v2, s[8:11], s22 offen offset:1024 sc1
  buffer_load_dwordx4 a[24:27], v2, s[8:11], s22 offen offset:2048 sc1
  buffer_load_dwordx4 a[28:31], v2, s[8:11], s22 offen offset:3072 sc1
  s_add_u32 s22, s31, 8192
  buffer_load_dwordx4 a[32:35], v2, s[8:11], s22 offen offset:0 sc1
  buffer_load_dwordx4 a[36:39], v2, s[8:11], s22 offen offset:1024 sc1
  buffer_load_dwordx4 a[40:43], v2, s[8:11], s22 offen offset:2048 sc1
  buffer_load_dwordx4 a[44:47], v2, s[8:11], s22 offen offset:3072 sc1
  s_add_u32 s22, s31, 12288
  buffer_load_dwordx4 a[48:51], v2, s[8:11], s22 offen offset:0 sc1
  buffer_load_dwordx4 a[52:55], v2, s[8:11], s22 offen offset:1024 sc1
  buffer_load_dwordx4 a[56:59], v2, s[8:11], s22 offen offset:2048 sc1
  buffer_load_dwordx4 a[60:63], v2, s[8:11], s22 offen offset:3072 sc1
  s_add_u32 s22, s31, 16384
  buffer_load_dwordx4 a[64:67], v2, s[8:11], s22 offen offset:0 sc1
  buffer_load_dwordx4 a[68:71], v2, s[8:11], s22 offen offset:1024 sc1
  buffer_load_dwordx4 a[72:75], v2, s[8:11], s22 offen offset:2048 sc1
  buffer_load_dwordx4 a[76:79], v2, s[8:11], s22 offen offset:3072 sc1
  s_add_u32 s22, s31, 20480
  buffer_load_dwordx4 a[80:83], v2, s[8:11], s22 offen offset:0 sc1
  buffer_load_dwordx4 a[84:87], v2, s[8:11], s22 offen offset:1024 sc1
  buffer_load_dwordx4 a[88:91], v2, s[8:11], s22 offen offset:2048 sc1
  buffer_load_dwordx4 a[92:95], v2, s[8:11], s22 offen offset:3072 sc1
  s_add_u32 s22, s31, 24576
  buffer_load_dwordx4 a[96:99], v2, s[8:11], s22 offen offset:0 sc1
  buffer_load_dwordx4 a[100:103], v2, s[8:11], s22 offen offset:1024 sc1
  buffer_load_dwordx4 a[104:107], v2, s[8:11], s22 offen offset:2048 sc1
  buffer_load_dwordx4 a[108:111], v2, s[8:11], s22 offen offset:3072 sc1
  s_add_u32 s22, s31, 28672
  buffer_load_dwordx4 a[112:115], v2, s[8:11], s22 offen offset:0 sc1
  buffer_load_dwordx4 a[116:119], v2, s[8:11], s22 offen offset:1024 sc1
  buffer_load_dwordx4 a[120:123], v2, s[8:11], s22 offen offset:2048 sc1
  buffer_load_dwordx4 a[124:127], v2, s[8:11], s22 offen offset:3072 sc1
  s_waitcnt vmcnt(24)
  s_add_u32 s22, s31, 32768
  buffer_load_dwordx4 a[128:131], v2, s[8:11], s22 offen offset:0 sc1
  buffer_load_dwordx4 a[132:135], v2, s[8:11], s22 offen offset:1024 sc1
  buffer_load_dwordx4 a[136:139], v2, s[8:11], s22 offen offset:2048 sc1
  buffer_load_dwordx4 a[140:143], v2, s[8:11], s22 offen offset:3072 sc1
  s_add_u32 s22, s31, 36864
  buffer_load_dwordx4 a[144:147], v2, s[8:11], s22 offen offset:0 sc1
  buffer_load_dwordx4 a[148:151], v2, s[8:11], s22 offen offset:1024 sc1
  buffer_load_dwordx4 a[152:155], v2, s[8:11], s22 offen offset:2048 sc1
  buffer_load_dwordx4 a[156:159], v2, s[8:11], s22 offen offset:3072 sc1
  s_add_u32 s22, s31, 40960
  buffer_load_dwordx4 a[160:163], v2, s[8:11], s22 offen offset:0 sc1
  buffer_load_dwordx4 a[164:167], v2, s[8:11], s22 offen offset:1024 sc1
  buffer_load_dwordx4 a[168:171], v2, s[8:11], s22 offen offset:2048 sc1
  buffer_load_dwordx4 a[172:175], v2, s[8:11], s22 offen offset:3072 sc1
  s_add_u32 s22, s31, 45056
  buffer_load_dwordx4 a[176:179], v2, s[8:11], s22 offen offset:0 sc1
  buffer_load_dwordx4 a[180:183], v2, s[8:11], s22 offen offset:1024 sc1
  buffer_load_dwordx4 a[184:187], v2, s[8:11], s22 offen offset:2048 sc1
  buffer_load_dwordx4 a[188:191], v2, s[8:11], s22 offen offset:3072 sc1
  s_add_u32 s22, s31, 49152
  buffer_load_dwordx4 a[192:195], v2, s[8:11], s22 offen offset:0 sc1
  buffer_load_dwordx4 a[196:199], v2, s[8:11], s22 offen offset:1024 sc1
  buffer_load_dwordx4 a[200:203], v2, s[8:11], s22 offen offset:2048 sc1
  buffer_load_dwordx4 a[204:207], v2, s[8:11], s22 offen offset:3072 sc1
  s_add_u32 s22, s31, 53248
  buffer_load_dwordx4 a[208:211], v2, s[8:11], s22 offen offset:0 sc1
  buffer_load_dwordx4 a[212:215], v2, s[8:11], s22 offen offset:1024 sc1
  buffer_load_dwordx4 a[216:219], v2, s[8:11], s22 offen offset:2048 sc1
  buffer_load_dwordx4 a[220:223], v2, s[8:11], s22 offen offset:3072 sc1
  s_add_u32 s22, s31, 57344
  buffer_load_dwordx4 a[224:227], v2, s[8:11], s22 offen offset:0 sc1
  buffer_load_dwordx4 a[228:231], v2, s[8:11], s22 offen offset:1024 sc1
  buffer_load_dwordx4 a[232:235], v2, s[8:11], s22 offen offset:2048 sc1
  buffer_load_dwordx4 a[236:239], v2, s[8:11], s22 offen offset:3072 sc1
  s_add_u32 s22, s31, 61440
  buffer_load_dwordx4 a[240:243], v2, s[8:11], s22 offen offset:0 sc1
  buffer_load_dwordx4 a[244:247], v2, s[8:11], s22 offen offset:1024 sc1
  buffer_load_dwordx4 a[248:251], v2, s[8:11], s22 offen offset:2048 sc1
  buffer_load_dwordx4 a[252:255], v2, s[8:11], s22 offen offset:3072 sc1
  s_waitcnt vmcnt(24)
  s_add_u32 s22, s31, 65536
  buffer_load_dwordx4 v[176:179], v2, s[8:11], s22 offen offset:0 sc1
  buffer_load_dwordx4 v[180:183], v2, s[8:11], s22 offen offset:1024 sc1
  buffer_load_dwordx4 v[184:187], v2, s[8:11], s22 offen offset:2048 sc1
  buffer_load_dwordx4 v[188:191], v2, s[8:11], s22 offen offset:3072 sc1
  s_add_u32 s22, s31, 69632
  buffer_load_dwordx4 v[192:195], v2, s[8:11], s22 offen offset:0 sc1
  buffer_load_dwordx4 v[196:199], v2, s[8:11], s22 offen offset:1024 sc1
  buffer_load_dwordx4 v[200:203], v2, s[8:11], s22 offen offset:2048 sc1
  buffer_load_dwordx4 v[204:207], v2, s[8:11], s22 offen offset:3072 sc1
  s_add_u32 s22, s31, 73728
  buffer_load_dwordx4 v[208:211], v2, s[8:11], s22 offen offset:0 sc1
  buffer_load_dwordx4 v[212:215], v2, s[8:11], s22 offen offset:1024 sc1
  buffer_load_dwordx4 v[216:219], v2, s[8:11], s22 offen offset:2048 sc1
  buffer_load_dwordx4 v[220:223], v2, s[8:11], s22 offen offset:3072 sc1
  s_add_u32 s22, s31, 77824
  buffer_load_dwordx4 v[224:227], v2, s[8:11], s22 offen offset:0 sc1
  buffer_load_dwordx4 v[228:231], v2, s[8:11], s22 offen offset:1024 sc1
  buffer_load_dwordx4 v[232:235], v2, s[8:11], s22 offen offset:2048 sc1
  buffer_load_dwordx4 v[236:239], v2, s[8:11], s22 offen offset:3072 sc1
  s_add_u32 s22, s31, 81920
  buffer_load_dwordx4 v[240:243], v2, s[8:11], s22 offen offset:0 sc1
  buffer_load_dwordx4 v[244:247], v2, s[8:11], s22 offen offset:1024 sc1
  buffer_load_dwordx4 v[248:251], v2, s[8:11], s22 offen offset:2048 sc1
  buffer_load_dwordx4 v[252:255], v2, s[8:11], s22 offen offset:3072 sc1
  s_mov_b32 m0, 30720
  s_add_u32 s22, s31, 86016
  buffer_load_dwordx4 v2, s[8:11], s22 offen offset:0 sc1 lds
  buffer_load_dwordx4 v2, s[8:11], s22 offen offset:1024 sc1 lds
  buffer_load_dwordx4 v2, s[8:11], s22 offen offset:2048 sc1 lds
  buffer_load_dwordx4 v2, s[8:11], s22 offen offset:3072 sc1 lds
  s_mov_b32 m0, 34816
  s_add_u32 s22, s31, 90112
  buffer_load_dwordx4 v2, s[8:11], s22 offen offset:0 sc1 lds
  buffer_load_dwordx4 v2, s[8:11], s22 offen offset:1024 sc1 lds
  buffer_load_dwordx4 v2, s[8:11], s22 offen offset:2048 sc1 lds
  buffer_load_dwordx4 v2, s[8:11], s22 offen offset:3072 sc1 lds
  s_mov_b32 m0, 38912
  s_add_u32 s22, s31, 94208
  buffer_load_dwordx4 v2, s[8:11], s22 offen offset:0 sc1 lds
  buffer_load_dwordx4 v2, s[8:11], s22 offen offset:1024 sc1 lds
  buffer_load_dwordx4 v2, s[8:11], s22 offen offset:2048 sc1 lds
  buffer_load_dwordx4 v2, s[8:11], s22 offen offset:3072 sc1 lds
  s_mov_b32 m0, 43008
  s_add_u32 s22, s31, 98304
  buffer_load_dwordx4 v2, s[8:11], s22 offen offset:0 sc1 lds
  buffer_load_dwordx4 v2, s[8:11], s22 offen offset:1024 sc1 lds
  v_mov_b32 v72, v116
  v_mov_b32 v73, v117
  v_lshrrev_b32 v65, 1, v72
  v_and_b32 v66, 1, v72
  v_mov_b32 v36, 0
  v_mov_b32 v37, 0
  v_mov_b32 v38, 0
  v_mov_b32 v39, 0
  v_mov_b32 v40, 0
  v_mov_b32 v41, 0
  v_mov_b32 v42, 0
  v_mov_b32 v43, 0
  v_mov_b32 v44, 0
  v_mov_b32 v45, 0
  v_mov_b32 v46, 0
  v_mov_b32 v47, 0
  v_mov_b32 v48, 0
  v_mov_b32 v49, 0
  v_mov_b32 v50, 0
  v_mov_b32 v51, 0
  v_mov_b32 v52, 0
  v_mov_b32 v53, 0
  v_mov_b32 v54, 0
  v_mov_b32 v55, 0
  v_mov_b32 v56, 0
  v_mov_b32 v57, 0
  v_mov_b32 v58, 0
  v_mov_b32 v59, 0
  v_mov_b32 v60, 0
  v_mov_b32 v61, 0
  v_mov_b32 v62, 0
  v_mov_b32 v63, 0
  v_lshlrev_b32 v75, 2, v65
  v_lshl_add_u32 v75, v66, 3, v75
  v_add_u32 v67, 112, v73
  v_mul_u32_u24 v68, 2341, v67
  v_lshrrev_b32 v68, 16, v68
  v_mul_u32_u24 v69, 28, v68
  v_sub_u32 v69, v67, v69
  v_lshrrev_b32 v70, 4, v69
  v_and_b32 v69, 15, v69
  v_lshlrev_b32 v71, 12, v70
  v_lshl_add_u32 v71, v68, 8, v71
  v_lshl_add_u32 v71, v69, 4, v71
  v_add_u32 v152, v71, v75
  v_add_u32 v67, 128, v73
  v_mul_u32_u24 v68, 2341, v67
  v_lshrrev_b32 v68, 16, v68
  v_mul_u32_u24 v69, 28, v68
  v_sub_u32 v69, v67, v69
  v_lshrrev_b32 v70, 4, v69
  v_and_b32 v69, 15, v69
  v_lshlrev_b32 v71, 12, v70
  v_lshl_add_u32 v71, v68, 8, v71
  v_lshl_add_u32 v71, v69, 4, v71
  v_add_u32 v153, v71, v75
  v_add_u32 v67, 144, v73
  v_mul_u32_u24 v68, 2341, v67
  v_lshrrev_b32 v68, 16, v68
  v_mul_u32_u24 v69, 28, v68
  v_sub_u32 v69, v67, v69
  v_lshrrev_b32 v70, 4, v69
  v_and_b32 v69, 15, v69
  v_lshlrev_b32 v71, 12, v70
  v_lshl_add_u32 v71, v68, 8, v71
  v_lshl_add_u32 v71, v69, 4, v71
  v_add_u32 v154, v71, v75
  v_add_u32 v67, 160, v73
  v_mul_u32_u24 v68, 2341, v67
  v_lshrrev_b32 v68, 16, v68
  v_mul_u32_u24 v69, 28, v68
  v_sub_u32 v69, v67, v69
  v_lshrrev_b32 v70, 4, v69
  v_and_b32 v69, 15, v69
  v_lshlrev_b32 v71, 12, v70
  v_lshl_add_u32 v71, v68, 8, v71
  v_lshl_add_u32 v71, v69, 4, v71
  v_add_u32 v155, v71, v75
  v_add_u32 v67, 176, v73
  v_mul_u32_u24 v68, 2341, v67
  v_lshrrev_b32 v68, 16, v68
  v_mul_u32_u24 v69, 28, v68
  v_sub_u32 v69, v67, v69
  v_lshrrev_b32 v70, 4, v69
  v_and_b32 v69, 15, v69
  v_lshlrev_b32 v71, 12, v70
  v_lshl_add_u32 v71, v68, 8, v71
  v_lshl_add_u32 v71, v69, 4, v71
  v_add_u32 v156, v71, v75
  v_add_u32 v67, 192, v73
  v_mul_u32_u24 v68, 2341, v67
  v_lshrrev_b32 v68, 16, v68
  v_mul_u32_u24 v69, 28, v68
  v_sub_u32 v69, v67, v69
  v_lshrrev_b32 v70, 4, v69
  v_and_b32 v69, 15, v69
  v_lshlrev_b32 v71, 12, v70
  v_lshl_add_u32 v71, v68, 8, v71
  v_lshl_add_u32 v71, v69, 4, v71
  v_add_u32 v157, v71, v75
  v_add_u32 v67, 208, v73
  v_mul_u32_u24 v68, 2341, v67
  v_lshrrev_b32 v68, 16, v68
  v_mul_u32_u24 v69, 28, v68
  v_sub_u32 v69, v67, v69
  v_lshrrev_b32 v70, 4, v69
  v_and_b32 v69, 15, v69
  v_lshlrev_b32 v71, 12, v70
  v_lshl_add_u32 v71, v68, 8, v71
  v_lshl_add_u32 v71, v69, 4, v71
  v_add_u32 v158, v71, v75
  v_mov_b32 v74, 0x40000000
  v_mov_b32 v76, 0
  v_mov_b32 v77, 0
  v_mov_b32 v78, 0
  v_mov_b32 v79, 0
  ds_write_b128 v2, v[76:79] offset:4096
  ds_write_b128 v2, v[76:79] offset:5120
  ds_write_b128 v2, v[76:79] offset:6144
  ds_write_b128 v2, v[76:79] offset:7168
  s_and_b32 s22, s17, 0
  s_lshl_b32 s22, s22, 7
  s_add_u32 s22, s22, 75729408
  v_lshl_add_u32 v4, v73, 2, s22
  v_and_b32 v64, 1, v73
  v_mov_b32 v5, 0x05040100
  v_mov_b32 v65, 0x03020706
  v_cmp_eq_u32 vcc, 1, v64
  s_nop 1
  v_cndmask_b32 v5, v5, v65, vcc
  s_lshl_b32 s22, s17, 2
  s_add_u32 s22, s22, 75733504
  v_lshl_add_u32 v7, v1, 7, s22
  v_cmp_gt_u32 vcc, 1, v1
  s_nop 1
  v_cndmask_b32 v7, v74, v7, vcc
  v_min_u32 v65, 11, v73
  v_mad_u32_u24 v65, v72, 12, v65
  v_lshlrev_b32 v6, 4, v65
  v_add_u32 v6, 1024, v6
  v_lshl_add_u32 v64, v66, 2, v64
  v_and_b32 v65, 2, v72
  v_add_u32 v64, v64, v65
  s_mul_i32 s22, s17, 12
  s_add_u32 s22, s22, 256
  v_add_u32 v75, s22, v73
  v_lshrrev_b32 v68, 4, v75
  v_lshlrev_b32 v68, 8, v68
  v_bfe_u32 v69, v75, 1, 1
  v_lshl_add_u32 v68, v69, 7, v68
  v_lshl_add_u32 v68, v64, 4, v68
  v_and_b32 v69, 12, v75
  v_add_u32 v1, v68, v69
  v_cmp_gt_u32 vcc, 12, v73
  s_nop 1
  v_cndmask_b32 v1, v74, v1, vcc
  s_mul_i32 s22, s17, 28672
  s_add_u32 s25, s22, 42205184
  s_and_b32 s27, s17, 0
  s_xor_b32 s22, s27, 0
  s_mul_i32 s80, s22, 7168
  s_lshl_b32 s22, s22, 11
  s_add_u32 s76, s22, 9216
  s_xor_b32 s22, s27, 1
  s_mul_i32 s81, s22, 7168
  s_lshl_b32 s22, s22, 11
  s_add_u32 s77, s22, 9216
  s_xor_b32 s22, s27, 2
  s_mul_i32 s82, s22, 7168
  s_lshl_b32 s22, s22, 11
  s_add_u32 s78, s22, 9216
  s_xor_b32 s22, s27, 3
  s_mul_i32 s83, s22, 7168
  s_lshl_b32 s22, s22, 11
  s_add_u32 s79, s22, 9216
  v_mov_b32 v162, -1
  s_mov_b32 s38, 0x40000000
  v_add_u32 v0, 30720, v2
  s_mov_b32 s30, 0
  v_mov_b32 v8, 0
ch_md5:
  buffer_load_dword v9, v8, s[12:15], 0 offen sc1
  s_waitcnt vmcnt(0) lgkmcnt(0)
  v_readfirstlane_b32 s22, v9
  s_and_b32 s31, s22, 0xffff
  s_cmp_ge_u32 s31, 32
  s_cbranch_scc1 ch_go5
  s_sleep 2
  s_add_u32 s30, s30, 1
  s_cmp_lt_u32 s30, 3200000
  s_cbranch_scc1 ch_md5
  s_branch ch_end
ch_go5:
  s_mov_b32 s31, 0
  s_lshr_b32 s22, s22, 16
  s_cmp_lg_u32 s22, 0
  s_cbranch_scc1 cB_va1_loop
  s_branch cA_va1_loop
ch_init6:
  s_mul_i32 s31, s17, 401408
  s_add_u32 s31, s31, 6623232
  s_mov_b32 s30, 0
ch_wr6:
  buffer_load_dword v65, off, s[12:15], 0 offset:128 sc1
  s_waitcnt vmcnt(0)
  v_cmp_ne_u32 vcc, 1, v65
  s_cbranch_vccz ch_wr6_ok
  s_sleep 8
  s_add_u32 s30, s30, 1
  s_cmp_lt_u32 s30, 400000
  s_cbranch_scc1 ch_wr6
  s_branch cA_abort
ch_wr6_ok:
  s_lshr_b32 s22, s17, 2
  s_lshl_b32 s28, 0x81, s22
  s_mul_i32 s27, s17, 12
  s_add_u32 s22, s27, 256
  s_lshr_b32 s22, s22, 6
  s_lshl_b32 s22, 0x81, s22
  s_or_b32 s28, s28, s22
  s_add_u32 s22, s27, 267
  s_lshr_b32 s22, s22, 6
  s_lshl_b32 s22, 0x81, s22
  s_or_b32 s28, s28, s22
  v_lshlrev_b32 v64, 7, v116
  s_mov_b32 s27, 88520192
  s_mov_b32 s30, 0
ch_ww6:
  buffer_load_dword v65, v64, s[8:11], s27 offen sc1
  s_waitcnt vmcnt(0)
  v_and_b32 v66, s28, v65
  v_cmp_ne_u32 vcc, s28, v66
  s_cbranch_vccz ch_ww6_ok
  s_sleep 3
  s_add_u32 s30, s30, 1
  s_cmp_lt_u32 s30, 400000
  s_cbranch_scc1 ch_ww6
  s_branch cA_abort
ch_ww6_ok:
  s_add_u32 s22, s31, 0
  buffer_load_dwordx4 a[0:3], v2, s[8:11], s22 offen offset:0 sc1
  buffer_load_dwordx4 a[4:7], v2, s[8:11], s22 offen offset:1024 sc1
  buffer_load_dwordx4 a[8:11], v2, s[8:11], s22 offen offset:2048 sc1
  buffer_load_dwordx4 a[12:15], v2, s[8:11], s22 offen offset:3072 sc1
  s_add_u32 s22, s31, 4096
  buffer_load_dwordx4 a[16:19], v2, s[8:11], s22 offen offset:0 sc1
  buffer_load_dwordx4 a[20:23], v2, s[8:11], s22 offen offset:1024 sc1
  buffer_load_dwordx4 a[24:27], v2, s[8:11], s22 offen offset:2048 sc1
  buffer_load_dwordx4 a[28:31], v2, s[8:11], s22 offen offset:3072 sc1
  s_add_u32 s22, s31, 8192
  buffer_load_dwordx4 a[32:35], v2, s[8:11], s22 offen offset:0 sc1
  buffer_load_dwordx4 a[36:39], v2, s[8:11], s22 offen offset:1024 sc1
  buffer_load_dwordx4 a[40:43], v2, s[8:11], s22 offen offset:2048 sc1
  buffer_load_dwordx4 a[44:47], v2, s[8:11], s22 offen offset:3072 sc1
  s_add_u32 s22, s31, 12288
  buffer_load_dwordx4 a[48:51], v2, s[8:11], s22 offen offset:0 sc1
  buffer_load_dwordx4 a[52:55], v2, s[8:11], s22 offen offset:1024 sc1
  buffer_load_dwordx4 a[56:59], v2, s[8:11], s22 offen offset:2048 sc1
  buffer_load_dwordx4 a[60:63], v2, s[8:11], s22 offen offset:3072 sc1
  s_add_u32 s22, s31, 16384
  buffer_load_dwordx4 a[64:67], v2, s[8:11], s22 offen offset:0 sc1
  buffer_load_dwordx4 a[68:71], v2, s[8:11], s22 offen offset:1024 sc1
  buffer_load_dwordx4 a[72:75], v2, s[8:11], s22 offen offset:2048 sc1
  buffer_load_dwordx4 a[76:79], v2, s[8:11], s22 offen offset:3072 sc1
  s_add_u32 s22, s31, 20480
  buffer_load_dwordx4 a[80:83], v2, s[8:11], s22 offen offset:0 sc1
  buffer_load_dwordx4 a[84:87], v2, s[8:11], s22 offen offset:1024 sc1
  buffer_load_dwordx4 a[88:91], v2, s[8:11], s22 offen offset:2048 sc1
  buffer_load_dwordx4 a[92:95], v2, s[8:11], s22 offen offset:3072 sc1
  s_add_u32 s22, s31, 24576
  buffer_load_dwordx4 a[96:99], v2, s[8:11], s22 offen offset:0 sc1
  buffer_load_dwordx4 a[100:103], v2, s[8:11], s22 offen offset:1024 sc1
  buffer_load_dwordx4 a[104:107], v2, s[8:11], s22 offen offset:2048 sc1
  buffer_load_dwordx4 a[108:111], v2, s[8:11], s22 offen offset:3072 sc1
  s_add_u32 s22, s31, 28672
  buffer_load_dwordx4 a[112:115], v2, s[8:11], s22 offen offset:0 sc1
  buffer_load_dwordx4 a[116:119], v2, s[8:11], s22 offen offset:1024 sc1
  buffer_load_dwordx4 a[120:123], v2, s[8:11], s22 offen offset:2048 sc1
  buffer_load_dwordx4 a[124:127], v2, s[8:11], s22 offen offset:3072 sc1
  s_waitcnt vmcnt(24)
  s_add_u32 s22, s31, 32768
  buffer_load_dwordx4 a[128:131], v2, s[8:11], s22 offen offset:0 sc1
  buffer_load_dwordx4 a[132:135], v2, s[8:11], s22 offen offset:1024 sc1
  buffer_load_dwordx4 a[136:139], v2, s[8:11], s22 offen offset:2048 sc1
  buffer_load_dwordx4 a[140:143], v2, s[8:11], s22 offen offset:3072 sc1
  s_add_u32 s22, s31, 36864
  buffer_load_dwordx4 a[144:147], v2, s[8:11], s22 offen offset:0 sc1
  buffer_load_dwordx4 a[148:151], v2, s[8:11], s22 offen offset:1024 sc1
  buffer_load_dwordx4 a[152:155], v2, s[8:11], s22 offen offset:2048 sc1
  buffer_load_dwordx4 a[156:159], v2, s[8:11], s22 offen offset:3072 sc1
  s_add_u32 s22, s31, 40960
  buffer_load_dwordx4 a[160:163], v2, s[8:11], s22 offen offset:0 sc1
  buffer_load_dwordx4 a[164:167], v2, s[8:11], s22 offen offset:1024 sc1
  buffer_load_dwordx4 a[168:171], v2, s[8:11], s22 offen offset:2048 sc1
  buffer_load_dwordx4 a[172:175], v2, s[8:11], s22 offen offset:3072 sc1
  s_add_u32 s22, s31, 45056
  buffer_load_dwordx4 a[176:179], v2, s[8:11], s22 offen offset:0 sc1
  buffer_load_dwordx4 a[180:183], v2, s[8:11], s22 offen offset:1024 sc1
  buffer_load_dwordx4 a[184:187], v2, s[8:11], s22 offen offset:2048 sc1
  buffer_load_dwordx4 a[188:191], v2, s[8:11], s22 offen offset:3072 sc1
  s_add_u32 s22, s31, 49152
  buffer_load_dwordx4 a[192:195], v2, s[8:11], s22 offen offset:0 sc1
  buffer_load_dwordx4 a[196:199], v2, s[8:11], s22 offen offset:1024 sc1
  buffer_load_dwordx4 a[200:203], v2, s[8:11], s22 offen offset:2048 sc1
  buffer_load_dwordx4 a[204:207], v2, s[8:11], s22 offen offset:3072 sc1
  s_add_u32 s22, s31, 53248
  buffer_load_dwordx4 a[208:211], v2, s[8:11], s22 offen offset:0 sc1
  buffer_load_dwordx4 a[212:215], v2, s[8:11], s22 offen offset:1024 sc1
  buffer_load_dwordx4 a[216:219], v2, s[8:11], s22 offen offset:2048 sc1
  buffer_load_dwordx4 a[220:223], v2, s[8:11], s22 offen offset:3072 sc1
  s_add_u32 s22, s31, 57344
  buffer_load_dwordx4 a[224:227], v2, s[8:11], s22 offen offset:0 sc1
  buffer_load_dwordx4 a[228:231], v2, s[8:11], s22 offen offset:1024 sc1
  buffer_load_dwordx4 a[232:235], v2, s[8:11], s22 offen offset:2048 sc1
  buffer_load_dwordx4 a[236:239], v2, s[8:11], s22 offen offset:3072 sc1
  s_add_u32 s22, s31, 61440
  buffer_load_dwordx4 a[240:243], v2, s[8:11], s22 offen offset:0 sc1
  buffer_load_dwordx4 a[244:247], v2, s[8:11], s22 offen offset:1024 sc1
  buffer_load_dwordx4 a[248:251], v2, s[8:11], s22 offen offset:2048 sc1
  buffer_load_dwordx4 a[252:255], v2, s[8:11], s22 offen offset:3072 sc1
  s_waitcnt vmcnt(24)
  s_add_u32 s22, s31, 65536
  buffer_load_dwordx4 v[120:123], v2, s[8:11], s22 offen offset:0 sc1
  buffer_load_dwordx4 v[124:127], v2, s[8:11], s22 offen offset:1024 sc1
  buffer_load_dwordx4 v[128:131], v2, s[8:11], s22 offen offset:2048 sc1
  buffer_load_dwordx4 v[132:135], v2, s[8:11], s22 offen offset:3072 sc1
  s_add_u32 s22, s31, 69632
  buffer_load_dwordx4 v[136:139], v2, s[8:11], s22 offen offset:0 sc1
  buffer_load_dwordx4 v[140:143], v2, s[8:11], s22 offen offset:1024 sc1
  buffer_load_dwordx4 v[144:147], v2, s[8:11], s22 offen offset:2048 sc1
  buffer_load_dwordx4 v[148:151], v2, s[8:11], s22 offen offset:3072 sc1
  s_add_u32 s22, s31, 73728
  buffer_load_dwordx4 v[152:155], v2, s[8:11], s22 offen offset:0 sc1
  buffer_load_dwordx4 v[156:159], v2, s[8:11], s22 offen offset:1024 sc1
  buffer_load_dwordx4 v[160:163], v2, s[8:11], s22 offen offset:2048 sc1
  buffer_load_dwordx4 v[164:167], v2, s[8:11], s22 offen offset:3072 sc1
  s_add_u32 s22, s31, 77824
  buffer_load_dwordx4 v[168:171], v2, s[8:11], s22 offen offset:0 sc1
  buffer_load_dwordx4 v[172:175], v2, s[8:11], s22 offen offset:1024 sc1
  buffer_load_dwordx4 v[176:179], v2, s[8:11], s22 offen offset:2048 sc1
  buffer_load_dwordx4 v[180:183], v2, s[8:11], s22 offen offset:3072 sc1
  s_add_u32 s22, s31, 81920
  buffer_load_dwordx4 v[184:187], v2, s[8:11], s22 offen offset:0 sc1
  buffer_load_dwordx4 v[188:191], v2, s[8:11], s22 offen offset:1024 sc1
  buffer_load_dwordx4 v[192:195], v2, s[8:11], s22 offen offset:2048 sc1
  buffer_load_dwordx4 v[196:199], v2, s[8:11], s22 offen offset:3072 sc1
  s_add_u32 s22, s31, 86016
  buffer_load_dwordx4 v[200:203], v2, s[8:11], s22 offen offset:0 sc1
  buffer_load_dwordx4 v[204:207], v2, s[8:11], s22 offen offset:1024 sc1
  buffer_load_dwordx4 v[208:211], v2, s[8:11], s22 offen offset:2048 sc1
  buffer_load_dwordx4 v[212:215], v2, s[8:11], s22 offen offset:3072 sc1
  s_add_u32 s22, s31, 90112
  buffer_load_dwordx4 v[216:219], v2, s[8:11], s22 offen offset:0 sc1
  buffer_load_dwordx4 v[220:223], v2, s[8:11], s22 offen offset:1024 sc1
  buffer_load_dwordx4 v[224:227], v2, s[8:11], s22 offen offset:2048 sc1
  buffer_load_dwordx4 v[228:231], v2, s[8:11], s22 offen offset:3072 sc1
  s_add_u32 s22, s31, 94208
  buffer_load_dwordx4 v[232:235], v2, s[8:11], s22 offen offset:0 sc1
  buffer_load_dwordx4 v[236:239], v2, s[8:11], s22 offen offset:1024 sc1
  buffer_load_dwordx4 v[240:243], v2, s[8:11], s22 offen offset:2048 sc1
  buffer_load_dwordx4 v[244:247], v2, s[8:11], s22 offen offset:3072 sc1
  s_waitcnt vmcnt(24)
  s_add_u32 s22, s31, 98304
  buffer_load_dwordx4 v[248:251], v2, s[8:11], s22 offen offset:0 sc1
  buffer_load_dwordx4 v[252:255], v2, s[8:11], s22 offen offset:1024 sc1
  v_mov_b32 v72, v116
  v_mov_b32 v73, v117
  v_lshrrev_b32 v65, 1, v72
  v_and_b32 v66, 1, v72
  v_mov_b32 v36, 0
  v_mov_b32 v37, 0
  v_mov_b32 v38, 0
  v_mov_b32 v39, 0
  v_mov_b32 v40, 0
  v_mov_b32 v41, 0
  v_mov_b32 v42, 0
  v_mov_b32 v43, 0
  v_mov_b32 v44, 0
  v_mov_b32 v45, 0
  v_mov_b32 v46, 0
  v_mov_b32 v47, 0
  v_mov_b32 v48, 0
  v_mov_b32 v49, 0
  v_mov_b32 v50, 0
  v_mov_b32 v51, 0
  v_mov_b32 v52, 0
  v_mov_b32 v53, 0
  v_mov_b32 v54, 0
  v_mov_b32 v55, 0
  v_mov_b32 v56, 0
  v_mov_b32 v57, 0
  v_mov_b32 v58, 0
  v_mov_b32 v59, 0
  v_mov_b32 v60, 0
  v_mov_b32 v61, 0
  v_mov_b32 v62, 0
  v_mov_b32 v63, 0
  v_lshlrev_b32 v75, 2, v65
  v_lshl_add_u32 v75, v66, 3, v75
  v_add_u32 v67, 224, v73
  v_mul_u32_u24 v68, 2341, v67
  v_lshrrev_b32 v68, 16, v68
  v_mul_u32_u24 v69, 28, v68
  v_sub_u32 v69, v67, v69
  v_lshrrev_b32 v70, 4, v69
  v_and_b32 v69, 15, v69
  v_lshlrev_b32 v71, 12, v70
  v_lshl_add_u32 v71, v68, 8, v71
  v_lshl_add_u32 v71, v69, 4, v71
  v_add_u32 v104, v71, v75
  v_add_u32 v67, 240, v73
  v_mul_u32_u24 v68, 2341, v67
  v_lshrrev_b32 v68, 16, v68
  v_mul_u32_u24 v69, 28, v68
  v_sub_u32 v69, v67, v69
  v_lshrrev_b32 v70, 4, v69
  v_and_b32 v69, 15, v69
  v_lshlrev_b32 v71, 12, v70
  v_lshl_add_u32 v71, v68, 8, v71
  v_lshl_add_u32 v71, v69, 4, v71
  v_add_u32 v105, v71, v75
  v_add_u32 v67, 256, v73
  v_mul_u32_u24 v68, 2341, v67
  v_lshrrev_b32 v68, 16, v68
  v_mul_u32_u24 v69, 28, v68
  v_sub_u32 v69, v67, v69
  v_lshrrev_b32 v70, 4, v69
  v_and_b32 v69, 15, v69
  v_lshlrev_b32 v71, 12, v70
  v_lshl_add_u32 v71, v68, 8, v71
  v_lshl_add_u32 v71, v69, 4, v71
  v_add_u32 v106, v71, v75
  v_add_u32 v67, 272, v73
  v_mul_u32_u24 v68, 2341, v67
  v_lshrrev_b32 v68, 16, v68
  v_mul_u32_u24 v69, 28, v68
  v_sub_u32 v69, v67, v69
  v_lshrrev_b32 v70, 4, v69
  v_and_b32 v69, 15, v69
  v_lshlrev_b32 v71, 12, v70
  v_lshl_add_u32 v71, v68, 8, v71
  v_lshl_add_u32 v71, v69, 4, v71
  v_add_u32 v107, v71, v75
  v_add_u32 v67, 288, v73
  v_mul_u32_u24 v68, 2341, v67
  v_lshrrev_b32 v68, 16, v68
  v_mul_u32_u24 v69, 28, v68
  v_sub_u32 v69, v67, v69
  v_lshrrev_b32 v70, 4, v69
  v_and_b32 v69, 15, v69
  v_lshlrev_b32 v71, 12, v70
  v_lshl_add_u32 v71, v68, 8, v71
  v_lshl_add_u32 v71, v69, 4, v71
  v_add_u32 v108, v71, v75
  v_add_u32 v67, 304, v73
  v_mul_u32_u24 v68, 2341, v67
  v_lshrrev_b32 v68, 16, v68
  v_mul_u32_u24 v69, 28, v68
  v_sub_u32 v69, v67, v69
  v_lshrrev_b32 v70, 4, v69
  v_and_b32 v69, 15, v69
  v_lshlrev_b32 v71, 12, v70
  v_lshl_add_u32 v71, v68, 8, v71
  v_lshl_add_u32 v71, v69, 4, v71
  v_add_u32 v109, v71, v75
  v_add_u32 v67, 320, v73
  v_mul_u32_u24 v68, 2341, v67
  v_lshrrev_b32 v68, 16, v68
  v_mul_u32_u24 v69, 28, v68
  v_sub_u32 v69, v67, v69
  v_lshrrev_b32 v70, 4, v69
  v_and_b32 v69, 15, v69
  v_lshlrev_b32 v71, 12, v70
  v_lshl_add_u32 v71, v68, 8, v71
  v_lshl_add_u32 v71, v69, 4, v71
  v_add_u32 v110, v71, v75
  v_mov_b32 v74, 0x40000000
  v_and_b32 v119, 15, v1
  s_and_b32 s22, s17, 0
  s_lshl_b32 s22, s22, 7
  s_add_u32 s22, s22, 75733504
  v_lshl_add_u32 v119, v119, 2, s22
  s_lshl_b32 s22, s17, 2
  s_add_u32 s22, s22, 75731456
  v_lshl_add_u32 v118, v1, 7, s22
  v_cmp_gt_u32 vcc, 1, v1
  s_nop 1
  v_cndmask_b32 v118, v74, v118, vcc
  s_lshl_b32 s35, s17, 7
  s_add_u32 s35, s35, 88461312
  s_mov_b32 s28, s35
  v_min_u32 v116, 13, v1
  s_mul_i32 s22, s17, 14
  v_add_u32 v116, s22, v116
  v_lshlrev_b32 v116, 7, v116
  s_mov_b32 s39, 72052736
  s_mov_b32 s39, 72081408
  s_mov_b32 s30, 0
ch_vw6i:
  buffer_load_dword v9, off, s[12:15], 0 offset:132 sc1
  s_waitcnt vmcnt(0)
  v_cmp_ne_u32 vcc, 1, v9
  s_cbranch_vccz ch_vw6i_ok
  s_sleep 8
  s_add_u32 s30, s30, 1
  s_cmp_lt_u32 s30, 400000
  s_cbranch_scc1 ch_vw6i
  s_branch cA_abort
ch_vw6i_ok:
  s_lshl_b32 s27, s17, 7
  s_add_u32 s27, s27, 88461312
  s_mov_b32 s30, 0
ch_vw6:
  buffer_load_dword v9, off, s[8:11], s27 sc1
  s_waitcnt vmcnt(0)
  v_cmp_ne_u32 vcc, 56, v9
  s_cbranch_vccz ch_vw6_d
  s_sleep 2
  s_add_u32 s30, s30, 1
  s_cmp_lt_u32 s30, 400000
  s_cbranch_scc1 ch_vw6
  s_branch cA_abort
ch_vw6_d:
  s_mov_b32 s30, 0
  v_mov_b32 v8, 0
ch_md6:
  buffer_load_dword v9, v8, s[12:15], 0 offen sc1
  s_waitcnt vmcnt(0) lgkmcnt(0)
  v_readfirstlane_b32 s22, v9
  s_and_b32 s31, s22, 0xffff
  s_cmp_ge_u32 s31, 32
  s_cbranch_scc1 ch_go6
  s_sleep 2
  s_add_u32 s30, s30, 1
  s_cmp_lt_u32 s30, 3200000
  s_cbranch_scc1 ch_md6
  s_branch ch_end
ch_go6:
  s_mov_b32 s31, 0
  s_lshr_b32 s22, s22, 16
  s_cmp_lg_u32 s22, 0
  s_cbranch_scc1 cB_va2_loop
  s_branch cA_va2_loop
ch_init7:
  s_mul_i32 s31, s17, 401408
  s_add_u32 s31, s31, 6723584
  s_mov_b32 s30, 0
ch_wr7:
  buffer_load_dword v65, off, s[12:15], 0 offset:128 sc1
  s_waitcnt vmcnt(0)
  v_cmp_ne_u32 vcc, 1, v65
  s_cbranch_vccz ch_wr7_ok
  s_sleep 8
  s_add_u32 s30, s30, 1
  s_cmp_lt_u32 s30, 400000
  s_cbranch_scc1 ch_wr7
  s_branch cA_abort
ch_wr7_ok:
  s_lshr_b32 s22, s17, 2
  s_lshl_b32 s28, 0x81, s22
  s_mul_i32 s27, s17, 12
  s_add_u32 s22, s27, 256
  s_lshr_b32 s22, s22, 6
  s_lshl_b32 s22, 0x81, s22
  s_or_b32 s28, s28, s22
  s_add_u32 s22, s27, 267
  s_lshr_b32 s22, s22, 6
  s_lshl_b32 s22, 0x81, s22
  s_or_b32 s28, s28, s22
  v_lshlrev_b32 v64, 7, v116
  s_mov_b32 s27, 88520704
  s_mov_b32 s30, 0
ch_ww7:
  buffer_load_dword v65, v64, s[8:11], s27 offen sc1
  s_waitcnt vmcnt(0)
  v_and_b32 v66, s28, v65
  v_cmp_ne_u32 vcc, s28, v66
  s_cbranch_vccz ch_ww7_ok
  s_sleep 3
  s_add_u32 s30, s30, 1
  s_cmp_lt_u32 s30, 400000
  s_cbranch_scc1 ch_ww7
  s_branch cA_abort
ch_ww7_ok:
  s_add_u32 s22, s31, 0
  buffer_load_dwordx4 a[0:3], v2, s[8:11], s22 offen offset:0 sc1
  buffer_load_dwordx4 a[4:7], v2, s[8:11], s22 offen offset:1024 sc1
  buffer_load_dwordx4 a[8:11], v2, s[8:11], s22 offen offset:2048 sc1
  buffer_load_dwordx4 a[12:15], v2, s[8:11], s22 offen offset:3072 sc1
  s_add_u32 s22, s31, 4096
  buffer_load_dwordx4 a[16:19], v2, s[8:11], s22 offen offset:0 sc1
  buffer_load_dwordx4 a[20:23], v2, s[8:11], s22 offen offset:1024 sc1
  buffer_load_dwordx4 a[24:27], v2, s[8:11], s22 offen offset:2048 sc1
  buffer_load_dwordx4 a[28:31], v2, s[8:11], s22 offen offset:3072 sc1
  s_add_u32 s22, s31, 8192
  buffer_load_dwordx4 a[32:35], v2, s[8:11], s22 offen offset:0 sc1
  buffer_load_dwordx4 a[36:39], v2, s[8:11], s22 offen offset:1024 sc1
  buffer_load_dwordx4 a[40:43], v2, s[8:11], s22 offen offset:2048 sc1
  buffer_load_dwordx4 a[44:47], v2, s[8:11], s22 offen offset:3072 sc1
  s_add_u32 s22, s31, 12288
  buffer_load_dwordx4 a[48:51], v2, s[8:11], s22 offen offset:0 sc1
  buffer_load_dwordx4 a[52:55], v2, s[8:11], s22 offen offset:1024 sc1
  buffer_load_dwordx4 a[56:59], v2, s[8:11], s22 offen offset:2048 sc1
  buffer_load_dwordx4 a[60:63], v2, s[8:11], s22 offen offset:3072 sc1
  s_add_u32 s22, s31, 16384
  buffer_load_dwordx4 a[64:67], v2, s[8:11], s22 offen offset:0 sc1
  buffer_load_dwordx4 a[68:71], v2, s[8:11], s22 offen offset:1024 sc1
  buffer_load_dwordx4 a[72:75], v2, s[8:11], s22 offen offset:2048 sc1
  buffer_load_dwordx4 a[76:79], v2, s[8:11], s22 offen offset:3072 sc1
  s_add_u32 s22, s31, 20480
  buffer_load_dwordx4 a[80:83], v2, s[8:11], s22 offen offset:0 sc1
  buffer_load_dwordx4 a[84:87], v2, s[8:11], s22 offen offset:1024 sc1
  buffer_load_dwordx4 a[88:91], v2, s[8:11], s22 offen offset:2048 sc1
  buffer_load_dwordx4 a[92:95], v2, s[8:11], s22 offen offset:3072 sc1
  s_add_u32 s22, s31, 24576
  buffer_load_dwordx4 a[96:99], v2, s[8:11], s22 offen offset:0 sc1
  buffer_load_dwordx4 a[100:103], v2, s[8:11], s22 offen offset:1024 sc1
  buffer_load_dwordx4 a[104:107], v2, s[8:11], s22 offen offset:2048 sc1
  buffer_load_dwordx4 a[108:111], v2, s[8:11], s22 offen offset:3072 sc1
  s_add_u32 s22, s31, 28672
  buffer_load_dwordx4 a[112:115], v2, s[8:11], s22 offen offset:0 sc1
  buffer_load_dwordx4 a[116:119], v2, s[8:11], s22 offen offset:1024 sc1
  buffer_load_dwordx4 a[120:123], v2, s[8:11], s22 offen offset:2048 sc1
  buffer_load_dwordx4 a[124:127], v2, s[8:11], s22 offen offset:3072 sc1
  s_waitcnt vmcnt(24)
  s_add_u32 s22, s31, 32768
  buffer_load_dwordx4 a[128:131], v2, s[8:11], s22 offen offset:0 sc1
  buffer_load_dwordx4 a[132:135], v2, s[8:11], s22 offen offset:1024 sc1
  buffer_load_dwordx4 a[136:139], v2, s[8:11], s22 offen offset:2048 sc1
  buffer_load_dwordx4 a[140:143], v2, s[8:11], s22 offen offset:3072 sc1
  s_add_u32 s22, s31, 36864
  buffer_load_dwordx4 a[144:147], v2, s[8:11], s22 offen offset:0 sc1
  buffer_load_dwordx4 a[148:151], v2, s[8:11], s22 offen offset:1024 sc1
  buffer_load_dwordx4 a[152:155], v2, s[8:11], s22 offen offset:2048 sc1
  buffer_load_dwordx4 a[156:159], v2, s[8:11], s22 offen offset:3072 sc1
  s_add_u32 s22, s31, 40960
  buffer_load_dwordx4 a[160:163], v2, s[8:11], s22 offen offset:0 sc1
  buffer_load_dwordx4 a[164:167], v2, s[8:11], s22 offen offset:1024 sc1
  buffer_load_dwordx4 a[168:171], v2, s[8:11], s22 offen offset:2048 sc1
  buffer_load_dwordx4 a[172:175], v2, s[8:11], s22 offen offset:3072 sc1
  s_add_u32 s22, s31, 45056
  buffer_load_dwordx4 a[176:179], v2, s[8:11], s22 offen offset:0 sc1
  buffer_load_dwordx4 a[180:183], v2, s[8:11], s22 offen offset:1024 sc1
  buffer_load_dwordx4 a[184:187], v2, s[8:11], s22 offen offset:2048 sc1
  buffer_load_dwordx4 a[188:191], v2, s[8:11], s22 offen offset:3072 sc1
  s_add_u32 s22, s31, 49152
  buffer_load_dwordx4 a[192:195], v2, s[8:11], s22 offen offset:0 sc1
  buffer_load_dwordx4 a[196:199], v2, s[8:11], s22 offen offset:1024 sc1
  buffer_load_dwordx4 a[200:203], v2, s[8:11], s22 offen offset:2048 sc1
  buffer_load_dwordx4 a[204:207], v2, s[8:11], s22 offen offset:3072 sc1
  s_add_u32 s22, s31, 53248
  buffer_load_dwordx4 a[208:211], v2, s[8:11], s22 offen offset:0 sc1
  buffer_load_dwordx4 a[212:215], v2, s[8:11], s22 offen offset:1024 sc1
  buffer_load_dwordx4 a[216:219], v2, s[8:11], s22 offen offset:2048 sc1
  buffer_load_dwordx4 a[220:223], v2, s[8:11], s22 offen offset:3072 sc1
  s_add_u32 s22, s31, 57344
  buffer_load_dwordx4 a[224:227], v2, s[8:11], s22 offen offset:0 sc1
  buffer_load_dwordx4 a[228:231], v2, s[8:11], s22 offen offset:1024 sc1
  buffer_load_dwordx4 a[232:235], v2, s[8:11], s22 offen offset:2048 sc1
  buffer_load_dwordx4 a[236:239], v2, s[8:11], s22 offen offset:3072 sc1
  s_add_u32 s22, s31, 61440
  buffer_load_dwordx4 a[240:243], v2, s[8:11], s22 offen offset:0 sc1
  buffer_load_dwordx4 a[244:247], v2, s[8:11], s22 offen offset:1024 sc1
  buffer_load_dwordx4 a[248:251], v2, s[8:11], s22 offen offset:2048 sc1
  buffer_load_dwordx4 a[252:255], v2, s[8:11], s22 offen offset:3072 sc1
  s_waitcnt vmcnt(24)
  s_add_u32 s22, s31, 65536
  buffer_load_dwordx4 v[120:123], v2, s[8:11], s22 offen offset:0 sc1
  buffer_load_dwordx4 v[124:127], v2, s[8:11], s22 offen offset:1024 sc1
  buffer_load_dwordx4 v[128:131], v2, s[8:11], s22 offen offset:2048 sc1
  buffer_load_dwordx4 v[132:135], v2, s[8:11], s22 offen offset:3072 sc1
  s_add_u32 s22, s31, 69632
  buffer_load_dwordx4 v[136:139], v2, s[8:11], s22 offen offset:0 sc1
  buffer_load_dwordx4 v[140:143], v2, s[8:11], s22 offen offset:1024 sc1
  buffer_load_dwordx4 v[144:147], v2, s[8:11], s22 offen offset:2048 sc1
  buffer_load_dwordx4 v[148:151], v2, s[8:11], s22 offen offset:3072 sc1
  s_add_u32 s22, s31, 73728
  buffer_load_dwordx4 v[152:155], v2, s[8:11], s22 offen offset:0 sc1
  buffer_load_dwordx4 v[156:159], v2, s[8:11], s22 offen offset:1024 sc1
  buffer_load_dwordx4 v[160:163], v2, s[8:11], s22 offen offset:2048 sc1
  buffer_load_dwordx4 v[164:167], v2, s[8:11], s22 offen offset:3072 sc1
  s_add_u32 s22, s31, 77824
  buffer_load_dwordx4 v[168:171], v2, s[8:11], s22 offen offset:0 sc1
  buffer_load_dwordx4 v[172:175], v2, s[8:11], s22 offen offset:1024 sc1
  buffer_load_dwordx4 v[176:179], v2, s[8:11], s22 offen offset:2048 sc1
  buffer_load_dwordx4 v[180:183], v2, s[8:11], s22 offen offset:3072 sc1
  s_add_u32 s22, s31, 81920
  buffer_load_dwordx4 v[184:187], v2, s[8:11], s22 offen offset:0 sc1
  buffer_load_dwordx4 v[188:191], v2, s[8:11], s22 offen offset:1024 sc1
  buffer_load_dwordx4 v[192:195], v2, s[8:11], s22 offen offset:2048 sc1
  buffer_load_dwordx4 v[196:199], v2, s[8:11], s22 offen offset:3072 sc1
  s_add_u32 s22, s31, 86016
  buffer_load_dwordx4 v[200:203], v2, s[8:11], s22 offen offset:0 sc1
  buffer_load_dwordx4 v[204:207], v2, s[8:11], s22 offen offset:1024 sc1
  buffer_load_dwordx4 v[208:211], v2, s[8:11], s22 offen offset:2048 sc1
  buffer_load_dwordx4 v[212:215], v2, s[8:11], s22 offen offset:3072 sc1
  s_add_u32 s22, s31, 90112
  buffer_load_dwordx4 v[216:219], v2, s[8:11], s22 offen offset:0 sc1
  buffer_load_dwordx4 v[220:223], v2, s[8:11], s22 offen offset:1024 sc1
  buffer_load_dwordx4 v[224:227], v2, s[8:11], s22 offen offset:2048 sc1
  buffer_load_dwordx4 v[228:231], v2, s[8:11], s22 offen offset:3072 sc1
  s_add_u32 s22, s31, 94208
  buffer_load_dwordx4 v[232:235], v2, s[8:11], s22 offen offset:0 sc1
  buffer_load_dwordx4 v[236:239], v2, s[8:11], s22 offen offset:1024 sc1
  buffer_load_dwordx4 v[240:243], v2, s[8:11], s22 offen offset:2048 sc1
  buffer_load_dwordx4 v[244:247], v2, s[8:11], s22 offen offset:3072 sc1
  s_waitcnt vmcnt(24)
  s_add_u32 s22, s31, 98304
  buffer_load_dwordx4 v[248:251], v2, s[8:11], s22 offen offset:0 sc1
  buffer_load_dwordx4 v[252:255], v2, s[8:11], s22 offen offset:1024 sc1
  v_mov_b32 v72, v116
  v_mov_b32 v73, v117
  v_lshrrev_b32 v65, 1, v72
  v_and_b32 v66, 1, v72
  v_mov_b32 v36, 0
  v_mov_b32 v37, 0
  v_mov_b32 v38, 0
  v_mov_b32 v39, 0
  v_mov_b32 v40, 0
  v_mov_b32 v41, 0
  v_mov_b32 v42, 0
  v_mov_b32 v43, 0
  v_mov_b32 v44, 0
  v_mov_b32 v45, 0
  v_mov_b32 v46, 0
  v_mov_b32 v47, 0
  v_mov_b32 v48, 0
  v_mov_b32 v49, 0
  v_mov_b32 v50, 0
  v_mov_b32 v51, 0
  v_mov_b32 v52, 0
  v_mov_b32 v53, 0
  v_mov_b32 v54, 0
  v_mov_b32 v55, 0
  v_mov_b32 v56, 0
  v_mov_b32 v57, 0
  v_mov_b32 v58, 0
  v_mov_b32 v59, 0
  v_mov_b32 v60, 0
  v_mov_b32 v61, 0
  v_mov_b32 v62, 0
  v_mov_b32 v63, 0
  v_lshlrev_b32 v75, 2, v65
  v_lshl_add_u32 v75, v66, 3, v75
  v_add_u32 v67, 336, v73
  v_mul_u32_u24 v68, 2341, v67
  v_lshrrev_b32 v68, 16, v68
  v_mul_u32_u24 v69, 28, v68
  v_sub_u32 v69, v67, v69
  v_lshrrev_b32 v70, 4, v69
  v_and_b32 v69, 15, v69
  v_lshlrev_b32 v71, 12, v70
  v_lshl_add_u32 v71, v68, 8, v71
  v_lshl_add_u32 v71, v69, 4, v71
  v_add_u32 v104, v71, v75
  v_add_u32 v67, 352, v73
  v_mul_u32_u24 v68, 2341, v67
  v_lshrrev_b32 v68, 16, v68
  v_mul_u32_u24 v69, 28, v68
  v_sub_u32 v69, v67, v69
  v_lshrrev_b32 v70, 4, v69
  v_and_b32 v69, 15, v69
  v_lshlrev_b32 v71, 12, v70
  v_lshl_add_u32 v71, v68, 8, v71
  v_lshl_add_u32 v71, v69, 4, v71
  v_add_u32 v105, v71, v75
  v_add_u32 v67, 368, v73
  v_mul_u32_u24 v68, 2341, v67
  v_lshrrev_b32 v68, 16, v68
  v_mul_u32_u24 v69, 28, v68
  v_sub_u32 v69, v67, v69
  v_lshrrev_b32 v70, 4, v69
  v_and_b32 v69, 15, v69
  v_lshlrev_b32 v71, 12, v70
  v_lshl_add_u32 v71, v68, 8, v71
  v_lshl_add_u32 v71, v69, 4, v71
  v_add_u32 v106, v71, v75
  v_add_u32 v67, 384, v73
  v_mul_u32_u24 v68, 2341, v67
  v_lshrrev_b32 v68, 16, v68
  v_mul_u32_u24 v69, 28, v68
  v_sub_u32 v69, v67, v69
  v_lshrrev_b32 v70, 4, v69
  v_and_b32 v69, 15, v69
  v_lshlrev_b32 v71, 12, v70
  v_lshl_add_u32 v71, v68, 8, v71
  v_lshl_add_u32 v71, v69, 4, v71
  v_add_u32 v107, v71, v75
  v_add_u32 v67, 400, v73
  v_mul_u32_u24 v68, 2341, v67
  v_lshrrev_b32 v68, 16, v68
  v_mul_u32_u24 v69, 28, v68
  v_sub_u32 v69, v67, v69
  v_lshrrev_b32 v70, 4, v69
  v_and_b32 v69, 15, v69
  v_lshlrev_b32 v71, 12, v70
  v_lshl_add_u32 v71, v68, 8, v71
  v_lshl_add_u32 v71, v69, 4, v71
  v_add_u32 v108, v71, v75
  v_add_u32 v67, 416, v73
  v_mul_u32_u24 v68, 2341, v67
  v_lshrrev_b32 v68, 16, v68
  v_mul_u32_u24 v69, 28, v68
  v_sub_u32 v69, v67, v69
  v_lshrrev_b32 v70, 4, v69
  v_and_b32 v69, 15, v69
  v_lshlrev_b32 v71, 12, v70
  v_lshl_add_u32 v71, v68, 8, v71
  v_lshl_add_u32 v71, v69, 4, v71
  v_add_u32 v109, v71, v75
  v_add_u32 v67, 432, v73
  v_mul_u32_u24 v68, 2341, v67
  v_lshrrev_b32 v68, 16, v68
  v_mul_u32_u24 v69, 28, v68
  v_sub_u32 v69, v67, v69
  v_lshrrev_b32 v70, 4, v69
  v_and_b32 v69, 15, v69
  v_lshlrev_b32 v71, 12, v70
  v_lshl_add_u32 v71, v68, 8, v71
  v_lshl_add_u32 v71, v69, 4, v71
  v_add_u32 v110, v71, v75
  v_mov_b32 v74, 0x40000000
  v_and_b32 v119, 15, v1
  s_and_b32 s22, s17, 0
  s_lshl_b32 s22, s22, 7
  s_add_u32 s22, s22, 75733504
  v_lshl_add_u32 v119, v119, 2, s22
  s_lshl_b32 s22, s17, 2
  s_add_u32 s22, s22, 75731456
  v_lshl_add_u32 v118, v1, 7, s22
  v_cmp_gt_u32 vcc, 1, v1
  s_nop 1
  v_cndmask_b32 v118, v74, v118, vcc
  s_lshl_b32 s35, s17, 7
  s_add_u32 s35, s35, 88461312
  s_mov_b32 s28, s35
  v_min_u32 v116, 13, v1
  s_mul_i32 s22, s17, 14
  v_add_u32 v116, s22, v116
  v_lshlrev_b32 v116, 7, v116
  s_mov_b32 s39, 72052736
  s_mov_b32 s30, 0
ch_vw7i:
  buffer_load_dword v9, off, s[12:15], 0 offset:132 sc1
  s_waitcnt vmcnt(0)
  v_cmp_ne_u32 vcc, 1, v9
  s_cbranch_vccz ch_vw7i_ok
  s_sleep 8
  s_add_u32 s30, s30, 1
  s_cmp_lt_u32 s30, 400000
  s_cbranch_scc1 ch_vw7i
  s_branch cA_abort
ch_vw7i_ok:
  s_lshl_b32 s27, s17, 7
  s_add_u32 s27, s27, 88461312
  s_mov_b32 s30, 0
ch_vw7:
  buffer_load_dword v9, off, s[8:11], s27 sc1
  s_waitcnt vmcnt(0)
  v_cmp_ne_u32 vcc, 56, v9
  s_cbranch_vccz ch_vw7_d
  s_sleep 2
  s_add_u32 s30, s30, 1
  s_cmp_lt_u32 s30, 400000
  s_cbranch_scc1 ch_vw7
  s_branch cA_abort
ch_vw7_d:
  buffer_load_dword v100, v116, s[8:11], s39 offen sc1
  s_mov_b32 s39, 72081408
  s_mov_b32 s30, 0
  v_mov_b32 v8, 0
ch_md7:
  buffer_load_dword v9, v8, s[12:15], 0 offen sc1
  s_waitcnt vmcnt(0) lgkmcnt(0)
  v_readfirstlane_b32 s22, v9
  s_and_b32 s31, s22, 0xffff
  s_cmp_ge_u32 s31, 32
  s_cbranch_scc1 ch_go7
  s_sleep 2
  s_add_u32 s30, s30, 1
  s_cmp_lt_u32 s30, 3200000
  s_cbranch_scc1 ch_md7
  s_branch ch_end
ch_go7:
  s_mov_b32 s31, 0
  s_lshr_b32 s22, s22, 16
  s_cmp_lg_u32 s22, 0
  s_cbranch_scc1 cB_va3_loop
  s_branch cA_va3_loop
.p2align 6
cA_sc0_loop:
  s_mov_b32 s30, 0
  s_mov_b32 s62, 0
  s_setprio 3
  s_sleep 6
  buffer_load_dword v76, v0, s[8:11], 0 offen sc1
  buffer_load_dword v77, v0, s[8:11], 0 offen sc1
  buffer_load_dword v78, v0, s[8:11], 0 offen sc1
  buffer_load_dword v79, v0, s[8:11], 0 offen sc1
cA_sc0_fp_l:
  s_waitcnt vmcnt(3)
  v_cmp_gt_u32 vcc, s19, v76
  s_cbranch_vccz cA_sc0_fp_d
  buffer_load_dword v76, v0, s[8:11], 0 offen sc1
  s_waitcnt vmcnt(3)
  v_cmp_gt_u32 vcc, s19, v77
  s_cbranch_vccz cA_sc0_fp_d
  buffer_load_dword v77, v0, s[8:11], 0 offen sc1
  s_waitcnt vmcnt(3)
  v_cmp_gt_u32 vcc, s19, v78
  s_cbranch_vccz cA_sc0_fp_d
  buffer_load_dword v78, v0, s[8:11], 0 offen sc1
  s_waitcnt vmcnt(3)
  v_cmp_gt_u32 vcc, s19, v79
  s_cbranch_vccz cA_sc0_fp_d
  buffer_load_dword v79, v0, s[8:11], 0 offen sc1
  s_add_u32 s30, s30, 1
  s_cmp_lt_u32 s30, 400000
  s_cbranch_scc1 cA_sc0_fp_l
  s_branch cA_abort
cA_sc0_fp_d:
  buffer_load_dwordx4 v[8:11], v2, s[8:11], s20 offen offset:0 sc1
  s_barrier
  s_setprio 2
  buffer_load_dwordx4 v[12:15], v2, s[8:11], s20 offen offset:1024 sc1
  s_setprio 1
  buffer_load_dwordx4 v[16:19], v2, s[8:11], s20 offen offset:2048 sc1
  s_setprio 0
  buffer_load_dwordx4 v[20:23], v2, s[8:11], s20 offen offset:3072 sc1
cA_sc0_go:
  s_waitcnt vmcnt(3)
  v_smfmac_f32_16x16x64_bf16 v[36:39], v[8:11], a[0:7], v3
  buffer_load_dwordx4 v[32:35], v2, s[8:11], s23 offen offset:0 sc1
  v_cmp_eq_u32 vcc, -1, v8
  v_smfmac_f32_16x16x64_bf16 v[40:43], v[8:11], a[56:63], v3
  v_smfmac_f32_16x16x64_bf16 v[44:47], v[8:11], a[112:119], v3
  buffer_load_dwordx4 v[24:27], v2, s[8:11], s23 offen offset:1024 sc1
  s_cbranch_vccnz cA_sc0_r0
  v_smfmac_f32_16x16x64_bf16 v[48:51], v[8:11], a[168:175], v3
  v_smfmac_f32_16x16x64_bf16 v[52:55], v[8:11], a[224:231], v3
  s_waitcnt vmcnt(4)
  v_cmp_eq_u32 vcc, -1, v12
  v_smfmac_f32_16x16x64_bf16 v[56:59], v[8:11], v[144:151], v3
  buffer_load_dwordx4 v[28:31], v2, s[8:11], s23 offen offset:2048 sc1
  v_smfmac_f32_16x16x64_bf16 v[60:63], v[8:11], v[200:207], v3
  s_cbranch_vccnz cA_sc0_r1
cA_sc0_c1:
  v_smfmac_f32_16x16x64_bf16 v[36:39], v[12:15], a[8:15], v3
  v_smfmac_f32_16x16x64_bf16 v[40:43], v[12:15], a[64:71], v3
  v_smfmac_f32_16x16x64_bf16 v[44:47], v[12:15], a[120:127], v3
  v_smfmac_f32_16x16x64_bf16 v[48:51], v[12:15], a[176:183], v3
  v_smfmac_f32_16x16x64_bf16 v[52:55], v[12:15], a[232:239], v3
  s_waitcnt vmcnt(4)
  v_cmp_eq_u32 vcc, -1, v16
  v_smfmac_f32_16x16x64_bf16 v[56:59], v[12:15], v[152:159], v3
  buffer_load_dwordx4 v[88:91], v117, s[8:11], s26 offen offset:0 sc1
  v_smfmac_f32_16x16x64_bf16 v[60:63], v[12:15], v[208:215], v3
  s_cbranch_vccnz cA_sc0_r2
cA_sc0_c2:
  v_smfmac_f32_16x16x64_bf16 v[36:39], v[16:19], a[16:23], v3
  v_smfmac_f32_16x16x64_bf16 v[40:43], v[16:19], a[72:79], v3
  v_smfmac_f32_16x16x64_bf16 v[44:47], v[16:19], a[128:135], v3
  buffer_load_dwordx4 v[92:95], v117, s[8:11], s26 offen offset:1024 sc1
  v_smfmac_f32_16x16x64_bf16 v[48:51], v[16:19], a[184:191], v3
  v_smfmac_f32_16x16x64_bf16 v[52:55], v[16:19], a[240:247], v3
  s_waitcnt vmcnt(5)
  v_cmp_eq_u32 vcc, -1, v20
  v_smfmac_f32_16x16x64_bf16 v[56:59], v[16:19], v[160:167], v3
  v_smfmac_f32_16x16x64_bf16 v[60:63], v[16:19], v[216:223], v3
  buffer_load_dwordx4 v[96:99], v2, s[8:11], s24 offen offset:0 sc1
  s_cbranch_vccnz cA_sc0_r3
cA_sc0_c3:
  v_smfmac_f32_16x16x64_bf16 v[36:39], v[20:23], a[24:31], v3
  v_smfmac_f32_16x16x64_bf16 v[40:43], v[20:23], a[80:87], v3
  s_waitcnt vmcnt(3)
  v_max3_u32 v66, v24, v27, v28
  v_smfmac_f32_16x16x64_bf16 v[44:47], v[20:23], a[136:143], v3
  v_max3_u32 v66, v66, v31, v32
  v_smfmac_f32_16x16x64_bf16 v[48:51], v[20:23], a[192:199], v3
  buffer_load_dwordx4 v[100:103], v2, s[8:11], s24 offen offset:1024 sc1
  v_max_u32 v66, v66, v35
  v_smfmac_f32_16x16x64_bf16 v[52:55], v[20:23], a[248:255], v3
  v_cmp_eq_u32 vcc, -1, v66
  v_smfmac_f32_16x16x64_bf16 v[56:59], v[20:23], v[168:175], v3
  v_smfmac_f32_16x16x64_bf16 v[60:63], v[20:23], v[224:231], v3
  s_cbranch_vccnz cA_sc0_r4
cA_sc0_c4:
  v_smfmac_f32_16x16x64_bf16 v[60:63], v[32:35], v[232:239], v3
  buffer_load_dwordx4 v[104:107], v2, s[8:11], s26 offen offset:0 sc1
  v_smfmac_f32_16x16x64_bf16 v[60:63], v[24:27], v[240:247], v3
  v_smfmac_f32_16x16x64_bf16 v[60:63], v[28:31], v[248:255], v3
  v_smfmac_f32_16x16x64_bf16 v[52:55], v[32:35], v[120:127], v3
  v_smfmac_f32_16x16x64_bf16 v[52:55], v[24:27], v[128:135], v3
  buffer_load_dwordx4 v[108:111], v2, s[8:11], s26 offen offset:1024 sc1
  v_smfmac_f32_16x16x64_bf16 v[52:55], v[28:31], v[136:143], v3
  v_cvt_pk_bf16_f32 v63, v62, v63
  v_smfmac_f32_16x16x64_bf16 v[56:59], v[32:35], v[176:183], v3
  v_cvt_pk_bf16_f32 v62, v60, v61
  v_smfmac_f32_16x16x64_bf16 v[56:59], v[24:27], v[184:191], v3
  v_mfma_f32_16x16x32_bf16 v[12:15], v[62:65], v[4:7], 0
  v_cvt_pk_bf16_f32 v55, v54, v55
  v_smfmac_f32_16x16x64_bf16 v[56:59], v[28:31], v[192:199], v3
  v_cvt_pk_bf16_f32 v54, v52, v53
  v_smfmac_f32_16x16x64_bf16 v[36:39], v[32:35], a[32:39], v3
  s_nop 1
  v_cvt_pk_bf16_f32 v76, v12, v13
  v_smfmac_f32_16x16x64_bf16 v[36:39], v[24:27], a[40:47], v3
  v_cvt_pk_bf16_f32 v77, v14, v15
  v_smfmac_f32_16x16x64_bf16 v[36:39], v[28:31], a[48:55], v3
  v_cvt_pk_bf16_f32 v56, v56, v57
  v_smfmac_f32_16x16x64_bf16 v[40:43], v[32:35], a[88:95], v3
  v_cvt_pk_bf16_f32 v57, v58, v59
  v_smfmac_f32_16x16x64_bf16 v[40:43], v[24:27], a[96:103], v3
  v_mfma_f32_16x16x32_bf16 v[16:19], v[54:57], v[4:7], 0
  v_cvt_pk_bf16_f32 v39, v38, v39
  v_smfmac_f32_16x16x64_bf16 v[40:43], v[28:31], a[104:111], v3
  v_cvt_pk_bf16_f32 v38, v36, v37
  v_smfmac_f32_16x16x64_bf16 v[44:47], v[32:35], a[144:151], v3
  s_nop 1
  v_cvt_pk_bf16_f32 v78, v16, v17
  v_smfmac_f32_16x16x64_bf16 v[44:47], v[24:27], a[152:159], v3
  v_cvt_pk_bf16_f32 v79, v18, v19
  v_smfmac_f32_16x16x64_bf16 v[44:47], v[28:31], a[160:167], v3
  v_cvt_pk_bf16_f32 v40, v40, v41
  v_smfmac_f32_16x16x64_bf16 v[48:51], v[32:35], a[200:207], v3
  v_cvt_pk_bf16_f32 v41, v42, v43
  v_smfmac_f32_16x16x64_bf16 v[48:51], v[24:27], a[208:215], v3
  v_smfmac_f32_16x16x64_bf16 v[48:51], v[28:31], a[216:223], v3
  s_waitcnt vmcnt(4)
  v_cvt_pk_bf16_f32 v47, v46, v47
  v_smfmac_f32_16x16x64_bf16 v[68:71], v[76:79], v[80:87], v3
  v_cvt_pk_bf16_f32 v46, v44, v45
  v_mfma_f32_16x16x32_bf16 v[12:15], v[38:41], v[4:7], 0
  s_nop 1
  v_cvt_pk_bf16_f32 v48, v48, v49
  v_cvt_pk_bf16_f32 v49, v50, v51
  s_nop 1
  v_mfma_f32_16x16x32_bf16 v[16:19], v[46:49], v[4:7], 0
  v_smfmac_f32_16x16x64_bf16 v[72:75], v[76:79], v[88:95], v3
  v_cvt_pk_bf16_f32 v20, v12, v13
  v_mfma_f32_16x16x32_bf16 v[52:55], v[30:33], v[76:79], 0
  s_waitcnt vmcnt(0)
  v_cvt_pk_bf16_f32 v21, v14, v15
  v_cvt_pk_bf16_f32 v22, v16, v17
  v_cvt_pk_bf16_f32 v23, v18, v19
  s_nop 1
  v_mfma_f32_16x16x32_bf16 v[52:55], v[8:11], v[20:23], v[52:55]
  v_smfmac_f32_16x16x64_bf16 v[68:71], v[20:23], v[96:103], v3
  v_smfmac_f32_16x16x64_bf16 v[72:75], v[20:23], v[104:111], v3
  s_nop 1
  ds_write_b128 v113, v[52:55]
  s_nop 1
  v_permlane32_swap_b32 v68, v70
  v_permlane32_swap_b32 v69, v71
  v_add_f32 v56, v68, v70
  v_add_f32 v58, v69, v71
  v_permlane32_swap_b32 v72, v74
  v_permlane32_swap_b32 v73, v75
  v_add_f32 v57, v72, v74
  v_add_f32 v59, v73, v75
  ds_write_b128 v2, v[56:59] offset:0
  v_cmp_u_f32 vcc, v57, v59
  v_mov_b32 v68, 0
  v_mov_b32 v69, 0
  v_mov_b32 v70, 0
  v_mov_b32 v71, 0
  s_cbranch_vccnz cA_sc0_retry
cA_sc0_cont:
  s_add_u32 s24, s24, 28672
  s_add_u32 s26, s26, 28672
  buffer_load_dwordx4 v[80:83], v117, s[8:11], s24 offen offset:0 sc1
  buffer_load_dwordx4 v[84:87], v117, s[8:11], s24 offen offset:1024 sc1
  v_mov_b32 v72, 0
  v_mov_b32 v73, 0
  v_mfma_f32_32x32x16_bf16 v[36:51], v[68:71], v[68:71], 0
  s_waitcnt lgkmcnt(0)
  s_barrier
  ds_read_b64 v[8:9], v114 offset:0
  ds_read_b64 v[10:11], v114 offset:1024
  ds_read_b64 v[12:13], v114 offset:2048
  ds_read_b64 v[14:15], v114 offset:3072
  ds_read2_b32 v[16:17], v115 offset0:0 offset1:64
  ds_read2_b32 v[18:19], v115 offset0:128 offset1:192
  v_mfma_f32_32x32x16_bf16 v[52:67], v[68:71], v[68:71], 0
  s_waitcnt lgkmcnt(0)
  v_pk_add_f32 v[16:17], v[16:17], v[18:19]
  v_pk_add_f32 v[8:9], v[8:9], v[10:11]
  v_pk_add_f32 v[12:13], v[12:13], v[14:15]
  v_add_f32 v20, v16, v17
  v_pk_add_f32 v[8:9], v[8:9], v[12:13]
  v_max_f32 v22, v8, v9
  v_add_f32_dpp v20, v20, v20 row_ror:8 row_mask:0xf bank_mask:0xf
  s_nop 0
  v_max_f32_dpp v22, v22, v22 row_ror:8 row_mask:0xf bank_mask:0xf
  v_max_f32 v22, v22, v20
  s_nop 1
  v_max_f32_dpp v22, v22, v22 quad_perm:[1,0,3,2] row_mask:0xf bank_mask:0xf
  s_nop 1
  v_max_f32_dpp v22, v22, v22 quad_perm:[2,3,0,1] row_mask:0xf bank_mask:0xf
  s_nop 1
  v_max_f32_dpp v22, v22, v22 row_half_mirror row_mask:0xf bank_mask:0xf
  v_pk_add_f32 v[8:9], v[8:9], v[22:23] op_sel_hi:[1,0] neg_lo:[0,1] neg_hi:[0,1]
  v_sub_f32 v20, v20, v22
  v_exp_f32 v8, v8
  v_exp_f32 v9, v9
  v_exp_f32 v20, v20
  v_add_f32 v24, v8, v9
  v_fmac_f32 v24, 0.5, v20
  v_mov_b32_dpp v21, v20 quad_perm:[1,0,3,2] row_mask:0xf bank_mask:0xf
  s_nop 0
  v_add_f32_dpp v24, v24, v24 quad_perm:[1,0,3,2] row_mask:0xf bank_mask:0xf
  s_nop 1
  v_add_f32_dpp v24, v24, v24 quad_perm:[2,3,0,1] row_mask:0xf bank_mask:0xf
  s_nop 1
  v_add_f32_dpp v24, v24, v24 row_half_mirror row_mask:0xf bank_mask:0xf
  s_nop 1
  v_add_f32_dpp v24, v24, v24 row_ror:8 row_mask:0xf bank_mask:0xf
  v_rcp_f32 v24, v24
  s_nop 0
  v_pk_mul_f32 v[8:9], v[8:9], v[24:25] op_sel_hi:[1,0]
  v_pk_mul_f32 v[20:21], v[20:21], v[24:25] op_sel_hi:[1,0]
  v_cvt_pk_bf16_f32 v8, v8, v9
  v_cvt_pk_bf16_f32 v20, v20, v21
  v_min_u32 v8, -2, v8
  buffer_store_dword v8, v1, s[8:11], s20 offen
  v_min_u32 v20, -2, v20
  buffer_store_dword v20, v118, s[8:11], s20 offen
  buffer_store_dword v119, v1, s[8:11], s21 offen
  buffer_store_dword v119, v118, s[8:11], s21 offen
  v_mov_b32 v74, 0
  v_mov_b32 v75, 0
  s_mov_b32 s19, s18
  s_add_u32 s18, s18, 1
  s_mov_b32 s22, s20
  s_mov_b32 s20, s21
  s_mov_b32 s21, s22
  s_add_u32 s23, s20, 4096
  s_cmp_lt_u32 s19, 63
  s_cbranch_scc1 cA_sc0_loop
  s_branch cA_done
cA_sc0_r0:
  s_add_u32 s31, s31, 1
  buffer_load_dwordx4 v[8:11], v2, s[8:11], s20 offen offset:0 sc1
  s_waitcnt vmcnt(0)
  v_cmp_eq_u32 vcc, -1, v8
  v_mov_b32 v36, 0
  v_mov_b32 v37, 0
  v_mov_b32 v38, 0
  v_mov_b32 v39, 0
  v_mov_b32 v40, 0
  v_mov_b32 v41, 0
  v_mov_b32 v42, 0
  v_mov_b32 v43, 0
  v_mov_b32 v44, 0
  v_mov_b32 v45, 0
  v_mov_b32 v46, 0
  v_mov_b32 v47, 0
  v_mov_b32 v48, 0
  v_mov_b32 v49, 0
  v_mov_b32 v50, 0
  v_mov_b32 v51, 0
  s_nop 1
  s_cbranch_vccz cA_sc0_go
  s_add_u32 s30, s30, 1
  s_cmp_lt_u32 s30, 400000
  s_cbranch_scc1 cA_sc0_r0
  s_branch cA_abort
cA_sc0_r1:
  s_add_u32 s31, s31, 1
  buffer_load_dwordx4 v[12:15], v2, s[8:11], s20 offen offset:1024 sc1
  s_waitcnt vmcnt(0)
  v_cmp_eq_u32 vcc, -1, v12
  s_nop 4
  s_cbranch_vccz cA_sc0_c1
  s_add_u32 s30, s30, 1
  s_cmp_lt_u32 s30, 400000
  s_cbranch_scc1 cA_sc0_r1
  s_branch cA_abort
cA_sc0_r2:
  s_add_u32 s31, s31, 1
  buffer_load_dwordx4 v[16:19], v2, s[8:11], s20 offen offset:2048 sc1
  s_waitcnt vmcnt(0)
  v_cmp_eq_u32 vcc, -1, v16
  s_nop 4
  s_cbranch_vccz cA_sc0_c2
  s_add_u32 s30, s30, 1
  s_cmp_lt_u32 s30, 400000
  s_cbranch_scc1 cA_sc0_r2
  s_branch cA_abort
cA_sc0_r3:
  s_add_u32 s31, s31, 1
  buffer_load_dwordx4 v[20:23], v2, s[8:11], s20 offen offset:3072 sc1
  s_waitcnt vmcnt(0)
  v_cmp_eq_u32 vcc, -1, v20
  s_nop 4
  s_cbranch_vccz cA_sc0_c3
  s_add_u32 s30, s30, 1
  s_cmp_lt_u32 s30, 400000
  s_cbranch_scc1 cA_sc0_r3
  s_branch cA_abort
cA_sc0_r4:
  s_add_u32 s31, s31, 1
  buffer_load_dwordx4 v[32:35], v2, s[8:11], s23 offen offset:0 sc1
  buffer_load_dwordx4 v[24:27], v2, s[8:11], s23 offen offset:1024 sc1
  buffer_load_dwordx4 v[28:31], v2, s[8:11], s23 offen offset:2048 sc1
  s_waitcnt vmcnt(0)
  v_max3_u32 v66, v24, v27, v28
  v_max3_u32 v66, v66, v31, v32
  v_max_u32 v66, v66, v35
  v_cmp_eq_u32 vcc, -1, v66
  s_nop 4
  s_cbranch_vccz cA_sc0_c4
  s_add_u32 s30, s30, 1
  s_cmp_lt_u32 s30, 400000
  s_cbranch_scc1 cA_sc0_r4
  s_branch cA_abort
cA_sc0_retry:
  s_cmp_lg_u32 s62, 0
  s_cbranch_scc1 cA_sc0_cont
  s_waitcnt vmcnt(0) lgkmcnt(0)
cA_sc0_rv:
  buffer_load_dwordx4 v[8:11], v2, s[8:11], s20 offen offset:0 sc1
  buffer_load_dwordx4 v[12:15], v2, s[8:11], s20 offen offset:1024 sc1
  buffer_load_dwordx4 v[16:19], v2, s[8:11], s20 offen offset:2048 sc1
  buffer_load_dwordx4 v[20:23], v2, s[8:11], s20 offen offset:3072 sc1
  buffer_load_dwordx4 v[32:35], v2, s[8:11], s23 offen offset:0 sc1
  buffer_load_dwordx4 v[24:27], v2, s[8:11], s23 offen offset:1024 sc1
  buffer_load_dwordx4 v[28:31], v2, s[8:11], s23 offen offset:2048 sc1
  s_waitcnt vmcnt(0)
  v_pk_max_u16 v66, v8, v9
  v_pk_max_u16 v66, v66, v10
  v_pk_max_u16 v66, v66, v11
  v_pk_max_u16 v66, v66, v12
  v_pk_max_u16 v66, v66, v13
  v_pk_max_u16 v66, v66, v14
  v_pk_max_u16 v66, v66, v15
  v_pk_max_u16 v66, v66, v16
  v_pk_max_u16 v66, v66, v17
  v_pk_max_u16 v66, v66, v18
  v_pk_max_u16 v66, v66, v19
  v_pk_max_u16 v66, v66, v20
  v_pk_max_u16 v66, v66, v21
  v_pk_max_u16 v66, v66, v22
  v_pk_max_u16 v66, v66, v23
  v_pk_max_u16 v66, v66, v24
  v_pk_max_u16 v66, v66, v25
  v_pk_max_u16 v66, v66, v26
  v_pk_max_u16 v66, v66, v27
  v_pk_max_u16 v66, v66, v28
  v_pk_max_u16 v66, v66, v29
  v_pk_max_u16 v66, v66, v30
  v_pk_max_u16 v66, v66, v31
  v_pk_max_u16 v66, v66, v32
  v_pk_max_u16 v66, v66, v33
  v_pk_max_u16 v66, v66, v34
  v_pk_max_u16 v66, v66, v35
  v_lshlrev_b32 v67, 16, v66
  v_max_u32 v66, v66, v67
  v_cmp_le_u32 vcc, 0xffff0000, v66
  s_cbranch_vccz cA_sc0_rk
  s_add_u32 s30, s30, 1
  s_cmp_lt_u32 s30, 400000
  s_cbranch_scc1 cA_sc0_rv
  s_branch cA_abort
cA_sc0_rk:
  s_mov_b32 s62, 1
  v_mov_b32 v36, 0
  v_mov_b32 v37, 0
  v_mov_b32 v38, 0
  v_mov_b32 v39, 0
  v_mov_b32 v40, 0
  v_mov_b32 v41, 0
  v_mov_b32 v42, 0
  v_mov_b32 v43, 0
  v_mov_b32 v44, 0
  v_mov_b32 v45, 0
  v_mov_b32 v46, 0
  v_mov_b32 v47, 0
  v_mov_b32 v48, 0
  v_mov_b32 v49, 0
  v_mov_b32 v50, 0
  v_mov_b32 v51, 0
  v_mov_b32 v60, 0
  v_mov_b32 v61, 0
  v_mov_b32 v62, 0
  v_mov_b32 v63, 0
  v_mov_b32 v68, 0
  v_mov_b32 v69, 0
  v_mov_b32 v70, 0
  v_mov_b32 v71, 0
  v_mov_b32 v72, 0
  v_mov_b32 v73, 0
  v_mov_b32 v74, 0
  v_mov_b32 v75, 0
  v_mov_b32 v52, 0
  v_mov_b32 v53, 0
  v_mov_b32 v54, 0
  v_mov_b32 v55, 0
  v_mov_b32 v56, 0
  v_mov_b32 v57, 0
  v_mov_b32 v58, 0
  v_mov_b32 v59, 0
  s_add_u32 s31, s31, 0x100
  s_nop 0
  s_branch cA_sc0_go
.p2align 6
cA_sc1_loop:
  s_mov_b32 s30, 0
  s_mov_b32 s62, 0
  s_setprio 3
  s_barrier
  buffer_load_dwordx4 v[8:11], v2, s[8:11], s20 offen offset:0 sc1
  s_setprio 2
  buffer_load_dwordx4 v[12:15], v2, s[8:11], s20 offen offset:1024 sc1
  s_setprio 1
  buffer_load_dwordx4 v[16:19], v2, s[8:11], s20 offen offset:2048 sc1
  s_setprio 0
  buffer_load_dwordx4 v[20:23], v2, s[8:11], s20 offen offset:3072 sc1
cA_sc1_go:
  s_waitcnt vmcnt(3)
  v_smfmac_f32_16x16x64_bf16 v[36:39], v[8:11], a[0:7], v3
  buffer_load_dwordx4 v[28:31], v2, s[8:11], s23 offen offset:0 sc1
  v_cmp_eq_u32 vcc, -1, v8
  v_smfmac_f32_16x16x64_bf16 v[40:43], v[8:11], a[56:63], v3
  v_smfmac_f32_16x16x64_bf16 v[44:47], v[8:11], a[112:119], v3
  buffer_load_dwordx4 v[24:27], v2, s[8:11], s23 offen offset:1024 sc1
  s_cbranch_vccnz cA_sc1_r0
  v_smfmac_f32_16x16x64_bf16 v[48:51], v[8:11], a[168:175], v3
  v_smfmac_f32_16x16x64_bf16 v[52:55], v[8:11], a[224:231], v3
  s_waitcnt vmcnt(4)
  v_cmp_eq_u32 vcc, -1, v12
  v_smfmac_f32_16x16x64_bf16 v[56:59], v[8:11], v[144:151], v3
  buffer_load_dwordx4 v[32:35], v2, s[8:11], s23 offen offset:2048 sc1
  v_smfmac_f32_16x16x64_bf16 v[60:63], v[8:11], v[200:207], v3
  s_cbranch_vccnz cA_sc1_r1
cA_sc1_c1:
  v_smfmac_f32_16x16x64_bf16 v[36:39], v[12:15], a[8:15], v3
  v_smfmac_f32_16x16x64_bf16 v[40:43], v[12:15], a[64:71], v3
  v_smfmac_f32_16x16x64_bf16 v[44:47], v[12:15], a[120:127], v3
  v_smfmac_f32_16x16x64_bf16 v[48:51], v[12:15], a[176:183], v3
  v_smfmac_f32_16x16x64_bf16 v[52:55], v[12:15], a[232:239], v3
  s_waitcnt vmcnt(4)
  v_cmp_eq_u32 vcc, -1, v16
  v_smfmac_f32_16x16x64_bf16 v[56:59], v[12:15], v[152:159], v3
  buffer_load_dwordx4 v[88:91], v117, s[8:11], s26 offen offset:0 sc1
  v_smfmac_f32_16x16x64_bf16 v[60:63], v[12:15], v[208:215], v3
  s_cbranch_vccnz cA_sc1_r2
cA_sc1_c2:
  v_smfmac_f32_16x16x64_bf16 v[36:39], v[16:19], a[16:23], v3
  v_smfmac_f32_16x16x64_bf16 v[40:43], v[16:19], a[72:79], v3
  v_smfmac_f32_16x16x64_bf16 v[44:47], v[16:19], a[128:135], v3
  buffer_load_dwordx4 v[92:95], v117, s[8:11], s26 offen offset:1024 sc1
  v_smfmac_f32_16x16x64_bf16 v[48:51], v[16:19], a[184:191], v3
  v_smfmac_f32_16x16x64_bf16 v[52:55], v[16:19], a[240:247], v3
  s_waitcnt vmcnt(5)
  v_cmp_eq_u32 vcc, -1, v20
  v_smfmac_f32_16x16x64_bf16 v[56:59], v[16:19], v[160:167], v3
  v_smfmac_f32_16x16x64_bf16 v[60:63], v[16:19], v[216:223], v3
  buffer_load_dwordx4 v[96:99], v2, s[8:11], s24 offen offset:0 sc1
  s_cbranch_vccnz cA_sc1_r3
cA_sc1_c3:
  v_smfmac_f32_16x16x64_bf16 v[36:39], v[20:23], a[24:31], v3
  v_smfmac_f32_16x16x64_bf16 v[40:43], v[20:23], a[80:87], v3
  s_waitcnt vmcnt(3)
  v_max3_u32 v66, v24, v27, v28
  v_smfmac_f32_16x16x64_bf16 v[44:47], v[20:23], a[136:143], v3
  v_max3_u32 v66, v66, v31, v32
  v_smfmac_f32_16x16x64_bf16 v[48:51], v[20:23], a[192:199], v3
  buffer_load_dwordx4 v[100:103], v2, s[8:11], s24 offen offset:1024 sc1
  v_max_u32 v66, v66, v35
  v_smfmac_f32_16x16x64_bf16 v[52:55], v[20:23], a[248:255], v3
  v_cmp_eq_u32 vcc, -1, v66
  v_smfmac_f32_16x16x64_bf16 v[56:59], v[20:23], v[168:175], v3
  v_smfmac_f32_16x16x64_bf16 v[60:63], v[20:23], v[224:231], v3
  s_cbranch_vccnz cA_sc1_r4
cA_sc1_c4:
  v_smfmac_f32_16x16x64_bf16 v[60:63], v[28:31], v[232:239], v3
  buffer_load_dwordx4 v[104:107], v2, s[8:11], s26 offen offset:0 sc1
  v_smfmac_f32_16x16x64_bf16 v[60:63], v[24:27], v[240:247], v3
  v_smfmac_f32_16x16x64_bf16 v[60:63], v[32:35], v[248:255], v3
  v_smfmac_f32_16x16x64_bf16 v[52:55], v[28:31], v[120:127], v3
  v_smfmac_f32_16x16x64_bf16 v[52:55], v[24:27], v[128:135], v3
  buffer_load_dwordx4 v[108:111], v2, s[8:11], s26 offen offset:1024 sc1
  v_smfmac_f32_16x16x64_bf16 v[52:55], v[32:35], v[136:143], v3
  v_cvt_pk_bf16_f32 v63, v62, v63
  v_smfmac_f32_16x16x64_bf16 v[56:59], v[28:31], v[176:183], v3
  v_cvt_pk_bf16_f32 v62, v60, v61
  v_smfmac_f32_16x16x64_bf16 v[56:59], v[24:27], v[184:191], v3
  v_mfma_f32_16x16x32_bf16 v[8:11], v[62:65], v[4:7], 0
  v_cvt_pk_bf16_f32 v55, v54, v55
  v_smfmac_f32_16x16x64_bf16 v[56:59], v[32:35], v[192:199], v3
  v_cvt_pk_bf16_f32 v54, v52, v53
  v_smfmac_f32_16x16x64_bf16 v[36:39], v[28:31], a[32:39], v3
  s_nop 1
  v_cvt_pk_bf16_f32 v78, v8, v9
  v_smfmac_f32_16x16x64_bf16 v[36:39], v[24:27], a[40:47], v3
  v_cvt_pk_bf16_f32 v79, v10, v11
  v_smfmac_f32_16x16x64_bf16 v[36:39], v[32:35], a[48:55], v3
  v_cvt_pk_bf16_f32 v56, v56, v57
  v_smfmac_f32_16x16x64_bf16 v[40:43], v[28:31], a[88:95], v3
  v_cvt_pk_bf16_f32 v57, v58, v59
  v_smfmac_f32_16x16x64_bf16 v[40:43], v[24:27], a[96:103], v3
  v_mfma_f32_16x16x32_bf16 v[16:19], v[54:57], v[4:7], 0
  v_cvt_pk_bf16_f32 v39, v38, v39
  v_smfmac_f32_16x16x64_bf16 v[40:43], v[32:35], a[104:111], v3
  v_cvt_pk_bf16_f32 v38, v36, v37
  v_smfmac_f32_16x16x64_bf16 v[44:47], v[28:31], a[144:151], v3
  s_nop 1
  v_cvt_pk_bf16_f32 v76, v16, v17
  v_smfmac_f32_16x16x64_bf16 v[44:47], v[24:27], a[152:159], v3
  v_cvt_pk_bf16_f32 v77, v18, v19
  v_smfmac_f32_16x16x64_bf16 v[44:47], v[32:35], a[160:167], v3
  v_cvt_pk_bf16_f32 v40, v40, v41
  v_smfmac_f32_16x16x64_bf16 v[48:51], v[28:31], a[200:207], v3
  v_cvt_pk_bf16_f32 v41, v42, v43
  v_smfmac_f32_16x16x64_bf16 v[48:51], v[24:27], a[208:215], v3
  v_smfmac_f32_16x16x64_bf16 v[48:51], v[32:35], a[216:223], v3
  s_waitcnt vmcnt(4)
  v_cvt_pk_bf16_f32 v47, v46, v47
  v_smfmac_f32_16x16x64_bf16 v[68:71], v[76:79], v[80:87], v3
  v_cvt_pk_bf16_f32 v46, v44, v45
  v_mfma_f32_16x16x32_bf16 v[8:11], v[38:41], v[4:7], 0
  s_nop 1
  v_cvt_pk_bf16_f32 v48, v48, v49
  v_cvt_pk_bf16_f32 v49, v50, v51
  s_nop 1
  v_mfma_f32_16x16x32_bf16 v[16:19], v[46:49], v[4:7], 0
  v_smfmac_f32_16x16x64_bf16 v[72:75], v[76:79], v[88:95], v3
  v_cvt_pk_bf16_f32 v20, v8, v9
  v_mfma_f32_16x16x32_bf16 v[52:55], v[30:33], v[76:79], 0
  s_waitcnt vmcnt(0)
  v_cvt_pk_bf16_f32 v21, v10, v11
  v_cvt_pk_bf16_f32 v22, v16, v17
  v_cvt_pk_bf16_f32 v23, v18, v19
  s_nop 1
  v_mfma_f32_16x16x32_bf16 v[52:55], v[12:15], v[20:23], v[52:55]
  v_smfmac_f32_16x16x64_bf16 v[68:71], v[20:23], v[96:103], v3
  v_smfmac_f32_16x16x64_bf16 v[72:75], v[20:23], v[104:111], v3
  s_nop 1
  ds_write_b128 v113, v[52:55]
  s_nop 1
  v_permlane32_swap_b32 v68, v70
  v_permlane32_swap_b32 v69, v71
  v_add_f32 v56, v68, v70
  v_add_f32 v58, v69, v71
  v_permlane32_swap_b32 v72, v74
  v_permlane32_swap_b32 v73, v75
  v_add_f32 v57, v72, v74
  v_add_f32 v59, v73, v75
  ds_write_b128 v2, v[56:59] offset:1024
  v_cmp_u_f32 vcc, v57, v59
  v_mov_b32 v68, 0
  v_mov_b32 v69, 0
  v_mov_b32 v70, 0
  v_mov_b32 v71, 0
  s_cbranch_vccnz cA_sc1_retry
cA_sc1_cont:
  s_add_u32 s24, s24, 28672
  s_add_u32 s26, s26, 28672
  buffer_load_dwordx4 v[80:83], v117, s[8:11], s24 offen offset:0 sc1
  buffer_load_dwordx4 v[84:87], v117, s[8:11], s24 offen offset:1024 sc1
  v_mov_b32 v72, 0
  v_mov_b32 v73, 0
  v_mfma_f32_32x32x16_bf16 v[36:51], v[68:71], v[68:71], 0
  s_waitcnt lgkmcnt(0)
  s_barrier
  ds_read_b64 v[8:9], v114 offset:0
  ds_read_b64 v[10:11], v114 offset:1024
  ds_read_b64 v[12:13], v114 offset:2048
  ds_read_b64 v[14:15], v114 offset:3072
  ds_read2_b32 v[16:17], v115 offset0:0 offset1:64
  ds_read2_b32 v[18:19], v115 offset0:128 offset1:192
  v_mfma_f32_32x32x16_bf16 v[52:67], v[68:71], v[68:71], 0
  s_waitcnt lgkmcnt(0)
  v_pk_add_f32 v[16:17], v[16:17], v[18:19]
  v_pk_add_f32 v[8:9], v[8:9], v[10:11]
  v_pk_add_f32 v[12:13], v[12:13], v[14:15]
  v_add_f32 v20, v16, v17
  v_pk_add_f32 v[8:9], v[8:9], v[12:13]
  v_max_f32 v22, v8, v9
  v_add_f32_dpp v20, v20, v20 row_ror:8 row_mask:0xf bank_mask:0xf
  s_nop 0
  v_max_f32_dpp v22, v22, v22 row_ror:8 row_mask:0xf bank_mask:0xf
  v_max_f32 v22, v22, v20
  s_nop 1
  v_max_f32_dpp v22, v22, v22 quad_perm:[1,0,3,2] row_mask:0xf bank_mask:0xf
  s_nop 1
  v_max_f32_dpp v22, v22, v22 quad_perm:[2,3,0,1] row_mask:0xf bank_mask:0xf
  s_nop 1
  v_max_f32_dpp v22, v22, v22 row_half_mirror row_mask:0xf bank_mask:0xf
  v_pk_add_f32 v[8:9], v[8:9], v[22:23] op_sel_hi:[1,0] neg_lo:[0,1] neg_hi:[0,1]
  v_sub_f32 v20, v20, v22
  v_exp_f32 v8, v8
  v_exp_f32 v9, v9
  v_exp_f32 v20, v20
  buffer_store_dword v112, v116, s[8:11], 0 offen
  v_add_f32 v24, v8, v9
  v_fmac_f32 v24, 0.5, v20
  v_mov_b32_dpp v21, v20 quad_perm:[1,0,3,2] row_mask:0xf bank_mask:0xf
  s_nop 0
  v_add_f32_dpp v24, v24, v24 quad_perm:[1,0,3,2] row_mask:0xf bank_mask:0xf
  s_nop 1
  v_add_f32_dpp v24, v24, v24 quad_perm:[2,3,0,1] row_mask:0xf bank_mask:0xf
  s_nop 1
  v_add_f32_dpp v24, v24, v24 row_half_mirror row_mask:0xf bank_mask:0xf
  s_nop 1
  v_add_f32_dpp v24, v24, v24 row_ror:8 row_mask:0xf bank_mask:0xf
  v_rcp_f32 v24, v24
  s_nop 0
  v_pk_mul_f32 v[8:9], v[8:9], v[24:25] op_sel_hi:[1,0]
  v_pk_mul_f32 v[20:21], v[20:21], v[24:25] op_sel_hi:[1,0]
  v_cvt_pk_bf16_f32 v8, v8, v9
  v_cvt_pk_bf16_f32 v20, v20, v21
  v_min_u32 v8, -2, v8
  buffer_store_dword v8, v1, s[8:11], s20 offen
  v_min_u32 v20, -2, v20
  buffer_store_dword v20, v118, s[8:11], s20 offen
  buffer_store_dword v119, v1, s[8:11], s21 offen
  buffer_store_dword v119, v118, s[8:11], s21 offen
  v_mov_b32 v74, 0
  v_mov_b32 v75, 0
  s_mov_b32 s19, s18
  s_add_u32 s18, s18, 1
  s_mov_b32 s22, s20
  s_mov_b32 s20, s21
  s_mov_b32 s21, s22
  s_add_u32 s23, s20, 4096
  v_mov_b32 v112, s18
  s_cmp_lt_u32 s19, 63
  s_nop 0
  s_cbranch_scc1 cA_sc1_loop
  s_branch cA_done
cA_sc1_r0:
  s_add_u32 s31, s31, 1
  buffer_load_dwordx4 v[8:11], v2, s[8:11], s20 offen offset:0 sc1
  s_waitcnt vmcnt(0)
  v_cmp_eq_u32 vcc, -1, v8
  v_mov_b32 v36, 0
  v_mov_b32 v37, 0
  v_mov_b32 v38, 0
  v_mov_b32 v39, 0
  v_mov_b32 v40, 0
  v_mov_b32 v41, 0
  v_mov_b32 v42, 0
  v_mov_b32 v43, 0
  v_mov_b32 v44, 0
  v_mov_b32 v45, 0
  v_mov_b32 v46, 0
  v_mov_b32 v47, 0
  v_mov_b32 v48, 0
  v_mov_b32 v49, 0
  v_mov_b32 v50, 0
  v_mov_b32 v51, 0
  s_nop 1
  s_cbranch_vccz cA_sc1_go
  s_add_u32 s30, s30, 1
  s_cmp_lt_u32 s30, 400000
  s_cbranch_scc1 cA_sc1_r0
  s_branch cA_abort
cA_sc1_r1:
  s_add_u32 s31, s31, 1
  buffer_load_dwordx4 v[12:15], v2, s[8:11], s20 offen offset:1024 sc1
  s_waitcnt vmcnt(0)
  v_cmp_eq_u32 vcc, -1, v12
  s_nop 4
  s_cbranch_vccz cA_sc1_c1
  s_add_u32 s30, s30, 1
  s_cmp_lt_u32 s30, 400000
  s_cbranch_scc1 cA_sc1_r1
  s_branch cA_abort
cA_sc1_r2:
  s_add_u32 s31, s31, 1
  buffer_load_dwordx4 v[16:19], v2, s[8:11], s20 offen offset:2048 sc1
  s_waitcnt vmcnt(0)
  v_cmp_eq_u32 vcc, -1, v16
  s_nop 4
  s_cbranch_vccz cA_sc1_c2
  s_add_u32 s30, s30, 1
  s_cmp_lt_u32 s30, 400000
  s_cbranch_scc1 cA_sc1_r2
  s_branch cA_abort
cA_sc1_r3:
  s_add_u32 s31, s31, 1
  buffer_load_dwordx4 v[20:23], v2, s[8:11], s20 offen offset:3072 sc1
  s_waitcnt vmcnt(0)
  v_cmp_eq_u32 vcc, -1, v20
  s_nop 4
  s_cbranch_vccz cA_sc1_c3
  s_add_u32 s30, s30, 1
  s_cmp_lt_u32 s30, 400000
  s_cbranch_scc1 cA_sc1_r3
  s_branch cA_abort
cA_sc1_r4:
  s_add_u32 s31, s31, 1
  buffer_load_dwordx4 v[28:31], v2, s[8:11], s23 offen offset:0 sc1
  buffer_load_dwordx4 v[24:27], v2, s[8:11], s23 offen offset:1024 sc1
  buffer_load_dwordx4 v[32:35], v2, s[8:11], s23 offen offset:2048 sc1
  s_waitcnt vmcnt(0)
  v_max3_u32 v66, v24, v27, v28
  v_max3_u32 v66, v66, v31, v32
  v_max_u32 v66, v66, v35
  v_cmp_eq_u32 vcc, -1, v66
  s_nop 4
  s_cbranch_vccz cA_sc1_c4
  s_add_u32 s30, s30, 1
  s_cmp_lt_u32 s30, 400000
  s_cbranch_scc1 cA_sc1_r4
  s_branch cA_abort
cA_sc1_retry:
  s_cmp_lg_u32 s62, 0
  s_cbranch_scc1 cA_sc1_cont
  s_waitcnt vmcnt(0) lgkmcnt(0)
cA_sc1_rv:
  buffer_load_dwordx4 v[8:11], v2, s[8:11], s20 offen offset:0 sc1
  buffer_load_dwordx4 v[12:15], v2, s[8:11], s20 offen offset:1024 sc1
  buffer_load_dwordx4 v[16:19], v2, s[8:11], s20 offen offset:2048 sc1
  buffer_load_dwordx4 v[20:23], v2, s[8:11], s20 offen offset:3072 sc1
  buffer_load_dwordx4 v[28:31], v2, s[8:11], s23 offen offset:0 sc1
  buffer_load_dwordx4 v[24:27], v2, s[8:11], s23 offen offset:1024 sc1
  buffer_load_dwordx4 v[32:35], v2, s[8:11], s23 offen offset:2048 sc1
  s_waitcnt vmcnt(0)
  v_pk_max_u16 v66, v8, v9
  v_pk_max_u16 v66, v66, v10
  v_pk_max_u16 v66, v66, v11
  v_pk_max_u16 v66, v66, v12
  v_pk_max_u16 v66, v66, v13
  v_pk_max_u16 v66, v66, v14
  v_pk_max_u16 v66, v66, v15
  v_pk_max_u16 v66, v66, v16
  v_pk_max_u16 v66, v66, v17
  v_pk_max_u16 v66, v66, v18
  v_pk_max_u16 v66, v66, v19
  v_pk_max_u16 v66, v66, v20
  v_pk_max_u16 v66, v66, v21
  v_pk_max_u16 v66, v66, v22
  v_pk_max_u16 v66, v66, v23
  v_pk_max_u16 v66, v66, v24
  v_pk_max_u16 v66, v66, v25
  v_pk_max_u16 v66, v66, v26
  v_pk_max_u16 v66, v66, v27
  v_pk_max_u16 v66, v66, v28
  v_pk_max_u16 v66, v66, v29
  v_pk_max_u16 v66, v66, v30
  v_pk_max_u16 v66, v66, v31
  v_pk_max_u16 v66, v66, v32
  v_pk_max_u16 v66, v66, v33
  v_pk_max_u16 v66, v66, v34
  v_pk_max_u16 v66, v66, v35
  v_lshlrev_b32 v67, 16, v66
  v_max_u32 v66, v66, v67
  v_cmp_le_u32 vcc, 0xffff0000, v66
  s_cbranch_vccz cA_sc1_rk
  s_add_u32 s30, s30, 1
  s_cmp_lt_u32 s30, 400000
  s_cbranch_scc1 cA_sc1_rv
  s_branch cA_abort
cA_sc1_rk:
  s_mov_b32 s62, 1
  v_mov_b32 v36, 0
  v_mov_b32 v37, 0
  v_mov_b32 v38, 0
  v_mov_b32 v39, 0
  v_mov_b32 v40, 0
  v_mov_b32 v41, 0
  v_mov_b32 v42, 0
  v_mov_b32 v43, 0
  v_mov_b32 v44, 0
  v_mov_b32 v45, 0
  v_mov_b32 v46, 0
  v_mov_b32 v47, 0
  v_mov_b32 v48, 0
  v_mov_b32 v49, 0
  v_mov_b32 v50, 0
  v_mov_b32 v51, 0
  v_mov_b32 v60, 0
  v_mov_b32 v61, 0
  v_mov_b32 v62, 0
  v_mov_b32 v63, 0
  v_mov_b32 v68, 0
  v_mov_b32 v69, 0
  v_mov_b32 v70, 0
  v_mov_b32 v71, 0
  v_mov_b32 v72, 0
  v_mov_b32 v73, 0
  v_mov_b32 v74, 0
  v_mov_b32 v75, 0
  v_mov_b32 v52, 0
  v_mov_b32 v53, 0
  v_mov_b32 v54, 0
  v_mov_b32 v55, 0
  v_mov_b32 v56, 0
  v_mov_b32 v57, 0
  v_mov_b32 v58, 0
  v_mov_b32 v59, 0
  s_add_u32 s31, s31, 0x100
  s_nop 0
  s_branch cA_sc1_go
.p2align 6
cA_sc2_loop:
  s_mov_b32 s30, 0
  s_mov_b32 s62, 0
  s_setprio 3
  s_barrier
  buffer_load_dwordx4 v[8:11], v2, s[8:11], s20 offen offset:0 sc1
  s_setprio 2
  buffer_load_dwordx4 v[12:15], v2, s[8:11], s20 offen offset:1024 sc1
  s_setprio 1
  buffer_load_dwordx4 v[16:19], v2, s[8:11], s20 offen offset:2048 sc1
  s_setprio 0
  buffer_load_dwordx4 v[20:23], v2, s[8:11], s20 offen offset:3072 sc1
cA_sc2_go:
  s_waitcnt vmcnt(3)
  v_smfmac_f32_16x16x64_bf16 v[36:39], v[8:11], a[0:7], v3
  buffer_load_dwordx4 v[24:27], v2, s[8:11], s23 offen offset:0 sc1
  v_cmp_eq_u32 vcc, -1, v8
  v_smfmac_f32_16x16x64_bf16 v[40:43], v[8:11], a[56:63], v3
  v_smfmac_f32_16x16x64_bf16 v[44:47], v[8:11], a[112:119], v3
  buffer_load_dwordx4 v[32:35], v2, s[8:11], s23 offen offset:1024 sc1
  s_cbranch_vccnz cA_sc2_r0
  v_smfmac_f32_16x16x64_bf16 v[48:51], v[8:11], a[168:175], v3
  v_smfmac_f32_16x16x64_bf16 v[52:55], v[8:11], a[224:231], v3
  s_waitcnt vmcnt(4)
  v_cmp_eq_u32 vcc, -1, v12
  v_smfmac_f32_16x16x64_bf16 v[56:59], v[8:11], v[144:151], v3
  buffer_load_dwordx4 v[28:31], v2, s[8:11], s23 offen offset:2048 sc1
  v_smfmac_f32_16x16x64_bf16 v[62:65], v[8:11], v[200:207], v3
  s_cbranch_vccnz cA_sc2_r1
cA_sc2_c1:
  v_smfmac_f32_16x16x64_bf16 v[36:39], v[12:15], a[8:15], v3
  v_smfmac_f32_16x16x64_bf16 v[40:43], v[12:15], a[64:71], v3
  v_smfmac_f32_16x16x64_bf16 v[44:47], v[12:15], a[120:127], v3
  v_smfmac_f32_16x16x64_bf16 v[48:51], v[12:15], a[176:183], v3
  v_smfmac_f32_16x16x64_bf16 v[52:55], v[12:15], a[232:239], v3
  s_waitcnt vmcnt(4)
  v_cmp_eq_u32 vcc, -1, v16
  v_smfmac_f32_16x16x64_bf16 v[56:59], v[12:15], v[152:159], v3
  buffer_load_dwordx4 v[88:91], v117, s[8:11], s26 offen offset:0 sc1
  v_smfmac_f32_16x16x64_bf16 v[62:65], v[12:15], v[208:215], v3
  s_cbranch_vccnz cA_sc2_r2
cA_sc2_c2:
  v_smfmac_f32_16x16x64_bf16 v[36:39], v[16:19], a[16:23], v3
  v_smfmac_f32_16x16x64_bf16 v[40:43], v[16:19], a[72:79], v3
  v_smfmac_f32_16x16x64_bf16 v[44:47], v[16:19], a[128:135], v3
  buffer_load_dwordx4 v[92:95], v117, s[8:11], s26 offen offset:1024 sc1
  v_smfmac_f32_16x16x64_bf16 v[48:51], v[16:19], a[184:191], v3
  v_smfmac_f32_16x16x64_bf16 v[52:55], v[16:19], a[240:247], v3
  s_waitcnt vmcnt(5)
  v_cmp_eq_u32 vcc, -1, v20
  v_smfmac_f32_16x16x64_bf16 v[56:59], v[16:19], v[160:167], v3
  v_smfmac_f32_16x16x64_bf16 v[62:65], v[16:19], v[216:223], v3
  buffer_load_dwordx4 v[96:99], v2, s[8:11], s24 offen offset:0 sc1
  s_cbranch_vccnz cA_sc2_r3
cA_sc2_c3:
  v_smfmac_f32_16x16x64_bf16 v[36:39], v[20:23], a[24:31], v3
  v_smfmac_f32_16x16x64_bf16 v[40:43], v[20:23], a[80:87], v3
  s_waitcnt vmcnt(3)
  v_max3_u32 v66, v24, v27, v28
  v_smfmac_f32_16x16x64_bf16 v[44:47], v[20:23], a[136:143], v3
  v_max3_u32 v66, v66, v31, v32
  v_smfmac_f32_16x16x64_bf16 v[48:51], v[20:23], a[192:199], v3
  buffer_load_dwordx4 v[100:103], v2, s[8:11], s24 offen offset:1024 sc1
  v_max_u32 v66, v66, v35
  v_smfmac_f32_16x16x64_bf16 v[52:55], v[20:23], a[248:255], v3
  v_cmp_eq_u32 vcc, -1, v66
  v_smfmac_f32_16x16x64_bf16 v[56:59], v[20:23], v[168:175], v3
  v_smfmac_f32_16x16x64_bf16 v[62:65], v[20:23], v[224:231], v3
  s_cbranch_vccnz cA_sc2_r4
cA_sc2_c4:
  v_smfmac_f32_16x16x64_bf16 v[62:65], v[24:27], v[232:239], v3
  buffer_load_dwordx4 v[104:107], v2, s[8:11], s26 offen offset:0 sc1
  v_smfmac_f32_16x16x64_bf16 v[62:65], v[32:35], v[240:247], v3
  v_smfmac_f32_16x16x64_bf16 v[62:65], v[28:31], v[248:255], v3
  v_smfmac_f32_16x16x64_bf16 v[52:55], v[24:27], v[120:127], v3
  v_smfmac_f32_16x16x64_bf16 v[52:55], v[32:35], v[128:135], v3
  buffer_load_dwordx4 v[108:111], v2, s[8:11], s26 offen offset:1024 sc1
  v_smfmac_f32_16x16x64_bf16 v[52:55], v[28:31], v[136:143], v3
  v_cvt_pk_bf16_f32 v62, v62, v63
  v_smfmac_f32_16x16x64_bf16 v[56:59], v[24:27], v[176:183], v3
  v_cvt_pk_bf16_f32 v63, v64, v65
  v_smfmac_f32_16x16x64_bf16 v[56:59], v[32:35], v[184:191], v3
  v_mfma_f32_16x16x32_bf16 v[8:11], v[60:63], v[4:7], 0
  v_cvt_pk_bf16_f32 v55, v54, v55
  v_smfmac_f32_16x16x64_bf16 v[56:59], v[28:31], v[192:199], v3
  v_cvt_pk_bf16_f32 v54, v52, v53
  v_smfmac_f32_16x16x64_bf16 v[36:39], v[24:27], a[32:39], v3
  s_nop 1
  v_cvt_pk_bf16_f32 v76, v8, v9
  v_smfmac_f32_16x16x64_bf16 v[36:39], v[32:35], a[40:47], v3
  v_cvt_pk_bf16_f32 v77, v10, v11
  v_smfmac_f32_16x16x64_bf16 v[36:39], v[28:31], a[48:55], v3
  v_cvt_pk_bf16_f32 v56, v56, v57
  v_smfmac_f32_16x16x64_bf16 v[40:43], v[24:27], a[88:95], v3
  v_cvt_pk_bf16_f32 v57, v58, v59
  v_smfmac_f32_16x16x64_bf16 v[40:43], v[32:35], a[96:103], v3
  v_mfma_f32_16x16x32_bf16 v[12:15], v[54:57], v[4:7], 0
  v_cvt_pk_bf16_f32 v39, v38, v39
  v_smfmac_f32_16x16x64_bf16 v[40:43], v[28:31], a[104:111], v3
  v_cvt_pk_bf16_f32 v38, v36, v37
  v_smfmac_f32_16x16x64_bf16 v[44:47], v[24:27], a[144:151], v3
  s_nop 1
  v_cvt_pk_bf16_f32 v78, v12, v13
  v_smfmac_f32_16x16x64_bf16 v[44:47], v[32:35], a[152:159], v3
  v_cvt_pk_bf16_f32 v79, v14, v15
  v_smfmac_f32_16x16x64_bf16 v[44:47], v[28:31], a[160:167], v3
  v_cvt_pk_bf16_f32 v40, v40, v41
  v_smfmac_f32_16x16x64_bf16 v[48:51], v[24:27], a[200:207], v3
  v_cvt_pk_bf16_f32 v41, v42, v43
  v_smfmac_f32_16x16x64_bf16 v[48:51], v[32:35], a[208:215], v3
  v_smfmac_f32_16x16x64_bf16 v[48:51], v[28:31], a[216:223], v3
  s_waitcnt vmcnt(4)
  v_cvt_pk_bf16_f32 v47, v46, v47
  v_smfmac_f32_16x16x64_bf16 v[68:71], v[76:79], v[80:87], v3
  v_cvt_pk_bf16_f32 v46, v44, v45
  v_mfma_f32_16x16x32_bf16 v[8:11], v[38:41], v[4:7], 0
  s_nop 1
  v_cvt_pk_bf16_f32 v48, v48, v49
  v_cvt_pk_bf16_f32 v49, v50, v51
  s_nop 1
  v_mfma_f32_16x16x32_bf16 v[12:15], v[46:49], v[4:7], 0
  v_smfmac_f32_16x16x64_bf16 v[72:75], v[76:79], v[88:95], v3
  v_cvt_pk_bf16_f32 v20, v8, v9
  v_mfma_f32_16x16x32_bf16 v[52:55], v[30:33], v[76:79], 0
  s_waitcnt vmcnt(0)
  v_cvt_pk_bf16_f32 v21, v10, v11
  v_cvt_pk_bf16_f32 v22, v12, v13
  v_cvt_pk_bf16_f32 v23, v14, v15
  s_nop 1
  v_mfma_f32_16x16x32_bf16 v[52:55], v[16:19], v[20:23], v[52:55]
  v_smfmac_f32_16x16x64_bf16 v[68:71], v[20:23], v[96:103], v3
  v_smfmac_f32_16x16x64_bf16 v[72:75], v[20:23], v[104:111], v3
  s_nop 1
  ds_write_b128 v113, v[52:55]
  s_nop 1
  v_permlane32_swap_b32 v68, v70
  v_permlane32_swap_b32 v69, v71
  v_add_f32 v56, v68, v70
  v_add_f32 v58, v69, v71
  v_permlane32_swap_b32 v72, v74
  v_permlane32_swap_b32 v73, v75
  v_add_f32 v57, v72, v74
  v_add_f32 v59, v73, v75
  ds_write_b128 v2, v[56:59] offset:2048
  v_cmp_u_f32 vcc, v57, v59
  v_mov_b32 v68, 0
  v_mov_b32 v69, 0
  v_mov_b32 v70, 0
  v_mov_b32 v71, 0
  s_cbranch_vccnz cA_sc2_retry
cA_sc2_cont:
  s_add_u32 s24, s24, 28672
  s_add_u32 s26, s26, 28672
  buffer_load_dwordx4 v[80:83], v117, s[8:11], s24 offen offset:0 sc1
  buffer_load_dwordx4 v[84:87], v117, s[8:11], s24 offen offset:1024 sc1
  v_mov_b32 v72, 0
  v_mov_b32 v73, 0
  v_mfma_f32_32x32x16_bf16 v[36:51], v[68:71], v[68:71], 0
  s_waitcnt lgkmcnt(0)
  s_barrier
  v_mfma_f32_32x32x16_bf16 v[52:67], v[68:71], v[68:71], 0
  s_buffer_load_dword s70, s[8:11], s35
  s_add_u32 s22, s24, 114688
  s_buffer_load_dword s71, s[8:11], s22
  s_mul_i32 s22, s18, 7168
  s_add_u32 s22, s22, 88024064
  s_buffer_load_dword s72, s[8:11], s22
  s_add_u32 s35, s35, 458752
  v_mov_b32 v74, 0
  v_mov_b32 v75, 0
  s_mov_b32 s19, s18
  s_add_u32 s18, s18, 1
  s_mov_b32 s22, s20
  s_mov_b32 s20, s21
  s_mov_b32 s21, s22
  s_add_u32 s23, s20, 4096
  s_cmp_lt_u32 s19, 63
  s_cbranch_scc1 cA_sc2_loop
  s_branch cA_done
cA_sc2_r0:
  s_add_u32 s31, s31, 1
  buffer_load_dwordx4 v[8:11], v2, s[8:11], s20 offen offset:0 sc1
  s_waitcnt vmcnt(0)
  v_cmp_eq_u32 vcc, -1, v8
  v_mov_b32 v36, 0
  v_mov_b32 v37, 0
  v_mov_b32 v38, 0
  v_mov_b32 v39, 0
  v_mov_b32 v40, 0
  v_mov_b32 v41, 0
  v_mov_b32 v42, 0
  v_mov_b32 v43, 0
  v_mov_b32 v44, 0
  v_mov_b32 v45, 0
  v_mov_b32 v46, 0
  v_mov_b32 v47, 0
  v_mov_b32 v48, 0
  v_mov_b32 v49, 0
  v_mov_b32 v50, 0
  v_mov_b32 v51, 0
  s_nop 1
  s_cbranch_vccz cA_sc2_go
  s_add_u32 s30, s30, 1
  s_cmp_lt_u32 s30, 400000
  s_cbranch_scc1 cA_sc2_r0
  s_branch cA_abort
cA_sc2_r1:
  s_add_u32 s31, s31, 1
  buffer_load_dwordx4 v[12:15], v2, s[8:11], s20 offen offset:1024 sc1
  s_waitcnt vmcnt(0)
  v_cmp_eq_u32 vcc, -1, v12
  s_nop 4
  s_cbranch_vccz cA_sc2_c1
  s_add_u32 s30, s30, 1
  s_cmp_lt_u32 s30, 400000
  s_cbranch_scc1 cA_sc2_r1
  s_branch cA_abort
cA_sc2_r2:
  s_add_u32 s31, s31, 1
  buffer_load_dwordx4 v[16:19], v2, s[8:11], s20 offen offset:2048 sc1
  s_waitcnt vmcnt(0)
  v_cmp_eq_u32 vcc, -1, v16
  s_nop 4
  s_cbranch_vccz cA_sc2_c2
  s_add_u32 s30, s30, 1
  s_cmp_lt_u32 s30, 400000
  s_cbranch_scc1 cA_sc2_r2
  s_branch cA_abort
cA_sc2_r3:
  s_add_u32 s31, s31, 1
  buffer_load_dwordx4 v[20:23], v2, s[8:11], s20 offen offset:3072 sc1
  s_waitcnt vmcnt(0)
  v_cmp_eq_u32 vcc, -1, v20
  s_nop 4
  s_cbranch_vccz cA_sc2_c3
  s_add_u32 s30, s30, 1
  s_cmp_lt_u32 s30, 400000
  s_cbranch_scc1 cA_sc2_r3
  s_branch cA_abort
cA_sc2_r4:
  s_add_u32 s31, s31, 1
  buffer_load_dwordx4 v[24:27], v2, s[8:11], s23 offen offset:0 sc1
  buffer_load_dwordx4 v[32:35], v2, s[8:11], s23 offen offset:1024 sc1
  buffer_load_dwordx4 v[28:31], v2, s[8:11], s23 offen offset:2048 sc1
  s_waitcnt vmcnt(0)
  v_max3_u32 v66, v24, v27, v28
  v_max3_u32 v66, v66, v31, v32
  v_max_u32 v66, v66, v35
  v_cmp_eq_u32 vcc, -1, v66
  s_nop 4
  s_cbranch_vccz cA_sc2_c4
  s_add_u32 s30, s30, 1
  s_cmp_lt_u32 s30, 400000
  s_cbranch_scc1 cA_sc2_r4
  s_branch cA_abort
cA_sc2_retry:
  s_cmp_lg_u32 s62, 0
  s_cbranch_scc1 cA_sc2_cont
  s_waitcnt vmcnt(0) lgkmcnt(0)
cA_sc2_rv:
  buffer_load_dwordx4 v[8:11], v2, s[8:11], s20 offen offset:0 sc1
  buffer_load_dwordx4 v[12:15], v2, s[8:11], s20 offen offset:1024 sc1
  buffer_load_dwordx4 v[16:19], v2, s[8:11], s20 offen offset:2048 sc1
  buffer_load_dwordx4 v[20:23], v2, s[8:11], s20 offen offset:3072 sc1
  buffer_load_dwordx4 v[24:27], v2, s[8:11], s23 offen offset:0 sc1
  buffer_load_dwordx4 v[32:35], v2, s[8:11], s23 offen offset:1024 sc1
  buffer_load_dwordx4 v[28:31], v2, s[8:11], s23 offen offset:2048 sc1
  s_waitcnt vmcnt(0)
  v_pk_max_u16 v66, v8, v9
  v_pk_max_u16 v66, v66, v10
  v_pk_max_u16 v66, v66, v11
  v_pk_max_u16 v66, v66, v12
  v_pk_max_u16 v66, v66, v13
  v_pk_max_u16 v66, v66, v14
  v_pk_max_u16 v66, v66, v15
  v_pk_max_u16 v66, v66, v16
  v_pk_max_u16 v66, v66, v17
  v_pk_max_u16 v66, v66, v18
  v_pk_max_u16 v66, v66, v19
  v_pk_max_u16 v66, v66, v20
  v_pk_max_u16 v66, v66, v21
  v_pk_max_u16 v66, v66, v22
  v_pk_max_u16 v66, v66, v23
  v_pk_max_u16 v66, v66, v24
  v_pk_max_u16 v66, v66, v25
  v_pk_max_u16 v66, v66, v26
  v_pk_max_u16 v66, v66, v27
  v_pk_max_u16 v66, v66, v28
  v_pk_max_u16 v66, v66, v29
  v_pk_max_u16 v66, v66, v30
  v_pk_max_u16 v66, v66, v31
  v_pk_max_u16 v66, v66, v32
  v_pk_max_u16 v66, v66, v33
  v_pk_max_u16 v66, v66, v34
  v_pk_max_u16 v66, v66, v35
  v_lshlrev_b32 v67, 16, v66
  v_max_u32 v66, v66, v67
  v_cmp_le_u32 vcc, 0xffff0000, v66
  s_cbranch_vccz cA_sc2_rk
  s_add_u32 s30, s30, 1
  s_cmp_lt_u32 s30, 400000
  s_cbranch_scc1 cA_sc2_rv
  s_branch cA_abort
cA_sc2_rk:
  s_mov_b32 s62, 1
  v_mov_b32 v36, 0
  v_mov_b32 v37, 0
  v_mov_b32 v38, 0
  v_mov_b32 v39, 0
  v_mov_b32 v40, 0
  v_mov_b32 v41, 0
  v_mov_b32 v42, 0
  v_mov_b32 v43, 0
  v_mov_b32 v44, 0
  v_mov_b32 v45, 0
  v_mov_b32 v46, 0
  v_mov_b32 v47, 0
  v_mov_b32 v48, 0
  v_mov_b32 v49, 0
  v_mov_b32 v50, 0
  v_mov_b32 v51, 0
  v_mov_b32 v62, 0
  v_mov_b32 v63, 0
  v_mov_b32 v64, 0
  v_mov_b32 v65, 0
  v_mov_b32 v68, 0
  v_mov_b32 v69, 0
  v_mov_b32 v70, 0
  v_mov_b32 v71, 0
  v_mov_b32 v72, 0
  v_mov_b32 v73, 0
  v_mov_b32 v74, 0
  v_mov_b32 v75, 0
  v_mov_b32 v52, 0
  v_mov_b32 v53, 0
  v_mov_b32 v54, 0
  v_mov_b32 v55, 0
  v_mov_b32 v56, 0
  v_mov_b32 v57, 0
  v_mov_b32 v58, 0
  v_mov_b32 v59, 0
  s_add_u32 s31, s31, 0x100
  s_nop 0
  s_branch cA_sc2_go
.p2align 6
cA_sc3_loop:
  s_mov_b32 s30, 0
  s_mov_b32 s62, 0
  s_setprio 3
  s_barrier
  buffer_load_dwordx4 v[8:11], v2, s[8:11], s20 offen offset:0 sc1
  s_setprio 2
  buffer_load_dwordx4 v[12:15], v2, s[8:11], s20 offen offset:1024 sc1
  s_setprio 1
  buffer_load_dwordx4 v[16:19], v2, s[8:11], s20 offen offset:2048 sc1
  s_setprio 0
  buffer_load_dwordx4 v[20:23], v2, s[8:11], s20 offen offset:3072 sc1
cA_sc3_go:
  s_waitcnt vmcnt(3)
  v_smfmac_f32_16x16x64_bf16 v[36:39], v[8:11], a[0:7], v3
  buffer_load_dwordx4 v[24:27], v2, s[8:11], s23 offen offset:0 sc1
  v_cmp_eq_u32 vcc, -1, v8
  v_smfmac_f32_16x16x64_bf16 v[40:43], v[8:11], a[56:63], v3
  v_smfmac_f32_16x16x64_bf16 v[44:47], v[8:11], a[112:119], v3
  buffer_load_dwordx4 v[28:31], v2, s[8:11], s23 offen offset:1024 sc1
  s_cbranch_vccnz cA_sc3_r0
  v_smfmac_f32_16x16x64_bf16 v[48:51], v[8:11], a[168:175], v3
  v_smfmac_f32_16x16x64_bf16 v[52:55], v[8:11], a[224:231], v3
  s_waitcnt vmcnt(4)
  v_cmp_eq_u32 vcc, -1, v12
  v_smfmac_f32_16x16x64_bf16 v[56:59], v[8:11], v[144:151], v3
  buffer_load_dwordx4 v[32:35], v2, s[8:11], s23 offen offset:2048 sc1
  v_smfmac_f32_16x16x64_bf16 v[62:65], v[8:11], v[200:207], v3
  s_cbranch_vccnz cA_sc3_r1
cA_sc3_c1:
  v_smfmac_f32_16x16x64_bf16 v[36:39], v[12:15], a[8:15], v3
  v_smfmac_f32_16x16x64_bf16 v[40:43], v[12:15], a[64:71], v3
  v_smfmac_f32_16x16x64_bf16 v[44:47], v[12:15], a[120:127], v3
  v_smfmac_f32_16x16x64_bf16 v[48:51], v[12:15], a[176:183], v3
  v_smfmac_f32_16x16x64_bf16 v[52:55], v[12:15], a[232:239], v3
  s_waitcnt vmcnt(4)
  v_cmp_eq_u32 vcc, -1, v16
  v_smfmac_f32_16x16x64_bf16 v[56:59], v[12:15], v[152:159], v3
  buffer_load_dwordx4 v[88:91], v117, s[8:11], s26 offen offset:0 sc1
  v_smfmac_f32_16x16x64_bf16 v[62:65], v[12:15], v[208:215], v3
  s_cbranch_vccnz cA_sc3_r2
cA_sc3_c2:
  v_smfmac_f32_16x16x64_bf16 v[36:39], v[16:19], a[16:23], v3
  v_smfmac_f32_16x16x64_bf16 v[40:43], v[16:19], a[72:79], v3
  v_smfmac_f32_16x16x64_bf16 v[44:47], v[16:19], a[128:135], v3
  buffer_load_dwordx4 v[92:95], v117, s[8:11], s26 offen offset:1024 sc1
  v_smfmac_f32_16x16x64_bf16 v[48:51], v[16:19], a[184:191], v3
  v_smfmac_f32_16x16x64_bf16 v[52:55], v[16:19], a[240:247], v3
  s_waitcnt vmcnt(5)
  v_cmp_eq_u32 vcc, -1, v20
  v_smfmac_f32_16x16x64_bf16 v[56:59], v[16:19], v[160:167], v3
  v_smfmac_f32_16x16x64_bf16 v[62:65], v[16:19], v[216:223], v3
  buffer_load_dwordx4 v[96:99], v2, s[8:11], s24 offen offset:0 sc1
  s_cbranch_vccnz cA_sc3_r3
cA_sc3_c3:
  v_smfmac_f32_16x16x64_bf16 v[36:39], v[20:23], a[24:31], v3
  v_smfmac_f32_16x16x64_bf16 v[40:43], v[20:23], a[80:87], v3
  s_waitcnt vmcnt(3)
  v_max3_u32 v66, v24, v27, v28
  v_smfmac_f32_16x16x64_bf16 v[44:47], v[20:23], a[136:143], v3
  v_max3_u32 v66, v66, v31, v32
  v_smfmac_f32_16x16x64_bf16 v[48:51], v[20:23], a[192:199], v3
  buffer_load_dwordx4 v[100:103], v2, s[8:11], s24 offen offset:1024 sc1
  v_max_u32 v66, v66, v35
  v_smfmac_f32_16x16x64_bf16 v[52:55], v[20:23], a[248:255], v3
  v_cmp_eq_u32 vcc, -1, v66
  v_smfmac_f32_16x16x64_bf16 v[56:59], v[20:23], v[168:175], v3
  v_smfmac_f32_16x16x64_bf16 v[62:65], v[20:23], v[224:231], v3
  s_cbranch_vccnz cA_sc3_r4
cA_sc3_c4:
  v_smfmac_f32_16x16x64_bf16 v[62:65], v[24:27], v[232:239], v3
  buffer_load_dwordx4 v[104:107], v2, s[8:11], s26 offen offset:0 sc1
  v_smfmac_f32_16x16x64_bf16 v[62:65], v[28:31], v[240:247], v3
  v_smfmac_f32_16x16x64_bf16 v[62:65], v[32:35], v[248:255], v3
  v_smfmac_f32_16x16x64_bf16 v[52:55], v[24:27], v[120:127], v3
  v_smfmac_f32_16x16x64_bf16 v[52:55], v[28:31], v[128:135], v3
  buffer_load_dwordx4 v[108:111], v2, s[8:11], s26 offen offset:1024 sc1
  v_smfmac_f32_16x16x64_bf16 v[52:55], v[32:35], v[136:143], v3
  v_cvt_pk_bf16_f32 v62, v62, v63
  v_smfmac_f32_16x16x64_bf16 v[56:59], v[24:27], v[176:183], v3
  v_cvt_pk_bf16_f32 v63, v64, v65
  v_smfmac_f32_16x16x64_bf16 v[56:59], v[28:31], v[184:191], v3
  v_mfma_f32_16x16x32_bf16 v[8:11], v[60:63], v[4:7], 0
  v_cvt_pk_bf16_f32 v55, v54, v55
  v_smfmac_f32_16x16x64_bf16 v[56:59], v[32:35], v[192:199], v3
  v_cvt_pk_bf16_f32 v54, v52, v53
  v_smfmac_f32_16x16x64_bf16 v[36:39], v[24:27], a[32:39], v3
  s_nop 1
  v_cvt_pk_bf16_f32 v78, v8, v9
  v_smfmac_f32_16x16x64_bf16 v[36:39], v[28:31], a[40:47], v3
  v_cvt_pk_bf16_f32 v79, v10, v11
  v_smfmac_f32_16x16x64_bf16 v[36:39], v[32:35], a[48:55], v3
  v_cvt_pk_bf16_f32 v56, v56, v57
  v_smfmac_f32_16x16x64_bf16 v[40:43], v[24:27], a[88:95], v3
  v_cvt_pk_bf16_f32 v57, v58, v59
  v_smfmac_f32_16x16x64_bf16 v[40:43], v[28:31], a[96:103], v3
  v_mfma_f32_16x16x32_bf16 v[12:15], v[54:57], v[4:7], 0
  v_cvt_pk_bf16_f32 v39, v38, v39
  v_smfmac_f32_16x16x64_bf16 v[40:43], v[32:35], a[104:111], v3
  v_cvt_pk_bf16_f32 v38, v36, v37
  v_smfmac_f32_16x16x64_bf16 v[44:47], v[24:27], a[144:151], v3
  s_nop 1
  v_cvt_pk_bf16_f32 v76, v12, v13
  v_smfmac_f32_16x16x64_bf16 v[44:47], v[28:31], a[152:159], v3
  v_cvt_pk_bf16_f32 v77, v14, v15
  v_smfmac_f32_16x16x64_bf16 v[44:47], v[32:35], a[160:167], v3
  v_cvt_pk_bf16_f32 v40, v40, v41
  v_smfmac_f32_16x16x64_bf16 v[48:51], v[24:27], a[200:207], v3
  v_cvt_pk_bf16_f32 v41, v42, v43
  v_smfmac_f32_16x16x64_bf16 v[48:51], v[28:31], a[208:215], v3
  v_smfmac_f32_16x16x64_bf16 v[48:51], v[32:35], a[216:223], v3
  s_waitcnt vmcnt(4)
  v_cvt_pk_bf16_f32 v47, v46, v47
  v_smfmac_f32_16x16x64_bf16 v[68:71], v[76:79], v[80:87], v3
  v_cvt_pk_bf16_f32 v46, v44, v45
  v_mfma_f32_16x16x32_bf16 v[8:11], v[38:41], v[4:7], 0
  s_nop 1
  v_cvt_pk_bf16_f32 v48, v48, v49
  v_cvt_pk_bf16_f32 v49, v50, v51
  s_nop 1
  v_mfma_f32_16x16x32_bf16 v[12:15], v[46:49], v[4:7], 0
  v_smfmac_f32_16x16x64_bf16 v[72:75], v[76:79], v[88:95], v3
  v_cvt_pk_bf16_f32 v16, v8, v9
  v_mfma_f32_16x16x32_bf16 v[52:55], v[30:33], v[76:79], 0
  s_waitcnt vmcnt(0)
  v_cvt_pk_bf16_f32 v17, v10, v11
  v_cvt_pk_bf16_f32 v18, v12, v13
  v_cvt_pk_bf16_f32 v19, v14, v15
  s_nop 1
  v_mfma_f32_16x16x32_bf16 v[52:55], v[20:23], v[16:19], v[52:55]
  v_smfmac_f32_16x16x64_bf16 v[68:71], v[16:19], v[96:103], v3
  v_smfmac_f32_16x16x64_bf16 v[72:75], v[16:19], v[104:111], v3
  s_nop 1
  ds_write_b128 v113, v[52:55]
  s_nop 1
  v_permlane32_swap_b32 v68, v70
  v_permlane32_swap_b32 v69, v71
  v_add_f32 v56, v68, v70
  v_add_f32 v58, v69, v71
  v_permlane32_swap_b32 v72, v74
  v_permlane32_swap_b32 v73, v75
  v_add_f32 v57, v72, v74
  v_add_f32 v59, v73, v75
  ds_write_b128 v2, v[56:59] offset:3072
  v_cmp_u_f32 vcc, v57, v59
  v_mov_b32 v68, 0
  v_mov_b32 v69, 0
  v_mov_b32 v70, 0
  v_mov_b32 v71, 0
  s_cbranch_vccnz cA_sc3_retry
cA_sc3_cont:
  s_add_u32 s24, s24, 28672
  s_add_u32 s26, s26, 28672
  buffer_load_dwordx4 v[80:83], v117, s[8:11], s24 offen offset:0 sc1
  buffer_load_dwordx4 v[84:87], v117, s[8:11], s24 offen offset:1024 sc1
  v_mov_b32 v72, 0
  v_mov_b32 v73, 0
  v_mfma_f32_16x16x32_bf16 v[62:65], v[68:71], v[68:71], 0
  s_waitcnt lgkmcnt(0)
  s_barrier
  v_mov_b32 v52, 0
  v_mov_b32 v53, 0
  v_mov_b32 v54, 0
  v_mov_b32 v55, 0
  v_mov_b32 v56, 0
  v_mov_b32 v57, 0
  v_mov_b32 v58, 0
  v_mov_b32 v59, 0
  v_mfma_f32_32x32x16_bf16 v[36:51], v[68:71], v[68:71], 0
  v_mov_b32 v74, 0
  v_mov_b32 v75, 0
  s_mov_b32 s19, s18
  s_add_u32 s18, s18, 1
  s_mov_b32 s22, s20
  s_mov_b32 s20, s21
  s_mov_b32 s21, s22
  s_add_u32 s23, s20, 4096
  s_cmp_lt_u32 s19, 63
  s_nop 2
  s_cbranch_scc1 cA_sc3_loop
  s_branch cA_done
cA_sc3_r0:
  s_add_u32 s31, s31, 1
  buffer_load_dwordx4 v[8:11], v2, s[8:11], s20 offen offset:0 sc1
  s_waitcnt vmcnt(0)
  v_cmp_eq_u32 vcc, -1, v8
  v_mov_b32 v36, 0
  v_mov_b32 v37, 0
  v_mov_b32 v38, 0
  v_mov_b32 v39, 0
  v_mov_b32 v40, 0
  v_mov_b32 v41, 0
  v_mov_b32 v42, 0
  v_mov_b32 v43, 0
  v_mov_b32 v44, 0
  v_mov_b32 v45, 0
  v_mov_b32 v46, 0
  v_mov_b32 v47, 0
  v_mov_b32 v48, 0
  v_mov_b32 v49, 0
  v_mov_b32 v50, 0
  v_mov_b32 v51, 0
  s_nop 1
  s_cbranch_vccz cA_sc3_go
  s_add_u32 s30, s30, 1
  s_cmp_lt_u32 s30, 400000
  s_cbranch_scc1 cA_sc3_r0
  s_branch cA_abort
cA_sc3_r1:
  s_add_u32 s31, s31, 1
  buffer_load_dwordx4 v[12:15], v2, s[8:11], s20 offen offset:1024 sc1
  s_waitcnt vmcnt(0)
  v_cmp_eq_u32 vcc, -1, v12
  s_nop 4
  s_cbranch_vccz cA_sc3_c1
  s_add_u32 s30, s30, 1
  s_cmp_lt_u32 s30, 400000
  s_cbranch_scc1 cA_sc3_r1
  s_branch cA_abort
cA_sc3_r2:
  s_add_u32 s31, s31, 1
  buffer_load_dwordx4 v[16:19], v2, s[8:11], s20 offen offset:2048 sc1
  s_waitcnt vmcnt(0)
  v_cmp_eq_u32 vcc, -1, v16
  s_nop 4
  s_cbranch_vccz cA_sc3_c2
  s_add_u32 s30, s30, 1
  s_cmp_lt_u32 s30, 400000
  s_cbranch_scc1 cA_sc3_r2
  s_branch cA_abort
cA_sc3_r3:
  s_add_u32 s31, s31, 1
  buffer_load_dwordx4 v[20:23], v2, s[8:11], s20 offen offset:3072 sc1
  s_waitcnt vmcnt(0)
  v_cmp_eq_u32 vcc, -1, v20
  s_nop 4
  s_cbranch_vccz cA_sc3_c3
  s_add_u32 s30, s30, 1
  s_cmp_lt_u32 s30, 400000
  s_cbranch_scc1 cA_sc3_r3
  s_branch cA_abort
cA_sc3_r4:
  s_add_u32 s31, s31, 1
  buffer_load_dwordx4 v[24:27], v2, s[8:11], s23 offen offset:0 sc1
  buffer_load_dwordx4 v[28:31], v2, s[8:11], s23 offen offset:1024 sc1
  buffer_load_dwordx4 v[32:35], v2, s[8:11], s23 offen offset:2048 sc1
  s_waitcnt vmcnt(0)
  v_max3_u32 v66, v24, v27, v28
  v_max3_u32 v66, v66, v31, v32
  v_max_u32 v66, v66, v35
  v_cmp_eq_u32 vcc, -1, v66
  s_nop 4
  s_cbranch_vccz cA_sc3_c4
  s_add_u32 s30, s30, 1
  s_cmp_lt_u32 s30, 400000
  s_cbranch_scc1 cA_sc3_r4
  s_branch cA_abort
cA_sc3_retry:
  s_cmp_lg_u32 s62, 0
  s_cbranch_scc1 cA_sc3_cont
  s_waitcnt vmcnt(0) lgkmcnt(0)
cA_sc3_rv:
  buffer_load_dwordx4 v[8:11], v2, s[8:11], s20 offen offset:0 sc1
  buffer_load_dwordx4 v[12:15], v2, s[8:11], s20 offen offset:1024 sc1
  buffer_load_dwordx4 v[16:19], v2, s[8:11], s20 offen offset:2048 sc1
  buffer_load_dwordx4 v[20:23], v2, s[8:11], s20 offen offset:3072 sc1
  buffer_load_dwordx4 v[24:27], v2, s[8:11], s23 offen offset:0 sc1
  buffer_load_dwordx4 v[28:31], v2, s[8:11], s23 offen offset:1024 sc1
  buffer_load_dwordx4 v[32:35], v2, s[8:11], s23 offen offset:2048 sc1
  s_waitcnt vmcnt(0)
  v_pk_max_u16 v66, v8, v9
  v_pk_max_u16 v66, v66, v10
  v_pk_max_u16 v66, v66, v11
  v_pk_max_u16 v66, v66, v12
  v_pk_max_u16 v66, v66, v13
  v_pk_max_u16 v66, v66, v14
  v_pk_max_u16 v66, v66, v15
  v_pk_max_u16 v66, v66, v16
  v_pk_max_u16 v66, v66, v17
  v_pk_max_u16 v66, v66, v18
  v_pk_max_u16 v66, v66, v19
  v_pk_max_u16 v66, v66, v20
  v_pk_max_u16 v66, v66, v21
  v_pk_max_u16 v66, v66, v22
  v_pk_max_u16 v66, v66, v23
  v_pk_max_u16 v66, v66, v24
  v_pk_max_u16 v66, v66, v25
  v_pk_max_u16 v66, v66, v26
  v_pk_max_u16 v66, v66, v27
  v_pk_max_u16 v66, v66, v28
  v_pk_max_u16 v66, v66, v29
  v_pk_max_u16 v66, v66, v30
  v_pk_max_u16 v66, v66, v31
  v_pk_max_u16 v66, v66, v32
  v_pk_max_u16 v66, v66, v33
  v_pk_max_u16 v66, v66, v34
  v_pk_max_u16 v66, v66, v35
  v_lshlrev_b32 v67, 16, v66
  v_max_u32 v66, v66, v67
  v_cmp_le_u32 vcc, 0xffff0000, v66
  s_cbranch_vccz cA_sc3_rk
  s_add_u32 s30, s30, 1
  s_cmp_lt_u32 s30, 400000
  s_cbranch_scc1 cA_sc3_rv
  s_branch cA_abort
cA_sc3_rk:
  s_mov_b32 s62, 1
  v_mov_b32 v36, 0
  v_mov_b32 v37, 0
  v_mov_b32 v38, 0
  v_mov_b32 v39, 0
  v_mov_b32 v40, 0
  v_mov_b32 v41, 0
  v_mov_b32 v42, 0
  v_mov_b32 v43, 0
  v_mov_b32 v44, 0
  v_mov_b32 v45, 0
  v_mov_b32 v46, 0
  v_mov_b32 v47, 0
  v_mov_b32 v48, 0
  v_mov_b32 v49, 0
  v_mov_b32 v50, 0
  v_mov_b32 v51, 0
  v_mov_b32 v62, 0
  v_mov_b32 v63, 0
  v_mov_b32 v64, 0
  v_mov_b32 v65, 0
  v_mov_b32 v68, 0
  v_mov_b32 v69, 0
  v_mov_b32 v70, 0
  v_mov_b32 v71, 0
  v_mov_b32 v72, 0
  v_mov_b32 v73, 0
  v_mov_b32 v74, 0
  v_mov_b32 v75, 0
  v_mov_b32 v52, 0
  v_mov_b32 v53, 0
  v_mov_b32 v54, 0
  v_mov_b32 v55, 0
  v_mov_b32 v56, 0
  v_mov_b32 v57, 0
  v_mov_b32 v58, 0
  v_mov_b32 v59, 0
  s_add_u32 s31, s31, 0x100
  s_nop 0
  s_branch cA_sc3_go
.p2align 6
cA_va0_loop:
  s_mov_b32 s30, 0
  s_barrier
  buffer_load_dwordx4 v[24:27], v2, s[8:11], s23 offen offset:0 sc1
  buffer_load_dwordx4 v[28:31], v2, s[8:11], s23 offen offset:1024 sc1
  s_barrier
  s_cmp_lt_u32 s19, 58
  s_cbranch_scc1 cA_va0_m1
  buffer_store_dword v160, v1, s[8:11], s38 offen sc1
  s_branch cA_va0_m2
cA_va0_m1:
  buffer_store_dword v160, v1, s[8:11], s38 offen nt
cA_va0_m2:
  s_add_u32 s22, s25, 0
  buffer_load_dwordx4 v[80:83], v6, s[8:11], s22 offen offset:0 sc1
  buffer_load_dwordx4 v[84:87], v6, s[8:11], s22 offen offset:1792 sc1
  s_add_u32 s22, s25, 3584
  buffer_load_dwordx4 v[88:91], v6, s[8:11], s22 offen offset:0 sc1
  buffer_load_dwordx4 v[92:95], v6, s[8:11], s22 offen offset:1792 sc1
  s_add_u32 s22, s25, 7168
  buffer_load_dwordx4 v[96:99], v6, s[8:11], s22 offen offset:0 sc1
  s_mul_i32 s38, s18, 7168
  s_add_u32 s38, s38, 88002560
  s_waitcnt vmcnt(6)
  ds_write_b128 v2, v[24:27] offset:12288
  ds_write_b128 v2, v[28:31] offset:13312
  v_smfmac_f32_16x16x64_bf16 v[36:39], v[24:27], a[32:39], v3
  buffer_load_dwordx4 v[100:103], v6, s[8:11], s22 offen offset:1792 sc1
  v_smfmac_f32_16x16x64_bf16 v[40:43], v[24:27], a[88:95], v3
  s_add_u32 s22, s25, 10752
  buffer_load_dwordx4 v[104:107], v6, s[8:11], s22 offen offset:0 sc1
  v_smfmac_f32_16x16x64_bf16 v[44:47], v[24:27], a[144:151], v3
  buffer_load_dwordx4 v[108:111], v6, s[8:11], s22 offen offset:1792 sc1
  v_smfmac_f32_16x16x64_bf16 v[48:51], v[24:27], a[200:207], v3
  s_add_u32 s22, s25, 14336
  buffer_load_dwordx4 v[112:115], v6, s[8:11], s22 offen offset:0 sc1
  v_smfmac_f32_16x16x64_bf16 v[52:55], v[24:27], v[176:183], v3
  s_waitcnt lgkmcnt(0)
  s_barrier
  ds_read_b128 v[8:11], v2 offset:8192
  ds_read_b128 v[12:15], v2 offset:9216
  ds_read_b128 v[16:19], v2 offset:10240
  ds_read_b128 v[20:23], v2 offset:11264
  ds_read_b128 v[32:35], v2 offset:14336
  buffer_load_dwordx4 v[116:119], v6, s[8:11], s22 offen offset:1792 sc1
  v_smfmac_f32_16x16x64_bf16 v[56:59], v[24:27], v[232:239], v3
  s_add_u32 s22, s25, 17920
  buffer_load_dwordx4 v[120:123], v6, s[8:11], s22 offen offset:0 sc1
  v_smfmac_f32_16x16x64_bf16 v[36:39], v[28:31], a[40:47], v3
  buffer_load_dwordx4 v[124:127], v6, s[8:11], s22 offen offset:1792 sc1
  v_smfmac_f32_16x16x64_bf16 v[40:43], v[28:31], a[96:103], v3
  s_add_u32 s22, s25, 21504
  buffer_load_dwordx4 v[128:131], v6, s[8:11], s22 offen offset:0 sc1
  v_smfmac_f32_16x16x64_bf16 v[44:47], v[28:31], a[152:159], v3
  buffer_load_dwordx4 v[132:135], v6, s[8:11], s22 offen offset:1792 sc1
  v_smfmac_f32_16x16x64_bf16 v[48:51], v[28:31], a[208:215], v3
  s_add_u32 s22, s25, 25088
  buffer_load_dwordx4 v[136:139], v6, s[8:11], s22 offen offset:0 sc1
  v_smfmac_f32_16x16x64_bf16 v[52:55], v[28:31], v[184:191], v3
  ds_read_b128 v[64:67], v0 offset:0
  ds_read_b128 v[68:71], v0 offset:1024
  buffer_load_dwordx4 v[140:143], v6, s[8:11], s22 offen offset:1792 sc1
  v_smfmac_f32_16x16x64_bf16 v[56:59], v[28:31], v[240:247], v3
  s_waitcnt lgkmcnt(6)
  ds_read_b128 v[72:75], v0 offset:2048
  ds_read_b128 v[76:79], v0 offset:3072
  v_smfmac_f32_16x16x64_bf16 v[36:39], v[8:11], a[0:7], v3
  s_waitcnt lgkmcnt(7)
  v_smfmac_f32_16x16x64_bf16 v[36:39], v[12:15], a[8:15], v3
  s_waitcnt lgkmcnt(6)
  v_smfmac_f32_16x16x64_bf16 v[36:39], v[16:19], a[16:23], v3
  s_waitcnt lgkmcnt(2)
  v_smfmac_f32_16x16x64_bf16 v[60:63], v[8:11], v[64:71], v3
  s_waitcnt lgkmcnt(5)
  ds_read_b128 v[144:147], v0 offset:4096
  ds_read_b128 v[148:151], v0 offset:5120
  v_smfmac_f32_16x16x64_bf16 v[36:39], v[20:23], a[24:31], v3
  s_waitcnt lgkmcnt(6)
  v_smfmac_f32_16x16x64_bf16 v[36:39], v[32:35], a[48:55], v3
  v_smfmac_f32_16x16x64_bf16 v[40:43], v[8:11], a[56:63], v3
  s_waitcnt lgkmcnt(2)
  v_smfmac_f32_16x16x64_bf16 v[60:63], v[12:15], v[72:79], v3
  ds_read_b128 v[64:67], v0 offset:6144
  ds_read_b128 v[68:71], v0 offset:7168
  v_smfmac_f32_16x16x64_bf16 v[40:43], v[12:15], a[64:71], v3
  v_permlane32_swap_b32 v36, v38
  v_smfmac_f32_16x16x64_bf16 v[40:43], v[16:19], a[72:79], v3
  v_permlane32_swap_b32 v37, v39
  v_smfmac_f32_16x16x64_bf16 v[40:43], v[20:23], a[80:87], v3
  s_waitcnt lgkmcnt(2)
  v_add_f32 v36, v36, v38
  v_smfmac_f32_16x16x64_bf16 v[60:63], v[16:19], v[144:151], v3
  ds_read_b128 v[72:75], v0 offset:8192
  ds_read_b128 v[76:79], v0 offset:9216
  v_add_f32 v37, v37, v39
  v_smfmac_f32_16x16x64_bf16 v[40:43], v[32:35], a[104:111], v3
  v_cmp_u_f32 vcc, v36, v37
  v_smfmac_f32_16x16x64_bf16 v[44:47], v[8:11], a[112:119], v3
  v_cvt_pk_bf16_f32 v38, v36, v37
  v_smfmac_f32_16x16x64_bf16 v[44:47], v[12:15], a[120:127], v3
  ds_write_b32 v152, v38
  s_waitcnt lgkmcnt(3)
  s_cbranch_vccnz cA_va0_slow
  v_permlane32_swap_b32 v40, v42
  v_smfmac_f32_16x16x64_bf16 v[60:63], v[20:23], v[64:71], v3
  ds_read_b128 v[144:147], v0 offset:10240
  ds_read_b128 v[148:151], v0 offset:11264
  v_permlane32_swap_b32 v41, v43
  v_smfmac_f32_16x16x64_bf16 v[44:47], v[16:19], a[128:135], v3
  buffer_store_dword v162, v1, s[8:11], s21 offen
  v_add_f32 v40, v40, v42
  v_smfmac_f32_16x16x64_bf16 v[44:47], v[20:23], a[136:143], v3
  v_add_f32 v41, v41, v43
  v_smfmac_f32_16x16x64_bf16 v[44:47], v[32:35], a[160:167], v3
  s_waitcnt lgkmcnt(3)
  v_cvt_pk_bf16_f32 v42, v40, v41
  v_smfmac_f32_16x16x64_bf16 v[60:63], v[24:27], v[72:79], v3
  ds_write_b32 v153, v42
  ds_read_b128 v[64:67], v0 offset:12288
  ds_read_b128 v[68:71], v0 offset:13312
  v_smfmac_f32_16x16x64_bf16 v[48:51], v[8:11], a[168:175], v3
  s_nop 0
  v_permlane32_swap_b32 v44, v46
  v_smfmac_f32_16x16x64_bf16 v[48:51], v[12:15], a[176:183], v3
  v_permlane32_swap_b32 v45, v47
  v_smfmac_f32_16x16x64_bf16 v[48:51], v[16:19], a[184:191], v3
  s_waitcnt lgkmcnt(3)
  v_add_f32 v44, v44, v46
  v_smfmac_f32_16x16x64_bf16 v[60:63], v[28:31], v[144:151], v3
  v_add_f32 v45, v45, v47
  v_smfmac_f32_16x16x64_bf16 v[48:51], v[20:23], a[192:199], v3
  v_cvt_pk_bf16_f32 v46, v44, v45
  v_smfmac_f32_16x16x64_bf16 v[48:51], v[32:35], a[216:223], v3
  ds_write_b32 v154, v46
  v_smfmac_f32_16x16x64_bf16 v[52:55], v[8:11], a[224:231], v3
  s_waitcnt lgkmcnt(1)
  v_smfmac_f32_16x16x64_bf16 v[60:63], v[32:35], v[64:71], v3
  v_smfmac_f32_16x16x64_bf16 v[52:55], v[12:15], a[232:239], v3
  v_permlane32_swap_b32 v48, v50
  v_smfmac_f32_16x16x64_bf16 v[52:55], v[16:19], a[240:247], v3
  v_permlane32_swap_b32 v49, v51
  v_smfmac_f32_16x16x64_bf16 v[52:55], v[20:23], a[248:255], v3
  v_add_f32 v48, v48, v50
  v_smfmac_f32_16x16x64_bf16 v[52:55], v[32:35], v[192:199], v3
  v_add_f32 v49, v49, v51
  v_smfmac_f32_16x16x64_bf16 v[56:59], v[8:11], v[200:207], v3
  v_cvt_pk_bf16_f32 v50, v48, v49
  v_smfmac_f32_16x16x64_bf16 v[56:59], v[12:15], v[208:215], v3
  ds_write_b32 v155, v50
  v_permlane32_swap_b32 v60, v62
  v_smfmac_f32_16x16x64_bf16 v[56:59], v[16:19], v[216:223], v3
  v_permlane32_swap_b32 v61, v63
  v_smfmac_f32_16x16x64_bf16 v[56:59], v[20:23], v[224:231], v3
  v_add_f32 v60, v60, v62
  v_smfmac_f32_16x16x64_bf16 v[56:59], v[32:35], v[248:255], v3
  v_add_f32 v61, v61, v63
  v_cvt_pk_bf16_f32 v62, v60, v61
  ds_write_b32 v158, v62
  v_permlane32_swap_b32 v52, v54
  v_permlane32_swap_b32 v53, v55
  v_add_f32 v52, v52, v54
  v_add_f32 v53, v53, v55
  v_cvt_pk_bf16_f32 v54, v52, v53
  ds_write_b32 v156, v54
  v_permlane32_swap_b32 v56, v58
  v_permlane32_swap_b32 v57, v59
  v_add_f32 v56, v56, v58
  v_add_f32 v57, v57, v59
  v_cvt_pk_bf16_f32 v58, v56, v57
  ds_write_b32 v157, v58
cA_va0_t2d:
  s_add_u32 s22, s20, 9216
  s_add_u32 s34, s20, 13312
  s_add_u32 s36, s20, 7168
  s_mov_b32 s37, 0
  v_mov_b32 v48, 0
  v_mov_b32 v49, 0
  v_mov_b32 v50, 0
  v_mov_b32 v51, 0
  v_mov_b32 v163, s18
  s_waitcnt lgkmcnt(0)
  s_setprio 3
  buffer_load_dword v52, v4, s[8:11], 0 offen sc1
  buffer_load_dword v53, v4, s[8:11], 0 offen sc1
  buffer_load_dword v54, v4, s[8:11], 0 offen sc1
  buffer_load_dword v55, v4, s[8:11], 0 offen sc1
cA_va0_fw_l:
  s_waitcnt vmcnt(3)
  v_cmp_gt_u32 vcc, s18, v52
  s_cbranch_vccz cA_va0_fw_d
  buffer_load_dword v52, v4, s[8:11], 0 offen sc1
  s_waitcnt vmcnt(3)
  v_cmp_gt_u32 vcc, s18, v53
  s_cbranch_vccz cA_va0_fw_d
  buffer_load_dword v53, v4, s[8:11], 0 offen sc1
  s_waitcnt vmcnt(3)
  v_cmp_gt_u32 vcc, s18, v54
  s_cbranch_vccz cA_va0_fw_d
  buffer_load_dword v54, v4, s[8:11], 0 offen sc1
  s_waitcnt vmcnt(3)
  v_cmp_gt_u32 vcc, s18, v55
  s_cbranch_vccz cA_va0_fw_d
  buffer_load_dword v55, v4, s[8:11], 0 offen sc1
  s_add_u32 s30, s30, 1
  s_cmp_lt_u32 s30, 400000
  s_cbranch_scc1 cA_va0_fw_l
  s_branch cA_abort
cA_va0_fw_d:
  buffer_load_dwordx4 v[8:11], v2, s[8:11], s22 offen offset:0 sc1
  buffer_load_dwordx4 v[12:15], v2, s[8:11], s22 offen offset:1024 sc1
  buffer_load_dwordx4 v[16:19], v2, s[8:11], s22 offen offset:2048 sc1
  buffer_load_dwordx4 v[20:23], v2, s[8:11], s22 offen offset:3072 sc1
  buffer_load_dwordx4 v[24:27], v2, s[8:11], s34 offen offset:0 sc1
  buffer_load_dwordx4 v[28:31], v2, s[8:11], s34 offen offset:1024 sc1
  buffer_load_dwordx4 v[32:35], v2, s[8:11], s34 offen offset:2048 sc1
  buffer_load_dwordx4 v[36:39], v2, s[8:11], s34 offen offset:3072 sc1
  buffer_load_dwordx4 v[40:43], v2, s[8:11], s36 offen offset:0 sc1
  buffer_load_dwordx4 v[44:47], v2, s[8:11], s36 offen offset:1024 sc1
  s_barrier
  ds_read_b128 v[64:67], v2 offset:0
  ds_read_b128 v[68:71], v2 offset:1024
  ds_read_b128 v[72:75], v2 offset:2048
  ds_read_b128 v[76:79], v2 offset:3072
cA_va0_lp:
  s_waitcnt vmcnt(9)
  v_smfmac_f32_16x16x64_bf16 v[48:51], v[8:11], v[80:87], v3
  s_waitcnt vmcnt(8)
  v_smfmac_f32_16x16x64_bf16 v[48:51], v[12:15], v[88:95], v3
  s_waitcnt vmcnt(7)
  v_smfmac_f32_16x16x64_bf16 v[48:51], v[16:19], v[96:103], v3
  s_waitcnt vmcnt(6)
  v_smfmac_f32_16x16x64_bf16 v[48:51], v[20:23], v[104:111], v3
  s_waitcnt vmcnt(5)
  v_smfmac_f32_16x16x64_bf16 v[48:51], v[24:27], v[112:119], v3
  s_waitcnt vmcnt(4)
  v_smfmac_f32_16x16x64_bf16 v[48:51], v[28:31], v[120:127], v3
  s_waitcnt vmcnt(3)
  v_smfmac_f32_16x16x64_bf16 v[48:51], v[32:35], v[128:135], v3
  s_waitcnt vmcnt(2)
  v_smfmac_f32_16x16x64_bf16 v[48:51], v[36:39], v[136:143], v3
  s_waitcnt vmcnt(1) lgkmcnt(0)
  v_smfmac_f32_16x16x64_bf16 v[48:51], v[40:43], v[64:71], v3
  s_waitcnt vmcnt(0)
  v_smfmac_f32_16x16x64_bf16 v[48:51], v[44:47], v[72:79], v3
  s_nop 7
  v_permlane32_swap_b32 v48, v50
  v_permlane32_swap_b32 v49, v51
  v_add_f32 v48, v48, v50
  v_add_f32 v49, v49, v51
  v_cvt_pk_bf16_f32 v160, v48, v49
  v_cmp_u_f32 vcc, v48, v49
  s_nop 0
  v_mov_b32_dpp v161, v160 quad_perm:[1,0,3,2] row_mask:0xf bank_mask:0xf
  v_perm_b32 v160, v161, v160, v5
  v_min_u32 v160, -2, v160
  s_cbranch_vccnz cA_va0_rp
cA_va0_cont:
  buffer_store_dword v160, v1, s[8:11], s21 offen
  s_setprio 0
  s_cmp_lg_u32 s19, 62
  s_cbranch_scc1 cA_va0_nl
  buffer_store_dword v160, v1, s[8:11], s38 offen sc1
  s_waitcnt vmcnt(0)
  buffer_wbl2 sc1
  s_branch cA_done
cA_va0_nl:
  s_add_u32 s25, s25, 458752
  v_mov_b32 v36, 0
  v_mov_b32 v37, 0
  v_mov_b32 v38, 0
  v_mov_b32 v39, 0
  v_mov_b32 v40, 0
  v_mov_b32 v41, 0
  v_mov_b32 v42, 0
  v_mov_b32 v43, 0
  v_mov_b32 v44, 0
  v_mov_b32 v45, 0
  v_mov_b32 v46, 0
  v_mov_b32 v47, 0
  v_mov_b32 v48, 0
  v_mov_b32 v49, 0
  v_mov_b32 v50, 0
  v_mov_b32 v51, 0
  v_mov_b32 v52, 0
  v_mov_b32 v53, 0
  v_mov_b32 v54, 0
  v_mov_b32 v55, 0
  v_mov_b32 v56, 0
  v_mov_b32 v57, 0
  v_mov_b32 v58, 0
  v_mov_b32 v59, 0
  v_mov_b32 v60, 0
  v_mov_b32 v61, 0
  v_mov_b32 v62, 0
  v_mov_b32 v63, 0
  s_mov_b32 s19, s18
  s_add_u32 s18, s18, 1
  s_mov_b32 s22, s20
  s_mov_b32 s20, s21
  s_mov_b32 s21, s22
  s_add_u32 s23, s20, 4096
  s_branch cA_va0_loop
cA_va0_slow:
  s_waitcnt lgkmcnt(0)
cA_va0_sl1:
  s_add_u32 s31, s31, 0x1000000
  buffer_load_dwordx4 v[8:11], v2, s[8:11], s20 offen offset:0 sc1
  buffer_load_dwordx4 v[12:15], v2, s[8:11], s20 offen offset:1024 sc1
  buffer_load_dwordx4 v[16:19], v2, s[8:11], s20 offen offset:2048 sc1
  buffer_load_dwordx4 v[20:23], v2, s[8:11], s20 offen offset:3072 sc1
  buffer_load_dwordx4 v[24:27], v2, s[8:11], s23 offen offset:0 sc1
  buffer_load_dwordx4 v[28:31], v2, s[8:11], s23 offen offset:1024 sc1
  buffer_load_dwordx4 v[32:35], v2, s[8:11], s23 offen offset:2048 sc1
  s_waitcnt vmcnt(0)
  v_max3_u32 v36, v8, v9, v10
  v_max3_u32 v36, v36, v11, v12
  v_max3_u32 v36, v36, v13, v14
  v_max3_u32 v36, v36, v15, v16
  v_max3_u32 v36, v36, v17, v18
  v_max3_u32 v36, v36, v19, v20
  v_max3_u32 v36, v36, v21, v22
  v_max3_u32 v36, v36, v23, v24
  v_max3_u32 v36, v36, v25, v26
  v_max3_u32 v36, v36, v27, v28
  v_max3_u32 v36, v36, v29, v30
  v_max3_u32 v36, v36, v31, v32
  v_max3_u32 v36, v36, v33, v34
  v_max_u32 v36, v36, v35
  v_cmp_eq_u32 vcc, -1, v36
  s_cbranch_vccz cA_va0_sl2
  s_add_u32 s30, s30, 1
  s_cmp_lt_u32 s30, 400000
  s_cbranch_scc1 cA_va0_sl1
  s_branch cA_abort
cA_va0_sl2:
  v_mov_b32 v36, 0
  v_mov_b32 v37, 0
  v_mov_b32 v38, 0
  v_mov_b32 v39, 0
  v_mov_b32 v40, 0
  v_mov_b32 v41, 0
  v_mov_b32 v42, 0
  v_mov_b32 v43, 0
  v_mov_b32 v44, 0
  v_mov_b32 v45, 0
  v_mov_b32 v46, 0
  v_mov_b32 v47, 0
  v_mov_b32 v48, 0
  v_mov_b32 v49, 0
  v_mov_b32 v50, 0
  v_mov_b32 v51, 0
  v_mov_b32 v52, 0
  v_mov_b32 v53, 0
  v_mov_b32 v54, 0
  v_mov_b32 v55, 0
  v_mov_b32 v56, 0
  v_mov_b32 v57, 0
  v_mov_b32 v58, 0
  v_mov_b32 v59, 0
  v_mov_b32 v60, 0
  v_mov_b32 v61, 0
  v_mov_b32 v62, 0
  v_mov_b32 v63, 0
  buffer_store_dword v162, v1, s[8:11], s21 offen
  ds_read_b128 v[64:67], v0 offset:0
  ds_read_b128 v[68:71], v0 offset:1024
  v_smfmac_f32_16x16x64_bf16 v[36:39], v[8:11], a[0:7], v3
  v_smfmac_f32_16x16x64_bf16 v[40:43], v[8:11], a[56:63], v3
  v_smfmac_f32_16x16x64_bf16 v[44:47], v[8:11], a[112:119], v3
  v_smfmac_f32_16x16x64_bf16 v[48:51], v[8:11], a[168:175], v3
  v_smfmac_f32_16x16x64_bf16 v[52:55], v[8:11], a[224:231], v3
  v_smfmac_f32_16x16x64_bf16 v[56:59], v[8:11], v[200:207], v3
  s_waitcnt lgkmcnt(0)
  v_smfmac_f32_16x16x64_bf16 v[60:63], v[8:11], v[64:71], v3
  ds_read_b128 v[72:75], v0 offset:2048
  ds_read_b128 v[76:79], v0 offset:3072
  v_smfmac_f32_16x16x64_bf16 v[36:39], v[12:15], a[8:15], v3
  v_smfmac_f32_16x16x64_bf16 v[40:43], v[12:15], a[64:71], v3
  v_smfmac_f32_16x16x64_bf16 v[44:47], v[12:15], a[120:127], v3
  v_smfmac_f32_16x16x64_bf16 v[48:51], v[12:15], a[176:183], v3
  v_smfmac_f32_16x16x64_bf16 v[52:55], v[12:15], a[232:239], v3
  v_smfmac_f32_16x16x64_bf16 v[56:59], v[12:15], v[208:215], v3
  s_waitcnt lgkmcnt(0)
  v_smfmac_f32_16x16x64_bf16 v[60:63], v[12:15], v[72:79], v3
  ds_read_b128 v[144:147], v0 offset:4096
  ds_read_b128 v[148:151], v0 offset:5120
  v_smfmac_f32_16x16x64_bf16 v[36:39], v[16:19], a[16:23], v3
  v_smfmac_f32_16x16x64_bf16 v[40:43], v[16:19], a[72:79], v3
  v_smfmac_f32_16x16x64_bf16 v[44:47], v[16:19], a[128:135], v3
  v_smfmac_f32_16x16x64_bf16 v[48:51], v[16:19], a[184:191], v3
  v_smfmac_f32_16x16x64_bf16 v[52:55], v[16:19], a[240:247], v3
  v_smfmac_f32_16x16x64_bf16 v[56:59], v[16:19], v[216:223], v3
  s_waitcnt lgkmcnt(0)
  v_smfmac_f32_16x16x64_bf16 v[60:63], v[16:19], v[144:151], v3
  ds_read_b128 v[64:67], v0 offset:6144
  ds_read_b128 v[68:71], v0 offset:7168
  v_smfmac_f32_16x16x64_bf16 v[36:39], v[20:23], a[24:31], v3
  v_smfmac_f32_16x16x64_bf16 v[40:43], v[20:23], a[80:87], v3
  v_smfmac_f32_16x16x64_bf16 v[44:47], v[20:23], a[136:143], v3
  v_smfmac_f32_16x16x64_bf16 v[48:51], v[20:23], a[192:199], v3
  v_smfmac_f32_16x16x64_bf16 v[52:55], v[20:23], a[248:255], v3
  v_smfmac_f32_16x16x64_bf16 v[56:59], v[20:23], v[224:231], v3
  s_waitcnt lgkmcnt(0)
  v_smfmac_f32_16x16x64_bf16 v[60:63], v[20:23], v[64:71], v3
  ds_read_b128 v[72:75], v0 offset:8192
  ds_read_b128 v[76:79], v0 offset:9216
  v_smfmac_f32_16x16x64_bf16 v[36:39], v[24:27], a[32:39], v3
  v_smfmac_f32_16x16x64_bf16 v[40:43], v[24:27], a[88:95], v3
  v_smfmac_f32_16x16x64_bf16 v[44:47], v[24:27], a[144:151], v3
  v_smfmac_f32_16x16x64_bf16 v[48:51], v[24:27], a[200:207], v3
  v_smfmac_f32_16x16x64_bf16 v[52:55], v[24:27], v[176:183], v3
  v_smfmac_f32_16x16x64_bf16 v[56:59], v[24:27], v[232:239], v3
  s_waitcnt lgkmcnt(0)
  v_smfmac_f32_16x16x64_bf16 v[60:63], v[24:27], v[72:79], v3
  ds_read_b128 v[144:147], v0 offset:10240
  ds_read_b128 v[148:151], v0 offset:11264
  v_smfmac_f32_16x16x64_bf16 v[36:39], v[28:31], a[40:47], v3
  v_smfmac_f32_16x16x64_bf16 v[40:43], v[28:31], a[96:103], v3
  v_smfmac_f32_16x16x64_bf16 v[44:47], v[28:31], a[152:159], v3
  v_smfmac_f32_16x16x64_bf16 v[48:51], v[28:31], a[208:215], v3
  v_smfmac_f32_16x16x64_bf16 v[52:55], v[28:31], v[184:191], v3
  v_smfmac_f32_16x16x64_bf16 v[56:59], v[28:31], v[240:247], v3
  s_waitcnt lgkmcnt(0)
  v_smfmac_f32_16x16x64_bf16 v[60:63], v[28:31], v[144:151], v3
  ds_read_b128 v[64:67], v0 offset:12288
  ds_read_b128 v[68:71], v0 offset:13312
  v_smfmac_f32_16x16x64_bf16 v[36:39], v[32:35], a[48:55], v3
  v_smfmac_f32_16x16x64_bf16 v[40:43], v[32:35], a[104:111], v3
  v_smfmac_f32_16x16x64_bf16 v[44:47], v[32:35], a[160:167], v3
  v_smfmac_f32_16x16x64_bf16 v[48:51], v[32:35], a[216:223], v3
  v_smfmac_f32_16x16x64_bf16 v[52:55], v[32:35], v[192:199], v3
  v_smfmac_f32_16x16x64_bf16 v[56:59], v[32:35], v[248:255], v3
  s_waitcnt lgkmcnt(0)
  v_smfmac_f32_16x16x64_bf16 v[60:63], v[32:35], v[64:71], v3
  v_permlane32_swap_b32 v36, v38
  v_permlane32_swap_b32 v37, v39
  v_add_f32 v36, v36, v38
  v_add_f32 v37, v37, v39
  v_cvt_pk_bf16_f32 v38, v36, v37
  ds_write_b32 v152, v38
  v_permlane32_swap_b32 v40, v42
  v_permlane32_swap_b32 v41, v43
  v_add_f32 v40, v40, v42
  v_add_f32 v41, v41, v43
  v_cvt_pk_bf16_f32 v42, v40, v41
  ds_write_b32 v153, v42
  v_permlane32_swap_b32 v44, v46
  v_permlane32_swap_b32 v45, v47
  v_add_f32 v44, v44, v46
  v_add_f32 v45, v45, v47
  v_cvt_pk_bf16_f32 v46, v44, v45
  ds_write_b32 v154, v46
  v_permlane32_swap_b32 v48, v50
  v_permlane32_swap_b32 v49, v51
  v_add_f32 v48, v48, v50
  v_add_f32 v49, v49, v51
  v_cvt_pk_bf16_f32 v50, v48, v49
  ds_write_b32 v155, v50
  v_permlane32_swap_b32 v52, v54
  v_permlane32_swap_b32 v53, v55
  v_add_f32 v52, v52, v54
  v_add_f32 v53, v53, v55
  v_cvt_pk_bf16_f32 v54, v52, v53
  ds_write_b32 v156, v54
  v_permlane32_swap_b32 v56, v58
  v_permlane32_swap_b32 v57, v59
  v_add_f32 v56, v56, v58
  v_add_f32 v57, v57, v59
  v_cvt_pk_bf16_f32 v58, v56, v57
  ds_write_b32 v157, v58
  v_permlane32_swap_b32 v60, v62
  v_permlane32_swap_b32 v61, v63
  v_add_f32 v60, v60, v62
  v_add_f32 v61, v61, v63
  v_cvt_pk_bf16_f32 v62, v60, v61
  ds_write_b32 v158, v62
  s_branch cA_va0_t2d
cA_va0_rp:
  s_cmp_lg_u32 s37, 0
  s_cbranch_scc1 cA_va0_cont
cA_va0_rv:
  s_add_u32 s31, s31, 0x10000
  buffer_load_dwordx4 v[8:11], v2, s[8:11], s22 offen offset:0 sc1
  buffer_load_dwordx4 v[12:15], v2, s[8:11], s22 offen offset:1024 sc1
  buffer_load_dwordx4 v[16:19], v2, s[8:11], s22 offen offset:2048 sc1
  buffer_load_dwordx4 v[20:23], v2, s[8:11], s22 offen offset:3072 sc1
  buffer_load_dwordx4 v[24:27], v2, s[8:11], s34 offen offset:0 sc1
  buffer_load_dwordx4 v[28:31], v2, s[8:11], s34 offen offset:1024 sc1
  buffer_load_dwordx4 v[32:35], v2, s[8:11], s34 offen offset:2048 sc1
  buffer_load_dwordx4 v[36:39], v2, s[8:11], s34 offen offset:3072 sc1
  buffer_load_dwordx4 v[40:43], v2, s[8:11], s36 offen offset:0 sc1
  buffer_load_dwordx4 v[44:47], v2, s[8:11], s36 offen offset:1024 sc1
  s_waitcnt vmcnt(0)
  v_max3_u32 v52, v8, v9, v10
  v_max3_u32 v52, v52, v11, v12
  v_max3_u32 v52, v52, v13, v14
  v_max3_u32 v52, v52, v15, v16
  v_max3_u32 v52, v52, v17, v18
  v_max3_u32 v52, v52, v19, v20
  v_max3_u32 v52, v52, v21, v22
  v_max3_u32 v52, v52, v23, v24
  v_max3_u32 v52, v52, v25, v26
  v_max3_u32 v52, v52, v27, v28
  v_max3_u32 v52, v52, v29, v30
  v_max3_u32 v52, v52, v31, v32
  v_max3_u32 v52, v52, v33, v34
  v_max3_u32 v52, v52, v35, v36
  v_max3_u32 v52, v52, v37, v38
  v_max3_u32 v52, v52, v39, v40
  v_max3_u32 v52, v52, v41, v42
  v_max3_u32 v52, v52, v43, v44
  v_max3_u32 v52, v52, v45, v46
  v_max_u32 v52, v52, v47
  v_cmp_eq_u32 vcc, -1, v52
  s_mov_b32 s37, 1
  v_mov_b32 v48, 0
  v_mov_b32 v49, 0
  v_mov_b32 v50, 0
  v_mov_b32 v51, 0
  s_nop 1
  s_cbranch_vccz cA_va0_lp
  s_add_u32 s30, s30, 1
  s_cmp_lt_u32 s30, 400000
  s_cbranch_scc1 cA_va0_rv
  s_branch cA_abort
.p2align 6
cA_va1_loop:
  s_mov_b32 s30, 0
  s_barrier
  buffer_load_dwordx4 v[28:31], v2, s[8:11], s23 offen offset:1024 sc1
  buffer_load_dwordx4 v[32:35], v2, s[8:11], s23 offen offset:2048 sc1
  s_barrier
  s_cmp_lt_u32 s19, 58
  s_cbranch_scc1 cA_va1_m1
  buffer_store_dword v160, v1, s[8:11], s38 offen sc1
  s_branch cA_va1_m2
cA_va1_m1:
  buffer_store_dword v160, v1, s[8:11], s38 offen nt
cA_va1_m2:
  s_add_u32 s22, s25, 0
  buffer_load_dwordx4 v[80:83], v6, s[8:11], s22 offen offset:0 sc1
  buffer_load_dwordx4 v[84:87], v6, s[8:11], s22 offen offset:1792 sc1
  s_add_u32 s22, s25, 3584
  buffer_load_dwordx4 v[88:91], v6, s[8:11], s22 offen offset:0 sc1
  buffer_load_dwordx4 v[92:95], v6, s[8:11], s22 offen offset:1792 sc1
  s_add_u32 s22, s25, 7168
  buffer_load_dwordx4 v[96:99], v6, s[8:11], s22 offen offset:0 sc1
  s_mul_i32 s38, s18, 7168
  s_add_u32 s38, s38, 88002560
  s_waitcnt vmcnt(6)
  ds_write_b128 v2, v[32:35] offset:14336
  v_smfmac_f32_16x16x64_bf16 v[36:39], v[28:31], a[40:47], v3
  buffer_load_dwordx4 v[100:103], v6, s[8:11], s22 offen offset:1792 sc1
  v_smfmac_f32_16x16x64_bf16 v[40:43], v[28:31], a[96:103], v3
  s_add_u32 s22, s25, 10752
  buffer_load_dwordx4 v[104:107], v6, s[8:11], s22 offen offset:0 sc1
  v_smfmac_f32_16x16x64_bf16 v[44:47], v[28:31], a[152:159], v3
  buffer_load_dwordx4 v[108:111], v6, s[8:11], s22 offen offset:1792 sc1
  v_smfmac_f32_16x16x64_bf16 v[48:51], v[28:31], a[208:215], v3
  s_add_u32 s22, s25, 14336
  buffer_load_dwordx4 v[112:115], v6, s[8:11], s22 offen offset:0 sc1
  v_smfmac_f32_16x16x64_bf16 v[52:55], v[28:31], v[184:191], v3
  s_waitcnt lgkmcnt(0)
  s_barrier
  ds_read_b128 v[8:11], v2 offset:8192
  ds_read_b128 v[12:15], v2 offset:9216
  ds_read_b128 v[16:19], v2 offset:10240
  ds_read_b128 v[20:23], v2 offset:11264
  ds_read_b128 v[24:27], v2 offset:12288
  buffer_load_dwordx4 v[116:119], v6, s[8:11], s22 offen offset:1792 sc1
  v_smfmac_f32_16x16x64_bf16 v[56:59], v[28:31], v[240:247], v3
  s_add_u32 s22, s25, 17920
  buffer_load_dwordx4 v[120:123], v6, s[8:11], s22 offen offset:0 sc1
  v_smfmac_f32_16x16x64_bf16 v[36:39], v[32:35], a[48:55], v3
  buffer_load_dwordx4 v[124:127], v6, s[8:11], s22 offen offset:1792 sc1
  v_smfmac_f32_16x16x64_bf16 v[40:43], v[32:35], a[104:111], v3
  s_add_u32 s22, s25, 21504
  buffer_load_dwordx4 v[128:131], v6, s[8:11], s22 offen offset:0 sc1
  v_smfmac_f32_16x16x64_bf16 v[44:47], v[32:35], a[160:167], v3
  buffer_load_dwordx4 v[132:135], v6, s[8:11], s22 offen offset:1792 sc1
  v_smfmac_f32_16x16x64_bf16 v[48:51], v[32:35], a[216:223], v3
  s_add_u32 s22, s25, 25088
  buffer_load_dwordx4 v[136:139], v6, s[8:11], s22 offen offset:0 sc1
  v_smfmac_f32_16x16x64_bf16 v[52:55], v[32:35], v[192:199], v3
  ds_read_b128 v[64:67], v0 offset:0
  ds_read_b128 v[68:71], v0 offset:1024
  buffer_load_dwordx4 v[140:143], v6, s[8:11], s22 offen offset:1792 sc1
  v_smfmac_f32_16x16x64_bf16 v[56:59], v[32:35], v[248:255], v3
  s_waitcnt lgkmcnt(6)
  ds_read_b128 v[72:75], v0 offset:2048
  ds_read_b128 v[76:79], v0 offset:3072
  v_smfmac_f32_16x16x64_bf16 v[36:39], v[8:11], a[0:7], v3
  s_waitcnt lgkmcnt(7)
  v_smfmac_f32_16x16x64_bf16 v[36:39], v[12:15], a[8:15], v3
  s_waitcnt lgkmcnt(6)
  v_smfmac_f32_16x16x64_bf16 v[36:39], v[16:19], a[16:23], v3
  s_waitcnt lgkmcnt(2)
  v_smfmac_f32_16x16x64_bf16 v[60:63], v[8:11], v[64:71], v3
  s_waitcnt lgkmcnt(5)
  ds_read_b128 v[144:147], v0 offset:4096
  ds_read_b128 v[148:151], v0 offset:5120
  v_smfmac_f32_16x16x64_bf16 v[36:39], v[20:23], a[24:31], v3
  s_waitcnt lgkmcnt(6)
  v_smfmac_f32_16x16x64_bf16 v[36:39], v[24:27], a[32:39], v3
  v_smfmac_f32_16x16x64_bf16 v[40:43], v[8:11], a[56:63], v3
  s_waitcnt lgkmcnt(2)
  v_smfmac_f32_16x16x64_bf16 v[60:63], v[12:15], v[72:79], v3
  ds_read_b128 v[64:67], v0 offset:6144
  ds_read_b128 v[68:71], v0 offset:7168
  v_smfmac_f32_16x16x64_bf16 v[40:43], v[12:15], a[64:71], v3
  v_permlane32_swap_b32 v36, v38
  v_smfmac_f32_16x16x64_bf16 v[40:43], v[16:19], a[72:79], v3
  v_permlane32_swap_b32 v37, v39
  v_smfmac_f32_16x16x64_bf16 v[40:43], v[20:23], a[80:87], v3
  s_waitcnt lgkmcnt(2)
  v_add_f32 v36, v36, v38
  v_smfmac_f32_16x16x64_bf16 v[60:63], v[16:19], v[144:151], v3
  ds_read_b128 v[72:75], v0 offset:8192
  ds_read_b128 v[76:79], v0 offset:9216
  v_add_f32 v37, v37, v39
  v_smfmac_f32_16x16x64_bf16 v[40:43], v[24:27], a[88:95], v3
  v_cmp_u_f32 vcc, v36, v37
  v_smfmac_f32_16x16x64_bf16 v[44:47], v[8:11], a[112:119], v3
  v_cvt_pk_bf16_f32 v38, v36, v37
  v_smfmac_f32_16x16x64_bf16 v[44:47], v[12:15], a[120:127], v3
  ds_write_b32 v152, v38
  s_waitcnt lgkmcnt(3)
  s_cbranch_vccnz cA_va1_slow
  v_permlane32_swap_b32 v40, v42
  v_smfmac_f32_16x16x64_bf16 v[60:63], v[20:23], v[64:71], v3
  ds_read_b128 v[144:147], v0 offset:10240
  ds_read_b128 v[148:151], v0 offset:11264
  v_permlane32_swap_b32 v41, v43
  v_smfmac_f32_16x16x64_bf16 v[44:47], v[16:19], a[128:135], v3
  buffer_store_dword v162, v1, s[8:11], s21 offen
  v_add_f32 v40, v40, v42
  v_smfmac_f32_16x16x64_bf16 v[44:47], v[20:23], a[136:143], v3
  v_add_f32 v41, v41, v43
  v_smfmac_f32_16x16x64_bf16 v[44:47], v[24:27], a[144:151], v3
  s_waitcnt lgkmcnt(3)
  v_cvt_pk_bf16_f32 v42, v40, v41
  v_smfmac_f32_16x16x64_bf16 v[60:63], v[24:27], v[72:79], v3
  ds_write_b32 v153, v42
  ds_read_b128 v[64:67], v0 offset:12288
  ds_read_b128 v[68:71], v0 offset:13312
  v_smfmac_f32_16x16x64_bf16 v[48:51], v[8:11], a[168:175], v3
  s_nop 0
  v_permlane32_swap_b32 v44, v46
  v_smfmac_f32_16x16x64_bf16 v[48:51], v[12:15], a[176:183], v3
  v_permlane32_swap_b32 v45, v47
  v_smfmac_f32_16x16x64_bf16 v[48:51], v[16:19], a[184:191], v3
  s_waitcnt lgkmcnt(3)
  v_add_f32 v44, v44, v46
  v_smfmac_f32_16x16x64_bf16 v[60:63], v[28:31], v[144:151], v3
  v_add_f32 v45, v45, v47
  v_smfmac_f32_16x16x64_bf16 v[48:51], v[20:23], a[192:199], v3
  v_cvt_pk_bf16_f32 v46, v44, v45
  v_smfmac_f32_16x16x64_bf16 v[48:51], v[24:27], a[200:207], v3
  ds_write_b32 v154, v46
  v_smfmac_f32_16x16x64_bf16 v[52:55], v[8:11], a[224:231], v3
  s_waitcnt lgkmcnt(1)
  v_smfmac_f32_16x16x64_bf16 v[60:63], v[32:35], v[64:71], v3
  v_smfmac_f32_16x16x64_bf16 v[52:55], v[12:15], a[232:239], v3
  v_permlane32_swap_b32 v48, v50
  v_smfmac_f32_16x16x64_bf16 v[52:55], v[16:19], a[240:247], v3
  v_permlane32_swap_b32 v49, v51
  v_smfmac_f32_16x16x64_bf16 v[52:55], v[20:23], a[248:255], v3
  v_add_f32 v48, v48, v50
  v_smfmac_f32_16x16x64_bf16 v[52:55], v[24:27], v[176:183], v3
  v_add_f32 v49, v49, v51
  v_smfmac_f32_16x16x64_bf16 v[56:59], v[8:11], v[200:207], v3
  v_cvt_pk_bf16_f32 v50, v48, v49
  v_smfmac_f32_16x16x64_bf16 v[56:59], v[12:15], v[208:215], v3
  ds_write_b32 v155, v50
  v_permlane32_swap_b32 v60, v62
  v_smfmac_f32_16x16x64_bf16 v[56:59], v[16:19], v[216:223], v3
  v_permlane32_swap_b32 v61, v63
  v_smfmac_f32_16x16x64_bf16 v[56:59], v[20:23], v[224:231], v3
  v_add_f32 v60, v60, v62
  v_smfmac_f32_16x16x64_bf16 v[56:59], v[24:27], v[232:239], v3
  v_add_f32 v61, v61, v63
  v_cvt_pk_bf16_f32 v62, v60, v61
  ds_write_b32 v158, v62
  v_permlane32_swap_b32 v52, v54
  v_permlane32_swap_b32 v53, v55
  v_add_f32 v52, v52, v54
  v_add_f32 v53, v53, v55
  v_cvt_pk_bf16_f32 v54, v52, v53
  ds_write_b32 v156, v54
  v_permlane32_swap_b32 v56, v58
  v_permlane32_swap_b32 v57, v59
  v_add_f32 v56, v56, v58
  v_add_f32 v57, v57, v59
  v_cvt_pk_bf16_f32 v58, v56, v57
  ds_write_b32 v157, v58
cA_va1_t2d:
  s_add_u32 s22, s20, 9216
  s_add_u32 s34, s20, 13312
  s_add_u32 s36, s20, 7168
  s_mov_b32 s37, 0
  v_mov_b32 v48, 0
  v_mov_b32 v49, 0
  v_mov_b32 v50, 0
  v_mov_b32 v51, 0
  v_mov_b32 v163, s18
  s_waitcnt lgkmcnt(0)
  s_barrier
  buffer_load_dwordx4 v[8:11], v2, s[8:11], s22 offen offset:0 sc1
  buffer_load_dwordx4 v[12:15], v2, s[8:11], s22 offen offset:1024 sc1
  buffer_load_dwordx4 v[16:19], v2, s[8:11], s22 offen offset:2048 sc1
  buffer_load_dwordx4 v[20:23], v2, s[8:11], s22 offen offset:3072 sc1
  buffer_load_dwordx4 v[24:27], v2, s[8:11], s34 offen offset:0 sc1
  buffer_load_dwordx4 v[28:31], v2, s[8:11], s34 offen offset:1024 sc1
  buffer_load_dwordx4 v[32:35], v2, s[8:11], s34 offen offset:2048 sc1
  buffer_load_dwordx4 v[36:39], v2, s[8:11], s34 offen offset:3072 sc1
  buffer_load_dwordx4 v[40:43], v2, s[8:11], s36 offen offset:0 sc1
  buffer_load_dwordx4 v[44:47], v2, s[8:11], s36 offen offset:1024 sc1
  ds_read_b128 v[64:67], v2 offset:4096
  ds_read_b128 v[68:71], v2 offset:5120
  ds_read_b128 v[72:75], v2 offset:6144
  ds_read_b128 v[76:79], v2 offset:7168
cA_va1_lp:
  s_waitcnt vmcnt(9)
  v_smfmac_f32_16x16x64_bf16 v[48:51], v[8:11], v[80:87], v3
  s_waitcnt vmcnt(8)
  v_smfmac_f32_16x16x64_bf16 v[48:51], v[12:15], v[88:95], v3
  s_waitcnt vmcnt(7)
  v_smfmac_f32_16x16x64_bf16 v[48:51], v[16:19], v[96:103], v3
  v_max3_u32 v55, v8, v12, v16
  s_waitcnt vmcnt(6)
  v_smfmac_f32_16x16x64_bf16 v[48:51], v[20:23], v[104:111], v3
  v_max_u32 v55, v55, v20
  v_cmp_eq_u32 vcc, -1, v55
  s_waitcnt vmcnt(5)
  v_smfmac_f32_16x16x64_bf16 v[48:51], v[24:27], v[112:119], v3
  s_waitcnt vmcnt(4)
  v_smfmac_f32_16x16x64_bf16 v[48:51], v[28:31], v[120:127], v3
  s_cbranch_vccnz cA_va1_rv
  buffer_store_dword v163, v7, s[8:11], 0 offen
  s_waitcnt vmcnt(4)
  v_smfmac_f32_16x16x64_bf16 v[48:51], v[32:35], v[128:135], v3
  s_waitcnt vmcnt(3)
  v_smfmac_f32_16x16x64_bf16 v[48:51], v[36:39], v[136:143], v3
  s_waitcnt vmcnt(2) lgkmcnt(0)
  v_smfmac_f32_16x16x64_bf16 v[48:51], v[40:43], v[64:71], v3
  s_waitcnt vmcnt(1)
  v_smfmac_f32_16x16x64_bf16 v[48:51], v[44:47], v[72:79], v3
  s_nop 7
  v_permlane32_swap_b32 v48, v50
  v_permlane32_swap_b32 v49, v51
  v_add_f32 v48, v48, v50
  v_add_f32 v49, v49, v51
  v_cvt_pk_bf16_f32 v160, v48, v49
  v_cmp_u_f32 vcc, v48, v49
  s_nop 0
  v_mov_b32_dpp v161, v160 quad_perm:[1,0,3,2] row_mask:0xf bank_mask:0xf
  v_perm_b32 v160, v161, v160, v5
  v_min_u32 v160, -2, v160
  s_cbranch_vccnz cA_va1_rp
cA_va1_cont:
  buffer_store_dword v160, v1, s[8:11], s21 offen
  s_cmp_lg_u32 s19, 62
  s_cbranch_scc1 cA_va1_nl
  buffer_store_dword v160, v1, s[8:11], s38 offen sc1
  s_waitcnt vmcnt(0)
  buffer_wbl2 sc1
  s_branch cA_done
cA_va1_nl:
  s_add_u32 s25, s25, 458752
  v_mov_b32 v36, 0
  v_mov_b32 v37, 0
  v_mov_b32 v38, 0
  v_mov_b32 v39, 0
  v_mov_b32 v40, 0
  v_mov_b32 v41, 0
  v_mov_b32 v42, 0
  v_mov_b32 v43, 0
  v_mov_b32 v44, 0
  v_mov_b32 v45, 0
  v_mov_b32 v46, 0
  v_mov_b32 v47, 0
  v_mov_b32 v48, 0
  v_mov_b32 v49, 0
  v_mov_b32 v50, 0
  v_mov_b32 v51, 0
  v_mov_b32 v52, 0
  v_mov_b32 v53, 0
  v_mov_b32 v54, 0
  v_mov_b32 v55, 0
  v_mov_b32 v56, 0
  v_mov_b32 v57, 0
  v_mov_b32 v58, 0
  v_mov_b32 v59, 0
  v_mov_b32 v60, 0
  v_mov_b32 v61, 0
  v_mov_b32 v62, 0
  v_mov_b32 v63, 0
  s_mov_b32 s19, s18
  s_add_u32 s18, s18, 1
  s_mov_b32 s22, s20
  s_mov_b32 s20, s21
  s_mov_b32 s21, s22
  s_add_u32 s23, s20, 4096
  s_branch cA_va1_loop
cA_va1_slow:
  s_waitcnt lgkmcnt(0)
cA_va1_sl1:
  s_add_u32 s31, s31, 0x1000000
  buffer_load_dwordx4 v[8:11], v2, s[8:11], s20 offen offset:0 sc1
  buffer_load_dwordx4 v[12:15], v2, s[8:11], s20 offen offset:1024 sc1
  buffer_load_dwordx4 v[16:19], v2, s[8:11], s20 offen offset:2048 sc1
  buffer_load_dwordx4 v[20:23], v2, s[8:11], s20 offen offset:3072 sc1
  buffer_load_dwordx4 v[24:27], v2, s[8:11], s23 offen offset:0 sc1
  buffer_load_dwordx4 v[28:31], v2, s[8:11], s23 offen offset:1024 sc1
  buffer_load_dwordx4 v[32:35], v2, s[8:11], s23 offen offset:2048 sc1
  s_waitcnt vmcnt(0)
  v_max3_u32 v36, v8, v9, v10
  v_max3_u32 v36, v36, v11, v12
  v_max3_u32 v36, v36, v13, v14
  v_max3_u32 v36, v36, v15, v16
  v_max3_u32 v36, v36, v17, v18
  v_max3_u32 v36, v36, v19, v20
  v_max3_u32 v36, v36, v21, v22
  v_max3_u32 v36, v36, v23, v24
  v_max3_u32 v36, v36, v25, v26
  v_max3_u32 v36, v36, v27, v28
  v_max3_u32 v36, v36, v29, v30
  v_max3_u32 v36, v36, v31, v32
  v_max3_u32 v36, v36, v33, v34
  v_max_u32 v36, v36, v35
  v_cmp_eq_u32 vcc, -1, v36
  s_cbranch_vccz cA_va1_sl2
  s_add_u32 s30, s30, 1
  s_cmp_lt_u32 s30, 400000
  s_cbranch_scc1 cA_va1_sl1
  s_branch cA_abort
cA_va1_sl2:
  v_mov_b32 v36, 0
  v_mov_b32 v37, 0
  v_mov_b32 v38, 0
  v_mov_b32 v39, 0
  v_mov_b32 v40, 0
  v_mov_b32 v41, 0
  v_mov_b32 v42, 0
  v_mov_b32 v43, 0
  v_mov_b32 v44, 0
  v_mov_b32 v45, 0
  v_mov_b32 v46, 0
  v_mov_b32 v47, 0
  v_mov_b32 v48, 0
  v_mov_b32 v49, 0
  v_mov_b32 v50, 0
  v_mov_b32 v51, 0
  v_mov_b32 v52, 0
  v_mov_b32 v53, 0
  v_mov_b32 v54, 0
  v_mov_b32 v55, 0
  v_mov_b32 v56, 0
  v_mov_b32 v57, 0
  v_mov_b32 v58, 0
  v_mov_b32 v59, 0
  v_mov_b32 v60, 0
  v_mov_b32 v61, 0
  v_mov_b32 v62, 0
  v_mov_b32 v63, 0
  buffer_store_dword v162, v1, s[8:11], s21 offen
  ds_read_b128 v[64:67], v0 offset:0
  ds_read_b128 v[68:71], v0 offset:1024
  v_smfmac_f32_16x16x64_bf16 v[36:39], v[8:11], a[0:7], v3
  v_smfmac_f32_16x16x64_bf16 v[40:43], v[8:11], a[56:63], v3
  v_smfmac_f32_16x16x64_bf16 v[44:47], v[8:11], a[112:119], v3
  v_smfmac_f32_16x16x64_bf16 v[48:51], v[8:11], a[168:175], v3
  v_smfmac_f32_16x16x64_bf16 v[52:55], v[8:11], a[224:231], v3
  v_smfmac_f32_16x16x64_bf16 v[56:59], v[8:11], v[200:207], v3
  s_waitcnt lgkmcnt(0)
  v_smfmac_f32_16x16x64_bf16 v[60:63], v[8:11], v[64:71], v3
  ds_read_b128 v[72:75], v0 offset:2048
  ds_read_b128 v[76:79], v0 offset:3072
  v_smfmac_f32_16x16x64_bf16 v[36:39], v[12:15], a[8:15], v3
  v_smfmac_f32_16x16x64_bf16 v[40:43], v[12:15], a[64:71], v3
  v_smfmac_f32_16x16x64_bf16 v[44:47], v[12:15], a[120:127], v3
  v_smfmac_f32_16x16x64_bf16 v[48:51], v[12:15], a[176:183], v3
  v_smfmac_f32_16x16x64_bf16 v[52:55], v[12:15], a[232:239], v3
  v_smfmac_f32_16x16x64_bf16 v[56:59], v[12:15], v[208:215], v3
  s_waitcnt lgkmcnt(0)
  v_smfmac_f32_16x16x64_bf16 v[60:63], v[12:15], v[72:79], v3
  ds_read_b128 v[144:147], v0 offset:4096
  ds_read_b128 v[148:151], v0 offset:5120
  v_smfmac_f32_16x16x64_bf16 v[36:39], v[16:19], a[16:23], v3
  v_smfmac_f32_16x16x64_bf16 v[40:43], v[16:19], a[72:79], v3
  v_smfmac_f32_16x16x64_bf16 v[44:47], v[16:19], a[128:135], v3
  v_smfmac_f32_16x16x64_bf16 v[48:51], v[16:19], a[184:191], v3
  v_smfmac_f32_16x16x64_bf16 v[52:55], v[16:19], a[240:247], v3
  v_smfmac_f32_16x16x64_bf16 v[56:59], v[16:19], v[216:223], v3
  s_waitcnt lgkmcnt(0)
  v_smfmac_f32_16x16x64_bf16 v[60:63], v[16:19], v[144:151], v3
  ds_read_b128 v[64:67], v0 offset:6144
  ds_read_b128 v[68:71], v0 offset:7168
  v_smfmac_f32_16x16x64_bf16 v[36:39], v[20:23], a[24:31], v3
  v_smfmac_f32_16x16x64_bf16 v[40:43], v[20:23], a[80:87], v3
  v_smfmac_f32_16x16x64_bf16 v[44:47], v[20:23], a[136:143], v3
  v_smfmac_f32_16x16x64_bf16 v[48:51], v[20:23], a[192:199], v3
  v_smfmac_f32_16x16x64_bf16 v[52:55], v[20:23], a[248:255], v3
  v_smfmac_f32_16x16x64_bf16 v[56:59], v[20:23], v[224:231], v3
  s_waitcnt lgkmcnt(0)
  v_smfmac_f32_16x16x64_bf16 v[60:63], v[20:23], v[64:71], v3
  ds_read_b128 v[72:75], v0 offset:8192
  ds_read_b128 v[76:79], v0 offset:9216
  v_smfmac_f32_16x16x64_bf16 v[36:39], v[24:27], a[32:39], v3
  v_smfmac_f32_16x16x64_bf16 v[40:43], v[24:27], a[88:95], v3
  v_smfmac_f32_16x16x64_bf16 v[44:47], v[24:27], a[144:151], v3
  v_smfmac_f32_16x16x64_bf16 v[48:51], v[24:27], a[200:207], v3
  v_smfmac_f32_16x16x64_bf16 v[52:55], v[24:27], v[176:183], v3
  v_smfmac_f32_16x16x64_bf16 v[56:59], v[24:27], v[232:239], v3
  s_waitcnt lgkmcnt(0)
  v_smfmac_f32_16x16x64_bf16 v[60:63], v[24:27], v[72:79], v3
  ds_read_b128 v[144:147], v0 offset:10240
  ds_read_b128 v[148:151], v0 offset:11264
  v_smfmac_f32_16x16x64_bf16 v[36:39], v[28:31], a[40:47], v3
  v_smfmac_f32_16x16x64_bf16 v[40:43], v[28:31], a[96:103], v3
  v_smfmac_f32_16x16x64_bf16 v[44:47], v[28:31], a[152:159], v3
  v_smfmac_f32_16x16x64_bf16 v[48:51], v[28:31], a[208:215], v3
  v_smfmac_f32_16x16x64_bf16 v[52:55], v[28:31], v[184:191], v3
  v_smfmac_f32_16x16x64_bf16 v[56:59], v[28:31], v[240:247], v3
  s_waitcnt lgkmcnt(0)
  v_smfmac_f32_16x16x64_bf16 v[60:63], v[28:31], v[144:151], v3
  ds_read_b128 v[64:67], v0 offset:12288
  ds_read_b128 v[68:71], v0 offset:13312
  v_smfmac_f32_16x16x64_bf16 v[36:39], v[32:35], a[48:55], v3
  v_smfmac_f32_16x16x64_bf16 v[40:43], v[32:35], a[104:111], v3
  v_smfmac_f32_16x16x64_bf16 v[44:47], v[32:35], a[160:167], v3
  v_smfmac_f32_16x16x64_bf16 v[48:51], v[32:35], a[216:223], v3
  v_smfmac_f32_16x16x64_bf16 v[52:55], v[32:35], v[192:199], v3
  v_smfmac_f32_16x16x64_bf16 v[56:59], v[32:35], v[248:255], v3
  s_waitcnt lgkmcnt(0)
  v_smfmac_f32_16x16x64_bf16 v[60:63], v[32:35], v[64:71], v3
  v_permlane32_swap_b32 v36, v38
  v_permlane32_swap_b32 v37, v39
  v_add_f32 v36, v36, v38
  v_add_f32 v37, v37, v39
  v_cvt_pk_bf16_f32 v38, v36, v37
  ds_write_b32 v152, v38
  v_permlane32_swap_b32 v40, v42
  v_permlane32_swap_b32 v41, v43
  v_add_f32 v40, v40, v42
  v_add_f32 v41, v41, v43
  v_cvt_pk_bf16_f32 v42, v40, v41
  ds_write_b32 v153, v42
  v_permlane32_swap_b32 v44, v46
  v_permlane32_swap_b32 v45, v47
  v_add_f32 v44, v44, v46
  v_add_f32 v45, v45, v47
  v_cvt_pk_bf16_f32 v46, v44, v45
  ds_write_b32 v154, v46
  v_permlane32_swap_b32 v48, v50
  v_permlane32_swap_b32 v49, v51
  v_add_f32 v48, v48, v50
  v_add_f32 v49, v49, v51
  v_cvt_pk_bf16_f32 v50, v48, v49
  ds_write_b32 v155, v50
  v_permlane32_swap_b32 v52, v54
  v_permlane32_swap_b32 v53, v55
  v_add_f32 v52, v52, v54
  v_add_f32 v53, v53, v55
  v_cvt_pk_bf16_f32 v54, v52, v53
  ds_write_b32 v156, v54
  v_permlane32_swap_b32 v56, v58
  v_permlane32_swap_b32 v57, v59
  v_add_f32 v56, v56, v58
  v_add_f32 v57, v57, v59
  v_cvt_pk_bf16_f32 v58, v56, v57
  ds_write_b32 v157, v58
  v_permlane32_swap_b32 v60, v62
  v_permlane32_swap_b32 v61, v63
  v_add_f32 v60, v60, v62
  v_add_f32 v61, v61, v63
  v_cvt_pk_bf16_f32 v62, v60, v61
  ds_write_b32 v158, v62
  s_branch cA_va1_t2d
cA_va1_rp:
  s_cmp_lg_u32 s37, 0
  s_cbranch_scc1 cA_va1_cont
cA_va1_rv:
  s_add_u32 s31, s31, 0x10000
  buffer_load_dwordx4 v[8:11], v2, s[8:11], s22 offen offset:0 sc1
  buffer_load_dwordx4 v[12:15], v2, s[8:11], s22 offen offset:1024 sc1
  buffer_load_dwordx4 v[16:19], v2, s[8:11], s22 offen offset:2048 sc1
  buffer_load_dwordx4 v[20:23], v2, s[8:11], s22 offen offset:3072 sc1
  buffer_load_dwordx4 v[24:27], v2, s[8:11], s34 offen offset:0 sc1
  buffer_load_dwordx4 v[28:31], v2, s[8:11], s34 offen offset:1024 sc1
  buffer_load_dwordx4 v[32:35], v2, s[8:11], s34 offen offset:2048 sc1
  buffer_load_dwordx4 v[36:39], v2, s[8:11], s34 offen offset:3072 sc1
  buffer_load_dwordx4 v[40:43], v2, s[8:11], s36 offen offset:0 sc1
  buffer_load_dwordx4 v[44:47], v2, s[8:11], s36 offen offset:1024 sc1
  s_waitcnt vmcnt(0)
  v_max3_u32 v52, v8, v9, v10
  v_max3_u32 v52, v52, v11, v12
  v_max3_u32 v52, v52, v13, v14
  v_max3_u32 v52, v52, v15, v16
  v_max3_u32 v52, v52, v17, v18
  v_max3_u32 v52, v52, v19, v20
  v_max3_u32 v52, v52, v21, v22
  v_max3_u32 v52, v52, v23, v24
  v_max3_u32 v52, v52, v25, v26
  v_max3_u32 v52, v52, v27, v28
  v_max3_u32 v52, v52, v29, v30
  v_max3_u32 v52, v52, v31, v32
  v_max3_u32 v52, v52, v33, v34
  v_max3_u32 v52, v52, v35, v36
  v_max3_u32 v52, v52, v37, v38
  v_max3_u32 v52, v52, v39, v40
  v_max3_u32 v52, v52, v41, v42
  v_max3_u32 v52, v52, v43, v44
  v_max3_u32 v52, v52, v45, v46
  v_max_u32 v52, v52, v47
  v_cmp_eq_u32 vcc, -1, v52
  s_mov_b32 s37, 1
  v_mov_b32 v48, 0
  v_mov_b32 v49, 0
  v_mov_b32 v50, 0
  v_mov_b32 v51, 0
  s_nop 1
  s_cbranch_vccz cA_va1_lp
  s_add_u32 s30, s30, 1
  s_cmp_lt_u32 s30, 400000
  s_cbranch_scc1 cA_va1_rv
  s_branch cA_abort
.p2align 6
cA_va2_loop:
  s_mov_b32 s30, 0
  buffer_load_dword v100, v119, s[8:11], 0 offen sc1
  buffer_load_dword v101, v119, s[8:11], 0 offen sc1
  buffer_load_dword v102, v119, s[8:11], 0 offen sc1
  buffer_load_dword v103, v119, s[8:11], 0 offen sc1
cA_va2_fp_l:
  s_waitcnt vmcnt(3)
  v_cmp_gt_u32 vcc, s19, v100
  s_cbranch_vccz cA_va2_fp_d
  buffer_load_dword v100, v119, s[8:11], 0 offen sc1
  s_waitcnt vmcnt(3)
  v_cmp_gt_u32 vcc, s19, v101
  s_cbranch_vccz cA_va2_fp_d
  buffer_load_dword v101, v119, s[8:11], 0 offen sc1
  s_waitcnt vmcnt(3)
  v_cmp_gt_u32 vcc, s19, v102
  s_cbranch_vccz cA_va2_fp_d
  buffer_load_dword v102, v119, s[8:11], 0 offen sc1
  s_waitcnt vmcnt(3)
  v_cmp_gt_u32 vcc, s19, v103
  s_cbranch_vccz cA_va2_fp_d
  buffer_load_dword v103, v119, s[8:11], 0 offen sc1
  s_add_u32 s30, s30, 1
  s_cmp_lt_u32 s30, 400000
  s_cbranch_scc1 cA_va2_fp_l
  s_branch cA_abort
cA_va2_fp_d:
  buffer_load_dwordx4 v[8:11], v2, s[8:11], s20 offen offset:0 sc1
  buffer_load_dwordx4 v[12:15], v2, s[8:11], s20 offen offset:1024 sc1
  s_barrier
  s_barrier
  s_waitcnt vmcnt(0)
  ds_write_b128 v2, v[8:11] offset:8192
  ds_write_b128 v2, v[12:15] offset:9216
  v_smfmac_f32_16x16x64_bf16 v[36:39], v[8:11], a[0:7], v3
  v_smfmac_f32_16x16x64_bf16 v[40:43], v[8:11], a[56:63], v3
  v_smfmac_f32_16x16x64_bf16 v[44:47], v[8:11], a[112:119], v3
  v_smfmac_f32_16x16x64_bf16 v[48:51], v[8:11], a[168:175], v3
  v_smfmac_f32_16x16x64_bf16 v[52:55], v[8:11], a[224:231], v3
  s_waitcnt lgkmcnt(0)
  s_barrier
  ds_read_b128 v[16:19], v2 offset:10240
  ds_read_b128 v[20:23], v2 offset:11264
  ds_read_b128 v[24:27], v2 offset:12288
  ds_read_b128 v[28:31], v2 offset:13312
  ds_read_b128 v[32:35], v2 offset:14336
  v_smfmac_f32_16x16x64_bf16 v[56:59], v[8:11], v[144:151], v3
  v_smfmac_f32_16x16x64_bf16 v[60:63], v[8:11], v[200:207], v3
  v_smfmac_f32_16x16x64_bf16 v[36:39], v[12:15], a[8:15], v3
  v_smfmac_f32_16x16x64_bf16 v[40:43], v[12:15], a[64:71], v3
  v_smfmac_f32_16x16x64_bf16 v[44:47], v[12:15], a[120:127], v3
  v_smfmac_f32_16x16x64_bf16 v[48:51], v[12:15], a[176:183], v3
  v_smfmac_f32_16x16x64_bf16 v[52:55], v[12:15], a[232:239], v3
  v_smfmac_f32_16x16x64_bf16 v[56:59], v[12:15], v[152:159], v3
  v_smfmac_f32_16x16x64_bf16 v[60:63], v[12:15], v[208:215], v3
  s_waitcnt lgkmcnt(4)
  v_smfmac_f32_16x16x64_bf16 v[36:39], v[16:19], a[16:23], v3
  s_waitcnt lgkmcnt(3)
  v_smfmac_f32_16x16x64_bf16 v[36:39], v[20:23], a[24:31], v3
  s_waitcnt lgkmcnt(2)
  v_smfmac_f32_16x16x64_bf16 v[36:39], v[24:27], a[32:39], v3
  s_waitcnt lgkmcnt(1)
  v_smfmac_f32_16x16x64_bf16 v[36:39], v[28:31], a[40:47], v3
  s_waitcnt lgkmcnt(0)
  v_smfmac_f32_16x16x64_bf16 v[36:39], v[32:35], a[48:55], v3
  v_smfmac_f32_16x16x64_bf16 v[40:43], v[16:19], a[72:79], v3
  v_smfmac_f32_16x16x64_bf16 v[40:43], v[20:23], a[80:87], v3
  v_smfmac_f32_16x16x64_bf16 v[40:43], v[24:27], a[88:95], v3
  v_permlane32_swap_b32 v36, v38
  v_smfmac_f32_16x16x64_bf16 v[40:43], v[28:31], a[96:103], v3
  v_permlane32_swap_b32 v37, v39
  v_smfmac_f32_16x16x64_bf16 v[40:43], v[32:35], a[104:111], v3
  v_add_f32 v36, v36, v38
  v_smfmac_f32_16x16x64_bf16 v[44:47], v[16:19], a[128:135], v3
  v_add_f32 v37, v37, v39
  v_smfmac_f32_16x16x64_bf16 v[44:47], v[20:23], a[136:143], v3
  v_cmp_u_f32 vcc, v36, v37
  v_smfmac_f32_16x16x64_bf16 v[44:47], v[24:27], a[144:151], v3
  v_cvt_pk_bf16_f32 v38, v36, v37
  v_smfmac_f32_16x16x64_bf16 v[44:47], v[28:31], a[152:159], v3
  ds_write_b32 v104, v38
  s_cbranch_vccnz cA_va2_slow
  v_permlane32_swap_b32 v40, v42
  v_smfmac_f32_16x16x64_bf16 v[44:47], v[32:35], a[160:167], v3
  v_permlane32_swap_b32 v41, v43
  v_smfmac_f32_16x16x64_bf16 v[48:51], v[16:19], a[184:191], v3
  v_add_f32 v40, v40, v42
  v_smfmac_f32_16x16x64_bf16 v[48:51], v[20:23], a[192:199], v3
  v_add_f32 v41, v41, v43
  v_smfmac_f32_16x16x64_bf16 v[48:51], v[24:27], a[200:207], v3
  v_cvt_pk_bf16_f32 v42, v40, v41
  v_smfmac_f32_16x16x64_bf16 v[48:51], v[28:31], a[208:215], v3
  ds_write_b32 v105, v42
  v_permlane32_swap_b32 v44, v46
  v_smfmac_f32_16x16x64_bf16 v[48:51], v[32:35], a[216:223], v3
  v_permlane32_swap_b32 v45, v47
  v_smfmac_f32_16x16x64_bf16 v[52:55], v[16:19], a[240:247], v3
  v_add_f32 v44, v44, v46
  v_smfmac_f32_16x16x64_bf16 v[52:55], v[20:23], a[248:255], v3
  v_add_f32 v45, v45, v47
  v_smfmac_f32_16x16x64_bf16 v[52:55], v[24:27], v[120:127], v3
  v_cvt_pk_bf16_f32 v46, v44, v45
  v_smfmac_f32_16x16x64_bf16 v[52:55], v[28:31], v[128:135], v3
  ds_write_b32 v106, v46
  v_permlane32_swap_b32 v48, v50
  v_smfmac_f32_16x16x64_bf16 v[52:55], v[32:35], v[136:143], v3
  v_permlane32_swap_b32 v49, v51
  v_smfmac_f32_16x16x64_bf16 v[56:59], v[16:19], v[160:167], v3
  v_add_f32 v48, v48, v50
  v_smfmac_f32_16x16x64_bf16 v[56:59], v[20:23], v[168:175], v3
  v_add_f32 v49, v49, v51
  v_smfmac_f32_16x16x64_bf16 v[56:59], v[24:27], v[176:183], v3
  v_cvt_pk_bf16_f32 v50, v48, v49
  v_smfmac_f32_16x16x64_bf16 v[56:59], v[28:31], v[184:191], v3
  ds_write_b32 v107, v50
  v_permlane32_swap_b32 v52, v54
  v_smfmac_f32_16x16x64_bf16 v[56:59], v[32:35], v[192:199], v3
  v_permlane32_swap_b32 v53, v55
  v_smfmac_f32_16x16x64_bf16 v[60:63], v[16:19], v[216:223], v3
  v_add_f32 v52, v52, v54
  v_smfmac_f32_16x16x64_bf16 v[60:63], v[20:23], v[224:231], v3
  v_add_f32 v53, v53, v55
  v_smfmac_f32_16x16x64_bf16 v[60:63], v[24:27], v[232:239], v3
  v_cvt_pk_bf16_f32 v54, v52, v53
  v_smfmac_f32_16x16x64_bf16 v[60:63], v[28:31], v[240:247], v3
  ds_write_b32 v108, v54
  v_permlane32_swap_b32 v56, v58
  v_smfmac_f32_16x16x64_bf16 v[60:63], v[32:35], v[248:255], v3
  v_permlane32_swap_b32 v57, v59
  v_add_f32 v56, v56, v58
  v_add_f32 v57, v57, v59
  v_cvt_pk_bf16_f32 v58, v56, v57
  ds_write_b32 v109, v58
  s_nop 2
  v_permlane32_swap_b32 v60, v62
  v_permlane32_swap_b32 v61, v63
  v_add_f32 v60, v60, v62
  v_add_f32 v61, v61, v63
  v_cvt_pk_bf16_f32 v62, v60, v61
  ds_write_b32 v110, v62
cA_va2_t2d:
  v_mov_b32 v117, s18
  s_waitcnt lgkmcnt(0)
  s_barrier
  s_cmp_eq_u32 s19, 62
  s_cbranch_scc1 cA_done
  s_sleep 1
  v_mov_b32 v36, 0
  v_mov_b32 v37, 0
  v_mov_b32 v38, 0
  v_mov_b32 v39, 0
  v_mov_b32 v40, 0
  v_mov_b32 v41, 0
  v_mov_b32 v42, 0
  v_mov_b32 v43, 0
  v_mov_b32 v44, 0
  v_mov_b32 v45, 0
  v_mov_b32 v46, 0
  v_mov_b32 v47, 0
  v_mov_b32 v48, 0
  v_mov_b32 v49, 0
  v_mov_b32 v50, 0
  v_mov_b32 v51, 0
  v_mov_b32 v52, 0
  v_mov_b32 v53, 0
  v_mov_b32 v54, 0
  v_mov_b32 v55, 0
  v_mov_b32 v56, 0
  v_mov_b32 v57, 0
  v_mov_b32 v58, 0
  v_mov_b32 v59, 0
  v_mov_b32 v60, 0
  v_mov_b32 v61, 0
  v_mov_b32 v62, 0
  v_mov_b32 v63, 0
  s_sleep 3
  s_mov_b32 s19, s18
  s_add_u32 s18, s18, 1
  s_mov_b32 s22, s20
  s_mov_b32 s20, s21
  s_mov_b32 s21, s22
  s_add_u32 s23, s20, 4096
  s_branch cA_va2_loop
cA_va2_slow:
  s_waitcnt lgkmcnt(0)
cA_va2_sl1:
  s_add_u32 s31, s31, 0x1000000
  buffer_load_dwordx4 v[8:11], v2, s[8:11], s20 offen offset:0 sc1
  buffer_load_dwordx4 v[12:15], v2, s[8:11], s20 offen offset:1024 sc1
  buffer_load_dwordx4 v[16:19], v2, s[8:11], s20 offen offset:2048 sc1
  buffer_load_dwordx4 v[20:23], v2, s[8:11], s20 offen offset:3072 sc1
  buffer_load_dwordx4 v[24:27], v2, s[8:11], s23 offen offset:0 sc1
  buffer_load_dwordx4 v[28:31], v2, s[8:11], s23 offen offset:1024 sc1
  buffer_load_dwordx4 v[32:35], v2, s[8:11], s23 offen offset:2048 sc1
  s_waitcnt vmcnt(0)
  v_max3_u32 v36, v8, v9, v10
  v_max3_u32 v36, v36, v11, v12
  v_max3_u32 v36, v36, v13, v14
  v_max3_u32 v36, v36, v15, v16
  v_max3_u32 v36, v36, v17, v18
  v_max3_u32 v36, v36, v19, v20
  v_max3_u32 v36, v36, v21, v22
  v_max3_u32 v36, v36, v23, v24
  v_max3_u32 v36, v36, v25, v26
  v_max3_u32 v36, v36, v27, v28
  v_max3_u32 v36, v36, v29, v30
  v_max3_u32 v36, v36, v31, v32
  v_max3_u32 v36, v36, v33, v34
  v_max_u32 v36, v36, v35
  v_cmp_eq_u32 vcc, -1, v36
  s_cbranch_vccz cA_va2_sl2
  s_add_u32 s30, s30, 1
  s_cmp_lt_u32 s30, 400000
  s_cbranch_scc1 cA_va2_sl1
  s_branch cA_abort
cA_va2_sl2:
  v_mov_b32 v36, 0
  v_mov_b32 v37, 0
  v_mov_b32 v38, 0
  v_mov_b32 v39, 0
  v_mov_b32 v40, 0
  v_mov_b32 v41, 0
  v_mov_b32 v42, 0
  v_mov_b32 v43, 0
  v_mov_b32 v44, 0
  v_mov_b32 v45, 0
  v_mov_b32 v46, 0
  v_mov_b32 v47, 0
  v_mov_b32 v48, 0
  v_mov_b32 v49, 0
  v_mov_b32 v50, 0
  v_mov_b32 v51, 0
  v_mov_b32 v52, 0
  v_mov_b32 v53, 0
  v_mov_b32 v54, 0
  v_mov_b32 v55, 0
  v_mov_b32 v56, 0
  v_mov_b32 v57, 0
  v_mov_b32 v58, 0
  v_mov_b32 v59, 0
  v_mov_b32 v60, 0
  v_mov_b32 v61, 0
  v_mov_b32 v62, 0
  v_mov_b32 v63, 0
  v_smfmac_f32_16x16x64_bf16 v[36:39], v[8:11], a[0:7], v3
  v_smfmac_f32_16x16x64_bf16 v[40:43], v[8:11], a[56:63], v3
  v_smfmac_f32_16x16x64_bf16 v[44:47], v[8:11], a[112:119], v3
  v_smfmac_f32_16x16x64_bf16 v[48:51], v[8:11], a[168:175], v3
  v_smfmac_f32_16x16x64_bf16 v[52:55], v[8:11], a[224:231], v3
  v_smfmac_f32_16x16x64_bf16 v[56:59], v[8:11], v[144:151], v3
  v_smfmac_f32_16x16x64_bf16 v[60:63], v[8:11], v[200:207], v3
  v_smfmac_f32_16x16x64_bf16 v[36:39], v[12:15], a[8:15], v3
  v_smfmac_f32_16x16x64_bf16 v[40:43], v[12:15], a[64:71], v3
  v_smfmac_f32_16x16x64_bf16 v[44:47], v[12:15], a[120:127], v3
  v_smfmac_f32_16x16x64_bf16 v[48:51], v[12:15], a[176:183], v3
  v_smfmac_f32_16x16x64_bf16 v[52:55], v[12:15], a[232:239], v3
  v_smfmac_f32_16x16x64_bf16 v[56:59], v[12:15], v[152:159], v3
  v_smfmac_f32_16x16x64_bf16 v[60:63], v[12:15], v[208:215], v3
  v_smfmac_f32_16x16x64_bf16 v[36:39], v[16:19], a[16:23], v3
  v_smfmac_f32_16x16x64_bf16 v[40:43], v[16:19], a[72:79], v3
  v_smfmac_f32_16x16x64_bf16 v[44:47], v[16:19], a[128:135], v3
  v_smfmac_f32_16x16x64_bf16 v[48:51], v[16:19], a[184:191], v3
  v_smfmac_f32_16x16x64_bf16 v[52:55], v[16:19], a[240:247], v3
  v_smfmac_f32_16x16x64_bf16 v[56:59], v[16:19], v[160:167], v3
  v_smfmac_f32_16x16x64_bf16 v[60:63], v[16:19], v[216:223], v3
  v_smfmac_f32_16x16x64_bf16 v[36:39], v[20:23], a[24:31], v3
  v_smfmac_f32_16x16x64_bf16 v[40:43], v[20:23], a[80:87], v3
  v_smfmac_f32_16x16x64_bf16 v[44:47], v[20:23], a[136:143], v3
  v_smfmac_f32_16x16x64_bf16 v[48:51], v[20:23], a[192:199], v3
  v_smfmac_f32_16x16x64_bf16 v[52:55], v[20:23], a[248:255], v3
  v_smfmac_f32_16x16x64_bf16 v[56:59], v[20:23], v[168:175], v3
  v_smfmac_f32_16x16x64_bf16 v[60:63], v[20:23], v[224:231], v3
  v_smfmac_f32_16x16x64_bf16 v[36:39], v[24:27], a[32:39], v3
  v_smfmac_f32_16x16x64_bf16 v[40:43], v[24:27], a[88:95], v3
  v_smfmac_f32_16x16x64_bf16 v[44:47], v[24:27], a[144:151], v3
  v_smfmac_f32_16x16x64_bf16 v[48:51], v[24:27], a[200:207], v3
  v_smfmac_f32_16x16x64_bf16 v[52:55], v[24:27], v[120:127], v3
  v_smfmac_f32_16x16x64_bf16 v[56:59], v[24:27], v[176:183], v3
  v_smfmac_f32_16x16x64_bf16 v[60:63], v[24:27], v[232:239], v3
  v_smfmac_f32_16x16x64_bf16 v[36:39], v[28:31], a[40:47], v3
  v_smfmac_f32_16x16x64_bf16 v[40:43], v[28:31], a[96:103], v3
  v_smfmac_f32_16x16x64_bf16 v[44:47], v[28:31], a[152:159], v3
  v_smfmac_f32_16x16x64_bf16 v[48:51], v[28:31], a[208:215], v3
  v_smfmac_f32_16x16x64_bf16 v[52:55], v[28:31], v[128:135], v3
  v_smfmac_f32_16x16x64_bf16 v[56:59], v[28:31], v[184:191], v3
  v_smfmac_f32_16x16x64_bf16 v[60:63], v[28:31], v[240:247], v3
  v_smfmac_f32_16x16x64_bf16 v[36:39], v[32:35], a[48:55], v3
  v_smfmac_f32_16x16x64_bf16 v[40:43], v[32:35], a[104:111], v3
  v_smfmac_f32_16x16x64_bf16 v[44:47], v[32:35], a[160:167], v3
  v_smfmac_f32_16x16x64_bf16 v[48:51], v[32:35], a[216:223], v3
  v_smfmac_f32_16x16x64_bf16 v[52:55], v[32:35], v[136:143], v3
  v_smfmac_f32_16x16x64_bf16 v[56:59], v[32:35], v[192:199], v3
  v_smfmac_f32_16x16x64_bf16 v[60:63], v[32:35], v[248:255], v3
  v_permlane32_swap_b32 v36, v38
  v_permlane32_swap_b32 v37, v39
  v_add_f32 v36, v36, v38
  v_add_f32 v37, v37, v39
  v_cvt_pk_bf16_f32 v38, v36, v37
  ds_write_b32 v104, v38
  v_permlane32_swap_b32 v40, v42
  v_permlane32_swap_b32 v41, v43
  v_add_f32 v40, v40, v42
  v_add_f32 v41, v41, v43
  v_cvt_pk_bf16_f32 v42, v40, v41
  ds_write_b32 v105, v42
  v_permlane32_swap_b32 v44, v46
  v_permlane32_swap_b32 v45, v47
  v_add_f32 v44, v44, v46
  v_add_f32 v45, v45, v47
  v_cvt_pk_bf16_f32 v46, v44, v45
  ds_write_b32 v106, v46
  v_permlane32_swap_b32 v48, v50
  v_permlane32_swap_b32 v49, v51
  v_add_f32 v48, v48, v50
  v_add_f32 v49, v49, v51
  v_cvt_pk_bf16_f32 v50, v48, v49
  ds_write_b32 v107, v50
  v_permlane32_swap_b32 v52, v54
  v_permlane32_swap_b32 v53, v55
  v_add_f32 v52, v52, v54
  v_add_f32 v53, v53, v55
  v_cvt_pk_bf16_f32 v54, v52, v53
  ds_write_b32 v108, v54
  v_permlane32_swap_b32 v56, v58
  v_permlane32_swap_b32 v57, v59
  v_add_f32 v56, v56, v58
  v_add_f32 v57, v57, v59
  v_cvt_pk_bf16_f32 v58, v56, v57
  ds_write_b32 v109, v58
  v_permlane32_swap_b32 v60, v62
  v_permlane32_swap_b32 v61, v63
  v_add_f32 v60, v60, v62
  v_add_f32 v61, v61, v63
  v_cvt_pk_bf16_f32 v62, v60, v61
  ds_write_b32 v110, v62
  s_branch cA_va2_t2d
.p2align 6
cA_va3_loop:
  s_mov_b32 s30, 0
  s_barrier
  buffer_load_dwordx4 v[16:19], v2, s[8:11], s20 offen offset:2048 sc1
  buffer_load_dwordx4 v[20:23], v2, s[8:11], s20 offen offset:3072 sc1
  s_barrier
  buffer_load_dword v100, v116, s[8:11], s39 offen sc1
  s_add_u32 s27, s19, 2
  s_min_u32 s27, s27, 63
  s_lshr_b32 s27, s27, 3
  s_lshl_b32 s27, s27, 11
  s_add_u32 s27, s27, s35
  s_cmp_eq_u32 s27, s28
  s_cselect_b32 s29, 75729408, s27
  buffer_load_dword v101, off, s[8:11], s29 sc1
  s_add_u32 s39, s39, 28672
  s_waitcnt vmcnt(2)
  ds_write_b128 v2, v[16:19] offset:10240
  ds_write_b128 v2, v[20:23] offset:11264
  v_smfmac_f32_16x16x64_bf16 v[36:39], v[16:19], a[16:23], v3
  v_smfmac_f32_16x16x64_bf16 v[40:43], v[16:19], a[72:79], v3
  v_smfmac_f32_16x16x64_bf16 v[44:47], v[16:19], a[128:135], v3
  v_smfmac_f32_16x16x64_bf16 v[48:51], v[16:19], a[184:191], v3
  v_smfmac_f32_16x16x64_bf16 v[52:55], v[16:19], a[240:247], v3
  s_waitcnt lgkmcnt(0)
  s_barrier
  ds_read_b128 v[8:11], v2 offset:8192
  ds_read_b128 v[12:15], v2 offset:9216
  ds_read_b128 v[24:27], v2 offset:12288
  ds_read_b128 v[28:31], v2 offset:13312
  ds_read_b128 v[32:35], v2 offset:14336
  v_smfmac_f32_16x16x64_bf16 v[56:59], v[16:19], v[160:167], v3
  v_smfmac_f32_16x16x64_bf16 v[60:63], v[16:19], v[216:223], v3
  v_smfmac_f32_16x16x64_bf16 v[36:39], v[20:23], a[24:31], v3
  v_smfmac_f32_16x16x64_bf16 v[40:43], v[20:23], a[80:87], v3
  v_smfmac_f32_16x16x64_bf16 v[44:47], v[20:23], a[136:143], v3
  v_smfmac_f32_16x16x64_bf16 v[48:51], v[20:23], a[192:199], v3
  v_smfmac_f32_16x16x64_bf16 v[52:55], v[20:23], a[248:255], v3
  v_smfmac_f32_16x16x64_bf16 v[56:59], v[20:23], v[168:175], v3
  v_smfmac_f32_16x16x64_bf16 v[60:63], v[20:23], v[224:231], v3
  s_waitcnt lgkmcnt(4)
  v_smfmac_f32_16x16x64_bf16 v[36:39], v[8:11], a[0:7], v3
  s_waitcnt lgkmcnt(3)
  v_smfmac_f32_16x16x64_bf16 v[36:39], v[12:15], a[8:15], v3
  s_waitcnt lgkmcnt(2)
  v_smfmac_f32_16x16x64_bf16 v[36:39], v[24:27], a[32:39], v3
  s_waitcnt lgkmcnt(1)
  v_smfmac_f32_16x16x64_bf16 v[36:39], v[28:31], a[40:47], v3
  s_waitcnt lgkmcnt(0)
  v_smfmac_f32_16x16x64_bf16 v[36:39], v[32:35], a[48:55], v3
  v_smfmac_f32_16x16x64_bf16 v[40:43], v[8:11], a[56:63], v3
  v_smfmac_f32_16x16x64_bf16 v[40:43], v[12:15], a[64:71], v3
  v_smfmac_f32_16x16x64_bf16 v[40:43], v[24:27], a[88:95], v3
  v_permlane32_swap_b32 v36, v38
  v_smfmac_f32_16x16x64_bf16 v[40:43], v[28:31], a[96:103], v3
  v_permlane32_swap_b32 v37, v39
  v_smfmac_f32_16x16x64_bf16 v[40:43], v[32:35], a[104:111], v3
  v_add_f32 v36, v36, v38
  v_smfmac_f32_16x16x64_bf16 v[44:47], v[8:11], a[112:119], v3
  v_add_f32 v37, v37, v39
  v_smfmac_f32_16x16x64_bf16 v[44:47], v[12:15], a[120:127], v3
  v_cmp_u_f32 vcc, v36, v37
  v_smfmac_f32_16x16x64_bf16 v[44:47], v[24:27], a[144:151], v3
  v_cvt_pk_bf16_f32 v38, v36, v37
  v_smfmac_f32_16x16x64_bf16 v[44:47], v[28:31], a[152:159], v3
  ds_write_b32 v104, v38
  s_cbranch_vccnz cA_va3_slow
  v_permlane32_swap_b32 v40, v42
  v_smfmac_f32_16x16x64_bf16 v[44:47], v[32:35], a[160:167], v3
  v_permlane32_swap_b32 v41, v43
  v_smfmac_f32_16x16x64_bf16 v[48:51], v[8:11], a[168:175], v3
  v_add_f32 v40, v40, v42
  v_smfmac_f32_16x16x64_bf16 v[48:51], v[12:15], a[176:183], v3
  v_add_f32 v41, v41, v43
  v_smfmac_f32_16x16x64_bf16 v[48:51], v[24:27], a[200:207], v3
  v_cvt_pk_bf16_f32 v42, v40, v41
  v_smfmac_f32_16x16x64_bf16 v[48:51], v[28:31], a[208:215], v3
  ds_write_b32 v105, v42
  v_permlane32_swap_b32 v44, v46
  v_smfmac_f32_16x16x64_bf16 v[48:51], v[32:35], a[216:223], v3
  v_permlane32_swap_b32 v45, v47
  v_smfmac_f32_16x16x64_bf16 v[52:55], v[8:11], a[224:231], v3
  v_add_f32 v44, v44, v46
  v_smfmac_f32_16x16x64_bf16 v[52:55], v[12:15], a[232:239], v3
  v_add_f32 v45, v45, v47
  v_smfmac_f32_16x16x64_bf16 v[52:55], v[24:27], v[120:127], v3
  v_cvt_pk_bf16_f32 v46, v44, v45
  v_smfmac_f32_16x16x64_bf16 v[52:55], v[28:31], v[128:135], v3
  ds_write_b32 v106, v46
  v_permlane32_swap_b32 v48, v50
  v_smfmac_f32_16x16x64_bf16 v[52:55], v[32:35], v[136:143], v3
  v_permlane32_swap_b32 v49, v51
  v_smfmac_f32_16x16x64_bf16 v[56:59], v[8:11], v[144:151], v3
  v_add_f32 v48, v48, v50
  v_smfmac_f32_16x16x64_bf16 v[56:59], v[12:15], v[152:159], v3
  v_add_f32 v49, v49, v51
  v_smfmac_f32_16x16x64_bf16 v[56:59], v[24:27], v[176:183], v3
  v_cvt_pk_bf16_f32 v50, v48, v49
  v_smfmac_f32_16x16x64_bf16 v[56:59], v[28:31], v[184:191], v3
  ds_write_b32 v107, v50
  v_permlane32_swap_b32 v52, v54
  v_smfmac_f32_16x16x64_bf16 v[56:59], v[32:35], v[192:199], v3
  v_permlane32_swap_b32 v53, v55
  v_smfmac_f32_16x16x64_bf16 v[60:63], v[8:11], v[200:207], v3
  v_add_f32 v52, v52, v54
  v_smfmac_f32_16x16x64_bf16 v[60:63], v[12:15], v[208:215], v3
  v_add_f32 v53, v53, v55
  v_smfmac_f32_16x16x64_bf16 v[60:63], v[24:27], v[232:239], v3
  v_cvt_pk_bf16_f32 v54, v52, v53
  v_smfmac_f32_16x16x64_bf16 v[60:63], v[28:31], v[240:247], v3
  ds_write_b32 v108, v54
  v_permlane32_swap_b32 v56, v58
  v_smfmac_f32_16x16x64_bf16 v[60:63], v[32:35], v[248:255], v3
  v_permlane32_swap_b32 v57, v59
  v_add_f32 v56, v56, v58
  v_add_f32 v57, v57, v59
  v_cvt_pk_bf16_f32 v58, v56, v57
  ds_write_b32 v109, v58
  s_nop 2
  v_permlane32_swap_b32 v60, v62
  v_permlane32_swap_b32 v61, v63
  v_add_f32 v60, v60, v62
  v_add_f32 v61, v61, v63
  v_cvt_pk_bf16_f32 v62, v60, v61
  ds_write_b32 v110, v62
cA_va3_t2d:
  v_mov_b32 v117, s18
  s_cmp_eq_u32 s27, s28
  s_cbranch_scc1 cA_va3_vok
cA_va3_vow:
  s_waitcnt vmcnt(0)
  v_cmp_ne_u32 vcc, 56, v101
  s_cbranch_vccnz cA_va3_vor
  s_mov_b32 s28, s27
cA_va3_vok:
  s_waitcnt lgkmcnt(0)
  s_setprio 3
  s_barrier
  v_mov_b32 v36, 0
  v_mov_b32 v37, 0
  v_mov_b32 v38, 0
  v_mov_b32 v39, 0
  buffer_store_dword v117, v118, s[8:11], 0 offen
  s_setprio 0
  s_cmp_eq_u32 s19, 62
  s_cbranch_scc1 cA_done
  v_mov_b32 v40, 0
  v_mov_b32 v41, 0
  v_mov_b32 v42, 0
  v_mov_b32 v43, 0
  v_mov_b32 v44, 0
  v_mov_b32 v45, 0
  v_mov_b32 v46, 0
  v_mov_b32 v47, 0
  v_mov_b32 v48, 0
  v_mov_b32 v49, 0
  v_mov_b32 v50, 0
  v_mov_b32 v51, 0
  v_mov_b32 v52, 0
  v_mov_b32 v53, 0
  v_mov_b32 v54, 0
  v_mov_b32 v55, 0
  v_mov_b32 v56, 0
  v_mov_b32 v57, 0
  v_mov_b32 v58, 0
  v_mov_b32 v59, 0
  v_mov_b32 v60, 0
  v_mov_b32 v61, 0
  v_mov_b32 v62, 0
  v_mov_b32 v63, 0
  s_mov_b32 s19, s18
  s_add_u32 s18, s18, 1
  s_mov_b32 s22, s20
  s_mov_b32 s20, s21
  s_mov_b32 s21, s22
  s_add_u32 s23, s20, 4096
  s_branch cA_va3_loop
cA_va3_slow:
  s_waitcnt lgkmcnt(0)
cA_va3_sl1:
  s_add_u32 s31, s31, 0x1000000
  buffer_load_dwordx4 v[8:11], v2, s[8:11], s20 offen offset:0 sc1
  buffer_load_dwordx4 v[12:15], v2, s[8:11], s20 offen offset:1024 sc1
  buffer_load_dwordx4 v[16:19], v2, s[8:11], s20 offen offset:2048 sc1
  buffer_load_dwordx4 v[20:23], v2, s[8:11], s20 offen offset:3072 sc1
  buffer_load_dwordx4 v[24:27], v2, s[8:11], s23 offen offset:0 sc1
  buffer_load_dwordx4 v[28:31], v2, s[8:11], s23 offen offset:1024 sc1
  buffer_load_dwordx4 v[32:35], v2, s[8:11], s23 offen offset:2048 sc1
  s_waitcnt vmcnt(0)
  v_max3_u32 v36, v8, v9, v10
  v_max3_u32 v36, v36, v11, v12
  v_max3_u32 v36, v36, v13, v14
  v_max3_u32 v36, v36, v15, v16
  v_max3_u32 v36, v36, v17, v18
  v_max3_u32 v36, v36, v19, v20
  v_max3_u32 v36, v36, v21, v22
  v_max3_u32 v36, v36, v23, v24
  v_max3_u32 v36, v36, v25, v26
  v_max3_u32 v36, v36, v27, v28
  v_max3_u32 v36, v36, v29, v30
  v_max3_u32 v36, v36, v31, v32
  v_max3_u32 v36, v36, v33, v34
  v_max_u32 v36, v36, v35
  v_cmp_eq_u32 vcc, -1, v36
  s_cbranch_vccz cA_va3_sl2
  s_add_u32 s30, s30, 1
  s_cmp_lt_u32 s30, 400000
  s_cbranch_scc1 cA_va3_sl1
  s_branch cA_abort
cA_va3_sl2:
  v_mov_b32 v36, 0
  v_mov_b32 v37, 0
  v_mov_b32 v38, 0
  v_mov_b32 v39, 0
  v_mov_b32 v40, 0
  v_mov_b32 v41, 0
  v_mov_b32 v42, 0
  v_mov_b32 v43, 0
  v_mov_b32 v44, 0
  v_mov_b32 v45, 0
  v_mov_b32 v46, 0
  v_mov_b32 v47, 0
  v_mov_b32 v48, 0
  v_mov_b32 v49, 0
  v_mov_b32 v50, 0
  v_mov_b32 v51, 0
  v_mov_b32 v52, 0
  v_mov_b32 v53, 0
  v_mov_b32 v54, 0
  v_mov_b32 v55, 0
  v_mov_b32 v56, 0
  v_mov_b32 v57, 0
  v_mov_b32 v58, 0
  v_mov_b32 v59, 0
  v_mov_b32 v60, 0
  v_mov_b32 v61, 0
  v_mov_b32 v62, 0
  v_mov_b32 v63, 0
  v_smfmac_f32_16x16x64_bf16 v[36:39], v[8:11], a[0:7], v3
  v_smfmac_f32_16x16x64_bf16 v[40:43], v[8:11], a[56:63], v3
  v_smfmac_f32_16x16x64_bf16 v[44:47], v[8:11], a[112:119], v3
  v_smfmac_f32_16x16x64_bf16 v[48:51], v[8:11], a[168:175], v3
  v_smfmac_f32_16x16x64_bf16 v[52:55], v[8:11], a[224:231], v3
  v_smfmac_f32_16x16x64_bf16 v[56:59], v[8:11], v[144:151], v3
  v_smfmac_f32_16x16x64_bf16 v[60:63], v[8:11], v[200:207], v3
  v_smfmac_f32_16x16x64_bf16 v[36:39], v[12:15], a[8:15], v3
  v_smfmac_f32_16x16x64_bf16 v[40:43], v[12:15], a[64:71], v3
  v_smfmac_f32_16x16x64_bf16 v[44:47], v[12:15], a[120:127], v3
  v_smfmac_f32_16x16x64_bf16 v[48:51], v[12:15], a[176:183], v3
  v_smfmac_f32_16x16x64_bf16 v[52:55], v[12:15], a[232:239], v3
  v_smfmac_f32_16x16x64_bf16 v[56:59], v[12:15], v[152:159], v3
  v_smfmac_f32_16x16x64_bf16 v[60:63], v[12:15], v[208:215], v3
  v_smfmac_f32_16x16x64_bf16 v[36:39], v[16:19], a[16:23], v3
  v_smfmac_f32_16x16x64_bf16 v[40:43], v[16:19], a[72:79], v3
  v_smfmac_f32_16x16x64_bf16 v[44:47], v[16:19], a[128:135], v3
  v_smfmac_f32_16x16x64_bf16 v[48:51], v[16:19], a[184:191], v3
  v_smfmac_f32_16x16x64_bf16 v[52:55], v[16:19], a[240:247], v3
  v_smfmac_f32_16x16x64_bf16 v[56:59], v[16:19], v[160:167], v3
  v_smfmac_f32_16x16x64_bf16 v[60:63], v[16:19], v[216:223], v3
  v_smfmac_f32_16x16x64_bf16 v[36:39], v[20:23], a[24:31], v3
  v_smfmac_f32_16x16x64_bf16 v[40:43], v[20:23], a[80:87], v3
  v_smfmac_f32_16x16x64_bf16 v[44:47], v[20:23], a[136:143], v3
  v_smfmac_f32_16x16x64_bf16 v[48:51], v[20:23], a[192:199], v3
  v_smfmac_f32_16x16x64_bf16 v[52:55], v[20:23], a[248:255], v3
  v_smfmac_f32_16x16x64_bf16 v[56:59], v[20:23], v[168:175], v3
  v_smfmac_f32_16x16x64_bf16 v[60:63], v[20:23], v[224:231], v3
  v_smfmac_f32_16x16x64_bf16 v[36:39], v[24:27], a[32:39], v3
  v_smfmac_f32_16x16x64_bf16 v[40:43], v[24:27], a[88:95], v3
  v_smfmac_f32_16x16x64_bf16 v[44:47], v[24:27], a[144:151], v3
  v_smfmac_f32_16x16x64_bf16 v[48:51], v[24:27], a[200:207], v3
  v_smfmac_f32_16x16x64_bf16 v[52:55], v[24:27], v[120:127], v3
  v_smfmac_f32_16x16x64_bf16 v[56:59], v[24:27], v[176:183], v3
  v_smfmac_f32_16x16x64_bf16 v[60:63], v[24:27], v[232:239], v3
  v_smfmac_f32_16x16x64_bf16 v[36:39], v[28:31], a[40:47], v3
  v_smfmac_f32_16x16x64_bf16 v[40:43], v[28:31], a[96:103], v3
  v_smfmac_f32_16x16x64_bf16 v[44:47], v[28:31], a[152:159], v3
  v_smfmac_f32_16x16x64_bf16 v[48:51], v[28:31], a[208:215], v3
  v_smfmac_f32_16x16x64_bf16 v[52:55], v[28:31], v[128:135], v3
  v_smfmac_f32_16x16x64_bf16 v[56:59], v[28:31], v[184:191], v3
  v_smfmac_f32_16x16x64_bf16 v[60:63], v[28:31], v[240:247], v3
  v_smfmac_f32_16x16x64_bf16 v[36:39], v[32:35], a[48:55], v3
  v_smfmac_f32_16x16x64_bf16 v[40:43], v[32:35], a[104:111], v3
  v_smfmac_f32_16x16x64_bf16 v[44:47], v[32:35], a[160:167], v3
  v_smfmac_f32_16x16x64_bf16 v[48:51], v[32:35], a[216:223], v3
  v_smfmac_f32_16x16x64_bf16 v[52:55], v[32:35], v[136:143], v3
  v_smfmac_f32_16x16x64_bf16 v[56:59], v[32:35], v[192:199], v3
  v_smfmac_f32_16x16x64_bf16 v[60:63], v[32:35], v[248:255], v3
  v_permlane32_swap_b32 v36, v38
  v_permlane32_swap_b32 v37, v39
  v_add_f32 v36, v36, v38
  v_add_f32 v37, v37, v39
  v_cvt_pk_bf16_f32 v38, v36, v37
  ds_write_b32 v104, v38
  v_permlane32_swap_b32 v40, v42
  v_permlane32_swap_b32 v41, v43
  v_add_f32 v40, v40, v42
  v_add_f32 v41, v41, v43
  v_cvt_pk_bf16_f32 v42, v40, v41
  ds_write_b32 v105, v42
  v_permlane32_swap_b32 v44, v46
  v_permlane32_swap_b32 v45, v47
  v_add_f32 v44, v44, v46
  v_add_f32 v45, v45, v47
  v_cvt_pk_bf16_f32 v46, v44, v45
  ds_write_b32 v106, v46
  v_permlane32_swap_b32 v48, v50
  v_permlane32_swap_b32 v49, v51
  v_add_f32 v48, v48, v50
  v_add_f32 v49, v49, v51
  v_cvt_pk_bf16_f32 v50, v48, v49
  ds_write_b32 v107, v50
  v_permlane32_swap_b32 v52, v54
  v_permlane32_swap_b32 v53, v55
  v_add_f32 v52, v52, v54
  v_add_f32 v53, v53, v55
  v_cvt_pk_bf16_f32 v54, v52, v53
  ds_write_b32 v108, v54
  v_permlane32_swap_b32 v56, v58
  v_permlane32_swap_b32 v57, v59
  v_add_f32 v56, v56, v58
  v_add_f32 v57, v57, v59
  v_cvt_pk_bf16_f32 v58, v56, v57
  ds_write_b32 v109, v58
  v_permlane32_swap_b32 v60, v62
  v_permlane32_swap_b32 v61, v63
  v_add_f32 v60, v60, v62
  v_add_f32 v61, v61, v63
  v_cvt_pk_bf16_f32 v62, v60, v61
  ds_write_b32 v110, v62
  s_branch cA_va3_t2d
cA_va3_vor:
  s_sleep 2
  buffer_load_dword v101, off, s[8:11], s27 sc1
  s_add_u32 s30, s30, 1
  s_cmp_lt_u32 s30, 400000
  s_cbranch_scc1 cA_va3_vow
  s_branch cA_abort
cA_abort:
  v_mov_b32 v4, 0xdead
  v_mov_b32 v5, 16
  buffer_store_dword v4, v5, s[12:15], 0 offen
  s_branch ch_end
cA_done:
  s_branch ch_end
.p2align 6
cB_sc0_loop:
  s_mov_b32 s30, 0
  s_mov_b32 s62, 0
  s_setprio 3
  s_sleep 6
  buffer_load_dword v76, v0, s[8:11], 0 offen sc1
  buffer_load_dword v77, v0, s[8:11], 0 offen sc1
  buffer_load_dword v78, v0, s[8:11], 0 offen sc1
  buffer_load_dword v79, v0, s[8:11], 0 offen sc1
cB_sc0_fp_l:
  s_waitcnt vmcnt(3)
  v_cmp_gt_u32 vcc, s19, v76
  s_cbranch_vccz cB_sc0_fp_d
  buffer_load_dword v76, v0, s[8:11], 0 offen sc1
  s_waitcnt vmcnt(3)
  v_cmp_gt_u32 vcc, s19, v77
  s_cbranch_vccz cB_sc0_fp_d
  buffer_load_dword v77, v0, s[8:11], 0 offen sc1
  s_waitcnt vmcnt(3)
  v_cmp_gt_u32 vcc, s19, v78
  s_cbranch_vccz cB_sc0_fp_d
  buffer_load_dword v78, v0, s[8:11], 0 offen sc1
  s_waitcnt vmcnt(3)
  v_cmp_gt_u32 vcc, s19, v79
  s_cbranch_vccz cB_sc0_fp_d
  buffer_load_dword v79, v0, s[8:11], 0 offen sc1
  s_add_u32 s30, s30, 1
  s_cmp_lt_u32 s30, 400000
  s_cbranch_scc1 cB_sc0_fp_l
  s_branch cB_abort
cB_sc0_fp_d:
  buffer_load_dwordx4 v[8:11], v2, s[8:11], s20 offen offset:0 sc1
  s_barrier
  s_setprio 2
  buffer_load_dwordx4 v[12:15], v2, s[8:11], s20 offen offset:1024 sc1
  s_setprio 1
  buffer_load_dwordx4 v[16:19], v2, s[8:11], s20 offen offset:2048 sc1
  s_setprio 0
  buffer_load_dwordx4 v[20:23], v2, s[8:11], s20 offen offset:3072 sc1
cB_sc0_go:
  s_waitcnt vmcnt(3)
  v_smfmac_f32_16x16x64_bf16 v[36:39], v[8:11], a[0:7], v3
  buffer_load_dwordx4 v[32:35], v2, s[8:11], s23 offen offset:0 sc1
  v_cmp_eq_u32 vcc, -1, v8
  v_smfmac_f32_16x16x64_bf16 v[40:43], v[8:11], a[56:63], v3
  v_smfmac_f32_16x16x64_bf16 v[44:47], v[8:11], a[112:119], v3
  buffer_load_dwordx4 v[24:27], v2, s[8:11], s23 offen offset:1024 sc1
  s_cbranch_vccnz cB_sc0_r0
  v_smfmac_f32_16x16x64_bf16 v[48:51], v[8:11], a[168:175], v3
  v_smfmac_f32_16x16x64_bf16 v[52:55], v[8:11], a[224:231], v3
  s_waitcnt vmcnt(4)
  v_cmp_eq_u32 vcc, -1, v12
  v_smfmac_f32_16x16x64_bf16 v[56:59], v[8:11], v[144:151], v3
  buffer_load_dwordx4 v[28:31], v2, s[8:11], s23 offen offset:2048 sc1
  v_smfmac_f32_16x16x64_bf16 v[60:63], v[8:11], v[200:207], v3
  s_cbranch_vccnz cB_sc0_r1
cB_sc0_c1:
  v_smfmac_f32_16x16x64_bf16 v[36:39], v[12:15], a[8:15], v3
  v_smfmac_f32_16x16x64_bf16 v[40:43], v[12:15], a[64:71], v3
  v_smfmac_f32_16x16x64_bf16 v[44:47], v[12:15], a[120:127], v3
  v_smfmac_f32_16x16x64_bf16 v[48:51], v[12:15], a[176:183], v3
  v_smfmac_f32_16x16x64_bf16 v[52:55], v[12:15], a[232:239], v3
  s_waitcnt vmcnt(4)
  v_cmp_eq_u32 vcc, -1, v16
  v_smfmac_f32_16x16x64_bf16 v[56:59], v[12:15], v[152:159], v3
  buffer_load_dwordx4 v[88:91], v117, s[8:11], s26 offen offset:0 sc1
  v_smfmac_f32_16x16x64_bf16 v[60:63], v[12:15], v[208:215], v3
  s_cbranch_vccnz cB_sc0_r2
cB_sc0_c2:
  v_smfmac_f32_16x16x64_bf16 v[36:39], v[16:19], a[16:23], v3
  v_smfmac_f32_16x16x64_bf16 v[40:43], v[16:19], a[72:79], v3
  v_smfmac_f32_16x16x64_bf16 v[44:47], v[16:19], a[128:135], v3
  buffer_load_dwordx4 v[92:95], v117, s[8:11], s26 offen offset:1024 sc1
  v_smfmac_f32_16x16x64_bf16 v[48:51], v[16:19], a[184:191], v3
  v_smfmac_f32_16x16x64_bf16 v[52:55], v[16:19], a[240:247], v3
  s_waitcnt vmcnt(5)
  v_cmp_eq_u32 vcc, -1, v20
  v_smfmac_f32_16x16x64_bf16 v[56:59], v[16:19], v[160:167], v3
  v_smfmac_f32_16x16x64_bf16 v[60:63], v[16:19], v[216:223], v3
  buffer_load_dwordx4 v[96:99], v2, s[8:11], s24 offen offset:0 sc1
  s_cbranch_vccnz cB_sc0_r3
cB_sc0_c3:
  v_smfmac_f32_16x16x64_bf16 v[36:39], v[20:23], a[24:31], v3
  v_smfmac_f32_16x16x64_bf16 v[40:43], v[20:23], a[80:87], v3
  s_waitcnt vmcnt(3)
  v_max3_u32 v66, v24, v27, v28
  v_smfmac_f32_16x16x64_bf16 v[44:47], v[20:23], a[136:143], v3
  v_max3_u32 v66, v66, v31, v32
  v_smfmac_f32_16x16x64_bf16 v[48:51], v[20:23], a[192:199], v3
  buffer_load_dwordx4 v[100:103], v2, s[8:11], s24 offen offset:1024 sc1
  v_max_u32 v66, v66, v35
  v_smfmac_f32_16x16x64_bf16 v[52:55], v[20:23], a[248:255], v3
  v_cmp_eq_u32 vcc, -1, v66
  v_smfmac_f32_16x16x64_bf16 v[56:59], v[20:23], v[168:175], v3
  v_smfmac_f32_16x16x64_bf16 v[60:63], v[20:23], v[224:231], v3
  s_cbranch_vccnz cB_sc0_r4
cB_sc0_c4:
  v_smfmac_f32_16x16x64_bf16 v[60:63], v[32:35], v[232:239], v3
  buffer_load_dwordx4 v[104:107], v2, s[8:11], s26 offen offset:0 sc1
  v_smfmac_f32_16x16x64_bf16 v[60:63], v[24:27], v[240:247], v3
  v_smfmac_f32_16x16x64_bf16 v[60:63], v[28:31], v[248:255], v3
  v_smfmac_f32_16x16x64_bf16 v[52:55], v[32:35], v[120:127], v3
  v_smfmac_f32_16x16x64_bf16 v[52:55], v[24:27], v[128:135], v3
  buffer_load_dwordx4 v[108:111], v2, s[8:11], s26 offen offset:1024 sc1
  v_smfmac_f32_16x16x64_bf16 v[52:55], v[28:31], v[136:143], v3
  v_cvt_pk_bf16_f32 v63, v62, v63
  v_smfmac_f32_16x16x64_bf16 v[56:59], v[32:35], v[176:183], v3
  v_cvt_pk_bf16_f32 v62, v60, v61
  v_smfmac_f32_16x16x64_bf16 v[56:59], v[24:27], v[184:191], v3
  v_mfma_f32_16x16x32_bf16 v[12:15], v[62:65], v[4:7], 0
  v_cvt_pk_bf16_f32 v55, v54, v55
  v_smfmac_f32_16x16x64_bf16 v[56:59], v[28:31], v[192:199], v3
  v_cvt_pk_bf16_f32 v54, v52, v53
  v_smfmac_f32_16x16x64_bf16 v[36:39], v[32:35], a[32:39], v3
  s_nop 1
  v_cvt_pk_bf16_f32 v76, v12, v13
  v_smfmac_f32_16x16x64_bf16 v[36:39], v[24:27], a[40:47], v3
  v_cvt_pk_bf16_f32 v77, v14, v15
  v_smfmac_f32_16x16x64_bf16 v[36:39], v[28:31], a[48:55], v3
  v_cvt_pk_bf16_f32 v56, v56, v57
  v_smfmac_f32_16x16x64_bf16 v[40:43], v[32:35], a[88:95], v3
  v_cvt_pk_bf16_f32 v57, v58, v59
  v_smfmac_f32_16x16x64_bf16 v[40:43], v[24:27], a[96:103], v3
  v_mfma_f32_16x16x32_bf16 v[16:19], v[54:57], v[4:7], 0
  v_cvt_pk_bf16_f32 v39, v38, v39
  v_smfmac_f32_16x16x64_bf16 v[40:43], v[28:31], a[104:111], v3
  v_cvt_pk_bf16_f32 v38, v36, v37
  v_smfmac_f32_16x16x64_bf16 v[44:47], v[32:35], a[144:151], v3
  s_nop 1
  v_cvt_pk_bf16_f32 v78, v16, v17
  v_smfmac_f32_16x16x64_bf16 v[44:47], v[24:27], a[152:159], v3
  v_cvt_pk_bf16_f32 v79, v18, v19
  v_smfmac_f32_16x16x64_bf16 v[44:47], v[28:31], a[160:167], v3
  v_cvt_pk_bf16_f32 v40, v40, v41
  v_smfmac_f32_16x16x64_bf16 v[48:51], v[32:35], a[200:207], v3
  v_cvt_pk_bf16_f32 v41, v42, v43
  v_smfmac_f32_16x16x64_bf16 v[48:51], v[24:27], a[208:215], v3
  v_smfmac_f32_16x16x64_bf16 v[48:51], v[28:31], a[216:223], v3
  s_waitcnt vmcnt(4)
  v_cvt_pk_bf16_f32 v47, v46, v47
  v_smfmac_f32_16x16x64_bf16 v[68:71], v[76:79], v[80:87], v3
  v_cvt_pk_bf16_f32 v46, v44, v45
  v_mfma_f32_16x16x32_bf16 v[12:15], v[38:41], v[4:7], 0
  s_nop 1
  v_cvt_pk_bf16_f32 v48, v48, v49
  v_cvt_pk_bf16_f32 v49, v50, v51
  s_nop 1
  v_mfma_f32_16x16x32_bf16 v[16:19], v[46:49], v[4:7], 0
  v_smfmac_f32_16x16x64_bf16 v[72:75], v[76:79], v[88:95], v3
  v_cvt_pk_bf16_f32 v20, v12, v13
  v_mfma_f32_16x16x32_bf16 v[52:55], v[30:33], v[76:79], 0
  s_waitcnt vmcnt(0)
  v_cvt_pk_bf16_f32 v21, v14, v15
  v_cvt_pk_bf16_f32 v22, v16, v17
  v_cvt_pk_bf16_f32 v23, v18, v19
  s_nop 1
  v_mfma_f32_16x16x32_bf16 v[52:55], v[8:11], v[20:23], v[52:55]
  v_smfmac_f32_16x16x64_bf16 v[68:71], v[20:23], v[96:103], v3
  v_smfmac_f32_16x16x64_bf16 v[72:75], v[20:23], v[104:111], v3
  s_nop 1
  ds_write_b128 v113, v[52:55]
  s_nop 1
  v_permlane32_swap_b32 v68, v70
  v_permlane32_swap_b32 v69, v71
  v_add_f32 v56, v68, v70
  v_add_f32 v58, v69, v71
  v_permlane32_swap_b32 v72, v74
  v_permlane32_swap_b32 v73, v75
  v_add_f32 v57, v72, v74
  v_add_f32 v59, v73, v75
  ds_write_b128 v2, v[56:59] offset:0
  v_cmp_u_f32 vcc, v57, v59
  v_mov_b32 v68, 0
  v_mov_b32 v69, 0
  v_mov_b32 v70, 0
  v_mov_b32 v71, 0
  s_cbranch_vccnz cB_sc0_retry
cB_sc0_cont:
  s_add_u32 s24, s24, 28672
  s_add_u32 s26, s26, 28672
  buffer_load_dwordx4 v[80:83], v117, s[8:11], s24 offen offset:0 sc1
  buffer_load_dwordx4 v[84:87], v117, s[8:11], s24 offen offset:1024 sc1
  v_mov_b32 v72, 0
  v_mov_b32 v73, 0
  v_mfma_f32_32x32x16_bf16 v[36:51], v[68:71], v[68:71], 0
  s_waitcnt lgkmcnt(0)
  s_barrier
  ds_read_b64 v[8:9], v114 offset:0
  ds_read_b64 v[10:11], v114 offset:1024
  ds_read_b64 v[12:13], v114 offset:2048
  ds_read_b64 v[14:15], v114 offset:3072
  ds_read2_b32 v[16:17], v115 offset0:0 offset1:64
  ds_read2_b32 v[18:19], v115 offset0:128 offset1:192
  v_mfma_f32_32x32x16_bf16 v[52:67], v[68:71], v[68:71], 0
  s_waitcnt lgkmcnt(0)
  v_pk_add_f32 v[16:17], v[16:17], v[18:19]
  v_pk_add_f32 v[8:9], v[8:9], v[10:11]
  v_pk_add_f32 v[12:13], v[12:13], v[14:15]
  v_add_f32 v20, v16, v17
  v_pk_add_f32 v[8:9], v[8:9], v[12:13]
  v_max_f32 v22, v8, v9
  v_add_f32_dpp v20, v20, v20 row_ror:8 row_mask:0xf bank_mask:0xf
  s_nop 0
  v_max_f32_dpp v22, v22, v22 row_ror:8 row_mask:0xf bank_mask:0xf
  v_max_f32 v22, v22, v20
  s_nop 1
  v_max_f32_dpp v22, v22, v22 quad_perm:[1,0,3,2] row_mask:0xf bank_mask:0xf
  s_nop 1
  v_max_f32_dpp v22, v22, v22 quad_perm:[2,3,0,1] row_mask:0xf bank_mask:0xf
  s_nop 1
  v_max_f32_dpp v22, v22, v22 row_half_mirror row_mask:0xf bank_mask:0xf
  v_pk_add_f32 v[8:9], v[8:9], v[22:23] op_sel_hi:[1,0] neg_lo:[0,1] neg_hi:[0,1]
  v_sub_f32 v20, v20, v22
  v_exp_f32 v8, v8
  v_exp_f32 v9, v9
  v_exp_f32 v20, v20
  v_add_f32 v24, v8, v9
  v_fmac_f32 v24, 0.5, v20
  v_mov_b32_dpp v21, v20 quad_perm:[1,0,3,2] row_mask:0xf bank_mask:0xf
  s_nop 0
  v_add_f32_dpp v24, v24, v24 quad_perm:[1,0,3,2] row_mask:0xf bank_mask:0xf
  s_nop 1
  v_add_f32_dpp v24, v24, v24 quad_perm:[2,3,0,1] row_mask:0xf bank_mask:0xf
  s_nop 1
  v_add_f32_dpp v24, v24, v24 row_half_mirror row_mask:0xf bank_mask:0xf
  s_nop 1
  v_add_f32_dpp v24, v24, v24 row_ror:8 row_mask:0xf bank_mask:0xf
  v_rcp_f32 v24, v24
  s_nop 0
  v_pk_mul_f32 v[8:9], v[8:9], v[24:25] op_sel_hi:[1,0]
  v_pk_mul_f32 v[20:21], v[20:21], v[24:25] op_sel_hi:[1,0]
  v_cvt_pk_bf16_f32 v8, v8, v9
  v_cvt_pk_bf16_f32 v20, v20, v21
  v_min_u32 v8, -2, v8
  buffer_store_dword v8, v1, s[8:11], s20 offen sc1
  v_min_u32 v20, -2, v20
  buffer_store_dword v20, v118, s[8:11], s20 offen sc1
  buffer_store_dword v119, v1, s[8:11], s21 offen sc1
  buffer_store_dword v119, v118, s[8:11], s21 offen sc1
  v_mov_b32 v74, 0
  v_mov_b32 v75, 0
  s_mov_b32 s19, s18
  s_add_u32 s18, s18, 1
  s_mov_b32 s22, s20
  s_mov_b32 s20, s21
  s_mov_b32 s21, s22
  s_add_u32 s23, s20, 4096
  s_cmp_lt_u32 s19, 63
  s_cbranch_scc1 cB_sc0_loop
  s_branch cB_done
cB_sc0_r0:
  s_add_u32 s31, s31, 1
  buffer_load_dwordx4 v[8:11], v2, s[8:11], s20 offen offset:0 sc1
  s_waitcnt vmcnt(0)
  v_cmp_eq_u32 vcc, -1, v8
  v_mov_b32 v36, 0
  v_mov_b32 v37, 0
  v_mov_b32 v38, 0
  v_mov_b32 v39, 0
  v_mov_b32 v40, 0
  v_mov_b32 v41, 0
  v_mov_b32 v42, 0
  v_mov_b32 v43, 0
  v_mov_b32 v44, 0
  v_mov_b32 v45, 0
  v_mov_b32 v46, 0
  v_mov_b32 v47, 0
  v_mov_b32 v48, 0
  v_mov_b32 v49, 0
  v_mov_b32 v50, 0
  v_mov_b32 v51, 0
  s_nop 1
  s_cbranch_vccz cB_sc0_go
  s_add_u32 s30, s30, 1
  s_cmp_lt_u32 s30, 400000
  s_cbranch_scc1 cB_sc0_r0
  s_branch cB_abort
cB_sc0_r1:
  s_add_u32 s31, s31, 1
  buffer_load_dwordx4 v[12:15], v2, s[8:11], s20 offen offset:1024 sc1
  s_waitcnt vmcnt(0)
  v_cmp_eq_u32 vcc, -1, v12
  s_nop 4
  s_cbranch_vccz cB_sc0_c1
  s_add_u32 s30, s30, 1
  s_cmp_lt_u32 s30, 400000
  s_cbranch_scc1 cB_sc0_r1
  s_branch cB_abort
cB_sc0_r2:
  s_add_u32 s31, s31, 1
  buffer_load_dwordx4 v[16:19], v2, s[8:11], s20 offen offset:2048 sc1
  s_waitcnt vmcnt(0)
  v_cmp_eq_u32 vcc, -1, v16
  s_nop 4
  s_cbranch_vccz cB_sc0_c2
  s_add_u32 s30, s30, 1
  s_cmp_lt_u32 s30, 400000
  s_cbranch_scc1 cB_sc0_r2
  s_branch cB_abort
cB_sc0_r3:
  s_add_u32 s31, s31, 1
  buffer_load_dwordx4 v[20:23], v2, s[8:11], s20 offen offset:3072 sc1
  s_waitcnt vmcnt(0)
  v_cmp_eq_u32 vcc, -1, v20
  s_nop 4
  s_cbranch_vccz cB_sc0_c3
  s_add_u32 s30, s30, 1
  s_cmp_lt_u32 s30, 400000
  s_cbranch_scc1 cB_sc0_r3
  s_branch cB_abort
cB_sc0_r4:
  s_add_u32 s31, s31, 1
  buffer_load_dwordx4 v[32:35], v2, s[8:11], s23 offen offset:0 sc1
  buffer_load_dwordx4 v[24:27], v2, s[8:11], s23 offen offset:1024 sc1
  buffer_load_dwordx4 v[28:31], v2, s[8:11], s23 offen offset:2048 sc1
  s_waitcnt vmcnt(0)
  v_max3_u32 v66, v24, v27, v28
  v_max3_u32 v66, v66, v31, v32
  v_max_u32 v66, v66, v35
  v_cmp_eq_u32 vcc, -1, v66
  s_nop 4
  s_cbranch_vccz cB_sc0_c4
  s_add_u32 s30, s30, 1
  s_cmp_lt_u32 s30, 400000
  s_cbranch_scc1 cB_sc0_r4
  s_branch cB_abort
cB_sc0_retry:
  s_cmp_lg_u32 s62, 0
  s_cbranch_scc1 cB_sc0_cont
  s_waitcnt vmcnt(0) lgkmcnt(0)
cB_sc0_rv:
  buffer_load_dwordx4 v[8:11], v2, s[8:11], s20 offen offset:0 sc1
  buffer_load_dwordx4 v[12:15], v2, s[8:11], s20 offen offset:1024 sc1
  buffer_load_dwordx4 v[16:19], v2, s[8:11], s20 offen offset:2048 sc1
  buffer_load_dwordx4 v[20:23], v2, s[8:11], s20 offen offset:3072 sc1
  buffer_load_dwordx4 v[32:35], v2, s[8:11], s23 offen offset:0 sc1
  buffer_load_dwordx4 v[24:27], v2, s[8:11], s23 offen offset:1024 sc1
  buffer_load_dwordx4 v[28:31], v2, s[8:11], s23 offen offset:2048 sc1
  s_waitcnt vmcnt(0)
  v_pk_max_u16 v66, v8, v9
  v_pk_max_u16 v66, v66, v10
  v_pk_max_u16 v66, v66, v11
  v_pk_max_u16 v66, v66, v12
  v_pk_max_u16 v66, v66, v13
  v_pk_max_u16 v66, v66, v14
  v_pk_max_u16 v66, v66, v15
  v_pk_max_u16 v66, v66, v16
  v_pk_max_u16 v66, v66, v17
  v_pk_max_u16 v66, v66, v18
  v_pk_max_u16 v66, v66, v19
  v_pk_max_u16 v66, v66, v20
  v_pk_max_u16 v66, v66, v21
  v_pk_max_u16 v66, v66, v22
  v_pk_max_u16 v66, v66, v23
  v_pk_max_u16 v66, v66, v24
  v_pk_max_u16 v66, v66, v25
  v_pk_max_u16 v66, v66, v26
  v_pk_max_u16 v66, v66, v27
  v_pk_max_u16 v66, v66, v28
  v_pk_max_u16 v66, v66, v29
  v_pk_max_u16 v66, v66, v30
  v_pk_max_u16 v66, v66, v31
  v_pk_max_u16 v66, v66, v32
  v_pk_max_u16 v66, v66, v33
  v_pk_max_u16 v66, v66, v34
  v_pk_max_u16 v66, v66, v35
  v_lshlrev_b32 v67, 16, v66
  v_max_u32 v66, v66, v67
  v_cmp_le_u32 vcc, 0xffff0000, v66
  s_cbranch_vccz cB_sc0_rk
  s_add_u32 s30, s30, 1
  s_cmp_lt_u32 s30, 400000
  s_cbranch_scc1 cB_sc0_rv
  s_branch cB_abort
cB_sc0_rk:
  s_mov_b32 s62, 1
  v_mov_b32 v36, 0
  v_mov_b32 v37, 0
  v_mov_b32 v38, 0
  v_mov_b32 v39, 0
  v_mov_b32 v40, 0
  v_mov_b32 v41, 0
  v_mov_b32 v42, 0
  v_mov_b32 v43, 0
  v_mov_b32 v44, 0
  v_mov_b32 v45, 0
  v_mov_b32 v46, 0
  v_mov_b32 v47, 0
  v_mov_b32 v48, 0
  v_mov_b32 v49, 0
  v_mov_b32 v50, 0
  v_mov_b32 v51, 0
  v_mov_b32 v60, 0
  v_mov_b32 v61, 0
  v_mov_b32 v62, 0
  v_mov_b32 v63, 0
  v_mov_b32 v68, 0
  v_mov_b32 v69, 0
  v_mov_b32 v70, 0
  v_mov_b32 v71, 0
  v_mov_b32 v72, 0
  v_mov_b32 v73, 0
  v_mov_b32 v74, 0
  v_mov_b32 v75, 0
  v_mov_b32 v52, 0
  v_mov_b32 v53, 0
  v_mov_b32 v54, 0
  v_mov_b32 v55, 0
  v_mov_b32 v56, 0
  v_mov_b32 v57, 0
  v_mov_b32 v58, 0
  v_mov_b32 v59, 0
  s_add_u32 s31, s31, 0x100
  s_nop 0
  s_branch cB_sc0_go
.p2align 6
cB_sc1_loop:
  s_mov_b32 s30, 0
  s_mov_b32 s62, 0
  s_setprio 3
  s_barrier
  buffer_load_dwordx4 v[8:11], v2, s[8:11], s20 offen offset:0 sc1
  s_setprio 2
  buffer_load_dwordx4 v[12:15], v2, s[8:11], s20 offen offset:1024 sc1
  s_setprio 1
  buffer_load_dwordx4 v[16:19], v2, s[8:11], s20 offen offset:2048 sc1
  s_setprio 0
  buffer_load_dwordx4 v[20:23], v2, s[8:11], s20 offen offset:3072 sc1
cB_sc1_go:
  s_waitcnt vmcnt(3)
  v_smfmac_f32_16x16x64_bf16 v[36:39], v[8:11], a[0:7], v3
  buffer_load_dwordx4 v[28:31], v2, s[8:11], s23 offen offset:0 sc1
  v_cmp_eq_u32 vcc, -1, v8
  v_smfmac_f32_16x16x64_bf16 v[40:43], v[8:11], a[56:63], v3
  v_smfmac_f32_16x16x64_bf16 v[44:47], v[8:11], a[112:119], v3
  buffer_load_dwordx4 v[24:27], v2, s[8:11], s23 offen offset:1024 sc1
  s_cbranch_vccnz cB_sc1_r0
  v_smfmac_f32_16x16x64_bf16 v[48:51], v[8:11], a[168:175], v3
  v_smfmac_f32_16x16x64_bf16 v[52:55], v[8:11], a[224:231], v3
  s_waitcnt vmcnt(4)
  v_cmp_eq_u32 vcc, -1, v12
  v_smfmac_f32_16x16x64_bf16 v[56:59], v[8:11], v[144:151], v3
  buffer_load_dwordx4 v[32:35], v2, s[8:11], s23 offen offset:2048 sc1
  v_smfmac_f32_16x16x64_bf16 v[60:63], v[8:11], v[200:207], v3
  s_cbranch_vccnz cB_sc1_r1
cB_sc1_c1:
  v_smfmac_f32_16x16x64_bf16 v[36:39], v[12:15], a[8:15], v3
  v_smfmac_f32_16x16x64_bf16 v[40:43], v[12:15], a[64:71], v3
  v_smfmac_f32_16x16x64_bf16 v[44:47], v[12:15], a[120:127], v3
  v_smfmac_f32_16x16x64_bf16 v[48:51], v[12:15], a[176:183], v3
  v_smfmac_f32_16x16x64_bf16 v[52:55], v[12:15], a[232:239], v3
  s_waitcnt vmcnt(4)
  v_cmp_eq_u32 vcc, -1, v16
  v_smfmac_f32_16x16x64_bf16 v[56:59], v[12:15], v[152:159], v3
  buffer_load_dwordx4 v[88:91], v117, s[8:11], s26 offen offset:0 sc1
  v_smfmac_f32_16x16x64_bf16 v[60:63], v[12:15], v[208:215], v3
  s_cbranch_vccnz cB_sc1_r2
cB_sc1_c2:
  v_smfmac_f32_16x16x64_bf16 v[36:39], v[16:19], a[16:23], v3
  v_smfmac_f32_16x16x64_bf16 v[40:43], v[16:19], a[72:79], v3
  v_smfmac_f32_16x16x64_bf16 v[44:47], v[16:19], a[128:135], v3
  buffer_load_dwordx4 v[92:95], v117, s[8:11], s26 offen offset:1024 sc1
  v_smfmac_f32_16x16x64_bf16 v[48:51], v[16:19], a[184:191], v3
  v_smfmac_f32_16x16x64_bf16 v[52:55], v[16:19], a[240:247], v3
  s_waitcnt vmcnt(5)
  v_cmp_eq_u32 vcc, -1, v20
  v_smfmac_f32_16x16x64_bf16 v[56:59], v[16:19], v[160:167], v3
  v_smfmac_f32_16x16x64_bf16 v[60:63], v[16:19], v[216:223], v3
  buffer_load_dwordx4 v[96:99], v2, s[8:11], s24 offen offset:0 sc1
  s_cbranch_vccnz cB_sc1_r3
cB_sc1_c3:
  v_smfmac_f32_16x16x64_bf16 v[36:39], v[20:23], a[24:31], v3
  v_smfmac_f32_16x16x64_bf16 v[40:43], v[20:23], a[80:87], v3
  s_waitcnt vmcnt(3)
  v_max3_u32 v66, v24, v27, v28
  v_smfmac_f32_16x16x64_bf16 v[44:47], v[20:23], a[136:143], v3
  v_max3_u32 v66, v66, v31, v32
  v_smfmac_f32_16x16x64_bf16 v[48:51], v[20:23], a[192:199], v3
  buffer_load_dwordx4 v[100:103], v2, s[8:11], s24 offen offset:1024 sc1
  v_max_u32 v66, v66, v35
  v_smfmac_f32_16x16x64_bf16 v[52:55], v[20:23], a[248:255], v3
  v_cmp_eq_u32 vcc, -1, v66
  v_smfmac_f32_16x16x64_bf16 v[56:59], v[20:23], v[168:175], v3
  v_smfmac_f32_16x16x64_bf16 v[60:63], v[20:23], v[224:231], v3
  s_cbranch_vccnz cB_sc1_r4
cB_sc1_c4:
  v_smfmac_f32_16x16x64_bf16 v[60:63], v[28:31], v[232:239], v3
  buffer_load_dwordx4 v[104:107], v2, s[8:11], s26 offen offset:0 sc1
  v_smfmac_f32_16x16x64_bf16 v[60:63], v[24:27], v[240:247], v3
  v_smfmac_f32_16x16x64_bf16 v[60:63], v[32:35], v[248:255], v3
  v_smfmac_f32_16x16x64_bf16 v[52:55], v[28:31], v[120:127], v3
  v_smfmac_f32_16x16x64_bf16 v[52:55], v[24:27], v[128:135], v3
  buffer_load_dwordx4 v[108:111], v2, s[8:11], s26 offen offset:1024 sc1
  v_smfmac_f32_16x16x64_bf16 v[52:55], v[32:35], v[136:143], v3
  v_cvt_pk_bf16_f32 v63, v62, v63
  v_smfmac_f32_16x16x64_bf16 v[56:59], v[28:31], v[176:183], v3
  v_cvt_pk_bf16_f32 v62, v60, v61
  v_smfmac_f32_16x16x64_bf16 v[56:59], v[24:27], v[184:191], v3
  v_mfma_f32_16x16x32_bf16 v[8:11], v[62:65], v[4:7], 0
  v_cvt_pk_bf16_f32 v55, v54, v55
  v_smfmac_f32_16x16x64_bf16 v[56:59], v[32:35], v[192:199], v3
  v_cvt_pk_bf16_f32 v54, v52, v53
  v_smfmac_f32_16x16x64_bf16 v[36:39], v[28:31], a[32:39], v3
  s_nop 1
  v_cvt_pk_bf16_f32 v78, v8, v9
  v_smfmac_f32_16x16x64_bf16 v[36:39], v[24:27], a[40:47], v3
  v_cvt_pk_bf16_f32 v79, v10, v11
  v_smfmac_f32_16x16x64_bf16 v[36:39], v[32:35], a[48:55], v3
  v_cvt_pk_bf16_f32 v56, v56, v57
  v_smfmac_f32_16x16x64_bf16 v[40:43], v[28:31], a[88:95], v3
  v_cvt_pk_bf16_f32 v57, v58, v59
  v_smfmac_f32_16x16x64_bf16 v[40:43], v[24:27], a[96:103], v3
  v_mfma_f32_16x16x32_bf16 v[16:19], v[54:57], v[4:7], 0
  v_cvt_pk_bf16_f32 v39, v38, v39
  v_smfmac_f32_16x16x64_bf16 v[40:43], v[32:35], a[104:111], v3
  v_cvt_pk_bf16_f32 v38, v36, v37
  v_smfmac_f32_16x16x64_bf16 v[44:47], v[28:31], a[144:151], v3
  s_nop 1
  v_cvt_pk_bf16_f32 v76, v16, v17
  v_smfmac_f32_16x16x64_bf16 v[44:47], v[24:27], a[152:159], v3
  v_cvt_pk_bf16_f32 v77, v18, v19
  v_smfmac_f32_16x16x64_bf16 v[44:47], v[32:35], a[160:167], v3
  v_cvt_pk_bf16_f32 v40, v40, v41
  v_smfmac_f32_16x16x64_bf16 v[48:51], v[28:31], a[200:207], v3
  v_cvt_pk_bf16_f32 v41, v42, v43
  v_smfmac_f32_16x16x64_bf16 v[48:51], v[24:27], a[208:215], v3
  v_smfmac_f32_16x16x64_bf16 v[48:51], v[32:35], a[216:223], v3
  s_waitcnt vmcnt(4)
  v_cvt_pk_bf16_f32 v47, v46, v47
  v_smfmac_f32_16x16x64_bf16 v[68:71], v[76:79], v[80:87], v3
  v_cvt_pk_bf16_f32 v46, v44, v45
  v_mfma_f32_16x16x32_bf16 v[8:11], v[38:41], v[4:7], 0
  s_nop 1
  v_cvt_pk_bf16_f32 v48, v48, v49
  v_cvt_pk_bf16_f32 v49, v50, v51
  s_nop 1
  v_mfma_f32_16x16x32_bf16 v[16:19], v[46:49], v[4:7], 0
  v_smfmac_f32_16x16x64_bf16 v[72:75], v[76:79], v[88:95], v3
  v_cvt_pk_bf16_f32 v20, v8, v9
  v_mfma_f32_16x16x32_bf16 v[52:55], v[30:33], v[76:79], 0
  s_waitcnt vmcnt(0)
  v_cvt_pk_bf16_f32 v21, v10, v11
  v_cvt_pk_bf16_f32 v22, v16, v17
  v_cvt_pk_bf16_f32 v23, v18, v19
  s_nop 1
  v_mfma_f32_16x16x32_bf16 v[52:55], v[12:15], v[20:23], v[52:55]
  v_smfmac_f32_16x16x64_bf16 v[68:71], v[20:23], v[96:103], v3
  v_smfmac_f32_16x16x64_bf16 v[72:75], v[20:23], v[104:111], v3
  s_nop 1
  ds_write_b128 v113, v[52:55]
  s_nop 1
  v_permlane32_swap_b32 v68, v70
  v_permlane32_swap_b32 v69, v71
  v_add_f32 v56, v68, v70
  v_add_f32 v58, v69, v71
  v_permlane32_swap_b32 v72, v74
  v_permlane32_swap_b32 v73, v75
  v_add_f32 v57, v72, v74
  v_add_f32 v59, v73, v75
  ds_write_b128 v2, v[56:59] offset:1024
  v_cmp_u_f32 vcc, v57, v59
  v_mov_b32 v68, 0
  v_mov_b32 v69, 0
  v_mov_b32 v70, 0
  v_mov_b32 v71, 0
  s_cbranch_vccnz cB_sc1_retry
cB_sc1_cont:
  s_add_u32 s24, s24, 28672
  s_add_u32 s26, s26, 28672
  buffer_load_dwordx4 v[80:83], v117, s[8:11], s24 offen offset:0 sc1
  buffer_load_dwordx4 v[84:87], v117, s[8:11], s24 offen offset:1024 sc1
  v_mov_b32 v72, 0
  v_mov_b32 v73, 0
  v_mfma_f32_32x32x16_bf16 v[36:51], v[68:71], v[68:71], 0
  s_waitcnt lgkmcnt(0)
  s_barrier
  ds_read_b64 v[8:9], v114 offset:0
  ds_read_b64 v[10:11], v114 offset:1024
  ds_read_b64 v[12:13], v114 offset:2048
  ds_read_b64 v[14:15], v114 offset:3072
  ds_read2_b32 v[16:17], v115 offset0:0 offset1:64
  ds_read2_b32 v[18:19], v115 offset0:128 offset1:192
  v_mfma_f32_32x32x16_bf16 v[52:67], v[68:71], v[68:71], 0
  s_waitcnt lgkmcnt(0)
  v_pk_add_f32 v[16:17], v[16:17], v[18:19]
  v_pk_add_f32 v[8:9], v[8:9], v[10:11]
  v_pk_add_f32 v[12:13], v[12:13], v[14:15]
  v_add_f32 v20, v16, v17
  v_pk_add_f32 v[8:9], v[8:9], v[12:13]
  v_max_f32 v22, v8, v9
  v_add_f32_dpp v20, v20, v20 row_ror:8 row_mask:0xf bank_mask:0xf
  s_nop 0
  v_max_f32_dpp v22, v22, v22 row_ror:8 row_mask:0xf bank_mask:0xf
  v_max_f32 v22, v22, v20
  s_nop 1
  v_max_f32_dpp v22, v22, v22 quad_perm:[1,0,3,2] row_mask:0xf bank_mask:0xf
  s_nop 1
  v_max_f32_dpp v22, v22, v22 quad_perm:[2,3,0,1] row_mask:0xf bank_mask:0xf
  s_nop 1
  v_max_f32_dpp v22, v22, v22 row_half_mirror row_mask:0xf bank_mask:0xf
  v_pk_add_f32 v[8:9], v[8:9], v[22:23] op_sel_hi:[1,0] neg_lo:[0,1] neg_hi:[0,1]
  v_sub_f32 v20, v20, v22
  v_exp_f32 v8, v8
  v_exp_f32 v9, v9
  v_exp_f32 v20, v20
  buffer_store_dword v112, v116, s[8:11], 0 offen sc1
  v_add_f32 v24, v8, v9
  v_fmac_f32 v24, 0.5, v20
  v_mov_b32_dpp v21, v20 quad_perm:[1,0,3,2] row_mask:0xf bank_mask:0xf
  s_nop 0
  v_add_f32_dpp v24, v24, v24 quad_perm:[1,0,3,2] row_mask:0xf bank_mask:0xf
  s_nop 1
  v_add_f32_dpp v24, v24, v24 quad_perm:[2,3,0,1] row_mask:0xf bank_mask:0xf
  s_nop 1
  v_add_f32_dpp v24, v24, v24 row_half_mirror row_mask:0xf bank_mask:0xf
  s_nop 1
  v_add_f32_dpp v24, v24, v24 row_ror:8 row_mask:0xf bank_mask:0xf
  v_rcp_f32 v24, v24
  s_nop 0
  v_pk_mul_f32 v[8:9], v[8:9], v[24:25] op_sel_hi:[1,0]
  v_pk_mul_f32 v[20:21], v[20:21], v[24:25] op_sel_hi:[1,0]
  v_cvt_pk_bf16_f32 v8, v8, v9
  v_cvt_pk_bf16_f32 v20, v20, v21
  v_min_u32 v8, -2, v8
  buffer_store_dword v8, v1, s[8:11], s20 offen sc1
  v_min_u32 v20, -2, v20
  buffer_store_dword v20, v118, s[8:11], s20 offen sc1
  buffer_store_dword v119, v1, s[8:11], s21 offen sc1
  buffer_store_dword v119, v118, s[8:11], s21 offen sc1
  v_mov_b32 v74, 0
  v_mov_b32 v75, 0
  s_mov_b32 s19, s18
  s_add_u32 s18, s18, 1
  s_mov_b32 s22, s20
  s_mov_b32 s20, s21
  s_mov_b32 s21, s22
  s_add_u32 s23, s20, 4096
  v_mov_b32 v112, s18
  s_cmp_lt_u32 s19, 63
  s_nop 0
  s_cbranch_scc1 cB_sc1_loop
  s_branch cB_done
cB_sc1_r0:
  s_add_u32 s31, s31, 1
  buffer_load_dwordx4 v[8:11], v2, s[8:11], s20 offen offset:0 sc1
  s_waitcnt vmcnt(0)
  v_cmp_eq_u32 vcc, -1, v8
  v_mov_b32 v36, 0
  v_mov_b32 v37, 0
  v_mov_b32 v38, 0
  v_mov_b32 v39, 0
  v_mov_b32 v40, 0
  v_mov_b32 v41, 0
  v_mov_b32 v42, 0
  v_mov_b32 v43, 0
  v_mov_b32 v44, 0
  v_mov_b32 v45, 0
  v_mov_b32 v46, 0
  v_mov_b32 v47, 0
  v_mov_b32 v48, 0
  v_mov_b32 v49, 0
  v_mov_b32 v50, 0
  v_mov_b32 v51, 0
  s_nop 1
  s_cbranch_vccz cB_sc1_go
  s_add_u32 s30, s30, 1
  s_cmp_lt_u32 s30, 400000
  s_cbranch_scc1 cB_sc1_r0
  s_branch cB_abort
cB_sc1_r1:
  s_add_u32 s31, s31, 1
  buffer_load_dwordx4 v[12:15], v2, s[8:11], s20 offen offset:1024 sc1
  s_waitcnt vmcnt(0)
  v_cmp_eq_u32 vcc, -1, v12
  s_nop 4
  s_cbranch_vccz cB_sc1_c1
  s_add_u32 s30, s30, 1
  s_cmp_lt_u32 s30, 400000
  s_cbranch_scc1 cB_sc1_r1
  s_branch cB_abort
cB_sc1_r2:
  s_add_u32 s31, s31, 1
  buffer_load_dwordx4 v[16:19], v2, s[8:11], s20 offen offset:2048 sc1
  s_waitcnt vmcnt(0)
  v_cmp_eq_u32 vcc, -1, v16
  s_nop 4
  s_cbranch_vccz cB_sc1_c2
  s_add_u32 s30, s30, 1
  s_cmp_lt_u32 s30, 400000
  s_cbranch_scc1 cB_sc1_r2
  s_branch cB_abort
cB_sc1_r3:
  s_add_u32 s31, s31, 1
  buffer_load_dwordx4 v[20:23], v2, s[8:11], s20 offen offset:3072 sc1
  s_waitcnt vmcnt(0)
  v_cmp_eq_u32 vcc, -1, v20
  s_nop 4
  s_cbranch_vccz cB_sc1_c3
  s_add_u32 s30, s30, 1
  s_cmp_lt_u32 s30, 400000
  s_cbranch_scc1 cB_sc1_r3
  s_branch cB_abort
cB_sc1_r4:
  s_add_u32 s31, s31, 1
  buffer_load_dwordx4 v[28:31], v2, s[8:11], s23 offen offset:0 sc1
  buffer_load_dwordx4 v[24:27], v2, s[8:11], s23 offen offset:1024 sc1
  buffer_load_dwordx4 v[32:35], v2, s[8:11], s23 offen offset:2048 sc1
  s_waitcnt vmcnt(0)
  v_max3_u32 v66, v24, v27, v28
  v_max3_u32 v66, v66, v31, v32
  v_max_u32 v66, v66, v35
  v_cmp_eq_u32 vcc, -1, v66
  s_nop 4
  s_cbranch_vccz cB_sc1_c4
  s_add_u32 s30, s30, 1
  s_cmp_lt_u32 s30, 400000
  s_cbranch_scc1 cB_sc1_r4
  s_branch cB_abort
cB_sc1_retry:
  s_cmp_lg_u32 s62, 0
  s_cbranch_scc1 cB_sc1_cont
  s_waitcnt vmcnt(0) lgkmcnt(0)
cB_sc1_rv:
  buffer_load_dwordx4 v[8:11], v2, s[8:11], s20 offen offset:0 sc1
  buffer_load_dwordx4 v[12:15], v2, s[8:11], s20 offen offset:1024 sc1
  buffer_load_dwordx4 v[16:19], v2, s[8:11], s20 offen offset:2048 sc1
  buffer_load_dwordx4 v[20:23], v2, s[8:11], s20 offen offset:3072 sc1
  buffer_load_dwordx4 v[28:31], v2, s[8:11], s23 offen offset:0 sc1
  buffer_load_dwordx4 v[24:27], v2, s[8:11], s23 offen offset:1024 sc1
  buffer_load_dwordx4 v[32:35], v2, s[8:11], s23 offen offset:2048 sc1
  s_waitcnt vmcnt(0)
  v_pk_max_u16 v66, v8, v9
  v_pk_max_u16 v66, v66, v10
  v_pk_max_u16 v66, v66, v11
  v_pk_max_u16 v66, v66, v12
  v_pk_max_u16 v66, v66, v13
  v_pk_max_u16 v66, v66, v14
  v_pk_max_u16 v66, v66, v15
  v_pk_max_u16 v66, v66, v16
  v_pk_max_u16 v66, v66, v17
  v_pk_max_u16 v66, v66, v18
  v_pk_max_u16 v66, v66, v19
  v_pk_max_u16 v66, v66, v20
  v_pk_max_u16 v66, v66, v21
  v_pk_max_u16 v66, v66, v22
  v_pk_max_u16 v66, v66, v23
  v_pk_max_u16 v66, v66, v24
  v_pk_max_u16 v66, v66, v25
  v_pk_max_u16 v66, v66, v26
  v_pk_max_u16 v66, v66, v27
  v_pk_max_u16 v66, v66, v28
  v_pk_max_u16 v66, v66, v29
  v_pk_max_u16 v66, v66, v30
  v_pk_max_u16 v66, v66, v31
  v_pk_max_u16 v66, v66, v32
  v_pk_max_u16 v66, v66, v33
  v_pk_max_u16 v66, v66, v34
  v_pk_max_u16 v66, v66, v35
  v_lshlrev_b32 v67, 16, v66
  v_max_u32 v66, v66, v67
  v_cmp_le_u32 vcc, 0xffff0000, v66
  s_cbranch_vccz cB_sc1_rk
  s_add_u32 s30, s30, 1
  s_cmp_lt_u32 s30, 400000
  s_cbranch_scc1 cB_sc1_rv
  s_branch cB_abort
cB_sc1_rk:
  s_mov_b32 s62, 1
  v_mov_b32 v36, 0
  v_mov_b32 v37, 0
  v_mov_b32 v38, 0
  v_mov_b32 v39, 0
  v_mov_b32 v40, 0
  v_mov_b32 v41, 0
  v_mov_b32 v42, 0
  v_mov_b32 v43, 0
  v_mov_b32 v44, 0
  v_mov_b32 v45, 0
  v_mov_b32 v46, 0
  v_mov_b32 v47, 0
  v_mov_b32 v48, 0
  v_mov_b32 v49, 0
  v_mov_b32 v50, 0
  v_mov_b32 v51, 0
  v_mov_b32 v60, 0
  v_mov_b32 v61, 0
  v_mov_b32 v62, 0
  v_mov_b32 v63, 0
  v_mov_b32 v68, 0
  v_mov_b32 v69, 0
  v_mov_b32 v70, 0
  v_mov_b32 v71, 0
  v_mov_b32 v72, 0
  v_mov_b32 v73, 0
  v_mov_b32 v74, 0
  v_mov_b32 v75, 0
  v_mov_b32 v52, 0
  v_mov_b32 v53, 0
  v_mov_b32 v54, 0
  v_mov_b32 v55, 0
  v_mov_b32 v56, 0
  v_mov_b32 v57, 0
  v_mov_b32 v58, 0
  v_mov_b32 v59, 0
  s_add_u32 s31, s31, 0x100
  s_nop 0
  s_branch cB_sc1_go
.p2align 6
cB_sc2_loop:
  s_mov_b32 s30, 0
  s_mov_b32 s62, 0
  s_setprio 3
  s_barrier
  buffer_load_dwordx4 v[8:11], v2, s[8:11], s20 offen offset:0 sc1
  s_setprio 2
  buffer_load_dwordx4 v[12:15], v2, s[8:11], s20 offen offset:1024 sc1
  s_setprio 1
  buffer_load_dwordx4 v[16:19], v2, s[8:11], s20 offen offset:2048 sc1
  s_setprio 0
  buffer_load_dwordx4 v[20:23], v2, s[8:11], s20 offen offset:3072 sc1
cB_sc2_go:
  s_waitcnt vmcnt(3)
  v_smfmac_f32_16x16x64_bf16 v[36:39], v[8:11], a[0:7], v3
  buffer_load_dwordx4 v[24:27], v2, s[8:11], s23 offen offset:0 sc1
  v_cmp_eq_u32 vcc, -1, v8
  v_smfmac_f32_16x16x64_bf16 v[40:43], v[8:11], a[56:63], v3
  v_smfmac_f32_16x16x64_bf16 v[44:47], v[8:11], a[112:119], v3
  buffer_load_dwordx4 v[32:35], v2, s[8:11], s23 offen offset:1024 sc1
  s_cbranch_vccnz cB_sc2_r0
  v_smfmac_f32_16x16x64_bf16 v[48:51], v[8:11], a[168:175], v3
  v_smfmac_f32_16x16x64_bf16 v[52:55], v[8:11], a[224:231], v3
  s_waitcnt vmcnt(4)
  v_cmp_eq_u32 vcc, -1, v12
  v_smfmac_f32_16x16x64_bf16 v[56:59], v[8:11], v[144:151], v3
  buffer_load_dwordx4 v[28:31], v2, s[8:11], s23 offen offset:2048 sc1
  v_smfmac_f32_16x16x64_bf16 v[62:65], v[8:11], v[200:207], v3
  s_cbranch_vccnz cB_sc2_r1
cB_sc2_c1:
  v_smfmac_f32_16x16x64_bf16 v[36:39], v[12:15], a[8:15], v3
  v_smfmac_f32_16x16x64_bf16 v[40:43], v[12:15], a[64:71], v3
  v_smfmac_f32_16x16x64_bf16 v[44:47], v[12:15], a[120:127], v3
  v_smfmac_f32_16x16x64_bf16 v[48:51], v[12:15], a[176:183], v3
  v_smfmac_f32_16x16x64_bf16 v[52:55], v[12:15], a[232:239], v3
  s_waitcnt vmcnt(4)
  v_cmp_eq_u32 vcc, -1, v16
  v_smfmac_f32_16x16x64_bf16 v[56:59], v[12:15], v[152:159], v3
  buffer_load_dwordx4 v[88:91], v117, s[8:11], s26 offen offset:0 sc1
  v_smfmac_f32_16x16x64_bf16 v[62:65], v[12:15], v[208:215], v3
  s_cbranch_vccnz cB_sc2_r2
cB_sc2_c2:
  v_smfmac_f32_16x16x64_bf16 v[36:39], v[16:19], a[16:23], v3
  v_smfmac_f32_16x16x64_bf16 v[40:43], v[16:19], a[72:79], v3
  v_smfmac_f32_16x16x64_bf16 v[44:47], v[16:19], a[128:135], v3
  buffer_load_dwordx4 v[92:95], v117, s[8:11], s26 offen offset:1024 sc1
  v_smfmac_f32_16x16x64_bf16 v[48:51], v[16:19], a[184:191], v3
  v_smfmac_f32_16x16x64_bf16 v[52:55], v[16:19], a[240:247], v3
  s_waitcnt vmcnt(5)
  v_cmp_eq_u32 vcc, -1, v20
  v_smfmac_f32_16x16x64_bf16 v[56:59], v[16:19], v[160:167], v3
  v_smfmac_f32_16x16x64_bf16 v[62:65], v[16:19], v[216:223], v3
  buffer_load_dwordx4 v[96:99], v2, s[8:11], s24 offen offset:0 sc1
  s_cbranch_vccnz cB_sc2_r3
cB_sc2_c3:
  v_smfmac_f32_16x16x64_bf16 v[36:39], v[20:23], a[24:31], v3
  v_smfmac_f32_16x16x64_bf16 v[40:43], v[20:23], a[80:87], v3
  s_waitcnt vmcnt(3)
  v_max3_u32 v66, v24, v27, v28
  v_smfmac_f32_16x16x64_bf16 v[44:47], v[20:23], a[136:143], v3
  v_max3_u32 v66, v66, v31, v32
  v_smfmac_f32_16x16x64_bf16 v[48:51], v[20:23], a[192:199], v3
  buffer_load_dwordx4 v[100:103], v2, s[8:11], s24 offen offset:1024 sc1
  v_max_u32 v66, v66, v35
  v_smfmac_f32_16x16x64_bf16 v[52:55], v[20:23], a[248:255], v3
  v_cmp_eq_u32 vcc, -1, v66
  v_smfmac_f32_16x16x64_bf16 v[56:59], v[20:23], v[168:175], v3
  v_smfmac_f32_16x16x64_bf16 v[62:65], v[20:23], v[224:231], v3
  s_cbranch_vccnz cB_sc2_r4
cB_sc2_c4:
  v_smfmac_f32_16x16x64_bf16 v[62:65], v[24:27], v[232:239], v3
  buffer_load_dwordx4 v[104:107], v2, s[8:11], s26 offen offset:0 sc1
  v_smfmac_f32_16x16x64_bf16 v[62:65], v[32:35], v[240:247], v3
  v_smfmac_f32_16x16x64_bf16 v[62:65], v[28:31], v[248:255], v3
  v_smfmac_f32_16x16x64_bf16 v[52:55], v[24:27], v[120:127], v3
  v_smfmac_f32_16x16x64_bf16 v[52:55], v[32:35], v[128:135], v3
  buffer_load_dwordx4 v[108:111], v2, s[8:11], s26 offen offset:1024 sc1
  v_smfmac_f32_16x16x64_bf16 v[52:55], v[28:31], v[136:143], v3
  v_cvt_pk_bf16_f32 v62, v62, v63
  v_smfmac_f32_16x16x64_bf16 v[56:59], v[24:27], v[176:183], v3
  v_cvt_pk_bf16_f32 v63, v64, v65
  v_smfmac_f32_16x16x64_bf16 v[56:59], v[32:35], v[184:191], v3
  v_mfma_f32_16x16x32_bf16 v[8:11], v[60:63], v[4:7], 0
  v_cvt_pk_bf16_f32 v55, v54, v55
  v_smfmac_f32_16x16x64_bf16 v[56:59], v[28:31], v[192:199], v3
  v_cvt_pk_bf16_f32 v54, v52, v53
  v_smfmac_f32_16x16x64_bf16 v[36:39], v[24:27], a[32:39], v3
  s_nop 1
  v_cvt_pk_bf16_f32 v76, v8, v9
  v_smfmac_f32_16x16x64_bf16 v[36:39], v[32:35], a[40:47], v3
  v_cvt_pk_bf16_f32 v77, v10, v11
  v_smfmac_f32_16x16x64_bf16 v[36:39], v[28:31], a[48:55], v3
  v_cvt_pk_bf16_f32 v56, v56, v57
  v_smfmac_f32_16x16x64_bf16 v[40:43], v[24:27], a[88:95], v3
  v_cvt_pk_bf16_f32 v57, v58, v59
  v_smfmac_f32_16x16x64_bf16 v[40:43], v[32:35], a[96:103], v3
  v_mfma_f32_16x16x32_bf16 v[12:15], v[54:57], v[4:7], 0
  v_cvt_pk_bf16_f32 v39, v38, v39
  v_smfmac_f32_16x16x64_bf16 v[40:43], v[28:31], a[104:111], v3
  v_cvt_pk_bf16_f32 v38, v36, v37
  v_smfmac_f32_16x16x64_bf16 v[44:47], v[24:27], a[144:151], v3
  s_nop 1
  v_cvt_pk_bf16_f32 v78, v12, v13
  v_smfmac_f32_16x16x64_bf16 v[44:47], v[32:35], a[152:159], v3
  v_cvt_pk_bf16_f32 v79, v14, v15
  v_smfmac_f32_16x16x64_bf16 v[44:47], v[28:31], a[160:167], v3
  v_cvt_pk_bf16_f32 v40, v40, v41
  v_smfmac_f32_16x16x64_bf16 v[48:51], v[24:27], a[200:207], v3
  v_cvt_pk_bf16_f32 v41, v42, v43
  v_smfmac_f32_16x16x64_bf16 v[48:51], v[32:35], a[208:215], v3
  v_smfmac_f32_16x16x64_bf16 v[48:51], v[28:31], a[216:223], v3
  s_waitcnt vmcnt(4)
  v_cvt_pk_bf16_f32 v47, v46, v47
  v_smfmac_f32_16x16x64_bf16 v[68:71], v[76:79], v[80:87], v3
  v_cvt_pk_bf16_f32 v46, v44, v45
  v_mfma_f32_16x16x32_bf16 v[8:11], v[38:41], v[4:7], 0
  s_nop 1
  v_cvt_pk_bf16_f32 v48, v48, v49
  v_cvt_pk_bf16_f32 v49, v50, v51
  s_nop 1
  v_mfma_f32_16x16x32_bf16 v[12:15], v[46:49], v[4:7], 0
  v_smfmac_f32_16x16x64_bf16 v[72:75], v[76:79], v[88:95], v3
  v_cvt_pk_bf16_f32 v20, v8, v9
  v_mfma_f32_16x16x32_bf16 v[52:55], v[30:33], v[76:79], 0
  s_waitcnt vmcnt(0)
  v_cvt_pk_bf16_f32 v21, v10, v11
  v_cvt_pk_bf16_f32 v22, v12, v13
  v_cvt_pk_bf16_f32 v23, v14, v15
  s_nop 1
  v_mfma_f32_16x16x32_bf16 v[52:55], v[16:19], v[20:23], v[52:55]
  v_smfmac_f32_16x16x64_bf16 v[68:71], v[20:23], v[96:103], v3
  v_smfmac_f32_16x16x64_bf16 v[72:75], v[20:23], v[104:111], v3
  s_nop 1
  ds_write_b128 v113, v[52:55]
  s_nop 1
  v_permlane32_swap_b32 v68, v70
  v_permlane32_swap_b32 v69, v71
  v_add_f32 v56, v68, v70
  v_add_f32 v58, v69, v71
  v_permlane32_swap_b32 v72, v74
  v_permlane32_swap_b32 v73, v75
  v_add_f32 v57, v72, v74
  v_add_f32 v59, v73, v75
  ds_write_b128 v2, v[56:59] offset:2048
  v_cmp_u_f32 vcc, v57, v59
  v_mov_b32 v68, 0
  v_mov_b32 v69, 0
  v_mov_b32 v70, 0
  v_mov_b32 v71, 0
  s_cbranch_vccnz cB_sc2_retry
cB_sc2_cont:
  s_add_u32 s24, s24, 28672
  s_add_u32 s26, s26, 28672
  buffer_load_dwordx4 v[80:83], v117, s[8:11], s24 offen offset:0 sc1
  buffer_load_dwordx4 v[84:87], v117, s[8:11], s24 offen offset:1024 sc1
  v_mov_b32 v72, 0
  v_mov_b32 v73, 0
  v_mfma_f32_32x32x16_bf16 v[36:51], v[68:71], v[68:71], 0
  s_waitcnt lgkmcnt(0)
  s_barrier
  v_mfma_f32_32x32x16_bf16 v[52:67], v[68:71], v[68:71], 0
  s_buffer_load_dword s70, s[8:11], s35
  s_add_u32 s22, s24, 114688
  s_buffer_load_dword s71, s[8:11], s22
  s_mul_i32 s22, s18, 7168
  s_add_u32 s22, s22, 88024064
  s_buffer_load_dword s72, s[8:11], s22
  s_add_u32 s35, s35, 458752
  v_mov_b32 v74, 0
  v_mov_b32 v75, 0
  s_mov_b32 s19, s18
  s_add_u32 s18, s18, 1
  s_mov_b32 s22, s20
  s_mov_b32 s20, s21
  s_mov_b32 s21, s22
  s_add_u32 s23, s20, 4096
  s_cmp_lt_u32 s19, 63
  s_cbranch_scc1 cB_sc2_loop
  s_branch cB_done
cB_sc2_r0:
  s_add_u32 s31, s31, 1
  buffer_load_dwordx4 v[8:11], v2, s[8:11], s20 offen offset:0 sc1
  s_waitcnt vmcnt(0)
  v_cmp_eq_u32 vcc, -1, v8
  v_mov_b32 v36, 0
  v_mov_b32 v37, 0
  v_mov_b32 v38, 0
  v_mov_b32 v39, 0
  v_mov_b32 v40, 0
  v_mov_b32 v41, 0
  v_mov_b32 v42, 0
  v_mov_b32 v43, 0
  v_mov_b32 v44, 0
  v_mov_b32 v45, 0
  v_mov_b32 v46, 0
  v_mov_b32 v47, 0
  v_mov_b32 v48, 0
  v_mov_b32 v49, 0
  v_mov_b32 v50, 0
  v_mov_b32 v51, 0
  s_nop 1
  s_cbranch_vccz cB_sc2_go
  s_add_u32 s30, s30, 1
  s_cmp_lt_u32 s30, 400000
  s_cbranch_scc1 cB_sc2_r0
  s_branch cB_abort
cB_sc2_r1:
  s_add_u32 s31, s31, 1
  buffer_load_dwordx4 v[12:15], v2, s[8:11], s20 offen offset:1024 sc1
  s_waitcnt vmcnt(0)
  v_cmp_eq_u32 vcc, -1, v12
  s_nop 4
  s_cbranch_vccz cB_sc2_c1
  s_add_u32 s30, s30, 1
  s_cmp_lt_u32 s30, 400000
  s_cbranch_scc1 cB_sc2_r1
  s_branch cB_abort
cB_sc2_r2:
  s_add_u32 s31, s31, 1
  buffer_load_dwordx4 v[16:19], v2, s[8:11], s20 offen offset:2048 sc1
  s_waitcnt vmcnt(0)
  v_cmp_eq_u32 vcc, -1, v16
  s_nop 4
  s_cbranch_vccz cB_sc2_c2
  s_add_u32 s30, s30, 1
  s_cmp_lt_u32 s30, 400000
  s_cbranch_scc1 cB_sc2_r2
  s_branch cB_abort
cB_sc2_r3:
  s_add_u32 s31, s31, 1
  buffer_load_dwordx4 v[20:23], v2, s[8:11], s20 offen offset:3072 sc1
  s_waitcnt vmcnt(0)
  v_cmp_eq_u32 vcc, -1, v20
  s_nop 4
  s_cbranch_vccz cB_sc2_c3
  s_add_u32 s30, s30, 1
  s_cmp_lt_u32 s30, 400000
  s_cbranch_scc1 cB_sc2_r3
  s_branch cB_abort
cB_sc2_r4:
  s_add_u32 s31, s31, 1
  buffer_load_dwordx4 v[24:27], v2, s[8:11], s23 offen offset:0 sc1
  buffer_load_dwordx4 v[32:35], v2, s[8:11], s23 offen offset:1024 sc1
  buffer_load_dwordx4 v[28:31], v2, s[8:11], s23 offen offset:2048 sc1
  s_waitcnt vmcnt(0)
  v_max3_u32 v66, v24, v27, v28
  v_max3_u32 v66, v66, v31, v32
  v_max_u32 v66, v66, v35
  v_cmp_eq_u32 vcc, -1, v66
  s_nop 4
  s_cbranch_vccz cB_sc2_c4
  s_add_u32 s30, s30, 1
  s_cmp_lt_u32 s30, 400000
  s_cbranch_scc1 cB_sc2_r4
  s_branch cB_abort
cB_sc2_retry:
  s_cmp_lg_u32 s62, 0
  s_cbranch_scc1 cB_sc2_cont
  s_waitcnt vmcnt(0) lgkmcnt(0)
cB_sc2_rv:
  buffer_load_dwordx4 v[8:11], v2, s[8:11], s20 offen offset:0 sc1
  buffer_load_dwordx4 v[12:15], v2, s[8:11], s20 offen offset:1024 sc1
  buffer_load_dwordx4 v[16:19], v2, s[8:11], s20 offen offset:2048 sc1
  buffer_load_dwordx4 v[20:23], v2, s[8:11], s20 offen offset:3072 sc1
  buffer_load_dwordx4 v[24:27], v2, s[8:11], s23 offen offset:0 sc1
  buffer_load_dwordx4 v[32:35], v2, s[8:11], s23 offen offset:1024 sc1
  buffer_load_dwordx4 v[28:31], v2, s[8:11], s23 offen offset:2048 sc1
  s_waitcnt vmcnt(0)
  v_pk_max_u16 v66, v8, v9
  v_pk_max_u16 v66, v66, v10
  v_pk_max_u16 v66, v66, v11
  v_pk_max_u16 v66, v66, v12
  v_pk_max_u16 v66, v66, v13
  v_pk_max_u16 v66, v66, v14
  v_pk_max_u16 v66, v66, v15
  v_pk_max_u16 v66, v66, v16
  v_pk_max_u16 v66, v66, v17
  v_pk_max_u16 v66, v66, v18
  v_pk_max_u16 v66, v66, v19
  v_pk_max_u16 v66, v66, v20
  v_pk_max_u16 v66, v66, v21
  v_pk_max_u16 v66, v66, v22
  v_pk_max_u16 v66, v66, v23
  v_pk_max_u16 v66, v66, v24
  v_pk_max_u16 v66, v66, v25
  v_pk_max_u16 v66, v66, v26
  v_pk_max_u16 v66, v66, v27
  v_pk_max_u16 v66, v66, v28
  v_pk_max_u16 v66, v66, v29
  v_pk_max_u16 v66, v66, v30
  v_pk_max_u16 v66, v66, v31
  v_pk_max_u16 v66, v66, v32
  v_pk_max_u16 v66, v66, v33
  v_pk_max_u16 v66, v66, v34
  v_pk_max_u16 v66, v66, v35
  v_lshlrev_b32 v67, 16, v66
  v_max_u32 v66, v66, v67
  v_cmp_le_u32 vcc, 0xffff0000, v66
  s_cbranch_vccz cB_sc2_rk
  s_add_u32 s30, s30, 1
  s_cmp_lt_u32 s30, 400000
  s_cbranch_scc1 cB_sc2_rv
  s_branch cB_abort
cB_sc2_rk:
  s_mov_b32 s62, 1
  v_mov_b32 v36, 0
  v_mov_b32 v37, 0
  v_mov_b32 v38, 0
  v_mov_b32 v39, 0
  v_mov_b32 v40, 0
  v_mov_b32 v41, 0
  v_mov_b32 v42, 0
  v_mov_b32 v43, 0
  v_mov_b32 v44, 0
  v_mov_b32 v45, 0
  v_mov_b32 v46, 0
  v_mov_b32 v47, 0
  v_mov_b32 v48, 0
  v_mov_b32 v49, 0
  v_mov_b32 v50, 0
  v_mov_b32 v51, 0
  v_mov_b32 v62, 0
  v_mov_b32 v63, 0
  v_mov_b32 v64, 0
  v_mov_b32 v65, 0
  v_mov_b32 v68, 0
  v_mov_b32 v69, 0
  v_mov_b32 v70, 0
  v_mov_b32 v71, 0
  v_mov_b32 v72, 0
  v_mov_b32 v73, 0
  v_mov_b32 v74, 0
  v_mov_b32 v75, 0
  v_mov_b32 v52, 0
  v_mov_b32 v53, 0
  v_mov_b32 v54, 0
  v_mov_b32 v55, 0
  v_mov_b32 v56, 0
  v_mov_b32 v57, 0
  v_mov_b32 v58, 0
  v_mov_b32 v59, 0
  s_add_u32 s31, s31, 0x100
  s_nop 0
  s_branch cB_sc2_go
.p2align 6
cB_sc3_loop:
  s_mov_b32 s30, 0
  s_mov_b32 s62, 0
  s_setprio 3
  s_barrier
  buffer_load_dwordx4 v[8:11], v2, s[8:11], s20 offen offset:0 sc1
  s_setprio 2
  buffer_load_dwordx4 v[12:15], v2, s[8:11], s20 offen offset:1024 sc1
  s_setprio 1
  buffer_load_dwordx4 v[16:19], v2, s[8:11], s20 offen offset:2048 sc1
  s_setprio 0
  buffer_load_dwordx4 v[20:23], v2, s[8:11], s20 offen offset:3072 sc1
cB_sc3_go:
  s_waitcnt vmcnt(3)
  v_smfmac_f32_16x16x64_bf16 v[36:39], v[8:11], a[0:7], v3
  buffer_load_dwordx4 v[24:27], v2, s[8:11], s23 offen offset:0 sc1
  v_cmp_eq_u32 vcc, -1, v8
  v_smfmac_f32_16x16x64_bf16 v[40:43], v[8:11], a[56:63], v3
  v_smfmac_f32_16x16x64_bf16 v[44:47], v[8:11], a[112:119], v3
  buffer_load_dwordx4 v[28:31], v2, s[8:11], s23 offen offset:1024 sc1
  s_cbranch_vccnz cB_sc3_r0
  v_smfmac_f32_16x16x64_bf16 v[48:51], v[8:11], a[168:175], v3
  v_smfmac_f32_16x16x64_bf16 v[52:55], v[8:11], a[224:231], v3
  s_waitcnt vmcnt(4)
  v_cmp_eq_u32 vcc, -1, v12
  v_smfmac_f32_16x16x64_bf16 v[56:59], v[8:11], v[144:151], v3
  buffer_load_dwordx4 v[32:35], v2, s[8:11], s23 offen offset:2048 sc1
  v_smfmac_f32_16x16x64_bf16 v[62:65], v[8:11], v[200:207], v3
  s_cbranch_vccnz cB_sc3_r1
cB_sc3_c1:
  v_smfmac_f32_16x16x64_bf16 v[36:39], v[12:15], a[8:15], v3
  v_smfmac_f32_16x16x64_bf16 v[40:43], v[12:15], a[64:71], v3
  v_smfmac_f32_16x16x64_bf16 v[44:47], v[12:15], a[120:127], v3
  v_smfmac_f32_16x16x64_bf16 v[48:51], v[12:15], a[176:183], v3
  v_smfmac_f32_16x16x64_bf16 v[52:55], v[12:15], a[232:239], v3
  s_waitcnt vmcnt(4)
  v_cmp_eq_u32 vcc, -1, v16
  v_smfmac_f32_16x16x64_bf16 v[56:59], v[12:15], v[152:159], v3
  buffer_load_dwordx4 v[88:91], v117, s[8:11], s26 offen offset:0 sc1
  v_smfmac_f32_16x16x64_bf16 v[62:65], v[12:15], v[208:215], v3
  s_cbranch_vccnz cB_sc3_r2
cB_sc3_c2:
  v_smfmac_f32_16x16x64_bf16 v[36:39], v[16:19], a[16:23], v3
  v_smfmac_f32_16x16x64_bf16 v[40:43], v[16:19], a[72:79], v3
  v_smfmac_f32_16x16x64_bf16 v[44:47], v[16:19], a[128:135], v3
  buffer_load_dwordx4 v[92:95], v117, s[8:11], s26 offen offset:1024 sc1
  v_smfmac_f32_16x16x64_bf16 v[48:51], v[16:19], a[184:191], v3
  v_smfmac_f32_16x16x64_bf16 v[52:55], v[16:19], a[240:247], v3
  s_waitcnt vmcnt(5)
  v_cmp_eq_u32 vcc, -1, v20
  v_smfmac_f32_16x16x64_bf16 v[56:59], v[16:19], v[160:167], v3
  v_smfmac_f32_16x16x64_bf16 v[62:65], v[16:19], v[216:223], v3
  buffer_load_dwordx4 v[96:99], v2, s[8:11], s24 offen offset:0 sc1
  s_cbranch_vccnz cB_sc3_r3
cB_sc3_c3:
  v_smfmac_f32_16x16x64_bf16 v[36:39], v[20:23], a[24:31], v3
  v_smfmac_f32_16x16x64_bf16 v[40:43], v[20:23], a[80:87], v3
  s_waitcnt vmcnt(3)
  v_max3_u32 v66, v24, v27, v28
  v_smfmac_f32_16x16x64_bf16 v[44:47], v[20:23], a[136:143], v3
  v_max3_u32 v66, v66, v31, v32
  v_smfmac_f32_16x16x64_bf16 v[48:51], v[20:23], a[192:199], v3
  buffer_load_dwordx4 v[100:103], v2, s[8:11], s24 offen offset:1024 sc1
  v_max_u32 v66, v66, v35
  v_smfmac_f32_16x16x64_bf16 v[52:55], v[20:23], a[248:255], v3
  v_cmp_eq_u32 vcc, -1, v66
  v_smfmac_f32_16x16x64_bf16 v[56:59], v[20:23], v[168:175], v3
  v_smfmac_f32_16x16x64_bf16 v[62:65], v[20:23], v[224:231], v3
  s_cbranch_vccnz cB_sc3_r4
cB_sc3_c4:
  v_smfmac_f32_16x16x64_bf16 v[62:65], v[24:27], v[232:239], v3
  buffer_load_dwordx4 v[104:107], v2, s[8:11], s26 offen offset:0 sc1
  v_smfmac_f32_16x16x64_bf16 v[62:65], v[28:31], v[240:247], v3
  v_smfmac_f32_16x16x64_bf16 v[62:65], v[32:35], v[248:255], v3
  v_smfmac_f32_16x16x64_bf16 v[52:55], v[24:27], v[120:127], v3
  v_smfmac_f32_16x16x64_bf16 v[52:55], v[28:31], v[128:135], v3
  buffer_load_dwordx4 v[108:111], v2, s[8:11], s26 offen offset:1024 sc1
  v_smfmac_f32_16x16x64_bf16 v[52:55], v[32:35], v[136:143], v3
  v_cvt_pk_bf16_f32 v62, v62, v63
  v_smfmac_f32_16x16x64_bf16 v[56:59], v[24:27], v[176:183], v3
  v_cvt_pk_bf16_f32 v63, v64, v65
  v_smfmac_f32_16x16x64_bf16 v[56:59], v[28:31], v[184:191], v3
  v_mfma_f32_16x16x32_bf16 v[8:11], v[60:63], v[4:7], 0
  v_cvt_pk_bf16_f32 v55, v54, v55
  v_smfmac_f32_16x16x64_bf16 v[56:59], v[32:35], v[192:199], v3
  v_cvt_pk_bf16_f32 v54, v52, v53
  v_smfmac_f32_16x16x64_bf16 v[36:39], v[24:27], a[32:39], v3
  s_nop 1
  v_cvt_pk_bf16_f32 v78, v8, v9
  v_smfmac_f32_16x16x64_bf16 v[36:39], v[28:31], a[40:47], v3
  v_cvt_pk_bf16_f32 v79, v10, v11
  v_smfmac_f32_16x16x64_bf16 v[36:39], v[32:35], a[48:55], v3
  v_cvt_pk_bf16_f32 v56, v56, v57
  v_smfmac_f32_16x16x64_bf16 v[40:43], v[24:27], a[88:95], v3
  v_cvt_pk_bf16_f32 v57, v58, v59
  v_smfmac_f32_16x16x64_bf16 v[40:43], v[28:31], a[96:103], v3
  v_mfma_f32_16x16x32_bf16 v[12:15], v[54:57], v[4:7], 0
  v_cvt_pk_bf16_f32 v39, v38, v39
  v_smfmac_f32_16x16x64_bf16 v[40:43], v[32:35], a[104:111], v3
  v_cvt_pk_bf16_f32 v38, v36, v37
  v_smfmac_f32_16x16x64_bf16 v[44:47], v[24:27], a[144:151], v3
  s_nop 1
  v_cvt_pk_bf16_f32 v76, v12, v13
  v_smfmac_f32_16x16x64_bf16 v[44:47], v[28:31], a[152:159], v3
  v_cvt_pk_bf16_f32 v77, v14, v15
  v_smfmac_f32_16x16x64_bf16 v[44:47], v[32:35], a[160:167], v3
  v_cvt_pk_bf16_f32 v40, v40, v41
  v_smfmac_f32_16x16x64_bf16 v[48:51], v[24:27], a[200:207], v3
  v_cvt_pk_bf16_f32 v41, v42, v43
  v_smfmac_f32_16x16x64_bf16 v[48:51], v[28:31], a[208:215], v3
  v_smfmac_f32_16x16x64_bf16 v[48:51], v[32:35], a[216:223], v3
  s_waitcnt vmcnt(4)
  v_cvt_pk_bf16_f32 v47, v46, v47
  v_smfmac_f32_16x16x64_bf16 v[68:71], v[76:79], v[80:87], v3
  v_cvt_pk_bf16_f32 v46, v44, v45
  v_mfma_f32_16x16x32_bf16 v[8:11], v[38:41], v[4:7], 0
  s_nop 1
  v_cvt_pk_bf16_f32 v48, v48, v49
  v_cvt_pk_bf16_f32 v49, v50, v51
  s_nop 1
  v_mfma_f32_16x16x32_bf16 v[12:15], v[46:49], v[4:7], 0
  v_smfmac_f32_16x16x64_bf16 v[72:75], v[76:79], v[88:95], v3
  v_cvt_pk_bf16_f32 v16, v8, v9
  v_mfma_f32_16x16x32_bf16 v[52:55], v[30:33], v[76:79], 0
  s_waitcnt vmcnt(0)
  v_cvt_pk_bf16_f32 v17, v10, v11
  v_cvt_pk_bf16_f32 v18, v12, v13
  v_cvt_pk_bf16_f32 v19, v14, v15
  s_nop 1
  v_mfma_f32_16x16x32_bf16 v[52:55], v[20:23], v[16:19], v[52:55]
  v_smfmac_f32_16x16x64_bf16 v[68:71], v[16:19], v[96:103], v3
  v_smfmac_f32_16x16x64_bf16 v[72:75], v[16:19], v[104:111], v3
  s_nop 1
  ds_write_b128 v113, v[52:55]
  s_nop 1
  v_permlane32_swap_b32 v68, v70
  v_permlane32_swap_b32 v69, v71
  v_add_f32 v56, v68, v70
  v_add_f32 v58, v69, v71
  v_permlane32_swap_b32 v72, v74
  v_permlane32_swap_b32 v73, v75
  v_add_f32 v57, v72, v74
  v_add_f32 v59, v73, v75
  ds_write_b128 v2, v[56:59] offset:3072
  v_cmp_u_f32 vcc, v57, v59
  v_mov_b32 v68, 0
  v_mov_b32 v69, 0
  v_mov_b32 v70, 0
  v_mov_b32 v71, 0
  s_cbranch_vccnz cB_sc3_retry
cB_sc3_cont:
  s_add_u32 s24, s24, 28672
  s_add_u32 s26, s26, 28672
  buffer_load_dwordx4 v[80:83], v117, s[8:11], s24 offen offset:0 sc1
  buffer_load_dwordx4 v[84:87], v117, s[8:11], s24 offen offset:1024 sc1
  v_mov_b32 v72, 0
  v_mov_b32 v73, 0
  v_mfma_f32_16x16x32_bf16 v[62:65], v[68:71], v[68:71], 0
  s_waitcnt lgkmcnt(0)
  s_barrier
  v_mov_b32 v52, 0
  v_mov_b32 v53, 0
  v_mov_b32 v54, 0
  v_mov_b32 v55, 0
  v_mov_b32 v56, 0
  v_mov_b32 v57, 0
  v_mov_b32 v58, 0
  v_mov_b32 v59, 0
  v_mfma_f32_32x32x16_bf16 v[36:51], v[68:71], v[68:71], 0
  v_mov_b32 v74, 0
  v_mov_b32 v75, 0
  s_mov_b32 s19, s18
  s_add_u32 s18, s18, 1
  s_mov_b32 s22, s20
  s_mov_b32 s20, s21
  s_mov_b32 s21, s22
  s_add_u32 s23, s20, 4096
  s_cmp_lt_u32 s19, 63
  s_nop 2
  s_cbranch_scc1 cB_sc3_loop
  s_branch cB_done
cB_sc3_r0:
  s_add_u32 s31, s31, 1
  buffer_load_dwordx4 v[8:11], v2, s[8:11], s20 offen offset:0 sc1
  s_waitcnt vmcnt(0)
  v_cmp_eq_u32 vcc, -1, v8
  v_mov_b32 v36, 0
  v_mov_b32 v37, 0
  v_mov_b32 v38, 0
  v_mov_b32 v39, 0
  v_mov_b32 v40, 0
  v_mov_b32 v41, 0
  v_mov_b32 v42, 0
  v_mov_b32 v43, 0
  v_mov_b32 v44, 0
  v_mov_b32 v45, 0
  v_mov_b32 v46, 0
  v_mov_b32 v47, 0
  v_mov_b32 v48, 0
  v_mov_b32 v49, 0
  v_mov_b32 v50, 0
  v_mov_b32 v51, 0
  s_nop 1
  s_cbranch_vccz cB_sc3_go
  s_add_u32 s30, s30, 1
  s_cmp_lt_u32 s30, 400000
  s_cbranch_scc1 cB_sc3_r0
  s_branch cB_abort
cB_sc3_r1:
  s_add_u32 s31, s31, 1
  buffer_load_dwordx4 v[12:15], v2, s[8:11], s20 offen offset:1024 sc1
  s_waitcnt vmcnt(0)
  v_cmp_eq_u32 vcc, -1, v12
  s_nop 4
  s_cbranch_vccz cB_sc3_c1
  s_add_u32 s30, s30, 1
  s_cmp_lt_u32 s30, 400000
  s_cbranch_scc1 cB_sc3_r1
  s_branch cB_abort
cB_sc3_r2:
  s_add_u32 s31, s31, 1
  buffer_load_dwordx4 v[16:19], v2, s[8:11], s20 offen offset:2048 sc1
  s_waitcnt vmcnt(0)
  v_cmp_eq_u32 vcc, -1, v16
  s_nop 4
  s_cbranch_vccz cB_sc3_c2
  s_add_u32 s30, s30, 1
  s_cmp_lt_u32 s30, 400000
  s_cbranch_scc1 cB_sc3_r2
  s_branch cB_abort
cB_sc3_r3:
  s_add_u32 s31, s31, 1
  buffer_load_dwordx4 v[20:23], v2, s[8:11], s20 offen offset:3072 sc1
  s_waitcnt vmcnt(0)
  v_cmp_eq_u32 vcc, -1, v20
  s_nop 4
  s_cbranch_vccz cB_sc3_c3
  s_add_u32 s30, s30, 1
  s_cmp_lt_u32 s30, 400000
  s_cbranch_scc1 cB_sc3_r3
  s_branch cB_abort
cB_sc3_r4:
  s_add_u32 s31, s31, 1
  buffer_load_dwordx4 v[24:27], v2, s[8:11], s23 offen offset:0 sc1
  buffer_load_dwordx4 v[28:31], v2, s[8:11], s23 offen offset:1024 sc1
  buffer_load_dwordx4 v[32:35], v2, s[8:11], s23 offen offset:2048 sc1
  s_waitcnt vmcnt(0)
  v_max3_u32 v66, v24, v27, v28
  v_max3_u32 v66, v66, v31, v32
  v_max_u32 v66, v66, v35
  v_cmp_eq_u32 vcc, -1, v66
  s_nop 4
  s_cbranch_vccz cB_sc3_c4
  s_add_u32 s30, s30, 1
  s_cmp_lt_u32 s30, 400000
  s_cbranch_scc1 cB_sc3_r4
  s_branch cB_abort
cB_sc3_retry:
  s_cmp_lg_u32 s62, 0
  s_cbranch_scc1 cB_sc3_cont
  s_waitcnt vmcnt(0) lgkmcnt(0)
cB_sc3_rv:
  buffer_load_dwordx4 v[8:11], v2, s[8:11], s20 offen offset:0 sc1
  buffer_load_dwordx4 v[12:15], v2, s[8:11], s20 offen offset:1024 sc1
  buffer_load_dwordx4 v[16:19], v2, s[8:11], s20 offen offset:2048 sc1
  buffer_load_dwordx4 v[20:23], v2, s[8:11], s20 offen offset:3072 sc1
  buffer_load_dwordx4 v[24:27], v2, s[8:11], s23 offen offset:0 sc1
  buffer_load_dwordx4 v[28:31], v2, s[8:11], s23 offen offset:1024 sc1
  buffer_load_dwordx4 v[32:35], v2, s[8:11], s23 offen offset:2048 sc1
  s_waitcnt vmcnt(0)
  v_pk_max_u16 v66, v8, v9
  v_pk_max_u16 v66, v66, v10
  v_pk_max_u16 v66, v66, v11
  v_pk_max_u16 v66, v66, v12
  v_pk_max_u16 v66, v66, v13
  v_pk_max_u16 v66, v66, v14
  v_pk_max_u16 v66, v66, v15
  v_pk_max_u16 v66, v66, v16
  v_pk_max_u16 v66, v66, v17
  v_pk_max_u16 v66, v66, v18
  v_pk_max_u16 v66, v66, v19
  v_pk_max_u16 v66, v66, v20
  v_pk_max_u16 v66, v66, v21
  v_pk_max_u16 v66, v66, v22
  v_pk_max_u16 v66, v66, v23
  v_pk_max_u16 v66, v66, v24
  v_pk_max_u16 v66, v66, v25
  v_pk_max_u16 v66, v66, v26
  v_pk_max_u16 v66, v66, v27
  v_pk_max_u16 v66, v66, v28
  v_pk_max_u16 v66, v66, v29
  v_pk_max_u16 v66, v66, v30
  v_pk_max_u16 v66, v66, v31
  v_pk_max_u16 v66, v66, v32
  v_pk_max_u16 v66, v66, v33
  v_pk_max_u16 v66, v66, v34
  v_pk_max_u16 v66, v66, v35
  v_lshlrev_b32 v67, 16, v66
  v_max_u32 v66, v66, v67
  v_cmp_le_u32 vcc, 0xffff0000, v66
  s_cbranch_vccz cB_sc3_rk
  s_add_u32 s30, s30, 1
  s_cmp_lt_u32 s30, 400000
  s_cbranch_scc1 cB_sc3_rv
  s_branch cB_abort
cB_sc3_rk:
  s_mov_b32 s62, 1
  v_mov_b32 v36, 0
  v_mov_b32 v37, 0
  v_mov_b32 v38, 0
  v_mov_b32 v39, 0
  v_mov_b32 v40, 0
  v_mov_b32 v41, 0
  v_mov_b32 v42, 0
  v_mov_b32 v43, 0
  v_mov_b32 v44, 0
  v_mov_b32 v45, 0
  v_mov_b32 v46, 0
  v_mov_b32 v47, 0
  v_mov_b32 v48, 0
  v_mov_b32 v49, 0
  v_mov_b32 v50, 0
  v_mov_b32 v51, 0
  v_mov_b32 v62, 0
  v_mov_b32 v63, 0
  v_mov_b32 v64, 0
  v_mov_b32 v65, 0
  v_mov_b32 v68, 0
  v_mov_b32 v69, 0
  v_mov_b32 v70, 0
  v_mov_b32 v71, 0
  v_mov_b32 v72, 0
  v_mov_b32 v73, 0
  v_mov_b32 v74, 0
  v_mov_b32 v75, 0
  v_mov_b32 v52, 0
  v_mov_b32 v53, 0
  v_mov_b32 v54, 0
  v_mov_b32 v55, 0
  v_mov_b32 v56, 0
  v_mov_b32 v57, 0
  v_mov_b32 v58, 0
  v_mov_b32 v59, 0
  s_add_u32 s31, s31, 0x100
  s_nop 0
  s_branch cB_sc3_go
.p2align 6
cB_va0_loop:
  s_mov_b32 s30, 0
  s_barrier
  buffer_load_dwordx4 v[24:27], v2, s[8:11], s23 offen offset:0 sc1
  buffer_load_dwordx4 v[28:31], v2, s[8:11], s23 offen offset:1024 sc1
  s_barrier
  buffer_store_dword v160, v1, s[8:11], s38 offen sc1
  s_add_u32 s22, s25, 0
  buffer_load_dwordx4 v[80:83], v6, s[8:11], s22 offen offset:0 sc1
  buffer_load_dwordx4 v[84:87], v6, s[8:11], s22 offen offset:1792 sc1
  s_add_u32 s22, s25, 3584
  buffer_load_dwordx4 v[88:91], v6, s[8:11], s22 offen offset:0 sc1
  buffer_load_dwordx4 v[92:95], v6, s[8:11], s22 offen offset:1792 sc1
  s_add_u32 s22, s25, 7168
  buffer_load_dwordx4 v[96:99], v6, s[8:11], s22 offen offset:0 sc1
  s_mul_i32 s38, s18, 7168
  s_add_u32 s38, s38, 88002560
  s_waitcnt vmcnt(6)
  ds_write_b128 v2, v[24:27] offset:12288
  ds_write_b128 v2, v[28:31] offset:13312
  v_smfmac_f32_16x16x64_bf16 v[36:39], v[24:27], a[32:39], v3
  buffer_load_dwordx4 v[100:103], v6, s[8:11], s22 offen offset:1792 sc1
  v_smfmac_f32_16x16x64_bf16 v[40:43], v[24:27], a[88:95], v3
  s_add_u32 s22, s25, 10752
  buffer_load_dwordx4 v[104:107], v6, s[8:11], s22 offen offset:0 sc1
  v_smfmac_f32_16x16x64_bf16 v[44:47], v[24:27], a[144:151], v3
  buffer_load_dwordx4 v[108:111], v6, s[8:11], s22 offen offset:1792 sc1
  v_smfmac_f32_16x16x64_bf16 v[48:51], v[24:27], a[200:207], v3
  s_add_u32 s22, s25, 14336
  buffer_load_dwordx4 v[112:115], v6, s[8:11], s22 offen offset:0 sc1
  v_smfmac_f32_16x16x64_bf16 v[52:55], v[24:27], v[176:183], v3
  s_waitcnt lgkmcnt(0)
  s_barrier
  ds_read_b128 v[8:11], v2 offset:8192
  ds_read_b128 v[12:15], v2 offset:9216
  ds_read_b128 v[16:19], v2 offset:10240
  ds_read_b128 v[20:23], v2 offset:11264
  ds_read_b128 v[32:35], v2 offset:14336
  buffer_load_dwordx4 v[116:119], v6, s[8:11], s22 offen offset:1792 sc1
  v_smfmac_f32_16x16x64_bf16 v[56:59], v[24:27], v[232:239], v3
  s_add_u32 s22, s25, 17920
  buffer_load_dwordx4 v[120:123], v6, s[8:11], s22 offen offset:0 sc1
  v_smfmac_f32_16x16x64_bf16 v[36:39], v[28:31], a[40:47], v3
  buffer_load_dwordx4 v[124:127], v6, s[8:11], s22 offen offset:1792 sc1
  v_smfmac_f32_16x16x64_bf16 v[40:43], v[28:31], a[96:103], v3
  s_add_u32 s22, s25, 21504
  buffer_load_dwordx4 v[128:131], v6, s[8:11], s22 offen offset:0 sc1
  v_smfmac_f32_16x16x64_bf16 v[44:47], v[28:31], a[152:159], v3
  buffer_load_dwordx4 v[132:135], v6, s[8:11], s22 offen offset:1792 sc1
  v_smfmac_f32_16x16x64_bf16 v[48:51], v[28:31], a[208:215], v3
  s_add_u32 s22, s25, 25088
  buffer_load_dwordx4 v[136:139], v6, s[8:11], s22 offen offset:0 sc1
  v_smfmac_f32_16x16x64_bf16 v[52:55], v[28:31], v[184:191], v3
  ds_read_b128 v[64:67], v0 offset:0
  ds_read_b128 v[68:71], v0 offset:1024
  buffer_load_dwordx4 v[140:143], v6, s[8:11], s22 offen offset:1792 sc1
  v_smfmac_f32_16x16x64_bf16 v[56:59], v[28:31], v[240:247], v3
  s_waitcnt lgkmcnt(6)
  ds_read_b128 v[72:75], v0 offset:2048
  ds_read_b128 v[76:79], v0 offset:3072
  v_smfmac_f32_16x16x64_bf16 v[36:39], v[8:11], a[0:7], v3
  s_waitcnt lgkmcnt(7)
  v_smfmac_f32_16x16x64_bf16 v[36:39], v[12:15], a[8:15], v3
  s_waitcnt lgkmcnt(6)
  v_smfmac_f32_16x16x64_bf16 v[36:39], v[16:19], a[16:23], v3
  s_waitcnt lgkmcnt(2)
  v_smfmac_f32_16x16x64_bf16 v[60:63], v[8:11], v[64:71], v3
  s_waitcnt lgkmcnt(5)
  ds_read_b128 v[144:147], v0 offset:4096
  ds_read_b128 v[148:151], v0 offset:5120
  v_smfmac_f32_16x16x64_bf16 v[36:39], v[20:23], a[24:31], v3
  s_waitcnt lgkmcnt(6)
  v_smfmac_f32_16x16x64_bf16 v[36:39], v[32:35], a[48:55], v3
  v_smfmac_f32_16x16x64_bf16 v[40:43], v[8:11], a[56:63], v3
  s_waitcnt lgkmcnt(2)
  v_smfmac_f32_16x16x64_bf16 v[60:63], v[12:15], v[72:79], v3
  ds_read_b128 v[64:67], v0 offset:6144
  ds_read_b128 v[68:71], v0 offset:7168
  v_smfmac_f32_16x16x64_bf16 v[40:43], v[12:15], a[64:71], v3
  v_permlane32_swap_b32 v36, v38
  v_smfmac_f32_16x16x64_bf16 v[40:43], v[16:19], a[72:79], v3
  v_permlane32_swap_b32 v37, v39
  v_smfmac_f32_16x16x64_bf16 v[40:43], v[20:23], a[80:87], v3
  s_waitcnt lgkmcnt(2)
  v_add_f32 v36, v36, v38
  v_smfmac_f32_16x16x64_bf16 v[60:63], v[16:19], v[144:151], v3
  ds_read_b128 v[72:75], v0 offset:8192
  ds_read_b128 v[76:79], v0 offset:9216
  v_add_f32 v37, v37, v39
  v_smfmac_f32_16x16x64_bf16 v[40:43], v[32:35], a[104:111], v3
  v_cmp_u_f32 vcc, v36, v37
  v_smfmac_f32_16x16x64_bf16 v[44:47], v[8:11], a[112:119], v3
  v_cvt_pk_bf16_f32 v38, v36, v37
  v_smfmac_f32_16x16x64_bf16 v[44:47], v[12:15], a[120:127], v3
  ds_write_b32 v152, v38
  s_waitcnt lgkmcnt(3)
  s_cbranch_vccnz cB_va0_slow
  v_permlane32_swap_b32 v40, v42
  v_smfmac_f32_16x16x64_bf16 v[60:63], v[20:23], v[64:71], v3
  ds_read_b128 v[144:147], v0 offset:10240
  ds_read_b128 v[148:151], v0 offset:11264
  v_permlane32_swap_b32 v41, v43
  v_smfmac_f32_16x16x64_bf16 v[44:47], v[16:19], a[128:135], v3
  buffer_store_dword v162, v1, s[8:11], s21 offen sc1
  v_add_f32 v40, v40, v42
  v_smfmac_f32_16x16x64_bf16 v[44:47], v[20:23], a[136:143], v3
  v_add_f32 v41, v41, v43
  v_smfmac_f32_16x16x64_bf16 v[44:47], v[32:35], a[160:167], v3
  s_waitcnt lgkmcnt(3)
  v_cvt_pk_bf16_f32 v42, v40, v41
  v_smfmac_f32_16x16x64_bf16 v[60:63], v[24:27], v[72:79], v3
  ds_write_b32 v153, v42
  ds_read_b128 v[64:67], v0 offset:12288
  ds_read_b128 v[68:71], v0 offset:13312
  v_smfmac_f32_16x16x64_bf16 v[48:51], v[8:11], a[168:175], v3
  s_nop 0
  v_permlane32_swap_b32 v44, v46
  v_smfmac_f32_16x16x64_bf16 v[48:51], v[12:15], a[176:183], v3
  v_permlane32_swap_b32 v45, v47
  v_smfmac_f32_16x16x64_bf16 v[48:51], v[16:19], a[184:191], v3
  s_waitcnt lgkmcnt(3)
  v_add_f32 v44, v44, v46
  v_smfmac_f32_16x16x64_bf16 v[60:63], v[28:31], v[144:151], v3
  v_add_f32 v45, v45, v47
  v_smfmac_f32_16x16x64_bf16 v[48:51], v[20:23], a[192:199], v3
  v_cvt_pk_bf16_f32 v46, v44, v45
  v_smfmac_f32_16x16x64_bf16 v[48:51], v[32:35], a[216:223], v3
  ds_write_b32 v154, v46
  v_smfmac_f32_16x16x64_bf16 v[52:55], v[8:11], a[224:231], v3
  s_waitcnt lgkmcnt(1)
  v_smfmac_f32_16x16x64_bf16 v[60:63], v[32:35], v[64:71], v3
  v_smfmac_f32_16x16x64_bf16 v[52:55], v[12:15], a[232:239], v3
  v_permlane32_swap_b32 v48, v50
  v_smfmac_f32_16x16x64_bf16 v[52:55], v[16:19], a[240:247], v3
  v_permlane32_swap_b32 v49, v51
  v_smfmac_f32_16x16x64_bf16 v[52:55], v[20:23], a[248:255], v3
  v_add_f32 v48, v48, v50
  v_smfmac_f32_16x16x64_bf16 v[52:55], v[32:35], v[192:199], v3
  v_add_f32 v49, v49, v51
  v_smfmac_f32_16x16x64_bf16 v[56:59], v[8:11], v[200:207], v3
  v_cvt_pk_bf16_f32 v50, v48, v49
  v_smfmac_f32_16x16x64_bf16 v[56:59], v[12:15], v[208:215], v3
  ds_write_b32 v155, v50
  v_permlane32_swap_b32 v60, v62
  v_smfmac_f32_16x16x64_bf16 v[56:59], v[16:19], v[216:223], v3
  v_permlane32_swap_b32 v61, v63
  v_smfmac_f32_16x16x64_bf16 v[56:59], v[20:23], v[224:231], v3
  v_add_f32 v60, v60, v62
  v_smfmac_f32_16x16x64_bf16 v[56:59], v[32:35], v[248:255], v3
  v_add_f32 v61, v61, v63
  v_cvt_pk_bf16_f32 v62, v60, v61
  ds_write_b32 v158, v62
  v_permlane32_swap_b32 v52, v54
  v_permlane32_swap_b32 v53, v55
  v_add_f32 v52, v52, v54
  v_add_f32 v53, v53, v55
  v_cvt_pk_bf16_f32 v54, v52, v53
  ds_write_b32 v156, v54
  v_permlane32_swap_b32 v56, v58
  v_permlane32_swap_b32 v57, v59
  v_add_f32 v56, v56, v58
  v_add_f32 v57, v57, v59
  v_cvt_pk_bf16_f32 v58, v56, v57
  ds_write_b32 v157, v58
cB_va0_t2d:
  s_add_u32 s22, s20, 9216
  s_add_u32 s34, s20, 13312
  s_add_u32 s36, s20, 7168
  s_mov_b32 s37, 0
  v_mov_b32 v48, 0
  v_mov_b32 v49, 0
  v_mov_b32 v50, 0
  v_mov_b32 v51, 0
  v_mov_b32 v163, s18
  s_waitcnt lgkmcnt(0)
  s_setprio 3
  buffer_load_dword v52, v4, s[8:11], 0 offen sc1
  buffer_load_dword v53, v4, s[8:11], 0 offen sc1
  buffer_load_dword v54, v4, s[8:11], 0 offen sc1
  buffer_load_dword v55, v4, s[8:11], 0 offen sc1
cB_va0_fw_l:
  s_waitcnt vmcnt(3)
  v_cmp_gt_u32 vcc, s18, v52
  s_cbranch_vccz cB_va0_fw_d
  buffer_load_dword v52, v4, s[8:11], 0 offen sc1
  s_waitcnt vmcnt(3)
  v_cmp_gt_u32 vcc, s18, v53
  s_cbranch_vccz cB_va0_fw_d
  buffer_load_dword v53, v4, s[8:11], 0 offen sc1
  s_waitcnt vmcnt(3)
  v_cmp_gt_u32 vcc, s18, v54
  s_cbranch_vccz cB_va0_fw_d
  buffer_load_dword v54, v4, s[8:11], 0 offen sc1
  s_waitcnt vmcnt(3)
  v_cmp_gt_u32 vcc, s18, v55
  s_cbranch_vccz cB_va0_fw_d
  buffer_load_dword v55, v4, s[8:11], 0 offen sc1
  s_add_u32 s30, s30, 1
  s_cmp_lt_u32 s30, 400000
  s_cbranch_scc1 cB_va0_fw_l
  s_branch cB_abort
cB_va0_fw_d:
  buffer_load_dwordx4 v[8:11], v2, s[8:11], s22 offen offset:0 sc1
  buffer_load_dwordx4 v[12:15], v2, s[8:11], s22 offen offset:1024 sc1
  buffer_load_dwordx4 v[16:19], v2, s[8:11], s22 offen offset:2048 sc1
  buffer_load_dwordx4 v[20:23], v2, s[8:11], s22 offen offset:3072 sc1
  buffer_load_dwordx4 v[24:27], v2, s[8:11], s34 offen offset:0 sc1
  buffer_load_dwordx4 v[28:31], v2, s[8:11], s34 offen offset:1024 sc1
  buffer_load_dwordx4 v[32:35], v2, s[8:11], s34 offen offset:2048 sc1
  buffer_load_dwordx4 v[36:39], v2, s[8:11], s34 offen offset:3072 sc1
  buffer_load_dwordx4 v[40:43], v2, s[8:11], s36 offen offset:0 sc1
  buffer_load_dwordx4 v[44:47], v2, s[8:11], s36 offen offset:1024 sc1
  s_barrier
  ds_read_b128 v[64:67], v2 offset:0
  ds_read_b128 v[68:71], v2 offset:1024
  ds_read_b128 v[72:75], v2 offset:2048
  ds_read_b128 v[76:79], v2 offset:3072
cB_va0_lp:
  s_waitcnt vmcnt(9)
  v_smfmac_f32_16x16x64_bf16 v[48:51], v[8:11], v[80:87], v3
  s_waitcnt vmcnt(8)
  v_smfmac_f32_16x16x64_bf16 v[48:51], v[12:15], v[88:95], v3
  s_waitcnt vmcnt(7)
  v_smfmac_f32_16x16x64_bf16 v[48:51], v[16:19], v[96:103], v3
  s_waitcnt vmcnt(6)
  v_smfmac_f32_16x16x64_bf16 v[48:51], v[20:23], v[104:111], v3
  s_waitcnt vmcnt(5)
  v_smfmac_f32_16x16x64_bf16 v[48:51], v[24:27], v[112:119], v3
  s_waitcnt vmcnt(4)
  v_smfmac_f32_16x16x64_bf16 v[48:51], v[28:31], v[120:127], v3
  s_waitcnt vmcnt(3)
  v_smfmac_f32_16x16x64_bf16 v[48:51], v[32:35], v[128:135], v3
  s_waitcnt vmcnt(2)
  v_smfmac_f32_16x16x64_bf16 v[48:51], v[36:39], v[136:143], v3
  s_waitcnt vmcnt(1) lgkmcnt(0)
  v_smfmac_f32_16x16x64_bf16 v[48:51], v[40:43], v[64:71], v3
  s_waitcnt vmcnt(0)
  v_smfmac_f32_16x16x64_bf16 v[48:51], v[44:47], v[72:79], v3
  s_nop 7
  v_permlane32_swap_b32 v48, v50
  v_permlane32_swap_b32 v49, v51
  v_add_f32 v48, v48, v50
  v_add_f32 v49, v49, v51
  v_cvt_pk_bf16_f32 v160, v48, v49
  v_cmp_u_f32 vcc, v48, v49
  s_nop 0
  v_mov_b32_dpp v161, v160 quad_perm:[1,0,3,2] row_mask:0xf bank_mask:0xf
  v_perm_b32 v160, v161, v160, v5
  v_min_u32 v160, -2, v160
  s_cbranch_vccnz cB_va0_rp
cB_va0_cont:
  buffer_store_dword v160, v1, s[8:11], s21 offen sc1
  s_setprio 0
  s_cmp_lg_u32 s19, 62
  s_cbranch_scc1 cB_va0_nl
  buffer_store_dword v160, v1, s[8:11], s38 offen sc1
  s_waitcnt vmcnt(0)
  buffer_wbl2 sc1
  s_branch cB_done
cB_va0_nl:
  s_add_u32 s25, s25, 458752
  v_mov_b32 v36, 0
  v_mov_b32 v37, 0
  v_mov_b32 v38, 0
  v_mov_b32 v39, 0
  v_mov_b32 v40, 0
  v_mov_b32 v41, 0
  v_mov_b32 v42, 0
  v_mov_b32 v43, 0
  v_mov_b32 v44, 0
  v_mov_b32 v45, 0
  v_mov_b32 v46, 0
  v_mov_b32 v47, 0
  v_mov_b32 v48, 0
  v_mov_b32 v49, 0
  v_mov_b32 v50, 0
  v_mov_b32 v51, 0
  v_mov_b32 v52, 0
  v_mov_b32 v53, 0
  v_mov_b32 v54, 0
  v_mov_b32 v55, 0
  v_mov_b32 v56, 0
  v_mov_b32 v57, 0
  v_mov_b32 v58, 0
  v_mov_b32 v59, 0
  v_mov_b32 v60, 0
  v_mov_b32 v61, 0
  v_mov_b32 v62, 0
  v_mov_b32 v63, 0
  s_mov_b32 s19, s18
  s_add_u32 s18, s18, 1
  s_mov_b32 s22, s20
  s_mov_b32 s20, s21
  s_mov_b32 s21, s22
  s_add_u32 s23, s20, 4096
  s_branch cB_va0_loop
cB_va0_slow:
  s_waitcnt lgkmcnt(0)
cB_va0_sl1:
  s_add_u32 s31, s31, 0x1000000
  buffer_load_dwordx4 v[8:11], v2, s[8:11], s20 offen offset:0 sc1
  buffer_load_dwordx4 v[12:15], v2, s[8:11], s20 offen offset:1024 sc1
  buffer_load_dwordx4 v[16:19], v2, s[8:11], s20 offen offset:2048 sc1
  buffer_load_dwordx4 v[20:23], v2, s[8:11], s20 offen offset:3072 sc1
  buffer_load_dwordx4 v[24:27], v2, s[8:11], s23 offen offset:0 sc1
  buffer_load_dwordx4 v[28:31], v2, s[8:11], s23 offen offset:1024 sc1
  buffer_load_dwordx4 v[32:35], v2, s[8:11], s23 offen offset:2048 sc1
  s_waitcnt vmcnt(0)
  v_max3_u32 v36, v8, v9, v10
  v_max3_u32 v36, v36, v11, v12
  v_max3_u32 v36, v36, v13, v14
  v_max3_u32 v36, v36, v15, v16
  v_max3_u32 v36, v36, v17, v18
  v_max3_u32 v36, v36, v19, v20
  v_max3_u32 v36, v36, v21, v22
  v_max3_u32 v36, v36, v23, v24
  v_max3_u32 v36, v36, v25, v26
  v_max3_u32 v36, v36, v27, v28
  v_max3_u32 v36, v36, v29, v30
  v_max3_u32 v36, v36, v31, v32
  v_max3_u32 v36, v36, v33, v34
  v_max_u32 v36, v36, v35
  v_cmp_eq_u32 vcc, -1, v36
  s_cbranch_vccz cB_va0_sl2
  s_add_u32 s30, s30, 1
  s_cmp_lt_u32 s30, 400000
  s_cbranch_scc1 cB_va0_sl1
  s_branch cB_abort
cB_va0_sl2:
  v_mov_b32 v36, 0
  v_mov_b32 v37, 0
  v_mov_b32 v38, 0
  v_mov_b32 v39, 0
  v_mov_b32 v40, 0
  v_mov_b32 v41, 0
  v_mov_b32 v42, 0
  v_mov_b32 v43, 0
  v_mov_b32 v44, 0
  v_mov_b32 v45, 0
  v_mov_b32 v46, 0
  v_mov_b32 v47, 0
  v_mov_b32 v48, 0
  v_mov_b32 v49, 0
  v_mov_b32 v50, 0
  v_mov_b32 v51, 0
  v_mov_b32 v52, 0
  v_mov_b32 v53, 0
  v_mov_b32 v54, 0
  v_mov_b32 v55, 0
  v_mov_b32 v56, 0
  v_mov_b32 v57, 0
  v_mov_b32 v58, 0
  v_mov_b32 v59, 0
  v_mov_b32 v60, 0
  v_mov_b32 v61, 0
  v_mov_b32 v62, 0
  v_mov_b32 v63, 0
  buffer_store_dword v162, v1, s[8:11], s21 offen sc1
  ds_read_b128 v[64:67], v0 offset:0
  ds_read_b128 v[68:71], v0 offset:1024
  v_smfmac_f32_16x16x64_bf16 v[36:39], v[8:11], a[0:7], v3
  v_smfmac_f32_16x16x64_bf16 v[40:43], v[8:11], a[56:63], v3
  v_smfmac_f32_16x16x64_bf16 v[44:47], v[8:11], a[112:119], v3
  v_smfmac_f32_16x16x64_bf16 v[48:51], v[8:11], a[168:175], v3
  v_smfmac_f32_16x16x64_bf16 v[52:55], v[8:11], a[224:231], v3
  v_smfmac_f32_16x16x64_bf16 v[56:59], v[8:11], v[200:207], v3
  s_waitcnt lgkmcnt(0)
  v_smfmac_f32_16x16x64_bf16 v[60:63], v[8:11], v[64:71], v3
  ds_read_b128 v[72:75], v0 offset:2048
  ds_read_b128 v[76:79], v0 offset:3072
  v_smfmac_f32_16x16x64_bf16 v[36:39], v[12:15], a[8:15], v3
  v_smfmac_f32_16x16x64_bf16 v[40:43], v[12:15], a[64:71], v3
  v_smfmac_f32_16x16x64_bf16 v[44:47], v[12:15], a[120:127], v3
  v_smfmac_f32_16x16x64_bf16 v[48:51], v[12:15], a[176:183], v3
  v_smfmac_f32_16x16x64_bf16 v[52:55], v[12:15], a[232:239], v3
  v_smfmac_f32_16x16x64_bf16 v[56:59], v[12:15], v[208:215], v3
  s_waitcnt lgkmcnt(0)
  v_smfmac_f32_16x16x64_bf16 v[60:63], v[12:15], v[72:79], v3
  ds_read_b128 v[144:147], v0 offset:4096
  ds_read_b128 v[148:151], v0 offset:5120
  v_smfmac_f32_16x16x64_bf16 v[36:39], v[16:19], a[16:23], v3
  v_smfmac_f32_16x16x64_bf16 v[40:43], v[16:19], a[72:79], v3
  v_smfmac_f32_16x16x64_bf16 v[44:47], v[16:19], a[128:135], v3
  v_smfmac_f32_16x16x64_bf16 v[48:51], v[16:19], a[184:191], v3
  v_smfmac_f32_16x16x64_bf16 v[52:55], v[16:19], a[240:247], v3
  v_smfmac_f32_16x16x64_bf16 v[56:59], v[16:19], v[216:223], v3
  s_waitcnt lgkmcnt(0)
  v_smfmac_f32_16x16x64_bf16 v[60:63], v[16:19], v[144:151], v3
  ds_read_b128 v[64:67], v0 offset:6144
  ds_read_b128 v[68:71], v0 offset:7168
  v_smfmac_f32_16x16x64_bf16 v[36:39], v[20:23], a[24:31], v3
  v_smfmac_f32_16x16x64_bf16 v[40:43], v[20:23], a[80:87], v3
  v_smfmac_f32_16x16x64_bf16 v[44:47], v[20:23], a[136:143], v3
  v_smfmac_f32_16x16x64_bf16 v[48:51], v[20:23], a[192:199], v3
  v_smfmac_f32_16x16x64_bf16 v[52:55], v[20:23], a[248:255], v3
  v_smfmac_f32_16x16x64_bf16 v[56:59], v[20:23], v[224:231], v3
  s_waitcnt lgkmcnt(0)
  v_smfmac_f32_16x16x64_bf16 v[60:63], v[20:23], v[64:71], v3
  ds_read_b128 v[72:75], v0 offset:8192
  ds_read_b128 v[76:79], v0 offset:9216
  v_smfmac_f32_16x16x64_bf16 v[36:39], v[24:27], a[32:39], v3
  v_smfmac_f32_16x16x64_bf16 v[40:43], v[24:27], a[88:95], v3
  v_smfmac_f32_16x16x64_bf16 v[44:47], v[24:27], a[144:151], v3
  v_smfmac_f32_16x16x64_bf16 v[48:51], v[24:27], a[200:207], v3
  v_smfmac_f32_16x16x64_bf16 v[52:55], v[24:27], v[176:183], v3
  v_smfmac_f32_16x16x64_bf16 v[56:59], v[24:27], v[232:239], v3
  s_waitcnt lgkmcnt(0)
  v_smfmac_f32_16x16x64_bf16 v[60:63], v[24:27], v[72:79], v3
  ds_read_b128 v[144:147], v0 offset:10240
  ds_read_b128 v[148:151], v0 offset:11264
  v_smfmac_f32_16x16x64_bf16 v[36:39], v[28:31], a[40:47], v3
  v_smfmac_f32_16x16x64_bf16 v[40:43], v[28:31], a[96:103], v3
  v_smfmac_f32_16x16x64_bf16 v[44:47], v[28:31], a[152:159], v3
  v_smfmac_f32_16x16x64_bf16 v[48:51], v[28:31], a[208:215], v3
  v_smfmac_f32_16x16x64_bf16 v[52:55], v[28:31], v[184:191], v3
  v_smfmac_f32_16x16x64_bf16 v[56:59], v[28:31], v[240:247], v3
  s_waitcnt lgkmcnt(0)
  v_smfmac_f32_16x16x64_bf16 v[60:63], v[28:31], v[144:151], v3
  ds_read_b128 v[64:67], v0 offset:12288
  ds_read_b128 v[68:71], v0 offset:13312
  v_smfmac_f32_16x16x64_bf16 v[36:39], v[32:35], a[48:55], v3
  v_smfmac_f32_16x16x64_bf16 v[40:43], v[32:35], a[104:111], v3
  v_smfmac_f32_16x16x64_bf16 v[44:47], v[32:35], a[160:167], v3
  v_smfmac_f32_16x16x64_bf16 v[48:51], v[32:35], a[216:223], v3
  v_smfmac_f32_16x16x64_bf16 v[52:55], v[32:35], v[192:199], v3
  v_smfmac_f32_16x16x64_bf16 v[56:59], v[32:35], v[248:255], v3
  s_waitcnt lgkmcnt(0)
  v_smfmac_f32_16x16x64_bf16 v[60:63], v[32:35], v[64:71], v3
  v_permlane32_swap_b32 v36, v38
  v_permlane32_swap_b32 v37, v39
  v_add_f32 v36, v36, v38
  v_add_f32 v37, v37, v39
  v_cvt_pk_bf16_f32 v38, v36, v37
  ds_write_b32 v152, v38
  v_permlane32_swap_b32 v40, v42
  v_permlane32_swap_b32 v41, v43
  v_add_f32 v40, v40, v42
  v_add_f32 v41, v41, v43
  v_cvt_pk_bf16_f32 v42, v40, v41
  ds_write_b32 v153, v42
  v_permlane32_swap_b32 v44, v46
  v_permlane32_swap_b32 v45, v47
  v_add_f32 v44, v44, v46
  v_add_f32 v45, v45, v47
  v_cvt_pk_bf16_f32 v46, v44, v45
  ds_write_b32 v154, v46
  v_permlane32_swap_b32 v48, v50
  v_permlane32_swap_b32 v49, v51
  v_add_f32 v48, v48, v50
  v_add_f32 v49, v49, v51
  v_cvt_pk_bf16_f32 v50, v48, v49
  ds_write_b32 v155, v50
  v_permlane32_swap_b32 v52, v54
  v_permlane32_swap_b32 v53, v55
  v_add_f32 v52, v52, v54
  v_add_f32 v53, v53, v55
  v_cvt_pk_bf16_f32 v54, v52, v53
  ds_write_b32 v156, v54
  v_permlane32_swap_b32 v56, v58
  v_permlane32_swap_b32 v57, v59
  v_add_f32 v56, v56, v58
  v_add_f32 v57, v57, v59
  v_cvt_pk_bf16_f32 v58, v56, v57
  ds_write_b32 v157, v58
  v_permlane32_swap_b32 v60, v62
  v_permlane32_swap_b32 v61, v63
  v_add_f32 v60, v60, v62
  v_add_f32 v61, v61, v63
  v_cvt_pk_bf16_f32 v62, v60, v61
  ds_write_b32 v158, v62
  s_branch cB_va0_t2d
cB_va0_rp:
  s_cmp_lg_u32 s37, 0
  s_cbranch_scc1 cB_va0_cont
cB_va0_rv:
  s_add_u32 s31, s31, 0x10000
  buffer_load_dwordx4 v[8:11], v2, s[8:11], s22 offen offset:0 sc1
  buffer_load_dwordx4 v[12:15], v2, s[8:11], s22 offen offset:1024 sc1
  buffer_load_dwordx4 v[16:19], v2, s[8:11], s22 offen offset:2048 sc1
  buffer_load_dwordx4 v[20:23], v2, s[8:11], s22 offen offset:3072 sc1
  buffer_load_dwordx4 v[24:27], v2, s[8:11], s34 offen offset:0 sc1
  buffer_load_dwordx4 v[28:31], v2, s[8:11], s34 offen offset:1024 sc1
  buffer_load_dwordx4 v[32:35], v2, s[8:11], s34 offen offset:2048 sc1
  buffer_load_dwordx4 v[36:39], v2, s[8:11], s34 offen offset:3072 sc1
  buffer_load_dwordx4 v[40:43], v2, s[8:11], s36 offen offset:0 sc1
  buffer_load_dwordx4 v[44:47], v2, s[8:11], s36 offen offset:1024 sc1
  s_waitcnt vmcnt(0)
  v_max3_u32 v52, v8, v9, v10
  v_max3_u32 v52, v52, v11, v12
  v_max3_u32 v52, v52, v13, v14
  v_max3_u32 v52, v52, v15, v16
  v_max3_u32 v52, v52, v17, v18
  v_max3_u32 v52, v52, v19, v20
  v_max3_u32 v52, v52, v21, v22
  v_max3_u32 v52, v52, v23, v24
  v_max3_u32 v52, v52, v25, v26
  v_max3_u32 v52, v52, v27, v28
  v_max3_u32 v52, v52, v29, v30
  v_max3_u32 v52, v52, v31, v32
  v_max3_u32 v52, v52, v33, v34
  v_max3_u32 v52, v52, v35, v36
  v_max3_u32 v52, v52, v37, v38
  v_max3_u32 v52, v52, v39, v40
  v_max3_u32 v52, v52, v41, v42
  v_max3_u32 v52, v52, v43, v44
  v_max3_u32 v52, v52, v45, v46
  v_max_u32 v52, v52, v47
  v_cmp_eq_u32 vcc, -1, v52
  s_mov_b32 s37, 1
  v_mov_b32 v48, 0
  v_mov_b32 v49, 0
  v_mov_b32 v50, 0
  v_mov_b32 v51, 0
  s_nop 1
  s_cbranch_vccz cB_va0_lp
  s_add_u32 s30, s30, 1
  s_cmp_lt_u32 s30, 400000
  s_cbranch_scc1 cB_va0_rv
  s_branch cB_abort
.p2align 6
cB_va1_loop:
  s_mov_b32 s30, 0
  s_barrier
  buffer_load_dwordx4 v[28:31], v2, s[8:11], s23 offen offset:1024 sc1
  buffer_load_dwordx4 v[32:35], v2, s[8:11], s23 offen offset:2048 sc1
  s_barrier
  buffer_store_dword v160, v1, s[8:11], s38 offen sc1
  s_add_u32 s22, s25, 0
  buffer_load_dwordx4 v[80:83], v6, s[8:11], s22 offen offset:0 sc1
  buffer_load_dwordx4 v[84:87], v6, s[8:11], s22 offen offset:1792 sc1
  s_add_u32 s22, s25, 3584
  buffer_load_dwordx4 v[88:91], v6, s[8:11], s22 offen offset:0 sc1
  buffer_load_dwordx4 v[92:95], v6, s[8:11], s22 offen offset:1792 sc1
  s_add_u32 s22, s25, 7168
  buffer_load_dwordx4 v[96:99], v6, s[8:11], s22 offen offset:0 sc1
  s_mul_i32 s38, s18, 7168
  s_add_u32 s38, s38, 88002560
  s_waitcnt vmcnt(6)
  ds_write_b128 v2, v[32:35] offset:14336
  v_smfmac_f32_16x16x64_bf16 v[36:39], v[28:31], a[40:47], v3
  buffer_load_dwordx4 v[100:103], v6, s[8:11], s22 offen offset:1792 sc1
  v_smfmac_f32_16x16x64_bf16 v[40:43], v[28:31], a[96:103], v3
  s_add_u32 s22, s25, 10752
  buffer_load_dwordx4 v[104:107], v6, s[8:11], s22 offen offset:0 sc1
  v_smfmac_f32_16x16x64_bf16 v[44:47], v[28:31], a[152:159], v3
  buffer_load_dwordx4 v[108:111], v6, s[8:11], s22 offen offset:1792 sc1
  v_smfmac_f32_16x16x64_bf16 v[48:51], v[28:31], a[208:215], v3
  s_add_u32 s22, s25, 14336
  buffer_load_dwordx4 v[112:115], v6, s[8:11], s22 offen offset:0 sc1
  v_smfmac_f32_16x16x64_bf16 v[52:55], v[28:31], v[184:191], v3
  s_waitcnt lgkmcnt(0)
  s_barrier
  ds_read_b128 v[8:11], v2 offset:8192
  ds_read_b128 v[12:15], v2 offset:9216
  ds_read_b128 v[16:19], v2 offset:10240
  ds_read_b128 v[20:23], v2 offset:11264
  ds_read_b128 v[24:27], v2 offset:12288
  buffer_load_dwordx4 v[116:119], v6, s[8:11], s22 offen offset:1792 sc1
  v_smfmac_f32_16x16x64_bf16 v[56:59], v[28:31], v[240:247], v3
  s_add_u32 s22, s25, 17920
  buffer_load_dwordx4 v[120:123], v6, s[8:11], s22 offen offset:0 sc1
  v_smfmac_f32_16x16x64_bf16 v[36:39], v[32:35], a[48:55], v3
  buffer_load_dwordx4 v[124:127], v6, s[8:11], s22 offen offset:1792 sc1
  v_smfmac_f32_16x16x64_bf16 v[40:43], v[32:35], a[104:111], v3
  s_add_u32 s22, s25, 21504
  buffer_load_dwordx4 v[128:131], v6, s[8:11], s22 offen offset:0 sc1
  v_smfmac_f32_16x16x64_bf16 v[44:47], v[32:35], a[160:167], v3
  buffer_load_dwordx4 v[132:135], v6, s[8:11], s22 offen offset:1792 sc1
  v_smfmac_f32_16x16x64_bf16 v[48:51], v[32:35], a[216:223], v3
  s_add_u32 s22, s25, 25088
  buffer_load_dwordx4 v[136:139], v6, s[8:11], s22 offen offset:0 sc1
  v_smfmac_f32_16x16x64_bf16 v[52:55], v[32:35], v[192:199], v3
  ds_read_b128 v[64:67], v0 offset:0
  ds_read_b128 v[68:71], v0 offset:1024
  buffer_load_dwordx4 v[140:143], v6, s[8:11], s22 offen offset:1792 sc1
  v_smfmac_f32_16x16x64_bf16 v[56:59], v[32:35], v[248:255], v3
  s_waitcnt lgkmcnt(6)
  ds_read_b128 v[72:75], v0 offset:2048
  ds_read_b128 v[76:79], v0 offset:3072
  v_smfmac_f32_16x16x64_bf16 v[36:39], v[8:11], a[0:7], v3
  s_waitcnt lgkmcnt(7)
  v_smfmac_f32_16x16x64_bf16 v[36:39], v[12:15], a[8:15], v3
  s_waitcnt lgkmcnt(6)
  v_smfmac_f32_16x16x64_bf16 v[36:39], v[16:19], a[16:23], v3
  s_waitcnt lgkmcnt(2)
  v_smfmac_f32_16x16x64_bf16 v[60:63], v[8:11], v[64:71], v3
  s_waitcnt lgkmcnt(5)
  ds_read_b128 v[144:147], v0 offset:4096
  ds_read_b128 v[148:151], v0 offset:5120
  v_smfmac_f32_16x16x64_bf16 v[36:39], v[20:23], a[24:31], v3
  s_waitcnt lgkmcnt(6)
  v_smfmac_f32_16x16x64_bf16 v[36:39], v[24:27], a[32:39], v3
  v_smfmac_f32_16x16x64_bf16 v[40:43], v[8:11], a[56:63], v3
  s_waitcnt lgkmcnt(2)
  v_smfmac_f32_16x16x64_bf16 v[60:63], v[12:15], v[72:79], v3
  ds_read_b128 v[64:67], v0 offset:6144
  ds_read_b128 v[68:71], v0 offset:7168
  v_smfmac_f32_16x16x64_bf16 v[40:43], v[12:15], a[64:71], v3
  v_permlane32_swap_b32 v36, v38
  v_smfmac_f32_16x16x64_bf16 v[40:43], v[16:19], a[72:79], v3
  v_permlane32_swap_b32 v37, v39
  v_smfmac_f32_16x16x64_bf16 v[40:43], v[20:23], a[80:87], v3
  s_waitcnt lgkmcnt(2)
  v_add_f32 v36, v36, v38
  v_smfmac_f32_16x16x64_bf16 v[60:63], v[16:19], v[144:151], v3
  ds_read_b128 v[72:75], v0 offset:8192
  ds_read_b128 v[76:79], v0 offset:9216
  v_add_f32 v37, v37, v39
  v_smfmac_f32_16x16x64_bf16 v[40:43], v[24:27], a[88:95], v3
  v_cmp_u_f32 vcc, v36, v37
  v_smfmac_f32_16x16x64_bf16 v[44:47], v[8:11], a[112:119], v3
  v_cvt_pk_bf16_f32 v38, v36, v37
  v_smfmac_f32_16x16x64_bf16 v[44:47], v[12:15], a[120:127], v3
  ds_write_b32 v152, v38
  s_waitcnt lgkmcnt(3)
  s_cbranch_vccnz cB_va1_slow
  v_permlane32_swap_b32 v40, v42
  v_smfmac_f32_16x16x64_bf16 v[60:63], v[20:23], v[64:71], v3
  ds_read_b128 v[144:147], v0 offset:10240
  ds_read_b128 v[148:151], v0 offset:11264
  v_permlane32_swap_b32 v41, v43
  v_smfmac_f32_16x16x64_bf16 v[44:47], v[16:19], a[128:135], v3
  buffer_store_dword v162, v1, s[8:11], s21 offen sc1
  v_add_f32 v40, v40, v42
  v_smfmac_f32_16x16x64_bf16 v[44:47], v[20:23], a[136:143], v3
  v_add_f32 v41, v41, v43
  v_smfmac_f32_16x16x64_bf16 v[44:47], v[24:27], a[144:151], v3
  s_waitcnt lgkmcnt(3)
  v_cvt_pk_bf16_f32 v42, v40, v41
  v_smfmac_f32_16x16x64_bf16 v[60:63], v[24:27], v[72:79], v3
  ds_write_b32 v153, v42
  ds_read_b128 v[64:67], v0 offset:12288
  ds_read_b128 v[68:71], v0 offset:13312
  v_smfmac_f32_16x16x64_bf16 v[48:51], v[8:11], a[168:175], v3
  s_nop 0
  v_permlane32_swap_b32 v44, v46
  v_smfmac_f32_16x16x64_bf16 v[48:51], v[12:15], a[176:183], v3
  v_permlane32_swap_b32 v45, v47
  v_smfmac_f32_16x16x64_bf16 v[48:51], v[16:19], a[184:191], v3
  s_waitcnt lgkmcnt(3)
  v_add_f32 v44, v44, v46
  v_smfmac_f32_16x16x64_bf16 v[60:63], v[28:31], v[144:151], v3
  v_add_f32 v45, v45, v47
  v_smfmac_f32_16x16x64_bf16 v[48:51], v[20:23], a[192:199], v3
  v_cvt_pk_bf16_f32 v46, v44, v45
  v_smfmac_f32_16x16x64_bf16 v[48:51], v[24:27], a[200:207], v3
  ds_write_b32 v154, v46
  v_smfmac_f32_16x16x64_bf16 v[52:55], v[8:11], a[224:231], v3
  s_waitcnt lgkmcnt(1)
  v_smfmac_f32_16x16x64_bf16 v[60:63], v[32:35], v[64:71], v3
  v_smfmac_f32_16x16x64_bf16 v[52:55], v[12:15], a[232:239], v3
  v_permlane32_swap_b32 v48, v50
  v_smfmac_f32_16x16x64_bf16 v[52:55], v[16:19], a[240:247], v3
  v_permlane32_swap_b32 v49, v51
  v_smfmac_f32_16x16x64_bf16 v[52:55], v[20:23], a[248:255], v3
  v_add_f32 v48, v48, v50
  v_smfmac_f32_16x16x64_bf16 v[52:55], v[24:27], v[176:183], v3
  v_add_f32 v49, v49, v51
  v_smfmac_f32_16x16x64_bf16 v[56:59], v[8:11], v[200:207], v3
  v_cvt_pk_bf16_f32 v50, v48, v49
  v_smfmac_f32_16x16x64_bf16 v[56:59], v[12:15], v[208:215], v3
  ds_write_b32 v155, v50
  v_permlane32_swap_b32 v60, v62
  v_smfmac_f32_16x16x64_bf16 v[56:59], v[16:19], v[216:223], v3
  v_permlane32_swap_b32 v61, v63
  v_smfmac_f32_16x16x64_bf16 v[56:59], v[20:23], v[224:231], v3
  v_add_f32 v60, v60, v62
  v_smfmac_f32_16x16x64_bf16 v[56:59], v[24:27], v[232:239], v3
  v_add_f32 v61, v61, v63
  v_cvt_pk_bf16_f32 v62, v60, v61
  ds_write_b32 v158, v62
  v_permlane32_swap_b32 v52, v54
  v_permlane32_swap_b32 v53, v55
  v_add_f32 v52, v52, v54
  v_add_f32 v53, v53, v55
  v_cvt_pk_bf16_f32 v54, v52, v53
  ds_write_b32 v156, v54
  v_permlane32_swap_b32 v56, v58
  v_permlane32_swap_b32 v57, v59
  v_add_f32 v56, v56, v58
  v_add_f32 v57, v57, v59
  v_cvt_pk_bf16_f32 v58, v56, v57
  ds_write_b32 v157, v58
cB_va1_t2d:
  s_add_u32 s22, s20, 9216
  s_add_u32 s34, s20, 13312
  s_add_u32 s36, s20, 7168
  s_mov_b32 s37, 0
  v_mov_b32 v48, 0
  v_mov_b32 v49, 0
  v_mov_b32 v50, 0
  v_mov_b32 v51, 0
  v_mov_b32 v163, s18
  s_waitcnt lgkmcnt(0)
  s_barrier
  buffer_load_dwordx4 v[8:11], v2, s[8:11], s22 offen offset:0 sc1
  buffer_load_dwordx4 v[12:15], v2, s[8:11], s22 offen offset:1024 sc1
  buffer_load_dwordx4 v[16:19], v2, s[8:11], s22 offen offset:2048 sc1
  buffer_load_dwordx4 v[20:23], v2, s[8:11], s22 offen offset:3072 sc1
  buffer_load_dwordx4 v[24:27], v2, s[8:11], s34 offen offset:0 sc1
  buffer_load_dwordx4 v[28:31], v2, s[8:11], s34 offen offset:1024 sc1
  buffer_load_dwordx4 v[32:35], v2, s[8:11], s34 offen offset:2048 sc1
  buffer_load_dwordx4 v[36:39], v2, s[8:11], s34 offen offset:3072 sc1
  buffer_load_dwordx4 v[40:43], v2, s[8:11], s36 offen offset:0 sc1
  buffer_load_dwordx4 v[44:47], v2, s[8:11], s36 offen offset:1024 sc1
  ds_read_b128 v[64:67], v2 offset:4096
  ds_read_b128 v[68:71], v2 offset:5120
  ds_read_b128 v[72:75], v2 offset:6144
  ds_read_b128 v[76:79], v2 offset:7168
cB_va1_lp:
  s_waitcnt vmcnt(9)
  v_smfmac_f32_16x16x64_bf16 v[48:51], v[8:11], v[80:87], v3
  s_waitcnt vmcnt(8)
  v_smfmac_f32_16x16x64_bf16 v[48:51], v[12:15], v[88:95], v3
  s_waitcnt vmcnt(7)
  v_smfmac_f32_16x16x64_bf16 v[48:51], v[16:19], v[96:103], v3
  v_max3_u32 v55, v8, v12, v16
  s_waitcnt vmcnt(6)
  v_smfmac_f32_16x16x64_bf16 v[48:51], v[20:23], v[104:111], v3
  v_max_u32 v55, v55, v20
  v_cmp_eq_u32 vcc, -1, v55
  s_waitcnt vmcnt(5)
  v_smfmac_f32_16x16x64_bf16 v[48:51], v[24:27], v[112:119], v3
  s_waitcnt vmcnt(4)
  v_smfmac_f32_16x16x64_bf16 v[48:51], v[28:31], v[120:127], v3
  s_cbranch_vccnz cB_va1_rv
  buffer_store_dword v163, v7, s[8:11], 0 offen sc1
  s_waitcnt vmcnt(4)
  v_smfmac_f32_16x16x64_bf16 v[48:51], v[32:35], v[128:135], v3
  s_waitcnt vmcnt(3)
  v_smfmac_f32_16x16x64_bf16 v[48:51], v[36:39], v[136:143], v3
  s_waitcnt vmcnt(2) lgkmcnt(0)
  v_smfmac_f32_16x16x64_bf16 v[48:51], v[40:43], v[64:71], v3
  s_waitcnt vmcnt(1)
  v_smfmac_f32_16x16x64_bf16 v[48:51], v[44:47], v[72:79], v3
  s_nop 7
  v_permlane32_swap_b32 v48, v50
  v_permlane32_swap_b32 v49, v51
  v_add_f32 v48, v48, v50
  v_add_f32 v49, v49, v51
  v_cvt_pk_bf16_f32 v160, v48, v49
  v_cmp_u_f32 vcc, v48, v49
  s_nop 0
  v_mov_b32_dpp v161, v160 quad_perm:[1,0,3,2] row_mask:0xf bank_mask:0xf
  v_perm_b32 v160, v161, v160, v5
  v_min_u32 v160, -2, v160
  s_cbranch_vccnz cB_va1_rp
cB_va1_cont:
  buffer_store_dword v160, v1, s[8:11], s21 offen sc1
  s_cmp_lg_u32 s19, 62
  s_cbranch_scc1 cB_va1_nl
  buffer_store_dword v160, v1, s[8:11], s38 offen sc1
  s_waitcnt vmcnt(0)
  buffer_wbl2 sc1
  s_branch cB_done
cB_va1_nl:
  s_add_u32 s25, s25, 458752
  v_mov_b32 v36, 0
  v_mov_b32 v37, 0
  v_mov_b32 v38, 0
  v_mov_b32 v39, 0
  v_mov_b32 v40, 0
  v_mov_b32 v41, 0
  v_mov_b32 v42, 0
  v_mov_b32 v43, 0
  v_mov_b32 v44, 0
  v_mov_b32 v45, 0
  v_mov_b32 v46, 0
  v_mov_b32 v47, 0
  v_mov_b32 v48, 0
  v_mov_b32 v49, 0
  v_mov_b32 v50, 0
  v_mov_b32 v51, 0
  v_mov_b32 v52, 0
  v_mov_b32 v53, 0
  v_mov_b32 v54, 0
  v_mov_b32 v55, 0
  v_mov_b32 v56, 0
  v_mov_b32 v57, 0
  v_mov_b32 v58, 0
  v_mov_b32 v59, 0
  v_mov_b32 v60, 0
  v_mov_b32 v61, 0
  v_mov_b32 v62, 0
  v_mov_b32 v63, 0
  s_mov_b32 s19, s18
  s_add_u32 s18, s18, 1
  s_mov_b32 s22, s20
  s_mov_b32 s20, s21
  s_mov_b32 s21, s22
  s_add_u32 s23, s20, 4096
  s_branch cB_va1_loop
cB_va1_slow:
  s_waitcnt lgkmcnt(0)
cB_va1_sl1:
  s_add_u32 s31, s31, 0x1000000
  buffer_load_dwordx4 v[8:11], v2, s[8:11], s20 offen offset:0 sc1
  buffer_load_dwordx4 v[12:15], v2, s[8:11], s20 offen offset:1024 sc1
  buffer_load_dwordx4 v[16:19], v2, s[8:11], s20 offen offset:2048 sc1
  buffer_load_dwordx4 v[20:23], v2, s[8:11], s20 offen offset:3072 sc1
  buffer_load_dwordx4 v[24:27], v2, s[8:11], s23 offen offset:0 sc1
  buffer_load_dwordx4 v[28:31], v2, s[8:11], s23 offen offset:1024 sc1
  buffer_load_dwordx4 v[32:35], v2, s[8:11], s23 offen offset:2048 sc1
  s_waitcnt vmcnt(0)
  v_max3_u32 v36, v8, v9, v10
  v_max3_u32 v36, v36, v11, v12
  v_max3_u32 v36, v36, v13, v14
  v_max3_u32 v36, v36, v15, v16
  v_max3_u32 v36, v36, v17, v18
  v_max3_u32 v36, v36, v19, v20
  v_max3_u32 v36, v36, v21, v22
  v_max3_u32 v36, v36, v23, v24
  v_max3_u32 v36, v36, v25, v26
  v_max3_u32 v36, v36, v27, v28
  v_max3_u32 v36, v36, v29, v30
  v_max3_u32 v36, v36, v31, v32
  v_max3_u32 v36, v36, v33, v34
  v_max_u32 v36, v36, v35
  v_cmp_eq_u32 vcc, -1, v36
  s_cbranch_vccz cB_va1_sl2
  s_add_u32 s30, s30, 1
  s_cmp_lt_u32 s30, 400000
  s_cbranch_scc1 cB_va1_sl1
  s_branch cB_abort
cB_va1_sl2:
  v_mov_b32 v36, 0
  v_mov_b32 v37, 0
  v_mov_b32 v38, 0
  v_mov_b32 v39, 0
  v_mov_b32 v40, 0
  v_mov_b32 v41, 0
  v_mov_b32 v42, 0
  v_mov_b32 v43, 0
  v_mov_b32 v44, 0
  v_mov_b32 v45, 0
  v_mov_b32 v46, 0
  v_mov_b32 v47, 0
  v_mov_b32 v48, 0
  v_mov_b32 v49, 0
  v_mov_b32 v50, 0
  v_mov_b32 v51, 0
  v_mov_b32 v52, 0
  v_mov_b32 v53, 0
  v_mov_b32 v54, 0
  v_mov_b32 v55, 0
  v_mov_b32 v56, 0
  v_mov_b32 v57, 0
  v_mov_b32 v58, 0
  v_mov_b32 v59, 0
  v_mov_b32 v60, 0
  v_mov_b32 v61, 0
  v_mov_b32 v62, 0
  v_mov_b32 v63, 0
  buffer_store_dword v162, v1, s[8:11], s21 offen sc1
  ds_read_b128 v[64:67], v0 offset:0
  ds_read_b128 v[68:71], v0 offset:1024
  v_smfmac_f32_16x16x64_bf16 v[36:39], v[8:11], a[0:7], v3
  v_smfmac_f32_16x16x64_bf16 v[40:43], v[8:11], a[56:63], v3
  v_smfmac_f32_16x16x64_bf16 v[44:47], v[8:11], a[112:119], v3
  v_smfmac_f32_16x16x64_bf16 v[48:51], v[8:11], a[168:175], v3
  v_smfmac_f32_16x16x64_bf16 v[52:55], v[8:11], a[224:231], v3
  v_smfmac_f32_16x16x64_bf16 v[56:59], v[8:11], v[200:207], v3
  s_waitcnt lgkmcnt(0)
  v_smfmac_f32_16x16x64_bf16 v[60:63], v[8:11], v[64:71], v3
  ds_read_b128 v[72:75], v0 offset:2048
  ds_read_b128 v[76:79], v0 offset:3072
  v_smfmac_f32_16x16x64_bf16 v[36:39], v[12:15], a[8:15], v3
  v_smfmac_f32_16x16x64_bf16 v[40:43], v[12:15], a[64:71], v3
  v_smfmac_f32_16x16x64_bf16 v[44:47], v[12:15], a[120:127], v3
  v_smfmac_f32_16x16x64_bf16 v[48:51], v[12:15], a[176:183], v3
  v_smfmac_f32_16x16x64_bf16 v[52:55], v[12:15], a[232:239], v3
  v_smfmac_f32_16x16x64_bf16 v[56:59], v[12:15], v[208:215], v3
  s_waitcnt lgkmcnt(0)
  v_smfmac_f32_16x16x64_bf16 v[60:63], v[12:15], v[72:79], v3
  ds_read_b128 v[144:147], v0 offset:4096
  ds_read_b128 v[148:151], v0 offset:5120
  v_smfmac_f32_16x16x64_bf16 v[36:39], v[16:19], a[16:23], v3
  v_smfmac_f32_16x16x64_bf16 v[40:43], v[16:19], a[72:79], v3
  v_smfmac_f32_16x16x64_bf16 v[44:47], v[16:19], a[128:135], v3
  v_smfmac_f32_16x16x64_bf16 v[48:51], v[16:19], a[184:191], v3
  v_smfmac_f32_16x16x64_bf16 v[52:55], v[16:19], a[240:247], v3
  v_smfmac_f32_16x16x64_bf16 v[56:59], v[16:19], v[216:223], v3
  s_waitcnt lgkmcnt(0)
  v_smfmac_f32_16x16x64_bf16 v[60:63], v[16:19], v[144:151], v3
  ds_read_b128 v[64:67], v0 offset:6144
  ds_read_b128 v[68:71], v0 offset:7168
  v_smfmac_f32_16x16x64_bf16 v[36:39], v[20:23], a[24:31], v3
  v_smfmac_f32_16x16x64_bf16 v[40:43], v[20:23], a[80:87], v3
  v_smfmac_f32_16x16x64_bf16 v[44:47], v[20:23], a[136:143], v3
  v_smfmac_f32_16x16x64_bf16 v[48:51], v[20:23], a[192:199], v3
  v_smfmac_f32_16x16x64_bf16 v[52:55], v[20:23], a[248:255], v3
  v_smfmac_f32_16x16x64_bf16 v[56:59], v[20:23], v[224:231], v3
  s_waitcnt lgkmcnt(0)
  v_smfmac_f32_16x16x64_bf16 v[60:63], v[20:23], v[64:71], v3
  ds_read_b128 v[72:75], v0 offset:8192
  ds_read_b128 v[76:79], v0 offset:9216
  v_smfmac_f32_16x16x64_bf16 v[36:39], v[24:27], a[32:39], v3
  v_smfmac_f32_16x16x64_bf16 v[40:43], v[24:27], a[88:95], v3
  v_smfmac_f32_16x16x64_bf16 v[44:47], v[24:27], a[144:151], v3
  v_smfmac_f32_16x16x64_bf16 v[48:51], v[24:27], a[200:207], v3
  v_smfmac_f32_16x16x64_bf16 v[52:55], v[24:27], v[176:183], v3
  v_smfmac_f32_16x16x64_bf16 v[56:59], v[24:27], v[232:239], v3
  s_waitcnt lgkmcnt(0)
  v_smfmac_f32_16x16x64_bf16 v[60:63], v[24:27], v[72:79], v3
  ds_read_b128 v[144:147], v0 offset:10240
  ds_read_b128 v[148:151], v0 offset:11264
  v_smfmac_f32_16x16x64_bf16 v[36:39], v[28:31], a[40:47], v3
  v_smfmac_f32_16x16x64_bf16 v[40:43], v[28:31], a[96:103], v3
  v_smfmac_f32_16x16x64_bf16 v[44:47], v[28:31], a[152:159], v3
  v_smfmac_f32_16x16x64_bf16 v[48:51], v[28:31], a[208:215], v3
  v_smfmac_f32_16x16x64_bf16 v[52:55], v[28:31], v[184:191], v3
  v_smfmac_f32_16x16x64_bf16 v[56:59], v[28:31], v[240:247], v3
  s_waitcnt lgkmcnt(0)
  v_smfmac_f32_16x16x64_bf16 v[60:63], v[28:31], v[144:151], v3
  ds_read_b128 v[64:67], v0 offset:12288
  ds_read_b128 v[68:71], v0 offset:13312
  v_smfmac_f32_16x16x64_bf16 v[36:39], v[32:35], a[48:55], v3
  v_smfmac_f32_16x16x64_bf16 v[40:43], v[32:35], a[104:111], v3
  v_smfmac_f32_16x16x64_bf16 v[44:47], v[32:35], a[160:167], v3
  v_smfmac_f32_16x16x64_bf16 v[48:51], v[32:35], a[216:223], v3
  v_smfmac_f32_16x16x64_bf16 v[52:55], v[32:35], v[192:199], v3
  v_smfmac_f32_16x16x64_bf16 v[56:59], v[32:35], v[248:255], v3
  s_waitcnt lgkmcnt(0)
  v_smfmac_f32_16x16x64_bf16 v[60:63], v[32:35], v[64:71], v3
  v_permlane32_swap_b32 v36, v38
  v_permlane32_swap_b32 v37, v39
  v_add_f32 v36, v36, v38
  v_add_f32 v37, v37, v39
  v_cvt_pk_bf16_f32 v38, v36, v37
  ds_write_b32 v152, v38
  v_permlane32_swap_b32 v40, v42
  v_permlane32_swap_b32 v41, v43
  v_add_f32 v40, v40, v42
  v_add_f32 v41, v41, v43
  v_cvt_pk_bf16_f32 v42, v40, v41
  ds_write_b32 v153, v42
  v_permlane32_swap_b32 v44, v46
  v_permlane32_swap_b32 v45, v47
  v_add_f32 v44, v44, v46
  v_add_f32 v45, v45, v47
  v_cvt_pk_bf16_f32 v46, v44, v45
  ds_write_b32 v154, v46
  v_permlane32_swap_b32 v48, v50
  v_permlane32_swap_b32 v49, v51
  v_add_f32 v48, v48, v50
  v_add_f32 v49, v49, v51
  v_cvt_pk_bf16_f32 v50, v48, v49
  ds_write_b32 v155, v50
  v_permlane32_swap_b32 v52, v54
  v_permlane32_swap_b32 v53, v55
  v_add_f32 v52, v52, v54
  v_add_f32 v53, v53, v55
  v_cvt_pk_bf16_f32 v54, v52, v53
  ds_write_b32 v156, v54
  v_permlane32_swap_b32 v56, v58
  v_permlane32_swap_b32 v57, v59
  v_add_f32 v56, v56, v58
  v_add_f32 v57, v57, v59
  v_cvt_pk_bf16_f32 v58, v56, v57
  ds_write_b32 v157, v58
  v_permlane32_swap_b32 v60, v62
  v_permlane32_swap_b32 v61, v63
  v_add_f32 v60, v60, v62
  v_add_f32 v61, v61, v63
  v_cvt_pk_bf16_f32 v62, v60, v61
  ds_write_b32 v158, v62
  s_branch cB_va1_t2d
cB_va1_rp:
  s_cmp_lg_u32 s37, 0
  s_cbranch_scc1 cB_va1_cont
cB_va1_rv:
  s_add_u32 s31, s31, 0x10000
  buffer_load_dwordx4 v[8:11], v2, s[8:11], s22 offen offset:0 sc1
  buffer_load_dwordx4 v[12:15], v2, s[8:11], s22 offen offset:1024 sc1
  buffer_load_dwordx4 v[16:19], v2, s[8:11], s22 offen offset:2048 sc1
  buffer_load_dwordx4 v[20:23], v2, s[8:11], s22 offen offset:3072 sc1
  buffer_load_dwordx4 v[24:27], v2, s[8:11], s34 offen offset:0 sc1
  buffer_load_dwordx4 v[28:31], v2, s[8:11], s34 offen offset:1024 sc1
  buffer_load_dwordx4 v[32:35], v2, s[8:11], s34 offen offset:2048 sc1
  buffer_load_dwordx4 v[36:39], v2, s[8:11], s34 offen offset:3072 sc1
  buffer_load_dwordx4 v[40:43], v2, s[8:11], s36 offen offset:0 sc1
  buffer_load_dwordx4 v[44:47], v2, s[8:11], s36 offen offset:1024 sc1
  s_waitcnt vmcnt(0)
  v_max3_u32 v52, v8, v9, v10
  v_max3_u32 v52, v52, v11, v12
  v_max3_u32 v52, v52, v13, v14
  v_max3_u32 v52, v52, v15, v16
  v_max3_u32 v52, v52, v17, v18
  v_max3_u32 v52, v52, v19, v20
  v_max3_u32 v52, v52, v21, v22
  v_max3_u32 v52, v52, v23, v24
  v_max3_u32 v52, v52, v25, v26
  v_max3_u32 v52, v52, v27, v28
  v_max3_u32 v52, v52, v29, v30
  v_max3_u32 v52, v52, v31, v32
  v_max3_u32 v52, v52, v33, v34
  v_max3_u32 v52, v52, v35, v36
  v_max3_u32 v52, v52, v37, v38
  v_max3_u32 v52, v52, v39, v40
  v_max3_u32 v52, v52, v41, v42
  v_max3_u32 v52, v52, v43, v44
  v_max3_u32 v52, v52, v45, v46
  v_max_u32 v52, v52, v47
  v_cmp_eq_u32 vcc, -1, v52
  s_mov_b32 s37, 1
  v_mov_b32 v48, 0
  v_mov_b32 v49, 0
  v_mov_b32 v50, 0
  v_mov_b32 v51, 0
  s_nop 1
  s_cbranch_vccz cB_va1_lp
  s_add_u32 s30, s30, 1
  s_cmp_lt_u32 s30, 400000
  s_cbranch_scc1 cB_va1_rv
  s_branch cB_abort
.p2align 6
cB_va2_loop:
  s_mov_b32 s30, 0
  buffer_load_dword v100, v119, s[8:11], 0 offen sc1
  buffer_load_dword v101, v119, s[8:11], 0 offen sc1
  buffer_load_dword v102, v119, s[8:11], 0 offen sc1
  buffer_load_dword v103, v119, s[8:11], 0 offen sc1
cB_va2_fp_l:
  s_waitcnt vmcnt(3)
  v_cmp_gt_u32 vcc, s19, v100
  s_cbranch_vccz cB_va2_fp_d
  buffer_load_dword v100, v119, s[8:11], 0 offen sc1
  s_waitcnt vmcnt(3)
  v_cmp_gt_u32 vcc, s19, v101
  s_cbranch_vccz cB_va2_fp_d
  buffer_load_dword v101, v119, s[8:11], 0 offen sc1
  s_waitcnt vmcnt(3)
  v_cmp_gt_u32 vcc, s19, v102
  s_cbranch_vccz cB_va2_fp_d
  buffer_load_dword v102, v119, s[8:11], 0 offen sc1
  s_waitcnt vmcnt(3)
  v_cmp_gt_u32 vcc, s19, v103
  s_cbranch_vccz cB_va2_fp_d
  buffer_load_dword v103, v119, s[8:11], 0 offen sc1
  s_add_u32 s30, s30, 1
  s_cmp_lt_u32 s30, 400000
  s_cbranch_scc1 cB_va2_fp_l
  s_branch cB_abort
cB_va2_fp_d:
  buffer_load_dwordx4 v[8:11], v2, s[8:11], s20 offen offset:0 sc1
  buffer_load_dwordx4 v[12:15], v2, s[8:11], s20 offen offset:1024 sc1
  s_barrier
  s_barrier
  s_waitcnt vmcnt(0)
  ds_write_b128 v2, v[8:11] offset:8192
  ds_write_b128 v2, v[12:15] offset:9216
  v_smfmac_f32_16x16x64_bf16 v[36:39], v[8:11], a[0:7], v3
  v_smfmac_f32_16x16x64_bf16 v[40:43], v[8:11], a[56:63], v3
  v_smfmac_f32_16x16x64_bf16 v[44:47], v[8:11], a[112:119], v3
  v_smfmac_f32_16x16x64_bf16 v[48:51], v[8:11], a[168:175], v3
  v_smfmac_f32_16x16x64_bf16 v[52:55], v[8:11], a[224:231], v3
  s_waitcnt lgkmcnt(0)
  s_barrier
  ds_read_b128 v[16:19], v2 offset:10240
  ds_read_b128 v[20:23], v2 offset:11264
  ds_read_b128 v[24:27], v2 offset:12288
  ds_read_b128 v[28:31], v2 offset:13312
  ds_read_b128 v[32:35], v2 offset:14336
  v_smfmac_f32_16x16x64_bf16 v[56:59], v[8:11], v[144:151], v3
  v_smfmac_f32_16x16x64_bf16 v[60:63], v[8:11], v[200:207], v3
  v_smfmac_f32_16x16x64_bf16 v[36:39], v[12:15], a[8:15], v3
  v_smfmac_f32_16x16x64_bf16 v[40:43], v[12:15], a[64:71], v3
  v_smfmac_f32_16x16x64_bf16 v[44:47], v[12:15], a[120:127], v3
  v_smfmac_f32_16x16x64_bf16 v[48:51], v[12:15], a[176:183], v3
  v_smfmac_f32_16x16x64_bf16 v[52:55], v[12:15], a[232:239], v3
  v_smfmac_f32_16x16x64_bf16 v[56:59], v[12:15], v[152:159], v3
  v_smfmac_f32_16x16x64_bf16 v[60:63], v[12:15], v[208:215], v3
  s_waitcnt lgkmcnt(4)
  v_smfmac_f32_16x16x64_bf16 v[36:39], v[16:19], a[16:23], v3
  s_waitcnt lgkmcnt(3)
  v_smfmac_f32_16x16x64_bf16 v[36:39], v[20:23], a[24:31], v3
  s_waitcnt lgkmcnt(2)
  v_smfmac_f32_16x16x64_bf16 v[36:39], v[24:27], a[32:39], v3
  s_waitcnt lgkmcnt(1)
  v_smfmac_f32_16x16x64_bf16 v[36:39], v[28:31], a[40:47], v3
  s_waitcnt lgkmcnt(0)
  v_smfmac_f32_16x16x64_bf16 v[36:39], v[32:35], a[48:55], v3
  v_smfmac_f32_16x16x64_bf16 v[40:43], v[16:19], a[72:79], v3
  v_smfmac_f32_16x16x64_bf16 v[40:43], v[20:23], a[80:87], v3
  v_smfmac_f32_16x16x64_bf16 v[40:43], v[24:27], a[88:95], v3
  v_permlane32_swap_b32 v36, v38
  v_smfmac_f32_16x16x64_bf16 v[40:43], v[28:31], a[96:103], v3
  v_permlane32_swap_b32 v37, v39
  v_smfmac_f32_16x16x64_bf16 v[40:43], v[32:35], a[104:111], v3
  v_add_f32 v36, v36, v38
  v_smfmac_f32_16x16x64_bf16 v[44:47], v[16:19], a[128:135], v3
  v_add_f32 v37, v37, v39
  v_smfmac_f32_16x16x64_bf16 v[44:47], v[20:23], a[136:143], v3
  v_cmp_u_f32 vcc, v36, v37
  v_smfmac_f32_16x16x64_bf16 v[44:47], v[24:27], a[144:151], v3
  v_cvt_pk_bf16_f32 v38, v36, v37
  v_smfmac_f32_16x16x64_bf16 v[44:47], v[28:31], a[152:159], v3
  ds_write_b32 v104, v38
  s_cbranch_vccnz cB_va2_slow
  v_permlane32_swap_b32 v40, v42
  v_smfmac_f32_16x16x64_bf16 v[44:47], v[32:35], a[160:167], v3
  v_permlane32_swap_b32 v41, v43
  v_smfmac_f32_16x16x64_bf16 v[48:51], v[16:19], a[184:191], v3
  v_add_f32 v40, v40, v42
  v_smfmac_f32_16x16x64_bf16 v[48:51], v[20:23], a[192:199], v3
  v_add_f32 v41, v41, v43
  v_smfmac_f32_16x16x64_bf16 v[48:51], v[24:27], a[200:207], v3
  v_cvt_pk_bf16_f32 v42, v40, v41
  v_smfmac_f32_16x16x64_bf16 v[48:51], v[28:31], a[208:215], v3
  ds_write_b32 v105, v42
  v_permlane32_swap_b32 v44, v46
  v_smfmac_f32_16x16x64_bf16 v[48:51], v[32:35], a[216:223], v3
  v_permlane32_swap_b32 v45, v47
  v_smfmac_f32_16x16x64_bf16 v[52:55], v[16:19], a[240:247], v3
  v_add_f32 v44, v44, v46
  v_smfmac_f32_16x16x64_bf16 v[52:55], v[20:23], a[248:255], v3
  v_add_f32 v45, v45, v47
  v_smfmac_f32_16x16x64_bf16 v[52:55], v[24:27], v[120:127], v3
  v_cvt_pk_bf16_f32 v46, v44, v45
  v_smfmac_f32_16x16x64_bf16 v[52:55], v[28:31], v[128:135], v3
  ds_write_b32 v106, v46
  v_permlane32_swap_b32 v48, v50
  v_smfmac_f32_16x16x64_bf16 v[52:55], v[32:35], v[136:143], v3
  v_permlane32_swap_b32 v49, v51
  v_smfmac_f32_16x16x64_bf16 v[56:59], v[16:19], v[160:167], v3
  v_add_f32 v48, v48, v50
  v_smfmac_f32_16x16x64_bf16 v[56:59], v[20:23], v[168:175], v3
  v_add_f32 v49, v49, v51
  v_smfmac_f32_16x16x64_bf16 v[56:59], v[24:27], v[176:183], v3
  v_cvt_pk_bf16_f32 v50, v48, v49
  v_smfmac_f32_16x16x64_bf16 v[56:59], v[28:31], v[184:191], v3
  ds_write_b32 v107, v50
  v_permlane32_swap_b32 v52, v54
  v_smfmac_f32_16x16x64_bf16 v[56:59], v[32:35], v[192:199], v3
  v_permlane32_swap_b32 v53, v55
  v_smfmac_f32_16x16x64_bf16 v[60:63], v[16:19], v[216:223], v3
  v_add_f32 v52, v52, v54
  v_smfmac_f32_16x16x64_bf16 v[60:63], v[20:23], v[224:231], v3
  v_add_f32 v53, v53, v55
  v_smfmac_f32_16x16x64_bf16 v[60:63], v[24:27], v[232:239], v3
  v_cvt_pk_bf16_f32 v54, v52, v53
  v_smfmac_f32_16x16x64_bf16 v[60:63], v[28:31], v[240:247], v3
  ds_write_b32 v108, v54
  v_permlane32_swap_b32 v56, v58
  v_smfmac_f32_16x16x64_bf16 v[60:63], v[32:35], v[248:255], v3
  v_permlane32_swap_b32 v57, v59
  v_add_f32 v56, v56, v58
  v_add_f32 v57, v57, v59
  v_cvt_pk_bf16_f32 v58, v56, v57
  ds_write_b32 v109, v58
  s_nop 2
  v_permlane32_swap_b32 v60, v62
  v_permlane32_swap_b32 v61, v63
  v_add_f32 v60, v60, v62
  v_add_f32 v61, v61, v63
  v_cvt_pk_bf16_f32 v62, v60, v61
  ds_write_b32 v110, v62
cB_va2_t2d:
  v_mov_b32 v117, s18
  s_waitcnt lgkmcnt(0)
  s_barrier
  s_cmp_eq_u32 s19, 62
  s_cbranch_scc1 cB_done
  s_sleep 1
  v_mov_b32 v36, 0
  v_mov_b32 v37, 0
  v_mov_b32 v38, 0
  v_mov_b32 v39, 0
  v_mov_b32 v40, 0
  v_mov_b32 v41, 0
  v_mov_b32 v42, 0
  v_mov_b32 v43, 0
  v_mov_b32 v44, 0
  v_mov_b32 v45, 0
  v_mov_b32 v46, 0
  v_mov_b32 v47, 0
  v_mov_b32 v48, 0
  v_mov_b32 v49, 0
  v_mov_b32 v50, 0
  v_mov_b32 v51, 0
  v_mov_b32 v52, 0
  v_mov_b32 v53, 0
  v_mov_b32 v54, 0
  v_mov_b32 v55, 0
  v_mov_b32 v56, 0
  v_mov_b32 v57, 0
  v_mov_b32 v58, 0
  v_mov_b32 v59, 0
  v_mov_b32 v60, 0
  v_mov_b32 v61, 0
  v_mov_b32 v62, 0
  v_mov_b32 v63, 0
  s_sleep 3
  s_mov_b32 s19, s18
  s_add_u32 s18, s18, 1
  s_mov_b32 s22, s20
  s_mov_b32 s20, s21
  s_mov_b32 s21, s22
  s_add_u32 s23, s20, 4096
  s_branch cB_va2_loop
cB_va2_slow:
  s_waitcnt lgkmcnt(0)
cB_va2_sl1:
  s_add_u32 s31, s31, 0x1000000
  buffer_load_dwordx4 v[8:11], v2, s[8:11], s20 offen offset:0 sc1
  buffer_load_dwordx4 v[12:15], v2, s[8:11], s20 offen offset:1024 sc1
  buffer_load_dwordx4 v[16:19], v2, s[8:11], s20 offen offset:2048 sc1
  buffer_load_dwordx4 v[20:23], v2, s[8:11], s20 offen offset:3072 sc1
  buffer_load_dwordx4 v[24:27], v2, s[8:11], s23 offen offset:0 sc1
  buffer_load_dwordx4 v[28:31], v2, s[8:11], s23 offen offset:1024 sc1
  buffer_load_dwordx4 v[32:35], v2, s[8:11], s23 offen offset:2048 sc1
  s_waitcnt vmcnt(0)
  v_max3_u32 v36, v8, v9, v10
  v_max3_u32 v36, v36, v11, v12
  v_max3_u32 v36, v36, v13, v14
  v_max3_u32 v36, v36, v15, v16
  v_max3_u32 v36, v36, v17, v18
  v_max3_u32 v36, v36, v19, v20
  v_max3_u32 v36, v36, v21, v22
  v_max3_u32 v36, v36, v23, v24
  v_max3_u32 v36, v36, v25, v26
  v_max3_u32 v36, v36, v27, v28
  v_max3_u32 v36, v36, v29, v30
  v_max3_u32 v36, v36, v31, v32
  v_max3_u32 v36, v36, v33, v34
  v_max_u32 v36, v36, v35
  v_cmp_eq_u32 vcc, -1, v36
  s_cbranch_vccz cB_va2_sl2
  s_add_u32 s30, s30, 1
  s_cmp_lt_u32 s30, 400000
  s_cbranch_scc1 cB_va2_sl1
  s_branch cB_abort
cB_va2_sl2:
  v_mov_b32 v36, 0
  v_mov_b32 v37, 0
  v_mov_b32 v38, 0
  v_mov_b32 v39, 0
  v_mov_b32 v40, 0
  v_mov_b32 v41, 0
  v_mov_b32 v42, 0
  v_mov_b32 v43, 0
  v_mov_b32 v44, 0
  v_mov_b32 v45, 0
  v_mov_b32 v46, 0
  v_mov_b32 v47, 0
  v_mov_b32 v48, 0
  v_mov_b32 v49, 0
  v_mov_b32 v50, 0
  v_mov_b32 v51, 0
  v_mov_b32 v52, 0
  v_mov_b32 v53, 0
  v_mov_b32 v54, 0
  v_mov_b32 v55, 0
  v_mov_b32 v56, 0
  v_mov_b32 v57, 0
  v_mov_b32 v58, 0
  v_mov_b32 v59, 0
  v_mov_b32 v60, 0
  v_mov_b32 v61, 0
  v_mov_b32 v62, 0
  v_mov_b32 v63, 0
  v_smfmac_f32_16x16x64_bf16 v[36:39], v[8:11], a[0:7], v3
  v_smfmac_f32_16x16x64_bf16 v[40:43], v[8:11], a[56:63], v3
  v_smfmac_f32_16x16x64_bf16 v[44:47], v[8:11], a[112:119], v3
  v_smfmac_f32_16x16x64_bf16 v[48:51], v[8:11], a[168:175], v3
  v_smfmac_f32_16x16x64_bf16 v[52:55], v[8:11], a[224:231], v3
  v_smfmac_f32_16x16x64_bf16 v[56:59], v[8:11], v[144:151], v3
  v_smfmac_f32_16x16x64_bf16 v[60:63], v[8:11], v[200:207], v3
  v_smfmac_f32_16x16x64_bf16 v[36:39], v[12:15], a[8:15], v3
  v_smfmac_f32_16x16x64_bf16 v[40:43], v[12:15], a[64:71], v3
  v_smfmac_f32_16x16x64_bf16 v[44:47], v[12:15], a[120:127], v3
  v_smfmac_f32_16x16x64_bf16 v[48:51], v[12:15], a[176:183], v3
  v_smfmac_f32_16x16x64_bf16 v[52:55], v[12:15], a[232:239], v3
  v_smfmac_f32_16x16x64_bf16 v[56:59], v[12:15], v[152:159], v3
  v_smfmac_f32_16x16x64_bf16 v[60:63], v[12:15], v[208:215], v3
  v_smfmac_f32_16x16x64_bf16 v[36:39], v[16:19], a[16:23], v3
  v_smfmac_f32_16x16x64_bf16 v[40:43], v[16:19], a[72:79], v3
  v_smfmac_f32_16x16x64_bf16 v[44:47], v[16:19], a[128:135], v3
  v_smfmac_f32_16x16x64_bf16 v[48:51], v[16:19], a[184:191], v3
  v_smfmac_f32_16x16x64_bf16 v[52:55], v[16:19], a[240:247], v3
  v_smfmac_f32_16x16x64_bf16 v[56:59], v[16:19], v[160:167], v3
  v_smfmac_f32_16x16x64_bf16 v[60:63], v[16:19], v[216:223], v3
  v_smfmac_f32_16x16x64_bf16 v[36:39], v[20:23], a[24:31], v3
  v_smfmac_f32_16x16x64_bf16 v[40:43], v[20:23], a[80:87], v3
  v_smfmac_f32_16x16x64_bf16 v[44:47], v[20:23], a[136:143], v3
  v_smfmac_f32_16x16x64_bf16 v[48:51], v[20:23], a[192:199], v3
  v_smfmac_f32_16x16x64_bf16 v[52:55], v[20:23], a[248:255], v3
  v_smfmac_f32_16x16x64_bf16 v[56:59], v[20:23], v[168:175], v3
  v_smfmac_f32_16x16x64_bf16 v[60:63], v[20:23], v[224:231], v3
  v_smfmac_f32_16x16x64_bf16 v[36:39], v[24:27], a[32:39], v3
  v_smfmac_f32_16x16x64_bf16 v[40:43], v[24:27], a[88:95], v3
  v_smfmac_f32_16x16x64_bf16 v[44:47], v[24:27], a[144:151], v3
  v_smfmac_f32_16x16x64_bf16 v[48:51], v[24:27], a[200:207], v3
  v_smfmac_f32_16x16x64_bf16 v[52:55], v[24:27], v[120:127], v3
  v_smfmac_f32_16x16x64_bf16 v[56:59], v[24:27], v[176:183], v3
  v_smfmac_f32_16x16x64_bf16 v[60:63], v[24:27], v[232:239], v3
  v_smfmac_f32_16x16x64_bf16 v[36:39], v[28:31], a[40:47], v3
  v_smfmac_f32_16x16x64_bf16 v[40:43], v[28:31], a[96:103], v3
  v_smfmac_f32_16x16x64_bf16 v[44:47], v[28:31], a[152:159], v3
  v_smfmac_f32_16x16x64_bf16 v[48:51], v[28:31], a[208:215], v3
  v_smfmac_f32_16x16x64_bf16 v[52:55], v[28:31], v[128:135], v3
  v_smfmac_f32_16x16x64_bf16 v[56:59], v[28:31], v[184:191], v3
  v_smfmac_f32_16x16x64_bf16 v[60:63], v[28:31], v[240:247], v3
  v_smfmac_f32_16x16x64_bf16 v[36:39], v[32:35], a[48:55], v3
  v_smfmac_f32_16x16x64_bf16 v[40:43], v[32:35], a[104:111], v3
  v_smfmac_f32_16x16x64_bf16 v[44:47], v[32:35], a[160:167], v3
  v_smfmac_f32_16x16x64_bf16 v[48:51], v[32:35], a[216:223], v3
  v_smfmac_f32_16x16x64_bf16 v[52:55], v[32:35], v[136:143], v3
  v_smfmac_f32_16x16x64_bf16 v[56:59], v[32:35], v[192:199], v3
  v_smfmac_f32_16x16x64_bf16 v[60:63], v[32:35], v[248:255], v3
  v_permlane32_swap_b32 v36, v38
  v_permlane32_swap_b32 v37, v39
  v_add_f32 v36, v36, v38
  v_add_f32 v37, v37, v39
  v_cvt_pk_bf16_f32 v38, v36, v37
  ds_write_b32 v104, v38
  v_permlane32_swap_b32 v40, v42
  v_permlane32_swap_b32 v41, v43
  v_add_f32 v40, v40, v42
  v_add_f32 v41, v41, v43
  v_cvt_pk_bf16_f32 v42, v40, v41
  ds_write_b32 v105, v42
  v_permlane32_swap_b32 v44, v46
  v_permlane32_swap_b32 v45, v47
  v_add_f32 v44, v44, v46
  v_add_f32 v45, v45, v47
  v_cvt_pk_bf16_f32 v46, v44, v45
  ds_write_b32 v106, v46
  v_permlane32_swap_b32 v48, v50
  v_permlane32_swap_b32 v49, v51
  v_add_f32 v48, v48, v50
  v_add_f32 v49, v49, v51
  v_cvt_pk_bf16_f32 v50, v48, v49
  ds_write_b32 v107, v50
  v_permlane32_swap_b32 v52, v54
  v_permlane32_swap_b32 v53, v55
  v_add_f32 v52, v52, v54
  v_add_f32 v53, v53, v55
  v_cvt_pk_bf16_f32 v54, v52, v53
  ds_write_b32 v108, v54
  v_permlane32_swap_b32 v56, v58
  v_permlane32_swap_b32 v57, v59
  v_add_f32 v56, v56, v58
  v_add_f32 v57, v57, v59
  v_cvt_pk_bf16_f32 v58, v56, v57
  ds_write_b32 v109, v58
  v_permlane32_swap_b32 v60, v62
  v_permlane32_swap_b32 v61, v63
  v_add_f32 v60, v60, v62
  v_add_f32 v61, v61, v63
  v_cvt_pk_bf16_f32 v62, v60, v61
  ds_write_b32 v110, v62
  s_branch cB_va2_t2d
.p2align 6
cB_va3_loop:
  s_mov_b32 s30, 0
  s_barrier
  buffer_load_dwordx4 v[16:19], v2, s[8:11], s20 offen offset:2048 sc1
  buffer_load_dwordx4 v[20:23], v2, s[8:11], s20 offen offset:3072 sc1
  s_barrier
  buffer_load_dword v100, v116, s[8:11], s39 offen sc1
  s_add_u32 s27, s19, 2
  s_min_u32 s27, s27, 63
  s_lshr_b32 s27, s27, 3
  s_lshl_b32 s27, s27, 11
  s_add_u32 s27, s27, s35
  s_cmp_eq_u32 s27, s28
  s_cselect_b32 s29, 75729408, s27
  buffer_load_dword v101, off, s[8:11], s29 sc1
  s_add_u32 s39, s39, 28672
  s_waitcnt vmcnt(2)
  ds_write_b128 v2, v[16:19] offset:10240
  ds_write_b128 v2, v[20:23] offset:11264
  v_smfmac_f32_16x16x64_bf16 v[36:39], v[16:19], a[16:23], v3
  v_smfmac_f32_16x16x64_bf16 v[40:43], v[16:19], a[72:79], v3
  v_smfmac_f32_16x16x64_bf16 v[44:47], v[16:19], a[128:135], v3
  v_smfmac_f32_16x16x64_bf16 v[48:51], v[16:19], a[184:191], v3
  v_smfmac_f32_16x16x64_bf16 v[52:55], v[16:19], a[240:247], v3
  s_waitcnt lgkmcnt(0)
  s_barrier
  ds_read_b128 v[8:11], v2 offset:8192
  ds_read_b128 v[12:15], v2 offset:9216
  ds_read_b128 v[24:27], v2 offset:12288
  ds_read_b128 v[28:31], v2 offset:13312
  ds_read_b128 v[32:35], v2 offset:14336
  v_smfmac_f32_16x16x64_bf16 v[56:59], v[16:19], v[160:167], v3
  v_smfmac_f32_16x16x64_bf16 v[60:63], v[16:19], v[216:223], v3
  v_smfmac_f32_16x16x64_bf16 v[36:39], v[20:23], a[24:31], v3
  v_smfmac_f32_16x16x64_bf16 v[40:43], v[20:23], a[80:87], v3
  v_smfmac_f32_16x16x64_bf16 v[44:47], v[20:23], a[136:143], v3
  v_smfmac_f32_16x16x64_bf16 v[48:51], v[20:23], a[192:199], v3
  v_smfmac_f32_16x16x64_bf16 v[52:55], v[20:23], a[248:255], v3
  v_smfmac_f32_16x16x64_bf16 v[56:59], v[20:23], v[168:175], v3
  v_smfmac_f32_16x16x64_bf16 v[60:63], v[20:23], v[224:231], v3
  s_waitcnt lgkmcnt(4)
  v_smfmac_f32_16x16x64_bf16 v[36:39], v[8:11], a[0:7], v3
  s_waitcnt lgkmcnt(3)
  v_smfmac_f32_16x16x64_bf16 v[36:39], v[12:15], a[8:15], v3
  s_waitcnt lgkmcnt(2)
  v_smfmac_f32_16x16x64_bf16 v[36:39], v[24:27], a[32:39], v3
  s_waitcnt lgkmcnt(1)
  v_smfmac_f32_16x16x64_bf16 v[36:39], v[28:31], a[40:47], v3
  s_waitcnt lgkmcnt(0)
  v_smfmac_f32_16x16x64_bf16 v[36:39], v[32:35], a[48:55], v3
  v_smfmac_f32_16x16x64_bf16 v[40:43], v[8:11], a[56:63], v3
  v_smfmac_f32_16x16x64_bf16 v[40:43], v[12:15], a[64:71], v3
  v_smfmac_f32_16x16x64_bf16 v[40:43], v[24:27], a[88:95], v3
  v_permlane32_swap_b32 v36, v38
  v_smfmac_f32_16x16x64_bf16 v[40:43], v[28:31], a[96:103], v3
  v_permlane32_swap_b32 v37, v39
  v_smfmac_f32_16x16x64_bf16 v[40:43], v[32:35], a[104:111], v3
  v_add_f32 v36, v36, v38
  v_smfmac_f32_16x16x64_bf16 v[44:47], v[8:11], a[112:119], v3
  v_add_f32 v37, v37, v39
  v_smfmac_f32_16x16x64_bf16 v[44:47], v[12:15], a[120:127], v3
  v_cmp_u_f32 vcc, v36, v37
  v_smfmac_f32_16x16x64_bf16 v[44:47], v[24:27], a[144:151], v3
  v_cvt_pk_bf16_f32 v38, v36, v37
  v_smfmac_f32_16x16x64_bf16 v[44:47], v[28:31], a[152:159], v3
  ds_write_b32 v104, v38
  s_cbranch_vccnz cB_va3_slow
  v_permlane32_swap_b32 v40, v42
  v_smfmac_f32_16x16x64_bf16 v[44:47], v[32:35], a[160:167], v3
  v_permlane32_swap_b32 v41, v43
  v_smfmac_f32_16x16x64_bf16 v[48:51], v[8:11], a[168:175], v3
  v_add_f32 v40, v40, v42
  v_smfmac_f32_16x16x64_bf16 v[48:51], v[12:15], a[176:183], v3
  v_add_f32 v41, v41, v43
  v_smfmac_f32_16x16x64_bf16 v[48:51], v[24:27], a[200:207], v3
  v_cvt_pk_bf16_f32 v42, v40, v41
  v_smfmac_f32_16x16x64_bf16 v[48:51], v[28:31], a[208:215], v3
  ds_write_b32 v105, v42
  v_permlane32_swap_b32 v44, v46
  v_smfmac_f32_16x16x64_bf16 v[48:51], v[32:35], a[216:223], v3
  v_permlane32_swap_b32 v45, v47
  v_smfmac_f32_16x16x64_bf16 v[52:55], v[8:11], a[224:231], v3
  v_add_f32 v44, v44, v46
  v_smfmac_f32_16x16x64_bf16 v[52:55], v[12:15], a[232:239], v3
  v_add_f32 v45, v45, v47
  v_smfmac_f32_16x16x64_bf16 v[52:55], v[24:27], v[120:127], v3
  v_cvt_pk_bf16_f32 v46, v44, v45
  v_smfmac_f32_16x16x64_bf16 v[52:55], v[28:31], v[128:135], v3
  ds_write_b32 v106, v46
  v_permlane32_swap_b32 v48, v50
  v_smfmac_f32_16x16x64_bf16 v[52:55], v[32:35], v[136:143], v3
  v_permlane32_swap_b32 v49, v51
  v_smfmac_f32_16x16x64_bf16 v[56:59], v[8:11], v[144:151], v3
  v_add_f32 v48, v48, v50
  v_smfmac_f32_16x16x64_bf16 v[56:59], v[12:15], v[152:159], v3
  v_add_f32 v49, v49, v51
  v_smfmac_f32_16x16x64_bf16 v[56:59], v[24:27], v[176:183], v3
  v_cvt_pk_bf16_f32 v50, v48, v49
  v_smfmac_f32_16x16x64_bf16 v[56:59], v[28:31], v[184:191], v3
  ds_write_b32 v107, v50
  v_permlane32_swap_b32 v52, v54
  v_smfmac_f32_16x16x64_bf16 v[56:59], v[32:35], v[192:199], v3
  v_permlane32_swap_b32 v53, v55
  v_smfmac_f32_16x16x64_bf16 v[60:63], v[8:11], v[200:207], v3
  v_add_f32 v52, v52, v54
  v_smfmac_f32_16x16x64_bf16 v[60:63], v[12:15], v[208:215], v3
  v_add_f32 v53, v53, v55
  v_smfmac_f32_16x16x64_bf16 v[60:63], v[24:27], v[232:239], v3
  v_cvt_pk_bf16_f32 v54, v52, v53
  v_smfmac_f32_16x16x64_bf16 v[60:63], v[28:31], v[240:247], v3
  ds_write_b32 v108, v54
  v_permlane32_swap_b32 v56, v58
  v_smfmac_f32_16x16x64_bf16 v[60:63], v[32:35], v[248:255], v3
  v_permlane32_swap_b32 v57, v59
  v_add_f32 v56, v56, v58
  v_add_f32 v57, v57, v59
  v_cvt_pk_bf16_f32 v58, v56, v57
  ds_write_b32 v109, v58
  s_nop 2
  v_permlane32_swap_b32 v60, v62
  v_permlane32_swap_b32 v61, v63
  v_add_f32 v60, v60, v62
  v_add_f32 v61, v61, v63
  v_cvt_pk_bf16_f32 v62, v60, v61
  ds_write_b32 v110, v62
cB_va3_t2d:
  v_mov_b32 v117, s18
  s_cmp_eq_u32 s27, s28
  s_cbranch_scc1 cB_va3_vok
cB_va3_vow:
  s_waitcnt vmcnt(0)
  v_cmp_ne_u32 vcc, 56, v101
  s_cbranch_vccnz cB_va3_vor
  s_mov_b32 s28, s27
cB_va3_vok:
  s_waitcnt lgkmcnt(0)
  s_setprio 3
  s_barrier
  v_mov_b32 v36, 0
  v_mov_b32 v37, 0
  v_mov_b32 v38, 0
  v_mov_b32 v39, 0
  buffer_store_dword v117, v118, s[8:11], 0 offen sc1
  s_setprio 0
  s_cmp_eq_u32 s19, 62
  s_cbranch_scc1 cB_done
  v_mov_b32 v40, 0
  v_mov_b32 v41, 0
  v_mov_b32 v42, 0
  v_mov_b32 v43, 0
  v_mov_b32 v44, 0
  v_mov_b32 v45, 0
  v_mov_b32 v46, 0
  v_mov_b32 v47, 0
  v_mov_b32 v48, 0
  v_mov_b32 v49, 0
  v_mov_b32 v50, 0
  v_mov_b32 v51, 0
  v_mov_b32 v52, 0
  v_mov_b32 v53, 0
  v_mov_b32 v54, 0
  v_mov_b32 v55, 0
  v_mov_b32 v56, 0
  v_mov_b32 v57, 0
  v_mov_b32 v58, 0
  v_mov_b32 v59, 0
  v_mov_b32 v60, 0
  v_mov_b32 v61, 0
  v_mov_b32 v62, 0
  v_mov_b32 v63, 0
  s_mov_b32 s19, s18
  s_add_u32 s18, s18, 1
  s_mov_b32 s22, s20
  s_mov_b32 s20, s21
  s_mov_b32 s21, s22
  s_add_u32 s23, s20, 4096
  s_branch cB_va3_loop
cB_va3_slow:
  s_waitcnt lgkmcnt(0)
cB_va3_sl1:
  s_add_u32 s31, s31, 0x1000000
  buffer_load_dwordx4 v[8:11], v2, s[8:11], s20 offen offset:0 sc1
  buffer_load_dwordx4 v[12:15], v2, s[8:11], s20 offen offset:1024 sc1
  buffer_load_dwordx4 v[16:19], v2, s[8:11], s20 offen offset:2048 sc1
  buffer_load_dwordx4 v[20:23], v2, s[8:11], s20 offen offset:3072 sc1
  buffer_load_dwordx4 v[24:27], v2, s[8:11], s23 offen offset:0 sc1
  buffer_load_dwordx4 v[28:31], v2, s[8:11], s23 offen offset:1024 sc1
  buffer_load_dwordx4 v[32:35], v2, s[8:11], s23 offen offset:2048 sc1
  s_waitcnt vmcnt(0)
  v_max3_u32 v36, v8, v9, v10
  v_max3_u32 v36, v36, v11, v12
  v_max3_u32 v36, v36, v13, v14
  v_max3_u32 v36, v36, v15, v16
  v_max3_u32 v36, v36, v17, v18
  v_max3_u32 v36, v36, v19, v20
  v_max3_u32 v36, v36, v21, v22
  v_max3_u32 v36, v36, v23, v24
  v_max3_u32 v36, v36, v25, v26
  v_max3_u32 v36, v36, v27, v28
  v_max3_u32 v36, v36, v29, v30
  v_max3_u32 v36, v36, v31, v32
  v_max3_u32 v36, v36, v33, v34
  v_max_u32 v36, v36, v35
  v_cmp_eq_u32 vcc, -1, v36
  s_cbranch_vccz cB_va3_sl2
  s_add_u32 s30, s30, 1
  s_cmp_lt_u32 s30, 400000
  s_cbranch_scc1 cB_va3_sl1
  s_branch cB_abort
cB_va3_sl2:
  v_mov_b32 v36, 0
  v_mov_b32 v37, 0
  v_mov_b32 v38, 0
  v_mov_b32 v39, 0
  v_mov_b32 v40, 0
  v_mov_b32 v41, 0
  v_mov_b32 v42, 0
  v_mov_b32 v43, 0
  v_mov_b32 v44, 0
  v_mov_b32 v45, 0
  v_mov_b32 v46, 0
  v_mov_b32 v47, 0
  v_mov_b32 v48, 0
  v_mov_b32 v49, 0
  v_mov_b32 v50, 0
  v_mov_b32 v51, 0
  v_mov_b32 v52, 0
  v_mov_b32 v53, 0
  v_mov_b32 v54, 0
  v_mov_b32 v55, 0
  v_mov_b32 v56, 0
  v_mov_b32 v57, 0
  v_mov_b32 v58, 0
  v_mov_b32 v59, 0
  v_mov_b32 v60, 0
  v_mov_b32 v61, 0
  v_mov_b32 v62, 0
  v_mov_b32 v63, 0
  v_smfmac_f32_16x16x64_bf16 v[36:39], v[8:11], a[0:7], v3
  v_smfmac_f32_16x16x64_bf16 v[40:43], v[8:11], a[56:63], v3
  v_smfmac_f32_16x16x64_bf16 v[44:47], v[8:11], a[112:119], v3
  v_smfmac_f32_16x16x64_bf16 v[48:51], v[8:11], a[168:175], v3
  v_smfmac_f32_16x16x64_bf16 v[52:55], v[8:11], a[224:231], v3
  v_smfmac_f32_16x16x64_bf16 v[56:59], v[8:11], v[144:151], v3
  v_smfmac_f32_16x16x64_bf16 v[60:63], v[8:11], v[200:207], v3
  v_smfmac_f32_16x16x64_bf16 v[36:39], v[12:15], a[8:15], v3
  v_smfmac_f32_16x16x64_bf16 v[40:43], v[12:15], a[64:71], v3
  v_smfmac_f32_16x16x64_bf16 v[44:47], v[12:15], a[120:127], v3
  v_smfmac_f32_16x16x64_bf16 v[48:51], v[12:15], a[176:183], v3
  v_smfmac_f32_16x16x64_bf16 v[52:55], v[12:15], a[232:239], v3
  v_smfmac_f32_16x16x64_bf16 v[56:59], v[12:15], v[152:159], v3
  v_smfmac_f32_16x16x64_bf16 v[60:63], v[12:15], v[208:215], v3
  v_smfmac_f32_16x16x64_bf16 v[36:39], v[16:19], a[16:23], v3
  v_smfmac_f32_16x16x64_bf16 v[40:43], v[16:19], a[72:79], v3
  v_smfmac_f32_16x16x64_bf16 v[44:47], v[16:19], a[128:135], v3
  v_smfmac_f32_16x16x64_bf16 v[48:51], v[16:19], a[184:191], v3
  v_smfmac_f32_16x16x64_bf16 v[52:55], v[16:19], a[240:247], v3
  v_smfmac_f32_16x16x64_bf16 v[56:59], v[16:19], v[160:167], v3
  v_smfmac_f32_16x16x64_bf16 v[60:63], v[16:19], v[216:223], v3
  v_smfmac_f32_16x16x64_bf16 v[36:39], v[20:23], a[24:31], v3
  v_smfmac_f32_16x16x64_bf16 v[40:43], v[20:23], a[80:87], v3
  v_smfmac_f32_16x16x64_bf16 v[44:47], v[20:23], a[136:143], v3
  v_smfmac_f32_16x16x64_bf16 v[48:51], v[20:23], a[192:199], v3
  v_smfmac_f32_16x16x64_bf16 v[52:55], v[20:23], a[248:255], v3
  v_smfmac_f32_16x16x64_bf16 v[56:59], v[20:23], v[168:175], v3
  v_smfmac_f32_16x16x64_bf16 v[60:63], v[20:23], v[224:231], v3
  v_smfmac_f32_16x16x64_bf16 v[36:39], v[24:27], a[32:39], v3
  v_smfmac_f32_16x16x64_bf16 v[40:43], v[24:27], a[88:95], v3
  v_smfmac_f32_16x16x64_bf16 v[44:47], v[24:27], a[144:151], v3
  v_smfmac_f32_16x16x64_bf16 v[48:51], v[24:27], a[200:207], v3
  v_smfmac_f32_16x16x64_bf16 v[52:55], v[24:27], v[120:127], v3
  v_smfmac_f32_16x16x64_bf16 v[56:59], v[24:27], v[176:183], v3
  v_smfmac_f32_16x16x64_bf16 v[60:63], v[24:27], v[232:239], v3
  v_smfmac_f32_16x16x64_bf16 v[36:39], v[28:31], a[40:47], v3
  v_smfmac_f32_16x16x64_bf16 v[40:43], v[28:31], a[96:103], v3
  v_smfmac_f32_16x16x64_bf16 v[44:47], v[28:31], a[152:159], v3
  v_smfmac_f32_16x16x64_bf16 v[48:51], v[28:31], a[208:215], v3
  v_smfmac_f32_16x16x64_bf16 v[52:55], v[28:31], v[128:135], v3
  v_smfmac_f32_16x16x64_bf16 v[56:59], v[28:31], v[184:191], v3
  v_smfmac_f32_16x16x64_bf16 v[60:63], v[28:31], v[240:247], v3
  v_smfmac_f32_16x16x64_bf16 v[36:39], v[32:35], a[48:55], v3
  v_smfmac_f32_16x16x64_bf16 v[40:43], v[32:35], a[104:111], v3
  v_smfmac_f32_16x16x64_bf16 v[44:47], v[32:35], a[160:167], v3
  v_smfmac_f32_16x16x64_bf16 v[48:51], v[32:35], a[216:223], v3
  v_smfmac_f32_16x16x64_bf16 v[52:55], v[32:35], v[136:143], v3
  v_smfmac_f32_16x16x64_bf16 v[56:59], v[32:35], v[192:199], v3
  v_smfmac_f32_16x16x64_bf16 v[60:63], v[32:35], v[248:255], v3
  v_permlane32_swap_b32 v36, v38
  v_permlane32_swap_b32 v37, v39
  v_add_f32 v36, v36, v38
  v_add_f32 v37, v37, v39
  v_cvt_pk_bf16_f32 v38, v36, v37
  ds_write_b32 v104, v38
  v_permlane32_swap_b32 v40, v42
  v_permlane32_swap_b32 v41, v43
  v_add_f32 v40, v40, v42
  v_add_f32 v41, v41, v43
  v_cvt_pk_bf16_f32 v42, v40, v41
  ds_write_b32 v105, v42
  v_permlane32_swap_b32 v44, v46
  v_permlane32_swap_b32 v45, v47
  v_add_f32 v44, v44, v46
  v_add_f32 v45, v45, v47
  v_cvt_pk_bf16_f32 v46, v44, v45
  ds_write_b32 v106, v46
  v_permlane32_swap_b32 v48, v50
  v_permlane32_swap_b32 v49, v51
  v_add_f32 v48, v48, v50
  v_add_f32 v49, v49, v51
  v_cvt_pk_bf16_f32 v50, v48, v49
  ds_write_b32 v107, v50
  v_permlane32_swap_b32 v52, v54
  v_permlane32_swap_b32 v53, v55
  v_add_f32 v52, v52, v54
  v_add_f32 v53, v53, v55
  v_cvt_pk_bf16_f32 v54, v52, v53
  ds_write_b32 v108, v54
  v_permlane32_swap_b32 v56, v58
  v_permlane32_swap_b32 v57, v59
  v_add_f32 v56, v56, v58
  v_add_f32 v57, v57, v59
  v_cvt_pk_bf16_f32 v58, v56, v57
  ds_write_b32 v109, v58
  v_permlane32_swap_b32 v60, v62
  v_permlane32_swap_b32 v61, v63
  v_add_f32 v60, v60, v62
  v_add_f32 v61, v61, v63
  v_cvt_pk_bf16_f32 v62, v60, v61
  ds_write_b32 v110, v62
  s_branch cB_va3_t2d
cB_va3_vor:
  s_sleep 2
  buffer_load_dword v101, off, s[8:11], s27 sc1
  s_add_u32 s30, s30, 1
  s_cmp_lt_u32 s30, 400000
  s_cbranch_scc1 cB_va3_vow
  s_branch cB_abort
cB_abort:
  v_mov_b32 v4, 0xdead
  v_mov_b32 v5, 16
  buffer_store_dword v4, v5, s[12:15], 0 offen
  s_branch ch_end
cB_done:
  s_branch ch_end
ch_worker:
  s_sub_u32 s35, s3, 0
  s_and_b32 s35, s35, 7
  s_lshr_b32 s36, s2, 3
  s_mul_i32 s33, s35, 28
  s_add_u32 s33, s33, s36
  s_mov_b32 s97, 0
  s_mov_b32 s96, 0
  s_mov_b32 s37, 0
  s_mov_b32 s38, 0
  s_mov_b32 s39, 0xffff0000
  v_and_b32 v1, 63, v0
  v_lshlrev_b32 v2, 4, v1
  v_lshrrev_b32 v3, 4, v1
  v_and_b32 v4, 15, v1
  v_lshrrev_b32 v5, 5, v1
  v_and_b32 v6, 31, v1
  v_xor_b32 v8, v6, v5
  v_lshlrev_b32 v8, 4, v8
  v_lshl_add_u32 v16, v5, 13, v8
  v_xor_b32 v17, 32, v16
  v_xor_b32 v18, 64, v16
  v_xor_b32 v19, 96, v16
  v_xor_b32 v20, 128, v16
  v_xor_b32 v21, 160, v16
  v_xor_b32 v22, 192, v16
  v_xor_b32 v23, 224, v16
  s_lshl_b32 s20, s16, 6
  v_xor_b32 v26, s20, v16
  v_xor_b32 v27, 32, v26
  s_cmp_lt_u32 s36, 28
  s_cbranch_scc1 wp_B
  s_cmp_eq_u32 s35, 0
  s_cbranch_scc1 wp_ini
  s_lshl_b32 s33, s35, 2
  s_add_u32 s33, s33, s36
  s_sub_u32 s33, s33, 32
  s_mul_i32 s17, s33, 4682
  s_lshr_b32 s17, s17, 16
  s_mul_i32 s23, s17, 14
  s_sub_u32 s19, s33, s23
  s_cmp_lt_u32 s19, 7
  s_cselect_b32 s18, 0, 7
  s_cselect_b32 s28, 0, 8
  s_sub_u32 s18, s19, s18
  s_add_u32 s28, s28, s16
  s_lshl_b32 s25, s16, 15
  s_add_u32 s25, s25, 32768
  s_lshl_b32 s26, s17, 9
  s_branch wp_A0
wp_ini:
  v_mov_b32 v4, 1
  v_mov_b32 v5, 4
  v_mov_b32 v6, 160000
  s_barrier
  s_cmp_lg_u32 s16, 0
  s_cbranch_scc1 wp_ic1
  s_mov_b64 exec, 1
  buffer_atomic_add v4, v5, s[12:15], 0 offen sc0
  s_waitcnt vmcnt(0)
  ds_write_b32 v6, v4
  s_waitcnt lgkmcnt(0)
  s_mov_b64 exec, -1
wp_ic1:
  s_barrier
  ds_read_b32 v4, v6
  s_waitcnt lgkmcnt(0)
  v_readfirstlane_b32 s33, v4
  v_and_b32 v1, 63, v0
  v_lshlrev_b32 v2, 4, v1
  v_lshrrev_b32 v3, 4, v1
  v_and_b32 v4, 15, v1
  s_cmp_ge_u32 s33, 4
  s_cbranch_scc1 wp_ini2
  v_mov_b32 v10, 0x40000000
  v_mov_b32 v5, 1
  v_mov_b32 v148, 0
  v_mov_b32 v149, 0
  v_mov_b32 v150, 0
  v_mov_b32 v151, 0
  v_mov_b32 v152, -1
  v_mov_b32 v153, -1
  v_mov_b32 v154, -1
  v_mov_b32 v155, -1
  v_lshlrev_b32 v8, 4, v0
  s_cmp_lg_u32 s33, 0
  s_cbranch_scc1 wp_ij_1
  s_mov_b32 s23, 88519168
  buffer_store_dwordx4 v[148:151], v8, s[8:11], s23 offen sc1
  s_mov_b32 s23, 88523264
  buffer_store_dwordx4 v[148:151], v8, s[8:11], s23 offen sc1
  s_waitcnt vmcnt(0)
  s_barrier
  buffer_store_dword v5, v252, s[12:15], 0 offen offset:128 sc1
wp_ij_1:
  s_mov_b32 s68, s50
  s_and_b32 s69, s51, 0xffff
  s_mov_b32 s70, 7168
  s_mov_b32 s71, 0x20000
  v_lshrrev_b32 v6, 3, v0
  v_min_u32 v6, 27, v6
  v_and_b32 v7, 7, v0
  v_mul_u32_u24 v9, 896, v7
  v_lshl_add_u32 v9, v6, 5, v9
  buffer_load_dwordx4 v[176:179], v9, s[68:71], 0 offen
  buffer_load_dwordx4 v[180:183], v9, s[68:71], 0 offen offset:16
  s_lshl_b32 s20, s33, 12
  v_add_u32 v8, s20, v8
  s_mov_b32 s23, 88461312
wp_ijlp_2:
  buffer_store_dwordx4 v[148:151], v8, s[8:11], s23 offen sc1
  s_add_u32 s23, s23, 16384
  s_cmp_lt_u32 s23, 88510464
  s_cbranch_scc1 wp_ijlp_2
  v_cmp_gt_u32 vcc, 8704, v8
  s_nop 1
  v_cndmask_b32 v9, v10, v8, vcc
  buffer_store_dwordx4 v[148:151], v9, s[8:11], s23 offen sc1
  s_mov_b32 s23, 75729408
  v_cmp_gt_u32 vcc, 6144, v8
  s_nop 1
  v_cndmask_b32 v9, v10, v8, vcc
  buffer_store_dwordx4 v[148:151], v9, s[8:11], s23 offen sc1
  s_mov_b32 s23, 75701248
wp_ijlp_3:
  buffer_store_dwordx4 v[152:155], v8, s[8:11], s23 offen sc1
  s_add_u32 s23, s23, 16384
  s_cmp_lt_u32 s23, 75717632
  s_cbranch_scc1 wp_ijlp_3
  v_cmp_gt_u32 vcc, 11776, v8
  s_nop 1
  v_cndmask_b32 v9, v10, v8, vcc
  buffer_store_dwordx4 v[152:155], v9, s[8:11], s23 offen sc1
  s_mov_b32 s23, 88009728
wp_ijlp_4:
  buffer_store_dwordx4 v[152:155], v8, s[8:11], s23 offen sc1
  s_add_u32 s23, s23, 16384
  s_cmp_lt_u32 s23, 88452096
  s_cbranch_scc1 wp_ijlp_4
  v_cmp_gt_u32 vcc, 9216, v8
  s_nop 1
  v_cndmask_b32 v9, v10, v8, vcc
  buffer_store_dwordx4 v[152:155], v9, s[8:11], s23 offen sc1
  s_cmp_lg_u32 s33, 1
  s_cbranch_scc1 wp_ij_nm
  v_lshrrev_b32 v6, 3, v0
  v_and_b32 v7, 7, v0
  v_lshlrev_b32 v8, 8, v6
  v_lshl_add_u32 v8, v7, 4, v8
  v_cmp_gt_u32 vcc, 28, v6
  s_nop 1
  v_cndmask_b32 v8, v10, v8, vcc
  s_waitcnt vmcnt(8)
  v_mov_b32 v184, v176
  v_mov_b32 v188, v177
  v_mov_b32 v185, v178
  v_mov_b32 v189, v179
  v_mov_b32 v186, v180
  v_mov_b32 v190, v181
  v_mov_b32 v187, v182
  v_mov_b32 v191, v183
  s_mov_b32 s23, 75694080
  buffer_store_dwordx4 v[184:187], v8, s[8:11], s23 offen sc1
  buffer_store_dwordx4 v[188:191], v8, s[8:11], s23 offen offset:128 sc1
  s_mov_b32 s23, 88002560
  buffer_store_dwordx4 v[184:187], v8, s[8:11], s23 offen sc1
  buffer_store_dwordx4 v[188:191], v8, s[8:11], s23 offen offset:128 sc1
wp_ij_nm:
  s_waitcnt vmcnt(0)
  s_barrier
  s_cmp_lg_u32 s16, 0
  s_cbranch_scc1 wp_ij_e
  v_mov_b32 v6, 1
  s_mov_b64 exec, 1
  buffer_atomic_add v6, v252, s[12:15], 0 offen offset:12 sc0
  s_waitcnt vmcnt(0)
  v_readfirstlane_b32 s20, v6
  s_cmp_lg_u32 s20, 3
  s_cbranch_scc1 wp_ij_e0
  buffer_store_dword v5, v252, s[12:15], 0 offen offset:132 sc1
wp_ij_e0:
  s_mov_b64 exec, -1
wp_ij_e:
wp_ini2:
  s_cmp_lg_u32 s97, 0
  s_cbranch_scc1 wp_all
  s_cmp_lg_u32 s3, 0
  s_cbranch_scc1 wp_all
  v_readfirstlane_b32 s91, v249
  v_mov_b32 v6, 160032
  s_nop 0
  v_mov_b32 v7, s91
  s_barrier
  s_cmp_lg_u32 s16, 0
  s_cbranch_scc1 uni_5
  ds_write_b32 v6, v7
  s_waitcnt lgkmcnt(0)
uni_5:
  s_barrier
  ds_read_b32 v7, v6
  s_waitcnt lgkmcnt(0)
  v_readfirstlane_b32 s91, v7
  s_and_b32 s91, s91, 0xffff
  s_cmp_lt_u32 s91, 32
  s_cbranch_scc1 ch_role2
  s_branch wp_all
wp_B:
  s_mul_i32 s17, s33, 4682
  s_lshr_b32 s17, s17, 16
  s_mul_i32 s23, s17, 14
  s_sub_u32 s19, s33, s23
  s_cmp_lt_u32 s19, 7
  s_cselect_b32 s18, 0, 7
  s_cselect_b32 s28, 0, 8
  s_sub_u32 s18, s19, s18
  s_add_u32 s28, s28, s16
  s_lshl_b32 s25, s16, 15
  s_add_u32 s25, s25, 32768
  s_lshl_b32 s26, s17, 9
  s_cmp_lt_u32 s19, 7
  s_cselect_b32 s64, s44, s46
  s_cselect_b32 s65, s45, s47
  s_cselect_b32 s27, 0, 7
  s_mov_b32 s68, s64
  s_and_b32 s69, s65, 0xffff
  s_mov_b32 s70, 3670016
  s_mov_b32 s71, 0x20000
  s_sub_u32 s31, s19, s27
  s_lshl_b32 s27, s31, 19
  s_add_u32 s27, s27, s26
  v_lshrrev_b32 v7, 2, v0
  v_and_b32 v8, 3, v0
  v_lshlrev_b32 v8, 7, v8
  v_lshl_add_u32 v9, v7, 13, v8
  s_mul_i32 s30, s17, 229376
  s_lshl_b32 s31, s31, 15
  s_add_u32 s30, s30, s31
  s_cmp_lt_u32 s19, 7
  s_cselect_b32 s27, s27, s30
  s_cselect_b64 vcc, -1, 0
  v_lshlrev_b32 v8, 7, v0
  v_cndmask_b32 v9, v8, v9, vcc
  buffer_load_dword v253, v9, s[68:71], s27 offen nt
  s_lshl_b32 s20, s33, 2
  s_add_u32 s20, s20, s16
  s_mul_i32 s21, s20, 9363
  s_lshr_b32 s21, s21, 16
  s_mul_i32 s22, s21, 7
  s_sub_u32 s22, s20, s22
  s_mul_i32 s21, s21, 14336
  s_lshl_b32 s20, s22, 7
  s_add_u32 s20, s20, s21
  s_lshl_b32 s22, s22, 11
  s_add_u32 s52, s21, s22
  s_mov_b32 s68, s48
  s_and_b32 s69, s49, 0xffff
  s_mov_b32 s70, 1835008
  s_mov_b32 s71, 0x20000
  v_mul_u32_u24 v7, 896, v4
  v_lshl_add_u32 v7, v3, 5, v7
  buffer_load_dwordx4 v[128:131], v7, s[68:71], s20 offen
  buffer_load_dwordx4 v[132:135], v7, s[68:71], s20 offen offset:16
  v_lshrrev_b32 v7, 2, v4
  v_lshlrev_b32 v11, 4, v7
  v_lshlrev_b32 v7, 3, v7
  v_and_b32 v8, 3, v4
  v_add_u32 v7, v7, v8
  v_and_b32 v8, 2, v4
  v_lshl_add_u32 v11, v8, 1, v11
  v_and_b32 v8, 1, v4
  v_add_u32 v11, v11, v8
  v_or_b32 v10, 0, v3
  v_xor_b32 v10, v10, v4
  v_lshlrev_b32 v10, 4, v10
  v_lshl_add_u32 v44, v11, 9, v10
  v_lshl_add_u32 v10, v7, 9, v10
  v_add_u32 v32, s25, v10
  v_or_b32 v10, 4, v3
  v_xor_b32 v10, v10, v4
  v_lshlrev_b32 v10, 4, v10
  v_lshl_add_u32 v45, v11, 9, v10
  v_lshl_add_u32 v10, v7, 9, v10
  v_add_u32 v33, s25, v10
  v_or_b32 v10, 8, v3
  v_xor_b32 v10, v10, v4
  v_lshlrev_b32 v10, 4, v10
  v_lshl_add_u32 v46, v11, 9, v10
  v_lshl_add_u32 v10, v7, 9, v10
  v_add_u32 v34, s25, v10
  v_or_b32 v10, 12, v3
  v_xor_b32 v10, v10, v4
  v_lshlrev_b32 v10, 4, v10
  v_lshl_add_u32 v47, v11, 9, v10
  v_lshl_add_u32 v10, v7, 9, v10
  v_add_u32 v35, s25, v10
  s_mul_i32 s30, s17, 401408
  s_mul_i32 s31, s18, 57344
  s_add_u32 s30, s30, s31
  s_add_u32 s30, s30, 0
  v_add_u32 v28, s30, v2
  s_add_u32 s30, s30, 14336
  v_add_u32 v29, s30, v2
  s_add_u32 s30, s30, 14336
  v_add_u32 v30, s30, v2
  s_add_u32 s30, s30, 14336
  v_add_u32 v31, s30, v2
  s_add_u32 s30, s30, 14336
  v_mov_b32 v48, 1035512379
  v_lshrrev_b32 v7, 2, v4
  v_lshl_add_u32 v7, v3, 3, v7
  v_lshlrev_b32 v7, 7, v7
  v_and_b32 v8, 3, v4
  v_lshl_add_u32 v7, v8, 3, v7
  v_lshrrev_b32 v8, 3, v4
  v_and_b32 v9, 1, v3
  v_lshl_add_u32 v8, v9, 1, v8
  v_lshl_add_u32 v40, v8, 5, v7
  s_mul_i32 s31, s17, 28
  s_mov_b32 s29, 401408
  s_lshl_b32 s30, s18, 6
  s_add_u32 s30, s30, 0
  v_add_u32 v8, s30, v4
  v_subrev_u32 v9, 256, v8
  v_mul_u32_u24 v11, 171, v9
  v_lshrrev_b32 v11, 11, v11
  v_mul_u32_u24 v38, 12, v11
  v_sub_u32 v38, v9, v38
  v_add_u32 v38, 16, v38
  v_lshrrev_b32 v10, 4, v8
  v_cmp_gt_i32 vcc, 0, v9
  s_nop 1
  v_cndmask_b32 v10, v11, v10, vcc
  v_cndmask_b32 v39, v38, v4, vcc
  v_add_u32 v39, s31, v39
  v_lshrrev_b32 v38, 4, v39
  v_and_b32 v39, 15, v39
  v_mul_lo_u32 v10, v10, s29
  v_mul_u32_u24 v38, 14336, v38
  v_add_u32 v10, v10, v38
  v_lshl_add_u32 v10, v3, 8, v10
  v_lshl_add_u32 v10, v39, 4, v10
  v_add_u32 v12, 6422528, v10
  v_xor_b32 v41, 32, v40
  s_lshl_b32 s30, s18, 6
  s_add_u32 s30, s30, 16
  v_add_u32 v8, s30, v4
  v_subrev_u32 v9, 256, v8
  v_mul_u32_u24 v11, 171, v9
  v_lshrrev_b32 v11, 11, v11
  v_mul_u32_u24 v38, 12, v11
  v_sub_u32 v38, v9, v38
  v_add_u32 v38, 16, v38
  v_lshrrev_b32 v10, 4, v8
  v_cmp_gt_i32 vcc, 0, v9
  s_nop 1
  v_cndmask_b32 v10, v11, v10, vcc
  v_cndmask_b32 v39, v38, v4, vcc
  v_add_u32 v39, s31, v39
  v_lshrrev_b32 v38, 4, v39
  v_and_b32 v39, 15, v39
  v_mul_lo_u32 v10, v10, s29
  v_mul_u32_u24 v38, 14336, v38
  v_add_u32 v10, v10, v38
  v_lshl_add_u32 v10, v3, 8, v10
  v_lshl_add_u32 v10, v39, 4, v10
  v_add_u32 v13, 6422528, v10
  v_xor_b32 v42, 64, v40
  s_lshl_b32 s30, s18, 6
  s_add_u32 s30, s30, 32
  v_add_u32 v8, s30, v4
  v_subrev_u32 v9, 256, v8
  v_mul_u32_u24 v11, 171, v9
  v_lshrrev_b32 v11, 11, v11
  v_mul_u32_u24 v38, 12, v11
  v_sub_u32 v38, v9, v38
  v_add_u32 v38, 16, v38
  v_lshrrev_b32 v10, 4, v8
  v_cmp_gt_i32 vcc, 0, v9
  s_nop 1
  v_cndmask_b32 v10, v11, v10, vcc
  v_cndmask_b32 v39, v38, v4, vcc
  v_add_u32 v39, s31, v39
  v_lshrrev_b32 v38, 4, v39
  v_and_b32 v39, 15, v39
  v_mul_lo_u32 v10, v10, s29
  v_mul_u32_u24 v38, 14336, v38
  v_add_u32 v10, v10, v38
  v_lshl_add_u32 v10, v3, 8, v10
  v_lshl_add_u32 v10, v39, 4, v10
  v_add_u32 v14, 6422528, v10
  v_xor_b32 v43, 96, v40
  s_lshl_b32 s30, s18, 6
  s_add_u32 s30, s30, 48
  v_add_u32 v8, s30, v4
  v_subrev_u32 v9, 256, v8
  v_mul_u32_u24 v11, 171, v9
  v_lshrrev_b32 v11, 11, v11
  v_mul_u32_u24 v38, 12, v11
  v_sub_u32 v38, v9, v38
  v_add_u32 v38, 16, v38
  v_lshrrev_b32 v10, 4, v8
  v_cmp_gt_i32 vcc, 0, v9
  s_nop 1
  v_cndmask_b32 v10, v11, v10, vcc
  v_cndmask_b32 v39, v38, v4, vcc
  v_add_u32 v39, s31, v39
  v_lshrrev_b32 v38, 4, v39
  v_and_b32 v39, 15, v39
  v_mul_lo_u32 v10, v10, s29
  v_mul_u32_u24 v38, 14336, v38
  v_add_u32 v10, v10, v38
  v_lshl_add_u32 v10, v3, 8, v10
  v_lshl_add_u32 v10, v39, 4, v10
  v_add_u32 v15, 6422528, v10
  s_cmp_eq_u32 s35, 0
  s_cselect_b32 s34, 1, s97
  s_mov_b32 s60, s44
  s_and_b32 s61, s45, 0xffff
  s_mov_b32 s62, 3670016
  s_mov_b32 s63, 0x20000
  s_mov_b32 s56, s46
  s_and_b32 s57, s47, 0xffff
  s_mov_b32 s58, 3670016
  s_mov_b32 s59, 0x20000
  s_mul_i32 s27, s17, 229376
  s_lshl_b32 s30, s18, 7
  s_add_u32 s27, s27, s30
  s_mul_i32 s30, s16, 57344
  s_add_u32 s27, s27, s30
  v_lshrrev_b32 v7, 3, v1
  v_and_b32 v8, 7, v1
  v_and_b32 v9, 2, v7
  v_xor_b32 v8, v8, v9
  v_mul_u32_u24 v7, 896, v7
  v_lshl_add_u32 v24, v8, 4, v7
  v_xor_b32 v25, 64, v24
  s_lshl_b32 s30, s16, 13
  s_add_u32 m0, s30, 0
  s_nop 0
  buffer_load_dwordx4 v24, s[56:59], s27 offen  lds
  s_add_u32 s27, s27, 7168
  s_add_u32 m0, s30, 1024
  s_nop 0
  buffer_load_dwordx4 v25, s[56:59], s27 offen  lds
  s_add_u32 s27, s27, 7168
  s_add_u32 m0, s30, 2048
  s_nop 0
  buffer_load_dwordx4 v24, s[56:59], s27 offen  lds
  s_add_u32 s27, s27, 7168
  s_add_u32 m0, s30, 3072
  s_nop 0
  buffer_load_dwordx4 v25, s[56:59], s27 offen  lds
  s_add_u32 s27, s27, 7168
  s_add_u32 m0, s30, 4096
  s_nop 0
  buffer_load_dwordx4 v24, s[56:59], s27 offen  lds
  s_add_u32 s27, s27, 7168
  s_add_u32 m0, s30, 5120
  s_nop 0
  buffer_load_dwordx4 v25, s[56:59], s27 offen  lds
  s_add_u32 s27, s27, 7168
  s_add_u32 m0, s30, 6144
  s_nop 0
  buffer_load_dwordx4 v24, s[56:59], s27 offen  lds
  s_add_u32 s27, s27, 7168
  s_add_u32 m0, s30, 7168
  s_nop 0
  buffer_load_dwordx4 v25, s[56:59], s27 offen  lds
  s_add_u32 s27, s27, 7168
  s_add_u32 s27, s28, 0
  s_min_u32 s27, s27, 13
  s_lshl_b32 s27, s27, 18
  s_add_u32 s27, s27, s26
  s_add_u32 m0, s25, 0
  s_nop 0
  buffer_load_dwordx4 v16, s[60:63], s27 offen  lds
  s_add_u32 s27, s27, 16384
  s_add_u32 m0, s25, 1024
  s_nop 0
  buffer_load_dwordx4 v17, s[60:63], s27 offen  lds
  s_add_u32 s27, s27, 16384
  s_add_u32 m0, s25, 2048
  s_nop 0
  buffer_load_dwordx4 v16, s[60:63], s27 offen  lds
  s_add_u32 s27, s27, 16384
  s_add_u32 m0, s25, 3072
  s_nop 0
  buffer_load_dwordx4 v17, s[60:63], s27 offen  lds
  s_add_u32 s27, s27, 16384
  s_add_u32 m0, s25, 4096
  s_nop 0
  buffer_load_dwordx4 v18, s[60:63], s27 offen  lds
  s_add_u32 s27, s27, 16384
  s_add_u32 m0, s25, 5120
  s_nop 0
  buffer_load_dwordx4 v19, s[60:63], s27 offen  lds
  s_add_u32 s27, s27, 16384
  s_add_u32 m0, s25, 6144
  s_nop 0
  buffer_load_dwordx4 v18, s[60:63], s27 offen  lds
  s_add_u32 s27, s27, 16384
  s_add_u32 m0, s25, 7168
  s_nop 0
  buffer_load_dwordx4 v19, s[60:63], s27 offen  lds
  s_add_u32 s27, s27, 16384
  s_add_u32 m0, s25, 8192
  s_nop 0
  buffer_load_dwordx4 v20, s[60:63], s27 offen  lds
  s_add_u32 s27, s27, 16384
  s_add_u32 m0, s25, 9216
  s_nop 0
  buffer_load_dwordx4 v21, s[60:63], s27 offen  lds
  s_add_u32 s27, s27, 16384
  s_add_u32 m0, s25, 10240
  s_nop 0
  buffer_load_dwordx4 v20, s[60:63], s27 offen  lds
  s_add_u32 s27, s27, 16384
  s_add_u32 m0, s25, 11264
  s_nop 0
  buffer_load_dwordx4 v21, s[60:63], s27 offen  lds
  s_add_u32 s27, s27, 16384
  s_add_u32 m0, s25, 12288
  s_nop 0
  buffer_load_dwordx4 v22, s[60:63], s27 offen  lds
  s_add_u32 s27, s27, 16384
  s_add_u32 m0, s25, 13312
  s_nop 0
  buffer_load_dwordx4 v23, s[60:63], s27 offen  lds
  s_add_u32 s27, s27, 16384
  s_add_u32 m0, s25, 14336
  s_nop 0
  buffer_load_dwordx4 v22, s[60:63], s27 offen  lds
  s_add_u32 s27, s27, 16384
  s_add_u32 m0, s25, 15360
  s_nop 0
  buffer_load_dwordx4 v23, s[60:63], s27 offen  lds
  s_add_u32 s27, s27, 16384
  s_add_u32 s27, s28, 4
  s_min_u32 s27, s27, 13
  s_lshl_b32 s27, s27, 18
  s_add_u32 s27, s27, s26
  s_add_u32 m0, s25, 16384
  s_nop 0
  buffer_load_dwordx4 v16, s[60:63], s27 offen  lds
  s_add_u32 s27, s27, 16384
  s_add_u32 m0, s25, 17408
  s_nop 0
  buffer_load_dwordx4 v17, s[60:63], s27 offen  lds
  s_add_u32 s27, s27, 16384
  s_add_u32 m0, s25, 18432
  s_nop 0
  buffer_load_dwordx4 v16, s[60:63], s27 offen  lds
  s_add_u32 s27, s27, 16384
  s_add_u32 m0, s25, 19456
  s_nop 0
  buffer_load_dwordx4 v17, s[60:63], s27 offen  lds
  s_add_u32 s27, s27, 16384
  s_add_u32 m0, s25, 20480
  s_nop 0
  buffer_load_dwordx4 v18, s[60:63], s27 offen  lds
  s_add_u32 s27, s27, 16384
  s_add_u32 m0, s25, 21504
  s_nop 0
  buffer_load_dwordx4 v19, s[60:63], s27 offen  lds
  s_add_u32 s27, s27, 16384
  s_add_u32 m0, s25, 22528
  s_nop 0
  buffer_load_dwordx4 v18, s[60:63], s27 offen  lds
  s_add_u32 s27, s27, 16384
  s_add_u32 m0, s25, 23552
  s_nop 0
  buffer_load_dwordx4 v19, s[60:63], s27 offen  lds
  s_add_u32 s27, s27, 16384
  s_add_u32 m0, s25, 24576
  s_nop 0
  buffer_load_dwordx4 v20, s[60:63], s27 offen  lds
  s_add_u32 s27, s27, 16384
  s_add_u32 m0, s25, 25600
  s_nop 0
  buffer_load_dwordx4 v21, s[60:63], s27 offen  lds
  s_add_u32 s27, s27, 16384
  s_add_u32 m0, s25, 26624
  s_nop 0
  buffer_load_dwordx4 v20, s[60:63], s27 offen  lds
  s_add_u32 s27, s27, 16384
  s_add_u32 m0, s25, 27648
  s_nop 0
  buffer_load_dwordx4 v21, s[60:63], s27 offen  lds
  s_add_u32 s27, s27, 16384
  s_add_u32 m0, s25, 28672
  s_nop 0
  buffer_load_dwordx4 v22, s[60:63], s27 offen  lds
  s_add_u32 s27, s27, 16384
  s_add_u32 m0, s25, 29696
  s_nop 0
  buffer_load_dwordx4 v23, s[60:63], s27 offen  lds
  s_add_u32 s27, s27, 16384
  s_add_u32 m0, s25, 30720
  s_nop 0
  buffer_load_dwordx4 v22, s[60:63], s27 offen  lds
  s_add_u32 s27, s27, 16384
  s_add_u32 m0, s25, 31744
  s_nop 0
  buffer_load_dwordx4 v23, s[60:63], s27 offen  lds
  s_add_u32 s27, s27, 16384
  s_mov_b32 s55, s27
  s_cmp_lt_u32 s19, 7
  s_cselect_b32 s64, s40, s42
  s_cselect_b32 s65, s41, s43
  s_cselect_b32 s27, 0, 7
  s_mov_b32 s68, s64
  s_and_b32 s69, s65, 0xffff
  s_mov_b32 s70, 3670016
  s_mov_b32 s71, 0x20000
  s_sub_u32 s31, s19, s27
  s_lshl_b32 s27, s31, 19
  s_add_u32 s27, s27, s26
  v_lshrrev_b32 v7, 2, v0
  v_and_b32 v8, 3, v0
  v_lshlrev_b32 v8, 7, v8
  v_lshl_add_u32 v9, v7, 13, v8
  s_cmp_lg_u32 s34, 0
  s_cselect_b32 s27, 0x40000000, s27
  buffer_load_dword v253, v9, s[68:71], s27 offen nt
  s_mov_b32 s27, s55
  s_lshl_b32 s29, s28, 10
  s_add_u32 s31, s29, 4096
  s_cmp_lt_u32 s28, 10
  s_cselect_b32 s31, s31, 0x40000000
  s_waitcnt vmcnt(1)
  s_barrier
  ds_read_b64_tr_b16 a[0:1], v40 offset:0
  ds_read_b64_tr_b16 a[2:3], v40 offset:512
  ds_read_b64_tr_b16 a[32:33], v41 offset:0
  ds_read_b64_tr_b16 a[34:35], v41 offset:512
  ds_read_b64_tr_b16 a[64:65], v42 offset:0
  ds_read_b64_tr_b16 a[66:67], v42 offset:512
  ds_read_b64_tr_b16 a[96:97], v43 offset:0
  ds_read_b64_tr_b16 a[98:99], v43 offset:512
  ds_read_b128 a[128:131], v32 offset:0
  ds_read_b128 a[160:163], v32 offset:2048
  ds_read_b128 a[192:195], v32 offset:16384
  ds_read_b128 a[224:227], v32 offset:18432
  v_lshlrev_b32 v144, 9, v3
  v_lshl_add_u32 v144, v4, 4, v144
  s_add_u32 s53, s52, 73859072
  s_add_u32 s52, s52, 72024064
  v_mov_b32 v136, v128
  v_mov_b32 v140, v129
  v_mov_b32 v137, v130
  v_mov_b32 v141, v131
  v_mov_b32 v138, v132
  v_mov_b32 v142, v133
  v_mov_b32 v139, v134
  v_mov_b32 v143, v135
  buffer_store_dwordx4 v[128:131], v144, s[8:11], s52 offen sc1
  buffer_store_dwordx4 v[132:135], v144, s[8:11], s52 offen offset:256 sc1
  buffer_store_dwordx4 v[136:139], v2, s[8:11], s53 offen sc1
  buffer_store_dwordx4 v[140:143], v2, s[8:11], s53 offen offset:1024 sc1
  s_waitcnt lgkmcnt(0)
  v_mfma_f32_16x16x32_bf16 v[64:67], a[128:131], a[0:3], 0
  ds_read_b64_tr_b16 a[4:5], v40 offset:4096
  ds_read_b64_tr_b16 a[6:7], v40 offset:4608
  v_mfma_f32_16x16x32_bf16 v[68:71], a[160:163], a[0:3], 0
  ds_read_b64_tr_b16 a[36:37], v41 offset:4096
  ds_read_b64_tr_b16 a[38:39], v41 offset:4608
  v_mfma_f32_16x16x32_bf16 v[72:75], a[128:131], a[32:35], 0
  ds_read_b64_tr_b16 a[68:69], v42 offset:4096
  ds_read_b64_tr_b16 a[70:71], v42 offset:4608
  v_mfma_f32_16x16x32_bf16 v[76:79], a[160:163], a[32:35], 0
  ds_read_b64_tr_b16 a[100:101], v43 offset:4096
  ds_read_b64_tr_b16 a[102:103], v43 offset:4608
  v_mfma_f32_16x16x32_bf16 v[80:83], a[128:131], a[64:67], 0
  ds_read_b128 a[132:135], v33 offset:0
  ds_read_b128 a[164:167], v33 offset:2048
  v_mfma_f32_16x16x32_bf16 v[84:87], a[160:163], a[64:67], 0
  ds_read_b128 a[196:199], v33 offset:16384
  ds_read_b128 a[228:231], v33 offset:18432
  v_mfma_f32_16x16x32_bf16 v[88:91], a[128:131], a[96:99], 0
  v_mfma_f32_16x16x32_bf16 v[92:95], a[160:163], a[96:99], 0
  v_mfma_f32_16x16x32_bf16 v[96:99], a[192:195], a[0:3], 0
  v_mfma_f32_16x16x32_bf16 v[100:103], a[224:227], a[0:3], 0
  v_mfma_f32_16x16x32_bf16 v[104:107], a[192:195], a[32:35], 0
  v_mfma_f32_16x16x32_bf16 v[108:111], a[224:227], a[32:35], 0
  v_mfma_f32_16x16x32_bf16 v[112:115], a[192:195], a[64:67], 0
  v_mfma_f32_16x16x32_bf16 v[116:119], a[224:227], a[64:67], 0
  v_mfma_f32_16x16x32_bf16 v[120:123], a[192:195], a[96:99], 0
  v_mfma_f32_16x16x32_bf16 v[124:127], a[224:227], a[96:99], 0
  s_waitcnt lgkmcnt(0)
  v_mfma_f32_16x16x32_bf16 v[64:67], a[132:135], a[4:7], v[64:67]
  ds_read_b64_tr_b16 a[8:9], v40 offset:8192
  ds_read_b64_tr_b16 a[10:11], v40 offset:8704
  v_mfma_f32_16x16x32_bf16 v[68:71], a[164:167], a[4:7], v[68:71]
  ds_read_b64_tr_b16 a[40:41], v41 offset:8192
  ds_read_b64_tr_b16 a[42:43], v41 offset:8704
  v_mfma_f32_16x16x32_bf16 v[72:75], a[132:135], a[36:39], v[72:75]
  ds_read_b64_tr_b16 a[72:73], v42 offset:8192
  ds_read_b64_tr_b16 a[74:75], v42 offset:8704
  v_mfma_f32_16x16x32_bf16 v[76:79], a[164:167], a[36:39], v[76:79]
  ds_read_b64_tr_b16 a[104:105], v43 offset:8192
  ds_read_b64_tr_b16 a[106:107], v43 offset:8704
  v_mfma_f32_16x16x32_bf16 v[80:83], a[132:135], a[68:71], v[80:83]
  ds_read_b128 a[136:139], v34 offset:0
  ds_read_b128 a[168:171], v34 offset:2048
  v_mfma_f32_16x16x32_bf16 v[84:87], a[164:167], a[68:71], v[84:87]
  ds_read_b128 a[200:203], v34 offset:16384
  ds_read_b128 a[232:235], v34 offset:18432
  v_mfma_f32_16x16x32_bf16 v[88:91], a[132:135], a[100:103], v[88:91]
  v_mfma_f32_16x16x32_bf16 v[92:95], a[164:167], a[100:103], v[92:95]
  v_mfma_f32_16x16x32_bf16 v[96:99], a[196:199], a[4:7], v[96:99]
  v_mfma_f32_16x16x32_bf16 v[100:103], a[228:231], a[4:7], v[100:103]
  v_mfma_f32_16x16x32_bf16 v[104:107], a[196:199], a[36:39], v[104:107]
  v_mfma_f32_16x16x32_bf16 v[108:111], a[228:231], a[36:39], v[108:111]
  v_mfma_f32_16x16x32_bf16 v[112:115], a[196:199], a[68:71], v[112:115]
  v_mfma_f32_16x16x32_bf16 v[116:119], a[228:231], a[68:71], v[116:119]
  v_mfma_f32_16x16x32_bf16 v[120:123], a[196:199], a[100:103], v[120:123]
  v_mfma_f32_16x16x32_bf16 v[124:127], a[228:231], a[100:103], v[124:127]
  s_waitcnt lgkmcnt(0)
  v_mfma_f32_16x16x32_bf16 v[64:67], a[136:139], a[8:11], v[64:67]
  ds_read_b64_tr_b16 a[12:13], v40 offset:12288
  ds_read_b64_tr_b16 a[14:15], v40 offset:12800
  v_mfma_f32_16x16x32_bf16 v[68:71], a[168:171], a[8:11], v[68:71]
  ds_read_b64_tr_b16 a[44:45], v41 offset:12288
  ds_read_b64_tr_b16 a[46:47], v41 offset:12800
  v_mfma_f32_16x16x32_bf16 v[72:75], a[136:139], a[40:43], v[72:75]
  ds_read_b64_tr_b16 a[76:77], v42 offset:12288
  ds_read_b64_tr_b16 a[78:79], v42 offset:12800
  v_mfma_f32_16x16x32_bf16 v[76:79], a[168:171], a[40:43], v[76:79]
  ds_read_b64_tr_b16 a[108:109], v43 offset:12288
  ds_read_b64_tr_b16 a[110:111], v43 offset:12800
  v_mfma_f32_16x16x32_bf16 v[80:83], a[136:139], a[72:75], v[80:83]
  ds_read_b128 a[140:143], v35 offset:0
  ds_read_b128 a[172:175], v35 offset:2048
  v_mfma_f32_16x16x32_bf16 v[84:87], a[168:171], a[72:75], v[84:87]
  ds_read_b128 a[204:207], v35 offset:16384
  ds_read_b128 a[236:239], v35 offset:18432
  v_mfma_f32_16x16x32_bf16 v[88:91], a[136:139], a[104:107], v[88:91]
  v_mfma_f32_16x16x32_bf16 v[92:95], a[168:171], a[104:107], v[92:95]
  v_mfma_f32_16x16x32_bf16 v[96:99], a[200:203], a[8:11], v[96:99]
  v_mfma_f32_16x16x32_bf16 v[100:103], a[232:235], a[8:11], v[100:103]
  v_mfma_f32_16x16x32_bf16 v[104:107], a[200:203], a[40:43], v[104:107]
  v_mfma_f32_16x16x32_bf16 v[108:111], a[232:235], a[40:43], v[108:111]
  v_mfma_f32_16x16x32_bf16 v[112:115], a[200:203], a[72:75], v[112:115]
  v_mfma_f32_16x16x32_bf16 v[116:119], a[232:235], a[72:75], v[116:119]
  v_mfma_f32_16x16x32_bf16 v[120:123], a[200:203], a[104:107], v[120:123]
  v_mfma_f32_16x16x32_bf16 v[124:127], a[232:235], a[104:107], v[124:127]
  s_waitcnt lgkmcnt(0)
  v_mfma_f32_16x16x32_bf16 v[64:67], a[140:143], a[12:15], v[64:67]
  ds_read_b64_tr_b16 a[16:17], v40 offset:16384
  ds_read_b64_tr_b16 a[18:19], v40 offset:16896
  v_mfma_f32_16x16x32_bf16 v[68:71], a[172:175], a[12:15], v[68:71]
  ds_read_b64_tr_b16 a[48:49], v41 offset:16384
  ds_read_b64_tr_b16 a[50:51], v41 offset:16896
  v_mfma_f32_16x16x32_bf16 v[72:75], a[140:143], a[44:47], v[72:75]
  ds_read_b64_tr_b16 a[80:81], v42 offset:16384
  ds_read_b64_tr_b16 a[82:83], v42 offset:16896
  v_mfma_f32_16x16x32_bf16 v[76:79], a[172:175], a[44:47], v[76:79]
  ds_read_b64_tr_b16 a[112:113], v43 offset:16384
  ds_read_b64_tr_b16 a[114:115], v43 offset:16896
  v_mfma_f32_16x16x32_bf16 v[80:83], a[140:143], a[76:79], v[80:83]
  ds_read_b128 a[144:147], v32 offset:256
  ds_read_b128 a[176:179], v32 offset:2304
  v_mfma_f32_16x16x32_bf16 v[84:87], a[172:175], a[76:79], v[84:87]
  ds_read_b128 a[208:211], v32 offset:16640
  ds_read_b128 a[240:243], v32 offset:18688
  v_mfma_f32_16x16x32_bf16 v[88:91], a[140:143], a[108:111], v[88:91]
  v_mfma_f32_16x16x32_bf16 v[92:95], a[172:175], a[108:111], v[92:95]
  v_mfma_f32_16x16x32_bf16 v[96:99], a[204:207], a[12:15], v[96:99]
  v_mfma_f32_16x16x32_bf16 v[100:103], a[236:239], a[12:15], v[100:103]
  v_mfma_f32_16x16x32_bf16 v[104:107], a[204:207], a[44:47], v[104:107]
  v_mfma_f32_16x16x32_bf16 v[108:111], a[236:239], a[44:47], v[108:111]
  v_mfma_f32_16x16x32_bf16 v[112:115], a[204:207], a[76:79], v[112:115]
  v_mfma_f32_16x16x32_bf16 v[116:119], a[236:239], a[76:79], v[116:119]
  v_mfma_f32_16x16x32_bf16 v[120:123], a[204:207], a[108:111], v[120:123]
  v_mfma_f32_16x16x32_bf16 v[124:127], a[236:239], a[108:111], v[124:127]
  s_waitcnt lgkmcnt(0)
  v_mfma_f32_16x16x32_bf16 v[64:67], a[144:147], a[16:19], v[64:67]
  ds_read_b64_tr_b16 a[20:21], v40 offset:20480
  ds_read_b64_tr_b16 a[22:23], v40 offset:20992
  v_mfma_f32_16x16x32_bf16 v[68:71], a[176:179], a[16:19], v[68:71]
  ds_read_b64_tr_b16 a[52:53], v41 offset:20480
  ds_read_b64_tr_b16 a[54:55], v41 offset:20992
  v_mfma_f32_16x16x32_bf16 v[72:75], a[144:147], a[48:51], v[72:75]
  ds_read_b64_tr_b16 a[84:85], v42 offset:20480
  ds_read_b64_tr_b16 a[86:87], v42 offset:20992
  v_mfma_f32_16x16x32_bf16 v[76:79], a[176:179], a[48:51], v[76:79]
  ds_read_b64_tr_b16 a[116:117], v43 offset:20480
  ds_read_b64_tr_b16 a[118:119], v43 offset:20992
  v_mfma_f32_16x16x32_bf16 v[80:83], a[144:147], a[80:83], v[80:83]
  ds_read_b128 a[148:151], v33 offset:256
  ds_read_b128 a[180:183], v33 offset:2304
  v_mfma_f32_16x16x32_bf16 v[84:87], a[176:179], a[80:83], v[84:87]
  ds_read_b128 a[212:215], v33 offset:16640
  ds_read_b128 a[244:247], v33 offset:18688
  v_mfma_f32_16x16x32_bf16 v[88:91], a[144:147], a[112:115], v[88:91]
  v_mfma_f32_16x16x32_bf16 v[92:95], a[176:179], a[112:115], v[92:95]
  v_mfma_f32_16x16x32_bf16 v[96:99], a[208:211], a[16:19], v[96:99]
  v_mfma_f32_16x16x32_bf16 v[100:103], a[240:243], a[16:19], v[100:103]
  v_mfma_f32_16x16x32_bf16 v[104:107], a[208:211], a[48:51], v[104:107]
  v_mfma_f32_16x16x32_bf16 v[108:111], a[240:243], a[48:51], v[108:111]
  v_mfma_f32_16x16x32_bf16 v[112:115], a[208:211], a[80:83], v[112:115]
  v_mfma_f32_16x16x32_bf16 v[116:119], a[240:243], a[80:83], v[116:119]
  v_mfma_f32_16x16x32_bf16 v[120:123], a[208:211], a[112:115], v[120:123]
  v_mfma_f32_16x16x32_bf16 v[124:127], a[240:243], a[112:115], v[124:127]
  s_waitcnt lgkmcnt(0)
  v_mfma_f32_16x16x32_bf16 v[64:67], a[148:151], a[20:23], v[64:67]
  ds_read_b64_tr_b16 a[24:25], v40 offset:24576
  ds_read_b64_tr_b16 a[26:27], v40 offset:25088
  v_mfma_f32_16x16x32_bf16 v[68:71], a[180:183], a[20:23], v[68:71]
  ds_read_b64_tr_b16 a[56:57], v41 offset:24576
  ds_read_b64_tr_b16 a[58:59], v41 offset:25088
  v_mfma_f32_16x16x32_bf16 v[72:75], a[148:151], a[52:55], v[72:75]
  ds_read_b64_tr_b16 a[88:89], v42 offset:24576
  ds_read_b64_tr_b16 a[90:91], v42 offset:25088
  v_mfma_f32_16x16x32_bf16 v[76:79], a[180:183], a[52:55], v[76:79]
  ds_read_b64_tr_b16 a[120:121], v43 offset:24576
  ds_read_b64_tr_b16 a[122:123], v43 offset:25088
  v_mfma_f32_16x16x32_bf16 v[80:83], a[148:151], a[84:87], v[80:83]
  ds_read_b128 a[152:155], v34 offset:256
  ds_read_b128 a[184:187], v34 offset:2304
  v_mfma_f32_16x16x32_bf16 v[84:87], a[180:183], a[84:87], v[84:87]
  ds_read_b128 a[216:219], v34 offset:16640
  ds_read_b128 a[248:251], v34 offset:18688
  v_mfma_f32_16x16x32_bf16 v[88:91], a[148:151], a[116:119], v[88:91]
  v_mfma_f32_16x16x32_bf16 v[92:95], a[180:183], a[116:119], v[92:95]
  v_mfma_f32_16x16x32_bf16 v[96:99], a[212:215], a[20:23], v[96:99]
  v_mfma_f32_16x16x32_bf16 v[100:103], a[244:247], a[20:23], v[100:103]
  v_mfma_f32_16x16x32_bf16 v[104:107], a[212:215], a[52:55], v[104:107]
  v_mfma_f32_16x16x32_bf16 v[108:111], a[244:247], a[52:55], v[108:111]
  v_mfma_f32_16x16x32_bf16 v[112:115], a[212:215], a[84:87], v[112:115]
  v_mfma_f32_16x16x32_bf16 v[116:119], a[244:247], a[84:87], v[116:119]
  v_mfma_f32_16x16x32_bf16 v[120:123], a[212:215], a[116:119], v[120:123]
  v_mfma_f32_16x16x32_bf16 v[124:127], a[244:247], a[116:119], v[124:127]
  s_waitcnt lgkmcnt(0)
  v_mfma_f32_16x16x32_bf16 v[64:67], a[152:155], a[24:27], v[64:67]
  ds_read_b64_tr_b16 a[28:29], v40 offset:28672
  ds_read_b64_tr_b16 a[30:31], v40 offset:29184
  v_mfma_f32_16x16x32_bf16 v[68:71], a[184:187], a[24:27], v[68:71]
  ds_read_b64_tr_b16 a[60:61], v41 offset:28672
  ds_read_b64_tr_b16 a[62:63], v41 offset:29184
  v_mfma_f32_16x16x32_bf16 v[72:75], a[152:155], a[56:59], v[72:75]
  ds_read_b64_tr_b16 a[92:93], v42 offset:28672
  ds_read_b64_tr_b16 a[94:95], v42 offset:29184
  v_mfma_f32_16x16x32_bf16 v[76:79], a[184:187], a[56:59], v[76:79]
  ds_read_b64_tr_b16 a[124:125], v43 offset:28672
  ds_read_b64_tr_b16 a[126:127], v43 offset:29184
  v_mfma_f32_16x16x32_bf16 v[80:83], a[152:155], a[88:91], v[80:83]
  ds_read_b128 a[156:159], v35 offset:256
  ds_read_b128 a[188:191], v35 offset:2304
  v_mfma_f32_16x16x32_bf16 v[84:87], a[184:187], a[88:91], v[84:87]
  ds_read_b128 a[220:223], v35 offset:16640
  ds_read_b128 a[252:255], v35 offset:18688
  v_mfma_f32_16x16x32_bf16 v[88:91], a[152:155], a[120:123], v[88:91]
  v_mfma_f32_16x16x32_bf16 v[92:95], a[184:187], a[120:123], v[92:95]
  v_mfma_f32_16x16x32_bf16 v[96:99], a[216:219], a[24:27], v[96:99]
  v_mfma_f32_16x16x32_bf16 v[100:103], a[248:251], a[24:27], v[100:103]
  v_mfma_f32_16x16x32_bf16 v[104:107], a[216:219], a[56:59], v[104:107]
  v_mfma_f32_16x16x32_bf16 v[108:111], a[248:251], a[56:59], v[108:111]
  v_mfma_f32_16x16x32_bf16 v[112:115], a[216:219], a[88:91], v[112:115]
  v_mfma_f32_16x16x32_bf16 v[116:119], a[248:251], a[88:91], v[116:119]
  v_mfma_f32_16x16x32_bf16 v[120:123], a[216:219], a[120:123], v[120:123]
  v_mfma_f32_16x16x32_bf16 v[124:127], a[248:251], a[120:123], v[124:127]
  s_waitcnt lgkmcnt(0)
  s_barrier
  buffer_load_dwordx2 v[254:255], v252, s[12:15], 0 offen offset:128 sc1
  v_mfma_f32_16x16x32_bf16 v[64:67], a[156:159], a[28:31], v[64:67]
  v_mfma_f32_16x16x32_bf16 v[68:71], a[188:191], a[28:31], v[68:71]
  v_mfma_f32_16x16x32_bf16 v[72:75], a[156:159], a[60:63], v[72:75]
  v_mfma_f32_16x16x32_bf16 v[76:79], a[188:191], a[60:63], v[76:79]
  v_mfma_f32_16x16x32_bf16 v[80:83], a[156:159], a[92:95], v[80:83]
  v_cvt_pk_bf16_f32 v64, v64, v65
  v_cvt_pk_bf16_f32 v65, v66, v67
  v_mfma_f32_16x16x32_bf16 v[84:87], a[188:191], a[92:95], v[84:87]
  v_cvt_pk_bf16_f32 v66, v68, v69
  v_cvt_pk_bf16_f32 v67, v70, v71
  v_mfma_f32_16x16x32_bf16 v[88:91], a[156:159], a[124:127], v[88:91]
  buffer_store_dwordx4 v[64:67], v12, s[8:11], s29 offen sc1
  v_cvt_pk_bf16_f32 v72, v72, v73
  v_mfma_f32_16x16x32_bf16 v[92:95], a[188:191], a[124:127], v[92:95]
  v_cvt_pk_bf16_f32 v73, v74, v75
  v_cvt_pk_bf16_f32 v74, v76, v77
  v_mfma_f32_16x16x32_bf16 v[96:99], a[220:223], a[28:31], v[96:99]
  v_cvt_pk_bf16_f32 v75, v78, v79
  buffer_store_dwordx4 v[72:75], v13, s[8:11], s29 offen sc1
  v_mfma_f32_16x16x32_bf16 v[100:103], a[252:255], a[28:31], v[100:103]
  v_cvt_pk_bf16_f32 v80, v80, v81
  v_cvt_pk_bf16_f32 v81, v82, v83
  v_mfma_f32_16x16x32_bf16 v[104:107], a[220:223], a[60:63], v[104:107]
  v_cvt_pk_bf16_f32 v82, v84, v85
  v_cvt_pk_bf16_f32 v83, v86, v87
  v_mfma_f32_16x16x32_bf16 v[108:111], a[252:255], a[60:63], v[108:111]
  buffer_store_dwordx4 v[80:83], v14, s[8:11], s29 offen sc1
  v_cvt_pk_bf16_f32 v88, v88, v89
  v_mfma_f32_16x16x32_bf16 v[112:115], a[220:223], a[92:95], v[112:115]
  v_cvt_pk_bf16_f32 v89, v90, v91
  v_cvt_pk_bf16_f32 v90, v92, v93
  v_mfma_f32_16x16x32_bf16 v[116:119], a[252:255], a[92:95], v[116:119]
  v_cvt_pk_bf16_f32 v91, v94, v95
  buffer_store_dwordx4 v[88:91], v15, s[8:11], s29 offen sc1
  v_mfma_f32_16x16x32_bf16 v[120:123], a[220:223], a[124:127], v[120:123]
  v_cvt_pk_bf16_f32 v96, v96, v97
  v_cvt_pk_bf16_f32 v97, v98, v99
  v_mfma_f32_16x16x32_bf16 v[124:127], a[252:255], a[124:127], v[124:127]
  v_cvt_pk_bf16_f32 v98, v100, v101
  v_cvt_pk_bf16_f32 v99, v102, v103
  buffer_store_dwordx4 v[96:99], v12, s[8:11], s31 offen sc1
  v_cvt_pk_bf16_f32 v104, v104, v105
  v_cvt_pk_bf16_f32 v105, v106, v107
  v_cvt_pk_bf16_f32 v106, v108, v109
  v_cvt_pk_bf16_f32 v107, v110, v111
  buffer_store_dwordx4 v[104:107], v13, s[8:11], s31 offen sc1
  v_cvt_pk_bf16_f32 v112, v112, v113
  v_cvt_pk_bf16_f32 v113, v114, v115
  v_cvt_pk_bf16_f32 v114, v116, v117
  v_cvt_pk_bf16_f32 v115, v118, v119
  buffer_store_dwordx4 v[112:115], v14, s[8:11], s31 offen sc1
  v_cvt_pk_bf16_f32 v120, v120, v121
  v_cvt_pk_bf16_f32 v121, v122, v123
  v_cvt_pk_bf16_f32 v122, v124, v125
  v_cvt_pk_bf16_f32 v123, v126, v127
  buffer_store_dwordx4 v[120:123], v15, s[8:11], s31 offen sc1
  s_cmp_lg_u32 s34, 0
  s_cbranch_scc1 wp_B2
  s_mov_b32 s60, s40
  s_and_b32 s61, s41, 0xffff
  s_mov_b32 s62, 3670016
  s_mov_b32 s63, 0x20000
  s_mov_b32 s56, s42
  s_and_b32 s57, s43, 0xffff
  s_mov_b32 s58, 3670016
  s_mov_b32 s59, 0x20000
  s_lshl_b32 s27, s18, 2
  s_add_u32 s27, s27, s16
  s_lshl_b32 s27, s27, 17
  s_add_u32 s27, s27, s26
  s_lshl_b32 s30, s16, 13
  s_add_u32 m0, s30, 0
  s_nop 0
  buffer_load_dwordx4 v26, s[56:59], s27 offen  lds
  s_add_u32 s27, s27, 16384
  s_add_u32 m0, s30, 1024
  s_nop 0
  buffer_load_dwordx4 v26, s[56:59], s27 offen  lds
  s_add_u32 s27, s27, 16384
  s_add_u32 m0, s30, 2048
  s_nop 0
  buffer_load_dwordx4 v27, s[56:59], s27 offen  lds
  s_add_u32 s27, s27, 16384
  s_add_u32 m0, s30, 3072
  s_nop 0
  buffer_load_dwordx4 v27, s[56:59], s27 offen  lds
  s_add_u32 s27, s27, 16384
  s_add_u32 m0, s30, 4096
  s_nop 0
  buffer_load_dwordx4 v26, s[56:59], s27 offen  lds
  s_add_u32 s27, s27, 16384
  s_add_u32 m0, s30, 5120
  s_nop 0
  buffer_load_dwordx4 v26, s[56:59], s27 offen  lds
  s_add_u32 s27, s27, 16384
  s_add_u32 m0, s30, 6144
  s_nop 0
  buffer_load_dwordx4 v27, s[56:59], s27 offen  lds
  s_add_u32 s27, s27, 16384
  s_add_u32 m0, s30, 7168
  s_nop 0
  buffer_load_dwordx4 v27, s[56:59], s27 offen  lds
  s_add_u32 s27, s27, 16384
  s_add_u32 s27, s28, 0
  s_min_u32 s27, s27, 13
  s_lshl_b32 s27, s27, 18
  s_add_u32 s27, s27, s26
  s_add_u32 m0, s25, 0
  s_nop 0
  buffer_load_dwordx4 v16, s[60:63], s27 offen  lds
  s_add_u32 s27, s27, 16384
  s_add_u32 m0, s25, 1024
  s_nop 0
  buffer_load_dwordx4 v17, s[60:63], s27 offen  lds
  s_add_u32 s27, s27, 16384
  s_add_u32 m0, s25, 2048
  s_nop 0
  buffer_load_dwordx4 v16, s[60:63], s27 offen  lds
  s_add_u32 s27, s27, 16384
  s_add_u32 m0, s25, 3072
  s_nop 0
  buffer_load_dwordx4 v17, s[60:63], s27 offen  lds
  s_add_u32 s27, s27, 16384
  s_waitcnt vmcnt(12)
  s_barrier
  s_cmp_lg_u32 s16, 0
  s_cbranch_scc1 wp_f1_f
  v_readfirstlane_b32 s20, v254
  s_cmp_eq_u32 s20, 1
  s_cbranch_scc1 wp_f1_w_ok
  s_mov_b32 s30, 0
wp_f1_w:
  buffer_load_dword v254, off, s[12:15], 0 offset:128 sc1
  s_waitcnt vmcnt(0)
  v_cmp_ne_u32 vcc, 1, v254
  s_cbranch_vccz wp_f1_w_ok
  s_sleep 8
  s_add_u32 s30, s30, 1
  s_cmp_lt_u32 s30, 16
  s_cbranch_scc1 wp_f1_w
  s_branch wp_f1_f
wp_f1_w_ok:
  s_lshl_b32 s20, s17, 7
  s_add_u32 s20, s20, 88519168
  s_lshl_b32 s21, 1, s19
  v_mov_b32 v248, s21
  s_mov_b64 exec, 1
  buffer_atomic_or v248, v252, s[8:11], s20 offen sc0
  s_mov_b64 exec, -1
  s_mov_b32 s37, s21
wp_f1_f:
  s_add_u32 m0, s25, 4096
  s_nop 0
  buffer_load_dwordx4 v18, s[60:63], s27 offen  lds
  s_add_u32 s27, s27, 16384
  s_add_u32 m0, s25, 5120
  s_nop 0
  buffer_load_dwordx4 v19, s[60:63], s27 offen  lds
  s_add_u32 s27, s27, 16384
  s_add_u32 m0, s25, 6144
  s_nop 0
  buffer_load_dwordx4 v18, s[60:63], s27 offen  lds
  s_add_u32 s27, s27, 16384
  s_add_u32 m0, s25, 7168
  s_nop 0
  buffer_load_dwordx4 v19, s[60:63], s27 offen  lds
  s_add_u32 s27, s27, 16384
  s_add_u32 m0, s25, 8192
  s_nop 0
  buffer_load_dwordx4 v20, s[60:63], s27 offen  lds
  s_add_u32 s27, s27, 16384
  s_add_u32 m0, s25, 9216
  s_nop 0
  buffer_load_dwordx4 v21, s[60:63], s27 offen  lds
  s_add_u32 s27, s27, 16384
  s_add_u32 m0, s25, 10240
  s_nop 0
  buffer_load_dwordx4 v20, s[60:63], s27 offen  lds
  s_add_u32 s27, s27, 16384
  s_add_u32 m0, s25, 11264
  s_nop 0
  buffer_load_dwordx4 v21, s[60:63], s27 offen  lds
  s_add_u32 s27, s27, 16384
  s_add_u32 m0, s25, 12288
  s_nop 0
  buffer_load_dwordx4 v22, s[60:63], s27 offen  lds
  s_add_u32 s27, s27, 16384
  s_add_u32 m0, s25, 13312
  s_nop 0
  buffer_load_dwordx4 v23, s[60:63], s27 offen  lds
  s_add_u32 s27, s27, 16384
  s_add_u32 m0, s25, 14336
  s_nop 0
  buffer_load_dwordx4 v22, s[60:63], s27 offen  lds
  s_add_u32 s27, s27, 16384
  s_add_u32 m0, s25, 15360
  s_nop 0
  buffer_load_dwordx4 v23, s[60:63], s27 offen  lds
  s_add_u32 s27, s27, 16384
  s_add_u32 s27, s28, 4
  s_min_u32 s27, s27, 13
  s_lshl_b32 s27, s27, 18
  s_add_u32 s27, s27, s26
  s_add_u32 m0, s25, 16384
  s_nop 0
  buffer_load_dwordx4 v16, s[60:63], s27 offen  lds
  s_add_u32 s27, s27, 16384
  s_add_u32 m0, s25, 17408
  s_nop 0
  buffer_load_dwordx4 v17, s[60:63], s27 offen  lds
  s_add_u32 s27, s27, 16384
  s_add_u32 m0, s25, 18432
  s_nop 0
  buffer_load_dwordx4 v16, s[60:63], s27 offen  lds
  s_add_u32 s27, s27, 16384
  s_add_u32 m0, s25, 19456
  s_nop 0
  buffer_load_dwordx4 v17, s[60:63], s27 offen  lds
  s_add_u32 s27, s27, 16384
  s_add_u32 m0, s25, 20480
  s_nop 0
  buffer_load_dwordx4 v18, s[60:63], s27 offen  lds
  s_add_u32 s27, s27, 16384
  s_add_u32 m0, s25, 21504
  s_nop 0
  buffer_load_dwordx4 v19, s[60:63], s27 offen  lds
  s_add_u32 s27, s27, 16384
  s_add_u32 m0, s25, 22528
  s_nop 0
  buffer_load_dwordx4 v18, s[60:63], s27 offen  lds
  s_add_u32 s27, s27, 16384
  s_add_u32 m0, s25, 23552
  s_nop 0
  buffer_load_dwordx4 v19, s[60:63], s27 offen  lds
  s_add_u32 s27, s27, 16384
  s_add_u32 m0, s25, 24576
  s_nop 0
  buffer_load_dwordx4 v20, s[60:63], s27 offen  lds
  s_add_u32 s27, s27, 16384
  s_add_u32 m0, s25, 25600
  s_nop 0
  buffer_load_dwordx4 v21, s[60:63], s27 offen  lds
  s_add_u32 s27, s27, 16384
  s_add_u32 m0, s25, 26624
  s_nop 0
  buffer_load_dwordx4 v20, s[60:63], s27 offen  lds
  s_add_u32 s27, s27, 16384
  s_add_u32 m0, s25, 27648
  s_nop 0
  buffer_load_dwordx4 v21, s[60:63], s27 offen  lds
  s_add_u32 s27, s27, 16384
  s_add_u32 m0, s25, 28672
  s_nop 0
  buffer_load_dwordx4 v22, s[60:63], s27 offen  lds
  s_add_u32 s27, s27, 16384
  s_add_u32 m0, s25, 29696
  s_nop 0
  buffer_load_dwordx4 v23, s[60:63], s27 offen  lds
  s_add_u32 s27, s27, 16384
  s_add_u32 m0, s25, 30720
  s_nop 0
  buffer_load_dwordx4 v22, s[60:63], s27 offen  lds
  s_add_u32 s27, s27, 16384
  s_add_u32 m0, s25, 31744
  s_nop 0
  buffer_load_dwordx4 v23, s[60:63], s27 offen  lds
  s_add_u32 s27, s27, 16384
  s_branch wp_A
wp_B2:
  s_waitcnt vmcnt(0)
  s_barrier
  s_cmp_lg_u32 s16, 0
  s_cbranch_scc1 wp_f2_f
  v_readfirstlane_b32 s20, v254
  s_cmp_eq_u32 s20, 1
  s_cbranch_scc1 wp_f2_w_ok
  s_mov_b32 s30, 0
wp_f2_w:
  buffer_load_dword v254, off, s[12:15], 0 offset:128 sc1
  s_waitcnt vmcnt(0)
  v_cmp_ne_u32 vcc, 1, v254
  s_cbranch_vccz wp_f2_w_ok
  s_sleep 8
  s_add_u32 s30, s30, 1
  s_cmp_lt_u32 s30, 16
  s_cbranch_scc1 wp_f2_w
  s_branch wp_f2_f
wp_f2_w_ok:
  s_lshl_b32 s20, s17, 7
  s_add_u32 s20, s20, 88519168
  s_lshl_b32 s21, 1, s19
  v_mov_b32 v248, s21
  s_mov_b64 exec, 1
  buffer_atomic_or v248, v252, s[8:11], s20 offen sc0
  s_mov_b64 exec, -1
  s_mov_b32 s37, s21
wp_f2_f:
  s_waitcnt vmcnt(0)
  v_readfirstlane_b32 s20, v248
  s_xor_b32 s20, s20, s37
  s_cmp_lg_u32 s20, 0x3fff
  s_cselect_b32 s20, 0, s37
  s_mov_b32 s37, 0
  s_cmp_eq_u32 s20, 0
  s_cbranch_scc1 wp_g2
  s_lshl_b32 s21, 1, s17
  v_mov_b32 v248, s21
  s_mov_b32 s20, 88523264
  s_mov_b64 exec, 1
  buffer_atomic_or v248, v252, s[8:11], s20 offen
  s_mov_b64 exec, -1
wp_g2:
  s_cmp_lg_u32 s97, 0
  s_cbranch_scc1 wp_rep
  s_branch wp_ini2
wp_A0:
  s_mov_b32 s60, s40
  s_and_b32 s61, s41, 0xffff
  s_mov_b32 s62, 3670016
  s_mov_b32 s63, 0x20000
  s_mov_b32 s56, s42
  s_and_b32 s57, s43, 0xffff
  s_mov_b32 s58, 3670016
  s_mov_b32 s59, 0x20000
  s_lshl_b32 s27, s18, 2
  s_add_u32 s27, s27, s16
  s_lshl_b32 s27, s27, 17
  s_add_u32 s27, s27, s26
  s_lshl_b32 s30, s16, 13
  s_add_u32 m0, s30, 0
  s_nop 0
  buffer_load_dwordx4 v26, s[56:59], s27 offen  lds
  s_add_u32 s27, s27, 16384
  s_add_u32 m0, s30, 1024
  s_nop 0
  buffer_load_dwordx4 v26, s[56:59], s27 offen  lds
  s_add_u32 s27, s27, 16384
  s_add_u32 m0, s30, 2048
  s_nop 0
  buffer_load_dwordx4 v27, s[56:59], s27 offen  lds
  s_add_u32 s27, s27, 16384
  s_add_u32 m0, s30, 3072
  s_nop 0
  buffer_load_dwordx4 v27, s[56:59], s27 offen  lds
  s_add_u32 s27, s27, 16384
  s_add_u32 m0, s30, 4096
  s_nop 0
  buffer_load_dwordx4 v26, s[56:59], s27 offen  lds
  s_add_u32 s27, s27, 16384
  s_add_u32 m0, s30, 5120
  s_nop 0
  buffer_load_dwordx4 v26, s[56:59], s27 offen  lds
  s_add_u32 s27, s27, 16384
  s_add_u32 m0, s30, 6144
  s_nop 0
  buffer_load_dwordx4 v27, s[56:59], s27 offen  lds
  s_add_u32 s27, s27, 16384
  s_add_u32 m0, s30, 7168
  s_nop 0
  buffer_load_dwordx4 v27, s[56:59], s27 offen  lds
  s_add_u32 s27, s27, 16384
  s_add_u32 s27, s28, 0
  s_min_u32 s27, s27, 13
  s_lshl_b32 s27, s27, 18
  s_add_u32 s27, s27, s26
  s_add_u32 m0, s25, 0
  s_nop 0
  buffer_load_dwordx4 v16, s[60:63], s27 offen  lds
  s_add_u32 s27, s27, 16384
  s_add_u32 m0, s25, 1024
  s_nop 0
  buffer_load_dwordx4 v17, s[60:63], s27 offen  lds
  s_add_u32 s27, s27, 16384
  s_add_u32 m0, s25, 2048
  s_nop 0
  buffer_load_dwordx4 v16, s[60:63], s27 offen  lds
  s_add_u32 s27, s27, 16384
  s_add_u32 m0, s25, 3072
  s_nop 0
  buffer_load_dwordx4 v17, s[60:63], s27 offen  lds
  s_add_u32 s27, s27, 16384
  s_add_u32 m0, s25, 4096
  s_nop 0
  buffer_load_dwordx4 v18, s[60:63], s27 offen  lds
  s_add_u32 s27, s27, 16384
  s_add_u32 m0, s25, 5120
  s_nop 0
  buffer_load_dwordx4 v19, s[60:63], s27 offen  lds
  s_add_u32 s27, s27, 16384
  s_add_u32 m0, s25, 6144
  s_nop 0
  buffer_load_dwordx4 v18, s[60:63], s27 offen  lds
  s_add_u32 s27, s27, 16384
  s_add_u32 m0, s25, 7168
  s_nop 0
  buffer_load_dwordx4 v19, s[60:63], s27 offen  lds
  s_add_u32 s27, s27, 16384
  s_add_u32 m0, s25, 8192
  s_nop 0
  buffer_load_dwordx4 v20, s[60:63], s27 offen  lds
  s_add_u32 s27, s27, 16384
  s_add_u32 m0, s25, 9216
  s_nop 0
  buffer_load_dwordx4 v21, s[60:63], s27 offen  lds
  s_add_u32 s27, s27, 16384
  s_add_u32 m0, s25, 10240
  s_nop 0
  buffer_load_dwordx4 v20, s[60:63], s27 offen  lds
  s_add_u32 s27, s27, 16384
  s_add_u32 m0, s25, 11264
  s_nop 0
  buffer_load_dwordx4 v21, s[60:63], s27 offen  lds
  s_add_u32 s27, s27, 16384
  s_add_u32 m0, s25, 12288
  s_nop 0
  buffer_load_dwordx4 v22, s[60:63], s27 offen  lds
  s_add_u32 s27, s27, 16384
  s_add_u32 m0, s25, 13312
  s_nop 0
  buffer_load_dwordx4 v23, s[60:63], s27 offen  lds
  s_add_u32 s27, s27, 16384
  s_add_u32 m0, s25, 14336
  s_nop 0
  buffer_load_dwordx4 v22, s[60:63], s27 offen  lds
  s_add_u32 s27, s27, 16384
  s_add_u32 m0, s25, 15360
  s_nop 0
  buffer_load_dwordx4 v23, s[60:63], s27 offen  lds
  s_add_u32 s27, s27, 16384
  s_add_u32 s27, s28, 4
  s_min_u32 s27, s27, 13
  s_lshl_b32 s27, s27, 18
  s_add_u32 s27, s27, s26
  s_add_u32 m0, s25, 16384
  s_nop 0
  buffer_load_dwordx4 v16, s[60:63], s27 offen  lds
  s_add_u32 s27, s27, 16384
  s_add_u32 m0, s25, 17408
  s_nop 0
  buffer_load_dwordx4 v17, s[60:63], s27 offen  lds
  s_add_u32 s27, s27, 16384
  s_add_u32 m0, s25, 18432
  s_nop 0
  buffer_load_dwordx4 v16, s[60:63], s27 offen  lds
  s_add_u32 s27, s27, 16384
  s_add_u32 m0, s25, 19456
  s_nop 0
  buffer_load_dwordx4 v17, s[60:63], s27 offen  lds
  s_add_u32 s27, s27, 16384
  s_add_u32 m0, s25, 20480
  s_nop 0
  buffer_load_dwordx4 v18, s[60:63], s27 offen  lds
  s_add_u32 s27, s27, 16384
  s_add_u32 m0, s25, 21504
  s_nop 0
  buffer_load_dwordx4 v19, s[60:63], s27 offen  lds
  s_add_u32 s27, s27, 16384
  s_add_u32 m0, s25, 22528
  s_nop 0
  buffer_load_dwordx4 v18, s[60:63], s27 offen  lds
  s_add_u32 s27, s27, 16384
  s_add_u32 m0, s25, 23552
  s_nop 0
  buffer_load_dwordx4 v19, s[60:63], s27 offen  lds
  s_add_u32 s27, s27, 16384
  s_add_u32 m0, s25, 24576
  s_nop 0
  buffer_load_dwordx4 v20, s[60:63], s27 offen  lds
  s_add_u32 s27, s27, 16384
  s_add_u32 m0, s25, 25600
  s_nop 0
  buffer_load_dwordx4 v21, s[60:63], s27 offen  lds
  s_add_u32 s27, s27, 16384
  s_add_u32 m0, s25, 26624
  s_nop 0
  buffer_load_dwordx4 v20, s[60:63], s27 offen  lds
  s_add_u32 s27, s27, 16384
  s_add_u32 m0, s25, 27648
  s_nop 0
  buffer_load_dwordx4 v21, s[60:63], s27 offen  lds
  s_add_u32 s27, s27, 16384
  s_add_u32 m0, s25, 28672
  s_nop 0
  buffer_load_dwordx4 v22, s[60:63], s27 offen  lds
  s_add_u32 s27, s27, 16384
  s_add_u32 m0, s25, 29696
  s_nop 0
  buffer_load_dwordx4 v23, s[60:63], s27 offen  lds
  s_add_u32 s27, s27, 16384
  s_add_u32 m0, s25, 30720
  s_nop 0
  buffer_load_dwordx4 v22, s[60:63], s27 offen  lds
  s_add_u32 s27, s27, 16384
  s_add_u32 m0, s25, 31744
  s_nop 0
  buffer_load_dwordx4 v23, s[60:63], s27 offen  lds
  s_add_u32 s27, s27, 16384
  v_lshrrev_b32 v7, 2, v4
  v_lshlrev_b32 v11, 4, v7
  v_lshlrev_b32 v7, 3, v7
  v_and_b32 v8, 3, v4
  v_add_u32 v7, v7, v8
  v_and_b32 v8, 2, v4
  v_lshl_add_u32 v11, v8, 1, v11
  v_and_b32 v8, 1, v4
  v_add_u32 v11, v11, v8
  v_or_b32 v10, 0, v3
  v_xor_b32 v10, v10, v4
  v_lshlrev_b32 v10, 4, v10
  v_lshl_add_u32 v44, v11, 9, v10
  v_lshl_add_u32 v10, v7, 9, v10
  v_add_u32 v32, s25, v10
  v_or_b32 v10, 4, v3
  v_xor_b32 v10, v10, v4
  v_lshlrev_b32 v10, 4, v10
  v_lshl_add_u32 v45, v11, 9, v10
  v_lshl_add_u32 v10, v7, 9, v10
  v_add_u32 v33, s25, v10
  v_or_b32 v10, 8, v3
  v_xor_b32 v10, v10, v4
  v_lshlrev_b32 v10, 4, v10
  v_lshl_add_u32 v46, v11, 9, v10
  v_lshl_add_u32 v10, v7, 9, v10
  v_add_u32 v34, s25, v10
  v_or_b32 v10, 12, v3
  v_xor_b32 v10, v10, v4
  v_lshlrev_b32 v10, 4, v10
  v_lshl_add_u32 v47, v11, 9, v10
  v_lshl_add_u32 v10, v7, 9, v10
  v_add_u32 v35, s25, v10
  s_mul_i32 s30, s17, 401408
  s_mul_i32 s31, s18, 57344
  s_add_u32 s30, s30, s31
  s_add_u32 s30, s30, 0
  v_add_u32 v28, s30, v2
  s_add_u32 s30, s30, 14336
  v_add_u32 v29, s30, v2
  s_add_u32 s30, s30, 14336
  v_add_u32 v30, s30, v2
  s_add_u32 s30, s30, 14336
  v_add_u32 v31, s30, v2
  s_add_u32 s30, s30, 14336
  v_mov_b32 v48, 1035512379
wp_A:
  s_lshl_b32 s29, s28, 10
  s_add_u32 s31, s29, 4096
  s_cmp_lt_u32 s28, 10
  s_cselect_b32 s31, s31, 0x40000000
  s_waitcnt vmcnt(0)
  s_barrier
  ds_read_b128 a[0:3], v44 offset:0
  ds_read_b128 a[32:35], v44 offset:1024
  ds_read_b128 a[64:67], v44 offset:4096
  ds_read_b128 a[96:99], v44 offset:5120
  ds_read_b128 a[128:131], v32 offset:0
  ds_read_b128 a[160:163], v32 offset:2048
  ds_read_b128 a[192:195], v32 offset:16384
  ds_read_b128 a[224:227], v32 offset:18432
  v_readfirstlane_b32 s20, v248
  s_xor_b32 s20, s20, s37
  s_cmp_lg_u32 s20, 0x3fff
  s_cselect_b32 s20, 0, s37
  s_mov_b32 s37, 0
  s_cmp_eq_u32 s20, 0
  s_cbranch_scc1 wp_g1
  s_lshl_b32 s21, 1, s17
  v_mov_b32 v248, s21
  s_mov_b32 s20, 88523264
  s_mov_b64 exec, 1
  buffer_atomic_or v248, v252, s[8:11], s20 offen
  s_mov_b64 exec, -1
wp_g1:
  s_waitcnt lgkmcnt(0)
  v_mfma_f32_16x16x32_bf16 v[64:67], a[128:131], a[0:3], 0
  ds_read_b128 a[4:7], v45 offset:0
  ds_read_b128 a[36:39], v45 offset:1024
  v_mfma_f32_16x16x32_bf16 v[68:71], a[160:163], a[0:3], 0
  ds_read_b128 a[68:71], v45 offset:4096
  ds_read_b128 a[100:103], v45 offset:5120
  v_mfma_f32_16x16x32_bf16 v[72:75], a[128:131], a[32:35], 0
  ds_read_b128 a[132:135], v33 offset:0
  ds_read_b128 a[164:167], v33 offset:2048
  v_mfma_f32_16x16x32_bf16 v[76:79], a[160:163], a[32:35], 0
  ds_read_b128 a[196:199], v33 offset:16384
  ds_read_b128 a[228:231], v33 offset:18432
  v_mfma_f32_16x16x32_bf16 v[80:83], a[128:131], a[64:67], 0
  v_mfma_f32_16x16x32_bf16 v[84:87], a[160:163], a[64:67], 0
  v_mfma_f32_16x16x32_bf16 v[88:91], a[128:131], a[96:99], 0
  v_mfma_f32_16x16x32_bf16 v[92:95], a[160:163], a[96:99], 0
  v_mfma_f32_16x16x32_bf16 v[96:99], a[192:195], a[0:3], 0
  v_mfma_f32_16x16x32_bf16 v[100:103], a[224:227], a[0:3], 0
  v_mfma_f32_16x16x32_bf16 v[104:107], a[192:195], a[32:35], 0
  v_mfma_f32_16x16x32_bf16 v[108:111], a[224:227], a[32:35], 0
  v_mfma_f32_16x16x32_bf16 v[112:115], a[192:195], a[64:67], 0
  v_mfma_f32_16x16x32_bf16 v[116:119], a[224:227], a[64:67], 0
  v_mfma_f32_16x16x32_bf16 v[120:123], a[192:195], a[96:99], 0
  v_mfma_f32_16x16x32_bf16 v[124:127], a[224:227], a[96:99], 0
  s_waitcnt lgkmcnt(0)
  v_mfma_f32_16x16x32_bf16 v[64:67], a[132:135], a[4:7], v[64:67]
  ds_read_b128 a[8:11], v46 offset:0
  ds_read_b128 a[40:43], v46 offset:1024
  v_mfma_f32_16x16x32_bf16 v[68:71], a[164:167], a[4:7], v[68:71]
  ds_read_b128 a[72:75], v46 offset:4096
  ds_read_b128 a[104:107], v46 offset:5120
  v_mfma_f32_16x16x32_bf16 v[72:75], a[132:135], a[36:39], v[72:75]
  ds_read_b128 a[136:139], v34 offset:0
  ds_read_b128 a[168:171], v34 offset:2048
  v_mfma_f32_16x16x32_bf16 v[76:79], a[164:167], a[36:39], v[76:79]
  ds_read_b128 a[200:203], v34 offset:16384
  ds_read_b128 a[232:235], v34 offset:18432
  v_mfma_f32_16x16x32_bf16 v[80:83], a[132:135], a[68:71], v[80:83]
  v_mfma_f32_16x16x32_bf16 v[84:87], a[164:167], a[68:71], v[84:87]
  v_mfma_f32_16x16x32_bf16 v[88:91], a[132:135], a[100:103], v[88:91]
  v_mfma_f32_16x16x32_bf16 v[92:95], a[164:167], a[100:103], v[92:95]
  v_mfma_f32_16x16x32_bf16 v[96:99], a[196:199], a[4:7], v[96:99]
  v_mfma_f32_16x16x32_bf16 v[100:103], a[228:231], a[4:7], v[100:103]
  v_mfma_f32_16x16x32_bf16 v[104:107], a[196:199], a[36:39], v[104:107]
  v_mfma_f32_16x16x32_bf16 v[108:111], a[228:231], a[36:39], v[108:111]
  v_mfma_f32_16x16x32_bf16 v[112:115], a[196:199], a[68:71], v[112:115]
  v_mfma_f32_16x16x32_bf16 v[116:119], a[228:231], a[68:71], v[116:119]
  v_mfma_f32_16x16x32_bf16 v[120:123], a[196:199], a[100:103], v[120:123]
  v_mfma_f32_16x16x32_bf16 v[124:127], a[228:231], a[100:103], v[124:127]
  s_waitcnt lgkmcnt(0)
  v_mfma_f32_16x16x32_bf16 v[64:67], a[136:139], a[8:11], v[64:67]
  ds_read_b128 a[12:15], v47 offset:0
  ds_read_b128 a[44:47], v47 offset:1024
  v_mfma_f32_16x16x32_bf16 v[68:71], a[168:171], a[8:11], v[68:71]
  ds_read_b128 a[76:79], v47 offset:4096
  ds_read_b128 a[108:111], v47 offset:5120
  v_mfma_f32_16x16x32_bf16 v[72:75], a[136:139], a[40:43], v[72:75]
  ds_read_b128 a[140:143], v35 offset:0
  ds_read_b128 a[172:175], v35 offset:2048
  v_mfma_f32_16x16x32_bf16 v[76:79], a[168:171], a[40:43], v[76:79]
  ds_read_b128 a[204:207], v35 offset:16384
  ds_read_b128 a[236:239], v35 offset:18432
  v_mfma_f32_16x16x32_bf16 v[80:83], a[136:139], a[72:75], v[80:83]
  v_mfma_f32_16x16x32_bf16 v[84:87], a[168:171], a[72:75], v[84:87]
  v_mfma_f32_16x16x32_bf16 v[88:91], a[136:139], a[104:107], v[88:91]
  v_mfma_f32_16x16x32_bf16 v[92:95], a[168:171], a[104:107], v[92:95]
  v_mfma_f32_16x16x32_bf16 v[96:99], a[200:203], a[8:11], v[96:99]
  v_mfma_f32_16x16x32_bf16 v[100:103], a[232:235], a[8:11], v[100:103]
  v_mfma_f32_16x16x32_bf16 v[104:107], a[200:203], a[40:43], v[104:107]
  v_mfma_f32_16x16x32_bf16 v[108:111], a[232:235], a[40:43], v[108:111]
  v_mfma_f32_16x16x32_bf16 v[112:115], a[200:203], a[72:75], v[112:115]
  v_mfma_f32_16x16x32_bf16 v[116:119], a[232:235], a[72:75], v[116:119]
  v_mfma_f32_16x16x32_bf16 v[120:123], a[200:203], a[104:107], v[120:123]
  v_mfma_f32_16x16x32_bf16 v[124:127], a[232:235], a[104:107], v[124:127]
  s_waitcnt lgkmcnt(0)
  v_mfma_f32_16x16x32_bf16 v[64:67], a[140:143], a[12:15], v[64:67]
  ds_read_b128 a[16:19], v44 offset:256
  ds_read_b128 a[48:51], v44 offset:1280
  v_mfma_f32_16x16x32_bf16 v[68:71], a[172:175], a[12:15], v[68:71]
  ds_read_b128 a[80:83], v44 offset:4352
  ds_read_b128 a[112:115], v44 offset:5376
  v_mfma_f32_16x16x32_bf16 v[72:75], a[140:143], a[44:47], v[72:75]
  ds_read_b128 a[144:147], v32 offset:256
  ds_read_b128 a[176:179], v32 offset:2304
  v_mfma_f32_16x16x32_bf16 v[76:79], a[172:175], a[44:47], v[76:79]
  ds_read_b128 a[208:211], v32 offset:16640
  ds_read_b128 a[240:243], v32 offset:18688
  v_mfma_f32_16x16x32_bf16 v[80:83], a[140:143], a[76:79], v[80:83]
  v_mfma_f32_16x16x32_bf16 v[84:87], a[172:175], a[76:79], v[84:87]
  v_mfma_f32_16x16x32_bf16 v[88:91], a[140:143], a[108:111], v[88:91]
  v_mfma_f32_16x16x32_bf16 v[92:95], a[172:175], a[108:111], v[92:95]
  v_mfma_f32_16x16x32_bf16 v[96:99], a[204:207], a[12:15], v[96:99]
  v_mfma_f32_16x16x32_bf16 v[100:103], a[236:239], a[12:15], v[100:103]
  v_mfma_f32_16x16x32_bf16 v[104:107], a[204:207], a[44:47], v[104:107]
  v_mfma_f32_16x16x32_bf16 v[108:111], a[236:239], a[44:47], v[108:111]
  v_mfma_f32_16x16x32_bf16 v[112:115], a[204:207], a[76:79], v[112:115]
  v_mfma_f32_16x16x32_bf16 v[116:119], a[236:239], a[76:79], v[116:119]
  v_mfma_f32_16x16x32_bf16 v[120:123], a[204:207], a[108:111], v[120:123]
  v_mfma_f32_16x16x32_bf16 v[124:127], a[236:239], a[108:111], v[124:127]
  s_waitcnt lgkmcnt(0)
  v_mfma_f32_16x16x32_bf16 v[64:67], a[144:147], a[16:19], v[64:67]
  ds_read_b128 a[20:23], v45 offset:256
  ds_read_b128 a[52:55], v45 offset:1280
  v_mfma_f32_16x16x32_bf16 v[68:71], a[176:179], a[16:19], v[68:71]
  ds_read_b128 a[84:87], v45 offset:4352
  ds_read_b128 a[116:119], v45 offset:5376
  v_mfma_f32_16x16x32_bf16 v[72:75], a[144:147], a[48:51], v[72:75]
  ds_read_b128 a[148:151], v33 offset:256
  ds_read_b128 a[180:183], v33 offset:2304
  v_mfma_f32_16x16x32_bf16 v[76:79], a[176:179], a[48:51], v[76:79]
  ds_read_b128 a[212:215], v33 offset:16640
  ds_read_b128 a[244:247], v33 offset:18688
  v_mfma_f32_16x16x32_bf16 v[80:83], a[144:147], a[80:83], v[80:83]
  v_mfma_f32_16x16x32_bf16 v[84:87], a[176:179], a[80:83], v[84:87]
  v_mfma_f32_16x16x32_bf16 v[88:91], a[144:147], a[112:115], v[88:91]
  v_mfma_f32_16x16x32_bf16 v[92:95], a[176:179], a[112:115], v[92:95]
  v_mfma_f32_16x16x32_bf16 v[96:99], a[208:211], a[16:19], v[96:99]
  v_mfma_f32_16x16x32_bf16 v[100:103], a[240:243], a[16:19], v[100:103]
  v_mfma_f32_16x16x32_bf16 v[104:107], a[208:211], a[48:51], v[104:107]
  v_mfma_f32_16x16x32_bf16 v[108:111], a[240:243], a[48:51], v[108:111]
  v_mfma_f32_16x16x32_bf16 v[112:115], a[208:211], a[80:83], v[112:115]
  v_mfma_f32_16x16x32_bf16 v[116:119], a[240:243], a[80:83], v[116:119]
  v_mfma_f32_16x16x32_bf16 v[120:123], a[208:211], a[112:115], v[120:123]
  v_mfma_f32_16x16x32_bf16 v[124:127], a[240:243], a[112:115], v[124:127]
  s_waitcnt lgkmcnt(0)
  v_mfma_f32_16x16x32_bf16 v[64:67], a[148:151], a[20:23], v[64:67]
  ds_read_b128 a[24:27], v46 offset:256
  ds_read_b128 a[56:59], v46 offset:1280
  v_mfma_f32_16x16x32_bf16 v[68:71], a[180:183], a[20:23], v[68:71]
  ds_read_b128 a[88:91], v46 offset:4352
  ds_read_b128 a[120:123], v46 offset:5376
  v_mfma_f32_16x16x32_bf16 v[72:75], a[148:151], a[52:55], v[72:75]
  ds_read_b128 a[152:155], v34 offset:256
  ds_read_b128 a[184:187], v34 offset:2304
  v_mfma_f32_16x16x32_bf16 v[76:79], a[180:183], a[52:55], v[76:79]
  ds_read_b128 a[216:219], v34 offset:16640
  ds_read_b128 a[248:251], v34 offset:18688
  v_mfma_f32_16x16x32_bf16 v[80:83], a[148:151], a[84:87], v[80:83]
  v_mfma_f32_16x16x32_bf16 v[84:87], a[180:183], a[84:87], v[84:87]
  v_mfma_f32_16x16x32_bf16 v[88:91], a[148:151], a[116:119], v[88:91]
  v_mfma_f32_16x16x32_bf16 v[92:95], a[180:183], a[116:119], v[92:95]
  v_mfma_f32_16x16x32_bf16 v[96:99], a[212:215], a[20:23], v[96:99]
  v_mfma_f32_16x16x32_bf16 v[100:103], a[244:247], a[20:23], v[100:103]
  v_mfma_f32_16x16x32_bf16 v[104:107], a[212:215], a[52:55], v[104:107]
  v_mfma_f32_16x16x32_bf16 v[108:111], a[244:247], a[52:55], v[108:111]
  v_mfma_f32_16x16x32_bf16 v[112:115], a[212:215], a[84:87], v[112:115]
  v_mfma_f32_16x16x32_bf16 v[116:119], a[244:247], a[84:87], v[116:119]
  v_mfma_f32_16x16x32_bf16 v[120:123], a[212:215], a[116:119], v[120:123]
  v_mfma_f32_16x16x32_bf16 v[124:127], a[244:247], a[116:119], v[124:127]
  s_waitcnt lgkmcnt(0)
  v_mfma_f32_16x16x32_bf16 v[64:67], a[152:155], a[24:27], v[64:67]
  ds_read_b128 a[28:31], v47 offset:256
  ds_read_b128 a[60:63], v47 offset:1280
  v_mfma_f32_16x16x32_bf16 v[68:71], a[184:187], a[24:27], v[68:71]
  ds_read_b128 a[92:95], v47 offset:4352
  ds_read_b128 a[124:127], v47 offset:5376
  v_mfma_f32_16x16x32_bf16 v[72:75], a[152:155], a[56:59], v[72:75]
  ds_read_b128 a[156:159], v35 offset:256
  ds_read_b128 a[188:191], v35 offset:2304
  v_mfma_f32_16x16x32_bf16 v[76:79], a[184:187], a[56:59], v[76:79]
  ds_read_b128 a[220:223], v35 offset:16640
  ds_read_b128 a[252:255], v35 offset:18688
  v_mfma_f32_16x16x32_bf16 v[80:83], a[152:155], a[88:91], v[80:83]
  v_mfma_f32_16x16x32_bf16 v[84:87], a[184:187], a[88:91], v[84:87]
  v_mfma_f32_16x16x32_bf16 v[88:91], a[152:155], a[120:123], v[88:91]
  v_mfma_f32_16x16x32_bf16 v[92:95], a[184:187], a[120:123], v[92:95]
  v_mfma_f32_16x16x32_bf16 v[96:99], a[216:219], a[24:27], v[96:99]
  v_mfma_f32_16x16x32_bf16 v[100:103], a[248:251], a[24:27], v[100:103]
  v_mfma_f32_16x16x32_bf16 v[104:107], a[216:219], a[56:59], v[104:107]
  v_mfma_f32_16x16x32_bf16 v[108:111], a[248:251], a[56:59], v[108:111]
  v_mfma_f32_16x16x32_bf16 v[112:115], a[216:219], a[88:91], v[112:115]
  v_mfma_f32_16x16x32_bf16 v[116:119], a[248:251], a[88:91], v[116:119]
  v_mfma_f32_16x16x32_bf16 v[120:123], a[216:219], a[120:123], v[120:123]
  v_mfma_f32_16x16x32_bf16 v[124:127], a[248:251], a[120:123], v[124:127]
  s_waitcnt lgkmcnt(0)
  s_barrier
  buffer_load_dwordx2 v[254:255], v252, s[12:15], 0 offen offset:128 sc1
  buffer_load_dword v253, v252, s[12:15], 0 offen sc1
  v_mfma_f32_16x16x32_bf16 v[64:67], a[156:159], a[28:31], v[64:67]
  v_mfma_f32_16x16x32_bf16 v[68:71], a[188:191], a[28:31], v[68:71]
  v_mfma_f32_16x16x32_bf16 v[72:75], a[156:159], a[60:63], v[72:75]
  v_mfma_f32_16x16x32_bf16 v[76:79], a[188:191], a[60:63], v[76:79]
  v_mfma_f32_16x16x32_bf16 v[80:83], a[156:159], a[92:95], v[80:83]
  v_pk_mul_f32 v[64:65], v[64:65], v[48:49] op_sel_hi:[1,0]
  v_pk_mul_f32 v[66:67], v[66:67], v[48:49] op_sel_hi:[1,0]
  v_mfma_f32_16x16x32_bf16 v[84:87], a[188:191], a[92:95], v[84:87]
  v_pk_mul_f32 v[68:69], v[68:69], v[48:49] op_sel_hi:[1,0]
  v_pk_mul_f32 v[70:71], v[70:71], v[48:49] op_sel_hi:[1,0]
  v_mfma_f32_16x16x32_bf16 v[88:91], a[156:159], a[124:127], v[88:91]
  v_cvt_pk_bf16_f32 v64, v64, v65
  v_cvt_pk_bf16_f32 v65, v66, v67
  v_mfma_f32_16x16x32_bf16 v[92:95], a[188:191], a[124:127], v[92:95]
  v_cvt_pk_bf16_f32 v66, v68, v69
  v_cvt_pk_bf16_f32 v67, v70, v71
  v_mfma_f32_16x16x32_bf16 v[96:99], a[220:223], a[28:31], v[96:99]
  buffer_store_dwordx4 v[64:67], v28, s[8:11], s29 offen sc1
  v_pk_mul_f32 v[72:73], v[72:73], v[48:49] op_sel_hi:[1,0]
  v_mfma_f32_16x16x32_bf16 v[100:103], a[252:255], a[28:31], v[100:103]
  v_pk_mul_f32 v[74:75], v[74:75], v[48:49] op_sel_hi:[1,0]
  v_pk_mul_f32 v[76:77], v[76:77], v[48:49] op_sel_hi:[1,0]
  v_mfma_f32_16x16x32_bf16 v[104:107], a[220:223], a[60:63], v[104:107]
  v_pk_mul_f32 v[78:79], v[78:79], v[48:49] op_sel_hi:[1,0]
  v_cvt_pk_bf16_f32 v72, v72, v73
  v_mfma_f32_16x16x32_bf16 v[108:111], a[252:255], a[60:63], v[108:111]
  v_cvt_pk_bf16_f32 v73, v74, v75
  v_cvt_pk_bf16_f32 v74, v76, v77
  v_mfma_f32_16x16x32_bf16 v[112:115], a[220:223], a[92:95], v[112:115]
  v_cvt_pk_bf16_f32 v75, v78, v79
  buffer_store_dwordx4 v[72:75], v29, s[8:11], s29 offen sc1
  v_mfma_f32_16x16x32_bf16 v[116:119], a[252:255], a[92:95], v[116:119]
  v_pk_mul_f32 v[80:81], v[80:81], v[48:49] op_sel_hi:[1,0]
  v_pk_mul_f32 v[82:83], v[82:83], v[48:49] op_sel_hi:[1,0]
  v_mfma_f32_16x16x32_bf16 v[120:123], a[220:223], a[124:127], v[120:123]
  v_pk_mul_f32 v[84:85], v[84:85], v[48:49] op_sel_hi:[1,0]
  v_pk_mul_f32 v[86:87], v[86:87], v[48:49] op_sel_hi:[1,0]
  v_mfma_f32_16x16x32_bf16 v[124:127], a[252:255], a[124:127], v[124:127]
  v_cvt_pk_bf16_f32 v80, v80, v81
  v_cvt_pk_bf16_f32 v81, v82, v83
  v_cvt_pk_bf16_f32 v82, v84, v85
  v_cvt_pk_bf16_f32 v83, v86, v87
  buffer_store_dwordx4 v[80:83], v30, s[8:11], s29 offen sc1
  v_pk_mul_f32 v[88:89], v[88:89], v[48:49] op_sel_hi:[1,0]
  v_pk_mul_f32 v[90:91], v[90:91], v[48:49] op_sel_hi:[1,0]
  v_pk_mul_f32 v[92:93], v[92:93], v[48:49] op_sel_hi:[1,0]
  v_pk_mul_f32 v[94:95], v[94:95], v[48:49] op_sel_hi:[1,0]
  v_cvt_pk_bf16_f32 v88, v88, v89
  v_cvt_pk_bf16_f32 v89, v90, v91
  v_cvt_pk_bf16_f32 v90, v92, v93
  v_cvt_pk_bf16_f32 v91, v94, v95
  buffer_store_dwordx4 v[88:91], v31, s[8:11], s29 offen sc1
  v_pk_mul_f32 v[96:97], v[96:97], v[48:49] op_sel_hi:[1,0]
  v_pk_mul_f32 v[98:99], v[98:99], v[48:49] op_sel_hi:[1,0]
  v_pk_mul_f32 v[100:101], v[100:101], v[48:49] op_sel_hi:[1,0]
  v_pk_mul_f32 v[102:103], v[102:103], v[48:49] op_sel_hi:[1,0]
  v_cvt_pk_bf16_f32 v96, v96, v97
  v_cvt_pk_bf16_f32 v97, v98, v99
  v_cvt_pk_bf16_f32 v98, v100, v101
  v_cvt_pk_bf16_f32 v99, v102, v103
  buffer_store_dwordx4 v[96:99], v28, s[8:11], s31 offen sc1
  v_pk_mul_f32 v[104:105], v[104:105], v[48:49] op_sel_hi:[1,0]
  v_pk_mul_f32 v[106:107], v[106:107], v[48:49] op_sel_hi:[1,0]
  v_pk_mul_f32 v[108:109], v[108:109], v[48:49] op_sel_hi:[1,0]
  v_pk_mul_f32 v[110:111], v[110:111], v[48:49] op_sel_hi:[1,0]
  v_cvt_pk_bf16_f32 v104, v104, v105
  v_cvt_pk_bf16_f32 v105, v106, v107
  v_cvt_pk_bf16_f32 v106, v108, v109
  v_cvt_pk_bf16_f32 v107, v110, v111
  buffer_store_dwordx4 v[104:107], v29, s[8:11], s31 offen sc1
  v_pk_mul_f32 v[112:113], v[112:113], v[48:49] op_sel_hi:[1,0]
  v_pk_mul_f32 v[114:115], v[114:115], v[48:49] op_sel_hi:[1,0]
  v_pk_mul_f32 v[116:117], v[116:117], v[48:49] op_sel_hi:[1,0]
  v_pk_mul_f32 v[118:119], v[118:119], v[48:49] op_sel_hi:[1,0]
  v_cvt_pk_bf16_f32 v112, v112, v113
  v_cvt_pk_bf16_f32 v113, v114, v115
  v_cvt_pk_bf16_f32 v114, v116, v117
  v_cvt_pk_bf16_f32 v115, v118, v119
  buffer_store_dwordx4 v[112:115], v30, s[8:11], s31 offen sc1
  v_pk_mul_f32 v[120:121], v[120:121], v[48:49] op_sel_hi:[1,0]
  v_pk_mul_f32 v[122:123], v[122:123], v[48:49] op_sel_hi:[1,0]
  v_pk_mul_f32 v[124:125], v[124:125], v[48:49] op_sel_hi:[1,0]
  v_pk_mul_f32 v[126:127], v[126:127], v[48:49] op_sel_hi:[1,0]
  v_cvt_pk_bf16_f32 v120, v120, v121
  v_cvt_pk_bf16_f32 v121, v122, v123
  v_cvt_pk_bf16_f32 v122, v124, v125
  v_cvt_pk_bf16_f32 v123, v126, v127
  buffer_store_dwordx4 v[120:123], v31, s[8:11], s31 offen sc1
  s_waitcnt vmcnt(0)
  s_barrier
  s_cmp_lg_u32 s16, 0
  s_cbranch_scc1 wp_f3_f
  v_readfirstlane_b32 s20, v254
  s_cmp_eq_u32 s20, 1
  s_cbranch_scc1 wp_f3_w_ok
  s_mov_b32 s30, 0
wp_f3_w:
  buffer_load_dword v254, off, s[12:15], 0 offset:128 sc1
  s_waitcnt vmcnt(0)
  v_cmp_ne_u32 vcc, 1, v254
  s_cbranch_vccz wp_f3_w_ok
  s_sleep 8
  s_add_u32 s30, s30, 1
  s_cmp_lt_u32 s30, 16
  s_cbranch_scc1 wp_f3_w
  s_branch wp_f3_f
wp_f3_w_ok:
  s_lshl_b32 s20, s17, 7
  s_add_u32 s20, s20, 88521216
  s_lshl_b32 s21, 1, s19
  v_mov_b32 v248, s21
  s_mov_b64 exec, 1
  buffer_atomic_or v248, v252, s[8:11], s20 offen sc0
  s_mov_b64 exec, -1
  s_mov_b32 s38, s21
wp_f3_f:
  s_cmp_lg_u32 s97, 0
  s_cbranch_scc1 wp_all
  v_readfirstlane_b32 s20, v255
  v_readfirstlane_b32 s21, v253
  s_and_b32 s21, s21, 0xffe0
  s_cselect_b32 s96, s20, 0
  s_cmp_eq_u32 s96, 0
  s_cbranch_scc1 wp_all
  v_mov_b32 v250, 1
  s_mov_b32 s20, 88518656
  s_mov_b64 exec, 1
  buffer_atomic_add v250, v252, s[8:11], s20 offen sc0
  s_mov_b64 exec, -1
wp_all:
  v_mov_b32 v252, 0x40000000
  v_cmp_eq_u32 vcc, 0, v0
  s_nop 1
  v_cndmask_b32 v252, v252, v0, vcc
  s_mov_b32 s34, 0
  s_cmp_lg_u32 s16, 0
  s_cbranch_scc1 wp_w2
  s_mov_b32 s24, 88523264
  buffer_load_dword v66, off, s[8:11], s24 sc1
  s_waitcnt vmcnt(0)
  v_readfirstlane_b32 s20, v248
  s_xor_b32 s20, s20, s38
  s_cmp_lg_u32 s20, 0x3fff
  s_cselect_b32 s20, 0, s38
  s_mov_b32 s38, 0
  s_cmp_eq_u32 s20, 0
  s_cbranch_scc1 wp_g3
  s_lshl_b32 s21, 65536, s17
  v_mov_b32 v248, s21
  s_mov_b32 s20, 88523264
  s_mov_b64 exec, 1
  buffer_atomic_or v248, v252, s[8:11], s20 offen
  s_mov_b64 exec, -1
wp_g3:
  s_cmp_lg_u32 s96, 0
  s_cbranch_scc1 wp_v2
  s_mov_b32 s30, 0
wp_v:
  buffer_load_dwordx2 v[64:65], off, s[12:15], 0 sc1
  buffer_load_dword v66, off, s[12:15], 0 offset:132 sc1
  s_waitcnt vmcnt(0)
  v_and_b32 v68, 0xffe0, v64
  v_min_u32 v68, v68, v66
  v_cmp_ne_u32 vcc, 1, v68
  s_cbranch_vccz wp_v_ok
  s_sleep 16
  s_add_u32 s30, s30, 1
  s_cmp_lt_u32 s30, 30
  s_cbranch_scc1 wp_v
  s_branch wp_w1
wp_v_ok:
  buffer_load_dword v66, off, s[8:11], s24 sc1
  s_waitcnt vmcnt(0)
wp_v2:
  v_mov_b32 v64, 32
  v_mov_b32 v65, 4
  v_or_b32 v66, s39, v66
  v_cmp_ne_u32 vcc, -1, v66
  s_cbranch_vccz wp_w2
  s_cmp_eq_u32 s97, 2
  s_cbranch_scc1 wp_w1
  s_mov_b32 s30, 0
wp_w:
  buffer_load_dword v66, off, s[8:11], s24 sc1
  s_waitcnt vmcnt(0)
  v_or_b32 v66, s39, v66
  v_cmp_ne_u32 vcc, -1, v66
  s_cbranch_vccz wp_w_ok
  s_sleep 8
  s_add_u32 s30, s30, 1
  s_cmp_lt_u32 s30, 60
  s_cbranch_scc1 wp_w
  s_branch wp_w1
wp_w_ok:
  s_branch wp_w2
wp_w1:
  v_readfirstlane_b32 s20, v64
  v_readfirstlane_b32 s21, v65
  s_and_b32 s20, s20, 0xffff
  s_cmp_lt_u32 s20, 32
  s_cselect_b32 s34, 2, 1
  s_cmp_lt_u32 s21, 4
  s_cselect_b32 s34, 4, s34
  s_add_u32 s32, s32, 1
  s_cmp_lt_u32 s32, 4000
  s_cselect_b32 s34, s34, 3
wp_w2:
  v_mov_b32 v6, 160032
  v_mov_b32 v7, s34
  s_barrier
  s_cmp_lg_u32 s16, 0
  s_cbranch_scc1 uni_6
  ds_write_b32 v6, v7
  s_waitcnt lgkmcnt(0)
uni_6:
  s_barrier
  ds_read_b32 v7, v6
  s_waitcnt lgkmcnt(0)
  v_readfirstlane_b32 s34, v7
  s_cmp_eq_u32 s34, 0
  s_cbranch_scc1 wp_done
  s_mov_b32 s97, 1
  s_cmp_eq_u32 s34, 1
  s_cbranch_scc1 wp_rep
  s_cmp_eq_u32 s34, 3
  s_cbranch_scc1 cA_abort
  s_cmp_eq_u32 s34, 4
  s_cbranch_scc1 wp_ini
  v_mov_b32 v4, 0x10001
  s_branch ch_take
wp_rep:
  s_load_dwordx8 s[40:47], s[0:1], 72
  s_load_dwordx4 s[48:51], s[0:1], 56
  s_waitcnt vmcnt(0) lgkmcnt(0)
  v_mov_b32 v4, 1
  v_mov_b32 v5, 20
  v_mov_b32 v6, 160000
  s_barrier
  s_cmp_lg_u32 s16, 0
  s_cbranch_scc1 wp_el1
  s_mov_b64 exec, 1
  buffer_atomic_add v4, v5, s[12:15], 0 offen sc0
  s_waitcnt vmcnt(0)
  ds_write_b32 v6, v4
  s_waitcnt lgkmcnt(0)
  s_mov_b64 exec, -1
wp_el1:
  s_barrier
  ds_read_b32 v4, v6
  s_waitcnt lgkmcnt(0)
  v_readfirstlane_b32 s33, v4
  v_and_b32 v1, 63, v0
  v_lshlrev_b32 v2, 4, v1
  v_lshrrev_b32 v3, 4, v1
  v_and_b32 v4, 15, v1
  v_lshrrev_b32 v5, 5, v1
  v_and_b32 v6, 31, v1
  v_xor_b32 v8, v6, v5
  v_lshlrev_b32 v8, 4, v8
  v_lshl_add_u32 v16, v5, 13, v8
  v_xor_b32 v17, 32, v16
  v_xor_b32 v18, 64, v16
  v_xor_b32 v19, 96, v16
  v_xor_b32 v20, 128, v16
  v_xor_b32 v21, 160, v16
  v_xor_b32 v22, 192, v16
  v_xor_b32 v23, 224, v16
  s_lshl_b32 s20, s16, 6
  v_xor_b32 v26, s20, v16
  v_xor_b32 v27, 32, v26
  s_and_b32 s33, s33, 511
  s_and_b32 s20, s33, 255
  s_cmp_ge_u32 s20, 224
  s_cselect_b32 s97, 1, 2
  s_cbranch_scc1 wp_all
  s_mul_i32 s17, s20, 4682
  s_lshr_b32 s17, s17, 16
  s_mul_i32 s23, s17, 14
  s_sub_u32 s19, s20, s23
  s_cmp_lt_u32 s19, 7
  s_cselect_b32 s18, 0, 7
  s_cselect_b32 s28, 0, 8
  s_sub_u32 s18, s19, s18
  s_add_u32 s28, s28, s16
  s_lshl_b32 s25, s16, 15
  s_add_u32 s25, s25, 32768
  s_lshl_b32 s26, s17, 9
  s_lshl_b32 s20, s17, 7
  s_lshr_b32 s21, s33, 8
  s_lshl_b32 s21, s21, 11
  s_add_u32 s20, s20, s21
  s_add_u32 s20, s20, 88519168
  buffer_load_dword v5, off, s[8:11], s20 sc1
  s_waitcnt vmcnt(0)
  v_readfirstlane_b32 s34, v5
  v_mov_b32 v6, 160032
  s_nop 0
  v_mov_b32 v7, s34
  s_barrier
  s_cmp_lg_u32 s16, 0
  s_cbranch_scc1 uni_7
  ds_write_b32 v6, v7
  s_waitcnt lgkmcnt(0)
uni_7:
  s_barrier
  ds_read_b32 v7, v6
  s_waitcnt lgkmcnt(0)
  v_readfirstlane_b32 s34, v7
  s_bitcmp1_b32 s34, s19
  s_cbranch_scc1 wp_rep
  s_barrier
  s_cmp_lt_u32 s33, 256
  s_cbranch_scc1 wp_B
  s_branch wp_A0
wp_done:
  s_load_dwordx2 s[36:37], s[0:1], 112
  s_waitcnt lgkmcnt(0)
  s_mov_b32 s92, s36
  s_and_b32 s93, s37, 0xffff
  s_mov_b32 s94, 3670016
  s_mov_b32 s95, 0x20000
  s_mov_b32 s97, s39
  s_cmp_lg_u32 s96, 0
  s_cbranch_scc1 wk_next
  s_cmp_lg_u32 s16, 0
  s_cbranch_scc1 ask_8
  v_mov_b32 v250, 1
  v_mov_b32 v251, 88518656
  s_mov_b64 exec, 1
  buffer_atomic_add v250, v251, s[8:11], 0 offen sc0
  s_mov_b64 exec, -1
ask_8:
  s_branch wk_next
wk_loop:
  s_waitcnt vmcnt(0) lgkmcnt(0)
wk_ask:
  v_readfirstlane_b32 s22, v250
  s_cmp_ge_u32 s22, 1248
  s_cbranch_scc1 wk_next
  s_cmp_lg_u32 s16, 0
  s_cbranch_scc1 ask_9
  v_mov_b32 v250, 1
  v_mov_b32 v251, 88518656
  s_mov_b64 exec, 1
  buffer_atomic_add v250, v251, s[8:11], 0 offen sc0
  s_mov_b64 exec, -1
ask_9:
wk_next:
  v_mov_b32 v6, 160000
  s_waitcnt vmcnt(0)
  s_barrier
  s_cmp_lg_u32 s16, 0
  s_cbranch_scc1 wk_n1
  s_mov_b64 exec, 1
  ds_write_b32 v6, v250
  s_mov_b64 exec, -1
  s_waitcnt lgkmcnt(0)
wk_n1:
  s_barrier
  ds_read_b32 v4, v6
  s_waitcnt lgkmcnt(0)
  v_readfirstlane_b32 s3, v4
  s_cmp_ge_u32 s3, 1248
  s_cbranch_scc1 wk_done
  v_mov_b32 v250, 0
  v_mov_b32 v251, 88518656
  v_and_b32 v1, 63, v0
  v_lshlrev_b32 v2, 4, v1
  v_lshrrev_b32 v3, 4, v1
  v_and_b32 v4, 15, v1
  s_cmp_ge_u32 s3, 224
  s_cbranch_scc1 wk_n0
  s_mov_b32 s18, 0
  s_and_b32 s17, s3, 15
  s_add_u32 s17, s17, 16
  s_lshr_b32 s34, s3, 4
  s_add_u32 s35, s34, 1
  s_branch wk_gemm
wk_n0:
  s_cmp_eq_u32 s97, 0
  s_cbranch_scc1 wk_n2
  v_mov_b32 v250, s3
  s_mov_b32 s96, 1
  s_mov_b32 s97, 1
  s_mov_b32 s39, 0
  s_mov_b32 s37, 0
  s_mov_b32 s38, 0
  s_mov_b32 s32, 0
  s_branch wp_all
wk_n2:
  s_cmp_ge_u32 s3, 736
  s_cbranch_scc1 wk_tok
  s_cmp_ge_u32 s3, 624
  s_cbranch_scc1 wk_s4d
  s_cmp_ge_u32 s3, 432
  s_cbranch_scc1 wk_full
  s_cmp_ge_u32 s3, 400
  s_cbranch_scc1 wk_srv
  s_and_b32 s17, s3, 15
  s_add_u32 s17, s17, 16
  s_cmp_ge_u32 s3, 336
  s_cbranch_scc1 wk_half
  s_mov_b32 s18, 1
  s_sub_u32 s34, s3, 224
  s_lshr_b32 s34, s34, 4
  s_lshl_b32 s34, s34, 1
  s_add_u32 s35, s34, 2
  s_branch wk_gemm
wk_half:
  s_sub_u32 s20, s3, 336
  s_lshr_b32 s18, s20, 5
  s_add_u32 s18, s18, 2
  s_bitcmp1_b32 s20, 4
  s_cselect_b32 s34, 7, 0
  s_add_u32 s35, s34, 7
  s_branch wk_gemm
wk_full:
  s_sub_u32 s20, s3, 368
  s_and_b32 s17, s20, 15
  s_lshr_b32 s18, s20, 4
  s_cmp_lt_u32 s18, 8
  s_cselect_b32 s21, 16, 0
  s_add_u32 s17, s17, s21
  s_and_b32 s18, s18, 7
  s_mov_b32 s34, 0
  s_mov_b32 s35, 14
wk_gemm:
  s_lshl_b32 s20, s18, 4
  s_lshl_b32 s21, s16, 2
  s_add_u32 s20, s20, s21
  s_mul_i32 s21, s20, 14336
  s_add_u32 s21, s21, 72024064
  s_add_u32 s22, s21, 0
  buffer_load_dwordx4 a[0:3], v2, s[8:11], s22 offen offset:0 sc1
  buffer_load_dwordx4 a[4:7], v2, s[8:11], s22 offen offset:1024 sc1
  buffer_load_dwordx4 a[8:11], v2, s[8:11], s22 offen offset:2048 sc1
  buffer_load_dwordx4 a[12:15], v2, s[8:11], s22 offen offset:3072 sc1
  s_add_u32 s22, s21, 4096
  buffer_load_dwordx4 a[16:19], v2, s[8:11], s22 offen offset:0 sc1
  buffer_load_dwordx4 a[20:23], v2, s[8:11], s22 offen offset:1024 sc1
  buffer_load_dwordx4 a[24:27], v2, s[8:11], s22 offen offset:2048 sc1
  buffer_load_dwordx4 a[28:31], v2, s[8:11], s22 offen offset:3072 sc1
  s_add_u32 s22, s21, 8192
  buffer_load_dwordx4 a[32:35], v2, s[8:11], s22 offen offset:0 sc1
  buffer_load_dwordx4 a[36:39], v2, s[8:11], s22 offen offset:1024 sc1
  buffer_load_dwordx4 a[40:43], v2, s[8:11], s22 offen offset:2048 sc1
  buffer_load_dwordx4 a[44:47], v2, s[8:11], s22 offen offset:3072 sc1
  s_add_u32 s22, s21, 12288
  buffer_load_dwordx4 a[48:51], v2, s[8:11], s22 offen offset:0 sc1
  buffer_load_dwordx4 a[52:55], v2, s[8:11], s22 offen offset:1024 sc1
  buffer_load_dwordx4 a[56:59], v2, s[8:11], s22 offen offset:2048 sc1
  buffer_load_dwordx4 a[60:63], v2, s[8:11], s22 offen offset:3072 sc1
  s_add_u32 s22, s21, 16384
  buffer_load_dwordx4 a[64:67], v2, s[8:11], s22 offen offset:0 sc1
  buffer_load_dwordx4 a[68:71], v2, s[8:11], s22 offen offset:1024 sc1
  buffer_load_dwordx4 a[72:75], v2, s[8:11], s22 offen offset:2048 sc1
  buffer_load_dwordx4 a[76:79], v2, s[8:11], s22 offen offset:3072 sc1
  s_add_u32 s22, s21, 20480
  buffer_load_dwordx4 a[80:83], v2, s[8:11], s22 offen offset:0 sc1
  buffer_load_dwordx4 a[84:87], v2, s[8:11], s22 offen offset:1024 sc1
  buffer_load_dwordx4 a[88:91], v2, s[8:11], s22 offen offset:2048 sc1
  buffer_load_dwordx4 a[92:95], v2, s[8:11], s22 offen offset:3072 sc1
  s_add_u32 s22, s21, 24576
  buffer_load_dwordx4 a[96:99], v2, s[8:11], s22 offen offset:0 sc1
  buffer_load_dwordx4 a[100:103], v2, s[8:11], s22 offen offset:1024 sc1
  buffer_load_dwordx4 a[104:107], v2, s[8:11], s22 offen offset:2048 sc1
  buffer_load_dwordx4 a[108:111], v2, s[8:11], s22 offen offset:3072 sc1
  s_add_u32 s22, s21, 28672
  buffer_load_dwordx4 a[112:115], v2, s[8:11], s22 offen offset:0 sc1
  buffer_load_dwordx4 a[116:119], v2, s[8:11], s22 offen offset:1024 sc1
  buffer_load_dwordx4 a[120:123], v2, s[8:11], s22 offen offset:2048 sc1
  buffer_load_dwordx4 a[124:127], v2, s[8:11], s22 offen offset:3072 sc1
  s_add_u32 s22, s21, 32768
  buffer_load_dwordx4 a[128:131], v2, s[8:11], s22 offen offset:0 sc1
  buffer_load_dwordx4 a[132:135], v2, s[8:11], s22 offen offset:1024 sc1
  buffer_load_dwordx4 a[136:139], v2, s[8:11], s22 offen offset:2048 sc1
  buffer_load_dwordx4 a[140:143], v2, s[8:11], s22 offen offset:3072 sc1
  s_add_u32 s22, s21, 36864
  buffer_load_dwordx4 a[144:147], v2, s[8:11], s22 offen offset:0 sc1
  buffer_load_dwordx4 a[148:151], v2, s[8:11], s22 offen offset:1024 sc1
  buffer_load_dwordx4 a[152:155], v2, s[8:11], s22 offen offset:2048 sc1
  buffer_load_dwordx4 a[156:159], v2, s[8:11], s22 offen offset:3072 sc1
  s_add_u32 s22, s21, 40960
  buffer_load_dwordx4 a[160:163], v2, s[8:11], s22 offen offset:0 sc1
  buffer_load_dwordx4 a[164:167], v2, s[8:11], s22 offen offset:1024 sc1
  buffer_load_dwordx4 a[168:171], v2, s[8:11], s22 offen offset:2048 sc1
  buffer_load_dwordx4 a[172:175], v2, s[8:11], s22 offen offset:3072 sc1
  s_add_u32 s22, s21, 45056
  buffer_load_dwordx4 a[176:179], v2, s[8:11], s22 offen offset:0 sc1
  buffer_load_dwordx4 a[180:183], v2, s[8:11], s22 offen offset:1024 sc1
  buffer_load_dwordx4 a[184:187], v2, s[8:11], s22 offen offset:2048 sc1
  buffer_load_dwordx4 a[188:191], v2, s[8:11], s22 offen offset:3072 sc1
  s_add_u32 s22, s21, 49152
  buffer_load_dwordx4 a[192:195], v2, s[8:11], s22 offen offset:0 sc1
  buffer_load_dwordx4 a[196:199], v2, s[8:11], s22 offen offset:1024 sc1
  buffer_load_dwordx4 a[200:203], v2, s[8:11], s22 offen offset:2048 sc1
  buffer_load_dwordx4 a[204:207], v2, s[8:11], s22 offen offset:3072 sc1
  s_add_u32 s22, s21, 53248
  buffer_load_dwordx4 a[208:211], v2, s[8:11], s22 offen offset:0 sc1
  buffer_load_dwordx4 a[212:215], v2, s[8:11], s22 offen offset:1024 sc1
  buffer_load_dwordx4 a[216:219], v2, s[8:11], s22 offen offset:2048 sc1
  buffer_load_dwordx4 a[220:223], v2, s[8:11], s22 offen offset:3072 sc1
  s_waitcnt vmcnt(40)
  s_mul_i32 s23, s17, 401408
  s_and_b32 s22, s16, 1
  s_mul_i32 s22, s22, 7168
  s_add_u32 s23, s23, s22
  s_add_u32 s23, s23, 0
  s_lshr_b32 s22, s16, 1
  s_mul_i32 s22, s22, 14336
  s_add_u32 s23, s23, s22
  s_mul_i32 s27, s16, 7168
  s_lshr_b32 s28, s20, 1
  s_cmp_lt_u32 s17, 16
  s_cbranch_scc0 wg_vo
  s_add_u32 s23, s23, s22
  s_lshl_b32 s29, s28, 4
  s_add_u32 s29, s29, s17
  s_mul_i32 s29, s29, 28672
  s_add_u32 s29, s29, 12845056
  s_mov_b32 s31, 0
  s_lshr_b32 s24, s34, 1
  s_lshl_b32 s24, s24, 2
  s_and_b32 s25, s34, 1
  s_add_u32 s24, s24, s25
  s_mul_i32 s24, s24, 14336
  s_add_u32 s24, s24, s23
  s_add_u32 m0, s31, s27
  s_nop 0
  buffer_load_dwordx4 v2, s[8:11], s24 offen offset:0 sc1 lds
  buffer_load_dwordx4 v2, s[8:11], s24 offen offset:1024 sc1 lds
  buffer_load_dwordx4 v2, s[8:11], s24 offen offset:2048 sc1 lds
  buffer_load_dwordx4 v2, s[8:11], s24 offen offset:3072 sc1 lds
  s_add_u32 m0, m0, 4096
  s_add_u32 s24, s24, 4096
  buffer_load_dwordx4 v2, s[8:11], s24 offen offset:0 sc1 lds
  buffer_load_dwordx4 v2, s[8:11], s24 offen offset:1024 sc1 lds
  buffer_load_dwordx4 v2, s[8:11], s24 offen offset:2048 sc1 lds
  s_sub_u32 s36, s35, 1
  s_add_u32 s30, s34, 1
  s_min_u32 s30, s30, s36
  s_mov_b32 s31, 28672
  s_lshr_b32 s24, s30, 1
  s_lshl_b32 s24, s24, 2
  s_and_b32 s25, s30, 1
  s_add_u32 s24, s24, s25
  s_mul_i32 s24, s24, 14336
  s_add_u32 s24, s24, s23
  s_add_u32 m0, s31, s27
  s_nop 0
  buffer_load_dwordx4 v2, s[8:11], s24 offen offset:0 sc1 lds
  buffer_load_dwordx4 v2, s[8:11], s24 offen offset:1024 sc1 lds
  buffer_load_dwordx4 v2, s[8:11], s24 offen offset:2048 sc1 lds
  buffer_load_dwordx4 v2, s[8:11], s24 offen offset:3072 sc1 lds
  s_add_u32 m0, m0, 4096
  s_add_u32 s24, s24, 4096
  buffer_load_dwordx4 v2, s[8:11], s24 offen offset:0 sc1 lds
  buffer_load_dwordx4 v2, s[8:11], s24 offen offset:1024 sc1 lds
  buffer_load_dwordx4 v2, s[8:11], s24 offen offset:2048 sc1 lds
  s_mov_b32 s19, s34
  s_mov_b32 s32, 0
  s_mov_b32 s33, 57344
  s_waitcnt vmcnt(7)
  s_branch wg_f_in
wg_f_loop:
  s_waitcnt vmcnt(11)
wg_f_in:
  s_barrier
  s_add_u32 s30, s19, 2
  s_min_u32 s30, s30, s36
  s_lshr_b32 s24, s30, 1
  s_lshl_b32 s24, s24, 2
  s_and_b32 s25, s30, 1
  s_add_u32 s24, s24, s25
  s_mul_i32 s24, s24, 14336
  s_add_u32 s24, s24, s23
  s_add_u32 m0, s33, s27
  s_nop 0
  buffer_load_dwordx4 v2, s[8:11], s24 offen offset:0 sc1 lds
  buffer_load_dwordx4 v2, s[8:11], s24 offen offset:1024 sc1 lds
  buffer_load_dwordx4 v2, s[8:11], s24 offen offset:2048 sc1 lds
  buffer_load_dwordx4 v2, s[8:11], s24 offen offset:3072 sc1 lds
  s_add_u32 m0, m0, 4096
  s_add_u32 s24, s24, 4096
  buffer_load_dwordx4 v2, s[8:11], s24 offen offset:0 sc1 lds
  buffer_load_dwordx4 v2, s[8:11], s24 offen offset:1024 sc1 lds
  buffer_load_dwordx4 v2, s[8:11], s24 offen offset:2048 sc1 lds
  v_add_u32 v5, s32, v2
  ds_read_b128 v[8:11], v5 offset:0
  ds_read_b128 v[12:15], v5 offset:14336
  ds_read_b128 v[16:19], v5 offset:1024
  ds_read_b128 v[20:23], v5 offset:15360
  ds_read_b128 v[24:27], v5 offset:2048
  ds_read_b128 v[28:31], v5 offset:16384
  ds_read_b128 v[32:35], v5 offset:3072
  s_waitcnt lgkmcnt(6)
  v_mfma_f32_16x16x32_bf16 v[40:43], v[8:11], a[0:3], 0
  v_mfma_f32_16x16x32_bf16 v[44:47], v[8:11], a[56:59], 0
  v_mfma_f32_16x16x32_bf16 v[48:51], v[8:11], a[112:115], 0
  v_mfma_f32_16x16x32_bf16 v[52:55], v[8:11], a[168:171], 0
  ds_read_b128 v[36:39], v5 offset:17408
  s_waitcnt lgkmcnt(6)
  v_mfma_f32_16x16x32_bf16 v[56:59], v[12:15], a[0:3], 0
  v_mfma_f32_16x16x32_bf16 v[60:63], v[12:15], a[56:59], 0
  v_mfma_f32_16x16x32_bf16 v[64:67], v[12:15], a[112:115], 0
  v_mfma_f32_16x16x32_bf16 v[68:71], v[12:15], a[168:171], 0
  ds_read_b128 v[8:11], v5 offset:4096
  s_waitcnt lgkmcnt(6)
  v_mfma_f32_16x16x32_bf16 v[40:43], v[16:19], a[4:7], v[40:43]
  v_mfma_f32_16x16x32_bf16 v[44:47], v[16:19], a[60:63], v[44:47]
  v_mfma_f32_16x16x32_bf16 v[48:51], v[16:19], a[116:119], v[48:51]
  v_mfma_f32_16x16x32_bf16 v[52:55], v[16:19], a[172:175], v[52:55]
  ds_read_b128 v[12:15], v5 offset:18432
  s_waitcnt lgkmcnt(6)
  v_mfma_f32_16x16x32_bf16 v[56:59], v[20:23], a[4:7], v[56:59]
  v_mfma_f32_16x16x32_bf16 v[60:63], v[20:23], a[60:63], v[60:63]
  v_mfma_f32_16x16x32_bf16 v[64:67], v[20:23], a[116:119], v[64:67]
  v_mfma_f32_16x16x32_bf16 v[68:71], v[20:23], a[172:175], v[68:71]
  ds_read_b128 v[16:19], v5 offset:5120
  s_waitcnt lgkmcnt(6)
  v_mfma_f32_16x16x32_bf16 v[40:43], v[24:27], a[8:11], v[40:43]
  v_mfma_f32_16x16x32_bf16 v[44:47], v[24:27], a[64:67], v[44:47]
  v_mfma_f32_16x16x32_bf16 v[48:51], v[24:27], a[120:123], v[48:51]
  v_mfma_f32_16x16x32_bf16 v[52:55], v[24:27], a[176:179], v[52:55]
  ds_read_b128 v[20:23], v5 offset:19456
  s_waitcnt lgkmcnt(6)
  v_mfma_f32_16x16x32_bf16 v[56:59], v[28:31], a[8:11], v[56:59]
  v_mfma_f32_16x16x32_bf16 v[60:63], v[28:31], a[64:67], v[60:63]
  v_mfma_f32_16x16x32_bf16 v[64:67], v[28:31], a[120:123], v[64:67]
  v_mfma_f32_16x16x32_bf16 v[68:71], v[28:31], a[176:179], v[68:71]
  ds_read_b128 v[24:27], v5 offset:6144
  s_waitcnt lgkmcnt(6)
  v_mfma_f32_16x16x32_bf16 v[40:43], v[32:35], a[12:15], v[40:43]
  v_mfma_f32_16x16x32_bf16 v[44:47], v[32:35], a[68:71], v[44:47]
  v_mfma_f32_16x16x32_bf16 v[48:51], v[32:35], a[124:127], v[48:51]
  v_mfma_f32_16x16x32_bf16 v[52:55], v[32:35], a[180:183], v[52:55]
  ds_read_b128 v[28:31], v5 offset:20480
  s_waitcnt lgkmcnt(6)
  v_mfma_f32_16x16x32_bf16 v[56:59], v[36:39], a[12:15], v[56:59]
  v_mfma_f32_16x16x32_bf16 v[60:63], v[36:39], a[68:71], v[60:63]
  v_mfma_f32_16x16x32_bf16 v[64:67], v[36:39], a[124:127], v[64:67]
  v_mfma_f32_16x16x32_bf16 v[68:71], v[36:39], a[180:183], v[68:71]
  ds_read_b128 v[32:35], v5 offset:7168
  s_waitcnt lgkmcnt(6)
  v_mfma_f32_16x16x32_bf16 v[40:43], v[8:11], a[16:19], v[40:43]
  v_mfma_f32_16x16x32_bf16 v[44:47], v[8:11], a[72:75], v[44:47]
  v_mfma_f32_16x16x32_bf16 v[48:51], v[8:11], a[128:131], v[48:51]
  v_mfma_f32_16x16x32_bf16 v[52:55], v[8:11], a[184:187], v[52:55]
  ds_read_b128 v[36:39], v5 offset:21504
  s_waitcnt lgkmcnt(6)
  v_mfma_f32_16x16x32_bf16 v[56:59], v[12:15], a[16:19], v[56:59]
  v_mfma_f32_16x16x32_bf16 v[60:63], v[12:15], a[72:75], v[60:63]
  v_mfma_f32_16x16x32_bf16 v[64:67], v[12:15], a[128:131], v[64:67]
  v_mfma_f32_16x16x32_bf16 v[68:71], v[12:15], a[184:187], v[68:71]
  ds_read_b128 v[8:11], v5 offset:8192
  s_waitcnt lgkmcnt(6)
  v_mfma_f32_16x16x32_bf16 v[40:43], v[16:19], a[20:23], v[40:43]
  v_mfma_f32_16x16x32_bf16 v[44:47], v[16:19], a[76:79], v[44:47]
  v_mfma_f32_16x16x32_bf16 v[48:51], v[16:19], a[132:135], v[48:51]
  v_mfma_f32_16x16x32_bf16 v[52:55], v[16:19], a[188:191], v[52:55]
  ds_read_b128 v[12:15], v5 offset:22528
  s_waitcnt lgkmcnt(6)
  v_mfma_f32_16x16x32_bf16 v[56:59], v[20:23], a[20:23], v[56:59]
  v_mfma_f32_16x16x32_bf16 v[60:63], v[20:23], a[76:79], v[60:63]
  v_mfma_f32_16x16x32_bf16 v[64:67], v[20:23], a[132:135], v[64:67]
  v_mfma_f32_16x16x32_bf16 v[68:71], v[20:23], a[188:191], v[68:71]
  ds_read_b128 v[16:19], v5 offset:9216
  s_waitcnt lgkmcnt(6)
  v_mfma_f32_16x16x32_bf16 v[40:43], v[24:27], a[24:27], v[40:43]
  v_mfma_f32_16x16x32_bf16 v[44:47], v[24:27], a[80:83], v[44:47]
  v_mfma_f32_16x16x32_bf16 v[48:51], v[24:27], a[136:139], v[48:51]
  v_mfma_f32_16x16x32_bf16 v[52:55], v[24:27], a[192:195], v[52:55]
  ds_read_b128 v[20:23], v5 offset:23552
  s_waitcnt lgkmcnt(6)
  v_mfma_f32_16x16x32_bf16 v[56:59], v[28:31], a[24:27], v[56:59]
  v_mfma_f32_16x16x32_bf16 v[60:63], v[28:31], a[80:83], v[60:63]
  v_mfma_f32_16x16x32_bf16 v[64:67], v[28:31], a[136:139], v[64:67]
  v_mfma_f32_16x16x32_bf16 v[68:71], v[28:31], a[192:195], v[68:71]
  ds_read_b128 v[24:27], v5 offset:10240
  s_waitcnt lgkmcnt(6)
  v_mfma_f32_16x16x32_bf16 v[40:43], v[32:35], a[28:31], v[40:43]
  v_mfma_f32_16x16x32_bf16 v[44:47], v[32:35], a[84:87], v[44:47]
  v_mfma_f32_16x16x32_bf16 v[48:51], v[32:35], a[140:143], v[48:51]
  v_mfma_f32_16x16x32_bf16 v[52:55], v[32:35], a[196:199], v[52:55]
  ds_read_b128 v[28:31], v5 offset:24576
  s_waitcnt lgkmcnt(6)
  v_mfma_f32_16x16x32_bf16 v[56:59], v[36:39], a[28:31], v[56:59]
  v_mfma_f32_16x16x32_bf16 v[60:63], v[36:39], a[84:87], v[60:63]
  v_mfma_f32_16x16x32_bf16 v[64:67], v[36:39], a[140:143], v[64:67]
  v_mfma_f32_16x16x32_bf16 v[68:71], v[36:39], a[196:199], v[68:71]
  ds_read_b128 v[32:35], v5 offset:11264
  s_waitcnt lgkmcnt(6)
  v_mfma_f32_16x16x32_bf16 v[40:43], v[8:11], a[32:35], v[40:43]
  v_mfma_f32_16x16x32_bf16 v[44:47], v[8:11], a[88:91], v[44:47]
  v_mfma_f32_16x16x32_bf16 v[48:51], v[8:11], a[144:147], v[48:51]
  v_mfma_f32_16x16x32_bf16 v[52:55], v[8:11], a[200:203], v[52:55]
  ds_read_b128 v[36:39], v5 offset:25600
  s_waitcnt lgkmcnt(6)
  v_mfma_f32_16x16x32_bf16 v[56:59], v[12:15], a[32:35], v[56:59]
  v_mfma_f32_16x16x32_bf16 v[60:63], v[12:15], a[88:91], v[60:63]
  v_mfma_f32_16x16x32_bf16 v[64:67], v[12:15], a[144:147], v[64:67]
  v_mfma_f32_16x16x32_bf16 v[68:71], v[12:15], a[200:203], v[68:71]
  ds_read_b128 v[8:11], v5 offset:12288
  s_waitcnt lgkmcnt(6)
  v_mfma_f32_16x16x32_bf16 v[40:43], v[16:19], a[36:39], v[40:43]
  v_mfma_f32_16x16x32_bf16 v[44:47], v[16:19], a[92:95], v[44:47]
  v_mfma_f32_16x16x32_bf16 v[48:51], v[16:19], a[148:151], v[48:51]
  v_mfma_f32_16x16x32_bf16 v[52:55], v[16:19], a[204:207], v[52:55]
  ds_read_b128 v[12:15], v5 offset:26624
  s_waitcnt lgkmcnt(6)
  v_mfma_f32_16x16x32_bf16 v[56:59], v[20:23], a[36:39], v[56:59]
  v_mfma_f32_16x16x32_bf16 v[60:63], v[20:23], a[92:95], v[60:63]
  v_mfma_f32_16x16x32_bf16 v[64:67], v[20:23], a[148:151], v[64:67]
  v_mfma_f32_16x16x32_bf16 v[68:71], v[20:23], a[204:207], v[68:71]
  ds_read_b128 v[16:19], v5 offset:13312
  s_waitcnt lgkmcnt(6)
  v_mfma_f32_16x16x32_bf16 v[40:43], v[24:27], a[40:43], v[40:43]
  v_mfma_f32_16x16x32_bf16 v[44:47], v[24:27], a[96:99], v[44:47]
  v_mfma_f32_16x16x32_bf16 v[48:51], v[24:27], a[152:155], v[48:51]
  v_mfma_f32_16x16x32_bf16 v[52:55], v[24:27], a[208:211], v[52:55]
  ds_read_b128 v[20:23], v5 offset:27648
  s_waitcnt lgkmcnt(6)
  v_mfma_f32_16x16x32_bf16 v[56:59], v[28:31], a[40:43], v[56:59]
  v_mfma_f32_16x16x32_bf16 v[60:63], v[28:31], a[96:99], v[60:63]
  v_mfma_f32_16x16x32_bf16 v[64:67], v[28:31], a[152:155], v[64:67]
  v_mfma_f32_16x16x32_bf16 v[68:71], v[28:31], a[208:211], v[68:71]
  s_waitcnt lgkmcnt(5)
  v_mfma_f32_16x16x32_bf16 v[40:43], v[32:35], a[44:47], v[40:43]
  v_mfma_f32_16x16x32_bf16 v[44:47], v[32:35], a[100:103], v[44:47]
  v_mfma_f32_16x16x32_bf16 v[48:51], v[32:35], a[156:159], v[48:51]
  v_mfma_f32_16x16x32_bf16 v[52:55], v[32:35], a[212:215], v[52:55]
  s_waitcnt lgkmcnt(4)
  v_mfma_f32_16x16x32_bf16 v[56:59], v[36:39], a[44:47], v[56:59]
  v_mfma_f32_16x16x32_bf16 v[60:63], v[36:39], a[100:103], v[60:63]
  v_mfma_f32_16x16x32_bf16 v[64:67], v[36:39], a[156:159], v[64:67]
  v_mfma_f32_16x16x32_bf16 v[68:71], v[36:39], a[212:215], v[68:71]
  s_waitcnt lgkmcnt(3)
  v_mfma_f32_16x16x32_bf16 v[40:43], v[8:11], a[48:51], v[40:43]
  v_mfma_f32_16x16x32_bf16 v[44:47], v[8:11], a[104:107], v[44:47]
  v_mfma_f32_16x16x32_bf16 v[48:51], v[8:11], a[160:163], v[48:51]
  v_mfma_f32_16x16x32_bf16 v[52:55], v[8:11], a[216:219], v[52:55]
  s_waitcnt lgkmcnt(2)
  v_mfma_f32_16x16x32_bf16 v[56:59], v[12:15], a[48:51], v[56:59]
  v_mfma_f32_16x16x32_bf16 v[60:63], v[12:15], a[104:107], v[60:63]
  v_mfma_f32_16x16x32_bf16 v[64:67], v[12:15], a[160:163], v[64:67]
  v_mfma_f32_16x16x32_bf16 v[68:71], v[12:15], a[216:219], v[68:71]
  s_waitcnt lgkmcnt(1)
  v_mfma_f32_16x16x32_bf16 v[40:43], v[16:19], a[52:55], v[40:43]
  v_mfma_f32_16x16x32_bf16 v[44:47], v[16:19], a[108:111], v[44:47]
  v_mfma_f32_16x16x32_bf16 v[48:51], v[16:19], a[164:167], v[48:51]
  v_mfma_f32_16x16x32_bf16 v[52:55], v[16:19], a[220:223], v[52:55]
  s_waitcnt lgkmcnt(0)
  v_mfma_f32_16x16x32_bf16 v[56:59], v[20:23], a[52:55], v[56:59]
  v_mfma_f32_16x16x32_bf16 v[60:63], v[20:23], a[108:111], v[60:63]
  v_mfma_f32_16x16x32_bf16 v[64:67], v[20:23], a[164:167], v[64:67]
  v_mfma_f32_16x16x32_bf16 v[68:71], v[20:23], a[220:223], v[68:71]
  s_lshl_b32 s24, s19, 10
  s_add_u32 s24, s24, s29
  v_cvt_pk_bf16_f32 v72, v40, v41
  v_cvt_pk_bf16_f32 v73, v42, v43
  v_cvt_pk_bf16_f32 v74, v56, v57
  v_cvt_pk_bf16_f32 v75, v58, v59
  s_add_u32 s25, s24, 0
  buffer_store_dwordx4 v[72:75], v2, s[8:11], s25 offen sc1
  v_cvt_pk_bf16_f32 v76, v44, v45
  v_cvt_pk_bf16_f32 v77, v46, v47
  v_cvt_pk_bf16_f32 v78, v60, v61
  v_cvt_pk_bf16_f32 v79, v62, v63
  s_add_u32 s25, s24, 14336
  buffer_store_dwordx4 v[76:79], v2, s[8:11], s25 offen sc1
  v_cvt_pk_bf16_f32 v80, v48, v49
  v_cvt_pk_bf16_f32 v81, v50, v51
  v_cvt_pk_bf16_f32 v82, v64, v65
  v_cvt_pk_bf16_f32 v83, v66, v67
  s_add_u32 s25, s24, 458752
  buffer_store_dwordx4 v[80:83], v2, s[8:11], s25 offen sc1
  v_cvt_pk_bf16_f32 v84, v52, v53
  v_cvt_pk_bf16_f32 v85, v54, v55
  v_cvt_pk_bf16_f32 v86, v68, v69
  v_cvt_pk_bf16_f32 v87, v70, v71
  s_add_u32 s25, s24, 473088
  buffer_store_dwordx4 v[84:87], v2, s[8:11], s25 offen sc1
  s_mov_b32 s33, s32
  s_add_u32 s32, s32, 28672
  s_cmp_eq_u32 s32, 86016
  s_cselect_b32 s32, 0, s32
  s_add_u32 s19, s19, 1
  s_cmp_lt_u32 s19, s35
  s_cbranch_scc1 wg_f_loop
  s_branch wg_done
wg_vo:
  s_sub_u32 s29, s17, 16
  s_mul_i32 s29, s29, 28672
  s_mul_i32 s24, s28, 458752
  s_add_u32 s29, s29, s24
  s_add_u32 s29, s29, 42205184
  v_lshlrev_b32 v6, 4, v3
  v_mul_u32_u24 v7, 12, v3
  v_add_u32 v7, 48, v7
  s_mov_b32 s31, 0
  s_lshl_b32 s24, s34, 1
  s_mul_i32 s24, s24, 14336
  s_add_u32 s24, s24, s23
  s_add_u32 m0, s31, s27
  s_nop 0
  buffer_load_dwordx4 v2, s[8:11], s24 offen offset:0 sc1 lds
  buffer_load_dwordx4 v2, s[8:11], s24 offen offset:1024 sc1 lds
  buffer_load_dwordx4 v2, s[8:11], s24 offen offset:2048 sc1 lds
  buffer_load_dwordx4 v2, s[8:11], s24 offen offset:3072 sc1 lds
  s_add_u32 m0, m0, 4096
  s_add_u32 s24, s24, 4096
  buffer_load_dwordx4 v2, s[8:11], s24 offen offset:0 sc1 lds
  buffer_load_dwordx4 v2, s[8:11], s24 offen offset:1024 sc1 lds
  buffer_load_dwordx4 v2, s[8:11], s24 offen offset:2048 sc1 lds
  s_sub_u32 s36, s35, 1
  s_add_u32 s30, s34, 1
  s_min_u32 s30, s30, s36
  s_mov_b32 s31, 28672
  s_lshl_b32 s24, s30, 1
  s_mul_i32 s24, s24, 14336
  s_add_u32 s24, s24, s23
  s_add_u32 m0, s31, s27
  s_nop 0
  buffer_load_dwordx4 v2, s[8:11], s24 offen offset:0 sc1 lds
  buffer_load_dwordx4 v2, s[8:11], s24 offen offset:1024 sc1 lds
  buffer_load_dwordx4 v2, s[8:11], s24 offen offset:2048 sc1 lds
  buffer_load_dwordx4 v2, s[8:11], s24 offen offset:3072 sc1 lds
  s_add_u32 m0, m0, 4096
  s_add_u32 s24, s24, 4096
  buffer_load_dwordx4 v2, s[8:11], s24 offen offset:0 sc1 lds
  buffer_load_dwordx4 v2, s[8:11], s24 offen offset:1024 sc1 lds
  buffer_load_dwordx4 v2, s[8:11], s24 offen offset:2048 sc1 lds
  s_mov_b32 s19, s34
  s_mov_b32 s32, 0
  s_mov_b32 s33, 57344
  s_waitcnt vmcnt(7)
  s_branch wg_vo_in
wg_vo_loop:
  s_waitcnt vmcnt(11)
wg_vo_in:
  s_barrier
  s_add_u32 s30, s19, 2
  s_min_u32 s30, s30, s36
  s_lshl_b32 s24, s30, 1
  s_mul_i32 s24, s24, 14336
  s_add_u32 s24, s24, s23
  s_add_u32 m0, s33, s27
  s_nop 0
  buffer_load_dwordx4 v2, s[8:11], s24 offen offset:0 sc1 lds
  buffer_load_dwordx4 v2, s[8:11], s24 offen offset:1024 sc1 lds
  buffer_load_dwordx4 v2, s[8:11], s24 offen offset:2048 sc1 lds
  buffer_load_dwordx4 v2, s[8:11], s24 offen offset:3072 sc1 lds
  s_add_u32 m0, m0, 4096
  s_add_u32 s24, s24, 4096
  buffer_load_dwordx4 v2, s[8:11], s24 offen offset:0 sc1 lds
  buffer_load_dwordx4 v2, s[8:11], s24 offen offset:1024 sc1 lds
  buffer_load_dwordx4 v2, s[8:11], s24 offen offset:2048 sc1 lds
  v_add_u32 v5, s32, v2
  ds_read_b128 v[8:11], v5 offset:0
  ds_read_b128 v[12:15], v5 offset:14336
  ds_read_b128 v[16:19], v5 offset:1024
  ds_read_b128 v[20:23], v5 offset:15360
  ds_read_b128 v[24:27], v5 offset:2048
  ds_read_b128 v[28:31], v5 offset:16384
  ds_read_b128 v[32:35], v5 offset:3072
  s_waitcnt lgkmcnt(6)
  v_mfma_f32_16x16x32_bf16 v[40:43], a[0:3], v[8:11], 0
  v_mfma_f32_16x16x32_bf16 v[44:47], a[56:59], v[8:11], 0
  v_mfma_f32_16x16x32_bf16 v[48:51], a[112:115], v[8:11], 0
  v_mfma_f32_16x16x32_bf16 v[52:55], a[168:171], v[8:11], 0
  ds_read_b128 v[36:39], v5 offset:17408
  s_waitcnt lgkmcnt(6)
  v_mfma_f32_16x16x32_bf16 v[56:59], a[0:3], v[12:15], 0
  v_mfma_f32_16x16x32_bf16 v[60:63], a[56:59], v[12:15], 0
  v_mfma_f32_16x16x32_bf16 v[64:67], a[112:115], v[12:15], 0
  v_mfma_f32_16x16x32_bf16 v[68:71], a[168:171], v[12:15], 0
  ds_read_b128 v[8:11], v5 offset:4096
  s_waitcnt lgkmcnt(6)
  v_mfma_f32_16x16x32_bf16 v[40:43], a[4:7], v[16:19], v[40:43]
  v_mfma_f32_16x16x32_bf16 v[44:47], a[60:63], v[16:19], v[44:47]
  v_mfma_f32_16x16x32_bf16 v[48:51], a[116:119], v[16:19], v[48:51]
  v_mfma_f32_16x16x32_bf16 v[52:55], a[172:175], v[16:19], v[52:55]
  ds_read_b128 v[12:15], v5 offset:18432
  s_waitcnt lgkmcnt(6)
  v_mfma_f32_16x16x32_bf16 v[56:59], a[4:7], v[20:23], v[56:59]
  v_mfma_f32_16x16x32_bf16 v[60:63], a[60:63], v[20:23], v[60:63]
  v_mfma_f32_16x16x32_bf16 v[64:67], a[116:119], v[20:23], v[64:67]
  v_mfma_f32_16x16x32_bf16 v[68:71], a[172:175], v[20:23], v[68:71]
  ds_read_b128 v[16:19], v5 offset:5120
  s_waitcnt lgkmcnt(6)
  v_mfma_f32_16x16x32_bf16 v[40:43], a[8:11], v[24:27], v[40:43]
  v_mfma_f32_16x16x32_bf16 v[44:47], a[64:67], v[24:27], v[44:47]
  v_mfma_f32_16x16x32_bf16 v[48:51], a[120:123], v[24:27], v[48:51]
  v_mfma_f32_16x16x32_bf16 v[52:55], a[176:179], v[24:27], v[52:55]
  ds_read_b128 v[20:23], v5 offset:19456
  s_waitcnt lgkmcnt(6)
  v_mfma_f32_16x16x32_bf16 v[56:59], a[8:11], v[28:31], v[56:59]
  v_mfma_f32_16x16x32_bf16 v[60:63], a[64:67], v[28:31], v[60:63]
  v_mfma_f32_16x16x32_bf16 v[64:67], a[120:123], v[28:31], v[64:67]
  v_mfma_f32_16x16x32_bf16 v[68:71], a[176:179], v[28:31], v[68:71]
  ds_read_b128 v[24:27], v5 offset:6144
  s_waitcnt lgkmcnt(6)
  v_mfma_f32_16x16x32_bf16 v[40:43], a[12:15], v[32:35], v[40:43]
  v_mfma_f32_16x16x32_bf16 v[44:47], a[68:71], v[32:35], v[44:47]
  v_mfma_f32_16x16x32_bf16 v[48:51], a[124:127], v[32:35], v[48:51]
  v_mfma_f32_16x16x32_bf16 v[52:55], a[180:183], v[32:35], v[52:55]
  ds_read_b128 v[28:31], v5 offset:20480
  s_waitcnt lgkmcnt(6)
  v_mfma_f32_16x16x32_bf16 v[56:59], a[12:15], v[36:39], v[56:59]
  v_mfma_f32_16x16x32_bf16 v[60:63], a[68:71], v[36:39], v[60:63]
  v_mfma_f32_16x16x32_bf16 v[64:67], a[124:127], v[36:39], v[64:67]
  v_mfma_f32_16x16x32_bf16 v[68:71], a[180:183], v[36:39], v[68:71]
  ds_read_b128 v[32:35], v5 offset:7168
  s_waitcnt lgkmcnt(6)
  v_mfma_f32_16x16x32_bf16 v[40:43], a[16:19], v[8:11], v[40:43]
  v_mfma_f32_16x16x32_bf16 v[44:47], a[72:75], v[8:11], v[44:47]
  v_mfma_f32_16x16x32_bf16 v[48:51], a[128:131], v[8:11], v[48:51]
  v_mfma_f32_16x16x32_bf16 v[52:55], a[184:187], v[8:11], v[52:55]
  ds_read_b128 v[36:39], v5 offset:21504
  s_waitcnt lgkmcnt(6)
  v_mfma_f32_16x16x32_bf16 v[56:59], a[16:19], v[12:15], v[56:59]
  v_mfma_f32_16x16x32_bf16 v[60:63], a[72:75], v[12:15], v[60:63]
  v_mfma_f32_16x16x32_bf16 v[64:67], a[128:131], v[12:15], v[64:67]
  v_mfma_f32_16x16x32_bf16 v[68:71], a[184:187], v[12:15], v[68:71]
  ds_read_b128 v[8:11], v5 offset:8192
  s_waitcnt lgkmcnt(6)
  v_mfma_f32_16x16x32_bf16 v[40:43], a[20:23], v[16:19], v[40:43]
  v_mfma_f32_16x16x32_bf16 v[44:47], a[76:79], v[16:19], v[44:47]
  v_mfma_f32_16x16x32_bf16 v[48:51], a[132:135], v[16:19], v[48:51]
  v_mfma_f32_16x16x32_bf16 v[52:55], a[188:191], v[16:19], v[52:55]
  ds_read_b128 v[12:15], v5 offset:22528
  s_waitcnt lgkmcnt(6)
  v_mfma_f32_16x16x32_bf16 v[56:59], a[20:23], v[20:23], v[56:59]
  v_mfma_f32_16x16x32_bf16 v[60:63], a[76:79], v[20:23], v[60:63]
  v_mfma_f32_16x16x32_bf16 v[64:67], a[132:135], v[20:23], v[64:67]
  v_mfma_f32_16x16x32_bf16 v[68:71], a[188:191], v[20:23], v[68:71]
  ds_read_b128 v[16:19], v5 offset:9216
  s_waitcnt lgkmcnt(6)
  v_mfma_f32_16x16x32_bf16 v[40:43], a[24:27], v[24:27], v[40:43]
  v_mfma_f32_16x16x32_bf16 v[44:47], a[80:83], v[24:27], v[44:47]
  v_mfma_f32_16x16x32_bf16 v[48:51], a[136:139], v[24:27], v[48:51]
  v_mfma_f32_16x16x32_bf16 v[52:55], a[192:195], v[24:27], v[52:55]
  ds_read_b128 v[20:23], v5 offset:23552
  s_waitcnt lgkmcnt(6)
  v_mfma_f32_16x16x32_bf16 v[56:59], a[24:27], v[28:31], v[56:59]
  v_mfma_f32_16x16x32_bf16 v[60:63], a[80:83], v[28:31], v[60:63]
  v_mfma_f32_16x16x32_bf16 v[64:67], a[136:139], v[28:31], v[64:67]
  v_mfma_f32_16x16x32_bf16 v[68:71], a[192:195], v[28:31], v[68:71]
  ds_read_b128 v[24:27], v5 offset:10240
  s_waitcnt lgkmcnt(6)
  v_mfma_f32_16x16x32_bf16 v[40:43], a[28:31], v[32:35], v[40:43]
  v_mfma_f32_16x16x32_bf16 v[44:47], a[84:87], v[32:35], v[44:47]
  v_mfma_f32_16x16x32_bf16 v[48:51], a[140:143], v[32:35], v[48:51]
  v_mfma_f32_16x16x32_bf16 v[52:55], a[196:199], v[32:35], v[52:55]
  ds_read_b128 v[28:31], v5 offset:24576
  s_waitcnt lgkmcnt(6)
  v_mfma_f32_16x16x32_bf16 v[56:59], a[28:31], v[36:39], v[56:59]
  v_mfma_f32_16x16x32_bf16 v[60:63], a[84:87], v[36:39], v[60:63]
  v_mfma_f32_16x16x32_bf16 v[64:67], a[140:143], v[36:39], v[64:67]
  v_mfma_f32_16x16x32_bf16 v[68:71], a[196:199], v[36:39], v[68:71]
  ds_read_b128 v[32:35], v5 offset:11264
  s_waitcnt lgkmcnt(6)
  v_mfma_f32_16x16x32_bf16 v[40:43], a[32:35], v[8:11], v[40:43]
  v_mfma_f32_16x16x32_bf16 v[44:47], a[88:91], v[8:11], v[44:47]
  v_mfma_f32_16x16x32_bf16 v[48:51], a[144:147], v[8:11], v[48:51]
  v_mfma_f32_16x16x32_bf16 v[52:55], a[200:203], v[8:11], v[52:55]
  ds_read_b128 v[36:39], v5 offset:25600
  s_waitcnt lgkmcnt(6)
  v_mfma_f32_16x16x32_bf16 v[56:59], a[32:35], v[12:15], v[56:59]
  v_mfma_f32_16x16x32_bf16 v[60:63], a[88:91], v[12:15], v[60:63]
  v_mfma_f32_16x16x32_bf16 v[64:67], a[144:147], v[12:15], v[64:67]
  v_mfma_f32_16x16x32_bf16 v[68:71], a[200:203], v[12:15], v[68:71]
  ds_read_b128 v[8:11], v5 offset:12288
  s_waitcnt lgkmcnt(6)
  v_mfma_f32_16x16x32_bf16 v[40:43], a[36:39], v[16:19], v[40:43]
  v_mfma_f32_16x16x32_bf16 v[44:47], a[92:95], v[16:19], v[44:47]
  v_mfma_f32_16x16x32_bf16 v[48:51], a[148:151], v[16:19], v[48:51]
  v_mfma_f32_16x16x32_bf16 v[52:55], a[204:207], v[16:19], v[52:55]
  ds_read_b128 v[12:15], v5 offset:26624
  s_waitcnt lgkmcnt(6)
  v_mfma_f32_16x16x32_bf16 v[56:59], a[36:39], v[20:23], v[56:59]
  v_mfma_f32_16x16x32_bf16 v[60:63], a[92:95], v[20:23], v[60:63]
  v_mfma_f32_16x16x32_bf16 v[64:67], a[148:151], v[20:23], v[64:67]
  v_mfma_f32_16x16x32_bf16 v[68:71], a[204:207], v[20:23], v[68:71]
  ds_read_b128 v[16:19], v5 offset:13312
  s_waitcnt lgkmcnt(6)
  v_mfma_f32_16x16x32_bf16 v[40:43], a[40:43], v[24:27], v[40:43]
  v_mfma_f32_16x16x32_bf16 v[44:47], a[96:99], v[24:27], v[44:47]
  v_mfma_f32_16x16x32_bf16 v[48:51], a[152:155], v[24:27], v[48:51]
  v_mfma_f32_16x16x32_bf16 v[52:55], a[208:211], v[24:27], v[52:55]
  ds_read_b128 v[20:23], v5 offset:27648
  s_waitcnt lgkmcnt(6)
  v_mfma_f32_16x16x32_bf16 v[56:59], a[40:43], v[28:31], v[56:59]
  v_mfma_f32_16x16x32_bf16 v[60:63], a[96:99], v[28:31], v[60:63]
  v_mfma_f32_16x16x32_bf16 v[64:67], a[152:155], v[28:31], v[64:67]
  v_mfma_f32_16x16x32_bf16 v[68:71], a[208:211], v[28:31], v[68:71]
  s_waitcnt lgkmcnt(5)
  v_mfma_f32_16x16x32_bf16 v[40:43], a[44:47], v[32:35], v[40:43]
  v_mfma_f32_16x16x32_bf16 v[44:47], a[100:103], v[32:35], v[44:47]
  v_mfma_f32_16x16x32_bf16 v[48:51], a[156:159], v[32:35], v[48:51]
  v_mfma_f32_16x16x32_bf16 v[52:55], a[212:215], v[32:35], v[52:55]
  s_waitcnt lgkmcnt(4)
  v_mfma_f32_16x16x32_bf16 v[56:59], a[44:47], v[36:39], v[56:59]
  v_mfma_f32_16x16x32_bf16 v[60:63], a[100:103], v[36:39], v[60:63]
  v_mfma_f32_16x16x32_bf16 v[64:67], a[156:159], v[36:39], v[64:67]
  v_mfma_f32_16x16x32_bf16 v[68:71], a[212:215], v[36:39], v[68:71]
  s_waitcnt lgkmcnt(3)
  v_mfma_f32_16x16x32_bf16 v[40:43], a[48:51], v[8:11], v[40:43]
  v_mfma_f32_16x16x32_bf16 v[44:47], a[104:107], v[8:11], v[44:47]
  v_mfma_f32_16x16x32_bf16 v[48:51], a[160:163], v[8:11], v[48:51]
  v_mfma_f32_16x16x32_bf16 v[52:55], a[216:219], v[8:11], v[52:55]
  s_waitcnt lgkmcnt(2)
  v_mfma_f32_16x16x32_bf16 v[56:59], a[48:51], v[12:15], v[56:59]
  v_mfma_f32_16x16x32_bf16 v[60:63], a[104:107], v[12:15], v[60:63]
  v_mfma_f32_16x16x32_bf16 v[64:67], a[160:163], v[12:15], v[64:67]
  v_mfma_f32_16x16x32_bf16 v[68:71], a[216:219], v[12:15], v[68:71]
  s_waitcnt lgkmcnt(1)
  v_mfma_f32_16x16x32_bf16 v[40:43], a[52:55], v[16:19], v[40:43]
  v_mfma_f32_16x16x32_bf16 v[44:47], a[108:111], v[16:19], v[44:47]
  v_mfma_f32_16x16x32_bf16 v[48:51], a[164:167], v[16:19], v[48:51]
  v_mfma_f32_16x16x32_bf16 v[52:55], a[220:223], v[16:19], v[52:55]
  s_waitcnt lgkmcnt(0)
  v_mfma_f32_16x16x32_bf16 v[56:59], a[52:55], v[20:23], v[56:59]
  v_mfma_f32_16x16x32_bf16 v[60:63], a[108:111], v[20:23], v[60:63]
  v_mfma_f32_16x16x32_bf16 v[64:67], a[164:167], v[20:23], v[64:67]
  v_mfma_f32_16x16x32_bf16 v[68:71], a[220:223], v[20:23], v[68:71]
  s_add_u32 s25, s29, 458752
  s_lshl_b32 s24, s19, 5
  s_add_u32 s24, s24, 0
  v_add_u32 v88, s24, v4
  v_mul_u32_u24 v89, 2341, v88
  v_lshrrev_b32 v89, 16, v89
  v_mul_u32_u24 v92, 28, v89
  v_sub_u32 v92, v88, v92
  v_cmp_gt_u32 vcc, 16, v92
  v_mul_u32_u24 v89, 84, v89
  s_nop 0
  v_cndmask_b32 v92, v7, v6, vcc
  v_add3_u32 v88, v88, v89, v92
  v_lshlrev_b32 v90, 4, v88
  v_cvt_pk_bf16_f32 v72, v40, v44
  v_cvt_pk_bf16_f32 v73, v41, v45
  v_cvt_pk_bf16_f32 v74, v42, v46
  v_cvt_pk_bf16_f32 v75, v43, v47
  buffer_store_dwordx4 v[72:75], v90, s[8:11], s29 offen sc1
  v_cvt_pk_bf16_f32 v76, v48, v52
  v_cvt_pk_bf16_f32 v77, v49, v53
  v_cvt_pk_bf16_f32 v78, v50, v54
  v_cvt_pk_bf16_f32 v79, v51, v55
  buffer_store_dwordx4 v[76:79], v90, s[8:11], s25 offen sc1
  s_lshl_b32 s24, s19, 5
  s_add_u32 s24, s24, 16
  v_add_u32 v88, s24, v4
  v_mul_u32_u24 v89, 2341, v88
  v_lshrrev_b32 v89, 16, v89
  v_mul_u32_u24 v92, 28, v89
  v_sub_u32 v92, v88, v92
  v_cmp_gt_u32 vcc, 16, v92
  v_mul_u32_u24 v89, 84, v89
  s_nop 0
  v_cndmask_b32 v92, v7, v6, vcc
  v_add3_u32 v88, v88, v89, v92
  v_lshlrev_b32 v91, 4, v88
  v_cvt_pk_bf16_f32 v80, v56, v60
  v_cvt_pk_bf16_f32 v81, v57, v61
  v_cvt_pk_bf16_f32 v82, v58, v62
  v_cvt_pk_bf16_f32 v83, v59, v63
  buffer_store_dwordx4 v[80:83], v91, s[8:11], s29 offen sc1
  v_cvt_pk_bf16_f32 v84, v64, v68
  v_cvt_pk_bf16_f32 v85, v65, v69
  v_cvt_pk_bf16_f32 v86, v66, v70
  v_cvt_pk_bf16_f32 v87, v67, v71
  buffer_store_dwordx4 v[84:87], v91, s[8:11], s25 offen sc1
  s_mov_b32 s33, s32
  s_add_u32 s32, s32, 28672
  s_cmp_eq_u32 s32, 86016
  s_cselect_b32 s32, 0, s32
  s_add_u32 s19, s19, 1
  s_cmp_lt_u32 s19, s35
  s_cbranch_scc1 wg_vo_loop
  s_branch wg_done
wg_done:
  s_lshl_b32 s20, s18, 4
  s_and_b32 s21, s17, 15
  s_add_u32 s20, s20, s21
  s_lshl_b32 s20, s20, 7
  s_cmp_lt_u32 s17, 16
  s_cselect_b32 s21, 16384, 0
  s_add_u32 s20, s20, s21
  s_add_u32 s20, s20, 88461312
  s_sub_u32 s21, s35, s34
  s_lshl_b32 s21, s21, 2
  v_mov_b32 v5, s21
  v_mov_b32 v6, 0
  s_waitcnt vmcnt(0)
  s_barrier
  s_cmp_lg_u32 s16, 0
  s_cbranch_scc1 wg_sg
  s_mov_b64 exec, 1
  buffer_atomic_add v5, v6, s[8:11], s20 offen
  s_mov_b64 exec, -1
wg_sg:
  s_branch wk_loop
wk_srv:
  s_and_b32 s18, s3, 15
  s_lshr_b32 s19, s3, 4
  s_and_b32 s19, s19, 1
  s_mul_i32 s20, s18, 401408
  s_mul_i32 s21, s16, 100352
  s_add_u32 s20, s20, s21
  s_add_u32 s20, s20, 6422528
  s_add_u32 s22, s20, 0
  buffer_load_dwordx4 a[0:3], v2, s[8:11], s22 offen offset:0 sc1
  buffer_load_dwordx4 a[4:7], v2, s[8:11], s22 offen offset:1024 sc1
  buffer_load_dwordx4 a[8:11], v2, s[8:11], s22 offen offset:2048 sc1
  buffer_load_dwordx4 a[12:15], v2, s[8:11], s22 offen offset:3072 sc1
  s_add_u32 s22, s20, 4096
  buffer_load_dwordx4 a[16:19], v2, s[8:11], s22 offen offset:0 sc1
  buffer_load_dwordx4 a[20:23], v2, s[8:11], s22 offen offset:1024 sc1
  buffer_load_dwordx4 a[24:27], v2, s[8:11], s22 offen offset:2048 sc1
  buffer_load_dwordx4 a[28:31], v2, s[8:11], s22 offen offset:3072 sc1
  s_add_u32 s22, s20, 8192
  buffer_load_dwordx4 a[32:35], v2, s[8:11], s22 offen offset:0 sc1
  buffer_load_dwordx4 a[36:39], v2, s[8:11], s22 offen offset:1024 sc1
  buffer_load_dwordx4 a[40:43], v2, s[8:11], s22 offen offset:2048 sc1
  buffer_load_dwordx4 a[44:47], v2, s[8:11], s22 offen offset:3072 sc1
  s_add_u32 s22, s20, 12288
  buffer_load_dwordx4 a[48:51], v2, s[8:11], s22 offen offset:0 sc1
  buffer_load_dwordx4 a[52:55], v2, s[8:11], s22 offen offset:1024 sc1
  buffer_load_dwordx4 a[56:59], v2, s[8:11], s22 offen offset:2048 sc1
  buffer_load_dwordx4 a[60:63], v2, s[8:11], s22 offen offset:3072 sc1
  s_add_u32 s22, s20, 16384
  buffer_load_dwordx4 a[64:67], v2, s[8:11], s22 offen offset:0 sc1
  buffer_load_dwordx4 a[68:71], v2, s[8:11], s22 offen offset:1024 sc1
  buffer_load_dwordx4 a[72:75], v2, s[8:11], s22 offen offset:2048 sc1
  buffer_load_dwordx4 a[76:79], v2, s[8:11], s22 offen offset:3072 sc1
  s_add_u32 s22, s20, 20480
  buffer_load_dwordx4 a[80:83], v2, s[8:11], s22 offen offset:0 sc1
  buffer_load_dwordx4 a[84:87], v2, s[8:11], s22 offen offset:1024 sc1
  buffer_load_dwordx4 a[88:91], v2, s[8:11], s22 offen offset:2048 sc1
  buffer_load_dwordx4 a[92:95], v2, s[8:11], s22 offen offset:3072 sc1
  s_add_u32 s22, s20, 24576
  buffer_load_dwordx4 a[96:99], v2, s[8:11], s22 offen offset:0 sc1
  buffer_load_dwordx4 a[100:103], v2, s[8:11], s22 offen offset:1024 sc1
  buffer_load_dwordx4 a[104:107], v2, s[8:11], s22 offen offset:2048 sc1
  buffer_load_dwordx4 a[108:111], v2, s[8:11], s22 offen offset:3072 sc1
  s_add_u32 s22, s20, 28672
  buffer_load_dwordx4 a[112:115], v2, s[8:11], s22 offen offset:0 sc1
  buffer_load_dwordx4 a[116:119], v2, s[8:11], s22 offen offset:1024 sc1
  buffer_load_dwordx4 a[120:123], v2, s[8:11], s22 offen offset:2048 sc1
  buffer_load_dwordx4 a[124:127], v2, s[8:11], s22 offen offset:3072 sc1
  s_waitcnt vmcnt(24)
  s_add_u32 s22, s20, 32768
  buffer_load_dwordx4 a[128:131], v2, s[8:11], s22 offen offset:0 sc1
  buffer_load_dwordx4 a[132:135], v2, s[8:11], s22 offen offset:1024 sc1
  buffer_load_dwordx4 a[136:139], v2, s[8:11], s22 offen offset:2048 sc1
  buffer_load_dwordx4 a[140:143], v2, s[8:11], s22 offen offset:3072 sc1
  s_add_u32 s22, s20, 36864
  buffer_load_dwordx4 a[144:147], v2, s[8:11], s22 offen offset:0 sc1
  buffer_load_dwordx4 a[148:151], v2, s[8:11], s22 offen offset:1024 sc1
  buffer_load_dwordx4 a[152:155], v2, s[8:11], s22 offen offset:2048 sc1
  buffer_load_dwordx4 a[156:159], v2, s[8:11], s22 offen offset:3072 sc1
  s_add_u32 s22, s20, 40960
  buffer_load_dwordx4 a[160:163], v2, s[8:11], s22 offen offset:0 sc1
  buffer_load_dwordx4 a[164:167], v2, s[8:11], s22 offen offset:1024 sc1
  buffer_load_dwordx4 a[168:171], v2, s[8:11], s22 offen offset:2048 sc1
  buffer_load_dwordx4 a[172:175], v2, s[8:11], s22 offen offset:3072 sc1
  s_add_u32 s22, s20, 45056
  buffer_load_dwordx4 a[176:179], v2, s[8:11], s22 offen offset:0 sc1
  buffer_load_dwordx4 a[180:183], v2, s[8:11], s22 offen offset:1024 sc1
  buffer_load_dwordx4 a[184:187], v2, s[8:11], s22 offen offset:2048 sc1
  buffer_load_dwordx4 a[188:191], v2, s[8:11], s22 offen offset:3072 sc1
  s_add_u32 s22, s20, 49152
  buffer_load_dwordx4 a[192:195], v2, s[8:11], s22 offen offset:0 sc1
  buffer_load_dwordx4 a[196:199], v2, s[8:11], s22 offen offset:1024 sc1
  buffer_load_dwordx4 a[200:203], v2, s[8:11], s22 offen offset:2048 sc1
  buffer_load_dwordx4 a[204:207], v2, s[8:11], s22 offen offset:3072 sc1
  s_add_u32 s22, s20, 53248
  buffer_load_dwordx4 a[208:211], v2, s[8:11], s22 offen offset:0 sc1
  buffer_load_dwordx4 a[212:215], v2, s[8:11], s22 offen offset:1024 sc1
  buffer_load_dwordx4 a[216:219], v2, s[8:11], s22 offen offset:2048 sc1
  buffer_load_dwordx4 a[220:223], v2, s[8:11], s22 offen offset:3072 sc1
  s_add_u32 s22, s20, 57344
  buffer_load_dwordx4 a[224:227], v2, s[8:11], s22 offen offset:0 sc1
  buffer_load_dwordx4 a[228:231], v2, s[8:11], s22 offen offset:1024 sc1
  buffer_load_dwordx4 a[232:235], v2, s[8:11], s22 offen offset:2048 sc1
  buffer_load_dwordx4 a[236:239], v2, s[8:11], s22 offen offset:3072 sc1
  s_add_u32 s22, s20, 61440
  buffer_load_dwordx4 a[240:243], v2, s[8:11], s22 offen offset:0 sc1
  buffer_load_dwordx4 a[244:247], v2, s[8:11], s22 offen offset:1024 sc1
  buffer_load_dwordx4 a[248:251], v2, s[8:11], s22 offen offset:2048 sc1
  buffer_load_dwordx4 a[252:255], v2, s[8:11], s22 offen offset:3072 sc1
  s_waitcnt vmcnt(24)
  s_add_u32 s22, s20, 65536
  buffer_load_dwordx4 v[120:123], v2, s[8:11], s22 offen offset:0 sc1
  buffer_load_dwordx4 v[124:127], v2, s[8:11], s22 offen offset:1024 sc1
  buffer_load_dwordx4 v[128:131], v2, s[8:11], s22 offen offset:2048 sc1
  buffer_load_dwordx4 v[132:135], v2, s[8:11], s22 offen offset:3072 sc1
  s_add_u32 s22, s20, 69632
  buffer_load_dwordx4 v[136:139], v2, s[8:11], s22 offen offset:0 sc1
  buffer_load_dwordx4 v[140:143], v2, s[8:11], s22 offen offset:1024 sc1
  buffer_load_dwordx4 v[144:147], v2, s[8:11], s22 offen offset:2048 sc1
  buffer_load_dwordx4 v[148:151], v2, s[8:11], s22 offen offset:3072 sc1
  s_add_u32 s22, s20, 73728
  buffer_load_dwordx4 v[152:155], v2, s[8:11], s22 offen offset:0 sc1
  buffer_load_dwordx4 v[156:159], v2, s[8:11], s22 offen offset:1024 sc1
  buffer_load_dwordx4 v[160:163], v2, s[8:11], s22 offen offset:2048 sc1
  buffer_load_dwordx4 v[164:167], v2, s[8:11], s22 offen offset:3072 sc1
  s_add_u32 s22, s20, 77824
  buffer_load_dwordx4 v[168:171], v2, s[8:11], s22 offen offset:0 sc1
  buffer_load_dwordx4 v[172:175], v2, s[8:11], s22 offen offset:1024 sc1
  buffer_load_dwordx4 v[176:179], v2, s[8:11], s22 offen offset:2048 sc1
  buffer_load_dwordx4 v[180:183], v2, s[8:11], s22 offen offset:3072 sc1
  s_add_u32 s22, s20, 81920
  buffer_load_dwordx4 v[184:187], v2, s[8:11], s22 offen offset:0 sc1
  buffer_load_dwordx4 v[188:191], v2, s[8:11], s22 offen offset:1024 sc1
  buffer_load_dwordx4 v[192:195], v2, s[8:11], s22 offen offset:2048 sc1
  buffer_load_dwordx4 v[196:199], v2, s[8:11], s22 offen offset:3072 sc1
  s_add_u32 s22, s20, 86016
  buffer_load_dwordx4 v[200:203], v2, s[8:11], s22 offen offset:0 sc1
  buffer_load_dwordx4 v[204:207], v2, s[8:11], s22 offen offset:1024 sc1
  buffer_load_dwordx4 v[208:211], v2, s[8:11], s22 offen offset:2048 sc1
  buffer_load_dwordx4 v[212:215], v2, s[8:11], s22 offen offset:3072 sc1
  s_add_u32 s22, s20, 90112
  buffer_load_dwordx4 v[216:219], v2, s[8:11], s22 offen offset:0 sc1
  buffer_load_dwordx4 v[220:223], v2, s[8:11], s22 offen offset:1024 sc1
  buffer_load_dwordx4 v[224:227], v2, s[8:11], s22 offen offset:2048 sc1
  buffer_load_dwordx4 v[228:231], v2, s[8:11], s22 offen offset:3072 sc1
  s_add_u32 s22, s20, 94208
  buffer_load_dwordx4 v[232:235], v2, s[8:11], s22 offen offset:0 sc1
  buffer_load_dwordx4 v[236:239], v2, s[8:11], s22 offen offset:1024 sc1
  buffer_load_dwordx4 v[240:243], v2, s[8:11], s22 offen offset:2048 sc1
  buffer_load_dwordx4 v[244:247], v2, s[8:11], s22 offen offset:3072 sc1
  s_waitcnt vmcnt(24)
  s_add_u32 s22, s20, 98304
  buffer_load_dwordx4 v[248:251], v2, s[8:11], s22 offen offset:0 sc1
  buffer_load_dwordx4 v[252:255], v2, s[8:11], s22 offen offset:1024 sc1
  v_mov_b32 v5, 0x4444
  v_mov_b32 v6, 0xeeee
  v_cmp_lt_u32 vcc, 7, v4
  s_nop 1
  v_cndmask_b32 v5, v5, v6, vcc
  s_lshl_b32 s23, s16, 11
  v_lshrrev_b32 v80, 1, v3
  v_and_b32 v81, 1, v3
  v_add_u32 v82, 0, v80
  v_lshl_add_u32 v82, v82, 4, v4
  v_mul_u32_u24 v83, 2341, v82
  v_lshrrev_b32 v83, 16, v83
  v_mul_u32_u24 v84, 28, v83
  v_sub_u32 v84, v82, v84
  v_lshrrev_b32 v85, 4, v84
  v_and_b32 v84, 15, v84
  v_lshlrev_b32 v86, 10, v85
  v_lshl_add_u32 v86, v83, 8, v86
  v_lshl_add_u32 v86, v84, 4, v86
  v_lshl_add_u32 v86, v81, 3, v86
  v_add_u32 v72, s23, v86
  v_add_u32 v82, 2, v80
  v_lshl_add_u32 v82, v82, 4, v4
  v_mul_u32_u24 v83, 2341, v82
  v_lshrrev_b32 v83, 16, v83
  v_mul_u32_u24 v84, 28, v83
  v_sub_u32 v84, v82, v84
  v_lshrrev_b32 v85, 4, v84
  v_and_b32 v84, 15, v84
  v_lshlrev_b32 v86, 10, v85
  v_lshl_add_u32 v86, v83, 8, v86
  v_lshl_add_u32 v86, v84, 4, v86
  v_lshl_add_u32 v86, v81, 3, v86
  v_add_u32 v73, s23, v86
  v_add_u32 v82, 4, v80
  v_lshl_add_u32 v82, v82, 4, v4
  v_mul_u32_u24 v83, 2341, v82
  v_lshrrev_b32 v83, 16, v83
  v_mul_u32_u24 v84, 28, v83
  v_sub_u32 v84, v82, v84
  v_lshrrev_b32 v85, 4, v84
  v_and_b32 v84, 15, v84
  v_lshlrev_b32 v86, 10, v85
  v_lshl_add_u32 v86, v83, 8, v86
  v_lshl_add_u32 v86, v84, 4, v86
  v_lshl_add_u32 v86, v81, 3, v86
  v_add_u32 v74, s23, v86
  v_mov_b32 v82, 6
  v_lshl_add_u32 v82, v82, 4, v4
  v_mul_u32_u24 v83, 2341, v82
  v_lshrrev_b32 v83, 16, v83
  v_mul_u32_u24 v84, 28, v83
  v_sub_u32 v84, v82, v84
  v_lshrrev_b32 v85, 4, v84
  v_and_b32 v84, 15, v84
  v_lshlrev_b32 v86, 10, v85
  v_lshl_add_u32 v86, v83, 8, v86
  v_lshl_add_u32 v86, v84, 4, v86
  v_lshl_add_u32 v86, v81, 3, v86
  v_add_u32 v75, s23, v86
  v_add_u32 v76, s23, v2
  s_mul_i32 s27, s18, 448
  v_mov_b32 v77, s27
  v_mov_b32 v78, 1
  s_mov_b32 s17, s19
  s_mul_i32 s24, s19, 7168
  s_add_u32 s24, s24, 88002560
  s_mul_i32 s25, s18, 65
  s_add_u32 s25, s25, s19
  s_lshl_b32 s25, s25, 13
  s_add_u32 s25, s25, s23
  s_add_u32 s25, s25, 76869632
  s_lshl_b32 s26, s18, 6
  s_add_u32 s26, s26, s19
  s_lshl_b32 s26, s26, 4
  s_lshl_b32 s27, s16, 2
  s_add_u32 s26, s26, s27
  s_add_u32 s26, s26, 88502272
  v_mov_b32 v88, 0
  v_mov_b32 v89, 0
  v_mov_b32 v90, 0
  v_mov_b32 v91, 0
  v_mov_b32 v92, -1
  v_mov_b32 v93, -1
  v_mov_b32 v94, -1
  v_mov_b32 v95, -1
  ds_write_b128 v76, v[88:91]
  ds_write_b128 v76, v[88:91] offset:1024
  s_branch ws_arm
ws_loop:
  v_mov_b32 v36, 0
  v_mov_b32 v37, 0
  v_mov_b32 v38, 0
  v_mov_b32 v39, 0
  v_mov_b32 v40, 0
  v_mov_b32 v41, 0
  v_mov_b32 v42, 0
  v_mov_b32 v43, 0
  v_mov_b32 v44, 0
  v_mov_b32 v45, 0
  v_mov_b32 v46, 0
  v_mov_b32 v47, 0
  v_mov_b32 v48, 0
  v_mov_b32 v49, 0
  v_mov_b32 v50, 0
  v_mov_b32 v51, 0
  v_mov_b32 v52, 0
  v_mov_b32 v53, 0
  v_mov_b32 v54, 0
  v_mov_b32 v55, 0
  v_mov_b32 v56, 0
  v_mov_b32 v57, 0
  v_mov_b32 v58, 0
  v_mov_b32 v59, 0
  v_mov_b32 v60, 0
  v_mov_b32 v61, 0
  v_mov_b32 v62, 0
  v_mov_b32 v63, 0
  s_mov_b32 s30, 0
  s_branch ws_fl
ws_pm:
  s_cmp_ge_u32 s17, 64
  s_cbranch_scc1 ws_fl
  buffer_load_dword v79, v77, s[8:11], s24 offen sc1
  s_waitcnt vmcnt(0)
  v_cmp_eq_u32 vcc, -1, v79
  s_cbranch_vccnz ws_pr
ws_fl:
  s_add_u32 s22, s24, 4096
  buffer_load_dwordx4 v[8:11], v2, s[8:11], s24 offen offset:0 sc1
  buffer_load_dwordx4 v[12:15], v2, s[8:11], s24 offen offset:1024 sc1
  buffer_load_dwordx4 v[16:19], v2, s[8:11], s24 offen offset:2048 sc1
  buffer_load_dwordx4 v[20:23], v2, s[8:11], s24 offen offset:3072 sc1
  buffer_load_dwordx4 v[24:27], v2, s[8:11], s22 offen offset:0 sc1
  buffer_load_dwordx4 v[28:31], v2, s[8:11], s22 offen offset:1024 sc1
  buffer_load_dwordx4 v[32:35], v2, s[8:11], s22 offen offset:2048 sc1
  s_waitcnt vmcnt(0)
  v_max_u32 v79, v8, v9
  v_max3_u32 v79, v79, v10, v11
  v_max3_u32 v79, v79, v12, v13
  v_max3_u32 v79, v79, v14, v15
  v_max3_u32 v79, v79, v16, v17
  v_max3_u32 v79, v79, v18, v19
  v_max3_u32 v79, v79, v20, v21
  v_max3_u32 v79, v79, v22, v23
  v_max3_u32 v79, v79, v24, v25
  v_max3_u32 v79, v79, v26, v27
  v_max3_u32 v79, v79, v28, v29
  v_max3_u32 v79, v79, v30, v31
  v_max3_u32 v79, v79, v32, v33
  v_max3_u32 v79, v79, v34, v35
  v_cmp_eq_u32 vcc, -1, v79
  s_cbranch_vccz ws_pk
ws_pr:
  s_sleep 6
  s_add_u32 s30, s30, 1
  s_cmp_lt_u32 s30, 2000000
  s_cbranch_scc1 ws_pm
  s_branch cA_abort
ws_pk:
  v_smfmac_f32_16x16x64_bf16 v[36:39], v[8:11], a[0:7], v5
  v_smfmac_f32_16x16x64_bf16 v[36:39], v[12:15], a[8:15], v5
  v_smfmac_f32_16x16x64_bf16 v[36:39], v[16:19], a[16:23], v5
  v_smfmac_f32_16x16x64_bf16 v[36:39], v[20:23], a[24:31], v5
  v_smfmac_f32_16x16x64_bf16 v[36:39], v[24:27], a[32:39], v5
  v_smfmac_f32_16x16x64_bf16 v[36:39], v[28:31], a[40:47], v5
  v_smfmac_f32_16x16x64_bf16 v[36:39], v[32:35], a[48:55], v5
  v_smfmac_f32_16x16x64_bf16 v[40:43], v[8:11], a[56:63], v5
  v_smfmac_f32_16x16x64_bf16 v[40:43], v[12:15], a[64:71], v5
  v_smfmac_f32_16x16x64_bf16 v[40:43], v[16:19], a[72:79], v5
  v_smfmac_f32_16x16x64_bf16 v[40:43], v[20:23], a[80:87], v5
  v_smfmac_f32_16x16x64_bf16 v[40:43], v[24:27], a[88:95], v5
  v_smfmac_f32_16x16x64_bf16 v[40:43], v[28:31], a[96:103], v5
  v_smfmac_f32_16x16x64_bf16 v[40:43], v[32:35], a[104:111], v5
  v_smfmac_f32_16x16x64_bf16 v[44:47], v[8:11], a[112:119], v5
  v_smfmac_f32_16x16x64_bf16 v[44:47], v[12:15], a[120:127], v5
  v_smfmac_f32_16x16x64_bf16 v[44:47], v[16:19], a[128:135], v5
  v_smfmac_f32_16x16x64_bf16 v[44:47], v[20:23], a[136:143], v5
  v_smfmac_f32_16x16x64_bf16 v[44:47], v[24:27], a[144:151], v5
  v_smfmac_f32_16x16x64_bf16 v[44:47], v[28:31], a[152:159], v5
  v_smfmac_f32_16x16x64_bf16 v[44:47], v[32:35], a[160:167], v5
  v_smfmac_f32_16x16x64_bf16 v[48:51], v[8:11], a[168:175], v5
  v_smfmac_f32_16x16x64_bf16 v[48:51], v[12:15], a[176:183], v5
  v_smfmac_f32_16x16x64_bf16 v[48:51], v[16:19], a[184:191], v5
  v_smfmac_f32_16x16x64_bf16 v[48:51], v[20:23], a[192:199], v5
  v_smfmac_f32_16x16x64_bf16 v[48:51], v[24:27], a[200:207], v5
  v_smfmac_f32_16x16x64_bf16 v[48:51], v[28:31], a[208:215], v5
  v_smfmac_f32_16x16x64_bf16 v[48:51], v[32:35], a[216:223], v5
  v_smfmac_f32_16x16x64_bf16 v[52:55], v[8:11], a[224:231], v5
  v_smfmac_f32_16x16x64_bf16 v[52:55], v[12:15], a[232:239], v5
  v_smfmac_f32_16x16x64_bf16 v[52:55], v[16:19], a[240:247], v5
  v_smfmac_f32_16x16x64_bf16 v[52:55], v[20:23], a[248:255], v5
  v_smfmac_f32_16x16x64_bf16 v[52:55], v[24:27], v[120:127], v5
  v_smfmac_f32_16x16x64_bf16 v[52:55], v[28:31], v[128:135], v5
  v_smfmac_f32_16x16x64_bf16 v[52:55], v[32:35], v[136:143], v5
  v_smfmac_f32_16x16x64_bf16 v[56:59], v[8:11], v[144:151], v5
  v_smfmac_f32_16x16x64_bf16 v[56:59], v[12:15], v[152:159], v5
  v_smfmac_f32_16x16x64_bf16 v[56:59], v[16:19], v[160:167], v5
  v_smfmac_f32_16x16x64_bf16 v[56:59], v[20:23], v[168:175], v5
  v_smfmac_f32_16x16x64_bf16 v[56:59], v[24:27], v[176:183], v5
  v_smfmac_f32_16x16x64_bf16 v[56:59], v[28:31], v[184:191], v5
  v_smfmac_f32_16x16x64_bf16 v[56:59], v[32:35], v[192:199], v5
  v_smfmac_f32_16x16x64_bf16 v[60:63], v[8:11], v[200:207], v5
  v_smfmac_f32_16x16x64_bf16 v[60:63], v[12:15], v[208:215], v5
  v_smfmac_f32_16x16x64_bf16 v[60:63], v[16:19], v[216:223], v5
  v_smfmac_f32_16x16x64_bf16 v[60:63], v[20:23], v[224:231], v5
  v_smfmac_f32_16x16x64_bf16 v[60:63], v[24:27], v[232:239], v5
  v_smfmac_f32_16x16x64_bf16 v[60:63], v[28:31], v[240:247], v5
  v_smfmac_f32_16x16x64_bf16 v[60:63], v[32:35], v[248:255], v5
  v_permlane32_swap_b32 v36, v40
  v_permlane32_swap_b32 v37, v41
  v_permlane32_swap_b32 v38, v42
  v_permlane32_swap_b32 v39, v43
  v_add_f32 v36, v36, v40
  v_add_f32 v37, v37, v41
  v_add_f32 v38, v38, v42
  v_add_f32 v39, v39, v43
  v_cvt_pk_bf16_f32 v40, v36, v37
  v_cvt_pk_bf16_f32 v41, v38, v39
  v_min_u32 v40, -2, v40
  v_min_u32 v41, -2, v41
  ds_write_b64 v72, v[40:41]
  v_permlane32_swap_b32 v44, v48
  v_permlane32_swap_b32 v45, v49
  v_permlane32_swap_b32 v46, v50
  v_permlane32_swap_b32 v47, v51
  v_add_f32 v44, v44, v48
  v_add_f32 v45, v45, v49
  v_add_f32 v46, v46, v50
  v_add_f32 v47, v47, v51
  v_cvt_pk_bf16_f32 v48, v44, v45
  v_cvt_pk_bf16_f32 v49, v46, v47
  v_min_u32 v48, -2, v48
  v_min_u32 v49, -2, v49
  ds_write_b64 v73, v[48:49]
  v_permlane32_swap_b32 v52, v56
  v_permlane32_swap_b32 v53, v57
  v_permlane32_swap_b32 v54, v58
  v_permlane32_swap_b32 v55, v59
  v_add_f32 v52, v52, v56
  v_add_f32 v53, v53, v57
  v_add_f32 v54, v54, v58
  v_add_f32 v55, v55, v59
  v_cvt_pk_bf16_f32 v56, v52, v53
  v_cvt_pk_bf16_f32 v57, v54, v55
  v_min_u32 v56, -2, v56
  v_min_u32 v57, -2, v57
  ds_write_b64 v74, v[56:57]
  v_mov_b32 v64, v60
  v_mov_b32 v65, v61
  v_mov_b32 v66, v62
  v_mov_b32 v67, v63
  v_permlane32_swap_b32 v60, v64
  v_permlane32_swap_b32 v61, v65
  v_permlane32_swap_b32 v62, v66
  v_permlane32_swap_b32 v63, v67
  v_add_f32 v60, v60, v64
  v_add_f32 v61, v61, v65
  v_add_f32 v62, v62, v66
  v_add_f32 v63, v63, v67
  v_cvt_pk_bf16_f32 v64, v60, v61
  v_cvt_pk_bf16_f32 v65, v62, v63
  v_min_u32 v64, -2, v64
  v_min_u32 v65, -2, v65
  ds_write_b64 v75, v[64:65]
  s_waitcnt lgkmcnt(0)
  ds_read_b128 v[64:67], v76
  ds_read_b128 v[68:71], v76 offset:1024
  s_waitcnt lgkmcnt(0)
  buffer_store_dwordx4 v[64:67], v2, s[8:11], s25 offen sc1
  buffer_store_dwordx4 v[68:71], v2, s[8:11], s25 offen offset:1024 sc1
  s_add_u32 s24, s24, 14336
  s_add_u32 s25, s25, 16384
  s_add_u32 s26, s26, 32
  s_add_u32 s17, s17, 2
  s_cmp_ge_u32 s17, 64
  s_cbranch_scc1 ws_end
ws_arm:
  buffer_store_dwordx4 v[92:95], v2, s[8:11], s25 offen sc1
  buffer_store_dwordx4 v[92:95], v2, s[8:11], s25 offen offset:1024 sc1
  s_waitcnt vmcnt(0)
  s_mov_b64 exec, 1
  buffer_store_dword v78, v2, s[8:11], s26 offen sc1
  s_mov_b64 exec, -1
  s_branch ws_loop
ws_end:
  v_mov_b32 v250, 0
  s_branch wk_loop
wk_s4d:
  s_sub_u32 s3, s3, 624
  s_load_dwordx8 s[40:47], s[0:1], 0
  s_load_dwordx4 s[48:51], s[0:1], 32
  s_load_dwordx2 s[52:53], s[0:1], 48
  s_load_dwordx2 s[54:55], s[0:1], 112
  v_lshrrev_b32 v1, 6, v0
  s_nop 0
  v_readfirstlane_b32 s16, v1
  v_and_b32 v1, 63, v0
  v_lshrrev_b32 v3, 4, v1
  v_and_b32 v4, 15, v1
  s_mul_i32 s17, s16, 24576
  s_waitcnt lgkmcnt(0)
  s_mov_b32 s60, s40
  s_and_b32 s61, s41, 0xffff
  s_mov_b32 s62, 1835008
  s_mov_b32 s63, 0x20000
  s_mov_b32 s64, s42
  s_and_b32 s65, s43, 0xffff
  s_mov_b32 s66, 229376
  s_mov_b32 s67, 0x20000
  s_mov_b32 s68, s44
  s_and_b32 s69, s45, 0xffff
  s_mov_b32 s70, 229376
  s_mov_b32 s71, 0x20000
  s_mov_b32 s72, s46
  s_and_b32 s73, s47, 0xffff
  s_mov_b32 s74, 229376
  s_mov_b32 s75, 0x20000
  s_mov_b32 s76, s48
  s_and_b32 s77, s49, 0xffff
  s_mov_b32 s78, 229376
  s_mov_b32 s79, 0x20000
  s_mov_b32 s80, s50
  s_and_b32 s81, s51, 0xffff
  s_mov_b32 s82, 896
  s_mov_b32 s83, 0x20000
  s_mov_b32 s84, s52
  s_and_b32 s85, s53, 0xffff
  s_mov_b32 s86, 896
  s_mov_b32 s87, 0x20000
  s_mov_b32 s88, s54
  s_and_b32 s89, s55, 0xffff
  s_mov_b32 s90, 3670016
  s_mov_b32 s91, 0x20000
  v_lshlrev_b32 v5, 5, v1
  v_sub_u32 v5, 2047, v5
  s_add_u32 s18, s17, 13056
  v_subrev_u32 v6, 0, v5
  v_max_i32 v7, 0, v6
  v_cvt_f32_u32 v7, v7
  v_cvt_pk_bf16_f32 v8, v7, v7
  v_and_b32 v7, 0xffff0000, v8
  v_lshrrev_b32 v8, 23, v7
  v_subrev_u32 v8, 134, v8
  v_max_i32 v8, 0, v8
  v_cvt_u32_f32 v7, v7
  v_lshrrev_b32 v7, v8, v7
  v_lshl_add_u32 v7, v8, 8, v7
  v_lshl_add_u32 v200, v7, 2, s18
  v_subrev_u32 v6, 1, v5
  v_max_i32 v7, 0, v6
  v_cvt_f32_u32 v7, v7
  v_cvt_pk_bf16_f32 v8, v7, v7
  v_and_b32 v7, 0xffff0000, v8
  v_lshrrev_b32 v8, 23, v7
  v_subrev_u32 v8, 134, v8
  v_max_i32 v8, 0, v8
  v_cvt_u32_f32 v7, v7
  v_lshrrev_b32 v7, v8, v7
  v_lshl_add_u32 v7, v8, 8, v7
  v_lshl_add_u32 v201, v7, 2, s18
  v_subrev_u32 v6, 2, v5
  v_max_i32 v7, 0, v6
  v_cvt_f32_u32 v7, v7
  v_cvt_pk_bf16_f32 v8, v7, v7
  v_and_b32 v7, 0xffff0000, v8
  v_lshrrev_b32 v8, 23, v7
  v_subrev_u32 v8, 134, v8
  v_max_i32 v8, 0, v8
  v_cvt_u32_f32 v7, v7
  v_lshrrev_b32 v7, v8, v7
  v_lshl_add_u32 v7, v8, 8, v7
  v_lshl_add_u32 v202, v7, 2, s18
  v_subrev_u32 v6, 3, v5
  v_max_i32 v7, 0, v6
  v_cvt_f32_u32 v7, v7
  v_cvt_pk_bf16_f32 v8, v7, v7
  v_and_b32 v7, 0xffff0000, v8
  v_lshrrev_b32 v8, 23, v7
  v_subrev_u32 v8, 134, v8
  v_max_i32 v8, 0, v8
  v_cvt_u32_f32 v7, v7
  v_lshrrev_b32 v7, v8, v7
  v_lshl_add_u32 v7, v8, 8, v7
  v_lshl_add_u32 v203, v7, 2, s18
  v_subrev_u32 v6, 4, v5
  v_max_i32 v7, 0, v6
  v_cvt_f32_u32 v7, v7
  v_cvt_pk_bf16_f32 v8, v7, v7
  v_and_b32 v7, 0xffff0000, v8
  v_lshrrev_b32 v8, 23, v7
  v_subrev_u32 v8, 134, v8
  v_max_i32 v8, 0, v8
  v_cvt_u32_f32 v7, v7
  v_lshrrev_b32 v7, v8, v7
  v_lshl_add_u32 v7, v8, 8, v7
  v_lshl_add_u32 v204, v7, 2, s18
  v_subrev_u32 v6, 5, v5
  v_max_i32 v7, 0, v6
  v_cvt_f32_u32 v7, v7
  v_cvt_pk_bf16_f32 v8, v7, v7
  v_and_b32 v7, 0xffff0000, v8
  v_lshrrev_b32 v8, 23, v7
  v_subrev_u32 v8, 134, v8
  v_max_i32 v8, 0, v8
  v_cvt_u32_f32 v7, v7
  v_lshrrev_b32 v7, v8, v7
  v_lshl_add_u32 v7, v8, 8, v7
  v_lshl_add_u32 v205, v7, 2, s18
  v_subrev_u32 v6, 6, v5
  v_max_i32 v7, 0, v6
  v_cvt_f32_u32 v7, v7
  v_cvt_pk_bf16_f32 v8, v7, v7
  v_and_b32 v7, 0xffff0000, v8
  v_lshrrev_b32 v8, 23, v7
  v_subrev_u32 v8, 134, v8
  v_max_i32 v8, 0, v8
  v_cvt_u32_f32 v7, v7
  v_lshrrev_b32 v7, v8, v7
  v_lshl_add_u32 v7, v8, 8, v7
  v_lshl_add_u32 v206, v7, 2, s18
  v_subrev_u32 v6, 7, v5
  v_max_i32 v7, 0, v6
  v_cvt_f32_u32 v7, v7
  v_cvt_pk_bf16_f32 v8, v7, v7
  v_and_b32 v7, 0xffff0000, v8
  v_lshrrev_b32 v8, 23, v7
  v_subrev_u32 v8, 134, v8
  v_max_i32 v8, 0, v8
  v_cvt_u32_f32 v7, v7
  v_lshrrev_b32 v7, v8, v7
  v_lshl_add_u32 v7, v8, 8, v7
  v_lshl_add_u32 v207, v7, 2, s18
  v_subrev_u32 v6, 8, v5
  v_max_i32 v7, 0, v6
  v_cvt_f32_u32 v7, v7
  v_cvt_pk_bf16_f32 v8, v7, v7
  v_and_b32 v7, 0xffff0000, v8
  v_lshrrev_b32 v8, 23, v7
  v_subrev_u32 v8, 134, v8
  v_max_i32 v8, 0, v8
  v_cvt_u32_f32 v7, v7
  v_lshrrev_b32 v7, v8, v7
  v_lshl_add_u32 v7, v8, 8, v7
  v_lshl_add_u32 v208, v7, 2, s18
  v_subrev_u32 v6, 9, v5
  v_max_i32 v7, 0, v6
  v_cvt_f32_u32 v7, v7
  v_cvt_pk_bf16_f32 v8, v7, v7
  v_and_b32 v7, 0xffff0000, v8
  v_lshrrev_b32 v8, 23, v7
  v_subrev_u32 v8, 134, v8
  v_max_i32 v8, 0, v8
  v_cvt_u32_f32 v7, v7
  v_lshrrev_b32 v7, v8, v7
  v_lshl_add_u32 v7, v8, 8, v7
  v_lshl_add_u32 v209, v7, 2, s18
  v_subrev_u32 v6, 10, v5
  v_max_i32 v7, 0, v6
  v_cvt_f32_u32 v7, v7
  v_cvt_pk_bf16_f32 v8, v7, v7
  v_and_b32 v7, 0xffff0000, v8
  v_lshrrev_b32 v8, 23, v7
  v_subrev_u32 v8, 134, v8
  v_max_i32 v8, 0, v8
  v_cvt_u32_f32 v7, v7
  v_lshrrev_b32 v7, v8, v7
  v_lshl_add_u32 v7, v8, 8, v7
  v_lshl_add_u32 v210, v7, 2, s18
  v_subrev_u32 v6, 11, v5
  v_max_i32 v7, 0, v6
  v_cvt_f32_u32 v7, v7
  v_cvt_pk_bf16_f32 v8, v7, v7
  v_and_b32 v7, 0xffff0000, v8
  v_lshrrev_b32 v8, 23, v7
  v_subrev_u32 v8, 134, v8
  v_max_i32 v8, 0, v8
  v_cvt_u32_f32 v7, v7
  v_lshrrev_b32 v7, v8, v7
  v_lshl_add_u32 v7, v8, 8, v7
  v_lshl_add_u32 v211, v7, 2, s18
  v_subrev_u32 v6, 12, v5
  v_max_i32 v7, 0, v6
  v_cvt_f32_u32 v7, v7
  v_cvt_pk_bf16_f32 v8, v7, v7
  v_and_b32 v7, 0xffff0000, v8
  v_lshrrev_b32 v8, 23, v7
  v_subrev_u32 v8, 134, v8
  v_max_i32 v8, 0, v8
  v_cvt_u32_f32 v7, v7
  v_lshrrev_b32 v7, v8, v7
  v_lshl_add_u32 v7, v8, 8, v7
  v_lshl_add_u32 v212, v7, 2, s18
  v_subrev_u32 v6, 13, v5
  v_max_i32 v7, 0, v6
  v_cvt_f32_u32 v7, v7
  v_cvt_pk_bf16_f32 v8, v7, v7
  v_and_b32 v7, 0xffff0000, v8
  v_lshrrev_b32 v8, 23, v7
  v_subrev_u32 v8, 134, v8
  v_max_i32 v8, 0, v8
  v_cvt_u32_f32 v7, v7
  v_lshrrev_b32 v7, v8, v7
  v_lshl_add_u32 v7, v8, 8, v7
  v_lshl_add_u32 v213, v7, 2, s18
  v_subrev_u32 v6, 14, v5
  v_max_i32 v7, 0, v6
  v_cvt_f32_u32 v7, v7
  v_cvt_pk_bf16_f32 v8, v7, v7
  v_and_b32 v7, 0xffff0000, v8
  v_lshrrev_b32 v8, 23, v7
  v_subrev_u32 v8, 134, v8
  v_max_i32 v8, 0, v8
  v_cvt_u32_f32 v7, v7
  v_lshrrev_b32 v7, v8, v7
  v_lshl_add_u32 v7, v8, 8, v7
  v_lshl_add_u32 v214, v7, 2, s18
  v_subrev_u32 v6, 15, v5
  v_max_i32 v7, 0, v6
  v_cvt_f32_u32 v7, v7
  v_cvt_pk_bf16_f32 v8, v7, v7
  v_and_b32 v7, 0xffff0000, v8
  v_lshrrev_b32 v8, 23, v7
  v_subrev_u32 v8, 134, v8
  v_max_i32 v8, 0, v8
  v_cvt_u32_f32 v7, v7
  v_lshrrev_b32 v7, v8, v7
  v_lshl_add_u32 v7, v8, 8, v7
  v_lshl_add_u32 v215, v7, 2, s18
  v_subrev_u32 v6, 16, v5
  v_max_i32 v7, 0, v6
  v_cvt_f32_u32 v7, v7
  v_cvt_pk_bf16_f32 v8, v7, v7
  v_and_b32 v7, 0xffff0000, v8
  v_lshrrev_b32 v8, 23, v7
  v_subrev_u32 v8, 134, v8
  v_max_i32 v8, 0, v8
  v_cvt_u32_f32 v7, v7
  v_lshrrev_b32 v7, v8, v7
  v_lshl_add_u32 v7, v8, 8, v7
  v_lshl_add_u32 v216, v7, 2, s18
  v_subrev_u32 v6, 17, v5
  v_max_i32 v7, 0, v6
  v_cvt_f32_u32 v7, v7
  v_cvt_pk_bf16_f32 v8, v7, v7
  v_and_b32 v7, 0xffff0000, v8
  v_lshrrev_b32 v8, 23, v7
  v_subrev_u32 v8, 134, v8
  v_max_i32 v8, 0, v8
  v_cvt_u32_f32 v7, v7
  v_lshrrev_b32 v7, v8, v7
  v_lshl_add_u32 v7, v8, 8, v7
  v_lshl_add_u32 v217, v7, 2, s18
  v_subrev_u32 v6, 18, v5
  v_max_i32 v7, 0, v6
  v_cvt_f32_u32 v7, v7
  v_cvt_pk_bf16_f32 v8, v7, v7
  v_and_b32 v7, 0xffff0000, v8
  v_lshrrev_b32 v8, 23, v7
  v_subrev_u32 v8, 134, v8
  v_max_i32 v8, 0, v8
  v_cvt_u32_f32 v7, v7
  v_lshrrev_b32 v7, v8, v7
  v_lshl_add_u32 v7, v8, 8, v7
  v_lshl_add_u32 v218, v7, 2, s18
  v_subrev_u32 v6, 19, v5
  v_max_i32 v7, 0, v6
  v_cvt_f32_u32 v7, v7
  v_cvt_pk_bf16_f32 v8, v7, v7
  v_and_b32 v7, 0xffff0000, v8
  v_lshrrev_b32 v8, 23, v7
  v_subrev_u32 v8, 134, v8
  v_max_i32 v8, 0, v8
  v_cvt_u32_f32 v7, v7
  v_lshrrev_b32 v7, v8, v7
  v_lshl_add_u32 v7, v8, 8, v7
  v_lshl_add_u32 v219, v7, 2, s18
  v_subrev_u32 v6, 20, v5
  v_max_i32 v7, 0, v6
  v_cvt_f32_u32 v7, v7
  v_cvt_pk_bf16_f32 v8, v7, v7
  v_and_b32 v7, 0xffff0000, v8
  v_lshrrev_b32 v8, 23, v7
  v_subrev_u32 v8, 134, v8
  v_max_i32 v8, 0, v8
  v_cvt_u32_f32 v7, v7
  v_lshrrev_b32 v7, v8, v7
  v_lshl_add_u32 v7, v8, 8, v7
  v_lshl_add_u32 v220, v7, 2, s18
  v_subrev_u32 v6, 21, v5
  v_max_i32 v7, 0, v6
  v_cvt_f32_u32 v7, v7
  v_cvt_pk_bf16_f32 v8, v7, v7
  v_and_b32 v7, 0xffff0000, v8
  v_lshrrev_b32 v8, 23, v7
  v_subrev_u32 v8, 134, v8
  v_max_i32 v8, 0, v8
  v_cvt_u32_f32 v7, v7
  v_lshrrev_b32 v7, v8, v7
  v_lshl_add_u32 v7, v8, 8, v7
  v_lshl_add_u32 v221, v7, 2, s18
  v_subrev_u32 v6, 22, v5
  v_max_i32 v7, 0, v6
  v_cvt_f32_u32 v7, v7
  v_cvt_pk_bf16_f32 v8, v7, v7
  v_and_b32 v7, 0xffff0000, v8
  v_lshrrev_b32 v8, 23, v7
  v_subrev_u32 v8, 134, v8
  v_max_i32 v8, 0, v8
  v_cvt_u32_f32 v7, v7
  v_lshrrev_b32 v7, v8, v7
  v_lshl_add_u32 v7, v8, 8, v7
  v_lshl_add_u32 v222, v7, 2, s18
  v_subrev_u32 v6, 23, v5
  v_max_i32 v7, 0, v6
  v_cvt_f32_u32 v7, v7
  v_cvt_pk_bf16_f32 v8, v7, v7
  v_and_b32 v7, 0xffff0000, v8
  v_lshrrev_b32 v8, 23, v7
  v_subrev_u32 v8, 134, v8
  v_max_i32 v8, 0, v8
  v_cvt_u32_f32 v7, v7
  v_lshrrev_b32 v7, v8, v7
  v_lshl_add_u32 v7, v8, 8, v7
  v_lshl_add_u32 v223, v7, 2, s18
  v_subrev_u32 v6, 24, v5
  v_max_i32 v7, 0, v6
  v_cvt_f32_u32 v7, v7
  v_cvt_pk_bf16_f32 v8, v7, v7
  v_and_b32 v7, 0xffff0000, v8
  v_lshrrev_b32 v8, 23, v7
  v_subrev_u32 v8, 134, v8
  v_max_i32 v8, 0, v8
  v_cvt_u32_f32 v7, v7
  v_lshrrev_b32 v7, v8, v7
  v_lshl_add_u32 v7, v8, 8, v7
  v_lshl_add_u32 v224, v7, 2, s18
  v_subrev_u32 v6, 25, v5
  v_max_i32 v7, 0, v6
  v_cvt_f32_u32 v7, v7
  v_cvt_pk_bf16_f32 v8, v7, v7
  v_and_b32 v7, 0xffff0000, v8
  v_lshrrev_b32 v8, 23, v7
  v_subrev_u32 v8, 134, v8
  v_max_i32 v8, 0, v8
  v_cvt_u32_f32 v7, v7
  v_lshrrev_b32 v7, v8, v7
  v_lshl_add_u32 v7, v8, 8, v7
  v_lshl_add_u32 v225, v7, 2, s18
  v_subrev_u32 v6, 26, v5
  v_max_i32 v7, 0, v6
  v_cvt_f32_u32 v7, v7
  v_cvt_pk_bf16_f32 v8, v7, v7
  v_and_b32 v7, 0xffff0000, v8
  v_lshrrev_b32 v8, 23, v7
  v_subrev_u32 v8, 134, v8
  v_max_i32 v8, 0, v8
  v_cvt_u32_f32 v7, v7
  v_lshrrev_b32 v7, v8, v7
  v_lshl_add_u32 v7, v8, 8, v7
  v_lshl_add_u32 v226, v7, 2, s18
  v_subrev_u32 v6, 27, v5
  v_max_i32 v7, 0, v6
  v_cvt_f32_u32 v7, v7
  v_cvt_pk_bf16_f32 v8, v7, v7
  v_and_b32 v7, 0xffff0000, v8
  v_lshrrev_b32 v8, 23, v7
  v_subrev_u32 v8, 134, v8
  v_max_i32 v8, 0, v8
  v_cvt_u32_f32 v7, v7
  v_lshrrev_b32 v7, v8, v7
  v_lshl_add_u32 v7, v8, 8, v7
  v_lshl_add_u32 v227, v7, 2, s18
  v_subrev_u32 v6, 28, v5
  v_max_i32 v7, 0, v6
  v_cvt_f32_u32 v7, v7
  v_cvt_pk_bf16_f32 v8, v7, v7
  v_and_b32 v7, 0xffff0000, v8
  v_lshrrev_b32 v8, 23, v7
  v_subrev_u32 v8, 134, v8
  v_max_i32 v8, 0, v8
  v_cvt_u32_f32 v7, v7
  v_lshrrev_b32 v7, v8, v7
  v_lshl_add_u32 v7, v8, 8, v7
  v_lshl_add_u32 v228, v7, 2, s18
  v_subrev_u32 v6, 29, v5
  v_max_i32 v7, 0, v6
  v_cvt_f32_u32 v7, v7
  v_cvt_pk_bf16_f32 v8, v7, v7
  v_and_b32 v7, 0xffff0000, v8
  v_lshrrev_b32 v8, 23, v7
  v_subrev_u32 v8, 134, v8
  v_max_i32 v8, 0, v8
  v_cvt_u32_f32 v7, v7
  v_lshrrev_b32 v7, v8, v7
  v_lshl_add_u32 v7, v8, 8, v7
  v_lshl_add_u32 v229, v7, 2, s18
  v_subrev_u32 v6, 30, v5
  v_max_i32 v7, 0, v6
  v_cvt_f32_u32 v7, v7
  v_cvt_pk_bf16_f32 v8, v7, v7
  v_and_b32 v7, 0xffff0000, v8
  v_lshrrev_b32 v8, 23, v7
  v_subrev_u32 v8, 134, v8
  v_max_i32 v8, 0, v8
  v_cvt_u32_f32 v7, v7
  v_lshrrev_b32 v7, v8, v7
  v_lshl_add_u32 v7, v8, 8, v7
  v_lshl_add_u32 v230, v7, 2, s18
  v_subrev_u32 v6, 31, v5
  v_max_i32 v7, 0, v6
  v_cvt_f32_u32 v7, v7
  v_cvt_pk_bf16_f32 v8, v7, v7
  v_and_b32 v7, 0xffff0000, v8
  v_lshrrev_b32 v8, 23, v7
  v_subrev_u32 v8, 134, v8
  v_max_i32 v8, 0, v8
  v_cvt_u32_f32 v7, v7
  v_lshrrev_b32 v7, v8, v7
  v_lshl_add_u32 v7, v8, 8, v7
  v_lshl_add_u32 v231, v7, 2, s18
  v_subrev_u32 v6, 32, v5
  v_max_i32 v7, 0, v6
  v_cvt_f32_u32 v7, v7
  v_cvt_pk_bf16_f32 v8, v7, v7
  v_and_b32 v7, 0xffff0000, v8
  v_lshrrev_b32 v8, 23, v7
  v_subrev_u32 v8, 134, v8
  v_max_i32 v8, 0, v8
  v_cvt_u32_f32 v7, v7
  v_lshrrev_b32 v7, v8, v7
  v_lshl_add_u32 v7, v8, 8, v7
  v_mov_b32 v8, 1280
  v_cmp_gt_i32 vcc, 0, v6
  s_nop 1
  v_cndmask_b32 v7, v7, v8, vcc
  v_lshl_add_u32 v232, v7, 2, s18
  v_mov_b32 v8, 0
  v_mov_b32 v9, 0
  v_lshlrev_b32 v5, 3, v1
  v_add_u32 v5, s17, v5
  ds_write_b64 v5, v[8:9]
  v_and_b32 v6, 15, v1
  v_lshlrev_b32 v6, 3, v6
  v_add_u32 v6, s17, v6
  ds_write_b64 v6, v[8:9] offset:8704
  ds_write_b64 v6, v[8:9] offset:12928
  v_mov_b32 v6, s17
  ds_write_b64 v6, v[8:9] offset:18176
  s_lshl_b32 s19, s3, 2
  s_add_u32 s20, s19, s16
  s_lshl_b32 s21, s3, 3
  v_mul_u32_u24 v5, 3584, v0
  s_add_u32 s22, s21, 0
  buffer_load_dwordx2 v[8:9], v5, s[60:63], s22 offen offset:0
  buffer_load_dwordx2 v[10:11], v5, s[60:63], s22 offen offset:896
  buffer_load_dwordx2 v[12:13], v5, s[60:63], s22 offen offset:1792
  buffer_load_dwordx2 v[14:15], v5, s[60:63], s22 offen offset:2688
  s_add_u32 s22, s21, 917504
  buffer_load_dwordx2 v[16:17], v5, s[60:63], s22 offen offset:0
  buffer_load_dwordx2 v[18:19], v5, s[60:63], s22 offen offset:896
  buffer_load_dwordx2 v[20:21], v5, s[60:63], s22 offen offset:1792
  buffer_load_dwordx2 v[22:23], v5, s[60:63], s22 offen offset:2688
  s_lshl_b32 s22, s20, 9
  v_lshlrev_b32 v6, 3, v1
  buffer_load_dwordx2 v[24:25], v6, s[64:67], s22 offen
  buffer_load_dwordx2 v[26:27], v6, s[68:71], s22 offen
  buffer_load_dwordx2 v[28:29], v6, s[72:75], s22 offen
  buffer_load_dwordx2 v[30:31], v6, s[76:79], s22 offen
  s_lshl_b32 s22, s20, 1
  v_mov_b32 v7, 0
  buffer_load_ushort v32, v7, s[80:83], s22 offen
  buffer_load_ushort v33, v7, s[84:87], s22 offen
  s_mov_b32 s24, 0x05040100
  s_mov_b32 s25, 0x07060302
  s_barrier
  s_waitcnt vmcnt(6)
  v_lshlrev_b32 v6, 3, v0
  v_perm_b32 v34, v10, v8, s24
  v_perm_b32 v35, v14, v12, s24
  v_add_u32 v36, 512, v6
  ds_write_b64 v36, v[34:35]
  v_perm_b32 v34, v10, v8, s25
  v_perm_b32 v35, v14, v12, s25
  v_add_u32 v36, 25088, v6
  ds_write_b64 v36, v[34:35]
  v_perm_b32 v34, v11, v9, s24
  v_perm_b32 v35, v15, v13, s24
  v_add_u32 v36, 49664, v6
  ds_write_b64 v36, v[34:35]
  v_perm_b32 v34, v11, v9, s25
  v_perm_b32 v35, v15, v13, s25
  v_add_u32 v36, 74240, v6
  ds_write_b64 v36, v[34:35]
  v_perm_b32 v34, v18, v16, s24
  v_perm_b32 v35, v22, v20, s24
  v_add_u32 v36, 2560, v6
  ds_write_b64 v36, v[34:35]
  v_perm_b32 v34, v18, v16, s25
  v_perm_b32 v35, v22, v20, s25
  v_add_u32 v36, 27136, v6
  ds_write_b64 v36, v[34:35]
  v_perm_b32 v34, v19, v17, s24
  v_perm_b32 v35, v23, v21, s24
  v_add_u32 v36, 51712, v6
  ds_write_b64 v36, v[34:35]
  v_perm_b32 v34, v19, v17, s25
  v_perm_b32 v35, v23, v21, s25
  v_add_u32 v36, 76288, v6
  ds_write_b64 v36, v[34:35]
  s_waitcnt vmcnt(0)
  s_mov_b32 s26, 1069066811
  s_mov_b32 s27, 1042479491
  v_lshlrev_b32 v32, 16, v32
  v_lshlrev_b32 v33, 16, v33
  v_mul_f32 v32, s26, v32
  v_exp_f32 v32, v32
  s_nop 0
  v_cvt_pk_bf16_f32 v34, v32, v32
  v_and_b32 v32, 0xffff0000, v34
  v_lshlrev_b32 v37, 6, v1
  v_add_u32 v37, s17, v37
  v_lshlrev_b32 v40, 16, v24
  v_lshlrev_b32 v41, 16, v26
  v_lshlrev_b32 v42, 16, v28
  v_lshlrev_b32 v43, 16, v30
  v_mul_f32 v40, s26, v40
  v_exp_f32 v40, v40
  s_nop 0
  v_cvt_pk_bf16_f32 v34, v40, v40
  v_and_b32 v40, 0xffff0000, v34
  v_mul_f32 v40, v40, v32
  v_mul_f32 v40, s26, v40
  v_sub_f32 v40, 0, v40
  v_mul_f32 v41, v41, v32
  v_mul_f32 v41, s27, v41
  v_mul_f32 v42, v42, v32
  v_mul_f32 v43, v43, v32
  v_add_f32 v42, v42, v42
  v_add_f32 v43, v43, v43
  ds_write_b128 v37, v[40:43] offset:18240
  v_and_b32 v40, 0xffff0000, v24
  v_and_b32 v41, 0xffff0000, v26
  v_and_b32 v42, 0xffff0000, v28
  v_and_b32 v43, 0xffff0000, v30
  v_mul_f32 v40, s26, v40
  v_exp_f32 v40, v40
  s_nop 0
  v_cvt_pk_bf16_f32 v34, v40, v40
  v_and_b32 v40, 0xffff0000, v34
  v_mul_f32 v40, v40, v32
  v_mul_f32 v40, s26, v40
  v_sub_f32 v40, 0, v40
  v_mul_f32 v41, v41, v32
  v_mul_f32 v41, s27, v41
  v_mul_f32 v42, v42, v32
  v_mul_f32 v43, v43, v32
  v_add_f32 v42, v42, v42
  v_add_f32 v43, v43, v43
  ds_write_b128 v37, v[40:43] offset:18256
  v_lshlrev_b32 v40, 16, v25
  v_lshlrev_b32 v41, 16, v27
  v_lshlrev_b32 v42, 16, v29
  v_lshlrev_b32 v43, 16, v31
  v_mul_f32 v40, s26, v40
  v_exp_f32 v40, v40
  s_nop 0
  v_cvt_pk_bf16_f32 v34, v40, v40
  v_and_b32 v40, 0xffff0000, v34
  v_mul_f32 v40, v40, v32
  v_mul_f32 v40, s26, v40
  v_sub_f32 v40, 0, v40
  v_mul_f32 v41, v41, v32
  v_mul_f32 v41, s27, v41
  v_mul_f32 v42, v42, v32
  v_mul_f32 v43, v43, v32
  v_add_f32 v42, v42, v42
  v_add_f32 v43, v43, v43
  ds_write_b128 v37, v[40:43] offset:18272
  v_and_b32 v40, 0xffff0000, v25
  v_and_b32 v41, 0xffff0000, v27
  v_and_b32 v42, 0xffff0000, v29
  v_and_b32 v43, 0xffff0000, v31
  v_mul_f32 v40, s26, v40
  v_exp_f32 v40, v40
  s_nop 0
  v_cvt_pk_bf16_f32 v34, v40, v40
  v_and_b32 v40, 0xffff0000, v34
  v_mul_f32 v40, v40, v32
  v_mul_f32 v40, s26, v40
  v_sub_f32 v40, 0, v40
  v_mul_f32 v41, v41, v32
  v_mul_f32 v41, s27, v41
  v_mul_f32 v42, v42, v32
  v_mul_f32 v43, v43, v32
  v_add_f32 v42, v42, v42
  v_add_f32 v43, v43, v43
  ds_write_b128 v37, v[40:43] offset:18288
  v_cvt_f32_u32 v44, v4
  v_lshlrev_b32 v45, 4, v4
  v_cvt_f32_u32 v45, v45
  v_lshlrev_b32 v46, 4, v3
  v_add_u32 v46, s17, v46
  v_mov_b32 v48, 0
  v_mov_b32 v49, 0
  v_mov_b32 v50, 0
  v_mov_b32 v51, 0
  v_mov_b32 v52, 0
  v_mov_b32 v53, 0
  v_mov_b32 v54, 0
  v_mov_b32 v55, 0
  v_mov_b32 v56, 0
  v_mov_b32 v57, 0
  v_mov_b32 v58, 0
  v_mov_b32 v59, 0
  v_mov_b32 v60, 0
  v_mov_b32 v61, 0
  v_mov_b32 v62, 0
  v_mov_b32 v63, 0
  v_mov_b32 v64, 0
  v_mov_b32 v65, 0
  v_mov_b32 v66, 0
  v_mov_b32 v67, 0
  s_mov_b32 s28, 0
  s_waitcnt lgkmcnt(0)
  ds_read_b128 v[68:71], v46 offset:18240
wk_kl:
  s_waitcnt lgkmcnt(0)
  v_mov_b32 v72, v68
  v_mov_b32 v73, v69
  v_mov_b32 v74, v70
  v_mov_b32 v75, v71
  v_add_u32 v46, 64, v46
  ds_read_b128 v[68:71], v46 offset:18240
  v_mul_f32 v80, v72, v45
  v_mul_f32 v81, v73, v45
  v_exp_f32 v80, v80
  v_fract_f32 v81, v81
  v_cos_f32 v76, v81
  v_sin_f32 v77, v81
  v_mul_f32 v76, v76, v80
  v_mul_f32 v77, v77, v80
  v_mul_f32 v80, v72, v44
  v_mul_f32 v81, v73, v44
  v_exp_f32 v80, v80
  v_fract_f32 v81, v81
  v_cos_f32 v78, v81
  v_sin_f32 v79, v81
  v_mul_f32 v78, v78, v80
  v_mul_f32 v79, v79, v80
  v_mul_f32 v82, v74, v76
  v_mul_f32 v83, v74, v77
  v_fma_f32 v82, -v75, v77, v82
  v_fma_f32 v83, -v75, v76, -v83
  v_mul_f32 v86, v76, v76
  v_mul_f32 v87, v76, v77
  v_fma_f32 v86, -v77, v77, v86
  v_add_f32 v87, v87, v87
  v_mfma_f32_16x16x4_f32 v[48:51], v82, v78, v[48:51]
  v_mul_f32 v88, v78, v78
  v_mul_f32 v89, v78, v79
  v_fma_f32 v88, -v79, v79, v88
  v_add_f32 v89, v89, v89
  v_mfma_f32_16x16x4_f32 v[48:51], v83, v79, v[48:51]
  v_mul_f32 v84, v74, v86
  v_mul_f32 v85, v74, v87
  v_fma_f32 v84, -v75, v87, v84
  v_fma_f32 v85, -v75, v86, -v85
  v_mul_f32 v76, v86, v86
  v_mul_f32 v77, v86, v87
  v_fma_f32 v76, -v87, v87, v76
  v_add_f32 v77, v77, v77
  v_mfma_f32_16x16x4_f32 v[52:55], v84, v88, v[52:55]
  v_mul_f32 v78, v88, v88
  v_mul_f32 v79, v88, v89
  v_fma_f32 v78, -v89, v89, v78
  v_add_f32 v79, v79, v79
  v_mfma_f32_16x16x4_f32 v[52:55], v85, v89, v[52:55]
  v_mul_f32 v82, v74, v76
  v_mul_f32 v83, v74, v77
  v_fma_f32 v82, -v75, v77, v82
  v_fma_f32 v83, -v75, v76, -v83
  v_mul_f32 v86, v76, v76
  v_mul_f32 v87, v76, v77
  v_fma_f32 v86, -v77, v77, v86
  v_add_f32 v87, v87, v87
  v_mfma_f32_16x16x4_f32 v[56:59], v82, v78, v[56:59]
  v_mul_f32 v88, v78, v78
  v_mul_f32 v89, v78, v79
  v_fma_f32 v88, -v79, v79, v88
  v_add_f32 v89, v89, v89
  v_mfma_f32_16x16x4_f32 v[56:59], v83, v79, v[56:59]
  v_mul_f32 v84, v74, v86
  v_mul_f32 v85, v74, v87
  v_fma_f32 v84, -v75, v87, v84
  v_fma_f32 v85, -v75, v86, -v85
  v_mul_f32 v76, v86, v86
  v_mul_f32 v77, v86, v87
  v_fma_f32 v76, -v87, v87, v76
  v_add_f32 v77, v77, v77
  v_mfma_f32_16x16x4_f32 v[60:63], v84, v88, v[60:63]
  v_mfma_f32_16x16x4_f32 v[60:63], v85, v89, v[60:63]
  v_mul_f32 v82, v74, v76
  v_fma_f32 v82, -v75, v77, v82
  s_nop 1
  v_mfma_f32_16x16x4_f32 v[64:67], v82, v88, v[64:67]
  s_add_u32 s28, s28, 1
  s_cmp_lt_u32 s28, 64
  s_cbranch_scc1 wk_kl
  s_nop 15
  s_nop 3
  v_lshlrev_b32 v46, 8, v3
  v_lshl_add_u32 v46, v4, 2, v46
  v_add_u32 v46, s17, v46
  ds_write_b32 v46, v48 offset:13056
  ds_write_b32 v46, v49 offset:13120
  ds_write_b32 v46, v50 offset:13184
  ds_write_b32 v46, v51 offset:13248
  s_waitcnt lgkmcnt(8)
  ds_write_b32 v46, v52 offset:14080
  ds_write_b32 v46, v53 offset:14144
  ds_write_b32 v46, v54 offset:14208
  ds_write_b32 v46, v55 offset:14272
  s_waitcnt lgkmcnt(8)
  ds_write_b32 v46, v56 offset:15104
  ds_write_b32 v46, v57 offset:15168
  ds_write_b32 v46, v58 offset:15232
  ds_write_b32 v46, v59 offset:15296
  s_waitcnt lgkmcnt(8)
  ds_write_b32 v46, v60 offset:16128
  ds_write_b32 v46, v61 offset:16192
  ds_write_b32 v46, v62 offset:16256
  ds_write_b32 v46, v63 offset:16320
  s_waitcnt lgkmcnt(8)
  ds_write_b32 v46, v64 offset:17152
  ds_write_b32 v46, v65 offset:17216
  ds_write_b32 v46, v66 offset:17280
  ds_write_b32 v46, v67 offset:17344
  s_waitcnt lgkmcnt(8)
  s_waitcnt lgkmcnt(0)
  ds_read_b32 v48, v200
  ds_read_b32 v49, v201
  ds_read_b32 v50, v202
  ds_read_b32 v51, v203
  ds_read_b32 v52, v204
  ds_read_b32 v53, v205
  ds_read_b32 v54, v206
  ds_read_b32 v55, v207
  s_waitcnt lgkmcnt(4)
  ds_read_b32 v56, v208
  ds_read_b32 v57, v209
  ds_read_b32 v58, v210
  ds_read_b32 v59, v211
  ds_read_b32 v60, v212
  ds_read_b32 v61, v213
  ds_read_b32 v62, v214
  ds_read_b32 v63, v215
  s_waitcnt lgkmcnt(4)
  ds_read_b32 v64, v216
  ds_read_b32 v65, v217
  ds_read_b32 v66, v218
  ds_read_b32 v67, v219
  ds_read_b32 v68, v220
  ds_read_b32 v69, v221
  ds_read_b32 v70, v222
  ds_read_b32 v71, v223
  s_waitcnt lgkmcnt(4)
  ds_read_b32 v72, v224
  ds_read_b32 v73, v225
  ds_read_b32 v74, v226
  ds_read_b32 v75, v227
  ds_read_b32 v76, v228
  ds_read_b32 v77, v229
  ds_read_b32 v78, v230
  ds_read_b32 v79, v231
  s_waitcnt lgkmcnt(4)
  ds_read_b32 v80, v232
  s_waitcnt lgkmcnt(0)
  v_lshlrev_b32 v46, 6, v1
  v_add_u32 v46, s17, v46
  v_cvt_pk_bf16_f32 v84, v48, v49
  v_cvt_pk_bf16_f32 v88, v49, v50
  v_cvt_pk_bf16_f32 v85, v50, v51
  v_cvt_pk_bf16_f32 v89, v51, v52
  v_cvt_pk_bf16_f32 v86, v52, v53
  v_cvt_pk_bf16_f32 v90, v53, v54
  v_cvt_pk_bf16_f32 v87, v54, v55
  v_cvt_pk_bf16_f32 v91, v55, v56
  ds_write_b128 v46, v[84:87] offset:4608
  ds_write_b128 v46, v[88:91] offset:8832
  s_waitcnt lgkmcnt(0)
  v_cvt_pk_bf16_f32 v84, v56, v57
  v_cvt_pk_bf16_f32 v88, v57, v58
  v_cvt_pk_bf16_f32 v85, v58, v59
  v_cvt_pk_bf16_f32 v89, v59, v60
  v_cvt_pk_bf16_f32 v86, v60, v61
  v_cvt_pk_bf16_f32 v90, v61, v62
  v_cvt_pk_bf16_f32 v87, v62, v63
  v_cvt_pk_bf16_f32 v91, v63, v64
  ds_write_b128 v46, v[84:87] offset:4624
  ds_write_b128 v46, v[88:91] offset:8848
  s_waitcnt lgkmcnt(0)
  v_cvt_pk_bf16_f32 v84, v64, v65
  v_cvt_pk_bf16_f32 v88, v65, v66
  v_cvt_pk_bf16_f32 v85, v66, v67
  v_cvt_pk_bf16_f32 v89, v67, v68
  v_cvt_pk_bf16_f32 v86, v68, v69
  v_cvt_pk_bf16_f32 v90, v69, v70
  v_cvt_pk_bf16_f32 v87, v70, v71
  v_cvt_pk_bf16_f32 v91, v71, v72
  ds_write_b128 v46, v[84:87] offset:4640
  ds_write_b128 v46, v[88:91] offset:8864
  s_waitcnt lgkmcnt(0)
  v_cvt_pk_bf16_f32 v84, v72, v73
  v_cvt_pk_bf16_f32 v88, v73, v74
  v_cvt_pk_bf16_f32 v85, v74, v75
  v_cvt_pk_bf16_f32 v89, v75, v76
  v_cvt_pk_bf16_f32 v86, v76, v77
  v_cvt_pk_bf16_f32 v90, v77, v78
  v_cvt_pk_bf16_f32 v87, v78, v79
  v_cvt_pk_bf16_f32 v91, v79, v80
  ds_write_b128 v46, v[84:87] offset:4656
  ds_write_b128 v46, v[88:91] offset:8880
  s_waitcnt lgkmcnt(0)
  s_barrier
  v_lshrrev_b32 v47, 1, v3
  v_sub_u32 v46, v4, v47
  v_add_u32 v46, 1, v46
  v_lshlrev_b32 v46, 5, v46
  v_and_b32 v48, 1, v3
  v_lshl_add_u32 v46, v48, 4, v46
  v_add_u32 v46, s17, v46
  ds_read_b128 a[0:3], v46 offset:32
  ds_read_b128 a[4:7], v46 offset:96
  ds_read_b128 a[8:11], v46 offset:160
  ds_read_b128 a[12:15], v46 offset:224
  ds_read_b128 a[16:19], v46 offset:288
  ds_read_b128 a[20:23], v46 offset:352
  ds_read_b128 a[24:27], v46 offset:416
  ds_read_b128 a[28:31], v46 offset:480
  s_waitcnt lgkmcnt(4)
  ds_read_b128 a[32:35], v46 offset:544
  ds_read_b128 a[36:39], v46 offset:608
  ds_read_b128 a[40:43], v46 offset:672
  ds_read_b128 a[44:47], v46 offset:736
  ds_read_b128 a[48:51], v46 offset:800
  ds_read_b128 a[52:55], v46 offset:864
  ds_read_b128 a[56:59], v46 offset:928
  ds_read_b128 a[60:63], v46 offset:992
  s_waitcnt lgkmcnt(4)
  ds_read_b128 a[64:67], v46 offset:1056
  ds_read_b128 a[68:71], v46 offset:1120
  ds_read_b128 a[72:75], v46 offset:1184
  ds_read_b128 a[76:79], v46 offset:1248
  ds_read_b128 a[80:83], v46 offset:1312
  ds_read_b128 a[84:87], v46 offset:1376
  ds_read_b128 a[88:91], v46 offset:1440
  ds_read_b128 a[92:95], v46 offset:1504
  s_waitcnt lgkmcnt(4)
  ds_read_b128 a[96:99], v46 offset:1568
  ds_read_b128 a[100:103], v46 offset:1632
  ds_read_b128 a[104:107], v46 offset:1696
  ds_read_b128 a[108:111], v46 offset:1760
  ds_read_b128 a[112:115], v46 offset:1824
  ds_read_b128 a[116:119], v46 offset:1888
  ds_read_b128 a[120:123], v46 offset:1952
  ds_read_b128 a[124:127], v46 offset:2016
  s_waitcnt lgkmcnt(4)
  ds_read_b128 a[128:131], v46 offset:2080
  ds_read_b128 a[132:135], v46 offset:2144
  ds_read_b128 a[136:139], v46 offset:2208
  ds_read_b128 a[140:143], v46 offset:2272
  ds_read_b128 a[144:147], v46 offset:2336
  ds_read_b128 a[148:151], v46 offset:2400
  ds_read_b128 a[152:155], v46 offset:2464
  ds_read_b128 a[156:159], v46 offset:2528
  s_waitcnt lgkmcnt(4)
  ds_read_b128 a[160:163], v46 offset:2592
  ds_read_b128 a[164:167], v46 offset:2656
  ds_read_b128 a[168:171], v46 offset:2720
  ds_read_b128 a[172:175], v46 offset:2784
  ds_read_b128 a[176:179], v46 offset:2848
  ds_read_b128 a[180:183], v46 offset:2912
  ds_read_b128 a[184:187], v46 offset:2976
  ds_read_b128 a[188:191], v46 offset:3040
  s_waitcnt lgkmcnt(4)
  ds_read_b128 a[192:195], v46 offset:3104
  ds_read_b128 a[196:199], v46 offset:3168
  ds_read_b128 a[200:203], v46 offset:3232
  ds_read_b128 a[204:207], v46 offset:3296
  ds_read_b128 a[208:211], v46 offset:3360
  ds_read_b128 a[212:215], v46 offset:3424
  ds_read_b128 a[216:219], v46 offset:3488
  ds_read_b128 a[220:223], v46 offset:3552
  s_waitcnt lgkmcnt(4)
  ds_read_b128 a[224:227], v46 offset:3616
  ds_read_b128 a[228:231], v46 offset:3680
  ds_read_b128 a[232:235], v46 offset:3744
  ds_read_b128 a[236:239], v46 offset:3808
  ds_read_b128 a[240:243], v46 offset:3872
  ds_read_b128 a[244:247], v46 offset:3936
  ds_read_b128 a[248:251], v46 offset:4000
  ds_read_b128 a[252:255], v46 offset:4064
  s_waitcnt lgkmcnt(4)
  v_lshlrev_b32 v49, 4, v47
  v_add_u32 v49, v49, v4
  v_sub_u32 v49, 2047, v49
  v_lshl_add_u32 v49, v48, 3, v49
  v_and_b32 v50, 1, v49
  v_lshrrev_b32 v49, 1, v49
  v_lshlrev_b32 v49, 2, v49
  v_mul_u32_u24 v50, 4224, v50
  v_add3_u32 v49, v49, v50, s17
  v_add_u32 v49, 4608, v49
  v_subrev_u32 v52, 896, v49
  v_subrev_u32 v53, 1856, v49
  v_subrev_u32 v54, 2816, v49
  v_subrev_u32 v55, 3776, v49
  v_subrev_u32 v56, 4736, v49
  s_waitcnt lgkmcnt(0)
  ds_read2_b32 v[92:93], v52 offset0:224 offset1:225
  ds_read2_b32 v[94:95], v52 offset0:226 offset1:227
  ds_read2_b32 v[96:97], v52 offset0:208 offset1:209
  ds_read2_b32 v[98:99], v52 offset0:210 offset1:211
  ds_read2_b32 v[100:101], v52 offset0:192 offset1:193
  ds_read2_b32 v[102:103], v52 offset0:194 offset1:195
  ds_read2_b32 v[104:105], v52 offset0:176 offset1:177
  ds_read2_b32 v[106:107], v52 offset0:178 offset1:179
  s_waitcnt lgkmcnt(6)
  v_mfma_f32_16x16x32_bf16 v[60:63], v[92:95], a[28:31], 0
  v_mfma_f32_16x16x32_bf16 v[64:67], v[92:95], a[60:63], 0
  v_mfma_f32_16x16x32_bf16 v[68:71], v[92:95], a[92:95], 0
  v_mfma_f32_16x16x32_bf16 v[72:75], v[92:95], a[124:127], 0
  v_mfma_f32_16x16x32_bf16 v[76:79], v[92:95], a[156:159], 0
  v_mfma_f32_16x16x32_bf16 v[80:83], v[92:95], a[188:191], 0
  v_mfma_f32_16x16x32_bf16 v[84:87], v[92:95], a[220:223], 0
  v_mfma_f32_16x16x32_bf16 v[88:91], v[92:95], a[252:255], 0
  ds_read2_b32 v[92:93], v52 offset0:160 offset1:161
  ds_read2_b32 v[94:95], v52 offset0:162 offset1:163
  s_waitcnt lgkmcnt(6)
  v_mfma_f32_16x16x32_bf16 v[60:63], v[96:99], a[24:27], v[60:63]
  v_mfma_f32_16x16x32_bf16 v[64:67], v[96:99], a[56:59], v[64:67]
  v_mfma_f32_16x16x32_bf16 v[68:71], v[96:99], a[88:91], v[68:71]
  v_mfma_f32_16x16x32_bf16 v[72:75], v[96:99], a[120:123], v[72:75]
  v_mfma_f32_16x16x32_bf16 v[76:79], v[96:99], a[152:155], v[76:79]
  v_mfma_f32_16x16x32_bf16 v[80:83], v[96:99], a[184:187], v[80:83]
  v_mfma_f32_16x16x32_bf16 v[84:87], v[96:99], a[216:219], v[84:87]
  v_mfma_f32_16x16x32_bf16 v[88:91], v[96:99], a[248:251], v[88:91]
  ds_read2_b32 v[96:97], v52 offset0:144 offset1:145
  ds_read2_b32 v[98:99], v52 offset0:146 offset1:147
  s_waitcnt lgkmcnt(6)
  v_mfma_f32_16x16x32_bf16 v[60:63], v[100:103], a[20:23], v[60:63]
  v_mfma_f32_16x16x32_bf16 v[64:67], v[100:103], a[52:55], v[64:67]
  v_mfma_f32_16x16x32_bf16 v[68:71], v[100:103], a[84:87], v[68:71]
  v_mfma_f32_16x16x32_bf16 v[72:75], v[100:103], a[116:119], v[72:75]
  v_mfma_f32_16x16x32_bf16 v[76:79], v[100:103], a[148:151], v[76:79]
  v_mfma_f32_16x16x32_bf16 v[80:83], v[100:103], a[180:183], v[80:83]
  v_mfma_f32_16x16x32_bf16 v[84:87], v[100:103], a[212:215], v[84:87]
  v_mfma_f32_16x16x32_bf16 v[88:91], v[100:103], a[244:247], v[88:91]
  ds_read2_b32 v[100:101], v52 offset0:128 offset1:129
  ds_read2_b32 v[102:103], v52 offset0:130 offset1:131
  s_waitcnt lgkmcnt(6)
  v_mfma_f32_16x16x32_bf16 v[60:63], v[104:107], a[16:19], v[60:63]
  v_mfma_f32_16x16x32_bf16 v[64:67], v[104:107], a[48:51], v[64:67]
  v_mfma_f32_16x16x32_bf16 v[68:71], v[104:107], a[80:83], v[68:71]
  v_mfma_f32_16x16x32_bf16 v[72:75], v[104:107], a[112:115], v[72:75]
  v_mfma_f32_16x16x32_bf16 v[76:79], v[104:107], a[144:147], v[76:79]
  v_mfma_f32_16x16x32_bf16 v[80:83], v[104:107], a[176:179], v[80:83]
  v_mfma_f32_16x16x32_bf16 v[84:87], v[104:107], a[208:211], v[84:87]
  v_mfma_f32_16x16x32_bf16 v[88:91], v[104:107], a[240:243], v[88:91]
  ds_read2_b32 v[104:105], v52 offset0:112 offset1:113
  ds_read2_b32 v[106:107], v52 offset0:114 offset1:115
  s_waitcnt lgkmcnt(6)
  v_mfma_f32_16x16x32_bf16 v[60:63], v[92:95], a[12:15], v[60:63]
  v_mfma_f32_16x16x32_bf16 v[64:67], v[92:95], a[44:47], v[64:67]
  v_mfma_f32_16x16x32_bf16 v[68:71], v[92:95], a[76:79], v[68:71]
  v_mfma_f32_16x16x32_bf16 v[72:75], v[92:95], a[108:111], v[72:75]
  v_mfma_f32_16x16x32_bf16 v[76:79], v[92:95], a[140:143], v[76:79]
  v_mfma_f32_16x16x32_bf16 v[80:83], v[92:95], a[172:175], v[80:83]
  v_mfma_f32_16x16x32_bf16 v[84:87], v[92:95], a[204:207], v[84:87]
  v_mfma_f32_16x16x32_bf16 v[88:91], v[92:95], a[236:239], v[88:91]
  ds_read2_b32 v[92:93], v52 offset0:96 offset1:97
  ds_read2_b32 v[94:95], v52 offset0:98 offset1:99
  s_waitcnt lgkmcnt(6)
  v_mfma_f32_16x16x32_bf16 v[60:63], v[96:99], a[8:11], v[60:63]
  v_mfma_f32_16x16x32_bf16 v[64:67], v[96:99], a[40:43], v[64:67]
  v_mfma_f32_16x16x32_bf16 v[68:71], v[96:99], a[72:75], v[68:71]
  v_mfma_f32_16x16x32_bf16 v[72:75], v[96:99], a[104:107], v[72:75]
  v_mfma_f32_16x16x32_bf16 v[76:79], v[96:99], a[136:139], v[76:79]
  v_mfma_f32_16x16x32_bf16 v[80:83], v[96:99], a[168:171], v[80:83]
  v_mfma_f32_16x16x32_bf16 v[84:87], v[96:99], a[200:203], v[84:87]
  v_mfma_f32_16x16x32_bf16 v[88:91], v[96:99], a[232:235], v[88:91]
  ds_read2_b32 v[96:97], v52 offset0:80 offset1:81
  ds_read2_b32 v[98:99], v52 offset0:82 offset1:83
  s_waitcnt lgkmcnt(6)
  v_mfma_f32_16x16x32_bf16 v[60:63], v[100:103], a[4:7], v[60:63]
  v_mfma_f32_16x16x32_bf16 v[64:67], v[100:103], a[36:39], v[64:67]
  v_mfma_f32_16x16x32_bf16 v[68:71], v[100:103], a[68:71], v[68:71]
  v_mfma_f32_16x16x32_bf16 v[72:75], v[100:103], a[100:103], v[72:75]
  v_mfma_f32_16x16x32_bf16 v[76:79], v[100:103], a[132:135], v[76:79]
  v_mfma_f32_16x16x32_bf16 v[80:83], v[100:103], a[164:167], v[80:83]
  v_mfma_f32_16x16x32_bf16 v[84:87], v[100:103], a[196:199], v[84:87]
  v_mfma_f32_16x16x32_bf16 v[88:91], v[100:103], a[228:231], v[88:91]
  ds_read2_b32 v[100:101], v52 offset0:64 offset1:65
  ds_read2_b32 v[102:103], v52 offset0:66 offset1:67
  s_waitcnt lgkmcnt(6)
  v_mfma_f32_16x16x32_bf16 v[60:63], v[104:107], a[0:3], v[60:63]
  v_mfma_f32_16x16x32_bf16 v[64:67], v[104:107], a[32:35], v[64:67]
  v_mfma_f32_16x16x32_bf16 v[68:71], v[104:107], a[64:67], v[68:71]
  v_mfma_f32_16x16x32_bf16 v[72:75], v[104:107], a[96:99], v[72:75]
  v_mfma_f32_16x16x32_bf16 v[76:79], v[104:107], a[128:131], v[76:79]
  v_mfma_f32_16x16x32_bf16 v[80:83], v[104:107], a[160:163], v[80:83]
  v_mfma_f32_16x16x32_bf16 v[84:87], v[104:107], a[192:195], v[84:87]
  v_mfma_f32_16x16x32_bf16 v[88:91], v[104:107], a[224:227], v[88:91]
  ds_read2_b32 v[104:105], v52 offset0:48 offset1:49
  ds_read2_b32 v[106:107], v52 offset0:50 offset1:51
  s_waitcnt lgkmcnt(6)
  v_mfma_f32_16x16x32_bf16 v[64:67], v[92:95], a[28:31], v[64:67]
  v_mfma_f32_16x16x32_bf16 v[68:71], v[92:95], a[60:63], v[68:71]
  v_mfma_f32_16x16x32_bf16 v[72:75], v[92:95], a[92:95], v[72:75]
  v_mfma_f32_16x16x32_bf16 v[76:79], v[92:95], a[124:127], v[76:79]
  v_mfma_f32_16x16x32_bf16 v[80:83], v[92:95], a[156:159], v[80:83]
  v_mfma_f32_16x16x32_bf16 v[84:87], v[92:95], a[188:191], v[84:87]
  v_mfma_f32_16x16x32_bf16 v[88:91], v[92:95], a[220:223], v[88:91]
  ds_read2_b32 v[92:93], v52 offset0:32 offset1:33
  ds_read2_b32 v[94:95], v52 offset0:34 offset1:35
  s_waitcnt lgkmcnt(6)
  v_mfma_f32_16x16x32_bf16 v[64:67], v[96:99], a[24:27], v[64:67]
  v_mfma_f32_16x16x32_bf16 v[68:71], v[96:99], a[56:59], v[68:71]
  v_mfma_f32_16x16x32_bf16 v[72:75], v[96:99], a[88:91], v[72:75]
  v_mfma_f32_16x16x32_bf16 v[76:79], v[96:99], a[120:123], v[76:79]
  v_mfma_f32_16x16x32_bf16 v[80:83], v[96:99], a[152:155], v[80:83]
  v_mfma_f32_16x16x32_bf16 v[84:87], v[96:99], a[184:187], v[84:87]
  v_mfma_f32_16x16x32_bf16 v[88:91], v[96:99], a[216:219], v[88:91]
  ds_read2_b32 v[96:97], v52 offset0:16 offset1:17
  ds_read2_b32 v[98:99], v52 offset0:18 offset1:19
  s_waitcnt lgkmcnt(6)
  v_mfma_f32_16x16x32_bf16 v[64:67], v[100:103], a[20:23], v[64:67]
  v_mfma_f32_16x16x32_bf16 v[68:71], v[100:103], a[52:55], v[68:71]
  v_mfma_f32_16x16x32_bf16 v[72:75], v[100:103], a[84:87], v[72:75]
  v_mfma_f32_16x16x32_bf16 v[76:79], v[100:103], a[116:119], v[76:79]
  v_mfma_f32_16x16x32_bf16 v[80:83], v[100:103], a[148:151], v[80:83]
  v_mfma_f32_16x16x32_bf16 v[84:87], v[100:103], a[180:183], v[84:87]
  v_mfma_f32_16x16x32_bf16 v[88:91], v[100:103], a[212:215], v[88:91]
  ds_read2_b32 v[100:101], v52 offset0:0 offset1:1
  ds_read2_b32 v[102:103], v52 offset0:2 offset1:3
  s_waitcnt lgkmcnt(6)
  v_mfma_f32_16x16x32_bf16 v[64:67], v[104:107], a[16:19], v[64:67]
  v_mfma_f32_16x16x32_bf16 v[68:71], v[104:107], a[48:51], v[68:71]
  v_mfma_f32_16x16x32_bf16 v[72:75], v[104:107], a[80:83], v[72:75]
  v_mfma_f32_16x16x32_bf16 v[76:79], v[104:107], a[112:115], v[76:79]
  v_mfma_f32_16x16x32_bf16 v[80:83], v[104:107], a[144:147], v[80:83]
  v_mfma_f32_16x16x32_bf16 v[84:87], v[104:107], a[176:179], v[84:87]
  v_mfma_f32_16x16x32_bf16 v[88:91], v[104:107], a[208:211], v[88:91]
  ds_read2_b32 v[104:105], v53 offset0:224 offset1:225
  ds_read2_b32 v[106:107], v53 offset0:226 offset1:227
  s_waitcnt lgkmcnt(6)
  v_mfma_f32_16x16x32_bf16 v[64:67], v[92:95], a[12:15], v[64:67]
  v_mfma_f32_16x16x32_bf16 v[68:71], v[92:95], a[44:47], v[68:71]
  v_mfma_f32_16x16x32_bf16 v[72:75], v[92:95], a[76:79], v[72:75]
  v_mfma_f32_16x16x32_bf16 v[76:79], v[92:95], a[108:111], v[76:79]
  v_mfma_f32_16x16x32_bf16 v[80:83], v[92:95], a[140:143], v[80:83]
  v_mfma_f32_16x16x32_bf16 v[84:87], v[92:95], a[172:175], v[84:87]
  v_mfma_f32_16x16x32_bf16 v[88:91], v[92:95], a[204:207], v[88:91]
  ds_read2_b32 v[92:93], v53 offset0:208 offset1:209
  ds_read2_b32 v[94:95], v53 offset0:210 offset1:211
  s_waitcnt lgkmcnt(6)
  v_mfma_f32_16x16x32_bf16 v[64:67], v[96:99], a[8:11], v[64:67]
  v_mfma_f32_16x16x32_bf16 v[68:71], v[96:99], a[40:43], v[68:71]
  v_mfma_f32_16x16x32_bf16 v[72:75], v[96:99], a[72:75], v[72:75]
  v_mfma_f32_16x16x32_bf16 v[76:79], v[96:99], a[104:107], v[76:79]
  v_mfma_f32_16x16x32_bf16 v[80:83], v[96:99], a[136:139], v[80:83]
  v_mfma_f32_16x16x32_bf16 v[84:87], v[96:99], a[168:171], v[84:87]
  v_mfma_f32_16x16x32_bf16 v[88:91], v[96:99], a[200:203], v[88:91]
  ds_read2_b32 v[96:97], v53 offset0:192 offset1:193
  ds_read2_b32 v[98:99], v53 offset0:194 offset1:195
  s_waitcnt lgkmcnt(6)
  v_mfma_f32_16x16x32_bf16 v[64:67], v[100:103], a[4:7], v[64:67]
  v_mfma_f32_16x16x32_bf16 v[68:71], v[100:103], a[36:39], v[68:71]
  v_mfma_f32_16x16x32_bf16 v[72:75], v[100:103], a[68:71], v[72:75]
  v_mfma_f32_16x16x32_bf16 v[76:79], v[100:103], a[100:103], v[76:79]
  v_mfma_f32_16x16x32_bf16 v[80:83], v[100:103], a[132:135], v[80:83]
  v_mfma_f32_16x16x32_bf16 v[84:87], v[100:103], a[164:167], v[84:87]
  v_mfma_f32_16x16x32_bf16 v[88:91], v[100:103], a[196:199], v[88:91]
  ds_read2_b32 v[100:101], v53 offset0:176 offset1:177
  ds_read2_b32 v[102:103], v53 offset0:178 offset1:179
  s_waitcnt lgkmcnt(6)
  v_mfma_f32_16x16x32_bf16 v[64:67], v[104:107], a[0:3], v[64:67]
  v_mfma_f32_16x16x32_bf16 v[68:71], v[104:107], a[32:35], v[68:71]
  v_mfma_f32_16x16x32_bf16 v[72:75], v[104:107], a[64:67], v[72:75]
  v_mfma_f32_16x16x32_bf16 v[76:79], v[104:107], a[96:99], v[76:79]
  v_mfma_f32_16x16x32_bf16 v[80:83], v[104:107], a[128:131], v[80:83]
  v_mfma_f32_16x16x32_bf16 v[84:87], v[104:107], a[160:163], v[84:87]
  v_mfma_f32_16x16x32_bf16 v[88:91], v[104:107], a[192:195], v[88:91]
  ds_read2_b32 v[104:105], v53 offset0:160 offset1:161
  ds_read2_b32 v[106:107], v53 offset0:162 offset1:163
  s_waitcnt lgkmcnt(6)
  v_mfma_f32_16x16x32_bf16 v[68:71], v[92:95], a[28:31], v[68:71]
  v_mfma_f32_16x16x32_bf16 v[72:75], v[92:95], a[60:63], v[72:75]
  v_mfma_f32_16x16x32_bf16 v[76:79], v[92:95], a[92:95], v[76:79]
  v_mfma_f32_16x16x32_bf16 v[80:83], v[92:95], a[124:127], v[80:83]
  v_mfma_f32_16x16x32_bf16 v[84:87], v[92:95], a[156:159], v[84:87]
  v_mfma_f32_16x16x32_bf16 v[88:91], v[92:95], a[188:191], v[88:91]
  ds_read2_b32 v[92:93], v53 offset0:144 offset1:145
  ds_read2_b32 v[94:95], v53 offset0:146 offset1:147
  s_waitcnt lgkmcnt(6)
  v_mfma_f32_16x16x32_bf16 v[68:71], v[96:99], a[24:27], v[68:71]
  v_mfma_f32_16x16x32_bf16 v[72:75], v[96:99], a[56:59], v[72:75]
  v_mfma_f32_16x16x32_bf16 v[76:79], v[96:99], a[88:91], v[76:79]
  v_mfma_f32_16x16x32_bf16 v[80:83], v[96:99], a[120:123], v[80:83]
  v_mfma_f32_16x16x32_bf16 v[84:87], v[96:99], a[152:155], v[84:87]
  v_mfma_f32_16x16x32_bf16 v[88:91], v[96:99], a[184:187], v[88:91]
  ds_read2_b32 v[96:97], v53 offset0:128 offset1:129
  ds_read2_b32 v[98:99], v53 offset0:130 offset1:131
  s_waitcnt lgkmcnt(6)
  v_mfma_f32_16x16x32_bf16 v[68:71], v[100:103], a[20:23], v[68:71]
  v_mfma_f32_16x16x32_bf16 v[72:75], v[100:103], a[52:55], v[72:75]
  v_mfma_f32_16x16x32_bf16 v[76:79], v[100:103], a[84:87], v[76:79]
  v_mfma_f32_16x16x32_bf16 v[80:83], v[100:103], a[116:119], v[80:83]
  v_mfma_f32_16x16x32_bf16 v[84:87], v[100:103], a[148:151], v[84:87]
  v_mfma_f32_16x16x32_bf16 v[88:91], v[100:103], a[180:183], v[88:91]
  ds_read2_b32 v[100:101], v53 offset0:112 offset1:113
  ds_read2_b32 v[102:103], v53 offset0:114 offset1:115
  s_waitcnt lgkmcnt(6)
  v_mfma_f32_16x16x32_bf16 v[68:71], v[104:107], a[16:19], v[68:71]
  v_mfma_f32_16x16x32_bf16 v[72:75], v[104:107], a[48:51], v[72:75]
  v_mfma_f32_16x16x32_bf16 v[76:79], v[104:107], a[80:83], v[76:79]
  v_mfma_f32_16x16x32_bf16 v[80:83], v[104:107], a[112:115], v[80:83]
  v_mfma_f32_16x16x32_bf16 v[84:87], v[104:107], a[144:147], v[84:87]
  v_mfma_f32_16x16x32_bf16 v[88:91], v[104:107], a[176:179], v[88:91]
  ds_read2_b32 v[104:105], v53 offset0:96 offset1:97
  ds_read2_b32 v[106:107], v53 offset0:98 offset1:99
  s_waitcnt lgkmcnt(6)
  v_mfma_f32_16x16x32_bf16 v[68:71], v[92:95], a[12:15], v[68:71]
  v_mfma_f32_16x16x32_bf16 v[72:75], v[92:95], a[44:47], v[72:75]
  v_mfma_f32_16x16x32_bf16 v[76:79], v[92:95], a[76:79], v[76:79]
  v_mfma_f32_16x16x32_bf16 v[80:83], v[92:95], a[108:111], v[80:83]
  v_mfma_f32_16x16x32_bf16 v[84:87], v[92:95], a[140:143], v[84:87]
  v_mfma_f32_16x16x32_bf16 v[88:91], v[92:95], a[172:175], v[88:91]
  ds_read2_b32 v[92:93], v53 offset0:80 offset1:81
  ds_read2_b32 v[94:95], v53 offset0:82 offset1:83
  s_waitcnt lgkmcnt(6)
  v_mfma_f32_16x16x32_bf16 v[68:71], v[96:99], a[8:11], v[68:71]
  v_mfma_f32_16x16x32_bf16 v[72:75], v[96:99], a[40:43], v[72:75]
  v_mfma_f32_16x16x32_bf16 v[76:79], v[96:99], a[72:75], v[76:79]
  v_mfma_f32_16x16x32_bf16 v[80:83], v[96:99], a[104:107], v[80:83]
  v_mfma_f32_16x16x32_bf16 v[84:87], v[96:99], a[136:139], v[84:87]
  v_mfma_f32_16x16x32_bf16 v[88:91], v[96:99], a[168:171], v[88:91]
  ds_read2_b32 v[96:97], v53 offset0:64 offset1:65
  ds_read2_b32 v[98:99], v53 offset0:66 offset1:67
  s_waitcnt lgkmcnt(6)
  v_mfma_f32_16x16x32_bf16 v[68:71], v[100:103], a[4:7], v[68:71]
  v_mfma_f32_16x16x32_bf16 v[72:75], v[100:103], a[36:39], v[72:75]
  v_mfma_f32_16x16x32_bf16 v[76:79], v[100:103], a[68:71], v[76:79]
  v_mfma_f32_16x16x32_bf16 v[80:83], v[100:103], a[100:103], v[80:83]
  v_mfma_f32_16x16x32_bf16 v[84:87], v[100:103], a[132:135], v[84:87]
  v_mfma_f32_16x16x32_bf16 v[88:91], v[100:103], a[164:167], v[88:91]
  ds_read2_b32 v[100:101], v53 offset0:48 offset1:49
  ds_read2_b32 v[102:103], v53 offset0:50 offset1:51
  s_waitcnt lgkmcnt(6)
  v_mfma_f32_16x16x32_bf16 v[68:71], v[104:107], a[0:3], v[68:71]
  v_mfma_f32_16x16x32_bf16 v[72:75], v[104:107], a[32:35], v[72:75]
  v_mfma_f32_16x16x32_bf16 v[76:79], v[104:107], a[64:67], v[76:79]
  v_mfma_f32_16x16x32_bf16 v[80:83], v[104:107], a[96:99], v[80:83]
  v_mfma_f32_16x16x32_bf16 v[84:87], v[104:107], a[128:131], v[84:87]
  v_mfma_f32_16x16x32_bf16 v[88:91], v[104:107], a[160:163], v[88:91]
  ds_read2_b32 v[104:105], v53 offset0:32 offset1:33
  ds_read2_b32 v[106:107], v53 offset0:34 offset1:35
  s_waitcnt lgkmcnt(6)
  v_mfma_f32_16x16x32_bf16 v[72:75], v[92:95], a[28:31], v[72:75]
  v_mfma_f32_16x16x32_bf16 v[76:79], v[92:95], a[60:63], v[76:79]
  v_mfma_f32_16x16x32_bf16 v[80:83], v[92:95], a[92:95], v[80:83]
  v_mfma_f32_16x16x32_bf16 v[84:87], v[92:95], a[124:127], v[84:87]
  v_mfma_f32_16x16x32_bf16 v[88:91], v[92:95], a[156:159], v[88:91]
  ds_read2_b32 v[92:93], v53 offset0:16 offset1:17
  ds_read2_b32 v[94:95], v53 offset0:18 offset1:19
  s_waitcnt lgkmcnt(6)
  v_mfma_f32_16x16x32_bf16 v[72:75], v[96:99], a[24:27], v[72:75]
  v_mfma_f32_16x16x32_bf16 v[76:79], v[96:99], a[56:59], v[76:79]
  v_mfma_f32_16x16x32_bf16 v[80:83], v[96:99], a[88:91], v[80:83]
  v_mfma_f32_16x16x32_bf16 v[84:87], v[96:99], a[120:123], v[84:87]
  v_mfma_f32_16x16x32_bf16 v[88:91], v[96:99], a[152:155], v[88:91]
  ds_read2_b32 v[96:97], v53 offset0:0 offset1:1
  ds_read2_b32 v[98:99], v53 offset0:2 offset1:3
  s_waitcnt lgkmcnt(6)
  v_mfma_f32_16x16x32_bf16 v[72:75], v[100:103], a[20:23], v[72:75]
  v_mfma_f32_16x16x32_bf16 v[76:79], v[100:103], a[52:55], v[76:79]
  v_mfma_f32_16x16x32_bf16 v[80:83], v[100:103], a[84:87], v[80:83]
  v_mfma_f32_16x16x32_bf16 v[84:87], v[100:103], a[116:119], v[84:87]
  v_mfma_f32_16x16x32_bf16 v[88:91], v[100:103], a[148:151], v[88:91]
  ds_read2_b32 v[100:101], v54 offset0:224 offset1:225
  ds_read2_b32 v[102:103], v54 offset0:226 offset1:227
  s_waitcnt lgkmcnt(6)
  v_mfma_f32_16x16x32_bf16 v[72:75], v[104:107], a[16:19], v[72:75]
  v_mfma_f32_16x16x32_bf16 v[76:79], v[104:107], a[48:51], v[76:79]
  v_mfma_f32_16x16x32_bf16 v[80:83], v[104:107], a[80:83], v[80:83]
  v_mfma_f32_16x16x32_bf16 v[84:87], v[104:107], a[112:115], v[84:87]
  v_mfma_f32_16x16x32_bf16 v[88:91], v[104:107], a[144:147], v[88:91]
  ds_read2_b32 v[104:105], v54 offset0:208 offset1:209
  ds_read2_b32 v[106:107], v54 offset0:210 offset1:211
  s_waitcnt lgkmcnt(6)
  v_mfma_f32_16x16x32_bf16 v[72:75], v[92:95], a[12:15], v[72:75]
  v_mfma_f32_16x16x32_bf16 v[76:79], v[92:95], a[44:47], v[76:79]
  v_mfma_f32_16x16x32_bf16 v[80:83], v[92:95], a[76:79], v[80:83]
  v_mfma_f32_16x16x32_bf16 v[84:87], v[92:95], a[108:111], v[84:87]
  v_mfma_f32_16x16x32_bf16 v[88:91], v[92:95], a[140:143], v[88:91]
  ds_read2_b32 v[92:93], v54 offset0:192 offset1:193
  ds_read2_b32 v[94:95], v54 offset0:194 offset1:195
  s_waitcnt lgkmcnt(6)
  v_mfma_f32_16x16x32_bf16 v[72:75], v[96:99], a[8:11], v[72:75]
  v_mfma_f32_16x16x32_bf16 v[76:79], v[96:99], a[40:43], v[76:79]
  v_mfma_f32_16x16x32_bf16 v[80:83], v[96:99], a[72:75], v[80:83]
  v_mfma_f32_16x16x32_bf16 v[84:87], v[96:99], a[104:107], v[84:87]
  v_mfma_f32_16x16x32_bf16 v[88:91], v[96:99], a[136:139], v[88:91]
  ds_read2_b32 v[96:97], v54 offset0:176 offset1:177
  ds_read2_b32 v[98:99], v54 offset0:178 offset1:179
  s_waitcnt lgkmcnt(6)
  v_mfma_f32_16x16x32_bf16 v[72:75], v[100:103], a[4:7], v[72:75]
  v_mfma_f32_16x16x32_bf16 v[76:79], v[100:103], a[36:39], v[76:79]
  v_mfma_f32_16x16x32_bf16 v[80:83], v[100:103], a[68:71], v[80:83]
  v_mfma_f32_16x16x32_bf16 v[84:87], v[100:103], a[100:103], v[84:87]
  v_mfma_f32_16x16x32_bf16 v[88:91], v[100:103], a[132:135], v[88:91]
  ds_read2_b32 v[100:101], v54 offset0:160 offset1:161
  ds_read2_b32 v[102:103], v54 offset0:162 offset1:163
  s_waitcnt lgkmcnt(6)
  v_mfma_f32_16x16x32_bf16 v[72:75], v[104:107], a[0:3], v[72:75]
  v_mfma_f32_16x16x32_bf16 v[76:79], v[104:107], a[32:35], v[76:79]
  v_mfma_f32_16x16x32_bf16 v[80:83], v[104:107], a[64:67], v[80:83]
  v_mfma_f32_16x16x32_bf16 v[84:87], v[104:107], a[96:99], v[84:87]
  v_mfma_f32_16x16x32_bf16 v[88:91], v[104:107], a[128:131], v[88:91]
  ds_read2_b32 v[104:105], v54 offset0:144 offset1:145
  ds_read2_b32 v[106:107], v54 offset0:146 offset1:147
  s_waitcnt lgkmcnt(6)
  v_mfma_f32_16x16x32_bf16 v[76:79], v[92:95], a[28:31], v[76:79]
  v_mfma_f32_16x16x32_bf16 v[80:83], v[92:95], a[60:63], v[80:83]
  v_mfma_f32_16x16x32_bf16 v[84:87], v[92:95], a[92:95], v[84:87]
  v_mfma_f32_16x16x32_bf16 v[88:91], v[92:95], a[124:127], v[88:91]
  ds_read2_b32 v[92:93], v54 offset0:128 offset1:129
  ds_read2_b32 v[94:95], v54 offset0:130 offset1:131
  s_waitcnt lgkmcnt(6)
  v_mfma_f32_16x16x32_bf16 v[76:79], v[96:99], a[24:27], v[76:79]
  v_mfma_f32_16x16x32_bf16 v[80:83], v[96:99], a[56:59], v[80:83]
  v_mfma_f32_16x16x32_bf16 v[84:87], v[96:99], a[88:91], v[84:87]
  v_mfma_f32_16x16x32_bf16 v[88:91], v[96:99], a[120:123], v[88:91]
  ds_read2_b32 v[96:97], v54 offset0:112 offset1:113
  ds_read2_b32 v[98:99], v54 offset0:114 offset1:115
  s_waitcnt lgkmcnt(6)
  v_mfma_f32_16x16x32_bf16 v[76:79], v[100:103], a[20:23], v[76:79]
  v_mfma_f32_16x16x32_bf16 v[80:83], v[100:103], a[52:55], v[80:83]
  v_mfma_f32_16x16x32_bf16 v[84:87], v[100:103], a[84:87], v[84:87]
  v_mfma_f32_16x16x32_bf16 v[88:91], v[100:103], a[116:119], v[88:91]
  ds_read2_b32 v[100:101], v54 offset0:96 offset1:97
  ds_read2_b32 v[102:103], v54 offset0:98 offset1:99
  s_waitcnt lgkmcnt(6)
  v_mfma_f32_16x16x32_bf16 v[76:79], v[104:107], a[16:19], v[76:79]
  v_mfma_f32_16x16x32_bf16 v[80:83], v[104:107], a[48:51], v[80:83]
  v_mfma_f32_16x16x32_bf16 v[84:87], v[104:107], a[80:83], v[84:87]
  v_mfma_f32_16x16x32_bf16 v[88:91], v[104:107], a[112:115], v[88:91]
  ds_read2_b32 v[104:105], v54 offset0:80 offset1:81
  ds_read2_b32 v[106:107], v54 offset0:82 offset1:83
  s_waitcnt lgkmcnt(6)
  v_mfma_f32_16x16x32_bf16 v[76:79], v[92:95], a[12:15], v[76:79]
  v_mfma_f32_16x16x32_bf16 v[80:83], v[92:95], a[44:47], v[80:83]
  v_mfma_f32_16x16x32_bf16 v[84:87], v[92:95], a[76:79], v[84:87]
  v_mfma_f32_16x16x32_bf16 v[88:91], v[92:95], a[108:111], v[88:91]
  ds_read2_b32 v[92:93], v54 offset0:64 offset1:65
  ds_read2_b32 v[94:95], v54 offset0:66 offset1:67
  s_waitcnt lgkmcnt(6)
  v_mfma_f32_16x16x32_bf16 v[76:79], v[96:99], a[8:11], v[76:79]
  v_mfma_f32_16x16x32_bf16 v[80:83], v[96:99], a[40:43], v[80:83]
  v_mfma_f32_16x16x32_bf16 v[84:87], v[96:99], a[72:75], v[84:87]
  v_mfma_f32_16x16x32_bf16 v[88:91], v[96:99], a[104:107], v[88:91]
  ds_read2_b32 v[96:97], v54 offset0:48 offset1:49
  ds_read2_b32 v[98:99], v54 offset0:50 offset1:51
  s_waitcnt lgkmcnt(6)
  v_mfma_f32_16x16x32_bf16 v[76:79], v[100:103], a[4:7], v[76:79]
  v_mfma_f32_16x16x32_bf16 v[80:83], v[100:103], a[36:39], v[80:83]
  v_mfma_f32_16x16x32_bf16 v[84:87], v[100:103], a[68:71], v[84:87]
  v_mfma_f32_16x16x32_bf16 v[88:91], v[100:103], a[100:103], v[88:91]
  ds_read2_b32 v[100:101], v54 offset0:32 offset1:33
  ds_read2_b32 v[102:103], v54 offset0:34 offset1:35
  s_waitcnt lgkmcnt(6)
  v_mfma_f32_16x16x32_bf16 v[76:79], v[104:107], a[0:3], v[76:79]
  v_mfma_f32_16x16x32_bf16 v[80:83], v[104:107], a[32:35], v[80:83]
  v_mfma_f32_16x16x32_bf16 v[84:87], v[104:107], a[64:67], v[84:87]
  v_mfma_f32_16x16x32_bf16 v[88:91], v[104:107], a[96:99], v[88:91]
  ds_read2_b32 v[104:105], v54 offset0:16 offset1:17
  ds_read2_b32 v[106:107], v54 offset0:18 offset1:19
  s_waitcnt lgkmcnt(6)
  v_mfma_f32_16x16x32_bf16 v[80:83], v[92:95], a[28:31], v[80:83]
  v_mfma_f32_16x16x32_bf16 v[84:87], v[92:95], a[60:63], v[84:87]
  v_mfma_f32_16x16x32_bf16 v[88:91], v[92:95], a[92:95], v[88:91]
  ds_read2_b32 v[92:93], v54 offset0:0 offset1:1
  ds_read2_b32 v[94:95], v54 offset0:2 offset1:3
  s_waitcnt lgkmcnt(6)
  v_mfma_f32_16x16x32_bf16 v[80:83], v[96:99], a[24:27], v[80:83]
  v_mfma_f32_16x16x32_bf16 v[84:87], v[96:99], a[56:59], v[84:87]
  v_mfma_f32_16x16x32_bf16 v[88:91], v[96:99], a[88:91], v[88:91]
  ds_read2_b32 v[96:97], v55 offset0:224 offset1:225
  ds_read2_b32 v[98:99], v55 offset0:226 offset1:227
  s_waitcnt lgkmcnt(6)
  v_mfma_f32_16x16x32_bf16 v[80:83], v[100:103], a[20:23], v[80:83]
  v_mfma_f32_16x16x32_bf16 v[84:87], v[100:103], a[52:55], v[84:87]
  v_mfma_f32_16x16x32_bf16 v[88:91], v[100:103], a[84:87], v[88:91]
  ds_read2_b32 v[100:101], v55 offset0:208 offset1:209
  ds_read2_b32 v[102:103], v55 offset0:210 offset1:211
  s_waitcnt lgkmcnt(6)
  v_mfma_f32_16x16x32_bf16 v[80:83], v[104:107], a[16:19], v[80:83]
  v_mfma_f32_16x16x32_bf16 v[84:87], v[104:107], a[48:51], v[84:87]
  v_mfma_f32_16x16x32_bf16 v[88:91], v[104:107], a[80:83], v[88:91]
  ds_read2_b32 v[104:105], v55 offset0:192 offset1:193
  ds_read2_b32 v[106:107], v55 offset0:194 offset1:195
  s_waitcnt lgkmcnt(6)
  v_mfma_f32_16x16x32_bf16 v[80:83], v[92:95], a[12:15], v[80:83]
  v_mfma_f32_16x16x32_bf16 v[84:87], v[92:95], a[44:47], v[84:87]
  v_mfma_f32_16x16x32_bf16 v[88:91], v[92:95], a[76:79], v[88:91]
  ds_read2_b32 v[92:93], v55 offset0:176 offset1:177
  ds_read2_b32 v[94:95], v55 offset0:178 offset1:179
  s_waitcnt lgkmcnt(6)
  v_mfma_f32_16x16x32_bf16 v[80:83], v[96:99], a[8:11], v[80:83]
  v_mfma_f32_16x16x32_bf16 v[84:87], v[96:99], a[40:43], v[84:87]
  v_mfma_f32_16x16x32_bf16 v[88:91], v[96:99], a[72:75], v[88:91]
  ds_read2_b32 v[96:97], v55 offset0:160 offset1:161
  ds_read2_b32 v[98:99], v55 offset0:162 offset1:163
  s_waitcnt lgkmcnt(6)
  v_mfma_f32_16x16x32_bf16 v[80:83], v[100:103], a[4:7], v[80:83]
  v_mfma_f32_16x16x32_bf16 v[84:87], v[100:103], a[36:39], v[84:87]
  v_mfma_f32_16x16x32_bf16 v[88:91], v[100:103], a[68:71], v[88:91]
  ds_read2_b32 v[100:101], v55 offset0:144 offset1:145
  ds_read2_b32 v[102:103], v55 offset0:146 offset1:147
  s_waitcnt lgkmcnt(6)
  v_mfma_f32_16x16x32_bf16 v[80:83], v[104:107], a[0:3], v[80:83]
  v_mfma_f32_16x16x32_bf16 v[84:87], v[104:107], a[32:35], v[84:87]
  v_mfma_f32_16x16x32_bf16 v[88:91], v[104:107], a[64:67], v[88:91]
  ds_read2_b32 v[104:105], v55 offset0:128 offset1:129
  ds_read2_b32 v[106:107], v55 offset0:130 offset1:131
  s_waitcnt lgkmcnt(6)
  v_mfma_f32_16x16x32_bf16 v[84:87], v[92:95], a[28:31], v[84:87]
  v_mfma_f32_16x16x32_bf16 v[88:91], v[92:95], a[60:63], v[88:91]
  ds_read2_b32 v[92:93], v55 offset0:112 offset1:113
  ds_read2_b32 v[94:95], v55 offset0:114 offset1:115
  s_waitcnt lgkmcnt(6)
  v_mfma_f32_16x16x32_bf16 v[84:87], v[96:99], a[24:27], v[84:87]
  v_mfma_f32_16x16x32_bf16 v[88:91], v[96:99], a[56:59], v[88:91]
  ds_read2_b32 v[96:97], v55 offset0:96 offset1:97
  ds_read2_b32 v[98:99], v55 offset0:98 offset1:99
  s_waitcnt lgkmcnt(6)
  v_mfma_f32_16x16x32_bf16 v[84:87], v[100:103], a[20:23], v[84:87]
  v_mfma_f32_16x16x32_bf16 v[88:91], v[100:103], a[52:55], v[88:91]
  ds_read2_b32 v[100:101], v55 offset0:80 offset1:81
  ds_read2_b32 v[102:103], v55 offset0:82 offset1:83
  s_waitcnt lgkmcnt(6)
  v_mfma_f32_16x16x32_bf16 v[84:87], v[104:107], a[16:19], v[84:87]
  v_mfma_f32_16x16x32_bf16 v[88:91], v[104:107], a[48:51], v[88:91]
  ds_read2_b32 v[104:105], v55 offset0:64 offset1:65
  ds_read2_b32 v[106:107], v55 offset0:66 offset1:67
  s_waitcnt lgkmcnt(6)
  v_mfma_f32_16x16x32_bf16 v[84:87], v[92:95], a[12:15], v[84:87]
  v_mfma_f32_16x16x32_bf16 v[88:91], v[92:95], a[44:47], v[88:91]
  ds_read2_b32 v[92:93], v55 offset0:48 offset1:49
  ds_read2_b32 v[94:95], v55 offset0:50 offset1:51
  s_waitcnt lgkmcnt(6)
  v_mfma_f32_16x16x32_bf16 v[84:87], v[96:99], a[8:11], v[84:87]
  v_mfma_f32_16x16x32_bf16 v[88:91], v[96:99], a[40:43], v[88:91]
  ds_read2_b32 v[96:97], v55 offset0:32 offset1:33
  ds_read2_b32 v[98:99], v55 offset0:34 offset1:35
  s_waitcnt lgkmcnt(6)
  v_mfma_f32_16x16x32_bf16 v[84:87], v[100:103], a[4:7], v[84:87]
  v_mfma_f32_16x16x32_bf16 v[88:91], v[100:103], a[36:39], v[88:91]
  ds_read2_b32 v[100:101], v55 offset0:16 offset1:17
  ds_read2_b32 v[102:103], v55 offset0:18 offset1:19
  s_waitcnt lgkmcnt(6)
  v_mfma_f32_16x16x32_bf16 v[84:87], v[104:107], a[0:3], v[84:87]
  v_mfma_f32_16x16x32_bf16 v[88:91], v[104:107], a[32:35], v[88:91]
  ds_read2_b32 v[104:105], v55 offset0:0 offset1:1
  ds_read2_b32 v[106:107], v55 offset0:2 offset1:3
  s_waitcnt lgkmcnt(6)
  v_mfma_f32_16x16x32_bf16 v[88:91], v[92:95], a[28:31], v[88:91]
  ds_read2_b32 v[92:93], v56 offset0:224 offset1:225
  ds_read2_b32 v[94:95], v56 offset0:226 offset1:227
  s_waitcnt lgkmcnt(6)
  v_mfma_f32_16x16x32_bf16 v[88:91], v[96:99], a[24:27], v[88:91]
  ds_read2_b32 v[96:97], v56 offset0:208 offset1:209
  ds_read2_b32 v[98:99], v56 offset0:210 offset1:211
  s_waitcnt lgkmcnt(6)
  v_mfma_f32_16x16x32_bf16 v[88:91], v[100:103], a[20:23], v[88:91]
  ds_read2_b32 v[100:101], v56 offset0:192 offset1:193
  ds_read2_b32 v[102:103], v56 offset0:194 offset1:195
  s_waitcnt lgkmcnt(6)
  v_mfma_f32_16x16x32_bf16 v[88:91], v[104:107], a[16:19], v[88:91]
  ds_read2_b32 v[104:105], v56 offset0:176 offset1:177
  ds_read2_b32 v[106:107], v56 offset0:178 offset1:179
  s_waitcnt lgkmcnt(6)
  v_mfma_f32_16x16x32_bf16 v[88:91], v[92:95], a[12:15], v[88:91]
  s_waitcnt lgkmcnt(4)
  v_mfma_f32_16x16x32_bf16 v[88:91], v[96:99], a[8:11], v[88:91]
  s_waitcnt lgkmcnt(2)
  v_mfma_f32_16x16x32_bf16 v[88:91], v[100:103], a[4:7], v[88:91]
  s_waitcnt lgkmcnt(0)
  v_mfma_f32_16x16x32_bf16 v[88:91], v[104:107], a[0:3], v[88:91]
  v_lshlrev_b32 v46, 5, v4
  v_lshl_add_u32 v46, v3, 3, v46
  v_add_u32 v46, s17, v46
  ds_read_b64 v[108:109], v46 offset:512
  ds_read_b64 v[110:111], v46 offset:1024
  ds_read_b64 v[112:113], v46 offset:1536
  ds_read_b64 v[114:115], v46 offset:2048
  ds_read_b64 v[116:117], v46 offset:2560
  ds_read_b64 v[118:119], v46 offset:3072
  ds_read_b64 v[120:121], v46 offset:3584
  ds_read_b64 v[122:123], v46 offset:4096
  s_waitcnt lgkmcnt(0)
  v_lshlrev_b32 v124, 16, v108
  v_and_b32 v125, 0xffff0000, v108
  v_lshlrev_b32 v126, 16, v109
  v_and_b32 v127, 0xffff0000, v109
  v_mul_f32 v124, v124, v33
  v_mul_f32 v125, v125, v33
  v_mul_f32 v126, v126, v33
  v_mul_f32 v127, v127, v33
  v_cvt_pk_bf16_f32 v128, v124, v125
  v_cvt_pk_bf16_f32 v129, v126, v127
  v_cvt_pk_bf16_f32 v130, v60, v61
  v_cvt_pk_bf16_f32 v131, v62, v63
  v_lshlrev_b32 v124, 16, v128
  v_and_b32 v125, 0xffff0000, v128
  v_lshlrev_b32 v132, 16, v130
  v_and_b32 v133, 0xffff0000, v130
  v_lshlrev_b32 v126, 16, v129
  v_and_b32 v127, 0xffff0000, v129
  v_lshlrev_b32 v134, 16, v131
  v_and_b32 v135, 0xffff0000, v131
  v_add_f32 v124, v124, v132
  v_add_f32 v125, v125, v133
  v_add_f32 v126, v126, v134
  v_add_f32 v127, v127, v135
  v_cvt_pk_bf16_f32 v108, v124, v125
  v_cvt_pk_bf16_f32 v109, v126, v127
  ds_write_b64 v46, v[108:109] offset:512
  v_lshlrev_b32 v124, 16, v110
  v_and_b32 v125, 0xffff0000, v110
  v_lshlrev_b32 v126, 16, v111
  v_and_b32 v127, 0xffff0000, v111
  v_mul_f32 v124, v124, v33
  v_mul_f32 v125, v125, v33
  v_mul_f32 v126, v126, v33
  v_mul_f32 v127, v127, v33
  v_cvt_pk_bf16_f32 v128, v124, v125
  v_cvt_pk_bf16_f32 v129, v126, v127
  v_cvt_pk_bf16_f32 v130, v64, v65
  v_cvt_pk_bf16_f32 v131, v66, v67
  v_lshlrev_b32 v124, 16, v128
  v_and_b32 v125, 0xffff0000, v128
  v_lshlrev_b32 v132, 16, v130
  v_and_b32 v133, 0xffff0000, v130
  v_lshlrev_b32 v126, 16, v129
  v_and_b32 v127, 0xffff0000, v129
  v_lshlrev_b32 v134, 16, v131
  v_and_b32 v135, 0xffff0000, v131
  v_add_f32 v124, v124, v132
  v_add_f32 v125, v125, v133
  v_add_f32 v126, v126, v134
  v_add_f32 v127, v127, v135
  v_cvt_pk_bf16_f32 v110, v124, v125
  v_cvt_pk_bf16_f32 v111, v126, v127
  ds_write_b64 v46, v[110:111] offset:1024
  v_lshlrev_b32 v124, 16, v112
  v_and_b32 v125, 0xffff0000, v112
  v_lshlrev_b32 v126, 16, v113
  v_and_b32 v127, 0xffff0000, v113
  v_mul_f32 v124, v124, v33
  v_mul_f32 v125, v125, v33
  v_mul_f32 v126, v126, v33
  v_mul_f32 v127, v127, v33
  v_cvt_pk_bf16_f32 v128, v124, v125
  v_cvt_pk_bf16_f32 v129, v126, v127
  v_cvt_pk_bf16_f32 v130, v68, v69
  v_cvt_pk_bf16_f32 v131, v70, v71
  v_lshlrev_b32 v124, 16, v128
  v_and_b32 v125, 0xffff0000, v128
  v_lshlrev_b32 v132, 16, v130
  v_and_b32 v133, 0xffff0000, v130
  v_lshlrev_b32 v126, 16, v129
  v_and_b32 v127, 0xffff0000, v129
  v_lshlrev_b32 v134, 16, v131
  v_and_b32 v135, 0xffff0000, v131
  v_add_f32 v124, v124, v132
  v_add_f32 v125, v125, v133
  v_add_f32 v126, v126, v134
  v_add_f32 v127, v127, v135
  v_cvt_pk_bf16_f32 v112, v124, v125
  v_cvt_pk_bf16_f32 v113, v126, v127
  ds_write_b64 v46, v[112:113] offset:1536
  v_lshlrev_b32 v124, 16, v114
  v_and_b32 v125, 0xffff0000, v114
  v_lshlrev_b32 v126, 16, v115
  v_and_b32 v127, 0xffff0000, v115
  v_mul_f32 v124, v124, v33
  v_mul_f32 v125, v125, v33
  v_mul_f32 v126, v126, v33
  v_mul_f32 v127, v127, v33
  v_cvt_pk_bf16_f32 v128, v124, v125
  v_cvt_pk_bf16_f32 v129, v126, v127
  v_cvt_pk_bf16_f32 v130, v72, v73
  v_cvt_pk_bf16_f32 v131, v74, v75
  v_lshlrev_b32 v124, 16, v128
  v_and_b32 v125, 0xffff0000, v128
  v_lshlrev_b32 v132, 16, v130
  v_and_b32 v133, 0xffff0000, v130
  v_lshlrev_b32 v126, 16, v129
  v_and_b32 v127, 0xffff0000, v129
  v_lshlrev_b32 v134, 16, v131
  v_and_b32 v135, 0xffff0000, v131
  v_add_f32 v124, v124, v132
  v_add_f32 v125, v125, v133
  v_add_f32 v126, v126, v134
  v_add_f32 v127, v127, v135
  v_cvt_pk_bf16_f32 v114, v124, v125
  v_cvt_pk_bf16_f32 v115, v126, v127
  ds_write_b64 v46, v[114:115] offset:2048
  v_lshlrev_b32 v124, 16, v116
  v_and_b32 v125, 0xffff0000, v116
  v_lshlrev_b32 v126, 16, v117
  v_and_b32 v127, 0xffff0000, v117
  v_mul_f32 v124, v124, v33
  v_mul_f32 v125, v125, v33
  v_mul_f32 v126, v126, v33
  v_mul_f32 v127, v127, v33
  v_cvt_pk_bf16_f32 v128, v124, v125
  v_cvt_pk_bf16_f32 v129, v126, v127
  v_cvt_pk_bf16_f32 v130, v76, v77
  v_cvt_pk_bf16_f32 v131, v78, v79
  v_lshlrev_b32 v124, 16, v128
  v_and_b32 v125, 0xffff0000, v128
  v_lshlrev_b32 v132, 16, v130
  v_and_b32 v133, 0xffff0000, v130
  v_lshlrev_b32 v126, 16, v129
  v_and_b32 v127, 0xffff0000, v129
  v_lshlrev_b32 v134, 16, v131
  v_and_b32 v135, 0xffff0000, v131
  v_add_f32 v124, v124, v132
  v_add_f32 v125, v125, v133
  v_add_f32 v126, v126, v134
  v_add_f32 v127, v127, v135
  v_cvt_pk_bf16_f32 v116, v124, v125
  v_cvt_pk_bf16_f32 v117, v126, v127
  ds_write_b64 v46, v[116:117] offset:2560
  v_lshlrev_b32 v124, 16, v118
  v_and_b32 v125, 0xffff0000, v118
  v_lshlrev_b32 v126, 16, v119
  v_and_b32 v127, 0xffff0000, v119
  v_mul_f32 v124, v124, v33
  v_mul_f32 v125, v125, v33
  v_mul_f32 v126, v126, v33
  v_mul_f32 v127, v127, v33
  v_cvt_pk_bf16_f32 v128, v124, v125
  v_cvt_pk_bf16_f32 v129, v126, v127
  v_cvt_pk_bf16_f32 v130, v80, v81
  v_cvt_pk_bf16_f32 v131, v82, v83
  v_lshlrev_b32 v124, 16, v128
  v_and_b32 v125, 0xffff0000, v128
  v_lshlrev_b32 v132, 16, v130
  v_and_b32 v133, 0xffff0000, v130
  v_lshlrev_b32 v126, 16, v129
  v_and_b32 v127, 0xffff0000, v129
  v_lshlrev_b32 v134, 16, v131
  v_and_b32 v135, 0xffff0000, v131
  v_add_f32 v124, v124, v132
  v_add_f32 v125, v125, v133
  v_add_f32 v126, v126, v134
  v_add_f32 v127, v127, v135
  v_cvt_pk_bf16_f32 v118, v124, v125
  v_cvt_pk_bf16_f32 v119, v126, v127
  ds_write_b64 v46, v[118:119] offset:3072
  v_lshlrev_b32 v124, 16, v120
  v_and_b32 v125, 0xffff0000, v120
  v_lshlrev_b32 v126, 16, v121
  v_and_b32 v127, 0xffff0000, v121
  v_mul_f32 v124, v124, v33
  v_mul_f32 v125, v125, v33
  v_mul_f32 v126, v126, v33
  v_mul_f32 v127, v127, v33
  v_cvt_pk_bf16_f32 v128, v124, v125
  v_cvt_pk_bf16_f32 v129, v126, v127
  v_cvt_pk_bf16_f32 v130, v84, v85
  v_cvt_pk_bf16_f32 v131, v86, v87
  v_lshlrev_b32 v124, 16, v128
  v_and_b32 v125, 0xffff0000, v128
  v_lshlrev_b32 v132, 16, v130
  v_and_b32 v133, 0xffff0000, v130
  v_lshlrev_b32 v126, 16, v129
  v_and_b32 v127, 0xffff0000, v129
  v_lshlrev_b32 v134, 16, v131
  v_and_b32 v135, 0xffff0000, v131
  v_add_f32 v124, v124, v132
  v_add_f32 v125, v125, v133
  v_add_f32 v126, v126, v134
  v_add_f32 v127, v127, v135
  v_cvt_pk_bf16_f32 v120, v124, v125
  v_cvt_pk_bf16_f32 v121, v126, v127
  ds_write_b64 v46, v[120:121] offset:3584
  v_lshlrev_b32 v124, 16, v122
  v_and_b32 v125, 0xffff0000, v122
  v_lshlrev_b32 v126, 16, v123
  v_and_b32 v127, 0xffff0000, v123
  v_mul_f32 v124, v124, v33
  v_mul_f32 v125, v125, v33
  v_mul_f32 v126, v126, v33
  v_mul_f32 v127, v127, v33
  v_cvt_pk_bf16_f32 v128, v124, v125
  v_cvt_pk_bf16_f32 v129, v126, v127
  v_cvt_pk_bf16_f32 v130, v88, v89
  v_cvt_pk_bf16_f32 v131, v90, v91
  v_lshlrev_b32 v124, 16, v128
  v_and_b32 v125, 0xffff0000, v128
  v_lshlrev_b32 v132, 16, v130
  v_and_b32 v133, 0xffff0000, v130
  v_lshlrev_b32 v126, 16, v129
  v_and_b32 v127, 0xffff0000, v129
  v_lshlrev_b32 v134, 16, v131
  v_and_b32 v135, 0xffff0000, v131
  v_add_f32 v124, v124, v132
  v_add_f32 v125, v125, v133
  v_add_f32 v126, v126, v134
  v_add_f32 v127, v127, v135
  v_cvt_pk_bf16_f32 v122, v124, v125
  v_cvt_pk_bf16_f32 v123, v126, v127
  ds_write_b64 v46, v[122:123] offset:4096
  s_waitcnt lgkmcnt(0)
  s_barrier
  v_lshlrev_b32 v6, 3, v0
  v_mul_u32_u24 v5, 7168, v0
  v_add_u32 v36, 512, v6
  ds_read_b64 v[8:9], v36
  v_add_u32 v36, 25088, v6
  ds_read_b64 v[10:11], v36
  v_add_u32 v36, 49664, v6
  ds_read_b64 v[12:13], v36
  v_add_u32 v36, 74240, v6
  ds_read_b64 v[14:15], v36
  s_waitcnt lgkmcnt(0)
  s_add_u32 s22, s21, 0
  s_add_u32 s23, s22, 3584
  v_perm_b32 v16, v10, v8, s24
  v_perm_b32 v17, v14, v12, s24
  buffer_store_dwordx2 v[16:17], v5, s[88:91], s22 offen offset:0
  v_perm_b32 v18, v10, v8, s25
  v_perm_b32 v19, v14, v12, s25
  buffer_store_dwordx2 v[18:19], v5, s[88:91], s22 offen offset:1792
  v_perm_b32 v20, v11, v9, s24
  v_perm_b32 v21, v15, v13, s24
  buffer_store_dwordx2 v[20:21], v5, s[88:91], s23 offen offset:0
  v_perm_b32 v22, v11, v9, s25
  v_perm_b32 v23, v15, v13, s25
  buffer_store_dwordx2 v[22:23], v5, s[88:91], s23 offen offset:1792
  v_add_u32 v36, 2560, v6
  ds_read_b64 v[8:9], v36
  v_add_u32 v36, 27136, v6
  ds_read_b64 v[10:11], v36
  v_add_u32 v36, 51712, v6
  ds_read_b64 v[12:13], v36
  v_add_u32 v36, 76288, v6
  ds_read_b64 v[14:15], v36
  s_waitcnt lgkmcnt(0)
  s_add_u32 s22, s21, 1835008
  s_add_u32 s23, s22, 3584
  v_perm_b32 v24, v10, v8, s24
  v_perm_b32 v25, v14, v12, s24
  buffer_store_dwordx2 v[24:25], v5, s[88:91], s22 offen offset:0
  v_perm_b32 v26, v10, v8, s25
  v_perm_b32 v27, v14, v12, s25
  buffer_store_dwordx2 v[26:27], v5, s[88:91], s22 offen offset:1792
  v_perm_b32 v28, v11, v9, s24
  v_perm_b32 v29, v15, v13, s24
  buffer_store_dwordx2 v[28:29], v5, s[88:91], s23 offen offset:0
  v_perm_b32 v30, v11, v9, s25
  v_perm_b32 v31, v15, v13, s25
  buffer_store_dwordx2 v[30:31], v5, s[88:91], s23 offen offset:1792
  s_branch wk_loop
wk_tok:
  s_sub_u32 s3, s3, 736
  s_cmp_ge_u32 s3, 512
  s_cbranch_scc1 wk_done
  s_lshr_b32 s17, s3, 3
  s_and_b32 s18, s3, 3
  s_bitcmp1_b32 s3, 2
  s_cbranch_scc1 wk_toko
  s_lshl_b32 s20, s18, 2
  s_add_u32 s20, s20, s16
  s_lshl_b32 s21, s17, 4
  s_add_u32 s21, s21, s20
  s_mul_i32 s21, s21, 28672
  s_add_u32 s21, s21, 12845056
  s_mul_i32 s23, s17, 28672
  s_add_u32 s23, s23, 73859072
  s_mul_i32 s24, s17, 7168
  s_add_u32 s24, s24, 88002560
  s_lshr_b32 s25, s17, 3
  s_lshl_b32 s25, s25, 4
  s_add_u32 s25, s25, s20
  s_lshl_b32 s25, s25, 7
  s_add_u32 s25, s25, 88477696
  v_mov_b32 v60, 0
  s_mov_b32 s30, 0
wp_wf:
  buffer_load_dword v61, v60, s[8:11], s25 offen sc1
  s_waitcnt vmcnt(0)
  v_cmp_ne_u32 vcc, 56, v61
  s_cbranch_vccz wp_wf_ok
  s_sleep 4
  s_cmp_ge_u32 s17, 56
  s_cbranch_scc1 wp_wf_bo
  s_sleep 127
wp_wf_bo:
  s_add_u32 s30, s30, 1
  s_cmp_lt_u32 s30, 2000000
  s_cbranch_scc1 wp_wf
  s_branch wp_abort
wp_wf_ok:
  s_lshl_b32 s25, s17, 1
  s_mul_i32 s25, s25, 20480
  s_add_u32 s25, s25, 85381120
  s_lshl_b32 s26, s20, 10
  s_add_u32 s26, s26, s25
  s_lshl_b32 s27, s18, 10
  s_add_u32 s27, s27, s25
  s_lshr_b32 s28, s16, 1
  s_lshl_b32 s28, s28, 3
  s_add_u32 s27, s27, s28
  s_add_u32 s27, s27, 16384
  s_and_b32 s28, s16, 1
  s_cmp_eq_u32 s28, 0
  s_cselect_b32 s50, -1, 0
  s_cselect_b32 s51, 0, -1
  v_mov_b32 v44, -1
  v_mov_b32 v45, -1
  v_mov_b32 v46, -1
  v_mov_b32 v47, -1
  s_add_u32 s28, s26, 0
  s_add_u32 s29, s27, 0
  buffer_store_dwordx4 v[44:47], v2, s[8:11], s28 offen sc1
  s_mov_b64 exec, s[50:51]
  buffer_store_dwordx2 v[44:45], v2, s[8:11], s29 offen sc1
  s_mov_b64 exec, -1
  s_add_u32 s28, s26, 20480
  s_add_u32 s29, s27, 20480
  buffer_store_dwordx4 v[44:47], v2, s[8:11], s28 offen sc1
  s_mov_b64 exec, s[50:51]
  buffer_store_dwordx2 v[44:45], v2, s[8:11], s29 offen sc1
  s_mov_b64 exec, -1
  s_add_u32 s22, s21, 0
  buffer_load_dwordx4 a[0:3], v2, s[8:11], s22 offen offset:0 sc1
  buffer_load_dwordx4 a[4:7], v2, s[8:11], s22 offen offset:1024 sc1
  buffer_load_dwordx4 a[8:11], v2, s[8:11], s22 offen offset:2048 sc1
  buffer_load_dwordx4 a[12:15], v2, s[8:11], s22 offen offset:3072 sc1
  s_add_u32 s22, s21, 4096
  buffer_load_dwordx4 a[16:19], v2, s[8:11], s22 offen offset:0 sc1
  buffer_load_dwordx4 a[20:23], v2, s[8:11], s22 offen offset:1024 sc1
  buffer_load_dwordx4 a[24:27], v2, s[8:11], s22 offen offset:2048 sc1
  buffer_load_dwordx4 a[28:31], v2, s[8:11], s22 offen offset:3072 sc1
  s_add_u32 s22, s21, 8192
  buffer_load_dwordx4 a[32:35], v2, s[8:11], s22 offen offset:0 sc1
  buffer_load_dwordx4 a[36:39], v2, s[8:11], s22 offen offset:1024 sc1
  buffer_load_dwordx4 a[40:43], v2, s[8:11], s22 offen offset:2048 sc1
  buffer_load_dwordx4 a[44:47], v2, s[8:11], s22 offen offset:3072 sc1
  s_add_u32 s22, s21, 12288
  buffer_load_dwordx4 a[48:51], v2, s[8:11], s22 offen offset:0 sc1
  buffer_load_dwordx4 a[52:55], v2, s[8:11], s22 offen offset:1024 sc1
  buffer_load_dwordx4 a[56:59], v2, s[8:11], s22 offen offset:2048 sc1
  buffer_load_dwordx4 a[60:63], v2, s[8:11], s22 offen offset:3072 sc1
  s_add_u32 s22, s21, 16384
  buffer_load_dwordx4 a[64:67], v2, s[8:11], s22 offen offset:0 sc1
  buffer_load_dwordx4 a[68:71], v2, s[8:11], s22 offen offset:1024 sc1
  buffer_load_dwordx4 a[72:75], v2, s[8:11], s22 offen offset:2048 sc1
  buffer_load_dwordx4 a[76:79], v2, s[8:11], s22 offen offset:3072 sc1
  s_add_u32 s22, s21, 20480
  buffer_load_dwordx4 a[80:83], v2, s[8:11], s22 offen offset:0 sc1
  buffer_load_dwordx4 a[84:87], v2, s[8:11], s22 offen offset:1024 sc1
  buffer_load_dwordx4 a[88:91], v2, s[8:11], s22 offen offset:2048 sc1
  buffer_load_dwordx4 a[92:95], v2, s[8:11], s22 offen offset:3072 sc1
  s_add_u32 s22, s21, 24576
  buffer_load_dwordx4 a[96:99], v2, s[8:11], s22 offen offset:0 sc1
  buffer_load_dwordx4 a[100:103], v2, s[8:11], s22 offen offset:1024 sc1
  buffer_load_dwordx4 a[104:107], v2, s[8:11], s22 offen offset:2048 sc1
  buffer_load_dwordx4 a[108:111], v2, s[8:11], s22 offen offset:3072 sc1
  s_add_u32 s22, s23, 0
  buffer_load_dwordx4 a[112:115], v2, s[8:11], s22 offen offset:0 sc1
  buffer_load_dwordx4 a[116:119], v2, s[8:11], s22 offen offset:1024 sc1
  buffer_load_dwordx4 a[120:123], v2, s[8:11], s22 offen offset:2048 sc1
  buffer_load_dwordx4 a[124:127], v2, s[8:11], s22 offen offset:3072 sc1
  s_add_u32 s22, s23, 4096
  buffer_load_dwordx4 a[128:131], v2, s[8:11], s22 offen offset:0 sc1
  buffer_load_dwordx4 a[132:135], v2, s[8:11], s22 offen offset:1024 sc1
  buffer_load_dwordx4 a[136:139], v2, s[8:11], s22 offen offset:2048 sc1
  buffer_load_dwordx4 a[140:143], v2, s[8:11], s22 offen offset:3072 sc1
  s_add_u32 s22, s23, 8192
  buffer_load_dwordx4 a[144:147], v2, s[8:11], s22 offen offset:0 sc1
  buffer_load_dwordx4 a[148:151], v2, s[8:11], s22 offen offset:1024 sc1
  buffer_load_dwordx4 a[152:155], v2, s[8:11], s22 offen offset:2048 sc1
  buffer_load_dwordx4 a[156:159], v2, s[8:11], s22 offen offset:3072 sc1
  s_add_u32 s22, s23, 12288
  buffer_load_dwordx4 a[160:163], v2, s[8:11], s22 offen offset:0 sc1
  buffer_load_dwordx4 a[164:167], v2, s[8:11], s22 offen offset:1024 sc1
  buffer_load_dwordx4 a[168:171], v2, s[8:11], s22 offen offset:2048 sc1
  buffer_load_dwordx4 a[172:175], v2, s[8:11], s22 offen offset:3072 sc1
  s_add_u32 s22, s23, 16384
  buffer_load_dwordx4 a[176:179], v2, s[8:11], s22 offen offset:0 sc1
  buffer_load_dwordx4 a[180:183], v2, s[8:11], s22 offen offset:1024 sc1
  buffer_load_dwordx4 a[184:187], v2, s[8:11], s22 offen offset:2048 sc1
  buffer_load_dwordx4 a[188:191], v2, s[8:11], s22 offen offset:3072 sc1
  s_add_u32 s22, s23, 20480
  buffer_load_dwordx4 a[192:195], v2, s[8:11], s22 offen offset:0 sc1
  buffer_load_dwordx4 a[196:199], v2, s[8:11], s22 offen offset:1024 sc1
  buffer_load_dwordx4 a[200:203], v2, s[8:11], s22 offen offset:2048 sc1
  buffer_load_dwordx4 a[204:207], v2, s[8:11], s22 offen offset:3072 sc1
  s_add_u32 s22, s23, 24576
  buffer_load_dwordx4 a[208:211], v2, s[8:11], s22 offen offset:0 sc1
  buffer_load_dwordx4 a[212:215], v2, s[8:11], s22 offen offset:1024 sc1
  buffer_load_dwordx4 a[216:219], v2, s[8:11], s22 offen offset:2048 sc1
  buffer_load_dwordx4 a[220:223], v2, s[8:11], s22 offen offset:3072 sc1
  v_lshl_add_u32 v5, v3, 2, 0
  v_cmp_le_u32 s[40:41], v5, v4
  v_lshl_add_u32 v5, v3, 2, 1
  v_cmp_le_u32 s[42:43], v5, v4
  v_lshl_add_u32 v5, v3, 2, 2
  v_cmp_le_u32 s[44:45], v5, v4
  v_lshl_add_u32 v5, v3, 2, 3
  v_cmp_le_u32 s[46:47], v5, v4
  v_cmp_gt_u32 s[48:49], 2, v3
  v_mov_b32 v6, 0xff800000
  s_waitcnt vmcnt(0)
  s_lshl_b32 s25, s17, 7
  s_add_u32 s25, s25, 88494080
  v_mov_b32 v5, 1
  v_mov_b32 v7, 0
  s_waitcnt vmcnt(0)
  s_mov_b64 exec, 1
  buffer_atomic_add v5, v7, s[8:11], s25 offen
  s_mov_b64 exec, -1
  v_mfma_f32_16x16x32_bf16 v[8:11], a[112:115], a[0:3], 0
  v_mfma_f32_16x16x32_bf16 v[12:15], a[112:115], a[56:59], 0
  v_mfma_f32_16x16x32_bf16 v[16:19], a[168:171], a[56:59], 0
  v_mfma_f32_16x16x32_bf16 v[8:11], a[116:119], a[4:7], v[8:11]
  v_mfma_f32_16x16x32_bf16 v[12:15], a[116:119], a[60:63], v[12:15]
  v_mfma_f32_16x16x32_bf16 v[16:19], a[172:175], a[60:63], v[16:19]
  v_mfma_f32_16x16x32_bf16 v[8:11], a[120:123], a[8:11], v[8:11]
  v_mfma_f32_16x16x32_bf16 v[12:15], a[120:123], a[64:67], v[12:15]
  v_mfma_f32_16x16x32_bf16 v[16:19], a[176:179], a[64:67], v[16:19]
  v_mfma_f32_16x16x32_bf16 v[8:11], a[124:127], a[12:15], v[8:11]
  v_mfma_f32_16x16x32_bf16 v[12:15], a[124:127], a[68:71], v[12:15]
  v_mfma_f32_16x16x32_bf16 v[16:19], a[180:183], a[68:71], v[16:19]
  v_mfma_f32_16x16x32_bf16 v[8:11], a[128:131], a[16:19], v[8:11]
  v_mfma_f32_16x16x32_bf16 v[12:15], a[128:131], a[72:75], v[12:15]
  v_mfma_f32_16x16x32_bf16 v[16:19], a[184:187], a[72:75], v[16:19]
  v_mfma_f32_16x16x32_bf16 v[8:11], a[132:135], a[20:23], v[8:11]
  v_mfma_f32_16x16x32_bf16 v[12:15], a[132:135], a[76:79], v[12:15]
  v_mfma_f32_16x16x32_bf16 v[16:19], a[188:191], a[76:79], v[16:19]
  v_mfma_f32_16x16x32_bf16 v[8:11], a[136:139], a[24:27], v[8:11]
  v_mfma_f32_16x16x32_bf16 v[12:15], a[136:139], a[80:83], v[12:15]
  v_mfma_f32_16x16x32_bf16 v[16:19], a[192:195], a[80:83], v[16:19]
  v_mfma_f32_16x16x32_bf16 v[8:11], a[140:143], a[28:31], v[8:11]
  v_mfma_f32_16x16x32_bf16 v[12:15], a[140:143], a[84:87], v[12:15]
  v_mfma_f32_16x16x32_bf16 v[16:19], a[196:199], a[84:87], v[16:19]
  v_mfma_f32_16x16x32_bf16 v[8:11], a[144:147], a[32:35], v[8:11]
  v_mfma_f32_16x16x32_bf16 v[12:15], a[144:147], a[88:91], v[12:15]
  v_mfma_f32_16x16x32_bf16 v[16:19], a[200:203], a[88:91], v[16:19]
  v_mfma_f32_16x16x32_bf16 v[8:11], a[148:151], a[36:39], v[8:11]
  v_mfma_f32_16x16x32_bf16 v[12:15], a[148:151], a[92:95], v[12:15]
  v_mfma_f32_16x16x32_bf16 v[16:19], a[204:207], a[92:95], v[16:19]
  v_mfma_f32_16x16x32_bf16 v[8:11], a[152:155], a[40:43], v[8:11]
  v_mfma_f32_16x16x32_bf16 v[12:15], a[152:155], a[96:99], v[12:15]
  v_mfma_f32_16x16x32_bf16 v[16:19], a[208:211], a[96:99], v[16:19]
  v_mfma_f32_16x16x32_bf16 v[8:11], a[156:159], a[44:47], v[8:11]
  v_mfma_f32_16x16x32_bf16 v[12:15], a[156:159], a[100:103], v[12:15]
  v_mfma_f32_16x16x32_bf16 v[16:19], a[212:215], a[100:103], v[16:19]
  v_mfma_f32_16x16x32_bf16 v[8:11], a[160:163], a[48:51], v[8:11]
  v_mfma_f32_16x16x32_bf16 v[12:15], a[160:163], a[104:107], v[12:15]
  v_mfma_f32_16x16x32_bf16 v[16:19], a[216:219], a[104:107], v[16:19]
  v_mfma_f32_16x16x32_bf16 v[8:11], a[164:167], a[52:55], v[8:11]
  v_mfma_f32_16x16x32_bf16 v[12:15], a[164:167], a[108:111], v[12:15]
  v_mfma_f32_16x16x32_bf16 v[16:19], a[220:223], a[108:111], v[16:19]
  s_mul_i32 s22, s20, 448
  v_mov_b32 v62, s22
  s_mov_b32 s30, 0
wp_pm:
  s_cmp_ge_u32 s17, 64
  s_cbranch_scc1 wp_pf
  buffer_load_dword v61, v62, s[8:11], s24 offen sc1
  s_waitcnt vmcnt(0)
  v_cmp_eq_u32 vcc, -1, v61
  s_cbranch_vccnz wp_pr
wp_pf:
  s_add_u32 s22, s24, 4096
  buffer_load_dwordx4 v[64:67], v2, s[8:11], s24 offen offset:0 sc1
  buffer_load_dwordx4 v[68:71], v2, s[8:11], s24 offen offset:1024 sc1
  buffer_load_dwordx4 v[72:75], v2, s[8:11], s24 offen offset:2048 sc1
  buffer_load_dwordx4 v[76:79], v2, s[8:11], s24 offen offset:3072 sc1
  buffer_load_dwordx4 v[80:83], v2, s[8:11], s22 offen offset:0 sc1
  buffer_load_dwordx4 v[84:87], v2, s[8:11], s22 offen offset:1024 sc1
  buffer_load_dwordx4 v[88:91], v2, s[8:11], s22 offen offset:2048 sc1
  s_waitcnt vmcnt(0)
  v_max_u32 v61, v64, v65
  v_max3_u32 v61, v61, v66, v67
  v_max3_u32 v61, v61, v68, v69
  v_max3_u32 v61, v61, v70, v71
  v_max3_u32 v61, v61, v72, v73
  v_max3_u32 v61, v61, v74, v75
  v_max3_u32 v61, v61, v76, v77
  v_max3_u32 v61, v61, v78, v79
  v_max3_u32 v61, v61, v80, v81
  v_max3_u32 v61, v61, v82, v83
  v_max3_u32 v61, v61, v84, v85
  v_max3_u32 v61, v61, v86, v87
  v_max3_u32 v61, v61, v88, v89
  v_max3_u32 v61, v61, v90, v91
  v_cmp_eq_u32 vcc, -1, v61
  s_cbranch_vccz wp_pk
wp_pr:
  s_sleep 4
  s_cmp_ge_u32 s17, 56
  s_cbranch_scc1 wp_pm_bo
  s_sleep 127
wp_pm_bo:
  s_add_u32 s30, s30, 1
  s_cmp_lt_u32 s30, 2000000
  s_cbranch_scc1 wp_pm
  s_branch wp_abort
wp_pk:
  buffer_load_dword v250, v251, s[8:11], 0 offen sc1
  v_mfma_f32_16x16x32_bf16 v[20:23], v[64:67], a[0:3], 0
  v_mfma_f32_16x16x32_bf16 v[24:27], v[64:67], a[4:7], 0
  v_mfma_f32_16x16x32_bf16 v[28:31], v[64:67], a[56:59], 0
  v_mfma_f32_16x16x32_bf16 v[32:35], v[64:67], a[60:63], 0
  v_mfma_f32_16x16x32_bf16 v[20:23], v[68:71], a[8:11], v[20:23]
  v_mfma_f32_16x16x32_bf16 v[24:27], v[68:71], a[12:15], v[24:27]
  v_mfma_f32_16x16x32_bf16 v[28:31], v[68:71], a[64:67], v[28:31]
  v_mfma_f32_16x16x32_bf16 v[32:35], v[68:71], a[68:71], v[32:35]
  v_mfma_f32_16x16x32_bf16 v[20:23], v[72:75], a[16:19], v[20:23]
  v_mfma_f32_16x16x32_bf16 v[24:27], v[72:75], a[20:23], v[24:27]
  v_mfma_f32_16x16x32_bf16 v[28:31], v[72:75], a[72:75], v[28:31]
  v_mfma_f32_16x16x32_bf16 v[32:35], v[72:75], a[76:79], v[32:35]
  v_mfma_f32_16x16x32_bf16 v[20:23], v[76:79], a[24:27], v[20:23]
  v_mfma_f32_16x16x32_bf16 v[24:27], v[76:79], a[28:31], v[24:27]
  v_mfma_f32_16x16x32_bf16 v[28:31], v[76:79], a[80:83], v[28:31]
  v_mfma_f32_16x16x32_bf16 v[32:35], v[76:79], a[84:87], v[32:35]
  v_mfma_f32_16x16x32_bf16 v[20:23], v[80:83], a[32:35], v[20:23]
  v_mfma_f32_16x16x32_bf16 v[24:27], v[80:83], a[36:39], v[24:27]
  v_mfma_f32_16x16x32_bf16 v[28:31], v[80:83], a[88:91], v[28:31]
  v_mfma_f32_16x16x32_bf16 v[32:35], v[80:83], a[92:95], v[32:35]
  v_mfma_f32_16x16x32_bf16 v[20:23], v[84:87], a[40:43], v[20:23]
  v_mfma_f32_16x16x32_bf16 v[24:27], v[84:87], a[44:47], v[24:27]
  v_mfma_f32_16x16x32_bf16 v[28:31], v[84:87], a[96:99], v[28:31]
  v_mfma_f32_16x16x32_bf16 v[32:35], v[84:87], a[100:103], v[32:35]
  v_mfma_f32_16x16x32_bf16 v[20:23], v[88:91], a[48:51], v[20:23]
  v_mfma_f32_16x16x32_bf16 v[24:27], v[88:91], a[52:55], v[24:27]
  v_mfma_f32_16x16x32_bf16 v[28:31], v[88:91], a[104:107], v[28:31]
  v_mfma_f32_16x16x32_bf16 v[32:35], v[88:91], a[108:111], v[32:35]
  v_cndmask_b32 v8, v6, v8, s[40:41]
  v_cndmask_b32 v9, v6, v9, s[42:43]
  v_cndmask_b32 v10, v6, v10, s[44:45]
  v_cndmask_b32 v11, v6, v11, s[46:47]
  v_cndmask_b32 v20, v24, v20, s[48:49]
  v_cndmask_b32 v21, v25, v21, s[48:49]
  v_cndmask_b32 v22, v26, v22, s[48:49]
  v_cndmask_b32 v23, v27, v23, s[48:49]
  v_mov_b32 v24, v20
  v_mov_b32 v25, v21
  v_mov_b32 v26, v22
  v_mov_b32 v27, v23
  v_permlane32_swap_b32 v20, v24
  v_permlane32_swap_b32 v21, v25
  v_permlane32_swap_b32 v22, v26
  v_permlane32_swap_b32 v23, v27
  v_add_f32 v20, v20, v24
  v_add_f32 v21, v21, v25
  v_add_f32 v22, v22, v26
  v_add_f32 v23, v23, v27
  v_max3_f32 v40, v8, v9, v10
  v_max3_f32 v40, v40, v11, v20
  v_max3_f32 v40, v40, v21, v22
  v_max_f32 v40, v40, v23
  v_mov_b32 v41, v40
  s_nop 1
  v_permlane16_swap_b32 v40, v41
  v_max_f32 v40, v40, v41
  v_mov_b32 v41, v40
  s_nop 1
  v_permlane32_swap_b32 v40, v41
  v_max_f32 v40, v40, v41
  v_sub_f32 v8, v8, v40
  v_sub_f32 v9, v9, v40
  v_sub_f32 v10, v10, v40
  v_sub_f32 v11, v11, v40
  v_sub_f32 v20, v20, v40
  v_sub_f32 v21, v21, v40
  v_sub_f32 v22, v22, v40
  v_sub_f32 v23, v23, v40
  v_exp_f32 v8, v8
  v_exp_f32 v9, v9
  v_exp_f32 v10, v10
  v_exp_f32 v11, v11
  v_exp_f32 v20, v20
  v_exp_f32 v21, v21
  v_exp_f32 v22, v22
  v_exp_f32 v23, v23
  v_add_f32 v42, v20, v21
  v_add_f32 v43, v22, v23
  v_add_f32 v42, v42, v43
  v_mul_f32 v42, 0.5, v42
  v_add_f32 v42, v42, v8
  v_add_f32 v42, v42, v9
  v_add_f32 v42, v42, v10
  v_add_f32 v42, v42, v11
  v_mov_b32 v41, v42
  s_nop 1
  v_permlane16_swap_b32 v42, v41
  v_add_f32 v42, v42, v41
  v_mov_b32 v41, v42
  s_nop 1
  v_permlane32_swap_b32 v42, v41
  v_add_f32 v42, v42, v41
  v_rcp_f32 v42, v42
  s_nop 0
  v_mul_f32 v8, v8, v42
  v_mul_f32 v9, v9, v42
  v_mul_f32 v10, v10, v42
  v_mul_f32 v11, v11, v42
  v_mul_f32 v20, v20, v42
  v_mul_f32 v21, v21, v42
  v_mul_f32 v22, v22, v42
  v_mul_f32 v23, v23, v42
  v_cvt_pk_bf16_f32 v44, v8, 0
  v_cvt_pk_bf16_f32 v45, v9, 0
  v_cvt_pk_bf16_f32 v46, v10, 0
  v_cvt_pk_bf16_f32 v47, v11, 0
  v_cvt_pk_bf16_f32 v48, v20, v21
  v_cvt_pk_bf16_f32 v49, v22, v23
  v_min_u32 v44, -2, v44
  v_min_u32 v45, -2, v45
  v_min_u32 v46, -2, v46
  v_min_u32 v47, -2, v47
  v_min_u32 v48, -2, v48
  v_min_u32 v49, -2, v49
  buffer_store_dwordx4 v[44:47], v2, s[8:11], s26 offen sc1
  s_mov_b64 exec, s[50:51]
  buffer_store_dwordx2 v[48:49], v2, s[8:11], s27 offen sc1
  s_mov_b64 exec, -1
  s_add_u32 s26, s26, 20480
  s_add_u32 s27, s27, 20480
  v_cndmask_b32 v16, v6, v16, s[40:41]
  v_cndmask_b32 v17, v6, v17, s[42:43]
  v_cndmask_b32 v18, v6, v18, s[44:45]
  v_cndmask_b32 v19, v6, v19, s[46:47]
  v_cndmask_b32 v28, v32, v28, s[48:49]
  v_cndmask_b32 v29, v33, v29, s[48:49]
  v_cndmask_b32 v30, v34, v30, s[48:49]
  v_cndmask_b32 v31, v35, v31, s[48:49]
  v_mov_b32 v32, v28
  v_mov_b32 v33, v29
  v_mov_b32 v34, v30
  v_mov_b32 v35, v31
  v_permlane32_swap_b32 v28, v32
  v_permlane32_swap_b32 v29, v33
  v_permlane32_swap_b32 v30, v34
  v_permlane32_swap_b32 v31, v35
  v_add_f32 v28, v28, v32
  v_add_f32 v29, v29, v33
  v_add_f32 v30, v30, v34
  v_add_f32 v31, v31, v35
  v_max3_f32 v40, v12, v13, v14
  v_max3_f32 v40, v40, v15, v16
  v_max3_f32 v40, v40, v17, v18
  v_max3_f32 v40, v40, v19, v28
  v_max3_f32 v40, v40, v29, v30
  v_max_f32 v40, v40, v31
  v_mov_b32 v41, v40
  s_nop 1
  v_permlane16_swap_b32 v40, v41
  v_max_f32 v40, v40, v41
  v_mov_b32 v41, v40
  s_nop 1
  v_permlane32_swap_b32 v40, v41
  v_max_f32 v40, v40, v41
  v_sub_f32 v12, v12, v40
  v_sub_f32 v13, v13, v40
  v_sub_f32 v14, v14, v40
  v_sub_f32 v15, v15, v40
  v_sub_f32 v16, v16, v40
  v_sub_f32 v17, v17, v40
  v_sub_f32 v18, v18, v40
  v_sub_f32 v19, v19, v40
  v_sub_f32 v28, v28, v40
  v_sub_f32 v29, v29, v40
  v_sub_f32 v30, v30, v40
  v_sub_f32 v31, v31, v40
  v_exp_f32 v12, v12
  v_exp_f32 v13, v13
  v_exp_f32 v14, v14
  v_exp_f32 v15, v15
  v_exp_f32 v16, v16
  v_exp_f32 v17, v17
  v_exp_f32 v18, v18
  v_exp_f32 v19, v19
  v_exp_f32 v28, v28
  v_exp_f32 v29, v29
  v_exp_f32 v30, v30
  v_exp_f32 v31, v31
  v_add_f32 v42, v28, v29
  v_add_f32 v43, v30, v31
  v_add_f32 v42, v42, v43
  v_mul_f32 v42, 0.5, v42
  v_add_f32 v42, v42, v12
  v_add_f32 v42, v42, v13
  v_add_f32 v42, v42, v14
  v_add_f32 v42, v42, v15
  v_add_f32 v42, v42, v16
  v_add_f32 v42, v42, v17
  v_add_f32 v42, v42, v18
  v_add_f32 v42, v42, v19
  v_mov_b32 v41, v42
  s_nop 1
  v_permlane16_swap_b32 v42, v41
  v_add_f32 v42, v42, v41
  v_mov_b32 v41, v42
  s_nop 1
  v_permlane32_swap_b32 v42, v41
  v_add_f32 v42, v42, v41
  v_rcp_f32 v42, v42
  s_nop 0
  v_mul_f32 v12, v12, v42
  v_mul_f32 v13, v13, v42
  v_mul_f32 v14, v14, v42
  v_mul_f32 v15, v15, v42
  v_mul_f32 v16, v16, v42
  v_mul_f32 v17, v17, v42
  v_mul_f32 v18, v18, v42
  v_mul_f32 v19, v19, v42
  v_mul_f32 v28, v28, v42
  v_mul_f32 v29, v29, v42
  v_mul_f32 v30, v30, v42
  v_mul_f32 v31, v31, v42
  v_cvt_pk_bf16_f32 v52, v12, v16
  v_cvt_pk_bf16_f32 v53, v13, v17
  v_cvt_pk_bf16_f32 v54, v14, v18
  v_cvt_pk_bf16_f32 v55, v15, v19
  v_cvt_pk_bf16_f32 v56, v28, v29
  v_cvt_pk_bf16_f32 v57, v30, v31
  v_min_u32 v52, -2, v52
  v_min_u32 v53, -2, v53
  v_min_u32 v54, -2, v54
  v_min_u32 v55, -2, v55
  v_min_u32 v56, -2, v56
  v_min_u32 v57, -2, v57
  buffer_store_dwordx4 v[52:55], v2, s[8:11], s26 offen sc1
  s_mov_b64 exec, s[50:51]
  buffer_store_dwordx2 v[56:57], v2, s[8:11], s27 offen sc1
  s_mov_b64 exec, -1
  s_branch wk_loop
wk_toko:
  s_lshl_b32 s20, s18, 2
  s_add_u32 s20, s20, s16
  s_mul_i32 s24, s20, 65
  s_add_u32 s24, s24, s17
  s_lshl_b32 s24, s24, 13
  s_add_u32 s24, s24, 76869632
  s_mul_i32 s21, s20, 28672
  s_mul_i32 s22, s17, 458752
  s_add_u32 s21, s21, s22
  s_add_u32 s21, s21, 42205184
  s_lshl_b32 s25, s17, 1
  s_mul_i32 s25, s25, 20480
  s_add_u32 s25, s25, 85381120
  v_mov_b32 v5, v2
  v_min_u32 v6, 11, v4
  v_mad_u32_u24 v6, v3, 12, v6
  v_lshlrev_b32 v6, 4, v6
  v_add_u32 v6, 1024, v6
  v_lshrrev_b32 v8, 1, v3
  v_lshl_add_u32 v8, v8, 4, v4
  v_lshlrev_b32 v8, 4, v8
  v_and_b32 v9, 1, v3
  v_lshl_add_u32 v7, v9, 3, v8
  s_lshr_b32 s26, s17, 3
  s_lshl_b32 s26, s26, 4
  s_add_u32 s26, s26, s20
  s_lshl_b32 s26, s26, 7
  s_add_u32 s26, s26, 88461312
  v_mov_b32 v60, 0
  s_mov_b32 s30, 0
wo_wv:
  buffer_load_dword v61, v60, s[8:11], s26 offen sc1
  s_waitcnt vmcnt(0)
  v_cmp_ne_u32 vcc, 56, v61
  s_cbranch_vccz wo_wv_ok
  s_sleep 4
  s_cmp_ge_u32 s17, 56
  s_cbranch_scc1 wo_wv_bo
  s_sleep 127
wo_wv_bo:
  s_add_u32 s30, s30, 1
  s_cmp_lt_u32 s30, 2000000
  s_cbranch_scc1 wo_wv
  s_branch wo_abort
wo_wv_ok:
  s_add_u32 s22, s21, 0
  buffer_load_dwordx4 a[0:3], v5, s[8:11], s22 offen offset:0 sc1
  buffer_load_dwordx4 a[4:7], v6, s[8:11], s22 offen offset:0 sc1
  buffer_load_dwordx4 a[8:11], v5, s[8:11], s22 offen offset:1792 sc1
  buffer_load_dwordx4 a[12:15], v6, s[8:11], s22 offen offset:1792 sc1
  s_add_u32 s22, s21, 3584
  buffer_load_dwordx4 a[16:19], v5, s[8:11], s22 offen offset:0 sc1
  buffer_load_dwordx4 a[20:23], v6, s[8:11], s22 offen offset:0 sc1
  buffer_load_dwordx4 a[24:27], v5, s[8:11], s22 offen offset:1792 sc1
  buffer_load_dwordx4 a[28:31], v6, s[8:11], s22 offen offset:1792 sc1
  s_add_u32 s22, s21, 7168
  buffer_load_dwordx4 a[32:35], v5, s[8:11], s22 offen offset:0 sc1
  buffer_load_dwordx4 a[36:39], v6, s[8:11], s22 offen offset:0 sc1
  buffer_load_dwordx4 a[40:43], v5, s[8:11], s22 offen offset:1792 sc1
  buffer_load_dwordx4 a[44:47], v6, s[8:11], s22 offen offset:1792 sc1
  s_add_u32 s22, s21, 10752
  buffer_load_dwordx4 a[48:51], v5, s[8:11], s22 offen offset:0 sc1
  buffer_load_dwordx4 a[52:55], v6, s[8:11], s22 offen offset:0 sc1
  buffer_load_dwordx4 a[56:59], v5, s[8:11], s22 offen offset:1792 sc1
  buffer_load_dwordx4 a[60:63], v6, s[8:11], s22 offen offset:1792 sc1
  s_add_u32 s22, s21, 14336
  buffer_load_dwordx4 a[64:67], v5, s[8:11], s22 offen offset:0 sc1
  buffer_load_dwordx4 a[68:71], v6, s[8:11], s22 offen offset:0 sc1
  buffer_load_dwordx4 a[72:75], v5, s[8:11], s22 offen offset:1792 sc1
  buffer_load_dwordx4 a[76:79], v6, s[8:11], s22 offen offset:1792 sc1
  s_add_u32 s22, s21, 17920
  buffer_load_dwordx4 a[80:83], v5, s[8:11], s22 offen offset:0 sc1
  buffer_load_dwordx4 a[84:87], v6, s[8:11], s22 offen offset:0 sc1
  buffer_load_dwordx4 a[88:91], v5, s[8:11], s22 offen offset:1792 sc1
  buffer_load_dwordx4 a[92:95], v6, s[8:11], s22 offen offset:1792 sc1
  s_add_u32 s22, s21, 21504
  buffer_load_dwordx4 a[96:99], v5, s[8:11], s22 offen offset:0 sc1
  buffer_load_dwordx4 a[100:103], v6, s[8:11], s22 offen offset:0 sc1
  buffer_load_dwordx4 a[104:107], v5, s[8:11], s22 offen offset:1792 sc1
  buffer_load_dwordx4 a[108:111], v6, s[8:11], s22 offen offset:1792 sc1
  s_add_u32 s22, s21, 25088
  buffer_load_dwordx4 a[112:115], v5, s[8:11], s22 offen offset:0 sc1
  buffer_load_dwordx4 a[116:119], v6, s[8:11], s22 offen offset:0 sc1
  buffer_load_dwordx4 a[120:123], v5, s[8:11], s22 offen offset:1792 sc1
  buffer_load_dwordx4 a[124:127], v6, s[8:11], s22 offen offset:1792 sc1
  s_lshl_b32 s26, s20, 6
  s_add_u32 s26, s26, s17
  s_lshl_b32 s26, s26, 4
  s_add_u32 s26, s26, 88502272
  v_lshlrev_b32 v60, 2, v3
  s_mov_b32 s30, 0
wo_wt:
  buffer_load_dword v61, v60, s[8:11], s26 offen sc1
  s_waitcnt vmcnt(0)
  v_cmp_ne_u32 vcc, 1, v61
  s_cbranch_vccz wo_wt_ok
  s_sleep 4
  s_cmp_ge_u32 s17, 56
  s_cbranch_scc1 wo_wt_bo
  s_sleep 127
wo_wt_bo:
  s_add_u32 s30, s30, 1
  s_cmp_lt_u32 s30, 2000000
  s_cbranch_scc1 wo_wt
  s_branch wo_abort
wo_wt_ok:
  s_lshl_b32 s26, s17, 7
  s_add_u32 s26, s26, 88494080
  v_mov_b32 v60, 0
  s_mov_b32 s30, 0
wo_wp:
  buffer_load_dword v61, v60, s[8:11], s26 offen sc1
  s_waitcnt vmcnt(0)
  v_cmp_ne_u32 vcc, 16, v61
  s_cbranch_vccz wo_wp_ok
  s_sleep 4
  s_cmp_ge_u32 s17, 56
  s_cbranch_scc1 wo_wp_bo
  s_sleep 127
wo_wp_bo:
  s_add_u32 s30, s30, 1
  s_cmp_lt_u32 s30, 2000000
  s_cbranch_scc1 wo_wp
  s_branch wo_abort
wo_wp_ok:
  s_lshl_b32 s28, s16, 12
  s_add_u32 s26, s25, s28
  s_add_u32 s27, s26, 20480
  s_lshl_b32 s28, s16, 10
  s_add_u32 s28, s28, s25
  s_add_u32 s28, s28, 16384
  s_add_u32 s29, s28, 20480
  s_add_u32 s23, s24, 4096
  s_mov_b32 s30, 0
wo_pl:
  buffer_load_dwordx4 v[64:67], v2, s[8:11], s26 offen offset:0 sc1
  buffer_load_dwordx4 v[68:71], v2, s[8:11], s26 offen offset:1024 sc1
  buffer_load_dwordx4 v[72:75], v2, s[8:11], s26 offen offset:2048 sc1
  buffer_load_dwordx4 v[76:79], v2, s[8:11], s26 offen offset:3072 sc1
  buffer_load_dwordx4 v[80:83], v2, s[8:11], s28 offen sc1
  buffer_load_dwordx4 v[84:87], v2, s[8:11], s27 offen offset:0 sc1
  buffer_load_dwordx4 v[88:91], v2, s[8:11], s27 offen offset:1024 sc1
  buffer_load_dwordx4 v[92:95], v2, s[8:11], s27 offen offset:2048 sc1
  buffer_load_dwordx4 v[96:99], v2, s[8:11], s27 offen offset:3072 sc1
  buffer_load_dwordx4 v[100:103], v2, s[8:11], s29 offen sc1
  buffer_load_dwordx2 v[28:29], v7, s[8:11], s24 offen offset:0 sc1
  buffer_load_dwordx2 v[30:31], v7, s[8:11], s24 offen offset:512 sc1
  buffer_load_dwordx2 v[32:33], v7, s[8:11], s24 offen offset:1024 sc1
  buffer_load_dwordx2 v[34:35], v7, s[8:11], s24 offen offset:1536 sc1
  buffer_load_dwordx2 v[36:37], v7, s[8:11], s24 offen offset:2048 sc1
  buffer_load_dwordx2 v[38:39], v7, s[8:11], s24 offen offset:2560 sc1
  buffer_load_dwordx2 v[40:41], v7, s[8:11], s24 offen offset:3072 sc1
  buffer_load_dwordx2 v[42:43], v7, s[8:11], s24 offen offset:3584 sc1
  buffer_load_dwordx2 v[44:45], v7, s[8:11], s23 offen offset:0 sc1
  buffer_load_dwordx2 v[46:47], v7, s[8:11], s23 offen offset:512 sc1
  buffer_load_dwordx2 v[48:49], v7, s[8:11], s23 offen offset:1024 sc1
  buffer_load_dwordx2 v[50:51], v7, s[8:11], s23 offen offset:1536 sc1
  buffer_load_dwordx2 v[52:53], v7, s[8:11], s23 offen offset:2048 sc1
  buffer_load_dwordx2 v[54:55], v7, s[8:11], s23 offen offset:2560 sc1
  buffer_load_dwordx2 v[56:57], v7, s[8:11], s23 offen offset:3072 sc1
  buffer_load_dwordx2 v[58:59], v7, s[8:11], s23 offen offset:3584 sc1
  s_waitcnt vmcnt(16)
  v_max_u32 v61, v64, v65
  v_max3_u32 v61, v61, v66, v67
  v_max3_u32 v61, v61, v68, v69
  v_max3_u32 v61, v61, v70, v71
  v_max3_u32 v61, v61, v72, v73
  v_max3_u32 v61, v61, v74, v75
  v_max3_u32 v61, v61, v76, v77
  v_max3_u32 v61, v61, v78, v79
  v_max3_u32 v61, v61, v80, v81
  v_max3_u32 v61, v61, v82, v83
  v_max3_u32 v61, v61, v84, v85
  v_max3_u32 v61, v61, v86, v87
  v_max3_u32 v61, v61, v88, v89
  v_max3_u32 v61, v61, v90, v91
  v_max3_u32 v61, v61, v92, v93
  v_max3_u32 v61, v61, v94, v95
  v_max3_u32 v61, v61, v96, v97
  v_max3_u32 v61, v61, v98, v99
  v_max3_u32 v61, v61, v100, v101
  v_max3_u32 v61, v61, v102, v103
  s_mul_i32 s22, s16, 10240
  v_add_u32 v62, s22, v2
  ds_write_b128 v62, v[64:67] offset:0
  ds_write_b128 v62, v[68:71] offset:1024
  ds_write_b128 v62, v[72:75] offset:2048
  ds_write_b128 v62, v[76:79] offset:3072
  ds_write_b128 v62, v[80:83] offset:4096
  ds_write_b128 v62, v[84:87] offset:5120
  ds_write_b128 v62, v[88:91] offset:6144
  ds_write_b128 v62, v[92:95] offset:7168
  ds_write_b128 v62, v[96:99] offset:8192
  ds_write_b128 v62, v[100:103] offset:9216
  s_waitcnt vmcnt(0)
  v_max3_u32 v61, v61, v28, v29
  v_max3_u32 v61, v61, v30, v31
  v_max3_u32 v61, v61, v32, v33
  v_max3_u32 v61, v61, v34, v35
  v_max3_u32 v61, v61, v36, v37
  v_max3_u32 v61, v61, v38, v39
  v_max3_u32 v61, v61, v40, v41
  v_max3_u32 v61, v61, v42, v43
  v_max3_u32 v61, v61, v44, v45
  v_max3_u32 v61, v61, v46, v47
  v_max3_u32 v61, v61, v48, v49
  v_max3_u32 v61, v61, v50, v51
  v_max3_u32 v61, v61, v52, v53
  v_max3_u32 v61, v61, v54, v55
  v_max3_u32 v61, v61, v56, v57
  v_max3_u32 v61, v61, v58, v59
  v_cmp_eq_u32 vcc, -1, v61
  s_cbranch_vccz wo_pk
  s_waitcnt lgkmcnt(0)
  s_sleep 1
  s_cmp_ge_u32 s17, 56
  s_cbranch_scc1 wo_pl_bo
  s_sleep 127
wo_pl_bo:
  s_add_u32 s30, s30, 1
  s_cmp_lt_u32 s30, 2000000
  s_cbranch_scc1 wo_pl
  s_branch wo_abort
wo_pk:
  buffer_load_dword v250, v251, s[8:11], 0 offen sc1
  s_waitcnt lgkmcnt(0)
  s_barrier
  ds_read_b128 v[64:67], v2 offset:0
  ds_read_b128 v[68:71], v2 offset:5120
  ds_read_b128 v[72:75], v2 offset:1024
  ds_read_b128 v[76:79], v2 offset:6144
  ds_read_b128 v[80:83], v2 offset:2048
  ds_read_b128 v[84:87], v2 offset:7168
  ds_read_b128 v[88:91], v2 offset:3072
  ds_read_b128 v[92:95], v2 offset:8192
  s_waitcnt lgkmcnt(7)
  v_mfma_f32_16x16x32_bf16 v[12:15], a[0:3], v[64:67], 0
  ds_read_b128 v[96:99], v2 offset:4096
  v_mfma_f32_16x16x32_bf16 v[20:23], a[4:7], v[64:67], 0
  s_waitcnt lgkmcnt(7)
  v_mfma_f32_16x16x32_bf16 v[16:19], a[0:3], v[68:71], 0
  ds_read_b128 v[100:103], v2 offset:9216
  v_mfma_f32_16x16x32_bf16 v[24:27], a[4:7], v[68:71], 0
  s_waitcnt lgkmcnt(7)
  v_mfma_f32_16x16x32_bf16 v[12:15], a[8:11], v[72:75], v[12:15]
  ds_read_b128 v[64:67], v2 offset:10240
  v_mfma_f32_16x16x32_bf16 v[20:23], a[12:15], v[72:75], v[20:23]
  s_waitcnt lgkmcnt(7)
  v_mfma_f32_16x16x32_bf16 v[16:19], a[8:11], v[76:79], v[16:19]
  ds_read_b128 v[68:71], v2 offset:15360
  v_mfma_f32_16x16x32_bf16 v[24:27], a[12:15], v[76:79], v[24:27]
  s_waitcnt lgkmcnt(7)
  v_mfma_f32_16x16x32_bf16 v[12:15], a[16:19], v[80:83], v[12:15]
  ds_read_b128 v[72:75], v2 offset:11264
  v_mfma_f32_16x16x32_bf16 v[20:23], a[20:23], v[80:83], v[20:23]
  s_waitcnt lgkmcnt(7)
  v_mfma_f32_16x16x32_bf16 v[16:19], a[16:19], v[84:87], v[16:19]
  ds_read_b128 v[76:79], v2 offset:16384
  v_mfma_f32_16x16x32_bf16 v[24:27], a[20:23], v[84:87], v[24:27]
  s_waitcnt lgkmcnt(7)
  v_mfma_f32_16x16x32_bf16 v[12:15], a[24:27], v[88:91], v[12:15]
  ds_read_b128 v[80:83], v2 offset:12288
  v_mfma_f32_16x16x32_bf16 v[20:23], a[28:31], v[88:91], v[20:23]
  s_waitcnt lgkmcnt(7)
  v_mfma_f32_16x16x32_bf16 v[16:19], a[24:27], v[92:95], v[16:19]
  ds_read_b128 v[84:87], v2 offset:17408
  v_mfma_f32_16x16x32_bf16 v[24:27], a[28:31], v[92:95], v[24:27]
  s_waitcnt lgkmcnt(7)
  v_mfma_f32_16x16x32_bf16 v[12:15], v[28:31], v[96:99], v[12:15]
  ds_read_b128 v[88:91], v2 offset:13312
  v_mfma_f32_16x16x32_bf16 v[20:23], v[32:35], v[96:99], v[20:23]
  s_waitcnt lgkmcnt(7)
  v_mfma_f32_16x16x32_bf16 v[16:19], v[28:31], v[100:103], v[16:19]
  ds_read_b128 v[92:95], v2 offset:18432
  v_mfma_f32_16x16x32_bf16 v[24:27], v[32:35], v[100:103], v[24:27]
  s_waitcnt lgkmcnt(7)
  v_mfma_f32_16x16x32_bf16 v[12:15], a[32:35], v[64:67], v[12:15]
  ds_read_b128 v[96:99], v2 offset:14336
  v_mfma_f32_16x16x32_bf16 v[20:23], a[36:39], v[64:67], v[20:23]
  s_waitcnt lgkmcnt(7)
  v_mfma_f32_16x16x32_bf16 v[16:19], a[32:35], v[68:71], v[16:19]
  ds_read_b128 v[100:103], v2 offset:19456
  v_mfma_f32_16x16x32_bf16 v[24:27], a[36:39], v[68:71], v[24:27]
  s_waitcnt lgkmcnt(7)
  v_mfma_f32_16x16x32_bf16 v[12:15], a[40:43], v[72:75], v[12:15]
  ds_read_b128 v[64:67], v2 offset:20480
  v_mfma_f32_16x16x32_bf16 v[20:23], a[44:47], v[72:75], v[20:23]
  s_waitcnt lgkmcnt(7)
  v_mfma_f32_16x16x32_bf16 v[16:19], a[40:43], v[76:79], v[16:19]
  ds_read_b128 v[68:71], v2 offset:25600
  v_mfma_f32_16x16x32_bf16 v[24:27], a[44:47], v[76:79], v[24:27]
  s_waitcnt lgkmcnt(7)
  v_mfma_f32_16x16x32_bf16 v[12:15], a[48:51], v[80:83], v[12:15]
  ds_read_b128 v[72:75], v2 offset:21504
  v_mfma_f32_16x16x32_bf16 v[20:23], a[52:55], v[80:83], v[20:23]
  s_waitcnt lgkmcnt(7)
  v_mfma_f32_16x16x32_bf16 v[16:19], a[48:51], v[84:87], v[16:19]
  ds_read_b128 v[76:79], v2 offset:26624
  v_mfma_f32_16x16x32_bf16 v[24:27], a[52:55], v[84:87], v[24:27]
  s_waitcnt lgkmcnt(7)
  v_mfma_f32_16x16x32_bf16 v[12:15], a[56:59], v[88:91], v[12:15]
  ds_read_b128 v[80:83], v2 offset:22528
  v_mfma_f32_16x16x32_bf16 v[20:23], a[60:63], v[88:91], v[20:23]
  s_waitcnt lgkmcnt(7)
  v_mfma_f32_16x16x32_bf16 v[16:19], a[56:59], v[92:95], v[16:19]
  ds_read_b128 v[84:87], v2 offset:27648
  v_mfma_f32_16x16x32_bf16 v[24:27], a[60:63], v[92:95], v[24:27]
  s_waitcnt lgkmcnt(7)
  v_mfma_f32_16x16x32_bf16 v[12:15], v[36:39], v[96:99], v[12:15]
  ds_read_b128 v[88:91], v2 offset:23552
  v_mfma_f32_16x16x32_bf16 v[20:23], v[40:43], v[96:99], v[20:23]
  s_waitcnt lgkmcnt(7)
  v_mfma_f32_16x16x32_bf16 v[16:19], v[36:39], v[100:103], v[16:19]
  ds_read_b128 v[92:95], v2 offset:28672
  v_mfma_f32_16x16x32_bf16 v[24:27], v[40:43], v[100:103], v[24:27]
  s_waitcnt lgkmcnt(7)
  v_mfma_f32_16x16x32_bf16 v[12:15], a[64:67], v[64:67], v[12:15]
  ds_read_b128 v[96:99], v2 offset:24576
  v_mfma_f32_16x16x32_bf16 v[20:23], a[68:71], v[64:67], v[20:23]
  s_waitcnt lgkmcnt(7)
  v_mfma_f32_16x16x32_bf16 v[16:19], a[64:67], v[68:71], v[16:19]
  ds_read_b128 v[100:103], v2 offset:29696
  v_mfma_f32_16x16x32_bf16 v[24:27], a[68:71], v[68:71], v[24:27]
  s_waitcnt lgkmcnt(7)
  v_mfma_f32_16x16x32_bf16 v[12:15], a[72:75], v[72:75], v[12:15]
  ds_read_b128 v[64:67], v2 offset:30720
  v_mfma_f32_16x16x32_bf16 v[20:23], a[76:79], v[72:75], v[20:23]
  s_waitcnt lgkmcnt(7)
  v_mfma_f32_16x16x32_bf16 v[16:19], a[72:75], v[76:79], v[16:19]
  ds_read_b128 v[68:71], v2 offset:35840
  v_mfma_f32_16x16x32_bf16 v[24:27], a[76:79], v[76:79], v[24:27]
  s_waitcnt lgkmcnt(7)
  v_mfma_f32_16x16x32_bf16 v[12:15], a[80:83], v[80:83], v[12:15]
  ds_read_b128 v[72:75], v2 offset:31744
  v_mfma_f32_16x16x32_bf16 v[20:23], a[84:87], v[80:83], v[20:23]
  s_waitcnt lgkmcnt(7)
  v_mfma_f32_16x16x32_bf16 v[16:19], a[80:83], v[84:87], v[16:19]
  ds_read_b128 v[76:79], v2 offset:36864
  v_mfma_f32_16x16x32_bf16 v[24:27], a[84:87], v[84:87], v[24:27]
  s_waitcnt lgkmcnt(7)
  v_mfma_f32_16x16x32_bf16 v[12:15], a[88:91], v[88:91], v[12:15]
  ds_read_b128 v[80:83], v2 offset:32768
  v_mfma_f32_16x16x32_bf16 v[20:23], a[92:95], v[88:91], v[20:23]
  s_waitcnt lgkmcnt(7)
  v_mfma_f32_16x16x32_bf16 v[16:19], a[88:91], v[92:95], v[16:19]
  ds_read_b128 v[84:87], v2 offset:37888
  v_mfma_f32_16x16x32_bf16 v[24:27], a[92:95], v[92:95], v[24:27]
  s_waitcnt lgkmcnt(7)
  v_mfma_f32_16x16x32_bf16 v[12:15], v[44:47], v[96:99], v[12:15]
  ds_read_b128 v[88:91], v2 offset:33792
  v_mfma_f32_16x16x32_bf16 v[20:23], v[48:51], v[96:99], v[20:23]
  s_waitcnt lgkmcnt(7)
  v_mfma_f32_16x16x32_bf16 v[16:19], v[44:47], v[100:103], v[16:19]
  ds_read_b128 v[92:95], v2 offset:38912
  v_mfma_f32_16x16x32_bf16 v[24:27], v[48:51], v[100:103], v[24:27]
  s_waitcnt lgkmcnt(7)
  v_mfma_f32_16x16x32_bf16 v[12:15], a[96:99], v[64:67], v[12:15]
  ds_read_b128 v[96:99], v2 offset:34816
  v_mfma_f32_16x16x32_bf16 v[20:23], a[100:103], v[64:67], v[20:23]
  s_waitcnt lgkmcnt(7)
  v_mfma_f32_16x16x32_bf16 v[16:19], a[96:99], v[68:71], v[16:19]
  ds_read_b128 v[100:103], v2 offset:39936
  v_mfma_f32_16x16x32_bf16 v[24:27], a[100:103], v[68:71], v[24:27]
  s_waitcnt lgkmcnt(7)
  v_mfma_f32_16x16x32_bf16 v[12:15], a[104:107], v[72:75], v[12:15]
  v_mfma_f32_16x16x32_bf16 v[20:23], a[108:111], v[72:75], v[20:23]
  s_waitcnt lgkmcnt(6)
  v_mfma_f32_16x16x32_bf16 v[16:19], a[104:107], v[76:79], v[16:19]
  v_mfma_f32_16x16x32_bf16 v[24:27], a[108:111], v[76:79], v[24:27]
  s_waitcnt lgkmcnt(5)
  v_mfma_f32_16x16x32_bf16 v[12:15], a[112:115], v[80:83], v[12:15]
  v_mfma_f32_16x16x32_bf16 v[20:23], a[116:119], v[80:83], v[20:23]
  s_waitcnt lgkmcnt(4)
  v_mfma_f32_16x16x32_bf16 v[16:19], a[112:115], v[84:87], v[16:19]
  v_mfma_f32_16x16x32_bf16 v[24:27], a[116:119], v[84:87], v[24:27]
  s_waitcnt lgkmcnt(3)
  v_mfma_f32_16x16x32_bf16 v[12:15], a[120:123], v[88:91], v[12:15]
  v_mfma_f32_16x16x32_bf16 v[20:23], a[124:127], v[88:91], v[20:23]
  s_waitcnt lgkmcnt(2)
  v_mfma_f32_16x16x32_bf16 v[16:19], a[120:123], v[92:95], v[16:19]
  v_mfma_f32_16x16x32_bf16 v[24:27], a[124:127], v[92:95], v[24:27]
  s_waitcnt lgkmcnt(1)
  v_mfma_f32_16x16x32_bf16 v[12:15], v[52:55], v[96:99], v[12:15]
  v_mfma_f32_16x16x32_bf16 v[20:23], v[56:59], v[96:99], v[20:23]
  s_waitcnt lgkmcnt(0)
  v_mfma_f32_16x16x32_bf16 v[16:19], v[52:55], v[100:103], v[16:19]
  v_mfma_f32_16x16x32_bf16 v[24:27], v[56:59], v[100:103], v[24:27]
  v_mul_u32_u24 v9, 1792, v4
  v_lshl_add_u32 v9, v3, 3, v9
  s_lshl_b32 s22, s20, 5
  v_add_u32 v8, s22, v9
  s_mul_i32 s22, s20, 24
  s_add_u32 s22, s22, 512
  v_add_u32 v9, s22, v9
  v_mov_b32 v10, 0x40000000
  v_cmp_eq_u32 vcc, 3, v3
  s_nop 1
  v_cndmask_b32 v9, v9, v10, vcc
  s_mul_i32 s26, s17, 57344
  s_add_u32 s26, s26, 896
  s_add_u32 s27, s26, 28672
  v_cvt_pk_bf16_f32 v108, v12, v13
  v_cvt_pk_bf16_f32 v109, v14, v15
  buffer_store_dwordx2 v[108:109], v8, s[92:95], s26 offen
  v_cvt_pk_bf16_f32 v110, v20, v21
  v_cvt_pk_bf16_f32 v111, v22, v23
  buffer_store_dwordx2 v[110:111], v9, s[92:95], s26 offen
  v_cvt_pk_bf16_f32 v112, v16, v17
  v_cvt_pk_bf16_f32 v113, v18, v19
  buffer_store_dwordx2 v[112:113], v8, s[92:95], s27 offen
  v_cvt_pk_bf16_f32 v114, v24, v25
  v_cvt_pk_bf16_f32 v115, v26, v27
  buffer_store_dwordx2 v[114:115], v9, s[92:95], s27 offen
  s_branch wk_loop
wp_abort:
wo_abort:
  s_branch cA_abort
wk_done:
ch_end:
  s_endpgm

.section .rodata,"a"
.p2align 6
.amdhsa_kernel main_kernel
  .amdhsa_next_free_vgpr 512
  .amdhsa_next_free_sgpr 102
  .amdhsa_accum_offset 256
  .amdhsa_group_segment_fixed_size 0
  .amdhsa_kernarg_size 136
  .amdhsa_user_sgpr_count 2
  .amdhsa_user_sgpr_kernarg_segment_ptr 1
  .amdhsa_system_sgpr_workgroup_id_x 1
.end_amdhsa_kernel
```

```asm
; @launch kernel=main_kernel grid=(256,1,1) block=(256,1,1) lds=163840
.amdgcn_target "amdgcn-amd-amdhsa--gfx950"
.text
.globl main_kernel
.p2align 8
.type main_kernel,@function
main_kernel:
  s_cmp_ge_u32 s2, 256
  s_cbranch_scc1 ch_end
  s_load_dwordx2 s[4:5], s[0:1], 120
  s_load_dwordx2 s[6:7], s[0:1], 128
  s_load_dwordx8 s[40:47], s[0:1], 72
  s_load_dwordx4 s[48:51], s[0:1], 56
  s_mov_b32 s32, 0
  s_getreg_b32 s3, hwreg(HW_REG_XCC_ID)
  s_and_b32 s3, s3, 15
  s_cmp_lg_u32 s3, 0
  s_cbranch_scc1 ch_pf
  s_cmp_lt_u32 s2, 224
  s_cbranch_scc1 ch_npf
ch_pf:
  s_getpc_b64 s[98:99]
pf_main_kernel_1:
  s_sub_u32 s98, s98, pf_main_kernel_1-main_kernel
  s_subb_u32 s99, s99, 0
  v_lshlrev_b32 v60, 7, v0
  v_min_u32 v61, ch_end-main_kernel-4, v60
  global_load_dword v62, v61, s[98:99]
  v_add_u32 v60, 32768, v60
  v_min_u32 v61, ch_end-main_kernel-4, v60
  global_load_dword v62, v61, s[98:99]
  v_add_u32 v60, 32768, v60
  v_min_u32 v61, ch_end-main_kernel-4, v60
  global_load_dword v62, v61, s[98:99]
  v_add_u32 v60, 32768, v60
  v_min_u32 v61, ch_end-main_kernel-4, v60
  global_load_dword v62, v61, s[98:99]
  v_add_u32 v60, 32768, v60
  v_min_u32 v61, ch_end-main_kernel-4, v60
  global_load_dword v62, v61, s[98:99]
  v_add_u32 v60, 32768, v60
ch_npf:
  v_lshrrev_b32 v1, 6, v0
  s_nop 0
  v_readfirstlane_b32 s16, v1
  s_waitcnt lgkmcnt(0)
  s_mov_b32 s8, s6
  s_and_b32 s9, s7, 0xffff
  s_mov_b32 s10, 0x10000000
  s_mov_b32 s11, 0x20000
  s_mov_b32 s12, s4
  s_and_b32 s13, s5, 0xffff
  s_mov_b32 s14, 256
  s_mov_b32 s15, 0x20000
  v_mov_b32 v252, 0x40000000
  v_cmp_eq_u32 vcc, 0, v0
  s_nop 1
  v_cndmask_b32 v252, v252, v0, vcc
  s_cmp_lg_u32 s3, 0
  s_cbranch_scc1 ch_worker
  s_mov_b32 s18, 0
  v_mov_b32 v249, 1
  s_mov_b64 exec, 1
  buffer_atomic_add v249, v252, s[12:15], 0 offen sc0
  s_mov_b64 exec, -1
  v_and_b32 v1, 63, v0
  v_lshlrev_b32 v2, 4, v1
  v_lshrrev_b32 v3, 4, v1
  v_and_b32 v4, 15, v1
  s_lshr_b32 s33, s2, 3
  s_lshl_b32 s27, s33, 2
  s_add_u32 s27, s27, s16
  s_lshl_b32 s27, s27, 13
  v_lshlrev_b32 v12, 7, v1
  s_mov_b32 s64, s42
  s_and_b32 s65, s43, 0xffff
  s_mov_b32 s66, 2097152
  s_mov_b32 s67, 0x20000
  s_mov_b32 s28, s27
  buffer_load_dword v13, v12, s[64:67], s28 offen
  s_add_u32 s28, s28, 1048576
  buffer_load_dword v13, v12, s[64:67], s28 offen
  s_add_u32 s28, s28, 1048576
  s_waitcnt vmcnt(2)
  v_readfirstlane_b32 s17, v249
  v_mov_b32 v6, 160032
  s_nop 0
  v_mov_b32 v7, s17
  s_barrier
  s_cmp_lg_u32 s16, 0
  s_cbranch_scc1 uni_2
  ds_write_b32 v6, v7
  s_waitcnt lgkmcnt(0)
uni_2:
  s_barrier
  ds_read_b32 v7, v6
  s_waitcnt lgkmcnt(0)
  v_readfirstlane_b32 s17, v7
  s_branch ch_got
ch_take:
  v_mov_b32 v5, 0
  v_mov_b32 v6, 160000
  s_barrier
  s_cmp_lg_u32 s16, 0
  s_cbranch_scc1 ch_el1
  s_mov_b64 exec, 1
  buffer_atomic_add v4, v5, s[12:15], 0 offen sc0
  s_waitcnt vmcnt(0)
  ds_write_b32 v6, v4
  s_waitcnt lgkmcnt(0)
  s_mov_b64 exec, -1
ch_el1:
  s_barrier
  ds_read_b32 v4, v6
  s_waitcnt lgkmcnt(0)
  v_readfirstlane_b32 s17, v4
ch_got:
  s_and_b32 s17, s17, 0xffff
  s_cmp_lt_u32 s17, 32
  s_cbranch_scc1 ch_role
  s_cmp_eq_u32 s18, 0
  s_cbranch_scc1 ch_worker
  v_and_b32 v1, 63, v0
  v_lshlrev_b32 v2, 4, v1
  v_lshrrev_b32 v3, 4, v1
  v_and_b32 v4, 15, v1
  s_branch wp_all
ch_role:
  v_and_b32 v1, 63, v0
  v_lshlrev_b32 v2, 4, v1
  v_lshrrev_b32 v3, 4, v1
  v_and_b32 v4, 15, v1
  s_cmp_lt_u32 s17, 16
  s_cbranch_scc1 ch_self
  s_cmp_lt_u32 s17, 28
  s_cbranch_scc1 ch_tch
  s_sub_u32 s33, s17, 28
  v_mov_b32 v10, 0x40000000
  v_mov_b32 v5, 1
  v_mov_b32 v148, 0
  v_mov_b32 v149, 0
  v_mov_b32 v150, 0
  v_mov_b32 v151, 0
  v_mov_b32 v152, -1
  v_mov_b32 v153, -1
  v_mov_b32 v154, -1
  v_mov_b32 v155, -1
  v_lshlrev_b32 v8, 4, v0
  s_cmp_lg_u32 s33, 0
  s_cbranch_scc1 ch_ij_1
  s_mov_b32 s23, 88519168
  buffer_store_dwordx4 v[148:151], v8, s[8:11], s23 offen sc1
  s_mov_b32 s23, 88523264
  buffer_store_dwordx4 v[148:151], v8, s[8:11], s23 offen sc1
  s_waitcnt vmcnt(0)
  s_barrier
  buffer_store_dword v5, v252, s[12:15], 0 offen offset:128 sc1
ch_ij_1:
  s_mov_b32 s68, s50
  s_and_b32 s69, s51, 0xffff
  s_mov_b32 s70, 7168
  s_mov_b32 s71, 0x20000
  v_lshrrev_b32 v6, 3, v0
  v_min_u32 v6, 27, v6
  v_and_b32 v7, 7, v0
  v_mul_u32_u24 v9, 896, v7
  v_lshl_add_u32 v9, v6, 5, v9
  buffer_load_dwordx4 v[176:179], v9, s[68:71], 0 offen
  buffer_load_dwordx4 v[180:183], v9, s[68:71], 0 offen offset:16
  s_lshl_b32 s20, s33, 12
  v_add_u32 v8, s20, v8
  s_mov_b32 s23, 88461312
ch_ijlp_3:
  buffer_store_dwordx4 v[148:151], v8, s[8:11], s23 offen sc1
  s_add_u32 s23, s23, 16384
  s_cmp_lt_u32 s23, 88510464
  s_cbranch_scc1 ch_ijlp_3
  v_cmp_gt_u32 vcc, 8704, v8
  s_nop 1
  v_cndmask_b32 v9, v10, v8, vcc
  buffer_store_dwordx4 v[148:151], v9, s[8:11], s23 offen sc1
  s_mov_b32 s23, 75729408
  v_cmp_gt_u32 vcc, 6144, v8
  s_nop 1
  v_cndmask_b32 v9, v10, v8, vcc
  buffer_store_dwordx4 v[148:151], v9, s[8:11], s23 offen sc1
  s_mov_b32 s23, 75701248
ch_ijlp_4:
  buffer_store_dwordx4 v[152:155], v8, s[8:11], s23 offen sc1
  s_add_u32 s23, s23, 16384
  s_cmp_lt_u32 s23, 75717632
  s_cbranch_scc1 ch_ijlp_4
  v_cmp_gt_u32 vcc, 11776, v8
  s_nop 1
  v_cndmask_b32 v9, v10, v8, vcc
  buffer_store_dwordx4 v[152:155], v9, s[8:11], s23 offen sc1
  s_mov_b32 s23, 88009728
ch_ijlp_5:
  buffer_store_dwordx4 v[152:155], v8, s[8:11], s23 offen sc1
  s_add_u32 s23, s23, 16384
  s_cmp_lt_u32 s23, 88452096
  s_cbranch_scc1 ch_ijlp_5
  v_cmp_gt_u32 vcc, 9216, v8
  s_nop 1
  v_cndmask_b32 v9, v10, v8, vcc
  buffer_store_dwordx4 v[152:155], v9, s[8:11], s23 offen sc1
  s_cmp_lg_u32 s33, 1
  s_cbranch_scc1 ch_ij_nm
  v_lshrrev_b32 v6, 3, v0
  v_and_b32 v7, 7, v0
  v_lshlrev_b32 v8, 8, v6
  v_lshl_add_u32 v8, v7, 4, v8
  v_cmp_gt_u32 vcc, 28, v6
  s_nop 1
  v_cndmask_b32 v8, v10, v8, vcc
  s_waitcnt vmcnt(4)
  v_mov_b32 v184, v176
  v_mov_b32 v188, v177
  v_mov_b32 v185, v178
  v_mov_b32 v189, v179
  v_mov_b32 v186, v180
  v_mov_b32 v190, v181
  v_mov_b32 v187, v182
  v_mov_b32 v191, v183
  s_mov_b32 s23, 75694080
  buffer_store_dwordx4 v[184:187], v8, s[8:11], s23 offen sc1
  buffer_store_dwordx4 v[188:191], v8, s[8:11], s23 offen offset:128 sc1
  s_mov_b32 s23, 88002560
  buffer_store_dwordx4 v[184:187], v8, s[8:11], s23 offen sc1
  buffer_store_dwordx4 v[188:191], v8, s[8:11], s23 offen offset:128 sc1
ch_ij_nm:
  s_waitcnt vmcnt(0)
  s_barrier
  s_cmp_lg_u32 s16, 0
  s_cbranch_scc1 ch_ij_e
  v_mov_b32 v6, 1
  s_mov_b64 exec, 1
  buffer_atomic_add v6, v252, s[12:15], 0 offen offset:12 sc0
  s_waitcnt vmcnt(0)
  v_readfirstlane_b32 s20, v6
  s_cmp_lg_u32 s20, 3
  s_cbranch_scc1 ch_ij_e0
  buffer_store_dword v5, v252, s[12:15], 0 offen offset:132 sc1
  s_mov_b64 exec, 0xff
  v_lshlrev_b32 v6, 7, v0
  s_mov_b32 s20, 88523264
  buffer_store_dword v5, v6, s[8:11], s20 offen offset:4 sc1
ch_ij_e0:
  s_mov_b64 exec, -1
ch_ij_e:
  s_branch ch_role2
ch_tch:
  s_sub_u32 s33, s17, 16
  s_lshl_b32 s27, s33, 2
  s_add_u32 s27, s27, s16
  s_lshl_b32 s27, s27, 13
  v_lshlrev_b32 v12, 7, v1
  s_mov_b32 s64, s40
  s_and_b32 s65, s41, 0xffff
  s_mov_b32 s66, 3670016
  s_mov_b32 s67, 0x20000
  s_mov_b32 s28, s27
  buffer_load_dword v13, v12, s[64:67], s28 offen
  s_add_u32 s28, s28, 393216
  buffer_load_dword v13, v12, s[64:67], s28 offen
  s_add_u32 s28, s28, 393216
  buffer_load_dword v13, v12, s[64:67], s28 offen
  s_add_u32 s28, s28, 393216
  buffer_load_dword v13, v12, s[64:67], s28 offen
  s_add_u32 s28, s28, 393216
  buffer_load_dword v13, v12, s[64:67], s28 offen
  s_add_u32 s28, s28, 393216
  buffer_load_dword v13, v12, s[64:67], s28 offen
  s_add_u32 s28, s28, 393216
  buffer_load_dword v13, v12, s[64:67], s28 offen
  s_add_u32 s28, s28, 393216
  buffer_load_dword v13, v12, s[64:67], s28 offen
  s_add_u32 s28, s28, 393216
  buffer_load_dword v13, v12, s[64:67], s28 offen
  s_add_u32 s28, s28, 393216
  buffer_load_dword v13, v12, s[64:67], s28 offen
  s_add_u32 s28, s28, 393216
  s_branch ch_role2
ch_self:
  v_lshrrev_b32 v5, 5, v1
  v_and_b32 v6, 31, v1
  v_xor_b32 v8, v6, v5
  v_lshlrev_b32 v8, 4, v8
  v_lshl_add_u32 v16, v5, 13, v8
  v_xor_b32 v17, 32, v16
  v_xor_b32 v18, 64, v16
  v_xor_b32 v19, 96, v16
  v_xor_b32 v20, 128, v16
  v_xor_b32 v21, 160, v16
  v_xor_b32 v22, 192, v16
  v_xor_b32 v23, 224, v16
  s_lshl_b32 s20, s16, 6
  v_xor_b32 v26, s20, v16
  v_xor_b32 v27, 32, v26
  s_mov_b32 s60, s40
  s_and_b32 s61, s41, 0xffff
  s_mov_b32 s62, 3670016
  s_mov_b32 s63, 0x20000
  s_mov_b32 s56, s42
  s_and_b32 s57, s43, 0xffff
  s_mov_b32 s58, 3670016
  s_mov_b32 s59, 0x20000
  s_lshl_b32 s26, s17, 9
  s_lshl_b32 s27, s16, 19
  s_add_u32 s27, s27, s26
  s_lshl_b32 s25, s16, 15
  s_add_u32 s25, s25, 32768
  s_barrier
  s_add_u32 m0, s25, 0
  s_nop 0
  buffer_load_dwordx4 v16, s[56:59], s27 offen lds
  s_add_u32 s27, s27, 16384
  s_add_u32 m0, s25, 1024
  s_nop 0
  buffer_load_dwordx4 v16, s[56:59], s27 offen lds
  s_add_u32 s27, s27, 16384
  s_add_u32 m0, s25, 2048
  s_nop 0
  buffer_load_dwordx4 v17, s[56:59], s27 offen lds
  s_add_u32 s27, s27, 16384
  s_add_u32 m0, s25, 3072
  s_nop 0
  buffer_load_dwordx4 v17, s[56:59], s27 offen lds
  s_add_u32 s27, s27, 16384
  s_add_u32 m0, s25, 4096
  s_nop 0
  buffer_load_dwordx4 v16, s[56:59], s27 offen lds
  s_add_u32 s27, s27, 16384
  s_add_u32 m0, s25, 5120
  s_nop 0
  buffer_load_dwordx4 v16, s[56:59], s27 offen lds
  s_add_u32 s27, s27, 16384
  s_add_u32 m0, s25, 6144
  s_nop 0
  buffer_load_dwordx4 v17, s[56:59], s27 offen lds
  s_add_u32 s27, s27, 16384
  s_add_u32 m0, s25, 7168
  s_nop 0
  buffer_load_dwordx4 v17, s[56:59], s27 offen lds
  s_add_u32 s27, s27, 16384
  s_add_u32 m0, s25, 8192
  s_nop 0
  buffer_load_dwordx4 v18, s[56:59], s27 offen lds
  s_add_u32 s27, s27, 16384
  s_add_u32 m0, s25, 9216
  s_nop 0
  buffer_load_dwordx4 v18, s[56:59], s27 offen lds
  s_add_u32 s27, s27, 16384
  s_add_u32 m0, s25, 10240
  s_nop 0
  buffer_load_dwordx4 v19, s[56:59], s27 offen lds
  s_add_u32 s27, s27, 16384
  s_add_u32 m0, s25, 11264
  s_nop 0
  buffer_load_dwordx4 v19, s[56:59], s27 offen lds
  s_add_u32 s27, s27, 16384
  s_add_u32 m0, s25, 12288
  s_nop 0
  buffer_load_dwordx4 v18, s[56:59], s27 offen lds
  s_add_u32 s27, s27, 16384
  s_add_u32 m0, s25, 13312
  s_nop 0
  buffer_load_dwordx4 v18, s[56:59], s27 offen lds
  s_add_u32 s27, s27, 16384
  s_add_u32 m0, s25, 14336
  s_nop 0
  buffer_load_dwordx4 v19, s[56:59], s27 offen lds
  s_add_u32 s27, s27, 16384
  s_add_u32 m0, s25, 15360
  s_nop 0
  buffer_load_dwordx4 v19, s[56:59], s27 offen lds
  s_add_u32 s27, s27, 16384
  s_add_u32 m0, s25, 16384
  s_nop 0
  buffer_load_dwordx4 v20, s[56:59], s27 offen lds
  s_add_u32 s27, s27, 16384
  s_add_u32 m0, s25, 17408
  s_nop 0
  buffer_load_dwordx4 v20, s[56:59], s27 offen lds
  s_add_u32 s27, s27, 16384
  s_add_u32 m0, s25, 18432
  s_nop 0
  buffer_load_dwordx4 v21, s[56:59], s27 offen lds
  s_add_u32 s27, s27, 16384
  s_add_u32 m0, s25, 19456
  s_nop 0
  buffer_load_dwordx4 v21, s[56:59], s27 offen lds
  s_add_u32 s27, s27, 16384
  s_add_u32 m0, s25, 20480
  s_nop 0
  buffer_load_dwordx4 v20, s[56:59], s27 offen lds
  s_add_u32 s27, s27, 16384
  s_add_u32 m0, s25, 21504
  s_nop 0
  buffer_load_dwordx4 v20, s[56:59], s27 offen lds
  s_add_u32 s27, s27, 16384
  s_add_u32 m0, s25, 22528
  s_nop 0
  buffer_load_dwordx4 v21, s[56:59], s27 offen lds
  s_add_u32 s27, s27, 16384
  s_add_u32 m0, s25, 23552
  s_nop 0
  buffer_load_dwordx4 v21, s[56:59], s27 offen lds
  s_add_u32 s27, s27, 16384
  s_add_u32 m0, s25, 24576
  s_nop 0
  buffer_load_dwordx4 v22, s[56:59], s27 offen lds
  s_add_u32 s27, s27, 16384
  s_add_u32 m0, s25, 25600
  s_nop 0
  buffer_load_dwordx4 v22, s[56:59], s27 offen lds
  s_add_u32 s27, s27, 16384
  s_add_u32 m0, s25, 26624
  s_nop 0
  buffer_load_dwordx4 v23, s[56:59], s27 offen lds
  s_add_u32 s27, s27, 16384
  s_add_u32 m0, s25, 27648
  s_nop 0
  buffer_load_dwordx4 v23, s[56:59], s27 offen lds
  s_add_u32 s27, s27, 16384
  s_add_u32 m0, s25, 28672
  s_nop 0
  buffer_load_dwordx4 v22, s[56:59], s27 offen lds
  s_add_u32 s27, s27, 16384
  s_add_u32 m0, s25, 29696
  s_nop 0
  buffer_load_dwordx4 v22, s[56:59], s27 offen lds
  s_add_u32 s27, s27, 16384
  s_add_u32 m0, s25, 30720
  s_nop 0
  buffer_load_dwordx4 v23, s[56:59], s27 offen lds
  s_add_u32 s27, s27, 16384
  s_add_u32 m0, s25, 31744
  s_nop 0
  buffer_load_dwordx4 v23, s[56:59], s27 offen lds
  s_add_u32 s27, s27, 16384
  v_mov_b32 v14, v26
  v_mov_b32 v15, v27
  s_lshl_b32 s28, s16, 16
  s_add_u32 s28, s28, s26
  s_lshl_b32 s29, s16, 12
  s_add_u32 m0, s29, 0
  s_add_u32 s27, s28, 0
  buffer_load_dwordx4 v14, s[60:63], s27 offen lds
  s_add_u32 m0, s29, 1024
  s_add_u32 s27, s28, 16384
  buffer_load_dwordx4 v15, s[60:63], s27 offen lds
  s_add_u32 m0, s29, 2048
  s_add_u32 s27, s28, 32768
  buffer_load_dwordx4 v14, s[60:63], s27 offen lds
  s_add_u32 m0, s29, 3072
  s_add_u32 s27, s28, 49152
  buffer_load_dwordx4 v15, s[60:63], s27 offen lds
  s_add_u32 m0, s29, 16384
  s_add_u32 s27, s28, 262144
  buffer_load_dwordx4 v14, s[60:63], s27 offen lds
  s_add_u32 m0, s29, 17408
  s_add_u32 s27, s28, 278528
  buffer_load_dwordx4 v15, s[60:63], s27 offen lds
  s_add_u32 m0, s29, 18432
  s_add_u32 s27, s28, 294912
  buffer_load_dwordx4 v14, s[60:63], s27 offen lds
  s_add_u32 m0, s29, 19456
  s_add_u32 s27, s28, 311296
  buffer_load_dwordx4 v15, s[60:63], s27 offen lds
  v_lshrrev_b32 v7, 2, v4
  v_lshlrev_b32 v11, 4, v7
  v_lshlrev_b32 v7, 3, v7
  v_and_b32 v8, 3, v4
  v_add_u32 v7, v7, v8
  v_and_b32 v8, 2, v4
  v_lshl_add_u32 v11, v8, 1, v11
  v_and_b32 v8, 1, v4
  v_add_u32 v11, v11, v8
  v_or_b32 v10, 0, v3
  v_xor_b32 v10, v10, v4
  v_lshlrev_b32 v10, 4, v10
  v_lshl_add_u32 v248, v7, 9, v10
  v_add_u32 v252, 65536, v248
  v_add_u32 v16, 131072, v248
  v_lshl_add_u32 v10, v11, 9, v10
  v_add_u32 v20, s25, v10
  v_or_b32 v10, 4, v3
  v_xor_b32 v10, v10, v4
  v_lshlrev_b32 v10, 4, v10
  v_lshl_add_u32 v249, v7, 9, v10
  v_add_u32 v253, 65536, v249
  v_add_u32 v17, 131072, v249
  v_lshl_add_u32 v10, v11, 9, v10
  v_add_u32 v21, s25, v10
  v_or_b32 v10, 8, v3
  v_xor_b32 v10, v10, v4
  v_lshlrev_b32 v10, 4, v10
  v_lshl_add_u32 v250, v7, 9, v10
  v_add_u32 v254, 65536, v250
  v_add_u32 v18, 131072, v250
  v_lshl_add_u32 v10, v11, 9, v10
  v_add_u32 v22, s25, v10
  v_or_b32 v10, 12, v3
  v_xor_b32 v10, v10, v4
  v_lshlrev_b32 v10, 4, v10
  v_lshl_add_u32 v251, v7, 9, v10
  v_add_u32 v255, 65536, v251
  v_add_u32 v19, 131072, v251
  v_lshl_add_u32 v10, v11, 9, v10
  v_add_u32 v23, s25, v10
  v_mov_b32 v12, 1035512379
  v_lshlrev_b32 v6, 7, v1
  s_getpc_b64 s[98:99]
  global_load_dword v7, v6, s[98:99]
  s_waitcnt vmcnt(9)
  ds_read_b128 v[120:123], v20 offset:0
  ds_read_b128 v[124:127], v21 offset:0
  ds_read_b128 v[128:131], v22 offset:0
  ds_read_b128 v[132:135], v23 offset:0
  ds_read_b128 v[136:139], v20 offset:256
  ds_read_b128 v[140:143], v21 offset:256
  ds_read_b128 v[144:147], v22 offset:256
  ds_read_b128 v[148:151], v23 offset:256
  s_waitcnt lgkmcnt(8)
  ds_read_b128 v[152:155], v20 offset:1024
  ds_read_b128 v[156:159], v21 offset:1024
  ds_read_b128 v[160:163], v22 offset:1024
  ds_read_b128 v[164:167], v23 offset:1024
  ds_read_b128 v[168:171], v20 offset:1280
  ds_read_b128 v[172:175], v21 offset:1280
  ds_read_b128 v[176:179], v22 offset:1280
  ds_read_b128 v[180:183], v23 offset:1280
  s_waitcnt lgkmcnt(8)
  ds_read_b128 v[184:187], v20 offset:4096
  ds_read_b128 v[188:191], v21 offset:4096
  ds_read_b128 v[192:195], v22 offset:4096
  ds_read_b128 v[196:199], v23 offset:4096
  ds_read_b128 v[200:203], v20 offset:4352
  ds_read_b128 v[204:207], v21 offset:4352
  ds_read_b128 v[208:211], v22 offset:4352
  ds_read_b128 v[212:215], v23 offset:4352
  s_waitcnt lgkmcnt(8)
  ds_read_b128 v[216:219], v20 offset:5120
  ds_read_b128 v[220:223], v21 offset:5120
  ds_read_b128 v[224:227], v22 offset:5120
  ds_read_b128 v[228:231], v23 offset:5120
  ds_read_b128 v[232:235], v20 offset:5376
  ds_read_b128 v[236:239], v21 offset:5376
  ds_read_b128 v[240:243], v22 offset:5376
  ds_read_b128 v[244:247], v23 offset:5376
  s_waitcnt lgkmcnt(8)
  s_waitcnt vmcnt(4) lgkmcnt(0)
  s_barrier
  s_add_u32 m0, s29, 32768
  s_add_u32 s27, s28, 524288
  buffer_load_dwordx4 v14, s[60:63], s27 offen lds
  s_add_u32 m0, s29, 33792
  s_add_u32 s27, s28, 540672
  buffer_load_dwordx4 v15, s[60:63], s27 offen lds
  s_add_u32 m0, s29, 34816
  s_add_u32 s27, s28, 557056
  buffer_load_dwordx4 v14, s[60:63], s27 offen lds
  s_add_u32 m0, s29, 35840
  s_add_u32 s27, s28, 573440
  buffer_load_dwordx4 v15, s[60:63], s27 offen lds
  ds_read_b128 v[24:27], v248 offset:0
  ds_read_b128 v[28:31], v248 offset:2048
  ds_read_b128 v[32:35], v249 offset:0
  ds_read_b128 v[36:39], v249 offset:2048
  ds_read_b128 v[40:43], v250 offset:0
  ds_read_b128 v[44:47], v250 offset:2048
  s_waitcnt lgkmcnt(5)
  s_getpc_b64 s[98:99]
  s_add_u32 s98, s98, 4096
  s_addc_u32 s99, s99, 0
  global_load_dword v7, v6, s[98:99]
  v_mfma_f32_16x16x32_bf16 v[56:59], v[24:27], v[120:123], 0
  ds_read_b128 v[48:51], v251 offset:0
  v_mfma_f32_16x16x32_bf16 v[64:67], v[24:27], v[152:155], 0
  v_mfma_f32_16x16x32_bf16 v[72:75], v[24:27], v[184:187], 0
  s_add_u32 m0, s29, 49152
  s_add_u32 s27, s28, 786432
  buffer_load_dwordx4 v14, s[60:63], s27 offen lds
  v_mfma_f32_16x16x32_bf16 v[80:83], v[24:27], v[216:219], 0
  s_waitcnt lgkmcnt(5)
  v_mfma_f32_16x16x32_bf16 v[60:63], v[28:31], v[120:123], 0
  ds_read_b128 v[52:55], v251 offset:2048
  v_mfma_f32_16x16x32_bf16 v[68:71], v[28:31], v[152:155], 0
  v_mfma_f32_16x16x32_bf16 v[76:79], v[28:31], v[184:187], 0
  v_mfma_f32_16x16x32_bf16 v[84:87], v[28:31], v[216:219], 0
  s_waitcnt lgkmcnt(5)
  v_mfma_f32_16x16x32_bf16 v[56:59], v[32:35], v[124:127], v[56:59]
  ds_read_b128 v[24:27], v248 offset:256
  v_mfma_f32_16x16x32_bf16 v[64:67], v[32:35], v[156:159], v[64:67]
  v_mfma_f32_16x16x32_bf16 v[72:75], v[32:35], v[188:191], v[72:75]
  s_add_u32 m0, s29, 50176
  s_add_u32 s27, s28, 802816
  buffer_load_dwordx4 v15, s[60:63], s27 offen lds
  v_mfma_f32_16x16x32_bf16 v[80:83], v[32:35], v[220:223], v[80:83]
  s_waitcnt lgkmcnt(5)
  v_mfma_f32_16x16x32_bf16 v[60:63], v[36:39], v[124:127], v[60:63]
  ds_read_b128 v[28:31], v248 offset:2304
  v_mfma_f32_16x16x32_bf16 v[68:71], v[36:39], v[156:159], v[68:71]
  v_mfma_f32_16x16x32_bf16 v[76:79], v[36:39], v[188:191], v[76:79]
  v_mfma_f32_16x16x32_bf16 v[84:87], v[36:39], v[220:223], v[84:87]
  s_waitcnt lgkmcnt(5)
  v_mfma_f32_16x16x32_bf16 v[56:59], v[40:43], v[128:131], v[56:59]
  ds_read_b128 v[32:35], v249 offset:256
  v_mfma_f32_16x16x32_bf16 v[64:67], v[40:43], v[160:163], v[64:67]
  v_mfma_f32_16x16x32_bf16 v[72:75], v[40:43], v[192:195], v[72:75]
  s_add_u32 m0, s29, 51200
  s_add_u32 s27, s28, 819200
  buffer_load_dwordx4 v14, s[60:63], s27 offen lds
  v_mfma_f32_16x16x32_bf16 v[80:83], v[40:43], v[224:227], v[80:83]
  s_waitcnt lgkmcnt(5)
  v_mfma_f32_16x16x32_bf16 v[60:63], v[44:47], v[128:131], v[60:63]
  ds_read_b128 v[36:39], v249 offset:2304
  v_mfma_f32_16x16x32_bf16 v[68:71], v[44:47], v[160:163], v[68:71]
  v_mfma_f32_16x16x32_bf16 v[76:79], v[44:47], v[192:195], v[76:79]
  v_mfma_f32_16x16x32_bf16 v[84:87], v[44:47], v[224:227], v[84:87]
  s_waitcnt lgkmcnt(5)
  v_mfma_f32_16x16x32_bf16 v[56:59], v[48:51], v[132:135], v[56:59]
  ds_read_b128 v[40:43], v250 offset:256
  v_mfma_f32_16x16x32_bf16 v[64:67], v[48:51], v[164:167], v[64:67]
  v_mfma_f32_16x16x32_bf16 v[72:75], v[48:51], v[196:199], v[72:75]
  s_add_u32 m0, s29, 52224
  s_add_u32 s27, s28, 835584
  buffer_load_dwordx4 v15, s[60:63], s27 offen lds
  v_mfma_f32_16x16x32_bf16 v[80:83], v[48:51], v[228:231], v[80:83]
  s_waitcnt lgkmcnt(5)
  v_mfma_f32_16x16x32_bf16 v[60:63], v[52:55], v[132:135], v[60:63]
  ds_read_b128 v[44:47], v250 offset:2304
  v_mfma_f32_16x16x32_bf16 v[68:71], v[52:55], v[164:167], v[68:71]
  v_mfma_f32_16x16x32_bf16 v[76:79], v[52:55], v[196:199], v[76:79]
  v_mfma_f32_16x16x32_bf16 v[84:87], v[52:55], v[228:231], v[84:87]
  s_waitcnt lgkmcnt(5)
  v_mfma_f32_16x16x32_bf16 v[56:59], v[24:27], v[136:139], v[56:59]
  ds_read_b128 v[48:51], v251 offset:256
  v_mfma_f32_16x16x32_bf16 v[64:67], v[24:27], v[168:171], v[64:67]
  v_mfma_f32_16x16x32_bf16 v[72:75], v[24:27], v[200:203], v[72:75]
  v_mfma_f32_16x16x32_bf16 v[80:83], v[24:27], v[232:235], v[80:83]
  s_waitcnt lgkmcnt(5)
  v_mfma_f32_16x16x32_bf16 v[60:63], v[28:31], v[136:139], v[60:63]
  ds_read_b128 v[52:55], v251 offset:2304
  v_mfma_f32_16x16x32_bf16 v[68:71], v[28:31], v[168:171], v[68:71]
  v_mfma_f32_16x16x32_bf16 v[76:79], v[28:31], v[200:203], v[76:79]
  v_mfma_f32_16x16x32_bf16 v[84:87], v[28:31], v[232:235], v[84:87]
  s_waitcnt lgkmcnt(5)
  v_mfma_f32_16x16x32_bf16 v[56:59], v[32:35], v[140:143], v[56:59]
  s_waitcnt vmcnt(8)
  s_barrier
  ds_read_b128 v[24:27], v248 offset:16384
  v_mfma_f32_16x16x32_bf16 v[64:67], v[32:35], v[172:175], v[64:67]
  v_mfma_f32_16x16x32_bf16 v[72:75], v[32:35], v[204:207], v[72:75]
  v_mfma_f32_16x16x32_bf16 v[80:83], v[32:35], v[236:239], v[80:83]
  s_waitcnt lgkmcnt(5)
  v_mfma_f32_16x16x32_bf16 v[60:63], v[36:39], v[140:143], v[60:63]
  ds_read_b128 v[28:31], v248 offset:18432
  v_mfma_f32_16x16x32_bf16 v[68:71], v[36:39], v[172:175], v[68:71]
  v_mfma_f32_16x16x32_bf16 v[76:79], v[36:39], v[204:207], v[76:79]
  v_mfma_f32_16x16x32_bf16 v[84:87], v[36:39], v[236:239], v[84:87]
  s_waitcnt lgkmcnt(5)
  v_mfma_f32_16x16x32_bf16 v[56:59], v[40:43], v[144:147], v[56:59]
  ds_read_b128 v[32:35], v249 offset:16384
  v_mfma_f32_16x16x32_bf16 v[64:67], v[40:43], v[176:179], v[64:67]
  v_mfma_f32_16x16x32_bf16 v[72:75], v[40:43], v[208:211], v[72:75]
  v_mfma_f32_16x16x32_bf16 v[80:83], v[40:43], v[240:243], v[80:83]
  s_waitcnt lgkmcnt(5)
  v_mfma_f32_16x16x32_bf16 v[60:63], v[44:47], v[144:147], v[60:63]
  ds_read_b128 v[36:39], v249 offset:18432
  v_mfma_f32_16x16x32_bf16 v[68:71], v[44:47], v[176:179], v[68:71]
  v_mfma_f32_16x16x32_bf16 v[76:79], v[44:47], v[208:211], v[76:79]
  v_mfma_f32_16x16x32_bf16 v[84:87], v[44:47], v[240:243], v[84:87]
  s_waitcnt lgkmcnt(5)
  v_mfma_f32_16x16x32_bf16 v[56:59], v[48:51], v[148:151], v[56:59]
  ds_read_b128 v[40:43], v250 offset:16384
  v_mfma_f32_16x16x32_bf16 v[64:67], v[48:51], v[180:183], v[64:67]
  v_mfma_f32_16x16x32_bf16 v[72:75], v[48:51], v[212:215], v[72:75]
  v_mfma_f32_16x16x32_bf16 v[80:83], v[48:51], v[244:247], v[80:83]
  s_waitcnt lgkmcnt(5)
  v_mfma_f32_16x16x32_bf16 v[60:63], v[52:55], v[148:151], v[60:63]
  ds_read_b128 v[44:47], v250 offset:18432
  v_mfma_f32_16x16x32_bf16 v[68:71], v[52:55], v[180:183], v[68:71]
  v_mfma_f32_16x16x32_bf16 v[76:79], v[52:55], v[212:215], v[76:79]
  v_mfma_f32_16x16x32_bf16 v[84:87], v[52:55], v[244:247], v[84:87]
  s_waitcnt lgkmcnt(5)
  v_mfma_f32_16x16x32_bf16 v[88:91], v[24:27], v[120:123], 0
  ds_read_b128 v[48:51], v251 offset:16384
  v_mfma_f32_16x16x32_bf16 v[96:99], v[24:27], v[152:155], 0
  v_mfma_f32_16x16x32_bf16 v[104:107], v[24:27], v[184:187], 0
  s_add_u32 m0, s29, 65536
  s_add_u32 s27, s28, 1048576
  buffer_load_dwordx4 v14, s[60:63], s27 offen lds
  v_mfma_f32_16x16x32_bf16 v[112:115], v[24:27], v[216:219], 0
  s_waitcnt lgkmcnt(5)
  v_mul_f32 v56, v12, v56
  v_mfma_f32_16x16x32_bf16 v[92:95], v[28:31], v[120:123], 0
  ds_read_b128 v[52:55], v251 offset:18432
  v_mul_f32 v57, v12, v57
  v_mfma_f32_16x16x32_bf16 v[100:103], v[28:31], v[152:155], 0
  v_mul_f32 v58, v12, v58
  v_mul_f32 v59, v12, v59
  v_mfma_f32_16x16x32_bf16 v[108:111], v[28:31], v[184:187], 0
  v_mul_f32 v60, v12, v60
  v_mfma_f32_16x16x32_bf16 v[116:119], v[28:31], v[216:219], 0
  s_waitcnt lgkmcnt(5)
  v_mul_f32 v61, v12, v61
  v_mfma_f32_16x16x32_bf16 v[88:91], v[32:35], v[124:127], v[88:91]
  ds_read_b128 v[24:27], v248 offset:16640
  v_mul_f32 v62, v12, v62
  v_mfma_f32_16x16x32_bf16 v[96:99], v[32:35], v[156:159], v[96:99]
  v_mul_f32 v63, v12, v63
  v_cvt_pk_bf16_f32 v56, v56, v57
  v_mfma_f32_16x16x32_bf16 v[104:107], v[32:35], v[188:191], v[104:107]
  s_add_u32 m0, s29, 66560
  s_add_u32 s27, s28, 1064960
  buffer_load_dwordx4 v15, s[60:63], s27 offen lds
  v_mfma_f32_16x16x32_bf16 v[112:115], v[32:35], v[220:223], v[112:115]
  s_waitcnt lgkmcnt(5)
  v_cvt_pk_bf16_f32 v57, v58, v59
  v_mfma_f32_16x16x32_bf16 v[92:95], v[36:39], v[124:127], v[92:95]
  ds_read_b128 v[28:31], v248 offset:18688
  v_cvt_pk_bf16_f32 v58, v60, v61
  v_mfma_f32_16x16x32_bf16 v[100:103], v[36:39], v[156:159], v[100:103]
  v_cvt_pk_bf16_f32 v59, v62, v63
  v_accvgpr_write_b32 a0, v56
  v_mfma_f32_16x16x32_bf16 v[108:111], v[36:39], v[188:191], v[108:111]
  v_accvgpr_write_b32 a1, v57
  v_mfma_f32_16x16x32_bf16 v[116:119], v[36:39], v[220:223], v[116:119]
  s_waitcnt lgkmcnt(5)
  v_accvgpr_write_b32 a2, v58
  v_mfma_f32_16x16x32_bf16 v[88:91], v[40:43], v[128:131], v[88:91]
  ds_read_b128 v[32:35], v249 offset:16640
  v_accvgpr_write_b32 a3, v59
  v_mfma_f32_16x16x32_bf16 v[96:99], v[40:43], v[160:163], v[96:99]
  v_mul_f32 v64, v12, v64
  v_mul_f32 v65, v12, v65
  v_mfma_f32_16x16x32_bf16 v[104:107], v[40:43], v[192:195], v[104:107]
  s_add_u32 m0, s29, 67584
  s_add_u32 s27, s28, 1081344
  buffer_load_dwordx4 v14, s[60:63], s27 offen lds
  v_mfma_f32_16x16x32_bf16 v[112:115], v[40:43], v[224:227], v[112:115]
  s_waitcnt lgkmcnt(5)
  v_mul_f32 v66, v12, v66
  v_mfma_f32_16x16x32_bf16 v[92:95], v[44:47], v[128:131], v[92:95]
  ds_read_b128 v[36:39], v249 offset:18688
  v_mul_f32 v67, v12, v67
  v_mfma_f32_16x16x32_bf16 v[100:103], v[44:47], v[160:163], v[100:103]
  v_mul_f32 v68, v12, v68
  v_mul_f32 v69, v12, v69
  v_mfma_f32_16x16x32_bf16 v[108:111], v[44:47], v[192:195], v[108:111]
  v_mul_f32 v70, v12, v70
  v_mfma_f32_16x16x32_bf16 v[116:119], v[44:47], v[224:227], v[116:119]
  s_waitcnt lgkmcnt(5)
  v_mul_f32 v71, v12, v71
  v_mfma_f32_16x16x32_bf16 v[88:91], v[48:51], v[132:135], v[88:91]
  ds_read_b128 v[40:43], v250 offset:16640
  v_cvt_pk_bf16_f32 v64, v64, v65
  v_mfma_f32_16x16x32_bf16 v[96:99], v[48:51], v[164:167], v[96:99]
  v_cvt_pk_bf16_f32 v65, v66, v67
  v_cvt_pk_bf16_f32 v66, v68, v69
  v_mfma_f32_16x16x32_bf16 v[104:107], v[48:51], v[196:199], v[104:107]
  s_add_u32 m0, s29, 68608
  s_add_u32 s27, s28, 1097728
  buffer_load_dwordx4 v15, s[60:63], s27 offen lds
  v_mfma_f32_16x16x32_bf16 v[112:115], v[48:51], v[228:231], v[112:115]
  s_waitcnt lgkmcnt(5)
  v_cvt_pk_bf16_f32 v67, v70, v71
  v_mfma_f32_16x16x32_bf16 v[92:95], v[52:55], v[132:135], v[92:95]
  ds_read_b128 v[44:47], v250 offset:18688
  v_accvgpr_write_b32 a56, v64
  v_mfma_f32_16x16x32_bf16 v[100:103], v[52:55], v[164:167], v[100:103]
  v_accvgpr_write_b32 a57, v65
  v_accvgpr_write_b32 a58, v66
  v_mfma_f32_16x16x32_bf16 v[108:111], v[52:55], v[196:199], v[108:111]
  v_accvgpr_write_b32 a59, v67
  v_mfma_f32_16x16x32_bf16 v[116:119], v[52:55], v[228:231], v[116:119]
  s_waitcnt lgkmcnt(5)
  v_mul_f32 v72, v12, v72
  v_mfma_f32_16x16x32_bf16 v[88:91], v[24:27], v[136:139], v[88:91]
  ds_read_b128 v[48:51], v251 offset:16640
  v_mul_f32 v73, v12, v73
  v_mfma_f32_16x16x32_bf16 v[96:99], v[24:27], v[168:171], v[96:99]
  v_mul_f32 v74, v12, v74
  v_mul_f32 v75, v12, v75
  v_mfma_f32_16x16x32_bf16 v[104:107], v[24:27], v[200:203], v[104:107]
  v_mul_f32 v76, v12, v76
  v_mfma_f32_16x16x32_bf16 v[112:115], v[24:27], v[232:235], v[112:115]
  s_waitcnt lgkmcnt(5)
  v_mul_f32 v77, v12, v77
  v_mfma_f32_16x16x32_bf16 v[92:95], v[28:31], v[136:139], v[92:95]
  ds_read_b128 v[52:55], v251 offset:18688
  v_mul_f32 v78, v12, v78
  v_mfma_f32_16x16x32_bf16 v[100:103], v[28:31], v[168:171], v[100:103]
  v_mul_f32 v79, v12, v79
  v_cvt_pk_bf16_f32 v72, v72, v73
  v_mfma_f32_16x16x32_bf16 v[108:111], v[28:31], v[200:203], v[108:111]
  v_cvt_pk_bf16_f32 v73, v74, v75
  v_mfma_f32_16x16x32_bf16 v[116:119], v[28:31], v[232:235], v[116:119]
  s_waitcnt lgkmcnt(5)
  v_cvt_pk_bf16_f32 v74, v76, v77
  v_mfma_f32_16x16x32_bf16 v[88:91], v[32:35], v[140:143], v[88:91]
  s_waitcnt vmcnt(8)
  s_barrier
  ds_read_b128 v[24:27], v248 offset:32768
  v_cvt_pk_bf16_f32 v75, v78, v79
  v_mfma_f32_16x16x32_bf16 v[96:99], v[32:35], v[172:175], v[96:99]
  v_accvgpr_write_b32 a112, v72
  v_accvgpr_write_b32 a113, v73
  v_mfma_f32_16x16x32_bf16 v[104:107], v[32:35], v[204:207], v[104:107]
  v_accvgpr_write_b32 a114, v74
  v_mfma_f32_16x16x32_bf16 v[112:115], v[32:35], v[236:239], v[112:115]
  s_waitcnt lgkmcnt(5)
  v_accvgpr_write_b32 a115, v75
  v_mfma_f32_16x16x32_bf16 v[92:95], v[36:39], v[140:143], v[92:95]
  ds_read_b128 v[28:31], v248 offset:34816
  v_mul_f32 v80, v12, v80
  v_mfma_f32_16x16x32_bf16 v[100:103], v[36:39], v[172:175], v[100:103]
  v_mul_f32 v81, v12, v81
  v_mul_f32 v82, v12, v82
  v_mfma_f32_16x16x32_bf16 v[108:111], v[36:39], v[204:207], v[108:111]
  v_mul_f32 v83, v12, v83
  v_mfma_f32_16x16x32_bf16 v[116:119], v[36:39], v[236:239], v[116:119]
  s_waitcnt lgkmcnt(5)
  v_mul_f32 v84, v12, v84
  v_mfma_f32_16x16x32_bf16 v[88:91], v[40:43], v[144:147], v[88:91]
  ds_read_b128 v[32:35], v249 offset:32768
  v_mul_f32 v85, v12, v85
  v_mfma_f32_16x16x32_bf16 v[96:99], v[40:43], v[176:179], v[96:99]
  v_mul_f32 v86, v12, v86
  v_mul_f32 v87, v12, v87
  v_mfma_f32_16x16x32_bf16 v[104:107], v[40:43], v[208:211], v[104:107]
  v_cvt_pk_bf16_f32 v80, v80, v81
  v_mfma_f32_16x16x32_bf16 v[112:115], v[40:43], v[240:243], v[112:115]
  s_waitcnt lgkmcnt(5)
  v_cvt_pk_bf16_f32 v81, v82, v83
  v_mfma_f32_16x16x32_bf16 v[92:95], v[44:47], v[144:147], v[92:95]
  ds_read_b128 v[36:39], v249 offset:34816
  v_cvt_pk_bf16_f32 v82, v84, v85
  v_mfma_f32_16x16x32_bf16 v[100:103], v[44:47], v[176:179], v[100:103]
  v_cvt_pk_bf16_f32 v83, v86, v87
  v_accvgpr_write_b32 a168, v80
  v_mfma_f32_16x16x32_bf16 v[108:111], v[44:47], v[208:211], v[108:111]
  v_accvgpr_write_b32 a169, v81
  v_mfma_f32_16x16x32_bf16 v[116:119], v[44:47], v[240:243], v[116:119]
  s_waitcnt lgkmcnt(5)
  v_accvgpr_write_b32 a170, v82
  v_mfma_f32_16x16x32_bf16 v[88:91], v[48:51], v[148:151], v[88:91]
  ds_read_b128 v[40:43], v250 offset:32768
  v_accvgpr_write_b32 a171, v83
  v_mfma_f32_16x16x32_bf16 v[96:99], v[48:51], v[180:183], v[96:99]
  v_mfma_f32_16x16x32_bf16 v[104:107], v[48:51], v[212:215], v[104:107]
  v_mfma_f32_16x16x32_bf16 v[112:115], v[48:51], v[244:247], v[112:115]
  s_waitcnt lgkmcnt(5)
  v_mfma_f32_16x16x32_bf16 v[92:95], v[52:55], v[148:151], v[92:95]
  ds_read_b128 v[44:47], v250 offset:34816
  v_mfma_f32_16x16x32_bf16 v[100:103], v[52:55], v[180:183], v[100:103]
  v_mfma_f32_16x16x32_bf16 v[108:111], v[52:55], v[212:215], v[108:111]
  v_mfma_f32_16x16x32_bf16 v[116:119], v[52:55], v[244:247], v[116:119]
  s_waitcnt lgkmcnt(5)
  v_mfma_f32_16x16x32_bf16 v[56:59], v[24:27], v[120:123], 0
  ds_read_b128 v[48:51], v251 offset:32768
  v_mfma_f32_16x16x32_bf16 v[64:67], v[24:27], v[152:155], 0
  v_mfma_f32_16x16x32_bf16 v[72:75], v[24:27], v[184:187], 0
  s_add_u32 m0, s29, 81920
  s_add_u32 s27, s28, 1310720
  buffer_load_dwordx4 v14, s[60:63], s27 offen lds
  v_mfma_f32_16x16x32_bf16 v[80:83], v[24:27], v[216:219], 0
  s_waitcnt lgkmcnt(5)
  v_mul_f32 v88, v12, v88
  v_mfma_f32_16x16x32_bf16 v[60:63], v[28:31], v[120:123], 0
  ds_read_b128 v[52:55], v251 offset:34816
  v_mul_f32 v89, v12, v89
  v_mfma_f32_16x16x32_bf16 v[68:71], v[28:31], v[152:155], 0
  v_mul_f32 v90, v12, v90
  v_mul_f32 v91, v12, v91
  v_mfma_f32_16x16x32_bf16 v[76:79], v[28:31], v[184:187], 0
  v_mul_f32 v92, v12, v92
  v_mfma_f32_16x16x32_bf16 v[84:87], v[28:31], v[216:219], 0
  s_waitcnt lgkmcnt(5)
  v_mul_f32 v93, v12, v93
  v_mfma_f32_16x16x32_bf16 v[56:59], v[32:35], v[124:127], v[56:59]
  ds_read_b128 v[24:27], v248 offset:33024
  v_mul_f32 v94, v12, v94
  v_mfma_f32_16x16x32_bf16 v[64:67], v[32:35], v[156:159], v[64:67]
  v_mul_f32 v95, v12, v95
  v_cvt_pk_bf16_f32 v88, v88, v89
  v_mfma_f32_16x16x32_bf16 v[72:75], v[32:35], v[188:191], v[72:75]
  s_add_u32 m0, s29, 82944
  s_add_u32 s27, s28, 1327104
  buffer_load_dwordx4 v15, s[60:63], s27 offen lds
  v_mfma_f32_16x16x32_bf16 v[80:83], v[32:35], v[220:223], v[80:83]
  s_waitcnt lgkmcnt(5)
  v_cvt_pk_bf16_f32 v89, v90, v91
  v_mfma_f32_16x16x32_bf16 v[60:63], v[36:39], v[124:127], v[60:63]
  ds_read_b128 v[28:31], v248 offset:35072
  v_cvt_pk_bf16_f32 v90, v92, v93
  v_mfma_f32_16x16x32_bf16 v[68:71], v[36:39], v[156:159], v[68:71]
  v_cvt_pk_bf16_f32 v91, v94, v95
  v_accvgpr_write_b32 a4, v88
  v_mfma_f32_16x16x32_bf16 v[76:79], v[36:39], v[188:191], v[76:79]
  v_accvgpr_write_b32 a5, v89
  v_mfma_f32_16x16x32_bf16 v[84:87], v[36:39], v[220:223], v[84:87]
  s_waitcnt lgkmcnt(5)
  v_accvgpr_write_b32 a6, v90
  v_mfma_f32_16x16x32_bf16 v[56:59], v[40:43], v[128:131], v[56:59]
  ds_read_b128 v[32:35], v249 offset:33024
  v_accvgpr_write_b32 a7, v91
  v_mfma_f32_16x16x32_bf16 v[64:67], v[40:43], v[160:163], v[64:67]
  v_mul_f32 v96, v12, v96
  v_mul_f32 v97, v12, v97
  v_mfma_f32_16x16x32_bf16 v[72:75], v[40:43], v[192:195], v[72:75]
  s_add_u32 m0, s29, 83968
  s_add_u32 s27, s28, 1343488
  buffer_load_dwordx4 v14, s[60:63], s27 offen lds
  v_mfma_f32_16x16x32_bf16 v[80:83], v[40:43], v[224:227], v[80:83]
  s_waitcnt lgkmcnt(5)
  v_mul_f32 v98, v12, v98
  v_mfma_f32_16x16x32_bf16 v[60:63], v[44:47], v[128:131], v[60:63]
  ds_read_b128 v[36:39], v249 offset:35072
  v_mul_f32 v99, v12, v99
  v_mfma_f32_16x16x32_bf16 v[68:71], v[44:47], v[160:163], v[68:71]
  v_mul_f32 v100, v12, v100
  v_mul_f32 v101, v12, v101
  v_mfma_f32_16x16x32_bf16 v[76:79], v[44:47], v[192:195], v[76:79]
  v_mul_f32 v102, v12, v102
  v_mfma_f32_16x16x32_bf16 v[84:87], v[44:47], v[224:227], v[84:87]
  s_waitcnt lgkmcnt(5)
  v_mul_f32 v103, v12, v103
  v_mfma_f32_16x16x32_bf16 v[56:59], v[48:51], v[132:135], v[56:59]
  ds_read_b128 v[40:43], v250 offset:33024
  v_cvt_pk_bf16_f32 v96, v96, v97
  v_mfma_f32_16x16x32_bf16 v[64:67], v[48:51], v[164:167], v[64:67]
  v_cvt_pk_bf16_f32 v97, v98, v99
  v_cvt_pk_bf16_f32 v98, v100, v101
  v_mfma_f32_16x16x32_bf16 v[72:75], v[48:51], v[196:199], v[72:75]
  s_add_u32 m0, s29, 84992
  s_add_u32 s27, s28, 1359872
  buffer_load_dwordx4 v15, s[60:63], s27 offen lds
  v_mfma_f32_16x16x32_bf16 v[80:83], v[48:51], v[228:231], v[80:83]
  s_waitcnt lgkmcnt(5)
  v_cvt_pk_bf16_f32 v99, v102, v103
  v_mfma_f32_16x16x32_bf16 v[60:63], v[52:55], v[132:135], v[60:63]
  ds_read_b128 v[44:47], v250 offset:35072
  v_accvgpr_write_b32 a60, v96
  v_mfma_f32_16x16x32_bf16 v[68:71], v[52:55], v[164:167], v[68:71]
  v_accvgpr_write_b32 a61, v97
  v_accvgpr_write_b32 a62, v98
  v_mfma_f32_16x16x32_bf16 v[76:79], v[52:55], v[196:199], v[76:79]
  v_accvgpr_write_b32 a63, v99
  v_mfma_f32_16x16x32_bf16 v[84:87], v[52:55], v[228:231], v[84:87]
  s_waitcnt lgkmcnt(5)
  v_mul_f32 v104, v12, v104
  v_mfma_f32_16x16x32_bf16 v[56:59], v[24:27], v[136:139], v[56:59]
  ds_read_b128 v[48:51], v251 offset:33024
  v_mul_f32 v105, v12, v105
  v_mfma_f32_16x16x32_bf16 v[64:67], v[24:27], v[168:171], v[64:67]
  v_mul_f32 v106, v12, v106
  v_mul_f32 v107, v12, v107
  v_mfma_f32_16x16x32_bf16 v[72:75], v[24:27], v[200:203], v[72:75]
  v_mul_f32 v108, v12, v108
  v_mfma_f32_16x16x32_bf16 v[80:83], v[24:27], v[232:235], v[80:83]
  s_waitcnt lgkmcnt(5)
  v_mul_f32 v109, v12, v109
  v_mfma_f32_16x16x32_bf16 v[60:63], v[28:31], v[136:139], v[60:63]
  ds_read_b128 v[52:55], v251 offset:35072
  v_mul_f32 v110, v12, v110
  v_mfma_f32_16x16x32_bf16 v[68:71], v[28:31], v[168:171], v[68:71]
  v_mul_f32 v111, v12, v111
  v_cvt_pk_bf16_f32 v104, v104, v105
  v_mfma_f32_16x16x32_bf16 v[76:79], v[28:31], v[200:203], v[76:79]
  v_cvt_pk_bf16_f32 v105, v106, v107
  v_mfma_f32_16x16x32_bf16 v[84:87], v[28:31], v[232:235], v[84:87]
  s_waitcnt lgkmcnt(5)
  v_cvt_pk_bf16_f32 v106, v108, v109
  v_mfma_f32_16x16x32_bf16 v[56:59], v[32:35], v[140:143], v[56:59]
  s_waitcnt vmcnt(8)
  s_barrier
  ds_read_b128 v[24:27], v248 offset:49152
  v_cvt_pk_bf16_f32 v107, v110, v111
  v_mfma_f32_16x16x32_bf16 v[64:67], v[32:35], v[172:175], v[64:67]
  v_accvgpr_write_b32 a116, v104
  v_accvgpr_write_b32 a117, v105
  v_mfma_f32_16x16x32_bf16 v[72:75], v[32:35], v[204:207], v[72:75]
  v_accvgpr_write_b32 a118, v106
  v_mfma_f32_16x16x32_bf16 v[80:83], v[32:35], v[236:239], v[80:83]
  s_waitcnt lgkmcnt(5)
  v_accvgpr_write_b32 a119, v107
  v_mfma_f32_16x16x32_bf16 v[60:63], v[36:39], v[140:143], v[60:63]
  ds_read_b128 v[28:31], v248 offset:51200
  v_mul_f32 v112, v12, v112
  v_mfma_f32_16x16x32_bf16 v[68:71], v[36:39], v[172:175], v[68:71]
  v_mul_f32 v113, v12, v113
  v_mul_f32 v114, v12, v114
  v_mfma_f32_16x16x32_bf16 v[76:79], v[36:39], v[204:207], v[76:79]
  v_mul_f32 v115, v12, v115
  v_mfma_f32_16x16x32_bf16 v[84:87], v[36:39], v[236:239], v[84:87]
  s_waitcnt lgkmcnt(5)
  v_mul_f32 v116, v12, v116
  v_mfma_f32_16x16x32_bf16 v[56:59], v[40:43], v[144:147], v[56:59]
  ds_read_b128 v[32:35], v249 offset:49152
  v_mul_f32 v117, v12, v117
  v_mfma_f32_16x16x32_bf16 v[64:67], v[40:43], v[176:179], v[64:67]
  v_mul_f32 v118, v12, v118
  v_mul_f32 v119, v12, v119
  v_mfma_f32_16x16x32_bf16 v[72:75], v[40:43], v[208:211], v[72:75]
  v_cvt_pk_bf16_f32 v112, v112, v113
  v_mfma_f32_16x16x32_bf16 v[80:83], v[40:43], v[240:243], v[80:83]
  s_waitcnt lgkmcnt(5)
  v_cvt_pk_bf16_f32 v113, v114, v115
  v_mfma_f32_16x16x32_bf16 v[60:63], v[44:47], v[144:147], v[60:63]
  ds_read_b128 v[36:39], v249 offset:51200
  v_cvt_pk_bf16_f32 v114, v116, v117
  v_mfma_f32_16x16x32_bf16 v[68:71], v[44:47], v[176:179], v[68:71]
  v_cvt_pk_bf16_f32 v115, v118, v119
  v_accvgpr_write_b32 a172, v112
  v_mfma_f32_16x16x32_bf16 v[76:79], v[44:47], v[208:211], v[76:79]
  v_accvgpr_write_b32 a173, v113
  v_mfma_f32_16x16x32_bf16 v[84:87], v[44:47], v[240:243], v[84:87]
  s_waitcnt lgkmcnt(5)
  v_accvgpr_write_b32 a174, v114
  v_mfma_f32_16x16x32_bf16 v[56:59], v[48:51], v[148:151], v[56:59]
  ds_read_b128 v[40:43], v250 offset:49152
  v_accvgpr_write_b32 a175, v115
  v_mfma_f32_16x16x32_bf16 v[64:67], v[48:51], v[180:183], v[64:67]
  v_mfma_f32_16x16x32_bf16 v[72:75], v[48:51], v[212:215], v[72:75]
  v_mfma_f32_16x16x32_bf16 v[80:83], v[48:51], v[244:247], v[80:83]
  s_waitcnt lgkmcnt(5)
  v_mfma_f32_16x16x32_bf16 v[60:63], v[52:55], v[148:151], v[60:63]
  ds_read_b128 v[44:47], v250 offset:51200
  v_mfma_f32_16x16x32_bf16 v[68:71], v[52:55], v[180:183], v[68:71]
  v_mfma_f32_16x16x32_bf16 v[76:79], v[52:55], v[212:215], v[76:79]
  v_mfma_f32_16x16x32_bf16 v[84:87], v[52:55], v[244:247], v[84:87]
  s_waitcnt lgkmcnt(5)
  s_getpc_b64 s[98:99]
  s_add_u32 s98, s98, 4096
  s_addc_u32 s99, s99, 0
  global_load_dword v7, v6, s[98:99]
  v_mfma_f32_16x16x32_bf16 v[88:91], v[24:27], v[120:123], 0
  ds_read_b128 v[48:51], v251 offset:49152
  v_mfma_f32_16x16x32_bf16 v[96:99], v[24:27], v[152:155], 0
  v_mfma_f32_16x16x32_bf16 v[104:107], v[24:27], v[184:187], 0
  s_add_u32 m0, s29, 98304
  s_add_u32 s27, s28, 1572864
  buffer_load_dwordx4 v14, s[60:63], s27 offen lds
  v_mfma_f32_16x16x32_bf16 v[112:115], v[24:27], v[216:219], 0
  s_waitcnt lgkmcnt(5)
  v_mul_f32 v56, v12, v56
  v_mfma_f32_16x16x32_bf16 v[92:95], v[28:31], v[120:123], 0
  ds_read_b128 v[52:55], v251 offset:51200
  v_mul_f32 v57, v12, v57
  v_mfma_f32_16x16x32_bf16 v[100:103], v[28:31], v[152:155], 0
  v_mul_f32 v58, v12, v58
  v_mul_f32 v59, v12, v59
  v_mfma_f32_16x16x32_bf16 v[108:111], v[28:31], v[184:187], 0
  v_mul_f32 v60, v12, v60
  v_mfma_f32_16x16x32_bf16 v[116:119], v[28:31], v[216:219], 0
  s_waitcnt lgkmcnt(5)
  v_mul_f32 v61, v12, v61
  v_mfma_f32_16x16x32_bf16 v[88:91], v[32:35], v[124:127], v[88:91]
  ds_read_b128 v[24:27], v248 offset:49408
  v_mul_f32 v62, v12, v62
  v_mfma_f32_16x16x32_bf16 v[96:99], v[32:35], v[156:159], v[96:99]
  v_mul_f32 v63, v12, v63
  v_cvt_pk_bf16_f32 v56, v56, v57
  v_mfma_f32_16x16x32_bf16 v[104:107], v[32:35], v[188:191], v[104:107]
  s_add_u32 m0, s29, 99328
  s_add_u32 s27, s28, 1589248
  buffer_load_dwordx4 v15, s[60:63], s27 offen lds
  v_mfma_f32_16x16x32_bf16 v[112:115], v[32:35], v[220:223], v[112:115]
  s_waitcnt lgkmcnt(5)
  v_cvt_pk_bf16_f32 v57, v58, v59
  v_mfma_f32_16x16x32_bf16 v[92:95], v[36:39], v[124:127], v[92:95]
  ds_read_b128 v[28:31], v248 offset:51456
  v_cvt_pk_bf16_f32 v58, v60, v61
  v_mfma_f32_16x16x32_bf16 v[100:103], v[36:39], v[156:159], v[100:103]
  v_cvt_pk_bf16_f32 v59, v62, v63
  v_accvgpr_write_b32 a8, v56
  v_mfma_f32_16x16x32_bf16 v[108:111], v[36:39], v[188:191], v[108:111]
  v_accvgpr_write_b32 a9, v57
  v_mfma_f32_16x16x32_bf16 v[116:119], v[36:39], v[220:223], v[116:119]
  s_waitcnt lgkmcnt(5)
  v_accvgpr_write_b32 a10, v58
  v_mfma_f32_16x16x32_bf16 v[88:91], v[40:43], v[128:131], v[88:91]
  ds_read_b128 v[32:35], v249 offset:49408
  v_accvgpr_write_b32 a11, v59
  v_mfma_f32_16x16x32_bf16 v[96:99], v[40:43], v[160:163], v[96:99]
  v_mul_f32 v64, v12, v64
  v_mul_f32 v65, v12, v65
  v_mfma_f32_16x16x32_bf16 v[104:107], v[40:43], v[192:195], v[104:107]
  s_add_u32 m0, s29, 100352
  s_add_u32 s27, s28, 1605632
  buffer_load_dwordx4 v14, s[60:63], s27 offen lds
  v_mfma_f32_16x16x32_bf16 v[112:115], v[40:43], v[224:227], v[112:115]
  s_waitcnt lgkmcnt(5)
  v_mul_f32 v66, v12, v66
  v_mfma_f32_16x16x32_bf16 v[92:95], v[44:47], v[128:131], v[92:95]
  ds_read_b128 v[36:39], v249 offset:51456
  v_mul_f32 v67, v12, v67
  v_mfma_f32_16x16x32_bf16 v[100:103], v[44:47], v[160:163], v[100:103]
  v_mul_f32 v68, v12, v68
  v_mul_f32 v69, v12, v69
  v_mfma_f32_16x16x32_bf16 v[108:111], v[44:47], v[192:195], v[108:111]
  v_mul_f32 v70, v12, v70
  v_mfma_f32_16x16x32_bf16 v[116:119], v[44:47], v[224:227], v[116:119]
  s_waitcnt lgkmcnt(5)
  v_mul_f32 v71, v12, v71
  v_mfma_f32_16x16x32_bf16 v[88:91], v[48:51], v[132:135], v[88:91]
  ds_read_b128 v[40:43], v250 offset:49408
  v_cvt_pk_bf16_f32 v64, v64, v65
  v_mfma_f32_16x16x32_bf16 v[96:99], v[48:51], v[164:167], v[96:99]
  v_cvt_pk_bf16_f32 v65, v66, v67
  v_cvt_pk_bf16_f32 v66, v68, v69
  v_mfma_f32_16x16x32_bf16 v[104:107], v[48:51], v[196:199], v[104:107]
  s_add_u32 m0, s29, 101376
  s_add_u32 s27, s28, 1622016
  buffer_load_dwordx4 v15, s[60:63], s27 offen lds
  v_mfma_f32_16x16x32_bf16 v[112:115], v[48:51], v[228:231], v[112:115]
  s_waitcnt lgkmcnt(5)
  v_cvt_pk_bf16_f32 v67, v70, v71
  v_mfma_f32_16x16x32_bf16 v[92:95], v[52:55], v[132:135], v[92:95]
  ds_read_b128 v[44:47], v250 offset:51456
  v_accvgpr_write_b32 a64, v64
  v_mfma_f32_16x16x32_bf16 v[100:103], v[52:55], v[164:167], v[100:103]
  v_accvgpr_write_b32 a65, v65
  v_accvgpr_write_b32 a66, v66
  v_mfma_f32_16x16x32_bf16 v[108:111], v[52:55], v[196:199], v[108:111]
  v_accvgpr_write_b32 a67, v67
  v_mfma_f32_16x16x32_bf16 v[116:119], v[52:55], v[228:231], v[116:119]
  s_waitcnt lgkmcnt(5)
  v_mul_f32 v72, v12, v72
  v_mfma_f32_16x16x32_bf16 v[88:91], v[24:27], v[136:139], v[88:91]
  ds_read_b128 v[48:51], v251 offset:49408
  v_mul_f32 v73, v12, v73
  v_mfma_f32_16x16x32_bf16 v[96:99], v[24:27], v[168:171], v[96:99]
  v_mul_f32 v74, v12, v74
  v_mul_f32 v75, v12, v75
  v_mfma_f32_16x16x32_bf16 v[104:107], v[24:27], v[200:203], v[104:107]
  v_mul_f32 v76, v12, v76
  v_mfma_f32_16x16x32_bf16 v[112:115], v[24:27], v[232:235], v[112:115]
  s_waitcnt lgkmcnt(5)
  v_mul_f32 v77, v12, v77
  v_mfma_f32_16x16x32_bf16 v[92:95], v[28:31], v[136:139], v[92:95]
  ds_read_b128 v[52:55], v251 offset:51456
  v_mul_f32 v78, v12, v78
  v_mfma_f32_16x16x32_bf16 v[100:103], v[28:31], v[168:171], v[100:103]
  v_mul_f32 v79, v12, v79
  v_cvt_pk_bf16_f32 v72, v72, v73
  v_mfma_f32_16x16x32_bf16 v[108:111], v[28:31], v[200:203], v[108:111]
  v_cvt_pk_bf16_f32 v73, v74, v75
  v_mfma_f32_16x16x32_bf16 v[116:119], v[28:31], v[232:235], v[116:119]
  s_waitcnt lgkmcnt(5)
  v_cvt_pk_bf16_f32 v74, v76, v77
  v_mfma_f32_16x16x32_bf16 v[88:91], v[32:35], v[140:143], v[88:91]
  s_waitcnt vmcnt(8)
  s_barrier
  ds_read_b128 v[24:27], v252 offset:0
  v_cvt_pk_bf16_f32 v75, v78, v79
  v_mfma_f32_16x16x32_bf16 v[96:99], v[32:35], v[172:175], v[96:99]
  v_accvgpr_write_b32 a120, v72
  v_accvgpr_write_b32 a121, v73
  v_mfma_f32_16x16x32_bf16 v[104:107], v[32:35], v[204:207], v[104:107]
  v_accvgpr_write_b32 a122, v74
  v_mfma_f32_16x16x32_bf16 v[112:115], v[32:35], v[236:239], v[112:115]
  s_waitcnt lgkmcnt(5)
  v_accvgpr_write_b32 a123, v75
  v_mfma_f32_16x16x32_bf16 v[92:95], v[36:39], v[140:143], v[92:95]
  ds_read_b128 v[28:31], v252 offset:2048
  v_mul_f32 v80, v12, v80
  v_mfma_f32_16x16x32_bf16 v[100:103], v[36:39], v[172:175], v[100:103]
  v_mul_f32 v81, v12, v81
  v_mul_f32 v82, v12, v82
  v_mfma_f32_16x16x32_bf16 v[108:111], v[36:39], v[204:207], v[108:111]
  v_mul_f32 v83, v12, v83
  v_mfma_f32_16x16x32_bf16 v[116:119], v[36:39], v[236:239], v[116:119]
  s_waitcnt lgkmcnt(5)
  v_mul_f32 v84, v12, v84
  v_mfma_f32_16x16x32_bf16 v[88:91], v[40:43], v[144:147], v[88:91]
  ds_read_b128 v[32:35], v253 offset:0
  v_mul_f32 v85, v12, v85
  v_mfma_f32_16x16x32_bf16 v[96:99], v[40:43], v[176:179], v[96:99]
  v_mul_f32 v86, v12, v86
  v_mul_f32 v87, v12, v87
  v_mfma_f32_16x16x32_bf16 v[104:107], v[40:43], v[208:211], v[104:107]
  v_cvt_pk_bf16_f32 v80, v80, v81
  v_mfma_f32_16x16x32_bf16 v[112:115], v[40:43], v[240:243], v[112:115]
  s_waitcnt lgkmcnt(5)
  v_cvt_pk_bf16_f32 v81, v82, v83
  v_mfma_f32_16x16x32_bf16 v[92:95], v[44:47], v[144:147], v[92:95]
  ds_read_b128 v[36:39], v253 offset:2048
  v_cvt_pk_bf16_f32 v82, v84, v85
  v_mfma_f32_16x16x32_bf16 v[100:103], v[44:47], v[176:179], v[100:103]
  v_cvt_pk_bf16_f32 v83, v86, v87
  v_accvgpr_write_b32 a176, v80
  v_mfma_f32_16x16x32_bf16 v[108:111], v[44:47], v[208:211], v[108:111]
  v_accvgpr_write_b32 a177, v81
  v_mfma_f32_16x16x32_bf16 v[116:119], v[44:47], v[240:243], v[116:119]
  s_waitcnt lgkmcnt(5)
  v_accvgpr_write_b32 a178, v82
  v_mfma_f32_16x16x32_bf16 v[88:91], v[48:51], v[148:151], v[88:91]
  ds_read_b128 v[40:43], v254 offset:0
  v_accvgpr_write_b32 a179, v83
  v_mfma_f32_16x16x32_bf16 v[96:99], v[48:51], v[180:183], v[96:99]
  v_mfma_f32_16x16x32_bf16 v[104:107], v[48:51], v[212:215], v[104:107]
  v_mfma_f32_16x16x32_bf16 v[112:115], v[48:51], v[244:247], v[112:115]
  s_waitcnt lgkmcnt(5)
  v_mfma_f32_16x16x32_bf16 v[92:95], v[52:55], v[148:151], v[92:95]
  ds_read_b128 v[44:47], v254 offset:2048
  v_mfma_f32_16x16x32_bf16 v[100:103], v[52:55], v[180:183], v[100:103]
  v_mfma_f32_16x16x32_bf16 v[108:111], v[52:55], v[212:215], v[108:111]
  v_mfma_f32_16x16x32_bf16 v[116:119], v[52:55], v[244:247], v[116:119]
  s_waitcnt lgkmcnt(5)
  v_mfma_f32_16x16x32_bf16 v[56:59], v[24:27], v[120:123], 0
  ds_read_b128 v[48:51], v255 offset:0
  v_mfma_f32_16x16x32_bf16 v[64:67], v[24:27], v[152:155], 0
  v_mfma_f32_16x16x32_bf16 v[72:75], v[24:27], v[184:187], 0
  s_add_u32 m0, s29, 114688
  s_add_u32 s27, s28, 1835008
  buffer_load_dwordx4 v14, s[60:63], s27 offen lds
  v_mfma_f32_16x16x32_bf16 v[80:83], v[24:27], v[216:219], 0
  s_waitcnt lgkmcnt(5)
  v_mul_f32 v88, v12, v88
  v_mfma_f32_16x16x32_bf16 v[60:63], v[28:31], v[120:123], 0
  ds_read_b128 v[52:55], v255 offset:2048
  v_mul_f32 v89, v12, v89
  v_mfma_f32_16x16x32_bf16 v[68:71], v[28:31], v[152:155], 0
  v_mul_f32 v90, v12, v90
  v_mul_f32 v91, v12, v91
  v_mfma_f32_16x16x32_bf16 v[76:79], v[28:31], v[184:187], 0
  v_mul_f32 v92, v12, v92
  v_mfma_f32_16x16x32_bf16 v[84:87], v[28:31], v[216:219], 0
  s_waitcnt lgkmcnt(5)
  v_mul_f32 v93, v12, v93
  v_mfma_f32_16x16x32_bf16 v[56:59], v[32:35], v[124:127], v[56:59]
  ds_read_b128 v[24:27], v252 offset:256
  v_mul_f32 v94, v12, v94
  v_mfma_f32_16x16x32_bf16 v[64:67], v[32:35], v[156:159], v[64:67]
  v_mul_f32 v95, v12, v95
  v_cvt_pk_bf16_f32 v88, v88, v89
  v_mfma_f32_16x16x32_bf16 v[72:75], v[32:35], v[188:191], v[72:75]
  s_add_u32 m0, s29, 115712
  s_add_u32 s27, s28, 1851392
  buffer_load_dwordx4 v15, s[60:63], s27 offen lds
  v_mfma_f32_16x16x32_bf16 v[80:83], v[32:35], v[220:223], v[80:83]
  s_waitcnt lgkmcnt(5)
  v_cvt_pk_bf16_f32 v89, v90, v91
  v_mfma_f32_16x16x32_bf16 v[60:63], v[36:39], v[124:127], v[60:63]
  ds_read_b128 v[28:31], v252 offset:2304
  v_cvt_pk_bf16_f32 v90, v92, v93
  v_mfma_f32_16x16x32_bf16 v[68:71], v[36:39], v[156:159], v[68:71]
  v_cvt_pk_bf16_f32 v91, v94, v95
  v_accvgpr_write_b32 a12, v88
  v_mfma_f32_16x16x32_bf16 v[76:79], v[36:39], v[188:191], v[76:79]
  v_accvgpr_write_b32 a13, v89
  v_mfma_f32_16x16x32_bf16 v[84:87], v[36:39], v[220:223], v[84:87]
  s_waitcnt lgkmcnt(5)
  v_accvgpr_write_b32 a14, v90
  v_mfma_f32_16x16x32_bf16 v[56:59], v[40:43], v[128:131], v[56:59]
  ds_read_b128 v[32:35], v253 offset:256
  v_accvgpr_write_b32 a15, v91
  v_mfma_f32_16x16x32_bf16 v[64:67], v[40:43], v[160:163], v[64:67]
  v_mul_f32 v96, v12, v96
  v_mul_f32 v97, v12, v97
  v_mfma_f32_16x16x32_bf16 v[72:75], v[40:43], v[192:195], v[72:75]
  s_add_u32 m0, s29, 116736
  s_add_u32 s27, s28, 1867776
  buffer_load_dwordx4 v14, s[60:63], s27 offen lds
  v_mfma_f32_16x16x32_bf16 v[80:83], v[40:43], v[224:227], v[80:83]
  s_waitcnt lgkmcnt(5)
  v_mul_f32 v98, v12, v98
  v_mfma_f32_16x16x32_bf16 v[60:63], v[44:47], v[128:131], v[60:63]
  ds_read_b128 v[36:39], v253 offset:2304
  v_mul_f32 v99, v12, v99
  v_mfma_f32_16x16x32_bf16 v[68:71], v[44:47], v[160:163], v[68:71]
  v_mul_f32 v100, v12, v100
  v_mul_f32 v101, v12, v101
  v_mfma_f32_16x16x32_bf16 v[76:79], v[44:47], v[192:195], v[76:79]
  v_mul_f32 v102, v12, v102
  v_mfma_f32_16x16x32_bf16 v[84:87], v[44:47], v[224:227], v[84:87]
  s_waitcnt lgkmcnt(5)
  v_mul_f32 v103, v12, v103
  v_mfma_f32_16x16x32_bf16 v[56:59], v[48:51], v[132:135], v[56:59]
  ds_read_b128 v[40:43], v254 offset:256
  v_cvt_pk_bf16_f32 v96, v96, v97
  v_mfma_f32_16x16x32_bf16 v[64:67], v[48:51], v[164:167], v[64:67]
  v_cvt_pk_bf16_f32 v97, v98, v99
  v_cvt_pk_bf16_f32 v98, v100, v101
  v_mfma_f32_16x16x32_bf16 v[72:75], v[48:51], v[196:199], v[72:75]
  s_add_u32 m0, s29, 117760
  s_add_u32 s27, s28, 1884160
  buffer_load_dwordx4 v15, s[60:63], s27 offen lds
  v_mfma_f32_16x16x32_bf16 v[80:83], v[48:51], v[228:231], v[80:83]
  s_waitcnt lgkmcnt(5)
  v_cvt_pk_bf16_f32 v99, v102, v103
  v_mfma_f32_16x16x32_bf16 v[60:63], v[52:55], v[132:135], v[60:63]
  ds_read_b128 v[44:47], v254 offset:2304
  v_accvgpr_write_b32 a68, v96
  v_mfma_f32_16x16x32_bf16 v[68:71], v[52:55], v[164:167], v[68:71]
  v_accvgpr_write_b32 a69, v97
  v_accvgpr_write_b32 a70, v98
  v_mfma_f32_16x16x32_bf16 v[76:79], v[52:55], v[196:199], v[76:79]
  v_accvgpr_write_b32 a71, v99
  v_mfma_f32_16x16x32_bf16 v[84:87], v[52:55], v[228:231], v[84:87]
  s_waitcnt lgkmcnt(5)
  v_mul_f32 v104, v12, v104
  v_mfma_f32_16x16x32_bf16 v[56:59], v[24:27], v[136:139], v[56:59]
  ds_read_b128 v[48:51], v255 offset:256
  v_mul_f32 v105, v12, v105
  v_mfma_f32_16x16x32_bf16 v[64:67], v[24:27], v[168:171], v[64:67]
  v_mul_f32 v106, v12, v106
  v_mul_f32 v107, v12, v107
  v_mfma_f32_16x16x32_bf16 v[72:75], v[24:27], v[200:203], v[72:75]
  v_mul_f32 v108, v12, v108
  v_mfma_f32_16x16x32_bf16 v[80:83], v[24:27], v[232:235], v[80:83]
  s_waitcnt lgkmcnt(5)
  v_mul_f32 v109, v12, v109
  v_mfma_f32_16x16x32_bf16 v[60:63], v[28:31], v[136:139], v[60:63]
  ds_read_b128 v[52:55], v255 offset:2304
  v_mul_f32 v110, v12, v110
  v_mfma_f32_16x16x32_bf16 v[68:71], v[28:31], v[168:171], v[68:71]
  v_mul_f32 v111, v12, v111
  v_cvt_pk_bf16_f32 v104, v104, v105
  v_mfma_f32_16x16x32_bf16 v[76:79], v[28:31], v[200:203], v[76:79]
  v_cvt_pk_bf16_f32 v105, v106, v107
  v_mfma_f32_16x16x32_bf16 v[84:87], v[28:31], v[232:235], v[84:87]
  s_waitcnt lgkmcnt(5)
  v_cvt_pk_bf16_f32 v106, v108, v109
  v_mfma_f32_16x16x32_bf16 v[56:59], v[32:35], v[140:143], v[56:59]
  s_waitcnt vmcnt(8)
  s_barrier
  ds_read_b128 v[24:27], v252 offset:16384
  v_cvt_pk_bf16_f32 v107, v110, v111
  v_mfma_f32_16x16x32_bf16 v[64:67], v[32:35], v[172:175], v[64:67]
  v_accvgpr_write_b32 a124, v104
  v_accvgpr_write_b32 a125, v105
  v_mfma_f32_16x16x32_bf16 v[72:75], v[32:35], v[204:207], v[72:75]
  v_accvgpr_write_b32 a126, v106
  v_mfma_f32_16x16x32_bf16 v[80:83], v[32:35], v[236:239], v[80:83]
  s_waitcnt lgkmcnt(5)
  v_accvgpr_write_b32 a127, v107
  v_mfma_f32_16x16x32_bf16 v[60:63], v[36:39], v[140:143], v[60:63]
  ds_read_b128 v[28:31], v252 offset:18432
  v_mul_f32 v112, v12, v112
  v_mfma_f32_16x16x32_bf16 v[68:71], v[36:39], v[172:175], v[68:71]
  v_mul_f32 v113, v12, v113
  v_mul_f32 v114, v12, v114
  v_mfma_f32_16x16x32_bf16 v[76:79], v[36:39], v[204:207], v[76:79]
  v_mul_f32 v115, v12, v115
  v_mfma_f32_16x16x32_bf16 v[84:87], v[36:39], v[236:239], v[84:87]
  s_waitcnt lgkmcnt(5)
  v_mul_f32 v116, v12, v116
  v_mfma_f32_16x16x32_bf16 v[56:59], v[40:43], v[144:147], v[56:59]
  ds_read_b128 v[32:35], v253 offset:16384
  v_mul_f32 v117, v12, v117
  v_mfma_f32_16x16x32_bf16 v[64:67], v[40:43], v[176:179], v[64:67]
  v_mul_f32 v118, v12, v118
  v_mul_f32 v119, v12, v119
  v_mfma_f32_16x16x32_bf16 v[72:75], v[40:43], v[208:211], v[72:75]
  v_cvt_pk_bf16_f32 v112, v112, v113
  v_mfma_f32_16x16x32_bf16 v[80:83], v[40:43], v[240:243], v[80:83]
  s_waitcnt lgkmcnt(5)
  v_cvt_pk_bf16_f32 v113, v114, v115
  v_mfma_f32_16x16x32_bf16 v[60:63], v[44:47], v[144:147], v[60:63]
  ds_read_b128 v[36:39], v253 offset:18432
  v_cvt_pk_bf16_f32 v114, v116, v117
  v_mfma_f32_16x16x32_bf16 v[68:71], v[44:47], v[176:179], v[68:71]
  v_cvt_pk_bf16_f32 v115, v118, v119
  v_accvgpr_write_b32 a180, v112
  v_mfma_f32_16x16x32_bf16 v[76:79], v[44:47], v[208:211], v[76:79]
  v_accvgpr_write_b32 a181, v113
  v_mfma_f32_16x16x32_bf16 v[84:87], v[44:47], v[240:243], v[84:87]
  s_waitcnt lgkmcnt(5)
  v_accvgpr_write_b32 a182, v114
  v_mfma_f32_16x16x32_bf16 v[56:59], v[48:51], v[148:151], v[56:59]
  ds_read_b128 v[40:43], v254 offset:16384
  v_accvgpr_write_b32 a183, v115
  v_mfma_f32_16x16x32_bf16 v[64:67], v[48:51], v[180:183], v[64:67]
  v_mfma_f32_16x16x32_bf16 v[72:75], v[48:51], v[212:215], v[72:75]
  v_mfma_f32_16x16x32_bf16 v[80:83], v[48:51], v[244:247], v[80:83]
  s_waitcnt lgkmcnt(5)
  v_mfma_f32_16x16x32_bf16 v[60:63], v[52:55], v[148:151], v[60:63]
  ds_read_b128 v[44:47], v254 offset:18432
  v_mfma_f32_16x16x32_bf16 v[68:71], v[52:55], v[180:183], v[68:71]
  v_mfma_f32_16x16x32_bf16 v[76:79], v[52:55], v[212:215], v[76:79]
  v_mfma_f32_16x16x32_bf16 v[84:87], v[52:55], v[244:247], v[84:87]
  s_waitcnt lgkmcnt(5)
  v_mfma_f32_16x16x32_bf16 v[88:91], v[24:27], v[120:123], 0
  ds_read_b128 v[48:51], v255 offset:16384
  v_mfma_f32_16x16x32_bf16 v[96:99], v[24:27], v[152:155], 0
  v_mfma_f32_16x16x32_bf16 v[104:107], v[24:27], v[184:187], 0
  s_add_u32 m0, s29, 131072
  s_add_u32 s27, s28, 2097152
  buffer_load_dwordx4 v14, s[60:63], s27 offen lds
  v_mfma_f32_16x16x32_bf16 v[112:115], v[24:27], v[216:219], 0
  s_waitcnt lgkmcnt(5)
  v_mul_f32 v56, v12, v56
  v_mfma_f32_16x16x32_bf16 v[92:95], v[28:31], v[120:123], 0
  ds_read_b128 v[52:55], v255 offset:18432
  v_mul_f32 v57, v12, v57
  v_mfma_f32_16x16x32_bf16 v[100:103], v[28:31], v[152:155], 0
  v_mul_f32 v58, v12, v58
  v_mul_f32 v59, v12, v59
  v_mfma_f32_16x16x32_bf16 v[108:111], v[28:31], v[184:187], 0
  v_mul_f32 v60, v12, v60
  v_mfma_f32_16x16x32_bf16 v[116:119], v[28:31], v[216:219], 0
  s_waitcnt lgkmcnt(5)
  v_mul_f32 v61, v12, v61
  v_mfma_f32_16x16x32_bf16 v[88:91], v[32:35], v[124:127], v[88:91]
  ds_read_b128 v[24:27], v252 offset:16640
  v_mul_f32 v62, v12, v62
  v_mfma_f32_16x16x32_bf16 v[96:99], v[32:35], v[156:159], v[96:99]
  v_mul_f32 v63, v12, v63
  v_cvt_pk_bf16_f32 v56, v56, v57
  v_mfma_f32_16x16x32_bf16 v[104:107], v[32:35], v[188:191], v[104:107]
  s_add_u32 m0, s29, 132096
  s_add_u32 s27, s28, 2113536
  buffer_load_dwordx4 v15, s[60:63], s27 offen lds
  v_mfma_f32_16x16x32_bf16 v[112:115], v[32:35], v[220:223], v[112:115]
  s_waitcnt lgkmcnt(5)
  v_cvt_pk_bf16_f32 v57, v58, v59
  v_mfma_f32_16x16x32_bf16 v[92:95], v[36:39], v[124:127], v[92:95]
  ds_read_b128 v[28:31], v252 offset:18688
  v_cvt_pk_bf16_f32 v58, v60, v61
  v_mfma_f32_16x16x32_bf16 v[100:103], v[36:39], v[156:159], v[100:103]
  v_cvt_pk_bf16_f32 v59, v62, v63
  v_accvgpr_write_b32 a16, v56
  v_mfma_f32_16x16x32_bf16 v[108:111], v[36:39], v[188:191], v[108:111]
  v_accvgpr_write_b32 a17, v57
  v_mfma_f32_16x16x32_bf16 v[116:119], v[36:39], v[220:223], v[116:119]
  s_waitcnt lgkmcnt(5)
  v_accvgpr_write_b32 a18, v58
  v_mfma_f32_16x16x32_bf16 v[88:91], v[40:43], v[128:131], v[88:91]
  ds_read_b128 v[32:35], v253 offset:16640
  v_accvgpr_write_b32 a19, v59
  v_mfma_f32_16x16x32_bf16 v[96:99], v[40:43], v[160:163], v[96:99]
  v_mul_f32 v64, v12, v64
  v_mul_f32 v65, v12, v65
  v_mfma_f32_16x16x32_bf16 v[104:107], v[40:43], v[192:195], v[104:107]
  s_add_u32 m0, s29, 133120
  s_add_u32 s27, s28, 2129920
  buffer_load_dwordx4 v14, s[60:63], s27 offen lds
  v_mfma_f32_16x16x32_bf16 v[112:115], v[40:43], v[224:227], v[112:115]
  s_waitcnt lgkmcnt(5)
  v_mul_f32 v66, v12, v66
  v_mfma_f32_16x16x32_bf16 v[92:95], v[44:47], v[128:131], v[92:95]
  ds_read_b128 v[36:39], v253 offset:18688
  v_mul_f32 v67, v12, v67
  v_mfma_f32_16x16x32_bf16 v[100:103], v[44:47], v[160:163], v[100:103]
  v_mul_f32 v68, v12, v68
  v_mul_f32 v69, v12, v69
  v_mfma_f32_16x16x32_bf16 v[108:111], v[44:47], v[192:195], v[108:111]
  v_mul_f32 v70, v12, v70
  v_mfma_f32_16x16x32_bf16 v[116:119], v[44:47], v[224:227], v[116:119]
  s_waitcnt lgkmcnt(5)
  v_mul_f32 v71, v12, v71
  v_mfma_f32_16x16x32_bf16 v[88:91], v[48:51], v[132:135], v[88:91]
  ds_read_b128 v[40:43], v254 offset:16640
  v_cvt_pk_bf16_f32 v64, v64, v65
  v_mfma_f32_16x16x32_bf16 v[96:99], v[48:51], v[164:167], v[96:99]
  v_cvt_pk_bf16_f32 v65, v66, v67
  v_cvt_pk_bf16_f32 v66, v68, v69
  v_mfma_f32_16x16x32_bf16 v[104:107], v[48:51], v[196:199], v[104:107]
  s_add_u32 m0, s29, 134144
  s_add_u32 s27, s28, 2146304
  buffer_load_dwordx4 v15, s[60:63], s27 offen lds
  v_mfma_f32_16x16x32_bf16 v[112:115], v[48:51], v[228:231], v[112:115]
  s_waitcnt lgkmcnt(5)
  v_cvt_pk_bf16_f32 v67, v70, v71
  v_mfma_f32_16x16x32_bf16 v[92:95], v[52:55], v[132:135], v[92:95]
  ds_read_b128 v[44:47], v254 offset:18688
  v_accvgpr_write_b32 a72, v64
  v_mfma_f32_16x16x32_bf16 v[100:103], v[52:55], v[164:167], v[100:103]
  v_accvgpr_write_b32 a73, v65
  v_accvgpr_write_b32 a74, v66
  v_mfma_f32_16x16x32_bf16 v[108:111], v[52:55], v[196:199], v[108:111]
  v_accvgpr_write_b32 a75, v67
  v_mfma_f32_16x16x32_bf16 v[116:119], v[52:55], v[228:231], v[116:119]
  s_waitcnt lgkmcnt(5)
  v_mul_f32 v72, v12, v72
  v_mfma_f32_16x16x32_bf16 v[88:91], v[24:27], v[136:139], v[88:91]
  ds_read_b128 v[48:51], v255 offset:16640
  v_mul_f32 v73, v12, v73
  v_mfma_f32_16x16x32_bf16 v[96:99], v[24:27], v[168:171], v[96:99]
  v_mul_f32 v74, v12, v74
  v_mul_f32 v75, v12, v75
  v_mfma_f32_16x16x32_bf16 v[104:107], v[24:27], v[200:203], v[104:107]
  v_mul_f32 v76, v12, v76
  v_mfma_f32_16x16x32_bf16 v[112:115], v[24:27], v[232:235], v[112:115]
  s_waitcnt lgkmcnt(5)
  v_mul_f32 v77, v12, v77
  v_mfma_f32_16x16x32_bf16 v[92:95], v[28:31], v[136:139], v[92:95]
  ds_read_b128 v[52:55], v255 offset:18688
  v_mul_f32 v78, v12, v78
  v_mfma_f32_16x16x32_bf16 v[100:103], v[28:31], v[168:171], v[100:103]
  v_mul_f32 v79, v12, v79
  v_cvt_pk_bf16_f32 v72, v72, v73
  v_mfma_f32_16x16x32_bf16 v[108:111], v[28:31], v[200:203], v[108:111]
  v_cvt_pk_bf16_f32 v73, v74, v75
  v_mfma_f32_16x16x32_bf16 v[116:119], v[28:31], v[232:235], v[116:119]
  s_waitcnt lgkmcnt(5)
  v_cvt_pk_bf16_f32 v74, v76, v77
  v_mfma_f32_16x16x32_bf16 v[88:91], v[32:35], v[140:143], v[88:91]
  s_waitcnt vmcnt(8)
  s_barrier
  ds_read_b128 v[24:27], v252 offset:32768
  v_cvt_pk_bf16_f32 v75, v78, v79
  v_mfma_f32_16x16x32_bf16 v[96:99], v[32:35], v[172:175], v[96:99]
  v_accvgpr_write_b32 a128, v72
  v_accvgpr_write_b32 a129, v73
  v_mfma_f32_16x16x32_bf16 v[104:107], v[32:35], v[204:207], v[104:107]
  v_accvgpr_write_b32 a130, v74
  v_mfma_f32_16x16x32_bf16 v[112:115], v[32:35], v[236:239], v[112:115]
  s_waitcnt lgkmcnt(5)
  v_accvgpr_write_b32 a131, v75
  v_mfma_f32_16x16x32_bf16 v[92:95], v[36:39], v[140:143], v[92:95]
  ds_read_b128 v[28:31], v252 offset:34816
  v_mul_f32 v80, v12, v80
  v_mfma_f32_16x16x32_bf16 v[100:103], v[36:39], v[172:175], v[100:103]
  v_mul_f32 v81, v12, v81
  v_mul_f32 v82, v12, v82
  v_mfma_f32_16x16x32_bf16 v[108:111], v[36:39], v[204:207], v[108:111]
  v_mul_f32 v83, v12, v83
  v_mfma_f32_16x16x32_bf16 v[116:119], v[36:39], v[236:239], v[116:119]
  s_waitcnt lgkmcnt(5)
  v_mul_f32 v84, v12, v84
  v_mfma_f32_16x16x32_bf16 v[88:91], v[40:43], v[144:147], v[88:91]
  ds_read_b128 v[32:35], v253 offset:32768
  v_mul_f32 v85, v12, v85
  v_mfma_f32_16x16x32_bf16 v[96:99], v[40:43], v[176:179], v[96:99]
  v_mul_f32 v86, v12, v86
  v_mul_f32 v87, v12, v87
  v_mfma_f32_16x16x32_bf16 v[104:107], v[40:43], v[208:211], v[104:107]
  v_cvt_pk_bf16_f32 v80, v80, v81
  v_mfma_f32_16x16x32_bf16 v[112:115], v[40:43], v[240:243], v[112:115]
  s_waitcnt lgkmcnt(5)
  v_cvt_pk_bf16_f32 v81, v82, v83
  v_mfma_f32_16x16x32_bf16 v[92:95], v[44:47], v[144:147], v[92:95]
  ds_read_b128 v[36:39], v253 offset:34816
  v_cvt_pk_bf16_f32 v82, v84, v85
  v_mfma_f32_16x16x32_bf16 v[100:103], v[44:47], v[176:179], v[100:103]
  v_cvt_pk_bf16_f32 v83, v86, v87
  v_accvgpr_write_b32 a184, v80
  v_mfma_f32_16x16x32_bf16 v[108:111], v[44:47], v[208:211], v[108:111]
  v_accvgpr_write_b32 a185, v81
  v_mfma_f32_16x16x32_bf16 v[116:119], v[44:47], v[240:243], v[116:119]
  s_waitcnt lgkmcnt(5)
  v_accvgpr_write_b32 a186, v82
  v_mfma_f32_16x16x32_bf16 v[88:91], v[48:51], v[148:151], v[88:91]
  ds_read_b128 v[40:43], v254 offset:32768
  v_accvgpr_write_b32 a187, v83
  v_mfma_f32_16x16x32_bf16 v[96:99], v[48:51], v[180:183], v[96:99]
  v_mfma_f32_16x16x32_bf16 v[104:107], v[48:51], v[212:215], v[104:107]
  v_mfma_f32_16x16x32_bf16 v[112:115], v[48:51], v[244:247], v[112:115]
  s_waitcnt lgkmcnt(5)
  v_mfma_f32_16x16x32_bf16 v[92:95], v[52:55], v[148:151], v[92:95]
  ds_read_b128 v[44:47], v254 offset:34816
  v_mfma_f32_16x16x32_bf16 v[100:103], v[52:55], v[180:183], v[100:103]
  v_mfma_f32_16x16x32_bf16 v[108:111], v[52:55], v[212:215], v[108:111]
  v_mfma_f32_16x16x32_bf16 v[116:119], v[52:55], v[244:247], v[116:119]
  s_waitcnt lgkmcnt(5)
  s_getpc_b64 s[98:99]
  s_add_u32 s98, s98, 4096
  s_addc_u32 s99, s99, 0
  global_load_dword v7, v6, s[98:99]
  v_mfma_f32_16x16x32_bf16 v[56:59], v[24:27], v[120:123], 0
  ds_read_b128 v[48:51], v255 offset:32768
  v_mfma_f32_16x16x32_bf16 v[64:67], v[24:27], v[152:155], 0
  v_mfma_f32_16x16x32_bf16 v[72:75], v[24:27], v[184:187], 0
  s_add_u32 m0, s29, 147456
  s_add_u32 s27, s28, 2359296
  buffer_load_dwordx4 v14, s[60:63], s27 offen lds
  v_mfma_f32_16x16x32_bf16 v[80:83], v[24:27], v[216:219], 0
  s_waitcnt lgkmcnt(5)
  v_mul_f32 v88, v12, v88
  v_mfma_f32_16x16x32_bf16 v[60:63], v[28:31], v[120:123], 0
  ds_read_b128 v[52:55], v255 offset:34816
  v_mul_f32 v89, v12, v89
  v_mfma_f32_16x16x32_bf16 v[68:71], v[28:31], v[152:155], 0
  v_mul_f32 v90, v12, v90
  v_mul_f32 v91, v12, v91
  v_mfma_f32_16x16x32_bf16 v[76:79], v[28:31], v[184:187], 0
  v_mul_f32 v92, v12, v92
  v_mfma_f32_16x16x32_bf16 v[84:87], v[28:31], v[216:219], 0
  s_waitcnt lgkmcnt(5)
  v_mul_f32 v93, v12, v93
  v_mfma_f32_16x16x32_bf16 v[56:59], v[32:35], v[124:127], v[56:59]
  ds_read_b128 v[24:27], v252 offset:33024
  v_mul_f32 v94, v12, v94
  v_mfma_f32_16x16x32_bf16 v[64:67], v[32:35], v[156:159], v[64:67]
  v_mul_f32 v95, v12, v95
  v_cvt_pk_bf16_f32 v88, v88, v89
  v_mfma_f32_16x16x32_bf16 v[72:75], v[32:35], v[188:191], v[72:75]
  s_add_u32 m0, s29, 148480
  s_add_u32 s27, s28, 2375680
  buffer_load_dwordx4 v15, s[60:63], s27 offen lds
  v_mfma_f32_16x16x32_bf16 v[80:83], v[32:35], v[220:223], v[80:83]
  s_waitcnt lgkmcnt(5)
  v_cvt_pk_bf16_f32 v89, v90, v91
  v_mfma_f32_16x16x32_bf16 v[60:63], v[36:39], v[124:127], v[60:63]
  ds_read_b128 v[28:31], v252 offset:35072
  v_cvt_pk_bf16_f32 v90, v92, v93
  v_mfma_f32_16x16x32_bf16 v[68:71], v[36:39], v[156:159], v[68:71]
  v_cvt_pk_bf16_f32 v91, v94, v95
  v_accvgpr_write_b32 a20, v88
  v_mfma_f32_16x16x32_bf16 v[76:79], v[36:39], v[188:191], v[76:79]
  v_accvgpr_write_b32 a21, v89
  v_mfma_f32_16x16x32_bf16 v[84:87], v[36:39], v[220:223], v[84:87]
  s_waitcnt lgkmcnt(5)
  v_accvgpr_write_b32 a22, v90
  v_mfma_f32_16x16x32_bf16 v[56:59], v[40:43], v[128:131], v[56:59]
  ds_read_b128 v[32:35], v253 offset:33024
  v_accvgpr_write_b32 a23, v91
  v_mfma_f32_16x16x32_bf16 v[64:67], v[40:43], v[160:163], v[64:67]
  v_mul_f32 v96, v12, v96
  v_mul_f32 v97, v12, v97
  v_mfma_f32_16x16x32_bf16 v[72:75], v[40:43], v[192:195], v[72:75]
  s_add_u32 m0, s29, 149504
  s_add_u32 s27, s28, 2392064
  buffer_load_dwordx4 v14, s[60:63], s27 offen lds
  v_mfma_f32_16x16x32_bf16 v[80:83], v[40:43], v[224:227], v[80:83]
  s_waitcnt lgkmcnt(5)
  v_mul_f32 v98, v12, v98
  v_mfma_f32_16x16x32_bf16 v[60:63], v[44:47], v[128:131], v[60:63]
  ds_read_b128 v[36:39], v253 offset:35072
  v_mul_f32 v99, v12, v99
  v_mfma_f32_16x16x32_bf16 v[68:71], v[44:47], v[160:163], v[68:71]
  v_mul_f32 v100, v12, v100
  v_mul_f32 v101, v12, v101
  v_mfma_f32_16x16x32_bf16 v[76:79], v[44:47], v[192:195], v[76:79]
  v_mul_f32 v102, v12, v102
  v_mfma_f32_16x16x32_bf16 v[84:87], v[44:47], v[224:227], v[84:87]
  s_waitcnt lgkmcnt(5)
  v_mul_f32 v103, v12, v103
  v_mfma_f32_16x16x32_bf16 v[56:59], v[48:51], v[132:135], v[56:59]
  ds_read_b128 v[40:43], v254 offset:33024
  v_cvt_pk_bf16_f32 v96, v96, v97
  v_mfma_f32_16x16x32_bf16 v[64:67], v[48:51], v[164:167], v[64:67]
  v_cvt_pk_bf16_f32 v97, v98, v99
  v_cvt_pk_bf16_f32 v98, v100, v101
  v_mfma_f32_16x16x32_bf16 v[72:75], v[48:51], v[196:199], v[72:75]
  s_add_u32 m0, s29, 150528
  s_add_u32 s27, s28, 2408448
  buffer_load_dwordx4 v15, s[60:63], s27 offen lds
  v_mfma_f32_16x16x32_bf16 v[80:83], v[48:51], v[228:231], v[80:83]
  s_waitcnt lgkmcnt(5)
  v_cvt_pk_bf16_f32 v99, v102, v103
  v_mfma_f32_16x16x32_bf16 v[60:63], v[52:55], v[132:135], v[60:63]
  ds_read_b128 v[44:47], v254 offset:35072
  v_accvgpr_write_b32 a76, v96
  v_mfma_f32_16x16x32_bf16 v[68:71], v[52:55], v[164:167], v[68:71]
  v_accvgpr_write_b32 a77, v97
  v_accvgpr_write_b32 a78, v98
  v_mfma_f32_16x16x32_bf16 v[76:79], v[52:55], v[196:199], v[76:79]
  v_accvgpr_write_b32 a79, v99
  v_mfma_f32_16x16x32_bf16 v[84:87], v[52:55], v[228:231], v[84:87]
  s_waitcnt lgkmcnt(5)
  v_mul_f32 v104, v12, v104
  v_mfma_f32_16x16x32_bf16 v[56:59], v[24:27], v[136:139], v[56:59]
  ds_read_b128 v[48:51], v255 offset:33024
  v_mul_f32 v105, v12, v105
  v_mfma_f32_16x16x32_bf16 v[64:67], v[24:27], v[168:171], v[64:67]
  v_mul_f32 v106, v12, v106
  v_mul_f32 v107, v12, v107
  v_mfma_f32_16x16x32_bf16 v[72:75], v[24:27], v[200:203], v[72:75]
  v_mul_f32 v108, v12, v108
  v_mfma_f32_16x16x32_bf16 v[80:83], v[24:27], v[232:235], v[80:83]
  s_waitcnt lgkmcnt(5)
  v_mul_f32 v109, v12, v109
  v_mfma_f32_16x16x32_bf16 v[60:63], v[28:31], v[136:139], v[60:63]
  ds_read_b128 v[52:55], v255 offset:35072
  v_mul_f32 v110, v12, v110
  v_mfma_f32_16x16x32_bf16 v[68:71], v[28:31], v[168:171], v[68:71]
  v_mul_f32 v111, v12, v111
  v_cvt_pk_bf16_f32 v104, v104, v105
  v_mfma_f32_16x16x32_bf16 v[76:79], v[28:31], v[200:203], v[76:79]
  v_cvt_pk_bf16_f32 v105, v106, v107
  v_mfma_f32_16x16x32_bf16 v[84:87], v[28:31], v[232:235], v[84:87]
  s_waitcnt lgkmcnt(5)
  v_cvt_pk_bf16_f32 v106, v108, v109
  v_mfma_f32_16x16x32_bf16 v[56:59], v[32:35], v[140:143], v[56:59]
  s_waitcnt vmcnt(8)
  s_barrier
  ds_read_b128 v[24:27], v252 offset:49152
  v_cvt_pk_bf16_f32 v107, v110, v111
  v_mfma_f32_16x16x32_bf16 v[64:67], v[32:35], v[172:175], v[64:67]
  v_accvgpr_write_b32 a132, v104
  v_accvgpr_write_b32 a133, v105
  v_mfma_f32_16x16x32_bf16 v[72:75], v[32:35], v[204:207], v[72:75]
  v_accvgpr_write_b32 a134, v106
  v_mfma_f32_16x16x32_bf16 v[80:83], v[32:35], v[236:239], v[80:83]
  s_waitcnt lgkmcnt(5)
  v_accvgpr_write_b32 a135, v107
  v_mfma_f32_16x16x32_bf16 v[60:63], v[36:39], v[140:143], v[60:63]
  ds_read_b128 v[28:31], v252 offset:51200
  v_mul_f32 v112, v12, v112
  v_mfma_f32_16x16x32_bf16 v[68:71], v[36:39], v[172:175], v[68:71]
  v_mul_f32 v113, v12, v113
  v_mul_f32 v114, v12, v114
  v_mfma_f32_16x16x32_bf16 v[76:79], v[36:39], v[204:207], v[76:79]
  v_mul_f32 v115, v12, v115
  v_mfma_f32_16x16x32_bf16 v[84:87], v[36:39], v[236:239], v[84:87]
  s_waitcnt lgkmcnt(5)
  v_mul_f32 v116, v12, v116
  v_mfma_f32_16x16x32_bf16 v[56:59], v[40:43], v[144:147], v[56:59]
  ds_read_b128 v[32:35], v253 offset:49152
  v_mul_f32 v117, v12, v117
  v_mfma_f32_16x16x32_bf16 v[64:67], v[40:43], v[176:179], v[64:67]
  v_mul_f32 v118, v12, v118
  v_mul_f32 v119, v12, v119
  v_mfma_f32_16x16x32_bf16 v[72:75], v[40:43], v[208:211], v[72:75]
  v_cvt_pk_bf16_f32 v112, v112, v113
  v_mfma_f32_16x16x32_bf16 v[80:83], v[40:43], v[240:243], v[80:83]
  s_waitcnt lgkmcnt(5)
  v_cvt_pk_bf16_f32 v113, v114, v115
  v_mfma_f32_16x16x32_bf16 v[60:63], v[44:47], v[144:147], v[60:63]
  ds_read_b128 v[36:39], v253 offset:51200
  v_cvt_pk_bf16_f32 v114, v116, v117
  v_mfma_f32_16x16x32_bf16 v[68:71], v[44:47], v[176:179], v[68:71]
  v_cvt_pk_bf16_f32 v115, v118, v119
  v_accvgpr_write_b32 a188, v112
  v_mfma_f32_16x16x32_bf16 v[76:79], v[44:47], v[208:211], v[76:79]
  v_accvgpr_write_b32 a189, v113
  v_mfma_f32_16x16x32_bf16 v[84:87], v[44:47], v[240:243], v[84:87]
  s_waitcnt lgkmcnt(5)
  v_accvgpr_write_b32 a190, v114
  v_mfma_f32_16x16x32_bf16 v[56:59], v[48:51], v[148:151], v[56:59]
  ds_read_b128 v[40:43], v254 offset:49152
  v_accvgpr_write_b32 a191, v115
  v_mfma_f32_16x16x32_bf16 v[64:67], v[48:51], v[180:183], v[64:67]
  v_mfma_f32_16x16x32_bf16 v[72:75], v[48:51], v[212:215], v[72:75]
  v_mfma_f32_16x16x32_bf16 v[80:83], v[48:51], v[244:247], v[80:83]
  s_waitcnt lgkmcnt(5)
  v_mfma_f32_16x16x32_bf16 v[60:63], v[52:55], v[148:151], v[60:63]
  ds_read_b128 v[44:47], v254 offset:51200
  v_mfma_f32_16x16x32_bf16 v[68:71], v[52:55], v[180:183], v[68:71]
  v_mfma_f32_16x16x32_bf16 v[76:79], v[52:55], v[212:215], v[76:79]
  v_mfma_f32_16x16x32_bf16 v[84:87], v[52:55], v[244:247], v[84:87]
  s_waitcnt lgkmcnt(5)
  v_mfma_f32_16x16x32_bf16 v[88:91], v[24:27], v[120:123], 0
  ds_read_b128 v[48:51], v255 offset:49152
  v_mfma_f32_16x16x32_bf16 v[96:99], v[24:27], v[152:155], 0
  v_mfma_f32_16x16x32_bf16 v[104:107], v[24:27], v[184:187], 0
  s_add_u32 m0, s29, 0
  s_add_u32 s27, s28, 2621440
  buffer_load_dwordx4 v14, s[60:63], s27 offen lds
  v_mfma_f32_16x16x32_bf16 v[112:115], v[24:27], v[216:219], 0
  s_waitcnt lgkmcnt(5)
  v_mul_f32 v56, v12, v56
  v_mfma_f32_16x16x32_bf16 v[92:95], v[28:31], v[120:123], 0
  ds_read_b128 v[52:55], v255 offset:51200
  v_mul_f32 v57, v12, v57
  v_mfma_f32_16x16x32_bf16 v[100:103], v[28:31], v[152:155], 0
  v_mul_f32 v58, v12, v58
  v_mul_f32 v59, v12, v59
  v_mfma_f32_16x16x32_bf16 v[108:111], v[28:31], v[184:187], 0
  v_mul_f32 v60, v12, v60
  v_mfma_f32_16x16x32_bf16 v[116:119], v[28:31], v[216:219], 0
  s_waitcnt lgkmcnt(5)
  v_mul_f32 v61, v12, v61
  v_mfma_f32_16x16x32_bf16 v[88:91], v[32:35], v[124:127], v[88:91]
  ds_read_b128 v[24:27], v252 offset:49408
  v_mul_f32 v62, v12, v62
  v_mfma_f32_16x16x32_bf16 v[96:99], v[32:35], v[156:159], v[96:99]
  v_mul_f32 v63, v12, v63
  v_cvt_pk_bf16_f32 v56, v56, v57
  v_mfma_f32_16x16x32_bf16 v[104:107], v[32:35], v[188:191], v[104:107]
  s_add_u32 m0, s29, 1024
  s_add_u32 s27, s28, 2637824
  buffer_load_dwordx4 v15, s[60:63], s27 offen lds
  v_mfma_f32_16x16x32_bf16 v[112:115], v[32:35], v[220:223], v[112:115]
  s_waitcnt lgkmcnt(5)
  v_cvt_pk_bf16_f32 v57, v58, v59
  v_mfma_f32_16x16x32_bf16 v[92:95], v[36:39], v[124:127], v[92:95]
  ds_read_b128 v[28:31], v252 offset:51456
  v_cvt_pk_bf16_f32 v58, v60, v61
  v_mfma_f32_16x16x32_bf16 v[100:103], v[36:39], v[156:159], v[100:103]
  v_cvt_pk_bf16_f32 v59, v62, v63
  v_accvgpr_write_b32 a24, v56
  v_mfma_f32_16x16x32_bf16 v[108:111], v[36:39], v[188:191], v[108:111]
  v_accvgpr_write_b32 a25, v57
  v_mfma_f32_16x16x32_bf16 v[116:119], v[36:39], v[220:223], v[116:119]
  s_waitcnt lgkmcnt(5)
  v_accvgpr_write_b32 a26, v58
  v_mfma_f32_16x16x32_bf16 v[88:91], v[40:43], v[128:131], v[88:91]
  ds_read_b128 v[32:35], v253 offset:49408
  v_accvgpr_write_b32 a27, v59
  v_mfma_f32_16x16x32_bf16 v[96:99], v[40:43], v[160:163], v[96:99]
  v_mul_f32 v64, v12, v64
  v_mul_f32 v65, v12, v65
  v_mfma_f32_16x16x32_bf16 v[104:107], v[40:43], v[192:195], v[104:107]
  s_add_u32 m0, s29, 2048
  s_add_u32 s27, s28, 2654208
  buffer_load_dwordx4 v14, s[60:63], s27 offen lds
  v_mfma_f32_16x16x32_bf16 v[112:115], v[40:43], v[224:227], v[112:115]
  s_waitcnt lgkmcnt(5)
  v_mul_f32 v66, v12, v66
  v_mfma_f32_16x16x32_bf16 v[92:95], v[44:47], v[128:131], v[92:95]
  ds_read_b128 v[36:39], v253 offset:51456
  v_mul_f32 v67, v12, v67
  v_mfma_f32_16x16x32_bf16 v[100:103], v[44:47], v[160:163], v[100:103]
  v_mul_f32 v68, v12, v68
  v_mul_f32 v69, v12, v69
  v_mfma_f32_16x16x32_bf16 v[108:111], v[44:47], v[192:195], v[108:111]
  v_mul_f32 v70, v12, v70
  v_mfma_f32_16x16x32_bf16 v[116:119], v[44:47], v[224:227], v[116:119]
  s_waitcnt lgkmcnt(5)
  v_mul_f32 v71, v12, v71
  v_mfma_f32_16x16x32_bf16 v[88:91], v[48:51], v[132:135], v[88:91]
  ds_read_b128 v[40:43], v254 offset:49408
  v_cvt_pk_bf16_f32 v64, v64, v65
  v_mfma_f32_16x16x32_bf16 v[96:99], v[48:51], v[164:167], v[96:99]
  v_cvt_pk_bf16_f32 v65, v66, v67
  v_cvt_pk_bf16_f32 v66, v68, v69
  v_mfma_f32_16x16x32_bf16 v[104:107], v[48:51], v[196:199], v[104:107]
  s_add_u32 m0, s29, 3072
  s_add_u32 s27, s28, 2670592
  buffer_load_dwordx4 v15, s[60:63], s27 offen lds
  v_mfma_f32_16x16x32_bf16 v[112:115], v[48:51], v[228:231], v[112:115]
  s_waitcnt lgkmcnt(5)
  v_cvt_pk_bf16_f32 v67, v70, v71
  v_mfma_f32_16x16x32_bf16 v[92:95], v[52:55], v[132:135], v[92:95]
  ds_read_b128 v[44:47], v254 offset:51456
  v_accvgpr_write_b32 a80, v64
  v_mfma_f32_16x16x32_bf16 v[100:103], v[52:55], v[164:167], v[100:103]
  v_accvgpr_write_b32 a81, v65
  v_accvgpr_write_b32 a82, v66
  v_mfma_f32_16x16x32_bf16 v[108:111], v[52:55], v[196:199], v[108:111]
  v_accvgpr_write_b32 a83, v67
  v_mfma_f32_16x16x32_bf16 v[116:119], v[52:55], v[228:231], v[116:119]
  s_waitcnt lgkmcnt(5)
  v_mul_f32 v72, v12, v72
  v_mfma_f32_16x16x32_bf16 v[88:91], v[24:27], v[136:139], v[88:91]
  ds_read_b128 v[48:51], v255 offset:49408
  v_mul_f32 v73, v12, v73
  v_mfma_f32_16x16x32_bf16 v[96:99], v[24:27], v[168:171], v[96:99]
  v_mul_f32 v74, v12, v74
  v_mul_f32 v75, v12, v75
  v_mfma_f32_16x16x32_bf16 v[104:107], v[24:27], v[200:203], v[104:107]
  v_mul_f32 v76, v12, v76
  v_mfma_f32_16x16x32_bf16 v[112:115], v[24:27], v[232:235], v[112:115]
  s_waitcnt lgkmcnt(5)
  v_mul_f32 v77, v12, v77
  v_mfma_f32_16x16x32_bf16 v[92:95], v[28:31], v[136:139], v[92:95]
  ds_read_b128 v[52:55], v255 offset:51456
  v_mul_f32 v78, v12, v78
  v_mfma_f32_16x16x32_bf16 v[100:103], v[28:31], v[168:171], v[100:103]
  v_mul_f32 v79, v12, v79
  v_cvt_pk_bf16_f32 v72, v72, v73
  v_mfma_f32_16x16x32_bf16 v[108:111], v[28:31], v[200:203], v[108:111]
  v_cvt_pk_bf16_f32 v73, v74, v75
  v_mfma_f32_16x16x32_bf16 v[116:119], v[28:31], v[232:235], v[116:119]
  s_waitcnt lgkmcnt(5)
  v_cvt_pk_bf16_f32 v74, v76, v77
  v_mfma_f32_16x16x32_bf16 v[88:91], v[32:35], v[140:143], v[88:91]
  s_waitcnt vmcnt(8)
  s_barrier
  ds_read_b128 v[24:27], v16 offset:0
  v_cvt_pk_bf16_f32 v75, v78, v79
  v_mfma_f32_16x16x32_bf16 v[96:99], v[32:35], v[172:175], v[96:99]
  v_accvgpr_write_b32 a136, v72
  v_accvgpr_write_b32 a137, v73
  v_mfma_f32_16x16x32_bf16 v[104:107], v[32:35], v[204:207], v[104:107]
  v_accvgpr_write_b32 a138, v74
  v_mfma_f32_16x16x32_bf16 v[112:115], v[32:35], v[236:239], v[112:115]
  s_waitcnt lgkmcnt(5)
  v_accvgpr_write_b32 a139, v75
  v_mfma_f32_16x16x32_bf16 v[92:95], v[36:39], v[140:143], v[92:95]
  ds_read_b128 v[28:31], v16 offset:2048
  v_mul_f32 v80, v12, v80
  v_mfma_f32_16x16x32_bf16 v[100:103], v[36:39], v[172:175], v[100:103]
  v_mul_f32 v81, v12, v81
  v_mul_f32 v82, v12, v82
  v_mfma_f32_16x16x32_bf16 v[108:111], v[36:39], v[204:207], v[108:111]
  v_mul_f32 v83, v12, v83
  v_mfma_f32_16x16x32_bf16 v[116:119], v[36:39], v[236:239], v[116:119]
  s_waitcnt lgkmcnt(5)
  v_mul_f32 v84, v12, v84
  v_mfma_f32_16x16x32_bf16 v[88:91], v[40:43], v[144:147], v[88:91]
  ds_read_b128 v[32:35], v17 offset:0
  v_mul_f32 v85, v12, v85
  v_mfma_f32_16x16x32_bf16 v[96:99], v[40:43], v[176:179], v[96:99]
  v_mul_f32 v86, v12, v86
  v_mul_f32 v87, v12, v87
  v_mfma_f32_16x16x32_bf16 v[104:107], v[40:43], v[208:211], v[104:107]
  v_cvt_pk_bf16_f32 v80, v80, v81
  v_mfma_f32_16x16x32_bf16 v[112:115], v[40:43], v[240:243], v[112:115]
  s_waitcnt lgkmcnt(5)
  v_cvt_pk_bf16_f32 v81, v82, v83
  v_mfma_f32_16x16x32_bf16 v[92:95], v[44:47], v[144:147], v[92:95]
  ds_read_b128 v[36:39], v17 offset:2048
  v_cvt_pk_bf16_f32 v82, v84, v85
  v_mfma_f32_16x16x32_bf16 v[100:103], v[44:47], v[176:179], v[100:103]
  v_cvt_pk_bf16_f32 v83, v86, v87
  v_accvgpr_write_b32 a192, v80
  v_mfma_f32_16x16x32_bf16 v[108:111], v[44:47], v[208:211], v[108:111]
  v_accvgpr_write_b32 a193, v81
  v_mfma_f32_16x16x32_bf16 v[116:119], v[44:47], v[240:243], v[116:119]
  s_waitcnt lgkmcnt(5)
  v_accvgpr_write_b32 a194, v82
  v_mfma_f32_16x16x32_bf16 v[88:91], v[48:51], v[148:151], v[88:91]
  ds_read_b128 v[40:43], v18 offset:0
  v_accvgpr_write_b32 a195, v83
  v_mfma_f32_16x16x32_bf16 v[96:99], v[48:51], v[180:183], v[96:99]
  v_mfma_f32_16x16x32_bf16 v[104:107], v[48:51], v[212:215], v[104:107]
  v_mfma_f32_16x16x32_bf16 v[112:115], v[48:51], v[244:247], v[112:115]
  s_waitcnt lgkmcnt(5)
  v_mfma_f32_16x16x32_bf16 v[92:95], v[52:55], v[148:151], v[92:95]
  ds_read_b128 v[44:47], v18 offset:2048
  v_mfma_f32_16x16x32_bf16 v[100:103], v[52:55], v[180:183], v[100:103]
  v_mfma_f32_16x16x32_bf16 v[108:111], v[52:55], v[212:215], v[108:111]
  v_mfma_f32_16x16x32_bf16 v[116:119], v[52:55], v[244:247], v[116:119]
  s_waitcnt lgkmcnt(5)
  v_mfma_f32_16x16x32_bf16 v[56:59], v[24:27], v[120:123], 0
  ds_read_b128 v[48:51], v19 offset:0
  v_mfma_f32_16x16x32_bf16 v[64:67], v[24:27], v[152:155], 0
  v_mfma_f32_16x16x32_bf16 v[72:75], v[24:27], v[184:187], 0
  s_add_u32 m0, s29, 16384
  s_add_u32 s27, s28, 2883584
  buffer_load_dwordx4 v14, s[60:63], s27 offen lds
  v_mfma_f32_16x16x32_bf16 v[80:83], v[24:27], v[216:219], 0
  s_waitcnt lgkmcnt(5)
  v_mul_f32 v88, v12, v88
  v_mfma_f32_16x16x32_bf16 v[60:63], v[28:31], v[120:123], 0
  ds_read_b128 v[52:55], v19 offset:2048
  v_mul_f32 v89, v12, v89
  v_mfma_f32_16x16x32_bf16 v[68:71], v[28:31], v[152:155], 0
  v_mul_f32 v90, v12, v90
  v_mul_f32 v91, v12, v91
  v_mfma_f32_16x16x32_bf16 v[76:79], v[28:31], v[184:187], 0
  v_mul_f32 v92, v12, v92
  v_mfma_f32_16x16x32_bf16 v[84:87], v[28:31], v[216:219], 0
  s_waitcnt lgkmcnt(5)
  v_mul_f32 v93, v12, v93
  v_mfma_f32_16x16x32_bf16 v[56:59], v[32:35], v[124:127], v[56:59]
  ds_read_b128 v[24:27], v16 offset:256
  v_mul_f32 v94, v12, v94
  v_mfma_f32_16x16x32_bf16 v[64:67], v[32:35], v[156:159], v[64:67]
  v_mul_f32 v95, v12, v95
  v_cvt_pk_bf16_f32 v88, v88, v89
  v_mfma_f32_16x16x32_bf16 v[72:75], v[32:35], v[188:191], v[72:75]
  s_add_u32 m0, s29, 17408
  s_add_u32 s27, s28, 2899968
  buffer_load_dwordx4 v15, s[60:63], s27 offen lds
  v_mfma_f32_16x16x32_bf16 v[80:83], v[32:35], v[220:223], v[80:83]
  s_waitcnt lgkmcnt(5)
  v_cvt_pk_bf16_f32 v89, v90, v91
  v_mfma_f32_16x16x32_bf16 v[60:63], v[36:39], v[124:127], v[60:63]
  ds_read_b128 v[28:31], v16 offset:2304
  v_cvt_pk_bf16_f32 v90, v92, v93
  v_mfma_f32_16x16x32_bf16 v[68:71], v[36:39], v[156:159], v[68:71]
  v_cvt_pk_bf16_f32 v91, v94, v95
  v_accvgpr_write_b32 a28, v88
  v_mfma_f32_16x16x32_bf16 v[76:79], v[36:39], v[188:191], v[76:79]
  v_accvgpr_write_b32 a29, v89
  v_mfma_f32_16x16x32_bf16 v[84:87], v[36:39], v[220:223], v[84:87]
  s_waitcnt lgkmcnt(5)
  v_accvgpr_write_b32 a30, v90
  v_mfma_f32_16x16x32_bf16 v[56:59], v[40:43], v[128:131], v[56:59]
  ds_read_b128 v[32:35], v17 offset:256
  v_accvgpr_write_b32 a31, v91
  v_mfma_f32_16x16x32_bf16 v[64:67], v[40:43], v[160:163], v[64:67]
  v_mul_f32 v96, v12, v96
  v_mul_f32 v97, v12, v97
  v_mfma_f32_16x16x32_bf16 v[72:75], v[40:43], v[192:195], v[72:75]
  s_add_u32 m0, s29, 18432
  s_add_u32 s27, s28, 2916352
  buffer_load_dwordx4 v14, s[60:63], s27 offen lds
  v_mfma_f32_16x16x32_bf16 v[80:83], v[40:43], v[224:227], v[80:83]
  s_waitcnt lgkmcnt(5)
  v_mul_f32 v98, v12, v98
  v_mfma_f32_16x16x32_bf16 v[60:63], v[44:47], v[128:131], v[60:63]
  ds_read_b128 v[36:39], v17 offset:2304
  v_mul_f32 v99, v12, v99
  v_mfma_f32_16x16x32_bf16 v[68:71], v[44:47], v[160:163], v[68:71]
  v_mul_f32 v100, v12, v100
  v_mul_f32 v101, v12, v101
  v_mfma_f32_16x16x32_bf16 v[76:79], v[44:47], v[192:195], v[76:79]
  v_mul_f32 v102, v12, v102
  v_mfma_f32_16x16x32_bf16 v[84:87], v[44:47], v[224:227], v[84:87]
  s_waitcnt lgkmcnt(5)
  v_mul_f32 v103, v12, v103
  v_mfma_f32_16x16x32_bf16 v[56:59], v[48:51], v[132:135], v[56:59]
  ds_read_b128 v[40:43], v18 offset:256
  v_cvt_pk_bf16_f32 v96, v96, v97
  v_mfma_f32_16x16x32_bf16 v[64:67], v[48:51], v[164:167], v[64:67]
  v_cvt_pk_bf16_f32 v97, v98, v99
  v_cvt_pk_bf16_f32 v98, v100, v101
  v_mfma_f32_16x16x32_bf16 v[72:75], v[48:51], v[196:199], v[72:75]
  s_add_u32 m0, s29, 19456
  s_add_u32 s27, s28, 2932736
  buffer_load_dwordx4 v15, s[60:63], s27 offen lds
  v_mfma_f32_16x16x32_bf16 v[80:83], v[48:51], v[228:231], v[80:83]
  s_waitcnt lgkmcnt(5)
  v_cvt_pk_bf16_f32 v99, v102, v103
  v_mfma_f32_16x16x32_bf16 v[60:63], v[52:55], v[132:135], v[60:63]
  ds_read_b128 v[44:47], v18 offset:2304
  v_accvgpr_write_b32 a84, v96
  v_mfma_f32_16x16x32_bf16 v[68:71], v[52:55], v[164:167], v[68:71]
  v_accvgpr_write_b32 a85, v97
  v_accvgpr_write_b32 a86, v98
  v_mfma_f32_16x16x32_bf16 v[76:79], v[52:55], v[196:199], v[76:79]
  v_accvgpr_write_b32 a87, v99
  v_mfma_f32_16x16x32_bf16 v[84:87], v[52:55], v[228:231], v[84:87]
  s_waitcnt lgkmcnt(5)
  v_mul_f32 v104, v12, v104
  v_mfma_f32_16x16x32_bf16 v[56:59], v[24:27], v[136:139], v[56:59]
  ds_read_b128 v[48:51], v19 offset:256
  v_mul_f32 v105, v12, v105
  v_mfma_f32_16x16x32_bf16 v[64:67], v[24:27], v[168:171], v[64:67]
  v_mul_f32 v106, v12, v106
  v_mul_f32 v107, v12, v107
  v_mfma_f32_16x16x32_bf16 v[72:75], v[24:27], v[200:203], v[72:75]
  v_mul_f32 v108, v12, v108
  v_mfma_f32_16x16x32_bf16 v[80:83], v[24:27], v[232:235], v[80:83]
  s_waitcnt lgkmcnt(5)
  v_mul_f32 v109, v12, v109
  v_mfma_f32_16x16x32_bf16 v[60:63], v[28:31], v[136:139], v[60:63]
  ds_read_b128 v[52:55], v19 offset:2304
  v_mul_f32 v110, v12, v110
  v_mfma_f32_16x16x32_bf16 v[68:71], v[28:31], v[168:171], v[68:71]
  v_mul_f32 v111, v12, v111
  v_cvt_pk_bf16_f32 v104, v104, v105
  v_mfma_f32_16x16x32_bf16 v[76:79], v[28:31], v[200:203], v[76:79]
  v_cvt_pk_bf16_f32 v105, v106, v107
  v_mfma_f32_16x16x32_bf16 v[84:87], v[28:31], v[232:235], v[84:87]
  s_waitcnt lgkmcnt(5)
  v_cvt_pk_bf16_f32 v106, v108, v109
  v_mfma_f32_16x16x32_bf16 v[56:59], v[32:35], v[140:143], v[56:59]
  s_waitcnt vmcnt(8)
  s_barrier
  ds_read_b128 v[24:27], v16 offset:16384
  v_cvt_pk_bf16_f32 v107, v110, v111
  v_mfma_f32_16x16x32_bf16 v[64:67], v[32:35], v[172:175], v[64:67]
  v_accvgpr_write_b32 a140, v104
  v_accvgpr_write_b32 a141, v105
  v_mfma_f32_16x16x32_bf16 v[72:75], v[32:35], v[204:207], v[72:75]
  v_accvgpr_write_b32 a142, v106
  v_mfma_f32_16x16x32_bf16 v[80:83], v[32:35], v[236:239], v[80:83]
  s_waitcnt lgkmcnt(5)
  v_accvgpr_write_b32 a143, v107
  v_mfma_f32_16x16x32_bf16 v[60:63], v[36:39], v[140:143], v[60:63]
  ds_read_b128 v[28:31], v16 offset:18432
  v_mul_f32 v112, v12, v112
  v_mfma_f32_16x16x32_bf16 v[68:71], v[36:39], v[172:175], v[68:71]
  v_mul_f32 v113, v12, v113
  v_mul_f32 v114, v12, v114
  v_mfma_f32_16x16x32_bf16 v[76:79], v[36:39], v[204:207], v[76:79]
  v_mul_f32 v115, v12, v115
  v_mfma_f32_16x16x32_bf16 v[84:87], v[36:39], v[236:239], v[84:87]
  s_waitcnt lgkmcnt(5)
  v_mul_f32 v116, v12, v116
  v_mfma_f32_16x16x32_bf16 v[56:59], v[40:43], v[144:147], v[56:59]
  ds_read_b128 v[32:35], v17 offset:16384
  v_mul_f32 v117, v12, v117
  v_mfma_f32_16x16x32_bf16 v[64:67], v[40:43], v[176:179], v[64:67]
  v_mul_f32 v118, v12, v118
  v_mul_f32 v119, v12, v119
  v_mfma_f32_16x16x32_bf16 v[72:75], v[40:43], v[208:211], v[72:75]
  v_cvt_pk_bf16_f32 v112, v112, v113
  v_mfma_f32_16x16x32_bf16 v[80:83], v[40:43], v[240:243], v[80:83]
  s_waitcnt lgkmcnt(5)
  v_cvt_pk_bf16_f32 v113, v114, v115
  v_mfma_f32_16x16x32_bf16 v[60:63], v[44:47], v[144:147], v[60:63]
  ds_read_b128 v[36:39], v17 offset:18432
  v_cvt_pk_bf16_f32 v114, v116, v117
  v_mfma_f32_16x16x32_bf16 v[68:71], v[44:47], v[176:179], v[68:71]
  v_cvt_pk_bf16_f32 v115, v118, v119
  v_accvgpr_write_b32 a196, v112
  v_mfma_f32_16x16x32_bf16 v[76:79], v[44:47], v[208:211], v[76:79]
  v_accvgpr_write_b32 a197, v113
  v_mfma_f32_16x16x32_bf16 v[84:87], v[44:47], v[240:243], v[84:87]
  s_waitcnt lgkmcnt(5)
  v_accvgpr_write_b32 a198, v114
  v_mfma_f32_16x16x32_bf16 v[56:59], v[48:51], v[148:151], v[56:59]
  ds_read_b128 v[40:43], v18 offset:16384
  v_accvgpr_write_b32 a199, v115
  v_mfma_f32_16x16x32_bf16 v[64:67], v[48:51], v[180:183], v[64:67]
  v_mfma_f32_16x16x32_bf16 v[72:75], v[48:51], v[212:215], v[72:75]
  v_mfma_f32_16x16x32_bf16 v[80:83], v[48:51], v[244:247], v[80:83]
  s_waitcnt lgkmcnt(5)
  v_mfma_f32_16x16x32_bf16 v[60:63], v[52:55], v[148:151], v[60:63]
  ds_read_b128 v[44:47], v18 offset:18432
  v_mfma_f32_16x16x32_bf16 v[68:71], v[52:55], v[180:183], v[68:71]
  v_mfma_f32_16x16x32_bf16 v[76:79], v[52:55], v[212:215], v[76:79]
  v_mfma_f32_16x16x32_bf16 v[84:87], v[52:55], v[244:247], v[84:87]
  s_waitcnt lgkmcnt(5)
  s_getpc_b64 s[98:99]
  s_add_u32 s98, s98, 4096
  s_addc_u32 s99, s99, 0
  global_load_dword v7, v6, s[98:99]
  v_mfma_f32_16x16x32_bf16 v[88:91], v[24:27], v[120:123], 0
  ds_read_b128 v[48:51], v19 offset:16384
  v_mfma_f32_16x16x32_bf16 v[96:99], v[24:27], v[152:155], 0
  v_mfma_f32_16x16x32_bf16 v[104:107], v[24:27], v[184:187], 0
  s_add_u32 m0, s29, 32768
  s_add_u32 s27, s28, 3145728
  buffer_load_dwordx4 v14, s[60:63], s27 offen lds
  v_mfma_f32_16x16x32_bf16 v[112:115], v[24:27], v[216:219], 0
  s_waitcnt lgkmcnt(5)
  v_mul_f32 v56, v12, v56
  v_mfma_f32_16x16x32_bf16 v[92:95], v[28:31], v[120:123], 0
  ds_read_b128 v[52:55], v19 offset:18432
  v_mul_f32 v57, v12, v57
  v_mfma_f32_16x16x32_bf16 v[100:103], v[28:31], v[152:155], 0
  v_mul_f32 v58, v12, v58
  v_mul_f32 v59, v12, v59
  v_mfma_f32_16x16x32_bf16 v[108:111], v[28:31], v[184:187], 0
  v_mul_f32 v60, v12, v60
  v_mfma_f32_16x16x32_bf16 v[116:119], v[28:31], v[216:219], 0
  s_waitcnt lgkmcnt(5)
  v_mul_f32 v61, v12, v61
  v_mfma_f32_16x16x32_bf16 v[88:91], v[32:35], v[124:127], v[88:91]
  ds_read_b128 v[24:27], v16 offset:16640
  v_mul_f32 v62, v12, v62
  v_mfma_f32_16x16x32_bf16 v[96:99], v[32:35], v[156:159], v[96:99]
  v_mul_f32 v63, v12, v63
  v_cvt_pk_bf16_f32 v56, v56, v57
  v_mfma_f32_16x16x32_bf16 v[104:107], v[32:35], v[188:191], v[104:107]
  s_add_u32 m0, s29, 33792
  s_add_u32 s27, s28, 3162112
  buffer_load_dwordx4 v15, s[60:63], s27 offen lds
  v_mfma_f32_16x16x32_bf16 v[112:115], v[32:35], v[220:223], v[112:115]
  s_waitcnt lgkmcnt(5)
  v_cvt_pk_bf16_f32 v57, v58, v59
  v_mfma_f32_16x16x32_bf16 v[92:95], v[36:39], v[124:127], v[92:95]
  ds_read_b128 v[28:31], v16 offset:18688
  v_cvt_pk_bf16_f32 v58, v60, v61
  v_mfma_f32_16x16x32_bf16 v[100:103], v[36:39], v[156:159], v[100:103]
  v_cvt_pk_bf16_f32 v59, v62, v63
  v_accvgpr_write_b32 a32, v56
  v_mfma_f32_16x16x32_bf16 v[108:111], v[36:39], v[188:191], v[108:111]
  v_accvgpr_write_b32 a33, v57
  v_mfma_f32_16x16x32_bf16 v[116:119], v[36:39], v[220:223], v[116:119]
  s_waitcnt lgkmcnt(5)
  v_accvgpr_write_b32 a34, v58
  v_mfma_f32_16x16x32_bf16 v[88:91], v[40:43], v[128:131], v[88:91]
  ds_read_b128 v[32:35], v17 offset:16640
  v_accvgpr_write_b32 a35, v59
  v_mfma_f32_16x16x32_bf16 v[96:99], v[40:43], v[160:163], v[96:99]
  v_mul_f32 v64, v12, v64
  v_mul_f32 v65, v12, v65
  v_mfma_f32_16x16x32_bf16 v[104:107], v[40:43], v[192:195], v[104:107]
  s_add_u32 m0, s29, 34816
  s_add_u32 s27, s28, 3178496
  buffer_load_dwordx4 v14, s[60:63], s27 offen lds
  v_mfma_f32_16x16x32_bf16 v[112:115], v[40:43], v[224:227], v[112:115]
  s_waitcnt lgkmcnt(5)
  v_mul_f32 v66, v12, v66
  v_mfma_f32_16x16x32_bf16 v[92:95], v[44:47], v[128:131], v[92:95]
  ds_read_b128 v[36:39], v17 offset:18688
  v_mul_f32 v67, v12, v67
  v_mfma_f32_16x16x32_bf16 v[100:103], v[44:47], v[160:163], v[100:103]
  v_mul_f32 v68, v12, v68
  v_mul_f32 v69, v12, v69
  v_mfma_f32_16x16x32_bf16 v[108:111], v[44:47], v[192:195], v[108:111]
  v_mul_f32 v70, v12, v70
  v_mfma_f32_16x16x32_bf16 v[116:119], v[44:47], v[224:227], v[116:119]
  s_waitcnt lgkmcnt(5)
  v_mul_f32 v71, v12, v71
  v_mfma_f32_16x16x32_bf16 v[88:91], v[48:51], v[132:135], v[88:91]
  ds_read_b128 v[40:43], v18 offset:16640
  v_cvt_pk_bf16_f32 v64, v64, v65
  v_mfma_f32_16x16x32_bf16 v[96:99], v[48:51], v[164:167], v[96:99]
  v_cvt_pk_bf16_f32 v65, v66, v67
  v_cvt_pk_bf16_f32 v66, v68, v69
  v_mfma_f32_16x16x32_bf16 v[104:107], v[48:51], v[196:199], v[104:107]
  s_add_u32 m0, s29, 35840
  s_add_u32 s27, s28, 3194880
  buffer_load_dwordx4 v15, s[60:63], s27 offen lds
  v_mfma_f32_16x16x32_bf16 v[112:115], v[48:51], v[228:231], v[112:115]
  s_waitcnt lgkmcnt(5)
  v_cvt_pk_bf16_f32 v67, v70, v71
  v_mfma_f32_16x16x32_bf16 v[92:95], v[52:55], v[132:135], v[92:95]
  ds_read_b128 v[44:47], v18 offset:18688
  v_accvgpr_write_b32 a88, v64
  v_mfma_f32_16x16x32_bf16 v[100:103], v[52:55], v[164:167], v[100:103]
  v_accvgpr_write_b32 a89, v65
  v_accvgpr_write_b32 a90, v66
  v_mfma_f32_16x16x32_bf16 v[108:111], v[52:55], v[196:199], v[108:111]
  v_accvgpr_write_b32 a91, v67
  v_mfma_f32_16x16x32_bf16 v[116:119], v[52:55], v[228:231], v[116:119]
  s_waitcnt lgkmcnt(5)
  v_mul_f32 v72, v12, v72
  v_mfma_f32_16x16x32_bf16 v[88:91], v[24:27], v[136:139], v[88:91]
  ds_read_b128 v[48:51], v19 offset:16640
  v_mul_f32 v73, v12, v73
  v_mfma_f32_16x16x32_bf16 v[96:99], v[24:27], v[168:171], v[96:99]
  v_mul_f32 v74, v12, v74
  v_mul_f32 v75, v12, v75
  v_mfma_f32_16x16x32_bf16 v[104:107], v[24:27], v[200:203], v[104:107]
  v_mul_f32 v76, v12, v76
  v_mfma_f32_16x16x32_bf16 v[112:115], v[24:27], v[232:235], v[112:115]
  s_waitcnt lgkmcnt(5)
  v_mul_f32 v77, v12, v77
  v_mfma_f32_16x16x32_bf16 v[92:95], v[28:31], v[136:139], v[92:95]
  ds_read_b128 v[52:55], v19 offset:18688
  v_mul_f32 v78, v12, v78
  v_mfma_f32_16x16x32_bf16 v[100:103], v[28:31], v[168:171], v[100:103]
  v_mul_f32 v79, v12, v79
  v_cvt_pk_bf16_f32 v72, v72, v73
  v_mfma_f32_16x16x32_bf16 v[108:111], v[28:31], v[200:203], v[108:111]
  v_cvt_pk_bf16_f32 v73, v74, v75
  v_mfma_f32_16x16x32_bf16 v[116:119], v[28:31], v[232:235], v[116:119]
  s_waitcnt lgkmcnt(5)
  v_cvt_pk_bf16_f32 v74, v76, v77
  v_mfma_f32_16x16x32_bf16 v[88:91], v[32:35], v[140:143], v[88:91]
  s_waitcnt vmcnt(8)
  s_barrier
  ds_read_b128 v[24:27], v248 offset:0
  v_cvt_pk_bf16_f32 v75, v78, v79
  v_mfma_f32_16x16x32_bf16 v[96:99], v[32:35], v[172:175], v[96:99]
  v_accvgpr_write_b32 a144, v72
  v_accvgpr_write_b32 a145, v73
  v_mfma_f32_16x16x32_bf16 v[104:107], v[32:35], v[204:207], v[104:107]
  v_accvgpr_write_b32 a146, v74
  v_mfma_f32_16x16x32_bf16 v[112:115], v[32:35], v[236:239], v[112:115]
  s_waitcnt lgkmcnt(5)
  v_accvgpr_write_b32 a147, v75
  v_mfma_f32_16x16x32_bf16 v[92:95], v[36:39], v[140:143], v[92:95]
  ds_read_b128 v[28:31], v248 offset:2048
  v_mul_f32 v80, v12, v80
  v_mfma_f32_16x16x32_bf16 v[100:103], v[36:39], v[172:175], v[100:103]
  v_mul_f32 v81, v12, v81
  v_mul_f32 v82, v12, v82
  v_mfma_f32_16x16x32_bf16 v[108:111], v[36:39], v[204:207], v[108:111]
  v_mul_f32 v83, v12, v83
  v_mfma_f32_16x16x32_bf16 v[116:119], v[36:39], v[236:239], v[116:119]
  s_waitcnt lgkmcnt(5)
  v_mul_f32 v84, v12, v84
  v_mfma_f32_16x16x32_bf16 v[88:91], v[40:43], v[144:147], v[88:91]
  ds_read_b128 v[32:35], v249 offset:0
  v_mul_f32 v85, v12, v85
  v_mfma_f32_16x16x32_bf16 v[96:99], v[40:43], v[176:179], v[96:99]
  v_mul_f32 v86, v12, v86
  v_mul_f32 v87, v12, v87
  v_mfma_f32_16x16x32_bf16 v[104:107], v[40:43], v[208:211], v[104:107]
  v_cvt_pk_bf16_f32 v80, v80, v81
  v_mfma_f32_16x16x32_bf16 v[112:115], v[40:43], v[240:243], v[112:115]
  s_waitcnt lgkmcnt(5)
  v_cvt_pk_bf16_f32 v81, v82, v83
  v_mfma_f32_16x16x32_bf16 v[92:95], v[44:47], v[144:147], v[92:95]
  ds_read_b128 v[36:39], v249 offset:2048
  v_cvt_pk_bf16_f32 v82, v84, v85
  v_mfma_f32_16x16x32_bf16 v[100:103], v[44:47], v[176:179], v[100:103]
  v_cvt_pk_bf16_f32 v83, v86, v87
  v_accvgpr_write_b32 a200, v80
  v_mfma_f32_16x16x32_bf16 v[108:111], v[44:47], v[208:211], v[108:111]
  v_accvgpr_write_b32 a201, v81
  v_mfma_f32_16x16x32_bf16 v[116:119], v[44:47], v[240:243], v[116:119]
  s_waitcnt lgkmcnt(5)
  v_accvgpr_write_b32 a202, v82
  v_mfma_f32_16x16x32_bf16 v[88:91], v[48:51], v[148:151], v[88:91]
  ds_read_b128 v[40:43], v250 offset:0
  v_accvgpr_write_b32 a203, v83
  v_mfma_f32_16x16x32_bf16 v[96:99], v[48:51], v[180:183], v[96:99]
  v_mfma_f32_16x16x32_bf16 v[104:107], v[48:51], v[212:215], v[104:107]
  v_mfma_f32_16x16x32_bf16 v[112:115], v[48:51], v[244:247], v[112:115]
  s_waitcnt lgkmcnt(5)
  v_mfma_f32_16x16x32_bf16 v[92:95], v[52:55], v[148:151], v[92:95]
  ds_read_b128 v[44:47], v250 offset:2048
  v_mfma_f32_16x16x32_bf16 v[100:103], v[52:55], v[180:183], v[100:103]
  v_mfma_f32_16x16x32_bf16 v[108:111], v[52:55], v[212:215], v[108:111]
  v_mfma_f32_16x16x32_bf16 v[116:119], v[52:55], v[244:247], v[116:119]
  s_waitcnt lgkmcnt(5)
  v_mfma_f32_16x16x32_bf16 v[56:59], v[24:27], v[120:123], 0
  ds_read_b128 v[48:51], v251 offset:0
  v_mfma_f32_16x16x32_bf16 v[64:67], v[24:27], v[152:155], 0
  v_mfma_f32_16x16x32_bf16 v[72:75], v[24:27], v[184:187], 0
  s_add_u32 m0, s29, 49152
  s_add_u32 s27, s28, 3407872
  buffer_load_dwordx4 v14, s[60:63], s27 offen lds
  v_mfma_f32_16x16x32_bf16 v[80:83], v[24:27], v[216:219], 0
  s_waitcnt lgkmcnt(5)
  v_mul_f32 v88, v12, v88
  v_mfma_f32_16x16x32_bf16 v[60:63], v[28:31], v[120:123], 0
  ds_read_b128 v[52:55], v251 offset:2048
  v_mul_f32 v89, v12, v89
  v_mfma_f32_16x16x32_bf16 v[68:71], v[28:31], v[152:155], 0
  v_mul_f32 v90, v12, v90
  v_mul_f32 v91, v12, v91
  v_mfma_f32_16x16x32_bf16 v[76:79], v[28:31], v[184:187], 0
  v_mul_f32 v92, v12, v92
  v_mfma_f32_16x16x32_bf16 v[84:87], v[28:31], v[216:219], 0
  s_waitcnt lgkmcnt(5)
  v_mul_f32 v93, v12, v93
  v_mfma_f32_16x16x32_bf16 v[56:59], v[32:35], v[124:127], v[56:59]
  ds_read_b128 v[24:27], v248 offset:256
  v_mul_f32 v94, v12, v94
  v_mfma_f32_16x16x32_bf16 v[64:67], v[32:35], v[156:159], v[64:67]
  v_mul_f32 v95, v12, v95
  v_cvt_pk_bf16_f32 v88, v88, v89
  v_mfma_f32_16x16x32_bf16 v[72:75], v[32:35], v[188:191], v[72:75]
  s_add_u32 m0, s29, 50176
  s_add_u32 s27, s28, 3424256
  buffer_load_dwordx4 v15, s[60:63], s27 offen lds
  v_mfma_f32_16x16x32_bf16 v[80:83], v[32:35], v[220:223], v[80:83]
  s_waitcnt lgkmcnt(5)
  v_cvt_pk_bf16_f32 v89, v90, v91
  v_mfma_f32_16x16x32_bf16 v[60:63], v[36:39], v[124:127], v[60:63]
  ds_read_b128 v[28:31], v248 offset:2304
  v_cvt_pk_bf16_f32 v90, v92, v93
  v_mfma_f32_16x16x32_bf16 v[68:71], v[36:39], v[156:159], v[68:71]
  v_cvt_pk_bf16_f32 v91, v94, v95
  v_accvgpr_write_b32 a36, v88
  v_mfma_f32_16x16x32_bf16 v[76:79], v[36:39], v[188:191], v[76:79]
  v_accvgpr_write_b32 a37, v89
  v_mfma_f32_16x16x32_bf16 v[84:87], v[36:39], v[220:223], v[84:87]
  s_waitcnt lgkmcnt(5)
  v_accvgpr_write_b32 a38, v90
  v_mfma_f32_16x16x32_bf16 v[56:59], v[40:43], v[128:131], v[56:59]
  ds_read_b128 v[32:35], v249 offset:256
  v_accvgpr_write_b32 a39, v91
  v_mfma_f32_16x16x32_bf16 v[64:67], v[40:43], v[160:163], v[64:67]
  v_mul_f32 v96, v12, v96
  v_mul_f32 v97, v12, v97
  v_mfma_f32_16x16x32_bf16 v[72:75], v[40:43], v[192:195], v[72:75]
  s_add_u32 m0, s29, 51200
  s_add_u32 s27, s28, 3440640
  buffer_load_dwordx4 v14, s[60:63], s27 offen lds
  v_mfma_f32_16x16x32_bf16 v[80:83], v[40:43], v[224:227], v[80:83]
  s_waitcnt lgkmcnt(5)
  v_mul_f32 v98, v12, v98
  v_mfma_f32_16x16x32_bf16 v[60:63], v[44:47], v[128:131], v[60:63]
  ds_read_b128 v[36:39], v249 offset:2304
  v_mul_f32 v99, v12, v99
  v_mfma_f32_16x16x32_bf16 v[68:71], v[44:47], v[160:163], v[68:71]
  v_mul_f32 v100, v12, v100
  v_mul_f32 v101, v12, v101
  v_mfma_f32_16x16x32_bf16 v[76:79], v[44:47], v[192:195], v[76:79]
  v_mul_f32 v102, v12, v102
  v_mfma_f32_16x16x32_bf16 v[84:87], v[44:47], v[224:227], v[84:87]
  s_waitcnt lgkmcnt(5)
  v_mul_f32 v103, v12, v103
  v_mfma_f32_16x16x32_bf16 v[56:59], v[48:51], v[132:135], v[56:59]
  ds_read_b128 v[40:43], v250 offset:256
  v_cvt_pk_bf16_f32 v96, v96, v97
  v_mfma_f32_16x16x32_bf16 v[64:67], v[48:51], v[164:167], v[64:67]
  v_cvt_pk_bf16_f32 v97, v98, v99
  v_cvt_pk_bf16_f32 v98, v100, v101
  v_mfma_f32_16x16x32_bf16 v[72:75], v[48:51], v[196:199], v[72:75]
  s_add_u32 m0, s29, 52224
  s_add_u32 s27, s28, 3457024
  buffer_load_dwordx4 v15, s[60:63], s27 offen lds
  v_mfma_f32_16x16x32_bf16 v[80:83], v[48:51], v[228:231], v[80:83]
  s_waitcnt lgkmcnt(5)
  v_cvt_pk_bf16_f32 v99, v102, v103
  v_mfma_f32_16x16x32_bf16 v[60:63], v[52:55], v[132:135], v[60:63]
  ds_read_b128 v[44:47], v250 offset:2304
  v_accvgpr_write_b32 a92, v96
  v_mfma_f32_16x16x32_bf16 v[68:71], v[52:55], v[164:167], v[68:71]
  v_accvgpr_write_b32 a93, v97
  v_accvgpr_write_b32 a94, v98
  v_mfma_f32_16x16x32_bf16 v[76:79], v[52:55], v[196:199], v[76:79]
  v_accvgpr_write_b32 a95, v99
  v_mfma_f32_16x16x32_bf16 v[84:87], v[52:55], v[228:231], v[84:87]
  s_waitcnt lgkmcnt(5)
  v_mul_f32 v104, v12, v104
  v_mfma_f32_16x16x32_bf16 v[56:59], v[24:27], v[136:139], v[56:59]
  ds_read_b128 v[48:51], v251 offset:256
  v_mul_f32 v105, v12, v105
  v_mfma_f32_16x16x32_bf16 v[64:67], v[24:27], v[168:171], v[64:67]
  v_mul_f32 v106, v12, v106
  v_mul_f32 v107, v12, v107
  v_mfma_f32_16x16x32_bf16 v[72:75], v[24:27], v[200:203], v[72:75]
  v_mul_f32 v108, v12, v108
  v_mfma_f32_16x16x32_bf16 v[80:83], v[24:27], v[232:235], v[80:83]
  s_waitcnt lgkmcnt(5)
  v_mul_f32 v109, v12, v109
  v_mfma_f32_16x16x32_bf16 v[60:63], v[28:31], v[136:139], v[60:63]
  ds_read_b128 v[52:55], v251 offset:2304
  v_mul_f32 v110, v12, v110
  v_mfma_f32_16x16x32_bf16 v[68:71], v[28:31], v[168:171], v[68:71]
  v_mul_f32 v111, v12, v111
  v_cvt_pk_bf16_f32 v104, v104, v105
  v_mfma_f32_16x16x32_bf16 v[76:79], v[28:31], v[200:203], v[76:79]
  v_cvt_pk_bf16_f32 v105, v106, v107
  v_mfma_f32_16x16x32_bf16 v[84:87], v[28:31], v[232:235], v[84:87]
  s_waitcnt lgkmcnt(5)
  v_cvt_pk_bf16_f32 v106, v108, v109
  v_mfma_f32_16x16x32_bf16 v[56:59], v[32:35], v[140:143], v[56:59]
  s_waitcnt vmcnt(8)
  s_barrier
  ds_read_b128 v[24:27], v248 offset:16384
  v_cvt_pk_bf16_f32 v107, v110, v111
  v_mfma_f32_16x16x32_bf16 v[64:67], v[32:35], v[172:175], v[64:67]
  v_accvgpr_write_b32 a148, v104
  v_accvgpr_write_b32 a149, v105
  v_mfma_f32_16x16x32_bf16 v[72:75], v[32:35], v[204:207], v[72:75]
  v_accvgpr_write_b32 a150, v106
  v_mfma_f32_16x16x32_bf16 v[80:83], v[32:35], v[236:239], v[80:83]
  s_waitcnt lgkmcnt(5)
  v_accvgpr_write_b32 a151, v107
  v_mfma_f32_16x16x32_bf16 v[60:63], v[36:39], v[140:143], v[60:63]
  ds_read_b128 v[28:31], v248 offset:18432
  v_mul_f32 v112, v12, v112
  v_mfma_f32_16x16x32_bf16 v[68:71], v[36:39], v[172:175], v[68:71]
  v_mul_f32 v113, v12, v113
  v_mul_f32 v114, v12, v114
  v_mfma_f32_16x16x32_bf16 v[76:79], v[36:39], v[204:207], v[76:79]
  v_mul_f32 v115, v12, v115
  v_mfma_f32_16x16x32_bf16 v[84:87], v[36:39], v[236:239], v[84:87]
  s_waitcnt lgkmcnt(5)
  v_mul_f32 v116, v12, v116
  v_mfma_f32_16x16x32_bf16 v[56:59], v[40:43], v[144:147], v[56:59]
  ds_read_b128 v[32:35], v249 offset:16384
  v_mul_f32 v117, v12, v117
  v_mfma_f32_16x16x32_bf16 v[64:67], v[40:43], v[176:179], v[64:67]
  v_mul_f32 v118, v12, v118
  v_mul_f32 v119, v12, v119
  v_mfma_f32_16x16x32_bf16 v[72:75], v[40:43], v[208:211], v[72:75]
  v_cvt_pk_bf16_f32 v112, v112, v113
  v_mfma_f32_16x16x32_bf16 v[80:83], v[40:43], v[240:243], v[80:83]
  s_waitcnt lgkmcnt(5)
  v_cvt_pk_bf16_f32 v113, v114, v115
  v_mfma_f32_16x16x32_bf16 v[60:63], v[44:47], v[144:147], v[60:63]
  ds_read_b128 v[36:39], v249 offset:18432
  v_cvt_pk_bf16_f32 v114, v116, v117
  v_mfma_f32_16x16x32_bf16 v[68:71], v[44:47], v[176:179], v[68:71]
  v_cvt_pk_bf16_f32 v115, v118, v119
  v_accvgpr_write_b32 a204, v112
  v_mfma_f32_16x16x32_bf16 v[76:79], v[44:47], v[208:211], v[76:79]
  v_accvgpr_write_b32 a205, v113
  v_mfma_f32_16x16x32_bf16 v[84:87], v[44:47], v[240:243], v[84:87]
  s_waitcnt lgkmcnt(5)
  v_accvgpr_write_b32 a206, v114
  v_mfma_f32_16x16x32_bf16 v[56:59], v[48:51], v[148:151], v[56:59]
  ds_read_b128 v[40:43], v250 offset:16384
  v_accvgpr_write_b32 a207, v115
  v_mfma_f32_16x16x32_bf16 v[64:67], v[48:51], v[180:183], v[64:67]
  v_mfma_f32_16x16x32_bf16 v[72:75], v[48:51], v[212:215], v[72:75]
  v_mfma_f32_16x16x32_bf16 v[80:83], v[48:51], v[244:247], v[80:83]
  s_waitcnt lgkmcnt(5)
  v_mfma_f32_16x16x32_bf16 v[60:63], v[52:55], v[148:151], v[60:63]
  ds_read_b128 v[44:47], v250 offset:18432
  v_mfma_f32_16x16x32_bf16 v[68:71], v[52:55], v[180:183], v[68:71]
  v_mfma_f32_16x16x32_bf16 v[76:79], v[52:55], v[212:215], v[76:79]
  v_mfma_f32_16x16x32_bf16 v[84:87], v[52:55], v[244:247], v[84:87]
  s_waitcnt lgkmcnt(5)
  v_mfma_f32_16x16x32_bf16 v[88:91], v[24:27], v[120:123], 0
  ds_read_b128 v[48:51], v251 offset:16384
  v_mfma_f32_16x16x32_bf16 v[96:99], v[24:27], v[152:155], 0
  v_mfma_f32_16x16x32_bf16 v[104:107], v[24:27], v[184:187], 0
  buffer_load_dword v13, off, s[12:15], 0 offset:132 sc1
  v_mfma_f32_16x16x32_bf16 v[112:115], v[24:27], v[216:219], 0
  s_waitcnt lgkmcnt(5)
  v_mul_f32 v56, v12, v56
  v_mfma_f32_16x16x32_bf16 v[92:95], v[28:31], v[120:123], 0
  ds_read_b128 v[52:55], v251 offset:18432
  v_mul_f32 v57, v12, v57
  v_mfma_f32_16x16x32_bf16 v[100:103], v[28:31], v[152:155], 0
  v_mul_f32 v58, v12, v58
  v_mul_f32 v59, v12, v59
  v_mfma_f32_16x16x32_bf16 v[108:111], v[28:31], v[184:187], 0
  v_mul_f32 v60, v12, v60
  v_mfma_f32_16x16x32_bf16 v[116:119], v[28:31], v[216:219], 0
  s_waitcnt lgkmcnt(5)
  v_mul_f32 v61, v12, v61
  v_mfma_f32_16x16x32_bf16 v[88:91], v[32:35], v[124:127], v[88:91]
  ds_read_b128 v[24:27], v248 offset:16640
  v_mul_f32 v62, v12, v62
  v_mfma_f32_16x16x32_bf16 v[96:99], v[32:35], v[156:159], v[96:99]
  v_mul_f32 v63, v12, v63
  v_cvt_pk_bf16_f32 v56, v56, v57
  v_mfma_f32_16x16x32_bf16 v[104:107], v[32:35], v[188:191], v[104:107]
  v_cvt_pk_bf16_f32 v57, v58, v59
  v_mfma_f32_16x16x32_bf16 v[112:115], v[32:35], v[220:223], v[112:115]
  s_waitcnt lgkmcnt(5)
  v_cvt_pk_bf16_f32 v58, v60, v61
  v_mfma_f32_16x16x32_bf16 v[92:95], v[36:39], v[124:127], v[92:95]
  ds_read_b128 v[28:31], v248 offset:18688
  v_cvt_pk_bf16_f32 v59, v62, v63
  v_mfma_f32_16x16x32_bf16 v[100:103], v[36:39], v[156:159], v[100:103]
  v_accvgpr_write_b32 a40, v56
  v_accvgpr_write_b32 a41, v57
  v_mfma_f32_16x16x32_bf16 v[108:111], v[36:39], v[188:191], v[108:111]
  v_accvgpr_write_b32 a42, v58
  v_mfma_f32_16x16x32_bf16 v[116:119], v[36:39], v[220:223], v[116:119]
  s_waitcnt lgkmcnt(5)
  v_accvgpr_write_b32 a43, v59
  v_mfma_f32_16x16x32_bf16 v[88:91], v[40:43], v[128:131], v[88:91]
  ds_read_b128 v[32:35], v249 offset:16640
  v_mul_f32 v64, v12, v64
  v_mfma_f32_16x16x32_bf16 v[96:99], v[40:43], v[160:163], v[96:99]
  v_mul_f32 v65, v12, v65
  v_mul_f32 v66, v12, v66
  v_mfma_f32_16x16x32_bf16 v[104:107], v[40:43], v[192:195], v[104:107]
  v_mul_f32 v67, v12, v67
  v_mfma_f32_16x16x32_bf16 v[112:115], v[40:43], v[224:227], v[112:115]
  s_waitcnt lgkmcnt(5)
  v_mul_f32 v68, v12, v68
  v_mfma_f32_16x16x32_bf16 v[92:95], v[44:47], v[128:131], v[92:95]
  ds_read_b128 v[36:39], v249 offset:18688
  v_mul_f32 v69, v12, v69
  v_mfma_f32_16x16x32_bf16 v[100:103], v[44:47], v[160:163], v[100:103]
  v_mul_f32 v70, v12, v70
  v_mul_f32 v71, v12, v71
  v_mfma_f32_16x16x32_bf16 v[108:111], v[44:47], v[192:195], v[108:111]
  v_cvt_pk_bf16_f32 v64, v64, v65
  v_mfma_f32_16x16x32_bf16 v[116:119], v[44:47], v[224:227], v[116:119]
  s_waitcnt lgkmcnt(5)
  v_cvt_pk_bf16_f32 v65, v66, v67
  v_mfma_f32_16x16x32_bf16 v[88:91], v[48:51], v[132:135], v[88:91]
  ds_read_b128 v[40:43], v250 offset:16640
  v_cvt_pk_bf16_f32 v66, v68, v69
  v_mfma_f32_16x16x32_bf16 v[96:99], v[48:51], v[164:167], v[96:99]
  v_cvt_pk_bf16_f32 v67, v70, v71
  v_accvgpr_write_b32 a96, v64
  v_mfma_f32_16x16x32_bf16 v[104:107], v[48:51], v[196:199], v[104:107]
  v_accvgpr_write_b32 a97, v65
  v_mfma_f32_16x16x32_bf16 v[112:115], v[48:51], v[228:231], v[112:115]
  s_waitcnt lgkmcnt(5)
  v_accvgpr_write_b32 a98, v66
  v_mfma_f32_16x16x32_bf16 v[92:95], v[52:55], v[132:135], v[92:95]
  ds_read_b128 v[44:47], v250 offset:18688
  v_accvgpr_write_b32 a99, v67
  v_mfma_f32_16x16x32_bf16 v[100:103], v[52:55], v[164:167], v[100:103]
  v_mul_f32 v72, v12, v72
  v_mul_f32 v73, v12, v73
  v_mfma_f32_16x16x32_bf16 v[108:111], v[52:55], v[196:199], v[108:111]
  v_mul_f32 v74, v12, v74
  v_mfma_f32_16x16x32_bf16 v[116:119], v[52:55], v[228:231], v[116:119]
  s_waitcnt lgkmcnt(5)
  v_mul_f32 v75, v12, v75
  v_mfma_f32_16x16x32_bf16 v[88:91], v[24:27], v[136:139], v[88:91]
  ds_read_b128 v[48:51], v251 offset:16640
  v_mul_f32 v76, v12, v76
  v_mfma_f32_16x16x32_bf16 v[96:99], v[24:27], v[168:171], v[96:99]
  v_mul_f32 v77, v12, v77
  v_mul_f32 v78, v12, v78
  v_mfma_f32_16x16x32_bf16 v[104:107], v[24:27], v[200:203], v[104:107]
  v_mul_f32 v79, v12, v79
  v_mfma_f32_16x16x32_bf16 v[112:115], v[24:27], v[232:235], v[112:115]
  s_waitcnt lgkmcnt(5)
  v_cvt_pk_bf16_f32 v72, v72, v73
  v_mfma_f32_16x16x32_bf16 v[92:95], v[28:31], v[136:139], v[92:95]
  ds_read_b128 v[52:55], v251 offset:18688
  v_cvt_pk_bf16_f32 v73, v74, v75
  v_mfma_f32_16x16x32_bf16 v[100:103], v[28:31], v[168:171], v[100:103]
  v_cvt_pk_bf16_f32 v74, v76, v77
  v_cvt_pk_bf16_f32 v75, v78, v79
  v_mfma_f32_16x16x32_bf16 v[108:111], v[28:31], v[200:203], v[108:111]
  v_accvgpr_write_b32 a152, v72
  v_mfma_f32_16x16x32_bf16 v[116:119], v[28:31], v[232:235], v[116:119]
  s_waitcnt lgkmcnt(5)
  v_accvgpr_write_b32 a153, v73
  v_mfma_f32_16x16x32_bf16 v[88:91], v[32:35], v[140:143], v[88:91]
  s_waitcnt vmcnt(5)
  s_barrier
  ds_read_b128 v[24:27], v248 offset:32768
  v_accvgpr_write_b32 a154, v74
  v_mfma_f32_16x16x32_bf16 v[96:99], v[32:35], v[172:175], v[96:99]
  v_accvgpr_write_b32 a155, v75
  v_mul_f32 v80, v12, v80
  v_mfma_f32_16x16x32_bf16 v[104:107], v[32:35], v[204:207], v[104:107]
  v_mul_f32 v81, v12, v81
  v_mfma_f32_16x16x32_bf16 v[112:115], v[32:35], v[236:239], v[112:115]
  s_waitcnt lgkmcnt(5)
  v_mul_f32 v82, v12, v82
  v_mfma_f32_16x16x32_bf16 v[92:95], v[36:39], v[140:143], v[92:95]
  ds_read_b128 v[28:31], v248 offset:34816
  v_mul_f32 v83, v12, v83
  v_mfma_f32_16x16x32_bf16 v[100:103], v[36:39], v[172:175], v[100:103]
  v_mul_f32 v84, v12, v84
  v_mul_f32 v85, v12, v85
  v_mfma_f32_16x16x32_bf16 v[108:111], v[36:39], v[204:207], v[108:111]
  v_mul_f32 v86, v12, v86
  v_mfma_f32_16x16x32_bf16 v[116:119], v[36:39], v[236:239], v[116:119]
  s_waitcnt lgkmcnt(5)
  v_mul_f32 v87, v12, v87
  v_mfma_f32_16x16x32_bf16 v[88:91], v[40:43], v[144:147], v[88:91]
  ds_read_b128 v[32:35], v249 offset:32768
  v_cvt_pk_bf16_f32 v80, v80, v81
  v_mfma_f32_16x16x32_bf16 v[96:99], v[40:43], v[176:179], v[96:99]
  v_cvt_pk_bf16_f32 v81, v82, v83
  v_cvt_pk_bf16_f32 v82, v84, v85
  v_mfma_f32_16x16x32_bf16 v[104:107], v[40:43], v[208:211], v[104:107]
  v_cvt_pk_bf16_f32 v83, v86, v87
  v_mfma_f32_16x16x32_bf16 v[112:115], v[40:43], v[240:243], v[112:115]
  s_waitcnt lgkmcnt(5)
  v_accvgpr_write_b32 a208, v80
  v_mfma_f32_16x16x32_bf16 v[92:95], v[44:47], v[144:147], v[92:95]
  ds_read_b128 v[36:39], v249 offset:34816
  v_accvgpr_write_b32 a209, v81
  v_mfma_f32_16x16x32_bf16 v[100:103], v[44:47], v[176:179], v[100:103]
  v_accvgpr_write_b32 a210, v82
  v_accvgpr_write_b32 a211, v83
  v_mfma_f32_16x16x32_bf16 v[108:111], v[44:47], v[208:211], v[108:111]
  v_mfma_f32_16x16x32_bf16 v[116:119], v[44:47], v[240:243], v[116:119]
  s_waitcnt lgkmcnt(5)
  v_mfma_f32_16x16x32_bf16 v[88:91], v[48:51], v[148:151], v[88:91]
  ds_read_b128 v[40:43], v250 offset:32768
  v_mfma_f32_16x16x32_bf16 v[96:99], v[48:51], v[180:183], v[96:99]
  v_mfma_f32_16x16x32_bf16 v[104:107], v[48:51], v[212:215], v[104:107]
  v_mfma_f32_16x16x32_bf16 v[112:115], v[48:51], v[244:247], v[112:115]
  s_waitcnt lgkmcnt(5)
  v_mfma_f32_16x16x32_bf16 v[92:95], v[52:55], v[148:151], v[92:95]
  ds_read_b128 v[44:47], v250 offset:34816
  v_mfma_f32_16x16x32_bf16 v[100:103], v[52:55], v[180:183], v[100:103]
  v_mfma_f32_16x16x32_bf16 v[108:111], v[52:55], v[212:215], v[108:111]
  v_mfma_f32_16x16x32_bf16 v[116:119], v[52:55], v[244:247], v[116:119]
  s_waitcnt lgkmcnt(5)
  s_getpc_b64 s[98:99]
  s_add_u32 s98, s98, 4096
  s_addc_u32 s99, s99, 0
  global_load_dword v7, v6, s[98:99]
  v_mfma_f32_16x16x32_bf16 v[56:59], v[24:27], v[120:123], 0
  ds_read_b128 v[48:51], v251 offset:32768
  v_mfma_f32_16x16x32_bf16 v[64:67], v[24:27], v[152:155], 0
  v_mfma_f32_16x16x32_bf16 v[72:75], v[24:27], v[184:187], 0
  v_mfma_f32_16x16x32_bf16 v[80:83], v[24:27], v[216:219], 0
  s_waitcnt lgkmcnt(5)
  v_mul_f32 v88, v12, v88
  v_mfma_f32_16x16x32_bf16 v[60:63], v[28:31], v[120:123], 0
  ds_read_b128 v[52:55], v251 offset:34816
  v_mul_f32 v89, v12, v89
  v_mfma_f32_16x16x32_bf16 v[68:71], v[28:31], v[152:155], 0
  v_mul_f32 v90, v12, v90
  v_mul_f32 v91, v12, v91
  v_mfma_f32_16x16x32_bf16 v[76:79], v[28:31], v[184:187], 0
  v_mul_f32 v92, v12, v92
  v_mfma_f32_16x16x32_bf16 v[84:87], v[28:31], v[216:219], 0
  s_waitcnt lgkmcnt(5)
  v_mul_f32 v93, v12, v93
  v_mfma_f32_16x16x32_bf16 v[56:59], v[32:35], v[124:127], v[56:59]
  ds_read_b128 v[24:27], v248 offset:33024
  v_mul_f32 v94, v12, v94
  v_mfma_f32_16x16x32_bf16 v[64:67], v[32:35], v[156:159], v[64:67]
  v_mul_f32 v95, v12, v95
  v_cvt_pk_bf16_f32 v88, v88, v89
  v_mfma_f32_16x16x32_bf16 v[72:75], v[32:35], v[188:191], v[72:75]
  v_cvt_pk_bf16_f32 v89, v90, v91
  v_mfma_f32_16x16x32_bf16 v[80:83], v[32:35], v[220:223], v[80:83]
  s_waitcnt lgkmcnt(5)
  v_cvt_pk_bf16_f32 v90, v92, v93
  v_mfma_f32_16x16x32_bf16 v[60:63], v[36:39], v[124:127], v[60:63]
  ds_read_b128 v[28:31], v248 offset:35072
  v_cvt_pk_bf16_f32 v91, v94, v95
  v_mfma_f32_16x16x32_bf16 v[68:71], v[36:39], v[156:159], v[68:71]
  v_accvgpr_write_b32 a44, v88
  v_accvgpr_write_b32 a45, v89
  v_mfma_f32_16x16x32_bf16 v[76:79], v[36:39], v[188:191], v[76:79]
  v_accvgpr_write_b32 a46, v90
  v_mfma_f32_16x16x32_bf16 v[84:87], v[36:39], v[220:223], v[84:87]
  s_waitcnt lgkmcnt(5)
  v_accvgpr_write_b32 a47, v91
  v_mfma_f32_16x16x32_bf16 v[56:59], v[40:43], v[128:131], v[56:59]
  ds_read_b128 v[32:35], v249 offset:33024
  v_mul_f32 v96, v12, v96
  v_mfma_f32_16x16x32_bf16 v[64:67], v[40:43], v[160:163], v[64:67]
  v_mul_f32 v97, v12, v97
  v_mul_f32 v98, v12, v98
  v_mfma_f32_16x16x32_bf16 v[72:75], v[40:43], v[192:195], v[72:75]
  v_mul_f32 v99, v12, v99
  v_mfma_f32_16x16x32_bf16 v[80:83], v[40:43], v[224:227], v[80:83]
  s_waitcnt lgkmcnt(5)
  v_mul_f32 v100, v12, v100
  v_mfma_f32_16x16x32_bf16 v[60:63], v[44:47], v[128:131], v[60:63]
  ds_read_b128 v[36:39], v249 offset:35072
  v_mul_f32 v101, v12, v101
  v_mfma_f32_16x16x32_bf16 v[68:71], v[44:47], v[160:163], v[68:71]
  v_mul_f32 v102, v12, v102
  v_mul_f32 v103, v12, v103
  v_mfma_f32_16x16x32_bf16 v[76:79], v[44:47], v[192:195], v[76:79]
  v_cvt_pk_bf16_f32 v96, v96, v97
  v_mfma_f32_16x16x32_bf16 v[84:87], v[44:47], v[224:227], v[84:87]
  s_waitcnt lgkmcnt(5)
  v_cvt_pk_bf16_f32 v97, v98, v99
  v_mfma_f32_16x16x32_bf16 v[56:59], v[48:51], v[132:135], v[56:59]
  ds_read_b128 v[40:43], v250 offset:33024
  v_cvt_pk_bf16_f32 v98, v100, v101
  v_mfma_f32_16x16x32_bf16 v[64:67], v[48:51], v[164:167], v[64:67]
  v_cvt_pk_bf16_f32 v99, v102, v103
  v_accvgpr_write_b32 a100, v96
  v_mfma_f32_16x16x32_bf16 v[72:75], v[48:51], v[196:199], v[72:75]
  v_accvgpr_write_b32 a101, v97
  v_mfma_f32_16x16x32_bf16 v[80:83], v[48:51], v[228:231], v[80:83]
  s_waitcnt lgkmcnt(5)
  v_accvgpr_write_b32 a102, v98
  v_mfma_f32_16x16x32_bf16 v[60:63], v[52:55], v[132:135], v[60:63]
  ds_read_b128 v[44:47], v250 offset:35072
  v_accvgpr_write_b32 a103, v99
  v_mfma_f32_16x16x32_bf16 v[68:71], v[52:55], v[164:167], v[68:71]
  v_mul_f32 v104, v12, v104
  v_mul_f32 v105, v12, v105
  v_mfma_f32_16x16x32_bf16 v[76:79], v[52:55], v[196:199], v[76:79]
  v_mul_f32 v106, v12, v106
  v_mfma_f32_16x16x32_bf16 v[84:87], v[52:55], v[228:231], v[84:87]
  s_waitcnt lgkmcnt(5)
  v_mul_f32 v107, v12, v107
  v_mfma_f32_16x16x32_bf16 v[56:59], v[24:27], v[136:139], v[56:59]
  ds_read_b128 v[48:51], v251 offset:33024
  v_mul_f32 v108, v12, v108
  v_mfma_f32_16x16x32_bf16 v[64:67], v[24:27], v[168:171], v[64:67]
  v_mul_f32 v109, v12, v109
  v_mul_f32 v110, v12, v110
  v_mfma_f32_16x16x32_bf16 v[72:75], v[24:27], v[200:203], v[72:75]
  v_mul_f32 v111, v12, v111
  v_mfma_f32_16x16x32_bf16 v[80:83], v[24:27], v[232:235], v[80:83]
  s_waitcnt lgkmcnt(5)
  v_cvt_pk_bf16_f32 v104, v104, v105
  v_mfma_f32_16x16x32_bf16 v[60:63], v[28:31], v[136:139], v[60:63]
  ds_read_b128 v[52:55], v251 offset:35072
  v_cvt_pk_bf16_f32 v105, v106, v107
  v_mfma_f32_16x16x32_bf16 v[68:71], v[28:31], v[168:171], v[68:71]
  v_cvt_pk_bf16_f32 v106, v108, v109
  v_cvt_pk_bf16_f32 v107, v110, v111
  v_mfma_f32_16x16x32_bf16 v[76:79], v[28:31], v[200:203], v[76:79]
  v_accvgpr_write_b32 a156, v104
  v_mfma_f32_16x16x32_bf16 v[84:87], v[28:31], v[232:235], v[84:87]
  s_waitcnt lgkmcnt(5)
  v_accvgpr_write_b32 a157, v105
  v_mfma_f32_16x16x32_bf16 v[56:59], v[32:35], v[140:143], v[56:59]
  s_waitcnt vmcnt(0)
  s_barrier
  ds_read_b128 v[24:27], v248 offset:49152
  v_accvgpr_write_b32 a158, v106
  v_mfma_f32_16x16x32_bf16 v[64:67], v[32:35], v[172:175], v[64:67]
  v_accvgpr_write_b32 a159, v107
  v_mul_f32 v112, v12, v112
  v_mfma_f32_16x16x32_bf16 v[72:75], v[32:35], v[204:207], v[72:75]
  v_mul_f32 v113, v12, v113
  v_mfma_f32_16x16x32_bf16 v[80:83], v[32:35], v[236:239], v[80:83]
  s_waitcnt lgkmcnt(5)
  v_mul_f32 v114, v12, v114
  v_mfma_f32_16x16x32_bf16 v[60:63], v[36:39], v[140:143], v[60:63]
  ds_read_b128 v[28:31], v248 offset:51200
  v_mul_f32 v115, v12, v115
  v_mfma_f32_16x16x32_bf16 v[68:71], v[36:39], v[172:175], v[68:71]
  v_mul_f32 v116, v12, v116
  v_mul_f32 v117, v12, v117
  v_mfma_f32_16x16x32_bf16 v[76:79], v[36:39], v[204:207], v[76:79]
  v_mul_f32 v118, v12, v118
  v_mfma_f32_16x16x32_bf16 v[84:87], v[36:39], v[236:239], v[84:87]
  s_waitcnt lgkmcnt(5)
  v_mul_f32 v119, v12, v119
  v_mfma_f32_16x16x32_bf16 v[56:59], v[40:43], v[144:147], v[56:59]
  ds_read_b128 v[32:35], v249 offset:49152
  v_cvt_pk_bf16_f32 v112, v112, v113
  v_mfma_f32_16x16x32_bf16 v[64:67], v[40:43], v[176:179], v[64:67]
  v_cvt_pk_bf16_f32 v113, v114, v115
  v_cvt_pk_bf16_f32 v114, v116, v117
  v_mfma_f32_16x16x32_bf16 v[72:75], v[40:43], v[208:211], v[72:75]
  v_cvt_pk_bf16_f32 v115, v118, v119
  v_mfma_f32_16x16x32_bf16 v[80:83], v[40:43], v[240:243], v[80:83]
  s_waitcnt lgkmcnt(5)
  v_accvgpr_write_b32 a212, v112
  v_mfma_f32_16x16x32_bf16 v[60:63], v[44:47], v[144:147], v[60:63]
  ds_read_b128 v[36:39], v249 offset:51200
  v_accvgpr_write_b32 a213, v113
  v_mfma_f32_16x16x32_bf16 v[68:71], v[44:47], v[176:179], v[68:71]
  v_accvgpr_write_b32 a214, v114
  v_accvgpr_write_b32 a215, v115
  v_mfma_f32_16x16x32_bf16 v[76:79], v[44:47], v[208:211], v[76:79]
  v_mfma_f32_16x16x32_bf16 v[84:87], v[44:47], v[240:243], v[84:87]
  s_waitcnt lgkmcnt(5)
  v_mfma_f32_16x16x32_bf16 v[56:59], v[48:51], v[148:151], v[56:59]
  ds_read_b128 v[40:43], v250 offset:49152
  v_mfma_f32_16x16x32_bf16 v[64:67], v[48:51], v[180:183], v[64:67]
  v_mfma_f32_16x16x32_bf16 v[72:75], v[48:51], v[212:215], v[72:75]
  v_mfma_f32_16x16x32_bf16 v[80:83], v[48:51], v[244:247], v[80:83]
  s_waitcnt lgkmcnt(5)
  v_mfma_f32_16x16x32_bf16 v[60:63], v[52:55], v[148:151], v[60:63]
  ds_read_b128 v[44:47], v250 offset:51200
  v_mfma_f32_16x16x32_bf16 v[68:71], v[52:55], v[180:183], v[68:71]
  v_mfma_f32_16x16x32_bf16 v[76:79], v[52:55], v[212:215], v[76:79]
  v_mfma_f32_16x16x32_bf16 v[84:87], v[52:55], v[244:247], v[84:87]
  s_waitcnt lgkmcnt(5)
  v_mfma_f32_16x16x32_bf16 v[88:91], v[24:27], v[120:123], 0
  ds_read_b128 v[48:51], v251 offset:49152
  v_mfma_f32_16x16x32_bf16 v[96:99], v[24:27], v[152:155], 0
  v_mfma_f32_16x16x32_bf16 v[104:107], v[24:27], v[184:187], 0
  v_readfirstlane_b32 s86, v13
  s_lshl_b32 s22, s17, 7
  s_add_u32 s22, s22, 88521216
  s_mov_b32 s23, 88523264
  buffer_load_dword v13, off, s[8:11], s22 sc1
  buffer_load_dword v5, off, s[8:11], s23 sc1
  buffer_load_dword v9, off, s[12:15], 0 sc1
  v_mfma_f32_16x16x32_bf16 v[112:115], v[24:27], v[216:219], 0
  s_waitcnt lgkmcnt(5)
  v_mul_f32 v56, v12, v56
  v_mfma_f32_16x16x32_bf16 v[92:95], v[28:31], v[120:123], 0
  ds_read_b128 v[52:55], v251 offset:51200
  v_mul_f32 v57, v12, v57
  v_mfma_f32_16x16x32_bf16 v[100:103], v[28:31], v[152:155], 0
  v_mul_f32 v58, v12, v58
  v_mul_f32 v59, v12, v59
  v_mfma_f32_16x16x32_bf16 v[108:111], v[28:31], v[184:187], 0
  v_mul_f32 v60, v12, v60
  v_mfma_f32_16x16x32_bf16 v[116:119], v[28:31], v[216:219], 0
  s_waitcnt lgkmcnt(5)
  v_mul_f32 v61, v12, v61
  v_mfma_f32_16x16x32_bf16 v[88:91], v[32:35], v[124:127], v[88:91]
  ds_read_b128 v[24:27], v248 offset:49408
  v_mul_f32 v62, v12, v62
  v_mfma_f32_16x16x32_bf16 v[96:99], v[32:35], v[156:159], v[96:99]
  v_mul_f32 v63, v12, v63
  v_cvt_pk_bf16_f32 v56, v56, v57
  v_mfma_f32_16x16x32_bf16 v[104:107], v[32:35], v[188:191], v[104:107]
  v_cvt_pk_bf16_f32 v57, v58, v59
  v_mfma_f32_16x16x32_bf16 v[112:115], v[32:35], v[220:223], v[112:115]
  s_waitcnt lgkmcnt(5)
  v_cvt_pk_bf16_f32 v58, v60, v61
  v_mfma_f32_16x16x32_bf16 v[92:95], v[36:39], v[124:127], v[92:95]
  ds_read_b128 v[28:31], v248 offset:51456
  v_cvt_pk_bf16_f32 v59, v62, v63
  v_mfma_f32_16x16x32_bf16 v[100:103], v[36:39], v[156:159], v[100:103]
  v_accvgpr_write_b32 a48, v56
  v_accvgpr_write_b32 a49, v57
  v_mfma_f32_16x16x32_bf16 v[108:111], v[36:39], v[188:191], v[108:111]
  v_accvgpr_write_b32 a50, v58
  v_mfma_f32_16x16x32_bf16 v[116:119], v[36:39], v[220:223], v[116:119]
  s_waitcnt lgkmcnt(5)
  v_accvgpr_write_b32 a51, v59
  v_mfma_f32_16x16x32_bf16 v[88:91], v[40:43], v[128:131], v[88:91]
  ds_read_b128 v[32:35], v249 offset:49408
  v_mul_f32 v64, v12, v64
  v_mfma_f32_16x16x32_bf16 v[96:99], v[40:43], v[160:163], v[96:99]
  v_mul_f32 v65, v12, v65
  v_mul_f32 v66, v12, v66
  v_mfma_f32_16x16x32_bf16 v[104:107], v[40:43], v[192:195], v[104:107]
  v_mul_f32 v67, v12, v67
  v_mfma_f32_16x16x32_bf16 v[112:115], v[40:43], v[224:227], v[112:115]
  s_waitcnt lgkmcnt(5)
  v_mul_f32 v68, v12, v68
  v_mfma_f32_16x16x32_bf16 v[92:95], v[44:47], v[128:131], v[92:95]
  ds_read_b128 v[36:39], v249 offset:51456
  v_mul_f32 v69, v12, v69
  v_mfma_f32_16x16x32_bf16 v[100:103], v[44:47], v[160:163], v[100:103]
  v_mul_f32 v70, v12, v70
  v_mul_f32 v71, v12, v71
  v_mfma_f32_16x16x32_bf16 v[108:111], v[44:47], v[192:195], v[108:111]
  v_cvt_pk_bf16_f32 v64, v64, v65
  v_mfma_f32_16x16x32_bf16 v[116:119], v[44:47], v[224:227], v[116:119]
  s_waitcnt lgkmcnt(5)
  v_cvt_pk_bf16_f32 v65, v66, v67
  v_mfma_f32_16x16x32_bf16 v[88:91], v[48:51], v[132:135], v[88:91]
  ds_read_b128 v[40:43], v250 offset:49408
  v_cvt_pk_bf16_f32 v66, v68, v69
  v_mfma_f32_16x16x32_bf16 v[96:99], v[48:51], v[164:167], v[96:99]
  v_cvt_pk_bf16_f32 v67, v70, v71
  v_accvgpr_write_b32 a104, v64
  v_mfma_f32_16x16x32_bf16 v[104:107], v[48:51], v[196:199], v[104:107]
  v_accvgpr_write_b32 a105, v65
  v_mfma_f32_16x16x32_bf16 v[112:115], v[48:51], v[228:231], v[112:115]
  s_waitcnt lgkmcnt(5)
  v_accvgpr_write_b32 a106, v66
  v_mfma_f32_16x16x32_bf16 v[92:95], v[52:55], v[132:135], v[92:95]
  ds_read_b128 v[44:47], v250 offset:51456
  v_accvgpr_write_b32 a107, v67
  v_mfma_f32_16x16x32_bf16 v[100:103], v[52:55], v[164:167], v[100:103]
  v_mul_f32 v72, v12, v72
  v_mul_f32 v73, v12, v73
  v_mfma_f32_16x16x32_bf16 v[108:111], v[52:55], v[196:199], v[108:111]
  v_mul_f32 v74, v12, v74
  v_mfma_f32_16x16x32_bf16 v[116:119], v[52:55], v[228:231], v[116:119]
  s_waitcnt lgkmcnt(5)
  v_mul_f32 v75, v12, v75
  v_mfma_f32_16x16x32_bf16 v[88:91], v[24:27], v[136:139], v[88:91]
  ds_read_b128 v[48:51], v251 offset:49408
  v_mul_f32 v76, v12, v76
  v_mfma_f32_16x16x32_bf16 v[96:99], v[24:27], v[168:171], v[96:99]
  v_mul_f32 v77, v12, v77
  v_mul_f32 v78, v12, v78
  v_mfma_f32_16x16x32_bf16 v[104:107], v[24:27], v[200:203], v[104:107]
  v_mul_f32 v79, v12, v79
  v_mfma_f32_16x16x32_bf16 v[112:115], v[24:27], v[232:235], v[112:115]
  s_waitcnt lgkmcnt(5)
  v_cvt_pk_bf16_f32 v72, v72, v73
  v_mfma_f32_16x16x32_bf16 v[92:95], v[28:31], v[136:139], v[92:95]
  ds_read_b128 v[52:55], v251 offset:51456
  v_cvt_pk_bf16_f32 v73, v74, v75
  v_mfma_f32_16x16x32_bf16 v[100:103], v[28:31], v[168:171], v[100:103]
  v_cvt_pk_bf16_f32 v74, v76, v77
  v_cvt_pk_bf16_f32 v75, v78, v79
  v_mfma_f32_16x16x32_bf16 v[108:111], v[28:31], v[200:203], v[108:111]
  v_accvgpr_write_b32 a160, v72
  v_mfma_f32_16x16x32_bf16 v[116:119], v[28:31], v[232:235], v[116:119]
  s_waitcnt lgkmcnt(5)
  v_accvgpr_write_b32 a161, v73
  v_mfma_f32_16x16x32_bf16 v[88:91], v[32:35], v[140:143], v[88:91]
  v_accvgpr_write_b32 a162, v74
  v_mfma_f32_16x16x32_bf16 v[96:99], v[32:35], v[172:175], v[96:99]
  v_accvgpr_write_b32 a163, v75
  v_mul_f32 v80, v12, v80
  v_mfma_f32_16x16x32_bf16 v[104:107], v[32:35], v[204:207], v[104:107]
  v_mul_f32 v81, v12, v81
  v_mfma_f32_16x16x32_bf16 v[112:115], v[32:35], v[236:239], v[112:115]
  s_waitcnt lgkmcnt(4)
  v_mul_f32 v82, v12, v82
  v_mfma_f32_16x16x32_bf16 v[92:95], v[36:39], v[140:143], v[92:95]
  v_mul_f32 v83, v12, v83
  v_mfma_f32_16x16x32_bf16 v[100:103], v[36:39], v[172:175], v[100:103]
  v_mul_f32 v84, v12, v84
  v_mul_f32 v85, v12, v85
  v_mfma_f32_16x16x32_bf16 v[108:111], v[36:39], v[204:207], v[108:111]
  v_mul_f32 v86, v12, v86
  v_mfma_f32_16x16x32_bf16 v[116:119], v[36:39], v[236:239], v[116:119]
  s_waitcnt lgkmcnt(3)
  v_mul_f32 v87, v12, v87
  v_mfma_f32_16x16x32_bf16 v[88:91], v[40:43], v[144:147], v[88:91]
  v_cvt_pk_bf16_f32 v80, v80, v81
  v_mfma_f32_16x16x32_bf16 v[96:99], v[40:43], v[176:179], v[96:99]
  v_cvt_pk_bf16_f32 v81, v82, v83
  v_cvt_pk_bf16_f32 v82, v84, v85
  v_mfma_f32_16x16x32_bf16 v[104:107], v[40:43], v[208:211], v[104:107]
  v_cvt_pk_bf16_f32 v83, v86, v87
  v_mfma_f32_16x16x32_bf16 v[112:115], v[40:43], v[240:243], v[112:115]
  s_waitcnt lgkmcnt(2)
  v_accvgpr_write_b32 a216, v80
  v_mfma_f32_16x16x32_bf16 v[92:95], v[44:47], v[144:147], v[92:95]
  v_accvgpr_write_b32 a217, v81
  v_mfma_f32_16x16x32_bf16 v[100:103], v[44:47], v[176:179], v[100:103]
  v_accvgpr_write_b32 a218, v82
  v_accvgpr_write_b32 a219, v83
  v_mfma_f32_16x16x32_bf16 v[108:111], v[44:47], v[208:211], v[108:111]
  v_mfma_f32_16x16x32_bf16 v[116:119], v[44:47], v[240:243], v[116:119]
  s_waitcnt lgkmcnt(1)
  v_mfma_f32_16x16x32_bf16 v[88:91], v[48:51], v[148:151], v[88:91]
  v_mfma_f32_16x16x32_bf16 v[96:99], v[48:51], v[180:183], v[96:99]
  v_mfma_f32_16x16x32_bf16 v[104:107], v[48:51], v[212:215], v[104:107]
  v_mfma_f32_16x16x32_bf16 v[112:115], v[48:51], v[244:247], v[112:115]
  s_waitcnt lgkmcnt(0)
  v_mfma_f32_16x16x32_bf16 v[92:95], v[52:55], v[148:151], v[92:95]
  v_mfma_f32_16x16x32_bf16 v[100:103], v[52:55], v[180:183], v[100:103]
  v_mfma_f32_16x16x32_bf16 v[108:111], v[52:55], v[212:215], v[108:111]
  v_mfma_f32_16x16x32_bf16 v[116:119], v[52:55], v[244:247], v[116:119]
  v_mul_f32 v88, v12, v88
  v_mul_f32 v89, v12, v89
  v_mul_f32 v90, v12, v90
  v_mul_f32 v91, v12, v91
  v_mul_f32 v92, v12, v92
  v_mul_f32 v93, v12, v93
  v_mul_f32 v94, v12, v94
  v_mul_f32 v95, v12, v95
  v_cvt_pk_bf16_f32 v88, v88, v89
  v_cvt_pk_bf16_f32 v89, v90, v91
  v_cvt_pk_bf16_f32 v90, v92, v93
  v_cvt_pk_bf16_f32 v91, v94, v95
  v_accvgpr_write_b32 a52, v88
  v_accvgpr_write_b32 a53, v89
  v_accvgpr_write_b32 a54, v90
  v_accvgpr_write_b32 a55, v91
  v_mul_f32 v96, v12, v96
  v_mul_f32 v97, v12, v97
  v_mul_f32 v98, v12, v98
  v_mul_f32 v99, v12, v99
  v_mul_f32 v100, v12, v100
  v_mul_f32 v101, v12, v101
  v_mul_f32 v102, v12, v102
  v_mul_f32 v103, v12, v103
  v_cvt_pk_bf16_f32 v96, v96, v97
  v_cvt_pk_bf16_f32 v97, v98, v99
  v_cvt_pk_bf16_f32 v98, v100, v101
  v_cvt_pk_bf16_f32 v99, v102, v103
  v_accvgpr_write_b32 a108, v96
  v_accvgpr_write_b32 a109, v97
  v_accvgpr_write_b32 a110, v98
  v_accvgpr_write_b32 a111, v99
  v_mul_f32 v104, v12, v104
  v_mul_f32 v105, v12, v105
  v_mul_f32 v106, v12, v106
  v_mul_f32 v107, v12, v107
  v_mul_f32 v108, v12, v108
  v_mul_f32 v109, v12, v109
  v_mul_f32 v110, v12, v110
  v_mul_f32 v111, v12, v111
  v_cvt_pk_bf16_f32 v104, v104, v105
  v_cvt_pk_bf16_f32 v105, v106, v107
  v_cvt_pk_bf16_f32 v106, v108, v109
  v_cvt_pk_bf16_f32 v107, v110, v111
  v_accvgpr_write_b32 a164, v104
  v_accvgpr_write_b32 a165, v105
  v_accvgpr_write_b32 a166, v106
  v_accvgpr_write_b32 a167, v107
  v_mul_f32 v112, v12, v112
  v_mul_f32 v113, v12, v113
  v_mul_f32 v114, v12, v114
  v_mul_f32 v115, v12, v115
  v_mul_f32 v116, v12, v116
  v_mul_f32 v117, v12, v117
  v_mul_f32 v118, v12, v118
  v_mul_f32 v119, v12, v119
  v_cvt_pk_bf16_f32 v112, v112, v113
  v_cvt_pk_bf16_f32 v113, v114, v115
  v_cvt_pk_bf16_f32 v114, v116, v117
  v_cvt_pk_bf16_f32 v115, v118, v119
  v_accvgpr_write_b32 a220, v112
  v_accvgpr_write_b32 a221, v113
  v_accvgpr_write_b32 a222, v114
  v_accvgpr_write_b32 a223, v115
  s_waitcnt vmcnt(0)
  s_barrier
  v_readfirstlane_b32 s84, v13
  v_readfirstlane_b32 s85, v5
  s_cmp_eq_u32 s86, 1
  s_cselect_b32 s84, s84, 0
  v_and_b32 v10, 0xffe0, v9
  v_cmp_eq_u32 vcc, 0, v10
  s_cbranch_vccz ch_md_ok
ch_role2:
  s_mov_b32 s30, 0
ch_md:
  buffer_load_dword v9, off, s[12:15], 0 sc1
  s_waitcnt vmcnt(0)
  v_and_b32 v10, 0xffe0, v9
  v_cmp_eq_u32 vcc, 0, v10
  s_cbranch_vccz ch_md_ok
  s_sleep 4
  s_add_u32 s30, s30, 1
  s_cmp_lt_u32 s30, 1600000
  s_cbranch_scc1 ch_md
  s_branch ch_end
ch_md_ok:
  v_readfirstlane_b32 s88, v9
  s_lshr_b32 s88, s88, 16
  v_and_b32 v1, 63, v0
  v_lshlrev_b32 v2, 4, v1
  v_lshrrev_b32 v116, 4, v1
  v_and_b32 v117, 15, v1
  v_mov_b32 v3, 0x4444
  v_mov_b32 v118, 0xeeee
  v_cmp_lt_u32 vcc, 7, v117
  s_nop 1
  v_cndmask_b32 v3, v3, v118, vcc
  s_mov_b32 s19, 0
  s_mov_b32 s18, 1
  s_mov_b32 s20, 75694080
  s_mov_b32 s21, 75711744
  s_mov_b32 s23, 75698176
  s_lshr_b32 s89, s17, 4
  s_lshl_b32 s89, s89, 2
  s_add_u32 s89, s89, s16
  s_and_b32 s17, s17, 15
  s_cmp_eq_u32 s89, 0
  s_cbranch_scc1 ch_init0
  s_cmp_eq_u32 s89, 1
  s_cbranch_scc1 ch_init1
  s_cmp_eq_u32 s89, 2
  s_cbranch_scc1 ch_init2
  s_cmp_eq_u32 s89, 3
  s_cbranch_scc1 ch_init3
  s_cmp_eq_u32 s89, 4
  s_cbranch_scc1 ch_init4
  s_cmp_eq_u32 s89, 5
  s_cbranch_scc1 ch_init5
  s_cmp_eq_u32 s89, 6
  s_cbranch_scc1 ch_init6
  s_cmp_eq_u32 s89, 7
  s_cbranch_scc1 ch_init7
  s_branch ch_end
ch_init0:
  s_mul_i32 s31, s17, 401408
  s_add_u32 s31, s31, 0
  s_and_b32 s28, s84, 10320
  s_lshl_b32 s22, s85, 16
  s_or_b32 s28, s28, s22
  s_cmp_eq_u32 s28, 4294912080
  s_cbranch_scc1 ch_wx0_ok
  s_mov_b32 s30, 0
ch_wr0:
  buffer_load_dword v9, off, s[12:15], 0 offset:132 sc1
  s_waitcnt vmcnt(0)
  v_cmp_ne_u32 vcc, 1, v9
  s_cbranch_vccz ch_wr0_ok
  s_sleep 8
  s_add_u32 s30, s30, 1
  s_cmp_lt_u32 s30, 400000
  s_cbranch_scc1 ch_wr0
  s_branch cA_abort
ch_wr0_ok:
  s_lshl_b32 s27, s17, 7
  s_add_u32 s27, s27, 88521216
  s_mov_b32 s28, 10320
  s_mov_b32 s30, 0
ch_wb0:
  buffer_load_dword v9, off, s[8:11], s27  sc1
  s_waitcnt vmcnt(0)
  v_and_b32 v10, s28, v9
  v_cmp_ne_u32 vcc, s28, v10
  s_cbranch_vccz ch_wb0_ok
  s_sleep 3
  s_add_u32 s30, s30, 1
  s_cmp_lt_u32 s30, 400000
  s_cbranch_scc1 ch_wb0
  s_branch cA_abort
ch_wb0_ok:
  s_mov_b32 s29, 88523264
  s_mov_b32 s28, 0xffff
  s_mov_b32 s30, 0
ch_wx0:
  buffer_load_dword v9, off, s[8:11], s29  sc1
  s_waitcnt vmcnt(0)
  v_and_b32 v10, s28, v9
  v_cmp_ne_u32 vcc, s28, v10
  s_cbranch_vccz ch_wx0_ok
  s_sleep 8
  s_add_u32 s30, s30, 1
  s_cmp_lt_u32 s30, 400000
  s_cbranch_scc1 ch_wx0
  s_branch cA_abort
ch_wx0_ok:
  s_add_u32 s22, s31, 229376
  buffer_load_dwordx4 a[224:227], v2, s[8:11], s22 offen offset:0 sc1
  buffer_load_dwordx4 a[228:231], v2, s[8:11], s22 offen offset:1024 sc1
  buffer_load_dwordx4 a[232:235], v2, s[8:11], s22 offen offset:2048 sc1
  buffer_load_dwordx4 a[236:239], v2, s[8:11], s22 offen offset:3072 sc1
  s_add_u32 s22, s31, 233472
  buffer_load_dwordx4 a[240:243], v2, s[8:11], s22 offen offset:0 sc1
  buffer_load_dwordx4 a[244:247], v2, s[8:11], s22 offen offset:1024 sc1
  buffer_load_dwordx4 a[248:251], v2, s[8:11], s22 offen offset:2048 sc1
  buffer_load_dwordx4 a[252:255], v2, s[8:11], s22 offen offset:3072 sc1
  s_add_u32 s22, s31, 237568
  buffer_load_dwordx4 v[120:123], v2, s[8:11], s22 offen offset:0 sc1
  buffer_load_dwordx4 v[124:127], v2, s[8:11], s22 offen offset:1024 sc1
  buffer_load_dwordx4 v[128:131], v2, s[8:11], s22 offen offset:2048 sc1
  buffer_load_dwordx4 v[132:135], v2, s[8:11], s22 offen offset:3072 sc1
  s_add_u32 s22, s31, 241664
  buffer_load_dwordx4 v[136:139], v2, s[8:11], s22 offen offset:0 sc1
  buffer_load_dwordx4 v[140:143], v2, s[8:11], s22 offen offset:1024 sc1
  buffer_load_dwordx4 v[144:147], v2, s[8:11], s22 offen offset:2048 sc1
  buffer_load_dwordx4 v[148:151], v2, s[8:11], s22 offen offset:3072 sc1
  s_add_u32 s22, s31, 245760
  buffer_load_dwordx4 v[152:155], v2, s[8:11], s22 offen offset:0 sc1
  buffer_load_dwordx4 v[156:159], v2, s[8:11], s22 offen offset:1024 sc1
  buffer_load_dwordx4 v[160:163], v2, s[8:11], s22 offen offset:2048 sc1
  buffer_load_dwordx4 v[164:167], v2, s[8:11], s22 offen offset:3072 sc1
  s_add_u32 s22, s31, 249856
  buffer_load_dwordx4 v[168:171], v2, s[8:11], s22 offen offset:0 sc1
  buffer_load_dwordx4 v[172:175], v2, s[8:11], s22 offen offset:1024 sc1
  buffer_load_dwordx4 v[176:179], v2, s[8:11], s22 offen offset:2048 sc1
  buffer_load_dwordx4 v[180:183], v2, s[8:11], s22 offen offset:3072 sc1
  s_mov_b32 s24, 72024064
  s_mov_b32 s26, 72038400
  v_and_b32 v64, 7, v117
  v_and_b32 v65, 1, v116
  v_lshlrev_b32 v65, 2, v65
  v_sub_u32 v64, v64, v65
  v_lshrrev_b32 v65, 3, v117
  v_lshl_add_u32 v66, v65, 2, v64
  v_cmp_gt_u32 vcc, 4, v64
  v_mov_b32 v67, 99
  s_nop 0
  v_cndmask_b32 v66, v67, v66, vcc
  v_mov_b32 v68, 0x3f80
  v_mov_b32 v69, 0x3f800000
  v_mov_b32 v4, 0
  v_cmp_eq_u32 vcc, 0, v66
  s_nop 1
  v_cndmask_b32 v4, v4, v68, vcc
  v_cmp_eq_u32 vcc, 1, v66
  s_nop 1
  v_cndmask_b32 v4, v4, v69, vcc
  v_mov_b32 v5, 0
  v_cmp_eq_u32 vcc, 2, v66
  s_nop 1
  v_cndmask_b32 v5, v5, v68, vcc
  v_cmp_eq_u32 vcc, 3, v66
  s_nop 1
  v_cndmask_b32 v5, v5, v69, vcc
  v_mov_b32 v6, 0
  v_cmp_eq_u32 vcc, 4, v66
  s_nop 1
  v_cndmask_b32 v6, v6, v68, vcc
  v_cmp_eq_u32 vcc, 5, v66
  s_nop 1
  v_cndmask_b32 v6, v6, v69, vcc
  v_mov_b32 v7, 0
  v_cmp_eq_u32 vcc, 6, v66
  s_nop 1
  v_cndmask_b32 v7, v7, v68, vcc
  v_cmp_eq_u32 vcc, 7, v66
  s_nop 1
  v_cndmask_b32 v7, v7, v69, vcc
  v_lshrrev_b32 v64, 1, v116
  v_lshrrev_b32 v65, 3, v117
  v_and_b32 v66, 1, v116
  v_and_b32 v68, 7, v117
  v_lshlrev_b32 v67, 8, v65
  v_lshl_add_u32 v67, v68, 5, v67
  v_lshl_add_u32 v67, v66, 4, v67
  v_add_u32 v69, 4096, v67
  v_add_u32 v70, 6400, v67
  v_cmp_eq_u32 vcc, v64, v65
  s_nop 1
  v_cndmask_b32 v113, v70, v69, vcc
  v_lshlrev_b32 v67, 9, v64
  v_lshl_add_u32 v67, v117, 4, v67
  v_lshl_add_u32 v67, v66, 3, v67
  v_add_u32 v114, 0, v67
  v_mul_u32_u24 v67, 1088, v65
  v_lshl_add_u32 v67, v116, 5, v67
  v_lshl_add_u32 v67, v68, 2, v67
  v_add_u32 v115, 4096, v67
  v_and_b32 v69, 1, v117
  v_lshlrev_b32 v67, 7, v69
  v_lshl_add_u32 v67, v116, 4, v67
  v_lshl_add_u32 v67, v65, 8, v67
  v_bfe_u32 v69, v117, 1, 2
  v_lshl_add_u32 v67, v69, 2, v67
  s_lshl_b32 s22, s17, 9
  s_add_u32 s22, s22, 9216
  v_add_u32 v72, s22, v67
  v_bfe_u32 v69, v117, 1, 1
  v_lshlrev_b32 v67, 7, v69
  v_lshl_add_u32 v67, v116, 4, v67
  v_and_b32 v69, 4, v117
  v_add_u32 v67, v67, v69
  s_lshr_b32 s22, s17, 1
  s_lshl_b32 s22, s22, 8
  s_and_b32 s27, s17, 1
  s_lshl_b32 s27, s27, 3
  s_add_u32 s22, s22, s27
  s_add_u32 s22, s22, 7168
  v_add_u32 v67, s22, v67
  v_and_b32 v69, 9, v117
  v_mov_b32 v70, 0x40000000
  v_cmp_eq_u32 vcc, 0, v69
  s_nop 1
  v_cndmask_b32 v118, v70, v67, vcc
  v_mov_b32 v119, -1
  v_and_b32 v0, 15, v1
  s_and_b32 s22, s17, 0
  s_lshl_b32 s22, s22, 7
  s_add_u32 s22, s22, 75731456
  v_lshl_add_u32 v0, v0, 2, s22
  v_xor_b32 v69, 256, v2
  v_mul_i32_i24 v70, -4096, v66
  v_add_u32 v69, v69, v70
  v_add_u32 v117, 12288, v69
  v_mov_b32 v116, v73
  s_mul_i32 s35, s17, 28672
  s_add_u32 s35, s35, 44040192
  v_mov_b32 v1, v72
  v_mov_b32 v36, 0
  v_mov_b32 v37, 0
  v_mov_b32 v38, 0
  v_mov_b32 v39, 0
  v_mov_b32 v40, 0
  v_mov_b32 v41, 0
  v_mov_b32 v42, 0
  v_mov_b32 v43, 0
  v_mov_b32 v44, 0
  v_mov_b32 v45, 0
  v_mov_b32 v46, 0
  v_mov_b32 v47, 0
  v_mov_b32 v48, 0
  v_mov_b32 v49, 0
  v_mov_b32 v50, 0
  v_mov_b32 v51, 0
  v_mov_b32 v52, 0
  v_mov_b32 v53, 0
  v_mov_b32 v54, 0
  v_mov_b32 v55, 0
  v_mov_b32 v56, 0
  v_mov_b32 v57, 0
  v_mov_b32 v58, 0
  v_mov_b32 v59, 0
  v_mov_b32 v60, 0
  v_mov_b32 v61, 0
  v_mov_b32 v62, 0
  v_mov_b32 v63, 0
  v_mov_b32 v64, 0
  v_mov_b32 v65, 0
  v_mov_b32 v66, 0
  v_mov_b32 v67, 0
  v_mov_b32 v68, 0
  v_mov_b32 v69, 0
  v_mov_b32 v70, 0
  v_mov_b32 v71, 0
  v_mov_b32 v72, 0
  v_mov_b32 v73, 0
  v_mov_b32 v74, 0
  v_mov_b32 v75, 0
  v_mov_b32 v76, 0
  v_mov_b32 v77, 0
  v_mov_b32 v78, 0
  v_mov_b32 v79, 0
  s_mov_b32 s22, 75694080
  v_lshrrev_b32 v14, 4, v2
  v_add_u32 v14, 0, v14
  v_min_u32 v14, 308, v14
  v_lshlrev_b32 v14, 7, v14
  buffer_load_dword v15, v14, s[8:11], s22 offen sc1
  v_lshrrev_b32 v14, 4, v2
  v_add_u32 v14, 256, v14
  v_min_u32 v14, 308, v14
  v_lshlrev_b32 v14, 7, v14
  buffer_load_dword v15, v14, s[8:11], s22 offen sc1
  buffer_load_dwordx4 v[80:83], v117, s[8:11], s24 offen offset:0 sc1
  buffer_load_dwordx4 v[84:87], v117, s[8:11], s24 offen offset:1024 sc1
  buffer_load_dwordx4 v[88:91], v117, s[8:11], s26 offen offset:0 sc1
  buffer_load_dwordx4 v[92:95], v117, s[8:11], s26 offen offset:1024 sc1
  buffer_load_dwordx4 v[96:99], v2, s[8:11], s24 offen offset:0 sc1
  buffer_load_dwordx4 v[100:103], v2, s[8:11], s24 offen offset:1024 sc1
  buffer_load_dwordx4 v[104:107], v2, s[8:11], s26 offen offset:0 sc1
  buffer_load_dwordx4 v[108:111], v2, s[8:11], s26 offen offset:1024 sc1
  s_add_u32 s22, s31, 253952
  buffer_load_dwordx4 v[184:187], v2, s[8:11], s22 offen offset:0 sc1
  buffer_load_dwordx4 v[188:191], v2, s[8:11], s22 offen offset:1024 sc1
  buffer_load_dwordx4 v[192:195], v2, s[8:11], s22 offen offset:2048 sc1
  buffer_load_dwordx4 v[196:199], v2, s[8:11], s22 offen offset:3072 sc1
  s_add_u32 s22, s31, 372736
  buffer_load_dwordx4 v[200:203], v2, s[8:11], s22 offen offset:0 sc1
  buffer_load_dwordx4 v[204:207], v2, s[8:11], s22 offen offset:1024 sc1
  buffer_load_dwordx4 v[208:211], v2, s[8:11], s22 offen offset:2048 sc1
  buffer_load_dwordx4 v[212:215], v2, s[8:11], s22 offen offset:3072 sc1
  s_add_u32 s22, s31, 376832
  buffer_load_dwordx4 v[216:219], v2, s[8:11], s22 offen offset:0 sc1
  buffer_load_dwordx4 v[220:223], v2, s[8:11], s22 offen offset:1024 sc1
  buffer_load_dwordx4 v[224:227], v2, s[8:11], s22 offen offset:2048 sc1
  buffer_load_dwordx4 v[228:231], v2, s[8:11], s22 offen offset:3072 sc1
  s_add_u32 s22, s31, 380928
  buffer_load_dwordx4 v[232:235], v2, s[8:11], s22 offen offset:0 sc1
  buffer_load_dwordx4 v[236:239], v2, s[8:11], s22 offen offset:1024 sc1
  buffer_load_dwordx4 v[240:243], v2, s[8:11], s22 offen offset:2048 sc1
  buffer_load_dwordx4 v[244:247], v2, s[8:11], s22 offen offset:3072 sc1
  s_add_u32 s22, s31, 385024
  buffer_load_dwordx4 v[248:251], v2, s[8:11], s22 offen offset:0 sc1
  buffer_load_dwordx4 v[252:255], v2, s[8:11], s22 offen offset:1024 sc1
  s_waitcnt vmcnt(0) lgkmcnt(0)
  s_mov_b32 s31, 0
  s_cmp_lg_u32 s88, 0
  s_cbranch_scc1 cB_sc0_loop
  s_branch cA_sc0_loop
ch_init1:
  s_mul_i32 s31, s17, 401408
  s_add_u32 s31, s31, 0
  s_and_b32 s28, s84, 10320
  s_lshl_b32 s22, s85, 16
  s_or_b32 s28, s28, s22
  s_cmp_eq_u32 s28, 4294912080
  s_cbranch_scc1 ch_wx1_ok
  s_mov_b32 s30, 0
ch_wr1:
  buffer_load_dword v9, off, s[12:15], 0 offset:132 sc1
  s_waitcnt vmcnt(0)
  v_cmp_ne_u32 vcc, 1, v9
  s_cbranch_vccz ch_wr1_ok
  s_sleep 8
  s_add_u32 s30, s30, 1
  s_cmp_lt_u32 s30, 400000
  s_cbranch_scc1 ch_wr1
  s_branch cA_abort
ch_wr1_ok:
  s_lshl_b32 s27, s17, 7
  s_add_u32 s27, s27, 88521216
  s_mov_b32 s28, 10320
  s_mov_b32 s30, 0
ch_wb1:
  buffer_load_dword v9, off, s[8:11], s27  sc1
  s_waitcnt vmcnt(0)
  v_and_b32 v10, s28, v9
  v_cmp_ne_u32 vcc, s28, v10
  s_cbranch_vccz ch_wb1_ok
  s_sleep 3
  s_add_u32 s30, s30, 1
  s_cmp_lt_u32 s30, 400000
  s_cbranch_scc1 ch_wb1
  s_branch cA_abort
ch_wb1_ok:
  s_mov_b32 s29, 88523264
  s_mov_b32 s28, 0xffff
  s_mov_b32 s30, 0
ch_wx1:
  buffer_load_dword v9, off, s[8:11], s29  sc1
  s_waitcnt vmcnt(0)
  v_and_b32 v10, s28, v9
  v_cmp_ne_u32 vcc, s28, v10
  s_cbranch_vccz ch_wx1_ok
  s_sleep 8
  s_add_u32 s30, s30, 1
  s_cmp_lt_u32 s30, 400000
  s_cbranch_scc1 ch_wx1
  s_branch cA_abort
ch_wx1_ok:
  s_add_u32 s22, s31, 258048
  buffer_load_dwordx4 a[224:227], v2, s[8:11], s22 offen offset:0 sc1
  buffer_load_dwordx4 a[228:231], v2, s[8:11], s22 offen offset:1024 sc1
  buffer_load_dwordx4 a[232:235], v2, s[8:11], s22 offen offset:2048 sc1
  buffer_load_dwordx4 a[236:239], v2, s[8:11], s22 offen offset:3072 sc1
  s_add_u32 s22, s31, 262144
  buffer_load_dwordx4 a[240:243], v2, s[8:11], s22 offen offset:0 sc1
  buffer_load_dwordx4 a[244:247], v2, s[8:11], s22 offen offset:1024 sc1
  buffer_load_dwordx4 a[248:251], v2, s[8:11], s22 offen offset:2048 sc1
  buffer_load_dwordx4 a[252:255], v2, s[8:11], s22 offen offset:3072 sc1
  s_add_u32 s22, s31, 266240
  buffer_load_dwordx4 v[120:123], v2, s[8:11], s22 offen offset:0 sc1
  buffer_load_dwordx4 v[124:127], v2, s[8:11], s22 offen offset:1024 sc1
  buffer_load_dwordx4 v[128:131], v2, s[8:11], s22 offen offset:2048 sc1
  buffer_load_dwordx4 v[132:135], v2, s[8:11], s22 offen offset:3072 sc1
  s_add_u32 s22, s31, 270336
  buffer_load_dwordx4 v[136:139], v2, s[8:11], s22 offen offset:0 sc1
  buffer_load_dwordx4 v[140:143], v2, s[8:11], s22 offen offset:1024 sc1
  buffer_load_dwordx4 v[144:147], v2, s[8:11], s22 offen offset:2048 sc1
  buffer_load_dwordx4 v[148:151], v2, s[8:11], s22 offen offset:3072 sc1
  s_add_u32 s22, s31, 274432
  buffer_load_dwordx4 v[152:155], v2, s[8:11], s22 offen offset:0 sc1
  buffer_load_dwordx4 v[156:159], v2, s[8:11], s22 offen offset:1024 sc1
  buffer_load_dwordx4 v[160:163], v2, s[8:11], s22 offen offset:2048 sc1
  buffer_load_dwordx4 v[164:167], v2, s[8:11], s22 offen offset:3072 sc1
  s_add_u32 s22, s31, 278528
  buffer_load_dwordx4 v[168:171], v2, s[8:11], s22 offen offset:0 sc1
  buffer_load_dwordx4 v[172:175], v2, s[8:11], s22 offen offset:1024 sc1
  buffer_load_dwordx4 v[176:179], v2, s[8:11], s22 offen offset:2048 sc1
  buffer_load_dwordx4 v[180:183], v2, s[8:11], s22 offen offset:3072 sc1
  s_mov_b32 s24, 72026112
  s_mov_b32 s26, 72040448
  v_and_b32 v64, 7, v117
  v_and_b32 v65, 1, v116
  v_lshlrev_b32 v65, 2, v65
  v_sub_u32 v64, v64, v65
  v_lshrrev_b32 v65, 3, v117
  v_lshl_add_u32 v66, v65, 2, v64
  v_cmp_gt_u32 vcc, 4, v64
  v_mov_b32 v67, 99
  s_nop 0
  v_cndmask_b32 v66, v67, v66, vcc
  v_mov_b32 v68, 0x3f80
  v_mov_b32 v69, 0x3f800000
  v_mov_b32 v4, 0
  v_cmp_eq_u32 vcc, 0, v66
  s_nop 1
  v_cndmask_b32 v4, v4, v68, vcc
  v_cmp_eq_u32 vcc, 1, v66
  s_nop 1
  v_cndmask_b32 v4, v4, v69, vcc
  v_mov_b32 v5, 0
  v_cmp_eq_u32 vcc, 2, v66
  s_nop 1
  v_cndmask_b32 v5, v5, v68, vcc
  v_cmp_eq_u32 vcc, 3, v66
  s_nop 1
  v_cndmask_b32 v5, v5, v69, vcc
  v_mov_b32 v6, 0
  v_cmp_eq_u32 vcc, 4, v66
  s_nop 1
  v_cndmask_b32 v6, v6, v68, vcc
  v_cmp_eq_u32 vcc, 5, v66
  s_nop 1
  v_cndmask_b32 v6, v6, v69, vcc
  v_mov_b32 v7, 0
  v_cmp_eq_u32 vcc, 6, v66
  s_nop 1
  v_cndmask_b32 v7, v7, v68, vcc
  v_cmp_eq_u32 vcc, 7, v66
  s_nop 1
  v_cndmask_b32 v7, v7, v69, vcc
  v_lshrrev_b32 v64, 1, v116
  v_lshrrev_b32 v65, 3, v117
  v_and_b32 v66, 1, v116
  v_and_b32 v68, 7, v117
  v_lshlrev_b32 v67, 8, v65
  v_lshl_add_u32 v67, v68, 5, v67
  v_lshl_add_u32 v67, v66, 4, v67
  v_add_u32 v69, 4608, v67
  v_add_u32 v70, 6400, v67
  v_cmp_eq_u32 vcc, v64, v65
  s_nop 1
  v_cndmask_b32 v113, v70, v69, vcc
  v_lshlrev_b32 v67, 9, v64
  v_lshl_add_u32 v67, v117, 4, v67
  v_lshl_add_u32 v67, v66, 3, v67
  v_add_u32 v114, 256, v67
  v_mul_u32_u24 v67, 1088, v65
  v_lshl_add_u32 v67, v116, 5, v67
  v_lshl_add_u32 v67, v68, 2, v67
  v_add_u32 v115, 4224, v67
  v_and_b32 v69, 1, v117
  v_lshlrev_b32 v67, 7, v69
  v_lshl_add_u32 v67, v116, 4, v67
  v_lshl_add_u32 v67, v65, 8, v67
  v_bfe_u32 v69, v117, 1, 2
  v_lshl_add_u32 v67, v69, 2, v67
  s_lshl_b32 s22, s17, 9
  s_add_u32 s22, s22, 9280
  v_add_u32 v72, s22, v67
  v_bfe_u32 v69, v117, 1, 1
  v_lshlrev_b32 v67, 7, v69
  v_lshl_add_u32 v67, v116, 4, v67
  v_and_b32 v69, 4, v117
  v_add_u32 v67, v67, v69
  s_lshr_b32 s22, s17, 1
  s_lshl_b32 s22, s22, 8
  s_and_b32 s27, s17, 1
  s_lshl_b32 s27, s27, 3
  s_add_u32 s22, s22, s27
  s_add_u32 s22, s22, 7232
  v_add_u32 v67, s22, v67
  v_and_b32 v69, 9, v117
  v_mov_b32 v70, 0x40000000
  v_cmp_eq_u32 vcc, 0, v69
  s_nop 1
  v_cndmask_b32 v118, v70, v67, vcc
  v_mov_b32 v119, -1
  s_lshl_b32 s22, s17, 2
  s_add_u32 s22, s22, 75729408
  v_lshl_add_u32 v67, v1, 7, s22
  v_mov_b32 v70, 0x40000000
  v_cmp_gt_u32 vcc, 1, v1
  s_nop 1
  v_cndmask_b32 v73, v70, v67, vcc
  v_mov_b32 v112, 1
  v_and_b32 v0, 15, v1
  s_and_b32 s22, s17, 0
  s_lshl_b32 s22, s22, 7
  s_add_u32 s22, s22, 75731456
  v_lshl_add_u32 v0, v0, 2, s22
  v_xor_b32 v69, 256, v2
  v_mul_i32_i24 v70, 4096, v66
  v_add_u32 v69, v69, v70
  v_add_u32 v117, 6144, v69
  v_mov_b32 v116, v73
  s_mul_i32 s35, s17, 28672
  s_add_u32 s35, s35, 44040192
  v_mov_b32 v1, v72
  v_mov_b32 v36, 0
  v_mov_b32 v37, 0
  v_mov_b32 v38, 0
  v_mov_b32 v39, 0
  v_mov_b32 v40, 0
  v_mov_b32 v41, 0
  v_mov_b32 v42, 0
  v_mov_b32 v43, 0
  v_mov_b32 v44, 0
  v_mov_b32 v45, 0
  v_mov_b32 v46, 0
  v_mov_b32 v47, 0
  v_mov_b32 v48, 0
  v_mov_b32 v49, 0
  v_mov_b32 v50, 0
  v_mov_b32 v51, 0
  v_mov_b32 v52, 0
  v_mov_b32 v53, 0
  v_mov_b32 v54, 0
  v_mov_b32 v55, 0
  v_mov_b32 v56, 0
  v_mov_b32 v57, 0
  v_mov_b32 v58, 0
  v_mov_b32 v59, 0
  v_mov_b32 v60, 0
  v_mov_b32 v61, 0
  v_mov_b32 v62, 0
  v_mov_b32 v63, 0
  v_mov_b32 v64, 0
  v_mov_b32 v65, 0
  v_mov_b32 v66, 0
  v_mov_b32 v67, 0
  v_mov_b32 v68, 0
  v_mov_b32 v69, 0
  v_mov_b32 v70, 0
  v_mov_b32 v71, 0
  v_mov_b32 v72, 0
  v_mov_b32 v73, 0
  v_mov_b32 v74, 0
  v_mov_b32 v75, 0
  v_mov_b32 v76, 0
  v_mov_b32 v77, 0
  v_mov_b32 v78, 0
  v_mov_b32 v79, 0
  s_mov_b32 s22, 75694080
  v_lshrrev_b32 v14, 4, v2
  v_add_u32 v14, 64, v14
  v_min_u32 v14, 308, v14
  v_lshlrev_b32 v14, 7, v14
  buffer_load_dword v15, v14, s[8:11], s22 offen sc1
  buffer_load_dwordx4 v[80:83], v117, s[8:11], s24 offen offset:0 sc1
  buffer_load_dwordx4 v[84:87], v117, s[8:11], s24 offen offset:1024 sc1
  buffer_load_dwordx4 v[88:91], v117, s[8:11], s26 offen offset:0 sc1
  buffer_load_dwordx4 v[92:95], v117, s[8:11], s26 offen offset:1024 sc1
  buffer_load_dwordx4 v[96:99], v2, s[8:11], s24 offen offset:0 sc1
  buffer_load_dwordx4 v[100:103], v2, s[8:11], s24 offen offset:1024 sc1
  buffer_load_dwordx4 v[104:107], v2, s[8:11], s26 offen offset:0 sc1
  buffer_load_dwordx4 v[108:111], v2, s[8:11], s26 offen offset:1024 sc1
  s_add_u32 s22, s31, 282624
  buffer_load_dwordx4 v[184:187], v2, s[8:11], s22 offen offset:0 sc1
  buffer_load_dwordx4 v[188:191], v2, s[8:11], s22 offen offset:1024 sc1
  buffer_load_dwordx4 v[192:195], v2, s[8:11], s22 offen offset:2048 sc1
  buffer_load_dwordx4 v[196:199], v2, s[8:11], s22 offen offset:3072 sc1
  s_add_u32 s22, s31, 344064
  buffer_load_dwordx4 v[200:203], v2, s[8:11], s22 offen offset:0 sc1
  buffer_load_dwordx4 v[204:207], v2, s[8:11], s22 offen offset:1024 sc1
  buffer_load_dwordx4 v[208:211], v2, s[8:11], s22 offen offset:2048 sc1
  buffer_load_dwordx4 v[212:215], v2, s[8:11], s22 offen offset:3072 sc1
  s_add_u32 s22, s31, 348160
  buffer_load_dwordx4 v[216:219], v2, s[8:11], s22 offen offset:0 sc1
  buffer_load_dwordx4 v[220:223], v2, s[8:11], s22 offen offset:1024 sc1
  buffer_load_dwordx4 v[224:227], v2, s[8:11], s22 offen offset:2048 sc1
  buffer_load_dwordx4 v[228:231], v2, s[8:11], s22 offen offset:3072 sc1
  s_add_u32 s22, s31, 352256
  buffer_load_dwordx4 v[232:235], v2, s[8:11], s22 offen offset:0 sc1
  buffer_load_dwordx4 v[236:239], v2, s[8:11], s22 offen offset:1024 sc1
  buffer_load_dwordx4 v[240:243], v2, s[8:11], s22 offen offset:2048 sc1
  buffer_load_dwordx4 v[244:247], v2, s[8:11], s22 offen offset:3072 sc1
  s_add_u32 s22, s31, 356352
  buffer_load_dwordx4 v[248:251], v2, s[8:11], s22 offen offset:0 sc1
  buffer_load_dwordx4 v[252:255], v2, s[8:11], s22 offen offset:1024 sc1
  s_waitcnt vmcnt(0) lgkmcnt(0)
  s_mov_b32 s31, 0
  s_cmp_lg_u32 s88, 0
  s_cbranch_scc1 cB_sc1_loop
  s_branch cA_sc1_loop
ch_init2:
  s_mul_i32 s31, s17, 401408
  s_add_u32 s31, s31, 0
  s_and_b32 s28, s84, 12384
  s_lshl_b32 s22, s85, 16
  s_or_b32 s28, s28, s22
  s_cmp_eq_u32 s28, 4294914144
  s_cbranch_scc1 ch_wx2_ok
  s_mov_b32 s30, 0
ch_wr2:
  buffer_load_dword v9, off, s[12:15], 0 offset:132 sc1
  s_waitcnt vmcnt(0)
  v_cmp_ne_u32 vcc, 1, v9
  s_cbranch_vccz ch_wr2_ok
  s_sleep 8
  s_add_u32 s30, s30, 1
  s_cmp_lt_u32 s30, 400000
  s_cbranch_scc1 ch_wr2
  s_branch cA_abort
ch_wr2_ok:
  s_lshl_b32 s27, s17, 7
  s_add_u32 s27, s27, 88521216
  s_mov_b32 s28, 12384
  s_mov_b32 s30, 0
ch_wb2:
  buffer_load_dword v9, off, s[8:11], s27  sc1
  s_waitcnt vmcnt(0)
  v_and_b32 v10, s28, v9
  v_cmp_ne_u32 vcc, s28, v10
  s_cbranch_vccz ch_wb2_ok
  s_sleep 3
  s_add_u32 s30, s30, 1
  s_cmp_lt_u32 s30, 400000
  s_cbranch_scc1 ch_wb2
  s_branch cA_abort
ch_wb2_ok:
  s_mov_b32 s29, 88523264
  s_mov_b32 s28, 0xffff
  s_mov_b32 s30, 0
ch_wx2:
  buffer_load_dword v9, off, s[8:11], s29  sc1
  s_waitcnt vmcnt(0)
  v_and_b32 v10, s28, v9
  v_cmp_ne_u32 vcc, s28, v10
  s_cbranch_vccz ch_wx2_ok
  s_sleep 8
  s_add_u32 s30, s30, 1
  s_cmp_lt_u32 s30, 400000
  s_cbranch_scc1 ch_wx2
  s_branch cA_abort
ch_wx2_ok:
  s_add_u32 s22, s31, 286720
  buffer_load_dwordx4 a[224:227], v2, s[8:11], s22 offen offset:0 sc1
  buffer_load_dwordx4 a[228:231], v2, s[8:11], s22 offen offset:1024 sc1
  buffer_load_dwordx4 a[232:235], v2, s[8:11], s22 offen offset:2048 sc1
  buffer_load_dwordx4 a[236:239], v2, s[8:11], s22 offen offset:3072 sc1
  s_add_u32 s22, s31, 290816
  buffer_load_dwordx4 a[240:243], v2, s[8:11], s22 offen offset:0 sc1
  buffer_load_dwordx4 a[244:247], v2, s[8:11], s22 offen offset:1024 sc1
  buffer_load_dwordx4 a[248:251], v2, s[8:11], s22 offen offset:2048 sc1
  buffer_load_dwordx4 a[252:255], v2, s[8:11], s22 offen offset:3072 sc1
  s_add_u32 s22, s31, 294912
  buffer_load_dwordx4 v[120:123], v2, s[8:11], s22 offen offset:0 sc1
  buffer_load_dwordx4 v[124:127], v2, s[8:11], s22 offen offset:1024 sc1
  buffer_load_dwordx4 v[128:131], v2, s[8:11], s22 offen offset:2048 sc1
  buffer_load_dwordx4 v[132:135], v2, s[8:11], s22 offen offset:3072 sc1
  s_add_u32 s22, s31, 299008
  buffer_load_dwordx4 v[136:139], v2, s[8:11], s22 offen offset:0 sc1
  buffer_load_dwordx4 v[140:143], v2, s[8:11], s22 offen offset:1024 sc1
  buffer_load_dwordx4 v[144:147], v2, s[8:11], s22 offen offset:2048 sc1
  buffer_load_dwordx4 v[148:151], v2, s[8:11], s22 offen offset:3072 sc1
  s_add_u32 s22, s31, 303104
  buffer_load_dwordx4 v[152:155], v2, s[8:11], s22 offen offset:0 sc1
  buffer_load_dwordx4 v[156:159], v2, s[8:11], s22 offen offset:1024 sc1
  buffer_load_dwordx4 v[160:163], v2, s[8:11], s22 offen offset:2048 sc1
  buffer_load_dwordx4 v[164:167], v2, s[8:11], s22 offen offset:3072 sc1
  s_add_u32 s22, s31, 307200
  buffer_load_dwordx4 v[168:171], v2, s[8:11], s22 offen offset:0 sc1
  buffer_load_dwordx4 v[172:175], v2, s[8:11], s22 offen offset:1024 sc1
  buffer_load_dwordx4 v[176:179], v2, s[8:11], s22 offen offset:2048 sc1
  buffer_load_dwordx4 v[180:183], v2, s[8:11], s22 offen offset:3072 sc1
  s_mov_b32 s24, 72028160
  s_mov_b32 s26, 72042496
  v_and_b32 v64, 7, v117
  v_and_b32 v65, 1, v116
  v_lshlrev_b32 v65, 2, v65
  v_sub_u32 v64, v64, v65
  v_lshrrev_b32 v65, 3, v117
  v_lshl_add_u32 v66, v65, 2, v64
  v_cmp_gt_u32 vcc, 4, v64
  v_mov_b32 v67, 99
  s_nop 0
  v_cndmask_b32 v66, v67, v66, vcc
  v_mov_b32 v68, 0x3f80
  v_mov_b32 v69, 0x3f800000
  v_mov_b32 v4, 0
  v_cmp_eq_u32 vcc, 0, v66
  s_nop 1
  v_cndmask_b32 v4, v4, v68, vcc
  v_cmp_eq_u32 vcc, 1, v66
  s_nop 1
  v_cndmask_b32 v4, v4, v69, vcc
  v_mov_b32 v5, 0
  v_cmp_eq_u32 vcc, 2, v66
  s_nop 1
  v_cndmask_b32 v5, v5, v68, vcc
  v_cmp_eq_u32 vcc, 3, v66
  s_nop 1
  v_cndmask_b32 v5, v5, v69, vcc
  v_mov_b32 v6, 0
  v_cmp_eq_u32 vcc, 4, v66
  s_nop 1
  v_cndmask_b32 v6, v6, v68, vcc
  v_cmp_eq_u32 vcc, 5, v66
  s_nop 1
  v_cndmask_b32 v6, v6, v69, vcc
  v_mov_b32 v7, 0
  v_cmp_eq_u32 vcc, 6, v66
  s_nop 1
  v_cndmask_b32 v7, v7, v68, vcc
  v_cmp_eq_u32 vcc, 7, v66
  s_nop 1
  v_cndmask_b32 v7, v7, v69, vcc
  v_lshrrev_b32 v64, 1, v116
  v_lshrrev_b32 v65, 3, v117
  v_and_b32 v66, 1, v116
  v_and_b32 v68, 7, v117
  v_lshlrev_b32 v67, 8, v65
  v_lshl_add_u32 v67, v68, 5, v67
  v_lshl_add_u32 v67, v66, 4, v67
  v_add_u32 v69, 5184, v67
  v_add_u32 v70, 6400, v67
  v_cmp_eq_u32 vcc, v64, v65
  s_nop 1
  v_cndmask_b32 v113, v70, v69, vcc
  v_and_b32 v0, 15, v1
  s_and_b32 s22, s17, 0
  s_lshl_b32 s22, s22, 7
  s_add_u32 s22, s22, 75731456
  v_lshl_add_u32 v0, v0, 2, s22
  v_xor_b32 v69, 256, v2
  v_mul_i32_i24 v70, -2048, v66
  v_add_u32 v69, v69, v70
  v_add_u32 v117, 8192, v69
  v_mov_b32 v116, v73
  s_mul_i32 s35, s17, 28672
  s_add_u32 s35, s35, 44040192
  v_mov_b32 v36, 0
  v_mov_b32 v37, 0
  v_mov_b32 v38, 0
  v_mov_b32 v39, 0
  v_mov_b32 v40, 0
  v_mov_b32 v41, 0
  v_mov_b32 v42, 0
  v_mov_b32 v43, 0
  v_mov_b32 v44, 0
  v_mov_b32 v45, 0
  v_mov_b32 v46, 0
  v_mov_b32 v47, 0
  v_mov_b32 v48, 0
  v_mov_b32 v49, 0
  v_mov_b32 v50, 0
  v_mov_b32 v51, 0
  v_mov_b32 v52, 0
  v_mov_b32 v53, 0
  v_mov_b32 v54, 0
  v_mov_b32 v55, 0
  v_mov_b32 v56, 0
  v_mov_b32 v57, 0
  v_mov_b32 v58, 0
  v_mov_b32 v59, 0
  v_mov_b32 v60, 0
  v_mov_b32 v61, 0
  v_mov_b32 v62, 0
  v_mov_b32 v63, 0
  v_mov_b32 v64, 0
  v_mov_b32 v65, 0
  v_mov_b32 v66, 0
  v_mov_b32 v67, 0
  v_mov_b32 v68, 0
  v_mov_b32 v69, 0
  v_mov_b32 v70, 0
  v_mov_b32 v71, 0
  v_mov_b32 v72, 0
  v_mov_b32 v73, 0
  v_mov_b32 v74, 0
  v_mov_b32 v75, 0
  v_mov_b32 v76, 0
  v_mov_b32 v77, 0
  v_mov_b32 v78, 0
  v_mov_b32 v79, 0
  s_mov_b32 s22, 75694080
  v_lshrrev_b32 v14, 4, v2
  v_add_u32 v14, 128, v14
  v_min_u32 v14, 308, v14
  v_lshlrev_b32 v14, 7, v14
  buffer_load_dword v15, v14, s[8:11], s22 offen sc1
  buffer_load_dwordx4 v[80:83], v117, s[8:11], s24 offen offset:0 sc1
  buffer_load_dwordx4 v[84:87], v117, s[8:11], s24 offen offset:1024 sc1
  buffer_load_dwordx4 v[88:91], v117, s[8:11], s26 offen offset:0 sc1
  buffer_load_dwordx4 v[92:95], v117, s[8:11], s26 offen offset:1024 sc1
  buffer_load_dwordx4 v[96:99], v2, s[8:11], s24 offen offset:0 sc1
  buffer_load_dwordx4 v[100:103], v2, s[8:11], s24 offen offset:1024 sc1
  buffer_load_dwordx4 v[104:107], v2, s[8:11], s26 offen offset:0 sc1
  buffer_load_dwordx4 v[108:111], v2, s[8:11], s26 offen offset:1024 sc1
  s_add_u32 s22, s31, 311296
  buffer_load_dwordx4 v[184:187], v2, s[8:11], s22 offen offset:0 sc1
  buffer_load_dwordx4 v[188:191], v2, s[8:11], s22 offen offset:1024 sc1
  buffer_load_dwordx4 v[192:195], v2, s[8:11], s22 offen offset:2048 sc1
  buffer_load_dwordx4 v[196:199], v2, s[8:11], s22 offen offset:3072 sc1
  s_add_u32 s22, s31, 385024
  buffer_load_dwordx4 v[200:203], v2, s[8:11], s22 offen offset:2048 sc1
  buffer_load_dwordx4 v[204:207], v2, s[8:11], s22 offen offset:3072 sc1
  s_add_u32 s22, s31, 389120
  buffer_load_dwordx4 v[208:211], v2, s[8:11], s22 offen offset:0 sc1
  buffer_load_dwordx4 v[212:215], v2, s[8:11], s22 offen offset:1024 sc1
  buffer_load_dwordx4 v[216:219], v2, s[8:11], s22 offen offset:2048 sc1
  buffer_load_dwordx4 v[220:223], v2, s[8:11], s22 offen offset:3072 sc1
  s_add_u32 s22, s31, 393216
  buffer_load_dwordx4 v[224:227], v2, s[8:11], s22 offen offset:0 sc1
  buffer_load_dwordx4 v[228:231], v2, s[8:11], s22 offen offset:1024 sc1
  buffer_load_dwordx4 v[232:235], v2, s[8:11], s22 offen offset:2048 sc1
  buffer_load_dwordx4 v[236:239], v2, s[8:11], s22 offen offset:3072 sc1
  s_add_u32 s22, s31, 397312
  buffer_load_dwordx4 v[240:243], v2, s[8:11], s22 offen offset:0 sc1
  buffer_load_dwordx4 v[244:247], v2, s[8:11], s22 offen offset:1024 sc1
  buffer_load_dwordx4 v[248:251], v2, s[8:11], s22 offen offset:2048 sc1
  buffer_load_dwordx4 v[252:255], v2, s[8:11], s22 offen offset:3072 sc1
  s_waitcnt vmcnt(0) lgkmcnt(0)
  s_mov_b32 s31, 0
  s_cmp_lg_u32 s88, 0
  s_cbranch_scc1 cB_sc2_loop
  s_branch cA_sc2_loop
ch_init3:
  s_mul_i32 s31, s17, 401408
  s_add_u32 s31, s31, 0
  s_and_b32 s28, s84, 12384
  s_lshl_b32 s22, s85, 16
  s_or_b32 s28, s28, s22
  s_cmp_eq_u32 s28, 4294914144
  s_cbranch_scc1 ch_wx3_ok
  s_mov_b32 s30, 0
ch_wr3:
  buffer_load_dword v9, off, s[12:15], 0 offset:132 sc1
  s_waitcnt vmcnt(0)
  v_cmp_ne_u32 vcc, 1, v9
  s_cbranch_vccz ch_wr3_ok
  s_sleep 8
  s_add_u32 s30, s30, 1
  s_cmp_lt_u32 s30, 400000
  s_cbranch_scc1 ch_wr3
  s_branch cA_abort
ch_wr3_ok:
  s_lshl_b32 s27, s17, 7
  s_add_u32 s27, s27, 88521216
  s_mov_b32 s28, 12384
  s_mov_b32 s30, 0
ch_wb3:
  buffer_load_dword v9, off, s[8:11], s27  sc1
  s_waitcnt vmcnt(0)
  v_and_b32 v10, s28, v9
  v_cmp_ne_u32 vcc, s28, v10
  s_cbranch_vccz ch_wb3_ok
  s_sleep 3
  s_add_u32 s30, s30, 1
  s_cmp_lt_u32 s30, 400000
  s_cbranch_scc1 ch_wb3
  s_branch cA_abort
ch_wb3_ok:
  s_mov_b32 s29, 88523264
  s_mov_b32 s28, 0xffff
  s_mov_b32 s30, 0
ch_wx3:
  buffer_load_dword v9, off, s[8:11], s29  sc1
  s_waitcnt vmcnt(0)
  v_and_b32 v10, s28, v9
  v_cmp_ne_u32 vcc, s28, v10
  s_cbranch_vccz ch_wx3_ok
  s_sleep 8
  s_add_u32 s30, s30, 1
  s_cmp_lt_u32 s30, 400000
  s_cbranch_scc1 ch_wx3
  s_branch cA_abort
ch_wx3_ok:
  s_add_u32 s22, s31, 315392
  buffer_load_dwordx4 a[224:227], v2, s[8:11], s22 offen offset:0 sc1
  buffer_load_dwordx4 a[228:231], v2, s[8:11], s22 offen offset:1024 sc1
  buffer_load_dwordx4 a[232:235], v2, s[8:11], s22 offen offset:2048 sc1
  buffer_load_dwordx4 a[236:239], v2, s[8:11], s22 offen offset:3072 sc1
  s_add_u32 s22, s31, 319488
  buffer_load_dwordx4 a[240:243], v2, s[8:11], s22 offen offset:0 sc1
  buffer_load_dwordx4 a[244:247], v2, s[8:11], s22 offen offset:1024 sc1
  buffer_load_dwordx4 a[248:251], v2, s[8:11], s22 offen offset:2048 sc1
  buffer_load_dwordx4 a[252:255], v2, s[8:11], s22 offen offset:3072 sc1
  s_add_u32 s22, s31, 323584
  buffer_load_dwordx4 v[120:123], v2, s[8:11], s22 offen offset:0 sc1
  buffer_load_dwordx4 v[124:127], v2, s[8:11], s22 offen offset:1024 sc1
  buffer_load_dwordx4 v[128:131], v2, s[8:11], s22 offen offset:2048 sc1
  buffer_load_dwordx4 v[132:135], v2, s[8:11], s22 offen offset:3072 sc1
  s_add_u32 s22, s31, 327680
  buffer_load_dwordx4 v[136:139], v2, s[8:11], s22 offen offset:0 sc1
  buffer_load_dwordx4 v[140:143], v2, s[8:11], s22 offen offset:1024 sc1
  buffer_load_dwordx4 v[144:147], v2, s[8:11], s22 offen offset:2048 sc1
  buffer_load_dwordx4 v[148:151], v2, s[8:11], s22 offen offset:3072 sc1
  s_add_u32 s22, s31, 331776
  buffer_load_dwordx4 v[152:155], v2, s[8:11], s22 offen offset:0 sc1
  buffer_load_dwordx4 v[156:159], v2, s[8:11], s22 offen offset:1024 sc1
  buffer_load_dwordx4 v[160:163], v2, s[8:11], s22 offen offset:2048 sc1
  buffer_load_dwordx4 v[164:167], v2, s[8:11], s22 offen offset:3072 sc1
  s_add_u32 s22, s31, 335872
  buffer_load_dwordx4 v[168:171], v2, s[8:11], s22 offen offset:0 sc1
  buffer_load_dwordx4 v[172:175], v2, s[8:11], s22 offen offset:1024 sc1
  buffer_load_dwordx4 v[176:179], v2, s[8:11], s22 offen offset:2048 sc1
  buffer_load_dwordx4 v[180:183], v2, s[8:11], s22 offen offset:3072 sc1
  s_mov_b32 s24, 72030208
  s_mov_b32 s26, 72044544
  v_and_b32 v64, 7, v117
  v_and_b32 v65, 1, v116
  v_lshlrev_b32 v65, 2, v65
  v_sub_u32 v64, v64, v65
  v_lshrrev_b32 v65, 3, v117
  v_lshl_add_u32 v66, v65, 2, v64
  v_cmp_gt_u32 vcc, 4, v64
  v_mov_b32 v67, 99
  s_nop 0
  v_cndmask_b32 v66, v67, v66, vcc
  v_mov_b32 v68, 0x3f80
  v_mov_b32 v69, 0x3f800000
  v_mov_b32 v4, 0
  v_cmp_eq_u32 vcc, 0, v66
  s_nop 1
  v_cndmask_b32 v4, v4, v68, vcc
  v_cmp_eq_u32 vcc, 1, v66
  s_nop 1
  v_cndmask_b32 v4, v4, v69, vcc
  v_mov_b32 v5, 0
  v_cmp_eq_u32 vcc, 2, v66
  s_nop 1
  v_cndmask_b32 v5, v5, v68, vcc
  v_cmp_eq_u32 vcc, 3, v66
  s_nop 1
  v_cndmask_b32 v5, v5, v69, vcc
  v_mov_b32 v6, 0
  v_cmp_eq_u32 vcc, 4, v66
  s_nop 1
  v_cndmask_b32 v6, v6, v68, vcc
  v_cmp_eq_u32 vcc, 5, v66
  s_nop 1
  v_cndmask_b32 v6, v6, v69, vcc
  v_mov_b32 v7, 0
  v_cmp_eq_u32 vcc, 6, v66
  s_nop 1
  v_cndmask_b32 v7, v7, v68, vcc
  v_cmp_eq_u32 vcc, 7, v66
  s_nop 1
  v_cndmask_b32 v7, v7, v69, vcc
  v_lshrrev_b32 v64, 1, v116
  v_lshrrev_b32 v65, 3, v117
  v_and_b32 v66, 1, v116
  v_and_b32 v68, 7, v117
  v_lshlrev_b32 v67, 8, v65
  v_lshl_add_u32 v67, v68, 5, v67
  v_lshl_add_u32 v67, v66, 4, v67
  v_add_u32 v69, 5696, v67
  v_add_u32 v70, 6400, v67
  v_cmp_eq_u32 vcc, v64, v65
  s_nop 1
  v_cndmask_b32 v113, v70, v69, vcc
  v_and_b32 v0, 15, v1
  s_and_b32 s22, s17, 0
  s_lshl_b32 s22, s22, 7
  s_add_u32 s22, s22, 75731456
  v_lshl_add_u32 v0, v0, 2, s22
  v_xor_b32 v69, 256, v2
  v_mul_i32_i24 v70, 2048, v66
  v_add_u32 v69, v69, v70
  v_add_u32 v117, 4096, v69
  v_mov_b32 v116, v73
  s_mul_i32 s35, s17, 28672
  s_add_u32 s35, s35, 44040192
  v_mov_b32 v36, 0
  v_mov_b32 v37, 0
  v_mov_b32 v38, 0
  v_mov_b32 v39, 0
  v_mov_b32 v40, 0
  v_mov_b32 v41, 0
  v_mov_b32 v42, 0
  v_mov_b32 v43, 0
  v_mov_b32 v44, 0
  v_mov_b32 v45, 0
  v_mov_b32 v46, 0
  v_mov_b32 v47, 0
  v_mov_b32 v48, 0
  v_mov_b32 v49, 0
  v_mov_b32 v50, 0
  v_mov_b32 v51, 0
  v_mov_b32 v52, 0
  v_mov_b32 v53, 0
  v_mov_b32 v54, 0
  v_mov_b32 v55, 0
  v_mov_b32 v56, 0
  v_mov_b32 v57, 0
  v_mov_b32 v58, 0
  v_mov_b32 v59, 0
  v_mov_b32 v60, 0
  v_mov_b32 v61, 0
  v_mov_b32 v62, 0
  v_mov_b32 v63, 0
  v_mov_b32 v64, 0
  v_mov_b32 v65, 0
  v_mov_b32 v66, 0
  v_mov_b32 v67, 0
  v_mov_b32 v68, 0
  v_mov_b32 v69, 0
  v_mov_b32 v70, 0
  v_mov_b32 v71, 0
  v_mov_b32 v72, 0
  v_mov_b32 v73, 0
  v_mov_b32 v74, 0
  v_mov_b32 v75, 0
  v_mov_b32 v76, 0
  v_mov_b32 v77, 0
  v_mov_b32 v78, 0
  v_mov_b32 v79, 0
  s_mov_b32 s22, 75694080
  v_lshrrev_b32 v14, 4, v2
  v_add_u32 v14, 192, v14
  v_min_u32 v14, 308, v14
  v_lshlrev_b32 v14, 7, v14
  buffer_load_dword v15, v14, s[8:11], s22 offen sc1
  buffer_load_dwordx4 v[80:83], v117, s[8:11], s24 offen offset:0 sc1
  buffer_load_dwordx4 v[84:87], v117, s[8:11], s24 offen offset:1024 sc1
  buffer_load_dwordx4 v[88:91], v117, s[8:11], s26 offen offset:0 sc1
  buffer_load_dwordx4 v[92:95], v117, s[8:11], s26 offen offset:1024 sc1
  buffer_load_dwordx4 v[96:99], v2, s[8:11], s24 offen offset:0 sc1
  buffer_load_dwordx4 v[100:103], v2, s[8:11], s24 offen offset:1024 sc1
  buffer_load_dwordx4 v[104:107], v2, s[8:11], s26 offen offset:0 sc1
  buffer_load_dwordx4 v[108:111], v2, s[8:11], s26 offen offset:1024 sc1
  s_add_u32 s22, s31, 339968
  buffer_load_dwordx4 v[184:187], v2, s[8:11], s22 offen offset:0 sc1
  buffer_load_dwordx4 v[188:191], v2, s[8:11], s22 offen offset:1024 sc1
  buffer_load_dwordx4 v[192:195], v2, s[8:11], s22 offen offset:2048 sc1
  buffer_load_dwordx4 v[196:199], v2, s[8:11], s22 offen offset:3072 sc1
  s_add_u32 s22, s31, 356352
  buffer_load_dwordx4 v[200:203], v2, s[8:11], s22 offen offset:2048 sc1
  buffer_load_dwordx4 v[204:207], v2, s[8:11], s22 offen offset:3072 sc1
  s_add_u32 s22, s31, 360448
  buffer_load_dwordx4 v[208:211], v2, s[8:11], s22 offen offset:0 sc1
  buffer_load_dwordx4 v[212:215], v2, s[8:11], s22 offen offset:1024 sc1
  buffer_load_dwordx4 v[216:219], v2, s[8:11], s22 offen offset:2048 sc1
  buffer_load_dwordx4 v[220:223], v2, s[8:11], s22 offen offset:3072 sc1
  s_add_u32 s22, s31, 364544
  buffer_load_dwordx4 v[224:227], v2, s[8:11], s22 offen offset:0 sc1
  buffer_load_dwordx4 v[228:231], v2, s[8:11], s22 offen offset:1024 sc1
  buffer_load_dwordx4 v[232:235], v2, s[8:11], s22 offen offset:2048 sc1
  buffer_load_dwordx4 v[236:239], v2, s[8:11], s22 offen offset:3072 sc1
  s_add_u32 s22, s31, 368640
  buffer_load_dwordx4 v[240:243], v2, s[8:11], s22 offen offset:0 sc1
  buffer_load_dwordx4 v[244:247], v2, s[8:11], s22 offen offset:1024 sc1
  buffer_load_dwordx4 v[248:251], v2, s[8:11], s22 offen offset:2048 sc1
  buffer_load_dwordx4 v[252:255], v2, s[8:11], s22 offen offset:3072 sc1
  s_waitcnt vmcnt(0) lgkmcnt(0)
  s_mov_b32 s31, 0
  s_cmp_lg_u32 s88, 0
  s_cbranch_scc1 cB_sc3_loop
  s_branch cA_sc3_loop
ch_init4:
  v_mov_b32 v72, v116
  v_mov_b32 v73, v117
  v_lshrrev_b32 v65, 1, v72
  v_and_b32 v66, 1, v72
  v_mov_b32 v36, 0
  v_mov_b32 v37, 0
  v_mov_b32 v38, 0
  v_mov_b32 v39, 0
  v_mov_b32 v40, 0
  v_mov_b32 v41, 0
  v_mov_b32 v42, 0
  v_mov_b32 v43, 0
  v_mov_b32 v44, 0
  v_mov_b32 v45, 0
  v_mov_b32 v46, 0
  v_mov_b32 v47, 0
  v_mov_b32 v48, 0
  v_mov_b32 v49, 0
  v_mov_b32 v50, 0
  v_mov_b32 v51, 0
  v_mov_b32 v52, 0
  v_mov_b32 v53, 0
  v_mov_b32 v54, 0
  v_mov_b32 v55, 0
  v_mov_b32 v56, 0
  v_mov_b32 v57, 0
  v_mov_b32 v58, 0
  v_mov_b32 v59, 0
  v_mov_b32 v60, 0
  v_mov_b32 v61, 0
  v_mov_b32 v62, 0
  v_mov_b32 v63, 0
  v_lshlrev_b32 v75, 2, v65
  v_lshl_add_u32 v75, v66, 3, v75
  v_add_u32 v67, 0, v73
  v_mul_u32_u24 v68, 2341, v67
  v_lshrrev_b32 v68, 16, v68
  v_mul_u32_u24 v69, 28, v68
  v_sub_u32 v69, v67, v69
  v_lshrrev_b32 v70, 4, v69
  v_and_b32 v69, 15, v69
  v_lshlrev_b32 v71, 12, v70
  v_lshl_add_u32 v71, v68, 8, v71
  v_lshl_add_u32 v71, v69, 4, v71
  v_add_u32 v152, v71, v75
  v_add_u32 v67, 16, v73
  v_mul_u32_u24 v68, 2341, v67
  v_lshrrev_b32 v68, 16, v68
  v_mul_u32_u24 v69, 28, v68
  v_sub_u32 v69, v67, v69
  v_lshrrev_b32 v70, 4, v69
  v_and_b32 v69, 15, v69
  v_lshlrev_b32 v71, 12, v70
  v_lshl_add_u32 v71, v68, 8, v71
  v_lshl_add_u32 v71, v69, 4, v71
  v_add_u32 v153, v71, v75
  v_add_u32 v67, 32, v73
  v_mul_u32_u24 v68, 2341, v67
  v_lshrrev_b32 v68, 16, v68
  v_mul_u32_u24 v69, 28, v68
  v_sub_u32 v69, v67, v69
  v_lshrrev_b32 v70, 4, v69
  v_and_b32 v69, 15, v69
  v_lshlrev_b32 v71, 12, v70
  v_lshl_add_u32 v71, v68, 8, v71
  v_lshl_add_u32 v71, v69, 4, v71
  v_add_u32 v154, v71, v75
  v_add_u32 v67, 48, v73
  v_mul_u32_u24 v68, 2341, v67
  v_lshrrev_b32 v68, 16, v68
  v_mul_u32_u24 v69, 28, v68
  v_sub_u32 v69, v67, v69
  v_lshrrev_b32 v70, 4, v69
  v_and_b32 v69, 15, v69
  v_lshlrev_b32 v71, 12, v70
  v_lshl_add_u32 v71, v68, 8, v71
  v_lshl_add_u32 v71, v69, 4, v71
  v_add_u32 v155, v71, v75
  v_add_u32 v67, 64, v73
  v_mul_u32_u24 v68, 2341, v67
  v_lshrrev_b32 v68, 16, v68
  v_mul_u32_u24 v69, 28, v68
  v_sub_u32 v69, v67, v69
  v_lshrrev_b32 v70, 4, v69
  v_and_b32 v69, 15, v69
  v_lshlrev_b32 v71, 12, v70
  v_lshl_add_u32 v71, v68, 8, v71
  v_lshl_add_u32 v71, v69, 4, v71
  v_add_u32 v156, v71, v75
  v_add_u32 v67, 80, v73
  v_mul_u32_u24 v68, 2341, v67
  v_lshrrev_b32 v68, 16, v68
  v_mul_u32_u24 v69, 28, v68
  v_sub_u32 v69, v67, v69
  v_lshrrev_b32 v70, 4, v69
  v_and_b32 v69, 15, v69
  v_lshlrev_b32 v71, 12, v70
  v_lshl_add_u32 v71, v68, 8, v71
  v_lshl_add_u32 v71, v69, 4, v71
  v_add_u32 v157, v71, v75
  v_add_u32 v67, 96, v73
  v_mul_u32_u24 v68, 2341, v67
  v_lshrrev_b32 v68, 16, v68
  v_mul_u32_u24 v69, 28, v68
  v_sub_u32 v69, v67, v69
  v_lshrrev_b32 v70, 4, v69
  v_and_b32 v69, 15, v69
  v_lshlrev_b32 v71, 12, v70
  v_lshl_add_u32 v71, v68, 8, v71
  v_lshl_add_u32 v71, v69, 4, v71
  v_add_u32 v158, v71, v75
  v_mov_b32 v74, 0x40000000
  v_mov_b32 v76, 0
  v_mov_b32 v77, 0
  v_mov_b32 v78, 0
  v_mov_b32 v79, 0
  ds_write_b128 v2, v[76:79] offset:0
  ds_write_b128 v2, v[76:79] offset:1024
  ds_write_b128 v2, v[76:79] offset:2048
  ds_write_b128 v2, v[76:79] offset:3072
  s_and_b32 s22, s17, 0
  s_lshl_b32 s22, s22, 7
  s_add_u32 s22, s22, 75729408
  v_lshl_add_u32 v4, v73, 2, s22
  v_and_b32 v64, 1, v73
  v_mov_b32 v5, 0x05040100
  v_mov_b32 v65, 0x03020706
  v_cmp_eq_u32 vcc, 1, v64
  s_nop 1
  v_cndmask_b32 v5, v5, v65, vcc
  s_lshl_b32 s22, s17, 2
  s_add_u32 s22, s22, 75733504
  v_lshl_add_u32 v7, v1, 7, s22
  v_cmp_gt_u32 vcc, 1, v1
  s_nop 1
  v_cndmask_b32 v7, v74, v7, vcc
  v_mov_b32 v6, v2
  v_lshl_add_u32 v64, v66, 2, v64
  v_and_b32 v65, 2, v72
  v_add_u32 v64, v64, v65
  s_mul_i32 s22, s17, 16
  v_add_u32 v75, s22, v73
  v_lshrrev_b32 v68, 4, v75
  v_lshlrev_b32 v68, 8, v68
  v_bfe_u32 v69, v75, 1, 1
  v_lshl_add_u32 v68, v69, 7, v68
  v_lshl_add_u32 v68, v64, 4, v68
  v_and_b32 v69, 12, v75
  v_add_u32 v1, v68, v69
  s_mul_i32 s22, s17, 28672
  s_add_u32 s25, s22, 42205184
  s_and_b32 s27, s17, 0
  s_xor_b32 s22, s27, 0
  s_mul_i32 s80, s22, 7168
  s_lshl_b32 s22, s22, 11
  s_add_u32 s76, s22, 9216
  s_xor_b32 s22, s27, 1
  s_mul_i32 s81, s22, 7168
  s_lshl_b32 s22, s22, 11
  s_add_u32 s77, s22, 9216
  s_xor_b32 s22, s27, 2
  s_mul_i32 s82, s22, 7168
  s_lshl_b32 s22, s22, 11
  s_add_u32 s78, s22, 9216
  s_xor_b32 s22, s27, 3
  s_mul_i32 s83, s22, 7168
  s_lshl_b32 s22, s22, 11
  s_add_u32 s79, s22, 9216
  v_mov_b32 v162, -1
  s_mov_b32 s38, 0x40000000
  v_add_u32 v0, 16384, v2
  s_mul_i32 s31, s17, 401408
  s_add_u32 s31, s31, 6422528
  s_mov_b32 s30, 0
ch_wr4:
  buffer_load_dword v9, off, s[12:15], 0 offset:128 sc1
  s_waitcnt vmcnt(0)
  v_cmp_ne_u32 vcc, 1, v9
  s_cbranch_vccz ch_wr4_ok
  s_sleep 8
  s_add_u32 s30, s30, 1
  s_cmp_lt_u32 s30, 400000
  s_cbranch_scc1 ch_wr4
  s_branch cA_abort
ch_wr4_ok:
  s_lshr_b32 s22, s17, 2
  s_lshl_b32 s28, 0x81, s22
  s_mul_i32 s27, s17, 12
  s_add_u32 s22, s27, 256
  s_lshr_b32 s22, s22, 6
  s_lshl_b32 s22, 0x81, s22
  s_or_b32 s28, s28, s22
  s_add_u32 s22, s27, 267
  s_lshr_b32 s22, s22, 6
  s_lshl_b32 s22, 0x81, s22
  s_or_b32 s28, s28, s22
  v_lshrrev_b32 v12, 8, v2
  v_lshlrev_b32 v12, 7, v12
  s_mov_b32 s27, 88519168
  s_mov_b32 s30, 0
ch_ww4:
  buffer_load_dword v9, v12, s[8:11], s27 offen sc1
  s_waitcnt vmcnt(0)
  v_and_b32 v10, s28, v9
  v_cmp_ne_u32 vcc, s28, v10
  s_cbranch_vccz ch_ww4_ok
  s_sleep 3
  s_add_u32 s30, s30, 1
  s_cmp_lt_u32 s30, 400000
  s_cbranch_scc1 ch_ww4
  s_branch cA_abort
ch_ww4_ok:
  s_add_u32 s22, s31, 0
  buffer_load_dwordx4 a[0:3], v2, s[8:11], s22 offen offset:0 sc1
  buffer_load_dwordx4 a[4:7], v2, s[8:11], s22 offen offset:1024 sc1
  buffer_load_dwordx4 a[8:11], v2, s[8:11], s22 offen offset:2048 sc1
  buffer_load_dwordx4 a[12:15], v2, s[8:11], s22 offen offset:3072 sc1
  s_add_u32 s22, s31, 4096
  buffer_load_dwordx4 a[16:19], v2, s[8:11], s22 offen offset:0 sc1
  buffer_load_dwordx4 a[20:23], v2, s[8:11], s22 offen offset:1024 sc1
  buffer_load_dwordx4 a[24:27], v2, s[8:11], s22 offen offset:2048 sc1
  buffer_load_dwordx4 a[28:31], v2, s[8:11], s22 offen offset:3072 sc1
  s_add_u32 s22, s31, 8192
  buffer_load_dwordx4 a[32:35], v2, s[8:11], s22 offen offset:0 sc1
  buffer_load_dwordx4 a[36:39], v2, s[8:11], s22 offen offset:1024 sc1
  buffer_load_dwordx4 a[40:43], v2, s[8:11], s22 offen offset:2048 sc1
  buffer_load_dwordx4 a[44:47], v2, s[8:11], s22 offen offset:3072 sc1
  s_add_u32 s22, s31, 12288
  buffer_load_dwordx4 a[48:51], v2, s[8:11], s22 offen offset:0 sc1
  buffer_load_dwordx4 a[52:55], v2, s[8:11], s22 offen offset:1024 sc1
  buffer_load_dwordx4 a[56:59], v2, s[8:11], s22 offen offset:2048 sc1
  buffer_load_dwordx4 a[60:63], v2, s[8:11], s22 offen offset:3072 sc1
  s_add_u32 s22, s31, 16384
  buffer_load_dwordx4 a[64:67], v2, s[8:11], s22 offen offset:0 sc1
  buffer_load_dwordx4 a[68:71], v2, s[8:11], s22 offen offset:1024 sc1
  buffer_load_dwordx4 a[72:75], v2, s[8:11], s22 offen offset:2048 sc1
  buffer_load_dwordx4 a[76:79], v2, s[8:11], s22 offen offset:3072 sc1
  s_add_u32 s22, s31, 20480
  buffer_load_dwordx4 a[80:83], v2, s[8:11], s22 offen offset:0 sc1
  buffer_load_dwordx4 a[84:87], v2, s[8:11], s22 offen offset:1024 sc1
  buffer_load_dwordx4 a[88:91], v2, s[8:11], s22 offen offset:2048 sc1
  buffer_load_dwordx4 a[92:95], v2, s[8:11], s22 offen offset:3072 sc1
  s_add_u32 s22, s31, 24576
  buffer_load_dwordx4 a[96:99], v2, s[8:11], s22 offen offset:0 sc1
  buffer_load_dwordx4 a[100:103], v2, s[8:11], s22 offen offset:1024 sc1
  buffer_load_dwordx4 a[104:107], v2, s[8:11], s22 offen offset:2048 sc1
  buffer_load_dwordx4 a[108:111], v2, s[8:11], s22 offen offset:3072 sc1
  s_add_u32 s22, s31, 28672
  buffer_load_dwordx4 a[112:115], v2, s[8:11], s22 offen offset:0 sc1
  buffer_load_dwordx4 a[116:119], v2, s[8:11], s22 offen offset:1024 sc1
  buffer_load_dwordx4 a[120:123], v2, s[8:11], s22 offen offset:2048 sc1
  buffer_load_dwordx4 a[124:127], v2, s[8:11], s22 offen offset:3072 sc1
  s_waitcnt vmcnt(24)
  s_add_u32 s22, s31, 32768
  buffer_load_dwordx4 a[128:131], v2, s[8:11], s22 offen offset:0 sc1
  buffer_load_dwordx4 a[132:135], v2, s[8:11], s22 offen offset:1024 sc1
  buffer_load_dwordx4 a[136:139], v2, s[8:11], s22 offen offset:2048 sc1
  buffer_load_dwordx4 a[140:143], v2, s[8:11], s22 offen offset:3072 sc1
  s_add_u32 s22, s31, 36864
  buffer_load_dwordx4 a[144:147], v2, s[8:11], s22 offen offset:0 sc1
  buffer_load_dwordx4 a[148:151], v2, s[8:11], s22 offen offset:1024 sc1
  buffer_load_dwordx4 a[152:155], v2, s[8:11], s22 offen offset:2048 sc1
  buffer_load_dwordx4 a[156:159], v2, s[8:11], s22 offen offset:3072 sc1
  s_add_u32 s22, s31, 40960
  buffer_load_dwordx4 a[160:163], v2, s[8:11], s22 offen offset:0 sc1
  buffer_load_dwordx4 a[164:167], v2, s[8:11], s22 offen offset:1024 sc1
  buffer_load_dwordx4 a[168:171], v2, s[8:11], s22 offen offset:2048 sc1
  buffer_load_dwordx4 a[172:175], v2, s[8:11], s22 offen offset:3072 sc1
  s_add_u32 s22, s31, 45056
  buffer_load_dwordx4 a[176:179], v2, s[8:11], s22 offen offset:0 sc1
  buffer_load_dwordx4 a[180:183], v2, s[8:11], s22 offen offset:1024 sc1
  buffer_load_dwordx4 a[184:187], v2, s[8:11], s22 offen offset:2048 sc1
  buffer_load_dwordx4 a[188:191], v2, s[8:11], s22 offen offset:3072 sc1
  s_add_u32 s22, s31, 49152
  buffer_load_dwordx4 a[192:195], v2, s[8:11], s22 offen offset:0 sc1
  buffer_load_dwordx4 a[196:199], v2, s[8:11], s22 offen offset:1024 sc1
  buffer_load_dwordx4 a[200:203], v2, s[8:11], s22 offen offset:2048 sc1
  buffer_load_dwordx4 a[204:207], v2, s[8:11], s22 offen offset:3072 sc1
  s_add_u32 s22, s31, 53248
  buffer_load_dwordx4 a[208:211], v2, s[8:11], s22 offen offset:0 sc1
  buffer_load_dwordx4 a[212:215], v2, s[8:11], s22 offen offset:1024 sc1
  buffer_load_dwordx4 a[216:219], v2, s[8:11], s22 offen offset:2048 sc1
  buffer_load_dwordx4 a[220:223], v2, s[8:11], s22 offen offset:3072 sc1
  s_add_u32 s22, s31, 57344
  buffer_load_dwordx4 a[224:227], v2, s[8:11], s22 offen offset:0 sc1
  buffer_load_dwordx4 a[228:231], v2, s[8:11], s22 offen offset:1024 sc1
  buffer_load_dwordx4 a[232:235], v2, s[8:11], s22 offen offset:2048 sc1
  buffer_load_dwordx4 a[236:239], v2, s[8:11], s22 offen offset:3072 sc1
  s_add_u32 s22, s31, 61440
  buffer_load_dwordx4 a[240:243], v2, s[8:11], s22 offen offset:0 sc1
  buffer_load_dwordx4 a[244:247], v2, s[8:11], s22 offen offset:1024 sc1
  buffer_load_dwordx4 a[248:251], v2, s[8:11], s22 offen offset:2048 sc1
  buffer_load_dwordx4 a[252:255], v2, s[8:11], s22 offen offset:3072 sc1
  s_waitcnt vmcnt(24)
  s_add_u32 s22, s31, 65536
  buffer_load_dwordx4 v[176:179], v2, s[8:11], s22 offen offset:0 sc1
  buffer_load_dwordx4 v[180:183], v2, s[8:11], s22 offen offset:1024 sc1
  buffer_load_dwordx4 v[184:187], v2, s[8:11], s22 offen offset:2048 sc1
  buffer_load_dwordx4 v[188:191], v2, s[8:11], s22 offen offset:3072 sc1
  s_add_u32 s22, s31, 69632
  buffer_load_dwordx4 v[192:195], v2, s[8:11], s22 offen offset:0 sc1
  buffer_load_dwordx4 v[196:199], v2, s[8:11], s22 offen offset:1024 sc1
  buffer_load_dwordx4 v[200:203], v2, s[8:11], s22 offen offset:2048 sc1
  buffer_load_dwordx4 v[204:207], v2, s[8:11], s22 offen offset:3072 sc1
  s_add_u32 s22, s31, 73728
  buffer_load_dwordx4 v[208:211], v2, s[8:11], s22 offen offset:0 sc1
  buffer_load_dwordx4 v[212:215], v2, s[8:11], s22 offen offset:1024 sc1
  buffer_load_dwordx4 v[216:219], v2, s[8:11], s22 offen offset:2048 sc1
  buffer_load_dwordx4 v[220:223], v2, s[8:11], s22 offen offset:3072 sc1
  s_add_u32 s22, s31, 77824
  buffer_load_dwordx4 v[224:227], v2, s[8:11], s22 offen offset:0 sc1
  buffer_load_dwordx4 v[228:231], v2, s[8:11], s22 offen offset:1024 sc1
  buffer_load_dwordx4 v[232:235], v2, s[8:11], s22 offen offset:2048 sc1
  buffer_load_dwordx4 v[236:239], v2, s[8:11], s22 offen offset:3072 sc1
  s_add_u32 s22, s31, 81920
  buffer_load_dwordx4 v[240:243], v2, s[8:11], s22 offen offset:0 sc1
  buffer_load_dwordx4 v[244:247], v2, s[8:11], s22 offen offset:1024 sc1
  buffer_load_dwordx4 v[248:251], v2, s[8:11], s22 offen offset:2048 sc1
  buffer_load_dwordx4 v[252:255], v2, s[8:11], s22 offen offset:3072 sc1
  s_mov_b32 m0, 16384
  s_add_u32 s22, s31, 86016
  buffer_load_dwordx4 v2, s[8:11], s22 offen offset:0 sc1 lds
  buffer_load_dwordx4 v2, s[8:11], s22 offen offset:1024 sc1 lds
  buffer_load_dwordx4 v2, s[8:11], s22 offen offset:2048 sc1 lds
  buffer_load_dwordx4 v2, s[8:11], s22 offen offset:3072 sc1 lds
  s_mov_b32 m0, 20480
  s_add_u32 s22, s31, 90112
  buffer_load_dwordx4 v2, s[8:11], s22 offen offset:0 sc1 lds
  buffer_load_dwordx4 v2, s[8:11], s22 offen offset:1024 sc1 lds
  buffer_load_dwordx4 v2, s[8:11], s22 offen offset:2048 sc1 lds
  buffer_load_dwordx4 v2, s[8:11], s22 offen offset:3072 sc1 lds
  s_mov_b32 m0, 24576
  s_add_u32 s22, s31, 94208
  buffer_load_dwordx4 v2, s[8:11], s22 offen offset:0 sc1 lds
  buffer_load_dwordx4 v2, s[8:11], s22 offen offset:1024 sc1 lds
  buffer_load_dwordx4 v2, s[8:11], s22 offen offset:2048 sc1 lds
  buffer_load_dwordx4 v2, s[8:11], s22 offen offset:3072 sc1 lds
  s_mov_b32 m0, 28672
  s_add_u32 s22, s31, 98304
  buffer_load_dwordx4 v2, s[8:11], s22 offen offset:0 sc1 lds
  buffer_load_dwordx4 v2, s[8:11], s22 offen offset:1024 sc1 lds
  s_mov_b32 s28, s35
  s_waitcnt vmcnt(0) lgkmcnt(0)
  s_mov_b32 s31, 0
  s_cmp_lg_u32 s88, 0
  s_cbranch_scc1 cB_va0_loop
  s_branch cA_va0_loop
ch_init5:
  v_mov_b32 v72, v116
  v_mov_b32 v73, v117
  v_lshrrev_b32 v65, 1, v72
  v_and_b32 v66, 1, v72
  v_mov_b32 v36, 0
  v_mov_b32 v37, 0
  v_mov_b32 v38, 0
  v_mov_b32 v39, 0
  v_mov_b32 v40, 0
  v_mov_b32 v41, 0
  v_mov_b32 v42, 0
  v_mov_b32 v43, 0
  v_mov_b32 v44, 0
  v_mov_b32 v45, 0
  v_mov_b32 v46, 0
  v_mov_b32 v47, 0
  v_mov_b32 v48, 0
  v_mov_b32 v49, 0
  v_mov_b32 v50, 0
  v_mov_b32 v51, 0
  v_mov_b32 v52, 0
  v_mov_b32 v53, 0
  v_mov_b32 v54, 0
  v_mov_b32 v55, 0
  v_mov_b32 v56, 0
  v_mov_b32 v57, 0
  v_mov_b32 v58, 0
  v_mov_b32 v59, 0
  v_mov_b32 v60, 0
  v_mov_b32 v61, 0
  v_mov_b32 v62, 0
  v_mov_b32 v63, 0
  v_lshlrev_b32 v75, 2, v65
  v_lshl_add_u32 v75, v66, 3, v75
  v_add_u32 v67, 112, v73
  v_mul_u32_u24 v68, 2341, v67
  v_lshrrev_b32 v68, 16, v68
  v_mul_u32_u24 v69, 28, v68
  v_sub_u32 v69, v67, v69
  v_lshrrev_b32 v70, 4, v69
  v_and_b32 v69, 15, v69
  v_lshlrev_b32 v71, 12, v70
  v_lshl_add_u32 v71, v68, 8, v71
  v_lshl_add_u32 v71, v69, 4, v71
  v_add_u32 v152, v71, v75
  v_add_u32 v67, 128, v73
  v_mul_u32_u24 v68, 2341, v67
  v_lshrrev_b32 v68, 16, v68
  v_mul_u32_u24 v69, 28, v68
  v_sub_u32 v69, v67, v69
  v_lshrrev_b32 v70, 4, v69
  v_and_b32 v69, 15, v69
  v_lshlrev_b32 v71, 12, v70
  v_lshl_add_u32 v71, v68, 8, v71
  v_lshl_add_u32 v71, v69, 4, v71
  v_add_u32 v153, v71, v75
  v_add_u32 v67, 144, v73
  v_mul_u32_u24 v68, 2341, v67
  v_lshrrev_b32 v68, 16, v68
  v_mul_u32_u24 v69, 28, v68
  v_sub_u32 v69, v67, v69
  v_lshrrev_b32 v70, 4, v69
  v_and_b32 v69, 15, v69
  v_lshlrev_b32 v71, 12, v70
  v_lshl_add_u32 v71, v68, 8, v71
  v_lshl_add_u32 v71, v69, 4, v71
  v_add_u32 v154, v71, v75
  v_add_u32 v67, 160, v73
  v_mul_u32_u24 v68, 2341, v67
  v_lshrrev_b32 v68, 16, v68
  v_mul_u32_u24 v69, 28, v68
  v_sub_u32 v69, v67, v69
  v_lshrrev_b32 v70, 4, v69
  v_and_b32 v69, 15, v69
  v_lshlrev_b32 v71, 12, v70
  v_lshl_add_u32 v71, v68, 8, v71
  v_lshl_add_u32 v71, v69, 4, v71
  v_add_u32 v155, v71, v75
  v_add_u32 v67, 176, v73
  v_mul_u32_u24 v68, 2341, v67
  v_lshrrev_b32 v68, 16, v68
  v_mul_u32_u24 v69, 28, v68
  v_sub_u32 v69, v67, v69
  v_lshrrev_b32 v70, 4, v69
  v_and_b32 v69, 15, v69
  v_lshlrev_b32 v71, 12, v70
  v_lshl_add_u32 v71, v68, 8, v71
  v_lshl_add_u32 v71, v69, 4, v71
  v_add_u32 v156, v71, v75
  v_add_u32 v67, 192, v73
  v_mul_u32_u24 v68, 2341, v67
  v_lshrrev_b32 v68, 16, v68
  v_mul_u32_u24 v69, 28, v68
  v_sub_u32 v69, v67, v69
  v_lshrrev_b32 v70, 4, v69
  v_and_b32 v69, 15, v69
  v_lshlrev_b32 v71, 12, v70
  v_lshl_add_u32 v71, v68, 8, v71
  v_lshl_add_u32 v71, v69, 4, v71
  v_add_u32 v157, v71, v75
  v_add_u32 v67, 208, v73
  v_mul_u32_u24 v68, 2341, v67
  v_lshrrev_b32 v68, 16, v68
  v_mul_u32_u24 v69, 28, v68
  v_sub_u32 v69, v67, v69
  v_lshrrev_b32 v70, 4, v69
  v_and_b32 v69, 15, v69
  v_lshlrev_b32 v71, 12, v70
  v_lshl_add_u32 v71, v68, 8, v71
  v_lshl_add_u32 v71, v69, 4, v71
  v_add_u32 v158, v71, v75
  v_mov_b32 v74, 0x40000000
  v_mov_b32 v76, 0
  v_mov_b32 v77, 0
  v_mov_b32 v78, 0
  v_mov_b32 v79, 0
  ds_write_b128 v2, v[76:79] offset:4096
  ds_write_b128 v2, v[76:79] offset:5120
  ds_write_b128 v2, v[76:79] offset:6144
  ds_write_b128 v2, v[76:79] offset:7168
  s_and_b32 s22, s17, 0
  s_lshl_b32 s22, s22, 7
  s_add_u32 s22, s22, 75729408
  v_lshl_add_u32 v4, v73, 2, s22
  v_and_b32 v64, 1, v73
  v_mov_b32 v5, 0x05040100
  v_mov_b32 v65, 0x03020706
  v_cmp_eq_u32 vcc, 1, v64
  s_nop 1
  v_cndmask_b32 v5, v5, v65, vcc
  s_lshl_b32 s22, s17, 2
  s_add_u32 s22, s22, 75733504
  v_lshl_add_u32 v7, v1, 7, s22
  v_cmp_gt_u32 vcc, 1, v1
  s_nop 1
  v_cndmask_b32 v7, v74, v7, vcc
  v_min_u32 v65, 11, v73
  v_mad_u32_u24 v65, v72, 12, v65
  v_lshlrev_b32 v6, 4, v65
  v_add_u32 v6, 1024, v6
  v_lshl_add_u32 v64, v66, 2, v64
  v_and_b32 v65, 2, v72
  v_add_u32 v64, v64, v65
  s_mul_i32 s22, s17, 12
  s_add_u32 s22, s22, 256
  v_add_u32 v75, s22, v73
  v_lshrrev_b32 v68, 4, v75
  v_lshlrev_b32 v68, 8, v68
  v_bfe_u32 v69, v75, 1, 1
  v_lshl_add_u32 v68, v69, 7, v68
  v_lshl_add_u32 v68, v64, 4, v68
  v_and_b32 v69, 12, v75
  v_add_u32 v1, v68, v69
  v_cmp_gt_u32 vcc, 12, v73
  s_nop 1
  v_cndmask_b32 v1, v74, v1, vcc
  s_mul_i32 s22, s17, 28672
  s_add_u32 s25, s22, 42205184
  s_and_b32 s27, s17, 0
  s_xor_b32 s22, s27, 0
  s_mul_i32 s80, s22, 7168
  s_lshl_b32 s22, s22, 11
  s_add_u32 s76, s22, 9216
  s_xor_b32 s22, s27, 1
  s_mul_i32 s81, s22, 7168
  s_lshl_b32 s22, s22, 11
  s_add_u32 s77, s22, 9216
  s_xor_b32 s22, s27, 2
  s_mul_i32 s82, s22, 7168
  s_lshl_b32 s22, s22, 11
  s_add_u32 s78, s22, 9216
  s_xor_b32 s22, s27, 3
  s_mul_i32 s83, s22, 7168
  s_lshl_b32 s22, s22, 11
  s_add_u32 s79, s22, 9216
  v_mov_b32 v162, -1
  s_mov_b32 s38, 0x40000000
  v_add_u32 v0, 30720, v2
  s_mul_i32 s31, s17, 401408
  s_add_u32 s31, s31, 6522880
  s_mov_b32 s30, 0
ch_wr5:
  buffer_load_dword v9, off, s[12:15], 0 offset:128 sc1
  s_waitcnt vmcnt(0)
  v_cmp_ne_u32 vcc, 1, v9
  s_cbranch_vccz ch_wr5_ok
  s_sleep 8
  s_add_u32 s30, s30, 1
  s_cmp_lt_u32 s30, 400000
  s_cbranch_scc1 ch_wr5
  s_branch cA_abort
ch_wr5_ok:
  s_lshr_b32 s22, s17, 2
  s_lshl_b32 s28, 0x81, s22
  s_mul_i32 s27, s17, 12
  s_add_u32 s22, s27, 256
  s_lshr_b32 s22, s22, 6
  s_lshl_b32 s22, 0x81, s22
  s_or_b32 s28, s28, s22
  s_add_u32 s22, s27, 267
  s_lshr_b32 s22, s22, 6
  s_lshl_b32 s22, 0x81, s22
  s_or_b32 s28, s28, s22
  v_lshrrev_b32 v12, 8, v2
  v_lshlrev_b32 v12, 7, v12
  s_mov_b32 s27, 88519680
  s_mov_b32 s30, 0
ch_ww5:
  buffer_load_dword v9, v12, s[8:11], s27 offen sc1
  s_waitcnt vmcnt(0)
  v_and_b32 v10, s28, v9
  v_cmp_ne_u32 vcc, s28, v10
  s_cbranch_vccz ch_ww5_ok
  s_sleep 3
  s_add_u32 s30, s30, 1
  s_cmp_lt_u32 s30, 400000
  s_cbranch_scc1 ch_ww5
  s_branch cA_abort
ch_ww5_ok:
  s_add_u32 s22, s31, 0
  buffer_load_dwordx4 a[0:3], v2, s[8:11], s22 offen offset:0 sc1
  buffer_load_dwordx4 a[4:7], v2, s[8:11], s22 offen offset:1024 sc1
  buffer_load_dwordx4 a[8:11], v2, s[8:11], s22 offen offset:2048 sc1
  buffer_load_dwordx4 a[12:15], v2, s[8:11], s22 offen offset:3072 sc1
  s_add_u32 s22, s31, 4096
  buffer_load_dwordx4 a[16:19], v2, s[8:11], s22 offen offset:0 sc1
  buffer_load_dwordx4 a[20:23], v2, s[8:11], s22 offen offset:1024 sc1
  buffer_load_dwordx4 a[24:27], v2, s[8:11], s22 offen offset:2048 sc1
  buffer_load_dwordx4 a[28:31], v2, s[8:11], s22 offen offset:3072 sc1
  s_add_u32 s22, s31, 8192
  buffer_load_dwordx4 a[32:35], v2, s[8:11], s22 offen offset:0 sc1
  buffer_load_dwordx4 a[36:39], v2, s[8:11], s22 offen offset:1024 sc1
  buffer_load_dwordx4 a[40:43], v2, s[8:11], s22 offen offset:2048 sc1
  buffer_load_dwordx4 a[44:47], v2, s[8:11], s22 offen offset:3072 sc1
  s_add_u32 s22, s31, 12288
  buffer_load_dwordx4 a[48:51], v2, s[8:11], s22 offen offset:0 sc1
  buffer_load_dwordx4 a[52:55], v2, s[8:11], s22 offen offset:1024 sc1
  buffer_load_dwordx4 a[56:59], v2, s[8:11], s22 offen offset:2048 sc1
  buffer_load_dwordx4 a[60:63], v2, s[8:11], s22 offen offset:3072 sc1
  s_add_u32 s22, s31, 16384
  buffer_load_dwordx4 a[64:67], v2, s[8:11], s22 offen offset:0 sc1
  buffer_load_dwordx4 a[68:71], v2, s[8:11], s22 offen offset:1024 sc1
  buffer_load_dwordx4 a[72:75], v2, s[8:11], s22 offen offset:2048 sc1
  buffer_load_dwordx4 a[76:79], v2, s[8:11], s22 offen offset:3072 sc1
  s_add_u32 s22, s31, 20480
  buffer_load_dwordx4 a[80:83], v2, s[8:11], s22 offen offset:0 sc1
  buffer_load_dwordx4 a[84:87], v2, s[8:11], s22 offen offset:1024 sc1
  buffer_load_dwordx4 a[88:91], v2, s[8:11], s22 offen offset:2048 sc1
  buffer_load_dwordx4 a[92:95], v2, s[8:11], s22 offen offset:3072 sc1
  s_add_u32 s22, s31, 24576
  buffer_load_dwordx4 a[96:99], v2, s[8:11], s22 offen offset:0 sc1
  buffer_load_dwordx4 a[100:103], v2, s[8:11], s22 offen offset:1024 sc1
  buffer_load_dwordx4 a[104:107], v2, s[8:11], s22 offen offset:2048 sc1
  buffer_load_dwordx4 a[108:111], v2, s[8:11], s22 offen offset:3072 sc1
  s_add_u32 s22, s31, 28672
  buffer_load_dwordx4 a[112:115], v2, s[8:11], s22 offen offset:0 sc1
  buffer_load_dwordx4 a[116:119], v2, s[8:11], s22 offen offset:1024 sc1
  buffer_load_dwordx4 a[120:123], v2, s[8:11], s22 offen offset:2048 sc1
  buffer_load_dwordx4 a[124:127], v2, s[8:11], s22 offen offset:3072 sc1
  s_waitcnt vmcnt(24)
  s_add_u32 s22, s31, 32768
  buffer_load_dwordx4 a[128:131], v2, s[8:11], s22 offen offset:0 sc1
  buffer_load_dwordx4 a[132:135], v2, s[8:11], s22 offen offset:1024 sc1
  buffer_load_dwordx4 a[136:139], v2, s[8:11], s22 offen offset:2048 sc1
  buffer_load_dwordx4 a[140:143], v2, s[8:11], s22 offen offset:3072 sc1
  s_add_u32 s22, s31, 36864
  buffer_load_dwordx4 a[144:147], v2, s[8:11], s22 offen offset:0 sc1
  buffer_load_dwordx4 a[148:151], v2, s[8:11], s22 offen offset:1024 sc1
  buffer_load_dwordx4 a[152:155], v2, s[8:11], s22 offen offset:2048 sc1
  buffer_load_dwordx4 a[156:159], v2, s[8:11], s22 offen offset:3072 sc1
  s_add_u32 s22, s31, 40960
  buffer_load_dwordx4 a[160:163], v2, s[8:11], s22 offen offset:0 sc1
  buffer_load_dwordx4 a[164:167], v2, s[8:11], s22 offen offset:1024 sc1
  buffer_load_dwordx4 a[168:171], v2, s[8:11], s22 offen offset:2048 sc1
  buffer_load_dwordx4 a[172:175], v2, s[8:11], s22 offen offset:3072 sc1
  s_add_u32 s22, s31, 45056
  buffer_load_dwordx4 a[176:179], v2, s[8:11], s22 offen offset:0 sc1
  buffer_load_dwordx4 a[180:183], v2, s[8:11], s22 offen offset:1024 sc1
  buffer_load_dwordx4 a[184:187], v2, s[8:11], s22 offen offset:2048 sc1
  buffer_load_dwordx4 a[188:191], v2, s[8:11], s22 offen offset:3072 sc1
  s_add_u32 s22, s31, 49152
  buffer_load_dwordx4 a[192:195], v2, s[8:11], s22 offen offset:0 sc1
  buffer_load_dwordx4 a[196:199], v2, s[8:11], s22 offen offset:1024 sc1
  buffer_load_dwordx4 a[200:203], v2, s[8:11], s22 offen offset:2048 sc1
  buffer_load_dwordx4 a[204:207], v2, s[8:11], s22 offen offset:3072 sc1
  s_add_u32 s22, s31, 53248
  buffer_load_dwordx4 a[208:211], v2, s[8:11], s22 offen offset:0 sc1
  buffer_load_dwordx4 a[212:215], v2, s[8:11], s22 offen offset:1024 sc1
  buffer_load_dwordx4 a[216:219], v2, s[8:11], s22 offen offset:2048 sc1
  buffer_load_dwordx4 a[220:223], v2, s[8:11], s22 offen offset:3072 sc1
  s_add_u32 s22, s31, 57344
  buffer_load_dwordx4 a[224:227], v2, s[8:11], s22 offen offset:0 sc1
  buffer_load_dwordx4 a[228:231], v2, s[8:11], s22 offen offset:1024 sc1
  buffer_load_dwordx4 a[232:235], v2, s[8:11], s22 offen offset:2048 sc1
  buffer_load_dwordx4 a[236:239], v2, s[8:11], s22 offen offset:3072 sc1
  s_add_u32 s22, s31, 61440
  buffer_load_dwordx4 a[240:243], v2, s[8:11], s22 offen offset:0 sc1
  buffer_load_dwordx4 a[244:247], v2, s[8:11], s22 offen offset:1024 sc1
  buffer_load_dwordx4 a[248:251], v2, s[8:11], s22 offen offset:2048 sc1
  buffer_load_dwordx4 a[252:255], v2, s[8:11], s22 offen offset:3072 sc1
  s_waitcnt vmcnt(24)
  s_add_u32 s22, s31, 65536
  buffer_load_dwordx4 v[176:179], v2, s[8:11], s22 offen offset:0 sc1
  buffer_load_dwordx4 v[180:183], v2, s[8:11], s22 offen offset:1024 sc1
  buffer_load_dwordx4 v[184:187], v2, s[8:11], s22 offen offset:2048 sc1
  buffer_load_dwordx4 v[188:191], v2, s[8:11], s22 offen offset:3072 sc1
  s_add_u32 s22, s31, 69632
  buffer_load_dwordx4 v[192:195], v2, s[8:11], s22 offen offset:0 sc1
  buffer_load_dwordx4 v[196:199], v2, s[8:11], s22 offen offset:1024 sc1
  buffer_load_dwordx4 v[200:203], v2, s[8:11], s22 offen offset:2048 sc1
  buffer_load_dwordx4 v[204:207], v2, s[8:11], s22 offen offset:3072 sc1
  s_add_u32 s22, s31, 73728
  buffer_load_dwordx4 v[208:211], v2, s[8:11], s22 offen offset:0 sc1
  buffer_load_dwordx4 v[212:215], v2, s[8:11], s22 offen offset:1024 sc1
  buffer_load_dwordx4 v[216:219], v2, s[8:11], s22 offen offset:2048 sc1
  buffer_load_dwordx4 v[220:223], v2, s[8:11], s22 offen offset:3072 sc1
  s_add_u32 s22, s31, 77824
  buffer_load_dwordx4 v[224:227], v2, s[8:11], s22 offen offset:0 sc1
  buffer_load_dwordx4 v[228:231], v2, s[8:11], s22 offen offset:1024 sc1
  buffer_load_dwordx4 v[232:235], v2, s[8:11], s22 offen offset:2048 sc1
  buffer_load_dwordx4 v[236:239], v2, s[8:11], s22 offen offset:3072 sc1
  s_add_u32 s22, s31, 81920
  buffer_load_dwordx4 v[240:243], v2, s[8:11], s22 offen offset:0 sc1
  buffer_load_dwordx4 v[244:247], v2, s[8:11], s22 offen offset:1024 sc1
  buffer_load_dwordx4 v[248:251], v2, s[8:11], s22 offen offset:2048 sc1
  buffer_load_dwordx4 v[252:255], v2, s[8:11], s22 offen offset:3072 sc1
  s_mov_b32 m0, 30720
  s_add_u32 s22, s31, 86016
  buffer_load_dwordx4 v2, s[8:11], s22 offen offset:0 sc1 lds
  buffer_load_dwordx4 v2, s[8:11], s22 offen offset:1024 sc1 lds
  buffer_load_dwordx4 v2, s[8:11], s22 offen offset:2048 sc1 lds
  buffer_load_dwordx4 v2, s[8:11], s22 offen offset:3072 sc1 lds
  s_mov_b32 m0, 34816
  s_add_u32 s22, s31, 90112
  buffer_load_dwordx4 v2, s[8:11], s22 offen offset:0 sc1 lds
  buffer_load_dwordx4 v2, s[8:11], s22 offen offset:1024 sc1 lds
  buffer_load_dwordx4 v2, s[8:11], s22 offen offset:2048 sc1 lds
  buffer_load_dwordx4 v2, s[8:11], s22 offen offset:3072 sc1 lds
  s_mov_b32 m0, 38912
  s_add_u32 s22, s31, 94208
  buffer_load_dwordx4 v2, s[8:11], s22 offen offset:0 sc1 lds
  buffer_load_dwordx4 v2, s[8:11], s22 offen offset:1024 sc1 lds
  buffer_load_dwordx4 v2, s[8:11], s22 offen offset:2048 sc1 lds
  buffer_load_dwordx4 v2, s[8:11], s22 offen offset:3072 sc1 lds
  s_mov_b32 m0, 43008
  s_add_u32 s22, s31, 98304
  buffer_load_dwordx4 v2, s[8:11], s22 offen offset:0 sc1 lds
  buffer_load_dwordx4 v2, s[8:11], s22 offen offset:1024 sc1 lds
  s_mov_b32 s28, s35
  s_waitcnt vmcnt(0) lgkmcnt(0)
  s_mov_b32 s31, 0
  s_cmp_lg_u32 s88, 0
  s_cbranch_scc1 cB_va1_loop
  s_branch cA_va1_loop
ch_init6:
  v_mov_b32 v72, v116
  v_mov_b32 v73, v117
  v_lshrrev_b32 v65, 1, v72
  v_and_b32 v66, 1, v72
  v_mov_b32 v36, 0
  v_mov_b32 v37, 0
  v_mov_b32 v38, 0
  v_mov_b32 v39, 0
  v_mov_b32 v40, 0
  v_mov_b32 v41, 0
  v_mov_b32 v42, 0
  v_mov_b32 v43, 0
  v_mov_b32 v44, 0
  v_mov_b32 v45, 0
  v_mov_b32 v46, 0
  v_mov_b32 v47, 0
  v_mov_b32 v48, 0
  v_mov_b32 v49, 0
  v_mov_b32 v50, 0
  v_mov_b32 v51, 0
  v_mov_b32 v52, 0
  v_mov_b32 v53, 0
  v_mov_b32 v54, 0
  v_mov_b32 v55, 0
  v_mov_b32 v56, 0
  v_mov_b32 v57, 0
  v_mov_b32 v58, 0
  v_mov_b32 v59, 0
  v_mov_b32 v60, 0
  v_mov_b32 v61, 0
  v_mov_b32 v62, 0
  v_mov_b32 v63, 0
  v_lshlrev_b32 v75, 2, v65
  v_lshl_add_u32 v75, v66, 3, v75
  v_add_u32 v67, 224, v73
  v_mul_u32_u24 v68, 2341, v67
  v_lshrrev_b32 v68, 16, v68
  v_mul_u32_u24 v69, 28, v68
  v_sub_u32 v69, v67, v69
  v_lshrrev_b32 v70, 4, v69
  v_and_b32 v69, 15, v69
  v_lshlrev_b32 v71, 12, v70
  v_lshl_add_u32 v71, v68, 8, v71
  v_lshl_add_u32 v71, v69, 4, v71
  v_add_u32 v104, v71, v75
  v_add_u32 v67, 240, v73
  v_mul_u32_u24 v68, 2341, v67
  v_lshrrev_b32 v68, 16, v68
  v_mul_u32_u24 v69, 28, v68
  v_sub_u32 v69, v67, v69
  v_lshrrev_b32 v70, 4, v69
  v_and_b32 v69, 15, v69
  v_lshlrev_b32 v71, 12, v70
  v_lshl_add_u32 v71, v68, 8, v71
  v_lshl_add_u32 v71, v69, 4, v71
  v_add_u32 v105, v71, v75
  v_add_u32 v67, 256, v73
  v_mul_u32_u24 v68, 2341, v67
  v_lshrrev_b32 v68, 16, v68
  v_mul_u32_u24 v69, 28, v68
  v_sub_u32 v69, v67, v69
  v_lshrrev_b32 v70, 4, v69
  v_and_b32 v69, 15, v69
  v_lshlrev_b32 v71, 12, v70
  v_lshl_add_u32 v71, v68, 8, v71
  v_lshl_add_u32 v71, v69, 4, v71
  v_add_u32 v106, v71, v75
  v_add_u32 v67, 272, v73
  v_mul_u32_u24 v68, 2341, v67
  v_lshrrev_b32 v68, 16, v68
  v_mul_u32_u24 v69, 28, v68
  v_sub_u32 v69, v67, v69
  v_lshrrev_b32 v70, 4, v69
  v_and_b32 v69, 15, v69
  v_lshlrev_b32 v71, 12, v70
  v_lshl_add_u32 v71, v68, 8, v71
  v_lshl_add_u32 v71, v69, 4, v71
  v_add_u32 v107, v71, v75
  v_add_u32 v67, 288, v73
  v_mul_u32_u24 v68, 2341, v67
  v_lshrrev_b32 v68, 16, v68
  v_mul_u32_u24 v69, 28, v68
  v_sub_u32 v69, v67, v69
  v_lshrrev_b32 v70, 4, v69
  v_and_b32 v69, 15, v69
  v_lshlrev_b32 v71, 12, v70
  v_lshl_add_u32 v71, v68, 8, v71
  v_lshl_add_u32 v71, v69, 4, v71
  v_add_u32 v108, v71, v75
  v_add_u32 v67, 304, v73
  v_mul_u32_u24 v68, 2341, v67
  v_lshrrev_b32 v68, 16, v68
  v_mul_u32_u24 v69, 28, v68
  v_sub_u32 v69, v67, v69
  v_lshrrev_b32 v70, 4, v69
  v_and_b32 v69, 15, v69
  v_lshlrev_b32 v71, 12, v70
  v_lshl_add_u32 v71, v68, 8, v71
  v_lshl_add_u32 v71, v69, 4, v71
  v_add_u32 v109, v71, v75
  v_add_u32 v67, 320, v73
  v_mul_u32_u24 v68, 2341, v67
  v_lshrrev_b32 v68, 16, v68
  v_mul_u32_u24 v69, 28, v68
  v_sub_u32 v69, v67, v69
  v_lshrrev_b32 v70, 4, v69
  v_and_b32 v69, 15, v69
  v_lshlrev_b32 v71, 12, v70
  v_lshl_add_u32 v71, v68, 8, v71
  v_lshl_add_u32 v71, v69, 4, v71
  v_add_u32 v110, v71, v75
  v_mov_b32 v74, 0x40000000
  v_and_b32 v119, 15, v1
  s_and_b32 s22, s17, 0
  s_lshl_b32 s22, s22, 7
  s_add_u32 s22, s22, 75733504
  v_lshl_add_u32 v119, v119, 2, s22
  s_lshl_b32 s22, s17, 2
  s_add_u32 s22, s22, 75731456
  v_lshl_add_u32 v118, v1, 7, s22
  v_cmp_gt_u32 vcc, 1, v1
  s_nop 1
  v_cndmask_b32 v118, v74, v118, vcc
  s_lshl_b32 s35, s17, 7
  s_add_u32 s35, s35, 88461312
  v_min_u32 v116, 13, v1
  s_mul_i32 s22, s17, 14
  v_add_u32 v116, s22, v116
  v_lshlrev_b32 v116, 7, v116
  s_mul_i32 s31, s17, 401408
  s_add_u32 s31, s31, 6623232
  s_mov_b32 s30, 0
ch_wr6:
  buffer_load_dword v9, off, s[12:15], 0 offset:132 sc1
  s_waitcnt vmcnt(0)
  v_cmp_ne_u32 vcc, 1, v9
  s_cbranch_vccz ch_wr6_ok
  s_sleep 8
  s_add_u32 s30, s30, 1
  s_cmp_lt_u32 s30, 400000
  s_cbranch_scc1 ch_wr6
  s_branch cA_abort
ch_wr6_ok:
  s_lshr_b32 s22, s17, 2
  s_lshl_b32 s28, 0x81, s22
  s_mul_i32 s27, s17, 12
  s_add_u32 s22, s27, 256
  s_lshr_b32 s22, s22, 6
  s_lshl_b32 s22, 0x81, s22
  s_or_b32 s28, s28, s22
  s_add_u32 s22, s27, 267
  s_lshr_b32 s22, s22, 6
  s_lshl_b32 s22, 0x81, s22
  s_or_b32 s28, s28, s22
  v_lshrrev_b32 v12, 8, v2
  v_lshlrev_b32 v12, 7, v12
  s_mov_b32 s27, 88520192
  s_mov_b32 s30, 0
ch_ww6:
  buffer_load_dword v9, v12, s[8:11], s27 offen sc1
  s_waitcnt vmcnt(0)
  v_and_b32 v10, s28, v9
  v_cmp_ne_u32 vcc, s28, v10
  s_cbranch_vccz ch_ww6_ok
  s_sleep 3
  s_add_u32 s30, s30, 1
  s_cmp_lt_u32 s30, 400000
  s_cbranch_scc1 ch_ww6
  s_branch cA_abort
ch_ww6_ok:
  s_add_u32 s22, s31, 0
  buffer_load_dwordx4 a[0:3], v2, s[8:11], s22 offen offset:0 sc1
  buffer_load_dwordx4 a[4:7], v2, s[8:11], s22 offen offset:1024 sc1
  buffer_load_dwordx4 a[8:11], v2, s[8:11], s22 offen offset:2048 sc1
  buffer_load_dwordx4 a[12:15], v2, s[8:11], s22 offen offset:3072 sc1
  s_add_u32 s22, s31, 4096
  buffer_load_dwordx4 a[16:19], v2, s[8:11], s22 offen offset:0 sc1
  buffer_load_dwordx4 a[20:23], v2, s[8:11], s22 offen offset:1024 sc1
  buffer_load_dwordx4 a[24:27], v2, s[8:11], s22 offen offset:2048 sc1
  buffer_load_dwordx4 a[28:31], v2, s[8:11], s22 offen offset:3072 sc1
  s_add_u32 s22, s31, 8192
  buffer_load_dwordx4 a[32:35], v2, s[8:11], s22 offen offset:0 sc1
  buffer_load_dwordx4 a[36:39], v2, s[8:11], s22 offen offset:1024 sc1
  buffer_load_dwordx4 a[40:43], v2, s[8:11], s22 offen offset:2048 sc1
  buffer_load_dwordx4 a[44:47], v2, s[8:11], s22 offen offset:3072 sc1
  s_add_u32 s22, s31, 12288
  buffer_load_dwordx4 a[48:51], v2, s[8:11], s22 offen offset:0 sc1
  buffer_load_dwordx4 a[52:55], v2, s[8:11], s22 offen offset:1024 sc1
  buffer_load_dwordx4 a[56:59], v2, s[8:11], s22 offen offset:2048 sc1
  buffer_load_dwordx4 a[60:63], v2, s[8:11], s22 offen offset:3072 sc1
  s_add_u32 s22, s31, 16384
  buffer_load_dwordx4 a[64:67], v2, s[8:11], s22 offen offset:0 sc1
  buffer_load_dwordx4 a[68:71], v2, s[8:11], s22 offen offset:1024 sc1
  buffer_load_dwordx4 a[72:75], v2, s[8:11], s22 offen offset:2048 sc1
  buffer_load_dwordx4 a[76:79], v2, s[8:11], s22 offen offset:3072 sc1
  s_add_u32 s22, s31, 20480
  buffer_load_dwordx4 a[80:83], v2, s[8:11], s22 offen offset:0 sc1
  buffer_load_dwordx4 a[84:87], v2, s[8:11], s22 offen offset:1024 sc1
  buffer_load_dwordx4 a[88:91], v2, s[8:11], s22 offen offset:2048 sc1
  buffer_load_dwordx4 a[92:95], v2, s[8:11], s22 offen offset:3072 sc1
  s_add_u32 s22, s31, 24576
  buffer_load_dwordx4 a[96:99], v2, s[8:11], s22 offen offset:0 sc1
  buffer_load_dwordx4 a[100:103], v2, s[8:11], s22 offen offset:1024 sc1
  buffer_load_dwordx4 a[104:107], v2, s[8:11], s22 offen offset:2048 sc1
  buffer_load_dwordx4 a[108:111], v2, s[8:11], s22 offen offset:3072 sc1
  s_add_u32 s22, s31, 28672
  buffer_load_dwordx4 a[112:115], v2, s[8:11], s22 offen offset:0 sc1
  buffer_load_dwordx4 a[116:119], v2, s[8:11], s22 offen offset:1024 sc1
  buffer_load_dwordx4 a[120:123], v2, s[8:11], s22 offen offset:2048 sc1
  buffer_load_dwordx4 a[124:127], v2, s[8:11], s22 offen offset:3072 sc1
  s_waitcnt vmcnt(24)
  s_add_u32 s22, s31, 32768
  buffer_load_dwordx4 a[128:131], v2, s[8:11], s22 offen offset:0 sc1
  buffer_load_dwordx4 a[132:135], v2, s[8:11], s22 offen offset:1024 sc1
  buffer_load_dwordx4 a[136:139], v2, s[8:11], s22 offen offset:2048 sc1
  buffer_load_dwordx4 a[140:143], v2, s[8:11], s22 offen offset:3072 sc1
  s_add_u32 s22, s31, 36864
  buffer_load_dwordx4 a[144:147], v2, s[8:11], s22 offen offset:0 sc1
  buffer_load_dwordx4 a[148:151], v2, s[8:11], s22 offen offset:1024 sc1
  buffer_load_dwordx4 a[152:155], v2, s[8:11], s22 offen offset:2048 sc1
  buffer_load_dwordx4 a[156:159], v2, s[8:11], s22 offen offset:3072 sc1
  s_add_u32 s22, s31, 40960
  buffer_load_dwordx4 a[160:163], v2, s[8:11], s22 offen offset:0 sc1
  buffer_load_dwordx4 a[164:167], v2, s[8:11], s22 offen offset:1024 sc1
  buffer_load_dwordx4 a[168:171], v2, s[8:11], s22 offen offset:2048 sc1
  buffer_load_dwordx4 a[172:175], v2, s[8:11], s22 offen offset:3072 sc1
  s_add_u32 s22, s31, 45056
  buffer_load_dwordx4 a[176:179], v2, s[8:11], s22 offen offset:0 sc1
  buffer_load_dwordx4 a[180:183], v2, s[8:11], s22 offen offset:1024 sc1
  buffer_load_dwordx4 a[184:187], v2, s[8:11], s22 offen offset:2048 sc1
  buffer_load_dwordx4 a[188:191], v2, s[8:11], s22 offen offset:3072 sc1
  s_add_u32 s22, s31, 49152
  buffer_load_dwordx4 a[192:195], v2, s[8:11], s22 offen offset:0 sc1
  buffer_load_dwordx4 a[196:199], v2, s[8:11], s22 offen offset:1024 sc1
  buffer_load_dwordx4 a[200:203], v2, s[8:11], s22 offen offset:2048 sc1
  buffer_load_dwordx4 a[204:207], v2, s[8:11], s22 offen offset:3072 sc1
  s_add_u32 s22, s31, 53248
  buffer_load_dwordx4 a[208:211], v2, s[8:11], s22 offen offset:0 sc1
  buffer_load_dwordx4 a[212:215], v2, s[8:11], s22 offen offset:1024 sc1
  buffer_load_dwordx4 a[216:219], v2, s[8:11], s22 offen offset:2048 sc1
  buffer_load_dwordx4 a[220:223], v2, s[8:11], s22 offen offset:3072 sc1
  s_add_u32 s22, s31, 57344
  buffer_load_dwordx4 a[224:227], v2, s[8:11], s22 offen offset:0 sc1
  buffer_load_dwordx4 a[228:231], v2, s[8:11], s22 offen offset:1024 sc1
  buffer_load_dwordx4 a[232:235], v2, s[8:11], s22 offen offset:2048 sc1
  buffer_load_dwordx4 a[236:239], v2, s[8:11], s22 offen offset:3072 sc1
  s_add_u32 s22, s31, 61440
  buffer_load_dwordx4 a[240:243], v2, s[8:11], s22 offen offset:0 sc1
  buffer_load_dwordx4 a[244:247], v2, s[8:11], s22 offen offset:1024 sc1
  buffer_load_dwordx4 a[248:251], v2, s[8:11], s22 offen offset:2048 sc1
  buffer_load_dwordx4 a[252:255], v2, s[8:11], s22 offen offset:3072 sc1
  s_waitcnt vmcnt(24)
  s_add_u32 s22, s31, 65536
  buffer_load_dwordx4 v[120:123], v2, s[8:11], s22 offen offset:0 sc1
  buffer_load_dwordx4 v[124:127], v2, s[8:11], s22 offen offset:1024 sc1
  buffer_load_dwordx4 v[128:131], v2, s[8:11], s22 offen offset:2048 sc1
  buffer_load_dwordx4 v[132:135], v2, s[8:11], s22 offen offset:3072 sc1
  s_add_u32 s22, s31, 69632
  buffer_load_dwordx4 v[136:139], v2, s[8:11], s22 offen offset:0 sc1
  buffer_load_dwordx4 v[140:143], v2, s[8:11], s22 offen offset:1024 sc1
  buffer_load_dwordx4 v[144:147], v2, s[8:11], s22 offen offset:2048 sc1
  buffer_load_dwordx4 v[148:151], v2, s[8:11], s22 offen offset:3072 sc1
  s_add_u32 s22, s31, 73728
  buffer_load_dwordx4 v[152:155], v2, s[8:11], s22 offen offset:0 sc1
  buffer_load_dwordx4 v[156:159], v2, s[8:11], s22 offen offset:1024 sc1
  buffer_load_dwordx4 v[160:163], v2, s[8:11], s22 offen offset:2048 sc1
  buffer_load_dwordx4 v[164:167], v2, s[8:11], s22 offen offset:3072 sc1
  s_add_u32 s22, s31, 77824
  buffer_load_dwordx4 v[168:171], v2, s[8:11], s22 offen offset:0 sc1
  buffer_load_dwordx4 v[172:175], v2, s[8:11], s22 offen offset:1024 sc1
  buffer_load_dwordx4 v[176:179], v2, s[8:11], s22 offen offset:2048 sc1
  buffer_load_dwordx4 v[180:183], v2, s[8:11], s22 offen offset:3072 sc1
  s_add_u32 s22, s31, 81920
  buffer_load_dwordx4 v[184:187], v2, s[8:11], s22 offen offset:0 sc1
  buffer_load_dwordx4 v[188:191], v2, s[8:11], s22 offen offset:1024 sc1
  buffer_load_dwordx4 v[192:195], v2, s[8:11], s22 offen offset:2048 sc1
  buffer_load_dwordx4 v[196:199], v2, s[8:11], s22 offen offset:3072 sc1
  s_add_u32 s22, s31, 86016
  buffer_load_dwordx4 v[200:203], v2, s[8:11], s22 offen offset:0 sc1
  buffer_load_dwordx4 v[204:207], v2, s[8:11], s22 offen offset:1024 sc1
  buffer_load_dwordx4 v[208:211], v2, s[8:11], s22 offen offset:2048 sc1
  buffer_load_dwordx4 v[212:215], v2, s[8:11], s22 offen offset:3072 sc1
  s_add_u32 s22, s31, 90112
  buffer_load_dwordx4 v[216:219], v2, s[8:11], s22 offen offset:0 sc1
  buffer_load_dwordx4 v[220:223], v2, s[8:11], s22 offen offset:1024 sc1
  buffer_load_dwordx4 v[224:227], v2, s[8:11], s22 offen offset:2048 sc1
  buffer_load_dwordx4 v[228:231], v2, s[8:11], s22 offen offset:3072 sc1
  s_add_u32 s22, s31, 94208
  buffer_load_dwordx4 v[232:235], v2, s[8:11], s22 offen offset:0 sc1
  buffer_load_dwordx4 v[236:239], v2, s[8:11], s22 offen offset:1024 sc1
  buffer_load_dwordx4 v[240:243], v2, s[8:11], s22 offen offset:2048 sc1
  buffer_load_dwordx4 v[244:247], v2, s[8:11], s22 offen offset:3072 sc1
  s_waitcnt vmcnt(24)
  s_add_u32 s22, s31, 98304
  buffer_load_dwordx4 v[248:251], v2, s[8:11], s22 offen offset:0 sc1
  buffer_load_dwordx4 v[252:255], v2, s[8:11], s22 offen offset:1024 sc1
  s_lshl_b32 s27, s17, 7
  s_add_u32 s27, s27, 88461312
  s_mov_b32 s30, 0
ch_vw2:
  buffer_load_dword v9, off, s[8:11], s27 sc1
  s_waitcnt vmcnt(0)
  v_cmp_ne_u32 vcc, 56, v9
  s_cbranch_vccz ch_vw2_d
  s_sleep 2
  s_add_u32 s30, s30, 1
  s_cmp_lt_u32 s30, 400000
  s_cbranch_scc1 ch_vw2
  s_branch cA_abort
ch_vw2_d:
  s_mov_b32 s28, s35
  s_waitcnt vmcnt(0) lgkmcnt(0)
  s_mov_b32 s31, 0
  s_cmp_lg_u32 s88, 0
  s_cbranch_scc1 cB_va2_loop
  s_branch cA_va2_loop
ch_init7:
  v_mov_b32 v72, v116
  v_mov_b32 v73, v117
  v_lshrrev_b32 v65, 1, v72
  v_and_b32 v66, 1, v72
  v_mov_b32 v36, 0
  v_mov_b32 v37, 0
  v_mov_b32 v38, 0
  v_mov_b32 v39, 0
  v_mov_b32 v40, 0
  v_mov_b32 v41, 0
  v_mov_b32 v42, 0
  v_mov_b32 v43, 0
  v_mov_b32 v44, 0
  v_mov_b32 v45, 0
  v_mov_b32 v46, 0
  v_mov_b32 v47, 0
  v_mov_b32 v48, 0
  v_mov_b32 v49, 0
  v_mov_b32 v50, 0
  v_mov_b32 v51, 0
  v_mov_b32 v52, 0
  v_mov_b32 v53, 0
  v_mov_b32 v54, 0
  v_mov_b32 v55, 0
  v_mov_b32 v56, 0
  v_mov_b32 v57, 0
  v_mov_b32 v58, 0
  v_mov_b32 v59, 0
  v_mov_b32 v60, 0
  v_mov_b32 v61, 0
  v_mov_b32 v62, 0
  v_mov_b32 v63, 0
  v_lshlrev_b32 v75, 2, v65
  v_lshl_add_u32 v75, v66, 3, v75
  v_add_u32 v67, 336, v73
  v_mul_u32_u24 v68, 2341, v67
  v_lshrrev_b32 v68, 16, v68
  v_mul_u32_u24 v69, 28, v68
  v_sub_u32 v69, v67, v69
  v_lshrrev_b32 v70, 4, v69
  v_and_b32 v69, 15, v69
  v_lshlrev_b32 v71, 12, v70
  v_lshl_add_u32 v71, v68, 8, v71
  v_lshl_add_u32 v71, v69, 4, v71
  v_add_u32 v104, v71, v75
  v_add_u32 v67, 352, v73
  v_mul_u32_u24 v68, 2341, v67
  v_lshrrev_b32 v68, 16, v68
  v_mul_u32_u24 v69, 28, v68
  v_sub_u32 v69, v67, v69
  v_lshrrev_b32 v70, 4, v69
  v_and_b32 v69, 15, v69
  v_lshlrev_b32 v71, 12, v70
  v_lshl_add_u32 v71, v68, 8, v71
  v_lshl_add_u32 v71, v69, 4, v71
  v_add_u32 v105, v71, v75
  v_add_u32 v67, 368, v73
  v_mul_u32_u24 v68, 2341, v67
  v_lshrrev_b32 v68, 16, v68
  v_mul_u32_u24 v69, 28, v68
  v_sub_u32 v69, v67, v69
  v_lshrrev_b32 v70, 4, v69
  v_and_b32 v69, 15, v69
  v_lshlrev_b32 v71, 12, v70
  v_lshl_add_u32 v71, v68, 8, v71
  v_lshl_add_u32 v71, v69, 4, v71
  v_add_u32 v106, v71, v75
  v_add_u32 v67, 384, v73
  v_mul_u32_u24 v68, 2341, v67
  v_lshrrev_b32 v68, 16, v68
  v_mul_u32_u24 v69, 28, v68
  v_sub_u32 v69, v67, v69
  v_lshrrev_b32 v70, 4, v69
  v_and_b32 v69, 15, v69
  v_lshlrev_b32 v71, 12, v70
  v_lshl_add_u32 v71, v68, 8, v71
  v_lshl_add_u32 v71, v69, 4, v71
  v_add_u32 v107, v71, v75
  v_add_u32 v67, 400, v73
  v_mul_u32_u24 v68, 2341, v67
  v_lshrrev_b32 v68, 16, v68
  v_mul_u32_u24 v69, 28, v68
  v_sub_u32 v69, v67, v69
  v_lshrrev_b32 v70, 4, v69
  v_and_b32 v69, 15, v69
  v_lshlrev_b32 v71, 12, v70
  v_lshl_add_u32 v71, v68, 8, v71
  v_lshl_add_u32 v71, v69, 4, v71
  v_add_u32 v108, v71, v75
  v_add_u32 v67, 416, v73
  v_mul_u32_u24 v68, 2341, v67
  v_lshrrev_b32 v68, 16, v68
  v_mul_u32_u24 v69, 28, v68
  v_sub_u32 v69, v67, v69
  v_lshrrev_b32 v70, 4, v69
  v_and_b32 v69, 15, v69
  v_lshlrev_b32 v71, 12, v70
  v_lshl_add_u32 v71, v68, 8, v71
  v_lshl_add_u32 v71, v69, 4, v71
  v_add_u32 v109, v71, v75
  v_add_u32 v67, 432, v73
  v_mul_u32_u24 v68, 2341, v67
  v_lshrrev_b32 v68, 16, v68
  v_mul_u32_u24 v69, 28, v68
  v_sub_u32 v69, v67, v69
  v_lshrrev_b32 v70, 4, v69
  v_and_b32 v69, 15, v69
  v_lshlrev_b32 v71, 12, v70
  v_lshl_add_u32 v71, v68, 8, v71
  v_lshl_add_u32 v71, v69, 4, v71
  v_add_u32 v110, v71, v75
  v_mov_b32 v74, 0x40000000
  v_and_b32 v119, 15, v1
  s_and_b32 s22, s17, 0
  s_lshl_b32 s22, s22, 7
  s_add_u32 s22, s22, 75733504
  v_lshl_add_u32 v119, v119, 2, s22
  s_lshl_b32 s22, s17, 2
  s_add_u32 s22, s22, 75731456
  v_lshl_add_u32 v118, v1, 7, s22
  v_cmp_gt_u32 vcc, 1, v1
  s_nop 1
  v_cndmask_b32 v118, v74, v118, vcc
  s_lshl_b32 s35, s17, 7
  s_add_u32 s35, s35, 88461312
  v_min_u32 v116, 13, v1
  s_mul_i32 s22, s17, 14
  v_add_u32 v116, s22, v116
  v_lshlrev_b32 v116, 7, v116
  s_mul_i32 s31, s17, 401408
  s_add_u32 s31, s31, 6723584
  s_mov_b32 s30, 0
ch_wr7:
  buffer_load_dword v9, off, s[12:15], 0 offset:132 sc1
  s_waitcnt vmcnt(0)
  v_cmp_ne_u32 vcc, 1, v9
  s_cbranch_vccz ch_wr7_ok
  s_sleep 8
  s_add_u32 s30, s30, 1
  s_cmp_lt_u32 s30, 400000
  s_cbranch_scc1 ch_wr7
  s_branch cA_abort
ch_wr7_ok:
  s_lshr_b32 s22, s17, 2
  s_lshl_b32 s28, 0x81, s22
  s_mul_i32 s27, s17, 12
  s_add_u32 s22, s27, 256
  s_lshr_b32 s22, s22, 6
  s_lshl_b32 s22, 0x81, s22
  s_or_b32 s28, s28, s22
  s_add_u32 s22, s27, 267
  s_lshr_b32 s22, s22, 6
  s_lshl_b32 s22, 0x81, s22
  s_or_b32 s28, s28, s22
  v_lshrrev_b32 v12, 8, v2
  v_lshlrev_b32 v12, 7, v12
  s_mov_b32 s27, 88520704
  s_mov_b32 s30, 0
ch_ww7:
  buffer_load_dword v9, v12, s[8:11], s27 offen sc1
  s_waitcnt vmcnt(0)
  v_and_b32 v10, s28, v9
  v_cmp_ne_u32 vcc, s28, v10
  s_cbranch_vccz ch_ww7_ok
  s_sleep 3
  s_add_u32 s30, s30, 1
  s_cmp_lt_u32 s30, 400000
  s_cbranch_scc1 ch_ww7
  s_branch cA_abort
ch_ww7_ok:
  s_add_u32 s22, s31, 0
  buffer_load_dwordx4 a[0:3], v2, s[8:11], s22 offen offset:0 sc1
  buffer_load_dwordx4 a[4:7], v2, s[8:11], s22 offen offset:1024 sc1
  buffer_load_dwordx4 a[8:11], v2, s[8:11], s22 offen offset:2048 sc1
  buffer_load_dwordx4 a[12:15], v2, s[8:11], s22 offen offset:3072 sc1
  s_add_u32 s22, s31, 4096
  buffer_load_dwordx4 a[16:19], v2, s[8:11], s22 offen offset:0 sc1
  buffer_load_dwordx4 a[20:23], v2, s[8:11], s22 offen offset:1024 sc1
  buffer_load_dwordx4 a[24:27], v2, s[8:11], s22 offen offset:2048 sc1
  buffer_load_dwordx4 a[28:31], v2, s[8:11], s22 offen offset:3072 sc1
  s_add_u32 s22, s31, 8192
  buffer_load_dwordx4 a[32:35], v2, s[8:11], s22 offen offset:0 sc1
  buffer_load_dwordx4 a[36:39], v2, s[8:11], s22 offen offset:1024 sc1
  buffer_load_dwordx4 a[40:43], v2, s[8:11], s22 offen offset:2048 sc1
  buffer_load_dwordx4 a[44:47], v2, s[8:11], s22 offen offset:3072 sc1
  s_add_u32 s22, s31, 12288
  buffer_load_dwordx4 a[48:51], v2, s[8:11], s22 offen offset:0 sc1
  buffer_load_dwordx4 a[52:55], v2, s[8:11], s22 offen offset:1024 sc1
  buffer_load_dwordx4 a[56:59], v2, s[8:11], s22 offen offset:2048 sc1
  buffer_load_dwordx4 a[60:63], v2, s[8:11], s22 offen offset:3072 sc1
  s_add_u32 s22, s31, 16384
  buffer_load_dwordx4 a[64:67], v2, s[8:11], s22 offen offset:0 sc1
  buffer_load_dwordx4 a[68:71], v2, s[8:11], s22 offen offset:1024 sc1
  buffer_load_dwordx4 a[72:75], v2, s[8:11], s22 offen offset:2048 sc1
  buffer_load_dwordx4 a[76:79], v2, s[8:11], s22 offen offset:3072 sc1
  s_add_u32 s22, s31, 20480
  buffer_load_dwordx4 a[80:83], v2, s[8:11], s22 offen offset:0 sc1
  buffer_load_dwordx4 a[84:87], v2, s[8:11], s22 offen offset:1024 sc1
  buffer_load_dwordx4 a[88:91], v2, s[8:11], s22 offen offset:2048 sc1
  buffer_load_dwordx4 a[92:95], v2, s[8:11], s22 offen offset:3072 sc1
  s_add_u32 s22, s31, 24576
  buffer_load_dwordx4 a[96:99], v2, s[8:11], s22 offen offset:0 sc1
  buffer_load_dwordx4 a[100:103], v2, s[8:11], s22 offen offset:1024 sc1
  buffer_load_dwordx4 a[104:107], v2, s[8:11], s22 offen offset:2048 sc1
  buffer_load_dwordx4 a[108:111], v2, s[8:11], s22 offen offset:3072 sc1
  s_add_u32 s22, s31, 28672
  buffer_load_dwordx4 a[112:115], v2, s[8:11], s22 offen offset:0 sc1
  buffer_load_dwordx4 a[116:119], v2, s[8:11], s22 offen offset:1024 sc1
  buffer_load_dwordx4 a[120:123], v2, s[8:11], s22 offen offset:2048 sc1
  buffer_load_dwordx4 a[124:127], v2, s[8:11], s22 offen offset:3072 sc1
  s_waitcnt vmcnt(24)
  s_add_u32 s22, s31, 32768
  buffer_load_dwordx4 a[128:131], v2, s[8:11], s22 offen offset:0 sc1
  buffer_load_dwordx4 a[132:135], v2, s[8:11], s22 offen offset:1024 sc1
  buffer_load_dwordx4 a[136:139], v2, s[8:11], s22 offen offset:2048 sc1
  buffer_load_dwordx4 a[140:143], v2, s[8:11], s22 offen offset:3072 sc1
  s_add_u32 s22, s31, 36864
  buffer_load_dwordx4 a[144:147], v2, s[8:11], s22 offen offset:0 sc1
  buffer_load_dwordx4 a[148:151], v2, s[8:11], s22 offen offset:1024 sc1
  buffer_load_dwordx4 a[152:155], v2, s[8:11], s22 offen offset:2048 sc1
  buffer_load_dwordx4 a[156:159], v2, s[8:11], s22 offen offset:3072 sc1
  s_add_u32 s22, s31, 40960
  buffer_load_dwordx4 a[160:163], v2, s[8:11], s22 offen offset:0 sc1
  buffer_load_dwordx4 a[164:167], v2, s[8:11], s22 offen offset:1024 sc1
  buffer_load_dwordx4 a[168:171], v2, s[8:11], s22 offen offset:2048 sc1
  buffer_load_dwordx4 a[172:175], v2, s[8:11], s22 offen offset:3072 sc1
  s_add_u32 s22, s31, 45056
  buffer_load_dwordx4 a[176:179], v2, s[8:11], s22 offen offset:0 sc1
  buffer_load_dwordx4 a[180:183], v2, s[8:11], s22 offen offset:1024 sc1
  buffer_load_dwordx4 a[184:187], v2, s[8:11], s22 offen offset:2048 sc1
  buffer_load_dwordx4 a[188:191], v2, s[8:11], s22 offen offset:3072 sc1
  s_add_u32 s22, s31, 49152
  buffer_load_dwordx4 a[192:195], v2, s[8:11], s22 offen offset:0 sc1
  buffer_load_dwordx4 a[196:199], v2, s[8:11], s22 offen offset:1024 sc1
  buffer_load_dwordx4 a[200:203], v2, s[8:11], s22 offen offset:2048 sc1
  buffer_load_dwordx4 a[204:207], v2, s[8:11], s22 offen offset:3072 sc1
  s_add_u32 s22, s31, 53248
  buffer_load_dwordx4 a[208:211], v2, s[8:11], s22 offen offset:0 sc1
  buffer_load_dwordx4 a[212:215], v2, s[8:11], s22 offen offset:1024 sc1
  buffer_load_dwordx4 a[216:219], v2, s[8:11], s22 offen offset:2048 sc1
  buffer_load_dwordx4 a[220:223], v2, s[8:11], s22 offen offset:3072 sc1
  s_add_u32 s22, s31, 57344
  buffer_load_dwordx4 a[224:227], v2, s[8:11], s22 offen offset:0 sc1
  buffer_load_dwordx4 a[228:231], v2, s[8:11], s22 offen offset:1024 sc1
  buffer_load_dwordx4 a[232:235], v2, s[8:11], s22 offen offset:2048 sc1
  buffer_load_dwordx4 a[236:239], v2, s[8:11], s22 offen offset:3072 sc1
  s_add_u32 s22, s31, 61440
  buffer_load_dwordx4 a[240:243], v2, s[8:11], s22 offen offset:0 sc1
  buffer_load_dwordx4 a[244:247], v2, s[8:11], s22 offen offset:1024 sc1
  buffer_load_dwordx4 a[248:251], v2, s[8:11], s22 offen offset:2048 sc1
  buffer_load_dwordx4 a[252:255], v2, s[8:11], s22 offen offset:3072 sc1
  s_waitcnt vmcnt(24)
  s_add_u32 s22, s31, 65536
  buffer_load_dwordx4 v[120:123], v2, s[8:11], s22 offen offset:0 sc1
  buffer_load_dwordx4 v[124:127], v2, s[8:11], s22 offen offset:1024 sc1
  buffer_load_dwordx4 v[128:131], v2, s[8:11], s22 offen offset:2048 sc1
  buffer_load_dwordx4 v[132:135], v2, s[8:11], s22 offen offset:3072 sc1
  s_add_u32 s22, s31, 69632
  buffer_load_dwordx4 v[136:139], v2, s[8:11], s22 offen offset:0 sc1
  buffer_load_dwordx4 v[140:143], v2, s[8:11], s22 offen offset:1024 sc1
  buffer_load_dwordx4 v[144:147], v2, s[8:11], s22 offen offset:2048 sc1
  buffer_load_dwordx4 v[148:151], v2, s[8:11], s22 offen offset:3072 sc1
  s_add_u32 s22, s31, 73728
  buffer_load_dwordx4 v[152:155], v2, s[8:11], s22 offen offset:0 sc1
  buffer_load_dwordx4 v[156:159], v2, s[8:11], s22 offen offset:1024 sc1
  buffer_load_dwordx4 v[160:163], v2, s[8:11], s22 offen offset:2048 sc1
  buffer_load_dwordx4 v[164:167], v2, s[8:11], s22 offen offset:3072 sc1
  s_add_u32 s22, s31, 77824
  buffer_load_dwordx4 v[168:171], v2, s[8:11], s22 offen offset:0 sc1
  buffer_load_dwordx4 v[172:175], v2, s[8:11], s22 offen offset:1024 sc1
  buffer_load_dwordx4 v[176:179], v2, s[8:11], s22 offen offset:2048 sc1
  buffer_load_dwordx4 v[180:183], v2, s[8:11], s22 offen offset:3072 sc1
  s_add_u32 s22, s31, 81920
  buffer_load_dwordx4 v[184:187], v2, s[8:11], s22 offen offset:0 sc1
  buffer_load_dwordx4 v[188:191], v2, s[8:11], s22 offen offset:1024 sc1
  buffer_load_dwordx4 v[192:195], v2, s[8:11], s22 offen offset:2048 sc1
  buffer_load_dwordx4 v[196:199], v2, s[8:11], s22 offen offset:3072 sc1
  s_add_u32 s22, s31, 86016
  buffer_load_dwordx4 v[200:203], v2, s[8:11], s22 offen offset:0 sc1
  buffer_load_dwordx4 v[204:207], v2, s[8:11], s22 offen offset:1024 sc1
  buffer_load_dwordx4 v[208:211], v2, s[8:11], s22 offen offset:2048 sc1
  buffer_load_dwordx4 v[212:215], v2, s[8:11], s22 offen offset:3072 sc1
  s_add_u32 s22, s31, 90112
  buffer_load_dwordx4 v[216:219], v2, s[8:11], s22 offen offset:0 sc1
  buffer_load_dwordx4 v[220:223], v2, s[8:11], s22 offen offset:1024 sc1
  buffer_load_dwordx4 v[224:227], v2, s[8:11], s22 offen offset:2048 sc1
  buffer_load_dwordx4 v[228:231], v2, s[8:11], s22 offen offset:3072 sc1
  s_add_u32 s22, s31, 94208
  buffer_load_dwordx4 v[232:235], v2, s[8:11], s22 offen offset:0 sc1
  buffer_load_dwordx4 v[236:239], v2, s[8:11], s22 offen offset:1024 sc1
  buffer_load_dwordx4 v[240:243], v2, s[8:11], s22 offen offset:2048 sc1
  buffer_load_dwordx4 v[244:247], v2, s[8:11], s22 offen offset:3072 sc1
  s_waitcnt vmcnt(24)
  s_add_u32 s22, s31, 98304
  buffer_load_dwordx4 v[248:251], v2, s[8:11], s22 offen offset:0 sc1
  buffer_load_dwordx4 v[252:255], v2, s[8:11], s22 offen offset:1024 sc1
  s_lshl_b32 s27, s17, 7
  s_add_u32 s27, s27, 88461312
  s_mov_b32 s30, 0
ch_vw3:
  buffer_load_dword v9, off, s[8:11], s27 sc1
  s_waitcnt vmcnt(0)
  v_cmp_ne_u32 vcc, 56, v9
  s_cbranch_vccz ch_vw3_d
  s_sleep 2
  s_add_u32 s30, s30, 1
  s_cmp_lt_u32 s30, 400000
  s_cbranch_scc1 ch_vw3
  s_branch cA_abort
ch_vw3_d:
  s_mov_b32 s28, s35
  s_mov_b32 s39, 72052736
  buffer_load_dword v100, v116, s[8:11], s39 offen sc1
  s_mov_b32 s39, 72081408
  s_waitcnt vmcnt(1) lgkmcnt(0)
  s_mov_b32 s31, 0
  s_cmp_lg_u32 s88, 0
  s_cbranch_scc1 cB_va3_loop
  s_branch cA_va3_loop
.p2align 6
cA_sc0_loop:
  s_mov_b32 s30, 0
  s_mov_b32 s62, 0
  s_setprio 3
  s_sleep 6
  buffer_load_dword v76, v0, s[8:11], 0 offen sc1
  buffer_load_dword v77, v0, s[8:11], 0 offen sc1
  buffer_load_dword v78, v0, s[8:11], 0 offen sc1
  buffer_load_dword v79, v0, s[8:11], 0 offen sc1
cA_sc0_fp_l:
  s_waitcnt vmcnt(3)
  v_cmp_gt_u32 vcc, s19, v76
  s_cbranch_vccz cA_sc0_fp_d
  buffer_load_dword v76, v0, s[8:11], 0 offen sc1
  s_waitcnt vmcnt(3)
  v_cmp_gt_u32 vcc, s19, v77
  s_cbranch_vccz cA_sc0_fp_d
  buffer_load_dword v77, v0, s[8:11], 0 offen sc1
  s_waitcnt vmcnt(3)
  v_cmp_gt_u32 vcc, s19, v78
  s_cbranch_vccz cA_sc0_fp_d
  buffer_load_dword v78, v0, s[8:11], 0 offen sc1
  s_waitcnt vmcnt(3)
  v_cmp_gt_u32 vcc, s19, v79
  s_cbranch_vccz cA_sc0_fp_d
  buffer_load_dword v79, v0, s[8:11], 0 offen sc1
  s_add_u32 s30, s30, 1
  s_cmp_lt_u32 s30, 400000
  s_cbranch_scc1 cA_sc0_fp_l
  s_branch cA_abort
cA_sc0_fp_d:
  buffer_load_dwordx4 v[8:11], v2, s[8:11], s20 offen offset:0 sc1
  s_barrier
  s_setprio 2
  buffer_load_dwordx4 v[12:15], v2, s[8:11], s20 offen offset:1024 sc1
  s_setprio 1
  buffer_load_dwordx4 v[16:19], v2, s[8:11], s20 offen offset:2048 sc1
  s_setprio 0
  buffer_load_dwordx4 v[20:23], v2, s[8:11], s20 offen offset:3072 sc1
cA_sc0_go:
  s_waitcnt vmcnt(3)
  v_smfmac_f32_16x16x64_bf16 v[36:39], v[8:11], a[0:7], v3
  buffer_load_dwordx4 v[32:35], v2, s[8:11], s23 offen offset:0 sc1
  v_cmp_eq_u32 vcc, -1, v8
  v_smfmac_f32_16x16x64_bf16 v[40:43], v[8:11], a[56:63], v3
  v_smfmac_f32_16x16x64_bf16 v[44:47], v[8:11], a[112:119], v3
  buffer_load_dwordx4 v[24:27], v2, s[8:11], s23 offen offset:1024 sc1
  s_cbranch_vccnz cA_sc0_r0
  v_smfmac_f32_16x16x64_bf16 v[48:51], v[8:11], a[168:175], v3
  v_smfmac_f32_16x16x64_bf16 v[52:55], v[8:11], a[224:231], v3
  s_waitcnt vmcnt(4)
  v_cmp_eq_u32 vcc, -1, v12
  v_smfmac_f32_16x16x64_bf16 v[56:59], v[8:11], v[144:151], v3
  buffer_load_dwordx4 v[28:31], v2, s[8:11], s23 offen offset:2048 sc1
  v_smfmac_f32_16x16x64_bf16 v[60:63], v[8:11], v[200:207], v3
  s_cbranch_vccnz cA_sc0_r1
cA_sc0_c1:
  v_smfmac_f32_16x16x64_bf16 v[36:39], v[12:15], a[8:15], v3
  v_smfmac_f32_16x16x64_bf16 v[40:43], v[12:15], a[64:71], v3
  v_smfmac_f32_16x16x64_bf16 v[44:47], v[12:15], a[120:127], v3
  v_smfmac_f32_16x16x64_bf16 v[48:51], v[12:15], a[176:183], v3
  v_smfmac_f32_16x16x64_bf16 v[52:55], v[12:15], a[232:239], v3
  s_waitcnt vmcnt(4)
  v_cmp_eq_u32 vcc, -1, v16
  v_smfmac_f32_16x16x64_bf16 v[56:59], v[12:15], v[152:159], v3
  buffer_load_dwordx4 v[88:91], v117, s[8:11], s26 offen offset:0 sc1
  v_smfmac_f32_16x16x64_bf16 v[60:63], v[12:15], v[208:215], v3
  s_cbranch_vccnz cA_sc0_r2
cA_sc0_c2:
  v_smfmac_f32_16x16x64_bf16 v[36:39], v[16:19], a[16:23], v3
  v_smfmac_f32_16x16x64_bf16 v[40:43], v[16:19], a[72:79], v3
  v_smfmac_f32_16x16x64_bf16 v[44:47], v[16:19], a[128:135], v3
  buffer_load_dwordx4 v[92:95], v117, s[8:11], s26 offen offset:1024 sc1
  v_smfmac_f32_16x16x64_bf16 v[48:51], v[16:19], a[184:191], v3
  v_smfmac_f32_16x16x64_bf16 v[52:55], v[16:19], a[240:247], v3
  s_waitcnt vmcnt(5)
  v_cmp_eq_u32 vcc, -1, v20
  v_smfmac_f32_16x16x64_bf16 v[56:59], v[16:19], v[160:167], v3
  v_smfmac_f32_16x16x64_bf16 v[60:63], v[16:19], v[216:223], v3
  buffer_load_dwordx4 v[96:99], v2, s[8:11], s24 offen offset:0 sc1
  s_cbranch_vccnz cA_sc0_r3
cA_sc0_c3:
  v_smfmac_f32_16x16x64_bf16 v[36:39], v[20:23], a[24:31], v3
  v_smfmac_f32_16x16x64_bf16 v[40:43], v[20:23], a[80:87], v3
  s_waitcnt vmcnt(3)
  v_max3_u32 v66, v24, v27, v28
  v_smfmac_f32_16x16x64_bf16 v[44:47], v[20:23], a[136:143], v3
  v_max3_u32 v66, v66, v31, v32
  v_smfmac_f32_16x16x64_bf16 v[48:51], v[20:23], a[192:199], v3
  buffer_load_dwordx4 v[100:103], v2, s[8:11], s24 offen offset:1024 sc1
  v_max_u32 v66, v66, v35
  v_smfmac_f32_16x16x64_bf16 v[52:55], v[20:23], a[248:255], v3
  v_cmp_eq_u32 vcc, -1, v66
  v_smfmac_f32_16x16x64_bf16 v[56:59], v[20:23], v[168:175], v3
  v_smfmac_f32_16x16x64_bf16 v[60:63], v[20:23], v[224:231], v3
  s_cbranch_vccnz cA_sc0_r4
cA_sc0_c4:
  v_smfmac_f32_16x16x64_bf16 v[60:63], v[32:35], v[232:239], v3
  buffer_load_dwordx4 v[104:107], v2, s[8:11], s26 offen offset:0 sc1
  v_smfmac_f32_16x16x64_bf16 v[60:63], v[24:27], v[240:247], v3
  v_smfmac_f32_16x16x64_bf16 v[60:63], v[28:31], v[248:255], v3
  v_smfmac_f32_16x16x64_bf16 v[52:55], v[32:35], v[120:127], v3
  v_smfmac_f32_16x16x64_bf16 v[52:55], v[24:27], v[128:135], v3
  buffer_load_dwordx4 v[108:111], v2, s[8:11], s26 offen offset:1024 sc1
  v_smfmac_f32_16x16x64_bf16 v[52:55], v[28:31], v[136:143], v3
  v_cvt_pk_bf16_f32 v63, v62, v63
  v_smfmac_f32_16x16x64_bf16 v[56:59], v[32:35], v[176:183], v3
  v_cvt_pk_bf16_f32 v62, v60, v61
  v_smfmac_f32_16x16x64_bf16 v[56:59], v[24:27], v[184:191], v3
  v_mfma_f32_16x16x32_bf16 v[12:15], v[62:65], v[4:7], 0
  v_cvt_pk_bf16_f32 v55, v54, v55
  v_smfmac_f32_16x16x64_bf16 v[56:59], v[28:31], v[192:199], v3
  v_cvt_pk_bf16_f32 v54, v52, v53
  v_smfmac_f32_16x16x64_bf16 v[36:39], v[32:35], a[32:39], v3
  s_nop 1
  v_cvt_pk_bf16_f32 v76, v12, v13
  v_smfmac_f32_16x16x64_bf16 v[36:39], v[24:27], a[40:47], v3
  v_cvt_pk_bf16_f32 v77, v14, v15
  v_smfmac_f32_16x16x64_bf16 v[36:39], v[28:31], a[48:55], v3
  v_cvt_pk_bf16_f32 v56, v56, v57
  v_smfmac_f32_16x16x64_bf16 v[40:43], v[32:35], a[88:95], v3
  v_cvt_pk_bf16_f32 v57, v58, v59
  v_smfmac_f32_16x16x64_bf16 v[40:43], v[24:27], a[96:103], v3
  v_mfma_f32_16x16x32_bf16 v[16:19], v[54:57], v[4:7], 0
  v_cvt_pk_bf16_f32 v39, v38, v39
  v_smfmac_f32_16x16x64_bf16 v[40:43], v[28:31], a[104:111], v3
  v_cvt_pk_bf16_f32 v38, v36, v37
  v_smfmac_f32_16x16x64_bf16 v[44:47], v[32:35], a[144:151], v3
  s_nop 1
  v_cvt_pk_bf16_f32 v78, v16, v17
  v_smfmac_f32_16x16x64_bf16 v[44:47], v[24:27], a[152:159], v3
  v_cvt_pk_bf16_f32 v79, v18, v19
  v_smfmac_f32_16x16x64_bf16 v[44:47], v[28:31], a[160:167], v3
  v_cvt_pk_bf16_f32 v40, v40, v41
  v_smfmac_f32_16x16x64_bf16 v[48:51], v[32:35], a[200:207], v3
  v_cvt_pk_bf16_f32 v41, v42, v43
  v_smfmac_f32_16x16x64_bf16 v[48:51], v[24:27], a[208:215], v3
  v_smfmac_f32_16x16x64_bf16 v[48:51], v[28:31], a[216:223], v3
  s_waitcnt vmcnt(4)
  v_cvt_pk_bf16_f32 v47, v46, v47
  v_smfmac_f32_16x16x64_bf16 v[68:71], v[76:79], v[80:87], v3
  v_cvt_pk_bf16_f32 v46, v44, v45
  v_mfma_f32_16x16x32_bf16 v[12:15], v[38:41], v[4:7], 0
  s_nop 1
  v_cvt_pk_bf16_f32 v48, v48, v49
  v_cvt_pk_bf16_f32 v49, v50, v51
  s_nop 1
  v_mfma_f32_16x16x32_bf16 v[16:19], v[46:49], v[4:7], 0
  v_smfmac_f32_16x16x64_bf16 v[72:75], v[76:79], v[88:95], v3
  v_cvt_pk_bf16_f32 v20, v12, v13
  v_mfma_f32_16x16x32_bf16 v[52:55], v[30:33], v[76:79], 0
  s_waitcnt vmcnt(0)
  v_cvt_pk_bf16_f32 v21, v14, v15
  v_cvt_pk_bf16_f32 v22, v16, v17
  v_cvt_pk_bf16_f32 v23, v18, v19
  s_nop 1
  v_mfma_f32_16x16x32_bf16 v[52:55], v[8:11], v[20:23], v[52:55]
  v_smfmac_f32_16x16x64_bf16 v[68:71], v[20:23], v[96:103], v3
  v_smfmac_f32_16x16x64_bf16 v[72:75], v[20:23], v[104:111], v3
  s_nop 1
  ds_write_b128 v113, v[52:55]
  s_nop 1
  v_permlane32_swap_b32 v68, v70
  v_permlane32_swap_b32 v69, v71
  v_add_f32 v56, v68, v70
  v_add_f32 v58, v69, v71
  v_permlane32_swap_b32 v72, v74
  v_permlane32_swap_b32 v73, v75
  v_add_f32 v57, v72, v74
  v_add_f32 v59, v73, v75
  ds_write_b128 v2, v[56:59] offset:0
  v_cmp_u_f32 vcc, v57, v59
  v_mov_b32 v68, 0
  v_mov_b32 v69, 0
  v_mov_b32 v70, 0
  v_mov_b32 v71, 0
  s_cbranch_vccnz cA_sc0_retry
cA_sc0_cont:
  s_add_u32 s24, s24, 28672
  s_add_u32 s26, s26, 28672
  buffer_load_dwordx4 v[80:83], v117, s[8:11], s24 offen offset:0 sc1
  buffer_load_dwordx4 v[84:87], v117, s[8:11], s24 offen offset:1024 sc1
  v_mov_b32 v72, 0
  v_mov_b32 v73, 0
  v_mfma_f32_32x32x16_bf16 v[36:51], v[68:71], v[68:71], 0
  s_waitcnt lgkmcnt(0)
  s_barrier
  ds_read_b64 v[8:9], v114 offset:0
  ds_read_b64 v[10:11], v114 offset:1024
  ds_read_b64 v[12:13], v114 offset:2048
  ds_read_b64 v[14:15], v114 offset:3072
  ds_read2_b32 v[16:17], v115 offset0:0 offset1:64
  ds_read2_b32 v[18:19], v115 offset0:128 offset1:192
  v_mfma_f32_32x32x16_bf16 v[52:67], v[68:71], v[68:71], 0
  s_waitcnt lgkmcnt(0)
  v_pk_add_f32 v[16:17], v[16:17], v[18:19]
  v_pk_add_f32 v[8:9], v[8:9], v[10:11]
  v_pk_add_f32 v[12:13], v[12:13], v[14:15]
  v_add_f32 v20, v16, v17
  v_pk_add_f32 v[8:9], v[8:9], v[12:13]
  v_max_f32 v22, v8, v9
  v_add_f32_dpp v20, v20, v20 row_ror:8 row_mask:0xf bank_mask:0xf
  s_nop 0
  v_max_f32_dpp v22, v22, v22 row_ror:8 row_mask:0xf bank_mask:0xf
  v_max_f32 v22, v22, v20
  s_nop 1
  v_max_f32_dpp v22, v22, v22 quad_perm:[1,0,3,2] row_mask:0xf bank_mask:0xf
  s_nop 1
  v_max_f32_dpp v22, v22, v22 quad_perm:[2,3,0,1] row_mask:0xf bank_mask:0xf
  s_nop 1
  v_max_f32_dpp v22, v22, v22 row_half_mirror row_mask:0xf bank_mask:0xf
  v_pk_add_f32 v[8:9], v[8:9], v[22:23] op_sel_hi:[1,0] neg_lo:[0,1] neg_hi:[0,1]
  v_sub_f32 v20, v20, v22
  v_exp_f32 v8, v8
  v_exp_f32 v9, v9
  v_exp_f32 v20, v20
  v_add_f32 v24, v8, v9
  v_fmac_f32 v24, 0.5, v20
  v_mov_b32_dpp v21, v20 quad_perm:[1,0,3,2] row_mask:0xf bank_mask:0xf
  s_nop 0
  v_add_f32_dpp v24, v24, v24 quad_perm:[1,0,3,2] row_mask:0xf bank_mask:0xf
  s_nop 1
  v_add_f32_dpp v24, v24, v24 quad_perm:[2,3,0,1] row_mask:0xf bank_mask:0xf
  s_nop 1
  v_add_f32_dpp v24, v24, v24 row_half_mirror row_mask:0xf bank_mask:0xf
  s_nop 1
  v_add_f32_dpp v24, v24, v24 row_ror:8 row_mask:0xf bank_mask:0xf
  v_rcp_f32 v24, v24
  s_nop 0
  v_pk_mul_f32 v[8:9], v[8:9], v[24:25] op_sel_hi:[1,0]
  v_pk_mul_f32 v[20:21], v[20:21], v[24:25] op_sel_hi:[1,0]
  v_cvt_pk_bf16_f32 v8, v8, v9
  v_cvt_pk_bf16_f32 v20, v20, v21
  v_min_u32 v8, -2, v8
  buffer_store_dword v8, v1, s[8:11], s20 offen
  v_min_u32 v20, -2, v20
  buffer_store_dword v20, v118, s[8:11], s20 offen
  buffer_store_dword v119, v1, s[8:11], s21 offen
  buffer_store_dword v119, v118, s[8:11], s21 offen
  v_mov_b32 v74, 0
  v_mov_b32 v75, 0
  s_mov_b32 s19, s18
  s_add_u32 s18, s18, 1
  s_mov_b32 s22, s20
  s_mov_b32 s20, s21
  s_mov_b32 s21, s22
  s_add_u32 s23, s20, 4096
  s_cmp_lt_u32 s19, 63
  s_cbranch_scc1 cA_sc0_loop
  s_branch cA_done
cA_sc0_r0:
  s_add_u32 s31, s31, 1
  buffer_load_dwordx4 v[8:11], v2, s[8:11], s20 offen offset:0 sc1
  s_waitcnt vmcnt(0)
  v_cmp_eq_u32 vcc, -1, v8
  v_mov_b32 v36, 0
  v_mov_b32 v37, 0
  v_mov_b32 v38, 0
  v_mov_b32 v39, 0
  v_mov_b32 v40, 0
  v_mov_b32 v41, 0
  v_mov_b32 v42, 0
  v_mov_b32 v43, 0
  v_mov_b32 v44, 0
  v_mov_b32 v45, 0
  v_mov_b32 v46, 0
  v_mov_b32 v47, 0
  v_mov_b32 v48, 0
  v_mov_b32 v49, 0
  v_mov_b32 v50, 0
  v_mov_b32 v51, 0
  s_nop 1
  s_cbranch_vccz cA_sc0_go
  s_add_u32 s30, s30, 1
  s_cmp_lt_u32 s30, 400000
  s_cbranch_scc1 cA_sc0_r0
  s_branch cA_abort
cA_sc0_r1:
  s_add_u32 s31, s31, 1
  buffer_load_dwordx4 v[12:15], v2, s[8:11], s20 offen offset:1024 sc1
  s_waitcnt vmcnt(0)
  v_cmp_eq_u32 vcc, -1, v12
  s_nop 4
  s_cbranch_vccz cA_sc0_c1
  s_add_u32 s30, s30, 1
  s_cmp_lt_u32 s30, 400000
  s_cbranch_scc1 cA_sc0_r1
  s_branch cA_abort
cA_sc0_r2:
  s_add_u32 s31, s31, 1
  buffer_load_dwordx4 v[16:19], v2, s[8:11], s20 offen offset:2048 sc1
  s_waitcnt vmcnt(0)
  v_cmp_eq_u32 vcc, -1, v16
  s_nop 4
  s_cbranch_vccz cA_sc0_c2
  s_add_u32 s30, s30, 1
  s_cmp_lt_u32 s30, 400000
  s_cbranch_scc1 cA_sc0_r2
  s_branch cA_abort
cA_sc0_r3:
  s_add_u32 s31, s31, 1
  buffer_load_dwordx4 v[20:23], v2, s[8:11], s20 offen offset:3072 sc1
  s_waitcnt vmcnt(0)
  v_cmp_eq_u32 vcc, -1, v20
  s_nop 4
  s_cbranch_vccz cA_sc0_c3
  s_add_u32 s30, s30, 1
  s_cmp_lt_u32 s30, 400000
  s_cbranch_scc1 cA_sc0_r3
  s_branch cA_abort
cA_sc0_r4:
  s_add_u32 s31, s31, 1
  buffer_load_dwordx4 v[32:35], v2, s[8:11], s23 offen offset:0 sc1
  buffer_load_dwordx4 v[24:27], v2, s[8:11], s23 offen offset:1024 sc1
  buffer_load_dwordx4 v[28:31], v2, s[8:11], s23 offen offset:2048 sc1
  s_waitcnt vmcnt(0)
  v_max3_u32 v66, v24, v27, v28
  v_max3_u32 v66, v66, v31, v32
  v_max_u32 v66, v66, v35
  v_cmp_eq_u32 vcc, -1, v66
  s_nop 4
  s_cbranch_vccz cA_sc0_c4
  s_add_u32 s30, s30, 1
  s_cmp_lt_u32 s30, 400000
  s_cbranch_scc1 cA_sc0_r4
  s_branch cA_abort
cA_sc0_retry:
  s_cmp_lg_u32 s62, 0
  s_cbranch_scc1 cA_sc0_cont
  s_waitcnt vmcnt(0) lgkmcnt(0)
cA_sc0_rv:
  buffer_load_dwordx4 v[8:11], v2, s[8:11], s20 offen offset:0 sc1
  buffer_load_dwordx4 v[12:15], v2, s[8:11], s20 offen offset:1024 sc1
  buffer_load_dwordx4 v[16:19], v2, s[8:11], s20 offen offset:2048 sc1
  buffer_load_dwordx4 v[20:23], v2, s[8:11], s20 offen offset:3072 sc1
  buffer_load_dwordx4 v[32:35], v2, s[8:11], s23 offen offset:0 sc1
  buffer_load_dwordx4 v[24:27], v2, s[8:11], s23 offen offset:1024 sc1
  buffer_load_dwordx4 v[28:31], v2, s[8:11], s23 offen offset:2048 sc1
  s_waitcnt vmcnt(0)
  v_pk_max_u16 v66, v8, v9
  v_pk_max_u16 v66, v66, v10
  v_pk_max_u16 v66, v66, v11
  v_pk_max_u16 v66, v66, v12
  v_pk_max_u16 v66, v66, v13
  v_pk_max_u16 v66, v66, v14
  v_pk_max_u16 v66, v66, v15
  v_pk_max_u16 v66, v66, v16
  v_pk_max_u16 v66, v66, v17
  v_pk_max_u16 v66, v66, v18
  v_pk_max_u16 v66, v66, v19
  v_pk_max_u16 v66, v66, v20
  v_pk_max_u16 v66, v66, v21
  v_pk_max_u16 v66, v66, v22
  v_pk_max_u16 v66, v66, v23
  v_pk_max_u16 v66, v66, v24
  v_pk_max_u16 v66, v66, v25
  v_pk_max_u16 v66, v66, v26
  v_pk_max_u16 v66, v66, v27
  v_pk_max_u16 v66, v66, v28
  v_pk_max_u16 v66, v66, v29
  v_pk_max_u16 v66, v66, v30
  v_pk_max_u16 v66, v66, v31
  v_pk_max_u16 v66, v66, v32
  v_pk_max_u16 v66, v66, v33
  v_pk_max_u16 v66, v66, v34
  v_pk_max_u16 v66, v66, v35
  v_lshlrev_b32 v67, 16, v66
  v_max_u32 v66, v66, v67
  v_cmp_le_u32 vcc, 0xffff0000, v66
  s_cbranch_vccz cA_sc0_rk
  s_add_u32 s30, s30, 1
  s_cmp_lt_u32 s30, 400000
  s_cbranch_scc1 cA_sc0_rv
  s_branch cA_abort
cA_sc0_rk:
  s_mov_b32 s62, 1
  v_mov_b32 v36, 0
  v_mov_b32 v37, 0
  v_mov_b32 v38, 0
  v_mov_b32 v39, 0
  v_mov_b32 v40, 0
  v_mov_b32 v41, 0
  v_mov_b32 v42, 0
  v_mov_b32 v43, 0
  v_mov_b32 v44, 0
  v_mov_b32 v45, 0
  v_mov_b32 v46, 0
  v_mov_b32 v47, 0
  v_mov_b32 v48, 0
  v_mov_b32 v49, 0
  v_mov_b32 v50, 0
  v_mov_b32 v51, 0
  v_mov_b32 v60, 0
  v_mov_b32 v61, 0
  v_mov_b32 v62, 0
  v_mov_b32 v63, 0
  v_mov_b32 v68, 0
  v_mov_b32 v69, 0
  v_mov_b32 v70, 0
  v_mov_b32 v71, 0
  v_mov_b32 v72, 0
  v_mov_b32 v73, 0
  v_mov_b32 v74, 0
  v_mov_b32 v75, 0
  v_mov_b32 v52, 0
  v_mov_b32 v53, 0
  v_mov_b32 v54, 0
  v_mov_b32 v55, 0
  v_mov_b32 v56, 0
  v_mov_b32 v57, 0
  v_mov_b32 v58, 0
  v_mov_b32 v59, 0
  s_add_u32 s31, s31, 0x100
  s_nop 0
  s_branch cA_sc0_go
.p2align 6
cA_sc1_loop:
  s_mov_b32 s30, 0
  s_mov_b32 s62, 0
  s_setprio 3
  s_barrier
  buffer_load_dwordx4 v[8:11], v2, s[8:11], s20 offen offset:0 sc1
  s_setprio 2
  buffer_load_dwordx4 v[12:15], v2, s[8:11], s20 offen offset:1024 sc1
  s_setprio 1
  buffer_load_dwordx4 v[16:19], v2, s[8:11], s20 offen offset:2048 sc1
  s_setprio 0
  buffer_load_dwordx4 v[20:23], v2, s[8:11], s20 offen offset:3072 sc1
cA_sc1_go:
  s_waitcnt vmcnt(3)
  v_smfmac_f32_16x16x64_bf16 v[36:39], v[8:11], a[0:7], v3
  buffer_load_dwordx4 v[28:31], v2, s[8:11], s23 offen offset:0 sc1
  v_cmp_eq_u32 vcc, -1, v8
  v_smfmac_f32_16x16x64_bf16 v[40:43], v[8:11], a[56:63], v3
  v_smfmac_f32_16x16x64_bf16 v[44:47], v[8:11], a[112:119], v3
  buffer_load_dwordx4 v[24:27], v2, s[8:11], s23 offen offset:1024 sc1
  s_cbranch_vccnz cA_sc1_r0
  v_smfmac_f32_16x16x64_bf16 v[48:51], v[8:11], a[168:175], v3
  v_smfmac_f32_16x16x64_bf16 v[52:55], v[8:11], a[224:231], v3
  s_waitcnt vmcnt(4)
  v_cmp_eq_u32 vcc, -1, v12
  v_smfmac_f32_16x16x64_bf16 v[56:59], v[8:11], v[144:151], v3
  buffer_load_dwordx4 v[32:35], v2, s[8:11], s23 offen offset:2048 sc1
  v_smfmac_f32_16x16x64_bf16 v[60:63], v[8:11], v[200:207], v3
  s_cbranch_vccnz cA_sc1_r1
cA_sc1_c1:
  v_smfmac_f32_16x16x64_bf16 v[36:39], v[12:15], a[8:15], v3
  v_smfmac_f32_16x16x64_bf16 v[40:43], v[12:15], a[64:71], v3
  v_smfmac_f32_16x16x64_bf16 v[44:47], v[12:15], a[120:127], v3
  v_smfmac_f32_16x16x64_bf16 v[48:51], v[12:15], a[176:183], v3
  v_smfmac_f32_16x16x64_bf16 v[52:55], v[12:15], a[232:239], v3
  s_waitcnt vmcnt(4)
  v_cmp_eq_u32 vcc, -1, v16
  v_smfmac_f32_16x16x64_bf16 v[56:59], v[12:15], v[152:159], v3
  buffer_load_dwordx4 v[88:91], v117, s[8:11], s26 offen offset:0 sc1
  v_smfmac_f32_16x16x64_bf16 v[60:63], v[12:15], v[208:215], v3
  s_cbranch_vccnz cA_sc1_r2
cA_sc1_c2:
  v_smfmac_f32_16x16x64_bf16 v[36:39], v[16:19], a[16:23], v3
  v_smfmac_f32_16x16x64_bf16 v[40:43], v[16:19], a[72:79], v3
  v_smfmac_f32_16x16x64_bf16 v[44:47], v[16:19], a[128:135], v3
  buffer_load_dwordx4 v[92:95], v117, s[8:11], s26 offen offset:1024 sc1
  v_smfmac_f32_16x16x64_bf16 v[48:51], v[16:19], a[184:191], v3
  v_smfmac_f32_16x16x64_bf16 v[52:55], v[16:19], a[240:247], v3
  s_waitcnt vmcnt(5)
  v_cmp_eq_u32 vcc, -1, v20
  v_smfmac_f32_16x16x64_bf16 v[56:59], v[16:19], v[160:167], v3
  v_smfmac_f32_16x16x64_bf16 v[60:63], v[16:19], v[216:223], v3
  buffer_load_dwordx4 v[96:99], v2, s[8:11], s24 offen offset:0 sc1
  s_cbranch_vccnz cA_sc1_r3
cA_sc1_c3:
  v_smfmac_f32_16x16x64_bf16 v[36:39], v[20:23], a[24:31], v3
  v_smfmac_f32_16x16x64_bf16 v[40:43], v[20:23], a[80:87], v3
  s_waitcnt vmcnt(3)
  v_max3_u32 v66, v24, v27, v28
  v_smfmac_f32_16x16x64_bf16 v[44:47], v[20:23], a[136:143], v3
  v_max3_u32 v66, v66, v31, v32
  v_smfmac_f32_16x16x64_bf16 v[48:51], v[20:23], a[192:199], v3
  buffer_load_dwordx4 v[100:103], v2, s[8:11], s24 offen offset:1024 sc1
  v_max_u32 v66, v66, v35
  v_smfmac_f32_16x16x64_bf16 v[52:55], v[20:23], a[248:255], v3
  v_cmp_eq_u32 vcc, -1, v66
  v_smfmac_f32_16x16x64_bf16 v[56:59], v[20:23], v[168:175], v3
  v_smfmac_f32_16x16x64_bf16 v[60:63], v[20:23], v[224:231], v3
  s_cbranch_vccnz cA_sc1_r4
cA_sc1_c4:
  v_smfmac_f32_16x16x64_bf16 v[60:63], v[28:31], v[232:239], v3
  buffer_load_dwordx4 v[104:107], v2, s[8:11], s26 offen offset:0 sc1
  v_smfmac_f32_16x16x64_bf16 v[60:63], v[24:27], v[240:247], v3
  v_smfmac_f32_16x16x64_bf16 v[60:63], v[32:35], v[248:255], v3
  v_smfmac_f32_16x16x64_bf16 v[52:55], v[28:31], v[120:127], v3
  v_smfmac_f32_16x16x64_bf16 v[52:55], v[24:27], v[128:135], v3
  buffer_load_dwordx4 v[108:111], v2, s[8:11], s26 offen offset:1024 sc1
  v_smfmac_f32_16x16x64_bf16 v[52:55], v[32:35], v[136:143], v3
  v_cvt_pk_bf16_f32 v63, v62, v63
  v_smfmac_f32_16x16x64_bf16 v[56:59], v[28:31], v[176:183], v3
  v_cvt_pk_bf16_f32 v62, v60, v61
  v_smfmac_f32_16x16x64_bf16 v[56:59], v[24:27], v[184:191], v3
  v_mfma_f32_16x16x32_bf16 v[8:11], v[62:65], v[4:7], 0
  v_cvt_pk_bf16_f32 v55, v54, v55
  v_smfmac_f32_16x16x64_bf16 v[56:59], v[32:35], v[192:199], v3
  v_cvt_pk_bf16_f32 v54, v52, v53
  v_smfmac_f32_16x16x64_bf16 v[36:39], v[28:31], a[32:39], v3
  s_nop 1
  v_cvt_pk_bf16_f32 v78, v8, v9
  v_smfmac_f32_16x16x64_bf16 v[36:39], v[24:27], a[40:47], v3
  v_cvt_pk_bf16_f32 v79, v10, v11
  v_smfmac_f32_16x16x64_bf16 v[36:39], v[32:35], a[48:55], v3
  v_cvt_pk_bf16_f32 v56, v56, v57
  v_smfmac_f32_16x16x64_bf16 v[40:43], v[28:31], a[88:95], v3
  v_cvt_pk_bf16_f32 v57, v58, v59
  v_smfmac_f32_16x16x64_bf16 v[40:43], v[24:27], a[96:103], v3
  v_mfma_f32_16x16x32_bf16 v[16:19], v[54:57], v[4:7], 0
  v_cvt_pk_bf16_f32 v39, v38, v39
  v_smfmac_f32_16x16x64_bf16 v[40:43], v[32:35], a[104:111], v3
  v_cvt_pk_bf16_f32 v38, v36, v37
  v_smfmac_f32_16x16x64_bf16 v[44:47], v[28:31], a[144:151], v3
  s_nop 1
  v_cvt_pk_bf16_f32 v76, v16, v17
  v_smfmac_f32_16x16x64_bf16 v[44:47], v[24:27], a[152:159], v3
  v_cvt_pk_bf16_f32 v77, v18, v19
  v_smfmac_f32_16x16x64_bf16 v[44:47], v[32:35], a[160:167], v3
  v_cvt_pk_bf16_f32 v40, v40, v41
  v_smfmac_f32_16x16x64_bf16 v[48:51], v[28:31], a[200:207], v3
  v_cvt_pk_bf16_f32 v41, v42, v43
  v_smfmac_f32_16x16x64_bf16 v[48:51], v[24:27], a[208:215], v3
  v_smfmac_f32_16x16x64_bf16 v[48:51], v[32:35], a[216:223], v3
  s_waitcnt vmcnt(4)
  v_cvt_pk_bf16_f32 v47, v46, v47
  v_smfmac_f32_16x16x64_bf16 v[68:71], v[76:79], v[80:87], v3
  v_cvt_pk_bf16_f32 v46, v44, v45
  v_mfma_f32_16x16x32_bf16 v[8:11], v[38:41], v[4:7], 0
  s_nop 1
  v_cvt_pk_bf16_f32 v48, v48, v49
  v_cvt_pk_bf16_f32 v49, v50, v51
  s_nop 1
  v_mfma_f32_16x16x32_bf16 v[16:19], v[46:49], v[4:7], 0
  v_smfmac_f32_16x16x64_bf16 v[72:75], v[76:79], v[88:95], v3
  v_cvt_pk_bf16_f32 v20, v8, v9
  v_mfma_f32_16x16x32_bf16 v[52:55], v[30:33], v[76:79], 0
  s_waitcnt vmcnt(0)
  v_cvt_pk_bf16_f32 v21, v10, v11
  v_cvt_pk_bf16_f32 v22, v16, v17
  v_cvt_pk_bf16_f32 v23, v18, v19
  s_nop 1
  v_mfma_f32_16x16x32_bf16 v[52:55], v[12:15], v[20:23], v[52:55]
  v_smfmac_f32_16x16x64_bf16 v[68:71], v[20:23], v[96:103], v3
  v_smfmac_f32_16x16x64_bf16 v[72:75], v[20:23], v[104:111], v3
  s_nop 1
  ds_write_b128 v113, v[52:55]
  s_nop 1
  v_permlane32_swap_b32 v68, v70
  v_permlane32_swap_b32 v69, v71
  v_add_f32 v56, v68, v70
  v_add_f32 v58, v69, v71
  v_permlane32_swap_b32 v72, v74
  v_permlane32_swap_b32 v73, v75
  v_add_f32 v57, v72, v74
  v_add_f32 v59, v73, v75
  ds_write_b128 v2, v[56:59] offset:1024
  v_cmp_u_f32 vcc, v57, v59
  v_mov_b32 v68, 0
  v_mov_b32 v69, 0
  v_mov_b32 v70, 0
  v_mov_b32 v71, 0
  s_cbranch_vccnz cA_sc1_retry
cA_sc1_cont:
  s_add_u32 s24, s24, 28672
  s_add_u32 s26, s26, 28672
  buffer_load_dwordx4 v[80:83], v117, s[8:11], s24 offen offset:0 sc1
  buffer_load_dwordx4 v[84:87], v117, s[8:11], s24 offen offset:1024 sc1
  v_mov_b32 v72, 0
  v_mov_b32 v73, 0
  v_mfma_f32_32x32x16_bf16 v[36:51], v[68:71], v[68:71], 0
  s_waitcnt lgkmcnt(0)
  s_barrier
  ds_read_b64 v[8:9], v114 offset:0
  ds_read_b64 v[10:11], v114 offset:1024
  ds_read_b64 v[12:13], v114 offset:2048
  ds_read_b64 v[14:15], v114 offset:3072
  ds_read2_b32 v[16:17], v115 offset0:0 offset1:64
  ds_read2_b32 v[18:19], v115 offset0:128 offset1:192
  v_mfma_f32_32x32x16_bf16 v[52:67], v[68:71], v[68:71], 0
  s_waitcnt lgkmcnt(0)
  v_pk_add_f32 v[16:17], v[16:17], v[18:19]
  v_pk_add_f32 v[8:9], v[8:9], v[10:11]
  v_pk_add_f32 v[12:13], v[12:13], v[14:15]
  v_add_f32 v20, v16, v17
  v_pk_add_f32 v[8:9], v[8:9], v[12:13]
  v_max_f32 v22, v8, v9
  v_add_f32_dpp v20, v20, v20 row_ror:8 row_mask:0xf bank_mask:0xf
  s_nop 0
  v_max_f32_dpp v22, v22, v22 row_ror:8 row_mask:0xf bank_mask:0xf
  v_max_f32 v22, v22, v20
  s_nop 1
  v_max_f32_dpp v22, v22, v22 quad_perm:[1,0,3,2] row_mask:0xf bank_mask:0xf
  s_nop 1
  v_max_f32_dpp v22, v22, v22 quad_perm:[2,3,0,1] row_mask:0xf bank_mask:0xf
  s_nop 1
  v_max_f32_dpp v22, v22, v22 row_half_mirror row_mask:0xf bank_mask:0xf
  v_pk_add_f32 v[8:9], v[8:9], v[22:23] op_sel_hi:[1,0] neg_lo:[0,1] neg_hi:[0,1]
  v_sub_f32 v20, v20, v22
  v_exp_f32 v8, v8
  v_exp_f32 v9, v9
  v_exp_f32 v20, v20
  buffer_store_dword v112, v116, s[8:11], 0 offen
  v_add_f32 v24, v8, v9
  v_fmac_f32 v24, 0.5, v20
  v_mov_b32_dpp v21, v20 quad_perm:[1,0,3,2] row_mask:0xf bank_mask:0xf
  s_nop 0
  v_add_f32_dpp v24, v24, v24 quad_perm:[1,0,3,2] row_mask:0xf bank_mask:0xf
  s_nop 1
  v_add_f32_dpp v24, v24, v24 quad_perm:[2,3,0,1] row_mask:0xf bank_mask:0xf
  s_nop 1
  v_add_f32_dpp v24, v24, v24 row_half_mirror row_mask:0xf bank_mask:0xf
  s_nop 1
  v_add_f32_dpp v24, v24, v24 row_ror:8 row_mask:0xf bank_mask:0xf
  v_rcp_f32 v24, v24
  s_nop 0
  v_pk_mul_f32 v[8:9], v[8:9], v[24:25] op_sel_hi:[1,0]
  v_pk_mul_f32 v[20:21], v[20:21], v[24:25] op_sel_hi:[1,0]
  v_cvt_pk_bf16_f32 v8, v8, v9
  v_cvt_pk_bf16_f32 v20, v20, v21
  v_min_u32 v8, -2, v8
  buffer_store_dword v8, v1, s[8:11], s20 offen
  v_min_u32 v20, -2, v20
  buffer_store_dword v20, v118, s[8:11], s20 offen
  buffer_store_dword v119, v1, s[8:11], s21 offen
  buffer_store_dword v119, v118, s[8:11], s21 offen
  v_mov_b32 v74, 0
  v_mov_b32 v75, 0
  s_mov_b32 s19, s18
  s_add_u32 s18, s18, 1
  s_mov_b32 s22, s20
  s_mov_b32 s20, s21
  s_mov_b32 s21, s22
  s_add_u32 s23, s20, 4096
  v_mov_b32 v112, s18
  s_cmp_lt_u32 s19, 63
  s_nop 0
  s_cbranch_scc1 cA_sc1_loop
  s_branch cA_done
cA_sc1_r0:
  s_add_u32 s31, s31, 1
  buffer_load_dwordx4 v[8:11], v2, s[8:11], s20 offen offset:0 sc1
  s_waitcnt vmcnt(0)
  v_cmp_eq_u32 vcc, -1, v8
  v_mov_b32 v36, 0
  v_mov_b32 v37, 0
  v_mov_b32 v38, 0
  v_mov_b32 v39, 0
  v_mov_b32 v40, 0
  v_mov_b32 v41, 0
  v_mov_b32 v42, 0
  v_mov_b32 v43, 0
  v_mov_b32 v44, 0
  v_mov_b32 v45, 0
  v_mov_b32 v46, 0
  v_mov_b32 v47, 0
  v_mov_b32 v48, 0
  v_mov_b32 v49, 0
  v_mov_b32 v50, 0
  v_mov_b32 v51, 0
  s_nop 1
  s_cbranch_vccz cA_sc1_go
  s_add_u32 s30, s30, 1
  s_cmp_lt_u32 s30, 400000
  s_cbranch_scc1 cA_sc1_r0
  s_branch cA_abort
cA_sc1_r1:
  s_add_u32 s31, s31, 1
  buffer_load_dwordx4 v[12:15], v2, s[8:11], s20 offen offset:1024 sc1
  s_waitcnt vmcnt(0)
  v_cmp_eq_u32 vcc, -1, v12
  s_nop 4
  s_cbranch_vccz cA_sc1_c1
  s_add_u32 s30, s30, 1
  s_cmp_lt_u32 s30, 400000
  s_cbranch_scc1 cA_sc1_r1
  s_branch cA_abort
cA_sc1_r2:
  s_add_u32 s31, s31, 1
  buffer_load_dwordx4 v[16:19], v2, s[8:11], s20 offen offset:2048 sc1
  s_waitcnt vmcnt(0)
  v_cmp_eq_u32 vcc, -1, v16
  s_nop 4
  s_cbranch_vccz cA_sc1_c2
  s_add_u32 s30, s30, 1
  s_cmp_lt_u32 s30, 400000
  s_cbranch_scc1 cA_sc1_r2
  s_branch cA_abort
cA_sc1_r3:
  s_add_u32 s31, s31, 1
  buffer_load_dwordx4 v[20:23], v2, s[8:11], s20 offen offset:3072 sc1
  s_waitcnt vmcnt(0)
  v_cmp_eq_u32 vcc, -1, v20
  s_nop 4
  s_cbranch_vccz cA_sc1_c3
  s_add_u32 s30, s30, 1
  s_cmp_lt_u32 s30, 400000
  s_cbranch_scc1 cA_sc1_r3
  s_branch cA_abort
cA_sc1_r4:
  s_add_u32 s31, s31, 1
  buffer_load_dwordx4 v[28:31], v2, s[8:11], s23 offen offset:0 sc1
  buffer_load_dwordx4 v[24:27], v2, s[8:11], s23 offen offset:1024 sc1
  buffer_load_dwordx4 v[32:35], v2, s[8:11], s23 offen offset:2048 sc1
  s_waitcnt vmcnt(0)
  v_max3_u32 v66, v24, v27, v28
  v_max3_u32 v66, v66, v31, v32
  v_max_u32 v66, v66, v35
  v_cmp_eq_u32 vcc, -1, v66
  s_nop 4
  s_cbranch_vccz cA_sc1_c4
  s_add_u32 s30, s30, 1
  s_cmp_lt_u32 s30, 400000
  s_cbranch_scc1 cA_sc1_r4
  s_branch cA_abort
cA_sc1_retry:
  s_cmp_lg_u32 s62, 0
  s_cbranch_scc1 cA_sc1_cont
  s_waitcnt vmcnt(0) lgkmcnt(0)
cA_sc1_rv:
  buffer_load_dwordx4 v[8:11], v2, s[8:11], s20 offen offset:0 sc1
  buffer_load_dwordx4 v[12:15], v2, s[8:11], s20 offen offset:1024 sc1
  buffer_load_dwordx4 v[16:19], v2, s[8:11], s20 offen offset:2048 sc1
  buffer_load_dwordx4 v[20:23], v2, s[8:11], s20 offen offset:3072 sc1
  buffer_load_dwordx4 v[28:31], v2, s[8:11], s23 offen offset:0 sc1
  buffer_load_dwordx4 v[24:27], v2, s[8:11], s23 offen offset:1024 sc1
  buffer_load_dwordx4 v[32:35], v2, s[8:11], s23 offen offset:2048 sc1
  s_waitcnt vmcnt(0)
  v_pk_max_u16 v66, v8, v9
  v_pk_max_u16 v66, v66, v10
  v_pk_max_u16 v66, v66, v11
  v_pk_max_u16 v66, v66, v12
  v_pk_max_u16 v66, v66, v13
  v_pk_max_u16 v66, v66, v14
  v_pk_max_u16 v66, v66, v15
  v_pk_max_u16 v66, v66, v16
  v_pk_max_u16 v66, v66, v17
  v_pk_max_u16 v66, v66, v18
  v_pk_max_u16 v66, v66, v19
  v_pk_max_u16 v66, v66, v20
  v_pk_max_u16 v66, v66, v21
  v_pk_max_u16 v66, v66, v22
  v_pk_max_u16 v66, v66, v23
  v_pk_max_u16 v66, v66, v24
  v_pk_max_u16 v66, v66, v25
  v_pk_max_u16 v66, v66, v26
  v_pk_max_u16 v66, v66, v27
  v_pk_max_u16 v66, v66, v28
  v_pk_max_u16 v66, v66, v29
  v_pk_max_u16 v66, v66, v30
  v_pk_max_u16 v66, v66, v31
  v_pk_max_u16 v66, v66, v32
  v_pk_max_u16 v66, v66, v33
  v_pk_max_u16 v66, v66, v34
  v_pk_max_u16 v66, v66, v35
  v_lshlrev_b32 v67, 16, v66
  v_max_u32 v66, v66, v67
  v_cmp_le_u32 vcc, 0xffff0000, v66
  s_cbranch_vccz cA_sc1_rk
  s_add_u32 s30, s30, 1
  s_cmp_lt_u32 s30, 400000
  s_cbranch_scc1 cA_sc1_rv
  s_branch cA_abort
cA_sc1_rk:
  s_mov_b32 s62, 1
  v_mov_b32 v36, 0
  v_mov_b32 v37, 0
  v_mov_b32 v38, 0
  v_mov_b32 v39, 0
  v_mov_b32 v40, 0
  v_mov_b32 v41, 0
  v_mov_b32 v42, 0
  v_mov_b32 v43, 0
  v_mov_b32 v44, 0
  v_mov_b32 v45, 0
  v_mov_b32 v46, 0
  v_mov_b32 v47, 0
  v_mov_b32 v48, 0
  v_mov_b32 v49, 0
  v_mov_b32 v50, 0
  v_mov_b32 v51, 0
  v_mov_b32 v60, 0
  v_mov_b32 v61, 0
  v_mov_b32 v62, 0
  v_mov_b32 v63, 0
  v_mov_b32 v68, 0
  v_mov_b32 v69, 0
  v_mov_b32 v70, 0
  v_mov_b32 v71, 0
  v_mov_b32 v72, 0
  v_mov_b32 v73, 0
  v_mov_b32 v74, 0
  v_mov_b32 v75, 0
  v_mov_b32 v52, 0
  v_mov_b32 v53, 0
  v_mov_b32 v54, 0
  v_mov_b32 v55, 0
  v_mov_b32 v56, 0
  v_mov_b32 v57, 0
  v_mov_b32 v58, 0
  v_mov_b32 v59, 0
  s_add_u32 s31, s31, 0x100
  s_nop 0
  s_branch cA_sc1_go
.p2align 6
cA_sc2_loop:
  s_mov_b32 s30, 0
  s_mov_b32 s62, 0
  s_setprio 3
  s_barrier
  buffer_load_dwordx4 v[8:11], v2, s[8:11], s20 offen offset:0 sc1
  s_setprio 2
  buffer_load_dwordx4 v[12:15], v2, s[8:11], s20 offen offset:1024 sc1
  s_setprio 1
  buffer_load_dwordx4 v[16:19], v2, s[8:11], s20 offen offset:2048 sc1
  s_setprio 0
  buffer_load_dwordx4 v[20:23], v2, s[8:11], s20 offen offset:3072 sc1
cA_sc2_go:
  s_waitcnt vmcnt(3)
  v_smfmac_f32_16x16x64_bf16 v[36:39], v[8:11], a[0:7], v3
  buffer_load_dwordx4 v[24:27], v2, s[8:11], s23 offen offset:0 sc1
  v_cmp_eq_u32 vcc, -1, v8
  v_smfmac_f32_16x16x64_bf16 v[40:43], v[8:11], a[56:63], v3
  v_smfmac_f32_16x16x64_bf16 v[44:47], v[8:11], a[112:119], v3
  buffer_load_dwordx4 v[32:35], v2, s[8:11], s23 offen offset:1024 sc1
  s_cbranch_vccnz cA_sc2_r0
  v_smfmac_f32_16x16x64_bf16 v[48:51], v[8:11], a[168:175], v3
  v_smfmac_f32_16x16x64_bf16 v[52:55], v[8:11], a[224:231], v3
  s_waitcnt vmcnt(4)
  v_cmp_eq_u32 vcc, -1, v12
  v_smfmac_f32_16x16x64_bf16 v[56:59], v[8:11], v[144:151], v3
  buffer_load_dwordx4 v[28:31], v2, s[8:11], s23 offen offset:2048 sc1
  v_smfmac_f32_16x16x64_bf16 v[62:65], v[8:11], v[200:207], v3
  s_cbranch_vccnz cA_sc2_r1
cA_sc2_c1:
  v_smfmac_f32_16x16x64_bf16 v[36:39], v[12:15], a[8:15], v3
  v_smfmac_f32_16x16x64_bf16 v[40:43], v[12:15], a[64:71], v3
  v_smfmac_f32_16x16x64_bf16 v[44:47], v[12:15], a[120:127], v3
  v_smfmac_f32_16x16x64_bf16 v[48:51], v[12:15], a[176:183], v3
  v_smfmac_f32_16x16x64_bf16 v[52:55], v[12:15], a[232:239], v3
  s_waitcnt vmcnt(4)
  v_cmp_eq_u32 vcc, -1, v16
  v_smfmac_f32_16x16x64_bf16 v[56:59], v[12:15], v[152:159], v3
  buffer_load_dwordx4 v[88:91], v117, s[8:11], s26 offen offset:0 sc1
  v_smfmac_f32_16x16x64_bf16 v[62:65], v[12:15], v[208:215], v3
  s_cbranch_vccnz cA_sc2_r2
cA_sc2_c2:
  v_smfmac_f32_16x16x64_bf16 v[36:39], v[16:19], a[16:23], v3
  v_smfmac_f32_16x16x64_bf16 v[40:43], v[16:19], a[72:79], v3
  v_smfmac_f32_16x16x64_bf16 v[44:47], v[16:19], a[128:135], v3
  buffer_load_dwordx4 v[92:95], v117, s[8:11], s26 offen offset:1024 sc1
  v_smfmac_f32_16x16x64_bf16 v[48:51], v[16:19], a[184:191], v3
  v_smfmac_f32_16x16x64_bf16 v[52:55], v[16:19], a[240:247], v3
  s_waitcnt vmcnt(5)
  v_cmp_eq_u32 vcc, -1, v20
  v_smfmac_f32_16x16x64_bf16 v[56:59], v[16:19], v[160:167], v3
  v_smfmac_f32_16x16x64_bf16 v[62:65], v[16:19], v[216:223], v3
  buffer_load_dwordx4 v[96:99], v2, s[8:11], s24 offen offset:0 sc1
  s_cbranch_vccnz cA_sc2_r3
cA_sc2_c3:
  v_smfmac_f32_16x16x64_bf16 v[36:39], v[20:23], a[24:31], v3
  v_smfmac_f32_16x16x64_bf16 v[40:43], v[20:23], a[80:87], v3
  s_waitcnt vmcnt(3)
  v_max3_u32 v66, v24, v27, v28
  v_smfmac_f32_16x16x64_bf16 v[44:47], v[20:23], a[136:143], v3
  v_max3_u32 v66, v66, v31, v32
  v_smfmac_f32_16x16x64_bf16 v[48:51], v[20:23], a[192:199], v3
  buffer_load_dwordx4 v[100:103], v2, s[8:11], s24 offen offset:1024 sc1
  v_max_u32 v66, v66, v35
  v_smfmac_f32_16x16x64_bf16 v[52:55], v[20:23], a[248:255], v3
  v_cmp_eq_u32 vcc, -1, v66
  v_smfmac_f32_16x16x64_bf16 v[56:59], v[20:23], v[168:175], v3
  v_smfmac_f32_16x16x64_bf16 v[62:65], v[20:23], v[224:231], v3
  s_cbranch_vccnz cA_sc2_r4
cA_sc2_c4:
  v_smfmac_f32_16x16x64_bf16 v[62:65], v[24:27], v[232:239], v3
  buffer_load_dwordx4 v[104:107], v2, s[8:11], s26 offen offset:0 sc1
  v_smfmac_f32_16x16x64_bf16 v[62:65], v[32:35], v[240:247], v3
  v_smfmac_f32_16x16x64_bf16 v[62:65], v[28:31], v[248:255], v3
  v_smfmac_f32_16x16x64_bf16 v[52:55], v[24:27], v[120:127], v3
  v_smfmac_f32_16x16x64_bf16 v[52:55], v[32:35], v[128:135], v3
  buffer_load_dwordx4 v[108:111], v2, s[8:11], s26 offen offset:1024 sc1
  v_smfmac_f32_16x16x64_bf16 v[52:55], v[28:31], v[136:143], v3
  v_cvt_pk_bf16_f32 v62, v62, v63
  v_smfmac_f32_16x16x64_bf16 v[56:59], v[24:27], v[176:183], v3
  v_cvt_pk_bf16_f32 v63, v64, v65
  v_smfmac_f32_16x16x64_bf16 v[56:59], v[32:35], v[184:191], v3
  v_mfma_f32_16x16x32_bf16 v[8:11], v[60:63], v[4:7], 0
  v_cvt_pk_bf16_f32 v55, v54, v55
  v_smfmac_f32_16x16x64_bf16 v[56:59], v[28:31], v[192:199], v3
  v_cvt_pk_bf16_f32 v54, v52, v53
  v_smfmac_f32_16x16x64_bf16 v[36:39], v[24:27], a[32:39], v3
  s_nop 1
  v_cvt_pk_bf16_f32 v76, v8, v9
  v_smfmac_f32_16x16x64_bf16 v[36:39], v[32:35], a[40:47], v3
  v_cvt_pk_bf16_f32 v77, v10, v11
  v_smfmac_f32_16x16x64_bf16 v[36:39], v[28:31], a[48:55], v3
  v_cvt_pk_bf16_f32 v56, v56, v57
  v_smfmac_f32_16x16x64_bf16 v[40:43], v[24:27], a[88:95], v3
  v_cvt_pk_bf16_f32 v57, v58, v59
  v_smfmac_f32_16x16x64_bf16 v[40:43], v[32:35], a[96:103], v3
  v_mfma_f32_16x16x32_bf16 v[12:15], v[54:57], v[4:7], 0
  v_cvt_pk_bf16_f32 v39, v38, v39
  v_smfmac_f32_16x16x64_bf16 v[40:43], v[28:31], a[104:111], v3
  v_cvt_pk_bf16_f32 v38, v36, v37
  v_smfmac_f32_16x16x64_bf16 v[44:47], v[24:27], a[144:151], v3
  s_nop 1
  v_cvt_pk_bf16_f32 v78, v12, v13
  v_smfmac_f32_16x16x64_bf16 v[44:47], v[32:35], a[152:159], v3
  v_cvt_pk_bf16_f32 v79, v14, v15
  v_smfmac_f32_16x16x64_bf16 v[44:47], v[28:31], a[160:167], v3
  v_cvt_pk_bf16_f32 v40, v40, v41
  v_smfmac_f32_16x16x64_bf16 v[48:51], v[24:27], a[200:207], v3
  v_cvt_pk_bf16_f32 v41, v42, v43
  v_smfmac_f32_16x16x64_bf16 v[48:51], v[32:35], a[208:215], v3
  v_smfmac_f32_16x16x64_bf16 v[48:51], v[28:31], a[216:223], v3
  s_waitcnt vmcnt(4)
  v_cvt_pk_bf16_f32 v47, v46, v47
  v_smfmac_f32_16x16x64_bf16 v[68:71], v[76:79], v[80:87], v3
  v_cvt_pk_bf16_f32 v46, v44, v45
  v_mfma_f32_16x16x32_bf16 v[8:11], v[38:41], v[4:7], 0
  s_nop 1
  v_cvt_pk_bf16_f32 v48, v48, v49
  v_cvt_pk_bf16_f32 v49, v50, v51
  s_nop 1
  v_mfma_f32_16x16x32_bf16 v[12:15], v[46:49], v[4:7], 0
  v_smfmac_f32_16x16x64_bf16 v[72:75], v[76:79], v[88:95], v3
  v_cvt_pk_bf16_f32 v20, v8, v9
  v_mfma_f32_16x16x32_bf16 v[52:55], v[30:33], v[76:79], 0
  s_waitcnt vmcnt(0)
  v_cvt_pk_bf16_f32 v21, v10, v11
  v_cvt_pk_bf16_f32 v22, v12, v13
  v_cvt_pk_bf16_f32 v23, v14, v15
  s_nop 1
  v_mfma_f32_16x16x32_bf16 v[52:55], v[16:19], v[20:23], v[52:55]
  v_smfmac_f32_16x16x64_bf16 v[68:71], v[20:23], v[96:103], v3
  v_smfmac_f32_16x16x64_bf16 v[72:75], v[20:23], v[104:111], v3
  s_nop 1
  ds_write_b128 v113, v[52:55]
  s_nop 1
  v_permlane32_swap_b32 v68, v70
  v_permlane32_swap_b32 v69, v71
  v_add_f32 v56, v68, v70
  v_add_f32 v58, v69, v71
  v_permlane32_swap_b32 v72, v74
  v_permlane32_swap_b32 v73, v75
  v_add_f32 v57, v72, v74
  v_add_f32 v59, v73, v75
  ds_write_b128 v2, v[56:59] offset:2048
  v_cmp_u_f32 vcc, v57, v59
  v_mov_b32 v68, 0
  v_mov_b32 v69, 0
  v_mov_b32 v70, 0
  v_mov_b32 v71, 0
  s_cbranch_vccnz cA_sc2_retry
cA_sc2_cont:
  s_add_u32 s24, s24, 28672
  s_add_u32 s26, s26, 28672
  buffer_load_dwordx4 v[80:83], v117, s[8:11], s24 offen offset:0 sc1
  buffer_load_dwordx4 v[84:87], v117, s[8:11], s24 offen offset:1024 sc1
  v_mov_b32 v72, 0
  v_mov_b32 v73, 0
  v_mfma_f32_32x32x16_bf16 v[36:51], v[68:71], v[68:71], 0
  s_waitcnt lgkmcnt(0)
  s_barrier
  v_mfma_f32_32x32x16_bf16 v[52:67], v[68:71], v[68:71], 0
  s_buffer_load_dword s70, s[8:11], s35
  s_add_u32 s22, s24, 114688
  s_buffer_load_dword s71, s[8:11], s22
  s_mul_i32 s22, s18, 7168
  s_add_u32 s22, s22, 88024064
  s_buffer_load_dword s72, s[8:11], s22
  s_add_u32 s35, s35, 458752
  v_mov_b32 v74, 0
  v_mov_b32 v75, 0
  s_mov_b32 s19, s18
  s_add_u32 s18, s18, 1
  s_mov_b32 s22, s20
  s_mov_b32 s20, s21
  s_mov_b32 s21, s22
  s_add_u32 s23, s20, 4096
  s_cmp_lt_u32 s19, 63
  s_cbranch_scc1 cA_sc2_loop
  s_branch cA_done
cA_sc2_r0:
  s_add_u32 s31, s31, 1
  buffer_load_dwordx4 v[8:11], v2, s[8:11], s20 offen offset:0 sc1
  s_waitcnt vmcnt(0)
  v_cmp_eq_u32 vcc, -1, v8
  v_mov_b32 v36, 0
  v_mov_b32 v37, 0
  v_mov_b32 v38, 0
  v_mov_b32 v39, 0
  v_mov_b32 v40, 0
  v_mov_b32 v41, 0
  v_mov_b32 v42, 0
  v_mov_b32 v43, 0
  v_mov_b32 v44, 0
  v_mov_b32 v45, 0
  v_mov_b32 v46, 0
  v_mov_b32 v47, 0
  v_mov_b32 v48, 0
  v_mov_b32 v49, 0
  v_mov_b32 v50, 0
  v_mov_b32 v51, 0
  s_nop 1
  s_cbranch_vccz cA_sc2_go
  s_add_u32 s30, s30, 1
  s_cmp_lt_u32 s30, 400000
  s_cbranch_scc1 cA_sc2_r0
  s_branch cA_abort
cA_sc2_r1:
  s_add_u32 s31, s31, 1
  buffer_load_dwordx4 v[12:15], v2, s[8:11], s20 offen offset:1024 sc1
  s_waitcnt vmcnt(0)
  v_cmp_eq_u32 vcc, -1, v12
  s_nop 4
  s_cbranch_vccz cA_sc2_c1
  s_add_u32 s30, s30, 1
  s_cmp_lt_u32 s30, 400000
  s_cbranch_scc1 cA_sc2_r1
  s_branch cA_abort
cA_sc2_r2:
  s_add_u32 s31, s31, 1
  buffer_load_dwordx4 v[16:19], v2, s[8:11], s20 offen offset:2048 sc1
  s_waitcnt vmcnt(0)
  v_cmp_eq_u32 vcc, -1, v16
  s_nop 4
  s_cbranch_vccz cA_sc2_c2
  s_add_u32 s30, s30, 1
  s_cmp_lt_u32 s30, 400000
  s_cbranch_scc1 cA_sc2_r2
  s_branch cA_abort
cA_sc2_r3:
  s_add_u32 s31, s31, 1
  buffer_load_dwordx4 v[20:23], v2, s[8:11], s20 offen offset:3072 sc1
  s_waitcnt vmcnt(0)
  v_cmp_eq_u32 vcc, -1, v20
  s_nop 4
  s_cbranch_vccz cA_sc2_c3
  s_add_u32 s30, s30, 1
  s_cmp_lt_u32 s30, 400000
  s_cbranch_scc1 cA_sc2_r3
  s_branch cA_abort
cA_sc2_r4:
  s_add_u32 s31, s31, 1
  buffer_load_dwordx4 v[24:27], v2, s[8:11], s23 offen offset:0 sc1
  buffer_load_dwordx4 v[32:35], v2, s[8:11], s23 offen offset:1024 sc1
  buffer_load_dwordx4 v[28:31], v2, s[8:11], s23 offen offset:2048 sc1
  s_waitcnt vmcnt(0)
  v_max3_u32 v66, v24, v27, v28
  v_max3_u32 v66, v66, v31, v32
  v_max_u32 v66, v66, v35
  v_cmp_eq_u32 vcc, -1, v66
  s_nop 4
  s_cbranch_vccz cA_sc2_c4
  s_add_u32 s30, s30, 1
  s_cmp_lt_u32 s30, 400000
  s_cbranch_scc1 cA_sc2_r4
  s_branch cA_abort
cA_sc2_retry:
  s_cmp_lg_u32 s62, 0
  s_cbranch_scc1 cA_sc2_cont
  s_waitcnt vmcnt(0) lgkmcnt(0)
cA_sc2_rv:
  buffer_load_dwordx4 v[8:11], v2, s[8:11], s20 offen offset:0 sc1
  buffer_load_dwordx4 v[12:15], v2, s[8:11], s20 offen offset:1024 sc1
  buffer_load_dwordx4 v[16:19], v2, s[8:11], s20 offen offset:2048 sc1
  buffer_load_dwordx4 v[20:23], v2, s[8:11], s20 offen offset:3072 sc1
  buffer_load_dwordx4 v[24:27], v2, s[8:11], s23 offen offset:0 sc1
  buffer_load_dwordx4 v[32:35], v2, s[8:11], s23 offen offset:1024 sc1
  buffer_load_dwordx4 v[28:31], v2, s[8:11], s23 offen offset:2048 sc1
  s_waitcnt vmcnt(0)
  v_pk_max_u16 v66, v8, v9
  v_pk_max_u16 v66, v66, v10
  v_pk_max_u16 v66, v66, v11
  v_pk_max_u16 v66, v66, v12
  v_pk_max_u16 v66, v66, v13
  v_pk_max_u16 v66, v66, v14
  v_pk_max_u16 v66, v66, v15
  v_pk_max_u16 v66, v66, v16
  v_pk_max_u16 v66, v66, v17
  v_pk_max_u16 v66, v66, v18
  v_pk_max_u16 v66, v66, v19
  v_pk_max_u16 v66, v66, v20
  v_pk_max_u16 v66, v66, v21
  v_pk_max_u16 v66, v66, v22
  v_pk_max_u16 v66, v66, v23
  v_pk_max_u16 v66, v66, v24
  v_pk_max_u16 v66, v66, v25
  v_pk_max_u16 v66, v66, v26
  v_pk_max_u16 v66, v66, v27
  v_pk_max_u16 v66, v66, v28
  v_pk_max_u16 v66, v66, v29
  v_pk_max_u16 v66, v66, v30
  v_pk_max_u16 v66, v66, v31
  v_pk_max_u16 v66, v66, v32
  v_pk_max_u16 v66, v66, v33
  v_pk_max_u16 v66, v66, v34
  v_pk_max_u16 v66, v66, v35
  v_lshlrev_b32 v67, 16, v66
  v_max_u32 v66, v66, v67
  v_cmp_le_u32 vcc, 0xffff0000, v66
  s_cbranch_vccz cA_sc2_rk
  s_add_u32 s30, s30, 1
  s_cmp_lt_u32 s30, 400000
  s_cbranch_scc1 cA_sc2_rv
  s_branch cA_abort
cA_sc2_rk:
  s_mov_b32 s62, 1
  v_mov_b32 v36, 0
  v_mov_b32 v37, 0
  v_mov_b32 v38, 0
  v_mov_b32 v39, 0
  v_mov_b32 v40, 0
  v_mov_b32 v41, 0
  v_mov_b32 v42, 0
  v_mov_b32 v43, 0
  v_mov_b32 v44, 0
  v_mov_b32 v45, 0
  v_mov_b32 v46, 0
  v_mov_b32 v47, 0
  v_mov_b32 v48, 0
  v_mov_b32 v49, 0
  v_mov_b32 v50, 0
  v_mov_b32 v51, 0
  v_mov_b32 v62, 0
  v_mov_b32 v63, 0
  v_mov_b32 v64, 0
  v_mov_b32 v65, 0
  v_mov_b32 v68, 0
  v_mov_b32 v69, 0
  v_mov_b32 v70, 0
  v_mov_b32 v71, 0
  v_mov_b32 v72, 0
  v_mov_b32 v73, 0
  v_mov_b32 v74, 0
  v_mov_b32 v75, 0
  v_mov_b32 v52, 0
  v_mov_b32 v53, 0
  v_mov_b32 v54, 0
  v_mov_b32 v55, 0
  v_mov_b32 v56, 0
  v_mov_b32 v57, 0
  v_mov_b32 v58, 0
  v_mov_b32 v59, 0
  s_add_u32 s31, s31, 0x100
  s_nop 0
  s_branch cA_sc2_go
.p2align 6
cA_sc3_loop:
  s_mov_b32 s30, 0
  s_mov_b32 s62, 0
  s_setprio 3
  s_barrier
  buffer_load_dwordx4 v[8:11], v2, s[8:11], s20 offen offset:0 sc1
  s_setprio 2
  buffer_load_dwordx4 v[12:15], v2, s[8:11], s20 offen offset:1024 sc1
  s_setprio 1
  buffer_load_dwordx4 v[16:19], v2, s[8:11], s20 offen offset:2048 sc1
  s_setprio 0
  buffer_load_dwordx4 v[20:23], v2, s[8:11], s20 offen offset:3072 sc1
cA_sc3_go:
  s_waitcnt vmcnt(3)
  v_smfmac_f32_16x16x64_bf16 v[36:39], v[8:11], a[0:7], v3
  buffer_load_dwordx4 v[24:27], v2, s[8:11], s23 offen offset:0 sc1
  v_cmp_eq_u32 vcc, -1, v8
  v_smfmac_f32_16x16x64_bf16 v[40:43], v[8:11], a[56:63], v3
  v_smfmac_f32_16x16x64_bf16 v[44:47], v[8:11], a[112:119], v3
  buffer_load_dwordx4 v[28:31], v2, s[8:11], s23 offen offset:1024 sc1
  s_cbranch_vccnz cA_sc3_r0
  v_smfmac_f32_16x16x64_bf16 v[48:51], v[8:11], a[168:175], v3
  v_smfmac_f32_16x16x64_bf16 v[52:55], v[8:11], a[224:231], v3
  s_waitcnt vmcnt(4)
  v_cmp_eq_u32 vcc, -1, v12
  v_smfmac_f32_16x16x64_bf16 v[56:59], v[8:11], v[144:151], v3
  buffer_load_dwordx4 v[32:35], v2, s[8:11], s23 offen offset:2048 sc1
  v_smfmac_f32_16x16x64_bf16 v[62:65], v[8:11], v[200:207], v3
  s_cbranch_vccnz cA_sc3_r1
cA_sc3_c1:
  v_smfmac_f32_16x16x64_bf16 v[36:39], v[12:15], a[8:15], v3
  v_smfmac_f32_16x16x64_bf16 v[40:43], v[12:15], a[64:71], v3
  v_smfmac_f32_16x16x64_bf16 v[44:47], v[12:15], a[120:127], v3
  v_smfmac_f32_16x16x64_bf16 v[48:51], v[12:15], a[176:183], v3
  v_smfmac_f32_16x16x64_bf16 v[52:55], v[12:15], a[232:239], v3
  s_waitcnt vmcnt(4)
  v_cmp_eq_u32 vcc, -1, v16
  v_smfmac_f32_16x16x64_bf16 v[56:59], v[12:15], v[152:159], v3
  buffer_load_dwordx4 v[88:91], v117, s[8:11], s26 offen offset:0 sc1
  v_smfmac_f32_16x16x64_bf16 v[62:65], v[12:15], v[208:215], v3
  s_cbranch_vccnz cA_sc3_r2
cA_sc3_c2:
  v_smfmac_f32_16x16x64_bf16 v[36:39], v[16:19], a[16:23], v3
  v_smfmac_f32_16x16x64_bf16 v[40:43], v[16:19], a[72:79], v3
  v_smfmac_f32_16x16x64_bf16 v[44:47], v[16:19], a[128:135], v3
  buffer_load_dwordx4 v[92:95], v117, s[8:11], s26 offen offset:1024 sc1
  v_smfmac_f32_16x16x64_bf16 v[48:51], v[16:19], a[184:191], v3
  v_smfmac_f32_16x16x64_bf16 v[52:55], v[16:19], a[240:247], v3
  s_waitcnt vmcnt(5)
  v_cmp_eq_u32 vcc, -1, v20
  v_smfmac_f32_16x16x64_bf16 v[56:59], v[16:19], v[160:167], v3
  v_smfmac_f32_16x16x64_bf16 v[62:65], v[16:19], v[216:223], v3
  buffer_load_dwordx4 v[96:99], v2, s[8:11], s24 offen offset:0 sc1
  s_cbranch_vccnz cA_sc3_r3
cA_sc3_c3:
  v_smfmac_f32_16x16x64_bf16 v[36:39], v[20:23], a[24:31], v3
  v_smfmac_f32_16x16x64_bf16 v[40:43], v[20:23], a[80:87], v3
  s_waitcnt vmcnt(3)
  v_max3_u32 v66, v24, v27, v28
  v_smfmac_f32_16x16x64_bf16 v[44:47], v[20:23], a[136:143], v3
  v_max3_u32 v66, v66, v31, v32
  v_smfmac_f32_16x16x64_bf16 v[48:51], v[20:23], a[192:199], v3
  buffer_load_dwordx4 v[100:103], v2, s[8:11], s24 offen offset:1024 sc1
  v_max_u32 v66, v66, v35
  v_smfmac_f32_16x16x64_bf16 v[52:55], v[20:23], a[248:255], v3
  v_cmp_eq_u32 vcc, -1, v66
  v_smfmac_f32_16x16x64_bf16 v[56:59], v[20:23], v[168:175], v3
  v_smfmac_f32_16x16x64_bf16 v[62:65], v[20:23], v[224:231], v3
  s_cbranch_vccnz cA_sc3_r4
cA_sc3_c4:
  v_smfmac_f32_16x16x64_bf16 v[62:65], v[24:27], v[232:239], v3
  buffer_load_dwordx4 v[104:107], v2, s[8:11], s26 offen offset:0 sc1
  v_smfmac_f32_16x16x64_bf16 v[62:65], v[28:31], v[240:247], v3
  v_smfmac_f32_16x16x64_bf16 v[62:65], v[32:35], v[248:255], v3
  v_smfmac_f32_16x16x64_bf16 v[52:55], v[24:27], v[120:127], v3
  v_smfmac_f32_16x16x64_bf16 v[52:55], v[28:31], v[128:135], v3
  buffer_load_dwordx4 v[108:111], v2, s[8:11], s26 offen offset:1024 sc1
  v_smfmac_f32_16x16x64_bf16 v[52:55], v[32:35], v[136:143], v3
  v_cvt_pk_bf16_f32 v62, v62, v63
  v_smfmac_f32_16x16x64_bf16 v[56:59], v[24:27], v[176:183], v3
  v_cvt_pk_bf16_f32 v63, v64, v65
  v_smfmac_f32_16x16x64_bf16 v[56:59], v[28:31], v[184:191], v3
  v_mfma_f32_16x16x32_bf16 v[8:11], v[60:63], v[4:7], 0
  v_cvt_pk_bf16_f32 v55, v54, v55
  v_smfmac_f32_16x16x64_bf16 v[56:59], v[32:35], v[192:199], v3
  v_cvt_pk_bf16_f32 v54, v52, v53
  v_smfmac_f32_16x16x64_bf16 v[36:39], v[24:27], a[32:39], v3
  s_nop 1
  v_cvt_pk_bf16_f32 v78, v8, v9
  v_smfmac_f32_16x16x64_bf16 v[36:39], v[28:31], a[40:47], v3
  v_cvt_pk_bf16_f32 v79, v10, v11
  v_smfmac_f32_16x16x64_bf16 v[36:39], v[32:35], a[48:55], v3
  v_cvt_pk_bf16_f32 v56, v56, v57
  v_smfmac_f32_16x16x64_bf16 v[40:43], v[24:27], a[88:95], v3
  v_cvt_pk_bf16_f32 v57, v58, v59
  v_smfmac_f32_16x16x64_bf16 v[40:43], v[28:31], a[96:103], v3
  v_mfma_f32_16x16x32_bf16 v[12:15], v[54:57], v[4:7], 0
  v_cvt_pk_bf16_f32 v39, v38, v39
  v_smfmac_f32_16x16x64_bf16 v[40:43], v[32:35], a[104:111], v3
  v_cvt_pk_bf16_f32 v38, v36, v37
  v_smfmac_f32_16x16x64_bf16 v[44:47], v[24:27], a[144:151], v3
  s_nop 1
  v_cvt_pk_bf16_f32 v76, v12, v13
  v_smfmac_f32_16x16x64_bf16 v[44:47], v[28:31], a[152:159], v3
  v_cvt_pk_bf16_f32 v77, v14, v15
  v_smfmac_f32_16x16x64_bf16 v[44:47], v[32:35], a[160:167], v3
  v_cvt_pk_bf16_f32 v40, v40, v41
  v_smfmac_f32_16x16x64_bf16 v[48:51], v[24:27], a[200:207], v3
  v_cvt_pk_bf16_f32 v41, v42, v43
  v_smfmac_f32_16x16x64_bf16 v[48:51], v[28:31], a[208:215], v3
  v_smfmac_f32_16x16x64_bf16 v[48:51], v[32:35], a[216:223], v3
  s_waitcnt vmcnt(4)
  v_cvt_pk_bf16_f32 v47, v46, v47
  v_smfmac_f32_16x16x64_bf16 v[68:71], v[76:79], v[80:87], v3
  v_cvt_pk_bf16_f32 v46, v44, v45
  v_mfma_f32_16x16x32_bf16 v[8:11], v[38:41], v[4:7], 0
  s_nop 1
  v_cvt_pk_bf16_f32 v48, v48, v49
  v_cvt_pk_bf16_f32 v49, v50, v51
  s_nop 1
  v_mfma_f32_16x16x32_bf16 v[12:15], v[46:49], v[4:7], 0
  v_smfmac_f32_16x16x64_bf16 v[72:75], v[76:79], v[88:95], v3
  v_cvt_pk_bf16_f32 v16, v8, v9
  v_mfma_f32_16x16x32_bf16 v[52:55], v[30:33], v[76:79], 0
  s_waitcnt vmcnt(0)
  v_cvt_pk_bf16_f32 v17, v10, v11
  v_cvt_pk_bf16_f32 v18, v12, v13
  v_cvt_pk_bf16_f32 v19, v14, v15
  s_nop 1
  v_mfma_f32_16x16x32_bf16 v[52:55], v[20:23], v[16:19], v[52:55]
  v_smfmac_f32_16x16x64_bf16 v[68:71], v[16:19], v[96:103], v3
  v_smfmac_f32_16x16x64_bf16 v[72:75], v[16:19], v[104:111], v3
  s_nop 1
  ds_write_b128 v113, v[52:55]
  s_nop 1
  v_permlane32_swap_b32 v68, v70
  v_permlane32_swap_b32 v69, v71
  v_add_f32 v56, v68, v70
  v_add_f32 v58, v69, v71
  v_permlane32_swap_b32 v72, v74
  v_permlane32_swap_b32 v73, v75
  v_add_f32 v57, v72, v74
  v_add_f32 v59, v73, v75
  ds_write_b128 v2, v[56:59] offset:3072
  v_cmp_u_f32 vcc, v57, v59
  v_mov_b32 v68, 0
  v_mov_b32 v69, 0
  v_mov_b32 v70, 0
  v_mov_b32 v71, 0
  s_cbranch_vccnz cA_sc3_retry
cA_sc3_cont:
  s_add_u32 s24, s24, 28672
  s_add_u32 s26, s26, 28672
  buffer_load_dwordx4 v[80:83], v117, s[8:11], s24 offen offset:0 sc1
  buffer_load_dwordx4 v[84:87], v117, s[8:11], s24 offen offset:1024 sc1
  v_mov_b32 v72, 0
  v_mov_b32 v73, 0
  v_mfma_f32_16x16x32_bf16 v[62:65], v[68:71], v[68:71], 0
  s_waitcnt lgkmcnt(0)
  s_barrier
  v_mov_b32 v52, 0
  v_mov_b32 v53, 0
  v_mov_b32 v54, 0
  v_mov_b32 v55, 0
  v_mov_b32 v56, 0
  v_mov_b32 v57, 0
  v_mov_b32 v58, 0
  v_mov_b32 v59, 0
  v_mfma_f32_32x32x16_bf16 v[36:51], v[68:71], v[68:71], 0
  v_mov_b32 v74, 0
  v_mov_b32 v75, 0
  s_mov_b32 s19, s18
  s_add_u32 s18, s18, 1
  s_mov_b32 s22, s20
  s_mov_b32 s20, s21
  s_mov_b32 s21, s22
  s_add_u32 s23, s20, 4096
  s_cmp_lt_u32 s19, 63
  s_nop 2
  s_cbranch_scc1 cA_sc3_loop
  s_branch cA_done
cA_sc3_r0:
  s_add_u32 s31, s31, 1
  buffer_load_dwordx4 v[8:11], v2, s[8:11], s20 offen offset:0 sc1
  s_waitcnt vmcnt(0)
  v_cmp_eq_u32 vcc, -1, v8
  v_mov_b32 v36, 0
  v_mov_b32 v37, 0
  v_mov_b32 v38, 0
  v_mov_b32 v39, 0
  v_mov_b32 v40, 0
  v_mov_b32 v41, 0
  v_mov_b32 v42, 0
  v_mov_b32 v43, 0
  v_mov_b32 v44, 0
  v_mov_b32 v45, 0
  v_mov_b32 v46, 0
  v_mov_b32 v47, 0
  v_mov_b32 v48, 0
  v_mov_b32 v49, 0
  v_mov_b32 v50, 0
  v_mov_b32 v51, 0
  s_nop 1
  s_cbranch_vccz cA_sc3_go
  s_add_u32 s30, s30, 1
  s_cmp_lt_u32 s30, 400000
  s_cbranch_scc1 cA_sc3_r0
  s_branch cA_abort
cA_sc3_r1:
  s_add_u32 s31, s31, 1
  buffer_load_dwordx4 v[12:15], v2, s[8:11], s20 offen offset:1024 sc1
  s_waitcnt vmcnt(0)
  v_cmp_eq_u32 vcc, -1, v12
  s_nop 4
  s_cbranch_vccz cA_sc3_c1
  s_add_u32 s30, s30, 1
  s_cmp_lt_u32 s30, 400000
  s_cbranch_scc1 cA_sc3_r1
  s_branch cA_abort
cA_sc3_r2:
  s_add_u32 s31, s31, 1
  buffer_load_dwordx4 v[16:19], v2, s[8:11], s20 offen offset:2048 sc1
  s_waitcnt vmcnt(0)
  v_cmp_eq_u32 vcc, -1, v16
  s_nop 4
  s_cbranch_vccz cA_sc3_c2
  s_add_u32 s30, s30, 1
  s_cmp_lt_u32 s30, 400000
  s_cbranch_scc1 cA_sc3_r2
  s_branch cA_abort
cA_sc3_r3:
  s_add_u32 s31, s31, 1
  buffer_load_dwordx4 v[20:23], v2, s[8:11], s20 offen offset:3072 sc1
  s_waitcnt vmcnt(0)
  v_cmp_eq_u32 vcc, -1, v20
  s_nop 4
  s_cbranch_vccz cA_sc3_c3
  s_add_u32 s30, s30, 1
  s_cmp_lt_u32 s30, 400000
  s_cbranch_scc1 cA_sc3_r3
  s_branch cA_abort
cA_sc3_r4:
  s_add_u32 s31, s31, 1
  buffer_load_dwordx4 v[24:27], v2, s[8:11], s23 offen offset:0 sc1
  buffer_load_dwordx4 v[28:31], v2, s[8:11], s23 offen offset:1024 sc1
  buffer_load_dwordx4 v[32:35], v2, s[8:11], s23 offen offset:2048 sc1
  s_waitcnt vmcnt(0)
  v_max3_u32 v66, v24, v27, v28
  v_max3_u32 v66, v66, v31, v32
  v_max_u32 v66, v66, v35
  v_cmp_eq_u32 vcc, -1, v66
  s_nop 4
  s_cbranch_vccz cA_sc3_c4
  s_add_u32 s30, s30, 1
  s_cmp_lt_u32 s30, 400000
  s_cbranch_scc1 cA_sc3_r4
  s_branch cA_abort
cA_sc3_retry:
  s_cmp_lg_u32 s62, 0
  s_cbranch_scc1 cA_sc3_cont
  s_waitcnt vmcnt(0) lgkmcnt(0)
cA_sc3_rv:
  buffer_load_dwordx4 v[8:11], v2, s[8:11], s20 offen offset:0 sc1
  buffer_load_dwordx4 v[12:15], v2, s[8:11], s20 offen offset:1024 sc1
  buffer_load_dwordx4 v[16:19], v2, s[8:11], s20 offen offset:2048 sc1
  buffer_load_dwordx4 v[20:23], v2, s[8:11], s20 offen offset:3072 sc1
  buffer_load_dwordx4 v[24:27], v2, s[8:11], s23 offen offset:0 sc1
  buffer_load_dwordx4 v[28:31], v2, s[8:11], s23 offen offset:1024 sc1
  buffer_load_dwordx4 v[32:35], v2, s[8:11], s23 offen offset:2048 sc1
  s_waitcnt vmcnt(0)
  v_pk_max_u16 v66, v8, v9
  v_pk_max_u16 v66, v66, v10
  v_pk_max_u16 v66, v66, v11
  v_pk_max_u16 v66, v66, v12
  v_pk_max_u16 v66, v66, v13
  v_pk_max_u16 v66, v66, v14
  v_pk_max_u16 v66, v66, v15
  v_pk_max_u16 v66, v66, v16
  v_pk_max_u16 v66, v66, v17
  v_pk_max_u16 v66, v66, v18
  v_pk_max_u16 v66, v66, v19
  v_pk_max_u16 v66, v66, v20
  v_pk_max_u16 v66, v66, v21
  v_pk_max_u16 v66, v66, v22
  v_pk_max_u16 v66, v66, v23
  v_pk_max_u16 v66, v66, v24
  v_pk_max_u16 v66, v66, v25
  v_pk_max_u16 v66, v66, v26
  v_pk_max_u16 v66, v66, v27
  v_pk_max_u16 v66, v66, v28
  v_pk_max_u16 v66, v66, v29
  v_pk_max_u16 v66, v66, v30
  v_pk_max_u16 v66, v66, v31
  v_pk_max_u16 v66, v66, v32
  v_pk_max_u16 v66, v66, v33
  v_pk_max_u16 v66, v66, v34
  v_pk_max_u16 v66, v66, v35
  v_lshlrev_b32 v67, 16, v66
  v_max_u32 v66, v66, v67
  v_cmp_le_u32 vcc, 0xffff0000, v66
  s_cbranch_vccz cA_sc3_rk
  s_add_u32 s30, s30, 1
  s_cmp_lt_u32 s30, 400000
  s_cbranch_scc1 cA_sc3_rv
  s_branch cA_abort
cA_sc3_rk:
  s_mov_b32 s62, 1
  v_mov_b32 v36, 0
  v_mov_b32 v37, 0
  v_mov_b32 v38, 0
  v_mov_b32 v39, 0
  v_mov_b32 v40, 0
  v_mov_b32 v41, 0
  v_mov_b32 v42, 0
  v_mov_b32 v43, 0
  v_mov_b32 v44, 0
  v_mov_b32 v45, 0
  v_mov_b32 v46, 0
  v_mov_b32 v47, 0
  v_mov_b32 v48, 0
  v_mov_b32 v49, 0
  v_mov_b32 v50, 0
  v_mov_b32 v51, 0
  v_mov_b32 v62, 0
  v_mov_b32 v63, 0
  v_mov_b32 v64, 0
  v_mov_b32 v65, 0
  v_mov_b32 v68, 0
  v_mov_b32 v69, 0
  v_mov_b32 v70, 0
  v_mov_b32 v71, 0
  v_mov_b32 v72, 0
  v_mov_b32 v73, 0
  v_mov_b32 v74, 0
  v_mov_b32 v75, 0
  v_mov_b32 v52, 0
  v_mov_b32 v53, 0
  v_mov_b32 v54, 0
  v_mov_b32 v55, 0
  v_mov_b32 v56, 0
  v_mov_b32 v57, 0
  v_mov_b32 v58, 0
  v_mov_b32 v59, 0
  s_add_u32 s31, s31, 0x100
  s_nop 0
  s_branch cA_sc3_go
.p2align 6
cA_va0_loop:
  s_mov_b32 s30, 0
  s_barrier
  buffer_load_dwordx4 v[24:27], v2, s[8:11], s23 offen offset:0 sc1
  buffer_load_dwordx4 v[28:31], v2, s[8:11], s23 offen offset:1024 sc1
  s_barrier
  s_cmp_lt_u32 s19, 58
  s_cbranch_scc1 cA_va0_m1
  buffer_store_dword v160, v1, s[8:11], s38 offen sc1
  s_branch cA_va0_m2
cA_va0_m1:
  buffer_store_dword v160, v1, s[8:11], s38 offen nt
cA_va0_m2:
  s_add_u32 s22, s25, 0
  buffer_load_dwordx4 v[80:83], v6, s[8:11], s22 offen offset:0 sc1
  buffer_load_dwordx4 v[84:87], v6, s[8:11], s22 offen offset:1792 sc1
  s_add_u32 s22, s25, 3584
  buffer_load_dwordx4 v[88:91], v6, s[8:11], s22 offen offset:0 sc1
  buffer_load_dwordx4 v[92:95], v6, s[8:11], s22 offen offset:1792 sc1
  s_add_u32 s22, s25, 7168
  buffer_load_dwordx4 v[96:99], v6, s[8:11], s22 offen offset:0 sc1
  s_mul_i32 s38, s18, 7168
  s_add_u32 s38, s38, 88002560
  s_waitcnt vmcnt(6)
  ds_write_b128 v2, v[24:27] offset:12288
  ds_write_b128 v2, v[28:31] offset:13312
  v_smfmac_f32_16x16x64_bf16 v[36:39], v[24:27], a[32:39], v3
  buffer_load_dwordx4 v[100:103], v6, s[8:11], s22 offen offset:1792 sc1
  v_smfmac_f32_16x16x64_bf16 v[40:43], v[24:27], a[88:95], v3
  s_add_u32 s22, s25, 10752
  buffer_load_dwordx4 v[104:107], v6, s[8:11], s22 offen offset:0 sc1
  v_smfmac_f32_16x16x64_bf16 v[44:47], v[24:27], a[144:151], v3
  buffer_load_dwordx4 v[108:111], v6, s[8:11], s22 offen offset:1792 sc1
  v_smfmac_f32_16x16x64_bf16 v[48:51], v[24:27], a[200:207], v3
  s_add_u32 s22, s25, 14336
  buffer_load_dwordx4 v[112:115], v6, s[8:11], s22 offen offset:0 sc1
  v_smfmac_f32_16x16x64_bf16 v[52:55], v[24:27], v[176:183], v3
  s_waitcnt lgkmcnt(0)
  s_barrier
  ds_read_b128 v[8:11], v2 offset:8192
  ds_read_b128 v[12:15], v2 offset:9216
  ds_read_b128 v[16:19], v2 offset:10240
  ds_read_b128 v[20:23], v2 offset:11264
  ds_read_b128 v[32:35], v2 offset:14336
  buffer_load_dwordx4 v[116:119], v6, s[8:11], s22 offen offset:1792 sc1
  v_smfmac_f32_16x16x64_bf16 v[56:59], v[24:27], v[232:239], v3
  s_add_u32 s22, s25, 17920
  buffer_load_dwordx4 v[120:123], v6, s[8:11], s22 offen offset:0 sc1
  v_smfmac_f32_16x16x64_bf16 v[36:39], v[28:31], a[40:47], v3
  buffer_load_dwordx4 v[124:127], v6, s[8:11], s22 offen offset:1792 sc1
  v_smfmac_f32_16x16x64_bf16 v[40:43], v[28:31], a[96:103], v3
  s_add_u32 s22, s25, 21504
  buffer_load_dwordx4 v[128:131], v6, s[8:11], s22 offen offset:0 sc1
  v_smfmac_f32_16x16x64_bf16 v[44:47], v[28:31], a[152:159], v3
  buffer_load_dwordx4 v[132:135], v6, s[8:11], s22 offen offset:1792 sc1
  v_smfmac_f32_16x16x64_bf16 v[48:51], v[28:31], a[208:215], v3
  s_add_u32 s22, s25, 25088
  buffer_load_dwordx4 v[136:139], v6, s[8:11], s22 offen offset:0 sc1
  v_smfmac_f32_16x16x64_bf16 v[52:55], v[28:31], v[184:191], v3
  ds_read_b128 v[64:67], v0 offset:0
  ds_read_b128 v[68:71], v0 offset:1024
  buffer_load_dwordx4 v[140:143], v6, s[8:11], s22 offen offset:1792 sc1
  v_smfmac_f32_16x16x64_bf16 v[56:59], v[28:31], v[240:247], v3
  s_waitcnt lgkmcnt(6)
  ds_read_b128 v[72:75], v0 offset:2048
  ds_read_b128 v[76:79], v0 offset:3072
  v_smfmac_f32_16x16x64_bf16 v[36:39], v[8:11], a[0:7], v3
  s_waitcnt lgkmcnt(7)
  v_smfmac_f32_16x16x64_bf16 v[36:39], v[12:15], a[8:15], v3
  s_waitcnt lgkmcnt(6)
  v_smfmac_f32_16x16x64_bf16 v[36:39], v[16:19], a[16:23], v3
  s_waitcnt lgkmcnt(2)
  v_smfmac_f32_16x16x64_bf16 v[60:63], v[8:11], v[64:71], v3
  s_waitcnt lgkmcnt(5)
  ds_read_b128 v[144:147], v0 offset:4096
  ds_read_b128 v[148:151], v0 offset:5120
  v_smfmac_f32_16x16x64_bf16 v[36:39], v[20:23], a[24:31], v3
  s_waitcnt lgkmcnt(6)
  v_smfmac_f32_16x16x64_bf16 v[36:39], v[32:35], a[48:55], v3
  v_smfmac_f32_16x16x64_bf16 v[40:43], v[8:11], a[56:63], v3
  s_waitcnt lgkmcnt(2)
  v_smfmac_f32_16x16x64_bf16 v[60:63], v[12:15], v[72:79], v3
  ds_read_b128 v[64:67], v0 offset:6144
  ds_read_b128 v[68:71], v0 offset:7168
  v_smfmac_f32_16x16x64_bf16 v[40:43], v[12:15], a[64:71], v3
  v_permlane32_swap_b32 v36, v38
  v_smfmac_f32_16x16x64_bf16 v[40:43], v[16:19], a[72:79], v3
  v_permlane32_swap_b32 v37, v39
  v_smfmac_f32_16x16x64_bf16 v[40:43], v[20:23], a[80:87], v3
  s_waitcnt lgkmcnt(2)
  v_add_f32 v36, v36, v38
  v_smfmac_f32_16x16x64_bf16 v[60:63], v[16:19], v[144:151], v3
  ds_read_b128 v[72:75], v0 offset:8192
  ds_read_b128 v[76:79], v0 offset:9216
  v_add_f32 v37, v37, v39
  v_smfmac_f32_16x16x64_bf16 v[40:43], v[32:35], a[104:111], v3
  v_cmp_u_f32 vcc, v36, v37
  v_smfmac_f32_16x16x64_bf16 v[44:47], v[8:11], a[112:119], v3
  v_cvt_pk_bf16_f32 v38, v36, v37
  v_smfmac_f32_16x16x64_bf16 v[44:47], v[12:15], a[120:127], v3
  ds_write_b32 v152, v38
  s_waitcnt lgkmcnt(3)
  s_cbranch_vccnz cA_va0_slow
  v_permlane32_swap_b32 v40, v42
  v_smfmac_f32_16x16x64_bf16 v[60:63], v[20:23], v[64:71], v3
  ds_read_b128 v[144:147], v0 offset:10240
  ds_read_b128 v[148:151], v0 offset:11264
  v_permlane32_swap_b32 v41, v43
  v_smfmac_f32_16x16x64_bf16 v[44:47], v[16:19], a[128:135], v3
  buffer_store_dword v162, v1, s[8:11], s21 offen
  v_add_f32 v40, v40, v42
  v_smfmac_f32_16x16x64_bf16 v[44:47], v[20:23], a[136:143], v3
  v_add_f32 v41, v41, v43
  v_smfmac_f32_16x16x64_bf16 v[44:47], v[32:35], a[160:167], v3
  s_waitcnt lgkmcnt(3)
  v_cvt_pk_bf16_f32 v42, v40, v41
  v_smfmac_f32_16x16x64_bf16 v[60:63], v[24:27], v[72:79], v3
  ds_write_b32 v153, v42
  ds_read_b128 v[64:67], v0 offset:12288
  ds_read_b128 v[68:71], v0 offset:13312
  v_smfmac_f32_16x16x64_bf16 v[48:51], v[8:11], a[168:175], v3
  s_nop 0
  v_permlane32_swap_b32 v44, v46
  v_smfmac_f32_16x16x64_bf16 v[48:51], v[12:15], a[176:183], v3
  v_permlane32_swap_b32 v45, v47
  v_smfmac_f32_16x16x64_bf16 v[48:51], v[16:19], a[184:191], v3
  s_waitcnt lgkmcnt(3)
  v_add_f32 v44, v44, v46
  v_smfmac_f32_16x16x64_bf16 v[60:63], v[28:31], v[144:151], v3
  v_add_f32 v45, v45, v47
  v_smfmac_f32_16x16x64_bf16 v[48:51], v[20:23], a[192:199], v3
  v_cvt_pk_bf16_f32 v46, v44, v45
  v_smfmac_f32_16x16x64_bf16 v[48:51], v[32:35], a[216:223], v3
  ds_write_b32 v154, v46
  v_smfmac_f32_16x16x64_bf16 v[52:55], v[8:11], a[224:231], v3
  s_waitcnt lgkmcnt(1)
  v_smfmac_f32_16x16x64_bf16 v[60:63], v[32:35], v[64:71], v3
  v_smfmac_f32_16x16x64_bf16 v[52:55], v[12:15], a[232:239], v3
  v_permlane32_swap_b32 v48, v50
  v_smfmac_f32_16x16x64_bf16 v[52:55], v[16:19], a[240:247], v3
  v_permlane32_swap_b32 v49, v51
  v_smfmac_f32_16x16x64_bf16 v[52:55], v[20:23], a[248:255], v3
  v_add_f32 v48, v48, v50
  v_smfmac_f32_16x16x64_bf16 v[52:55], v[32:35], v[192:199], v3
  v_add_f32 v49, v49, v51
  v_smfmac_f32_16x16x64_bf16 v[56:59], v[8:11], v[200:207], v3
  v_cvt_pk_bf16_f32 v50, v48, v49
  v_smfmac_f32_16x16x64_bf16 v[56:59], v[12:15], v[208:215], v3
  ds_write_b32 v155, v50
  v_permlane32_swap_b32 v60, v62
  v_smfmac_f32_16x16x64_bf16 v[56:59], v[16:19], v[216:223], v3
  v_permlane32_swap_b32 v61, v63
  v_smfmac_f32_16x16x64_bf16 v[56:59], v[20:23], v[224:231], v3
  v_add_f32 v60, v60, v62
  v_smfmac_f32_16x16x64_bf16 v[56:59], v[32:35], v[248:255], v3
  v_add_f32 v61, v61, v63
  v_cvt_pk_bf16_f32 v62, v60, v61
  ds_write_b32 v158, v62
  v_permlane32_swap_b32 v52, v54
  v_permlane32_swap_b32 v53, v55
  v_add_f32 v52, v52, v54
  v_add_f32 v53, v53, v55
  v_cvt_pk_bf16_f32 v54, v52, v53
  ds_write_b32 v156, v54
  v_permlane32_swap_b32 v56, v58
  v_permlane32_swap_b32 v57, v59
  v_add_f32 v56, v56, v58
  v_add_f32 v57, v57, v59
  v_cvt_pk_bf16_f32 v58, v56, v57
  ds_write_b32 v157, v58
cA_va0_t2d:
  s_add_u32 s22, s20, 9216
  s_add_u32 s34, s20, 13312
  s_add_u32 s36, s20, 7168
  s_mov_b32 s37, 0
  v_mov_b32 v48, 0
  v_mov_b32 v49, 0
  v_mov_b32 v50, 0
  v_mov_b32 v51, 0
  v_mov_b32 v163, s18
  s_waitcnt lgkmcnt(0)
  s_setprio 3
  buffer_load_dword v52, v4, s[8:11], 0 offen sc1
  buffer_load_dword v53, v4, s[8:11], 0 offen sc1
  buffer_load_dword v54, v4, s[8:11], 0 offen sc1
  buffer_load_dword v55, v4, s[8:11], 0 offen sc1
cA_va0_fw_l:
  s_waitcnt vmcnt(3)
  v_cmp_gt_u32 vcc, s18, v52
  s_cbranch_vccz cA_va0_fw_d
  buffer_load_dword v52, v4, s[8:11], 0 offen sc1
  s_waitcnt vmcnt(3)
  v_cmp_gt_u32 vcc, s18, v53
  s_cbranch_vccz cA_va0_fw_d
  buffer_load_dword v53, v4, s[8:11], 0 offen sc1
  s_waitcnt vmcnt(3)
  v_cmp_gt_u32 vcc, s18, v54
  s_cbranch_vccz cA_va0_fw_d
  buffer_load_dword v54, v4, s[8:11], 0 offen sc1
  s_waitcnt vmcnt(3)
  v_cmp_gt_u32 vcc, s18, v55
  s_cbranch_vccz cA_va0_fw_d
  buffer_load_dword v55, v4, s[8:11], 0 offen sc1
  s_add_u32 s30, s30, 1
  s_cmp_lt_u32 s30, 400000
  s_cbranch_scc1 cA_va0_fw_l
  s_branch cA_abort
cA_va0_fw_d:
  buffer_load_dwordx4 v[8:11], v2, s[8:11], s22 offen offset:0 sc1
  buffer_load_dwordx4 v[12:15], v2, s[8:11], s22 offen offset:1024 sc1
  buffer_load_dwordx4 v[16:19], v2, s[8:11], s22 offen offset:2048 sc1
  buffer_load_dwordx4 v[20:23], v2, s[8:11], s22 offen offset:3072 sc1
  buffer_load_dwordx4 v[24:27], v2, s[8:11], s34 offen offset:0 sc1
  buffer_load_dwordx4 v[28:31], v2, s[8:11], s34 offen offset:1024 sc1
  buffer_load_dwordx4 v[32:35], v2, s[8:11], s34 offen offset:2048 sc1
  buffer_load_dwordx4 v[36:39], v2, s[8:11], s34 offen offset:3072 sc1
  buffer_load_dwordx4 v[40:43], v2, s[8:11], s36 offen offset:0 sc1
  buffer_load_dwordx4 v[44:47], v2, s[8:11], s36 offen offset:1024 sc1
  s_barrier
  ds_read_b128 v[64:67], v2 offset:0
  ds_read_b128 v[68:71], v2 offset:1024
  ds_read_b128 v[72:75], v2 offset:2048
  ds_read_b128 v[76:79], v2 offset:3072
cA_va0_lp:
  s_waitcnt vmcnt(9)
  v_smfmac_f32_16x16x64_bf16 v[48:51], v[8:11], v[80:87], v3
  s_waitcnt vmcnt(8)
  v_smfmac_f32_16x16x64_bf16 v[48:51], v[12:15], v[88:95], v3
  s_waitcnt vmcnt(7)
  v_smfmac_f32_16x16x64_bf16 v[48:51], v[16:19], v[96:103], v3
  s_waitcnt vmcnt(6)
  v_smfmac_f32_16x16x64_bf16 v[48:51], v[20:23], v[104:111], v3
  s_waitcnt vmcnt(5)
  v_smfmac_f32_16x16x64_bf16 v[48:51], v[24:27], v[112:119], v3
  s_waitcnt vmcnt(4)
  v_smfmac_f32_16x16x64_bf16 v[48:51], v[28:31], v[120:127], v3
  s_waitcnt vmcnt(3)
  v_smfmac_f32_16x16x64_bf16 v[48:51], v[32:35], v[128:135], v3
  s_waitcnt vmcnt(2)
  v_smfmac_f32_16x16x64_bf16 v[48:51], v[36:39], v[136:143], v3
  s_waitcnt vmcnt(1) lgkmcnt(0)
  v_smfmac_f32_16x16x64_bf16 v[48:51], v[40:43], v[64:71], v3
  s_waitcnt vmcnt(0)
  v_smfmac_f32_16x16x64_bf16 v[48:51], v[44:47], v[72:79], v3
  s_nop 7
  v_permlane32_swap_b32 v48, v50
  v_permlane32_swap_b32 v49, v51
  v_add_f32 v48, v48, v50
  v_add_f32 v49, v49, v51
  v_cvt_pk_bf16_f32 v160, v48, v49
  v_cmp_u_f32 vcc, v48, v49
  s_nop 0
  v_mov_b32_dpp v161, v160 quad_perm:[1,0,3,2] row_mask:0xf bank_mask:0xf
  v_perm_b32 v160, v161, v160, v5
  v_min_u32 v160, -2, v160
  s_cbranch_vccnz cA_va0_rp
cA_va0_cont:
  buffer_store_dword v160, v1, s[8:11], s21 offen
  s_setprio 0
  s_cmp_lg_u32 s19, 62
  s_cbranch_scc1 cA_va0_nl
  buffer_store_dword v160, v1, s[8:11], s38 offen sc1
  s_waitcnt vmcnt(0)
  buffer_wbl2 sc1
  s_branch cA_done
cA_va0_nl:
  s_add_u32 s25, s25, 458752
  v_mov_b32 v36, 0
  v_mov_b32 v37, 0
  v_mov_b32 v38, 0
  v_mov_b32 v39, 0
  v_mov_b32 v40, 0
  v_mov_b32 v41, 0
  v_mov_b32 v42, 0
  v_mov_b32 v43, 0
  v_mov_b32 v44, 0
  v_mov_b32 v45, 0
  v_mov_b32 v46, 0
  v_mov_b32 v47, 0
  v_mov_b32 v48, 0
  v_mov_b32 v49, 0
  v_mov_b32 v50, 0
  v_mov_b32 v51, 0
  v_mov_b32 v52, 0
  v_mov_b32 v53, 0
  v_mov_b32 v54, 0
  v_mov_b32 v55, 0
  v_mov_b32 v56, 0
  v_mov_b32 v57, 0
  v_mov_b32 v58, 0
  v_mov_b32 v59, 0
  v_mov_b32 v60, 0
  v_mov_b32 v61, 0
  v_mov_b32 v62, 0
  v_mov_b32 v63, 0
  s_mov_b32 s19, s18
  s_add_u32 s18, s18, 1
  s_mov_b32 s22, s20
  s_mov_b32 s20, s21
  s_mov_b32 s21, s22
  s_add_u32 s23, s20, 4096
  s_branch cA_va0_loop
cA_va0_slow:
  s_waitcnt lgkmcnt(0)
cA_va0_sl1:
  s_add_u32 s31, s31, 0x1000000
  buffer_load_dwordx4 v[8:11], v2, s[8:11], s20 offen offset:0 sc1
  buffer_load_dwordx4 v[12:15], v2, s[8:11], s20 offen offset:1024 sc1
  buffer_load_dwordx4 v[16:19], v2, s[8:11], s20 offen offset:2048 sc1
  buffer_load_dwordx4 v[20:23], v2, s[8:11], s20 offen offset:3072 sc1
  buffer_load_dwordx4 v[24:27], v2, s[8:11], s23 offen offset:0 sc1
  buffer_load_dwordx4 v[28:31], v2, s[8:11], s23 offen offset:1024 sc1
  buffer_load_dwordx4 v[32:35], v2, s[8:11], s23 offen offset:2048 sc1
  s_waitcnt vmcnt(0)
  v_max3_u32 v36, v8, v9, v10
  v_max3_u32 v36, v36, v11, v12
  v_max3_u32 v36, v36, v13, v14
  v_max3_u32 v36, v36, v15, v16
  v_max3_u32 v36, v36, v17, v18
  v_max3_u32 v36, v36, v19, v20
  v_max3_u32 v36, v36, v21, v22
  v_max3_u32 v36, v36, v23, v24
  v_max3_u32 v36, v36, v25, v26
  v_max3_u32 v36, v36, v27, v28
  v_max3_u32 v36, v36, v29, v30
  v_max3_u32 v36, v36, v31, v32
  v_max3_u32 v36, v36, v33, v34
  v_max_u32 v36, v36, v35
  v_cmp_eq_u32 vcc, -1, v36
  s_cbranch_vccz cA_va0_sl2
  s_add_u32 s30, s30, 1
  s_cmp_lt_u32 s30, 400000
  s_cbranch_scc1 cA_va0_sl1
  s_branch cA_abort
cA_va0_sl2:
  v_mov_b32 v36, 0
  v_mov_b32 v37, 0
  v_mov_b32 v38, 0
  v_mov_b32 v39, 0
  v_mov_b32 v40, 0
  v_mov_b32 v41, 0
  v_mov_b32 v42, 0
  v_mov_b32 v43, 0
  v_mov_b32 v44, 0
  v_mov_b32 v45, 0
  v_mov_b32 v46, 0
  v_mov_b32 v47, 0
  v_mov_b32 v48, 0
  v_mov_b32 v49, 0
  v_mov_b32 v50, 0
  v_mov_b32 v51, 0
  v_mov_b32 v52, 0
  v_mov_b32 v53, 0
  v_mov_b32 v54, 0
  v_mov_b32 v55, 0
  v_mov_b32 v56, 0
  v_mov_b32 v57, 0
  v_mov_b32 v58, 0
  v_mov_b32 v59, 0
  v_mov_b32 v60, 0
  v_mov_b32 v61, 0
  v_mov_b32 v62, 0
  v_mov_b32 v63, 0
  buffer_store_dword v162, v1, s[8:11], s21 offen
  ds_read_b128 v[64:67], v0 offset:0
  ds_read_b128 v[68:71], v0 offset:1024
  v_smfmac_f32_16x16x64_bf16 v[36:39], v[8:11], a[0:7], v3
  v_smfmac_f32_16x16x64_bf16 v[40:43], v[8:11], a[56:63], v3
  v_smfmac_f32_16x16x64_bf16 v[44:47], v[8:11], a[112:119], v3
  v_smfmac_f32_16x16x64_bf16 v[48:51], v[8:11], a[168:175], v3
  v_smfmac_f32_16x16x64_bf16 v[52:55], v[8:11], a[224:231], v3
  v_smfmac_f32_16x16x64_bf16 v[56:59], v[8:11], v[200:207], v3
  s_waitcnt lgkmcnt(0)
  v_smfmac_f32_16x16x64_bf16 v[60:63], v[8:11], v[64:71], v3
  ds_read_b128 v[72:75], v0 offset:2048
  ds_read_b128 v[76:79], v0 offset:3072
  v_smfmac_f32_16x16x64_bf16 v[36:39], v[12:15], a[8:15], v3
  v_smfmac_f32_16x16x64_bf16 v[40:43], v[12:15], a[64:71], v3
  v_smfmac_f32_16x16x64_bf16 v[44:47], v[12:15], a[120:127], v3
  v_smfmac_f32_16x16x64_bf16 v[48:51], v[12:15], a[176:183], v3
  v_smfmac_f32_16x16x64_bf16 v[52:55], v[12:15], a[232:239], v3
  v_smfmac_f32_16x16x64_bf16 v[56:59], v[12:15], v[208:215], v3
  s_waitcnt lgkmcnt(0)
  v_smfmac_f32_16x16x64_bf16 v[60:63], v[12:15], v[72:79], v3
  ds_read_b128 v[144:147], v0 offset:4096
  ds_read_b128 v[148:151], v0 offset:5120
  v_smfmac_f32_16x16x64_bf16 v[36:39], v[16:19], a[16:23], v3
  v_smfmac_f32_16x16x64_bf16 v[40:43], v[16:19], a[72:79], v3
  v_smfmac_f32_16x16x64_bf16 v[44:47], v[16:19], a[128:135], v3
  v_smfmac_f32_16x16x64_bf16 v[48:51], v[16:19], a[184:191], v3
  v_smfmac_f32_16x16x64_bf16 v[52:55], v[16:19], a[240:247], v3
  v_smfmac_f32_16x16x64_bf16 v[56:59], v[16:19], v[216:223], v3
  s_waitcnt lgkmcnt(0)
  v_smfmac_f32_16x16x64_bf16 v[60:63], v[16:19], v[144:151], v3
  ds_read_b128 v[64:67], v0 offset:6144
  ds_read_b128 v[68:71], v0 offset:7168
  v_smfmac_f32_16x16x64_bf16 v[36:39], v[20:23], a[24:31], v3
  v_smfmac_f32_16x16x64_bf16 v[40:43], v[20:23], a[80:87], v3
  v_smfmac_f32_16x16x64_bf16 v[44:47], v[20:23], a[136:143], v3
  v_smfmac_f32_16x16x64_bf16 v[48:51], v[20:23], a[192:199], v3
  v_smfmac_f32_16x16x64_bf16 v[52:55], v[20:23], a[248:255], v3
  v_smfmac_f32_16x16x64_bf16 v[56:59], v[20:23], v[224:231], v3
  s_waitcnt lgkmcnt(0)
  v_smfmac_f32_16x16x64_bf16 v[60:63], v[20:23], v[64:71], v3
  ds_read_b128 v[72:75], v0 offset:8192
  ds_read_b128 v[76:79], v0 offset:9216
  v_smfmac_f32_16x16x64_bf16 v[36:39], v[24:27], a[32:39], v3
  v_smfmac_f32_16x16x64_bf16 v[40:43], v[24:27], a[88:95], v3
  v_smfmac_f32_16x16x64_bf16 v[44:47], v[24:27], a[144:151], v3
  v_smfmac_f32_16x16x64_bf16 v[48:51], v[24:27], a[200:207], v3
  v_smfmac_f32_16x16x64_bf16 v[52:55], v[24:27], v[176:183], v3
  v_smfmac_f32_16x16x64_bf16 v[56:59], v[24:27], v[232:239], v3
  s_waitcnt lgkmcnt(0)
  v_smfmac_f32_16x16x64_bf16 v[60:63], v[24:27], v[72:79], v3
  ds_read_b128 v[144:147], v0 offset:10240
  ds_read_b128 v[148:151], v0 offset:11264
  v_smfmac_f32_16x16x64_bf16 v[36:39], v[28:31], a[40:47], v3
  v_smfmac_f32_16x16x64_bf16 v[40:43], v[28:31], a[96:103], v3
  v_smfmac_f32_16x16x64_bf16 v[44:47], v[28:31], a[152:159], v3
  v_smfmac_f32_16x16x64_bf16 v[48:51], v[28:31], a[208:215], v3
  v_smfmac_f32_16x16x64_bf16 v[52:55], v[28:31], v[184:191], v3
  v_smfmac_f32_16x16x64_bf16 v[56:59], v[28:31], v[240:247], v3
  s_waitcnt lgkmcnt(0)
  v_smfmac_f32_16x16x64_bf16 v[60:63], v[28:31], v[144:151], v3
  ds_read_b128 v[64:67], v0 offset:12288
  ds_read_b128 v[68:71], v0 offset:13312
  v_smfmac_f32_16x16x64_bf16 v[36:39], v[32:35], a[48:55], v3
  v_smfmac_f32_16x16x64_bf16 v[40:43], v[32:35], a[104:111], v3
  v_smfmac_f32_16x16x64_bf16 v[44:47], v[32:35], a[160:167], v3
  v_smfmac_f32_16x16x64_bf16 v[48:51], v[32:35], a[216:223], v3
  v_smfmac_f32_16x16x64_bf16 v[52:55], v[32:35], v[192:199], v3
  v_smfmac_f32_16x16x64_bf16 v[56:59], v[32:35], v[248:255], v3
  s_waitcnt lgkmcnt(0)
  v_smfmac_f32_16x16x64_bf16 v[60:63], v[32:35], v[64:71], v3
  v_permlane32_swap_b32 v36, v38
  v_permlane32_swap_b32 v37, v39
  v_add_f32 v36, v36, v38
  v_add_f32 v37, v37, v39
  v_cvt_pk_bf16_f32 v38, v36, v37
  ds_write_b32 v152, v38
  v_permlane32_swap_b32 v40, v42
  v_permlane32_swap_b32 v41, v43
  v_add_f32 v40, v40, v42
  v_add_f32 v41, v41, v43
  v_cvt_pk_bf16_f32 v42, v40, v41
  ds_write_b32 v153, v42
  v_permlane32_swap_b32 v44, v46
  v_permlane32_swap_b32 v45, v47
  v_add_f32 v44, v44, v46
  v_add_f32 v45, v45, v47
  v_cvt_pk_bf16_f32 v46, v44, v45
  ds_write_b32 v154, v46
  v_permlane32_swap_b32 v48, v50
  v_permlane32_swap_b32 v49, v51
  v_add_f32 v48, v48, v50
  v_add_f32 v49, v49, v51
  v_cvt_pk_bf16_f32 v50, v48, v49
  ds_write_b32 v155, v50
  v_permlane32_swap_b32 v52, v54
  v_permlane32_swap_b32 v53, v55
  v_add_f32 v52, v52, v54
  v_add_f32 v53, v53, v55
  v_cvt_pk_bf16_f32 v54, v52, v53
  ds_write_b32 v156, v54
  v_permlane32_swap_b32 v56, v58
  v_permlane32_swap_b32 v57, v59
  v_add_f32 v56, v56, v58
  v_add_f32 v57, v57, v59
  v_cvt_pk_bf16_f32 v58, v56, v57
  ds_write_b32 v157, v58
  v_permlane32_swap_b32 v60, v62
  v_permlane32_swap_b32 v61, v63
  v_add_f32 v60, v60, v62
  v_add_f32 v61, v61, v63
  v_cvt_pk_bf16_f32 v62, v60, v61
  ds_write_b32 v158, v62
  s_branch cA_va0_t2d
cA_va0_rp:
  s_cmp_lg_u32 s37, 0
  s_cbranch_scc1 cA_va0_cont
cA_va0_rv:
  s_add_u32 s31, s31, 0x10000
  buffer_load_dwordx4 v[8:11], v2, s[8:11], s22 offen offset:0 sc1
  buffer_load_dwordx4 v[12:15], v2, s[8:11], s22 offen offset:1024 sc1
  buffer_load_dwordx4 v[16:19], v2, s[8:11], s22 offen offset:2048 sc1
  buffer_load_dwordx4 v[20:23], v2, s[8:11], s22 offen offset:3072 sc1
  buffer_load_dwordx4 v[24:27], v2, s[8:11], s34 offen offset:0 sc1
  buffer_load_dwordx4 v[28:31], v2, s[8:11], s34 offen offset:1024 sc1
  buffer_load_dwordx4 v[32:35], v2, s[8:11], s34 offen offset:2048 sc1
  buffer_load_dwordx4 v[36:39], v2, s[8:11], s34 offen offset:3072 sc1
  buffer_load_dwordx4 v[40:43], v2, s[8:11], s36 offen offset:0 sc1
  buffer_load_dwordx4 v[44:47], v2, s[8:11], s36 offen offset:1024 sc1
  s_waitcnt vmcnt(0)
  v_max3_u32 v52, v8, v9, v10
  v_max3_u32 v52, v52, v11, v12
  v_max3_u32 v52, v52, v13, v14
  v_max3_u32 v52, v52, v15, v16
  v_max3_u32 v52, v52, v17, v18
  v_max3_u32 v52, v52, v19, v20
  v_max3_u32 v52, v52, v21, v22
  v_max3_u32 v52, v52, v23, v24
  v_max3_u32 v52, v52, v25, v26
  v_max3_u32 v52, v52, v27, v28
  v_max3_u32 v52, v52, v29, v30
  v_max3_u32 v52, v52, v31, v32
  v_max3_u32 v52, v52, v33, v34
  v_max3_u32 v52, v52, v35, v36
  v_max3_u32 v52, v52, v37, v38
  v_max3_u32 v52, v52, v39, v40
  v_max3_u32 v52, v52, v41, v42
  v_max3_u32 v52, v52, v43, v44
  v_max3_u32 v52, v52, v45, v46
  v_max_u32 v52, v52, v47
  v_cmp_eq_u32 vcc, -1, v52
  s_mov_b32 s37, 1
  v_mov_b32 v48, 0
  v_mov_b32 v49, 0
  v_mov_b32 v50, 0
  v_mov_b32 v51, 0
  s_nop 1
  s_cbranch_vccz cA_va0_lp
  s_add_u32 s30, s30, 1
  s_cmp_lt_u32 s30, 400000
  s_cbranch_scc1 cA_va0_rv
  s_branch cA_abort
.p2align 6
cA_va1_loop:
  s_mov_b32 s30, 0
  s_barrier
  buffer_load_dwordx4 v[28:31], v2, s[8:11], s23 offen offset:1024 sc1
  buffer_load_dwordx4 v[32:35], v2, s[8:11], s23 offen offset:2048 sc1
  s_barrier
  s_cmp_lt_u32 s19, 58
  s_cbranch_scc1 cA_va1_m1
  buffer_store_dword v160, v1, s[8:11], s38 offen sc1
  s_branch cA_va1_m2
cA_va1_m1:
  buffer_store_dword v160, v1, s[8:11], s38 offen nt
cA_va1_m2:
  s_add_u32 s22, s25, 0
  buffer_load_dwordx4 v[80:83], v6, s[8:11], s22 offen offset:0 sc1
  buffer_load_dwordx4 v[84:87], v6, s[8:11], s22 offen offset:1792 sc1
  s_add_u32 s22, s25, 3584
  buffer_load_dwordx4 v[88:91], v6, s[8:11], s22 offen offset:0 sc1
  buffer_load_dwordx4 v[92:95], v6, s[8:11], s22 offen offset:1792 sc1
  s_add_u32 s22, s25, 7168
  buffer_load_dwordx4 v[96:99], v6, s[8:11], s22 offen offset:0 sc1
  s_mul_i32 s38, s18, 7168
  s_add_u32 s38, s38, 88002560
  s_waitcnt vmcnt(6)
  ds_write_b128 v2, v[32:35] offset:14336
  v_smfmac_f32_16x16x64_bf16 v[36:39], v[28:31], a[40:47], v3
  buffer_load_dwordx4 v[100:103], v6, s[8:11], s22 offen offset:1792 sc1
  v_smfmac_f32_16x16x64_bf16 v[40:43], v[28:31], a[96:103], v3
  s_add_u32 s22, s25, 10752
  buffer_load_dwordx4 v[104:107], v6, s[8:11], s22 offen offset:0 sc1
  v_smfmac_f32_16x16x64_bf16 v[44:47], v[28:31], a[152:159], v3
  buffer_load_dwordx4 v[108:111], v6, s[8:11], s22 offen offset:1792 sc1
  v_smfmac_f32_16x16x64_bf16 v[48:51], v[28:31], a[208:215], v3
  s_add_u32 s22, s25, 14336
  buffer_load_dwordx4 v[112:115], v6, s[8:11], s22 offen offset:0 sc1
  v_smfmac_f32_16x16x64_bf16 v[52:55], v[28:31], v[184:191], v3
  s_waitcnt lgkmcnt(0)
  s_barrier
  ds_read_b128 v[8:11], v2 offset:8192
  ds_read_b128 v[12:15], v2 offset:9216
  ds_read_b128 v[16:19], v2 offset:10240
  ds_read_b128 v[20:23], v2 offset:11264
  ds_read_b128 v[24:27], v2 offset:12288
  buffer_load_dwordx4 v[116:119], v6, s[8:11], s22 offen offset:1792 sc1
  v_smfmac_f32_16x16x64_bf16 v[56:59], v[28:31], v[240:247], v3
  s_add_u32 s22, s25, 17920
  buffer_load_dwordx4 v[120:123], v6, s[8:11], s22 offen offset:0 sc1
  v_smfmac_f32_16x16x64_bf16 v[36:39], v[32:35], a[48:55], v3
  buffer_load_dwordx4 v[124:127], v6, s[8:11], s22 offen offset:1792 sc1
  v_smfmac_f32_16x16x64_bf16 v[40:43], v[32:35], a[104:111], v3
  s_add_u32 s22, s25, 21504
  buffer_load_dwordx4 v[128:131], v6, s[8:11], s22 offen offset:0 sc1
  v_smfmac_f32_16x16x64_bf16 v[44:47], v[32:35], a[160:167], v3
  buffer_load_dwordx4 v[132:135], v6, s[8:11], s22 offen offset:1792 sc1
  v_smfmac_f32_16x16x64_bf16 v[48:51], v[32:35], a[216:223], v3
  s_add_u32 s22, s25, 25088
  buffer_load_dwordx4 v[136:139], v6, s[8:11], s22 offen offset:0 sc1
  v_smfmac_f32_16x16x64_bf16 v[52:55], v[32:35], v[192:199], v3
  ds_read_b128 v[64:67], v0 offset:0
  ds_read_b128 v[68:71], v0 offset:1024
  buffer_load_dwordx4 v[140:143], v6, s[8:11], s22 offen offset:1792 sc1
  v_smfmac_f32_16x16x64_bf16 v[56:59], v[32:35], v[248:255], v3
  s_waitcnt lgkmcnt(6)
  ds_read_b128 v[72:75], v0 offset:2048
  ds_read_b128 v[76:79], v0 offset:3072
  v_smfmac_f32_16x16x64_bf16 v[36:39], v[8:11], a[0:7], v3
  s_waitcnt lgkmcnt(7)
  v_smfmac_f32_16x16x64_bf16 v[36:39], v[12:15], a[8:15], v3
  s_waitcnt lgkmcnt(6)
  v_smfmac_f32_16x16x64_bf16 v[36:39], v[16:19], a[16:23], v3
  s_waitcnt lgkmcnt(2)
  v_smfmac_f32_16x16x64_bf16 v[60:63], v[8:11], v[64:71], v3
  s_waitcnt lgkmcnt(5)
  ds_read_b128 v[144:147], v0 offset:4096
  ds_read_b128 v[148:151], v0 offset:5120
  v_smfmac_f32_16x16x64_bf16 v[36:39], v[20:23], a[24:31], v3
  s_waitcnt lgkmcnt(6)
  v_smfmac_f32_16x16x64_bf16 v[36:39], v[24:27], a[32:39], v3
  v_smfmac_f32_16x16x64_bf16 v[40:43], v[8:11], a[56:63], v3
  s_waitcnt lgkmcnt(2)
  v_smfmac_f32_16x16x64_bf16 v[60:63], v[12:15], v[72:79], v3
  ds_read_b128 v[64:67], v0 offset:6144
  ds_read_b128 v[68:71], v0 offset:7168
  v_smfmac_f32_16x16x64_bf16 v[40:43], v[12:15], a[64:71], v3
  v_permlane32_swap_b32 v36, v38
  v_smfmac_f32_16x16x64_bf16 v[40:43], v[16:19], a[72:79], v3
  v_permlane32_swap_b32 v37, v39
  v_smfmac_f32_16x16x64_bf16 v[40:43], v[20:23], a[80:87], v3
  s_waitcnt lgkmcnt(2)
  v_add_f32 v36, v36, v38
  v_smfmac_f32_16x16x64_bf16 v[60:63], v[16:19], v[144:151], v3
  ds_read_b128 v[72:75], v0 offset:8192
  ds_read_b128 v[76:79], v0 offset:9216
  v_add_f32 v37, v37, v39
  v_smfmac_f32_16x16x64_bf16 v[40:43], v[24:27], a[88:95], v3
  v_cmp_u_f32 vcc, v36, v37
  v_smfmac_f32_16x16x64_bf16 v[44:47], v[8:11], a[112:119], v3
  v_cvt_pk_bf16_f32 v38, v36, v37
  v_smfmac_f32_16x16x64_bf16 v[44:47], v[12:15], a[120:127], v3
  ds_write_b32 v152, v38
  s_waitcnt lgkmcnt(3)
  s_cbranch_vccnz cA_va1_slow
  v_permlane32_swap_b32 v40, v42
  v_smfmac_f32_16x16x64_bf16 v[60:63], v[20:23], v[64:71], v3
  ds_read_b128 v[144:147], v0 offset:10240
  ds_read_b128 v[148:151], v0 offset:11264
  v_permlane32_swap_b32 v41, v43
  v_smfmac_f32_16x16x64_bf16 v[44:47], v[16:19], a[128:135], v3
  buffer_store_dword v162, v1, s[8:11], s21 offen
  v_add_f32 v40, v40, v42
  v_smfmac_f32_16x16x64_bf16 v[44:47], v[20:23], a[136:143], v3
  v_add_f32 v41, v41, v43
  v_smfmac_f32_16x16x64_bf16 v[44:47], v[24:27], a[144:151], v3
  s_waitcnt lgkmcnt(3)
  v_cvt_pk_bf16_f32 v42, v40, v41
  v_smfmac_f32_16x16x64_bf16 v[60:63], v[24:27], v[72:79], v3
  ds_write_b32 v153, v42
  ds_read_b128 v[64:67], v0 offset:12288
  ds_read_b128 v[68:71], v0 offset:13312
  v_smfmac_f32_16x16x64_bf16 v[48:51], v[8:11], a[168:175], v3
  s_nop 0
  v_permlane32_swap_b32 v44, v46
  v_smfmac_f32_16x16x64_bf16 v[48:51], v[12:15], a[176:183], v3
  v_permlane32_swap_b32 v45, v47
  v_smfmac_f32_16x16x64_bf16 v[48:51], v[16:19], a[184:191], v3
  s_waitcnt lgkmcnt(3)
  v_add_f32 v44, v44, v46
  v_smfmac_f32_16x16x64_bf16 v[60:63], v[28:31], v[144:151], v3
  v_add_f32 v45, v45, v47
  v_smfmac_f32_16x16x64_bf16 v[48:51], v[20:23], a[192:199], v3
  v_cvt_pk_bf16_f32 v46, v44, v45
  v_smfmac_f32_16x16x64_bf16 v[48:51], v[24:27], a[200:207], v3
  ds_write_b32 v154, v46
  v_smfmac_f32_16x16x64_bf16 v[52:55], v[8:11], a[224:231], v3
  s_waitcnt lgkmcnt(1)
  v_smfmac_f32_16x16x64_bf16 v[60:63], v[32:35], v[64:71], v3
  v_smfmac_f32_16x16x64_bf16 v[52:55], v[12:15], a[232:239], v3
  v_permlane32_swap_b32 v48, v50
  v_smfmac_f32_16x16x64_bf16 v[52:55], v[16:19], a[240:247], v3
  v_permlane32_swap_b32 v49, v51
  v_smfmac_f32_16x16x64_bf16 v[52:55], v[20:23], a[248:255], v3
  v_add_f32 v48, v48, v50
  v_smfmac_f32_16x16x64_bf16 v[52:55], v[24:27], v[176:183], v3
  v_add_f32 v49, v49, v51
  v_smfmac_f32_16x16x64_bf16 v[56:59], v[8:11], v[200:207], v3
  v_cvt_pk_bf16_f32 v50, v48, v49
  v_smfmac_f32_16x16x64_bf16 v[56:59], v[12:15], v[208:215], v3
  ds_write_b32 v155, v50
  v_permlane32_swap_b32 v60, v62
  v_smfmac_f32_16x16x64_bf16 v[56:59], v[16:19], v[216:223], v3
  v_permlane32_swap_b32 v61, v63
  v_smfmac_f32_16x16x64_bf16 v[56:59], v[20:23], v[224:231], v3
  v_add_f32 v60, v60, v62
  v_smfmac_f32_16x16x64_bf16 v[56:59], v[24:27], v[232:239], v3
  v_add_f32 v61, v61, v63
  v_cvt_pk_bf16_f32 v62, v60, v61
  ds_write_b32 v158, v62
  v_permlane32_swap_b32 v52, v54
  v_permlane32_swap_b32 v53, v55
  v_add_f32 v52, v52, v54
  v_add_f32 v53, v53, v55
  v_cvt_pk_bf16_f32 v54, v52, v53
  ds_write_b32 v156, v54
  v_permlane32_swap_b32 v56, v58
  v_permlane32_swap_b32 v57, v59
  v_add_f32 v56, v56, v58
  v_add_f32 v57, v57, v59
  v_cvt_pk_bf16_f32 v58, v56, v57
  ds_write_b32 v157, v58
cA_va1_t2d:
  s_add_u32 s22, s20, 9216
  s_add_u32 s34, s20, 13312
  s_add_u32 s36, s20, 7168
  s_mov_b32 s37, 0
  v_mov_b32 v48, 0
  v_mov_b32 v49, 0
  v_mov_b32 v50, 0
  v_mov_b32 v51, 0
  v_mov_b32 v163, s18
  s_waitcnt lgkmcnt(0)
  s_barrier
  buffer_load_dwordx4 v[8:11], v2, s[8:11], s22 offen offset:0 sc1
  buffer_load_dwordx4 v[12:15], v2, s[8:11], s22 offen offset:1024 sc1
  buffer_load_dwordx4 v[16:19], v2, s[8:11], s22 offen offset:2048 sc1
  buffer_load_dwordx4 v[20:23], v2, s[8:11], s22 offen offset:3072 sc1
  buffer_load_dwordx4 v[24:27], v2, s[8:11], s34 offen offset:0 sc1
  buffer_load_dwordx4 v[28:31], v2, s[8:11], s34 offen offset:1024 sc1
  buffer_load_dwordx4 v[32:35], v2, s[8:11], s34 offen offset:2048 sc1
  buffer_load_dwordx4 v[36:39], v2, s[8:11], s34 offen offset:3072 sc1
  buffer_load_dwordx4 v[40:43], v2, s[8:11], s36 offen offset:0 sc1
  buffer_load_dwordx4 v[44:47], v2, s[8:11], s36 offen offset:1024 sc1
  ds_read_b128 v[64:67], v2 offset:4096
  ds_read_b128 v[68:71], v2 offset:5120
  ds_read_b128 v[72:75], v2 offset:6144
  ds_read_b128 v[76:79], v2 offset:7168
cA_va1_lp:
  s_waitcnt vmcnt(9)
  v_smfmac_f32_16x16x64_bf16 v[48:51], v[8:11], v[80:87], v3
  s_waitcnt vmcnt(8)
  v_smfmac_f32_16x16x64_bf16 v[48:51], v[12:15], v[88:95], v3
  s_waitcnt vmcnt(7)
  v_smfmac_f32_16x16x64_bf16 v[48:51], v[16:19], v[96:103], v3
  v_max3_u32 v55, v8, v12, v16
  s_waitcnt vmcnt(6)
  v_smfmac_f32_16x16x64_bf16 v[48:51], v[20:23], v[104:111], v3
  v_max_u32 v55, v55, v20
  v_cmp_eq_u32 vcc, -1, v55
  s_waitcnt vmcnt(5)
  v_smfmac_f32_16x16x64_bf16 v[48:51], v[24:27], v[112:119], v3
  s_waitcnt vmcnt(4)
  v_smfmac_f32_16x16x64_bf16 v[48:51], v[28:31], v[120:127], v3
  s_cbranch_vccnz cA_va1_rv
  buffer_store_dword v163, v7, s[8:11], 0 offen
  s_waitcnt vmcnt(4)
  v_smfmac_f32_16x16x64_bf16 v[48:51], v[32:35], v[128:135], v3
  s_waitcnt vmcnt(3)
  v_smfmac_f32_16x16x64_bf16 v[48:51], v[36:39], v[136:143], v3
  s_waitcnt vmcnt(2) lgkmcnt(0)
  v_smfmac_f32_16x16x64_bf16 v[48:51], v[40:43], v[64:71], v3
  s_waitcnt vmcnt(1)
  v_smfmac_f32_16x16x64_bf16 v[48:51], v[44:47], v[72:79], v3
  s_nop 7
  v_permlane32_swap_b32 v48, v50
  v_permlane32_swap_b32 v49, v51
  v_add_f32 v48, v48, v50
  v_add_f32 v49, v49, v51
  v_cvt_pk_bf16_f32 v160, v48, v49
  v_cmp_u_f32 vcc, v48, v49
  s_nop 0
  v_mov_b32_dpp v161, v160 quad_perm:[1,0,3,2] row_mask:0xf bank_mask:0xf
  v_perm_b32 v160, v161, v160, v5
  v_min_u32 v160, -2, v160
  s_cbranch_vccnz cA_va1_rp
cA_va1_cont:
  buffer_store_dword v160, v1, s[8:11], s21 offen
  s_cmp_lg_u32 s19, 62
  s_cbranch_scc1 cA_va1_nl
  buffer_store_dword v160, v1, s[8:11], s38 offen sc1
  s_waitcnt vmcnt(0)
  buffer_wbl2 sc1
  s_branch cA_done
cA_va1_nl:
  s_add_u32 s25, s25, 458752
  v_mov_b32 v36, 0
  v_mov_b32 v37, 0
  v_mov_b32 v38, 0
  v_mov_b32 v39, 0
  v_mov_b32 v40, 0
  v_mov_b32 v41, 0
  v_mov_b32 v42, 0
  v_mov_b32 v43, 0
  v_mov_b32 v44, 0
  v_mov_b32 v45, 0
  v_mov_b32 v46, 0
  v_mov_b32 v47, 0
  v_mov_b32 v48, 0
  v_mov_b32 v49, 0
  v_mov_b32 v50, 0
  v_mov_b32 v51, 0
  v_mov_b32 v52, 0
  v_mov_b32 v53, 0
  v_mov_b32 v54, 0
  v_mov_b32 v55, 0
  v_mov_b32 v56, 0
  v_mov_b32 v57, 0
  v_mov_b32 v58, 0
  v_mov_b32 v59, 0
  v_mov_b32 v60, 0
  v_mov_b32 v61, 0
  v_mov_b32 v62, 0
  v_mov_b32 v63, 0
  s_mov_b32 s19, s18
  s_add_u32 s18, s18, 1
  s_mov_b32 s22, s20
  s_mov_b32 s20, s21
  s_mov_b32 s21, s22
  s_add_u32 s23, s20, 4096
  s_branch cA_va1_loop
cA_va1_slow:
  s_waitcnt lgkmcnt(0)
cA_va1_sl1:
  s_add_u32 s31, s31, 0x1000000
  buffer_load_dwordx4 v[8:11], v2, s[8:11], s20 offen offset:0 sc1
  buffer_load_dwordx4 v[12:15], v2, s[8:11], s20 offen offset:1024 sc1
  buffer_load_dwordx4 v[16:19], v2, s[8:11], s20 offen offset:2048 sc1
  buffer_load_dwordx4 v[20:23], v2, s[8:11], s20 offen offset:3072 sc1
  buffer_load_dwordx4 v[24:27], v2, s[8:11], s23 offen offset:0 sc1
  buffer_load_dwordx4 v[28:31], v2, s[8:11], s23 offen offset:1024 sc1
  buffer_load_dwordx4 v[32:35], v2, s[8:11], s23 offen offset:2048 sc1
  s_waitcnt vmcnt(0)
  v_max3_u32 v36, v8, v9, v10
  v_max3_u32 v36, v36, v11, v12
  v_max3_u32 v36, v36, v13, v14
  v_max3_u32 v36, v36, v15, v16
  v_max3_u32 v36, v36, v17, v18
  v_max3_u32 v36, v36, v19, v20
  v_max3_u32 v36, v36, v21, v22
  v_max3_u32 v36, v36, v23, v24
  v_max3_u32 v36, v36, v25, v26
  v_max3_u32 v36, v36, v27, v28
  v_max3_u32 v36, v36, v29, v30
  v_max3_u32 v36, v36, v31, v32
  v_max3_u32 v36, v36, v33, v34
  v_max_u32 v36, v36, v35
  v_cmp_eq_u32 vcc, -1, v36
  s_cbranch_vccz cA_va1_sl2
  s_add_u32 s30, s30, 1
  s_cmp_lt_u32 s30, 400000
  s_cbranch_scc1 cA_va1_sl1
  s_branch cA_abort
cA_va1_sl2:
  v_mov_b32 v36, 0
  v_mov_b32 v37, 0
  v_mov_b32 v38, 0
  v_mov_b32 v39, 0
  v_mov_b32 v40, 0
  v_mov_b32 v41, 0
  v_mov_b32 v42, 0
  v_mov_b32 v43, 0
  v_mov_b32 v44, 0
  v_mov_b32 v45, 0
  v_mov_b32 v46, 0
  v_mov_b32 v47, 0
  v_mov_b32 v48, 0
  v_mov_b32 v49, 0
  v_mov_b32 v50, 0
  v_mov_b32 v51, 0
  v_mov_b32 v52, 0
  v_mov_b32 v53, 0
  v_mov_b32 v54, 0
  v_mov_b32 v55, 0
  v_mov_b32 v56, 0
  v_mov_b32 v57, 0
  v_mov_b32 v58, 0
  v_mov_b32 v59, 0
  v_mov_b32 v60, 0
  v_mov_b32 v61, 0
  v_mov_b32 v62, 0
  v_mov_b32 v63, 0
  buffer_store_dword v162, v1, s[8:11], s21 offen
  ds_read_b128 v[64:67], v0 offset:0
  ds_read_b128 v[68:71], v0 offset:1024
  v_smfmac_f32_16x16x64_bf16 v[36:39], v[8:11], a[0:7], v3
  v_smfmac_f32_16x16x64_bf16 v[40:43], v[8:11], a[56:63], v3
  v_smfmac_f32_16x16x64_bf16 v[44:47], v[8:11], a[112:119], v3
  v_smfmac_f32_16x16x64_bf16 v[48:51], v[8:11], a[168:175], v3
  v_smfmac_f32_16x16x64_bf16 v[52:55], v[8:11], a[224:231], v3
  v_smfmac_f32_16x16x64_bf16 v[56:59], v[8:11], v[200:207], v3
  s_waitcnt lgkmcnt(0)
  v_smfmac_f32_16x16x64_bf16 v[60:63], v[8:11], v[64:71], v3
  ds_read_b128 v[72:75], v0 offset:2048
  ds_read_b128 v[76:79], v0 offset:3072
  v_smfmac_f32_16x16x64_bf16 v[36:39], v[12:15], a[8:15], v3
  v_smfmac_f32_16x16x64_bf16 v[40:43], v[12:15], a[64:71], v3
  v_smfmac_f32_16x16x64_bf16 v[44:47], v[12:15], a[120:127], v3
  v_smfmac_f32_16x16x64_bf16 v[48:51], v[12:15], a[176:183], v3
  v_smfmac_f32_16x16x64_bf16 v[52:55], v[12:15], a[232:239], v3
  v_smfmac_f32_16x16x64_bf16 v[56:59], v[12:15], v[208:215], v3
  s_waitcnt lgkmcnt(0)
  v_smfmac_f32_16x16x64_bf16 v[60:63], v[12:15], v[72:79], v3
  ds_read_b128 v[144:147], v0 offset:4096
  ds_read_b128 v[148:151], v0 offset:5120
  v_smfmac_f32_16x16x64_bf16 v[36:39], v[16:19], a[16:23], v3
  v_smfmac_f32_16x16x64_bf16 v[40:43], v[16:19], a[72:79], v3
  v_smfmac_f32_16x16x64_bf16 v[44:47], v[16:19], a[128:135], v3
  v_smfmac_f32_16x16x64_bf16 v[48:51], v[16:19], a[184:191], v3
  v_smfmac_f32_16x16x64_bf16 v[52:55], v[16:19], a[240:247], v3
  v_smfmac_f32_16x16x64_bf16 v[56:59], v[16:19], v[216:223], v3
  s_waitcnt lgkmcnt(0)
  v_smfmac_f32_16x16x64_bf16 v[60:63], v[16:19], v[144:151], v3
  ds_read_b128 v[64:67], v0 offset:6144
  ds_read_b128 v[68:71], v0 offset:7168
  v_smfmac_f32_16x16x64_bf16 v[36:39], v[20:23], a[24:31], v3
  v_smfmac_f32_16x16x64_bf16 v[40:43], v[20:23], a[80:87], v3
  v_smfmac_f32_16x16x64_bf16 v[44:47], v[20:23], a[136:143], v3
  v_smfmac_f32_16x16x64_bf16 v[48:51], v[20:23], a[192:199], v3
  v_smfmac_f32_16x16x64_bf16 v[52:55], v[20:23], a[248:255], v3
  v_smfmac_f32_16x16x64_bf16 v[56:59], v[20:23], v[224:231], v3
  s_waitcnt lgkmcnt(0)
  v_smfmac_f32_16x16x64_bf16 v[60:63], v[20:23], v[64:71], v3
  ds_read_b128 v[72:75], v0 offset:8192
  ds_read_b128 v[76:79], v0 offset:9216
  v_smfmac_f32_16x16x64_bf16 v[36:39], v[24:27], a[32:39], v3
  v_smfmac_f32_16x16x64_bf16 v[40:43], v[24:27], a[88:95], v3
  v_smfmac_f32_16x16x64_bf16 v[44:47], v[24:27], a[144:151], v3
  v_smfmac_f32_16x16x64_bf16 v[48:51], v[24:27], a[200:207], v3
  v_smfmac_f32_16x16x64_bf16 v[52:55], v[24:27], v[176:183], v3
  v_smfmac_f32_16x16x64_bf16 v[56:59], v[24:27], v[232:239], v3
  s_waitcnt lgkmcnt(0)
  v_smfmac_f32_16x16x64_bf16 v[60:63], v[24:27], v[72:79], v3
  ds_read_b128 v[144:147], v0 offset:10240
  ds_read_b128 v[148:151], v0 offset:11264
  v_smfmac_f32_16x16x64_bf16 v[36:39], v[28:31], a[40:47], v3
  v_smfmac_f32_16x16x64_bf16 v[40:43], v[28:31], a[96:103], v3
  v_smfmac_f32_16x16x64_bf16 v[44:47], v[28:31], a[152:159], v3
  v_smfmac_f32_16x16x64_bf16 v[48:51], v[28:31], a[208:215], v3
  v_smfmac_f32_16x16x64_bf16 v[52:55], v[28:31], v[184:191], v3
  v_smfmac_f32_16x16x64_bf16 v[56:59], v[28:31], v[240:247], v3
  s_waitcnt lgkmcnt(0)
  v_smfmac_f32_16x16x64_bf16 v[60:63], v[28:31], v[144:151], v3
  ds_read_b128 v[64:67], v0 offset:12288
  ds_read_b128 v[68:71], v0 offset:13312
  v_smfmac_f32_16x16x64_bf16 v[36:39], v[32:35], a[48:55], v3
  v_smfmac_f32_16x16x64_bf16 v[40:43], v[32:35], a[104:111], v3
  v_smfmac_f32_16x16x64_bf16 v[44:47], v[32:35], a[160:167], v3
  v_smfmac_f32_16x16x64_bf16 v[48:51], v[32:35], a[216:223], v3
  v_smfmac_f32_16x16x64_bf16 v[52:55], v[32:35], v[192:199], v3
  v_smfmac_f32_16x16x64_bf16 v[56:59], v[32:35], v[248:255], v3
  s_waitcnt lgkmcnt(0)
  v_smfmac_f32_16x16x64_bf16 v[60:63], v[32:35], v[64:71], v3
  v_permlane32_swap_b32 v36, v38
  v_permlane32_swap_b32 v37, v39
  v_add_f32 v36, v36, v38
  v_add_f32 v37, v37, v39
  v_cvt_pk_bf16_f32 v38, v36, v37
  ds_write_b32 v152, v38
  v_permlane32_swap_b32 v40, v42
  v_permlane32_swap_b32 v41, v43
  v_add_f32 v40, v40, v42
  v_add_f32 v41, v41, v43
  v_cvt_pk_bf16_f32 v42, v40, v41
  ds_write_b32 v153, v42
  v_permlane32_swap_b32 v44, v46
  v_permlane32_swap_b32 v45, v47
  v_add_f32 v44, v44, v46
  v_add_f32 v45, v45, v47
  v_cvt_pk_bf16_f32 v46, v44, v45
  ds_write_b32 v154, v46
  v_permlane32_swap_b32 v48, v50
  v_permlane32_swap_b32 v49, v51
  v_add_f32 v48, v48, v50
  v_add_f32 v49, v49, v51
  v_cvt_pk_bf16_f32 v50, v48, v49
  ds_write_b32 v155, v50
  v_permlane32_swap_b32 v52, v54
  v_permlane32_swap_b32 v53, v55
  v_add_f32 v52, v52, v54
  v_add_f32 v53, v53, v55
  v_cvt_pk_bf16_f32 v54, v52, v53
  ds_write_b32 v156, v54
  v_permlane32_swap_b32 v56, v58
  v_permlane32_swap_b32 v57, v59
  v_add_f32 v56, v56, v58
  v_add_f32 v57, v57, v59
  v_cvt_pk_bf16_f32 v58, v56, v57
  ds_write_b32 v157, v58
  v_permlane32_swap_b32 v60, v62
  v_permlane32_swap_b32 v61, v63
  v_add_f32 v60, v60, v62
  v_add_f32 v61, v61, v63
  v_cvt_pk_bf16_f32 v62, v60, v61
  ds_write_b32 v158, v62
  s_branch cA_va1_t2d
cA_va1_rp:
  s_cmp_lg_u32 s37, 0
  s_cbranch_scc1 cA_va1_cont
cA_va1_rv:
  s_add_u32 s31, s31, 0x10000
  buffer_load_dwordx4 v[8:11], v2, s[8:11], s22 offen offset:0 sc1
  buffer_load_dwordx4 v[12:15], v2, s[8:11], s22 offen offset:1024 sc1
  buffer_load_dwordx4 v[16:19], v2, s[8:11], s22 offen offset:2048 sc1
  buffer_load_dwordx4 v[20:23], v2, s[8:11], s22 offen offset:3072 sc1
  buffer_load_dwordx4 v[24:27], v2, s[8:11], s34 offen offset:0 sc1
  buffer_load_dwordx4 v[28:31], v2, s[8:11], s34 offen offset:1024 sc1
  buffer_load_dwordx4 v[32:35], v2, s[8:11], s34 offen offset:2048 sc1
  buffer_load_dwordx4 v[36:39], v2, s[8:11], s34 offen offset:3072 sc1
  buffer_load_dwordx4 v[40:43], v2, s[8:11], s36 offen offset:0 sc1
  buffer_load_dwordx4 v[44:47], v2, s[8:11], s36 offen offset:1024 sc1
  s_waitcnt vmcnt(0)
  v_max3_u32 v52, v8, v9, v10
  v_max3_u32 v52, v52, v11, v12
  v_max3_u32 v52, v52, v13, v14
  v_max3_u32 v52, v52, v15, v16
  v_max3_u32 v52, v52, v17, v18
  v_max3_u32 v52, v52, v19, v20
  v_max3_u32 v52, v52, v21, v22
  v_max3_u32 v52, v52, v23, v24
  v_max3_u32 v52, v52, v25, v26
  v_max3_u32 v52, v52, v27, v28
  v_max3_u32 v52, v52, v29, v30
  v_max3_u32 v52, v52, v31, v32
  v_max3_u32 v52, v52, v33, v34
  v_max3_u32 v52, v52, v35, v36
  v_max3_u32 v52, v52, v37, v38
  v_max3_u32 v52, v52, v39, v40
  v_max3_u32 v52, v52, v41, v42
  v_max3_u32 v52, v52, v43, v44
  v_max3_u32 v52, v52, v45, v46
  v_max_u32 v52, v52, v47
  v_cmp_eq_u32 vcc, -1, v52
  s_mov_b32 s37, 1
  v_mov_b32 v48, 0
  v_mov_b32 v49, 0
  v_mov_b32 v50, 0
  v_mov_b32 v51, 0
  s_nop 1
  s_cbranch_vccz cA_va1_lp
  s_add_u32 s30, s30, 1
  s_cmp_lt_u32 s30, 400000
  s_cbranch_scc1 cA_va1_rv
  s_branch cA_abort
.p2align 6
cA_va2_loop:
  s_mov_b32 s30, 0
  buffer_load_dword v100, v119, s[8:11], 0 offen sc1
  buffer_load_dword v101, v119, s[8:11], 0 offen sc1
  buffer_load_dword v102, v119, s[8:11], 0 offen sc1
  buffer_load_dword v103, v119, s[8:11], 0 offen sc1
cA_va2_fp_l:
  s_waitcnt vmcnt(3)
  v_cmp_gt_u32 vcc, s19, v100
  s_cbranch_vccz cA_va2_fp_d
  buffer_load_dword v100, v119, s[8:11], 0 offen sc1
  s_waitcnt vmcnt(3)
  v_cmp_gt_u32 vcc, s19, v101
  s_cbranch_vccz cA_va2_fp_d
  buffer_load_dword v101, v119, s[8:11], 0 offen sc1
  s_waitcnt vmcnt(3)
  v_cmp_gt_u32 vcc, s19, v102
  s_cbranch_vccz cA_va2_fp_d
  buffer_load_dword v102, v119, s[8:11], 0 offen sc1
  s_waitcnt vmcnt(3)
  v_cmp_gt_u32 vcc, s19, v103
  s_cbranch_vccz cA_va2_fp_d
  buffer_load_dword v103, v119, s[8:11], 0 offen sc1
  s_add_u32 s30, s30, 1
  s_cmp_lt_u32 s30, 400000
  s_cbranch_scc1 cA_va2_fp_l
  s_branch cA_abort
cA_va2_fp_d:
  buffer_load_dwordx4 v[8:11], v2, s[8:11], s20 offen offset:0 sc1
  buffer_load_dwordx4 v[12:15], v2, s[8:11], s20 offen offset:1024 sc1
  s_barrier
  s_barrier
  s_waitcnt vmcnt(0)
  ds_write_b128 v2, v[8:11] offset:8192
  ds_write_b128 v2, v[12:15] offset:9216
  v_smfmac_f32_16x16x64_bf16 v[36:39], v[8:11], a[0:7], v3
  v_smfmac_f32_16x16x64_bf16 v[40:43], v[8:11], a[56:63], v3
  v_smfmac_f32_16x16x64_bf16 v[44:47], v[8:11], a[112:119], v3
  v_smfmac_f32_16x16x64_bf16 v[48:51], v[8:11], a[168:175], v3
  v_smfmac_f32_16x16x64_bf16 v[52:55], v[8:11], a[224:231], v3
  s_waitcnt lgkmcnt(0)
  s_barrier
  ds_read_b128 v[16:19], v2 offset:10240
  ds_read_b128 v[20:23], v2 offset:11264
  ds_read_b128 v[24:27], v2 offset:12288
  ds_read_b128 v[28:31], v2 offset:13312
  ds_read_b128 v[32:35], v2 offset:14336
  v_smfmac_f32_16x16x64_bf16 v[56:59], v[8:11], v[144:151], v3
  v_smfmac_f32_16x16x64_bf16 v[60:63], v[8:11], v[200:207], v3
  v_smfmac_f32_16x16x64_bf16 v[36:39], v[12:15], a[8:15], v3
  v_smfmac_f32_16x16x64_bf16 v[40:43], v[12:15], a[64:71], v3
  v_smfmac_f32_16x16x64_bf16 v[44:47], v[12:15], a[120:127], v3
  v_smfmac_f32_16x16x64_bf16 v[48:51], v[12:15], a[176:183], v3
  v_smfmac_f32_16x16x64_bf16 v[52:55], v[12:15], a[232:239], v3
  v_smfmac_f32_16x16x64_bf16 v[56:59], v[12:15], v[152:159], v3
  v_smfmac_f32_16x16x64_bf16 v[60:63], v[12:15], v[208:215], v3
  s_waitcnt lgkmcnt(4)
  v_smfmac_f32_16x16x64_bf16 v[36:39], v[16:19], a[16:23], v3
  s_waitcnt lgkmcnt(3)
  v_smfmac_f32_16x16x64_bf16 v[36:39], v[20:23], a[24:31], v3
  s_waitcnt lgkmcnt(2)
  v_smfmac_f32_16x16x64_bf16 v[36:39], v[24:27], a[32:39], v3
  s_waitcnt lgkmcnt(1)
  v_smfmac_f32_16x16x64_bf16 v[36:39], v[28:31], a[40:47], v3
  s_waitcnt lgkmcnt(0)
  v_smfmac_f32_16x16x64_bf16 v[36:39], v[32:35], a[48:55], v3
  v_smfmac_f32_16x16x64_bf16 v[40:43], v[16:19], a[72:79], v3
  v_smfmac_f32_16x16x64_bf16 v[40:43], v[20:23], a[80:87], v3
  v_smfmac_f32_16x16x64_bf16 v[40:43], v[24:27], a[88:95], v3
  v_permlane32_swap_b32 v36, v38
  v_smfmac_f32_16x16x64_bf16 v[40:43], v[28:31], a[96:103], v3
  v_permlane32_swap_b32 v37, v39
  v_smfmac_f32_16x16x64_bf16 v[40:43], v[32:35], a[104:111], v3
  v_add_f32 v36, v36, v38
  v_smfmac_f32_16x16x64_bf16 v[44:47], v[16:19], a[128:135], v3
  v_add_f32 v37, v37, v39
  v_smfmac_f32_16x16x64_bf16 v[44:47], v[20:23], a[136:143], v3
  v_cmp_u_f32 vcc, v36, v37
  v_smfmac_f32_16x16x64_bf16 v[44:47], v[24:27], a[144:151], v3
  v_cvt_pk_bf16_f32 v38, v36, v37
  v_smfmac_f32_16x16x64_bf16 v[44:47], v[28:31], a[152:159], v3
  ds_write_b32 v104, v38
  s_cbranch_vccnz cA_va2_slow
  v_permlane32_swap_b32 v40, v42
  v_smfmac_f32_16x16x64_bf16 v[44:47], v[32:35], a[160:167], v3
  v_permlane32_swap_b32 v41, v43
  v_smfmac_f32_16x16x64_bf16 v[48:51], v[16:19], a[184:191], v3
  v_add_f32 v40, v40, v42
  v_smfmac_f32_16x16x64_bf16 v[48:51], v[20:23], a[192:199], v3
  v_add_f32 v41, v41, v43
  v_smfmac_f32_16x16x64_bf16 v[48:51], v[24:27], a[200:207], v3
  v_cvt_pk_bf16_f32 v42, v40, v41
  v_smfmac_f32_16x16x64_bf16 v[48:51], v[28:31], a[208:215], v3
  ds_write_b32 v105, v42
  v_permlane32_swap_b32 v44, v46
  v_smfmac_f32_16x16x64_bf16 v[48:51], v[32:35], a[216:223], v3
  v_permlane32_swap_b32 v45, v47
  v_smfmac_f32_16x16x64_bf16 v[52:55], v[16:19], a[240:247], v3
  v_add_f32 v44, v44, v46
  v_smfmac_f32_16x16x64_bf16 v[52:55], v[20:23], a[248:255], v3
  v_add_f32 v45, v45, v47
  v_smfmac_f32_16x16x64_bf16 v[52:55], v[24:27], v[120:127], v3
  v_cvt_pk_bf16_f32 v46, v44, v45
  v_smfmac_f32_16x16x64_bf16 v[52:55], v[28:31], v[128:135], v3
  ds_write_b32 v106, v46
  v_permlane32_swap_b32 v48, v50
  v_smfmac_f32_16x16x64_bf16 v[52:55], v[32:35], v[136:143], v3
  v_permlane32_swap_b32 v49, v51
  v_smfmac_f32_16x16x64_bf16 v[56:59], v[16:19], v[160:167], v3
  v_add_f32 v48, v48, v50
  v_smfmac_f32_16x16x64_bf16 v[56:59], v[20:23], v[168:175], v3
  v_add_f32 v49, v49, v51
  v_smfmac_f32_16x16x64_bf16 v[56:59], v[24:27], v[176:183], v3
  v_cvt_pk_bf16_f32 v50, v48, v49
  v_smfmac_f32_16x16x64_bf16 v[56:59], v[28:31], v[184:191], v3
  ds_write_b32 v107, v50
  v_permlane32_swap_b32 v52, v54
  v_smfmac_f32_16x16x64_bf16 v[56:59], v[32:35], v[192:199], v3
  v_permlane32_swap_b32 v53, v55
  v_smfmac_f32_16x16x64_bf16 v[60:63], v[16:19], v[216:223], v3
  v_add_f32 v52, v52, v54
  v_smfmac_f32_16x16x64_bf16 v[60:63], v[20:23], v[224:231], v3
  v_add_f32 v53, v53, v55
  v_smfmac_f32_16x16x64_bf16 v[60:63], v[24:27], v[232:239], v3
  v_cvt_pk_bf16_f32 v54, v52, v53
  v_smfmac_f32_16x16x64_bf16 v[60:63], v[28:31], v[240:247], v3
  ds_write_b32 v108, v54
  v_permlane32_swap_b32 v56, v58
  v_smfmac_f32_16x16x64_bf16 v[60:63], v[32:35], v[248:255], v3
  v_permlane32_swap_b32 v57, v59
  v_add_f32 v56, v56, v58
  v_add_f32 v57, v57, v59
  v_cvt_pk_bf16_f32 v58, v56, v57
  ds_write_b32 v109, v58
  s_nop 2
  v_permlane32_swap_b32 v60, v62
  v_permlane32_swap_b32 v61, v63
  v_add_f32 v60, v60, v62
  v_add_f32 v61, v61, v63
  v_cvt_pk_bf16_f32 v62, v60, v61
  ds_write_b32 v110, v62
cA_va2_t2d:
  v_mov_b32 v117, s18
  s_waitcnt lgkmcnt(0)
  s_barrier
  s_cmp_eq_u32 s19, 62
  s_cbranch_scc1 cA_done
  s_sleep 1
  v_mov_b32 v36, 0
  v_mov_b32 v37, 0
  v_mov_b32 v38, 0
  v_mov_b32 v39, 0
  v_mov_b32 v40, 0
  v_mov_b32 v41, 0
  v_mov_b32 v42, 0
  v_mov_b32 v43, 0
  v_mov_b32 v44, 0
  v_mov_b32 v45, 0
  v_mov_b32 v46, 0
  v_mov_b32 v47, 0
  v_mov_b32 v48, 0
  v_mov_b32 v49, 0
  v_mov_b32 v50, 0
  v_mov_b32 v51, 0
  v_mov_b32 v52, 0
  v_mov_b32 v53, 0
  v_mov_b32 v54, 0
  v_mov_b32 v55, 0
  v_mov_b32 v56, 0
  v_mov_b32 v57, 0
  v_mov_b32 v58, 0
  v_mov_b32 v59, 0
  v_mov_b32 v60, 0
  v_mov_b32 v61, 0
  v_mov_b32 v62, 0
  v_mov_b32 v63, 0
  s_sleep 3
  s_mov_b32 s19, s18
  s_add_u32 s18, s18, 1
  s_mov_b32 s22, s20
  s_mov_b32 s20, s21
  s_mov_b32 s21, s22
  s_add_u32 s23, s20, 4096
  s_branch cA_va2_loop
cA_va2_slow:
  s_waitcnt lgkmcnt(0)
cA_va2_sl1:
  s_add_u32 s31, s31, 0x1000000
  buffer_load_dwordx4 v[8:11], v2, s[8:11], s20 offen offset:0 sc1
  buffer_load_dwordx4 v[12:15], v2, s[8:11], s20 offen offset:1024 sc1
  buffer_load_dwordx4 v[16:19], v2, s[8:11], s20 offen offset:2048 sc1
  buffer_load_dwordx4 v[20:23], v2, s[8:11], s20 offen offset:3072 sc1
  buffer_load_dwordx4 v[24:27], v2, s[8:11], s23 offen offset:0 sc1
  buffer_load_dwordx4 v[28:31], v2, s[8:11], s23 offen offset:1024 sc1
  buffer_load_dwordx4 v[32:35], v2, s[8:11], s23 offen offset:2048 sc1
  s_waitcnt vmcnt(0)
  v_max3_u32 v36, v8, v9, v10
  v_max3_u32 v36, v36, v11, v12
  v_max3_u32 v36, v36, v13, v14
  v_max3_u32 v36, v36, v15, v16
  v_max3_u32 v36, v36, v17, v18
  v_max3_u32 v36, v36, v19, v20
  v_max3_u32 v36, v36, v21, v22
  v_max3_u32 v36, v36, v23, v24
  v_max3_u32 v36, v36, v25, v26
  v_max3_u32 v36, v36, v27, v28
  v_max3_u32 v36, v36, v29, v30
  v_max3_u32 v36, v36, v31, v32
  v_max3_u32 v36, v36, v33, v34
  v_max_u32 v36, v36, v35
  v_cmp_eq_u32 vcc, -1, v36
  s_cbranch_vccz cA_va2_sl2
  s_add_u32 s30, s30, 1
  s_cmp_lt_u32 s30, 400000
  s_cbranch_scc1 cA_va2_sl1
  s_branch cA_abort
cA_va2_sl2:
  v_mov_b32 v36, 0
  v_mov_b32 v37, 0
  v_mov_b32 v38, 0
  v_mov_b32 v39, 0
  v_mov_b32 v40, 0
  v_mov_b32 v41, 0
  v_mov_b32 v42, 0
  v_mov_b32 v43, 0
  v_mov_b32 v44, 0
  v_mov_b32 v45, 0
  v_mov_b32 v46, 0
  v_mov_b32 v47, 0
  v_mov_b32 v48, 0
  v_mov_b32 v49, 0
  v_mov_b32 v50, 0
  v_mov_b32 v51, 0
  v_mov_b32 v52, 0
  v_mov_b32 v53, 0
  v_mov_b32 v54, 0
  v_mov_b32 v55, 0
  v_mov_b32 v56, 0
  v_mov_b32 v57, 0
  v_mov_b32 v58, 0
  v_mov_b32 v59, 0
  v_mov_b32 v60, 0
  v_mov_b32 v61, 0
  v_mov_b32 v62, 0
  v_mov_b32 v63, 0
  v_smfmac_f32_16x16x64_bf16 v[36:39], v[8:11], a[0:7], v3
  v_smfmac_f32_16x16x64_bf16 v[40:43], v[8:11], a[56:63], v3
  v_smfmac_f32_16x16x64_bf16 v[44:47], v[8:11], a[112:119], v3
  v_smfmac_f32_16x16x64_bf16 v[48:51], v[8:11], a[168:175], v3
  v_smfmac_f32_16x16x64_bf16 v[52:55], v[8:11], a[224:231], v3
  v_smfmac_f32_16x16x64_bf16 v[56:59], v[8:11], v[144:151], v3
  v_smfmac_f32_16x16x64_bf16 v[60:63], v[8:11], v[200:207], v3
  v_smfmac_f32_16x16x64_bf16 v[36:39], v[12:15], a[8:15], v3
  v_smfmac_f32_16x16x64_bf16 v[40:43], v[12:15], a[64:71], v3
  v_smfmac_f32_16x16x64_bf16 v[44:47], v[12:15], a[120:127], v3
  v_smfmac_f32_16x16x64_bf16 v[48:51], v[12:15], a[176:183], v3
  v_smfmac_f32_16x16x64_bf16 v[52:55], v[12:15], a[232:239], v3
  v_smfmac_f32_16x16x64_bf16 v[56:59], v[12:15], v[152:159], v3
  v_smfmac_f32_16x16x64_bf16 v[60:63], v[12:15], v[208:215], v3
  v_smfmac_f32_16x16x64_bf16 v[36:39], v[16:19], a[16:23], v3
  v_smfmac_f32_16x16x64_bf16 v[40:43], v[16:19], a[72:79], v3
  v_smfmac_f32_16x16x64_bf16 v[44:47], v[16:19], a[128:135], v3
  v_smfmac_f32_16x16x64_bf16 v[48:51], v[16:19], a[184:191], v3
  v_smfmac_f32_16x16x64_bf16 v[52:55], v[16:19], a[240:247], v3
  v_smfmac_f32_16x16x64_bf16 v[56:59], v[16:19], v[160:167], v3
  v_smfmac_f32_16x16x64_bf16 v[60:63], v[16:19], v[216:223], v3
  v_smfmac_f32_16x16x64_bf16 v[36:39], v[20:23], a[24:31], v3
  v_smfmac_f32_16x16x64_bf16 v[40:43], v[20:23], a[80:87], v3
  v_smfmac_f32_16x16x64_bf16 v[44:47], v[20:23], a[136:143], v3
  v_smfmac_f32_16x16x64_bf16 v[48:51], v[20:23], a[192:199], v3
  v_smfmac_f32_16x16x64_bf16 v[52:55], v[20:23], a[248:255], v3
  v_smfmac_f32_16x16x64_bf16 v[56:59], v[20:23], v[168:175], v3
  v_smfmac_f32_16x16x64_bf16 v[60:63], v[20:23], v[224:231], v3
  v_smfmac_f32_16x16x64_bf16 v[36:39], v[24:27], a[32:39], v3
  v_smfmac_f32_16x16x64_bf16 v[40:43], v[24:27], a[88:95], v3
  v_smfmac_f32_16x16x64_bf16 v[44:47], v[24:27], a[144:151], v3
  v_smfmac_f32_16x16x64_bf16 v[48:51], v[24:27], a[200:207], v3
  v_smfmac_f32_16x16x64_bf16 v[52:55], v[24:27], v[120:127], v3
  v_smfmac_f32_16x16x64_bf16 v[56:59], v[24:27], v[176:183], v3
  v_smfmac_f32_16x16x64_bf16 v[60:63], v[24:27], v[232:239], v3
  v_smfmac_f32_16x16x64_bf16 v[36:39], v[28:31], a[40:47], v3
  v_smfmac_f32_16x16x64_bf16 v[40:43], v[28:31], a[96:103], v3
  v_smfmac_f32_16x16x64_bf16 v[44:47], v[28:31], a[152:159], v3
  v_smfmac_f32_16x16x64_bf16 v[48:51], v[28:31], a[208:215], v3
  v_smfmac_f32_16x16x64_bf16 v[52:55], v[28:31], v[128:135], v3
  v_smfmac_f32_16x16x64_bf16 v[56:59], v[28:31], v[184:191], v3
  v_smfmac_f32_16x16x64_bf16 v[60:63], v[28:31], v[240:247], v3
  v_smfmac_f32_16x16x64_bf16 v[36:39], v[32:35], a[48:55], v3
  v_smfmac_f32_16x16x64_bf16 v[40:43], v[32:35], a[104:111], v3
  v_smfmac_f32_16x16x64_bf16 v[44:47], v[32:35], a[160:167], v3
  v_smfmac_f32_16x16x64_bf16 v[48:51], v[32:35], a[216:223], v3
  v_smfmac_f32_16x16x64_bf16 v[52:55], v[32:35], v[136:143], v3
  v_smfmac_f32_16x16x64_bf16 v[56:59], v[32:35], v[192:199], v3
  v_smfmac_f32_16x16x64_bf16 v[60:63], v[32:35], v[248:255], v3
  v_permlane32_swap_b32 v36, v38
  v_permlane32_swap_b32 v37, v39
  v_add_f32 v36, v36, v38
  v_add_f32 v37, v37, v39
  v_cvt_pk_bf16_f32 v38, v36, v37
  ds_write_b32 v104, v38
  v_permlane32_swap_b32 v40, v42
  v_permlane32_swap_b32 v41, v43
  v_add_f32 v40, v40, v42
  v_add_f32 v41, v41, v43
  v_cvt_pk_bf16_f32 v42, v40, v41
  ds_write_b32 v105, v42
  v_permlane32_swap_b32 v44, v46
  v_permlane32_swap_b32 v45, v47
  v_add_f32 v44, v44, v46
  v_add_f32 v45, v45, v47
  v_cvt_pk_bf16_f32 v46, v44, v45
  ds_write_b32 v106, v46
  v_permlane32_swap_b32 v48, v50
  v_permlane32_swap_b32 v49, v51
  v_add_f32 v48, v48, v50
  v_add_f32 v49, v49, v51
  v_cvt_pk_bf16_f32 v50, v48, v49
  ds_write_b32 v107, v50
  v_permlane32_swap_b32 v52, v54
  v_permlane32_swap_b32 v53, v55
  v_add_f32 v52, v52, v54
  v_add_f32 v53, v53, v55
  v_cvt_pk_bf16_f32 v54, v52, v53
  ds_write_b32 v108, v54
  v_permlane32_swap_b32 v56, v58
  v_permlane32_swap_b32 v57, v59
  v_add_f32 v56, v56, v58
  v_add_f32 v57, v57, v59
  v_cvt_pk_bf16_f32 v58, v56, v57
  ds_write_b32 v109, v58
  v_permlane32_swap_b32 v60, v62
  v_permlane32_swap_b32 v61, v63
  v_add_f32 v60, v60, v62
  v_add_f32 v61, v61, v63
  v_cvt_pk_bf16_f32 v62, v60, v61
  ds_write_b32 v110, v62
  s_branch cA_va2_t2d
.p2align 6
cA_va3_loop:
  s_mov_b32 s30, 0
  s_barrier
  buffer_load_dwordx4 v[16:19], v2, s[8:11], s20 offen offset:2048 sc1
  buffer_load_dwordx4 v[20:23], v2, s[8:11], s20 offen offset:3072 sc1
  s_barrier
  buffer_load_dword v100, v116, s[8:11], s39 offen sc1
  s_add_u32 s27, s19, 2
  s_min_u32 s27, s27, 63
  s_lshr_b32 s27, s27, 3
  s_lshl_b32 s27, s27, 11
  s_add_u32 s27, s27, s35
  s_cmp_eq_u32 s27, s28
  s_cselect_b32 s29, 75729408, s27
  buffer_load_dword v101, off, s[8:11], s29 sc1
  s_add_u32 s39, s39, 28672
  s_waitcnt vmcnt(2)
  ds_write_b128 v2, v[16:19] offset:10240
  ds_write_b128 v2, v[20:23] offset:11264
  v_smfmac_f32_16x16x64_bf16 v[36:39], v[16:19], a[16:23], v3
  v_smfmac_f32_16x16x64_bf16 v[40:43], v[16:19], a[72:79], v3
  v_smfmac_f32_16x16x64_bf16 v[44:47], v[16:19], a[128:135], v3
  v_smfmac_f32_16x16x64_bf16 v[48:51], v[16:19], a[184:191], v3
  v_smfmac_f32_16x16x64_bf16 v[52:55], v[16:19], a[240:247], v3
  s_waitcnt lgkmcnt(0)
  s_barrier
  ds_read_b128 v[8:11], v2 offset:8192
  ds_read_b128 v[12:15], v2 offset:9216
  ds_read_b128 v[24:27], v2 offset:12288
  ds_read_b128 v[28:31], v2 offset:13312
  ds_read_b128 v[32:35], v2 offset:14336
  v_smfmac_f32_16x16x64_bf16 v[56:59], v[16:19], v[160:167], v3
  v_smfmac_f32_16x16x64_bf16 v[60:63], v[16:19], v[216:223], v3
  v_smfmac_f32_16x16x64_bf16 v[36:39], v[20:23], a[24:31], v3
  v_smfmac_f32_16x16x64_bf16 v[40:43], v[20:23], a[80:87], v3
  v_smfmac_f32_16x16x64_bf16 v[44:47], v[20:23], a[136:143], v3
  v_smfmac_f32_16x16x64_bf16 v[48:51], v[20:23], a[192:199], v3
  v_smfmac_f32_16x16x64_bf16 v[52:55], v[20:23], a[248:255], v3
  v_smfmac_f32_16x16x64_bf16 v[56:59], v[20:23], v[168:175], v3
  v_smfmac_f32_16x16x64_bf16 v[60:63], v[20:23], v[224:231], v3
  s_waitcnt lgkmcnt(4)
  v_smfmac_f32_16x16x64_bf16 v[36:39], v[8:11], a[0:7], v3
  s_waitcnt lgkmcnt(3)
  v_smfmac_f32_16x16x64_bf16 v[36:39], v[12:15], a[8:15], v3
  s_waitcnt lgkmcnt(2)
  v_smfmac_f32_16x16x64_bf16 v[36:39], v[24:27], a[32:39], v3
  s_waitcnt lgkmcnt(1)
  v_smfmac_f32_16x16x64_bf16 v[36:39], v[28:31], a[40:47], v3
  s_waitcnt lgkmcnt(0)
  v_smfmac_f32_16x16x64_bf16 v[36:39], v[32:35], a[48:55], v3
  v_smfmac_f32_16x16x64_bf16 v[40:43], v[8:11], a[56:63], v3
  v_smfmac_f32_16x16x64_bf16 v[40:43], v[12:15], a[64:71], v3
  v_smfmac_f32_16x16x64_bf16 v[40:43], v[24:27], a[88:95], v3
  v_permlane32_swap_b32 v36, v38
  v_smfmac_f32_16x16x64_bf16 v[40:43], v[28:31], a[96:103], v3
  v_permlane32_swap_b32 v37, v39
  v_smfmac_f32_16x16x64_bf16 v[40:43], v[32:35], a[104:111], v3
  v_add_f32 v36, v36, v38
  v_smfmac_f32_16x16x64_bf16 v[44:47], v[8:11], a[112:119], v3
  v_add_f32 v37, v37, v39
  v_smfmac_f32_16x16x64_bf16 v[44:47], v[12:15], a[120:127], v3
  v_cmp_u_f32 vcc, v36, v37
  v_smfmac_f32_16x16x64_bf16 v[44:47], v[24:27], a[144:151], v3
  v_cvt_pk_bf16_f32 v38, v36, v37
  v_smfmac_f32_16x16x64_bf16 v[44:47], v[28:31], a[152:159], v3
  ds_write_b32 v104, v38
  s_cbranch_vccnz cA_va3_slow
  v_permlane32_swap_b32 v40, v42
  v_smfmac_f32_16x16x64_bf16 v[44:47], v[32:35], a[160:167], v3
  v_permlane32_swap_b32 v41, v43
  v_smfmac_f32_16x16x64_bf16 v[48:51], v[8:11], a[168:175], v3
  v_add_f32 v40, v40, v42
  v_smfmac_f32_16x16x64_bf16 v[48:51], v[12:15], a[176:183], v3
  v_add_f32 v41, v41, v43
  v_smfmac_f32_16x16x64_bf16 v[48:51], v[24:27], a[200:207], v3
  v_cvt_pk_bf16_f32 v42, v40, v41
  v_smfmac_f32_16x16x64_bf16 v[48:51], v[28:31], a[208:215], v3
  ds_write_b32 v105, v42
  v_permlane32_swap_b32 v44, v46
  v_smfmac_f32_16x16x64_bf16 v[48:51], v[32:35], a[216:223], v3
  v_permlane32_swap_b32 v45, v47
  v_smfmac_f32_16x16x64_bf16 v[52:55], v[8:11], a[224:231], v3
  v_add_f32 v44, v44, v46
  v_smfmac_f32_16x16x64_bf16 v[52:55], v[12:15], a[232:239], v3
  v_add_f32 v45, v45, v47
  v_smfmac_f32_16x16x64_bf16 v[52:55], v[24:27], v[120:127], v3
  v_cvt_pk_bf16_f32 v46, v44, v45
  v_smfmac_f32_16x16x64_bf16 v[52:55], v[28:31], v[128:135], v3
  ds_write_b32 v106, v46
  v_permlane32_swap_b32 v48, v50
  v_smfmac_f32_16x16x64_bf16 v[52:55], v[32:35], v[136:143], v3
  v_permlane32_swap_b32 v49, v51
  v_smfmac_f32_16x16x64_bf16 v[56:59], v[8:11], v[144:151], v3
  v_add_f32 v48, v48, v50
  v_smfmac_f32_16x16x64_bf16 v[56:59], v[12:15], v[152:159], v3
  v_add_f32 v49, v49, v51
  v_smfmac_f32_16x16x64_bf16 v[56:59], v[24:27], v[176:183], v3
  v_cvt_pk_bf16_f32 v50, v48, v49
  v_smfmac_f32_16x16x64_bf16 v[56:59], v[28:31], v[184:191], v3
  ds_write_b32 v107, v50
  v_permlane32_swap_b32 v52, v54
  v_smfmac_f32_16x16x64_bf16 v[56:59], v[32:35], v[192:199], v3
  v_permlane32_swap_b32 v53, v55
  v_smfmac_f32_16x16x64_bf16 v[60:63], v[8:11], v[200:207], v3
  v_add_f32 v52, v52, v54
  v_smfmac_f32_16x16x64_bf16 v[60:63], v[12:15], v[208:215], v3
  v_add_f32 v53, v53, v55
  v_smfmac_f32_16x16x64_bf16 v[60:63], v[24:27], v[232:239], v3
  v_cvt_pk_bf16_f32 v54, v52, v53
  v_smfmac_f32_16x16x64_bf16 v[60:63], v[28:31], v[240:247], v3
  ds_write_b32 v108, v54
  v_permlane32_swap_b32 v56, v58
  v_smfmac_f32_16x16x64_bf16 v[60:63], v[32:35], v[248:255], v3
  v_permlane32_swap_b32 v57, v59
  v_add_f32 v56, v56, v58
  v_add_f32 v57, v57, v59
  v_cvt_pk_bf16_f32 v58, v56, v57
  ds_write_b32 v109, v58
  s_nop 2
  v_permlane32_swap_b32 v60, v62
  v_permlane32_swap_b32 v61, v63
  v_add_f32 v60, v60, v62
  v_add_f32 v61, v61, v63
  v_cvt_pk_bf16_f32 v62, v60, v61
  ds_write_b32 v110, v62
cA_va3_t2d:
  v_mov_b32 v117, s18
  s_cmp_eq_u32 s27, s28
  s_cbranch_scc1 cA_va3_vok
cA_va3_vow:
  s_waitcnt vmcnt(0)
  v_cmp_ne_u32 vcc, 56, v101
  s_cbranch_vccnz cA_va3_vor
  s_mov_b32 s28, s27
cA_va3_vok:
  s_waitcnt lgkmcnt(0)
  s_setprio 3
  s_barrier
  v_mov_b32 v36, 0
  v_mov_b32 v37, 0
  v_mov_b32 v38, 0
  v_mov_b32 v39, 0
  buffer_store_dword v117, v118, s[8:11], 0 offen
  s_setprio 0
  s_cmp_eq_u32 s19, 62
  s_cbranch_scc1 cA_done
  v_mov_b32 v40, 0
  v_mov_b32 v41, 0
  v_mov_b32 v42, 0
  v_mov_b32 v43, 0
  v_mov_b32 v44, 0
  v_mov_b32 v45, 0
  v_mov_b32 v46, 0
  v_mov_b32 v47, 0
  v_mov_b32 v48, 0
  v_mov_b32 v49, 0
  v_mov_b32 v50, 0
  v_mov_b32 v51, 0
  v_mov_b32 v52, 0
  v_mov_b32 v53, 0
  v_mov_b32 v54, 0
  v_mov_b32 v55, 0
  v_mov_b32 v56, 0
  v_mov_b32 v57, 0
  v_mov_b32 v58, 0
  v_mov_b32 v59, 0
  v_mov_b32 v60, 0
  v_mov_b32 v61, 0
  v_mov_b32 v62, 0
  v_mov_b32 v63, 0
  s_mov_b32 s19, s18
  s_add_u32 s18, s18, 1
  s_mov_b32 s22, s20
  s_mov_b32 s20, s21
  s_mov_b32 s21, s22
  s_add_u32 s23, s20, 4096
  s_branch cA_va3_loop
cA_va3_slow:
  s_waitcnt lgkmcnt(0)
cA_va3_sl1:
  s_add_u32 s31, s31, 0x1000000
  buffer_load_dwordx4 v[8:11], v2, s[8:11], s20 offen offset:0 sc1
  buffer_load_dwordx4 v[12:15], v2, s[8:11], s20 offen offset:1024 sc1
  buffer_load_dwordx4 v[16:19], v2, s[8:11], s20 offen offset:2048 sc1
  buffer_load_dwordx4 v[20:23], v2, s[8:11], s20 offen offset:3072 sc1
  buffer_load_dwordx4 v[24:27], v2, s[8:11], s23 offen offset:0 sc1
  buffer_load_dwordx4 v[28:31], v2, s[8:11], s23 offen offset:1024 sc1
  buffer_load_dwordx4 v[32:35], v2, s[8:11], s23 offen offset:2048 sc1
  s_waitcnt vmcnt(0)
  v_max3_u32 v36, v8, v9, v10
  v_max3_u32 v36, v36, v11, v12
  v_max3_u32 v36, v36, v13, v14
  v_max3_u32 v36, v36, v15, v16
  v_max3_u32 v36, v36, v17, v18
  v_max3_u32 v36, v36, v19, v20
  v_max3_u32 v36, v36, v21, v22
  v_max3_u32 v36, v36, v23, v24
  v_max3_u32 v36, v36, v25, v26
  v_max3_u32 v36, v36, v27, v28
  v_max3_u32 v36, v36, v29, v30
  v_max3_u32 v36, v36, v31, v32
  v_max3_u32 v36, v36, v33, v34
  v_max_u32 v36, v36, v35
  v_cmp_eq_u32 vcc, -1, v36
  s_cbranch_vccz cA_va3_sl2
  s_add_u32 s30, s30, 1
  s_cmp_lt_u32 s30, 400000
  s_cbranch_scc1 cA_va3_sl1
  s_branch cA_abort
cA_va3_sl2:
  v_mov_b32 v36, 0
  v_mov_b32 v37, 0
  v_mov_b32 v38, 0
  v_mov_b32 v39, 0
  v_mov_b32 v40, 0
  v_mov_b32 v41, 0
  v_mov_b32 v42, 0
  v_mov_b32 v43, 0
  v_mov_b32 v44, 0
  v_mov_b32 v45, 0
  v_mov_b32 v46, 0
  v_mov_b32 v47, 0
  v_mov_b32 v48, 0
  v_mov_b32 v49, 0
  v_mov_b32 v50, 0
  v_mov_b32 v51, 0
  v_mov_b32 v52, 0
  v_mov_b32 v53, 0
  v_mov_b32 v54, 0
  v_mov_b32 v55, 0
  v_mov_b32 v56, 0
  v_mov_b32 v57, 0
  v_mov_b32 v58, 0
  v_mov_b32 v59, 0
  v_mov_b32 v60, 0
  v_mov_b32 v61, 0
  v_mov_b32 v62, 0
  v_mov_b32 v63, 0
  v_smfmac_f32_16x16x64_bf16 v[36:39], v[8:11], a[0:7], v3
  v_smfmac_f32_16x16x64_bf16 v[40:43], v[8:11], a[56:63], v3
  v_smfmac_f32_16x16x64_bf16 v[44:47], v[8:11], a[112:119], v3
  v_smfmac_f32_16x16x64_bf16 v[48:51], v[8:11], a[168:175], v3
  v_smfmac_f32_16x16x64_bf16 v[52:55], v[8:11], a[224:231], v3
  v_smfmac_f32_16x16x64_bf16 v[56:59], v[8:11], v[144:151], v3
  v_smfmac_f32_16x16x64_bf16 v[60:63], v[8:11], v[200:207], v3
  v_smfmac_f32_16x16x64_bf16 v[36:39], v[12:15], a[8:15], v3
  v_smfmac_f32_16x16x64_bf16 v[40:43], v[12:15], a[64:71], v3
  v_smfmac_f32_16x16x64_bf16 v[44:47], v[12:15], a[120:127], v3
  v_smfmac_f32_16x16x64_bf16 v[48:51], v[12:15], a[176:183], v3
  v_smfmac_f32_16x16x64_bf16 v[52:55], v[12:15], a[232:239], v3
  v_smfmac_f32_16x16x64_bf16 v[56:59], v[12:15], v[152:159], v3
  v_smfmac_f32_16x16x64_bf16 v[60:63], v[12:15], v[208:215], v3
  v_smfmac_f32_16x16x64_bf16 v[36:39], v[16:19], a[16:23], v3
  v_smfmac_f32_16x16x64_bf16 v[40:43], v[16:19], a[72:79], v3
  v_smfmac_f32_16x16x64_bf16 v[44:47], v[16:19], a[128:135], v3
  v_smfmac_f32_16x16x64_bf16 v[48:51], v[16:19], a[184:191], v3
  v_smfmac_f32_16x16x64_bf16 v[52:55], v[16:19], a[240:247], v3
  v_smfmac_f32_16x16x64_bf16 v[56:59], v[16:19], v[160:167], v3
  v_smfmac_f32_16x16x64_bf16 v[60:63], v[16:19], v[216:223], v3
  v_smfmac_f32_16x16x64_bf16 v[36:39], v[20:23], a[24:31], v3
  v_smfmac_f32_16x16x64_bf16 v[40:43], v[20:23], a[80:87], v3
  v_smfmac_f32_16x16x64_bf16 v[44:47], v[20:23], a[136:143], v3
  v_smfmac_f32_16x16x64_bf16 v[48:51], v[20:23], a[192:199], v3
  v_smfmac_f32_16x16x64_bf16 v[52:55], v[20:23], a[248:255], v3
  v_smfmac_f32_16x16x64_bf16 v[56:59], v[20:23], v[168:175], v3
  v_smfmac_f32_16x16x64_bf16 v[60:63], v[20:23], v[224:231], v3
  v_smfmac_f32_16x16x64_bf16 v[36:39], v[24:27], a[32:39], v3
  v_smfmac_f32_16x16x64_bf16 v[40:43], v[24:27], a[88:95], v3
  v_smfmac_f32_16x16x64_bf16 v[44:47], v[24:27], a[144:151], v3
  v_smfmac_f32_16x16x64_bf16 v[48:51], v[24:27], a[200:207], v3
  v_smfmac_f32_16x16x64_bf16 v[52:55], v[24:27], v[120:127], v3
  v_smfmac_f32_16x16x64_bf16 v[56:59], v[24:27], v[176:183], v3
  v_smfmac_f32_16x16x64_bf16 v[60:63], v[24:27], v[232:239], v3
  v_smfmac_f32_16x16x64_bf16 v[36:39], v[28:31], a[40:47], v3
  v_smfmac_f32_16x16x64_bf16 v[40:43], v[28:31], a[96:103], v3
  v_smfmac_f32_16x16x64_bf16 v[44:47], v[28:31], a[152:159], v3
  v_smfmac_f32_16x16x64_bf16 v[48:51], v[28:31], a[208:215], v3
  v_smfmac_f32_16x16x64_bf16 v[52:55], v[28:31], v[128:135], v3
  v_smfmac_f32_16x16x64_bf16 v[56:59], v[28:31], v[184:191], v3
  v_smfmac_f32_16x16x64_bf16 v[60:63], v[28:31], v[240:247], v3
  v_smfmac_f32_16x16x64_bf16 v[36:39], v[32:35], a[48:55], v3
  v_smfmac_f32_16x16x64_bf16 v[40:43], v[32:35], a[104:111], v3
  v_smfmac_f32_16x16x64_bf16 v[44:47], v[32:35], a[160:167], v3
  v_smfmac_f32_16x16x64_bf16 v[48:51], v[32:35], a[216:223], v3
  v_smfmac_f32_16x16x64_bf16 v[52:55], v[32:35], v[136:143], v3
  v_smfmac_f32_16x16x64_bf16 v[56:59], v[32:35], v[192:199], v3
  v_smfmac_f32_16x16x64_bf16 v[60:63], v[32:35], v[248:255], v3
  v_permlane32_swap_b32 v36, v38
  v_permlane32_swap_b32 v37, v39
  v_add_f32 v36, v36, v38
  v_add_f32 v37, v37, v39
  v_cvt_pk_bf16_f32 v38, v36, v37
  ds_write_b32 v104, v38
  v_permlane32_swap_b32 v40, v42
  v_permlane32_swap_b32 v41, v43
  v_add_f32 v40, v40, v42
  v_add_f32 v41, v41, v43
  v_cvt_pk_bf16_f32 v42, v40, v41
  ds_write_b32 v105, v42
  v_permlane32_swap_b32 v44, v46
  v_permlane32_swap_b32 v45, v47
  v_add_f32 v44, v44, v46
  v_add_f32 v45, v45, v47
  v_cvt_pk_bf16_f32 v46, v44, v45
  ds_write_b32 v106, v46
  v_permlane32_swap_b32 v48, v50
  v_permlane32_swap_b32 v49, v51
  v_add_f32 v48, v48, v50
  v_add_f32 v49, v49, v51
  v_cvt_pk_bf16_f32 v50, v48, v49
  ds_write_b32 v107, v50
  v_permlane32_swap_b32 v52, v54
  v_permlane32_swap_b32 v53, v55
  v_add_f32 v52, v52, v54
  v_add_f32 v53, v53, v55
  v_cvt_pk_bf16_f32 v54, v52, v53
  ds_write_b32 v108, v54
  v_permlane32_swap_b32 v56, v58
  v_permlane32_swap_b32 v57, v59
  v_add_f32 v56, v56, v58
  v_add_f32 v57, v57, v59
  v_cvt_pk_bf16_f32 v58, v56, v57
  ds_write_b32 v109, v58
  v_permlane32_swap_b32 v60, v62
  v_permlane32_swap_b32 v61, v63
  v_add_f32 v60, v60, v62
  v_add_f32 v61, v61, v63
  v_cvt_pk_bf16_f32 v62, v60, v61
  ds_write_b32 v110, v62
  s_branch cA_va3_t2d
cA_va3_vor:
  s_sleep 2
  buffer_load_dword v101, off, s[8:11], s27 sc1
  s_add_u32 s30, s30, 1
  s_cmp_lt_u32 s30, 400000
  s_cbranch_scc1 cA_va3_vow
  s_branch cA_abort
cA_abort:
  v_mov_b32 v4, 0xdead
  v_mov_b32 v5, 16
  buffer_store_dword v4, v5, s[12:15], 0 offen
  s_branch ch_end
cA_done:
  s_branch ch_end
.p2align 6
cB_sc0_loop:
  s_mov_b32 s30, 0
  s_mov_b32 s62, 0
  s_setprio 3
  s_sleep 6
  buffer_load_dword v76, v0, s[8:11], 0 offen sc1
  buffer_load_dword v77, v0, s[8:11], 0 offen sc1
  buffer_load_dword v78, v0, s[8:11], 0 offen sc1
  buffer_load_dword v79, v0, s[8:11], 0 offen sc1
cB_sc0_fp_l:
  s_waitcnt vmcnt(3)
  v_cmp_gt_u32 vcc, s19, v76
  s_cbranch_vccz cB_sc0_fp_d
  buffer_load_dword v76, v0, s[8:11], 0 offen sc1
  s_waitcnt vmcnt(3)
  v_cmp_gt_u32 vcc, s19, v77
  s_cbranch_vccz cB_sc0_fp_d
  buffer_load_dword v77, v0, s[8:11], 0 offen sc1
  s_waitcnt vmcnt(3)
  v_cmp_gt_u32 vcc, s19, v78
  s_cbranch_vccz cB_sc0_fp_d
  buffer_load_dword v78, v0, s[8:11], 0 offen sc1
  s_waitcnt vmcnt(3)
  v_cmp_gt_u32 vcc, s19, v79
  s_cbranch_vccz cB_sc0_fp_d
  buffer_load_dword v79, v0, s[8:11], 0 offen sc1
  s_add_u32 s30, s30, 1
  s_cmp_lt_u32 s30, 400000
  s_cbranch_scc1 cB_sc0_fp_l
  s_branch cB_abort
cB_sc0_fp_d:
  buffer_load_dwordx4 v[8:11], v2, s[8:11], s20 offen offset:0 sc1
  s_barrier
  s_setprio 2
  buffer_load_dwordx4 v[12:15], v2, s[8:11], s20 offen offset:1024 sc1
  s_setprio 1
  buffer_load_dwordx4 v[16:19], v2, s[8:11], s20 offen offset:2048 sc1
  s_setprio 0
  buffer_load_dwordx4 v[20:23], v2, s[8:11], s20 offen offset:3072 sc1
cB_sc0_go:
  s_waitcnt vmcnt(3)
  v_smfmac_f32_16x16x64_bf16 v[36:39], v[8:11], a[0:7], v3
  buffer_load_dwordx4 v[32:35], v2, s[8:11], s23 offen offset:0 sc1
  v_cmp_eq_u32 vcc, -1, v8
  v_smfmac_f32_16x16x64_bf16 v[40:43], v[8:11], a[56:63], v3
  v_smfmac_f32_16x16x64_bf16 v[44:47], v[8:11], a[112:119], v3
  buffer_load_dwordx4 v[24:27], v2, s[8:11], s23 offen offset:1024 sc1
  s_cbranch_vccnz cB_sc0_r0
  v_smfmac_f32_16x16x64_bf16 v[48:51], v[8:11], a[168:175], v3
  v_smfmac_f32_16x16x64_bf16 v[52:55], v[8:11], a[224:231], v3
  s_waitcnt vmcnt(4)
  v_cmp_eq_u32 vcc, -1, v12
  v_smfmac_f32_16x16x64_bf16 v[56:59], v[8:11], v[144:151], v3
  buffer_load_dwordx4 v[28:31], v2, s[8:11], s23 offen offset:2048 sc1
  v_smfmac_f32_16x16x64_bf16 v[60:63], v[8:11], v[200:207], v3
  s_cbranch_vccnz cB_sc0_r1
cB_sc0_c1:
  v_smfmac_f32_16x16x64_bf16 v[36:39], v[12:15], a[8:15], v3
  v_smfmac_f32_16x16x64_bf16 v[40:43], v[12:15], a[64:71], v3
  v_smfmac_f32_16x16x64_bf16 v[44:47], v[12:15], a[120:127], v3
  v_smfmac_f32_16x16x64_bf16 v[48:51], v[12:15], a[176:183], v3
  v_smfmac_f32_16x16x64_bf16 v[52:55], v[12:15], a[232:239], v3
  s_waitcnt vmcnt(4)
  v_cmp_eq_u32 vcc, -1, v16
  v_smfmac_f32_16x16x64_bf16 v[56:59], v[12:15], v[152:159], v3
  buffer_load_dwordx4 v[88:91], v117, s[8:11], s26 offen offset:0 sc1
  v_smfmac_f32_16x16x64_bf16 v[60:63], v[12:15], v[208:215], v3
  s_cbranch_vccnz cB_sc0_r2
cB_sc0_c2:
  v_smfmac_f32_16x16x64_bf16 v[36:39], v[16:19], a[16:23], v3
  v_smfmac_f32_16x16x64_bf16 v[40:43], v[16:19], a[72:79], v3
  v_smfmac_f32_16x16x64_bf16 v[44:47], v[16:19], a[128:135], v3
  buffer_load_dwordx4 v[92:95], v117, s[8:11], s26 offen offset:1024 sc1
  v_smfmac_f32_16x16x64_bf16 v[48:51], v[16:19], a[184:191], v3
  v_smfmac_f32_16x16x64_bf16 v[52:55], v[16:19], a[240:247], v3
  s_waitcnt vmcnt(5)
  v_cmp_eq_u32 vcc, -1, v20
  v_smfmac_f32_16x16x64_bf16 v[56:59], v[16:19], v[160:167], v3
  v_smfmac_f32_16x16x64_bf16 v[60:63], v[16:19], v[216:223], v3
  buffer_load_dwordx4 v[96:99], v2, s[8:11], s24 offen offset:0 sc1
  s_cbranch_vccnz cB_sc0_r3
cB_sc0_c3:
  v_smfmac_f32_16x16x64_bf16 v[36:39], v[20:23], a[24:31], v3
  v_smfmac_f32_16x16x64_bf16 v[40:43], v[20:23], a[80:87], v3
  s_waitcnt vmcnt(3)
  v_max3_u32 v66, v24, v27, v28
  v_smfmac_f32_16x16x64_bf16 v[44:47], v[20:23], a[136:143], v3
  v_max3_u32 v66, v66, v31, v32
  v_smfmac_f32_16x16x64_bf16 v[48:51], v[20:23], a[192:199], v3
  buffer_load_dwordx4 v[100:103], v2, s[8:11], s24 offen offset:1024 sc1
  v_max_u32 v66, v66, v35
  v_smfmac_f32_16x16x64_bf16 v[52:55], v[20:23], a[248:255], v3
  v_cmp_eq_u32 vcc, -1, v66
  v_smfmac_f32_16x16x64_bf16 v[56:59], v[20:23], v[168:175], v3
  v_smfmac_f32_16x16x64_bf16 v[60:63], v[20:23], v[224:231], v3
  s_cbranch_vccnz cB_sc0_r4
cB_sc0_c4:
  v_smfmac_f32_16x16x64_bf16 v[60:63], v[32:35], v[232:239], v3
  buffer_load_dwordx4 v[104:107], v2, s[8:11], s26 offen offset:0 sc1
  v_smfmac_f32_16x16x64_bf16 v[60:63], v[24:27], v[240:247], v3
  v_smfmac_f32_16x16x64_bf16 v[60:63], v[28:31], v[248:255], v3
  v_smfmac_f32_16x16x64_bf16 v[52:55], v[32:35], v[120:127], v3
  v_smfmac_f32_16x16x64_bf16 v[52:55], v[24:27], v[128:135], v3
  buffer_load_dwordx4 v[108:111], v2, s[8:11], s26 offen offset:1024 sc1
  v_smfmac_f32_16x16x64_bf16 v[52:55], v[28:31], v[136:143], v3
  v_cvt_pk_bf16_f32 v63, v62, v63
  v_smfmac_f32_16x16x64_bf16 v[56:59], v[32:35], v[176:183], v3
  v_cvt_pk_bf16_f32 v62, v60, v61
  v_smfmac_f32_16x16x64_bf16 v[56:59], v[24:27], v[184:191], v3
  v_mfma_f32_16x16x32_bf16 v[12:15], v[62:65], v[4:7], 0
  v_cvt_pk_bf16_f32 v55, v54, v55
  v_smfmac_f32_16x16x64_bf16 v[56:59], v[28:31], v[192:199], v3
  v_cvt_pk_bf16_f32 v54, v52, v53
  v_smfmac_f32_16x16x64_bf16 v[36:39], v[32:35], a[32:39], v3
  s_nop 1
  v_cvt_pk_bf16_f32 v76, v12, v13
  v_smfmac_f32_16x16x64_bf16 v[36:39], v[24:27], a[40:47], v3
  v_cvt_pk_bf16_f32 v77, v14, v15
  v_smfmac_f32_16x16x64_bf16 v[36:39], v[28:31], a[48:55], v3
  v_cvt_pk_bf16_f32 v56, v56, v57
  v_smfmac_f32_16x16x64_bf16 v[40:43], v[32:35], a[88:95], v3
  v_cvt_pk_bf16_f32 v57, v58, v59
  v_smfmac_f32_16x16x64_bf16 v[40:43], v[24:27], a[96:103], v3
  v_mfma_f32_16x16x32_bf16 v[16:19], v[54:57], v[4:7], 0
  v_cvt_pk_bf16_f32 v39, v38, v39
  v_smfmac_f32_16x16x64_bf16 v[40:43], v[28:31], a[104:111], v3
  v_cvt_pk_bf16_f32 v38, v36, v37
  v_smfmac_f32_16x16x64_bf16 v[44:47], v[32:35], a[144:151], v3
  s_nop 1
  v_cvt_pk_bf16_f32 v78, v16, v17
  v_smfmac_f32_16x16x64_bf16 v[44:47], v[24:27], a[152:159], v3
  v_cvt_pk_bf16_f32 v79, v18, v19
  v_smfmac_f32_16x16x64_bf16 v[44:47], v[28:31], a[160:167], v3
  v_cvt_pk_bf16_f32 v40, v40, v41
  v_smfmac_f32_16x16x64_bf16 v[48:51], v[32:35], a[200:207], v3
  v_cvt_pk_bf16_f32 v41, v42, v43
  v_smfmac_f32_16x16x64_bf16 v[48:51], v[24:27], a[208:215], v3
  v_smfmac_f32_16x16x64_bf16 v[48:51], v[28:31], a[216:223], v3
  s_waitcnt vmcnt(4)
  v_cvt_pk_bf16_f32 v47, v46, v47
  v_smfmac_f32_16x16x64_bf16 v[68:71], v[76:79], v[80:87], v3
  v_cvt_pk_bf16_f32 v46, v44, v45
  v_mfma_f32_16x16x32_bf16 v[12:15], v[38:41], v[4:7], 0
  s_nop 1
  v_cvt_pk_bf16_f32 v48, v48, v49
  v_cvt_pk_bf16_f32 v49, v50, v51
  s_nop 1
  v_mfma_f32_16x16x32_bf16 v[16:19], v[46:49], v[4:7], 0
  v_smfmac_f32_16x16x64_bf16 v[72:75], v[76:79], v[88:95], v3
  v_cvt_pk_bf16_f32 v20, v12, v13
  v_mfma_f32_16x16x32_bf16 v[52:55], v[30:33], v[76:79], 0
  s_waitcnt vmcnt(0)
  v_cvt_pk_bf16_f32 v21, v14, v15
  v_cvt_pk_bf16_f32 v22, v16, v17
  v_cvt_pk_bf16_f32 v23, v18, v19
  s_nop 1
  v_mfma_f32_16x16x32_bf16 v[52:55], v[8:11], v[20:23], v[52:55]
  v_smfmac_f32_16x16x64_bf16 v[68:71], v[20:23], v[96:103], v3
  v_smfmac_f32_16x16x64_bf16 v[72:75], v[20:23], v[104:111], v3
  s_nop 1
  ds_write_b128 v113, v[52:55]
  s_nop 1
  v_permlane32_swap_b32 v68, v70
  v_permlane32_swap_b32 v69, v71
  v_add_f32 v56, v68, v70
  v_add_f32 v58, v69, v71
  v_permlane32_swap_b32 v72, v74
  v_permlane32_swap_b32 v73, v75
  v_add_f32 v57, v72, v74
  v_add_f32 v59, v73, v75
  ds_write_b128 v2, v[56:59] offset:0
  v_cmp_u_f32 vcc, v57, v59
  v_mov_b32 v68, 0
  v_mov_b32 v69, 0
  v_mov_b32 v70, 0
  v_mov_b32 v71, 0
  s_cbranch_vccnz cB_sc0_retry
cB_sc0_cont:
  s_add_u32 s24, s24, 28672
  s_add_u32 s26, s26, 28672
  buffer_load_dwordx4 v[80:83], v117, s[8:11], s24 offen offset:0 sc1
  buffer_load_dwordx4 v[84:87], v117, s[8:11], s24 offen offset:1024 sc1
  v_mov_b32 v72, 0
  v_mov_b32 v73, 0
  v_mfma_f32_32x32x16_bf16 v[36:51], v[68:71], v[68:71], 0
  s_waitcnt lgkmcnt(0)
  s_barrier
  ds_read_b64 v[8:9], v114 offset:0
  ds_read_b64 v[10:11], v114 offset:1024
  ds_read_b64 v[12:13], v114 offset:2048
  ds_read_b64 v[14:15], v114 offset:3072
  ds_read2_b32 v[16:17], v115 offset0:0 offset1:64
  ds_read2_b32 v[18:19], v115 offset0:128 offset1:192
  v_mfma_f32_32x32x16_bf16 v[52:67], v[68:71], v[68:71], 0
  s_waitcnt lgkmcnt(0)
  v_pk_add_f32 v[16:17], v[16:17], v[18:19]
  v_pk_add_f32 v[8:9], v[8:9], v[10:11]
  v_pk_add_f32 v[12:13], v[12:13], v[14:15]
  v_add_f32 v20, v16, v17
  v_pk_add_f32 v[8:9], v[8:9], v[12:13]
  v_max_f32 v22, v8, v9
  v_add_f32_dpp v20, v20, v20 row_ror:8 row_mask:0xf bank_mask:0xf
  s_nop 0
  v_max_f32_dpp v22, v22, v22 row_ror:8 row_mask:0xf bank_mask:0xf
  v_max_f32 v22, v22, v20
  s_nop 1
  v_max_f32_dpp v22, v22, v22 quad_perm:[1,0,3,2] row_mask:0xf bank_mask:0xf
  s_nop 1
  v_max_f32_dpp v22, v22, v22 quad_perm:[2,3,0,1] row_mask:0xf bank_mask:0xf
  s_nop 1
  v_max_f32_dpp v22, v22, v22 row_half_mirror row_mask:0xf bank_mask:0xf
  v_pk_add_f32 v[8:9], v[8:9], v[22:23] op_sel_hi:[1,0] neg_lo:[0,1] neg_hi:[0,1]
  v_sub_f32 v20, v20, v22
  v_exp_f32 v8, v8
  v_exp_f32 v9, v9
  v_exp_f32 v20, v20
  v_add_f32 v24, v8, v9
  v_fmac_f32 v24, 0.5, v20
  v_mov_b32_dpp v21, v20 quad_perm:[1,0,3,2] row_mask:0xf bank_mask:0xf
  s_nop 0
  v_add_f32_dpp v24, v24, v24 quad_perm:[1,0,3,2] row_mask:0xf bank_mask:0xf
  s_nop 1
  v_add_f32_dpp v24, v24, v24 quad_perm:[2,3,0,1] row_mask:0xf bank_mask:0xf
  s_nop 1
  v_add_f32_dpp v24, v24, v24 row_half_mirror row_mask:0xf bank_mask:0xf
  s_nop 1
  v_add_f32_dpp v24, v24, v24 row_ror:8 row_mask:0xf bank_mask:0xf
  v_rcp_f32 v24, v24
  s_nop 0
  v_pk_mul_f32 v[8:9], v[8:9], v[24:25] op_sel_hi:[1,0]
  v_pk_mul_f32 v[20:21], v[20:21], v[24:25] op_sel_hi:[1,0]
  v_cvt_pk_bf16_f32 v8, v8, v9
  v_cvt_pk_bf16_f32 v20, v20, v21
  v_min_u32 v8, -2, v8
  buffer_store_dword v8, v1, s[8:11], s20 offen sc1
  v_min_u32 v20, -2, v20
  buffer_store_dword v20, v118, s[8:11], s20 offen sc1
  buffer_store_dword v119, v1, s[8:11], s21 offen sc1
  buffer_store_dword v119, v118, s[8:11], s21 offen sc1
  v_mov_b32 v74, 0
  v_mov_b32 v75, 0
  s_mov_b32 s19, s18
  s_add_u32 s18, s18, 1
  s_mov_b32 s22, s20
  s_mov_b32 s20, s21
  s_mov_b32 s21, s22
  s_add_u32 s23, s20, 4096
  s_cmp_lt_u32 s19, 63
  s_cbranch_scc1 cB_sc0_loop
  s_branch cB_done
cB_sc0_r0:
  s_add_u32 s31, s31, 1
  buffer_load_dwordx4 v[8:11], v2, s[8:11], s20 offen offset:0 sc1
  s_waitcnt vmcnt(0)
  v_cmp_eq_u32 vcc, -1, v8
  v_mov_b32 v36, 0
  v_mov_b32 v37, 0
  v_mov_b32 v38, 0
  v_mov_b32 v39, 0
  v_mov_b32 v40, 0
  v_mov_b32 v41, 0
  v_mov_b32 v42, 0
  v_mov_b32 v43, 0
  v_mov_b32 v44, 0
  v_mov_b32 v45, 0
  v_mov_b32 v46, 0
  v_mov_b32 v47, 0
  v_mov_b32 v48, 0
  v_mov_b32 v49, 0
  v_mov_b32 v50, 0
  v_mov_b32 v51, 0
  s_nop 1
  s_cbranch_vccz cB_sc0_go
  s_add_u32 s30, s30, 1
  s_cmp_lt_u32 s30, 400000
  s_cbranch_scc1 cB_sc0_r0
  s_branch cB_abort
cB_sc0_r1:
  s_add_u32 s31, s31, 1
  buffer_load_dwordx4 v[12:15], v2, s[8:11], s20 offen offset:1024 sc1
  s_waitcnt vmcnt(0)
  v_cmp_eq_u32 vcc, -1, v12
  s_nop 4
  s_cbranch_vccz cB_sc0_c1
  s_add_u32 s30, s30, 1
  s_cmp_lt_u32 s30, 400000
  s_cbranch_scc1 cB_sc0_r1
  s_branch cB_abort
cB_sc0_r2:
  s_add_u32 s31, s31, 1
  buffer_load_dwordx4 v[16:19], v2, s[8:11], s20 offen offset:2048 sc1
  s_waitcnt vmcnt(0)
  v_cmp_eq_u32 vcc, -1, v16
  s_nop 4
  s_cbranch_vccz cB_sc0_c2
  s_add_u32 s30, s30, 1
  s_cmp_lt_u32 s30, 400000
  s_cbranch_scc1 cB_sc0_r2
  s_branch cB_abort
cB_sc0_r3:
  s_add_u32 s31, s31, 1
  buffer_load_dwordx4 v[20:23], v2, s[8:11], s20 offen offset:3072 sc1
  s_waitcnt vmcnt(0)
  v_cmp_eq_u32 vcc, -1, v20
  s_nop 4
  s_cbranch_vccz cB_sc0_c3
  s_add_u32 s30, s30, 1
  s_cmp_lt_u32 s30, 400000
  s_cbranch_scc1 cB_sc0_r3
  s_branch cB_abort
cB_sc0_r4:
  s_add_u32 s31, s31, 1
  buffer_load_dwordx4 v[32:35], v2, s[8:11], s23 offen offset:0 sc1
  buffer_load_dwordx4 v[24:27], v2, s[8:11], s23 offen offset:1024 sc1
  buffer_load_dwordx4 v[28:31], v2, s[8:11], s23 offen offset:2048 sc1
  s_waitcnt vmcnt(0)
  v_max3_u32 v66, v24, v27, v28
  v_max3_u32 v66, v66, v31, v32
  v_max_u32 v66, v66, v35
  v_cmp_eq_u32 vcc, -1, v66
  s_nop 4
  s_cbranch_vccz cB_sc0_c4
  s_add_u32 s30, s30, 1
  s_cmp_lt_u32 s30, 400000
  s_cbranch_scc1 cB_sc0_r4
  s_branch cB_abort
cB_sc0_retry:
  s_cmp_lg_u32 s62, 0
  s_cbranch_scc1 cB_sc0_cont
  s_waitcnt vmcnt(0) lgkmcnt(0)
cB_sc0_rv:
  buffer_load_dwordx4 v[8:11], v2, s[8:11], s20 offen offset:0 sc1
  buffer_load_dwordx4 v[12:15], v2, s[8:11], s20 offen offset:1024 sc1
  buffer_load_dwordx4 v[16:19], v2, s[8:11], s20 offen offset:2048 sc1
  buffer_load_dwordx4 v[20:23], v2, s[8:11], s20 offen offset:3072 sc1
  buffer_load_dwordx4 v[32:35], v2, s[8:11], s23 offen offset:0 sc1
  buffer_load_dwordx4 v[24:27], v2, s[8:11], s23 offen offset:1024 sc1
  buffer_load_dwordx4 v[28:31], v2, s[8:11], s23 offen offset:2048 sc1
  s_waitcnt vmcnt(0)
  v_pk_max_u16 v66, v8, v9
  v_pk_max_u16 v66, v66, v10
  v_pk_max_u16 v66, v66, v11
  v_pk_max_u16 v66, v66, v12
  v_pk_max_u16 v66, v66, v13
  v_pk_max_u16 v66, v66, v14
  v_pk_max_u16 v66, v66, v15
  v_pk_max_u16 v66, v66, v16
  v_pk_max_u16 v66, v66, v17
  v_pk_max_u16 v66, v66, v18
  v_pk_max_u16 v66, v66, v19
  v_pk_max_u16 v66, v66, v20
  v_pk_max_u16 v66, v66, v21
  v_pk_max_u16 v66, v66, v22
  v_pk_max_u16 v66, v66, v23
  v_pk_max_u16 v66, v66, v24
  v_pk_max_u16 v66, v66, v25
  v_pk_max_u16 v66, v66, v26
  v_pk_max_u16 v66, v66, v27
  v_pk_max_u16 v66, v66, v28
  v_pk_max_u16 v66, v66, v29
  v_pk_max_u16 v66, v66, v30
  v_pk_max_u16 v66, v66, v31
  v_pk_max_u16 v66, v66, v32
  v_pk_max_u16 v66, v66, v33
  v_pk_max_u16 v66, v66, v34
  v_pk_max_u16 v66, v66, v35
  v_lshlrev_b32 v67, 16, v66
  v_max_u32 v66, v66, v67
  v_cmp_le_u32 vcc, 0xffff0000, v66
  s_cbranch_vccz cB_sc0_rk
  s_add_u32 s30, s30, 1
  s_cmp_lt_u32 s30, 400000
  s_cbranch_scc1 cB_sc0_rv
  s_branch cB_abort
cB_sc0_rk:
  s_mov_b32 s62, 1
  v_mov_b32 v36, 0
  v_mov_b32 v37, 0
  v_mov_b32 v38, 0
  v_mov_b32 v39, 0
  v_mov_b32 v40, 0
  v_mov_b32 v41, 0
  v_mov_b32 v42, 0
  v_mov_b32 v43, 0
  v_mov_b32 v44, 0
  v_mov_b32 v45, 0
  v_mov_b32 v46, 0
  v_mov_b32 v47, 0
  v_mov_b32 v48, 0
  v_mov_b32 v49, 0
  v_mov_b32 v50, 0
  v_mov_b32 v51, 0
  v_mov_b32 v60, 0
  v_mov_b32 v61, 0
  v_mov_b32 v62, 0
  v_mov_b32 v63, 0
  v_mov_b32 v68, 0
  v_mov_b32 v69, 0
  v_mov_b32 v70, 0
  v_mov_b32 v71, 0
  v_mov_b32 v72, 0
  v_mov_b32 v73, 0
  v_mov_b32 v74, 0
  v_mov_b32 v75, 0
  v_mov_b32 v52, 0
  v_mov_b32 v53, 0
  v_mov_b32 v54, 0
  v_mov_b32 v55, 0
  v_mov_b32 v56, 0
  v_mov_b32 v57, 0
  v_mov_b32 v58, 0
  v_mov_b32 v59, 0
  s_add_u32 s31, s31, 0x100
  s_nop 0
  s_branch cB_sc0_go
.p2align 6
cB_sc1_loop:
  s_mov_b32 s30, 0
  s_mov_b32 s62, 0
  s_setprio 3
  s_barrier
  buffer_load_dwordx4 v[8:11], v2, s[8:11], s20 offen offset:0 sc1
  s_setprio 2
  buffer_load_dwordx4 v[12:15], v2, s[8:11], s20 offen offset:1024 sc1
  s_setprio 1
  buffer_load_dwordx4 v[16:19], v2, s[8:11], s20 offen offset:2048 sc1
  s_setprio 0
  buffer_load_dwordx4 v[20:23], v2, s[8:11], s20 offen offset:3072 sc1
cB_sc1_go:
  s_waitcnt vmcnt(3)
  v_smfmac_f32_16x16x64_bf16 v[36:39], v[8:11], a[0:7], v3
  buffer_load_dwordx4 v[28:31], v2, s[8:11], s23 offen offset:0 sc1
  v_cmp_eq_u32 vcc, -1, v8
  v_smfmac_f32_16x16x64_bf16 v[40:43], v[8:11], a[56:63], v3
  v_smfmac_f32_16x16x64_bf16 v[44:47], v[8:11], a[112:119], v3
  buffer_load_dwordx4 v[24:27], v2, s[8:11], s23 offen offset:1024 sc1
  s_cbranch_vccnz cB_sc1_r0
  v_smfmac_f32_16x16x64_bf16 v[48:51], v[8:11], a[168:175], v3
  v_smfmac_f32_16x16x64_bf16 v[52:55], v[8:11], a[224:231], v3
  s_waitcnt vmcnt(4)
  v_cmp_eq_u32 vcc, -1, v12
  v_smfmac_f32_16x16x64_bf16 v[56:59], v[8:11], v[144:151], v3
  buffer_load_dwordx4 v[32:35], v2, s[8:11], s23 offen offset:2048 sc1
  v_smfmac_f32_16x16x64_bf16 v[60:63], v[8:11], v[200:207], v3
  s_cbranch_vccnz cB_sc1_r1
cB_sc1_c1:
  v_smfmac_f32_16x16x64_bf16 v[36:39], v[12:15], a[8:15], v3
  v_smfmac_f32_16x16x64_bf16 v[40:43], v[12:15], a[64:71], v3
  v_smfmac_f32_16x16x64_bf16 v[44:47], v[12:15], a[120:127], v3
  v_smfmac_f32_16x16x64_bf16 v[48:51], v[12:15], a[176:183], v3
  v_smfmac_f32_16x16x64_bf16 v[52:55], v[12:15], a[232:239], v3
  s_waitcnt vmcnt(4)
  v_cmp_eq_u32 vcc, -1, v16
  v_smfmac_f32_16x16x64_bf16 v[56:59], v[12:15], v[152:159], v3
  buffer_load_dwordx4 v[88:91], v117, s[8:11], s26 offen offset:0 sc1
  v_smfmac_f32_16x16x64_bf16 v[60:63], v[12:15], v[208:215], v3
  s_cbranch_vccnz cB_sc1_r2
cB_sc1_c2:
  v_smfmac_f32_16x16x64_bf16 v[36:39], v[16:19], a[16:23], v3
  v_smfmac_f32_16x16x64_bf16 v[40:43], v[16:19], a[72:79], v3
  v_smfmac_f32_16x16x64_bf16 v[44:47], v[16:19], a[128:135], v3
  buffer_load_dwordx4 v[92:95], v117, s[8:11], s26 offen offset:1024 sc1
  v_smfmac_f32_16x16x64_bf16 v[48:51], v[16:19], a[184:191], v3
  v_smfmac_f32_16x16x64_bf16 v[52:55], v[16:19], a[240:247], v3
  s_waitcnt vmcnt(5)
  v_cmp_eq_u32 vcc, -1, v20
  v_smfmac_f32_16x16x64_bf16 v[56:59], v[16:19], v[160:167], v3
  v_smfmac_f32_16x16x64_bf16 v[60:63], v[16:19], v[216:223], v3
  buffer_load_dwordx4 v[96:99], v2, s[8:11], s24 offen offset:0 sc1
  s_cbranch_vccnz cB_sc1_r3
cB_sc1_c3:
  v_smfmac_f32_16x16x64_bf16 v[36:39], v[20:23], a[24:31], v3
  v_smfmac_f32_16x16x64_bf16 v[40:43], v[20:23], a[80:87], v3
  s_waitcnt vmcnt(3)
  v_max3_u32 v66, v24, v27, v28
  v_smfmac_f32_16x16x64_bf16 v[44:47], v[20:23], a[136:143], v3
  v_max3_u32 v66, v66, v31, v32
  v_smfmac_f32_16x16x64_bf16 v[48:51], v[20:23], a[192:199], v3
  buffer_load_dwordx4 v[100:103], v2, s[8:11], s24 offen offset:1024 sc1
  v_max_u32 v66, v66, v35
  v_smfmac_f32_16x16x64_bf16 v[52:55], v[20:23], a[248:255], v3
  v_cmp_eq_u32 vcc, -1, v66
  v_smfmac_f32_16x16x64_bf16 v[56:59], v[20:23], v[168:175], v3
  v_smfmac_f32_16x16x64_bf16 v[60:63], v[20:23], v[224:231], v3
  s_cbranch_vccnz cB_sc1_r4
cB_sc1_c4:
  v_smfmac_f32_16x16x64_bf16 v[60:63], v[28:31], v[232:239], v3
  buffer_load_dwordx4 v[104:107], v2, s[8:11], s26 offen offset:0 sc1
  v_smfmac_f32_16x16x64_bf16 v[60:63], v[24:27], v[240:247], v3
  v_smfmac_f32_16x16x64_bf16 v[60:63], v[32:35], v[248:255], v3
  v_smfmac_f32_16x16x64_bf16 v[52:55], v[28:31], v[120:127], v3
  v_smfmac_f32_16x16x64_bf16 v[52:55], v[24:27], v[128:135], v3
  buffer_load_dwordx4 v[108:111], v2, s[8:11], s26 offen offset:1024 sc1
  v_smfmac_f32_16x16x64_bf16 v[52:55], v[32:35], v[136:143], v3
  v_cvt_pk_bf16_f32 v63, v62, v63
  v_smfmac_f32_16x16x64_bf16 v[56:59], v[28:31], v[176:183], v3
  v_cvt_pk_bf16_f32 v62, v60, v61
  v_smfmac_f32_16x16x64_bf16 v[56:59], v[24:27], v[184:191], v3
  v_mfma_f32_16x16x32_bf16 v[8:11], v[62:65], v[4:7], 0
  v_cvt_pk_bf16_f32 v55, v54, v55
  v_smfmac_f32_16x16x64_bf16 v[56:59], v[32:35], v[192:199], v3
  v_cvt_pk_bf16_f32 v54, v52, v53
  v_smfmac_f32_16x16x64_bf16 v[36:39], v[28:31], a[32:39], v3
  s_nop 1
  v_cvt_pk_bf16_f32 v78, v8, v9
  v_smfmac_f32_16x16x64_bf16 v[36:39], v[24:27], a[40:47], v3
  v_cvt_pk_bf16_f32 v79, v10, v11
  v_smfmac_f32_16x16x64_bf16 v[36:39], v[32:35], a[48:55], v3
  v_cvt_pk_bf16_f32 v56, v56, v57
  v_smfmac_f32_16x16x64_bf16 v[40:43], v[28:31], a[88:95], v3
  v_cvt_pk_bf16_f32 v57, v58, v59
  v_smfmac_f32_16x16x64_bf16 v[40:43], v[24:27], a[96:103], v3
  v_mfma_f32_16x16x32_bf16 v[16:19], v[54:57], v[4:7], 0
  v_cvt_pk_bf16_f32 v39, v38, v39
  v_smfmac_f32_16x16x64_bf16 v[40:43], v[32:35], a[104:111], v3
  v_cvt_pk_bf16_f32 v38, v36, v37
  v_smfmac_f32_16x16x64_bf16 v[44:47], v[28:31], a[144:151], v3
  s_nop 1
  v_cvt_pk_bf16_f32 v76, v16, v17
  v_smfmac_f32_16x16x64_bf16 v[44:47], v[24:27], a[152:159], v3
  v_cvt_pk_bf16_f32 v77, v18, v19
  v_smfmac_f32_16x16x64_bf16 v[44:47], v[32:35], a[160:167], v3
  v_cvt_pk_bf16_f32 v40, v40, v41
  v_smfmac_f32_16x16x64_bf16 v[48:51], v[28:31], a[200:207], v3
  v_cvt_pk_bf16_f32 v41, v42, v43
  v_smfmac_f32_16x16x64_bf16 v[48:51], v[24:27], a[208:215], v3
  v_smfmac_f32_16x16x64_bf16 v[48:51], v[32:35], a[216:223], v3
  s_waitcnt vmcnt(4)
  v_cvt_pk_bf16_f32 v47, v46, v47
  v_smfmac_f32_16x16x64_bf16 v[68:71], v[76:79], v[80:87], v3
  v_cvt_pk_bf16_f32 v46, v44, v45
  v_mfma_f32_16x16x32_bf16 v[8:11], v[38:41], v[4:7], 0
  s_nop 1
  v_cvt_pk_bf16_f32 v48, v48, v49
  v_cvt_pk_bf16_f32 v49, v50, v51
  s_nop 1
  v_mfma_f32_16x16x32_bf16 v[16:19], v[46:49], v[4:7], 0
  v_smfmac_f32_16x16x64_bf16 v[72:75], v[76:79], v[88:95], v3
  v_cvt_pk_bf16_f32 v20, v8, v9
  v_mfma_f32_16x16x32_bf16 v[52:55], v[30:33], v[76:79], 0
  s_waitcnt vmcnt(0)
  v_cvt_pk_bf16_f32 v21, v10, v11
  v_cvt_pk_bf16_f32 v22, v16, v17
  v_cvt_pk_bf16_f32 v23, v18, v19
  s_nop 1
  v_mfma_f32_16x16x32_bf16 v[52:55], v[12:15], v[20:23], v[52:55]
  v_smfmac_f32_16x16x64_bf16 v[68:71], v[20:23], v[96:103], v3
  v_smfmac_f32_16x16x64_bf16 v[72:75], v[20:23], v[104:111], v3
  s_nop 1
  ds_write_b128 v113, v[52:55]
  s_nop 1
  v_permlane32_swap_b32 v68, v70
  v_permlane32_swap_b32 v69, v71
  v_add_f32 v56, v68, v70
  v_add_f32 v58, v69, v71
  v_permlane32_swap_b32 v72, v74
  v_permlane32_swap_b32 v73, v75
  v_add_f32 v57, v72, v74
  v_add_f32 v59, v73, v75
  ds_write_b128 v2, v[56:59] offset:1024
  v_cmp_u_f32 vcc, v57, v59
  v_mov_b32 v68, 0
  v_mov_b32 v69, 0
  v_mov_b32 v70, 0
  v_mov_b32 v71, 0
  s_cbranch_vccnz cB_sc1_retry
cB_sc1_cont:
  s_add_u32 s24, s24, 28672
  s_add_u32 s26, s26, 28672
  buffer_load_dwordx4 v[80:83], v117, s[8:11], s24 offen offset:0 sc1
  buffer_load_dwordx4 v[84:87], v117, s[8:11], s24 offen offset:1024 sc1
  v_mov_b32 v72, 0
  v_mov_b32 v73, 0
  v_mfma_f32_32x32x16_bf16 v[36:51], v[68:71], v[68:71], 0
  s_waitcnt lgkmcnt(0)
  s_barrier
  ds_read_b64 v[8:9], v114 offset:0
  ds_read_b64 v[10:11], v114 offset:1024
  ds_read_b64 v[12:13], v114 offset:2048
  ds_read_b64 v[14:15], v114 offset:3072
  ds_read2_b32 v[16:17], v115 offset0:0 offset1:64
  ds_read2_b32 v[18:19], v115 offset0:128 offset1:192
  v_mfma_f32_32x32x16_bf16 v[52:67], v[68:71], v[68:71], 0
  s_waitcnt lgkmcnt(0)
  v_pk_add_f32 v[16:17], v[16:17], v[18:19]
  v_pk_add_f32 v[8:9], v[8:9], v[10:11]
  v_pk_add_f32 v[12:13], v[12:13], v[14:15]
  v_add_f32 v20, v16, v17
  v_pk_add_f32 v[8:9], v[8:9], v[12:13]
  v_max_f32 v22, v8, v9
  v_add_f32_dpp v20, v20, v20 row_ror:8 row_mask:0xf bank_mask:0xf
  s_nop 0
  v_max_f32_dpp v22, v22, v22 row_ror:8 row_mask:0xf bank_mask:0xf
  v_max_f32 v22, v22, v20
  s_nop 1
  v_max_f32_dpp v22, v22, v22 quad_perm:[1,0,3,2] row_mask:0xf bank_mask:0xf
  s_nop 1
  v_max_f32_dpp v22, v22, v22 quad_perm:[2,3,0,1] row_mask:0xf bank_mask:0xf
  s_nop 1
  v_max_f32_dpp v22, v22, v22 row_half_mirror row_mask:0xf bank_mask:0xf
  v_pk_add_f32 v[8:9], v[8:9], v[22:23] op_sel_hi:[1,0] neg_lo:[0,1] neg_hi:[0,1]
  v_sub_f32 v20, v20, v22
  v_exp_f32 v8, v8
  v_exp_f32 v9, v9
  v_exp_f32 v20, v20
  buffer_store_dword v112, v116, s[8:11], 0 offen sc1
  v_add_f32 v24, v8, v9
  v_fmac_f32 v24, 0.5, v20
  v_mov_b32_dpp v21, v20 quad_perm:[1,0,3,2] row_mask:0xf bank_mask:0xf
  s_nop 0
  v_add_f32_dpp v24, v24, v24 quad_perm:[1,0,3,2] row_mask:0xf bank_mask:0xf
  s_nop 1
  v_add_f32_dpp v24, v24, v24 quad_perm:[2,3,0,1] row_mask:0xf bank_mask:0xf
  s_nop 1
  v_add_f32_dpp v24, v24, v24 row_half_mirror row_mask:0xf bank_mask:0xf
  s_nop 1
  v_add_f32_dpp v24, v24, v24 row_ror:8 row_mask:0xf bank_mask:0xf
  v_rcp_f32 v24, v24
  s_nop 0
  v_pk_mul_f32 v[8:9], v[8:9], v[24:25] op_sel_hi:[1,0]
  v_pk_mul_f32 v[20:21], v[20:21], v[24:25] op_sel_hi:[1,0]
  v_cvt_pk_bf16_f32 v8, v8, v9
  v_cvt_pk_bf16_f32 v20, v20, v21
  v_min_u32 v8, -2, v8
  buffer_store_dword v8, v1, s[8:11], s20 offen sc1
  v_min_u32 v20, -2, v20
  buffer_store_dword v20, v118, s[8:11], s20 offen sc1
  buffer_store_dword v119, v1, s[8:11], s21 offen sc1
  buffer_store_dword v119, v118, s[8:11], s21 offen sc1
  v_mov_b32 v74, 0
  v_mov_b32 v75, 0
  s_mov_b32 s19, s18
  s_add_u32 s18, s18, 1
  s_mov_b32 s22, s20
  s_mov_b32 s20, s21
  s_mov_b32 s21, s22
  s_add_u32 s23, s20, 4096
  v_mov_b32 v112, s18
  s_cmp_lt_u32 s19, 63
  s_nop 0
  s_cbranch_scc1 cB_sc1_loop
  s_branch cB_done
cB_sc1_r0:
  s_add_u32 s31, s31, 1
  buffer_load_dwordx4 v[8:11], v2, s[8:11], s20 offen offset:0 sc1
  s_waitcnt vmcnt(0)
  v_cmp_eq_u32 vcc, -1, v8
  v_mov_b32 v36, 0
  v_mov_b32 v37, 0
  v_mov_b32 v38, 0
  v_mov_b32 v39, 0
  v_mov_b32 v40, 0
  v_mov_b32 v41, 0
  v_mov_b32 v42, 0
  v_mov_b32 v43, 0
  v_mov_b32 v44, 0
  v_mov_b32 v45, 0
  v_mov_b32 v46, 0
  v_mov_b32 v47, 0
  v_mov_b32 v48, 0
  v_mov_b32 v49, 0
  v_mov_b32 v50, 0
  v_mov_b32 v51, 0
  s_nop 1
  s_cbranch_vccz cB_sc1_go
  s_add_u32 s30, s30, 1
  s_cmp_lt_u32 s30, 400000
  s_cbranch_scc1 cB_sc1_r0
  s_branch cB_abort
cB_sc1_r1:
  s_add_u32 s31, s31, 1
  buffer_load_dwordx4 v[12:15], v2, s[8:11], s20 offen offset:1024 sc1
  s_waitcnt vmcnt(0)
  v_cmp_eq_u32 vcc, -1, v12
  s_nop 4
  s_cbranch_vccz cB_sc1_c1
  s_add_u32 s30, s30, 1
  s_cmp_lt_u32 s30, 400000
  s_cbranch_scc1 cB_sc1_r1
  s_branch cB_abort
cB_sc1_r2:
  s_add_u32 s31, s31, 1
  buffer_load_dwordx4 v[16:19], v2, s[8:11], s20 offen offset:2048 sc1
  s_waitcnt vmcnt(0)
  v_cmp_eq_u32 vcc, -1, v16
  s_nop 4
  s_cbranch_vccz cB_sc1_c2
  s_add_u32 s30, s30, 1
  s_cmp_lt_u32 s30, 400000
  s_cbranch_scc1 cB_sc1_r2
  s_branch cB_abort
cB_sc1_r3:
  s_add_u32 s31, s31, 1
  buffer_load_dwordx4 v[20:23], v2, s[8:11], s20 offen offset:3072 sc1
  s_waitcnt vmcnt(0)
  v_cmp_eq_u32 vcc, -1, v20
  s_nop 4
  s_cbranch_vccz cB_sc1_c3
  s_add_u32 s30, s30, 1
  s_cmp_lt_u32 s30, 400000
  s_cbranch_scc1 cB_sc1_r3
  s_branch cB_abort
cB_sc1_r4:
  s_add_u32 s31, s31, 1
  buffer_load_dwordx4 v[28:31], v2, s[8:11], s23 offen offset:0 sc1
  buffer_load_dwordx4 v[24:27], v2, s[8:11], s23 offen offset:1024 sc1
  buffer_load_dwordx4 v[32:35], v2, s[8:11], s23 offen offset:2048 sc1
  s_waitcnt vmcnt(0)
  v_max3_u32 v66, v24, v27, v28
  v_max3_u32 v66, v66, v31, v32
  v_max_u32 v66, v66, v35
  v_cmp_eq_u32 vcc, -1, v66
  s_nop 4
  s_cbranch_vccz cB_sc1_c4
  s_add_u32 s30, s30, 1
  s_cmp_lt_u32 s30, 400000
  s_cbranch_scc1 cB_sc1_r4
  s_branch cB_abort
cB_sc1_retry:
  s_cmp_lg_u32 s62, 0
  s_cbranch_scc1 cB_sc1_cont
  s_waitcnt vmcnt(0) lgkmcnt(0)
cB_sc1_rv:
  buffer_load_dwordx4 v[8:11], v2, s[8:11], s20 offen offset:0 sc1
  buffer_load_dwordx4 v[12:15], v2, s[8:11], s20 offen offset:1024 sc1
  buffer_load_dwordx4 v[16:19], v2, s[8:11], s20 offen offset:2048 sc1
  buffer_load_dwordx4 v[20:23], v2, s[8:11], s20 offen offset:3072 sc1
  buffer_load_dwordx4 v[28:31], v2, s[8:11], s23 offen offset:0 sc1
  buffer_load_dwordx4 v[24:27], v2, s[8:11], s23 offen offset:1024 sc1
  buffer_load_dwordx4 v[32:35], v2, s[8:11], s23 offen offset:2048 sc1
  s_waitcnt vmcnt(0)
  v_pk_max_u16 v66, v8, v9
  v_pk_max_u16 v66, v66, v10
  v_pk_max_u16 v66, v66, v11
  v_pk_max_u16 v66, v66, v12
  v_pk_max_u16 v66, v66, v13
  v_pk_max_u16 v66, v66, v14
  v_pk_max_u16 v66, v66, v15
  v_pk_max_u16 v66, v66, v16
  v_pk_max_u16 v66, v66, v17
  v_pk_max_u16 v66, v66, v18
  v_pk_max_u16 v66, v66, v19
  v_pk_max_u16 v66, v66, v20
  v_pk_max_u16 v66, v66, v21
  v_pk_max_u16 v66, v66, v22
  v_pk_max_u16 v66, v66, v23
  v_pk_max_u16 v66, v66, v24
  v_pk_max_u16 v66, v66, v25
  v_pk_max_u16 v66, v66, v26
  v_pk_max_u16 v66, v66, v27
  v_pk_max_u16 v66, v66, v28
  v_pk_max_u16 v66, v66, v29
  v_pk_max_u16 v66, v66, v30
  v_pk_max_u16 v66, v66, v31
  v_pk_max_u16 v66, v66, v32
  v_pk_max_u16 v66, v66, v33
  v_pk_max_u16 v66, v66, v34
  v_pk_max_u16 v66, v66, v35
  v_lshlrev_b32 v67, 16, v66
  v_max_u32 v66, v66, v67
  v_cmp_le_u32 vcc, 0xffff0000, v66
  s_cbranch_vccz cB_sc1_rk
  s_add_u32 s30, s30, 1
  s_cmp_lt_u32 s30, 400000
  s_cbranch_scc1 cB_sc1_rv
  s_branch cB_abort
cB_sc1_rk:
  s_mov_b32 s62, 1
  v_mov_b32 v36, 0
  v_mov_b32 v37, 0
  v_mov_b32 v38, 0
  v_mov_b32 v39, 0
  v_mov_b32 v40, 0
  v_mov_b32 v41, 0
  v_mov_b32 v42, 0
  v_mov_b32 v43, 0
  v_mov_b32 v44, 0
  v_mov_b32 v45, 0
  v_mov_b32 v46, 0
  v_mov_b32 v47, 0
  v_mov_b32 v48, 0
  v_mov_b32 v49, 0
  v_mov_b32 v50, 0
  v_mov_b32 v51, 0
  v_mov_b32 v60, 0
  v_mov_b32 v61, 0
  v_mov_b32 v62, 0
  v_mov_b32 v63, 0
  v_mov_b32 v68, 0
  v_mov_b32 v69, 0
  v_mov_b32 v70, 0
  v_mov_b32 v71, 0
  v_mov_b32 v72, 0
  v_mov_b32 v73, 0
  v_mov_b32 v74, 0
  v_mov_b32 v75, 0
  v_mov_b32 v52, 0
  v_mov_b32 v53, 0
  v_mov_b32 v54, 0
  v_mov_b32 v55, 0
  v_mov_b32 v56, 0
  v_mov_b32 v57, 0
  v_mov_b32 v58, 0
  v_mov_b32 v59, 0
  s_add_u32 s31, s31, 0x100
  s_nop 0
  s_branch cB_sc1_go
.p2align 6
cB_sc2_loop:
  s_mov_b32 s30, 0
  s_mov_b32 s62, 0
  s_setprio 3
  s_barrier
  buffer_load_dwordx4 v[8:11], v2, s[8:11], s20 offen offset:0 sc1
  s_setprio 2
  buffer_load_dwordx4 v[12:15], v2, s[8:11], s20 offen offset:1024 sc1
  s_setprio 1
  buffer_load_dwordx4 v[16:19], v2, s[8:11], s20 offen offset:2048 sc1
  s_setprio 0
  buffer_load_dwordx4 v[20:23], v2, s[8:11], s20 offen offset:3072 sc1
cB_sc2_go:
  s_waitcnt vmcnt(3)
  v_smfmac_f32_16x16x64_bf16 v[36:39], v[8:11], a[0:7], v3
  buffer_load_dwordx4 v[24:27], v2, s[8:11], s23 offen offset:0 sc1
  v_cmp_eq_u32 vcc, -1, v8
  v_smfmac_f32_16x16x64_bf16 v[40:43], v[8:11], a[56:63], v3
  v_smfmac_f32_16x16x64_bf16 v[44:47], v[8:11], a[112:119], v3
  buffer_load_dwordx4 v[32:35], v2, s[8:11], s23 offen offset:1024 sc1
  s_cbranch_vccnz cB_sc2_r0
  v_smfmac_f32_16x16x64_bf16 v[48:51], v[8:11], a[168:175], v3
  v_smfmac_f32_16x16x64_bf16 v[52:55], v[8:11], a[224:231], v3
  s_waitcnt vmcnt(4)
  v_cmp_eq_u32 vcc, -1, v12
  v_smfmac_f32_16x16x64_bf16 v[56:59], v[8:11], v[144:151], v3
  buffer_load_dwordx4 v[28:31], v2, s[8:11], s23 offen offset:2048 sc1
  v_smfmac_f32_16x16x64_bf16 v[62:65], v[8:11], v[200:207], v3
  s_cbranch_vccnz cB_sc2_r1
cB_sc2_c1:
  v_smfmac_f32_16x16x64_bf16 v[36:39], v[12:15], a[8:15], v3
  v_smfmac_f32_16x16x64_bf16 v[40:43], v[12:15], a[64:71], v3
  v_smfmac_f32_16x16x64_bf16 v[44:47], v[12:15], a[120:127], v3
  v_smfmac_f32_16x16x64_bf16 v[48:51], v[12:15], a[176:183], v3
  v_smfmac_f32_16x16x64_bf16 v[52:55], v[12:15], a[232:239], v3
  s_waitcnt vmcnt(4)
  v_cmp_eq_u32 vcc, -1, v16
  v_smfmac_f32_16x16x64_bf16 v[56:59], v[12:15], v[152:159], v3
  buffer_load_dwordx4 v[88:91], v117, s[8:11], s26 offen offset:0 sc1
  v_smfmac_f32_16x16x64_bf16 v[62:65], v[12:15], v[208:215], v3
  s_cbranch_vccnz cB_sc2_r2
cB_sc2_c2:
  v_smfmac_f32_16x16x64_bf16 v[36:39], v[16:19], a[16:23], v3
  v_smfmac_f32_16x16x64_bf16 v[40:43], v[16:19], a[72:79], v3
  v_smfmac_f32_16x16x64_bf16 v[44:47], v[16:19], a[128:135], v3
  buffer_load_dwordx4 v[92:95], v117, s[8:11], s26 offen offset:1024 sc1
  v_smfmac_f32_16x16x64_bf16 v[48:51], v[16:19], a[184:191], v3
  v_smfmac_f32_16x16x64_bf16 v[52:55], v[16:19], a[240:247], v3
  s_waitcnt vmcnt(5)
  v_cmp_eq_u32 vcc, -1, v20
  v_smfmac_f32_16x16x64_bf16 v[56:59], v[16:19], v[160:167], v3
  v_smfmac_f32_16x16x64_bf16 v[62:65], v[16:19], v[216:223], v3
  buffer_load_dwordx4 v[96:99], v2, s[8:11], s24 offen offset:0 sc1
  s_cbranch_vccnz cB_sc2_r3
cB_sc2_c3:
  v_smfmac_f32_16x16x64_bf16 v[36:39], v[20:23], a[24:31], v3
  v_smfmac_f32_16x16x64_bf16 v[40:43], v[20:23], a[80:87], v3
  s_waitcnt vmcnt(3)
  v_max3_u32 v66, v24, v27, v28
  v_smfmac_f32_16x16x64_bf16 v[44:47], v[20:23], a[136:143], v3
  v_max3_u32 v66, v66, v31, v32
  v_smfmac_f32_16x16x64_bf16 v[48:51], v[20:23], a[192:199], v3
  buffer_load_dwordx4 v[100:103], v2, s[8:11], s24 offen offset:1024 sc1
  v_max_u32 v66, v66, v35
  v_smfmac_f32_16x16x64_bf16 v[52:55], v[20:23], a[248:255], v3
  v_cmp_eq_u32 vcc, -1, v66
  v_smfmac_f32_16x16x64_bf16 v[56:59], v[20:23], v[168:175], v3
  v_smfmac_f32_16x16x64_bf16 v[62:65], v[20:23], v[224:231], v3
  s_cbranch_vccnz cB_sc2_r4
cB_sc2_c4:
  v_smfmac_f32_16x16x64_bf16 v[62:65], v[24:27], v[232:239], v3
  buffer_load_dwordx4 v[104:107], v2, s[8:11], s26 offen offset:0 sc1
  v_smfmac_f32_16x16x64_bf16 v[62:65], v[32:35], v[240:247], v3
  v_smfmac_f32_16x16x64_bf16 v[62:65], v[28:31], v[248:255], v3
  v_smfmac_f32_16x16x64_bf16 v[52:55], v[24:27], v[120:127], v3
  v_smfmac_f32_16x16x64_bf16 v[52:55], v[32:35], v[128:135], v3
  buffer_load_dwordx4 v[108:111], v2, s[8:11], s26 offen offset:1024 sc1
  v_smfmac_f32_16x16x64_bf16 v[52:55], v[28:31], v[136:143], v3
  v_cvt_pk_bf16_f32 v62, v62, v63
  v_smfmac_f32_16x16x64_bf16 v[56:59], v[24:27], v[176:183], v3
  v_cvt_pk_bf16_f32 v63, v64, v65
  v_smfmac_f32_16x16x64_bf16 v[56:59], v[32:35], v[184:191], v3
  v_mfma_f32_16x16x32_bf16 v[8:11], v[60:63], v[4:7], 0
  v_cvt_pk_bf16_f32 v55, v54, v55
  v_smfmac_f32_16x16x64_bf16 v[56:59], v[28:31], v[192:199], v3
  v_cvt_pk_bf16_f32 v54, v52, v53
  v_smfmac_f32_16x16x64_bf16 v[36:39], v[24:27], a[32:39], v3
  s_nop 1
  v_cvt_pk_bf16_f32 v76, v8, v9
  v_smfmac_f32_16x16x64_bf16 v[36:39], v[32:35], a[40:47], v3
  v_cvt_pk_bf16_f32 v77, v10, v11
  v_smfmac_f32_16x16x64_bf16 v[36:39], v[28:31], a[48:55], v3
  v_cvt_pk_bf16_f32 v56, v56, v57
  v_smfmac_f32_16x16x64_bf16 v[40:43], v[24:27], a[88:95], v3
  v_cvt_pk_bf16_f32 v57, v58, v59
  v_smfmac_f32_16x16x64_bf16 v[40:43], v[32:35], a[96:103], v3
  v_mfma_f32_16x16x32_bf16 v[12:15], v[54:57], v[4:7], 0
  v_cvt_pk_bf16_f32 v39, v38, v39
  v_smfmac_f32_16x16x64_bf16 v[40:43], v[28:31], a[104:111], v3
  v_cvt_pk_bf16_f32 v38, v36, v37
  v_smfmac_f32_16x16x64_bf16 v[44:47], v[24:27], a[144:151], v3
  s_nop 1
  v_cvt_pk_bf16_f32 v78, v12, v13
  v_smfmac_f32_16x16x64_bf16 v[44:47], v[32:35], a[152:159], v3
  v_cvt_pk_bf16_f32 v79, v14, v15
  v_smfmac_f32_16x16x64_bf16 v[44:47], v[28:31], a[160:167], v3
  v_cvt_pk_bf16_f32 v40, v40, v41
  v_smfmac_f32_16x16x64_bf16 v[48:51], v[24:27], a[200:207], v3
  v_cvt_pk_bf16_f32 v41, v42, v43
  v_smfmac_f32_16x16x64_bf16 v[48:51], v[32:35], a[208:215], v3
  v_smfmac_f32_16x16x64_bf16 v[48:51], v[28:31], a[216:223], v3
  s_waitcnt vmcnt(4)
  v_cvt_pk_bf16_f32 v47, v46, v47
  v_smfmac_f32_16x16x64_bf16 v[68:71], v[76:79], v[80:87], v3
  v_cvt_pk_bf16_f32 v46, v44, v45
  v_mfma_f32_16x16x32_bf16 v[8:11], v[38:41], v[4:7], 0
  s_nop 1
  v_cvt_pk_bf16_f32 v48, v48, v49
  v_cvt_pk_bf16_f32 v49, v50, v51
  s_nop 1
  v_mfma_f32_16x16x32_bf16 v[12:15], v[46:49], v[4:7], 0
  v_smfmac_f32_16x16x64_bf16 v[72:75], v[76:79], v[88:95], v3
  v_cvt_pk_bf16_f32 v20, v8, v9
  v_mfma_f32_16x16x32_bf16 v[52:55], v[30:33], v[76:79], 0
  s_waitcnt vmcnt(0)
  v_cvt_pk_bf16_f32 v21, v10, v11
  v_cvt_pk_bf16_f32 v22, v12, v13
  v_cvt_pk_bf16_f32 v23, v14, v15
  s_nop 1
  v_mfma_f32_16x16x32_bf16 v[52:55], v[16:19], v[20:23], v[52:55]
  v_smfmac_f32_16x16x64_bf16 v[68:71], v[20:23], v[96:103], v3
  v_smfmac_f32_16x16x64_bf16 v[72:75], v[20:23], v[104:111], v3
  s_nop 1
  ds_write_b128 v113, v[52:55]
  s_nop 1
  v_permlane32_swap_b32 v68, v70
  v_permlane32_swap_b32 v69, v71
  v_add_f32 v56, v68, v70
  v_add_f32 v58, v69, v71
  v_permlane32_swap_b32 v72, v74
  v_permlane32_swap_b32 v73, v75
  v_add_f32 v57, v72, v74
  v_add_f32 v59, v73, v75
  ds_write_b128 v2, v[56:59] offset:2048
  v_cmp_u_f32 vcc, v57, v59
  v_mov_b32 v68, 0
  v_mov_b32 v69, 0
  v_mov_b32 v70, 0
  v_mov_b32 v71, 0
  s_cbranch_vccnz cB_sc2_retry
cB_sc2_cont:
  s_add_u32 s24, s24, 28672
  s_add_u32 s26, s26, 28672
  buffer_load_dwordx4 v[80:83], v117, s[8:11], s24 offen offset:0 sc1
  buffer_load_dwordx4 v[84:87], v117, s[8:11], s24 offen offset:1024 sc1
  v_mov_b32 v72, 0
  v_mov_b32 v73, 0
  v_mfma_f32_32x32x16_bf16 v[36:51], v[68:71], v[68:71], 0
  s_waitcnt lgkmcnt(0)
  s_barrier
  v_mfma_f32_32x32x16_bf16 v[52:67], v[68:71], v[68:71], 0
  s_buffer_load_dword s70, s[8:11], s35
  s_add_u32 s22, s24, 114688
  s_buffer_load_dword s71, s[8:11], s22
  s_mul_i32 s22, s18, 7168
  s_add_u32 s22, s22, 88024064
  s_buffer_load_dword s72, s[8:11], s22
  s_add_u32 s35, s35, 458752
  v_mov_b32 v74, 0
  v_mov_b32 v75, 0
  s_mov_b32 s19, s18
  s_add_u32 s18, s18, 1
  s_mov_b32 s22, s20
  s_mov_b32 s20, s21
  s_mov_b32 s21, s22
  s_add_u32 s23, s20, 4096
  s_cmp_lt_u32 s19, 63
  s_cbranch_scc1 cB_sc2_loop
  s_branch cB_done
cB_sc2_r0:
  s_add_u32 s31, s31, 1
  buffer_load_dwordx4 v[8:11], v2, s[8:11], s20 offen offset:0 sc1
  s_waitcnt vmcnt(0)
  v_cmp_eq_u32 vcc, -1, v8
  v_mov_b32 v36, 0
  v_mov_b32 v37, 0
  v_mov_b32 v38, 0
  v_mov_b32 v39, 0
  v_mov_b32 v40, 0
  v_mov_b32 v41, 0
  v_mov_b32 v42, 0
  v_mov_b32 v43, 0
  v_mov_b32 v44, 0
  v_mov_b32 v45, 0
  v_mov_b32 v46, 0
  v_mov_b32 v47, 0
  v_mov_b32 v48, 0
  v_mov_b32 v49, 0
  v_mov_b32 v50, 0
  v_mov_b32 v51, 0
  s_nop 1
  s_cbranch_vccz cB_sc2_go
  s_add_u32 s30, s30, 1
  s_cmp_lt_u32 s30, 400000
  s_cbranch_scc1 cB_sc2_r0
  s_branch cB_abort
cB_sc2_r1:
  s_add_u32 s31, s31, 1
  buffer_load_dwordx4 v[12:15], v2, s[8:11], s20 offen offset:1024 sc1
  s_waitcnt vmcnt(0)
  v_cmp_eq_u32 vcc, -1, v12
  s_nop 4
  s_cbranch_vccz cB_sc2_c1
  s_add_u32 s30, s30, 1
  s_cmp_lt_u32 s30, 400000
  s_cbranch_scc1 cB_sc2_r1
  s_branch cB_abort
cB_sc2_r2:
  s_add_u32 s31, s31, 1
  buffer_load_dwordx4 v[16:19], v2, s[8:11], s20 offen offset:2048 sc1
  s_waitcnt vmcnt(0)
  v_cmp_eq_u32 vcc, -1, v16
  s_nop 4
  s_cbranch_vccz cB_sc2_c2
  s_add_u32 s30, s30, 1
  s_cmp_lt_u32 s30, 400000
  s_cbranch_scc1 cB_sc2_r2
  s_branch cB_abort
cB_sc2_r3:
  s_add_u32 s31, s31, 1
  buffer_load_dwordx4 v[20:23], v2, s[8:11], s20 offen offset:3072 sc1
  s_waitcnt vmcnt(0)
  v_cmp_eq_u32 vcc, -1, v20
  s_nop 4
  s_cbranch_vccz cB_sc2_c3
  s_add_u32 s30, s30, 1
  s_cmp_lt_u32 s30, 400000
  s_cbranch_scc1 cB_sc2_r3
  s_branch cB_abort
cB_sc2_r4:
  s_add_u32 s31, s31, 1
  buffer_load_dwordx4 v[24:27], v2, s[8:11], s23 offen offset:0 sc1
  buffer_load_dwordx4 v[32:35], v2, s[8:11], s23 offen offset:1024 sc1
  buffer_load_dwordx4 v[28:31], v2, s[8:11], s23 offen offset:2048 sc1
  s_waitcnt vmcnt(0)
  v_max3_u32 v66, v24, v27, v28
  v_max3_u32 v66, v66, v31, v32
  v_max_u32 v66, v66, v35
  v_cmp_eq_u32 vcc, -1, v66
  s_nop 4
  s_cbranch_vccz cB_sc2_c4
  s_add_u32 s30, s30, 1
  s_cmp_lt_u32 s30, 400000
  s_cbranch_scc1 cB_sc2_r4
  s_branch cB_abort
cB_sc2_retry:
  s_cmp_lg_u32 s62, 0
  s_cbranch_scc1 cB_sc2_cont
  s_waitcnt vmcnt(0) lgkmcnt(0)
cB_sc2_rv:
  buffer_load_dwordx4 v[8:11], v2, s[8:11], s20 offen offset:0 sc1
  buffer_load_dwordx4 v[12:15], v2, s[8:11], s20 offen offset:1024 sc1
  buffer_load_dwordx4 v[16:19], v2, s[8:11], s20 offen offset:2048 sc1
  buffer_load_dwordx4 v[20:23], v2, s[8:11], s20 offen offset:3072 sc1
  buffer_load_dwordx4 v[24:27], v2, s[8:11], s23 offen offset:0 sc1
  buffer_load_dwordx4 v[32:35], v2, s[8:11], s23 offen offset:1024 sc1
  buffer_load_dwordx4 v[28:31], v2, s[8:11], s23 offen offset:2048 sc1
  s_waitcnt vmcnt(0)
  v_pk_max_u16 v66, v8, v9
  v_pk_max_u16 v66, v66, v10
  v_pk_max_u16 v66, v66, v11
  v_pk_max_u16 v66, v66, v12
  v_pk_max_u16 v66, v66, v13
  v_pk_max_u16 v66, v66, v14
  v_pk_max_u16 v66, v66, v15
  v_pk_max_u16 v66, v66, v16
  v_pk_max_u16 v66, v66, v17
  v_pk_max_u16 v66, v66, v18
  v_pk_max_u16 v66, v66, v19
  v_pk_max_u16 v66, v66, v20
  v_pk_max_u16 v66, v66, v21
  v_pk_max_u16 v66, v66, v22
  v_pk_max_u16 v66, v66, v23
  v_pk_max_u16 v66, v66, v24
  v_pk_max_u16 v66, v66, v25
  v_pk_max_u16 v66, v66, v26
  v_pk_max_u16 v66, v66, v27
  v_pk_max_u16 v66, v66, v28
  v_pk_max_u16 v66, v66, v29
  v_pk_max_u16 v66, v66, v30
  v_pk_max_u16 v66, v66, v31
  v_pk_max_u16 v66, v66, v32
  v_pk_max_u16 v66, v66, v33
  v_pk_max_u16 v66, v66, v34
  v_pk_max_u16 v66, v66, v35
  v_lshlrev_b32 v67, 16, v66
  v_max_u32 v66, v66, v67
  v_cmp_le_u32 vcc, 0xffff0000, v66
  s_cbranch_vccz cB_sc2_rk
  s_add_u32 s30, s30, 1
  s_cmp_lt_u32 s30, 400000
  s_cbranch_scc1 cB_sc2_rv
  s_branch cB_abort
cB_sc2_rk:
  s_mov_b32 s62, 1
  v_mov_b32 v36, 0
  v_mov_b32 v37, 0
  v_mov_b32 v38, 0
  v_mov_b32 v39, 0
  v_mov_b32 v40, 0
  v_mov_b32 v41, 0
  v_mov_b32 v42, 0
  v_mov_b32 v43, 0
  v_mov_b32 v44, 0
  v_mov_b32 v45, 0
  v_mov_b32 v46, 0
  v_mov_b32 v47, 0
  v_mov_b32 v48, 0
  v_mov_b32 v49, 0
  v_mov_b32 v50, 0
  v_mov_b32 v51, 0
  v_mov_b32 v62, 0
  v_mov_b32 v63, 0
  v_mov_b32 v64, 0
  v_mov_b32 v65, 0
  v_mov_b32 v68, 0
  v_mov_b32 v69, 0
  v_mov_b32 v70, 0
  v_mov_b32 v71, 0
  v_mov_b32 v72, 0
  v_mov_b32 v73, 0
  v_mov_b32 v74, 0
  v_mov_b32 v75, 0
  v_mov_b32 v52, 0
  v_mov_b32 v53, 0
  v_mov_b32 v54, 0
  v_mov_b32 v55, 0
  v_mov_b32 v56, 0
  v_mov_b32 v57, 0
  v_mov_b32 v58, 0
  v_mov_b32 v59, 0
  s_add_u32 s31, s31, 0x100
  s_nop 0
  s_branch cB_sc2_go
.p2align 6
cB_sc3_loop:
  s_mov_b32 s30, 0
  s_mov_b32 s62, 0
  s_setprio 3
  s_barrier
  buffer_load_dwordx4 v[8:11], v2, s[8:11], s20 offen offset:0 sc1
  s_setprio 2
  buffer_load_dwordx4 v[12:15], v2, s[8:11], s20 offen offset:1024 sc1
  s_setprio 1
  buffer_load_dwordx4 v[16:19], v2, s[8:11], s20 offen offset:2048 sc1
  s_setprio 0
  buffer_load_dwordx4 v[20:23], v2, s[8:11], s20 offen offset:3072 sc1
cB_sc3_go:
  s_waitcnt vmcnt(3)
  v_smfmac_f32_16x16x64_bf16 v[36:39], v[8:11], a[0:7], v3
  buffer_load_dwordx4 v[24:27], v2, s[8:11], s23 offen offset:0 sc1
  v_cmp_eq_u32 vcc, -1, v8
  v_smfmac_f32_16x16x64_bf16 v[40:43], v[8:11], a[56:63], v3
  v_smfmac_f32_16x16x64_bf16 v[44:47], v[8:11], a[112:119], v3
  buffer_load_dwordx4 v[28:31], v2, s[8:11], s23 offen offset:1024 sc1
  s_cbranch_vccnz cB_sc3_r0
  v_smfmac_f32_16x16x64_bf16 v[48:51], v[8:11], a[168:175], v3
  v_smfmac_f32_16x16x64_bf16 v[52:55], v[8:11], a[224:231], v3
  s_waitcnt vmcnt(4)
  v_cmp_eq_u32 vcc, -1, v12
  v_smfmac_f32_16x16x64_bf16 v[56:59], v[8:11], v[144:151], v3
  buffer_load_dwordx4 v[32:35], v2, s[8:11], s23 offen offset:2048 sc1
  v_smfmac_f32_16x16x64_bf16 v[62:65], v[8:11], v[200:207], v3
  s_cbranch_vccnz cB_sc3_r1
cB_sc3_c1:
  v_smfmac_f32_16x16x64_bf16 v[36:39], v[12:15], a[8:15], v3
  v_smfmac_f32_16x16x64_bf16 v[40:43], v[12:15], a[64:71], v3
  v_smfmac_f32_16x16x64_bf16 v[44:47], v[12:15], a[120:127], v3
  v_smfmac_f32_16x16x64_bf16 v[48:51], v[12:15], a[176:183], v3
  v_smfmac_f32_16x16x64_bf16 v[52:55], v[12:15], a[232:239], v3
  s_waitcnt vmcnt(4)
  v_cmp_eq_u32 vcc, -1, v16
  v_smfmac_f32_16x16x64_bf16 v[56:59], v[12:15], v[152:159], v3
  buffer_load_dwordx4 v[88:91], v117, s[8:11], s26 offen offset:0 sc1
  v_smfmac_f32_16x16x64_bf16 v[62:65], v[12:15], v[208:215], v3
  s_cbranch_vccnz cB_sc3_r2
cB_sc3_c2:
  v_smfmac_f32_16x16x64_bf16 v[36:39], v[16:19], a[16:23], v3
  v_smfmac_f32_16x16x64_bf16 v[40:43], v[16:19], a[72:79], v3
  v_smfmac_f32_16x16x64_bf16 v[44:47], v[16:19], a[128:135], v3
  buffer_load_dwordx4 v[92:95], v117, s[8:11], s26 offen offset:1024 sc1
  v_smfmac_f32_16x16x64_bf16 v[48:51], v[16:19], a[184:191], v3
  v_smfmac_f32_16x16x64_bf16 v[52:55], v[16:19], a[240:247], v3
  s_waitcnt vmcnt(5)
  v_cmp_eq_u32 vcc, -1, v20
  v_smfmac_f32_16x16x64_bf16 v[56:59], v[16:19], v[160:167], v3
  v_smfmac_f32_16x16x64_bf16 v[62:65], v[16:19], v[216:223], v3
  buffer_load_dwordx4 v[96:99], v2, s[8:11], s24 offen offset:0 sc1
  s_cbranch_vccnz cB_sc3_r3
cB_sc3_c3:
  v_smfmac_f32_16x16x64_bf16 v[36:39], v[20:23], a[24:31], v3
  v_smfmac_f32_16x16x64_bf16 v[40:43], v[20:23], a[80:87], v3
  s_waitcnt vmcnt(3)
  v_max3_u32 v66, v24, v27, v28
  v_smfmac_f32_16x16x64_bf16 v[44:47], v[20:23], a[136:143], v3
  v_max3_u32 v66, v66, v31, v32
  v_smfmac_f32_16x16x64_bf16 v[48:51], v[20:23], a[192:199], v3
  buffer_load_dwordx4 v[100:103], v2, s[8:11], s24 offen offset:1024 sc1
  v_max_u32 v66, v66, v35
  v_smfmac_f32_16x16x64_bf16 v[52:55], v[20:23], a[248:255], v3
  v_cmp_eq_u32 vcc, -1, v66
  v_smfmac_f32_16x16x64_bf16 v[56:59], v[20:23], v[168:175], v3
  v_smfmac_f32_16x16x64_bf16 v[62:65], v[20:23], v[224:231], v3
  s_cbranch_vccnz cB_sc3_r4
cB_sc3_c4:
  v_smfmac_f32_16x16x64_bf16 v[62:65], v[24:27], v[232:239], v3
  buffer_load_dwordx4 v[104:107], v2, s[8:11], s26 offen offset:0 sc1
  v_smfmac_f32_16x16x64_bf16 v[62:65], v[28:31], v[240:247], v3
  v_smfmac_f32_16x16x64_bf16 v[62:65], v[32:35], v[248:255], v3
  v_smfmac_f32_16x16x64_bf16 v[52:55], v[24:27], v[120:127], v3
  v_smfmac_f32_16x16x64_bf16 v[52:55], v[28:31], v[128:135], v3
  buffer_load_dwordx4 v[108:111], v2, s[8:11], s26 offen offset:1024 sc1
  v_smfmac_f32_16x16x64_bf16 v[52:55], v[32:35], v[136:143], v3
  v_cvt_pk_bf16_f32 v62, v62, v63
  v_smfmac_f32_16x16x64_bf16 v[56:59], v[24:27], v[176:183], v3
  v_cvt_pk_bf16_f32 v63, v64, v65
  v_smfmac_f32_16x16x64_bf16 v[56:59], v[28:31], v[184:191], v3
  v_mfma_f32_16x16x32_bf16 v[8:11], v[60:63], v[4:7], 0
  v_cvt_pk_bf16_f32 v55, v54, v55
  v_smfmac_f32_16x16x64_bf16 v[56:59], v[32:35], v[192:199], v3
  v_cvt_pk_bf16_f32 v54, v52, v53
  v_smfmac_f32_16x16x64_bf16 v[36:39], v[24:27], a[32:39], v3
  s_nop 1
  v_cvt_pk_bf16_f32 v78, v8, v9
  v_smfmac_f32_16x16x64_bf16 v[36:39], v[28:31], a[40:47], v3
  v_cvt_pk_bf16_f32 v79, v10, v11
  v_smfmac_f32_16x16x64_bf16 v[36:39], v[32:35], a[48:55], v3
  v_cvt_pk_bf16_f32 v56, v56, v57
  v_smfmac_f32_16x16x64_bf16 v[40:43], v[24:27], a[88:95], v3
  v_cvt_pk_bf16_f32 v57, v58, v59
  v_smfmac_f32_16x16x64_bf16 v[40:43], v[28:31], a[96:103], v3
  v_mfma_f32_16x16x32_bf16 v[12:15], v[54:57], v[4:7], 0
  v_cvt_pk_bf16_f32 v39, v38, v39
  v_smfmac_f32_16x16x64_bf16 v[40:43], v[32:35], a[104:111], v3
  v_cvt_pk_bf16_f32 v38, v36, v37
  v_smfmac_f32_16x16x64_bf16 v[44:47], v[24:27], a[144:151], v3
  s_nop 1
  v_cvt_pk_bf16_f32 v76, v12, v13
  v_smfmac_f32_16x16x64_bf16 v[44:47], v[28:31], a[152:159], v3
  v_cvt_pk_bf16_f32 v77, v14, v15
  v_smfmac_f32_16x16x64_bf16 v[44:47], v[32:35], a[160:167], v3
  v_cvt_pk_bf16_f32 v40, v40, v41
  v_smfmac_f32_16x16x64_bf16 v[48:51], v[24:27], a[200:207], v3
  v_cvt_pk_bf16_f32 v41, v42, v43
  v_smfmac_f32_16x16x64_bf16 v[48:51], v[28:31], a[208:215], v3
  v_smfmac_f32_16x16x64_bf16 v[48:51], v[32:35], a[216:223], v3
  s_waitcnt vmcnt(4)
  v_cvt_pk_bf16_f32 v47, v46, v47
  v_smfmac_f32_16x16x64_bf16 v[68:71], v[76:79], v[80:87], v3
  v_cvt_pk_bf16_f32 v46, v44, v45
  v_mfma_f32_16x16x32_bf16 v[8:11], v[38:41], v[4:7], 0
  s_nop 1
  v_cvt_pk_bf16_f32 v48, v48, v49
  v_cvt_pk_bf16_f32 v49, v50, v51
  s_nop 1
  v_mfma_f32_16x16x32_bf16 v[12:15], v[46:49], v[4:7], 0
  v_smfmac_f32_16x16x64_bf16 v[72:75], v[76:79], v[88:95], v3
  v_cvt_pk_bf16_f32 v16, v8, v9
  v_mfma_f32_16x16x32_bf16 v[52:55], v[30:33], v[76:79], 0
  s_waitcnt vmcnt(0)
  v_cvt_pk_bf16_f32 v17, v10, v11
  v_cvt_pk_bf16_f32 v18, v12, v13
  v_cvt_pk_bf16_f32 v19, v14, v15
  s_nop 1
  v_mfma_f32_16x16x32_bf16 v[52:55], v[20:23], v[16:19], v[52:55]
  v_smfmac_f32_16x16x64_bf16 v[68:71], v[16:19], v[96:103], v3
  v_smfmac_f32_16x16x64_bf16 v[72:75], v[16:19], v[104:111], v3
  s_nop 1
  ds_write_b128 v113, v[52:55]
  s_nop 1
  v_permlane32_swap_b32 v68, v70
  v_permlane32_swap_b32 v69, v71
  v_add_f32 v56, v68, v70
  v_add_f32 v58, v69, v71
  v_permlane32_swap_b32 v72, v74
  v_permlane32_swap_b32 v73, v75
  v_add_f32 v57, v72, v74
  v_add_f32 v59, v73, v75
  ds_write_b128 v2, v[56:59] offset:3072
  v_cmp_u_f32 vcc, v57, v59
  v_mov_b32 v68, 0
  v_mov_b32 v69, 0
  v_mov_b32 v70, 0
  v_mov_b32 v71, 0
  s_cbranch_vccnz cB_sc3_retry
cB_sc3_cont:
  s_add_u32 s24, s24, 28672
  s_add_u32 s26, s26, 28672
  buffer_load_dwordx4 v[80:83], v117, s[8:11], s24 offen offset:0 sc1
  buffer_load_dwordx4 v[84:87], v117, s[8:11], s24 offen offset:1024 sc1
  v_mov_b32 v72, 0
  v_mov_b32 v73, 0
  v_mfma_f32_16x16x32_bf16 v[62:65], v[68:71], v[68:71], 0
  s_waitcnt lgkmcnt(0)
  s_barrier
  v_mov_b32 v52, 0
  v_mov_b32 v53, 0
  v_mov_b32 v54, 0
  v_mov_b32 v55, 0
  v_mov_b32 v56, 0
  v_mov_b32 v57, 0
  v_mov_b32 v58, 0
  v_mov_b32 v59, 0
  v_mfma_f32_32x32x16_bf16 v[36:51], v[68:71], v[68:71], 0
  v_mov_b32 v74, 0
  v_mov_b32 v75, 0
  s_mov_b32 s19, s18
  s_add_u32 s18, s18, 1
  s_mov_b32 s22, s20
  s_mov_b32 s20, s21
  s_mov_b32 s21, s22
  s_add_u32 s23, s20, 4096
  s_cmp_lt_u32 s19, 63
  s_nop 2
  s_cbranch_scc1 cB_sc3_loop
  s_branch cB_done
cB_sc3_r0:
  s_add_u32 s31, s31, 1
  buffer_load_dwordx4 v[8:11], v2, s[8:11], s20 offen offset:0 sc1
  s_waitcnt vmcnt(0)
  v_cmp_eq_u32 vcc, -1, v8
  v_mov_b32 v36, 0
  v_mov_b32 v37, 0
  v_mov_b32 v38, 0
  v_mov_b32 v39, 0
  v_mov_b32 v40, 0
  v_mov_b32 v41, 0
  v_mov_b32 v42, 0
  v_mov_b32 v43, 0
  v_mov_b32 v44, 0
  v_mov_b32 v45, 0
  v_mov_b32 v46, 0
  v_mov_b32 v47, 0
  v_mov_b32 v48, 0
  v_mov_b32 v49, 0
  v_mov_b32 v50, 0
  v_mov_b32 v51, 0
  s_nop 1
  s_cbranch_vccz cB_sc3_go
  s_add_u32 s30, s30, 1
  s_cmp_lt_u32 s30, 400000
  s_cbranch_scc1 cB_sc3_r0
  s_branch cB_abort
cB_sc3_r1:
  s_add_u32 s31, s31, 1
  buffer_load_dwordx4 v[12:15], v2, s[8:11], s20 offen offset:1024 sc1
  s_waitcnt vmcnt(0)
  v_cmp_eq_u32 vcc, -1, v12
  s_nop 4
  s_cbranch_vccz cB_sc3_c1
  s_add_u32 s30, s30, 1
  s_cmp_lt_u32 s30, 400000
  s_cbranch_scc1 cB_sc3_r1
  s_branch cB_abort
cB_sc3_r2:
  s_add_u32 s31, s31, 1
  buffer_load_dwordx4 v[16:19], v2, s[8:11], s20 offen offset:2048 sc1
  s_waitcnt vmcnt(0)
  v_cmp_eq_u32 vcc, -1, v16
  s_nop 4
  s_cbranch_vccz cB_sc3_c2
  s_add_u32 s30, s30, 1
  s_cmp_lt_u32 s30, 400000
  s_cbranch_scc1 cB_sc3_r2
  s_branch cB_abort
cB_sc3_r3:
  s_add_u32 s31, s31, 1
  buffer_load_dwordx4 v[20:23], v2, s[8:11], s20 offen offset:3072 sc1
  s_waitcnt vmcnt(0)
  v_cmp_eq_u32 vcc, -1, v20
  s_nop 4
  s_cbranch_vccz cB_sc3_c3
  s_add_u32 s30, s30, 1
  s_cmp_lt_u32 s30, 400000
  s_cbranch_scc1 cB_sc3_r3
  s_branch cB_abort
cB_sc3_r4:
  s_add_u32 s31, s31, 1
  buffer_load_dwordx4 v[24:27], v2, s[8:11], s23 offen offset:0 sc1
  buffer_load_dwordx4 v[28:31], v2, s[8:11], s23 offen offset:1024 sc1
  buffer_load_dwordx4 v[32:35], v2, s[8:11], s23 offen offset:2048 sc1
  s_waitcnt vmcnt(0)
  v_max3_u32 v66, v24, v27, v28
  v_max3_u32 v66, v66, v31, v32
  v_max_u32 v66, v66, v35
  v_cmp_eq_u32 vcc, -1, v66
  s_nop 4
  s_cbranch_vccz cB_sc3_c4
  s_add_u32 s30, s30, 1
  s_cmp_lt_u32 s30, 400000
  s_cbranch_scc1 cB_sc3_r4
  s_branch cB_abort
cB_sc3_retry:
  s_cmp_lg_u32 s62, 0
  s_cbranch_scc1 cB_sc3_cont
  s_waitcnt vmcnt(0) lgkmcnt(0)
cB_sc3_rv:
  buffer_load_dwordx4 v[8:11], v2, s[8:11], s20 offen offset:0 sc1
  buffer_load_dwordx4 v[12:15], v2, s[8:11], s20 offen offset:1024 sc1
  buffer_load_dwordx4 v[16:19], v2, s[8:11], s20 offen offset:2048 sc1
  buffer_load_dwordx4 v[20:23], v2, s[8:11], s20 offen offset:3072 sc1
  buffer_load_dwordx4 v[24:27], v2, s[8:11], s23 offen offset:0 sc1
  buffer_load_dwordx4 v[28:31], v2, s[8:11], s23 offen offset:1024 sc1
  buffer_load_dwordx4 v[32:35], v2, s[8:11], s23 offen offset:2048 sc1
  s_waitcnt vmcnt(0)
  v_pk_max_u16 v66, v8, v9
  v_pk_max_u16 v66, v66, v10
  v_pk_max_u16 v66, v66, v11
  v_pk_max_u16 v66, v66, v12
  v_pk_max_u16 v66, v66, v13
  v_pk_max_u16 v66, v66, v14
  v_pk_max_u16 v66, v66, v15
  v_pk_max_u16 v66, v66, v16
  v_pk_max_u16 v66, v66, v17
  v_pk_max_u16 v66, v66, v18
  v_pk_max_u16 v66, v66, v19
  v_pk_max_u16 v66, v66, v20
  v_pk_max_u16 v66, v66, v21
  v_pk_max_u16 v66, v66, v22
  v_pk_max_u16 v66, v66, v23
  v_pk_max_u16 v66, v66, v24
  v_pk_max_u16 v66, v66, v25
  v_pk_max_u16 v66, v66, v26
  v_pk_max_u16 v66, v66, v27
  v_pk_max_u16 v66, v66, v28
  v_pk_max_u16 v66, v66, v29
  v_pk_max_u16 v66, v66, v30
  v_pk_max_u16 v66, v66, v31
  v_pk_max_u16 v66, v66, v32
  v_pk_max_u16 v66, v66, v33
  v_pk_max_u16 v66, v66, v34
  v_pk_max_u16 v66, v66, v35
  v_lshlrev_b32 v67, 16, v66
  v_max_u32 v66, v66, v67
  v_cmp_le_u32 vcc, 0xffff0000, v66
  s_cbranch_vccz cB_sc3_rk
  s_add_u32 s30, s30, 1
  s_cmp_lt_u32 s30, 400000
  s_cbranch_scc1 cB_sc3_rv
  s_branch cB_abort
cB_sc3_rk:
  s_mov_b32 s62, 1
  v_mov_b32 v36, 0
  v_mov_b32 v37, 0
  v_mov_b32 v38, 0
  v_mov_b32 v39, 0
  v_mov_b32 v40, 0
  v_mov_b32 v41, 0
  v_mov_b32 v42, 0
  v_mov_b32 v43, 0
  v_mov_b32 v44, 0
  v_mov_b32 v45, 0
  v_mov_b32 v46, 0
  v_mov_b32 v47, 0
  v_mov_b32 v48, 0
  v_mov_b32 v49, 0
  v_mov_b32 v50, 0
  v_mov_b32 v51, 0
  v_mov_b32 v62, 0
  v_mov_b32 v63, 0
  v_mov_b32 v64, 0
  v_mov_b32 v65, 0
  v_mov_b32 v68, 0
  v_mov_b32 v69, 0
  v_mov_b32 v70, 0
  v_mov_b32 v71, 0
  v_mov_b32 v72, 0
  v_mov_b32 v73, 0
  v_mov_b32 v74, 0
  v_mov_b32 v75, 0
  v_mov_b32 v52, 0
  v_mov_b32 v53, 0
  v_mov_b32 v54, 0
  v_mov_b32 v55, 0
  v_mov_b32 v56, 0
  v_mov_b32 v57, 0
  v_mov_b32 v58, 0
  v_mov_b32 v59, 0
  s_add_u32 s31, s31, 0x100
  s_nop 0
  s_branch cB_sc3_go
.p2align 6
cB_va0_loop:
  s_mov_b32 s30, 0
  s_barrier
  buffer_load_dwordx4 v[24:27], v2, s[8:11], s23 offen offset:0 sc1
  buffer_load_dwordx4 v[28:31], v2, s[8:11], s23 offen offset:1024 sc1
  s_barrier
  buffer_store_dword v160, v1, s[8:11], s38 offen sc1
  s_add_u32 s22, s25, 0
  buffer_load_dwordx4 v[80:83], v6, s[8:11], s22 offen offset:0 sc1
  buffer_load_dwordx4 v[84:87], v6, s[8:11], s22 offen offset:1792 sc1
  s_add_u32 s22, s25, 3584
  buffer_load_dwordx4 v[88:91], v6, s[8:11], s22 offen offset:0 sc1
  buffer_load_dwordx4 v[92:95], v6, s[8:11], s22 offen offset:1792 sc1
  s_add_u32 s22, s25, 7168
  buffer_load_dwordx4 v[96:99], v6, s[8:11], s22 offen offset:0 sc1
  s_mul_i32 s38, s18, 7168
  s_add_u32 s38, s38, 88002560
  s_waitcnt vmcnt(6)
  ds_write_b128 v2, v[24:27] offset:12288
  ds_write_b128 v2, v[28:31] offset:13312
  v_smfmac_f32_16x16x64_bf16 v[36:39], v[24:27], a[32:39], v3
  buffer_load_dwordx4 v[100:103], v6, s[8:11], s22 offen offset:1792 sc1
  v_smfmac_f32_16x16x64_bf16 v[40:43], v[24:27], a[88:95], v3
  s_add_u32 s22, s25, 10752
  buffer_load_dwordx4 v[104:107], v6, s[8:11], s22 offen offset:0 sc1
  v_smfmac_f32_16x16x64_bf16 v[44:47], v[24:27], a[144:151], v3
  buffer_load_dwordx4 v[108:111], v6, s[8:11], s22 offen offset:1792 sc1
  v_smfmac_f32_16x16x64_bf16 v[48:51], v[24:27], a[200:207], v3
  s_add_u32 s22, s25, 14336
  buffer_load_dwordx4 v[112:115], v6, s[8:11], s22 offen offset:0 sc1
  v_smfmac_f32_16x16x64_bf16 v[52:55], v[24:27], v[176:183], v3
  s_waitcnt lgkmcnt(0)
  s_barrier
  ds_read_b128 v[8:11], v2 offset:8192
  ds_read_b128 v[12:15], v2 offset:9216
  ds_read_b128 v[16:19], v2 offset:10240
  ds_read_b128 v[20:23], v2 offset:11264
  ds_read_b128 v[32:35], v2 offset:14336
  buffer_load_dwordx4 v[116:119], v6, s[8:11], s22 offen offset:1792 sc1
  v_smfmac_f32_16x16x64_bf16 v[56:59], v[24:27], v[232:239], v3
  s_add_u32 s22, s25, 17920
  buffer_load_dwordx4 v[120:123], v6, s[8:11], s22 offen offset:0 sc1
  v_smfmac_f32_16x16x64_bf16 v[36:39], v[28:31], a[40:47], v3
  buffer_load_dwordx4 v[124:127], v6, s[8:11], s22 offen offset:1792 sc1
  v_smfmac_f32_16x16x64_bf16 v[40:43], v[28:31], a[96:103], v3
  s_add_u32 s22, s25, 21504
  buffer_load_dwordx4 v[128:131], v6, s[8:11], s22 offen offset:0 sc1
  v_smfmac_f32_16x16x64_bf16 v[44:47], v[28:31], a[152:159], v3
  buffer_load_dwordx4 v[132:135], v6, s[8:11], s22 offen offset:1792 sc1
  v_smfmac_f32_16x16x64_bf16 v[48:51], v[28:31], a[208:215], v3
  s_add_u32 s22, s25, 25088
  buffer_load_dwordx4 v[136:139], v6, s[8:11], s22 offen offset:0 sc1
  v_smfmac_f32_16x16x64_bf16 v[52:55], v[28:31], v[184:191], v3
  ds_read_b128 v[64:67], v0 offset:0
  ds_read_b128 v[68:71], v0 offset:1024
  buffer_load_dwordx4 v[140:143], v6, s[8:11], s22 offen offset:1792 sc1
  v_smfmac_f32_16x16x64_bf16 v[56:59], v[28:31], v[240:247], v3
  s_waitcnt lgkmcnt(6)
  ds_read_b128 v[72:75], v0 offset:2048
  ds_read_b128 v[76:79], v0 offset:3072
  v_smfmac_f32_16x16x64_bf16 v[36:39], v[8:11], a[0:7], v3
  s_waitcnt lgkmcnt(7)
  v_smfmac_f32_16x16x64_bf16 v[36:39], v[12:15], a[8:15], v3
  s_waitcnt lgkmcnt(6)
  v_smfmac_f32_16x16x64_bf16 v[36:39], v[16:19], a[16:23], v3
  s_waitcnt lgkmcnt(2)
  v_smfmac_f32_16x16x64_bf16 v[60:63], v[8:11], v[64:71], v3
  s_waitcnt lgkmcnt(5)
  ds_read_b128 v[144:147], v0 offset:4096
  ds_read_b128 v[148:151], v0 offset:5120
  v_smfmac_f32_16x16x64_bf16 v[36:39], v[20:23], a[24:31], v3
  s_waitcnt lgkmcnt(6)
  v_smfmac_f32_16x16x64_bf16 v[36:39], v[32:35], a[48:55], v3
  v_smfmac_f32_16x16x64_bf16 v[40:43], v[8:11], a[56:63], v3
  s_waitcnt lgkmcnt(2)
  v_smfmac_f32_16x16x64_bf16 v[60:63], v[12:15], v[72:79], v3
  ds_read_b128 v[64:67], v0 offset:6144
  ds_read_b128 v[68:71], v0 offset:7168
  v_smfmac_f32_16x16x64_bf16 v[40:43], v[12:15], a[64:71], v3
  v_permlane32_swap_b32 v36, v38
  v_smfmac_f32_16x16x64_bf16 v[40:43], v[16:19], a[72:79], v3
  v_permlane32_swap_b32 v37, v39
  v_smfmac_f32_16x16x64_bf16 v[40:43], v[20:23], a[80:87], v3
  s_waitcnt lgkmcnt(2)
  v_add_f32 v36, v36, v38
  v_smfmac_f32_16x16x64_bf16 v[60:63], v[16:19], v[144:151], v3
  ds_read_b128 v[72:75], v0 offset:8192
  ds_read_b128 v[76:79], v0 offset:9216
  v_add_f32 v37, v37, v39
  v_smfmac_f32_16x16x64_bf16 v[40:43], v[32:35], a[104:111], v3
  v_cmp_u_f32 vcc, v36, v37
  v_smfmac_f32_16x16x64_bf16 v[44:47], v[8:11], a[112:119], v3
  v_cvt_pk_bf16_f32 v38, v36, v37
  v_smfmac_f32_16x16x64_bf16 v[44:47], v[12:15], a[120:127], v3
  ds_write_b32 v152, v38
  s_waitcnt lgkmcnt(3)
  s_cbranch_vccnz cB_va0_slow
  v_permlane32_swap_b32 v40, v42
  v_smfmac_f32_16x16x64_bf16 v[60:63], v[20:23], v[64:71], v3
  ds_read_b128 v[144:147], v0 offset:10240
  ds_read_b128 v[148:151], v0 offset:11264
  v_permlane32_swap_b32 v41, v43
  v_smfmac_f32_16x16x64_bf16 v[44:47], v[16:19], a[128:135], v3
  buffer_store_dword v162, v1, s[8:11], s21 offen sc1
  v_add_f32 v40, v40, v42
  v_smfmac_f32_16x16x64_bf16 v[44:47], v[20:23], a[136:143], v3
  v_add_f32 v41, v41, v43
  v_smfmac_f32_16x16x64_bf16 v[44:47], v[32:35], a[160:167], v3
  s_waitcnt lgkmcnt(3)
  v_cvt_pk_bf16_f32 v42, v40, v41
  v_smfmac_f32_16x16x64_bf16 v[60:63], v[24:27], v[72:79], v3
  ds_write_b32 v153, v42
  ds_read_b128 v[64:67], v0 offset:12288
  ds_read_b128 v[68:71], v0 offset:13312
  v_smfmac_f32_16x16x64_bf16 v[48:51], v[8:11], a[168:175], v3
  s_nop 0
  v_permlane32_swap_b32 v44, v46
  v_smfmac_f32_16x16x64_bf16 v[48:51], v[12:15], a[176:183], v3
  v_permlane32_swap_b32 v45, v47
  v_smfmac_f32_16x16x64_bf16 v[48:51], v[16:19], a[184:191], v3
  s_waitcnt lgkmcnt(3)
  v_add_f32 v44, v44, v46
  v_smfmac_f32_16x16x64_bf16 v[60:63], v[28:31], v[144:151], v3
  v_add_f32 v45, v45, v47
  v_smfmac_f32_16x16x64_bf16 v[48:51], v[20:23], a[192:199], v3
  v_cvt_pk_bf16_f32 v46, v44, v45
  v_smfmac_f32_16x16x64_bf16 v[48:51], v[32:35], a[216:223], v3
  ds_write_b32 v154, v46
  v_smfmac_f32_16x16x64_bf16 v[52:55], v[8:11], a[224:231], v3
  s_waitcnt lgkmcnt(1)
  v_smfmac_f32_16x16x64_bf16 v[60:63], v[32:35], v[64:71], v3
  v_smfmac_f32_16x16x64_bf16 v[52:55], v[12:15], a[232:239], v3
  v_permlane32_swap_b32 v48, v50
  v_smfmac_f32_16x16x64_bf16 v[52:55], v[16:19], a[240:247], v3
  v_permlane32_swap_b32 v49, v51
  v_smfmac_f32_16x16x64_bf16 v[52:55], v[20:23], a[248:255], v3
  v_add_f32 v48, v48, v50
  v_smfmac_f32_16x16x64_bf16 v[52:55], v[32:35], v[192:199], v3
  v_add_f32 v49, v49, v51
  v_smfmac_f32_16x16x64_bf16 v[56:59], v[8:11], v[200:207], v3
  v_cvt_pk_bf16_f32 v50, v48, v49
  v_smfmac_f32_16x16x64_bf16 v[56:59], v[12:15], v[208:215], v3
  ds_write_b32 v155, v50
  v_permlane32_swap_b32 v60, v62
  v_smfmac_f32_16x16x64_bf16 v[56:59], v[16:19], v[216:223], v3
  v_permlane32_swap_b32 v61, v63
  v_smfmac_f32_16x16x64_bf16 v[56:59], v[20:23], v[224:231], v3
  v_add_f32 v60, v60, v62
  v_smfmac_f32_16x16x64_bf16 v[56:59], v[32:35], v[248:255], v3
  v_add_f32 v61, v61, v63
  v_cvt_pk_bf16_f32 v62, v60, v61
  ds_write_b32 v158, v62
  v_permlane32_swap_b32 v52, v54
  v_permlane32_swap_b32 v53, v55
  v_add_f32 v52, v52, v54
  v_add_f32 v53, v53, v55
  v_cvt_pk_bf16_f32 v54, v52, v53
  ds_write_b32 v156, v54
  v_permlane32_swap_b32 v56, v58
  v_permlane32_swap_b32 v57, v59
  v_add_f32 v56, v56, v58
  v_add_f32 v57, v57, v59
  v_cvt_pk_bf16_f32 v58, v56, v57
  ds_write_b32 v157, v58
cB_va0_t2d:
  s_add_u32 s22, s20, 9216
  s_add_u32 s34, s20, 13312
  s_add_u32 s36, s20, 7168
  s_mov_b32 s37, 0
  v_mov_b32 v48, 0
  v_mov_b32 v49, 0
  v_mov_b32 v50, 0
  v_mov_b32 v51, 0
  v_mov_b32 v163, s18
  s_waitcnt lgkmcnt(0)
  s_setprio 3
  buffer_load_dword v52, v4, s[8:11], 0 offen sc1
  buffer_load_dword v53, v4, s[8:11], 0 offen sc1
  buffer_load_dword v54, v4, s[8:11], 0 offen sc1
  buffer_load_dword v55, v4, s[8:11], 0 offen sc1
cB_va0_fw_l:
  s_waitcnt vmcnt(3)
  v_cmp_gt_u32 vcc, s18, v52
  s_cbranch_vccz cB_va0_fw_d
  buffer_load_dword v52, v4, s[8:11], 0 offen sc1
  s_waitcnt vmcnt(3)
  v_cmp_gt_u32 vcc, s18, v53
  s_cbranch_vccz cB_va0_fw_d
  buffer_load_dword v53, v4, s[8:11], 0 offen sc1
  s_waitcnt vmcnt(3)
  v_cmp_gt_u32 vcc, s18, v54
  s_cbranch_vccz cB_va0_fw_d
  buffer_load_dword v54, v4, s[8:11], 0 offen sc1
  s_waitcnt vmcnt(3)
  v_cmp_gt_u32 vcc, s18, v55
  s_cbranch_vccz cB_va0_fw_d
  buffer_load_dword v55, v4, s[8:11], 0 offen sc1
  s_add_u32 s30, s30, 1
  s_cmp_lt_u32 s30, 400000
  s_cbranch_scc1 cB_va0_fw_l
  s_branch cB_abort
cB_va0_fw_d:
  buffer_load_dwordx4 v[8:11], v2, s[8:11], s22 offen offset:0 sc1
  buffer_load_dwordx4 v[12:15], v2, s[8:11], s22 offen offset:1024 sc1
  buffer_load_dwordx4 v[16:19], v2, s[8:11], s22 offen offset:2048 sc1
  buffer_load_dwordx4 v[20:23], v2, s[8:11], s22 offen offset:3072 sc1
  buffer_load_dwordx4 v[24:27], v2, s[8:11], s34 offen offset:0 sc1
  buffer_load_dwordx4 v[28:31], v2, s[8:11], s34 offen offset:1024 sc1
  buffer_load_dwordx4 v[32:35], v2, s[8:11], s34 offen offset:2048 sc1
  buffer_load_dwordx4 v[36:39], v2, s[8:11], s34 offen offset:3072 sc1
  buffer_load_dwordx4 v[40:43], v2, s[8:11], s36 offen offset:0 sc1
  buffer_load_dwordx4 v[44:47], v2, s[8:11], s36 offen offset:1024 sc1
  s_barrier
  ds_read_b128 v[64:67], v2 offset:0
  ds_read_b128 v[68:71], v2 offset:1024
  ds_read_b128 v[72:75], v2 offset:2048
  ds_read_b128 v[76:79], v2 offset:3072
cB_va0_lp:
  s_waitcnt vmcnt(9)
  v_smfmac_f32_16x16x64_bf16 v[48:51], v[8:11], v[80:87], v3
  s_waitcnt vmcnt(8)
  v_smfmac_f32_16x16x64_bf16 v[48:51], v[12:15], v[88:95], v3
  s_waitcnt vmcnt(7)
  v_smfmac_f32_16x16x64_bf16 v[48:51], v[16:19], v[96:103], v3
  s_waitcnt vmcnt(6)
  v_smfmac_f32_16x16x64_bf16 v[48:51], v[20:23], v[104:111], v3
  s_waitcnt vmcnt(5)
  v_smfmac_f32_16x16x64_bf16 v[48:51], v[24:27], v[112:119], v3
  s_waitcnt vmcnt(4)
  v_smfmac_f32_16x16x64_bf16 v[48:51], v[28:31], v[120:127], v3
  s_waitcnt vmcnt(3)
  v_smfmac_f32_16x16x64_bf16 v[48:51], v[32:35], v[128:135], v3
  s_waitcnt vmcnt(2)
  v_smfmac_f32_16x16x64_bf16 v[48:51], v[36:39], v[136:143], v3
  s_waitcnt vmcnt(1) lgkmcnt(0)
  v_smfmac_f32_16x16x64_bf16 v[48:51], v[40:43], v[64:71], v3
  s_waitcnt vmcnt(0)
  v_smfmac_f32_16x16x64_bf16 v[48:51], v[44:47], v[72:79], v3
  s_nop 7
  v_permlane32_swap_b32 v48, v50
  v_permlane32_swap_b32 v49, v51
  v_add_f32 v48, v48, v50
  v_add_f32 v49, v49, v51
  v_cvt_pk_bf16_f32 v160, v48, v49
  v_cmp_u_f32 vcc, v48, v49
  s_nop 0
  v_mov_b32_dpp v161, v160 quad_perm:[1,0,3,2] row_mask:0xf bank_mask:0xf
  v_perm_b32 v160, v161, v160, v5
  v_min_u32 v160, -2, v160
  s_cbranch_vccnz cB_va0_rp
cB_va0_cont:
  buffer_store_dword v160, v1, s[8:11], s21 offen sc1
  s_setprio 0
  s_cmp_lg_u32 s19, 62
  s_cbranch_scc1 cB_va0_nl
  buffer_store_dword v160, v1, s[8:11], s38 offen sc1
  s_waitcnt vmcnt(0)
  buffer_wbl2 sc1
  s_branch cB_done
cB_va0_nl:
  s_add_u32 s25, s25, 458752
  v_mov_b32 v36, 0
  v_mov_b32 v37, 0
  v_mov_b32 v38, 0
  v_mov_b32 v39, 0
  v_mov_b32 v40, 0
  v_mov_b32 v41, 0
  v_mov_b32 v42, 0
  v_mov_b32 v43, 0
  v_mov_b32 v44, 0
  v_mov_b32 v45, 0
  v_mov_b32 v46, 0
  v_mov_b32 v47, 0
  v_mov_b32 v48, 0
  v_mov_b32 v49, 0
  v_mov_b32 v50, 0
  v_mov_b32 v51, 0
  v_mov_b32 v52, 0
  v_mov_b32 v53, 0
  v_mov_b32 v54, 0
  v_mov_b32 v55, 0
  v_mov_b32 v56, 0
  v_mov_b32 v57, 0
  v_mov_b32 v58, 0
  v_mov_b32 v59, 0
  v_mov_b32 v60, 0
  v_mov_b32 v61, 0
  v_mov_b32 v62, 0
  v_mov_b32 v63, 0
  s_mov_b32 s19, s18
  s_add_u32 s18, s18, 1
  s_mov_b32 s22, s20
  s_mov_b32 s20, s21
  s_mov_b32 s21, s22
  s_add_u32 s23, s20, 4096
  s_branch cB_va0_loop
cB_va0_slow:
  s_waitcnt lgkmcnt(0)
cB_va0_sl1:
  s_add_u32 s31, s31, 0x1000000
  buffer_load_dwordx4 v[8:11], v2, s[8:11], s20 offen offset:0 sc1
  buffer_load_dwordx4 v[12:15], v2, s[8:11], s20 offen offset:1024 sc1
  buffer_load_dwordx4 v[16:19], v2, s[8:11], s20 offen offset:2048 sc1
  buffer_load_dwordx4 v[20:23], v2, s[8:11], s20 offen offset:3072 sc1
  buffer_load_dwordx4 v[24:27], v2, s[8:11], s23 offen offset:0 sc1
  buffer_load_dwordx4 v[28:31], v2, s[8:11], s23 offen offset:1024 sc1
  buffer_load_dwordx4 v[32:35], v2, s[8:11], s23 offen offset:2048 sc1
  s_waitcnt vmcnt(0)
  v_max3_u32 v36, v8, v9, v10
  v_max3_u32 v36, v36, v11, v12
  v_max3_u32 v36, v36, v13, v14
  v_max3_u32 v36, v36, v15, v16
  v_max3_u32 v36, v36, v17, v18
  v_max3_u32 v36, v36, v19, v20
  v_max3_u32 v36, v36, v21, v22
  v_max3_u32 v36, v36, v23, v24
  v_max3_u32 v36, v36, v25, v26
  v_max3_u32 v36, v36, v27, v28
  v_max3_u32 v36, v36, v29, v30
  v_max3_u32 v36, v36, v31, v32
  v_max3_u32 v36, v36, v33, v34
  v_max_u32 v36, v36, v35
  v_cmp_eq_u32 vcc, -1, v36
  s_cbranch_vccz cB_va0_sl2
  s_add_u32 s30, s30, 1
  s_cmp_lt_u32 s30, 400000
  s_cbranch_scc1 cB_va0_sl1
  s_branch cB_abort
cB_va0_sl2:
  v_mov_b32 v36, 0
  v_mov_b32 v37, 0
  v_mov_b32 v38, 0
  v_mov_b32 v39, 0
  v_mov_b32 v40, 0
  v_mov_b32 v41, 0
  v_mov_b32 v42, 0
  v_mov_b32 v43, 0
  v_mov_b32 v44, 0
  v_mov_b32 v45, 0
  v_mov_b32 v46, 0
  v_mov_b32 v47, 0
  v_mov_b32 v48, 0
  v_mov_b32 v49, 0
  v_mov_b32 v50, 0
  v_mov_b32 v51, 0
  v_mov_b32 v52, 0
  v_mov_b32 v53, 0
  v_mov_b32 v54, 0
  v_mov_b32 v55, 0
  v_mov_b32 v56, 0
  v_mov_b32 v57, 0
  v_mov_b32 v58, 0
  v_mov_b32 v59, 0
  v_mov_b32 v60, 0
  v_mov_b32 v61, 0
  v_mov_b32 v62, 0
  v_mov_b32 v63, 0
  buffer_store_dword v162, v1, s[8:11], s21 offen sc1
  ds_read_b128 v[64:67], v0 offset:0
  ds_read_b128 v[68:71], v0 offset:1024
  v_smfmac_f32_16x16x64_bf16 v[36:39], v[8:11], a[0:7], v3
  v_smfmac_f32_16x16x64_bf16 v[40:43], v[8:11], a[56:63], v3
  v_smfmac_f32_16x16x64_bf16 v[44:47], v[8:11], a[112:119], v3
  v_smfmac_f32_16x16x64_bf16 v[48:51], v[8:11], a[168:175], v3
  v_smfmac_f32_16x16x64_bf16 v[52:55], v[8:11], a[224:231], v3
  v_smfmac_f32_16x16x64_bf16 v[56:59], v[8:11], v[200:207], v3
  s_waitcnt lgkmcnt(0)
  v_smfmac_f32_16x16x64_bf16 v[60:63], v[8:11], v[64:71], v3
  ds_read_b128 v[72:75], v0 offset:2048
  ds_read_b128 v[76:79], v0 offset:3072
  v_smfmac_f32_16x16x64_bf16 v[36:39], v[12:15], a[8:15], v3
  v_smfmac_f32_16x16x64_bf16 v[40:43], v[12:15], a[64:71], v3
  v_smfmac_f32_16x16x64_bf16 v[44:47], v[12:15], a[120:127], v3
  v_smfmac_f32_16x16x64_bf16 v[48:51], v[12:15], a[176:183], v3
  v_smfmac_f32_16x16x64_bf16 v[52:55], v[12:15], a[232:239], v3
  v_smfmac_f32_16x16x64_bf16 v[56:59], v[12:15], v[208:215], v3
  s_waitcnt lgkmcnt(0)
  v_smfmac_f32_16x16x64_bf16 v[60:63], v[12:15], v[72:79], v3
  ds_read_b128 v[144:147], v0 offset:4096
  ds_read_b128 v[148:151], v0 offset:5120
  v_smfmac_f32_16x16x64_bf16 v[36:39], v[16:19], a[16:23], v3
  v_smfmac_f32_16x16x64_bf16 v[40:43], v[16:19], a[72:79], v3
  v_smfmac_f32_16x16x64_bf16 v[44:47], v[16:19], a[128:135], v3
  v_smfmac_f32_16x16x64_bf16 v[48:51], v[16:19], a[184:191], v3
  v_smfmac_f32_16x16x64_bf16 v[52:55], v[16:19], a[240:247], v3
  v_smfmac_f32_16x16x64_bf16 v[56:59], v[16:19], v[216:223], v3
  s_waitcnt lgkmcnt(0)
  v_smfmac_f32_16x16x64_bf16 v[60:63], v[16:19], v[144:151], v3
  ds_read_b128 v[64:67], v0 offset:6144
  ds_read_b128 v[68:71], v0 offset:7168
  v_smfmac_f32_16x16x64_bf16 v[36:39], v[20:23], a[24:31], v3
  v_smfmac_f32_16x16x64_bf16 v[40:43], v[20:23], a[80:87], v3
  v_smfmac_f32_16x16x64_bf16 v[44:47], v[20:23], a[136:143], v3
  v_smfmac_f32_16x16x64_bf16 v[48:51], v[20:23], a[192:199], v3
  v_smfmac_f32_16x16x64_bf16 v[52:55], v[20:23], a[248:255], v3
  v_smfmac_f32_16x16x64_bf16 v[56:59], v[20:23], v[224:231], v3
  s_waitcnt lgkmcnt(0)
  v_smfmac_f32_16x16x64_bf16 v[60:63], v[20:23], v[64:71], v3
  ds_read_b128 v[72:75], v0 offset:8192
  ds_read_b128 v[76:79], v0 offset:9216
  v_smfmac_f32_16x16x64_bf16 v[36:39], v[24:27], a[32:39], v3
  v_smfmac_f32_16x16x64_bf16 v[40:43], v[24:27], a[88:95], v3
  v_smfmac_f32_16x16x64_bf16 v[44:47], v[24:27], a[144:151], v3
  v_smfmac_f32_16x16x64_bf16 v[48:51], v[24:27], a[200:207], v3
  v_smfmac_f32_16x16x64_bf16 v[52:55], v[24:27], v[176:183], v3
  v_smfmac_f32_16x16x64_bf16 v[56:59], v[24:27], v[232:239], v3
  s_waitcnt lgkmcnt(0)
  v_smfmac_f32_16x16x64_bf16 v[60:63], v[24:27], v[72:79], v3
  ds_read_b128 v[144:147], v0 offset:10240
  ds_read_b128 v[148:151], v0 offset:11264
  v_smfmac_f32_16x16x64_bf16 v[36:39], v[28:31], a[40:47], v3
  v_smfmac_f32_16x16x64_bf16 v[40:43], v[28:31], a[96:103], v3
  v_smfmac_f32_16x16x64_bf16 v[44:47], v[28:31], a[152:159], v3
  v_smfmac_f32_16x16x64_bf16 v[48:51], v[28:31], a[208:215], v3
  v_smfmac_f32_16x16x64_bf16 v[52:55], v[28:31], v[184:191], v3
  v_smfmac_f32_16x16x64_bf16 v[56:59], v[28:31], v[240:247], v3
  s_waitcnt lgkmcnt(0)
  v_smfmac_f32_16x16x64_bf16 v[60:63], v[28:31], v[144:151], v3
  ds_read_b128 v[64:67], v0 offset:12288
  ds_read_b128 v[68:71], v0 offset:13312
  v_smfmac_f32_16x16x64_bf16 v[36:39], v[32:35], a[48:55], v3
  v_smfmac_f32_16x16x64_bf16 v[40:43], v[32:35], a[104:111], v3
  v_smfmac_f32_16x16x64_bf16 v[44:47], v[32:35], a[160:167], v3
  v_smfmac_f32_16x16x64_bf16 v[48:51], v[32:35], a[216:223], v3
  v_smfmac_f32_16x16x64_bf16 v[52:55], v[32:35], v[192:199], v3
  v_smfmac_f32_16x16x64_bf16 v[56:59], v[32:35], v[248:255], v3
  s_waitcnt lgkmcnt(0)
  v_smfmac_f32_16x16x64_bf16 v[60:63], v[32:35], v[64:71], v3
  v_permlane32_swap_b32 v36, v38
  v_permlane32_swap_b32 v37, v39
  v_add_f32 v36, v36, v38
  v_add_f32 v37, v37, v39
  v_cvt_pk_bf16_f32 v38, v36, v37
  ds_write_b32 v152, v38
  v_permlane32_swap_b32 v40, v42
  v_permlane32_swap_b32 v41, v43
  v_add_f32 v40, v40, v42
  v_add_f32 v41, v41, v43
  v_cvt_pk_bf16_f32 v42, v40, v41
  ds_write_b32 v153, v42
  v_permlane32_swap_b32 v44, v46
  v_permlane32_swap_b32 v45, v47
  v_add_f32 v44, v44, v46
  v_add_f32 v45, v45, v47
  v_cvt_pk_bf16_f32 v46, v44, v45
  ds_write_b32 v154, v46
  v_permlane32_swap_b32 v48, v50
  v_permlane32_swap_b32 v49, v51
  v_add_f32 v48, v48, v50
  v_add_f32 v49, v49, v51
  v_cvt_pk_bf16_f32 v50, v48, v49
  ds_write_b32 v155, v50
  v_permlane32_swap_b32 v52, v54
  v_permlane32_swap_b32 v53, v55
  v_add_f32 v52, v52, v54
  v_add_f32 v53, v53, v55
  v_cvt_pk_bf16_f32 v54, v52, v53
  ds_write_b32 v156, v54
  v_permlane32_swap_b32 v56, v58
  v_permlane32_swap_b32 v57, v59
  v_add_f32 v56, v56, v58
  v_add_f32 v57, v57, v59
  v_cvt_pk_bf16_f32 v58, v56, v57
  ds_write_b32 v157, v58
  v_permlane32_swap_b32 v60, v62
  v_permlane32_swap_b32 v61, v63
  v_add_f32 v60, v60, v62
  v_add_f32 v61, v61, v63
  v_cvt_pk_bf16_f32 v62, v60, v61
  ds_write_b32 v158, v62
  s_branch cB_va0_t2d
cB_va0_rp:
  s_cmp_lg_u32 s37, 0
  s_cbranch_scc1 cB_va0_cont
cB_va0_rv:
  s_add_u32 s31, s31, 0x10000
  buffer_load_dwordx4 v[8:11], v2, s[8:11], s22 offen offset:0 sc1
  buffer_load_dwordx4 v[12:15], v2, s[8:11], s22 offen offset:1024 sc1
  buffer_load_dwordx4 v[16:19], v2, s[8:11], s22 offen offset:2048 sc1
  buffer_load_dwordx4 v[20:23], v2, s[8:11], s22 offen offset:3072 sc1
  buffer_load_dwordx4 v[24:27], v2, s[8:11], s34 offen offset:0 sc1
  buffer_load_dwordx4 v[28:31], v2, s[8:11], s34 offen offset:1024 sc1
  buffer_load_dwordx4 v[32:35], v2, s[8:11], s34 offen offset:2048 sc1
  buffer_load_dwordx4 v[36:39], v2, s[8:11], s34 offen offset:3072 sc1
  buffer_load_dwordx4 v[40:43], v2, s[8:11], s36 offen offset:0 sc1
  buffer_load_dwordx4 v[44:47], v2, s[8:11], s36 offen offset:1024 sc1
  s_waitcnt vmcnt(0)
  v_max3_u32 v52, v8, v9, v10
  v_max3_u32 v52, v52, v11, v12
  v_max3_u32 v52, v52, v13, v14
  v_max3_u32 v52, v52, v15, v16
  v_max3_u32 v52, v52, v17, v18
  v_max3_u32 v52, v52, v19, v20
  v_max3_u32 v52, v52, v21, v22
  v_max3_u32 v52, v52, v23, v24
  v_max3_u32 v52, v52, v25, v26
  v_max3_u32 v52, v52, v27, v28
  v_max3_u32 v52, v52, v29, v30
  v_max3_u32 v52, v52, v31, v32
  v_max3_u32 v52, v52, v33, v34
  v_max3_u32 v52, v52, v35, v36
  v_max3_u32 v52, v52, v37, v38
  v_max3_u32 v52, v52, v39, v40
  v_max3_u32 v52, v52, v41, v42
  v_max3_u32 v52, v52, v43, v44
  v_max3_u32 v52, v52, v45, v46
  v_max_u32 v52, v52, v47
  v_cmp_eq_u32 vcc, -1, v52
  s_mov_b32 s37, 1
  v_mov_b32 v48, 0
  v_mov_b32 v49, 0
  v_mov_b32 v50, 0
  v_mov_b32 v51, 0
  s_nop 1
  s_cbranch_vccz cB_va0_lp
  s_add_u32 s30, s30, 1
  s_cmp_lt_u32 s30, 400000
  s_cbranch_scc1 cB_va0_rv
  s_branch cB_abort
.p2align 6
cB_va1_loop:
  s_mov_b32 s30, 0
  s_barrier
  buffer_load_dwordx4 v[28:31], v2, s[8:11], s23 offen offset:1024 sc1
  buffer_load_dwordx4 v[32:35], v2, s[8:11], s23 offen offset:2048 sc1
  s_barrier
  buffer_store_dword v160, v1, s[8:11], s38 offen sc1
  s_add_u32 s22, s25, 0
  buffer_load_dwordx4 v[80:83], v6, s[8:11], s22 offen offset:0 sc1
  buffer_load_dwordx4 v[84:87], v6, s[8:11], s22 offen offset:1792 sc1
  s_add_u32 s22, s25, 3584
  buffer_load_dwordx4 v[88:91], v6, s[8:11], s22 offen offset:0 sc1
  buffer_load_dwordx4 v[92:95], v6, s[8:11], s22 offen offset:1792 sc1
  s_add_u32 s22, s25, 7168
  buffer_load_dwordx4 v[96:99], v6, s[8:11], s22 offen offset:0 sc1
  s_mul_i32 s38, s18, 7168
  s_add_u32 s38, s38, 88002560
  s_waitcnt vmcnt(6)
  ds_write_b128 v2, v[32:35] offset:14336
  v_smfmac_f32_16x16x64_bf16 v[36:39], v[28:31], a[40:47], v3
  buffer_load_dwordx4 v[100:103], v6, s[8:11], s22 offen offset:1792 sc1
  v_smfmac_f32_16x16x64_bf16 v[40:43], v[28:31], a[96:103], v3
  s_add_u32 s22, s25, 10752
  buffer_load_dwordx4 v[104:107], v6, s[8:11], s22 offen offset:0 sc1
  v_smfmac_f32_16x16x64_bf16 v[44:47], v[28:31], a[152:159], v3
  buffer_load_dwordx4 v[108:111], v6, s[8:11], s22 offen offset:1792 sc1
  v_smfmac_f32_16x16x64_bf16 v[48:51], v[28:31], a[208:215], v3
  s_add_u32 s22, s25, 14336
  buffer_load_dwordx4 v[112:115], v6, s[8:11], s22 offen offset:0 sc1
  v_smfmac_f32_16x16x64_bf16 v[52:55], v[28:31], v[184:191], v3
  s_waitcnt lgkmcnt(0)
  s_barrier
  ds_read_b128 v[8:11], v2 offset:8192
  ds_read_b128 v[12:15], v2 offset:9216
  ds_read_b128 v[16:19], v2 offset:10240
  ds_read_b128 v[20:23], v2 offset:11264
  ds_read_b128 v[24:27], v2 offset:12288
  buffer_load_dwordx4 v[116:119], v6, s[8:11], s22 offen offset:1792 sc1
  v_smfmac_f32_16x16x64_bf16 v[56:59], v[28:31], v[240:247], v3
  s_add_u32 s22, s25, 17920
  buffer_load_dwordx4 v[120:123], v6, s[8:11], s22 offen offset:0 sc1
  v_smfmac_f32_16x16x64_bf16 v[36:39], v[32:35], a[48:55], v3
  buffer_load_dwordx4 v[124:127], v6, s[8:11], s22 offen offset:1792 sc1
  v_smfmac_f32_16x16x64_bf16 v[40:43], v[32:35], a[104:111], v3
  s_add_u32 s22, s25, 21504
  buffer_load_dwordx4 v[128:131], v6, s[8:11], s22 offen offset:0 sc1
  v_smfmac_f32_16x16x64_bf16 v[44:47], v[32:35], a[160:167], v3
  buffer_load_dwordx4 v[132:135], v6, s[8:11], s22 offen offset:1792 sc1
  v_smfmac_f32_16x16x64_bf16 v[48:51], v[32:35], a[216:223], v3
  s_add_u32 s22, s25, 25088
  buffer_load_dwordx4 v[136:139], v6, s[8:11], s22 offen offset:0 sc1
  v_smfmac_f32_16x16x64_bf16 v[52:55], v[32:35], v[192:199], v3
  ds_read_b128 v[64:67], v0 offset:0
  ds_read_b128 v[68:71], v0 offset:1024
  buffer_load_dwordx4 v[140:143], v6, s[8:11], s22 offen offset:1792 sc1
  v_smfmac_f32_16x16x64_bf16 v[56:59], v[32:35], v[248:255], v3
  s_waitcnt lgkmcnt(6)
  ds_read_b128 v[72:75], v0 offset:2048
  ds_read_b128 v[76:79], v0 offset:3072
  v_smfmac_f32_16x16x64_bf16 v[36:39], v[8:11], a[0:7], v3
  s_waitcnt lgkmcnt(7)
  v_smfmac_f32_16x16x64_bf16 v[36:39], v[12:15], a[8:15], v3
  s_waitcnt lgkmcnt(6)
  v_smfmac_f32_16x16x64_bf16 v[36:39], v[16:19], a[16:23], v3
  s_waitcnt lgkmcnt(2)
  v_smfmac_f32_16x16x64_bf16 v[60:63], v[8:11], v[64:71], v3
  s_waitcnt lgkmcnt(5)
  ds_read_b128 v[144:147], v0 offset:4096
  ds_read_b128 v[148:151], v0 offset:5120
  v_smfmac_f32_16x16x64_bf16 v[36:39], v[20:23], a[24:31], v3
  s_waitcnt lgkmcnt(6)
  v_smfmac_f32_16x16x64_bf16 v[36:39], v[24:27], a[32:39], v3
  v_smfmac_f32_16x16x64_bf16 v[40:43], v[8:11], a[56:63], v3
  s_waitcnt lgkmcnt(2)
  v_smfmac_f32_16x16x64_bf16 v[60:63], v[12:15], v[72:79], v3
  ds_read_b128 v[64:67], v0 offset:6144
  ds_read_b128 v[68:71], v0 offset:7168
  v_smfmac_f32_16x16x64_bf16 v[40:43], v[12:15], a[64:71], v3
  v_permlane32_swap_b32 v36, v38
  v_smfmac_f32_16x16x64_bf16 v[40:43], v[16:19], a[72:79], v3
  v_permlane32_swap_b32 v37, v39
  v_smfmac_f32_16x16x64_bf16 v[40:43], v[20:23], a[80:87], v3
  s_waitcnt lgkmcnt(2)
  v_add_f32 v36, v36, v38
  v_smfmac_f32_16x16x64_bf16 v[60:63], v[16:19], v[144:151], v3
  ds_read_b128 v[72:75], v0 offset:8192
  ds_read_b128 v[76:79], v0 offset:9216
  v_add_f32 v37, v37, v39
  v_smfmac_f32_16x16x64_bf16 v[40:43], v[24:27], a[88:95], v3
  v_cmp_u_f32 vcc, v36, v37
  v_smfmac_f32_16x16x64_bf16 v[44:47], v[8:11], a[112:119], v3
  v_cvt_pk_bf16_f32 v38, v36, v37
  v_smfmac_f32_16x16x64_bf16 v[44:47], v[12:15], a[120:127], v3
  ds_write_b32 v152, v38
  s_waitcnt lgkmcnt(3)
  s_cbranch_vccnz cB_va1_slow
  v_permlane32_swap_b32 v40, v42
  v_smfmac_f32_16x16x64_bf16 v[60:63], v[20:23], v[64:71], v3
  ds_read_b128 v[144:147], v0 offset:10240
  ds_read_b128 v[148:151], v0 offset:11264
  v_permlane32_swap_b32 v41, v43
  v_smfmac_f32_16x16x64_bf16 v[44:47], v[16:19], a[128:135], v3
  buffer_store_dword v162, v1, s[8:11], s21 offen sc1
  v_add_f32 v40, v40, v42
  v_smfmac_f32_16x16x64_bf16 v[44:47], v[20:23], a[136:143], v3
  v_add_f32 v41, v41, v43
  v_smfmac_f32_16x16x64_bf16 v[44:47], v[24:27], a[144:151], v3
  s_waitcnt lgkmcnt(3)
  v_cvt_pk_bf16_f32 v42, v40, v41
  v_smfmac_f32_16x16x64_bf16 v[60:63], v[24:27], v[72:79], v3
  ds_write_b32 v153, v42
  ds_read_b128 v[64:67], v0 offset:12288
  ds_read_b128 v[68:71], v0 offset:13312
  v_smfmac_f32_16x16x64_bf16 v[48:51], v[8:11], a[168:175], v3
  s_nop 0
  v_permlane32_swap_b32 v44, v46
  v_smfmac_f32_16x16x64_bf16 v[48:51], v[12:15], a[176:183], v3
  v_permlane32_swap_b32 v45, v47
  v_smfmac_f32_16x16x64_bf16 v[48:51], v[16:19], a[184:191], v3
  s_waitcnt lgkmcnt(3)
  v_add_f32 v44, v44, v46
  v_smfmac_f32_16x16x64_bf16 v[60:63], v[28:31], v[144:151], v3
  v_add_f32 v45, v45, v47
  v_smfmac_f32_16x16x64_bf16 v[48:51], v[20:23], a[192:199], v3
  v_cvt_pk_bf16_f32 v46, v44, v45
  v_smfmac_f32_16x16x64_bf16 v[48:51], v[24:27], a[200:207], v3
  ds_write_b32 v154, v46
  v_smfmac_f32_16x16x64_bf16 v[52:55], v[8:11], a[224:231], v3
  s_waitcnt lgkmcnt(1)
  v_smfmac_f32_16x16x64_bf16 v[60:63], v[32:35], v[64:71], v3
  v_smfmac_f32_16x16x64_bf16 v[52:55], v[12:15], a[232:239], v3
  v_permlane32_swap_b32 v48, v50
  v_smfmac_f32_16x16x64_bf16 v[52:55], v[16:19], a[240:247], v3
  v_permlane32_swap_b32 v49, v51
  v_smfmac_f32_16x16x64_bf16 v[52:55], v[20:23], a[248:255], v3
  v_add_f32 v48, v48, v50
  v_smfmac_f32_16x16x64_bf16 v[52:55], v[24:27], v[176:183], v3
  v_add_f32 v49, v49, v51
  v_smfmac_f32_16x16x64_bf16 v[56:59], v[8:11], v[200:207], v3
  v_cvt_pk_bf16_f32 v50, v48, v49
  v_smfmac_f32_16x16x64_bf16 v[56:59], v[12:15], v[208:215], v3
  ds_write_b32 v155, v50
  v_permlane32_swap_b32 v60, v62
  v_smfmac_f32_16x16x64_bf16 v[56:59], v[16:19], v[216:223], v3
  v_permlane32_swap_b32 v61, v63
  v_smfmac_f32_16x16x64_bf16 v[56:59], v[20:23], v[224:231], v3
  v_add_f32 v60, v60, v62
  v_smfmac_f32_16x16x64_bf16 v[56:59], v[24:27], v[232:239], v3
  v_add_f32 v61, v61, v63
  v_cvt_pk_bf16_f32 v62, v60, v61
  ds_write_b32 v158, v62
  v_permlane32_swap_b32 v52, v54
  v_permlane32_swap_b32 v53, v55
  v_add_f32 v52, v52, v54
  v_add_f32 v53, v53, v55
  v_cvt_pk_bf16_f32 v54, v52, v53
  ds_write_b32 v156, v54
  v_permlane32_swap_b32 v56, v58
  v_permlane32_swap_b32 v57, v59
  v_add_f32 v56, v56, v58
  v_add_f32 v57, v57, v59
  v_cvt_pk_bf16_f32 v58, v56, v57
  ds_write_b32 v157, v58
cB_va1_t2d:
  s_add_u32 s22, s20, 9216
  s_add_u32 s34, s20, 13312
  s_add_u32 s36, s20, 7168
  s_mov_b32 s37, 0
  v_mov_b32 v48, 0
  v_mov_b32 v49, 0
  v_mov_b32 v50, 0
  v_mov_b32 v51, 0
  v_mov_b32 v163, s18
  s_waitcnt lgkmcnt(0)
  s_barrier
  buffer_load_dwordx4 v[8:11], v2, s[8:11], s22 offen offset:0 sc1
  buffer_load_dwordx4 v[12:15], v2, s[8:11], s22 offen offset:1024 sc1
  buffer_load_dwordx4 v[16:19], v2, s[8:11], s22 offen offset:2048 sc1
  buffer_load_dwordx4 v[20:23], v2, s[8:11], s22 offen offset:3072 sc1
  buffer_load_dwordx4 v[24:27], v2, s[8:11], s34 offen offset:0 sc1
  buffer_load_dwordx4 v[28:31], v2, s[8:11], s34 offen offset:1024 sc1
  buffer_load_dwordx4 v[32:35], v2, s[8:11], s34 offen offset:2048 sc1
  buffer_load_dwordx4 v[36:39], v2, s[8:11], s34 offen offset:3072 sc1
  buffer_load_dwordx4 v[40:43], v2, s[8:11], s36 offen offset:0 sc1
  buffer_load_dwordx4 v[44:47], v2, s[8:11], s36 offen offset:1024 sc1
  ds_read_b128 v[64:67], v2 offset:4096
  ds_read_b128 v[68:71], v2 offset:5120
  ds_read_b128 v[72:75], v2 offset:6144
  ds_read_b128 v[76:79], v2 offset:7168
cB_va1_lp:
  s_waitcnt vmcnt(9)
  v_smfmac_f32_16x16x64_bf16 v[48:51], v[8:11], v[80:87], v3
  s_waitcnt vmcnt(8)
  v_smfmac_f32_16x16x64_bf16 v[48:51], v[12:15], v[88:95], v3
  s_waitcnt vmcnt(7)
  v_smfmac_f32_16x16x64_bf16 v[48:51], v[16:19], v[96:103], v3
  v_max3_u32 v55, v8, v12, v16
  s_waitcnt vmcnt(6)
  v_smfmac_f32_16x16x64_bf16 v[48:51], v[20:23], v[104:111], v3
  v_max_u32 v55, v55, v20
  v_cmp_eq_u32 vcc, -1, v55
  s_waitcnt vmcnt(5)
  v_smfmac_f32_16x16x64_bf16 v[48:51], v[24:27], v[112:119], v3
  s_waitcnt vmcnt(4)
  v_smfmac_f32_16x16x64_bf16 v[48:51], v[28:31], v[120:127], v3
  s_cbranch_vccnz cB_va1_rv
  buffer_store_dword v163, v7, s[8:11], 0 offen sc1
  s_waitcnt vmcnt(4)
  v_smfmac_f32_16x16x64_bf16 v[48:51], v[32:35], v[128:135], v3
  s_waitcnt vmcnt(3)
  v_smfmac_f32_16x16x64_bf16 v[48:51], v[36:39], v[136:143], v3
  s_waitcnt vmcnt(2) lgkmcnt(0)
  v_smfmac_f32_16x16x64_bf16 v[48:51], v[40:43], v[64:71], v3
  s_waitcnt vmcnt(1)
  v_smfmac_f32_16x16x64_bf16 v[48:51], v[44:47], v[72:79], v3
  s_nop 7
  v_permlane32_swap_b32 v48, v50
  v_permlane32_swap_b32 v49, v51
  v_add_f32 v48, v48, v50
  v_add_f32 v49, v49, v51
  v_cvt_pk_bf16_f32 v160, v48, v49
  v_cmp_u_f32 vcc, v48, v49
  s_nop 0
  v_mov_b32_dpp v161, v160 quad_perm:[1,0,3,2] row_mask:0xf bank_mask:0xf
  v_perm_b32 v160, v161, v160, v5
  v_min_u32 v160, -2, v160
  s_cbranch_vccnz cB_va1_rp
cB_va1_cont:
  buffer_store_dword v160, v1, s[8:11], s21 offen sc1
  s_cmp_lg_u32 s19, 62
  s_cbranch_scc1 cB_va1_nl
  buffer_store_dword v160, v1, s[8:11], s38 offen sc1
  s_waitcnt vmcnt(0)
  buffer_wbl2 sc1
  s_branch cB_done
cB_va1_nl:
  s_add_u32 s25, s25, 458752
  v_mov_b32 v36, 0
  v_mov_b32 v37, 0
  v_mov_b32 v38, 0
  v_mov_b32 v39, 0
  v_mov_b32 v40, 0
  v_mov_b32 v41, 0
  v_mov_b32 v42, 0
  v_mov_b32 v43, 0
  v_mov_b32 v44, 0
  v_mov_b32 v45, 0
  v_mov_b32 v46, 0
  v_mov_b32 v47, 0
  v_mov_b32 v48, 0
  v_mov_b32 v49, 0
  v_mov_b32 v50, 0
  v_mov_b32 v51, 0
  v_mov_b32 v52, 0
  v_mov_b32 v53, 0
  v_mov_b32 v54, 0
  v_mov_b32 v55, 0
  v_mov_b32 v56, 0
  v_mov_b32 v57, 0
  v_mov_b32 v58, 0
  v_mov_b32 v59, 0
  v_mov_b32 v60, 0
  v_mov_b32 v61, 0
  v_mov_b32 v62, 0
  v_mov_b32 v63, 0
  s_mov_b32 s19, s18
  s_add_u32 s18, s18, 1
  s_mov_b32 s22, s20
  s_mov_b32 s20, s21
  s_mov_b32 s21, s22
  s_add_u32 s23, s20, 4096
  s_branch cB_va1_loop
cB_va1_slow:
  s_waitcnt lgkmcnt(0)
cB_va1_sl1:
  s_add_u32 s31, s31, 0x1000000
  buffer_load_dwordx4 v[8:11], v2, s[8:11], s20 offen offset:0 sc1
  buffer_load_dwordx4 v[12:15], v2, s[8:11], s20 offen offset:1024 sc1
  buffer_load_dwordx4 v[16:19], v2, s[8:11], s20 offen offset:2048 sc1
  buffer_load_dwordx4 v[20:23], v2, s[8:11], s20 offen offset:3072 sc1
  buffer_load_dwordx4 v[24:27], v2, s[8:11], s23 offen offset:0 sc1
  buffer_load_dwordx4 v[28:31], v2, s[8:11], s23 offen offset:1024 sc1
  buffer_load_dwordx4 v[32:35], v2, s[8:11], s23 offen offset:2048 sc1
  s_waitcnt vmcnt(0)
  v_max3_u32 v36, v8, v9, v10
  v_max3_u32 v36, v36, v11, v12
  v_max3_u32 v36, v36, v13, v14
  v_max3_u32 v36, v36, v15, v16
  v_max3_u32 v36, v36, v17, v18
  v_max3_u32 v36, v36, v19, v20
  v_max3_u32 v36, v36, v21, v22
  v_max3_u32 v36, v36, v23, v24
  v_max3_u32 v36, v36, v25, v26
  v_max3_u32 v36, v36, v27, v28
  v_max3_u32 v36, v36, v29, v30
  v_max3_u32 v36, v36, v31, v32
  v_max3_u32 v36, v36, v33, v34
  v_max_u32 v36, v36, v35
  v_cmp_eq_u32 vcc, -1, v36
  s_cbranch_vccz cB_va1_sl2
  s_add_u32 s30, s30, 1
  s_cmp_lt_u32 s30, 400000
  s_cbranch_scc1 cB_va1_sl1
  s_branch cB_abort
cB_va1_sl2:
  v_mov_b32 v36, 0
  v_mov_b32 v37, 0
  v_mov_b32 v38, 0
  v_mov_b32 v39, 0
  v_mov_b32 v40, 0
  v_mov_b32 v41, 0
  v_mov_b32 v42, 0
  v_mov_b32 v43, 0
  v_mov_b32 v44, 0
  v_mov_b32 v45, 0
  v_mov_b32 v46, 0
  v_mov_b32 v47, 0
  v_mov_b32 v48, 0
  v_mov_b32 v49, 0
  v_mov_b32 v50, 0
  v_mov_b32 v51, 0
  v_mov_b32 v52, 0
  v_mov_b32 v53, 0
  v_mov_b32 v54, 0
  v_mov_b32 v55, 0
  v_mov_b32 v56, 0
  v_mov_b32 v57, 0
  v_mov_b32 v58, 0
  v_mov_b32 v59, 0
  v_mov_b32 v60, 0
  v_mov_b32 v61, 0
  v_mov_b32 v62, 0
  v_mov_b32 v63, 0
  buffer_store_dword v162, v1, s[8:11], s21 offen sc1
  ds_read_b128 v[64:67], v0 offset:0
  ds_read_b128 v[68:71], v0 offset:1024
  v_smfmac_f32_16x16x64_bf16 v[36:39], v[8:11], a[0:7], v3
  v_smfmac_f32_16x16x64_bf16 v[40:43], v[8:11], a[56:63], v3
  v_smfmac_f32_16x16x64_bf16 v[44:47], v[8:11], a[112:119], v3
  v_smfmac_f32_16x16x64_bf16 v[48:51], v[8:11], a[168:175], v3
  v_smfmac_f32_16x16x64_bf16 v[52:55], v[8:11], a[224:231], v3
  v_smfmac_f32_16x16x64_bf16 v[56:59], v[8:11], v[200:207], v3
  s_waitcnt lgkmcnt(0)
  v_smfmac_f32_16x16x64_bf16 v[60:63], v[8:11], v[64:71], v3
  ds_read_b128 v[72:75], v0 offset:2048
  ds_read_b128 v[76:79], v0 offset:3072
  v_smfmac_f32_16x16x64_bf16 v[36:39], v[12:15], a[8:15], v3
  v_smfmac_f32_16x16x64_bf16 v[40:43], v[12:15], a[64:71], v3
  v_smfmac_f32_16x16x64_bf16 v[44:47], v[12:15], a[120:127], v3
  v_smfmac_f32_16x16x64_bf16 v[48:51], v[12:15], a[176:183], v3
  v_smfmac_f32_16x16x64_bf16 v[52:55], v[12:15], a[232:239], v3
  v_smfmac_f32_16x16x64_bf16 v[56:59], v[12:15], v[208:215], v3
  s_waitcnt lgkmcnt(0)
  v_smfmac_f32_16x16x64_bf16 v[60:63], v[12:15], v[72:79], v3
  ds_read_b128 v[144:147], v0 offset:4096
  ds_read_b128 v[148:151], v0 offset:5120
  v_smfmac_f32_16x16x64_bf16 v[36:39], v[16:19], a[16:23], v3
  v_smfmac_f32_16x16x64_bf16 v[40:43], v[16:19], a[72:79], v3
  v_smfmac_f32_16x16x64_bf16 v[44:47], v[16:19], a[128:135], v3
  v_smfmac_f32_16x16x64_bf16 v[48:51], v[16:19], a[184:191], v3
  v_smfmac_f32_16x16x64_bf16 v[52:55], v[16:19], a[240:247], v3
  v_smfmac_f32_16x16x64_bf16 v[56:59], v[16:19], v[216:223], v3
  s_waitcnt lgkmcnt(0)
  v_smfmac_f32_16x16x64_bf16 v[60:63], v[16:19], v[144:151], v3
  ds_read_b128 v[64:67], v0 offset:6144
  ds_read_b128 v[68:71], v0 offset:7168
  v_smfmac_f32_16x16x64_bf16 v[36:39], v[20:23], a[24:31], v3
  v_smfmac_f32_16x16x64_bf16 v[40:43], v[20:23], a[80:87], v3
  v_smfmac_f32_16x16x64_bf16 v[44:47], v[20:23], a[136:143], v3
  v_smfmac_f32_16x16x64_bf16 v[48:51], v[20:23], a[192:199], v3
  v_smfmac_f32_16x16x64_bf16 v[52:55], v[20:23], a[248:255], v3
  v_smfmac_f32_16x16x64_bf16 v[56:59], v[20:23], v[224:231], v3
  s_waitcnt lgkmcnt(0)
  v_smfmac_f32_16x16x64_bf16 v[60:63], v[20:23], v[64:71], v3
  ds_read_b128 v[72:75], v0 offset:8192
  ds_read_b128 v[76:79], v0 offset:9216
  v_smfmac_f32_16x16x64_bf16 v[36:39], v[24:27], a[32:39], v3
  v_smfmac_f32_16x16x64_bf16 v[40:43], v[24:27], a[88:95], v3
  v_smfmac_f32_16x16x64_bf16 v[44:47], v[24:27], a[144:151], v3
  v_smfmac_f32_16x16x64_bf16 v[48:51], v[24:27], a[200:207], v3
  v_smfmac_f32_16x16x64_bf16 v[52:55], v[24:27], v[176:183], v3
  v_smfmac_f32_16x16x64_bf16 v[56:59], v[24:27], v[232:239], v3
  s_waitcnt lgkmcnt(0)
  v_smfmac_f32_16x16x64_bf16 v[60:63], v[24:27], v[72:79], v3
  ds_read_b128 v[144:147], v0 offset:10240
  ds_read_b128 v[148:151], v0 offset:11264
  v_smfmac_f32_16x16x64_bf16 v[36:39], v[28:31], a[40:47], v3
  v_smfmac_f32_16x16x64_bf16 v[40:43], v[28:31], a[96:103], v3
  v_smfmac_f32_16x16x64_bf16 v[44:47], v[28:31], a[152:159], v3
  v_smfmac_f32_16x16x64_bf16 v[48:51], v[28:31], a[208:215], v3
  v_smfmac_f32_16x16x64_bf16 v[52:55], v[28:31], v[184:191], v3
  v_smfmac_f32_16x16x64_bf16 v[56:59], v[28:31], v[240:247], v3
  s_waitcnt lgkmcnt(0)
  v_smfmac_f32_16x16x64_bf16 v[60:63], v[28:31], v[144:151], v3
  ds_read_b128 v[64:67], v0 offset:12288
  ds_read_b128 v[68:71], v0 offset:13312
  v_smfmac_f32_16x16x64_bf16 v[36:39], v[32:35], a[48:55], v3
  v_smfmac_f32_16x16x64_bf16 v[40:43], v[32:35], a[104:111], v3
  v_smfmac_f32_16x16x64_bf16 v[44:47], v[32:35], a[160:167], v3
  v_smfmac_f32_16x16x64_bf16 v[48:51], v[32:35], a[216:223], v3
  v_smfmac_f32_16x16x64_bf16 v[52:55], v[32:35], v[192:199], v3
  v_smfmac_f32_16x16x64_bf16 v[56:59], v[32:35], v[248:255], v3
  s_waitcnt lgkmcnt(0)
  v_smfmac_f32_16x16x64_bf16 v[60:63], v[32:35], v[64:71], v3
  v_permlane32_swap_b32 v36, v38
  v_permlane32_swap_b32 v37, v39
  v_add_f32 v36, v36, v38
  v_add_f32 v37, v37, v39
  v_cvt_pk_bf16_f32 v38, v36, v37
  ds_write_b32 v152, v38
  v_permlane32_swap_b32 v40, v42
  v_permlane32_swap_b32 v41, v43
  v_add_f32 v40, v40, v42
  v_add_f32 v41, v41, v43
  v_cvt_pk_bf16_f32 v42, v40, v41
  ds_write_b32 v153, v42
  v_permlane32_swap_b32 v44, v46
  v_permlane32_swap_b32 v45, v47
  v_add_f32 v44, v44, v46
  v_add_f32 v45, v45, v47
  v_cvt_pk_bf16_f32 v46, v44, v45
  ds_write_b32 v154, v46
  v_permlane32_swap_b32 v48, v50
  v_permlane32_swap_b32 v49, v51
  v_add_f32 v48, v48, v50
  v_add_f32 v49, v49, v51
  v_cvt_pk_bf16_f32 v50, v48, v49
  ds_write_b32 v155, v50
  v_permlane32_swap_b32 v52, v54
  v_permlane32_swap_b32 v53, v55
  v_add_f32 v52, v52, v54
  v_add_f32 v53, v53, v55
  v_cvt_pk_bf16_f32 v54, v52, v53
  ds_write_b32 v156, v54
  v_permlane32_swap_b32 v56, v58
  v_permlane32_swap_b32 v57, v59
  v_add_f32 v56, v56, v58
  v_add_f32 v57, v57, v59
  v_cvt_pk_bf16_f32 v58, v56, v57
  ds_write_b32 v157, v58
  v_permlane32_swap_b32 v60, v62
  v_permlane32_swap_b32 v61, v63
  v_add_f32 v60, v60, v62
  v_add_f32 v61, v61, v63
  v_cvt_pk_bf16_f32 v62, v60, v61
  ds_write_b32 v158, v62
  s_branch cB_va1_t2d
cB_va1_rp:
  s_cmp_lg_u32 s37, 0
  s_cbranch_scc1 cB_va1_cont
cB_va1_rv:
  s_add_u32 s31, s31, 0x10000
  buffer_load_dwordx4 v[8:11], v2, s[8:11], s22 offen offset:0 sc1
  buffer_load_dwordx4 v[12:15], v2, s[8:11], s22 offen offset:1024 sc1
  buffer_load_dwordx4 v[16:19], v2, s[8:11], s22 offen offset:2048 sc1
  buffer_load_dwordx4 v[20:23], v2, s[8:11], s22 offen offset:3072 sc1
  buffer_load_dwordx4 v[24:27], v2, s[8:11], s34 offen offset:0 sc1
  buffer_load_dwordx4 v[28:31], v2, s[8:11], s34 offen offset:1024 sc1
  buffer_load_dwordx4 v[32:35], v2, s[8:11], s34 offen offset:2048 sc1
  buffer_load_dwordx4 v[36:39], v2, s[8:11], s34 offen offset:3072 sc1
  buffer_load_dwordx4 v[40:43], v2, s[8:11], s36 offen offset:0 sc1
  buffer_load_dwordx4 v[44:47], v2, s[8:11], s36 offen offset:1024 sc1
  s_waitcnt vmcnt(0)
  v_max3_u32 v52, v8, v9, v10
  v_max3_u32 v52, v52, v11, v12
  v_max3_u32 v52, v52, v13, v14
  v_max3_u32 v52, v52, v15, v16
  v_max3_u32 v52, v52, v17, v18
  v_max3_u32 v52, v52, v19, v20
  v_max3_u32 v52, v52, v21, v22
  v_max3_u32 v52, v52, v23, v24
  v_max3_u32 v52, v52, v25, v26
  v_max3_u32 v52, v52, v27, v28
  v_max3_u32 v52, v52, v29, v30
  v_max3_u32 v52, v52, v31, v32
  v_max3_u32 v52, v52, v33, v34
  v_max3_u32 v52, v52, v35, v36
  v_max3_u32 v52, v52, v37, v38
  v_max3_u32 v52, v52, v39, v40
  v_max3_u32 v52, v52, v41, v42
  v_max3_u32 v52, v52, v43, v44
  v_max3_u32 v52, v52, v45, v46
  v_max_u32 v52, v52, v47
  v_cmp_eq_u32 vcc, -1, v52
  s_mov_b32 s37, 1
  v_mov_b32 v48, 0
  v_mov_b32 v49, 0
  v_mov_b32 v50, 0
  v_mov_b32 v51, 0
  s_nop 1
  s_cbranch_vccz cB_va1_lp
  s_add_u32 s30, s30, 1
  s_cmp_lt_u32 s30, 400000
  s_cbranch_scc1 cB_va1_rv
  s_branch cB_abort
.p2align 6
cB_va2_loop:
  s_mov_b32 s30, 0
  buffer_load_dword v100, v119, s[8:11], 0 offen sc1
  buffer_load_dword v101, v119, s[8:11], 0 offen sc1
  buffer_load_dword v102, v119, s[8:11], 0 offen sc1
  buffer_load_dword v103, v119, s[8:11], 0 offen sc1
cB_va2_fp_l:
  s_waitcnt vmcnt(3)
  v_cmp_gt_u32 vcc, s19, v100
  s_cbranch_vccz cB_va2_fp_d
  buffer_load_dword v100, v119, s[8:11], 0 offen sc1
  s_waitcnt vmcnt(3)
  v_cmp_gt_u32 vcc, s19, v101
  s_cbranch_vccz cB_va2_fp_d
  buffer_load_dword v101, v119, s[8:11], 0 offen sc1
  s_waitcnt vmcnt(3)
  v_cmp_gt_u32 vcc, s19, v102
  s_cbranch_vccz cB_va2_fp_d
  buffer_load_dword v102, v119, s[8:11], 0 offen sc1
  s_waitcnt vmcnt(3)
  v_cmp_gt_u32 vcc, s19, v103
  s_cbranch_vccz cB_va2_fp_d
  buffer_load_dword v103, v119, s[8:11], 0 offen sc1
  s_add_u32 s30, s30, 1
  s_cmp_lt_u32 s30, 400000
  s_cbranch_scc1 cB_va2_fp_l
  s_branch cB_abort
cB_va2_fp_d:
  buffer_load_dwordx4 v[8:11], v2, s[8:11], s20 offen offset:0 sc1
  buffer_load_dwordx4 v[12:15], v2, s[8:11], s20 offen offset:1024 sc1
  s_barrier
  s_barrier
  s_waitcnt vmcnt(0)
  ds_write_b128 v2, v[8:11] offset:8192
  ds_write_b128 v2, v[12:15] offset:9216
  v_smfmac_f32_16x16x64_bf16 v[36:39], v[8:11], a[0:7], v3
  v_smfmac_f32_16x16x64_bf16 v[40:43], v[8:11], a[56:63], v3
  v_smfmac_f32_16x16x64_bf16 v[44:47], v[8:11], a[112:119], v3
  v_smfmac_f32_16x16x64_bf16 v[48:51], v[8:11], a[168:175], v3
  v_smfmac_f32_16x16x64_bf16 v[52:55], v[8:11], a[224:231], v3
  s_waitcnt lgkmcnt(0)
  s_barrier
  ds_read_b128 v[16:19], v2 offset:10240
  ds_read_b128 v[20:23], v2 offset:11264
  ds_read_b128 v[24:27], v2 offset:12288
  ds_read_b128 v[28:31], v2 offset:13312
  ds_read_b128 v[32:35], v2 offset:14336
  v_smfmac_f32_16x16x64_bf16 v[56:59], v[8:11], v[144:151], v3
  v_smfmac_f32_16x16x64_bf16 v[60:63], v[8:11], v[200:207], v3
  v_smfmac_f32_16x16x64_bf16 v[36:39], v[12:15], a[8:15], v3
  v_smfmac_f32_16x16x64_bf16 v[40:43], v[12:15], a[64:71], v3
  v_smfmac_f32_16x16x64_bf16 v[44:47], v[12:15], a[120:127], v3
  v_smfmac_f32_16x16x64_bf16 v[48:51], v[12:15], a[176:183], v3
  v_smfmac_f32_16x16x64_bf16 v[52:55], v[12:15], a[232:239], v3
  v_smfmac_f32_16x16x64_bf16 v[56:59], v[12:15], v[152:159], v3
  v_smfmac_f32_16x16x64_bf16 v[60:63], v[12:15], v[208:215], v3
  s_waitcnt lgkmcnt(4)
  v_smfmac_f32_16x16x64_bf16 v[36:39], v[16:19], a[16:23], v3
  s_waitcnt lgkmcnt(3)
  v_smfmac_f32_16x16x64_bf16 v[36:39], v[20:23], a[24:31], v3
  s_waitcnt lgkmcnt(2)
  v_smfmac_f32_16x16x64_bf16 v[36:39], v[24:27], a[32:39], v3
  s_waitcnt lgkmcnt(1)
  v_smfmac_f32_16x16x64_bf16 v[36:39], v[28:31], a[40:47], v3
  s_waitcnt lgkmcnt(0)
  v_smfmac_f32_16x16x64_bf16 v[36:39], v[32:35], a[48:55], v3
  v_smfmac_f32_16x16x64_bf16 v[40:43], v[16:19], a[72:79], v3
  v_smfmac_f32_16x16x64_bf16 v[40:43], v[20:23], a[80:87], v3
  v_smfmac_f32_16x16x64_bf16 v[40:43], v[24:27], a[88:95], v3
  v_permlane32_swap_b32 v36, v38
  v_smfmac_f32_16x16x64_bf16 v[40:43], v[28:31], a[96:103], v3
  v_permlane32_swap_b32 v37, v39
  v_smfmac_f32_16x16x64_bf16 v[40:43], v[32:35], a[104:111], v3
  v_add_f32 v36, v36, v38
  v_smfmac_f32_16x16x64_bf16 v[44:47], v[16:19], a[128:135], v3
  v_add_f32 v37, v37, v39
  v_smfmac_f32_16x16x64_bf16 v[44:47], v[20:23], a[136:143], v3
  v_cmp_u_f32 vcc, v36, v37
  v_smfmac_f32_16x16x64_bf16 v[44:47], v[24:27], a[144:151], v3
  v_cvt_pk_bf16_f32 v38, v36, v37
  v_smfmac_f32_16x16x64_bf16 v[44:47], v[28:31], a[152:159], v3
  ds_write_b32 v104, v38
  s_cbranch_vccnz cB_va2_slow
  v_permlane32_swap_b32 v40, v42
  v_smfmac_f32_16x16x64_bf16 v[44:47], v[32:35], a[160:167], v3
  v_permlane32_swap_b32 v41, v43
  v_smfmac_f32_16x16x64_bf16 v[48:51], v[16:19], a[184:191], v3
  v_add_f32 v40, v40, v42
  v_smfmac_f32_16x16x64_bf16 v[48:51], v[20:23], a[192:199], v3
  v_add_f32 v41, v41, v43
  v_smfmac_f32_16x16x64_bf16 v[48:51], v[24:27], a[200:207], v3
  v_cvt_pk_bf16_f32 v42, v40, v41
  v_smfmac_f32_16x16x64_bf16 v[48:51], v[28:31], a[208:215], v3
  ds_write_b32 v105, v42
  v_permlane32_swap_b32 v44, v46
  v_smfmac_f32_16x16x64_bf16 v[48:51], v[32:35], a[216:223], v3
  v_permlane32_swap_b32 v45, v47
  v_smfmac_f32_16x16x64_bf16 v[52:55], v[16:19], a[240:247], v3
  v_add_f32 v44, v44, v46
  v_smfmac_f32_16x16x64_bf16 v[52:55], v[20:23], a[248:255], v3
  v_add_f32 v45, v45, v47
  v_smfmac_f32_16x16x64_bf16 v[52:55], v[24:27], v[120:127], v3
  v_cvt_pk_bf16_f32 v46, v44, v45
  v_smfmac_f32_16x16x64_bf16 v[52:55], v[28:31], v[128:135], v3
  ds_write_b32 v106, v46
  v_permlane32_swap_b32 v48, v50
  v_smfmac_f32_16x16x64_bf16 v[52:55], v[32:35], v[136:143], v3
  v_permlane32_swap_b32 v49, v51
  v_smfmac_f32_16x16x64_bf16 v[56:59], v[16:19], v[160:167], v3
  v_add_f32 v48, v48, v50
  v_smfmac_f32_16x16x64_bf16 v[56:59], v[20:23], v[168:175], v3
  v_add_f32 v49, v49, v51
  v_smfmac_f32_16x16x64_bf16 v[56:59], v[24:27], v[176:183], v3
  v_cvt_pk_bf16_f32 v50, v48, v49
  v_smfmac_f32_16x16x64_bf16 v[56:59], v[28:31], v[184:191], v3
  ds_write_b32 v107, v50
  v_permlane32_swap_b32 v52, v54
  v_smfmac_f32_16x16x64_bf16 v[56:59], v[32:35], v[192:199], v3
  v_permlane32_swap_b32 v53, v55
  v_smfmac_f32_16x16x64_bf16 v[60:63], v[16:19], v[216:223], v3
  v_add_f32 v52, v52, v54
  v_smfmac_f32_16x16x64_bf16 v[60:63], v[20:23], v[224:231], v3
  v_add_f32 v53, v53, v55
  v_smfmac_f32_16x16x64_bf16 v[60:63], v[24:27], v[232:239], v3
  v_cvt_pk_bf16_f32 v54, v52, v53
  v_smfmac_f32_16x16x64_bf16 v[60:63], v[28:31], v[240:247], v3
  ds_write_b32 v108, v54
  v_permlane32_swap_b32 v56, v58
  v_smfmac_f32_16x16x64_bf16 v[60:63], v[32:35], v[248:255], v3
  v_permlane32_swap_b32 v57, v59
  v_add_f32 v56, v56, v58
  v_add_f32 v57, v57, v59
  v_cvt_pk_bf16_f32 v58, v56, v57
  ds_write_b32 v109, v58
  s_nop 2
  v_permlane32_swap_b32 v60, v62
  v_permlane32_swap_b32 v61, v63
  v_add_f32 v60, v60, v62
  v_add_f32 v61, v61, v63
  v_cvt_pk_bf16_f32 v62, v60, v61
  ds_write_b32 v110, v62
cB_va2_t2d:
  v_mov_b32 v117, s18
  s_waitcnt lgkmcnt(0)
  s_barrier
  s_cmp_eq_u32 s19, 62
  s_cbranch_scc1 cB_done
  s_sleep 1
  v_mov_b32 v36, 0
  v_mov_b32 v37, 0
  v_mov_b32 v38, 0
  v_mov_b32 v39, 0
  v_mov_b32 v40, 0
  v_mov_b32 v41, 0
  v_mov_b32 v42, 0
  v_mov_b32 v43, 0
  v_mov_b32 v44, 0
  v_mov_b32 v45, 0
  v_mov_b32 v46, 0
  v_mov_b32 v47, 0
  v_mov_b32 v48, 0
  v_mov_b32 v49, 0
  v_mov_b32 v50, 0
  v_mov_b32 v51, 0
  v_mov_b32 v52, 0
  v_mov_b32 v53, 0
  v_mov_b32 v54, 0
  v_mov_b32 v55, 0
  v_mov_b32 v56, 0
  v_mov_b32 v57, 0
  v_mov_b32 v58, 0
  v_mov_b32 v59, 0
  v_mov_b32 v60, 0
  v_mov_b32 v61, 0
  v_mov_b32 v62, 0
  v_mov_b32 v63, 0
  s_sleep 3
  s_mov_b32 s19, s18
  s_add_u32 s18, s18, 1
  s_mov_b32 s22, s20
  s_mov_b32 s20, s21
  s_mov_b32 s21, s22
  s_add_u32 s23, s20, 4096
  s_branch cB_va2_loop
cB_va2_slow:
  s_waitcnt lgkmcnt(0)
cB_va2_sl1:
  s_add_u32 s31, s31, 0x1000000
  buffer_load_dwordx4 v[8:11], v2, s[8:11], s20 offen offset:0 sc1
  buffer_load_dwordx4 v[12:15], v2, s[8:11], s20 offen offset:1024 sc1
  buffer_load_dwordx4 v[16:19], v2, s[8:11], s20 offen offset:2048 sc1
  buffer_load_dwordx4 v[20:23], v2, s[8:11], s20 offen offset:3072 sc1
  buffer_load_dwordx4 v[24:27], v2, s[8:11], s23 offen offset:0 sc1
  buffer_load_dwordx4 v[28:31], v2, s[8:11], s23 offen offset:1024 sc1
  buffer_load_dwordx4 v[32:35], v2, s[8:11], s23 offen offset:2048 sc1
  s_waitcnt vmcnt(0)
  v_max3_u32 v36, v8, v9, v10
  v_max3_u32 v36, v36, v11, v12
  v_max3_u32 v36, v36, v13, v14
  v_max3_u32 v36, v36, v15, v16
  v_max3_u32 v36, v36, v17, v18
  v_max3_u32 v36, v36, v19, v20
  v_max3_u32 v36, v36, v21, v22
  v_max3_u32 v36, v36, v23, v24
  v_max3_u32 v36, v36, v25, v26
  v_max3_u32 v36, v36, v27, v28
  v_max3_u32 v36, v36, v29, v30
  v_max3_u32 v36, v36, v31, v32
  v_max3_u32 v36, v36, v33, v34
  v_max_u32 v36, v36, v35
  v_cmp_eq_u32 vcc, -1, v36
  s_cbranch_vccz cB_va2_sl2
  s_add_u32 s30, s30, 1
  s_cmp_lt_u32 s30, 400000
  s_cbranch_scc1 cB_va2_sl1
  s_branch cB_abort
cB_va2_sl2:
  v_mov_b32 v36, 0
  v_mov_b32 v37, 0
  v_mov_b32 v38, 0
  v_mov_b32 v39, 0
  v_mov_b32 v40, 0
  v_mov_b32 v41, 0
  v_mov_b32 v42, 0
  v_mov_b32 v43, 0
  v_mov_b32 v44, 0
  v_mov_b32 v45, 0
  v_mov_b32 v46, 0
  v_mov_b32 v47, 0
  v_mov_b32 v48, 0
  v_mov_b32 v49, 0
  v_mov_b32 v50, 0
  v_mov_b32 v51, 0
  v_mov_b32 v52, 0
  v_mov_b32 v53, 0
  v_mov_b32 v54, 0
  v_mov_b32 v55, 0
  v_mov_b32 v56, 0
  v_mov_b32 v57, 0
  v_mov_b32 v58, 0
  v_mov_b32 v59, 0
  v_mov_b32 v60, 0
  v_mov_b32 v61, 0
  v_mov_b32 v62, 0
  v_mov_b32 v63, 0
  v_smfmac_f32_16x16x64_bf16 v[36:39], v[8:11], a[0:7], v3
  v_smfmac_f32_16x16x64_bf16 v[40:43], v[8:11], a[56:63], v3
  v_smfmac_f32_16x16x64_bf16 v[44:47], v[8:11], a[112:119], v3
  v_smfmac_f32_16x16x64_bf16 v[48:51], v[8:11], a[168:175], v3
  v_smfmac_f32_16x16x64_bf16 v[52:55], v[8:11], a[224:231], v3
  v_smfmac_f32_16x16x64_bf16 v[56:59], v[8:11], v[144:151], v3
  v_smfmac_f32_16x16x64_bf16 v[60:63], v[8:11], v[200:207], v3
  v_smfmac_f32_16x16x64_bf16 v[36:39], v[12:15], a[8:15], v3
  v_smfmac_f32_16x16x64_bf16 v[40:43], v[12:15], a[64:71], v3
  v_smfmac_f32_16x16x64_bf16 v[44:47], v[12:15], a[120:127], v3
  v_smfmac_f32_16x16x64_bf16 v[48:51], v[12:15], a[176:183], v3
  v_smfmac_f32_16x16x64_bf16 v[52:55], v[12:15], a[232:239], v3
  v_smfmac_f32_16x16x64_bf16 v[56:59], v[12:15], v[152:159], v3
  v_smfmac_f32_16x16x64_bf16 v[60:63], v[12:15], v[208:215], v3
  v_smfmac_f32_16x16x64_bf16 v[36:39], v[16:19], a[16:23], v3
  v_smfmac_f32_16x16x64_bf16 v[40:43], v[16:19], a[72:79], v3
  v_smfmac_f32_16x16x64_bf16 v[44:47], v[16:19], a[128:135], v3
  v_smfmac_f32_16x16x64_bf16 v[48:51], v[16:19], a[184:191], v3
  v_smfmac_f32_16x16x64_bf16 v[52:55], v[16:19], a[240:247], v3
  v_smfmac_f32_16x16x64_bf16 v[56:59], v[16:19], v[160:167], v3
  v_smfmac_f32_16x16x64_bf16 v[60:63], v[16:19], v[216:223], v3
  v_smfmac_f32_16x16x64_bf16 v[36:39], v[20:23], a[24:31], v3
  v_smfmac_f32_16x16x64_bf16 v[40:43], v[20:23], a[80:87], v3
  v_smfmac_f32_16x16x64_bf16 v[44:47], v[20:23], a[136:143], v3
  v_smfmac_f32_16x16x64_bf16 v[48:51], v[20:23], a[192:199], v3
  v_smfmac_f32_16x16x64_bf16 v[52:55], v[20:23], a[248:255], v3
  v_smfmac_f32_16x16x64_bf16 v[56:59], v[20:23], v[168:175], v3
  v_smfmac_f32_16x16x64_bf16 v[60:63], v[20:23], v[224:231], v3
  v_smfmac_f32_16x16x64_bf16 v[36:39], v[24:27], a[32:39], v3
  v_smfmac_f32_16x16x64_bf16 v[40:43], v[24:27], a[88:95], v3
  v_smfmac_f32_16x16x64_bf16 v[44:47], v[24:27], a[144:151], v3
  v_smfmac_f32_16x16x64_bf16 v[48:51], v[24:27], a[200:207], v3
  v_smfmac_f32_16x16x64_bf16 v[52:55], v[24:27], v[120:127], v3
  v_smfmac_f32_16x16x64_bf16 v[56:59], v[24:27], v[176:183], v3
  v_smfmac_f32_16x16x64_bf16 v[60:63], v[24:27], v[232:239], v3
  v_smfmac_f32_16x16x64_bf16 v[36:39], v[28:31], a[40:47], v3
  v_smfmac_f32_16x16x64_bf16 v[40:43], v[28:31], a[96:103], v3
  v_smfmac_f32_16x16x64_bf16 v[44:47], v[28:31], a[152:159], v3
  v_smfmac_f32_16x16x64_bf16 v[48:51], v[28:31], a[208:215], v3
  v_smfmac_f32_16x16x64_bf16 v[52:55], v[28:31], v[128:135], v3
  v_smfmac_f32_16x16x64_bf16 v[56:59], v[28:31], v[184:191], v3
  v_smfmac_f32_16x16x64_bf16 v[60:63], v[28:31], v[240:247], v3
  v_smfmac_f32_16x16x64_bf16 v[36:39], v[32:35], a[48:55], v3
  v_smfmac_f32_16x16x64_bf16 v[40:43], v[32:35], a[104:111], v3
  v_smfmac_f32_16x16x64_bf16 v[44:47], v[32:35], a[160:167], v3
  v_smfmac_f32_16x16x64_bf16 v[48:51], v[32:35], a[216:223], v3
  v_smfmac_f32_16x16x64_bf16 v[52:55], v[32:35], v[136:143], v3
  v_smfmac_f32_16x16x64_bf16 v[56:59], v[32:35], v[192:199], v3
  v_smfmac_f32_16x16x64_bf16 v[60:63], v[32:35], v[248:255], v3
  v_permlane32_swap_b32 v36, v38
  v_permlane32_swap_b32 v37, v39
  v_add_f32 v36, v36, v38
  v_add_f32 v37, v37, v39
  v_cvt_pk_bf16_f32 v38, v36, v37
  ds_write_b32 v104, v38
  v_permlane32_swap_b32 v40, v42
  v_permlane32_swap_b32 v41, v43
  v_add_f32 v40, v40, v42
  v_add_f32 v41, v41, v43
  v_cvt_pk_bf16_f32 v42, v40, v41
  ds_write_b32 v105, v42
  v_permlane32_swap_b32 v44, v46
  v_permlane32_swap_b32 v45, v47
  v_add_f32 v44, v44, v46
  v_add_f32 v45, v45, v47
  v_cvt_pk_bf16_f32 v46, v44, v45
  ds_write_b32 v106, v46
  v_permlane32_swap_b32 v48, v50
  v_permlane32_swap_b32 v49, v51
  v_add_f32 v48, v48, v50
  v_add_f32 v49, v49, v51
  v_cvt_pk_bf16_f32 v50, v48, v49
  ds_write_b32 v107, v50
  v_permlane32_swap_b32 v52, v54
  v_permlane32_swap_b32 v53, v55
  v_add_f32 v52, v52, v54
  v_add_f32 v53, v53, v55
  v_cvt_pk_bf16_f32 v54, v52, v53
  ds_write_b32 v108, v54
  v_permlane32_swap_b32 v56, v58
  v_permlane32_swap_b32 v57, v59
  v_add_f32 v56, v56, v58
  v_add_f32 v57, v57, v59
  v_cvt_pk_bf16_f32 v58, v56, v57
  ds_write_b32 v109, v58
  v_permlane32_swap_b32 v60, v62
  v_permlane32_swap_b32 v61, v63
  v_add_f32 v60, v60, v62
  v_add_f32 v61, v61, v63
  v_cvt_pk_bf16_f32 v62, v60, v61
  ds_write_b32 v110, v62
  s_branch cB_va2_t2d
.p2align 6
cB_va3_loop:
  s_mov_b32 s30, 0
  s_barrier
  buffer_load_dwordx4 v[16:19], v2, s[8:11], s20 offen offset:2048 sc1
  buffer_load_dwordx4 v[20:23], v2, s[8:11], s20 offen offset:3072 sc1
  s_barrier
  buffer_load_dword v100, v116, s[8:11], s39 offen sc1
  s_add_u32 s27, s19, 2
  s_min_u32 s27, s27, 63
  s_lshr_b32 s27, s27, 3
  s_lshl_b32 s27, s27, 11
  s_add_u32 s27, s27, s35
  s_cmp_eq_u32 s27, s28
  s_cselect_b32 s29, 75729408, s27
  buffer_load_dword v101, off, s[8:11], s29 sc1
  s_add_u32 s39, s39, 28672
  s_waitcnt vmcnt(2)
  ds_write_b128 v2, v[16:19] offset:10240
  ds_write_b128 v2, v[20:23] offset:11264
  v_smfmac_f32_16x16x64_bf16 v[36:39], v[16:19], a[16:23], v3
  v_smfmac_f32_16x16x64_bf16 v[40:43], v[16:19], a[72:79], v3
  v_smfmac_f32_16x16x64_bf16 v[44:47], v[16:19], a[128:135], v3
  v_smfmac_f32_16x16x64_bf16 v[48:51], v[16:19], a[184:191], v3
  v_smfmac_f32_16x16x64_bf16 v[52:55], v[16:19], a[240:247], v3
  s_waitcnt lgkmcnt(0)
  s_barrier
  ds_read_b128 v[8:11], v2 offset:8192
  ds_read_b128 v[12:15], v2 offset:9216
  ds_read_b128 v[24:27], v2 offset:12288
  ds_read_b128 v[28:31], v2 offset:13312
  ds_read_b128 v[32:35], v2 offset:14336
  v_smfmac_f32_16x16x64_bf16 v[56:59], v[16:19], v[160:167], v3
  v_smfmac_f32_16x16x64_bf16 v[60:63], v[16:19], v[216:223], v3
  v_smfmac_f32_16x16x64_bf16 v[36:39], v[20:23], a[24:31], v3
  v_smfmac_f32_16x16x64_bf16 v[40:43], v[20:23], a[80:87], v3
  v_smfmac_f32_16x16x64_bf16 v[44:47], v[20:23], a[136:143], v3
  v_smfmac_f32_16x16x64_bf16 v[48:51], v[20:23], a[192:199], v3
  v_smfmac_f32_16x16x64_bf16 v[52:55], v[20:23], a[248:255], v3
  v_smfmac_f32_16x16x64_bf16 v[56:59], v[20:23], v[168:175], v3
  v_smfmac_f32_16x16x64_bf16 v[60:63], v[20:23], v[224:231], v3
  s_waitcnt lgkmcnt(4)
  v_smfmac_f32_16x16x64_bf16 v[36:39], v[8:11], a[0:7], v3
  s_waitcnt lgkmcnt(3)
  v_smfmac_f32_16x16x64_bf16 v[36:39], v[12:15], a[8:15], v3
  s_waitcnt lgkmcnt(2)
  v_smfmac_f32_16x16x64_bf16 v[36:39], v[24:27], a[32:39], v3
  s_waitcnt lgkmcnt(1)
  v_smfmac_f32_16x16x64_bf16 v[36:39], v[28:31], a[40:47], v3
  s_waitcnt lgkmcnt(0)
  v_smfmac_f32_16x16x64_bf16 v[36:39], v[32:35], a[48:55], v3
  v_smfmac_f32_16x16x64_bf16 v[40:43], v[8:11], a[56:63], v3
  v_smfmac_f32_16x16x64_bf16 v[40:43], v[12:15], a[64:71], v3
  v_smfmac_f32_16x16x64_bf16 v[40:43], v[24:27], a[88:95], v3
  v_permlane32_swap_b32 v36, v38
  v_smfmac_f32_16x16x64_bf16 v[40:43], v[28:31], a[96:103], v3
  v_permlane32_swap_b32 v37, v39
  v_smfmac_f32_16x16x64_bf16 v[40:43], v[32:35], a[104:111], v3
  v_add_f32 v36, v36, v38
  v_smfmac_f32_16x16x64_bf16 v[44:47], v[8:11], a[112:119], v3
  v_add_f32 v37, v37, v39
  v_smfmac_f32_16x16x64_bf16 v[44:47], v[12:15], a[120:127], v3
  v_cmp_u_f32 vcc, v36, v37
  v_smfmac_f32_16x16x64_bf16 v[44:47], v[24:27], a[144:151], v3
  v_cvt_pk_bf16_f32 v38, v36, v37
  v_smfmac_f32_16x16x64_bf16 v[44:47], v[28:31], a[152:159], v3
  ds_write_b32 v104, v38
  s_cbranch_vccnz cB_va3_slow
  v_permlane32_swap_b32 v40, v42
  v_smfmac_f32_16x16x64_bf16 v[44:47], v[32:35], a[160:167], v3
  v_permlane32_swap_b32 v41, v43
  v_smfmac_f32_16x16x64_bf16 v[48:51], v[8:11], a[168:175], v3
  v_add_f32 v40, v40, v42
  v_smfmac_f32_16x16x64_bf16 v[48:51], v[12:15], a[176:183], v3
  v_add_f32 v41, v41, v43
  v_smfmac_f32_16x16x64_bf16 v[48:51], v[24:27], a[200:207], v3
  v_cvt_pk_bf16_f32 v42, v40, v41
  v_smfmac_f32_16x16x64_bf16 v[48:51], v[28:31], a[208:215], v3
  ds_write_b32 v105, v42
  v_permlane32_swap_b32 v44, v46
  v_smfmac_f32_16x16x64_bf16 v[48:51], v[32:35], a[216:223], v3
  v_permlane32_swap_b32 v45, v47
  v_smfmac_f32_16x16x64_bf16 v[52:55], v[8:11], a[224:231], v3
  v_add_f32 v44, v44, v46
  v_smfmac_f32_16x16x64_bf16 v[52:55], v[12:15], a[232:239], v3
  v_add_f32 v45, v45, v47
  v_smfmac_f32_16x16x64_bf16 v[52:55], v[24:27], v[120:127], v3
  v_cvt_pk_bf16_f32 v46, v44, v45
  v_smfmac_f32_16x16x64_bf16 v[52:55], v[28:31], v[128:135], v3
  ds_write_b32 v106, v46
  v_permlane32_swap_b32 v48, v50
  v_smfmac_f32_16x16x64_bf16 v[52:55], v[32:35], v[136:143], v3
  v_permlane32_swap_b32 v49, v51
  v_smfmac_f32_16x16x64_bf16 v[56:59], v[8:11], v[144:151], v3
  v_add_f32 v48, v48, v50
  v_smfmac_f32_16x16x64_bf16 v[56:59], v[12:15], v[152:159], v3
  v_add_f32 v49, v49, v51
  v_smfmac_f32_16x16x64_bf16 v[56:59], v[24:27], v[176:183], v3
  v_cvt_pk_bf16_f32 v50, v48, v49
  v_smfmac_f32_16x16x64_bf16 v[56:59], v[28:31], v[184:191], v3
  ds_write_b32 v107, v50
  v_permlane32_swap_b32 v52, v54
  v_smfmac_f32_16x16x64_bf16 v[56:59], v[32:35], v[192:199], v3
  v_permlane32_swap_b32 v53, v55
  v_smfmac_f32_16x16x64_bf16 v[60:63], v[8:11], v[200:207], v3
  v_add_f32 v52, v52, v54
  v_smfmac_f32_16x16x64_bf16 v[60:63], v[12:15], v[208:215], v3
  v_add_f32 v53, v53, v55
  v_smfmac_f32_16x16x64_bf16 v[60:63], v[24:27], v[232:239], v3
  v_cvt_pk_bf16_f32 v54, v52, v53
  v_smfmac_f32_16x16x64_bf16 v[60:63], v[28:31], v[240:247], v3
  ds_write_b32 v108, v54
  v_permlane32_swap_b32 v56, v58
  v_smfmac_f32_16x16x64_bf16 v[60:63], v[32:35], v[248:255], v3
  v_permlane32_swap_b32 v57, v59
  v_add_f32 v56, v56, v58
  v_add_f32 v57, v57, v59
  v_cvt_pk_bf16_f32 v58, v56, v57
  ds_write_b32 v109, v58
  s_nop 2
  v_permlane32_swap_b32 v60, v62
  v_permlane32_swap_b32 v61, v63
  v_add_f32 v60, v60, v62
  v_add_f32 v61, v61, v63
  v_cvt_pk_bf16_f32 v62, v60, v61
  ds_write_b32 v110, v62
cB_va3_t2d:
  v_mov_b32 v117, s18
  s_cmp_eq_u32 s27, s28
  s_cbranch_scc1 cB_va3_vok
cB_va3_vow:
  s_waitcnt vmcnt(0)
  v_cmp_ne_u32 vcc, 56, v101
  s_cbranch_vccnz cB_va3_vor
  s_mov_b32 s28, s27
cB_va3_vok:
  s_waitcnt lgkmcnt(0)
  s_setprio 3
  s_barrier
  v_mov_b32 v36, 0
  v_mov_b32 v37, 0
  v_mov_b32 v38, 0
  v_mov_b32 v39, 0
  buffer_store_dword v117, v118, s[8:11], 0 offen sc1
  s_setprio 0
  s_cmp_eq_u32 s19, 62
  s_cbranch_scc1 cB_done
  v_mov_b32 v40, 0
  v_mov_b32 v41, 0
  v_mov_b32 v42, 0
  v_mov_b32 v43, 0
  v_mov_b32 v44, 0
  v_mov_b32 v45, 0
  v_mov_b32 v46, 0
  v_mov_b32 v47, 0
  v_mov_b32 v48, 0
  v_mov_b32 v49, 0
  v_mov_b32 v50, 0
  v_mov_b32 v51, 0
  v_mov_b32 v52, 0
  v_mov_b32 v53, 0
  v_mov_b32 v54, 0
  v_mov_b32 v55, 0
  v_mov_b32 v56, 0
  v_mov_b32 v57, 0
  v_mov_b32 v58, 0
  v_mov_b32 v59, 0
  v_mov_b32 v60, 0
  v_mov_b32 v61, 0
  v_mov_b32 v62, 0
  v_mov_b32 v63, 0
  s_mov_b32 s19, s18
  s_add_u32 s18, s18, 1
  s_mov_b32 s22, s20
  s_mov_b32 s20, s21
  s_mov_b32 s21, s22
  s_add_u32 s23, s20, 4096
  s_branch cB_va3_loop
cB_va3_slow:
  s_waitcnt lgkmcnt(0)
cB_va3_sl1:
  s_add_u32 s31, s31, 0x1000000
  buffer_load_dwordx4 v[8:11], v2, s[8:11], s20 offen offset:0 sc1
  buffer_load_dwordx4 v[12:15], v2, s[8:11], s20 offen offset:1024 sc1
  buffer_load_dwordx4 v[16:19], v2, s[8:11], s20 offen offset:2048 sc1
  buffer_load_dwordx4 v[20:23], v2, s[8:11], s20 offen offset:3072 sc1
  buffer_load_dwordx4 v[24:27], v2, s[8:11], s23 offen offset:0 sc1
  buffer_load_dwordx4 v[28:31], v2, s[8:11], s23 offen offset:1024 sc1
  buffer_load_dwordx4 v[32:35], v2, s[8:11], s23 offen offset:2048 sc1
  s_waitcnt vmcnt(0)
  v_max3_u32 v36, v8, v9, v10
  v_max3_u32 v36, v36, v11, v12
  v_max3_u32 v36, v36, v13, v14
  v_max3_u32 v36, v36, v15, v16
  v_max3_u32 v36, v36, v17, v18
  v_max3_u32 v36, v36, v19, v20
  v_max3_u32 v36, v36, v21, v22
  v_max3_u32 v36, v36, v23, v24
  v_max3_u32 v36, v36, v25, v26
  v_max3_u32 v36, v36, v27, v28
  v_max3_u32 v36, v36, v29, v30
  v_max3_u32 v36, v36, v31, v32
  v_max3_u32 v36, v36, v33, v34
  v_max_u32 v36, v36, v35
  v_cmp_eq_u32 vcc, -1, v36
  s_cbranch_vccz cB_va3_sl2
  s_add_u32 s30, s30, 1
  s_cmp_lt_u32 s30, 400000
  s_cbranch_scc1 cB_va3_sl1
  s_branch cB_abort
cB_va3_sl2:
  v_mov_b32 v36, 0
  v_mov_b32 v37, 0
  v_mov_b32 v38, 0
  v_mov_b32 v39, 0
  v_mov_b32 v40, 0
  v_mov_b32 v41, 0
  v_mov_b32 v42, 0
  v_mov_b32 v43, 0
  v_mov_b32 v44, 0
  v_mov_b32 v45, 0
  v_mov_b32 v46, 0
  v_mov_b32 v47, 0
  v_mov_b32 v48, 0
  v_mov_b32 v49, 0
  v_mov_b32 v50, 0
  v_mov_b32 v51, 0
  v_mov_b32 v52, 0
  v_mov_b32 v53, 0
  v_mov_b32 v54, 0
  v_mov_b32 v55, 0
  v_mov_b32 v56, 0
  v_mov_b32 v57, 0
  v_mov_b32 v58, 0
  v_mov_b32 v59, 0
  v_mov_b32 v60, 0
  v_mov_b32 v61, 0
  v_mov_b32 v62, 0
  v_mov_b32 v63, 0
  v_smfmac_f32_16x16x64_bf16 v[36:39], v[8:11], a[0:7], v3
  v_smfmac_f32_16x16x64_bf16 v[40:43], v[8:11], a[56:63], v3
  v_smfmac_f32_16x16x64_bf16 v[44:47], v[8:11], a[112:119], v3
  v_smfmac_f32_16x16x64_bf16 v[48:51], v[8:11], a[168:175], v3
  v_smfmac_f32_16x16x64_bf16 v[52:55], v[8:11], a[224:231], v3
  v_smfmac_f32_16x16x64_bf16 v[56:59], v[8:11], v[144:151], v3
  v_smfmac_f32_16x16x64_bf16 v[60:63], v[8:11], v[200:207], v3
  v_smfmac_f32_16x16x64_bf16 v[36:39], v[12:15], a[8:15], v3
  v_smfmac_f32_16x16x64_bf16 v[40:43], v[12:15], a[64:71], v3
  v_smfmac_f32_16x16x64_bf16 v[44:47], v[12:15], a[120:127], v3
  v_smfmac_f32_16x16x64_bf16 v[48:51], v[12:15], a[176:183], v3
  v_smfmac_f32_16x16x64_bf16 v[52:55], v[12:15], a[232:239], v3
  v_smfmac_f32_16x16x64_bf16 v[56:59], v[12:15], v[152:159], v3
  v_smfmac_f32_16x16x64_bf16 v[60:63], v[12:15], v[208:215], v3
  v_smfmac_f32_16x16x64_bf16 v[36:39], v[16:19], a[16:23], v3
  v_smfmac_f32_16x16x64_bf16 v[40:43], v[16:19], a[72:79], v3
  v_smfmac_f32_16x16x64_bf16 v[44:47], v[16:19], a[128:135], v3
  v_smfmac_f32_16x16x64_bf16 v[48:51], v[16:19], a[184:191], v3
  v_smfmac_f32_16x16x64_bf16 v[52:55], v[16:19], a[240:247], v3
  v_smfmac_f32_16x16x64_bf16 v[56:59], v[16:19], v[160:167], v3
  v_smfmac_f32_16x16x64_bf16 v[60:63], v[16:19], v[216:223], v3
  v_smfmac_f32_16x16x64_bf16 v[36:39], v[20:23], a[24:31], v3
  v_smfmac_f32_16x16x64_bf16 v[40:43], v[20:23], a[80:87], v3
  v_smfmac_f32_16x16x64_bf16 v[44:47], v[20:23], a[136:143], v3
  v_smfmac_f32_16x16x64_bf16 v[48:51], v[20:23], a[192:199], v3
  v_smfmac_f32_16x16x64_bf16 v[52:55], v[20:23], a[248:255], v3
  v_smfmac_f32_16x16x64_bf16 v[56:59], v[20:23], v[168:175], v3
  v_smfmac_f32_16x16x64_bf16 v[60:63], v[20:23], v[224:231], v3
  v_smfmac_f32_16x16x64_bf16 v[36:39], v[24:27], a[32:39], v3
  v_smfmac_f32_16x16x64_bf16 v[40:43], v[24:27], a[88:95], v3
  v_smfmac_f32_16x16x64_bf16 v[44:47], v[24:27], a[144:151], v3
  v_smfmac_f32_16x16x64_bf16 v[48:51], v[24:27], a[200:207], v3
  v_smfmac_f32_16x16x64_bf16 v[52:55], v[24:27], v[120:127], v3
  v_smfmac_f32_16x16x64_bf16 v[56:59], v[24:27], v[176:183], v3
  v_smfmac_f32_16x16x64_bf16 v[60:63], v[24:27], v[232:239], v3
  v_smfmac_f32_16x16x64_bf16 v[36:39], v[28:31], a[40:47], v3
  v_smfmac_f32_16x16x64_bf16 v[40:43], v[28:31], a[96:103], v3
  v_smfmac_f32_16x16x64_bf16 v[44:47], v[28:31], a[152:159], v3
  v_smfmac_f32_16x16x64_bf16 v[48:51], v[28:31], a[208:215], v3
  v_smfmac_f32_16x16x64_bf16 v[52:55], v[28:31], v[128:135], v3
  v_smfmac_f32_16x16x64_bf16 v[56:59], v[28:31], v[184:191], v3
  v_smfmac_f32_16x16x64_bf16 v[60:63], v[28:31], v[240:247], v3
  v_smfmac_f32_16x16x64_bf16 v[36:39], v[32:35], a[48:55], v3
  v_smfmac_f32_16x16x64_bf16 v[40:43], v[32:35], a[104:111], v3
  v_smfmac_f32_16x16x64_bf16 v[44:47], v[32:35], a[160:167], v3
  v_smfmac_f32_16x16x64_bf16 v[48:51], v[32:35], a[216:223], v3
  v_smfmac_f32_16x16x64_bf16 v[52:55], v[32:35], v[136:143], v3
  v_smfmac_f32_16x16x64_bf16 v[56:59], v[32:35], v[192:199], v3
  v_smfmac_f32_16x16x64_bf16 v[60:63], v[32:35], v[248:255], v3
  v_permlane32_swap_b32 v36, v38
  v_permlane32_swap_b32 v37, v39
  v_add_f32 v36, v36, v38
  v_add_f32 v37, v37, v39
  v_cvt_pk_bf16_f32 v38, v36, v37
  ds_write_b32 v104, v38
  v_permlane32_swap_b32 v40, v42
  v_permlane32_swap_b32 v41, v43
  v_add_f32 v40, v40, v42
  v_add_f32 v41, v41, v43
  v_cvt_pk_bf16_f32 v42, v40, v41
  ds_write_b32 v105, v42
  v_permlane32_swap_b32 v44, v46
  v_permlane32_swap_b32 v45, v47
  v_add_f32 v44, v44, v46
  v_add_f32 v45, v45, v47
  v_cvt_pk_bf16_f32 v46, v44, v45
  ds_write_b32 v106, v46
  v_permlane32_swap_b32 v48, v50
  v_permlane32_swap_b32 v49, v51
  v_add_f32 v48, v48, v50
  v_add_f32 v49, v49, v51
  v_cvt_pk_bf16_f32 v50, v48, v49
  ds_write_b32 v107, v50
  v_permlane32_swap_b32 v52, v54
  v_permlane32_swap_b32 v53, v55
  v_add_f32 v52, v52, v54
  v_add_f32 v53, v53, v55
  v_cvt_pk_bf16_f32 v54, v52, v53
  ds_write_b32 v108, v54
  v_permlane32_swap_b32 v56, v58
  v_permlane32_swap_b32 v57, v59
  v_add_f32 v56, v56, v58
  v_add_f32 v57, v57, v59
  v_cvt_pk_bf16_f32 v58, v56, v57
  ds_write_b32 v109, v58
  v_permlane32_swap_b32 v60, v62
  v_permlane32_swap_b32 v61, v63
  v_add_f32 v60, v60, v62
  v_add_f32 v61, v61, v63
  v_cvt_pk_bf16_f32 v62, v60, v61
  ds_write_b32 v110, v62
  s_branch cB_va3_t2d
cB_va3_vor:
  s_sleep 2
  buffer_load_dword v101, off, s[8:11], s27 sc1
  s_add_u32 s30, s30, 1
  s_cmp_lt_u32 s30, 400000
  s_cbranch_scc1 cB_va3_vow
  s_branch cB_abort
cB_abort:
  v_mov_b32 v4, 0xdead
  v_mov_b32 v5, 16
  buffer_store_dword v4, v5, s[12:15], 0 offen
  s_branch ch_end
cB_done:
  s_branch ch_end
ch_worker:
  s_sub_u32 s35, s3, 1
  s_and_b32 s35, s35, 7
  s_lshr_b32 s36, s2, 3
  s_lshl_b32 s33, s35, 5
  s_add_u32 s33, s33, s36
  s_mov_b32 s97, 0
  s_mov_b32 s96, 0
  s_mov_b32 s37, 0
  s_mov_b32 s38, 0
  s_mov_b32 s39, 0xffff0000
  s_mov_b32 s101, -1
  v_and_b32 v1, 63, v0
  v_lshlrev_b32 v2, 4, v1
  v_lshrrev_b32 v3, 4, v1
  v_and_b32 v4, 15, v1
  s_cmp_ge_u32 s33, 224
  s_cbranch_scc1 wp_all
  s_mov_b32 s68, s44
  s_and_b32 s69, s45, 0xffff
  s_mov_b32 s70, 3670016
  s_mov_b32 s71, 0x20000
  s_and_b32 s20, s33, 0xe0
  s_mul_i32 s20, s20, 9363
  s_lshr_b32 s20, s20, 16
  s_lshl_b32 s20, s20, 10
  s_and_b32 s21, s33, 31
  s_mul_i32 s21, s21, 192
  s_add_u32 s20, s20, s21
  v_min_u32 v7, 191, v0
  v_add_u32 v7, s20, v7
  v_lshrrev_b32 v8, 11, v7
  v_min_u32 v8, 15, v8
  v_bfe_u32 v9, v7, 2, 9
  v_lshlrev_b32 v9, 13, v9
  v_lshl_add_u32 v9, v8, 9, v9
  v_and_b32 v7, 3, v7
  v_lshl_add_u32 v9, v7, 7, v9
  buffer_load_dword v253, v9, s[68:71], 0 offen
  v_lshrrev_b32 v5, 5, v1
  v_and_b32 v6, 31, v1
  v_xor_b32 v8, v6, v5
  v_lshlrev_b32 v8, 4, v8
  v_lshl_add_u32 v16, v5, 13, v8
  v_xor_b32 v17, 32, v16
  v_xor_b32 v18, 64, v16
  v_xor_b32 v19, 96, v16
  v_xor_b32 v20, 128, v16
  v_xor_b32 v21, 160, v16
  v_xor_b32 v22, 192, v16
  v_xor_b32 v23, 224, v16
  s_lshl_b32 s20, s16, 6
  v_xor_b32 v26, s20, v16
  v_xor_b32 v27, 32, v26
wp_B:
  s_mul_i32 s17, s33, 4682
  s_lshr_b32 s17, s17, 16
  s_mul_i32 s23, s17, 14
  s_sub_u32 s19, s33, s23
  s_cmp_lt_u32 s19, 7
  s_cselect_b32 s18, 0, 7
  s_cselect_b32 s28, 0, 8
  s_sub_u32 s18, s19, s18
  s_add_u32 s28, s28, s16
  s_lshl_b32 s25, s16, 15
  s_add_u32 s25, s25, 32768
  s_lshl_b32 s26, s17, 9
  s_lshl_b32 s20, s33, 2
  s_add_u32 s20, s20, s16
  s_mul_i32 s21, s20, 9363
  s_lshr_b32 s21, s21, 16
  s_mul_i32 s22, s21, 7
  s_sub_u32 s22, s20, s22
  s_mul_i32 s21, s21, 14336
  s_lshl_b32 s20, s22, 7
  s_add_u32 s20, s20, s21
  s_lshl_b32 s22, s22, 11
  s_add_u32 s52, s21, s22
  s_mov_b32 s68, s48
  s_and_b32 s69, s49, 0xffff
  s_mov_b32 s70, 1835008
  s_mov_b32 s71, 0x20000
  v_mul_u32_u24 v7, 896, v4
  v_lshl_add_u32 v7, v3, 5, v7
  buffer_load_dwordx4 v[128:131], v7, s[68:71], s20 offen
  buffer_load_dwordx4 v[132:135], v7, s[68:71], s20 offen offset:16
  s_mov_b32 s60, s44
  s_and_b32 s61, s45, 0xffff
  s_mov_b32 s62, 3670016
  s_mov_b32 s63, 0x20000
  s_mov_b32 s56, s46
  s_and_b32 s57, s47, 0xffff
  s_mov_b32 s58, 3670016
  s_mov_b32 s59, 0x20000
  s_mul_i32 s27, s17, 229376
  s_lshl_b32 s30, s18, 7
  s_add_u32 s27, s27, s30
  s_mul_i32 s30, s16, 57344
  s_add_u32 s27, s27, s30
  v_lshrrev_b32 v7, 3, v1
  v_and_b32 v8, 7, v1
  v_and_b32 v9, 2, v7
  v_xor_b32 v8, v8, v9
  v_mul_u32_u24 v7, 896, v7
  v_lshl_add_u32 v24, v8, 4, v7
  v_xor_b32 v25, 64, v24
  s_lshl_b32 s30, s16, 13
  s_add_u32 m0, s30, 0
  s_nop 0
  buffer_load_dwordx4 v24, s[56:59], s27 offen  lds
  s_add_u32 s27, s27, 7168
  s_add_u32 m0, s30, 1024
  s_nop 0
  buffer_load_dwordx4 v25, s[56:59], s27 offen  lds
  s_add_u32 s27, s27, 7168
  s_add_u32 m0, s30, 2048
  s_nop 0
  buffer_load_dwordx4 v24, s[56:59], s27 offen  lds
  s_add_u32 s27, s27, 7168
  s_add_u32 m0, s30, 3072
  s_nop 0
  buffer_load_dwordx4 v25, s[56:59], s27 offen  lds
  s_add_u32 s27, s27, 7168
  s_add_u32 m0, s30, 4096
  s_nop 0
  buffer_load_dwordx4 v24, s[56:59], s27 offen  lds
  s_add_u32 s27, s27, 7168
  s_add_u32 m0, s30, 5120
  s_nop 0
  buffer_load_dwordx4 v25, s[56:59], s27 offen  lds
  s_add_u32 s27, s27, 7168
  s_add_u32 m0, s30, 6144
  s_nop 0
  buffer_load_dwordx4 v24, s[56:59], s27 offen  lds
  s_add_u32 s27, s27, 7168
  s_add_u32 m0, s30, 7168
  s_nop 0
  buffer_load_dwordx4 v25, s[56:59], s27 offen  lds
  s_add_u32 s27, s27, 7168
  s_add_u32 s27, s28, 0
  s_min_u32 s27, s27, 13
  s_lshl_b32 s27, s27, 18
  s_add_u32 s27, s27, s26
  s_mov_b32 s55, s27
  v_lshrrev_b32 v7, 2, v4
  v_lshlrev_b32 v11, 4, v7
  v_lshlrev_b32 v7, 3, v7
  v_and_b32 v8, 3, v4
  v_add_u32 v7, v7, v8
  v_and_b32 v8, 2, v4
  v_lshl_add_u32 v11, v8, 1, v11
  v_and_b32 v8, 1, v4
  v_add_u32 v11, v11, v8
  v_or_b32 v10, 0, v3
  v_xor_b32 v10, v10, v4
  v_lshlrev_b32 v10, 4, v10
  v_lshl_add_u32 v44, v11, 9, v10
  v_lshl_add_u32 v10, v7, 9, v10
  v_add_u32 v32, s25, v10
  v_or_b32 v10, 4, v3
  v_xor_b32 v10, v10, v4
  v_lshlrev_b32 v10, 4, v10
  v_lshl_add_u32 v45, v11, 9, v10
  v_lshl_add_u32 v10, v7, 9, v10
  v_add_u32 v33, s25, v10
  v_or_b32 v10, 8, v3
  v_xor_b32 v10, v10, v4
  v_lshlrev_b32 v10, 4, v10
  v_lshl_add_u32 v46, v11, 9, v10
  v_lshl_add_u32 v10, v7, 9, v10
  v_add_u32 v34, s25, v10
  v_or_b32 v10, 12, v3
  v_xor_b32 v10, v10, v4
  v_lshlrev_b32 v10, 4, v10
  v_lshl_add_u32 v47, v11, 9, v10
  v_lshl_add_u32 v10, v7, 9, v10
  v_add_u32 v35, s25, v10
  s_mul_i32 s30, s17, 401408
  s_mul_i32 s31, s18, 57344
  s_add_u32 s30, s30, s31
  s_add_u32 s30, s30, 0
  v_add_u32 v28, s30, v2
  s_add_u32 s30, s30, 14336
  v_add_u32 v29, s30, v2
  s_add_u32 s30, s30, 14336
  v_add_u32 v30, s30, v2
  s_add_u32 s30, s30, 14336
  v_add_u32 v31, s30, v2
  s_add_u32 s30, s30, 14336
  v_mov_b32 v48, 1035512379
  v_lshrrev_b32 v7, 2, v4
  v_lshl_add_u32 v7, v3, 3, v7
  v_lshlrev_b32 v7, 7, v7
  v_and_b32 v8, 3, v4
  v_lshl_add_u32 v7, v8, 3, v7
  v_lshrrev_b32 v8, 3, v4
  v_and_b32 v9, 1, v3
  v_lshl_add_u32 v8, v9, 1, v8
  v_lshl_add_u32 v40, v8, 5, v7
  s_mul_i32 s31, s17, 28
  s_mov_b32 s29, 401408
  s_lshl_b32 s30, s18, 6
  s_add_u32 s30, s30, 0
  v_add_u32 v8, s30, v4
  v_subrev_u32 v9, 256, v8
  v_mul_u32_u24 v11, 171, v9
  v_lshrrev_b32 v11, 11, v11
  v_mul_u32_u24 v38, 12, v11
  v_sub_u32 v38, v9, v38
  v_add_u32 v38, 16, v38
  v_lshrrev_b32 v10, 4, v8
  v_cmp_gt_i32 vcc, 0, v9
  s_nop 1
  v_cndmask_b32 v10, v11, v10, vcc
  v_cndmask_b32 v39, v38, v4, vcc
  v_add_u32 v39, s31, v39
  v_lshrrev_b32 v38, 4, v39
  v_and_b32 v39, 15, v39
  v_mul_lo_u32 v10, v10, s29
  v_mul_u32_u24 v38, 14336, v38
  v_add_u32 v10, v10, v38
  v_lshl_add_u32 v10, v3, 8, v10
  v_lshl_add_u32 v10, v39, 4, v10
  v_add_u32 v12, 6422528, v10
  v_xor_b32 v41, 32, v40
  s_lshl_b32 s30, s18, 6
  s_add_u32 s30, s30, 16
  v_add_u32 v8, s30, v4
  v_subrev_u32 v9, 256, v8
  v_mul_u32_u24 v11, 171, v9
  v_lshrrev_b32 v11, 11, v11
  v_mul_u32_u24 v38, 12, v11
  v_sub_u32 v38, v9, v38
  v_add_u32 v38, 16, v38
  v_lshrrev_b32 v10, 4, v8
  v_cmp_gt_i32 vcc, 0, v9
  s_nop 1
  v_cndmask_b32 v10, v11, v10, vcc
  v_cndmask_b32 v39, v38, v4, vcc
  v_add_u32 v39, s31, v39
  v_lshrrev_b32 v38, 4, v39
  v_and_b32 v39, 15, v39
  v_mul_lo_u32 v10, v10, s29
  v_mul_u32_u24 v38, 14336, v38
  v_add_u32 v10, v10, v38
  v_lshl_add_u32 v10, v3, 8, v10
  v_lshl_add_u32 v10, v39, 4, v10
  v_add_u32 v13, 6422528, v10
  v_xor_b32 v42, 64, v40
  s_lshl_b32 s30, s18, 6
  s_add_u32 s30, s30, 32
  v_add_u32 v8, s30, v4
  v_subrev_u32 v9, 256, v8
  v_mul_u32_u24 v11, 171, v9
  v_lshrrev_b32 v11, 11, v11
  v_mul_u32_u24 v38, 12, v11
  v_sub_u32 v38, v9, v38
  v_add_u32 v38, 16, v38
  v_lshrrev_b32 v10, 4, v8
  v_cmp_gt_i32 vcc, 0, v9
  s_nop 1
  v_cndmask_b32 v10, v11, v10, vcc
  v_cndmask_b32 v39, v38, v4, vcc
  v_add_u32 v39, s31, v39
  v_lshrrev_b32 v38, 4, v39
  v_and_b32 v39, 15, v39
  v_mul_lo_u32 v10, v10, s29
  v_mul_u32_u24 v38, 14336, v38
  v_add_u32 v10, v10, v38
  v_lshl_add_u32 v10, v3, 8, v10
  v_lshl_add_u32 v10, v39, 4, v10
  v_add_u32 v14, 6422528, v10
  v_xor_b32 v43, 96, v40
  s_lshl_b32 s30, s18, 6
  s_add_u32 s30, s30, 48
  v_add_u32 v8, s30, v4
  v_subrev_u32 v9, 256, v8
  v_mul_u32_u24 v11, 171, v9
  v_lshrrev_b32 v11, 11, v11
  v_mul_u32_u24 v38, 12, v11
  v_sub_u32 v38, v9, v38
  v_add_u32 v38, 16, v38
  v_lshrrev_b32 v10, 4, v8
  v_cmp_gt_i32 vcc, 0, v9
  s_nop 1
  v_cndmask_b32 v10, v11, v10, vcc
  v_cndmask_b32 v39, v38, v4, vcc
  v_add_u32 v39, s31, v39
  v_lshrrev_b32 v38, 4, v39
  v_and_b32 v39, 15, v39
  v_mul_lo_u32 v10, v10, s29
  v_mul_u32_u24 v38, 14336, v38
  v_add_u32 v10, v10, v38
  v_lshl_add_u32 v10, v3, 8, v10
  v_lshl_add_u32 v10, v39, 4, v10
  v_add_u32 v15, 6422528, v10
  s_mov_b32 s27, s55
  s_add_u32 m0, s25, 0
  s_nop 0
  buffer_load_dwordx4 v16, s[60:63], s27 offen  lds
  s_add_u32 s27, s27, 16384
  s_add_u32 m0, s25, 1024
  s_nop 0
  buffer_load_dwordx4 v17, s[60:63], s27 offen  lds
  s_add_u32 s27, s27, 16384
  s_add_u32 m0, s25, 2048
  s_nop 0
  buffer_load_dwordx4 v16, s[60:63], s27 offen  lds
  s_add_u32 s27, s27, 16384
  s_add_u32 m0, s25, 3072
  s_nop 0
  buffer_load_dwordx4 v17, s[60:63], s27 offen  lds
  s_add_u32 s27, s27, 16384
  s_add_u32 m0, s25, 4096
  s_nop 0
  buffer_load_dwordx4 v18, s[60:63], s27 offen  lds
  s_add_u32 s27, s27, 16384
  s_add_u32 m0, s25, 5120
  s_nop 0
  buffer_load_dwordx4 v19, s[60:63], s27 offen  lds
  s_add_u32 s27, s27, 16384
  s_add_u32 m0, s25, 6144
  s_nop 0
  buffer_load_dwordx4 v18, s[60:63], s27 offen  lds
  s_add_u32 s27, s27, 16384
  s_add_u32 m0, s25, 7168
  s_nop 0
  buffer_load_dwordx4 v19, s[60:63], s27 offen  lds
  s_add_u32 s27, s27, 16384
  s_add_u32 m0, s25, 8192
  s_nop 0
  buffer_load_dwordx4 v20, s[60:63], s27 offen  lds
  s_add_u32 s27, s27, 16384
  s_add_u32 m0, s25, 9216
  s_nop 0
  buffer_load_dwordx4 v21, s[60:63], s27 offen  lds
  s_add_u32 s27, s27, 16384
  s_add_u32 m0, s25, 10240
  s_nop 0
  buffer_load_dwordx4 v20, s[60:63], s27 offen  lds
  s_add_u32 s27, s27, 16384
  s_add_u32 m0, s25, 11264
  s_nop 0
  buffer_load_dwordx4 v21, s[60:63], s27 offen  lds
  s_add_u32 s27, s27, 16384
  s_add_u32 m0, s25, 12288
  s_nop 0
  buffer_load_dwordx4 v22, s[60:63], s27 offen  lds
  s_add_u32 s27, s27, 16384
  s_add_u32 m0, s25, 13312
  s_nop 0
  buffer_load_dwordx4 v23, s[60:63], s27 offen  lds
  s_add_u32 s27, s27, 16384
  s_add_u32 m0, s25, 14336
  s_nop 0
  buffer_load_dwordx4 v22, s[60:63], s27 offen  lds
  s_add_u32 s27, s27, 16384
  s_add_u32 m0, s25, 15360
  s_nop 0
  buffer_load_dwordx4 v23, s[60:63], s27 offen  lds
  s_add_u32 s27, s27, 16384
  s_add_u32 s27, s28, 4
  s_min_u32 s27, s27, 13
  s_lshl_b32 s27, s27, 18
  s_add_u32 s27, s27, s26
  s_add_u32 m0, s25, 16384
  s_nop 0
  buffer_load_dwordx4 v16, s[60:63], s27 offen  lds
  s_add_u32 s27, s27, 16384
  s_add_u32 m0, s25, 17408
  s_nop 0
  buffer_load_dwordx4 v17, s[60:63], s27 offen  lds
  s_add_u32 s27, s27, 16384
  s_add_u32 m0, s25, 18432
  s_nop 0
  buffer_load_dwordx4 v16, s[60:63], s27 offen  lds
  s_add_u32 s27, s27, 16384
  s_add_u32 m0, s25, 19456
  s_nop 0
  buffer_load_dwordx4 v17, s[60:63], s27 offen  lds
  s_add_u32 s27, s27, 16384
  s_add_u32 m0, s25, 20480
  s_nop 0
  buffer_load_dwordx4 v18, s[60:63], s27 offen  lds
  s_add_u32 s27, s27, 16384
  s_add_u32 m0, s25, 21504
  s_nop 0
  buffer_load_dwordx4 v19, s[60:63], s27 offen  lds
  s_add_u32 s27, s27, 16384
  s_add_u32 m0, s25, 22528
  s_nop 0
  buffer_load_dwordx4 v18, s[60:63], s27 offen  lds
  s_add_u32 s27, s27, 16384
  s_add_u32 m0, s25, 23552
  s_nop 0
  buffer_load_dwordx4 v19, s[60:63], s27 offen  lds
  s_add_u32 s27, s27, 16384
  s_add_u32 m0, s25, 24576
  s_nop 0
  buffer_load_dwordx4 v20, s[60:63], s27 offen  lds
  s_add_u32 s27, s27, 16384
  s_add_u32 m0, s25, 25600
  s_nop 0
  buffer_load_dwordx4 v21, s[60:63], s27 offen  lds
  s_add_u32 s27, s27, 16384
  s_add_u32 m0, s25, 26624
  s_nop 0
  buffer_load_dwordx4 v20, s[60:63], s27 offen  lds
  s_add_u32 s27, s27, 16384
  s_add_u32 m0, s25, 27648
  s_nop 0
  buffer_load_dwordx4 v21, s[60:63], s27 offen  lds
  s_add_u32 s27, s27, 16384
  s_add_u32 m0, s25, 28672
  s_nop 0
  buffer_load_dwordx4 v22, s[60:63], s27 offen  lds
  s_add_u32 s27, s27, 16384
  s_add_u32 m0, s25, 29696
  s_nop 0
  buffer_load_dwordx4 v23, s[60:63], s27 offen  lds
  s_add_u32 s27, s27, 16384
  s_add_u32 m0, s25, 30720
  s_nop 0
  buffer_load_dwordx4 v22, s[60:63], s27 offen  lds
  s_add_u32 s27, s27, 16384
  s_add_u32 m0, s25, 31744
  s_nop 0
  buffer_load_dwordx4 v23, s[60:63], s27 offen  lds
  s_add_u32 s27, s27, 16384
  s_cmp_lt_u32 s18, 4
  s_cselect_b32 s34, 1, s97
  s_mov_b32 s68, s40
  s_and_b32 s69, s41, 0xffff
  s_mov_b32 s70, 3670016
  s_mov_b32 s71, 0x20000
  s_and_b32 s20, s33, 0xe0
  s_mul_i32 s20, s20, 9363
  s_lshr_b32 s20, s20, 16
  s_lshl_b32 s20, s20, 10
  s_and_b32 s21, s33, 31
  s_mul_i32 s21, s21, 192
  s_add_u32 s20, s20, s21
  v_min_u32 v7, 191, v0
  v_add_u32 v7, s20, v7
  v_lshrrev_b32 v8, 11, v7
  v_min_u32 v8, 15, v8
  v_bfe_u32 v9, v7, 2, 9
  v_lshlrev_b32 v9, 13, v9
  v_lshl_add_u32 v9, v8, 9, v9
  v_and_b32 v7, 3, v7
  v_lshl_add_u32 v9, v7, 7, v9
  buffer_load_dword v253, v9, s[68:71], 0 offen
  s_mov_b32 s68, s42
  s_and_b32 s69, s43, 0xffff
  s_mov_b32 s70, 3670016
  s_mov_b32 s71, 0x20000
  s_lshl_b32 s27, s18, 19
  s_add_u32 s27, s27, s26
  s_cmp_lg_u32 s34, 0
  s_cselect_b32 s27, 0x40000000, s27
  v_lshrrev_b32 v7, 2, v0
  v_and_b32 v8, 3, v0
  v_lshlrev_b32 v8, 7, v8
  v_lshl_add_u32 v9, v7, 13, v8
  buffer_load_dword v253, v9, s[68:71], s27 offen
  s_lshl_b32 s29, s28, 10
  s_add_u32 s31, s29, 4096
  s_cmp_lt_u32 s28, 10
  s_cselect_b32 s31, s31, 0x40000000
  s_waitcnt vmcnt(2)
  s_barrier
  ds_read_b64_tr_b16 a[0:1], v40 offset:0
  ds_read_b64_tr_b16 a[2:3], v40 offset:512
  ds_read_b64_tr_b16 a[32:33], v41 offset:0
  ds_read_b64_tr_b16 a[34:35], v41 offset:512
  ds_read_b64_tr_b16 a[64:65], v42 offset:0
  ds_read_b64_tr_b16 a[66:67], v42 offset:512
  ds_read_b64_tr_b16 a[96:97], v43 offset:0
  ds_read_b64_tr_b16 a[98:99], v43 offset:512
  ds_read_b128 a[128:131], v32 offset:0
  ds_read_b128 a[160:163], v32 offset:2048
  ds_read_b128 a[192:195], v32 offset:16384
  ds_read_b128 a[224:227], v32 offset:18432
  v_lshlrev_b32 v144, 9, v3
  v_lshl_add_u32 v144, v4, 4, v144
  s_add_u32 s53, s52, 73859072
  s_add_u32 s52, s52, 72024064
  v_mov_b32 v136, v128
  v_mov_b32 v140, v129
  v_mov_b32 v137, v130
  v_mov_b32 v141, v131
  v_mov_b32 v138, v132
  v_mov_b32 v142, v133
  v_mov_b32 v139, v134
  v_mov_b32 v143, v135
  buffer_store_dwordx4 v[128:131], v144, s[8:11], s52 offen sc1
  buffer_store_dwordx4 v[132:135], v144, s[8:11], s52 offen offset:256 sc1
  buffer_store_dwordx4 v[136:139], v2, s[8:11], s53 offen sc1
  buffer_store_dwordx4 v[140:143], v2, s[8:11], s53 offen offset:1024 sc1
  s_waitcnt lgkmcnt(0)
  v_mfma_f32_16x16x32_bf16 v[64:67], a[128:131], a[0:3], 0
  ds_read_b64_tr_b16 a[4:5], v40 offset:4096
  ds_read_b64_tr_b16 a[6:7], v40 offset:4608
  v_mfma_f32_16x16x32_bf16 v[68:71], a[160:163], a[0:3], 0
  ds_read_b64_tr_b16 a[36:37], v41 offset:4096
  ds_read_b64_tr_b16 a[38:39], v41 offset:4608
  v_mfma_f32_16x16x32_bf16 v[72:75], a[128:131], a[32:35], 0
  ds_read_b64_tr_b16 a[68:69], v42 offset:4096
  ds_read_b64_tr_b16 a[70:71], v42 offset:4608
  v_mfma_f32_16x16x32_bf16 v[76:79], a[160:163], a[32:35], 0
  ds_read_b64_tr_b16 a[100:101], v43 offset:4096
  ds_read_b64_tr_b16 a[102:103], v43 offset:4608
  v_mfma_f32_16x16x32_bf16 v[80:83], a[128:131], a[64:67], 0
  ds_read_b128 a[132:135], v33 offset:0
  ds_read_b128 a[164:167], v33 offset:2048
  v_mfma_f32_16x16x32_bf16 v[84:87], a[160:163], a[64:67], 0
  ds_read_b128 a[196:199], v33 offset:16384
  ds_read_b128 a[228:231], v33 offset:18432
  v_mfma_f32_16x16x32_bf16 v[88:91], a[128:131], a[96:99], 0
  v_mfma_f32_16x16x32_bf16 v[92:95], a[160:163], a[96:99], 0
  v_mfma_f32_16x16x32_bf16 v[96:99], a[192:195], a[0:3], 0
  v_mfma_f32_16x16x32_bf16 v[100:103], a[224:227], a[0:3], 0
  v_mfma_f32_16x16x32_bf16 v[104:107], a[192:195], a[32:35], 0
  v_mfma_f32_16x16x32_bf16 v[108:111], a[224:227], a[32:35], 0
  v_mfma_f32_16x16x32_bf16 v[112:115], a[192:195], a[64:67], 0
  v_mfma_f32_16x16x32_bf16 v[116:119], a[224:227], a[64:67], 0
  v_mfma_f32_16x16x32_bf16 v[120:123], a[192:195], a[96:99], 0
  v_mfma_f32_16x16x32_bf16 v[124:127], a[224:227], a[96:99], 0
  s_waitcnt lgkmcnt(0)
  v_mfma_f32_16x16x32_bf16 v[64:67], a[132:135], a[4:7], v[64:67]
  ds_read_b64_tr_b16 a[8:9], v40 offset:8192
  ds_read_b64_tr_b16 a[10:11], v40 offset:8704
  v_mfma_f32_16x16x32_bf16 v[68:71], a[164:167], a[4:7], v[68:71]
  ds_read_b64_tr_b16 a[40:41], v41 offset:8192
  ds_read_b64_tr_b16 a[42:43], v41 offset:8704
  v_mfma_f32_16x16x32_bf16 v[72:75], a[132:135], a[36:39], v[72:75]
  ds_read_b64_tr_b16 a[72:73], v42 offset:8192
  ds_read_b64_tr_b16 a[74:75], v42 offset:8704
  v_mfma_f32_16x16x32_bf16 v[76:79], a[164:167], a[36:39], v[76:79]
  ds_read_b64_tr_b16 a[104:105], v43 offset:8192
  ds_read_b64_tr_b16 a[106:107], v43 offset:8704
  v_mfma_f32_16x16x32_bf16 v[80:83], a[132:135], a[68:71], v[80:83]
  ds_read_b128 a[136:139], v34 offset:0
  ds_read_b128 a[168:171], v34 offset:2048
  v_mfma_f32_16x16x32_bf16 v[84:87], a[164:167], a[68:71], v[84:87]
  ds_read_b128 a[200:203], v34 offset:16384
  ds_read_b128 a[232:235], v34 offset:18432
  v_mfma_f32_16x16x32_bf16 v[88:91], a[132:135], a[100:103], v[88:91]
  v_mfma_f32_16x16x32_bf16 v[92:95], a[164:167], a[100:103], v[92:95]
  v_mfma_f32_16x16x32_bf16 v[96:99], a[196:199], a[4:7], v[96:99]
  v_mfma_f32_16x16x32_bf16 v[100:103], a[228:231], a[4:7], v[100:103]
  v_mfma_f32_16x16x32_bf16 v[104:107], a[196:199], a[36:39], v[104:107]
  v_mfma_f32_16x16x32_bf16 v[108:111], a[228:231], a[36:39], v[108:111]
  v_mfma_f32_16x16x32_bf16 v[112:115], a[196:199], a[68:71], v[112:115]
  v_mfma_f32_16x16x32_bf16 v[116:119], a[228:231], a[68:71], v[116:119]
  v_mfma_f32_16x16x32_bf16 v[120:123], a[196:199], a[100:103], v[120:123]
  v_mfma_f32_16x16x32_bf16 v[124:127], a[228:231], a[100:103], v[124:127]
  s_waitcnt lgkmcnt(0)
  v_mfma_f32_16x16x32_bf16 v[64:67], a[136:139], a[8:11], v[64:67]
  ds_read_b64_tr_b16 a[12:13], v40 offset:12288
  ds_read_b64_tr_b16 a[14:15], v40 offset:12800
  v_mfma_f32_16x16x32_bf16 v[68:71], a[168:171], a[8:11], v[68:71]
  ds_read_b64_tr_b16 a[44:45], v41 offset:12288
  ds_read_b64_tr_b16 a[46:47], v41 offset:12800
  v_mfma_f32_16x16x32_bf16 v[72:75], a[136:139], a[40:43], v[72:75]
  ds_read_b64_tr_b16 a[76:77], v42 offset:12288
  ds_read_b64_tr_b16 a[78:79], v42 offset:12800
  v_mfma_f32_16x16x32_bf16 v[76:79], a[168:171], a[40:43], v[76:79]
  ds_read_b64_tr_b16 a[108:109], v43 offset:12288
  ds_read_b64_tr_b16 a[110:111], v43 offset:12800
  v_mfma_f32_16x16x32_bf16 v[80:83], a[136:139], a[72:75], v[80:83]
  ds_read_b128 a[140:143], v35 offset:0
  ds_read_b128 a[172:175], v35 offset:2048
  v_mfma_f32_16x16x32_bf16 v[84:87], a[168:171], a[72:75], v[84:87]
  ds_read_b128 a[204:207], v35 offset:16384
  ds_read_b128 a[236:239], v35 offset:18432
  v_mfma_f32_16x16x32_bf16 v[88:91], a[136:139], a[104:107], v[88:91]
  v_mfma_f32_16x16x32_bf16 v[92:95], a[168:171], a[104:107], v[92:95]
  v_mfma_f32_16x16x32_bf16 v[96:99], a[200:203], a[8:11], v[96:99]
  v_mfma_f32_16x16x32_bf16 v[100:103], a[232:235], a[8:11], v[100:103]
  v_mfma_f32_16x16x32_bf16 v[104:107], a[200:203], a[40:43], v[104:107]
  v_mfma_f32_16x16x32_bf16 v[108:111], a[232:235], a[40:43], v[108:111]
  v_mfma_f32_16x16x32_bf16 v[112:115], a[200:203], a[72:75], v[112:115]
  v_mfma_f32_16x16x32_bf16 v[116:119], a[232:235], a[72:75], v[116:119]
  v_mfma_f32_16x16x32_bf16 v[120:123], a[200:203], a[104:107], v[120:123]
  v_mfma_f32_16x16x32_bf16 v[124:127], a[232:235], a[104:107], v[124:127]
  s_waitcnt lgkmcnt(0)
  v_mfma_f32_16x16x32_bf16 v[64:67], a[140:143], a[12:15], v[64:67]
  ds_read_b64_tr_b16 a[16:17], v40 offset:16384
  ds_read_b64_tr_b16 a[18:19], v40 offset:16896
  v_mfma_f32_16x16x32_bf16 v[68:71], a[172:175], a[12:15], v[68:71]
  ds_read_b64_tr_b16 a[48:49], v41 offset:16384
  ds_read_b64_tr_b16 a[50:51], v41 offset:16896
  v_mfma_f32_16x16x32_bf16 v[72:75], a[140:143], a[44:47], v[72:75]
  ds_read_b64_tr_b16 a[80:81], v42 offset:16384
  ds_read_b64_tr_b16 a[82:83], v42 offset:16896
  v_mfma_f32_16x16x32_bf16 v[76:79], a[172:175], a[44:47], v[76:79]
  ds_read_b64_tr_b16 a[112:113], v43 offset:16384
  ds_read_b64_tr_b16 a[114:115], v43 offset:16896
  v_mfma_f32_16x16x32_bf16 v[80:83], a[140:143], a[76:79], v[80:83]
  ds_read_b128 a[144:147], v32 offset:256
  ds_read_b128 a[176:179], v32 offset:2304
  v_mfma_f32_16x16x32_bf16 v[84:87], a[172:175], a[76:79], v[84:87]
  ds_read_b128 a[208:211], v32 offset:16640
  ds_read_b128 a[240:243], v32 offset:18688
  v_mfma_f32_16x16x32_bf16 v[88:91], a[140:143], a[108:111], v[88:91]
  v_mfma_f32_16x16x32_bf16 v[92:95], a[172:175], a[108:111], v[92:95]
  v_mfma_f32_16x16x32_bf16 v[96:99], a[204:207], a[12:15], v[96:99]
  v_mfma_f32_16x16x32_bf16 v[100:103], a[236:239], a[12:15], v[100:103]
  v_mfma_f32_16x16x32_bf16 v[104:107], a[204:207], a[44:47], v[104:107]
  v_mfma_f32_16x16x32_bf16 v[108:111], a[236:239], a[44:47], v[108:111]
  v_mfma_f32_16x16x32_bf16 v[112:115], a[204:207], a[76:79], v[112:115]
  v_mfma_f32_16x16x32_bf16 v[116:119], a[236:239], a[76:79], v[116:119]
  v_mfma_f32_16x16x32_bf16 v[120:123], a[204:207], a[108:111], v[120:123]
  v_mfma_f32_16x16x32_bf16 v[124:127], a[236:239], a[108:111], v[124:127]
  s_waitcnt lgkmcnt(0)
  v_mfma_f32_16x16x32_bf16 v[64:67], a[144:147], a[16:19], v[64:67]
  ds_read_b64_tr_b16 a[20:21], v40 offset:20480
  ds_read_b64_tr_b16 a[22:23], v40 offset:20992
  v_mfma_f32_16x16x32_bf16 v[68:71], a[176:179], a[16:19], v[68:71]
  ds_read_b64_tr_b16 a[52:53], v41 offset:20480
  ds_read_b64_tr_b16 a[54:55], v41 offset:20992
  v_mfma_f32_16x16x32_bf16 v[72:75], a[144:147], a[48:51], v[72:75]
  ds_read_b64_tr_b16 a[84:85], v42 offset:20480
  ds_read_b64_tr_b16 a[86:87], v42 offset:20992
  v_mfma_f32_16x16x32_bf16 v[76:79], a[176:179], a[48:51], v[76:79]
  ds_read_b64_tr_b16 a[116:117], v43 offset:20480
  ds_read_b64_tr_b16 a[118:119], v43 offset:20992
  v_mfma_f32_16x16x32_bf16 v[80:83], a[144:147], a[80:83], v[80:83]
  ds_read_b128 a[148:151], v33 offset:256
  ds_read_b128 a[180:183], v33 offset:2304
  v_mfma_f32_16x16x32_bf16 v[84:87], a[176:179], a[80:83], v[84:87]
  ds_read_b128 a[212:215], v33 offset:16640
  ds_read_b128 a[244:247], v33 offset:18688
  v_mfma_f32_16x16x32_bf16 v[88:91], a[144:147], a[112:115], v[88:91]
  v_mfma_f32_16x16x32_bf16 v[92:95], a[176:179], a[112:115], v[92:95]
  v_mfma_f32_16x16x32_bf16 v[96:99], a[208:211], a[16:19], v[96:99]
  v_mfma_f32_16x16x32_bf16 v[100:103], a[240:243], a[16:19], v[100:103]
  v_mfma_f32_16x16x32_bf16 v[104:107], a[208:211], a[48:51], v[104:107]
  v_mfma_f32_16x16x32_bf16 v[108:111], a[240:243], a[48:51], v[108:111]
  v_mfma_f32_16x16x32_bf16 v[112:115], a[208:211], a[80:83], v[112:115]
  v_mfma_f32_16x16x32_bf16 v[116:119], a[240:243], a[80:83], v[116:119]
  v_mfma_f32_16x16x32_bf16 v[120:123], a[208:211], a[112:115], v[120:123]
  v_mfma_f32_16x16x32_bf16 v[124:127], a[240:243], a[112:115], v[124:127]
  s_waitcnt lgkmcnt(0)
  v_mfma_f32_16x16x32_bf16 v[64:67], a[148:151], a[20:23], v[64:67]
  ds_read_b64_tr_b16 a[24:25], v40 offset:24576
  ds_read_b64_tr_b16 a[26:27], v40 offset:25088
  v_mfma_f32_16x16x32_bf16 v[68:71], a[180:183], a[20:23], v[68:71]
  ds_read_b64_tr_b16 a[56:57], v41 offset:24576
  ds_read_b64_tr_b16 a[58:59], v41 offset:25088
  v_mfma_f32_16x16x32_bf16 v[72:75], a[148:151], a[52:55], v[72:75]
  ds_read_b64_tr_b16 a[88:89], v42 offset:24576
  ds_read_b64_tr_b16 a[90:91], v42 offset:25088
  v_mfma_f32_16x16x32_bf16 v[76:79], a[180:183], a[52:55], v[76:79]
  ds_read_b64_tr_b16 a[120:121], v43 offset:24576
  ds_read_b64_tr_b16 a[122:123], v43 offset:25088
  v_mfma_f32_16x16x32_bf16 v[80:83], a[148:151], a[84:87], v[80:83]
  ds_read_b128 a[152:155], v34 offset:256
  ds_read_b128 a[184:187], v34 offset:2304
  v_mfma_f32_16x16x32_bf16 v[84:87], a[180:183], a[84:87], v[84:87]
  ds_read_b128 a[216:219], v34 offset:16640
  ds_read_b128 a[248:251], v34 offset:18688
  v_mfma_f32_16x16x32_bf16 v[88:91], a[148:151], a[116:119], v[88:91]
  v_mfma_f32_16x16x32_bf16 v[92:95], a[180:183], a[116:119], v[92:95]
  v_mfma_f32_16x16x32_bf16 v[96:99], a[212:215], a[20:23], v[96:99]
  v_mfma_f32_16x16x32_bf16 v[100:103], a[244:247], a[20:23], v[100:103]
  v_mfma_f32_16x16x32_bf16 v[104:107], a[212:215], a[52:55], v[104:107]
  v_mfma_f32_16x16x32_bf16 v[108:111], a[244:247], a[52:55], v[108:111]
  v_mfma_f32_16x16x32_bf16 v[112:115], a[212:215], a[84:87], v[112:115]
  v_mfma_f32_16x16x32_bf16 v[116:119], a[244:247], a[84:87], v[116:119]
  v_mfma_f32_16x16x32_bf16 v[120:123], a[212:215], a[116:119], v[120:123]
  v_mfma_f32_16x16x32_bf16 v[124:127], a[244:247], a[116:119], v[124:127]
  s_waitcnt lgkmcnt(0)
  v_mfma_f32_16x16x32_bf16 v[64:67], a[152:155], a[24:27], v[64:67]
  ds_read_b64_tr_b16 a[28:29], v40 offset:28672
  ds_read_b64_tr_b16 a[30:31], v40 offset:29184
  v_mfma_f32_16x16x32_bf16 v[68:71], a[184:187], a[24:27], v[68:71]
  ds_read_b64_tr_b16 a[60:61], v41 offset:28672
  ds_read_b64_tr_b16 a[62:63], v41 offset:29184
  v_mfma_f32_16x16x32_bf16 v[72:75], a[152:155], a[56:59], v[72:75]
  ds_read_b64_tr_b16 a[92:93], v42 offset:28672
  ds_read_b64_tr_b16 a[94:95], v42 offset:29184
  v_mfma_f32_16x16x32_bf16 v[76:79], a[184:187], a[56:59], v[76:79]
  ds_read_b64_tr_b16 a[124:125], v43 offset:28672
  ds_read_b64_tr_b16 a[126:127], v43 offset:29184
  v_mfma_f32_16x16x32_bf16 v[80:83], a[152:155], a[88:91], v[80:83]
  ds_read_b128 a[156:159], v35 offset:256
  ds_read_b128 a[188:191], v35 offset:2304
  v_mfma_f32_16x16x32_bf16 v[84:87], a[184:187], a[88:91], v[84:87]
  ds_read_b128 a[220:223], v35 offset:16640
  ds_read_b128 a[252:255], v35 offset:18688
  v_mfma_f32_16x16x32_bf16 v[88:91], a[152:155], a[120:123], v[88:91]
  v_mfma_f32_16x16x32_bf16 v[92:95], a[184:187], a[120:123], v[92:95]
  v_mfma_f32_16x16x32_bf16 v[96:99], a[216:219], a[24:27], v[96:99]
  v_mfma_f32_16x16x32_bf16 v[100:103], a[248:251], a[24:27], v[100:103]
  v_mfma_f32_16x16x32_bf16 v[104:107], a[216:219], a[56:59], v[104:107]
  v_mfma_f32_16x16x32_bf16 v[108:111], a[248:251], a[56:59], v[108:111]
  v_mfma_f32_16x16x32_bf16 v[112:115], a[216:219], a[88:91], v[112:115]
  v_mfma_f32_16x16x32_bf16 v[116:119], a[248:251], a[88:91], v[116:119]
  v_mfma_f32_16x16x32_bf16 v[120:123], a[216:219], a[120:123], v[120:123]
  v_mfma_f32_16x16x32_bf16 v[124:127], a[248:251], a[120:123], v[124:127]
  s_waitcnt lgkmcnt(0)
  s_barrier
  buffer_load_dwordx2 v[254:255], v252, s[12:15], 0 offen offset:128 sc1
  buffer_load_dword v253, v252, s[12:15], 0 offen sc1
  v_mfma_f32_16x16x32_bf16 v[64:67], a[156:159], a[28:31], v[64:67]
  v_mfma_f32_16x16x32_bf16 v[68:71], a[188:191], a[28:31], v[68:71]
  v_mfma_f32_16x16x32_bf16 v[72:75], a[156:159], a[60:63], v[72:75]
  v_mfma_f32_16x16x32_bf16 v[76:79], a[188:191], a[60:63], v[76:79]
  v_mfma_f32_16x16x32_bf16 v[80:83], a[156:159], a[92:95], v[80:83]
  v_cvt_pk_bf16_f32 v64, v64, v65
  v_cvt_pk_bf16_f32 v65, v66, v67
  v_mfma_f32_16x16x32_bf16 v[84:87], a[188:191], a[92:95], v[84:87]
  v_cvt_pk_bf16_f32 v66, v68, v69
  v_cvt_pk_bf16_f32 v67, v70, v71
  v_mfma_f32_16x16x32_bf16 v[88:91], a[156:159], a[124:127], v[88:91]
  buffer_store_dwordx4 v[64:67], v12, s[8:11], s29 offen sc1
  v_cvt_pk_bf16_f32 v72, v72, v73
  v_mfma_f32_16x16x32_bf16 v[92:95], a[188:191], a[124:127], v[92:95]
  v_cvt_pk_bf16_f32 v73, v74, v75
  v_cvt_pk_bf16_f32 v74, v76, v77
  v_mfma_f32_16x16x32_bf16 v[96:99], a[220:223], a[28:31], v[96:99]
  v_cvt_pk_bf16_f32 v75, v78, v79
  buffer_store_dwordx4 v[72:75], v13, s[8:11], s29 offen sc1
  v_mfma_f32_16x16x32_bf16 v[100:103], a[252:255], a[28:31], v[100:103]
  v_cvt_pk_bf16_f32 v80, v80, v81
  v_cvt_pk_bf16_f32 v81, v82, v83
  v_mfma_f32_16x16x32_bf16 v[104:107], a[220:223], a[60:63], v[104:107]
  v_cvt_pk_bf16_f32 v82, v84, v85
  v_cvt_pk_bf16_f32 v83, v86, v87
  v_mfma_f32_16x16x32_bf16 v[108:111], a[252:255], a[60:63], v[108:111]
  buffer_store_dwordx4 v[80:83], v14, s[8:11], s29 offen sc1
  v_cvt_pk_bf16_f32 v88, v88, v89
  v_mfma_f32_16x16x32_bf16 v[112:115], a[220:223], a[92:95], v[112:115]
  v_cvt_pk_bf16_f32 v89, v90, v91
  v_cvt_pk_bf16_f32 v90, v92, v93
  v_mfma_f32_16x16x32_bf16 v[116:119], a[252:255], a[92:95], v[116:119]
  v_cvt_pk_bf16_f32 v91, v94, v95
  buffer_store_dwordx4 v[88:91], v15, s[8:11], s29 offen sc1
  v_mfma_f32_16x16x32_bf16 v[120:123], a[220:223], a[124:127], v[120:123]
  v_cvt_pk_bf16_f32 v96, v96, v97
  v_cvt_pk_bf16_f32 v97, v98, v99
  v_mfma_f32_16x16x32_bf16 v[124:127], a[252:255], a[124:127], v[124:127]
  v_cvt_pk_bf16_f32 v98, v100, v101
  v_cvt_pk_bf16_f32 v99, v102, v103
  buffer_store_dwordx4 v[96:99], v12, s[8:11], s31 offen sc1
  v_cvt_pk_bf16_f32 v104, v104, v105
  v_cvt_pk_bf16_f32 v105, v106, v107
  v_cvt_pk_bf16_f32 v106, v108, v109
  v_cvt_pk_bf16_f32 v107, v110, v111
  buffer_store_dwordx4 v[104:107], v13, s[8:11], s31 offen sc1
  v_cvt_pk_bf16_f32 v112, v112, v113
  v_cvt_pk_bf16_f32 v113, v114, v115
  v_cvt_pk_bf16_f32 v114, v116, v117
  v_cvt_pk_bf16_f32 v115, v118, v119
  buffer_store_dwordx4 v[112:115], v14, s[8:11], s31 offen sc1
  v_cvt_pk_bf16_f32 v120, v120, v121
  v_cvt_pk_bf16_f32 v121, v122, v123
  v_cvt_pk_bf16_f32 v122, v124, v125
  v_cvt_pk_bf16_f32 v123, v126, v127
  buffer_store_dwordx4 v[120:123], v15, s[8:11], s31 offen sc1
  s_cmp_lg_u32 s34, 0
  s_cbranch_scc1 wp_B2
  s_mov_b32 s60, s40
  s_and_b32 s61, s41, 0xffff
  s_mov_b32 s62, 3670016
  s_mov_b32 s63, 0x20000
  s_mov_b32 s56, s42
  s_and_b32 s57, s43, 0xffff
  s_mov_b32 s58, 3670016
  s_mov_b32 s59, 0x20000
  s_lshl_b32 s27, s18, 2
  s_add_u32 s27, s27, s16
  s_lshl_b32 s27, s27, 17
  s_add_u32 s27, s27, s26
  s_lshl_b32 s30, s16, 13
  s_add_u32 m0, s30, 0
  s_nop 0
  buffer_load_dwordx4 v26, s[56:59], s27 offen  lds
  s_add_u32 s27, s27, 16384
  s_add_u32 m0, s30, 1024
  s_nop 0
  buffer_load_dwordx4 v26, s[56:59], s27 offen  lds
  s_add_u32 s27, s27, 16384
  s_add_u32 m0, s30, 2048
  s_nop 0
  buffer_load_dwordx4 v27, s[56:59], s27 offen  lds
  s_add_u32 s27, s27, 16384
  s_add_u32 m0, s30, 3072
  s_nop 0
  buffer_load_dwordx4 v27, s[56:59], s27 offen  lds
  s_add_u32 s27, s27, 16384
  s_add_u32 m0, s30, 4096
  s_nop 0
  buffer_load_dwordx4 v26, s[56:59], s27 offen  lds
  s_add_u32 s27, s27, 16384
  s_add_u32 m0, s30, 5120
  s_nop 0
  buffer_load_dwordx4 v26, s[56:59], s27 offen  lds
  s_add_u32 s27, s27, 16384
  s_add_u32 m0, s30, 6144
  s_nop 0
  buffer_load_dwordx4 v27, s[56:59], s27 offen  lds
  s_add_u32 s27, s27, 16384
  s_add_u32 m0, s30, 7168
  s_nop 0
  buffer_load_dwordx4 v27, s[56:59], s27 offen  lds
  s_add_u32 s27, s27, 16384
  s_add_u32 s27, s28, 0
  s_min_u32 s27, s27, 13
  s_lshl_b32 s27, s27, 18
  s_add_u32 s27, s27, s26
  s_add_u32 m0, s25, 0
  s_nop 0
  buffer_load_dwordx4 v16, s[60:63], s27 offen  lds
  s_add_u32 s27, s27, 16384
  s_add_u32 m0, s25, 1024
  s_nop 0
  buffer_load_dwordx4 v17, s[60:63], s27 offen  lds
  s_add_u32 s27, s27, 16384
  s_add_u32 m0, s25, 2048
  s_nop 0
  buffer_load_dwordx4 v16, s[60:63], s27 offen  lds
  s_add_u32 s27, s27, 16384
  s_add_u32 m0, s25, 3072
  s_nop 0
  buffer_load_dwordx4 v17, s[60:63], s27 offen  lds
  s_add_u32 s27, s27, 16384
  s_waitcnt vmcnt(12)
  s_barrier
  s_cmp_lg_u32 s16, 0
  s_cbranch_scc1 wp_f1_f
  v_readfirstlane_b32 s20, v254
  s_cmp_eq_u32 s20, 1
  s_cbranch_scc1 wp_f1_w_ok
  s_mov_b32 s30, 0
wp_f1_w:
  buffer_load_dword v254, off, s[12:15], 0 offset:128 sc1
  s_waitcnt vmcnt(0)
  v_cmp_ne_u32 vcc, 1, v254
  s_cbranch_vccz wp_f1_w_ok
  s_sleep 8
  s_add_u32 s30, s30, 1
  s_cmp_lt_u32 s30, 16
  s_cbranch_scc1 wp_f1_w
  s_branch wp_f1_f
wp_f1_w_ok:
  s_lshl_b32 s20, s17, 7
  s_add_u32 s20, s20, 88519168
  s_lshl_b32 s21, 1, s19
  v_mov_b32 v248, s21
  s_mov_b64 exec, 1
  buffer_atomic_or v248, v252, s[8:11], s20 offen sc0
  s_mov_b64 exec, -1
  s_mov_b32 s37, s21
wp_f1_f:
  s_add_u32 m0, s25, 4096
  s_nop 0
  buffer_load_dwordx4 v18, s[60:63], s27 offen  lds
  s_add_u32 s27, s27, 16384
  s_add_u32 m0, s25, 5120
  s_nop 0
  buffer_load_dwordx4 v19, s[60:63], s27 offen  lds
  s_add_u32 s27, s27, 16384
  s_add_u32 m0, s25, 6144
  s_nop 0
  buffer_load_dwordx4 v18, s[60:63], s27 offen  lds
  s_add_u32 s27, s27, 16384
  s_add_u32 m0, s25, 7168
  s_nop 0
  buffer_load_dwordx4 v19, s[60:63], s27 offen  lds
  s_add_u32 s27, s27, 16384
  s_add_u32 m0, s25, 8192
  s_nop 0
  buffer_load_dwordx4 v20, s[60:63], s27 offen  lds
  s_add_u32 s27, s27, 16384
  s_add_u32 m0, s25, 9216
  s_nop 0
  buffer_load_dwordx4 v21, s[60:63], s27 offen  lds
  s_add_u32 s27, s27, 16384
  s_add_u32 m0, s25, 10240
  s_nop 0
  buffer_load_dwordx4 v20, s[60:63], s27 offen  lds
  s_add_u32 s27, s27, 16384
  s_add_u32 m0, s25, 11264
  s_nop 0
  buffer_load_dwordx4 v21, s[60:63], s27 offen  lds
  s_add_u32 s27, s27, 16384
  s_add_u32 m0, s25, 12288
  s_nop 0
  buffer_load_dwordx4 v22, s[60:63], s27 offen  lds
  s_add_u32 s27, s27, 16384
  s_add_u32 m0, s25, 13312
  s_nop 0
  buffer_load_dwordx4 v23, s[60:63], s27 offen  lds
  s_add_u32 s27, s27, 16384
  s_add_u32 m0, s25, 14336
  s_nop 0
  buffer_load_dwordx4 v22, s[60:63], s27 offen  lds
  s_add_u32 s27, s27, 16384
  s_add_u32 m0, s25, 15360
  s_nop 0
  buffer_load_dwordx4 v23, s[60:63], s27 offen  lds
  s_add_u32 s27, s27, 16384
  s_add_u32 s27, s28, 4
  s_min_u32 s27, s27, 13
  s_lshl_b32 s27, s27, 18
  s_add_u32 s27, s27, s26
  s_waitcnt vmcnt(12)
  v_readfirstlane_b32 s20, v248
  s_and_b32 s20, s20, 16383
  s_xor_b32 s20, s20, s37
  s_cmp_lg_u32 s20, 16383
  s_cselect_b32 s20, 0, s37
  s_mov_b32 s37, 0
  s_cmp_eq_u32 s20, 0
  s_cbranch_scc1 wp_g1
  s_lshl_b32 s21, 1, s17
  v_mov_b32 v248, s21
  s_mov_b32 s20, 88523264
  v_lshlrev_b32 v247, 7, v0
  s_mov_b64 exec, 0xff
  buffer_atomic_or v248, v247, s[8:11], s20 offen
  s_mov_b64 exec, -1
wp_g1:
  s_add_u32 m0, s25, 16384
  s_nop 0
  buffer_load_dwordx4 v16, s[60:63], s27 offen  lds
  s_add_u32 s27, s27, 16384
  s_add_u32 m0, s25, 17408
  s_nop 0
  buffer_load_dwordx4 v17, s[60:63], s27 offen  lds
  s_add_u32 s27, s27, 16384
  s_add_u32 m0, s25, 18432
  s_nop 0
  buffer_load_dwordx4 v16, s[60:63], s27 offen  lds
  s_add_u32 s27, s27, 16384
  s_add_u32 m0, s25, 19456
  s_nop 0
  buffer_load_dwordx4 v17, s[60:63], s27 offen  lds
  s_add_u32 s27, s27, 16384
  s_add_u32 m0, s25, 20480
  s_nop 0
  buffer_load_dwordx4 v18, s[60:63], s27 offen  lds
  s_add_u32 s27, s27, 16384
  s_add_u32 m0, s25, 21504
  s_nop 0
  buffer_load_dwordx4 v19, s[60:63], s27 offen  lds
  s_add_u32 s27, s27, 16384
  s_add_u32 m0, s25, 22528
  s_nop 0
  buffer_load_dwordx4 v18, s[60:63], s27 offen  lds
  s_add_u32 s27, s27, 16384
  s_add_u32 m0, s25, 23552
  s_nop 0
  buffer_load_dwordx4 v19, s[60:63], s27 offen  lds
  s_add_u32 s27, s27, 16384
  s_add_u32 m0, s25, 24576
  s_nop 0
  buffer_load_dwordx4 v20, s[60:63], s27 offen  lds
  s_add_u32 s27, s27, 16384
  s_add_u32 m0, s25, 25600
  s_nop 0
  buffer_load_dwordx4 v21, s[60:63], s27 offen  lds
  s_add_u32 s27, s27, 16384
  s_add_u32 m0, s25, 26624
  s_nop 0
  buffer_load_dwordx4 v20, s[60:63], s27 offen  lds
  s_add_u32 s27, s27, 16384
  s_add_u32 m0, s25, 27648
  s_nop 0
  buffer_load_dwordx4 v21, s[60:63], s27 offen  lds
  s_add_u32 s27, s27, 16384
  s_add_u32 m0, s25, 28672
  s_nop 0
  buffer_load_dwordx4 v22, s[60:63], s27 offen  lds
  s_add_u32 s27, s27, 16384
  s_add_u32 m0, s25, 29696
  s_nop 0
  buffer_load_dwordx4 v23, s[60:63], s27 offen  lds
  s_add_u32 s27, s27, 16384
  s_add_u32 m0, s25, 30720
  s_nop 0
  buffer_load_dwordx4 v22, s[60:63], s27 offen  lds
  s_add_u32 s27, s27, 16384
  s_add_u32 m0, s25, 31744
  s_nop 0
  buffer_load_dwordx4 v23, s[60:63], s27 offen  lds
  s_add_u32 s27, s27, 16384
  s_branch wp_A
wp_B2:
  v_lshlrev_b32 v6, 7, v1
  s_getpc_b64 s[98:99]
ct_6:
  s_add_u32 s98, s98, wp_fin-ct_6
  s_addc_u32 s99, s99, 0
  global_load_dword v7, v6, s[98:99]
  s_getpc_b64 s[98:99]
ct_7:
  s_add_u32 s98, s98, wg_vo-ct_7
  s_addc_u32 s99, s99, 0
  global_load_dword v7, v6, s[98:99]
  s_waitcnt vmcnt(2)
  s_barrier
  s_cmp_lg_u32 s16, 0
  s_cbranch_scc1 wp_f2_f
  v_readfirstlane_b32 s20, v254
  s_cmp_eq_u32 s20, 1
  s_cbranch_scc1 wp_f2_w_ok
  s_mov_b32 s30, 0
wp_f2_w:
  buffer_load_dword v254, off, s[12:15], 0 offset:128 sc1
  s_waitcnt vmcnt(0)
  v_cmp_ne_u32 vcc, 1, v254
  s_cbranch_vccz wp_f2_w_ok
  s_sleep 8
  s_add_u32 s30, s30, 1
  s_cmp_lt_u32 s30, 16
  s_cbranch_scc1 wp_f2_w
  s_branch wp_f2_f
wp_f2_w_ok:
  s_lshl_b32 s20, s17, 7
  s_add_u32 s20, s20, 88519168
  s_lshl_b32 s21, 1, s19
  v_mov_b32 v248, s21
  s_mov_b64 exec, 1
  buffer_atomic_or v248, v252, s[8:11], s20 offen sc0
  s_mov_b64 exec, -1
  s_mov_b32 s37, s21
wp_f2_f:
  s_cmp_eq_u32 s97, 0
  s_cselect_b32 s39, -4, s39
  s_branch wp_fin
wp_A0:
  s_mov_b32 s60, s40
  s_and_b32 s61, s41, 0xffff
  s_mov_b32 s62, 3670016
  s_mov_b32 s63, 0x20000
  s_mov_b32 s56, s42
  s_and_b32 s57, s43, 0xffff
  s_mov_b32 s58, 3670016
  s_mov_b32 s59, 0x20000
  s_lshl_b32 s27, s18, 2
  s_add_u32 s27, s27, s16
  s_lshl_b32 s27, s27, 17
  s_add_u32 s27, s27, s26
  s_lshl_b32 s30, s16, 13
  s_add_u32 m0, s30, 0
  s_nop 0
  buffer_load_dwordx4 v26, s[56:59], s27 offen  lds
  s_add_u32 s27, s27, 16384
  s_add_u32 m0, s30, 1024
  s_nop 0
  buffer_load_dwordx4 v26, s[56:59], s27 offen  lds
  s_add_u32 s27, s27, 16384
  s_add_u32 m0, s30, 2048
  s_nop 0
  buffer_load_dwordx4 v27, s[56:59], s27 offen  lds
  s_add_u32 s27, s27, 16384
  s_add_u32 m0, s30, 3072
  s_nop 0
  buffer_load_dwordx4 v27, s[56:59], s27 offen  lds
  s_add_u32 s27, s27, 16384
  s_add_u32 m0, s30, 4096
  s_nop 0
  buffer_load_dwordx4 v26, s[56:59], s27 offen  lds
  s_add_u32 s27, s27, 16384
  s_add_u32 m0, s30, 5120
  s_nop 0
  buffer_load_dwordx4 v26, s[56:59], s27 offen  lds
  s_add_u32 s27, s27, 16384
  s_add_u32 m0, s30, 6144
  s_nop 0
  buffer_load_dwordx4 v27, s[56:59], s27 offen  lds
  s_add_u32 s27, s27, 16384
  s_add_u32 m0, s30, 7168
  s_nop 0
  buffer_load_dwordx4 v27, s[56:59], s27 offen  lds
  s_add_u32 s27, s27, 16384
  s_add_u32 s27, s28, 0
  s_min_u32 s27, s27, 13
  s_lshl_b32 s27, s27, 18
  s_add_u32 s27, s27, s26
  s_add_u32 m0, s25, 0
  s_nop 0
  buffer_load_dwordx4 v16, s[60:63], s27 offen  lds
  s_add_u32 s27, s27, 16384
  s_add_u32 m0, s25, 1024
  s_nop 0
  buffer_load_dwordx4 v17, s[60:63], s27 offen  lds
  s_add_u32 s27, s27, 16384
  s_add_u32 m0, s25, 2048
  s_nop 0
  buffer_load_dwordx4 v16, s[60:63], s27 offen  lds
  s_add_u32 s27, s27, 16384
  s_add_u32 m0, s25, 3072
  s_nop 0
  buffer_load_dwordx4 v17, s[60:63], s27 offen  lds
  s_add_u32 s27, s27, 16384
  s_add_u32 m0, s25, 4096
  s_nop 0
  buffer_load_dwordx4 v18, s[60:63], s27 offen  lds
  s_add_u32 s27, s27, 16384
  s_add_u32 m0, s25, 5120
  s_nop 0
  buffer_load_dwordx4 v19, s[60:63], s27 offen  lds
  s_add_u32 s27, s27, 16384
  s_add_u32 m0, s25, 6144
  s_nop 0
  buffer_load_dwordx4 v18, s[60:63], s27 offen  lds
  s_add_u32 s27, s27, 16384
  s_add_u32 m0, s25, 7168
  s_nop 0
  buffer_load_dwordx4 v19, s[60:63], s27 offen  lds
  s_add_u32 s27, s27, 16384
  s_add_u32 m0, s25, 8192
  s_nop 0
  buffer_load_dwordx4 v20, s[60:63], s27 offen  lds
  s_add_u32 s27, s27, 16384
  s_add_u32 m0, s25, 9216
  s_nop 0
  buffer_load_dwordx4 v21, s[60:63], s27 offen  lds
  s_add_u32 s27, s27, 16384
  s_add_u32 m0, s25, 10240
  s_nop 0
  buffer_load_dwordx4 v20, s[60:63], s27 offen  lds
  s_add_u32 s27, s27, 16384
  s_add_u32 m0, s25, 11264
  s_nop 0
  buffer_load_dwordx4 v21, s[60:63], s27 offen  lds
  s_add_u32 s27, s27, 16384
  s_add_u32 m0, s25, 12288
  s_nop 0
  buffer_load_dwordx4 v22, s[60:63], s27 offen  lds
  s_add_u32 s27, s27, 16384
  s_add_u32 m0, s25, 13312
  s_nop 0
  buffer_load_dwordx4 v23, s[60:63], s27 offen  lds
  s_add_u32 s27, s27, 16384
  s_add_u32 m0, s25, 14336
  s_nop 0
  buffer_load_dwordx4 v22, s[60:63], s27 offen  lds
  s_add_u32 s27, s27, 16384
  s_add_u32 m0, s25, 15360
  s_nop 0
  buffer_load_dwordx4 v23, s[60:63], s27 offen  lds
  s_add_u32 s27, s27, 16384
  s_add_u32 s27, s28, 4
  s_min_u32 s27, s27, 13
  s_lshl_b32 s27, s27, 18
  s_add_u32 s27, s27, s26
  s_add_u32 m0, s25, 16384
  s_nop 0
  buffer_load_dwordx4 v16, s[60:63], s27 offen  lds
  s_add_u32 s27, s27, 16384
  s_add_u32 m0, s25, 17408
  s_nop 0
  buffer_load_dwordx4 v17, s[60:63], s27 offen  lds
  s_add_u32 s27, s27, 16384
  s_add_u32 m0, s25, 18432
  s_nop 0
  buffer_load_dwordx4 v16, s[60:63], s27 offen  lds
  s_add_u32 s27, s27, 16384
  s_add_u32 m0, s25, 19456
  s_nop 0
  buffer_load_dwordx4 v17, s[60:63], s27 offen  lds
  s_add_u32 s27, s27, 16384
  s_add_u32 m0, s25, 20480
  s_nop 0
  buffer_load_dwordx4 v18, s[60:63], s27 offen  lds
  s_add_u32 s27, s27, 16384
  s_add_u32 m0, s25, 21504
  s_nop 0
  buffer_load_dwordx4 v19, s[60:63], s27 offen  lds
  s_add_u32 s27, s27, 16384
  s_add_u32 m0, s25, 22528
  s_nop 0
  buffer_load_dwordx4 v18, s[60:63], s27 offen  lds
  s_add_u32 s27, s27, 16384
  s_add_u32 m0, s25, 23552
  s_nop 0
  buffer_load_dwordx4 v19, s[60:63], s27 offen  lds
  s_add_u32 s27, s27, 16384
  s_add_u32 m0, s25, 24576
  s_nop 0
  buffer_load_dwordx4 v20, s[60:63], s27 offen  lds
  s_add_u32 s27, s27, 16384
  s_add_u32 m0, s25, 25600
  s_nop 0
  buffer_load_dwordx4 v21, s[60:63], s27 offen  lds
  s_add_u32 s27, s27, 16384
  s_add_u32 m0, s25, 26624
  s_nop 0
  buffer_load_dwordx4 v20, s[60:63], s27 offen  lds
  s_add_u32 s27, s27, 16384
  s_add_u32 m0, s25, 27648
  s_nop 0
  buffer_load_dwordx4 v21, s[60:63], s27 offen  lds
  s_add_u32 s27, s27, 16384
  s_add_u32 m0, s25, 28672
  s_nop 0
  buffer_load_dwordx4 v22, s[60:63], s27 offen  lds
  s_add_u32 s27, s27, 16384
  s_add_u32 m0, s25, 29696
  s_nop 0
  buffer_load_dwordx4 v23, s[60:63], s27 offen  lds
  s_add_u32 s27, s27, 16384
  s_add_u32 m0, s25, 30720
  s_nop 0
  buffer_load_dwordx4 v22, s[60:63], s27 offen  lds
  s_add_u32 s27, s27, 16384
  s_add_u32 m0, s25, 31744
  s_nop 0
  buffer_load_dwordx4 v23, s[60:63], s27 offen  lds
  s_add_u32 s27, s27, 16384
  v_lshrrev_b32 v7, 2, v4
  v_lshlrev_b32 v11, 4, v7
  v_lshlrev_b32 v7, 3, v7
  v_and_b32 v8, 3, v4
  v_add_u32 v7, v7, v8
  v_and_b32 v8, 2, v4
  v_lshl_add_u32 v11, v8, 1, v11
  v_and_b32 v8, 1, v4
  v_add_u32 v11, v11, v8
  v_or_b32 v10, 0, v3
  v_xor_b32 v10, v10, v4
  v_lshlrev_b32 v10, 4, v10
  v_lshl_add_u32 v44, v11, 9, v10
  v_lshl_add_u32 v10, v7, 9, v10
  v_add_u32 v32, s25, v10
  v_or_b32 v10, 4, v3
  v_xor_b32 v10, v10, v4
  v_lshlrev_b32 v10, 4, v10
  v_lshl_add_u32 v45, v11, 9, v10
  v_lshl_add_u32 v10, v7, 9, v10
  v_add_u32 v33, s25, v10
  v_or_b32 v10, 8, v3
  v_xor_b32 v10, v10, v4
  v_lshlrev_b32 v10, 4, v10
  v_lshl_add_u32 v46, v11, 9, v10
  v_lshl_add_u32 v10, v7, 9, v10
  v_add_u32 v34, s25, v10
  v_or_b32 v10, 12, v3
  v_xor_b32 v10, v10, v4
  v_lshlrev_b32 v10, 4, v10
  v_lshl_add_u32 v47, v11, 9, v10
  v_lshl_add_u32 v10, v7, 9, v10
  v_add_u32 v35, s25, v10
  s_mul_i32 s30, s17, 401408
  s_mul_i32 s31, s18, 57344
  s_add_u32 s30, s30, s31
  s_add_u32 s30, s30, 0
  v_add_u32 v28, s30, v2
  s_add_u32 s30, s30, 14336
  v_add_u32 v29, s30, v2
  s_add_u32 s30, s30, 14336
  v_add_u32 v30, s30, v2
  s_add_u32 s30, s30, 14336
  v_add_u32 v31, s30, v2
  s_add_u32 s30, s30, 14336
  v_mov_b32 v48, 1035512379
wp_A:
  s_lshl_b32 s29, s28, 10
  s_add_u32 s31, s29, 4096
  s_cmp_lt_u32 s28, 10
  s_cselect_b32 s31, s31, 0x40000000
  s_waitcnt vmcnt(0)
  s_barrier
  ds_read_b128 a[0:3], v44 offset:0
  ds_read_b128 a[32:35], v44 offset:1024
  ds_read_b128 a[64:67], v44 offset:4096
  ds_read_b128 a[96:99], v44 offset:5120
  ds_read_b128 a[128:131], v32 offset:0
  ds_read_b128 a[160:163], v32 offset:2048
  ds_read_b128 a[192:195], v32 offset:16384
  ds_read_b128 a[224:227], v32 offset:18432
  s_waitcnt lgkmcnt(0)
  v_mfma_f32_16x16x32_bf16 v[64:67], a[128:131], a[0:3], 0
  ds_read_b128 a[4:7], v45 offset:0
  ds_read_b128 a[36:39], v45 offset:1024
  v_mfma_f32_16x16x32_bf16 v[68:71], a[160:163], a[0:3], 0
  ds_read_b128 a[68:71], v45 offset:4096
  ds_read_b128 a[100:103], v45 offset:5120
  v_mfma_f32_16x16x32_bf16 v[72:75], a[128:131], a[32:35], 0
  ds_read_b128 a[132:135], v33 offset:0
  ds_read_b128 a[164:167], v33 offset:2048
  v_mfma_f32_16x16x32_bf16 v[76:79], a[160:163], a[32:35], 0
  ds_read_b128 a[196:199], v33 offset:16384
  ds_read_b128 a[228:231], v33 offset:18432
  v_mfma_f32_16x16x32_bf16 v[80:83], a[128:131], a[64:67], 0
  v_mfma_f32_16x16x32_bf16 v[84:87], a[160:163], a[64:67], 0
  v_mfma_f32_16x16x32_bf16 v[88:91], a[128:131], a[96:99], 0
  v_mfma_f32_16x16x32_bf16 v[92:95], a[160:163], a[96:99], 0
  v_mfma_f32_16x16x32_bf16 v[96:99], a[192:195], a[0:3], 0
  v_mfma_f32_16x16x32_bf16 v[100:103], a[224:227], a[0:3], 0
  v_mfma_f32_16x16x32_bf16 v[104:107], a[192:195], a[32:35], 0
  v_mfma_f32_16x16x32_bf16 v[108:111], a[224:227], a[32:35], 0
  v_mfma_f32_16x16x32_bf16 v[112:115], a[192:195], a[64:67], 0
  v_mfma_f32_16x16x32_bf16 v[116:119], a[224:227], a[64:67], 0
  v_mfma_f32_16x16x32_bf16 v[120:123], a[192:195], a[96:99], 0
  v_mfma_f32_16x16x32_bf16 v[124:127], a[224:227], a[96:99], 0
  s_waitcnt lgkmcnt(0)
  v_mfma_f32_16x16x32_bf16 v[64:67], a[132:135], a[4:7], v[64:67]
  ds_read_b128 a[8:11], v46 offset:0
  ds_read_b128 a[40:43], v46 offset:1024
  v_mfma_f32_16x16x32_bf16 v[68:71], a[164:167], a[4:7], v[68:71]
  ds_read_b128 a[72:75], v46 offset:4096
  ds_read_b128 a[104:107], v46 offset:5120
  v_mfma_f32_16x16x32_bf16 v[72:75], a[132:135], a[36:39], v[72:75]
  ds_read_b128 a[136:139], v34 offset:0
  ds_read_b128 a[168:171], v34 offset:2048
  v_mfma_f32_16x16x32_bf16 v[76:79], a[164:167], a[36:39], v[76:79]
  ds_read_b128 a[200:203], v34 offset:16384
  ds_read_b128 a[232:235], v34 offset:18432
  v_mfma_f32_16x16x32_bf16 v[80:83], a[132:135], a[68:71], v[80:83]
  v_mfma_f32_16x16x32_bf16 v[84:87], a[164:167], a[68:71], v[84:87]
  v_mfma_f32_16x16x32_bf16 v[88:91], a[132:135], a[100:103], v[88:91]
  v_mfma_f32_16x16x32_bf16 v[92:95], a[164:167], a[100:103], v[92:95]
  v_mfma_f32_16x16x32_bf16 v[96:99], a[196:199], a[4:7], v[96:99]
  v_mfma_f32_16x16x32_bf16 v[100:103], a[228:231], a[4:7], v[100:103]
  v_mfma_f32_16x16x32_bf16 v[104:107], a[196:199], a[36:39], v[104:107]
  v_mfma_f32_16x16x32_bf16 v[108:111], a[228:231], a[36:39], v[108:111]
  v_mfma_f32_16x16x32_bf16 v[112:115], a[196:199], a[68:71], v[112:115]
  v_mfma_f32_16x16x32_bf16 v[116:119], a[228:231], a[68:71], v[116:119]
  v_mfma_f32_16x16x32_bf16 v[120:123], a[196:199], a[100:103], v[120:123]
  v_mfma_f32_16x16x32_bf16 v[124:127], a[228:231], a[100:103], v[124:127]
  s_waitcnt lgkmcnt(0)
  v_mfma_f32_16x16x32_bf16 v[64:67], a[136:139], a[8:11], v[64:67]
  ds_read_b128 a[12:15], v47 offset:0
  ds_read_b128 a[44:47], v47 offset:1024
  v_mfma_f32_16x16x32_bf16 v[68:71], a[168:171], a[8:11], v[68:71]
  ds_read_b128 a[76:79], v47 offset:4096
  ds_read_b128 a[108:111], v47 offset:5120
  v_mfma_f32_16x16x32_bf16 v[72:75], a[136:139], a[40:43], v[72:75]
  ds_read_b128 a[140:143], v35 offset:0
  ds_read_b128 a[172:175], v35 offset:2048
  v_mfma_f32_16x16x32_bf16 v[76:79], a[168:171], a[40:43], v[76:79]
  ds_read_b128 a[204:207], v35 offset:16384
  ds_read_b128 a[236:239], v35 offset:18432
  v_mfma_f32_16x16x32_bf16 v[80:83], a[136:139], a[72:75], v[80:83]
  v_mfma_f32_16x16x32_bf16 v[84:87], a[168:171], a[72:75], v[84:87]
  v_mfma_f32_16x16x32_bf16 v[88:91], a[136:139], a[104:107], v[88:91]
  v_mfma_f32_16x16x32_bf16 v[92:95], a[168:171], a[104:107], v[92:95]
  v_mfma_f32_16x16x32_bf16 v[96:99], a[200:203], a[8:11], v[96:99]
  v_mfma_f32_16x16x32_bf16 v[100:103], a[232:235], a[8:11], v[100:103]
  v_mfma_f32_16x16x32_bf16 v[104:107], a[200:203], a[40:43], v[104:107]
  v_mfma_f32_16x16x32_bf16 v[108:111], a[232:235], a[40:43], v[108:111]
  v_mfma_f32_16x16x32_bf16 v[112:115], a[200:203], a[72:75], v[112:115]
  v_mfma_f32_16x16x32_bf16 v[116:119], a[232:235], a[72:75], v[116:119]
  v_mfma_f32_16x16x32_bf16 v[120:123], a[200:203], a[104:107], v[120:123]
  v_mfma_f32_16x16x32_bf16 v[124:127], a[232:235], a[104:107], v[124:127]
  s_waitcnt lgkmcnt(0)
  v_mfma_f32_16x16x32_bf16 v[64:67], a[140:143], a[12:15], v[64:67]
  ds_read_b128 a[16:19], v44 offset:256
  ds_read_b128 a[48:51], v44 offset:1280
  v_mfma_f32_16x16x32_bf16 v[68:71], a[172:175], a[12:15], v[68:71]
  ds_read_b128 a[80:83], v44 offset:4352
  ds_read_b128 a[112:115], v44 offset:5376
  v_mfma_f32_16x16x32_bf16 v[72:75], a[140:143], a[44:47], v[72:75]
  ds_read_b128 a[144:147], v32 offset:256
  ds_read_b128 a[176:179], v32 offset:2304
  v_mfma_f32_16x16x32_bf16 v[76:79], a[172:175], a[44:47], v[76:79]
  ds_read_b128 a[208:211], v32 offset:16640
  ds_read_b128 a[240:243], v32 offset:18688
  v_mfma_f32_16x16x32_bf16 v[80:83], a[140:143], a[76:79], v[80:83]
  v_mfma_f32_16x16x32_bf16 v[84:87], a[172:175], a[76:79], v[84:87]
  v_mfma_f32_16x16x32_bf16 v[88:91], a[140:143], a[108:111], v[88:91]
  v_mfma_f32_16x16x32_bf16 v[92:95], a[172:175], a[108:111], v[92:95]
  v_mfma_f32_16x16x32_bf16 v[96:99], a[204:207], a[12:15], v[96:99]
  v_mfma_f32_16x16x32_bf16 v[100:103], a[236:239], a[12:15], v[100:103]
  v_mfma_f32_16x16x32_bf16 v[104:107], a[204:207], a[44:47], v[104:107]
  v_mfma_f32_16x16x32_bf16 v[108:111], a[236:239], a[44:47], v[108:111]
  v_mfma_f32_16x16x32_bf16 v[112:115], a[204:207], a[76:79], v[112:115]
  v_mfma_f32_16x16x32_bf16 v[116:119], a[236:239], a[76:79], v[116:119]
  v_mfma_f32_16x16x32_bf16 v[120:123], a[204:207], a[108:111], v[120:123]
  v_mfma_f32_16x16x32_bf16 v[124:127], a[236:239], a[108:111], v[124:127]
  s_waitcnt lgkmcnt(0)
  v_mfma_f32_16x16x32_bf16 v[64:67], a[144:147], a[16:19], v[64:67]
  ds_read_b128 a[20:23], v45 offset:256
  ds_read_b128 a[52:55], v45 offset:1280
  v_mfma_f32_16x16x32_bf16 v[68:71], a[176:179], a[16:19], v[68:71]
  ds_read_b128 a[84:87], v45 offset:4352
  ds_read_b128 a[116:119], v45 offset:5376
  v_mfma_f32_16x16x32_bf16 v[72:75], a[144:147], a[48:51], v[72:75]
  ds_read_b128 a[148:151], v33 offset:256
  ds_read_b128 a[180:183], v33 offset:2304
  v_mfma_f32_16x16x32_bf16 v[76:79], a[176:179], a[48:51], v[76:79]
  ds_read_b128 a[212:215], v33 offset:16640
  ds_read_b128 a[244:247], v33 offset:18688
  v_mfma_f32_16x16x32_bf16 v[80:83], a[144:147], a[80:83], v[80:83]
  v_mfma_f32_16x16x32_bf16 v[84:87], a[176:179], a[80:83], v[84:87]
  v_mfma_f32_16x16x32_bf16 v[88:91], a[144:147], a[112:115], v[88:91]
  v_mfma_f32_16x16x32_bf16 v[92:95], a[176:179], a[112:115], v[92:95]
  v_mfma_f32_16x16x32_bf16 v[96:99], a[208:211], a[16:19], v[96:99]
  v_mfma_f32_16x16x32_bf16 v[100:103], a[240:243], a[16:19], v[100:103]
  v_mfma_f32_16x16x32_bf16 v[104:107], a[208:211], a[48:51], v[104:107]
  v_mfma_f32_16x16x32_bf16 v[108:111], a[240:243], a[48:51], v[108:111]
  v_mfma_f32_16x16x32_bf16 v[112:115], a[208:211], a[80:83], v[112:115]
  v_mfma_f32_16x16x32_bf16 v[116:119], a[240:243], a[80:83], v[116:119]
  v_mfma_f32_16x16x32_bf16 v[120:123], a[208:211], a[112:115], v[120:123]
  v_mfma_f32_16x16x32_bf16 v[124:127], a[240:243], a[112:115], v[124:127]
  s_waitcnt lgkmcnt(0)
  v_mfma_f32_16x16x32_bf16 v[64:67], a[148:151], a[20:23], v[64:67]
  ds_read_b128 a[24:27], v46 offset:256
  ds_read_b128 a[56:59], v46 offset:1280
  v_mfma_f32_16x16x32_bf16 v[68:71], a[180:183], a[20:23], v[68:71]
  ds_read_b128 a[88:91], v46 offset:4352
  ds_read_b128 a[120:123], v46 offset:5376
  v_mfma_f32_16x16x32_bf16 v[72:75], a[148:151], a[52:55], v[72:75]
  ds_read_b128 a[152:155], v34 offset:256
  ds_read_b128 a[184:187], v34 offset:2304
  v_mfma_f32_16x16x32_bf16 v[76:79], a[180:183], a[52:55], v[76:79]
  ds_read_b128 a[216:219], v34 offset:16640
  ds_read_b128 a[248:251], v34 offset:18688
  v_mfma_f32_16x16x32_bf16 v[80:83], a[148:151], a[84:87], v[80:83]
  v_mfma_f32_16x16x32_bf16 v[84:87], a[180:183], a[84:87], v[84:87]
  v_mfma_f32_16x16x32_bf16 v[88:91], a[148:151], a[116:119], v[88:91]
  v_mfma_f32_16x16x32_bf16 v[92:95], a[180:183], a[116:119], v[92:95]
  v_mfma_f32_16x16x32_bf16 v[96:99], a[212:215], a[20:23], v[96:99]
  v_mfma_f32_16x16x32_bf16 v[100:103], a[244:247], a[20:23], v[100:103]
  v_mfma_f32_16x16x32_bf16 v[104:107], a[212:215], a[52:55], v[104:107]
  v_mfma_f32_16x16x32_bf16 v[108:111], a[244:247], a[52:55], v[108:111]
  v_mfma_f32_16x16x32_bf16 v[112:115], a[212:215], a[84:87], v[112:115]
  v_mfma_f32_16x16x32_bf16 v[116:119], a[244:247], a[84:87], v[116:119]
  v_mfma_f32_16x16x32_bf16 v[120:123], a[212:215], a[116:119], v[120:123]
  v_mfma_f32_16x16x32_bf16 v[124:127], a[244:247], a[116:119], v[124:127]
  s_waitcnt lgkmcnt(0)
  v_mfma_f32_16x16x32_bf16 v[64:67], a[152:155], a[24:27], v[64:67]
  ds_read_b128 a[28:31], v47 offset:256
  ds_read_b128 a[60:63], v47 offset:1280
  v_mfma_f32_16x16x32_bf16 v[68:71], a[184:187], a[24:27], v[68:71]
  ds_read_b128 a[92:95], v47 offset:4352
  ds_read_b128 a[124:127], v47 offset:5376
  v_mfma_f32_16x16x32_bf16 v[72:75], a[152:155], a[56:59], v[72:75]
  ds_read_b128 a[156:159], v35 offset:256
  ds_read_b128 a[188:191], v35 offset:2304
  v_mfma_f32_16x16x32_bf16 v[76:79], a[184:187], a[56:59], v[76:79]
  ds_read_b128 a[220:223], v35 offset:16640
  ds_read_b128 a[252:255], v35 offset:18688
  v_mfma_f32_16x16x32_bf16 v[80:83], a[152:155], a[88:91], v[80:83]
  v_mfma_f32_16x16x32_bf16 v[84:87], a[184:187], a[88:91], v[84:87]
  v_mfma_f32_16x16x32_bf16 v[88:91], a[152:155], a[120:123], v[88:91]
  v_mfma_f32_16x16x32_bf16 v[92:95], a[184:187], a[120:123], v[92:95]
  v_mfma_f32_16x16x32_bf16 v[96:99], a[216:219], a[24:27], v[96:99]
  v_mfma_f32_16x16x32_bf16 v[100:103], a[248:251], a[24:27], v[100:103]
  v_mfma_f32_16x16x32_bf16 v[104:107], a[216:219], a[56:59], v[104:107]
  v_mfma_f32_16x16x32_bf16 v[108:111], a[248:251], a[56:59], v[108:111]
  v_mfma_f32_16x16x32_bf16 v[112:115], a[216:219], a[88:91], v[112:115]
  v_mfma_f32_16x16x32_bf16 v[116:119], a[248:251], a[88:91], v[116:119]
  v_mfma_f32_16x16x32_bf16 v[120:123], a[216:219], a[120:123], v[120:123]
  v_mfma_f32_16x16x32_bf16 v[124:127], a[248:251], a[120:123], v[124:127]
  s_waitcnt lgkmcnt(0)
  s_barrier
  buffer_load_dwordx2 v[254:255], v252, s[12:15], 0 offen offset:128 sc1
  buffer_load_dword v253, v252, s[12:15], 0 offen sc1
  v_mfma_f32_16x16x32_bf16 v[64:67], a[156:159], a[28:31], v[64:67]
  v_mfma_f32_16x16x32_bf16 v[68:71], a[188:191], a[28:31], v[68:71]
  v_mfma_f32_16x16x32_bf16 v[72:75], a[156:159], a[60:63], v[72:75]
  v_mfma_f32_16x16x32_bf16 v[76:79], a[188:191], a[60:63], v[76:79]
  v_mfma_f32_16x16x32_bf16 v[80:83], a[156:159], a[92:95], v[80:83]
  v_pk_mul_f32 v[64:65], v[64:65], v[48:49] op_sel_hi:[1,0]
  v_pk_mul_f32 v[66:67], v[66:67], v[48:49] op_sel_hi:[1,0]
  v_mfma_f32_16x16x32_bf16 v[84:87], a[188:191], a[92:95], v[84:87]
  v_pk_mul_f32 v[68:69], v[68:69], v[48:49] op_sel_hi:[1,0]
  v_pk_mul_f32 v[70:71], v[70:71], v[48:49] op_sel_hi:[1,0]
  v_mfma_f32_16x16x32_bf16 v[88:91], a[156:159], a[124:127], v[88:91]
  v_cvt_pk_bf16_f32 v64, v64, v65
  v_cvt_pk_bf16_f32 v65, v66, v67
  v_mfma_f32_16x16x32_bf16 v[92:95], a[188:191], a[124:127], v[92:95]
  v_cvt_pk_bf16_f32 v66, v68, v69
  v_cvt_pk_bf16_f32 v67, v70, v71
  v_mfma_f32_16x16x32_bf16 v[96:99], a[220:223], a[28:31], v[96:99]
  buffer_store_dwordx4 v[64:67], v28, s[8:11], s29 offen sc1
  v_pk_mul_f32 v[72:73], v[72:73], v[48:49] op_sel_hi:[1,0]
  v_mfma_f32_16x16x32_bf16 v[100:103], a[252:255], a[28:31], v[100:103]
  v_pk_mul_f32 v[74:75], v[74:75], v[48:49] op_sel_hi:[1,0]
  v_pk_mul_f32 v[76:77], v[76:77], v[48:49] op_sel_hi:[1,0]
  v_mfma_f32_16x16x32_bf16 v[104:107], a[220:223], a[60:63], v[104:107]
  v_pk_mul_f32 v[78:79], v[78:79], v[48:49] op_sel_hi:[1,0]
  v_cvt_pk_bf16_f32 v72, v72, v73
  v_mfma_f32_16x16x32_bf16 v[108:111], a[252:255], a[60:63], v[108:111]
  v_cvt_pk_bf16_f32 v73, v74, v75
  v_cvt_pk_bf16_f32 v74, v76, v77
  v_mfma_f32_16x16x32_bf16 v[112:115], a[220:223], a[92:95], v[112:115]
  v_cvt_pk_bf16_f32 v75, v78, v79
  buffer_store_dwordx4 v[72:75], v29, s[8:11], s29 offen sc1
  v_mfma_f32_16x16x32_bf16 v[116:119], a[252:255], a[92:95], v[116:119]
  v_pk_mul_f32 v[80:81], v[80:81], v[48:49] op_sel_hi:[1,0]
  v_pk_mul_f32 v[82:83], v[82:83], v[48:49] op_sel_hi:[1,0]
  v_mfma_f32_16x16x32_bf16 v[120:123], a[220:223], a[124:127], v[120:123]
  v_pk_mul_f32 v[84:85], v[84:85], v[48:49] op_sel_hi:[1,0]
  v_pk_mul_f32 v[86:87], v[86:87], v[48:49] op_sel_hi:[1,0]
  v_mfma_f32_16x16x32_bf16 v[124:127], a[252:255], a[124:127], v[124:127]
  v_cvt_pk_bf16_f32 v80, v80, v81
  v_cvt_pk_bf16_f32 v81, v82, v83
  v_cvt_pk_bf16_f32 v82, v84, v85
  v_cvt_pk_bf16_f32 v83, v86, v87
  buffer_store_dwordx4 v[80:83], v30, s[8:11], s29 offen sc1
  v_pk_mul_f32 v[88:89], v[88:89], v[48:49] op_sel_hi:[1,0]
  v_pk_mul_f32 v[90:91], v[90:91], v[48:49] op_sel_hi:[1,0]
  v_pk_mul_f32 v[92:93], v[92:93], v[48:49] op_sel_hi:[1,0]
  v_pk_mul_f32 v[94:95], v[94:95], v[48:49] op_sel_hi:[1,0]
  v_cvt_pk_bf16_f32 v88, v88, v89
  v_cvt_pk_bf16_f32 v89, v90, v91
  v_cvt_pk_bf16_f32 v90, v92, v93
  v_cvt_pk_bf16_f32 v91, v94, v95
  buffer_store_dwordx4 v[88:91], v31, s[8:11], s29 offen sc1
  v_pk_mul_f32 v[96:97], v[96:97], v[48:49] op_sel_hi:[1,0]
  v_pk_mul_f32 v[98:99], v[98:99], v[48:49] op_sel_hi:[1,0]
  v_pk_mul_f32 v[100:101], v[100:101], v[48:49] op_sel_hi:[1,0]
  v_pk_mul_f32 v[102:103], v[102:103], v[48:49] op_sel_hi:[1,0]
  v_cvt_pk_bf16_f32 v96, v96, v97
  v_cvt_pk_bf16_f32 v97, v98, v99
  v_cvt_pk_bf16_f32 v98, v100, v101
  v_cvt_pk_bf16_f32 v99, v102, v103
  buffer_store_dwordx4 v[96:99], v28, s[8:11], s31 offen sc1
  v_pk_mul_f32 v[104:105], v[104:105], v[48:49] op_sel_hi:[1,0]
  v_pk_mul_f32 v[106:107], v[106:107], v[48:49] op_sel_hi:[1,0]
  v_pk_mul_f32 v[108:109], v[108:109], v[48:49] op_sel_hi:[1,0]
  v_pk_mul_f32 v[110:111], v[110:111], v[48:49] op_sel_hi:[1,0]
  v_cvt_pk_bf16_f32 v104, v104, v105
  v_cvt_pk_bf16_f32 v105, v106, v107
  v_cvt_pk_bf16_f32 v106, v108, v109
  v_cvt_pk_bf16_f32 v107, v110, v111
  buffer_store_dwordx4 v[104:107], v29, s[8:11], s31 offen sc1
  v_pk_mul_f32 v[112:113], v[112:113], v[48:49] op_sel_hi:[1,0]
  v_pk_mul_f32 v[114:115], v[114:115], v[48:49] op_sel_hi:[1,0]
  v_pk_mul_f32 v[116:117], v[116:117], v[48:49] op_sel_hi:[1,0]
  v_pk_mul_f32 v[118:119], v[118:119], v[48:49] op_sel_hi:[1,0]
  v_cvt_pk_bf16_f32 v112, v112, v113
  v_cvt_pk_bf16_f32 v113, v114, v115
  v_cvt_pk_bf16_f32 v114, v116, v117
  v_cvt_pk_bf16_f32 v115, v118, v119
  buffer_store_dwordx4 v[112:115], v30, s[8:11], s31 offen sc1
  v_pk_mul_f32 v[120:121], v[120:121], v[48:49] op_sel_hi:[1,0]
  v_pk_mul_f32 v[122:123], v[122:123], v[48:49] op_sel_hi:[1,0]
  v_pk_mul_f32 v[124:125], v[124:125], v[48:49] op_sel_hi:[1,0]
  v_pk_mul_f32 v[126:127], v[126:127], v[48:49] op_sel_hi:[1,0]
  v_cvt_pk_bf16_f32 v120, v120, v121
  v_cvt_pk_bf16_f32 v121, v122, v123
  v_cvt_pk_bf16_f32 v122, v124, v125
  v_cvt_pk_bf16_f32 v123, v126, v127
  buffer_store_dwordx4 v[120:123], v31, s[8:11], s31 offen sc1
  s_waitcnt vmcnt(0)
  s_barrier
  s_cmp_lg_u32 s16, 0
  s_cbranch_scc1 wp_f3_f
  v_readfirstlane_b32 s20, v254
  s_cmp_eq_u32 s20, 1
  s_cbranch_scc1 wp_f3_w_ok
  s_mov_b32 s30, 0
wp_f3_w:
  buffer_load_dword v254, off, s[12:15], 0 offset:128 sc1
  s_waitcnt vmcnt(0)
  v_cmp_ne_u32 vcc, 1, v254
  s_cbranch_vccz wp_f3_w_ok
  s_sleep 8
  s_add_u32 s30, s30, 1
  s_cmp_lt_u32 s30, 16
  s_cbranch_scc1 wp_f3_w
  s_branch wp_f3_f
wp_f3_w_ok:
  s_lshl_b32 s20, s17, 7
  s_add_u32 s20, s20, 88521216
  s_lshl_b32 s21, 1, s19
  v_mov_b32 v248, s21
  s_mov_b64 exec, 1
  buffer_atomic_or v248, v252, s[8:11], s20 offen sc0
  s_mov_b64 exec, -1
  s_mov_b32 s38, s21
wp_f3_f:
  s_cmp_eq_u32 s97, 3
  s_cbranch_scc1 wk_adone
wp_fin:
  s_cmp_lg_u32 s97, 0
  s_cbranch_scc1 wp_all
  v_readfirstlane_b32 s20, v254
  v_readfirstlane_b32 s21, v253
  s_and_b32 s21, s21, 0xffe0
  s_cselect_b32 s96, s20, 0
  s_cmp_eq_u32 s96, 0
  s_cbranch_scc1 wp_all
  v_mov_b32 v250, 1
  s_mov_b32 s20, 88525312
  s_mov_b64 exec, 1
  buffer_atomic_add v250, v252, s[8:11], s20 offen sc0
  s_mov_b64 exec, -1
wp_all:
  v_mov_b32 v252, 0x40000000
  v_cmp_eq_u32 vcc, 0, v0
  s_nop 1
  v_cndmask_b32 v252, v252, v0, vcc
  s_mov_b32 s34, 0
  s_cmp_lg_u32 s16, 0
  s_cbranch_scc1 wp_w2
  s_getreg_b32 s24, hwreg(HW_REG_XCC_ID)
  s_sub_u32 s24, s24, 0
  s_and_b32 s24, s24, 7
  s_lshl_b32 s24, s24, 7
  s_add_u32 s24, s24, 88523264
  s_cmp_lg_u32 s96, 0
  s_cbranch_scc1 wp_v0
  s_waitcnt vmcnt(0)
wp_v0:
  s_cmp_eq_u32 s97, 0
  s_cbranch_scc1 wp_v1
  s_waitcnt vmcnt(0)
wp_v1:
  s_waitcnt vmcnt(1)
  v_readfirstlane_b32 s20, v248
  s_and_b32 s20, s20, 14448
  s_xor_b32 s20, s20, s38
  s_cmp_lg_u32 s20, 14448
  s_cselect_b32 s20, 0, s38
  s_mov_b32 s38, 0
  s_cmp_eq_u32 s20, 0
  s_cbranch_scc1 wp_g3
  s_lshl_b32 s21, 65536, s17
  v_mov_b32 v248, s21
  s_mov_b32 s20, 88523264
  v_lshlrev_b32 v247, 7, v0
  s_mov_b64 exec, 0xff
  buffer_atomic_or v248, v247, s[8:11], s20 offen
  s_mov_b64 exec, -1
wp_g3:
  v_readfirstlane_b32 s20, v248
  s_and_b32 s20, s20, 16383
  s_xor_b32 s20, s20, s37
  s_cmp_lg_u32 s20, 16383
  s_cselect_b32 s20, 0, s37
  s_mov_b32 s37, 0
  s_cmp_eq_u32 s20, 0
  s_cbranch_scc1 wp_g2
  s_lshl_b32 s21, 1, s17
  v_mov_b32 v248, s21
  s_mov_b32 s20, 88523264
  v_lshlrev_b32 v247, 7, v0
  s_mov_b64 exec, 0xff
  buffer_atomic_or v248, v247, s[8:11], s20 offen
  s_mov_b64 exec, -1
wp_g2:
  s_cmp_lg_u32 s96, 0
  s_cbranch_scc1 wp_v_ok
  s_mov_b32 s30, 0
wp_v:
  buffer_load_dwordx2 v[64:65], off, s[12:15], 0 sc1
  buffer_load_dword v66, off, s[12:15], 0 offset:128 sc1
  s_waitcnt vmcnt(0)
  v_and_b32 v68, 0xffe0, v64
  v_min_u32 v68, v68, v66
  v_cmp_ne_u32 vcc, 1, v68
  s_cbranch_vccz wp_v_ok
  s_sleep 16
  s_add_u32 s30, s30, 1
  s_cmp_lt_u32 s30, 30
  s_cbranch_scc1 wp_v
  s_branch wp_w1
wp_v_ok:
  v_mov_b32 v64, 32
  s_cmp_eq_u32 s97, 2
  s_cselect_b32 s31, 1, 60
  s_mov_b32 s30, 0
wp_w:
  buffer_load_dwordx2 v[66:67], off, s[8:11], s24 sc1
  s_waitcnt vmcnt(0)
  v_or_b32 v66, s39, v66
  v_add_u32 v66, v66, v67
  v_cmp_ne_u32 vcc, 0, v66
  s_cbranch_vccz wp_w_ok
  s_sleep 8
  s_add_u32 s30, s30, 1
  s_cmp_lt_u32 s30, s31
  s_cbranch_scc1 wp_w
  s_branch wp_w1
wp_w_ok:
  s_branch wp_w2
wp_w1:
  v_readfirstlane_b32 s20, v64
  v_readfirstlane_b32 s21, v65
  s_and_b32 s20, s20, 0xffff
  s_cmp_lt_u32 s20, 32
  s_cselect_b32 s34, 2, 1
  s_add_u32 s32, s32, 1
  s_cmp_lt_u32 s32, 4000
  s_cselect_b32 s34, s34, 3
wp_w2:
  v_mov_b32 v6, 160032
  v_mov_b32 v7, s34
  s_barrier
  s_cmp_lg_u32 s16, 0
  s_cbranch_scc1 uni_8
  ds_write_b32 v6, v7
  s_waitcnt lgkmcnt(0)
uni_8:
  s_barrier
  ds_read_b32 v7, v6
  s_waitcnt lgkmcnt(0)
  v_readfirstlane_b32 s34, v7
  s_cmp_lg_u32 s34, 0
  s_cbranch_scc1 wp_bad
  s_cmp_lg_u32 s39, -4
  s_cbranch_scc1 wp_done
  s_mov_b32 s101, 0
  s_lshl_b32 s20, s101, 4
  s_lshr_b32 s21, s2, 3
  s_add_u32 s21, s21, s16
  s_and_b32 s21, s21, 3
  s_lshl_b32 s21, s21, 2
  s_add_u32 s20, s20, s21
  s_mul_i32 s21, s20, 14336
  s_add_u32 s21, s21, 72024064
  s_add_u32 s22, s21, 0
  buffer_load_dwordx4 a[0:3], v2, s[8:11], s22 offen offset:0 sc1
  buffer_load_dwordx4 a[4:7], v2, s[8:11], s22 offen offset:1024 sc1
  buffer_load_dwordx4 a[8:11], v2, s[8:11], s22 offen offset:2048 sc1
  buffer_load_dwordx4 a[12:15], v2, s[8:11], s22 offen offset:3072 sc1
  s_add_u32 s22, s21, 4096
  buffer_load_dwordx4 a[16:19], v2, s[8:11], s22 offen offset:0 sc1
  buffer_load_dwordx4 a[20:23], v2, s[8:11], s22 offen offset:1024 sc1
  buffer_load_dwordx4 a[24:27], v2, s[8:11], s22 offen offset:2048 sc1
  buffer_load_dwordx4 a[28:31], v2, s[8:11], s22 offen offset:3072 sc1
  s_add_u32 s22, s21, 8192
  buffer_load_dwordx4 a[32:35], v2, s[8:11], s22 offen offset:0 sc1
  buffer_load_dwordx4 a[36:39], v2, s[8:11], s22 offen offset:1024 sc1
  buffer_load_dwordx4 a[40:43], v2, s[8:11], s22 offen offset:2048 sc1
  buffer_load_dwordx4 a[44:47], v2, s[8:11], s22 offen offset:3072 sc1
  s_add_u32 s22, s21, 12288
  buffer_load_dwordx4 a[48:51], v2, s[8:11], s22 offen offset:0 sc1
  buffer_load_dwordx4 a[52:55], v2, s[8:11], s22 offen offset:1024 sc1
  buffer_load_dwordx4 a[56:59], v2, s[8:11], s22 offen offset:2048 sc1
  buffer_load_dwordx4 a[60:63], v2, s[8:11], s22 offen offset:3072 sc1
  s_add_u32 s22, s21, 16384
  buffer_load_dwordx4 a[64:67], v2, s[8:11], s22 offen offset:0 sc1
  buffer_load_dwordx4 a[68:71], v2, s[8:11], s22 offen offset:1024 sc1
  buffer_load_dwordx4 a[72:75], v2, s[8:11], s22 offen offset:2048 sc1
  buffer_load_dwordx4 a[76:79], v2, s[8:11], s22 offen offset:3072 sc1
  s_add_u32 s22, s21, 20480
  buffer_load_dwordx4 a[80:83], v2, s[8:11], s22 offen offset:0 sc1
  buffer_load_dwordx4 a[84:87], v2, s[8:11], s22 offen offset:1024 sc1
  buffer_load_dwordx4 a[88:91], v2, s[8:11], s22 offen offset:2048 sc1
  buffer_load_dwordx4 a[92:95], v2, s[8:11], s22 offen offset:3072 sc1
  s_add_u32 s22, s21, 24576
  buffer_load_dwordx4 a[96:99], v2, s[8:11], s22 offen offset:0 sc1
  buffer_load_dwordx4 a[100:103], v2, s[8:11], s22 offen offset:1024 sc1
  buffer_load_dwordx4 a[104:107], v2, s[8:11], s22 offen offset:2048 sc1
  buffer_load_dwordx4 a[108:111], v2, s[8:11], s22 offen offset:3072 sc1
  s_add_u32 s22, s21, 28672
  buffer_load_dwordx4 a[112:115], v2, s[8:11], s22 offen offset:0 sc1
  buffer_load_dwordx4 a[116:119], v2, s[8:11], s22 offen offset:1024 sc1
  buffer_load_dwordx4 a[120:123], v2, s[8:11], s22 offen offset:2048 sc1
  buffer_load_dwordx4 a[124:127], v2, s[8:11], s22 offen offset:3072 sc1
  s_add_u32 s22, s21, 32768
  buffer_load_dwordx4 a[128:131], v2, s[8:11], s22 offen offset:0 sc1
  buffer_load_dwordx4 a[132:135], v2, s[8:11], s22 offen offset:1024 sc1
  buffer_load_dwordx4 a[136:139], v2, s[8:11], s22 offen offset:2048 sc1
  buffer_load_dwordx4 a[140:143], v2, s[8:11], s22 offen offset:3072 sc1
  s_add_u32 s22, s21, 36864
  buffer_load_dwordx4 a[144:147], v2, s[8:11], s22 offen offset:0 sc1
  buffer_load_dwordx4 a[148:151], v2, s[8:11], s22 offen offset:1024 sc1
  buffer_load_dwordx4 a[152:155], v2, s[8:11], s22 offen offset:2048 sc1
  buffer_load_dwordx4 a[156:159], v2, s[8:11], s22 offen offset:3072 sc1
  s_add_u32 s22, s21, 40960
  s_waitcnt vmcnt(40)
  buffer_load_dwordx4 a[160:163], v2, s[8:11], s22 offen offset:0 sc1
  buffer_load_dwordx4 a[164:167], v2, s[8:11], s22 offen offset:1024 sc1
  buffer_load_dwordx4 a[168:171], v2, s[8:11], s22 offen offset:2048 sc1
  buffer_load_dwordx4 a[172:175], v2, s[8:11], s22 offen offset:3072 sc1
  s_add_u32 s22, s21, 45056
  buffer_load_dwordx4 a[176:179], v2, s[8:11], s22 offen offset:0 sc1
  buffer_load_dwordx4 a[180:183], v2, s[8:11], s22 offen offset:1024 sc1
  buffer_load_dwordx4 a[184:187], v2, s[8:11], s22 offen offset:2048 sc1
  buffer_load_dwordx4 a[188:191], v2, s[8:11], s22 offen offset:3072 sc1
  s_add_u32 s22, s21, 49152
  buffer_load_dwordx4 a[192:195], v2, s[8:11], s22 offen offset:0 sc1
  buffer_load_dwordx4 a[196:199], v2, s[8:11], s22 offen offset:1024 sc1
  buffer_load_dwordx4 a[200:203], v2, s[8:11], s22 offen offset:2048 sc1
  buffer_load_dwordx4 a[204:207], v2, s[8:11], s22 offen offset:3072 sc1
  s_add_u32 s22, s21, 53248
  buffer_load_dwordx4 a[208:211], v2, s[8:11], s22 offen offset:0 sc1
  buffer_load_dwordx4 a[212:215], v2, s[8:11], s22 offen offset:1024 sc1
  buffer_load_dwordx4 a[216:219], v2, s[8:11], s22 offen offset:2048 sc1
  buffer_load_dwordx4 a[220:223], v2, s[8:11], s22 offen offset:3072 sc1
  s_mov_b32 s39, 0xffff0000
  s_branch wp_all
wp_bad:
  s_and_b32 s39, s39, 0xffff0000
  s_mov_b32 s97, 1
  s_cmp_eq_u32 s34, 1
  s_cbranch_scc1 wp_rep
  s_cmp_eq_u32 s34, 3
  s_cbranch_scc1 cA_abort
  s_load_dwordx8 s[40:47], s[0:1], 72
  s_load_dwordx4 s[48:51], s[0:1], 56
  s_waitcnt lgkmcnt(0)
  v_mov_b32 v4, 0x10001
  s_mov_b32 s18, 1
  s_branch ch_take
wp_rep:
  s_mov_b32 s101, -1
  s_load_dwordx8 s[40:47], s[0:1], 72
  s_load_dwordx4 s[48:51], s[0:1], 56
  s_waitcnt vmcnt(0) lgkmcnt(0)
  v_mov_b32 v4, 1
  v_mov_b32 v5, 20
  v_mov_b32 v6, 160000
  s_barrier
  s_cmp_lg_u32 s16, 0
  s_cbranch_scc1 wp_el1
  s_mov_b64 exec, 1
  buffer_atomic_add v4, v5, s[12:15], 0 offen sc0
  s_waitcnt vmcnt(0)
  ds_write_b32 v6, v4
  s_waitcnt lgkmcnt(0)
  s_mov_b64 exec, -1
wp_el1:
  s_barrier
  ds_read_b32 v4, v6
  s_waitcnt lgkmcnt(0)
  v_readfirstlane_b32 s33, v4
  v_and_b32 v1, 63, v0
  v_lshlrev_b32 v2, 4, v1
  v_lshrrev_b32 v3, 4, v1
  v_and_b32 v4, 15, v1
  v_lshrrev_b32 v5, 5, v1
  v_and_b32 v6, 31, v1
  v_xor_b32 v8, v6, v5
  v_lshlrev_b32 v8, 4, v8
  v_lshl_add_u32 v16, v5, 13, v8
  v_xor_b32 v17, 32, v16
  v_xor_b32 v18, 64, v16
  v_xor_b32 v19, 96, v16
  v_xor_b32 v20, 128, v16
  v_xor_b32 v21, 160, v16
  v_xor_b32 v22, 192, v16
  v_xor_b32 v23, 224, v16
  s_lshl_b32 s20, s16, 6
  v_xor_b32 v26, s20, v16
  v_xor_b32 v27, 32, v26
  s_and_b32 s33, s33, 511
  s_and_b32 s20, s33, 255
  s_cmp_ge_u32 s20, 224
  s_cselect_b32 s97, 1, 2
  s_cbranch_scc1 wp_all
  s_mul_i32 s17, s20, 4682
  s_lshr_b32 s17, s17, 16
  s_mul_i32 s23, s17, 14
  s_sub_u32 s19, s20, s23
  s_cmp_lt_u32 s19, 7
  s_cselect_b32 s18, 0, 7
  s_cselect_b32 s28, 0, 8
  s_sub_u32 s18, s19, s18
  s_add_u32 s28, s28, s16
  s_lshl_b32 s25, s16, 15
  s_add_u32 s25, s25, 32768
  s_lshl_b32 s26, s17, 9
  s_lshl_b32 s20, s17, 7
  s_lshr_b32 s21, s33, 8
  s_lshl_b32 s21, s21, 11
  s_add_u32 s20, s20, s21
  s_add_u32 s20, s20, 88519168
  buffer_load_dword v5, off, s[8:11], s20 sc1
  s_waitcnt vmcnt(0)
  v_readfirstlane_b32 s34, v5
  v_mov_b32 v6, 160032
  s_nop 0
  v_mov_b32 v7, s34
  s_barrier
  s_cmp_lg_u32 s16, 0
  s_cbranch_scc1 uni_9
  ds_write_b32 v6, v7
  s_waitcnt lgkmcnt(0)
uni_9:
  s_barrier
  ds_read_b32 v7, v6
  s_waitcnt lgkmcnt(0)
  v_readfirstlane_b32 s34, v7
  s_cmp_lt_u32 s33, 256
  s_cselect_b32 s20, 0, 1935
  s_or_b32 s34, s34, s20
  s_bitcmp1_b32 s34, s19
  s_cbranch_scc1 wp_rep
  s_barrier
  s_cmp_lt_u32 s33, 256
  s_cbranch_scc1 wp_B
  s_branch wp_A0
wp_done:
  s_mov_b32 s97, s39
  s_cmp_lg_u32 s96, 0
  s_cbranch_scc1 wk_next
  s_cmp_lg_u32 s16, 0
  s_cbranch_scc1 ask_10
  v_mov_b32 v250, 1
  v_mov_b32 v251, 88525312
  s_mov_b64 exec, 1
  buffer_atomic_add v250, v251, s[8:11], 0 offen sc0
  s_mov_b64 exec, -1
ask_10:
  s_branch wk_next
wk_loop:
  s_waitcnt vmcnt(0) lgkmcnt(0)
wk_ask:
  v_readfirstlane_b32 s22, v250
  s_cmp_ge_u32 s22, 1264
  s_cbranch_scc1 wk_next
  s_cmp_lg_u32 s16, 0
  s_cbranch_scc1 ask_11
  v_mov_b32 v250, 1
  v_mov_b32 v251, 88525312
  s_mov_b64 exec, 1
  buffer_atomic_add v250, v251, s[8:11], 0 offen sc0
  s_mov_b64 exec, -1
ask_11:
wk_next:
  v_mov_b32 v6, 160000
  s_waitcnt vmcnt(0)
  s_barrier
  s_cmp_lg_u32 s16, 0
  s_cbranch_scc1 wk_n1
  s_mov_b64 exec, 1
  ds_write_b32 v6, v250
  s_mov_b64 exec, -1
  s_waitcnt lgkmcnt(0)
wk_n1:
  s_barrier
  ds_read_b32 v4, v6
  s_waitcnt lgkmcnt(0)
  v_readfirstlane_b32 s3, v4
  s_cmp_ge_u32 s3, 1264
  s_cbranch_scc1 wk_done
  v_mov_b32 v250, 0
  v_mov_b32 v251, 88525312
  v_and_b32 v1, 63, v0
  v_lshlrev_b32 v2, 4, v1
  v_lshrrev_b32 v3, 4, v1
  v_and_b32 v4, 15, v1
  s_cmp_lt_u32 s3, 112
  s_cbranch_scc1 wk_n2
  s_cmp_eq_u32 s97, 0
  s_cbranch_scc1 wk_n2
  v_mov_b32 v250, s3
  s_mov_b32 s96, 1
  s_mov_b32 s97, 1
  s_mov_b32 s39, 0
  s_mov_b32 s37, 0
  s_mov_b32 s38, 0
  s_mov_b32 s32, 0
  s_branch wp_all
wk_n2:
  s_cmp_ge_u32 s3, 752
  s_cbranch_scc1 wk_tok
  s_cmp_ge_u32 s3, 640
  s_cbranch_scc1 wk_s4d
  s_cmp_ge_u32 s3, 448
  s_cbranch_scc1 wk_full
  s_cmp_ge_u32 s3, 320
  s_cbranch_scc1 wk_adef
  s_cmp_ge_u32 s3, 288
  s_cbranch_scc1 wk_srv
  s_and_b32 s17, s3, 15
  s_add_u32 s17, s17, 16
  s_cmp_ge_u32 s3, 224
  s_cbranch_scc1 wk_half
  s_cmp_ge_u32 s3, 112
  s_cselect_b32 s18, 1, 0
  s_cselect_b32 s20, 112, 0
  s_sub_u32 s34, s3, s20
  s_lshr_b32 s34, s34, 4
  s_lshl_b32 s34, s34, 1
  s_add_u32 s35, s34, 2
  s_branch wk_gemm
wk_adef:
  s_mov_b32 s101, -1
  s_load_dwordx8 s[40:47], s[0:1], 72
  s_sub_u32 s20, s3, 320
  s_lshr_b32 s33, s20, 2
  s_mul_i32 s33, s33, 7
  s_and_b32 s20, s20, 3
  s_add_u32 s33, s33, s20
  s_mov_b32 s97, 3
  v_mov_b32 v252, 0x40000000
  v_cmp_eq_u32 vcc, 0, v0
  s_nop 1
  v_cndmask_b32 v252, v252, v0, vcc
  v_lshrrev_b32 v5, 5, v1
  v_and_b32 v6, 31, v1
  v_xor_b32 v8, v6, v5
  v_lshlrev_b32 v8, 4, v8
  v_lshl_add_u32 v16, v5, 13, v8
  v_xor_b32 v17, 32, v16
  v_xor_b32 v18, 64, v16
  v_xor_b32 v19, 96, v16
  v_xor_b32 v20, 128, v16
  v_xor_b32 v21, 160, v16
  v_xor_b32 v22, 192, v16
  v_xor_b32 v23, 224, v16
  s_lshl_b32 s20, s16, 6
  v_xor_b32 v26, s20, v16
  v_xor_b32 v27, 32, v26
  s_mul_i32 s17, s33, 4682
  s_lshr_b32 s17, s17, 16
  s_mul_i32 s23, s17, 14
  s_sub_u32 s19, s33, s23
  s_cmp_lt_u32 s19, 7
  s_cselect_b32 s18, 0, 7
  s_cselect_b32 s28, 0, 8
  s_sub_u32 s18, s19, s18
  s_add_u32 s28, s28, s16
  s_lshl_b32 s25, s16, 15
  s_add_u32 s25, s25, 32768
  s_lshl_b32 s26, s17, 9
  s_waitcnt lgkmcnt(0)
  s_barrier
  s_branch wp_A0
wk_adone:
  s_mov_b32 s97, 0
  s_branch wk_loop
wk_half:
  s_sub_u32 s20, s3, 224
  s_lshr_b32 s18, s20, 5
  s_add_u32 s18, s18, 2
  s_bitcmp1_b32 s20, 4
  s_cselect_b32 s34, 7, 0
  s_add_u32 s35, s34, 7
  s_branch wk_gemm
wk_full:
  s_sub_u32 s20, s3, 384
  s_and_b32 s17, s20, 15
  s_lshr_b32 s18, s20, 4
  s_mov_b32 s34, 0
  s_mov_b32 s35, 14
  s_cmp_lt_u32 s18, 8
  s_cselect_b32 s21, 16, 0
  s_add_u32 s17, s17, s21
  s_and_b32 s18, s18, 7
  s_cmp_ge_u32 s17, 16
  s_cbranch_scc1 wk_gemm
  s_lshl_b32 s27, s17, 7
  s_add_u32 s27, s27, 88521216
  s_mov_b32 s28, 16383
  s_mov_b32 s30, 0
wk_aw:
  buffer_load_dword v9, off, s[8:11], s27  sc1
  s_waitcnt vmcnt(0)
  v_and_b32 v10, s28, v9
  v_cmp_ne_u32 vcc, s28, v10
  s_cbranch_vccz wk_aw_ok
  s_sleep 3
  s_add_u32 s30, s30, 1
  s_cmp_lt_u32 s30, 400000
  s_cbranch_scc1 wk_aw
  s_branch cA_abort
wk_aw_ok:
wk_gemm:
  s_lshl_b32 s20, s18, 4
  s_lshr_b32 s21, s2, 3
  s_add_u32 s21, s21, s16
  s_and_b32 s21, s21, 3
  s_lshl_b32 s21, s21, 2
  s_add_u32 s20, s20, s21
  s_mul_i32 s21, s20, 14336
  s_add_u32 s21, s21, 72024064
  s_mul_i32 s23, s17, 401408
  s_and_b32 s22, s16, 1
  s_mul_i32 s22, s22, 7168
  s_add_u32 s23, s23, s22
  s_add_u32 s23, s23, 0
  s_lshr_b32 s22, s16, 1
  s_mul_i32 s22, s22, 14336
  s_add_u32 s23, s23, s22
  s_mul_i32 s27, s16, 7168
  s_lshr_b32 s28, s20, 1
  s_cmp_lt_u32 s17, 16
  s_cbranch_scc0 wg_vo
  s_add_u32 s23, s23, s22
  s_lshl_b32 s29, s28, 4
  s_add_u32 s29, s29, s17
  s_mul_i32 s29, s29, 28672
  s_add_u32 s29, s29, 12845056
  s_mov_b32 s31, 0
  s_lshr_b32 s24, s34, 1
  s_lshl_b32 s24, s24, 2
  s_and_b32 s25, s34, 1
  s_add_u32 s24, s24, s25
  s_mul_i32 s24, s24, 14336
  s_add_u32 s24, s24, s23
  s_add_u32 m0, s31, s27
  s_nop 0
  buffer_load_dwordx4 v2, s[8:11], s24 offen offset:0 sc1 lds
  buffer_load_dwordx4 v2, s[8:11], s24 offen offset:1024 sc1 lds
  buffer_load_dwordx4 v2, s[8:11], s24 offen offset:2048 sc1 lds
  buffer_load_dwordx4 v2, s[8:11], s24 offen offset:3072 sc1 lds
  s_add_u32 m0, m0, 4096
  s_add_u32 s24, s24, 4096
  buffer_load_dwordx4 v2, s[8:11], s24 offen offset:0 sc1 lds
  buffer_load_dwordx4 v2, s[8:11], s24 offen offset:1024 sc1 lds
  buffer_load_dwordx4 v2, s[8:11], s24 offen offset:2048 sc1 lds
  s_sub_u32 s36, s35, 1
  s_add_u32 s30, s34, 1
  s_min_u32 s30, s30, s36
  s_mov_b32 s31, 28672
  s_lshr_b32 s24, s30, 1
  s_lshl_b32 s24, s24, 2
  s_and_b32 s25, s30, 1
  s_add_u32 s24, s24, s25
  s_mul_i32 s24, s24, 14336
  s_add_u32 s24, s24, s23
  s_add_u32 m0, s31, s27
  s_nop 0
  buffer_load_dwordx4 v2, s[8:11], s24 offen offset:0 sc1 lds
  buffer_load_dwordx4 v2, s[8:11], s24 offen offset:1024 sc1 lds
  buffer_load_dwordx4 v2, s[8:11], s24 offen offset:2048 sc1 lds
  buffer_load_dwordx4 v2, s[8:11], s24 offen offset:3072 sc1 lds
  s_add_u32 m0, m0, 4096
  s_add_u32 s24, s24, 4096
  buffer_load_dwordx4 v2, s[8:11], s24 offen offset:0 sc1 lds
  buffer_load_dwordx4 v2, s[8:11], s24 offen offset:1024 sc1 lds
  buffer_load_dwordx4 v2, s[8:11], s24 offen offset:2048 sc1 lds
  s_mov_b32 s19, s34
  s_mov_b32 s32, 0
  s_mov_b32 s33, 57344
  s_cmp_eq_u32 s18, s101
  s_cbranch_scc1 wg_f_hx
  s_add_u32 s22, s21, 0
  buffer_load_dwordx4 a[0:3], v2, s[8:11], s22 offen offset:0 sc1
  buffer_load_dwordx4 a[4:7], v2, s[8:11], s22 offen offset:1024 sc1
  buffer_load_dwordx4 a[8:11], v2, s[8:11], s22 offen offset:2048 sc1
  buffer_load_dwordx4 a[12:15], v2, s[8:11], s22 offen offset:3072 sc1
  s_add_u32 s22, s21, 4096
  buffer_load_dwordx4 a[16:19], v2, s[8:11], s22 offen offset:0 sc1
  buffer_load_dwordx4 a[20:23], v2, s[8:11], s22 offen offset:1024 sc1
  buffer_load_dwordx4 a[24:27], v2, s[8:11], s22 offen offset:2048 sc1
  buffer_load_dwordx4 a[28:31], v2, s[8:11], s22 offen offset:3072 sc1
  s_add_u32 s22, s21, 8192
  buffer_load_dwordx4 a[32:35], v2, s[8:11], s22 offen offset:0 sc1
  buffer_load_dwordx4 a[36:39], v2, s[8:11], s22 offen offset:1024 sc1
  buffer_load_dwordx4 a[40:43], v2, s[8:11], s22 offen offset:2048 sc1
  buffer_load_dwordx4 a[44:47], v2, s[8:11], s22 offen offset:3072 sc1
  s_add_u32 s22, s21, 12288
  buffer_load_dwordx4 a[48:51], v2, s[8:11], s22 offen offset:0 sc1
  buffer_load_dwordx4 a[52:55], v2, s[8:11], s22 offen offset:1024 sc1
  buffer_load_dwordx4 a[56:59], v2, s[8:11], s22 offen offset:2048 sc1
  buffer_load_dwordx4 a[60:63], v2, s[8:11], s22 offen offset:3072 sc1
  s_add_u32 s22, s21, 16384
  buffer_load_dwordx4 a[64:67], v2, s[8:11], s22 offen offset:0 sc1
  buffer_load_dwordx4 a[68:71], v2, s[8:11], s22 offen offset:1024 sc1
  buffer_load_dwordx4 a[72:75], v2, s[8:11], s22 offen offset:2048 sc1
  buffer_load_dwordx4 a[76:79], v2, s[8:11], s22 offen offset:3072 sc1
  s_add_u32 s22, s21, 20480
  buffer_load_dwordx4 a[80:83], v2, s[8:11], s22 offen offset:0 sc1
  buffer_load_dwordx4 a[84:87], v2, s[8:11], s22 offen offset:1024 sc1
  buffer_load_dwordx4 a[88:91], v2, s[8:11], s22 offen offset:2048 sc1
  buffer_load_dwordx4 a[92:95], v2, s[8:11], s22 offen offset:3072 sc1
  s_add_u32 s22, s21, 24576
  buffer_load_dwordx4 a[96:99], v2, s[8:11], s22 offen offset:0 sc1
  buffer_load_dwordx4 a[100:103], v2, s[8:11], s22 offen offset:1024 sc1
  buffer_load_dwordx4 a[104:107], v2, s[8:11], s22 offen offset:2048 sc1
  buffer_load_dwordx4 a[108:111], v2, s[8:11], s22 offen offset:3072 sc1
  s_add_u32 s22, s21, 28672
  buffer_load_dwordx4 a[112:115], v2, s[8:11], s22 offen offset:0 sc1
  buffer_load_dwordx4 a[116:119], v2, s[8:11], s22 offen offset:1024 sc1
  buffer_load_dwordx4 a[120:123], v2, s[8:11], s22 offen offset:2048 sc1
  buffer_load_dwordx4 a[124:127], v2, s[8:11], s22 offen offset:3072 sc1
  s_add_u32 s22, s21, 32768
  buffer_load_dwordx4 a[128:131], v2, s[8:11], s22 offen offset:0 sc1
  buffer_load_dwordx4 a[132:135], v2, s[8:11], s22 offen offset:1024 sc1
  buffer_load_dwordx4 a[136:139], v2, s[8:11], s22 offen offset:2048 sc1
  buffer_load_dwordx4 a[140:143], v2, s[8:11], s22 offen offset:3072 sc1
  s_add_u32 s22, s21, 36864
  buffer_load_dwordx4 a[144:147], v2, s[8:11], s22 offen offset:0 sc1
  buffer_load_dwordx4 a[148:151], v2, s[8:11], s22 offen offset:1024 sc1
  buffer_load_dwordx4 a[152:155], v2, s[8:11], s22 offen offset:2048 sc1
  buffer_load_dwordx4 a[156:159], v2, s[8:11], s22 offen offset:3072 sc1
  s_add_u32 s22, s21, 40960
  s_waitcnt vmcnt(40)
  buffer_load_dwordx4 a[160:163], v2, s[8:11], s22 offen offset:0 sc1
  buffer_load_dwordx4 a[164:167], v2, s[8:11], s22 offen offset:1024 sc1
  buffer_load_dwordx4 a[168:171], v2, s[8:11], s22 offen offset:2048 sc1
  buffer_load_dwordx4 a[172:175], v2, s[8:11], s22 offen offset:3072 sc1
  s_add_u32 s22, s21, 45056
  buffer_load_dwordx4 a[176:179], v2, s[8:11], s22 offen offset:0 sc1
  buffer_load_dwordx4 a[180:183], v2, s[8:11], s22 offen offset:1024 sc1
  buffer_load_dwordx4 a[184:187], v2, s[8:11], s22 offen offset:2048 sc1
  buffer_load_dwordx4 a[188:191], v2, s[8:11], s22 offen offset:3072 sc1
  s_add_u32 s22, s21, 49152
  buffer_load_dwordx4 a[192:195], v2, s[8:11], s22 offen offset:0 sc1
  buffer_load_dwordx4 a[196:199], v2, s[8:11], s22 offen offset:1024 sc1
  buffer_load_dwordx4 a[200:203], v2, s[8:11], s22 offen offset:2048 sc1
  buffer_load_dwordx4 a[204:207], v2, s[8:11], s22 offen offset:3072 sc1
  s_add_u32 s22, s21, 53248
  buffer_load_dwordx4 a[208:211], v2, s[8:11], s22 offen offset:0 sc1
  buffer_load_dwordx4 a[212:215], v2, s[8:11], s22 offen offset:1024 sc1
  buffer_load_dwordx4 a[216:219], v2, s[8:11], s22 offen offset:2048 sc1
  buffer_load_dwordx4 a[220:223], v2, s[8:11], s22 offen offset:3072 sc1
wg_f_hx:
  s_mov_b32 s101, -1
  s_waitcnt vmcnt(0)
  s_branch wg_f_in
wg_f_loop:
  s_waitcnt vmcnt(11)
wg_f_in:
  s_barrier
  s_add_u32 s30, s19, 2
  s_min_u32 s30, s30, s36
  s_lshr_b32 s24, s30, 1
  s_lshl_b32 s24, s24, 2
  s_and_b32 s25, s30, 1
  s_add_u32 s24, s24, s25
  s_mul_i32 s24, s24, 14336
  s_add_u32 s24, s24, s23
  s_add_u32 m0, s33, s27
  s_nop 0
  buffer_load_dwordx4 v2, s[8:11], s24 offen offset:0 sc1 lds
  buffer_load_dwordx4 v2, s[8:11], s24 offen offset:1024 sc1 lds
  buffer_load_dwordx4 v2, s[8:11], s24 offen offset:2048 sc1 lds
  buffer_load_dwordx4 v2, s[8:11], s24 offen offset:3072 sc1 lds
  s_add_u32 m0, m0, 4096
  s_add_u32 s24, s24, 4096
  buffer_load_dwordx4 v2, s[8:11], s24 offen offset:0 sc1 lds
  buffer_load_dwordx4 v2, s[8:11], s24 offen offset:1024 sc1 lds
  buffer_load_dwordx4 v2, s[8:11], s24 offen offset:2048 sc1 lds
  v_add_u32 v5, s32, v2
  ds_read_b128 v[8:11], v5 offset:0
  ds_read_b128 v[12:15], v5 offset:14336
  ds_read_b128 v[16:19], v5 offset:1024
  ds_read_b128 v[20:23], v5 offset:15360
  ds_read_b128 v[24:27], v5 offset:2048
  ds_read_b128 v[28:31], v5 offset:16384
  ds_read_b128 v[32:35], v5 offset:3072
  s_waitcnt lgkmcnt(6)
  v_mfma_f32_16x16x32_bf16 v[40:43], v[8:11], a[0:3], 0
  v_mfma_f32_16x16x32_bf16 v[44:47], v[8:11], a[56:59], 0
  v_mfma_f32_16x16x32_bf16 v[48:51], v[8:11], a[112:115], 0
  v_mfma_f32_16x16x32_bf16 v[52:55], v[8:11], a[168:171], 0
  ds_read_b128 v[36:39], v5 offset:17408
  s_waitcnt lgkmcnt(6)
  v_mfma_f32_16x16x32_bf16 v[56:59], v[12:15], a[0:3], 0
  v_mfma_f32_16x16x32_bf16 v[60:63], v[12:15], a[56:59], 0
  v_mfma_f32_16x16x32_bf16 v[64:67], v[12:15], a[112:115], 0
  v_mfma_f32_16x16x32_bf16 v[68:71], v[12:15], a[168:171], 0
  ds_read_b128 v[8:11], v5 offset:4096
  s_waitcnt lgkmcnt(6)
  v_mfma_f32_16x16x32_bf16 v[40:43], v[16:19], a[4:7], v[40:43]
  v_mfma_f32_16x16x32_bf16 v[44:47], v[16:19], a[60:63], v[44:47]
  v_mfma_f32_16x16x32_bf16 v[48:51], v[16:19], a[116:119], v[48:51]
  v_mfma_f32_16x16x32_bf16 v[52:55], v[16:19], a[172:175], v[52:55]
  ds_read_b128 v[12:15], v5 offset:18432
  s_waitcnt lgkmcnt(6)
  v_mfma_f32_16x16x32_bf16 v[56:59], v[20:23], a[4:7], v[56:59]
  v_mfma_f32_16x16x32_bf16 v[60:63], v[20:23], a[60:63], v[60:63]
  v_mfma_f32_16x16x32_bf16 v[64:67], v[20:23], a[116:119], v[64:67]
  v_mfma_f32_16x16x32_bf16 v[68:71], v[20:23], a[172:175], v[68:71]
  ds_read_b128 v[16:19], v5 offset:5120
  s_waitcnt lgkmcnt(6)
  v_mfma_f32_16x16x32_bf16 v[40:43], v[24:27], a[8:11], v[40:43]
  v_mfma_f32_16x16x32_bf16 v[44:47], v[24:27], a[64:67], v[44:47]
  v_mfma_f32_16x16x32_bf16 v[48:51], v[24:27], a[120:123], v[48:51]
  v_mfma_f32_16x16x32_bf16 v[52:55], v[24:27], a[176:179], v[52:55]
  ds_read_b128 v[20:23], v5 offset:19456
  s_waitcnt lgkmcnt(6)
  v_mfma_f32_16x16x32_bf16 v[56:59], v[28:31], a[8:11], v[56:59]
  v_mfma_f32_16x16x32_bf16 v[60:63], v[28:31], a[64:67], v[60:63]
  v_mfma_f32_16x16x32_bf16 v[64:67], v[28:31], a[120:123], v[64:67]
  v_mfma_f32_16x16x32_bf16 v[68:71], v[28:31], a[176:179], v[68:71]
  ds_read_b128 v[24:27], v5 offset:6144
  s_waitcnt lgkmcnt(6)
  v_mfma_f32_16x16x32_bf16 v[40:43], v[32:35], a[12:15], v[40:43]
  v_mfma_f32_16x16x32_bf16 v[44:47], v[32:35], a[68:71], v[44:47]
  v_mfma_f32_16x16x32_bf16 v[48:51], v[32:35], a[124:127], v[48:51]
  v_mfma_f32_16x16x32_bf16 v[52:55], v[32:35], a[180:183], v[52:55]
  ds_read_b128 v[28:31], v5 offset:20480
  s_waitcnt lgkmcnt(6)
  v_mfma_f32_16x16x32_bf16 v[56:59], v[36:39], a[12:15], v[56:59]
  v_mfma_f32_16x16x32_bf16 v[60:63], v[36:39], a[68:71], v[60:63]
  v_mfma_f32_16x16x32_bf16 v[64:67], v[36:39], a[124:127], v[64:67]
  v_mfma_f32_16x16x32_bf16 v[68:71], v[36:39], a[180:183], v[68:71]
  ds_read_b128 v[32:35], v5 offset:7168
  s_waitcnt lgkmcnt(6)
  v_mfma_f32_16x16x32_bf16 v[40:43], v[8:11], a[16:19], v[40:43]
  v_mfma_f32_16x16x32_bf16 v[44:47], v[8:11], a[72:75], v[44:47]
  v_mfma_f32_16x16x32_bf16 v[48:51], v[8:11], a[128:131], v[48:51]
  v_mfma_f32_16x16x32_bf16 v[52:55], v[8:11], a[184:187], v[52:55]
  ds_read_b128 v[36:39], v5 offset:21504
  s_waitcnt lgkmcnt(6)
  v_mfma_f32_16x16x32_bf16 v[56:59], v[12:15], a[16:19], v[56:59]
  v_mfma_f32_16x16x32_bf16 v[60:63], v[12:15], a[72:75], v[60:63]
  v_mfma_f32_16x16x32_bf16 v[64:67], v[12:15], a[128:131], v[64:67]
  v_mfma_f32_16x16x32_bf16 v[68:71], v[12:15], a[184:187], v[68:71]
  ds_read_b128 v[8:11], v5 offset:8192
  s_waitcnt lgkmcnt(6)
  v_mfma_f32_16x16x32_bf16 v[40:43], v[16:19], a[20:23], v[40:43]
  v_mfma_f32_16x16x32_bf16 v[44:47], v[16:19], a[76:79], v[44:47]
  v_mfma_f32_16x16x32_bf16 v[48:51], v[16:19], a[132:135], v[48:51]
  v_mfma_f32_16x16x32_bf16 v[52:55], v[16:19], a[188:191], v[52:55]
  ds_read_b128 v[12:15], v5 offset:22528
  s_waitcnt lgkmcnt(6)
  v_mfma_f32_16x16x32_bf16 v[56:59], v[20:23], a[20:23], v[56:59]
  v_mfma_f32_16x16x32_bf16 v[60:63], v[20:23], a[76:79], v[60:63]
  v_mfma_f32_16x16x32_bf16 v[64:67], v[20:23], a[132:135], v[64:67]
  v_mfma_f32_16x16x32_bf16 v[68:71], v[20:23], a[188:191], v[68:71]
  ds_read_b128 v[16:19], v5 offset:9216
  s_waitcnt lgkmcnt(6)
  v_mfma_f32_16x16x32_bf16 v[40:43], v[24:27], a[24:27], v[40:43]
  v_mfma_f32_16x16x32_bf16 v[44:47], v[24:27], a[80:83], v[44:47]
  v_mfma_f32_16x16x32_bf16 v[48:51], v[24:27], a[136:139], v[48:51]
  v_mfma_f32_16x16x32_bf16 v[52:55], v[24:27], a[192:195], v[52:55]
  ds_read_b128 v[20:23], v5 offset:23552
  s_waitcnt lgkmcnt(6)
  v_mfma_f32_16x16x32_bf16 v[56:59], v[28:31], a[24:27], v[56:59]
  v_mfma_f32_16x16x32_bf16 v[60:63], v[28:31], a[80:83], v[60:63]
  v_mfma_f32_16x16x32_bf16 v[64:67], v[28:31], a[136:139], v[64:67]
  v_mfma_f32_16x16x32_bf16 v[68:71], v[28:31], a[192:195], v[68:71]
  ds_read_b128 v[24:27], v5 offset:10240
  s_waitcnt lgkmcnt(6)
  v_mfma_f32_16x16x32_bf16 v[40:43], v[32:35], a[28:31], v[40:43]
  v_mfma_f32_16x16x32_bf16 v[44:47], v[32:35], a[84:87], v[44:47]
  v_mfma_f32_16x16x32_bf16 v[48:51], v[32:35], a[140:143], v[48:51]
  v_mfma_f32_16x16x32_bf16 v[52:55], v[32:35], a[196:199], v[52:55]
  ds_read_b128 v[28:31], v5 offset:24576
  s_waitcnt lgkmcnt(6)
  v_mfma_f32_16x16x32_bf16 v[56:59], v[36:39], a[28:31], v[56:59]
  v_mfma_f32_16x16x32_bf16 v[60:63], v[36:39], a[84:87], v[60:63]
  v_mfma_f32_16x16x32_bf16 v[64:67], v[36:39], a[140:143], v[64:67]
  v_mfma_f32_16x16x32_bf16 v[68:71], v[36:39], a[196:199], v[68:71]
  ds_read_b128 v[32:35], v5 offset:11264
  s_waitcnt lgkmcnt(6)
  v_mfma_f32_16x16x32_bf16 v[40:43], v[8:11], a[32:35], v[40:43]
  v_mfma_f32_16x16x32_bf16 v[44:47], v[8:11], a[88:91], v[44:47]
  v_mfma_f32_16x16x32_bf16 v[48:51], v[8:11], a[144:147], v[48:51]
  v_mfma_f32_16x16x32_bf16 v[52:55], v[8:11], a[200:203], v[52:55]
  ds_read_b128 v[36:39], v5 offset:25600
  s_waitcnt lgkmcnt(6)
  v_mfma_f32_16x16x32_bf16 v[56:59], v[12:15], a[32:35], v[56:59]
  v_mfma_f32_16x16x32_bf16 v[60:63], v[12:15], a[88:91], v[60:63]
  v_mfma_f32_16x16x32_bf16 v[64:67], v[12:15], a[144:147], v[64:67]
  v_mfma_f32_16x16x32_bf16 v[68:71], v[12:15], a[200:203], v[68:71]
  ds_read_b128 v[8:11], v5 offset:12288
  s_waitcnt lgkmcnt(6)
  v_mfma_f32_16x16x32_bf16 v[40:43], v[16:19], a[36:39], v[40:43]
  v_mfma_f32_16x16x32_bf16 v[44:47], v[16:19], a[92:95], v[44:47]
  v_mfma_f32_16x16x32_bf16 v[48:51], v[16:19], a[148:151], v[48:51]
  v_mfma_f32_16x16x32_bf16 v[52:55], v[16:19], a[204:207], v[52:55]
  ds_read_b128 v[12:15], v5 offset:26624
  s_waitcnt lgkmcnt(6)
  v_mfma_f32_16x16x32_bf16 v[56:59], v[20:23], a[36:39], v[56:59]
  v_mfma_f32_16x16x32_bf16 v[60:63], v[20:23], a[92:95], v[60:63]
  v_mfma_f32_16x16x32_bf16 v[64:67], v[20:23], a[148:151], v[64:67]
  v_mfma_f32_16x16x32_bf16 v[68:71], v[20:23], a[204:207], v[68:71]
  ds_read_b128 v[16:19], v5 offset:13312
  s_waitcnt lgkmcnt(6)
  v_mfma_f32_16x16x32_bf16 v[40:43], v[24:27], a[40:43], v[40:43]
  v_mfma_f32_16x16x32_bf16 v[44:47], v[24:27], a[96:99], v[44:47]
  v_mfma_f32_16x16x32_bf16 v[48:51], v[24:27], a[152:155], v[48:51]
  v_mfma_f32_16x16x32_bf16 v[52:55], v[24:27], a[208:211], v[52:55]
  ds_read_b128 v[20:23], v5 offset:27648
  s_waitcnt lgkmcnt(6)
  v_mfma_f32_16x16x32_bf16 v[56:59], v[28:31], a[40:43], v[56:59]
  v_mfma_f32_16x16x32_bf16 v[60:63], v[28:31], a[96:99], v[60:63]
  v_mfma_f32_16x16x32_bf16 v[64:67], v[28:31], a[152:155], v[64:67]
  v_mfma_f32_16x16x32_bf16 v[68:71], v[28:31], a[208:211], v[68:71]
  s_waitcnt lgkmcnt(5)
  v_mfma_f32_16x16x32_bf16 v[40:43], v[32:35], a[44:47], v[40:43]
  v_mfma_f32_16x16x32_bf16 v[44:47], v[32:35], a[100:103], v[44:47]
  v_mfma_f32_16x16x32_bf16 v[48:51], v[32:35], a[156:159], v[48:51]
  v_mfma_f32_16x16x32_bf16 v[52:55], v[32:35], a[212:215], v[52:55]
  s_waitcnt lgkmcnt(4)
  v_mfma_f32_16x16x32_bf16 v[56:59], v[36:39], a[44:47], v[56:59]
  v_mfma_f32_16x16x32_bf16 v[60:63], v[36:39], a[100:103], v[60:63]
  v_mfma_f32_16x16x32_bf16 v[64:67], v[36:39], a[156:159], v[64:67]
  v_mfma_f32_16x16x32_bf16 v[68:71], v[36:39], a[212:215], v[68:71]
  s_waitcnt lgkmcnt(3)
  v_mfma_f32_16x16x32_bf16 v[40:43], v[8:11], a[48:51], v[40:43]
  v_mfma_f32_16x16x32_bf16 v[44:47], v[8:11], a[104:107], v[44:47]
  v_mfma_f32_16x16x32_bf16 v[48:51], v[8:11], a[160:163], v[48:51]
  v_mfma_f32_16x16x32_bf16 v[52:55], v[8:11], a[216:219], v[52:55]
  s_waitcnt lgkmcnt(2)
  v_mfma_f32_16x16x32_bf16 v[56:59], v[12:15], a[48:51], v[56:59]
  v_mfma_f32_16x16x32_bf16 v[60:63], v[12:15], a[104:107], v[60:63]
  v_mfma_f32_16x16x32_bf16 v[64:67], v[12:15], a[160:163], v[64:67]
  v_mfma_f32_16x16x32_bf16 v[68:71], v[12:15], a[216:219], v[68:71]
  s_waitcnt lgkmcnt(1)
  v_mfma_f32_16x16x32_bf16 v[40:43], v[16:19], a[52:55], v[40:43]
  v_mfma_f32_16x16x32_bf16 v[44:47], v[16:19], a[108:111], v[44:47]
  v_mfma_f32_16x16x32_bf16 v[48:51], v[16:19], a[164:167], v[48:51]
  v_mfma_f32_16x16x32_bf16 v[52:55], v[16:19], a[220:223], v[52:55]
  s_waitcnt lgkmcnt(0)
  v_mfma_f32_16x16x32_bf16 v[56:59], v[20:23], a[52:55], v[56:59]
  v_mfma_f32_16x16x32_bf16 v[60:63], v[20:23], a[108:111], v[60:63]
  v_mfma_f32_16x16x32_bf16 v[64:67], v[20:23], a[164:167], v[64:67]
  v_mfma_f32_16x16x32_bf16 v[68:71], v[20:23], a[220:223], v[68:71]
  s_lshl_b32 s24, s19, 10
  s_add_u32 s24, s24, s29
  v_cvt_pk_bf16_f32 v72, v40, v41
  v_cvt_pk_bf16_f32 v73, v42, v43
  v_cvt_pk_bf16_f32 v74, v56, v57
  v_cvt_pk_bf16_f32 v75, v58, v59
  s_add_u32 s25, s24, 0
  buffer_store_dwordx4 v[72:75], v2, s[8:11], s25 offen sc1
  v_cvt_pk_bf16_f32 v76, v44, v45
  v_cvt_pk_bf16_f32 v77, v46, v47
  v_cvt_pk_bf16_f32 v78, v60, v61
  v_cvt_pk_bf16_f32 v79, v62, v63
  s_add_u32 s25, s24, 14336
  buffer_store_dwordx4 v[76:79], v2, s[8:11], s25 offen sc1
  v_cvt_pk_bf16_f32 v80, v48, v49
  v_cvt_pk_bf16_f32 v81, v50, v51
  v_cvt_pk_bf16_f32 v82, v64, v65
  v_cvt_pk_bf16_f32 v83, v66, v67
  s_add_u32 s25, s24, 458752
  buffer_store_dwordx4 v[80:83], v2, s[8:11], s25 offen sc1
  v_cvt_pk_bf16_f32 v84, v52, v53
  v_cvt_pk_bf16_f32 v85, v54, v55
  v_cvt_pk_bf16_f32 v86, v68, v69
  v_cvt_pk_bf16_f32 v87, v70, v71
  s_add_u32 s25, s24, 473088
  buffer_store_dwordx4 v[84:87], v2, s[8:11], s25 offen sc1
  s_mov_b32 s33, s32
  s_add_u32 s32, s32, 28672
  s_cmp_eq_u32 s32, 86016
  s_cselect_b32 s32, 0, s32
  s_add_u32 s19, s19, 1
  s_cmp_lt_u32 s19, s35
  s_cbranch_scc1 wg_f_loop
  s_branch wg_done
wg_vo:
  s_sub_u32 s29, s17, 16
  s_mul_i32 s29, s29, 28672
  s_mul_i32 s24, s28, 458752
  s_add_u32 s29, s29, s24
  s_add_u32 s29, s29, 42205184
  v_lshlrev_b32 v6, 4, v3
  v_mul_u32_u24 v7, 12, v3
  v_add_u32 v7, 48, v7
  s_mov_b32 s31, 0
  s_lshl_b32 s24, s34, 1
  s_mul_i32 s24, s24, 14336
  s_add_u32 s24, s24, s23
  s_add_u32 m0, s31, s27
  s_nop 0
  buffer_load_dwordx4 v2, s[8:11], s24 offen offset:0 sc1 lds
  buffer_load_dwordx4 v2, s[8:11], s24 offen offset:1024 sc1 lds
  buffer_load_dwordx4 v2, s[8:11], s24 offen offset:2048 sc1 lds
  buffer_load_dwordx4 v2, s[8:11], s24 offen offset:3072 sc1 lds
  s_add_u32 m0, m0, 4096
  s_add_u32 s24, s24, 4096
  buffer_load_dwordx4 v2, s[8:11], s24 offen offset:0 sc1 lds
  buffer_load_dwordx4 v2, s[8:11], s24 offen offset:1024 sc1 lds
  buffer_load_dwordx4 v2, s[8:11], s24 offen offset:2048 sc1 lds
  s_sub_u32 s36, s35, 1
  s_add_u32 s30, s34, 1
  s_min_u32 s30, s30, s36
  s_mov_b32 s31, 28672
  s_lshl_b32 s24, s30, 1
  s_mul_i32 s24, s24, 14336
  s_add_u32 s24, s24, s23
  s_add_u32 m0, s31, s27
  s_nop 0
  buffer_load_dwordx4 v2, s[8:11], s24 offen offset:0 sc1 lds
  buffer_load_dwordx4 v2, s[8:11], s24 offen offset:1024 sc1 lds
  buffer_load_dwordx4 v2, s[8:11], s24 offen offset:2048 sc1 lds
  buffer_load_dwordx4 v2, s[8:11], s24 offen offset:3072 sc1 lds
  s_add_u32 m0, m0, 4096
  s_add_u32 s24, s24, 4096
  buffer_load_dwordx4 v2, s[8:11], s24 offen offset:0 sc1 lds
  buffer_load_dwordx4 v2, s[8:11], s24 offen offset:1024 sc1 lds
  buffer_load_dwordx4 v2, s[8:11], s24 offen offset:2048 sc1 lds
  s_mov_b32 s19, s34
  s_mov_b32 s32, 0
  s_mov_b32 s33, 57344
  s_cmp_eq_u32 s18, s101
  s_cbranch_scc1 wg_vo_hx
  s_add_u32 s22, s21, 0
  buffer_load_dwordx4 a[0:3], v2, s[8:11], s22 offen offset:0 sc1
  buffer_load_dwordx4 a[4:7], v2, s[8:11], s22 offen offset:1024 sc1
  buffer_load_dwordx4 a[8:11], v2, s[8:11], s22 offen offset:2048 sc1
  buffer_load_dwordx4 a[12:15], v2, s[8:11], s22 offen offset:3072 sc1
  s_add_u32 s22, s21, 4096
  buffer_load_dwordx4 a[16:19], v2, s[8:11], s22 offen offset:0 sc1
  buffer_load_dwordx4 a[20:23], v2, s[8:11], s22 offen offset:1024 sc1
  buffer_load_dwordx4 a[24:27], v2, s[8:11], s22 offen offset:2048 sc1
  buffer_load_dwordx4 a[28:31], v2, s[8:11], s22 offen offset:3072 sc1
  s_add_u32 s22, s21, 8192
  buffer_load_dwordx4 a[32:35], v2, s[8:11], s22 offen offset:0 sc1
  buffer_load_dwordx4 a[36:39], v2, s[8:11], s22 offen offset:1024 sc1
  buffer_load_dwordx4 a[40:43], v2, s[8:11], s22 offen offset:2048 sc1
  buffer_load_dwordx4 a[44:47], v2, s[8:11], s22 offen offset:3072 sc1
  s_add_u32 s22, s21, 12288
  buffer_load_dwordx4 a[48:51], v2, s[8:11], s22 offen offset:0 sc1
  buffer_load_dwordx4 a[52:55], v2, s[8:11], s22 offen offset:1024 sc1
  buffer_load_dwordx4 a[56:59], v2, s[8:11], s22 offen offset:2048 sc1
  buffer_load_dwordx4 a[60:63], v2, s[8:11], s22 offen offset:3072 sc1
  s_add_u32 s22, s21, 16384
  buffer_load_dwordx4 a[64:67], v2, s[8:11], s22 offen offset:0 sc1
  buffer_load_dwordx4 a[68:71], v2, s[8:11], s22 offen offset:1024 sc1
  buffer_load_dwordx4 a[72:75], v2, s[8:11], s22 offen offset:2048 sc1
  buffer_load_dwordx4 a[76:79], v2, s[8:11], s22 offen offset:3072 sc1
  s_add_u32 s22, s21, 20480
  buffer_load_dwordx4 a[80:83], v2, s[8:11], s22 offen offset:0 sc1
  buffer_load_dwordx4 a[84:87], v2, s[8:11], s22 offen offset:1024 sc1
  buffer_load_dwordx4 a[88:91], v2, s[8:11], s22 offen offset:2048 sc1
  buffer_load_dwordx4 a[92:95], v2, s[8:11], s22 offen offset:3072 sc1
  s_add_u32 s22, s21, 24576
  buffer_load_dwordx4 a[96:99], v2, s[8:11], s22 offen offset:0 sc1
  buffer_load_dwordx4 a[100:103], v2, s[8:11], s22 offen offset:1024 sc1
  buffer_load_dwordx4 a[104:107], v2, s[8:11], s22 offen offset:2048 sc1
  buffer_load_dwordx4 a[108:111], v2, s[8:11], s22 offen offset:3072 sc1
  s_add_u32 s22, s21, 28672
  buffer_load_dwordx4 a[112:115], v2, s[8:11], s22 offen offset:0 sc1
  buffer_load_dwordx4 a[116:119], v2, s[8:11], s22 offen offset:1024 sc1
  buffer_load_dwordx4 a[120:123], v2, s[8:11], s22 offen offset:2048 sc1
  buffer_load_dwordx4 a[124:127], v2, s[8:11], s22 offen offset:3072 sc1
  s_add_u32 s22, s21, 32768
  buffer_load_dwordx4 a[128:131], v2, s[8:11], s22 offen offset:0 sc1
  buffer_load_dwordx4 a[132:135], v2, s[8:11], s22 offen offset:1024 sc1
  buffer_load_dwordx4 a[136:139], v2, s[8:11], s22 offen offset:2048 sc1
  buffer_load_dwordx4 a[140:143], v2, s[8:11], s22 offen offset:3072 sc1
  s_add_u32 s22, s21, 36864
  buffer_load_dwordx4 a[144:147], v2, s[8:11], s22 offen offset:0 sc1
  buffer_load_dwordx4 a[148:151], v2, s[8:11], s22 offen offset:1024 sc1
  buffer_load_dwordx4 a[152:155], v2, s[8:11], s22 offen offset:2048 sc1
  buffer_load_dwordx4 a[156:159], v2, s[8:11], s22 offen offset:3072 sc1
  s_add_u32 s22, s21, 40960
  s_waitcnt vmcnt(40)
  buffer_load_dwordx4 a[160:163], v2, s[8:11], s22 offen offset:0 sc1
  buffer_load_dwordx4 a[164:167], v2, s[8:11], s22 offen offset:1024 sc1
  buffer_load_dwordx4 a[168:171], v2, s[8:11], s22 offen offset:2048 sc1
  buffer_load_dwordx4 a[172:175], v2, s[8:11], s22 offen offset:3072 sc1
  s_add_u32 s22, s21, 45056
  buffer_load_dwordx4 a[176:179], v2, s[8:11], s22 offen offset:0 sc1
  buffer_load_dwordx4 a[180:183], v2, s[8:11], s22 offen offset:1024 sc1
  buffer_load_dwordx4 a[184:187], v2, s[8:11], s22 offen offset:2048 sc1
  buffer_load_dwordx4 a[188:191], v2, s[8:11], s22 offen offset:3072 sc1
  s_add_u32 s22, s21, 49152
  buffer_load_dwordx4 a[192:195], v2, s[8:11], s22 offen offset:0 sc1
  buffer_load_dwordx4 a[196:199], v2, s[8:11], s22 offen offset:1024 sc1
  buffer_load_dwordx4 a[200:203], v2, s[8:11], s22 offen offset:2048 sc1
  buffer_load_dwordx4 a[204:207], v2, s[8:11], s22 offen offset:3072 sc1
  s_add_u32 s22, s21, 53248
  buffer_load_dwordx4 a[208:211], v2, s[8:11], s22 offen offset:0 sc1
  buffer_load_dwordx4 a[212:215], v2, s[8:11], s22 offen offset:1024 sc1
  buffer_load_dwordx4 a[216:219], v2, s[8:11], s22 offen offset:2048 sc1
  buffer_load_dwordx4 a[220:223], v2, s[8:11], s22 offen offset:3072 sc1
wg_vo_hx:
  s_mov_b32 s101, -1
  s_waitcnt vmcnt(0)
  s_branch wg_vo_in
wg_vo_loop:
  s_waitcnt vmcnt(11)
wg_vo_in:
  s_barrier
  s_add_u32 s30, s19, 2
  s_min_u32 s30, s30, s36
  s_lshl_b32 s24, s30, 1
  s_mul_i32 s24, s24, 14336
  s_add_u32 s24, s24, s23
  s_add_u32 m0, s33, s27
  s_nop 0
  buffer_load_dwordx4 v2, s[8:11], s24 offen offset:0 sc1 lds
  buffer_load_dwordx4 v2, s[8:11], s24 offen offset:1024 sc1 lds
  buffer_load_dwordx4 v2, s[8:11], s24 offen offset:2048 sc1 lds
  buffer_load_dwordx4 v2, s[8:11], s24 offen offset:3072 sc1 lds
  s_add_u32 m0, m0, 4096
  s_add_u32 s24, s24, 4096
  buffer_load_dwordx4 v2, s[8:11], s24 offen offset:0 sc1 lds
  buffer_load_dwordx4 v2, s[8:11], s24 offen offset:1024 sc1 lds
  buffer_load_dwordx4 v2, s[8:11], s24 offen offset:2048 sc1 lds
  v_add_u32 v5, s32, v2
  ds_read_b128 v[8:11], v5 offset:0
  ds_read_b128 v[12:15], v5 offset:14336
  ds_read_b128 v[16:19], v5 offset:1024
  ds_read_b128 v[20:23], v5 offset:15360
  ds_read_b128 v[24:27], v5 offset:2048
  ds_read_b128 v[28:31], v5 offset:16384
  ds_read_b128 v[32:35], v5 offset:3072
  s_waitcnt lgkmcnt(6)
  v_mfma_f32_16x16x32_bf16 v[40:43], a[0:3], v[8:11], 0
  v_mfma_f32_16x16x32_bf16 v[44:47], a[56:59], v[8:11], 0
  v_mfma_f32_16x16x32_bf16 v[48:51], a[112:115], v[8:11], 0
  v_mfma_f32_16x16x32_bf16 v[52:55], a[168:171], v[8:11], 0
  ds_read_b128 v[36:39], v5 offset:17408
  s_waitcnt lgkmcnt(6)
  v_mfma_f32_16x16x32_bf16 v[56:59], a[0:3], v[12:15], 0
  v_mfma_f32_16x16x32_bf16 v[60:63], a[56:59], v[12:15], 0
  v_mfma_f32_16x16x32_bf16 v[64:67], a[112:115], v[12:15], 0
  v_mfma_f32_16x16x32_bf16 v[68:71], a[168:171], v[12:15], 0
  ds_read_b128 v[8:11], v5 offset:4096
  s_waitcnt lgkmcnt(6)
  v_mfma_f32_16x16x32_bf16 v[40:43], a[4:7], v[16:19], v[40:43]
  v_mfma_f32_16x16x32_bf16 v[44:47], a[60:63], v[16:19], v[44:47]
  v_mfma_f32_16x16x32_bf16 v[48:51], a[116:119], v[16:19], v[48:51]
  v_mfma_f32_16x16x32_bf16 v[52:55], a[172:175], v[16:19], v[52:55]
  ds_read_b128 v[12:15], v5 offset:18432
  s_waitcnt lgkmcnt(6)
  v_mfma_f32_16x16x32_bf16 v[56:59], a[4:7], v[20:23], v[56:59]
  v_mfma_f32_16x16x32_bf16 v[60:63], a[60:63], v[20:23], v[60:63]
  v_mfma_f32_16x16x32_bf16 v[64:67], a[116:119], v[20:23], v[64:67]
  v_mfma_f32_16x16x32_bf16 v[68:71], a[172:175], v[20:23], v[68:71]
  ds_read_b128 v[16:19], v5 offset:5120
  s_waitcnt lgkmcnt(6)
  v_mfma_f32_16x16x32_bf16 v[40:43], a[8:11], v[24:27], v[40:43]
  v_mfma_f32_16x16x32_bf16 v[44:47], a[64:67], v[24:27], v[44:47]
  v_mfma_f32_16x16x32_bf16 v[48:51], a[120:123], v[24:27], v[48:51]
  v_mfma_f32_16x16x32_bf16 v[52:55], a[176:179], v[24:27], v[52:55]
  ds_read_b128 v[20:23], v5 offset:19456
  s_waitcnt lgkmcnt(6)
  v_mfma_f32_16x16x32_bf16 v[56:59], a[8:11], v[28:31], v[56:59]
  v_mfma_f32_16x16x32_bf16 v[60:63], a[64:67], v[28:31], v[60:63]
  v_mfma_f32_16x16x32_bf16 v[64:67], a[120:123], v[28:31], v[64:67]
  v_mfma_f32_16x16x32_bf16 v[68:71], a[176:179], v[28:31], v[68:71]
  ds_read_b128 v[24:27], v5 offset:6144
  s_waitcnt lgkmcnt(6)
  v_mfma_f32_16x16x32_bf16 v[40:43], a[12:15], v[32:35], v[40:43]
  v_mfma_f32_16x16x32_bf16 v[44:47], a[68:71], v[32:35], v[44:47]
  v_mfma_f32_16x16x32_bf16 v[48:51], a[124:127], v[32:35], v[48:51]
  v_mfma_f32_16x16x32_bf16 v[52:55], a[180:183], v[32:35], v[52:55]
  ds_read_b128 v[28:31], v5 offset:20480
  s_waitcnt lgkmcnt(6)
  v_mfma_f32_16x16x32_bf16 v[56:59], a[12:15], v[36:39], v[56:59]
  v_mfma_f32_16x16x32_bf16 v[60:63], a[68:71], v[36:39], v[60:63]
  v_mfma_f32_16x16x32_bf16 v[64:67], a[124:127], v[36:39], v[64:67]
  v_mfma_f32_16x16x32_bf16 v[68:71], a[180:183], v[36:39], v[68:71]
  ds_read_b128 v[32:35], v5 offset:7168
  s_waitcnt lgkmcnt(6)
  v_mfma_f32_16x16x32_bf16 v[40:43], a[16:19], v[8:11], v[40:43]
  v_mfma_f32_16x16x32_bf16 v[44:47], a[72:75], v[8:11], v[44:47]
  v_mfma_f32_16x16x32_bf16 v[48:51], a[128:131], v[8:11], v[48:51]
  v_mfma_f32_16x16x32_bf16 v[52:55], a[184:187], v[8:11], v[52:55]
  ds_read_b128 v[36:39], v5 offset:21504
  s_waitcnt lgkmcnt(6)
  v_mfma_f32_16x16x32_bf16 v[56:59], a[16:19], v[12:15], v[56:59]
  v_mfma_f32_16x16x32_bf16 v[60:63], a[72:75], v[12:15], v[60:63]
  v_mfma_f32_16x16x32_bf16 v[64:67], a[128:131], v[12:15], v[64:67]
  v_mfma_f32_16x16x32_bf16 v[68:71], a[184:187], v[12:15], v[68:71]
  ds_read_b128 v[8:11], v5 offset:8192
  s_waitcnt lgkmcnt(6)
  v_mfma_f32_16x16x32_bf16 v[40:43], a[20:23], v[16:19], v[40:43]
  v_mfma_f32_16x16x32_bf16 v[44:47], a[76:79], v[16:19], v[44:47]
  v_mfma_f32_16x16x32_bf16 v[48:51], a[132:135], v[16:19], v[48:51]
  v_mfma_f32_16x16x32_bf16 v[52:55], a[188:191], v[16:19], v[52:55]
  ds_read_b128 v[12:15], v5 offset:22528
  s_waitcnt lgkmcnt(6)
  v_mfma_f32_16x16x32_bf16 v[56:59], a[20:23], v[20:23], v[56:59]
  v_mfma_f32_16x16x32_bf16 v[60:63], a[76:79], v[20:23], v[60:63]
  v_mfma_f32_16x16x32_bf16 v[64:67], a[132:135], v[20:23], v[64:67]
  v_mfma_f32_16x16x32_bf16 v[68:71], a[188:191], v[20:23], v[68:71]
  ds_read_b128 v[16:19], v5 offset:9216
  s_waitcnt lgkmcnt(6)
  v_mfma_f32_16x16x32_bf16 v[40:43], a[24:27], v[24:27], v[40:43]
  v_mfma_f32_16x16x32_bf16 v[44:47], a[80:83], v[24:27], v[44:47]
  v_mfma_f32_16x16x32_bf16 v[48:51], a[136:139], v[24:27], v[48:51]
  v_mfma_f32_16x16x32_bf16 v[52:55], a[192:195], v[24:27], v[52:55]
  ds_read_b128 v[20:23], v5 offset:23552
  s_waitcnt lgkmcnt(6)
  v_mfma_f32_16x16x32_bf16 v[56:59], a[24:27], v[28:31], v[56:59]
  v_mfma_f32_16x16x32_bf16 v[60:63], a[80:83], v[28:31], v[60:63]
  v_mfma_f32_16x16x32_bf16 v[64:67], a[136:139], v[28:31], v[64:67]
  v_mfma_f32_16x16x32_bf16 v[68:71], a[192:195], v[28:31], v[68:71]
  ds_read_b128 v[24:27], v5 offset:10240
  s_waitcnt lgkmcnt(6)
  v_mfma_f32_16x16x32_bf16 v[40:43], a[28:31], v[32:35], v[40:43]
  v_mfma_f32_16x16x32_bf16 v[44:47], a[84:87], v[32:35], v[44:47]
  v_mfma_f32_16x16x32_bf16 v[48:51], a[140:143], v[32:35], v[48:51]
  v_mfma_f32_16x16x32_bf16 v[52:55], a[196:199], v[32:35], v[52:55]
  ds_read_b128 v[28:31], v5 offset:24576
  s_waitcnt lgkmcnt(6)
  v_mfma_f32_16x16x32_bf16 v[56:59], a[28:31], v[36:39], v[56:59]
  v_mfma_f32_16x16x32_bf16 v[60:63], a[84:87], v[36:39], v[60:63]
  v_mfma_f32_16x16x32_bf16 v[64:67], a[140:143], v[36:39], v[64:67]
  v_mfma_f32_16x16x32_bf16 v[68:71], a[196:199], v[36:39], v[68:71]
  ds_read_b128 v[32:35], v5 offset:11264
  s_waitcnt lgkmcnt(6)
  v_mfma_f32_16x16x32_bf16 v[40:43], a[32:35], v[8:11], v[40:43]
  v_mfma_f32_16x16x32_bf16 v[44:47], a[88:91], v[8:11], v[44:47]
  v_mfma_f32_16x16x32_bf16 v[48:51], a[144:147], v[8:11], v[48:51]
  v_mfma_f32_16x16x32_bf16 v[52:55], a[200:203], v[8:11], v[52:55]
  ds_read_b128 v[36:39], v5 offset:25600
  s_waitcnt lgkmcnt(6)
  v_mfma_f32_16x16x32_bf16 v[56:59], a[32:35], v[12:15], v[56:59]
  v_mfma_f32_16x16x32_bf16 v[60:63], a[88:91], v[12:15], v[60:63]
  v_mfma_f32_16x16x32_bf16 v[64:67], a[144:147], v[12:15], v[64:67]
  v_mfma_f32_16x16x32_bf16 v[68:71], a[200:203], v[12:15], v[68:71]
  ds_read_b128 v[8:11], v5 offset:12288
  s_waitcnt lgkmcnt(6)
  v_mfma_f32_16x16x32_bf16 v[40:43], a[36:39], v[16:19], v[40:43]
  v_mfma_f32_16x16x32_bf16 v[44:47], a[92:95], v[16:19], v[44:47]
  v_mfma_f32_16x16x32_bf16 v[48:51], a[148:151], v[16:19], v[48:51]
  v_mfma_f32_16x16x32_bf16 v[52:55], a[204:207], v[16:19], v[52:55]
  ds_read_b128 v[12:15], v5 offset:26624
  s_waitcnt lgkmcnt(6)
  v_mfma_f32_16x16x32_bf16 v[56:59], a[36:39], v[20:23], v[56:59]
  v_mfma_f32_16x16x32_bf16 v[60:63], a[92:95], v[20:23], v[60:63]
  v_mfma_f32_16x16x32_bf16 v[64:67], a[148:151], v[20:23], v[64:67]
  v_mfma_f32_16x16x32_bf16 v[68:71], a[204:207], v[20:23], v[68:71]
  ds_read_b128 v[16:19], v5 offset:13312
  s_waitcnt lgkmcnt(6)
  v_mfma_f32_16x16x32_bf16 v[40:43], a[40:43], v[24:27], v[40:43]
  v_mfma_f32_16x16x32_bf16 v[44:47], a[96:99], v[24:27], v[44:47]
  v_mfma_f32_16x16x32_bf16 v[48:51], a[152:155], v[24:27], v[48:51]
  v_mfma_f32_16x16x32_bf16 v[52:55], a[208:211], v[24:27], v[52:55]
  ds_read_b128 v[20:23], v5 offset:27648
  s_waitcnt lgkmcnt(6)
  v_mfma_f32_16x16x32_bf16 v[56:59], a[40:43], v[28:31], v[56:59]
  v_mfma_f32_16x16x32_bf16 v[60:63], a[96:99], v[28:31], v[60:63]
  v_mfma_f32_16x16x32_bf16 v[64:67], a[152:155], v[28:31], v[64:67]
  v_mfma_f32_16x16x32_bf16 v[68:71], a[208:211], v[28:31], v[68:71]
  s_waitcnt lgkmcnt(5)
  v_mfma_f32_16x16x32_bf16 v[40:43], a[44:47], v[32:35], v[40:43]
  v_mfma_f32_16x16x32_bf16 v[44:47], a[100:103], v[32:35], v[44:47]
  v_mfma_f32_16x16x32_bf16 v[48:51], a[156:159], v[32:35], v[48:51]
  v_mfma_f32_16x16x32_bf16 v[52:55], a[212:215], v[32:35], v[52:55]
  s_waitcnt lgkmcnt(4)
  v_mfma_f32_16x16x32_bf16 v[56:59], a[44:47], v[36:39], v[56:59]
  v_mfma_f32_16x16x32_bf16 v[60:63], a[100:103], v[36:39], v[60:63]
  v_mfma_f32_16x16x32_bf16 v[64:67], a[156:159], v[36:39], v[64:67]
  v_mfma_f32_16x16x32_bf16 v[68:71], a[212:215], v[36:39], v[68:71]
  s_waitcnt lgkmcnt(3)
  v_mfma_f32_16x16x32_bf16 v[40:43], a[48:51], v[8:11], v[40:43]
  v_mfma_f32_16x16x32_bf16 v[44:47], a[104:107], v[8:11], v[44:47]
  v_mfma_f32_16x16x32_bf16 v[48:51], a[160:163], v[8:11], v[48:51]
  v_mfma_f32_16x16x32_bf16 v[52:55], a[216:219], v[8:11], v[52:55]
  s_waitcnt lgkmcnt(2)
  v_mfma_f32_16x16x32_bf16 v[56:59], a[48:51], v[12:15], v[56:59]
  v_mfma_f32_16x16x32_bf16 v[60:63], a[104:107], v[12:15], v[60:63]
  v_mfma_f32_16x16x32_bf16 v[64:67], a[160:163], v[12:15], v[64:67]
  v_mfma_f32_16x16x32_bf16 v[68:71], a[216:219], v[12:15], v[68:71]
  s_waitcnt lgkmcnt(1)
  v_mfma_f32_16x16x32_bf16 v[40:43], a[52:55], v[16:19], v[40:43]
  v_mfma_f32_16x16x32_bf16 v[44:47], a[108:111], v[16:19], v[44:47]
  v_mfma_f32_16x16x32_bf16 v[48:51], a[164:167], v[16:19], v[48:51]
  v_mfma_f32_16x16x32_bf16 v[52:55], a[220:223], v[16:19], v[52:55]
  s_waitcnt lgkmcnt(0)
  v_mfma_f32_16x16x32_bf16 v[56:59], a[52:55], v[20:23], v[56:59]
  v_mfma_f32_16x16x32_bf16 v[60:63], a[108:111], v[20:23], v[60:63]
  v_mfma_f32_16x16x32_bf16 v[64:67], a[164:167], v[20:23], v[64:67]
  v_mfma_f32_16x16x32_bf16 v[68:71], a[220:223], v[20:23], v[68:71]
  s_add_u32 s25, s29, 458752
  s_lshl_b32 s24, s19, 5
  s_add_u32 s24, s24, 0
  v_add_u32 v88, s24, v4
  v_mul_u32_u24 v89, 2341, v88
  v_lshrrev_b32 v89, 16, v89
  v_mul_u32_u24 v92, 28, v89
  v_sub_u32 v92, v88, v92
  v_cmp_gt_u32 vcc, 16, v92
  v_mul_u32_u24 v89, 84, v89
  s_nop 0
  v_cndmask_b32 v92, v7, v6, vcc
  v_add3_u32 v88, v88, v89, v92
  v_lshlrev_b32 v90, 4, v88
  v_cvt_pk_bf16_f32 v72, v40, v44
  v_cvt_pk_bf16_f32 v73, v41, v45
  v_cvt_pk_bf16_f32 v74, v42, v46
  v_cvt_pk_bf16_f32 v75, v43, v47
  buffer_store_dwordx4 v[72:75], v90, s[8:11], s29 offen sc1
  v_cvt_pk_bf16_f32 v76, v48, v52
  v_cvt_pk_bf16_f32 v77, v49, v53
  v_cvt_pk_bf16_f32 v78, v50, v54
  v_cvt_pk_bf16_f32 v79, v51, v55
  buffer_store_dwordx4 v[76:79], v90, s[8:11], s25 offen sc1
  s_lshl_b32 s24, s19, 5
  s_add_u32 s24, s24, 16
  v_add_u32 v88, s24, v4
  v_mul_u32_u24 v89, 2341, v88
  v_lshrrev_b32 v89, 16, v89
  v_mul_u32_u24 v92, 28, v89
  v_sub_u32 v92, v88, v92
  v_cmp_gt_u32 vcc, 16, v92
  v_mul_u32_u24 v89, 84, v89
  s_nop 0
  v_cndmask_b32 v92, v7, v6, vcc
  v_add3_u32 v88, v88, v89, v92
  v_lshlrev_b32 v91, 4, v88
  v_cvt_pk_bf16_f32 v80, v56, v60
  v_cvt_pk_bf16_f32 v81, v57, v61
  v_cvt_pk_bf16_f32 v82, v58, v62
  v_cvt_pk_bf16_f32 v83, v59, v63
  buffer_store_dwordx4 v[80:83], v91, s[8:11], s29 offen sc1
  v_cvt_pk_bf16_f32 v84, v64, v68
  v_cvt_pk_bf16_f32 v85, v65, v69
  v_cvt_pk_bf16_f32 v86, v66, v70
  v_cvt_pk_bf16_f32 v87, v67, v71
  buffer_store_dwordx4 v[84:87], v91, s[8:11], s25 offen sc1
  s_mov_b32 s33, s32
  s_add_u32 s32, s32, 28672
  s_cmp_eq_u32 s32, 86016
  s_cselect_b32 s32, 0, s32
  s_add_u32 s19, s19, 1
  s_cmp_lt_u32 s19, s35
  s_cbranch_scc1 wg_vo_loop
  s_branch wg_done
wg_done:
  s_lshl_b32 s20, s18, 4
  s_and_b32 s21, s17, 15
  s_add_u32 s20, s20, s21
  s_lshl_b32 s20, s20, 7
  s_cmp_lt_u32 s17, 16
  s_cselect_b32 s21, 16384, 0
  s_add_u32 s20, s20, s21
  s_add_u32 s20, s20, 88461312
  s_sub_u32 s21, s35, s34
  s_lshl_b32 s21, s21, 2
  v_mov_b32 v5, s21
  v_mov_b32 v6, 0
  s_waitcnt vmcnt(0)
  s_barrier
  s_cmp_lg_u32 s16, 0
  s_cbranch_scc1 wg_sg
  s_mov_b64 exec, 1
  buffer_atomic_add v5, v6, s[8:11], s20 offen
  s_mov_b64 exec, -1
wg_sg:
  s_branch wk_loop
wk_srv:
  s_and_b32 s18, s3, 15
  s_lshr_b32 s19, s3, 4
  s_and_b32 s19, s19, 1
  s_mul_i32 s20, s18, 401408
  s_mul_i32 s21, s16, 100352
  s_add_u32 s20, s20, s21
  s_add_u32 s20, s20, 6422528
  s_add_u32 s22, s20, 0
  buffer_load_dwordx4 a[0:3], v2, s[8:11], s22 offen offset:0 sc1
  buffer_load_dwordx4 a[4:7], v2, s[8:11], s22 offen offset:1024 sc1
  buffer_load_dwordx4 a[8:11], v2, s[8:11], s22 offen offset:2048 sc1
  buffer_load_dwordx4 a[12:15], v2, s[8:11], s22 offen offset:3072 sc1
  s_add_u32 s22, s20, 4096
  buffer_load_dwordx4 a[16:19], v2, s[8:11], s22 offen offset:0 sc1
  buffer_load_dwordx4 a[20:23], v2, s[8:11], s22 offen offset:1024 sc1
  buffer_load_dwordx4 a[24:27], v2, s[8:11], s22 offen offset:2048 sc1
  buffer_load_dwordx4 a[28:31], v2, s[8:11], s22 offen offset:3072 sc1
  s_add_u32 s22, s20, 8192
  buffer_load_dwordx4 a[32:35], v2, s[8:11], s22 offen offset:0 sc1
  buffer_load_dwordx4 a[36:39], v2, s[8:11], s22 offen offset:1024 sc1
  buffer_load_dwordx4 a[40:43], v2, s[8:11], s22 offen offset:2048 sc1
  buffer_load_dwordx4 a[44:47], v2, s[8:11], s22 offen offset:3072 sc1
  s_add_u32 s22, s20, 12288
  buffer_load_dwordx4 a[48:51], v2, s[8:11], s22 offen offset:0 sc1
  buffer_load_dwordx4 a[52:55], v2, s[8:11], s22 offen offset:1024 sc1
  buffer_load_dwordx4 a[56:59], v2, s[8:11], s22 offen offset:2048 sc1
  buffer_load_dwordx4 a[60:63], v2, s[8:11], s22 offen offset:3072 sc1
  s_add_u32 s22, s20, 16384
  buffer_load_dwordx4 a[64:67], v2, s[8:11], s22 offen offset:0 sc1
  buffer_load_dwordx4 a[68:71], v2, s[8:11], s22 offen offset:1024 sc1
  buffer_load_dwordx4 a[72:75], v2, s[8:11], s22 offen offset:2048 sc1
  buffer_load_dwordx4 a[76:79], v2, s[8:11], s22 offen offset:3072 sc1
  s_add_u32 s22, s20, 20480
  buffer_load_dwordx4 a[80:83], v2, s[8:11], s22 offen offset:0 sc1
  buffer_load_dwordx4 a[84:87], v2, s[8:11], s22 offen offset:1024 sc1
  buffer_load_dwordx4 a[88:91], v2, s[8:11], s22 offen offset:2048 sc1
  buffer_load_dwordx4 a[92:95], v2, s[8:11], s22 offen offset:3072 sc1
  s_add_u32 s22, s20, 24576
  buffer_load_dwordx4 a[96:99], v2, s[8:11], s22 offen offset:0 sc1
  buffer_load_dwordx4 a[100:103], v2, s[8:11], s22 offen offset:1024 sc1
  buffer_load_dwordx4 a[104:107], v2, s[8:11], s22 offen offset:2048 sc1
  buffer_load_dwordx4 a[108:111], v2, s[8:11], s22 offen offset:3072 sc1
  s_add_u32 s22, s20, 28672
  buffer_load_dwordx4 a[112:115], v2, s[8:11], s22 offen offset:0 sc1
  buffer_load_dwordx4 a[116:119], v2, s[8:11], s22 offen offset:1024 sc1
  buffer_load_dwordx4 a[120:123], v2, s[8:11], s22 offen offset:2048 sc1
  buffer_load_dwordx4 a[124:127], v2, s[8:11], s22 offen offset:3072 sc1
  s_waitcnt vmcnt(24)
  s_add_u32 s22, s20, 32768
  buffer_load_dwordx4 a[128:131], v2, s[8:11], s22 offen offset:0 sc1
  buffer_load_dwordx4 a[132:135], v2, s[8:11], s22 offen offset:1024 sc1
  buffer_load_dwordx4 a[136:139], v2, s[8:11], s22 offen offset:2048 sc1
  buffer_load_dwordx4 a[140:143], v2, s[8:11], s22 offen offset:3072 sc1
  s_add_u32 s22, s20, 36864
  buffer_load_dwordx4 a[144:147], v2, s[8:11], s22 offen offset:0 sc1
  buffer_load_dwordx4 a[148:151], v2, s[8:11], s22 offen offset:1024 sc1
  buffer_load_dwordx4 a[152:155], v2, s[8:11], s22 offen offset:2048 sc1
  buffer_load_dwordx4 a[156:159], v2, s[8:11], s22 offen offset:3072 sc1
  s_add_u32 s22, s20, 40960
  buffer_load_dwordx4 a[160:163], v2, s[8:11], s22 offen offset:0 sc1
  buffer_load_dwordx4 a[164:167], v2, s[8:11], s22 offen offset:1024 sc1
  buffer_load_dwordx4 a[168:171], v2, s[8:11], s22 offen offset:2048 sc1
  buffer_load_dwordx4 a[172:175], v2, s[8:11], s22 offen offset:3072 sc1
  s_add_u32 s22, s20, 45056
  buffer_load_dwordx4 a[176:179], v2, s[8:11], s22 offen offset:0 sc1
  buffer_load_dwordx4 a[180:183], v2, s[8:11], s22 offen offset:1024 sc1
  buffer_load_dwordx4 a[184:187], v2, s[8:11], s22 offen offset:2048 sc1
  buffer_load_dwordx4 a[188:191], v2, s[8:11], s22 offen offset:3072 sc1
  s_add_u32 s22, s20, 49152
  buffer_load_dwordx4 a[192:195], v2, s[8:11], s22 offen offset:0 sc1
  buffer_load_dwordx4 a[196:199], v2, s[8:11], s22 offen offset:1024 sc1
  buffer_load_dwordx4 a[200:203], v2, s[8:11], s22 offen offset:2048 sc1
  buffer_load_dwordx4 a[204:207], v2, s[8:11], s22 offen offset:3072 sc1
  s_add_u32 s22, s20, 53248
  buffer_load_dwordx4 a[208:211], v2, s[8:11], s22 offen offset:0 sc1
  buffer_load_dwordx4 a[212:215], v2, s[8:11], s22 offen offset:1024 sc1
  buffer_load_dwordx4 a[216:219], v2, s[8:11], s22 offen offset:2048 sc1
  buffer_load_dwordx4 a[220:223], v2, s[8:11], s22 offen offset:3072 sc1
  s_add_u32 s22, s20, 57344
  buffer_load_dwordx4 a[224:227], v2, s[8:11], s22 offen offset:0 sc1
  buffer_load_dwordx4 a[228:231], v2, s[8:11], s22 offen offset:1024 sc1
  buffer_load_dwordx4 a[232:235], v2, s[8:11], s22 offen offset:2048 sc1
  buffer_load_dwordx4 a[236:239], v2, s[8:11], s22 offen offset:3072 sc1
  s_add_u32 s22, s20, 61440
  buffer_load_dwordx4 a[240:243], v2, s[8:11], s22 offen offset:0 sc1
  buffer_load_dwordx4 a[244:247], v2, s[8:11], s22 offen offset:1024 sc1
  buffer_load_dwordx4 a[248:251], v2, s[8:11], s22 offen offset:2048 sc1
  buffer_load_dwordx4 a[252:255], v2, s[8:11], s22 offen offset:3072 sc1
  s_waitcnt vmcnt(24)
  s_add_u32 s22, s20, 65536
  buffer_load_dwordx4 v[120:123], v2, s[8:11], s22 offen offset:0 sc1
  buffer_load_dwordx4 v[124:127], v2, s[8:11], s22 offen offset:1024 sc1
  buffer_load_dwordx4 v[128:131], v2, s[8:11], s22 offen offset:2048 sc1
  buffer_load_dwordx4 v[132:135], v2, s[8:11], s22 offen offset:3072 sc1
  s_add_u32 s22, s20, 69632
  buffer_load_dwordx4 v[136:139], v2, s[8:11], s22 offen offset:0 sc1
  buffer_load_dwordx4 v[140:143], v2, s[8:11], s22 offen offset:1024 sc1
  buffer_load_dwordx4 v[144:147], v2, s[8:11], s22 offen offset:2048 sc1
  buffer_load_dwordx4 v[148:151], v2, s[8:11], s22 offen offset:3072 sc1
  s_add_u32 s22, s20, 73728
  buffer_load_dwordx4 v[152:155], v2, s[8:11], s22 offen offset:0 sc1
  buffer_load_dwordx4 v[156:159], v2, s[8:11], s22 offen offset:1024 sc1
  buffer_load_dwordx4 v[160:163], v2, s[8:11], s22 offen offset:2048 sc1
  buffer_load_dwordx4 v[164:167], v2, s[8:11], s22 offen offset:3072 sc1
  s_add_u32 s22, s20, 77824
  buffer_load_dwordx4 v[168:171], v2, s[8:11], s22 offen offset:0 sc1
  buffer_load_dwordx4 v[172:175], v2, s[8:11], s22 offen offset:1024 sc1
  buffer_load_dwordx4 v[176:179], v2, s[8:11], s22 offen offset:2048 sc1
  buffer_load_dwordx4 v[180:183], v2, s[8:11], s22 offen offset:3072 sc1
  s_add_u32 s22, s20, 81920
  buffer_load_dwordx4 v[184:187], v2, s[8:11], s22 offen offset:0 sc1
  buffer_load_dwordx4 v[188:191], v2, s[8:11], s22 offen offset:1024 sc1
  buffer_load_dwordx4 v[192:195], v2, s[8:11], s22 offen offset:2048 sc1
  buffer_load_dwordx4 v[196:199], v2, s[8:11], s22 offen offset:3072 sc1
  s_add_u32 s22, s20, 86016
  buffer_load_dwordx4 v[200:203], v2, s[8:11], s22 offen offset:0 sc1
  buffer_load_dwordx4 v[204:207], v2, s[8:11], s22 offen offset:1024 sc1
  buffer_load_dwordx4 v[208:211], v2, s[8:11], s22 offen offset:2048 sc1
  buffer_load_dwordx4 v[212:215], v2, s[8:11], s22 offen offset:3072 sc1
  s_add_u32 s22, s20, 90112
  buffer_load_dwordx4 v[216:219], v2, s[8:11], s22 offen offset:0 sc1
  buffer_load_dwordx4 v[220:223], v2, s[8:11], s22 offen offset:1024 sc1
  buffer_load_dwordx4 v[224:227], v2, s[8:11], s22 offen offset:2048 sc1
  buffer_load_dwordx4 v[228:231], v2, s[8:11], s22 offen offset:3072 sc1
  s_add_u32 s22, s20, 94208
  buffer_load_dwordx4 v[232:235], v2, s[8:11], s22 offen offset:0 sc1
  buffer_load_dwordx4 v[236:239], v2, s[8:11], s22 offen offset:1024 sc1
  buffer_load_dwordx4 v[240:243], v2, s[8:11], s22 offen offset:2048 sc1
  buffer_load_dwordx4 v[244:247], v2, s[8:11], s22 offen offset:3072 sc1
  s_waitcnt vmcnt(24)
  s_add_u32 s22, s20, 98304
  buffer_load_dwordx4 v[248:251], v2, s[8:11], s22 offen offset:0 sc1
  buffer_load_dwordx4 v[252:255], v2, s[8:11], s22 offen offset:1024 sc1
  v_mov_b32 v5, 0x4444
  v_mov_b32 v6, 0xeeee
  v_cmp_lt_u32 vcc, 7, v4
  s_nop 1
  v_cndmask_b32 v5, v5, v6, vcc
  s_lshl_b32 s23, s16, 11
  v_lshrrev_b32 v80, 1, v3
  v_and_b32 v81, 1, v3
  v_add_u32 v82, 0, v80
  v_lshl_add_u32 v82, v82, 4, v4
  v_mul_u32_u24 v83, 2341, v82
  v_lshrrev_b32 v83, 16, v83
  v_mul_u32_u24 v84, 28, v83
  v_sub_u32 v84, v82, v84
  v_lshrrev_b32 v85, 4, v84
  v_and_b32 v84, 15, v84
  v_lshlrev_b32 v86, 10, v85
  v_lshl_add_u32 v86, v83, 8, v86
  v_lshl_add_u32 v86, v84, 4, v86
  v_lshl_add_u32 v86, v81, 3, v86
  v_add_u32 v72, s23, v86
  v_add_u32 v82, 2, v80
  v_lshl_add_u32 v82, v82, 4, v4
  v_mul_u32_u24 v83, 2341, v82
  v_lshrrev_b32 v83, 16, v83
  v_mul_u32_u24 v84, 28, v83
  v_sub_u32 v84, v82, v84
  v_lshrrev_b32 v85, 4, v84
  v_and_b32 v84, 15, v84
  v_lshlrev_b32 v86, 10, v85
  v_lshl_add_u32 v86, v83, 8, v86
  v_lshl_add_u32 v86, v84, 4, v86
  v_lshl_add_u32 v86, v81, 3, v86
  v_add_u32 v73, s23, v86
  v_add_u32 v82, 4, v80
  v_lshl_add_u32 v82, v82, 4, v4
  v_mul_u32_u24 v83, 2341, v82
  v_lshrrev_b32 v83, 16, v83
  v_mul_u32_u24 v84, 28, v83
  v_sub_u32 v84, v82, v84
  v_lshrrev_b32 v85, 4, v84
  v_and_b32 v84, 15, v84
  v_lshlrev_b32 v86, 10, v85
  v_lshl_add_u32 v86, v83, 8, v86
  v_lshl_add_u32 v86, v84, 4, v86
  v_lshl_add_u32 v86, v81, 3, v86
  v_add_u32 v74, s23, v86
  v_mov_b32 v82, 6
  v_lshl_add_u32 v82, v82, 4, v4
  v_mul_u32_u24 v83, 2341, v82
  v_lshrrev_b32 v83, 16, v83
  v_mul_u32_u24 v84, 28, v83
  v_sub_u32 v84, v82, v84
  v_lshrrev_b32 v85, 4, v84
  v_and_b32 v84, 15, v84
  v_lshlrev_b32 v86, 10, v85
  v_lshl_add_u32 v86, v83, 8, v86
  v_lshl_add_u32 v86, v84, 4, v86
  v_lshl_add_u32 v86, v81, 3, v86
  v_add_u32 v75, s23, v86
  v_add_u32 v76, s23, v2
  s_mul_i32 s27, s18, 448
  v_mov_b32 v77, s27
  v_mov_b32 v78, 1
  s_mov_b32 s17, s19
  s_mul_i32 s24, s19, 7168
  s_add_u32 s24, s24, 88002560
  s_mul_i32 s25, s18, 65
  s_add_u32 s25, s25, s19
  s_lshl_b32 s25, s25, 13
  s_add_u32 s25, s25, s23
  s_add_u32 s25, s25, 76869632
  s_lshl_b32 s26, s18, 6
  s_add_u32 s26, s26, s19
  s_lshl_b32 s26, s26, 4
  s_lshl_b32 s27, s16, 2
  s_add_u32 s26, s26, s27
  s_add_u32 s26, s26, 88502272
  v_mov_b32 v88, 0
  v_mov_b32 v89, 0
  v_mov_b32 v90, 0
  v_mov_b32 v91, 0
  v_mov_b32 v92, -1
  v_mov_b32 v93, -1
  v_mov_b32 v94, -1
  v_mov_b32 v95, -1
  ds_write_b128 v76, v[88:91]
  ds_write_b128 v76, v[88:91] offset:1024
  s_branch ws_arm
ws_loop:
  v_mov_b32 v36, 0
  v_mov_b32 v37, 0
  v_mov_b32 v38, 0
  v_mov_b32 v39, 0
  v_mov_b32 v40, 0
  v_mov_b32 v41, 0
  v_mov_b32 v42, 0
  v_mov_b32 v43, 0
  v_mov_b32 v44, 0
  v_mov_b32 v45, 0
  v_mov_b32 v46, 0
  v_mov_b32 v47, 0
  v_mov_b32 v48, 0
  v_mov_b32 v49, 0
  v_mov_b32 v50, 0
  v_mov_b32 v51, 0
  v_mov_b32 v52, 0
  v_mov_b32 v53, 0
  v_mov_b32 v54, 0
  v_mov_b32 v55, 0
  v_mov_b32 v56, 0
  v_mov_b32 v57, 0
  v_mov_b32 v58, 0
  v_mov_b32 v59, 0
  v_mov_b32 v60, 0
  v_mov_b32 v61, 0
  v_mov_b32 v62, 0
  v_mov_b32 v63, 0
  s_mov_b32 s30, 0
  s_branch ws_fl
ws_pm:
  s_cmp_ge_u32 s17, 64
  s_cbranch_scc1 ws_fl
  buffer_load_dword v79, v77, s[8:11], s24 offen sc1
  s_waitcnt vmcnt(0)
  v_cmp_eq_u32 vcc, -1, v79
  s_cbranch_vccnz ws_pr
ws_fl:
  s_add_u32 s22, s24, 4096
  buffer_load_dwordx4 v[8:11], v2, s[8:11], s24 offen offset:0 sc1
  buffer_load_dwordx4 v[12:15], v2, s[8:11], s24 offen offset:1024 sc1
  buffer_load_dwordx4 v[16:19], v2, s[8:11], s24 offen offset:2048 sc1
  buffer_load_dwordx4 v[20:23], v2, s[8:11], s24 offen offset:3072 sc1
  buffer_load_dwordx4 v[24:27], v2, s[8:11], s22 offen offset:0 sc1
  buffer_load_dwordx4 v[28:31], v2, s[8:11], s22 offen offset:1024 sc1
  buffer_load_dwordx4 v[32:35], v2, s[8:11], s22 offen offset:2048 sc1
  s_waitcnt vmcnt(0)
  v_max_u32 v79, v8, v9
  v_max3_u32 v79, v79, v10, v11
  v_max3_u32 v79, v79, v12, v13
  v_max3_u32 v79, v79, v14, v15
  v_max3_u32 v79, v79, v16, v17
  v_max3_u32 v79, v79, v18, v19
  v_max3_u32 v79, v79, v20, v21
  v_max3_u32 v79, v79, v22, v23
  v_max3_u32 v79, v79, v24, v25
  v_max3_u32 v79, v79, v26, v27
  v_max3_u32 v79, v79, v28, v29
  v_max3_u32 v79, v79, v30, v31
  v_max3_u32 v79, v79, v32, v33
  v_max3_u32 v79, v79, v34, v35
  v_cmp_eq_u32 vcc, -1, v79
  s_cbranch_vccz ws_pk
ws_pr:
  s_sleep 6
  s_add_u32 s30, s30, 1
  s_cmp_lt_u32 s30, 2000000
  s_cbranch_scc1 ws_pm
  s_branch cA_abort
ws_pk:
  v_smfmac_f32_16x16x64_bf16 v[36:39], v[8:11], a[0:7], v5
  v_smfmac_f32_16x16x64_bf16 v[36:39], v[12:15], a[8:15], v5
  v_smfmac_f32_16x16x64_bf16 v[36:39], v[16:19], a[16:23], v5
  v_smfmac_f32_16x16x64_bf16 v[36:39], v[20:23], a[24:31], v5
  v_smfmac_f32_16x16x64_bf16 v[36:39], v[24:27], a[32:39], v5
  v_smfmac_f32_16x16x64_bf16 v[36:39], v[28:31], a[40:47], v5
  v_smfmac_f32_16x16x64_bf16 v[36:39], v[32:35], a[48:55], v5
  v_smfmac_f32_16x16x64_bf16 v[40:43], v[8:11], a[56:63], v5
  v_smfmac_f32_16x16x64_bf16 v[40:43], v[12:15], a[64:71], v5
  v_smfmac_f32_16x16x64_bf16 v[40:43], v[16:19], a[72:79], v5
  v_smfmac_f32_16x16x64_bf16 v[40:43], v[20:23], a[80:87], v5
  v_smfmac_f32_16x16x64_bf16 v[40:43], v[24:27], a[88:95], v5
  v_smfmac_f32_16x16x64_bf16 v[40:43], v[28:31], a[96:103], v5
  v_smfmac_f32_16x16x64_bf16 v[40:43], v[32:35], a[104:111], v5
  v_smfmac_f32_16x16x64_bf16 v[44:47], v[8:11], a[112:119], v5
  v_smfmac_f32_16x16x64_bf16 v[44:47], v[12:15], a[120:127], v5
  v_smfmac_f32_16x16x64_bf16 v[44:47], v[16:19], a[128:135], v5
  v_smfmac_f32_16x16x64_bf16 v[44:47], v[20:23], a[136:143], v5
  v_smfmac_f32_16x16x64_bf16 v[44:47], v[24:27], a[144:151], v5
  v_smfmac_f32_16x16x64_bf16 v[44:47], v[28:31], a[152:159], v5
  v_smfmac_f32_16x16x64_bf16 v[44:47], v[32:35], a[160:167], v5
  v_smfmac_f32_16x16x64_bf16 v[48:51], v[8:11], a[168:175], v5
  v_smfmac_f32_16x16x64_bf16 v[48:51], v[12:15], a[176:183], v5
  v_smfmac_f32_16x16x64_bf16 v[48:51], v[16:19], a[184:191], v5
  v_smfmac_f32_16x16x64_bf16 v[48:51], v[20:23], a[192:199], v5
  v_smfmac_f32_16x16x64_bf16 v[48:51], v[24:27], a[200:207], v5
  v_smfmac_f32_16x16x64_bf16 v[48:51], v[28:31], a[208:215], v5
  v_smfmac_f32_16x16x64_bf16 v[48:51], v[32:35], a[216:223], v5
  v_smfmac_f32_16x16x64_bf16 v[52:55], v[8:11], a[224:231], v5
  v_smfmac_f32_16x16x64_bf16 v[52:55], v[12:15], a[232:239], v5
  v_smfmac_f32_16x16x64_bf16 v[52:55], v[16:19], a[240:247], v5
  v_smfmac_f32_16x16x64_bf16 v[52:55], v[20:23], a[248:255], v5
  v_smfmac_f32_16x16x64_bf16 v[52:55], v[24:27], v[120:127], v5
  v_smfmac_f32_16x16x64_bf16 v[52:55], v[28:31], v[128:135], v5
  v_smfmac_f32_16x16x64_bf16 v[52:55], v[32:35], v[136:143], v5
  v_smfmac_f32_16x16x64_bf16 v[56:59], v[8:11], v[144:151], v5
  v_smfmac_f32_16x16x64_bf16 v[56:59], v[12:15], v[152:159], v5
  v_smfmac_f32_16x16x64_bf16 v[56:59], v[16:19], v[160:167], v5
  v_smfmac_f32_16x16x64_bf16 v[56:59], v[20:23], v[168:175], v5
  v_smfmac_f32_16x16x64_bf16 v[56:59], v[24:27], v[176:183], v5
  v_smfmac_f32_16x16x64_bf16 v[56:59], v[28:31], v[184:191], v5
  v_smfmac_f32_16x16x64_bf16 v[56:59], v[32:35], v[192:199], v5
  v_smfmac_f32_16x16x64_bf16 v[60:63], v[8:11], v[200:207], v5
  v_smfmac_f32_16x16x64_bf16 v[60:63], v[12:15], v[208:215], v5
  v_smfmac_f32_16x16x64_bf16 v[60:63], v[16:19], v[216:223], v5
  v_smfmac_f32_16x16x64_bf16 v[60:63], v[20:23], v[224:231], v5
  v_smfmac_f32_16x16x64_bf16 v[60:63], v[24:27], v[232:239], v5
  v_smfmac_f32_16x16x64_bf16 v[60:63], v[28:31], v[240:247], v5
  v_smfmac_f32_16x16x64_bf16 v[60:63], v[32:35], v[248:255], v5
  v_permlane32_swap_b32 v36, v40
  v_permlane32_swap_b32 v37, v41
  v_permlane32_swap_b32 v38, v42
  v_permlane32_swap_b32 v39, v43
  v_add_f32 v36, v36, v40
  v_add_f32 v37, v37, v41
  v_add_f32 v38, v38, v42
  v_add_f32 v39, v39, v43
  v_cvt_pk_bf16_f32 v40, v36, v37
  v_cvt_pk_bf16_f32 v41, v38, v39
  v_min_u32 v40, -2, v40
  v_min_u32 v41, -2, v41
  ds_write_b64 v72, v[40:41]
  v_permlane32_swap_b32 v44, v48
  v_permlane32_swap_b32 v45, v49
  v_permlane32_swap_b32 v46, v50
  v_permlane32_swap_b32 v47, v51
  v_add_f32 v44, v44, v48
  v_add_f32 v45, v45, v49
  v_add_f32 v46, v46, v50
  v_add_f32 v47, v47, v51
  v_cvt_pk_bf16_f32 v48, v44, v45
  v_cvt_pk_bf16_f32 v49, v46, v47
  v_min_u32 v48, -2, v48
  v_min_u32 v49, -2, v49
  ds_write_b64 v73, v[48:49]
  v_permlane32_swap_b32 v52, v56
  v_permlane32_swap_b32 v53, v57
  v_permlane32_swap_b32 v54, v58
  v_permlane32_swap_b32 v55, v59
  v_add_f32 v52, v52, v56
  v_add_f32 v53, v53, v57
  v_add_f32 v54, v54, v58
  v_add_f32 v55, v55, v59
  v_cvt_pk_bf16_f32 v56, v52, v53
  v_cvt_pk_bf16_f32 v57, v54, v55
  v_min_u32 v56, -2, v56
  v_min_u32 v57, -2, v57
  ds_write_b64 v74, v[56:57]
  v_mov_b32 v64, v60
  v_mov_b32 v65, v61
  v_mov_b32 v66, v62
  v_mov_b32 v67, v63
  v_permlane32_swap_b32 v60, v64
  v_permlane32_swap_b32 v61, v65
  v_permlane32_swap_b32 v62, v66
  v_permlane32_swap_b32 v63, v67
  v_add_f32 v60, v60, v64
  v_add_f32 v61, v61, v65
  v_add_f32 v62, v62, v66
  v_add_f32 v63, v63, v67
  v_cvt_pk_bf16_f32 v64, v60, v61
  v_cvt_pk_bf16_f32 v65, v62, v63
  v_min_u32 v64, -2, v64
  v_min_u32 v65, -2, v65
  ds_write_b64 v75, v[64:65]
  s_waitcnt lgkmcnt(0)
  ds_read_b128 v[64:67], v76
  ds_read_b128 v[68:71], v76 offset:1024
  s_waitcnt lgkmcnt(0)
  buffer_store_dwordx4 v[64:67], v2, s[8:11], s25 offen sc1
  buffer_store_dwordx4 v[68:71], v2, s[8:11], s25 offen offset:1024 sc1
  s_add_u32 s24, s24, 14336
  s_add_u32 s25, s25, 16384
  s_add_u32 s26, s26, 32
  s_add_u32 s17, s17, 2
  s_cmp_ge_u32 s17, 64
  s_cbranch_scc1 ws_end
ws_arm:
  buffer_store_dwordx4 v[92:95], v2, s[8:11], s25 offen sc1
  buffer_store_dwordx4 v[92:95], v2, s[8:11], s25 offen offset:1024 sc1
  s_waitcnt vmcnt(0)
  s_mov_b64 exec, 1
  buffer_store_dword v78, v2, s[8:11], s26 offen sc1
  s_mov_b64 exec, -1
  s_branch ws_loop
ws_end:
  v_mov_b32 v250, 0
  s_branch wk_loop
wk_s4d:
  s_sub_u32 s3, s3, 640
  s_load_dwordx8 s[40:47], s[0:1], 0
  s_load_dwordx4 s[48:51], s[0:1], 32
  s_load_dwordx2 s[52:53], s[0:1], 48
  s_load_dwordx2 s[54:55], s[0:1], 112
  v_lshrrev_b32 v1, 6, v0
  s_nop 0
  v_readfirstlane_b32 s16, v1
  v_and_b32 v1, 63, v0
  v_lshrrev_b32 v3, 4, v1
  v_and_b32 v4, 15, v1
  s_mul_i32 s17, s16, 24576
  s_waitcnt lgkmcnt(0)
  s_mov_b32 s60, s40
  s_and_b32 s61, s41, 0xffff
  s_mov_b32 s62, 1835008
  s_mov_b32 s63, 0x20000
  s_mov_b32 s64, s42
  s_and_b32 s65, s43, 0xffff
  s_mov_b32 s66, 229376
  s_mov_b32 s67, 0x20000
  s_mov_b32 s68, s44
  s_and_b32 s69, s45, 0xffff
  s_mov_b32 s70, 229376
  s_mov_b32 s71, 0x20000
  s_mov_b32 s72, s46
  s_and_b32 s73, s47, 0xffff
  s_mov_b32 s74, 229376
  s_mov_b32 s75, 0x20000
  s_mov_b32 s76, s48
  s_and_b32 s77, s49, 0xffff
  s_mov_b32 s78, 229376
  s_mov_b32 s79, 0x20000
  s_mov_b32 s80, s50
  s_and_b32 s81, s51, 0xffff
  s_mov_b32 s82, 896
  s_mov_b32 s83, 0x20000
  s_mov_b32 s84, s52
  s_and_b32 s85, s53, 0xffff
  s_mov_b32 s86, 896
  s_mov_b32 s87, 0x20000
  s_mov_b32 s88, s54
  s_and_b32 s89, s55, 0xffff
  s_mov_b32 s90, 3670016
  s_mov_b32 s91, 0x20000
  v_lshlrev_b32 v5, 5, v1
  v_sub_u32 v5, 2047, v5
  s_add_u32 s18, s17, 13056
  v_subrev_u32 v6, 0, v5
  v_max_i32 v7, 0, v6
  v_cvt_f32_u32 v7, v7
  v_cvt_pk_bf16_f32 v8, v7, v7
  v_and_b32 v7, 0xffff0000, v8
  v_lshrrev_b32 v8, 23, v7
  v_subrev_u32 v8, 134, v8
  v_max_i32 v8, 0, v8
  v_cvt_u32_f32 v7, v7
  v_lshrrev_b32 v7, v8, v7
  v_lshl_add_u32 v7, v8, 8, v7
  v_lshl_add_u32 v200, v7, 2, s18
  v_subrev_u32 v6, 1, v5
  v_max_i32 v7, 0, v6
  v_cvt_f32_u32 v7, v7
  v_cvt_pk_bf16_f32 v8, v7, v7
  v_and_b32 v7, 0xffff0000, v8
  v_lshrrev_b32 v8, 23, v7
  v_subrev_u32 v8, 134, v8
  v_max_i32 v8, 0, v8
  v_cvt_u32_f32 v7, v7
  v_lshrrev_b32 v7, v8, v7
  v_lshl_add_u32 v7, v8, 8, v7
  v_lshl_add_u32 v201, v7, 2, s18
  v_subrev_u32 v6, 2, v5
  v_max_i32 v7, 0, v6
  v_cvt_f32_u32 v7, v7
  v_cvt_pk_bf16_f32 v8, v7, v7
  v_and_b32 v7, 0xffff0000, v8
  v_lshrrev_b32 v8, 23, v7
  v_subrev_u32 v8, 134, v8
  v_max_i32 v8, 0, v8
  v_cvt_u32_f32 v7, v7
  v_lshrrev_b32 v7, v8, v7
  v_lshl_add_u32 v7, v8, 8, v7
  v_lshl_add_u32 v202, v7, 2, s18
  v_subrev_u32 v6, 3, v5
  v_max_i32 v7, 0, v6
  v_cvt_f32_u32 v7, v7
  v_cvt_pk_bf16_f32 v8, v7, v7
  v_and_b32 v7, 0xffff0000, v8
  v_lshrrev_b32 v8, 23, v7
  v_subrev_u32 v8, 134, v8
  v_max_i32 v8, 0, v8
  v_cvt_u32_f32 v7, v7
  v_lshrrev_b32 v7, v8, v7
  v_lshl_add_u32 v7, v8, 8, v7
  v_lshl_add_u32 v203, v7, 2, s18
  v_subrev_u32 v6, 4, v5
  v_max_i32 v7, 0, v6
  v_cvt_f32_u32 v7, v7
  v_cvt_pk_bf16_f32 v8, v7, v7
  v_and_b32 v7, 0xffff0000, v8
  v_lshrrev_b32 v8, 23, v7
  v_subrev_u32 v8, 134, v8
  v_max_i32 v8, 0, v8
  v_cvt_u32_f32 v7, v7
  v_lshrrev_b32 v7, v8, v7
  v_lshl_add_u32 v7, v8, 8, v7
  v_lshl_add_u32 v204, v7, 2, s18
  v_subrev_u32 v6, 5, v5
  v_max_i32 v7, 0, v6
  v_cvt_f32_u32 v7, v7
  v_cvt_pk_bf16_f32 v8, v7, v7
  v_and_b32 v7, 0xffff0000, v8
  v_lshrrev_b32 v8, 23, v7
  v_subrev_u32 v8, 134, v8
  v_max_i32 v8, 0, v8
  v_cvt_u32_f32 v7, v7
  v_lshrrev_b32 v7, v8, v7
  v_lshl_add_u32 v7, v8, 8, v7
  v_lshl_add_u32 v205, v7, 2, s18
  v_subrev_u32 v6, 6, v5
  v_max_i32 v7, 0, v6
  v_cvt_f32_u32 v7, v7
  v_cvt_pk_bf16_f32 v8, v7, v7
  v_and_b32 v7, 0xffff0000, v8
  v_lshrrev_b32 v8, 23, v7
  v_subrev_u32 v8, 134, v8
  v_max_i32 v8, 0, v8
  v_cvt_u32_f32 v7, v7
  v_lshrrev_b32 v7, v8, v7
  v_lshl_add_u32 v7, v8, 8, v7
  v_lshl_add_u32 v206, v7, 2, s18
  v_subrev_u32 v6, 7, v5
  v_max_i32 v7, 0, v6
  v_cvt_f32_u32 v7, v7
  v_cvt_pk_bf16_f32 v8, v7, v7
  v_and_b32 v7, 0xffff0000, v8
  v_lshrrev_b32 v8, 23, v7
  v_subrev_u32 v8, 134, v8
  v_max_i32 v8, 0, v8
  v_cvt_u32_f32 v7, v7
  v_lshrrev_b32 v7, v8, v7
  v_lshl_add_u32 v7, v8, 8, v7
  v_lshl_add_u32 v207, v7, 2, s18
  v_subrev_u32 v6, 8, v5
  v_max_i32 v7, 0, v6
  v_cvt_f32_u32 v7, v7
  v_cvt_pk_bf16_f32 v8, v7, v7
  v_and_b32 v7, 0xffff0000, v8
  v_lshrrev_b32 v8, 23, v7
  v_subrev_u32 v8, 134, v8
  v_max_i32 v8, 0, v8
  v_cvt_u32_f32 v7, v7
  v_lshrrev_b32 v7, v8, v7
  v_lshl_add_u32 v7, v8, 8, v7
  v_lshl_add_u32 v208, v7, 2, s18
  v_subrev_u32 v6, 9, v5
  v_max_i32 v7, 0, v6
  v_cvt_f32_u32 v7, v7
  v_cvt_pk_bf16_f32 v8, v7, v7
  v_and_b32 v7, 0xffff0000, v8
  v_lshrrev_b32 v8, 23, v7
  v_subrev_u32 v8, 134, v8
  v_max_i32 v8, 0, v8
  v_cvt_u32_f32 v7, v7
  v_lshrrev_b32 v7, v8, v7
  v_lshl_add_u32 v7, v8, 8, v7
  v_lshl_add_u32 v209, v7, 2, s18
  v_subrev_u32 v6, 10, v5
  v_max_i32 v7, 0, v6
  v_cvt_f32_u32 v7, v7
  v_cvt_pk_bf16_f32 v8, v7, v7
  v_and_b32 v7, 0xffff0000, v8
  v_lshrrev_b32 v8, 23, v7
  v_subrev_u32 v8, 134, v8
  v_max_i32 v8, 0, v8
  v_cvt_u32_f32 v7, v7
  v_lshrrev_b32 v7, v8, v7
  v_lshl_add_u32 v7, v8, 8, v7
  v_lshl_add_u32 v210, v7, 2, s18
  v_subrev_u32 v6, 11, v5
  v_max_i32 v7, 0, v6
  v_cvt_f32_u32 v7, v7
  v_cvt_pk_bf16_f32 v8, v7, v7
  v_and_b32 v7, 0xffff0000, v8
  v_lshrrev_b32 v8, 23, v7
  v_subrev_u32 v8, 134, v8
  v_max_i32 v8, 0, v8
  v_cvt_u32_f32 v7, v7
  v_lshrrev_b32 v7, v8, v7
  v_lshl_add_u32 v7, v8, 8, v7
  v_lshl_add_u32 v211, v7, 2, s18
  v_subrev_u32 v6, 12, v5
  v_max_i32 v7, 0, v6
  v_cvt_f32_u32 v7, v7
  v_cvt_pk_bf16_f32 v8, v7, v7
  v_and_b32 v7, 0xffff0000, v8
  v_lshrrev_b32 v8, 23, v7
  v_subrev_u32 v8, 134, v8
  v_max_i32 v8, 0, v8
  v_cvt_u32_f32 v7, v7
  v_lshrrev_b32 v7, v8, v7
  v_lshl_add_u32 v7, v8, 8, v7
  v_lshl_add_u32 v212, v7, 2, s18
  v_subrev_u32 v6, 13, v5
  v_max_i32 v7, 0, v6
  v_cvt_f32_u32 v7, v7
  v_cvt_pk_bf16_f32 v8, v7, v7
  v_and_b32 v7, 0xffff0000, v8
  v_lshrrev_b32 v8, 23, v7
  v_subrev_u32 v8, 134, v8
  v_max_i32 v8, 0, v8
  v_cvt_u32_f32 v7, v7
  v_lshrrev_b32 v7, v8, v7
  v_lshl_add_u32 v7, v8, 8, v7
  v_lshl_add_u32 v213, v7, 2, s18
  v_subrev_u32 v6, 14, v5
  v_max_i32 v7, 0, v6
  v_cvt_f32_u32 v7, v7
  v_cvt_pk_bf16_f32 v8, v7, v7
  v_and_b32 v7, 0xffff0000, v8
  v_lshrrev_b32 v8, 23, v7
  v_subrev_u32 v8, 134, v8
  v_max_i32 v8, 0, v8
  v_cvt_u32_f32 v7, v7
  v_lshrrev_b32 v7, v8, v7
  v_lshl_add_u32 v7, v8, 8, v7
  v_lshl_add_u32 v214, v7, 2, s18
  v_subrev_u32 v6, 15, v5
  v_max_i32 v7, 0, v6
  v_cvt_f32_u32 v7, v7
  v_cvt_pk_bf16_f32 v8, v7, v7
  v_and_b32 v7, 0xffff0000, v8
  v_lshrrev_b32 v8, 23, v7
  v_subrev_u32 v8, 134, v8
  v_max_i32 v8, 0, v8
  v_cvt_u32_f32 v7, v7
  v_lshrrev_b32 v7, v8, v7
  v_lshl_add_u32 v7, v8, 8, v7
  v_lshl_add_u32 v215, v7, 2, s18
  v_subrev_u32 v6, 16, v5
  v_max_i32 v7, 0, v6
  v_cvt_f32_u32 v7, v7
  v_cvt_pk_bf16_f32 v8, v7, v7
  v_and_b32 v7, 0xffff0000, v8
  v_lshrrev_b32 v8, 23, v7
  v_subrev_u32 v8, 134, v8
  v_max_i32 v8, 0, v8
  v_cvt_u32_f32 v7, v7
  v_lshrrev_b32 v7, v8, v7
  v_lshl_add_u32 v7, v8, 8, v7
  v_lshl_add_u32 v216, v7, 2, s18
  v_subrev_u32 v6, 17, v5
  v_max_i32 v7, 0, v6
  v_cvt_f32_u32 v7, v7
  v_cvt_pk_bf16_f32 v8, v7, v7
  v_and_b32 v7, 0xffff0000, v8
  v_lshrrev_b32 v8, 23, v7
  v_subrev_u32 v8, 134, v8
  v_max_i32 v8, 0, v8
  v_cvt_u32_f32 v7, v7
  v_lshrrev_b32 v7, v8, v7
  v_lshl_add_u32 v7, v8, 8, v7
  v_lshl_add_u32 v217, v7, 2, s18
  v_subrev_u32 v6, 18, v5
  v_max_i32 v7, 0, v6
  v_cvt_f32_u32 v7, v7
  v_cvt_pk_bf16_f32 v8, v7, v7
  v_and_b32 v7, 0xffff0000, v8
  v_lshrrev_b32 v8, 23, v7
  v_subrev_u32 v8, 134, v8
  v_max_i32 v8, 0, v8
  v_cvt_u32_f32 v7, v7
  v_lshrrev_b32 v7, v8, v7
  v_lshl_add_u32 v7, v8, 8, v7
  v_lshl_add_u32 v218, v7, 2, s18
  v_subrev_u32 v6, 19, v5
  v_max_i32 v7, 0, v6
  v_cvt_f32_u32 v7, v7
  v_cvt_pk_bf16_f32 v8, v7, v7
  v_and_b32 v7, 0xffff0000, v8
  v_lshrrev_b32 v8, 23, v7
  v_subrev_u32 v8, 134, v8
  v_max_i32 v8, 0, v8
  v_cvt_u32_f32 v7, v7
  v_lshrrev_b32 v7, v8, v7
  v_lshl_add_u32 v7, v8, 8, v7
  v_lshl_add_u32 v219, v7, 2, s18
  v_subrev_u32 v6, 20, v5
  v_max_i32 v7, 0, v6
  v_cvt_f32_u32 v7, v7
  v_cvt_pk_bf16_f32 v8, v7, v7
  v_and_b32 v7, 0xffff0000, v8
  v_lshrrev_b32 v8, 23, v7
  v_subrev_u32 v8, 134, v8
  v_max_i32 v8, 0, v8
  v_cvt_u32_f32 v7, v7
  v_lshrrev_b32 v7, v8, v7
  v_lshl_add_u32 v7, v8, 8, v7
  v_lshl_add_u32 v220, v7, 2, s18
  v_subrev_u32 v6, 21, v5
  v_max_i32 v7, 0, v6
  v_cvt_f32_u32 v7, v7
  v_cvt_pk_bf16_f32 v8, v7, v7
  v_and_b32 v7, 0xffff0000, v8
  v_lshrrev_b32 v8, 23, v7
  v_subrev_u32 v8, 134, v8
  v_max_i32 v8, 0, v8
  v_cvt_u32_f32 v7, v7
  v_lshrrev_b32 v7, v8, v7
  v_lshl_add_u32 v7, v8, 8, v7
  v_lshl_add_u32 v221, v7, 2, s18
  v_subrev_u32 v6, 22, v5
  v_max_i32 v7, 0, v6
  v_cvt_f32_u32 v7, v7
  v_cvt_pk_bf16_f32 v8, v7, v7
  v_and_b32 v7, 0xffff0000, v8
  v_lshrrev_b32 v8, 23, v7
  v_subrev_u32 v8, 134, v8
  v_max_i32 v8, 0, v8
  v_cvt_u32_f32 v7, v7
  v_lshrrev_b32 v7, v8, v7
  v_lshl_add_u32 v7, v8, 8, v7
  v_lshl_add_u32 v222, v7, 2, s18
  v_subrev_u32 v6, 23, v5
  v_max_i32 v7, 0, v6
  v_cvt_f32_u32 v7, v7
  v_cvt_pk_bf16_f32 v8, v7, v7
  v_and_b32 v7, 0xffff0000, v8
  v_lshrrev_b32 v8, 23, v7
  v_subrev_u32 v8, 134, v8
  v_max_i32 v8, 0, v8
  v_cvt_u32_f32 v7, v7
  v_lshrrev_b32 v7, v8, v7
  v_lshl_add_u32 v7, v8, 8, v7
  v_lshl_add_u32 v223, v7, 2, s18
  v_subrev_u32 v6, 24, v5
  v_max_i32 v7, 0, v6
  v_cvt_f32_u32 v7, v7
  v_cvt_pk_bf16_f32 v8, v7, v7
  v_and_b32 v7, 0xffff0000, v8
  v_lshrrev_b32 v8, 23, v7
  v_subrev_u32 v8, 134, v8
  v_max_i32 v8, 0, v8
  v_cvt_u32_f32 v7, v7
  v_lshrrev_b32 v7, v8, v7
  v_lshl_add_u32 v7, v8, 8, v7
  v_lshl_add_u32 v224, v7, 2, s18
  v_subrev_u32 v6, 25, v5
  v_max_i32 v7, 0, v6
  v_cvt_f32_u32 v7, v7
  v_cvt_pk_bf16_f32 v8, v7, v7
  v_and_b32 v7, 0xffff0000, v8
  v_lshrrev_b32 v8, 23, v7
  v_subrev_u32 v8, 134, v8
  v_max_i32 v8, 0, v8
  v_cvt_u32_f32 v7, v7
  v_lshrrev_b32 v7, v8, v7
  v_lshl_add_u32 v7, v8, 8, v7
  v_lshl_add_u32 v225, v7, 2, s18
  v_subrev_u32 v6, 26, v5
  v_max_i32 v7, 0, v6
  v_cvt_f32_u32 v7, v7
  v_cvt_pk_bf16_f32 v8, v7, v7
  v_and_b32 v7, 0xffff0000, v8
  v_lshrrev_b32 v8, 23, v7
  v_subrev_u32 v8, 134, v8
  v_max_i32 v8, 0, v8
  v_cvt_u32_f32 v7, v7
  v_lshrrev_b32 v7, v8, v7
  v_lshl_add_u32 v7, v8, 8, v7
  v_lshl_add_u32 v226, v7, 2, s18
  v_subrev_u32 v6, 27, v5
  v_max_i32 v7, 0, v6
  v_cvt_f32_u32 v7, v7
  v_cvt_pk_bf16_f32 v8, v7, v7
  v_and_b32 v7, 0xffff0000, v8
  v_lshrrev_b32 v8, 23, v7
  v_subrev_u32 v8, 134, v8
  v_max_i32 v8, 0, v8
  v_cvt_u32_f32 v7, v7
  v_lshrrev_b32 v7, v8, v7
  v_lshl_add_u32 v7, v8, 8, v7
  v_lshl_add_u32 v227, v7, 2, s18
  v_subrev_u32 v6, 28, v5
  v_max_i32 v7, 0, v6
  v_cvt_f32_u32 v7, v7
  v_cvt_pk_bf16_f32 v8, v7, v7
  v_and_b32 v7, 0xffff0000, v8
  v_lshrrev_b32 v8, 23, v7
  v_subrev_u32 v8, 134, v8
  v_max_i32 v8, 0, v8
  v_cvt_u32_f32 v7, v7
  v_lshrrev_b32 v7, v8, v7
  v_lshl_add_u32 v7, v8, 8, v7
  v_lshl_add_u32 v228, v7, 2, s18
  v_subrev_u32 v6, 29, v5
  v_max_i32 v7, 0, v6
  v_cvt_f32_u32 v7, v7
  v_cvt_pk_bf16_f32 v8, v7, v7
  v_and_b32 v7, 0xffff0000, v8
  v_lshrrev_b32 v8, 23, v7
  v_subrev_u32 v8, 134, v8
  v_max_i32 v8, 0, v8
  v_cvt_u32_f32 v7, v7
  v_lshrrev_b32 v7, v8, v7
  v_lshl_add_u32 v7, v8, 8, v7
  v_lshl_add_u32 v229, v7, 2, s18
  v_subrev_u32 v6, 30, v5
  v_max_i32 v7, 0, v6
  v_cvt_f32_u32 v7, v7
  v_cvt_pk_bf16_f32 v8, v7, v7
  v_and_b32 v7, 0xffff0000, v8
  v_lshrrev_b32 v8, 23, v7
  v_subrev_u32 v8, 134, v8
  v_max_i32 v8, 0, v8
  v_cvt_u32_f32 v7, v7
  v_lshrrev_b32 v7, v8, v7
  v_lshl_add_u32 v7, v8, 8, v7
  v_lshl_add_u32 v230, v7, 2, s18
  v_subrev_u32 v6, 31, v5
  v_max_i32 v7, 0, v6
  v_cvt_f32_u32 v7, v7
  v_cvt_pk_bf16_f32 v8, v7, v7
  v_and_b32 v7, 0xffff0000, v8
  v_lshrrev_b32 v8, 23, v7
  v_subrev_u32 v8, 134, v8
  v_max_i32 v8, 0, v8
  v_cvt_u32_f32 v7, v7
  v_lshrrev_b32 v7, v8, v7
  v_lshl_add_u32 v7, v8, 8, v7
  v_lshl_add_u32 v231, v7, 2, s18
  v_subrev_u32 v6, 32, v5
  v_max_i32 v7, 0, v6
  v_cvt_f32_u32 v7, v7
  v_cvt_pk_bf16_f32 v8, v7, v7
  v_and_b32 v7, 0xffff0000, v8
  v_lshrrev_b32 v8, 23, v7
  v_subrev_u32 v8, 134, v8
  v_max_i32 v8, 0, v8
  v_cvt_u32_f32 v7, v7
  v_lshrrev_b32 v7, v8, v7
  v_lshl_add_u32 v7, v8, 8, v7
  v_mov_b32 v8, 1280
  v_cmp_gt_i32 vcc, 0, v6
  s_nop 1
  v_cndmask_b32 v7, v7, v8, vcc
  v_lshl_add_u32 v232, v7, 2, s18
  v_mov_b32 v8, 0
  v_mov_b32 v9, 0
  v_lshlrev_b32 v5, 3, v1
  v_add_u32 v5, s17, v5
  ds_write_b64 v5, v[8:9]
  v_and_b32 v6, 15, v1
  v_lshlrev_b32 v6, 3, v6
  v_add_u32 v6, s17, v6
  ds_write_b64 v6, v[8:9] offset:8704
  ds_write_b64 v6, v[8:9] offset:12928
  v_mov_b32 v6, s17
  ds_write_b64 v6, v[8:9] offset:18176
  s_lshl_b32 s19, s3, 2
  s_add_u32 s20, s19, s16
  s_lshl_b32 s21, s3, 3
  v_mul_u32_u24 v5, 3584, v0
  s_add_u32 s22, s21, 0
  buffer_load_dwordx2 v[8:9], v5, s[60:63], s22 offen offset:0
  buffer_load_dwordx2 v[10:11], v5, s[60:63], s22 offen offset:896
  buffer_load_dwordx2 v[12:13], v5, s[60:63], s22 offen offset:1792
  buffer_load_dwordx2 v[14:15], v5, s[60:63], s22 offen offset:2688
  s_add_u32 s22, s21, 917504
  buffer_load_dwordx2 v[16:17], v5, s[60:63], s22 offen offset:0
  buffer_load_dwordx2 v[18:19], v5, s[60:63], s22 offen offset:896
  buffer_load_dwordx2 v[20:21], v5, s[60:63], s22 offen offset:1792
  buffer_load_dwordx2 v[22:23], v5, s[60:63], s22 offen offset:2688
  s_lshl_b32 s22, s20, 9
  v_lshlrev_b32 v6, 3, v1
  buffer_load_dwordx2 v[24:25], v6, s[64:67], s22 offen
  buffer_load_dwordx2 v[26:27], v6, s[68:71], s22 offen
  buffer_load_dwordx2 v[28:29], v6, s[72:75], s22 offen
  buffer_load_dwordx2 v[30:31], v6, s[76:79], s22 offen
  s_lshl_b32 s22, s20, 1
  v_mov_b32 v7, 0
  buffer_load_ushort v32, v7, s[80:83], s22 offen
  buffer_load_ushort v33, v7, s[84:87], s22 offen
  s_mov_b32 s24, 0x05040100
  s_mov_b32 s25, 0x07060302
  s_barrier
  s_waitcnt vmcnt(6)
  v_lshlrev_b32 v6, 3, v0
  v_perm_b32 v34, v10, v8, s24
  v_perm_b32 v35, v14, v12, s24
  v_add_u32 v36, 512, v6
  ds_write_b64 v36, v[34:35]
  v_perm_b32 v34, v10, v8, s25
  v_perm_b32 v35, v14, v12, s25
  v_add_u32 v36, 25088, v6
  ds_write_b64 v36, v[34:35]
  v_perm_b32 v34, v11, v9, s24
  v_perm_b32 v35, v15, v13, s24
  v_add_u32 v36, 49664, v6
  ds_write_b64 v36, v[34:35]
  v_perm_b32 v34, v11, v9, s25
  v_perm_b32 v35, v15, v13, s25
  v_add_u32 v36, 74240, v6
  ds_write_b64 v36, v[34:35]
  v_perm_b32 v34, v18, v16, s24
  v_perm_b32 v35, v22, v20, s24
  v_add_u32 v36, 2560, v6
  ds_write_b64 v36, v[34:35]
  v_perm_b32 v34, v18, v16, s25
  v_perm_b32 v35, v22, v20, s25
  v_add_u32 v36, 27136, v6
  ds_write_b64 v36, v[34:35]
  v_perm_b32 v34, v19, v17, s24
  v_perm_b32 v35, v23, v21, s24
  v_add_u32 v36, 51712, v6
  ds_write_b64 v36, v[34:35]
  v_perm_b32 v34, v19, v17, s25
  v_perm_b32 v35, v23, v21, s25
  v_add_u32 v36, 76288, v6
  ds_write_b64 v36, v[34:35]
  s_waitcnt vmcnt(0)
  s_mov_b32 s26, 1069066811
  s_mov_b32 s27, 1042479491
  v_lshlrev_b32 v32, 16, v32
  v_lshlrev_b32 v33, 16, v33
  v_mul_f32 v32, s26, v32
  v_exp_f32 v32, v32
  s_nop 0
  v_cvt_pk_bf16_f32 v34, v32, v32
  v_and_b32 v32, 0xffff0000, v34
  v_lshlrev_b32 v37, 6, v1
  v_add_u32 v37, s17, v37
  v_lshlrev_b32 v40, 16, v24
  v_lshlrev_b32 v41, 16, v26
  v_lshlrev_b32 v42, 16, v28
  v_lshlrev_b32 v43, 16, v30
  v_mul_f32 v40, s26, v40
  v_exp_f32 v40, v40
  s_nop 0
  v_cvt_pk_bf16_f32 v34, v40, v40
  v_and_b32 v40, 0xffff0000, v34
  v_mul_f32 v40, v40, v32
  v_mul_f32 v40, s26, v40
  v_sub_f32 v40, 0, v40
  v_mul_f32 v41, v41, v32
  v_mul_f32 v41, s27, v41
  v_mul_f32 v42, v42, v32
  v_mul_f32 v43, v43, v32
  v_add_f32 v42, v42, v42
  v_add_f32 v43, v43, v43
  ds_write_b128 v37, v[40:43] offset:18240
  v_and_b32 v40, 0xffff0000, v24
  v_and_b32 v41, 0xffff0000, v26
  v_and_b32 v42, 0xffff0000, v28
  v_and_b32 v43, 0xffff0000, v30
  v_mul_f32 v40, s26, v40
  v_exp_f32 v40, v40
  s_nop 0
  v_cvt_pk_bf16_f32 v34, v40, v40
  v_and_b32 v40, 0xffff0000, v34
  v_mul_f32 v40, v40, v32
  v_mul_f32 v40, s26, v40
  v_sub_f32 v40, 0, v40
  v_mul_f32 v41, v41, v32
  v_mul_f32 v41, s27, v41
  v_mul_f32 v42, v42, v32
  v_mul_f32 v43, v43, v32
  v_add_f32 v42, v42, v42
  v_add_f32 v43, v43, v43
  ds_write_b128 v37, v[40:43] offset:18256
  v_lshlrev_b32 v40, 16, v25
  v_lshlrev_b32 v41, 16, v27
  v_lshlrev_b32 v42, 16, v29
  v_lshlrev_b32 v43, 16, v31
  v_mul_f32 v40, s26, v40
  v_exp_f32 v40, v40
  s_nop 0
  v_cvt_pk_bf16_f32 v34, v40, v40
  v_and_b32 v40, 0xffff0000, v34
  v_mul_f32 v40, v40, v32
  v_mul_f32 v40, s26, v40
  v_sub_f32 v40, 0, v40
  v_mul_f32 v41, v41, v32
  v_mul_f32 v41, s27, v41
  v_mul_f32 v42, v42, v32
  v_mul_f32 v43, v43, v32
  v_add_f32 v42, v42, v42
  v_add_f32 v43, v43, v43
  ds_write_b128 v37, v[40:43] offset:18272
  v_and_b32 v40, 0xffff0000, v25
  v_and_b32 v41, 0xffff0000, v27
  v_and_b32 v42, 0xffff0000, v29
  v_and_b32 v43, 0xffff0000, v31
  v_mul_f32 v40, s26, v40
  v_exp_f32 v40, v40
  s_nop 0
  v_cvt_pk_bf16_f32 v34, v40, v40
  v_and_b32 v40, 0xffff0000, v34
  v_mul_f32 v40, v40, v32
  v_mul_f32 v40, s26, v40
  v_sub_f32 v40, 0, v40
  v_mul_f32 v41, v41, v32
  v_mul_f32 v41, s27, v41
  v_mul_f32 v42, v42, v32
  v_mul_f32 v43, v43, v32
  v_add_f32 v42, v42, v42
  v_add_f32 v43, v43, v43
  ds_write_b128 v37, v[40:43] offset:18288
  v_cvt_f32_u32 v44, v4
  v_lshlrev_b32 v45, 4, v4
  v_cvt_f32_u32 v45, v45
  v_lshlrev_b32 v46, 4, v3
  v_add_u32 v46, s17, v46
  v_mov_b32 v48, 0
  v_mov_b32 v49, 0
  v_mov_b32 v50, 0
  v_mov_b32 v51, 0
  v_mov_b32 v52, 0
  v_mov_b32 v53, 0
  v_mov_b32 v54, 0
  v_mov_b32 v55, 0
  v_mov_b32 v56, 0
  v_mov_b32 v57, 0
  v_mov_b32 v58, 0
  v_mov_b32 v59, 0
  v_mov_b32 v60, 0
  v_mov_b32 v61, 0
  v_mov_b32 v62, 0
  v_mov_b32 v63, 0
  v_mov_b32 v64, 0
  v_mov_b32 v65, 0
  v_mov_b32 v66, 0
  v_mov_b32 v67, 0
  s_mov_b32 s28, 0
  s_waitcnt lgkmcnt(0)
  ds_read_b128 v[68:71], v46 offset:18240
wk_kl:
  s_waitcnt lgkmcnt(0)
  v_mov_b32 v72, v68
  v_mov_b32 v73, v69
  v_mov_b32 v74, v70
  v_mov_b32 v75, v71
  v_add_u32 v46, 64, v46
  ds_read_b128 v[68:71], v46 offset:18240
  v_mul_f32 v80, v72, v45
  v_mul_f32 v81, v73, v45
  v_exp_f32 v80, v80
  v_fract_f32 v81, v81
  v_cos_f32 v76, v81
  v_sin_f32 v77, v81
  v_mul_f32 v76, v76, v80
  v_mul_f32 v77, v77, v80
  v_mul_f32 v80, v72, v44
  v_mul_f32 v81, v73, v44
  v_exp_f32 v80, v80
  v_fract_f32 v81, v81
  v_cos_f32 v78, v81
  v_sin_f32 v79, v81
  v_mul_f32 v78, v78, v80
  v_mul_f32 v79, v79, v80
  v_mul_f32 v82, v74, v76
  v_mul_f32 v83, v74, v77
  v_fma_f32 v82, -v75, v77, v82
  v_fma_f32 v83, -v75, v76, -v83
  v_mul_f32 v86, v76, v76
  v_mul_f32 v87, v76, v77
  v_fma_f32 v86, -v77, v77, v86
  v_add_f32 v87, v87, v87
  v_mfma_f32_16x16x4_f32 v[48:51], v82, v78, v[48:51]
  v_mul_f32 v88, v78, v78
  v_mul_f32 v89, v78, v79
  v_fma_f32 v88, -v79, v79, v88
  v_add_f32 v89, v89, v89
  v_mfma_f32_16x16x4_f32 v[48:51], v83, v79, v[48:51]
  v_mul_f32 v84, v74, v86
  v_mul_f32 v85, v74, v87
  v_fma_f32 v84, -v75, v87, v84
  v_fma_f32 v85, -v75, v86, -v85
  v_mul_f32 v76, v86, v86
  v_mul_f32 v77, v86, v87
  v_fma_f32 v76, -v87, v87, v76
  v_add_f32 v77, v77, v77
  v_mfma_f32_16x16x4_f32 v[52:55], v84, v88, v[52:55]
  v_mul_f32 v78, v88, v88
  v_mul_f32 v79, v88, v89
  v_fma_f32 v78, -v89, v89, v78
  v_add_f32 v79, v79, v79
  v_mfma_f32_16x16x4_f32 v[52:55], v85, v89, v[52:55]
  v_mul_f32 v82, v74, v76
  v_mul_f32 v83, v74, v77
  v_fma_f32 v82, -v75, v77, v82
  v_fma_f32 v83, -v75, v76, -v83
  v_mul_f32 v86, v76, v76
  v_mul_f32 v87, v76, v77
  v_fma_f32 v86, -v77, v77, v86
  v_add_f32 v87, v87, v87
  v_mfma_f32_16x16x4_f32 v[56:59], v82, v78, v[56:59]
  v_mul_f32 v88, v78, v78
  v_mul_f32 v89, v78, v79
  v_fma_f32 v88, -v79, v79, v88
  v_add_f32 v89, v89, v89
  v_mfma_f32_16x16x4_f32 v[56:59], v83, v79, v[56:59]
  v_mul_f32 v84, v74, v86
  v_mul_f32 v85, v74, v87
  v_fma_f32 v84, -v75, v87, v84
  v_fma_f32 v85, -v75, v86, -v85
  v_mul_f32 v76, v86, v86
  v_mul_f32 v77, v86, v87
  v_fma_f32 v76, -v87, v87, v76
  v_add_f32 v77, v77, v77
  v_mfma_f32_16x16x4_f32 v[60:63], v84, v88, v[60:63]
  v_mfma_f32_16x16x4_f32 v[60:63], v85, v89, v[60:63]
  v_mul_f32 v82, v74, v76
  v_fma_f32 v82, -v75, v77, v82
  s_nop 1
  v_mfma_f32_16x16x4_f32 v[64:67], v82, v88, v[64:67]
  s_add_u32 s28, s28, 1
  s_cmp_lt_u32 s28, 64
  s_cbranch_scc1 wk_kl
  s_nop 15
  s_nop 3
  v_lshlrev_b32 v46, 8, v3
  v_lshl_add_u32 v46, v4, 2, v46
  v_add_u32 v46, s17, v46
  ds_write_b32 v46, v48 offset:13056
  ds_write_b32 v46, v49 offset:13120
  ds_write_b32 v46, v50 offset:13184
  ds_write_b32 v46, v51 offset:13248
  s_waitcnt lgkmcnt(8)
  ds_write_b32 v46, v52 offset:14080
  ds_write_b32 v46, v53 offset:14144
  ds_write_b32 v46, v54 offset:14208
  ds_write_b32 v46, v55 offset:14272
  s_waitcnt lgkmcnt(8)
  ds_write_b32 v46, v56 offset:15104
  ds_write_b32 v46, v57 offset:15168
  ds_write_b32 v46, v58 offset:15232
  ds_write_b32 v46, v59 offset:15296
  s_waitcnt lgkmcnt(8)
  ds_write_b32 v46, v60 offset:16128
  ds_write_b32 v46, v61 offset:16192
  ds_write_b32 v46, v62 offset:16256
  ds_write_b32 v46, v63 offset:16320
  s_waitcnt lgkmcnt(8)
  ds_write_b32 v46, v64 offset:17152
  ds_write_b32 v46, v65 offset:17216
  ds_write_b32 v46, v66 offset:17280
  ds_write_b32 v46, v67 offset:17344
  s_waitcnt lgkmcnt(8)
  s_waitcnt lgkmcnt(0)
  ds_read_b32 v48, v200
  ds_read_b32 v49, v201
  ds_read_b32 v50, v202
  ds_read_b32 v51, v203
  ds_read_b32 v52, v204
  ds_read_b32 v53, v205
  ds_read_b32 v54, v206
  ds_read_b32 v55, v207
  s_waitcnt lgkmcnt(4)
  ds_read_b32 v56, v208
  ds_read_b32 v57, v209
  ds_read_b32 v58, v210
  ds_read_b32 v59, v211
  ds_read_b32 v60, v212
  ds_read_b32 v61, v213
  ds_read_b32 v62, v214
  ds_read_b32 v63, v215
  s_waitcnt lgkmcnt(4)
  ds_read_b32 v64, v216
  ds_read_b32 v65, v217
  ds_read_b32 v66, v218
  ds_read_b32 v67, v219
  ds_read_b32 v68, v220
  ds_read_b32 v69, v221
  ds_read_b32 v70, v222
  ds_read_b32 v71, v223
  s_waitcnt lgkmcnt(4)
  ds_read_b32 v72, v224
  ds_read_b32 v73, v225
  ds_read_b32 v74, v226
  ds_read_b32 v75, v227
  ds_read_b32 v76, v228
  ds_read_b32 v77, v229
  ds_read_b32 v78, v230
  ds_read_b32 v79, v231
  s_waitcnt lgkmcnt(4)
  ds_read_b32 v80, v232
  s_waitcnt lgkmcnt(0)
  v_lshlrev_b32 v46, 6, v1
  v_add_u32 v46, s17, v46
  v_cvt_pk_bf16_f32 v84, v48, v49
  v_cvt_pk_bf16_f32 v88, v49, v50
  v_cvt_pk_bf16_f32 v85, v50, v51
  v_cvt_pk_bf16_f32 v89, v51, v52
  v_cvt_pk_bf16_f32 v86, v52, v53
  v_cvt_pk_bf16_f32 v90, v53, v54
  v_cvt_pk_bf16_f32 v87, v54, v55
  v_cvt_pk_bf16_f32 v91, v55, v56
  ds_write_b128 v46, v[84:87] offset:4608
  ds_write_b128 v46, v[88:91] offset:8832
  s_waitcnt lgkmcnt(0)
  v_cvt_pk_bf16_f32 v84, v56, v57
  v_cvt_pk_bf16_f32 v88, v57, v58
  v_cvt_pk_bf16_f32 v85, v58, v59
  v_cvt_pk_bf16_f32 v89, v59, v60
  v_cvt_pk_bf16_f32 v86, v60, v61
  v_cvt_pk_bf16_f32 v90, v61, v62
  v_cvt_pk_bf16_f32 v87, v62, v63
  v_cvt_pk_bf16_f32 v91, v63, v64
  ds_write_b128 v46, v[84:87] offset:4624
  ds_write_b128 v46, v[88:91] offset:8848
  s_waitcnt lgkmcnt(0)
  v_cvt_pk_bf16_f32 v84, v64, v65
  v_cvt_pk_bf16_f32 v88, v65, v66
  v_cvt_pk_bf16_f32 v85, v66, v67
  v_cvt_pk_bf16_f32 v89, v67, v68
  v_cvt_pk_bf16_f32 v86, v68, v69
  v_cvt_pk_bf16_f32 v90, v69, v70
  v_cvt_pk_bf16_f32 v87, v70, v71
  v_cvt_pk_bf16_f32 v91, v71, v72
  ds_write_b128 v46, v[84:87] offset:4640
  ds_write_b128 v46, v[88:91] offset:8864
  s_waitcnt lgkmcnt(0)
  v_cvt_pk_bf16_f32 v84, v72, v73
  v_cvt_pk_bf16_f32 v88, v73, v74
  v_cvt_pk_bf16_f32 v85, v74, v75
  v_cvt_pk_bf16_f32 v89, v75, v76
  v_cvt_pk_bf16_f32 v86, v76, v77
  v_cvt_pk_bf16_f32 v90, v77, v78
  v_cvt_pk_bf16_f32 v87, v78, v79
  v_cvt_pk_bf16_f32 v91, v79, v80
  ds_write_b128 v46, v[84:87] offset:4656
  ds_write_b128 v46, v[88:91] offset:8880
  s_waitcnt lgkmcnt(0)
  s_barrier
  v_lshrrev_b32 v47, 1, v3
  v_sub_u32 v46, v4, v47
  v_add_u32 v46, 1, v46
  v_lshlrev_b32 v46, 5, v46
  v_and_b32 v48, 1, v3
  v_lshl_add_u32 v46, v48, 4, v46
  v_add_u32 v46, s17, v46
  ds_read_b128 a[0:3], v46 offset:32
  ds_read_b128 a[4:7], v46 offset:96
  ds_read_b128 a[8:11], v46 offset:160
  ds_read_b128 a[12:15], v46 offset:224
  ds_read_b128 a[16:19], v46 offset:288
  ds_read_b128 a[20:23], v46 offset:352
  ds_read_b128 a[24:27], v46 offset:416
  ds_read_b128 a[28:31], v46 offset:480
  s_waitcnt lgkmcnt(4)
  ds_read_b128 a[32:35], v46 offset:544
  ds_read_b128 a[36:39], v46 offset:608
  ds_read_b128 a[40:43], v46 offset:672
  ds_read_b128 a[44:47], v46 offset:736
  ds_read_b128 a[48:51], v46 offset:800
  ds_read_b128 a[52:55], v46 offset:864
  ds_read_b128 a[56:59], v46 offset:928
  ds_read_b128 a[60:63], v46 offset:992
  s_waitcnt lgkmcnt(4)
  ds_read_b128 a[64:67], v46 offset:1056
  ds_read_b128 a[68:71], v46 offset:1120
  ds_read_b128 a[72:75], v46 offset:1184
  ds_read_b128 a[76:79], v46 offset:1248
  ds_read_b128 a[80:83], v46 offset:1312
  ds_read_b128 a[84:87], v46 offset:1376
  ds_read_b128 a[88:91], v46 offset:1440
  ds_read_b128 a[92:95], v46 offset:1504
  s_waitcnt lgkmcnt(4)
  ds_read_b128 a[96:99], v46 offset:1568
  ds_read_b128 a[100:103], v46 offset:1632
  ds_read_b128 a[104:107], v46 offset:1696
  ds_read_b128 a[108:111], v46 offset:1760
  ds_read_b128 a[112:115], v46 offset:1824
  ds_read_b128 a[116:119], v46 offset:1888
  ds_read_b128 a[120:123], v46 offset:1952
  ds_read_b128 a[124:127], v46 offset:2016
  s_waitcnt lgkmcnt(4)
  ds_read_b128 a[128:131], v46 offset:2080
  ds_read_b128 a[132:135], v46 offset:2144
  ds_read_b128 a[136:139], v46 offset:2208
  ds_read_b128 a[140:143], v46 offset:2272
  ds_read_b128 a[144:147], v46 offset:2336
  ds_read_b128 a[148:151], v46 offset:2400
  ds_read_b128 a[152:155], v46 offset:2464
  ds_read_b128 a[156:159], v46 offset:2528
  s_waitcnt lgkmcnt(4)
  ds_read_b128 a[160:163], v46 offset:2592
  ds_read_b128 a[164:167], v46 offset:2656
  ds_read_b128 a[168:171], v46 offset:2720
  ds_read_b128 a[172:175], v46 offset:2784
  ds_read_b128 a[176:179], v46 offset:2848
  ds_read_b128 a[180:183], v46 offset:2912
  ds_read_b128 a[184:187], v46 offset:2976
  ds_read_b128 a[188:191], v46 offset:3040
  s_waitcnt lgkmcnt(4)
  ds_read_b128 a[192:195], v46 offset:3104
  ds_read_b128 a[196:199], v46 offset:3168
  ds_read_b128 a[200:203], v46 offset:3232
  ds_read_b128 a[204:207], v46 offset:3296
  ds_read_b128 a[208:211], v46 offset:3360
  ds_read_b128 a[212:215], v46 offset:3424
  ds_read_b128 a[216:219], v46 offset:3488
  ds_read_b128 a[220:223], v46 offset:3552
  s_waitcnt lgkmcnt(4)
  ds_read_b128 a[224:227], v46 offset:3616
  ds_read_b128 a[228:231], v46 offset:3680
  ds_read_b128 a[232:235], v46 offset:3744
  ds_read_b128 a[236:239], v46 offset:3808
  ds_read_b128 a[240:243], v46 offset:3872
  ds_read_b128 a[244:247], v46 offset:3936
  ds_read_b128 a[248:251], v46 offset:4000
  ds_read_b128 a[252:255], v46 offset:4064
  s_waitcnt lgkmcnt(4)
  v_lshlrev_b32 v49, 4, v47
  v_add_u32 v49, v49, v4
  v_sub_u32 v49, 2047, v49
  v_lshl_add_u32 v49, v48, 3, v49
  v_and_b32 v50, 1, v49
  v_lshrrev_b32 v49, 1, v49
  v_lshlrev_b32 v49, 2, v49
  v_mul_u32_u24 v50, 4224, v50
  v_add3_u32 v49, v49, v50, s17
  v_add_u32 v49, 4608, v49
  v_subrev_u32 v52, 896, v49
  v_subrev_u32 v53, 1856, v49
  v_subrev_u32 v54, 2816, v49
  v_subrev_u32 v55, 3776, v49
  v_subrev_u32 v56, 4736, v49
  s_waitcnt lgkmcnt(0)
  ds_read2_b32 v[92:93], v52 offset0:224 offset1:225
  ds_read2_b32 v[94:95], v52 offset0:226 offset1:227
  ds_read2_b32 v[96:97], v52 offset0:208 offset1:209
  ds_read2_b32 v[98:99], v52 offset0:210 offset1:211
  ds_read2_b32 v[100:101], v52 offset0:192 offset1:193
  ds_read2_b32 v[102:103], v52 offset0:194 offset1:195
  ds_read2_b32 v[104:105], v52 offset0:176 offset1:177
  ds_read2_b32 v[106:107], v52 offset0:178 offset1:179
  s_waitcnt lgkmcnt(6)
  v_mfma_f32_16x16x32_bf16 v[60:63], v[92:95], a[28:31], 0
  v_mfma_f32_16x16x32_bf16 v[64:67], v[92:95], a[60:63], 0
  v_mfma_f32_16x16x32_bf16 v[68:71], v[92:95], a[92:95], 0
  v_mfma_f32_16x16x32_bf16 v[72:75], v[92:95], a[124:127], 0
  v_mfma_f32_16x16x32_bf16 v[76:79], v[92:95], a[156:159], 0
  v_mfma_f32_16x16x32_bf16 v[80:83], v[92:95], a[188:191], 0
  v_mfma_f32_16x16x32_bf16 v[84:87], v[92:95], a[220:223], 0
  v_mfma_f32_16x16x32_bf16 v[88:91], v[92:95], a[252:255], 0
  ds_read2_b32 v[92:93], v52 offset0:160 offset1:161
  ds_read2_b32 v[94:95], v52 offset0:162 offset1:163
  s_waitcnt lgkmcnt(6)
  v_mfma_f32_16x16x32_bf16 v[60:63], v[96:99], a[24:27], v[60:63]
  v_mfma_f32_16x16x32_bf16 v[64:67], v[96:99], a[56:59], v[64:67]
  v_mfma_f32_16x16x32_bf16 v[68:71], v[96:99], a[88:91], v[68:71]
  v_mfma_f32_16x16x32_bf16 v[72:75], v[96:99], a[120:123], v[72:75]
  v_mfma_f32_16x16x32_bf16 v[76:79], v[96:99], a[152:155], v[76:79]
  v_mfma_f32_16x16x32_bf16 v[80:83], v[96:99], a[184:187], v[80:83]
  v_mfma_f32_16x16x32_bf16 v[84:87], v[96:99], a[216:219], v[84:87]
  v_mfma_f32_16x16x32_bf16 v[88:91], v[96:99], a[248:251], v[88:91]
  ds_read2_b32 v[96:97], v52 offset0:144 offset1:145
  ds_read2_b32 v[98:99], v52 offset0:146 offset1:147
  s_waitcnt lgkmcnt(6)
  v_mfma_f32_16x16x32_bf16 v[60:63], v[100:103], a[20:23], v[60:63]
  v_mfma_f32_16x16x32_bf16 v[64:67], v[100:103], a[52:55], v[64:67]
  v_mfma_f32_16x16x32_bf16 v[68:71], v[100:103], a[84:87], v[68:71]
  v_mfma_f32_16x16x32_bf16 v[72:75], v[100:103], a[116:119], v[72:75]
  v_mfma_f32_16x16x32_bf16 v[76:79], v[100:103], a[148:151], v[76:79]
  v_mfma_f32_16x16x32_bf16 v[80:83], v[100:103], a[180:183], v[80:83]
  v_mfma_f32_16x16x32_bf16 v[84:87], v[100:103], a[212:215], v[84:87]
  v_mfma_f32_16x16x32_bf16 v[88:91], v[100:103], a[244:247], v[88:91]
  ds_read2_b32 v[100:101], v52 offset0:128 offset1:129
  ds_read2_b32 v[102:103], v52 offset0:130 offset1:131
  s_waitcnt lgkmcnt(6)
  v_mfma_f32_16x16x32_bf16 v[60:63], v[104:107], a[16:19], v[60:63]
  v_mfma_f32_16x16x32_bf16 v[64:67], v[104:107], a[48:51], v[64:67]
  v_mfma_f32_16x16x32_bf16 v[68:71], v[104:107], a[80:83], v[68:71]
  v_mfma_f32_16x16x32_bf16 v[72:75], v[104:107], a[112:115], v[72:75]
  v_mfma_f32_16x16x32_bf16 v[76:79], v[104:107], a[144:147], v[76:79]
  v_mfma_f32_16x16x32_bf16 v[80:83], v[104:107], a[176:179], v[80:83]
  v_mfma_f32_16x16x32_bf16 v[84:87], v[104:107], a[208:211], v[84:87]
  v_mfma_f32_16x16x32_bf16 v[88:91], v[104:107], a[240:243], v[88:91]
  ds_read2_b32 v[104:105], v52 offset0:112 offset1:113
  ds_read2_b32 v[106:107], v52 offset0:114 offset1:115
  s_waitcnt lgkmcnt(6)
  v_mfma_f32_16x16x32_bf16 v[60:63], v[92:95], a[12:15], v[60:63]
  v_mfma_f32_16x16x32_bf16 v[64:67], v[92:95], a[44:47], v[64:67]
  v_mfma_f32_16x16x32_bf16 v[68:71], v[92:95], a[76:79], v[68:71]
  v_mfma_f32_16x16x32_bf16 v[72:75], v[92:95], a[108:111], v[72:75]
  v_mfma_f32_16x16x32_bf16 v[76:79], v[92:95], a[140:143], v[76:79]
  v_mfma_f32_16x16x32_bf16 v[80:83], v[92:95], a[172:175], v[80:83]
  v_mfma_f32_16x16x32_bf16 v[84:87], v[92:95], a[204:207], v[84:87]
  v_mfma_f32_16x16x32_bf16 v[88:91], v[92:95], a[236:239], v[88:91]
  ds_read2_b32 v[92:93], v52 offset0:96 offset1:97
  ds_read2_b32 v[94:95], v52 offset0:98 offset1:99
  s_waitcnt lgkmcnt(6)
  v_mfma_f32_16x16x32_bf16 v[60:63], v[96:99], a[8:11], v[60:63]
  v_mfma_f32_16x16x32_bf16 v[64:67], v[96:99], a[40:43], v[64:67]
  v_mfma_f32_16x16x32_bf16 v[68:71], v[96:99], a[72:75], v[68:71]
  v_mfma_f32_16x16x32_bf16 v[72:75], v[96:99], a[104:107], v[72:75]
  v_mfma_f32_16x16x32_bf16 v[76:79], v[96:99], a[136:139], v[76:79]
  v_mfma_f32_16x16x32_bf16 v[80:83], v[96:99], a[168:171], v[80:83]
  v_mfma_f32_16x16x32_bf16 v[84:87], v[96:99], a[200:203], v[84:87]
  v_mfma_f32_16x16x32_bf16 v[88:91], v[96:99], a[232:235], v[88:91]
  ds_read2_b32 v[96:97], v52 offset0:80 offset1:81
  ds_read2_b32 v[98:99], v52 offset0:82 offset1:83
  s_waitcnt lgkmcnt(6)
  v_mfma_f32_16x16x32_bf16 v[60:63], v[100:103], a[4:7], v[60:63]
  v_mfma_f32_16x16x32_bf16 v[64:67], v[100:103], a[36:39], v[64:67]
  v_mfma_f32_16x16x32_bf16 v[68:71], v[100:103], a[68:71], v[68:71]
  v_mfma_f32_16x16x32_bf16 v[72:75], v[100:103], a[100:103], v[72:75]
  v_mfma_f32_16x16x32_bf16 v[76:79], v[100:103], a[132:135], v[76:79]
  v_mfma_f32_16x16x32_bf16 v[80:83], v[100:103], a[164:167], v[80:83]
  v_mfma_f32_16x16x32_bf16 v[84:87], v[100:103], a[196:199], v[84:87]
  v_mfma_f32_16x16x32_bf16 v[88:91], v[100:103], a[228:231], v[88:91]
  ds_read2_b32 v[100:101], v52 offset0:64 offset1:65
  ds_read2_b32 v[102:103], v52 offset0:66 offset1:67
  s_waitcnt lgkmcnt(6)
  v_mfma_f32_16x16x32_bf16 v[60:63], v[104:107], a[0:3], v[60:63]
  v_mfma_f32_16x16x32_bf16 v[64:67], v[104:107], a[32:35], v[64:67]
  v_mfma_f32_16x16x32_bf16 v[68:71], v[104:107], a[64:67], v[68:71]
  v_mfma_f32_16x16x32_bf16 v[72:75], v[104:107], a[96:99], v[72:75]
  v_mfma_f32_16x16x32_bf16 v[76:79], v[104:107], a[128:131], v[76:79]
  v_mfma_f32_16x16x32_bf16 v[80:83], v[104:107], a[160:163], v[80:83]
  v_mfma_f32_16x16x32_bf16 v[84:87], v[104:107], a[192:195], v[84:87]
  v_mfma_f32_16x16x32_bf16 v[88:91], v[104:107], a[224:227], v[88:91]
  ds_read2_b32 v[104:105], v52 offset0:48 offset1:49
  ds_read2_b32 v[106:107], v52 offset0:50 offset1:51
  s_waitcnt lgkmcnt(6)
  v_mfma_f32_16x16x32_bf16 v[64:67], v[92:95], a[28:31], v[64:67]
  v_mfma_f32_16x16x32_bf16 v[68:71], v[92:95], a[60:63], v[68:71]
  v_mfma_f32_16x16x32_bf16 v[72:75], v[92:95], a[92:95], v[72:75]
  v_mfma_f32_16x16x32_bf16 v[76:79], v[92:95], a[124:127], v[76:79]
  v_mfma_f32_16x16x32_bf16 v[80:83], v[92:95], a[156:159], v[80:83]
  v_mfma_f32_16x16x32_bf16 v[84:87], v[92:95], a[188:191], v[84:87]
  v_mfma_f32_16x16x32_bf16 v[88:91], v[92:95], a[220:223], v[88:91]
  ds_read2_b32 v[92:93], v52 offset0:32 offset1:33
  ds_read2_b32 v[94:95], v52 offset0:34 offset1:35
  s_waitcnt lgkmcnt(6)
  v_mfma_f32_16x16x32_bf16 v[64:67], v[96:99], a[24:27], v[64:67]
  v_mfma_f32_16x16x32_bf16 v[68:71], v[96:99], a[56:59], v[68:71]
  v_mfma_f32_16x16x32_bf16 v[72:75], v[96:99], a[88:91], v[72:75]
  v_mfma_f32_16x16x32_bf16 v[76:79], v[96:99], a[120:123], v[76:79]
  v_mfma_f32_16x16x32_bf16 v[80:83], v[96:99], a[152:155], v[80:83]
  v_mfma_f32_16x16x32_bf16 v[84:87], v[96:99], a[184:187], v[84:87]
  v_mfma_f32_16x16x32_bf16 v[88:91], v[96:99], a[216:219], v[88:91]
  ds_read2_b32 v[96:97], v52 offset0:16 offset1:17
  ds_read2_b32 v[98:99], v52 offset0:18 offset1:19
  s_waitcnt lgkmcnt(6)
  v_mfma_f32_16x16x32_bf16 v[64:67], v[100:103], a[20:23], v[64:67]
  v_mfma_f32_16x16x32_bf16 v[68:71], v[100:103], a[52:55], v[68:71]
  v_mfma_f32_16x16x32_bf16 v[72:75], v[100:103], a[84:87], v[72:75]
  v_mfma_f32_16x16x32_bf16 v[76:79], v[100:103], a[116:119], v[76:79]
  v_mfma_f32_16x16x32_bf16 v[80:83], v[100:103], a[148:151], v[80:83]
  v_mfma_f32_16x16x32_bf16 v[84:87], v[100:103], a[180:183], v[84:87]
  v_mfma_f32_16x16x32_bf16 v[88:91], v[100:103], a[212:215], v[88:91]
  ds_read2_b32 v[100:101], v52 offset0:0 offset1:1
  ds_read2_b32 v[102:103], v52 offset0:2 offset1:3
  s_waitcnt lgkmcnt(6)
  v_mfma_f32_16x16x32_bf16 v[64:67], v[104:107], a[16:19], v[64:67]
  v_mfma_f32_16x16x32_bf16 v[68:71], v[104:107], a[48:51], v[68:71]
  v_mfma_f32_16x16x32_bf16 v[72:75], v[104:107], a[80:83], v[72:75]
  v_mfma_f32_16x16x32_bf16 v[76:79], v[104:107], a[112:115], v[76:79]
  v_mfma_f32_16x16x32_bf16 v[80:83], v[104:107], a[144:147], v[80:83]
  v_mfma_f32_16x16x32_bf16 v[84:87], v[104:107], a[176:179], v[84:87]
  v_mfma_f32_16x16x32_bf16 v[88:91], v[104:107], a[208:211], v[88:91]
  ds_read2_b32 v[104:105], v53 offset0:224 offset1:225
  ds_read2_b32 v[106:107], v53 offset0:226 offset1:227
  s_waitcnt lgkmcnt(6)
  v_mfma_f32_16x16x32_bf16 v[64:67], v[92:95], a[12:15], v[64:67]
  v_mfma_f32_16x16x32_bf16 v[68:71], v[92:95], a[44:47], v[68:71]
  v_mfma_f32_16x16x32_bf16 v[72:75], v[92:95], a[76:79], v[72:75]
  v_mfma_f32_16x16x32_bf16 v[76:79], v[92:95], a[108:111], v[76:79]
  v_mfma_f32_16x16x32_bf16 v[80:83], v[92:95], a[140:143], v[80:83]
  v_mfma_f32_16x16x32_bf16 v[84:87], v[92:95], a[172:175], v[84:87]
  v_mfma_f32_16x16x32_bf16 v[88:91], v[92:95], a[204:207], v[88:91]
  ds_read2_b32 v[92:93], v53 offset0:208 offset1:209
  ds_read2_b32 v[94:95], v53 offset0:210 offset1:211
  s_waitcnt lgkmcnt(6)
  v_mfma_f32_16x16x32_bf16 v[64:67], v[96:99], a[8:11], v[64:67]
  v_mfma_f32_16x16x32_bf16 v[68:71], v[96:99], a[40:43], v[68:71]
  v_mfma_f32_16x16x32_bf16 v[72:75], v[96:99], a[72:75], v[72:75]
  v_mfma_f32_16x16x32_bf16 v[76:79], v[96:99], a[104:107], v[76:79]
  v_mfma_f32_16x16x32_bf16 v[80:83], v[96:99], a[136:139], v[80:83]
  v_mfma_f32_16x16x32_bf16 v[84:87], v[96:99], a[168:171], v[84:87]
  v_mfma_f32_16x16x32_bf16 v[88:91], v[96:99], a[200:203], v[88:91]
  ds_read2_b32 v[96:97], v53 offset0:192 offset1:193
  ds_read2_b32 v[98:99], v53 offset0:194 offset1:195
  s_waitcnt lgkmcnt(6)
  v_mfma_f32_16x16x32_bf16 v[64:67], v[100:103], a[4:7], v[64:67]
  v_mfma_f32_16x16x32_bf16 v[68:71], v[100:103], a[36:39], v[68:71]
  v_mfma_f32_16x16x32_bf16 v[72:75], v[100:103], a[68:71], v[72:75]
  v_mfma_f32_16x16x32_bf16 v[76:79], v[100:103], a[100:103], v[76:79]
  v_mfma_f32_16x16x32_bf16 v[80:83], v[100:103], a[132:135], v[80:83]
  v_mfma_f32_16x16x32_bf16 v[84:87], v[100:103], a[164:167], v[84:87]
  v_mfma_f32_16x16x32_bf16 v[88:91], v[100:103], a[196:199], v[88:91]
  ds_read2_b32 v[100:101], v53 offset0:176 offset1:177
  ds_read2_b32 v[102:103], v53 offset0:178 offset1:179
  s_waitcnt lgkmcnt(6)
  v_mfma_f32_16x16x32_bf16 v[64:67], v[104:107], a[0:3], v[64:67]
  v_mfma_f32_16x16x32_bf16 v[68:71], v[104:107], a[32:35], v[68:71]
  v_mfma_f32_16x16x32_bf16 v[72:75], v[104:107], a[64:67], v[72:75]
  v_mfma_f32_16x16x32_bf16 v[76:79], v[104:107], a[96:99], v[76:79]
  v_mfma_f32_16x16x32_bf16 v[80:83], v[104:107], a[128:131], v[80:83]
  v_mfma_f32_16x16x32_bf16 v[84:87], v[104:107], a[160:163], v[84:87]
  v_mfma_f32_16x16x32_bf16 v[88:91], v[104:107], a[192:195], v[88:91]
  ds_read2_b32 v[104:105], v53 offset0:160 offset1:161
  ds_read2_b32 v[106:107], v53 offset0:162 offset1:163
  s_waitcnt lgkmcnt(6)
  v_mfma_f32_16x16x32_bf16 v[68:71], v[92:95], a[28:31], v[68:71]
  v_mfma_f32_16x16x32_bf16 v[72:75], v[92:95], a[60:63], v[72:75]
  v_mfma_f32_16x16x32_bf16 v[76:79], v[92:95], a[92:95], v[76:79]
  v_mfma_f32_16x16x32_bf16 v[80:83], v[92:95], a[124:127], v[80:83]
  v_mfma_f32_16x16x32_bf16 v[84:87], v[92:95], a[156:159], v[84:87]
  v_mfma_f32_16x16x32_bf16 v[88:91], v[92:95], a[188:191], v[88:91]
  ds_read2_b32 v[92:93], v53 offset0:144 offset1:145
  ds_read2_b32 v[94:95], v53 offset0:146 offset1:147
  s_waitcnt lgkmcnt(6)
  v_mfma_f32_16x16x32_bf16 v[68:71], v[96:99], a[24:27], v[68:71]
  v_mfma_f32_16x16x32_bf16 v[72:75], v[96:99], a[56:59], v[72:75]
  v_mfma_f32_16x16x32_bf16 v[76:79], v[96:99], a[88:91], v[76:79]
  v_mfma_f32_16x16x32_bf16 v[80:83], v[96:99], a[120:123], v[80:83]
  v_mfma_f32_16x16x32_bf16 v[84:87], v[96:99], a[152:155], v[84:87]
  v_mfma_f32_16x16x32_bf16 v[88:91], v[96:99], a[184:187], v[88:91]
  ds_read2_b32 v[96:97], v53 offset0:128 offset1:129
  ds_read2_b32 v[98:99], v53 offset0:130 offset1:131
  s_waitcnt lgkmcnt(6)
  v_mfma_f32_16x16x32_bf16 v[68:71], v[100:103], a[20:23], v[68:71]
  v_mfma_f32_16x16x32_bf16 v[72:75], v[100:103], a[52:55], v[72:75]
  v_mfma_f32_16x16x32_bf16 v[76:79], v[100:103], a[84:87], v[76:79]
  v_mfma_f32_16x16x32_bf16 v[80:83], v[100:103], a[116:119], v[80:83]
  v_mfma_f32_16x16x32_bf16 v[84:87], v[100:103], a[148:151], v[84:87]
  v_mfma_f32_16x16x32_bf16 v[88:91], v[100:103], a[180:183], v[88:91]
  ds_read2_b32 v[100:101], v53 offset0:112 offset1:113
  ds_read2_b32 v[102:103], v53 offset0:114 offset1:115
  s_waitcnt lgkmcnt(6)
  v_mfma_f32_16x16x32_bf16 v[68:71], v[104:107], a[16:19], v[68:71]
  v_mfma_f32_16x16x32_bf16 v[72:75], v[104:107], a[48:51], v[72:75]
  v_mfma_f32_16x16x32_bf16 v[76:79], v[104:107], a[80:83], v[76:79]
  v_mfma_f32_16x16x32_bf16 v[80:83], v[104:107], a[112:115], v[80:83]
  v_mfma_f32_16x16x32_bf16 v[84:87], v[104:107], a[144:147], v[84:87]
  v_mfma_f32_16x16x32_bf16 v[88:91], v[104:107], a[176:179], v[88:91]
  ds_read2_b32 v[104:105], v53 offset0:96 offset1:97
  ds_read2_b32 v[106:107], v53 offset0:98 offset1:99
  s_waitcnt lgkmcnt(6)
  v_mfma_f32_16x16x32_bf16 v[68:71], v[92:95], a[12:15], v[68:71]
  v_mfma_f32_16x16x32_bf16 v[72:75], v[92:95], a[44:47], v[72:75]
  v_mfma_f32_16x16x32_bf16 v[76:79], v[92:95], a[76:79], v[76:79]
  v_mfma_f32_16x16x32_bf16 v[80:83], v[92:95], a[108:111], v[80:83]
  v_mfma_f32_16x16x32_bf16 v[84:87], v[92:95], a[140:143], v[84:87]
  v_mfma_f32_16x16x32_bf16 v[88:91], v[92:95], a[172:175], v[88:91]
  ds_read2_b32 v[92:93], v53 offset0:80 offset1:81
  ds_read2_b32 v[94:95], v53 offset0:82 offset1:83
  s_waitcnt lgkmcnt(6)
  v_mfma_f32_16x16x32_bf16 v[68:71], v[96:99], a[8:11], v[68:71]
  v_mfma_f32_16x16x32_bf16 v[72:75], v[96:99], a[40:43], v[72:75]
  v_mfma_f32_16x16x32_bf16 v[76:79], v[96:99], a[72:75], v[76:79]
  v_mfma_f32_16x16x32_bf16 v[80:83], v[96:99], a[104:107], v[80:83]
  v_mfma_f32_16x16x32_bf16 v[84:87], v[96:99], a[136:139], v[84:87]
  v_mfma_f32_16x16x32_bf16 v[88:91], v[96:99], a[168:171], v[88:91]
  ds_read2_b32 v[96:97], v53 offset0:64 offset1:65
  ds_read2_b32 v[98:99], v53 offset0:66 offset1:67
  s_waitcnt lgkmcnt(6)
  v_mfma_f32_16x16x32_bf16 v[68:71], v[100:103], a[4:7], v[68:71]
  v_mfma_f32_16x16x32_bf16 v[72:75], v[100:103], a[36:39], v[72:75]
  v_mfma_f32_16x16x32_bf16 v[76:79], v[100:103], a[68:71], v[76:79]
  v_mfma_f32_16x16x32_bf16 v[80:83], v[100:103], a[100:103], v[80:83]
  v_mfma_f32_16x16x32_bf16 v[84:87], v[100:103], a[132:135], v[84:87]
  v_mfma_f32_16x16x32_bf16 v[88:91], v[100:103], a[164:167], v[88:91]
  ds_read2_b32 v[100:101], v53 offset0:48 offset1:49
  ds_read2_b32 v[102:103], v53 offset0:50 offset1:51
  s_waitcnt lgkmcnt(6)
  v_mfma_f32_16x16x32_bf16 v[68:71], v[104:107], a[0:3], v[68:71]
  v_mfma_f32_16x16x32_bf16 v[72:75], v[104:107], a[32:35], v[72:75]
  v_mfma_f32_16x16x32_bf16 v[76:79], v[104:107], a[64:67], v[76:79]
  v_mfma_f32_16x16x32_bf16 v[80:83], v[104:107], a[96:99], v[80:83]
  v_mfma_f32_16x16x32_bf16 v[84:87], v[104:107], a[128:131], v[84:87]
  v_mfma_f32_16x16x32_bf16 v[88:91], v[104:107], a[160:163], v[88:91]
  ds_read2_b32 v[104:105], v53 offset0:32 offset1:33
  ds_read2_b32 v[106:107], v53 offset0:34 offset1:35
  s_waitcnt lgkmcnt(6)
  v_mfma_f32_16x16x32_bf16 v[72:75], v[92:95], a[28:31], v[72:75]
  v_mfma_f32_16x16x32_bf16 v[76:79], v[92:95], a[60:63], v[76:79]
  v_mfma_f32_16x16x32_bf16 v[80:83], v[92:95], a[92:95], v[80:83]
  v_mfma_f32_16x16x32_bf16 v[84:87], v[92:95], a[124:127], v[84:87]
  v_mfma_f32_16x16x32_bf16 v[88:91], v[92:95], a[156:159], v[88:91]
  ds_read2_b32 v[92:93], v53 offset0:16 offset1:17
  ds_read2_b32 v[94:95], v53 offset0:18 offset1:19
  s_waitcnt lgkmcnt(6)
  v_mfma_f32_16x16x32_bf16 v[72:75], v[96:99], a[24:27], v[72:75]
  v_mfma_f32_16x16x32_bf16 v[76:79], v[96:99], a[56:59], v[76:79]
  v_mfma_f32_16x16x32_bf16 v[80:83], v[96:99], a[88:91], v[80:83]
  v_mfma_f32_16x16x32_bf16 v[84:87], v[96:99], a[120:123], v[84:87]
  v_mfma_f32_16x16x32_bf16 v[88:91], v[96:99], a[152:155], v[88:91]
  ds_read2_b32 v[96:97], v53 offset0:0 offset1:1
  ds_read2_b32 v[98:99], v53 offset0:2 offset1:3
  s_waitcnt lgkmcnt(6)
  v_mfma_f32_16x16x32_bf16 v[72:75], v[100:103], a[20:23], v[72:75]
  v_mfma_f32_16x16x32_bf16 v[76:79], v[100:103], a[52:55], v[76:79]
  v_mfma_f32_16x16x32_bf16 v[80:83], v[100:103], a[84:87], v[80:83]
  v_mfma_f32_16x16x32_bf16 v[84:87], v[100:103], a[116:119], v[84:87]
  v_mfma_f32_16x16x32_bf16 v[88:91], v[100:103], a[148:151], v[88:91]
  ds_read2_b32 v[100:101], v54 offset0:224 offset1:225
  ds_read2_b32 v[102:103], v54 offset0:226 offset1:227
  s_waitcnt lgkmcnt(6)
  v_mfma_f32_16x16x32_bf16 v[72:75], v[104:107], a[16:19], v[72:75]
  v_mfma_f32_16x16x32_bf16 v[76:79], v[104:107], a[48:51], v[76:79]
  v_mfma_f32_16x16x32_bf16 v[80:83], v[104:107], a[80:83], v[80:83]
  v_mfma_f32_16x16x32_bf16 v[84:87], v[104:107], a[112:115], v[84:87]
  v_mfma_f32_16x16x32_bf16 v[88:91], v[104:107], a[144:147], v[88:91]
  ds_read2_b32 v[104:105], v54 offset0:208 offset1:209
  ds_read2_b32 v[106:107], v54 offset0:210 offset1:211
  s_waitcnt lgkmcnt(6)
  v_mfma_f32_16x16x32_bf16 v[72:75], v[92:95], a[12:15], v[72:75]
  v_mfma_f32_16x16x32_bf16 v[76:79], v[92:95], a[44:47], v[76:79]
  v_mfma_f32_16x16x32_bf16 v[80:83], v[92:95], a[76:79], v[80:83]
  v_mfma_f32_16x16x32_bf16 v[84:87], v[92:95], a[108:111], v[84:87]
  v_mfma_f32_16x16x32_bf16 v[88:91], v[92:95], a[140:143], v[88:91]
  ds_read2_b32 v[92:93], v54 offset0:192 offset1:193
  ds_read2_b32 v[94:95], v54 offset0:194 offset1:195
  s_waitcnt lgkmcnt(6)
  v_mfma_f32_16x16x32_bf16 v[72:75], v[96:99], a[8:11], v[72:75]
  v_mfma_f32_16x16x32_bf16 v[76:79], v[96:99], a[40:43], v[76:79]
  v_mfma_f32_16x16x32_bf16 v[80:83], v[96:99], a[72:75], v[80:83]
  v_mfma_f32_16x16x32_bf16 v[84:87], v[96:99], a[104:107], v[84:87]
  v_mfma_f32_16x16x32_bf16 v[88:91], v[96:99], a[136:139], v[88:91]
  ds_read2_b32 v[96:97], v54 offset0:176 offset1:177
  ds_read2_b32 v[98:99], v54 offset0:178 offset1:179
  s_waitcnt lgkmcnt(6)
  v_mfma_f32_16x16x32_bf16 v[72:75], v[100:103], a[4:7], v[72:75]
  v_mfma_f32_16x16x32_bf16 v[76:79], v[100:103], a[36:39], v[76:79]
  v_mfma_f32_16x16x32_bf16 v[80:83], v[100:103], a[68:71], v[80:83]
  v_mfma_f32_16x16x32_bf16 v[84:87], v[100:103], a[100:103], v[84:87]
  v_mfma_f32_16x16x32_bf16 v[88:91], v[100:103], a[132:135], v[88:91]
  ds_read2_b32 v[100:101], v54 offset0:160 offset1:161
  ds_read2_b32 v[102:103], v54 offset0:162 offset1:163
  s_waitcnt lgkmcnt(6)
  v_mfma_f32_16x16x32_bf16 v[72:75], v[104:107], a[0:3], v[72:75]
  v_mfma_f32_16x16x32_bf16 v[76:79], v[104:107], a[32:35], v[76:79]
  v_mfma_f32_16x16x32_bf16 v[80:83], v[104:107], a[64:67], v[80:83]
  v_mfma_f32_16x16x32_bf16 v[84:87], v[104:107], a[96:99], v[84:87]
  v_mfma_f32_16x16x32_bf16 v[88:91], v[104:107], a[128:131], v[88:91]
  ds_read2_b32 v[104:105], v54 offset0:144 offset1:145
  ds_read2_b32 v[106:107], v54 offset0:146 offset1:147
  s_waitcnt lgkmcnt(6)
  v_mfma_f32_16x16x32_bf16 v[76:79], v[92:95], a[28:31], v[76:79]
  v_mfma_f32_16x16x32_bf16 v[80:83], v[92:95], a[60:63], v[80:83]
  v_mfma_f32_16x16x32_bf16 v[84:87], v[92:95], a[92:95], v[84:87]
  v_mfma_f32_16x16x32_bf16 v[88:91], v[92:95], a[124:127], v[88:91]
  ds_read2_b32 v[92:93], v54 offset0:128 offset1:129
  ds_read2_b32 v[94:95], v54 offset0:130 offset1:131
  s_waitcnt lgkmcnt(6)
  v_mfma_f32_16x16x32_bf16 v[76:79], v[96:99], a[24:27], v[76:79]
  v_mfma_f32_16x16x32_bf16 v[80:83], v[96:99], a[56:59], v[80:83]
  v_mfma_f32_16x16x32_bf16 v[84:87], v[96:99], a[88:91], v[84:87]
  v_mfma_f32_16x16x32_bf16 v[88:91], v[96:99], a[120:123], v[88:91]
  ds_read2_b32 v[96:97], v54 offset0:112 offset1:113
  ds_read2_b32 v[98:99], v54 offset0:114 offset1:115
  s_waitcnt lgkmcnt(6)
  v_mfma_f32_16x16x32_bf16 v[76:79], v[100:103], a[20:23], v[76:79]
  v_mfma_f32_16x16x32_bf16 v[80:83], v[100:103], a[52:55], v[80:83]
  v_mfma_f32_16x16x32_bf16 v[84:87], v[100:103], a[84:87], v[84:87]
  v_mfma_f32_16x16x32_bf16 v[88:91], v[100:103], a[116:119], v[88:91]
  ds_read2_b32 v[100:101], v54 offset0:96 offset1:97
  ds_read2_b32 v[102:103], v54 offset0:98 offset1:99
  s_waitcnt lgkmcnt(6)
  v_mfma_f32_16x16x32_bf16 v[76:79], v[104:107], a[16:19], v[76:79]
  v_mfma_f32_16x16x32_bf16 v[80:83], v[104:107], a[48:51], v[80:83]
  v_mfma_f32_16x16x32_bf16 v[84:87], v[104:107], a[80:83], v[84:87]
  v_mfma_f32_16x16x32_bf16 v[88:91], v[104:107], a[112:115], v[88:91]
  ds_read2_b32 v[104:105], v54 offset0:80 offset1:81
  ds_read2_b32 v[106:107], v54 offset0:82 offset1:83
  s_waitcnt lgkmcnt(6)
  v_mfma_f32_16x16x32_bf16 v[76:79], v[92:95], a[12:15], v[76:79]
  v_mfma_f32_16x16x32_bf16 v[80:83], v[92:95], a[44:47], v[80:83]
  v_mfma_f32_16x16x32_bf16 v[84:87], v[92:95], a[76:79], v[84:87]
  v_mfma_f32_16x16x32_bf16 v[88:91], v[92:95], a[108:111], v[88:91]
  ds_read2_b32 v[92:93], v54 offset0:64 offset1:65
  ds_read2_b32 v[94:95], v54 offset0:66 offset1:67
  s_waitcnt lgkmcnt(6)
  v_mfma_f32_16x16x32_bf16 v[76:79], v[96:99], a[8:11], v[76:79]
  v_mfma_f32_16x16x32_bf16 v[80:83], v[96:99], a[40:43], v[80:83]
  v_mfma_f32_16x16x32_bf16 v[84:87], v[96:99], a[72:75], v[84:87]
  v_mfma_f32_16x16x32_bf16 v[88:91], v[96:99], a[104:107], v[88:91]
  ds_read2_b32 v[96:97], v54 offset0:48 offset1:49
  ds_read2_b32 v[98:99], v54 offset0:50 offset1:51
  s_waitcnt lgkmcnt(6)
  v_mfma_f32_16x16x32_bf16 v[76:79], v[100:103], a[4:7], v[76:79]
  v_mfma_f32_16x16x32_bf16 v[80:83], v[100:103], a[36:39], v[80:83]
  v_mfma_f32_16x16x32_bf16 v[84:87], v[100:103], a[68:71], v[84:87]
  v_mfma_f32_16x16x32_bf16 v[88:91], v[100:103], a[100:103], v[88:91]
  ds_read2_b32 v[100:101], v54 offset0:32 offset1:33
  ds_read2_b32 v[102:103], v54 offset0:34 offset1:35
  s_waitcnt lgkmcnt(6)
  v_mfma_f32_16x16x32_bf16 v[76:79], v[104:107], a[0:3], v[76:79]
  v_mfma_f32_16x16x32_bf16 v[80:83], v[104:107], a[32:35], v[80:83]
  v_mfma_f32_16x16x32_bf16 v[84:87], v[104:107], a[64:67], v[84:87]
  v_mfma_f32_16x16x32_bf16 v[88:91], v[104:107], a[96:99], v[88:91]
  ds_read2_b32 v[104:105], v54 offset0:16 offset1:17
  ds_read2_b32 v[106:107], v54 offset0:18 offset1:19
  s_waitcnt lgkmcnt(6)
  v_mfma_f32_16x16x32_bf16 v[80:83], v[92:95], a[28:31], v[80:83]
  v_mfma_f32_16x16x32_bf16 v[84:87], v[92:95], a[60:63], v[84:87]
  v_mfma_f32_16x16x32_bf16 v[88:91], v[92:95], a[92:95], v[88:91]
  ds_read2_b32 v[92:93], v54 offset0:0 offset1:1
  ds_read2_b32 v[94:95], v54 offset0:2 offset1:3
  s_waitcnt lgkmcnt(6)
  v_mfma_f32_16x16x32_bf16 v[80:83], v[96:99], a[24:27], v[80:83]
  v_mfma_f32_16x16x32_bf16 v[84:87], v[96:99], a[56:59], v[84:87]
  v_mfma_f32_16x16x32_bf16 v[88:91], v[96:99], a[88:91], v[88:91]
  ds_read2_b32 v[96:97], v55 offset0:224 offset1:225
  ds_read2_b32 v[98:99], v55 offset0:226 offset1:227
  s_waitcnt lgkmcnt(6)
  v_mfma_f32_16x16x32_bf16 v[80:83], v[100:103], a[20:23], v[80:83]
  v_mfma_f32_16x16x32_bf16 v[84:87], v[100:103], a[52:55], v[84:87]
  v_mfma_f32_16x16x32_bf16 v[88:91], v[100:103], a[84:87], v[88:91]
  ds_read2_b32 v[100:101], v55 offset0:208 offset1:209
  ds_read2_b32 v[102:103], v55 offset0:210 offset1:211
  s_waitcnt lgkmcnt(6)
  v_mfma_f32_16x16x32_bf16 v[80:83], v[104:107], a[16:19], v[80:83]
  v_mfma_f32_16x16x32_bf16 v[84:87], v[104:107], a[48:51], v[84:87]
  v_mfma_f32_16x16x32_bf16 v[88:91], v[104:107], a[80:83], v[88:91]
  ds_read2_b32 v[104:105], v55 offset0:192 offset1:193
  ds_read2_b32 v[106:107], v55 offset0:194 offset1:195
  s_waitcnt lgkmcnt(6)
  v_mfma_f32_16x16x32_bf16 v[80:83], v[92:95], a[12:15], v[80:83]
  v_mfma_f32_16x16x32_bf16 v[84:87], v[92:95], a[44:47], v[84:87]
  v_mfma_f32_16x16x32_bf16 v[88:91], v[92:95], a[76:79], v[88:91]
  ds_read2_b32 v[92:93], v55 offset0:176 offset1:177
  ds_read2_b32 v[94:95], v55 offset0:178 offset1:179
  s_waitcnt lgkmcnt(6)
  v_mfma_f32_16x16x32_bf16 v[80:83], v[96:99], a[8:11], v[80:83]
  v_mfma_f32_16x16x32_bf16 v[84:87], v[96:99], a[40:43], v[84:87]
  v_mfma_f32_16x16x32_bf16 v[88:91], v[96:99], a[72:75], v[88:91]
  ds_read2_b32 v[96:97], v55 offset0:160 offset1:161
  ds_read2_b32 v[98:99], v55 offset0:162 offset1:163
  s_waitcnt lgkmcnt(6)
  v_mfma_f32_16x16x32_bf16 v[80:83], v[100:103], a[4:7], v[80:83]
  v_mfma_f32_16x16x32_bf16 v[84:87], v[100:103], a[36:39], v[84:87]
  v_mfma_f32_16x16x32_bf16 v[88:91], v[100:103], a[68:71], v[88:91]
  ds_read2_b32 v[100:101], v55 offset0:144 offset1:145
  ds_read2_b32 v[102:103], v55 offset0:146 offset1:147
  s_waitcnt lgkmcnt(6)
  v_mfma_f32_16x16x32_bf16 v[80:83], v[104:107], a[0:3], v[80:83]
  v_mfma_f32_16x16x32_bf16 v[84:87], v[104:107], a[32:35], v[84:87]
  v_mfma_f32_16x16x32_bf16 v[88:91], v[104:107], a[64:67], v[88:91]
  ds_read2_b32 v[104:105], v55 offset0:128 offset1:129
  ds_read2_b32 v[106:107], v55 offset0:130 offset1:131
  s_waitcnt lgkmcnt(6)
  v_mfma_f32_16x16x32_bf16 v[84:87], v[92:95], a[28:31], v[84:87]
  v_mfma_f32_16x16x32_bf16 v[88:91], v[92:95], a[60:63], v[88:91]
  ds_read2_b32 v[92:93], v55 offset0:112 offset1:113
  ds_read2_b32 v[94:95], v55 offset0:114 offset1:115
  s_waitcnt lgkmcnt(6)
  v_mfma_f32_16x16x32_bf16 v[84:87], v[96:99], a[24:27], v[84:87]
  v_mfma_f32_16x16x32_bf16 v[88:91], v[96:99], a[56:59], v[88:91]
  ds_read2_b32 v[96:97], v55 offset0:96 offset1:97
  ds_read2_b32 v[98:99], v55 offset0:98 offset1:99
  s_waitcnt lgkmcnt(6)
  v_mfma_f32_16x16x32_bf16 v[84:87], v[100:103], a[20:23], v[84:87]
  v_mfma_f32_16x16x32_bf16 v[88:91], v[100:103], a[52:55], v[88:91]
  ds_read2_b32 v[100:101], v55 offset0:80 offset1:81
  ds_read2_b32 v[102:103], v55 offset0:82 offset1:83
  s_waitcnt lgkmcnt(6)
  v_mfma_f32_16x16x32_bf16 v[84:87], v[104:107], a[16:19], v[84:87]
  v_mfma_f32_16x16x32_bf16 v[88:91], v[104:107], a[48:51], v[88:91]
  ds_read2_b32 v[104:105], v55 offset0:64 offset1:65
  ds_read2_b32 v[106:107], v55 offset0:66 offset1:67
  s_waitcnt lgkmcnt(6)
  v_mfma_f32_16x16x32_bf16 v[84:87], v[92:95], a[12:15], v[84:87]
  v_mfma_f32_16x16x32_bf16 v[88:91], v[92:95], a[44:47], v[88:91]
  ds_read2_b32 v[92:93], v55 offset0:48 offset1:49
  ds_read2_b32 v[94:95], v55 offset0:50 offset1:51
  s_waitcnt lgkmcnt(6)
  v_mfma_f32_16x16x32_bf16 v[84:87], v[96:99], a[8:11], v[84:87]
  v_mfma_f32_16x16x32_bf16 v[88:91], v[96:99], a[40:43], v[88:91]
  ds_read2_b32 v[96:97], v55 offset0:32 offset1:33
  ds_read2_b32 v[98:99], v55 offset0:34 offset1:35
  s_waitcnt lgkmcnt(6)
  v_mfma_f32_16x16x32_bf16 v[84:87], v[100:103], a[4:7], v[84:87]
  v_mfma_f32_16x16x32_bf16 v[88:91], v[100:103], a[36:39], v[88:91]
  ds_read2_b32 v[100:101], v55 offset0:16 offset1:17
  ds_read2_b32 v[102:103], v55 offset0:18 offset1:19
  s_waitcnt lgkmcnt(6)
  v_mfma_f32_16x16x32_bf16 v[84:87], v[104:107], a[0:3], v[84:87]
  v_mfma_f32_16x16x32_bf16 v[88:91], v[104:107], a[32:35], v[88:91]
  ds_read2_b32 v[104:105], v55 offset0:0 offset1:1
  ds_read2_b32 v[106:107], v55 offset0:2 offset1:3
  s_waitcnt lgkmcnt(6)
  v_mfma_f32_16x16x32_bf16 v[88:91], v[92:95], a[28:31], v[88:91]
  ds_read2_b32 v[92:93], v56 offset0:224 offset1:225
  ds_read2_b32 v[94:95], v56 offset0:226 offset1:227
  s_waitcnt lgkmcnt(6)
  v_mfma_f32_16x16x32_bf16 v[88:91], v[96:99], a[24:27], v[88:91]
  ds_read2_b32 v[96:97], v56 offset0:208 offset1:209
  ds_read2_b32 v[98:99], v56 offset0:210 offset1:211
  s_waitcnt lgkmcnt(6)
  v_mfma_f32_16x16x32_bf16 v[88:91], v[100:103], a[20:23], v[88:91]
  ds_read2_b32 v[100:101], v56 offset0:192 offset1:193
  ds_read2_b32 v[102:103], v56 offset0:194 offset1:195
  s_waitcnt lgkmcnt(6)
  v_mfma_f32_16x16x32_bf16 v[88:91], v[104:107], a[16:19], v[88:91]
  ds_read2_b32 v[104:105], v56 offset0:176 offset1:177
  ds_read2_b32 v[106:107], v56 offset0:178 offset1:179
  s_waitcnt lgkmcnt(6)
  v_mfma_f32_16x16x32_bf16 v[88:91], v[92:95], a[12:15], v[88:91]
  s_waitcnt lgkmcnt(4)
  v_mfma_f32_16x16x32_bf16 v[88:91], v[96:99], a[8:11], v[88:91]
  s_waitcnt lgkmcnt(2)
  v_mfma_f32_16x16x32_bf16 v[88:91], v[100:103], a[4:7], v[88:91]
  s_waitcnt lgkmcnt(0)
  v_mfma_f32_16x16x32_bf16 v[88:91], v[104:107], a[0:3], v[88:91]
  v_lshlrev_b32 v46, 5, v4
  v_lshl_add_u32 v46, v3, 3, v46
  v_add_u32 v46, s17, v46
  ds_read_b64 v[108:109], v46 offset:512
  ds_read_b64 v[110:111], v46 offset:1024
  ds_read_b64 v[112:113], v46 offset:1536
  ds_read_b64 v[114:115], v46 offset:2048
  ds_read_b64 v[116:117], v46 offset:2560
  ds_read_b64 v[118:119], v46 offset:3072
  ds_read_b64 v[120:121], v46 offset:3584
  ds_read_b64 v[122:123], v46 offset:4096
  s_waitcnt lgkmcnt(0)
  v_lshlrev_b32 v124, 16, v108
  v_and_b32 v125, 0xffff0000, v108
  v_lshlrev_b32 v126, 16, v109
  v_and_b32 v127, 0xffff0000, v109
  v_mul_f32 v124, v124, v33
  v_mul_f32 v125, v125, v33
  v_mul_f32 v126, v126, v33
  v_mul_f32 v127, v127, v33
  v_cvt_pk_bf16_f32 v128, v124, v125
  v_cvt_pk_bf16_f32 v129, v126, v127
  v_cvt_pk_bf16_f32 v130, v60, v61
  v_cvt_pk_bf16_f32 v131, v62, v63
  v_lshlrev_b32 v124, 16, v128
  v_and_b32 v125, 0xffff0000, v128
  v_lshlrev_b32 v132, 16, v130
  v_and_b32 v133, 0xffff0000, v130
  v_lshlrev_b32 v126, 16, v129
  v_and_b32 v127, 0xffff0000, v129
  v_lshlrev_b32 v134, 16, v131
  v_and_b32 v135, 0xffff0000, v131
  v_add_f32 v124, v124, v132
  v_add_f32 v125, v125, v133
  v_add_f32 v126, v126, v134
  v_add_f32 v127, v127, v135
  v_cvt_pk_bf16_f32 v108, v124, v125
  v_cvt_pk_bf16_f32 v109, v126, v127
  ds_write_b64 v46, v[108:109] offset:512
  v_lshlrev_b32 v124, 16, v110
  v_and_b32 v125, 0xffff0000, v110
  v_lshlrev_b32 v126, 16, v111
  v_and_b32 v127, 0xffff0000, v111
  v_mul_f32 v124, v124, v33
  v_mul_f32 v125, v125, v33
  v_mul_f32 v126, v126, v33
  v_mul_f32 v127, v127, v33
  v_cvt_pk_bf16_f32 v128, v124, v125
  v_cvt_pk_bf16_f32 v129, v126, v127
  v_cvt_pk_bf16_f32 v130, v64, v65
  v_cvt_pk_bf16_f32 v131, v66, v67
  v_lshlrev_b32 v124, 16, v128
  v_and_b32 v125, 0xffff0000, v128
  v_lshlrev_b32 v132, 16, v130
  v_and_b32 v133, 0xffff0000, v130
  v_lshlrev_b32 v126, 16, v129
  v_and_b32 v127, 0xffff0000, v129
  v_lshlrev_b32 v134, 16, v131
  v_and_b32 v135, 0xffff0000, v131
  v_add_f32 v124, v124, v132
  v_add_f32 v125, v125, v133
  v_add_f32 v126, v126, v134
  v_add_f32 v127, v127, v135
  v_cvt_pk_bf16_f32 v110, v124, v125
  v_cvt_pk_bf16_f32 v111, v126, v127
  ds_write_b64 v46, v[110:111] offset:1024
  v_lshlrev_b32 v124, 16, v112
  v_and_b32 v125, 0xffff0000, v112
  v_lshlrev_b32 v126, 16, v113
  v_and_b32 v127, 0xffff0000, v113
  v_mul_f32 v124, v124, v33
  v_mul_f32 v125, v125, v33
  v_mul_f32 v126, v126, v33
  v_mul_f32 v127, v127, v33
  v_cvt_pk_bf16_f32 v128, v124, v125
  v_cvt_pk_bf16_f32 v129, v126, v127
  v_cvt_pk_bf16_f32 v130, v68, v69
  v_cvt_pk_bf16_f32 v131, v70, v71
  v_lshlrev_b32 v124, 16, v128
  v_and_b32 v125, 0xffff0000, v128
  v_lshlrev_b32 v132, 16, v130
  v_and_b32 v133, 0xffff0000, v130
  v_lshlrev_b32 v126, 16, v129
  v_and_b32 v127, 0xffff0000, v129
  v_lshlrev_b32 v134, 16, v131
  v_and_b32 v135, 0xffff0000, v131
  v_add_f32 v124, v124, v132
  v_add_f32 v125, v125, v133
  v_add_f32 v126, v126, v134
  v_add_f32 v127, v127, v135
  v_cvt_pk_bf16_f32 v112, v124, v125
  v_cvt_pk_bf16_f32 v113, v126, v127
  ds_write_b64 v46, v[112:113] offset:1536
  v_lshlrev_b32 v124, 16, v114
  v_and_b32 v125, 0xffff0000, v114
  v_lshlrev_b32 v126, 16, v115
  v_and_b32 v127, 0xffff0000, v115
  v_mul_f32 v124, v124, v33
  v_mul_f32 v125, v125, v33
  v_mul_f32 v126, v126, v33
  v_mul_f32 v127, v127, v33
  v_cvt_pk_bf16_f32 v128, v124, v125
  v_cvt_pk_bf16_f32 v129, v126, v127
  v_cvt_pk_bf16_f32 v130, v72, v73
  v_cvt_pk_bf16_f32 v131, v74, v75
  v_lshlrev_b32 v124, 16, v128
  v_and_b32 v125, 0xffff0000, v128
  v_lshlrev_b32 v132, 16, v130
  v_and_b32 v133, 0xffff0000, v130
  v_lshlrev_b32 v126, 16, v129
  v_and_b32 v127, 0xffff0000, v129
  v_lshlrev_b32 v134, 16, v131
  v_and_b32 v135, 0xffff0000, v131
  v_add_f32 v124, v124, v132
  v_add_f32 v125, v125, v133
  v_add_f32 v126, v126, v134
  v_add_f32 v127, v127, v135
  v_cvt_pk_bf16_f32 v114, v124, v125
  v_cvt_pk_bf16_f32 v115, v126, v127
  ds_write_b64 v46, v[114:115] offset:2048
  v_lshlrev_b32 v124, 16, v116
  v_and_b32 v125, 0xffff0000, v116
  v_lshlrev_b32 v126, 16, v117
  v_and_b32 v127, 0xffff0000, v117
  v_mul_f32 v124, v124, v33
  v_mul_f32 v125, v125, v33
  v_mul_f32 v126, v126, v33
  v_mul_f32 v127, v127, v33
  v_cvt_pk_bf16_f32 v128, v124, v125
  v_cvt_pk_bf16_f32 v129, v126, v127
  v_cvt_pk_bf16_f32 v130, v76, v77
  v_cvt_pk_bf16_f32 v131, v78, v79
  v_lshlrev_b32 v124, 16, v128
  v_and_b32 v125, 0xffff0000, v128
  v_lshlrev_b32 v132, 16, v130
  v_and_b32 v133, 0xffff0000, v130
  v_lshlrev_b32 v126, 16, v129
  v_and_b32 v127, 0xffff0000, v129
  v_lshlrev_b32 v134, 16, v131
  v_and_b32 v135, 0xffff0000, v131
  v_add_f32 v124, v124, v132
  v_add_f32 v125, v125, v133
  v_add_f32 v126, v126, v134
  v_add_f32 v127, v127, v135
  v_cvt_pk_bf16_f32 v116, v124, v125
  v_cvt_pk_bf16_f32 v117, v126, v127
  ds_write_b64 v46, v[116:117] offset:2560
  v_lshlrev_b32 v124, 16, v118
  v_and_b32 v125, 0xffff0000, v118
  v_lshlrev_b32 v126, 16, v119
  v_and_b32 v127, 0xffff0000, v119
  v_mul_f32 v124, v124, v33
  v_mul_f32 v125, v125, v33
  v_mul_f32 v126, v126, v33
  v_mul_f32 v127, v127, v33
  v_cvt_pk_bf16_f32 v128, v124, v125
  v_cvt_pk_bf16_f32 v129, v126, v127
  v_cvt_pk_bf16_f32 v130, v80, v81
  v_cvt_pk_bf16_f32 v131, v82, v83
  v_lshlrev_b32 v124, 16, v128
  v_and_b32 v125, 0xffff0000, v128
  v_lshlrev_b32 v132, 16, v130
  v_and_b32 v133, 0xffff0000, v130
  v_lshlrev_b32 v126, 16, v129
  v_and_b32 v127, 0xffff0000, v129
  v_lshlrev_b32 v134, 16, v131
  v_and_b32 v135, 0xffff0000, v131
  v_add_f32 v124, v124, v132
  v_add_f32 v125, v125, v133
  v_add_f32 v126, v126, v134
  v_add_f32 v127, v127, v135
  v_cvt_pk_bf16_f32 v118, v124, v125
  v_cvt_pk_bf16_f32 v119, v126, v127
  ds_write_b64 v46, v[118:119] offset:3072
  v_lshlrev_b32 v124, 16, v120
  v_and_b32 v125, 0xffff0000, v120
  v_lshlrev_b32 v126, 16, v121
  v_and_b32 v127, 0xffff0000, v121
  v_mul_f32 v124, v124, v33
  v_mul_f32 v125, v125, v33
  v_mul_f32 v126, v126, v33
  v_mul_f32 v127, v127, v33
  v_cvt_pk_bf16_f32 v128, v124, v125
  v_cvt_pk_bf16_f32 v129, v126, v127
  v_cvt_pk_bf16_f32 v130, v84, v85
  v_cvt_pk_bf16_f32 v131, v86, v87
  v_lshlrev_b32 v124, 16, v128
  v_and_b32 v125, 0xffff0000, v128
  v_lshlrev_b32 v132, 16, v130
  v_and_b32 v133, 0xffff0000, v130
  v_lshlrev_b32 v126, 16, v129
  v_and_b32 v127, 0xffff0000, v129
  v_lshlrev_b32 v134, 16, v131
  v_and_b32 v135, 0xffff0000, v131
  v_add_f32 v124, v124, v132
  v_add_f32 v125, v125, v133
  v_add_f32 v126, v126, v134
  v_add_f32 v127, v127, v135
  v_cvt_pk_bf16_f32 v120, v124, v125
  v_cvt_pk_bf16_f32 v121, v126, v127
  ds_write_b64 v46, v[120:121] offset:3584
  v_lshlrev_b32 v124, 16, v122
  v_and_b32 v125, 0xffff0000, v122
  v_lshlrev_b32 v126, 16, v123
  v_and_b32 v127, 0xffff0000, v123
  v_mul_f32 v124, v124, v33
  v_mul_f32 v125, v125, v33
  v_mul_f32 v126, v126, v33
  v_mul_f32 v127, v127, v33
  v_cvt_pk_bf16_f32 v128, v124, v125
  v_cvt_pk_bf16_f32 v129, v126, v127
  v_cvt_pk_bf16_f32 v130, v88, v89
  v_cvt_pk_bf16_f32 v131, v90, v91
  v_lshlrev_b32 v124, 16, v128
  v_and_b32 v125, 0xffff0000, v128
  v_lshlrev_b32 v132, 16, v130
  v_and_b32 v133, 0xffff0000, v130
  v_lshlrev_b32 v126, 16, v129
  v_and_b32 v127, 0xffff0000, v129
  v_lshlrev_b32 v134, 16, v131
  v_and_b32 v135, 0xffff0000, v131
  v_add_f32 v124, v124, v132
  v_add_f32 v125, v125, v133
  v_add_f32 v126, v126, v134
  v_add_f32 v127, v127, v135
  v_cvt_pk_bf16_f32 v122, v124, v125
  v_cvt_pk_bf16_f32 v123, v126, v127
  ds_write_b64 v46, v[122:123] offset:4096
  s_waitcnt lgkmcnt(0)
  s_barrier
  v_lshlrev_b32 v6, 3, v0
  v_mul_u32_u24 v5, 7168, v0
  v_add_u32 v36, 512, v6
  ds_read_b64 v[8:9], v36
  v_add_u32 v36, 25088, v6
  ds_read_b64 v[10:11], v36
  v_add_u32 v36, 49664, v6
  ds_read_b64 v[12:13], v36
  v_add_u32 v36, 74240, v6
  ds_read_b64 v[14:15], v36
  s_waitcnt lgkmcnt(0)
  s_add_u32 s22, s21, 0
  s_add_u32 s23, s22, 3584
  v_perm_b32 v16, v10, v8, s24
  v_perm_b32 v17, v14, v12, s24
  buffer_store_dwordx2 v[16:17], v5, s[88:91], s22 offen offset:0
  v_perm_b32 v18, v10, v8, s25
  v_perm_b32 v19, v14, v12, s25
  buffer_store_dwordx2 v[18:19], v5, s[88:91], s22 offen offset:1792
  v_perm_b32 v20, v11, v9, s24
  v_perm_b32 v21, v15, v13, s24
  buffer_store_dwordx2 v[20:21], v5, s[88:91], s23 offen offset:0
  v_perm_b32 v22, v11, v9, s25
  v_perm_b32 v23, v15, v13, s25
  buffer_store_dwordx2 v[22:23], v5, s[88:91], s23 offen offset:1792
  v_add_u32 v36, 2560, v6
  ds_read_b64 v[8:9], v36
  v_add_u32 v36, 27136, v6
  ds_read_b64 v[10:11], v36
  v_add_u32 v36, 51712, v6
  ds_read_b64 v[12:13], v36
  v_add_u32 v36, 76288, v6
  ds_read_b64 v[14:15], v36
  s_waitcnt lgkmcnt(0)
  s_add_u32 s22, s21, 1835008
  s_add_u32 s23, s22, 3584
  v_perm_b32 v24, v10, v8, s24
  v_perm_b32 v25, v14, v12, s24
  buffer_store_dwordx2 v[24:25], v5, s[88:91], s22 offen offset:0
  v_perm_b32 v26, v10, v8, s25
  v_perm_b32 v27, v14, v12, s25
  buffer_store_dwordx2 v[26:27], v5, s[88:91], s22 offen offset:1792
  v_perm_b32 v28, v11, v9, s24
  v_perm_b32 v29, v15, v13, s24
  buffer_store_dwordx2 v[28:29], v5, s[88:91], s23 offen offset:0
  v_perm_b32 v30, v11, v9, s25
  v_perm_b32 v31, v15, v13, s25
  buffer_store_dwordx2 v[30:31], v5, s[88:91], s23 offen offset:1792
  s_branch wk_loop
wk_tok:
  s_sub_u32 s3, s3, 752
  s_cmp_ge_u32 s3, 512
  s_cbranch_scc1 wk_done
  s_lshr_b32 s17, s3, 3
  s_and_b32 s18, s3, 3
  s_bitcmp1_b32 s3, 2
  s_cbranch_scc1 wk_toko
  s_lshl_b32 s20, s18, 2
  s_add_u32 s20, s20, s16
  s_lshl_b32 s21, s17, 4
  s_add_u32 s21, s21, s20
  s_mul_i32 s21, s21, 28672
  s_add_u32 s21, s21, 12845056
  s_mul_i32 s23, s17, 28672
  s_add_u32 s23, s23, 73859072
  s_mul_i32 s24, s17, 7168
  s_add_u32 s24, s24, 88002560
  s_lshr_b32 s25, s17, 3
  s_lshl_b32 s25, s25, 4
  s_add_u32 s25, s25, s20
  s_lshl_b32 s25, s25, 7
  s_add_u32 s25, s25, 88477696
  v_mov_b32 v60, 0
  s_mov_b32 s30, 0
wp_wf:
  buffer_load_dword v61, v60, s[8:11], s25 offen sc1
  s_waitcnt vmcnt(0)
  v_cmp_ne_u32 vcc, 56, v61
  s_cbranch_vccz wp_wf_ok
  s_sleep 4
  s_cmp_ge_u32 s17, 56
  s_cbranch_scc1 wp_wf_bo
  s_sleep 127
wp_wf_bo:
  s_add_u32 s30, s30, 1
  s_cmp_lt_u32 s30, 2000000
  s_cbranch_scc1 wp_wf
  s_branch wp_abort
wp_wf_ok:
  s_lshl_b32 s25, s17, 1
  s_mul_i32 s25, s25, 20480
  s_add_u32 s25, s25, 85381120
  s_lshl_b32 s26, s20, 10
  s_add_u32 s26, s26, s25
  s_lshl_b32 s27, s18, 10
  s_add_u32 s27, s27, s25
  s_lshr_b32 s28, s16, 1
  s_lshl_b32 s28, s28, 3
  s_add_u32 s27, s27, s28
  s_add_u32 s27, s27, 16384
  s_and_b32 s28, s16, 1
  s_cmp_eq_u32 s28, 0
  s_cselect_b32 s50, -1, 0
  s_cselect_b32 s51, 0, -1
  v_mov_b32 v44, -1
  v_mov_b32 v45, -1
  v_mov_b32 v46, -1
  v_mov_b32 v47, -1
  s_add_u32 s28, s26, 0
  s_add_u32 s29, s27, 0
  buffer_store_dwordx4 v[44:47], v2, s[8:11], s28 offen sc1
  s_mov_b64 exec, s[50:51]
  buffer_store_dwordx2 v[44:45], v2, s[8:11], s29 offen sc1
  s_mov_b64 exec, -1
  s_add_u32 s28, s26, 20480
  s_add_u32 s29, s27, 20480
  buffer_store_dwordx4 v[44:47], v2, s[8:11], s28 offen sc1
  s_mov_b64 exec, s[50:51]
  buffer_store_dwordx2 v[44:45], v2, s[8:11], s29 offen sc1
  s_mov_b64 exec, -1
  s_add_u32 s22, s21, 0
  buffer_load_dwordx4 a[0:3], v2, s[8:11], s22 offen offset:0 sc1
  buffer_load_dwordx4 a[4:7], v2, s[8:11], s22 offen offset:1024 sc1
  buffer_load_dwordx4 a[8:11], v2, s[8:11], s22 offen offset:2048 sc1
  buffer_load_dwordx4 a[12:15], v2, s[8:11], s22 offen offset:3072 sc1
  s_add_u32 s22, s21, 4096
  buffer_load_dwordx4 a[16:19], v2, s[8:11], s22 offen offset:0 sc1
  buffer_load_dwordx4 a[20:23], v2, s[8:11], s22 offen offset:1024 sc1
  buffer_load_dwordx4 a[24:27], v2, s[8:11], s22 offen offset:2048 sc1
  buffer_load_dwordx4 a[28:31], v2, s[8:11], s22 offen offset:3072 sc1
  s_add_u32 s22, s21, 8192
  buffer_load_dwordx4 a[32:35], v2, s[8:11], s22 offen offset:0 sc1
  buffer_load_dwordx4 a[36:39], v2, s[8:11], s22 offen offset:1024 sc1
  buffer_load_dwordx4 a[40:43], v2, s[8:11], s22 offen offset:2048 sc1
  buffer_load_dwordx4 a[44:47], v2, s[8:11], s22 offen offset:3072 sc1
  s_add_u32 s22, s21, 12288
  buffer_load_dwordx4 a[48:51], v2, s[8:11], s22 offen offset:0 sc1
  buffer_load_dwordx4 a[52:55], v2, s[8:11], s22 offen offset:1024 sc1
  buffer_load_dwordx4 a[56:59], v2, s[8:11], s22 offen offset:2048 sc1
  buffer_load_dwordx4 a[60:63], v2, s[8:11], s22 offen offset:3072 sc1
  s_add_u32 s22, s21, 16384
  buffer_load_dwordx4 a[64:67], v2, s[8:11], s22 offen offset:0 sc1
  buffer_load_dwordx4 a[68:71], v2, s[8:11], s22 offen offset:1024 sc1
  buffer_load_dwordx4 a[72:75], v2, s[8:11], s22 offen offset:2048 sc1
  buffer_load_dwordx4 a[76:79], v2, s[8:11], s22 offen offset:3072 sc1
  s_add_u32 s22, s21, 20480
  buffer_load_dwordx4 a[80:83], v2, s[8:11], s22 offen offset:0 sc1
  buffer_load_dwordx4 a[84:87], v2, s[8:11], s22 offen offset:1024 sc1
  buffer_load_dwordx4 a[88:91], v2, s[8:11], s22 offen offset:2048 sc1
  buffer_load_dwordx4 a[92:95], v2, s[8:11], s22 offen offset:3072 sc1
  s_add_u32 s22, s21, 24576
  buffer_load_dwordx4 a[96:99], v2, s[8:11], s22 offen offset:0 sc1
  buffer_load_dwordx4 a[100:103], v2, s[8:11], s22 offen offset:1024 sc1
  buffer_load_dwordx4 a[104:107], v2, s[8:11], s22 offen offset:2048 sc1
  buffer_load_dwordx4 a[108:111], v2, s[8:11], s22 offen offset:3072 sc1
  s_add_u32 s22, s23, 0
  buffer_load_dwordx4 a[112:115], v2, s[8:11], s22 offen offset:0 sc1
  buffer_load_dwordx4 a[116:119], v2, s[8:11], s22 offen offset:1024 sc1
  buffer_load_dwordx4 a[120:123], v2, s[8:11], s22 offen offset:2048 sc1
  buffer_load_dwordx4 a[124:127], v2, s[8:11], s22 offen offset:3072 sc1
  s_add_u32 s22, s23, 4096
  buffer_load_dwordx4 a[128:131], v2, s[8:11], s22 offen offset:0 sc1
  buffer_load_dwordx4 a[132:135], v2, s[8:11], s22 offen offset:1024 sc1
  buffer_load_dwordx4 a[136:139], v2, s[8:11], s22 offen offset:2048 sc1
  buffer_load_dwordx4 a[140:143], v2, s[8:11], s22 offen offset:3072 sc1
  s_add_u32 s22, s23, 8192
  buffer_load_dwordx4 a[144:147], v2, s[8:11], s22 offen offset:0 sc1
  buffer_load_dwordx4 a[148:151], v2, s[8:11], s22 offen offset:1024 sc1
  buffer_load_dwordx4 a[152:155], v2, s[8:11], s22 offen offset:2048 sc1
  buffer_load_dwordx4 a[156:159], v2, s[8:11], s22 offen offset:3072 sc1
  s_add_u32 s22, s23, 12288
  buffer_load_dwordx4 a[160:163], v2, s[8:11], s22 offen offset:0 sc1
  buffer_load_dwordx4 a[164:167], v2, s[8:11], s22 offen offset:1024 sc1
  buffer_load_dwordx4 a[168:171], v2, s[8:11], s22 offen offset:2048 sc1
  buffer_load_dwordx4 a[172:175], v2, s[8:11], s22 offen offset:3072 sc1
  s_add_u32 s22, s23, 16384
  buffer_load_dwordx4 a[176:179], v2, s[8:11], s22 offen offset:0 sc1
  buffer_load_dwordx4 a[180:183], v2, s[8:11], s22 offen offset:1024 sc1
  buffer_load_dwordx4 a[184:187], v2, s[8:11], s22 offen offset:2048 sc1
  buffer_load_dwordx4 a[188:191], v2, s[8:11], s22 offen offset:3072 sc1
  s_add_u32 s22, s23, 20480
  buffer_load_dwordx4 a[192:195], v2, s[8:11], s22 offen offset:0 sc1
  buffer_load_dwordx4 a[196:199], v2, s[8:11], s22 offen offset:1024 sc1
  buffer_load_dwordx4 a[200:203], v2, s[8:11], s22 offen offset:2048 sc1
  buffer_load_dwordx4 a[204:207], v2, s[8:11], s22 offen offset:3072 sc1
  s_add_u32 s22, s23, 24576
  buffer_load_dwordx4 a[208:211], v2, s[8:11], s22 offen offset:0 sc1
  buffer_load_dwordx4 a[212:215], v2, s[8:11], s22 offen offset:1024 sc1
  buffer_load_dwordx4 a[216:219], v2, s[8:11], s22 offen offset:2048 sc1
  buffer_load_dwordx4 a[220:223], v2, s[8:11], s22 offen offset:3072 sc1
  v_lshl_add_u32 v5, v3, 2, 0
  v_cmp_le_u32 s[40:41], v5, v4
  v_lshl_add_u32 v5, v3, 2, 1
  v_cmp_le_u32 s[42:43], v5, v4
  v_lshl_add_u32 v5, v3, 2, 2
  v_cmp_le_u32 s[44:45], v5, v4
  v_lshl_add_u32 v5, v3, 2, 3
  v_cmp_le_u32 s[46:47], v5, v4
  v_cmp_gt_u32 s[48:49], 2, v3
  v_mov_b32 v6, 0xff800000
  s_waitcnt vmcnt(0)
  s_lshl_b32 s25, s17, 7
  s_add_u32 s25, s25, 88494080
  v_mov_b32 v5, 1
  v_mov_b32 v7, 0
  s_waitcnt vmcnt(0)
  s_mov_b64 exec, 1
  buffer_atomic_add v5, v7, s[8:11], s25 offen
  s_mov_b64 exec, -1
  v_mfma_f32_16x16x32_bf16 v[8:11], a[112:115], a[0:3], 0
  v_mfma_f32_16x16x32_bf16 v[12:15], a[112:115], a[56:59], 0
  v_mfma_f32_16x16x32_bf16 v[16:19], a[168:171], a[56:59], 0
  v_mfma_f32_16x16x32_bf16 v[8:11], a[116:119], a[4:7], v[8:11]
  v_mfma_f32_16x16x32_bf16 v[12:15], a[116:119], a[60:63], v[12:15]
  v_mfma_f32_16x16x32_bf16 v[16:19], a[172:175], a[60:63], v[16:19]
  v_mfma_f32_16x16x32_bf16 v[8:11], a[120:123], a[8:11], v[8:11]
  v_mfma_f32_16x16x32_bf16 v[12:15], a[120:123], a[64:67], v[12:15]
  v_mfma_f32_16x16x32_bf16 v[16:19], a[176:179], a[64:67], v[16:19]
  v_mfma_f32_16x16x32_bf16 v[8:11], a[124:127], a[12:15], v[8:11]
  v_mfma_f32_16x16x32_bf16 v[12:15], a[124:127], a[68:71], v[12:15]
  v_mfma_f32_16x16x32_bf16 v[16:19], a[180:183], a[68:71], v[16:19]
  v_mfma_f32_16x16x32_bf16 v[8:11], a[128:131], a[16:19], v[8:11]
  v_mfma_f32_16x16x32_bf16 v[12:15], a[128:131], a[72:75], v[12:15]
  v_mfma_f32_16x16x32_bf16 v[16:19], a[184:187], a[72:75], v[16:19]
  v_mfma_f32_16x16x32_bf16 v[8:11], a[132:135], a[20:23], v[8:11]
  v_mfma_f32_16x16x32_bf16 v[12:15], a[132:135], a[76:79], v[12:15]
  v_mfma_f32_16x16x32_bf16 v[16:19], a[188:191], a[76:79], v[16:19]
  v_mfma_f32_16x16x32_bf16 v[8:11], a[136:139], a[24:27], v[8:11]
  v_mfma_f32_16x16x32_bf16 v[12:15], a[136:139], a[80:83], v[12:15]
  v_mfma_f32_16x16x32_bf16 v[16:19], a[192:195], a[80:83], v[16:19]
  v_mfma_f32_16x16x32_bf16 v[8:11], a[140:143], a[28:31], v[8:11]
  v_mfma_f32_16x16x32_bf16 v[12:15], a[140:143], a[84:87], v[12:15]
  v_mfma_f32_16x16x32_bf16 v[16:19], a[196:199], a[84:87], v[16:19]
  v_mfma_f32_16x16x32_bf16 v[8:11], a[144:147], a[32:35], v[8:11]
  v_mfma_f32_16x16x32_bf16 v[12:15], a[144:147], a[88:91], v[12:15]
  v_mfma_f32_16x16x32_bf16 v[16:19], a[200:203], a[88:91], v[16:19]
  v_mfma_f32_16x16x32_bf16 v[8:11], a[148:151], a[36:39], v[8:11]
  v_mfma_f32_16x16x32_bf16 v[12:15], a[148:151], a[92:95], v[12:15]
  v_mfma_f32_16x16x32_bf16 v[16:19], a[204:207], a[92:95], v[16:19]
  v_mfma_f32_16x16x32_bf16 v[8:11], a[152:155], a[40:43], v[8:11]
  v_mfma_f32_16x16x32_bf16 v[12:15], a[152:155], a[96:99], v[12:15]
  v_mfma_f32_16x16x32_bf16 v[16:19], a[208:211], a[96:99], v[16:19]
  v_mfma_f32_16x16x32_bf16 v[8:11], a[156:159], a[44:47], v[8:11]
  v_mfma_f32_16x16x32_bf16 v[12:15], a[156:159], a[100:103], v[12:15]
  v_mfma_f32_16x16x32_bf16 v[16:19], a[212:215], a[100:103], v[16:19]
  v_mfma_f32_16x16x32_bf16 v[8:11], a[160:163], a[48:51], v[8:11]
  v_mfma_f32_16x16x32_bf16 v[12:15], a[160:163], a[104:107], v[12:15]
  v_mfma_f32_16x16x32_bf16 v[16:19], a[216:219], a[104:107], v[16:19]
  v_mfma_f32_16x16x32_bf16 v[8:11], a[164:167], a[52:55], v[8:11]
  v_mfma_f32_16x16x32_bf16 v[12:15], a[164:167], a[108:111], v[12:15]
  v_mfma_f32_16x16x32_bf16 v[16:19], a[220:223], a[108:111], v[16:19]
  s_mul_i32 s22, s20, 448
  v_mov_b32 v62, s22
  s_mov_b32 s30, 0
wp_pm:
  s_cmp_ge_u32 s17, 64
  s_cbranch_scc1 wp_pf
  buffer_load_dword v61, v62, s[8:11], s24 offen sc1
  s_waitcnt vmcnt(0)
  v_cmp_eq_u32 vcc, -1, v61
  s_cbranch_vccnz wp_pr
wp_pf:
  s_add_u32 s22, s24, 4096
  buffer_load_dwordx4 v[64:67], v2, s[8:11], s24 offen offset:0 sc1
  buffer_load_dwordx4 v[68:71], v2, s[8:11], s24 offen offset:1024 sc1
  buffer_load_dwordx4 v[72:75], v2, s[8:11], s24 offen offset:2048 sc1
  buffer_load_dwordx4 v[76:79], v2, s[8:11], s24 offen offset:3072 sc1
  buffer_load_dwordx4 v[80:83], v2, s[8:11], s22 offen offset:0 sc1
  buffer_load_dwordx4 v[84:87], v2, s[8:11], s22 offen offset:1024 sc1
  buffer_load_dwordx4 v[88:91], v2, s[8:11], s22 offen offset:2048 sc1
  s_waitcnt vmcnt(0)
  v_max_u32 v61, v64, v65
  v_max3_u32 v61, v61, v66, v67
  v_max3_u32 v61, v61, v68, v69
  v_max3_u32 v61, v61, v70, v71
  v_max3_u32 v61, v61, v72, v73
  v_max3_u32 v61, v61, v74, v75
  v_max3_u32 v61, v61, v76, v77
  v_max3_u32 v61, v61, v78, v79
  v_max3_u32 v61, v61, v80, v81
  v_max3_u32 v61, v61, v82, v83
  v_max3_u32 v61, v61, v84, v85
  v_max3_u32 v61, v61, v86, v87
  v_max3_u32 v61, v61, v88, v89
  v_max3_u32 v61, v61, v90, v91
  v_cmp_eq_u32 vcc, -1, v61
  s_cbranch_vccz wp_pk
wp_pr:
  s_sleep 4
  s_cmp_ge_u32 s17, 56
  s_cbranch_scc1 wp_pm_bo
  s_sleep 127
wp_pm_bo:
  s_add_u32 s30, s30, 1
  s_cmp_lt_u32 s30, 2000000
  s_cbranch_scc1 wp_pm
  s_branch wp_abort
wp_pk:
  buffer_load_dword v250, v251, s[8:11], 0 offen sc1
  v_mfma_f32_16x16x32_bf16 v[20:23], v[64:67], a[0:3], 0
  v_mfma_f32_16x16x32_bf16 v[24:27], v[64:67], a[4:7], 0
  v_mfma_f32_16x16x32_bf16 v[28:31], v[64:67], a[56:59], 0
  v_mfma_f32_16x16x32_bf16 v[32:35], v[64:67], a[60:63], 0
  v_mfma_f32_16x16x32_bf16 v[20:23], v[68:71], a[8:11], v[20:23]
  v_mfma_f32_16x16x32_bf16 v[24:27], v[68:71], a[12:15], v[24:27]
  v_mfma_f32_16x16x32_bf16 v[28:31], v[68:71], a[64:67], v[28:31]
  v_mfma_f32_16x16x32_bf16 v[32:35], v[68:71], a[68:71], v[32:35]
  v_mfma_f32_16x16x32_bf16 v[20:23], v[72:75], a[16:19], v[20:23]
  v_mfma_f32_16x16x32_bf16 v[24:27], v[72:75], a[20:23], v[24:27]
  v_mfma_f32_16x16x32_bf16 v[28:31], v[72:75], a[72:75], v[28:31]
  v_mfma_f32_16x16x32_bf16 v[32:35], v[72:75], a[76:79], v[32:35]
  v_mfma_f32_16x16x32_bf16 v[20:23], v[76:79], a[24:27], v[20:23]
  v_mfma_f32_16x16x32_bf16 v[24:27], v[76:79], a[28:31], v[24:27]
  v_mfma_f32_16x16x32_bf16 v[28:31], v[76:79], a[80:83], v[28:31]
  v_mfma_f32_16x16x32_bf16 v[32:35], v[76:79], a[84:87], v[32:35]
  v_mfma_f32_16x16x32_bf16 v[20:23], v[80:83], a[32:35], v[20:23]
  v_mfma_f32_16x16x32_bf16 v[24:27], v[80:83], a[36:39], v[24:27]
  v_mfma_f32_16x16x32_bf16 v[28:31], v[80:83], a[88:91], v[28:31]
  v_mfma_f32_16x16x32_bf16 v[32:35], v[80:83], a[92:95], v[32:35]
  v_mfma_f32_16x16x32_bf16 v[20:23], v[84:87], a[40:43], v[20:23]
  v_mfma_f32_16x16x32_bf16 v[24:27], v[84:87], a[44:47], v[24:27]
  v_mfma_f32_16x16x32_bf16 v[28:31], v[84:87], a[96:99], v[28:31]
  v_mfma_f32_16x16x32_bf16 v[32:35], v[84:87], a[100:103], v[32:35]
  v_mfma_f32_16x16x32_bf16 v[20:23], v[88:91], a[48:51], v[20:23]
  v_mfma_f32_16x16x32_bf16 v[24:27], v[88:91], a[52:55], v[24:27]
  v_mfma_f32_16x16x32_bf16 v[28:31], v[88:91], a[104:107], v[28:31]
  v_mfma_f32_16x16x32_bf16 v[32:35], v[88:91], a[108:111], v[32:35]
  v_cndmask_b32 v8, v6, v8, s[40:41]
  v_cndmask_b32 v9, v6, v9, s[42:43]
  v_cndmask_b32 v10, v6, v10, s[44:45]
  v_cndmask_b32 v11, v6, v11, s[46:47]
  v_cndmask_b32 v20, v24, v20, s[48:49]
  v_cndmask_b32 v21, v25, v21, s[48:49]
  v_cndmask_b32 v22, v26, v22, s[48:49]
  v_cndmask_b32 v23, v27, v23, s[48:49]
  v_mov_b32 v24, v20
  v_mov_b32 v25, v21
  v_mov_b32 v26, v22
  v_mov_b32 v27, v23
  v_permlane32_swap_b32 v20, v24
  v_permlane32_swap_b32 v21, v25
  v_permlane32_swap_b32 v22, v26
  v_permlane32_swap_b32 v23, v27
  v_add_f32 v20, v20, v24
  v_add_f32 v21, v21, v25
  v_add_f32 v22, v22, v26
  v_add_f32 v23, v23, v27
  v_max3_f32 v40, v8, v9, v10
  v_max3_f32 v40, v40, v11, v20
  v_max3_f32 v40, v40, v21, v22
  v_max_f32 v40, v40, v23
  v_mov_b32 v41, v40
  s_nop 1
  v_permlane16_swap_b32 v40, v41
  v_max_f32 v40, v40, v41
  v_mov_b32 v41, v40
  s_nop 1
  v_permlane32_swap_b32 v40, v41
  v_max_f32 v40, v40, v41
  v_sub_f32 v8, v8, v40
  v_sub_f32 v9, v9, v40
  v_sub_f32 v10, v10, v40
  v_sub_f32 v11, v11, v40
  v_sub_f32 v20, v20, v40
  v_sub_f32 v21, v21, v40
  v_sub_f32 v22, v22, v40
  v_sub_f32 v23, v23, v40
  v_exp_f32 v8, v8
  v_exp_f32 v9, v9
  v_exp_f32 v10, v10
  v_exp_f32 v11, v11
  v_exp_f32 v20, v20
  v_exp_f32 v21, v21
  v_exp_f32 v22, v22
  v_exp_f32 v23, v23
  v_add_f32 v42, v20, v21
  v_add_f32 v43, v22, v23
  v_add_f32 v42, v42, v43
  v_mul_f32 v42, 0.5, v42
  v_add_f32 v42, v42, v8
  v_add_f32 v42, v42, v9
  v_add_f32 v42, v42, v10
  v_add_f32 v42, v42, v11
  v_mov_b32 v41, v42
  s_nop 1
  v_permlane16_swap_b32 v42, v41
  v_add_f32 v42, v42, v41
  v_mov_b32 v41, v42
  s_nop 1
  v_permlane32_swap_b32 v42, v41
  v_add_f32 v42, v42, v41
  v_rcp_f32 v42, v42
  s_nop 0
  v_mul_f32 v8, v8, v42
  v_mul_f32 v9, v9, v42
  v_mul_f32 v10, v10, v42
  v_mul_f32 v11, v11, v42
  v_mul_f32 v20, v20, v42
  v_mul_f32 v21, v21, v42
  v_mul_f32 v22, v22, v42
  v_mul_f32 v23, v23, v42
  v_cvt_pk_bf16_f32 v44, v8, 0
  v_cvt_pk_bf16_f32 v45, v9, 0
  v_cvt_pk_bf16_f32 v46, v10, 0
  v_cvt_pk_bf16_f32 v47, v11, 0
  v_cvt_pk_bf16_f32 v48, v20, v21
  v_cvt_pk_bf16_f32 v49, v22, v23
  v_min_u32 v44, -2, v44
  v_min_u32 v45, -2, v45
  v_min_u32 v46, -2, v46
  v_min_u32 v47, -2, v47
  v_min_u32 v48, -2, v48
  v_min_u32 v49, -2, v49
  buffer_store_dwordx4 v[44:47], v2, s[8:11], s26 offen sc1
  s_mov_b64 exec, s[50:51]
  buffer_store_dwordx2 v[48:49], v2, s[8:11], s27 offen sc1
  s_mov_b64 exec, -1
  s_add_u32 s26, s26, 20480
  s_add_u32 s27, s27, 20480
  v_cndmask_b32 v16, v6, v16, s[40:41]
  v_cndmask_b32 v17, v6, v17, s[42:43]
  v_cndmask_b32 v18, v6, v18, s[44:45]
  v_cndmask_b32 v19, v6, v19, s[46:47]
  v_cndmask_b32 v28, v32, v28, s[48:49]
  v_cndmask_b32 v29, v33, v29, s[48:49]
  v_cndmask_b32 v30, v34, v30, s[48:49]
  v_cndmask_b32 v31, v35, v31, s[48:49]
  v_mov_b32 v32, v28
  v_mov_b32 v33, v29
  v_mov_b32 v34, v30
  v_mov_b32 v35, v31
  v_permlane32_swap_b32 v28, v32
  v_permlane32_swap_b32 v29, v33
  v_permlane32_swap_b32 v30, v34
  v_permlane32_swap_b32 v31, v35
  v_add_f32 v28, v28, v32
  v_add_f32 v29, v29, v33
  v_add_f32 v30, v30, v34
  v_add_f32 v31, v31, v35
  v_max3_f32 v40, v12, v13, v14
  v_max3_f32 v40, v40, v15, v16
  v_max3_f32 v40, v40, v17, v18
  v_max3_f32 v40, v40, v19, v28
  v_max3_f32 v40, v40, v29, v30
  v_max_f32 v40, v40, v31
  v_mov_b32 v41, v40
  s_nop 1
  v_permlane16_swap_b32 v40, v41
  v_max_f32 v40, v40, v41
  v_mov_b32 v41, v40
  s_nop 1
  v_permlane32_swap_b32 v40, v41
  v_max_f32 v40, v40, v41
  v_sub_f32 v12, v12, v40
  v_sub_f32 v13, v13, v40
  v_sub_f32 v14, v14, v40
  v_sub_f32 v15, v15, v40
  v_sub_f32 v16, v16, v40
  v_sub_f32 v17, v17, v40
  v_sub_f32 v18, v18, v40
  v_sub_f32 v19, v19, v40
  v_sub_f32 v28, v28, v40
  v_sub_f32 v29, v29, v40
  v_sub_f32 v30, v30, v40
  v_sub_f32 v31, v31, v40
  v_exp_f32 v12, v12
  v_exp_f32 v13, v13
  v_exp_f32 v14, v14
  v_exp_f32 v15, v15
  v_exp_f32 v16, v16
  v_exp_f32 v17, v17
  v_exp_f32 v18, v18
  v_exp_f32 v19, v19
  v_exp_f32 v28, v28
  v_exp_f32 v29, v29
  v_exp_f32 v30, v30
  v_exp_f32 v31, v31
  v_add_f32 v42, v28, v29
  v_add_f32 v43, v30, v31
  v_add_f32 v42, v42, v43
  v_mul_f32 v42, 0.5, v42
  v_add_f32 v42, v42, v12
  v_add_f32 v42, v42, v13
  v_add_f32 v42, v42, v14
  v_add_f32 v42, v42, v15
  v_add_f32 v42, v42, v16
  v_add_f32 v42, v42, v17
  v_add_f32 v42, v42, v18
  v_add_f32 v42, v42, v19
  v_mov_b32 v41, v42
  s_nop 1
  v_permlane16_swap_b32 v42, v41
  v_add_f32 v42, v42, v41
  v_mov_b32 v41, v42
  s_nop 1
  v_permlane32_swap_b32 v42, v41
  v_add_f32 v42, v42, v41
  v_rcp_f32 v42, v42
  s_nop 0
  v_mul_f32 v12, v12, v42
  v_mul_f32 v13, v13, v42
  v_mul_f32 v14, v14, v42
  v_mul_f32 v15, v15, v42
  v_mul_f32 v16, v16, v42
  v_mul_f32 v17, v17, v42
  v_mul_f32 v18, v18, v42
  v_mul_f32 v19, v19, v42
  v_mul_f32 v28, v28, v42
  v_mul_f32 v29, v29, v42
  v_mul_f32 v30, v30, v42
  v_mul_f32 v31, v31, v42
  v_cvt_pk_bf16_f32 v52, v12, v16
  v_cvt_pk_bf16_f32 v53, v13, v17
  v_cvt_pk_bf16_f32 v54, v14, v18
  v_cvt_pk_bf16_f32 v55, v15, v19
  v_cvt_pk_bf16_f32 v56, v28, v29
  v_cvt_pk_bf16_f32 v57, v30, v31
  v_min_u32 v52, -2, v52
  v_min_u32 v53, -2, v53
  v_min_u32 v54, -2, v54
  v_min_u32 v55, -2, v55
  v_min_u32 v56, -2, v56
  v_min_u32 v57, -2, v57
  buffer_store_dwordx4 v[52:55], v2, s[8:11], s26 offen sc1
  s_mov_b64 exec, s[50:51]
  buffer_store_dwordx2 v[56:57], v2, s[8:11], s27 offen sc1
  s_mov_b64 exec, -1
  s_branch wk_loop
wk_toko:
  s_load_dwordx2 s[36:37], s[0:1], 112
  s_waitcnt lgkmcnt(0)
  s_mov_b32 s92, s36
  s_and_b32 s93, s37, 0xffff
  s_mov_b32 s94, 3670016
  s_mov_b32 s95, 0x20000
  s_lshl_b32 s20, s18, 2
  s_add_u32 s20, s20, s16
  s_mul_i32 s24, s20, 65
  s_add_u32 s24, s24, s17
  s_lshl_b32 s24, s24, 13
  s_add_u32 s24, s24, 76869632
  s_mul_i32 s21, s20, 28672
  s_mul_i32 s22, s17, 458752
  s_add_u32 s21, s21, s22
  s_add_u32 s21, s21, 42205184
  s_lshl_b32 s25, s17, 1
  s_mul_i32 s25, s25, 20480
  s_add_u32 s25, s25, 85381120
  v_mov_b32 v5, v2
  v_min_u32 v6, 11, v4
  v_mad_u32_u24 v6, v3, 12, v6
  v_lshlrev_b32 v6, 4, v6
  v_add_u32 v6, 1024, v6
  v_lshrrev_b32 v8, 1, v3
  v_lshl_add_u32 v8, v8, 4, v4
  v_lshlrev_b32 v8, 4, v8
  v_and_b32 v9, 1, v3
  v_lshl_add_u32 v7, v9, 3, v8
  s_lshr_b32 s26, s17, 3
  s_lshl_b32 s26, s26, 4
  s_add_u32 s26, s26, s20
  s_lshl_b32 s26, s26, 7
  s_add_u32 s26, s26, 88461312
  v_mov_b32 v60, 0
  s_mov_b32 s30, 0
wo_wv:
  buffer_load_dword v61, v60, s[8:11], s26 offen sc1
  s_waitcnt vmcnt(0)
  v_cmp_ne_u32 vcc, 56, v61
  s_cbranch_vccz wo_wv_ok
  s_sleep 4
  s_cmp_ge_u32 s17, 56
  s_cbranch_scc1 wo_wv_bo
  s_sleep 127
wo_wv_bo:
  s_add_u32 s30, s30, 1
  s_cmp_lt_u32 s30, 2000000
  s_cbranch_scc1 wo_wv
  s_branch wo_abort
wo_wv_ok:
  s_add_u32 s22, s21, 0
  buffer_load_dwordx4 a[0:3], v5, s[8:11], s22 offen offset:0 sc1
  buffer_load_dwordx4 a[4:7], v6, s[8:11], s22 offen offset:0 sc1
  buffer_load_dwordx4 a[8:11], v5, s[8:11], s22 offen offset:1792 sc1
  buffer_load_dwordx4 a[12:15], v6, s[8:11], s22 offen offset:1792 sc1
  s_add_u32 s22, s21, 3584
  buffer_load_dwordx4 a[16:19], v5, s[8:11], s22 offen offset:0 sc1
  buffer_load_dwordx4 a[20:23], v6, s[8:11], s22 offen offset:0 sc1
  buffer_load_dwordx4 a[24:27], v5, s[8:11], s22 offen offset:1792 sc1
  buffer_load_dwordx4 a[28:31], v6, s[8:11], s22 offen offset:1792 sc1
  s_add_u32 s22, s21, 7168
  buffer_load_dwordx4 a[32:35], v5, s[8:11], s22 offen offset:0 sc1
  buffer_load_dwordx4 a[36:39], v6, s[8:11], s22 offen offset:0 sc1
  buffer_load_dwordx4 a[40:43], v5, s[8:11], s22 offen offset:1792 sc1
  buffer_load_dwordx4 a[44:47], v6, s[8:11], s22 offen offset:1792 sc1
  s_add_u32 s22, s21, 10752
  buffer_load_dwordx4 a[48:51], v5, s[8:11], s22 offen offset:0 sc1
  buffer_load_dwordx4 a[52:55], v6, s[8:11], s22 offen offset:0 sc1
  buffer_load_dwordx4 a[56:59], v5, s[8:11], s22 offen offset:1792 sc1
  buffer_load_dwordx4 a[60:63], v6, s[8:11], s22 offen offset:1792 sc1
  s_add_u32 s22, s21, 14336
  buffer_load_dwordx4 a[64:67], v5, s[8:11], s22 offen offset:0 sc1
  buffer_load_dwordx4 a[68:71], v6, s[8:11], s22 offen offset:0 sc1
  buffer_load_dwordx4 a[72:75], v5, s[8:11], s22 offen offset:1792 sc1
  buffer_load_dwordx4 a[76:79], v6, s[8:11], s22 offen offset:1792 sc1
  s_add_u32 s22, s21, 17920
  buffer_load_dwordx4 a[80:83], v5, s[8:11], s22 offen offset:0 sc1
  buffer_load_dwordx4 a[84:87], v6, s[8:11], s22 offen offset:0 sc1
  buffer_load_dwordx4 a[88:91], v5, s[8:11], s22 offen offset:1792 sc1
  buffer_load_dwordx4 a[92:95], v6, s[8:11], s22 offen offset:1792 sc1
  s_add_u32 s22, s21, 21504
  buffer_load_dwordx4 a[96:99], v5, s[8:11], s22 offen offset:0 sc1
  buffer_load_dwordx4 a[100:103], v6, s[8:11], s22 offen offset:0 sc1
  buffer_load_dwordx4 a[104:107], v5, s[8:11], s22 offen offset:1792 sc1
  buffer_load_dwordx4 a[108:111], v6, s[8:11], s22 offen offset:1792 sc1
  s_add_u32 s22, s21, 25088
  buffer_load_dwordx4 a[112:115], v5, s[8:11], s22 offen offset:0 sc1
  buffer_load_dwordx4 a[116:119], v6, s[8:11], s22 offen offset:0 sc1
  buffer_load_dwordx4 a[120:123], v5, s[8:11], s22 offen offset:1792 sc1
  buffer_load_dwordx4 a[124:127], v6, s[8:11], s22 offen offset:1792 sc1
  s_lshl_b32 s26, s20, 6
  s_add_u32 s26, s26, s17
  s_lshl_b32 s26, s26, 4
  s_add_u32 s26, s26, 88502272
  v_lshlrev_b32 v60, 2, v3
  s_mov_b32 s30, 0
wo_wt:
  buffer_load_dword v61, v60, s[8:11], s26 offen sc1
  s_waitcnt vmcnt(0)
  v_cmp_ne_u32 vcc, 1, v61
  s_cbranch_vccz wo_wt_ok
  s_sleep 4
  s_cmp_ge_u32 s17, 56
  s_cbranch_scc1 wo_wt_bo
  s_sleep 127
wo_wt_bo:
  s_add_u32 s30, s30, 1
  s_cmp_lt_u32 s30, 2000000
  s_cbranch_scc1 wo_wt
  s_branch wo_abort
wo_wt_ok:
  s_lshl_b32 s26, s17, 7
  s_add_u32 s26, s26, 88494080
  v_mov_b32 v60, 0
  s_mov_b32 s30, 0
wo_wp:
  buffer_load_dword v61, v60, s[8:11], s26 offen sc1
  s_waitcnt vmcnt(0)
  v_cmp_ne_u32 vcc, 16, v61
  s_cbranch_vccz wo_wp_ok
  s_sleep 4
  s_cmp_ge_u32 s17, 56
  s_cbranch_scc1 wo_wp_bo
  s_sleep 127
wo_wp_bo:
  s_add_u32 s30, s30, 1
  s_cmp_lt_u32 s30, 2000000
  s_cbranch_scc1 wo_wp
  s_branch wo_abort
wo_wp_ok:
  s_lshl_b32 s28, s16, 12
  s_add_u32 s26, s25, s28
  s_add_u32 s27, s26, 20480
  s_lshl_b32 s28, s16, 10
  s_add_u32 s28, s28, s25
  s_add_u32 s28, s28, 16384
  s_add_u32 s29, s28, 20480
  s_add_u32 s23, s24, 4096
  s_mov_b32 s30, 0
wo_pl:
  buffer_load_dwordx4 v[64:67], v2, s[8:11], s26 offen offset:0 sc1
  buffer_load_dwordx4 v[68:71], v2, s[8:11], s26 offen offset:1024 sc1
  buffer_load_dwordx4 v[72:75], v2, s[8:11], s26 offen offset:2048 sc1
  buffer_load_dwordx4 v[76:79], v2, s[8:11], s26 offen offset:3072 sc1
  buffer_load_dwordx4 v[80:83], v2, s[8:11], s28 offen sc1
  buffer_load_dwordx4 v[84:87], v2, s[8:11], s27 offen offset:0 sc1
  buffer_load_dwordx4 v[88:91], v2, s[8:11], s27 offen offset:1024 sc1
  buffer_load_dwordx4 v[92:95], v2, s[8:11], s27 offen offset:2048 sc1
  buffer_load_dwordx4 v[96:99], v2, s[8:11], s27 offen offset:3072 sc1
  buffer_load_dwordx4 v[100:103], v2, s[8:11], s29 offen sc1
  buffer_load_dwordx2 v[28:29], v7, s[8:11], s24 offen offset:0 sc1
  buffer_load_dwordx2 v[30:31], v7, s[8:11], s24 offen offset:512 sc1
  buffer_load_dwordx2 v[32:33], v7, s[8:11], s24 offen offset:1024 sc1
  buffer_load_dwordx2 v[34:35], v7, s[8:11], s24 offen offset:1536 sc1
  buffer_load_dwordx2 v[36:37], v7, s[8:11], s24 offen offset:2048 sc1
  buffer_load_dwordx2 v[38:39], v7, s[8:11], s24 offen offset:2560 sc1
  buffer_load_dwordx2 v[40:41], v7, s[8:11], s24 offen offset:3072 sc1
  buffer_load_dwordx2 v[42:43], v7, s[8:11], s24 offen offset:3584 sc1
  buffer_load_dwordx2 v[44:45], v7, s[8:11], s23 offen offset:0 sc1
  buffer_load_dwordx2 v[46:47], v7, s[8:11], s23 offen offset:512 sc1
  buffer_load_dwordx2 v[48:49], v7, s[8:11], s23 offen offset:1024 sc1
  buffer_load_dwordx2 v[50:51], v7, s[8:11], s23 offen offset:1536 sc1
  buffer_load_dwordx2 v[52:53], v7, s[8:11], s23 offen offset:2048 sc1
  buffer_load_dwordx2 v[54:55], v7, s[8:11], s23 offen offset:2560 sc1
  buffer_load_dwordx2 v[56:57], v7, s[8:11], s23 offen offset:3072 sc1
  buffer_load_dwordx2 v[58:59], v7, s[8:11], s23 offen offset:3584 sc1
  s_waitcnt vmcnt(16)
  v_max_u32 v61, v64, v65
  v_max3_u32 v61, v61, v66, v67
  v_max3_u32 v61, v61, v68, v69
  v_max3_u32 v61, v61, v70, v71
  v_max3_u32 v61, v61, v72, v73
  v_max3_u32 v61, v61, v74, v75
  v_max3_u32 v61, v61, v76, v77
  v_max3_u32 v61, v61, v78, v79
  v_max3_u32 v61, v61, v80, v81
  v_max3_u32 v61, v61, v82, v83
  v_max3_u32 v61, v61, v84, v85
  v_max3_u32 v61, v61, v86, v87
  v_max3_u32 v61, v61, v88, v89
  v_max3_u32 v61, v61, v90, v91
  v_max3_u32 v61, v61, v92, v93
  v_max3_u32 v61, v61, v94, v95
  v_max3_u32 v61, v61, v96, v97
  v_max3_u32 v61, v61, v98, v99
  v_max3_u32 v61, v61, v100, v101
  v_max3_u32 v61, v61, v102, v103
  s_mul_i32 s22, s16, 10240
  v_add_u32 v62, s22, v2
  ds_write_b128 v62, v[64:67] offset:0
  ds_write_b128 v62, v[68:71] offset:1024
  ds_write_b128 v62, v[72:75] offset:2048
  ds_write_b128 v62, v[76:79] offset:3072
  ds_write_b128 v62, v[80:83] offset:4096
  ds_write_b128 v62, v[84:87] offset:5120
  ds_write_b128 v62, v[88:91] offset:6144
  ds_write_b128 v62, v[92:95] offset:7168
  ds_write_b128 v62, v[96:99] offset:8192
  ds_write_b128 v62, v[100:103] offset:9216
  s_waitcnt vmcnt(0)
  v_max3_u32 v61, v61, v28, v29
  v_max3_u32 v61, v61, v30, v31
  v_max3_u32 v61, v61, v32, v33
  v_max3_u32 v61, v61, v34, v35
  v_max3_u32 v61, v61, v36, v37
  v_max3_u32 v61, v61, v38, v39
  v_max3_u32 v61, v61, v40, v41
  v_max3_u32 v61, v61, v42, v43
  v_max3_u32 v61, v61, v44, v45
  v_max3_u32 v61, v61, v46, v47
  v_max3_u32 v61, v61, v48, v49
  v_max3_u32 v61, v61, v50, v51
  v_max3_u32 v61, v61, v52, v53
  v_max3_u32 v61, v61, v54, v55
  v_max3_u32 v61, v61, v56, v57
  v_max3_u32 v61, v61, v58, v59
  v_cmp_eq_u32 vcc, -1, v61
  s_cbranch_vccz wo_pk
  s_waitcnt lgkmcnt(0)
  s_sleep 1
  s_cmp_ge_u32 s17, 56
  s_cbranch_scc1 wo_pl_bo
  s_sleep 127
wo_pl_bo:
  s_add_u32 s30, s30, 1
  s_cmp_lt_u32 s30, 2000000
  s_cbranch_scc1 wo_pl
  s_branch wo_abort
wo_pk:
  buffer_load_dword v250, v251, s[8:11], 0 offen sc1
  s_waitcnt lgkmcnt(0)
  s_barrier
  ds_read_b128 v[64:67], v2 offset:0
  ds_read_b128 v[68:71], v2 offset:5120
  ds_read_b128 v[72:75], v2 offset:1024
  ds_read_b128 v[76:79], v2 offset:6144
  ds_read_b128 v[80:83], v2 offset:2048
  ds_read_b128 v[84:87], v2 offset:7168
  ds_read_b128 v[88:91], v2 offset:3072
  ds_read_b128 v[92:95], v2 offset:8192
  s_waitcnt lgkmcnt(7)
  v_mfma_f32_16x16x32_bf16 v[12:15], a[0:3], v[64:67], 0
  ds_read_b128 v[96:99], v2 offset:4096
  v_mfma_f32_16x16x32_bf16 v[20:23], a[4:7], v[64:67], 0
  s_waitcnt lgkmcnt(7)
  v_mfma_f32_16x16x32_bf16 v[16:19], a[0:3], v[68:71], 0
  ds_read_b128 v[100:103], v2 offset:9216
  v_mfma_f32_16x16x32_bf16 v[24:27], a[4:7], v[68:71], 0
  s_waitcnt lgkmcnt(7)
  v_mfma_f32_16x16x32_bf16 v[12:15], a[8:11], v[72:75], v[12:15]
  ds_read_b128 v[64:67], v2 offset:10240
  v_mfma_f32_16x16x32_bf16 v[20:23], a[12:15], v[72:75], v[20:23]
  s_waitcnt lgkmcnt(7)
  v_mfma_f32_16x16x32_bf16 v[16:19], a[8:11], v[76:79], v[16:19]
  ds_read_b128 v[68:71], v2 offset:15360
  v_mfma_f32_16x16x32_bf16 v[24:27], a[12:15], v[76:79], v[24:27]
  s_waitcnt lgkmcnt(7)
  v_mfma_f32_16x16x32_bf16 v[12:15], a[16:19], v[80:83], v[12:15]
  ds_read_b128 v[72:75], v2 offset:11264
  v_mfma_f32_16x16x32_bf16 v[20:23], a[20:23], v[80:83], v[20:23]
  s_waitcnt lgkmcnt(7)
  v_mfma_f32_16x16x32_bf16 v[16:19], a[16:19], v[84:87], v[16:19]
  ds_read_b128 v[76:79], v2 offset:16384
  v_mfma_f32_16x16x32_bf16 v[24:27], a[20:23], v[84:87], v[24:27]
  s_waitcnt lgkmcnt(7)
  v_mfma_f32_16x16x32_bf16 v[12:15], a[24:27], v[88:91], v[12:15]
  ds_read_b128 v[80:83], v2 offset:12288
  v_mfma_f32_16x16x32_bf16 v[20:23], a[28:31], v[88:91], v[20:23]
  s_waitcnt lgkmcnt(7)
  v_mfma_f32_16x16x32_bf16 v[16:19], a[24:27], v[92:95], v[16:19]
  ds_read_b128 v[84:87], v2 offset:17408
  v_mfma_f32_16x16x32_bf16 v[24:27], a[28:31], v[92:95], v[24:27]
  s_waitcnt lgkmcnt(7)
  v_mfma_f32_16x16x32_bf16 v[12:15], v[28:31], v[96:99], v[12:15]
  ds_read_b128 v[88:91], v2 offset:13312
  v_mfma_f32_16x16x32_bf16 v[20:23], v[32:35], v[96:99], v[20:23]
  s_waitcnt lgkmcnt(7)
  v_mfma_f32_16x16x32_bf16 v[16:19], v[28:31], v[100:103], v[16:19]
  ds_read_b128 v[92:95], v2 offset:18432
  v_mfma_f32_16x16x32_bf16 v[24:27], v[32:35], v[100:103], v[24:27]
  s_waitcnt lgkmcnt(7)
  v_mfma_f32_16x16x32_bf16 v[12:15], a[32:35], v[64:67], v[12:15]
  ds_read_b128 v[96:99], v2 offset:14336
  v_mfma_f32_16x16x32_bf16 v[20:23], a[36:39], v[64:67], v[20:23]
  s_waitcnt lgkmcnt(7)
  v_mfma_f32_16x16x32_bf16 v[16:19], a[32:35], v[68:71], v[16:19]
  ds_read_b128 v[100:103], v2 offset:19456
  v_mfma_f32_16x16x32_bf16 v[24:27], a[36:39], v[68:71], v[24:27]
  s_waitcnt lgkmcnt(7)
  v_mfma_f32_16x16x32_bf16 v[12:15], a[40:43], v[72:75], v[12:15]
  ds_read_b128 v[64:67], v2 offset:20480
  v_mfma_f32_16x16x32_bf16 v[20:23], a[44:47], v[72:75], v[20:23]
  s_waitcnt lgkmcnt(7)
  v_mfma_f32_16x16x32_bf16 v[16:19], a[40:43], v[76:79], v[16:19]
  ds_read_b128 v[68:71], v2 offset:25600
  v_mfma_f32_16x16x32_bf16 v[24:27], a[44:47], v[76:79], v[24:27]
  s_waitcnt lgkmcnt(7)
  v_mfma_f32_16x16x32_bf16 v[12:15], a[48:51], v[80:83], v[12:15]
  ds_read_b128 v[72:75], v2 offset:21504
  v_mfma_f32_16x16x32_bf16 v[20:23], a[52:55], v[80:83], v[20:23]
  s_waitcnt lgkmcnt(7)
  v_mfma_f32_16x16x32_bf16 v[16:19], a[48:51], v[84:87], v[16:19]
  ds_read_b128 v[76:79], v2 offset:26624
  v_mfma_f32_16x16x32_bf16 v[24:27], a[52:55], v[84:87], v[24:27]
  s_waitcnt lgkmcnt(7)
  v_mfma_f32_16x16x32_bf16 v[12:15], a[56:59], v[88:91], v[12:15]
  ds_read_b128 v[80:83], v2 offset:22528
  v_mfma_f32_16x16x32_bf16 v[20:23], a[60:63], v[88:91], v[20:23]
  s_waitcnt lgkmcnt(7)
  v_mfma_f32_16x16x32_bf16 v[16:19], a[56:59], v[92:95], v[16:19]
  ds_read_b128 v[84:87], v2 offset:27648
  v_mfma_f32_16x16x32_bf16 v[24:27], a[60:63], v[92:95], v[24:27]
  s_waitcnt lgkmcnt(7)
  v_mfma_f32_16x16x32_bf16 v[12:15], v[36:39], v[96:99], v[12:15]
  ds_read_b128 v[88:91], v2 offset:23552
  v_mfma_f32_16x16x32_bf16 v[20:23], v[40:43], v[96:99], v[20:23]
  s_waitcnt lgkmcnt(7)
  v_mfma_f32_16x16x32_bf16 v[16:19], v[36:39], v[100:103], v[16:19]
  ds_read_b128 v[92:95], v2 offset:28672
  v_mfma_f32_16x16x32_bf16 v[24:27], v[40:43], v[100:103], v[24:27]
  s_waitcnt lgkmcnt(7)
  v_mfma_f32_16x16x32_bf16 v[12:15], a[64:67], v[64:67], v[12:15]
  ds_read_b128 v[96:99], v2 offset:24576
  v_mfma_f32_16x16x32_bf16 v[20:23], a[68:71], v[64:67], v[20:23]
  s_waitcnt lgkmcnt(7)
  v_mfma_f32_16x16x32_bf16 v[16:19], a[64:67], v[68:71], v[16:19]
  ds_read_b128 v[100:103], v2 offset:29696
  v_mfma_f32_16x16x32_bf16 v[24:27], a[68:71], v[68:71], v[24:27]
  s_waitcnt lgkmcnt(7)
  v_mfma_f32_16x16x32_bf16 v[12:15], a[72:75], v[72:75], v[12:15]
  ds_read_b128 v[64:67], v2 offset:30720
  v_mfma_f32_16x16x32_bf16 v[20:23], a[76:79], v[72:75], v[20:23]
  s_waitcnt lgkmcnt(7)
  v_mfma_f32_16x16x32_bf16 v[16:19], a[72:75], v[76:79], v[16:19]
  ds_read_b128 v[68:71], v2 offset:35840
  v_mfma_f32_16x16x32_bf16 v[24:27], a[76:79], v[76:79], v[24:27]
  s_waitcnt lgkmcnt(7)
  v_mfma_f32_16x16x32_bf16 v[12:15], a[80:83], v[80:83], v[12:15]
  ds_read_b128 v[72:75], v2 offset:31744
  v_mfma_f32_16x16x32_bf16 v[20:23], a[84:87], v[80:83], v[20:23]
  s_waitcnt lgkmcnt(7)
  v_mfma_f32_16x16x32_bf16 v[16:19], a[80:83], v[84:87], v[16:19]
  ds_read_b128 v[76:79], v2 offset:36864
  v_mfma_f32_16x16x32_bf16 v[24:27], a[84:87], v[84:87], v[24:27]
  s_waitcnt lgkmcnt(7)
  v_mfma_f32_16x16x32_bf16 v[12:15], a[88:91], v[88:91], v[12:15]
  ds_read_b128 v[80:83], v2 offset:32768
  v_mfma_f32_16x16x32_bf16 v[20:23], a[92:95], v[88:91], v[20:23]
  s_waitcnt lgkmcnt(7)
  v_mfma_f32_16x16x32_bf16 v[16:19], a[88:91], v[92:95], v[16:19]
  ds_read_b128 v[84:87], v2 offset:37888
  v_mfma_f32_16x16x32_bf16 v[24:27], a[92:95], v[92:95], v[24:27]
  s_waitcnt lgkmcnt(7)
  v_mfma_f32_16x16x32_bf16 v[12:15], v[44:47], v[96:99], v[12:15]
  ds_read_b128 v[88:91], v2 offset:33792
  v_mfma_f32_16x16x32_bf16 v[20:23], v[48:51], v[96:99], v[20:23]
  s_waitcnt lgkmcnt(7)
  v_mfma_f32_16x16x32_bf16 v[16:19], v[44:47], v[100:103], v[16:19]
  ds_read_b128 v[92:95], v2 offset:38912
  v_mfma_f32_16x16x32_bf16 v[24:27], v[48:51], v[100:103], v[24:27]
  s_waitcnt lgkmcnt(7)
  v_mfma_f32_16x16x32_bf16 v[12:15], a[96:99], v[64:67], v[12:15]
  ds_read_b128 v[96:99], v2 offset:34816
  v_mfma_f32_16x16x32_bf16 v[20:23], a[100:103], v[64:67], v[20:23]
  s_waitcnt lgkmcnt(7)
  v_mfma_f32_16x16x32_bf16 v[16:19], a[96:99], v[68:71], v[16:19]
  ds_read_b128 v[100:103], v2 offset:39936
  v_mfma_f32_16x16x32_bf16 v[24:27], a[100:103], v[68:71], v[24:27]
  s_waitcnt lgkmcnt(7)
  v_mfma_f32_16x16x32_bf16 v[12:15], a[104:107], v[72:75], v[12:15]
  v_mfma_f32_16x16x32_bf16 v[20:23], a[108:111], v[72:75], v[20:23]
  s_waitcnt lgkmcnt(6)
  v_mfma_f32_16x16x32_bf16 v[16:19], a[104:107], v[76:79], v[16:19]
  v_mfma_f32_16x16x32_bf16 v[24:27], a[108:111], v[76:79], v[24:27]
  s_waitcnt lgkmcnt(5)
  v_mfma_f32_16x16x32_bf16 v[12:15], a[112:115], v[80:83], v[12:15]
  v_mfma_f32_16x16x32_bf16 v[20:23], a[116:119], v[80:83], v[20:23]
  s_waitcnt lgkmcnt(4)
  v_mfma_f32_16x16x32_bf16 v[16:19], a[112:115], v[84:87], v[16:19]
  v_mfma_f32_16x16x32_bf16 v[24:27], a[116:119], v[84:87], v[24:27]
  s_waitcnt lgkmcnt(3)
  v_mfma_f32_16x16x32_bf16 v[12:15], a[120:123], v[88:91], v[12:15]
  v_mfma_f32_16x16x32_bf16 v[20:23], a[124:127], v[88:91], v[20:23]
  s_waitcnt lgkmcnt(2)
  v_mfma_f32_16x16x32_bf16 v[16:19], a[120:123], v[92:95], v[16:19]
  v_mfma_f32_16x16x32_bf16 v[24:27], a[124:127], v[92:95], v[24:27]
  s_waitcnt lgkmcnt(1)
  v_mfma_f32_16x16x32_bf16 v[12:15], v[52:55], v[96:99], v[12:15]
  v_mfma_f32_16x16x32_bf16 v[20:23], v[56:59], v[96:99], v[20:23]
  s_waitcnt lgkmcnt(0)
  v_mfma_f32_16x16x32_bf16 v[16:19], v[52:55], v[100:103], v[16:19]
  v_mfma_f32_16x16x32_bf16 v[24:27], v[56:59], v[100:103], v[24:27]
  v_mul_u32_u24 v9, 1792, v4
  v_lshl_add_u32 v9, v3, 3, v9
  s_lshl_b32 s22, s20, 5
  v_add_u32 v8, s22, v9
  s_mul_i32 s22, s20, 24
  s_add_u32 s22, s22, 512
  v_add_u32 v9, s22, v9
  v_mov_b32 v10, 0x40000000
  v_cmp_eq_u32 vcc, 3, v3
  s_nop 1
  v_cndmask_b32 v9, v9, v10, vcc
  s_mul_i32 s26, s17, 57344
  s_add_u32 s26, s26, 896
  s_add_u32 s27, s26, 28672
  v_cvt_pk_bf16_f32 v108, v12, v13
  v_cvt_pk_bf16_f32 v109, v14, v15
  buffer_store_dwordx2 v[108:109], v8, s[92:95], s26 offen
  v_cvt_pk_bf16_f32 v110, v20, v21
  v_cvt_pk_bf16_f32 v111, v22, v23
  buffer_store_dwordx2 v[110:111], v9, s[92:95], s26 offen
  v_cvt_pk_bf16_f32 v112, v16, v17
  v_cvt_pk_bf16_f32 v113, v18, v19
  buffer_store_dwordx2 v[112:113], v8, s[92:95], s27 offen
  v_cvt_pk_bf16_f32 v114, v24, v25
  v_cvt_pk_bf16_f32 v115, v26, v27
  buffer_store_dwordx2 v[114:115], v9, s[92:95], s27 offen
  s_branch wk_loop
wp_abort:
wo_abort:
  s_branch cA_abort
wk_done:
ch_end:
  s_endpgm

.section .rodata,"a"
.p2align 6
.amdhsa_kernel main_kernel
  .amdhsa_next_free_vgpr 512
  .amdhsa_next_free_sgpr 102
  .amdhsa_accum_offset 256
  .amdhsa_group_segment_fixed_size 0
  .amdhsa_kernarg_size 136
  .amdhsa_user_sgpr_count 2
  .amdhsa_user_sgpr_kernarg_segment_ptr 1
  .amdhsa_system_sgpr_workgroup_id_x 1
.end_amdhsa_kernel
```

```asm
; @launch kernel=main_kernel grid=(256,1,1) block=(256,1,1) lds=163840
.amdgcn_target "amdgcn-amd-amdhsa--gfx950"
.text
.globl main_kernel
.p2align 8
.type main_kernel,@function
main_kernel:
  s_cmp_ge_u32 s2, 256
  s_cbranch_scc1 ch_end
  s_load_dwordx2 s[4:5], s[0:1], 120
  s_load_dwordx2 s[6:7], s[0:1], 128
  s_load_dwordx8 s[40:47], s[0:1], 72
  s_load_dwordx4 s[48:51], s[0:1], 56
  s_mov_b32 s32, 0
  s_getreg_b32 s3, hwreg(HW_REG_XCC_ID)
  s_and_b32 s3, s3, 15
  s_cmp_lg_u32 s3, 0
  s_cbranch_scc1 ch_pf
  s_cmp_lt_u32 s2, 224
  s_cbranch_scc1 ch_npf
ch_pf:
  s_getpc_b64 s[98:99]
pf_main_kernel_1:
  s_sub_u32 s98, s98, pf_main_kernel_1-main_kernel
  s_subb_u32 s99, s99, 0
  v_lshlrev_b32 v60, 7, v0
  v_min_u32 v61, ch_end-main_kernel-4, v60
  global_load_dword v62, v61, s[98:99]
  v_add_u32 v60, 32768, v60
  v_min_u32 v61, ch_end-main_kernel-4, v60
  global_load_dword v62, v61, s[98:99]
  v_add_u32 v60, 32768, v60
  v_min_u32 v61, ch_end-main_kernel-4, v60
  global_load_dword v62, v61, s[98:99]
  v_add_u32 v60, 32768, v60
  v_min_u32 v61, ch_end-main_kernel-4, v60
  global_load_dword v62, v61, s[98:99]
  v_add_u32 v60, 32768, v60
  v_min_u32 v61, ch_end-main_kernel-4, v60
  global_load_dword v62, v61, s[98:99]
  v_add_u32 v60, 32768, v60
ch_npf:
  v_lshrrev_b32 v1, 6, v0
  s_nop 0
  v_readfirstlane_b32 s16, v1
  s_waitcnt lgkmcnt(0)
  s_mov_b32 s8, s6
  s_and_b32 s9, s7, 0xffff
  s_mov_b32 s10, 0x10000000
  s_mov_b32 s11, 0x20000
  s_mov_b32 s12, s4
  s_and_b32 s13, s5, 0xffff
  s_mov_b32 s14, 256
  s_mov_b32 s15, 0x20000
  v_mov_b32 v252, 0x40000000
  v_cmp_eq_u32 vcc, 0, v0
  s_nop 1
  v_cndmask_b32 v252, v252, v0, vcc
  s_cmp_lg_u32 s3, 0
  s_cbranch_scc1 ch_worker
  s_mov_b32 s18, 0
  v_mov_b32 v249, 1
  s_mov_b64 exec, 1
  buffer_atomic_add v249, v252, s[12:15], 0 offen sc0
  s_mov_b64 exec, -1
  v_and_b32 v1, 63, v0
  v_lshlrev_b32 v2, 4, v1
  v_lshrrev_b32 v3, 4, v1
  v_and_b32 v4, 15, v1
  s_lshr_b32 s33, s2, 3
  s_lshl_b32 s27, s33, 2
  s_add_u32 s27, s27, s16
  s_lshl_b32 s27, s27, 13
  v_lshlrev_b32 v12, 7, v1
  s_mov_b32 s64, s42
  s_and_b32 s65, s43, 0xffff
  s_mov_b32 s66, 2097152
  s_mov_b32 s67, 0x20000
  s_mov_b32 s28, s27
  buffer_load_dword v13, v12, s[64:67], s28 offen
  s_add_u32 s28, s28, 1048576
  buffer_load_dword v13, v12, s[64:67], s28 offen
  s_add_u32 s28, s28, 1048576
  s_waitcnt vmcnt(2)
  v_readfirstlane_b32 s17, v249
  v_mov_b32 v6, 160032
  s_nop 0
  v_mov_b32 v7, s17
  s_barrier
  s_cmp_lg_u32 s16, 0
  s_cbranch_scc1 uni_2
  ds_write_b32 v6, v7
  s_waitcnt lgkmcnt(0)
uni_2:
  s_barrier
  ds_read_b32 v7, v6
  s_waitcnt lgkmcnt(0)
  v_readfirstlane_b32 s17, v7
  s_branch ch_got
ch_take:
  v_mov_b32 v5, 0
  v_mov_b32 v6, 160000
  s_barrier
  s_cmp_lg_u32 s16, 0
  s_cbranch_scc1 ch_el1
  s_mov_b64 exec, 1
  buffer_atomic_add v4, v5, s[12:15], 0 offen sc0
  s_waitcnt vmcnt(0)
  ds_write_b32 v6, v4
  s_waitcnt lgkmcnt(0)
  s_mov_b64 exec, -1
ch_el1:
  s_barrier
  ds_read_b32 v4, v6
  s_waitcnt lgkmcnt(0)
  v_readfirstlane_b32 s17, v4
ch_got:
  s_and_b32 s17, s17, 0xffff
  s_cmp_lt_u32 s17, 32
  s_cbranch_scc1 ch_role
  s_cmp_eq_u32 s18, 0
  s_cbranch_scc1 ch_worker
  v_and_b32 v1, 63, v0
  v_lshlrev_b32 v2, 4, v1
  v_lshrrev_b32 v3, 4, v1
  v_and_b32 v4, 15, v1
  s_branch wp_all
ch_role:
  v_and_b32 v1, 63, v0
  v_lshlrev_b32 v2, 4, v1
  v_lshrrev_b32 v3, 4, v1
  v_and_b32 v4, 15, v1
  s_cmp_lt_u32 s17, 16
  s_cbranch_scc1 ch_self
  s_cmp_lt_u32 s17, 28
  s_cbranch_scc1 ch_tch
  s_sub_u32 s33, s17, 28
  v_mov_b32 v10, 0x40000000
  v_mov_b32 v5, 1
  v_mov_b32 v148, 0
  v_mov_b32 v149, 0
  v_mov_b32 v150, 0
  v_mov_b32 v151, 0
  v_mov_b32 v152, -1
  v_mov_b32 v153, -1
  v_mov_b32 v154, -1
  v_mov_b32 v155, -1
  v_lshlrev_b32 v8, 4, v0
  s_cmp_lg_u32 s33, 0
  s_cbranch_scc1 ch_ij_1
  s_mov_b32 s23, 88519168
  buffer_store_dwordx4 v[148:151], v8, s[8:11], s23 offen sc1
  s_mov_b32 s23, 88523264
  buffer_store_dwordx4 v[148:151], v8, s[8:11], s23 offen sc1
  s_waitcnt vmcnt(0)
  s_barrier
  buffer_store_dword v5, v252, s[12:15], 0 offen offset:128 sc1
ch_ij_1:
  s_mov_b32 s68, s50
  s_and_b32 s69, s51, 0xffff
  s_mov_b32 s70, 7168
  s_mov_b32 s71, 0x20000
  v_lshrrev_b32 v6, 3, v0
  v_min_u32 v6, 27, v6
  v_and_b32 v7, 7, v0
  v_mul_u32_u24 v9, 896, v7
  v_lshl_add_u32 v9, v6, 5, v9
  buffer_load_dwordx4 v[176:179], v9, s[68:71], 0 offen
  buffer_load_dwordx4 v[180:183], v9, s[68:71], 0 offen offset:16
  s_lshl_b32 s20, s33, 12
  v_add_u32 v8, s20, v8
  s_mov_b32 s23, 88461312
ch_ijlp_3:
  buffer_store_dwordx4 v[148:151], v8, s[8:11], s23 offen sc1
  s_add_u32 s23, s23, 16384
  s_cmp_lt_u32 s23, 88510464
  s_cbranch_scc1 ch_ijlp_3
  v_cmp_gt_u32 vcc, 8704, v8
  s_nop 1
  v_cndmask_b32 v9, v10, v8, vcc
  buffer_store_dwordx4 v[148:151], v9, s[8:11], s23 offen sc1
  s_mov_b32 s23, 75729408
  v_cmp_gt_u32 vcc, 6144, v8
  s_nop 1
  v_cndmask_b32 v9, v10, v8, vcc
  buffer_store_dwordx4 v[148:151], v9, s[8:11], s23 offen sc1
  s_mov_b32 s23, 75701248
ch_ijlp_4:
  buffer_store_dwordx4 v[152:155], v8, s[8:11], s23 offen sc1
  s_add_u32 s23, s23, 16384
  s_cmp_lt_u32 s23, 75717632
  s_cbranch_scc1 ch_ijlp_4
  v_cmp_gt_u32 vcc, 11776, v8
  s_nop 1
  v_cndmask_b32 v9, v10, v8, vcc
  buffer_store_dwordx4 v[152:155], v9, s[8:11], s23 offen sc1
  s_mov_b32 s23, 88009728
ch_ijlp_5:
  buffer_store_dwordx4 v[152:155], v8, s[8:11], s23 offen sc1
  s_add_u32 s23, s23, 16384
  s_cmp_lt_u32 s23, 88452096
  s_cbranch_scc1 ch_ijlp_5
  v_cmp_gt_u32 vcc, 9216, v8
  s_nop 1
  v_cndmask_b32 v9, v10, v8, vcc
  buffer_store_dwordx4 v[152:155], v9, s[8:11], s23 offen sc1
  s_cmp_lg_u32 s33, 1
  s_cbranch_scc1 ch_ij_nm
  v_lshrrev_b32 v6, 3, v0
  v_and_b32 v7, 7, v0
  v_lshlrev_b32 v8, 8, v6
  v_lshl_add_u32 v8, v7, 4, v8
  v_cmp_gt_u32 vcc, 28, v6
  s_nop 1
  v_cndmask_b32 v8, v10, v8, vcc
  s_waitcnt vmcnt(4)
  v_mov_b32 v184, v176
  v_mov_b32 v188, v177
  v_mov_b32 v185, v178
  v_mov_b32 v189, v179
  v_mov_b32 v186, v180
  v_mov_b32 v190, v181
  v_mov_b32 v187, v182
  v_mov_b32 v191, v183
  s_mov_b32 s23, 75694080
  buffer_store_dwordx4 v[184:187], v8, s[8:11], s23 offen sc1
  buffer_store_dwordx4 v[188:191], v8, s[8:11], s23 offen offset:128 sc1
  s_mov_b32 s23, 88002560
  buffer_store_dwordx4 v[184:187], v8, s[8:11], s23 offen sc1
  buffer_store_dwordx4 v[188:191], v8, s[8:11], s23 offen offset:128 sc1
ch_ij_nm:
  s_waitcnt vmcnt(0)
  s_barrier
  s_cmp_lg_u32 s16, 0
  s_cbranch_scc1 ch_ij_e
  v_mov_b32 v6, 1
  s_mov_b64 exec, 1
  buffer_atomic_add v6, v252, s[12:15], 0 offen offset:12 sc0
  s_waitcnt vmcnt(0)
  v_readfirstlane_b32 s20, v6
  s_cmp_lg_u32 s20, 3
  s_cbranch_scc1 ch_ij_e0
  buffer_store_dword v5, v252, s[12:15], 0 offen offset:132 sc1
  s_mov_b64 exec, 0xff
  v_lshlrev_b32 v6, 7, v0
  s_mov_b32 s20, 88523264
  buffer_store_dword v5, v6, s[8:11], s20 offen offset:4 sc1
ch_ij_e0:
  s_mov_b64 exec, -1
ch_ij_e:
  s_branch ch_role2
ch_tch:
  s_sub_u32 s33, s17, 16
  s_lshl_b32 s27, s33, 2
  s_add_u32 s27, s27, s16
  s_lshl_b32 s27, s27, 13
  v_lshlrev_b32 v12, 7, v1
  s_mov_b32 s64, s40
  s_and_b32 s65, s41, 0xffff
  s_mov_b32 s66, 3670016
  s_mov_b32 s67, 0x20000
  s_mov_b32 s28, s27
  buffer_load_dword v13, v12, s[64:67], s28 offen
  s_add_u32 s28, s28, 393216
  buffer_load_dword v13, v12, s[64:67], s28 offen
  s_add_u32 s28, s28, 393216
  buffer_load_dword v13, v12, s[64:67], s28 offen
  s_add_u32 s28, s28, 393216
  buffer_load_dword v13, v12, s[64:67], s28 offen
  s_add_u32 s28, s28, 393216
  buffer_load_dword v13, v12, s[64:67], s28 offen
  s_add_u32 s28, s28, 393216
  buffer_load_dword v13, v12, s[64:67], s28 offen
  s_add_u32 s28, s28, 393216
  buffer_load_dword v13, v12, s[64:67], s28 offen
  s_add_u32 s28, s28, 393216
  buffer_load_dword v13, v12, s[64:67], s28 offen
  s_add_u32 s28, s28, 393216
  buffer_load_dword v13, v12, s[64:67], s28 offen
  s_add_u32 s28, s28, 393216
  buffer_load_dword v13, v12, s[64:67], s28 offen
  s_add_u32 s28, s28, 393216
  s_branch ch_role2
ch_self:
  v_lshrrev_b32 v5, 5, v1
  v_and_b32 v6, 31, v1
  v_xor_b32 v8, v6, v5
  v_lshlrev_b32 v8, 4, v8
  v_lshl_add_u32 v16, v5, 13, v8
  v_xor_b32 v17, 32, v16
  v_xor_b32 v18, 64, v16
  v_xor_b32 v19, 96, v16
  v_xor_b32 v20, 128, v16
  v_xor_b32 v21, 160, v16
  v_xor_b32 v22, 192, v16
  v_xor_b32 v23, 224, v16
  s_lshl_b32 s20, s16, 6
  v_xor_b32 v26, s20, v16
  v_xor_b32 v27, 32, v26
  s_mov_b32 s60, s40
  s_and_b32 s61, s41, 0xffff
  s_mov_b32 s62, 3670016
  s_mov_b32 s63, 0x20000
  s_mov_b32 s56, s42
  s_and_b32 s57, s43, 0xffff
  s_mov_b32 s58, 3670016
  s_mov_b32 s59, 0x20000
  s_lshl_b32 s26, s17, 9
  s_lshl_b32 s27, s16, 19
  s_add_u32 s27, s27, s26
  s_lshl_b32 s25, s16, 15
  s_add_u32 s25, s25, 32768
  s_barrier
  s_add_u32 m0, s25, 0
  s_nop 0
  buffer_load_dwordx4 v16, s[56:59], s27 offen lds
  s_add_u32 s27, s27, 16384
  s_add_u32 m0, s25, 1024
  s_nop 0
  buffer_load_dwordx4 v16, s[56:59], s27 offen lds
  s_add_u32 s27, s27, 16384
  s_add_u32 m0, s25, 2048
  s_nop 0
  buffer_load_dwordx4 v17, s[56:59], s27 offen lds
  s_add_u32 s27, s27, 16384
  s_add_u32 m0, s25, 3072
  s_nop 0
  buffer_load_dwordx4 v17, s[56:59], s27 offen lds
  s_add_u32 s27, s27, 16384
  s_add_u32 m0, s25, 4096
  s_nop 0
  buffer_load_dwordx4 v16, s[56:59], s27 offen lds
  s_add_u32 s27, s27, 16384
  s_add_u32 m0, s25, 5120
  s_nop 0
  buffer_load_dwordx4 v16, s[56:59], s27 offen lds
  s_add_u32 s27, s27, 16384
  s_add_u32 m0, s25, 6144
  s_nop 0
  buffer_load_dwordx4 v17, s[56:59], s27 offen lds
  s_add_u32 s27, s27, 16384
  s_add_u32 m0, s25, 7168
  s_nop 0
  buffer_load_dwordx4 v17, s[56:59], s27 offen lds
  s_add_u32 s27, s27, 16384
  s_add_u32 m0, s25, 8192
  s_nop 0
  buffer_load_dwordx4 v18, s[56:59], s27 offen lds
  s_add_u32 s27, s27, 16384
  s_add_u32 m0, s25, 9216
  s_nop 0
  buffer_load_dwordx4 v18, s[56:59], s27 offen lds
  s_add_u32 s27, s27, 16384
  s_add_u32 m0, s25, 10240
  s_nop 0
  buffer_load_dwordx4 v19, s[56:59], s27 offen lds
  s_add_u32 s27, s27, 16384
  s_add_u32 m0, s25, 11264
  s_nop 0
  buffer_load_dwordx4 v19, s[56:59], s27 offen lds
  s_add_u32 s27, s27, 16384
  s_add_u32 m0, s25, 12288
  s_nop 0
  buffer_load_dwordx4 v18, s[56:59], s27 offen lds
  s_add_u32 s27, s27, 16384
  s_add_u32 m0, s25, 13312
  s_nop 0
  buffer_load_dwordx4 v18, s[56:59], s27 offen lds
  s_add_u32 s27, s27, 16384
  s_add_u32 m0, s25, 14336
  s_nop 0
  buffer_load_dwordx4 v19, s[56:59], s27 offen lds
  s_add_u32 s27, s27, 16384
  s_add_u32 m0, s25, 15360
  s_nop 0
  buffer_load_dwordx4 v19, s[56:59], s27 offen lds
  s_add_u32 s27, s27, 16384
  s_add_u32 m0, s25, 16384
  s_nop 0
  buffer_load_dwordx4 v20, s[56:59], s27 offen lds
  s_add_u32 s27, s27, 16384
  s_add_u32 m0, s25, 17408
  s_nop 0
  buffer_load_dwordx4 v20, s[56:59], s27 offen lds
  s_add_u32 s27, s27, 16384
  s_add_u32 m0, s25, 18432
  s_nop 0
  buffer_load_dwordx4 v21, s[56:59], s27 offen lds
  s_add_u32 s27, s27, 16384
  s_add_u32 m0, s25, 19456
  s_nop 0
  buffer_load_dwordx4 v21, s[56:59], s27 offen lds
  s_add_u32 s27, s27, 16384
  s_add_u32 m0, s25, 20480
  s_nop 0
  buffer_load_dwordx4 v20, s[56:59], s27 offen lds
  s_add_u32 s27, s27, 16384
  s_add_u32 m0, s25, 21504
  s_nop 0
  buffer_load_dwordx4 v20, s[56:59], s27 offen lds
  s_add_u32 s27, s27, 16384
  s_add_u32 m0, s25, 22528
  s_nop 0
  buffer_load_dwordx4 v21, s[56:59], s27 offen lds
  s_add_u32 s27, s27, 16384
  s_add_u32 m0, s25, 23552
  s_nop 0
  buffer_load_dwordx4 v21, s[56:59], s27 offen lds
  s_add_u32 s27, s27, 16384
  s_add_u32 m0, s25, 24576
  s_nop 0
  buffer_load_dwordx4 v22, s[56:59], s27 offen lds
  s_add_u32 s27, s27, 16384
  s_add_u32 m0, s25, 25600
  s_nop 0
  buffer_load_dwordx4 v22, s[56:59], s27 offen lds
  s_add_u32 s27, s27, 16384
  s_add_u32 m0, s25, 26624
  s_nop 0
  buffer_load_dwordx4 v23, s[56:59], s27 offen lds
  s_add_u32 s27, s27, 16384
  s_add_u32 m0, s25, 27648
  s_nop 0
  buffer_load_dwordx4 v23, s[56:59], s27 offen lds
  s_add_u32 s27, s27, 16384
  s_add_u32 m0, s25, 28672
  s_nop 0
  buffer_load_dwordx4 v22, s[56:59], s27 offen lds
  s_add_u32 s27, s27, 16384
  s_add_u32 m0, s25, 29696
  s_nop 0
  buffer_load_dwordx4 v22, s[56:59], s27 offen lds
  s_add_u32 s27, s27, 16384
  s_add_u32 m0, s25, 30720
  s_nop 0
  buffer_load_dwordx4 v23, s[56:59], s27 offen lds
  s_add_u32 s27, s27, 16384
  s_add_u32 m0, s25, 31744
  s_nop 0
  buffer_load_dwordx4 v23, s[56:59], s27 offen lds
  s_add_u32 s27, s27, 16384
  v_mov_b32 v14, v26
  v_mov_b32 v15, v27
  s_lshl_b32 s28, s16, 16
  s_add_u32 s28, s28, s26
  s_lshl_b32 s29, s16, 12
  s_add_u32 m0, s29, 0
  s_add_u32 s27, s28, 0
  buffer_load_dwordx4 v14, s[60:63], s27 offen lds
  s_add_u32 m0, s29, 1024
  s_add_u32 s27, s28, 16384
  buffer_load_dwordx4 v15, s[60:63], s27 offen lds
  s_add_u32 m0, s29, 2048
  s_add_u32 s27, s28, 32768
  buffer_load_dwordx4 v14, s[60:63], s27 offen lds
  s_add_u32 m0, s29, 3072
  s_add_u32 s27, s28, 49152
  buffer_load_dwordx4 v15, s[60:63], s27 offen lds
  s_add_u32 m0, s29, 16384
  s_add_u32 s27, s28, 262144
  buffer_load_dwordx4 v14, s[60:63], s27 offen lds
  s_add_u32 m0, s29, 17408
  s_add_u32 s27, s28, 278528
  buffer_load_dwordx4 v15, s[60:63], s27 offen lds
  s_add_u32 m0, s29, 18432
  s_add_u32 s27, s28, 294912
  buffer_load_dwordx4 v14, s[60:63], s27 offen lds
  s_add_u32 m0, s29, 19456
  s_add_u32 s27, s28, 311296
  buffer_load_dwordx4 v15, s[60:63], s27 offen lds
  v_lshrrev_b32 v7, 2, v4
  v_lshlrev_b32 v11, 4, v7
  v_lshlrev_b32 v7, 3, v7
  v_and_b32 v8, 3, v4
  v_add_u32 v7, v7, v8
  v_and_b32 v8, 2, v4
  v_lshl_add_u32 v11, v8, 1, v11
  v_and_b32 v8, 1, v4
  v_add_u32 v11, v11, v8
  v_or_b32 v10, 0, v3
  v_xor_b32 v10, v10, v4
  v_lshlrev_b32 v10, 4, v10
  v_lshl_add_u32 v248, v7, 9, v10
  v_add_u32 v252, 65536, v248
  v_add_u32 v16, 131072, v248
  v_lshl_add_u32 v10, v11, 9, v10
  v_add_u32 v20, s25, v10
  v_or_b32 v10, 4, v3
  v_xor_b32 v10, v10, v4
  v_lshlrev_b32 v10, 4, v10
  v_lshl_add_u32 v249, v7, 9, v10
  v_add_u32 v253, 65536, v249
  v_add_u32 v17, 131072, v249
  v_lshl_add_u32 v10, v11, 9, v10
  v_add_u32 v21, s25, v10
  v_or_b32 v10, 8, v3
  v_xor_b32 v10, v10, v4
  v_lshlrev_b32 v10, 4, v10
  v_lshl_add_u32 v250, v7, 9, v10
  v_add_u32 v254, 65536, v250
  v_add_u32 v18, 131072, v250
  v_lshl_add_u32 v10, v11, 9, v10
  v_add_u32 v22, s25, v10
  v_or_b32 v10, 12, v3
  v_xor_b32 v10, v10, v4
  v_lshlrev_b32 v10, 4, v10
  v_lshl_add_u32 v251, v7, 9, v10
  v_add_u32 v255, 65536, v251
  v_add_u32 v19, 131072, v251
  v_lshl_add_u32 v10, v11, 9, v10
  v_add_u32 v23, s25, v10
  v_mov_b32 v12, 1035512379
  v_lshlrev_b32 v6, 7, v1
  s_getpc_b64 s[98:99]
  global_load_dword v7, v6, s[98:99]
  s_waitcnt vmcnt(9)
  ds_read_b128 v[120:123], v20 offset:0
  ds_read_b128 v[124:127], v21 offset:0
  ds_read_b128 v[128:131], v22 offset:0
  ds_read_b128 v[132:135], v23 offset:0
  ds_read_b128 v[136:139], v20 offset:256
  ds_read_b128 v[140:143], v21 offset:256
  ds_read_b128 v[144:147], v22 offset:256
  ds_read_b128 v[148:151], v23 offset:256
  s_waitcnt lgkmcnt(8)
  ds_read_b128 v[152:155], v20 offset:1024
  ds_read_b128 v[156:159], v21 offset:1024
  ds_read_b128 v[160:163], v22 offset:1024
  ds_read_b128 v[164:167], v23 offset:1024
  ds_read_b128 v[168:171], v20 offset:1280
  ds_read_b128 v[172:175], v21 offset:1280
  ds_read_b128 v[176:179], v22 offset:1280
  ds_read_b128 v[180:183], v23 offset:1280
  s_waitcnt lgkmcnt(8)
  ds_read_b128 v[184:187], v20 offset:4096
  ds_read_b128 v[188:191], v21 offset:4096
  ds_read_b128 v[192:195], v22 offset:4096
  ds_read_b128 v[196:199], v23 offset:4096
  ds_read_b128 v[200:203], v20 offset:4352
  ds_read_b128 v[204:207], v21 offset:4352
  ds_read_b128 v[208:211], v22 offset:4352
  ds_read_b128 v[212:215], v23 offset:4352
  s_waitcnt lgkmcnt(8)
  ds_read_b128 v[216:219], v20 offset:5120
  ds_read_b128 v[220:223], v21 offset:5120
  ds_read_b128 v[224:227], v22 offset:5120
  ds_read_b128 v[228:231], v23 offset:5120
  ds_read_b128 v[232:235], v20 offset:5376
  ds_read_b128 v[236:239], v21 offset:5376
  ds_read_b128 v[240:243], v22 offset:5376
  ds_read_b128 v[244:247], v23 offset:5376
  s_waitcnt lgkmcnt(8)
  s_waitcnt vmcnt(4) lgkmcnt(0)
  s_barrier
  s_add_u32 m0, s29, 32768
  s_add_u32 s27, s28, 524288
  buffer_load_dwordx4 v14, s[60:63], s27 offen lds
  s_add_u32 m0, s29, 33792
  s_add_u32 s27, s28, 540672
  buffer_load_dwordx4 v15, s[60:63], s27 offen lds
  s_add_u32 m0, s29, 34816
  s_add_u32 s27, s28, 557056
  buffer_load_dwordx4 v14, s[60:63], s27 offen lds
  s_add_u32 m0, s29, 35840
  s_add_u32 s27, s28, 573440
  buffer_load_dwordx4 v15, s[60:63], s27 offen lds
  ds_read_b128 v[24:27], v248 offset:0
  ds_read_b128 v[28:31], v248 offset:2048
  ds_read_b128 v[32:35], v249 offset:0
  ds_read_b128 v[36:39], v249 offset:2048
  ds_read_b128 v[40:43], v250 offset:0
  ds_read_b128 v[44:47], v250 offset:2048
  s_waitcnt lgkmcnt(5)
  s_getpc_b64 s[98:99]
  s_add_u32 s98, s98, 4096
  s_addc_u32 s99, s99, 0
  global_load_dword v7, v6, s[98:99]
  v_mfma_f32_16x16x32_bf16 v[56:59], v[24:27], v[120:123], 0
  ds_read_b128 v[48:51], v251 offset:0
  v_mfma_f32_16x16x32_bf16 v[64:67], v[24:27], v[152:155], 0
  v_mfma_f32_16x16x32_bf16 v[72:75], v[24:27], v[184:187], 0
  s_add_u32 m0, s29, 49152
  s_add_u32 s27, s28, 786432
  buffer_load_dwordx4 v14, s[60:63], s27 offen lds
  v_mfma_f32_16x16x32_bf16 v[80:83], v[24:27], v[216:219], 0
  s_waitcnt lgkmcnt(5)
  v_mfma_f32_16x16x32_bf16 v[60:63], v[28:31], v[120:123], 0
  ds_read_b128 v[52:55], v251 offset:2048
  v_mfma_f32_16x16x32_bf16 v[68:71], v[28:31], v[152:155], 0
  v_mfma_f32_16x16x32_bf16 v[76:79], v[28:31], v[184:187], 0
  v_mfma_f32_16x16x32_bf16 v[84:87], v[28:31], v[216:219], 0
  s_waitcnt lgkmcnt(5)
  v_mfma_f32_16x16x32_bf16 v[56:59], v[32:35], v[124:127], v[56:59]
  ds_read_b128 v[24:27], v248 offset:256
  v_mfma_f32_16x16x32_bf16 v[64:67], v[32:35], v[156:159], v[64:67]
  v_mfma_f32_16x16x32_bf16 v[72:75], v[32:35], v[188:191], v[72:75]
  s_add_u32 m0, s29, 50176
  s_add_u32 s27, s28, 802816
  buffer_load_dwordx4 v15, s[60:63], s27 offen lds
  v_mfma_f32_16x16x32_bf16 v[80:83], v[32:35], v[220:223], v[80:83]
  s_waitcnt lgkmcnt(5)
  v_mfma_f32_16x16x32_bf16 v[60:63], v[36:39], v[124:127], v[60:63]
  ds_read_b128 v[28:31], v248 offset:2304
  v_mfma_f32_16x16x32_bf16 v[68:71], v[36:39], v[156:159], v[68:71]
  v_mfma_f32_16x16x32_bf16 v[76:79], v[36:39], v[188:191], v[76:79]
  v_mfma_f32_16x16x32_bf16 v[84:87], v[36:39], v[220:223], v[84:87]
  s_waitcnt lgkmcnt(5)
  v_mfma_f32_16x16x32_bf16 v[56:59], v[40:43], v[128:131], v[56:59]
  ds_read_b128 v[32:35], v249 offset:256
  v_mfma_f32_16x16x32_bf16 v[64:67], v[40:43], v[160:163], v[64:67]
  v_mfma_f32_16x16x32_bf16 v[72:75], v[40:43], v[192:195], v[72:75]
  s_add_u32 m0, s29, 51200
  s_add_u32 s27, s28, 819200
  buffer_load_dwordx4 v14, s[60:63], s27 offen lds
  v_mfma_f32_16x16x32_bf16 v[80:83], v[40:43], v[224:227], v[80:83]
  s_waitcnt lgkmcnt(5)
  v_mfma_f32_16x16x32_bf16 v[60:63], v[44:47], v[128:131], v[60:63]
  ds_read_b128 v[36:39], v249 offset:2304
  v_mfma_f32_16x16x32_bf16 v[68:71], v[44:47], v[160:163], v[68:71]
  v_mfma_f32_16x16x32_bf16 v[76:79], v[44:47], v[192:195], v[76:79]
  v_mfma_f32_16x16x32_bf16 v[84:87], v[44:47], v[224:227], v[84:87]
  s_waitcnt lgkmcnt(5)
  v_mfma_f32_16x16x32_bf16 v[56:59], v[48:51], v[132:135], v[56:59]
  ds_read_b128 v[40:43], v250 offset:256
  v_mfma_f32_16x16x32_bf16 v[64:67], v[48:51], v[164:167], v[64:67]
  v_mfma_f32_16x16x32_bf16 v[72:75], v[48:51], v[196:199], v[72:75]
  s_add_u32 m0, s29, 52224
  s_add_u32 s27, s28, 835584
  buffer_load_dwordx4 v15, s[60:63], s27 offen lds
  v_mfma_f32_16x16x32_bf16 v[80:83], v[48:51], v[228:231], v[80:83]
  s_waitcnt lgkmcnt(5)
  v_mfma_f32_16x16x32_bf16 v[60:63], v[52:55], v[132:135], v[60:63]
  ds_read_b128 v[44:47], v250 offset:2304
  v_mfma_f32_16x16x32_bf16 v[68:71], v[52:55], v[164:167], v[68:71]
  v_mfma_f32_16x16x32_bf16 v[76:79], v[52:55], v[196:199], v[76:79]
  v_mfma_f32_16x16x32_bf16 v[84:87], v[52:55], v[228:231], v[84:87]
  s_waitcnt lgkmcnt(5)
  v_mfma_f32_16x16x32_bf16 v[56:59], v[24:27], v[136:139], v[56:59]
  ds_read_b128 v[48:51], v251 offset:256
  v_mfma_f32_16x16x32_bf16 v[64:67], v[24:27], v[168:171], v[64:67]
  v_mfma_f32_16x16x32_bf16 v[72:75], v[24:27], v[200:203], v[72:75]
  v_mfma_f32_16x16x32_bf16 v[80:83], v[24:27], v[232:235], v[80:83]
  s_waitcnt lgkmcnt(5)
  v_mfma_f32_16x16x32_bf16 v[60:63], v[28:31], v[136:139], v[60:63]
  ds_read_b128 v[52:55], v251 offset:2304
  v_mfma_f32_16x16x32_bf16 v[68:71], v[28:31], v[168:171], v[68:71]
  v_mfma_f32_16x16x32_bf16 v[76:79], v[28:31], v[200:203], v[76:79]
  v_mfma_f32_16x16x32_bf16 v[84:87], v[28:31], v[232:235], v[84:87]
  s_waitcnt lgkmcnt(5)
  v_mfma_f32_16x16x32_bf16 v[56:59], v[32:35], v[140:143], v[56:59]
  s_waitcnt vmcnt(8)
  s_barrier
  ds_read_b128 v[24:27], v248 offset:16384
  v_mfma_f32_16x16x32_bf16 v[64:67], v[32:35], v[172:175], v[64:67]
  v_mfma_f32_16x16x32_bf16 v[72:75], v[32:35], v[204:207], v[72:75]
  v_mfma_f32_16x16x32_bf16 v[80:83], v[32:35], v[236:239], v[80:83]
  s_waitcnt lgkmcnt(5)
  v_mfma_f32_16x16x32_bf16 v[60:63], v[36:39], v[140:143], v[60:63]
  ds_read_b128 v[28:31], v248 offset:18432
  v_mfma_f32_16x16x32_bf16 v[68:71], v[36:39], v[172:175], v[68:71]
  v_mfma_f32_16x16x32_bf16 v[76:79], v[36:39], v[204:207], v[76:79]
  v_mfma_f32_16x16x32_bf16 v[84:87], v[36:39], v[236:239], v[84:87]
  s_waitcnt lgkmcnt(5)
  v_mfma_f32_16x16x32_bf16 v[56:59], v[40:43], v[144:147], v[56:59]
  ds_read_b128 v[32:35], v249 offset:16384
  v_mfma_f32_16x16x32_bf16 v[64:67], v[40:43], v[176:179], v[64:67]
  v_mfma_f32_16x16x32_bf16 v[72:75], v[40:43], v[208:211], v[72:75]
  v_mfma_f32_16x16x32_bf16 v[80:83], v[40:43], v[240:243], v[80:83]
  s_waitcnt lgkmcnt(5)
  v_mfma_f32_16x16x32_bf16 v[60:63], v[44:47], v[144:147], v[60:63]
  ds_read_b128 v[36:39], v249 offset:18432
  v_mfma_f32_16x16x32_bf16 v[68:71], v[44:47], v[176:179], v[68:71]
  v_mfma_f32_16x16x32_bf16 v[76:79], v[44:47], v[208:211], v[76:79]
  v_mfma_f32_16x16x32_bf16 v[84:87], v[44:47], v[240:243], v[84:87]
  s_waitcnt lgkmcnt(5)
  v_mfma_f32_16x16x32_bf16 v[56:59], v[48:51], v[148:151], v[56:59]
  ds_read_b128 v[40:43], v250 offset:16384
  v_mfma_f32_16x16x32_bf16 v[64:67], v[48:51], v[180:183], v[64:67]
  v_mfma_f32_16x16x32_bf16 v[72:75], v[48:51], v[212:215], v[72:75]
  v_mfma_f32_16x16x32_bf16 v[80:83], v[48:51], v[244:247], v[80:83]
  s_waitcnt lgkmcnt(5)
  v_mfma_f32_16x16x32_bf16 v[60:63], v[52:55], v[148:151], v[60:63]
  ds_read_b128 v[44:47], v250 offset:18432
  v_mfma_f32_16x16x32_bf16 v[68:71], v[52:55], v[180:183], v[68:71]
  v_mfma_f32_16x16x32_bf16 v[76:79], v[52:55], v[212:215], v[76:79]
  v_mfma_f32_16x16x32_bf16 v[84:87], v[52:55], v[244:247], v[84:87]
  s_waitcnt lgkmcnt(5)
  v_mfma_f32_16x16x32_bf16 v[88:91], v[24:27], v[120:123], 0
  ds_read_b128 v[48:51], v251 offset:16384
  v_mfma_f32_16x16x32_bf16 v[96:99], v[24:27], v[152:155], 0
  v_mfma_f32_16x16x32_bf16 v[104:107], v[24:27], v[184:187], 0
  s_add_u32 m0, s29, 65536
  s_add_u32 s27, s28, 1048576
  buffer_load_dwordx4 v14, s[60:63], s27 offen lds
  v_mfma_f32_16x16x32_bf16 v[112:115], v[24:27], v[216:219], 0
  s_waitcnt lgkmcnt(5)
  v_mul_f32 v56, v12, v56
  v_mfma_f32_16x16x32_bf16 v[92:95], v[28:31], v[120:123], 0
  ds_read_b128 v[52:55], v251 offset:18432
  v_mul_f32 v57, v12, v57
  v_mfma_f32_16x16x32_bf16 v[100:103], v[28:31], v[152:155], 0
  v_mul_f32 v58, v12, v58
  v_mul_f32 v59, v12, v59
  v_mfma_f32_16x16x32_bf16 v[108:111], v[28:31], v[184:187], 0
  v_mul_f32 v60, v12, v60
  v_mfma_f32_16x16x32_bf16 v[116:119], v[28:31], v[216:219], 0
  s_waitcnt lgkmcnt(5)
  v_mul_f32 v61, v12, v61
  v_mfma_f32_16x16x32_bf16 v[88:91], v[32:35], v[124:127], v[88:91]
  ds_read_b128 v[24:27], v248 offset:16640
  v_mul_f32 v62, v12, v62
  v_mfma_f32_16x16x32_bf16 v[96:99], v[32:35], v[156:159], v[96:99]
  v_mul_f32 v63, v12, v63
  v_cvt_pk_bf16_f32 v56, v56, v57
  v_mfma_f32_16x16x32_bf16 v[104:107], v[32:35], v[188:191], v[104:107]
  s_add_u32 m0, s29, 66560
  s_add_u32 s27, s28, 1064960
  buffer_load_dwordx4 v15, s[60:63], s27 offen lds
  v_mfma_f32_16x16x32_bf16 v[112:115], v[32:35], v[220:223], v[112:115]
  s_waitcnt lgkmcnt(5)
  v_cvt_pk_bf16_f32 v57, v58, v59
  v_mfma_f32_16x16x32_bf16 v[92:95], v[36:39], v[124:127], v[92:95]
  ds_read_b128 v[28:31], v248 offset:18688
  v_cvt_pk_bf16_f32 v58, v60, v61
  v_mfma_f32_16x16x32_bf16 v[100:103], v[36:39], v[156:159], v[100:103]
  v_cvt_pk_bf16_f32 v59, v62, v63
  v_accvgpr_write_b32 a0, v56
  v_mfma_f32_16x16x32_bf16 v[108:111], v[36:39], v[188:191], v[108:111]
  v_accvgpr_write_b32 a1, v57
  v_mfma_f32_16x16x32_bf16 v[116:119], v[36:39], v[220:223], v[116:119]
  s_waitcnt lgkmcnt(5)
  v_accvgpr_write_b32 a2, v58
  v_mfma_f32_16x16x32_bf16 v[88:91], v[40:43], v[128:131], v[88:91]
  ds_read_b128 v[32:35], v249 offset:16640
  v_accvgpr_write_b32 a3, v59
  v_mfma_f32_16x16x32_bf16 v[96:99], v[40:43], v[160:163], v[96:99]
  v_mul_f32 v64, v12, v64
  v_mul_f32 v65, v12, v65
  v_mfma_f32_16x16x32_bf16 v[104:107], v[40:43], v[192:195], v[104:107]
  s_add_u32 m0, s29, 67584
  s_add_u32 s27, s28, 1081344
  buffer_load_dwordx4 v14, s[60:63], s27 offen lds
  v_mfma_f32_16x16x32_bf16 v[112:115], v[40:43], v[224:227], v[112:115]
  s_waitcnt lgkmcnt(5)
  v_mul_f32 v66, v12, v66
  v_mfma_f32_16x16x32_bf16 v[92:95], v[44:47], v[128:131], v[92:95]
  ds_read_b128 v[36:39], v249 offset:18688
  v_mul_f32 v67, v12, v67
  v_mfma_f32_16x16x32_bf16 v[100:103], v[44:47], v[160:163], v[100:103]
  v_mul_f32 v68, v12, v68
  v_mul_f32 v69, v12, v69
  v_mfma_f32_16x16x32_bf16 v[108:111], v[44:47], v[192:195], v[108:111]
  v_mul_f32 v70, v12, v70
  v_mfma_f32_16x16x32_bf16 v[116:119], v[44:47], v[224:227], v[116:119]
  s_waitcnt lgkmcnt(5)
  v_mul_f32 v71, v12, v71
  v_mfma_f32_16x16x32_bf16 v[88:91], v[48:51], v[132:135], v[88:91]
  ds_read_b128 v[40:43], v250 offset:16640
  v_cvt_pk_bf16_f32 v64, v64, v65
  v_mfma_f32_16x16x32_bf16 v[96:99], v[48:51], v[164:167], v[96:99]
  v_cvt_pk_bf16_f32 v65, v66, v67
  v_cvt_pk_bf16_f32 v66, v68, v69
  v_mfma_f32_16x16x32_bf16 v[104:107], v[48:51], v[196:199], v[104:107]
  s_add_u32 m0, s29, 68608
  s_add_u32 s27, s28, 1097728
  buffer_load_dwordx4 v15, s[60:63], s27 offen lds
  v_mfma_f32_16x16x32_bf16 v[112:115], v[48:51], v[228:231], v[112:115]
  s_waitcnt lgkmcnt(5)
  v_cvt_pk_bf16_f32 v67, v70, v71
  v_mfma_f32_16x16x32_bf16 v[92:95], v[52:55], v[132:135], v[92:95]
  ds_read_b128 v[44:47], v250 offset:18688
  v_accvgpr_write_b32 a56, v64
  v_mfma_f32_16x16x32_bf16 v[100:103], v[52:55], v[164:167], v[100:103]
  v_accvgpr_write_b32 a57, v65
  v_accvgpr_write_b32 a58, v66
  v_mfma_f32_16x16x32_bf16 v[108:111], v[52:55], v[196:199], v[108:111]
  v_accvgpr_write_b32 a59, v67
  v_mfma_f32_16x16x32_bf16 v[116:119], v[52:55], v[228:231], v[116:119]
  s_waitcnt lgkmcnt(5)
  v_mul_f32 v72, v12, v72
  v_mfma_f32_16x16x32_bf16 v[88:91], v[24:27], v[136:139], v[88:91]
  ds_read_b128 v[48:51], v251 offset:16640
  v_mul_f32 v73, v12, v73
  v_mfma_f32_16x16x32_bf16 v[96:99], v[24:27], v[168:171], v[96:99]
  v_mul_f32 v74, v12, v74
  v_mul_f32 v75, v12, v75
  v_mfma_f32_16x16x32_bf16 v[104:107], v[24:27], v[200:203], v[104:107]
  v_mul_f32 v76, v12, v76
  v_mfma_f32_16x16x32_bf16 v[112:115], v[24:27], v[232:235], v[112:115]
  s_waitcnt lgkmcnt(5)
  v_mul_f32 v77, v12, v77
  v_mfma_f32_16x16x32_bf16 v[92:95], v[28:31], v[136:139], v[92:95]
  ds_read_b128 v[52:55], v251 offset:18688
  v_mul_f32 v78, v12, v78
  v_mfma_f32_16x16x32_bf16 v[100:103], v[28:31], v[168:171], v[100:103]
  v_mul_f32 v79, v12, v79
  v_cvt_pk_bf16_f32 v72, v72, v73
  v_mfma_f32_16x16x32_bf16 v[108:111], v[28:31], v[200:203], v[108:111]
  v_cvt_pk_bf16_f32 v73, v74, v75
  v_mfma_f32_16x16x32_bf16 v[116:119], v[28:31], v[232:235], v[116:119]
  s_waitcnt lgkmcnt(5)
  v_cvt_pk_bf16_f32 v74, v76, v77
  v_mfma_f32_16x16x32_bf16 v[88:91], v[32:35], v[140:143], v[88:91]
  s_waitcnt vmcnt(8)
  s_barrier
  ds_read_b128 v[24:27], v248 offset:32768
  v_cvt_pk_bf16_f32 v75, v78, v79
  v_mfma_f32_16x16x32_bf16 v[96:99], v[32:35], v[172:175], v[96:99]
  v_accvgpr_write_b32 a112, v72
  v_accvgpr_write_b32 a113, v73
  v_mfma_f32_16x16x32_bf16 v[104:107], v[32:35], v[204:207], v[104:107]
  v_accvgpr_write_b32 a114, v74
  v_mfma_f32_16x16x32_bf16 v[112:115], v[32:35], v[236:239], v[112:115]
  s_waitcnt lgkmcnt(5)
  v_accvgpr_write_b32 a115, v75
  v_mfma_f32_16x16x32_bf16 v[92:95], v[36:39], v[140:143], v[92:95]
  ds_read_b128 v[28:31], v248 offset:34816
  v_mul_f32 v80, v12, v80
  v_mfma_f32_16x16x32_bf16 v[100:103], v[36:39], v[172:175], v[100:103]
  v_mul_f32 v81, v12, v81
  v_mul_f32 v82, v12, v82
  v_mfma_f32_16x16x32_bf16 v[108:111], v[36:39], v[204:207], v[108:111]
  v_mul_f32 v83, v12, v83
  v_mfma_f32_16x16x32_bf16 v[116:119], v[36:39], v[236:239], v[116:119]
  s_waitcnt lgkmcnt(5)
  v_mul_f32 v84, v12, v84
  v_mfma_f32_16x16x32_bf16 v[88:91], v[40:43], v[144:147], v[88:91]
  ds_read_b128 v[32:35], v249 offset:32768
  v_mul_f32 v85, v12, v85
  v_mfma_f32_16x16x32_bf16 v[96:99], v[40:43], v[176:179], v[96:99]
  v_mul_f32 v86, v12, v86
  v_mul_f32 v87, v12, v87
  v_mfma_f32_16x16x32_bf16 v[104:107], v[40:43], v[208:211], v[104:107]
  v_cvt_pk_bf16_f32 v80, v80, v81
  v_mfma_f32_16x16x32_bf16 v[112:115], v[40:43], v[240:243], v[112:115]
  s_waitcnt lgkmcnt(5)
  v_cvt_pk_bf16_f32 v81, v82, v83
  v_mfma_f32_16x16x32_bf16 v[92:95], v[44:47], v[144:147], v[92:95]
  ds_read_b128 v[36:39], v249 offset:34816
  v_cvt_pk_bf16_f32 v82, v84, v85
  v_mfma_f32_16x16x32_bf16 v[100:103], v[44:47], v[176:179], v[100:103]
  v_cvt_pk_bf16_f32 v83, v86, v87
  v_accvgpr_write_b32 a168, v80
  v_mfma_f32_16x16x32_bf16 v[108:111], v[44:47], v[208:211], v[108:111]
  v_accvgpr_write_b32 a169, v81
  v_mfma_f32_16x16x32_bf16 v[116:119], v[44:47], v[240:243], v[116:119]
  s_waitcnt lgkmcnt(5)
  v_accvgpr_write_b32 a170, v82
  v_mfma_f32_16x16x32_bf16 v[88:91], v[48:51], v[148:151], v[88:91]
  ds_read_b128 v[40:43], v250 offset:32768
  v_accvgpr_write_b32 a171, v83
  v_mfma_f32_16x16x32_bf16 v[96:99], v[48:51], v[180:183], v[96:99]
  v_mfma_f32_16x16x32_bf16 v[104:107], v[48:51], v[212:215], v[104:107]
  v_mfma_f32_16x16x32_bf16 v[112:115], v[48:51], v[244:247], v[112:115]
  s_waitcnt lgkmcnt(5)
  v_mfma_f32_16x16x32_bf16 v[92:95], v[52:55], v[148:151], v[92:95]
  ds_read_b128 v[44:47], v250 offset:34816
  v_mfma_f32_16x16x32_bf16 v[100:103], v[52:55], v[180:183], v[100:103]
  v_mfma_f32_16x16x32_bf16 v[108:111], v[52:55], v[212:215], v[108:111]
  v_mfma_f32_16x16x32_bf16 v[116:119], v[52:55], v[244:247], v[116:119]
  s_waitcnt lgkmcnt(5)
  v_mfma_f32_16x16x32_bf16 v[56:59], v[24:27], v[120:123], 0
  ds_read_b128 v[48:51], v251 offset:32768
  v_mfma_f32_16x16x32_bf16 v[64:67], v[24:27], v[152:155], 0
  v_mfma_f32_16x16x32_bf16 v[72:75], v[24:27], v[184:187], 0
  s_add_u32 m0, s29, 81920
  s_add_u32 s27, s28, 1310720
  buffer_load_dwordx4 v14, s[60:63], s27 offen lds
  v_mfma_f32_16x16x32_bf16 v[80:83], v[24:27], v[216:219], 0
  s_waitcnt lgkmcnt(5)
  v_mul_f32 v88, v12, v88
  v_mfma_f32_16x16x32_bf16 v[60:63], v[28:31], v[120:123], 0
  ds_read_b128 v[52:55], v251 offset:34816
  v_mul_f32 v89, v12, v89
  v_mfma_f32_16x16x32_bf16 v[68:71], v[28:31], v[152:155], 0
  v_mul_f32 v90, v12, v90
  v_mul_f32 v91, v12, v91
  v_mfma_f32_16x16x32_bf16 v[76:79], v[28:31], v[184:187], 0
  v_mul_f32 v92, v12, v92
  v_mfma_f32_16x16x32_bf16 v[84:87], v[28:31], v[216:219], 0
  s_waitcnt lgkmcnt(5)
  v_mul_f32 v93, v12, v93
  v_mfma_f32_16x16x32_bf16 v[56:59], v[32:35], v[124:127], v[56:59]
  ds_read_b128 v[24:27], v248 offset:33024
  v_mul_f32 v94, v12, v94
  v_mfma_f32_16x16x32_bf16 v[64:67], v[32:35], v[156:159], v[64:67]
  v_mul_f32 v95, v12, v95
  v_cvt_pk_bf16_f32 v88, v88, v89
  v_mfma_f32_16x16x32_bf16 v[72:75], v[32:35], v[188:191], v[72:75]
  s_add_u32 m0, s29, 82944
  s_add_u32 s27, s28, 1327104
  buffer_load_dwordx4 v15, s[60:63], s27 offen lds
  v_mfma_f32_16x16x32_bf16 v[80:83], v[32:35], v[220:223], v[80:83]
  s_waitcnt lgkmcnt(5)
  v_cvt_pk_bf16_f32 v89, v90, v91
  v_mfma_f32_16x16x32_bf16 v[60:63], v[36:39], v[124:127], v[60:63]
  ds_read_b128 v[28:31], v248 offset:35072
  v_cvt_pk_bf16_f32 v90, v92, v93
  v_mfma_f32_16x16x32_bf16 v[68:71], v[36:39], v[156:159], v[68:71]
  v_cvt_pk_bf16_f32 v91, v94, v95
  v_accvgpr_write_b32 a4, v88
  v_mfma_f32_16x16x32_bf16 v[76:79], v[36:39], v[188:191], v[76:79]
  v_accvgpr_write_b32 a5, v89
  v_mfma_f32_16x16x32_bf16 v[84:87], v[36:39], v[220:223], v[84:87]
  s_waitcnt lgkmcnt(5)
  v_accvgpr_write_b32 a6, v90
  v_mfma_f32_16x16x32_bf16 v[56:59], v[40:43], v[128:131], v[56:59]
  ds_read_b128 v[32:35], v249 offset:33024
  v_accvgpr_write_b32 a7, v91
  v_mfma_f32_16x16x32_bf16 v[64:67], v[40:43], v[160:163], v[64:67]
  v_mul_f32 v96, v12, v96
  v_mul_f32 v97, v12, v97
  v_mfma_f32_16x16x32_bf16 v[72:75], v[40:43], v[192:195], v[72:75]
  s_add_u32 m0, s29, 83968
  s_add_u32 s27, s28, 1343488
  buffer_load_dwordx4 v14, s[60:63], s27 offen lds
  v_mfma_f32_16x16x32_bf16 v[80:83], v[40:43], v[224:227], v[80:83]
  s_waitcnt lgkmcnt(5)
  v_mul_f32 v98, v12, v98
  v_mfma_f32_16x16x32_bf16 v[60:63], v[44:47], v[128:131], v[60:63]
  ds_read_b128 v[36:39], v249 offset:35072
  v_mul_f32 v99, v12, v99
  v_mfma_f32_16x16x32_bf16 v[68:71], v[44:47], v[160:163], v[68:71]
  v_mul_f32 v100, v12, v100
  v_mul_f32 v101, v12, v101
  v_mfma_f32_16x16x32_bf16 v[76:79], v[44:47], v[192:195], v[76:79]
  v_mul_f32 v102, v12, v102
  v_mfma_f32_16x16x32_bf16 v[84:87], v[44:47], v[224:227], v[84:87]
  s_waitcnt lgkmcnt(5)
  v_mul_f32 v103, v12, v103
  v_mfma_f32_16x16x32_bf16 v[56:59], v[48:51], v[132:135], v[56:59]
  ds_read_b128 v[40:43], v250 offset:33024
  v_cvt_pk_bf16_f32 v96, v96, v97
  v_mfma_f32_16x16x32_bf16 v[64:67], v[48:51], v[164:167], v[64:67]
  v_cvt_pk_bf16_f32 v97, v98, v99
  v_cvt_pk_bf16_f32 v98, v100, v101
  v_mfma_f32_16x16x32_bf16 v[72:75], v[48:51], v[196:199], v[72:75]
  s_add_u32 m0, s29, 84992
  s_add_u32 s27, s28, 1359872
  buffer_load_dwordx4 v15, s[60:63], s27 offen lds
  v_mfma_f32_16x16x32_bf16 v[80:83], v[48:51], v[228:231], v[80:83]
  s_waitcnt lgkmcnt(5)
  v_cvt_pk_bf16_f32 v99, v102, v103
  v_mfma_f32_16x16x32_bf16 v[60:63], v[52:55], v[132:135], v[60:63]
  ds_read_b128 v[44:47], v250 offset:35072
  v_accvgpr_write_b32 a60, v96
  v_mfma_f32_16x16x32_bf16 v[68:71], v[52:55], v[164:167], v[68:71]
  v_accvgpr_write_b32 a61, v97
  v_accvgpr_write_b32 a62, v98
  v_mfma_f32_16x16x32_bf16 v[76:79], v[52:55], v[196:199], v[76:79]
  v_accvgpr_write_b32 a63, v99
  v_mfma_f32_16x16x32_bf16 v[84:87], v[52:55], v[228:231], v[84:87]
  s_waitcnt lgkmcnt(5)
  v_mul_f32 v104, v12, v104
  v_mfma_f32_16x16x32_bf16 v[56:59], v[24:27], v[136:139], v[56:59]
  ds_read_b128 v[48:51], v251 offset:33024
  v_mul_f32 v105, v12, v105
  v_mfma_f32_16x16x32_bf16 v[64:67], v[24:27], v[168:171], v[64:67]
  v_mul_f32 v106, v12, v106
  v_mul_f32 v107, v12, v107
  v_mfma_f32_16x16x32_bf16 v[72:75], v[24:27], v[200:203], v[72:75]
  v_mul_f32 v108, v12, v108
  v_mfma_f32_16x16x32_bf16 v[80:83], v[24:27], v[232:235], v[80:83]
  s_waitcnt lgkmcnt(5)
  v_mul_f32 v109, v12, v109
  v_mfma_f32_16x16x32_bf16 v[60:63], v[28:31], v[136:139], v[60:63]
  ds_read_b128 v[52:55], v251 offset:35072
  v_mul_f32 v110, v12, v110
  v_mfma_f32_16x16x32_bf16 v[68:71], v[28:31], v[168:171], v[68:71]
  v_mul_f32 v111, v12, v111
  v_cvt_pk_bf16_f32 v104, v104, v105
  v_mfma_f32_16x16x32_bf16 v[76:79], v[28:31], v[200:203], v[76:79]
  v_cvt_pk_bf16_f32 v105, v106, v107
  v_mfma_f32_16x16x32_bf16 v[84:87], v[28:31], v[232:235], v[84:87]
  s_waitcnt lgkmcnt(5)
  v_cvt_pk_bf16_f32 v106, v108, v109
  v_mfma_f32_16x16x32_bf16 v[56:59], v[32:35], v[140:143], v[56:59]
  s_waitcnt vmcnt(8)
  s_barrier
  ds_read_b128 v[24:27], v248 offset:49152
  v_cvt_pk_bf16_f32 v107, v110, v111
  v_mfma_f32_16x16x32_bf16 v[64:67], v[32:35], v[172:175], v[64:67]
  v_accvgpr_write_b32 a116, v104
  v_accvgpr_write_b32 a117, v105
  v_mfma_f32_16x16x32_bf16 v[72:75], v[32:35], v[204:207], v[72:75]
  v_accvgpr_write_b32 a118, v106
  v_mfma_f32_16x16x32_bf16 v[80:83], v[32:35], v[236:239], v[80:83]
  s_waitcnt lgkmcnt(5)
  v_accvgpr_write_b32 a119, v107
  v_mfma_f32_16x16x32_bf16 v[60:63], v[36:39], v[140:143], v[60:63]
  ds_read_b128 v[28:31], v248 offset:51200
  v_mul_f32 v112, v12, v112
  v_mfma_f32_16x16x32_bf16 v[68:71], v[36:39], v[172:175], v[68:71]
  v_mul_f32 v113, v12, v113
  v_mul_f32 v114, v12, v114
  v_mfma_f32_16x16x32_bf16 v[76:79], v[36:39], v[204:207], v[76:79]
  v_mul_f32 v115, v12, v115
  v_mfma_f32_16x16x32_bf16 v[84:87], v[36:39], v[236:239], v[84:87]
  s_waitcnt lgkmcnt(5)
  v_mul_f32 v116, v12, v116
  v_mfma_f32_16x16x32_bf16 v[56:59], v[40:43], v[144:147], v[56:59]
  ds_read_b128 v[32:35], v249 offset:49152
  v_mul_f32 v117, v12, v117
  v_mfma_f32_16x16x32_bf16 v[64:67], v[40:43], v[176:179], v[64:67]
  v_mul_f32 v118, v12, v118
  v_mul_f32 v119, v12, v119
  v_mfma_f32_16x16x32_bf16 v[72:75], v[40:43], v[208:211], v[72:75]
  v_cvt_pk_bf16_f32 v112, v112, v113
  v_mfma_f32_16x16x32_bf16 v[80:83], v[40:43], v[240:243], v[80:83]
  s_waitcnt lgkmcnt(5)
  v_cvt_pk_bf16_f32 v113, v114, v115
  v_mfma_f32_16x16x32_bf16 v[60:63], v[44:47], v[144:147], v[60:63]
  ds_read_b128 v[36:39], v249 offset:51200
  v_cvt_pk_bf16_f32 v114, v116, v117
  v_mfma_f32_16x16x32_bf16 v[68:71], v[44:47], v[176:179], v[68:71]
  v_cvt_pk_bf16_f32 v115, v118, v119
  v_accvgpr_write_b32 a172, v112
  v_mfma_f32_16x16x32_bf16 v[76:79], v[44:47], v[208:211], v[76:79]
  v_accvgpr_write_b32 a173, v113
  v_mfma_f32_16x16x32_bf16 v[84:87], v[44:47], v[240:243], v[84:87]
  s_waitcnt lgkmcnt(5)
  v_accvgpr_write_b32 a174, v114
  v_mfma_f32_16x16x32_bf16 v[56:59], v[48:51], v[148:151], v[56:59]
  ds_read_b128 v[40:43], v250 offset:49152
  v_accvgpr_write_b32 a175, v115
  v_mfma_f32_16x16x32_bf16 v[64:67], v[48:51], v[180:183], v[64:67]
  v_mfma_f32_16x16x32_bf16 v[72:75], v[48:51], v[212:215], v[72:75]
  v_mfma_f32_16x16x32_bf16 v[80:83], v[48:51], v[244:247], v[80:83]
  s_waitcnt lgkmcnt(5)
  v_mfma_f32_16x16x32_bf16 v[60:63], v[52:55], v[148:151], v[60:63]
  ds_read_b128 v[44:47], v250 offset:51200
  v_mfma_f32_16x16x32_bf16 v[68:71], v[52:55], v[180:183], v[68:71]
  v_mfma_f32_16x16x32_bf16 v[76:79], v[52:55], v[212:215], v[76:79]
  v_mfma_f32_16x16x32_bf16 v[84:87], v[52:55], v[244:247], v[84:87]
  s_waitcnt lgkmcnt(5)
  s_getpc_b64 s[98:99]
  s_add_u32 s98, s98, 4096
  s_addc_u32 s99, s99, 0
  global_load_dword v7, v6, s[98:99]
  v_mfma_f32_16x16x32_bf16 v[88:91], v[24:27], v[120:123], 0
  ds_read_b128 v[48:51], v251 offset:49152
  v_mfma_f32_16x16x32_bf16 v[96:99], v[24:27], v[152:155], 0
  v_mfma_f32_16x16x32_bf16 v[104:107], v[24:27], v[184:187], 0
  s_add_u32 m0, s29, 98304
  s_add_u32 s27, s28, 1572864
  buffer_load_dwordx4 v14, s[60:63], s27 offen lds
  v_mfma_f32_16x16x32_bf16 v[112:115], v[24:27], v[216:219], 0
  s_waitcnt lgkmcnt(5)
  v_mul_f32 v56, v12, v56
  v_mfma_f32_16x16x32_bf16 v[92:95], v[28:31], v[120:123], 0
  ds_read_b128 v[52:55], v251 offset:51200
  v_mul_f32 v57, v12, v57
  v_mfma_f32_16x16x32_bf16 v[100:103], v[28:31], v[152:155], 0
  v_mul_f32 v58, v12, v58
  v_mul_f32 v59, v12, v59
  v_mfma_f32_16x16x32_bf16 v[108:111], v[28:31], v[184:187], 0
  v_mul_f32 v60, v12, v60
  v_mfma_f32_16x16x32_bf16 v[116:119], v[28:31], v[216:219], 0
  s_waitcnt lgkmcnt(5)
  v_mul_f32 v61, v12, v61
  v_mfma_f32_16x16x32_bf16 v[88:91], v[32:35], v[124:127], v[88:91]
  ds_read_b128 v[24:27], v248 offset:49408
  v_mul_f32 v62, v12, v62
  v_mfma_f32_16x16x32_bf16 v[96:99], v[32:35], v[156:159], v[96:99]
  v_mul_f32 v63, v12, v63
  v_cvt_pk_bf16_f32 v56, v56, v57
  v_mfma_f32_16x16x32_bf16 v[104:107], v[32:35], v[188:191], v[104:107]
  s_add_u32 m0, s29, 99328
  s_add_u32 s27, s28, 1589248
  buffer_load_dwordx4 v15, s[60:63], s27 offen lds
  v_mfma_f32_16x16x32_bf16 v[112:115], v[32:35], v[220:223], v[112:115]
  s_waitcnt lgkmcnt(5)
  v_cvt_pk_bf16_f32 v57, v58, v59
  v_mfma_f32_16x16x32_bf16 v[92:95], v[36:39], v[124:127], v[92:95]
  ds_read_b128 v[28:31], v248 offset:51456
  v_cvt_pk_bf16_f32 v58, v60, v61
  v_mfma_f32_16x16x32_bf16 v[100:103], v[36:39], v[156:159], v[100:103]
  v_cvt_pk_bf16_f32 v59, v62, v63
  v_accvgpr_write_b32 a8, v56
  v_mfma_f32_16x16x32_bf16 v[108:111], v[36:39], v[188:191], v[108:111]
  v_accvgpr_write_b32 a9, v57
  v_mfma_f32_16x16x32_bf16 v[116:119], v[36:39], v[220:223], v[116:119]
  s_waitcnt lgkmcnt(5)
  v_accvgpr_write_b32 a10, v58
  v_mfma_f32_16x16x32_bf16 v[88:91], v[40:43], v[128:131], v[88:91]
  ds_read_b128 v[32:35], v249 offset:49408
  v_accvgpr_write_b32 a11, v59
  v_mfma_f32_16x16x32_bf16 v[96:99], v[40:43], v[160:163], v[96:99]
  v_mul_f32 v64, v12, v64
  v_mul_f32 v65, v12, v65
  v_mfma_f32_16x16x32_bf16 v[104:107], v[40:43], v[192:195], v[104:107]
  s_add_u32 m0, s29, 100352
  s_add_u32 s27, s28, 1605632
  buffer_load_dwordx4 v14, s[60:63], s27 offen lds
  v_mfma_f32_16x16x32_bf16 v[112:115], v[40:43], v[224:227], v[112:115]
  s_waitcnt lgkmcnt(5)
  v_mul_f32 v66, v12, v66
  v_mfma_f32_16x16x32_bf16 v[92:95], v[44:47], v[128:131], v[92:95]
  ds_read_b128 v[36:39], v249 offset:51456
  v_mul_f32 v67, v12, v67
  v_mfma_f32_16x16x32_bf16 v[100:103], v[44:47], v[160:163], v[100:103]
  v_mul_f32 v68, v12, v68
  v_mul_f32 v69, v12, v69
  v_mfma_f32_16x16x32_bf16 v[108:111], v[44:47], v[192:195], v[108:111]
  v_mul_f32 v70, v12, v70
  v_mfma_f32_16x16x32_bf16 v[116:119], v[44:47], v[224:227], v[116:119]
  s_waitcnt lgkmcnt(5)
  v_mul_f32 v71, v12, v71
  v_mfma_f32_16x16x32_bf16 v[88:91], v[48:51], v[132:135], v[88:91]
  ds_read_b128 v[40:43], v250 offset:49408
  v_cvt_pk_bf16_f32 v64, v64, v65
  v_mfma_f32_16x16x32_bf16 v[96:99], v[48:51], v[164:167], v[96:99]
  v_cvt_pk_bf16_f32 v65, v66, v67
  v_cvt_pk_bf16_f32 v66, v68, v69
  v_mfma_f32_16x16x32_bf16 v[104:107], v[48:51], v[196:199], v[104:107]
  s_add_u32 m0, s29, 101376
  s_add_u32 s27, s28, 1622016
  buffer_load_dwordx4 v15, s[60:63], s27 offen lds
  v_mfma_f32_16x16x32_bf16 v[112:115], v[48:51], v[228:231], v[112:115]
  s_waitcnt lgkmcnt(5)
  v_cvt_pk_bf16_f32 v67, v70, v71
  v_mfma_f32_16x16x32_bf16 v[92:95], v[52:55], v[132:135], v[92:95]
  ds_read_b128 v[44:47], v250 offset:51456
  v_accvgpr_write_b32 a64, v64
  v_mfma_f32_16x16x32_bf16 v[100:103], v[52:55], v[164:167], v[100:103]
  v_accvgpr_write_b32 a65, v65
  v_accvgpr_write_b32 a66, v66
  v_mfma_f32_16x16x32_bf16 v[108:111], v[52:55], v[196:199], v[108:111]
  v_accvgpr_write_b32 a67, v67
  v_mfma_f32_16x16x32_bf16 v[116:119], v[52:55], v[228:231], v[116:119]
  s_waitcnt lgkmcnt(5)
  v_mul_f32 v72, v12, v72
  v_mfma_f32_16x16x32_bf16 v[88:91], v[24:27], v[136:139], v[88:91]
  ds_read_b128 v[48:51], v251 offset:49408
  v_mul_f32 v73, v12, v73
  v_mfma_f32_16x16x32_bf16 v[96:99], v[24:27], v[168:171], v[96:99]
  v_mul_f32 v74, v12, v74
  v_mul_f32 v75, v12, v75
  v_mfma_f32_16x16x32_bf16 v[104:107], v[24:27], v[200:203], v[104:107]
  v_mul_f32 v76, v12, v76
  v_mfma_f32_16x16x32_bf16 v[112:115], v[24:27], v[232:235], v[112:115]
  s_waitcnt lgkmcnt(5)
  v_mul_f32 v77, v12, v77
  v_mfma_f32_16x16x32_bf16 v[92:95], v[28:31], v[136:139], v[92:95]
  ds_read_b128 v[52:55], v251 offset:51456
  v_mul_f32 v78, v12, v78
  v_mfma_f32_16x16x32_bf16 v[100:103], v[28:31], v[168:171], v[100:103]
  v_mul_f32 v79, v12, v79
  v_cvt_pk_bf16_f32 v72, v72, v73
  v_mfma_f32_16x16x32_bf16 v[108:111], v[28:31], v[200:203], v[108:111]
  v_cvt_pk_bf16_f32 v73, v74, v75
  v_mfma_f32_16x16x32_bf16 v[116:119], v[28:31], v[232:235], v[116:119]
  s_waitcnt lgkmcnt(5)
  v_cvt_pk_bf16_f32 v74, v76, v77
  v_mfma_f32_16x16x32_bf16 v[88:91], v[32:35], v[140:143], v[88:91]
  s_waitcnt vmcnt(8)
  s_barrier
  ds_read_b128 v[24:27], v252 offset:0
  v_cvt_pk_bf16_f32 v75, v78, v79
  v_mfma_f32_16x16x32_bf16 v[96:99], v[32:35], v[172:175], v[96:99]
  v_accvgpr_write_b32 a120, v72
  v_accvgpr_write_b32 a121, v73
  v_mfma_f32_16x16x32_bf16 v[104:107], v[32:35], v[204:207], v[104:107]
  v_accvgpr_write_b32 a122, v74
  v_mfma_f32_16x16x32_bf16 v[112:115], v[32:35], v[236:239], v[112:115]
  s_waitcnt lgkmcnt(5)
  v_accvgpr_write_b32 a123, v75
  v_mfma_f32_16x16x32_bf16 v[92:95], v[36:39], v[140:143], v[92:95]
  ds_read_b128 v[28:31], v252 offset:2048
  v_mul_f32 v80, v12, v80
  v_mfma_f32_16x16x32_bf16 v[100:103], v[36:39], v[172:175], v[100:103]
  v_mul_f32 v81, v12, v81
  v_mul_f32 v82, v12, v82
  v_mfma_f32_16x16x32_bf16 v[108:111], v[36:39], v[204:207], v[108:111]
  v_mul_f32 v83, v12, v83
  v_mfma_f32_16x16x32_bf16 v[116:119], v[36:39], v[236:239], v[116:119]
  s_waitcnt lgkmcnt(5)
  v_mul_f32 v84, v12, v84
  v_mfma_f32_16x16x32_bf16 v[88:91], v[40:43], v[144:147], v[88:91]
  ds_read_b128 v[32:35], v253 offset:0
  v_mul_f32 v85, v12, v85
  v_mfma_f32_16x16x32_bf16 v[96:99], v[40:43], v[176:179], v[96:99]
  v_mul_f32 v86, v12, v86
  v_mul_f32 v87, v12, v87
  v_mfma_f32_16x16x32_bf16 v[104:107], v[40:43], v[208:211], v[104:107]
  v_cvt_pk_bf16_f32 v80, v80, v81
  v_mfma_f32_16x16x32_bf16 v[112:115], v[40:43], v[240:243], v[112:115]
  s_waitcnt lgkmcnt(5)
  v_cvt_pk_bf16_f32 v81, v82, v83
  v_mfma_f32_16x16x32_bf16 v[92:95], v[44:47], v[144:147], v[92:95]
  ds_read_b128 v[36:39], v253 offset:2048
  v_cvt_pk_bf16_f32 v82, v84, v85
  v_mfma_f32_16x16x32_bf16 v[100:103], v[44:47], v[176:179], v[100:103]
  v_cvt_pk_bf16_f32 v83, v86, v87
  v_accvgpr_write_b32 a176, v80
  v_mfma_f32_16x16x32_bf16 v[108:111], v[44:47], v[208:211], v[108:111]
  v_accvgpr_write_b32 a177, v81
  v_mfma_f32_16x16x32_bf16 v[116:119], v[44:47], v[240:243], v[116:119]
  s_waitcnt lgkmcnt(5)
  v_accvgpr_write_b32 a178, v82
  v_mfma_f32_16x16x32_bf16 v[88:91], v[48:51], v[148:151], v[88:91]
  ds_read_b128 v[40:43], v254 offset:0
  v_accvgpr_write_b32 a179, v83
  v_mfma_f32_16x16x32_bf16 v[96:99], v[48:51], v[180:183], v[96:99]
  v_mfma_f32_16x16x32_bf16 v[104:107], v[48:51], v[212:215], v[104:107]
  v_mfma_f32_16x16x32_bf16 v[112:115], v[48:51], v[244:247], v[112:115]
  s_waitcnt lgkmcnt(5)
  v_mfma_f32_16x16x32_bf16 v[92:95], v[52:55], v[148:151], v[92:95]
  ds_read_b128 v[44:47], v254 offset:2048
  v_mfma_f32_16x16x32_bf16 v[100:103], v[52:55], v[180:183], v[100:103]
  v_mfma_f32_16x16x32_bf16 v[108:111], v[52:55], v[212:215], v[108:111]
  v_mfma_f32_16x16x32_bf16 v[116:119], v[52:55], v[244:247], v[116:119]
  s_waitcnt lgkmcnt(5)
  v_mfma_f32_16x16x32_bf16 v[56:59], v[24:27], v[120:123], 0
  ds_read_b128 v[48:51], v255 offset:0
  v_mfma_f32_16x16x32_bf16 v[64:67], v[24:27], v[152:155], 0
  v_mfma_f32_16x16x32_bf16 v[72:75], v[24:27], v[184:187], 0
  s_add_u32 m0, s29, 114688
  s_add_u32 s27, s28, 1835008
  buffer_load_dwordx4 v14, s[60:63], s27 offen lds
  v_mfma_f32_16x16x32_bf16 v[80:83], v[24:27], v[216:219], 0
  s_waitcnt lgkmcnt(5)
  v_mul_f32 v88, v12, v88
  v_mfma_f32_16x16x32_bf16 v[60:63], v[28:31], v[120:123], 0
  ds_read_b128 v[52:55], v255 offset:2048
  v_mul_f32 v89, v12, v89
  v_mfma_f32_16x16x32_bf16 v[68:71], v[28:31], v[152:155], 0
  v_mul_f32 v90, v12, v90
  v_mul_f32 v91, v12, v91
  v_mfma_f32_16x16x32_bf16 v[76:79], v[28:31], v[184:187], 0
  v_mul_f32 v92, v12, v92
  v_mfma_f32_16x16x32_bf16 v[84:87], v[28:31], v[216:219], 0
  s_waitcnt lgkmcnt(5)
  v_mul_f32 v93, v12, v93
  v_mfma_f32_16x16x32_bf16 v[56:59], v[32:35], v[124:127], v[56:59]
  ds_read_b128 v[24:27], v252 offset:256
  v_mul_f32 v94, v12, v94
  v_mfma_f32_16x16x32_bf16 v[64:67], v[32:35], v[156:159], v[64:67]
  v_mul_f32 v95, v12, v95
  v_cvt_pk_bf16_f32 v88, v88, v89
  v_mfma_f32_16x16x32_bf16 v[72:75], v[32:35], v[188:191], v[72:75]
  s_add_u32 m0, s29, 115712
  s_add_u32 s27, s28, 1851392
  buffer_load_dwordx4 v15, s[60:63], s27 offen lds
  v_mfma_f32_16x16x32_bf16 v[80:83], v[32:35], v[220:223], v[80:83]
  s_waitcnt lgkmcnt(5)
  v_cvt_pk_bf16_f32 v89, v90, v91
  v_mfma_f32_16x16x32_bf16 v[60:63], v[36:39], v[124:127], v[60:63]
  ds_read_b128 v[28:31], v252 offset:2304
  v_cvt_pk_bf16_f32 v90, v92, v93
  v_mfma_f32_16x16x32_bf16 v[68:71], v[36:39], v[156:159], v[68:71]
  v_cvt_pk_bf16_f32 v91, v94, v95
  v_accvgpr_write_b32 a12, v88
  v_mfma_f32_16x16x32_bf16 v[76:79], v[36:39], v[188:191], v[76:79]
  v_accvgpr_write_b32 a13, v89
  v_mfma_f32_16x16x32_bf16 v[84:87], v[36:39], v[220:223], v[84:87]
  s_waitcnt lgkmcnt(5)
  v_accvgpr_write_b32 a14, v90
  v_mfma_f32_16x16x32_bf16 v[56:59], v[40:43], v[128:131], v[56:59]
  ds_read_b128 v[32:35], v253 offset:256
  v_accvgpr_write_b32 a15, v91
  v_mfma_f32_16x16x32_bf16 v[64:67], v[40:43], v[160:163], v[64:67]
  v_mul_f32 v96, v12, v96
  v_mul_f32 v97, v12, v97
  v_mfma_f32_16x16x32_bf16 v[72:75], v[40:43], v[192:195], v[72:75]
  s_add_u32 m0, s29, 116736
  s_add_u32 s27, s28, 1867776
  buffer_load_dwordx4 v14, s[60:63], s27 offen lds
  v_mfma_f32_16x16x32_bf16 v[80:83], v[40:43], v[224:227], v[80:83]
  s_waitcnt lgkmcnt(5)
  v_mul_f32 v98, v12, v98
  v_mfma_f32_16x16x32_bf16 v[60:63], v[44:47], v[128:131], v[60:63]
  ds_read_b128 v[36:39], v253 offset:2304
  v_mul_f32 v99, v12, v99
  v_mfma_f32_16x16x32_bf16 v[68:71], v[44:47], v[160:163], v[68:71]
  v_mul_f32 v100, v12, v100
  v_mul_f32 v101, v12, v101
  v_mfma_f32_16x16x32_bf16 v[76:79], v[44:47], v[192:195], v[76:79]
  v_mul_f32 v102, v12, v102
  v_mfma_f32_16x16x32_bf16 v[84:87], v[44:47], v[224:227], v[84:87]
  s_waitcnt lgkmcnt(5)
  v_mul_f32 v103, v12, v103
  v_mfma_f32_16x16x32_bf16 v[56:59], v[48:51], v[132:135], v[56:59]
  ds_read_b128 v[40:43], v254 offset:256
  v_cvt_pk_bf16_f32 v96, v96, v97
  v_mfma_f32_16x16x32_bf16 v[64:67], v[48:51], v[164:167], v[64:67]
  v_cvt_pk_bf16_f32 v97, v98, v99
  v_cvt_pk_bf16_f32 v98, v100, v101
  v_mfma_f32_16x16x32_bf16 v[72:75], v[48:51], v[196:199], v[72:75]
  s_add_u32 m0, s29, 117760
  s_add_u32 s27, s28, 1884160
  buffer_load_dwordx4 v15, s[60:63], s27 offen lds
  v_mfma_f32_16x16x32_bf16 v[80:83], v[48:51], v[228:231], v[80:83]
  s_waitcnt lgkmcnt(5)
  v_cvt_pk_bf16_f32 v99, v102, v103
  v_mfma_f32_16x16x32_bf16 v[60:63], v[52:55], v[132:135], v[60:63]
  ds_read_b128 v[44:47], v254 offset:2304
  v_accvgpr_write_b32 a68, v96
  v_mfma_f32_16x16x32_bf16 v[68:71], v[52:55], v[164:167], v[68:71]
  v_accvgpr_write_b32 a69, v97
  v_accvgpr_write_b32 a70, v98
  v_mfma_f32_16x16x32_bf16 v[76:79], v[52:55], v[196:199], v[76:79]
  v_accvgpr_write_b32 a71, v99
  v_mfma_f32_16x16x32_bf16 v[84:87], v[52:55], v[228:231], v[84:87]
  s_waitcnt lgkmcnt(5)
  v_mul_f32 v104, v12, v104
  v_mfma_f32_16x16x32_bf16 v[56:59], v[24:27], v[136:139], v[56:59]
  ds_read_b128 v[48:51], v255 offset:256
  v_mul_f32 v105, v12, v105
  v_mfma_f32_16x16x32_bf16 v[64:67], v[24:27], v[168:171], v[64:67]
  v_mul_f32 v106, v12, v106
  v_mul_f32 v107, v12, v107
  v_mfma_f32_16x16x32_bf16 v[72:75], v[24:27], v[200:203], v[72:75]
  v_mul_f32 v108, v12, v108
  v_mfma_f32_16x16x32_bf16 v[80:83], v[24:27], v[232:235], v[80:83]
  s_waitcnt lgkmcnt(5)
  v_mul_f32 v109, v12, v109
  v_mfma_f32_16x16x32_bf16 v[60:63], v[28:31], v[136:139], v[60:63]
  ds_read_b128 v[52:55], v255 offset:2304
  v_mul_f32 v110, v12, v110
  v_mfma_f32_16x16x32_bf16 v[68:71], v[28:31], v[168:171], v[68:71]
  v_mul_f32 v111, v12, v111
  v_cvt_pk_bf16_f32 v104, v104, v105
  v_mfma_f32_16x16x32_bf16 v[76:79], v[28:31], v[200:203], v[76:79]
  v_cvt_pk_bf16_f32 v105, v106, v107
  v_mfma_f32_16x16x32_bf16 v[84:87], v[28:31], v[232:235], v[84:87]
  s_waitcnt lgkmcnt(5)
  v_cvt_pk_bf16_f32 v106, v108, v109
  v_mfma_f32_16x16x32_bf16 v[56:59], v[32:35], v[140:143], v[56:59]
  s_waitcnt vmcnt(8)
  s_barrier
  ds_read_b128 v[24:27], v252 offset:16384
  v_cvt_pk_bf16_f32 v107, v110, v111
  v_mfma_f32_16x16x32_bf16 v[64:67], v[32:35], v[172:175], v[64:67]
  v_accvgpr_write_b32 a124, v104
  v_accvgpr_write_b32 a125, v105
  v_mfma_f32_16x16x32_bf16 v[72:75], v[32:35], v[204:207], v[72:75]
  v_accvgpr_write_b32 a126, v106
  v_mfma_f32_16x16x32_bf16 v[80:83], v[32:35], v[236:239], v[80:83]
  s_waitcnt lgkmcnt(5)
  v_accvgpr_write_b32 a127, v107
  v_mfma_f32_16x16x32_bf16 v[60:63], v[36:39], v[140:143], v[60:63]
  ds_read_b128 v[28:31], v252 offset:18432
  v_mul_f32 v112, v12, v112
  v_mfma_f32_16x16x32_bf16 v[68:71], v[36:39], v[172:175], v[68:71]
  v_mul_f32 v113, v12, v113
  v_mul_f32 v114, v12, v114
  v_mfma_f32_16x16x32_bf16 v[76:79], v[36:39], v[204:207], v[76:79]
  v_mul_f32 v115, v12, v115
  v_mfma_f32_16x16x32_bf16 v[84:87], v[36:39], v[236:239], v[84:87]
  s_waitcnt lgkmcnt(5)
  v_mul_f32 v116, v12, v116
  v_mfma_f32_16x16x32_bf16 v[56:59], v[40:43], v[144:147], v[56:59]
  ds_read_b128 v[32:35], v253 offset:16384
  v_mul_f32 v117, v12, v117
  v_mfma_f32_16x16x32_bf16 v[64:67], v[40:43], v[176:179], v[64:67]
  v_mul_f32 v118, v12, v118
  v_mul_f32 v119, v12, v119
  v_mfma_f32_16x16x32_bf16 v[72:75], v[40:43], v[208:211], v[72:75]
  v_cvt_pk_bf16_f32 v112, v112, v113
  v_mfma_f32_16x16x32_bf16 v[80:83], v[40:43], v[240:243], v[80:83]
  s_waitcnt lgkmcnt(5)
  v_cvt_pk_bf16_f32 v113, v114, v115
  v_mfma_f32_16x16x32_bf16 v[60:63], v[44:47], v[144:147], v[60:63]
  ds_read_b128 v[36:39], v253 offset:18432
  v_cvt_pk_bf16_f32 v114, v116, v117
  v_mfma_f32_16x16x32_bf16 v[68:71], v[44:47], v[176:179], v[68:71]
  v_cvt_pk_bf16_f32 v115, v118, v119
  v_accvgpr_write_b32 a180, v112
  v_mfma_f32_16x16x32_bf16 v[76:79], v[44:47], v[208:211], v[76:79]
  v_accvgpr_write_b32 a181, v113
  v_mfma_f32_16x16x32_bf16 v[84:87], v[44:47], v[240:243], v[84:87]
  s_waitcnt lgkmcnt(5)
  v_accvgpr_write_b32 a182, v114
  v_mfma_f32_16x16x32_bf16 v[56:59], v[48:51], v[148:151], v[56:59]
  ds_read_b128 v[40:43], v254 offset:16384
  v_accvgpr_write_b32 a183, v115
  v_mfma_f32_16x16x32_bf16 v[64:67], v[48:51], v[180:183], v[64:67]
  v_mfma_f32_16x16x32_bf16 v[72:75], v[48:51], v[212:215], v[72:75]
  v_mfma_f32_16x16x32_bf16 v[80:83], v[48:51], v[244:247], v[80:83]
  s_waitcnt lgkmcnt(5)
  v_mfma_f32_16x16x32_bf16 v[60:63], v[52:55], v[148:151], v[60:63]
  ds_read_b128 v[44:47], v254 offset:18432
  v_mfma_f32_16x16x32_bf16 v[68:71], v[52:55], v[180:183], v[68:71]
  v_mfma_f32_16x16x32_bf16 v[76:79], v[52:55], v[212:215], v[76:79]
  v_mfma_f32_16x16x32_bf16 v[84:87], v[52:55], v[244:247], v[84:87]
  s_waitcnt lgkmcnt(5)
  v_mfma_f32_16x16x32_bf16 v[88:91], v[24:27], v[120:123], 0
  ds_read_b128 v[48:51], v255 offset:16384
  v_mfma_f32_16x16x32_bf16 v[96:99], v[24:27], v[152:155], 0
  v_mfma_f32_16x16x32_bf16 v[104:107], v[24:27], v[184:187], 0
  s_add_u32 m0, s29, 131072
  s_add_u32 s27, s28, 2097152
  buffer_load_dwordx4 v14, s[60:63], s27 offen lds
  v_mfma_f32_16x16x32_bf16 v[112:115], v[24:27], v[216:219], 0
  s_waitcnt lgkmcnt(5)
  v_mul_f32 v56, v12, v56
  v_mfma_f32_16x16x32_bf16 v[92:95], v[28:31], v[120:123], 0
  ds_read_b128 v[52:55], v255 offset:18432
  v_mul_f32 v57, v12, v57
  v_mfma_f32_16x16x32_bf16 v[100:103], v[28:31], v[152:155], 0
  v_mul_f32 v58, v12, v58
  v_mul_f32 v59, v12, v59
  v_mfma_f32_16x16x32_bf16 v[108:111], v[28:31], v[184:187], 0
  v_mul_f32 v60, v12, v60
  v_mfma_f32_16x16x32_bf16 v[116:119], v[28:31], v[216:219], 0
  s_waitcnt lgkmcnt(5)
  v_mul_f32 v61, v12, v61
  v_mfma_f32_16x16x32_bf16 v[88:91], v[32:35], v[124:127], v[88:91]
  ds_read_b128 v[24:27], v252 offset:16640
  v_mul_f32 v62, v12, v62
  v_mfma_f32_16x16x32_bf16 v[96:99], v[32:35], v[156:159], v[96:99]
  v_mul_f32 v63, v12, v63
  v_cvt_pk_bf16_f32 v56, v56, v57
  v_mfma_f32_16x16x32_bf16 v[104:107], v[32:35], v[188:191], v[104:107]
  s_add_u32 m0, s29, 132096
  s_add_u32 s27, s28, 2113536
  buffer_load_dwordx4 v15, s[60:63], s27 offen lds
  v_mfma_f32_16x16x32_bf16 v[112:115], v[32:35], v[220:223], v[112:115]
  s_waitcnt lgkmcnt(5)
  v_cvt_pk_bf16_f32 v57, v58, v59
  v_mfma_f32_16x16x32_bf16 v[92:95], v[36:39], v[124:127], v[92:95]
  ds_read_b128 v[28:31], v252 offset:18688
  v_cvt_pk_bf16_f32 v58, v60, v61
  v_mfma_f32_16x16x32_bf16 v[100:103], v[36:39], v[156:159], v[100:103]
  v_cvt_pk_bf16_f32 v59, v62, v63
  v_accvgpr_write_b32 a16, v56
  v_mfma_f32_16x16x32_bf16 v[108:111], v[36:39], v[188:191], v[108:111]
  v_accvgpr_write_b32 a17, v57
  v_mfma_f32_16x16x32_bf16 v[116:119], v[36:39], v[220:223], v[116:119]
  s_waitcnt lgkmcnt(5)
  v_accvgpr_write_b32 a18, v58
  v_mfma_f32_16x16x32_bf16 v[88:91], v[40:43], v[128:131], v[88:91]
  ds_read_b128 v[32:35], v253 offset:16640
  v_accvgpr_write_b32 a19, v59
  v_mfma_f32_16x16x32_bf16 v[96:99], v[40:43], v[160:163], v[96:99]
  v_mul_f32 v64, v12, v64
  v_mul_f32 v65, v12, v65
  v_mfma_f32_16x16x32_bf16 v[104:107], v[40:43], v[192:195], v[104:107]
  s_add_u32 m0, s29, 133120
  s_add_u32 s27, s28, 2129920
  buffer_load_dwordx4 v14, s[60:63], s27 offen lds
  v_mfma_f32_16x16x32_bf16 v[112:115], v[40:43], v[224:227], v[112:115]
  s_waitcnt lgkmcnt(5)
  v_mul_f32 v66, v12, v66
  v_mfma_f32_16x16x32_bf16 v[92:95], v[44:47], v[128:131], v[92:95]
  ds_read_b128 v[36:39], v253 offset:18688
  v_mul_f32 v67, v12, v67
  v_mfma_f32_16x16x32_bf16 v[100:103], v[44:47], v[160:163], v[100:103]
  v_mul_f32 v68, v12, v68
  v_mul_f32 v69, v12, v69
  v_mfma_f32_16x16x32_bf16 v[108:111], v[44:47], v[192:195], v[108:111]
  v_mul_f32 v70, v12, v70
  v_mfma_f32_16x16x32_bf16 v[116:119], v[44:47], v[224:227], v[116:119]
  s_waitcnt lgkmcnt(5)
  v_mul_f32 v71, v12, v71
  v_mfma_f32_16x16x32_bf16 v[88:91], v[48:51], v[132:135], v[88:91]
  ds_read_b128 v[40:43], v254 offset:16640
  v_cvt_pk_bf16_f32 v64, v64, v65
  v_mfma_f32_16x16x32_bf16 v[96:99], v[48:51], v[164:167], v[96:99]
  v_cvt_pk_bf16_f32 v65, v66, v67
  v_cvt_pk_bf16_f32 v66, v68, v69
  v_mfma_f32_16x16x32_bf16 v[104:107], v[48:51], v[196:199], v[104:107]
  s_add_u32 m0, s29, 134144
  s_add_u32 s27, s28, 2146304
  buffer_load_dwordx4 v15, s[60:63], s27 offen lds
  v_mfma_f32_16x16x32_bf16 v[112:115], v[48:51], v[228:231], v[112:115]
  s_waitcnt lgkmcnt(5)
  v_cvt_pk_bf16_f32 v67, v70, v71
  v_mfma_f32_16x16x32_bf16 v[92:95], v[52:55], v[132:135], v[92:95]
  ds_read_b128 v[44:47], v254 offset:18688
  v_accvgpr_write_b32 a72, v64
  v_mfma_f32_16x16x32_bf16 v[100:103], v[52:55], v[164:167], v[100:103]
  v_accvgpr_write_b32 a73, v65
  v_accvgpr_write_b32 a74, v66
  v_mfma_f32_16x16x32_bf16 v[108:111], v[52:55], v[196:199], v[108:111]
  v_accvgpr_write_b32 a75, v67
  v_mfma_f32_16x16x32_bf16 v[116:119], v[52:55], v[228:231], v[116:119]
  s_waitcnt lgkmcnt(5)
  v_mul_f32 v72, v12, v72
  v_mfma_f32_16x16x32_bf16 v[88:91], v[24:27], v[136:139], v[88:91]
  ds_read_b128 v[48:51], v255 offset:16640
  v_mul_f32 v73, v12, v73
  v_mfma_f32_16x16x32_bf16 v[96:99], v[24:27], v[168:171], v[96:99]
  v_mul_f32 v74, v12, v74
  v_mul_f32 v75, v12, v75
  v_mfma_f32_16x16x32_bf16 v[104:107], v[24:27], v[200:203], v[104:107]
  v_mul_f32 v76, v12, v76
  v_mfma_f32_16x16x32_bf16 v[112:115], v[24:27], v[232:235], v[112:115]
  s_waitcnt lgkmcnt(5)
  v_mul_f32 v77, v12, v77
  v_mfma_f32_16x16x32_bf16 v[92:95], v[28:31], v[136:139], v[92:95]
  ds_read_b128 v[52:55], v255 offset:18688
  v_mul_f32 v78, v12, v78
  v_mfma_f32_16x16x32_bf16 v[100:103], v[28:31], v[168:171], v[100:103]
  v_mul_f32 v79, v12, v79
  v_cvt_pk_bf16_f32 v72, v72, v73
  v_mfma_f32_16x16x32_bf16 v[108:111], v[28:31], v[200:203], v[108:111]
  v_cvt_pk_bf16_f32 v73, v74, v75
  v_mfma_f32_16x16x32_bf16 v[116:119], v[28:31], v[232:235], v[116:119]
  s_waitcnt lgkmcnt(5)
  v_cvt_pk_bf16_f32 v74, v76, v77
  v_mfma_f32_16x16x32_bf16 v[88:91], v[32:35], v[140:143], v[88:91]
  s_waitcnt vmcnt(8)
  s_barrier
  ds_read_b128 v[24:27], v252 offset:32768
  v_cvt_pk_bf16_f32 v75, v78, v79
  v_mfma_f32_16x16x32_bf16 v[96:99], v[32:35], v[172:175], v[96:99]
  v_accvgpr_write_b32 a128, v72
  v_accvgpr_write_b32 a129, v73
  v_mfma_f32_16x16x32_bf16 v[104:107], v[32:35], v[204:207], v[104:107]
  v_accvgpr_write_b32 a130, v74
  v_mfma_f32_16x16x32_bf16 v[112:115], v[32:35], v[236:239], v[112:115]
  s_waitcnt lgkmcnt(5)
  v_accvgpr_write_b32 a131, v75
  v_mfma_f32_16x16x32_bf16 v[92:95], v[36:39], v[140:143], v[92:95]
  ds_read_b128 v[28:31], v252 offset:34816
  v_mul_f32 v80, v12, v80
  v_mfma_f32_16x16x32_bf16 v[100:103], v[36:39], v[172:175], v[100:103]
  v_mul_f32 v81, v12, v81
  v_mul_f32 v82, v12, v82
  v_mfma_f32_16x16x32_bf16 v[108:111], v[36:39], v[204:207], v[108:111]
  v_mul_f32 v83, v12, v83
  v_mfma_f32_16x16x32_bf16 v[116:119], v[36:39], v[236:239], v[116:119]
  s_waitcnt lgkmcnt(5)
  v_mul_f32 v84, v12, v84
  v_mfma_f32_16x16x32_bf16 v[88:91], v[40:43], v[144:147], v[88:91]
  ds_read_b128 v[32:35], v253 offset:32768
  v_mul_f32 v85, v12, v85
  v_mfma_f32_16x16x32_bf16 v[96:99], v[40:43], v[176:179], v[96:99]
  v_mul_f32 v86, v12, v86
  v_mul_f32 v87, v12, v87
  v_mfma_f32_16x16x32_bf16 v[104:107], v[40:43], v[208:211], v[104:107]
  v_cvt_pk_bf16_f32 v80, v80, v81
  v_mfma_f32_16x16x32_bf16 v[112:115], v[40:43], v[240:243], v[112:115]
  s_waitcnt lgkmcnt(5)
  v_cvt_pk_bf16_f32 v81, v82, v83
  v_mfma_f32_16x16x32_bf16 v[92:95], v[44:47], v[144:147], v[92:95]
  ds_read_b128 v[36:39], v253 offset:34816
  v_cvt_pk_bf16_f32 v82, v84, v85
  v_mfma_f32_16x16x32_bf16 v[100:103], v[44:47], v[176:179], v[100:103]
  v_cvt_pk_bf16_f32 v83, v86, v87
  v_accvgpr_write_b32 a184, v80
  v_mfma_f32_16x16x32_bf16 v[108:111], v[44:47], v[208:211], v[108:111]
  v_accvgpr_write_b32 a185, v81
  v_mfma_f32_16x16x32_bf16 v[116:119], v[44:47], v[240:243], v[116:119]
  s_waitcnt lgkmcnt(5)
  v_accvgpr_write_b32 a186, v82
  v_mfma_f32_16x16x32_bf16 v[88:91], v[48:51], v[148:151], v[88:91]
  ds_read_b128 v[40:43], v254 offset:32768
  v_accvgpr_write_b32 a187, v83
  v_mfma_f32_16x16x32_bf16 v[96:99], v[48:51], v[180:183], v[96:99]
  v_mfma_f32_16x16x32_bf16 v[104:107], v[48:51], v[212:215], v[104:107]
  v_mfma_f32_16x16x32_bf16 v[112:115], v[48:51], v[244:247], v[112:115]
  s_waitcnt lgkmcnt(5)
  v_mfma_f32_16x16x32_bf16 v[92:95], v[52:55], v[148:151], v[92:95]
  ds_read_b128 v[44:47], v254 offset:34816
  v_mfma_f32_16x16x32_bf16 v[100:103], v[52:55], v[180:183], v[100:103]
  v_mfma_f32_16x16x32_bf16 v[108:111], v[52:55], v[212:215], v[108:111]
  v_mfma_f32_16x16x32_bf16 v[116:119], v[52:55], v[244:247], v[116:119]
  s_waitcnt lgkmcnt(5)
  s_getpc_b64 s[98:99]
  s_add_u32 s98, s98, 4096
  s_addc_u32 s99, s99, 0
  global_load_dword v7, v6, s[98:99]
  v_mfma_f32_16x16x32_bf16 v[56:59], v[24:27], v[120:123], 0
  ds_read_b128 v[48:51], v255 offset:32768
  v_mfma_f32_16x16x32_bf16 v[64:67], v[24:27], v[152:155], 0
  v_mfma_f32_16x16x32_bf16 v[72:75], v[24:27], v[184:187], 0
  s_add_u32 m0, s29, 147456
  s_add_u32 s27, s28, 2359296
  buffer_load_dwordx4 v14, s[60:63], s27 offen lds
  v_mfma_f32_16x16x32_bf16 v[80:83], v[24:27], v[216:219], 0
  s_waitcnt lgkmcnt(5)
  v_mul_f32 v88, v12, v88
  v_mfma_f32_16x16x32_bf16 v[60:63], v[28:31], v[120:123], 0
  ds_read_b128 v[52:55], v255 offset:34816
  v_mul_f32 v89, v12, v89
  v_mfma_f32_16x16x32_bf16 v[68:71], v[28:31], v[152:155], 0
  v_mul_f32 v90, v12, v90
  v_mul_f32 v91, v12, v91
  v_mfma_f32_16x16x32_bf16 v[76:79], v[28:31], v[184:187], 0
  v_mul_f32 v92, v12, v92
  v_mfma_f32_16x16x32_bf16 v[84:87], v[28:31], v[216:219], 0
  s_waitcnt lgkmcnt(5)
  v_mul_f32 v93, v12, v93
  v_mfma_f32_16x16x32_bf16 v[56:59], v[32:35], v[124:127], v[56:59]
  ds_read_b128 v[24:27], v252 offset:33024
  v_mul_f32 v94, v12, v94
  v_mfma_f32_16x16x32_bf16 v[64:67], v[32:35], v[156:159], v[64:67]
  v_mul_f32 v95, v12, v95
  v_cvt_pk_bf16_f32 v88, v88, v89
  v_mfma_f32_16x16x32_bf16 v[72:75], v[32:35], v[188:191], v[72:75]
  s_add_u32 m0, s29, 148480
  s_add_u32 s27, s28, 2375680
  buffer_load_dwordx4 v15, s[60:63], s27 offen lds
  v_mfma_f32_16x16x32_bf16 v[80:83], v[32:35], v[220:223], v[80:83]
  s_waitcnt lgkmcnt(5)
  v_cvt_pk_bf16_f32 v89, v90, v91
  v_mfma_f32_16x16x32_bf16 v[60:63], v[36:39], v[124:127], v[60:63]
  ds_read_b128 v[28:31], v252 offset:35072
  v_cvt_pk_bf16_f32 v90, v92, v93
  v_mfma_f32_16x16x32_bf16 v[68:71], v[36:39], v[156:159], v[68:71]
  v_cvt_pk_bf16_f32 v91, v94, v95
  v_accvgpr_write_b32 a20, v88
  v_mfma_f32_16x16x32_bf16 v[76:79], v[36:39], v[188:191], v[76:79]
  v_accvgpr_write_b32 a21, v89
  v_mfma_f32_16x16x32_bf16 v[84:87], v[36:39], v[220:223], v[84:87]
  s_waitcnt lgkmcnt(5)
  v_accvgpr_write_b32 a22, v90
  v_mfma_f32_16x16x32_bf16 v[56:59], v[40:43], v[128:131], v[56:59]
  ds_read_b128 v[32:35], v253 offset:33024
  v_accvgpr_write_b32 a23, v91
  v_mfma_f32_16x16x32_bf16 v[64:67], v[40:43], v[160:163], v[64:67]
  v_mul_f32 v96, v12, v96
  v_mul_f32 v97, v12, v97
  v_mfma_f32_16x16x32_bf16 v[72:75], v[40:43], v[192:195], v[72:75]
  s_add_u32 m0, s29, 149504
  s_add_u32 s27, s28, 2392064
  buffer_load_dwordx4 v14, s[60:63], s27 offen lds
  v_mfma_f32_16x16x32_bf16 v[80:83], v[40:43], v[224:227], v[80:83]
  s_waitcnt lgkmcnt(5)
  v_mul_f32 v98, v12, v98
  v_mfma_f32_16x16x32_bf16 v[60:63], v[44:47], v[128:131], v[60:63]
  ds_read_b128 v[36:39], v253 offset:35072
  v_mul_f32 v99, v12, v99
  v_mfma_f32_16x16x32_bf16 v[68:71], v[44:47], v[160:163], v[68:71]
  v_mul_f32 v100, v12, v100
  v_mul_f32 v101, v12, v101
  v_mfma_f32_16x16x32_bf16 v[76:79], v[44:47], v[192:195], v[76:79]
  v_mul_f32 v102, v12, v102
  v_mfma_f32_16x16x32_bf16 v[84:87], v[44:47], v[224:227], v[84:87]
  s_waitcnt lgkmcnt(5)
  v_mul_f32 v103, v12, v103
  v_mfma_f32_16x16x32_bf16 v[56:59], v[48:51], v[132:135], v[56:59]
  ds_read_b128 v[40:43], v254 offset:33024
  v_cvt_pk_bf16_f32 v96, v96, v97
  v_mfma_f32_16x16x32_bf16 v[64:67], v[48:51], v[164:167], v[64:67]
  v_cvt_pk_bf16_f32 v97, v98, v99
  v_cvt_pk_bf16_f32 v98, v100, v101
  v_mfma_f32_16x16x32_bf16 v[72:75], v[48:51], v[196:199], v[72:75]
  s_add_u32 m0, s29, 150528
  s_add_u32 s27, s28, 2408448
  buffer_load_dwordx4 v15, s[60:63], s27 offen lds
  v_mfma_f32_16x16x32_bf16 v[80:83], v[48:51], v[228:231], v[80:83]
  s_waitcnt lgkmcnt(5)
  v_cvt_pk_bf16_f32 v99, v102, v103
  v_mfma_f32_16x16x32_bf16 v[60:63], v[52:55], v[132:135], v[60:63]
  ds_read_b128 v[44:47], v254 offset:35072
  v_accvgpr_write_b32 a76, v96
  v_mfma_f32_16x16x32_bf16 v[68:71], v[52:55], v[164:167], v[68:71]
  v_accvgpr_write_b32 a77, v97
  v_accvgpr_write_b32 a78, v98
  v_mfma_f32_16x16x32_bf16 v[76:79], v[52:55], v[196:199], v[76:79]
  v_accvgpr_write_b32 a79, v99
  v_mfma_f32_16x16x32_bf16 v[84:87], v[52:55], v[228:231], v[84:87]
  s_waitcnt lgkmcnt(5)
  v_mul_f32 v104, v12, v104
  v_mfma_f32_16x16x32_bf16 v[56:59], v[24:27], v[136:139], v[56:59]
  ds_read_b128 v[48:51], v255 offset:33024
  v_mul_f32 v105, v12, v105
  v_mfma_f32_16x16x32_bf16 v[64:67], v[24:27], v[168:171], v[64:67]
  v_mul_f32 v106, v12, v106
  v_mul_f32 v107, v12, v107
  v_mfma_f32_16x16x32_bf16 v[72:75], v[24:27], v[200:203], v[72:75]
  v_mul_f32 v108, v12, v108
  v_mfma_f32_16x16x32_bf16 v[80:83], v[24:27], v[232:235], v[80:83]
  s_waitcnt lgkmcnt(5)
  v_mul_f32 v109, v12, v109
  v_mfma_f32_16x16x32_bf16 v[60:63], v[28:31], v[136:139], v[60:63]
  ds_read_b128 v[52:55], v255 offset:35072
  v_mul_f32 v110, v12, v110
  v_mfma_f32_16x16x32_bf16 v[68:71], v[28:31], v[168:171], v[68:71]
  v_mul_f32 v111, v12, v111
  v_cvt_pk_bf16_f32 v104, v104, v105
  v_mfma_f32_16x16x32_bf16 v[76:79], v[28:31], v[200:203], v[76:79]
  v_cvt_pk_bf16_f32 v105, v106, v107
  v_mfma_f32_16x16x32_bf16 v[84:87], v[28:31], v[232:235], v[84:87]
  s_waitcnt lgkmcnt(5)
  v_cvt_pk_bf16_f32 v106, v108, v109
  v_mfma_f32_16x16x32_bf16 v[56:59], v[32:35], v[140:143], v[56:59]
  s_waitcnt vmcnt(8)
  s_barrier
  ds_read_b128 v[24:27], v252 offset:49152
  v_cvt_pk_bf16_f32 v107, v110, v111
  v_mfma_f32_16x16x32_bf16 v[64:67], v[32:35], v[172:175], v[64:67]
  v_accvgpr_write_b32 a132, v104
  v_accvgpr_write_b32 a133, v105
  v_mfma_f32_16x16x32_bf16 v[72:75], v[32:35], v[204:207], v[72:75]
  v_accvgpr_write_b32 a134, v106
  v_mfma_f32_16x16x32_bf16 v[80:83], v[32:35], v[236:239], v[80:83]
  s_waitcnt lgkmcnt(5)
  v_accvgpr_write_b32 a135, v107
  v_mfma_f32_16x16x32_bf16 v[60:63], v[36:39], v[140:143], v[60:63]
  ds_read_b128 v[28:31], v252 offset:51200
  v_mul_f32 v112, v12, v112
  v_mfma_f32_16x16x32_bf16 v[68:71], v[36:39], v[172:175], v[68:71]
  v_mul_f32 v113, v12, v113
  v_mul_f32 v114, v12, v114
  v_mfma_f32_16x16x32_bf16 v[76:79], v[36:39], v[204:207], v[76:79]
  v_mul_f32 v115, v12, v115
  v_mfma_f32_16x16x32_bf16 v[84:87], v[36:39], v[236:239], v[84:87]
  s_waitcnt lgkmcnt(5)
  v_mul_f32 v116, v12, v116
  v_mfma_f32_16x16x32_bf16 v[56:59], v[40:43], v[144:147], v[56:59]
  ds_read_b128 v[32:35], v253 offset:49152
  v_mul_f32 v117, v12, v117
  v_mfma_f32_16x16x32_bf16 v[64:67], v[40:43], v[176:179], v[64:67]
  v_mul_f32 v118, v12, v118
  v_mul_f32 v119, v12, v119
  v_mfma_f32_16x16x32_bf16 v[72:75], v[40:43], v[208:211], v[72:75]
  v_cvt_pk_bf16_f32 v112, v112, v113
  v_mfma_f32_16x16x32_bf16 v[80:83], v[40:43], v[240:243], v[80:83]
  s_waitcnt lgkmcnt(5)
  v_cvt_pk_bf16_f32 v113, v114, v115
  v_mfma_f32_16x16x32_bf16 v[60:63], v[44:47], v[144:147], v[60:63]
  ds_read_b128 v[36:39], v253 offset:51200
  v_cvt_pk_bf16_f32 v114, v116, v117
  v_mfma_f32_16x16x32_bf16 v[68:71], v[44:47], v[176:179], v[68:71]
  v_cvt_pk_bf16_f32 v115, v118, v119
  v_accvgpr_write_b32 a188, v112
  v_mfma_f32_16x16x32_bf16 v[76:79], v[44:47], v[208:211], v[76:79]
  v_accvgpr_write_b32 a189, v113
  v_mfma_f32_16x16x32_bf16 v[84:87], v[44:47], v[240:243], v[84:87]
  s_waitcnt lgkmcnt(5)
  v_accvgpr_write_b32 a190, v114
  v_mfma_f32_16x16x32_bf16 v[56:59], v[48:51], v[148:151], v[56:59]
  ds_read_b128 v[40:43], v254 offset:49152
  v_accvgpr_write_b32 a191, v115
  v_mfma_f32_16x16x32_bf16 v[64:67], v[48:51], v[180:183], v[64:67]
  v_mfma_f32_16x16x32_bf16 v[72:75], v[48:51], v[212:215], v[72:75]
  v_mfma_f32_16x16x32_bf16 v[80:83], v[48:51], v[244:247], v[80:83]
  s_waitcnt lgkmcnt(5)
  v_mfma_f32_16x16x32_bf16 v[60:63], v[52:55], v[148:151], v[60:63]
  ds_read_b128 v[44:47], v254 offset:51200
  v_mfma_f32_16x16x32_bf16 v[68:71], v[52:55], v[180:183], v[68:71]
  v_mfma_f32_16x16x32_bf16 v[76:79], v[52:55], v[212:215], v[76:79]
  v_mfma_f32_16x16x32_bf16 v[84:87], v[52:55], v[244:247], v[84:87]
  s_waitcnt lgkmcnt(5)
  v_mfma_f32_16x16x32_bf16 v[88:91], v[24:27], v[120:123], 0
  ds_read_b128 v[48:51], v255 offset:49152
  v_mfma_f32_16x16x32_bf16 v[96:99], v[24:27], v[152:155], 0
  v_mfma_f32_16x16x32_bf16 v[104:107], v[24:27], v[184:187], 0
  s_add_u32 m0, s29, 0
  s_add_u32 s27, s28, 2621440
  buffer_load_dwordx4 v14, s[60:63], s27 offen lds
  v_mfma_f32_16x16x32_bf16 v[112:115], v[24:27], v[216:219], 0
  s_waitcnt lgkmcnt(5)
  v_mul_f32 v56, v12, v56
  v_mfma_f32_16x16x32_bf16 v[92:95], v[28:31], v[120:123], 0
  ds_read_b128 v[52:55], v255 offset:51200
  v_mul_f32 v57, v12, v57
  v_mfma_f32_16x16x32_bf16 v[100:103], v[28:31], v[152:155], 0
  v_mul_f32 v58, v12, v58
  v_mul_f32 v59, v12, v59
  v_mfma_f32_16x16x32_bf16 v[108:111], v[28:31], v[184:187], 0
  v_mul_f32 v60, v12, v60
  v_mfma_f32_16x16x32_bf16 v[116:119], v[28:31], v[216:219], 0
  s_waitcnt lgkmcnt(5)
  v_mul_f32 v61, v12, v61
  v_mfma_f32_16x16x32_bf16 v[88:91], v[32:35], v[124:127], v[88:91]
  ds_read_b128 v[24:27], v252 offset:49408
  v_mul_f32 v62, v12, v62
  v_mfma_f32_16x16x32_bf16 v[96:99], v[32:35], v[156:159], v[96:99]
  v_mul_f32 v63, v12, v63
  v_cvt_pk_bf16_f32 v56, v56, v57
  v_mfma_f32_16x16x32_bf16 v[104:107], v[32:35], v[188:191], v[104:107]
  s_add_u32 m0, s29, 1024
  s_add_u32 s27, s28, 2637824
  buffer_load_dwordx4 v15, s[60:63], s27 offen lds
  v_mfma_f32_16x16x32_bf16 v[112:115], v[32:35], v[220:223], v[112:115]
  s_waitcnt lgkmcnt(5)
  v_cvt_pk_bf16_f32 v57, v58, v59
  v_mfma_f32_16x16x32_bf16 v[92:95], v[36:39], v[124:127], v[92:95]
  ds_read_b128 v[28:31], v252 offset:51456
  v_cvt_pk_bf16_f32 v58, v60, v61
  v_mfma_f32_16x16x32_bf16 v[100:103], v[36:39], v[156:159], v[100:103]
  v_cvt_pk_bf16_f32 v59, v62, v63
  v_accvgpr_write_b32 a24, v56
  v_mfma_f32_16x16x32_bf16 v[108:111], v[36:39], v[188:191], v[108:111]
  v_accvgpr_write_b32 a25, v57
  v_mfma_f32_16x16x32_bf16 v[116:119], v[36:39], v[220:223], v[116:119]
  s_waitcnt lgkmcnt(5)
  v_accvgpr_write_b32 a26, v58
  v_mfma_f32_16x16x32_bf16 v[88:91], v[40:43], v[128:131], v[88:91]
  ds_read_b128 v[32:35], v253 offset:49408
  v_accvgpr_write_b32 a27, v59
  v_mfma_f32_16x16x32_bf16 v[96:99], v[40:43], v[160:163], v[96:99]
  v_mul_f32 v64, v12, v64
  v_mul_f32 v65, v12, v65
  v_mfma_f32_16x16x32_bf16 v[104:107], v[40:43], v[192:195], v[104:107]
  s_add_u32 m0, s29, 2048
  s_add_u32 s27, s28, 2654208
  buffer_load_dwordx4 v14, s[60:63], s27 offen lds
  v_mfma_f32_16x16x32_bf16 v[112:115], v[40:43], v[224:227], v[112:115]
  s_waitcnt lgkmcnt(5)
  v_mul_f32 v66, v12, v66
  v_mfma_f32_16x16x32_bf16 v[92:95], v[44:47], v[128:131], v[92:95]
  ds_read_b128 v[36:39], v253 offset:51456
  v_mul_f32 v67, v12, v67
  v_mfma_f32_16x16x32_bf16 v[100:103], v[44:47], v[160:163], v[100:103]
  v_mul_f32 v68, v12, v68
  v_mul_f32 v69, v12, v69
  v_mfma_f32_16x16x32_bf16 v[108:111], v[44:47], v[192:195], v[108:111]
  v_mul_f32 v70, v12, v70
  v_mfma_f32_16x16x32_bf16 v[116:119], v[44:47], v[224:227], v[116:119]
  s_waitcnt lgkmcnt(5)
  v_mul_f32 v71, v12, v71
  v_mfma_f32_16x16x32_bf16 v[88:91], v[48:51], v[132:135], v[88:91]
  ds_read_b128 v[40:43], v254 offset:49408
  v_cvt_pk_bf16_f32 v64, v64, v65
  v_mfma_f32_16x16x32_bf16 v[96:99], v[48:51], v[164:167], v[96:99]
  v_cvt_pk_bf16_f32 v65, v66, v67
  v_cvt_pk_bf16_f32 v66, v68, v69
  v_mfma_f32_16x16x32_bf16 v[104:107], v[48:51], v[196:199], v[104:107]
  s_add_u32 m0, s29, 3072
  s_add_u32 s27, s28, 2670592
  buffer_load_dwordx4 v15, s[60:63], s27 offen lds
  v_mfma_f32_16x16x32_bf16 v[112:115], v[48:51], v[228:231], v[112:115]
  s_waitcnt lgkmcnt(5)
  v_cvt_pk_bf16_f32 v67, v70, v71
  v_mfma_f32_16x16x32_bf16 v[92:95], v[52:55], v[132:135], v[92:95]
  ds_read_b128 v[44:47], v254 offset:51456
  v_accvgpr_write_b32 a80, v64
  v_mfma_f32_16x16x32_bf16 v[100:103], v[52:55], v[164:167], v[100:103]
  v_accvgpr_write_b32 a81, v65
  v_accvgpr_write_b32 a82, v66
  v_mfma_f32_16x16x32_bf16 v[108:111], v[52:55], v[196:199], v[108:111]
  v_accvgpr_write_b32 a83, v67
  v_mfma_f32_16x16x32_bf16 v[116:119], v[52:55], v[228:231], v[116:119]
  s_waitcnt lgkmcnt(5)
  v_mul_f32 v72, v12, v72
  v_mfma_f32_16x16x32_bf16 v[88:91], v[24:27], v[136:139], v[88:91]
  ds_read_b128 v[48:51], v255 offset:49408
  v_mul_f32 v73, v12, v73
  v_mfma_f32_16x16x32_bf16 v[96:99], v[24:27], v[168:171], v[96:99]
  v_mul_f32 v74, v12, v74
  v_mul_f32 v75, v12, v75
  v_mfma_f32_16x16x32_bf16 v[104:107], v[24:27], v[200:203], v[104:107]
  v_mul_f32 v76, v12, v76
  v_mfma_f32_16x16x32_bf16 v[112:115], v[24:27], v[232:235], v[112:115]
  s_waitcnt lgkmcnt(5)
  v_mul_f32 v77, v12, v77
  v_mfma_f32_16x16x32_bf16 v[92:95], v[28:31], v[136:139], v[92:95]
  ds_read_b128 v[52:55], v255 offset:51456
  v_mul_f32 v78, v12, v78
  v_mfma_f32_16x16x32_bf16 v[100:103], v[28:31], v[168:171], v[100:103]
  v_mul_f32 v79, v12, v79
  v_cvt_pk_bf16_f32 v72, v72, v73
  v_mfma_f32_16x16x32_bf16 v[108:111], v[28:31], v[200:203], v[108:111]
  v_cvt_pk_bf16_f32 v73, v74, v75
  v_mfma_f32_16x16x32_bf16 v[116:119], v[28:31], v[232:235], v[116:119]
  s_waitcnt lgkmcnt(5)
  v_cvt_pk_bf16_f32 v74, v76, v77
  v_mfma_f32_16x16x32_bf16 v[88:91], v[32:35], v[140:143], v[88:91]
  s_waitcnt vmcnt(8)
  s_barrier
  ds_read_b128 v[24:27], v16 offset:0
  v_cvt_pk_bf16_f32 v75, v78, v79
  v_mfma_f32_16x16x32_bf16 v[96:99], v[32:35], v[172:175], v[96:99]
  v_accvgpr_write_b32 a136, v72
  v_accvgpr_write_b32 a137, v73
  v_mfma_f32_16x16x32_bf16 v[104:107], v[32:35], v[204:207], v[104:107]
  v_accvgpr_write_b32 a138, v74
  v_mfma_f32_16x16x32_bf16 v[112:115], v[32:35], v[236:239], v[112:115]
  s_waitcnt lgkmcnt(5)
  v_accvgpr_write_b32 a139, v75
  v_mfma_f32_16x16x32_bf16 v[92:95], v[36:39], v[140:143], v[92:95]
  ds_read_b128 v[28:31], v16 offset:2048
  v_mul_f32 v80, v12, v80
  v_mfma_f32_16x16x32_bf16 v[100:103], v[36:39], v[172:175], v[100:103]
  v_mul_f32 v81, v12, v81
  v_mul_f32 v82, v12, v82
  v_mfma_f32_16x16x32_bf16 v[108:111], v[36:39], v[204:207], v[108:111]
  v_mul_f32 v83, v12, v83
  v_mfma_f32_16x16x32_bf16 v[116:119], v[36:39], v[236:239], v[116:119]
  s_waitcnt lgkmcnt(5)
  v_mul_f32 v84, v12, v84
  v_mfma_f32_16x16x32_bf16 v[88:91], v[40:43], v[144:147], v[88:91]
  ds_read_b128 v[32:35], v17 offset:0
  v_mul_f32 v85, v12, v85
  v_mfma_f32_16x16x32_bf16 v[96:99], v[40:43], v[176:179], v[96:99]
  v_mul_f32 v86, v12, v86
  v_mul_f32 v87, v12, v87
  v_mfma_f32_16x16x32_bf16 v[104:107], v[40:43], v[208:211], v[104:107]
  v_cvt_pk_bf16_f32 v80, v80, v81
  v_mfma_f32_16x16x32_bf16 v[112:115], v[40:43], v[240:243], v[112:115]
  s_waitcnt lgkmcnt(5)
  v_cvt_pk_bf16_f32 v81, v82, v83
  v_mfma_f32_16x16x32_bf16 v[92:95], v[44:47], v[144:147], v[92:95]
  ds_read_b128 v[36:39], v17 offset:2048
  v_cvt_pk_bf16_f32 v82, v84, v85
  v_mfma_f32_16x16x32_bf16 v[100:103], v[44:47], v[176:179], v[100:103]
  v_cvt_pk_bf16_f32 v83, v86, v87
  v_accvgpr_write_b32 a192, v80
  v_mfma_f32_16x16x32_bf16 v[108:111], v[44:47], v[208:211], v[108:111]
  v_accvgpr_write_b32 a193, v81
  v_mfma_f32_16x16x32_bf16 v[116:119], v[44:47], v[240:243], v[116:119]
  s_waitcnt lgkmcnt(5)
  v_accvgpr_write_b32 a194, v82
  v_mfma_f32_16x16x32_bf16 v[88:91], v[48:51], v[148:151], v[88:91]
  ds_read_b128 v[40:43], v18 offset:0
  v_accvgpr_write_b32 a195, v83
  v_mfma_f32_16x16x32_bf16 v[96:99], v[48:51], v[180:183], v[96:99]
  v_mfma_f32_16x16x32_bf16 v[104:107], v[48:51], v[212:215], v[104:107]
  v_mfma_f32_16x16x32_bf16 v[112:115], v[48:51], v[244:247], v[112:115]
  s_waitcnt lgkmcnt(5)
  v_mfma_f32_16x16x32_bf16 v[92:95], v[52:55], v[148:151], v[92:95]
  ds_read_b128 v[44:47], v18 offset:2048
  v_mfma_f32_16x16x32_bf16 v[100:103], v[52:55], v[180:183], v[100:103]
  v_mfma_f32_16x16x32_bf16 v[108:111], v[52:55], v[212:215], v[108:111]
  v_mfma_f32_16x16x32_bf16 v[116:119], v[52:55], v[244:247], v[116:119]
  s_waitcnt lgkmcnt(5)
  v_mfma_f32_16x16x32_bf16 v[56:59], v[24:27], v[120:123], 0
  ds_read_b128 v[48:51], v19 offset:0
  v_mfma_f32_16x16x32_bf16 v[64:67], v[24:27], v[152:155], 0
  v_mfma_f32_16x16x32_bf16 v[72:75], v[24:27], v[184:187], 0
  s_add_u32 m0, s29, 16384
  s_add_u32 s27, s28, 2883584
  buffer_load_dwordx4 v14, s[60:63], s27 offen lds
  v_mfma_f32_16x16x32_bf16 v[80:83], v[24:27], v[216:219], 0
  s_waitcnt lgkmcnt(5)
  v_mul_f32 v88, v12, v88
  v_mfma_f32_16x16x32_bf16 v[60:63], v[28:31], v[120:123], 0
  ds_read_b128 v[52:55], v19 offset:2048
  v_mul_f32 v89, v12, v89
  v_mfma_f32_16x16x32_bf16 v[68:71], v[28:31], v[152:155], 0
  v_mul_f32 v90, v12, v90
  v_mul_f32 v91, v12, v91
  v_mfma_f32_16x16x32_bf16 v[76:79], v[28:31], v[184:187], 0
  v_mul_f32 v92, v12, v92
  v_mfma_f32_16x16x32_bf16 v[84:87], v[28:31], v[216:219], 0
  s_waitcnt lgkmcnt(5)
  v_mul_f32 v93, v12, v93
  v_mfma_f32_16x16x32_bf16 v[56:59], v[32:35], v[124:127], v[56:59]
  ds_read_b128 v[24:27], v16 offset:256
  v_mul_f32 v94, v12, v94
  v_mfma_f32_16x16x32_bf16 v[64:67], v[32:35], v[156:159], v[64:67]
  v_mul_f32 v95, v12, v95
  v_cvt_pk_bf16_f32 v88, v88, v89
  v_mfma_f32_16x16x32_bf16 v[72:75], v[32:35], v[188:191], v[72:75]
  s_add_u32 m0, s29, 17408
  s_add_u32 s27, s28, 2899968
  buffer_load_dwordx4 v15, s[60:63], s27 offen lds
  v_mfma_f32_16x16x32_bf16 v[80:83], v[32:35], v[220:223], v[80:83]
  s_waitcnt lgkmcnt(5)
  v_cvt_pk_bf16_f32 v89, v90, v91
  v_mfma_f32_16x16x32_bf16 v[60:63], v[36:39], v[124:127], v[60:63]
  ds_read_b128 v[28:31], v16 offset:2304
  v_cvt_pk_bf16_f32 v90, v92, v93
  v_mfma_f32_16x16x32_bf16 v[68:71], v[36:39], v[156:159], v[68:71]
  v_cvt_pk_bf16_f32 v91, v94, v95
  v_accvgpr_write_b32 a28, v88
  v_mfma_f32_16x16x32_bf16 v[76:79], v[36:39], v[188:191], v[76:79]
  v_accvgpr_write_b32 a29, v89
  v_mfma_f32_16x16x32_bf16 v[84:87], v[36:39], v[220:223], v[84:87]
  s_waitcnt lgkmcnt(5)
  v_accvgpr_write_b32 a30, v90
  v_mfma_f32_16x16x32_bf16 v[56:59], v[40:43], v[128:131], v[56:59]
  ds_read_b128 v[32:35], v17 offset:256
  v_accvgpr_write_b32 a31, v91
  v_mfma_f32_16x16x32_bf16 v[64:67], v[40:43], v[160:163], v[64:67]
  v_mul_f32 v96, v12, v96
  v_mul_f32 v97, v12, v97
  v_mfma_f32_16x16x32_bf16 v[72:75], v[40:43], v[192:195], v[72:75]
  s_add_u32 m0, s29, 18432
  s_add_u32 s27, s28, 2916352
  buffer_load_dwordx4 v14, s[60:63], s27 offen lds
  v_mfma_f32_16x16x32_bf16 v[80:83], v[40:43], v[224:227], v[80:83]
  s_waitcnt lgkmcnt(5)
  v_mul_f32 v98, v12, v98
  v_mfma_f32_16x16x32_bf16 v[60:63], v[44:47], v[128:131], v[60:63]
  ds_read_b128 v[36:39], v17 offset:2304
  v_mul_f32 v99, v12, v99
  v_mfma_f32_16x16x32_bf16 v[68:71], v[44:47], v[160:163], v[68:71]
  v_mul_f32 v100, v12, v100
  v_mul_f32 v101, v12, v101
  v_mfma_f32_16x16x32_bf16 v[76:79], v[44:47], v[192:195], v[76:79]
  v_mul_f32 v102, v12, v102
  v_mfma_f32_16x16x32_bf16 v[84:87], v[44:47], v[224:227], v[84:87]
  s_waitcnt lgkmcnt(5)
  v_mul_f32 v103, v12, v103
  v_mfma_f32_16x16x32_bf16 v[56:59], v[48:51], v[132:135], v[56:59]
  ds_read_b128 v[40:43], v18 offset:256
  v_cvt_pk_bf16_f32 v96, v96, v97
  v_mfma_f32_16x16x32_bf16 v[64:67], v[48:51], v[164:167], v[64:67]
  v_cvt_pk_bf16_f32 v97, v98, v99
  v_cvt_pk_bf16_f32 v98, v100, v101
  v_mfma_f32_16x16x32_bf16 v[72:75], v[48:51], v[196:199], v[72:75]
  s_add_u32 m0, s29, 19456
  s_add_u32 s27, s28, 2932736
  buffer_load_dwordx4 v15, s[60:63], s27 offen lds
  v_mfma_f32_16x16x32_bf16 v[80:83], v[48:51], v[228:231], v[80:83]
  s_waitcnt lgkmcnt(5)
  v_cvt_pk_bf16_f32 v99, v102, v103
  v_mfma_f32_16x16x32_bf16 v[60:63], v[52:55], v[132:135], v[60:63]
  ds_read_b128 v[44:47], v18 offset:2304
  v_accvgpr_write_b32 a84, v96
  v_mfma_f32_16x16x32_bf16 v[68:71], v[52:55], v[164:167], v[68:71]
  v_accvgpr_write_b32 a85, v97
  v_accvgpr_write_b32 a86, v98
  v_mfma_f32_16x16x32_bf16 v[76:79], v[52:55], v[196:199], v[76:79]
  v_accvgpr_write_b32 a87, v99
  v_mfma_f32_16x16x32_bf16 v[84:87], v[52:55], v[228:231], v[84:87]
  s_waitcnt lgkmcnt(5)
  v_mul_f32 v104, v12, v104
  v_mfma_f32_16x16x32_bf16 v[56:59], v[24:27], v[136:139], v[56:59]
  ds_read_b128 v[48:51], v19 offset:256
  v_mul_f32 v105, v12, v105
  v_mfma_f32_16x16x32_bf16 v[64:67], v[24:27], v[168:171], v[64:67]
  v_mul_f32 v106, v12, v106
  v_mul_f32 v107, v12, v107
  v_mfma_f32_16x16x32_bf16 v[72:75], v[24:27], v[200:203], v[72:75]
  v_mul_f32 v108, v12, v108
  v_mfma_f32_16x16x32_bf16 v[80:83], v[24:27], v[232:235], v[80:83]
  s_waitcnt lgkmcnt(5)
  v_mul_f32 v109, v12, v109
  v_mfma_f32_16x16x32_bf16 v[60:63], v[28:31], v[136:139], v[60:63]
  ds_read_b128 v[52:55], v19 offset:2304
  v_mul_f32 v110, v12, v110
  v_mfma_f32_16x16x32_bf16 v[68:71], v[28:31], v[168:171], v[68:71]
  v_mul_f32 v111, v12, v111
  v_cvt_pk_bf16_f32 v104, v104, v105
  v_mfma_f32_16x16x32_bf16 v[76:79], v[28:31], v[200:203], v[76:79]
  v_cvt_pk_bf16_f32 v105, v106, v107
  v_mfma_f32_16x16x32_bf16 v[84:87], v[28:31], v[232:235], v[84:87]
  s_waitcnt lgkmcnt(5)
  v_cvt_pk_bf16_f32 v106, v108, v109
  v_mfma_f32_16x16x32_bf16 v[56:59], v[32:35], v[140:143], v[56:59]
  s_waitcnt vmcnt(8)
  s_barrier
  ds_read_b128 v[24:27], v16 offset:16384
  v_cvt_pk_bf16_f32 v107, v110, v111
  v_mfma_f32_16x16x32_bf16 v[64:67], v[32:35], v[172:175], v[64:67]
  v_accvgpr_write_b32 a140, v104
  v_accvgpr_write_b32 a141, v105
  v_mfma_f32_16x16x32_bf16 v[72:75], v[32:35], v[204:207], v[72:75]
  v_accvgpr_write_b32 a142, v106
  v_mfma_f32_16x16x32_bf16 v[80:83], v[32:35], v[236:239], v[80:83]
  s_waitcnt lgkmcnt(5)
  v_accvgpr_write_b32 a143, v107
  v_mfma_f32_16x16x32_bf16 v[60:63], v[36:39], v[140:143], v[60:63]
  ds_read_b128 v[28:31], v16 offset:18432
  v_mul_f32 v112, v12, v112
  v_mfma_f32_16x16x32_bf16 v[68:71], v[36:39], v[172:175], v[68:71]
  v_mul_f32 v113, v12, v113
  v_mul_f32 v114, v12, v114
  v_mfma_f32_16x16x32_bf16 v[76:79], v[36:39], v[204:207], v[76:79]
  v_mul_f32 v115, v12, v115
  v_mfma_f32_16x16x32_bf16 v[84:87], v[36:39], v[236:239], v[84:87]
  s_waitcnt lgkmcnt(5)
  v_mul_f32 v116, v12, v116
  v_mfma_f32_16x16x32_bf16 v[56:59], v[40:43], v[144:147], v[56:59]
  ds_read_b128 v[32:35], v17 offset:16384
  v_mul_f32 v117, v12, v117
  v_mfma_f32_16x16x32_bf16 v[64:67], v[40:43], v[176:179], v[64:67]
  v_mul_f32 v118, v12, v118
  v_mul_f32 v119, v12, v119
  v_mfma_f32_16x16x32_bf16 v[72:75], v[40:43], v[208:211], v[72:75]
  v_cvt_pk_bf16_f32 v112, v112, v113
  v_mfma_f32_16x16x32_bf16 v[80:83], v[40:43], v[240:243], v[80:83]
  s_waitcnt lgkmcnt(5)
  v_cvt_pk_bf16_f32 v113, v114, v115
  v_mfma_f32_16x16x32_bf16 v[60:63], v[44:47], v[144:147], v[60:63]
  ds_read_b128 v[36:39], v17 offset:18432
  v_cvt_pk_bf16_f32 v114, v116, v117
  v_mfma_f32_16x16x32_bf16 v[68:71], v[44:47], v[176:179], v[68:71]
  v_cvt_pk_bf16_f32 v115, v118, v119
  v_accvgpr_write_b32 a196, v112
  v_mfma_f32_16x16x32_bf16 v[76:79], v[44:47], v[208:211], v[76:79]
  v_accvgpr_write_b32 a197, v113
  v_mfma_f32_16x16x32_bf16 v[84:87], v[44:47], v[240:243], v[84:87]
  s_waitcnt lgkmcnt(5)
  v_accvgpr_write_b32 a198, v114
  v_mfma_f32_16x16x32_bf16 v[56:59], v[48:51], v[148:151], v[56:59]
  ds_read_b128 v[40:43], v18 offset:16384
  v_accvgpr_write_b32 a199, v115
  v_mfma_f32_16x16x32_bf16 v[64:67], v[48:51], v[180:183], v[64:67]
  v_mfma_f32_16x16x32_bf16 v[72:75], v[48:51], v[212:215], v[72:75]
  v_mfma_f32_16x16x32_bf16 v[80:83], v[48:51], v[244:247], v[80:83]
  s_waitcnt lgkmcnt(5)
  v_mfma_f32_16x16x32_bf16 v[60:63], v[52:55], v[148:151], v[60:63]
  ds_read_b128 v[44:47], v18 offset:18432
  v_mfma_f32_16x16x32_bf16 v[68:71], v[52:55], v[180:183], v[68:71]
  v_mfma_f32_16x16x32_bf16 v[76:79], v[52:55], v[212:215], v[76:79]
  v_mfma_f32_16x16x32_bf16 v[84:87], v[52:55], v[244:247], v[84:87]
  s_waitcnt lgkmcnt(5)
  s_getpc_b64 s[98:99]
  s_add_u32 s98, s98, 4096
  s_addc_u32 s99, s99, 0
  global_load_dword v7, v6, s[98:99]
  v_mfma_f32_16x16x32_bf16 v[88:91], v[24:27], v[120:123], 0
  ds_read_b128 v[48:51], v19 offset:16384
  v_mfma_f32_16x16x32_bf16 v[96:99], v[24:27], v[152:155], 0
  v_mfma_f32_16x16x32_bf16 v[104:107], v[24:27], v[184:187], 0
  s_add_u32 m0, s29, 32768
  s_add_u32 s27, s28, 3145728
  buffer_load_dwordx4 v14, s[60:63], s27 offen lds
  v_mfma_f32_16x16x32_bf16 v[112:115], v[24:27], v[216:219], 0
  s_waitcnt lgkmcnt(5)
  v_mul_f32 v56, v12, v56
  v_mfma_f32_16x16x32_bf16 v[92:95], v[28:31], v[120:123], 0
  ds_read_b128 v[52:55], v19 offset:18432
  v_mul_f32 v57, v12, v57
  v_mfma_f32_16x16x32_bf16 v[100:103], v[28:31], v[152:155], 0
  v_mul_f32 v58, v12, v58
  v_mul_f32 v59, v12, v59
  v_mfma_f32_16x16x32_bf16 v[108:111], v[28:31], v[184:187], 0
  v_mul_f32 v60, v12, v60
  v_mfma_f32_16x16x32_bf16 v[116:119], v[28:31], v[216:219], 0
  s_waitcnt lgkmcnt(5)
  v_mul_f32 v61, v12, v61
  v_mfma_f32_16x16x32_bf16 v[88:91], v[32:35], v[124:127], v[88:91]
  ds_read_b128 v[24:27], v16 offset:16640
  v_mul_f32 v62, v12, v62
  v_mfma_f32_16x16x32_bf16 v[96:99], v[32:35], v[156:159], v[96:99]
  v_mul_f32 v63, v12, v63
  v_cvt_pk_bf16_f32 v56, v56, v57
  v_mfma_f32_16x16x32_bf16 v[104:107], v[32:35], v[188:191], v[104:107]
  s_add_u32 m0, s29, 33792
  s_add_u32 s27, s28, 3162112
  buffer_load_dwordx4 v15, s[60:63], s27 offen lds
  v_mfma_f32_16x16x32_bf16 v[112:115], v[32:35], v[220:223], v[112:115]
  s_waitcnt lgkmcnt(5)
  v_cvt_pk_bf16_f32 v57, v58, v59
  v_mfma_f32_16x16x32_bf16 v[92:95], v[36:39], v[124:127], v[92:95]
  ds_read_b128 v[28:31], v16 offset:18688
  v_cvt_pk_bf16_f32 v58, v60, v61
  v_mfma_f32_16x16x32_bf16 v[100:103], v[36:39], v[156:159], v[100:103]
  v_cvt_pk_bf16_f32 v59, v62, v63
  v_accvgpr_write_b32 a32, v56
  v_mfma_f32_16x16x32_bf16 v[108:111], v[36:39], v[188:191], v[108:111]
  v_accvgpr_write_b32 a33, v57
  v_mfma_f32_16x16x32_bf16 v[116:119], v[36:39], v[220:223], v[116:119]
  s_waitcnt lgkmcnt(5)
  v_accvgpr_write_b32 a34, v58
  v_mfma_f32_16x16x32_bf16 v[88:91], v[40:43], v[128:131], v[88:91]
  ds_read_b128 v[32:35], v17 offset:16640
  v_accvgpr_write_b32 a35, v59
  v_mfma_f32_16x16x32_bf16 v[96:99], v[40:43], v[160:163], v[96:99]
  v_mul_f32 v64, v12, v64
  v_mul_f32 v65, v12, v65
  v_mfma_f32_16x16x32_bf16 v[104:107], v[40:43], v[192:195], v[104:107]
  s_add_u32 m0, s29, 34816
  s_add_u32 s27, s28, 3178496
  buffer_load_dwordx4 v14, s[60:63], s27 offen lds
  v_mfma_f32_16x16x32_bf16 v[112:115], v[40:43], v[224:227], v[112:115]
  s_waitcnt lgkmcnt(5)
  v_mul_f32 v66, v12, v66
  v_mfma_f32_16x16x32_bf16 v[92:95], v[44:47], v[128:131], v[92:95]
  ds_read_b128 v[36:39], v17 offset:18688
  v_mul_f32 v67, v12, v67
  v_mfma_f32_16x16x32_bf16 v[100:103], v[44:47], v[160:163], v[100:103]
  v_mul_f32 v68, v12, v68
  v_mul_f32 v69, v12, v69
  v_mfma_f32_16x16x32_bf16 v[108:111], v[44:47], v[192:195], v[108:111]
  v_mul_f32 v70, v12, v70
  v_mfma_f32_16x16x32_bf16 v[116:119], v[44:47], v[224:227], v[116:119]
  s_waitcnt lgkmcnt(5)
  v_mul_f32 v71, v12, v71
  v_mfma_f32_16x16x32_bf16 v[88:91], v[48:51], v[132:135], v[88:91]
  ds_read_b128 v[40:43], v18 offset:16640
  v_cvt_pk_bf16_f32 v64, v64, v65
  v_mfma_f32_16x16x32_bf16 v[96:99], v[48:51], v[164:167], v[96:99]
  v_cvt_pk_bf16_f32 v65, v66, v67
  v_cvt_pk_bf16_f32 v66, v68, v69
  v_mfma_f32_16x16x32_bf16 v[104:107], v[48:51], v[196:199], v[104:107]
  s_add_u32 m0, s29, 35840
  s_add_u32 s27, s28, 3194880
  buffer_load_dwordx4 v15, s[60:63], s27 offen lds
  v_mfma_f32_16x16x32_bf16 v[112:115], v[48:51], v[228:231], v[112:115]
  s_waitcnt lgkmcnt(5)
  v_cvt_pk_bf16_f32 v67, v70, v71
  v_mfma_f32_16x16x32_bf16 v[92:95], v[52:55], v[132:135], v[92:95]
  ds_read_b128 v[44:47], v18 offset:18688
  v_accvgpr_write_b32 a88, v64
  v_mfma_f32_16x16x32_bf16 v[100:103], v[52:55], v[164:167], v[100:103]
  v_accvgpr_write_b32 a89, v65
  v_accvgpr_write_b32 a90, v66
  v_mfma_f32_16x16x32_bf16 v[108:111], v[52:55], v[196:199], v[108:111]
  v_accvgpr_write_b32 a91, v67
  v_mfma_f32_16x16x32_bf16 v[116:119], v[52:55], v[228:231], v[116:119]
  s_waitcnt lgkmcnt(5)
  v_mul_f32 v72, v12, v72
  v_mfma_f32_16x16x32_bf16 v[88:91], v[24:27], v[136:139], v[88:91]
  ds_read_b128 v[48:51], v19 offset:16640
  v_mul_f32 v73, v12, v73
  v_mfma_f32_16x16x32_bf16 v[96:99], v[24:27], v[168:171], v[96:99]
  v_mul_f32 v74, v12, v74
  v_mul_f32 v75, v12, v75
  v_mfma_f32_16x16x32_bf16 v[104:107], v[24:27], v[200:203], v[104:107]
  v_mul_f32 v76, v12, v76
  v_mfma_f32_16x16x32_bf16 v[112:115], v[24:27], v[232:235], v[112:115]
  s_waitcnt lgkmcnt(5)
  v_mul_f32 v77, v12, v77
  v_mfma_f32_16x16x32_bf16 v[92:95], v[28:31], v[136:139], v[92:95]
  ds_read_b128 v[52:55], v19 offset:18688
  v_mul_f32 v78, v12, v78
  v_mfma_f32_16x16x32_bf16 v[100:103], v[28:31], v[168:171], v[100:103]
  v_mul_f32 v79, v12, v79
  v_cvt_pk_bf16_f32 v72, v72, v73
  v_mfma_f32_16x16x32_bf16 v[108:111], v[28:31], v[200:203], v[108:111]
  v_cvt_pk_bf16_f32 v73, v74, v75
  v_mfma_f32_16x16x32_bf16 v[116:119], v[28:31], v[232:235], v[116:119]
  s_waitcnt lgkmcnt(5)
  v_cvt_pk_bf16_f32 v74, v76, v77
  v_mfma_f32_16x16x32_bf16 v[88:91], v[32:35], v[140:143], v[88:91]
  s_waitcnt vmcnt(8)
  s_barrier
  ds_read_b128 v[24:27], v248 offset:0
  v_cvt_pk_bf16_f32 v75, v78, v79
  v_mfma_f32_16x16x32_bf16 v[96:99], v[32:35], v[172:175], v[96:99]
  v_accvgpr_write_b32 a144, v72
  v_accvgpr_write_b32 a145, v73
  v_mfma_f32_16x16x32_bf16 v[104:107], v[32:35], v[204:207], v[104:107]
  v_accvgpr_write_b32 a146, v74
  v_mfma_f32_16x16x32_bf16 v[112:115], v[32:35], v[236:239], v[112:115]
  s_waitcnt lgkmcnt(5)
  v_accvgpr_write_b32 a147, v75
  v_mfma_f32_16x16x32_bf16 v[92:95], v[36:39], v[140:143], v[92:95]
  ds_read_b128 v[28:31], v248 offset:2048
  v_mul_f32 v80, v12, v80
  v_mfma_f32_16x16x32_bf16 v[100:103], v[36:39], v[172:175], v[100:103]
  v_mul_f32 v81, v12, v81
  v_mul_f32 v82, v12, v82
  v_mfma_f32_16x16x32_bf16 v[108:111], v[36:39], v[204:207], v[108:111]
  v_mul_f32 v83, v12, v83
  v_mfma_f32_16x16x32_bf16 v[116:119], v[36:39], v[236:239], v[116:119]
  s_waitcnt lgkmcnt(5)
  v_mul_f32 v84, v12, v84
  v_mfma_f32_16x16x32_bf16 v[88:91], v[40:43], v[144:147], v[88:91]
  ds_read_b128 v[32:35], v249 offset:0
  v_mul_f32 v85, v12, v85
  v_mfma_f32_16x16x32_bf16 v[96:99], v[40:43], v[176:179], v[96:99]
  v_mul_f32 v86, v12, v86
  v_mul_f32 v87, v12, v87
  v_mfma_f32_16x16x32_bf16 v[104:107], v[40:43], v[208:211], v[104:107]
  v_cvt_pk_bf16_f32 v80, v80, v81
  v_mfma_f32_16x16x32_bf16 v[112:115], v[40:43], v[240:243], v[112:115]
  s_waitcnt lgkmcnt(5)
  v_cvt_pk_bf16_f32 v81, v82, v83
  v_mfma_f32_16x16x32_bf16 v[92:95], v[44:47], v[144:147], v[92:95]
  ds_read_b128 v[36:39], v249 offset:2048
  v_cvt_pk_bf16_f32 v82, v84, v85
  v_mfma_f32_16x16x32_bf16 v[100:103], v[44:47], v[176:179], v[100:103]
  v_cvt_pk_bf16_f32 v83, v86, v87
  v_accvgpr_write_b32 a200, v80
  v_mfma_f32_16x16x32_bf16 v[108:111], v[44:47], v[208:211], v[108:111]
  v_accvgpr_write_b32 a201, v81
  v_mfma_f32_16x16x32_bf16 v[116:119], v[44:47], v[240:243], v[116:119]
  s_waitcnt lgkmcnt(5)
  v_accvgpr_write_b32 a202, v82
  v_mfma_f32_16x16x32_bf16 v[88:91], v[48:51], v[148:151], v[88:91]
  ds_read_b128 v[40:43], v250 offset:0
  v_accvgpr_write_b32 a203, v83
  v_mfma_f32_16x16x32_bf16 v[96:99], v[48:51], v[180:183], v[96:99]
  v_mfma_f32_16x16x32_bf16 v[104:107], v[48:51], v[212:215], v[104:107]
  v_mfma_f32_16x16x32_bf16 v[112:115], v[48:51], v[244:247], v[112:115]
  s_waitcnt lgkmcnt(5)
  v_mfma_f32_16x16x32_bf16 v[92:95], v[52:55], v[148:151], v[92:95]
  ds_read_b128 v[44:47], v250 offset:2048
  v_mfma_f32_16x16x32_bf16 v[100:103], v[52:55], v[180:183], v[100:103]
  v_mfma_f32_16x16x32_bf16 v[108:111], v[52:55], v[212:215], v[108:111]
  v_mfma_f32_16x16x32_bf16 v[116:119], v[52:55], v[244:247], v[116:119]
  s_waitcnt lgkmcnt(5)
  v_mfma_f32_16x16x32_bf16 v[56:59], v[24:27], v[120:123], 0
  ds_read_b128 v[48:51], v251 offset:0
  v_mfma_f32_16x16x32_bf16 v[64:67], v[24:27], v[152:155], 0
  v_mfma_f32_16x16x32_bf16 v[72:75], v[24:27], v[184:187], 0
  s_add_u32 m0, s29, 49152
  s_add_u32 s27, s28, 3407872
  buffer_load_dwordx4 v14, s[60:63], s27 offen lds
  v_mfma_f32_16x16x32_bf16 v[80:83], v[24:27], v[216:219], 0
  s_waitcnt lgkmcnt(5)
  v_mul_f32 v88, v12, v88
  v_mfma_f32_16x16x32_bf16 v[60:63], v[28:31], v[120:123], 0
  ds_read_b128 v[52:55], v251 offset:2048
  v_mul_f32 v89, v12, v89
  v_mfma_f32_16x16x32_bf16 v[68:71], v[28:31], v[152:155], 0
  v_mul_f32 v90, v12, v90
  v_mul_f32 v91, v12, v91
  v_mfma_f32_16x16x32_bf16 v[76:79], v[28:31], v[184:187], 0
  v_mul_f32 v92, v12, v92
  v_mfma_f32_16x16x32_bf16 v[84:87], v[28:31], v[216:219], 0
  s_waitcnt lgkmcnt(5)
  v_mul_f32 v93, v12, v93
  v_mfma_f32_16x16x32_bf16 v[56:59], v[32:35], v[124:127], v[56:59]
  ds_read_b128 v[24:27], v248 offset:256
  v_mul_f32 v94, v12, v94
  v_mfma_f32_16x16x32_bf16 v[64:67], v[32:35], v[156:159], v[64:67]
  v_mul_f32 v95, v12, v95
  v_cvt_pk_bf16_f32 v88, v88, v89
  v_mfma_f32_16x16x32_bf16 v[72:75], v[32:35], v[188:191], v[72:75]
  s_add_u32 m0, s29, 50176
  s_add_u32 s27, s28, 3424256
  buffer_load_dwordx4 v15, s[60:63], s27 offen lds
  v_mfma_f32_16x16x32_bf16 v[80:83], v[32:35], v[220:223], v[80:83]
  s_waitcnt lgkmcnt(5)
  v_cvt_pk_bf16_f32 v89, v90, v91
  v_mfma_f32_16x16x32_bf16 v[60:63], v[36:39], v[124:127], v[60:63]
  ds_read_b128 v[28:31], v248 offset:2304
  v_cvt_pk_bf16_f32 v90, v92, v93
  v_mfma_f32_16x16x32_bf16 v[68:71], v[36:39], v[156:159], v[68:71]
  v_cvt_pk_bf16_f32 v91, v94, v95
  v_accvgpr_write_b32 a36, v88
  v_mfma_f32_16x16x32_bf16 v[76:79], v[36:39], v[188:191], v[76:79]
  v_accvgpr_write_b32 a37, v89
  v_mfma_f32_16x16x32_bf16 v[84:87], v[36:39], v[220:223], v[84:87]
  s_waitcnt lgkmcnt(5)
  v_accvgpr_write_b32 a38, v90
  v_mfma_f32_16x16x32_bf16 v[56:59], v[40:43], v[128:131], v[56:59]
  ds_read_b128 v[32:35], v249 offset:256
  v_accvgpr_write_b32 a39, v91
  v_mfma_f32_16x16x32_bf16 v[64:67], v[40:43], v[160:163], v[64:67]
  v_mul_f32 v96, v12, v96
  v_mul_f32 v97, v12, v97
  v_mfma_f32_16x16x32_bf16 v[72:75], v[40:43], v[192:195], v[72:75]
  s_add_u32 m0, s29, 51200
  s_add_u32 s27, s28, 3440640
  buffer_load_dwordx4 v14, s[60:63], s27 offen lds
  v_mfma_f32_16x16x32_bf16 v[80:83], v[40:43], v[224:227], v[80:83]
  s_waitcnt lgkmcnt(5)
  v_mul_f32 v98, v12, v98
  v_mfma_f32_16x16x32_bf16 v[60:63], v[44:47], v[128:131], v[60:63]
  ds_read_b128 v[36:39], v249 offset:2304
  v_mul_f32 v99, v12, v99
  v_mfma_f32_16x16x32_bf16 v[68:71], v[44:47], v[160:163], v[68:71]
  v_mul_f32 v100, v12, v100
  v_mul_f32 v101, v12, v101
  v_mfma_f32_16x16x32_bf16 v[76:79], v[44:47], v[192:195], v[76:79]
  v_mul_f32 v102, v12, v102
  v_mfma_f32_16x16x32_bf16 v[84:87], v[44:47], v[224:227], v[84:87]
  s_waitcnt lgkmcnt(5)
  v_mul_f32 v103, v12, v103
  v_mfma_f32_16x16x32_bf16 v[56:59], v[48:51], v[132:135], v[56:59]
  ds_read_b128 v[40:43], v250 offset:256
  v_cvt_pk_bf16_f32 v96, v96, v97
  v_mfma_f32_16x16x32_bf16 v[64:67], v[48:51], v[164:167], v[64:67]
  v_cvt_pk_bf16_f32 v97, v98, v99
  v_cvt_pk_bf16_f32 v98, v100, v101
  v_mfma_f32_16x16x32_bf16 v[72:75], v[48:51], v[196:199], v[72:75]
  s_add_u32 m0, s29, 52224
  s_add_u32 s27, s28, 3457024
  buffer_load_dwordx4 v15, s[60:63], s27 offen lds
  v_mfma_f32_16x16x32_bf16 v[80:83], v[48:51], v[228:231], v[80:83]
  s_waitcnt lgkmcnt(5)
  v_cvt_pk_bf16_f32 v99, v102, v103
  v_mfma_f32_16x16x32_bf16 v[60:63], v[52:55], v[132:135], v[60:63]
  ds_read_b128 v[44:47], v250 offset:2304
  v_accvgpr_write_b32 a92, v96
  v_mfma_f32_16x16x32_bf16 v[68:71], v[52:55], v[164:167], v[68:71]
  v_accvgpr_write_b32 a93, v97
  v_accvgpr_write_b32 a94, v98
  v_mfma_f32_16x16x32_bf16 v[76:79], v[52:55], v[196:199], v[76:79]
  v_accvgpr_write_b32 a95, v99
  v_mfma_f32_16x16x32_bf16 v[84:87], v[52:55], v[228:231], v[84:87]
  s_waitcnt lgkmcnt(5)
  v_mul_f32 v104, v12, v104
  v_mfma_f32_16x16x32_bf16 v[56:59], v[24:27], v[136:139], v[56:59]
  ds_read_b128 v[48:51], v251 offset:256
  v_mul_f32 v105, v12, v105
  v_mfma_f32_16x16x32_bf16 v[64:67], v[24:27], v[168:171], v[64:67]
  v_mul_f32 v106, v12, v106
  v_mul_f32 v107, v12, v107
  v_mfma_f32_16x16x32_bf16 v[72:75], v[24:27], v[200:203], v[72:75]
  v_mul_f32 v108, v12, v108
  v_mfma_f32_16x16x32_bf16 v[80:83], v[24:27], v[232:235], v[80:83]
  s_waitcnt lgkmcnt(5)
  v_mul_f32 v109, v12, v109
  v_mfma_f32_16x16x32_bf16 v[60:63], v[28:31], v[136:139], v[60:63]
  ds_read_b128 v[52:55], v251 offset:2304
  v_mul_f32 v110, v12, v110
  v_mfma_f32_16x16x32_bf16 v[68:71], v[28:31], v[168:171], v[68:71]
  v_mul_f32 v111, v12, v111
  v_cvt_pk_bf16_f32 v104, v104, v105
  v_mfma_f32_16x16x32_bf16 v[76:79], v[28:31], v[200:203], v[76:79]
  v_cvt_pk_bf16_f32 v105, v106, v107
  v_mfma_f32_16x16x32_bf16 v[84:87], v[28:31], v[232:235], v[84:87]
  s_waitcnt lgkmcnt(5)
  v_cvt_pk_bf16_f32 v106, v108, v109
  v_mfma_f32_16x16x32_bf16 v[56:59], v[32:35], v[140:143], v[56:59]
  s_waitcnt vmcnt(8)
  s_barrier
  ds_read_b128 v[24:27], v248 offset:16384
  v_cvt_pk_bf16_f32 v107, v110, v111
  v_mfma_f32_16x16x32_bf16 v[64:67], v[32:35], v[172:175], v[64:67]
  v_accvgpr_write_b32 a148, v104
  v_accvgpr_write_b32 a149, v105
  v_mfma_f32_16x16x32_bf16 v[72:75], v[32:35], v[204:207], v[72:75]
  v_accvgpr_write_b32 a150, v106
  v_mfma_f32_16x16x32_bf16 v[80:83], v[32:35], v[236:239], v[80:83]
  s_waitcnt lgkmcnt(5)
  v_accvgpr_write_b32 a151, v107
  v_mfma_f32_16x16x32_bf16 v[60:63], v[36:39], v[140:143], v[60:63]
  ds_read_b128 v[28:31], v248 offset:18432
  v_mul_f32 v112, v12, v112
  v_mfma_f32_16x16x32_bf16 v[68:71], v[36:39], v[172:175], v[68:71]
  v_mul_f32 v113, v12, v113
  v_mul_f32 v114, v12, v114
  v_mfma_f32_16x16x32_bf16 v[76:79], v[36:39], v[204:207], v[76:79]
  v_mul_f32 v115, v12, v115
  v_mfma_f32_16x16x32_bf16 v[84:87], v[36:39], v[236:239], v[84:87]
  s_waitcnt lgkmcnt(5)
  v_mul_f32 v116, v12, v116
  v_mfma_f32_16x16x32_bf16 v[56:59], v[40:43], v[144:147], v[56:59]
  ds_read_b128 v[32:35], v249 offset:16384
  v_mul_f32 v117, v12, v117
  v_mfma_f32_16x16x32_bf16 v[64:67], v[40:43], v[176:179], v[64:67]
  v_mul_f32 v118, v12, v118
  v_mul_f32 v119, v12, v119
  v_mfma_f32_16x16x32_bf16 v[72:75], v[40:43], v[208:211], v[72:75]
  v_cvt_pk_bf16_f32 v112, v112, v113
  v_mfma_f32_16x16x32_bf16 v[80:83], v[40:43], v[240:243], v[80:83]
  s_waitcnt lgkmcnt(5)
  v_cvt_pk_bf16_f32 v113, v114, v115
  v_mfma_f32_16x16x32_bf16 v[60:63], v[44:47], v[144:147], v[60:63]
  ds_read_b128 v[36:39], v249 offset:18432
  v_cvt_pk_bf16_f32 v114, v116, v117
  v_mfma_f32_16x16x32_bf16 v[68:71], v[44:47], v[176:179], v[68:71]
  v_cvt_pk_bf16_f32 v115, v118, v119
  v_accvgpr_write_b32 a204, v112
  v_mfma_f32_16x16x32_bf16 v[76:79], v[44:47], v[208:211], v[76:79]
  v_accvgpr_write_b32 a205, v113
  v_mfma_f32_16x16x32_bf16 v[84:87], v[44:47], v[240:243], v[84:87]
  s_waitcnt lgkmcnt(5)
  v_accvgpr_write_b32 a206, v114
  v_mfma_f32_16x16x32_bf16 v[56:59], v[48:51], v[148:151], v[56:59]
  ds_read_b128 v[40:43], v250 offset:16384
  v_accvgpr_write_b32 a207, v115
  v_mfma_f32_16x16x32_bf16 v[64:67], v[48:51], v[180:183], v[64:67]
  v_mfma_f32_16x16x32_bf16 v[72:75], v[48:51], v[212:215], v[72:75]
  v_mfma_f32_16x16x32_bf16 v[80:83], v[48:51], v[244:247], v[80:83]
  s_waitcnt lgkmcnt(5)
  v_mfma_f32_16x16x32_bf16 v[60:63], v[52:55], v[148:151], v[60:63]
  ds_read_b128 v[44:47], v250 offset:18432
  v_mfma_f32_16x16x32_bf16 v[68:71], v[52:55], v[180:183], v[68:71]
  v_mfma_f32_16x16x32_bf16 v[76:79], v[52:55], v[212:215], v[76:79]
  v_mfma_f32_16x16x32_bf16 v[84:87], v[52:55], v[244:247], v[84:87]
  s_waitcnt lgkmcnt(5)
  v_mfma_f32_16x16x32_bf16 v[88:91], v[24:27], v[120:123], 0
  ds_read_b128 v[48:51], v251 offset:16384
  v_mfma_f32_16x16x32_bf16 v[96:99], v[24:27], v[152:155], 0
  v_mfma_f32_16x16x32_bf16 v[104:107], v[24:27], v[184:187], 0
  buffer_load_dword v13, off, s[12:15], 0 offset:132 sc1
  v_mfma_f32_16x16x32_bf16 v[112:115], v[24:27], v[216:219], 0
  s_waitcnt lgkmcnt(5)
  v_mul_f32 v56, v12, v56
  v_mfma_f32_16x16x32_bf16 v[92:95], v[28:31], v[120:123], 0
  ds_read_b128 v[52:55], v251 offset:18432
  v_mul_f32 v57, v12, v57
  v_mfma_f32_16x16x32_bf16 v[100:103], v[28:31], v[152:155], 0
  v_mul_f32 v58, v12, v58
  v_mul_f32 v59, v12, v59
  v_mfma_f32_16x16x32_bf16 v[108:111], v[28:31], v[184:187], 0
  v_mul_f32 v60, v12, v60
  v_mfma_f32_16x16x32_bf16 v[116:119], v[28:31], v[216:219], 0
  s_waitcnt lgkmcnt(5)
  v_mul_f32 v61, v12, v61
  v_mfma_f32_16x16x32_bf16 v[88:91], v[32:35], v[124:127], v[88:91]
  ds_read_b128 v[24:27], v248 offset:16640
  v_mul_f32 v62, v12, v62
  v_mfma_f32_16x16x32_bf16 v[96:99], v[32:35], v[156:159], v[96:99]
  v_mul_f32 v63, v12, v63
  v_cvt_pk_bf16_f32 v56, v56, v57
  v_mfma_f32_16x16x32_bf16 v[104:107], v[32:35], v[188:191], v[104:107]
  v_cvt_pk_bf16_f32 v57, v58, v59
  v_mfma_f32_16x16x32_bf16 v[112:115], v[32:35], v[220:223], v[112:115]
  s_waitcnt lgkmcnt(5)
  v_cvt_pk_bf16_f32 v58, v60, v61
  v_mfma_f32_16x16x32_bf16 v[92:95], v[36:39], v[124:127], v[92:95]
  ds_read_b128 v[28:31], v248 offset:18688
  v_cvt_pk_bf16_f32 v59, v62, v63
  v_mfma_f32_16x16x32_bf16 v[100:103], v[36:39], v[156:159], v[100:103]
  v_accvgpr_write_b32 a40, v56
  v_accvgpr_write_b32 a41, v57
  v_mfma_f32_16x16x32_bf16 v[108:111], v[36:39], v[188:191], v[108:111]
  v_accvgpr_write_b32 a42, v58
  v_mfma_f32_16x16x32_bf16 v[116:119], v[36:39], v[220:223], v[116:119]
  s_waitcnt lgkmcnt(5)
  v_accvgpr_write_b32 a43, v59
  v_mfma_f32_16x16x32_bf16 v[88:91], v[40:43], v[128:131], v[88:91]
  ds_read_b128 v[32:35], v249 offset:16640
  v_mul_f32 v64, v12, v64
  v_mfma_f32_16x16x32_bf16 v[96:99], v[40:43], v[160:163], v[96:99]
  v_mul_f32 v65, v12, v65
  v_mul_f32 v66, v12, v66
  v_mfma_f32_16x16x32_bf16 v[104:107], v[40:43], v[192:195], v[104:107]
  v_mul_f32 v67, v12, v67
  v_mfma_f32_16x16x32_bf16 v[112:115], v[40:43], v[224:227], v[112:115]
  s_waitcnt lgkmcnt(5)
  v_mul_f32 v68, v12, v68
  v_mfma_f32_16x16x32_bf16 v[92:95], v[44:47], v[128:131], v[92:95]
  ds_read_b128 v[36:39], v249 offset:18688
  v_mul_f32 v69, v12, v69
  v_mfma_f32_16x16x32_bf16 v[100:103], v[44:47], v[160:163], v[100:103]
  v_mul_f32 v70, v12, v70
  v_mul_f32 v71, v12, v71
  v_mfma_f32_16x16x32_bf16 v[108:111], v[44:47], v[192:195], v[108:111]
  v_cvt_pk_bf16_f32 v64, v64, v65
  v_mfma_f32_16x16x32_bf16 v[116:119], v[44:47], v[224:227], v[116:119]
  s_waitcnt lgkmcnt(5)
  v_cvt_pk_bf16_f32 v65, v66, v67
  v_mfma_f32_16x16x32_bf16 v[88:91], v[48:51], v[132:135], v[88:91]
  ds_read_b128 v[40:43], v250 offset:16640
  v_cvt_pk_bf16_f32 v66, v68, v69
  v_mfma_f32_16x16x32_bf16 v[96:99], v[48:51], v[164:167], v[96:99]
  v_cvt_pk_bf16_f32 v67, v70, v71
  v_accvgpr_write_b32 a96, v64
  v_mfma_f32_16x16x32_bf16 v[104:107], v[48:51], v[196:199], v[104:107]
  v_accvgpr_write_b32 a97, v65
  v_mfma_f32_16x16x32_bf16 v[112:115], v[48:51], v[228:231], v[112:115]
  s_waitcnt lgkmcnt(5)
  v_accvgpr_write_b32 a98, v66
  v_mfma_f32_16x16x32_bf16 v[92:95], v[52:55], v[132:135], v[92:95]
  ds_read_b128 v[44:47], v250 offset:18688
  v_accvgpr_write_b32 a99, v67
  v_mfma_f32_16x16x32_bf16 v[100:103], v[52:55], v[164:167], v[100:103]
  v_mul_f32 v72, v12, v72
  v_mul_f32 v73, v12, v73
  v_mfma_f32_16x16x32_bf16 v[108:111], v[52:55], v[196:199], v[108:111]
  v_mul_f32 v74, v12, v74
  v_mfma_f32_16x16x32_bf16 v[116:119], v[52:55], v[228:231], v[116:119]
  s_waitcnt lgkmcnt(5)
  v_mul_f32 v75, v12, v75
  v_mfma_f32_16x16x32_bf16 v[88:91], v[24:27], v[136:139], v[88:91]
  ds_read_b128 v[48:51], v251 offset:16640
  v_mul_f32 v76, v12, v76
  v_mfma_f32_16x16x32_bf16 v[96:99], v[24:27], v[168:171], v[96:99]
  v_mul_f32 v77, v12, v77
  v_mul_f32 v78, v12, v78
  v_mfma_f32_16x16x32_bf16 v[104:107], v[24:27], v[200:203], v[104:107]
  v_mul_f32 v79, v12, v79
  v_mfma_f32_16x16x32_bf16 v[112:115], v[24:27], v[232:235], v[112:115]
  s_waitcnt lgkmcnt(5)
  v_cvt_pk_bf16_f32 v72, v72, v73
  v_mfma_f32_16x16x32_bf16 v[92:95], v[28:31], v[136:139], v[92:95]
  ds_read_b128 v[52:55], v251 offset:18688
  v_cvt_pk_bf16_f32 v73, v74, v75
  v_mfma_f32_16x16x32_bf16 v[100:103], v[28:31], v[168:171], v[100:103]
  v_cvt_pk_bf16_f32 v74, v76, v77
  v_cvt_pk_bf16_f32 v75, v78, v79
  v_mfma_f32_16x16x32_bf16 v[108:111], v[28:31], v[200:203], v[108:111]
  v_accvgpr_write_b32 a152, v72
  v_mfma_f32_16x16x32_bf16 v[116:119], v[28:31], v[232:235], v[116:119]
  s_waitcnt lgkmcnt(5)
  v_accvgpr_write_b32 a153, v73
  v_mfma_f32_16x16x32_bf16 v[88:91], v[32:35], v[140:143], v[88:91]
  s_waitcnt vmcnt(5)
  s_barrier
  ds_read_b128 v[24:27], v248 offset:32768
  v_accvgpr_write_b32 a154, v74
  v_mfma_f32_16x16x32_bf16 v[96:99], v[32:35], v[172:175], v[96:99]
  v_accvgpr_write_b32 a155, v75
  v_mul_f32 v80, v12, v80
  v_mfma_f32_16x16x32_bf16 v[104:107], v[32:35], v[204:207], v[104:107]
  v_mul_f32 v81, v12, v81
  v_mfma_f32_16x16x32_bf16 v[112:115], v[32:35], v[236:239], v[112:115]
  s_waitcnt lgkmcnt(5)
  v_mul_f32 v82, v12, v82
  v_mfma_f32_16x16x32_bf16 v[92:95], v[36:39], v[140:143], v[92:95]
  ds_read_b128 v[28:31], v248 offset:34816
  v_mul_f32 v83, v12, v83
  v_mfma_f32_16x16x32_bf16 v[100:103], v[36:39], v[172:175], v[100:103]
  v_mul_f32 v84, v12, v84
  v_mul_f32 v85, v12, v85
  v_mfma_f32_16x16x32_bf16 v[108:111], v[36:39], v[204:207], v[108:111]
  v_mul_f32 v86, v12, v86
  v_mfma_f32_16x16x32_bf16 v[116:119], v[36:39], v[236:239], v[116:119]
  s_waitcnt lgkmcnt(5)
  v_mul_f32 v87, v12, v87
  v_mfma_f32_16x16x32_bf16 v[88:91], v[40:43], v[144:147], v[88:91]
  ds_read_b128 v[32:35], v249 offset:32768
  v_cvt_pk_bf16_f32 v80, v80, v81
  v_mfma_f32_16x16x32_bf16 v[96:99], v[40:43], v[176:179], v[96:99]
  v_cvt_pk_bf16_f32 v81, v82, v83
  v_cvt_pk_bf16_f32 v82, v84, v85
  v_mfma_f32_16x16x32_bf16 v[104:107], v[40:43], v[208:211], v[104:107]
  v_cvt_pk_bf16_f32 v83, v86, v87
  v_mfma_f32_16x16x32_bf16 v[112:115], v[40:43], v[240:243], v[112:115]
  s_waitcnt lgkmcnt(5)
  v_accvgpr_write_b32 a208, v80
  v_mfma_f32_16x16x32_bf16 v[92:95], v[44:47], v[144:147], v[92:95]
  ds_read_b128 v[36:39], v249 offset:34816
  v_accvgpr_write_b32 a209, v81
  v_mfma_f32_16x16x32_bf16 v[100:103], v[44:47], v[176:179], v[100:103]
  v_accvgpr_write_b32 a210, v82
  v_accvgpr_write_b32 a211, v83
  v_mfma_f32_16x16x32_bf16 v[108:111], v[44:47], v[208:211], v[108:111]
  v_mfma_f32_16x16x32_bf16 v[116:119], v[44:47], v[240:243], v[116:119]
  s_waitcnt lgkmcnt(5)
  v_mfma_f32_16x16x32_bf16 v[88:91], v[48:51], v[148:151], v[88:91]
  ds_read_b128 v[40:43], v250 offset:32768
  v_mfma_f32_16x16x32_bf16 v[96:99], v[48:51], v[180:183], v[96:99]
  v_mfma_f32_16x16x32_bf16 v[104:107], v[48:51], v[212:215], v[104:107]
  v_mfma_f32_16x16x32_bf16 v[112:115], v[48:51], v[244:247], v[112:115]
  s_waitcnt lgkmcnt(5)
  v_mfma_f32_16x16x32_bf16 v[92:95], v[52:55], v[148:151], v[92:95]
  ds_read_b128 v[44:47], v250 offset:34816
  v_mfma_f32_16x16x32_bf16 v[100:103], v[52:55], v[180:183], v[100:103]
  v_mfma_f32_16x16x32_bf16 v[108:111], v[52:55], v[212:215], v[108:111]
  v_mfma_f32_16x16x32_bf16 v[116:119], v[52:55], v[244:247], v[116:119]
  s_waitcnt lgkmcnt(5)
  s_getpc_b64 s[98:99]
  s_add_u32 s98, s98, 4096
  s_addc_u32 s99, s99, 0
  global_load_dword v7, v6, s[98:99]
  v_mfma_f32_16x16x32_bf16 v[56:59], v[24:27], v[120:123], 0
  ds_read_b128 v[48:51], v251 offset:32768
  v_mfma_f32_16x16x32_bf16 v[64:67], v[24:27], v[152:155], 0
  v_mfma_f32_16x16x32_bf16 v[72:75], v[24:27], v[184:187], 0
  v_mfma_f32_16x16x32_bf16 v[80:83], v[24:27], v[216:219], 0
  s_waitcnt lgkmcnt(5)
  v_mul_f32 v88, v12, v88
  v_mfma_f32_16x16x32_bf16 v[60:63], v[28:31], v[120:123], 0
  ds_read_b128 v[52:55], v251 offset:34816
  v_mul_f32 v89, v12, v89
  v_mfma_f32_16x16x32_bf16 v[68:71], v[28:31], v[152:155], 0
  v_mul_f32 v90, v12, v90
  v_mul_f32 v91, v12, v91
  v_mfma_f32_16x16x32_bf16 v[76:79], v[28:31], v[184:187], 0
  v_mul_f32 v92, v12, v92
  v_mfma_f32_16x16x32_bf16 v[84:87], v[28:31], v[216:219], 0
  s_waitcnt lgkmcnt(5)
  v_mul_f32 v93, v12, v93
  v_mfma_f32_16x16x32_bf16 v[56:59], v[32:35], v[124:127], v[56:59]
  ds_read_b128 v[24:27], v248 offset:33024
  v_mul_f32 v94, v12, v94
  v_mfma_f32_16x16x32_bf16 v[64:67], v[32:35], v[156:159], v[64:67]
  v_mul_f32 v95, v12, v95
  v_cvt_pk_bf16_f32 v88, v88, v89
  v_mfma_f32_16x16x32_bf16 v[72:75], v[32:35], v[188:191], v[72:75]
  v_cvt_pk_bf16_f32 v89, v90, v91
  v_mfma_f32_16x16x32_bf16 v[80:83], v[32:35], v[220:223], v[80:83]
  s_waitcnt lgkmcnt(5)
  v_cvt_pk_bf16_f32 v90, v92, v93
  v_mfma_f32_16x16x32_bf16 v[60:63], v[36:39], v[124:127], v[60:63]
  ds_read_b128 v[28:31], v248 offset:35072
  v_cvt_pk_bf16_f32 v91, v94, v95
  v_mfma_f32_16x16x32_bf16 v[68:71], v[36:39], v[156:159], v[68:71]
  v_accvgpr_write_b32 a44, v88
  v_accvgpr_write_b32 a45, v89
  v_mfma_f32_16x16x32_bf16 v[76:79], v[36:39], v[188:191], v[76:79]
  v_accvgpr_write_b32 a46, v90
  v_mfma_f32_16x16x32_bf16 v[84:87], v[36:39], v[220:223], v[84:87]
  s_waitcnt lgkmcnt(5)
  v_accvgpr_write_b32 a47, v91
  v_mfma_f32_16x16x32_bf16 v[56:59], v[40:43], v[128:131], v[56:59]
  ds_read_b128 v[32:35], v249 offset:33024
  v_mul_f32 v96, v12, v96
  v_mfma_f32_16x16x32_bf16 v[64:67], v[40:43], v[160:163], v[64:67]
  v_mul_f32 v97, v12, v97
  v_mul_f32 v98, v12, v98
  v_mfma_f32_16x16x32_bf16 v[72:75], v[40:43], v[192:195], v[72:75]
  v_mul_f32 v99, v12, v99
  v_mfma_f32_16x16x32_bf16 v[80:83], v[40:43], v[224:227], v[80:83]
  s_waitcnt lgkmcnt(5)
  v_mul_f32 v100, v12, v100
  v_mfma_f32_16x16x32_bf16 v[60:63], v[44:47], v[128:131], v[60:63]
  ds_read_b128 v[36:39], v249 offset:35072
  v_mul_f32 v101, v12, v101
  v_mfma_f32_16x16x32_bf16 v[68:71], v[44:47], v[160:163], v[68:71]
  v_mul_f32 v102, v12, v102
  v_mul_f32 v103, v12, v103
  v_mfma_f32_16x16x32_bf16 v[76:79], v[44:47], v[192:195], v[76:79]
  v_cvt_pk_bf16_f32 v96, v96, v97
  v_mfma_f32_16x16x32_bf16 v[84:87], v[44:47], v[224:227], v[84:87]
  s_waitcnt lgkmcnt(5)
  v_cvt_pk_bf16_f32 v97, v98, v99
  v_mfma_f32_16x16x32_bf16 v[56:59], v[48:51], v[132:135], v[56:59]
  ds_read_b128 v[40:43], v250 offset:33024
  v_cvt_pk_bf16_f32 v98, v100, v101
  v_mfma_f32_16x16x32_bf16 v[64:67], v[48:51], v[164:167], v[64:67]
  v_cvt_pk_bf16_f32 v99, v102, v103
  v_accvgpr_write_b32 a100, v96
  v_mfma_f32_16x16x32_bf16 v[72:75], v[48:51], v[196:199], v[72:75]
  v_accvgpr_write_b32 a101, v97
  v_mfma_f32_16x16x32_bf16 v[80:83], v[48:51], v[228:231], v[80:83]
  s_waitcnt lgkmcnt(5)
  v_accvgpr_write_b32 a102, v98
  v_mfma_f32_16x16x32_bf16 v[60:63], v[52:55], v[132:135], v[60:63]
  ds_read_b128 v[44:47], v250 offset:35072
  v_accvgpr_write_b32 a103, v99
  v_mfma_f32_16x16x32_bf16 v[68:71], v[52:55], v[164:167], v[68:71]
  v_mul_f32 v104, v12, v104
  v_mul_f32 v105, v12, v105
  v_mfma_f32_16x16x32_bf16 v[76:79], v[52:55], v[196:199], v[76:79]
  v_mul_f32 v106, v12, v106
  v_mfma_f32_16x16x32_bf16 v[84:87], v[52:55], v[228:231], v[84:87]
  s_waitcnt lgkmcnt(5)
  v_mul_f32 v107, v12, v107
  v_mfma_f32_16x16x32_bf16 v[56:59], v[24:27], v[136:139], v[56:59]
  ds_read_b128 v[48:51], v251 offset:33024
  v_mul_f32 v108, v12, v108
  v_mfma_f32_16x16x32_bf16 v[64:67], v[24:27], v[168:171], v[64:67]
  v_mul_f32 v109, v12, v109
  v_mul_f32 v110, v12, v110
  v_mfma_f32_16x16x32_bf16 v[72:75], v[24:27], v[200:203], v[72:75]
  v_mul_f32 v111, v12, v111
  v_mfma_f32_16x16x32_bf16 v[80:83], v[24:27], v[232:235], v[80:83]
  s_waitcnt lgkmcnt(5)
  v_cvt_pk_bf16_f32 v104, v104, v105
  v_mfma_f32_16x16x32_bf16 v[60:63], v[28:31], v[136:139], v[60:63]
  ds_read_b128 v[52:55], v251 offset:35072
  v_cvt_pk_bf16_f32 v105, v106, v107
  v_mfma_f32_16x16x32_bf16 v[68:71], v[28:31], v[168:171], v[68:71]
  v_cvt_pk_bf16_f32 v106, v108, v109
  v_cvt_pk_bf16_f32 v107, v110, v111
  v_mfma_f32_16x16x32_bf16 v[76:79], v[28:31], v[200:203], v[76:79]
  v_accvgpr_write_b32 a156, v104
  v_mfma_f32_16x16x32_bf16 v[84:87], v[28:31], v[232:235], v[84:87]
  s_waitcnt lgkmcnt(5)
  v_accvgpr_write_b32 a157, v105
  v_mfma_f32_16x16x32_bf16 v[56:59], v[32:35], v[140:143], v[56:59]
  s_waitcnt vmcnt(0)
  s_barrier
  ds_read_b128 v[24:27], v248 offset:49152
  v_accvgpr_write_b32 a158, v106
  v_mfma_f32_16x16x32_bf16 v[64:67], v[32:35], v[172:175], v[64:67]
  v_accvgpr_write_b32 a159, v107
  v_mul_f32 v112, v12, v112
  v_mfma_f32_16x16x32_bf16 v[72:75], v[32:35], v[204:207], v[72:75]
  v_mul_f32 v113, v12, v113
  v_mfma_f32_16x16x32_bf16 v[80:83], v[32:35], v[236:239], v[80:83]
  s_waitcnt lgkmcnt(5)
  v_mul_f32 v114, v12, v114
  v_mfma_f32_16x16x32_bf16 v[60:63], v[36:39], v[140:143], v[60:63]
  ds_read_b128 v[28:31], v248 offset:51200
  v_mul_f32 v115, v12, v115
  v_mfma_f32_16x16x32_bf16 v[68:71], v[36:39], v[172:175], v[68:71]
  v_mul_f32 v116, v12, v116
  v_mul_f32 v117, v12, v117
  v_mfma_f32_16x16x32_bf16 v[76:79], v[36:39], v[204:207], v[76:79]
  v_mul_f32 v118, v12, v118
  v_mfma_f32_16x16x32_bf16 v[84:87], v[36:39], v[236:239], v[84:87]
  s_waitcnt lgkmcnt(5)
  v_mul_f32 v119, v12, v119
  v_mfma_f32_16x16x32_bf16 v[56:59], v[40:43], v[144:147], v[56:59]
  ds_read_b128 v[32:35], v249 offset:49152
  v_cvt_pk_bf16_f32 v112, v112, v113
  v_mfma_f32_16x16x32_bf16 v[64:67], v[40:43], v[176:179], v[64:67]
  v_cvt_pk_bf16_f32 v113, v114, v115
  v_cvt_pk_bf16_f32 v114, v116, v117
  v_mfma_f32_16x16x32_bf16 v[72:75], v[40:43], v[208:211], v[72:75]
  v_cvt_pk_bf16_f32 v115, v118, v119
  v_mfma_f32_16x16x32_bf16 v[80:83], v[40:43], v[240:243], v[80:83]
  s_waitcnt lgkmcnt(5)
  v_accvgpr_write_b32 a212, v112
  v_mfma_f32_16x16x32_bf16 v[60:63], v[44:47], v[144:147], v[60:63]
  ds_read_b128 v[36:39], v249 offset:51200
  v_accvgpr_write_b32 a213, v113
  v_mfma_f32_16x16x32_bf16 v[68:71], v[44:47], v[176:179], v[68:71]
  v_accvgpr_write_b32 a214, v114
  v_accvgpr_write_b32 a215, v115
  v_mfma_f32_16x16x32_bf16 v[76:79], v[44:47], v[208:211], v[76:79]
  v_mfma_f32_16x16x32_bf16 v[84:87], v[44:47], v[240:243], v[84:87]
  s_waitcnt lgkmcnt(5)
  v_mfma_f32_16x16x32_bf16 v[56:59], v[48:51], v[148:151], v[56:59]
  ds_read_b128 v[40:43], v250 offset:49152
  v_mfma_f32_16x16x32_bf16 v[64:67], v[48:51], v[180:183], v[64:67]
  v_mfma_f32_16x16x32_bf16 v[72:75], v[48:51], v[212:215], v[72:75]
  v_mfma_f32_16x16x32_bf16 v[80:83], v[48:51], v[244:247], v[80:83]
  s_waitcnt lgkmcnt(5)
  v_mfma_f32_16x16x32_bf16 v[60:63], v[52:55], v[148:151], v[60:63]
  ds_read_b128 v[44:47], v250 offset:51200
  v_mfma_f32_16x16x32_bf16 v[68:71], v[52:55], v[180:183], v[68:71]
  v_mfma_f32_16x16x32_bf16 v[76:79], v[52:55], v[212:215], v[76:79]
  v_mfma_f32_16x16x32_bf16 v[84:87], v[52:55], v[244:247], v[84:87]
  s_waitcnt lgkmcnt(5)
  v_mfma_f32_16x16x32_bf16 v[88:91], v[24:27], v[120:123], 0
  ds_read_b128 v[48:51], v251 offset:49152
  v_mfma_f32_16x16x32_bf16 v[96:99], v[24:27], v[152:155], 0
  v_mfma_f32_16x16x32_bf16 v[104:107], v[24:27], v[184:187], 0
  v_readfirstlane_b32 s86, v13
  s_lshl_b32 s22, s17, 7
  s_add_u32 s22, s22, 88521216
  s_mov_b32 s23, 88523264
  buffer_load_dword v13, off, s[8:11], s22 sc1
  buffer_load_dword v5, off, s[8:11], s23 sc1
  buffer_load_dword v9, off, s[12:15], 0 sc1
  v_mfma_f32_16x16x32_bf16 v[112:115], v[24:27], v[216:219], 0
  s_waitcnt lgkmcnt(5)
  v_mul_f32 v56, v12, v56
  v_mfma_f32_16x16x32_bf16 v[92:95], v[28:31], v[120:123], 0
  ds_read_b128 v[52:55], v251 offset:51200
  v_mul_f32 v57, v12, v57
  v_mfma_f32_16x16x32_bf16 v[100:103], v[28:31], v[152:155], 0
  v_mul_f32 v58, v12, v58
  v_mul_f32 v59, v12, v59
  v_mfma_f32_16x16x32_bf16 v[108:111], v[28:31], v[184:187], 0
  v_mul_f32 v60, v12, v60
  v_mfma_f32_16x16x32_bf16 v[116:119], v[28:31], v[216:219], 0
  s_waitcnt lgkmcnt(5)
  v_mul_f32 v61, v12, v61
  v_mfma_f32_16x16x32_bf16 v[88:91], v[32:35], v[124:127], v[88:91]
  ds_read_b128 v[24:27], v248 offset:49408
  v_mul_f32 v62, v12, v62
  v_mfma_f32_16x16x32_bf16 v[96:99], v[32:35], v[156:159], v[96:99]
  v_mul_f32 v63, v12, v63
  v_cvt_pk_bf16_f32 v56, v56, v57
  v_mfma_f32_16x16x32_bf16 v[104:107], v[32:35], v[188:191], v[104:107]
  v_cvt_pk_bf16_f32 v57, v58, v59
  v_mfma_f32_16x16x32_bf16 v[112:115], v[32:35], v[220:223], v[112:115]
  s_waitcnt lgkmcnt(5)
  v_cvt_pk_bf16_f32 v58, v60, v61
  v_mfma_f32_16x16x32_bf16 v[92:95], v[36:39], v[124:127], v[92:95]
  ds_read_b128 v[28:31], v248 offset:51456
  v_cvt_pk_bf16_f32 v59, v62, v63
  v_mfma_f32_16x16x32_bf16 v[100:103], v[36:39], v[156:159], v[100:103]
  v_accvgpr_write_b32 a48, v56
  v_accvgpr_write_b32 a49, v57
  v_mfma_f32_16x16x32_bf16 v[108:111], v[36:39], v[188:191], v[108:111]
  v_accvgpr_write_b32 a50, v58
  v_mfma_f32_16x16x32_bf16 v[116:119], v[36:39], v[220:223], v[116:119]
  s_waitcnt lgkmcnt(5)
  v_accvgpr_write_b32 a51, v59
  v_mfma_f32_16x16x32_bf16 v[88:91], v[40:43], v[128:131], v[88:91]
  ds_read_b128 v[32:35], v249 offset:49408
  v_mul_f32 v64, v12, v64
  v_mfma_f32_16x16x32_bf16 v[96:99], v[40:43], v[160:163], v[96:99]
  v_mul_f32 v65, v12, v65
  v_mul_f32 v66, v12, v66
  v_mfma_f32_16x16x32_bf16 v[104:107], v[40:43], v[192:195], v[104:107]
  v_mul_f32 v67, v12, v67
  v_mfma_f32_16x16x32_bf16 v[112:115], v[40:43], v[224:227], v[112:115]
  s_waitcnt lgkmcnt(5)
  v_mul_f32 v68, v12, v68
  v_mfma_f32_16x16x32_bf16 v[92:95], v[44:47], v[128:131], v[92:95]
  ds_read_b128 v[36:39], v249 offset:51456
  v_mul_f32 v69, v12, v69
  v_mfma_f32_16x16x32_bf16 v[100:103], v[44:47], v[160:163], v[100:103]
  v_mul_f32 v70, v12, v70
  v_mul_f32 v71, v12, v71
  v_mfma_f32_16x16x32_bf16 v[108:111], v[44:47], v[192:195], v[108:111]
  v_cvt_pk_bf16_f32 v64, v64, v65
  v_mfma_f32_16x16x32_bf16 v[116:119], v[44:47], v[224:227], v[116:119]
  s_waitcnt lgkmcnt(5)
  v_cvt_pk_bf16_f32 v65, v66, v67
  v_mfma_f32_16x16x32_bf16 v[88:91], v[48:51], v[132:135], v[88:91]
  ds_read_b128 v[40:43], v250 offset:49408
  v_cvt_pk_bf16_f32 v66, v68, v69
  v_mfma_f32_16x16x32_bf16 v[96:99], v[48:51], v[164:167], v[96:99]
  v_cvt_pk_bf16_f32 v67, v70, v71
  v_accvgpr_write_b32 a104, v64
  v_mfma_f32_16x16x32_bf16 v[104:107], v[48:51], v[196:199], v[104:107]
  v_accvgpr_write_b32 a105, v65
  v_mfma_f32_16x16x32_bf16 v[112:115], v[48:51], v[228:231], v[112:115]
  s_waitcnt lgkmcnt(5)
  v_accvgpr_write_b32 a106, v66
  v_mfma_f32_16x16x32_bf16 v[92:95], v[52:55], v[132:135], v[92:95]
  ds_read_b128 v[44:47], v250 offset:51456
  v_accvgpr_write_b32 a107, v67
  v_mfma_f32_16x16x32_bf16 v[100:103], v[52:55], v[164:167], v[100:103]
  v_mul_f32 v72, v12, v72
  v_mul_f32 v73, v12, v73
  v_mfma_f32_16x16x32_bf16 v[108:111], v[52:55], v[196:199], v[108:111]
  v_mul_f32 v74, v12, v74
  v_mfma_f32_16x16x32_bf16 v[116:119], v[52:55], v[228:231], v[116:119]
  s_waitcnt lgkmcnt(5)
  v_mul_f32 v75, v12, v75
  v_mfma_f32_16x16x32_bf16 v[88:91], v[24:27], v[136:139], v[88:91]
  ds_read_b128 v[48:51], v251 offset:49408
  v_mul_f32 v76, v12, v76
  v_mfma_f32_16x16x32_bf16 v[96:99], v[24:27], v[168:171], v[96:99]
  v_mul_f32 v77, v12, v77
  v_mul_f32 v78, v12, v78
  v_mfma_f32_16x16x32_bf16 v[104:107], v[24:27], v[200:203], v[104:107]
  v_mul_f32 v79, v12, v79
  v_mfma_f32_16x16x32_bf16 v[112:115], v[24:27], v[232:235], v[112:115]
  s_waitcnt lgkmcnt(5)
  v_cvt_pk_bf16_f32 v72, v72, v73
  v_mfma_f32_16x16x32_bf16 v[92:95], v[28:31], v[136:139], v[92:95]
  ds_read_b128 v[52:55], v251 offset:51456
  v_cvt_pk_bf16_f32 v73, v74, v75
  v_mfma_f32_16x16x32_bf16 v[100:103], v[28:31], v[168:171], v[100:103]
  v_cvt_pk_bf16_f32 v74, v76, v77
  v_cvt_pk_bf16_f32 v75, v78, v79
  v_mfma_f32_16x16x32_bf16 v[108:111], v[28:31], v[200:203], v[108:111]
  v_accvgpr_write_b32 a160, v72
  v_mfma_f32_16x16x32_bf16 v[116:119], v[28:31], v[232:235], v[116:119]
  s_waitcnt lgkmcnt(5)
  v_accvgpr_write_b32 a161, v73
  v_mfma_f32_16x16x32_bf16 v[88:91], v[32:35], v[140:143], v[88:91]
  v_accvgpr_write_b32 a162, v74
  v_mfma_f32_16x16x32_bf16 v[96:99], v[32:35], v[172:175], v[96:99]
  v_accvgpr_write_b32 a163, v75
  v_mul_f32 v80, v12, v80
  v_mfma_f32_16x16x32_bf16 v[104:107], v[32:35], v[204:207], v[104:107]
  v_mul_f32 v81, v12, v81
  v_mfma_f32_16x16x32_bf16 v[112:115], v[32:35], v[236:239], v[112:115]
  s_waitcnt lgkmcnt(4)
  v_mul_f32 v82, v12, v82
  v_mfma_f32_16x16x32_bf16 v[92:95], v[36:39], v[140:143], v[92:95]
  v_mul_f32 v83, v12, v83
  v_mfma_f32_16x16x32_bf16 v[100:103], v[36:39], v[172:175], v[100:103]
  v_mul_f32 v84, v12, v84
  v_mul_f32 v85, v12, v85
  v_mfma_f32_16x16x32_bf16 v[108:111], v[36:39], v[204:207], v[108:111]
  v_mul_f32 v86, v12, v86
  v_mfma_f32_16x16x32_bf16 v[116:119], v[36:39], v[236:239], v[116:119]
  s_waitcnt lgkmcnt(3)
  v_mul_f32 v87, v12, v87
  v_mfma_f32_16x16x32_bf16 v[88:91], v[40:43], v[144:147], v[88:91]
  v_cvt_pk_bf16_f32 v80, v80, v81
  v_mfma_f32_16x16x32_bf16 v[96:99], v[40:43], v[176:179], v[96:99]
  v_cvt_pk_bf16_f32 v81, v82, v83
  v_cvt_pk_bf16_f32 v82, v84, v85
  v_mfma_f32_16x16x32_bf16 v[104:107], v[40:43], v[208:211], v[104:107]
  v_cvt_pk_bf16_f32 v83, v86, v87
  v_mfma_f32_16x16x32_bf16 v[112:115], v[40:43], v[240:243], v[112:115]
  s_waitcnt lgkmcnt(2)
  v_accvgpr_write_b32 a216, v80
  v_mfma_f32_16x16x32_bf16 v[92:95], v[44:47], v[144:147], v[92:95]
  v_accvgpr_write_b32 a217, v81
  v_mfma_f32_16x16x32_bf16 v[100:103], v[44:47], v[176:179], v[100:103]
  v_accvgpr_write_b32 a218, v82
  v_accvgpr_write_b32 a219, v83
  v_mfma_f32_16x16x32_bf16 v[108:111], v[44:47], v[208:211], v[108:111]
  v_mfma_f32_16x16x32_bf16 v[116:119], v[44:47], v[240:243], v[116:119]
  s_waitcnt lgkmcnt(1)
  v_mfma_f32_16x16x32_bf16 v[88:91], v[48:51], v[148:151], v[88:91]
  v_mfma_f32_16x16x32_bf16 v[96:99], v[48:51], v[180:183], v[96:99]
  v_mfma_f32_16x16x32_bf16 v[104:107], v[48:51], v[212:215], v[104:107]
  v_mfma_f32_16x16x32_bf16 v[112:115], v[48:51], v[244:247], v[112:115]
  s_waitcnt lgkmcnt(0)
  v_mfma_f32_16x16x32_bf16 v[92:95], v[52:55], v[148:151], v[92:95]
  v_mfma_f32_16x16x32_bf16 v[100:103], v[52:55], v[180:183], v[100:103]
  v_mfma_f32_16x16x32_bf16 v[108:111], v[52:55], v[212:215], v[108:111]
  v_mfma_f32_16x16x32_bf16 v[116:119], v[52:55], v[244:247], v[116:119]
  v_mul_f32 v88, v12, v88
  v_mul_f32 v89, v12, v89
  v_mul_f32 v90, v12, v90
  v_mul_f32 v91, v12, v91
  v_mul_f32 v92, v12, v92
  v_mul_f32 v93, v12, v93
  v_mul_f32 v94, v12, v94
  v_mul_f32 v95, v12, v95
  v_cvt_pk_bf16_f32 v88, v88, v89
  v_cvt_pk_bf16_f32 v89, v90, v91
  v_cvt_pk_bf16_f32 v90, v92, v93
  v_cvt_pk_bf16_f32 v91, v94, v95
  v_accvgpr_write_b32 a52, v88
  v_accvgpr_write_b32 a53, v89
  v_accvgpr_write_b32 a54, v90
  v_accvgpr_write_b32 a55, v91
  v_mul_f32 v96, v12, v96
  v_mul_f32 v97, v12, v97
  v_mul_f32 v98, v12, v98
  v_mul_f32 v99, v12, v99
  v_mul_f32 v100, v12, v100
  v_mul_f32 v101, v12, v101
  v_mul_f32 v102, v12, v102
  v_mul_f32 v103, v12, v103
  v_cvt_pk_bf16_f32 v96, v96, v97
  v_cvt_pk_bf16_f32 v97, v98, v99
  v_cvt_pk_bf16_f32 v98, v100, v101
  v_cvt_pk_bf16_f32 v99, v102, v103
  v_accvgpr_write_b32 a108, v96
  v_accvgpr_write_b32 a109, v97
  v_accvgpr_write_b32 a110, v98
  v_accvgpr_write_b32 a111, v99
  v_mul_f32 v104, v12, v104
  v_mul_f32 v105, v12, v105
  v_mul_f32 v106, v12, v106
  v_mul_f32 v107, v12, v107
  v_mul_f32 v108, v12, v108
  v_mul_f32 v109, v12, v109
  v_mul_f32 v110, v12, v110
  v_mul_f32 v111, v12, v111
  v_cvt_pk_bf16_f32 v104, v104, v105
  v_cvt_pk_bf16_f32 v105, v106, v107
  v_cvt_pk_bf16_f32 v106, v108, v109
  v_cvt_pk_bf16_f32 v107, v110, v111
  v_accvgpr_write_b32 a164, v104
  v_accvgpr_write_b32 a165, v105
  v_accvgpr_write_b32 a166, v106
  v_accvgpr_write_b32 a167, v107
  v_mul_f32 v112, v12, v112
  v_mul_f32 v113, v12, v113
  v_mul_f32 v114, v12, v114
  v_mul_f32 v115, v12, v115
  v_mul_f32 v116, v12, v116
  v_mul_f32 v117, v12, v117
  v_mul_f32 v118, v12, v118
  v_mul_f32 v119, v12, v119
  v_cvt_pk_bf16_f32 v112, v112, v113
  v_cvt_pk_bf16_f32 v113, v114, v115
  v_cvt_pk_bf16_f32 v114, v116, v117
  v_cvt_pk_bf16_f32 v115, v118, v119
  v_accvgpr_write_b32 a220, v112
  v_accvgpr_write_b32 a221, v113
  v_accvgpr_write_b32 a222, v114
  v_accvgpr_write_b32 a223, v115
  s_waitcnt vmcnt(0)
  s_barrier
  v_readfirstlane_b32 s84, v13
  v_readfirstlane_b32 s85, v5
  s_cmp_eq_u32 s86, 1
  s_cselect_b32 s84, s84, 0
  v_and_b32 v10, 0xffe0, v9
  v_cmp_eq_u32 vcc, 0, v10
  s_cbranch_vccz ch_md_ok
ch_role2:
  s_mov_b32 s30, 0
ch_md:
  buffer_load_dword v9, off, s[12:15], 0 sc1
  s_waitcnt vmcnt(0)
  v_and_b32 v10, 0xffe0, v9
  v_cmp_eq_u32 vcc, 0, v10
  s_cbranch_vccz ch_md_ok
  s_sleep 4
  s_add_u32 s30, s30, 1
  s_cmp_lt_u32 s30, 1600000
  s_cbranch_scc1 ch_md
  s_branch ch_end
ch_md_ok:
  v_readfirstlane_b32 s88, v9
  s_lshr_b32 s88, s88, 16
  v_and_b32 v1, 63, v0
  v_lshlrev_b32 v2, 4, v1
  v_lshrrev_b32 v116, 4, v1
  v_and_b32 v117, 15, v1
  v_mov_b32 v3, 0x4444
  v_mov_b32 v118, 0xeeee
  v_cmp_lt_u32 vcc, 7, v117
  s_nop 1
  v_cndmask_b32 v3, v3, v118, vcc
  s_mov_b32 s19, 0
  s_mov_b32 s18, 1
  s_mov_b32 s20, 75694080
  s_mov_b32 s21, 75711744
  s_mov_b32 s23, 75698176
  s_lshr_b32 s89, s17, 4
  s_lshl_b32 s89, s89, 2
  s_add_u32 s89, s89, s16
  s_and_b32 s17, s17, 15
  s_cmp_eq_u32 s89, 0
  s_cbranch_scc1 ch_init0
  s_cmp_eq_u32 s89, 1
  s_cbranch_scc1 ch_init1
  s_cmp_eq_u32 s89, 2
  s_cbranch_scc1 ch_init2
  s_cmp_eq_u32 s89, 3
  s_cbranch_scc1 ch_init3
  s_cmp_eq_u32 s89, 4
  s_cbranch_scc1 ch_init4
  s_cmp_eq_u32 s89, 5
  s_cbranch_scc1 ch_init5
  s_cmp_eq_u32 s89, 6
  s_cbranch_scc1 ch_init6
  s_cmp_eq_u32 s89, 7
  s_cbranch_scc1 ch_init7
  s_branch ch_end
ch_init0:
  s_mul_i32 s31, s17, 401408
  s_add_u32 s31, s31, 0
  s_and_b32 s28, s84, 10320
  s_lshl_b32 s22, s85, 16
  s_or_b32 s28, s28, s22
  s_cmp_eq_u32 s28, 4294912080
  s_cbranch_scc1 ch_wx0_ok
  s_mov_b32 s30, 0
ch_wr0:
  buffer_load_dword v9, off, s[12:15], 0 offset:132 sc1
  s_waitcnt vmcnt(0)
  v_cmp_ne_u32 vcc, 1, v9
  s_cbranch_vccz ch_wr0_ok
  s_sleep 8
  s_add_u32 s30, s30, 1
  s_cmp_lt_u32 s30, 400000
  s_cbranch_scc1 ch_wr0
  s_branch cA_abort
ch_wr0_ok:
  s_lshl_b32 s27, s17, 7
  s_add_u32 s27, s27, 88521216
  s_mov_b32 s28, 10320
  s_mov_b32 s30, 0
ch_wb0:
  buffer_load_dword v9, off, s[8:11], s27  sc1
  s_waitcnt vmcnt(0)
  v_and_b32 v10, s28, v9
  v_cmp_ne_u32 vcc, s28, v10
  s_cbranch_vccz ch_wb0_ok
  s_sleep 3
  s_add_u32 s30, s30, 1
  s_cmp_lt_u32 s30, 400000
  s_cbranch_scc1 ch_wb0
  s_branch cA_abort
ch_wb0_ok:
  s_mov_b32 s29, 88523264
  s_mov_b32 s28, 0xffff
  s_mov_b32 s30, 0
ch_wx0:
  buffer_load_dword v9, off, s[8:11], s29  sc1
  s_waitcnt vmcnt(0)
  v_and_b32 v10, s28, v9
  v_cmp_ne_u32 vcc, s28, v10
  s_cbranch_vccz ch_wx0_ok
  s_sleep 8
  s_add_u32 s30, s30, 1
  s_cmp_lt_u32 s30, 400000
  s_cbranch_scc1 ch_wx0
  s_branch cA_abort
ch_wx0_ok:
  s_add_u32 s22, s31, 229376
  buffer_load_dwordx4 a[224:227], v2, s[8:11], s22 offen offset:0 sc1
  buffer_load_dwordx4 a[228:231], v2, s[8:11], s22 offen offset:1024 sc1
  buffer_load_dwordx4 a[232:235], v2, s[8:11], s22 offen offset:2048 sc1
  buffer_load_dwordx4 a[236:239], v2, s[8:11], s22 offen offset:3072 sc1
  s_add_u32 s22, s31, 233472
  buffer_load_dwordx4 a[240:243], v2, s[8:11], s22 offen offset:0 sc1
  buffer_load_dwordx4 a[244:247], v2, s[8:11], s22 offen offset:1024 sc1
  buffer_load_dwordx4 a[248:251], v2, s[8:11], s22 offen offset:2048 sc1
  buffer_load_dwordx4 a[252:255], v2, s[8:11], s22 offen offset:3072 sc1
  s_add_u32 s22, s31, 237568
  buffer_load_dwordx4 v[120:123], v2, s[8:11], s22 offen offset:0 sc1
  buffer_load_dwordx4 v[124:127], v2, s[8:11], s22 offen offset:1024 sc1
  buffer_load_dwordx4 v[128:131], v2, s[8:11], s22 offen offset:2048 sc1
  buffer_load_dwordx4 v[132:135], v2, s[8:11], s22 offen offset:3072 sc1
  s_add_u32 s22, s31, 241664
  buffer_load_dwordx4 v[136:139], v2, s[8:11], s22 offen offset:0 sc1
  buffer_load_dwordx4 v[140:143], v2, s[8:11], s22 offen offset:1024 sc1
  buffer_load_dwordx4 v[144:147], v2, s[8:11], s22 offen offset:2048 sc1
  buffer_load_dwordx4 v[148:151], v2, s[8:11], s22 offen offset:3072 sc1
  s_add_u32 s22, s31, 245760
  buffer_load_dwordx4 v[152:155], v2, s[8:11], s22 offen offset:0 sc1
  buffer_load_dwordx4 v[156:159], v2, s[8:11], s22 offen offset:1024 sc1
  buffer_load_dwordx4 v[160:163], v2, s[8:11], s22 offen offset:2048 sc1
  buffer_load_dwordx4 v[164:167], v2, s[8:11], s22 offen offset:3072 sc1
  s_add_u32 s22, s31, 249856
  buffer_load_dwordx4 v[168:171], v2, s[8:11], s22 offen offset:0 sc1
  buffer_load_dwordx4 v[172:175], v2, s[8:11], s22 offen offset:1024 sc1
  buffer_load_dwordx4 v[176:179], v2, s[8:11], s22 offen offset:2048 sc1
  buffer_load_dwordx4 v[180:183], v2, s[8:11], s22 offen offset:3072 sc1
  s_mov_b32 s24, 72024064
  s_mov_b32 s26, 72038400
  v_and_b32 v64, 7, v117
  v_and_b32 v65, 1, v116
  v_lshlrev_b32 v65, 2, v65
  v_sub_u32 v64, v64, v65
  v_lshrrev_b32 v65, 3, v117
  v_lshl_add_u32 v66, v65, 2, v64
  v_cmp_gt_u32 vcc, 4, v64
  v_mov_b32 v67, 99
  s_nop 0
  v_cndmask_b32 v66, v67, v66, vcc
  v_mov_b32 v68, 0x3f80
  v_mov_b32 v69, 0x3f800000
  v_mov_b32 v4, 0
  v_cmp_eq_u32 vcc, 0, v66
  s_nop 1
  v_cndmask_b32 v4, v4, v68, vcc
  v_cmp_eq_u32 vcc, 1, v66
  s_nop 1
  v_cndmask_b32 v4, v4, v69, vcc
  v_mov_b32 v5, 0
  v_cmp_eq_u32 vcc, 2, v66
  s_nop 1
  v_cndmask_b32 v5, v5, v68, vcc
  v_cmp_eq_u32 vcc, 3, v66
  s_nop 1
  v_cndmask_b32 v5, v5, v69, vcc
  v_mov_b32 v6, 0
  v_cmp_eq_u32 vcc, 4, v66
  s_nop 1
  v_cndmask_b32 v6, v6, v68, vcc
  v_cmp_eq_u32 vcc, 5, v66
  s_nop 1
  v_cndmask_b32 v6, v6, v69, vcc
  v_mov_b32 v7, 0
  v_cmp_eq_u32 vcc, 6, v66
  s_nop 1
  v_cndmask_b32 v7, v7, v68, vcc
  v_cmp_eq_u32 vcc, 7, v66
  s_nop 1
  v_cndmask_b32 v7, v7, v69, vcc
  v_lshrrev_b32 v64, 1, v116
  v_lshrrev_b32 v65, 3, v117
  v_and_b32 v66, 1, v116
  v_and_b32 v68, 7, v117
  v_lshlrev_b32 v67, 8, v65
  v_lshl_add_u32 v67, v68, 5, v67
  v_lshl_add_u32 v67, v66, 4, v67
  v_add_u32 v69, 4096, v67
  v_add_u32 v70, 6400, v67
  v_cmp_eq_u32 vcc, v64, v65
  s_nop 1
  v_cndmask_b32 v113, v70, v69, vcc
  v_and_b32 v74, 3, v117
  v_lshlrev_b32 v74, 1, v74
  v_bfe_u32 v75, v117, 2, 1
  v_or_b32 v74, v74, v75
  v_and_b32 v75, 8, v117
  v_or_b32 v74, v74, v75
  v_lshlrev_b32 v67, 9, v64
  v_lshl_add_u32 v67, v74, 4, v67
  v_lshl_add_u32 v67, v66, 3, v67
  v_add_u32 v114, 0, v67
  v_mul_u32_u24 v67, 1088, v65
  v_lshl_add_u32 v67, v116, 5, v67
  v_and_b32 v75, 1, v117
  v_and_b32 v76, 2, v117
  v_lshl_add_u32 v75, v76, 1, v75
  v_bfe_u32 v76, v117, 2, 1
  v_lshl_add_u32 v75, v76, 1, v75
  v_lshl_add_u32 v67, v75, 2, v67
  v_add_u32 v115, 4096, v67
  v_and_b32 v69, 1, v74
  v_lshlrev_b32 v67, 7, v69
  v_lshl_add_u32 v67, v116, 4, v67
  v_lshl_add_u32 v67, v65, 8, v67
  v_bfe_u32 v69, v74, 1, 2
  v_lshl_add_u32 v67, v69, 2, v67
  s_lshl_b32 s22, s17, 9
  s_add_u32 s22, s22, 9216
  v_add_u32 v72, s22, v67
  v_bfe_u32 v69, v75, 1, 1
  v_lshlrev_b32 v67, 7, v69
  v_lshl_add_u32 v67, v116, 4, v67
  v_and_b32 v69, 4, v75
  v_add_u32 v67, v67, v69
  s_lshr_b32 s22, s17, 1
  s_lshl_b32 s22, s22, 8
  s_and_b32 s27, s17, 1
  s_lshl_b32 s27, s27, 3
  s_add_u32 s22, s22, s27
  s_add_u32 s22, s22, 7168
  v_add_u32 v67, s22, v67
  v_and_b32 v69, 9, v117
  v_mov_b32 v70, 0x40000000
  v_cmp_eq_u32 vcc, 0, v69
  s_nop 1
  v_cndmask_b32 v118, v70, v67, vcc
  v_mov_b32 v119, -1
  v_and_b32 v0, 15, v1
  s_and_b32 s22, s17, 0
  s_lshl_b32 s22, s22, 7
  s_add_u32 s22, s22, 75731456
  v_lshl_add_u32 v0, v0, 2, s22
  v_xor_b32 v69, 256, v2
  v_mul_i32_i24 v70, -4096, v66
  v_add_u32 v69, v69, v70
  v_add_u32 v117, 12288, v69
  v_mov_b32 v116, v73
  s_mul_i32 s35, s17, 28672
  s_add_u32 s35, s35, 44040192
  v_mov_b32 v1, v72
  v_mov_b32 v36, 0
  v_mov_b32 v37, 0
  v_mov_b32 v38, 0
  v_mov_b32 v39, 0
  v_mov_b32 v40, 0
  v_mov_b32 v41, 0
  v_mov_b32 v42, 0
  v_mov_b32 v43, 0
  v_mov_b32 v44, 0
  v_mov_b32 v45, 0
  v_mov_b32 v46, 0
  v_mov_b32 v47, 0
  v_mov_b32 v48, 0
  v_mov_b32 v49, 0
  v_mov_b32 v50, 0
  v_mov_b32 v51, 0
  v_mov_b32 v52, 0
  v_mov_b32 v53, 0
  v_mov_b32 v54, 0
  v_mov_b32 v55, 0
  v_mov_b32 v56, 0
  v_mov_b32 v57, 0
  v_mov_b32 v58, 0
  v_mov_b32 v59, 0
  v_mov_b32 v60, 0
  v_mov_b32 v61, 0
  v_mov_b32 v62, 0
  v_mov_b32 v63, 0
  v_mov_b32 v64, 0
  v_mov_b32 v65, 0
  v_mov_b32 v66, 0
  v_mov_b32 v67, 0
  v_mov_b32 v68, 0
  v_mov_b32 v69, 0
  v_mov_b32 v70, 0
  v_mov_b32 v71, 0
  v_mov_b32 v72, 0
  v_mov_b32 v73, 0
  v_mov_b32 v74, 0
  v_mov_b32 v75, 0
  v_mov_b32 v76, 0
  v_mov_b32 v77, 0
  v_mov_b32 v78, 0
  v_mov_b32 v79, 0
  s_mov_b32 s22, 75694080
  v_lshrrev_b32 v14, 4, v2
  v_add_u32 v14, 0, v14
  v_min_u32 v14, 308, v14
  v_lshlrev_b32 v14, 7, v14
  buffer_load_dword v15, v14, s[8:11], s22 offen sc1
  v_lshrrev_b32 v14, 4, v2
  v_add_u32 v14, 256, v14
  v_min_u32 v14, 308, v14
  v_lshlrev_b32 v14, 7, v14
  buffer_load_dword v15, v14, s[8:11], s22 offen sc1
  buffer_load_dwordx4 v[80:83], v117, s[8:11], s24 offen offset:0 sc1
  buffer_load_dwordx4 v[84:87], v117, s[8:11], s24 offen offset:1024 sc1
  buffer_load_dwordx4 v[88:91], v117, s[8:11], s26 offen offset:0 sc1
  buffer_load_dwordx4 v[92:95], v117, s[8:11], s26 offen offset:1024 sc1
  buffer_load_dwordx4 v[96:99], v2, s[8:11], s24 offen offset:0 sc1
  buffer_load_dwordx4 v[100:103], v2, s[8:11], s24 offen offset:1024 sc1
  buffer_load_dwordx4 v[104:107], v2, s[8:11], s26 offen offset:0 sc1
  buffer_load_dwordx4 v[108:111], v2, s[8:11], s26 offen offset:1024 sc1
  s_add_u32 s22, s31, 253952
  buffer_load_dwordx4 v[184:187], v2, s[8:11], s22 offen offset:0 sc1
  buffer_load_dwordx4 v[188:191], v2, s[8:11], s22 offen offset:1024 sc1
  buffer_load_dwordx4 v[192:195], v2, s[8:11], s22 offen offset:2048 sc1
  buffer_load_dwordx4 v[196:199], v2, s[8:11], s22 offen offset:3072 sc1
  s_add_u32 s22, s31, 372736
  buffer_load_dwordx4 v[200:203], v2, s[8:11], s22 offen offset:0 sc1
  buffer_load_dwordx4 v[204:207], v2, s[8:11], s22 offen offset:1024 sc1
  buffer_load_dwordx4 v[208:211], v2, s[8:11], s22 offen offset:2048 sc1
  buffer_load_dwordx4 v[212:215], v2, s[8:11], s22 offen offset:3072 sc1
  s_add_u32 s22, s31, 376832
  buffer_load_dwordx4 v[216:219], v2, s[8:11], s22 offen offset:0 sc1
  buffer_load_dwordx4 v[220:223], v2, s[8:11], s22 offen offset:1024 sc1
  buffer_load_dwordx4 v[224:227], v2, s[8:11], s22 offen offset:2048 sc1
  buffer_load_dwordx4 v[228:231], v2, s[8:11], s22 offen offset:3072 sc1
  s_add_u32 s22, s31, 380928
  buffer_load_dwordx4 v[232:235], v2, s[8:11], s22 offen offset:0 sc1
  buffer_load_dwordx4 v[236:239], v2, s[8:11], s22 offen offset:1024 sc1
  buffer_load_dwordx4 v[240:243], v2, s[8:11], s22 offen offset:2048 sc1
  buffer_load_dwordx4 v[244:247], v2, s[8:11], s22 offen offset:3072 sc1
  s_add_u32 s22, s31, 385024
  buffer_load_dwordx4 v[248:251], v2, s[8:11], s22 offen offset:0 sc1
  buffer_load_dwordx4 v[252:255], v2, s[8:11], s22 offen offset:1024 sc1
  s_waitcnt vmcnt(0) lgkmcnt(0)
  s_mov_b32 s31, 0
  s_cmp_lg_u32 s88, 0
  s_cbranch_scc1 cB_sc0_loop
  s_branch cA_sc0_loop
ch_init1:
  s_mul_i32 s31, s17, 401408
  s_add_u32 s31, s31, 0
  s_and_b32 s28, s84, 10320
  s_lshl_b32 s22, s85, 16
  s_or_b32 s28, s28, s22
  s_cmp_eq_u32 s28, 4294912080
  s_cbranch_scc1 ch_wx1_ok
  s_mov_b32 s30, 0
ch_wr1:
  buffer_load_dword v9, off, s[12:15], 0 offset:132 sc1
  s_waitcnt vmcnt(0)
  v_cmp_ne_u32 vcc, 1, v9
  s_cbranch_vccz ch_wr1_ok
  s_sleep 8
  s_add_u32 s30, s30, 1
  s_cmp_lt_u32 s30, 400000
  s_cbranch_scc1 ch_wr1
  s_branch cA_abort
ch_wr1_ok:
  s_lshl_b32 s27, s17, 7
  s_add_u32 s27, s27, 88521216
  s_mov_b32 s28, 10320
  s_mov_b32 s30, 0
ch_wb1:
  buffer_load_dword v9, off, s[8:11], s27  sc1
  s_waitcnt vmcnt(0)
  v_and_b32 v10, s28, v9
  v_cmp_ne_u32 vcc, s28, v10
  s_cbranch_vccz ch_wb1_ok
  s_sleep 3
  s_add_u32 s30, s30, 1
  s_cmp_lt_u32 s30, 400000
  s_cbranch_scc1 ch_wb1
  s_branch cA_abort
ch_wb1_ok:
  s_mov_b32 s29, 88523264
  s_mov_b32 s28, 0xffff
  s_mov_b32 s30, 0
ch_wx1:
  buffer_load_dword v9, off, s[8:11], s29  sc1
  s_waitcnt vmcnt(0)
  v_and_b32 v10, s28, v9
  v_cmp_ne_u32 vcc, s28, v10
  s_cbranch_vccz ch_wx1_ok
  s_sleep 8
  s_add_u32 s30, s30, 1
  s_cmp_lt_u32 s30, 400000
  s_cbranch_scc1 ch_wx1
  s_branch cA_abort
ch_wx1_ok:
  s_add_u32 s22, s31, 258048
  buffer_load_dwordx4 a[224:227], v2, s[8:11], s22 offen offset:0 sc1
  buffer_load_dwordx4 a[228:231], v2, s[8:11], s22 offen offset:1024 sc1
  buffer_load_dwordx4 a[232:235], v2, s[8:11], s22 offen offset:2048 sc1
  buffer_load_dwordx4 a[236:239], v2, s[8:11], s22 offen offset:3072 sc1
  s_add_u32 s22, s31, 262144
  buffer_load_dwordx4 a[240:243], v2, s[8:11], s22 offen offset:0 sc1
  buffer_load_dwordx4 a[244:247], v2, s[8:11], s22 offen offset:1024 sc1
  buffer_load_dwordx4 a[248:251], v2, s[8:11], s22 offen offset:2048 sc1
  buffer_load_dwordx4 a[252:255], v2, s[8:11], s22 offen offset:3072 sc1
  s_add_u32 s22, s31, 266240
  buffer_load_dwordx4 v[120:123], v2, s[8:11], s22 offen offset:0 sc1
  buffer_load_dwordx4 v[124:127], v2, s[8:11], s22 offen offset:1024 sc1
  buffer_load_dwordx4 v[128:131], v2, s[8:11], s22 offen offset:2048 sc1
  buffer_load_dwordx4 v[132:135], v2, s[8:11], s22 offen offset:3072 sc1
  s_add_u32 s22, s31, 270336
  buffer_load_dwordx4 v[136:139], v2, s[8:11], s22 offen offset:0 sc1
  buffer_load_dwordx4 v[140:143], v2, s[8:11], s22 offen offset:1024 sc1
  buffer_load_dwordx4 v[144:147], v2, s[8:11], s22 offen offset:2048 sc1
  buffer_load_dwordx4 v[148:151], v2, s[8:11], s22 offen offset:3072 sc1
  s_add_u32 s22, s31, 274432
  buffer_load_dwordx4 v[152:155], v2, s[8:11], s22 offen offset:0 sc1
  buffer_load_dwordx4 v[156:159], v2, s[8:11], s22 offen offset:1024 sc1
  buffer_load_dwordx4 v[160:163], v2, s[8:11], s22 offen offset:2048 sc1
  buffer_load_dwordx4 v[164:167], v2, s[8:11], s22 offen offset:3072 sc1
  s_add_u32 s22, s31, 278528
  buffer_load_dwordx4 v[168:171], v2, s[8:11], s22 offen offset:0 sc1
  buffer_load_dwordx4 v[172:175], v2, s[8:11], s22 offen offset:1024 sc1
  buffer_load_dwordx4 v[176:179], v2, s[8:11], s22 offen offset:2048 sc1
  buffer_load_dwordx4 v[180:183], v2, s[8:11], s22 offen offset:3072 sc1
  s_mov_b32 s24, 72026112
  s_mov_b32 s26, 72040448
  v_and_b32 v64, 7, v117
  v_and_b32 v65, 1, v116
  v_lshlrev_b32 v65, 2, v65
  v_sub_u32 v64, v64, v65
  v_lshrrev_b32 v65, 3, v117
  v_lshl_add_u32 v66, v65, 2, v64
  v_cmp_gt_u32 vcc, 4, v64
  v_mov_b32 v67, 99
  s_nop 0
  v_cndmask_b32 v66, v67, v66, vcc
  v_mov_b32 v68, 0x3f80
  v_mov_b32 v69, 0x3f800000
  v_mov_b32 v4, 0
  v_cmp_eq_u32 vcc, 0, v66
  s_nop 1
  v_cndmask_b32 v4, v4, v68, vcc
  v_cmp_eq_u32 vcc, 1, v66
  s_nop 1
  v_cndmask_b32 v4, v4, v69, vcc
  v_mov_b32 v5, 0
  v_cmp_eq_u32 vcc, 2, v66
  s_nop 1
  v_cndmask_b32 v5, v5, v68, vcc
  v_cmp_eq_u32 vcc, 3, v66
  s_nop 1
  v_cndmask_b32 v5, v5, v69, vcc
  v_mov_b32 v6, 0
  v_cmp_eq_u32 vcc, 4, v66
  s_nop 1
  v_cndmask_b32 v6, v6, v68, vcc
  v_cmp_eq_u32 vcc, 5, v66
  s_nop 1
  v_cndmask_b32 v6, v6, v69, vcc
  v_mov_b32 v7, 0
  v_cmp_eq_u32 vcc, 6, v66
  s_nop 1
  v_cndmask_b32 v7, v7, v68, vcc
  v_cmp_eq_u32 vcc, 7, v66
  s_nop 1
  v_cndmask_b32 v7, v7, v69, vcc
  v_lshrrev_b32 v64, 1, v116
  v_lshrrev_b32 v65, 3, v117
  v_and_b32 v66, 1, v116
  v_and_b32 v68, 7, v117
  v_lshlrev_b32 v67, 8, v65
  v_lshl_add_u32 v67, v68, 5, v67
  v_lshl_add_u32 v67, v66, 4, v67
  v_add_u32 v69, 4608, v67
  v_add_u32 v70, 6400, v67
  v_cmp_eq_u32 vcc, v64, v65
  s_nop 1
  v_cndmask_b32 v113, v70, v69, vcc
  v_and_b32 v74, 3, v117
  v_lshlrev_b32 v74, 1, v74
  v_bfe_u32 v75, v117, 2, 1
  v_or_b32 v74, v74, v75
  v_and_b32 v75, 8, v117
  v_or_b32 v74, v74, v75
  v_lshlrev_b32 v67, 9, v64
  v_lshl_add_u32 v67, v74, 4, v67
  v_lshl_add_u32 v67, v66, 3, v67
  v_add_u32 v114, 256, v67
  v_mul_u32_u24 v67, 1088, v65
  v_lshl_add_u32 v67, v116, 5, v67
  v_and_b32 v75, 1, v117
  v_and_b32 v76, 2, v117
  v_lshl_add_u32 v75, v76, 1, v75
  v_bfe_u32 v76, v117, 2, 1
  v_lshl_add_u32 v75, v76, 1, v75
  v_lshl_add_u32 v67, v75, 2, v67
  v_add_u32 v115, 4224, v67
  v_and_b32 v69, 1, v74
  v_lshlrev_b32 v67, 7, v69
  v_lshl_add_u32 v67, v116, 4, v67
  v_lshl_add_u32 v67, v65, 8, v67
  v_bfe_u32 v69, v74, 1, 2
  v_lshl_add_u32 v67, v69, 2, v67
  s_lshl_b32 s22, s17, 9
  s_add_u32 s22, s22, 9280
  v_add_u32 v72, s22, v67
  v_bfe_u32 v69, v75, 1, 1
  v_lshlrev_b32 v67, 7, v69
  v_lshl_add_u32 v67, v116, 4, v67
  v_and_b32 v69, 4, v75
  v_add_u32 v67, v67, v69
  s_lshr_b32 s22, s17, 1
  s_lshl_b32 s22, s22, 8
  s_and_b32 s27, s17, 1
  s_lshl_b32 s27, s27, 3
  s_add_u32 s22, s22, s27
  s_add_u32 s22, s22, 7232
  v_add_u32 v67, s22, v67
  v_and_b32 v69, 9, v117
  v_mov_b32 v70, 0x40000000
  v_cmp_eq_u32 vcc, 0, v69
  s_nop 1
  v_cndmask_b32 v118, v70, v67, vcc
  v_mov_b32 v119, -1
  s_lshl_b32 s22, s17, 2
  s_add_u32 s22, s22, 75729408
  v_lshl_add_u32 v67, v1, 7, s22
  v_mov_b32 v70, 0x40000000
  v_cmp_gt_u32 vcc, 1, v1
  s_nop 1
  v_cndmask_b32 v73, v70, v67, vcc
  v_mov_b32 v112, 1
  v_and_b32 v0, 15, v1
  s_and_b32 s22, s17, 0
  s_lshl_b32 s22, s22, 7
  s_add_u32 s22, s22, 75731456
  v_lshl_add_u32 v0, v0, 2, s22
  v_xor_b32 v69, 256, v2
  v_mul_i32_i24 v70, 4096, v66
  v_add_u32 v69, v69, v70
  v_add_u32 v117, 6144, v69
  v_mov_b32 v116, v73
  s_mul_i32 s35, s17, 28672
  s_add_u32 s35, s35, 44040192
  v_mov_b32 v1, v72
  v_mov_b32 v36, 0
  v_mov_b32 v37, 0
  v_mov_b32 v38, 0
  v_mov_b32 v39, 0
  v_mov_b32 v40, 0
  v_mov_b32 v41, 0
  v_mov_b32 v42, 0
  v_mov_b32 v43, 0
  v_mov_b32 v44, 0
  v_mov_b32 v45, 0
  v_mov_b32 v46, 0
  v_mov_b32 v47, 0
  v_mov_b32 v48, 0
  v_mov_b32 v49, 0
  v_mov_b32 v50, 0
  v_mov_b32 v51, 0
  v_mov_b32 v52, 0
  v_mov_b32 v53, 0
  v_mov_b32 v54, 0
  v_mov_b32 v55, 0
  v_mov_b32 v56, 0
  v_mov_b32 v57, 0
  v_mov_b32 v58, 0
  v_mov_b32 v59, 0
  v_mov_b32 v60, 0
  v_mov_b32 v61, 0
  v_mov_b32 v62, 0
  v_mov_b32 v63, 0
  v_mov_b32 v64, 0
  v_mov_b32 v65, 0
  v_mov_b32 v66, 0
  v_mov_b32 v67, 0
  v_mov_b32 v68, 0
  v_mov_b32 v69, 0
  v_mov_b32 v70, 0
  v_mov_b32 v71, 0
  v_mov_b32 v72, 0
  v_mov_b32 v73, 0
  v_mov_b32 v74, 0
  v_mov_b32 v75, 0
  v_mov_b32 v76, 0
  v_mov_b32 v77, 0
  v_mov_b32 v78, 0
  v_mov_b32 v79, 0
  s_mov_b32 s22, 75694080
  v_lshrrev_b32 v14, 4, v2
  v_add_u32 v14, 64, v14
  v_min_u32 v14, 308, v14
  v_lshlrev_b32 v14, 7, v14
  buffer_load_dword v15, v14, s[8:11], s22 offen sc1
  buffer_load_dwordx4 v[80:83], v117, s[8:11], s24 offen offset:0 sc1
  buffer_load_dwordx4 v[84:87], v117, s[8:11], s24 offen offset:1024 sc1
  buffer_load_dwordx4 v[88:91], v117, s[8:11], s26 offen offset:0 sc1
  buffer_load_dwordx4 v[92:95], v117, s[8:11], s26 offen offset:1024 sc1
  buffer_load_dwordx4 v[96:99], v2, s[8:11], s24 offen offset:0 sc1
  buffer_load_dwordx4 v[100:103], v2, s[8:11], s24 offen offset:1024 sc1
  buffer_load_dwordx4 v[104:107], v2, s[8:11], s26 offen offset:0 sc1
  buffer_load_dwordx4 v[108:111], v2, s[8:11], s26 offen offset:1024 sc1
  s_add_u32 s22, s31, 282624
  buffer_load_dwordx4 v[184:187], v2, s[8:11], s22 offen offset:0 sc1
  buffer_load_dwordx4 v[188:191], v2, s[8:11], s22 offen offset:1024 sc1
  buffer_load_dwordx4 v[192:195], v2, s[8:11], s22 offen offset:2048 sc1
  buffer_load_dwordx4 v[196:199], v2, s[8:11], s22 offen offset:3072 sc1
  s_add_u32 s22, s31, 344064
  buffer_load_dwordx4 v[200:203], v2, s[8:11], s22 offen offset:0 sc1
  buffer_load_dwordx4 v[204:207], v2, s[8:11], s22 offen offset:1024 sc1
  buffer_load_dwordx4 v[208:211], v2, s[8:11], s22 offen offset:2048 sc1
  buffer_load_dwordx4 v[212:215], v2, s[8:11], s22 offen offset:3072 sc1
  s_add_u32 s22, s31, 348160
  buffer_load_dwordx4 v[216:219], v2, s[8:11], s22 offen offset:0 sc1
  buffer_load_dwordx4 v[220:223], v2, s[8:11], s22 offen offset:1024 sc1
  buffer_load_dwordx4 v[224:227], v2, s[8:11], s22 offen offset:2048 sc1
  buffer_load_dwordx4 v[228:231], v2, s[8:11], s22 offen offset:3072 sc1
  s_add_u32 s22, s31, 352256
  buffer_load_dwordx4 v[232:235], v2, s[8:11], s22 offen offset:0 sc1
  buffer_load_dwordx4 v[236:239], v2, s[8:11], s22 offen offset:1024 sc1
  buffer_load_dwordx4 v[240:243], v2, s[8:11], s22 offen offset:2048 sc1
  buffer_load_dwordx4 v[244:247], v2, s[8:11], s22 offen offset:3072 sc1
  s_add_u32 s22, s31, 356352
  buffer_load_dwordx4 v[248:251], v2, s[8:11], s22 offen offset:0 sc1
  buffer_load_dwordx4 v[252:255], v2, s[8:11], s22 offen offset:1024 sc1
  s_waitcnt vmcnt(0) lgkmcnt(0)
  s_mov_b32 s31, 0
  s_cmp_lg_u32 s88, 0
  s_cbranch_scc1 cB_sc1_loop
  s_branch cA_sc1_loop
ch_init2:
  s_mul_i32 s31, s17, 401408
  s_add_u32 s31, s31, 0
  s_and_b32 s28, s84, 12384
  s_lshl_b32 s22, s85, 16
  s_or_b32 s28, s28, s22
  s_cmp_eq_u32 s28, 4294914144
  s_cbranch_scc1 ch_wx2_ok
  s_mov_b32 s30, 0
ch_wr2:
  buffer_load_dword v9, off, s[12:15], 0 offset:132 sc1
  s_waitcnt vmcnt(0)
  v_cmp_ne_u32 vcc, 1, v9
  s_cbranch_vccz ch_wr2_ok
  s_sleep 8
  s_add_u32 s30, s30, 1
  s_cmp_lt_u32 s30, 400000
  s_cbranch_scc1 ch_wr2
  s_branch cA_abort
ch_wr2_ok:
  s_lshl_b32 s27, s17, 7
  s_add_u32 s27, s27, 88521216
  s_mov_b32 s28, 12384
  s_mov_b32 s30, 0
ch_wb2:
  buffer_load_dword v9, off, s[8:11], s27  sc1
  s_waitcnt vmcnt(0)
  v_and_b32 v10, s28, v9
  v_cmp_ne_u32 vcc, s28, v10
  s_cbranch_vccz ch_wb2_ok
  s_sleep 3
  s_add_u32 s30, s30, 1
  s_cmp_lt_u32 s30, 400000
  s_cbranch_scc1 ch_wb2
  s_branch cA_abort
ch_wb2_ok:
  s_mov_b32 s29, 88523264
  s_mov_b32 s28, 0xffff
  s_mov_b32 s30, 0
ch_wx2:
  buffer_load_dword v9, off, s[8:11], s29  sc1
  s_waitcnt vmcnt(0)
  v_and_b32 v10, s28, v9
  v_cmp_ne_u32 vcc, s28, v10
  s_cbranch_vccz ch_wx2_ok
  s_sleep 8
  s_add_u32 s30, s30, 1
  s_cmp_lt_u32 s30, 400000
  s_cbranch_scc1 ch_wx2
  s_branch cA_abort
ch_wx2_ok:
  s_add_u32 s22, s31, 286720
  buffer_load_dwordx4 a[224:227], v2, s[8:11], s22 offen offset:0 sc1
  buffer_load_dwordx4 a[228:231], v2, s[8:11], s22 offen offset:1024 sc1
  buffer_load_dwordx4 a[232:235], v2, s[8:11], s22 offen offset:2048 sc1
  buffer_load_dwordx4 a[236:239], v2, s[8:11], s22 offen offset:3072 sc1
  s_add_u32 s22, s31, 290816
  buffer_load_dwordx4 a[240:243], v2, s[8:11], s22 offen offset:0 sc1
  buffer_load_dwordx4 a[244:247], v2, s[8:11], s22 offen offset:1024 sc1
  buffer_load_dwordx4 a[248:251], v2, s[8:11], s22 offen offset:2048 sc1
  buffer_load_dwordx4 a[252:255], v2, s[8:11], s22 offen offset:3072 sc1
  s_add_u32 s22, s31, 294912
  buffer_load_dwordx4 v[120:123], v2, s[8:11], s22 offen offset:0 sc1
  buffer_load_dwordx4 v[124:127], v2, s[8:11], s22 offen offset:1024 sc1
  buffer_load_dwordx4 v[128:131], v2, s[8:11], s22 offen offset:2048 sc1
  buffer_load_dwordx4 v[132:135], v2, s[8:11], s22 offen offset:3072 sc1
  s_add_u32 s22, s31, 299008
  buffer_load_dwordx4 v[136:139], v2, s[8:11], s22 offen offset:0 sc1
  buffer_load_dwordx4 v[140:143], v2, s[8:11], s22 offen offset:1024 sc1
  buffer_load_dwordx4 v[144:147], v2, s[8:11], s22 offen offset:2048 sc1
  buffer_load_dwordx4 v[148:151], v2, s[8:11], s22 offen offset:3072 sc1
  s_add_u32 s22, s31, 303104
  buffer_load_dwordx4 v[152:155], v2, s[8:11], s22 offen offset:0 sc1
  buffer_load_dwordx4 v[156:159], v2, s[8:11], s22 offen offset:1024 sc1
  buffer_load_dwordx4 v[160:163], v2, s[8:11], s22 offen offset:2048 sc1
  buffer_load_dwordx4 v[164:167], v2, s[8:11], s22 offen offset:3072 sc1
  s_add_u32 s22, s31, 307200
  buffer_load_dwordx4 v[168:171], v2, s[8:11], s22 offen offset:0 sc1
  buffer_load_dwordx4 v[172:175], v2, s[8:11], s22 offen offset:1024 sc1
  buffer_load_dwordx4 v[176:179], v2, s[8:11], s22 offen offset:2048 sc1
  buffer_load_dwordx4 v[180:183], v2, s[8:11], s22 offen offset:3072 sc1
  s_mov_b32 s24, 72028160
  s_mov_b32 s26, 72042496
  v_and_b32 v64, 7, v117
  v_and_b32 v65, 1, v116
  v_lshlrev_b32 v65, 2, v65
  v_sub_u32 v64, v64, v65
  v_lshrrev_b32 v65, 3, v117
  v_lshl_add_u32 v66, v65, 2, v64
  v_cmp_gt_u32 vcc, 4, v64
  v_mov_b32 v67, 99
  s_nop 0
  v_cndmask_b32 v66, v67, v66, vcc
  v_mov_b32 v68, 0x3f80
  v_mov_b32 v69, 0x3f800000
  v_mov_b32 v4, 0
  v_cmp_eq_u32 vcc, 0, v66
  s_nop 1
  v_cndmask_b32 v4, v4, v68, vcc
  v_cmp_eq_u32 vcc, 1, v66
  s_nop 1
  v_cndmask_b32 v4, v4, v69, vcc
  v_mov_b32 v5, 0
  v_cmp_eq_u32 vcc, 2, v66
  s_nop 1
  v_cndmask_b32 v5, v5, v68, vcc
  v_cmp_eq_u32 vcc, 3, v66
  s_nop 1
  v_cndmask_b32 v5, v5, v69, vcc
  v_mov_b32 v6, 0
  v_cmp_eq_u32 vcc, 4, v66
  s_nop 1
  v_cndmask_b32 v6, v6, v68, vcc
  v_cmp_eq_u32 vcc, 5, v66
  s_nop 1
  v_cndmask_b32 v6, v6, v69, vcc
  v_mov_b32 v7, 0
  v_cmp_eq_u32 vcc, 6, v66
  s_nop 1
  v_cndmask_b32 v7, v7, v68, vcc
  v_cmp_eq_u32 vcc, 7, v66
  s_nop 1
  v_cndmask_b32 v7, v7, v69, vcc
  v_lshrrev_b32 v64, 1, v116
  v_lshrrev_b32 v65, 3, v117
  v_and_b32 v66, 1, v116
  v_and_b32 v68, 7, v117
  v_lshlrev_b32 v67, 8, v65
  v_lshl_add_u32 v67, v68, 5, v67
  v_lshl_add_u32 v67, v66, 4, v67
  v_add_u32 v69, 5184, v67
  v_add_u32 v70, 6400, v67
  v_cmp_eq_u32 vcc, v64, v65
  s_nop 1
  v_cndmask_b32 v113, v70, v69, vcc
  s_lshl_b32 s22, s17, 9
  s_add_u32 s22, s22, 9216
  v_lshl_add_u32 v114, v1, 3, s22
  s_lshr_b32 s22, s17, 1
  s_lshl_b32 s22, s22, 8
  s_and_b32 s27, s17, 1
  s_lshl_b32 s27, s27, 3
  s_add_u32 s22, s22, s27
  s_add_u32 s22, s22, 7168
  v_add_u32 v115, s22, v2
  v_mov_b32 v70, 0x40000000
  v_cmp_gt_u32 vcc, 16, v1
  s_nop 1
  v_cndmask_b32 v115, v70, v115, vcc
  v_mov_b32 v118, -1
  v_mov_b32 v119, -1
  v_and_b32 v0, 15, v1
  s_and_b32 s22, s17, 0
  s_lshl_b32 s22, s22, 7
  s_add_u32 s22, s22, 75731456
  v_lshl_add_u32 v0, v0, 2, s22
  v_xor_b32 v69, 256, v2
  v_mul_i32_i24 v70, -2048, v66
  v_add_u32 v69, v69, v70
  v_add_u32 v117, 8192, v69
  v_mov_b32 v116, v73
  s_mul_i32 s35, s17, 28672
  s_add_u32 s35, s35, 44040192
  v_mov_b32 v36, 0
  v_mov_b32 v37, 0
  v_mov_b32 v38, 0
  v_mov_b32 v39, 0
  v_mov_b32 v40, 0
  v_mov_b32 v41, 0
  v_mov_b32 v42, 0
  v_mov_b32 v43, 0
  v_mov_b32 v44, 0
  v_mov_b32 v45, 0
  v_mov_b32 v46, 0
  v_mov_b32 v47, 0
  v_mov_b32 v48, 0
  v_mov_b32 v49, 0
  v_mov_b32 v50, 0
  v_mov_b32 v51, 0
  v_mov_b32 v52, 0
  v_mov_b32 v53, 0
  v_mov_b32 v54, 0
  v_mov_b32 v55, 0
  v_mov_b32 v56, 0
  v_mov_b32 v57, 0
  v_mov_b32 v58, 0
  v_mov_b32 v59, 0
  v_mov_b32 v60, 0
  v_mov_b32 v61, 0
  v_mov_b32 v62, 0
  v_mov_b32 v63, 0
  v_mov_b32 v64, 0
  v_mov_b32 v65, 0
  v_mov_b32 v66, 0
  v_mov_b32 v67, 0
  v_mov_b32 v68, 0
  v_mov_b32 v69, 0
  v_mov_b32 v70, 0
  v_mov_b32 v71, 0
  v_mov_b32 v72, 0
  v_mov_b32 v73, 0
  v_mov_b32 v74, 0
  v_mov_b32 v75, 0
  v_mov_b32 v76, 0
  v_mov_b32 v77, 0
  v_mov_b32 v78, 0
  v_mov_b32 v79, 0
  s_mov_b32 s22, 75694080
  v_lshrrev_b32 v14, 4, v2
  v_add_u32 v14, 128, v14
  v_min_u32 v14, 308, v14
  v_lshlrev_b32 v14, 7, v14
  buffer_load_dword v15, v14, s[8:11], s22 offen sc1
  buffer_load_dwordx4 v[80:83], v117, s[8:11], s24 offen offset:0 sc1
  buffer_load_dwordx4 v[84:87], v117, s[8:11], s24 offen offset:1024 sc1
  buffer_load_dwordx4 v[88:91], v117, s[8:11], s26 offen offset:0 sc1
  buffer_load_dwordx4 v[92:95], v117, s[8:11], s26 offen offset:1024 sc1
  buffer_load_dwordx4 v[96:99], v2, s[8:11], s24 offen offset:0 sc1
  buffer_load_dwordx4 v[100:103], v2, s[8:11], s24 offen offset:1024 sc1
  buffer_load_dwordx4 v[104:107], v2, s[8:11], s26 offen offset:0 sc1
  buffer_load_dwordx4 v[108:111], v2, s[8:11], s26 offen offset:1024 sc1
  s_add_u32 s22, s31, 311296
  buffer_load_dwordx4 v[184:187], v2, s[8:11], s22 offen offset:0 sc1
  buffer_load_dwordx4 v[188:191], v2, s[8:11], s22 offen offset:1024 sc1
  buffer_load_dwordx4 v[192:195], v2, s[8:11], s22 offen offset:2048 sc1
  buffer_load_dwordx4 v[196:199], v2, s[8:11], s22 offen offset:3072 sc1
  s_add_u32 s22, s31, 385024
  buffer_load_dwordx4 v[200:203], v2, s[8:11], s22 offen offset:2048 sc1
  buffer_load_dwordx4 v[204:207], v2, s[8:11], s22 offen offset:3072 sc1
  s_add_u32 s22, s31, 389120
  buffer_load_dwordx4 v[208:211], v2, s[8:11], s22 offen offset:0 sc1
  buffer_load_dwordx4 v[212:215], v2, s[8:11], s22 offen offset:1024 sc1
  buffer_load_dwordx4 v[216:219], v2, s[8:11], s22 offen offset:2048 sc1
  buffer_load_dwordx4 v[220:223], v2, s[8:11], s22 offen offset:3072 sc1
  s_add_u32 s22, s31, 393216
  buffer_load_dwordx4 v[224:227], v2, s[8:11], s22 offen offset:0 sc1
  buffer_load_dwordx4 v[228:231], v2, s[8:11], s22 offen offset:1024 sc1
  buffer_load_dwordx4 v[232:235], v2, s[8:11], s22 offen offset:2048 sc1
  buffer_load_dwordx4 v[236:239], v2, s[8:11], s22 offen offset:3072 sc1
  s_add_u32 s22, s31, 397312
  buffer_load_dwordx4 v[240:243], v2, s[8:11], s22 offen offset:0 sc1
  buffer_load_dwordx4 v[244:247], v2, s[8:11], s22 offen offset:1024 sc1
  buffer_load_dwordx4 v[248:251], v2, s[8:11], s22 offen offset:2048 sc1
  buffer_load_dwordx4 v[252:255], v2, s[8:11], s22 offen offset:3072 sc1
  s_waitcnt vmcnt(0) lgkmcnt(0)
  s_mov_b32 s31, 0
  s_cmp_lg_u32 s88, 0
  s_cbranch_scc1 cB_sc2_loop
  s_branch cA_sc2_loop
ch_init3:
  s_mul_i32 s31, s17, 401408
  s_add_u32 s31, s31, 0
  s_and_b32 s28, s84, 12384
  s_lshl_b32 s22, s85, 16
  s_or_b32 s28, s28, s22
  s_cmp_eq_u32 s28, 4294914144
  s_cbranch_scc1 ch_wx3_ok
  s_mov_b32 s30, 0
ch_wr3:
  buffer_load_dword v9, off, s[12:15], 0 offset:132 sc1
  s_waitcnt vmcnt(0)
  v_cmp_ne_u32 vcc, 1, v9
  s_cbranch_vccz ch_wr3_ok
  s_sleep 8
  s_add_u32 s30, s30, 1
  s_cmp_lt_u32 s30, 400000
  s_cbranch_scc1 ch_wr3
  s_branch cA_abort
ch_wr3_ok:
  s_lshl_b32 s27, s17, 7
  s_add_u32 s27, s27, 88521216
  s_mov_b32 s28, 12384
  s_mov_b32 s30, 0
ch_wb3:
  buffer_load_dword v9, off, s[8:11], s27  sc1
  s_waitcnt vmcnt(0)
  v_and_b32 v10, s28, v9
  v_cmp_ne_u32 vcc, s28, v10
  s_cbranch_vccz ch_wb3_ok
  s_sleep 3
  s_add_u32 s30, s30, 1
  s_cmp_lt_u32 s30, 400000
  s_cbranch_scc1 ch_wb3
  s_branch cA_abort
ch_wb3_ok:
  s_mov_b32 s29, 88523264
  s_mov_b32 s28, 0xffff
  s_mov_b32 s30, 0
ch_wx3:
  buffer_load_dword v9, off, s[8:11], s29  sc1
  s_waitcnt vmcnt(0)
  v_and_b32 v10, s28, v9
  v_cmp_ne_u32 vcc, s28, v10
  s_cbranch_vccz ch_wx3_ok
  s_sleep 8
  s_add_u32 s30, s30, 1
  s_cmp_lt_u32 s30, 400000
  s_cbranch_scc1 ch_wx3
  s_branch cA_abort
ch_wx3_ok:
  s_add_u32 s22, s31, 315392
  buffer_load_dwordx4 a[224:227], v2, s[8:11], s22 offen offset:0 sc1
  buffer_load_dwordx4 a[228:231], v2, s[8:11], s22 offen offset:1024 sc1
  buffer_load_dwordx4 a[232:235], v2, s[8:11], s22 offen offset:2048 sc1
  buffer_load_dwordx4 a[236:239], v2, s[8:11], s22 offen offset:3072 sc1
  s_add_u32 s22, s31, 319488
  buffer_load_dwordx4 a[240:243], v2, s[8:11], s22 offen offset:0 sc1
  buffer_load_dwordx4 a[244:247], v2, s[8:11], s22 offen offset:1024 sc1
  buffer_load_dwordx4 a[248:251], v2, s[8:11], s22 offen offset:2048 sc1
  buffer_load_dwordx4 a[252:255], v2, s[8:11], s22 offen offset:3072 sc1
  s_add_u32 s22, s31, 323584
  buffer_load_dwordx4 v[120:123], v2, s[8:11], s22 offen offset:0 sc1
  buffer_load_dwordx4 v[124:127], v2, s[8:11], s22 offen offset:1024 sc1
  buffer_load_dwordx4 v[128:131], v2, s[8:11], s22 offen offset:2048 sc1
  buffer_load_dwordx4 v[132:135], v2, s[8:11], s22 offen offset:3072 sc1
  s_add_u32 s22, s31, 327680
  buffer_load_dwordx4 v[136:139], v2, s[8:11], s22 offen offset:0 sc1
  buffer_load_dwordx4 v[140:143], v2, s[8:11], s22 offen offset:1024 sc1
  buffer_load_dwordx4 v[144:147], v2, s[8:11], s22 offen offset:2048 sc1
  buffer_load_dwordx4 v[148:151], v2, s[8:11], s22 offen offset:3072 sc1
  s_add_u32 s22, s31, 331776
  buffer_load_dwordx4 v[152:155], v2, s[8:11], s22 offen offset:0 sc1
  buffer_load_dwordx4 v[156:159], v2, s[8:11], s22 offen offset:1024 sc1
  buffer_load_dwordx4 v[160:163], v2, s[8:11], s22 offen offset:2048 sc1
  buffer_load_dwordx4 v[164:167], v2, s[8:11], s22 offen offset:3072 sc1
  s_add_u32 s22, s31, 335872
  buffer_load_dwordx4 v[168:171], v2, s[8:11], s22 offen offset:0 sc1
  buffer_load_dwordx4 v[172:175], v2, s[8:11], s22 offen offset:1024 sc1
  buffer_load_dwordx4 v[176:179], v2, s[8:11], s22 offen offset:2048 sc1
  buffer_load_dwordx4 v[180:183], v2, s[8:11], s22 offen offset:3072 sc1
  s_mov_b32 s24, 72030208
  s_mov_b32 s26, 72044544
  v_and_b32 v64, 7, v117
  v_and_b32 v65, 1, v116
  v_lshlrev_b32 v65, 2, v65
  v_sub_u32 v64, v64, v65
  v_lshrrev_b32 v65, 3, v117
  v_lshl_add_u32 v66, v65, 2, v64
  v_cmp_gt_u32 vcc, 4, v64
  v_mov_b32 v67, 99
  s_nop 0
  v_cndmask_b32 v66, v67, v66, vcc
  v_mov_b32 v68, 0x3f80
  v_mov_b32 v69, 0x3f800000
  v_mov_b32 v4, 0
  v_cmp_eq_u32 vcc, 0, v66
  s_nop 1
  v_cndmask_b32 v4, v4, v68, vcc
  v_cmp_eq_u32 vcc, 1, v66
  s_nop 1
  v_cndmask_b32 v4, v4, v69, vcc
  v_mov_b32 v5, 0
  v_cmp_eq_u32 vcc, 2, v66
  s_nop 1
  v_cndmask_b32 v5, v5, v68, vcc
  v_cmp_eq_u32 vcc, 3, v66
  s_nop 1
  v_cndmask_b32 v5, v5, v69, vcc
  v_mov_b32 v6, 0
  v_cmp_eq_u32 vcc, 4, v66
  s_nop 1
  v_cndmask_b32 v6, v6, v68, vcc
  v_cmp_eq_u32 vcc, 5, v66
  s_nop 1
  v_cndmask_b32 v6, v6, v69, vcc
  v_mov_b32 v7, 0
  v_cmp_eq_u32 vcc, 6, v66
  s_nop 1
  v_cndmask_b32 v7, v7, v68, vcc
  v_cmp_eq_u32 vcc, 7, v66
  s_nop 1
  v_cndmask_b32 v7, v7, v69, vcc
  v_lshrrev_b32 v64, 1, v116
  v_lshrrev_b32 v65, 3, v117
  v_and_b32 v66, 1, v116
  v_and_b32 v68, 7, v117
  v_lshlrev_b32 v67, 8, v65
  v_lshl_add_u32 v67, v68, 5, v67
  v_lshl_add_u32 v67, v66, 4, v67
  v_add_u32 v69, 5696, v67
  v_add_u32 v70, 6400, v67
  v_cmp_eq_u32 vcc, v64, v65
  s_nop 1
  v_cndmask_b32 v113, v70, v69, vcc
  v_and_b32 v0, 15, v1
  s_and_b32 s22, s17, 0
  s_lshl_b32 s22, s22, 7
  s_add_u32 s22, s22, 75731456
  v_lshl_add_u32 v0, v0, 2, s22
  v_xor_b32 v69, 256, v2
  v_mul_i32_i24 v70, 2048, v66
  v_add_u32 v69, v69, v70
  v_add_u32 v117, 4096, v69
  v_mov_b32 v116, v73
  s_mul_i32 s35, s17, 28672
  s_add_u32 s35, s35, 44040192
  v_mov_b32 v36, 0
  v_mov_b32 v37, 0
  v_mov_b32 v38, 0
  v_mov_b32 v39, 0
  v_mov_b32 v40, 0
  v_mov_b32 v41, 0
  v_mov_b32 v42, 0
  v_mov_b32 v43, 0
  v_mov_b32 v44, 0
  v_mov_b32 v45, 0
  v_mov_b32 v46, 0
  v_mov_b32 v47, 0
  v_mov_b32 v48, 0
  v_mov_b32 v49, 0
  v_mov_b32 v50, 0
  v_mov_b32 v51, 0
  v_mov_b32 v52, 0
  v_mov_b32 v53, 0
  v_mov_b32 v54, 0
  v_mov_b32 v55, 0
  v_mov_b32 v56, 0
  v_mov_b32 v57, 0
  v_mov_b32 v58, 0
  v_mov_b32 v59, 0
  v_mov_b32 v60, 0
  v_mov_b32 v61, 0
  v_mov_b32 v62, 0
  v_mov_b32 v63, 0
  v_mov_b32 v64, 0
  v_mov_b32 v65, 0
  v_mov_b32 v66, 0
  v_mov_b32 v67, 0
  v_mov_b32 v68, 0
  v_mov_b32 v69, 0
  v_mov_b32 v70, 0
  v_mov_b32 v71, 0
  v_mov_b32 v72, 0
  v_mov_b32 v73, 0
  v_mov_b32 v74, 0
  v_mov_b32 v75, 0
  v_mov_b32 v76, 0
  v_mov_b32 v77, 0
  v_mov_b32 v78, 0
  v_mov_b32 v79, 0
  s_mov_b32 s22, 75694080
  v_lshrrev_b32 v14, 4, v2
  v_add_u32 v14, 192, v14
  v_min_u32 v14, 308, v14
  v_lshlrev_b32 v14, 7, v14
  buffer_load_dword v15, v14, s[8:11], s22 offen sc1
  buffer_load_dwordx4 v[80:83], v117, s[8:11], s24 offen offset:0 sc1
  buffer_load_dwordx4 v[84:87], v117, s[8:11], s24 offen offset:1024 sc1
  buffer_load_dwordx4 v[88:91], v117, s[8:11], s26 offen offset:0 sc1
  buffer_load_dwordx4 v[92:95], v117, s[8:11], s26 offen offset:1024 sc1
  buffer_load_dwordx4 v[96:99], v2, s[8:11], s24 offen offset:0 sc1
  buffer_load_dwordx4 v[100:103], v2, s[8:11], s24 offen offset:1024 sc1
  buffer_load_dwordx4 v[104:107], v2, s[8:11], s26 offen offset:0 sc1
  buffer_load_dwordx4 v[108:111], v2, s[8:11], s26 offen offset:1024 sc1
  s_add_u32 s22, s31, 339968
  buffer_load_dwordx4 v[184:187], v2, s[8:11], s22 offen offset:0 sc1
  buffer_load_dwordx4 v[188:191], v2, s[8:11], s22 offen offset:1024 sc1
  buffer_load_dwordx4 v[192:195], v2, s[8:11], s22 offen offset:2048 sc1
  buffer_load_dwordx4 v[196:199], v2, s[8:11], s22 offen offset:3072 sc1
  s_add_u32 s22, s31, 356352
  buffer_load_dwordx4 v[200:203], v2, s[8:11], s22 offen offset:2048 sc1
  buffer_load_dwordx4 v[204:207], v2, s[8:11], s22 offen offset:3072 sc1
  s_add_u32 s22, s31, 360448
  buffer_load_dwordx4 v[208:211], v2, s[8:11], s22 offen offset:0 sc1
  buffer_load_dwordx4 v[212:215], v2, s[8:11], s22 offen offset:1024 sc1
  buffer_load_dwordx4 v[216:219], v2, s[8:11], s22 offen offset:2048 sc1
  buffer_load_dwordx4 v[220:223], v2, s[8:11], s22 offen offset:3072 sc1
  s_add_u32 s22, s31, 364544
  buffer_load_dwordx4 v[224:227], v2, s[8:11], s22 offen offset:0 sc1
  buffer_load_dwordx4 v[228:231], v2, s[8:11], s22 offen offset:1024 sc1
  buffer_load_dwordx4 v[232:235], v2, s[8:11], s22 offen offset:2048 sc1
  buffer_load_dwordx4 v[236:239], v2, s[8:11], s22 offen offset:3072 sc1
  s_add_u32 s22, s31, 368640
  buffer_load_dwordx4 v[240:243], v2, s[8:11], s22 offen offset:0 sc1
  buffer_load_dwordx4 v[244:247], v2, s[8:11], s22 offen offset:1024 sc1
  buffer_load_dwordx4 v[248:251], v2, s[8:11], s22 offen offset:2048 sc1
  buffer_load_dwordx4 v[252:255], v2, s[8:11], s22 offen offset:3072 sc1
  s_waitcnt vmcnt(0) lgkmcnt(0)
  s_mov_b32 s31, 0
  s_cmp_lg_u32 s88, 0
  s_cbranch_scc1 cB_sc3_loop
  s_branch cA_sc3_loop
ch_init4:
  v_mov_b32 v72, v116
  v_mov_b32 v73, v117
  v_lshrrev_b32 v65, 1, v72
  v_and_b32 v66, 1, v72
  v_mov_b32 v36, 0
  v_mov_b32 v37, 0
  v_mov_b32 v38, 0
  v_mov_b32 v39, 0
  v_mov_b32 v40, 0
  v_mov_b32 v41, 0
  v_mov_b32 v42, 0
  v_mov_b32 v43, 0
  v_mov_b32 v44, 0
  v_mov_b32 v45, 0
  v_mov_b32 v46, 0
  v_mov_b32 v47, 0
  v_mov_b32 v48, 0
  v_mov_b32 v49, 0
  v_mov_b32 v50, 0
  v_mov_b32 v51, 0
  v_mov_b32 v52, 0
  v_mov_b32 v53, 0
  v_mov_b32 v54, 0
  v_mov_b32 v55, 0
  v_mov_b32 v56, 0
  v_mov_b32 v57, 0
  v_mov_b32 v58, 0
  v_mov_b32 v59, 0
  v_mov_b32 v60, 0
  v_mov_b32 v61, 0
  v_mov_b32 v62, 0
  v_mov_b32 v63, 0
  v_lshlrev_b32 v75, 2, v65
  v_lshl_add_u32 v75, v66, 3, v75
  v_add_u32 v67, 0, v73
  v_mul_u32_u24 v68, 2341, v67
  v_lshrrev_b32 v68, 16, v68
  v_mul_u32_u24 v69, 28, v68
  v_sub_u32 v69, v67, v69
  v_lshrrev_b32 v70, 4, v69
  v_and_b32 v69, 15, v69
  v_lshlrev_b32 v71, 12, v70
  v_lshl_add_u32 v71, v68, 8, v71
  v_lshl_add_u32 v71, v69, 4, v71
  v_add_u32 v152, v71, v75
  v_add_u32 v67, 16, v73
  v_mul_u32_u24 v68, 2341, v67
  v_lshrrev_b32 v68, 16, v68
  v_mul_u32_u24 v69, 28, v68
  v_sub_u32 v69, v67, v69
  v_lshrrev_b32 v70, 4, v69
  v_and_b32 v69, 15, v69
  v_lshlrev_b32 v71, 12, v70
  v_lshl_add_u32 v71, v68, 8, v71
  v_lshl_add_u32 v71, v69, 4, v71
  v_add_u32 v153, v71, v75
  v_add_u32 v67, 32, v73
  v_mul_u32_u24 v68, 2341, v67
  v_lshrrev_b32 v68, 16, v68
  v_mul_u32_u24 v69, 28, v68
  v_sub_u32 v69, v67, v69
  v_lshrrev_b32 v70, 4, v69
  v_and_b32 v69, 15, v69
  v_lshlrev_b32 v71, 12, v70
  v_lshl_add_u32 v71, v68, 8, v71
  v_lshl_add_u32 v71, v69, 4, v71
  v_add_u32 v154, v71, v75
  v_add_u32 v67, 48, v73
  v_mul_u32_u24 v68, 2341, v67
  v_lshrrev_b32 v68, 16, v68
  v_mul_u32_u24 v69, 28, v68
  v_sub_u32 v69, v67, v69
  v_lshrrev_b32 v70, 4, v69
  v_and_b32 v69, 15, v69
  v_lshlrev_b32 v71, 12, v70
  v_lshl_add_u32 v71, v68, 8, v71
  v_lshl_add_u32 v71, v69, 4, v71
  v_add_u32 v155, v71, v75
  v_add_u32 v67, 64, v73
  v_mul_u32_u24 v68, 2341, v67
  v_lshrrev_b32 v68, 16, v68
  v_mul_u32_u24 v69, 28, v68
  v_sub_u32 v69, v67, v69
  v_lshrrev_b32 v70, 4, v69
  v_and_b32 v69, 15, v69
  v_lshlrev_b32 v71, 12, v70
  v_lshl_add_u32 v71, v68, 8, v71
  v_lshl_add_u32 v71, v69, 4, v71
  v_add_u32 v156, v71, v75
  v_add_u32 v67, 80, v73
  v_mul_u32_u24 v68, 2341, v67
  v_lshrrev_b32 v68, 16, v68
  v_mul_u32_u24 v69, 28, v68
  v_sub_u32 v69, v67, v69
  v_lshrrev_b32 v70, 4, v69
  v_and_b32 v69, 15, v69
  v_lshlrev_b32 v71, 12, v70
  v_lshl_add_u32 v71, v68, 8, v71
  v_lshl_add_u32 v71, v69, 4, v71
  v_add_u32 v157, v71, v75
  v_add_u32 v67, 96, v73
  v_mul_u32_u24 v68, 2341, v67
  v_lshrrev_b32 v68, 16, v68
  v_mul_u32_u24 v69, 28, v68
  v_sub_u32 v69, v67, v69
  v_lshrrev_b32 v70, 4, v69
  v_and_b32 v69, 15, v69
  v_lshlrev_b32 v71, 12, v70
  v_lshl_add_u32 v71, v68, 8, v71
  v_lshl_add_u32 v71, v69, 4, v71
  v_add_u32 v158, v71, v75
  v_mov_b32 v74, 0x40000000
  v_mov_b32 v76, 0
  v_mov_b32 v77, 0
  v_mov_b32 v78, 0
  v_mov_b32 v79, 0
  ds_write_b128 v2, v[76:79] offset:0
  ds_write_b128 v2, v[76:79] offset:1024
  ds_write_b128 v2, v[76:79] offset:2048
  ds_write_b128 v2, v[76:79] offset:3072
  s_and_b32 s22, s17, 0
  s_lshl_b32 s22, s22, 7
  s_add_u32 s22, s22, 75729408
  v_lshl_add_u32 v4, v73, 2, s22
  v_and_b32 v64, 1, v73
  v_mov_b32 v5, 0x05040100
  v_mov_b32 v65, 0x03020706
  v_cmp_eq_u32 vcc, 1, v64
  s_nop 1
  v_cndmask_b32 v5, v5, v65, vcc
  s_lshl_b32 s22, s17, 2
  s_add_u32 s22, s22, 75733504
  v_lshl_add_u32 v7, v1, 7, s22
  v_cmp_gt_u32 vcc, 1, v1
  s_nop 1
  v_cndmask_b32 v7, v74, v7, vcc
  v_mov_b32 v6, v2
  v_lshl_add_u32 v64, v66, 2, v64
  v_and_b32 v65, 2, v72
  v_add_u32 v64, v64, v65
  s_mul_i32 s22, s17, 16
  v_add_u32 v75, s22, v73
  v_lshrrev_b32 v68, 4, v75
  v_lshlrev_b32 v68, 8, v68
  v_bfe_u32 v69, v75, 1, 1
  v_lshl_add_u32 v68, v69, 7, v68
  v_lshl_add_u32 v68, v64, 4, v68
  v_and_b32 v69, 12, v75
  v_add_u32 v1, v68, v69
  s_mul_i32 s22, s17, 28672
  s_add_u32 s25, s22, 42205184
  s_and_b32 s27, s17, 0
  s_xor_b32 s22, s27, 0
  s_mul_i32 s80, s22, 7168
  s_lshl_b32 s22, s22, 11
  s_add_u32 s76, s22, 9216
  s_xor_b32 s22, s27, 1
  s_mul_i32 s81, s22, 7168
  s_lshl_b32 s22, s22, 11
  s_add_u32 s77, s22, 9216
  s_xor_b32 s22, s27, 2
  s_mul_i32 s82, s22, 7168
  s_lshl_b32 s22, s22, 11
  s_add_u32 s78, s22, 9216
  s_xor_b32 s22, s27, 3
  s_mul_i32 s83, s22, 7168
  s_lshl_b32 s22, s22, 11
  s_add_u32 s79, s22, 9216
  v_mov_b32 v162, -1
  s_mov_b32 s38, 0x40000000
  v_add_u32 v0, 16384, v2
  s_mul_i32 s31, s17, 401408
  s_add_u32 s31, s31, 6422528
  s_mov_b32 s30, 0
ch_wr4:
  buffer_load_dword v9, off, s[12:15], 0 offset:128 sc1
  s_waitcnt vmcnt(0)
  v_cmp_ne_u32 vcc, 1, v9
  s_cbranch_vccz ch_wr4_ok
  s_sleep 8
  s_add_u32 s30, s30, 1
  s_cmp_lt_u32 s30, 400000
  s_cbranch_scc1 ch_wr4
  s_branch cA_abort
ch_wr4_ok:
  s_lshr_b32 s22, s17, 2
  s_lshl_b32 s28, 0x81, s22
  s_mul_i32 s27, s17, 12
  s_add_u32 s22, s27, 256
  s_lshr_b32 s22, s22, 6
  s_lshl_b32 s22, 0x81, s22
  s_or_b32 s28, s28, s22
  s_add_u32 s22, s27, 267
  s_lshr_b32 s22, s22, 6
  s_lshl_b32 s22, 0x81, s22
  s_or_b32 s28, s28, s22
  v_lshrrev_b32 v12, 8, v2
  v_lshlrev_b32 v12, 7, v12
  s_mov_b32 s27, 88519168
  s_mov_b32 s30, 0
ch_ww4:
  buffer_load_dword v9, v12, s[8:11], s27 offen sc1
  s_waitcnt vmcnt(0)
  v_and_b32 v10, s28, v9
  v_cmp_ne_u32 vcc, s28, v10
  s_cbranch_vccz ch_ww4_ok
  s_sleep 3
  s_add_u32 s30, s30, 1
  s_cmp_lt_u32 s30, 400000
  s_cbranch_scc1 ch_ww4
  s_branch cA_abort
ch_ww4_ok:
  s_add_u32 s22, s31, 0
  buffer_load_dwordx4 a[0:3], v2, s[8:11], s22 offen offset:0 sc1
  buffer_load_dwordx4 a[4:7], v2, s[8:11], s22 offen offset:1024 sc1
  buffer_load_dwordx4 a[8:11], v2, s[8:11], s22 offen offset:2048 sc1
  buffer_load_dwordx4 a[12:15], v2, s[8:11], s22 offen offset:3072 sc1
  s_add_u32 s22, s31, 4096
  buffer_load_dwordx4 a[16:19], v2, s[8:11], s22 offen offset:0 sc1
  buffer_load_dwordx4 a[20:23], v2, s[8:11], s22 offen offset:1024 sc1
  buffer_load_dwordx4 a[24:27], v2, s[8:11], s22 offen offset:2048 sc1
  buffer_load_dwordx4 a[28:31], v2, s[8:11], s22 offen offset:3072 sc1
  s_add_u32 s22, s31, 8192
  buffer_load_dwordx4 a[32:35], v2, s[8:11], s22 offen offset:0 sc1
  buffer_load_dwordx4 a[36:39], v2, s[8:11], s22 offen offset:1024 sc1
  buffer_load_dwordx4 a[40:43], v2, s[8:11], s22 offen offset:2048 sc1
  buffer_load_dwordx4 a[44:47], v2, s[8:11], s22 offen offset:3072 sc1
  s_add_u32 s22, s31, 12288
  buffer_load_dwordx4 a[48:51], v2, s[8:11], s22 offen offset:0 sc1
  buffer_load_dwordx4 a[52:55], v2, s[8:11], s22 offen offset:1024 sc1
  buffer_load_dwordx4 a[56:59], v2, s[8:11], s22 offen offset:2048 sc1
  buffer_load_dwordx4 a[60:63], v2, s[8:11], s22 offen offset:3072 sc1
  s_add_u32 s22, s31, 16384
  buffer_load_dwordx4 a[64:67], v2, s[8:11], s22 offen offset:0 sc1
  buffer_load_dwordx4 a[68:71], v2, s[8:11], s22 offen offset:1024 sc1
  buffer_load_dwordx4 a[72:75], v2, s[8:11], s22 offen offset:2048 sc1
  buffer_load_dwordx4 a[76:79], v2, s[8:11], s22 offen offset:3072 sc1
  s_add_u32 s22, s31, 20480
  buffer_load_dwordx4 a[80:83], v2, s[8:11], s22 offen offset:0 sc1
  buffer_load_dwordx4 a[84:87], v2, s[8:11], s22 offen offset:1024 sc1
  buffer_load_dwordx4 a[88:91], v2, s[8:11], s22 offen offset:2048 sc1
  buffer_load_dwordx4 a[92:95], v2, s[8:11], s22 offen offset:3072 sc1
  s_add_u32 s22, s31, 24576
  buffer_load_dwordx4 a[96:99], v2, s[8:11], s22 offen offset:0 sc1
  buffer_load_dwordx4 a[100:103], v2, s[8:11], s22 offen offset:1024 sc1
  buffer_load_dwordx4 a[104:107], v2, s[8:11], s22 offen offset:2048 sc1
  buffer_load_dwordx4 a[108:111], v2, s[8:11], s22 offen offset:3072 sc1
  s_add_u32 s22, s31, 28672
  buffer_load_dwordx4 a[112:115], v2, s[8:11], s22 offen offset:0 sc1
  buffer_load_dwordx4 a[116:119], v2, s[8:11], s22 offen offset:1024 sc1
  buffer_load_dwordx4 a[120:123], v2, s[8:11], s22 offen offset:2048 sc1
  buffer_load_dwordx4 a[124:127], v2, s[8:11], s22 offen offset:3072 sc1
  s_waitcnt vmcnt(24)
  s_add_u32 s22, s31, 32768
  buffer_load_dwordx4 a[128:131], v2, s[8:11], s22 offen offset:0 sc1
  buffer_load_dwordx4 a[132:135], v2, s[8:11], s22 offen offset:1024 sc1
  buffer_load_dwordx4 a[136:139], v2, s[8:11], s22 offen offset:2048 sc1
  buffer_load_dwordx4 a[140:143], v2, s[8:11], s22 offen offset:3072 sc1
  s_add_u32 s22, s31, 36864
  buffer_load_dwordx4 a[144:147], v2, s[8:11], s22 offen offset:0 sc1
  buffer_load_dwordx4 a[148:151], v2, s[8:11], s22 offen offset:1024 sc1
  buffer_load_dwordx4 a[152:155], v2, s[8:11], s22 offen offset:2048 sc1
  buffer_load_dwordx4 a[156:159], v2, s[8:11], s22 offen offset:3072 sc1
  s_add_u32 s22, s31, 40960
  buffer_load_dwordx4 a[160:163], v2, s[8:11], s22 offen offset:0 sc1
  buffer_load_dwordx4 a[164:167], v2, s[8:11], s22 offen offset:1024 sc1
  buffer_load_dwordx4 a[168:171], v2, s[8:11], s22 offen offset:2048 sc1
  buffer_load_dwordx4 a[172:175], v2, s[8:11], s22 offen offset:3072 sc1
  s_add_u32 s22, s31, 45056
  buffer_load_dwordx4 a[176:179], v2, s[8:11], s22 offen offset:0 sc1
  buffer_load_dwordx4 a[180:183], v2, s[8:11], s22 offen offset:1024 sc1
  buffer_load_dwordx4 a[184:187], v2, s[8:11], s22 offen offset:2048 sc1
  buffer_load_dwordx4 a[188:191], v2, s[8:11], s22 offen offset:3072 sc1
  s_add_u32 s22, s31, 49152
  buffer_load_dwordx4 a[192:195], v2, s[8:11], s22 offen offset:0 sc1
  buffer_load_dwordx4 a[196:199], v2, s[8:11], s22 offen offset:1024 sc1
  buffer_load_dwordx4 a[200:203], v2, s[8:11], s22 offen offset:2048 sc1
  buffer_load_dwordx4 a[204:207], v2, s[8:11], s22 offen offset:3072 sc1
  s_add_u32 s22, s31, 53248
  buffer_load_dwordx4 a[208:211], v2, s[8:11], s22 offen offset:0 sc1
  buffer_load_dwordx4 a[212:215], v2, s[8:11], s22 offen offset:1024 sc1
  buffer_load_dwordx4 a[216:219], v2, s[8:11], s22 offen offset:2048 sc1
  buffer_load_dwordx4 a[220:223], v2, s[8:11], s22 offen offset:3072 sc1
  s_add_u32 s22, s31, 57344
  buffer_load_dwordx4 a[224:227], v2, s[8:11], s22 offen offset:0 sc1
  buffer_load_dwordx4 a[228:231], v2, s[8:11], s22 offen offset:1024 sc1
  buffer_load_dwordx4 a[232:235], v2, s[8:11], s22 offen offset:2048 sc1
  buffer_load_dwordx4 a[236:239], v2, s[8:11], s22 offen offset:3072 sc1
  s_add_u32 s22, s31, 61440
  buffer_load_dwordx4 a[240:243], v2, s[8:11], s22 offen offset:0 sc1
  buffer_load_dwordx4 a[244:247], v2, s[8:11], s22 offen offset:1024 sc1
  buffer_load_dwordx4 a[248:251], v2, s[8:11], s22 offen offset:2048 sc1
  buffer_load_dwordx4 a[252:255], v2, s[8:11], s22 offen offset:3072 sc1
  s_waitcnt vmcnt(24)
  s_add_u32 s22, s31, 65536
  buffer_load_dwordx4 v[176:179], v2, s[8:11], s22 offen offset:0 sc1
  buffer_load_dwordx4 v[180:183], v2, s[8:11], s22 offen offset:1024 sc1
  buffer_load_dwordx4 v[184:187], v2, s[8:11], s22 offen offset:2048 sc1
  buffer_load_dwordx4 v[188:191], v2, s[8:11], s22 offen offset:3072 sc1
  s_add_u32 s22, s31, 69632
  buffer_load_dwordx4 v[192:195], v2, s[8:11], s22 offen offset:0 sc1
  buffer_load_dwordx4 v[196:199], v2, s[8:11], s22 offen offset:1024 sc1
  buffer_load_dwordx4 v[200:203], v2, s[8:11], s22 offen offset:2048 sc1
  buffer_load_dwordx4 v[204:207], v2, s[8:11], s22 offen offset:3072 sc1
  s_add_u32 s22, s31, 73728
  buffer_load_dwordx4 v[208:211], v2, s[8:11], s22 offen offset:0 sc1
  buffer_load_dwordx4 v[212:215], v2, s[8:11], s22 offen offset:1024 sc1
  buffer_load_dwordx4 v[216:219], v2, s[8:11], s22 offen offset:2048 sc1
  buffer_load_dwordx4 v[220:223], v2, s[8:11], s22 offen offset:3072 sc1
  s_add_u32 s22, s31, 77824
  buffer_load_dwordx4 v[224:227], v2, s[8:11], s22 offen offset:0 sc1
  buffer_load_dwordx4 v[228:231], v2, s[8:11], s22 offen offset:1024 sc1
  buffer_load_dwordx4 v[232:235], v2, s[8:11], s22 offen offset:2048 sc1
  buffer_load_dwordx4 v[236:239], v2, s[8:11], s22 offen offset:3072 sc1
  s_add_u32 s22, s31, 81920
  buffer_load_dwordx4 v[240:243], v2, s[8:11], s22 offen offset:0 sc1
  buffer_load_dwordx4 v[244:247], v2, s[8:11], s22 offen offset:1024 sc1
  buffer_load_dwordx4 v[248:251], v2, s[8:11], s22 offen offset:2048 sc1
  buffer_load_dwordx4 v[252:255], v2, s[8:11], s22 offen offset:3072 sc1
  s_mov_b32 m0, 16384
  s_add_u32 s22, s31, 86016
  buffer_load_dwordx4 v2, s[8:11], s22 offen offset:0 sc1 lds
  buffer_load_dwordx4 v2, s[8:11], s22 offen offset:1024 sc1 lds
  buffer_load_dwordx4 v2, s[8:11], s22 offen offset:2048 sc1 lds
  buffer_load_dwordx4 v2, s[8:11], s22 offen offset:3072 sc1 lds
  s_mov_b32 m0, 20480
  s_add_u32 s22, s31, 90112
  buffer_load_dwordx4 v2, s[8:11], s22 offen offset:0 sc1 lds
  buffer_load_dwordx4 v2, s[8:11], s22 offen offset:1024 sc1 lds
  buffer_load_dwordx4 v2, s[8:11], s22 offen offset:2048 sc1 lds
  buffer_load_dwordx4 v2, s[8:11], s22 offen offset:3072 sc1 lds
  s_mov_b32 m0, 24576
  s_add_u32 s22, s31, 94208
  buffer_load_dwordx4 v2, s[8:11], s22 offen offset:0 sc1 lds
  buffer_load_dwordx4 v2, s[8:11], s22 offen offset:1024 sc1 lds
  buffer_load_dwordx4 v2, s[8:11], s22 offen offset:2048 sc1 lds
  buffer_load_dwordx4 v2, s[8:11], s22 offen offset:3072 sc1 lds
  s_mov_b32 m0, 28672
  s_add_u32 s22, s31, 98304
  buffer_load_dwordx4 v2, s[8:11], s22 offen offset:0 sc1 lds
  buffer_load_dwordx4 v2, s[8:11], s22 offen offset:1024 sc1 lds
  s_mov_b32 s28, s35
  s_waitcnt vmcnt(0) lgkmcnt(0)
  s_mov_b32 s31, 0
  s_cmp_lg_u32 s88, 0
  s_cbranch_scc1 cB_va0_loop
  s_branch cA_va0_loop
ch_init5:
  v_mov_b32 v72, v116
  v_mov_b32 v73, v117
  v_lshrrev_b32 v65, 1, v72
  v_and_b32 v66, 1, v72
  v_mov_b32 v36, 0
  v_mov_b32 v37, 0
  v_mov_b32 v38, 0
  v_mov_b32 v39, 0
  v_mov_b32 v40, 0
  v_mov_b32 v41, 0
  v_mov_b32 v42, 0
  v_mov_b32 v43, 0
  v_mov_b32 v44, 0
  v_mov_b32 v45, 0
  v_mov_b32 v46, 0
  v_mov_b32 v47, 0
  v_mov_b32 v48, 0
  v_mov_b32 v49, 0
  v_mov_b32 v50, 0
  v_mov_b32 v51, 0
  v_mov_b32 v52, 0
  v_mov_b32 v53, 0
  v_mov_b32 v54, 0
  v_mov_b32 v55, 0
  v_mov_b32 v56, 0
  v_mov_b32 v57, 0
  v_mov_b32 v58, 0
  v_mov_b32 v59, 0
  v_mov_b32 v60, 0
  v_mov_b32 v61, 0
  v_mov_b32 v62, 0
  v_mov_b32 v63, 0
  v_lshlrev_b32 v75, 2, v65
  v_lshl_add_u32 v75, v66, 3, v75
  v_add_u32 v67, 112, v73
  v_mul_u32_u24 v68, 2341, v67
  v_lshrrev_b32 v68, 16, v68
  v_mul_u32_u24 v69, 28, v68
  v_sub_u32 v69, v67, v69
  v_lshrrev_b32 v70, 4, v69
  v_and_b32 v69, 15, v69
  v_lshlrev_b32 v71, 12, v70
  v_lshl_add_u32 v71, v68, 8, v71
  v_lshl_add_u32 v71, v69, 4, v71
  v_add_u32 v152, v71, v75
  v_add_u32 v67, 128, v73
  v_mul_u32_u24 v68, 2341, v67
  v_lshrrev_b32 v68, 16, v68
  v_mul_u32_u24 v69, 28, v68
  v_sub_u32 v69, v67, v69
  v_lshrrev_b32 v70, 4, v69
  v_and_b32 v69, 15, v69
  v_lshlrev_b32 v71, 12, v70
  v_lshl_add_u32 v71, v68, 8, v71
  v_lshl_add_u32 v71, v69, 4, v71
  v_add_u32 v153, v71, v75
  v_add_u32 v67, 144, v73
  v_mul_u32_u24 v68, 2341, v67
  v_lshrrev_b32 v68, 16, v68
  v_mul_u32_u24 v69, 28, v68
  v_sub_u32 v69, v67, v69
  v_lshrrev_b32 v70, 4, v69
  v_and_b32 v69, 15, v69
  v_lshlrev_b32 v71, 12, v70
  v_lshl_add_u32 v71, v68, 8, v71
  v_lshl_add_u32 v71, v69, 4, v71
  v_add_u32 v154, v71, v75
  v_add_u32 v67, 160, v73
  v_mul_u32_u24 v68, 2341, v67
  v_lshrrev_b32 v68, 16, v68
  v_mul_u32_u24 v69, 28, v68
  v_sub_u32 v69, v67, v69
  v_lshrrev_b32 v70, 4, v69
  v_and_b32 v69, 15, v69
  v_lshlrev_b32 v71, 12, v70
  v_lshl_add_u32 v71, v68, 8, v71
  v_lshl_add_u32 v71, v69, 4, v71
  v_add_u32 v155, v71, v75
  v_add_u32 v67, 176, v73
  v_mul_u32_u24 v68, 2341, v67
  v_lshrrev_b32 v68, 16, v68
  v_mul_u32_u24 v69, 28, v68
  v_sub_u32 v69, v67, v69
  v_lshrrev_b32 v70, 4, v69
  v_and_b32 v69, 15, v69
  v_lshlrev_b32 v71, 12, v70
  v_lshl_add_u32 v71, v68, 8, v71
  v_lshl_add_u32 v71, v69, 4, v71
  v_add_u32 v156, v71, v75
  v_add_u32 v67, 192, v73
  v_mul_u32_u24 v68, 2341, v67
  v_lshrrev_b32 v68, 16, v68
  v_mul_u32_u24 v69, 28, v68
  v_sub_u32 v69, v67, v69
  v_lshrrev_b32 v70, 4, v69
  v_and_b32 v69, 15, v69
  v_lshlrev_b32 v71, 12, v70
  v_lshl_add_u32 v71, v68, 8, v71
  v_lshl_add_u32 v71, v69, 4, v71
  v_add_u32 v157, v71, v75
  v_add_u32 v67, 208, v73
  v_mul_u32_u24 v68, 2341, v67
  v_lshrrev_b32 v68, 16, v68
  v_mul_u32_u24 v69, 28, v68
  v_sub_u32 v69, v67, v69
  v_lshrrev_b32 v70, 4, v69
  v_and_b32 v69, 15, v69
  v_lshlrev_b32 v71, 12, v70
  v_lshl_add_u32 v71, v68, 8, v71
  v_lshl_add_u32 v71, v69, 4, v71
  v_add_u32 v158, v71, v75
  v_mov_b32 v74, 0x40000000
  v_mov_b32 v76, 0
  v_mov_b32 v77, 0
  v_mov_b32 v78, 0
  v_mov_b32 v79, 0
  ds_write_b128 v2, v[76:79] offset:4096
  ds_write_b128 v2, v[76:79] offset:5120
  ds_write_b128 v2, v[76:79] offset:6144
  ds_write_b128 v2, v[76:79] offset:7168
  s_and_b32 s22, s17, 0
  s_lshl_b32 s22, s22, 7
  s_add_u32 s22, s22, 75729408
  v_lshl_add_u32 v4, v73, 2, s22
  v_and_b32 v64, 1, v73
  v_mov_b32 v5, 0x05040100
  v_mov_b32 v65, 0x03020706
  v_cmp_eq_u32 vcc, 1, v64
  s_nop 1
  v_cndmask_b32 v5, v5, v65, vcc
  s_lshl_b32 s22, s17, 2
  s_add_u32 s22, s22, 75733504
  v_lshl_add_u32 v7, v1, 7, s22
  v_cmp_gt_u32 vcc, 1, v1
  s_nop 1
  v_cndmask_b32 v7, v74, v7, vcc
  v_min_u32 v65, 11, v73
  v_mad_u32_u24 v65, v72, 12, v65
  v_lshlrev_b32 v6, 4, v65
  v_add_u32 v6, 1024, v6
  v_lshl_add_u32 v64, v66, 2, v64
  v_and_b32 v65, 2, v72
  v_add_u32 v64, v64, v65
  s_mul_i32 s22, s17, 12
  s_add_u32 s22, s22, 256
  v_add_u32 v75, s22, v73
  v_lshrrev_b32 v68, 4, v75
  v_lshlrev_b32 v68, 8, v68
  v_bfe_u32 v69, v75, 1, 1
  v_lshl_add_u32 v68, v69, 7, v68
  v_lshl_add_u32 v68, v64, 4, v68
  v_and_b32 v69, 12, v75
  v_add_u32 v1, v68, v69
  v_cmp_gt_u32 vcc, 12, v73
  s_nop 1
  v_cndmask_b32 v1, v74, v1, vcc
  s_mul_i32 s22, s17, 28672
  s_add_u32 s25, s22, 42205184
  s_and_b32 s27, s17, 0
  s_xor_b32 s22, s27, 0
  s_mul_i32 s80, s22, 7168
  s_lshl_b32 s22, s22, 11
  s_add_u32 s76, s22, 9216
  s_xor_b32 s22, s27, 1
  s_mul_i32 s81, s22, 7168
  s_lshl_b32 s22, s22, 11
  s_add_u32 s77, s22, 9216
  s_xor_b32 s22, s27, 2
  s_mul_i32 s82, s22, 7168
  s_lshl_b32 s22, s22, 11
  s_add_u32 s78, s22, 9216
  s_xor_b32 s22, s27, 3
  s_mul_i32 s83, s22, 7168
  s_lshl_b32 s22, s22, 11
  s_add_u32 s79, s22, 9216
  v_mov_b32 v162, -1
  s_mov_b32 s38, 0x40000000
  v_add_u32 v0, 30720, v2
  s_mul_i32 s31, s17, 401408
  s_add_u32 s31, s31, 6522880
  s_mov_b32 s30, 0
ch_wr5:
  buffer_load_dword v9, off, s[12:15], 0 offset:128 sc1
  s_waitcnt vmcnt(0)
  v_cmp_ne_u32 vcc, 1, v9
  s_cbranch_vccz ch_wr5_ok
  s_sleep 8
  s_add_u32 s30, s30, 1
  s_cmp_lt_u32 s30, 400000
  s_cbranch_scc1 ch_wr5
  s_branch cA_abort
ch_wr5_ok:
  s_lshr_b32 s22, s17, 2
  s_lshl_b32 s28, 0x81, s22
  s_mul_i32 s27, s17, 12
  s_add_u32 s22, s27, 256
  s_lshr_b32 s22, s22, 6
  s_lshl_b32 s22, 0x81, s22
  s_or_b32 s28, s28, s22
  s_add_u32 s22, s27, 267
  s_lshr_b32 s22, s22, 6
  s_lshl_b32 s22, 0x81, s22
  s_or_b32 s28, s28, s22
  v_lshrrev_b32 v12, 8, v2
  v_lshlrev_b32 v12, 7, v12
  s_mov_b32 s27, 88519680
  s_mov_b32 s30, 0
ch_ww5:
  buffer_load_dword v9, v12, s[8:11], s27 offen sc1
  s_waitcnt vmcnt(0)
  v_and_b32 v10, s28, v9
  v_cmp_ne_u32 vcc, s28, v10
  s_cbranch_vccz ch_ww5_ok
  s_sleep 3
  s_add_u32 s30, s30, 1
  s_cmp_lt_u32 s30, 400000
  s_cbranch_scc1 ch_ww5
  s_branch cA_abort
ch_ww5_ok:
  s_add_u32 s22, s31, 0
  buffer_load_dwordx4 a[0:3], v2, s[8:11], s22 offen offset:0 sc1
  buffer_load_dwordx4 a[4:7], v2, s[8:11], s22 offen offset:1024 sc1
  buffer_load_dwordx4 a[8:11], v2, s[8:11], s22 offen offset:2048 sc1
  buffer_load_dwordx4 a[12:15], v2, s[8:11], s22 offen offset:3072 sc1
  s_add_u32 s22, s31, 4096
  buffer_load_dwordx4 a[16:19], v2, s[8:11], s22 offen offset:0 sc1
  buffer_load_dwordx4 a[20:23], v2, s[8:11], s22 offen offset:1024 sc1
  buffer_load_dwordx4 a[24:27], v2, s[8:11], s22 offen offset:2048 sc1
  buffer_load_dwordx4 a[28:31], v2, s[8:11], s22 offen offset:3072 sc1
  s_add_u32 s22, s31, 8192
  buffer_load_dwordx4 a[32:35], v2, s[8:11], s22 offen offset:0 sc1
  buffer_load_dwordx4 a[36:39], v2, s[8:11], s22 offen offset:1024 sc1
  buffer_load_dwordx4 a[40:43], v2, s[8:11], s22 offen offset:2048 sc1
  buffer_load_dwordx4 a[44:47], v2, s[8:11], s22 offen offset:3072 sc1
  s_add_u32 s22, s31, 12288
  buffer_load_dwordx4 a[48:51], v2, s[8:11], s22 offen offset:0 sc1
  buffer_load_dwordx4 a[52:55], v2, s[8:11], s22 offen offset:1024 sc1
  buffer_load_dwordx4 a[56:59], v2, s[8:11], s22 offen offset:2048 sc1
  buffer_load_dwordx4 a[60:63], v2, s[8:11], s22 offen offset:3072 sc1
  s_add_u32 s22, s31, 16384
  buffer_load_dwordx4 a[64:67], v2, s[8:11], s22 offen offset:0 sc1
  buffer_load_dwordx4 a[68:71], v2, s[8:11], s22 offen offset:1024 sc1
  buffer_load_dwordx4 a[72:75], v2, s[8:11], s22 offen offset:2048 sc1
  buffer_load_dwordx4 a[76:79], v2, s[8:11], s22 offen offset:3072 sc1
  s_add_u32 s22, s31, 20480
  buffer_load_dwordx4 a[80:83], v2, s[8:11], s22 offen offset:0 sc1
  buffer_load_dwordx4 a[84:87], v2, s[8:11], s22 offen offset:1024 sc1
  buffer_load_dwordx4 a[88:91], v2, s[8:11], s22 offen offset:2048 sc1
  buffer_load_dwordx4 a[92:95], v2, s[8:11], s22 offen offset:3072 sc1
  s_add_u32 s22, s31, 24576
  buffer_load_dwordx4 a[96:99], v2, s[8:11], s22 offen offset:0 sc1
  buffer_load_dwordx4 a[100:103], v2, s[8:11], s22 offen offset:1024 sc1
  buffer_load_dwordx4 a[104:107], v2, s[8:11], s22 offen offset:2048 sc1
  buffer_load_dwordx4 a[108:111], v2, s[8:11], s22 offen offset:3072 sc1
  s_add_u32 s22, s31, 28672
  buffer_load_dwordx4 a[112:115], v2, s[8:11], s22 offen offset:0 sc1
  buffer_load_dwordx4 a[116:119], v2, s[8:11], s22 offen offset:1024 sc1
  buffer_load_dwordx4 a[120:123], v2, s[8:11], s22 offen offset:2048 sc1
  buffer_load_dwordx4 a[124:127], v2, s[8:11], s22 offen offset:3072 sc1
  s_waitcnt vmcnt(24)
  s_add_u32 s22, s31, 32768
  buffer_load_dwordx4 a[128:131], v2, s[8:11], s22 offen offset:0 sc1
  buffer_load_dwordx4 a[132:135], v2, s[8:11], s22 offen offset:1024 sc1
  buffer_load_dwordx4 a[136:139], v2, s[8:11], s22 offen offset:2048 sc1
  buffer_load_dwordx4 a[140:143], v2, s[8:11], s22 offen offset:3072 sc1
  s_add_u32 s22, s31, 36864
  buffer_load_dwordx4 a[144:147], v2, s[8:11], s22 offen offset:0 sc1
  buffer_load_dwordx4 a[148:151], v2, s[8:11], s22 offen offset:1024 sc1
  buffer_load_dwordx4 a[152:155], v2, s[8:11], s22 offen offset:2048 sc1
  buffer_load_dwordx4 a[156:159], v2, s[8:11], s22 offen offset:3072 sc1
  s_add_u32 s22, s31, 40960
  buffer_load_dwordx4 a[160:163], v2, s[8:11], s22 offen offset:0 sc1
  buffer_load_dwordx4 a[164:167], v2, s[8:11], s22 offen offset:1024 sc1
  buffer_load_dwordx4 a[168:171], v2, s[8:11], s22 offen offset:2048 sc1
  buffer_load_dwordx4 a[172:175], v2, s[8:11], s22 offen offset:3072 sc1
  s_add_u32 s22, s31, 45056
  buffer_load_dwordx4 a[176:179], v2, s[8:11], s22 offen offset:0 sc1
  buffer_load_dwordx4 a[180:183], v2, s[8:11], s22 offen offset:1024 sc1
  buffer_load_dwordx4 a[184:187], v2, s[8:11], s22 offen offset:2048 sc1
  buffer_load_dwordx4 a[188:191], v2, s[8:11], s22 offen offset:3072 sc1
  s_add_u32 s22, s31, 49152
  buffer_load_dwordx4 a[192:195], v2, s[8:11], s22 offen offset:0 sc1
  buffer_load_dwordx4 a[196:199], v2, s[8:11], s22 offen offset:1024 sc1
  buffer_load_dwordx4 a[200:203], v2, s[8:11], s22 offen offset:2048 sc1
  buffer_load_dwordx4 a[204:207], v2, s[8:11], s22 offen offset:3072 sc1
  s_add_u32 s22, s31, 53248
  buffer_load_dwordx4 a[208:211], v2, s[8:11], s22 offen offset:0 sc1
  buffer_load_dwordx4 a[212:215], v2, s[8:11], s22 offen offset:1024 sc1
  buffer_load_dwordx4 a[216:219], v2, s[8:11], s22 offen offset:2048 sc1
  buffer_load_dwordx4 a[220:223], v2, s[8:11], s22 offen offset:3072 sc1
  s_add_u32 s22, s31, 57344
  buffer_load_dwordx4 a[224:227], v2, s[8:11], s22 offen offset:0 sc1
  buffer_load_dwordx4 a[228:231], v2, s[8:11], s22 offen offset:1024 sc1
  buffer_load_dwordx4 a[232:235], v2, s[8:11], s22 offen offset:2048 sc1
  buffer_load_dwordx4 a[236:239], v2, s[8:11], s22 offen offset:3072 sc1
  s_add_u32 s22, s31, 61440
  buffer_load_dwordx4 a[240:243], v2, s[8:11], s22 offen offset:0 sc1
  buffer_load_dwordx4 a[244:247], v2, s[8:11], s22 offen offset:1024 sc1
  buffer_load_dwordx4 a[248:251], v2, s[8:11], s22 offen offset:2048 sc1
  buffer_load_dwordx4 a[252:255], v2, s[8:11], s22 offen offset:3072 sc1
  s_waitcnt vmcnt(24)
  s_add_u32 s22, s31, 65536
  buffer_load_dwordx4 v[176:179], v2, s[8:11], s22 offen offset:0 sc1
  buffer_load_dwordx4 v[180:183], v2, s[8:11], s22 offen offset:1024 sc1
  buffer_load_dwordx4 v[184:187], v2, s[8:11], s22 offen offset:2048 sc1
  buffer_load_dwordx4 v[188:191], v2, s[8:11], s22 offen offset:3072 sc1
  s_add_u32 s22, s31, 69632
  buffer_load_dwordx4 v[192:195], v2, s[8:11], s22 offen offset:0 sc1
  buffer_load_dwordx4 v[196:199], v2, s[8:11], s22 offen offset:1024 sc1
  buffer_load_dwordx4 v[200:203], v2, s[8:11], s22 offen offset:2048 sc1
  buffer_load_dwordx4 v[204:207], v2, s[8:11], s22 offen offset:3072 sc1
  s_add_u32 s22, s31, 73728
  buffer_load_dwordx4 v[208:211], v2, s[8:11], s22 offen offset:0 sc1
  buffer_load_dwordx4 v[212:215], v2, s[8:11], s22 offen offset:1024 sc1
  buffer_load_dwordx4 v[216:219], v2, s[8:11], s22 offen offset:2048 sc1
  buffer_load_dwordx4 v[220:223], v2, s[8:11], s22 offen offset:3072 sc1
  s_add_u32 s22, s31, 77824
  buffer_load_dwordx4 v[224:227], v2, s[8:11], s22 offen offset:0 sc1
  buffer_load_dwordx4 v[228:231], v2, s[8:11], s22 offen offset:1024 sc1
  buffer_load_dwordx4 v[232:235], v2, s[8:11], s22 offen offset:2048 sc1
  buffer_load_dwordx4 v[236:239], v2, s[8:11], s22 offen offset:3072 sc1
  s_add_u32 s22, s31, 81920
  buffer_load_dwordx4 v[240:243], v2, s[8:11], s22 offen offset:0 sc1
  buffer_load_dwordx4 v[244:247], v2, s[8:11], s22 offen offset:1024 sc1
  buffer_load_dwordx4 v[248:251], v2, s[8:11], s22 offen offset:2048 sc1
  buffer_load_dwordx4 v[252:255], v2, s[8:11], s22 offen offset:3072 sc1
  s_mov_b32 m0, 30720
  s_add_u32 s22, s31, 86016
  buffer_load_dwordx4 v2, s[8:11], s22 offen offset:0 sc1 lds
  buffer_load_dwordx4 v2, s[8:11], s22 offen offset:1024 sc1 lds
  buffer_load_dwordx4 v2, s[8:11], s22 offen offset:2048 sc1 lds
  buffer_load_dwordx4 v2, s[8:11], s22 offen offset:3072 sc1 lds
  s_mov_b32 m0, 34816
  s_add_u32 s22, s31, 90112
  buffer_load_dwordx4 v2, s[8:11], s22 offen offset:0 sc1 lds
  buffer_load_dwordx4 v2, s[8:11], s22 offen offset:1024 sc1 lds
  buffer_load_dwordx4 v2, s[8:11], s22 offen offset:2048 sc1 lds
  buffer_load_dwordx4 v2, s[8:11], s22 offen offset:3072 sc1 lds
  s_mov_b32 m0, 38912
  s_add_u32 s22, s31, 94208
  buffer_load_dwordx4 v2, s[8:11], s22 offen offset:0 sc1 lds
  buffer_load_dwordx4 v2, s[8:11], s22 offen offset:1024 sc1 lds
  buffer_load_dwordx4 v2, s[8:11], s22 offen offset:2048 sc1 lds
  buffer_load_dwordx4 v2, s[8:11], s22 offen offset:3072 sc1 lds
  s_mov_b32 m0, 43008
  s_add_u32 s22, s31, 98304
  buffer_load_dwordx4 v2, s[8:11], s22 offen offset:0 sc1 lds
  buffer_load_dwordx4 v2, s[8:11], s22 offen offset:1024 sc1 lds
  s_mov_b32 s28, s35
  s_waitcnt vmcnt(0) lgkmcnt(0)
  s_mov_b32 s31, 0
  s_cmp_lg_u32 s88, 0
  s_cbranch_scc1 cB_va1_loop
  s_branch cA_va1_loop
ch_init6:
  v_mov_b32 v72, v116
  v_mov_b32 v73, v117
  v_lshrrev_b32 v65, 1, v72
  v_and_b32 v66, 1, v72
  v_mov_b32 v36, 0
  v_mov_b32 v37, 0
  v_mov_b32 v38, 0
  v_mov_b32 v39, 0
  v_mov_b32 v40, 0
  v_mov_b32 v41, 0
  v_mov_b32 v42, 0
  v_mov_b32 v43, 0
  v_mov_b32 v44, 0
  v_mov_b32 v45, 0
  v_mov_b32 v46, 0
  v_mov_b32 v47, 0
  v_mov_b32 v48, 0
  v_mov_b32 v49, 0
  v_mov_b32 v50, 0
  v_mov_b32 v51, 0
  v_mov_b32 v52, 0
  v_mov_b32 v53, 0
  v_mov_b32 v54, 0
  v_mov_b32 v55, 0
  v_mov_b32 v56, 0
  v_mov_b32 v57, 0
  v_mov_b32 v58, 0
  v_mov_b32 v59, 0
  v_mov_b32 v60, 0
  v_mov_b32 v61, 0
  v_mov_b32 v62, 0
  v_mov_b32 v63, 0
  v_lshlrev_b32 v75, 2, v65
  v_lshl_add_u32 v75, v66, 3, v75
  v_add_u32 v67, 224, v73
  v_mul_u32_u24 v68, 2341, v67
  v_lshrrev_b32 v68, 16, v68
  v_mul_u32_u24 v69, 28, v68
  v_sub_u32 v69, v67, v69
  v_lshrrev_b32 v70, 4, v69
  v_and_b32 v69, 15, v69
  v_lshlrev_b32 v71, 12, v70
  v_lshl_add_u32 v71, v68, 8, v71
  v_lshl_add_u32 v71, v69, 4, v71
  v_add_u32 v104, v71, v75
  v_add_u32 v67, 240, v73
  v_mul_u32_u24 v68, 2341, v67
  v_lshrrev_b32 v68, 16, v68
  v_mul_u32_u24 v69, 28, v68
  v_sub_u32 v69, v67, v69
  v_lshrrev_b32 v70, 4, v69
  v_and_b32 v69, 15, v69
  v_lshlrev_b32 v71, 12, v70
  v_lshl_add_u32 v71, v68, 8, v71
  v_lshl_add_u32 v71, v69, 4, v71
  v_add_u32 v105, v71, v75
  v_add_u32 v67, 256, v73
  v_mul_u32_u24 v68, 2341, v67
  v_lshrrev_b32 v68, 16, v68
  v_mul_u32_u24 v69, 28, v68
  v_sub_u32 v69, v67, v69
  v_lshrrev_b32 v70, 4, v69
  v_and_b32 v69, 15, v69
  v_lshlrev_b32 v71, 12, v70
  v_lshl_add_u32 v71, v68, 8, v71
  v_lshl_add_u32 v71, v69, 4, v71
  v_add_u32 v106, v71, v75
  v_add_u32 v67, 272, v73
  v_mul_u32_u24 v68, 2341, v67
  v_lshrrev_b32 v68, 16, v68
  v_mul_u32_u24 v69, 28, v68
  v_sub_u32 v69, v67, v69
  v_lshrrev_b32 v70, 4, v69
  v_and_b32 v69, 15, v69
  v_lshlrev_b32 v71, 12, v70
  v_lshl_add_u32 v71, v68, 8, v71
  v_lshl_add_u32 v71, v69, 4, v71
  v_add_u32 v107, v71, v75
  v_add_u32 v67, 288, v73
  v_mul_u32_u24 v68, 2341, v67
  v_lshrrev_b32 v68, 16, v68
  v_mul_u32_u24 v69, 28, v68
  v_sub_u32 v69, v67, v69
  v_lshrrev_b32 v70, 4, v69
  v_and_b32 v69, 15, v69
  v_lshlrev_b32 v71, 12, v70
  v_lshl_add_u32 v71, v68, 8, v71
  v_lshl_add_u32 v71, v69, 4, v71
  v_add_u32 v108, v71, v75
  v_add_u32 v67, 304, v73
  v_mul_u32_u24 v68, 2341, v67
  v_lshrrev_b32 v68, 16, v68
  v_mul_u32_u24 v69, 28, v68
  v_sub_u32 v69, v67, v69
  v_lshrrev_b32 v70, 4, v69
  v_and_b32 v69, 15, v69
  v_lshlrev_b32 v71, 12, v70
  v_lshl_add_u32 v71, v68, 8, v71
  v_lshl_add_u32 v71, v69, 4, v71
  v_add_u32 v109, v71, v75
  v_add_u32 v67, 320, v73
  v_mul_u32_u24 v68, 2341, v67
  v_lshrrev_b32 v68, 16, v68
  v_mul_u32_u24 v69, 28, v68
  v_sub_u32 v69, v67, v69
  v_lshrrev_b32 v70, 4, v69
  v_and_b32 v69, 15, v69
  v_lshlrev_b32 v71, 12, v70
  v_lshl_add_u32 v71, v68, 8, v71
  v_lshl_add_u32 v71, v69, 4, v71
  v_add_u32 v110, v71, v75
  v_mov_b32 v74, 0x40000000
  v_and_b32 v119, 15, v1
  s_and_b32 s22, s17, 0
  s_lshl_b32 s22, s22, 7
  s_add_u32 s22, s22, 75733504
  v_lshl_add_u32 v119, v119, 2, s22
  s_lshl_b32 s22, s17, 2
  s_add_u32 s22, s22, 75731456
  v_lshl_add_u32 v118, v1, 7, s22
  v_cmp_gt_u32 vcc, 1, v1
  s_nop 1
  v_cndmask_b32 v118, v74, v118, vcc
  s_lshl_b32 s35, s17, 7
  s_add_u32 s35, s35, 88461312
  v_min_u32 v116, 13, v1
  s_mul_i32 s22, s17, 14
  v_add_u32 v116, s22, v116
  v_lshlrev_b32 v116, 7, v116
  s_mul_i32 s31, s17, 401408
  s_add_u32 s31, s31, 6623232
  s_mov_b32 s30, 0
ch_wr6:
  buffer_load_dword v9, off, s[12:15], 0 offset:132 sc1
  s_waitcnt vmcnt(0)
  v_cmp_ne_u32 vcc, 1, v9
  s_cbranch_vccz ch_wr6_ok
  s_sleep 8
  s_add_u32 s30, s30, 1
  s_cmp_lt_u32 s30, 400000
  s_cbranch_scc1 ch_wr6
  s_branch cA_abort
ch_wr6_ok:
  s_lshr_b32 s22, s17, 2
  s_lshl_b32 s28, 0x81, s22
  s_mul_i32 s27, s17, 12
  s_add_u32 s22, s27, 256
  s_lshr_b32 s22, s22, 6
  s_lshl_b32 s22, 0x81, s22
  s_or_b32 s28, s28, s22
  s_add_u32 s22, s27, 267
  s_lshr_b32 s22, s22, 6
  s_lshl_b32 s22, 0x81, s22
  s_or_b32 s28, s28, s22
  v_lshrrev_b32 v12, 8, v2
  v_lshlrev_b32 v12, 7, v12
  s_mov_b32 s27, 88520192
  s_mov_b32 s30, 0
ch_ww6:
  buffer_load_dword v9, v12, s[8:11], s27 offen sc1
  s_waitcnt vmcnt(0)
  v_and_b32 v10, s28, v9
  v_cmp_ne_u32 vcc, s28, v10
  s_cbranch_vccz ch_ww6_ok
  s_sleep 3
  s_add_u32 s30, s30, 1
  s_cmp_lt_u32 s30, 400000
  s_cbranch_scc1 ch_ww6
  s_branch cA_abort
ch_ww6_ok:
  s_add_u32 s22, s31, 0
  buffer_load_dwordx4 a[0:3], v2, s[8:11], s22 offen offset:0 sc1
  buffer_load_dwordx4 a[4:7], v2, s[8:11], s22 offen offset:1024 sc1
  buffer_load_dwordx4 a[8:11], v2, s[8:11], s22 offen offset:2048 sc1
  buffer_load_dwordx4 a[12:15], v2, s[8:11], s22 offen offset:3072 sc1
  s_add_u32 s22, s31, 4096
  buffer_load_dwordx4 a[16:19], v2, s[8:11], s22 offen offset:0 sc1
  buffer_load_dwordx4 a[20:23], v2, s[8:11], s22 offen offset:1024 sc1
  buffer_load_dwordx4 a[24:27], v2, s[8:11], s22 offen offset:2048 sc1
  buffer_load_dwordx4 a[28:31], v2, s[8:11], s22 offen offset:3072 sc1
  s_add_u32 s22, s31, 8192
  buffer_load_dwordx4 a[32:35], v2, s[8:11], s22 offen offset:0 sc1
  buffer_load_dwordx4 a[36:39], v2, s[8:11], s22 offen offset:1024 sc1
  buffer_load_dwordx4 a[40:43], v2, s[8:11], s22 offen offset:2048 sc1
  buffer_load_dwordx4 a[44:47], v2, s[8:11], s22 offen offset:3072 sc1
  s_add_u32 s22, s31, 12288
  buffer_load_dwordx4 a[48:51], v2, s[8:11], s22 offen offset:0 sc1
  buffer_load_dwordx4 a[52:55], v2, s[8:11], s22 offen offset:1024 sc1
  buffer_load_dwordx4 a[56:59], v2, s[8:11], s22 offen offset:2048 sc1
  buffer_load_dwordx4 a[60:63], v2, s[8:11], s22 offen offset:3072 sc1
  s_add_u32 s22, s31, 16384
  buffer_load_dwordx4 a[64:67], v2, s[8:11], s22 offen offset:0 sc1
  buffer_load_dwordx4 a[68:71], v2, s[8:11], s22 offen offset:1024 sc1
  buffer_load_dwordx4 a[72:75], v2, s[8:11], s22 offen offset:2048 sc1
  buffer_load_dwordx4 a[76:79], v2, s[8:11], s22 offen offset:3072 sc1
  s_add_u32 s22, s31, 20480
  buffer_load_dwordx4 a[80:83], v2, s[8:11], s22 offen offset:0 sc1
  buffer_load_dwordx4 a[84:87], v2, s[8:11], s22 offen offset:1024 sc1
  buffer_load_dwordx4 a[88:91], v2, s[8:11], s22 offen offset:2048 sc1
  buffer_load_dwordx4 a[92:95], v2, s[8:11], s22 offen offset:3072 sc1
  s_add_u32 s22, s31, 24576
  buffer_load_dwordx4 a[96:99], v2, s[8:11], s22 offen offset:0 sc1
  buffer_load_dwordx4 a[100:103], v2, s[8:11], s22 offen offset:1024 sc1
  buffer_load_dwordx4 a[104:107], v2, s[8:11], s22 offen offset:2048 sc1
  buffer_load_dwordx4 a[108:111], v2, s[8:11], s22 offen offset:3072 sc1
  s_add_u32 s22, s31, 28672
  buffer_load_dwordx4 a[112:115], v2, s[8:11], s22 offen offset:0 sc1
  buffer_load_dwordx4 a[116:119], v2, s[8:11], s22 offen offset:1024 sc1
  buffer_load_dwordx4 a[120:123], v2, s[8:11], s22 offen offset:2048 sc1
  buffer_load_dwordx4 a[124:127], v2, s[8:11], s22 offen offset:3072 sc1
  s_waitcnt vmcnt(24)
  s_add_u32 s22, s31, 32768
  buffer_load_dwordx4 a[128:131], v2, s[8:11], s22 offen offset:0 sc1
  buffer_load_dwordx4 a[132:135], v2, s[8:11], s22 offen offset:1024 sc1
  buffer_load_dwordx4 a[136:139], v2, s[8:11], s22 offen offset:2048 sc1
  buffer_load_dwordx4 a[140:143], v2, s[8:11], s22 offen offset:3072 sc1
  s_add_u32 s22, s31, 36864
  buffer_load_dwordx4 a[144:147], v2, s[8:11], s22 offen offset:0 sc1
  buffer_load_dwordx4 a[148:151], v2, s[8:11], s22 offen offset:1024 sc1
  buffer_load_dwordx4 a[152:155], v2, s[8:11], s22 offen offset:2048 sc1
  buffer_load_dwordx4 a[156:159], v2, s[8:11], s22 offen offset:3072 sc1
  s_add_u32 s22, s31, 40960
  buffer_load_dwordx4 a[160:163], v2, s[8:11], s22 offen offset:0 sc1
  buffer_load_dwordx4 a[164:167], v2, s[8:11], s22 offen offset:1024 sc1
  buffer_load_dwordx4 a[168:171], v2, s[8:11], s22 offen offset:2048 sc1
  buffer_load_dwordx4 a[172:175], v2, s[8:11], s22 offen offset:3072 sc1
  s_add_u32 s22, s31, 45056
  buffer_load_dwordx4 a[176:179], v2, s[8:11], s22 offen offset:0 sc1
  buffer_load_dwordx4 a[180:183], v2, s[8:11], s22 offen offset:1024 sc1
  buffer_load_dwordx4 a[184:187], v2, s[8:11], s22 offen offset:2048 sc1
  buffer_load_dwordx4 a[188:191], v2, s[8:11], s22 offen offset:3072 sc1
  s_add_u32 s22, s31, 49152
  buffer_load_dwordx4 a[192:195], v2, s[8:11], s22 offen offset:0 sc1
  buffer_load_dwordx4 a[196:199], v2, s[8:11], s22 offen offset:1024 sc1
  buffer_load_dwordx4 a[200:203], v2, s[8:11], s22 offen offset:2048 sc1
  buffer_load_dwordx4 a[204:207], v2, s[8:11], s22 offen offset:3072 sc1
  s_add_u32 s22, s31, 53248
  buffer_load_dwordx4 a[208:211], v2, s[8:11], s22 offen offset:0 sc1
  buffer_load_dwordx4 a[212:215], v2, s[8:11], s22 offen offset:1024 sc1
  buffer_load_dwordx4 a[216:219], v2, s[8:11], s22 offen offset:2048 sc1
  buffer_load_dwordx4 a[220:223], v2, s[8:11], s22 offen offset:3072 sc1
  s_add_u32 s22, s31, 57344
  buffer_load_dwordx4 a[224:227], v2, s[8:11], s22 offen offset:0 sc1
  buffer_load_dwordx4 a[228:231], v2, s[8:11], s22 offen offset:1024 sc1
  buffer_load_dwordx4 a[232:235], v2, s[8:11], s22 offen offset:2048 sc1
  buffer_load_dwordx4 a[236:239], v2, s[8:11], s22 offen offset:3072 sc1
  s_add_u32 s22, s31, 61440
  buffer_load_dwordx4 a[240:243], v2, s[8:11], s22 offen offset:0 sc1
  buffer_load_dwordx4 a[244:247], v2, s[8:11], s22 offen offset:1024 sc1
  buffer_load_dwordx4 a[248:251], v2, s[8:11], s22 offen offset:2048 sc1
  buffer_load_dwordx4 a[252:255], v2, s[8:11], s22 offen offset:3072 sc1
  s_waitcnt vmcnt(24)
  s_add_u32 s22, s31, 65536
  buffer_load_dwordx4 v[120:123], v2, s[8:11], s22 offen offset:0 sc1
  buffer_load_dwordx4 v[124:127], v2, s[8:11], s22 offen offset:1024 sc1
  buffer_load_dwordx4 v[128:131], v2, s[8:11], s22 offen offset:2048 sc1
  buffer_load_dwordx4 v[132:135], v2, s[8:11], s22 offen offset:3072 sc1
  s_add_u32 s22, s31, 69632
  buffer_load_dwordx4 v[136:139], v2, s[8:11], s22 offen offset:0 sc1
  buffer_load_dwordx4 v[140:143], v2, s[8:11], s22 offen offset:1024 sc1
  buffer_load_dwordx4 v[144:147], v2, s[8:11], s22 offen offset:2048 sc1
  buffer_load_dwordx4 v[148:151], v2, s[8:11], s22 offen offset:3072 sc1
  s_add_u32 s22, s31, 73728
  buffer_load_dwordx4 v[152:155], v2, s[8:11], s22 offen offset:0 sc1
  buffer_load_dwordx4 v[156:159], v2, s[8:11], s22 offen offset:1024 sc1
  buffer_load_dwordx4 v[160:163], v2, s[8:11], s22 offen offset:2048 sc1
  buffer_load_dwordx4 v[164:167], v2, s[8:11], s22 offen offset:3072 sc1
  s_add_u32 s22, s31, 77824
  buffer_load_dwordx4 v[168:171], v2, s[8:11], s22 offen offset:0 sc1
  buffer_load_dwordx4 v[172:175], v2, s[8:11], s22 offen offset:1024 sc1
  buffer_load_dwordx4 v[176:179], v2, s[8:11], s22 offen offset:2048 sc1
  buffer_load_dwordx4 v[180:183], v2, s[8:11], s22 offen offset:3072 sc1
  s_add_u32 s22, s31, 81920
  buffer_load_dwordx4 v[184:187], v2, s[8:11], s22 offen offset:0 sc1
  buffer_load_dwordx4 v[188:191], v2, s[8:11], s22 offen offset:1024 sc1
  buffer_load_dwordx4 v[192:195], v2, s[8:11], s22 offen offset:2048 sc1
  buffer_load_dwordx4 v[196:199], v2, s[8:11], s22 offen offset:3072 sc1
  s_add_u32 s22, s31, 86016
  buffer_load_dwordx4 v[200:203], v2, s[8:11], s22 offen offset:0 sc1
  buffer_load_dwordx4 v[204:207], v2, s[8:11], s22 offen offset:1024 sc1
  buffer_load_dwordx4 v[208:211], v2, s[8:11], s22 offen offset:2048 sc1
  buffer_load_dwordx4 v[212:215], v2, s[8:11], s22 offen offset:3072 sc1
  s_add_u32 s22, s31, 90112
  buffer_load_dwordx4 v[216:219], v2, s[8:11], s22 offen offset:0 sc1
  buffer_load_dwordx4 v[220:223], v2, s[8:11], s22 offen offset:1024 sc1
  buffer_load_dwordx4 v[224:227], v2, s[8:11], s22 offen offset:2048 sc1
  buffer_load_dwordx4 v[228:231], v2, s[8:11], s22 offen offset:3072 sc1
  s_add_u32 s22, s31, 94208
  buffer_load_dwordx4 v[232:235], v2, s[8:11], s22 offen offset:0 sc1
  buffer_load_dwordx4 v[236:239], v2, s[8:11], s22 offen offset:1024 sc1
  buffer_load_dwordx4 v[240:243], v2, s[8:11], s22 offen offset:2048 sc1
  buffer_load_dwordx4 v[244:247], v2, s[8:11], s22 offen offset:3072 sc1
  s_waitcnt vmcnt(24)
  s_add_u32 s22, s31, 98304
  buffer_load_dwordx4 v[248:251], v2, s[8:11], s22 offen offset:0 sc1
  buffer_load_dwordx4 v[252:255], v2, s[8:11], s22 offen offset:1024 sc1
  s_lshl_b32 s27, s17, 7
  s_add_u32 s27, s27, 88461312
  s_mov_b32 s30, 0
ch_vw2:
  buffer_load_dword v9, off, s[8:11], s27 sc1
  s_waitcnt vmcnt(0)
  v_cmp_ne_u32 vcc, 56, v9
  s_cbranch_vccz ch_vw2_d
  s_sleep 2
  s_add_u32 s30, s30, 1
  s_cmp_lt_u32 s30, 400000
  s_cbranch_scc1 ch_vw2
  s_branch cA_abort
ch_vw2_d:
  s_mov_b32 s28, s35
  s_waitcnt vmcnt(0) lgkmcnt(0)
  s_mov_b32 s31, 0
  s_cmp_lg_u32 s88, 0
  s_cbranch_scc1 cB_va2_loop
  s_branch cA_va2_loop
ch_init7:
  v_mov_b32 v72, v116
  v_mov_b32 v73, v117
  v_lshrrev_b32 v65, 1, v72
  v_and_b32 v66, 1, v72
  v_mov_b32 v36, 0
  v_mov_b32 v37, 0
  v_mov_b32 v38, 0
  v_mov_b32 v39, 0
  v_mov_b32 v40, 0
  v_mov_b32 v41, 0
  v_mov_b32 v42, 0
  v_mov_b32 v43, 0
  v_mov_b32 v44, 0
  v_mov_b32 v45, 0
  v_mov_b32 v46, 0
  v_mov_b32 v47, 0
  v_mov_b32 v48, 0
  v_mov_b32 v49, 0
  v_mov_b32 v50, 0
  v_mov_b32 v51, 0
  v_mov_b32 v52, 0
  v_mov_b32 v53, 0
  v_mov_b32 v54, 0
  v_mov_b32 v55, 0
  v_mov_b32 v56, 0
  v_mov_b32 v57, 0
  v_mov_b32 v58, 0
  v_mov_b32 v59, 0
  v_mov_b32 v60, 0
  v_mov_b32 v61, 0
  v_mov_b32 v62, 0
  v_mov_b32 v63, 0
  v_lshlrev_b32 v75, 2, v65
  v_lshl_add_u32 v75, v66, 3, v75
  v_add_u32 v67, 336, v73
  v_mul_u32_u24 v68, 2341, v67
  v_lshrrev_b32 v68, 16, v68
  v_mul_u32_u24 v69, 28, v68
  v_sub_u32 v69, v67, v69
  v_lshrrev_b32 v70, 4, v69
  v_and_b32 v69, 15, v69
  v_lshlrev_b32 v71, 12, v70
  v_lshl_add_u32 v71, v68, 8, v71
  v_lshl_add_u32 v71, v69, 4, v71
  v_add_u32 v104, v71, v75
  v_add_u32 v67, 352, v73
  v_mul_u32_u24 v68, 2341, v67
  v_lshrrev_b32 v68, 16, v68
  v_mul_u32_u24 v69, 28, v68
  v_sub_u32 v69, v67, v69
  v_lshrrev_b32 v70, 4, v69
  v_and_b32 v69, 15, v69
  v_lshlrev_b32 v71, 12, v70
  v_lshl_add_u32 v71, v68, 8, v71
  v_lshl_add_u32 v71, v69, 4, v71
  v_add_u32 v105, v71, v75
  v_add_u32 v67, 368, v73
  v_mul_u32_u24 v68, 2341, v67
  v_lshrrev_b32 v68, 16, v68
  v_mul_u32_u24 v69, 28, v68
  v_sub_u32 v69, v67, v69
  v_lshrrev_b32 v70, 4, v69
  v_and_b32 v69, 15, v69
  v_lshlrev_b32 v71, 12, v70
  v_lshl_add_u32 v71, v68, 8, v71
  v_lshl_add_u32 v71, v69, 4, v71
  v_add_u32 v106, v71, v75
  v_add_u32 v67, 384, v73
  v_mul_u32_u24 v68, 2341, v67
  v_lshrrev_b32 v68, 16, v68
  v_mul_u32_u24 v69, 28, v68
  v_sub_u32 v69, v67, v69
  v_lshrrev_b32 v70, 4, v69
  v_and_b32 v69, 15, v69
  v_lshlrev_b32 v71, 12, v70
  v_lshl_add_u32 v71, v68, 8, v71
  v_lshl_add_u32 v71, v69, 4, v71
  v_add_u32 v107, v71, v75
  v_add_u32 v67, 400, v73
  v_mul_u32_u24 v68, 2341, v67
  v_lshrrev_b32 v68, 16, v68
  v_mul_u32_u24 v69, 28, v68
  v_sub_u32 v69, v67, v69
  v_lshrrev_b32 v70, 4, v69
  v_and_b32 v69, 15, v69
  v_lshlrev_b32 v71, 12, v70
  v_lshl_add_u32 v71, v68, 8, v71
  v_lshl_add_u32 v71, v69, 4, v71
  v_add_u32 v108, v71, v75
  v_add_u32 v67, 416, v73
  v_mul_u32_u24 v68, 2341, v67
  v_lshrrev_b32 v68, 16, v68
  v_mul_u32_u24 v69, 28, v68
  v_sub_u32 v69, v67, v69
  v_lshrrev_b32 v70, 4, v69
  v_and_b32 v69, 15, v69
  v_lshlrev_b32 v71, 12, v70
  v_lshl_add_u32 v71, v68, 8, v71
  v_lshl_add_u32 v71, v69, 4, v71
  v_add_u32 v109, v71, v75
  v_add_u32 v67, 432, v73
  v_mul_u32_u24 v68, 2341, v67
  v_lshrrev_b32 v68, 16, v68
  v_mul_u32_u24 v69, 28, v68
  v_sub_u32 v69, v67, v69
  v_lshrrev_b32 v70, 4, v69
  v_and_b32 v69, 15, v69
  v_lshlrev_b32 v71, 12, v70
  v_lshl_add_u32 v71, v68, 8, v71
  v_lshl_add_u32 v71, v69, 4, v71
  v_add_u32 v110, v71, v75
  v_mov_b32 v74, 0x40000000
  v_and_b32 v119, 15, v1
  s_and_b32 s22, s17, 0
  s_lshl_b32 s22, s22, 7
  s_add_u32 s22, s22, 75733504
  v_lshl_add_u32 v119, v119, 2, s22
  s_lshl_b32 s22, s17, 2
  s_add_u32 s22, s22, 75731456
  v_lshl_add_u32 v118, v1, 7, s22
  v_cmp_gt_u32 vcc, 1, v1
  s_nop 1
  v_cndmask_b32 v118, v74, v118, vcc
  s_lshl_b32 s35, s17, 7
  s_add_u32 s35, s35, 88461312
  v_min_u32 v116, 13, v1
  s_mul_i32 s22, s17, 14
  v_add_u32 v116, s22, v116
  v_lshlrev_b32 v116, 7, v116
  s_mul_i32 s31, s17, 401408
  s_add_u32 s31, s31, 6723584
  s_mov_b32 s30, 0
ch_wr7:
  buffer_load_dword v9, off, s[12:15], 0 offset:132 sc1
  s_waitcnt vmcnt(0)
  v_cmp_ne_u32 vcc, 1, v9
  s_cbranch_vccz ch_wr7_ok
  s_sleep 8
  s_add_u32 s30, s30, 1
  s_cmp_lt_u32 s30, 400000
  s_cbranch_scc1 ch_wr7
  s_branch cA_abort
ch_wr7_ok:
  s_lshr_b32 s22, s17, 2
  s_lshl_b32 s28, 0x81, s22
  s_mul_i32 s27, s17, 12
  s_add_u32 s22, s27, 256
  s_lshr_b32 s22, s22, 6
  s_lshl_b32 s22, 0x81, s22
  s_or_b32 s28, s28, s22
  s_add_u32 s22, s27, 267
  s_lshr_b32 s22, s22, 6
  s_lshl_b32 s22, 0x81, s22
  s_or_b32 s28, s28, s22
  v_lshrrev_b32 v12, 8, v2
  v_lshlrev_b32 v12, 7, v12
  s_mov_b32 s27, 88520704
  s_mov_b32 s30, 0
ch_ww7:
  buffer_load_dword v9, v12, s[8:11], s27 offen sc1
  s_waitcnt vmcnt(0)
  v_and_b32 v10, s28, v9
  v_cmp_ne_u32 vcc, s28, v10
  s_cbranch_vccz ch_ww7_ok
  s_sleep 3
  s_add_u32 s30, s30, 1
  s_cmp_lt_u32 s30, 400000
  s_cbranch_scc1 ch_ww7
  s_branch cA_abort
ch_ww7_ok:
  s_add_u32 s22, s31, 0
  buffer_load_dwordx4 a[0:3], v2, s[8:11], s22 offen offset:0 sc1
  buffer_load_dwordx4 a[4:7], v2, s[8:11], s22 offen offset:1024 sc1
  buffer_load_dwordx4 a[8:11], v2, s[8:11], s22 offen offset:2048 sc1
  buffer_load_dwordx4 a[12:15], v2, s[8:11], s22 offen offset:3072 sc1
  s_add_u32 s22, s31, 4096
  buffer_load_dwordx4 a[16:19], v2, s[8:11], s22 offen offset:0 sc1
  buffer_load_dwordx4 a[20:23], v2, s[8:11], s22 offen offset:1024 sc1
  buffer_load_dwordx4 a[24:27], v2, s[8:11], s22 offen offset:2048 sc1
  buffer_load_dwordx4 a[28:31], v2, s[8:11], s22 offen offset:3072 sc1
  s_add_u32 s22, s31, 8192
  buffer_load_dwordx4 a[32:35], v2, s[8:11], s22 offen offset:0 sc1
  buffer_load_dwordx4 a[36:39], v2, s[8:11], s22 offen offset:1024 sc1
  buffer_load_dwordx4 a[40:43], v2, s[8:11], s22 offen offset:2048 sc1
  buffer_load_dwordx4 a[44:47], v2, s[8:11], s22 offen offset:3072 sc1
  s_add_u32 s22, s31, 12288
  buffer_load_dwordx4 a[48:51], v2, s[8:11], s22 offen offset:0 sc1
  buffer_load_dwordx4 a[52:55], v2, s[8:11], s22 offen offset:1024 sc1
  buffer_load_dwordx4 a[56:59], v2, s[8:11], s22 offen offset:2048 sc1
  buffer_load_dwordx4 a[60:63], v2, s[8:11], s22 offen offset:3072 sc1
  s_add_u32 s22, s31, 16384
  buffer_load_dwordx4 a[64:67], v2, s[8:11], s22 offen offset:0 sc1
  buffer_load_dwordx4 a[68:71], v2, s[8:11], s22 offen offset:1024 sc1
  buffer_load_dwordx4 a[72:75], v2, s[8:11], s22 offen offset:2048 sc1
  buffer_load_dwordx4 a[76:79], v2, s[8:11], s22 offen offset:3072 sc1
  s_add_u32 s22, s31, 20480
  buffer_load_dwordx4 a[80:83], v2, s[8:11], s22 offen offset:0 sc1
  buffer_load_dwordx4 a[84:87], v2, s[8:11], s22 offen offset:1024 sc1
  buffer_load_dwordx4 a[88:91], v2, s[8:11], s22 offen offset:2048 sc1
  buffer_load_dwordx4 a[92:95], v2, s[8:11], s22 offen offset:3072 sc1
  s_add_u32 s22, s31, 24576
  buffer_load_dwordx4 a[96:99], v2, s[8:11], s22 offen offset:0 sc1
  buffer_load_dwordx4 a[100:103], v2, s[8:11], s22 offen offset:1024 sc1
  buffer_load_dwordx4 a[104:107], v2, s[8:11], s22 offen offset:2048 sc1
  buffer_load_dwordx4 a[108:111], v2, s[8:11], s22 offen offset:3072 sc1
  s_add_u32 s22, s31, 28672
  buffer_load_dwordx4 a[112:115], v2, s[8:11], s22 offen offset:0 sc1
  buffer_load_dwordx4 a[116:119], v2, s[8:11], s22 offen offset:1024 sc1
  buffer_load_dwordx4 a[120:123], v2, s[8:11], s22 offen offset:2048 sc1
  buffer_load_dwordx4 a[124:127], v2, s[8:11], s22 offen offset:3072 sc1
  s_waitcnt vmcnt(24)
  s_add_u32 s22, s31, 32768
  buffer_load_dwordx4 a[128:131], v2, s[8:11], s22 offen offset:0 sc1
  buffer_load_dwordx4 a[132:135], v2, s[8:11], s22 offen offset:1024 sc1
  buffer_load_dwordx4 a[136:139], v2, s[8:11], s22 offen offset:2048 sc1
  buffer_load_dwordx4 a[140:143], v2, s[8:11], s22 offen offset:3072 sc1
  s_add_u32 s22, s31, 36864
  buffer_load_dwordx4 a[144:147], v2, s[8:11], s22 offen offset:0 sc1
  buffer_load_dwordx4 a[148:151], v2, s[8:11], s22 offen offset:1024 sc1
  buffer_load_dwordx4 a[152:155], v2, s[8:11], s22 offen offset:2048 sc1
  buffer_load_dwordx4 a[156:159], v2, s[8:11], s22 offen offset:3072 sc1
  s_add_u32 s22, s31, 40960
  buffer_load_dwordx4 a[160:163], v2, s[8:11], s22 offen offset:0 sc1
  buffer_load_dwordx4 a[164:167], v2, s[8:11], s22 offen offset:1024 sc1
  buffer_load_dwordx4 a[168:171], v2, s[8:11], s22 offen offset:2048 sc1
  buffer_load_dwordx4 a[172:175], v2, s[8:11], s22 offen offset:3072 sc1
  s_add_u32 s22, s31, 45056
  buffer_load_dwordx4 a[176:179], v2, s[8:11], s22 offen offset:0 sc1
  buffer_load_dwordx4 a[180:183], v2, s[8:11], s22 offen offset:1024 sc1
  buffer_load_dwordx4 a[184:187], v2, s[8:11], s22 offen offset:2048 sc1
  buffer_load_dwordx4 a[188:191], v2, s[8:11], s22 offen offset:3072 sc1
  s_add_u32 s22, s31, 49152
  buffer_load_dwordx4 a[192:195], v2, s[8:11], s22 offen offset:0 sc1
  buffer_load_dwordx4 a[196:199], v2, s[8:11], s22 offen offset:1024 sc1
  buffer_load_dwordx4 a[200:203], v2, s[8:11], s22 offen offset:2048 sc1
  buffer_load_dwordx4 a[204:207], v2, s[8:11], s22 offen offset:3072 sc1
  s_add_u32 s22, s31, 53248
  buffer_load_dwordx4 a[208:211], v2, s[8:11], s22 offen offset:0 sc1
  buffer_load_dwordx4 a[212:215], v2, s[8:11], s22 offen offset:1024 sc1
  buffer_load_dwordx4 a[216:219], v2, s[8:11], s22 offen offset:2048 sc1
  buffer_load_dwordx4 a[220:223], v2, s[8:11], s22 offen offset:3072 sc1
  s_add_u32 s22, s31, 57344
  buffer_load_dwordx4 a[224:227], v2, s[8:11], s22 offen offset:0 sc1
  buffer_load_dwordx4 a[228:231], v2, s[8:11], s22 offen offset:1024 sc1
  buffer_load_dwordx4 a[232:235], v2, s[8:11], s22 offen offset:2048 sc1
  buffer_load_dwordx4 a[236:239], v2, s[8:11], s22 offen offset:3072 sc1
  s_add_u32 s22, s31, 61440
  buffer_load_dwordx4 a[240:243], v2, s[8:11], s22 offen offset:0 sc1
  buffer_load_dwordx4 a[244:247], v2, s[8:11], s22 offen offset:1024 sc1
  buffer_load_dwordx4 a[248:251], v2, s[8:11], s22 offen offset:2048 sc1
  buffer_load_dwordx4 a[252:255], v2, s[8:11], s22 offen offset:3072 sc1
  s_waitcnt vmcnt(24)
  s_add_u32 s22, s31, 65536
  buffer_load_dwordx4 v[120:123], v2, s[8:11], s22 offen offset:0 sc1
  buffer_load_dwordx4 v[124:127], v2, s[8:11], s22 offen offset:1024 sc1
  buffer_load_dwordx4 v[128:131], v2, s[8:11], s22 offen offset:2048 sc1
  buffer_load_dwordx4 v[132:135], v2, s[8:11], s22 offen offset:3072 sc1
  s_add_u32 s22, s31, 69632
  buffer_load_dwordx4 v[136:139], v2, s[8:11], s22 offen offset:0 sc1
  buffer_load_dwordx4 v[140:143], v2, s[8:11], s22 offen offset:1024 sc1
  buffer_load_dwordx4 v[144:147], v2, s[8:11], s22 offen offset:2048 sc1
  buffer_load_dwordx4 v[148:151], v2, s[8:11], s22 offen offset:3072 sc1
  s_add_u32 s22, s31, 73728
  buffer_load_dwordx4 v[152:155], v2, s[8:11], s22 offen offset:0 sc1
  buffer_load_dwordx4 v[156:159], v2, s[8:11], s22 offen offset:1024 sc1
  buffer_load_dwordx4 v[160:163], v2, s[8:11], s22 offen offset:2048 sc1
  buffer_load_dwordx4 v[164:167], v2, s[8:11], s22 offen offset:3072 sc1
  s_add_u32 s22, s31, 77824
  buffer_load_dwordx4 v[168:171], v2, s[8:11], s22 offen offset:0 sc1
  buffer_load_dwordx4 v[172:175], v2, s[8:11], s22 offen offset:1024 sc1
  buffer_load_dwordx4 v[176:179], v2, s[8:11], s22 offen offset:2048 sc1
  buffer_load_dwordx4 v[180:183], v2, s[8:11], s22 offen offset:3072 sc1
  s_add_u32 s22, s31, 81920
  buffer_load_dwordx4 v[184:187], v2, s[8:11], s22 offen offset:0 sc1
  buffer_load_dwordx4 v[188:191], v2, s[8:11], s22 offen offset:1024 sc1
  buffer_load_dwordx4 v[192:195], v2, s[8:11], s22 offen offset:2048 sc1
  buffer_load_dwordx4 v[196:199], v2, s[8:11], s22 offen offset:3072 sc1
  s_add_u32 s22, s31, 86016
  buffer_load_dwordx4 v[200:203], v2, s[8:11], s22 offen offset:0 sc1
  buffer_load_dwordx4 v[204:207], v2, s[8:11], s22 offen offset:1024 sc1
  buffer_load_dwordx4 v[208:211], v2, s[8:11], s22 offen offset:2048 sc1
  buffer_load_dwordx4 v[212:215], v2, s[8:11], s22 offen offset:3072 sc1
  s_add_u32 s22, s31, 90112
  buffer_load_dwordx4 v[216:219], v2, s[8:11], s22 offen offset:0 sc1
  buffer_load_dwordx4 v[220:223], v2, s[8:11], s22 offen offset:1024 sc1
  buffer_load_dwordx4 v[224:227], v2, s[8:11], s22 offen offset:2048 sc1
  buffer_load_dwordx4 v[228:231], v2, s[8:11], s22 offen offset:3072 sc1
  s_add_u32 s22, s31, 94208
  buffer_load_dwordx4 v[232:235], v2, s[8:11], s22 offen offset:0 sc1
  buffer_load_dwordx4 v[236:239], v2, s[8:11], s22 offen offset:1024 sc1
  buffer_load_dwordx4 v[240:243], v2, s[8:11], s22 offen offset:2048 sc1
  buffer_load_dwordx4 v[244:247], v2, s[8:11], s22 offen offset:3072 sc1
  s_waitcnt vmcnt(24)
  s_add_u32 s22, s31, 98304
  buffer_load_dwordx4 v[248:251], v2, s[8:11], s22 offen offset:0 sc1
  buffer_load_dwordx4 v[252:255], v2, s[8:11], s22 offen offset:1024 sc1
  s_lshl_b32 s27, s17, 7
  s_add_u32 s27, s27, 88461312
  s_mov_b32 s30, 0
ch_vw3:
  buffer_load_dword v9, off, s[8:11], s27 sc1
  s_waitcnt vmcnt(0)
  v_cmp_ne_u32 vcc, 56, v9
  s_cbranch_vccz ch_vw3_d
  s_sleep 2
  s_add_u32 s30, s30, 1
  s_cmp_lt_u32 s30, 400000
  s_cbranch_scc1 ch_vw3
  s_branch cA_abort
ch_vw3_d:
  s_mov_b32 s28, s35
  s_mov_b32 s39, 72052736
  buffer_load_dword v100, v116, s[8:11], s39 offen sc1
  s_mov_b32 s39, 72081408
  s_waitcnt vmcnt(1) lgkmcnt(0)
  s_mov_b32 s31, 0
  s_cmp_lg_u32 s88, 0
  s_cbranch_scc1 cB_va3_loop
  s_branch cA_va3_loop
.p2align 6
cA_sc0_loop:
  s_mov_b32 s30, 0
  s_mov_b32 s62, 0
  s_setprio 3
  s_sleep 6
  buffer_load_dword v24, v0, s[8:11], 0 offen sc1
  buffer_load_dword v25, v0, s[8:11], 0 offen sc1
  buffer_load_dword v26, v0, s[8:11], 0 offen sc1
  buffer_load_dword v27, v0, s[8:11], 0 offen sc1
  buffer_load_dword v28, v0, s[8:11], 0 offen sc1
cA_sc0_fp_l:
  s_waitcnt vmcnt(4)
  v_cmp_gt_u32 vcc, s19, v24
  buffer_load_dword v24, v0, s[8:11], 0 offen sc1
  s_cbranch_vccz cA_sc0_fp_d
  s_waitcnt vmcnt(4)
  v_cmp_gt_u32 vcc, s19, v25
  buffer_load_dword v25, v0, s[8:11], 0 offen sc1
  s_cbranch_vccz cA_sc0_fp_d
  s_waitcnt vmcnt(4)
  v_cmp_gt_u32 vcc, s19, v26
  buffer_load_dword v26, v0, s[8:11], 0 offen sc1
  s_cbranch_vccz cA_sc0_fp_d
  s_waitcnt vmcnt(4)
  v_cmp_gt_u32 vcc, s19, v27
  buffer_load_dword v27, v0, s[8:11], 0 offen sc1
  s_cbranch_vccz cA_sc0_fp_d
  s_waitcnt vmcnt(4)
  v_cmp_gt_u32 vcc, s19, v28
  buffer_load_dword v28, v0, s[8:11], 0 offen sc1
  s_cbranch_vccz cA_sc0_fp_d
  s_waitcnt vmcnt(4)
  v_cmp_gt_u32 vcc, s19, v24
  buffer_load_dword v24, v0, s[8:11], 0 offen sc1
  s_cbranch_vccz cA_sc0_fp_d
  s_waitcnt vmcnt(4)
  v_cmp_gt_u32 vcc, s19, v25
  buffer_load_dword v25, v0, s[8:11], 0 offen sc1
  s_cbranch_vccz cA_sc0_fp_d
  s_waitcnt vmcnt(4)
  v_cmp_gt_u32 vcc, s19, v26
  buffer_load_dword v26, v0, s[8:11], 0 offen sc1
  s_cbranch_vccz cA_sc0_fp_d
  s_waitcnt vmcnt(4)
  v_cmp_gt_u32 vcc, s19, v27
  buffer_load_dword v27, v0, s[8:11], 0 offen sc1
  s_cbranch_vccz cA_sc0_fp_d
  s_waitcnt vmcnt(4)
  v_cmp_gt_u32 vcc, s19, v28
  buffer_load_dword v28, v0, s[8:11], 0 offen sc1
  s_cbranch_vccz cA_sc0_fp_d
  s_waitcnt vmcnt(4)
  v_cmp_gt_u32 vcc, s19, v24
  buffer_load_dword v24, v0, s[8:11], 0 offen sc1
  s_cbranch_vccz cA_sc0_fp_d
  s_waitcnt vmcnt(4)
  v_cmp_gt_u32 vcc, s19, v25
  buffer_load_dword v25, v0, s[8:11], 0 offen sc1
  s_cbranch_vccz cA_sc0_fp_d
  s_waitcnt vmcnt(4)
  v_cmp_gt_u32 vcc, s19, v26
  buffer_load_dword v26, v0, s[8:11], 0 offen sc1
  s_cbranch_vccz cA_sc0_fp_d
  s_waitcnt vmcnt(4)
  v_cmp_gt_u32 vcc, s19, v27
  buffer_load_dword v27, v0, s[8:11], 0 offen sc1
  s_cbranch_vccz cA_sc0_fp_d
  s_waitcnt vmcnt(4)
  v_cmp_gt_u32 vcc, s19, v28
  buffer_load_dword v28, v0, s[8:11], 0 offen sc1
  s_cbranch_vccz cA_sc0_fp_d
  s_add_u32 s30, s30, 1
  s_cmp_lt_u32 s30, 400000
  s_cbranch_scc1 cA_sc0_fp_l
  s_branch cA_abort
cA_sc0_fp_d:
  buffer_load_dwordx4 v[8:11], v2, s[8:11], s20 offen offset:0 sc1
  s_barrier
  s_setprio 2
  buffer_load_dwordx4 v[12:15], v2, s[8:11], s20 offen offset:1024 sc1
  s_setprio 1
  buffer_load_dwordx4 v[16:19], v2, s[8:11], s20 offen offset:2048 sc1
  s_setprio 0
  buffer_load_dwordx4 v[20:23], v2, s[8:11], s20 offen offset:3072 sc1
cA_sc0_go:
  s_waitcnt vmcnt(3)
  v_smfmac_f32_16x16x64_bf16 v[36:39], v[8:11], a[0:7], v3
  buffer_load_dwordx4 v[32:35], v2, s[8:11], s23 offen offset:0 sc1
  v_cmp_eq_u32 vcc, -1, v8
  v_smfmac_f32_16x16x64_bf16 v[40:43], v[8:11], a[56:63], v3
  v_smfmac_f32_16x16x64_bf16 v[44:47], v[8:11], a[112:119], v3
  buffer_load_dwordx4 v[24:27], v2, s[8:11], s23 offen offset:1024 sc1
  s_cbranch_vccnz cA_sc0_r0
  v_smfmac_f32_16x16x64_bf16 v[48:51], v[8:11], a[168:175], v3
  v_smfmac_f32_16x16x64_bf16 v[52:55], v[8:11], a[224:231], v3
  s_waitcnt vmcnt(4)
  v_cmp_eq_u32 vcc, -1, v12
  v_smfmac_f32_16x16x64_bf16 v[56:59], v[8:11], v[144:151], v3
  buffer_load_dwordx4 v[28:31], v2, s[8:11], s23 offen offset:2048 sc1
  v_smfmac_f32_16x16x64_bf16 v[60:63], v[8:11], v[200:207], v3
  s_cbranch_vccnz cA_sc0_r1
cA_sc0_c1:
  v_smfmac_f32_16x16x64_bf16 v[36:39], v[12:15], a[8:15], v3
  v_smfmac_f32_16x16x64_bf16 v[40:43], v[12:15], a[64:71], v3
  v_smfmac_f32_16x16x64_bf16 v[44:47], v[12:15], a[120:127], v3
  v_smfmac_f32_16x16x64_bf16 v[48:51], v[12:15], a[176:183], v3
  v_smfmac_f32_16x16x64_bf16 v[52:55], v[12:15], a[232:239], v3
  s_waitcnt vmcnt(4)
  v_cmp_eq_u32 vcc, -1, v16
  v_smfmac_f32_16x16x64_bf16 v[56:59], v[12:15], v[152:159], v3
  buffer_load_dwordx4 v[88:91], v117, s[8:11], s26 offen offset:0 sc1
  v_smfmac_f32_16x16x64_bf16 v[60:63], v[12:15], v[208:215], v3
  s_cbranch_vccnz cA_sc0_r2
cA_sc0_c2:
  v_smfmac_f32_16x16x64_bf16 v[36:39], v[16:19], a[16:23], v3
  v_smfmac_f32_16x16x64_bf16 v[40:43], v[16:19], a[72:79], v3
  v_smfmac_f32_16x16x64_bf16 v[44:47], v[16:19], a[128:135], v3
  buffer_load_dwordx4 v[92:95], v117, s[8:11], s26 offen offset:1024 sc1
  v_smfmac_f32_16x16x64_bf16 v[48:51], v[16:19], a[184:191], v3
  v_smfmac_f32_16x16x64_bf16 v[52:55], v[16:19], a[240:247], v3
  s_waitcnt vmcnt(5)
  v_cmp_eq_u32 vcc, -1, v20
  v_smfmac_f32_16x16x64_bf16 v[56:59], v[16:19], v[160:167], v3
  v_smfmac_f32_16x16x64_bf16 v[60:63], v[16:19], v[216:223], v3
  buffer_load_dwordx4 v[96:99], v2, s[8:11], s24 offen offset:0 sc1
  s_cbranch_vccnz cA_sc0_r3
cA_sc0_c3:
  v_smfmac_f32_16x16x64_bf16 v[36:39], v[20:23], a[24:31], v3
  v_smfmac_f32_16x16x64_bf16 v[40:43], v[20:23], a[80:87], v3
  s_waitcnt vmcnt(3)
  v_max3_u32 v66, v24, v27, v28
  v_smfmac_f32_16x16x64_bf16 v[44:47], v[20:23], a[136:143], v3
  v_max3_u32 v66, v66, v31, v32
  v_smfmac_f32_16x16x64_bf16 v[48:51], v[20:23], a[192:199], v3
  buffer_load_dwordx4 v[100:103], v2, s[8:11], s24 offen offset:1024 sc1
  v_max_u32 v66, v66, v35
  v_smfmac_f32_16x16x64_bf16 v[52:55], v[20:23], a[248:255], v3
  v_cmp_eq_u32 vcc, -1, v66
  v_smfmac_f32_16x16x64_bf16 v[56:59], v[20:23], v[168:175], v3
  v_smfmac_f32_16x16x64_bf16 v[60:63], v[20:23], v[224:231], v3
  s_cbranch_vccnz cA_sc0_r4
cA_sc0_c4:
  v_smfmac_f32_16x16x64_bf16 v[60:63], v[32:35], v[232:239], v3
  buffer_load_dwordx4 v[104:107], v2, s[8:11], s26 offen offset:0 sc1
  v_smfmac_f32_16x16x64_bf16 v[60:63], v[24:27], v[240:247], v3
  v_smfmac_f32_16x16x64_bf16 v[60:63], v[28:31], v[248:255], v3
  v_smfmac_f32_16x16x64_bf16 v[52:55], v[32:35], v[120:127], v3
  v_smfmac_f32_16x16x64_bf16 v[52:55], v[24:27], v[128:135], v3
  buffer_load_dwordx4 v[108:111], v2, s[8:11], s26 offen offset:1024 sc1
  v_smfmac_f32_16x16x64_bf16 v[52:55], v[28:31], v[136:143], v3
  v_cvt_pk_bf16_f32 v63, v62, v63
  v_smfmac_f32_16x16x64_bf16 v[56:59], v[32:35], v[176:183], v3
  v_cvt_pk_bf16_f32 v62, v60, v61
  v_smfmac_f32_16x16x64_bf16 v[56:59], v[24:27], v[184:191], v3
  v_mfma_f32_16x16x32_bf16 v[12:15], v[62:65], v[4:7], 0
  v_cvt_pk_bf16_f32 v55, v54, v55
  v_smfmac_f32_16x16x64_bf16 v[56:59], v[28:31], v[192:199], v3
  v_cvt_pk_bf16_f32 v54, v52, v53
  v_smfmac_f32_16x16x64_bf16 v[36:39], v[32:35], a[32:39], v3
  s_nop 1
  v_cvt_pk_bf16_f32 v76, v12, v13
  v_smfmac_f32_16x16x64_bf16 v[36:39], v[24:27], a[40:47], v3
  v_cvt_pk_bf16_f32 v77, v14, v15
  v_smfmac_f32_16x16x64_bf16 v[36:39], v[28:31], a[48:55], v3
  v_cvt_pk_bf16_f32 v56, v56, v57
  v_smfmac_f32_16x16x64_bf16 v[40:43], v[32:35], a[88:95], v3
  v_cvt_pk_bf16_f32 v57, v58, v59
  v_smfmac_f32_16x16x64_bf16 v[40:43], v[24:27], a[96:103], v3
  v_mfma_f32_16x16x32_bf16 v[16:19], v[54:57], v[4:7], 0
  v_cvt_pk_bf16_f32 v39, v38, v39
  v_smfmac_f32_16x16x64_bf16 v[40:43], v[28:31], a[104:111], v3
  v_cvt_pk_bf16_f32 v38, v36, v37
  v_smfmac_f32_16x16x64_bf16 v[44:47], v[32:35], a[144:151], v3
  s_nop 1
  v_cvt_pk_bf16_f32 v78, v16, v17
  v_smfmac_f32_16x16x64_bf16 v[44:47], v[24:27], a[152:159], v3
  v_cvt_pk_bf16_f32 v79, v18, v19
  v_smfmac_f32_16x16x64_bf16 v[44:47], v[28:31], a[160:167], v3
  v_cvt_pk_bf16_f32 v40, v40, v41
  v_smfmac_f32_16x16x64_bf16 v[48:51], v[32:35], a[200:207], v3
  v_cvt_pk_bf16_f32 v41, v42, v43
  v_smfmac_f32_16x16x64_bf16 v[48:51], v[24:27], a[208:215], v3
  v_smfmac_f32_16x16x64_bf16 v[48:51], v[28:31], a[216:223], v3
  s_waitcnt vmcnt(4)
  v_cvt_pk_bf16_f32 v47, v46, v47
  v_smfmac_f32_16x16x64_bf16 v[68:71], v[76:79], v[80:87], v3
  v_cvt_pk_bf16_f32 v46, v44, v45
  v_mfma_f32_16x16x32_bf16 v[12:15], v[38:41], v[4:7], 0
  s_nop 1
  v_cvt_pk_bf16_f32 v48, v48, v49
  v_cvt_pk_bf16_f32 v49, v50, v51
  s_nop 1
  v_mfma_f32_16x16x32_bf16 v[16:19], v[46:49], v[4:7], 0
  v_smfmac_f32_16x16x64_bf16 v[72:75], v[76:79], v[88:95], v3
  v_cvt_pk_bf16_f32 v20, v12, v13
  v_mfma_f32_16x16x32_bf16 v[52:55], v[30:33], v[76:79], 0
  s_waitcnt vmcnt(0)
  v_cvt_pk_bf16_f32 v21, v14, v15
  v_cvt_pk_bf16_f32 v22, v16, v17
  v_cvt_pk_bf16_f32 v23, v18, v19
  s_nop 1
  v_mfma_f32_16x16x32_bf16 v[52:55], v[8:11], v[20:23], v[52:55]
  v_smfmac_f32_16x16x64_bf16 v[68:71], v[20:23], v[96:103], v3
  v_smfmac_f32_16x16x64_bf16 v[72:75], v[20:23], v[104:111], v3
  s_nop 1
  ds_write_b128 v113, v[52:55]
  s_nop 1
  v_permlane32_swap_b32 v68, v70
  v_permlane32_swap_b32 v69, v71
  v_add_f32 v56, v68, v70
  v_add_f32 v58, v69, v71
  v_permlane32_swap_b32 v72, v74
  v_permlane32_swap_b32 v73, v75
  v_add_f32 v57, v72, v74
  v_add_f32 v59, v73, v75
  ds_write_b128 v2, v[56:59] offset:0
  v_cmp_u_f32 vcc, v57, v59
  v_mov_b32 v68, 0
  v_mov_b32 v69, 0
  v_mov_b32 v70, 0
  v_mov_b32 v71, 0
  s_cbranch_vccnz cA_sc0_retry
cA_sc0_cont:
  s_add_u32 s24, s24, 28672
  s_add_u32 s26, s26, 28672
  buffer_load_dwordx4 v[80:83], v117, s[8:11], s24 offen offset:0 sc1
  buffer_load_dwordx4 v[84:87], v117, s[8:11], s24 offen offset:1024 sc1
  v_mov_b32 v72, 0
  v_mov_b32 v73, 0
  v_mfma_f32_32x32x16_bf16 v[36:51], v[68:71], v[68:71], 0
  s_waitcnt lgkmcnt(0)
  s_barrier
  ds_read_b64 v[8:9], v114 offset:0
  ds_read_b64 v[10:11], v114 offset:1024
  ds_read_b64 v[12:13], v114 offset:2048
  ds_read_b64 v[14:15], v114 offset:3072
  ds_read2_b32 v[16:17], v115 offset0:0 offset1:64
  ds_read2_b32 v[18:19], v115 offset0:128 offset1:192
  v_mfma_f32_32x32x16_bf16 v[52:67], v[68:71], v[68:71], 0
  s_waitcnt lgkmcnt(0)
  v_pk_add_f32 v[16:17], v[16:17], v[18:19]
  v_pk_add_f32 v[8:9], v[8:9], v[10:11]
  v_pk_add_f32 v[12:13], v[12:13], v[14:15]
  v_add_f32 v20, v16, v17
  v_pk_add_f32 v[8:9], v[8:9], v[12:13]
  v_max_f32 v22, v8, v9
  v_add_f32_dpp v20, v20, v20 row_ror:8 row_mask:0xf bank_mask:0xf
  s_nop 0
  v_max_f32_dpp v22, v22, v22 row_ror:8 row_mask:0xf bank_mask:0xf
  v_max_f32 v22, v22, v20
  s_nop 1
  v_max_f32_dpp v22, v22, v22 quad_perm:[1,0,3,2] row_mask:0xf bank_mask:0xf
  s_nop 1
  v_max_f32_dpp v22, v22, v22 quad_perm:[2,3,0,1] row_mask:0xf bank_mask:0xf
  s_nop 1
  v_max_f32_dpp v22, v22, v22 row_half_mirror row_mask:0xf bank_mask:0xf
  v_pk_add_f32 v[8:9], v[8:9], v[22:23] op_sel_hi:[1,0] neg_lo:[0,1] neg_hi:[0,1]
  v_sub_f32 v20, v20, v22
  v_exp_f32 v8, v8
  v_exp_f32 v9, v9
  v_exp_f32 v20, v20
  v_add_f32 v24, v8, v9
  v_fmac_f32 v24, 0.5, v20
  v_mov_b32_dpp v21, v20 quad_perm:[1,0,3,2] row_mask:0xf bank_mask:0xf
  s_nop 0
  v_add_f32_dpp v24, v24, v24 quad_perm:[1,0,3,2] row_mask:0xf bank_mask:0xf
  s_nop 1
  v_add_f32_dpp v24, v24, v24 quad_perm:[2,3,0,1] row_mask:0xf bank_mask:0xf
  s_nop 1
  v_add_f32_dpp v24, v24, v24 row_half_mirror row_mask:0xf bank_mask:0xf
  s_nop 1
  v_add_f32_dpp v24, v24, v24 row_ror:8 row_mask:0xf bank_mask:0xf
  v_rcp_f32 v24, v24
  s_nop 0
  v_pk_mul_f32 v[8:9], v[8:9], v[24:25] op_sel_hi:[1,0]
  v_pk_mul_f32 v[20:21], v[20:21], v[24:25] op_sel_hi:[1,0]
  v_cvt_pk_bf16_f32 v8, v8, v9
  v_cvt_pk_bf16_f32 v20, v20, v21
  v_min_u32 v8, -2, v8
  buffer_store_dword v8, v1, s[8:11], s20 offen
  v_min_u32 v20, -2, v20
  buffer_store_dword v20, v118, s[8:11], s20 offen
  v_mov_b32 v74, 0
  v_mov_b32 v75, 0
  s_mov_b32 s19, s18
  s_add_u32 s18, s18, 1
  s_mov_b32 s22, s20
  s_mov_b32 s20, s21
  s_mov_b32 s21, s22
  s_add_u32 s23, s20, 4096
  s_cmp_lt_u32 s19, 63
  s_cbranch_scc1 cA_sc0_loop
  s_branch cA_done
cA_sc0_r0:
  s_add_u32 s31, s31, 1
  buffer_load_dwordx4 v[8:11], v2, s[8:11], s20 offen offset:0 sc1
  s_waitcnt vmcnt(0)
  v_cmp_eq_u32 vcc, -1, v8
  v_mov_b32 v36, 0
  v_mov_b32 v37, 0
  v_mov_b32 v38, 0
  v_mov_b32 v39, 0
  v_mov_b32 v40, 0
  v_mov_b32 v41, 0
  v_mov_b32 v42, 0
  v_mov_b32 v43, 0
  v_mov_b32 v44, 0
  v_mov_b32 v45, 0
  v_mov_b32 v46, 0
  v_mov_b32 v47, 0
  v_mov_b32 v48, 0
  v_mov_b32 v49, 0
  v_mov_b32 v50, 0
  v_mov_b32 v51, 0
  s_nop 1
  s_cbranch_vccz cA_sc0_go
  s_add_u32 s30, s30, 1
  s_cmp_lt_u32 s30, 400000
  s_cbranch_scc1 cA_sc0_r0
  s_branch cA_abort
cA_sc0_r1:
  s_add_u32 s31, s31, 1
  buffer_load_dwordx4 v[12:15], v2, s[8:11], s20 offen offset:1024 sc1
  s_waitcnt vmcnt(0)
  v_cmp_eq_u32 vcc, -1, v12
  s_nop 4
  s_cbranch_vccz cA_sc0_c1
  s_add_u32 s30, s30, 1
  s_cmp_lt_u32 s30, 400000
  s_cbranch_scc1 cA_sc0_r1
  s_branch cA_abort
cA_sc0_r2:
  s_add_u32 s31, s31, 1
  buffer_load_dwordx4 v[16:19], v2, s[8:11], s20 offen offset:2048 sc1
  s_waitcnt vmcnt(0)
  v_cmp_eq_u32 vcc, -1, v16
  s_nop 4
  s_cbranch_vccz cA_sc0_c2
  s_add_u32 s30, s30, 1
  s_cmp_lt_u32 s30, 400000
  s_cbranch_scc1 cA_sc0_r2
  s_branch cA_abort
cA_sc0_r3:
  s_add_u32 s31, s31, 1
  buffer_load_dwordx4 v[20:23], v2, s[8:11], s20 offen offset:3072 sc1
  s_waitcnt vmcnt(0)
  v_cmp_eq_u32 vcc, -1, v20
  s_nop 4
  s_cbranch_vccz cA_sc0_c3
  s_add_u32 s30, s30, 1
  s_cmp_lt_u32 s30, 400000
  s_cbranch_scc1 cA_sc0_r3
  s_branch cA_abort
cA_sc0_r4:
  s_add_u32 s31, s31, 1
  buffer_load_dwordx4 v[32:35], v2, s[8:11], s23 offen offset:0 sc1
  buffer_load_dwordx4 v[24:27], v2, s[8:11], s23 offen offset:1024 sc1
  buffer_load_dwordx4 v[28:31], v2, s[8:11], s23 offen offset:2048 sc1
  s_waitcnt vmcnt(0)
  v_max3_u32 v66, v24, v27, v28
  v_max3_u32 v66, v66, v31, v32
  v_max_u32 v66, v66, v35
  v_cmp_eq_u32 vcc, -1, v66
  s_nop 4
  s_cbranch_vccz cA_sc0_c4
  s_add_u32 s30, s30, 1
  s_cmp_lt_u32 s30, 400000
  s_cbranch_scc1 cA_sc0_r4
  s_branch cA_abort
cA_sc0_retry:
  s_cmp_lg_u32 s62, 0
  s_cbranch_scc1 cA_sc0_cont
  s_waitcnt vmcnt(0) lgkmcnt(0)
cA_sc0_rv:
  buffer_load_dwordx4 v[8:11], v2, s[8:11], s20 offen offset:0 sc1
  buffer_load_dwordx4 v[12:15], v2, s[8:11], s20 offen offset:1024 sc1
  buffer_load_dwordx4 v[16:19], v2, s[8:11], s20 offen offset:2048 sc1
  buffer_load_dwordx4 v[20:23], v2, s[8:11], s20 offen offset:3072 sc1
  buffer_load_dwordx4 v[32:35], v2, s[8:11], s23 offen offset:0 sc1
  buffer_load_dwordx4 v[24:27], v2, s[8:11], s23 offen offset:1024 sc1
  buffer_load_dwordx4 v[28:31], v2, s[8:11], s23 offen offset:2048 sc1
  s_waitcnt vmcnt(0)
  v_pk_max_u16 v66, v8, v9
  v_pk_max_u16 v66, v66, v10
  v_pk_max_u16 v66, v66, v11
  v_pk_max_u16 v66, v66, v12
  v_pk_max_u16 v66, v66, v13
  v_pk_max_u16 v66, v66, v14
  v_pk_max_u16 v66, v66, v15
  v_pk_max_u16 v66, v66, v16
  v_pk_max_u16 v66, v66, v17
  v_pk_max_u16 v66, v66, v18
  v_pk_max_u16 v66, v66, v19
  v_pk_max_u16 v66, v66, v20
  v_pk_max_u16 v66, v66, v21
  v_pk_max_u16 v66, v66, v22
  v_pk_max_u16 v66, v66, v23
  v_pk_max_u16 v66, v66, v24
  v_pk_max_u16 v66, v66, v25
  v_pk_max_u16 v66, v66, v26
  v_pk_max_u16 v66, v66, v27
  v_pk_max_u16 v66, v66, v28
  v_pk_max_u16 v66, v66, v29
  v_pk_max_u16 v66, v66, v30
  v_pk_max_u16 v66, v66, v31
  v_pk_max_u16 v66, v66, v32
  v_pk_max_u16 v66, v66, v33
  v_pk_max_u16 v66, v66, v34
  v_pk_max_u16 v66, v66, v35
  v_lshlrev_b32 v67, 16, v66
  v_max_u32 v66, v66, v67
  v_cmp_le_u32 vcc, 0xffff0000, v66
  s_cbranch_vccz cA_sc0_rk
  s_add_u32 s30, s30, 1
  s_cmp_lt_u32 s30, 400000
  s_cbranch_scc1 cA_sc0_rv
  s_branch cA_abort
cA_sc0_rk:
  s_mov_b32 s62, 1
  v_mov_b32 v36, 0
  v_mov_b32 v37, 0
  v_mov_b32 v38, 0
  v_mov_b32 v39, 0
  v_mov_b32 v40, 0
  v_mov_b32 v41, 0
  v_mov_b32 v42, 0
  v_mov_b32 v43, 0
  v_mov_b32 v44, 0
  v_mov_b32 v45, 0
  v_mov_b32 v46, 0
  v_mov_b32 v47, 0
  v_mov_b32 v48, 0
  v_mov_b32 v49, 0
  v_mov_b32 v50, 0
  v_mov_b32 v51, 0
  v_mov_b32 v60, 0
  v_mov_b32 v61, 0
  v_mov_b32 v62, 0
  v_mov_b32 v63, 0
  v_mov_b32 v68, 0
  v_mov_b32 v69, 0
  v_mov_b32 v70, 0
  v_mov_b32 v71, 0
  v_mov_b32 v72, 0
  v_mov_b32 v73, 0
  v_mov_b32 v74, 0
  v_mov_b32 v75, 0
  v_mov_b32 v52, 0
  v_mov_b32 v53, 0
  v_mov_b32 v54, 0
  v_mov_b32 v55, 0
  v_mov_b32 v56, 0
  v_mov_b32 v57, 0
  v_mov_b32 v58, 0
  v_mov_b32 v59, 0
  s_add_u32 s31, s31, 0x100
  s_nop 0
  s_branch cA_sc0_go
.p2align 6
cA_sc1_loop:
  s_mov_b32 s30, 0
  s_mov_b32 s62, 0
  s_setprio 3
  s_barrier
  buffer_load_dwordx4 v[8:11], v2, s[8:11], s20 offen offset:0 sc1
  s_setprio 2
  buffer_load_dwordx4 v[12:15], v2, s[8:11], s20 offen offset:1024 sc1
  s_setprio 1
  buffer_load_dwordx4 v[16:19], v2, s[8:11], s20 offen offset:2048 sc1
  s_setprio 0
  buffer_load_dwordx4 v[20:23], v2, s[8:11], s20 offen offset:3072 sc1
cA_sc1_go:
  s_waitcnt vmcnt(3)
  v_smfmac_f32_16x16x64_bf16 v[36:39], v[8:11], a[0:7], v3
  buffer_load_dwordx4 v[28:31], v2, s[8:11], s23 offen offset:0 sc1
  v_cmp_eq_u32 vcc, -1, v8
  v_smfmac_f32_16x16x64_bf16 v[40:43], v[8:11], a[56:63], v3
  v_smfmac_f32_16x16x64_bf16 v[44:47], v[8:11], a[112:119], v3
  buffer_load_dwordx4 v[24:27], v2, s[8:11], s23 offen offset:1024 sc1
  s_cbranch_vccnz cA_sc1_r0
  v_smfmac_f32_16x16x64_bf16 v[48:51], v[8:11], a[168:175], v3
  v_smfmac_f32_16x16x64_bf16 v[52:55], v[8:11], a[224:231], v3
  s_waitcnt vmcnt(4)
  v_cmp_eq_u32 vcc, -1, v12
  v_smfmac_f32_16x16x64_bf16 v[56:59], v[8:11], v[144:151], v3
  buffer_load_dwordx4 v[32:35], v2, s[8:11], s23 offen offset:2048 sc1
  v_smfmac_f32_16x16x64_bf16 v[60:63], v[8:11], v[200:207], v3
  s_cbranch_vccnz cA_sc1_r1
cA_sc1_c1:
  v_smfmac_f32_16x16x64_bf16 v[36:39], v[12:15], a[8:15], v3
  v_smfmac_f32_16x16x64_bf16 v[40:43], v[12:15], a[64:71], v3
  v_smfmac_f32_16x16x64_bf16 v[44:47], v[12:15], a[120:127], v3
  v_smfmac_f32_16x16x64_bf16 v[48:51], v[12:15], a[176:183], v3
  v_smfmac_f32_16x16x64_bf16 v[52:55], v[12:15], a[232:239], v3
  s_waitcnt vmcnt(4)
  v_cmp_eq_u32 vcc, -1, v16
  v_smfmac_f32_16x16x64_bf16 v[56:59], v[12:15], v[152:159], v3
  buffer_load_dwordx4 v[88:91], v117, s[8:11], s26 offen offset:0 sc1
  v_smfmac_f32_16x16x64_bf16 v[60:63], v[12:15], v[208:215], v3
  s_cbranch_vccnz cA_sc1_r2
cA_sc1_c2:
  v_smfmac_f32_16x16x64_bf16 v[36:39], v[16:19], a[16:23], v3
  v_smfmac_f32_16x16x64_bf16 v[40:43], v[16:19], a[72:79], v3
  v_smfmac_f32_16x16x64_bf16 v[44:47], v[16:19], a[128:135], v3
  buffer_load_dwordx4 v[92:95], v117, s[8:11], s26 offen offset:1024 sc1
  v_smfmac_f32_16x16x64_bf16 v[48:51], v[16:19], a[184:191], v3
  v_smfmac_f32_16x16x64_bf16 v[52:55], v[16:19], a[240:247], v3
  s_waitcnt vmcnt(5)
  v_cmp_eq_u32 vcc, -1, v20
  v_smfmac_f32_16x16x64_bf16 v[56:59], v[16:19], v[160:167], v3
  v_smfmac_f32_16x16x64_bf16 v[60:63], v[16:19], v[216:223], v3
  buffer_load_dwordx4 v[96:99], v2, s[8:11], s24 offen offset:0 sc1
  s_cbranch_vccnz cA_sc1_r3
cA_sc1_c3:
  v_smfmac_f32_16x16x64_bf16 v[36:39], v[20:23], a[24:31], v3
  v_smfmac_f32_16x16x64_bf16 v[40:43], v[20:23], a[80:87], v3
  s_waitcnt vmcnt(3)
  v_max3_u32 v66, v24, v27, v28
  v_smfmac_f32_16x16x64_bf16 v[44:47], v[20:23], a[136:143], v3
  v_max3_u32 v66, v66, v31, v32
  v_smfmac_f32_16x16x64_bf16 v[48:51], v[20:23], a[192:199], v3
  buffer_load_dwordx4 v[100:103], v2, s[8:11], s24 offen offset:1024 sc1
  v_max_u32 v66, v66, v35
  v_smfmac_f32_16x16x64_bf16 v[52:55], v[20:23], a[248:255], v3
  v_cmp_eq_u32 vcc, -1, v66
  v_smfmac_f32_16x16x64_bf16 v[56:59], v[20:23], v[168:175], v3
  v_smfmac_f32_16x16x64_bf16 v[60:63], v[20:23], v[224:231], v3
  s_cbranch_vccnz cA_sc1_r4
cA_sc1_c4:
  v_smfmac_f32_16x16x64_bf16 v[60:63], v[28:31], v[232:239], v3
  buffer_load_dwordx4 v[104:107], v2, s[8:11], s26 offen offset:0 sc1
  v_smfmac_f32_16x16x64_bf16 v[60:63], v[24:27], v[240:247], v3
  v_smfmac_f32_16x16x64_bf16 v[60:63], v[32:35], v[248:255], v3
  v_smfmac_f32_16x16x64_bf16 v[52:55], v[28:31], v[120:127], v3
  v_smfmac_f32_16x16x64_bf16 v[52:55], v[24:27], v[128:135], v3
  buffer_load_dwordx4 v[108:111], v2, s[8:11], s26 offen offset:1024 sc1
  v_smfmac_f32_16x16x64_bf16 v[52:55], v[32:35], v[136:143], v3
  v_cvt_pk_bf16_f32 v63, v62, v63
  v_smfmac_f32_16x16x64_bf16 v[56:59], v[28:31], v[176:183], v3
  v_cvt_pk_bf16_f32 v62, v60, v61
  v_smfmac_f32_16x16x64_bf16 v[56:59], v[24:27], v[184:191], v3
  v_mfma_f32_16x16x32_bf16 v[8:11], v[62:65], v[4:7], 0
  v_cvt_pk_bf16_f32 v55, v54, v55
  v_smfmac_f32_16x16x64_bf16 v[56:59], v[32:35], v[192:199], v3
  v_cvt_pk_bf16_f32 v54, v52, v53
  v_smfmac_f32_16x16x64_bf16 v[36:39], v[28:31], a[32:39], v3
  s_nop 1
  v_cvt_pk_bf16_f32 v78, v8, v9
  v_smfmac_f32_16x16x64_bf16 v[36:39], v[24:27], a[40:47], v3
  v_cvt_pk_bf16_f32 v79, v10, v11
  v_smfmac_f32_16x16x64_bf16 v[36:39], v[32:35], a[48:55], v3
  v_cvt_pk_bf16_f32 v56, v56, v57
  v_smfmac_f32_16x16x64_bf16 v[40:43], v[28:31], a[88:95], v3
  v_cvt_pk_bf16_f32 v57, v58, v59
  v_smfmac_f32_16x16x64_bf16 v[40:43], v[24:27], a[96:103], v3
  v_mfma_f32_16x16x32_bf16 v[16:19], v[54:57], v[4:7], 0
  v_cvt_pk_bf16_f32 v39, v38, v39
  v_smfmac_f32_16x16x64_bf16 v[40:43], v[32:35], a[104:111], v3
  v_cvt_pk_bf16_f32 v38, v36, v37
  v_smfmac_f32_16x16x64_bf16 v[44:47], v[28:31], a[144:151], v3
  s_nop 1
  v_cvt_pk_bf16_f32 v76, v16, v17
  v_smfmac_f32_16x16x64_bf16 v[44:47], v[24:27], a[152:159], v3
  v_cvt_pk_bf16_f32 v77, v18, v19
  v_smfmac_f32_16x16x64_bf16 v[44:47], v[32:35], a[160:167], v3
  v_cvt_pk_bf16_f32 v40, v40, v41
  v_smfmac_f32_16x16x64_bf16 v[48:51], v[28:31], a[200:207], v3
  v_cvt_pk_bf16_f32 v41, v42, v43
  v_smfmac_f32_16x16x64_bf16 v[48:51], v[24:27], a[208:215], v3
  v_smfmac_f32_16x16x64_bf16 v[48:51], v[32:35], a[216:223], v3
  s_waitcnt vmcnt(4)
  v_cvt_pk_bf16_f32 v47, v46, v47
  v_smfmac_f32_16x16x64_bf16 v[68:71], v[76:79], v[80:87], v3
  v_cvt_pk_bf16_f32 v46, v44, v45
  v_mfma_f32_16x16x32_bf16 v[8:11], v[38:41], v[4:7], 0
  s_nop 1
  v_cvt_pk_bf16_f32 v48, v48, v49
  v_cvt_pk_bf16_f32 v49, v50, v51
  s_nop 1
  v_mfma_f32_16x16x32_bf16 v[16:19], v[46:49], v[4:7], 0
  v_smfmac_f32_16x16x64_bf16 v[72:75], v[76:79], v[88:95], v3
  v_cvt_pk_bf16_f32 v20, v8, v9
  v_mfma_f32_16x16x32_bf16 v[52:55], v[30:33], v[76:79], 0
  s_waitcnt vmcnt(0)
  v_cvt_pk_bf16_f32 v21, v10, v11
  v_cvt_pk_bf16_f32 v22, v16, v17
  v_cvt_pk_bf16_f32 v23, v18, v19
  s_nop 1
  v_mfma_f32_16x16x32_bf16 v[52:55], v[12:15], v[20:23], v[52:55]
  v_smfmac_f32_16x16x64_bf16 v[68:71], v[20:23], v[96:103], v3
  v_smfmac_f32_16x16x64_bf16 v[72:75], v[20:23], v[104:111], v3
  s_nop 1
  ds_write_b128 v113, v[52:55]
  s_nop 1
  v_permlane32_swap_b32 v68, v70
  v_permlane32_swap_b32 v69, v71
  v_add_f32 v56, v68, v70
  v_add_f32 v58, v69, v71
  v_permlane32_swap_b32 v72, v74
  v_permlane32_swap_b32 v73, v75
  v_add_f32 v57, v72, v74
  v_add_f32 v59, v73, v75
  ds_write_b128 v2, v[56:59] offset:1024
  v_cmp_u_f32 vcc, v57, v59
  v_mov_b32 v68, 0
  v_mov_b32 v69, 0
  v_mov_b32 v70, 0
  v_mov_b32 v71, 0
  s_cbranch_vccnz cA_sc1_retry
cA_sc1_cont:
  s_add_u32 s24, s24, 28672
  s_add_u32 s26, s26, 28672
  buffer_load_dwordx4 v[80:83], v117, s[8:11], s24 offen offset:0 sc1
  buffer_load_dwordx4 v[84:87], v117, s[8:11], s24 offen offset:1024 sc1
  v_mov_b32 v72, 0
  v_mov_b32 v73, 0
  v_mfma_f32_32x32x16_bf16 v[36:51], v[68:71], v[68:71], 0
  s_waitcnt lgkmcnt(0)
  s_barrier
  ds_read_b64 v[8:9], v114 offset:0
  ds_read_b64 v[10:11], v114 offset:1024
  ds_read_b64 v[12:13], v114 offset:2048
  ds_read_b64 v[14:15], v114 offset:3072
  ds_read2_b32 v[16:17], v115 offset0:0 offset1:64
  ds_read2_b32 v[18:19], v115 offset0:128 offset1:192
  v_mfma_f32_32x32x16_bf16 v[52:67], v[68:71], v[68:71], 0
  s_waitcnt lgkmcnt(0)
  v_pk_add_f32 v[16:17], v[16:17], v[18:19]
  v_pk_add_f32 v[8:9], v[8:9], v[10:11]
  v_pk_add_f32 v[12:13], v[12:13], v[14:15]
  v_add_f32 v20, v16, v17
  v_pk_add_f32 v[8:9], v[8:9], v[12:13]
  v_max_f32 v22, v8, v9
  v_add_f32_dpp v20, v20, v20 row_ror:8 row_mask:0xf bank_mask:0xf
  s_nop 0
  v_max_f32_dpp v22, v22, v22 row_ror:8 row_mask:0xf bank_mask:0xf
  v_max_f32 v22, v22, v20
  buffer_store_dword v112, v116, s[8:11], 0 offen
  s_nop 0
  v_max_f32_dpp v22, v22, v22 quad_perm:[1,0,3,2] row_mask:0xf bank_mask:0xf
  s_nop 1
  v_max_f32_dpp v22, v22, v22 quad_perm:[2,3,0,1] row_mask:0xf bank_mask:0xf
  s_nop 1
  v_max_f32_dpp v22, v22, v22 row_half_mirror row_mask:0xf bank_mask:0xf
  v_pk_add_f32 v[8:9], v[8:9], v[22:23] op_sel_hi:[1,0] neg_lo:[0,1] neg_hi:[0,1]
  v_sub_f32 v20, v20, v22
  v_exp_f32 v8, v8
  v_exp_f32 v9, v9
  v_exp_f32 v20, v20
  v_add_f32 v24, v8, v9
  v_fmac_f32 v24, 0.5, v20
  v_mov_b32_dpp v21, v20 quad_perm:[1,0,3,2] row_mask:0xf bank_mask:0xf
  s_nop 0
  v_add_f32_dpp v24, v24, v24 quad_perm:[1,0,3,2] row_mask:0xf bank_mask:0xf
  s_nop 1
  v_add_f32_dpp v24, v24, v24 quad_perm:[2,3,0,1] row_mask:0xf bank_mask:0xf
  s_nop 1
  v_add_f32_dpp v24, v24, v24 row_half_mirror row_mask:0xf bank_mask:0xf
  s_nop 1
  v_add_f32_dpp v24, v24, v24 row_ror:8 row_mask:0xf bank_mask:0xf
  v_rcp_f32 v24, v24
  s_nop 0
  v_pk_mul_f32 v[8:9], v[8:9], v[24:25] op_sel_hi:[1,0]
  v_pk_mul_f32 v[20:21], v[20:21], v[24:25] op_sel_hi:[1,0]
  v_cvt_pk_bf16_f32 v8, v8, v9
  v_cvt_pk_bf16_f32 v20, v20, v21
  v_min_u32 v8, -2, v8
  buffer_store_dword v8, v1, s[8:11], s20 offen
  v_min_u32 v20, -2, v20
  buffer_store_dword v20, v118, s[8:11], s20 offen
  v_mov_b32 v74, 0
  v_mov_b32 v75, 0
  s_mov_b32 s19, s18
  s_add_u32 s18, s18, 1
  s_mov_b32 s22, s20
  s_mov_b32 s20, s21
  s_mov_b32 s21, s22
  s_add_u32 s23, s20, 4096
  v_mov_b32 v112, s18
  s_cmp_lt_u32 s19, 63
  s_nop 0
  s_cbranch_scc1 cA_sc1_loop
  s_branch cA_done
cA_sc1_r0:
  s_add_u32 s31, s31, 1
  buffer_load_dwordx4 v[8:11], v2, s[8:11], s20 offen offset:0 sc1
  s_waitcnt vmcnt(0)
  v_cmp_eq_u32 vcc, -1, v8
  v_mov_b32 v36, 0
  v_mov_b32 v37, 0
  v_mov_b32 v38, 0
  v_mov_b32 v39, 0
  v_mov_b32 v40, 0
  v_mov_b32 v41, 0
  v_mov_b32 v42, 0
  v_mov_b32 v43, 0
  v_mov_b32 v44, 0
  v_mov_b32 v45, 0
  v_mov_b32 v46, 0
  v_mov_b32 v47, 0
  v_mov_b32 v48, 0
  v_mov_b32 v49, 0
  v_mov_b32 v50, 0
  v_mov_b32 v51, 0
  s_nop 1
  s_cbranch_vccz cA_sc1_go
  s_add_u32 s30, s30, 1
  s_cmp_lt_u32 s30, 400000
  s_cbranch_scc1 cA_sc1_r0
  s_branch cA_abort
cA_sc1_r1:
  s_add_u32 s31, s31, 1
  buffer_load_dwordx4 v[12:15], v2, s[8:11], s20 offen offset:1024 sc1
  s_waitcnt vmcnt(0)
  v_cmp_eq_u32 vcc, -1, v12
  s_nop 4
  s_cbranch_vccz cA_sc1_c1
  s_add_u32 s30, s30, 1
  s_cmp_lt_u32 s30, 400000
  s_cbranch_scc1 cA_sc1_r1
  s_branch cA_abort
cA_sc1_r2:
  s_add_u32 s31, s31, 1
  buffer_load_dwordx4 v[16:19], v2, s[8:11], s20 offen offset:2048 sc1
  s_waitcnt vmcnt(0)
  v_cmp_eq_u32 vcc, -1, v16
  s_nop 4
  s_cbranch_vccz cA_sc1_c2
  s_add_u32 s30, s30, 1
  s_cmp_lt_u32 s30, 400000
  s_cbranch_scc1 cA_sc1_r2
  s_branch cA_abort
cA_sc1_r3:
  s_add_u32 s31, s31, 1
  buffer_load_dwordx4 v[20:23], v2, s[8:11], s20 offen offset:3072 sc1
  s_waitcnt vmcnt(0)
  v_cmp_eq_u32 vcc, -1, v20
  s_nop 4
  s_cbranch_vccz cA_sc1_c3
  s_add_u32 s30, s30, 1
  s_cmp_lt_u32 s30, 400000
  s_cbranch_scc1 cA_sc1_r3
  s_branch cA_abort
cA_sc1_r4:
  s_add_u32 s31, s31, 1
  buffer_load_dwordx4 v[28:31], v2, s[8:11], s23 offen offset:0 sc1
  buffer_load_dwordx4 v[24:27], v2, s[8:11], s23 offen offset:1024 sc1
  buffer_load_dwordx4 v[32:35], v2, s[8:11], s23 offen offset:2048 sc1
  s_waitcnt vmcnt(0)
  v_max3_u32 v66, v24, v27, v28
  v_max3_u32 v66, v66, v31, v32
  v_max_u32 v66, v66, v35
  v_cmp_eq_u32 vcc, -1, v66
  s_nop 4
  s_cbranch_vccz cA_sc1_c4
  s_add_u32 s30, s30, 1
  s_cmp_lt_u32 s30, 400000
  s_cbranch_scc1 cA_sc1_r4
  s_branch cA_abort
cA_sc1_retry:
  s_cmp_lg_u32 s62, 0
  s_cbranch_scc1 cA_sc1_cont
  s_waitcnt vmcnt(0) lgkmcnt(0)
cA_sc1_rv:
  buffer_load_dwordx4 v[8:11], v2, s[8:11], s20 offen offset:0 sc1
  buffer_load_dwordx4 v[12:15], v2, s[8:11], s20 offen offset:1024 sc1
  buffer_load_dwordx4 v[16:19], v2, s[8:11], s20 offen offset:2048 sc1
  buffer_load_dwordx4 v[20:23], v2, s[8:11], s20 offen offset:3072 sc1
  buffer_load_dwordx4 v[28:31], v2, s[8:11], s23 offen offset:0 sc1
  buffer_load_dwordx4 v[24:27], v2, s[8:11], s23 offen offset:1024 sc1
  buffer_load_dwordx4 v[32:35], v2, s[8:11], s23 offen offset:2048 sc1
  s_waitcnt vmcnt(0)
  v_pk_max_u16 v66, v8, v9
  v_pk_max_u16 v66, v66, v10
  v_pk_max_u16 v66, v66, v11
  v_pk_max_u16 v66, v66, v12
  v_pk_max_u16 v66, v66, v13
  v_pk_max_u16 v66, v66, v14
  v_pk_max_u16 v66, v66, v15
  v_pk_max_u16 v66, v66, v16
  v_pk_max_u16 v66, v66, v17
  v_pk_max_u16 v66, v66, v18
  v_pk_max_u16 v66, v66, v19
  v_pk_max_u16 v66, v66, v20
  v_pk_max_u16 v66, v66, v21
  v_pk_max_u16 v66, v66, v22
  v_pk_max_u16 v66, v66, v23
  v_pk_max_u16 v66, v66, v24
  v_pk_max_u16 v66, v66, v25
  v_pk_max_u16 v66, v66, v26
  v_pk_max_u16 v66, v66, v27
  v_pk_max_u16 v66, v66, v28
  v_pk_max_u16 v66, v66, v29
  v_pk_max_u16 v66, v66, v30
  v_pk_max_u16 v66, v66, v31
  v_pk_max_u16 v66, v66, v32
  v_pk_max_u16 v66, v66, v33
  v_pk_max_u16 v66, v66, v34
  v_pk_max_u16 v66, v66, v35
  v_lshlrev_b32 v67, 16, v66
  v_max_u32 v66, v66, v67
  v_cmp_le_u32 vcc, 0xffff0000, v66
  s_cbranch_vccz cA_sc1_rk
  s_add_u32 s30, s30, 1
  s_cmp_lt_u32 s30, 400000
  s_cbranch_scc1 cA_sc1_rv
  s_branch cA_abort
cA_sc1_rk:
  s_mov_b32 s62, 1
  v_mov_b32 v36, 0
  v_mov_b32 v37, 0
  v_mov_b32 v38, 0
  v_mov_b32 v39, 0
  v_mov_b32 v40, 0
  v_mov_b32 v41, 0
  v_mov_b32 v42, 0
  v_mov_b32 v43, 0
  v_mov_b32 v44, 0
  v_mov_b32 v45, 0
  v_mov_b32 v46, 0
  v_mov_b32 v47, 0
  v_mov_b32 v48, 0
  v_mov_b32 v49, 0
  v_mov_b32 v50, 0
  v_mov_b32 v51, 0
  v_mov_b32 v60, 0
  v_mov_b32 v61, 0
  v_mov_b32 v62, 0
  v_mov_b32 v63, 0
  v_mov_b32 v68, 0
  v_mov_b32 v69, 0
  v_mov_b32 v70, 0
  v_mov_b32 v71, 0
  v_mov_b32 v72, 0
  v_mov_b32 v73, 0
  v_mov_b32 v74, 0
  v_mov_b32 v75, 0
  v_mov_b32 v52, 0
  v_mov_b32 v53, 0
  v_mov_b32 v54, 0
  v_mov_b32 v55, 0
  v_mov_b32 v56, 0
  v_mov_b32 v57, 0
  v_mov_b32 v58, 0
  v_mov_b32 v59, 0
  s_add_u32 s31, s31, 0x100
  s_nop 0
  s_branch cA_sc1_go
.p2align 6
cA_sc2_loop:
  s_mov_b32 s30, 0
  s_mov_b32 s62, 0
  s_setprio 3
  s_barrier
  buffer_load_dwordx4 v[8:11], v2, s[8:11], s20 offen offset:0 sc1
  s_setprio 2
  buffer_load_dwordx4 v[12:15], v2, s[8:11], s20 offen offset:1024 sc1
  s_setprio 1
  buffer_load_dwordx4 v[16:19], v2, s[8:11], s20 offen offset:2048 sc1
  s_setprio 0
  buffer_load_dwordx4 v[20:23], v2, s[8:11], s20 offen offset:3072 sc1
cA_sc2_go:
  s_waitcnt vmcnt(3)
  v_smfmac_f32_16x16x64_bf16 v[36:39], v[8:11], a[0:7], v3
  buffer_load_dwordx4 v[24:27], v2, s[8:11], s23 offen offset:0 sc1
  v_cmp_eq_u32 vcc, -1, v8
  v_smfmac_f32_16x16x64_bf16 v[40:43], v[8:11], a[56:63], v3
  v_smfmac_f32_16x16x64_bf16 v[44:47], v[8:11], a[112:119], v3
  buffer_load_dwordx4 v[32:35], v2, s[8:11], s23 offen offset:1024 sc1
  s_cbranch_vccnz cA_sc2_r0
  v_smfmac_f32_16x16x64_bf16 v[48:51], v[8:11], a[168:175], v3
  v_smfmac_f32_16x16x64_bf16 v[52:55], v[8:11], a[224:231], v3
  s_waitcnt vmcnt(4)
  v_cmp_eq_u32 vcc, -1, v12
  v_smfmac_f32_16x16x64_bf16 v[56:59], v[8:11], v[144:151], v3
  buffer_load_dwordx4 v[28:31], v2, s[8:11], s23 offen offset:2048 sc1
  v_smfmac_f32_16x16x64_bf16 v[62:65], v[8:11], v[200:207], v3
  s_cbranch_vccnz cA_sc2_r1
cA_sc2_c1:
  v_smfmac_f32_16x16x64_bf16 v[36:39], v[12:15], a[8:15], v3
  v_smfmac_f32_16x16x64_bf16 v[40:43], v[12:15], a[64:71], v3
  v_smfmac_f32_16x16x64_bf16 v[44:47], v[12:15], a[120:127], v3
  v_smfmac_f32_16x16x64_bf16 v[48:51], v[12:15], a[176:183], v3
  v_smfmac_f32_16x16x64_bf16 v[52:55], v[12:15], a[232:239], v3
  s_waitcnt vmcnt(4)
  v_cmp_eq_u32 vcc, -1, v16
  v_smfmac_f32_16x16x64_bf16 v[56:59], v[12:15], v[152:159], v3
  buffer_load_dwordx4 v[88:91], v117, s[8:11], s26 offen offset:0 sc1
  v_smfmac_f32_16x16x64_bf16 v[62:65], v[12:15], v[208:215], v3
  s_cbranch_vccnz cA_sc2_r2
cA_sc2_c2:
  v_smfmac_f32_16x16x64_bf16 v[36:39], v[16:19], a[16:23], v3
  v_smfmac_f32_16x16x64_bf16 v[40:43], v[16:19], a[72:79], v3
  v_smfmac_f32_16x16x64_bf16 v[44:47], v[16:19], a[128:135], v3
  buffer_load_dwordx4 v[92:95], v117, s[8:11], s26 offen offset:1024 sc1
  v_smfmac_f32_16x16x64_bf16 v[48:51], v[16:19], a[184:191], v3
  v_smfmac_f32_16x16x64_bf16 v[52:55], v[16:19], a[240:247], v3
  s_waitcnt vmcnt(5)
  v_cmp_eq_u32 vcc, -1, v20
  v_smfmac_f32_16x16x64_bf16 v[56:59], v[16:19], v[160:167], v3
  v_smfmac_f32_16x16x64_bf16 v[62:65], v[16:19], v[216:223], v3
  buffer_load_dwordx4 v[96:99], v2, s[8:11], s24 offen offset:0 sc1
  s_cbranch_vccnz cA_sc2_r3
cA_sc2_c3:
  v_smfmac_f32_16x16x64_bf16 v[36:39], v[20:23], a[24:31], v3
  v_smfmac_f32_16x16x64_bf16 v[40:43], v[20:23], a[80:87], v3
  s_waitcnt vmcnt(3)
  v_max3_u32 v66, v24, v27, v28
  v_smfmac_f32_16x16x64_bf16 v[44:47], v[20:23], a[136:143], v3
  v_max3_u32 v66, v66, v31, v32
  v_smfmac_f32_16x16x64_bf16 v[48:51], v[20:23], a[192:199], v3
  buffer_load_dwordx4 v[100:103], v2, s[8:11], s24 offen offset:1024 sc1
  v_max_u32 v66, v66, v35
  v_smfmac_f32_16x16x64_bf16 v[52:55], v[20:23], a[248:255], v3
  v_cmp_eq_u32 vcc, -1, v66
  v_smfmac_f32_16x16x64_bf16 v[56:59], v[20:23], v[168:175], v3
  v_smfmac_f32_16x16x64_bf16 v[62:65], v[20:23], v[224:231], v3
  s_cbranch_vccnz cA_sc2_r4
cA_sc2_c4:
  v_smfmac_f32_16x16x64_bf16 v[62:65], v[24:27], v[232:239], v3
  buffer_load_dwordx4 v[104:107], v2, s[8:11], s26 offen offset:0 sc1
  v_smfmac_f32_16x16x64_bf16 v[62:65], v[32:35], v[240:247], v3
  v_smfmac_f32_16x16x64_bf16 v[62:65], v[28:31], v[248:255], v3
  v_smfmac_f32_16x16x64_bf16 v[52:55], v[24:27], v[120:127], v3
  v_smfmac_f32_16x16x64_bf16 v[52:55], v[32:35], v[128:135], v3
  buffer_load_dwordx4 v[108:111], v2, s[8:11], s26 offen offset:1024 sc1
  v_smfmac_f32_16x16x64_bf16 v[52:55], v[28:31], v[136:143], v3
  v_cvt_pk_bf16_f32 v62, v62, v63
  v_smfmac_f32_16x16x64_bf16 v[56:59], v[24:27], v[176:183], v3
  v_cvt_pk_bf16_f32 v63, v64, v65
  v_smfmac_f32_16x16x64_bf16 v[56:59], v[32:35], v[184:191], v3
  v_mfma_f32_16x16x32_bf16 v[8:11], v[60:63], v[4:7], 0
  v_cvt_pk_bf16_f32 v55, v54, v55
  v_smfmac_f32_16x16x64_bf16 v[56:59], v[28:31], v[192:199], v3
  v_cvt_pk_bf16_f32 v54, v52, v53
  v_smfmac_f32_16x16x64_bf16 v[36:39], v[24:27], a[32:39], v3
  s_nop 1
  v_cvt_pk_bf16_f32 v76, v8, v9
  v_smfmac_f32_16x16x64_bf16 v[36:39], v[32:35], a[40:47], v3
  v_cvt_pk_bf16_f32 v77, v10, v11
  v_smfmac_f32_16x16x64_bf16 v[36:39], v[28:31], a[48:55], v3
  v_cvt_pk_bf16_f32 v56, v56, v57
  v_smfmac_f32_16x16x64_bf16 v[40:43], v[24:27], a[88:95], v3
  v_cvt_pk_bf16_f32 v57, v58, v59
  v_smfmac_f32_16x16x64_bf16 v[40:43], v[32:35], a[96:103], v3
  v_mfma_f32_16x16x32_bf16 v[12:15], v[54:57], v[4:7], 0
  v_cvt_pk_bf16_f32 v39, v38, v39
  v_smfmac_f32_16x16x64_bf16 v[40:43], v[28:31], a[104:111], v3
  v_cvt_pk_bf16_f32 v38, v36, v37
  v_smfmac_f32_16x16x64_bf16 v[44:47], v[24:27], a[144:151], v3
  s_nop 1
  v_cvt_pk_bf16_f32 v78, v12, v13
  v_smfmac_f32_16x16x64_bf16 v[44:47], v[32:35], a[152:159], v3
  v_cvt_pk_bf16_f32 v79, v14, v15
  v_smfmac_f32_16x16x64_bf16 v[44:47], v[28:31], a[160:167], v3
  v_cvt_pk_bf16_f32 v40, v40, v41
  v_smfmac_f32_16x16x64_bf16 v[48:51], v[24:27], a[200:207], v3
  v_cvt_pk_bf16_f32 v41, v42, v43
  v_smfmac_f32_16x16x64_bf16 v[48:51], v[32:35], a[208:215], v3
  v_smfmac_f32_16x16x64_bf16 v[48:51], v[28:31], a[216:223], v3
  s_waitcnt vmcnt(4)
  v_cvt_pk_bf16_f32 v47, v46, v47
  v_smfmac_f32_16x16x64_bf16 v[68:71], v[76:79], v[80:87], v3
  v_cvt_pk_bf16_f32 v46, v44, v45
  v_mfma_f32_16x16x32_bf16 v[8:11], v[38:41], v[4:7], 0
  s_nop 1
  v_cvt_pk_bf16_f32 v48, v48, v49
  v_cvt_pk_bf16_f32 v49, v50, v51
  s_nop 1
  v_mfma_f32_16x16x32_bf16 v[12:15], v[46:49], v[4:7], 0
  v_smfmac_f32_16x16x64_bf16 v[72:75], v[76:79], v[88:95], v3
  v_cvt_pk_bf16_f32 v20, v8, v9
  v_mfma_f32_16x16x32_bf16 v[52:55], v[30:33], v[76:79], 0
  s_waitcnt vmcnt(0)
  v_cvt_pk_bf16_f32 v21, v10, v11
  v_cvt_pk_bf16_f32 v22, v12, v13
  v_cvt_pk_bf16_f32 v23, v14, v15
  s_nop 1
  v_mfma_f32_16x16x32_bf16 v[52:55], v[16:19], v[20:23], v[52:55]
  v_smfmac_f32_16x16x64_bf16 v[68:71], v[20:23], v[96:103], v3
  v_smfmac_f32_16x16x64_bf16 v[72:75], v[20:23], v[104:111], v3
  s_nop 1
  ds_write_b128 v113, v[52:55]
  s_nop 1
  v_permlane32_swap_b32 v68, v70
  v_permlane32_swap_b32 v69, v71
  v_add_f32 v56, v68, v70
  v_add_f32 v58, v69, v71
  v_permlane32_swap_b32 v72, v74
  v_permlane32_swap_b32 v73, v75
  v_add_f32 v57, v72, v74
  v_add_f32 v59, v73, v75
  ds_write_b128 v2, v[56:59] offset:2048
  v_cmp_u_f32 vcc, v57, v59
  v_mov_b32 v68, 0
  v_mov_b32 v69, 0
  v_mov_b32 v70, 0
  v_mov_b32 v71, 0
  s_cbranch_vccnz cA_sc2_retry
cA_sc2_cont:
  s_add_u32 s24, s24, 28672
  s_add_u32 s26, s26, 28672
  buffer_load_dwordx4 v[80:83], v117, s[8:11], s24 offen offset:0 sc1
  buffer_load_dwordx4 v[84:87], v117, s[8:11], s24 offen offset:1024 sc1
  v_mov_b32 v72, 0
  v_mov_b32 v73, 0
  v_mfma_f32_32x32x16_bf16 v[36:51], v[68:71], v[68:71], 0
  s_waitcnt lgkmcnt(0)
  s_barrier
  v_mfma_f32_32x32x16_bf16 v[52:67], v[68:71], v[68:71], 0
  buffer_store_dwordx2 v[118:119], v114, s[8:11], s21 offen
  buffer_store_dwordx2 v[118:119], v115, s[8:11], s21 offen
  s_buffer_load_dword s70, s[8:11], s35
  s_add_u32 s22, s24, 114688
  s_buffer_load_dword s71, s[8:11], s22
  s_mul_i32 s22, s18, 7168
  s_add_u32 s22, s22, 88024064
  s_buffer_load_dword s72, s[8:11], s22
  s_add_u32 s35, s35, 458752
  v_mov_b32 v74, 0
  v_mov_b32 v75, 0
  s_mov_b32 s19, s18
  s_add_u32 s18, s18, 1
  s_mov_b32 s22, s20
  s_mov_b32 s20, s21
  s_mov_b32 s21, s22
  s_add_u32 s23, s20, 4096
  s_cmp_lt_u32 s19, 63
  s_cbranch_scc1 cA_sc2_loop
  s_branch cA_done
cA_sc2_r0:
  s_add_u32 s31, s31, 1
  buffer_load_dwordx4 v[8:11], v2, s[8:11], s20 offen offset:0 sc1
  s_waitcnt vmcnt(0)
  v_cmp_eq_u32 vcc, -1, v8
  v_mov_b32 v36, 0
  v_mov_b32 v37, 0
  v_mov_b32 v38, 0
  v_mov_b32 v39, 0
  v_mov_b32 v40, 0
  v_mov_b32 v41, 0
  v_mov_b32 v42, 0
  v_mov_b32 v43, 0
  v_mov_b32 v44, 0
  v_mov_b32 v45, 0
  v_mov_b32 v46, 0
  v_mov_b32 v47, 0
  v_mov_b32 v48, 0
  v_mov_b32 v49, 0
  v_mov_b32 v50, 0
  v_mov_b32 v51, 0
  s_nop 1
  s_cbranch_vccz cA_sc2_go
  s_add_u32 s30, s30, 1
  s_cmp_lt_u32 s30, 400000
  s_cbranch_scc1 cA_sc2_r0
  s_branch cA_abort
cA_sc2_r1:
  s_add_u32 s31, s31, 1
  buffer_load_dwordx4 v[12:15], v2, s[8:11], s20 offen offset:1024 sc1
  s_waitcnt vmcnt(0)
  v_cmp_eq_u32 vcc, -1, v12
  s_nop 4
  s_cbranch_vccz cA_sc2_c1
  s_add_u32 s30, s30, 1
  s_cmp_lt_u32 s30, 400000
  s_cbranch_scc1 cA_sc2_r1
  s_branch cA_abort
cA_sc2_r2:
  s_add_u32 s31, s31, 1
  buffer_load_dwordx4 v[16:19], v2, s[8:11], s20 offen offset:2048 sc1
  s_waitcnt vmcnt(0)
  v_cmp_eq_u32 vcc, -1, v16
  s_nop 4
  s_cbranch_vccz cA_sc2_c2
  s_add_u32 s30, s30, 1
  s_cmp_lt_u32 s30, 400000
  s_cbranch_scc1 cA_sc2_r2
  s_branch cA_abort
cA_sc2_r3:
  s_add_u32 s31, s31, 1
  buffer_load_dwordx4 v[20:23], v2, s[8:11], s20 offen offset:3072 sc1
  s_waitcnt vmcnt(0)
  v_cmp_eq_u32 vcc, -1, v20
  s_nop 4
  s_cbranch_vccz cA_sc2_c3
  s_add_u32 s30, s30, 1
  s_cmp_lt_u32 s30, 400000
  s_cbranch_scc1 cA_sc2_r3
  s_branch cA_abort
cA_sc2_r4:
  s_add_u32 s31, s31, 1
  buffer_load_dwordx4 v[24:27], v2, s[8:11], s23 offen offset:0 sc1
  buffer_load_dwordx4 v[32:35], v2, s[8:11], s23 offen offset:1024 sc1
  buffer_load_dwordx4 v[28:31], v2, s[8:11], s23 offen offset:2048 sc1
  s_waitcnt vmcnt(0)
  v_max3_u32 v66, v24, v27, v28
  v_max3_u32 v66, v66, v31, v32
  v_max_u32 v66, v66, v35
  v_cmp_eq_u32 vcc, -1, v66
  s_nop 4
  s_cbranch_vccz cA_sc2_c4
  s_add_u32 s30, s30, 1
  s_cmp_lt_u32 s30, 400000
  s_cbranch_scc1 cA_sc2_r4
  s_branch cA_abort
cA_sc2_retry:
  s_cmp_lg_u32 s62, 0
  s_cbranch_scc1 cA_sc2_cont
  s_waitcnt vmcnt(0) lgkmcnt(0)
cA_sc2_rv:
  buffer_load_dwordx4 v[8:11], v2, s[8:11], s20 offen offset:0 sc1
  buffer_load_dwordx4 v[12:15], v2, s[8:11], s20 offen offset:1024 sc1
  buffer_load_dwordx4 v[16:19], v2, s[8:11], s20 offen offset:2048 sc1
  buffer_load_dwordx4 v[20:23], v2, s[8:11], s20 offen offset:3072 sc1
  buffer_load_dwordx4 v[24:27], v2, s[8:11], s23 offen offset:0 sc1
  buffer_load_dwordx4 v[32:35], v2, s[8:11], s23 offen offset:1024 sc1
  buffer_load_dwordx4 v[28:31], v2, s[8:11], s23 offen offset:2048 sc1
  s_waitcnt vmcnt(0)
  v_pk_max_u16 v66, v8, v9
  v_pk_max_u16 v66, v66, v10
  v_pk_max_u16 v66, v66, v11
  v_pk_max_u16 v66, v66, v12
  v_pk_max_u16 v66, v66, v13
  v_pk_max_u16 v66, v66, v14
  v_pk_max_u16 v66, v66, v15
  v_pk_max_u16 v66, v66, v16
  v_pk_max_u16 v66, v66, v17
  v_pk_max_u16 v66, v66, v18
  v_pk_max_u16 v66, v66, v19
  v_pk_max_u16 v66, v66, v20
  v_pk_max_u16 v66, v66, v21
  v_pk_max_u16 v66, v66, v22
  v_pk_max_u16 v66, v66, v23
  v_pk_max_u16 v66, v66, v24
  v_pk_max_u16 v66, v66, v25
  v_pk_max_u16 v66, v66, v26
  v_pk_max_u16 v66, v66, v27
  v_pk_max_u16 v66, v66, v28
  v_pk_max_u16 v66, v66, v29
  v_pk_max_u16 v66, v66, v30
  v_pk_max_u16 v66, v66, v31
  v_pk_max_u16 v66, v66, v32
  v_pk_max_u16 v66, v66, v33
  v_pk_max_u16 v66, v66, v34
  v_pk_max_u16 v66, v66, v35
  v_lshlrev_b32 v67, 16, v66
  v_max_u32 v66, v66, v67
  v_cmp_le_u32 vcc, 0xffff0000, v66
  s_cbranch_vccz cA_sc2_rk
  s_add_u32 s30, s30, 1
  s_cmp_lt_u32 s30, 400000
  s_cbranch_scc1 cA_sc2_rv
  s_branch cA_abort
cA_sc2_rk:
  s_mov_b32 s62, 1
  v_mov_b32 v36, 0
  v_mov_b32 v37, 0
  v_mov_b32 v38, 0
  v_mov_b32 v39, 0
  v_mov_b32 v40, 0
  v_mov_b32 v41, 0
  v_mov_b32 v42, 0
  v_mov_b32 v43, 0
  v_mov_b32 v44, 0
  v_mov_b32 v45, 0
  v_mov_b32 v46, 0
  v_mov_b32 v47, 0
  v_mov_b32 v48, 0
  v_mov_b32 v49, 0
  v_mov_b32 v50, 0
  v_mov_b32 v51, 0
  v_mov_b32 v62, 0
  v_mov_b32 v63, 0
  v_mov_b32 v64, 0
  v_mov_b32 v65, 0
  v_mov_b32 v68, 0
  v_mov_b32 v69, 0
  v_mov_b32 v70, 0
  v_mov_b32 v71, 0
  v_mov_b32 v72, 0
  v_mov_b32 v73, 0
  v_mov_b32 v74, 0
  v_mov_b32 v75, 0
  v_mov_b32 v52, 0
  v_mov_b32 v53, 0
  v_mov_b32 v54, 0
  v_mov_b32 v55, 0
  v_mov_b32 v56, 0
  v_mov_b32 v57, 0
  v_mov_b32 v58, 0
  v_mov_b32 v59, 0
  s_add_u32 s31, s31, 0x100
  s_nop 0
  s_branch cA_sc2_go
.p2align 6
cA_sc3_loop:
  s_mov_b32 s30, 0
  s_mov_b32 s62, 0
  s_setprio 3
  s_barrier
  buffer_load_dwordx4 v[8:11], v2, s[8:11], s20 offen offset:0 sc1
  s_setprio 2
  buffer_load_dwordx4 v[12:15], v2, s[8:11], s20 offen offset:1024 sc1
  s_setprio 1
  buffer_load_dwordx4 v[16:19], v2, s[8:11], s20 offen offset:2048 sc1
  s_setprio 0
  buffer_load_dwordx4 v[20:23], v2, s[8:11], s20 offen offset:3072 sc1
cA_sc3_go:
  s_waitcnt vmcnt(3)
  v_smfmac_f32_16x16x64_bf16 v[36:39], v[8:11], a[0:7], v3
  buffer_load_dwordx4 v[24:27], v2, s[8:11], s23 offen offset:0 sc1
  v_cmp_eq_u32 vcc, -1, v8
  v_smfmac_f32_16x16x64_bf16 v[40:43], v[8:11], a[56:63], v3
  v_smfmac_f32_16x16x64_bf16 v[44:47], v[8:11], a[112:119], v3
  buffer_load_dwordx4 v[28:31], v2, s[8:11], s23 offen offset:1024 sc1
  s_cbranch_vccnz cA_sc3_r0
  v_smfmac_f32_16x16x64_bf16 v[48:51], v[8:11], a[168:175], v3
  v_smfmac_f32_16x16x64_bf16 v[52:55], v[8:11], a[224:231], v3
  s_waitcnt vmcnt(4)
  v_cmp_eq_u32 vcc, -1, v12
  v_smfmac_f32_16x16x64_bf16 v[56:59], v[8:11], v[144:151], v3
  buffer_load_dwordx4 v[32:35], v2, s[8:11], s23 offen offset:2048 sc1
  v_smfmac_f32_16x16x64_bf16 v[62:65], v[8:11], v[200:207], v3
  s_cbranch_vccnz cA_sc3_r1
cA_sc3_c1:
  v_smfmac_f32_16x16x64_bf16 v[36:39], v[12:15], a[8:15], v3
  v_smfmac_f32_16x16x64_bf16 v[40:43], v[12:15], a[64:71], v3
  v_smfmac_f32_16x16x64_bf16 v[44:47], v[12:15], a[120:127], v3
  v_smfmac_f32_16x16x64_bf16 v[48:51], v[12:15], a[176:183], v3
  v_smfmac_f32_16x16x64_bf16 v[52:55], v[12:15], a[232:239], v3
  s_waitcnt vmcnt(4)
  v_cmp_eq_u32 vcc, -1, v16
  v_smfmac_f32_16x16x64_bf16 v[56:59], v[12:15], v[152:159], v3
  buffer_load_dwordx4 v[88:91], v117, s[8:11], s26 offen offset:0 sc1
  v_smfmac_f32_16x16x64_bf16 v[62:65], v[12:15], v[208:215], v3
  s_cbranch_vccnz cA_sc3_r2
cA_sc3_c2:
  v_smfmac_f32_16x16x64_bf16 v[36:39], v[16:19], a[16:23], v3
  v_smfmac_f32_16x16x64_bf16 v[40:43], v[16:19], a[72:79], v3
  v_smfmac_f32_16x16x64_bf16 v[44:47], v[16:19], a[128:135], v3
  buffer_load_dwordx4 v[92:95], v117, s[8:11], s26 offen offset:1024 sc1
  v_smfmac_f32_16x16x64_bf16 v[48:51], v[16:19], a[184:191], v3
  v_smfmac_f32_16x16x64_bf16 v[52:55], v[16:19], a[240:247], v3
  s_waitcnt vmcnt(5)
  v_cmp_eq_u32 vcc, -1, v20
  v_smfmac_f32_16x16x64_bf16 v[56:59], v[16:19], v[160:167], v3
  v_smfmac_f32_16x16x64_bf16 v[62:65], v[16:19], v[216:223], v3
  buffer_load_dwordx4 v[96:99], v2, s[8:11], s24 offen offset:0 sc1
  s_cbranch_vccnz cA_sc3_r3
cA_sc3_c3:
  v_smfmac_f32_16x16x64_bf16 v[36:39], v[20:23], a[24:31], v3
  v_smfmac_f32_16x16x64_bf16 v[40:43], v[20:23], a[80:87], v3
  s_waitcnt vmcnt(3)
  v_max3_u32 v66, v24, v27, v28
  v_smfmac_f32_16x16x64_bf16 v[44:47], v[20:23], a[136:143], v3
  v_max3_u32 v66, v66, v31, v32
  v_smfmac_f32_16x16x64_bf16 v[48:51], v[20:23], a[192:199], v3
  buffer_load_dwordx4 v[100:103], v2, s[8:11], s24 offen offset:1024 sc1
  v_max_u32 v66, v66, v35
  v_smfmac_f32_16x16x64_bf16 v[52:55], v[20:23], a[248:255], v3
  v_cmp_eq_u32 vcc, -1, v66
  v_smfmac_f32_16x16x64_bf16 v[56:59], v[20:23], v[168:175], v3
  v_smfmac_f32_16x16x64_bf16 v[62:65], v[20:23], v[224:231], v3
  s_cbranch_vccnz cA_sc3_r4
cA_sc3_c4:
  v_smfmac_f32_16x16x64_bf16 v[62:65], v[24:27], v[232:239], v3
  buffer_load_dwordx4 v[104:107], v2, s[8:11], s26 offen offset:0 sc1
  v_smfmac_f32_16x16x64_bf16 v[62:65], v[28:31], v[240:247], v3
  v_smfmac_f32_16x16x64_bf16 v[62:65], v[32:35], v[248:255], v3
  v_smfmac_f32_16x16x64_bf16 v[52:55], v[24:27], v[120:127], v3
  v_smfmac_f32_16x16x64_bf16 v[52:55], v[28:31], v[128:135], v3
  buffer_load_dwordx4 v[108:111], v2, s[8:11], s26 offen offset:1024 sc1
  v_smfmac_f32_16x16x64_bf16 v[52:55], v[32:35], v[136:143], v3
  v_cvt_pk_bf16_f32 v62, v62, v63
  v_smfmac_f32_16x16x64_bf16 v[56:59], v[24:27], v[176:183], v3
  v_cvt_pk_bf16_f32 v63, v64, v65
  v_smfmac_f32_16x16x64_bf16 v[56:59], v[28:31], v[184:191], v3
  v_mfma_f32_16x16x32_bf16 v[8:11], v[60:63], v[4:7], 0
  v_cvt_pk_bf16_f32 v55, v54, v55
  v_smfmac_f32_16x16x64_bf16 v[56:59], v[32:35], v[192:199], v3
  v_cvt_pk_bf16_f32 v54, v52, v53
  v_smfmac_f32_16x16x64_bf16 v[36:39], v[24:27], a[32:39], v3
  s_nop 1
  v_cvt_pk_bf16_f32 v78, v8, v9
  v_smfmac_f32_16x16x64_bf16 v[36:39], v[28:31], a[40:47], v3
  v_cvt_pk_bf16_f32 v79, v10, v11
  v_smfmac_f32_16x16x64_bf16 v[36:39], v[32:35], a[48:55], v3
  v_cvt_pk_bf16_f32 v56, v56, v57
  v_smfmac_f32_16x16x64_bf16 v[40:43], v[24:27], a[88:95], v3
  v_cvt_pk_bf16_f32 v57, v58, v59
  v_smfmac_f32_16x16x64_bf16 v[40:43], v[28:31], a[96:103], v3
  v_mfma_f32_16x16x32_bf16 v[12:15], v[54:57], v[4:7], 0
  v_cvt_pk_bf16_f32 v39, v38, v39
  v_smfmac_f32_16x16x64_bf16 v[40:43], v[32:35], a[104:111], v3
  v_cvt_pk_bf16_f32 v38, v36, v37
  v_smfmac_f32_16x16x64_bf16 v[44:47], v[24:27], a[144:151], v3
  s_nop 1
  v_cvt_pk_bf16_f32 v76, v12, v13
  v_smfmac_f32_16x16x64_bf16 v[44:47], v[28:31], a[152:159], v3
  v_cvt_pk_bf16_f32 v77, v14, v15
  v_smfmac_f32_16x16x64_bf16 v[44:47], v[32:35], a[160:167], v3
  v_cvt_pk_bf16_f32 v40, v40, v41
  v_smfmac_f32_16x16x64_bf16 v[48:51], v[24:27], a[200:207], v3
  v_cvt_pk_bf16_f32 v41, v42, v43
  v_smfmac_f32_16x16x64_bf16 v[48:51], v[28:31], a[208:215], v3
  v_smfmac_f32_16x16x64_bf16 v[48:51], v[32:35], a[216:223], v3
  s_waitcnt vmcnt(4)
  v_cvt_pk_bf16_f32 v47, v46, v47
  v_smfmac_f32_16x16x64_bf16 v[68:71], v[76:79], v[80:87], v3
  v_cvt_pk_bf16_f32 v46, v44, v45
  v_mfma_f32_16x16x32_bf16 v[8:11], v[38:41], v[4:7], 0
  s_nop 1
  v_cvt_pk_bf16_f32 v48, v48, v49
  v_cvt_pk_bf16_f32 v49, v50, v51
  s_nop 1
  v_mfma_f32_16x16x32_bf16 v[12:15], v[46:49], v[4:7], 0
  v_smfmac_f32_16x16x64_bf16 v[72:75], v[76:79], v[88:95], v3
  v_cvt_pk_bf16_f32 v16, v8, v9
  v_mfma_f32_16x16x32_bf16 v[52:55], v[30:33], v[76:79], 0
  s_waitcnt vmcnt(0)
  v_cvt_pk_bf16_f32 v17, v10, v11
  v_cvt_pk_bf16_f32 v18, v12, v13
  v_cvt_pk_bf16_f32 v19, v14, v15
  s_nop 1
  v_mfma_f32_16x16x32_bf16 v[52:55], v[20:23], v[16:19], v[52:55]
  v_smfmac_f32_16x16x64_bf16 v[68:71], v[16:19], v[96:103], v3
  v_smfmac_f32_16x16x64_bf16 v[72:75], v[16:19], v[104:111], v3
  s_nop 1
  ds_write_b128 v113, v[52:55]
  s_nop 1
  v_permlane32_swap_b32 v68, v70
  v_permlane32_swap_b32 v69, v71
  v_add_f32 v56, v68, v70
  v_add_f32 v58, v69, v71
  v_permlane32_swap_b32 v72, v74
  v_permlane32_swap_b32 v73, v75
  v_add_f32 v57, v72, v74
  v_add_f32 v59, v73, v75
  ds_write_b128 v2, v[56:59] offset:3072
  v_cmp_u_f32 vcc, v57, v59
  v_mov_b32 v68, 0
  v_mov_b32 v69, 0
  v_mov_b32 v70, 0
  v_mov_b32 v71, 0
  s_cbranch_vccnz cA_sc3_retry
cA_sc3_cont:
  s_add_u32 s24, s24, 28672
  s_add_u32 s26, s26, 28672
  buffer_load_dwordx4 v[80:83], v117, s[8:11], s24 offen offset:0 sc1
  buffer_load_dwordx4 v[84:87], v117, s[8:11], s24 offen offset:1024 sc1
  v_mov_b32 v72, 0
  v_mov_b32 v73, 0
  v_mfma_f32_16x16x32_bf16 v[62:65], v[68:71], v[68:71], 0
  s_waitcnt lgkmcnt(0)
  s_barrier
  v_mov_b32 v52, 0
  v_mov_b32 v53, 0
  v_mov_b32 v54, 0
  v_mov_b32 v55, 0
  v_mov_b32 v56, 0
  v_mov_b32 v57, 0
  v_mov_b32 v58, 0
  v_mov_b32 v59, 0
  v_mfma_f32_32x32x16_bf16 v[36:51], v[68:71], v[68:71], 0
  v_mov_b32 v74, 0
  v_mov_b32 v75, 0
  s_mov_b32 s19, s18
  s_add_u32 s18, s18, 1
  s_mov_b32 s22, s20
  s_mov_b32 s20, s21
  s_mov_b32 s21, s22
  s_add_u32 s23, s20, 4096
  s_cmp_lt_u32 s19, 63
  s_nop 2
  s_cbranch_scc1 cA_sc3_loop
  s_branch cA_done
cA_sc3_r0:
  s_add_u32 s31, s31, 1
  buffer_load_dwordx4 v[8:11], v2, s[8:11], s20 offen offset:0 sc1
  s_waitcnt vmcnt(0)
  v_cmp_eq_u32 vcc, -1, v8
  v_mov_b32 v36, 0
  v_mov_b32 v37, 0
  v_mov_b32 v38, 0
  v_mov_b32 v39, 0
  v_mov_b32 v40, 0
  v_mov_b32 v41, 0
  v_mov_b32 v42, 0
  v_mov_b32 v43, 0
  v_mov_b32 v44, 0
  v_mov_b32 v45, 0
  v_mov_b32 v46, 0
  v_mov_b32 v47, 0
  v_mov_b32 v48, 0
  v_mov_b32 v49, 0
  v_mov_b32 v50, 0
  v_mov_b32 v51, 0
  s_nop 1
  s_cbranch_vccz cA_sc3_go
  s_add_u32 s30, s30, 1
  s_cmp_lt_u32 s30, 400000
  s_cbranch_scc1 cA_sc3_r0
  s_branch cA_abort
cA_sc3_r1:
  s_add_u32 s31, s31, 1
  buffer_load_dwordx4 v[12:15], v2, s[8:11], s20 offen offset:1024 sc1
  s_waitcnt vmcnt(0)
  v_cmp_eq_u32 vcc, -1, v12
  s_nop 4
  s_cbranch_vccz cA_sc3_c1
  s_add_u32 s30, s30, 1
  s_cmp_lt_u32 s30, 400000
  s_cbranch_scc1 cA_sc3_r1
  s_branch cA_abort
cA_sc3_r2:
  s_add_u32 s31, s31, 1
  buffer_load_dwordx4 v[16:19], v2, s[8:11], s20 offen offset:2048 sc1
  s_waitcnt vmcnt(0)
  v_cmp_eq_u32 vcc, -1, v16
  s_nop 4
  s_cbranch_vccz cA_sc3_c2
  s_add_u32 s30, s30, 1
  s_cmp_lt_u32 s30, 400000
  s_cbranch_scc1 cA_sc3_r2
  s_branch cA_abort
cA_sc3_r3:
  s_add_u32 s31, s31, 1
  buffer_load_dwordx4 v[20:23], v2, s[8:11], s20 offen offset:3072 sc1
  s_waitcnt vmcnt(0)
  v_cmp_eq_u32 vcc, -1, v20
  s_nop 4
  s_cbranch_vccz cA_sc3_c3
  s_add_u32 s30, s30, 1
  s_cmp_lt_u32 s30, 400000
  s_cbranch_scc1 cA_sc3_r3
  s_branch cA_abort
cA_sc3_r4:
  s_add_u32 s31, s31, 1
  buffer_load_dwordx4 v[24:27], v2, s[8:11], s23 offen offset:0 sc1
  buffer_load_dwordx4 v[28:31], v2, s[8:11], s23 offen offset:1024 sc1
  buffer_load_dwordx4 v[32:35], v2, s[8:11], s23 offen offset:2048 sc1
  s_waitcnt vmcnt(0)
  v_max3_u32 v66, v24, v27, v28
  v_max3_u32 v66, v66, v31, v32
  v_max_u32 v66, v66, v35
  v_cmp_eq_u32 vcc, -1, v66
  s_nop 4
  s_cbranch_vccz cA_sc3_c4
  s_add_u32 s30, s30, 1
  s_cmp_lt_u32 s30, 400000
  s_cbranch_scc1 cA_sc3_r4
  s_branch cA_abort
cA_sc3_retry:
  s_cmp_lg_u32 s62, 0
  s_cbranch_scc1 cA_sc3_cont
  s_waitcnt vmcnt(0) lgkmcnt(0)
cA_sc3_rv:
  buffer_load_dwordx4 v[8:11], v2, s[8:11], s20 offen offset:0 sc1
  buffer_load_dwordx4 v[12:15], v2, s[8:11], s20 offen offset:1024 sc1
  buffer_load_dwordx4 v[16:19], v2, s[8:11], s20 offen offset:2048 sc1
  buffer_load_dwordx4 v[20:23], v2, s[8:11], s20 offen offset:3072 sc1
  buffer_load_dwordx4 v[24:27], v2, s[8:11], s23 offen offset:0 sc1
  buffer_load_dwordx4 v[28:31], v2, s[8:11], s23 offen offset:1024 sc1
  buffer_load_dwordx4 v[32:35], v2, s[8:11], s23 offen offset:2048 sc1
  s_waitcnt vmcnt(0)
  v_pk_max_u16 v66, v8, v9
  v_pk_max_u16 v66, v66, v10
  v_pk_max_u16 v66, v66, v11
  v_pk_max_u16 v66, v66, v12
  v_pk_max_u16 v66, v66, v13
  v_pk_max_u16 v66, v66, v14
  v_pk_max_u16 v66, v66, v15
  v_pk_max_u16 v66, v66, v16
  v_pk_max_u16 v66, v66, v17
  v_pk_max_u16 v66, v66, v18
  v_pk_max_u16 v66, v66, v19
  v_pk_max_u16 v66, v66, v20
  v_pk_max_u16 v66, v66, v21
  v_pk_max_u16 v66, v66, v22
  v_pk_max_u16 v66, v66, v23
  v_pk_max_u16 v66, v66, v24
  v_pk_max_u16 v66, v66, v25
  v_pk_max_u16 v66, v66, v26
  v_pk_max_u16 v66, v66, v27
  v_pk_max_u16 v66, v66, v28
  v_pk_max_u16 v66, v66, v29
  v_pk_max_u16 v66, v66, v30
  v_pk_max_u16 v66, v66, v31
  v_pk_max_u16 v66, v66, v32
  v_pk_max_u16 v66, v66, v33
  v_pk_max_u16 v66, v66, v34
  v_pk_max_u16 v66, v66, v35
  v_lshlrev_b32 v67, 16, v66
  v_max_u32 v66, v66, v67
  v_cmp_le_u32 vcc, 0xffff0000, v66
  s_cbranch_vccz cA_sc3_rk
  s_add_u32 s30, s30, 1
  s_cmp_lt_u32 s30, 400000
  s_cbranch_scc1 cA_sc3_rv
  s_branch cA_abort
cA_sc3_rk:
  s_mov_b32 s62, 1
  v_mov_b32 v36, 0
  v_mov_b32 v37, 0
  v_mov_b32 v38, 0
  v_mov_b32 v39, 0
  v_mov_b32 v40, 0
  v_mov_b32 v41, 0
  v_mov_b32 v42, 0
  v_mov_b32 v43, 0
  v_mov_b32 v44, 0
  v_mov_b32 v45, 0
  v_mov_b32 v46, 0
  v_mov_b32 v47, 0
  v_mov_b32 v48, 0
  v_mov_b32 v49, 0
  v_mov_b32 v50, 0
  v_mov_b32 v51, 0
  v_mov_b32 v62, 0
  v_mov_b32 v63, 0
  v_mov_b32 v64, 0
  v_mov_b32 v65, 0
  v_mov_b32 v68, 0
  v_mov_b32 v69, 0
  v_mov_b32 v70, 0
  v_mov_b32 v71, 0
  v_mov_b32 v72, 0
  v_mov_b32 v73, 0
  v_mov_b32 v74, 0
  v_mov_b32 v75, 0
  v_mov_b32 v52, 0
  v_mov_b32 v53, 0
  v_mov_b32 v54, 0
  v_mov_b32 v55, 0
  v_mov_b32 v56, 0
  v_mov_b32 v57, 0
  v_mov_b32 v58, 0
  v_mov_b32 v59, 0
  s_add_u32 s31, s31, 0x100
  s_nop 0
  s_branch cA_sc3_go
.p2align 6
cA_va0_loop:
  s_mov_b32 s30, 0
  s_barrier
  buffer_load_dwordx4 v[24:27], v2, s[8:11], s23 offen offset:0 sc1
  buffer_load_dwordx4 v[28:31], v2, s[8:11], s23 offen offset:1024 sc1
  s_barrier
  s_cmp_lt_u32 s19, 58
  s_cbranch_scc1 cA_va0_m1
  buffer_store_dword v160, v1, s[8:11], s38 offen sc1
  s_branch cA_va0_m2
cA_va0_m1:
  buffer_store_dword v160, v1, s[8:11], s38 offen nt
cA_va0_m2:
  s_add_u32 s22, s25, 0
  buffer_load_dwordx4 v[80:83], v6, s[8:11], s22 offen offset:0 sc1
  buffer_load_dwordx4 v[84:87], v6, s[8:11], s22 offen offset:1792 sc1
  s_add_u32 s22, s25, 3584
  buffer_load_dwordx4 v[88:91], v6, s[8:11], s22 offen offset:0 sc1
  buffer_load_dwordx4 v[92:95], v6, s[8:11], s22 offen offset:1792 sc1
  s_add_u32 s22, s25, 7168
  buffer_load_dwordx4 v[96:99], v6, s[8:11], s22 offen offset:0 sc1
  s_mul_i32 s38, s18, 7168
  s_add_u32 s38, s38, 88002560
  s_waitcnt vmcnt(6)
  ds_write_b128 v2, v[24:27] offset:12288
  ds_write_b128 v2, v[28:31] offset:13312
  v_smfmac_f32_16x16x64_bf16 v[36:39], v[24:27], a[32:39], v3
  buffer_load_dwordx4 v[100:103], v6, s[8:11], s22 offen offset:1792 sc1
  v_smfmac_f32_16x16x64_bf16 v[40:43], v[24:27], a[88:95], v3
  s_add_u32 s22, s25, 10752
  buffer_load_dwordx4 v[104:107], v6, s[8:11], s22 offen offset:0 sc1
  v_smfmac_f32_16x16x64_bf16 v[44:47], v[24:27], a[144:151], v3
  buffer_load_dwordx4 v[108:111], v6, s[8:11], s22 offen offset:1792 sc1
  v_smfmac_f32_16x16x64_bf16 v[48:51], v[24:27], a[200:207], v3
  s_add_u32 s22, s25, 14336
  buffer_load_dwordx4 v[112:115], v6, s[8:11], s22 offen offset:0 sc1
  v_smfmac_f32_16x16x64_bf16 v[52:55], v[24:27], v[176:183], v3
  s_waitcnt lgkmcnt(0)
  s_barrier
  ds_read_b128 v[8:11], v2 offset:8192
  ds_read_b128 v[12:15], v2 offset:9216
  ds_read_b128 v[16:19], v2 offset:10240
  ds_read_b128 v[20:23], v2 offset:11264
  ds_read_b128 v[32:35], v2 offset:14336
  buffer_load_dwordx4 v[116:119], v6, s[8:11], s22 offen offset:1792 sc1
  v_smfmac_f32_16x16x64_bf16 v[56:59], v[24:27], v[232:239], v3
  s_add_u32 s22, s25, 17920
  buffer_load_dwordx4 v[120:123], v6, s[8:11], s22 offen offset:0 sc1
  v_smfmac_f32_16x16x64_bf16 v[36:39], v[28:31], a[40:47], v3
  buffer_load_dwordx4 v[124:127], v6, s[8:11], s22 offen offset:1792 sc1
  v_smfmac_f32_16x16x64_bf16 v[40:43], v[28:31], a[96:103], v3
  s_add_u32 s22, s25, 21504
  buffer_load_dwordx4 v[128:131], v6, s[8:11], s22 offen offset:0 sc1
  v_smfmac_f32_16x16x64_bf16 v[44:47], v[28:31], a[152:159], v3
  buffer_load_dwordx4 v[132:135], v6, s[8:11], s22 offen offset:1792 sc1
  v_smfmac_f32_16x16x64_bf16 v[48:51], v[28:31], a[208:215], v3
  s_add_u32 s22, s25, 25088
  buffer_load_dwordx4 v[136:139], v6, s[8:11], s22 offen offset:0 sc1
  v_smfmac_f32_16x16x64_bf16 v[52:55], v[28:31], v[184:191], v3
  ds_read_b128 v[64:67], v0 offset:0
  ds_read_b128 v[68:71], v0 offset:1024
  buffer_load_dwordx4 v[140:143], v6, s[8:11], s22 offen offset:1792 sc1
  v_smfmac_f32_16x16x64_bf16 v[56:59], v[28:31], v[240:247], v3
  s_waitcnt lgkmcnt(6)
  ds_read_b128 v[72:75], v0 offset:2048
  ds_read_b128 v[76:79], v0 offset:3072
  v_smfmac_f32_16x16x64_bf16 v[36:39], v[8:11], a[0:7], v3
  s_waitcnt lgkmcnt(7)
  v_smfmac_f32_16x16x64_bf16 v[36:39], v[12:15], a[8:15], v3
  s_waitcnt lgkmcnt(6)
  v_smfmac_f32_16x16x64_bf16 v[36:39], v[16:19], a[16:23], v3
  s_waitcnt lgkmcnt(2)
  v_smfmac_f32_16x16x64_bf16 v[60:63], v[8:11], v[64:71], v3
  s_waitcnt lgkmcnt(5)
  ds_read_b128 v[144:147], v0 offset:4096
  ds_read_b128 v[148:151], v0 offset:5120
  v_smfmac_f32_16x16x64_bf16 v[36:39], v[20:23], a[24:31], v3
  s_waitcnt lgkmcnt(6)
  v_smfmac_f32_16x16x64_bf16 v[36:39], v[32:35], a[48:55], v3
  v_smfmac_f32_16x16x64_bf16 v[40:43], v[8:11], a[56:63], v3
  s_waitcnt lgkmcnt(2)
  v_smfmac_f32_16x16x64_bf16 v[60:63], v[12:15], v[72:79], v3
  ds_read_b128 v[64:67], v0 offset:6144
  ds_read_b128 v[68:71], v0 offset:7168
  v_smfmac_f32_16x16x64_bf16 v[40:43], v[12:15], a[64:71], v3
  v_permlane32_swap_b32 v36, v38
  v_smfmac_f32_16x16x64_bf16 v[40:43], v[16:19], a[72:79], v3
  v_permlane32_swap_b32 v37, v39
  v_smfmac_f32_16x16x64_bf16 v[40:43], v[20:23], a[80:87], v3
  s_waitcnt lgkmcnt(2)
  v_add_f32 v36, v36, v38
  v_smfmac_f32_16x16x64_bf16 v[60:63], v[16:19], v[144:151], v3
  ds_read_b128 v[72:75], v0 offset:8192
  ds_read_b128 v[76:79], v0 offset:9216
  v_add_f32 v37, v37, v39
  v_smfmac_f32_16x16x64_bf16 v[40:43], v[32:35], a[104:111], v3
  v_cmp_u_f32 vcc, v36, v37
  v_smfmac_f32_16x16x64_bf16 v[44:47], v[8:11], a[112:119], v3
  v_cvt_pk_bf16_f32 v38, v36, v37
  v_smfmac_f32_16x16x64_bf16 v[44:47], v[12:15], a[120:127], v3
  ds_write_b32 v152, v38
  s_waitcnt lgkmcnt(3)
  s_cbranch_vccnz cA_va0_slow
  v_permlane32_swap_b32 v40, v42
  v_smfmac_f32_16x16x64_bf16 v[60:63], v[20:23], v[64:71], v3
  ds_read_b128 v[144:147], v0 offset:10240
  ds_read_b128 v[148:151], v0 offset:11264
  v_permlane32_swap_b32 v41, v43
  v_smfmac_f32_16x16x64_bf16 v[44:47], v[16:19], a[128:135], v3
  buffer_store_dword v162, v1, s[8:11], s21 offen
  v_add_f32 v40, v40, v42
  v_smfmac_f32_16x16x64_bf16 v[44:47], v[20:23], a[136:143], v3
  v_add_f32 v41, v41, v43
  v_smfmac_f32_16x16x64_bf16 v[44:47], v[32:35], a[160:167], v3
  s_waitcnt lgkmcnt(3)
  v_cvt_pk_bf16_f32 v42, v40, v41
  v_smfmac_f32_16x16x64_bf16 v[60:63], v[24:27], v[72:79], v3
  ds_write_b32 v153, v42
  ds_read_b128 v[64:67], v0 offset:12288
  ds_read_b128 v[68:71], v0 offset:13312
  v_smfmac_f32_16x16x64_bf16 v[48:51], v[8:11], a[168:175], v3
  s_nop 0
  v_permlane32_swap_b32 v44, v46
  v_smfmac_f32_16x16x64_bf16 v[48:51], v[12:15], a[176:183], v3
  v_permlane32_swap_b32 v45, v47
  v_smfmac_f32_16x16x64_bf16 v[48:51], v[16:19], a[184:191], v3
  s_waitcnt lgkmcnt(3)
  v_add_f32 v44, v44, v46
  v_smfmac_f32_16x16x64_bf16 v[60:63], v[28:31], v[144:151], v3
  v_add_f32 v45, v45, v47
  v_smfmac_f32_16x16x64_bf16 v[48:51], v[20:23], a[192:199], v3
  buffer_load_dword v164, v4, s[8:11], 0 offen sc1
  v_cvt_pk_bf16_f32 v46, v44, v45
  v_smfmac_f32_16x16x64_bf16 v[48:51], v[32:35], a[216:223], v3
  ds_write_b32 v154, v46
  v_smfmac_f32_16x16x64_bf16 v[52:55], v[8:11], a[224:231], v3
  s_waitcnt lgkmcnt(1)
  v_smfmac_f32_16x16x64_bf16 v[60:63], v[32:35], v[64:71], v3
  buffer_load_dword v165, v4, s[8:11], 0 offen sc1
  v_smfmac_f32_16x16x64_bf16 v[52:55], v[12:15], a[232:239], v3
  v_permlane32_swap_b32 v48, v50
  v_smfmac_f32_16x16x64_bf16 v[52:55], v[16:19], a[240:247], v3
  v_permlane32_swap_b32 v49, v51
  v_smfmac_f32_16x16x64_bf16 v[52:55], v[20:23], a[248:255], v3
  buffer_load_dword v166, v4, s[8:11], 0 offen sc1
  v_add_f32 v48, v48, v50
  v_smfmac_f32_16x16x64_bf16 v[52:55], v[32:35], v[192:199], v3
  v_add_f32 v49, v49, v51
  v_smfmac_f32_16x16x64_bf16 v[56:59], v[8:11], v[200:207], v3
  v_cvt_pk_bf16_f32 v50, v48, v49
  v_smfmac_f32_16x16x64_bf16 v[56:59], v[12:15], v[208:215], v3
  ds_write_b32 v155, v50
  buffer_load_dword v167, v4, s[8:11], 0 offen sc1
  v_permlane32_swap_b32 v60, v62
  v_smfmac_f32_16x16x64_bf16 v[56:59], v[16:19], v[216:223], v3
  v_permlane32_swap_b32 v61, v63
  v_smfmac_f32_16x16x64_bf16 v[56:59], v[20:23], v[224:231], v3
  v_add_f32 v60, v60, v62
  v_smfmac_f32_16x16x64_bf16 v[56:59], v[32:35], v[248:255], v3
  buffer_load_dword v168, v4, s[8:11], 0 offen sc1
  v_add_f32 v61, v61, v63
  v_cvt_pk_bf16_f32 v62, v60, v61
  ds_write_b32 v158, v62
  v_permlane32_swap_b32 v52, v54
  v_permlane32_swap_b32 v53, v55
  v_add_f32 v52, v52, v54
  v_add_f32 v53, v53, v55
  v_cvt_pk_bf16_f32 v54, v52, v53
  ds_write_b32 v156, v54
  v_permlane32_swap_b32 v56, v58
  v_permlane32_swap_b32 v57, v59
  v_add_f32 v56, v56, v58
  v_add_f32 v57, v57, v59
  v_cvt_pk_bf16_f32 v58, v56, v57
  ds_write_b32 v157, v58
cA_va0_t2d:
  s_add_u32 s22, s20, 9216
  s_add_u32 s34, s20, 13312
  s_add_u32 s36, s20, 7168
  s_mov_b32 s37, 0
  v_mov_b32 v48, 0
  v_mov_b32 v49, 0
  v_mov_b32 v50, 0
  v_mov_b32 v51, 0
  v_mov_b32 v163, s18
  s_waitcnt lgkmcnt(0)
  s_setprio 3
cA_va0_fw_l:
  s_waitcnt vmcnt(4)
  v_cmp_gt_u32 vcc, s18, v164
  buffer_load_dword v164, v4, s[8:11], 0 offen sc1
  s_cbranch_vccz cA_va0_fw_d
  s_waitcnt vmcnt(4)
  v_cmp_gt_u32 vcc, s18, v165
  buffer_load_dword v165, v4, s[8:11], 0 offen sc1
  s_cbranch_vccz cA_va0_fw_d
  s_waitcnt vmcnt(4)
  v_cmp_gt_u32 vcc, s18, v166
  buffer_load_dword v166, v4, s[8:11], 0 offen sc1
  s_cbranch_vccz cA_va0_fw_d
  s_waitcnt vmcnt(4)
  v_cmp_gt_u32 vcc, s18, v167
  buffer_load_dword v167, v4, s[8:11], 0 offen sc1
  s_cbranch_vccz cA_va0_fw_d
  s_waitcnt vmcnt(4)
  v_cmp_gt_u32 vcc, s18, v168
  buffer_load_dword v168, v4, s[8:11], 0 offen sc1
  s_cbranch_vccz cA_va0_fw_d
  s_waitcnt vmcnt(4)
  v_cmp_gt_u32 vcc, s18, v164
  buffer_load_dword v164, v4, s[8:11], 0 offen sc1
  s_cbranch_vccz cA_va0_fw_d
  s_waitcnt vmcnt(4)
  v_cmp_gt_u32 vcc, s18, v165
  buffer_load_dword v165, v4, s[8:11], 0 offen sc1
  s_cbranch_vccz cA_va0_fw_d
  s_waitcnt vmcnt(4)
  v_cmp_gt_u32 vcc, s18, v166
  buffer_load_dword v166, v4, s[8:11], 0 offen sc1
  s_cbranch_vccz cA_va0_fw_d
  s_waitcnt vmcnt(4)
  v_cmp_gt_u32 vcc, s18, v167
  buffer_load_dword v167, v4, s[8:11], 0 offen sc1
  s_cbranch_vccz cA_va0_fw_d
  s_waitcnt vmcnt(4)
  v_cmp_gt_u32 vcc, s18, v168
  buffer_load_dword v168, v4, s[8:11], 0 offen sc1
  s_cbranch_vccz cA_va0_fw_d
  s_waitcnt vmcnt(4)
  v_cmp_gt_u32 vcc, s18, v164
  buffer_load_dword v164, v4, s[8:11], 0 offen sc1
  s_cbranch_vccz cA_va0_fw_d
  s_waitcnt vmcnt(4)
  v_cmp_gt_u32 vcc, s18, v165
  buffer_load_dword v165, v4, s[8:11], 0 offen sc1
  s_cbranch_vccz cA_va0_fw_d
  s_waitcnt vmcnt(4)
  v_cmp_gt_u32 vcc, s18, v166
  buffer_load_dword v166, v4, s[8:11], 0 offen sc1
  s_cbranch_vccz cA_va0_fw_d
  s_waitcnt vmcnt(4)
  v_cmp_gt_u32 vcc, s18, v167
  buffer_load_dword v167, v4, s[8:11], 0 offen sc1
  s_cbranch_vccz cA_va0_fw_d
  s_waitcnt vmcnt(4)
  v_cmp_gt_u32 vcc, s18, v168
  buffer_load_dword v168, v4, s[8:11], 0 offen sc1
  s_cbranch_vccz cA_va0_fw_d
  s_add_u32 s30, s30, 1
  s_cmp_lt_u32 s30, 400000
  s_cbranch_scc1 cA_va0_fw_l
  s_branch cA_abort
cA_va0_fw_d:
  buffer_load_dwordx4 v[8:11], v2, s[8:11], s22 offen offset:0 sc1
  buffer_load_dwordx4 v[12:15], v2, s[8:11], s22 offen offset:1024 sc1
  buffer_load_dwordx4 v[16:19], v2, s[8:11], s22 offen offset:2048 sc1
  buffer_load_dwordx4 v[20:23], v2, s[8:11], s22 offen offset:3072 sc1
  buffer_load_dwordx4 v[24:27], v2, s[8:11], s34 offen offset:0 sc1
  buffer_load_dwordx4 v[28:31], v2, s[8:11], s34 offen offset:1024 sc1
  buffer_load_dwordx4 v[32:35], v2, s[8:11], s34 offen offset:2048 sc1
  buffer_load_dwordx4 v[36:39], v2, s[8:11], s34 offen offset:3072 sc1
  buffer_load_dwordx4 v[40:43], v2, s[8:11], s36 offen offset:0 sc1
  buffer_load_dwordx4 v[44:47], v2, s[8:11], s36 offen offset:1024 sc1
  s_barrier
  ds_read_b128 v[64:67], v2 offset:0
  ds_read_b128 v[68:71], v2 offset:1024
  ds_read_b128 v[72:75], v2 offset:2048
  ds_read_b128 v[76:79], v2 offset:3072
cA_va0_lp:
  s_waitcnt vmcnt(9)
  v_smfmac_f32_16x16x64_bf16 v[48:51], v[8:11], v[80:87], v3
  s_waitcnt vmcnt(8)
  v_smfmac_f32_16x16x64_bf16 v[48:51], v[12:15], v[88:95], v3
  s_waitcnt vmcnt(7)
  v_smfmac_f32_16x16x64_bf16 v[48:51], v[16:19], v[96:103], v3
  s_waitcnt vmcnt(6)
  v_smfmac_f32_16x16x64_bf16 v[48:51], v[20:23], v[104:111], v3
  s_waitcnt vmcnt(5)
  v_smfmac_f32_16x16x64_bf16 v[48:51], v[24:27], v[112:119], v3
  s_waitcnt vmcnt(4)
  v_smfmac_f32_16x16x64_bf16 v[48:51], v[28:31], v[120:127], v3
  s_waitcnt vmcnt(3)
  v_smfmac_f32_16x16x64_bf16 v[48:51], v[32:35], v[128:135], v3
  s_waitcnt vmcnt(2)
  v_smfmac_f32_16x16x64_bf16 v[48:51], v[36:39], v[136:143], v3
  s_waitcnt vmcnt(1) lgkmcnt(0)
  v_smfmac_f32_16x16x64_bf16 v[48:51], v[40:43], v[64:71], v3
  s_waitcnt vmcnt(0)
  v_smfmac_f32_16x16x64_bf16 v[48:51], v[44:47], v[72:79], v3
  s_nop 7
  v_permlane32_swap_b32 v48, v50
  v_permlane32_swap_b32 v49, v51
  v_add_f32 v48, v48, v50
  v_add_f32 v49, v49, v51
  v_cvt_pk_bf16_f32 v160, v48, v49
  v_cmp_u_f32 vcc, v48, v49
  s_nop 0
  v_mov_b32_dpp v161, v160 quad_perm:[1,0,3,2] row_mask:0xf bank_mask:0xf
  v_perm_b32 v160, v161, v160, v5
  v_min_u32 v160, -2, v160
  s_cbranch_vccnz cA_va0_rp
cA_va0_cont:
  buffer_store_dword v160, v1, s[8:11], s21 offen
  s_setprio 0
  s_cmp_lg_u32 s19, 62
  s_cbranch_scc1 cA_va0_nl
  buffer_store_dword v160, v1, s[8:11], s38 offen sc1
  s_waitcnt vmcnt(0)
  buffer_wbl2 sc1
  s_branch cA_done
cA_va0_nl:
  s_add_u32 s25, s25, 458752
  v_mov_b32 v36, 0
  v_mov_b32 v37, 0
  v_mov_b32 v38, 0
  v_mov_b32 v39, 0
  v_mov_b32 v40, 0
  v_mov_b32 v41, 0
  v_mov_b32 v42, 0
  v_mov_b32 v43, 0
  v_mov_b32 v44, 0
  v_mov_b32 v45, 0
  v_mov_b32 v46, 0
  v_mov_b32 v47, 0
  v_mov_b32 v48, 0
  v_mov_b32 v49, 0
  v_mov_b32 v50, 0
  v_mov_b32 v51, 0
  v_mov_b32 v52, 0
  v_mov_b32 v53, 0
  v_mov_b32 v54, 0
  v_mov_b32 v55, 0
  v_mov_b32 v56, 0
  v_mov_b32 v57, 0
  v_mov_b32 v58, 0
  v_mov_b32 v59, 0
  v_mov_b32 v60, 0
  v_mov_b32 v61, 0
  v_mov_b32 v62, 0
  v_mov_b32 v63, 0
  s_mov_b32 s19, s18
  s_add_u32 s18, s18, 1
  s_mov_b32 s22, s20
  s_mov_b32 s20, s21
  s_mov_b32 s21, s22
  s_add_u32 s23, s20, 4096
  s_branch cA_va0_loop
cA_va0_slow:
  s_waitcnt lgkmcnt(0)
cA_va0_sl1:
  s_add_u32 s31, s31, 0x1000000
  buffer_load_dwordx4 v[8:11], v2, s[8:11], s20 offen offset:0 sc1
  buffer_load_dwordx4 v[12:15], v2, s[8:11], s20 offen offset:1024 sc1
  buffer_load_dwordx4 v[16:19], v2, s[8:11], s20 offen offset:2048 sc1
  buffer_load_dwordx4 v[20:23], v2, s[8:11], s20 offen offset:3072 sc1
  buffer_load_dwordx4 v[24:27], v2, s[8:11], s23 offen offset:0 sc1
  buffer_load_dwordx4 v[28:31], v2, s[8:11], s23 offen offset:1024 sc1
  buffer_load_dwordx4 v[32:35], v2, s[8:11], s23 offen offset:2048 sc1
  s_waitcnt vmcnt(0)
  v_max3_u32 v36, v8, v9, v10
  v_max3_u32 v36, v36, v11, v12
  v_max3_u32 v36, v36, v13, v14
  v_max3_u32 v36, v36, v15, v16
  v_max3_u32 v36, v36, v17, v18
  v_max3_u32 v36, v36, v19, v20
  v_max3_u32 v36, v36, v21, v22
  v_max3_u32 v36, v36, v23, v24
  v_max3_u32 v36, v36, v25, v26
  v_max3_u32 v36, v36, v27, v28
  v_max3_u32 v36, v36, v29, v30
  v_max3_u32 v36, v36, v31, v32
  v_max3_u32 v36, v36, v33, v34
  v_max_u32 v36, v36, v35
  v_cmp_eq_u32 vcc, -1, v36
  s_cbranch_vccz cA_va0_sl2
  s_add_u32 s30, s30, 1
  s_cmp_lt_u32 s30, 400000
  s_cbranch_scc1 cA_va0_sl1
  s_branch cA_abort
cA_va0_sl2:
  v_mov_b32 v36, 0
  v_mov_b32 v37, 0
  v_mov_b32 v38, 0
  v_mov_b32 v39, 0
  v_mov_b32 v40, 0
  v_mov_b32 v41, 0
  v_mov_b32 v42, 0
  v_mov_b32 v43, 0
  v_mov_b32 v44, 0
  v_mov_b32 v45, 0
  v_mov_b32 v46, 0
  v_mov_b32 v47, 0
  v_mov_b32 v48, 0
  v_mov_b32 v49, 0
  v_mov_b32 v50, 0
  v_mov_b32 v51, 0
  v_mov_b32 v52, 0
  v_mov_b32 v53, 0
  v_mov_b32 v54, 0
  v_mov_b32 v55, 0
  v_mov_b32 v56, 0
  v_mov_b32 v57, 0
  v_mov_b32 v58, 0
  v_mov_b32 v59, 0
  v_mov_b32 v60, 0
  v_mov_b32 v61, 0
  v_mov_b32 v62, 0
  v_mov_b32 v63, 0
  buffer_store_dword v162, v1, s[8:11], s21 offen
  ds_read_b128 v[64:67], v0 offset:0
  ds_read_b128 v[68:71], v0 offset:1024
  v_smfmac_f32_16x16x64_bf16 v[36:39], v[8:11], a[0:7], v3
  v_smfmac_f32_16x16x64_bf16 v[40:43], v[8:11], a[56:63], v3
  v_smfmac_f32_16x16x64_bf16 v[44:47], v[8:11], a[112:119], v3
  v_smfmac_f32_16x16x64_bf16 v[48:51], v[8:11], a[168:175], v3
  v_smfmac_f32_16x16x64_bf16 v[52:55], v[8:11], a[224:231], v3
  v_smfmac_f32_16x16x64_bf16 v[56:59], v[8:11], v[200:207], v3
  s_waitcnt lgkmcnt(0)
  v_smfmac_f32_16x16x64_bf16 v[60:63], v[8:11], v[64:71], v3
  ds_read_b128 v[72:75], v0 offset:2048
  ds_read_b128 v[76:79], v0 offset:3072
  v_smfmac_f32_16x16x64_bf16 v[36:39], v[12:15], a[8:15], v3
  v_smfmac_f32_16x16x64_bf16 v[40:43], v[12:15], a[64:71], v3
  v_smfmac_f32_16x16x64_bf16 v[44:47], v[12:15], a[120:127], v3
  v_smfmac_f32_16x16x64_bf16 v[48:51], v[12:15], a[176:183], v3
  v_smfmac_f32_16x16x64_bf16 v[52:55], v[12:15], a[232:239], v3
  v_smfmac_f32_16x16x64_bf16 v[56:59], v[12:15], v[208:215], v3
  s_waitcnt lgkmcnt(0)
  v_smfmac_f32_16x16x64_bf16 v[60:63], v[12:15], v[72:79], v3
  ds_read_b128 v[144:147], v0 offset:4096
  ds_read_b128 v[148:151], v0 offset:5120
  v_smfmac_f32_16x16x64_bf16 v[36:39], v[16:19], a[16:23], v3
  v_smfmac_f32_16x16x64_bf16 v[40:43], v[16:19], a[72:79], v3
  v_smfmac_f32_16x16x64_bf16 v[44:47], v[16:19], a[128:135], v3
  v_smfmac_f32_16x16x64_bf16 v[48:51], v[16:19], a[184:191], v3
  v_smfmac_f32_16x16x64_bf16 v[52:55], v[16:19], a[240:247], v3
  v_smfmac_f32_16x16x64_bf16 v[56:59], v[16:19], v[216:223], v3
  s_waitcnt lgkmcnt(0)
  v_smfmac_f32_16x16x64_bf16 v[60:63], v[16:19], v[144:151], v3
  ds_read_b128 v[64:67], v0 offset:6144
  ds_read_b128 v[68:71], v0 offset:7168
  v_smfmac_f32_16x16x64_bf16 v[36:39], v[20:23], a[24:31], v3
  v_smfmac_f32_16x16x64_bf16 v[40:43], v[20:23], a[80:87], v3
  v_smfmac_f32_16x16x64_bf16 v[44:47], v[20:23], a[136:143], v3
  v_smfmac_f32_16x16x64_bf16 v[48:51], v[20:23], a[192:199], v3
  v_smfmac_f32_16x16x64_bf16 v[52:55], v[20:23], a[248:255], v3
  v_smfmac_f32_16x16x64_bf16 v[56:59], v[20:23], v[224:231], v3
  s_waitcnt lgkmcnt(0)
  v_smfmac_f32_16x16x64_bf16 v[60:63], v[20:23], v[64:71], v3
  ds_read_b128 v[72:75], v0 offset:8192
  ds_read_b128 v[76:79], v0 offset:9216
  v_smfmac_f32_16x16x64_bf16 v[36:39], v[24:27], a[32:39], v3
  v_smfmac_f32_16x16x64_bf16 v[40:43], v[24:27], a[88:95], v3
  v_smfmac_f32_16x16x64_bf16 v[44:47], v[24:27], a[144:151], v3
  v_smfmac_f32_16x16x64_bf16 v[48:51], v[24:27], a[200:207], v3
  v_smfmac_f32_16x16x64_bf16 v[52:55], v[24:27], v[176:183], v3
  v_smfmac_f32_16x16x64_bf16 v[56:59], v[24:27], v[232:239], v3
  s_waitcnt lgkmcnt(0)
  v_smfmac_f32_16x16x64_bf16 v[60:63], v[24:27], v[72:79], v3
  ds_read_b128 v[144:147], v0 offset:10240
  ds_read_b128 v[148:151], v0 offset:11264
  v_smfmac_f32_16x16x64_bf16 v[36:39], v[28:31], a[40:47], v3
  v_smfmac_f32_16x16x64_bf16 v[40:43], v[28:31], a[96:103], v3
  v_smfmac_f32_16x16x64_bf16 v[44:47], v[28:31], a[152:159], v3
  v_smfmac_f32_16x16x64_bf16 v[48:51], v[28:31], a[208:215], v3
  v_smfmac_f32_16x16x64_bf16 v[52:55], v[28:31], v[184:191], v3
  v_smfmac_f32_16x16x64_bf16 v[56:59], v[28:31], v[240:247], v3
  s_waitcnt lgkmcnt(0)
  v_smfmac_f32_16x16x64_bf16 v[60:63], v[28:31], v[144:151], v3
  ds_read_b128 v[64:67], v0 offset:12288
  ds_read_b128 v[68:71], v0 offset:13312
  v_smfmac_f32_16x16x64_bf16 v[36:39], v[32:35], a[48:55], v3
  v_smfmac_f32_16x16x64_bf16 v[40:43], v[32:35], a[104:111], v3
  v_smfmac_f32_16x16x64_bf16 v[44:47], v[32:35], a[160:167], v3
  v_smfmac_f32_16x16x64_bf16 v[48:51], v[32:35], a[216:223], v3
  v_smfmac_f32_16x16x64_bf16 v[52:55], v[32:35], v[192:199], v3
  v_smfmac_f32_16x16x64_bf16 v[56:59], v[32:35], v[248:255], v3
  s_waitcnt lgkmcnt(0)
  v_smfmac_f32_16x16x64_bf16 v[60:63], v[32:35], v[64:71], v3
  v_permlane32_swap_b32 v36, v38
  v_permlane32_swap_b32 v37, v39
  v_add_f32 v36, v36, v38
  v_add_f32 v37, v37, v39
  v_cvt_pk_bf16_f32 v38, v36, v37
  ds_write_b32 v152, v38
  v_permlane32_swap_b32 v40, v42
  v_permlane32_swap_b32 v41, v43
  v_add_f32 v40, v40, v42
  v_add_f32 v41, v41, v43
  v_cvt_pk_bf16_f32 v42, v40, v41
  ds_write_b32 v153, v42
  v_permlane32_swap_b32 v44, v46
  v_permlane32_swap_b32 v45, v47
  v_add_f32 v44, v44, v46
  v_add_f32 v45, v45, v47
  v_cvt_pk_bf16_f32 v46, v44, v45
  ds_write_b32 v154, v46
  v_permlane32_swap_b32 v48, v50
  v_permlane32_swap_b32 v49, v51
  v_add_f32 v48, v48, v50
  v_add_f32 v49, v49, v51
  v_cvt_pk_bf16_f32 v50, v48, v49
  ds_write_b32 v155, v50
  v_permlane32_swap_b32 v52, v54
  v_permlane32_swap_b32 v53, v55
  v_add_f32 v52, v52, v54
  v_add_f32 v53, v53, v55
  v_cvt_pk_bf16_f32 v54, v52, v53
  ds_write_b32 v156, v54
  v_permlane32_swap_b32 v56, v58
  v_permlane32_swap_b32 v57, v59
  v_add_f32 v56, v56, v58
  v_add_f32 v57, v57, v59
  v_cvt_pk_bf16_f32 v58, v56, v57
  ds_write_b32 v157, v58
  v_permlane32_swap_b32 v60, v62
  v_permlane32_swap_b32 v61, v63
  v_add_f32 v60, v60, v62
  v_add_f32 v61, v61, v63
  v_cvt_pk_bf16_f32 v62, v60, v61
  ds_write_b32 v158, v62
  buffer_load_dword v164, v4, s[8:11], 0 offen sc1
  buffer_load_dword v165, v4, s[8:11], 0 offen sc1
  buffer_load_dword v166, v4, s[8:11], 0 offen sc1
  buffer_load_dword v167, v4, s[8:11], 0 offen sc1
  buffer_load_dword v168, v4, s[8:11], 0 offen sc1
  s_branch cA_va0_t2d
cA_va0_rp:
  s_cmp_lg_u32 s37, 0
  s_cbranch_scc1 cA_va0_cont
cA_va0_rv:
  s_add_u32 s31, s31, 0x10000
  buffer_load_dwordx4 v[8:11], v2, s[8:11], s22 offen offset:0 sc1
  buffer_load_dwordx4 v[12:15], v2, s[8:11], s22 offen offset:1024 sc1
  buffer_load_dwordx4 v[16:19], v2, s[8:11], s22 offen offset:2048 sc1
  buffer_load_dwordx4 v[20:23], v2, s[8:11], s22 offen offset:3072 sc1
  buffer_load_dwordx4 v[24:27], v2, s[8:11], s34 offen offset:0 sc1
  buffer_load_dwordx4 v[28:31], v2, s[8:11], s34 offen offset:1024 sc1
  buffer_load_dwordx4 v[32:35], v2, s[8:11], s34 offen offset:2048 sc1
  buffer_load_dwordx4 v[36:39], v2, s[8:11], s34 offen offset:3072 sc1
  buffer_load_dwordx4 v[40:43], v2, s[8:11], s36 offen offset:0 sc1
  buffer_load_dwordx4 v[44:47], v2, s[8:11], s36 offen offset:1024 sc1
  s_waitcnt vmcnt(0)
  v_max3_u32 v52, v8, v9, v10
  v_max3_u32 v52, v52, v11, v12
  v_max3_u32 v52, v52, v13, v14
  v_max3_u32 v52, v52, v15, v16
  v_max3_u32 v52, v52, v17, v18
  v_max3_u32 v52, v52, v19, v20
  v_max3_u32 v52, v52, v21, v22
  v_max3_u32 v52, v52, v23, v24
  v_max3_u32 v52, v52, v25, v26
  v_max3_u32 v52, v52, v27, v28
  v_max3_u32 v52, v52, v29, v30
  v_max3_u32 v52, v52, v31, v32
  v_max3_u32 v52, v52, v33, v34
  v_max3_u32 v52, v52, v35, v36
  v_max3_u32 v52, v52, v37, v38
  v_max3_u32 v52, v52, v39, v40
  v_max3_u32 v52, v52, v41, v42
  v_max3_u32 v52, v52, v43, v44
  v_max3_u32 v52, v52, v45, v46
  v_max_u32 v52, v52, v47
  v_cmp_eq_u32 vcc, -1, v52
  s_mov_b32 s37, 1
  v_mov_b32 v48, 0
  v_mov_b32 v49, 0
  v_mov_b32 v50, 0
  v_mov_b32 v51, 0
  s_nop 1
  s_cbranch_vccz cA_va0_lp
  s_add_u32 s30, s30, 1
  s_cmp_lt_u32 s30, 400000
  s_cbranch_scc1 cA_va0_rv
  s_branch cA_abort
.p2align 6
cA_va1_loop:
  s_mov_b32 s30, 0
  s_barrier
  buffer_load_dwordx4 v[28:31], v2, s[8:11], s23 offen offset:1024 sc1
  buffer_load_dwordx4 v[32:35], v2, s[8:11], s23 offen offset:2048 sc1
  s_barrier
  s_cmp_lt_u32 s19, 58
  s_cbranch_scc1 cA_va1_m1
  buffer_store_dword v160, v1, s[8:11], s38 offen sc1
  s_branch cA_va1_m2
cA_va1_m1:
  buffer_store_dword v160, v1, s[8:11], s38 offen nt
cA_va1_m2:
  s_add_u32 s22, s25, 0
  buffer_load_dwordx4 v[80:83], v6, s[8:11], s22 offen offset:0 sc1
  buffer_load_dwordx4 v[84:87], v6, s[8:11], s22 offen offset:1792 sc1
  s_add_u32 s22, s25, 3584
  buffer_load_dwordx4 v[88:91], v6, s[8:11], s22 offen offset:0 sc1
  buffer_load_dwordx4 v[92:95], v6, s[8:11], s22 offen offset:1792 sc1
  s_add_u32 s22, s25, 7168
  buffer_load_dwordx4 v[96:99], v6, s[8:11], s22 offen offset:0 sc1
  s_mul_i32 s38, s18, 7168
  s_add_u32 s38, s38, 88002560
  s_waitcnt vmcnt(6)
  ds_write_b128 v2, v[32:35] offset:14336
  v_smfmac_f32_16x16x64_bf16 v[36:39], v[28:31], a[40:47], v3
  buffer_load_dwordx4 v[100:103], v6, s[8:11], s22 offen offset:1792 sc1
  v_smfmac_f32_16x16x64_bf16 v[40:43], v[28:31], a[96:103], v3
  s_add_u32 s22, s25, 10752
  buffer_load_dwordx4 v[104:107], v6, s[8:11], s22 offen offset:0 sc1
  v_smfmac_f32_16x16x64_bf16 v[44:47], v[28:31], a[152:159], v3
  buffer_load_dwordx4 v[108:111], v6, s[8:11], s22 offen offset:1792 sc1
  v_smfmac_f32_16x16x64_bf16 v[48:51], v[28:31], a[208:215], v3
  s_add_u32 s22, s25, 14336
  buffer_load_dwordx4 v[112:115], v6, s[8:11], s22 offen offset:0 sc1
  v_smfmac_f32_16x16x64_bf16 v[52:55], v[28:31], v[184:191], v3
  s_waitcnt lgkmcnt(0)
  s_barrier
  ds_read_b128 v[8:11], v2 offset:8192
  ds_read_b128 v[12:15], v2 offset:9216
  ds_read_b128 v[16:19], v2 offset:10240
  ds_read_b128 v[20:23], v2 offset:11264
  ds_read_b128 v[24:27], v2 offset:12288
  buffer_load_dwordx4 v[116:119], v6, s[8:11], s22 offen offset:1792 sc1
  v_smfmac_f32_16x16x64_bf16 v[56:59], v[28:31], v[240:247], v3
  s_add_u32 s22, s25, 17920
  buffer_load_dwordx4 v[120:123], v6, s[8:11], s22 offen offset:0 sc1
  v_smfmac_f32_16x16x64_bf16 v[36:39], v[32:35], a[48:55], v3
  buffer_load_dwordx4 v[124:127], v6, s[8:11], s22 offen offset:1792 sc1
  v_smfmac_f32_16x16x64_bf16 v[40:43], v[32:35], a[104:111], v3
  s_add_u32 s22, s25, 21504
  buffer_load_dwordx4 v[128:131], v6, s[8:11], s22 offen offset:0 sc1
  v_smfmac_f32_16x16x64_bf16 v[44:47], v[32:35], a[160:167], v3
  buffer_load_dwordx4 v[132:135], v6, s[8:11], s22 offen offset:1792 sc1
  v_smfmac_f32_16x16x64_bf16 v[48:51], v[32:35], a[216:223], v3
  s_add_u32 s22, s25, 25088
  buffer_load_dwordx4 v[136:139], v6, s[8:11], s22 offen offset:0 sc1
  v_smfmac_f32_16x16x64_bf16 v[52:55], v[32:35], v[192:199], v3
  ds_read_b128 v[64:67], v0 offset:0
  ds_read_b128 v[68:71], v0 offset:1024
  buffer_load_dwordx4 v[140:143], v6, s[8:11], s22 offen offset:1792 sc1
  v_smfmac_f32_16x16x64_bf16 v[56:59], v[32:35], v[248:255], v3
  s_waitcnt lgkmcnt(6)
  ds_read_b128 v[72:75], v0 offset:2048
  ds_read_b128 v[76:79], v0 offset:3072
  v_smfmac_f32_16x16x64_bf16 v[36:39], v[8:11], a[0:7], v3
  s_waitcnt lgkmcnt(7)
  v_smfmac_f32_16x16x64_bf16 v[36:39], v[12:15], a[8:15], v3
  s_waitcnt lgkmcnt(6)
  v_smfmac_f32_16x16x64_bf16 v[36:39], v[16:19], a[16:23], v3
  s_waitcnt lgkmcnt(2)
  v_smfmac_f32_16x16x64_bf16 v[60:63], v[8:11], v[64:71], v3
  s_waitcnt lgkmcnt(5)
  ds_read_b128 v[144:147], v0 offset:4096
  ds_read_b128 v[148:151], v0 offset:5120
  v_smfmac_f32_16x16x64_bf16 v[36:39], v[20:23], a[24:31], v3
  s_waitcnt lgkmcnt(6)
  v_smfmac_f32_16x16x64_bf16 v[36:39], v[24:27], a[32:39], v3
  v_smfmac_f32_16x16x64_bf16 v[40:43], v[8:11], a[56:63], v3
  s_waitcnt lgkmcnt(2)
  v_smfmac_f32_16x16x64_bf16 v[60:63], v[12:15], v[72:79], v3
  ds_read_b128 v[64:67], v0 offset:6144
  ds_read_b128 v[68:71], v0 offset:7168
  v_smfmac_f32_16x16x64_bf16 v[40:43], v[12:15], a[64:71], v3
  v_permlane32_swap_b32 v36, v38
  v_smfmac_f32_16x16x64_bf16 v[40:43], v[16:19], a[72:79], v3
  v_permlane32_swap_b32 v37, v39
  v_smfmac_f32_16x16x64_bf16 v[40:43], v[20:23], a[80:87], v3
  s_waitcnt lgkmcnt(2)
  v_add_f32 v36, v36, v38
  v_smfmac_f32_16x16x64_bf16 v[60:63], v[16:19], v[144:151], v3
  ds_read_b128 v[72:75], v0 offset:8192
  ds_read_b128 v[76:79], v0 offset:9216
  v_add_f32 v37, v37, v39
  v_smfmac_f32_16x16x64_bf16 v[40:43], v[24:27], a[88:95], v3
  v_cmp_u_f32 vcc, v36, v37
  v_smfmac_f32_16x16x64_bf16 v[44:47], v[8:11], a[112:119], v3
  v_cvt_pk_bf16_f32 v38, v36, v37
  v_smfmac_f32_16x16x64_bf16 v[44:47], v[12:15], a[120:127], v3
  ds_write_b32 v152, v38
  s_waitcnt lgkmcnt(3)
  s_cbranch_vccnz cA_va1_slow
  v_permlane32_swap_b32 v40, v42
  v_smfmac_f32_16x16x64_bf16 v[60:63], v[20:23], v[64:71], v3
  ds_read_b128 v[144:147], v0 offset:10240
  ds_read_b128 v[148:151], v0 offset:11264
  v_permlane32_swap_b32 v41, v43
  v_smfmac_f32_16x16x64_bf16 v[44:47], v[16:19], a[128:135], v3
  buffer_store_dword v162, v1, s[8:11], s21 offen
  v_add_f32 v40, v40, v42
  v_smfmac_f32_16x16x64_bf16 v[44:47], v[20:23], a[136:143], v3
  v_add_f32 v41, v41, v43
  v_smfmac_f32_16x16x64_bf16 v[44:47], v[24:27], a[144:151], v3
  s_waitcnt lgkmcnt(3)
  v_cvt_pk_bf16_f32 v42, v40, v41
  v_smfmac_f32_16x16x64_bf16 v[60:63], v[24:27], v[72:79], v3
  ds_write_b32 v153, v42
  ds_read_b128 v[64:67], v0 offset:12288
  ds_read_b128 v[68:71], v0 offset:13312
  v_smfmac_f32_16x16x64_bf16 v[48:51], v[8:11], a[168:175], v3
  s_nop 0
  v_permlane32_swap_b32 v44, v46
  v_smfmac_f32_16x16x64_bf16 v[48:51], v[12:15], a[176:183], v3
  v_permlane32_swap_b32 v45, v47
  v_smfmac_f32_16x16x64_bf16 v[48:51], v[16:19], a[184:191], v3
  s_waitcnt lgkmcnt(3)
  v_add_f32 v44, v44, v46
  v_smfmac_f32_16x16x64_bf16 v[60:63], v[28:31], v[144:151], v3
  v_add_f32 v45, v45, v47
  v_smfmac_f32_16x16x64_bf16 v[48:51], v[20:23], a[192:199], v3
  v_cvt_pk_bf16_f32 v46, v44, v45
  v_smfmac_f32_16x16x64_bf16 v[48:51], v[24:27], a[200:207], v3
  ds_write_b32 v154, v46
  v_smfmac_f32_16x16x64_bf16 v[52:55], v[8:11], a[224:231], v3
  s_waitcnt lgkmcnt(1)
  v_smfmac_f32_16x16x64_bf16 v[60:63], v[32:35], v[64:71], v3
  v_smfmac_f32_16x16x64_bf16 v[52:55], v[12:15], a[232:239], v3
  v_permlane32_swap_b32 v48, v50
  v_smfmac_f32_16x16x64_bf16 v[52:55], v[16:19], a[240:247], v3
  v_permlane32_swap_b32 v49, v51
  v_smfmac_f32_16x16x64_bf16 v[52:55], v[20:23], a[248:255], v3
  v_add_f32 v48, v48, v50
  v_smfmac_f32_16x16x64_bf16 v[52:55], v[24:27], v[176:183], v3
  v_add_f32 v49, v49, v51
  v_smfmac_f32_16x16x64_bf16 v[56:59], v[8:11], v[200:207], v3
  v_cvt_pk_bf16_f32 v50, v48, v49
  v_smfmac_f32_16x16x64_bf16 v[56:59], v[12:15], v[208:215], v3
  ds_write_b32 v155, v50
  v_permlane32_swap_b32 v60, v62
  v_smfmac_f32_16x16x64_bf16 v[56:59], v[16:19], v[216:223], v3
  v_permlane32_swap_b32 v61, v63
  v_smfmac_f32_16x16x64_bf16 v[56:59], v[20:23], v[224:231], v3
  v_add_f32 v60, v60, v62
  v_smfmac_f32_16x16x64_bf16 v[56:59], v[24:27], v[232:239], v3
  v_add_f32 v61, v61, v63
  v_cvt_pk_bf16_f32 v62, v60, v61
  ds_write_b32 v158, v62
  v_permlane32_swap_b32 v52, v54
  v_permlane32_swap_b32 v53, v55
  v_add_f32 v52, v52, v54
  v_add_f32 v53, v53, v55
  v_cvt_pk_bf16_f32 v54, v52, v53
  ds_write_b32 v156, v54
  v_permlane32_swap_b32 v56, v58
  v_permlane32_swap_b32 v57, v59
  v_add_f32 v56, v56, v58
  v_add_f32 v57, v57, v59
  v_cvt_pk_bf16_f32 v58, v56, v57
  ds_write_b32 v157, v58
cA_va1_t2d:
  s_add_u32 s22, s20, 9216
  s_add_u32 s34, s20, 13312
  s_add_u32 s36, s20, 7168
  s_mov_b32 s37, 0
  v_mov_b32 v48, 0
  v_mov_b32 v49, 0
  v_mov_b32 v50, 0
  v_mov_b32 v51, 0
  v_mov_b32 v163, s18
  s_waitcnt lgkmcnt(0)
  s_barrier
  buffer_load_dwordx4 v[8:11], v2, s[8:11], s22 offen offset:0 sc1
  buffer_load_dwordx4 v[12:15], v2, s[8:11], s22 offen offset:1024 sc1
  buffer_load_dwordx4 v[16:19], v2, s[8:11], s22 offen offset:2048 sc1
  buffer_load_dwordx4 v[20:23], v2, s[8:11], s22 offen offset:3072 sc1
  buffer_load_dwordx4 v[24:27], v2, s[8:11], s34 offen offset:0 sc1
  buffer_load_dwordx4 v[28:31], v2, s[8:11], s34 offen offset:1024 sc1
  buffer_load_dwordx4 v[32:35], v2, s[8:11], s34 offen offset:2048 sc1
  buffer_load_dwordx4 v[36:39], v2, s[8:11], s34 offen offset:3072 sc1
  buffer_load_dwordx4 v[40:43], v2, s[8:11], s36 offen offset:0 sc1
  buffer_load_dwordx4 v[44:47], v2, s[8:11], s36 offen offset:1024 sc1
  ds_read_b128 v[64:67], v2 offset:4096
  ds_read_b128 v[68:71], v2 offset:5120
  ds_read_b128 v[72:75], v2 offset:6144
  ds_read_b128 v[76:79], v2 offset:7168
cA_va1_lp:
  s_waitcnt vmcnt(9)
  v_smfmac_f32_16x16x64_bf16 v[48:51], v[8:11], v[80:87], v3
  s_waitcnt vmcnt(8)
  v_smfmac_f32_16x16x64_bf16 v[48:51], v[12:15], v[88:95], v3
  s_waitcnt vmcnt(7)
  v_smfmac_f32_16x16x64_bf16 v[48:51], v[16:19], v[96:103], v3
  v_max3_u32 v55, v8, v12, v16
  s_waitcnt vmcnt(6)
  v_smfmac_f32_16x16x64_bf16 v[48:51], v[20:23], v[104:111], v3
  v_max_u32 v55, v55, v20
  v_cmp_eq_u32 vcc, -1, v55
  s_waitcnt vmcnt(5)
  v_smfmac_f32_16x16x64_bf16 v[48:51], v[24:27], v[112:119], v3
  s_waitcnt vmcnt(4)
  v_smfmac_f32_16x16x64_bf16 v[48:51], v[28:31], v[120:127], v3
  s_cbranch_vccnz cA_va1_rv
  buffer_store_dword v163, v7, s[8:11], 0 offen
  s_waitcnt vmcnt(4)
  v_smfmac_f32_16x16x64_bf16 v[48:51], v[32:35], v[128:135], v3
  s_waitcnt vmcnt(3)
  v_smfmac_f32_16x16x64_bf16 v[48:51], v[36:39], v[136:143], v3
  s_waitcnt vmcnt(2) lgkmcnt(0)
  v_smfmac_f32_16x16x64_bf16 v[48:51], v[40:43], v[64:71], v3
  s_waitcnt vmcnt(1)
  v_smfmac_f32_16x16x64_bf16 v[48:51], v[44:47], v[72:79], v3
  s_nop 7
  v_permlane32_swap_b32 v48, v50
  v_permlane32_swap_b32 v49, v51
  v_add_f32 v48, v48, v50
  v_add_f32 v49, v49, v51
  v_cvt_pk_bf16_f32 v160, v48, v49
  v_cmp_u_f32 vcc, v48, v49
  s_nop 0
  v_mov_b32_dpp v161, v160 quad_perm:[1,0,3,2] row_mask:0xf bank_mask:0xf
  v_perm_b32 v160, v161, v160, v5
  v_min_u32 v160, -2, v160
  s_cbranch_vccnz cA_va1_rp
cA_va1_cont:
  buffer_store_dword v160, v1, s[8:11], s21 offen
  s_cmp_lg_u32 s19, 62
  s_cbranch_scc1 cA_va1_nl
  buffer_store_dword v160, v1, s[8:11], s38 offen sc1
  s_waitcnt vmcnt(0)
  buffer_wbl2 sc1
  s_branch cA_done
cA_va1_nl:
  s_add_u32 s25, s25, 458752
  v_mov_b32 v36, 0
  v_mov_b32 v37, 0
  v_mov_b32 v38, 0
  v_mov_b32 v39, 0
  v_mov_b32 v40, 0
  v_mov_b32 v41, 0
  v_mov_b32 v42, 0
  v_mov_b32 v43, 0
  v_mov_b32 v44, 0
  v_mov_b32 v45, 0
  v_mov_b32 v46, 0
  v_mov_b32 v47, 0
  v_mov_b32 v48, 0
  v_mov_b32 v49, 0
  v_mov_b32 v50, 0
  v_mov_b32 v51, 0
  v_mov_b32 v52, 0
  v_mov_b32 v53, 0
  v_mov_b32 v54, 0
  v_mov_b32 v55, 0
  v_mov_b32 v56, 0
  v_mov_b32 v57, 0
  v_mov_b32 v58, 0
  v_mov_b32 v59, 0
  v_mov_b32 v60, 0
  v_mov_b32 v61, 0
  v_mov_b32 v62, 0
  v_mov_b32 v63, 0
  s_mov_b32 s19, s18
  s_add_u32 s18, s18, 1
  s_mov_b32 s22, s20
  s_mov_b32 s20, s21
  s_mov_b32 s21, s22
  s_add_u32 s23, s20, 4096
  s_branch cA_va1_loop
cA_va1_slow:
  s_waitcnt lgkmcnt(0)
cA_va1_sl1:
  s_add_u32 s31, s31, 0x1000000
  buffer_load_dwordx4 v[8:11], v2, s[8:11], s20 offen offset:0 sc1
  buffer_load_dwordx4 v[12:15], v2, s[8:11], s20 offen offset:1024 sc1
  buffer_load_dwordx4 v[16:19], v2, s[8:11], s20 offen offset:2048 sc1
  buffer_load_dwordx4 v[20:23], v2, s[8:11], s20 offen offset:3072 sc1
  buffer_load_dwordx4 v[24:27], v2, s[8:11], s23 offen offset:0 sc1
  buffer_load_dwordx4 v[28:31], v2, s[8:11], s23 offen offset:1024 sc1
  buffer_load_dwordx4 v[32:35], v2, s[8:11], s23 offen offset:2048 sc1
  s_waitcnt vmcnt(0)
  v_max3_u32 v36, v8, v9, v10
  v_max3_u32 v36, v36, v11, v12
  v_max3_u32 v36, v36, v13, v14
  v_max3_u32 v36, v36, v15, v16
  v_max3_u32 v36, v36, v17, v18
  v_max3_u32 v36, v36, v19, v20
  v_max3_u32 v36, v36, v21, v22
  v_max3_u32 v36, v36, v23, v24
  v_max3_u32 v36, v36, v25, v26
  v_max3_u32 v36, v36, v27, v28
  v_max3_u32 v36, v36, v29, v30
  v_max3_u32 v36, v36, v31, v32
  v_max3_u32 v36, v36, v33, v34
  v_max_u32 v36, v36, v35
  v_cmp_eq_u32 vcc, -1, v36
  s_cbranch_vccz cA_va1_sl2
  s_add_u32 s30, s30, 1
  s_cmp_lt_u32 s30, 400000
  s_cbranch_scc1 cA_va1_sl1
  s_branch cA_abort
cA_va1_sl2:
  v_mov_b32 v36, 0
  v_mov_b32 v37, 0
  v_mov_b32 v38, 0
  v_mov_b32 v39, 0
  v_mov_b32 v40, 0
  v_mov_b32 v41, 0
  v_mov_b32 v42, 0
  v_mov_b32 v43, 0
  v_mov_b32 v44, 0
  v_mov_b32 v45, 0
  v_mov_b32 v46, 0
  v_mov_b32 v47, 0
  v_mov_b32 v48, 0
  v_mov_b32 v49, 0
  v_mov_b32 v50, 0
  v_mov_b32 v51, 0
  v_mov_b32 v52, 0
  v_mov_b32 v53, 0
  v_mov_b32 v54, 0
  v_mov_b32 v55, 0
  v_mov_b32 v56, 0
  v_mov_b32 v57, 0
  v_mov_b32 v58, 0
  v_mov_b32 v59, 0
  v_mov_b32 v60, 0
  v_mov_b32 v61, 0
  v_mov_b32 v62, 0
  v_mov_b32 v63, 0
  buffer_store_dword v162, v1, s[8:11], s21 offen
  ds_read_b128 v[64:67], v0 offset:0
  ds_read_b128 v[68:71], v0 offset:1024
  v_smfmac_f32_16x16x64_bf16 v[36:39], v[8:11], a[0:7], v3
  v_smfmac_f32_16x16x64_bf16 v[40:43], v[8:11], a[56:63], v3
  v_smfmac_f32_16x16x64_bf16 v[44:47], v[8:11], a[112:119], v3
  v_smfmac_f32_16x16x64_bf16 v[48:51], v[8:11], a[168:175], v3
  v_smfmac_f32_16x16x64_bf16 v[52:55], v[8:11], a[224:231], v3
  v_smfmac_f32_16x16x64_bf16 v[56:59], v[8:11], v[200:207], v3
  s_waitcnt lgkmcnt(0)
  v_smfmac_f32_16x16x64_bf16 v[60:63], v[8:11], v[64:71], v3
  ds_read_b128 v[72:75], v0 offset:2048
  ds_read_b128 v[76:79], v0 offset:3072
  v_smfmac_f32_16x16x64_bf16 v[36:39], v[12:15], a[8:15], v3
  v_smfmac_f32_16x16x64_bf16 v[40:43], v[12:15], a[64:71], v3
  v_smfmac_f32_16x16x64_bf16 v[44:47], v[12:15], a[120:127], v3
  v_smfmac_f32_16x16x64_bf16 v[48:51], v[12:15], a[176:183], v3
  v_smfmac_f32_16x16x64_bf16 v[52:55], v[12:15], a[232:239], v3
  v_smfmac_f32_16x16x64_bf16 v[56:59], v[12:15], v[208:215], v3
  s_waitcnt lgkmcnt(0)
  v_smfmac_f32_16x16x64_bf16 v[60:63], v[12:15], v[72:79], v3
  ds_read_b128 v[144:147], v0 offset:4096
  ds_read_b128 v[148:151], v0 offset:5120
  v_smfmac_f32_16x16x64_bf16 v[36:39], v[16:19], a[16:23], v3
  v_smfmac_f32_16x16x64_bf16 v[40:43], v[16:19], a[72:79], v3
  v_smfmac_f32_16x16x64_bf16 v[44:47], v[16:19], a[128:135], v3
  v_smfmac_f32_16x16x64_bf16 v[48:51], v[16:19], a[184:191], v3
  v_smfmac_f32_16x16x64_bf16 v[52:55], v[16:19], a[240:247], v3
  v_smfmac_f32_16x16x64_bf16 v[56:59], v[16:19], v[216:223], v3
  s_waitcnt lgkmcnt(0)
  v_smfmac_f32_16x16x64_bf16 v[60:63], v[16:19], v[144:151], v3
  ds_read_b128 v[64:67], v0 offset:6144
  ds_read_b128 v[68:71], v0 offset:7168
  v_smfmac_f32_16x16x64_bf16 v[36:39], v[20:23], a[24:31], v3
  v_smfmac_f32_16x16x64_bf16 v[40:43], v[20:23], a[80:87], v3
  v_smfmac_f32_16x16x64_bf16 v[44:47], v[20:23], a[136:143], v3
  v_smfmac_f32_16x16x64_bf16 v[48:51], v[20:23], a[192:199], v3
  v_smfmac_f32_16x16x64_bf16 v[52:55], v[20:23], a[248:255], v3
  v_smfmac_f32_16x16x64_bf16 v[56:59], v[20:23], v[224:231], v3
  s_waitcnt lgkmcnt(0)
  v_smfmac_f32_16x16x64_bf16 v[60:63], v[20:23], v[64:71], v3
  ds_read_b128 v[72:75], v0 offset:8192
  ds_read_b128 v[76:79], v0 offset:9216
  v_smfmac_f32_16x16x64_bf16 v[36:39], v[24:27], a[32:39], v3
  v_smfmac_f32_16x16x64_bf16 v[40:43], v[24:27], a[88:95], v3
  v_smfmac_f32_16x16x64_bf16 v[44:47], v[24:27], a[144:151], v3
  v_smfmac_f32_16x16x64_bf16 v[48:51], v[24:27], a[200:207], v3
  v_smfmac_f32_16x16x64_bf16 v[52:55], v[24:27], v[176:183], v3
  v_smfmac_f32_16x16x64_bf16 v[56:59], v[24:27], v[232:239], v3
  s_waitcnt lgkmcnt(0)
  v_smfmac_f32_16x16x64_bf16 v[60:63], v[24:27], v[72:79], v3
  ds_read_b128 v[144:147], v0 offset:10240
  ds_read_b128 v[148:151], v0 offset:11264
  v_smfmac_f32_16x16x64_bf16 v[36:39], v[28:31], a[40:47], v3
  v_smfmac_f32_16x16x64_bf16 v[40:43], v[28:31], a[96:103], v3
  v_smfmac_f32_16x16x64_bf16 v[44:47], v[28:31], a[152:159], v3
  v_smfmac_f32_16x16x64_bf16 v[48:51], v[28:31], a[208:215], v3
  v_smfmac_f32_16x16x64_bf16 v[52:55], v[28:31], v[184:191], v3
  v_smfmac_f32_16x16x64_bf16 v[56:59], v[28:31], v[240:247], v3
  s_waitcnt lgkmcnt(0)
  v_smfmac_f32_16x16x64_bf16 v[60:63], v[28:31], v[144:151], v3
  ds_read_b128 v[64:67], v0 offset:12288
  ds_read_b128 v[68:71], v0 offset:13312
  v_smfmac_f32_16x16x64_bf16 v[36:39], v[32:35], a[48:55], v3
  v_smfmac_f32_16x16x64_bf16 v[40:43], v[32:35], a[104:111], v3
  v_smfmac_f32_16x16x64_bf16 v[44:47], v[32:35], a[160:167], v3
  v_smfmac_f32_16x16x64_bf16 v[48:51], v[32:35], a[216:223], v3
  v_smfmac_f32_16x16x64_bf16 v[52:55], v[32:35], v[192:199], v3
  v_smfmac_f32_16x16x64_bf16 v[56:59], v[32:35], v[248:255], v3
  s_waitcnt lgkmcnt(0)
  v_smfmac_f32_16x16x64_bf16 v[60:63], v[32:35], v[64:71], v3
  v_permlane32_swap_b32 v36, v38
  v_permlane32_swap_b32 v37, v39
  v_add_f32 v36, v36, v38
  v_add_f32 v37, v37, v39
  v_cvt_pk_bf16_f32 v38, v36, v37
  ds_write_b32 v152, v38
  v_permlane32_swap_b32 v40, v42
  v_permlane32_swap_b32 v41, v43
  v_add_f32 v40, v40, v42
  v_add_f32 v41, v41, v43
  v_cvt_pk_bf16_f32 v42, v40, v41
  ds_write_b32 v153, v42
  v_permlane32_swap_b32 v44, v46
  v_permlane32_swap_b32 v45, v47
  v_add_f32 v44, v44, v46
  v_add_f32 v45, v45, v47
  v_cvt_pk_bf16_f32 v46, v44, v45
  ds_write_b32 v154, v46
  v_permlane32_swap_b32 v48, v50
  v_permlane32_swap_b32 v49, v51
  v_add_f32 v48, v48, v50
  v_add_f32 v49, v49, v51
  v_cvt_pk_bf16_f32 v50, v48, v49
  ds_write_b32 v155, v50
  v_permlane32_swap_b32 v52, v54
  v_permlane32_swap_b32 v53, v55
  v_add_f32 v52, v52, v54
  v_add_f32 v53, v53, v55
  v_cvt_pk_bf16_f32 v54, v52, v53
  ds_write_b32 v156, v54
  v_permlane32_swap_b32 v56, v58
  v_permlane32_swap_b32 v57, v59
  v_add_f32 v56, v56, v58
  v_add_f32 v57, v57, v59
  v_cvt_pk_bf16_f32 v58, v56, v57
  ds_write_b32 v157, v58
  v_permlane32_swap_b32 v60, v62
  v_permlane32_swap_b32 v61, v63
  v_add_f32 v60, v60, v62
  v_add_f32 v61, v61, v63
  v_cvt_pk_bf16_f32 v62, v60, v61
  ds_write_b32 v158, v62
  s_branch cA_va1_t2d
cA_va1_rp:
  s_cmp_lg_u32 s37, 0
  s_cbranch_scc1 cA_va1_cont
cA_va1_rv:
  s_add_u32 s31, s31, 0x10000
  buffer_load_dwordx4 v[8:11], v2, s[8:11], s22 offen offset:0 sc1
  buffer_load_dwordx4 v[12:15], v2, s[8:11], s22 offen offset:1024 sc1
  buffer_load_dwordx4 v[16:19], v2, s[8:11], s22 offen offset:2048 sc1
  buffer_load_dwordx4 v[20:23], v2, s[8:11], s22 offen offset:3072 sc1
  buffer_load_dwordx4 v[24:27], v2, s[8:11], s34 offen offset:0 sc1
  buffer_load_dwordx4 v[28:31], v2, s[8:11], s34 offen offset:1024 sc1
  buffer_load_dwordx4 v[32:35], v2, s[8:11], s34 offen offset:2048 sc1
  buffer_load_dwordx4 v[36:39], v2, s[8:11], s34 offen offset:3072 sc1
  buffer_load_dwordx4 v[40:43], v2, s[8:11], s36 offen offset:0 sc1
  buffer_load_dwordx4 v[44:47], v2, s[8:11], s36 offen offset:1024 sc1
  s_waitcnt vmcnt(0)
  v_max3_u32 v52, v8, v9, v10
  v_max3_u32 v52, v52, v11, v12
  v_max3_u32 v52, v52, v13, v14
  v_max3_u32 v52, v52, v15, v16
  v_max3_u32 v52, v52, v17, v18
  v_max3_u32 v52, v52, v19, v20
  v_max3_u32 v52, v52, v21, v22
  v_max3_u32 v52, v52, v23, v24
  v_max3_u32 v52, v52, v25, v26
  v_max3_u32 v52, v52, v27, v28
  v_max3_u32 v52, v52, v29, v30
  v_max3_u32 v52, v52, v31, v32
  v_max3_u32 v52, v52, v33, v34
  v_max3_u32 v52, v52, v35, v36
  v_max3_u32 v52, v52, v37, v38
  v_max3_u32 v52, v52, v39, v40
  v_max3_u32 v52, v52, v41, v42
  v_max3_u32 v52, v52, v43, v44
  v_max3_u32 v52, v52, v45, v46
  v_max_u32 v52, v52, v47
  v_cmp_eq_u32 vcc, -1, v52
  s_mov_b32 s37, 1
  v_mov_b32 v48, 0
  v_mov_b32 v49, 0
  v_mov_b32 v50, 0
  v_mov_b32 v51, 0
  s_nop 1
  s_cbranch_vccz cA_va1_lp
  s_add_u32 s30, s30, 1
  s_cmp_lt_u32 s30, 400000
  s_cbranch_scc1 cA_va1_rv
  s_branch cA_abort
.p2align 6
cA_va2_loop:
  s_mov_b32 s30, 0
  buffer_load_dword v88, v119, s[8:11], 0 offen sc1
  buffer_load_dword v89, v119, s[8:11], 0 offen sc1
  buffer_load_dword v90, v119, s[8:11], 0 offen sc1
  buffer_load_dword v91, v119, s[8:11], 0 offen sc1
  buffer_load_dword v92, v119, s[8:11], 0 offen sc1
cA_va2_fp_l:
  s_waitcnt vmcnt(4)
  v_cmp_gt_u32 vcc, s19, v88
  buffer_load_dword v88, v119, s[8:11], 0 offen sc1
  s_cbranch_vccz cA_va2_fp_d
  s_waitcnt vmcnt(4)
  v_cmp_gt_u32 vcc, s19, v89
  buffer_load_dword v89, v119, s[8:11], 0 offen sc1
  s_cbranch_vccz cA_va2_fp_d
  s_waitcnt vmcnt(4)
  v_cmp_gt_u32 vcc, s19, v90
  buffer_load_dword v90, v119, s[8:11], 0 offen sc1
  s_cbranch_vccz cA_va2_fp_d
  s_waitcnt vmcnt(4)
  v_cmp_gt_u32 vcc, s19, v91
  buffer_load_dword v91, v119, s[8:11], 0 offen sc1
  s_cbranch_vccz cA_va2_fp_d
  s_waitcnt vmcnt(4)
  v_cmp_gt_u32 vcc, s19, v92
  buffer_load_dword v92, v119, s[8:11], 0 offen sc1
  s_cbranch_vccz cA_va2_fp_d
  s_waitcnt vmcnt(4)
  v_cmp_gt_u32 vcc, s19, v88
  buffer_load_dword v88, v119, s[8:11], 0 offen sc1
  s_cbranch_vccz cA_va2_fp_d
  s_waitcnt vmcnt(4)
  v_cmp_gt_u32 vcc, s19, v89
  buffer_load_dword v89, v119, s[8:11], 0 offen sc1
  s_cbranch_vccz cA_va2_fp_d
  s_waitcnt vmcnt(4)
  v_cmp_gt_u32 vcc, s19, v90
  buffer_load_dword v90, v119, s[8:11], 0 offen sc1
  s_cbranch_vccz cA_va2_fp_d
  s_waitcnt vmcnt(4)
  v_cmp_gt_u32 vcc, s19, v91
  buffer_load_dword v91, v119, s[8:11], 0 offen sc1
  s_cbranch_vccz cA_va2_fp_d
  s_waitcnt vmcnt(4)
  v_cmp_gt_u32 vcc, s19, v92
  buffer_load_dword v92, v119, s[8:11], 0 offen sc1
  s_cbranch_vccz cA_va2_fp_d
  s_waitcnt vmcnt(4)
  v_cmp_gt_u32 vcc, s19, v88
  buffer_load_dword v88, v119, s[8:11], 0 offen sc1
  s_cbranch_vccz cA_va2_fp_d
  s_waitcnt vmcnt(4)
  v_cmp_gt_u32 vcc, s19, v89
  buffer_load_dword v89, v119, s[8:11], 0 offen sc1
  s_cbranch_vccz cA_va2_fp_d
  s_waitcnt vmcnt(4)
  v_cmp_gt_u32 vcc, s19, v90
  buffer_load_dword v90, v119, s[8:11], 0 offen sc1
  s_cbranch_vccz cA_va2_fp_d
  s_waitcnt vmcnt(4)
  v_cmp_gt_u32 vcc, s19, v91
  buffer_load_dword v91, v119, s[8:11], 0 offen sc1
  s_cbranch_vccz cA_va2_fp_d
  s_waitcnt vmcnt(4)
  v_cmp_gt_u32 vcc, s19, v92
  buffer_load_dword v92, v119, s[8:11], 0 offen sc1
  s_cbranch_vccz cA_va2_fp_d
  s_add_u32 s30, s30, 1
  s_cmp_lt_u32 s30, 400000
  s_cbranch_scc1 cA_va2_fp_l
  s_branch cA_abort
cA_va2_fp_d:
  buffer_load_dwordx4 v[8:11], v2, s[8:11], s20 offen offset:0 sc1
  buffer_load_dwordx4 v[12:15], v2, s[8:11], s20 offen offset:1024 sc1
  s_barrier
  s_barrier
  s_waitcnt vmcnt(0)
  ds_write_b128 v2, v[8:11] offset:8192
  ds_write_b128 v2, v[12:15] offset:9216
  v_smfmac_f32_16x16x64_bf16 v[36:39], v[8:11], a[0:7], v3
  v_smfmac_f32_16x16x64_bf16 v[40:43], v[8:11], a[56:63], v3
  v_smfmac_f32_16x16x64_bf16 v[44:47], v[8:11], a[112:119], v3
  v_smfmac_f32_16x16x64_bf16 v[48:51], v[8:11], a[168:175], v3
  v_smfmac_f32_16x16x64_bf16 v[52:55], v[8:11], a[224:231], v3
  s_waitcnt lgkmcnt(0)
  s_barrier
  ds_read_b128 v[16:19], v2 offset:10240
  ds_read_b128 v[20:23], v2 offset:11264
  ds_read_b128 v[24:27], v2 offset:12288
  ds_read_b128 v[28:31], v2 offset:13312
  ds_read_b128 v[32:35], v2 offset:14336
  v_smfmac_f32_16x16x64_bf16 v[56:59], v[8:11], v[144:151], v3
  v_smfmac_f32_16x16x64_bf16 v[60:63], v[8:11], v[200:207], v3
  v_smfmac_f32_16x16x64_bf16 v[36:39], v[12:15], a[8:15], v3
  v_smfmac_f32_16x16x64_bf16 v[40:43], v[12:15], a[64:71], v3
  v_smfmac_f32_16x16x64_bf16 v[44:47], v[12:15], a[120:127], v3
  v_smfmac_f32_16x16x64_bf16 v[48:51], v[12:15], a[176:183], v3
  v_smfmac_f32_16x16x64_bf16 v[52:55], v[12:15], a[232:239], v3
  v_smfmac_f32_16x16x64_bf16 v[56:59], v[12:15], v[152:159], v3
  v_smfmac_f32_16x16x64_bf16 v[60:63], v[12:15], v[208:215], v3
  s_waitcnt lgkmcnt(4)
  v_smfmac_f32_16x16x64_bf16 v[36:39], v[16:19], a[16:23], v3
  s_waitcnt lgkmcnt(3)
  v_smfmac_f32_16x16x64_bf16 v[36:39], v[20:23], a[24:31], v3
  s_waitcnt lgkmcnt(2)
  v_smfmac_f32_16x16x64_bf16 v[36:39], v[24:27], a[32:39], v3
  s_waitcnt lgkmcnt(1)
  v_smfmac_f32_16x16x64_bf16 v[36:39], v[28:31], a[40:47], v3
  s_waitcnt lgkmcnt(0)
  v_smfmac_f32_16x16x64_bf16 v[36:39], v[32:35], a[48:55], v3
  v_smfmac_f32_16x16x64_bf16 v[40:43], v[16:19], a[72:79], v3
  v_smfmac_f32_16x16x64_bf16 v[40:43], v[20:23], a[80:87], v3
  v_smfmac_f32_16x16x64_bf16 v[40:43], v[24:27], a[88:95], v3
  v_permlane32_swap_b32 v36, v38
  v_smfmac_f32_16x16x64_bf16 v[40:43], v[28:31], a[96:103], v3
  v_permlane32_swap_b32 v37, v39
  v_smfmac_f32_16x16x64_bf16 v[40:43], v[32:35], a[104:111], v3
  v_add_f32 v36, v36, v38
  v_smfmac_f32_16x16x64_bf16 v[44:47], v[16:19], a[128:135], v3
  v_add_f32 v37, v37, v39
  v_smfmac_f32_16x16x64_bf16 v[44:47], v[20:23], a[136:143], v3
  v_cmp_u_f32 vcc, v36, v37
  v_smfmac_f32_16x16x64_bf16 v[44:47], v[24:27], a[144:151], v3
  v_cvt_pk_bf16_f32 v38, v36, v37
  v_smfmac_f32_16x16x64_bf16 v[44:47], v[28:31], a[152:159], v3
  ds_write_b32 v104, v38
  s_cbranch_vccnz cA_va2_slow
  v_permlane32_swap_b32 v40, v42
  v_smfmac_f32_16x16x64_bf16 v[44:47], v[32:35], a[160:167], v3
  v_permlane32_swap_b32 v41, v43
  v_smfmac_f32_16x16x64_bf16 v[48:51], v[16:19], a[184:191], v3
  v_add_f32 v40, v40, v42
  v_smfmac_f32_16x16x64_bf16 v[48:51], v[20:23], a[192:199], v3
  v_add_f32 v41, v41, v43
  v_smfmac_f32_16x16x64_bf16 v[48:51], v[24:27], a[200:207], v3
  v_cvt_pk_bf16_f32 v42, v40, v41
  v_smfmac_f32_16x16x64_bf16 v[48:51], v[28:31], a[208:215], v3
  ds_write_b32 v105, v42
  v_permlane32_swap_b32 v44, v46
  v_smfmac_f32_16x16x64_bf16 v[48:51], v[32:35], a[216:223], v3
  v_permlane32_swap_b32 v45, v47
  v_smfmac_f32_16x16x64_bf16 v[52:55], v[16:19], a[240:247], v3
  v_add_f32 v44, v44, v46
  v_smfmac_f32_16x16x64_bf16 v[52:55], v[20:23], a[248:255], v3
  v_add_f32 v45, v45, v47
  v_smfmac_f32_16x16x64_bf16 v[52:55], v[24:27], v[120:127], v3
  v_cvt_pk_bf16_f32 v46, v44, v45
  v_smfmac_f32_16x16x64_bf16 v[52:55], v[28:31], v[128:135], v3
  ds_write_b32 v106, v46
  v_permlane32_swap_b32 v48, v50
  v_smfmac_f32_16x16x64_bf16 v[52:55], v[32:35], v[136:143], v3
  v_permlane32_swap_b32 v49, v51
  v_smfmac_f32_16x16x64_bf16 v[56:59], v[16:19], v[160:167], v3
  v_add_f32 v48, v48, v50
  v_smfmac_f32_16x16x64_bf16 v[56:59], v[20:23], v[168:175], v3
  v_add_f32 v49, v49, v51
  v_smfmac_f32_16x16x64_bf16 v[56:59], v[24:27], v[176:183], v3
  v_cvt_pk_bf16_f32 v50, v48, v49
  v_smfmac_f32_16x16x64_bf16 v[56:59], v[28:31], v[184:191], v3
  ds_write_b32 v107, v50
  v_permlane32_swap_b32 v52, v54
  v_smfmac_f32_16x16x64_bf16 v[56:59], v[32:35], v[192:199], v3
  v_permlane32_swap_b32 v53, v55
  v_smfmac_f32_16x16x64_bf16 v[60:63], v[16:19], v[216:223], v3
  v_add_f32 v52, v52, v54
  v_smfmac_f32_16x16x64_bf16 v[60:63], v[20:23], v[224:231], v3
  v_add_f32 v53, v53, v55
  v_smfmac_f32_16x16x64_bf16 v[60:63], v[24:27], v[232:239], v3
  v_cvt_pk_bf16_f32 v54, v52, v53
  v_smfmac_f32_16x16x64_bf16 v[60:63], v[28:31], v[240:247], v3
  ds_write_b32 v108, v54
  v_permlane32_swap_b32 v56, v58
  v_smfmac_f32_16x16x64_bf16 v[60:63], v[32:35], v[248:255], v3
  v_permlane32_swap_b32 v57, v59
  v_add_f32 v56, v56, v58
  v_add_f32 v57, v57, v59
  v_cvt_pk_bf16_f32 v58, v56, v57
  ds_write_b32 v109, v58
  s_nop 2
  v_permlane32_swap_b32 v60, v62
  v_permlane32_swap_b32 v61, v63
  v_add_f32 v60, v60, v62
  v_add_f32 v61, v61, v63
  v_cvt_pk_bf16_f32 v62, v60, v61
  ds_write_b32 v110, v62
cA_va2_t2d:
  v_mov_b32 v117, s18
  s_waitcnt lgkmcnt(0)
  s_barrier
  s_cmp_eq_u32 s19, 62
  s_cbranch_scc1 cA_done
  s_sleep 1
  v_mov_b32 v36, 0
  v_mov_b32 v37, 0
  v_mov_b32 v38, 0
  v_mov_b32 v39, 0
  v_mov_b32 v40, 0
  v_mov_b32 v41, 0
  v_mov_b32 v42, 0
  v_mov_b32 v43, 0
  v_mov_b32 v44, 0
  v_mov_b32 v45, 0
  v_mov_b32 v46, 0
  v_mov_b32 v47, 0
  v_mov_b32 v48, 0
  v_mov_b32 v49, 0
  v_mov_b32 v50, 0
  v_mov_b32 v51, 0
  v_mov_b32 v52, 0
  v_mov_b32 v53, 0
  v_mov_b32 v54, 0
  v_mov_b32 v55, 0
  v_mov_b32 v56, 0
  v_mov_b32 v57, 0
  v_mov_b32 v58, 0
  v_mov_b32 v59, 0
  v_mov_b32 v60, 0
  v_mov_b32 v61, 0
  v_mov_b32 v62, 0
  v_mov_b32 v63, 0
  s_sleep 5
  s_mov_b32 s19, s18
  s_add_u32 s18, s18, 1
  s_mov_b32 s22, s20
  s_mov_b32 s20, s21
  s_mov_b32 s21, s22
  s_add_u32 s23, s20, 4096
  s_branch cA_va2_loop
cA_va2_slow:
  s_waitcnt lgkmcnt(0)
cA_va2_sl1:
  s_add_u32 s31, s31, 0x1000000
  buffer_load_dwordx4 v[8:11], v2, s[8:11], s20 offen offset:0 sc1
  buffer_load_dwordx4 v[12:15], v2, s[8:11], s20 offen offset:1024 sc1
  buffer_load_dwordx4 v[16:19], v2, s[8:11], s20 offen offset:2048 sc1
  buffer_load_dwordx4 v[20:23], v2, s[8:11], s20 offen offset:3072 sc1
  buffer_load_dwordx4 v[24:27], v2, s[8:11], s23 offen offset:0 sc1
  buffer_load_dwordx4 v[28:31], v2, s[8:11], s23 offen offset:1024 sc1
  buffer_load_dwordx4 v[32:35], v2, s[8:11], s23 offen offset:2048 sc1
  s_waitcnt vmcnt(0)
  v_max3_u32 v36, v8, v9, v10
  v_max3_u32 v36, v36, v11, v12
  v_max3_u32 v36, v36, v13, v14
  v_max3_u32 v36, v36, v15, v16
  v_max3_u32 v36, v36, v17, v18
  v_max3_u32 v36, v36, v19, v20
  v_max3_u32 v36, v36, v21, v22
  v_max3_u32 v36, v36, v23, v24
  v_max3_u32 v36, v36, v25, v26
  v_max3_u32 v36, v36, v27, v28
  v_max3_u32 v36, v36, v29, v30
  v_max3_u32 v36, v36, v31, v32
  v_max3_u32 v36, v36, v33, v34
  v_max_u32 v36, v36, v35
  v_cmp_eq_u32 vcc, -1, v36
  s_cbranch_vccz cA_va2_sl2
  s_add_u32 s30, s30, 1
  s_cmp_lt_u32 s30, 400000
  s_cbranch_scc1 cA_va2_sl1
  s_branch cA_abort
cA_va2_sl2:
  v_mov_b32 v36, 0
  v_mov_b32 v37, 0
  v_mov_b32 v38, 0
  v_mov_b32 v39, 0
  v_mov_b32 v40, 0
  v_mov_b32 v41, 0
  v_mov_b32 v42, 0
  v_mov_b32 v43, 0
  v_mov_b32 v44, 0
  v_mov_b32 v45, 0
  v_mov_b32 v46, 0
  v_mov_b32 v47, 0
  v_mov_b32 v48, 0
  v_mov_b32 v49, 0
  v_mov_b32 v50, 0
  v_mov_b32 v51, 0
  v_mov_b32 v52, 0
  v_mov_b32 v53, 0
  v_mov_b32 v54, 0
  v_mov_b32 v55, 0
  v_mov_b32 v56, 0
  v_mov_b32 v57, 0
  v_mov_b32 v58, 0
  v_mov_b32 v59, 0
  v_mov_b32 v60, 0
  v_mov_b32 v61, 0
  v_mov_b32 v62, 0
  v_mov_b32 v63, 0
  v_smfmac_f32_16x16x64_bf16 v[36:39], v[8:11], a[0:7], v3
  v_smfmac_f32_16x16x64_bf16 v[40:43], v[8:11], a[56:63], v3
  v_smfmac_f32_16x16x64_bf16 v[44:47], v[8:11], a[112:119], v3
  v_smfmac_f32_16x16x64_bf16 v[48:51], v[8:11], a[168:175], v3
  v_smfmac_f32_16x16x64_bf16 v[52:55], v[8:11], a[224:231], v3
  v_smfmac_f32_16x16x64_bf16 v[56:59], v[8:11], v[144:151], v3
  v_smfmac_f32_16x16x64_bf16 v[60:63], v[8:11], v[200:207], v3
  v_smfmac_f32_16x16x64_bf16 v[36:39], v[12:15], a[8:15], v3
  v_smfmac_f32_16x16x64_bf16 v[40:43], v[12:15], a[64:71], v3
  v_smfmac_f32_16x16x64_bf16 v[44:47], v[12:15], a[120:127], v3
  v_smfmac_f32_16x16x64_bf16 v[48:51], v[12:15], a[176:183], v3
  v_smfmac_f32_16x16x64_bf16 v[52:55], v[12:15], a[232:239], v3
  v_smfmac_f32_16x16x64_bf16 v[56:59], v[12:15], v[152:159], v3
  v_smfmac_f32_16x16x64_bf16 v[60:63], v[12:15], v[208:215], v3
  v_smfmac_f32_16x16x64_bf16 v[36:39], v[16:19], a[16:23], v3
  v_smfmac_f32_16x16x64_bf16 v[40:43], v[16:19], a[72:79], v3
  v_smfmac_f32_16x16x64_bf16 v[44:47], v[16:19], a[128:135], v3
  v_smfmac_f32_16x16x64_bf16 v[48:51], v[16:19], a[184:191], v3
  v_smfmac_f32_16x16x64_bf16 v[52:55], v[16:19], a[240:247], v3
  v_smfmac_f32_16x16x64_bf16 v[56:59], v[16:19], v[160:167], v3
  v_smfmac_f32_16x16x64_bf16 v[60:63], v[16:19], v[216:223], v3
  v_smfmac_f32_16x16x64_bf16 v[36:39], v[20:23], a[24:31], v3
  v_smfmac_f32_16x16x64_bf16 v[40:43], v[20:23], a[80:87], v3
  v_smfmac_f32_16x16x64_bf16 v[44:47], v[20:23], a[136:143], v3
  v_smfmac_f32_16x16x64_bf16 v[48:51], v[20:23], a[192:199], v3
  v_smfmac_f32_16x16x64_bf16 v[52:55], v[20:23], a[248:255], v3
  v_smfmac_f32_16x16x64_bf16 v[56:59], v[20:23], v[168:175], v3
  v_smfmac_f32_16x16x64_bf16 v[60:63], v[20:23], v[224:231], v3
  v_smfmac_f32_16x16x64_bf16 v[36:39], v[24:27], a[32:39], v3
  v_smfmac_f32_16x16x64_bf16 v[40:43], v[24:27], a[88:95], v3
  v_smfmac_f32_16x16x64_bf16 v[44:47], v[24:27], a[144:151], v3
  v_smfmac_f32_16x16x64_bf16 v[48:51], v[24:27], a[200:207], v3
  v_smfmac_f32_16x16x64_bf16 v[52:55], v[24:27], v[120:127], v3
  v_smfmac_f32_16x16x64_bf16 v[56:59], v[24:27], v[176:183], v3
  v_smfmac_f32_16x16x64_bf16 v[60:63], v[24:27], v[232:239], v3
  v_smfmac_f32_16x16x64_bf16 v[36:39], v[28:31], a[40:47], v3
  v_smfmac_f32_16x16x64_bf16 v[40:43], v[28:31], a[96:103], v3
  v_smfmac_f32_16x16x64_bf16 v[44:47], v[28:31], a[152:159], v3
  v_smfmac_f32_16x16x64_bf16 v[48:51], v[28:31], a[208:215], v3
  v_smfmac_f32_16x16x64_bf16 v[52:55], v[28:31], v[128:135], v3
  v_smfmac_f32_16x16x64_bf16 v[56:59], v[28:31], v[184:191], v3
  v_smfmac_f32_16x16x64_bf16 v[60:63], v[28:31], v[240:247], v3
  v_smfmac_f32_16x16x64_bf16 v[36:39], v[32:35], a[48:55], v3
  v_smfmac_f32_16x16x64_bf16 v[40:43], v[32:35], a[104:111], v3
  v_smfmac_f32_16x16x64_bf16 v[44:47], v[32:35], a[160:167], v3
  v_smfmac_f32_16x16x64_bf16 v[48:51], v[32:35], a[216:223], v3
  v_smfmac_f32_16x16x64_bf16 v[52:55], v[32:35], v[136:143], v3
  v_smfmac_f32_16x16x64_bf16 v[56:59], v[32:35], v[192:199], v3
  v_smfmac_f32_16x16x64_bf16 v[60:63], v[32:35], v[248:255], v3
  v_permlane32_swap_b32 v36, v38
  v_permlane32_swap_b32 v37, v39
  v_add_f32 v36, v36, v38
  v_add_f32 v37, v37, v39
  v_cvt_pk_bf16_f32 v38, v36, v37
  ds_write_b32 v104, v38
  v_permlane32_swap_b32 v40, v42
  v_permlane32_swap_b32 v41, v43
  v_add_f32 v40, v40, v42
  v_add_f32 v41, v41, v43
  v_cvt_pk_bf16_f32 v42, v40, v41
  ds_write_b32 v105, v42
  v_permlane32_swap_b32 v44, v46
  v_permlane32_swap_b32 v45, v47
  v_add_f32 v44, v44, v46
  v_add_f32 v45, v45, v47
  v_cvt_pk_bf16_f32 v46, v44, v45
  ds_write_b32 v106, v46
  v_permlane32_swap_b32 v48, v50
  v_permlane32_swap_b32 v49, v51
  v_add_f32 v48, v48, v50
  v_add_f32 v49, v49, v51
  v_cvt_pk_bf16_f32 v50, v48, v49
  ds_write_b32 v107, v50
  v_permlane32_swap_b32 v52, v54
  v_permlane32_swap_b32 v53, v55
  v_add_f32 v52, v52, v54
  v_add_f32 v53, v53, v55
  v_cvt_pk_bf16_f32 v54, v52, v53
  ds_write_b32 v108, v54
  v_permlane32_swap_b32 v56, v58
  v_permlane32_swap_b32 v57, v59
  v_add_f32 v56, v56, v58
  v_add_f32 v57, v57, v59
  v_cvt_pk_bf16_f32 v58, v56, v57
  ds_write_b32 v109, v58
  v_permlane32_swap_b32 v60, v62
  v_permlane32_swap_b32 v61, v63
  v_add_f32 v60, v60, v62
  v_add_f32 v61, v61, v63
  v_cvt_pk_bf16_f32 v62, v60, v61
  ds_write_b32 v110, v62
  s_branch cA_va2_t2d
.p2align 6
cA_va3_loop:
  s_mov_b32 s30, 0
  s_barrier
  buffer_load_dwordx4 v[16:19], v2, s[8:11], s20 offen offset:2048 sc1
  buffer_load_dwordx4 v[20:23], v2, s[8:11], s20 offen offset:3072 sc1
  s_barrier
  buffer_load_dword v100, v116, s[8:11], s39 offen sc1
  s_add_u32 s27, s19, 2
  s_min_u32 s27, s27, 63
  s_lshr_b32 s27, s27, 3
  s_lshl_b32 s27, s27, 11
  s_add_u32 s27, s27, s35
  s_cmp_eq_u32 s27, s28
  s_cselect_b32 s29, 75729408, s27
  buffer_load_dword v101, off, s[8:11], s29 sc1
  s_add_u32 s39, s39, 28672
  s_waitcnt vmcnt(2)
  ds_write_b128 v2, v[16:19] offset:10240
  ds_write_b128 v2, v[20:23] offset:11264
  v_smfmac_f32_16x16x64_bf16 v[36:39], v[16:19], a[16:23], v3
  v_smfmac_f32_16x16x64_bf16 v[40:43], v[16:19], a[72:79], v3
  v_smfmac_f32_16x16x64_bf16 v[44:47], v[16:19], a[128:135], v3
  v_smfmac_f32_16x16x64_bf16 v[48:51], v[16:19], a[184:191], v3
  v_smfmac_f32_16x16x64_bf16 v[52:55], v[16:19], a[240:247], v3
  s_waitcnt lgkmcnt(0)
  s_barrier
  ds_read_b128 v[8:11], v2 offset:8192
  ds_read_b128 v[12:15], v2 offset:9216
  ds_read_b128 v[24:27], v2 offset:12288
  ds_read_b128 v[28:31], v2 offset:13312
  ds_read_b128 v[32:35], v2 offset:14336
  v_smfmac_f32_16x16x64_bf16 v[56:59], v[16:19], v[160:167], v3
  v_smfmac_f32_16x16x64_bf16 v[60:63], v[16:19], v[216:223], v3
  v_smfmac_f32_16x16x64_bf16 v[36:39], v[20:23], a[24:31], v3
  v_smfmac_f32_16x16x64_bf16 v[40:43], v[20:23], a[80:87], v3
  v_smfmac_f32_16x16x64_bf16 v[44:47], v[20:23], a[136:143], v3
  v_smfmac_f32_16x16x64_bf16 v[48:51], v[20:23], a[192:199], v3
  v_smfmac_f32_16x16x64_bf16 v[52:55], v[20:23], a[248:255], v3
  v_smfmac_f32_16x16x64_bf16 v[56:59], v[20:23], v[168:175], v3
  v_smfmac_f32_16x16x64_bf16 v[60:63], v[20:23], v[224:231], v3
  s_waitcnt lgkmcnt(4)
  v_smfmac_f32_16x16x64_bf16 v[36:39], v[8:11], a[0:7], v3
  s_waitcnt lgkmcnt(3)
  v_smfmac_f32_16x16x64_bf16 v[36:39], v[12:15], a[8:15], v3
  s_waitcnt lgkmcnt(2)
  v_smfmac_f32_16x16x64_bf16 v[36:39], v[24:27], a[32:39], v3
  s_waitcnt lgkmcnt(1)
  v_smfmac_f32_16x16x64_bf16 v[36:39], v[28:31], a[40:47], v3
  s_waitcnt lgkmcnt(0)
  v_smfmac_f32_16x16x64_bf16 v[36:39], v[32:35], a[48:55], v3
  v_smfmac_f32_16x16x64_bf16 v[40:43], v[8:11], a[56:63], v3
  v_smfmac_f32_16x16x64_bf16 v[40:43], v[12:15], a[64:71], v3
  v_smfmac_f32_16x16x64_bf16 v[40:43], v[24:27], a[88:95], v3
  v_permlane32_swap_b32 v36, v38
  v_smfmac_f32_16x16x64_bf16 v[40:43], v[28:31], a[96:103], v3
  v_permlane32_swap_b32 v37, v39
  v_smfmac_f32_16x16x64_bf16 v[40:43], v[32:35], a[104:111], v3
  v_add_f32 v36, v36, v38
  v_smfmac_f32_16x16x64_bf16 v[44:47], v[8:11], a[112:119], v3
  v_add_f32 v37, v37, v39
  v_smfmac_f32_16x16x64_bf16 v[44:47], v[12:15], a[120:127], v3
  v_cmp_u_f32 vcc, v36, v37
  v_smfmac_f32_16x16x64_bf16 v[44:47], v[24:27], a[144:151], v3
  v_cvt_pk_bf16_f32 v38, v36, v37
  v_smfmac_f32_16x16x64_bf16 v[44:47], v[28:31], a[152:159], v3
  ds_write_b32 v104, v38
  s_cbranch_vccnz cA_va3_slow
  v_permlane32_swap_b32 v40, v42
  v_smfmac_f32_16x16x64_bf16 v[44:47], v[32:35], a[160:167], v3
  v_permlane32_swap_b32 v41, v43
  v_smfmac_f32_16x16x64_bf16 v[48:51], v[8:11], a[168:175], v3
  v_add_f32 v40, v40, v42
  v_smfmac_f32_16x16x64_bf16 v[48:51], v[12:15], a[176:183], v3
  v_add_f32 v41, v41, v43
  v_smfmac_f32_16x16x64_bf16 v[48:51], v[24:27], a[200:207], v3
  v_cvt_pk_bf16_f32 v42, v40, v41
  v_smfmac_f32_16x16x64_bf16 v[48:51], v[28:31], a[208:215], v3
  ds_write_b32 v105, v42
  v_permlane32_swap_b32 v44, v46
  v_smfmac_f32_16x16x64_bf16 v[48:51], v[32:35], a[216:223], v3
  v_permlane32_swap_b32 v45, v47
  v_smfmac_f32_16x16x64_bf16 v[52:55], v[8:11], a[224:231], v3
  v_add_f32 v44, v44, v46
  v_smfmac_f32_16x16x64_bf16 v[52:55], v[12:15], a[232:239], v3
  v_add_f32 v45, v45, v47
  v_smfmac_f32_16x16x64_bf16 v[52:55], v[24:27], v[120:127], v3
  v_cvt_pk_bf16_f32 v46, v44, v45
  v_smfmac_f32_16x16x64_bf16 v[52:55], v[28:31], v[128:135], v3
  ds_write_b32 v106, v46
  v_permlane32_swap_b32 v48, v50
  v_smfmac_f32_16x16x64_bf16 v[52:55], v[32:35], v[136:143], v3
  v_permlane32_swap_b32 v49, v51
  v_smfmac_f32_16x16x64_bf16 v[56:59], v[8:11], v[144:151], v3
  v_add_f32 v48, v48, v50
  v_smfmac_f32_16x16x64_bf16 v[56:59], v[12:15], v[152:159], v3
  v_add_f32 v49, v49, v51
  v_smfmac_f32_16x16x64_bf16 v[56:59], v[24:27], v[176:183], v3
  v_cvt_pk_bf16_f32 v50, v48, v49
  v_smfmac_f32_16x16x64_bf16 v[56:59], v[28:31], v[184:191], v3
  ds_write_b32 v107, v50
  v_permlane32_swap_b32 v52, v54
  v_smfmac_f32_16x16x64_bf16 v[56:59], v[32:35], v[192:199], v3
  v_permlane32_swap_b32 v53, v55
  v_smfmac_f32_16x16x64_bf16 v[60:63], v[8:11], v[200:207], v3
  v_add_f32 v52, v52, v54
  v_smfmac_f32_16x16x64_bf16 v[60:63], v[12:15], v[208:215], v3
  v_add_f32 v53, v53, v55
  v_smfmac_f32_16x16x64_bf16 v[60:63], v[24:27], v[232:239], v3
  v_cvt_pk_bf16_f32 v54, v52, v53
  v_smfmac_f32_16x16x64_bf16 v[60:63], v[28:31], v[240:247], v3
  ds_write_b32 v108, v54
  v_permlane32_swap_b32 v56, v58
  v_smfmac_f32_16x16x64_bf16 v[60:63], v[32:35], v[248:255], v3
  v_permlane32_swap_b32 v57, v59
  v_add_f32 v56, v56, v58
  v_add_f32 v57, v57, v59
  v_cvt_pk_bf16_f32 v58, v56, v57
  ds_write_b32 v109, v58
  s_nop 2
  v_permlane32_swap_b32 v60, v62
  v_permlane32_swap_b32 v61, v63
  v_add_f32 v60, v60, v62
  v_add_f32 v61, v61, v63
  v_cvt_pk_bf16_f32 v62, v60, v61
  ds_write_b32 v110, v62
cA_va3_t2d:
  v_mov_b32 v117, s18
  s_cmp_eq_u32 s27, s28
  s_cbranch_scc1 cA_va3_vok
cA_va3_vow:
  s_waitcnt vmcnt(0)
  v_cmp_ne_u32 vcc, 56, v101
  s_cbranch_vccnz cA_va3_vor
  s_mov_b32 s28, s27
cA_va3_vok:
  s_waitcnt lgkmcnt(0)
  s_setprio 3
  s_barrier
  v_mov_b32 v36, 0
  v_mov_b32 v37, 0
  v_mov_b32 v38, 0
  v_mov_b32 v39, 0
  buffer_store_dword v117, v118, s[8:11], 0 offen
  s_setprio 0
  s_cmp_eq_u32 s19, 62
  s_cbranch_scc1 cA_done
  v_mov_b32 v40, 0
  v_mov_b32 v41, 0
  v_mov_b32 v42, 0
  v_mov_b32 v43, 0
  v_mov_b32 v44, 0
  v_mov_b32 v45, 0
  v_mov_b32 v46, 0
  v_mov_b32 v47, 0
  v_mov_b32 v48, 0
  v_mov_b32 v49, 0
  v_mov_b32 v50, 0
  v_mov_b32 v51, 0
  v_mov_b32 v52, 0
  v_mov_b32 v53, 0
  v_mov_b32 v54, 0
  v_mov_b32 v55, 0
  v_mov_b32 v56, 0
  v_mov_b32 v57, 0
  v_mov_b32 v58, 0
  v_mov_b32 v59, 0
  v_mov_b32 v60, 0
  v_mov_b32 v61, 0
  v_mov_b32 v62, 0
  v_mov_b32 v63, 0
  s_mov_b32 s19, s18
  s_add_u32 s18, s18, 1
  s_mov_b32 s22, s20
  s_mov_b32 s20, s21
  s_mov_b32 s21, s22
  s_add_u32 s23, s20, 4096
  s_branch cA_va3_loop
cA_va3_slow:
  s_waitcnt lgkmcnt(0)
cA_va3_sl1:
  s_add_u32 s31, s31, 0x1000000
  buffer_load_dwordx4 v[8:11], v2, s[8:11], s20 offen offset:0 sc1
  buffer_load_dwordx4 v[12:15], v2, s[8:11], s20 offen offset:1024 sc1
  buffer_load_dwordx4 v[16:19], v2, s[8:11], s20 offen offset:2048 sc1
  buffer_load_dwordx4 v[20:23], v2, s[8:11], s20 offen offset:3072 sc1
  buffer_load_dwordx4 v[24:27], v2, s[8:11], s23 offen offset:0 sc1
  buffer_load_dwordx4 v[28:31], v2, s[8:11], s23 offen offset:1024 sc1
  buffer_load_dwordx4 v[32:35], v2, s[8:11], s23 offen offset:2048 sc1
  s_waitcnt vmcnt(0)
  v_max3_u32 v36, v8, v9, v10
  v_max3_u32 v36, v36, v11, v12
  v_max3_u32 v36, v36, v13, v14
  v_max3_u32 v36, v36, v15, v16
  v_max3_u32 v36, v36, v17, v18
  v_max3_u32 v36, v36, v19, v20
  v_max3_u32 v36, v36, v21, v22
  v_max3_u32 v36, v36, v23, v24
  v_max3_u32 v36, v36, v25, v26
  v_max3_u32 v36, v36, v27, v28
  v_max3_u32 v36, v36, v29, v30
  v_max3_u32 v36, v36, v31, v32
  v_max3_u32 v36, v36, v33, v34
  v_max_u32 v36, v36, v35
  v_cmp_eq_u32 vcc, -1, v36
  s_cbranch_vccz cA_va3_sl2
  s_add_u32 s30, s30, 1
  s_cmp_lt_u32 s30, 400000
  s_cbranch_scc1 cA_va3_sl1
  s_branch cA_abort
cA_va3_sl2:
  v_mov_b32 v36, 0
  v_mov_b32 v37, 0
  v_mov_b32 v38, 0
  v_mov_b32 v39, 0
  v_mov_b32 v40, 0
  v_mov_b32 v41, 0
  v_mov_b32 v42, 0
  v_mov_b32 v43, 0
  v_mov_b32 v44, 0
  v_mov_b32 v45, 0
  v_mov_b32 v46, 0
  v_mov_b32 v47, 0
  v_mov_b32 v48, 0
  v_mov_b32 v49, 0
  v_mov_b32 v50, 0
  v_mov_b32 v51, 0
  v_mov_b32 v52, 0
  v_mov_b32 v53, 0
  v_mov_b32 v54, 0
  v_mov_b32 v55, 0
  v_mov_b32 v56, 0
  v_mov_b32 v57, 0
  v_mov_b32 v58, 0
  v_mov_b32 v59, 0
  v_mov_b32 v60, 0
  v_mov_b32 v61, 0
  v_mov_b32 v62, 0
  v_mov_b32 v63, 0
  v_smfmac_f32_16x16x64_bf16 v[36:39], v[8:11], a[0:7], v3
  v_smfmac_f32_16x16x64_bf16 v[40:43], v[8:11], a[56:63], v3
  v_smfmac_f32_16x16x64_bf16 v[44:47], v[8:11], a[112:119], v3
  v_smfmac_f32_16x16x64_bf16 v[48:51], v[8:11], a[168:175], v3
  v_smfmac_f32_16x16x64_bf16 v[52:55], v[8:11], a[224:231], v3
  v_smfmac_f32_16x16x64_bf16 v[56:59], v[8:11], v[144:151], v3
  v_smfmac_f32_16x16x64_bf16 v[60:63], v[8:11], v[200:207], v3
  v_smfmac_f32_16x16x64_bf16 v[36:39], v[12:15], a[8:15], v3
  v_smfmac_f32_16x16x64_bf16 v[40:43], v[12:15], a[64:71], v3
  v_smfmac_f32_16x16x64_bf16 v[44:47], v[12:15], a[120:127], v3
  v_smfmac_f32_16x16x64_bf16 v[48:51], v[12:15], a[176:183], v3
  v_smfmac_f32_16x16x64_bf16 v[52:55], v[12:15], a[232:239], v3
  v_smfmac_f32_16x16x64_bf16 v[56:59], v[12:15], v[152:159], v3
  v_smfmac_f32_16x16x64_bf16 v[60:63], v[12:15], v[208:215], v3
  v_smfmac_f32_16x16x64_bf16 v[36:39], v[16:19], a[16:23], v3
  v_smfmac_f32_16x16x64_bf16 v[40:43], v[16:19], a[72:79], v3
  v_smfmac_f32_16x16x64_bf16 v[44:47], v[16:19], a[128:135], v3
  v_smfmac_f32_16x16x64_bf16 v[48:51], v[16:19], a[184:191], v3
  v_smfmac_f32_16x16x64_bf16 v[52:55], v[16:19], a[240:247], v3
  v_smfmac_f32_16x16x64_bf16 v[56:59], v[16:19], v[160:167], v3
  v_smfmac_f32_16x16x64_bf16 v[60:63], v[16:19], v[216:223], v3
  v_smfmac_f32_16x16x64_bf16 v[36:39], v[20:23], a[24:31], v3
  v_smfmac_f32_16x16x64_bf16 v[40:43], v[20:23], a[80:87], v3
  v_smfmac_f32_16x16x64_bf16 v[44:47], v[20:23], a[136:143], v3
  v_smfmac_f32_16x16x64_bf16 v[48:51], v[20:23], a[192:199], v3
  v_smfmac_f32_16x16x64_bf16 v[52:55], v[20:23], a[248:255], v3
  v_smfmac_f32_16x16x64_bf16 v[56:59], v[20:23], v[168:175], v3
  v_smfmac_f32_16x16x64_bf16 v[60:63], v[20:23], v[224:231], v3
  v_smfmac_f32_16x16x64_bf16 v[36:39], v[24:27], a[32:39], v3
  v_smfmac_f32_16x16x64_bf16 v[40:43], v[24:27], a[88:95], v3
  v_smfmac_f32_16x16x64_bf16 v[44:47], v[24:27], a[144:151], v3
  v_smfmac_f32_16x16x64_bf16 v[48:51], v[24:27], a[200:207], v3
  v_smfmac_f32_16x16x64_bf16 v[52:55], v[24:27], v[120:127], v3
  v_smfmac_f32_16x16x64_bf16 v[56:59], v[24:27], v[176:183], v3
  v_smfmac_f32_16x16x64_bf16 v[60:63], v[24:27], v[232:239], v3
  v_smfmac_f32_16x16x64_bf16 v[36:39], v[28:31], a[40:47], v3
  v_smfmac_f32_16x16x64_bf16 v[40:43], v[28:31], a[96:103], v3
  v_smfmac_f32_16x16x64_bf16 v[44:47], v[28:31], a[152:159], v3
  v_smfmac_f32_16x16x64_bf16 v[48:51], v[28:31], a[208:215], v3
  v_smfmac_f32_16x16x64_bf16 v[52:55], v[28:31], v[128:135], v3
  v_smfmac_f32_16x16x64_bf16 v[56:59], v[28:31], v[184:191], v3
  v_smfmac_f32_16x16x64_bf16 v[60:63], v[28:31], v[240:247], v3
  v_smfmac_f32_16x16x64_bf16 v[36:39], v[32:35], a[48:55], v3
  v_smfmac_f32_16x16x64_bf16 v[40:43], v[32:35], a[104:111], v3
  v_smfmac_f32_16x16x64_bf16 v[44:47], v[32:35], a[160:167], v3
  v_smfmac_f32_16x16x64_bf16 v[48:51], v[32:35], a[216:223], v3
  v_smfmac_f32_16x16x64_bf16 v[52:55], v[32:35], v[136:143], v3
  v_smfmac_f32_16x16x64_bf16 v[56:59], v[32:35], v[192:199], v3
  v_smfmac_f32_16x16x64_bf16 v[60:63], v[32:35], v[248:255], v3
  v_permlane32_swap_b32 v36, v38
  v_permlane32_swap_b32 v37, v39
  v_add_f32 v36, v36, v38
  v_add_f32 v37, v37, v39
  v_cvt_pk_bf16_f32 v38, v36, v37
  ds_write_b32 v104, v38
  v_permlane32_swap_b32 v40, v42
  v_permlane32_swap_b32 v41, v43
  v_add_f32 v40, v40, v42
  v_add_f32 v41, v41, v43
  v_cvt_pk_bf16_f32 v42, v40, v41
  ds_write_b32 v105, v42
  v_permlane32_swap_b32 v44, v46
  v_permlane32_swap_b32 v45, v47
  v_add_f32 v44, v44, v46
  v_add_f32 v45, v45, v47
  v_cvt_pk_bf16_f32 v46, v44, v45
  ds_write_b32 v106, v46
  v_permlane32_swap_b32 v48, v50
  v_permlane32_swap_b32 v49, v51
  v_add_f32 v48, v48, v50
  v_add_f32 v49, v49, v51
  v_cvt_pk_bf16_f32 v50, v48, v49
  ds_write_b32 v107, v50
  v_permlane32_swap_b32 v52, v54
  v_permlane32_swap_b32 v53, v55
  v_add_f32 v52, v52, v54
  v_add_f32 v53, v53, v55
  v_cvt_pk_bf16_f32 v54, v52, v53
  ds_write_b32 v108, v54
  v_permlane32_swap_b32 v56, v58
  v_permlane32_swap_b32 v57, v59
  v_add_f32 v56, v56, v58
  v_add_f32 v57, v57, v59
  v_cvt_pk_bf16_f32 v58, v56, v57
  ds_write_b32 v109, v58
  v_permlane32_swap_b32 v60, v62
  v_permlane32_swap_b32 v61, v63
  v_add_f32 v60, v60, v62
  v_add_f32 v61, v61, v63
  v_cvt_pk_bf16_f32 v62, v60, v61
  ds_write_b32 v110, v62
  s_branch cA_va3_t2d
cA_va3_vor:
  s_sleep 2
  buffer_load_dword v101, off, s[8:11], s27 sc1
  s_add_u32 s30, s30, 1
  s_cmp_lt_u32 s30, 400000
  s_cbranch_scc1 cA_va3_vow
  s_branch cA_abort
cA_abort:
  v_mov_b32 v4, 0xdead
  v_mov_b32 v5, 16
  buffer_store_dword v4, v5, s[12:15], 0 offen
  s_branch ch_end
cA_done:
  s_branch ch_end
.p2align 6
cB_sc0_loop:
  s_mov_b32 s30, 0
  s_mov_b32 s62, 0
  s_setprio 3
  s_sleep 6
  buffer_load_dword v24, v0, s[8:11], 0 offen sc1
  buffer_load_dword v25, v0, s[8:11], 0 offen sc1
  buffer_load_dword v26, v0, s[8:11], 0 offen sc1
  buffer_load_dword v27, v0, s[8:11], 0 offen sc1
  buffer_load_dword v28, v0, s[8:11], 0 offen sc1
cB_sc0_fp_l:
  s_waitcnt vmcnt(4)
  v_cmp_gt_u32 vcc, s19, v24
  buffer_load_dword v24, v0, s[8:11], 0 offen sc1
  s_cbranch_vccz cB_sc0_fp_d
  s_waitcnt vmcnt(4)
  v_cmp_gt_u32 vcc, s19, v25
  buffer_load_dword v25, v0, s[8:11], 0 offen sc1
  s_cbranch_vccz cB_sc0_fp_d
  s_waitcnt vmcnt(4)
  v_cmp_gt_u32 vcc, s19, v26
  buffer_load_dword v26, v0, s[8:11], 0 offen sc1
  s_cbranch_vccz cB_sc0_fp_d
  s_waitcnt vmcnt(4)
  v_cmp_gt_u32 vcc, s19, v27
  buffer_load_dword v27, v0, s[8:11], 0 offen sc1
  s_cbranch_vccz cB_sc0_fp_d
  s_waitcnt vmcnt(4)
  v_cmp_gt_u32 vcc, s19, v28
  buffer_load_dword v28, v0, s[8:11], 0 offen sc1
  s_cbranch_vccz cB_sc0_fp_d
  s_waitcnt vmcnt(4)
  v_cmp_gt_u32 vcc, s19, v24
  buffer_load_dword v24, v0, s[8:11], 0 offen sc1
  s_cbranch_vccz cB_sc0_fp_d
  s_waitcnt vmcnt(4)
  v_cmp_gt_u32 vcc, s19, v25
  buffer_load_dword v25, v0, s[8:11], 0 offen sc1
  s_cbranch_vccz cB_sc0_fp_d
  s_waitcnt vmcnt(4)
  v_cmp_gt_u32 vcc, s19, v26
  buffer_load_dword v26, v0, s[8:11], 0 offen sc1
  s_cbranch_vccz cB_sc0_fp_d
  s_waitcnt vmcnt(4)
  v_cmp_gt_u32 vcc, s19, v27
  buffer_load_dword v27, v0, s[8:11], 0 offen sc1
  s_cbranch_vccz cB_sc0_fp_d
  s_waitcnt vmcnt(4)
  v_cmp_gt_u32 vcc, s19, v28
  buffer_load_dword v28, v0, s[8:11], 0 offen sc1
  s_cbranch_vccz cB_sc0_fp_d
  s_waitcnt vmcnt(4)
  v_cmp_gt_u32 vcc, s19, v24
  buffer_load_dword v24, v0, s[8:11], 0 offen sc1
  s_cbranch_vccz cB_sc0_fp_d
  s_waitcnt vmcnt(4)
  v_cmp_gt_u32 vcc, s19, v25
  buffer_load_dword v25, v0, s[8:11], 0 offen sc1
  s_cbranch_vccz cB_sc0_fp_d
  s_waitcnt vmcnt(4)
  v_cmp_gt_u32 vcc, s19, v26
  buffer_load_dword v26, v0, s[8:11], 0 offen sc1
  s_cbranch_vccz cB_sc0_fp_d
  s_waitcnt vmcnt(4)
  v_cmp_gt_u32 vcc, s19, v27
  buffer_load_dword v27, v0, s[8:11], 0 offen sc1
  s_cbranch_vccz cB_sc0_fp_d
  s_waitcnt vmcnt(4)
  v_cmp_gt_u32 vcc, s19, v28
  buffer_load_dword v28, v0, s[8:11], 0 offen sc1
  s_cbranch_vccz cB_sc0_fp_d
  s_add_u32 s30, s30, 1
  s_cmp_lt_u32 s30, 400000
  s_cbranch_scc1 cB_sc0_fp_l
  s_branch cB_abort
cB_sc0_fp_d:
  buffer_load_dwordx4 v[8:11], v2, s[8:11], s20 offen offset:0 sc1
  s_barrier
  s_setprio 2
  buffer_load_dwordx4 v[12:15], v2, s[8:11], s20 offen offset:1024 sc1
  s_setprio 1
  buffer_load_dwordx4 v[16:19], v2, s[8:11], s20 offen offset:2048 sc1
  s_setprio 0
  buffer_load_dwordx4 v[20:23], v2, s[8:11], s20 offen offset:3072 sc1
cB_sc0_go:
  s_waitcnt vmcnt(3)
  v_smfmac_f32_16x16x64_bf16 v[36:39], v[8:11], a[0:7], v3
  buffer_load_dwordx4 v[32:35], v2, s[8:11], s23 offen offset:0 sc1
  v_cmp_eq_u32 vcc, -1, v8
  v_smfmac_f32_16x16x64_bf16 v[40:43], v[8:11], a[56:63], v3
  v_smfmac_f32_16x16x64_bf16 v[44:47], v[8:11], a[112:119], v3
  buffer_load_dwordx4 v[24:27], v2, s[8:11], s23 offen offset:1024 sc1
  s_cbranch_vccnz cB_sc0_r0
  v_smfmac_f32_16x16x64_bf16 v[48:51], v[8:11], a[168:175], v3
  v_smfmac_f32_16x16x64_bf16 v[52:55], v[8:11], a[224:231], v3
  s_waitcnt vmcnt(4)
  v_cmp_eq_u32 vcc, -1, v12
  v_smfmac_f32_16x16x64_bf16 v[56:59], v[8:11], v[144:151], v3
  buffer_load_dwordx4 v[28:31], v2, s[8:11], s23 offen offset:2048 sc1
  v_smfmac_f32_16x16x64_bf16 v[60:63], v[8:11], v[200:207], v3
  s_cbranch_vccnz cB_sc0_r1
cB_sc0_c1:
  v_smfmac_f32_16x16x64_bf16 v[36:39], v[12:15], a[8:15], v3
  v_smfmac_f32_16x16x64_bf16 v[40:43], v[12:15], a[64:71], v3
  v_smfmac_f32_16x16x64_bf16 v[44:47], v[12:15], a[120:127], v3
  v_smfmac_f32_16x16x64_bf16 v[48:51], v[12:15], a[176:183], v3
  v_smfmac_f32_16x16x64_bf16 v[52:55], v[12:15], a[232:239], v3
  s_waitcnt vmcnt(4)
  v_cmp_eq_u32 vcc, -1, v16
  v_smfmac_f32_16x16x64_bf16 v[56:59], v[12:15], v[152:159], v3
  buffer_load_dwordx4 v[88:91], v117, s[8:11], s26 offen offset:0 sc1
  v_smfmac_f32_16x16x64_bf16 v[60:63], v[12:15], v[208:215], v3
  s_cbranch_vccnz cB_sc0_r2
cB_sc0_c2:
  v_smfmac_f32_16x16x64_bf16 v[36:39], v[16:19], a[16:23], v3
  v_smfmac_f32_16x16x64_bf16 v[40:43], v[16:19], a[72:79], v3
  v_smfmac_f32_16x16x64_bf16 v[44:47], v[16:19], a[128:135], v3
  buffer_load_dwordx4 v[92:95], v117, s[8:11], s26 offen offset:1024 sc1
  v_smfmac_f32_16x16x64_bf16 v[48:51], v[16:19], a[184:191], v3
  v_smfmac_f32_16x16x64_bf16 v[52:55], v[16:19], a[240:247], v3
  s_waitcnt vmcnt(5)
  v_cmp_eq_u32 vcc, -1, v20
  v_smfmac_f32_16x16x64_bf16 v[56:59], v[16:19], v[160:167], v3
  v_smfmac_f32_16x16x64_bf16 v[60:63], v[16:19], v[216:223], v3
  buffer_load_dwordx4 v[96:99], v2, s[8:11], s24 offen offset:0 sc1
  s_cbranch_vccnz cB_sc0_r3
cB_sc0_c3:
  v_smfmac_f32_16x16x64_bf16 v[36:39], v[20:23], a[24:31], v3
  v_smfmac_f32_16x16x64_bf16 v[40:43], v[20:23], a[80:87], v3
  s_waitcnt vmcnt(3)
  v_max3_u32 v66, v24, v27, v28
  v_smfmac_f32_16x16x64_bf16 v[44:47], v[20:23], a[136:143], v3
  v_max3_u32 v66, v66, v31, v32
  v_smfmac_f32_16x16x64_bf16 v[48:51], v[20:23], a[192:199], v3
  buffer_load_dwordx4 v[100:103], v2, s[8:11], s24 offen offset:1024 sc1
  v_max_u32 v66, v66, v35
  v_smfmac_f32_16x16x64_bf16 v[52:55], v[20:23], a[248:255], v3
  v_cmp_eq_u32 vcc, -1, v66
  v_smfmac_f32_16x16x64_bf16 v[56:59], v[20:23], v[168:175], v3
  v_smfmac_f32_16x16x64_bf16 v[60:63], v[20:23], v[224:231], v3
  s_cbranch_vccnz cB_sc0_r4
cB_sc0_c4:
  v_smfmac_f32_16x16x64_bf16 v[60:63], v[32:35], v[232:239], v3
  buffer_load_dwordx4 v[104:107], v2, s[8:11], s26 offen offset:0 sc1
  v_smfmac_f32_16x16x64_bf16 v[60:63], v[24:27], v[240:247], v3
  v_smfmac_f32_16x16x64_bf16 v[60:63], v[28:31], v[248:255], v3
  v_smfmac_f32_16x16x64_bf16 v[52:55], v[32:35], v[120:127], v3
  v_smfmac_f32_16x16x64_bf16 v[52:55], v[24:27], v[128:135], v3
  buffer_load_dwordx4 v[108:111], v2, s[8:11], s26 offen offset:1024 sc1
  v_smfmac_f32_16x16x64_bf16 v[52:55], v[28:31], v[136:143], v3
  v_cvt_pk_bf16_f32 v63, v62, v63
  v_smfmac_f32_16x16x64_bf16 v[56:59], v[32:35], v[176:183], v3
  v_cvt_pk_bf16_f32 v62, v60, v61
  v_smfmac_f32_16x16x64_bf16 v[56:59], v[24:27], v[184:191], v3
  v_mfma_f32_16x16x32_bf16 v[12:15], v[62:65], v[4:7], 0
  v_cvt_pk_bf16_f32 v55, v54, v55
  v_smfmac_f32_16x16x64_bf16 v[56:59], v[28:31], v[192:199], v3
  v_cvt_pk_bf16_f32 v54, v52, v53
  v_smfmac_f32_16x16x64_bf16 v[36:39], v[32:35], a[32:39], v3
  s_nop 1
  v_cvt_pk_bf16_f32 v76, v12, v13
  v_smfmac_f32_16x16x64_bf16 v[36:39], v[24:27], a[40:47], v3
  v_cvt_pk_bf16_f32 v77, v14, v15
  v_smfmac_f32_16x16x64_bf16 v[36:39], v[28:31], a[48:55], v3
  v_cvt_pk_bf16_f32 v56, v56, v57
  v_smfmac_f32_16x16x64_bf16 v[40:43], v[32:35], a[88:95], v3
  v_cvt_pk_bf16_f32 v57, v58, v59
  v_smfmac_f32_16x16x64_bf16 v[40:43], v[24:27], a[96:103], v3
  v_mfma_f32_16x16x32_bf16 v[16:19], v[54:57], v[4:7], 0
  v_cvt_pk_bf16_f32 v39, v38, v39
  v_smfmac_f32_16x16x64_bf16 v[40:43], v[28:31], a[104:111], v3
  v_cvt_pk_bf16_f32 v38, v36, v37
  v_smfmac_f32_16x16x64_bf16 v[44:47], v[32:35], a[144:151], v3
  s_nop 1
  v_cvt_pk_bf16_f32 v78, v16, v17
  v_smfmac_f32_16x16x64_bf16 v[44:47], v[24:27], a[152:159], v3
  v_cvt_pk_bf16_f32 v79, v18, v19
  v_smfmac_f32_16x16x64_bf16 v[44:47], v[28:31], a[160:167], v3
  v_cvt_pk_bf16_f32 v40, v40, v41
  v_smfmac_f32_16x16x64_bf16 v[48:51], v[32:35], a[200:207], v3
  v_cvt_pk_bf16_f32 v41, v42, v43
  v_smfmac_f32_16x16x64_bf16 v[48:51], v[24:27], a[208:215], v3
  v_smfmac_f32_16x16x64_bf16 v[48:51], v[28:31], a[216:223], v3
  s_waitcnt vmcnt(4)
  v_cvt_pk_bf16_f32 v47, v46, v47
  v_smfmac_f32_16x16x64_bf16 v[68:71], v[76:79], v[80:87], v3
  v_cvt_pk_bf16_f32 v46, v44, v45
  v_mfma_f32_16x16x32_bf16 v[12:15], v[38:41], v[4:7], 0
  s_nop 1
  v_cvt_pk_bf16_f32 v48, v48, v49
  v_cvt_pk_bf16_f32 v49, v50, v51
  s_nop 1
  v_mfma_f32_16x16x32_bf16 v[16:19], v[46:49], v[4:7], 0
  v_smfmac_f32_16x16x64_bf16 v[72:75], v[76:79], v[88:95], v3
  v_cvt_pk_bf16_f32 v20, v12, v13
  v_mfma_f32_16x16x32_bf16 v[52:55], v[30:33], v[76:79], 0
  s_waitcnt vmcnt(0)
  v_cvt_pk_bf16_f32 v21, v14, v15
  v_cvt_pk_bf16_f32 v22, v16, v17
  v_cvt_pk_bf16_f32 v23, v18, v19
  s_nop 1
  v_mfma_f32_16x16x32_bf16 v[52:55], v[8:11], v[20:23], v[52:55]
  v_smfmac_f32_16x16x64_bf16 v[68:71], v[20:23], v[96:103], v3
  v_smfmac_f32_16x16x64_bf16 v[72:75], v[20:23], v[104:111], v3
  s_nop 1
  ds_write_b128 v113, v[52:55]
  s_nop 1
  v_permlane32_swap_b32 v68, v70
  v_permlane32_swap_b32 v69, v71
  v_add_f32 v56, v68, v70
  v_add_f32 v58, v69, v71
  v_permlane32_swap_b32 v72, v74
  v_permlane32_swap_b32 v73, v75
  v_add_f32 v57, v72, v74
  v_add_f32 v59, v73, v75
  ds_write_b128 v2, v[56:59] offset:0
  v_cmp_u_f32 vcc, v57, v59
  v_mov_b32 v68, 0
  v_mov_b32 v69, 0
  v_mov_b32 v70, 0
  v_mov_b32 v71, 0
  s_cbranch_vccnz cB_sc0_retry
cB_sc0_cont:
  s_add_u32 s24, s24, 28672
  s_add_u32 s26, s26, 28672
  buffer_load_dwordx4 v[80:83], v117, s[8:11], s24 offen offset:0 sc1
  buffer_load_dwordx4 v[84:87], v117, s[8:11], s24 offen offset:1024 sc1
  v_mov_b32 v72, 0
  v_mov_b32 v73, 0
  v_mfma_f32_32x32x16_bf16 v[36:51], v[68:71], v[68:71], 0
  s_waitcnt lgkmcnt(0)
  s_barrier
  ds_read_b64 v[8:9], v114 offset:0
  ds_read_b64 v[10:11], v114 offset:1024
  ds_read_b64 v[12:13], v114 offset:2048
  ds_read_b64 v[14:15], v114 offset:3072
  ds_read2_b32 v[16:17], v115 offset0:0 offset1:64
  ds_read2_b32 v[18:19], v115 offset0:128 offset1:192
  v_mfma_f32_32x32x16_bf16 v[52:67], v[68:71], v[68:71], 0
  s_waitcnt lgkmcnt(0)
  v_pk_add_f32 v[16:17], v[16:17], v[18:19]
  v_pk_add_f32 v[8:9], v[8:9], v[10:11]
  v_pk_add_f32 v[12:13], v[12:13], v[14:15]
  v_add_f32 v20, v16, v17
  v_pk_add_f32 v[8:9], v[8:9], v[12:13]
  v_max_f32 v22, v8, v9
  v_add_f32_dpp v20, v20, v20 row_ror:8 row_mask:0xf bank_mask:0xf
  s_nop 0
  v_max_f32_dpp v22, v22, v22 row_ror:8 row_mask:0xf bank_mask:0xf
  v_max_f32 v22, v22, v20
  s_nop 1
  v_max_f32_dpp v22, v22, v22 quad_perm:[1,0,3,2] row_mask:0xf bank_mask:0xf
  s_nop 1
  v_max_f32_dpp v22, v22, v22 quad_perm:[2,3,0,1] row_mask:0xf bank_mask:0xf
  s_nop 1
  v_max_f32_dpp v22, v22, v22 row_half_mirror row_mask:0xf bank_mask:0xf
  v_pk_add_f32 v[8:9], v[8:9], v[22:23] op_sel_hi:[1,0] neg_lo:[0,1] neg_hi:[0,1]
  v_sub_f32 v20, v20, v22
  v_exp_f32 v8, v8
  v_exp_f32 v9, v9
  v_exp_f32 v20, v20
  v_add_f32 v24, v8, v9
  v_fmac_f32 v24, 0.5, v20
  v_mov_b32_dpp v21, v20 quad_perm:[1,0,3,2] row_mask:0xf bank_mask:0xf
  s_nop 0
  v_add_f32_dpp v24, v24, v24 quad_perm:[1,0,3,2] row_mask:0xf bank_mask:0xf
  s_nop 1
  v_add_f32_dpp v24, v24, v24 quad_perm:[2,3,0,1] row_mask:0xf bank_mask:0xf
  s_nop 1
  v_add_f32_dpp v24, v24, v24 row_half_mirror row_mask:0xf bank_mask:0xf
  s_nop 1
  v_add_f32_dpp v24, v24, v24 row_ror:8 row_mask:0xf bank_mask:0xf
  v_rcp_f32 v24, v24
  s_nop 0
  v_pk_mul_f32 v[8:9], v[8:9], v[24:25] op_sel_hi:[1,0]
  v_pk_mul_f32 v[20:21], v[20:21], v[24:25] op_sel_hi:[1,0]
  v_cvt_pk_bf16_f32 v8, v8, v9
  v_cvt_pk_bf16_f32 v20, v20, v21
  v_min_u32 v8, -2, v8
  buffer_store_dword v8, v1, s[8:11], s20 offen sc1
  v_min_u32 v20, -2, v20
  buffer_store_dword v20, v118, s[8:11], s20 offen sc1
  v_mov_b32 v74, 0
  v_mov_b32 v75, 0
  s_mov_b32 s19, s18
  s_add_u32 s18, s18, 1
  s_mov_b32 s22, s20
  s_mov_b32 s20, s21
  s_mov_b32 s21, s22
  s_add_u32 s23, s20, 4096
  s_cmp_lt_u32 s19, 63
  s_cbranch_scc1 cB_sc0_loop
  s_branch cB_done
cB_sc0_r0:
  s_add_u32 s31, s31, 1
  buffer_load_dwordx4 v[8:11], v2, s[8:11], s20 offen offset:0 sc1
  s_waitcnt vmcnt(0)
  v_cmp_eq_u32 vcc, -1, v8
  v_mov_b32 v36, 0
  v_mov_b32 v37, 0
  v_mov_b32 v38, 0
  v_mov_b32 v39, 0
  v_mov_b32 v40, 0
  v_mov_b32 v41, 0
  v_mov_b32 v42, 0
  v_mov_b32 v43, 0
  v_mov_b32 v44, 0
  v_mov_b32 v45, 0
  v_mov_b32 v46, 0
  v_mov_b32 v47, 0
  v_mov_b32 v48, 0
  v_mov_b32 v49, 0
  v_mov_b32 v50, 0
  v_mov_b32 v51, 0
  s_nop 1
  s_cbranch_vccz cB_sc0_go
  s_add_u32 s30, s30, 1
  s_cmp_lt_u32 s30, 400000
  s_cbranch_scc1 cB_sc0_r0
  s_branch cB_abort
cB_sc0_r1:
  s_add_u32 s31, s31, 1
  buffer_load_dwordx4 v[12:15], v2, s[8:11], s20 offen offset:1024 sc1
  s_waitcnt vmcnt(0)
  v_cmp_eq_u32 vcc, -1, v12
  s_nop 4
  s_cbranch_vccz cB_sc0_c1
  s_add_u32 s30, s30, 1
  s_cmp_lt_u32 s30, 400000
  s_cbranch_scc1 cB_sc0_r1
  s_branch cB_abort
cB_sc0_r2:
  s_add_u32 s31, s31, 1
  buffer_load_dwordx4 v[16:19], v2, s[8:11], s20 offen offset:2048 sc1
  s_waitcnt vmcnt(0)
  v_cmp_eq_u32 vcc, -1, v16
  s_nop 4
  s_cbranch_vccz cB_sc0_c2
  s_add_u32 s30, s30, 1
  s_cmp_lt_u32 s30, 400000
  s_cbranch_scc1 cB_sc0_r2
  s_branch cB_abort
cB_sc0_r3:
  s_add_u32 s31, s31, 1
  buffer_load_dwordx4 v[20:23], v2, s[8:11], s20 offen offset:3072 sc1
  s_waitcnt vmcnt(0)
  v_cmp_eq_u32 vcc, -1, v20
  s_nop 4
  s_cbranch_vccz cB_sc0_c3
  s_add_u32 s30, s30, 1
  s_cmp_lt_u32 s30, 400000
  s_cbranch_scc1 cB_sc0_r3
  s_branch cB_abort
cB_sc0_r4:
  s_add_u32 s31, s31, 1
  buffer_load_dwordx4 v[32:35], v2, s[8:11], s23 offen offset:0 sc1
  buffer_load_dwordx4 v[24:27], v2, s[8:11], s23 offen offset:1024 sc1
  buffer_load_dwordx4 v[28:31], v2, s[8:11], s23 offen offset:2048 sc1
  s_waitcnt vmcnt(0)
  v_max3_u32 v66, v24, v27, v28
  v_max3_u32 v66, v66, v31, v32
  v_max_u32 v66, v66, v35
  v_cmp_eq_u32 vcc, -1, v66
  s_nop 4
  s_cbranch_vccz cB_sc0_c4
  s_add_u32 s30, s30, 1
  s_cmp_lt_u32 s30, 400000
  s_cbranch_scc1 cB_sc0_r4
  s_branch cB_abort
cB_sc0_retry:
  s_cmp_lg_u32 s62, 0
  s_cbranch_scc1 cB_sc0_cont
  s_waitcnt vmcnt(0) lgkmcnt(0)
cB_sc0_rv:
  buffer_load_dwordx4 v[8:11], v2, s[8:11], s20 offen offset:0 sc1
  buffer_load_dwordx4 v[12:15], v2, s[8:11], s20 offen offset:1024 sc1
  buffer_load_dwordx4 v[16:19], v2, s[8:11], s20 offen offset:2048 sc1
  buffer_load_dwordx4 v[20:23], v2, s[8:11], s20 offen offset:3072 sc1
  buffer_load_dwordx4 v[32:35], v2, s[8:11], s23 offen offset:0 sc1
  buffer_load_dwordx4 v[24:27], v2, s[8:11], s23 offen offset:1024 sc1
  buffer_load_dwordx4 v[28:31], v2, s[8:11], s23 offen offset:2048 sc1
  s_waitcnt vmcnt(0)
  v_pk_max_u16 v66, v8, v9
  v_pk_max_u16 v66, v66, v10
  v_pk_max_u16 v66, v66, v11
  v_pk_max_u16 v66, v66, v12
  v_pk_max_u16 v66, v66, v13
  v_pk_max_u16 v66, v66, v14
  v_pk_max_u16 v66, v66, v15
  v_pk_max_u16 v66, v66, v16
  v_pk_max_u16 v66, v66, v17
  v_pk_max_u16 v66, v66, v18
  v_pk_max_u16 v66, v66, v19
  v_pk_max_u16 v66, v66, v20
  v_pk_max_u16 v66, v66, v21
  v_pk_max_u16 v66, v66, v22
  v_pk_max_u16 v66, v66, v23
  v_pk_max_u16 v66, v66, v24
  v_pk_max_u16 v66, v66, v25
  v_pk_max_u16 v66, v66, v26
  v_pk_max_u16 v66, v66, v27
  v_pk_max_u16 v66, v66, v28
  v_pk_max_u16 v66, v66, v29
  v_pk_max_u16 v66, v66, v30
  v_pk_max_u16 v66, v66, v31
  v_pk_max_u16 v66, v66, v32
  v_pk_max_u16 v66, v66, v33
  v_pk_max_u16 v66, v66, v34
  v_pk_max_u16 v66, v66, v35
  v_lshlrev_b32 v67, 16, v66
  v_max_u32 v66, v66, v67
  v_cmp_le_u32 vcc, 0xffff0000, v66
  s_cbranch_vccz cB_sc0_rk
  s_add_u32 s30, s30, 1
  s_cmp_lt_u32 s30, 400000
  s_cbranch_scc1 cB_sc0_rv
  s_branch cB_abort
cB_sc0_rk:
  s_mov_b32 s62, 1
  v_mov_b32 v36, 0
  v_mov_b32 v37, 0
  v_mov_b32 v38, 0
  v_mov_b32 v39, 0
  v_mov_b32 v40, 0
  v_mov_b32 v41, 0
  v_mov_b32 v42, 0
  v_mov_b32 v43, 0
  v_mov_b32 v44, 0
  v_mov_b32 v45, 0
  v_mov_b32 v46, 0
  v_mov_b32 v47, 0
  v_mov_b32 v48, 0
  v_mov_b32 v49, 0
  v_mov_b32 v50, 0
  v_mov_b32 v51, 0
  v_mov_b32 v60, 0
  v_mov_b32 v61, 0
  v_mov_b32 v62, 0
  v_mov_b32 v63, 0
  v_mov_b32 v68, 0
  v_mov_b32 v69, 0
  v_mov_b32 v70, 0
  v_mov_b32 v71, 0
  v_mov_b32 v72, 0
  v_mov_b32 v73, 0
  v_mov_b32 v74, 0
  v_mov_b32 v75, 0
  v_mov_b32 v52, 0
  v_mov_b32 v53, 0
  v_mov_b32 v54, 0
  v_mov_b32 v55, 0
  v_mov_b32 v56, 0
  v_mov_b32 v57, 0
  v_mov_b32 v58, 0
  v_mov_b32 v59, 0
  s_add_u32 s31, s31, 0x100
  s_nop 0
  s_branch cB_sc0_go
.p2align 6
cB_sc1_loop:
  s_mov_b32 s30, 0
  s_mov_b32 s62, 0
  s_setprio 3
  s_barrier
  buffer_load_dwordx4 v[8:11], v2, s[8:11], s20 offen offset:0 sc1
  s_setprio 2
  buffer_load_dwordx4 v[12:15], v2, s[8:11], s20 offen offset:1024 sc1
  s_setprio 1
  buffer_load_dwordx4 v[16:19], v2, s[8:11], s20 offen offset:2048 sc1
  s_setprio 0
  buffer_load_dwordx4 v[20:23], v2, s[8:11], s20 offen offset:3072 sc1
cB_sc1_go:
  s_waitcnt vmcnt(3)
  v_smfmac_f32_16x16x64_bf16 v[36:39], v[8:11], a[0:7], v3
  buffer_load_dwordx4 v[28:31], v2, s[8:11], s23 offen offset:0 sc1
  v_cmp_eq_u32 vcc, -1, v8
  v_smfmac_f32_16x16x64_bf16 v[40:43], v[8:11], a[56:63], v3
  v_smfmac_f32_16x16x64_bf16 v[44:47], v[8:11], a[112:119], v3
  buffer_load_dwordx4 v[24:27], v2, s[8:11], s23 offen offset:1024 sc1
  s_cbranch_vccnz cB_sc1_r0
  v_smfmac_f32_16x16x64_bf16 v[48:51], v[8:11], a[168:175], v3
  v_smfmac_f32_16x16x64_bf16 v[52:55], v[8:11], a[224:231], v3
  s_waitcnt vmcnt(4)
  v_cmp_eq_u32 vcc, -1, v12
  v_smfmac_f32_16x16x64_bf16 v[56:59], v[8:11], v[144:151], v3
  buffer_load_dwordx4 v[32:35], v2, s[8:11], s23 offen offset:2048 sc1
  v_smfmac_f32_16x16x64_bf16 v[60:63], v[8:11], v[200:207], v3
  s_cbranch_vccnz cB_sc1_r1
cB_sc1_c1:
  v_smfmac_f32_16x16x64_bf16 v[36:39], v[12:15], a[8:15], v3
  v_smfmac_f32_16x16x64_bf16 v[40:43], v[12:15], a[64:71], v3
  v_smfmac_f32_16x16x64_bf16 v[44:47], v[12:15], a[120:127], v3
  v_smfmac_f32_16x16x64_bf16 v[48:51], v[12:15], a[176:183], v3
  v_smfmac_f32_16x16x64_bf16 v[52:55], v[12:15], a[232:239], v3
  s_waitcnt vmcnt(4)
  v_cmp_eq_u32 vcc, -1, v16
  v_smfmac_f32_16x16x64_bf16 v[56:59], v[12:15], v[152:159], v3
  buffer_load_dwordx4 v[88:91], v117, s[8:11], s26 offen offset:0 sc1
  v_smfmac_f32_16x16x64_bf16 v[60:63], v[12:15], v[208:215], v3
  s_cbranch_vccnz cB_sc1_r2
cB_sc1_c2:
  v_smfmac_f32_16x16x64_bf16 v[36:39], v[16:19], a[16:23], v3
  v_smfmac_f32_16x16x64_bf16 v[40:43], v[16:19], a[72:79], v3
  v_smfmac_f32_16x16x64_bf16 v[44:47], v[16:19], a[128:135], v3
  buffer_load_dwordx4 v[92:95], v117, s[8:11], s26 offen offset:1024 sc1
  v_smfmac_f32_16x16x64_bf16 v[48:51], v[16:19], a[184:191], v3
  v_smfmac_f32_16x16x64_bf16 v[52:55], v[16:19], a[240:247], v3
  s_waitcnt vmcnt(5)
  v_cmp_eq_u32 vcc, -1, v20
  v_smfmac_f32_16x16x64_bf16 v[56:59], v[16:19], v[160:167], v3
  v_smfmac_f32_16x16x64_bf16 v[60:63], v[16:19], v[216:223], v3
  buffer_load_dwordx4 v[96:99], v2, s[8:11], s24 offen offset:0 sc1
  s_cbranch_vccnz cB_sc1_r3
cB_sc1_c3:
  v_smfmac_f32_16x16x64_bf16 v[36:39], v[20:23], a[24:31], v3
  v_smfmac_f32_16x16x64_bf16 v[40:43], v[20:23], a[80:87], v3
  s_waitcnt vmcnt(3)
  v_max3_u32 v66, v24, v27, v28
  v_smfmac_f32_16x16x64_bf16 v[44:47], v[20:23], a[136:143], v3
  v_max3_u32 v66, v66, v31, v32
  v_smfmac_f32_16x16x64_bf16 v[48:51], v[20:23], a[192:199], v3
  buffer_load_dwordx4 v[100:103], v2, s[8:11], s24 offen offset:1024 sc1
  v_max_u32 v66, v66, v35
  v_smfmac_f32_16x16x64_bf16 v[52:55], v[20:23], a[248:255], v3
  v_cmp_eq_u32 vcc, -1, v66
  v_smfmac_f32_16x16x64_bf16 v[56:59], v[20:23], v[168:175], v3
  v_smfmac_f32_16x16x64_bf16 v[60:63], v[20:23], v[224:231], v3
  s_cbranch_vccnz cB_sc1_r4
cB_sc1_c4:
  v_smfmac_f32_16x16x64_bf16 v[60:63], v[28:31], v[232:239], v3
  buffer_load_dwordx4 v[104:107], v2, s[8:11], s26 offen offset:0 sc1
  v_smfmac_f32_16x16x64_bf16 v[60:63], v[24:27], v[240:247], v3
  v_smfmac_f32_16x16x64_bf16 v[60:63], v[32:35], v[248:255], v3
  v_smfmac_f32_16x16x64_bf16 v[52:55], v[28:31], v[120:127], v3
  v_smfmac_f32_16x16x64_bf16 v[52:55], v[24:27], v[128:135], v3
  buffer_load_dwordx4 v[108:111], v2, s[8:11], s26 offen offset:1024 sc1
  v_smfmac_f32_16x16x64_bf16 v[52:55], v[32:35], v[136:143], v3
  v_cvt_pk_bf16_f32 v63, v62, v63
  v_smfmac_f32_16x16x64_bf16 v[56:59], v[28:31], v[176:183], v3
  v_cvt_pk_bf16_f32 v62, v60, v61
  v_smfmac_f32_16x16x64_bf16 v[56:59], v[24:27], v[184:191], v3
  v_mfma_f32_16x16x32_bf16 v[8:11], v[62:65], v[4:7], 0
  v_cvt_pk_bf16_f32 v55, v54, v55
  v_smfmac_f32_16x16x64_bf16 v[56:59], v[32:35], v[192:199], v3
  v_cvt_pk_bf16_f32 v54, v52, v53
  v_smfmac_f32_16x16x64_bf16 v[36:39], v[28:31], a[32:39], v3
  s_nop 1
  v_cvt_pk_bf16_f32 v78, v8, v9
  v_smfmac_f32_16x16x64_bf16 v[36:39], v[24:27], a[40:47], v3
  v_cvt_pk_bf16_f32 v79, v10, v11
  v_smfmac_f32_16x16x64_bf16 v[36:39], v[32:35], a[48:55], v3
  v_cvt_pk_bf16_f32 v56, v56, v57
  v_smfmac_f32_16x16x64_bf16 v[40:43], v[28:31], a[88:95], v3
  v_cvt_pk_bf16_f32 v57, v58, v59
  v_smfmac_f32_16x16x64_bf16 v[40:43], v[24:27], a[96:103], v3
  v_mfma_f32_16x16x32_bf16 v[16:19], v[54:57], v[4:7], 0
  v_cvt_pk_bf16_f32 v39, v38, v39
  v_smfmac_f32_16x16x64_bf16 v[40:43], v[32:35], a[104:111], v3
  v_cvt_pk_bf16_f32 v38, v36, v37
  v_smfmac_f32_16x16x64_bf16 v[44:47], v[28:31], a[144:151], v3
  s_nop 1
  v_cvt_pk_bf16_f32 v76, v16, v17
  v_smfmac_f32_16x16x64_bf16 v[44:47], v[24:27], a[152:159], v3
  v_cvt_pk_bf16_f32 v77, v18, v19
  v_smfmac_f32_16x16x64_bf16 v[44:47], v[32:35], a[160:167], v3
  v_cvt_pk_bf16_f32 v40, v40, v41
  v_smfmac_f32_16x16x64_bf16 v[48:51], v[28:31], a[200:207], v3
  v_cvt_pk_bf16_f32 v41, v42, v43
  v_smfmac_f32_16x16x64_bf16 v[48:51], v[24:27], a[208:215], v3
  v_smfmac_f32_16x16x64_bf16 v[48:51], v[32:35], a[216:223], v3
  s_waitcnt vmcnt(4)
  v_cvt_pk_bf16_f32 v47, v46, v47
  v_smfmac_f32_16x16x64_bf16 v[68:71], v[76:79], v[80:87], v3
  v_cvt_pk_bf16_f32 v46, v44, v45
  v_mfma_f32_16x16x32_bf16 v[8:11], v[38:41], v[4:7], 0
  s_nop 1
  v_cvt_pk_bf16_f32 v48, v48, v49
  v_cvt_pk_bf16_f32 v49, v50, v51
  s_nop 1
  v_mfma_f32_16x16x32_bf16 v[16:19], v[46:49], v[4:7], 0
  v_smfmac_f32_16x16x64_bf16 v[72:75], v[76:79], v[88:95], v3
  v_cvt_pk_bf16_f32 v20, v8, v9
  v_mfma_f32_16x16x32_bf16 v[52:55], v[30:33], v[76:79], 0
  s_waitcnt vmcnt(0)
  v_cvt_pk_bf16_f32 v21, v10, v11
  v_cvt_pk_bf16_f32 v22, v16, v17
  v_cvt_pk_bf16_f32 v23, v18, v19
  s_nop 1
  v_mfma_f32_16x16x32_bf16 v[52:55], v[12:15], v[20:23], v[52:55]
  v_smfmac_f32_16x16x64_bf16 v[68:71], v[20:23], v[96:103], v3
  v_smfmac_f32_16x16x64_bf16 v[72:75], v[20:23], v[104:111], v3
  s_nop 1
  ds_write_b128 v113, v[52:55]
  s_nop 1
  v_permlane32_swap_b32 v68, v70
  v_permlane32_swap_b32 v69, v71
  v_add_f32 v56, v68, v70
  v_add_f32 v58, v69, v71
  v_permlane32_swap_b32 v72, v74
  v_permlane32_swap_b32 v73, v75
  v_add_f32 v57, v72, v74
  v_add_f32 v59, v73, v75
  ds_write_b128 v2, v[56:59] offset:1024
  v_cmp_u_f32 vcc, v57, v59
  v_mov_b32 v68, 0
  v_mov_b32 v69, 0
  v_mov_b32 v70, 0
  v_mov_b32 v71, 0
  s_cbranch_vccnz cB_sc1_retry
cB_sc1_cont:
  s_add_u32 s24, s24, 28672
  s_add_u32 s26, s26, 28672
  buffer_load_dwordx4 v[80:83], v117, s[8:11], s24 offen offset:0 sc1
  buffer_load_dwordx4 v[84:87], v117, s[8:11], s24 offen offset:1024 sc1
  v_mov_b32 v72, 0
  v_mov_b32 v73, 0
  v_mfma_f32_32x32x16_bf16 v[36:51], v[68:71], v[68:71], 0
  s_waitcnt lgkmcnt(0)
  s_barrier
  ds_read_b64 v[8:9], v114 offset:0
  ds_read_b64 v[10:11], v114 offset:1024
  ds_read_b64 v[12:13], v114 offset:2048
  ds_read_b64 v[14:15], v114 offset:3072
  ds_read2_b32 v[16:17], v115 offset0:0 offset1:64
  ds_read2_b32 v[18:19], v115 offset0:128 offset1:192
  v_mfma_f32_32x32x16_bf16 v[52:67], v[68:71], v[68:71], 0
  s_waitcnt lgkmcnt(0)
  v_pk_add_f32 v[16:17], v[16:17], v[18:19]
  v_pk_add_f32 v[8:9], v[8:9], v[10:11]
  v_pk_add_f32 v[12:13], v[12:13], v[14:15]
  v_add_f32 v20, v16, v17
  v_pk_add_f32 v[8:9], v[8:9], v[12:13]
  v_max_f32 v22, v8, v9
  v_add_f32_dpp v20, v20, v20 row_ror:8 row_mask:0xf bank_mask:0xf
  s_nop 0
  v_max_f32_dpp v22, v22, v22 row_ror:8 row_mask:0xf bank_mask:0xf
  v_max_f32 v22, v22, v20
  buffer_store_dword v112, v116, s[8:11], 0 offen sc1
  s_nop 0
  v_max_f32_dpp v22, v22, v22 quad_perm:[1,0,3,2] row_mask:0xf bank_mask:0xf
  s_nop 1
  v_max_f32_dpp v22, v22, v22 quad_perm:[2,3,0,1] row_mask:0xf bank_mask:0xf
  s_nop 1
  v_max_f32_dpp v22, v22, v22 row_half_mirror row_mask:0xf bank_mask:0xf
  v_pk_add_f32 v[8:9], v[8:9], v[22:23] op_sel_hi:[1,0] neg_lo:[0,1] neg_hi:[0,1]
  v_sub_f32 v20, v20, v22
  v_exp_f32 v8, v8
  v_exp_f32 v9, v9
  v_exp_f32 v20, v20
  v_add_f32 v24, v8, v9
  v_fmac_f32 v24, 0.5, v20
  v_mov_b32_dpp v21, v20 quad_perm:[1,0,3,2] row_mask:0xf bank_mask:0xf
  s_nop 0
  v_add_f32_dpp v24, v24, v24 quad_perm:[1,0,3,2] row_mask:0xf bank_mask:0xf
  s_nop 1
  v_add_f32_dpp v24, v24, v24 quad_perm:[2,3,0,1] row_mask:0xf bank_mask:0xf
  s_nop 1
  v_add_f32_dpp v24, v24, v24 row_half_mirror row_mask:0xf bank_mask:0xf
  s_nop 1
  v_add_f32_dpp v24, v24, v24 row_ror:8 row_mask:0xf bank_mask:0xf
  v_rcp_f32 v24, v24
  s_nop 0
  v_pk_mul_f32 v[8:9], v[8:9], v[24:25] op_sel_hi:[1,0]
  v_pk_mul_f32 v[20:21], v[20:21], v[24:25] op_sel_hi:[1,0]
  v_cvt_pk_bf16_f32 v8, v8, v9
  v_cvt_pk_bf16_f32 v20, v20, v21
  v_min_u32 v8, -2, v8
  buffer_store_dword v8, v1, s[8:11], s20 offen sc1
  v_min_u32 v20, -2, v20
  buffer_store_dword v20, v118, s[8:11], s20 offen sc1
  v_mov_b32 v74, 0
  v_mov_b32 v75, 0
  s_mov_b32 s19, s18
  s_add_u32 s18, s18, 1
  s_mov_b32 s22, s20
  s_mov_b32 s20, s21
  s_mov_b32 s21, s22
  s_add_u32 s23, s20, 4096
  v_mov_b32 v112, s18
  s_cmp_lt_u32 s19, 63
  s_nop 0
  s_cbranch_scc1 cB_sc1_loop
  s_branch cB_done
cB_sc1_r0:
  s_add_u32 s31, s31, 1
  buffer_load_dwordx4 v[8:11], v2, s[8:11], s20 offen offset:0 sc1
  s_waitcnt vmcnt(0)
  v_cmp_eq_u32 vcc, -1, v8
  v_mov_b32 v36, 0
  v_mov_b32 v37, 0
  v_mov_b32 v38, 0
  v_mov_b32 v39, 0
  v_mov_b32 v40, 0
  v_mov_b32 v41, 0
  v_mov_b32 v42, 0
  v_mov_b32 v43, 0
  v_mov_b32 v44, 0
  v_mov_b32 v45, 0
  v_mov_b32 v46, 0
  v_mov_b32 v47, 0
  v_mov_b32 v48, 0
  v_mov_b32 v49, 0
  v_mov_b32 v50, 0
  v_mov_b32 v51, 0
  s_nop 1
  s_cbranch_vccz cB_sc1_go
  s_add_u32 s30, s30, 1
  s_cmp_lt_u32 s30, 400000
  s_cbranch_scc1 cB_sc1_r0
  s_branch cB_abort
cB_sc1_r1:
  s_add_u32 s31, s31, 1
  buffer_load_dwordx4 v[12:15], v2, s[8:11], s20 offen offset:1024 sc1
  s_waitcnt vmcnt(0)
  v_cmp_eq_u32 vcc, -1, v12
  s_nop 4
  s_cbranch_vccz cB_sc1_c1
  s_add_u32 s30, s30, 1
  s_cmp_lt_u32 s30, 400000
  s_cbranch_scc1 cB_sc1_r1
  s_branch cB_abort
cB_sc1_r2:
  s_add_u32 s31, s31, 1
  buffer_load_dwordx4 v[16:19], v2, s[8:11], s20 offen offset:2048 sc1
  s_waitcnt vmcnt(0)
  v_cmp_eq_u32 vcc, -1, v16
  s_nop 4
  s_cbranch_vccz cB_sc1_c2
  s_add_u32 s30, s30, 1
  s_cmp_lt_u32 s30, 400000
  s_cbranch_scc1 cB_sc1_r2
  s_branch cB_abort
cB_sc1_r3:
  s_add_u32 s31, s31, 1
  buffer_load_dwordx4 v[20:23], v2, s[8:11], s20 offen offset:3072 sc1
  s_waitcnt vmcnt(0)
  v_cmp_eq_u32 vcc, -1, v20
  s_nop 4
  s_cbranch_vccz cB_sc1_c3
  s_add_u32 s30, s30, 1
  s_cmp_lt_u32 s30, 400000
  s_cbranch_scc1 cB_sc1_r3
  s_branch cB_abort
cB_sc1_r4:
  s_add_u32 s31, s31, 1
  buffer_load_dwordx4 v[28:31], v2, s[8:11], s23 offen offset:0 sc1
  buffer_load_dwordx4 v[24:27], v2, s[8:11], s23 offen offset:1024 sc1
  buffer_load_dwordx4 v[32:35], v2, s[8:11], s23 offen offset:2048 sc1
  s_waitcnt vmcnt(0)
  v_max3_u32 v66, v24, v27, v28
  v_max3_u32 v66, v66, v31, v32
  v_max_u32 v66, v66, v35
  v_cmp_eq_u32 vcc, -1, v66
  s_nop 4
  s_cbranch_vccz cB_sc1_c4
  s_add_u32 s30, s30, 1
  s_cmp_lt_u32 s30, 400000
  s_cbranch_scc1 cB_sc1_r4
  s_branch cB_abort
cB_sc1_retry:
  s_cmp_lg_u32 s62, 0
  s_cbranch_scc1 cB_sc1_cont
  s_waitcnt vmcnt(0) lgkmcnt(0)
cB_sc1_rv:
  buffer_load_dwordx4 v[8:11], v2, s[8:11], s20 offen offset:0 sc1
  buffer_load_dwordx4 v[12:15], v2, s[8:11], s20 offen offset:1024 sc1
  buffer_load_dwordx4 v[16:19], v2, s[8:11], s20 offen offset:2048 sc1
  buffer_load_dwordx4 v[20:23], v2, s[8:11], s20 offen offset:3072 sc1
  buffer_load_dwordx4 v[28:31], v2, s[8:11], s23 offen offset:0 sc1
  buffer_load_dwordx4 v[24:27], v2, s[8:11], s23 offen offset:1024 sc1
  buffer_load_dwordx4 v[32:35], v2, s[8:11], s23 offen offset:2048 sc1
  s_waitcnt vmcnt(0)
  v_pk_max_u16 v66, v8, v9
  v_pk_max_u16 v66, v66, v10
  v_pk_max_u16 v66, v66, v11
  v_pk_max_u16 v66, v66, v12
  v_pk_max_u16 v66, v66, v13
  v_pk_max_u16 v66, v66, v14
  v_pk_max_u16 v66, v66, v15
  v_pk_max_u16 v66, v66, v16
  v_pk_max_u16 v66, v66, v17
  v_pk_max_u16 v66, v66, v18
  v_pk_max_u16 v66, v66, v19
  v_pk_max_u16 v66, v66, v20
  v_pk_max_u16 v66, v66, v21
  v_pk_max_u16 v66, v66, v22
  v_pk_max_u16 v66, v66, v23
  v_pk_max_u16 v66, v66, v24
  v_pk_max_u16 v66, v66, v25
  v_pk_max_u16 v66, v66, v26
  v_pk_max_u16 v66, v66, v27
  v_pk_max_u16 v66, v66, v28
  v_pk_max_u16 v66, v66, v29
  v_pk_max_u16 v66, v66, v30
  v_pk_max_u16 v66, v66, v31
  v_pk_max_u16 v66, v66, v32
  v_pk_max_u16 v66, v66, v33
  v_pk_max_u16 v66, v66, v34
  v_pk_max_u16 v66, v66, v35
  v_lshlrev_b32 v67, 16, v66
  v_max_u32 v66, v66, v67
  v_cmp_le_u32 vcc, 0xffff0000, v66
  s_cbranch_vccz cB_sc1_rk
  s_add_u32 s30, s30, 1
  s_cmp_lt_u32 s30, 400000
  s_cbranch_scc1 cB_sc1_rv
  s_branch cB_abort
cB_sc1_rk:
  s_mov_b32 s62, 1
  v_mov_b32 v36, 0
  v_mov_b32 v37, 0
  v_mov_b32 v38, 0
  v_mov_b32 v39, 0
  v_mov_b32 v40, 0
  v_mov_b32 v41, 0
  v_mov_b32 v42, 0
  v_mov_b32 v43, 0
  v_mov_b32 v44, 0
  v_mov_b32 v45, 0
  v_mov_b32 v46, 0
  v_mov_b32 v47, 0
  v_mov_b32 v48, 0
  v_mov_b32 v49, 0
  v_mov_b32 v50, 0
  v_mov_b32 v51, 0
  v_mov_b32 v60, 0
  v_mov_b32 v61, 0
  v_mov_b32 v62, 0
  v_mov_b32 v63, 0
  v_mov_b32 v68, 0
  v_mov_b32 v69, 0
  v_mov_b32 v70, 0
  v_mov_b32 v71, 0
  v_mov_b32 v72, 0
  v_mov_b32 v73, 0
  v_mov_b32 v74, 0
  v_mov_b32 v75, 0
  v_mov_b32 v52, 0
  v_mov_b32 v53, 0
  v_mov_b32 v54, 0
  v_mov_b32 v55, 0
  v_mov_b32 v56, 0
  v_mov_b32 v57, 0
  v_mov_b32 v58, 0
  v_mov_b32 v59, 0
  s_add_u32 s31, s31, 0x100
  s_nop 0
  s_branch cB_sc1_go
.p2align 6
cB_sc2_loop:
  s_mov_b32 s30, 0
  s_mov_b32 s62, 0
  s_setprio 3
  s_barrier
  buffer_load_dwordx4 v[8:11], v2, s[8:11], s20 offen offset:0 sc1
  s_setprio 2
  buffer_load_dwordx4 v[12:15], v2, s[8:11], s20 offen offset:1024 sc1
  s_setprio 1
  buffer_load_dwordx4 v[16:19], v2, s[8:11], s20 offen offset:2048 sc1
  s_setprio 0
  buffer_load_dwordx4 v[20:23], v2, s[8:11], s20 offen offset:3072 sc1
cB_sc2_go:
  s_waitcnt vmcnt(3)
  v_smfmac_f32_16x16x64_bf16 v[36:39], v[8:11], a[0:7], v3
  buffer_load_dwordx4 v[24:27], v2, s[8:11], s23 offen offset:0 sc1
  v_cmp_eq_u32 vcc, -1, v8
  v_smfmac_f32_16x16x64_bf16 v[40:43], v[8:11], a[56:63], v3
  v_smfmac_f32_16x16x64_bf16 v[44:47], v[8:11], a[112:119], v3
  buffer_load_dwordx4 v[32:35], v2, s[8:11], s23 offen offset:1024 sc1
  s_cbranch_vccnz cB_sc2_r0
  v_smfmac_f32_16x16x64_bf16 v[48:51], v[8:11], a[168:175], v3
  v_smfmac_f32_16x16x64_bf16 v[52:55], v[8:11], a[224:231], v3
  s_waitcnt vmcnt(4)
  v_cmp_eq_u32 vcc, -1, v12
  v_smfmac_f32_16x16x64_bf16 v[56:59], v[8:11], v[144:151], v3
  buffer_load_dwordx4 v[28:31], v2, s[8:11], s23 offen offset:2048 sc1
  v_smfmac_f32_16x16x64_bf16 v[62:65], v[8:11], v[200:207], v3
  s_cbranch_vccnz cB_sc2_r1
cB_sc2_c1:
  v_smfmac_f32_16x16x64_bf16 v[36:39], v[12:15], a[8:15], v3
  v_smfmac_f32_16x16x64_bf16 v[40:43], v[12:15], a[64:71], v3
  v_smfmac_f32_16x16x64_bf16 v[44:47], v[12:15], a[120:127], v3
  v_smfmac_f32_16x16x64_bf16 v[48:51], v[12:15], a[176:183], v3
  v_smfmac_f32_16x16x64_bf16 v[52:55], v[12:15], a[232:239], v3
  s_waitcnt vmcnt(4)
  v_cmp_eq_u32 vcc, -1, v16
  v_smfmac_f32_16x16x64_bf16 v[56:59], v[12:15], v[152:159], v3
  buffer_load_dwordx4 v[88:91], v117, s[8:11], s26 offen offset:0 sc1
  v_smfmac_f32_16x16x64_bf16 v[62:65], v[12:15], v[208:215], v3
  s_cbranch_vccnz cB_sc2_r2
cB_sc2_c2:
  v_smfmac_f32_16x16x64_bf16 v[36:39], v[16:19], a[16:23], v3
  v_smfmac_f32_16x16x64_bf16 v[40:43], v[16:19], a[72:79], v3
  v_smfmac_f32_16x16x64_bf16 v[44:47], v[16:19], a[128:135], v3
  buffer_load_dwordx4 v[92:95], v117, s[8:11], s26 offen offset:1024 sc1
  v_smfmac_f32_16x16x64_bf16 v[48:51], v[16:19], a[184:191], v3
  v_smfmac_f32_16x16x64_bf16 v[52:55], v[16:19], a[240:247], v3
  s_waitcnt vmcnt(5)
  v_cmp_eq_u32 vcc, -1, v20
  v_smfmac_f32_16x16x64_bf16 v[56:59], v[16:19], v[160:167], v3
  v_smfmac_f32_16x16x64_bf16 v[62:65], v[16:19], v[216:223], v3
  buffer_load_dwordx4 v[96:99], v2, s[8:11], s24 offen offset:0 sc1
  s_cbranch_vccnz cB_sc2_r3
cB_sc2_c3:
  v_smfmac_f32_16x16x64_bf16 v[36:39], v[20:23], a[24:31], v3
  v_smfmac_f32_16x16x64_bf16 v[40:43], v[20:23], a[80:87], v3
  s_waitcnt vmcnt(3)
  v_max3_u32 v66, v24, v27, v28
  v_smfmac_f32_16x16x64_bf16 v[44:47], v[20:23], a[136:143], v3
  v_max3_u32 v66, v66, v31, v32
  v_smfmac_f32_16x16x64_bf16 v[48:51], v[20:23], a[192:199], v3
  buffer_load_dwordx4 v[100:103], v2, s[8:11], s24 offen offset:1024 sc1
  v_max_u32 v66, v66, v35
  v_smfmac_f32_16x16x64_bf16 v[52:55], v[20:23], a[248:255], v3
  v_cmp_eq_u32 vcc, -1, v66
  v_smfmac_f32_16x16x64_bf16 v[56:59], v[20:23], v[168:175], v3
  v_smfmac_f32_16x16x64_bf16 v[62:65], v[20:23], v[224:231], v3
  s_cbranch_vccnz cB_sc2_r4
cB_sc2_c4:
  v_smfmac_f32_16x16x64_bf16 v[62:65], v[24:27], v[232:239], v3
  buffer_load_dwordx4 v[104:107], v2, s[8:11], s26 offen offset:0 sc1
  v_smfmac_f32_16x16x64_bf16 v[62:65], v[32:35], v[240:247], v3
  v_smfmac_f32_16x16x64_bf16 v[62:65], v[28:31], v[248:255], v3
  v_smfmac_f32_16x16x64_bf16 v[52:55], v[24:27], v[120:127], v3
  v_smfmac_f32_16x16x64_bf16 v[52:55], v[32:35], v[128:135], v3
  buffer_load_dwordx4 v[108:111], v2, s[8:11], s26 offen offset:1024 sc1
  v_smfmac_f32_16x16x64_bf16 v[52:55], v[28:31], v[136:143], v3
  v_cvt_pk_bf16_f32 v62, v62, v63
  v_smfmac_f32_16x16x64_bf16 v[56:59], v[24:27], v[176:183], v3
  v_cvt_pk_bf16_f32 v63, v64, v65
  v_smfmac_f32_16x16x64_bf16 v[56:59], v[32:35], v[184:191], v3
  v_mfma_f32_16x16x32_bf16 v[8:11], v[60:63], v[4:7], 0
  v_cvt_pk_bf16_f32 v55, v54, v55
  v_smfmac_f32_16x16x64_bf16 v[56:59], v[28:31], v[192:199], v3
  v_cvt_pk_bf16_f32 v54, v52, v53
  v_smfmac_f32_16x16x64_bf16 v[36:39], v[24:27], a[32:39], v3
  s_nop 1
  v_cvt_pk_bf16_f32 v76, v8, v9
  v_smfmac_f32_16x16x64_bf16 v[36:39], v[32:35], a[40:47], v3
  v_cvt_pk_bf16_f32 v77, v10, v11
  v_smfmac_f32_16x16x64_bf16 v[36:39], v[28:31], a[48:55], v3
  v_cvt_pk_bf16_f32 v56, v56, v57
  v_smfmac_f32_16x16x64_bf16 v[40:43], v[24:27], a[88:95], v3
  v_cvt_pk_bf16_f32 v57, v58, v59
  v_smfmac_f32_16x16x64_bf16 v[40:43], v[32:35], a[96:103], v3
  v_mfma_f32_16x16x32_bf16 v[12:15], v[54:57], v[4:7], 0
  v_cvt_pk_bf16_f32 v39, v38, v39
  v_smfmac_f32_16x16x64_bf16 v[40:43], v[28:31], a[104:111], v3
  v_cvt_pk_bf16_f32 v38, v36, v37
  v_smfmac_f32_16x16x64_bf16 v[44:47], v[24:27], a[144:151], v3
  s_nop 1
  v_cvt_pk_bf16_f32 v78, v12, v13
  v_smfmac_f32_16x16x64_bf16 v[44:47], v[32:35], a[152:159], v3
  v_cvt_pk_bf16_f32 v79, v14, v15
  v_smfmac_f32_16x16x64_bf16 v[44:47], v[28:31], a[160:167], v3
  v_cvt_pk_bf16_f32 v40, v40, v41
  v_smfmac_f32_16x16x64_bf16 v[48:51], v[24:27], a[200:207], v3
  v_cvt_pk_bf16_f32 v41, v42, v43
  v_smfmac_f32_16x16x64_bf16 v[48:51], v[32:35], a[208:215], v3
  v_smfmac_f32_16x16x64_bf16 v[48:51], v[28:31], a[216:223], v3
  s_waitcnt vmcnt(4)
  v_cvt_pk_bf16_f32 v47, v46, v47
  v_smfmac_f32_16x16x64_bf16 v[68:71], v[76:79], v[80:87], v3
  v_cvt_pk_bf16_f32 v46, v44, v45
  v_mfma_f32_16x16x32_bf16 v[8:11], v[38:41], v[4:7], 0
  s_nop 1
  v_cvt_pk_bf16_f32 v48, v48, v49
  v_cvt_pk_bf16_f32 v49, v50, v51
  s_nop 1
  v_mfma_f32_16x16x32_bf16 v[12:15], v[46:49], v[4:7], 0
  v_smfmac_f32_16x16x64_bf16 v[72:75], v[76:79], v[88:95], v3
  v_cvt_pk_bf16_f32 v20, v8, v9
  v_mfma_f32_16x16x32_bf16 v[52:55], v[30:33], v[76:79], 0
  s_waitcnt vmcnt(0)
  v_cvt_pk_bf16_f32 v21, v10, v11
  v_cvt_pk_bf16_f32 v22, v12, v13
  v_cvt_pk_bf16_f32 v23, v14, v15
  s_nop 1
  v_mfma_f32_16x16x32_bf16 v[52:55], v[16:19], v[20:23], v[52:55]
  v_smfmac_f32_16x16x64_bf16 v[68:71], v[20:23], v[96:103], v3
  v_smfmac_f32_16x16x64_bf16 v[72:75], v[20:23], v[104:111], v3
  s_nop 1
  ds_write_b128 v113, v[52:55]
  s_nop 1
  v_permlane32_swap_b32 v68, v70
  v_permlane32_swap_b32 v69, v71
  v_add_f32 v56, v68, v70
  v_add_f32 v58, v69, v71
  v_permlane32_swap_b32 v72, v74
  v_permlane32_swap_b32 v73, v75
  v_add_f32 v57, v72, v74
  v_add_f32 v59, v73, v75
  ds_write_b128 v2, v[56:59] offset:2048
  v_cmp_u_f32 vcc, v57, v59
  v_mov_b32 v68, 0
  v_mov_b32 v69, 0
  v_mov_b32 v70, 0
  v_mov_b32 v71, 0
  s_cbranch_vccnz cB_sc2_retry
cB_sc2_cont:
  s_add_u32 s24, s24, 28672
  s_add_u32 s26, s26, 28672
  buffer_load_dwordx4 v[80:83], v117, s[8:11], s24 offen offset:0 sc1
  buffer_load_dwordx4 v[84:87], v117, s[8:11], s24 offen offset:1024 sc1
  v_mov_b32 v72, 0
  v_mov_b32 v73, 0
  v_mfma_f32_32x32x16_bf16 v[36:51], v[68:71], v[68:71], 0
  s_waitcnt lgkmcnt(0)
  s_barrier
  v_mfma_f32_32x32x16_bf16 v[52:67], v[68:71], v[68:71], 0
  buffer_store_dwordx2 v[118:119], v114, s[8:11], s21 offen sc1
  buffer_store_dwordx2 v[118:119], v115, s[8:11], s21 offen sc1
  s_buffer_load_dword s70, s[8:11], s35
  s_add_u32 s22, s24, 114688
  s_buffer_load_dword s71, s[8:11], s22
  s_mul_i32 s22, s18, 7168
  s_add_u32 s22, s22, 88024064
  s_buffer_load_dword s72, s[8:11], s22
  s_add_u32 s35, s35, 458752
  v_mov_b32 v74, 0
  v_mov_b32 v75, 0
  s_mov_b32 s19, s18
  s_add_u32 s18, s18, 1
  s_mov_b32 s22, s20
  s_mov_b32 s20, s21
  s_mov_b32 s21, s22
  s_add_u32 s23, s20, 4096
  s_cmp_lt_u32 s19, 63
  s_cbranch_scc1 cB_sc2_loop
  s_branch cB_done
cB_sc2_r0:
  s_add_u32 s31, s31, 1
  buffer_load_dwordx4 v[8:11], v2, s[8:11], s20 offen offset:0 sc1
  s_waitcnt vmcnt(0)
  v_cmp_eq_u32 vcc, -1, v8
  v_mov_b32 v36, 0
  v_mov_b32 v37, 0
  v_mov_b32 v38, 0
  v_mov_b32 v39, 0
  v_mov_b32 v40, 0
  v_mov_b32 v41, 0
  v_mov_b32 v42, 0
  v_mov_b32 v43, 0
  v_mov_b32 v44, 0
  v_mov_b32 v45, 0
  v_mov_b32 v46, 0
  v_mov_b32 v47, 0
  v_mov_b32 v48, 0
  v_mov_b32 v49, 0
  v_mov_b32 v50, 0
  v_mov_b32 v51, 0
  s_nop 1
  s_cbranch_vccz cB_sc2_go
  s_add_u32 s30, s30, 1
  s_cmp_lt_u32 s30, 400000
  s_cbranch_scc1 cB_sc2_r0
  s_branch cB_abort
cB_sc2_r1:
  s_add_u32 s31, s31, 1
  buffer_load_dwordx4 v[12:15], v2, s[8:11], s20 offen offset:1024 sc1
  s_waitcnt vmcnt(0)
  v_cmp_eq_u32 vcc, -1, v12
  s_nop 4
  s_cbranch_vccz cB_sc2_c1
  s_add_u32 s30, s30, 1
  s_cmp_lt_u32 s30, 400000
  s_cbranch_scc1 cB_sc2_r1
  s_branch cB_abort
cB_sc2_r2:
  s_add_u32 s31, s31, 1
  buffer_load_dwordx4 v[16:19], v2, s[8:11], s20 offen offset:2048 sc1
  s_waitcnt vmcnt(0)
  v_cmp_eq_u32 vcc, -1, v16
  s_nop 4
  s_cbranch_vccz cB_sc2_c2
  s_add_u32 s30, s30, 1
  s_cmp_lt_u32 s30, 400000
  s_cbranch_scc1 cB_sc2_r2
  s_branch cB_abort
cB_sc2_r3:
  s_add_u32 s31, s31, 1
  buffer_load_dwordx4 v[20:23], v2, s[8:11], s20 offen offset:3072 sc1
  s_waitcnt vmcnt(0)
  v_cmp_eq_u32 vcc, -1, v20
  s_nop 4
  s_cbranch_vccz cB_sc2_c3
  s_add_u32 s30, s30, 1
  s_cmp_lt_u32 s30, 400000
  s_cbranch_scc1 cB_sc2_r3
  s_branch cB_abort
cB_sc2_r4:
  s_add_u32 s31, s31, 1
  buffer_load_dwordx4 v[24:27], v2, s[8:11], s23 offen offset:0 sc1
  buffer_load_dwordx4 v[32:35], v2, s[8:11], s23 offen offset:1024 sc1
  buffer_load_dwordx4 v[28:31], v2, s[8:11], s23 offen offset:2048 sc1
  s_waitcnt vmcnt(0)
  v_max3_u32 v66, v24, v27, v28
  v_max3_u32 v66, v66, v31, v32
  v_max_u32 v66, v66, v35
  v_cmp_eq_u32 vcc, -1, v66
  s_nop 4
  s_cbranch_vccz cB_sc2_c4
  s_add_u32 s30, s30, 1
  s_cmp_lt_u32 s30, 400000
  s_cbranch_scc1 cB_sc2_r4
  s_branch cB_abort
cB_sc2_retry:
  s_cmp_lg_u32 s62, 0
  s_cbranch_scc1 cB_sc2_cont
  s_waitcnt vmcnt(0) lgkmcnt(0)
cB_sc2_rv:
  buffer_load_dwordx4 v[8:11], v2, s[8:11], s20 offen offset:0 sc1
  buffer_load_dwordx4 v[12:15], v2, s[8:11], s20 offen offset:1024 sc1
  buffer_load_dwordx4 v[16:19], v2, s[8:11], s20 offen offset:2048 sc1
  buffer_load_dwordx4 v[20:23], v2, s[8:11], s20 offen offset:3072 sc1
  buffer_load_dwordx4 v[24:27], v2, s[8:11], s23 offen offset:0 sc1
  buffer_load_dwordx4 v[32:35], v2, s[8:11], s23 offen offset:1024 sc1
  buffer_load_dwordx4 v[28:31], v2, s[8:11], s23 offen offset:2048 sc1
  s_waitcnt vmcnt(0)
  v_pk_max_u16 v66, v8, v9
  v_pk_max_u16 v66, v66, v10
  v_pk_max_u16 v66, v66, v11
  v_pk_max_u16 v66, v66, v12
  v_pk_max_u16 v66, v66, v13
  v_pk_max_u16 v66, v66, v14
  v_pk_max_u16 v66, v66, v15
  v_pk_max_u16 v66, v66, v16
  v_pk_max_u16 v66, v66, v17
  v_pk_max_u16 v66, v66, v18
  v_pk_max_u16 v66, v66, v19
  v_pk_max_u16 v66, v66, v20
  v_pk_max_u16 v66, v66, v21
  v_pk_max_u16 v66, v66, v22
  v_pk_max_u16 v66, v66, v23
  v_pk_max_u16 v66, v66, v24
  v_pk_max_u16 v66, v66, v25
  v_pk_max_u16 v66, v66, v26
  v_pk_max_u16 v66, v66, v27
  v_pk_max_u16 v66, v66, v28
  v_pk_max_u16 v66, v66, v29
  v_pk_max_u16 v66, v66, v30
  v_pk_max_u16 v66, v66, v31
  v_pk_max_u16 v66, v66, v32
  v_pk_max_u16 v66, v66, v33
  v_pk_max_u16 v66, v66, v34
  v_pk_max_u16 v66, v66, v35
  v_lshlrev_b32 v67, 16, v66
  v_max_u32 v66, v66, v67
  v_cmp_le_u32 vcc, 0xffff0000, v66
  s_cbranch_vccz cB_sc2_rk
  s_add_u32 s30, s30, 1
  s_cmp_lt_u32 s30, 400000
  s_cbranch_scc1 cB_sc2_rv
  s_branch cB_abort
cB_sc2_rk:
  s_mov_b32 s62, 1
  v_mov_b32 v36, 0
  v_mov_b32 v37, 0
  v_mov_b32 v38, 0
  v_mov_b32 v39, 0
  v_mov_b32 v40, 0
  v_mov_b32 v41, 0
  v_mov_b32 v42, 0
  v_mov_b32 v43, 0
  v_mov_b32 v44, 0
  v_mov_b32 v45, 0
  v_mov_b32 v46, 0
  v_mov_b32 v47, 0
  v_mov_b32 v48, 0
  v_mov_b32 v49, 0
  v_mov_b32 v50, 0
  v_mov_b32 v51, 0
  v_mov_b32 v62, 0
  v_mov_b32 v63, 0
  v_mov_b32 v64, 0
  v_mov_b32 v65, 0
  v_mov_b32 v68, 0
  v_mov_b32 v69, 0
  v_mov_b32 v70, 0
  v_mov_b32 v71, 0
  v_mov_b32 v72, 0
  v_mov_b32 v73, 0
  v_mov_b32 v74, 0
  v_mov_b32 v75, 0
  v_mov_b32 v52, 0
  v_mov_b32 v53, 0
  v_mov_b32 v54, 0
  v_mov_b32 v55, 0
  v_mov_b32 v56, 0
  v_mov_b32 v57, 0
  v_mov_b32 v58, 0
  v_mov_b32 v59, 0
  s_add_u32 s31, s31, 0x100
  s_nop 0
  s_branch cB_sc2_go
.p2align 6
cB_sc3_loop:
  s_mov_b32 s30, 0
  s_mov_b32 s62, 0
  s_setprio 3
  s_barrier
  buffer_load_dwordx4 v[8:11], v2, s[8:11], s20 offen offset:0 sc1
  s_setprio 2
  buffer_load_dwordx4 v[12:15], v2, s[8:11], s20 offen offset:1024 sc1
  s_setprio 1
  buffer_load_dwordx4 v[16:19], v2, s[8:11], s20 offen offset:2048 sc1
  s_setprio 0
  buffer_load_dwordx4 v[20:23], v2, s[8:11], s20 offen offset:3072 sc1
cB_sc3_go:
  s_waitcnt vmcnt(3)
  v_smfmac_f32_16x16x64_bf16 v[36:39], v[8:11], a[0:7], v3
  buffer_load_dwordx4 v[24:27], v2, s[8:11], s23 offen offset:0 sc1
  v_cmp_eq_u32 vcc, -1, v8
  v_smfmac_f32_16x16x64_bf16 v[40:43], v[8:11], a[56:63], v3
  v_smfmac_f32_16x16x64_bf16 v[44:47], v[8:11], a[112:119], v3
  buffer_load_dwordx4 v[28:31], v2, s[8:11], s23 offen offset:1024 sc1
  s_cbranch_vccnz cB_sc3_r0
  v_smfmac_f32_16x16x64_bf16 v[48:51], v[8:11], a[168:175], v3
  v_smfmac_f32_16x16x64_bf16 v[52:55], v[8:11], a[224:231], v3
  s_waitcnt vmcnt(4)
  v_cmp_eq_u32 vcc, -1, v12
  v_smfmac_f32_16x16x64_bf16 v[56:59], v[8:11], v[144:151], v3
  buffer_load_dwordx4 v[32:35], v2, s[8:11], s23 offen offset:2048 sc1
  v_smfmac_f32_16x16x64_bf16 v[62:65], v[8:11], v[200:207], v3
  s_cbranch_vccnz cB_sc3_r1
cB_sc3_c1:
  v_smfmac_f32_16x16x64_bf16 v[36:39], v[12:15], a[8:15], v3
  v_smfmac_f32_16x16x64_bf16 v[40:43], v[12:15], a[64:71], v3
  v_smfmac_f32_16x16x64_bf16 v[44:47], v[12:15], a[120:127], v3
  v_smfmac_f32_16x16x64_bf16 v[48:51], v[12:15], a[176:183], v3
  v_smfmac_f32_16x16x64_bf16 v[52:55], v[12:15], a[232:239], v3
  s_waitcnt vmcnt(4)
  v_cmp_eq_u32 vcc, -1, v16
  v_smfmac_f32_16x16x64_bf16 v[56:59], v[12:15], v[152:159], v3
  buffer_load_dwordx4 v[88:91], v117, s[8:11], s26 offen offset:0 sc1
  v_smfmac_f32_16x16x64_bf16 v[62:65], v[12:15], v[208:215], v3
  s_cbranch_vccnz cB_sc3_r2
cB_sc3_c2:
  v_smfmac_f32_16x16x64_bf16 v[36:39], v[16:19], a[16:23], v3
  v_smfmac_f32_16x16x64_bf16 v[40:43], v[16:19], a[72:79], v3
  v_smfmac_f32_16x16x64_bf16 v[44:47], v[16:19], a[128:135], v3
  buffer_load_dwordx4 v[92:95], v117, s[8:11], s26 offen offset:1024 sc1
  v_smfmac_f32_16x16x64_bf16 v[48:51], v[16:19], a[184:191], v3
  v_smfmac_f32_16x16x64_bf16 v[52:55], v[16:19], a[240:247], v3
  s_waitcnt vmcnt(5)
  v_cmp_eq_u32 vcc, -1, v20
  v_smfmac_f32_16x16x64_bf16 v[56:59], v[16:19], v[160:167], v3
  v_smfmac_f32_16x16x64_bf16 v[62:65], v[16:19], v[216:223], v3
  buffer_load_dwordx4 v[96:99], v2, s[8:11], s24 offen offset:0 sc1
  s_cbranch_vccnz cB_sc3_r3
cB_sc3_c3:
  v_smfmac_f32_16x16x64_bf16 v[36:39], v[20:23], a[24:31], v3
  v_smfmac_f32_16x16x64_bf16 v[40:43], v[20:23], a[80:87], v3
  s_waitcnt vmcnt(3)
  v_max3_u32 v66, v24, v27, v28
  v_smfmac_f32_16x16x64_bf16 v[44:47], v[20:23], a[136:143], v3
  v_max3_u32 v66, v66, v31, v32
  v_smfmac_f32_16x16x64_bf16 v[48:51], v[20:23], a[192:199], v3
  buffer_load_dwordx4 v[100:103], v2, s[8:11], s24 offen offset:1024 sc1
  v_max_u32 v66, v66, v35
  v_smfmac_f32_16x16x64_bf16 v[52:55], v[20:23], a[248:255], v3
  v_cmp_eq_u32 vcc, -1, v66
  v_smfmac_f32_16x16x64_bf16 v[56:59], v[20:23], v[168:175], v3
  v_smfmac_f32_16x16x64_bf16 v[62:65], v[20:23], v[224:231], v3
  s_cbranch_vccnz cB_sc3_r4
cB_sc3_c4:
  v_smfmac_f32_16x16x64_bf16 v[62:65], v[24:27], v[232:239], v3
  buffer_load_dwordx4 v[104:107], v2, s[8:11], s26 offen offset:0 sc1
  v_smfmac_f32_16x16x64_bf16 v[62:65], v[28:31], v[240:247], v3
  v_smfmac_f32_16x16x64_bf16 v[62:65], v[32:35], v[248:255], v3
  v_smfmac_f32_16x16x64_bf16 v[52:55], v[24:27], v[120:127], v3
  v_smfmac_f32_16x16x64_bf16 v[52:55], v[28:31], v[128:135], v3
  buffer_load_dwordx4 v[108:111], v2, s[8:11], s26 offen offset:1024 sc1
  v_smfmac_f32_16x16x64_bf16 v[52:55], v[32:35], v[136:143], v3
  v_cvt_pk_bf16_f32 v62, v62, v63
  v_smfmac_f32_16x16x64_bf16 v[56:59], v[24:27], v[176:183], v3
  v_cvt_pk_bf16_f32 v63, v64, v65
  v_smfmac_f32_16x16x64_bf16 v[56:59], v[28:31], v[184:191], v3
  v_mfma_f32_16x16x32_bf16 v[8:11], v[60:63], v[4:7], 0
  v_cvt_pk_bf16_f32 v55, v54, v55
  v_smfmac_f32_16x16x64_bf16 v[56:59], v[32:35], v[192:199], v3
  v_cvt_pk_bf16_f32 v54, v52, v53
  v_smfmac_f32_16x16x64_bf16 v[36:39], v[24:27], a[32:39], v3
  s_nop 1
  v_cvt_pk_bf16_f32 v78, v8, v9
  v_smfmac_f32_16x16x64_bf16 v[36:39], v[28:31], a[40:47], v3
  v_cvt_pk_bf16_f32 v79, v10, v11
  v_smfmac_f32_16x16x64_bf16 v[36:39], v[32:35], a[48:55], v3
  v_cvt_pk_bf16_f32 v56, v56, v57
  v_smfmac_f32_16x16x64_bf16 v[40:43], v[24:27], a[88:95], v3
  v_cvt_pk_bf16_f32 v57, v58, v59
  v_smfmac_f32_16x16x64_bf16 v[40:43], v[28:31], a[96:103], v3
  v_mfma_f32_16x16x32_bf16 v[12:15], v[54:57], v[4:7], 0
  v_cvt_pk_bf16_f32 v39, v38, v39
  v_smfmac_f32_16x16x64_bf16 v[40:43], v[32:35], a[104:111], v3
  v_cvt_pk_bf16_f32 v38, v36, v37
  v_smfmac_f32_16x16x64_bf16 v[44:47], v[24:27], a[144:151], v3
  s_nop 1
  v_cvt_pk_bf16_f32 v76, v12, v13
  v_smfmac_f32_16x16x64_bf16 v[44:47], v[28:31], a[152:159], v3
  v_cvt_pk_bf16_f32 v77, v14, v15
  v_smfmac_f32_16x16x64_bf16 v[44:47], v[32:35], a[160:167], v3
  v_cvt_pk_bf16_f32 v40, v40, v41
  v_smfmac_f32_16x16x64_bf16 v[48:51], v[24:27], a[200:207], v3
  v_cvt_pk_bf16_f32 v41, v42, v43
  v_smfmac_f32_16x16x64_bf16 v[48:51], v[28:31], a[208:215], v3
  v_smfmac_f32_16x16x64_bf16 v[48:51], v[32:35], a[216:223], v3
  s_waitcnt vmcnt(4)
  v_cvt_pk_bf16_f32 v47, v46, v47
  v_smfmac_f32_16x16x64_bf16 v[68:71], v[76:79], v[80:87], v3
  v_cvt_pk_bf16_f32 v46, v44, v45
  v_mfma_f32_16x16x32_bf16 v[8:11], v[38:41], v[4:7], 0
  s_nop 1
  v_cvt_pk_bf16_f32 v48, v48, v49
  v_cvt_pk_bf16_f32 v49, v50, v51
  s_nop 1
  v_mfma_f32_16x16x32_bf16 v[12:15], v[46:49], v[4:7], 0
  v_smfmac_f32_16x16x64_bf16 v[72:75], v[76:79], v[88:95], v3
  v_cvt_pk_bf16_f32 v16, v8, v9
  v_mfma_f32_16x16x32_bf16 v[52:55], v[30:33], v[76:79], 0
  s_waitcnt vmcnt(0)
  v_cvt_pk_bf16_f32 v17, v10, v11
  v_cvt_pk_bf16_f32 v18, v12, v13
  v_cvt_pk_bf16_f32 v19, v14, v15
  s_nop 1
  v_mfma_f32_16x16x32_bf16 v[52:55], v[20:23], v[16:19], v[52:55]
  v_smfmac_f32_16x16x64_bf16 v[68:71], v[16:19], v[96:103], v3
  v_smfmac_f32_16x16x64_bf16 v[72:75], v[16:19], v[104:111], v3
  s_nop 1
  ds_write_b128 v113, v[52:55]
  s_nop 1
  v_permlane32_swap_b32 v68, v70
  v_permlane32_swap_b32 v69, v71
  v_add_f32 v56, v68, v70
  v_add_f32 v58, v69, v71
  v_permlane32_swap_b32 v72, v74
  v_permlane32_swap_b32 v73, v75
  v_add_f32 v57, v72, v74
  v_add_f32 v59, v73, v75
  ds_write_b128 v2, v[56:59] offset:3072
  v_cmp_u_f32 vcc, v57, v59
  v_mov_b32 v68, 0
  v_mov_b32 v69, 0
  v_mov_b32 v70, 0
  v_mov_b32 v71, 0
  s_cbranch_vccnz cB_sc3_retry
cB_sc3_cont:
  s_add_u32 s24, s24, 28672
  s_add_u32 s26, s26, 28672
  buffer_load_dwordx4 v[80:83], v117, s[8:11], s24 offen offset:0 sc1
  buffer_load_dwordx4 v[84:87], v117, s[8:11], s24 offen offset:1024 sc1
  v_mov_b32 v72, 0
  v_mov_b32 v73, 0
  v_mfma_f32_16x16x32_bf16 v[62:65], v[68:71], v[68:71], 0
  s_waitcnt lgkmcnt(0)
  s_barrier
  v_mov_b32 v52, 0
  v_mov_b32 v53, 0
  v_mov_b32 v54, 0
  v_mov_b32 v55, 0
  v_mov_b32 v56, 0
  v_mov_b32 v57, 0
  v_mov_b32 v58, 0
  v_mov_b32 v59, 0
  v_mfma_f32_32x32x16_bf16 v[36:51], v[68:71], v[68:71], 0
  v_mov_b32 v74, 0
  v_mov_b32 v75, 0
  s_mov_b32 s19, s18
  s_add_u32 s18, s18, 1
  s_mov_b32 s22, s20
  s_mov_b32 s20, s21
  s_mov_b32 s21, s22
  s_add_u32 s23, s20, 4096
  s_cmp_lt_u32 s19, 63
  s_nop 2
  s_cbranch_scc1 cB_sc3_loop
  s_branch cB_done
cB_sc3_r0:
  s_add_u32 s31, s31, 1
  buffer_load_dwordx4 v[8:11], v2, s[8:11], s20 offen offset:0 sc1
  s_waitcnt vmcnt(0)
  v_cmp_eq_u32 vcc, -1, v8
  v_mov_b32 v36, 0
  v_mov_b32 v37, 0
  v_mov_b32 v38, 0
  v_mov_b32 v39, 0
  v_mov_b32 v40, 0
  v_mov_b32 v41, 0
  v_mov_b32 v42, 0
  v_mov_b32 v43, 0
  v_mov_b32 v44, 0
  v_mov_b32 v45, 0
  v_mov_b32 v46, 0
  v_mov_b32 v47, 0
  v_mov_b32 v48, 0
  v_mov_b32 v49, 0
  v_mov_b32 v50, 0
  v_mov_b32 v51, 0
  s_nop 1
  s_cbranch_vccz cB_sc3_go
  s_add_u32 s30, s30, 1
  s_cmp_lt_u32 s30, 400000
  s_cbranch_scc1 cB_sc3_r0
  s_branch cB_abort
cB_sc3_r1:
  s_add_u32 s31, s31, 1
  buffer_load_dwordx4 v[12:15], v2, s[8:11], s20 offen offset:1024 sc1
  s_waitcnt vmcnt(0)
  v_cmp_eq_u32 vcc, -1, v12
  s_nop 4
  s_cbranch_vccz cB_sc3_c1
  s_add_u32 s30, s30, 1
  s_cmp_lt_u32 s30, 400000
  s_cbranch_scc1 cB_sc3_r1
  s_branch cB_abort
cB_sc3_r2:
  s_add_u32 s31, s31, 1
  buffer_load_dwordx4 v[16:19], v2, s[8:11], s20 offen offset:2048 sc1
  s_waitcnt vmcnt(0)
  v_cmp_eq_u32 vcc, -1, v16
  s_nop 4
  s_cbranch_vccz cB_sc3_c2
  s_add_u32 s30, s30, 1
  s_cmp_lt_u32 s30, 400000
  s_cbranch_scc1 cB_sc3_r2
  s_branch cB_abort
cB_sc3_r3:
  s_add_u32 s31, s31, 1
  buffer_load_dwordx4 v[20:23], v2, s[8:11], s20 offen offset:3072 sc1
  s_waitcnt vmcnt(0)
  v_cmp_eq_u32 vcc, -1, v20
  s_nop 4
  s_cbranch_vccz cB_sc3_c3
  s_add_u32 s30, s30, 1
  s_cmp_lt_u32 s30, 400000
  s_cbranch_scc1 cB_sc3_r3
  s_branch cB_abort
cB_sc3_r4:
  s_add_u32 s31, s31, 1
  buffer_load_dwordx4 v[24:27], v2, s[8:11], s23 offen offset:0 sc1
  buffer_load_dwordx4 v[28:31], v2, s[8:11], s23 offen offset:1024 sc1
  buffer_load_dwordx4 v[32:35], v2, s[8:11], s23 offen offset:2048 sc1
  s_waitcnt vmcnt(0)
  v_max3_u32 v66, v24, v27, v28
  v_max3_u32 v66, v66, v31, v32
  v_max_u32 v66, v66, v35
  v_cmp_eq_u32 vcc, -1, v66
  s_nop 4
  s_cbranch_vccz cB_sc3_c4
  s_add_u32 s30, s30, 1
  s_cmp_lt_u32 s30, 400000
  s_cbranch_scc1 cB_sc3_r4
  s_branch cB_abort
cB_sc3_retry:
  s_cmp_lg_u32 s62, 0
  s_cbranch_scc1 cB_sc3_cont
  s_waitcnt vmcnt(0) lgkmcnt(0)
cB_sc3_rv:
  buffer_load_dwordx4 v[8:11], v2, s[8:11], s20 offen offset:0 sc1
  buffer_load_dwordx4 v[12:15], v2, s[8:11], s20 offen offset:1024 sc1
  buffer_load_dwordx4 v[16:19], v2, s[8:11], s20 offen offset:2048 sc1
  buffer_load_dwordx4 v[20:23], v2, s[8:11], s20 offen offset:3072 sc1
  buffer_load_dwordx4 v[24:27], v2, s[8:11], s23 offen offset:0 sc1
  buffer_load_dwordx4 v[28:31], v2, s[8:11], s23 offen offset:1024 sc1
  buffer_load_dwordx4 v[32:35], v2, s[8:11], s23 offen offset:2048 sc1
  s_waitcnt vmcnt(0)
  v_pk_max_u16 v66, v8, v9
  v_pk_max_u16 v66, v66, v10
  v_pk_max_u16 v66, v66, v11
  v_pk_max_u16 v66, v66, v12
  v_pk_max_u16 v66, v66, v13
  v_pk_max_u16 v66, v66, v14
  v_pk_max_u16 v66, v66, v15
  v_pk_max_u16 v66, v66, v16
  v_pk_max_u16 v66, v66, v17
  v_pk_max_u16 v66, v66, v18
  v_pk_max_u16 v66, v66, v19
  v_pk_max_u16 v66, v66, v20
  v_pk_max_u16 v66, v66, v21
  v_pk_max_u16 v66, v66, v22
  v_pk_max_u16 v66, v66, v23
  v_pk_max_u16 v66, v66, v24
  v_pk_max_u16 v66, v66, v25
  v_pk_max_u16 v66, v66, v26
  v_pk_max_u16 v66, v66, v27
  v_pk_max_u16 v66, v66, v28
  v_pk_max_u16 v66, v66, v29
  v_pk_max_u16 v66, v66, v30
  v_pk_max_u16 v66, v66, v31
  v_pk_max_u16 v66, v66, v32
  v_pk_max_u16 v66, v66, v33
  v_pk_max_u16 v66, v66, v34
  v_pk_max_u16 v66, v66, v35
  v_lshlrev_b32 v67, 16, v66
  v_max_u32 v66, v66, v67
  v_cmp_le_u32 vcc, 0xffff0000, v66
  s_cbranch_vccz cB_sc3_rk
  s_add_u32 s30, s30, 1
  s_cmp_lt_u32 s30, 400000
  s_cbranch_scc1 cB_sc3_rv
  s_branch cB_abort
cB_sc3_rk:
  s_mov_b32 s62, 1
  v_mov_b32 v36, 0
  v_mov_b32 v37, 0
  v_mov_b32 v38, 0
  v_mov_b32 v39, 0
  v_mov_b32 v40, 0
  v_mov_b32 v41, 0
  v_mov_b32 v42, 0
  v_mov_b32 v43, 0
  v_mov_b32 v44, 0
  v_mov_b32 v45, 0
  v_mov_b32 v46, 0
  v_mov_b32 v47, 0
  v_mov_b32 v48, 0
  v_mov_b32 v49, 0
  v_mov_b32 v50, 0
  v_mov_b32 v51, 0
  v_mov_b32 v62, 0
  v_mov_b32 v63, 0
  v_mov_b32 v64, 0
  v_mov_b32 v65, 0
  v_mov_b32 v68, 0
  v_mov_b32 v69, 0
  v_mov_b32 v70, 0
  v_mov_b32 v71, 0
  v_mov_b32 v72, 0
  v_mov_b32 v73, 0
  v_mov_b32 v74, 0
  v_mov_b32 v75, 0
  v_mov_b32 v52, 0
  v_mov_b32 v53, 0
  v_mov_b32 v54, 0
  v_mov_b32 v55, 0
  v_mov_b32 v56, 0
  v_mov_b32 v57, 0
  v_mov_b32 v58, 0
  v_mov_b32 v59, 0
  s_add_u32 s31, s31, 0x100
  s_nop 0
  s_branch cB_sc3_go
.p2align 6
cB_va0_loop:
  s_mov_b32 s30, 0
  s_barrier
  buffer_load_dwordx4 v[24:27], v2, s[8:11], s23 offen offset:0 sc1
  buffer_load_dwordx4 v[28:31], v2, s[8:11], s23 offen offset:1024 sc1
  s_barrier
  buffer_store_dword v160, v1, s[8:11], s38 offen sc1
  s_add_u32 s22, s25, 0
  buffer_load_dwordx4 v[80:83], v6, s[8:11], s22 offen offset:0 sc1
  buffer_load_dwordx4 v[84:87], v6, s[8:11], s22 offen offset:1792 sc1
  s_add_u32 s22, s25, 3584
  buffer_load_dwordx4 v[88:91], v6, s[8:11], s22 offen offset:0 sc1
  buffer_load_dwordx4 v[92:95], v6, s[8:11], s22 offen offset:1792 sc1
  s_add_u32 s22, s25, 7168
  buffer_load_dwordx4 v[96:99], v6, s[8:11], s22 offen offset:0 sc1
  s_mul_i32 s38, s18, 7168
  s_add_u32 s38, s38, 88002560
  s_waitcnt vmcnt(6)
  ds_write_b128 v2, v[24:27] offset:12288
  ds_write_b128 v2, v[28:31] offset:13312
  v_smfmac_f32_16x16x64_bf16 v[36:39], v[24:27], a[32:39], v3
  buffer_load_dwordx4 v[100:103], v6, s[8:11], s22 offen offset:1792 sc1
  v_smfmac_f32_16x16x64_bf16 v[40:43], v[24:27], a[88:95], v3
  s_add_u32 s22, s25, 10752
  buffer_load_dwordx4 v[104:107], v6, s[8:11], s22 offen offset:0 sc1
  v_smfmac_f32_16x16x64_bf16 v[44:47], v[24:27], a[144:151], v3
  buffer_load_dwordx4 v[108:111], v6, s[8:11], s22 offen offset:1792 sc1
  v_smfmac_f32_16x16x64_bf16 v[48:51], v[24:27], a[200:207], v3
  s_add_u32 s22, s25, 14336
  buffer_load_dwordx4 v[112:115], v6, s[8:11], s22 offen offset:0 sc1
  v_smfmac_f32_16x16x64_bf16 v[52:55], v[24:27], v[176:183], v3
  s_waitcnt lgkmcnt(0)
  s_barrier
  ds_read_b128 v[8:11], v2 offset:8192
  ds_read_b128 v[12:15], v2 offset:9216
  ds_read_b128 v[16:19], v2 offset:10240
  ds_read_b128 v[20:23], v2 offset:11264
  ds_read_b128 v[32:35], v2 offset:14336
  buffer_load_dwordx4 v[116:119], v6, s[8:11], s22 offen offset:1792 sc1
  v_smfmac_f32_16x16x64_bf16 v[56:59], v[24:27], v[232:239], v3
  s_add_u32 s22, s25, 17920
  buffer_load_dwordx4 v[120:123], v6, s[8:11], s22 offen offset:0 sc1
  v_smfmac_f32_16x16x64_bf16 v[36:39], v[28:31], a[40:47], v3
  buffer_load_dwordx4 v[124:127], v6, s[8:11], s22 offen offset:1792 sc1
  v_smfmac_f32_16x16x64_bf16 v[40:43], v[28:31], a[96:103], v3
  s_add_u32 s22, s25, 21504
  buffer_load_dwordx4 v[128:131], v6, s[8:11], s22 offen offset:0 sc1
  v_smfmac_f32_16x16x64_bf16 v[44:47], v[28:31], a[152:159], v3
  buffer_load_dwordx4 v[132:135], v6, s[8:11], s22 offen offset:1792 sc1
  v_smfmac_f32_16x16x64_bf16 v[48:51], v[28:31], a[208:215], v3
  s_add_u32 s22, s25, 25088
  buffer_load_dwordx4 v[136:139], v6, s[8:11], s22 offen offset:0 sc1
  v_smfmac_f32_16x16x64_bf16 v[52:55], v[28:31], v[184:191], v3
  ds_read_b128 v[64:67], v0 offset:0
  ds_read_b128 v[68:71], v0 offset:1024
  buffer_load_dwordx4 v[140:143], v6, s[8:11], s22 offen offset:1792 sc1
  v_smfmac_f32_16x16x64_bf16 v[56:59], v[28:31], v[240:247], v3
  s_waitcnt lgkmcnt(6)
  ds_read_b128 v[72:75], v0 offset:2048
  ds_read_b128 v[76:79], v0 offset:3072
  v_smfmac_f32_16x16x64_bf16 v[36:39], v[8:11], a[0:7], v3
  s_waitcnt lgkmcnt(7)
  v_smfmac_f32_16x16x64_bf16 v[36:39], v[12:15], a[8:15], v3
  s_waitcnt lgkmcnt(6)
  v_smfmac_f32_16x16x64_bf16 v[36:39], v[16:19], a[16:23], v3
  s_waitcnt lgkmcnt(2)
  v_smfmac_f32_16x16x64_bf16 v[60:63], v[8:11], v[64:71], v3
  s_waitcnt lgkmcnt(5)
  ds_read_b128 v[144:147], v0 offset:4096
  ds_read_b128 v[148:151], v0 offset:5120
  v_smfmac_f32_16x16x64_bf16 v[36:39], v[20:23], a[24:31], v3
  s_waitcnt lgkmcnt(6)
  v_smfmac_f32_16x16x64_bf16 v[36:39], v[32:35], a[48:55], v3
  v_smfmac_f32_16x16x64_bf16 v[40:43], v[8:11], a[56:63], v3
  s_waitcnt lgkmcnt(2)
  v_smfmac_f32_16x16x64_bf16 v[60:63], v[12:15], v[72:79], v3
  ds_read_b128 v[64:67], v0 offset:6144
  ds_read_b128 v[68:71], v0 offset:7168
  v_smfmac_f32_16x16x64_bf16 v[40:43], v[12:15], a[64:71], v3
  v_permlane32_swap_b32 v36, v38
  v_smfmac_f32_16x16x64_bf16 v[40:43], v[16:19], a[72:79], v3
  v_permlane32_swap_b32 v37, v39
  v_smfmac_f32_16x16x64_bf16 v[40:43], v[20:23], a[80:87], v3
  s_waitcnt lgkmcnt(2)
  v_add_f32 v36, v36, v38
  v_smfmac_f32_16x16x64_bf16 v[60:63], v[16:19], v[144:151], v3
  ds_read_b128 v[72:75], v0 offset:8192
  ds_read_b128 v[76:79], v0 offset:9216
  v_add_f32 v37, v37, v39
  v_smfmac_f32_16x16x64_bf16 v[40:43], v[32:35], a[104:111], v3
  v_cmp_u_f32 vcc, v36, v37
  v_smfmac_f32_16x16x64_bf16 v[44:47], v[8:11], a[112:119], v3
  v_cvt_pk_bf16_f32 v38, v36, v37
  v_smfmac_f32_16x16x64_bf16 v[44:47], v[12:15], a[120:127], v3
  ds_write_b32 v152, v38
  s_waitcnt lgkmcnt(3)
  s_cbranch_vccnz cB_va0_slow
  v_permlane32_swap_b32 v40, v42
  v_smfmac_f32_16x16x64_bf16 v[60:63], v[20:23], v[64:71], v3
  ds_read_b128 v[144:147], v0 offset:10240
  ds_read_b128 v[148:151], v0 offset:11264
  v_permlane32_swap_b32 v41, v43
  v_smfmac_f32_16x16x64_bf16 v[44:47], v[16:19], a[128:135], v3
  buffer_store_dword v162, v1, s[8:11], s21 offen sc1
  v_add_f32 v40, v40, v42
  v_smfmac_f32_16x16x64_bf16 v[44:47], v[20:23], a[136:143], v3
  v_add_f32 v41, v41, v43
  v_smfmac_f32_16x16x64_bf16 v[44:47], v[32:35], a[160:167], v3
  s_waitcnt lgkmcnt(3)
  v_cvt_pk_bf16_f32 v42, v40, v41
  v_smfmac_f32_16x16x64_bf16 v[60:63], v[24:27], v[72:79], v3
  ds_write_b32 v153, v42
  ds_read_b128 v[64:67], v0 offset:12288
  ds_read_b128 v[68:71], v0 offset:13312
  v_smfmac_f32_16x16x64_bf16 v[48:51], v[8:11], a[168:175], v3
  s_nop 0
  v_permlane32_swap_b32 v44, v46
  v_smfmac_f32_16x16x64_bf16 v[48:51], v[12:15], a[176:183], v3
  v_permlane32_swap_b32 v45, v47
  v_smfmac_f32_16x16x64_bf16 v[48:51], v[16:19], a[184:191], v3
  s_waitcnt lgkmcnt(3)
  v_add_f32 v44, v44, v46
  v_smfmac_f32_16x16x64_bf16 v[60:63], v[28:31], v[144:151], v3
  v_add_f32 v45, v45, v47
  v_smfmac_f32_16x16x64_bf16 v[48:51], v[20:23], a[192:199], v3
  buffer_load_dword v164, v4, s[8:11], 0 offen sc1
  v_cvt_pk_bf16_f32 v46, v44, v45
  v_smfmac_f32_16x16x64_bf16 v[48:51], v[32:35], a[216:223], v3
  ds_write_b32 v154, v46
  v_smfmac_f32_16x16x64_bf16 v[52:55], v[8:11], a[224:231], v3
  s_waitcnt lgkmcnt(1)
  v_smfmac_f32_16x16x64_bf16 v[60:63], v[32:35], v[64:71], v3
  buffer_load_dword v165, v4, s[8:11], 0 offen sc1
  v_smfmac_f32_16x16x64_bf16 v[52:55], v[12:15], a[232:239], v3
  v_permlane32_swap_b32 v48, v50
  v_smfmac_f32_16x16x64_bf16 v[52:55], v[16:19], a[240:247], v3
  v_permlane32_swap_b32 v49, v51
  v_smfmac_f32_16x16x64_bf16 v[52:55], v[20:23], a[248:255], v3
  buffer_load_dword v166, v4, s[8:11], 0 offen sc1
  v_add_f32 v48, v48, v50
  v_smfmac_f32_16x16x64_bf16 v[52:55], v[32:35], v[192:199], v3
  v_add_f32 v49, v49, v51
  v_smfmac_f32_16x16x64_bf16 v[56:59], v[8:11], v[200:207], v3
  v_cvt_pk_bf16_f32 v50, v48, v49
  v_smfmac_f32_16x16x64_bf16 v[56:59], v[12:15], v[208:215], v3
  ds_write_b32 v155, v50
  buffer_load_dword v167, v4, s[8:11], 0 offen sc1
  v_permlane32_swap_b32 v60, v62
  v_smfmac_f32_16x16x64_bf16 v[56:59], v[16:19], v[216:223], v3
  v_permlane32_swap_b32 v61, v63
  v_smfmac_f32_16x16x64_bf16 v[56:59], v[20:23], v[224:231], v3
  v_add_f32 v60, v60, v62
  v_smfmac_f32_16x16x64_bf16 v[56:59], v[32:35], v[248:255], v3
  buffer_load_dword v168, v4, s[8:11], 0 offen sc1
  v_add_f32 v61, v61, v63
  v_cvt_pk_bf16_f32 v62, v60, v61
  ds_write_b32 v158, v62
  v_permlane32_swap_b32 v52, v54
  v_permlane32_swap_b32 v53, v55
  v_add_f32 v52, v52, v54
  v_add_f32 v53, v53, v55
  v_cvt_pk_bf16_f32 v54, v52, v53
  ds_write_b32 v156, v54
  v_permlane32_swap_b32 v56, v58
  v_permlane32_swap_b32 v57, v59
  v_add_f32 v56, v56, v58
  v_add_f32 v57, v57, v59
  v_cvt_pk_bf16_f32 v58, v56, v57
  ds_write_b32 v157, v58
cB_va0_t2d:
  s_add_u32 s22, s20, 9216
  s_add_u32 s34, s20, 13312
  s_add_u32 s36, s20, 7168
  s_mov_b32 s37, 0
  v_mov_b32 v48, 0
  v_mov_b32 v49, 0
  v_mov_b32 v50, 0
  v_mov_b32 v51, 0
  v_mov_b32 v163, s18
  s_waitcnt lgkmcnt(0)
  s_setprio 3
cB_va0_fw_l:
  s_waitcnt vmcnt(4)
  v_cmp_gt_u32 vcc, s18, v164
  buffer_load_dword v164, v4, s[8:11], 0 offen sc1
  s_cbranch_vccz cB_va0_fw_d
  s_waitcnt vmcnt(4)
  v_cmp_gt_u32 vcc, s18, v165
  buffer_load_dword v165, v4, s[8:11], 0 offen sc1
  s_cbranch_vccz cB_va0_fw_d
  s_waitcnt vmcnt(4)
  v_cmp_gt_u32 vcc, s18, v166
  buffer_load_dword v166, v4, s[8:11], 0 offen sc1
  s_cbranch_vccz cB_va0_fw_d
  s_waitcnt vmcnt(4)
  v_cmp_gt_u32 vcc, s18, v167
  buffer_load_dword v167, v4, s[8:11], 0 offen sc1
  s_cbranch_vccz cB_va0_fw_d
  s_waitcnt vmcnt(4)
  v_cmp_gt_u32 vcc, s18, v168
  buffer_load_dword v168, v4, s[8:11], 0 offen sc1
  s_cbranch_vccz cB_va0_fw_d
  s_waitcnt vmcnt(4)
  v_cmp_gt_u32 vcc, s18, v164
  buffer_load_dword v164, v4, s[8:11], 0 offen sc1
  s_cbranch_vccz cB_va0_fw_d
  s_waitcnt vmcnt(4)
  v_cmp_gt_u32 vcc, s18, v165
  buffer_load_dword v165, v4, s[8:11], 0 offen sc1
  s_cbranch_vccz cB_va0_fw_d
  s_waitcnt vmcnt(4)
  v_cmp_gt_u32 vcc, s18, v166
  buffer_load_dword v166, v4, s[8:11], 0 offen sc1
  s_cbranch_vccz cB_va0_fw_d
  s_waitcnt vmcnt(4)
  v_cmp_gt_u32 vcc, s18, v167
  buffer_load_dword v167, v4, s[8:11], 0 offen sc1
  s_cbranch_vccz cB_va0_fw_d
  s_waitcnt vmcnt(4)
  v_cmp_gt_u32 vcc, s18, v168
  buffer_load_dword v168, v4, s[8:11], 0 offen sc1
  s_cbranch_vccz cB_va0_fw_d
  s_waitcnt vmcnt(4)
  v_cmp_gt_u32 vcc, s18, v164
  buffer_load_dword v164, v4, s[8:11], 0 offen sc1
  s_cbranch_vccz cB_va0_fw_d
  s_waitcnt vmcnt(4)
  v_cmp_gt_u32 vcc, s18, v165
  buffer_load_dword v165, v4, s[8:11], 0 offen sc1
  s_cbranch_vccz cB_va0_fw_d
  s_waitcnt vmcnt(4)
  v_cmp_gt_u32 vcc, s18, v166
  buffer_load_dword v166, v4, s[8:11], 0 offen sc1
  s_cbranch_vccz cB_va0_fw_d
  s_waitcnt vmcnt(4)
  v_cmp_gt_u32 vcc, s18, v167
  buffer_load_dword v167, v4, s[8:11], 0 offen sc1
  s_cbranch_vccz cB_va0_fw_d
  s_waitcnt vmcnt(4)
  v_cmp_gt_u32 vcc, s18, v168
  buffer_load_dword v168, v4, s[8:11], 0 offen sc1
  s_cbranch_vccz cB_va0_fw_d
  s_add_u32 s30, s30, 1
  s_cmp_lt_u32 s30, 400000
  s_cbranch_scc1 cB_va0_fw_l
  s_branch cB_abort
cB_va0_fw_d:
  buffer_load_dwordx4 v[8:11], v2, s[8:11], s22 offen offset:0 sc1
  buffer_load_dwordx4 v[12:15], v2, s[8:11], s22 offen offset:1024 sc1
  buffer_load_dwordx4 v[16:19], v2, s[8:11], s22 offen offset:2048 sc1
  buffer_load_dwordx4 v[20:23], v2, s[8:11], s22 offen offset:3072 sc1
  buffer_load_dwordx4 v[24:27], v2, s[8:11], s34 offen offset:0 sc1
  buffer_load_dwordx4 v[28:31], v2, s[8:11], s34 offen offset:1024 sc1
  buffer_load_dwordx4 v[32:35], v2, s[8:11], s34 offen offset:2048 sc1
  buffer_load_dwordx4 v[36:39], v2, s[8:11], s34 offen offset:3072 sc1
  buffer_load_dwordx4 v[40:43], v2, s[8:11], s36 offen offset:0 sc1
  buffer_load_dwordx4 v[44:47], v2, s[8:11], s36 offen offset:1024 sc1
  s_barrier
  ds_read_b128 v[64:67], v2 offset:0
  ds_read_b128 v[68:71], v2 offset:1024
  ds_read_b128 v[72:75], v2 offset:2048
  ds_read_b128 v[76:79], v2 offset:3072
cB_va0_lp:
  s_waitcnt vmcnt(9)
  v_smfmac_f32_16x16x64_bf16 v[48:51], v[8:11], v[80:87], v3
  s_waitcnt vmcnt(8)
  v_smfmac_f32_16x16x64_bf16 v[48:51], v[12:15], v[88:95], v3
  s_waitcnt vmcnt(7)
  v_smfmac_f32_16x16x64_bf16 v[48:51], v[16:19], v[96:103], v3
  s_waitcnt vmcnt(6)
  v_smfmac_f32_16x16x64_bf16 v[48:51], v[20:23], v[104:111], v3
  s_waitcnt vmcnt(5)
  v_smfmac_f32_16x16x64_bf16 v[48:51], v[24:27], v[112:119], v3
  s_waitcnt vmcnt(4)
  v_smfmac_f32_16x16x64_bf16 v[48:51], v[28:31], v[120:127], v3
  s_waitcnt vmcnt(3)
  v_smfmac_f32_16x16x64_bf16 v[48:51], v[32:35], v[128:135], v3
  s_waitcnt vmcnt(2)
  v_smfmac_f32_16x16x64_bf16 v[48:51], v[36:39], v[136:143], v3
  s_waitcnt vmcnt(1) lgkmcnt(0)
  v_smfmac_f32_16x16x64_bf16 v[48:51], v[40:43], v[64:71], v3
  s_waitcnt vmcnt(0)
  v_smfmac_f32_16x16x64_bf16 v[48:51], v[44:47], v[72:79], v3
  s_nop 7
  v_permlane32_swap_b32 v48, v50
  v_permlane32_swap_b32 v49, v51
  v_add_f32 v48, v48, v50
  v_add_f32 v49, v49, v51
  v_cvt_pk_bf16_f32 v160, v48, v49
  v_cmp_u_f32 vcc, v48, v49
  s_nop 0
  v_mov_b32_dpp v161, v160 quad_perm:[1,0,3,2] row_mask:0xf bank_mask:0xf
  v_perm_b32 v160, v161, v160, v5
  v_min_u32 v160, -2, v160
  s_cbranch_vccnz cB_va0_rp
cB_va0_cont:
  buffer_store_dword v160, v1, s[8:11], s21 offen sc1
  s_setprio 0
  s_cmp_lg_u32 s19, 62
  s_cbranch_scc1 cB_va0_nl
  buffer_store_dword v160, v1, s[8:11], s38 offen sc1
  s_waitcnt vmcnt(0)
  buffer_wbl2 sc1
  s_branch cB_done
cB_va0_nl:
  s_add_u32 s25, s25, 458752
  v_mov_b32 v36, 0
  v_mov_b32 v37, 0
  v_mov_b32 v38, 0
  v_mov_b32 v39, 0
  v_mov_b32 v40, 0
  v_mov_b32 v41, 0
  v_mov_b32 v42, 0
  v_mov_b32 v43, 0
  v_mov_b32 v44, 0
  v_mov_b32 v45, 0
  v_mov_b32 v46, 0
  v_mov_b32 v47, 0
  v_mov_b32 v48, 0
  v_mov_b32 v49, 0
  v_mov_b32 v50, 0
  v_mov_b32 v51, 0
  v_mov_b32 v52, 0
  v_mov_b32 v53, 0
  v_mov_b32 v54, 0
  v_mov_b32 v55, 0
  v_mov_b32 v56, 0
  v_mov_b32 v57, 0
  v_mov_b32 v58, 0
  v_mov_b32 v59, 0
  v_mov_b32 v60, 0
  v_mov_b32 v61, 0
  v_mov_b32 v62, 0
  v_mov_b32 v63, 0
  s_mov_b32 s19, s18
  s_add_u32 s18, s18, 1
  s_mov_b32 s22, s20
  s_mov_b32 s20, s21
  s_mov_b32 s21, s22
  s_add_u32 s23, s20, 4096
  s_branch cB_va0_loop
cB_va0_slow:
  s_waitcnt lgkmcnt(0)
cB_va0_sl1:
  s_add_u32 s31, s31, 0x1000000
  buffer_load_dwordx4 v[8:11], v2, s[8:11], s20 offen offset:0 sc1
  buffer_load_dwordx4 v[12:15], v2, s[8:11], s20 offen offset:1024 sc1
  buffer_load_dwordx4 v[16:19], v2, s[8:11], s20 offen offset:2048 sc1
  buffer_load_dwordx4 v[20:23], v2, s[8:11], s20 offen offset:3072 sc1
  buffer_load_dwordx4 v[24:27], v2, s[8:11], s23 offen offset:0 sc1
  buffer_load_dwordx4 v[28:31], v2, s[8:11], s23 offen offset:1024 sc1
  buffer_load_dwordx4 v[32:35], v2, s[8:11], s23 offen offset:2048 sc1
  s_waitcnt vmcnt(0)
  v_max3_u32 v36, v8, v9, v10
  v_max3_u32 v36, v36, v11, v12
  v_max3_u32 v36, v36, v13, v14
  v_max3_u32 v36, v36, v15, v16
  v_max3_u32 v36, v36, v17, v18
  v_max3_u32 v36, v36, v19, v20
  v_max3_u32 v36, v36, v21, v22
  v_max3_u32 v36, v36, v23, v24
  v_max3_u32 v36, v36, v25, v26
  v_max3_u32 v36, v36, v27, v28
  v_max3_u32 v36, v36, v29, v30
  v_max3_u32 v36, v36, v31, v32
  v_max3_u32 v36, v36, v33, v34
  v_max_u32 v36, v36, v35
  v_cmp_eq_u32 vcc, -1, v36
  s_cbranch_vccz cB_va0_sl2
  s_add_u32 s30, s30, 1
  s_cmp_lt_u32 s30, 400000
  s_cbranch_scc1 cB_va0_sl1
  s_branch cB_abort
cB_va0_sl2:
  v_mov_b32 v36, 0
  v_mov_b32 v37, 0
  v_mov_b32 v38, 0
  v_mov_b32 v39, 0
  v_mov_b32 v40, 0
  v_mov_b32 v41, 0
  v_mov_b32 v42, 0
  v_mov_b32 v43, 0
  v_mov_b32 v44, 0
  v_mov_b32 v45, 0
  v_mov_b32 v46, 0
  v_mov_b32 v47, 0
  v_mov_b32 v48, 0
  v_mov_b32 v49, 0
  v_mov_b32 v50, 0
  v_mov_b32 v51, 0
  v_mov_b32 v52, 0
  v_mov_b32 v53, 0
  v_mov_b32 v54, 0
  v_mov_b32 v55, 0
  v_mov_b32 v56, 0
  v_mov_b32 v57, 0
  v_mov_b32 v58, 0
  v_mov_b32 v59, 0
  v_mov_b32 v60, 0
  v_mov_b32 v61, 0
  v_mov_b32 v62, 0
  v_mov_b32 v63, 0
  buffer_store_dword v162, v1, s[8:11], s21 offen sc1
  ds_read_b128 v[64:67], v0 offset:0
  ds_read_b128 v[68:71], v0 offset:1024
  v_smfmac_f32_16x16x64_bf16 v[36:39], v[8:11], a[0:7], v3
  v_smfmac_f32_16x16x64_bf16 v[40:43], v[8:11], a[56:63], v3
  v_smfmac_f32_16x16x64_bf16 v[44:47], v[8:11], a[112:119], v3
  v_smfmac_f32_16x16x64_bf16 v[48:51], v[8:11], a[168:175], v3
  v_smfmac_f32_16x16x64_bf16 v[52:55], v[8:11], a[224:231], v3
  v_smfmac_f32_16x16x64_bf16 v[56:59], v[8:11], v[200:207], v3
  s_waitcnt lgkmcnt(0)
  v_smfmac_f32_16x16x64_bf16 v[60:63], v[8:11], v[64:71], v3
  ds_read_b128 v[72:75], v0 offset:2048
  ds_read_b128 v[76:79], v0 offset:3072
  v_smfmac_f32_16x16x64_bf16 v[36:39], v[12:15], a[8:15], v3
  v_smfmac_f32_16x16x64_bf16 v[40:43], v[12:15], a[64:71], v3
  v_smfmac_f32_16x16x64_bf16 v[44:47], v[12:15], a[120:127], v3
  v_smfmac_f32_16x16x64_bf16 v[48:51], v[12:15], a[176:183], v3
  v_smfmac_f32_16x16x64_bf16 v[52:55], v[12:15], a[232:239], v3
  v_smfmac_f32_16x16x64_bf16 v[56:59], v[12:15], v[208:215], v3
  s_waitcnt lgkmcnt(0)
  v_smfmac_f32_16x16x64_bf16 v[60:63], v[12:15], v[72:79], v3
  ds_read_b128 v[144:147], v0 offset:4096
  ds_read_b128 v[148:151], v0 offset:5120
  v_smfmac_f32_16x16x64_bf16 v[36:39], v[16:19], a[16:23], v3
  v_smfmac_f32_16x16x64_bf16 v[40:43], v[16:19], a[72:79], v3
  v_smfmac_f32_16x16x64_bf16 v[44:47], v[16:19], a[128:135], v3
  v_smfmac_f32_16x16x64_bf16 v[48:51], v[16:19], a[184:191], v3
  v_smfmac_f32_16x16x64_bf16 v[52:55], v[16:19], a[240:247], v3
  v_smfmac_f32_16x16x64_bf16 v[56:59], v[16:19], v[216:223], v3
  s_waitcnt lgkmcnt(0)
  v_smfmac_f32_16x16x64_bf16 v[60:63], v[16:19], v[144:151], v3
  ds_read_b128 v[64:67], v0 offset:6144
  ds_read_b128 v[68:71], v0 offset:7168
  v_smfmac_f32_16x16x64_bf16 v[36:39], v[20:23], a[24:31], v3
  v_smfmac_f32_16x16x64_bf16 v[40:43], v[20:23], a[80:87], v3
  v_smfmac_f32_16x16x64_bf16 v[44:47], v[20:23], a[136:143], v3
  v_smfmac_f32_16x16x64_bf16 v[48:51], v[20:23], a[192:199], v3
  v_smfmac_f32_16x16x64_bf16 v[52:55], v[20:23], a[248:255], v3
  v_smfmac_f32_16x16x64_bf16 v[56:59], v[20:23], v[224:231], v3
  s_waitcnt lgkmcnt(0)
  v_smfmac_f32_16x16x64_bf16 v[60:63], v[20:23], v[64:71], v3
  ds_read_b128 v[72:75], v0 offset:8192
  ds_read_b128 v[76:79], v0 offset:9216
  v_smfmac_f32_16x16x64_bf16 v[36:39], v[24:27], a[32:39], v3
  v_smfmac_f32_16x16x64_bf16 v[40:43], v[24:27], a[88:95], v3
  v_smfmac_f32_16x16x64_bf16 v[44:47], v[24:27], a[144:151], v3
  v_smfmac_f32_16x16x64_bf16 v[48:51], v[24:27], a[200:207], v3
  v_smfmac_f32_16x16x64_bf16 v[52:55], v[24:27], v[176:183], v3
  v_smfmac_f32_16x16x64_bf16 v[56:59], v[24:27], v[232:239], v3
  s_waitcnt lgkmcnt(0)
  v_smfmac_f32_16x16x64_bf16 v[60:63], v[24:27], v[72:79], v3
  ds_read_b128 v[144:147], v0 offset:10240
  ds_read_b128 v[148:151], v0 offset:11264
  v_smfmac_f32_16x16x64_bf16 v[36:39], v[28:31], a[40:47], v3
  v_smfmac_f32_16x16x64_bf16 v[40:43], v[28:31], a[96:103], v3
  v_smfmac_f32_16x16x64_bf16 v[44:47], v[28:31], a[152:159], v3
  v_smfmac_f32_16x16x64_bf16 v[48:51], v[28:31], a[208:215], v3
  v_smfmac_f32_16x16x64_bf16 v[52:55], v[28:31], v[184:191], v3
  v_smfmac_f32_16x16x64_bf16 v[56:59], v[28:31], v[240:247], v3
  s_waitcnt lgkmcnt(0)
  v_smfmac_f32_16x16x64_bf16 v[60:63], v[28:31], v[144:151], v3
  ds_read_b128 v[64:67], v0 offset:12288
  ds_read_b128 v[68:71], v0 offset:13312
  v_smfmac_f32_16x16x64_bf16 v[36:39], v[32:35], a[48:55], v3
  v_smfmac_f32_16x16x64_bf16 v[40:43], v[32:35], a[104:111], v3
  v_smfmac_f32_16x16x64_bf16 v[44:47], v[32:35], a[160:167], v3
  v_smfmac_f32_16x16x64_bf16 v[48:51], v[32:35], a[216:223], v3
  v_smfmac_f32_16x16x64_bf16 v[52:55], v[32:35], v[192:199], v3
  v_smfmac_f32_16x16x64_bf16 v[56:59], v[32:35], v[248:255], v3
  s_waitcnt lgkmcnt(0)
  v_smfmac_f32_16x16x64_bf16 v[60:63], v[32:35], v[64:71], v3
  v_permlane32_swap_b32 v36, v38
  v_permlane32_swap_b32 v37, v39
  v_add_f32 v36, v36, v38
  v_add_f32 v37, v37, v39
  v_cvt_pk_bf16_f32 v38, v36, v37
  ds_write_b32 v152, v38
  v_permlane32_swap_b32 v40, v42
  v_permlane32_swap_b32 v41, v43
  v_add_f32 v40, v40, v42
  v_add_f32 v41, v41, v43
  v_cvt_pk_bf16_f32 v42, v40, v41
  ds_write_b32 v153, v42
  v_permlane32_swap_b32 v44, v46
  v_permlane32_swap_b32 v45, v47
  v_add_f32 v44, v44, v46
  v_add_f32 v45, v45, v47
  v_cvt_pk_bf16_f32 v46, v44, v45
  ds_write_b32 v154, v46
  v_permlane32_swap_b32 v48, v50
  v_permlane32_swap_b32 v49, v51
  v_add_f32 v48, v48, v50
  v_add_f32 v49, v49, v51
  v_cvt_pk_bf16_f32 v50, v48, v49
  ds_write_b32 v155, v50
  v_permlane32_swap_b32 v52, v54
  v_permlane32_swap_b32 v53, v55
  v_add_f32 v52, v52, v54
  v_add_f32 v53, v53, v55
  v_cvt_pk_bf16_f32 v54, v52, v53
  ds_write_b32 v156, v54
  v_permlane32_swap_b32 v56, v58
  v_permlane32_swap_b32 v57, v59
  v_add_f32 v56, v56, v58
  v_add_f32 v57, v57, v59
  v_cvt_pk_bf16_f32 v58, v56, v57
  ds_write_b32 v157, v58
  v_permlane32_swap_b32 v60, v62
  v_permlane32_swap_b32 v61, v63
  v_add_f32 v60, v60, v62
  v_add_f32 v61, v61, v63
  v_cvt_pk_bf16_f32 v62, v60, v61
  ds_write_b32 v158, v62
  buffer_load_dword v164, v4, s[8:11], 0 offen sc1
  buffer_load_dword v165, v4, s[8:11], 0 offen sc1
  buffer_load_dword v166, v4, s[8:11], 0 offen sc1
  buffer_load_dword v167, v4, s[8:11], 0 offen sc1
  buffer_load_dword v168, v4, s[8:11], 0 offen sc1
  s_branch cB_va0_t2d
cB_va0_rp:
  s_cmp_lg_u32 s37, 0
  s_cbranch_scc1 cB_va0_cont
cB_va0_rv:
  s_add_u32 s31, s31, 0x10000
  buffer_load_dwordx4 v[8:11], v2, s[8:11], s22 offen offset:0 sc1
  buffer_load_dwordx4 v[12:15], v2, s[8:11], s22 offen offset:1024 sc1
  buffer_load_dwordx4 v[16:19], v2, s[8:11], s22 offen offset:2048 sc1
  buffer_load_dwordx4 v[20:23], v2, s[8:11], s22 offen offset:3072 sc1
  buffer_load_dwordx4 v[24:27], v2, s[8:11], s34 offen offset:0 sc1
  buffer_load_dwordx4 v[28:31], v2, s[8:11], s34 offen offset:1024 sc1
  buffer_load_dwordx4 v[32:35], v2, s[8:11], s34 offen offset:2048 sc1
  buffer_load_dwordx4 v[36:39], v2, s[8:11], s34 offen offset:3072 sc1
  buffer_load_dwordx4 v[40:43], v2, s[8:11], s36 offen offset:0 sc1
  buffer_load_dwordx4 v[44:47], v2, s[8:11], s36 offen offset:1024 sc1
  s_waitcnt vmcnt(0)
  v_max3_u32 v52, v8, v9, v10
  v_max3_u32 v52, v52, v11, v12
  v_max3_u32 v52, v52, v13, v14
  v_max3_u32 v52, v52, v15, v16
  v_max3_u32 v52, v52, v17, v18
  v_max3_u32 v52, v52, v19, v20
  v_max3_u32 v52, v52, v21, v22
  v_max3_u32 v52, v52, v23, v24
  v_max3_u32 v52, v52, v25, v26
  v_max3_u32 v52, v52, v27, v28
  v_max3_u32 v52, v52, v29, v30
  v_max3_u32 v52, v52, v31, v32
  v_max3_u32 v52, v52, v33, v34
  v_max3_u32 v52, v52, v35, v36
  v_max3_u32 v52, v52, v37, v38
  v_max3_u32 v52, v52, v39, v40
  v_max3_u32 v52, v52, v41, v42
  v_max3_u32 v52, v52, v43, v44
  v_max3_u32 v52, v52, v45, v46
  v_max_u32 v52, v52, v47
  v_cmp_eq_u32 vcc, -1, v52
  s_mov_b32 s37, 1
  v_mov_b32 v48, 0
  v_mov_b32 v49, 0
  v_mov_b32 v50, 0
  v_mov_b32 v51, 0
  s_nop 1
  s_cbranch_vccz cB_va0_lp
  s_add_u32 s30, s30, 1
  s_cmp_lt_u32 s30, 400000
  s_cbranch_scc1 cB_va0_rv
  s_branch cB_abort
.p2align 6
cB_va1_loop:
  s_mov_b32 s30, 0
  s_barrier
  buffer_load_dwordx4 v[28:31], v2, s[8:11], s23 offen offset:1024 sc1
  buffer_load_dwordx4 v[32:35], v2, s[8:11], s23 offen offset:2048 sc1
  s_barrier
  buffer_store_dword v160, v1, s[8:11], s38 offen sc1
  s_add_u32 s22, s25, 0
  buffer_load_dwordx4 v[80:83], v6, s[8:11], s22 offen offset:0 sc1
  buffer_load_dwordx4 v[84:87], v6, s[8:11], s22 offen offset:1792 sc1
  s_add_u32 s22, s25, 3584
  buffer_load_dwordx4 v[88:91], v6, s[8:11], s22 offen offset:0 sc1
  buffer_load_dwordx4 v[92:95], v6, s[8:11], s22 offen offset:1792 sc1
  s_add_u32 s22, s25, 7168
  buffer_load_dwordx4 v[96:99], v6, s[8:11], s22 offen offset:0 sc1
  s_mul_i32 s38, s18, 7168
  s_add_u32 s38, s38, 88002560
  s_waitcnt vmcnt(6)
  ds_write_b128 v2, v[32:35] offset:14336
  v_smfmac_f32_16x16x64_bf16 v[36:39], v[28:31], a[40:47], v3
  buffer_load_dwordx4 v[100:103], v6, s[8:11], s22 offen offset:1792 sc1
  v_smfmac_f32_16x16x64_bf16 v[40:43], v[28:31], a[96:103], v3
  s_add_u32 s22, s25, 10752
  buffer_load_dwordx4 v[104:107], v6, s[8:11], s22 offen offset:0 sc1
  v_smfmac_f32_16x16x64_bf16 v[44:47], v[28:31], a[152:159], v3
  buffer_load_dwordx4 v[108:111], v6, s[8:11], s22 offen offset:1792 sc1
  v_smfmac_f32_16x16x64_bf16 v[48:51], v[28:31], a[208:215], v3
  s_add_u32 s22, s25, 14336
  buffer_load_dwordx4 v[112:115], v6, s[8:11], s22 offen offset:0 sc1
  v_smfmac_f32_16x16x64_bf16 v[52:55], v[28:31], v[184:191], v3
  s_waitcnt lgkmcnt(0)
  s_barrier
  ds_read_b128 v[8:11], v2 offset:8192
  ds_read_b128 v[12:15], v2 offset:9216
  ds_read_b128 v[16:19], v2 offset:10240
  ds_read_b128 v[20:23], v2 offset:11264
  ds_read_b128 v[24:27], v2 offset:12288
  buffer_load_dwordx4 v[116:119], v6, s[8:11], s22 offen offset:1792 sc1
  v_smfmac_f32_16x16x64_bf16 v[56:59], v[28:31], v[240:247], v3
  s_add_u32 s22, s25, 17920
  buffer_load_dwordx4 v[120:123], v6, s[8:11], s22 offen offset:0 sc1
  v_smfmac_f32_16x16x64_bf16 v[36:39], v[32:35], a[48:55], v3
  buffer_load_dwordx4 v[124:127], v6, s[8:11], s22 offen offset:1792 sc1
  v_smfmac_f32_16x16x64_bf16 v[40:43], v[32:35], a[104:111], v3
  s_add_u32 s22, s25, 21504
  buffer_load_dwordx4 v[128:131], v6, s[8:11], s22 offen offset:0 sc1
  v_smfmac_f32_16x16x64_bf16 v[44:47], v[32:35], a[160:167], v3
  buffer_load_dwordx4 v[132:135], v6, s[8:11], s22 offen offset:1792 sc1
  v_smfmac_f32_16x16x64_bf16 v[48:51], v[32:35], a[216:223], v3
  s_add_u32 s22, s25, 25088
  buffer_load_dwordx4 v[136:139], v6, s[8:11], s22 offen offset:0 sc1
  v_smfmac_f32_16x16x64_bf16 v[52:55], v[32:35], v[192:199], v3
  ds_read_b128 v[64:67], v0 offset:0
  ds_read_b128 v[68:71], v0 offset:1024
  buffer_load_dwordx4 v[140:143], v6, s[8:11], s22 offen offset:1792 sc1
  v_smfmac_f32_16x16x64_bf16 v[56:59], v[32:35], v[248:255], v3
  s_waitcnt lgkmcnt(6)
  ds_read_b128 v[72:75], v0 offset:2048
  ds_read_b128 v[76:79], v0 offset:3072
  v_smfmac_f32_16x16x64_bf16 v[36:39], v[8:11], a[0:7], v3
  s_waitcnt lgkmcnt(7)
  v_smfmac_f32_16x16x64_bf16 v[36:39], v[12:15], a[8:15], v3
  s_waitcnt lgkmcnt(6)
  v_smfmac_f32_16x16x64_bf16 v[36:39], v[16:19], a[16:23], v3
  s_waitcnt lgkmcnt(2)
  v_smfmac_f32_16x16x64_bf16 v[60:63], v[8:11], v[64:71], v3
  s_waitcnt lgkmcnt(5)
  ds_read_b128 v[144:147], v0 offset:4096
  ds_read_b128 v[148:151], v0 offset:5120
  v_smfmac_f32_16x16x64_bf16 v[36:39], v[20:23], a[24:31], v3
  s_waitcnt lgkmcnt(6)
  v_smfmac_f32_16x16x64_bf16 v[36:39], v[24:27], a[32:39], v3
  v_smfmac_f32_16x16x64_bf16 v[40:43], v[8:11], a[56:63], v3
  s_waitcnt lgkmcnt(2)
  v_smfmac_f32_16x16x64_bf16 v[60:63], v[12:15], v[72:79], v3
  ds_read_b128 v[64:67], v0 offset:6144
  ds_read_b128 v[68:71], v0 offset:7168
  v_smfmac_f32_16x16x64_bf16 v[40:43], v[12:15], a[64:71], v3
  v_permlane32_swap_b32 v36, v38
  v_smfmac_f32_16x16x64_bf16 v[40:43], v[16:19], a[72:79], v3
  v_permlane32_swap_b32 v37, v39
  v_smfmac_f32_16x16x64_bf16 v[40:43], v[20:23], a[80:87], v3
  s_waitcnt lgkmcnt(2)
  v_add_f32 v36, v36, v38
  v_smfmac_f32_16x16x64_bf16 v[60:63], v[16:19], v[144:151], v3
  ds_read_b128 v[72:75], v0 offset:8192
  ds_read_b128 v[76:79], v0 offset:9216
  v_add_f32 v37, v37, v39
  v_smfmac_f32_16x16x64_bf16 v[40:43], v[24:27], a[88:95], v3
  v_cmp_u_f32 vcc, v36, v37
  v_smfmac_f32_16x16x64_bf16 v[44:47], v[8:11], a[112:119], v3
  v_cvt_pk_bf16_f32 v38, v36, v37
  v_smfmac_f32_16x16x64_bf16 v[44:47], v[12:15], a[120:127], v3
  ds_write_b32 v152, v38
  s_waitcnt lgkmcnt(3)
  s_cbranch_vccnz cB_va1_slow
  v_permlane32_swap_b32 v40, v42
  v_smfmac_f32_16x16x64_bf16 v[60:63], v[20:23], v[64:71], v3
  ds_read_b128 v[144:147], v0 offset:10240
  ds_read_b128 v[148:151], v0 offset:11264
  v_permlane32_swap_b32 v41, v43
  v_smfmac_f32_16x16x64_bf16 v[44:47], v[16:19], a[128:135], v3
  buffer_store_dword v162, v1, s[8:11], s21 offen sc1
  v_add_f32 v40, v40, v42
  v_smfmac_f32_16x16x64_bf16 v[44:47], v[20:23], a[136:143], v3
  v_add_f32 v41, v41, v43
  v_smfmac_f32_16x16x64_bf16 v[44:47], v[24:27], a[144:151], v3
  s_waitcnt lgkmcnt(3)
  v_cvt_pk_bf16_f32 v42, v40, v41
  v_smfmac_f32_16x16x64_bf16 v[60:63], v[24:27], v[72:79], v3
  ds_write_b32 v153, v42
  ds_read_b128 v[64:67], v0 offset:12288
  ds_read_b128 v[68:71], v0 offset:13312
  v_smfmac_f32_16x16x64_bf16 v[48:51], v[8:11], a[168:175], v3
  s_nop 0
  v_permlane32_swap_b32 v44, v46
  v_smfmac_f32_16x16x64_bf16 v[48:51], v[12:15], a[176:183], v3
  v_permlane32_swap_b32 v45, v47
  v_smfmac_f32_16x16x64_bf16 v[48:51], v[16:19], a[184:191], v3
  s_waitcnt lgkmcnt(3)
  v_add_f32 v44, v44, v46
  v_smfmac_f32_16x16x64_bf16 v[60:63], v[28:31], v[144:151], v3
  v_add_f32 v45, v45, v47
  v_smfmac_f32_16x16x64_bf16 v[48:51], v[20:23], a[192:199], v3
  v_cvt_pk_bf16_f32 v46, v44, v45
  v_smfmac_f32_16x16x64_bf16 v[48:51], v[24:27], a[200:207], v3
  ds_write_b32 v154, v46
  v_smfmac_f32_16x16x64_bf16 v[52:55], v[8:11], a[224:231], v3
  s_waitcnt lgkmcnt(1)
  v_smfmac_f32_16x16x64_bf16 v[60:63], v[32:35], v[64:71], v3
  v_smfmac_f32_16x16x64_bf16 v[52:55], v[12:15], a[232:239], v3
  v_permlane32_swap_b32 v48, v50
  v_smfmac_f32_16x16x64_bf16 v[52:55], v[16:19], a[240:247], v3
  v_permlane32_swap_b32 v49, v51
  v_smfmac_f32_16x16x64_bf16 v[52:55], v[20:23], a[248:255], v3
  v_add_f32 v48, v48, v50
  v_smfmac_f32_16x16x64_bf16 v[52:55], v[24:27], v[176:183], v3
  v_add_f32 v49, v49, v51
  v_smfmac_f32_16x16x64_bf16 v[56:59], v[8:11], v[200:207], v3
  v_cvt_pk_bf16_f32 v50, v48, v49
  v_smfmac_f32_16x16x64_bf16 v[56:59], v[12:15], v[208:215], v3
  ds_write_b32 v155, v50
  v_permlane32_swap_b32 v60, v62
  v_smfmac_f32_16x16x64_bf16 v[56:59], v[16:19], v[216:223], v3
  v_permlane32_swap_b32 v61, v63
  v_smfmac_f32_16x16x64_bf16 v[56:59], v[20:23], v[224:231], v3
  v_add_f32 v60, v60, v62
  v_smfmac_f32_16x16x64_bf16 v[56:59], v[24:27], v[232:239], v3
  v_add_f32 v61, v61, v63
  v_cvt_pk_bf16_f32 v62, v60, v61
  ds_write_b32 v158, v62
  v_permlane32_swap_b32 v52, v54
  v_permlane32_swap_b32 v53, v55
  v_add_f32 v52, v52, v54
  v_add_f32 v53, v53, v55
  v_cvt_pk_bf16_f32 v54, v52, v53
  ds_write_b32 v156, v54
  v_permlane32_swap_b32 v56, v58
  v_permlane32_swap_b32 v57, v59
  v_add_f32 v56, v56, v58
  v_add_f32 v57, v57, v59
  v_cvt_pk_bf16_f32 v58, v56, v57
  ds_write_b32 v157, v58
cB_va1_t2d:
  s_add_u32 s22, s20, 9216
  s_add_u32 s34, s20, 13312
  s_add_u32 s36, s20, 7168
  s_mov_b32 s37, 0
  v_mov_b32 v48, 0
  v_mov_b32 v49, 0
  v_mov_b32 v50, 0
  v_mov_b32 v51, 0
  v_mov_b32 v163, s18
  s_waitcnt lgkmcnt(0)
  s_barrier
  buffer_load_dwordx4 v[8:11], v2, s[8:11], s22 offen offset:0 sc1
  buffer_load_dwordx4 v[12:15], v2, s[8:11], s22 offen offset:1024 sc1
  buffer_load_dwordx4 v[16:19], v2, s[8:11], s22 offen offset:2048 sc1
  buffer_load_dwordx4 v[20:23], v2, s[8:11], s22 offen offset:3072 sc1
  buffer_load_dwordx4 v[24:27], v2, s[8:11], s34 offen offset:0 sc1
  buffer_load_dwordx4 v[28:31], v2, s[8:11], s34 offen offset:1024 sc1
  buffer_load_dwordx4 v[32:35], v2, s[8:11], s34 offen offset:2048 sc1
  buffer_load_dwordx4 v[36:39], v2, s[8:11], s34 offen offset:3072 sc1
  buffer_load_dwordx4 v[40:43], v2, s[8:11], s36 offen offset:0 sc1
  buffer_load_dwordx4 v[44:47], v2, s[8:11], s36 offen offset:1024 sc1
  ds_read_b128 v[64:67], v2 offset:4096
  ds_read_b128 v[68:71], v2 offset:5120
  ds_read_b128 v[72:75], v2 offset:6144
  ds_read_b128 v[76:79], v2 offset:7168
cB_va1_lp:
  s_waitcnt vmcnt(9)
  v_smfmac_f32_16x16x64_bf16 v[48:51], v[8:11], v[80:87], v3
  s_waitcnt vmcnt(8)
  v_smfmac_f32_16x16x64_bf16 v[48:51], v[12:15], v[88:95], v3
  s_waitcnt vmcnt(7)
  v_smfmac_f32_16x16x64_bf16 v[48:51], v[16:19], v[96:103], v3
  v_max3_u32 v55, v8, v12, v16
  s_waitcnt vmcnt(6)
  v_smfmac_f32_16x16x64_bf16 v[48:51], v[20:23], v[104:111], v3
  v_max_u32 v55, v55, v20
  v_cmp_eq_u32 vcc, -1, v55
  s_waitcnt vmcnt(5)
  v_smfmac_f32_16x16x64_bf16 v[48:51], v[24:27], v[112:119], v3
  s_waitcnt vmcnt(4)
  v_smfmac_f32_16x16x64_bf16 v[48:51], v[28:31], v[120:127], v3
  s_cbranch_vccnz cB_va1_rv
  buffer_store_dword v163, v7, s[8:11], 0 offen sc1
  s_waitcnt vmcnt(4)
  v_smfmac_f32_16x16x64_bf16 v[48:51], v[32:35], v[128:135], v3
  s_waitcnt vmcnt(3)
  v_smfmac_f32_16x16x64_bf16 v[48:51], v[36:39], v[136:143], v3
  s_waitcnt vmcnt(2) lgkmcnt(0)
  v_smfmac_f32_16x16x64_bf16 v[48:51], v[40:43], v[64:71], v3
  s_waitcnt vmcnt(1)
  v_smfmac_f32_16x16x64_bf16 v[48:51], v[44:47], v[72:79], v3
  s_nop 7
  v_permlane32_swap_b32 v48, v50
  v_permlane32_swap_b32 v49, v51
  v_add_f32 v48, v48, v50
  v_add_f32 v49, v49, v51
  v_cvt_pk_bf16_f32 v160, v48, v49
  v_cmp_u_f32 vcc, v48, v49
  s_nop 0
  v_mov_b32_dpp v161, v160 quad_perm:[1,0,3,2] row_mask:0xf bank_mask:0xf
  v_perm_b32 v160, v161, v160, v5
  v_min_u32 v160, -2, v160
  s_cbranch_vccnz cB_va1_rp
cB_va1_cont:
  buffer_store_dword v160, v1, s[8:11], s21 offen sc1
  s_cmp_lg_u32 s19, 62
  s_cbranch_scc1 cB_va1_nl
  buffer_store_dword v160, v1, s[8:11], s38 offen sc1
  s_waitcnt vmcnt(0)
  buffer_wbl2 sc1
  s_branch cB_done
cB_va1_nl:
  s_add_u32 s25, s25, 458752
  v_mov_b32 v36, 0
  v_mov_b32 v37, 0
  v_mov_b32 v38, 0
  v_mov_b32 v39, 0
  v_mov_b32 v40, 0
  v_mov_b32 v41, 0
  v_mov_b32 v42, 0
  v_mov_b32 v43, 0
  v_mov_b32 v44, 0
  v_mov_b32 v45, 0
  v_mov_b32 v46, 0
  v_mov_b32 v47, 0
  v_mov_b32 v48, 0
  v_mov_b32 v49, 0
  v_mov_b32 v50, 0
  v_mov_b32 v51, 0
  v_mov_b32 v52, 0
  v_mov_b32 v53, 0
  v_mov_b32 v54, 0
  v_mov_b32 v55, 0
  v_mov_b32 v56, 0
  v_mov_b32 v57, 0
  v_mov_b32 v58, 0
  v_mov_b32 v59, 0
  v_mov_b32 v60, 0
  v_mov_b32 v61, 0
  v_mov_b32 v62, 0
  v_mov_b32 v63, 0
  s_mov_b32 s19, s18
  s_add_u32 s18, s18, 1
  s_mov_b32 s22, s20
  s_mov_b32 s20, s21
  s_mov_b32 s21, s22
  s_add_u32 s23, s20, 4096
  s_branch cB_va1_loop
cB_va1_slow:
  s_waitcnt lgkmcnt(0)
cB_va1_sl1:
  s_add_u32 s31, s31, 0x1000000
  buffer_load_dwordx4 v[8:11], v2, s[8:11], s20 offen offset:0 sc1
  buffer_load_dwordx4 v[12:15], v2, s[8:11], s20 offen offset:1024 sc1
  buffer_load_dwordx4 v[16:19], v2, s[8:11], s20 offen offset:2048 sc1
  buffer_load_dwordx4 v[20:23], v2, s[8:11], s20 offen offset:3072 sc1
  buffer_load_dwordx4 v[24:27], v2, s[8:11], s23 offen offset:0 sc1
  buffer_load_dwordx4 v[28:31], v2, s[8:11], s23 offen offset:1024 sc1
  buffer_load_dwordx4 v[32:35], v2, s[8:11], s23 offen offset:2048 sc1
  s_waitcnt vmcnt(0)
  v_max3_u32 v36, v8, v9, v10
  v_max3_u32 v36, v36, v11, v12
  v_max3_u32 v36, v36, v13, v14
  v_max3_u32 v36, v36, v15, v16
  v_max3_u32 v36, v36, v17, v18
  v_max3_u32 v36, v36, v19, v20
  v_max3_u32 v36, v36, v21, v22
  v_max3_u32 v36, v36, v23, v24
  v_max3_u32 v36, v36, v25, v26
  v_max3_u32 v36, v36, v27, v28
  v_max3_u32 v36, v36, v29, v30
  v_max3_u32 v36, v36, v31, v32
  v_max3_u32 v36, v36, v33, v34
  v_max_u32 v36, v36, v35
  v_cmp_eq_u32 vcc, -1, v36
  s_cbranch_vccz cB_va1_sl2
  s_add_u32 s30, s30, 1
  s_cmp_lt_u32 s30, 400000
  s_cbranch_scc1 cB_va1_sl1
  s_branch cB_abort
cB_va1_sl2:
  v_mov_b32 v36, 0
  v_mov_b32 v37, 0
  v_mov_b32 v38, 0
  v_mov_b32 v39, 0
  v_mov_b32 v40, 0
  v_mov_b32 v41, 0
  v_mov_b32 v42, 0
  v_mov_b32 v43, 0
  v_mov_b32 v44, 0
  v_mov_b32 v45, 0
  v_mov_b32 v46, 0
  v_mov_b32 v47, 0
  v_mov_b32 v48, 0
  v_mov_b32 v49, 0
  v_mov_b32 v50, 0
  v_mov_b32 v51, 0
  v_mov_b32 v52, 0
  v_mov_b32 v53, 0
  v_mov_b32 v54, 0
  v_mov_b32 v55, 0
  v_mov_b32 v56, 0
  v_mov_b32 v57, 0
  v_mov_b32 v58, 0
  v_mov_b32 v59, 0
  v_mov_b32 v60, 0
  v_mov_b32 v61, 0
  v_mov_b32 v62, 0
  v_mov_b32 v63, 0
  buffer_store_dword v162, v1, s[8:11], s21 offen sc1
  ds_read_b128 v[64:67], v0 offset:0
  ds_read_b128 v[68:71], v0 offset:1024
  v_smfmac_f32_16x16x64_bf16 v[36:39], v[8:11], a[0:7], v3
  v_smfmac_f32_16x16x64_bf16 v[40:43], v[8:11], a[56:63], v3
  v_smfmac_f32_16x16x64_bf16 v[44:47], v[8:11], a[112:119], v3
  v_smfmac_f32_16x16x64_bf16 v[48:51], v[8:11], a[168:175], v3
  v_smfmac_f32_16x16x64_bf16 v[52:55], v[8:11], a[224:231], v3
  v_smfmac_f32_16x16x64_bf16 v[56:59], v[8:11], v[200:207], v3
  s_waitcnt lgkmcnt(0)
  v_smfmac_f32_16x16x64_bf16 v[60:63], v[8:11], v[64:71], v3
  ds_read_b128 v[72:75], v0 offset:2048
  ds_read_b128 v[76:79], v0 offset:3072
  v_smfmac_f32_16x16x64_bf16 v[36:39], v[12:15], a[8:15], v3
  v_smfmac_f32_16x16x64_bf16 v[40:43], v[12:15], a[64:71], v3
  v_smfmac_f32_16x16x64_bf16 v[44:47], v[12:15], a[120:127], v3
  v_smfmac_f32_16x16x64_bf16 v[48:51], v[12:15], a[176:183], v3
  v_smfmac_f32_16x16x64_bf16 v[52:55], v[12:15], a[232:239], v3
  v_smfmac_f32_16x16x64_bf16 v[56:59], v[12:15], v[208:215], v3
  s_waitcnt lgkmcnt(0)
  v_smfmac_f32_16x16x64_bf16 v[60:63], v[12:15], v[72:79], v3
  ds_read_b128 v[144:147], v0 offset:4096
  ds_read_b128 v[148:151], v0 offset:5120
  v_smfmac_f32_16x16x64_bf16 v[36:39], v[16:19], a[16:23], v3
  v_smfmac_f32_16x16x64_bf16 v[40:43], v[16:19], a[72:79], v3
  v_smfmac_f32_16x16x64_bf16 v[44:47], v[16:19], a[128:135], v3
  v_smfmac_f32_16x16x64_bf16 v[48:51], v[16:19], a[184:191], v3
  v_smfmac_f32_16x16x64_bf16 v[52:55], v[16:19], a[240:247], v3
  v_smfmac_f32_16x16x64_bf16 v[56:59], v[16:19], v[216:223], v3
  s_waitcnt lgkmcnt(0)
  v_smfmac_f32_16x16x64_bf16 v[60:63], v[16:19], v[144:151], v3
  ds_read_b128 v[64:67], v0 offset:6144
  ds_read_b128 v[68:71], v0 offset:7168
  v_smfmac_f32_16x16x64_bf16 v[36:39], v[20:23], a[24:31], v3
  v_smfmac_f32_16x16x64_bf16 v[40:43], v[20:23], a[80:87], v3
  v_smfmac_f32_16x16x64_bf16 v[44:47], v[20:23], a[136:143], v3
  v_smfmac_f32_16x16x64_bf16 v[48:51], v[20:23], a[192:199], v3
  v_smfmac_f32_16x16x64_bf16 v[52:55], v[20:23], a[248:255], v3
  v_smfmac_f32_16x16x64_bf16 v[56:59], v[20:23], v[224:231], v3
  s_waitcnt lgkmcnt(0)
  v_smfmac_f32_16x16x64_bf16 v[60:63], v[20:23], v[64:71], v3
  ds_read_b128 v[72:75], v0 offset:8192
  ds_read_b128 v[76:79], v0 offset:9216
  v_smfmac_f32_16x16x64_bf16 v[36:39], v[24:27], a[32:39], v3
  v_smfmac_f32_16x16x64_bf16 v[40:43], v[24:27], a[88:95], v3
  v_smfmac_f32_16x16x64_bf16 v[44:47], v[24:27], a[144:151], v3
  v_smfmac_f32_16x16x64_bf16 v[48:51], v[24:27], a[200:207], v3
  v_smfmac_f32_16x16x64_bf16 v[52:55], v[24:27], v[176:183], v3
  v_smfmac_f32_16x16x64_bf16 v[56:59], v[24:27], v[232:239], v3
  s_waitcnt lgkmcnt(0)
  v_smfmac_f32_16x16x64_bf16 v[60:63], v[24:27], v[72:79], v3
  ds_read_b128 v[144:147], v0 offset:10240
  ds_read_b128 v[148:151], v0 offset:11264
  v_smfmac_f32_16x16x64_bf16 v[36:39], v[28:31], a[40:47], v3
  v_smfmac_f32_16x16x64_bf16 v[40:43], v[28:31], a[96:103], v3
  v_smfmac_f32_16x16x64_bf16 v[44:47], v[28:31], a[152:159], v3
  v_smfmac_f32_16x16x64_bf16 v[48:51], v[28:31], a[208:215], v3
  v_smfmac_f32_16x16x64_bf16 v[52:55], v[28:31], v[184:191], v3
  v_smfmac_f32_16x16x64_bf16 v[56:59], v[28:31], v[240:247], v3
  s_waitcnt lgkmcnt(0)
  v_smfmac_f32_16x16x64_bf16 v[60:63], v[28:31], v[144:151], v3
  ds_read_b128 v[64:67], v0 offset:12288
  ds_read_b128 v[68:71], v0 offset:13312
  v_smfmac_f32_16x16x64_bf16 v[36:39], v[32:35], a[48:55], v3
  v_smfmac_f32_16x16x64_bf16 v[40:43], v[32:35], a[104:111], v3
  v_smfmac_f32_16x16x64_bf16 v[44:47], v[32:35], a[160:167], v3
  v_smfmac_f32_16x16x64_bf16 v[48:51], v[32:35], a[216:223], v3
  v_smfmac_f32_16x16x64_bf16 v[52:55], v[32:35], v[192:199], v3
  v_smfmac_f32_16x16x64_bf16 v[56:59], v[32:35], v[248:255], v3
  s_waitcnt lgkmcnt(0)
  v_smfmac_f32_16x16x64_bf16 v[60:63], v[32:35], v[64:71], v3
  v_permlane32_swap_b32 v36, v38
  v_permlane32_swap_b32 v37, v39
  v_add_f32 v36, v36, v38
  v_add_f32 v37, v37, v39
  v_cvt_pk_bf16_f32 v38, v36, v37
  ds_write_b32 v152, v38
  v_permlane32_swap_b32 v40, v42
  v_permlane32_swap_b32 v41, v43
  v_add_f32 v40, v40, v42
  v_add_f32 v41, v41, v43
  v_cvt_pk_bf16_f32 v42, v40, v41
  ds_write_b32 v153, v42
  v_permlane32_swap_b32 v44, v46
  v_permlane32_swap_b32 v45, v47
  v_add_f32 v44, v44, v46
  v_add_f32 v45, v45, v47
  v_cvt_pk_bf16_f32 v46, v44, v45
  ds_write_b32 v154, v46
  v_permlane32_swap_b32 v48, v50
  v_permlane32_swap_b32 v49, v51
  v_add_f32 v48, v48, v50
  v_add_f32 v49, v49, v51
  v_cvt_pk_bf16_f32 v50, v48, v49
  ds_write_b32 v155, v50
  v_permlane32_swap_b32 v52, v54
  v_permlane32_swap_b32 v53, v55
  v_add_f32 v52, v52, v54
  v_add_f32 v53, v53, v55
  v_cvt_pk_bf16_f32 v54, v52, v53
  ds_write_b32 v156, v54
  v_permlane32_swap_b32 v56, v58
  v_permlane32_swap_b32 v57, v59
  v_add_f32 v56, v56, v58
  v_add_f32 v57, v57, v59
  v_cvt_pk_bf16_f32 v58, v56, v57
  ds_write_b32 v157, v58
  v_permlane32_swap_b32 v60, v62
  v_permlane32_swap_b32 v61, v63
  v_add_f32 v60, v60, v62
  v_add_f32 v61, v61, v63
  v_cvt_pk_bf16_f32 v62, v60, v61
  ds_write_b32 v158, v62
  s_branch cB_va1_t2d
cB_va1_rp:
  s_cmp_lg_u32 s37, 0
  s_cbranch_scc1 cB_va1_cont
cB_va1_rv:
  s_add_u32 s31, s31, 0x10000
  buffer_load_dwordx4 v[8:11], v2, s[8:11], s22 offen offset:0 sc1
  buffer_load_dwordx4 v[12:15], v2, s[8:11], s22 offen offset:1024 sc1
  buffer_load_dwordx4 v[16:19], v2, s[8:11], s22 offen offset:2048 sc1
  buffer_load_dwordx4 v[20:23], v2, s[8:11], s22 offen offset:3072 sc1
  buffer_load_dwordx4 v[24:27], v2, s[8:11], s34 offen offset:0 sc1
  buffer_load_dwordx4 v[28:31], v2, s[8:11], s34 offen offset:1024 sc1
  buffer_load_dwordx4 v[32:35], v2, s[8:11], s34 offen offset:2048 sc1
  buffer_load_dwordx4 v[36:39], v2, s[8:11], s34 offen offset:3072 sc1
  buffer_load_dwordx4 v[40:43], v2, s[8:11], s36 offen offset:0 sc1
  buffer_load_dwordx4 v[44:47], v2, s[8:11], s36 offen offset:1024 sc1
  s_waitcnt vmcnt(0)
  v_max3_u32 v52, v8, v9, v10
  v_max3_u32 v52, v52, v11, v12
  v_max3_u32 v52, v52, v13, v14
  v_max3_u32 v52, v52, v15, v16
  v_max3_u32 v52, v52, v17, v18
  v_max3_u32 v52, v52, v19, v20
  v_max3_u32 v52, v52, v21, v22
  v_max3_u32 v52, v52, v23, v24
  v_max3_u32 v52, v52, v25, v26
  v_max3_u32 v52, v52, v27, v28
  v_max3_u32 v52, v52, v29, v30
  v_max3_u32 v52, v52, v31, v32
  v_max3_u32 v52, v52, v33, v34
  v_max3_u32 v52, v52, v35, v36
  v_max3_u32 v52, v52, v37, v38
  v_max3_u32 v52, v52, v39, v40
  v_max3_u32 v52, v52, v41, v42
  v_max3_u32 v52, v52, v43, v44
  v_max3_u32 v52, v52, v45, v46
  v_max_u32 v52, v52, v47
  v_cmp_eq_u32 vcc, -1, v52
  s_mov_b32 s37, 1
  v_mov_b32 v48, 0
  v_mov_b32 v49, 0
  v_mov_b32 v50, 0
  v_mov_b32 v51, 0
  s_nop 1
  s_cbranch_vccz cB_va1_lp
  s_add_u32 s30, s30, 1
  s_cmp_lt_u32 s30, 400000
  s_cbranch_scc1 cB_va1_rv
  s_branch cB_abort
.p2align 6
cB_va2_loop:
  s_mov_b32 s30, 0
  buffer_load_dword v88, v119, s[8:11], 0 offen sc1
  buffer_load_dword v89, v119, s[8:11], 0 offen sc1
  buffer_load_dword v90, v119, s[8:11], 0 offen sc1
  buffer_load_dword v91, v119, s[8:11], 0 offen sc1
  buffer_load_dword v92, v119, s[8:11], 0 offen sc1
cB_va2_fp_l:
  s_waitcnt vmcnt(4)
  v_cmp_gt_u32 vcc, s19, v88
  buffer_load_dword v88, v119, s[8:11], 0 offen sc1
  s_cbranch_vccz cB_va2_fp_d
  s_waitcnt vmcnt(4)
  v_cmp_gt_u32 vcc, s19, v89
  buffer_load_dword v89, v119, s[8:11], 0 offen sc1
  s_cbranch_vccz cB_va2_fp_d
  s_waitcnt vmcnt(4)
  v_cmp_gt_u32 vcc, s19, v90
  buffer_load_dword v90, v119, s[8:11], 0 offen sc1
  s_cbranch_vccz cB_va2_fp_d
  s_waitcnt vmcnt(4)
  v_cmp_gt_u32 vcc, s19, v91
  buffer_load_dword v91, v119, s[8:11], 0 offen sc1
  s_cbranch_vccz cB_va2_fp_d
  s_waitcnt vmcnt(4)
  v_cmp_gt_u32 vcc, s19, v92
  buffer_load_dword v92, v119, s[8:11], 0 offen sc1
  s_cbranch_vccz cB_va2_fp_d
  s_waitcnt vmcnt(4)
  v_cmp_gt_u32 vcc, s19, v88
  buffer_load_dword v88, v119, s[8:11], 0 offen sc1
  s_cbranch_vccz cB_va2_fp_d
  s_waitcnt vmcnt(4)
  v_cmp_gt_u32 vcc, s19, v89
  buffer_load_dword v89, v119, s[8:11], 0 offen sc1
  s_cbranch_vccz cB_va2_fp_d
  s_waitcnt vmcnt(4)
  v_cmp_gt_u32 vcc, s19, v90
  buffer_load_dword v90, v119, s[8:11], 0 offen sc1
  s_cbranch_vccz cB_va2_fp_d
  s_waitcnt vmcnt(4)
  v_cmp_gt_u32 vcc, s19, v91
  buffer_load_dword v91, v119, s[8:11], 0 offen sc1
  s_cbranch_vccz cB_va2_fp_d
  s_waitcnt vmcnt(4)
  v_cmp_gt_u32 vcc, s19, v92
  buffer_load_dword v92, v119, s[8:11], 0 offen sc1
  s_cbranch_vccz cB_va2_fp_d
  s_waitcnt vmcnt(4)
  v_cmp_gt_u32 vcc, s19, v88
  buffer_load_dword v88, v119, s[8:11], 0 offen sc1
  s_cbranch_vccz cB_va2_fp_d
  s_waitcnt vmcnt(4)
  v_cmp_gt_u32 vcc, s19, v89
  buffer_load_dword v89, v119, s[8:11], 0 offen sc1
  s_cbranch_vccz cB_va2_fp_d
  s_waitcnt vmcnt(4)
  v_cmp_gt_u32 vcc, s19, v90
  buffer_load_dword v90, v119, s[8:11], 0 offen sc1
  s_cbranch_vccz cB_va2_fp_d
  s_waitcnt vmcnt(4)
  v_cmp_gt_u32 vcc, s19, v91
  buffer_load_dword v91, v119, s[8:11], 0 offen sc1
  s_cbranch_vccz cB_va2_fp_d
  s_waitcnt vmcnt(4)
  v_cmp_gt_u32 vcc, s19, v92
  buffer_load_dword v92, v119, s[8:11], 0 offen sc1
  s_cbranch_vccz cB_va2_fp_d
  s_add_u32 s30, s30, 1
  s_cmp_lt_u32 s30, 400000
  s_cbranch_scc1 cB_va2_fp_l
  s_branch cB_abort
cB_va2_fp_d:
  buffer_load_dwordx4 v[8:11], v2, s[8:11], s20 offen offset:0 sc1
  buffer_load_dwordx4 v[12:15], v2, s[8:11], s20 offen offset:1024 sc1
  s_barrier
  s_barrier
  s_waitcnt vmcnt(0)
  ds_write_b128 v2, v[8:11] offset:8192
  ds_write_b128 v2, v[12:15] offset:9216
  v_smfmac_f32_16x16x64_bf16 v[36:39], v[8:11], a[0:7], v3
  v_smfmac_f32_16x16x64_bf16 v[40:43], v[8:11], a[56:63], v3
  v_smfmac_f32_16x16x64_bf16 v[44:47], v[8:11], a[112:119], v3
  v_smfmac_f32_16x16x64_bf16 v[48:51], v[8:11], a[168:175], v3
  v_smfmac_f32_16x16x64_bf16 v[52:55], v[8:11], a[224:231], v3
  s_waitcnt lgkmcnt(0)
  s_barrier
  ds_read_b128 v[16:19], v2 offset:10240
  ds_read_b128 v[20:23], v2 offset:11264
  ds_read_b128 v[24:27], v2 offset:12288
  ds_read_b128 v[28:31], v2 offset:13312
  ds_read_b128 v[32:35], v2 offset:14336
  v_smfmac_f32_16x16x64_bf16 v[56:59], v[8:11], v[144:151], v3
  v_smfmac_f32_16x16x64_bf16 v[60:63], v[8:11], v[200:207], v3
  v_smfmac_f32_16x16x64_bf16 v[36:39], v[12:15], a[8:15], v3
  v_smfmac_f32_16x16x64_bf16 v[40:43], v[12:15], a[64:71], v3
  v_smfmac_f32_16x16x64_bf16 v[44:47], v[12:15], a[120:127], v3
  v_smfmac_f32_16x16x64_bf16 v[48:51], v[12:15], a[176:183], v3
  v_smfmac_f32_16x16x64_bf16 v[52:55], v[12:15], a[232:239], v3
  v_smfmac_f32_16x16x64_bf16 v[56:59], v[12:15], v[152:159], v3
  v_smfmac_f32_16x16x64_bf16 v[60:63], v[12:15], v[208:215], v3
  s_waitcnt lgkmcnt(4)
  v_smfmac_f32_16x16x64_bf16 v[36:39], v[16:19], a[16:23], v3
  s_waitcnt lgkmcnt(3)
  v_smfmac_f32_16x16x64_bf16 v[36:39], v[20:23], a[24:31], v3
  s_waitcnt lgkmcnt(2)
  v_smfmac_f32_16x16x64_bf16 v[36:39], v[24:27], a[32:39], v3
  s_waitcnt lgkmcnt(1)
  v_smfmac_f32_16x16x64_bf16 v[36:39], v[28:31], a[40:47], v3
  s_waitcnt lgkmcnt(0)
  v_smfmac_f32_16x16x64_bf16 v[36:39], v[32:35], a[48:55], v3
  v_smfmac_f32_16x16x64_bf16 v[40:43], v[16:19], a[72:79], v3
  v_smfmac_f32_16x16x64_bf16 v[40:43], v[20:23], a[80:87], v3
  v_smfmac_f32_16x16x64_bf16 v[40:43], v[24:27], a[88:95], v3
  v_permlane32_swap_b32 v36, v38
  v_smfmac_f32_16x16x64_bf16 v[40:43], v[28:31], a[96:103], v3
  v_permlane32_swap_b32 v37, v39
  v_smfmac_f32_16x16x64_bf16 v[40:43], v[32:35], a[104:111], v3
  v_add_f32 v36, v36, v38
  v_smfmac_f32_16x16x64_bf16 v[44:47], v[16:19], a[128:135], v3
  v_add_f32 v37, v37, v39
  v_smfmac_f32_16x16x64_bf16 v[44:47], v[20:23], a[136:143], v3
  v_cmp_u_f32 vcc, v36, v37
  v_smfmac_f32_16x16x64_bf16 v[44:47], v[24:27], a[144:151], v3
  v_cvt_pk_bf16_f32 v38, v36, v37
  v_smfmac_f32_16x16x64_bf16 v[44:47], v[28:31], a[152:159], v3
  ds_write_b32 v104, v38
  s_cbranch_vccnz cB_va2_slow
  v_permlane32_swap_b32 v40, v42
  v_smfmac_f32_16x16x64_bf16 v[44:47], v[32:35], a[160:167], v3
  v_permlane32_swap_b32 v41, v43
  v_smfmac_f32_16x16x64_bf16 v[48:51], v[16:19], a[184:191], v3
  v_add_f32 v40, v40, v42
  v_smfmac_f32_16x16x64_bf16 v[48:51], v[20:23], a[192:199], v3
  v_add_f32 v41, v41, v43
  v_smfmac_f32_16x16x64_bf16 v[48:51], v[24:27], a[200:207], v3
  v_cvt_pk_bf16_f32 v42, v40, v41
  v_smfmac_f32_16x16x64_bf16 v[48:51], v[28:31], a[208:215], v3
  ds_write_b32 v105, v42
  v_permlane32_swap_b32 v44, v46
  v_smfmac_f32_16x16x64_bf16 v[48:51], v[32:35], a[216:223], v3
  v_permlane32_swap_b32 v45, v47
  v_smfmac_f32_16x16x64_bf16 v[52:55], v[16:19], a[240:247], v3
  v_add_f32 v44, v44, v46
  v_smfmac_f32_16x16x64_bf16 v[52:55], v[20:23], a[248:255], v3
  v_add_f32 v45, v45, v47
  v_smfmac_f32_16x16x64_bf16 v[52:55], v[24:27], v[120:127], v3
  v_cvt_pk_bf16_f32 v46, v44, v45
  v_smfmac_f32_16x16x64_bf16 v[52:55], v[28:31], v[128:135], v3
  ds_write_b32 v106, v46
  v_permlane32_swap_b32 v48, v50
  v_smfmac_f32_16x16x64_bf16 v[52:55], v[32:35], v[136:143], v3
  v_permlane32_swap_b32 v49, v51
  v_smfmac_f32_16x16x64_bf16 v[56:59], v[16:19], v[160:167], v3
  v_add_f32 v48, v48, v50
  v_smfmac_f32_16x16x64_bf16 v[56:59], v[20:23], v[168:175], v3
  v_add_f32 v49, v49, v51
  v_smfmac_f32_16x16x64_bf16 v[56:59], v[24:27], v[176:183], v3
  v_cvt_pk_bf16_f32 v50, v48, v49
  v_smfmac_f32_16x16x64_bf16 v[56:59], v[28:31], v[184:191], v3
  ds_write_b32 v107, v50
  v_permlane32_swap_b32 v52, v54
  v_smfmac_f32_16x16x64_bf16 v[56:59], v[32:35], v[192:199], v3
  v_permlane32_swap_b32 v53, v55
  v_smfmac_f32_16x16x64_bf16 v[60:63], v[16:19], v[216:223], v3
  v_add_f32 v52, v52, v54
  v_smfmac_f32_16x16x64_bf16 v[60:63], v[20:23], v[224:231], v3
  v_add_f32 v53, v53, v55
  v_smfmac_f32_16x16x64_bf16 v[60:63], v[24:27], v[232:239], v3
  v_cvt_pk_bf16_f32 v54, v52, v53
  v_smfmac_f32_16x16x64_bf16 v[60:63], v[28:31], v[240:247], v3
  ds_write_b32 v108, v54
  v_permlane32_swap_b32 v56, v58
  v_smfmac_f32_16x16x64_bf16 v[60:63], v[32:35], v[248:255], v3
  v_permlane32_swap_b32 v57, v59
  v_add_f32 v56, v56, v58
  v_add_f32 v57, v57, v59
  v_cvt_pk_bf16_f32 v58, v56, v57
  ds_write_b32 v109, v58
  s_nop 2
  v_permlane32_swap_b32 v60, v62
  v_permlane32_swap_b32 v61, v63
  v_add_f32 v60, v60, v62
  v_add_f32 v61, v61, v63
  v_cvt_pk_bf16_f32 v62, v60, v61
  ds_write_b32 v110, v62
cB_va2_t2d:
  v_mov_b32 v117, s18
  s_waitcnt lgkmcnt(0)
  s_barrier
  s_cmp_eq_u32 s19, 62
  s_cbranch_scc1 cB_done
  s_sleep 1
  v_mov_b32 v36, 0
  v_mov_b32 v37, 0
  v_mov_b32 v38, 0
  v_mov_b32 v39, 0
  v_mov_b32 v40, 0
  v_mov_b32 v41, 0
  v_mov_b32 v42, 0
  v_mov_b32 v43, 0
  v_mov_b32 v44, 0
  v_mov_b32 v45, 0
  v_mov_b32 v46, 0
  v_mov_b32 v47, 0
  v_mov_b32 v48, 0
  v_mov_b32 v49, 0
  v_mov_b32 v50, 0
  v_mov_b32 v51, 0
  v_mov_b32 v52, 0
  v_mov_b32 v53, 0
  v_mov_b32 v54, 0
  v_mov_b32 v55, 0
  v_mov_b32 v56, 0
  v_mov_b32 v57, 0
  v_mov_b32 v58, 0
  v_mov_b32 v59, 0
  v_mov_b32 v60, 0
  v_mov_b32 v61, 0
  v_mov_b32 v62, 0
  v_mov_b32 v63, 0
  s_sleep 5
  s_mov_b32 s19, s18
  s_add_u32 s18, s18, 1
  s_mov_b32 s22, s20
  s_mov_b32 s20, s21
  s_mov_b32 s21, s22
  s_add_u32 s23, s20, 4096
  s_branch cB_va2_loop
cB_va2_slow:
  s_waitcnt lgkmcnt(0)
cB_va2_sl1:
  s_add_u32 s31, s31, 0x1000000
  buffer_load_dwordx4 v[8:11], v2, s[8:11], s20 offen offset:0 sc1
  buffer_load_dwordx4 v[12:15], v2, s[8:11], s20 offen offset:1024 sc1
  buffer_load_dwordx4 v[16:19], v2, s[8:11], s20 offen offset:2048 sc1
  buffer_load_dwordx4 v[20:23], v2, s[8:11], s20 offen offset:3072 sc1
  buffer_load_dwordx4 v[24:27], v2, s[8:11], s23 offen offset:0 sc1
  buffer_load_dwordx4 v[28:31], v2, s[8:11], s23 offen offset:1024 sc1
  buffer_load_dwordx4 v[32:35], v2, s[8:11], s23 offen offset:2048 sc1
  s_waitcnt vmcnt(0)
  v_max3_u32 v36, v8, v9, v10
  v_max3_u32 v36, v36, v11, v12
  v_max3_u32 v36, v36, v13, v14
  v_max3_u32 v36, v36, v15, v16
  v_max3_u32 v36, v36, v17, v18
  v_max3_u32 v36, v36, v19, v20
  v_max3_u32 v36, v36, v21, v22
  v_max3_u32 v36, v36, v23, v24
  v_max3_u32 v36, v36, v25, v26
  v_max3_u32 v36, v36, v27, v28
  v_max3_u32 v36, v36, v29, v30
  v_max3_u32 v36, v36, v31, v32
  v_max3_u32 v36, v36, v33, v34
  v_max_u32 v36, v36, v35
  v_cmp_eq_u32 vcc, -1, v36
  s_cbranch_vccz cB_va2_sl2
  s_add_u32 s30, s30, 1
  s_cmp_lt_u32 s30, 400000
  s_cbranch_scc1 cB_va2_sl1
  s_branch cB_abort
cB_va2_sl2:
  v_mov_b32 v36, 0
  v_mov_b32 v37, 0
  v_mov_b32 v38, 0
  v_mov_b32 v39, 0
  v_mov_b32 v40, 0
  v_mov_b32 v41, 0
  v_mov_b32 v42, 0
  v_mov_b32 v43, 0
  v_mov_b32 v44, 0
  v_mov_b32 v45, 0
  v_mov_b32 v46, 0
  v_mov_b32 v47, 0
  v_mov_b32 v48, 0
  v_mov_b32 v49, 0
  v_mov_b32 v50, 0
  v_mov_b32 v51, 0
  v_mov_b32 v52, 0
  v_mov_b32 v53, 0
  v_mov_b32 v54, 0
  v_mov_b32 v55, 0
  v_mov_b32 v56, 0
  v_mov_b32 v57, 0
  v_mov_b32 v58, 0
  v_mov_b32 v59, 0
  v_mov_b32 v60, 0
  v_mov_b32 v61, 0
  v_mov_b32 v62, 0
  v_mov_b32 v63, 0
  v_smfmac_f32_16x16x64_bf16 v[36:39], v[8:11], a[0:7], v3
  v_smfmac_f32_16x16x64_bf16 v[40:43], v[8:11], a[56:63], v3
  v_smfmac_f32_16x16x64_bf16 v[44:47], v[8:11], a[112:119], v3
  v_smfmac_f32_16x16x64_bf16 v[48:51], v[8:11], a[168:175], v3
  v_smfmac_f32_16x16x64_bf16 v[52:55], v[8:11], a[224:231], v3
  v_smfmac_f32_16x16x64_bf16 v[56:59], v[8:11], v[144:151], v3
  v_smfmac_f32_16x16x64_bf16 v[60:63], v[8:11], v[200:207], v3
  v_smfmac_f32_16x16x64_bf16 v[36:39], v[12:15], a[8:15], v3
  v_smfmac_f32_16x16x64_bf16 v[40:43], v[12:15], a[64:71], v3
  v_smfmac_f32_16x16x64_bf16 v[44:47], v[12:15], a[120:127], v3
  v_smfmac_f32_16x16x64_bf16 v[48:51], v[12:15], a[176:183], v3
  v_smfmac_f32_16x16x64_bf16 v[52:55], v[12:15], a[232:239], v3
  v_smfmac_f32_16x16x64_bf16 v[56:59], v[12:15], v[152:159], v3
  v_smfmac_f32_16x16x64_bf16 v[60:63], v[12:15], v[208:215], v3
  v_smfmac_f32_16x16x64_bf16 v[36:39], v[16:19], a[16:23], v3
  v_smfmac_f32_16x16x64_bf16 v[40:43], v[16:19], a[72:79], v3
  v_smfmac_f32_16x16x64_bf16 v[44:47], v[16:19], a[128:135], v3
  v_smfmac_f32_16x16x64_bf16 v[48:51], v[16:19], a[184:191], v3
  v_smfmac_f32_16x16x64_bf16 v[52:55], v[16:19], a[240:247], v3
  v_smfmac_f32_16x16x64_bf16 v[56:59], v[16:19], v[160:167], v3
  v_smfmac_f32_16x16x64_bf16 v[60:63], v[16:19], v[216:223], v3
  v_smfmac_f32_16x16x64_bf16 v[36:39], v[20:23], a[24:31], v3
  v_smfmac_f32_16x16x64_bf16 v[40:43], v[20:23], a[80:87], v3
  v_smfmac_f32_16x16x64_bf16 v[44:47], v[20:23], a[136:143], v3
  v_smfmac_f32_16x16x64_bf16 v[48:51], v[20:23], a[192:199], v3
  v_smfmac_f32_16x16x64_bf16 v[52:55], v[20:23], a[248:255], v3
  v_smfmac_f32_16x16x64_bf16 v[56:59], v[20:23], v[168:175], v3
  v_smfmac_f32_16x16x64_bf16 v[60:63], v[20:23], v[224:231], v3
  v_smfmac_f32_16x16x64_bf16 v[36:39], v[24:27], a[32:39], v3
  v_smfmac_f32_16x16x64_bf16 v[40:43], v[24:27], a[88:95], v3
  v_smfmac_f32_16x16x64_bf16 v[44:47], v[24:27], a[144:151], v3
  v_smfmac_f32_16x16x64_bf16 v[48:51], v[24:27], a[200:207], v3
  v_smfmac_f32_16x16x64_bf16 v[52:55], v[24:27], v[120:127], v3
  v_smfmac_f32_16x16x64_bf16 v[56:59], v[24:27], v[176:183], v3
  v_smfmac_f32_16x16x64_bf16 v[60:63], v[24:27], v[232:239], v3
  v_smfmac_f32_16x16x64_bf16 v[36:39], v[28:31], a[40:47], v3
  v_smfmac_f32_16x16x64_bf16 v[40:43], v[28:31], a[96:103], v3
  v_smfmac_f32_16x16x64_bf16 v[44:47], v[28:31], a[152:159], v3
  v_smfmac_f32_16x16x64_bf16 v[48:51], v[28:31], a[208:215], v3
  v_smfmac_f32_16x16x64_bf16 v[52:55], v[28:31], v[128:135], v3
  v_smfmac_f32_16x16x64_bf16 v[56:59], v[28:31], v[184:191], v3
  v_smfmac_f32_16x16x64_bf16 v[60:63], v[28:31], v[240:247], v3
  v_smfmac_f32_16x16x64_bf16 v[36:39], v[32:35], a[48:55], v3
  v_smfmac_f32_16x16x64_bf16 v[40:43], v[32:35], a[104:111], v3
  v_smfmac_f32_16x16x64_bf16 v[44:47], v[32:35], a[160:167], v3
  v_smfmac_f32_16x16x64_bf16 v[48:51], v[32:35], a[216:223], v3
  v_smfmac_f32_16x16x64_bf16 v[52:55], v[32:35], v[136:143], v3
  v_smfmac_f32_16x16x64_bf16 v[56:59], v[32:35], v[192:199], v3
  v_smfmac_f32_16x16x64_bf16 v[60:63], v[32:35], v[248:255], v3
  v_permlane32_swap_b32 v36, v38
  v_permlane32_swap_b32 v37, v39
  v_add_f32 v36, v36, v38
  v_add_f32 v37, v37, v39
  v_cvt_pk_bf16_f32 v38, v36, v37
  ds_write_b32 v104, v38
  v_permlane32_swap_b32 v40, v42
  v_permlane32_swap_b32 v41, v43
  v_add_f32 v40, v40, v42
  v_add_f32 v41, v41, v43
  v_cvt_pk_bf16_f32 v42, v40, v41
  ds_write_b32 v105, v42
  v_permlane32_swap_b32 v44, v46
  v_permlane32_swap_b32 v45, v47
  v_add_f32 v44, v44, v46
  v_add_f32 v45, v45, v47
  v_cvt_pk_bf16_f32 v46, v44, v45
  ds_write_b32 v106, v46
  v_permlane32_swap_b32 v48, v50
  v_permlane32_swap_b32 v49, v51
  v_add_f32 v48, v48, v50
  v_add_f32 v49, v49, v51
  v_cvt_pk_bf16_f32 v50, v48, v49
  ds_write_b32 v107, v50
  v_permlane32_swap_b32 v52, v54
  v_permlane32_swap_b32 v53, v55
  v_add_f32 v52, v52, v54
  v_add_f32 v53, v53, v55
  v_cvt_pk_bf16_f32 v54, v52, v53
  ds_write_b32 v108, v54
  v_permlane32_swap_b32 v56, v58
  v_permlane32_swap_b32 v57, v59
  v_add_f32 v56, v56, v58
  v_add_f32 v57, v57, v59
  v_cvt_pk_bf16_f32 v58, v56, v57
  ds_write_b32 v109, v58
  v_permlane32_swap_b32 v60, v62
  v_permlane32_swap_b32 v61, v63
  v_add_f32 v60, v60, v62
  v_add_f32 v61, v61, v63
  v_cvt_pk_bf16_f32 v62, v60, v61
  ds_write_b32 v110, v62
  s_branch cB_va2_t2d
.p2align 6
cB_va3_loop:
  s_mov_b32 s30, 0
  s_barrier
  buffer_load_dwordx4 v[16:19], v2, s[8:11], s20 offen offset:2048 sc1
  buffer_load_dwordx4 v[20:23], v2, s[8:11], s20 offen offset:3072 sc1
  s_barrier
  buffer_load_dword v100, v116, s[8:11], s39 offen sc1
  s_add_u32 s27, s19, 2
  s_min_u32 s27, s27, 63
  s_lshr_b32 s27, s27, 3
  s_lshl_b32 s27, s27, 11
  s_add_u32 s27, s27, s35
  s_cmp_eq_u32 s27, s28
  s_cselect_b32 s29, 75729408, s27
  buffer_load_dword v101, off, s[8:11], s29 sc1
  s_add_u32 s39, s39, 28672
  s_waitcnt vmcnt(2)
  ds_write_b128 v2, v[16:19] offset:10240
  ds_write_b128 v2, v[20:23] offset:11264
  v_smfmac_f32_16x16x64_bf16 v[36:39], v[16:19], a[16:23], v3
  v_smfmac_f32_16x16x64_bf16 v[40:43], v[16:19], a[72:79], v3
  v_smfmac_f32_16x16x64_bf16 v[44:47], v[16:19], a[128:135], v3
  v_smfmac_f32_16x16x64_bf16 v[48:51], v[16:19], a[184:191], v3
  v_smfmac_f32_16x16x64_bf16 v[52:55], v[16:19], a[240:247], v3
  s_waitcnt lgkmcnt(0)
  s_barrier
  ds_read_b128 v[8:11], v2 offset:8192
  ds_read_b128 v[12:15], v2 offset:9216
  ds_read_b128 v[24:27], v2 offset:12288
  ds_read_b128 v[28:31], v2 offset:13312
  ds_read_b128 v[32:35], v2 offset:14336
  v_smfmac_f32_16x16x64_bf16 v[56:59], v[16:19], v[160:167], v3
  v_smfmac_f32_16x16x64_bf16 v[60:63], v[16:19], v[216:223], v3
  v_smfmac_f32_16x16x64_bf16 v[36:39], v[20:23], a[24:31], v3
  v_smfmac_f32_16x16x64_bf16 v[40:43], v[20:23], a[80:87], v3
  v_smfmac_f32_16x16x64_bf16 v[44:47], v[20:23], a[136:143], v3
  v_smfmac_f32_16x16x64_bf16 v[48:51], v[20:23], a[192:199], v3
  v_smfmac_f32_16x16x64_bf16 v[52:55], v[20:23], a[248:255], v3
  v_smfmac_f32_16x16x64_bf16 v[56:59], v[20:23], v[168:175], v3
  v_smfmac_f32_16x16x64_bf16 v[60:63], v[20:23], v[224:231], v3
  s_waitcnt lgkmcnt(4)
  v_smfmac_f32_16x16x64_bf16 v[36:39], v[8:11], a[0:7], v3
  s_waitcnt lgkmcnt(3)
  v_smfmac_f32_16x16x64_bf16 v[36:39], v[12:15], a[8:15], v3
  s_waitcnt lgkmcnt(2)
  v_smfmac_f32_16x16x64_bf16 v[36:39], v[24:27], a[32:39], v3
  s_waitcnt lgkmcnt(1)
  v_smfmac_f32_16x16x64_bf16 v[36:39], v[28:31], a[40:47], v3
  s_waitcnt lgkmcnt(0)
  v_smfmac_f32_16x16x64_bf16 v[36:39], v[32:35], a[48:55], v3
  v_smfmac_f32_16x16x64_bf16 v[40:43], v[8:11], a[56:63], v3
  v_smfmac_f32_16x16x64_bf16 v[40:43], v[12:15], a[64:71], v3
  v_smfmac_f32_16x16x64_bf16 v[40:43], v[24:27], a[88:95], v3
  v_permlane32_swap_b32 v36, v38
  v_smfmac_f32_16x16x64_bf16 v[40:43], v[28:31], a[96:103], v3
  v_permlane32_swap_b32 v37, v39
  v_smfmac_f32_16x16x64_bf16 v[40:43], v[32:35], a[104:111], v3
  v_add_f32 v36, v36, v38
  v_smfmac_f32_16x16x64_bf16 v[44:47], v[8:11], a[112:119], v3
  v_add_f32 v37, v37, v39
  v_smfmac_f32_16x16x64_bf16 v[44:47], v[12:15], a[120:127], v3
  v_cmp_u_f32 vcc, v36, v37
  v_smfmac_f32_16x16x64_bf16 v[44:47], v[24:27], a[144:151], v3
  v_cvt_pk_bf16_f32 v38, v36, v37
  v_smfmac_f32_16x16x64_bf16 v[44:47], v[28:31], a[152:159], v3
  ds_write_b32 v104, v38
  s_cbranch_vccnz cB_va3_slow
  v_permlane32_swap_b32 v40, v42
  v_smfmac_f32_16x16x64_bf16 v[44:47], v[32:35], a[160:167], v3
  v_permlane32_swap_b32 v41, v43
  v_smfmac_f32_16x16x64_bf16 v[48:51], v[8:11], a[168:175], v3
  v_add_f32 v40, v40, v42
  v_smfmac_f32_16x16x64_bf16 v[48:51], v[12:15], a[176:183], v3
  v_add_f32 v41, v41, v43
  v_smfmac_f32_16x16x64_bf16 v[48:51], v[24:27], a[200:207], v3
  v_cvt_pk_bf16_f32 v42, v40, v41
  v_smfmac_f32_16x16x64_bf16 v[48:51], v[28:31], a[208:215], v3
  ds_write_b32 v105, v42
  v_permlane32_swap_b32 v44, v46
  v_smfmac_f32_16x16x64_bf16 v[48:51], v[32:35], a[216:223], v3
  v_permlane32_swap_b32 v45, v47
  v_smfmac_f32_16x16x64_bf16 v[52:55], v[8:11], a[224:231], v3
  v_add_f32 v44, v44, v46
  v_smfmac_f32_16x16x64_bf16 v[52:55], v[12:15], a[232:239], v3
  v_add_f32 v45, v45, v47
  v_smfmac_f32_16x16x64_bf16 v[52:55], v[24:27], v[120:127], v3
  v_cvt_pk_bf16_f32 v46, v44, v45
  v_smfmac_f32_16x16x64_bf16 v[52:55], v[28:31], v[128:135], v3
  ds_write_b32 v106, v46
  v_permlane32_swap_b32 v48, v50
  v_smfmac_f32_16x16x64_bf16 v[52:55], v[32:35], v[136:143], v3
  v_permlane32_swap_b32 v49, v51
  v_smfmac_f32_16x16x64_bf16 v[56:59], v[8:11], v[144:151], v3
  v_add_f32 v48, v48, v50
  v_smfmac_f32_16x16x64_bf16 v[56:59], v[12:15], v[152:159], v3
  v_add_f32 v49, v49, v51
  v_smfmac_f32_16x16x64_bf16 v[56:59], v[24:27], v[176:183], v3
  v_cvt_pk_bf16_f32 v50, v48, v49
  v_smfmac_f32_16x16x64_bf16 v[56:59], v[28:31], v[184:191], v3
  ds_write_b32 v107, v50
  v_permlane32_swap_b32 v52, v54
  v_smfmac_f32_16x16x64_bf16 v[56:59], v[32:35], v[192:199], v3
  v_permlane32_swap_b32 v53, v55
  v_smfmac_f32_16x16x64_bf16 v[60:63], v[8:11], v[200:207], v3
  v_add_f32 v52, v52, v54
  v_smfmac_f32_16x16x64_bf16 v[60:63], v[12:15], v[208:215], v3
  v_add_f32 v53, v53, v55
  v_smfmac_f32_16x16x64_bf16 v[60:63], v[24:27], v[232:239], v3
  v_cvt_pk_bf16_f32 v54, v52, v53
  v_smfmac_f32_16x16x64_bf16 v[60:63], v[28:31], v[240:247], v3
  ds_write_b32 v108, v54
  v_permlane32_swap_b32 v56, v58
  v_smfmac_f32_16x16x64_bf16 v[60:63], v[32:35], v[248:255], v3
  v_permlane32_swap_b32 v57, v59
  v_add_f32 v56, v56, v58
  v_add_f32 v57, v57, v59
  v_cvt_pk_bf16_f32 v58, v56, v57
  ds_write_b32 v109, v58
  s_nop 2
  v_permlane32_swap_b32 v60, v62
  v_permlane32_swap_b32 v61, v63
  v_add_f32 v60, v60, v62
  v_add_f32 v61, v61, v63
  v_cvt_pk_bf16_f32 v62, v60, v61
  ds_write_b32 v110, v62
cB_va3_t2d:
  v_mov_b32 v117, s18
  s_cmp_eq_u32 s27, s28
  s_cbranch_scc1 cB_va3_vok
cB_va3_vow:
  s_waitcnt vmcnt(0)
  v_cmp_ne_u32 vcc, 56, v101
  s_cbranch_vccnz cB_va3_vor
  s_mov_b32 s28, s27
cB_va3_vok:
  s_waitcnt lgkmcnt(0)
  s_setprio 3
  s_barrier
  v_mov_b32 v36, 0
  v_mov_b32 v37, 0
  v_mov_b32 v38, 0
  v_mov_b32 v39, 0
  buffer_store_dword v117, v118, s[8:11], 0 offen sc1
  s_setprio 0
  s_cmp_eq_u32 s19, 62
  s_cbranch_scc1 cB_done
  v_mov_b32 v40, 0
  v_mov_b32 v41, 0
  v_mov_b32 v42, 0
  v_mov_b32 v43, 0
  v_mov_b32 v44, 0
  v_mov_b32 v45, 0
  v_mov_b32 v46, 0
  v_mov_b32 v47, 0
  v_mov_b32 v48, 0
  v_mov_b32 v49, 0
  v_mov_b32 v50, 0
  v_mov_b32 v51, 0
  v_mov_b32 v52, 0
  v_mov_b32 v53, 0
  v_mov_b32 v54, 0
  v_mov_b32 v55, 0
  v_mov_b32 v56, 0
  v_mov_b32 v57, 0
  v_mov_b32 v58, 0
  v_mov_b32 v59, 0
  v_mov_b32 v60, 0
  v_mov_b32 v61, 0
  v_mov_b32 v62, 0
  v_mov_b32 v63, 0
  s_mov_b32 s19, s18
  s_add_u32 s18, s18, 1
  s_mov_b32 s22, s20
  s_mov_b32 s20, s21
  s_mov_b32 s21, s22
  s_add_u32 s23, s20, 4096
  s_branch cB_va3_loop
cB_va3_slow:
  s_waitcnt lgkmcnt(0)
cB_va3_sl1:
  s_add_u32 s31, s31, 0x1000000
  buffer_load_dwordx4 v[8:11], v2, s[8:11], s20 offen offset:0 sc1
  buffer_load_dwordx4 v[12:15], v2, s[8:11], s20 offen offset:1024 sc1
  buffer_load_dwordx4 v[16:19], v2, s[8:11], s20 offen offset:2048 sc1
  buffer_load_dwordx4 v[20:23], v2, s[8:11], s20 offen offset:3072 sc1
  buffer_load_dwordx4 v[24:27], v2, s[8:11], s23 offen offset:0 sc1
  buffer_load_dwordx4 v[28:31], v2, s[8:11], s23 offen offset:1024 sc1
  buffer_load_dwordx4 v[32:35], v2, s[8:11], s23 offen offset:2048 sc1
  s_waitcnt vmcnt(0)
  v_max3_u32 v36, v8, v9, v10
  v_max3_u32 v36, v36, v11, v12
  v_max3_u32 v36, v36, v13, v14
  v_max3_u32 v36, v36, v15, v16
  v_max3_u32 v36, v36, v17, v18
  v_max3_u32 v36, v36, v19, v20
  v_max3_u32 v36, v36, v21, v22
  v_max3_u32 v36, v36, v23, v24
  v_max3_u32 v36, v36, v25, v26
  v_max3_u32 v36, v36, v27, v28
  v_max3_u32 v36, v36, v29, v30
  v_max3_u32 v36, v36, v31, v32
  v_max3_u32 v36, v36, v33, v34
  v_max_u32 v36, v36, v35
  v_cmp_eq_u32 vcc, -1, v36
  s_cbranch_vccz cB_va3_sl2
  s_add_u32 s30, s30, 1
  s_cmp_lt_u32 s30, 400000
  s_cbranch_scc1 cB_va3_sl1
  s_branch cB_abort
cB_va3_sl2:
  v_mov_b32 v36, 0
  v_mov_b32 v37, 0
  v_mov_b32 v38, 0
  v_mov_b32 v39, 0
  v_mov_b32 v40, 0
  v_mov_b32 v41, 0
  v_mov_b32 v42, 0
  v_mov_b32 v43, 0
  v_mov_b32 v44, 0
  v_mov_b32 v45, 0
  v_mov_b32 v46, 0
  v_mov_b32 v47, 0
  v_mov_b32 v48, 0
  v_mov_b32 v49, 0
  v_mov_b32 v50, 0
  v_mov_b32 v51, 0
  v_mov_b32 v52, 0
  v_mov_b32 v53, 0
  v_mov_b32 v54, 0
  v_mov_b32 v55, 0
  v_mov_b32 v56, 0
  v_mov_b32 v57, 0
  v_mov_b32 v58, 0
  v_mov_b32 v59, 0
  v_mov_b32 v60, 0
  v_mov_b32 v61, 0
  v_mov_b32 v62, 0
  v_mov_b32 v63, 0
  v_smfmac_f32_16x16x64_bf16 v[36:39], v[8:11], a[0:7], v3
  v_smfmac_f32_16x16x64_bf16 v[40:43], v[8:11], a[56:63], v3
  v_smfmac_f32_16x16x64_bf16 v[44:47], v[8:11], a[112:119], v3
  v_smfmac_f32_16x16x64_bf16 v[48:51], v[8:11], a[168:175], v3
  v_smfmac_f32_16x16x64_bf16 v[52:55], v[8:11], a[224:231], v3
  v_smfmac_f32_16x16x64_bf16 v[56:59], v[8:11], v[144:151], v3
  v_smfmac_f32_16x16x64_bf16 v[60:63], v[8:11], v[200:207], v3
  v_smfmac_f32_16x16x64_bf16 v[36:39], v[12:15], a[8:15], v3
  v_smfmac_f32_16x16x64_bf16 v[40:43], v[12:15], a[64:71], v3
  v_smfmac_f32_16x16x64_bf16 v[44:47], v[12:15], a[120:127], v3
  v_smfmac_f32_16x16x64_bf16 v[48:51], v[12:15], a[176:183], v3
  v_smfmac_f32_16x16x64_bf16 v[52:55], v[12:15], a[232:239], v3
  v_smfmac_f32_16x16x64_bf16 v[56:59], v[12:15], v[152:159], v3
  v_smfmac_f32_16x16x64_bf16 v[60:63], v[12:15], v[208:215], v3
  v_smfmac_f32_16x16x64_bf16 v[36:39], v[16:19], a[16:23], v3
  v_smfmac_f32_16x16x64_bf16 v[40:43], v[16:19], a[72:79], v3
  v_smfmac_f32_16x16x64_bf16 v[44:47], v[16:19], a[128:135], v3
  v_smfmac_f32_16x16x64_bf16 v[48:51], v[16:19], a[184:191], v3
  v_smfmac_f32_16x16x64_bf16 v[52:55], v[16:19], a[240:247], v3
  v_smfmac_f32_16x16x64_bf16 v[56:59], v[16:19], v[160:167], v3
  v_smfmac_f32_16x16x64_bf16 v[60:63], v[16:19], v[216:223], v3
  v_smfmac_f32_16x16x64_bf16 v[36:39], v[20:23], a[24:31], v3
  v_smfmac_f32_16x16x64_bf16 v[40:43], v[20:23], a[80:87], v3
  v_smfmac_f32_16x16x64_bf16 v[44:47], v[20:23], a[136:143], v3
  v_smfmac_f32_16x16x64_bf16 v[48:51], v[20:23], a[192:199], v3
  v_smfmac_f32_16x16x64_bf16 v[52:55], v[20:23], a[248:255], v3
  v_smfmac_f32_16x16x64_bf16 v[56:59], v[20:23], v[168:175], v3
  v_smfmac_f32_16x16x64_bf16 v[60:63], v[20:23], v[224:231], v3
  v_smfmac_f32_16x16x64_bf16 v[36:39], v[24:27], a[32:39], v3
  v_smfmac_f32_16x16x64_bf16 v[40:43], v[24:27], a[88:95], v3
  v_smfmac_f32_16x16x64_bf16 v[44:47], v[24:27], a[144:151], v3
  v_smfmac_f32_16x16x64_bf16 v[48:51], v[24:27], a[200:207], v3
  v_smfmac_f32_16x16x64_bf16 v[52:55], v[24:27], v[120:127], v3
  v_smfmac_f32_16x16x64_bf16 v[56:59], v[24:27], v[176:183], v3
  v_smfmac_f32_16x16x64_bf16 v[60:63], v[24:27], v[232:239], v3
  v_smfmac_f32_16x16x64_bf16 v[36:39], v[28:31], a[40:47], v3
  v_smfmac_f32_16x16x64_bf16 v[40:43], v[28:31], a[96:103], v3
  v_smfmac_f32_16x16x64_bf16 v[44:47], v[28:31], a[152:159], v3
  v_smfmac_f32_16x16x64_bf16 v[48:51], v[28:31], a[208:215], v3
  v_smfmac_f32_16x16x64_bf16 v[52:55], v[28:31], v[128:135], v3
  v_smfmac_f32_16x16x64_bf16 v[56:59], v[28:31], v[184:191], v3
  v_smfmac_f32_16x16x64_bf16 v[60:63], v[28:31], v[240:247], v3
  v_smfmac_f32_16x16x64_bf16 v[36:39], v[32:35], a[48:55], v3
  v_smfmac_f32_16x16x64_bf16 v[40:43], v[32:35], a[104:111], v3
  v_smfmac_f32_16x16x64_bf16 v[44:47], v[32:35], a[160:167], v3
  v_smfmac_f32_16x16x64_bf16 v[48:51], v[32:35], a[216:223], v3
  v_smfmac_f32_16x16x64_bf16 v[52:55], v[32:35], v[136:143], v3
  v_smfmac_f32_16x16x64_bf16 v[56:59], v[32:35], v[192:199], v3
  v_smfmac_f32_16x16x64_bf16 v[60:63], v[32:35], v[248:255], v3
  v_permlane32_swap_b32 v36, v38
  v_permlane32_swap_b32 v37, v39
  v_add_f32 v36, v36, v38
  v_add_f32 v37, v37, v39
  v_cvt_pk_bf16_f32 v38, v36, v37
  ds_write_b32 v104, v38
  v_permlane32_swap_b32 v40, v42
  v_permlane32_swap_b32 v41, v43
  v_add_f32 v40, v40, v42
  v_add_f32 v41, v41, v43
  v_cvt_pk_bf16_f32 v42, v40, v41
  ds_write_b32 v105, v42
  v_permlane32_swap_b32 v44, v46
  v_permlane32_swap_b32 v45, v47
  v_add_f32 v44, v44, v46
  v_add_f32 v45, v45, v47
  v_cvt_pk_bf16_f32 v46, v44, v45
  ds_write_b32 v106, v46
  v_permlane32_swap_b32 v48, v50
  v_permlane32_swap_b32 v49, v51
  v_add_f32 v48, v48, v50
  v_add_f32 v49, v49, v51
  v_cvt_pk_bf16_f32 v50, v48, v49
  ds_write_b32 v107, v50
  v_permlane32_swap_b32 v52, v54
  v_permlane32_swap_b32 v53, v55
  v_add_f32 v52, v52, v54
  v_add_f32 v53, v53, v55
  v_cvt_pk_bf16_f32 v54, v52, v53
  ds_write_b32 v108, v54
  v_permlane32_swap_b32 v56, v58
  v_permlane32_swap_b32 v57, v59
  v_add_f32 v56, v56, v58
  v_add_f32 v57, v57, v59
  v_cvt_pk_bf16_f32 v58, v56, v57
  ds_write_b32 v109, v58
  v_permlane32_swap_b32 v60, v62
  v_permlane32_swap_b32 v61, v63
  v_add_f32 v60, v60, v62
  v_add_f32 v61, v61, v63
  v_cvt_pk_bf16_f32 v62, v60, v61
  ds_write_b32 v110, v62
  s_branch cB_va3_t2d
cB_va3_vor:
  s_sleep 2
  buffer_load_dword v101, off, s[8:11], s27 sc1
  s_add_u32 s30, s30, 1
  s_cmp_lt_u32 s30, 400000
  s_cbranch_scc1 cB_va3_vow
  s_branch cB_abort
cB_abort:
  v_mov_b32 v4, 0xdead
  v_mov_b32 v5, 16
  buffer_store_dword v4, v5, s[12:15], 0 offen
  s_branch ch_end
cB_done:
  s_branch ch_end
ch_worker:
  s_sub_u32 s35, s3, 1
  s_and_b32 s35, s35, 7
  s_lshr_b32 s36, s2, 3
  s_lshl_b32 s33, s35, 5
  s_add_u32 s33, s33, s36
  s_mov_b32 s97, 0
  s_mov_b32 s96, 0
  s_mov_b32 s37, 0
  s_mov_b32 s38, 0
  s_mov_b32 s39, 0xffff0000
  s_mov_b32 s101, -1
  v_and_b32 v1, 63, v0
  v_lshlrev_b32 v2, 4, v1
  v_lshrrev_b32 v3, 4, v1
  v_and_b32 v4, 15, v1
  s_cmp_ge_u32 s33, 224
  s_cbranch_scc1 wp_all
  s_mov_b32 s68, s44
  s_and_b32 s69, s45, 0xffff
  s_mov_b32 s70, 3670016
  s_mov_b32 s71, 0x20000
  s_and_b32 s20, s33, 0xe0
  s_mul_i32 s20, s20, 9363
  s_lshr_b32 s20, s20, 16
  s_lshl_b32 s20, s20, 10
  s_and_b32 s21, s33, 31
  s_mul_i32 s21, s21, 192
  s_add_u32 s20, s20, s21
  v_min_u32 v7, 191, v0
  v_add_u32 v7, s20, v7
  v_lshrrev_b32 v8, 11, v7
  v_min_u32 v8, 15, v8
  v_bfe_u32 v9, v7, 2, 9
  v_lshlrev_b32 v9, 13, v9
  v_lshl_add_u32 v9, v8, 9, v9
  v_and_b32 v7, 3, v7
  v_lshl_add_u32 v9, v7, 7, v9
  buffer_load_dword v253, v9, s[68:71], 0 offen
  v_lshrrev_b32 v5, 5, v1
  v_and_b32 v6, 31, v1
  v_xor_b32 v8, v6, v5
  v_lshlrev_b32 v8, 4, v8
  v_lshl_add_u32 v16, v5, 13, v8
  v_xor_b32 v17, 32, v16
  v_xor_b32 v18, 64, v16
  v_xor_b32 v19, 96, v16
  v_xor_b32 v20, 128, v16
  v_xor_b32 v21, 160, v16
  v_xor_b32 v22, 192, v16
  v_xor_b32 v23, 224, v16
  s_lshl_b32 s20, s16, 6
  v_xor_b32 v26, s20, v16
  v_xor_b32 v27, 32, v26
wp_B:
  s_mul_i32 s17, s33, 4682
  s_lshr_b32 s17, s17, 16
  s_mul_i32 s23, s17, 14
  s_sub_u32 s19, s33, s23
  s_cmp_lt_u32 s19, 7
  s_cselect_b32 s18, 0, 7
  s_cselect_b32 s28, 0, 8
  s_sub_u32 s18, s19, s18
  s_add_u32 s28, s28, s16
  s_lshl_b32 s25, s16, 15
  s_add_u32 s25, s25, 32768
  s_lshl_b32 s26, s17, 9
  s_lshl_b32 s20, s33, 2
  s_add_u32 s20, s20, s16
  s_mul_i32 s21, s20, 9363
  s_lshr_b32 s21, s21, 16
  s_mul_i32 s22, s21, 7
  s_sub_u32 s22, s20, s22
  s_mul_i32 s21, s21, 14336
  s_lshl_b32 s20, s22, 7
  s_add_u32 s20, s20, s21
  s_lshl_b32 s22, s22, 11
  s_add_u32 s52, s21, s22
  s_mov_b32 s68, s48
  s_and_b32 s69, s49, 0xffff
  s_mov_b32 s70, 1835008
  s_mov_b32 s71, 0x20000
  v_mul_u32_u24 v7, 896, v4
  v_lshl_add_u32 v7, v3, 5, v7
  buffer_load_dwordx4 v[128:131], v7, s[68:71], s20 offen
  buffer_load_dwordx4 v[132:135], v7, s[68:71], s20 offen offset:16
  s_mov_b32 s60, s44
  s_and_b32 s61, s45, 0xffff
  s_mov_b32 s62, 3670016
  s_mov_b32 s63, 0x20000
  s_mov_b32 s56, s46
  s_and_b32 s57, s47, 0xffff
  s_mov_b32 s58, 3670016
  s_mov_b32 s59, 0x20000
  s_mul_i32 s27, s17, 229376
  s_lshl_b32 s30, s18, 7
  s_add_u32 s27, s27, s30
  s_mul_i32 s30, s16, 57344
  s_add_u32 s27, s27, s30
  v_lshrrev_b32 v7, 3, v1
  v_and_b32 v8, 7, v1
  v_and_b32 v9, 2, v7
  v_xor_b32 v8, v8, v9
  v_mul_u32_u24 v7, 896, v7
  v_lshl_add_u32 v24, v8, 4, v7
  v_xor_b32 v25, 64, v24
  s_lshl_b32 s30, s16, 13
  s_add_u32 m0, s30, 0
  s_nop 0
  buffer_load_dwordx4 v24, s[56:59], s27 offen  lds
  s_add_u32 s27, s27, 7168
  s_add_u32 m0, s30, 1024
  s_nop 0
  buffer_load_dwordx4 v25, s[56:59], s27 offen  lds
  s_add_u32 s27, s27, 7168
  s_add_u32 m0, s30, 2048
  s_nop 0
  buffer_load_dwordx4 v24, s[56:59], s27 offen  lds
  s_add_u32 s27, s27, 7168
  s_add_u32 m0, s30, 3072
  s_nop 0
  buffer_load_dwordx4 v25, s[56:59], s27 offen  lds
  s_add_u32 s27, s27, 7168
  s_add_u32 m0, s30, 4096
  s_nop 0
  buffer_load_dwordx4 v24, s[56:59], s27 offen  lds
  s_add_u32 s27, s27, 7168
  s_add_u32 m0, s30, 5120
  s_nop 0
  buffer_load_dwordx4 v25, s[56:59], s27 offen  lds
  s_add_u32 s27, s27, 7168
  s_add_u32 m0, s30, 6144
  s_nop 0
  buffer_load_dwordx4 v24, s[56:59], s27 offen  lds
  s_add_u32 s27, s27, 7168
  s_add_u32 m0, s30, 7168
  s_nop 0
  buffer_load_dwordx4 v25, s[56:59], s27 offen  lds
  s_add_u32 s27, s27, 7168
  s_add_u32 s27, s28, 0
  s_min_u32 s27, s27, 13
  s_lshl_b32 s27, s27, 18
  s_add_u32 s27, s27, s26
  s_mov_b32 s55, s27
  v_lshrrev_b32 v7, 2, v4
  v_lshlrev_b32 v11, 4, v7
  v_lshlrev_b32 v7, 3, v7
  v_and_b32 v8, 3, v4
  v_add_u32 v7, v7, v8
  v_and_b32 v8, 2, v4
  v_lshl_add_u32 v11, v8, 1, v11
  v_and_b32 v8, 1, v4
  v_add_u32 v11, v11, v8
  v_or_b32 v10, 0, v3
  v_xor_b32 v10, v10, v4
  v_lshlrev_b32 v10, 4, v10
  v_lshl_add_u32 v44, v11, 9, v10
  v_lshl_add_u32 v10, v7, 9, v10
  v_add_u32 v32, s25, v10
  v_or_b32 v10, 4, v3
  v_xor_b32 v10, v10, v4
  v_lshlrev_b32 v10, 4, v10
  v_lshl_add_u32 v45, v11, 9, v10
  v_lshl_add_u32 v10, v7, 9, v10
  v_add_u32 v33, s25, v10
  v_or_b32 v10, 8, v3
  v_xor_b32 v10, v10, v4
  v_lshlrev_b32 v10, 4, v10
  v_lshl_add_u32 v46, v11, 9, v10
  v_lshl_add_u32 v10, v7, 9, v10
  v_add_u32 v34, s25, v10
  v_or_b32 v10, 12, v3
  v_xor_b32 v10, v10, v4
  v_lshlrev_b32 v10, 4, v10
  v_lshl_add_u32 v47, v11, 9, v10
  v_lshl_add_u32 v10, v7, 9, v10
  v_add_u32 v35, s25, v10
  s_mul_i32 s30, s17, 401408
  s_mul_i32 s31, s18, 57344
  s_add_u32 s30, s30, s31
  s_add_u32 s30, s30, 0
  v_add_u32 v28, s30, v2
  s_add_u32 s30, s30, 14336
  v_add_u32 v29, s30, v2
  s_add_u32 s30, s30, 14336
  v_add_u32 v30, s30, v2
  s_add_u32 s30, s30, 14336
  v_add_u32 v31, s30, v2
  s_add_u32 s30, s30, 14336
  v_mov_b32 v48, 1035512379
  v_lshrrev_b32 v7, 2, v4
  v_lshl_add_u32 v7, v3, 3, v7
  v_lshlrev_b32 v7, 7, v7
  v_and_b32 v8, 3, v4
  v_lshl_add_u32 v7, v8, 3, v7
  v_lshrrev_b32 v8, 3, v4
  v_and_b32 v9, 1, v3
  v_lshl_add_u32 v8, v9, 1, v8
  v_lshl_add_u32 v40, v8, 5, v7
  s_mul_i32 s31, s17, 28
  s_mov_b32 s29, 401408
  s_lshl_b32 s30, s18, 6
  s_add_u32 s30, s30, 0
  v_add_u32 v8, s30, v4
  v_subrev_u32 v9, 256, v8
  v_mul_u32_u24 v11, 171, v9
  v_lshrrev_b32 v11, 11, v11
  v_mul_u32_u24 v38, 12, v11
  v_sub_u32 v38, v9, v38
  v_add_u32 v38, 16, v38
  v_lshrrev_b32 v10, 4, v8
  v_cmp_gt_i32 vcc, 0, v9
  s_nop 1
  v_cndmask_b32 v10, v11, v10, vcc
  v_cndmask_b32 v39, v38, v4, vcc
  v_add_u32 v39, s31, v39
  v_lshrrev_b32 v38, 4, v39
  v_and_b32 v39, 15, v39
  v_mul_lo_u32 v10, v10, s29
  v_mul_u32_u24 v38, 14336, v38
  v_add_u32 v10, v10, v38
  v_lshl_add_u32 v10, v3, 8, v10
  v_lshl_add_u32 v10, v39, 4, v10
  v_add_u32 v12, 6422528, v10
  v_xor_b32 v41, 32, v40
  s_lshl_b32 s30, s18, 6
  s_add_u32 s30, s30, 16
  v_add_u32 v8, s30, v4
  v_subrev_u32 v9, 256, v8
  v_mul_u32_u24 v11, 171, v9
  v_lshrrev_b32 v11, 11, v11
  v_mul_u32_u24 v38, 12, v11
  v_sub_u32 v38, v9, v38
  v_add_u32 v38, 16, v38
  v_lshrrev_b32 v10, 4, v8
  v_cmp_gt_i32 vcc, 0, v9
  s_nop 1
  v_cndmask_b32 v10, v11, v10, vcc
  v_cndmask_b32 v39, v38, v4, vcc
  v_add_u32 v39, s31, v39
  v_lshrrev_b32 v38, 4, v39
  v_and_b32 v39, 15, v39
  v_mul_lo_u32 v10, v10, s29
  v_mul_u32_u24 v38, 14336, v38
  v_add_u32 v10, v10, v38
  v_lshl_add_u32 v10, v3, 8, v10
  v_lshl_add_u32 v10, v39, 4, v10
  v_add_u32 v13, 6422528, v10
  v_xor_b32 v42, 64, v40
  s_lshl_b32 s30, s18, 6
  s_add_u32 s30, s30, 32
  v_add_u32 v8, s30, v4
  v_subrev_u32 v9, 256, v8
  v_mul_u32_u24 v11, 171, v9
  v_lshrrev_b32 v11, 11, v11
  v_mul_u32_u24 v38, 12, v11
  v_sub_u32 v38, v9, v38
  v_add_u32 v38, 16, v38
  v_lshrrev_b32 v10, 4, v8
  v_cmp_gt_i32 vcc, 0, v9
  s_nop 1
  v_cndmask_b32 v10, v11, v10, vcc
  v_cndmask_b32 v39, v38, v4, vcc
  v_add_u32 v39, s31, v39
  v_lshrrev_b32 v38, 4, v39
  v_and_b32 v39, 15, v39
  v_mul_lo_u32 v10, v10, s29
  v_mul_u32_u24 v38, 14336, v38
  v_add_u32 v10, v10, v38
  v_lshl_add_u32 v10, v3, 8, v10
  v_lshl_add_u32 v10, v39, 4, v10
  v_add_u32 v14, 6422528, v10
  v_xor_b32 v43, 96, v40
  s_lshl_b32 s30, s18, 6
  s_add_u32 s30, s30, 48
  v_add_u32 v8, s30, v4
  v_subrev_u32 v9, 256, v8
  v_mul_u32_u24 v11, 171, v9
  v_lshrrev_b32 v11, 11, v11
  v_mul_u32_u24 v38, 12, v11
  v_sub_u32 v38, v9, v38
  v_add_u32 v38, 16, v38
  v_lshrrev_b32 v10, 4, v8
  v_cmp_gt_i32 vcc, 0, v9
  s_nop 1
  v_cndmask_b32 v10, v11, v10, vcc
  v_cndmask_b32 v39, v38, v4, vcc
  v_add_u32 v39, s31, v39
  v_lshrrev_b32 v38, 4, v39
  v_and_b32 v39, 15, v39
  v_mul_lo_u32 v10, v10, s29
  v_mul_u32_u24 v38, 14336, v38
  v_add_u32 v10, v10, v38
  v_lshl_add_u32 v10, v3, 8, v10
  v_lshl_add_u32 v10, v39, 4, v10
  v_add_u32 v15, 6422528, v10
  s_mov_b32 s27, s55
  s_add_u32 m0, s25, 0
  s_nop 0
  buffer_load_dwordx4 v16, s[60:63], s27 offen  lds
  s_add_u32 s27, s27, 16384
  s_add_u32 m0, s25, 1024
  s_nop 0
  buffer_load_dwordx4 v17, s[60:63], s27 offen  lds
  s_add_u32 s27, s27, 16384
  s_add_u32 m0, s25, 2048
  s_nop 0
  buffer_load_dwordx4 v16, s[60:63], s27 offen  lds
  s_add_u32 s27, s27, 16384
  s_add_u32 m0, s25, 3072
  s_nop 0
  buffer_load_dwordx4 v17, s[60:63], s27 offen  lds
  s_add_u32 s27, s27, 16384
  s_add_u32 m0, s25, 4096
  s_nop 0
  buffer_load_dwordx4 v18, s[60:63], s27 offen  lds
  s_add_u32 s27, s27, 16384
  s_add_u32 m0, s25, 5120
  s_nop 0
  buffer_load_dwordx4 v19, s[60:63], s27 offen  lds
  s_add_u32 s27, s27, 16384
  s_add_u32 m0, s25, 6144
  s_nop 0
  buffer_load_dwordx4 v18, s[60:63], s27 offen  lds
  s_add_u32 s27, s27, 16384
  s_add_u32 m0, s25, 7168
  s_nop 0
  buffer_load_dwordx4 v19, s[60:63], s27 offen  lds
  s_add_u32 s27, s27, 16384
  s_add_u32 m0, s25, 8192
  s_nop 0
  buffer_load_dwordx4 v20, s[60:63], s27 offen  lds
  s_add_u32 s27, s27, 16384
  s_add_u32 m0, s25, 9216
  s_nop 0
  buffer_load_dwordx4 v21, s[60:63], s27 offen  lds
  s_add_u32 s27, s27, 16384
  s_add_u32 m0, s25, 10240
  s_nop 0
  buffer_load_dwordx4 v20, s[60:63], s27 offen  lds
  s_add_u32 s27, s27, 16384
  s_add_u32 m0, s25, 11264
  s_nop 0
  buffer_load_dwordx4 v21, s[60:63], s27 offen  lds
  s_add_u32 s27, s27, 16384
  s_add_u32 m0, s25, 12288
  s_nop 0
  buffer_load_dwordx4 v22, s[60:63], s27 offen  lds
  s_add_u32 s27, s27, 16384
  s_add_u32 m0, s25, 13312
  s_nop 0
  buffer_load_dwordx4 v23, s[60:63], s27 offen  lds
  s_add_u32 s27, s27, 16384
  s_add_u32 m0, s25, 14336
  s_nop 0
  buffer_load_dwordx4 v22, s[60:63], s27 offen  lds
  s_add_u32 s27, s27, 16384
  s_add_u32 m0, s25, 15360
  s_nop 0
  buffer_load_dwordx4 v23, s[60:63], s27 offen  lds
  s_add_u32 s27, s27, 16384
  s_add_u32 s27, s28, 4
  s_min_u32 s27, s27, 13
  s_lshl_b32 s27, s27, 18
  s_add_u32 s27, s27, s26
  s_add_u32 m0, s25, 16384
  s_nop 0
  buffer_load_dwordx4 v16, s[60:63], s27 offen  lds
  s_add_u32 s27, s27, 16384
  s_add_u32 m0, s25, 17408
  s_nop 0
  buffer_load_dwordx4 v17, s[60:63], s27 offen  lds
  s_add_u32 s27, s27, 16384
  s_add_u32 m0, s25, 18432
  s_nop 0
  buffer_load_dwordx4 v16, s[60:63], s27 offen  lds
  s_add_u32 s27, s27, 16384
  s_add_u32 m0, s25, 19456
  s_nop 0
  buffer_load_dwordx4 v17, s[60:63], s27 offen  lds
  s_add_u32 s27, s27, 16384
  s_add_u32 m0, s25, 20480
  s_nop 0
  buffer_load_dwordx4 v18, s[60:63], s27 offen  lds
  s_add_u32 s27, s27, 16384
  s_add_u32 m0, s25, 21504
  s_nop 0
  buffer_load_dwordx4 v19, s[60:63], s27 offen  lds
  s_add_u32 s27, s27, 16384
  s_add_u32 m0, s25, 22528
  s_nop 0
  buffer_load_dwordx4 v18, s[60:63], s27 offen  lds
  s_add_u32 s27, s27, 16384
  s_add_u32 m0, s25, 23552
  s_nop 0
  buffer_load_dwordx4 v19, s[60:63], s27 offen  lds
  s_add_u32 s27, s27, 16384
  s_add_u32 m0, s25, 24576
  s_nop 0
  buffer_load_dwordx4 v20, s[60:63], s27 offen  lds
  s_add_u32 s27, s27, 16384
  s_add_u32 m0, s25, 25600
  s_nop 0
  buffer_load_dwordx4 v21, s[60:63], s27 offen  lds
  s_add_u32 s27, s27, 16384
  s_add_u32 m0, s25, 26624
  s_nop 0
  buffer_load_dwordx4 v20, s[60:63], s27 offen  lds
  s_add_u32 s27, s27, 16384
  s_add_u32 m0, s25, 27648
  s_nop 0
  buffer_load_dwordx4 v21, s[60:63], s27 offen  lds
  s_add_u32 s27, s27, 16384
  s_add_u32 m0, s25, 28672
  s_nop 0
  buffer_load_dwordx4 v22, s[60:63], s27 offen  lds
  s_add_u32 s27, s27, 16384
  s_add_u32 m0, s25, 29696
  s_nop 0
  buffer_load_dwordx4 v23, s[60:63], s27 offen  lds
  s_add_u32 s27, s27, 16384
  s_add_u32 m0, s25, 30720
  s_nop 0
  buffer_load_dwordx4 v22, s[60:63], s27 offen  lds
  s_add_u32 s27, s27, 16384
  s_add_u32 m0, s25, 31744
  s_nop 0
  buffer_load_dwordx4 v23, s[60:63], s27 offen  lds
  s_add_u32 s27, s27, 16384
  s_cmp_lt_u32 s18, 4
  s_cselect_b32 s34, 1, s97
  s_mov_b32 s68, s40
  s_and_b32 s69, s41, 0xffff
  s_mov_b32 s70, 3670016
  s_mov_b32 s71, 0x20000
  s_and_b32 s20, s33, 0xe0
  s_mul_i32 s20, s20, 9363
  s_lshr_b32 s20, s20, 16
  s_lshl_b32 s20, s20, 10
  s_and_b32 s21, s33, 31
  s_mul_i32 s21, s21, 192
  s_add_u32 s20, s20, s21
  v_min_u32 v7, 191, v0
  v_add_u32 v7, s20, v7
  v_lshrrev_b32 v8, 11, v7
  v_min_u32 v8, 15, v8
  v_bfe_u32 v9, v7, 2, 9
  v_lshlrev_b32 v9, 13, v9
  v_lshl_add_u32 v9, v8, 9, v9
  v_and_b32 v7, 3, v7
  v_lshl_add_u32 v9, v7, 7, v9
  buffer_load_dword v253, v9, s[68:71], 0 offen
  s_mov_b32 s68, s42
  s_and_b32 s69, s43, 0xffff
  s_mov_b32 s70, 3670016
  s_mov_b32 s71, 0x20000
  s_lshl_b32 s27, s18, 19
  s_add_u32 s27, s27, s26
  s_cmp_lg_u32 s34, 0
  s_cselect_b32 s27, 0x40000000, s27
  v_lshrrev_b32 v7, 2, v0
  v_and_b32 v8, 3, v0
  v_lshlrev_b32 v8, 7, v8
  v_lshl_add_u32 v9, v7, 13, v8
  buffer_load_dword v253, v9, s[68:71], s27 offen
  s_lshl_b32 s29, s28, 10
  s_add_u32 s31, s29, 4096
  s_cmp_lt_u32 s28, 10
  s_cselect_b32 s31, s31, 0x40000000
  s_waitcnt vmcnt(2)
  s_barrier
  ds_read_b64_tr_b16 a[0:1], v40 offset:0
  ds_read_b64_tr_b16 a[2:3], v40 offset:512
  ds_read_b64_tr_b16 a[32:33], v41 offset:0
  ds_read_b64_tr_b16 a[34:35], v41 offset:512
  ds_read_b64_tr_b16 a[64:65], v42 offset:0
  ds_read_b64_tr_b16 a[66:67], v42 offset:512
  ds_read_b64_tr_b16 a[96:97], v43 offset:0
  ds_read_b64_tr_b16 a[98:99], v43 offset:512
  ds_read_b128 a[128:131], v32 offset:0
  ds_read_b128 a[160:163], v32 offset:2048
  ds_read_b128 a[192:195], v32 offset:16384
  ds_read_b128 a[224:227], v32 offset:18432
  v_lshlrev_b32 v144, 9, v3
  v_lshl_add_u32 v144, v4, 4, v144
  s_add_u32 s53, s52, 73859072
  s_add_u32 s52, s52, 72024064
  v_mov_b32 v136, v128
  v_mov_b32 v140, v129
  v_mov_b32 v137, v130
  v_mov_b32 v141, v131
  v_mov_b32 v138, v132
  v_mov_b32 v142, v133
  v_mov_b32 v139, v134
  v_mov_b32 v143, v135
  buffer_store_dwordx4 v[128:131], v144, s[8:11], s52 offen sc1
  buffer_store_dwordx4 v[132:135], v144, s[8:11], s52 offen offset:256 sc1
  buffer_store_dwordx4 v[136:139], v2, s[8:11], s53 offen sc1
  buffer_store_dwordx4 v[140:143], v2, s[8:11], s53 offen offset:1024 sc1
  s_waitcnt lgkmcnt(0)
  v_mfma_f32_16x16x32_bf16 v[64:67], a[128:131], a[0:3], 0
  ds_read_b64_tr_b16 a[4:5], v40 offset:4096
  ds_read_b64_tr_b16 a[6:7], v40 offset:4608
  v_mfma_f32_16x16x32_bf16 v[68:71], a[160:163], a[0:3], 0
  ds_read_b64_tr_b16 a[36:37], v41 offset:4096
  ds_read_b64_tr_b16 a[38:39], v41 offset:4608
  v_mfma_f32_16x16x32_bf16 v[72:75], a[128:131], a[32:35], 0
  ds_read_b64_tr_b16 a[68:69], v42 offset:4096
  ds_read_b64_tr_b16 a[70:71], v42 offset:4608
  v_mfma_f32_16x16x32_bf16 v[76:79], a[160:163], a[32:35], 0
  ds_read_b64_tr_b16 a[100:101], v43 offset:4096
  ds_read_b64_tr_b16 a[102:103], v43 offset:4608
  v_mfma_f32_16x16x32_bf16 v[80:83], a[128:131], a[64:67], 0
  ds_read_b128 a[132:135], v33 offset:0
  ds_read_b128 a[164:167], v33 offset:2048
  v_mfma_f32_16x16x32_bf16 v[84:87], a[160:163], a[64:67], 0
  ds_read_b128 a[196:199], v33 offset:16384
  ds_read_b128 a[228:231], v33 offset:18432
  v_mfma_f32_16x16x32_bf16 v[88:91], a[128:131], a[96:99], 0
  v_mfma_f32_16x16x32_bf16 v[92:95], a[160:163], a[96:99], 0
  v_mfma_f32_16x16x32_bf16 v[96:99], a[192:195], a[0:3], 0
  v_mfma_f32_16x16x32_bf16 v[100:103], a[224:227], a[0:3], 0
  v_mfma_f32_16x16x32_bf16 v[104:107], a[192:195], a[32:35], 0
  v_mfma_f32_16x16x32_bf16 v[108:111], a[224:227], a[32:35], 0
  v_mfma_f32_16x16x32_bf16 v[112:115], a[192:195], a[64:67], 0
  v_mfma_f32_16x16x32_bf16 v[116:119], a[224:227], a[64:67], 0
  v_mfma_f32_16x16x32_bf16 v[120:123], a[192:195], a[96:99], 0
  v_mfma_f32_16x16x32_bf16 v[124:127], a[224:227], a[96:99], 0
  s_waitcnt lgkmcnt(0)
  v_mfma_f32_16x16x32_bf16 v[64:67], a[132:135], a[4:7], v[64:67]
  ds_read_b64_tr_b16 a[8:9], v40 offset:8192
  ds_read_b64_tr_b16 a[10:11], v40 offset:8704
  v_mfma_f32_16x16x32_bf16 v[68:71], a[164:167], a[4:7], v[68:71]
  ds_read_b64_tr_b16 a[40:41], v41 offset:8192
  ds_read_b64_tr_b16 a[42:43], v41 offset:8704
  v_mfma_f32_16x16x32_bf16 v[72:75], a[132:135], a[36:39], v[72:75]
  ds_read_b64_tr_b16 a[72:73], v42 offset:8192
  ds_read_b64_tr_b16 a[74:75], v42 offset:8704
  v_mfma_f32_16x16x32_bf16 v[76:79], a[164:167], a[36:39], v[76:79]
  ds_read_b64_tr_b16 a[104:105], v43 offset:8192
  ds_read_b64_tr_b16 a[106:107], v43 offset:8704
  v_mfma_f32_16x16x32_bf16 v[80:83], a[132:135], a[68:71], v[80:83]
  ds_read_b128 a[136:139], v34 offset:0
  ds_read_b128 a[168:171], v34 offset:2048
  v_mfma_f32_16x16x32_bf16 v[84:87], a[164:167], a[68:71], v[84:87]
  ds_read_b128 a[200:203], v34 offset:16384
  ds_read_b128 a[232:235], v34 offset:18432
  v_mfma_f32_16x16x32_bf16 v[88:91], a[132:135], a[100:103], v[88:91]
  v_mfma_f32_16x16x32_bf16 v[92:95], a[164:167], a[100:103], v[92:95]
  v_mfma_f32_16x16x32_bf16 v[96:99], a[196:199], a[4:7], v[96:99]
  v_mfma_f32_16x16x32_bf16 v[100:103], a[228:231], a[4:7], v[100:103]
  v_mfma_f32_16x16x32_bf16 v[104:107], a[196:199], a[36:39], v[104:107]
  v_mfma_f32_16x16x32_bf16 v[108:111], a[228:231], a[36:39], v[108:111]
  v_mfma_f32_16x16x32_bf16 v[112:115], a[196:199], a[68:71], v[112:115]
  v_mfma_f32_16x16x32_bf16 v[116:119], a[228:231], a[68:71], v[116:119]
  v_mfma_f32_16x16x32_bf16 v[120:123], a[196:199], a[100:103], v[120:123]
  v_mfma_f32_16x16x32_bf16 v[124:127], a[228:231], a[100:103], v[124:127]
  s_waitcnt lgkmcnt(0)
  v_mfma_f32_16x16x32_bf16 v[64:67], a[136:139], a[8:11], v[64:67]
  ds_read_b64_tr_b16 a[12:13], v40 offset:12288
  ds_read_b64_tr_b16 a[14:15], v40 offset:12800
  v_mfma_f32_16x16x32_bf16 v[68:71], a[168:171], a[8:11], v[68:71]
  ds_read_b64_tr_b16 a[44:45], v41 offset:12288
  ds_read_b64_tr_b16 a[46:47], v41 offset:12800
  v_mfma_f32_16x16x32_bf16 v[72:75], a[136:139], a[40:43], v[72:75]
  ds_read_b64_tr_b16 a[76:77], v42 offset:12288
  ds_read_b64_tr_b16 a[78:79], v42 offset:12800
  v_mfma_f32_16x16x32_bf16 v[76:79], a[168:171], a[40:43], v[76:79]
  ds_read_b64_tr_b16 a[108:109], v43 offset:12288
  ds_read_b64_tr_b16 a[110:111], v43 offset:12800
  v_mfma_f32_16x16x32_bf16 v[80:83], a[136:139], a[72:75], v[80:83]
  ds_read_b128 a[140:143], v35 offset:0
  ds_read_b128 a[172:175], v35 offset:2048
  v_mfma_f32_16x16x32_bf16 v[84:87], a[168:171], a[72:75], v[84:87]
  ds_read_b128 a[204:207], v35 offset:16384
  ds_read_b128 a[236:239], v35 offset:18432
  v_mfma_f32_16x16x32_bf16 v[88:91], a[136:139], a[104:107], v[88:91]
  v_mfma_f32_16x16x32_bf16 v[92:95], a[168:171], a[104:107], v[92:95]
  v_mfma_f32_16x16x32_bf16 v[96:99], a[200:203], a[8:11], v[96:99]
  v_mfma_f32_16x16x32_bf16 v[100:103], a[232:235], a[8:11], v[100:103]
  v_mfma_f32_16x16x32_bf16 v[104:107], a[200:203], a[40:43], v[104:107]
  v_mfma_f32_16x16x32_bf16 v[108:111], a[232:235], a[40:43], v[108:111]
  v_mfma_f32_16x16x32_bf16 v[112:115], a[200:203], a[72:75], v[112:115]
  v_mfma_f32_16x16x32_bf16 v[116:119], a[232:235], a[72:75], v[116:119]
  v_mfma_f32_16x16x32_bf16 v[120:123], a[200:203], a[104:107], v[120:123]
  v_mfma_f32_16x16x32_bf16 v[124:127], a[232:235], a[104:107], v[124:127]
  s_waitcnt lgkmcnt(0)
  v_mfma_f32_16x16x32_bf16 v[64:67], a[140:143], a[12:15], v[64:67]
  ds_read_b64_tr_b16 a[16:17], v40 offset:16384
  ds_read_b64_tr_b16 a[18:19], v40 offset:16896
  v_mfma_f32_16x16x32_bf16 v[68:71], a[172:175], a[12:15], v[68:71]
  ds_read_b64_tr_b16 a[48:49], v41 offset:16384
  ds_read_b64_tr_b16 a[50:51], v41 offset:16896
  v_mfma_f32_16x16x32_bf16 v[72:75], a[140:143], a[44:47], v[72:75]
  ds_read_b64_tr_b16 a[80:81], v42 offset:16384
  ds_read_b64_tr_b16 a[82:83], v42 offset:16896
  v_mfma_f32_16x16x32_bf16 v[76:79], a[172:175], a[44:47], v[76:79]
  ds_read_b64_tr_b16 a[112:113], v43 offset:16384
  ds_read_b64_tr_b16 a[114:115], v43 offset:16896
  v_mfma_f32_16x16x32_bf16 v[80:83], a[140:143], a[76:79], v[80:83]
  ds_read_b128 a[144:147], v32 offset:256
  ds_read_b128 a[176:179], v32 offset:2304
  v_mfma_f32_16x16x32_bf16 v[84:87], a[172:175], a[76:79], v[84:87]
  ds_read_b128 a[208:211], v32 offset:16640
  ds_read_b128 a[240:243], v32 offset:18688
  v_mfma_f32_16x16x32_bf16 v[88:91], a[140:143], a[108:111], v[88:91]
  v_mfma_f32_16x16x32_bf16 v[92:95], a[172:175], a[108:111], v[92:95]
  v_mfma_f32_16x16x32_bf16 v[96:99], a[204:207], a[12:15], v[96:99]
  v_mfma_f32_16x16x32_bf16 v[100:103], a[236:239], a[12:15], v[100:103]
  v_mfma_f32_16x16x32_bf16 v[104:107], a[204:207], a[44:47], v[104:107]
  v_mfma_f32_16x16x32_bf16 v[108:111], a[236:239], a[44:47], v[108:111]
  v_mfma_f32_16x16x32_bf16 v[112:115], a[204:207], a[76:79], v[112:115]
  v_mfma_f32_16x16x32_bf16 v[116:119], a[236:239], a[76:79], v[116:119]
  v_mfma_f32_16x16x32_bf16 v[120:123], a[204:207], a[108:111], v[120:123]
  v_mfma_f32_16x16x32_bf16 v[124:127], a[236:239], a[108:111], v[124:127]
  s_waitcnt lgkmcnt(0)
  v_mfma_f32_16x16x32_bf16 v[64:67], a[144:147], a[16:19], v[64:67]
  ds_read_b64_tr_b16 a[20:21], v40 offset:20480
  ds_read_b64_tr_b16 a[22:23], v40 offset:20992
  v_mfma_f32_16x16x32_bf16 v[68:71], a[176:179], a[16:19], v[68:71]
  ds_read_b64_tr_b16 a[52:53], v41 offset:20480
  ds_read_b64_tr_b16 a[54:55], v41 offset:20992
  v_mfma_f32_16x16x32_bf16 v[72:75], a[144:147], a[48:51], v[72:75]
  ds_read_b64_tr_b16 a[84:85], v42 offset:20480
  ds_read_b64_tr_b16 a[86:87], v42 offset:20992
  v_mfma_f32_16x16x32_bf16 v[76:79], a[176:179], a[48:51], v[76:79]
  ds_read_b64_tr_b16 a[116:117], v43 offset:20480
  ds_read_b64_tr_b16 a[118:119], v43 offset:20992
  v_mfma_f32_16x16x32_bf16 v[80:83], a[144:147], a[80:83], v[80:83]
  ds_read_b128 a[148:151], v33 offset:256
  ds_read_b128 a[180:183], v33 offset:2304
  v_mfma_f32_16x16x32_bf16 v[84:87], a[176:179], a[80:83], v[84:87]
  ds_read_b128 a[212:215], v33 offset:16640
  ds_read_b128 a[244:247], v33 offset:18688
  v_mfma_f32_16x16x32_bf16 v[88:91], a[144:147], a[112:115], v[88:91]
  v_mfma_f32_16x16x32_bf16 v[92:95], a[176:179], a[112:115], v[92:95]
  v_mfma_f32_16x16x32_bf16 v[96:99], a[208:211], a[16:19], v[96:99]
  v_mfma_f32_16x16x32_bf16 v[100:103], a[240:243], a[16:19], v[100:103]
  v_mfma_f32_16x16x32_bf16 v[104:107], a[208:211], a[48:51], v[104:107]
  v_mfma_f32_16x16x32_bf16 v[108:111], a[240:243], a[48:51], v[108:111]
  v_mfma_f32_16x16x32_bf16 v[112:115], a[208:211], a[80:83], v[112:115]
  v_mfma_f32_16x16x32_bf16 v[116:119], a[240:243], a[80:83], v[116:119]
  v_mfma_f32_16x16x32_bf16 v[120:123], a[208:211], a[112:115], v[120:123]
  v_mfma_f32_16x16x32_bf16 v[124:127], a[240:243], a[112:115], v[124:127]
  s_waitcnt lgkmcnt(0)
  v_mfma_f32_16x16x32_bf16 v[64:67], a[148:151], a[20:23], v[64:67]
  ds_read_b64_tr_b16 a[24:25], v40 offset:24576
  ds_read_b64_tr_b16 a[26:27], v40 offset:25088
  v_mfma_f32_16x16x32_bf16 v[68:71], a[180:183], a[20:23], v[68:71]
  ds_read_b64_tr_b16 a[56:57], v41 offset:24576
  ds_read_b64_tr_b16 a[58:59], v41 offset:25088
  v_mfma_f32_16x16x32_bf16 v[72:75], a[148:151], a[52:55], v[72:75]
  ds_read_b64_tr_b16 a[88:89], v42 offset:24576
  ds_read_b64_tr_b16 a[90:91], v42 offset:25088
  v_mfma_f32_16x16x32_bf16 v[76:79], a[180:183], a[52:55], v[76:79]
  ds_read_b64_tr_b16 a[120:121], v43 offset:24576
  ds_read_b64_tr_b16 a[122:123], v43 offset:25088
  v_mfma_f32_16x16x32_bf16 v[80:83], a[148:151], a[84:87], v[80:83]
  ds_read_b128 a[152:155], v34 offset:256
  ds_read_b128 a[184:187], v34 offset:2304
  v_mfma_f32_16x16x32_bf16 v[84:87], a[180:183], a[84:87], v[84:87]
  ds_read_b128 a[216:219], v34 offset:16640
  ds_read_b128 a[248:251], v34 offset:18688
  v_mfma_f32_16x16x32_bf16 v[88:91], a[148:151], a[116:119], v[88:91]
  v_mfma_f32_16x16x32_bf16 v[92:95], a[180:183], a[116:119], v[92:95]
  v_mfma_f32_16x16x32_bf16 v[96:99], a[212:215], a[20:23], v[96:99]
  v_mfma_f32_16x16x32_bf16 v[100:103], a[244:247], a[20:23], v[100:103]
  v_mfma_f32_16x16x32_bf16 v[104:107], a[212:215], a[52:55], v[104:107]
  v_mfma_f32_16x16x32_bf16 v[108:111], a[244:247], a[52:55], v[108:111]
  v_mfma_f32_16x16x32_bf16 v[112:115], a[212:215], a[84:87], v[112:115]
  v_mfma_f32_16x16x32_bf16 v[116:119], a[244:247], a[84:87], v[116:119]
  v_mfma_f32_16x16x32_bf16 v[120:123], a[212:215], a[116:119], v[120:123]
  v_mfma_f32_16x16x32_bf16 v[124:127], a[244:247], a[116:119], v[124:127]
  s_waitcnt lgkmcnt(0)
  v_mfma_f32_16x16x32_bf16 v[64:67], a[152:155], a[24:27], v[64:67]
  ds_read_b64_tr_b16 a[28:29], v40 offset:28672
  ds_read_b64_tr_b16 a[30:31], v40 offset:29184
  v_mfma_f32_16x16x32_bf16 v[68:71], a[184:187], a[24:27], v[68:71]
  ds_read_b64_tr_b16 a[60:61], v41 offset:28672
  ds_read_b64_tr_b16 a[62:63], v41 offset:29184
  v_mfma_f32_16x16x32_bf16 v[72:75], a[152:155], a[56:59], v[72:75]
  ds_read_b64_tr_b16 a[92:93], v42 offset:28672
  ds_read_b64_tr_b16 a[94:95], v42 offset:29184
  v_mfma_f32_16x16x32_bf16 v[76:79], a[184:187], a[56:59], v[76:79]
  ds_read_b64_tr_b16 a[124:125], v43 offset:28672
  ds_read_b64_tr_b16 a[126:127], v43 offset:29184
  v_mfma_f32_16x16x32_bf16 v[80:83], a[152:155], a[88:91], v[80:83]
  ds_read_b128 a[156:159], v35 offset:256
  ds_read_b128 a[188:191], v35 offset:2304
  v_mfma_f32_16x16x32_bf16 v[84:87], a[184:187], a[88:91], v[84:87]
  ds_read_b128 a[220:223], v35 offset:16640
  ds_read_b128 a[252:255], v35 offset:18688
  v_mfma_f32_16x16x32_bf16 v[88:91], a[152:155], a[120:123], v[88:91]
  v_mfma_f32_16x16x32_bf16 v[92:95], a[184:187], a[120:123], v[92:95]
  v_mfma_f32_16x16x32_bf16 v[96:99], a[216:219], a[24:27], v[96:99]
  v_mfma_f32_16x16x32_bf16 v[100:103], a[248:251], a[24:27], v[100:103]
  v_mfma_f32_16x16x32_bf16 v[104:107], a[216:219], a[56:59], v[104:107]
  v_mfma_f32_16x16x32_bf16 v[108:111], a[248:251], a[56:59], v[108:111]
  v_mfma_f32_16x16x32_bf16 v[112:115], a[216:219], a[88:91], v[112:115]
  v_mfma_f32_16x16x32_bf16 v[116:119], a[248:251], a[88:91], v[116:119]
  v_mfma_f32_16x16x32_bf16 v[120:123], a[216:219], a[120:123], v[120:123]
  v_mfma_f32_16x16x32_bf16 v[124:127], a[248:251], a[120:123], v[124:127]
  s_waitcnt lgkmcnt(0)
  s_barrier
  buffer_load_dwordx2 v[254:255], v252, s[12:15], 0 offen offset:128 sc1
  buffer_load_dword v253, v252, s[12:15], 0 offen sc1
  v_mfma_f32_16x16x32_bf16 v[64:67], a[156:159], a[28:31], v[64:67]
  v_mfma_f32_16x16x32_bf16 v[68:71], a[188:191], a[28:31], v[68:71]
  v_mfma_f32_16x16x32_bf16 v[72:75], a[156:159], a[60:63], v[72:75]
  v_mfma_f32_16x16x32_bf16 v[76:79], a[188:191], a[60:63], v[76:79]
  v_mfma_f32_16x16x32_bf16 v[80:83], a[156:159], a[92:95], v[80:83]
  v_cvt_pk_bf16_f32 v64, v64, v65
  v_cvt_pk_bf16_f32 v65, v66, v67
  v_mfma_f32_16x16x32_bf16 v[84:87], a[188:191], a[92:95], v[84:87]
  v_cvt_pk_bf16_f32 v66, v68, v69
  v_cvt_pk_bf16_f32 v67, v70, v71
  v_mfma_f32_16x16x32_bf16 v[88:91], a[156:159], a[124:127], v[88:91]
  buffer_store_dwordx4 v[64:67], v12, s[8:11], s29 offen sc1
  v_cvt_pk_bf16_f32 v72, v72, v73
  v_mfma_f32_16x16x32_bf16 v[92:95], a[188:191], a[124:127], v[92:95]
  v_cvt_pk_bf16_f32 v73, v74, v75
  v_cvt_pk_bf16_f32 v74, v76, v77
  v_mfma_f32_16x16x32_bf16 v[96:99], a[220:223], a[28:31], v[96:99]
  v_cvt_pk_bf16_f32 v75, v78, v79
  buffer_store_dwordx4 v[72:75], v13, s[8:11], s29 offen sc1
  v_mfma_f32_16x16x32_bf16 v[100:103], a[252:255], a[28:31], v[100:103]
  v_cvt_pk_bf16_f32 v80, v80, v81
  v_cvt_pk_bf16_f32 v81, v82, v83
  v_mfma_f32_16x16x32_bf16 v[104:107], a[220:223], a[60:63], v[104:107]
  v_cvt_pk_bf16_f32 v82, v84, v85
  v_cvt_pk_bf16_f32 v83, v86, v87
  v_mfma_f32_16x16x32_bf16 v[108:111], a[252:255], a[60:63], v[108:111]
  buffer_store_dwordx4 v[80:83], v14, s[8:11], s29 offen sc1
  v_cvt_pk_bf16_f32 v88, v88, v89
  v_mfma_f32_16x16x32_bf16 v[112:115], a[220:223], a[92:95], v[112:115]
  v_cvt_pk_bf16_f32 v89, v90, v91
  v_cvt_pk_bf16_f32 v90, v92, v93
  v_mfma_f32_16x16x32_bf16 v[116:119], a[252:255], a[92:95], v[116:119]
  v_cvt_pk_bf16_f32 v91, v94, v95
  buffer_store_dwordx4 v[88:91], v15, s[8:11], s29 offen sc1
  v_mfma_f32_16x16x32_bf16 v[120:123], a[220:223], a[124:127], v[120:123]
  v_cvt_pk_bf16_f32 v96, v96, v97
  v_cvt_pk_bf16_f32 v97, v98, v99
  v_mfma_f32_16x16x32_bf16 v[124:127], a[252:255], a[124:127], v[124:127]
  v_cvt_pk_bf16_f32 v98, v100, v101
  v_cvt_pk_bf16_f32 v99, v102, v103
  buffer_store_dwordx4 v[96:99], v12, s[8:11], s31 offen sc1
  v_cvt_pk_bf16_f32 v104, v104, v105
  v_cvt_pk_bf16_f32 v105, v106, v107
  v_cvt_pk_bf16_f32 v106, v108, v109
  v_cvt_pk_bf16_f32 v107, v110, v111
  buffer_store_dwordx4 v[104:107], v13, s[8:11], s31 offen sc1
  v_cvt_pk_bf16_f32 v112, v112, v113
  v_cvt_pk_bf16_f32 v113, v114, v115
  v_cvt_pk_bf16_f32 v114, v116, v117
  v_cvt_pk_bf16_f32 v115, v118, v119
  buffer_store_dwordx4 v[112:115], v14, s[8:11], s31 offen sc1
  v_cvt_pk_bf16_f32 v120, v120, v121
  v_cvt_pk_bf16_f32 v121, v122, v123
  v_cvt_pk_bf16_f32 v122, v124, v125
  v_cvt_pk_bf16_f32 v123, v126, v127
  buffer_store_dwordx4 v[120:123], v15, s[8:11], s31 offen sc1
  s_cmp_lg_u32 s34, 0
  s_cbranch_scc1 wp_B2
  s_mov_b32 s60, s40
  s_and_b32 s61, s41, 0xffff
  s_mov_b32 s62, 3670016
  s_mov_b32 s63, 0x20000
  s_mov_b32 s56, s42
  s_and_b32 s57, s43, 0xffff
  s_mov_b32 s58, 3670016
  s_mov_b32 s59, 0x20000
  s_lshl_b32 s27, s18, 2
  s_add_u32 s27, s27, s16
  s_lshl_b32 s27, s27, 17
  s_add_u32 s27, s27, s26
  s_lshl_b32 s30, s16, 13
  s_add_u32 m0, s30, 0
  s_nop 0
  buffer_load_dwordx4 v26, s[56:59], s27 offen  lds
  s_add_u32 s27, s27, 16384
  s_add_u32 m0, s30, 1024
  s_nop 0
  buffer_load_dwordx4 v26, s[56:59], s27 offen  lds
  s_add_u32 s27, s27, 16384
  s_add_u32 m0, s30, 2048
  s_nop 0
  buffer_load_dwordx4 v27, s[56:59], s27 offen  lds
  s_add_u32 s27, s27, 16384
  s_add_u32 m0, s30, 3072
  s_nop 0
  buffer_load_dwordx4 v27, s[56:59], s27 offen  lds
  s_add_u32 s27, s27, 16384
  s_add_u32 m0, s30, 4096
  s_nop 0
  buffer_load_dwordx4 v26, s[56:59], s27 offen  lds
  s_add_u32 s27, s27, 16384
  s_add_u32 m0, s30, 5120
  s_nop 0
  buffer_load_dwordx4 v26, s[56:59], s27 offen  lds
  s_add_u32 s27, s27, 16384
  s_add_u32 m0, s30, 6144
  s_nop 0
  buffer_load_dwordx4 v27, s[56:59], s27 offen  lds
  s_add_u32 s27, s27, 16384
  s_add_u32 m0, s30, 7168
  s_nop 0
  buffer_load_dwordx4 v27, s[56:59], s27 offen  lds
  s_add_u32 s27, s27, 16384
  s_add_u32 s27, s28, 0
  s_min_u32 s27, s27, 13
  s_lshl_b32 s27, s27, 18
  s_add_u32 s27, s27, s26
  s_add_u32 m0, s25, 0
  s_nop 0
  buffer_load_dwordx4 v16, s[60:63], s27 offen  lds
  s_add_u32 s27, s27, 16384
  s_add_u32 m0, s25, 1024
  s_nop 0
  buffer_load_dwordx4 v17, s[60:63], s27 offen  lds
  s_add_u32 s27, s27, 16384
  s_add_u32 m0, s25, 2048
  s_nop 0
  buffer_load_dwordx4 v16, s[60:63], s27 offen  lds
  s_add_u32 s27, s27, 16384
  s_add_u32 m0, s25, 3072
  s_nop 0
  buffer_load_dwordx4 v17, s[60:63], s27 offen  lds
  s_add_u32 s27, s27, 16384
  s_waitcnt vmcnt(12)
  s_barrier
  s_cmp_lg_u32 s16, 0
  s_cbranch_scc1 wp_f1_f
  v_readfirstlane_b32 s20, v254
  s_cmp_eq_u32 s20, 1
  s_cbranch_scc1 wp_f1_w_ok
  s_mov_b32 s30, 0
wp_f1_w:
  buffer_load_dword v254, off, s[12:15], 0 offset:128 sc1
  s_waitcnt vmcnt(0)
  v_cmp_ne_u32 vcc, 1, v254
  s_cbranch_vccz wp_f1_w_ok
  s_sleep 8
  s_add_u32 s30, s30, 1
  s_cmp_lt_u32 s30, 16
  s_cbranch_scc1 wp_f1_w
  s_branch wp_f1_f
wp_f1_w_ok:
  s_lshl_b32 s20, s17, 7
  s_add_u32 s20, s20, 88519168
  s_lshl_b32 s21, 1, s19
  v_mov_b32 v248, s21
  s_mov_b64 exec, 1
  buffer_atomic_or v248, v252, s[8:11], s20 offen sc0
  s_mov_b64 exec, -1
  s_mov_b32 s37, s21
wp_f1_f:
  s_add_u32 m0, s25, 4096
  s_nop 0
  buffer_load_dwordx4 v18, s[60:63], s27 offen  lds
  s_add_u32 s27, s27, 16384
  s_add_u32 m0, s25, 5120
  s_nop 0
  buffer_load_dwordx4 v19, s[60:63], s27 offen  lds
  s_add_u32 s27, s27, 16384
  s_add_u32 m0, s25, 6144
  s_nop 0
  buffer_load_dwordx4 v18, s[60:63], s27 offen  lds
  s_add_u32 s27, s27, 16384
  s_add_u32 m0, s25, 7168
  s_nop 0
  buffer_load_dwordx4 v19, s[60:63], s27 offen  lds
  s_add_u32 s27, s27, 16384
  s_add_u32 m0, s25, 8192
  s_nop 0
  buffer_load_dwordx4 v20, s[60:63], s27 offen  lds
  s_add_u32 s27, s27, 16384
  s_add_u32 m0, s25, 9216
  s_nop 0
  buffer_load_dwordx4 v21, s[60:63], s27 offen  lds
  s_add_u32 s27, s27, 16384
  s_add_u32 m0, s25, 10240
  s_nop 0
  buffer_load_dwordx4 v20, s[60:63], s27 offen  lds
  s_add_u32 s27, s27, 16384
  s_add_u32 m0, s25, 11264
  s_nop 0
  buffer_load_dwordx4 v21, s[60:63], s27 offen  lds
  s_add_u32 s27, s27, 16384
  s_add_u32 m0, s25, 12288
  s_nop 0
  buffer_load_dwordx4 v22, s[60:63], s27 offen  lds
  s_add_u32 s27, s27, 16384
  s_add_u32 m0, s25, 13312
  s_nop 0
  buffer_load_dwordx4 v23, s[60:63], s27 offen  lds
  s_add_u32 s27, s27, 16384
  s_add_u32 m0, s25, 14336
  s_nop 0
  buffer_load_dwordx4 v22, s[60:63], s27 offen  lds
  s_add_u32 s27, s27, 16384
  s_add_u32 m0, s25, 15360
  s_nop 0
  buffer_load_dwordx4 v23, s[60:63], s27 offen  lds
  s_add_u32 s27, s27, 16384
  s_add_u32 s27, s28, 4
  s_min_u32 s27, s27, 13
  s_lshl_b32 s27, s27, 18
  s_add_u32 s27, s27, s26
  s_waitcnt vmcnt(12)
  v_readfirstlane_b32 s20, v248
  s_and_b32 s20, s20, 16383
  s_xor_b32 s20, s20, s37
  s_cmp_lg_u32 s20, 16383
  s_cselect_b32 s20, 0, s37
  s_mov_b32 s37, 0
  s_cmp_eq_u32 s20, 0
  s_cbranch_scc1 wp_g1
  s_lshl_b32 s21, 1, s17
  v_mov_b32 v248, s21
  s_mov_b32 s20, 88523264
  v_lshlrev_b32 v247, 7, v0
  s_mov_b64 exec, 0xff
  buffer_atomic_or v248, v247, s[8:11], s20 offen
  s_mov_b64 exec, -1
wp_g1:
  s_add_u32 m0, s25, 16384
  s_nop 0
  buffer_load_dwordx4 v16, s[60:63], s27 offen  lds
  s_add_u32 s27, s27, 16384
  s_add_u32 m0, s25, 17408
  s_nop 0
  buffer_load_dwordx4 v17, s[60:63], s27 offen  lds
  s_add_u32 s27, s27, 16384
  s_add_u32 m0, s25, 18432
  s_nop 0
  buffer_load_dwordx4 v16, s[60:63], s27 offen  lds
  s_add_u32 s27, s27, 16384
  s_add_u32 m0, s25, 19456
  s_nop 0
  buffer_load_dwordx4 v17, s[60:63], s27 offen  lds
  s_add_u32 s27, s27, 16384
  s_add_u32 m0, s25, 20480
  s_nop 0
  buffer_load_dwordx4 v18, s[60:63], s27 offen  lds
  s_add_u32 s27, s27, 16384
  s_add_u32 m0, s25, 21504
  s_nop 0
  buffer_load_dwordx4 v19, s[60:63], s27 offen  lds
  s_add_u32 s27, s27, 16384
  s_add_u32 m0, s25, 22528
  s_nop 0
  buffer_load_dwordx4 v18, s[60:63], s27 offen  lds
  s_add_u32 s27, s27, 16384
  s_add_u32 m0, s25, 23552
  s_nop 0
  buffer_load_dwordx4 v19, s[60:63], s27 offen  lds
  s_add_u32 s27, s27, 16384
  s_add_u32 m0, s25, 24576
  s_nop 0
  buffer_load_dwordx4 v20, s[60:63], s27 offen  lds
  s_add_u32 s27, s27, 16384
  s_add_u32 m0, s25, 25600
  s_nop 0
  buffer_load_dwordx4 v21, s[60:63], s27 offen  lds
  s_add_u32 s27, s27, 16384
  s_add_u32 m0, s25, 26624
  s_nop 0
  buffer_load_dwordx4 v20, s[60:63], s27 offen  lds
  s_add_u32 s27, s27, 16384
  s_add_u32 m0, s25, 27648
  s_nop 0
  buffer_load_dwordx4 v21, s[60:63], s27 offen  lds
  s_add_u32 s27, s27, 16384
  s_add_u32 m0, s25, 28672
  s_nop 0
  buffer_load_dwordx4 v22, s[60:63], s27 offen  lds
  s_add_u32 s27, s27, 16384
  s_add_u32 m0, s25, 29696
  s_nop 0
  buffer_load_dwordx4 v23, s[60:63], s27 offen  lds
  s_add_u32 s27, s27, 16384
  s_add_u32 m0, s25, 30720
  s_nop 0
  buffer_load_dwordx4 v22, s[60:63], s27 offen  lds
  s_add_u32 s27, s27, 16384
  s_add_u32 m0, s25, 31744
  s_nop 0
  buffer_load_dwordx4 v23, s[60:63], s27 offen  lds
  s_add_u32 s27, s27, 16384
  s_branch wp_A
wp_B2:
  v_lshlrev_b32 v6, 7, v1
  s_getpc_b64 s[98:99]
ct_6:
  s_add_u32 s98, s98, wp_fin-ct_6
  s_addc_u32 s99, s99, 0
  global_load_dword v7, v6, s[98:99]
  s_getpc_b64 s[98:99]
ct_7:
  s_add_u32 s98, s98, wg_vo-ct_7
  s_addc_u32 s99, s99, 0
  global_load_dword v7, v6, s[98:99]
  s_waitcnt vmcnt(2)
  s_barrier
  s_cmp_lg_u32 s16, 0
  s_cbranch_scc1 wp_f2_f
  v_readfirstlane_b32 s20, v254
  s_cmp_eq_u32 s20, 1
  s_cbranch_scc1 wp_f2_w_ok
  s_mov_b32 s30, 0
wp_f2_w:
  buffer_load_dword v254, off, s[12:15], 0 offset:128 sc1
  s_waitcnt vmcnt(0)
  v_cmp_ne_u32 vcc, 1, v254
  s_cbranch_vccz wp_f2_w_ok
  s_sleep 8
  s_add_u32 s30, s30, 1
  s_cmp_lt_u32 s30, 16
  s_cbranch_scc1 wp_f2_w
  s_branch wp_f2_f
wp_f2_w_ok:
  s_lshl_b32 s20, s17, 7
  s_add_u32 s20, s20, 88519168
  s_lshl_b32 s21, 1, s19
  v_mov_b32 v248, s21
  s_mov_b64 exec, 1
  buffer_atomic_or v248, v252, s[8:11], s20 offen sc0
  s_mov_b64 exec, -1
  s_mov_b32 s37, s21
wp_f2_f:
  s_cmp_eq_u32 s97, 0
  s_cselect_b32 s39, -4, s39
  s_branch wp_fin
wp_A0:
  s_mov_b32 s60, s40
  s_and_b32 s61, s41, 0xffff
  s_mov_b32 s62, 3670016
  s_mov_b32 s63, 0x20000
  s_mov_b32 s56, s42
  s_and_b32 s57, s43, 0xffff
  s_mov_b32 s58, 3670016
  s_mov_b32 s59, 0x20000
  s_lshl_b32 s27, s18, 2
  s_add_u32 s27, s27, s16
  s_lshl_b32 s27, s27, 17
  s_add_u32 s27, s27, s26
  s_lshl_b32 s30, s16, 13
  s_add_u32 m0, s30, 0
  s_nop 0
  buffer_load_dwordx4 v26, s[56:59], s27 offen  lds
  s_add_u32 s27, s27, 16384
  s_add_u32 m0, s30, 1024
  s_nop 0
  buffer_load_dwordx4 v26, s[56:59], s27 offen  lds
  s_add_u32 s27, s27, 16384
  s_add_u32 m0, s30, 2048
  s_nop 0
  buffer_load_dwordx4 v27, s[56:59], s27 offen  lds
  s_add_u32 s27, s27, 16384
  s_add_u32 m0, s30, 3072
  s_nop 0
  buffer_load_dwordx4 v27, s[56:59], s27 offen  lds
  s_add_u32 s27, s27, 16384
  s_add_u32 m0, s30, 4096
  s_nop 0
  buffer_load_dwordx4 v26, s[56:59], s27 offen  lds
  s_add_u32 s27, s27, 16384
  s_add_u32 m0, s30, 5120
  s_nop 0
  buffer_load_dwordx4 v26, s[56:59], s27 offen  lds
  s_add_u32 s27, s27, 16384
  s_add_u32 m0, s30, 6144
  s_nop 0
  buffer_load_dwordx4 v27, s[56:59], s27 offen  lds
  s_add_u32 s27, s27, 16384
  s_add_u32 m0, s30, 7168
  s_nop 0
  buffer_load_dwordx4 v27, s[56:59], s27 offen  lds
  s_add_u32 s27, s27, 16384
  s_add_u32 s27, s28, 0
  s_min_u32 s27, s27, 13
  s_lshl_b32 s27, s27, 18
  s_add_u32 s27, s27, s26
  s_add_u32 m0, s25, 0
  s_nop 0
  buffer_load_dwordx4 v16, s[60:63], s27 offen  lds
  s_add_u32 s27, s27, 16384
  s_add_u32 m0, s25, 1024
  s_nop 0
  buffer_load_dwordx4 v17, s[60:63], s27 offen  lds
  s_add_u32 s27, s27, 16384
  s_add_u32 m0, s25, 2048
  s_nop 0
  buffer_load_dwordx4 v16, s[60:63], s27 offen  lds
  s_add_u32 s27, s27, 16384
  s_add_u32 m0, s25, 3072
  s_nop 0
  buffer_load_dwordx4 v17, s[60:63], s27 offen  lds
  s_add_u32 s27, s27, 16384
  s_add_u32 m0, s25, 4096
  s_nop 0
  buffer_load_dwordx4 v18, s[60:63], s27 offen  lds
  s_add_u32 s27, s27, 16384
  s_add_u32 m0, s25, 5120
  s_nop 0
  buffer_load_dwordx4 v19, s[60:63], s27 offen  lds
  s_add_u32 s27, s27, 16384
  s_add_u32 m0, s25, 6144
  s_nop 0
  buffer_load_dwordx4 v18, s[60:63], s27 offen  lds
  s_add_u32 s27, s27, 16384
  s_add_u32 m0, s25, 7168
  s_nop 0
  buffer_load_dwordx4 v19, s[60:63], s27 offen  lds
  s_add_u32 s27, s27, 16384
  s_add_u32 m0, s25, 8192
  s_nop 0
  buffer_load_dwordx4 v20, s[60:63], s27 offen  lds
  s_add_u32 s27, s27, 16384
  s_add_u32 m0, s25, 9216
  s_nop 0
  buffer_load_dwordx4 v21, s[60:63], s27 offen  lds
  s_add_u32 s27, s27, 16384
  s_add_u32 m0, s25, 10240
  s_nop 0
  buffer_load_dwordx4 v20, s[60:63], s27 offen  lds
  s_add_u32 s27, s27, 16384
  s_add_u32 m0, s25, 11264
  s_nop 0
  buffer_load_dwordx4 v21, s[60:63], s27 offen  lds
  s_add_u32 s27, s27, 16384
  s_add_u32 m0, s25, 12288
  s_nop 0
  buffer_load_dwordx4 v22, s[60:63], s27 offen  lds
  s_add_u32 s27, s27, 16384
  s_add_u32 m0, s25, 13312
  s_nop 0
  buffer_load_dwordx4 v23, s[60:63], s27 offen  lds
  s_add_u32 s27, s27, 16384
  s_add_u32 m0, s25, 14336
  s_nop 0
  buffer_load_dwordx4 v22, s[60:63], s27 offen  lds
  s_add_u32 s27, s27, 16384
  s_add_u32 m0, s25, 15360
  s_nop 0
  buffer_load_dwordx4 v23, s[60:63], s27 offen  lds
  s_add_u32 s27, s27, 16384
  s_add_u32 s27, s28, 4
  s_min_u32 s27, s27, 13
  s_lshl_b32 s27, s27, 18
  s_add_u32 s27, s27, s26
  s_add_u32 m0, s25, 16384
  s_nop 0
  buffer_load_dwordx4 v16, s[60:63], s27 offen  lds
  s_add_u32 s27, s27, 16384
  s_add_u32 m0, s25, 17408
  s_nop 0
  buffer_load_dwordx4 v17, s[60:63], s27 offen  lds
  s_add_u32 s27, s27, 16384
  s_add_u32 m0, s25, 18432
  s_nop 0
  buffer_load_dwordx4 v16, s[60:63], s27 offen  lds
  s_add_u32 s27, s27, 16384
  s_add_u32 m0, s25, 19456
  s_nop 0
  buffer_load_dwordx4 v17, s[60:63], s27 offen  lds
  s_add_u32 s27, s27, 16384
  s_add_u32 m0, s25, 20480
  s_nop 0
  buffer_load_dwordx4 v18, s[60:63], s27 offen  lds
  s_add_u32 s27, s27, 16384
  s_add_u32 m0, s25, 21504
  s_nop 0
  buffer_load_dwordx4 v19, s[60:63], s27 offen  lds
  s_add_u32 s27, s27, 16384
  s_add_u32 m0, s25, 22528
  s_nop 0
  buffer_load_dwordx4 v18, s[60:63], s27 offen  lds
  s_add_u32 s27, s27, 16384
  s_add_u32 m0, s25, 23552
  s_nop 0
  buffer_load_dwordx4 v19, s[60:63], s27 offen  lds
  s_add_u32 s27, s27, 16384
  s_add_u32 m0, s25, 24576
  s_nop 0
  buffer_load_dwordx4 v20, s[60:63], s27 offen  lds
  s_add_u32 s27, s27, 16384
  s_add_u32 m0, s25, 25600
  s_nop 0
  buffer_load_dwordx4 v21, s[60:63], s27 offen  lds
  s_add_u32 s27, s27, 16384
  s_add_u32 m0, s25, 26624
  s_nop 0
  buffer_load_dwordx4 v20, s[60:63], s27 offen  lds
  s_add_u32 s27, s27, 16384
  s_add_u32 m0, s25, 27648
  s_nop 0
  buffer_load_dwordx4 v21, s[60:63], s27 offen  lds
  s_add_u32 s27, s27, 16384
  s_add_u32 m0, s25, 28672
  s_nop 0
  buffer_load_dwordx4 v22, s[60:63], s27 offen  lds
  s_add_u32 s27, s27, 16384
  s_add_u32 m0, s25, 29696
  s_nop 0
  buffer_load_dwordx4 v23, s[60:63], s27 offen  lds
  s_add_u32 s27, s27, 16384
  s_add_u32 m0, s25, 30720
  s_nop 0
  buffer_load_dwordx4 v22, s[60:63], s27 offen  lds
  s_add_u32 s27, s27, 16384
  s_add_u32 m0, s25, 31744
  s_nop 0
  buffer_load_dwordx4 v23, s[60:63], s27 offen  lds
  s_add_u32 s27, s27, 16384
  v_lshrrev_b32 v7, 2, v4
  v_lshlrev_b32 v11, 4, v7
  v_lshlrev_b32 v7, 3, v7
  v_and_b32 v8, 3, v4
  v_add_u32 v7, v7, v8
  v_and_b32 v8, 2, v4
  v_lshl_add_u32 v11, v8, 1, v11
  v_and_b32 v8, 1, v4
  v_add_u32 v11, v11, v8
  v_or_b32 v10, 0, v3
  v_xor_b32 v10, v10, v4
  v_lshlrev_b32 v10, 4, v10
  v_lshl_add_u32 v44, v11, 9, v10
  v_lshl_add_u32 v10, v7, 9, v10
  v_add_u32 v32, s25, v10
  v_or_b32 v10, 4, v3
  v_xor_b32 v10, v10, v4
  v_lshlrev_b32 v10, 4, v10
  v_lshl_add_u32 v45, v11, 9, v10
  v_lshl_add_u32 v10, v7, 9, v10
  v_add_u32 v33, s25, v10
  v_or_b32 v10, 8, v3
  v_xor_b32 v10, v10, v4
  v_lshlrev_b32 v10, 4, v10
  v_lshl_add_u32 v46, v11, 9, v10
  v_lshl_add_u32 v10, v7, 9, v10
  v_add_u32 v34, s25, v10
  v_or_b32 v10, 12, v3
  v_xor_b32 v10, v10, v4
  v_lshlrev_b32 v10, 4, v10
  v_lshl_add_u32 v47, v11, 9, v10
  v_lshl_add_u32 v10, v7, 9, v10
  v_add_u32 v35, s25, v10
  s_mul_i32 s30, s17, 401408
  s_mul_i32 s31, s18, 57344
  s_add_u32 s30, s30, s31
  s_add_u32 s30, s30, 0
  v_add_u32 v28, s30, v2
  s_add_u32 s30, s30, 14336
  v_add_u32 v29, s30, v2
  s_add_u32 s30, s30, 14336
  v_add_u32 v30, s30, v2
  s_add_u32 s30, s30, 14336
  v_add_u32 v31, s30, v2
  s_add_u32 s30, s30, 14336
  v_mov_b32 v48, 1035512379
wp_A:
  s_lshl_b32 s29, s28, 10
  s_add_u32 s31, s29, 4096
  s_cmp_lt_u32 s28, 10
  s_cselect_b32 s31, s31, 0x40000000
  s_waitcnt vmcnt(0)
  s_barrier
  ds_read_b128 a[0:3], v44 offset:0
  ds_read_b128 a[32:35], v44 offset:1024
  ds_read_b128 a[64:67], v44 offset:4096
  ds_read_b128 a[96:99], v44 offset:5120
  ds_read_b128 a[128:131], v32 offset:0
  ds_read_b128 a[160:163], v32 offset:2048
  ds_read_b128 a[192:195], v32 offset:16384
  ds_read_b128 a[224:227], v32 offset:18432
  s_waitcnt lgkmcnt(0)
  v_mfma_f32_16x16x32_bf16 v[64:67], a[128:131], a[0:3], 0
  ds_read_b128 a[4:7], v45 offset:0
  ds_read_b128 a[36:39], v45 offset:1024
  v_mfma_f32_16x16x32_bf16 v[68:71], a[160:163], a[0:3], 0
  ds_read_b128 a[68:71], v45 offset:4096
  ds_read_b128 a[100:103], v45 offset:5120
  v_mfma_f32_16x16x32_bf16 v[72:75], a[128:131], a[32:35], 0
  ds_read_b128 a[132:135], v33 offset:0
  ds_read_b128 a[164:167], v33 offset:2048
  v_mfma_f32_16x16x32_bf16 v[76:79], a[160:163], a[32:35], 0
  ds_read_b128 a[196:199], v33 offset:16384
  ds_read_b128 a[228:231], v33 offset:18432
  v_mfma_f32_16x16x32_bf16 v[80:83], a[128:131], a[64:67], 0
  v_mfma_f32_16x16x32_bf16 v[84:87], a[160:163], a[64:67], 0
  v_mfma_f32_16x16x32_bf16 v[88:91], a[128:131], a[96:99], 0
  v_mfma_f32_16x16x32_bf16 v[92:95], a[160:163], a[96:99], 0
  v_mfma_f32_16x16x32_bf16 v[96:99], a[192:195], a[0:3], 0
  v_mfma_f32_16x16x32_bf16 v[100:103], a[224:227], a[0:3], 0
  v_mfma_f32_16x16x32_bf16 v[104:107], a[192:195], a[32:35], 0
  v_mfma_f32_16x16x32_bf16 v[108:111], a[224:227], a[32:35], 0
  v_mfma_f32_16x16x32_bf16 v[112:115], a[192:195], a[64:67], 0
  v_mfma_f32_16x16x32_bf16 v[116:119], a[224:227], a[64:67], 0
  v_mfma_f32_16x16x32_bf16 v[120:123], a[192:195], a[96:99], 0
  v_mfma_f32_16x16x32_bf16 v[124:127], a[224:227], a[96:99], 0
  s_waitcnt lgkmcnt(0)
  v_mfma_f32_16x16x32_bf16 v[64:67], a[132:135], a[4:7], v[64:67]
  ds_read_b128 a[8:11], v46 offset:0
  ds_read_b128 a[40:43], v46 offset:1024
  v_mfma_f32_16x16x32_bf16 v[68:71], a[164:167], a[4:7], v[68:71]
  ds_read_b128 a[72:75], v46 offset:4096
  ds_read_b128 a[104:107], v46 offset:5120
  v_mfma_f32_16x16x32_bf16 v[72:75], a[132:135], a[36:39], v[72:75]
  ds_read_b128 a[136:139], v34 offset:0
  ds_read_b128 a[168:171], v34 offset:2048
  v_mfma_f32_16x16x32_bf16 v[76:79], a[164:167], a[36:39], v[76:79]
  ds_read_b128 a[200:203], v34 offset:16384
  ds_read_b128 a[232:235], v34 offset:18432
  v_mfma_f32_16x16x32_bf16 v[80:83], a[132:135], a[68:71], v[80:83]
  v_mfma_f32_16x16x32_bf16 v[84:87], a[164:167], a[68:71], v[84:87]
  v_mfma_f32_16x16x32_bf16 v[88:91], a[132:135], a[100:103], v[88:91]
  v_mfma_f32_16x16x32_bf16 v[92:95], a[164:167], a[100:103], v[92:95]
  v_mfma_f32_16x16x32_bf16 v[96:99], a[196:199], a[4:7], v[96:99]
  v_mfma_f32_16x16x32_bf16 v[100:103], a[228:231], a[4:7], v[100:103]
  v_mfma_f32_16x16x32_bf16 v[104:107], a[196:199], a[36:39], v[104:107]
  v_mfma_f32_16x16x32_bf16 v[108:111], a[228:231], a[36:39], v[108:111]
  v_mfma_f32_16x16x32_bf16 v[112:115], a[196:199], a[68:71], v[112:115]
  v_mfma_f32_16x16x32_bf16 v[116:119], a[228:231], a[68:71], v[116:119]
  v_mfma_f32_16x16x32_bf16 v[120:123], a[196:199], a[100:103], v[120:123]
  v_mfma_f32_16x16x32_bf16 v[124:127], a[228:231], a[100:103], v[124:127]
  s_waitcnt lgkmcnt(0)
  v_mfma_f32_16x16x32_bf16 v[64:67], a[136:139], a[8:11], v[64:67]
  ds_read_b128 a[12:15], v47 offset:0
  ds_read_b128 a[44:47], v47 offset:1024
  v_mfma_f32_16x16x32_bf16 v[68:71], a[168:171], a[8:11], v[68:71]
  ds_read_b128 a[76:79], v47 offset:4096
  ds_read_b128 a[108:111], v47 offset:5120
  v_mfma_f32_16x16x32_bf16 v[72:75], a[136:139], a[40:43], v[72:75]
  ds_read_b128 a[140:143], v35 offset:0
  ds_read_b128 a[172:175], v35 offset:2048
  v_mfma_f32_16x16x32_bf16 v[76:79], a[168:171], a[40:43], v[76:79]
  ds_read_b128 a[204:207], v35 offset:16384
  ds_read_b128 a[236:239], v35 offset:18432
  v_mfma_f32_16x16x32_bf16 v[80:83], a[136:139], a[72:75], v[80:83]
  v_mfma_f32_16x16x32_bf16 v[84:87], a[168:171], a[72:75], v[84:87]
  v_mfma_f32_16x16x32_bf16 v[88:91], a[136:139], a[104:107], v[88:91]
  v_mfma_f32_16x16x32_bf16 v[92:95], a[168:171], a[104:107], v[92:95]
  v_mfma_f32_16x16x32_bf16 v[96:99], a[200:203], a[8:11], v[96:99]
  v_mfma_f32_16x16x32_bf16 v[100:103], a[232:235], a[8:11], v[100:103]
  v_mfma_f32_16x16x32_bf16 v[104:107], a[200:203], a[40:43], v[104:107]
  v_mfma_f32_16x16x32_bf16 v[108:111], a[232:235], a[40:43], v[108:111]
  v_mfma_f32_16x16x32_bf16 v[112:115], a[200:203], a[72:75], v[112:115]
  v_mfma_f32_16x16x32_bf16 v[116:119], a[232:235], a[72:75], v[116:119]
  v_mfma_f32_16x16x32_bf16 v[120:123], a[200:203], a[104:107], v[120:123]
  v_mfma_f32_16x16x32_bf16 v[124:127], a[232:235], a[104:107], v[124:127]
  s_waitcnt lgkmcnt(0)
  v_mfma_f32_16x16x32_bf16 v[64:67], a[140:143], a[12:15], v[64:67]
  ds_read_b128 a[16:19], v44 offset:256
  ds_read_b128 a[48:51], v44 offset:1280
  v_mfma_f32_16x16x32_bf16 v[68:71], a[172:175], a[12:15], v[68:71]
  ds_read_b128 a[80:83], v44 offset:4352
  ds_read_b128 a[112:115], v44 offset:5376
  v_mfma_f32_16x16x32_bf16 v[72:75], a[140:143], a[44:47], v[72:75]
  ds_read_b128 a[144:147], v32 offset:256
  ds_read_b128 a[176:179], v32 offset:2304
  v_mfma_f32_16x16x32_bf16 v[76:79], a[172:175], a[44:47], v[76:79]
  ds_read_b128 a[208:211], v32 offset:16640
  ds_read_b128 a[240:243], v32 offset:18688
  v_mfma_f32_16x16x32_bf16 v[80:83], a[140:143], a[76:79], v[80:83]
  v_mfma_f32_16x16x32_bf16 v[84:87], a[172:175], a[76:79], v[84:87]
  v_mfma_f32_16x16x32_bf16 v[88:91], a[140:143], a[108:111], v[88:91]
  v_mfma_f32_16x16x32_bf16 v[92:95], a[172:175], a[108:111], v[92:95]
  v_mfma_f32_16x16x32_bf16 v[96:99], a[204:207], a[12:15], v[96:99]
  v_mfma_f32_16x16x32_bf16 v[100:103], a[236:239], a[12:15], v[100:103]
  v_mfma_f32_16x16x32_bf16 v[104:107], a[204:207], a[44:47], v[104:107]
  v_mfma_f32_16x16x32_bf16 v[108:111], a[236:239], a[44:47], v[108:111]
  v_mfma_f32_16x16x32_bf16 v[112:115], a[204:207], a[76:79], v[112:115]
  v_mfma_f32_16x16x32_bf16 v[116:119], a[236:239], a[76:79], v[116:119]
  v_mfma_f32_16x16x32_bf16 v[120:123], a[204:207], a[108:111], v[120:123]
  v_mfma_f32_16x16x32_bf16 v[124:127], a[236:239], a[108:111], v[124:127]
  s_waitcnt lgkmcnt(0)
  v_mfma_f32_16x16x32_bf16 v[64:67], a[144:147], a[16:19], v[64:67]
  ds_read_b128 a[20:23], v45 offset:256
  ds_read_b128 a[52:55], v45 offset:1280
  v_mfma_f32_16x16x32_bf16 v[68:71], a[176:179], a[16:19], v[68:71]
  ds_read_b128 a[84:87], v45 offset:4352
  ds_read_b128 a[116:119], v45 offset:5376
  v_mfma_f32_16x16x32_bf16 v[72:75], a[144:147], a[48:51], v[72:75]
  ds_read_b128 a[148:151], v33 offset:256
  ds_read_b128 a[180:183], v33 offset:2304
  v_mfma_f32_16x16x32_bf16 v[76:79], a[176:179], a[48:51], v[76:79]
  ds_read_b128 a[212:215], v33 offset:16640
  ds_read_b128 a[244:247], v33 offset:18688
  v_mfma_f32_16x16x32_bf16 v[80:83], a[144:147], a[80:83], v[80:83]
  v_mfma_f32_16x16x32_bf16 v[84:87], a[176:179], a[80:83], v[84:87]
  v_mfma_f32_16x16x32_bf16 v[88:91], a[144:147], a[112:115], v[88:91]
  v_mfma_f32_16x16x32_bf16 v[92:95], a[176:179], a[112:115], v[92:95]
  v_mfma_f32_16x16x32_bf16 v[96:99], a[208:211], a[16:19], v[96:99]
  v_mfma_f32_16x16x32_bf16 v[100:103], a[240:243], a[16:19], v[100:103]
  v_mfma_f32_16x16x32_bf16 v[104:107], a[208:211], a[48:51], v[104:107]
  v_mfma_f32_16x16x32_bf16 v[108:111], a[240:243], a[48:51], v[108:111]
  v_mfma_f32_16x16x32_bf16 v[112:115], a[208:211], a[80:83], v[112:115]
  v_mfma_f32_16x16x32_bf16 v[116:119], a[240:243], a[80:83], v[116:119]
  v_mfma_f32_16x16x32_bf16 v[120:123], a[208:211], a[112:115], v[120:123]
  v_mfma_f32_16x16x32_bf16 v[124:127], a[240:243], a[112:115], v[124:127]
  s_waitcnt lgkmcnt(0)
  v_mfma_f32_16x16x32_bf16 v[64:67], a[148:151], a[20:23], v[64:67]
  ds_read_b128 a[24:27], v46 offset:256
  ds_read_b128 a[56:59], v46 offset:1280
  v_mfma_f32_16x16x32_bf16 v[68:71], a[180:183], a[20:23], v[68:71]
  ds_read_b128 a[88:91], v46 offset:4352
  ds_read_b128 a[120:123], v46 offset:5376
  v_mfma_f32_16x16x32_bf16 v[72:75], a[148:151], a[52:55], v[72:75]
  ds_read_b128 a[152:155], v34 offset:256
  ds_read_b128 a[184:187], v34 offset:2304
  v_mfma_f32_16x16x32_bf16 v[76:79], a[180:183], a[52:55], v[76:79]
  ds_read_b128 a[216:219], v34 offset:16640
  ds_read_b128 a[248:251], v34 offset:18688
  v_mfma_f32_16x16x32_bf16 v[80:83], a[148:151], a[84:87], v[80:83]
  v_mfma_f32_16x16x32_bf16 v[84:87], a[180:183], a[84:87], v[84:87]
  v_mfma_f32_16x16x32_bf16 v[88:91], a[148:151], a[116:119], v[88:91]
  v_mfma_f32_16x16x32_bf16 v[92:95], a[180:183], a[116:119], v[92:95]
  v_mfma_f32_16x16x32_bf16 v[96:99], a[212:215], a[20:23], v[96:99]
  v_mfma_f32_16x16x32_bf16 v[100:103], a[244:247], a[20:23], v[100:103]
  v_mfma_f32_16x16x32_bf16 v[104:107], a[212:215], a[52:55], v[104:107]
  v_mfma_f32_16x16x32_bf16 v[108:111], a[244:247], a[52:55], v[108:111]
  v_mfma_f32_16x16x32_bf16 v[112:115], a[212:215], a[84:87], v[112:115]
  v_mfma_f32_16x16x32_bf16 v[116:119], a[244:247], a[84:87], v[116:119]
  v_mfma_f32_16x16x32_bf16 v[120:123], a[212:215], a[116:119], v[120:123]
  v_mfma_f32_16x16x32_bf16 v[124:127], a[244:247], a[116:119], v[124:127]
  s_waitcnt lgkmcnt(0)
  v_mfma_f32_16x16x32_bf16 v[64:67], a[152:155], a[24:27], v[64:67]
  ds_read_b128 a[28:31], v47 offset:256
  ds_read_b128 a[60:63], v47 offset:1280
  v_mfma_f32_16x16x32_bf16 v[68:71], a[184:187], a[24:27], v[68:71]
  ds_read_b128 a[92:95], v47 offset:4352
  ds_read_b128 a[124:127], v47 offset:5376
  v_mfma_f32_16x16x32_bf16 v[72:75], a[152:155], a[56:59], v[72:75]
  ds_read_b128 a[156:159], v35 offset:256
  ds_read_b128 a[188:191], v35 offset:2304
  v_mfma_f32_16x16x32_bf16 v[76:79], a[184:187], a[56:59], v[76:79]
  ds_read_b128 a[220:223], v35 offset:16640
  ds_read_b128 a[252:255], v35 offset:18688
  v_mfma_f32_16x16x32_bf16 v[80:83], a[152:155], a[88:91], v[80:83]
  v_mfma_f32_16x16x32_bf16 v[84:87], a[184:187], a[88:91], v[84:87]
  v_mfma_f32_16x16x32_bf16 v[88:91], a[152:155], a[120:123], v[88:91]
  v_mfma_f32_16x16x32_bf16 v[92:95], a[184:187], a[120:123], v[92:95]
  v_mfma_f32_16x16x32_bf16 v[96:99], a[216:219], a[24:27], v[96:99]
  v_mfma_f32_16x16x32_bf16 v[100:103], a[248:251], a[24:27], v[100:103]
  v_mfma_f32_16x16x32_bf16 v[104:107], a[216:219], a[56:59], v[104:107]
  v_mfma_f32_16x16x32_bf16 v[108:111], a[248:251], a[56:59], v[108:111]
  v_mfma_f32_16x16x32_bf16 v[112:115], a[216:219], a[88:91], v[112:115]
  v_mfma_f32_16x16x32_bf16 v[116:119], a[248:251], a[88:91], v[116:119]
  v_mfma_f32_16x16x32_bf16 v[120:123], a[216:219], a[120:123], v[120:123]
  v_mfma_f32_16x16x32_bf16 v[124:127], a[248:251], a[120:123], v[124:127]
  s_waitcnt lgkmcnt(0)
  s_barrier
  buffer_load_dwordx2 v[254:255], v252, s[12:15], 0 offen offset:128 sc1
  buffer_load_dword v253, v252, s[12:15], 0 offen sc1
  v_mfma_f32_16x16x32_bf16 v[64:67], a[156:159], a[28:31], v[64:67]
  v_mfma_f32_16x16x32_bf16 v[68:71], a[188:191], a[28:31], v[68:71]
  v_mfma_f32_16x16x32_bf16 v[72:75], a[156:159], a[60:63], v[72:75]
  v_mfma_f32_16x16x32_bf16 v[76:79], a[188:191], a[60:63], v[76:79]
  v_mfma_f32_16x16x32_bf16 v[80:83], a[156:159], a[92:95], v[80:83]
  v_pk_mul_f32 v[64:65], v[64:65], v[48:49] op_sel_hi:[1,0]
  v_pk_mul_f32 v[66:67], v[66:67], v[48:49] op_sel_hi:[1,0]
  v_mfma_f32_16x16x32_bf16 v[84:87], a[188:191], a[92:95], v[84:87]
  v_pk_mul_f32 v[68:69], v[68:69], v[48:49] op_sel_hi:[1,0]
  v_pk_mul_f32 v[70:71], v[70:71], v[48:49] op_sel_hi:[1,0]
  v_mfma_f32_16x16x32_bf16 v[88:91], a[156:159], a[124:127], v[88:91]
  v_cvt_pk_bf16_f32 v64, v64, v65
  v_cvt_pk_bf16_f32 v65, v66, v67
  v_mfma_f32_16x16x32_bf16 v[92:95], a[188:191], a[124:127], v[92:95]
  v_cvt_pk_bf16_f32 v66, v68, v69
  v_cvt_pk_bf16_f32 v67, v70, v71
  v_mfma_f32_16x16x32_bf16 v[96:99], a[220:223], a[28:31], v[96:99]
  buffer_store_dwordx4 v[64:67], v28, s[8:11], s29 offen sc1
  v_pk_mul_f32 v[72:73], v[72:73], v[48:49] op_sel_hi:[1,0]
  v_mfma_f32_16x16x32_bf16 v[100:103], a[252:255], a[28:31], v[100:103]
  v_pk_mul_f32 v[74:75], v[74:75], v[48:49] op_sel_hi:[1,0]
  v_pk_mul_f32 v[76:77], v[76:77], v[48:49] op_sel_hi:[1,0]
  v_mfma_f32_16x16x32_bf16 v[104:107], a[220:223], a[60:63], v[104:107]
  v_pk_mul_f32 v[78:79], v[78:79], v[48:49] op_sel_hi:[1,0]
  v_cvt_pk_bf16_f32 v72, v72, v73
  v_mfma_f32_16x16x32_bf16 v[108:111], a[252:255], a[60:63], v[108:111]
  v_cvt_pk_bf16_f32 v73, v74, v75
  v_cvt_pk_bf16_f32 v74, v76, v77
  v_mfma_f32_16x16x32_bf16 v[112:115], a[220:223], a[92:95], v[112:115]
  v_cvt_pk_bf16_f32 v75, v78, v79
  buffer_store_dwordx4 v[72:75], v29, s[8:11], s29 offen sc1
  v_mfma_f32_16x16x32_bf16 v[116:119], a[252:255], a[92:95], v[116:119]
  v_pk_mul_f32 v[80:81], v[80:81], v[48:49] op_sel_hi:[1,0]
  v_pk_mul_f32 v[82:83], v[82:83], v[48:49] op_sel_hi:[1,0]
  v_mfma_f32_16x16x32_bf16 v[120:123], a[220:223], a[124:127], v[120:123]
  v_pk_mul_f32 v[84:85], v[84:85], v[48:49] op_sel_hi:[1,0]
  v_pk_mul_f32 v[86:87], v[86:87], v[48:49] op_sel_hi:[1,0]
  v_mfma_f32_16x16x32_bf16 v[124:127], a[252:255], a[124:127], v[124:127]
  v_cvt_pk_bf16_f32 v80, v80, v81
  v_cvt_pk_bf16_f32 v81, v82, v83
  v_cvt_pk_bf16_f32 v82, v84, v85
  v_cvt_pk_bf16_f32 v83, v86, v87
  buffer_store_dwordx4 v[80:83], v30, s[8:11], s29 offen sc1
  v_pk_mul_f32 v[88:89], v[88:89], v[48:49] op_sel_hi:[1,0]
  v_pk_mul_f32 v[90:91], v[90:91], v[48:49] op_sel_hi:[1,0]
  v_pk_mul_f32 v[92:93], v[92:93], v[48:49] op_sel_hi:[1,0]
  v_pk_mul_f32 v[94:95], v[94:95], v[48:49] op_sel_hi:[1,0]
  v_cvt_pk_bf16_f32 v88, v88, v89
  v_cvt_pk_bf16_f32 v89, v90, v91
  v_cvt_pk_bf16_f32 v90, v92, v93
  v_cvt_pk_bf16_f32 v91, v94, v95
  buffer_store_dwordx4 v[88:91], v31, s[8:11], s29 offen sc1
  v_pk_mul_f32 v[96:97], v[96:97], v[48:49] op_sel_hi:[1,0]
  v_pk_mul_f32 v[98:99], v[98:99], v[48:49] op_sel_hi:[1,0]
  v_pk_mul_f32 v[100:101], v[100:101], v[48:49] op_sel_hi:[1,0]
  v_pk_mul_f32 v[102:103], v[102:103], v[48:49] op_sel_hi:[1,0]
  v_cvt_pk_bf16_f32 v96, v96, v97
  v_cvt_pk_bf16_f32 v97, v98, v99
  v_cvt_pk_bf16_f32 v98, v100, v101
  v_cvt_pk_bf16_f32 v99, v102, v103
  buffer_store_dwordx4 v[96:99], v28, s[8:11], s31 offen sc1
  v_pk_mul_f32 v[104:105], v[104:105], v[48:49] op_sel_hi:[1,0]
  v_pk_mul_f32 v[106:107], v[106:107], v[48:49] op_sel_hi:[1,0]
  v_pk_mul_f32 v[108:109], v[108:109], v[48:49] op_sel_hi:[1,0]
  v_pk_mul_f32 v[110:111], v[110:111], v[48:49] op_sel_hi:[1,0]
  v_cvt_pk_bf16_f32 v104, v104, v105
  v_cvt_pk_bf16_f32 v105, v106, v107
  v_cvt_pk_bf16_f32 v106, v108, v109
  v_cvt_pk_bf16_f32 v107, v110, v111
  buffer_store_dwordx4 v[104:107], v29, s[8:11], s31 offen sc1
  v_pk_mul_f32 v[112:113], v[112:113], v[48:49] op_sel_hi:[1,0]
  v_pk_mul_f32 v[114:115], v[114:115], v[48:49] op_sel_hi:[1,0]
  v_pk_mul_f32 v[116:117], v[116:117], v[48:49] op_sel_hi:[1,0]
  v_pk_mul_f32 v[118:119], v[118:119], v[48:49] op_sel_hi:[1,0]
  v_cvt_pk_bf16_f32 v112, v112, v113
  v_cvt_pk_bf16_f32 v113, v114, v115
  v_cvt_pk_bf16_f32 v114, v116, v117
  v_cvt_pk_bf16_f32 v115, v118, v119
  buffer_store_dwordx4 v[112:115], v30, s[8:11], s31 offen sc1
  v_pk_mul_f32 v[120:121], v[120:121], v[48:49] op_sel_hi:[1,0]
  v_pk_mul_f32 v[122:123], v[122:123], v[48:49] op_sel_hi:[1,0]
  v_pk_mul_f32 v[124:125], v[124:125], v[48:49] op_sel_hi:[1,0]
  v_pk_mul_f32 v[126:127], v[126:127], v[48:49] op_sel_hi:[1,0]
  v_cvt_pk_bf16_f32 v120, v120, v121
  v_cvt_pk_bf16_f32 v121, v122, v123
  v_cvt_pk_bf16_f32 v122, v124, v125
  v_cvt_pk_bf16_f32 v123, v126, v127
  buffer_store_dwordx4 v[120:123], v31, s[8:11], s31 offen sc1
  s_waitcnt vmcnt(0)
  s_barrier
  s_cmp_lg_u32 s16, 0
  s_cbranch_scc1 wp_f3_f
  v_readfirstlane_b32 s20, v254
  s_cmp_eq_u32 s20, 1
  s_cbranch_scc1 wp_f3_w_ok
  s_mov_b32 s30, 0
wp_f3_w:
  buffer_load_dword v254, off, s[12:15], 0 offset:128 sc1
  s_waitcnt vmcnt(0)
  v_cmp_ne_u32 vcc, 1, v254
  s_cbranch_vccz wp_f3_w_ok
  s_sleep 8
  s_add_u32 s30, s30, 1
  s_cmp_lt_u32 s30, 16
  s_cbranch_scc1 wp_f3_w
  s_branch wp_f3_f
wp_f3_w_ok:
  s_lshl_b32 s20, s17, 7
  s_add_u32 s20, s20, 88521216
  s_lshl_b32 s21, 1, s19
  v_mov_b32 v248, s21
  s_mov_b64 exec, 1
  buffer_atomic_or v248, v252, s[8:11], s20 offen sc0
  s_mov_b64 exec, -1
  s_mov_b32 s38, s21
wp_f3_f:
  s_cmp_eq_u32 s97, 3
  s_cbranch_scc1 wk_adone
wp_fin:
  s_cmp_lg_u32 s97, 0
  s_cbranch_scc1 wp_all
  v_readfirstlane_b32 s20, v254
  v_readfirstlane_b32 s21, v253
  s_and_b32 s21, s21, 0xffe0
  s_cselect_b32 s96, s20, 0
  s_cmp_eq_u32 s96, 0
  s_cbranch_scc1 wp_all
  v_mov_b32 v250, 1
  s_mov_b32 s20, 88525312
  s_mov_b64 exec, 1
  buffer_atomic_add v250, v252, s[8:11], s20 offen sc0
  s_mov_b64 exec, -1
wp_all:
  v_mov_b32 v252, 0x40000000
  v_cmp_eq_u32 vcc, 0, v0
  s_nop 1
  v_cndmask_b32 v252, v252, v0, vcc
  s_mov_b32 s34, 0
  s_cmp_lg_u32 s16, 0
  s_cbranch_scc1 wp_w2
  s_getreg_b32 s24, hwreg(HW_REG_XCC_ID)
  s_sub_u32 s24, s24, 0
  s_and_b32 s24, s24, 7
  s_lshl_b32 s24, s24, 7
  s_add_u32 s24, s24, 88523264
  s_cmp_lg_u32 s96, 0
  s_cbranch_scc1 wp_v0
  s_waitcnt vmcnt(0)
wp_v0:
  s_cmp_eq_u32 s97, 0
  s_cbranch_scc1 wp_v1
  s_waitcnt vmcnt(0)
wp_v1:
  s_waitcnt vmcnt(1)
  v_readfirstlane_b32 s20, v248
  s_and_b32 s20, s20, 14448
  s_xor_b32 s20, s20, s38
  s_cmp_lg_u32 s20, 14448
  s_cselect_b32 s20, 0, s38
  s_mov_b32 s38, 0
  s_cmp_eq_u32 s20, 0
  s_cbranch_scc1 wp_g3
  s_lshl_b32 s21, 65536, s17
  v_mov_b32 v248, s21
  s_mov_b32 s20, 88523264
  v_lshlrev_b32 v247, 7, v0
  s_mov_b64 exec, 0xff
  buffer_atomic_or v248, v247, s[8:11], s20 offen
  s_mov_b64 exec, -1
wp_g3:
  v_readfirstlane_b32 s20, v248
  s_and_b32 s20, s20, 16383
  s_xor_b32 s20, s20, s37
  s_cmp_lg_u32 s20, 16383
  s_cselect_b32 s20, 0, s37
  s_mov_b32 s37, 0
  s_cmp_eq_u32 s20, 0
  s_cbranch_scc1 wp_g2
  s_lshl_b32 s21, 1, s17
  v_mov_b32 v248, s21
  s_mov_b32 s20, 88523264
  v_lshlrev_b32 v247, 7, v0
  s_mov_b64 exec, 0xff
  buffer_atomic_or v248, v247, s[8:11], s20 offen
  s_mov_b64 exec, -1
wp_g2:
  s_cmp_lg_u32 s96, 0
  s_cbranch_scc1 wp_v_ok
  s_mov_b32 s30, 0
wp_v:
  buffer_load_dwordx2 v[64:65], off, s[12:15], 0 sc1
  buffer_load_dword v66, off, s[12:15], 0 offset:128 sc1
  s_waitcnt vmcnt(0)
  v_and_b32 v68, 0xffe0, v64
  v_min_u32 v68, v68, v66
  v_cmp_ne_u32 vcc, 1, v68
  s_cbranch_vccz wp_v_ok
  s_sleep 16
  s_add_u32 s30, s30, 1
  s_cmp_lt_u32 s30, 30
  s_cbranch_scc1 wp_v
  s_branch wp_w1
wp_v_ok:
  v_mov_b32 v64, 32
  s_cmp_eq_u32 s97, 2
  s_cselect_b32 s31, 1, 60
  s_mov_b32 s30, 0
wp_w:
  buffer_load_dwordx2 v[66:67], off, s[8:11], s24 sc1
  s_waitcnt vmcnt(0)
  v_or_b32 v66, s39, v66
  v_add_u32 v66, v66, v67
  v_cmp_ne_u32 vcc, 0, v66
  s_cbranch_vccz wp_w_ok
  s_sleep 8
  s_add_u32 s30, s30, 1
  s_cmp_lt_u32 s30, s31
  s_cbranch_scc1 wp_w
  s_branch wp_w1
wp_w_ok:
  s_branch wp_w2
wp_w1:
  v_readfirstlane_b32 s20, v64
  v_readfirstlane_b32 s21, v65
  s_and_b32 s20, s20, 0xffff
  s_cmp_lt_u32 s20, 32
  s_cselect_b32 s34, 2, 1
  s_add_u32 s32, s32, 1
  s_cmp_lt_u32 s32, 4000
  s_cselect_b32 s34, s34, 3
wp_w2:
  v_mov_b32 v6, 160032
  v_mov_b32 v7, s34
  s_barrier
  s_cmp_lg_u32 s16, 0
  s_cbranch_scc1 uni_8
  ds_write_b32 v6, v7
  s_waitcnt lgkmcnt(0)
uni_8:
  s_barrier
  ds_read_b32 v7, v6
  s_waitcnt lgkmcnt(0)
  v_readfirstlane_b32 s34, v7
  s_cmp_lg_u32 s34, 0
  s_cbranch_scc1 wp_bad
  s_cmp_lg_u32 s39, -4
  s_cbranch_scc1 wp_done
  s_mov_b32 s101, 0
  s_lshl_b32 s20, s101, 4
  s_lshr_b32 s21, s2, 3
  s_add_u32 s21, s21, s16
  s_and_b32 s21, s21, 3
  s_lshl_b32 s21, s21, 2
  s_add_u32 s20, s20, s21
  s_mul_i32 s21, s20, 14336
  s_add_u32 s21, s21, 72024064
  s_add_u32 s22, s21, 0
  buffer_load_dwordx4 a[0:3], v2, s[8:11], s22 offen offset:0 sc1
  buffer_load_dwordx4 a[4:7], v2, s[8:11], s22 offen offset:1024 sc1
  buffer_load_dwordx4 a[8:11], v2, s[8:11], s22 offen offset:2048 sc1
  buffer_load_dwordx4 a[12:15], v2, s[8:11], s22 offen offset:3072 sc1
  s_add_u32 s22, s21, 4096
  buffer_load_dwordx4 a[16:19], v2, s[8:11], s22 offen offset:0 sc1
  buffer_load_dwordx4 a[20:23], v2, s[8:11], s22 offen offset:1024 sc1
  buffer_load_dwordx4 a[24:27], v2, s[8:11], s22 offen offset:2048 sc1
  buffer_load_dwordx4 a[28:31], v2, s[8:11], s22 offen offset:3072 sc1
  s_add_u32 s22, s21, 8192
  buffer_load_dwordx4 a[32:35], v2, s[8:11], s22 offen offset:0 sc1
  buffer_load_dwordx4 a[36:39], v2, s[8:11], s22 offen offset:1024 sc1
  buffer_load_dwordx4 a[40:43], v2, s[8:11], s22 offen offset:2048 sc1
  buffer_load_dwordx4 a[44:47], v2, s[8:11], s22 offen offset:3072 sc1
  s_add_u32 s22, s21, 12288
  buffer_load_dwordx4 a[48:51], v2, s[8:11], s22 offen offset:0 sc1
  buffer_load_dwordx4 a[52:55], v2, s[8:11], s22 offen offset:1024 sc1
  buffer_load_dwordx4 a[56:59], v2, s[8:11], s22 offen offset:2048 sc1
  buffer_load_dwordx4 a[60:63], v2, s[8:11], s22 offen offset:3072 sc1
  s_add_u32 s22, s21, 16384
  buffer_load_dwordx4 a[64:67], v2, s[8:11], s22 offen offset:0 sc1
  buffer_load_dwordx4 a[68:71], v2, s[8:11], s22 offen offset:1024 sc1
  buffer_load_dwordx4 a[72:75], v2, s[8:11], s22 offen offset:2048 sc1
  buffer_load_dwordx4 a[76:79], v2, s[8:11], s22 offen offset:3072 sc1
  s_add_u32 s22, s21, 20480
  buffer_load_dwordx4 a[80:83], v2, s[8:11], s22 offen offset:0 sc1
  buffer_load_dwordx4 a[84:87], v2, s[8:11], s22 offen offset:1024 sc1
  buffer_load_dwordx4 a[88:91], v2, s[8:11], s22 offen offset:2048 sc1
  buffer_load_dwordx4 a[92:95], v2, s[8:11], s22 offen offset:3072 sc1
  s_add_u32 s22, s21, 24576
  buffer_load_dwordx4 a[96:99], v2, s[8:11], s22 offen offset:0 sc1
  buffer_load_dwordx4 a[100:103], v2, s[8:11], s22 offen offset:1024 sc1
  buffer_load_dwordx4 a[104:107], v2, s[8:11], s22 offen offset:2048 sc1
  buffer_load_dwordx4 a[108:111], v2, s[8:11], s22 offen offset:3072 sc1
  s_add_u32 s22, s21, 28672
  buffer_load_dwordx4 a[112:115], v2, s[8:11], s22 offen offset:0 sc1
  buffer_load_dwordx4 a[116:119], v2, s[8:11], s22 offen offset:1024 sc1
  buffer_load_dwordx4 a[120:123], v2, s[8:11], s22 offen offset:2048 sc1
  buffer_load_dwordx4 a[124:127], v2, s[8:11], s22 offen offset:3072 sc1
  s_add_u32 s22, s21, 32768
  buffer_load_dwordx4 a[128:131], v2, s[8:11], s22 offen offset:0 sc1
  buffer_load_dwordx4 a[132:135], v2, s[8:11], s22 offen offset:1024 sc1
  buffer_load_dwordx4 a[136:139], v2, s[8:11], s22 offen offset:2048 sc1
  buffer_load_dwordx4 a[140:143], v2, s[8:11], s22 offen offset:3072 sc1
  s_add_u32 s22, s21, 36864
  buffer_load_dwordx4 a[144:147], v2, s[8:11], s22 offen offset:0 sc1
  buffer_load_dwordx4 a[148:151], v2, s[8:11], s22 offen offset:1024 sc1
  buffer_load_dwordx4 a[152:155], v2, s[8:11], s22 offen offset:2048 sc1
  buffer_load_dwordx4 a[156:159], v2, s[8:11], s22 offen offset:3072 sc1
  s_add_u32 s22, s21, 40960
  s_waitcnt vmcnt(40)
  buffer_load_dwordx4 a[160:163], v2, s[8:11], s22 offen offset:0 sc1
  buffer_load_dwordx4 a[164:167], v2, s[8:11], s22 offen offset:1024 sc1
  buffer_load_dwordx4 a[168:171], v2, s[8:11], s22 offen offset:2048 sc1
  buffer_load_dwordx4 a[172:175], v2, s[8:11], s22 offen offset:3072 sc1
  s_add_u32 s22, s21, 45056
  buffer_load_dwordx4 a[176:179], v2, s[8:11], s22 offen offset:0 sc1
  buffer_load_dwordx4 a[180:183], v2, s[8:11], s22 offen offset:1024 sc1
  buffer_load_dwordx4 a[184:187], v2, s[8:11], s22 offen offset:2048 sc1
  buffer_load_dwordx4 a[188:191], v2, s[8:11], s22 offen offset:3072 sc1
  s_add_u32 s22, s21, 49152
  buffer_load_dwordx4 a[192:195], v2, s[8:11], s22 offen offset:0 sc1
  buffer_load_dwordx4 a[196:199], v2, s[8:11], s22 offen offset:1024 sc1
  buffer_load_dwordx4 a[200:203], v2, s[8:11], s22 offen offset:2048 sc1
  buffer_load_dwordx4 a[204:207], v2, s[8:11], s22 offen offset:3072 sc1
  s_add_u32 s22, s21, 53248
  buffer_load_dwordx4 a[208:211], v2, s[8:11], s22 offen offset:0 sc1
  buffer_load_dwordx4 a[212:215], v2, s[8:11], s22 offen offset:1024 sc1
  buffer_load_dwordx4 a[216:219], v2, s[8:11], s22 offen offset:2048 sc1
  buffer_load_dwordx4 a[220:223], v2, s[8:11], s22 offen offset:3072 sc1
  s_mov_b32 s39, 0xffff0000
  s_branch wp_all
wp_bad:
  s_and_b32 s39, s39, 0xffff0000
  s_mov_b32 s97, 1
  s_cmp_eq_u32 s34, 1
  s_cbranch_scc1 wp_rep
  s_cmp_eq_u32 s34, 3
  s_cbranch_scc1 cA_abort
  s_load_dwordx8 s[40:47], s[0:1], 72
  s_load_dwordx4 s[48:51], s[0:1], 56
  s_waitcnt lgkmcnt(0)
  v_mov_b32 v4, 0x10001
  s_mov_b32 s18, 1
  s_branch ch_take
wp_rep:
  s_mov_b32 s101, -1
  s_load_dwordx8 s[40:47], s[0:1], 72
  s_load_dwordx4 s[48:51], s[0:1], 56
  s_waitcnt vmcnt(0) lgkmcnt(0)
  v_mov_b32 v4, 1
  v_mov_b32 v5, 20
  v_mov_b32 v6, 160000
  s_barrier
  s_cmp_lg_u32 s16, 0
  s_cbranch_scc1 wp_el1
  s_mov_b64 exec, 1
  buffer_atomic_add v4, v5, s[12:15], 0 offen sc0
  s_waitcnt vmcnt(0)
  ds_write_b32 v6, v4
  s_waitcnt lgkmcnt(0)
  s_mov_b64 exec, -1
wp_el1:
  s_barrier
  ds_read_b32 v4, v6
  s_waitcnt lgkmcnt(0)
  v_readfirstlane_b32 s33, v4
  v_and_b32 v1, 63, v0
  v_lshlrev_b32 v2, 4, v1
  v_lshrrev_b32 v3, 4, v1
  v_and_b32 v4, 15, v1
  v_lshrrev_b32 v5, 5, v1
  v_and_b32 v6, 31, v1
  v_xor_b32 v8, v6, v5
  v_lshlrev_b32 v8, 4, v8
  v_lshl_add_u32 v16, v5, 13, v8
  v_xor_b32 v17, 32, v16
  v_xor_b32 v18, 64, v16
  v_xor_b32 v19, 96, v16
  v_xor_b32 v20, 128, v16
  v_xor_b32 v21, 160, v16
  v_xor_b32 v22, 192, v16
  v_xor_b32 v23, 224, v16
  s_lshl_b32 s20, s16, 6
  v_xor_b32 v26, s20, v16
  v_xor_b32 v27, 32, v26
  s_and_b32 s33, s33, 511
  s_and_b32 s20, s33, 255
  s_cmp_ge_u32 s20, 224
  s_cselect_b32 s97, 1, 2
  s_cbranch_scc1 wp_all
  s_mul_i32 s17, s20, 4682
  s_lshr_b32 s17, s17, 16
  s_mul_i32 s23, s17, 14
  s_sub_u32 s19, s20, s23
  s_cmp_lt_u32 s19, 7
  s_cselect_b32 s18, 0, 7
  s_cselect_b32 s28, 0, 8
  s_sub_u32 s18, s19, s18
  s_add_u32 s28, s28, s16
  s_lshl_b32 s25, s16, 15
  s_add_u32 s25, s25, 32768
  s_lshl_b32 s26, s17, 9
  s_lshl_b32 s20, s17, 7
  s_lshr_b32 s21, s33, 8
  s_lshl_b32 s21, s21, 11
  s_add_u32 s20, s20, s21
  s_add_u32 s20, s20, 88519168
  buffer_load_dword v5, off, s[8:11], s20 sc1
  s_waitcnt vmcnt(0)
  v_readfirstlane_b32 s34, v5
  v_mov_b32 v6, 160032
  s_nop 0
  v_mov_b32 v7, s34
  s_barrier
  s_cmp_lg_u32 s16, 0
  s_cbranch_scc1 uni_9
  ds_write_b32 v6, v7
  s_waitcnt lgkmcnt(0)
uni_9:
  s_barrier
  ds_read_b32 v7, v6
  s_waitcnt lgkmcnt(0)
  v_readfirstlane_b32 s34, v7
  s_cmp_lt_u32 s33, 256
  s_cselect_b32 s20, 0, 1935
  s_or_b32 s34, s34, s20
  s_bitcmp1_b32 s34, s19
  s_cbranch_scc1 wp_rep
  s_barrier
  s_cmp_lt_u32 s33, 256
  s_cbranch_scc1 wp_B
  s_branch wp_A0
wp_done:
  s_mov_b32 s97, s39
  s_cmp_lg_u32 s96, 0
  s_cbranch_scc1 wk_next
  s_cmp_lg_u32 s16, 0
  s_cbranch_scc1 ask_10
  v_mov_b32 v250, 1
  v_mov_b32 v251, 88525312
  s_mov_b64 exec, 1
  buffer_atomic_add v250, v251, s[8:11], 0 offen sc0
  s_mov_b64 exec, -1
ask_10:
  s_branch wk_next
wk_loop:
  s_waitcnt vmcnt(0) lgkmcnt(0)
wk_ask:
  v_readfirstlane_b32 s22, v250
  s_cmp_ge_u32 s22, 1264
  s_cbranch_scc1 wk_next
  s_cmp_lg_u32 s16, 0
  s_cbranch_scc1 ask_11
  v_mov_b32 v250, 1
  v_mov_b32 v251, 88525312
  s_mov_b64 exec, 1
  buffer_atomic_add v250, v251, s[8:11], 0 offen sc0
  s_mov_b64 exec, -1
ask_11:
wk_next:
  v_mov_b32 v6, 160000
  s_waitcnt vmcnt(0)
  s_barrier
  s_cmp_lg_u32 s16, 0
  s_cbranch_scc1 wk_n1
  s_mov_b64 exec, 1
  ds_write_b32 v6, v250
  s_mov_b64 exec, -1
  s_waitcnt lgkmcnt(0)
wk_n1:
  s_barrier
  ds_read_b32 v4, v6
  s_waitcnt lgkmcnt(0)
  v_readfirstlane_b32 s3, v4
  s_cmp_ge_u32 s3, 1264
  s_cbranch_scc1 wk_done
  v_mov_b32 v250, 0
  v_mov_b32 v251, 88525312
  v_and_b32 v1, 63, v0
  v_lshlrev_b32 v2, 4, v1
  v_lshrrev_b32 v3, 4, v1
  v_and_b32 v4, 15, v1
  s_cmp_lt_u32 s3, 112
  s_cbranch_scc1 wk_n2
  s_cmp_eq_u32 s97, 0
  s_cbranch_scc1 wk_n2
  v_mov_b32 v250, s3
  s_mov_b32 s96, 1
  s_mov_b32 s97, 1
  s_mov_b32 s39, 0
  s_mov_b32 s37, 0
  s_mov_b32 s38, 0
  s_mov_b32 s32, 0
  s_branch wp_all
wk_n2:
  s_cmp_ge_u32 s3, 752
  s_cbranch_scc1 wk_tok
  s_cmp_ge_u32 s3, 640
  s_cbranch_scc1 wk_s4d
  s_cmp_ge_u32 s3, 448
  s_cbranch_scc1 wk_full
  s_cmp_ge_u32 s3, 320
  s_cbranch_scc1 wk_adef
  s_cmp_ge_u32 s3, 288
  s_cbranch_scc1 wk_srv
  s_and_b32 s17, s3, 15
  s_add_u32 s17, s17, 16
  s_cmp_ge_u32 s3, 224
  s_cbranch_scc1 wk_half
  s_cmp_ge_u32 s3, 112
  s_cselect_b32 s18, 1, 0
  s_cselect_b32 s20, 112, 0
  s_sub_u32 s34, s3, s20
  s_lshr_b32 s34, s34, 4
  s_lshl_b32 s34, s34, 1
  s_add_u32 s35, s34, 2
  s_branch wk_gemm
wk_adef:
  s_mov_b32 s101, -1
  s_load_dwordx8 s[40:47], s[0:1], 72
  s_sub_u32 s20, s3, 320
  s_lshr_b32 s33, s20, 2
  s_mul_i32 s33, s33, 7
  s_and_b32 s20, s20, 3
  s_add_u32 s33, s33, s20
  s_mov_b32 s97, 3
  v_mov_b32 v252, 0x40000000
  v_cmp_eq_u32 vcc, 0, v0
  s_nop 1
  v_cndmask_b32 v252, v252, v0, vcc
  v_lshrrev_b32 v5, 5, v1
  v_and_b32 v6, 31, v1
  v_xor_b32 v8, v6, v5
  v_lshlrev_b32 v8, 4, v8
  v_lshl_add_u32 v16, v5, 13, v8
  v_xor_b32 v17, 32, v16
  v_xor_b32 v18, 64, v16
  v_xor_b32 v19, 96, v16
  v_xor_b32 v20, 128, v16
  v_xor_b32 v21, 160, v16
  v_xor_b32 v22, 192, v16
  v_xor_b32 v23, 224, v16
  s_lshl_b32 s20, s16, 6
  v_xor_b32 v26, s20, v16
  v_xor_b32 v27, 32, v26
  s_mul_i32 s17, s33, 4682
  s_lshr_b32 s17, s17, 16
  s_mul_i32 s23, s17, 14
  s_sub_u32 s19, s33, s23
  s_cmp_lt_u32 s19, 7
  s_cselect_b32 s18, 0, 7
  s_cselect_b32 s28, 0, 8
  s_sub_u32 s18, s19, s18
  s_add_u32 s28, s28, s16
  s_lshl_b32 s25, s16, 15
  s_add_u32 s25, s25, 32768
  s_lshl_b32 s26, s17, 9
  s_waitcnt lgkmcnt(0)
  s_barrier
  s_branch wp_A0
wk_adone:
  s_mov_b32 s97, 0
  s_branch wk_loop
wk_half:
  s_sub_u32 s20, s3, 224
  s_lshr_b32 s18, s20, 5
  s_add_u32 s18, s18, 2
  s_bitcmp1_b32 s20, 4
  s_cselect_b32 s34, 7, 0
  s_add_u32 s35, s34, 7
  s_branch wk_gemm
wk_full:
  s_sub_u32 s20, s3, 384
  s_and_b32 s17, s20, 15
  s_lshr_b32 s18, s20, 4
  s_mov_b32 s34, 0
  s_mov_b32 s35, 14
  s_cmp_lt_u32 s18, 8
  s_cselect_b32 s21, 16, 0
  s_add_u32 s17, s17, s21
  s_and_b32 s18, s18, 7
  s_cmp_ge_u32 s17, 16
  s_cbranch_scc1 wk_gemm
  s_lshl_b32 s27, s17, 7
  s_add_u32 s27, s27, 88521216
  s_mov_b32 s28, 16383
  s_mov_b32 s30, 0
wk_aw:
  buffer_load_dword v9, off, s[8:11], s27  sc1
  s_waitcnt vmcnt(0)
  v_and_b32 v10, s28, v9
  v_cmp_ne_u32 vcc, s28, v10
  s_cbranch_vccz wk_aw_ok
  s_sleep 3
  s_add_u32 s30, s30, 1
  s_cmp_lt_u32 s30, 400000
  s_cbranch_scc1 wk_aw
  s_branch cA_abort
wk_aw_ok:
wk_gemm:
  s_lshl_b32 s20, s18, 4
  s_lshr_b32 s21, s2, 3
  s_add_u32 s21, s21, s16
  s_and_b32 s21, s21, 3
  s_lshl_b32 s21, s21, 2
  s_add_u32 s20, s20, s21
  s_mul_i32 s21, s20, 14336
  s_add_u32 s21, s21, 72024064
  s_mul_i32 s23, s17, 401408
  s_and_b32 s22, s16, 1
  s_mul_i32 s22, s22, 7168
  s_add_u32 s23, s23, s22
  s_add_u32 s23, s23, 0
  s_lshr_b32 s22, s16, 1
  s_mul_i32 s22, s22, 14336
  s_add_u32 s23, s23, s22
  s_mul_i32 s27, s16, 7168
  s_lshr_b32 s28, s20, 1
  s_cmp_lt_u32 s17, 16
  s_cbranch_scc0 wg_vo
  s_add_u32 s23, s23, s22
  s_lshl_b32 s29, s28, 4
  s_add_u32 s29, s29, s17
  s_mul_i32 s29, s29, 28672
  s_add_u32 s29, s29, 12845056
  s_mov_b32 s31, 0
  s_lshr_b32 s24, s34, 1
  s_lshl_b32 s24, s24, 2
  s_and_b32 s25, s34, 1
  s_add_u32 s24, s24, s25
  s_mul_i32 s24, s24, 14336
  s_add_u32 s24, s24, s23
  s_add_u32 m0, s31, s27
  s_nop 0
  buffer_load_dwordx4 v2, s[8:11], s24 offen offset:0 sc1 lds
  buffer_load_dwordx4 v2, s[8:11], s24 offen offset:1024 sc1 lds
  buffer_load_dwordx4 v2, s[8:11], s24 offen offset:2048 sc1 lds
  buffer_load_dwordx4 v2, s[8:11], s24 offen offset:3072 sc1 lds
  s_add_u32 m0, m0, 4096
  s_add_u32 s24, s24, 4096
  buffer_load_dwordx4 v2, s[8:11], s24 offen offset:0 sc1 lds
  buffer_load_dwordx4 v2, s[8:11], s24 offen offset:1024 sc1 lds
  buffer_load_dwordx4 v2, s[8:11], s24 offen offset:2048 sc1 lds
  s_sub_u32 s36, s35, 1
  s_add_u32 s30, s34, 1
  s_min_u32 s30, s30, s36
  s_mov_b32 s31, 28672
  s_lshr_b32 s24, s30, 1
  s_lshl_b32 s24, s24, 2
  s_and_b32 s25, s30, 1
  s_add_u32 s24, s24, s25
  s_mul_i32 s24, s24, 14336
  s_add_u32 s24, s24, s23
  s_add_u32 m0, s31, s27
  s_nop 0
  buffer_load_dwordx4 v2, s[8:11], s24 offen offset:0 sc1 lds
  buffer_load_dwordx4 v2, s[8:11], s24 offen offset:1024 sc1 lds
  buffer_load_dwordx4 v2, s[8:11], s24 offen offset:2048 sc1 lds
  buffer_load_dwordx4 v2, s[8:11], s24 offen offset:3072 sc1 lds
  s_add_u32 m0, m0, 4096
  s_add_u32 s24, s24, 4096
  buffer_load_dwordx4 v2, s[8:11], s24 offen offset:0 sc1 lds
  buffer_load_dwordx4 v2, s[8:11], s24 offen offset:1024 sc1 lds
  buffer_load_dwordx4 v2, s[8:11], s24 offen offset:2048 sc1 lds
  s_mov_b32 s19, s34
  s_mov_b32 s32, 0
  s_mov_b32 s33, 57344
  s_cmp_eq_u32 s18, s101
  s_cbranch_scc1 wg_f_hx
  s_add_u32 s22, s21, 0
  buffer_load_dwordx4 a[0:3], v2, s[8:11], s22 offen offset:0 sc1
  buffer_load_dwordx4 a[4:7], v2, s[8:11], s22 offen offset:1024 sc1
  buffer_load_dwordx4 a[8:11], v2, s[8:11], s22 offen offset:2048 sc1
  buffer_load_dwordx4 a[12:15], v2, s[8:11], s22 offen offset:3072 sc1
  s_add_u32 s22, s21, 4096
  buffer_load_dwordx4 a[16:19], v2, s[8:11], s22 offen offset:0 sc1
  buffer_load_dwordx4 a[20:23], v2, s[8:11], s22 offen offset:1024 sc1
  buffer_load_dwordx4 a[24:27], v2, s[8:11], s22 offen offset:2048 sc1
  buffer_load_dwordx4 a[28:31], v2, s[8:11], s22 offen offset:3072 sc1
  s_add_u32 s22, s21, 8192
  buffer_load_dwordx4 a[32:35], v2, s[8:11], s22 offen offset:0 sc1
  buffer_load_dwordx4 a[36:39], v2, s[8:11], s22 offen offset:1024 sc1
  buffer_load_dwordx4 a[40:43], v2, s[8:11], s22 offen offset:2048 sc1
  buffer_load_dwordx4 a[44:47], v2, s[8:11], s22 offen offset:3072 sc1
  s_add_u32 s22, s21, 12288
  buffer_load_dwordx4 a[48:51], v2, s[8:11], s22 offen offset:0 sc1
  buffer_load_dwordx4 a[52:55], v2, s[8:11], s22 offen offset:1024 sc1
  buffer_load_dwordx4 a[56:59], v2, s[8:11], s22 offen offset:2048 sc1
  buffer_load_dwordx4 a[60:63], v2, s[8:11], s22 offen offset:3072 sc1
  s_add_u32 s22, s21, 16384
  buffer_load_dwordx4 a[64:67], v2, s[8:11], s22 offen offset:0 sc1
  buffer_load_dwordx4 a[68:71], v2, s[8:11], s22 offen offset:1024 sc1
  buffer_load_dwordx4 a[72:75], v2, s[8:11], s22 offen offset:2048 sc1
  buffer_load_dwordx4 a[76:79], v2, s[8:11], s22 offen offset:3072 sc1
  s_add_u32 s22, s21, 20480
  buffer_load_dwordx4 a[80:83], v2, s[8:11], s22 offen offset:0 sc1
  buffer_load_dwordx4 a[84:87], v2, s[8:11], s22 offen offset:1024 sc1
  buffer_load_dwordx4 a[88:91], v2, s[8:11], s22 offen offset:2048 sc1
  buffer_load_dwordx4 a[92:95], v2, s[8:11], s22 offen offset:3072 sc1
  s_add_u32 s22, s21, 24576
  buffer_load_dwordx4 a[96:99], v2, s[8:11], s22 offen offset:0 sc1
  buffer_load_dwordx4 a[100:103], v2, s[8:11], s22 offen offset:1024 sc1
  buffer_load_dwordx4 a[104:107], v2, s[8:11], s22 offen offset:2048 sc1
  buffer_load_dwordx4 a[108:111], v2, s[8:11], s22 offen offset:3072 sc1
  s_add_u32 s22, s21, 28672
  buffer_load_dwordx4 a[112:115], v2, s[8:11], s22 offen offset:0 sc1
  buffer_load_dwordx4 a[116:119], v2, s[8:11], s22 offen offset:1024 sc1
  buffer_load_dwordx4 a[120:123], v2, s[8:11], s22 offen offset:2048 sc1
  buffer_load_dwordx4 a[124:127], v2, s[8:11], s22 offen offset:3072 sc1
  s_add_u32 s22, s21, 32768
  buffer_load_dwordx4 a[128:131], v2, s[8:11], s22 offen offset:0 sc1
  buffer_load_dwordx4 a[132:135], v2, s[8:11], s22 offen offset:1024 sc1
  buffer_load_dwordx4 a[136:139], v2, s[8:11], s22 offen offset:2048 sc1
  buffer_load_dwordx4 a[140:143], v2, s[8:11], s22 offen offset:3072 sc1
  s_add_u32 s22, s21, 36864
  buffer_load_dwordx4 a[144:147], v2, s[8:11], s22 offen offset:0 sc1
  buffer_load_dwordx4 a[148:151], v2, s[8:11], s22 offen offset:1024 sc1
  buffer_load_dwordx4 a[152:155], v2, s[8:11], s22 offen offset:2048 sc1
  buffer_load_dwordx4 a[156:159], v2, s[8:11], s22 offen offset:3072 sc1
  s_add_u32 s22, s21, 40960
  s_waitcnt vmcnt(40)
  buffer_load_dwordx4 a[160:163], v2, s[8:11], s22 offen offset:0 sc1
  buffer_load_dwordx4 a[164:167], v2, s[8:11], s22 offen offset:1024 sc1
  buffer_load_dwordx4 a[168:171], v2, s[8:11], s22 offen offset:2048 sc1
  buffer_load_dwordx4 a[172:175], v2, s[8:11], s22 offen offset:3072 sc1
  s_add_u32 s22, s21, 45056
  buffer_load_dwordx4 a[176:179], v2, s[8:11], s22 offen offset:0 sc1
  buffer_load_dwordx4 a[180:183], v2, s[8:11], s22 offen offset:1024 sc1
  buffer_load_dwordx4 a[184:187], v2, s[8:11], s22 offen offset:2048 sc1
  buffer_load_dwordx4 a[188:191], v2, s[8:11], s22 offen offset:3072 sc1
  s_add_u32 s22, s21, 49152
  buffer_load_dwordx4 a[192:195], v2, s[8:11], s22 offen offset:0 sc1
  buffer_load_dwordx4 a[196:199], v2, s[8:11], s22 offen offset:1024 sc1
  buffer_load_dwordx4 a[200:203], v2, s[8:11], s22 offen offset:2048 sc1
  buffer_load_dwordx4 a[204:207], v2, s[8:11], s22 offen offset:3072 sc1
  s_add_u32 s22, s21, 53248
  buffer_load_dwordx4 a[208:211], v2, s[8:11], s22 offen offset:0 sc1
  buffer_load_dwordx4 a[212:215], v2, s[8:11], s22 offen offset:1024 sc1
  buffer_load_dwordx4 a[216:219], v2, s[8:11], s22 offen offset:2048 sc1
  buffer_load_dwordx4 a[220:223], v2, s[8:11], s22 offen offset:3072 sc1
wg_f_hx:
  s_mov_b32 s101, -1
  s_waitcnt vmcnt(0)
  s_branch wg_f_in
wg_f_loop:
  s_waitcnt vmcnt(11)
wg_f_in:
  s_barrier
  s_add_u32 s30, s19, 2
  s_min_u32 s30, s30, s36
  s_lshr_b32 s24, s30, 1
  s_lshl_b32 s24, s24, 2
  s_and_b32 s25, s30, 1
  s_add_u32 s24, s24, s25
  s_mul_i32 s24, s24, 14336
  s_add_u32 s24, s24, s23
  s_add_u32 m0, s33, s27
  s_nop 0
  buffer_load_dwordx4 v2, s[8:11], s24 offen offset:0 sc1 lds
  buffer_load_dwordx4 v2, s[8:11], s24 offen offset:1024 sc1 lds
  buffer_load_dwordx4 v2, s[8:11], s24 offen offset:2048 sc1 lds
  buffer_load_dwordx4 v2, s[8:11], s24 offen offset:3072 sc1 lds
  s_add_u32 m0, m0, 4096
  s_add_u32 s24, s24, 4096
  buffer_load_dwordx4 v2, s[8:11], s24 offen offset:0 sc1 lds
  buffer_load_dwordx4 v2, s[8:11], s24 offen offset:1024 sc1 lds
  buffer_load_dwordx4 v2, s[8:11], s24 offen offset:2048 sc1 lds
  v_add_u32 v5, s32, v2
  ds_read_b128 v[8:11], v5 offset:0
  ds_read_b128 v[12:15], v5 offset:14336
  ds_read_b128 v[16:19], v5 offset:1024
  ds_read_b128 v[20:23], v5 offset:15360
  ds_read_b128 v[24:27], v5 offset:2048
  ds_read_b128 v[28:31], v5 offset:16384
  ds_read_b128 v[32:35], v5 offset:3072
  s_waitcnt lgkmcnt(6)
  v_mfma_f32_16x16x32_bf16 v[40:43], v[8:11], a[0:3], 0
  v_mfma_f32_16x16x32_bf16 v[44:47], v[8:11], a[56:59], 0
  v_mfma_f32_16x16x32_bf16 v[48:51], v[8:11], a[112:115], 0
  v_mfma_f32_16x16x32_bf16 v[52:55], v[8:11], a[168:171], 0
  ds_read_b128 v[36:39], v5 offset:17408
  s_waitcnt lgkmcnt(6)
  v_mfma_f32_16x16x32_bf16 v[56:59], v[12:15], a[0:3], 0
  v_mfma_f32_16x16x32_bf16 v[60:63], v[12:15], a[56:59], 0
  v_mfma_f32_16x16x32_bf16 v[64:67], v[12:15], a[112:115], 0
  v_mfma_f32_16x16x32_bf16 v[68:71], v[12:15], a[168:171], 0
  ds_read_b128 v[8:11], v5 offset:4096
  s_waitcnt lgkmcnt(6)
  v_mfma_f32_16x16x32_bf16 v[40:43], v[16:19], a[4:7], v[40:43]
  v_mfma_f32_16x16x32_bf16 v[44:47], v[16:19], a[60:63], v[44:47]
  v_mfma_f32_16x16x32_bf16 v[48:51], v[16:19], a[116:119], v[48:51]
  v_mfma_f32_16x16x32_bf16 v[52:55], v[16:19], a[172:175], v[52:55]
  ds_read_b128 v[12:15], v5 offset:18432
  s_waitcnt lgkmcnt(6)
  v_mfma_f32_16x16x32_bf16 v[56:59], v[20:23], a[4:7], v[56:59]
  v_mfma_f32_16x16x32_bf16 v[60:63], v[20:23], a[60:63], v[60:63]
  v_mfma_f32_16x16x32_bf16 v[64:67], v[20:23], a[116:119], v[64:67]
  v_mfma_f32_16x16x32_bf16 v[68:71], v[20:23], a[172:175], v[68:71]
  ds_read_b128 v[16:19], v5 offset:5120
  s_waitcnt lgkmcnt(6)
  v_mfma_f32_16x16x32_bf16 v[40:43], v[24:27], a[8:11], v[40:43]
  v_mfma_f32_16x16x32_bf16 v[44:47], v[24:27], a[64:67], v[44:47]
  v_mfma_f32_16x16x32_bf16 v[48:51], v[24:27], a[120:123], v[48:51]
  v_mfma_f32_16x16x32_bf16 v[52:55], v[24:27], a[176:179], v[52:55]
  ds_read_b128 v[20:23], v5 offset:19456
  s_waitcnt lgkmcnt(6)
  v_mfma_f32_16x16x32_bf16 v[56:59], v[28:31], a[8:11], v[56:59]
  v_mfma_f32_16x16x32_bf16 v[60:63], v[28:31], a[64:67], v[60:63]
  v_mfma_f32_16x16x32_bf16 v[64:67], v[28:31], a[120:123], v[64:67]
  v_mfma_f32_16x16x32_bf16 v[68:71], v[28:31], a[176:179], v[68:71]
  ds_read_b128 v[24:27], v5 offset:6144
  s_waitcnt lgkmcnt(6)
  v_mfma_f32_16x16x32_bf16 v[40:43], v[32:35], a[12:15], v[40:43]
  v_mfma_f32_16x16x32_bf16 v[44:47], v[32:35], a[68:71], v[44:47]
  v_mfma_f32_16x16x32_bf16 v[48:51], v[32:35], a[124:127], v[48:51]
  v_mfma_f32_16x16x32_bf16 v[52:55], v[32:35], a[180:183], v[52:55]
  ds_read_b128 v[28:31], v5 offset:20480
  s_waitcnt lgkmcnt(6)
  v_mfma_f32_16x16x32_bf16 v[56:59], v[36:39], a[12:15], v[56:59]
  v_mfma_f32_16x16x32_bf16 v[60:63], v[36:39], a[68:71], v[60:63]
  v_mfma_f32_16x16x32_bf16 v[64:67], v[36:39], a[124:127], v[64:67]
  v_mfma_f32_16x16x32_bf16 v[68:71], v[36:39], a[180:183], v[68:71]
  ds_read_b128 v[32:35], v5 offset:7168
  s_waitcnt lgkmcnt(6)
  v_mfma_f32_16x16x32_bf16 v[40:43], v[8:11], a[16:19], v[40:43]
  v_mfma_f32_16x16x32_bf16 v[44:47], v[8:11], a[72:75], v[44:47]
  v_mfma_f32_16x16x32_bf16 v[48:51], v[8:11], a[128:131], v[48:51]
  v_mfma_f32_16x16x32_bf16 v[52:55], v[8:11], a[184:187], v[52:55]
  ds_read_b128 v[36:39], v5 offset:21504
  s_waitcnt lgkmcnt(6)
  v_mfma_f32_16x16x32_bf16 v[56:59], v[12:15], a[16:19], v[56:59]
  v_mfma_f32_16x16x32_bf16 v[60:63], v[12:15], a[72:75], v[60:63]
  v_mfma_f32_16x16x32_bf16 v[64:67], v[12:15], a[128:131], v[64:67]
  v_mfma_f32_16x16x32_bf16 v[68:71], v[12:15], a[184:187], v[68:71]
  ds_read_b128 v[8:11], v5 offset:8192
  s_waitcnt lgkmcnt(6)
  v_mfma_f32_16x16x32_bf16 v[40:43], v[16:19], a[20:23], v[40:43]
  v_mfma_f32_16x16x32_bf16 v[44:47], v[16:19], a[76:79], v[44:47]
  v_mfma_f32_16x16x32_bf16 v[48:51], v[16:19], a[132:135], v[48:51]
  v_mfma_f32_16x16x32_bf16 v[52:55], v[16:19], a[188:191], v[52:55]
  ds_read_b128 v[12:15], v5 offset:22528
  s_waitcnt lgkmcnt(6)
  v_mfma_f32_16x16x32_bf16 v[56:59], v[20:23], a[20:23], v[56:59]
  v_mfma_f32_16x16x32_bf16 v[60:63], v[20:23], a[76:79], v[60:63]
  v_mfma_f32_16x16x32_bf16 v[64:67], v[20:23], a[132:135], v[64:67]
  v_mfma_f32_16x16x32_bf16 v[68:71], v[20:23], a[188:191], v[68:71]
  ds_read_b128 v[16:19], v5 offset:9216
  s_waitcnt lgkmcnt(6)
  v_mfma_f32_16x16x32_bf16 v[40:43], v[24:27], a[24:27], v[40:43]
  v_mfma_f32_16x16x32_bf16 v[44:47], v[24:27], a[80:83], v[44:47]
  v_mfma_f32_16x16x32_bf16 v[48:51], v[24:27], a[136:139], v[48:51]
  v_mfma_f32_16x16x32_bf16 v[52:55], v[24:27], a[192:195], v[52:55]
  ds_read_b128 v[20:23], v5 offset:23552
  s_waitcnt lgkmcnt(6)
  v_mfma_f32_16x16x32_bf16 v[56:59], v[28:31], a[24:27], v[56:59]
  v_mfma_f32_16x16x32_bf16 v[60:63], v[28:31], a[80:83], v[60:63]
  v_mfma_f32_16x16x32_bf16 v[64:67], v[28:31], a[136:139], v[64:67]
  v_mfma_f32_16x16x32_bf16 v[68:71], v[28:31], a[192:195], v[68:71]
  ds_read_b128 v[24:27], v5 offset:10240
  s_waitcnt lgkmcnt(6)
  v_mfma_f32_16x16x32_bf16 v[40:43], v[32:35], a[28:31], v[40:43]
  v_mfma_f32_16x16x32_bf16 v[44:47], v[32:35], a[84:87], v[44:47]
  v_mfma_f32_16x16x32_bf16 v[48:51], v[32:35], a[140:143], v[48:51]
  v_mfma_f32_16x16x32_bf16 v[52:55], v[32:35], a[196:199], v[52:55]
  ds_read_b128 v[28:31], v5 offset:24576
  s_waitcnt lgkmcnt(6)
  v_mfma_f32_16x16x32_bf16 v[56:59], v[36:39], a[28:31], v[56:59]
  v_mfma_f32_16x16x32_bf16 v[60:63], v[36:39], a[84:87], v[60:63]
  v_mfma_f32_16x16x32_bf16 v[64:67], v[36:39], a[140:143], v[64:67]
  v_mfma_f32_16x16x32_bf16 v[68:71], v[36:39], a[196:199], v[68:71]
  ds_read_b128 v[32:35], v5 offset:11264
  s_waitcnt lgkmcnt(6)
  v_mfma_f32_16x16x32_bf16 v[40:43], v[8:11], a[32:35], v[40:43]
  v_mfma_f32_16x16x32_bf16 v[44:47], v[8:11], a[88:91], v[44:47]
  v_mfma_f32_16x16x32_bf16 v[48:51], v[8:11], a[144:147], v[48:51]
  v_mfma_f32_16x16x32_bf16 v[52:55], v[8:11], a[200:203], v[52:55]
  ds_read_b128 v[36:39], v5 offset:25600
  s_waitcnt lgkmcnt(6)
  v_mfma_f32_16x16x32_bf16 v[56:59], v[12:15], a[32:35], v[56:59]
  v_mfma_f32_16x16x32_bf16 v[60:63], v[12:15], a[88:91], v[60:63]
  v_mfma_f32_16x16x32_bf16 v[64:67], v[12:15], a[144:147], v[64:67]
  v_mfma_f32_16x16x32_bf16 v[68:71], v[12:15], a[200:203], v[68:71]
  ds_read_b128 v[8:11], v5 offset:12288
  s_waitcnt lgkmcnt(6)
  v_mfma_f32_16x16x32_bf16 v[40:43], v[16:19], a[36:39], v[40:43]
  v_mfma_f32_16x16x32_bf16 v[44:47], v[16:19], a[92:95], v[44:47]
  v_mfma_f32_16x16x32_bf16 v[48:51], v[16:19], a[148:151], v[48:51]
  v_mfma_f32_16x16x32_bf16 v[52:55], v[16:19], a[204:207], v[52:55]
  ds_read_b128 v[12:15], v5 offset:26624
  s_waitcnt lgkmcnt(6)
  v_mfma_f32_16x16x32_bf16 v[56:59], v[20:23], a[36:39], v[56:59]
  v_mfma_f32_16x16x32_bf16 v[60:63], v[20:23], a[92:95], v[60:63]
  v_mfma_f32_16x16x32_bf16 v[64:67], v[20:23], a[148:151], v[64:67]
  v_mfma_f32_16x16x32_bf16 v[68:71], v[20:23], a[204:207], v[68:71]
  ds_read_b128 v[16:19], v5 offset:13312
  s_waitcnt lgkmcnt(6)
  v_mfma_f32_16x16x32_bf16 v[40:43], v[24:27], a[40:43], v[40:43]
  v_mfma_f32_16x16x32_bf16 v[44:47], v[24:27], a[96:99], v[44:47]
  v_mfma_f32_16x16x32_bf16 v[48:51], v[24:27], a[152:155], v[48:51]
  v_mfma_f32_16x16x32_bf16 v[52:55], v[24:27], a[208:211], v[52:55]
  ds_read_b128 v[20:23], v5 offset:27648
  s_waitcnt lgkmcnt(6)
  v_mfma_f32_16x16x32_bf16 v[56:59], v[28:31], a[40:43], v[56:59]
  v_mfma_f32_16x16x32_bf16 v[60:63], v[28:31], a[96:99], v[60:63]
  v_mfma_f32_16x16x32_bf16 v[64:67], v[28:31], a[152:155], v[64:67]
  v_mfma_f32_16x16x32_bf16 v[68:71], v[28:31], a[208:211], v[68:71]
  s_waitcnt lgkmcnt(5)
  v_mfma_f32_16x16x32_bf16 v[40:43], v[32:35], a[44:47], v[40:43]
  v_mfma_f32_16x16x32_bf16 v[44:47], v[32:35], a[100:103], v[44:47]
  v_mfma_f32_16x16x32_bf16 v[48:51], v[32:35], a[156:159], v[48:51]
  v_mfma_f32_16x16x32_bf16 v[52:55], v[32:35], a[212:215], v[52:55]
  s_waitcnt lgkmcnt(4)
  v_mfma_f32_16x16x32_bf16 v[56:59], v[36:39], a[44:47], v[56:59]
  v_mfma_f32_16x16x32_bf16 v[60:63], v[36:39], a[100:103], v[60:63]
  v_mfma_f32_16x16x32_bf16 v[64:67], v[36:39], a[156:159], v[64:67]
  v_mfma_f32_16x16x32_bf16 v[68:71], v[36:39], a[212:215], v[68:71]
  s_waitcnt lgkmcnt(3)
  v_mfma_f32_16x16x32_bf16 v[40:43], v[8:11], a[48:51], v[40:43]
  v_mfma_f32_16x16x32_bf16 v[44:47], v[8:11], a[104:107], v[44:47]
  v_mfma_f32_16x16x32_bf16 v[48:51], v[8:11], a[160:163], v[48:51]
  v_mfma_f32_16x16x32_bf16 v[52:55], v[8:11], a[216:219], v[52:55]
  s_waitcnt lgkmcnt(2)
  v_mfma_f32_16x16x32_bf16 v[56:59], v[12:15], a[48:51], v[56:59]
  v_mfma_f32_16x16x32_bf16 v[60:63], v[12:15], a[104:107], v[60:63]
  v_mfma_f32_16x16x32_bf16 v[64:67], v[12:15], a[160:163], v[64:67]
  v_mfma_f32_16x16x32_bf16 v[68:71], v[12:15], a[216:219], v[68:71]
  s_waitcnt lgkmcnt(1)
  v_mfma_f32_16x16x32_bf16 v[40:43], v[16:19], a[52:55], v[40:43]
  v_mfma_f32_16x16x32_bf16 v[44:47], v[16:19], a[108:111], v[44:47]
  v_mfma_f32_16x16x32_bf16 v[48:51], v[16:19], a[164:167], v[48:51]
  v_mfma_f32_16x16x32_bf16 v[52:55], v[16:19], a[220:223], v[52:55]
  s_waitcnt lgkmcnt(0)
  v_mfma_f32_16x16x32_bf16 v[56:59], v[20:23], a[52:55], v[56:59]
  v_mfma_f32_16x16x32_bf16 v[60:63], v[20:23], a[108:111], v[60:63]
  v_mfma_f32_16x16x32_bf16 v[64:67], v[20:23], a[164:167], v[64:67]
  v_mfma_f32_16x16x32_bf16 v[68:71], v[20:23], a[220:223], v[68:71]
  s_lshl_b32 s24, s19, 10
  s_add_u32 s24, s24, s29
  v_cvt_pk_bf16_f32 v72, v40, v41
  v_cvt_pk_bf16_f32 v73, v42, v43
  v_cvt_pk_bf16_f32 v74, v56, v57
  v_cvt_pk_bf16_f32 v75, v58, v59
  s_add_u32 s25, s24, 0
  buffer_store_dwordx4 v[72:75], v2, s[8:11], s25 offen sc1
  v_cvt_pk_bf16_f32 v76, v44, v45
  v_cvt_pk_bf16_f32 v77, v46, v47
  v_cvt_pk_bf16_f32 v78, v60, v61
  v_cvt_pk_bf16_f32 v79, v62, v63
  s_add_u32 s25, s24, 14336
  buffer_store_dwordx4 v[76:79], v2, s[8:11], s25 offen sc1
  v_cvt_pk_bf16_f32 v80, v48, v49
  v_cvt_pk_bf16_f32 v81, v50, v51
  v_cvt_pk_bf16_f32 v82, v64, v65
  v_cvt_pk_bf16_f32 v83, v66, v67
  s_add_u32 s25, s24, 458752
  buffer_store_dwordx4 v[80:83], v2, s[8:11], s25 offen sc1
  v_cvt_pk_bf16_f32 v84, v52, v53
  v_cvt_pk_bf16_f32 v85, v54, v55
  v_cvt_pk_bf16_f32 v86, v68, v69
  v_cvt_pk_bf16_f32 v87, v70, v71
  s_add_u32 s25, s24, 473088
  buffer_store_dwordx4 v[84:87], v2, s[8:11], s25 offen sc1
  s_mov_b32 s33, s32
  s_add_u32 s32, s32, 28672
  s_cmp_eq_u32 s32, 86016
  s_cselect_b32 s32, 0, s32
  s_add_u32 s19, s19, 1
  s_cmp_lt_u32 s19, s35
  s_cbranch_scc1 wg_f_loop
  s_branch wg_done
wg_vo:
  s_sub_u32 s29, s17, 16
  s_mul_i32 s29, s29, 28672
  s_mul_i32 s24, s28, 458752
  s_add_u32 s29, s29, s24
  s_add_u32 s29, s29, 42205184
  v_lshlrev_b32 v6, 4, v3
  v_mul_u32_u24 v7, 12, v3
  v_add_u32 v7, 48, v7
  s_mov_b32 s31, 0
  s_lshl_b32 s24, s34, 1
  s_mul_i32 s24, s24, 14336
  s_add_u32 s24, s24, s23
  s_add_u32 m0, s31, s27
  s_nop 0
  buffer_load_dwordx4 v2, s[8:11], s24 offen offset:0 sc1 lds
  buffer_load_dwordx4 v2, s[8:11], s24 offen offset:1024 sc1 lds
  buffer_load_dwordx4 v2, s[8:11], s24 offen offset:2048 sc1 lds
  buffer_load_dwordx4 v2, s[8:11], s24 offen offset:3072 sc1 lds
  s_add_u32 m0, m0, 4096
  s_add_u32 s24, s24, 4096
  buffer_load_dwordx4 v2, s[8:11], s24 offen offset:0 sc1 lds
  buffer_load_dwordx4 v2, s[8:11], s24 offen offset:1024 sc1 lds
  buffer_load_dwordx4 v2, s[8:11], s24 offen offset:2048 sc1 lds
  s_sub_u32 s36, s35, 1
  s_add_u32 s30, s34, 1
  s_min_u32 s30, s30, s36
  s_mov_b32 s31, 28672
  s_lshl_b32 s24, s30, 1
  s_mul_i32 s24, s24, 14336
  s_add_u32 s24, s24, s23
  s_add_u32 m0, s31, s27
  s_nop 0
  buffer_load_dwordx4 v2, s[8:11], s24 offen offset:0 sc1 lds
  buffer_load_dwordx4 v2, s[8:11], s24 offen offset:1024 sc1 lds
  buffer_load_dwordx4 v2, s[8:11], s24 offen offset:2048 sc1 lds
  buffer_load_dwordx4 v2, s[8:11], s24 offen offset:3072 sc1 lds
  s_add_u32 m0, m0, 4096
  s_add_u32 s24, s24, 4096
  buffer_load_dwordx4 v2, s[8:11], s24 offen offset:0 sc1 lds
  buffer_load_dwordx4 v2, s[8:11], s24 offen offset:1024 sc1 lds
  buffer_load_dwordx4 v2, s[8:11], s24 offen offset:2048 sc1 lds
  s_mov_b32 s19, s34
  s_mov_b32 s32, 0
  s_mov_b32 s33, 57344
  s_cmp_eq_u32 s18, s101
  s_cbranch_scc1 wg_vo_hx
  s_add_u32 s22, s21, 0
  buffer_load_dwordx4 a[0:3], v2, s[8:11], s22 offen offset:0 sc1
  buffer_load_dwordx4 a[4:7], v2, s[8:11], s22 offen offset:1024 sc1
  buffer_load_dwordx4 a[8:11], v2, s[8:11], s22 offen offset:2048 sc1
  buffer_load_dwordx4 a[12:15], v2, s[8:11], s22 offen offset:3072 sc1
  s_add_u32 s22, s21, 4096
  buffer_load_dwordx4 a[16:19], v2, s[8:11], s22 offen offset:0 sc1
  buffer_load_dwordx4 a[20:23], v2, s[8:11], s22 offen offset:1024 sc1
  buffer_load_dwordx4 a[24:27], v2, s[8:11], s22 offen offset:2048 sc1
  buffer_load_dwordx4 a[28:31], v2, s[8:11], s22 offen offset:3072 sc1
  s_add_u32 s22, s21, 8192
  buffer_load_dwordx4 a[32:35], v2, s[8:11], s22 offen offset:0 sc1
  buffer_load_dwordx4 a[36:39], v2, s[8:11], s22 offen offset:1024 sc1
  buffer_load_dwordx4 a[40:43], v2, s[8:11], s22 offen offset:2048 sc1
  buffer_load_dwordx4 a[44:47], v2, s[8:11], s22 offen offset:3072 sc1
  s_add_u32 s22, s21, 12288
  buffer_load_dwordx4 a[48:51], v2, s[8:11], s22 offen offset:0 sc1
  buffer_load_dwordx4 a[52:55], v2, s[8:11], s22 offen offset:1024 sc1
  buffer_load_dwordx4 a[56:59], v2, s[8:11], s22 offen offset:2048 sc1
  buffer_load_dwordx4 a[60:63], v2, s[8:11], s22 offen offset:3072 sc1
  s_add_u32 s22, s21, 16384
  buffer_load_dwordx4 a[64:67], v2, s[8:11], s22 offen offset:0 sc1
  buffer_load_dwordx4 a[68:71], v2, s[8:11], s22 offen offset:1024 sc1
  buffer_load_dwordx4 a[72:75], v2, s[8:11], s22 offen offset:2048 sc1
  buffer_load_dwordx4 a[76:79], v2, s[8:11], s22 offen offset:3072 sc1
  s_add_u32 s22, s21, 20480
  buffer_load_dwordx4 a[80:83], v2, s[8:11], s22 offen offset:0 sc1
  buffer_load_dwordx4 a[84:87], v2, s[8:11], s22 offen offset:1024 sc1
  buffer_load_dwordx4 a[88:91], v2, s[8:11], s22 offen offset:2048 sc1
  buffer_load_dwordx4 a[92:95], v2, s[8:11], s22 offen offset:3072 sc1
  s_add_u32 s22, s21, 24576
  buffer_load_dwordx4 a[96:99], v2, s[8:11], s22 offen offset:0 sc1
  buffer_load_dwordx4 a[100:103], v2, s[8:11], s22 offen offset:1024 sc1
  buffer_load_dwordx4 a[104:107], v2, s[8:11], s22 offen offset:2048 sc1
  buffer_load_dwordx4 a[108:111], v2, s[8:11], s22 offen offset:3072 sc1
  s_add_u32 s22, s21, 28672
  buffer_load_dwordx4 a[112:115], v2, s[8:11], s22 offen offset:0 sc1
  buffer_load_dwordx4 a[116:119], v2, s[8:11], s22 offen offset:1024 sc1
  buffer_load_dwordx4 a[120:123], v2, s[8:11], s22 offen offset:2048 sc1
  buffer_load_dwordx4 a[124:127], v2, s[8:11], s22 offen offset:3072 sc1
  s_add_u32 s22, s21, 32768
  buffer_load_dwordx4 a[128:131], v2, s[8:11], s22 offen offset:0 sc1
  buffer_load_dwordx4 a[132:135], v2, s[8:11], s22 offen offset:1024 sc1
  buffer_load_dwordx4 a[136:139], v2, s[8:11], s22 offen offset:2048 sc1
  buffer_load_dwordx4 a[140:143], v2, s[8:11], s22 offen offset:3072 sc1
  s_add_u32 s22, s21, 36864
  buffer_load_dwordx4 a[144:147], v2, s[8:11], s22 offen offset:0 sc1
  buffer_load_dwordx4 a[148:151], v2, s[8:11], s22 offen offset:1024 sc1
  buffer_load_dwordx4 a[152:155], v2, s[8:11], s22 offen offset:2048 sc1
  buffer_load_dwordx4 a[156:159], v2, s[8:11], s22 offen offset:3072 sc1
  s_add_u32 s22, s21, 40960
  s_waitcnt vmcnt(40)
  buffer_load_dwordx4 a[160:163], v2, s[8:11], s22 offen offset:0 sc1
  buffer_load_dwordx4 a[164:167], v2, s[8:11], s22 offen offset:1024 sc1
  buffer_load_dwordx4 a[168:171], v2, s[8:11], s22 offen offset:2048 sc1
  buffer_load_dwordx4 a[172:175], v2, s[8:11], s22 offen offset:3072 sc1
  s_add_u32 s22, s21, 45056
  buffer_load_dwordx4 a[176:179], v2, s[8:11], s22 offen offset:0 sc1
  buffer_load_dwordx4 a[180:183], v2, s[8:11], s22 offen offset:1024 sc1
  buffer_load_dwordx4 a[184:187], v2, s[8:11], s22 offen offset:2048 sc1
  buffer_load_dwordx4 a[188:191], v2, s[8:11], s22 offen offset:3072 sc1
  s_add_u32 s22, s21, 49152
  buffer_load_dwordx4 a[192:195], v2, s[8:11], s22 offen offset:0 sc1
  buffer_load_dwordx4 a[196:199], v2, s[8:11], s22 offen offset:1024 sc1
  buffer_load_dwordx4 a[200:203], v2, s[8:11], s22 offen offset:2048 sc1
  buffer_load_dwordx4 a[204:207], v2, s[8:11], s22 offen offset:3072 sc1
  s_add_u32 s22, s21, 53248
  buffer_load_dwordx4 a[208:211], v2, s[8:11], s22 offen offset:0 sc1
  buffer_load_dwordx4 a[212:215], v2, s[8:11], s22 offen offset:1024 sc1
  buffer_load_dwordx4 a[216:219], v2, s[8:11], s22 offen offset:2048 sc1
  buffer_load_dwordx4 a[220:223], v2, s[8:11], s22 offen offset:3072 sc1
wg_vo_hx:
  s_mov_b32 s101, -1
  s_waitcnt vmcnt(0)
  s_branch wg_vo_in
wg_vo_loop:
  s_waitcnt vmcnt(11)
wg_vo_in:
  s_barrier
  s_add_u32 s30, s19, 2
  s_min_u32 s30, s30, s36
  s_lshl_b32 s24, s30, 1
  s_mul_i32 s24, s24, 14336
  s_add_u32 s24, s24, s23
  s_add_u32 m0, s33, s27
  s_nop 0
  buffer_load_dwordx4 v2, s[8:11], s24 offen offset:0 sc1 lds
  buffer_load_dwordx4 v2, s[8:11], s24 offen offset:1024 sc1 lds
  buffer_load_dwordx4 v2, s[8:11], s24 offen offset:2048 sc1 lds
  buffer_load_dwordx4 v2, s[8:11], s24 offen offset:3072 sc1 lds
  s_add_u32 m0, m0, 4096
  s_add_u32 s24, s24, 4096
  buffer_load_dwordx4 v2, s[8:11], s24 offen offset:0 sc1 lds
  buffer_load_dwordx4 v2, s[8:11], s24 offen offset:1024 sc1 lds
  buffer_load_dwordx4 v2, s[8:11], s24 offen offset:2048 sc1 lds
  v_add_u32 v5, s32, v2
  ds_read_b128 v[8:11], v5 offset:0
  ds_read_b128 v[12:15], v5 offset:14336
  ds_read_b128 v[16:19], v5 offset:1024
  ds_read_b128 v[20:23], v5 offset:15360
  ds_read_b128 v[24:27], v5 offset:2048
  ds_read_b128 v[28:31], v5 offset:16384
  ds_read_b128 v[32:35], v5 offset:3072
  s_waitcnt lgkmcnt(6)
  v_mfma_f32_16x16x32_bf16 v[40:43], a[0:3], v[8:11], 0
  v_mfma_f32_16x16x32_bf16 v[44:47], a[56:59], v[8:11], 0
  v_mfma_f32_16x16x32_bf16 v[48:51], a[112:115], v[8:11], 0
  v_mfma_f32_16x16x32_bf16 v[52:55], a[168:171], v[8:11], 0
  ds_read_b128 v[36:39], v5 offset:17408
  s_waitcnt lgkmcnt(6)
  v_mfma_f32_16x16x32_bf16 v[56:59], a[0:3], v[12:15], 0
  v_mfma_f32_16x16x32_bf16 v[60:63], a[56:59], v[12:15], 0
  v_mfma_f32_16x16x32_bf16 v[64:67], a[112:115], v[12:15], 0
  v_mfma_f32_16x16x32_bf16 v[68:71], a[168:171], v[12:15], 0
  ds_read_b128 v[8:11], v5 offset:4096
  s_waitcnt lgkmcnt(6)
  v_mfma_f32_16x16x32_bf16 v[40:43], a[4:7], v[16:19], v[40:43]
  v_mfma_f32_16x16x32_bf16 v[44:47], a[60:63], v[16:19], v[44:47]
  v_mfma_f32_16x16x32_bf16 v[48:51], a[116:119], v[16:19], v[48:51]
  v_mfma_f32_16x16x32_bf16 v[52:55], a[172:175], v[16:19], v[52:55]
  ds_read_b128 v[12:15], v5 offset:18432
  s_waitcnt lgkmcnt(6)
  v_mfma_f32_16x16x32_bf16 v[56:59], a[4:7], v[20:23], v[56:59]
  v_mfma_f32_16x16x32_bf16 v[60:63], a[60:63], v[20:23], v[60:63]
  v_mfma_f32_16x16x32_bf16 v[64:67], a[116:119], v[20:23], v[64:67]
  v_mfma_f32_16x16x32_bf16 v[68:71], a[172:175], v[20:23], v[68:71]
  ds_read_b128 v[16:19], v5 offset:5120
  s_waitcnt lgkmcnt(6)
  v_mfma_f32_16x16x32_bf16 v[40:43], a[8:11], v[24:27], v[40:43]
  v_mfma_f32_16x16x32_bf16 v[44:47], a[64:67], v[24:27], v[44:47]
  v_mfma_f32_16x16x32_bf16 v[48:51], a[120:123], v[24:27], v[48:51]
  v_mfma_f32_16x16x32_bf16 v[52:55], a[176:179], v[24:27], v[52:55]
  ds_read_b128 v[20:23], v5 offset:19456
  s_waitcnt lgkmcnt(6)
  v_mfma_f32_16x16x32_bf16 v[56:59], a[8:11], v[28:31], v[56:59]
  v_mfma_f32_16x16x32_bf16 v[60:63], a[64:67], v[28:31], v[60:63]
  v_mfma_f32_16x16x32_bf16 v[64:67], a[120:123], v[28:31], v[64:67]
  v_mfma_f32_16x16x32_bf16 v[68:71], a[176:179], v[28:31], v[68:71]
  ds_read_b128 v[24:27], v5 offset:6144
  s_waitcnt lgkmcnt(6)
  v_mfma_f32_16x16x32_bf16 v[40:43], a[12:15], v[32:35], v[40:43]
  v_mfma_f32_16x16x32_bf16 v[44:47], a[68:71], v[32:35], v[44:47]
  v_mfma_f32_16x16x32_bf16 v[48:51], a[124:127], v[32:35], v[48:51]
  v_mfma_f32_16x16x32_bf16 v[52:55], a[180:183], v[32:35], v[52:55]
  ds_read_b128 v[28:31], v5 offset:20480
  s_waitcnt lgkmcnt(6)
  v_mfma_f32_16x16x32_bf16 v[56:59], a[12:15], v[36:39], v[56:59]
  v_mfma_f32_16x16x32_bf16 v[60:63], a[68:71], v[36:39], v[60:63]
  v_mfma_f32_16x16x32_bf16 v[64:67], a[124:127], v[36:39], v[64:67]
  v_mfma_f32_16x16x32_bf16 v[68:71], a[180:183], v[36:39], v[68:71]
  ds_read_b128 v[32:35], v5 offset:7168
  s_waitcnt lgkmcnt(6)
  v_mfma_f32_16x16x32_bf16 v[40:43], a[16:19], v[8:11], v[40:43]
  v_mfma_f32_16x16x32_bf16 v[44:47], a[72:75], v[8:11], v[44:47]
  v_mfma_f32_16x16x32_bf16 v[48:51], a[128:131], v[8:11], v[48:51]
  v_mfma_f32_16x16x32_bf16 v[52:55], a[184:187], v[8:11], v[52:55]
  ds_read_b128 v[36:39], v5 offset:21504
  s_waitcnt lgkmcnt(6)
  v_mfma_f32_16x16x32_bf16 v[56:59], a[16:19], v[12:15], v[56:59]
  v_mfma_f32_16x16x32_bf16 v[60:63], a[72:75], v[12:15], v[60:63]
  v_mfma_f32_16x16x32_bf16 v[64:67], a[128:131], v[12:15], v[64:67]
  v_mfma_f32_16x16x32_bf16 v[68:71], a[184:187], v[12:15], v[68:71]
  ds_read_b128 v[8:11], v5 offset:8192
  s_waitcnt lgkmcnt(6)
  v_mfma_f32_16x16x32_bf16 v[40:43], a[20:23], v[16:19], v[40:43]
  v_mfma_f32_16x16x32_bf16 v[44:47], a[76:79], v[16:19], v[44:47]
  v_mfma_f32_16x16x32_bf16 v[48:51], a[132:135], v[16:19], v[48:51]
  v_mfma_f32_16x16x32_bf16 v[52:55], a[188:191], v[16:19], v[52:55]
  ds_read_b128 v[12:15], v5 offset:22528
  s_waitcnt lgkmcnt(6)
  v_mfma_f32_16x16x32_bf16 v[56:59], a[20:23], v[20:23], v[56:59]
  v_mfma_f32_16x16x32_bf16 v[60:63], a[76:79], v[20:23], v[60:63]
  v_mfma_f32_16x16x32_bf16 v[64:67], a[132:135], v[20:23], v[64:67]
  v_mfma_f32_16x16x32_bf16 v[68:71], a[188:191], v[20:23], v[68:71]
  ds_read_b128 v[16:19], v5 offset:9216
  s_waitcnt lgkmcnt(6)
  v_mfma_f32_16x16x32_bf16 v[40:43], a[24:27], v[24:27], v[40:43]
  v_mfma_f32_16x16x32_bf16 v[44:47], a[80:83], v[24:27], v[44:47]
  v_mfma_f32_16x16x32_bf16 v[48:51], a[136:139], v[24:27], v[48:51]
  v_mfma_f32_16x16x32_bf16 v[52:55], a[192:195], v[24:27], v[52:55]
  ds_read_b128 v[20:23], v5 offset:23552
  s_waitcnt lgkmcnt(6)
  v_mfma_f32_16x16x32_bf16 v[56:59], a[24:27], v[28:31], v[56:59]
  v_mfma_f32_16x16x32_bf16 v[60:63], a[80:83], v[28:31], v[60:63]
  v_mfma_f32_16x16x32_bf16 v[64:67], a[136:139], v[28:31], v[64:67]
  v_mfma_f32_16x16x32_bf16 v[68:71], a[192:195], v[28:31], v[68:71]
  ds_read_b128 v[24:27], v5 offset:10240
  s_waitcnt lgkmcnt(6)
  v_mfma_f32_16x16x32_bf16 v[40:43], a[28:31], v[32:35], v[40:43]
  v_mfma_f32_16x16x32_bf16 v[44:47], a[84:87], v[32:35], v[44:47]
  v_mfma_f32_16x16x32_bf16 v[48:51], a[140:143], v[32:35], v[48:51]
  v_mfma_f32_16x16x32_bf16 v[52:55], a[196:199], v[32:35], v[52:55]
  ds_read_b128 v[28:31], v5 offset:24576
  s_waitcnt lgkmcnt(6)
  v_mfma_f32_16x16x32_bf16 v[56:59], a[28:31], v[36:39], v[56:59]
  v_mfma_f32_16x16x32_bf16 v[60:63], a[84:87], v[36:39], v[60:63]
  v_mfma_f32_16x16x32_bf16 v[64:67], a[140:143], v[36:39], v[64:67]
  v_mfma_f32_16x16x32_bf16 v[68:71], a[196:199], v[36:39], v[68:71]
  ds_read_b128 v[32:35], v5 offset:11264
  s_waitcnt lgkmcnt(6)
  v_mfma_f32_16x16x32_bf16 v[40:43], a[32:35], v[8:11], v[40:43]
  v_mfma_f32_16x16x32_bf16 v[44:47], a[88:91], v[8:11], v[44:47]
  v_mfma_f32_16x16x32_bf16 v[48:51], a[144:147], v[8:11], v[48:51]
  v_mfma_f32_16x16x32_bf16 v[52:55], a[200:203], v[8:11], v[52:55]
  ds_read_b128 v[36:39], v5 offset:25600
  s_waitcnt lgkmcnt(6)
  v_mfma_f32_16x16x32_bf16 v[56:59], a[32:35], v[12:15], v[56:59]
  v_mfma_f32_16x16x32_bf16 v[60:63], a[88:91], v[12:15], v[60:63]
  v_mfma_f32_16x16x32_bf16 v[64:67], a[144:147], v[12:15], v[64:67]
  v_mfma_f32_16x16x32_bf16 v[68:71], a[200:203], v[12:15], v[68:71]
  ds_read_b128 v[8:11], v5 offset:12288
  s_waitcnt lgkmcnt(6)
  v_mfma_f32_16x16x32_bf16 v[40:43], a[36:39], v[16:19], v[40:43]
  v_mfma_f32_16x16x32_bf16 v[44:47], a[92:95], v[16:19], v[44:47]
  v_mfma_f32_16x16x32_bf16 v[48:51], a[148:151], v[16:19], v[48:51]
  v_mfma_f32_16x16x32_bf16 v[52:55], a[204:207], v[16:19], v[52:55]
  ds_read_b128 v[12:15], v5 offset:26624
  s_waitcnt lgkmcnt(6)
  v_mfma_f32_16x16x32_bf16 v[56:59], a[36:39], v[20:23], v[56:59]
  v_mfma_f32_16x16x32_bf16 v[60:63], a[92:95], v[20:23], v[60:63]
  v_mfma_f32_16x16x32_bf16 v[64:67], a[148:151], v[20:23], v[64:67]
  v_mfma_f32_16x16x32_bf16 v[68:71], a[204:207], v[20:23], v[68:71]
  ds_read_b128 v[16:19], v5 offset:13312
  s_waitcnt lgkmcnt(6)
  v_mfma_f32_16x16x32_bf16 v[40:43], a[40:43], v[24:27], v[40:43]
  v_mfma_f32_16x16x32_bf16 v[44:47], a[96:99], v[24:27], v[44:47]
  v_mfma_f32_16x16x32_bf16 v[48:51], a[152:155], v[24:27], v[48:51]
  v_mfma_f32_16x16x32_bf16 v[52:55], a[208:211], v[24:27], v[52:55]
  ds_read_b128 v[20:23], v5 offset:27648
  s_waitcnt lgkmcnt(6)
  v_mfma_f32_16x16x32_bf16 v[56:59], a[40:43], v[28:31], v[56:59]
  v_mfma_f32_16x16x32_bf16 v[60:63], a[96:99], v[28:31], v[60:63]
  v_mfma_f32_16x16x32_bf16 v[64:67], a[152:155], v[28:31], v[64:67]
  v_mfma_f32_16x16x32_bf16 v[68:71], a[208:211], v[28:31], v[68:71]
  s_waitcnt lgkmcnt(5)
  v_mfma_f32_16x16x32_bf16 v[40:43], a[44:47], v[32:35], v[40:43]
  v_mfma_f32_16x16x32_bf16 v[44:47], a[100:103], v[32:35], v[44:47]
  v_mfma_f32_16x16x32_bf16 v[48:51], a[156:159], v[32:35], v[48:51]
  v_mfma_f32_16x16x32_bf16 v[52:55], a[212:215], v[32:35], v[52:55]
  s_waitcnt lgkmcnt(4)
  v_mfma_f32_16x16x32_bf16 v[56:59], a[44:47], v[36:39], v[56:59]
  v_mfma_f32_16x16x32_bf16 v[60:63], a[100:103], v[36:39], v[60:63]
  v_mfma_f32_16x16x32_bf16 v[64:67], a[156:159], v[36:39], v[64:67]
  v_mfma_f32_16x16x32_bf16 v[68:71], a[212:215], v[36:39], v[68:71]
  s_waitcnt lgkmcnt(3)
  v_mfma_f32_16x16x32_bf16 v[40:43], a[48:51], v[8:11], v[40:43]
  v_mfma_f32_16x16x32_bf16 v[44:47], a[104:107], v[8:11], v[44:47]
  v_mfma_f32_16x16x32_bf16 v[48:51], a[160:163], v[8:11], v[48:51]
  v_mfma_f32_16x16x32_bf16 v[52:55], a[216:219], v[8:11], v[52:55]
  s_waitcnt lgkmcnt(2)
  v_mfma_f32_16x16x32_bf16 v[56:59], a[48:51], v[12:15], v[56:59]
  v_mfma_f32_16x16x32_bf16 v[60:63], a[104:107], v[12:15], v[60:63]
  v_mfma_f32_16x16x32_bf16 v[64:67], a[160:163], v[12:15], v[64:67]
  v_mfma_f32_16x16x32_bf16 v[68:71], a[216:219], v[12:15], v[68:71]
  s_waitcnt lgkmcnt(1)
  v_mfma_f32_16x16x32_bf16 v[40:43], a[52:55], v[16:19], v[40:43]
  v_mfma_f32_16x16x32_bf16 v[44:47], a[108:111], v[16:19], v[44:47]
  v_mfma_f32_16x16x32_bf16 v[48:51], a[164:167], v[16:19], v[48:51]
  v_mfma_f32_16x16x32_bf16 v[52:55], a[220:223], v[16:19], v[52:55]
  s_waitcnt lgkmcnt(0)
  v_mfma_f32_16x16x32_bf16 v[56:59], a[52:55], v[20:23], v[56:59]
  v_mfma_f32_16x16x32_bf16 v[60:63], a[108:111], v[20:23], v[60:63]
  v_mfma_f32_16x16x32_bf16 v[64:67], a[164:167], v[20:23], v[64:67]
  v_mfma_f32_16x16x32_bf16 v[68:71], a[220:223], v[20:23], v[68:71]
  s_add_u32 s25, s29, 458752
  s_lshl_b32 s24, s19, 5
  s_add_u32 s24, s24, 0
  v_add_u32 v88, s24, v4
  v_mul_u32_u24 v89, 2341, v88
  v_lshrrev_b32 v89, 16, v89
  v_mul_u32_u24 v92, 28, v89
  v_sub_u32 v92, v88, v92
  v_cmp_gt_u32 vcc, 16, v92
  v_mul_u32_u24 v89, 84, v89
  s_nop 0
  v_cndmask_b32 v92, v7, v6, vcc
  v_add3_u32 v88, v88, v89, v92
  v_lshlrev_b32 v90, 4, v88
  v_cvt_pk_bf16_f32 v72, v40, v44
  v_cvt_pk_bf16_f32 v73, v41, v45
  v_cvt_pk_bf16_f32 v74, v42, v46
  v_cvt_pk_bf16_f32 v75, v43, v47
  buffer_store_dwordx4 v[72:75], v90, s[8:11], s29 offen sc1
  v_cvt_pk_bf16_f32 v76, v48, v52
  v_cvt_pk_bf16_f32 v77, v49, v53
  v_cvt_pk_bf16_f32 v78, v50, v54
  v_cvt_pk_bf16_f32 v79, v51, v55
  buffer_store_dwordx4 v[76:79], v90, s[8:11], s25 offen sc1
  s_lshl_b32 s24, s19, 5
  s_add_u32 s24, s24, 16
  v_add_u32 v88, s24, v4
  v_mul_u32_u24 v89, 2341, v88
  v_lshrrev_b32 v89, 16, v89
  v_mul_u32_u24 v92, 28, v89
  v_sub_u32 v92, v88, v92
  v_cmp_gt_u32 vcc, 16, v92
  v_mul_u32_u24 v89, 84, v89
  s_nop 0
  v_cndmask_b32 v92, v7, v6, vcc
  v_add3_u32 v88, v88, v89, v92
  v_lshlrev_b32 v91, 4, v88
  v_cvt_pk_bf16_f32 v80, v56, v60
  v_cvt_pk_bf16_f32 v81, v57, v61
  v_cvt_pk_bf16_f32 v82, v58, v62
  v_cvt_pk_bf16_f32 v83, v59, v63
  buffer_store_dwordx4 v[80:83], v91, s[8:11], s29 offen sc1
  v_cvt_pk_bf16_f32 v84, v64, v68
  v_cvt_pk_bf16_f32 v85, v65, v69
  v_cvt_pk_bf16_f32 v86, v66, v70
  v_cvt_pk_bf16_f32 v87, v67, v71
  buffer_store_dwordx4 v[84:87], v91, s[8:11], s25 offen sc1
  s_mov_b32 s33, s32
  s_add_u32 s32, s32, 28672
  s_cmp_eq_u32 s32, 86016
  s_cselect_b32 s32, 0, s32
  s_add_u32 s19, s19, 1
  s_cmp_lt_u32 s19, s35
  s_cbranch_scc1 wg_vo_loop
  s_branch wg_done
wg_done:
  s_lshl_b32 s20, s18, 4
  s_and_b32 s21, s17, 15
  s_add_u32 s20, s20, s21
  s_lshl_b32 s20, s20, 7
  s_cmp_lt_u32 s17, 16
  s_cselect_b32 s21, 16384, 0
  s_add_u32 s20, s20, s21
  s_add_u32 s20, s20, 88461312
  s_sub_u32 s21, s35, s34
  s_lshl_b32 s21, s21, 2
  v_mov_b32 v5, s21
  v_mov_b32 v6, 0
  s_waitcnt vmcnt(0)
  s_barrier
  s_cmp_lg_u32 s16, 0
  s_cbranch_scc1 wg_sg
  s_mov_b64 exec, 1
  buffer_atomic_add v5, v6, s[8:11], s20 offen
  s_mov_b64 exec, -1
wg_sg:
  s_branch wk_loop
wk_srv:
  s_and_b32 s18, s3, 15
  s_lshr_b32 s19, s3, 4
  s_and_b32 s19, s19, 1
  s_mul_i32 s20, s18, 401408
  s_mul_i32 s21, s16, 100352
  s_add_u32 s20, s20, s21
  s_add_u32 s20, s20, 6422528
  s_add_u32 s22, s20, 0
  buffer_load_dwordx4 a[0:3], v2, s[8:11], s22 offen offset:0 sc1
  buffer_load_dwordx4 a[4:7], v2, s[8:11], s22 offen offset:1024 sc1
  buffer_load_dwordx4 a[8:11], v2, s[8:11], s22 offen offset:2048 sc1
  buffer_load_dwordx4 a[12:15], v2, s[8:11], s22 offen offset:3072 sc1
  s_add_u32 s22, s20, 4096
  buffer_load_dwordx4 a[16:19], v2, s[8:11], s22 offen offset:0 sc1
  buffer_load_dwordx4 a[20:23], v2, s[8:11], s22 offen offset:1024 sc1
  buffer_load_dwordx4 a[24:27], v2, s[8:11], s22 offen offset:2048 sc1
  buffer_load_dwordx4 a[28:31], v2, s[8:11], s22 offen offset:3072 sc1
  s_add_u32 s22, s20, 8192
  buffer_load_dwordx4 a[32:35], v2, s[8:11], s22 offen offset:0 sc1
  buffer_load_dwordx4 a[36:39], v2, s[8:11], s22 offen offset:1024 sc1
  buffer_load_dwordx4 a[40:43], v2, s[8:11], s22 offen offset:2048 sc1
  buffer_load_dwordx4 a[44:47], v2, s[8:11], s22 offen offset:3072 sc1
  s_add_u32 s22, s20, 12288
  buffer_load_dwordx4 a[48:51], v2, s[8:11], s22 offen offset:0 sc1
  buffer_load_dwordx4 a[52:55], v2, s[8:11], s22 offen offset:1024 sc1
  buffer_load_dwordx4 a[56:59], v2, s[8:11], s22 offen offset:2048 sc1
  buffer_load_dwordx4 a[60:63], v2, s[8:11], s22 offen offset:3072 sc1
  s_add_u32 s22, s20, 16384
  buffer_load_dwordx4 a[64:67], v2, s[8:11], s22 offen offset:0 sc1
  buffer_load_dwordx4 a[68:71], v2, s[8:11], s22 offen offset:1024 sc1
  buffer_load_dwordx4 a[72:75], v2, s[8:11], s22 offen offset:2048 sc1
  buffer_load_dwordx4 a[76:79], v2, s[8:11], s22 offen offset:3072 sc1
  s_add_u32 s22, s20, 20480
  buffer_load_dwordx4 a[80:83], v2, s[8:11], s22 offen offset:0 sc1
  buffer_load_dwordx4 a[84:87], v2, s[8:11], s22 offen offset:1024 sc1
  buffer_load_dwordx4 a[88:91], v2, s[8:11], s22 offen offset:2048 sc1
  buffer_load_dwordx4 a[92:95], v2, s[8:11], s22 offen offset:3072 sc1
  s_add_u32 s22, s20, 24576
  buffer_load_dwordx4 a[96:99], v2, s[8:11], s22 offen offset:0 sc1
  buffer_load_dwordx4 a[100:103], v2, s[8:11], s22 offen offset:1024 sc1
  buffer_load_dwordx4 a[104:107], v2, s[8:11], s22 offen offset:2048 sc1
  buffer_load_dwordx4 a[108:111], v2, s[8:11], s22 offen offset:3072 sc1
  s_add_u32 s22, s20, 28672
  buffer_load_dwordx4 a[112:115], v2, s[8:11], s22 offen offset:0 sc1
  buffer_load_dwordx4 a[116:119], v2, s[8:11], s22 offen offset:1024 sc1
  buffer_load_dwordx4 a[120:123], v2, s[8:11], s22 offen offset:2048 sc1
  buffer_load_dwordx4 a[124:127], v2, s[8:11], s22 offen offset:3072 sc1
  s_waitcnt vmcnt(24)
  s_add_u32 s22, s20, 32768
  buffer_load_dwordx4 a[128:131], v2, s[8:11], s22 offen offset:0 sc1
  buffer_load_dwordx4 a[132:135], v2, s[8:11], s22 offen offset:1024 sc1
  buffer_load_dwordx4 a[136:139], v2, s[8:11], s22 offen offset:2048 sc1
  buffer_load_dwordx4 a[140:143], v2, s[8:11], s22 offen offset:3072 sc1
  s_add_u32 s22, s20, 36864
  buffer_load_dwordx4 a[144:147], v2, s[8:11], s22 offen offset:0 sc1
  buffer_load_dwordx4 a[148:151], v2, s[8:11], s22 offen offset:1024 sc1
  buffer_load_dwordx4 a[152:155], v2, s[8:11], s22 offen offset:2048 sc1
  buffer_load_dwordx4 a[156:159], v2, s[8:11], s22 offen offset:3072 sc1
  s_add_u32 s22, s20, 40960
  buffer_load_dwordx4 a[160:163], v2, s[8:11], s22 offen offset:0 sc1
  buffer_load_dwordx4 a[164:167], v2, s[8:11], s22 offen offset:1024 sc1
  buffer_load_dwordx4 a[168:171], v2, s[8:11], s22 offen offset:2048 sc1
  buffer_load_dwordx4 a[172:175], v2, s[8:11], s22 offen offset:3072 sc1
  s_add_u32 s22, s20, 45056
  buffer_load_dwordx4 a[176:179], v2, s[8:11], s22 offen offset:0 sc1
  buffer_load_dwordx4 a[180:183], v2, s[8:11], s22 offen offset:1024 sc1
  buffer_load_dwordx4 a[184:187], v2, s[8:11], s22 offen offset:2048 sc1
  buffer_load_dwordx4 a[188:191], v2, s[8:11], s22 offen offset:3072 sc1
  s_add_u32 s22, s20, 49152
  buffer_load_dwordx4 a[192:195], v2, s[8:11], s22 offen offset:0 sc1
  buffer_load_dwordx4 a[196:199], v2, s[8:11], s22 offen offset:1024 sc1
  buffer_load_dwordx4 a[200:203], v2, s[8:11], s22 offen offset:2048 sc1
  buffer_load_dwordx4 a[204:207], v2, s[8:11], s22 offen offset:3072 sc1
  s_add_u32 s22, s20, 53248
  buffer_load_dwordx4 a[208:211], v2, s[8:11], s22 offen offset:0 sc1
  buffer_load_dwordx4 a[212:215], v2, s[8:11], s22 offen offset:1024 sc1
  buffer_load_dwordx4 a[216:219], v2, s[8:11], s22 offen offset:2048 sc1
  buffer_load_dwordx4 a[220:223], v2, s[8:11], s22 offen offset:3072 sc1
  s_add_u32 s22, s20, 57344
  buffer_load_dwordx4 a[224:227], v2, s[8:11], s22 offen offset:0 sc1
  buffer_load_dwordx4 a[228:231], v2, s[8:11], s22 offen offset:1024 sc1
  buffer_load_dwordx4 a[232:235], v2, s[8:11], s22 offen offset:2048 sc1
  buffer_load_dwordx4 a[236:239], v2, s[8:11], s22 offen offset:3072 sc1
  s_add_u32 s22, s20, 61440
  buffer_load_dwordx4 a[240:243], v2, s[8:11], s22 offen offset:0 sc1
  buffer_load_dwordx4 a[244:247], v2, s[8:11], s22 offen offset:1024 sc1
  buffer_load_dwordx4 a[248:251], v2, s[8:11], s22 offen offset:2048 sc1
  buffer_load_dwordx4 a[252:255], v2, s[8:11], s22 offen offset:3072 sc1
  s_waitcnt vmcnt(24)
  s_add_u32 s22, s20, 65536
  buffer_load_dwordx4 v[120:123], v2, s[8:11], s22 offen offset:0 sc1
  buffer_load_dwordx4 v[124:127], v2, s[8:11], s22 offen offset:1024 sc1
  buffer_load_dwordx4 v[128:131], v2, s[8:11], s22 offen offset:2048 sc1
  buffer_load_dwordx4 v[132:135], v2, s[8:11], s22 offen offset:3072 sc1
  s_add_u32 s22, s20, 69632
  buffer_load_dwordx4 v[136:139], v2, s[8:11], s22 offen offset:0 sc1
  buffer_load_dwordx4 v[140:143], v2, s[8:11], s22 offen offset:1024 sc1
  buffer_load_dwordx4 v[144:147], v2, s[8:11], s22 offen offset:2048 sc1
  buffer_load_dwordx4 v[148:151], v2, s[8:11], s22 offen offset:3072 sc1
  s_add_u32 s22, s20, 73728
  buffer_load_dwordx4 v[152:155], v2, s[8:11], s22 offen offset:0 sc1
  buffer_load_dwordx4 v[156:159], v2, s[8:11], s22 offen offset:1024 sc1
  buffer_load_dwordx4 v[160:163], v2, s[8:11], s22 offen offset:2048 sc1
  buffer_load_dwordx4 v[164:167], v2, s[8:11], s22 offen offset:3072 sc1
  s_add_u32 s22, s20, 77824
  buffer_load_dwordx4 v[168:171], v2, s[8:11], s22 offen offset:0 sc1
  buffer_load_dwordx4 v[172:175], v2, s[8:11], s22 offen offset:1024 sc1
  buffer_load_dwordx4 v[176:179], v2, s[8:11], s22 offen offset:2048 sc1
  buffer_load_dwordx4 v[180:183], v2, s[8:11], s22 offen offset:3072 sc1
  s_add_u32 s22, s20, 81920
  buffer_load_dwordx4 v[184:187], v2, s[8:11], s22 offen offset:0 sc1
  buffer_load_dwordx4 v[188:191], v2, s[8:11], s22 offen offset:1024 sc1
  buffer_load_dwordx4 v[192:195], v2, s[8:11], s22 offen offset:2048 sc1
  buffer_load_dwordx4 v[196:199], v2, s[8:11], s22 offen offset:3072 sc1
  s_add_u32 s22, s20, 86016
  buffer_load_dwordx4 v[200:203], v2, s[8:11], s22 offen offset:0 sc1
  buffer_load_dwordx4 v[204:207], v2, s[8:11], s22 offen offset:1024 sc1
  buffer_load_dwordx4 v[208:211], v2, s[8:11], s22 offen offset:2048 sc1
  buffer_load_dwordx4 v[212:215], v2, s[8:11], s22 offen offset:3072 sc1
  s_add_u32 s22, s20, 90112
  buffer_load_dwordx4 v[216:219], v2, s[8:11], s22 offen offset:0 sc1
  buffer_load_dwordx4 v[220:223], v2, s[8:11], s22 offen offset:1024 sc1
  buffer_load_dwordx4 v[224:227], v2, s[8:11], s22 offen offset:2048 sc1
  buffer_load_dwordx4 v[228:231], v2, s[8:11], s22 offen offset:3072 sc1
  s_add_u32 s22, s20, 94208
  buffer_load_dwordx4 v[232:235], v2, s[8:11], s22 offen offset:0 sc1
  buffer_load_dwordx4 v[236:239], v2, s[8:11], s22 offen offset:1024 sc1
  buffer_load_dwordx4 v[240:243], v2, s[8:11], s22 offen offset:2048 sc1
  buffer_load_dwordx4 v[244:247], v2, s[8:11], s22 offen offset:3072 sc1
  s_waitcnt vmcnt(24)
  s_add_u32 s22, s20, 98304
  buffer_load_dwordx4 v[248:251], v2, s[8:11], s22 offen offset:0 sc1
  buffer_load_dwordx4 v[252:255], v2, s[8:11], s22 offen offset:1024 sc1
  v_mov_b32 v5, 0x4444
  v_mov_b32 v6, 0xeeee
  v_cmp_lt_u32 vcc, 7, v4
  s_nop 1
  v_cndmask_b32 v5, v5, v6, vcc
  s_lshl_b32 s23, s16, 11
  v_lshrrev_b32 v80, 1, v3
  v_and_b32 v81, 1, v3
  v_add_u32 v82, 0, v80
  v_lshl_add_u32 v82, v82, 4, v4
  v_mul_u32_u24 v83, 2341, v82
  v_lshrrev_b32 v83, 16, v83
  v_mul_u32_u24 v84, 28, v83
  v_sub_u32 v84, v82, v84
  v_lshrrev_b32 v85, 4, v84
  v_and_b32 v84, 15, v84
  v_lshlrev_b32 v86, 10, v85
  v_lshl_add_u32 v86, v83, 8, v86
  v_lshl_add_u32 v86, v84, 4, v86
  v_lshl_add_u32 v86, v81, 3, v86
  v_add_u32 v72, s23, v86
  v_add_u32 v82, 2, v80
  v_lshl_add_u32 v82, v82, 4, v4
  v_mul_u32_u24 v83, 2341, v82
  v_lshrrev_b32 v83, 16, v83
  v_mul_u32_u24 v84, 28, v83
  v_sub_u32 v84, v82, v84
  v_lshrrev_b32 v85, 4, v84
  v_and_b32 v84, 15, v84
  v_lshlrev_b32 v86, 10, v85
  v_lshl_add_u32 v86, v83, 8, v86
  v_lshl_add_u32 v86, v84, 4, v86
  v_lshl_add_u32 v86, v81, 3, v86
  v_add_u32 v73, s23, v86
  v_add_u32 v82, 4, v80
  v_lshl_add_u32 v82, v82, 4, v4
  v_mul_u32_u24 v83, 2341, v82
  v_lshrrev_b32 v83, 16, v83
  v_mul_u32_u24 v84, 28, v83
  v_sub_u32 v84, v82, v84
  v_lshrrev_b32 v85, 4, v84
  v_and_b32 v84, 15, v84
  v_lshlrev_b32 v86, 10, v85
  v_lshl_add_u32 v86, v83, 8, v86
  v_lshl_add_u32 v86, v84, 4, v86
  v_lshl_add_u32 v86, v81, 3, v86
  v_add_u32 v74, s23, v86
  v_mov_b32 v82, 6
  v_lshl_add_u32 v82, v82, 4, v4
  v_mul_u32_u24 v83, 2341, v82
  v_lshrrev_b32 v83, 16, v83
  v_mul_u32_u24 v84, 28, v83
  v_sub_u32 v84, v82, v84
  v_lshrrev_b32 v85, 4, v84
  v_and_b32 v84, 15, v84
  v_lshlrev_b32 v86, 10, v85
  v_lshl_add_u32 v86, v83, 8, v86
  v_lshl_add_u32 v86, v84, 4, v86
  v_lshl_add_u32 v86, v81, 3, v86
  v_add_u32 v75, s23, v86
  v_add_u32 v76, s23, v2
  s_mul_i32 s27, s18, 448
  v_mov_b32 v77, s27
  v_mov_b32 v78, 1
  s_mov_b32 s17, s19
  s_mul_i32 s24, s19, 7168
  s_add_u32 s24, s24, 88002560
  s_mul_i32 s25, s18, 65
  s_add_u32 s25, s25, s19
  s_lshl_b32 s25, s25, 13
  s_add_u32 s25, s25, s23
  s_add_u32 s25, s25, 76869632
  s_lshl_b32 s26, s18, 6
  s_add_u32 s26, s26, s19
  s_lshl_b32 s26, s26, 4
  s_lshl_b32 s27, s16, 2
  s_add_u32 s26, s26, s27
  s_add_u32 s26, s26, 88502272
  v_mov_b32 v88, 0
  v_mov_b32 v89, 0
  v_mov_b32 v90, 0
  v_mov_b32 v91, 0
  v_mov_b32 v92, -1
  v_mov_b32 v93, -1
  v_mov_b32 v94, -1
  v_mov_b32 v95, -1
  ds_write_b128 v76, v[88:91]
  ds_write_b128 v76, v[88:91] offset:1024
  s_branch ws_arm
ws_loop:
  v_mov_b32 v36, 0
  v_mov_b32 v37, 0
  v_mov_b32 v38, 0
  v_mov_b32 v39, 0
  v_mov_b32 v40, 0
  v_mov_b32 v41, 0
  v_mov_b32 v42, 0
  v_mov_b32 v43, 0
  v_mov_b32 v44, 0
  v_mov_b32 v45, 0
  v_mov_b32 v46, 0
  v_mov_b32 v47, 0
  v_mov_b32 v48, 0
  v_mov_b32 v49, 0
  v_mov_b32 v50, 0
  v_mov_b32 v51, 0
  v_mov_b32 v52, 0
  v_mov_b32 v53, 0
  v_mov_b32 v54, 0
  v_mov_b32 v55, 0
  v_mov_b32 v56, 0
  v_mov_b32 v57, 0
  v_mov_b32 v58, 0
  v_mov_b32 v59, 0
  v_mov_b32 v60, 0
  v_mov_b32 v61, 0
  v_mov_b32 v62, 0
  v_mov_b32 v63, 0
  s_mov_b32 s30, 0
  s_branch ws_fl
ws_pm:
  s_cmp_ge_u32 s17, 64
  s_cbranch_scc1 ws_fl
  buffer_load_dword v79, v77, s[8:11], s24 offen sc1
  s_waitcnt vmcnt(0)
  v_cmp_eq_u32 vcc, -1, v79
  s_cbranch_vccnz ws_pr
ws_fl:
  s_add_u32 s22, s24, 4096
  buffer_load_dwordx4 v[8:11], v2, s[8:11], s24 offen offset:0 sc1
  buffer_load_dwordx4 v[12:15], v2, s[8:11], s24 offen offset:1024 sc1
  buffer_load_dwordx4 v[16:19], v2, s[8:11], s24 offen offset:2048 sc1
  buffer_load_dwordx4 v[20:23], v2, s[8:11], s24 offen offset:3072 sc1
  buffer_load_dwordx4 v[24:27], v2, s[8:11], s22 offen offset:0 sc1
  buffer_load_dwordx4 v[28:31], v2, s[8:11], s22 offen offset:1024 sc1
  buffer_load_dwordx4 v[32:35], v2, s[8:11], s22 offen offset:2048 sc1
  s_waitcnt vmcnt(0)
  v_max_u32 v79, v8, v9
  v_max3_u32 v79, v79, v10, v11
  v_max3_u32 v79, v79, v12, v13
  v_max3_u32 v79, v79, v14, v15
  v_max3_u32 v79, v79, v16, v17
  v_max3_u32 v79, v79, v18, v19
  v_max3_u32 v79, v79, v20, v21
  v_max3_u32 v79, v79, v22, v23
  v_max3_u32 v79, v79, v24, v25
  v_max3_u32 v79, v79, v26, v27
  v_max3_u32 v79, v79, v28, v29
  v_max3_u32 v79, v79, v30, v31
  v_max3_u32 v79, v79, v32, v33
  v_max3_u32 v79, v79, v34, v35
  v_cmp_eq_u32 vcc, -1, v79
  s_cbranch_vccz ws_pk
ws_pr:
  s_sleep 6
  s_add_u32 s30, s30, 1
  s_cmp_lt_u32 s30, 2000000
  s_cbranch_scc1 ws_pm
  s_branch cA_abort
ws_pk:
  v_smfmac_f32_16x16x64_bf16 v[36:39], v[8:11], a[0:7], v5
  v_smfmac_f32_16x16x64_bf16 v[36:39], v[12:15], a[8:15], v5
  v_smfmac_f32_16x16x64_bf16 v[36:39], v[16:19], a[16:23], v5
  v_smfmac_f32_16x16x64_bf16 v[36:39], v[20:23], a[24:31], v5
  v_smfmac_f32_16x16x64_bf16 v[36:39], v[24:27], a[32:39], v5
  v_smfmac_f32_16x16x64_bf16 v[36:39], v[28:31], a[40:47], v5
  v_smfmac_f32_16x16x64_bf16 v[36:39], v[32:35], a[48:55], v5
  v_smfmac_f32_16x16x64_bf16 v[40:43], v[8:11], a[56:63], v5
  v_smfmac_f32_16x16x64_bf16 v[40:43], v[12:15], a[64:71], v5
  v_smfmac_f32_16x16x64_bf16 v[40:43], v[16:19], a[72:79], v5
  v_smfmac_f32_16x16x64_bf16 v[40:43], v[20:23], a[80:87], v5
  v_smfmac_f32_16x16x64_bf16 v[40:43], v[24:27], a[88:95], v5
  v_smfmac_f32_16x16x64_bf16 v[40:43], v[28:31], a[96:103], v5
  v_smfmac_f32_16x16x64_bf16 v[40:43], v[32:35], a[104:111], v5
  v_smfmac_f32_16x16x64_bf16 v[44:47], v[8:11], a[112:119], v5
  v_smfmac_f32_16x16x64_bf16 v[44:47], v[12:15], a[120:127], v5
  v_smfmac_f32_16x16x64_bf16 v[44:47], v[16:19], a[128:135], v5
  v_smfmac_f32_16x16x64_bf16 v[44:47], v[20:23], a[136:143], v5
  v_smfmac_f32_16x16x64_bf16 v[44:47], v[24:27], a[144:151], v5
  v_smfmac_f32_16x16x64_bf16 v[44:47], v[28:31], a[152:159], v5
  v_smfmac_f32_16x16x64_bf16 v[44:47], v[32:35], a[160:167], v5
  v_smfmac_f32_16x16x64_bf16 v[48:51], v[8:11], a[168:175], v5
  v_smfmac_f32_16x16x64_bf16 v[48:51], v[12:15], a[176:183], v5
  v_smfmac_f32_16x16x64_bf16 v[48:51], v[16:19], a[184:191], v5
  v_smfmac_f32_16x16x64_bf16 v[48:51], v[20:23], a[192:199], v5
  v_smfmac_f32_16x16x64_bf16 v[48:51], v[24:27], a[200:207], v5
  v_smfmac_f32_16x16x64_bf16 v[48:51], v[28:31], a[208:215], v5
  v_smfmac_f32_16x16x64_bf16 v[48:51], v[32:35], a[216:223], v5
  v_smfmac_f32_16x16x64_bf16 v[52:55], v[8:11], a[224:231], v5
  v_smfmac_f32_16x16x64_bf16 v[52:55], v[12:15], a[232:239], v5
  v_smfmac_f32_16x16x64_bf16 v[52:55], v[16:19], a[240:247], v5
  v_smfmac_f32_16x16x64_bf16 v[52:55], v[20:23], a[248:255], v5
  v_smfmac_f32_16x16x64_bf16 v[52:55], v[24:27], v[120:127], v5
  v_smfmac_f32_16x16x64_bf16 v[52:55], v[28:31], v[128:135], v5
  v_smfmac_f32_16x16x64_bf16 v[52:55], v[32:35], v[136:143], v5
  v_smfmac_f32_16x16x64_bf16 v[56:59], v[8:11], v[144:151], v5
  v_smfmac_f32_16x16x64_bf16 v[56:59], v[12:15], v[152:159], v5
  v_smfmac_f32_16x16x64_bf16 v[56:59], v[16:19], v[160:167], v5
  v_smfmac_f32_16x16x64_bf16 v[56:59], v[20:23], v[168:175], v5
  v_smfmac_f32_16x16x64_bf16 v[56:59], v[24:27], v[176:183], v5
  v_smfmac_f32_16x16x64_bf16 v[56:59], v[28:31], v[184:191], v5
  v_smfmac_f32_16x16x64_bf16 v[56:59], v[32:35], v[192:199], v5
  v_smfmac_f32_16x16x64_bf16 v[60:63], v[8:11], v[200:207], v5
  v_smfmac_f32_16x16x64_bf16 v[60:63], v[12:15], v[208:215], v5
  v_smfmac_f32_16x16x64_bf16 v[60:63], v[16:19], v[216:223], v5
  v_smfmac_f32_16x16x64_bf16 v[60:63], v[20:23], v[224:231], v5
  v_smfmac_f32_16x16x64_bf16 v[60:63], v[24:27], v[232:239], v5
  v_smfmac_f32_16x16x64_bf16 v[60:63], v[28:31], v[240:247], v5
  v_smfmac_f32_16x16x64_bf16 v[60:63], v[32:35], v[248:255], v5
  v_permlane32_swap_b32 v36, v40
  v_permlane32_swap_b32 v37, v41
  v_permlane32_swap_b32 v38, v42
  v_permlane32_swap_b32 v39, v43
  v_add_f32 v36, v36, v40
  v_add_f32 v37, v37, v41
  v_add_f32 v38, v38, v42
  v_add_f32 v39, v39, v43
  v_cvt_pk_bf16_f32 v40, v36, v37
  v_cvt_pk_bf16_f32 v41, v38, v39
  v_min_u32 v40, -2, v40
  v_min_u32 v41, -2, v41
  ds_write_b64 v72, v[40:41]
  v_permlane32_swap_b32 v44, v48
  v_permlane32_swap_b32 v45, v49
  v_permlane32_swap_b32 v46, v50
  v_permlane32_swap_b32 v47, v51
  v_add_f32 v44, v44, v48
  v_add_f32 v45, v45, v49
  v_add_f32 v46, v46, v50
  v_add_f32 v47, v47, v51
  v_cvt_pk_bf16_f32 v48, v44, v45
  v_cvt_pk_bf16_f32 v49, v46, v47
  v_min_u32 v48, -2, v48
  v_min_u32 v49, -2, v49
  ds_write_b64 v73, v[48:49]
  v_permlane32_swap_b32 v52, v56
  v_permlane32_swap_b32 v53, v57
  v_permlane32_swap_b32 v54, v58
  v_permlane32_swap_b32 v55, v59
  v_add_f32 v52, v52, v56
  v_add_f32 v53, v53, v57
  v_add_f32 v54, v54, v58
  v_add_f32 v55, v55, v59
  v_cvt_pk_bf16_f32 v56, v52, v53
  v_cvt_pk_bf16_f32 v57, v54, v55
  v_min_u32 v56, -2, v56
  v_min_u32 v57, -2, v57
  ds_write_b64 v74, v[56:57]
  v_mov_b32 v64, v60
  v_mov_b32 v65, v61
  v_mov_b32 v66, v62
  v_mov_b32 v67, v63
  v_permlane32_swap_b32 v60, v64
  v_permlane32_swap_b32 v61, v65
  v_permlane32_swap_b32 v62, v66
  v_permlane32_swap_b32 v63, v67
  v_add_f32 v60, v60, v64
  v_add_f32 v61, v61, v65
  v_add_f32 v62, v62, v66
  v_add_f32 v63, v63, v67
  v_cvt_pk_bf16_f32 v64, v60, v61
  v_cvt_pk_bf16_f32 v65, v62, v63
  v_min_u32 v64, -2, v64
  v_min_u32 v65, -2, v65
  ds_write_b64 v75, v[64:65]
  s_waitcnt lgkmcnt(0)
  ds_read_b128 v[64:67], v76
  ds_read_b128 v[68:71], v76 offset:1024
  s_waitcnt lgkmcnt(0)
  buffer_store_dwordx4 v[64:67], v2, s[8:11], s25 offen sc1
  buffer_store_dwordx4 v[68:71], v2, s[8:11], s25 offen offset:1024 sc1
  s_add_u32 s24, s24, 14336
  s_add_u32 s25, s25, 16384
  s_add_u32 s26, s26, 32
  s_add_u32 s17, s17, 2
  s_cmp_ge_u32 s17, 64
  s_cbranch_scc1 ws_end
ws_arm:
  buffer_store_dwordx4 v[92:95], v2, s[8:11], s25 offen sc1
  buffer_store_dwordx4 v[92:95], v2, s[8:11], s25 offen offset:1024 sc1
  s_waitcnt vmcnt(0)
  s_mov_b64 exec, 1
  buffer_store_dword v78, v2, s[8:11], s26 offen sc1
  s_mov_b64 exec, -1
  s_branch ws_loop
ws_end:
  v_mov_b32 v250, 0
  s_branch wk_loop
wk_s4d:
  s_sub_u32 s3, s3, 640
  s_load_dwordx8 s[40:47], s[0:1], 0
  s_load_dwordx4 s[48:51], s[0:1], 32
  s_load_dwordx2 s[52:53], s[0:1], 48
  s_load_dwordx2 s[54:55], s[0:1], 112
  v_lshrrev_b32 v1, 6, v0
  s_nop 0
  v_readfirstlane_b32 s16, v1
  v_and_b32 v1, 63, v0
  v_lshrrev_b32 v3, 4, v1
  v_and_b32 v4, 15, v1
  s_mul_i32 s17, s16, 24576
  s_waitcnt lgkmcnt(0)
  s_mov_b32 s60, s40
  s_and_b32 s61, s41, 0xffff
  s_mov_b32 s62, 1835008
  s_mov_b32 s63, 0x20000
  s_mov_b32 s64, s42
  s_and_b32 s65, s43, 0xffff
  s_mov_b32 s66, 229376
  s_mov_b32 s67, 0x20000
  s_mov_b32 s68, s44
  s_and_b32 s69, s45, 0xffff
  s_mov_b32 s70, 229376
  s_mov_b32 s71, 0x20000
  s_mov_b32 s72, s46
  s_and_b32 s73, s47, 0xffff
  s_mov_b32 s74, 229376
  s_mov_b32 s75, 0x20000
  s_mov_b32 s76, s48
  s_and_b32 s77, s49, 0xffff
  s_mov_b32 s78, 229376
  s_mov_b32 s79, 0x20000
  s_mov_b32 s80, s50
  s_and_b32 s81, s51, 0xffff
  s_mov_b32 s82, 896
  s_mov_b32 s83, 0x20000
  s_mov_b32 s84, s52
  s_and_b32 s85, s53, 0xffff
  s_mov_b32 s86, 896
  s_mov_b32 s87, 0x20000
  s_mov_b32 s88, s54
  s_and_b32 s89, s55, 0xffff
  s_mov_b32 s90, 3670016
  s_mov_b32 s91, 0x20000
  v_lshlrev_b32 v5, 5, v1
  v_sub_u32 v5, 2047, v5
  s_add_u32 s18, s17, 13056
  v_subrev_u32 v6, 0, v5
  v_max_i32 v7, 0, v6
  v_cvt_f32_u32 v7, v7
  v_cvt_pk_bf16_f32 v8, v7, v7
  v_and_b32 v7, 0xffff0000, v8
  v_lshrrev_b32 v8, 23, v7
  v_subrev_u32 v8, 134, v8
  v_max_i32 v8, 0, v8
  v_cvt_u32_f32 v7, v7
  v_lshrrev_b32 v7, v8, v7
  v_lshl_add_u32 v7, v8, 8, v7
  v_lshl_add_u32 v200, v7, 2, s18
  v_subrev_u32 v6, 1, v5
  v_max_i32 v7, 0, v6
  v_cvt_f32_u32 v7, v7
  v_cvt_pk_bf16_f32 v8, v7, v7
  v_and_b32 v7, 0xffff0000, v8
  v_lshrrev_b32 v8, 23, v7
  v_subrev_u32 v8, 134, v8
  v_max_i32 v8, 0, v8
  v_cvt_u32_f32 v7, v7
  v_lshrrev_b32 v7, v8, v7
  v_lshl_add_u32 v7, v8, 8, v7
  v_lshl_add_u32 v201, v7, 2, s18
  v_subrev_u32 v6, 2, v5
  v_max_i32 v7, 0, v6
  v_cvt_f32_u32 v7, v7
  v_cvt_pk_bf16_f32 v8, v7, v7
  v_and_b32 v7, 0xffff0000, v8
  v_lshrrev_b32 v8, 23, v7
  v_subrev_u32 v8, 134, v8
  v_max_i32 v8, 0, v8
  v_cvt_u32_f32 v7, v7
  v_lshrrev_b32 v7, v8, v7
  v_lshl_add_u32 v7, v8, 8, v7
  v_lshl_add_u32 v202, v7, 2, s18
  v_subrev_u32 v6, 3, v5
  v_max_i32 v7, 0, v6
  v_cvt_f32_u32 v7, v7
  v_cvt_pk_bf16_f32 v8, v7, v7
  v_and_b32 v7, 0xffff0000, v8
  v_lshrrev_b32 v8, 23, v7
  v_subrev_u32 v8, 134, v8
  v_max_i32 v8, 0, v8
  v_cvt_u32_f32 v7, v7
  v_lshrrev_b32 v7, v8, v7
  v_lshl_add_u32 v7, v8, 8, v7
  v_lshl_add_u32 v203, v7, 2, s18
  v_subrev_u32 v6, 4, v5
  v_max_i32 v7, 0, v6
  v_cvt_f32_u32 v7, v7
  v_cvt_pk_bf16_f32 v8, v7, v7
  v_and_b32 v7, 0xffff0000, v8
  v_lshrrev_b32 v8, 23, v7
  v_subrev_u32 v8, 134, v8
  v_max_i32 v8, 0, v8
  v_cvt_u32_f32 v7, v7
  v_lshrrev_b32 v7, v8, v7
  v_lshl_add_u32 v7, v8, 8, v7
  v_lshl_add_u32 v204, v7, 2, s18
  v_subrev_u32 v6, 5, v5
  v_max_i32 v7, 0, v6
  v_cvt_f32_u32 v7, v7
  v_cvt_pk_bf16_f32 v8, v7, v7
  v_and_b32 v7, 0xffff0000, v8
  v_lshrrev_b32 v8, 23, v7
  v_subrev_u32 v8, 134, v8
  v_max_i32 v8, 0, v8
  v_cvt_u32_f32 v7, v7
  v_lshrrev_b32 v7, v8, v7
  v_lshl_add_u32 v7, v8, 8, v7
  v_lshl_add_u32 v205, v7, 2, s18
  v_subrev_u32 v6, 6, v5
  v_max_i32 v7, 0, v6
  v_cvt_f32_u32 v7, v7
  v_cvt_pk_bf16_f32 v8, v7, v7
  v_and_b32 v7, 0xffff0000, v8
  v_lshrrev_b32 v8, 23, v7
  v_subrev_u32 v8, 134, v8
  v_max_i32 v8, 0, v8
  v_cvt_u32_f32 v7, v7
  v_lshrrev_b32 v7, v8, v7
  v_lshl_add_u32 v7, v8, 8, v7
  v_lshl_add_u32 v206, v7, 2, s18
  v_subrev_u32 v6, 7, v5
  v_max_i32 v7, 0, v6
  v_cvt_f32_u32 v7, v7
  v_cvt_pk_bf16_f32 v8, v7, v7
  v_and_b32 v7, 0xffff0000, v8
  v_lshrrev_b32 v8, 23, v7
  v_subrev_u32 v8, 134, v8
  v_max_i32 v8, 0, v8
  v_cvt_u32_f32 v7, v7
  v_lshrrev_b32 v7, v8, v7
  v_lshl_add_u32 v7, v8, 8, v7
  v_lshl_add_u32 v207, v7, 2, s18
  v_subrev_u32 v6, 8, v5
  v_max_i32 v7, 0, v6
  v_cvt_f32_u32 v7, v7
  v_cvt_pk_bf16_f32 v8, v7, v7
  v_and_b32 v7, 0xffff0000, v8
  v_lshrrev_b32 v8, 23, v7
  v_subrev_u32 v8, 134, v8
  v_max_i32 v8, 0, v8
  v_cvt_u32_f32 v7, v7
  v_lshrrev_b32 v7, v8, v7
  v_lshl_add_u32 v7, v8, 8, v7
  v_lshl_add_u32 v208, v7, 2, s18
  v_subrev_u32 v6, 9, v5
  v_max_i32 v7, 0, v6
  v_cvt_f32_u32 v7, v7
  v_cvt_pk_bf16_f32 v8, v7, v7
  v_and_b32 v7, 0xffff0000, v8
  v_lshrrev_b32 v8, 23, v7
  v_subrev_u32 v8, 134, v8
  v_max_i32 v8, 0, v8
  v_cvt_u32_f32 v7, v7
  v_lshrrev_b32 v7, v8, v7
  v_lshl_add_u32 v7, v8, 8, v7
  v_lshl_add_u32 v209, v7, 2, s18
  v_subrev_u32 v6, 10, v5
  v_max_i32 v7, 0, v6
  v_cvt_f32_u32 v7, v7
  v_cvt_pk_bf16_f32 v8, v7, v7
  v_and_b32 v7, 0xffff0000, v8
  v_lshrrev_b32 v8, 23, v7
  v_subrev_u32 v8, 134, v8
  v_max_i32 v8, 0, v8
  v_cvt_u32_f32 v7, v7
  v_lshrrev_b32 v7, v8, v7
  v_lshl_add_u32 v7, v8, 8, v7
  v_lshl_add_u32 v210, v7, 2, s18
  v_subrev_u32 v6, 11, v5
  v_max_i32 v7, 0, v6
  v_cvt_f32_u32 v7, v7
  v_cvt_pk_bf16_f32 v8, v7, v7
  v_and_b32 v7, 0xffff0000, v8
  v_lshrrev_b32 v8, 23, v7
  v_subrev_u32 v8, 134, v8
  v_max_i32 v8, 0, v8
  v_cvt_u32_f32 v7, v7
  v_lshrrev_b32 v7, v8, v7
  v_lshl_add_u32 v7, v8, 8, v7
  v_lshl_add_u32 v211, v7, 2, s18
  v_subrev_u32 v6, 12, v5
  v_max_i32 v7, 0, v6
  v_cvt_f32_u32 v7, v7
  v_cvt_pk_bf16_f32 v8, v7, v7
  v_and_b32 v7, 0xffff0000, v8
  v_lshrrev_b32 v8, 23, v7
  v_subrev_u32 v8, 134, v8
  v_max_i32 v8, 0, v8
  v_cvt_u32_f32 v7, v7
  v_lshrrev_b32 v7, v8, v7
  v_lshl_add_u32 v7, v8, 8, v7
  v_lshl_add_u32 v212, v7, 2, s18
  v_subrev_u32 v6, 13, v5
  v_max_i32 v7, 0, v6
  v_cvt_f32_u32 v7, v7
  v_cvt_pk_bf16_f32 v8, v7, v7
  v_and_b32 v7, 0xffff0000, v8
  v_lshrrev_b32 v8, 23, v7
  v_subrev_u32 v8, 134, v8
  v_max_i32 v8, 0, v8
  v_cvt_u32_f32 v7, v7
  v_lshrrev_b32 v7, v8, v7
  v_lshl_add_u32 v7, v8, 8, v7
  v_lshl_add_u32 v213, v7, 2, s18
  v_subrev_u32 v6, 14, v5
  v_max_i32 v7, 0, v6
  v_cvt_f32_u32 v7, v7
  v_cvt_pk_bf16_f32 v8, v7, v7
  v_and_b32 v7, 0xffff0000, v8
  v_lshrrev_b32 v8, 23, v7
  v_subrev_u32 v8, 134, v8
  v_max_i32 v8, 0, v8
  v_cvt_u32_f32 v7, v7
  v_lshrrev_b32 v7, v8, v7
  v_lshl_add_u32 v7, v8, 8, v7
  v_lshl_add_u32 v214, v7, 2, s18
  v_subrev_u32 v6, 15, v5
  v_max_i32 v7, 0, v6
  v_cvt_f32_u32 v7, v7
  v_cvt_pk_bf16_f32 v8, v7, v7
  v_and_b32 v7, 0xffff0000, v8
  v_lshrrev_b32 v8, 23, v7
  v_subrev_u32 v8, 134, v8
  v_max_i32 v8, 0, v8
  v_cvt_u32_f32 v7, v7
  v_lshrrev_b32 v7, v8, v7
  v_lshl_add_u32 v7, v8, 8, v7
  v_lshl_add_u32 v215, v7, 2, s18
  v_subrev_u32 v6, 16, v5
  v_max_i32 v7, 0, v6
  v_cvt_f32_u32 v7, v7
  v_cvt_pk_bf16_f32 v8, v7, v7
  v_and_b32 v7, 0xffff0000, v8
  v_lshrrev_b32 v8, 23, v7
  v_subrev_u32 v8, 134, v8
  v_max_i32 v8, 0, v8
  v_cvt_u32_f32 v7, v7
  v_lshrrev_b32 v7, v8, v7
  v_lshl_add_u32 v7, v8, 8, v7
  v_lshl_add_u32 v216, v7, 2, s18
  v_subrev_u32 v6, 17, v5
  v_max_i32 v7, 0, v6
  v_cvt_f32_u32 v7, v7
  v_cvt_pk_bf16_f32 v8, v7, v7
  v_and_b32 v7, 0xffff0000, v8
  v_lshrrev_b32 v8, 23, v7
  v_subrev_u32 v8, 134, v8
  v_max_i32 v8, 0, v8
  v_cvt_u32_f32 v7, v7
  v_lshrrev_b32 v7, v8, v7
  v_lshl_add_u32 v7, v8, 8, v7
  v_lshl_add_u32 v217, v7, 2, s18
  v_subrev_u32 v6, 18, v5
  v_max_i32 v7, 0, v6
  v_cvt_f32_u32 v7, v7
  v_cvt_pk_bf16_f32 v8, v7, v7
  v_and_b32 v7, 0xffff0000, v8
  v_lshrrev_b32 v8, 23, v7
  v_subrev_u32 v8, 134, v8
  v_max_i32 v8, 0, v8
  v_cvt_u32_f32 v7, v7
  v_lshrrev_b32 v7, v8, v7
  v_lshl_add_u32 v7, v8, 8, v7
  v_lshl_add_u32 v218, v7, 2, s18
  v_subrev_u32 v6, 19, v5
  v_max_i32 v7, 0, v6
  v_cvt_f32_u32 v7, v7
  v_cvt_pk_bf16_f32 v8, v7, v7
  v_and_b32 v7, 0xffff0000, v8
  v_lshrrev_b32 v8, 23, v7
  v_subrev_u32 v8, 134, v8
  v_max_i32 v8, 0, v8
  v_cvt_u32_f32 v7, v7
  v_lshrrev_b32 v7, v8, v7
  v_lshl_add_u32 v7, v8, 8, v7
  v_lshl_add_u32 v219, v7, 2, s18
  v_subrev_u32 v6, 20, v5
  v_max_i32 v7, 0, v6
  v_cvt_f32_u32 v7, v7
  v_cvt_pk_bf16_f32 v8, v7, v7
  v_and_b32 v7, 0xffff0000, v8
  v_lshrrev_b32 v8, 23, v7
  v_subrev_u32 v8, 134, v8
  v_max_i32 v8, 0, v8
  v_cvt_u32_f32 v7, v7
  v_lshrrev_b32 v7, v8, v7
  v_lshl_add_u32 v7, v8, 8, v7
  v_lshl_add_u32 v220, v7, 2, s18
  v_subrev_u32 v6, 21, v5
  v_max_i32 v7, 0, v6
  v_cvt_f32_u32 v7, v7
  v_cvt_pk_bf16_f32 v8, v7, v7
  v_and_b32 v7, 0xffff0000, v8
  v_lshrrev_b32 v8, 23, v7
  v_subrev_u32 v8, 134, v8
  v_max_i32 v8, 0, v8
  v_cvt_u32_f32 v7, v7
  v_lshrrev_b32 v7, v8, v7
  v_lshl_add_u32 v7, v8, 8, v7
  v_lshl_add_u32 v221, v7, 2, s18
  v_subrev_u32 v6, 22, v5
  v_max_i32 v7, 0, v6
  v_cvt_f32_u32 v7, v7
  v_cvt_pk_bf16_f32 v8, v7, v7
  v_and_b32 v7, 0xffff0000, v8
  v_lshrrev_b32 v8, 23, v7
  v_subrev_u32 v8, 134, v8
  v_max_i32 v8, 0, v8
  v_cvt_u32_f32 v7, v7
  v_lshrrev_b32 v7, v8, v7
  v_lshl_add_u32 v7, v8, 8, v7
  v_lshl_add_u32 v222, v7, 2, s18
  v_subrev_u32 v6, 23, v5
  v_max_i32 v7, 0, v6
  v_cvt_f32_u32 v7, v7
  v_cvt_pk_bf16_f32 v8, v7, v7
  v_and_b32 v7, 0xffff0000, v8
  v_lshrrev_b32 v8, 23, v7
  v_subrev_u32 v8, 134, v8
  v_max_i32 v8, 0, v8
  v_cvt_u32_f32 v7, v7
  v_lshrrev_b32 v7, v8, v7
  v_lshl_add_u32 v7, v8, 8, v7
  v_lshl_add_u32 v223, v7, 2, s18
  v_subrev_u32 v6, 24, v5
  v_max_i32 v7, 0, v6
  v_cvt_f32_u32 v7, v7
  v_cvt_pk_bf16_f32 v8, v7, v7
  v_and_b32 v7, 0xffff0000, v8
  v_lshrrev_b32 v8, 23, v7
  v_subrev_u32 v8, 134, v8
  v_max_i32 v8, 0, v8
  v_cvt_u32_f32 v7, v7
  v_lshrrev_b32 v7, v8, v7
  v_lshl_add_u32 v7, v8, 8, v7
  v_lshl_add_u32 v224, v7, 2, s18
  v_subrev_u32 v6, 25, v5
  v_max_i32 v7, 0, v6
  v_cvt_f32_u32 v7, v7
  v_cvt_pk_bf16_f32 v8, v7, v7
  v_and_b32 v7, 0xffff0000, v8
  v_lshrrev_b32 v8, 23, v7
  v_subrev_u32 v8, 134, v8
  v_max_i32 v8, 0, v8
  v_cvt_u32_f32 v7, v7
  v_lshrrev_b32 v7, v8, v7
  v_lshl_add_u32 v7, v8, 8, v7
  v_lshl_add_u32 v225, v7, 2, s18
  v_subrev_u32 v6, 26, v5
  v_max_i32 v7, 0, v6
  v_cvt_f32_u32 v7, v7
  v_cvt_pk_bf16_f32 v8, v7, v7
  v_and_b32 v7, 0xffff0000, v8
  v_lshrrev_b32 v8, 23, v7
  v_subrev_u32 v8, 134, v8
  v_max_i32 v8, 0, v8
  v_cvt_u32_f32 v7, v7
  v_lshrrev_b32 v7, v8, v7
  v_lshl_add_u32 v7, v8, 8, v7
  v_lshl_add_u32 v226, v7, 2, s18
  v_subrev_u32 v6, 27, v5
  v_max_i32 v7, 0, v6
  v_cvt_f32_u32 v7, v7
  v_cvt_pk_bf16_f32 v8, v7, v7
  v_and_b32 v7, 0xffff0000, v8
  v_lshrrev_b32 v8, 23, v7
  v_subrev_u32 v8, 134, v8
  v_max_i32 v8, 0, v8
  v_cvt_u32_f32 v7, v7
  v_lshrrev_b32 v7, v8, v7
  v_lshl_add_u32 v7, v8, 8, v7
  v_lshl_add_u32 v227, v7, 2, s18
  v_subrev_u32 v6, 28, v5
  v_max_i32 v7, 0, v6
  v_cvt_f32_u32 v7, v7
  v_cvt_pk_bf16_f32 v8, v7, v7
  v_and_b32 v7, 0xffff0000, v8
  v_lshrrev_b32 v8, 23, v7
  v_subrev_u32 v8, 134, v8
  v_max_i32 v8, 0, v8
  v_cvt_u32_f32 v7, v7
  v_lshrrev_b32 v7, v8, v7
  v_lshl_add_u32 v7, v8, 8, v7
  v_lshl_add_u32 v228, v7, 2, s18
  v_subrev_u32 v6, 29, v5
  v_max_i32 v7, 0, v6
  v_cvt_f32_u32 v7, v7
  v_cvt_pk_bf16_f32 v8, v7, v7
  v_and_b32 v7, 0xffff0000, v8
  v_lshrrev_b32 v8, 23, v7
  v_subrev_u32 v8, 134, v8
  v_max_i32 v8, 0, v8
  v_cvt_u32_f32 v7, v7
  v_lshrrev_b32 v7, v8, v7
  v_lshl_add_u32 v7, v8, 8, v7
  v_lshl_add_u32 v229, v7, 2, s18
  v_subrev_u32 v6, 30, v5
  v_max_i32 v7, 0, v6
  v_cvt_f32_u32 v7, v7
  v_cvt_pk_bf16_f32 v8, v7, v7
  v_and_b32 v7, 0xffff0000, v8
  v_lshrrev_b32 v8, 23, v7
  v_subrev_u32 v8, 134, v8
  v_max_i32 v8, 0, v8
  v_cvt_u32_f32 v7, v7
  v_lshrrev_b32 v7, v8, v7
  v_lshl_add_u32 v7, v8, 8, v7
  v_lshl_add_u32 v230, v7, 2, s18
  v_subrev_u32 v6, 31, v5
  v_max_i32 v7, 0, v6
  v_cvt_f32_u32 v7, v7
  v_cvt_pk_bf16_f32 v8, v7, v7
  v_and_b32 v7, 0xffff0000, v8
  v_lshrrev_b32 v8, 23, v7
  v_subrev_u32 v8, 134, v8
  v_max_i32 v8, 0, v8
  v_cvt_u32_f32 v7, v7
  v_lshrrev_b32 v7, v8, v7
  v_lshl_add_u32 v7, v8, 8, v7
  v_lshl_add_u32 v231, v7, 2, s18
  v_subrev_u32 v6, 32, v5
  v_max_i32 v7, 0, v6
  v_cvt_f32_u32 v7, v7
  v_cvt_pk_bf16_f32 v8, v7, v7
  v_and_b32 v7, 0xffff0000, v8
  v_lshrrev_b32 v8, 23, v7
  v_subrev_u32 v8, 134, v8
  v_max_i32 v8, 0, v8
  v_cvt_u32_f32 v7, v7
  v_lshrrev_b32 v7, v8, v7
  v_lshl_add_u32 v7, v8, 8, v7
  v_mov_b32 v8, 1280
  v_cmp_gt_i32 vcc, 0, v6
  s_nop 1
  v_cndmask_b32 v7, v7, v8, vcc
  v_lshl_add_u32 v232, v7, 2, s18
  v_mov_b32 v8, 0
  v_mov_b32 v9, 0
  v_lshlrev_b32 v5, 3, v1
  v_add_u32 v5, s17, v5
  ds_write_b64 v5, v[8:9]
  v_and_b32 v6, 15, v1
  v_lshlrev_b32 v6, 3, v6
  v_add_u32 v6, s17, v6
  ds_write_b64 v6, v[8:9] offset:8704
  ds_write_b64 v6, v[8:9] offset:12928
  v_mov_b32 v6, s17
  ds_write_b64 v6, v[8:9] offset:18176
  s_lshl_b32 s19, s3, 2
  s_add_u32 s20, s19, s16
  s_lshl_b32 s21, s3, 3
  v_mul_u32_u24 v5, 3584, v0
  s_add_u32 s22, s21, 0
  buffer_load_dwordx2 v[8:9], v5, s[60:63], s22 offen offset:0
  buffer_load_dwordx2 v[10:11], v5, s[60:63], s22 offen offset:896
  buffer_load_dwordx2 v[12:13], v5, s[60:63], s22 offen offset:1792
  buffer_load_dwordx2 v[14:15], v5, s[60:63], s22 offen offset:2688
  s_add_u32 s22, s21, 917504
  buffer_load_dwordx2 v[16:17], v5, s[60:63], s22 offen offset:0
  buffer_load_dwordx2 v[18:19], v5, s[60:63], s22 offen offset:896
  buffer_load_dwordx2 v[20:21], v5, s[60:63], s22 offen offset:1792
  buffer_load_dwordx2 v[22:23], v5, s[60:63], s22 offen offset:2688
  s_lshl_b32 s22, s20, 9
  v_lshlrev_b32 v6, 3, v1
  buffer_load_dwordx2 v[24:25], v6, s[64:67], s22 offen
  buffer_load_dwordx2 v[26:27], v6, s[68:71], s22 offen
  buffer_load_dwordx2 v[28:29], v6, s[72:75], s22 offen
  buffer_load_dwordx2 v[30:31], v6, s[76:79], s22 offen
  s_lshl_b32 s22, s20, 1
  v_mov_b32 v7, 0
  buffer_load_ushort v32, v7, s[80:83], s22 offen
  buffer_load_ushort v33, v7, s[84:87], s22 offen
  s_mov_b32 s24, 0x05040100
  s_mov_b32 s25, 0x07060302
  s_barrier
  s_waitcnt vmcnt(6)
  v_lshlrev_b32 v6, 3, v0
  v_perm_b32 v34, v10, v8, s24
  v_perm_b32 v35, v14, v12, s24
  v_add_u32 v36, 512, v6
  ds_write_b64 v36, v[34:35]
  v_perm_b32 v34, v10, v8, s25
  v_perm_b32 v35, v14, v12, s25
  v_add_u32 v36, 25088, v6
  ds_write_b64 v36, v[34:35]
  v_perm_b32 v34, v11, v9, s24
  v_perm_b32 v35, v15, v13, s24
  v_add_u32 v36, 49664, v6
  ds_write_b64 v36, v[34:35]
  v_perm_b32 v34, v11, v9, s25
  v_perm_b32 v35, v15, v13, s25
  v_add_u32 v36, 74240, v6
  ds_write_b64 v36, v[34:35]
  v_perm_b32 v34, v18, v16, s24
  v_perm_b32 v35, v22, v20, s24
  v_add_u32 v36, 2560, v6
  ds_write_b64 v36, v[34:35]
  v_perm_b32 v34, v18, v16, s25
  v_perm_b32 v35, v22, v20, s25
  v_add_u32 v36, 27136, v6
  ds_write_b64 v36, v[34:35]
  v_perm_b32 v34, v19, v17, s24
  v_perm_b32 v35, v23, v21, s24
  v_add_u32 v36, 51712, v6
  ds_write_b64 v36, v[34:35]
  v_perm_b32 v34, v19, v17, s25
  v_perm_b32 v35, v23, v21, s25
  v_add_u32 v36, 76288, v6
  ds_write_b64 v36, v[34:35]
  s_waitcnt vmcnt(0)
  s_mov_b32 s26, 1069066811
  s_mov_b32 s27, 1042479491
  v_lshlrev_b32 v32, 16, v32
  v_lshlrev_b32 v33, 16, v33
  v_mul_f32 v32, s26, v32
  v_exp_f32 v32, v32
  s_nop 0
  v_cvt_pk_bf16_f32 v34, v32, v32
  v_and_b32 v32, 0xffff0000, v34
  v_lshlrev_b32 v37, 6, v1
  v_add_u32 v37, s17, v37
  v_lshlrev_b32 v40, 16, v24
  v_lshlrev_b32 v41, 16, v26
  v_lshlrev_b32 v42, 16, v28
  v_lshlrev_b32 v43, 16, v30
  v_mul_f32 v40, s26, v40
  v_exp_f32 v40, v40
  s_nop 0
  v_cvt_pk_bf16_f32 v34, v40, v40
  v_and_b32 v40, 0xffff0000, v34
  v_mul_f32 v40, v40, v32
  v_mul_f32 v40, s26, v40
  v_sub_f32 v40, 0, v40
  v_mul_f32 v41, v41, v32
  v_mul_f32 v41, s27, v41
  v_mul_f32 v42, v42, v32
  v_mul_f32 v43, v43, v32
  v_add_f32 v42, v42, v42
  v_add_f32 v43, v43, v43
  ds_write_b128 v37, v[40:43] offset:18240
  v_and_b32 v40, 0xffff0000, v24
  v_and_b32 v41, 0xffff0000, v26
  v_and_b32 v42, 0xffff0000, v28
  v_and_b32 v43, 0xffff0000, v30
  v_mul_f32 v40, s26, v40
  v_exp_f32 v40, v40
  s_nop 0
  v_cvt_pk_bf16_f32 v34, v40, v40
  v_and_b32 v40, 0xffff0000, v34
  v_mul_f32 v40, v40, v32
  v_mul_f32 v40, s26, v40
  v_sub_f32 v40, 0, v40
  v_mul_f32 v41, v41, v32
  v_mul_f32 v41, s27, v41
  v_mul_f32 v42, v42, v32
  v_mul_f32 v43, v43, v32
  v_add_f32 v42, v42, v42
  v_add_f32 v43, v43, v43
  ds_write_b128 v37, v[40:43] offset:18256
  v_lshlrev_b32 v40, 16, v25
  v_lshlrev_b32 v41, 16, v27
  v_lshlrev_b32 v42, 16, v29
  v_lshlrev_b32 v43, 16, v31
  v_mul_f32 v40, s26, v40
  v_exp_f32 v40, v40
  s_nop 0
  v_cvt_pk_bf16_f32 v34, v40, v40
  v_and_b32 v40, 0xffff0000, v34
  v_mul_f32 v40, v40, v32
  v_mul_f32 v40, s26, v40
  v_sub_f32 v40, 0, v40
  v_mul_f32 v41, v41, v32
  v_mul_f32 v41, s27, v41
  v_mul_f32 v42, v42, v32
  v_mul_f32 v43, v43, v32
  v_add_f32 v42, v42, v42
  v_add_f32 v43, v43, v43
  ds_write_b128 v37, v[40:43] offset:18272
  v_and_b32 v40, 0xffff0000, v25
  v_and_b32 v41, 0xffff0000, v27
  v_and_b32 v42, 0xffff0000, v29
  v_and_b32 v43, 0xffff0000, v31
  v_mul_f32 v40, s26, v40
  v_exp_f32 v40, v40
  s_nop 0
  v_cvt_pk_bf16_f32 v34, v40, v40
  v_and_b32 v40, 0xffff0000, v34
  v_mul_f32 v40, v40, v32
  v_mul_f32 v40, s26, v40
  v_sub_f32 v40, 0, v40
  v_mul_f32 v41, v41, v32
  v_mul_f32 v41, s27, v41
  v_mul_f32 v42, v42, v32
  v_mul_f32 v43, v43, v32
  v_add_f32 v42, v42, v42
  v_add_f32 v43, v43, v43
  ds_write_b128 v37, v[40:43] offset:18288
  v_cvt_f32_u32 v44, v4
  v_lshlrev_b32 v45, 4, v4
  v_cvt_f32_u32 v45, v45
  v_lshlrev_b32 v46, 4, v3
  v_add_u32 v46, s17, v46
  v_mov_b32 v48, 0
  v_mov_b32 v49, 0
  v_mov_b32 v50, 0
  v_mov_b32 v51, 0
  v_mov_b32 v52, 0
  v_mov_b32 v53, 0
  v_mov_b32 v54, 0
  v_mov_b32 v55, 0
  v_mov_b32 v56, 0
  v_mov_b32 v57, 0
  v_mov_b32 v58, 0
  v_mov_b32 v59, 0
  v_mov_b32 v60, 0
  v_mov_b32 v61, 0
  v_mov_b32 v62, 0
  v_mov_b32 v63, 0
  v_mov_b32 v64, 0
  v_mov_b32 v65, 0
  v_mov_b32 v66, 0
  v_mov_b32 v67, 0
  s_mov_b32 s28, 0
  s_waitcnt lgkmcnt(0)
  ds_read_b128 v[68:71], v46 offset:18240
wk_kl:
  s_waitcnt lgkmcnt(0)
  v_mov_b32 v72, v68
  v_mov_b32 v73, v69
  v_mov_b32 v74, v70
  v_mov_b32 v75, v71
  v_add_u32 v46, 64, v46
  ds_read_b128 v[68:71], v46 offset:18240
  v_mul_f32 v80, v72, v45
  v_mul_f32 v81, v73, v45
  v_exp_f32 v80, v80
  v_fract_f32 v81, v81
  v_cos_f32 v76, v81
  v_sin_f32 v77, v81
  v_mul_f32 v76, v76, v80
  v_mul_f32 v77, v77, v80
  v_mul_f32 v80, v72, v44
  v_mul_f32 v81, v73, v44
  v_exp_f32 v80, v80
  v_fract_f32 v81, v81
  v_cos_f32 v78, v81
  v_sin_f32 v79, v81
  v_mul_f32 v78, v78, v80
  v_mul_f32 v79, v79, v80
  v_mul_f32 v82, v74, v76
  v_mul_f32 v83, v74, v77
  v_fma_f32 v82, -v75, v77, v82
  v_fma_f32 v83, -v75, v76, -v83
  v_mul_f32 v86, v76, v76
  v_mul_f32 v87, v76, v77
  v_fma_f32 v86, -v77, v77, v86
  v_add_f32 v87, v87, v87
  v_mfma_f32_16x16x4_f32 v[48:51], v82, v78, v[48:51]
  v_mul_f32 v88, v78, v78
  v_mul_f32 v89, v78, v79
  v_fma_f32 v88, -v79, v79, v88
  v_add_f32 v89, v89, v89
  v_mfma_f32_16x16x4_f32 v[48:51], v83, v79, v[48:51]
  v_mul_f32 v84, v74, v86
  v_mul_f32 v85, v74, v87
  v_fma_f32 v84, -v75, v87, v84
  v_fma_f32 v85, -v75, v86, -v85
  v_mul_f32 v76, v86, v86
  v_mul_f32 v77, v86, v87
  v_fma_f32 v76, -v87, v87, v76
  v_add_f32 v77, v77, v77
  v_mfma_f32_16x16x4_f32 v[52:55], v84, v88, v[52:55]
  v_mul_f32 v78, v88, v88
  v_mul_f32 v79, v88, v89
  v_fma_f32 v78, -v89, v89, v78
  v_add_f32 v79, v79, v79
  v_mfma_f32_16x16x4_f32 v[52:55], v85, v89, v[52:55]
  v_mul_f32 v82, v74, v76
  v_mul_f32 v83, v74, v77
  v_fma_f32 v82, -v75, v77, v82
  v_fma_f32 v83, -v75, v76, -v83
  v_mul_f32 v86, v76, v76
  v_mul_f32 v87, v76, v77
  v_fma_f32 v86, -v77, v77, v86
  v_add_f32 v87, v87, v87
  v_mfma_f32_16x16x4_f32 v[56:59], v82, v78, v[56:59]
  v_mul_f32 v88, v78, v78
  v_mul_f32 v89, v78, v79
  v_fma_f32 v88, -v79, v79, v88
  v_add_f32 v89, v89, v89
  v_mfma_f32_16x16x4_f32 v[56:59], v83, v79, v[56:59]
  v_mul_f32 v84, v74, v86
  v_mul_f32 v85, v74, v87
  v_fma_f32 v84, -v75, v87, v84
  v_fma_f32 v85, -v75, v86, -v85
  v_mul_f32 v76, v86, v86
  v_mul_f32 v77, v86, v87
  v_fma_f32 v76, -v87, v87, v76
  v_add_f32 v77, v77, v77
  v_mfma_f32_16x16x4_f32 v[60:63], v84, v88, v[60:63]
  v_mfma_f32_16x16x4_f32 v[60:63], v85, v89, v[60:63]
  v_mul_f32 v82, v74, v76
  v_fma_f32 v82, -v75, v77, v82
  s_nop 1
  v_mfma_f32_16x16x4_f32 v[64:67], v82, v88, v[64:67]
  s_add_u32 s28, s28, 1
  s_cmp_lt_u32 s28, 64
  s_cbranch_scc1 wk_kl
  s_nop 15
  s_nop 3
  v_lshlrev_b32 v46, 8, v3
  v_lshl_add_u32 v46, v4, 2, v46
  v_add_u32 v46, s17, v46
  ds_write_b32 v46, v48 offset:13056
  ds_write_b32 v46, v49 offset:13120
  ds_write_b32 v46, v50 offset:13184
  ds_write_b32 v46, v51 offset:13248
  s_waitcnt lgkmcnt(8)
  ds_write_b32 v46, v52 offset:14080
  ds_write_b32 v46, v53 offset:14144
  ds_write_b32 v46, v54 offset:14208
  ds_write_b32 v46, v55 offset:14272
  s_waitcnt lgkmcnt(8)
  ds_write_b32 v46, v56 offset:15104
  ds_write_b32 v46, v57 offset:15168
  ds_write_b32 v46, v58 offset:15232
  ds_write_b32 v46, v59 offset:15296
  s_waitcnt lgkmcnt(8)
  ds_write_b32 v46, v60 offset:16128
  ds_write_b32 v46, v61 offset:16192
  ds_write_b32 v46, v62 offset:16256
  ds_write_b32 v46, v63 offset:16320
  s_waitcnt lgkmcnt(8)
  ds_write_b32 v46, v64 offset:17152
  ds_write_b32 v46, v65 offset:17216
  ds_write_b32 v46, v66 offset:17280
  ds_write_b32 v46, v67 offset:17344
  s_waitcnt lgkmcnt(8)
  s_waitcnt lgkmcnt(0)
  ds_read_b32 v48, v200
  ds_read_b32 v49, v201
  ds_read_b32 v50, v202
  ds_read_b32 v51, v203
  ds_read_b32 v52, v204
  ds_read_b32 v53, v205
  ds_read_b32 v54, v206
  ds_read_b32 v55, v207
  s_waitcnt lgkmcnt(4)
  ds_read_b32 v56, v208
  ds_read_b32 v57, v209
  ds_read_b32 v58, v210
  ds_read_b32 v59, v211
  ds_read_b32 v60, v212
  ds_read_b32 v61, v213
  ds_read_b32 v62, v214
  ds_read_b32 v63, v215
  s_waitcnt lgkmcnt(4)
  ds_read_b32 v64, v216
  ds_read_b32 v65, v217
  ds_read_b32 v66, v218
  ds_read_b32 v67, v219
  ds_read_b32 v68, v220
  ds_read_b32 v69, v221
  ds_read_b32 v70, v222
  ds_read_b32 v71, v223
  s_waitcnt lgkmcnt(4)
  ds_read_b32 v72, v224
  ds_read_b32 v73, v225
  ds_read_b32 v74, v226
  ds_read_b32 v75, v227
  ds_read_b32 v76, v228
  ds_read_b32 v77, v229
  ds_read_b32 v78, v230
  ds_read_b32 v79, v231
  s_waitcnt lgkmcnt(4)
  ds_read_b32 v80, v232
  s_waitcnt lgkmcnt(0)
  v_lshlrev_b32 v46, 6, v1
  v_add_u32 v46, s17, v46
  v_cvt_pk_bf16_f32 v84, v48, v49
  v_cvt_pk_bf16_f32 v88, v49, v50
  v_cvt_pk_bf16_f32 v85, v50, v51
  v_cvt_pk_bf16_f32 v89, v51, v52
  v_cvt_pk_bf16_f32 v86, v52, v53
  v_cvt_pk_bf16_f32 v90, v53, v54
  v_cvt_pk_bf16_f32 v87, v54, v55
  v_cvt_pk_bf16_f32 v91, v55, v56
  ds_write_b128 v46, v[84:87] offset:4608
  ds_write_b128 v46, v[88:91] offset:8832
  s_waitcnt lgkmcnt(0)
  v_cvt_pk_bf16_f32 v84, v56, v57
  v_cvt_pk_bf16_f32 v88, v57, v58
  v_cvt_pk_bf16_f32 v85, v58, v59
  v_cvt_pk_bf16_f32 v89, v59, v60
  v_cvt_pk_bf16_f32 v86, v60, v61
  v_cvt_pk_bf16_f32 v90, v61, v62
  v_cvt_pk_bf16_f32 v87, v62, v63
  v_cvt_pk_bf16_f32 v91, v63, v64
  ds_write_b128 v46, v[84:87] offset:4624
  ds_write_b128 v46, v[88:91] offset:8848
  s_waitcnt lgkmcnt(0)
  v_cvt_pk_bf16_f32 v84, v64, v65
  v_cvt_pk_bf16_f32 v88, v65, v66
  v_cvt_pk_bf16_f32 v85, v66, v67
  v_cvt_pk_bf16_f32 v89, v67, v68
  v_cvt_pk_bf16_f32 v86, v68, v69
  v_cvt_pk_bf16_f32 v90, v69, v70
  v_cvt_pk_bf16_f32 v87, v70, v71
  v_cvt_pk_bf16_f32 v91, v71, v72
  ds_write_b128 v46, v[84:87] offset:4640
  ds_write_b128 v46, v[88:91] offset:8864
  s_waitcnt lgkmcnt(0)
  v_cvt_pk_bf16_f32 v84, v72, v73
  v_cvt_pk_bf16_f32 v88, v73, v74
  v_cvt_pk_bf16_f32 v85, v74, v75
  v_cvt_pk_bf16_f32 v89, v75, v76
  v_cvt_pk_bf16_f32 v86, v76, v77
  v_cvt_pk_bf16_f32 v90, v77, v78
  v_cvt_pk_bf16_f32 v87, v78, v79
  v_cvt_pk_bf16_f32 v91, v79, v80
  ds_write_b128 v46, v[84:87] offset:4656
  ds_write_b128 v46, v[88:91] offset:8880
  s_waitcnt lgkmcnt(0)
  s_barrier
  v_lshrrev_b32 v47, 1, v3
  v_sub_u32 v46, v4, v47
  v_add_u32 v46, 1, v46
  v_lshlrev_b32 v46, 5, v46
  v_and_b32 v48, 1, v3
  v_lshl_add_u32 v46, v48, 4, v46
  v_add_u32 v46, s17, v46
  ds_read_b128 a[0:3], v46 offset:32
  ds_read_b128 a[4:7], v46 offset:96
  ds_read_b128 a[8:11], v46 offset:160
  ds_read_b128 a[12:15], v46 offset:224
  ds_read_b128 a[16:19], v46 offset:288
  ds_read_b128 a[20:23], v46 offset:352
  ds_read_b128 a[24:27], v46 offset:416
  ds_read_b128 a[28:31], v46 offset:480
  s_waitcnt lgkmcnt(4)
  ds_read_b128 a[32:35], v46 offset:544
  ds_read_b128 a[36:39], v46 offset:608
  ds_read_b128 a[40:43], v46 offset:672
  ds_read_b128 a[44:47], v46 offset:736
  ds_read_b128 a[48:51], v46 offset:800
  ds_read_b128 a[52:55], v46 offset:864
  ds_read_b128 a[56:59], v46 offset:928
  ds_read_b128 a[60:63], v46 offset:992
  s_waitcnt lgkmcnt(4)
  ds_read_b128 a[64:67], v46 offset:1056
  ds_read_b128 a[68:71], v46 offset:1120
  ds_read_b128 a[72:75], v46 offset:1184
  ds_read_b128 a[76:79], v46 offset:1248
  ds_read_b128 a[80:83], v46 offset:1312
  ds_read_b128 a[84:87], v46 offset:1376
  ds_read_b128 a[88:91], v46 offset:1440
  ds_read_b128 a[92:95], v46 offset:1504
  s_waitcnt lgkmcnt(4)
  ds_read_b128 a[96:99], v46 offset:1568
  ds_read_b128 a[100:103], v46 offset:1632
  ds_read_b128 a[104:107], v46 offset:1696
  ds_read_b128 a[108:111], v46 offset:1760
  ds_read_b128 a[112:115], v46 offset:1824
  ds_read_b128 a[116:119], v46 offset:1888
  ds_read_b128 a[120:123], v46 offset:1952
  ds_read_b128 a[124:127], v46 offset:2016
  s_waitcnt lgkmcnt(4)
  ds_read_b128 a[128:131], v46 offset:2080
  ds_read_b128 a[132:135], v46 offset:2144
  ds_read_b128 a[136:139], v46 offset:2208
  ds_read_b128 a[140:143], v46 offset:2272
  ds_read_b128 a[144:147], v46 offset:2336
  ds_read_b128 a[148:151], v46 offset:2400
  ds_read_b128 a[152:155], v46 offset:2464
  ds_read_b128 a[156:159], v46 offset:2528
  s_waitcnt lgkmcnt(4)
  ds_read_b128 a[160:163], v46 offset:2592
  ds_read_b128 a[164:167], v46 offset:2656
  ds_read_b128 a[168:171], v46 offset:2720
  ds_read_b128 a[172:175], v46 offset:2784
  ds_read_b128 a[176:179], v46 offset:2848
  ds_read_b128 a[180:183], v46 offset:2912
  ds_read_b128 a[184:187], v46 offset:2976
  ds_read_b128 a[188:191], v46 offset:3040
  s_waitcnt lgkmcnt(4)
  ds_read_b128 a[192:195], v46 offset:3104
  ds_read_b128 a[196:199], v46 offset:3168
  ds_read_b128 a[200:203], v46 offset:3232
  ds_read_b128 a[204:207], v46 offset:3296
  ds_read_b128 a[208:211], v46 offset:3360
  ds_read_b128 a[212:215], v46 offset:3424
  ds_read_b128 a[216:219], v46 offset:3488
  ds_read_b128 a[220:223], v46 offset:3552
  s_waitcnt lgkmcnt(4)
  ds_read_b128 a[224:227], v46 offset:3616
  ds_read_b128 a[228:231], v46 offset:3680
  ds_read_b128 a[232:235], v46 offset:3744
  ds_read_b128 a[236:239], v46 offset:3808
  ds_read_b128 a[240:243], v46 offset:3872
  ds_read_b128 a[244:247], v46 offset:3936
  ds_read_b128 a[248:251], v46 offset:4000
  ds_read_b128 a[252:255], v46 offset:4064
  s_waitcnt lgkmcnt(4)
  v_lshlrev_b32 v49, 4, v47
  v_add_u32 v49, v49, v4
  v_sub_u32 v49, 2047, v49
  v_lshl_add_u32 v49, v48, 3, v49
  v_and_b32 v50, 1, v49
  v_lshrrev_b32 v49, 1, v49
  v_lshlrev_b32 v49, 2, v49
  v_mul_u32_u24 v50, 4224, v50
  v_add3_u32 v49, v49, v50, s17
  v_add_u32 v49, 4608, v49
  v_subrev_u32 v52, 896, v49
  v_subrev_u32 v53, 1856, v49
  v_subrev_u32 v54, 2816, v49
  v_subrev_u32 v55, 3776, v49
  v_subrev_u32 v56, 4736, v49
  s_waitcnt lgkmcnt(0)
  ds_read2_b32 v[92:93], v52 offset0:224 offset1:225
  ds_read2_b32 v[94:95], v52 offset0:226 offset1:227
  ds_read2_b32 v[96:97], v52 offset0:208 offset1:209
  ds_read2_b32 v[98:99], v52 offset0:210 offset1:211
  ds_read2_b32 v[100:101], v52 offset0:192 offset1:193
  ds_read2_b32 v[102:103], v52 offset0:194 offset1:195
  ds_read2_b32 v[104:105], v52 offset0:176 offset1:177
  ds_read2_b32 v[106:107], v52 offset0:178 offset1:179
  s_waitcnt lgkmcnt(6)
  v_mfma_f32_16x16x32_bf16 v[60:63], v[92:95], a[28:31], 0
  v_mfma_f32_16x16x32_bf16 v[64:67], v[92:95], a[60:63], 0
  v_mfma_f32_16x16x32_bf16 v[68:71], v[92:95], a[92:95], 0
  v_mfma_f32_16x16x32_bf16 v[72:75], v[92:95], a[124:127], 0
  v_mfma_f32_16x16x32_bf16 v[76:79], v[92:95], a[156:159], 0
  v_mfma_f32_16x16x32_bf16 v[80:83], v[92:95], a[188:191], 0
  v_mfma_f32_16x16x32_bf16 v[84:87], v[92:95], a[220:223], 0
  v_mfma_f32_16x16x32_bf16 v[88:91], v[92:95], a[252:255], 0
  ds_read2_b32 v[92:93], v52 offset0:160 offset1:161
  ds_read2_b32 v[94:95], v52 offset0:162 offset1:163
  s_waitcnt lgkmcnt(6)
  v_mfma_f32_16x16x32_bf16 v[60:63], v[96:99], a[24:27], v[60:63]
  v_mfma_f32_16x16x32_bf16 v[64:67], v[96:99], a[56:59], v[64:67]
  v_mfma_f32_16x16x32_bf16 v[68:71], v[96:99], a[88:91], v[68:71]
  v_mfma_f32_16x16x32_bf16 v[72:75], v[96:99], a[120:123], v[72:75]
  v_mfma_f32_16x16x32_bf16 v[76:79], v[96:99], a[152:155], v[76:79]
  v_mfma_f32_16x16x32_bf16 v[80:83], v[96:99], a[184:187], v[80:83]
  v_mfma_f32_16x16x32_bf16 v[84:87], v[96:99], a[216:219], v[84:87]
  v_mfma_f32_16x16x32_bf16 v[88:91], v[96:99], a[248:251], v[88:91]
  ds_read2_b32 v[96:97], v52 offset0:144 offset1:145
  ds_read2_b32 v[98:99], v52 offset0:146 offset1:147
  s_waitcnt lgkmcnt(6)
  v_mfma_f32_16x16x32_bf16 v[60:63], v[100:103], a[20:23], v[60:63]
  v_mfma_f32_16x16x32_bf16 v[64:67], v[100:103], a[52:55], v[64:67]
  v_mfma_f32_16x16x32_bf16 v[68:71], v[100:103], a[84:87], v[68:71]
  v_mfma_f32_16x16x32_bf16 v[72:75], v[100:103], a[116:119], v[72:75]
  v_mfma_f32_16x16x32_bf16 v[76:79], v[100:103], a[148:151], v[76:79]
  v_mfma_f32_16x16x32_bf16 v[80:83], v[100:103], a[180:183], v[80:83]
  v_mfma_f32_16x16x32_bf16 v[84:87], v[100:103], a[212:215], v[84:87]
  v_mfma_f32_16x16x32_bf16 v[88:91], v[100:103], a[244:247], v[88:91]
  ds_read2_b32 v[100:101], v52 offset0:128 offset1:129
  ds_read2_b32 v[102:103], v52 offset0:130 offset1:131
  s_waitcnt lgkmcnt(6)
  v_mfma_f32_16x16x32_bf16 v[60:63], v[104:107], a[16:19], v[60:63]
  v_mfma_f32_16x16x32_bf16 v[64:67], v[104:107], a[48:51], v[64:67]
  v_mfma_f32_16x16x32_bf16 v[68:71], v[104:107], a[80:83], v[68:71]
  v_mfma_f32_16x16x32_bf16 v[72:75], v[104:107], a[112:115], v[72:75]
  v_mfma_f32_16x16x32_bf16 v[76:79], v[104:107], a[144:147], v[76:79]
  v_mfma_f32_16x16x32_bf16 v[80:83], v[104:107], a[176:179], v[80:83]
  v_mfma_f32_16x16x32_bf16 v[84:87], v[104:107], a[208:211], v[84:87]
  v_mfma_f32_16x16x32_bf16 v[88:91], v[104:107], a[240:243], v[88:91]
  ds_read2_b32 v[104:105], v52 offset0:112 offset1:113
  ds_read2_b32 v[106:107], v52 offset0:114 offset1:115
  s_waitcnt lgkmcnt(6)
  v_mfma_f32_16x16x32_bf16 v[60:63], v[92:95], a[12:15], v[60:63]
  v_mfma_f32_16x16x32_bf16 v[64:67], v[92:95], a[44:47], v[64:67]
  v_mfma_f32_16x16x32_bf16 v[68:71], v[92:95], a[76:79], v[68:71]
  v_mfma_f32_16x16x32_bf16 v[72:75], v[92:95], a[108:111], v[72:75]
  v_mfma_f32_16x16x32_bf16 v[76:79], v[92:95], a[140:143], v[76:79]
  v_mfma_f32_16x16x32_bf16 v[80:83], v[92:95], a[172:175], v[80:83]
  v_mfma_f32_16x16x32_bf16 v[84:87], v[92:95], a[204:207], v[84:87]
  v_mfma_f32_16x16x32_bf16 v[88:91], v[92:95], a[236:239], v[88:91]
  ds_read2_b32 v[92:93], v52 offset0:96 offset1:97
  ds_read2_b32 v[94:95], v52 offset0:98 offset1:99
  s_waitcnt lgkmcnt(6)
  v_mfma_f32_16x16x32_bf16 v[60:63], v[96:99], a[8:11], v[60:63]
  v_mfma_f32_16x16x32_bf16 v[64:67], v[96:99], a[40:43], v[64:67]
  v_mfma_f32_16x16x32_bf16 v[68:71], v[96:99], a[72:75], v[68:71]
  v_mfma_f32_16x16x32_bf16 v[72:75], v[96:99], a[104:107], v[72:75]
  v_mfma_f32_16x16x32_bf16 v[76:79], v[96:99], a[136:139], v[76:79]
  v_mfma_f32_16x16x32_bf16 v[80:83], v[96:99], a[168:171], v[80:83]
  v_mfma_f32_16x16x32_bf16 v[84:87], v[96:99], a[200:203], v[84:87]
  v_mfma_f32_16x16x32_bf16 v[88:91], v[96:99], a[232:235], v[88:91]
  ds_read2_b32 v[96:97], v52 offset0:80 offset1:81
  ds_read2_b32 v[98:99], v52 offset0:82 offset1:83
  s_waitcnt lgkmcnt(6)
  v_mfma_f32_16x16x32_bf16 v[60:63], v[100:103], a[4:7], v[60:63]
  v_mfma_f32_16x16x32_bf16 v[64:67], v[100:103], a[36:39], v[64:67]
  v_mfma_f32_16x16x32_bf16 v[68:71], v[100:103], a[68:71], v[68:71]
  v_mfma_f32_16x16x32_bf16 v[72:75], v[100:103], a[100:103], v[72:75]
  v_mfma_f32_16x16x32_bf16 v[76:79], v[100:103], a[132:135], v[76:79]
  v_mfma_f32_16x16x32_bf16 v[80:83], v[100:103], a[164:167], v[80:83]
  v_mfma_f32_16x16x32_bf16 v[84:87], v[100:103], a[196:199], v[84:87]
  v_mfma_f32_16x16x32_bf16 v[88:91], v[100:103], a[228:231], v[88:91]
  ds_read2_b32 v[100:101], v52 offset0:64 offset1:65
  ds_read2_b32 v[102:103], v52 offset0:66 offset1:67
  s_waitcnt lgkmcnt(6)
  v_mfma_f32_16x16x32_bf16 v[60:63], v[104:107], a[0:3], v[60:63]
  v_mfma_f32_16x16x32_bf16 v[64:67], v[104:107], a[32:35], v[64:67]
  v_mfma_f32_16x16x32_bf16 v[68:71], v[104:107], a[64:67], v[68:71]
  v_mfma_f32_16x16x32_bf16 v[72:75], v[104:107], a[96:99], v[72:75]
  v_mfma_f32_16x16x32_bf16 v[76:79], v[104:107], a[128:131], v[76:79]
  v_mfma_f32_16x16x32_bf16 v[80:83], v[104:107], a[160:163], v[80:83]
  v_mfma_f32_16x16x32_bf16 v[84:87], v[104:107], a[192:195], v[84:87]
  v_mfma_f32_16x16x32_bf16 v[88:91], v[104:107], a[224:227], v[88:91]
  ds_read2_b32 v[104:105], v52 offset0:48 offset1:49
  ds_read2_b32 v[106:107], v52 offset0:50 offset1:51
  s_waitcnt lgkmcnt(6)
  v_mfma_f32_16x16x32_bf16 v[64:67], v[92:95], a[28:31], v[64:67]
  v_mfma_f32_16x16x32_bf16 v[68:71], v[92:95], a[60:63], v[68:71]
  v_mfma_f32_16x16x32_bf16 v[72:75], v[92:95], a[92:95], v[72:75]
  v_mfma_f32_16x16x32_bf16 v[76:79], v[92:95], a[124:127], v[76:79]
  v_mfma_f32_16x16x32_bf16 v[80:83], v[92:95], a[156:159], v[80:83]
  v_mfma_f32_16x16x32_bf16 v[84:87], v[92:95], a[188:191], v[84:87]
  v_mfma_f32_16x16x32_bf16 v[88:91], v[92:95], a[220:223], v[88:91]
  ds_read2_b32 v[92:93], v52 offset0:32 offset1:33
  ds_read2_b32 v[94:95], v52 offset0:34 offset1:35
  s_waitcnt lgkmcnt(6)
  v_mfma_f32_16x16x32_bf16 v[64:67], v[96:99], a[24:27], v[64:67]
  v_mfma_f32_16x16x32_bf16 v[68:71], v[96:99], a[56:59], v[68:71]
  v_mfma_f32_16x16x32_bf16 v[72:75], v[96:99], a[88:91], v[72:75]
  v_mfma_f32_16x16x32_bf16 v[76:79], v[96:99], a[120:123], v[76:79]
  v_mfma_f32_16x16x32_bf16 v[80:83], v[96:99], a[152:155], v[80:83]
  v_mfma_f32_16x16x32_bf16 v[84:87], v[96:99], a[184:187], v[84:87]
  v_mfma_f32_16x16x32_bf16 v[88:91], v[96:99], a[216:219], v[88:91]
  ds_read2_b32 v[96:97], v52 offset0:16 offset1:17
  ds_read2_b32 v[98:99], v52 offset0:18 offset1:19
  s_waitcnt lgkmcnt(6)
  v_mfma_f32_16x16x32_bf16 v[64:67], v[100:103], a[20:23], v[64:67]
  v_mfma_f32_16x16x32_bf16 v[68:71], v[100:103], a[52:55], v[68:71]
  v_mfma_f32_16x16x32_bf16 v[72:75], v[100:103], a[84:87], v[72:75]
  v_mfma_f32_16x16x32_bf16 v[76:79], v[100:103], a[116:119], v[76:79]
  v_mfma_f32_16x16x32_bf16 v[80:83], v[100:103], a[148:151], v[80:83]
  v_mfma_f32_16x16x32_bf16 v[84:87], v[100:103], a[180:183], v[84:87]
  v_mfma_f32_16x16x32_bf16 v[88:91], v[100:103], a[212:215], v[88:91]
  ds_read2_b32 v[100:101], v52 offset0:0 offset1:1
  ds_read2_b32 v[102:103], v52 offset0:2 offset1:3
  s_waitcnt lgkmcnt(6)
  v_mfma_f32_16x16x32_bf16 v[64:67], v[104:107], a[16:19], v[64:67]
  v_mfma_f32_16x16x32_bf16 v[68:71], v[104:107], a[48:51], v[68:71]
  v_mfma_f32_16x16x32_bf16 v[72:75], v[104:107], a[80:83], v[72:75]
  v_mfma_f32_16x16x32_bf16 v[76:79], v[104:107], a[112:115], v[76:79]
  v_mfma_f32_16x16x32_bf16 v[80:83], v[104:107], a[144:147], v[80:83]
  v_mfma_f32_16x16x32_bf16 v[84:87], v[104:107], a[176:179], v[84:87]
  v_mfma_f32_16x16x32_bf16 v[88:91], v[104:107], a[208:211], v[88:91]
  ds_read2_b32 v[104:105], v53 offset0:224 offset1:225
  ds_read2_b32 v[106:107], v53 offset0:226 offset1:227
  s_waitcnt lgkmcnt(6)
  v_mfma_f32_16x16x32_bf16 v[64:67], v[92:95], a[12:15], v[64:67]
  v_mfma_f32_16x16x32_bf16 v[68:71], v[92:95], a[44:47], v[68:71]
  v_mfma_f32_16x16x32_bf16 v[72:75], v[92:95], a[76:79], v[72:75]
  v_mfma_f32_16x16x32_bf16 v[76:79], v[92:95], a[108:111], v[76:79]
  v_mfma_f32_16x16x32_bf16 v[80:83], v[92:95], a[140:143], v[80:83]
  v_mfma_f32_16x16x32_bf16 v[84:87], v[92:95], a[172:175], v[84:87]
  v_mfma_f32_16x16x32_bf16 v[88:91], v[92:95], a[204:207], v[88:91]
  ds_read2_b32 v[92:93], v53 offset0:208 offset1:209
  ds_read2_b32 v[94:95], v53 offset0:210 offset1:211
  s_waitcnt lgkmcnt(6)
  v_mfma_f32_16x16x32_bf16 v[64:67], v[96:99], a[8:11], v[64:67]
  v_mfma_f32_16x16x32_bf16 v[68:71], v[96:99], a[40:43], v[68:71]
  v_mfma_f32_16x16x32_bf16 v[72:75], v[96:99], a[72:75], v[72:75]
  v_mfma_f32_16x16x32_bf16 v[76:79], v[96:99], a[104:107], v[76:79]
  v_mfma_f32_16x16x32_bf16 v[80:83], v[96:99], a[136:139], v[80:83]
  v_mfma_f32_16x16x32_bf16 v[84:87], v[96:99], a[168:171], v[84:87]
  v_mfma_f32_16x16x32_bf16 v[88:91], v[96:99], a[200:203], v[88:91]
  ds_read2_b32 v[96:97], v53 offset0:192 offset1:193
  ds_read2_b32 v[98:99], v53 offset0:194 offset1:195
  s_waitcnt lgkmcnt(6)
  v_mfma_f32_16x16x32_bf16 v[64:67], v[100:103], a[4:7], v[64:67]
  v_mfma_f32_16x16x32_bf16 v[68:71], v[100:103], a[36:39], v[68:71]
  v_mfma_f32_16x16x32_bf16 v[72:75], v[100:103], a[68:71], v[72:75]
  v_mfma_f32_16x16x32_bf16 v[76:79], v[100:103], a[100:103], v[76:79]
  v_mfma_f32_16x16x32_bf16 v[80:83], v[100:103], a[132:135], v[80:83]
  v_mfma_f32_16x16x32_bf16 v[84:87], v[100:103], a[164:167], v[84:87]
  v_mfma_f32_16x16x32_bf16 v[88:91], v[100:103], a[196:199], v[88:91]
  ds_read2_b32 v[100:101], v53 offset0:176 offset1:177
  ds_read2_b32 v[102:103], v53 offset0:178 offset1:179
  s_waitcnt lgkmcnt(6)
  v_mfma_f32_16x16x32_bf16 v[64:67], v[104:107], a[0:3], v[64:67]
  v_mfma_f32_16x16x32_bf16 v[68:71], v[104:107], a[32:35], v[68:71]
  v_mfma_f32_16x16x32_bf16 v[72:75], v[104:107], a[64:67], v[72:75]
  v_mfma_f32_16x16x32_bf16 v[76:79], v[104:107], a[96:99], v[76:79]
  v_mfma_f32_16x16x32_bf16 v[80:83], v[104:107], a[128:131], v[80:83]
  v_mfma_f32_16x16x32_bf16 v[84:87], v[104:107], a[160:163], v[84:87]
  v_mfma_f32_16x16x32_bf16 v[88:91], v[104:107], a[192:195], v[88:91]
  ds_read2_b32 v[104:105], v53 offset0:160 offset1:161
  ds_read2_b32 v[106:107], v53 offset0:162 offset1:163
  s_waitcnt lgkmcnt(6)
  v_mfma_f32_16x16x32_bf16 v[68:71], v[92:95], a[28:31], v[68:71]
  v_mfma_f32_16x16x32_bf16 v[72:75], v[92:95], a[60:63], v[72:75]
  v_mfma_f32_16x16x32_bf16 v[76:79], v[92:95], a[92:95], v[76:79]
  v_mfma_f32_16x16x32_bf16 v[80:83], v[92:95], a[124:127], v[80:83]
  v_mfma_f32_16x16x32_bf16 v[84:87], v[92:95], a[156:159], v[84:87]
  v_mfma_f32_16x16x32_bf16 v[88:91], v[92:95], a[188:191], v[88:91]
  ds_read2_b32 v[92:93], v53 offset0:144 offset1:145
  ds_read2_b32 v[94:95], v53 offset0:146 offset1:147
  s_waitcnt lgkmcnt(6)
  v_mfma_f32_16x16x32_bf16 v[68:71], v[96:99], a[24:27], v[68:71]
  v_mfma_f32_16x16x32_bf16 v[72:75], v[96:99], a[56:59], v[72:75]
  v_mfma_f32_16x16x32_bf16 v[76:79], v[96:99], a[88:91], v[76:79]
  v_mfma_f32_16x16x32_bf16 v[80:83], v[96:99], a[120:123], v[80:83]
  v_mfma_f32_16x16x32_bf16 v[84:87], v[96:99], a[152:155], v[84:87]
  v_mfma_f32_16x16x32_bf16 v[88:91], v[96:99], a[184:187], v[88:91]
  ds_read2_b32 v[96:97], v53 offset0:128 offset1:129
  ds_read2_b32 v[98:99], v53 offset0:130 offset1:131
  s_waitcnt lgkmcnt(6)
  v_mfma_f32_16x16x32_bf16 v[68:71], v[100:103], a[20:23], v[68:71]
  v_mfma_f32_16x16x32_bf16 v[72:75], v[100:103], a[52:55], v[72:75]
  v_mfma_f32_16x16x32_bf16 v[76:79], v[100:103], a[84:87], v[76:79]
  v_mfma_f32_16x16x32_bf16 v[80:83], v[100:103], a[116:119], v[80:83]
  v_mfma_f32_16x16x32_bf16 v[84:87], v[100:103], a[148:151], v[84:87]
  v_mfma_f32_16x16x32_bf16 v[88:91], v[100:103], a[180:183], v[88:91]
  ds_read2_b32 v[100:101], v53 offset0:112 offset1:113
  ds_read2_b32 v[102:103], v53 offset0:114 offset1:115
  s_waitcnt lgkmcnt(6)
  v_mfma_f32_16x16x32_bf16 v[68:71], v[104:107], a[16:19], v[68:71]
  v_mfma_f32_16x16x32_bf16 v[72:75], v[104:107], a[48:51], v[72:75]
  v_mfma_f32_16x16x32_bf16 v[76:79], v[104:107], a[80:83], v[76:79]
  v_mfma_f32_16x16x32_bf16 v[80:83], v[104:107], a[112:115], v[80:83]
  v_mfma_f32_16x16x32_bf16 v[84:87], v[104:107], a[144:147], v[84:87]
  v_mfma_f32_16x16x32_bf16 v[88:91], v[104:107], a[176:179], v[88:91]
  ds_read2_b32 v[104:105], v53 offset0:96 offset1:97
  ds_read2_b32 v[106:107], v53 offset0:98 offset1:99
  s_waitcnt lgkmcnt(6)
  v_mfma_f32_16x16x32_bf16 v[68:71], v[92:95], a[12:15], v[68:71]
  v_mfma_f32_16x16x32_bf16 v[72:75], v[92:95], a[44:47], v[72:75]
  v_mfma_f32_16x16x32_bf16 v[76:79], v[92:95], a[76:79], v[76:79]
  v_mfma_f32_16x16x32_bf16 v[80:83], v[92:95], a[108:111], v[80:83]
  v_mfma_f32_16x16x32_bf16 v[84:87], v[92:95], a[140:143], v[84:87]
  v_mfma_f32_16x16x32_bf16 v[88:91], v[92:95], a[172:175], v[88:91]
  ds_read2_b32 v[92:93], v53 offset0:80 offset1:81
  ds_read2_b32 v[94:95], v53 offset0:82 offset1:83
  s_waitcnt lgkmcnt(6)
  v_mfma_f32_16x16x32_bf16 v[68:71], v[96:99], a[8:11], v[68:71]
  v_mfma_f32_16x16x32_bf16 v[72:75], v[96:99], a[40:43], v[72:75]
  v_mfma_f32_16x16x32_bf16 v[76:79], v[96:99], a[72:75], v[76:79]
  v_mfma_f32_16x16x32_bf16 v[80:83], v[96:99], a[104:107], v[80:83]
  v_mfma_f32_16x16x32_bf16 v[84:87], v[96:99], a[136:139], v[84:87]
  v_mfma_f32_16x16x32_bf16 v[88:91], v[96:99], a[168:171], v[88:91]
  ds_read2_b32 v[96:97], v53 offset0:64 offset1:65
  ds_read2_b32 v[98:99], v53 offset0:66 offset1:67
  s_waitcnt lgkmcnt(6)
  v_mfma_f32_16x16x32_bf16 v[68:71], v[100:103], a[4:7], v[68:71]
  v_mfma_f32_16x16x32_bf16 v[72:75], v[100:103], a[36:39], v[72:75]
  v_mfma_f32_16x16x32_bf16 v[76:79], v[100:103], a[68:71], v[76:79]
  v_mfma_f32_16x16x32_bf16 v[80:83], v[100:103], a[100:103], v[80:83]
  v_mfma_f32_16x16x32_bf16 v[84:87], v[100:103], a[132:135], v[84:87]
  v_mfma_f32_16x16x32_bf16 v[88:91], v[100:103], a[164:167], v[88:91]
  ds_read2_b32 v[100:101], v53 offset0:48 offset1:49
  ds_read2_b32 v[102:103], v53 offset0:50 offset1:51
  s_waitcnt lgkmcnt(6)
  v_mfma_f32_16x16x32_bf16 v[68:71], v[104:107], a[0:3], v[68:71]
  v_mfma_f32_16x16x32_bf16 v[72:75], v[104:107], a[32:35], v[72:75]
  v_mfma_f32_16x16x32_bf16 v[76:79], v[104:107], a[64:67], v[76:79]
  v_mfma_f32_16x16x32_bf16 v[80:83], v[104:107], a[96:99], v[80:83]
  v_mfma_f32_16x16x32_bf16 v[84:87], v[104:107], a[128:131], v[84:87]
  v_mfma_f32_16x16x32_bf16 v[88:91], v[104:107], a[160:163], v[88:91]
  ds_read2_b32 v[104:105], v53 offset0:32 offset1:33
  ds_read2_b32 v[106:107], v53 offset0:34 offset1:35
  s_waitcnt lgkmcnt(6)
  v_mfma_f32_16x16x32_bf16 v[72:75], v[92:95], a[28:31], v[72:75]
  v_mfma_f32_16x16x32_bf16 v[76:79], v[92:95], a[60:63], v[76:79]
  v_mfma_f32_16x16x32_bf16 v[80:83], v[92:95], a[92:95], v[80:83]
  v_mfma_f32_16x16x32_bf16 v[84:87], v[92:95], a[124:127], v[84:87]
  v_mfma_f32_16x16x32_bf16 v[88:91], v[92:95], a[156:159], v[88:91]
  ds_read2_b32 v[92:93], v53 offset0:16 offset1:17
  ds_read2_b32 v[94:95], v53 offset0:18 offset1:19
  s_waitcnt lgkmcnt(6)
  v_mfma_f32_16x16x32_bf16 v[72:75], v[96:99], a[24:27], v[72:75]
  v_mfma_f32_16x16x32_bf16 v[76:79], v[96:99], a[56:59], v[76:79]
  v_mfma_f32_16x16x32_bf16 v[80:83], v[96:99], a[88:91], v[80:83]
  v_mfma_f32_16x16x32_bf16 v[84:87], v[96:99], a[120:123], v[84:87]
  v_mfma_f32_16x16x32_bf16 v[88:91], v[96:99], a[152:155], v[88:91]
  ds_read2_b32 v[96:97], v53 offset0:0 offset1:1
  ds_read2_b32 v[98:99], v53 offset0:2 offset1:3
  s_waitcnt lgkmcnt(6)
  v_mfma_f32_16x16x32_bf16 v[72:75], v[100:103], a[20:23], v[72:75]
  v_mfma_f32_16x16x32_bf16 v[76:79], v[100:103], a[52:55], v[76:79]
  v_mfma_f32_16x16x32_bf16 v[80:83], v[100:103], a[84:87], v[80:83]
  v_mfma_f32_16x16x32_bf16 v[84:87], v[100:103], a[116:119], v[84:87]
  v_mfma_f32_16x16x32_bf16 v[88:91], v[100:103], a[148:151], v[88:91]
  ds_read2_b32 v[100:101], v54 offset0:224 offset1:225
  ds_read2_b32 v[102:103], v54 offset0:226 offset1:227
  s_waitcnt lgkmcnt(6)
  v_mfma_f32_16x16x32_bf16 v[72:75], v[104:107], a[16:19], v[72:75]
  v_mfma_f32_16x16x32_bf16 v[76:79], v[104:107], a[48:51], v[76:79]
  v_mfma_f32_16x16x32_bf16 v[80:83], v[104:107], a[80:83], v[80:83]
  v_mfma_f32_16x16x32_bf16 v[84:87], v[104:107], a[112:115], v[84:87]
  v_mfma_f32_16x16x32_bf16 v[88:91], v[104:107], a[144:147], v[88:91]
  ds_read2_b32 v[104:105], v54 offset0:208 offset1:209
  ds_read2_b32 v[106:107], v54 offset0:210 offset1:211
  s_waitcnt lgkmcnt(6)
  v_mfma_f32_16x16x32_bf16 v[72:75], v[92:95], a[12:15], v[72:75]
  v_mfma_f32_16x16x32_bf16 v[76:79], v[92:95], a[44:47], v[76:79]
  v_mfma_f32_16x16x32_bf16 v[80:83], v[92:95], a[76:79], v[80:83]
  v_mfma_f32_16x16x32_bf16 v[84:87], v[92:95], a[108:111], v[84:87]
  v_mfma_f32_16x16x32_bf16 v[88:91], v[92:95], a[140:143], v[88:91]
  ds_read2_b32 v[92:93], v54 offset0:192 offset1:193
  ds_read2_b32 v[94:95], v54 offset0:194 offset1:195
  s_waitcnt lgkmcnt(6)
  v_mfma_f32_16x16x32_bf16 v[72:75], v[96:99], a[8:11], v[72:75]
  v_mfma_f32_16x16x32_bf16 v[76:79], v[96:99], a[40:43], v[76:79]
  v_mfma_f32_16x16x32_bf16 v[80:83], v[96:99], a[72:75], v[80:83]
  v_mfma_f32_16x16x32_bf16 v[84:87], v[96:99], a[104:107], v[84:87]
  v_mfma_f32_16x16x32_bf16 v[88:91], v[96:99], a[136:139], v[88:91]
  ds_read2_b32 v[96:97], v54 offset0:176 offset1:177
  ds_read2_b32 v[98:99], v54 offset0:178 offset1:179
  s_waitcnt lgkmcnt(6)
  v_mfma_f32_16x16x32_bf16 v[72:75], v[100:103], a[4:7], v[72:75]
  v_mfma_f32_16x16x32_bf16 v[76:79], v[100:103], a[36:39], v[76:79]
  v_mfma_f32_16x16x32_bf16 v[80:83], v[100:103], a[68:71], v[80:83]
  v_mfma_f32_16x16x32_bf16 v[84:87], v[100:103], a[100:103], v[84:87]
  v_mfma_f32_16x16x32_bf16 v[88:91], v[100:103], a[132:135], v[88:91]
  ds_read2_b32 v[100:101], v54 offset0:160 offset1:161
  ds_read2_b32 v[102:103], v54 offset0:162 offset1:163
  s_waitcnt lgkmcnt(6)
  v_mfma_f32_16x16x32_bf16 v[72:75], v[104:107], a[0:3], v[72:75]
  v_mfma_f32_16x16x32_bf16 v[76:79], v[104:107], a[32:35], v[76:79]
  v_mfma_f32_16x16x32_bf16 v[80:83], v[104:107], a[64:67], v[80:83]
  v_mfma_f32_16x16x32_bf16 v[84:87], v[104:107], a[96:99], v[84:87]
  v_mfma_f32_16x16x32_bf16 v[88:91], v[104:107], a[128:131], v[88:91]
  ds_read2_b32 v[104:105], v54 offset0:144 offset1:145
  ds_read2_b32 v[106:107], v54 offset0:146 offset1:147
  s_waitcnt lgkmcnt(6)
  v_mfma_f32_16x16x32_bf16 v[76:79], v[92:95], a[28:31], v[76:79]
  v_mfma_f32_16x16x32_bf16 v[80:83], v[92:95], a[60:63], v[80:83]
  v_mfma_f32_16x16x32_bf16 v[84:87], v[92:95], a[92:95], v[84:87]
  v_mfma_f32_16x16x32_bf16 v[88:91], v[92:95], a[124:127], v[88:91]
  ds_read2_b32 v[92:93], v54 offset0:128 offset1:129
  ds_read2_b32 v[94:95], v54 offset0:130 offset1:131
  s_waitcnt lgkmcnt(6)
  v_mfma_f32_16x16x32_bf16 v[76:79], v[96:99], a[24:27], v[76:79]
  v_mfma_f32_16x16x32_bf16 v[80:83], v[96:99], a[56:59], v[80:83]
  v_mfma_f32_16x16x32_bf16 v[84:87], v[96:99], a[88:91], v[84:87]
  v_mfma_f32_16x16x32_bf16 v[88:91], v[96:99], a[120:123], v[88:91]
  ds_read2_b32 v[96:97], v54 offset0:112 offset1:113
  ds_read2_b32 v[98:99], v54 offset0:114 offset1:115
  s_waitcnt lgkmcnt(6)
  v_mfma_f32_16x16x32_bf16 v[76:79], v[100:103], a[20:23], v[76:79]
  v_mfma_f32_16x16x32_bf16 v[80:83], v[100:103], a[52:55], v[80:83]
  v_mfma_f32_16x16x32_bf16 v[84:87], v[100:103], a[84:87], v[84:87]
  v_mfma_f32_16x16x32_bf16 v[88:91], v[100:103], a[116:119], v[88:91]
  ds_read2_b32 v[100:101], v54 offset0:96 offset1:97
  ds_read2_b32 v[102:103], v54 offset0:98 offset1:99
  s_waitcnt lgkmcnt(6)
  v_mfma_f32_16x16x32_bf16 v[76:79], v[104:107], a[16:19], v[76:79]
  v_mfma_f32_16x16x32_bf16 v[80:83], v[104:107], a[48:51], v[80:83]
  v_mfma_f32_16x16x32_bf16 v[84:87], v[104:107], a[80:83], v[84:87]
  v_mfma_f32_16x16x32_bf16 v[88:91], v[104:107], a[112:115], v[88:91]
  ds_read2_b32 v[104:105], v54 offset0:80 offset1:81
  ds_read2_b32 v[106:107], v54 offset0:82 offset1:83
  s_waitcnt lgkmcnt(6)
  v_mfma_f32_16x16x32_bf16 v[76:79], v[92:95], a[12:15], v[76:79]
  v_mfma_f32_16x16x32_bf16 v[80:83], v[92:95], a[44:47], v[80:83]
  v_mfma_f32_16x16x32_bf16 v[84:87], v[92:95], a[76:79], v[84:87]
  v_mfma_f32_16x16x32_bf16 v[88:91], v[92:95], a[108:111], v[88:91]
  ds_read2_b32 v[92:93], v54 offset0:64 offset1:65
  ds_read2_b32 v[94:95], v54 offset0:66 offset1:67
  s_waitcnt lgkmcnt(6)
  v_mfma_f32_16x16x32_bf16 v[76:79], v[96:99], a[8:11], v[76:79]
  v_mfma_f32_16x16x32_bf16 v[80:83], v[96:99], a[40:43], v[80:83]
  v_mfma_f32_16x16x32_bf16 v[84:87], v[96:99], a[72:75], v[84:87]
  v_mfma_f32_16x16x32_bf16 v[88:91], v[96:99], a[104:107], v[88:91]
  ds_read2_b32 v[96:97], v54 offset0:48 offset1:49
  ds_read2_b32 v[98:99], v54 offset0:50 offset1:51
  s_waitcnt lgkmcnt(6)
  v_mfma_f32_16x16x32_bf16 v[76:79], v[100:103], a[4:7], v[76:79]
  v_mfma_f32_16x16x32_bf16 v[80:83], v[100:103], a[36:39], v[80:83]
  v_mfma_f32_16x16x32_bf16 v[84:87], v[100:103], a[68:71], v[84:87]
  v_mfma_f32_16x16x32_bf16 v[88:91], v[100:103], a[100:103], v[88:91]
  ds_read2_b32 v[100:101], v54 offset0:32 offset1:33
  ds_read2_b32 v[102:103], v54 offset0:34 offset1:35
  s_waitcnt lgkmcnt(6)
  v_mfma_f32_16x16x32_bf16 v[76:79], v[104:107], a[0:3], v[76:79]
  v_mfma_f32_16x16x32_bf16 v[80:83], v[104:107], a[32:35], v[80:83]
  v_mfma_f32_16x16x32_bf16 v[84:87], v[104:107], a[64:67], v[84:87]
  v_mfma_f32_16x16x32_bf16 v[88:91], v[104:107], a[96:99], v[88:91]
  ds_read2_b32 v[104:105], v54 offset0:16 offset1:17
  ds_read2_b32 v[106:107], v54 offset0:18 offset1:19
  s_waitcnt lgkmcnt(6)
  v_mfma_f32_16x16x32_bf16 v[80:83], v[92:95], a[28:31], v[80:83]
  v_mfma_f32_16x16x32_bf16 v[84:87], v[92:95], a[60:63], v[84:87]
  v_mfma_f32_16x16x32_bf16 v[88:91], v[92:95], a[92:95], v[88:91]
  ds_read2_b32 v[92:93], v54 offset0:0 offset1:1
  ds_read2_b32 v[94:95], v54 offset0:2 offset1:3
  s_waitcnt lgkmcnt(6)
  v_mfma_f32_16x16x32_bf16 v[80:83], v[96:99], a[24:27], v[80:83]
  v_mfma_f32_16x16x32_bf16 v[84:87], v[96:99], a[56:59], v[84:87]
  v_mfma_f32_16x16x32_bf16 v[88:91], v[96:99], a[88:91], v[88:91]
  ds_read2_b32 v[96:97], v55 offset0:224 offset1:225
  ds_read2_b32 v[98:99], v55 offset0:226 offset1:227
  s_waitcnt lgkmcnt(6)
  v_mfma_f32_16x16x32_bf16 v[80:83], v[100:103], a[20:23], v[80:83]
  v_mfma_f32_16x16x32_bf16 v[84:87], v[100:103], a[52:55], v[84:87]
  v_mfma_f32_16x16x32_bf16 v[88:91], v[100:103], a[84:87], v[88:91]
  ds_read2_b32 v[100:101], v55 offset0:208 offset1:209
  ds_read2_b32 v[102:103], v55 offset0:210 offset1:211
  s_waitcnt lgkmcnt(6)
  v_mfma_f32_16x16x32_bf16 v[80:83], v[104:107], a[16:19], v[80:83]
  v_mfma_f32_16x16x32_bf16 v[84:87], v[104:107], a[48:51], v[84:87]
  v_mfma_f32_16x16x32_bf16 v[88:91], v[104:107], a[80:83], v[88:91]
  ds_read2_b32 v[104:105], v55 offset0:192 offset1:193
  ds_read2_b32 v[106:107], v55 offset0:194 offset1:195
  s_waitcnt lgkmcnt(6)
  v_mfma_f32_16x16x32_bf16 v[80:83], v[92:95], a[12:15], v[80:83]
  v_mfma_f32_16x16x32_bf16 v[84:87], v[92:95], a[44:47], v[84:87]
  v_mfma_f32_16x16x32_bf16 v[88:91], v[92:95], a[76:79], v[88:91]
  ds_read2_b32 v[92:93], v55 offset0:176 offset1:177
  ds_read2_b32 v[94:95], v55 offset0:178 offset1:179
  s_waitcnt lgkmcnt(6)
  v_mfma_f32_16x16x32_bf16 v[80:83], v[96:99], a[8:11], v[80:83]
  v_mfma_f32_16x16x32_bf16 v[84:87], v[96:99], a[40:43], v[84:87]
  v_mfma_f32_16x16x32_bf16 v[88:91], v[96:99], a[72:75], v[88:91]
  ds_read2_b32 v[96:97], v55 offset0:160 offset1:161
  ds_read2_b32 v[98:99], v55 offset0:162 offset1:163
  s_waitcnt lgkmcnt(6)
  v_mfma_f32_16x16x32_bf16 v[80:83], v[100:103], a[4:7], v[80:83]
  v_mfma_f32_16x16x32_bf16 v[84:87], v[100:103], a[36:39], v[84:87]
  v_mfma_f32_16x16x32_bf16 v[88:91], v[100:103], a[68:71], v[88:91]
  ds_read2_b32 v[100:101], v55 offset0:144 offset1:145
  ds_read2_b32 v[102:103], v55 offset0:146 offset1:147
  s_waitcnt lgkmcnt(6)
  v_mfma_f32_16x16x32_bf16 v[80:83], v[104:107], a[0:3], v[80:83]
  v_mfma_f32_16x16x32_bf16 v[84:87], v[104:107], a[32:35], v[84:87]
  v_mfma_f32_16x16x32_bf16 v[88:91], v[104:107], a[64:67], v[88:91]
  ds_read2_b32 v[104:105], v55 offset0:128 offset1:129
  ds_read2_b32 v[106:107], v55 offset0:130 offset1:131
  s_waitcnt lgkmcnt(6)
  v_mfma_f32_16x16x32_bf16 v[84:87], v[92:95], a[28:31], v[84:87]
  v_mfma_f32_16x16x32_bf16 v[88:91], v[92:95], a[60:63], v[88:91]
  ds_read2_b32 v[92:93], v55 offset0:112 offset1:113
  ds_read2_b32 v[94:95], v55 offset0:114 offset1:115
  s_waitcnt lgkmcnt(6)
  v_mfma_f32_16x16x32_bf16 v[84:87], v[96:99], a[24:27], v[84:87]
  v_mfma_f32_16x16x32_bf16 v[88:91], v[96:99], a[56:59], v[88:91]
  ds_read2_b32 v[96:97], v55 offset0:96 offset1:97
  ds_read2_b32 v[98:99], v55 offset0:98 offset1:99
  s_waitcnt lgkmcnt(6)
  v_mfma_f32_16x16x32_bf16 v[84:87], v[100:103], a[20:23], v[84:87]
  v_mfma_f32_16x16x32_bf16 v[88:91], v[100:103], a[52:55], v[88:91]
  ds_read2_b32 v[100:101], v55 offset0:80 offset1:81
  ds_read2_b32 v[102:103], v55 offset0:82 offset1:83
  s_waitcnt lgkmcnt(6)
  v_mfma_f32_16x16x32_bf16 v[84:87], v[104:107], a[16:19], v[84:87]
  v_mfma_f32_16x16x32_bf16 v[88:91], v[104:107], a[48:51], v[88:91]
  ds_read2_b32 v[104:105], v55 offset0:64 offset1:65
  ds_read2_b32 v[106:107], v55 offset0:66 offset1:67
  s_waitcnt lgkmcnt(6)
  v_mfma_f32_16x16x32_bf16 v[84:87], v[92:95], a[12:15], v[84:87]
  v_mfma_f32_16x16x32_bf16 v[88:91], v[92:95], a[44:47], v[88:91]
  ds_read2_b32 v[92:93], v55 offset0:48 offset1:49
  ds_read2_b32 v[94:95], v55 offset0:50 offset1:51
  s_waitcnt lgkmcnt(6)
  v_mfma_f32_16x16x32_bf16 v[84:87], v[96:99], a[8:11], v[84:87]
  v_mfma_f32_16x16x32_bf16 v[88:91], v[96:99], a[40:43], v[88:91]
  ds_read2_b32 v[96:97], v55 offset0:32 offset1:33
  ds_read2_b32 v[98:99], v55 offset0:34 offset1:35
  s_waitcnt lgkmcnt(6)
  v_mfma_f32_16x16x32_bf16 v[84:87], v[100:103], a[4:7], v[84:87]
  v_mfma_f32_16x16x32_bf16 v[88:91], v[100:103], a[36:39], v[88:91]
  ds_read2_b32 v[100:101], v55 offset0:16 offset1:17
  ds_read2_b32 v[102:103], v55 offset0:18 offset1:19
  s_waitcnt lgkmcnt(6)
  v_mfma_f32_16x16x32_bf16 v[84:87], v[104:107], a[0:3], v[84:87]
  v_mfma_f32_16x16x32_bf16 v[88:91], v[104:107], a[32:35], v[88:91]
  ds_read2_b32 v[104:105], v55 offset0:0 offset1:1
  ds_read2_b32 v[106:107], v55 offset0:2 offset1:3
  s_waitcnt lgkmcnt(6)
  v_mfma_f32_16x16x32_bf16 v[88:91], v[92:95], a[28:31], v[88:91]
  ds_read2_b32 v[92:93], v56 offset0:224 offset1:225
  ds_read2_b32 v[94:95], v56 offset0:226 offset1:227
  s_waitcnt lgkmcnt(6)
  v_mfma_f32_16x16x32_bf16 v[88:91], v[96:99], a[24:27], v[88:91]
  ds_read2_b32 v[96:97], v56 offset0:208 offset1:209
  ds_read2_b32 v[98:99], v56 offset0:210 offset1:211
  s_waitcnt lgkmcnt(6)
  v_mfma_f32_16x16x32_bf16 v[88:91], v[100:103], a[20:23], v[88:91]
  ds_read2_b32 v[100:101], v56 offset0:192 offset1:193
  ds_read2_b32 v[102:103], v56 offset0:194 offset1:195
  s_waitcnt lgkmcnt(6)
  v_mfma_f32_16x16x32_bf16 v[88:91], v[104:107], a[16:19], v[88:91]
  ds_read2_b32 v[104:105], v56 offset0:176 offset1:177
  ds_read2_b32 v[106:107], v56 offset0:178 offset1:179
  s_waitcnt lgkmcnt(6)
  v_mfma_f32_16x16x32_bf16 v[88:91], v[92:95], a[12:15], v[88:91]
  s_waitcnt lgkmcnt(4)
  v_mfma_f32_16x16x32_bf16 v[88:91], v[96:99], a[8:11], v[88:91]
  s_waitcnt lgkmcnt(2)
  v_mfma_f32_16x16x32_bf16 v[88:91], v[100:103], a[4:7], v[88:91]
  s_waitcnt lgkmcnt(0)
  v_mfma_f32_16x16x32_bf16 v[88:91], v[104:107], a[0:3], v[88:91]
  v_lshlrev_b32 v46, 5, v4
  v_lshl_add_u32 v46, v3, 3, v46
  v_add_u32 v46, s17, v46
  ds_read_b64 v[108:109], v46 offset:512
  ds_read_b64 v[110:111], v46 offset:1024
  ds_read_b64 v[112:113], v46 offset:1536
  ds_read_b64 v[114:115], v46 offset:2048
  ds_read_b64 v[116:117], v46 offset:2560
  ds_read_b64 v[118:119], v46 offset:3072
  ds_read_b64 v[120:121], v46 offset:3584
  ds_read_b64 v[122:123], v46 offset:4096
  s_waitcnt lgkmcnt(0)
  v_lshlrev_b32 v124, 16, v108
  v_and_b32 v125, 0xffff0000, v108
  v_lshlrev_b32 v126, 16, v109
  v_and_b32 v127, 0xffff0000, v109
  v_mul_f32 v124, v124, v33
  v_mul_f32 v125, v125, v33
  v_mul_f32 v126, v126, v33
  v_mul_f32 v127, v127, v33
  v_cvt_pk_bf16_f32 v128, v124, v125
  v_cvt_pk_bf16_f32 v129, v126, v127
  v_cvt_pk_bf16_f32 v130, v60, v61
  v_cvt_pk_bf16_f32 v131, v62, v63
  v_lshlrev_b32 v124, 16, v128
  v_and_b32 v125, 0xffff0000, v128
  v_lshlrev_b32 v132, 16, v130
  v_and_b32 v133, 0xffff0000, v130
  v_lshlrev_b32 v126, 16, v129
  v_and_b32 v127, 0xffff0000, v129
  v_lshlrev_b32 v134, 16, v131
  v_and_b32 v135, 0xffff0000, v131
  v_add_f32 v124, v124, v132
  v_add_f32 v125, v125, v133
  v_add_f32 v126, v126, v134
  v_add_f32 v127, v127, v135
  v_cvt_pk_bf16_f32 v108, v124, v125
  v_cvt_pk_bf16_f32 v109, v126, v127
  ds_write_b64 v46, v[108:109] offset:512
  v_lshlrev_b32 v124, 16, v110
  v_and_b32 v125, 0xffff0000, v110
  v_lshlrev_b32 v126, 16, v111
  v_and_b32 v127, 0xffff0000, v111
  v_mul_f32 v124, v124, v33
  v_mul_f32 v125, v125, v33
  v_mul_f32 v126, v126, v33
  v_mul_f32 v127, v127, v33
  v_cvt_pk_bf16_f32 v128, v124, v125
  v_cvt_pk_bf16_f32 v129, v126, v127
  v_cvt_pk_bf16_f32 v130, v64, v65
  v_cvt_pk_bf16_f32 v131, v66, v67
  v_lshlrev_b32 v124, 16, v128
  v_and_b32 v125, 0xffff0000, v128
  v_lshlrev_b32 v132, 16, v130
  v_and_b32 v133, 0xffff0000, v130
  v_lshlrev_b32 v126, 16, v129
  v_and_b32 v127, 0xffff0000, v129
  v_lshlrev_b32 v134, 16, v131
  v_and_b32 v135, 0xffff0000, v131
  v_add_f32 v124, v124, v132
  v_add_f32 v125, v125, v133
  v_add_f32 v126, v126, v134
  v_add_f32 v127, v127, v135
  v_cvt_pk_bf16_f32 v110, v124, v125
  v_cvt_pk_bf16_f32 v111, v126, v127
  ds_write_b64 v46, v[110:111] offset:1024
  v_lshlrev_b32 v124, 16, v112
  v_and_b32 v125, 0xffff0000, v112
  v_lshlrev_b32 v126, 16, v113
  v_and_b32 v127, 0xffff0000, v113
  v_mul_f32 v124, v124, v33
  v_mul_f32 v125, v125, v33
  v_mul_f32 v126, v126, v33
  v_mul_f32 v127, v127, v33
  v_cvt_pk_bf16_f32 v128, v124, v125
  v_cvt_pk_bf16_f32 v129, v126, v127
  v_cvt_pk_bf16_f32 v130, v68, v69
  v_cvt_pk_bf16_f32 v131, v70, v71
  v_lshlrev_b32 v124, 16, v128
  v_and_b32 v125, 0xffff0000, v128
  v_lshlrev_b32 v132, 16, v130
  v_and_b32 v133, 0xffff0000, v130
  v_lshlrev_b32 v126, 16, v129
  v_and_b32 v127, 0xffff0000, v129
  v_lshlrev_b32 v134, 16, v131
  v_and_b32 v135, 0xffff0000, v131
  v_add_f32 v124, v124, v132
  v_add_f32 v125, v125, v133
  v_add_f32 v126, v126, v134
  v_add_f32 v127, v127, v135
  v_cvt_pk_bf16_f32 v112, v124, v125
  v_cvt_pk_bf16_f32 v113, v126, v127
  ds_write_b64 v46, v[112:113] offset:1536
  v_lshlrev_b32 v124, 16, v114
  v_and_b32 v125, 0xffff0000, v114
  v_lshlrev_b32 v126, 16, v115
  v_and_b32 v127, 0xffff0000, v115
  v_mul_f32 v124, v124, v33
  v_mul_f32 v125, v125, v33
  v_mul_f32 v126, v126, v33
  v_mul_f32 v127, v127, v33
  v_cvt_pk_bf16_f32 v128, v124, v125
  v_cvt_pk_bf16_f32 v129, v126, v127
  v_cvt_pk_bf16_f32 v130, v72, v73
  v_cvt_pk_bf16_f32 v131, v74, v75
  v_lshlrev_b32 v124, 16, v128
  v_and_b32 v125, 0xffff0000, v128
  v_lshlrev_b32 v132, 16, v130
  v_and_b32 v133, 0xffff0000, v130
  v_lshlrev_b32 v126, 16, v129
  v_and_b32 v127, 0xffff0000, v129
  v_lshlrev_b32 v134, 16, v131
  v_and_b32 v135, 0xffff0000, v131
  v_add_f32 v124, v124, v132
  v_add_f32 v125, v125, v133
  v_add_f32 v126, v126, v134
  v_add_f32 v127, v127, v135
  v_cvt_pk_bf16_f32 v114, v124, v125
  v_cvt_pk_bf16_f32 v115, v126, v127
  ds_write_b64 v46, v[114:115] offset:2048
  v_lshlrev_b32 v124, 16, v116
  v_and_b32 v125, 0xffff0000, v116
  v_lshlrev_b32 v126, 16, v117
  v_and_b32 v127, 0xffff0000, v117
  v_mul_f32 v124, v124, v33
  v_mul_f32 v125, v125, v33
  v_mul_f32 v126, v126, v33
  v_mul_f32 v127, v127, v33
  v_cvt_pk_bf16_f32 v128, v124, v125
  v_cvt_pk_bf16_f32 v129, v126, v127
  v_cvt_pk_bf16_f32 v130, v76, v77
  v_cvt_pk_bf16_f32 v131, v78, v79
  v_lshlrev_b32 v124, 16, v128
  v_and_b32 v125, 0xffff0000, v128
  v_lshlrev_b32 v132, 16, v130
  v_and_b32 v133, 0xffff0000, v130
  v_lshlrev_b32 v126, 16, v129
  v_and_b32 v127, 0xffff0000, v129
  v_lshlrev_b32 v134, 16, v131
  v_and_b32 v135, 0xffff0000, v131
  v_add_f32 v124, v124, v132
  v_add_f32 v125, v125, v133
  v_add_f32 v126, v126, v134
  v_add_f32 v127, v127, v135
  v_cvt_pk_bf16_f32 v116, v124, v125
  v_cvt_pk_bf16_f32 v117, v126, v127
  ds_write_b64 v46, v[116:117] offset:2560
  v_lshlrev_b32 v124, 16, v118
  v_and_b32 v125, 0xffff0000, v118
  v_lshlrev_b32 v126, 16, v119
  v_and_b32 v127, 0xffff0000, v119
  v_mul_f32 v124, v124, v33
  v_mul_f32 v125, v125, v33
  v_mul_f32 v126, v126, v33
  v_mul_f32 v127, v127, v33
  v_cvt_pk_bf16_f32 v128, v124, v125
  v_cvt_pk_bf16_f32 v129, v126, v127
  v_cvt_pk_bf16_f32 v130, v80, v81
  v_cvt_pk_bf16_f32 v131, v82, v83
  v_lshlrev_b32 v124, 16, v128
  v_and_b32 v125, 0xffff0000, v128
  v_lshlrev_b32 v132, 16, v130
  v_and_b32 v133, 0xffff0000, v130
  v_lshlrev_b32 v126, 16, v129
  v_and_b32 v127, 0xffff0000, v129
  v_lshlrev_b32 v134, 16, v131
  v_and_b32 v135, 0xffff0000, v131
  v_add_f32 v124, v124, v132
  v_add_f32 v125, v125, v133
  v_add_f32 v126, v126, v134
  v_add_f32 v127, v127, v135
  v_cvt_pk_bf16_f32 v118, v124, v125
  v_cvt_pk_bf16_f32 v119, v126, v127
  ds_write_b64 v46, v[118:119] offset:3072
  v_lshlrev_b32 v124, 16, v120
  v_and_b32 v125, 0xffff0000, v120
  v_lshlrev_b32 v126, 16, v121
  v_and_b32 v127, 0xffff0000, v121
  v_mul_f32 v124, v124, v33
  v_mul_f32 v125, v125, v33
  v_mul_f32 v126, v126, v33
  v_mul_f32 v127, v127, v33
  v_cvt_pk_bf16_f32 v128, v124, v125
  v_cvt_pk_bf16_f32 v129, v126, v127
  v_cvt_pk_bf16_f32 v130, v84, v85
  v_cvt_pk_bf16_f32 v131, v86, v87
  v_lshlrev_b32 v124, 16, v128
  v_and_b32 v125, 0xffff0000, v128
  v_lshlrev_b32 v132, 16, v130
  v_and_b32 v133, 0xffff0000, v130
  v_lshlrev_b32 v126, 16, v129
  v_and_b32 v127, 0xffff0000, v129
  v_lshlrev_b32 v134, 16, v131
  v_and_b32 v135, 0xffff0000, v131
  v_add_f32 v124, v124, v132
  v_add_f32 v125, v125, v133
  v_add_f32 v126, v126, v134
  v_add_f32 v127, v127, v135
  v_cvt_pk_bf16_f32 v120, v124, v125
  v_cvt_pk_bf16_f32 v121, v126, v127
  ds_write_b64 v46, v[120:121] offset:3584
  v_lshlrev_b32 v124, 16, v122
  v_and_b32 v125, 0xffff0000, v122
  v_lshlrev_b32 v126, 16, v123
  v_and_b32 v127, 0xffff0000, v123
  v_mul_f32 v124, v124, v33
  v_mul_f32 v125, v125, v33
  v_mul_f32 v126, v126, v33
  v_mul_f32 v127, v127, v33
  v_cvt_pk_bf16_f32 v128, v124, v125
  v_cvt_pk_bf16_f32 v129, v126, v127
  v_cvt_pk_bf16_f32 v130, v88, v89
  v_cvt_pk_bf16_f32 v131, v90, v91
  v_lshlrev_b32 v124, 16, v128
  v_and_b32 v125, 0xffff0000, v128
  v_lshlrev_b32 v132, 16, v130
  v_and_b32 v133, 0xffff0000, v130
  v_lshlrev_b32 v126, 16, v129
  v_and_b32 v127, 0xffff0000, v129
  v_lshlrev_b32 v134, 16, v131
  v_and_b32 v135, 0xffff0000, v131
  v_add_f32 v124, v124, v132
  v_add_f32 v125, v125, v133
  v_add_f32 v126, v126, v134
  v_add_f32 v127, v127, v135
  v_cvt_pk_bf16_f32 v122, v124, v125
  v_cvt_pk_bf16_f32 v123, v126, v127
  ds_write_b64 v46, v[122:123] offset:4096
  s_waitcnt lgkmcnt(0)
  s_barrier
  v_lshlrev_b32 v6, 3, v0
  v_mul_u32_u24 v5, 7168, v0
  v_add_u32 v36, 512, v6
  ds_read_b64 v[8:9], v36
  v_add_u32 v36, 25088, v6
  ds_read_b64 v[10:11], v36
  v_add_u32 v36, 49664, v6
  ds_read_b64 v[12:13], v36
  v_add_u32 v36, 74240, v6
  ds_read_b64 v[14:15], v36
  s_waitcnt lgkmcnt(0)
  s_add_u32 s22, s21, 0
  s_add_u32 s23, s22, 3584
  v_perm_b32 v16, v10, v8, s24
  v_perm_b32 v17, v14, v12, s24
  buffer_store_dwordx2 v[16:17], v5, s[88:91], s22 offen offset:0
  v_perm_b32 v18, v10, v8, s25
  v_perm_b32 v19, v14, v12, s25
  buffer_store_dwordx2 v[18:19], v5, s[88:91], s22 offen offset:1792
  v_perm_b32 v20, v11, v9, s24
  v_perm_b32 v21, v15, v13, s24
  buffer_store_dwordx2 v[20:21], v5, s[88:91], s23 offen offset:0
  v_perm_b32 v22, v11, v9, s25
  v_perm_b32 v23, v15, v13, s25
  buffer_store_dwordx2 v[22:23], v5, s[88:91], s23 offen offset:1792
  v_add_u32 v36, 2560, v6
  ds_read_b64 v[8:9], v36
  v_add_u32 v36, 27136, v6
  ds_read_b64 v[10:11], v36
  v_add_u32 v36, 51712, v6
  ds_read_b64 v[12:13], v36
  v_add_u32 v36, 76288, v6
  ds_read_b64 v[14:15], v36
  s_waitcnt lgkmcnt(0)
  s_add_u32 s22, s21, 1835008
  s_add_u32 s23, s22, 3584
  v_perm_b32 v24, v10, v8, s24
  v_perm_b32 v25, v14, v12, s24
  buffer_store_dwordx2 v[24:25], v5, s[88:91], s22 offen offset:0
  v_perm_b32 v26, v10, v8, s25
  v_perm_b32 v27, v14, v12, s25
  buffer_store_dwordx2 v[26:27], v5, s[88:91], s22 offen offset:1792
  v_perm_b32 v28, v11, v9, s24
  v_perm_b32 v29, v15, v13, s24
  buffer_store_dwordx2 v[28:29], v5, s[88:91], s23 offen offset:0
  v_perm_b32 v30, v11, v9, s25
  v_perm_b32 v31, v15, v13, s25
  buffer_store_dwordx2 v[30:31], v5, s[88:91], s23 offen offset:1792
  s_branch wk_loop
wk_tok:
  s_sub_u32 s3, s3, 752
  s_cmp_ge_u32 s3, 512
  s_cbranch_scc1 wk_done
  s_lshr_b32 s17, s3, 3
  s_and_b32 s18, s3, 3
  s_bitcmp1_b32 s3, 2
  s_cbranch_scc1 wk_toko
  s_lshl_b32 s20, s18, 2
  s_add_u32 s20, s20, s16
  s_lshl_b32 s21, s17, 4
  s_add_u32 s21, s21, s20
  s_mul_i32 s21, s21, 28672
  s_add_u32 s21, s21, 12845056
  s_mul_i32 s23, s17, 28672
  s_add_u32 s23, s23, 73859072
  s_mul_i32 s24, s17, 7168
  s_add_u32 s24, s24, 88002560
  s_lshr_b32 s25, s17, 3
  s_lshl_b32 s25, s25, 4
  s_add_u32 s25, s25, s20
  s_lshl_b32 s25, s25, 7
  s_add_u32 s25, s25, 88477696
  v_mov_b32 v60, 0
  s_mov_b32 s30, 0
wp_wf:
  buffer_load_dword v61, v60, s[8:11], s25 offen sc1
  s_waitcnt vmcnt(0)
  v_cmp_ne_u32 vcc, 56, v61
  s_cbranch_vccz wp_wf_ok
  s_sleep 4
  s_cmp_ge_u32 s17, 56
  s_cbranch_scc1 wp_wf_bo
  s_sleep 127
wp_wf_bo:
  s_add_u32 s30, s30, 1
  s_cmp_lt_u32 s30, 2000000
  s_cbranch_scc1 wp_wf
  s_branch wp_abort
wp_wf_ok:
  s_lshl_b32 s25, s17, 1
  s_mul_i32 s25, s25, 20480
  s_add_u32 s25, s25, 85381120
  s_lshl_b32 s26, s20, 10
  s_add_u32 s26, s26, s25
  s_lshl_b32 s27, s18, 10
  s_add_u32 s27, s27, s25
  s_lshr_b32 s28, s16, 1
  s_lshl_b32 s28, s28, 3
  s_add_u32 s27, s27, s28
  s_add_u32 s27, s27, 16384
  s_and_b32 s28, s16, 1
  s_cmp_eq_u32 s28, 0
  s_cselect_b32 s50, -1, 0
  s_cselect_b32 s51, 0, -1
  v_mov_b32 v44, -1
  v_mov_b32 v45, -1
  v_mov_b32 v46, -1
  v_mov_b32 v47, -1
  s_add_u32 s28, s26, 0
  s_add_u32 s29, s27, 0
  buffer_store_dwordx4 v[44:47], v2, s[8:11], s28 offen sc1
  s_mov_b64 exec, s[50:51]
  buffer_store_dwordx2 v[44:45], v2, s[8:11], s29 offen sc1
  s_mov_b64 exec, -1
  s_add_u32 s28, s26, 20480
  s_add_u32 s29, s27, 20480
  buffer_store_dwordx4 v[44:47], v2, s[8:11], s28 offen sc1
  s_mov_b64 exec, s[50:51]
  buffer_store_dwordx2 v[44:45], v2, s[8:11], s29 offen sc1
  s_mov_b64 exec, -1
  s_add_u32 s22, s21, 0
  buffer_load_dwordx4 a[0:3], v2, s[8:11], s22 offen offset:0 sc1
  buffer_load_dwordx4 a[4:7], v2, s[8:11], s22 offen offset:1024 sc1
  buffer_load_dwordx4 a[8:11], v2, s[8:11], s22 offen offset:2048 sc1
  buffer_load_dwordx4 a[12:15], v2, s[8:11], s22 offen offset:3072 sc1
  s_add_u32 s22, s21, 4096
  buffer_load_dwordx4 a[16:19], v2, s[8:11], s22 offen offset:0 sc1
  buffer_load_dwordx4 a[20:23], v2, s[8:11], s22 offen offset:1024 sc1
  buffer_load_dwordx4 a[24:27], v2, s[8:11], s22 offen offset:2048 sc1
  buffer_load_dwordx4 a[28:31], v2, s[8:11], s22 offen offset:3072 sc1
  s_add_u32 s22, s21, 8192
  buffer_load_dwordx4 a[32:35], v2, s[8:11], s22 offen offset:0 sc1
  buffer_load_dwordx4 a[36:39], v2, s[8:11], s22 offen offset:1024 sc1
  buffer_load_dwordx4 a[40:43], v2, s[8:11], s22 offen offset:2048 sc1
  buffer_load_dwordx4 a[44:47], v2, s[8:11], s22 offen offset:3072 sc1
  s_add_u32 s22, s21, 12288
  buffer_load_dwordx4 a[48:51], v2, s[8:11], s22 offen offset:0 sc1
  buffer_load_dwordx4 a[52:55], v2, s[8:11], s22 offen offset:1024 sc1
  buffer_load_dwordx4 a[56:59], v2, s[8:11], s22 offen offset:2048 sc1
  buffer_load_dwordx4 a[60:63], v2, s[8:11], s22 offen offset:3072 sc1
  s_add_u32 s22, s21, 16384
  buffer_load_dwordx4 a[64:67], v2, s[8:11], s22 offen offset:0 sc1
  buffer_load_dwordx4 a[68:71], v2, s[8:11], s22 offen offset:1024 sc1
  buffer_load_dwordx4 a[72:75], v2, s[8:11], s22 offen offset:2048 sc1
  buffer_load_dwordx4 a[76:79], v2, s[8:11], s22 offen offset:3072 sc1
  s_add_u32 s22, s21, 20480
  buffer_load_dwordx4 a[80:83], v2, s[8:11], s22 offen offset:0 sc1
  buffer_load_dwordx4 a[84:87], v2, s[8:11], s22 offen offset:1024 sc1
  buffer_load_dwordx4 a[88:91], v2, s[8:11], s22 offen offset:2048 sc1
  buffer_load_dwordx4 a[92:95], v2, s[8:11], s22 offen offset:3072 sc1
  s_add_u32 s22, s21, 24576
  buffer_load_dwordx4 a[96:99], v2, s[8:11], s22 offen offset:0 sc1
  buffer_load_dwordx4 a[100:103], v2, s[8:11], s22 offen offset:1024 sc1
  buffer_load_dwordx4 a[104:107], v2, s[8:11], s22 offen offset:2048 sc1
  buffer_load_dwordx4 a[108:111], v2, s[8:11], s22 offen offset:3072 sc1
  s_add_u32 s22, s23, 0
  buffer_load_dwordx4 a[112:115], v2, s[8:11], s22 offen offset:0 sc1
  buffer_load_dwordx4 a[116:119], v2, s[8:11], s22 offen offset:1024 sc1
  buffer_load_dwordx4 a[120:123], v2, s[8:11], s22 offen offset:2048 sc1
  buffer_load_dwordx4 a[124:127], v2, s[8:11], s22 offen offset:3072 sc1
  s_add_u32 s22, s23, 4096
  buffer_load_dwordx4 a[128:131], v2, s[8:11], s22 offen offset:0 sc1
  buffer_load_dwordx4 a[132:135], v2, s[8:11], s22 offen offset:1024 sc1
  buffer_load_dwordx4 a[136:139], v2, s[8:11], s22 offen offset:2048 sc1
  buffer_load_dwordx4 a[140:143], v2, s[8:11], s22 offen offset:3072 sc1
  s_add_u32 s22, s23, 8192
  buffer_load_dwordx4 a[144:147], v2, s[8:11], s22 offen offset:0 sc1
  buffer_load_dwordx4 a[148:151], v2, s[8:11], s22 offen offset:1024 sc1
  buffer_load_dwordx4 a[152:155], v2, s[8:11], s22 offen offset:2048 sc1
  buffer_load_dwordx4 a[156:159], v2, s[8:11], s22 offen offset:3072 sc1
  s_add_u32 s22, s23, 12288
  buffer_load_dwordx4 a[160:163], v2, s[8:11], s22 offen offset:0 sc1
  buffer_load_dwordx4 a[164:167], v2, s[8:11], s22 offen offset:1024 sc1
  buffer_load_dwordx4 a[168:171], v2, s[8:11], s22 offen offset:2048 sc1
  buffer_load_dwordx4 a[172:175], v2, s[8:11], s22 offen offset:3072 sc1
  s_add_u32 s22, s23, 16384
  buffer_load_dwordx4 a[176:179], v2, s[8:11], s22 offen offset:0 sc1
  buffer_load_dwordx4 a[180:183], v2, s[8:11], s22 offen offset:1024 sc1
  buffer_load_dwordx4 a[184:187], v2, s[8:11], s22 offen offset:2048 sc1
  buffer_load_dwordx4 a[188:191], v2, s[8:11], s22 offen offset:3072 sc1
  s_add_u32 s22, s23, 20480
  buffer_load_dwordx4 a[192:195], v2, s[8:11], s22 offen offset:0 sc1
  buffer_load_dwordx4 a[196:199], v2, s[8:11], s22 offen offset:1024 sc1
  buffer_load_dwordx4 a[200:203], v2, s[8:11], s22 offen offset:2048 sc1
  buffer_load_dwordx4 a[204:207], v2, s[8:11], s22 offen offset:3072 sc1
  s_add_u32 s22, s23, 24576
  buffer_load_dwordx4 a[208:211], v2, s[8:11], s22 offen offset:0 sc1
  buffer_load_dwordx4 a[212:215], v2, s[8:11], s22 offen offset:1024 sc1
  buffer_load_dwordx4 a[216:219], v2, s[8:11], s22 offen offset:2048 sc1
  buffer_load_dwordx4 a[220:223], v2, s[8:11], s22 offen offset:3072 sc1
  v_lshl_add_u32 v5, v3, 2, 0
  v_cmp_le_u32 s[40:41], v5, v4
  v_lshl_add_u32 v5, v3, 2, 1
  v_cmp_le_u32 s[42:43], v5, v4
  v_lshl_add_u32 v5, v3, 2, 2
  v_cmp_le_u32 s[44:45], v5, v4
  v_lshl_add_u32 v5, v3, 2, 3
  v_cmp_le_u32 s[46:47], v5, v4
  v_cmp_gt_u32 s[48:49], 2, v3
  v_mov_b32 v6, 0xff800000
  s_waitcnt vmcnt(0)
  s_lshl_b32 s25, s17, 7
  s_add_u32 s25, s25, 88494080
  v_mov_b32 v5, 1
  v_mov_b32 v7, 0
  s_waitcnt vmcnt(0)
  s_mov_b64 exec, 1
  buffer_atomic_add v5, v7, s[8:11], s25 offen
  s_mov_b64 exec, -1
  v_mfma_f32_16x16x32_bf16 v[8:11], a[112:115], a[0:3], 0
  v_mfma_f32_16x16x32_bf16 v[12:15], a[112:115], a[56:59], 0
  v_mfma_f32_16x16x32_bf16 v[16:19], a[168:171], a[56:59], 0
  v_mfma_f32_16x16x32_bf16 v[8:11], a[116:119], a[4:7], v[8:11]
  v_mfma_f32_16x16x32_bf16 v[12:15], a[116:119], a[60:63], v[12:15]
  v_mfma_f32_16x16x32_bf16 v[16:19], a[172:175], a[60:63], v[16:19]
  v_mfma_f32_16x16x32_bf16 v[8:11], a[120:123], a[8:11], v[8:11]
  v_mfma_f32_16x16x32_bf16 v[12:15], a[120:123], a[64:67], v[12:15]
  v_mfma_f32_16x16x32_bf16 v[16:19], a[176:179], a[64:67], v[16:19]
  v_mfma_f32_16x16x32_bf16 v[8:11], a[124:127], a[12:15], v[8:11]
  v_mfma_f32_16x16x32_bf16 v[12:15], a[124:127], a[68:71], v[12:15]
  v_mfma_f32_16x16x32_bf16 v[16:19], a[180:183], a[68:71], v[16:19]
  v_mfma_f32_16x16x32_bf16 v[8:11], a[128:131], a[16:19], v[8:11]
  v_mfma_f32_16x16x32_bf16 v[12:15], a[128:131], a[72:75], v[12:15]
  v_mfma_f32_16x16x32_bf16 v[16:19], a[184:187], a[72:75], v[16:19]
  v_mfma_f32_16x16x32_bf16 v[8:11], a[132:135], a[20:23], v[8:11]
  v_mfma_f32_16x16x32_bf16 v[12:15], a[132:135], a[76:79], v[12:15]
  v_mfma_f32_16x16x32_bf16 v[16:19], a[188:191], a[76:79], v[16:19]
  v_mfma_f32_16x16x32_bf16 v[8:11], a[136:139], a[24:27], v[8:11]
  v_mfma_f32_16x16x32_bf16 v[12:15], a[136:139], a[80:83], v[12:15]
  v_mfma_f32_16x16x32_bf16 v[16:19], a[192:195], a[80:83], v[16:19]
  v_mfma_f32_16x16x32_bf16 v[8:11], a[140:143], a[28:31], v[8:11]
  v_mfma_f32_16x16x32_bf16 v[12:15], a[140:143], a[84:87], v[12:15]
  v_mfma_f32_16x16x32_bf16 v[16:19], a[196:199], a[84:87], v[16:19]
  v_mfma_f32_16x16x32_bf16 v[8:11], a[144:147], a[32:35], v[8:11]
  v_mfma_f32_16x16x32_bf16 v[12:15], a[144:147], a[88:91], v[12:15]
  v_mfma_f32_16x16x32_bf16 v[16:19], a[200:203], a[88:91], v[16:19]
  v_mfma_f32_16x16x32_bf16 v[8:11], a[148:151], a[36:39], v[8:11]
  v_mfma_f32_16x16x32_bf16 v[12:15], a[148:151], a[92:95], v[12:15]
  v_mfma_f32_16x16x32_bf16 v[16:19], a[204:207], a[92:95], v[16:19]
  v_mfma_f32_16x16x32_bf16 v[8:11], a[152:155], a[40:43], v[8:11]
  v_mfma_f32_16x16x32_bf16 v[12:15], a[152:155], a[96:99], v[12:15]
  v_mfma_f32_16x16x32_bf16 v[16:19], a[208:211], a[96:99], v[16:19]
  v_mfma_f32_16x16x32_bf16 v[8:11], a[156:159], a[44:47], v[8:11]
  v_mfma_f32_16x16x32_bf16 v[12:15], a[156:159], a[100:103], v[12:15]
  v_mfma_f32_16x16x32_bf16 v[16:19], a[212:215], a[100:103], v[16:19]
  v_mfma_f32_16x16x32_bf16 v[8:11], a[160:163], a[48:51], v[8:11]
  v_mfma_f32_16x16x32_bf16 v[12:15], a[160:163], a[104:107], v[12:15]
  v_mfma_f32_16x16x32_bf16 v[16:19], a[216:219], a[104:107], v[16:19]
  v_mfma_f32_16x16x32_bf16 v[8:11], a[164:167], a[52:55], v[8:11]
  v_mfma_f32_16x16x32_bf16 v[12:15], a[164:167], a[108:111], v[12:15]
  v_mfma_f32_16x16x32_bf16 v[16:19], a[220:223], a[108:111], v[16:19]
  s_mul_i32 s22, s20, 448
  v_mov_b32 v62, s22
  s_mov_b32 s30, 0
wp_pm:
  s_cmp_ge_u32 s17, 64
  s_cbranch_scc1 wp_pf
  buffer_load_dword v61, v62, s[8:11], s24 offen sc1
  s_waitcnt vmcnt(0)
  v_cmp_eq_u32 vcc, -1, v61
  s_cbranch_vccnz wp_pr
wp_pf:
  s_add_u32 s22, s24, 4096
  buffer_load_dwordx4 v[64:67], v2, s[8:11], s24 offen offset:0 sc1
  buffer_load_dwordx4 v[68:71], v2, s[8:11], s24 offen offset:1024 sc1
  buffer_load_dwordx4 v[72:75], v2, s[8:11], s24 offen offset:2048 sc1
  buffer_load_dwordx4 v[76:79], v2, s[8:11], s24 offen offset:3072 sc1
  buffer_load_dwordx4 v[80:83], v2, s[8:11], s22 offen offset:0 sc1
  buffer_load_dwordx4 v[84:87], v2, s[8:11], s22 offen offset:1024 sc1
  buffer_load_dwordx4 v[88:91], v2, s[8:11], s22 offen offset:2048 sc1
  s_waitcnt vmcnt(0)
  v_max_u32 v61, v64, v65
  v_max3_u32 v61, v61, v66, v67
  v_max3_u32 v61, v61, v68, v69
  v_max3_u32 v61, v61, v70, v71
  v_max3_u32 v61, v61, v72, v73
  v_max3_u32 v61, v61, v74, v75
  v_max3_u32 v61, v61, v76, v77
  v_max3_u32 v61, v61, v78, v79
  v_max3_u32 v61, v61, v80, v81
  v_max3_u32 v61, v61, v82, v83
  v_max3_u32 v61, v61, v84, v85
  v_max3_u32 v61, v61, v86, v87
  v_max3_u32 v61, v61, v88, v89
  v_max3_u32 v61, v61, v90, v91
  v_cmp_eq_u32 vcc, -1, v61
  s_cbranch_vccz wp_pk
wp_pr:
  s_sleep 4
  s_cmp_ge_u32 s17, 56
  s_cbranch_scc1 wp_pm_bo
  s_sleep 127
wp_pm_bo:
  s_add_u32 s30, s30, 1
  s_cmp_lt_u32 s30, 2000000
  s_cbranch_scc1 wp_pm
  s_branch wp_abort
wp_pk:
  buffer_load_dword v250, v251, s[8:11], 0 offen sc1
  v_mfma_f32_16x16x32_bf16 v[20:23], v[64:67], a[0:3], 0
  v_mfma_f32_16x16x32_bf16 v[24:27], v[64:67], a[4:7], 0
  v_mfma_f32_16x16x32_bf16 v[28:31], v[64:67], a[56:59], 0
  v_mfma_f32_16x16x32_bf16 v[32:35], v[64:67], a[60:63], 0
  v_mfma_f32_16x16x32_bf16 v[20:23], v[68:71], a[8:11], v[20:23]
  v_mfma_f32_16x16x32_bf16 v[24:27], v[68:71], a[12:15], v[24:27]
  v_mfma_f32_16x16x32_bf16 v[28:31], v[68:71], a[64:67], v[28:31]
  v_mfma_f32_16x16x32_bf16 v[32:35], v[68:71], a[68:71], v[32:35]
  v_mfma_f32_16x16x32_bf16 v[20:23], v[72:75], a[16:19], v[20:23]
  v_mfma_f32_16x16x32_bf16 v[24:27], v[72:75], a[20:23], v[24:27]
  v_mfma_f32_16x16x32_bf16 v[28:31], v[72:75], a[72:75], v[28:31]
  v_mfma_f32_16x16x32_bf16 v[32:35], v[72:75], a[76:79], v[32:35]
  v_mfma_f32_16x16x32_bf16 v[20:23], v[76:79], a[24:27], v[20:23]
  v_mfma_f32_16x16x32_bf16 v[24:27], v[76:79], a[28:31], v[24:27]
  v_mfma_f32_16x16x32_bf16 v[28:31], v[76:79], a[80:83], v[28:31]
  v_mfma_f32_16x16x32_bf16 v[32:35], v[76:79], a[84:87], v[32:35]
  v_mfma_f32_16x16x32_bf16 v[20:23], v[80:83], a[32:35], v[20:23]
  v_mfma_f32_16x16x32_bf16 v[24:27], v[80:83], a[36:39], v[24:27]
  v_mfma_f32_16x16x32_bf16 v[28:31], v[80:83], a[88:91], v[28:31]
  v_mfma_f32_16x16x32_bf16 v[32:35], v[80:83], a[92:95], v[32:35]
  v_mfma_f32_16x16x32_bf16 v[20:23], v[84:87], a[40:43], v[20:23]
  v_mfma_f32_16x16x32_bf16 v[24:27], v[84:87], a[44:47], v[24:27]
  v_mfma_f32_16x16x32_bf16 v[28:31], v[84:87], a[96:99], v[28:31]
  v_mfma_f32_16x16x32_bf16 v[32:35], v[84:87], a[100:103], v[32:35]
  v_mfma_f32_16x16x32_bf16 v[20:23], v[88:91], a[48:51], v[20:23]
  v_mfma_f32_16x16x32_bf16 v[24:27], v[88:91], a[52:55], v[24:27]
  v_mfma_f32_16x16x32_bf16 v[28:31], v[88:91], a[104:107], v[28:31]
  v_mfma_f32_16x16x32_bf16 v[32:35], v[88:91], a[108:111], v[32:35]
  v_cndmask_b32 v8, v6, v8, s[40:41]
  v_cndmask_b32 v9, v6, v9, s[42:43]
  v_cndmask_b32 v10, v6, v10, s[44:45]
  v_cndmask_b32 v11, v6, v11, s[46:47]
  v_cndmask_b32 v20, v24, v20, s[48:49]
  v_cndmask_b32 v21, v25, v21, s[48:49]
  v_cndmask_b32 v22, v26, v22, s[48:49]
  v_cndmask_b32 v23, v27, v23, s[48:49]
  v_mov_b32 v24, v20
  v_mov_b32 v25, v21
  v_mov_b32 v26, v22
  v_mov_b32 v27, v23
  v_permlane32_swap_b32 v20, v24
  v_permlane32_swap_b32 v21, v25
  v_permlane32_swap_b32 v22, v26
  v_permlane32_swap_b32 v23, v27
  v_add_f32 v20, v20, v24
  v_add_f32 v21, v21, v25
  v_add_f32 v22, v22, v26
  v_add_f32 v23, v23, v27
  v_max3_f32 v40, v8, v9, v10
  v_max3_f32 v40, v40, v11, v20
  v_max3_f32 v40, v40, v21, v22
  v_max_f32 v40, v40, v23
  v_mov_b32 v41, v40
  s_nop 1
  v_permlane16_swap_b32 v40, v41
  v_max_f32 v40, v40, v41
  v_mov_b32 v41, v40
  s_nop 1
  v_permlane32_swap_b32 v40, v41
  v_max_f32 v40, v40, v41
  v_sub_f32 v8, v8, v40
  v_sub_f32 v9, v9, v40
  v_sub_f32 v10, v10, v40
  v_sub_f32 v11, v11, v40
  v_sub_f32 v20, v20, v40
  v_sub_f32 v21, v21, v40
  v_sub_f32 v22, v22, v40
  v_sub_f32 v23, v23, v40
  v_exp_f32 v8, v8
  v_exp_f32 v9, v9
  v_exp_f32 v10, v10
  v_exp_f32 v11, v11
  v_exp_f32 v20, v20
  v_exp_f32 v21, v21
  v_exp_f32 v22, v22
  v_exp_f32 v23, v23
  v_add_f32 v42, v20, v21
  v_add_f32 v43, v22, v23
  v_add_f32 v42, v42, v43
  v_mul_f32 v42, 0.5, v42
  v_add_f32 v42, v42, v8
  v_add_f32 v42, v42, v9
  v_add_f32 v42, v42, v10
  v_add_f32 v42, v42, v11
  v_mov_b32 v41, v42
  s_nop 1
  v_permlane16_swap_b32 v42, v41
  v_add_f32 v42, v42, v41
  v_mov_b32 v41, v42
  s_nop 1
  v_permlane32_swap_b32 v42, v41
  v_add_f32 v42, v42, v41
  v_rcp_f32 v42, v42
  s_nop 0
  v_mul_f32 v8, v8, v42
  v_mul_f32 v9, v9, v42
  v_mul_f32 v10, v10, v42
  v_mul_f32 v11, v11, v42
  v_mul_f32 v20, v20, v42
  v_mul_f32 v21, v21, v42
  v_mul_f32 v22, v22, v42
  v_mul_f32 v23, v23, v42
  v_cvt_pk_bf16_f32 v44, v8, 0
  v_cvt_pk_bf16_f32 v45, v9, 0
  v_cvt_pk_bf16_f32 v46, v10, 0
  v_cvt_pk_bf16_f32 v47, v11, 0
  v_cvt_pk_bf16_f32 v48, v20, v21
  v_cvt_pk_bf16_f32 v49, v22, v23
  v_min_u32 v44, -2, v44
  v_min_u32 v45, -2, v45
  v_min_u32 v46, -2, v46
  v_min_u32 v47, -2, v47
  v_min_u32 v48, -2, v48
  v_min_u32 v49, -2, v49
  buffer_store_dwordx4 v[44:47], v2, s[8:11], s26 offen sc1
  s_mov_b64 exec, s[50:51]
  buffer_store_dwordx2 v[48:49], v2, s[8:11], s27 offen sc1
  s_mov_b64 exec, -1
  s_add_u32 s26, s26, 20480
  s_add_u32 s27, s27, 20480
  v_cndmask_b32 v16, v6, v16, s[40:41]
  v_cndmask_b32 v17, v6, v17, s[42:43]
  v_cndmask_b32 v18, v6, v18, s[44:45]
  v_cndmask_b32 v19, v6, v19, s[46:47]
  v_cndmask_b32 v28, v32, v28, s[48:49]
  v_cndmask_b32 v29, v33, v29, s[48:49]
  v_cndmask_b32 v30, v34, v30, s[48:49]
  v_cndmask_b32 v31, v35, v31, s[48:49]
  v_mov_b32 v32, v28
  v_mov_b32 v33, v29
  v_mov_b32 v34, v30
  v_mov_b32 v35, v31
  v_permlane32_swap_b32 v28, v32
  v_permlane32_swap_b32 v29, v33
  v_permlane32_swap_b32 v30, v34
  v_permlane32_swap_b32 v31, v35
  v_add_f32 v28, v28, v32
  v_add_f32 v29, v29, v33
  v_add_f32 v30, v30, v34
  v_add_f32 v31, v31, v35
  v_max3_f32 v40, v12, v13, v14
  v_max3_f32 v40, v40, v15, v16
  v_max3_f32 v40, v40, v17, v18
  v_max3_f32 v40, v40, v19, v28
  v_max3_f32 v40, v40, v29, v30
  v_max_f32 v40, v40, v31
  v_mov_b32 v41, v40
  s_nop 1
  v_permlane16_swap_b32 v40, v41
  v_max_f32 v40, v40, v41
  v_mov_b32 v41, v40
  s_nop 1
  v_permlane32_swap_b32 v40, v41
  v_max_f32 v40, v40, v41
  v_sub_f32 v12, v12, v40
  v_sub_f32 v13, v13, v40
  v_sub_f32 v14, v14, v40
  v_sub_f32 v15, v15, v40
  v_sub_f32 v16, v16, v40
  v_sub_f32 v17, v17, v40
  v_sub_f32 v18, v18, v40
  v_sub_f32 v19, v19, v40
  v_sub_f32 v28, v28, v40
  v_sub_f32 v29, v29, v40
  v_sub_f32 v30, v30, v40
  v_sub_f32 v31, v31, v40
  v_exp_f32 v12, v12
  v_exp_f32 v13, v13
  v_exp_f32 v14, v14
  v_exp_f32 v15, v15
  v_exp_f32 v16, v16
  v_exp_f32 v17, v17
  v_exp_f32 v18, v18
  v_exp_f32 v19, v19
  v_exp_f32 v28, v28
  v_exp_f32 v29, v29
  v_exp_f32 v30, v30
  v_exp_f32 v31, v31
  v_add_f32 v42, v28, v29
  v_add_f32 v43, v30, v31
  v_add_f32 v42, v42, v43
  v_mul_f32 v42, 0.5, v42
  v_add_f32 v42, v42, v12
  v_add_f32 v42, v42, v13
  v_add_f32 v42, v42, v14
  v_add_f32 v42, v42, v15
  v_add_f32 v42, v42, v16
  v_add_f32 v42, v42, v17
  v_add_f32 v42, v42, v18
  v_add_f32 v42, v42, v19
  v_mov_b32 v41, v42
  s_nop 1
  v_permlane16_swap_b32 v42, v41
  v_add_f32 v42, v42, v41
  v_mov_b32 v41, v42
  s_nop 1
  v_permlane32_swap_b32 v42, v41
  v_add_f32 v42, v42, v41
  v_rcp_f32 v42, v42
  s_nop 0
  v_mul_f32 v12, v12, v42
  v_mul_f32 v13, v13, v42
  v_mul_f32 v14, v14, v42
  v_mul_f32 v15, v15, v42
  v_mul_f32 v16, v16, v42
  v_mul_f32 v17, v17, v42
  v_mul_f32 v18, v18, v42
  v_mul_f32 v19, v19, v42
  v_mul_f32 v28, v28, v42
  v_mul_f32 v29, v29, v42
  v_mul_f32 v30, v30, v42
  v_mul_f32 v31, v31, v42
  v_cvt_pk_bf16_f32 v52, v12, v16
  v_cvt_pk_bf16_f32 v53, v13, v17
  v_cvt_pk_bf16_f32 v54, v14, v18
  v_cvt_pk_bf16_f32 v55, v15, v19
  v_cvt_pk_bf16_f32 v56, v28, v29
  v_cvt_pk_bf16_f32 v57, v30, v31
  v_min_u32 v52, -2, v52
  v_min_u32 v53, -2, v53
  v_min_u32 v54, -2, v54
  v_min_u32 v55, -2, v55
  v_min_u32 v56, -2, v56
  v_min_u32 v57, -2, v57
  buffer_store_dwordx4 v[52:55], v2, s[8:11], s26 offen sc1
  s_mov_b64 exec, s[50:51]
  buffer_store_dwordx2 v[56:57], v2, s[8:11], s27 offen sc1
  s_mov_b64 exec, -1
  s_branch wk_loop
wk_toko:
  s_load_dwordx2 s[36:37], s[0:1], 112
  s_waitcnt lgkmcnt(0)
  s_mov_b32 s92, s36
  s_and_b32 s93, s37, 0xffff
  s_mov_b32 s94, 3670016
  s_mov_b32 s95, 0x20000
  s_lshl_b32 s20, s18, 2
  s_add_u32 s20, s20, s16
  s_mul_i32 s24, s20, 65
  s_add_u32 s24, s24, s17
  s_lshl_b32 s24, s24, 13
  s_add_u32 s24, s24, 76869632
  s_mul_i32 s21, s20, 28672
  s_mul_i32 s22, s17, 458752
  s_add_u32 s21, s21, s22
  s_add_u32 s21, s21, 42205184
  s_lshl_b32 s25, s17, 1
  s_mul_i32 s25, s25, 20480
  s_add_u32 s25, s25, 85381120
  v_mov_b32 v5, v2
  v_min_u32 v6, 11, v4
  v_mad_u32_u24 v6, v3, 12, v6
  v_lshlrev_b32 v6, 4, v6
  v_add_u32 v6, 1024, v6
  v_lshrrev_b32 v8, 1, v3
  v_lshl_add_u32 v8, v8, 4, v4
  v_lshlrev_b32 v8, 4, v8
  v_and_b32 v9, 1, v3
  v_lshl_add_u32 v7, v9, 3, v8
  s_lshr_b32 s26, s17, 3
  s_lshl_b32 s26, s26, 4
  s_add_u32 s26, s26, s20
  s_lshl_b32 s26, s26, 7
  s_add_u32 s26, s26, 88461312
  v_mov_b32 v60, 0
  s_mov_b32 s30, 0
wo_wv:
  buffer_load_dword v61, v60, s[8:11], s26 offen sc1
  s_waitcnt vmcnt(0)
  v_cmp_ne_u32 vcc, 56, v61
  s_cbranch_vccz wo_wv_ok
  s_sleep 4
  s_cmp_ge_u32 s17, 56
  s_cbranch_scc1 wo_wv_bo
  s_sleep 127
wo_wv_bo:
  s_add_u32 s30, s30, 1
  s_cmp_lt_u32 s30, 2000000
  s_cbranch_scc1 wo_wv
  s_branch wo_abort
wo_wv_ok:
  s_add_u32 s22, s21, 0
  buffer_load_dwordx4 a[0:3], v5, s[8:11], s22 offen offset:0 sc1
  buffer_load_dwordx4 a[4:7], v6, s[8:11], s22 offen offset:0 sc1
  buffer_load_dwordx4 a[8:11], v5, s[8:11], s22 offen offset:1792 sc1
  buffer_load_dwordx4 a[12:15], v6, s[8:11], s22 offen offset:1792 sc1
  s_add_u32 s22, s21, 3584
  buffer_load_dwordx4 a[16:19], v5, s[8:11], s22 offen offset:0 sc1
  buffer_load_dwordx4 a[20:23], v6, s[8:11], s22 offen offset:0 sc1
  buffer_load_dwordx4 a[24:27], v5, s[8:11], s22 offen offset:1792 sc1
  buffer_load_dwordx4 a[28:31], v6, s[8:11], s22 offen offset:1792 sc1
  s_add_u32 s22, s21, 7168
  buffer_load_dwordx4 a[32:35], v5, s[8:11], s22 offen offset:0 sc1
  buffer_load_dwordx4 a[36:39], v6, s[8:11], s22 offen offset:0 sc1
  buffer_load_dwordx4 a[40:43], v5, s[8:11], s22 offen offset:1792 sc1
  buffer_load_dwordx4 a[44:47], v6, s[8:11], s22 offen offset:1792 sc1
  s_add_u32 s22, s21, 10752
  buffer_load_dwordx4 a[48:51], v5, s[8:11], s22 offen offset:0 sc1
  buffer_load_dwordx4 a[52:55], v6, s[8:11], s22 offen offset:0 sc1
  buffer_load_dwordx4 a[56:59], v5, s[8:11], s22 offen offset:1792 sc1
  buffer_load_dwordx4 a[60:63], v6, s[8:11], s22 offen offset:1792 sc1
  s_add_u32 s22, s21, 14336
  buffer_load_dwordx4 a[64:67], v5, s[8:11], s22 offen offset:0 sc1
  buffer_load_dwordx4 a[68:71], v6, s[8:11], s22 offen offset:0 sc1
  buffer_load_dwordx4 a[72:75], v5, s[8:11], s22 offen offset:1792 sc1
  buffer_load_dwordx4 a[76:79], v6, s[8:11], s22 offen offset:1792 sc1
  s_add_u32 s22, s21, 17920
  buffer_load_dwordx4 a[80:83], v5, s[8:11], s22 offen offset:0 sc1
  buffer_load_dwordx4 a[84:87], v6, s[8:11], s22 offen offset:0 sc1
  buffer_load_dwordx4 a[88:91], v5, s[8:11], s22 offen offset:1792 sc1
  buffer_load_dwordx4 a[92:95], v6, s[8:11], s22 offen offset:1792 sc1
  s_add_u32 s22, s21, 21504
  buffer_load_dwordx4 a[96:99], v5, s[8:11], s22 offen offset:0 sc1
  buffer_load_dwordx4 a[100:103], v6, s[8:11], s22 offen offset:0 sc1
  buffer_load_dwordx4 a[104:107], v5, s[8:11], s22 offen offset:1792 sc1
  buffer_load_dwordx4 a[108:111], v6, s[8:11], s22 offen offset:1792 sc1
  s_add_u32 s22, s21, 25088
  buffer_load_dwordx4 a[112:115], v5, s[8:11], s22 offen offset:0 sc1
  buffer_load_dwordx4 a[116:119], v6, s[8:11], s22 offen offset:0 sc1
  buffer_load_dwordx4 a[120:123], v5, s[8:11], s22 offen offset:1792 sc1
  buffer_load_dwordx4 a[124:127], v6, s[8:11], s22 offen offset:1792 sc1
  s_lshl_b32 s26, s20, 6
  s_add_u32 s26, s26, s17
  s_lshl_b32 s26, s26, 4
  s_add_u32 s26, s26, 88502272
  v_lshlrev_b32 v60, 2, v3
  s_mov_b32 s30, 0
wo_wt:
  buffer_load_dword v61, v60, s[8:11], s26 offen sc1
  s_waitcnt vmcnt(0)
  v_cmp_ne_u32 vcc, 1, v61
  s_cbranch_vccz wo_wt_ok
  s_sleep 4
  s_cmp_ge_u32 s17, 56
  s_cbranch_scc1 wo_wt_bo
  s_sleep 127
wo_wt_bo:
  s_add_u32 s30, s30, 1
  s_cmp_lt_u32 s30, 2000000
  s_cbranch_scc1 wo_wt
  s_branch wo_abort
wo_wt_ok:
  s_lshl_b32 s26, s17, 7
  s_add_u32 s26, s26, 88494080
  v_mov_b32 v60, 0
  s_mov_b32 s30, 0
wo_wp:
  buffer_load_dword v61, v60, s[8:11], s26 offen sc1
  s_waitcnt vmcnt(0)
  v_cmp_ne_u32 vcc, 16, v61
  s_cbranch_vccz wo_wp_ok
  s_sleep 4
  s_cmp_ge_u32 s17, 56
  s_cbranch_scc1 wo_wp_bo
  s_sleep 127
wo_wp_bo:
  s_add_u32 s30, s30, 1
  s_cmp_lt_u32 s30, 2000000
  s_cbranch_scc1 wo_wp
  s_branch wo_abort
wo_wp_ok:
  s_lshl_b32 s28, s16, 12
  s_add_u32 s26, s25, s28
  s_add_u32 s27, s26, 20480
  s_lshl_b32 s28, s16, 10
  s_add_u32 s28, s28, s25
  s_add_u32 s28, s28, 16384
  s_add_u32 s29, s28, 20480
  s_add_u32 s23, s24, 4096
  s_mov_b32 s30, 0
wo_pl:
  buffer_load_dwordx4 v[64:67], v2, s[8:11], s26 offen offset:0 sc1
  buffer_load_dwordx4 v[68:71], v2, s[8:11], s26 offen offset:1024 sc1
  buffer_load_dwordx4 v[72:75], v2, s[8:11], s26 offen offset:2048 sc1
  buffer_load_dwordx4 v[76:79], v2, s[8:11], s26 offen offset:3072 sc1
  buffer_load_dwordx4 v[80:83], v2, s[8:11], s28 offen sc1
  buffer_load_dwordx4 v[84:87], v2, s[8:11], s27 offen offset:0 sc1
  buffer_load_dwordx4 v[88:91], v2, s[8:11], s27 offen offset:1024 sc1
  buffer_load_dwordx4 v[92:95], v2, s[8:11], s27 offen offset:2048 sc1
  buffer_load_dwordx4 v[96:99], v2, s[8:11], s27 offen offset:3072 sc1
  buffer_load_dwordx4 v[100:103], v2, s[8:11], s29 offen sc1
  buffer_load_dwordx2 v[28:29], v7, s[8:11], s24 offen offset:0 sc1
  buffer_load_dwordx2 v[30:31], v7, s[8:11], s24 offen offset:512 sc1
  buffer_load_dwordx2 v[32:33], v7, s[8:11], s24 offen offset:1024 sc1
  buffer_load_dwordx2 v[34:35], v7, s[8:11], s24 offen offset:1536 sc1
  buffer_load_dwordx2 v[36:37], v7, s[8:11], s24 offen offset:2048 sc1
  buffer_load_dwordx2 v[38:39], v7, s[8:11], s24 offen offset:2560 sc1
  buffer_load_dwordx2 v[40:41], v7, s[8:11], s24 offen offset:3072 sc1
  buffer_load_dwordx2 v[42:43], v7, s[8:11], s24 offen offset:3584 sc1
  buffer_load_dwordx2 v[44:45], v7, s[8:11], s23 offen offset:0 sc1
  buffer_load_dwordx2 v[46:47], v7, s[8:11], s23 offen offset:512 sc1
  buffer_load_dwordx2 v[48:49], v7, s[8:11], s23 offen offset:1024 sc1
  buffer_load_dwordx2 v[50:51], v7, s[8:11], s23 offen offset:1536 sc1
  buffer_load_dwordx2 v[52:53], v7, s[8:11], s23 offen offset:2048 sc1
  buffer_load_dwordx2 v[54:55], v7, s[8:11], s23 offen offset:2560 sc1
  buffer_load_dwordx2 v[56:57], v7, s[8:11], s23 offen offset:3072 sc1
  buffer_load_dwordx2 v[58:59], v7, s[8:11], s23 offen offset:3584 sc1
  s_waitcnt vmcnt(16)
  v_max_u32 v61, v64, v65
  v_max3_u32 v61, v61, v66, v67
  v_max3_u32 v61, v61, v68, v69
  v_max3_u32 v61, v61, v70, v71
  v_max3_u32 v61, v61, v72, v73
  v_max3_u32 v61, v61, v74, v75
  v_max3_u32 v61, v61, v76, v77
  v_max3_u32 v61, v61, v78, v79
  v_max3_u32 v61, v61, v80, v81
  v_max3_u32 v61, v61, v82, v83
  v_max3_u32 v61, v61, v84, v85
  v_max3_u32 v61, v61, v86, v87
  v_max3_u32 v61, v61, v88, v89
  v_max3_u32 v61, v61, v90, v91
  v_max3_u32 v61, v61, v92, v93
  v_max3_u32 v61, v61, v94, v95
  v_max3_u32 v61, v61, v96, v97
  v_max3_u32 v61, v61, v98, v99
  v_max3_u32 v61, v61, v100, v101
  v_max3_u32 v61, v61, v102, v103
  s_mul_i32 s22, s16, 10240
  v_add_u32 v62, s22, v2
  ds_write_b128 v62, v[64:67] offset:0
  ds_write_b128 v62, v[68:71] offset:1024
  ds_write_b128 v62, v[72:75] offset:2048
  ds_write_b128 v62, v[76:79] offset:3072
  ds_write_b128 v62, v[80:83] offset:4096
  ds_write_b128 v62, v[84:87] offset:5120
  ds_write_b128 v62, v[88:91] offset:6144
  ds_write_b128 v62, v[92:95] offset:7168
  ds_write_b128 v62, v[96:99] offset:8192
  ds_write_b128 v62, v[100:103] offset:9216
  s_waitcnt vmcnt(0)
  v_max3_u32 v61, v61, v28, v29
  v_max3_u32 v61, v61, v30, v31
  v_max3_u32 v61, v61, v32, v33
  v_max3_u32 v61, v61, v34, v35
  v_max3_u32 v61, v61, v36, v37
  v_max3_u32 v61, v61, v38, v39
  v_max3_u32 v61, v61, v40, v41
  v_max3_u32 v61, v61, v42, v43
  v_max3_u32 v61, v61, v44, v45
  v_max3_u32 v61, v61, v46, v47
  v_max3_u32 v61, v61, v48, v49
  v_max3_u32 v61, v61, v50, v51
  v_max3_u32 v61, v61, v52, v53
  v_max3_u32 v61, v61, v54, v55
  v_max3_u32 v61, v61, v56, v57
  v_max3_u32 v61, v61, v58, v59
  v_cmp_eq_u32 vcc, -1, v61
  s_cbranch_vccz wo_pk
  s_waitcnt lgkmcnt(0)
  s_sleep 1
  s_cmp_ge_u32 s17, 56
  s_cbranch_scc1 wo_pl_bo
  s_sleep 127
wo_pl_bo:
  s_add_u32 s30, s30, 1
  s_cmp_lt_u32 s30, 2000000
  s_cbranch_scc1 wo_pl
  s_branch wo_abort
wo_pk:
  buffer_load_dword v250, v251, s[8:11], 0 offen sc1
  s_waitcnt lgkmcnt(0)
  s_barrier
  ds_read_b128 v[64:67], v2 offset:0
  ds_read_b128 v[68:71], v2 offset:5120
  ds_read_b128 v[72:75], v2 offset:1024
  ds_read_b128 v[76:79], v2 offset:6144
  ds_read_b128 v[80:83], v2 offset:2048
  ds_read_b128 v[84:87], v2 offset:7168
  ds_read_b128 v[88:91], v2 offset:3072
  ds_read_b128 v[92:95], v2 offset:8192
  s_waitcnt lgkmcnt(7)
  v_mfma_f32_16x16x32_bf16 v[12:15], a[0:3], v[64:67], 0
  ds_read_b128 v[96:99], v2 offset:4096
  v_mfma_f32_16x16x32_bf16 v[20:23], a[4:7], v[64:67], 0
  s_waitcnt lgkmcnt(7)
  v_mfma_f32_16x16x32_bf16 v[16:19], a[0:3], v[68:71], 0
  ds_read_b128 v[100:103], v2 offset:9216
  v_mfma_f32_16x16x32_bf16 v[24:27], a[4:7], v[68:71], 0
  s_waitcnt lgkmcnt(7)
  v_mfma_f32_16x16x32_bf16 v[12:15], a[8:11], v[72:75], v[12:15]
  ds_read_b128 v[64:67], v2 offset:10240
  v_mfma_f32_16x16x32_bf16 v[20:23], a[12:15], v[72:75], v[20:23]
  s_waitcnt lgkmcnt(7)
  v_mfma_f32_16x16x32_bf16 v[16:19], a[8:11], v[76:79], v[16:19]
  ds_read_b128 v[68:71], v2 offset:15360
  v_mfma_f32_16x16x32_bf16 v[24:27], a[12:15], v[76:79], v[24:27]
  s_waitcnt lgkmcnt(7)
  v_mfma_f32_16x16x32_bf16 v[12:15], a[16:19], v[80:83], v[12:15]
  ds_read_b128 v[72:75], v2 offset:11264
  v_mfma_f32_16x16x32_bf16 v[20:23], a[20:23], v[80:83], v[20:23]
  s_waitcnt lgkmcnt(7)
  v_mfma_f32_16x16x32_bf16 v[16:19], a[16:19], v[84:87], v[16:19]
  ds_read_b128 v[76:79], v2 offset:16384
  v_mfma_f32_16x16x32_bf16 v[24:27], a[20:23], v[84:87], v[24:27]
  s_waitcnt lgkmcnt(7)
  v_mfma_f32_16x16x32_bf16 v[12:15], a[24:27], v[88:91], v[12:15]
  ds_read_b128 v[80:83], v2 offset:12288
  v_mfma_f32_16x16x32_bf16 v[20:23], a[28:31], v[88:91], v[20:23]
  s_waitcnt lgkmcnt(7)
  v_mfma_f32_16x16x32_bf16 v[16:19], a[24:27], v[92:95], v[16:19]
  ds_read_b128 v[84:87], v2 offset:17408
  v_mfma_f32_16x16x32_bf16 v[24:27], a[28:31], v[92:95], v[24:27]
  s_waitcnt lgkmcnt(7)
  v_mfma_f32_16x16x32_bf16 v[12:15], v[28:31], v[96:99], v[12:15]
  ds_read_b128 v[88:91], v2 offset:13312
  v_mfma_f32_16x16x32_bf16 v[20:23], v[32:35], v[96:99], v[20:23]
  s_waitcnt lgkmcnt(7)
  v_mfma_f32_16x16x32_bf16 v[16:19], v[28:31], v[100:103], v[16:19]
  ds_read_b128 v[92:95], v2 offset:18432
  v_mfma_f32_16x16x32_bf16 v[24:27], v[32:35], v[100:103], v[24:27]
  s_waitcnt lgkmcnt(7)
  v_mfma_f32_16x16x32_bf16 v[12:15], a[32:35], v[64:67], v[12:15]
  ds_read_b128 v[96:99], v2 offset:14336
  v_mfma_f32_16x16x32_bf16 v[20:23], a[36:39], v[64:67], v[20:23]
  s_waitcnt lgkmcnt(7)
  v_mfma_f32_16x16x32_bf16 v[16:19], a[32:35], v[68:71], v[16:19]
  ds_read_b128 v[100:103], v2 offset:19456
  v_mfma_f32_16x16x32_bf16 v[24:27], a[36:39], v[68:71], v[24:27]
  s_waitcnt lgkmcnt(7)
  v_mfma_f32_16x16x32_bf16 v[12:15], a[40:43], v[72:75], v[12:15]
  ds_read_b128 v[64:67], v2 offset:20480
  v_mfma_f32_16x16x32_bf16 v[20:23], a[44:47], v[72:75], v[20:23]
  s_waitcnt lgkmcnt(7)
  v_mfma_f32_16x16x32_bf16 v[16:19], a[40:43], v[76:79], v[16:19]
  ds_read_b128 v[68:71], v2 offset:25600
  v_mfma_f32_16x16x32_bf16 v[24:27], a[44:47], v[76:79], v[24:27]
  s_waitcnt lgkmcnt(7)
  v_mfma_f32_16x16x32_bf16 v[12:15], a[48:51], v[80:83], v[12:15]
  ds_read_b128 v[72:75], v2 offset:21504
  v_mfma_f32_16x16x32_bf16 v[20:23], a[52:55], v[80:83], v[20:23]
  s_waitcnt lgkmcnt(7)
  v_mfma_f32_16x16x32_bf16 v[16:19], a[48:51], v[84:87], v[16:19]
  ds_read_b128 v[76:79], v2 offset:26624
  v_mfma_f32_16x16x32_bf16 v[24:27], a[52:55], v[84:87], v[24:27]
  s_waitcnt lgkmcnt(7)
  v_mfma_f32_16x16x32_bf16 v[12:15], a[56:59], v[88:91], v[12:15]
  ds_read_b128 v[80:83], v2 offset:22528
  v_mfma_f32_16x16x32_bf16 v[20:23], a[60:63], v[88:91], v[20:23]
  s_waitcnt lgkmcnt(7)
  v_mfma_f32_16x16x32_bf16 v[16:19], a[56:59], v[92:95], v[16:19]
  ds_read_b128 v[84:87], v2 offset:27648
  v_mfma_f32_16x16x32_bf16 v[24:27], a[60:63], v[92:95], v[24:27]
  s_waitcnt lgkmcnt(7)
  v_mfma_f32_16x16x32_bf16 v[12:15], v[36:39], v[96:99], v[12:15]
  ds_read_b128 v[88:91], v2 offset:23552
  v_mfma_f32_16x16x32_bf16 v[20:23], v[40:43], v[96:99], v[20:23]
  s_waitcnt lgkmcnt(7)
  v_mfma_f32_16x16x32_bf16 v[16:19], v[36:39], v[100:103], v[16:19]
  ds_read_b128 v[92:95], v2 offset:28672
  v_mfma_f32_16x16x32_bf16 v[24:27], v[40:43], v[100:103], v[24:27]
  s_waitcnt lgkmcnt(7)
  v_mfma_f32_16x16x32_bf16 v[12:15], a[64:67], v[64:67], v[12:15]
  ds_read_b128 v[96:99], v2 offset:24576
  v_mfma_f32_16x16x32_bf16 v[20:23], a[68:71], v[64:67], v[20:23]
  s_waitcnt lgkmcnt(7)
  v_mfma_f32_16x16x32_bf16 v[16:19], a[64:67], v[68:71], v[16:19]
  ds_read_b128 v[100:103], v2 offset:29696
  v_mfma_f32_16x16x32_bf16 v[24:27], a[68:71], v[68:71], v[24:27]
  s_waitcnt lgkmcnt(7)
  v_mfma_f32_16x16x32_bf16 v[12:15], a[72:75], v[72:75], v[12:15]
  ds_read_b128 v[64:67], v2 offset:30720
  v_mfma_f32_16x16x32_bf16 v[20:23], a[76:79], v[72:75], v[20:23]
  s_waitcnt lgkmcnt(7)
  v_mfma_f32_16x16x32_bf16 v[16:19], a[72:75], v[76:79], v[16:19]
  ds_read_b128 v[68:71], v2 offset:35840
  v_mfma_f32_16x16x32_bf16 v[24:27], a[76:79], v[76:79], v[24:27]
  s_waitcnt lgkmcnt(7)
  v_mfma_f32_16x16x32_bf16 v[12:15], a[80:83], v[80:83], v[12:15]
  ds_read_b128 v[72:75], v2 offset:31744
  v_mfma_f32_16x16x32_bf16 v[20:23], a[84:87], v[80:83], v[20:23]
  s_waitcnt lgkmcnt(7)
  v_mfma_f32_16x16x32_bf16 v[16:19], a[80:83], v[84:87], v[16:19]
  ds_read_b128 v[76:79], v2 offset:36864
  v_mfma_f32_16x16x32_bf16 v[24:27], a[84:87], v[84:87], v[24:27]
  s_waitcnt lgkmcnt(7)
  v_mfma_f32_16x16x32_bf16 v[12:15], a[88:91], v[88:91], v[12:15]
  ds_read_b128 v[80:83], v2 offset:32768
  v_mfma_f32_16x16x32_bf16 v[20:23], a[92:95], v[88:91], v[20:23]
  s_waitcnt lgkmcnt(7)
  v_mfma_f32_16x16x32_bf16 v[16:19], a[88:91], v[92:95], v[16:19]
  ds_read_b128 v[84:87], v2 offset:37888
  v_mfma_f32_16x16x32_bf16 v[24:27], a[92:95], v[92:95], v[24:27]
  s_waitcnt lgkmcnt(7)
  v_mfma_f32_16x16x32_bf16 v[12:15], v[44:47], v[96:99], v[12:15]
  ds_read_b128 v[88:91], v2 offset:33792
  v_mfma_f32_16x16x32_bf16 v[20:23], v[48:51], v[96:99], v[20:23]
  s_waitcnt lgkmcnt(7)
  v_mfma_f32_16x16x32_bf16 v[16:19], v[44:47], v[100:103], v[16:19]
  ds_read_b128 v[92:95], v2 offset:38912
  v_mfma_f32_16x16x32_bf16 v[24:27], v[48:51], v[100:103], v[24:27]
  s_waitcnt lgkmcnt(7)
  v_mfma_f32_16x16x32_bf16 v[12:15], a[96:99], v[64:67], v[12:15]
  ds_read_b128 v[96:99], v2 offset:34816
  v_mfma_f32_16x16x32_bf16 v[20:23], a[100:103], v[64:67], v[20:23]
  s_waitcnt lgkmcnt(7)
  v_mfma_f32_16x16x32_bf16 v[16:19], a[96:99], v[68:71], v[16:19]
  ds_read_b128 v[100:103], v2 offset:39936
  v_mfma_f32_16x16x32_bf16 v[24:27], a[100:103], v[68:71], v[24:27]
  s_waitcnt lgkmcnt(7)
  v_mfma_f32_16x16x32_bf16 v[12:15], a[104:107], v[72:75], v[12:15]
  v_mfma_f32_16x16x32_bf16 v[20:23], a[108:111], v[72:75], v[20:23]
  s_waitcnt lgkmcnt(6)
  v_mfma_f32_16x16x32_bf16 v[16:19], a[104:107], v[76:79], v[16:19]
  v_mfma_f32_16x16x32_bf16 v[24:27], a[108:111], v[76:79], v[24:27]
  s_waitcnt lgkmcnt(5)
  v_mfma_f32_16x16x32_bf16 v[12:15], a[112:115], v[80:83], v[12:15]
  v_mfma_f32_16x16x32_bf16 v[20:23], a[116:119], v[80:83], v[20:23]
  s_waitcnt lgkmcnt(4)
  v_mfma_f32_16x16x32_bf16 v[16:19], a[112:115], v[84:87], v[16:19]
  v_mfma_f32_16x16x32_bf16 v[24:27], a[116:119], v[84:87], v[24:27]
  s_waitcnt lgkmcnt(3)
  v_mfma_f32_16x16x32_bf16 v[12:15], a[120:123], v[88:91], v[12:15]
  v_mfma_f32_16x16x32_bf16 v[20:23], a[124:127], v[88:91], v[20:23]
  s_waitcnt lgkmcnt(2)
  v_mfma_f32_16x16x32_bf16 v[16:19], a[120:123], v[92:95], v[16:19]
  v_mfma_f32_16x16x32_bf16 v[24:27], a[124:127], v[92:95], v[24:27]
  s_waitcnt lgkmcnt(1)
  v_mfma_f32_16x16x32_bf16 v[12:15], v[52:55], v[96:99], v[12:15]
  v_mfma_f32_16x16x32_bf16 v[20:23], v[56:59], v[96:99], v[20:23]
  s_waitcnt lgkmcnt(0)
  v_mfma_f32_16x16x32_bf16 v[16:19], v[52:55], v[100:103], v[16:19]
  v_mfma_f32_16x16x32_bf16 v[24:27], v[56:59], v[100:103], v[24:27]
  v_mul_u32_u24 v9, 1792, v4
  v_lshl_add_u32 v9, v3, 3, v9
  s_lshl_b32 s22, s20, 5
  v_add_u32 v8, s22, v9
  s_mul_i32 s22, s20, 24
  s_add_u32 s22, s22, 512
  v_add_u32 v9, s22, v9
  v_mov_b32 v10, 0x40000000
  v_cmp_eq_u32 vcc, 3, v3
  s_nop 1
  v_cndmask_b32 v9, v9, v10, vcc
  s_mul_i32 s26, s17, 57344
  s_add_u32 s26, s26, 896
  s_add_u32 s27, s26, 28672
  v_cvt_pk_bf16_f32 v108, v12, v13
  v_cvt_pk_bf16_f32 v109, v14, v15
  buffer_store_dwordx2 v[108:109], v8, s[92:95], s26 offen
  v_cvt_pk_bf16_f32 v110, v20, v21
  v_cvt_pk_bf16_f32 v111, v22, v23
  buffer_store_dwordx2 v[110:111], v9, s[92:95], s26 offen
  v_cvt_pk_bf16_f32 v112, v16, v17
  v_cvt_pk_bf16_f32 v113, v18, v19
  buffer_store_dwordx2 v[112:113], v8, s[92:95], s27 offen
  v_cvt_pk_bf16_f32 v114, v24, v25
  v_cvt_pk_bf16_f32 v115, v26, v27
  buffer_store_dwordx2 v[114:115], v9, s[92:95], s27 offen
  s_branch wk_loop
wp_abort:
wo_abort:
  s_branch cA_abort
wk_done:
ch_end:
  s_endpgm

.section .rodata,"a"
.p2align 6
.amdhsa_kernel main_kernel
  .amdhsa_next_free_vgpr 512
  .amdhsa_next_free_sgpr 102
  .amdhsa_accum_offset 256
  .amdhsa_group_segment_fixed_size 0
  .amdhsa_kernarg_size 136
  .amdhsa_user_sgpr_count 2
  .amdhsa_user_sgpr_kernarg_segment_ptr 1
  .amdhsa_system_sgpr_workgroup_id_x 1
.end_amdhsa_kernel
```

```asm
; @launch kernel=main_kernel grid=(256,1,1) block=(256,1,1) lds=163840
.amdgcn_target "amdgcn-amd-amdhsa--gfx950"
.text
.globl main_kernel
.p2align 8
.type main_kernel,@function
main_kernel:
  s_cmp_ge_u32 s2, 256
  s_cbranch_scc1 ch_end
  s_load_dwordx2 s[4:5], s[0:1], 120
  s_load_dwordx2 s[6:7], s[0:1], 128
  s_load_dwordx8 s[40:47], s[0:1], 72
  s_load_dwordx4 s[48:51], s[0:1], 56
  s_mov_b32 s32, 0
  s_getreg_b32 s3, hwreg(HW_REG_XCC_ID)
  s_and_b32 s3, s3, 15
  s_cmp_lg_u32 s3, 0
  s_cbranch_scc1 ch_pf
  s_cmp_lt_u32 s2, 224
  s_cbranch_scc1 ch_npf
ch_pf:
  s_getpc_b64 s[98:99]
pf_main_kernel_1:
  s_sub_u32 s98, s98, pf_main_kernel_1-main_kernel
  s_subb_u32 s99, s99, 0
  v_lshlrev_b32 v60, 7, v0
  v_min_u32 v61, ch_end-main_kernel-4, v60
  global_load_dword v62, v61, s[98:99]
  v_add_u32 v60, 32768, v60
  v_min_u32 v61, ch_end-main_kernel-4, v60
  global_load_dword v62, v61, s[98:99]
  v_add_u32 v60, 32768, v60
  v_min_u32 v61, ch_end-main_kernel-4, v60
  global_load_dword v62, v61, s[98:99]
  v_add_u32 v60, 32768, v60
  v_min_u32 v61, ch_end-main_kernel-4, v60
  global_load_dword v62, v61, s[98:99]
  v_add_u32 v60, 32768, v60
  v_min_u32 v61, ch_end-main_kernel-4, v60
  global_load_dword v62, v61, s[98:99]
  v_add_u32 v60, 32768, v60
ch_npf:
  v_lshrrev_b32 v1, 6, v0
  s_nop 0
  v_readfirstlane_b32 s16, v1
  s_waitcnt lgkmcnt(0)
  s_mov_b32 s8, s6
  s_and_b32 s9, s7, 0xffff
  s_mov_b32 s10, 0x10000000
  s_mov_b32 s11, 0x20000
  s_mov_b32 s12, s4
  s_and_b32 s13, s5, 0xffff
  s_mov_b32 s14, 256
  s_mov_b32 s15, 0x20000
  v_mov_b32 v252, 0x40000000
  v_cmp_eq_u32 vcc, 0, v0
  s_nop 1
  v_cndmask_b32 v252, v252, v0, vcc
  s_cmp_lg_u32 s3, 0
  s_cbranch_scc1 ch_worker
  s_mov_b32 s18, 0
  v_mov_b32 v249, 1
  s_mov_b64 exec, 1
  buffer_atomic_add v249, v252, s[12:15], 0 offen sc0
  s_mov_b64 exec, -1
  v_and_b32 v1, 63, v0
  v_lshlrev_b32 v2, 4, v1
  v_lshrrev_b32 v3, 4, v1
  v_and_b32 v4, 15, v1
  s_lshr_b32 s33, s2, 3
  s_lshl_b32 s27, s33, 2
  s_add_u32 s27, s27, s16
  s_lshl_b32 s27, s27, 13
  v_lshlrev_b32 v12, 7, v1
  s_mov_b32 s64, s42
  s_and_b32 s65, s43, 0xffff
  s_mov_b32 s66, 2097152
  s_mov_b32 s67, 0x20000
  s_mov_b32 s28, s27
  buffer_load_dword v13, v12, s[64:67], s28 offen
  s_add_u32 s28, s28, 1048576
  buffer_load_dword v13, v12, s[64:67], s28 offen
  s_add_u32 s28, s28, 1048576
  s_waitcnt vmcnt(2)
  v_readfirstlane_b32 s17, v249
  v_mov_b32 v6, 160032
  s_nop 0
  v_mov_b32 v7, s17
  s_barrier
  s_cmp_lg_u32 s16, 0
  s_cbranch_scc1 uni_2
  ds_write_b32 v6, v7
  s_waitcnt lgkmcnt(0)
uni_2:
  s_barrier
  ds_read_b32 v7, v6
  s_waitcnt lgkmcnt(0)
  v_readfirstlane_b32 s17, v7
  s_branch ch_got
ch_take:
  v_mov_b32 v5, 0
  v_mov_b32 v6, 160000
  s_barrier
  s_cmp_lg_u32 s16, 0
  s_cbranch_scc1 ch_el1
  s_mov_b64 exec, 1
  buffer_atomic_add v4, v5, s[12:15], 0 offen sc0
  s_waitcnt vmcnt(0)
  ds_write_b32 v6, v4
  s_waitcnt lgkmcnt(0)
  s_mov_b64 exec, -1
ch_el1:
  s_barrier
  ds_read_b32 v4, v6
  s_waitcnt lgkmcnt(0)
  v_readfirstlane_b32 s17, v4
ch_got:
  s_and_b32 s17, s17, 0xffff
  s_cmp_lt_u32 s17, 32
  s_cbranch_scc1 ch_role
  s_cmp_eq_u32 s18, 0
  s_cbranch_scc1 ch_worker
  v_and_b32 v1, 63, v0
  v_lshlrev_b32 v2, 4, v1
  v_lshrrev_b32 v3, 4, v1
  v_and_b32 v4, 15, v1
  s_branch wp_all
ch_role:
  v_and_b32 v1, 63, v0
  v_lshlrev_b32 v2, 4, v1
  v_lshrrev_b32 v3, 4, v1
  v_and_b32 v4, 15, v1
  s_cmp_lt_u32 s17, 16
  s_cbranch_scc1 ch_self
  s_cmp_lt_u32 s17, 28
  s_cbranch_scc1 ch_tch
  s_sub_u32 s33, s17, 28
  v_mov_b32 v10, 0x40000000
  v_mov_b32 v5, 1
  v_mov_b32 v148, 0
  v_mov_b32 v149, 0
  v_mov_b32 v150, 0
  v_mov_b32 v151, 0
  v_mov_b32 v152, -1
  v_mov_b32 v153, -1
  v_mov_b32 v154, -1
  v_mov_b32 v155, -1
  v_lshlrev_b32 v8, 4, v0
  s_cmp_lg_u32 s33, 0
  s_cbranch_scc1 ch_ij_1
  s_mov_b32 s23, 88519168
  buffer_store_dwordx4 v[148:151], v8, s[8:11], s23 offen sc1
  s_mov_b32 s23, 88523264
  buffer_store_dwordx4 v[148:151], v8, s[8:11], s23 offen sc1
  s_waitcnt vmcnt(0)
  s_barrier
  buffer_store_dword v5, v252, s[12:15], 0 offen offset:128 sc1
ch_ij_1:
  s_mov_b32 s68, s50
  s_and_b32 s69, s51, 0xffff
  s_mov_b32 s70, 7168
  s_mov_b32 s71, 0x20000
  v_lshrrev_b32 v6, 3, v0
  v_min_u32 v6, 27, v6
  v_and_b32 v7, 7, v0
  v_mul_u32_u24 v9, 896, v7
  v_lshl_add_u32 v9, v6, 5, v9
  buffer_load_dwordx4 v[176:179], v9, s[68:71], 0 offen
  buffer_load_dwordx4 v[180:183], v9, s[68:71], 0 offen offset:16
  s_lshl_b32 s20, s33, 12
  v_add_u32 v8, s20, v8
  s_mov_b32 s23, 88461312
ch_ijlp_3:
  buffer_store_dwordx4 v[148:151], v8, s[8:11], s23 offen sc1
  s_add_u32 s23, s23, 16384
  s_cmp_lt_u32 s23, 88510464
  s_cbranch_scc1 ch_ijlp_3
  v_cmp_gt_u32 vcc, 8704, v8
  s_nop 1
  v_cndmask_b32 v9, v10, v8, vcc
  buffer_store_dwordx4 v[148:151], v9, s[8:11], s23 offen sc1
  s_mov_b32 s23, 75729408
  v_cmp_gt_u32 vcc, 6144, v8
  s_nop 1
  v_cndmask_b32 v9, v10, v8, vcc
  buffer_store_dwordx4 v[148:151], v9, s[8:11], s23 offen sc1
  s_mov_b32 s23, 75701248
ch_ijlp_4:
  buffer_store_dwordx4 v[152:155], v8, s[8:11], s23 offen sc1
  s_add_u32 s23, s23, 16384
  s_cmp_lt_u32 s23, 75717632
  s_cbranch_scc1 ch_ijlp_4
  v_cmp_gt_u32 vcc, 11776, v8
  s_nop 1
  v_cndmask_b32 v9, v10, v8, vcc
  buffer_store_dwordx4 v[152:155], v9, s[8:11], s23 offen sc1
  s_mov_b32 s23, 88009728
ch_ijlp_5:
  buffer_store_dwordx4 v[152:155], v8, s[8:11], s23 offen sc1
  s_add_u32 s23, s23, 16384
  s_cmp_lt_u32 s23, 88452096
  s_cbranch_scc1 ch_ijlp_5
  v_cmp_gt_u32 vcc, 9216, v8
  s_nop 1
  v_cndmask_b32 v9, v10, v8, vcc
  buffer_store_dwordx4 v[152:155], v9, s[8:11], s23 offen sc1
  s_cmp_lg_u32 s33, 1
  s_cbranch_scc1 ch_ij_nm
  v_lshrrev_b32 v6, 3, v0
  v_and_b32 v7, 7, v0
  v_lshlrev_b32 v8, 8, v6
  v_lshl_add_u32 v8, v7, 4, v8
  v_cmp_gt_u32 vcc, 28, v6
  s_nop 1
  v_cndmask_b32 v8, v10, v8, vcc
  s_waitcnt vmcnt(4)
  v_mov_b32 v184, v176
  v_mov_b32 v188, v177
  v_mov_b32 v185, v178
  v_mov_b32 v189, v179
  v_mov_b32 v186, v180
  v_mov_b32 v190, v181
  v_mov_b32 v187, v182
  v_mov_b32 v191, v183
  s_mov_b32 s23, 75694080
  buffer_store_dwordx4 v[184:187], v8, s[8:11], s23 offen sc1
  buffer_store_dwordx4 v[188:191], v8, s[8:11], s23 offen offset:128 sc1
  s_mov_b32 s23, 88002560
  buffer_store_dwordx4 v[184:187], v8, s[8:11], s23 offen sc1
  buffer_store_dwordx4 v[188:191], v8, s[8:11], s23 offen offset:128 sc1
ch_ij_nm:
  s_waitcnt vmcnt(0)
  s_barrier
  s_cmp_lg_u32 s16, 0
  s_cbranch_scc1 ch_ij_e
  v_mov_b32 v6, 1
  s_mov_b64 exec, 1
  buffer_atomic_add v6, v252, s[12:15], 0 offen offset:12 sc0
  s_waitcnt vmcnt(0)
  v_readfirstlane_b32 s20, v6
  s_cmp_lg_u32 s20, 3
  s_cbranch_scc1 ch_ij_e0
  buffer_store_dword v5, v252, s[12:15], 0 offen offset:132 sc1
  s_mov_b64 exec, 0xff
  v_lshlrev_b32 v6, 7, v0
  s_mov_b32 s20, 88523264
  buffer_store_dword v5, v6, s[8:11], s20 offen offset:4 sc1
ch_ij_e0:
  s_mov_b64 exec, -1
ch_ij_e:
  s_branch ch_role2
ch_tch:
  s_sub_u32 s33, s17, 16
  s_lshl_b32 s27, s33, 2
  s_add_u32 s27, s27, s16
  s_lshl_b32 s27, s27, 13
  v_lshlrev_b32 v12, 7, v1
  s_mov_b32 s64, s40
  s_and_b32 s65, s41, 0xffff
  s_mov_b32 s66, 3670016
  s_mov_b32 s67, 0x20000
  s_mov_b32 s28, s27
  buffer_load_dword v13, v12, s[64:67], s28 offen
  s_add_u32 s28, s28, 393216
  buffer_load_dword v13, v12, s[64:67], s28 offen
  s_add_u32 s28, s28, 393216
  buffer_load_dword v13, v12, s[64:67], s28 offen
  s_add_u32 s28, s28, 393216
  buffer_load_dword v13, v12, s[64:67], s28 offen
  s_add_u32 s28, s28, 393216
  buffer_load_dword v13, v12, s[64:67], s28 offen
  s_add_u32 s28, s28, 393216
  buffer_load_dword v13, v12, s[64:67], s28 offen
  s_add_u32 s28, s28, 393216
  buffer_load_dword v13, v12, s[64:67], s28 offen
  s_add_u32 s28, s28, 393216
  buffer_load_dword v13, v12, s[64:67], s28 offen
  s_add_u32 s28, s28, 393216
  buffer_load_dword v13, v12, s[64:67], s28 offen
  s_add_u32 s28, s28, 393216
  buffer_load_dword v13, v12, s[64:67], s28 offen
  s_add_u32 s28, s28, 393216
  s_branch ch_role2
ch_self:
  v_lshrrev_b32 v5, 5, v1
  v_and_b32 v6, 31, v1
  v_xor_b32 v8, v6, v5
  v_lshlrev_b32 v8, 4, v8
  v_lshl_add_u32 v16, v5, 13, v8
  v_xor_b32 v17, 32, v16
  v_xor_b32 v18, 64, v16
  v_xor_b32 v19, 96, v16
  v_xor_b32 v20, 128, v16
  v_xor_b32 v21, 160, v16
  v_xor_b32 v22, 192, v16
  v_xor_b32 v23, 224, v16
  s_lshl_b32 s20, s16, 6
  v_xor_b32 v26, s20, v16
  v_xor_b32 v27, 32, v26
  s_mov_b32 s60, s40
  s_and_b32 s61, s41, 0xffff
  s_mov_b32 s62, 3670016
  s_mov_b32 s63, 0x20000
  s_mov_b32 s56, s42
  s_and_b32 s57, s43, 0xffff
  s_mov_b32 s58, 3670016
  s_mov_b32 s59, 0x20000
  s_lshl_b32 s26, s17, 9
  s_lshl_b32 s27, s16, 19
  s_add_u32 s27, s27, s26
  s_lshl_b32 s25, s16, 15
  s_add_u32 s25, s25, 32768
  s_barrier
  s_add_u32 m0, s25, 0
  s_nop 0
  buffer_load_dwordx4 v16, s[56:59], s27 offen lds
  s_add_u32 s27, s27, 16384
  s_add_u32 m0, s25, 1024
  s_nop 0
  buffer_load_dwordx4 v16, s[56:59], s27 offen lds
  s_add_u32 s27, s27, 16384
  s_add_u32 m0, s25, 2048
  s_nop 0
  buffer_load_dwordx4 v17, s[56:59], s27 offen lds
  s_add_u32 s27, s27, 16384
  s_add_u32 m0, s25, 3072
  s_nop 0
  buffer_load_dwordx4 v17, s[56:59], s27 offen lds
  s_add_u32 s27, s27, 16384
  s_add_u32 m0, s25, 4096
  s_nop 0
  buffer_load_dwordx4 v16, s[56:59], s27 offen lds
  s_add_u32 s27, s27, 16384
  s_add_u32 m0, s25, 5120
  s_nop 0
  buffer_load_dwordx4 v16, s[56:59], s27 offen lds
  s_add_u32 s27, s27, 16384
  s_add_u32 m0, s25, 6144
  s_nop 0
  buffer_load_dwordx4 v17, s[56:59], s27 offen lds
  s_add_u32 s27, s27, 16384
  s_add_u32 m0, s25, 7168
  s_nop 0
  buffer_load_dwordx4 v17, s[56:59], s27 offen lds
  s_add_u32 s27, s27, 16384
  s_add_u32 m0, s25, 8192
  s_nop 0
  buffer_load_dwordx4 v18, s[56:59], s27 offen lds
  s_add_u32 s27, s27, 16384
  s_add_u32 m0, s25, 9216
  s_nop 0
  buffer_load_dwordx4 v18, s[56:59], s27 offen lds
  s_add_u32 s27, s27, 16384
  s_add_u32 m0, s25, 10240
  s_nop 0
  buffer_load_dwordx4 v19, s[56:59], s27 offen lds
  s_add_u32 s27, s27, 16384
  s_add_u32 m0, s25, 11264
  s_nop 0
  buffer_load_dwordx4 v19, s[56:59], s27 offen lds
  s_add_u32 s27, s27, 16384
  s_add_u32 m0, s25, 12288
  s_nop 0
  buffer_load_dwordx4 v18, s[56:59], s27 offen lds
  s_add_u32 s27, s27, 16384
  s_add_u32 m0, s25, 13312
  s_nop 0
  buffer_load_dwordx4 v18, s[56:59], s27 offen lds
  s_add_u32 s27, s27, 16384
  s_add_u32 m0, s25, 14336
  s_nop 0
  buffer_load_dwordx4 v19, s[56:59], s27 offen lds
  s_add_u32 s27, s27, 16384
  s_add_u32 m0, s25, 15360
  s_nop 0
  buffer_load_dwordx4 v19, s[56:59], s27 offen lds
  s_add_u32 s27, s27, 16384
  s_add_u32 m0, s25, 16384
  s_nop 0
  buffer_load_dwordx4 v20, s[56:59], s27 offen lds
  s_add_u32 s27, s27, 16384
  s_add_u32 m0, s25, 17408
  s_nop 0
  buffer_load_dwordx4 v20, s[56:59], s27 offen lds
  s_add_u32 s27, s27, 16384
  s_add_u32 m0, s25, 18432
  s_nop 0
  buffer_load_dwordx4 v21, s[56:59], s27 offen lds
  s_add_u32 s27, s27, 16384
  s_add_u32 m0, s25, 19456
  s_nop 0
  buffer_load_dwordx4 v21, s[56:59], s27 offen lds
  s_add_u32 s27, s27, 16384
  s_add_u32 m0, s25, 20480
  s_nop 0
  buffer_load_dwordx4 v20, s[56:59], s27 offen lds
  s_add_u32 s27, s27, 16384
  s_add_u32 m0, s25, 21504
  s_nop 0
  buffer_load_dwordx4 v20, s[56:59], s27 offen lds
  s_add_u32 s27, s27, 16384
  s_add_u32 m0, s25, 22528
  s_nop 0
  buffer_load_dwordx4 v21, s[56:59], s27 offen lds
  s_add_u32 s27, s27, 16384
  s_add_u32 m0, s25, 23552
  s_nop 0
  buffer_load_dwordx4 v21, s[56:59], s27 offen lds
  s_add_u32 s27, s27, 16384
  s_add_u32 m0, s25, 24576
  s_nop 0
  buffer_load_dwordx4 v22, s[56:59], s27 offen lds
  s_add_u32 s27, s27, 16384
  s_add_u32 m0, s25, 25600
  s_nop 0
  buffer_load_dwordx4 v22, s[56:59], s27 offen lds
  s_add_u32 s27, s27, 16384
  s_add_u32 m0, s25, 26624
  s_nop 0
  buffer_load_dwordx4 v23, s[56:59], s27 offen lds
  s_add_u32 s27, s27, 16384
  s_add_u32 m0, s25, 27648
  s_nop 0
  buffer_load_dwordx4 v23, s[56:59], s27 offen lds
  s_add_u32 s27, s27, 16384
  s_add_u32 m0, s25, 28672
  s_nop 0
  buffer_load_dwordx4 v22, s[56:59], s27 offen lds
  s_add_u32 s27, s27, 16384
  s_add_u32 m0, s25, 29696
  s_nop 0
  buffer_load_dwordx4 v22, s[56:59], s27 offen lds
  s_add_u32 s27, s27, 16384
  s_add_u32 m0, s25, 30720
  s_nop 0
  buffer_load_dwordx4 v23, s[56:59], s27 offen lds
  s_add_u32 s27, s27, 16384
  s_add_u32 m0, s25, 31744
  s_nop 0
  buffer_load_dwordx4 v23, s[56:59], s27 offen lds
  s_add_u32 s27, s27, 16384
  v_mov_b32 v14, v26
  v_mov_b32 v15, v27
  s_lshl_b32 s28, s16, 16
  s_add_u32 s28, s28, s26
  s_lshl_b32 s29, s16, 12
  s_add_u32 m0, s29, 0
  s_add_u32 s27, s28, 0
  buffer_load_dwordx4 v14, s[60:63], s27 offen lds
  s_add_u32 m0, s29, 1024
  s_add_u32 s27, s28, 16384
  buffer_load_dwordx4 v15, s[60:63], s27 offen lds
  s_add_u32 m0, s29, 2048
  s_add_u32 s27, s28, 32768
  buffer_load_dwordx4 v14, s[60:63], s27 offen lds
  s_add_u32 m0, s29, 3072
  s_add_u32 s27, s28, 49152
  buffer_load_dwordx4 v15, s[60:63], s27 offen lds
  s_add_u32 m0, s29, 16384
  s_add_u32 s27, s28, 262144
  buffer_load_dwordx4 v14, s[60:63], s27 offen lds
  s_add_u32 m0, s29, 17408
  s_add_u32 s27, s28, 278528
  buffer_load_dwordx4 v15, s[60:63], s27 offen lds
  s_add_u32 m0, s29, 18432
  s_add_u32 s27, s28, 294912
  buffer_load_dwordx4 v14, s[60:63], s27 offen lds
  s_add_u32 m0, s29, 19456
  s_add_u32 s27, s28, 311296
  buffer_load_dwordx4 v15, s[60:63], s27 offen lds
  v_lshrrev_b32 v7, 2, v4
  v_lshlrev_b32 v11, 4, v7
  v_lshlrev_b32 v7, 3, v7
  v_and_b32 v8, 3, v4
  v_add_u32 v7, v7, v8
  v_and_b32 v8, 2, v4
  v_lshl_add_u32 v11, v8, 1, v11
  v_and_b32 v8, 1, v4
  v_add_u32 v11, v11, v8
  v_or_b32 v10, 0, v3
  v_xor_b32 v10, v10, v4
  v_lshlrev_b32 v10, 4, v10
  v_lshl_add_u32 v248, v7, 9, v10
  v_add_u32 v252, 65536, v248
  v_add_u32 v16, 131072, v248
  v_lshl_add_u32 v10, v11, 9, v10
  v_add_u32 v20, s25, v10
  v_or_b32 v10, 4, v3
  v_xor_b32 v10, v10, v4
  v_lshlrev_b32 v10, 4, v10
  v_lshl_add_u32 v249, v7, 9, v10
  v_add_u32 v253, 65536, v249
  v_add_u32 v17, 131072, v249
  v_lshl_add_u32 v10, v11, 9, v10
  v_add_u32 v21, s25, v10
  v_or_b32 v10, 8, v3
  v_xor_b32 v10, v10, v4
  v_lshlrev_b32 v10, 4, v10
  v_lshl_add_u32 v250, v7, 9, v10
  v_add_u32 v254, 65536, v250
  v_add_u32 v18, 131072, v250
  v_lshl_add_u32 v10, v11, 9, v10
  v_add_u32 v22, s25, v10
  v_or_b32 v10, 12, v3
  v_xor_b32 v10, v10, v4
  v_lshlrev_b32 v10, 4, v10
  v_lshl_add_u32 v251, v7, 9, v10
  v_add_u32 v255, 65536, v251
  v_add_u32 v19, 131072, v251
  v_lshl_add_u32 v10, v11, 9, v10
  v_add_u32 v23, s25, v10
  v_mov_b32 v12, 1035512379
  v_lshlrev_b32 v6, 7, v1
  s_getpc_b64 s[98:99]
  global_load_dword v7, v6, s[98:99]
  s_waitcnt vmcnt(9)
  ds_read_b128 v[120:123], v20 offset:0
  ds_read_b128 v[124:127], v21 offset:0
  ds_read_b128 v[128:131], v22 offset:0
  ds_read_b128 v[132:135], v23 offset:0
  ds_read_b128 v[136:139], v20 offset:256
  ds_read_b128 v[140:143], v21 offset:256
  ds_read_b128 v[144:147], v22 offset:256
  ds_read_b128 v[148:151], v23 offset:256
  s_waitcnt lgkmcnt(8)
  ds_read_b128 v[152:155], v20 offset:1024
  ds_read_b128 v[156:159], v21 offset:1024
  ds_read_b128 v[160:163], v22 offset:1024
  ds_read_b128 v[164:167], v23 offset:1024
  ds_read_b128 v[168:171], v20 offset:1280
  ds_read_b128 v[172:175], v21 offset:1280
  ds_read_b128 v[176:179], v22 offset:1280
  ds_read_b128 v[180:183], v23 offset:1280
  s_waitcnt lgkmcnt(8)
  ds_read_b128 v[184:187], v20 offset:4096
  ds_read_b128 v[188:191], v21 offset:4096
  ds_read_b128 v[192:195], v22 offset:4096
  ds_read_b128 v[196:199], v23 offset:4096
  ds_read_b128 v[200:203], v20 offset:4352
  ds_read_b128 v[204:207], v21 offset:4352
  ds_read_b128 v[208:211], v22 offset:4352
  ds_read_b128 v[212:215], v23 offset:4352
  s_waitcnt lgkmcnt(8)
  ds_read_b128 v[216:219], v20 offset:5120
  ds_read_b128 v[220:223], v21 offset:5120
  ds_read_b128 v[224:227], v22 offset:5120
  ds_read_b128 v[228:231], v23 offset:5120
  ds_read_b128 v[232:235], v20 offset:5376
  ds_read_b128 v[236:239], v21 offset:5376
  ds_read_b128 v[240:243], v22 offset:5376
  ds_read_b128 v[244:247], v23 offset:5376
  s_waitcnt lgkmcnt(8)
  s_waitcnt vmcnt(4) lgkmcnt(0)
  s_barrier
  s_add_u32 m0, s29, 32768
  s_add_u32 s27, s28, 524288
  buffer_load_dwordx4 v14, s[60:63], s27 offen lds
  s_add_u32 m0, s29, 33792
  s_add_u32 s27, s28, 540672
  buffer_load_dwordx4 v15, s[60:63], s27 offen lds
  s_add_u32 m0, s29, 34816
  s_add_u32 s27, s28, 557056
  buffer_load_dwordx4 v14, s[60:63], s27 offen lds
  s_add_u32 m0, s29, 35840
  s_add_u32 s27, s28, 573440
  buffer_load_dwordx4 v15, s[60:63], s27 offen lds
  ds_read_b128 v[24:27], v248 offset:0
  ds_read_b128 v[28:31], v248 offset:2048
  ds_read_b128 v[32:35], v249 offset:0
  ds_read_b128 v[36:39], v249 offset:2048
  ds_read_b128 v[40:43], v250 offset:0
  ds_read_b128 v[44:47], v250 offset:2048
  s_waitcnt lgkmcnt(5)
  s_getpc_b64 s[98:99]
  s_add_u32 s98, s98, 4096
  s_addc_u32 s99, s99, 0
  global_load_dword v7, v6, s[98:99]
  v_mfma_f32_16x16x32_bf16 v[56:59], v[24:27], v[120:123], 0
  ds_read_b128 v[48:51], v251 offset:0
  v_mfma_f32_16x16x32_bf16 v[64:67], v[24:27], v[152:155], 0
  v_mfma_f32_16x16x32_bf16 v[72:75], v[24:27], v[184:187], 0
  s_add_u32 m0, s29, 49152
  s_add_u32 s27, s28, 786432
  buffer_load_dwordx4 v14, s[60:63], s27 offen lds
  v_mfma_f32_16x16x32_bf16 v[80:83], v[24:27], v[216:219], 0
  s_waitcnt lgkmcnt(5)
  v_mfma_f32_16x16x32_bf16 v[60:63], v[28:31], v[120:123], 0
  ds_read_b128 v[52:55], v251 offset:2048
  v_mfma_f32_16x16x32_bf16 v[68:71], v[28:31], v[152:155], 0
  v_mfma_f32_16x16x32_bf16 v[76:79], v[28:31], v[184:187], 0
  v_mfma_f32_16x16x32_bf16 v[84:87], v[28:31], v[216:219], 0
  s_waitcnt lgkmcnt(5)
  v_mfma_f32_16x16x32_bf16 v[56:59], v[32:35], v[124:127], v[56:59]
  ds_read_b128 v[24:27], v248 offset:256
  v_mfma_f32_16x16x32_bf16 v[64:67], v[32:35], v[156:159], v[64:67]
  v_mfma_f32_16x16x32_bf16 v[72:75], v[32:35], v[188:191], v[72:75]
  s_add_u32 m0, s29, 50176
  s_add_u32 s27, s28, 802816
  buffer_load_dwordx4 v15, s[60:63], s27 offen lds
  v_mfma_f32_16x16x32_bf16 v[80:83], v[32:35], v[220:223], v[80:83]
  s_waitcnt lgkmcnt(5)
  v_mfma_f32_16x16x32_bf16 v[60:63], v[36:39], v[124:127], v[60:63]
  ds_read_b128 v[28:31], v248 offset:2304
  v_mfma_f32_16x16x32_bf16 v[68:71], v[36:39], v[156:159], v[68:71]
  v_mfma_f32_16x16x32_bf16 v[76:79], v[36:39], v[188:191], v[76:79]
  v_mfma_f32_16x16x32_bf16 v[84:87], v[36:39], v[220:223], v[84:87]
  s_waitcnt lgkmcnt(5)
  v_mfma_f32_16x16x32_bf16 v[56:59], v[40:43], v[128:131], v[56:59]
  ds_read_b128 v[32:35], v249 offset:256
  v_mfma_f32_16x16x32_bf16 v[64:67], v[40:43], v[160:163], v[64:67]
  v_mfma_f32_16x16x32_bf16 v[72:75], v[40:43], v[192:195], v[72:75]
  s_add_u32 m0, s29, 51200
  s_add_u32 s27, s28, 819200
  buffer_load_dwordx4 v14, s[60:63], s27 offen lds
  v_mfma_f32_16x16x32_bf16 v[80:83], v[40:43], v[224:227], v[80:83]
  s_waitcnt lgkmcnt(5)
  v_mfma_f32_16x16x32_bf16 v[60:63], v[44:47], v[128:131], v[60:63]
  ds_read_b128 v[36:39], v249 offset:2304
  v_mfma_f32_16x16x32_bf16 v[68:71], v[44:47], v[160:163], v[68:71]
  v_mfma_f32_16x16x32_bf16 v[76:79], v[44:47], v[192:195], v[76:79]
  v_mfma_f32_16x16x32_bf16 v[84:87], v[44:47], v[224:227], v[84:87]
  s_waitcnt lgkmcnt(5)
  v_mfma_f32_16x16x32_bf16 v[56:59], v[48:51], v[132:135], v[56:59]
  ds_read_b128 v[40:43], v250 offset:256
  v_mfma_f32_16x16x32_bf16 v[64:67], v[48:51], v[164:167], v[64:67]
  v_mfma_f32_16x16x32_bf16 v[72:75], v[48:51], v[196:199], v[72:75]
  s_add_u32 m0, s29, 52224
  s_add_u32 s27, s28, 835584
  buffer_load_dwordx4 v15, s[60:63], s27 offen lds
  v_mfma_f32_16x16x32_bf16 v[80:83], v[48:51], v[228:231], v[80:83]
  s_waitcnt lgkmcnt(5)
  v_mfma_f32_16x16x32_bf16 v[60:63], v[52:55], v[132:135], v[60:63]
  ds_read_b128 v[44:47], v250 offset:2304
  v_mfma_f32_16x16x32_bf16 v[68:71], v[52:55], v[164:167], v[68:71]
  v_mfma_f32_16x16x32_bf16 v[76:79], v[52:55], v[196:199], v[76:79]
  v_mfma_f32_16x16x32_bf16 v[84:87], v[52:55], v[228:231], v[84:87]
  s_waitcnt lgkmcnt(5)
  v_mfma_f32_16x16x32_bf16 v[56:59], v[24:27], v[136:139], v[56:59]
  ds_read_b128 v[48:51], v251 offset:256
  v_mfma_f32_16x16x32_bf16 v[64:67], v[24:27], v[168:171], v[64:67]
  v_mfma_f32_16x16x32_bf16 v[72:75], v[24:27], v[200:203], v[72:75]
  v_mfma_f32_16x16x32_bf16 v[80:83], v[24:27], v[232:235], v[80:83]
  s_waitcnt lgkmcnt(5)
  v_mfma_f32_16x16x32_bf16 v[60:63], v[28:31], v[136:139], v[60:63]
  ds_read_b128 v[52:55], v251 offset:2304
  v_mfma_f32_16x16x32_bf16 v[68:71], v[28:31], v[168:171], v[68:71]
  v_mfma_f32_16x16x32_bf16 v[76:79], v[28:31], v[200:203], v[76:79]
  v_mfma_f32_16x16x32_bf16 v[84:87], v[28:31], v[232:235], v[84:87]
  s_waitcnt lgkmcnt(5)
  v_mfma_f32_16x16x32_bf16 v[56:59], v[32:35], v[140:143], v[56:59]
  s_waitcnt vmcnt(8)
  s_barrier
  ds_read_b128 v[24:27], v248 offset:16384
  v_mfma_f32_16x16x32_bf16 v[64:67], v[32:35], v[172:175], v[64:67]
  v_mfma_f32_16x16x32_bf16 v[72:75], v[32:35], v[204:207], v[72:75]
  v_mfma_f32_16x16x32_bf16 v[80:83], v[32:35], v[236:239], v[80:83]
  s_waitcnt lgkmcnt(5)
  v_mfma_f32_16x16x32_bf16 v[60:63], v[36:39], v[140:143], v[60:63]
  ds_read_b128 v[28:31], v248 offset:18432
  v_mfma_f32_16x16x32_bf16 v[68:71], v[36:39], v[172:175], v[68:71]
  v_mfma_f32_16x16x32_bf16 v[76:79], v[36:39], v[204:207], v[76:79]
  v_mfma_f32_16x16x32_bf16 v[84:87], v[36:39], v[236:239], v[84:87]
  s_waitcnt lgkmcnt(5)
  v_mfma_f32_16x16x32_bf16 v[56:59], v[40:43], v[144:147], v[56:59]
  ds_read_b128 v[32:35], v249 offset:16384
  v_mfma_f32_16x16x32_bf16 v[64:67], v[40:43], v[176:179], v[64:67]
  v_mfma_f32_16x16x32_bf16 v[72:75], v[40:43], v[208:211], v[72:75]
  v_mfma_f32_16x16x32_bf16 v[80:83], v[40:43], v[240:243], v[80:83]
  s_waitcnt lgkmcnt(5)
  v_mfma_f32_16x16x32_bf16 v[60:63], v[44:47], v[144:147], v[60:63]
  ds_read_b128 v[36:39], v249 offset:18432
  v_mfma_f32_16x16x32_bf16 v[68:71], v[44:47], v[176:179], v[68:71]
  v_mfma_f32_16x16x32_bf16 v[76:79], v[44:47], v[208:211], v[76:79]
  v_mfma_f32_16x16x32_bf16 v[84:87], v[44:47], v[240:243], v[84:87]
  s_waitcnt lgkmcnt(5)
  v_mfma_f32_16x16x32_bf16 v[56:59], v[48:51], v[148:151], v[56:59]
  ds_read_b128 v[40:43], v250 offset:16384
  v_mfma_f32_16x16x32_bf16 v[64:67], v[48:51], v[180:183], v[64:67]
  v_mfma_f32_16x16x32_bf16 v[72:75], v[48:51], v[212:215], v[72:75]
  v_mfma_f32_16x16x32_bf16 v[80:83], v[48:51], v[244:247], v[80:83]
  s_waitcnt lgkmcnt(5)
  v_mfma_f32_16x16x32_bf16 v[60:63], v[52:55], v[148:151], v[60:63]
  ds_read_b128 v[44:47], v250 offset:18432
  v_mfma_f32_16x16x32_bf16 v[68:71], v[52:55], v[180:183], v[68:71]
  v_mfma_f32_16x16x32_bf16 v[76:79], v[52:55], v[212:215], v[76:79]
  v_mfma_f32_16x16x32_bf16 v[84:87], v[52:55], v[244:247], v[84:87]
  s_waitcnt lgkmcnt(5)
  v_mfma_f32_16x16x32_bf16 v[88:91], v[24:27], v[120:123], 0
  ds_read_b128 v[48:51], v251 offset:16384
  v_mfma_f32_16x16x32_bf16 v[96:99], v[24:27], v[152:155], 0
  v_mfma_f32_16x16x32_bf16 v[104:107], v[24:27], v[184:187], 0
  s_add_u32 m0, s29, 65536
  s_add_u32 s27, s28, 1048576
  buffer_load_dwordx4 v14, s[60:63], s27 offen lds
  v_mfma_f32_16x16x32_bf16 v[112:115], v[24:27], v[216:219], 0
  s_waitcnt lgkmcnt(5)
  v_mul_f32 v56, v12, v56
  v_mfma_f32_16x16x32_bf16 v[92:95], v[28:31], v[120:123], 0
  ds_read_b128 v[52:55], v251 offset:18432
  v_mul_f32 v57, v12, v57
  v_mfma_f32_16x16x32_bf16 v[100:103], v[28:31], v[152:155], 0
  v_mul_f32 v58, v12, v58
  v_mul_f32 v59, v12, v59
  v_mfma_f32_16x16x32_bf16 v[108:111], v[28:31], v[184:187], 0
  v_mul_f32 v60, v12, v60
  v_mfma_f32_16x16x32_bf16 v[116:119], v[28:31], v[216:219], 0
  s_waitcnt lgkmcnt(5)
  v_mul_f32 v61, v12, v61
  v_mfma_f32_16x16x32_bf16 v[88:91], v[32:35], v[124:127], v[88:91]
  ds_read_b128 v[24:27], v248 offset:16640
  v_mul_f32 v62, v12, v62
  v_mfma_f32_16x16x32_bf16 v[96:99], v[32:35], v[156:159], v[96:99]
  v_mul_f32 v63, v12, v63
  v_cvt_pk_bf16_f32 v56, v56, v57
  v_mfma_f32_16x16x32_bf16 v[104:107], v[32:35], v[188:191], v[104:107]
  s_add_u32 m0, s29, 66560
  s_add_u32 s27, s28, 1064960
  buffer_load_dwordx4 v15, s[60:63], s27 offen lds
  v_mfma_f32_16x16x32_bf16 v[112:115], v[32:35], v[220:223], v[112:115]
  s_waitcnt lgkmcnt(5)
  v_cvt_pk_bf16_f32 v57, v58, v59
  v_mfma_f32_16x16x32_bf16 v[92:95], v[36:39], v[124:127], v[92:95]
  ds_read_b128 v[28:31], v248 offset:18688
  v_cvt_pk_bf16_f32 v58, v60, v61
  v_mfma_f32_16x16x32_bf16 v[100:103], v[36:39], v[156:159], v[100:103]
  v_cvt_pk_bf16_f32 v59, v62, v63
  v_accvgpr_write_b32 a0, v56
  v_mfma_f32_16x16x32_bf16 v[108:111], v[36:39], v[188:191], v[108:111]
  v_accvgpr_write_b32 a1, v57
  v_mfma_f32_16x16x32_bf16 v[116:119], v[36:39], v[220:223], v[116:119]
  s_waitcnt lgkmcnt(5)
  v_accvgpr_write_b32 a2, v58
  v_mfma_f32_16x16x32_bf16 v[88:91], v[40:43], v[128:131], v[88:91]
  ds_read_b128 v[32:35], v249 offset:16640
  v_accvgpr_write_b32 a3, v59
  v_mfma_f32_16x16x32_bf16 v[96:99], v[40:43], v[160:163], v[96:99]
  v_mul_f32 v64, v12, v64
  v_mul_f32 v65, v12, v65
  v_mfma_f32_16x16x32_bf16 v[104:107], v[40:43], v[192:195], v[104:107]
  s_add_u32 m0, s29, 67584
  s_add_u32 s27, s28, 1081344
  buffer_load_dwordx4 v14, s[60:63], s27 offen lds
  v_mfma_f32_16x16x32_bf16 v[112:115], v[40:43], v[224:227], v[112:115]
  s_waitcnt lgkmcnt(5)
  v_mul_f32 v66, v12, v66
  v_mfma_f32_16x16x32_bf16 v[92:95], v[44:47], v[128:131], v[92:95]
  ds_read_b128 v[36:39], v249 offset:18688
  v_mul_f32 v67, v12, v67
  v_mfma_f32_16x16x32_bf16 v[100:103], v[44:47], v[160:163], v[100:103]
  v_mul_f32 v68, v12, v68
  v_mul_f32 v69, v12, v69
  v_mfma_f32_16x16x32_bf16 v[108:111], v[44:47], v[192:195], v[108:111]
  v_mul_f32 v70, v12, v70
  v_mfma_f32_16x16x32_bf16 v[116:119], v[44:47], v[224:227], v[116:119]
  s_waitcnt lgkmcnt(5)
  v_mul_f32 v71, v12, v71
  v_mfma_f32_16x16x32_bf16 v[88:91], v[48:51], v[132:135], v[88:91]
  ds_read_b128 v[40:43], v250 offset:16640
  v_cvt_pk_bf16_f32 v64, v64, v65
  v_mfma_f32_16x16x32_bf16 v[96:99], v[48:51], v[164:167], v[96:99]
  v_cvt_pk_bf16_f32 v65, v66, v67
  v_cvt_pk_bf16_f32 v66, v68, v69
  v_mfma_f32_16x16x32_bf16 v[104:107], v[48:51], v[196:199], v[104:107]
  s_add_u32 m0, s29, 68608
  s_add_u32 s27, s28, 1097728
  buffer_load_dwordx4 v15, s[60:63], s27 offen lds
  v_mfma_f32_16x16x32_bf16 v[112:115], v[48:51], v[228:231], v[112:115]
  s_waitcnt lgkmcnt(5)
  v_cvt_pk_bf16_f32 v67, v70, v71
  v_mfma_f32_16x16x32_bf16 v[92:95], v[52:55], v[132:135], v[92:95]
  ds_read_b128 v[44:47], v250 offset:18688
  v_accvgpr_write_b32 a56, v64
  v_mfma_f32_16x16x32_bf16 v[100:103], v[52:55], v[164:167], v[100:103]
  v_accvgpr_write_b32 a57, v65
  v_accvgpr_write_b32 a58, v66
  v_mfma_f32_16x16x32_bf16 v[108:111], v[52:55], v[196:199], v[108:111]
  v_accvgpr_write_b32 a59, v67
  v_mfma_f32_16x16x32_bf16 v[116:119], v[52:55], v[228:231], v[116:119]
  s_waitcnt lgkmcnt(5)
  v_mul_f32 v72, v12, v72
  v_mfma_f32_16x16x32_bf16 v[88:91], v[24:27], v[136:139], v[88:91]
  ds_read_b128 v[48:51], v251 offset:16640
  v_mul_f32 v73, v12, v73
  v_mfma_f32_16x16x32_bf16 v[96:99], v[24:27], v[168:171], v[96:99]
  v_mul_f32 v74, v12, v74
  v_mul_f32 v75, v12, v75
  v_mfma_f32_16x16x32_bf16 v[104:107], v[24:27], v[200:203], v[104:107]
  v_mul_f32 v76, v12, v76
  v_mfma_f32_16x16x32_bf16 v[112:115], v[24:27], v[232:235], v[112:115]
  s_waitcnt lgkmcnt(5)
  v_mul_f32 v77, v12, v77
  v_mfma_f32_16x16x32_bf16 v[92:95], v[28:31], v[136:139], v[92:95]
  ds_read_b128 v[52:55], v251 offset:18688
  v_mul_f32 v78, v12, v78
  v_mfma_f32_16x16x32_bf16 v[100:103], v[28:31], v[168:171], v[100:103]
  v_mul_f32 v79, v12, v79
  v_cvt_pk_bf16_f32 v72, v72, v73
  v_mfma_f32_16x16x32_bf16 v[108:111], v[28:31], v[200:203], v[108:111]
  v_cvt_pk_bf16_f32 v73, v74, v75
  v_mfma_f32_16x16x32_bf16 v[116:119], v[28:31], v[232:235], v[116:119]
  s_waitcnt lgkmcnt(5)
  v_cvt_pk_bf16_f32 v74, v76, v77
  v_mfma_f32_16x16x32_bf16 v[88:91], v[32:35], v[140:143], v[88:91]
  s_waitcnt vmcnt(8)
  s_barrier
  ds_read_b128 v[24:27], v248 offset:32768
  v_cvt_pk_bf16_f32 v75, v78, v79
  v_mfma_f32_16x16x32_bf16 v[96:99], v[32:35], v[172:175], v[96:99]
  v_accvgpr_write_b32 a112, v72
  v_accvgpr_write_b32 a113, v73
  v_mfma_f32_16x16x32_bf16 v[104:107], v[32:35], v[204:207], v[104:107]
  v_accvgpr_write_b32 a114, v74
  v_mfma_f32_16x16x32_bf16 v[112:115], v[32:35], v[236:239], v[112:115]
  s_waitcnt lgkmcnt(5)
  v_accvgpr_write_b32 a115, v75
  v_mfma_f32_16x16x32_bf16 v[92:95], v[36:39], v[140:143], v[92:95]
  ds_read_b128 v[28:31], v248 offset:34816
  v_mul_f32 v80, v12, v80
  v_mfma_f32_16x16x32_bf16 v[100:103], v[36:39], v[172:175], v[100:103]
  v_mul_f32 v81, v12, v81
  v_mul_f32 v82, v12, v82
  v_mfma_f32_16x16x32_bf16 v[108:111], v[36:39], v[204:207], v[108:111]
  v_mul_f32 v83, v12, v83
  v_mfma_f32_16x16x32_bf16 v[116:119], v[36:39], v[236:239], v[116:119]
  s_waitcnt lgkmcnt(5)
  v_mul_f32 v84, v12, v84
  v_mfma_f32_16x16x32_bf16 v[88:91], v[40:43], v[144:147], v[88:91]
  ds_read_b128 v[32:35], v249 offset:32768
  v_mul_f32 v85, v12, v85
  v_mfma_f32_16x16x32_bf16 v[96:99], v[40:43], v[176:179], v[96:99]
  v_mul_f32 v86, v12, v86
  v_mul_f32 v87, v12, v87
  v_mfma_f32_16x16x32_bf16 v[104:107], v[40:43], v[208:211], v[104:107]
  v_cvt_pk_bf16_f32 v80, v80, v81
  v_mfma_f32_16x16x32_bf16 v[112:115], v[40:43], v[240:243], v[112:115]
  s_waitcnt lgkmcnt(5)
  v_cvt_pk_bf16_f32 v81, v82, v83
  v_mfma_f32_16x16x32_bf16 v[92:95], v[44:47], v[144:147], v[92:95]
  ds_read_b128 v[36:39], v249 offset:34816
  v_cvt_pk_bf16_f32 v82, v84, v85
  v_mfma_f32_16x16x32_bf16 v[100:103], v[44:47], v[176:179], v[100:103]
  v_cvt_pk_bf16_f32 v83, v86, v87
  v_accvgpr_write_b32 a168, v80
  v_mfma_f32_16x16x32_bf16 v[108:111], v[44:47], v[208:211], v[108:111]
  v_accvgpr_write_b32 a169, v81
  v_mfma_f32_16x16x32_bf16 v[116:119], v[44:47], v[240:243], v[116:119]
  s_waitcnt lgkmcnt(5)
  v_accvgpr_write_b32 a170, v82
  v_mfma_f32_16x16x32_bf16 v[88:91], v[48:51], v[148:151], v[88:91]
  ds_read_b128 v[40:43], v250 offset:32768
  v_accvgpr_write_b32 a171, v83
  v_mfma_f32_16x16x32_bf16 v[96:99], v[48:51], v[180:183], v[96:99]
  v_mfma_f32_16x16x32_bf16 v[104:107], v[48:51], v[212:215], v[104:107]
  v_mfma_f32_16x16x32_bf16 v[112:115], v[48:51], v[244:247], v[112:115]
  s_waitcnt lgkmcnt(5)
  v_mfma_f32_16x16x32_bf16 v[92:95], v[52:55], v[148:151], v[92:95]
  ds_read_b128 v[44:47], v250 offset:34816
  v_mfma_f32_16x16x32_bf16 v[100:103], v[52:55], v[180:183], v[100:103]
  v_mfma_f32_16x16x32_bf16 v[108:111], v[52:55], v[212:215], v[108:111]
  v_mfma_f32_16x16x32_bf16 v[116:119], v[52:55], v[244:247], v[116:119]
  s_waitcnt lgkmcnt(5)
  v_mfma_f32_16x16x32_bf16 v[56:59], v[24:27], v[120:123], 0
  ds_read_b128 v[48:51], v251 offset:32768
  v_mfma_f32_16x16x32_bf16 v[64:67], v[24:27], v[152:155], 0
  v_mfma_f32_16x16x32_bf16 v[72:75], v[24:27], v[184:187], 0
  s_add_u32 m0, s29, 81920
  s_add_u32 s27, s28, 1310720
  buffer_load_dwordx4 v14, s[60:63], s27 offen lds
  v_mfma_f32_16x16x32_bf16 v[80:83], v[24:27], v[216:219], 0
  s_waitcnt lgkmcnt(5)
  v_mul_f32 v88, v12, v88
  v_mfma_f32_16x16x32_bf16 v[60:63], v[28:31], v[120:123], 0
  ds_read_b128 v[52:55], v251 offset:34816
  v_mul_f32 v89, v12, v89
  v_mfma_f32_16x16x32_bf16 v[68:71], v[28:31], v[152:155], 0
  v_mul_f32 v90, v12, v90
  v_mul_f32 v91, v12, v91
  v_mfma_f32_16x16x32_bf16 v[76:79], v[28:31], v[184:187], 0
  v_mul_f32 v92, v12, v92
  v_mfma_f32_16x16x32_bf16 v[84:87], v[28:31], v[216:219], 0
  s_waitcnt lgkmcnt(5)
  v_mul_f32 v93, v12, v93
  v_mfma_f32_16x16x32_bf16 v[56:59], v[32:35], v[124:127], v[56:59]
  ds_read_b128 v[24:27], v248 offset:33024
  v_mul_f32 v94, v12, v94
  v_mfma_f32_16x16x32_bf16 v[64:67], v[32:35], v[156:159], v[64:67]
  v_mul_f32 v95, v12, v95
  v_cvt_pk_bf16_f32 v88, v88, v89
  v_mfma_f32_16x16x32_bf16 v[72:75], v[32:35], v[188:191], v[72:75]
  s_add_u32 m0, s29, 82944
  s_add_u32 s27, s28, 1327104
  buffer_load_dwordx4 v15, s[60:63], s27 offen lds
  v_mfma_f32_16x16x32_bf16 v[80:83], v[32:35], v[220:223], v[80:83]
  s_waitcnt lgkmcnt(5)
  v_cvt_pk_bf16_f32 v89, v90, v91
  v_mfma_f32_16x16x32_bf16 v[60:63], v[36:39], v[124:127], v[60:63]
  ds_read_b128 v[28:31], v248 offset:35072
  v_cvt_pk_bf16_f32 v90, v92, v93
  v_mfma_f32_16x16x32_bf16 v[68:71], v[36:39], v[156:159], v[68:71]
  v_cvt_pk_bf16_f32 v91, v94, v95
  v_accvgpr_write_b32 a4, v88
  v_mfma_f32_16x16x32_bf16 v[76:79], v[36:39], v[188:191], v[76:79]
  v_accvgpr_write_b32 a5, v89
  v_mfma_f32_16x16x32_bf16 v[84:87], v[36:39], v[220:223], v[84:87]
  s_waitcnt lgkmcnt(5)
  v_accvgpr_write_b32 a6, v90
  v_mfma_f32_16x16x32_bf16 v[56:59], v[40:43], v[128:131], v[56:59]
  ds_read_b128 v[32:35], v249 offset:33024
  v_accvgpr_write_b32 a7, v91
  v_mfma_f32_16x16x32_bf16 v[64:67], v[40:43], v[160:163], v[64:67]
  v_mul_f32 v96, v12, v96
  v_mul_f32 v97, v12, v97
  v_mfma_f32_16x16x32_bf16 v[72:75], v[40:43], v[192:195], v[72:75]
  s_add_u32 m0, s29, 83968
  s_add_u32 s27, s28, 1343488
  buffer_load_dwordx4 v14, s[60:63], s27 offen lds
  v_mfma_f32_16x16x32_bf16 v[80:83], v[40:43], v[224:227], v[80:83]
  s_waitcnt lgkmcnt(5)
  v_mul_f32 v98, v12, v98
  v_mfma_f32_16x16x32_bf16 v[60:63], v[44:47], v[128:131], v[60:63]
  ds_read_b128 v[36:39], v249 offset:35072
  v_mul_f32 v99, v12, v99
  v_mfma_f32_16x16x32_bf16 v[68:71], v[44:47], v[160:163], v[68:71]
  v_mul_f32 v100, v12, v100
  v_mul_f32 v101, v12, v101
  v_mfma_f32_16x16x32_bf16 v[76:79], v[44:47], v[192:195], v[76:79]
  v_mul_f32 v102, v12, v102
  v_mfma_f32_16x16x32_bf16 v[84:87], v[44:47], v[224:227], v[84:87]
  s_waitcnt lgkmcnt(5)
  v_mul_f32 v103, v12, v103
  v_mfma_f32_16x16x32_bf16 v[56:59], v[48:51], v[132:135], v[56:59]
  ds_read_b128 v[40:43], v250 offset:33024
  v_cvt_pk_bf16_f32 v96, v96, v97
  v_mfma_f32_16x16x32_bf16 v[64:67], v[48:51], v[164:167], v[64:67]
  v_cvt_pk_bf16_f32 v97, v98, v99
  v_cvt_pk_bf16_f32 v98, v100, v101
  v_mfma_f32_16x16x32_bf16 v[72:75], v[48:51], v[196:199], v[72:75]
  s_add_u32 m0, s29, 84992
  s_add_u32 s27, s28, 1359872
  buffer_load_dwordx4 v15, s[60:63], s27 offen lds
  v_mfma_f32_16x16x32_bf16 v[80:83], v[48:51], v[228:231], v[80:83]
  s_waitcnt lgkmcnt(5)
  v_cvt_pk_bf16_f32 v99, v102, v103
  v_mfma_f32_16x16x32_bf16 v[60:63], v[52:55], v[132:135], v[60:63]
  ds_read_b128 v[44:47], v250 offset:35072
  v_accvgpr_write_b32 a60, v96
  v_mfma_f32_16x16x32_bf16 v[68:71], v[52:55], v[164:167], v[68:71]
  v_accvgpr_write_b32 a61, v97
  v_accvgpr_write_b32 a62, v98
  v_mfma_f32_16x16x32_bf16 v[76:79], v[52:55], v[196:199], v[76:79]
  v_accvgpr_write_b32 a63, v99
  v_mfma_f32_16x16x32_bf16 v[84:87], v[52:55], v[228:231], v[84:87]
  s_waitcnt lgkmcnt(5)
  v_mul_f32 v104, v12, v104
  v_mfma_f32_16x16x32_bf16 v[56:59], v[24:27], v[136:139], v[56:59]
  ds_read_b128 v[48:51], v251 offset:33024
  v_mul_f32 v105, v12, v105
  v_mfma_f32_16x16x32_bf16 v[64:67], v[24:27], v[168:171], v[64:67]
  v_mul_f32 v106, v12, v106
  v_mul_f32 v107, v12, v107
  v_mfma_f32_16x16x32_bf16 v[72:75], v[24:27], v[200:203], v[72:75]
  v_mul_f32 v108, v12, v108
  v_mfma_f32_16x16x32_bf16 v[80:83], v[24:27], v[232:235], v[80:83]
  s_waitcnt lgkmcnt(5)
  v_mul_f32 v109, v12, v109
  v_mfma_f32_16x16x32_bf16 v[60:63], v[28:31], v[136:139], v[60:63]
  ds_read_b128 v[52:55], v251 offset:35072
  v_mul_f32 v110, v12, v110
  v_mfma_f32_16x16x32_bf16 v[68:71], v[28:31], v[168:171], v[68:71]
  v_mul_f32 v111, v12, v111
  v_cvt_pk_bf16_f32 v104, v104, v105
  v_mfma_f32_16x16x32_bf16 v[76:79], v[28:31], v[200:203], v[76:79]
  v_cvt_pk_bf16_f32 v105, v106, v107
  v_mfma_f32_16x16x32_bf16 v[84:87], v[28:31], v[232:235], v[84:87]
  s_waitcnt lgkmcnt(5)
  v_cvt_pk_bf16_f32 v106, v108, v109
  v_mfma_f32_16x16x32_bf16 v[56:59], v[32:35], v[140:143], v[56:59]
  s_waitcnt vmcnt(8)
  s_barrier
  ds_read_b128 v[24:27], v248 offset:49152
  v_cvt_pk_bf16_f32 v107, v110, v111
  v_mfma_f32_16x16x32_bf16 v[64:67], v[32:35], v[172:175], v[64:67]
  v_accvgpr_write_b32 a116, v104
  v_accvgpr_write_b32 a117, v105
  v_mfma_f32_16x16x32_bf16 v[72:75], v[32:35], v[204:207], v[72:75]
  v_accvgpr_write_b32 a118, v106
  v_mfma_f32_16x16x32_bf16 v[80:83], v[32:35], v[236:239], v[80:83]
  s_waitcnt lgkmcnt(5)
  v_accvgpr_write_b32 a119, v107
  v_mfma_f32_16x16x32_bf16 v[60:63], v[36:39], v[140:143], v[60:63]
  ds_read_b128 v[28:31], v248 offset:51200
  v_mul_f32 v112, v12, v112
  v_mfma_f32_16x16x32_bf16 v[68:71], v[36:39], v[172:175], v[68:71]
  v_mul_f32 v113, v12, v113
  v_mul_f32 v114, v12, v114
  v_mfma_f32_16x16x32_bf16 v[76:79], v[36:39], v[204:207], v[76:79]
  v_mul_f32 v115, v12, v115
  v_mfma_f32_16x16x32_bf16 v[84:87], v[36:39], v[236:239], v[84:87]
  s_waitcnt lgkmcnt(5)
  v_mul_f32 v116, v12, v116
  v_mfma_f32_16x16x32_bf16 v[56:59], v[40:43], v[144:147], v[56:59]
  ds_read_b128 v[32:35], v249 offset:49152
  v_mul_f32 v117, v12, v117
  v_mfma_f32_16x16x32_bf16 v[64:67], v[40:43], v[176:179], v[64:67]
  v_mul_f32 v118, v12, v118
  v_mul_f32 v119, v12, v119
  v_mfma_f32_16x16x32_bf16 v[72:75], v[40:43], v[208:211], v[72:75]
  v_cvt_pk_bf16_f32 v112, v112, v113
  v_mfma_f32_16x16x32_bf16 v[80:83], v[40:43], v[240:243], v[80:83]
  s_waitcnt lgkmcnt(5)
  v_cvt_pk_bf16_f32 v113, v114, v115
  v_mfma_f32_16x16x32_bf16 v[60:63], v[44:47], v[144:147], v[60:63]
  ds_read_b128 v[36:39], v249 offset:51200
  v_cvt_pk_bf16_f32 v114, v116, v117
  v_mfma_f32_16x16x32_bf16 v[68:71], v[44:47], v[176:179], v[68:71]
  v_cvt_pk_bf16_f32 v115, v118, v119
  v_accvgpr_write_b32 a172, v112
  v_mfma_f32_16x16x32_bf16 v[76:79], v[44:47], v[208:211], v[76:79]
  v_accvgpr_write_b32 a173, v113
  v_mfma_f32_16x16x32_bf16 v[84:87], v[44:47], v[240:243], v[84:87]
  s_waitcnt lgkmcnt(5)
  v_accvgpr_write_b32 a174, v114
  v_mfma_f32_16x16x32_bf16 v[56:59], v[48:51], v[148:151], v[56:59]
  ds_read_b128 v[40:43], v250 offset:49152
  v_accvgpr_write_b32 a175, v115
  v_mfma_f32_16x16x32_bf16 v[64:67], v[48:51], v[180:183], v[64:67]
  v_mfma_f32_16x16x32_bf16 v[72:75], v[48:51], v[212:215], v[72:75]
  v_mfma_f32_16x16x32_bf16 v[80:83], v[48:51], v[244:247], v[80:83]
  s_waitcnt lgkmcnt(5)
  v_mfma_f32_16x16x32_bf16 v[60:63], v[52:55], v[148:151], v[60:63]
  ds_read_b128 v[44:47], v250 offset:51200
  v_mfma_f32_16x16x32_bf16 v[68:71], v[52:55], v[180:183], v[68:71]
  v_mfma_f32_16x16x32_bf16 v[76:79], v[52:55], v[212:215], v[76:79]
  v_mfma_f32_16x16x32_bf16 v[84:87], v[52:55], v[244:247], v[84:87]
  s_waitcnt lgkmcnt(5)
  s_getpc_b64 s[98:99]
  s_add_u32 s98, s98, 4096
  s_addc_u32 s99, s99, 0
  global_load_dword v7, v6, s[98:99]
  v_mfma_f32_16x16x32_bf16 v[88:91], v[24:27], v[120:123], 0
  ds_read_b128 v[48:51], v251 offset:49152
  v_mfma_f32_16x16x32_bf16 v[96:99], v[24:27], v[152:155], 0
  v_mfma_f32_16x16x32_bf16 v[104:107], v[24:27], v[184:187], 0
  s_add_u32 m0, s29, 98304
  s_add_u32 s27, s28, 1572864
  buffer_load_dwordx4 v14, s[60:63], s27 offen lds
  v_mfma_f32_16x16x32_bf16 v[112:115], v[24:27], v[216:219], 0
  s_waitcnt lgkmcnt(5)
  v_mul_f32 v56, v12, v56
  v_mfma_f32_16x16x32_bf16 v[92:95], v[28:31], v[120:123], 0
  ds_read_b128 v[52:55], v251 offset:51200
  v_mul_f32 v57, v12, v57
  v_mfma_f32_16x16x32_bf16 v[100:103], v[28:31], v[152:155], 0
  v_mul_f32 v58, v12, v58
  v_mul_f32 v59, v12, v59
  v_mfma_f32_16x16x32_bf16 v[108:111], v[28:31], v[184:187], 0
  v_mul_f32 v60, v12, v60
  v_mfma_f32_16x16x32_bf16 v[116:119], v[28:31], v[216:219], 0
  s_waitcnt lgkmcnt(5)
  v_mul_f32 v61, v12, v61
  v_mfma_f32_16x16x32_bf16 v[88:91], v[32:35], v[124:127], v[88:91]
  ds_read_b128 v[24:27], v248 offset:49408
  v_mul_f32 v62, v12, v62
  v_mfma_f32_16x16x32_bf16 v[96:99], v[32:35], v[156:159], v[96:99]
  v_mul_f32 v63, v12, v63
  v_cvt_pk_bf16_f32 v56, v56, v57
  v_mfma_f32_16x16x32_bf16 v[104:107], v[32:35], v[188:191], v[104:107]
  s_add_u32 m0, s29, 99328
  s_add_u32 s27, s28, 1589248
  buffer_load_dwordx4 v15, s[60:63], s27 offen lds
  v_mfma_f32_16x16x32_bf16 v[112:115], v[32:35], v[220:223], v[112:115]
  s_waitcnt lgkmcnt(5)
  v_cvt_pk_bf16_f32 v57, v58, v59
  v_mfma_f32_16x16x32_bf16 v[92:95], v[36:39], v[124:127], v[92:95]
  ds_read_b128 v[28:31], v248 offset:51456
  v_cvt_pk_bf16_f32 v58, v60, v61
  v_mfma_f32_16x16x32_bf16 v[100:103], v[36:39], v[156:159], v[100:103]
  v_cvt_pk_bf16_f32 v59, v62, v63
  v_accvgpr_write_b32 a8, v56
  v_mfma_f32_16x16x32_bf16 v[108:111], v[36:39], v[188:191], v[108:111]
  v_accvgpr_write_b32 a9, v57
  v_mfma_f32_16x16x32_bf16 v[116:119], v[36:39], v[220:223], v[116:119]
  s_waitcnt lgkmcnt(5)
  v_accvgpr_write_b32 a10, v58
  v_mfma_f32_16x16x32_bf16 v[88:91], v[40:43], v[128:131], v[88:91]
  ds_read_b128 v[32:35], v249 offset:49408
  v_accvgpr_write_b32 a11, v59
  v_mfma_f32_16x16x32_bf16 v[96:99], v[40:43], v[160:163], v[96:99]
  v_mul_f32 v64, v12, v64
  v_mul_f32 v65, v12, v65
  v_mfma_f32_16x16x32_bf16 v[104:107], v[40:43], v[192:195], v[104:107]
  s_add_u32 m0, s29, 100352
  s_add_u32 s27, s28, 1605632
  buffer_load_dwordx4 v14, s[60:63], s27 offen lds
  v_mfma_f32_16x16x32_bf16 v[112:115], v[40:43], v[224:227], v[112:115]
  s_waitcnt lgkmcnt(5)
  v_mul_f32 v66, v12, v66
  v_mfma_f32_16x16x32_bf16 v[92:95], v[44:47], v[128:131], v[92:95]
  ds_read_b128 v[36:39], v249 offset:51456
  v_mul_f32 v67, v12, v67
  v_mfma_f32_16x16x32_bf16 v[100:103], v[44:47], v[160:163], v[100:103]
  v_mul_f32 v68, v12, v68
  v_mul_f32 v69, v12, v69
  v_mfma_f32_16x16x32_bf16 v[108:111], v[44:47], v[192:195], v[108:111]
  v_mul_f32 v70, v12, v70
  v_mfma_f32_16x16x32_bf16 v[116:119], v[44:47], v[224:227], v[116:119]
  s_waitcnt lgkmcnt(5)
  v_mul_f32 v71, v12, v71
  v_mfma_f32_16x16x32_bf16 v[88:91], v[48:51], v[132:135], v[88:91]
  ds_read_b128 v[40:43], v250 offset:49408
  v_cvt_pk_bf16_f32 v64, v64, v65
  v_mfma_f32_16x16x32_bf16 v[96:99], v[48:51], v[164:167], v[96:99]
  v_cvt_pk_bf16_f32 v65, v66, v67
  v_cvt_pk_bf16_f32 v66, v68, v69
  v_mfma_f32_16x16x32_bf16 v[104:107], v[48:51], v[196:199], v[104:107]
  s_add_u32 m0, s29, 101376
  s_add_u32 s27, s28, 1622016
  buffer_load_dwordx4 v15, s[60:63], s27 offen lds
  v_mfma_f32_16x16x32_bf16 v[112:115], v[48:51], v[228:231], v[112:115]
  s_waitcnt lgkmcnt(5)
  v_cvt_pk_bf16_f32 v67, v70, v71
  v_mfma_f32_16x16x32_bf16 v[92:95], v[52:55], v[132:135], v[92:95]
  ds_read_b128 v[44:47], v250 offset:51456
  v_accvgpr_write_b32 a64, v64
  v_mfma_f32_16x16x32_bf16 v[100:103], v[52:55], v[164:167], v[100:103]
  v_accvgpr_write_b32 a65, v65
  v_accvgpr_write_b32 a66, v66
  v_mfma_f32_16x16x32_bf16 v[108:111], v[52:55], v[196:199], v[108:111]
  v_accvgpr_write_b32 a67, v67
  v_mfma_f32_16x16x32_bf16 v[116:119], v[52:55], v[228:231], v[116:119]
  s_waitcnt lgkmcnt(5)
  v_mul_f32 v72, v12, v72
  v_mfma_f32_16x16x32_bf16 v[88:91], v[24:27], v[136:139], v[88:91]
  ds_read_b128 v[48:51], v251 offset:49408
  v_mul_f32 v73, v12, v73
  v_mfma_f32_16x16x32_bf16 v[96:99], v[24:27], v[168:171], v[96:99]
  v_mul_f32 v74, v12, v74
  v_mul_f32 v75, v12, v75
  v_mfma_f32_16x16x32_bf16 v[104:107], v[24:27], v[200:203], v[104:107]
  v_mul_f32 v76, v12, v76
  v_mfma_f32_16x16x32_bf16 v[112:115], v[24:27], v[232:235], v[112:115]
  s_waitcnt lgkmcnt(5)
  v_mul_f32 v77, v12, v77
  v_mfma_f32_16x16x32_bf16 v[92:95], v[28:31], v[136:139], v[92:95]
  ds_read_b128 v[52:55], v251 offset:51456
  v_mul_f32 v78, v12, v78
  v_mfma_f32_16x16x32_bf16 v[100:103], v[28:31], v[168:171], v[100:103]
  v_mul_f32 v79, v12, v79
  v_cvt_pk_bf16_f32 v72, v72, v73
  v_mfma_f32_16x16x32_bf16 v[108:111], v[28:31], v[200:203], v[108:111]
  v_cvt_pk_bf16_f32 v73, v74, v75
  v_mfma_f32_16x16x32_bf16 v[116:119], v[28:31], v[232:235], v[116:119]
  s_waitcnt lgkmcnt(5)
  v_cvt_pk_bf16_f32 v74, v76, v77
  v_mfma_f32_16x16x32_bf16 v[88:91], v[32:35], v[140:143], v[88:91]
  s_waitcnt vmcnt(8)
  s_barrier
  ds_read_b128 v[24:27], v252 offset:0
  v_cvt_pk_bf16_f32 v75, v78, v79
  v_mfma_f32_16x16x32_bf16 v[96:99], v[32:35], v[172:175], v[96:99]
  v_accvgpr_write_b32 a120, v72
  v_accvgpr_write_b32 a121, v73
  v_mfma_f32_16x16x32_bf16 v[104:107], v[32:35], v[204:207], v[104:107]
  v_accvgpr_write_b32 a122, v74
  v_mfma_f32_16x16x32_bf16 v[112:115], v[32:35], v[236:239], v[112:115]
  s_waitcnt lgkmcnt(5)
  v_accvgpr_write_b32 a123, v75
  v_mfma_f32_16x16x32_bf16 v[92:95], v[36:39], v[140:143], v[92:95]
  ds_read_b128 v[28:31], v252 offset:2048
  v_mul_f32 v80, v12, v80
  v_mfma_f32_16x16x32_bf16 v[100:103], v[36:39], v[172:175], v[100:103]
  v_mul_f32 v81, v12, v81
  v_mul_f32 v82, v12, v82
  v_mfma_f32_16x16x32_bf16 v[108:111], v[36:39], v[204:207], v[108:111]
  v_mul_f32 v83, v12, v83
  v_mfma_f32_16x16x32_bf16 v[116:119], v[36:39], v[236:239], v[116:119]
  s_waitcnt lgkmcnt(5)
  v_mul_f32 v84, v12, v84
  v_mfma_f32_16x16x32_bf16 v[88:91], v[40:43], v[144:147], v[88:91]
  ds_read_b128 v[32:35], v253 offset:0
  v_mul_f32 v85, v12, v85
  v_mfma_f32_16x16x32_bf16 v[96:99], v[40:43], v[176:179], v[96:99]
  v_mul_f32 v86, v12, v86
  v_mul_f32 v87, v12, v87
  v_mfma_f32_16x16x32_bf16 v[104:107], v[40:43], v[208:211], v[104:107]
  v_cvt_pk_bf16_f32 v80, v80, v81
  v_mfma_f32_16x16x32_bf16 v[112:115], v[40:43], v[240:243], v[112:115]
  s_waitcnt lgkmcnt(5)
  v_cvt_pk_bf16_f32 v81, v82, v83
  v_mfma_f32_16x16x32_bf16 v[92:95], v[44:47], v[144:147], v[92:95]
  ds_read_b128 v[36:39], v253 offset:2048
  v_cvt_pk_bf16_f32 v82, v84, v85
  v_mfma_f32_16x16x32_bf16 v[100:103], v[44:47], v[176:179], v[100:103]
  v_cvt_pk_bf16_f32 v83, v86, v87
  v_accvgpr_write_b32 a176, v80
  v_mfma_f32_16x16x32_bf16 v[108:111], v[44:47], v[208:211], v[108:111]
  v_accvgpr_write_b32 a177, v81
  v_mfma_f32_16x16x32_bf16 v[116:119], v[44:47], v[240:243], v[116:119]
  s_waitcnt lgkmcnt(5)
  v_accvgpr_write_b32 a178, v82
  v_mfma_f32_16x16x32_bf16 v[88:91], v[48:51], v[148:151], v[88:91]
  ds_read_b128 v[40:43], v254 offset:0
  v_accvgpr_write_b32 a179, v83
  v_mfma_f32_16x16x32_bf16 v[96:99], v[48:51], v[180:183], v[96:99]
  v_mfma_f32_16x16x32_bf16 v[104:107], v[48:51], v[212:215], v[104:107]
  v_mfma_f32_16x16x32_bf16 v[112:115], v[48:51], v[244:247], v[112:115]
  s_waitcnt lgkmcnt(5)
  v_mfma_f32_16x16x32_bf16 v[92:95], v[52:55], v[148:151], v[92:95]
  ds_read_b128 v[44:47], v254 offset:2048
  v_mfma_f32_16x16x32_bf16 v[100:103], v[52:55], v[180:183], v[100:103]
  v_mfma_f32_16x16x32_bf16 v[108:111], v[52:55], v[212:215], v[108:111]
  v_mfma_f32_16x16x32_bf16 v[116:119], v[52:55], v[244:247], v[116:119]
  s_waitcnt lgkmcnt(5)
  v_mfma_f32_16x16x32_bf16 v[56:59], v[24:27], v[120:123], 0
  ds_read_b128 v[48:51], v255 offset:0
  v_mfma_f32_16x16x32_bf16 v[64:67], v[24:27], v[152:155], 0
  v_mfma_f32_16x16x32_bf16 v[72:75], v[24:27], v[184:187], 0
  s_add_u32 m0, s29, 114688
  s_add_u32 s27, s28, 1835008
  buffer_load_dwordx4 v14, s[60:63], s27 offen lds
  v_mfma_f32_16x16x32_bf16 v[80:83], v[24:27], v[216:219], 0
  s_waitcnt lgkmcnt(5)
  v_mul_f32 v88, v12, v88
  v_mfma_f32_16x16x32_bf16 v[60:63], v[28:31], v[120:123], 0
  ds_read_b128 v[52:55], v255 offset:2048
  v_mul_f32 v89, v12, v89
  v_mfma_f32_16x16x32_bf16 v[68:71], v[28:31], v[152:155], 0
  v_mul_f32 v90, v12, v90
  v_mul_f32 v91, v12, v91
  v_mfma_f32_16x16x32_bf16 v[76:79], v[28:31], v[184:187], 0
  v_mul_f32 v92, v12, v92
  v_mfma_f32_16x16x32_bf16 v[84:87], v[28:31], v[216:219], 0
  s_waitcnt lgkmcnt(5)
  v_mul_f32 v93, v12, v93
  v_mfma_f32_16x16x32_bf16 v[56:59], v[32:35], v[124:127], v[56:59]
  ds_read_b128 v[24:27], v252 offset:256
  v_mul_f32 v94, v12, v94
  v_mfma_f32_16x16x32_bf16 v[64:67], v[32:35], v[156:159], v[64:67]
  v_mul_f32 v95, v12, v95
  v_cvt_pk_bf16_f32 v88, v88, v89
  v_mfma_f32_16x16x32_bf16 v[72:75], v[32:35], v[188:191], v[72:75]
  s_add_u32 m0, s29, 115712
  s_add_u32 s27, s28, 1851392
  buffer_load_dwordx4 v15, s[60:63], s27 offen lds
  v_mfma_f32_16x16x32_bf16 v[80:83], v[32:35], v[220:223], v[80:83]
  s_waitcnt lgkmcnt(5)
  v_cvt_pk_bf16_f32 v89, v90, v91
  v_mfma_f32_16x16x32_bf16 v[60:63], v[36:39], v[124:127], v[60:63]
  ds_read_b128 v[28:31], v252 offset:2304
  v_cvt_pk_bf16_f32 v90, v92, v93
  v_mfma_f32_16x16x32_bf16 v[68:71], v[36:39], v[156:159], v[68:71]
  v_cvt_pk_bf16_f32 v91, v94, v95
  v_accvgpr_write_b32 a12, v88
  v_mfma_f32_16x16x32_bf16 v[76:79], v[36:39], v[188:191], v[76:79]
  v_accvgpr_write_b32 a13, v89
  v_mfma_f32_16x16x32_bf16 v[84:87], v[36:39], v[220:223], v[84:87]
  s_waitcnt lgkmcnt(5)
  v_accvgpr_write_b32 a14, v90
  v_mfma_f32_16x16x32_bf16 v[56:59], v[40:43], v[128:131], v[56:59]
  ds_read_b128 v[32:35], v253 offset:256
  v_accvgpr_write_b32 a15, v91
  v_mfma_f32_16x16x32_bf16 v[64:67], v[40:43], v[160:163], v[64:67]
  v_mul_f32 v96, v12, v96
  v_mul_f32 v97, v12, v97
  v_mfma_f32_16x16x32_bf16 v[72:75], v[40:43], v[192:195], v[72:75]
  s_add_u32 m0, s29, 116736
  s_add_u32 s27, s28, 1867776
  buffer_load_dwordx4 v14, s[60:63], s27 offen lds
  v_mfma_f32_16x16x32_bf16 v[80:83], v[40:43], v[224:227], v[80:83]
  s_waitcnt lgkmcnt(5)
  v_mul_f32 v98, v12, v98
  v_mfma_f32_16x16x32_bf16 v[60:63], v[44:47], v[128:131], v[60:63]
  ds_read_b128 v[36:39], v253 offset:2304
  v_mul_f32 v99, v12, v99
  v_mfma_f32_16x16x32_bf16 v[68:71], v[44:47], v[160:163], v[68:71]
  v_mul_f32 v100, v12, v100
  v_mul_f32 v101, v12, v101
  v_mfma_f32_16x16x32_bf16 v[76:79], v[44:47], v[192:195], v[76:79]
  v_mul_f32 v102, v12, v102
  v_mfma_f32_16x16x32_bf16 v[84:87], v[44:47], v[224:227], v[84:87]
  s_waitcnt lgkmcnt(5)
  v_mul_f32 v103, v12, v103
  v_mfma_f32_16x16x32_bf16 v[56:59], v[48:51], v[132:135], v[56:59]
  ds_read_b128 v[40:43], v254 offset:256
  v_cvt_pk_bf16_f32 v96, v96, v97
  v_mfma_f32_16x16x32_bf16 v[64:67], v[48:51], v[164:167], v[64:67]
  v_cvt_pk_bf16_f32 v97, v98, v99
  v_cvt_pk_bf16_f32 v98, v100, v101
  v_mfma_f32_16x16x32_bf16 v[72:75], v[48:51], v[196:199], v[72:75]
  s_add_u32 m0, s29, 117760
  s_add_u32 s27, s28, 1884160
  buffer_load_dwordx4 v15, s[60:63], s27 offen lds
  v_mfma_f32_16x16x32_bf16 v[80:83], v[48:51], v[228:231], v[80:83]
  s_waitcnt lgkmcnt(5)
  v_cvt_pk_bf16_f32 v99, v102, v103
  v_mfma_f32_16x16x32_bf16 v[60:63], v[52:55], v[132:135], v[60:63]
  ds_read_b128 v[44:47], v254 offset:2304
  v_accvgpr_write_b32 a68, v96
  v_mfma_f32_16x16x32_bf16 v[68:71], v[52:55], v[164:167], v[68:71]
  v_accvgpr_write_b32 a69, v97
  v_accvgpr_write_b32 a70, v98
  v_mfma_f32_16x16x32_bf16 v[76:79], v[52:55], v[196:199], v[76:79]
  v_accvgpr_write_b32 a71, v99
  v_mfma_f32_16x16x32_bf16 v[84:87], v[52:55], v[228:231], v[84:87]
  s_waitcnt lgkmcnt(5)
  v_mul_f32 v104, v12, v104
  v_mfma_f32_16x16x32_bf16 v[56:59], v[24:27], v[136:139], v[56:59]
  ds_read_b128 v[48:51], v255 offset:256
  v_mul_f32 v105, v12, v105
  v_mfma_f32_16x16x32_bf16 v[64:67], v[24:27], v[168:171], v[64:67]
  v_mul_f32 v106, v12, v106
  v_mul_f32 v107, v12, v107
  v_mfma_f32_16x16x32_bf16 v[72:75], v[24:27], v[200:203], v[72:75]
  v_mul_f32 v108, v12, v108
  v_mfma_f32_16x16x32_bf16 v[80:83], v[24:27], v[232:235], v[80:83]
  s_waitcnt lgkmcnt(5)
  v_mul_f32 v109, v12, v109
  v_mfma_f32_16x16x32_bf16 v[60:63], v[28:31], v[136:139], v[60:63]
  ds_read_b128 v[52:55], v255 offset:2304
  v_mul_f32 v110, v12, v110
  v_mfma_f32_16x16x32_bf16 v[68:71], v[28:31], v[168:171], v[68:71]
  v_mul_f32 v111, v12, v111
  v_cvt_pk_bf16_f32 v104, v104, v105
  v_mfma_f32_16x16x32_bf16 v[76:79], v[28:31], v[200:203], v[76:79]
  v_cvt_pk_bf16_f32 v105, v106, v107
  v_mfma_f32_16x16x32_bf16 v[84:87], v[28:31], v[232:235], v[84:87]
  s_waitcnt lgkmcnt(5)
  v_cvt_pk_bf16_f32 v106, v108, v109
  v_mfma_f32_16x16x32_bf16 v[56:59], v[32:35], v[140:143], v[56:59]
  s_waitcnt vmcnt(8)
  s_barrier
  ds_read_b128 v[24:27], v252 offset:16384
  v_cvt_pk_bf16_f32 v107, v110, v111
  v_mfma_f32_16x16x32_bf16 v[64:67], v[32:35], v[172:175], v[64:67]
  v_accvgpr_write_b32 a124, v104
  v_accvgpr_write_b32 a125, v105
  v_mfma_f32_16x16x32_bf16 v[72:75], v[32:35], v[204:207], v[72:75]
  v_accvgpr_write_b32 a126, v106
  v_mfma_f32_16x16x32_bf16 v[80:83], v[32:35], v[236:239], v[80:83]
  s_waitcnt lgkmcnt(5)
  v_accvgpr_write_b32 a127, v107
  v_mfma_f32_16x16x32_bf16 v[60:63], v[36:39], v[140:143], v[60:63]
  ds_read_b128 v[28:31], v252 offset:18432
  v_mul_f32 v112, v12, v112
  v_mfma_f32_16x16x32_bf16 v[68:71], v[36:39], v[172:175], v[68:71]
  v_mul_f32 v113, v12, v113
  v_mul_f32 v114, v12, v114
  v_mfma_f32_16x16x32_bf16 v[76:79], v[36:39], v[204:207], v[76:79]
  v_mul_f32 v115, v12, v115
  v_mfma_f32_16x16x32_bf16 v[84:87], v[36:39], v[236:239], v[84:87]
  s_waitcnt lgkmcnt(5)
  v_mul_f32 v116, v12, v116
  v_mfma_f32_16x16x32_bf16 v[56:59], v[40:43], v[144:147], v[56:59]
  ds_read_b128 v[32:35], v253 offset:16384
  v_mul_f32 v117, v12, v117
  v_mfma_f32_16x16x32_bf16 v[64:67], v[40:43], v[176:179], v[64:67]
  v_mul_f32 v118, v12, v118
  v_mul_f32 v119, v12, v119
  v_mfma_f32_16x16x32_bf16 v[72:75], v[40:43], v[208:211], v[72:75]
  v_cvt_pk_bf16_f32 v112, v112, v113
  v_mfma_f32_16x16x32_bf16 v[80:83], v[40:43], v[240:243], v[80:83]
  s_waitcnt lgkmcnt(5)
  v_cvt_pk_bf16_f32 v113, v114, v115
  v_mfma_f32_16x16x32_bf16 v[60:63], v[44:47], v[144:147], v[60:63]
  ds_read_b128 v[36:39], v253 offset:18432
  v_cvt_pk_bf16_f32 v114, v116, v117
  v_mfma_f32_16x16x32_bf16 v[68:71], v[44:47], v[176:179], v[68:71]
  v_cvt_pk_bf16_f32 v115, v118, v119
  v_accvgpr_write_b32 a180, v112
  v_mfma_f32_16x16x32_bf16 v[76:79], v[44:47], v[208:211], v[76:79]
  v_accvgpr_write_b32 a181, v113
  v_mfma_f32_16x16x32_bf16 v[84:87], v[44:47], v[240:243], v[84:87]
  s_waitcnt lgkmcnt(5)
  v_accvgpr_write_b32 a182, v114
  v_mfma_f32_16x16x32_bf16 v[56:59], v[48:51], v[148:151], v[56:59]
  ds_read_b128 v[40:43], v254 offset:16384
  v_accvgpr_write_b32 a183, v115
  v_mfma_f32_16x16x32_bf16 v[64:67], v[48:51], v[180:183], v[64:67]
  v_mfma_f32_16x16x32_bf16 v[72:75], v[48:51], v[212:215], v[72:75]
  v_mfma_f32_16x16x32_bf16 v[80:83], v[48:51], v[244:247], v[80:83]
  s_waitcnt lgkmcnt(5)
  v_mfma_f32_16x16x32_bf16 v[60:63], v[52:55], v[148:151], v[60:63]
  ds_read_b128 v[44:47], v254 offset:18432
  v_mfma_f32_16x16x32_bf16 v[68:71], v[52:55], v[180:183], v[68:71]
  v_mfma_f32_16x16x32_bf16 v[76:79], v[52:55], v[212:215], v[76:79]
  v_mfma_f32_16x16x32_bf16 v[84:87], v[52:55], v[244:247], v[84:87]
  s_waitcnt lgkmcnt(5)
  v_mfma_f32_16x16x32_bf16 v[88:91], v[24:27], v[120:123], 0
  ds_read_b128 v[48:51], v255 offset:16384
  v_mfma_f32_16x16x32_bf16 v[96:99], v[24:27], v[152:155], 0
  v_mfma_f32_16x16x32_bf16 v[104:107], v[24:27], v[184:187], 0
  s_add_u32 m0, s29, 131072
  s_add_u32 s27, s28, 2097152
  buffer_load_dwordx4 v14, s[60:63], s27 offen lds
  v_mfma_f32_16x16x32_bf16 v[112:115], v[24:27], v[216:219], 0
  s_waitcnt lgkmcnt(5)
  v_mul_f32 v56, v12, v56
  v_mfma_f32_16x16x32_bf16 v[92:95], v[28:31], v[120:123], 0
  ds_read_b128 v[52:55], v255 offset:18432
  v_mul_f32 v57, v12, v57
  v_mfma_f32_16x16x32_bf16 v[100:103], v[28:31], v[152:155], 0
  v_mul_f32 v58, v12, v58
  v_mul_f32 v59, v12, v59
  v_mfma_f32_16x16x32_bf16 v[108:111], v[28:31], v[184:187], 0
  v_mul_f32 v60, v12, v60
  v_mfma_f32_16x16x32_bf16 v[116:119], v[28:31], v[216:219], 0
  s_waitcnt lgkmcnt(5)
  v_mul_f32 v61, v12, v61
  v_mfma_f32_16x16x32_bf16 v[88:91], v[32:35], v[124:127], v[88:91]
  ds_read_b128 v[24:27], v252 offset:16640
  v_mul_f32 v62, v12, v62
  v_mfma_f32_16x16x32_bf16 v[96:99], v[32:35], v[156:159], v[96:99]
  v_mul_f32 v63, v12, v63
  v_cvt_pk_bf16_f32 v56, v56, v57
  v_mfma_f32_16x16x32_bf16 v[104:107], v[32:35], v[188:191], v[104:107]
  s_add_u32 m0, s29, 132096
  s_add_u32 s27, s28, 2113536
  buffer_load_dwordx4 v15, s[60:63], s27 offen lds
  v_mfma_f32_16x16x32_bf16 v[112:115], v[32:35], v[220:223], v[112:115]
  s_waitcnt lgkmcnt(5)
  v_cvt_pk_bf16_f32 v57, v58, v59
  v_mfma_f32_16x16x32_bf16 v[92:95], v[36:39], v[124:127], v[92:95]
  ds_read_b128 v[28:31], v252 offset:18688
  v_cvt_pk_bf16_f32 v58, v60, v61
  v_mfma_f32_16x16x32_bf16 v[100:103], v[36:39], v[156:159], v[100:103]
  v_cvt_pk_bf16_f32 v59, v62, v63
  v_accvgpr_write_b32 a16, v56
  v_mfma_f32_16x16x32_bf16 v[108:111], v[36:39], v[188:191], v[108:111]
  v_accvgpr_write_b32 a17, v57
  v_mfma_f32_16x16x32_bf16 v[116:119], v[36:39], v[220:223], v[116:119]
  s_waitcnt lgkmcnt(5)
  v_accvgpr_write_b32 a18, v58
  v_mfma_f32_16x16x32_bf16 v[88:91], v[40:43], v[128:131], v[88:91]
  ds_read_b128 v[32:35], v253 offset:16640
  v_accvgpr_write_b32 a19, v59
  v_mfma_f32_16x16x32_bf16 v[96:99], v[40:43], v[160:163], v[96:99]
  v_mul_f32 v64, v12, v64
  v_mul_f32 v65, v12, v65
  v_mfma_f32_16x16x32_bf16 v[104:107], v[40:43], v[192:195], v[104:107]
  s_add_u32 m0, s29, 133120
  s_add_u32 s27, s28, 2129920
  buffer_load_dwordx4 v14, s[60:63], s27 offen lds
  v_mfma_f32_16x16x32_bf16 v[112:115], v[40:43], v[224:227], v[112:115]
  s_waitcnt lgkmcnt(5)
  v_mul_f32 v66, v12, v66
  v_mfma_f32_16x16x32_bf16 v[92:95], v[44:47], v[128:131], v[92:95]
  ds_read_b128 v[36:39], v253 offset:18688
  v_mul_f32 v67, v12, v67
  v_mfma_f32_16x16x32_bf16 v[100:103], v[44:47], v[160:163], v[100:103]
  v_mul_f32 v68, v12, v68
  v_mul_f32 v69, v12, v69
  v_mfma_f32_16x16x32_bf16 v[108:111], v[44:47], v[192:195], v[108:111]
  v_mul_f32 v70, v12, v70
  v_mfma_f32_16x16x32_bf16 v[116:119], v[44:47], v[224:227], v[116:119]
  s_waitcnt lgkmcnt(5)
  v_mul_f32 v71, v12, v71
  v_mfma_f32_16x16x32_bf16 v[88:91], v[48:51], v[132:135], v[88:91]
  ds_read_b128 v[40:43], v254 offset:16640
  v_cvt_pk_bf16_f32 v64, v64, v65
  v_mfma_f32_16x16x32_bf16 v[96:99], v[48:51], v[164:167], v[96:99]
  v_cvt_pk_bf16_f32 v65, v66, v67
  v_cvt_pk_bf16_f32 v66, v68, v69
  v_mfma_f32_16x16x32_bf16 v[104:107], v[48:51], v[196:199], v[104:107]
  s_add_u32 m0, s29, 134144
  s_add_u32 s27, s28, 2146304
  buffer_load_dwordx4 v15, s[60:63], s27 offen lds
  v_mfma_f32_16x16x32_bf16 v[112:115], v[48:51], v[228:231], v[112:115]
  s_waitcnt lgkmcnt(5)
  v_cvt_pk_bf16_f32 v67, v70, v71
  v_mfma_f32_16x16x32_bf16 v[92:95], v[52:55], v[132:135], v[92:95]
  ds_read_b128 v[44:47], v254 offset:18688
  v_accvgpr_write_b32 a72, v64
  v_mfma_f32_16x16x32_bf16 v[100:103], v[52:55], v[164:167], v[100:103]
  v_accvgpr_write_b32 a73, v65
  v_accvgpr_write_b32 a74, v66
  v_mfma_f32_16x16x32_bf16 v[108:111], v[52:55], v[196:199], v[108:111]
  v_accvgpr_write_b32 a75, v67
  v_mfma_f32_16x16x32_bf16 v[116:119], v[52:55], v[228:231], v[116:119]
  s_waitcnt lgkmcnt(5)
  v_mul_f32 v72, v12, v72
  v_mfma_f32_16x16x32_bf16 v[88:91], v[24:27], v[136:139], v[88:91]
  ds_read_b128 v[48:51], v255 offset:16640
  v_mul_f32 v73, v12, v73
  v_mfma_f32_16x16x32_bf16 v[96:99], v[24:27], v[168:171], v[96:99]
  v_mul_f32 v74, v12, v74
  v_mul_f32 v75, v12, v75
  v_mfma_f32_16x16x32_bf16 v[104:107], v[24:27], v[200:203], v[104:107]
  v_mul_f32 v76, v12, v76
  v_mfma_f32_16x16x32_bf16 v[112:115], v[24:27], v[232:235], v[112:115]
  s_waitcnt lgkmcnt(5)
  v_mul_f32 v77, v12, v77
  v_mfma_f32_16x16x32_bf16 v[92:95], v[28:31], v[136:139], v[92:95]
  ds_read_b128 v[52:55], v255 offset:18688
  v_mul_f32 v78, v12, v78
  v_mfma_f32_16x16x32_bf16 v[100:103], v[28:31], v[168:171], v[100:103]
  v_mul_f32 v79, v12, v79
  v_cvt_pk_bf16_f32 v72, v72, v73
  v_mfma_f32_16x16x32_bf16 v[108:111], v[28:31], v[200:203], v[108:111]
  v_cvt_pk_bf16_f32 v73, v74, v75
  v_mfma_f32_16x16x32_bf16 v[116:119], v[28:31], v[232:235], v[116:119]
  s_waitcnt lgkmcnt(5)
  v_cvt_pk_bf16_f32 v74, v76, v77
  v_mfma_f32_16x16x32_bf16 v[88:91], v[32:35], v[140:143], v[88:91]
  s_waitcnt vmcnt(8)
  s_barrier
  ds_read_b128 v[24:27], v252 offset:32768
  v_cvt_pk_bf16_f32 v75, v78, v79
  v_mfma_f32_16x16x32_bf16 v[96:99], v[32:35], v[172:175], v[96:99]
  v_accvgpr_write_b32 a128, v72
  v_accvgpr_write_b32 a129, v73
  v_mfma_f32_16x16x32_bf16 v[104:107], v[32:35], v[204:207], v[104:107]
  v_accvgpr_write_b32 a130, v74
  v_mfma_f32_16x16x32_bf16 v[112:115], v[32:35], v[236:239], v[112:115]
  s_waitcnt lgkmcnt(5)
  v_accvgpr_write_b32 a131, v75
  v_mfma_f32_16x16x32_bf16 v[92:95], v[36:39], v[140:143], v[92:95]
  ds_read_b128 v[28:31], v252 offset:34816
  v_mul_f32 v80, v12, v80
  v_mfma_f32_16x16x32_bf16 v[100:103], v[36:39], v[172:175], v[100:103]
  v_mul_f32 v81, v12, v81
  v_mul_f32 v82, v12, v82
  v_mfma_f32_16x16x32_bf16 v[108:111], v[36:39], v[204:207], v[108:111]
  v_mul_f32 v83, v12, v83
  v_mfma_f32_16x16x32_bf16 v[116:119], v[36:39], v[236:239], v[116:119]
  s_waitcnt lgkmcnt(5)
  v_mul_f32 v84, v12, v84
  v_mfma_f32_16x16x32_bf16 v[88:91], v[40:43], v[144:147], v[88:91]
  ds_read_b128 v[32:35], v253 offset:32768
  v_mul_f32 v85, v12, v85
  v_mfma_f32_16x16x32_bf16 v[96:99], v[40:43], v[176:179], v[96:99]
  v_mul_f32 v86, v12, v86
  v_mul_f32 v87, v12, v87
  v_mfma_f32_16x16x32_bf16 v[104:107], v[40:43], v[208:211], v[104:107]
  v_cvt_pk_bf16_f32 v80, v80, v81
  v_mfma_f32_16x16x32_bf16 v[112:115], v[40:43], v[240:243], v[112:115]
  s_waitcnt lgkmcnt(5)
  v_cvt_pk_bf16_f32 v81, v82, v83
  v_mfma_f32_16x16x32_bf16 v[92:95], v[44:47], v[144:147], v[92:95]
  ds_read_b128 v[36:39], v253 offset:34816
  v_cvt_pk_bf16_f32 v82, v84, v85
  v_mfma_f32_16x16x32_bf16 v[100:103], v[44:47], v[176:179], v[100:103]
  v_cvt_pk_bf16_f32 v83, v86, v87
  v_accvgpr_write_b32 a184, v80
  v_mfma_f32_16x16x32_bf16 v[108:111], v[44:47], v[208:211], v[108:111]
  v_accvgpr_write_b32 a185, v81
  v_mfma_f32_16x16x32_bf16 v[116:119], v[44:47], v[240:243], v[116:119]
  s_waitcnt lgkmcnt(5)
  v_accvgpr_write_b32 a186, v82
  v_mfma_f32_16x16x32_bf16 v[88:91], v[48:51], v[148:151], v[88:91]
  ds_read_b128 v[40:43], v254 offset:32768
  v_accvgpr_write_b32 a187, v83
  v_mfma_f32_16x16x32_bf16 v[96:99], v[48:51], v[180:183], v[96:99]
  v_mfma_f32_16x16x32_bf16 v[104:107], v[48:51], v[212:215], v[104:107]
  v_mfma_f32_16x16x32_bf16 v[112:115], v[48:51], v[244:247], v[112:115]
  s_waitcnt lgkmcnt(5)
  v_mfma_f32_16x16x32_bf16 v[92:95], v[52:55], v[148:151], v[92:95]
  ds_read_b128 v[44:47], v254 offset:34816
  v_mfma_f32_16x16x32_bf16 v[100:103], v[52:55], v[180:183], v[100:103]
  v_mfma_f32_16x16x32_bf16 v[108:111], v[52:55], v[212:215], v[108:111]
  v_mfma_f32_16x16x32_bf16 v[116:119], v[52:55], v[244:247], v[116:119]
  s_waitcnt lgkmcnt(5)
  s_getpc_b64 s[98:99]
  s_add_u32 s98, s98, 4096
  s_addc_u32 s99, s99, 0
  global_load_dword v7, v6, s[98:99]
  v_mfma_f32_16x16x32_bf16 v[56:59], v[24:27], v[120:123], 0
  ds_read_b128 v[48:51], v255 offset:32768
  v_mfma_f32_16x16x32_bf16 v[64:67], v[24:27], v[152:155], 0
  v_mfma_f32_16x16x32_bf16 v[72:75], v[24:27], v[184:187], 0
  s_add_u32 m0, s29, 147456
  s_add_u32 s27, s28, 2359296
  buffer_load_dwordx4 v14, s[60:63], s27 offen lds
  v_mfma_f32_16x16x32_bf16 v[80:83], v[24:27], v[216:219], 0
  s_waitcnt lgkmcnt(5)
  v_mul_f32 v88, v12, v88
  v_mfma_f32_16x16x32_bf16 v[60:63], v[28:31], v[120:123], 0
  ds_read_b128 v[52:55], v255 offset:34816
  v_mul_f32 v89, v12, v89
  v_mfma_f32_16x16x32_bf16 v[68:71], v[28:31], v[152:155], 0
  v_mul_f32 v90, v12, v90
  v_mul_f32 v91, v12, v91
  v_mfma_f32_16x16x32_bf16 v[76:79], v[28:31], v[184:187], 0
  v_mul_f32 v92, v12, v92
  v_mfma_f32_16x16x32_bf16 v[84:87], v[28:31], v[216:219], 0
  s_waitcnt lgkmcnt(5)
  v_mul_f32 v93, v12, v93
  v_mfma_f32_16x16x32_bf16 v[56:59], v[32:35], v[124:127], v[56:59]
  ds_read_b128 v[24:27], v252 offset:33024
  v_mul_f32 v94, v12, v94
  v_mfma_f32_16x16x32_bf16 v[64:67], v[32:35], v[156:159], v[64:67]
  v_mul_f32 v95, v12, v95
  v_cvt_pk_bf16_f32 v88, v88, v89
  v_mfma_f32_16x16x32_bf16 v[72:75], v[32:35], v[188:191], v[72:75]
  s_add_u32 m0, s29, 148480
  s_add_u32 s27, s28, 2375680
  buffer_load_dwordx4 v15, s[60:63], s27 offen lds
  v_mfma_f32_16x16x32_bf16 v[80:83], v[32:35], v[220:223], v[80:83]
  s_waitcnt lgkmcnt(5)
  v_cvt_pk_bf16_f32 v89, v90, v91
  v_mfma_f32_16x16x32_bf16 v[60:63], v[36:39], v[124:127], v[60:63]
  ds_read_b128 v[28:31], v252 offset:35072
  v_cvt_pk_bf16_f32 v90, v92, v93
  v_mfma_f32_16x16x32_bf16 v[68:71], v[36:39], v[156:159], v[68:71]
  v_cvt_pk_bf16_f32 v91, v94, v95
  v_accvgpr_write_b32 a20, v88
  v_mfma_f32_16x16x32_bf16 v[76:79], v[36:39], v[188:191], v[76:79]
  v_accvgpr_write_b32 a21, v89
  v_mfma_f32_16x16x32_bf16 v[84:87], v[36:39], v[220:223], v[84:87]
  s_waitcnt lgkmcnt(5)
  v_accvgpr_write_b32 a22, v90
  v_mfma_f32_16x16x32_bf16 v[56:59], v[40:43], v[128:131], v[56:59]
  ds_read_b128 v[32:35], v253 offset:33024
  v_accvgpr_write_b32 a23, v91
  v_mfma_f32_16x16x32_bf16 v[64:67], v[40:43], v[160:163], v[64:67]
  v_mul_f32 v96, v12, v96
  v_mul_f32 v97, v12, v97
  v_mfma_f32_16x16x32_bf16 v[72:75], v[40:43], v[192:195], v[72:75]
  s_add_u32 m0, s29, 149504
  s_add_u32 s27, s28, 2392064
  buffer_load_dwordx4 v14, s[60:63], s27 offen lds
  v_mfma_f32_16x16x32_bf16 v[80:83], v[40:43], v[224:227], v[80:83]
  s_waitcnt lgkmcnt(5)
  v_mul_f32 v98, v12, v98
  v_mfma_f32_16x16x32_bf16 v[60:63], v[44:47], v[128:131], v[60:63]
  ds_read_b128 v[36:39], v253 offset:35072
  v_mul_f32 v99, v12, v99
  v_mfma_f32_16x16x32_bf16 v[68:71], v[44:47], v[160:163], v[68:71]
  v_mul_f32 v100, v12, v100
  v_mul_f32 v101, v12, v101
  v_mfma_f32_16x16x32_bf16 v[76:79], v[44:47], v[192:195], v[76:79]
  v_mul_f32 v102, v12, v102
  v_mfma_f32_16x16x32_bf16 v[84:87], v[44:47], v[224:227], v[84:87]
  s_waitcnt lgkmcnt(5)
  v_mul_f32 v103, v12, v103
  v_mfma_f32_16x16x32_bf16 v[56:59], v[48:51], v[132:135], v[56:59]
  ds_read_b128 v[40:43], v254 offset:33024
  v_cvt_pk_bf16_f32 v96, v96, v97
  v_mfma_f32_16x16x32_bf16 v[64:67], v[48:51], v[164:167], v[64:67]
  v_cvt_pk_bf16_f32 v97, v98, v99
  v_cvt_pk_bf16_f32 v98, v100, v101
  v_mfma_f32_16x16x32_bf16 v[72:75], v[48:51], v[196:199], v[72:75]
  s_add_u32 m0, s29, 150528
  s_add_u32 s27, s28, 2408448
  buffer_load_dwordx4 v15, s[60:63], s27 offen lds
  v_mfma_f32_16x16x32_bf16 v[80:83], v[48:51], v[228:231], v[80:83]
  s_waitcnt lgkmcnt(5)
  v_cvt_pk_bf16_f32 v99, v102, v103
  v_mfma_f32_16x16x32_bf16 v[60:63], v[52:55], v[132:135], v[60:63]
  ds_read_b128 v[44:47], v254 offset:35072
  v_accvgpr_write_b32 a76, v96
  v_mfma_f32_16x16x32_bf16 v[68:71], v[52:55], v[164:167], v[68:71]
  v_accvgpr_write_b32 a77, v97
  v_accvgpr_write_b32 a78, v98
  v_mfma_f32_16x16x32_bf16 v[76:79], v[52:55], v[196:199], v[76:79]
  v_accvgpr_write_b32 a79, v99
  v_mfma_f32_16x16x32_bf16 v[84:87], v[52:55], v[228:231], v[84:87]
  s_waitcnt lgkmcnt(5)
  v_mul_f32 v104, v12, v104
  v_mfma_f32_16x16x32_bf16 v[56:59], v[24:27], v[136:139], v[56:59]
  ds_read_b128 v[48:51], v255 offset:33024
  v_mul_f32 v105, v12, v105
  v_mfma_f32_16x16x32_bf16 v[64:67], v[24:27], v[168:171], v[64:67]
  v_mul_f32 v106, v12, v106
  v_mul_f32 v107, v12, v107
  v_mfma_f32_16x16x32_bf16 v[72:75], v[24:27], v[200:203], v[72:75]
  v_mul_f32 v108, v12, v108
  v_mfma_f32_16x16x32_bf16 v[80:83], v[24:27], v[232:235], v[80:83]
  s_waitcnt lgkmcnt(5)
  v_mul_f32 v109, v12, v109
  v_mfma_f32_16x16x32_bf16 v[60:63], v[28:31], v[136:139], v[60:63]
  ds_read_b128 v[52:55], v255 offset:35072
  v_mul_f32 v110, v12, v110
  v_mfma_f32_16x16x32_bf16 v[68:71], v[28:31], v[168:171], v[68:71]
  v_mul_f32 v111, v12, v111
  v_cvt_pk_bf16_f32 v104, v104, v105
  v_mfma_f32_16x16x32_bf16 v[76:79], v[28:31], v[200:203], v[76:79]
  v_cvt_pk_bf16_f32 v105, v106, v107
  v_mfma_f32_16x16x32_bf16 v[84:87], v[28:31], v[232:235], v[84:87]
  s_waitcnt lgkmcnt(5)
  v_cvt_pk_bf16_f32 v106, v108, v109
  v_mfma_f32_16x16x32_bf16 v[56:59], v[32:35], v[140:143], v[56:59]
  s_waitcnt vmcnt(8)
  s_barrier
  ds_read_b128 v[24:27], v252 offset:49152
  v_cvt_pk_bf16_f32 v107, v110, v111
  v_mfma_f32_16x16x32_bf16 v[64:67], v[32:35], v[172:175], v[64:67]
  v_accvgpr_write_b32 a132, v104
  v_accvgpr_write_b32 a133, v105
  v_mfma_f32_16x16x32_bf16 v[72:75], v[32:35], v[204:207], v[72:75]
  v_accvgpr_write_b32 a134, v106
  v_mfma_f32_16x16x32_bf16 v[80:83], v[32:35], v[236:239], v[80:83]
  s_waitcnt lgkmcnt(5)
  v_accvgpr_write_b32 a135, v107
  v_mfma_f32_16x16x32_bf16 v[60:63], v[36:39], v[140:143], v[60:63]
  ds_read_b128 v[28:31], v252 offset:51200
  v_mul_f32 v112, v12, v112
  v_mfma_f32_16x16x32_bf16 v[68:71], v[36:39], v[172:175], v[68:71]
  v_mul_f32 v113, v12, v113
  v_mul_f32 v114, v12, v114
  v_mfma_f32_16x16x32_bf16 v[76:79], v[36:39], v[204:207], v[76:79]
  v_mul_f32 v115, v12, v115
  v_mfma_f32_16x16x32_bf16 v[84:87], v[36:39], v[236:239], v[84:87]
  s_waitcnt lgkmcnt(5)
  v_mul_f32 v116, v12, v116
  v_mfma_f32_16x16x32_bf16 v[56:59], v[40:43], v[144:147], v[56:59]
  ds_read_b128 v[32:35], v253 offset:49152
  v_mul_f32 v117, v12, v117
  v_mfma_f32_16x16x32_bf16 v[64:67], v[40:43], v[176:179], v[64:67]
  v_mul_f32 v118, v12, v118
  v_mul_f32 v119, v12, v119
  v_mfma_f32_16x16x32_bf16 v[72:75], v[40:43], v[208:211], v[72:75]
  v_cvt_pk_bf16_f32 v112, v112, v113
  v_mfma_f32_16x16x32_bf16 v[80:83], v[40:43], v[240:243], v[80:83]
  s_waitcnt lgkmcnt(5)
  v_cvt_pk_bf16_f32 v113, v114, v115
  v_mfma_f32_16x16x32_bf16 v[60:63], v[44:47], v[144:147], v[60:63]
  ds_read_b128 v[36:39], v253 offset:51200
  v_cvt_pk_bf16_f32 v114, v116, v117
  v_mfma_f32_16x16x32_bf16 v[68:71], v[44:47], v[176:179], v[68:71]
  v_cvt_pk_bf16_f32 v115, v118, v119
  v_accvgpr_write_b32 a188, v112
  v_mfma_f32_16x16x32_bf16 v[76:79], v[44:47], v[208:211], v[76:79]
  v_accvgpr_write_b32 a189, v113
  v_mfma_f32_16x16x32_bf16 v[84:87], v[44:47], v[240:243], v[84:87]
  s_waitcnt lgkmcnt(5)
  v_accvgpr_write_b32 a190, v114
  v_mfma_f32_16x16x32_bf16 v[56:59], v[48:51], v[148:151], v[56:59]
  ds_read_b128 v[40:43], v254 offset:49152
  v_accvgpr_write_b32 a191, v115
  v_mfma_f32_16x16x32_bf16 v[64:67], v[48:51], v[180:183], v[64:67]
  v_mfma_f32_16x16x32_bf16 v[72:75], v[48:51], v[212:215], v[72:75]
  v_mfma_f32_16x16x32_bf16 v[80:83], v[48:51], v[244:247], v[80:83]
  s_waitcnt lgkmcnt(5)
  v_mfma_f32_16x16x32_bf16 v[60:63], v[52:55], v[148:151], v[60:63]
  ds_read_b128 v[44:47], v254 offset:51200
  v_mfma_f32_16x16x32_bf16 v[68:71], v[52:55], v[180:183], v[68:71]
  v_mfma_f32_16x16x32_bf16 v[76:79], v[52:55], v[212:215], v[76:79]
  v_mfma_f32_16x16x32_bf16 v[84:87], v[52:55], v[244:247], v[84:87]
  s_waitcnt lgkmcnt(5)
  v_mfma_f32_16x16x32_bf16 v[88:91], v[24:27], v[120:123], 0
  ds_read_b128 v[48:51], v255 offset:49152
  v_mfma_f32_16x16x32_bf16 v[96:99], v[24:27], v[152:155], 0
  v_mfma_f32_16x16x32_bf16 v[104:107], v[24:27], v[184:187], 0
  s_add_u32 m0, s29, 0
  s_add_u32 s27, s28, 2621440
  buffer_load_dwordx4 v14, s[60:63], s27 offen lds
  v_mfma_f32_16x16x32_bf16 v[112:115], v[24:27], v[216:219], 0
  s_waitcnt lgkmcnt(5)
  v_mul_f32 v56, v12, v56
  v_mfma_f32_16x16x32_bf16 v[92:95], v[28:31], v[120:123], 0
  ds_read_b128 v[52:55], v255 offset:51200
  v_mul_f32 v57, v12, v57
  v_mfma_f32_16x16x32_bf16 v[100:103], v[28:31], v[152:155], 0
  v_mul_f32 v58, v12, v58
  v_mul_f32 v59, v12, v59
  v_mfma_f32_16x16x32_bf16 v[108:111], v[28:31], v[184:187], 0
  v_mul_f32 v60, v12, v60
  v_mfma_f32_16x16x32_bf16 v[116:119], v[28:31], v[216:219], 0
  s_waitcnt lgkmcnt(5)
  v_mul_f32 v61, v12, v61
  v_mfma_f32_16x16x32_bf16 v[88:91], v[32:35], v[124:127], v[88:91]
  ds_read_b128 v[24:27], v252 offset:49408
  v_mul_f32 v62, v12, v62
  v_mfma_f32_16x16x32_bf16 v[96:99], v[32:35], v[156:159], v[96:99]
  v_mul_f32 v63, v12, v63
  v_cvt_pk_bf16_f32 v56, v56, v57
  v_mfma_f32_16x16x32_bf16 v[104:107], v[32:35], v[188:191], v[104:107]
  s_add_u32 m0, s29, 1024
  s_add_u32 s27, s28, 2637824
  buffer_load_dwordx4 v15, s[60:63], s27 offen lds
  v_mfma_f32_16x16x32_bf16 v[112:115], v[32:35], v[220:223], v[112:115]
  s_waitcnt lgkmcnt(5)
  v_cvt_pk_bf16_f32 v57, v58, v59
  v_mfma_f32_16x16x32_bf16 v[92:95], v[36:39], v[124:127], v[92:95]
  ds_read_b128 v[28:31], v252 offset:51456
  v_cvt_pk_bf16_f32 v58, v60, v61
  v_mfma_f32_16x16x32_bf16 v[100:103], v[36:39], v[156:159], v[100:103]
  v_cvt_pk_bf16_f32 v59, v62, v63
  v_accvgpr_write_b32 a24, v56
  v_mfma_f32_16x16x32_bf16 v[108:111], v[36:39], v[188:191], v[108:111]
  v_accvgpr_write_b32 a25, v57
  v_mfma_f32_16x16x32_bf16 v[116:119], v[36:39], v[220:223], v[116:119]
  s_waitcnt lgkmcnt(5)
  v_accvgpr_write_b32 a26, v58
  v_mfma_f32_16x16x32_bf16 v[88:91], v[40:43], v[128:131], v[88:91]
  ds_read_b128 v[32:35], v253 offset:49408
  v_accvgpr_write_b32 a27, v59
  v_mfma_f32_16x16x32_bf16 v[96:99], v[40:43], v[160:163], v[96:99]
  v_mul_f32 v64, v12, v64
  v_mul_f32 v65, v12, v65
  v_mfma_f32_16x16x32_bf16 v[104:107], v[40:43], v[192:195], v[104:107]
  s_add_u32 m0, s29, 2048
  s_add_u32 s27, s28, 2654208
  buffer_load_dwordx4 v14, s[60:63], s27 offen lds
  v_mfma_f32_16x16x32_bf16 v[112:115], v[40:43], v[224:227], v[112:115]
  s_waitcnt lgkmcnt(5)
  v_mul_f32 v66, v12, v66
  v_mfma_f32_16x16x32_bf16 v[92:95], v[44:47], v[128:131], v[92:95]
  ds_read_b128 v[36:39], v253 offset:51456
  v_mul_f32 v67, v12, v67
  v_mfma_f32_16x16x32_bf16 v[100:103], v[44:47], v[160:163], v[100:103]
  v_mul_f32 v68, v12, v68
  v_mul_f32 v69, v12, v69
  v_mfma_f32_16x16x32_bf16 v[108:111], v[44:47], v[192:195], v[108:111]
  v_mul_f32 v70, v12, v70
  v_mfma_f32_16x16x32_bf16 v[116:119], v[44:47], v[224:227], v[116:119]
  s_waitcnt lgkmcnt(5)
  v_mul_f32 v71, v12, v71
  v_mfma_f32_16x16x32_bf16 v[88:91], v[48:51], v[132:135], v[88:91]
  ds_read_b128 v[40:43], v254 offset:49408
  v_cvt_pk_bf16_f32 v64, v64, v65
  v_mfma_f32_16x16x32_bf16 v[96:99], v[48:51], v[164:167], v[96:99]
  v_cvt_pk_bf16_f32 v65, v66, v67
  v_cvt_pk_bf16_f32 v66, v68, v69
  v_mfma_f32_16x16x32_bf16 v[104:107], v[48:51], v[196:199], v[104:107]
  s_add_u32 m0, s29, 3072
  s_add_u32 s27, s28, 2670592
  buffer_load_dwordx4 v15, s[60:63], s27 offen lds
  v_mfma_f32_16x16x32_bf16 v[112:115], v[48:51], v[228:231], v[112:115]
  s_waitcnt lgkmcnt(5)
  v_cvt_pk_bf16_f32 v67, v70, v71
  v_mfma_f32_16x16x32_bf16 v[92:95], v[52:55], v[132:135], v[92:95]
  ds_read_b128 v[44:47], v254 offset:51456
  v_accvgpr_write_b32 a80, v64
  v_mfma_f32_16x16x32_bf16 v[100:103], v[52:55], v[164:167], v[100:103]
  v_accvgpr_write_b32 a81, v65
  v_accvgpr_write_b32 a82, v66
  v_mfma_f32_16x16x32_bf16 v[108:111], v[52:55], v[196:199], v[108:111]
  v_accvgpr_write_b32 a83, v67
  v_mfma_f32_16x16x32_bf16 v[116:119], v[52:55], v[228:231], v[116:119]
  s_waitcnt lgkmcnt(5)
  v_mul_f32 v72, v12, v72
  v_mfma_f32_16x16x32_bf16 v[88:91], v[24:27], v[136:139], v[88:91]
  ds_read_b128 v[48:51], v255 offset:49408
  v_mul_f32 v73, v12, v73
  v_mfma_f32_16x16x32_bf16 v[96:99], v[24:27], v[168:171], v[96:99]
  v_mul_f32 v74, v12, v74
  v_mul_f32 v75, v12, v75
  v_mfma_f32_16x16x32_bf16 v[104:107], v[24:27], v[200:203], v[104:107]
  v_mul_f32 v76, v12, v76
  v_mfma_f32_16x16x32_bf16 v[112:115], v[24:27], v[232:235], v[112:115]
  s_waitcnt lgkmcnt(5)
  v_mul_f32 v77, v12, v77
  v_mfma_f32_16x16x32_bf16 v[92:95], v[28:31], v[136:139], v[92:95]
  ds_read_b128 v[52:55], v255 offset:51456
  v_mul_f32 v78, v12, v78
  v_mfma_f32_16x16x32_bf16 v[100:103], v[28:31], v[168:171], v[100:103]
  v_mul_f32 v79, v12, v79
  v_cvt_pk_bf16_f32 v72, v72, v73
  v_mfma_f32_16x16x32_bf16 v[108:111], v[28:31], v[200:203], v[108:111]
  v_cvt_pk_bf16_f32 v73, v74, v75
  v_mfma_f32_16x16x32_bf16 v[116:119], v[28:31], v[232:235], v[116:119]
  s_waitcnt lgkmcnt(5)
  v_cvt_pk_bf16_f32 v74, v76, v77
  v_mfma_f32_16x16x32_bf16 v[88:91], v[32:35], v[140:143], v[88:91]
  s_waitcnt vmcnt(8)
  s_barrier
  ds_read_b128 v[24:27], v16 offset:0
  v_cvt_pk_bf16_f32 v75, v78, v79
  v_mfma_f32_16x16x32_bf16 v[96:99], v[32:35], v[172:175], v[96:99]
  v_accvgpr_write_b32 a136, v72
  v_accvgpr_write_b32 a137, v73
  v_mfma_f32_16x16x32_bf16 v[104:107], v[32:35], v[204:207], v[104:107]
  v_accvgpr_write_b32 a138, v74
  v_mfma_f32_16x16x32_bf16 v[112:115], v[32:35], v[236:239], v[112:115]
  s_waitcnt lgkmcnt(5)
  v_accvgpr_write_b32 a139, v75
  v_mfma_f32_16x16x32_bf16 v[92:95], v[36:39], v[140:143], v[92:95]
  ds_read_b128 v[28:31], v16 offset:2048
  v_mul_f32 v80, v12, v80
  v_mfma_f32_16x16x32_bf16 v[100:103], v[36:39], v[172:175], v[100:103]
  v_mul_f32 v81, v12, v81
  v_mul_f32 v82, v12, v82
  v_mfma_f32_16x16x32_bf16 v[108:111], v[36:39], v[204:207], v[108:111]
  v_mul_f32 v83, v12, v83
  v_mfma_f32_16x16x32_bf16 v[116:119], v[36:39], v[236:239], v[116:119]
  s_waitcnt lgkmcnt(5)
  v_mul_f32 v84, v12, v84
  v_mfma_f32_16x16x32_bf16 v[88:91], v[40:43], v[144:147], v[88:91]
  ds_read_b128 v[32:35], v17 offset:0
  v_mul_f32 v85, v12, v85
  v_mfma_f32_16x16x32_bf16 v[96:99], v[40:43], v[176:179], v[96:99]
  v_mul_f32 v86, v12, v86
  v_mul_f32 v87, v12, v87
  v_mfma_f32_16x16x32_bf16 v[104:107], v[40:43], v[208:211], v[104:107]
  v_cvt_pk_bf16_f32 v80, v80, v81
  v_mfma_f32_16x16x32_bf16 v[112:115], v[40:43], v[240:243], v[112:115]
  s_waitcnt lgkmcnt(5)
  v_cvt_pk_bf16_f32 v81, v82, v83
  v_mfma_f32_16x16x32_bf16 v[92:95], v[44:47], v[144:147], v[92:95]
  ds_read_b128 v[36:39], v17 offset:2048
  v_cvt_pk_bf16_f32 v82, v84, v85
  v_mfma_f32_16x16x32_bf16 v[100:103], v[44:47], v[176:179], v[100:103]
  v_cvt_pk_bf16_f32 v83, v86, v87
  v_accvgpr_write_b32 a192, v80
  v_mfma_f32_16x16x32_bf16 v[108:111], v[44:47], v[208:211], v[108:111]
  v_accvgpr_write_b32 a193, v81
  v_mfma_f32_16x16x32_bf16 v[116:119], v[44:47], v[240:243], v[116:119]
  s_waitcnt lgkmcnt(5)
  v_accvgpr_write_b32 a194, v82
  v_mfma_f32_16x16x32_bf16 v[88:91], v[48:51], v[148:151], v[88:91]
  ds_read_b128 v[40:43], v18 offset:0
  v_accvgpr_write_b32 a195, v83
  v_mfma_f32_16x16x32_bf16 v[96:99], v[48:51], v[180:183], v[96:99]
  v_mfma_f32_16x16x32_bf16 v[104:107], v[48:51], v[212:215], v[104:107]
  v_mfma_f32_16x16x32_bf16 v[112:115], v[48:51], v[244:247], v[112:115]
  s_waitcnt lgkmcnt(5)
  v_mfma_f32_16x16x32_bf16 v[92:95], v[52:55], v[148:151], v[92:95]
  ds_read_b128 v[44:47], v18 offset:2048
  v_mfma_f32_16x16x32_bf16 v[100:103], v[52:55], v[180:183], v[100:103]
  v_mfma_f32_16x16x32_bf16 v[108:111], v[52:55], v[212:215], v[108:111]
  v_mfma_f32_16x16x32_bf16 v[116:119], v[52:55], v[244:247], v[116:119]
  s_waitcnt lgkmcnt(5)
  v_mfma_f32_16x16x32_bf16 v[56:59], v[24:27], v[120:123], 0
  ds_read_b128 v[48:51], v19 offset:0
  v_mfma_f32_16x16x32_bf16 v[64:67], v[24:27], v[152:155], 0
  v_mfma_f32_16x16x32_bf16 v[72:75], v[24:27], v[184:187], 0
  s_add_u32 m0, s29, 16384
  s_add_u32 s27, s28, 2883584
  buffer_load_dwordx4 v14, s[60:63], s27 offen lds
  v_mfma_f32_16x16x32_bf16 v[80:83], v[24:27], v[216:219], 0
  s_waitcnt lgkmcnt(5)
  v_mul_f32 v88, v12, v88
  v_mfma_f32_16x16x32_bf16 v[60:63], v[28:31], v[120:123], 0
  ds_read_b128 v[52:55], v19 offset:2048
  v_mul_f32 v89, v12, v89
  v_mfma_f32_16x16x32_bf16 v[68:71], v[28:31], v[152:155], 0
  v_mul_f32 v90, v12, v90
  v_mul_f32 v91, v12, v91
  v_mfma_f32_16x16x32_bf16 v[76:79], v[28:31], v[184:187], 0
  v_mul_f32 v92, v12, v92
  v_mfma_f32_16x16x32_bf16 v[84:87], v[28:31], v[216:219], 0
  s_waitcnt lgkmcnt(5)
  v_mul_f32 v93, v12, v93
  v_mfma_f32_16x16x32_bf16 v[56:59], v[32:35], v[124:127], v[56:59]
  ds_read_b128 v[24:27], v16 offset:256
  v_mul_f32 v94, v12, v94
  v_mfma_f32_16x16x32_bf16 v[64:67], v[32:35], v[156:159], v[64:67]
  v_mul_f32 v95, v12, v95
  v_cvt_pk_bf16_f32 v88, v88, v89
  v_mfma_f32_16x16x32_bf16 v[72:75], v[32:35], v[188:191], v[72:75]
  s_add_u32 m0, s29, 17408
  s_add_u32 s27, s28, 2899968
  buffer_load_dwordx4 v15, s[60:63], s27 offen lds
  v_mfma_f32_16x16x32_bf16 v[80:83], v[32:35], v[220:223], v[80:83]
  s_waitcnt lgkmcnt(5)
  v_cvt_pk_bf16_f32 v89, v90, v91
  v_mfma_f32_16x16x32_bf16 v[60:63], v[36:39], v[124:127], v[60:63]
  ds_read_b128 v[28:31], v16 offset:2304
  v_cvt_pk_bf16_f32 v90, v92, v93
  v_mfma_f32_16x16x32_bf16 v[68:71], v[36:39], v[156:159], v[68:71]
  v_cvt_pk_bf16_f32 v91, v94, v95
  v_accvgpr_write_b32 a28, v88
  v_mfma_f32_16x16x32_bf16 v[76:79], v[36:39], v[188:191], v[76:79]
  v_accvgpr_write_b32 a29, v89
  v_mfma_f32_16x16x32_bf16 v[84:87], v[36:39], v[220:223], v[84:87]
  s_waitcnt lgkmcnt(5)
  v_accvgpr_write_b32 a30, v90
  v_mfma_f32_16x16x32_bf16 v[56:59], v[40:43], v[128:131], v[56:59]
  ds_read_b128 v[32:35], v17 offset:256
  v_accvgpr_write_b32 a31, v91
  v_mfma_f32_16x16x32_bf16 v[64:67], v[40:43], v[160:163], v[64:67]
  v_mul_f32 v96, v12, v96
  v_mul_f32 v97, v12, v97
  v_mfma_f32_16x16x32_bf16 v[72:75], v[40:43], v[192:195], v[72:75]
  s_add_u32 m0, s29, 18432
  s_add_u32 s27, s28, 2916352
  buffer_load_dwordx4 v14, s[60:63], s27 offen lds
  v_mfma_f32_16x16x32_bf16 v[80:83], v[40:43], v[224:227], v[80:83]
  s_waitcnt lgkmcnt(5)
  v_mul_f32 v98, v12, v98
  v_mfma_f32_16x16x32_bf16 v[60:63], v[44:47], v[128:131], v[60:63]
  ds_read_b128 v[36:39], v17 offset:2304
  v_mul_f32 v99, v12, v99
  v_mfma_f32_16x16x32_bf16 v[68:71], v[44:47], v[160:163], v[68:71]
  v_mul_f32 v100, v12, v100
  v_mul_f32 v101, v12, v101
  v_mfma_f32_16x16x32_bf16 v[76:79], v[44:47], v[192:195], v[76:79]
  v_mul_f32 v102, v12, v102
  v_mfma_f32_16x16x32_bf16 v[84:87], v[44:47], v[224:227], v[84:87]
  s_waitcnt lgkmcnt(5)
  v_mul_f32 v103, v12, v103
  v_mfma_f32_16x16x32_bf16 v[56:59], v[48:51], v[132:135], v[56:59]
  ds_read_b128 v[40:43], v18 offset:256
  v_cvt_pk_bf16_f32 v96, v96, v97
  v_mfma_f32_16x16x32_bf16 v[64:67], v[48:51], v[164:167], v[64:67]
  v_cvt_pk_bf16_f32 v97, v98, v99
  v_cvt_pk_bf16_f32 v98, v100, v101
  v_mfma_f32_16x16x32_bf16 v[72:75], v[48:51], v[196:199], v[72:75]
  s_add_u32 m0, s29, 19456
  s_add_u32 s27, s28, 2932736
  buffer_load_dwordx4 v15, s[60:63], s27 offen lds
  v_mfma_f32_16x16x32_bf16 v[80:83], v[48:51], v[228:231], v[80:83]
  s_waitcnt lgkmcnt(5)
  v_cvt_pk_bf16_f32 v99, v102, v103
  v_mfma_f32_16x16x32_bf16 v[60:63], v[52:55], v[132:135], v[60:63]
  ds_read_b128 v[44:47], v18 offset:2304
  v_accvgpr_write_b32 a84, v96
  v_mfma_f32_16x16x32_bf16 v[68:71], v[52:55], v[164:167], v[68:71]
  v_accvgpr_write_b32 a85, v97
  v_accvgpr_write_b32 a86, v98
  v_mfma_f32_16x16x32_bf16 v[76:79], v[52:55], v[196:199], v[76:79]
  v_accvgpr_write_b32 a87, v99
  v_mfma_f32_16x16x32_bf16 v[84:87], v[52:55], v[228:231], v[84:87]
  s_waitcnt lgkmcnt(5)
  v_mul_f32 v104, v12, v104
  v_mfma_f32_16x16x32_bf16 v[56:59], v[24:27], v[136:139], v[56:59]
  ds_read_b128 v[48:51], v19 offset:256
  v_mul_f32 v105, v12, v105
  v_mfma_f32_16x16x32_bf16 v[64:67], v[24:27], v[168:171], v[64:67]
  v_mul_f32 v106, v12, v106
  v_mul_f32 v107, v12, v107
  v_mfma_f32_16x16x32_bf16 v[72:75], v[24:27], v[200:203], v[72:75]
  v_mul_f32 v108, v12, v108
  v_mfma_f32_16x16x32_bf16 v[80:83], v[24:27], v[232:235], v[80:83]
  s_waitcnt lgkmcnt(5)
  v_mul_f32 v109, v12, v109
  v_mfma_f32_16x16x32_bf16 v[60:63], v[28:31], v[136:139], v[60:63]
  ds_read_b128 v[52:55], v19 offset:2304
  v_mul_f32 v110, v12, v110
  v_mfma_f32_16x16x32_bf16 v[68:71], v[28:31], v[168:171], v[68:71]
  v_mul_f32 v111, v12, v111
  v_cvt_pk_bf16_f32 v104, v104, v105
  v_mfma_f32_16x16x32_bf16 v[76:79], v[28:31], v[200:203], v[76:79]
  v_cvt_pk_bf16_f32 v105, v106, v107
  v_mfma_f32_16x16x32_bf16 v[84:87], v[28:31], v[232:235], v[84:87]
  s_waitcnt lgkmcnt(5)
  v_cvt_pk_bf16_f32 v106, v108, v109
  v_mfma_f32_16x16x32_bf16 v[56:59], v[32:35], v[140:143], v[56:59]
  s_waitcnt vmcnt(8)
  s_barrier
  ds_read_b128 v[24:27], v16 offset:16384
  v_cvt_pk_bf16_f32 v107, v110, v111
  v_mfma_f32_16x16x32_bf16 v[64:67], v[32:35], v[172:175], v[64:67]
  v_accvgpr_write_b32 a140, v104
  v_accvgpr_write_b32 a141, v105
  v_mfma_f32_16x16x32_bf16 v[72:75], v[32:35], v[204:207], v[72:75]
  v_accvgpr_write_b32 a142, v106
  v_mfma_f32_16x16x32_bf16 v[80:83], v[32:35], v[236:239], v[80:83]
  s_waitcnt lgkmcnt(5)
  v_accvgpr_write_b32 a143, v107
  v_mfma_f32_16x16x32_bf16 v[60:63], v[36:39], v[140:143], v[60:63]
  ds_read_b128 v[28:31], v16 offset:18432
  v_mul_f32 v112, v12, v112
  v_mfma_f32_16x16x32_bf16 v[68:71], v[36:39], v[172:175], v[68:71]
  v_mul_f32 v113, v12, v113
  v_mul_f32 v114, v12, v114
  v_mfma_f32_16x16x32_bf16 v[76:79], v[36:39], v[204:207], v[76:79]
  v_mul_f32 v115, v12, v115
  v_mfma_f32_16x16x32_bf16 v[84:87], v[36:39], v[236:239], v[84:87]
  s_waitcnt lgkmcnt(5)
  v_mul_f32 v116, v12, v116
  v_mfma_f32_16x16x32_bf16 v[56:59], v[40:43], v[144:147], v[56:59]
  ds_read_b128 v[32:35], v17 offset:16384
  v_mul_f32 v117, v12, v117
  v_mfma_f32_16x16x32_bf16 v[64:67], v[40:43], v[176:179], v[64:67]
  v_mul_f32 v118, v12, v118
  v_mul_f32 v119, v12, v119
  v_mfma_f32_16x16x32_bf16 v[72:75], v[40:43], v[208:211], v[72:75]
  v_cvt_pk_bf16_f32 v112, v112, v113
  v_mfma_f32_16x16x32_bf16 v[80:83], v[40:43], v[240:243], v[80:83]
  s_waitcnt lgkmcnt(5)
  v_cvt_pk_bf16_f32 v113, v114, v115
  v_mfma_f32_16x16x32_bf16 v[60:63], v[44:47], v[144:147], v[60:63]
  ds_read_b128 v[36:39], v17 offset:18432
  v_cvt_pk_bf16_f32 v114, v116, v117
  v_mfma_f32_16x16x32_bf16 v[68:71], v[44:47], v[176:179], v[68:71]
  v_cvt_pk_bf16_f32 v115, v118, v119
  v_accvgpr_write_b32 a196, v112
  v_mfma_f32_16x16x32_bf16 v[76:79], v[44:47], v[208:211], v[76:79]
  v_accvgpr_write_b32 a197, v113
  v_mfma_f32_16x16x32_bf16 v[84:87], v[44:47], v[240:243], v[84:87]
  s_waitcnt lgkmcnt(5)
  v_accvgpr_write_b32 a198, v114
  v_mfma_f32_16x16x32_bf16 v[56:59], v[48:51], v[148:151], v[56:59]
  ds_read_b128 v[40:43], v18 offset:16384
  v_accvgpr_write_b32 a199, v115
  v_mfma_f32_16x16x32_bf16 v[64:67], v[48:51], v[180:183], v[64:67]
  v_mfma_f32_16x16x32_bf16 v[72:75], v[48:51], v[212:215], v[72:75]
  v_mfma_f32_16x16x32_bf16 v[80:83], v[48:51], v[244:247], v[80:83]
  s_waitcnt lgkmcnt(5)
  v_mfma_f32_16x16x32_bf16 v[60:63], v[52:55], v[148:151], v[60:63]
  ds_read_b128 v[44:47], v18 offset:18432
  v_mfma_f32_16x16x32_bf16 v[68:71], v[52:55], v[180:183], v[68:71]
  v_mfma_f32_16x16x32_bf16 v[76:79], v[52:55], v[212:215], v[76:79]
  v_mfma_f32_16x16x32_bf16 v[84:87], v[52:55], v[244:247], v[84:87]
  s_waitcnt lgkmcnt(5)
  s_getpc_b64 s[98:99]
  s_add_u32 s98, s98, 4096
  s_addc_u32 s99, s99, 0
  global_load_dword v7, v6, s[98:99]
  v_mfma_f32_16x16x32_bf16 v[88:91], v[24:27], v[120:123], 0
  ds_read_b128 v[48:51], v19 offset:16384
  v_mfma_f32_16x16x32_bf16 v[96:99], v[24:27], v[152:155], 0
  v_mfma_f32_16x16x32_bf16 v[104:107], v[24:27], v[184:187], 0
  s_add_u32 m0, s29, 32768
  s_add_u32 s27, s28, 3145728
  buffer_load_dwordx4 v14, s[60:63], s27 offen lds
  v_mfma_f32_16x16x32_bf16 v[112:115], v[24:27], v[216:219], 0
  s_waitcnt lgkmcnt(5)
  v_mul_f32 v56, v12, v56
  v_mfma_f32_16x16x32_bf16 v[92:95], v[28:31], v[120:123], 0
  ds_read_b128 v[52:55], v19 offset:18432
  v_mul_f32 v57, v12, v57
  v_mfma_f32_16x16x32_bf16 v[100:103], v[28:31], v[152:155], 0
  v_mul_f32 v58, v12, v58
  v_mul_f32 v59, v12, v59
  v_mfma_f32_16x16x32_bf16 v[108:111], v[28:31], v[184:187], 0
  v_mul_f32 v60, v12, v60
  v_mfma_f32_16x16x32_bf16 v[116:119], v[28:31], v[216:219], 0
  s_waitcnt lgkmcnt(5)
  v_mul_f32 v61, v12, v61
  v_mfma_f32_16x16x32_bf16 v[88:91], v[32:35], v[124:127], v[88:91]
  ds_read_b128 v[24:27], v16 offset:16640
  v_mul_f32 v62, v12, v62
  v_mfma_f32_16x16x32_bf16 v[96:99], v[32:35], v[156:159], v[96:99]
  v_mul_f32 v63, v12, v63
  v_cvt_pk_bf16_f32 v56, v56, v57
  v_mfma_f32_16x16x32_bf16 v[104:107], v[32:35], v[188:191], v[104:107]
  s_add_u32 m0, s29, 33792
  s_add_u32 s27, s28, 3162112
  buffer_load_dwordx4 v15, s[60:63], s27 offen lds
  v_mfma_f32_16x16x32_bf16 v[112:115], v[32:35], v[220:223], v[112:115]
  s_waitcnt lgkmcnt(5)
  v_cvt_pk_bf16_f32 v57, v58, v59
  v_mfma_f32_16x16x32_bf16 v[92:95], v[36:39], v[124:127], v[92:95]
  ds_read_b128 v[28:31], v16 offset:18688
  v_cvt_pk_bf16_f32 v58, v60, v61
  v_mfma_f32_16x16x32_bf16 v[100:103], v[36:39], v[156:159], v[100:103]
  v_cvt_pk_bf16_f32 v59, v62, v63
  v_accvgpr_write_b32 a32, v56
  v_mfma_f32_16x16x32_bf16 v[108:111], v[36:39], v[188:191], v[108:111]
  v_accvgpr_write_b32 a33, v57
  v_mfma_f32_16x16x32_bf16 v[116:119], v[36:39], v[220:223], v[116:119]
  s_waitcnt lgkmcnt(5)
  v_accvgpr_write_b32 a34, v58
  v_mfma_f32_16x16x32_bf16 v[88:91], v[40:43], v[128:131], v[88:91]
  ds_read_b128 v[32:35], v17 offset:16640
  v_accvgpr_write_b32 a35, v59
  v_mfma_f32_16x16x32_bf16 v[96:99], v[40:43], v[160:163], v[96:99]
  v_mul_f32 v64, v12, v64
  v_mul_f32 v65, v12, v65
  v_mfma_f32_16x16x32_bf16 v[104:107], v[40:43], v[192:195], v[104:107]
  s_add_u32 m0, s29, 34816
  s_add_u32 s27, s28, 3178496
  buffer_load_dwordx4 v14, s[60:63], s27 offen lds
  v_mfma_f32_16x16x32_bf16 v[112:115], v[40:43], v[224:227], v[112:115]
  s_waitcnt lgkmcnt(5)
  v_mul_f32 v66, v12, v66
  v_mfma_f32_16x16x32_bf16 v[92:95], v[44:47], v[128:131], v[92:95]
  ds_read_b128 v[36:39], v17 offset:18688
  v_mul_f32 v67, v12, v67
  v_mfma_f32_16x16x32_bf16 v[100:103], v[44:47], v[160:163], v[100:103]
  v_mul_f32 v68, v12, v68
  v_mul_f32 v69, v12, v69
  v_mfma_f32_16x16x32_bf16 v[108:111], v[44:47], v[192:195], v[108:111]
  v_mul_f32 v70, v12, v70
  v_mfma_f32_16x16x32_bf16 v[116:119], v[44:47], v[224:227], v[116:119]
  s_waitcnt lgkmcnt(5)
  v_mul_f32 v71, v12, v71
  v_mfma_f32_16x16x32_bf16 v[88:91], v[48:51], v[132:135], v[88:91]
  ds_read_b128 v[40:43], v18 offset:16640
  v_cvt_pk_bf16_f32 v64, v64, v65
  v_mfma_f32_16x16x32_bf16 v[96:99], v[48:51], v[164:167], v[96:99]
  v_cvt_pk_bf16_f32 v65, v66, v67
  v_cvt_pk_bf16_f32 v66, v68, v69
  v_mfma_f32_16x16x32_bf16 v[104:107], v[48:51], v[196:199], v[104:107]
  s_add_u32 m0, s29, 35840
  s_add_u32 s27, s28, 3194880
  buffer_load_dwordx4 v15, s[60:63], s27 offen lds
  v_mfma_f32_16x16x32_bf16 v[112:115], v[48:51], v[228:231], v[112:115]
  s_waitcnt lgkmcnt(5)
  v_cvt_pk_bf16_f32 v67, v70, v71
  v_mfma_f32_16x16x32_bf16 v[92:95], v[52:55], v[132:135], v[92:95]
  ds_read_b128 v[44:47], v18 offset:18688
  v_accvgpr_write_b32 a88, v64
  v_mfma_f32_16x16x32_bf16 v[100:103], v[52:55], v[164:167], v[100:103]
  v_accvgpr_write_b32 a89, v65
  v_accvgpr_write_b32 a90, v66
  v_mfma_f32_16x16x32_bf16 v[108:111], v[52:55], v[196:199], v[108:111]
  v_accvgpr_write_b32 a91, v67
  v_mfma_f32_16x16x32_bf16 v[116:119], v[52:55], v[228:231], v[116:119]
  s_waitcnt lgkmcnt(5)
  v_mul_f32 v72, v12, v72
  v_mfma_f32_16x16x32_bf16 v[88:91], v[24:27], v[136:139], v[88:91]
  ds_read_b128 v[48:51], v19 offset:16640
  v_mul_f32 v73, v12, v73
  v_mfma_f32_16x16x32_bf16 v[96:99], v[24:27], v[168:171], v[96:99]
  v_mul_f32 v74, v12, v74
  v_mul_f32 v75, v12, v75
  v_mfma_f32_16x16x32_bf16 v[104:107], v[24:27], v[200:203], v[104:107]
  v_mul_f32 v76, v12, v76
  v_mfma_f32_16x16x32_bf16 v[112:115], v[24:27], v[232:235], v[112:115]
  s_waitcnt lgkmcnt(5)
  v_mul_f32 v77, v12, v77
  v_mfma_f32_16x16x32_bf16 v[92:95], v[28:31], v[136:139], v[92:95]
  ds_read_b128 v[52:55], v19 offset:18688
  v_mul_f32 v78, v12, v78
  v_mfma_f32_16x16x32_bf16 v[100:103], v[28:31], v[168:171], v[100:103]
  v_mul_f32 v79, v12, v79
  v_cvt_pk_bf16_f32 v72, v72, v73
  v_mfma_f32_16x16x32_bf16 v[108:111], v[28:31], v[200:203], v[108:111]
  v_cvt_pk_bf16_f32 v73, v74, v75
  v_mfma_f32_16x16x32_bf16 v[116:119], v[28:31], v[232:235], v[116:119]
  s_waitcnt lgkmcnt(5)
  v_cvt_pk_bf16_f32 v74, v76, v77
  v_mfma_f32_16x16x32_bf16 v[88:91], v[32:35], v[140:143], v[88:91]
  s_waitcnt vmcnt(8)
  s_barrier
  ds_read_b128 v[24:27], v248 offset:0
  v_cvt_pk_bf16_f32 v75, v78, v79
  v_mfma_f32_16x16x32_bf16 v[96:99], v[32:35], v[172:175], v[96:99]
  v_accvgpr_write_b32 a144, v72
  v_accvgpr_write_b32 a145, v73
  v_mfma_f32_16x16x32_bf16 v[104:107], v[32:35], v[204:207], v[104:107]
  v_accvgpr_write_b32 a146, v74
  v_mfma_f32_16x16x32_bf16 v[112:115], v[32:35], v[236:239], v[112:115]
  s_waitcnt lgkmcnt(5)
  v_accvgpr_write_b32 a147, v75
  v_mfma_f32_16x16x32_bf16 v[92:95], v[36:39], v[140:143], v[92:95]
  ds_read_b128 v[28:31], v248 offset:2048
  v_mul_f32 v80, v12, v80
  v_mfma_f32_16x16x32_bf16 v[100:103], v[36:39], v[172:175], v[100:103]
  v_mul_f32 v81, v12, v81
  v_mul_f32 v82, v12, v82
  v_mfma_f32_16x16x32_bf16 v[108:111], v[36:39], v[204:207], v[108:111]
  v_mul_f32 v83, v12, v83
  v_mfma_f32_16x16x32_bf16 v[116:119], v[36:39], v[236:239], v[116:119]
  s_waitcnt lgkmcnt(5)
  v_mul_f32 v84, v12, v84
  v_mfma_f32_16x16x32_bf16 v[88:91], v[40:43], v[144:147], v[88:91]
  ds_read_b128 v[32:35], v249 offset:0
  v_mul_f32 v85, v12, v85
  v_mfma_f32_16x16x32_bf16 v[96:99], v[40:43], v[176:179], v[96:99]
  v_mul_f32 v86, v12, v86
  v_mul_f32 v87, v12, v87
  v_mfma_f32_16x16x32_bf16 v[104:107], v[40:43], v[208:211], v[104:107]
  v_cvt_pk_bf16_f32 v80, v80, v81
  v_mfma_f32_16x16x32_bf16 v[112:115], v[40:43], v[240:243], v[112:115]
  s_waitcnt lgkmcnt(5)
  v_cvt_pk_bf16_f32 v81, v82, v83
  v_mfma_f32_16x16x32_bf16 v[92:95], v[44:47], v[144:147], v[92:95]
  ds_read_b128 v[36:39], v249 offset:2048
  v_cvt_pk_bf16_f32 v82, v84, v85
  v_mfma_f32_16x16x32_bf16 v[100:103], v[44:47], v[176:179], v[100:103]
  v_cvt_pk_bf16_f32 v83, v86, v87
  v_accvgpr_write_b32 a200, v80
  v_mfma_f32_16x16x32_bf16 v[108:111], v[44:47], v[208:211], v[108:111]
  v_accvgpr_write_b32 a201, v81
  v_mfma_f32_16x16x32_bf16 v[116:119], v[44:47], v[240:243], v[116:119]
  s_waitcnt lgkmcnt(5)
  v_accvgpr_write_b32 a202, v82
  v_mfma_f32_16x16x32_bf16 v[88:91], v[48:51], v[148:151], v[88:91]
  ds_read_b128 v[40:43], v250 offset:0
  v_accvgpr_write_b32 a203, v83
  v_mfma_f32_16x16x32_bf16 v[96:99], v[48:51], v[180:183], v[96:99]
  v_mfma_f32_16x16x32_bf16 v[104:107], v[48:51], v[212:215], v[104:107]
  v_mfma_f32_16x16x32_bf16 v[112:115], v[48:51], v[244:247], v[112:115]
  s_waitcnt lgkmcnt(5)
  v_mfma_f32_16x16x32_bf16 v[92:95], v[52:55], v[148:151], v[92:95]
  ds_read_b128 v[44:47], v250 offset:2048
  v_mfma_f32_16x16x32_bf16 v[100:103], v[52:55], v[180:183], v[100:103]
  v_mfma_f32_16x16x32_bf16 v[108:111], v[52:55], v[212:215], v[108:111]
  v_mfma_f32_16x16x32_bf16 v[116:119], v[52:55], v[244:247], v[116:119]
  s_waitcnt lgkmcnt(5)
  v_mfma_f32_16x16x32_bf16 v[56:59], v[24:27], v[120:123], 0
  ds_read_b128 v[48:51], v251 offset:0
  v_mfma_f32_16x16x32_bf16 v[64:67], v[24:27], v[152:155], 0
  v_mfma_f32_16x16x32_bf16 v[72:75], v[24:27], v[184:187], 0
  s_add_u32 m0, s29, 49152
  s_add_u32 s27, s28, 3407872
  buffer_load_dwordx4 v14, s[60:63], s27 offen lds
  v_mfma_f32_16x16x32_bf16 v[80:83], v[24:27], v[216:219], 0
  s_waitcnt lgkmcnt(5)
  v_mul_f32 v88, v12, v88
  v_mfma_f32_16x16x32_bf16 v[60:63], v[28:31], v[120:123], 0
  ds_read_b128 v[52:55], v251 offset:2048
  v_mul_f32 v89, v12, v89
  v_mfma_f32_16x16x32_bf16 v[68:71], v[28:31], v[152:155], 0
  v_mul_f32 v90, v12, v90
  v_mul_f32 v91, v12, v91
  v_mfma_f32_16x16x32_bf16 v[76:79], v[28:31], v[184:187], 0
  v_mul_f32 v92, v12, v92
  v_mfma_f32_16x16x32_bf16 v[84:87], v[28:31], v[216:219], 0
  s_waitcnt lgkmcnt(5)
  v_mul_f32 v93, v12, v93
  v_mfma_f32_16x16x32_bf16 v[56:59], v[32:35], v[124:127], v[56:59]
  ds_read_b128 v[24:27], v248 offset:256
  v_mul_f32 v94, v12, v94
  v_mfma_f32_16x16x32_bf16 v[64:67], v[32:35], v[156:159], v[64:67]
  v_mul_f32 v95, v12, v95
  v_cvt_pk_bf16_f32 v88, v88, v89
  v_mfma_f32_16x16x32_bf16 v[72:75], v[32:35], v[188:191], v[72:75]
  s_add_u32 m0, s29, 50176
  s_add_u32 s27, s28, 3424256
  buffer_load_dwordx4 v15, s[60:63], s27 offen lds
  v_mfma_f32_16x16x32_bf16 v[80:83], v[32:35], v[220:223], v[80:83]
  s_waitcnt lgkmcnt(5)
  v_cvt_pk_bf16_f32 v89, v90, v91
  v_mfma_f32_16x16x32_bf16 v[60:63], v[36:39], v[124:127], v[60:63]
  ds_read_b128 v[28:31], v248 offset:2304
  v_cvt_pk_bf16_f32 v90, v92, v93
  v_mfma_f32_16x16x32_bf16 v[68:71], v[36:39], v[156:159], v[68:71]
  v_cvt_pk_bf16_f32 v91, v94, v95
  v_accvgpr_write_b32 a36, v88
  v_mfma_f32_16x16x32_bf16 v[76:79], v[36:39], v[188:191], v[76:79]
  v_accvgpr_write_b32 a37, v89
  v_mfma_f32_16x16x32_bf16 v[84:87], v[36:39], v[220:223], v[84:87]
  s_waitcnt lgkmcnt(5)
  v_accvgpr_write_b32 a38, v90
  v_mfma_f32_16x16x32_bf16 v[56:59], v[40:43], v[128:131], v[56:59]
  ds_read_b128 v[32:35], v249 offset:256
  v_accvgpr_write_b32 a39, v91
  v_mfma_f32_16x16x32_bf16 v[64:67], v[40:43], v[160:163], v[64:67]
  v_mul_f32 v96, v12, v96
  v_mul_f32 v97, v12, v97
  v_mfma_f32_16x16x32_bf16 v[72:75], v[40:43], v[192:195], v[72:75]
  s_add_u32 m0, s29, 51200
  s_add_u32 s27, s28, 3440640
  buffer_load_dwordx4 v14, s[60:63], s27 offen lds
  v_mfma_f32_16x16x32_bf16 v[80:83], v[40:43], v[224:227], v[80:83]
  s_waitcnt lgkmcnt(5)
  v_mul_f32 v98, v12, v98
  v_mfma_f32_16x16x32_bf16 v[60:63], v[44:47], v[128:131], v[60:63]
  ds_read_b128 v[36:39], v249 offset:2304
  v_mul_f32 v99, v12, v99
  v_mfma_f32_16x16x32_bf16 v[68:71], v[44:47], v[160:163], v[68:71]
  v_mul_f32 v100, v12, v100
  v_mul_f32 v101, v12, v101
  v_mfma_f32_16x16x32_bf16 v[76:79], v[44:47], v[192:195], v[76:79]
  v_mul_f32 v102, v12, v102
  v_mfma_f32_16x16x32_bf16 v[84:87], v[44:47], v[224:227], v[84:87]
  s_waitcnt lgkmcnt(5)
  v_mul_f32 v103, v12, v103
  v_mfma_f32_16x16x32_bf16 v[56:59], v[48:51], v[132:135], v[56:59]
  ds_read_b128 v[40:43], v250 offset:256
  v_cvt_pk_bf16_f32 v96, v96, v97
  v_mfma_f32_16x16x32_bf16 v[64:67], v[48:51], v[164:167], v[64:67]
  v_cvt_pk_bf16_f32 v97, v98, v99
  v_cvt_pk_bf16_f32 v98, v100, v101
  v_mfma_f32_16x16x32_bf16 v[72:75], v[48:51], v[196:199], v[72:75]
  s_add_u32 m0, s29, 52224
  s_add_u32 s27, s28, 3457024
  buffer_load_dwordx4 v15, s[60:63], s27 offen lds
  v_mfma_f32_16x16x32_bf16 v[80:83], v[48:51], v[228:231], v[80:83]
  s_waitcnt lgkmcnt(5)
  v_cvt_pk_bf16_f32 v99, v102, v103
  v_mfma_f32_16x16x32_bf16 v[60:63], v[52:55], v[132:135], v[60:63]
  ds_read_b128 v[44:47], v250 offset:2304
  v_accvgpr_write_b32 a92, v96
  v_mfma_f32_16x16x32_bf16 v[68:71], v[52:55], v[164:167], v[68:71]
  v_accvgpr_write_b32 a93, v97
  v_accvgpr_write_b32 a94, v98
  v_mfma_f32_16x16x32_bf16 v[76:79], v[52:55], v[196:199], v[76:79]
  v_accvgpr_write_b32 a95, v99
  v_mfma_f32_16x16x32_bf16 v[84:87], v[52:55], v[228:231], v[84:87]
  s_waitcnt lgkmcnt(5)
  v_mul_f32 v104, v12, v104
  v_mfma_f32_16x16x32_bf16 v[56:59], v[24:27], v[136:139], v[56:59]
  ds_read_b128 v[48:51], v251 offset:256
  v_mul_f32 v105, v12, v105
  v_mfma_f32_16x16x32_bf16 v[64:67], v[24:27], v[168:171], v[64:67]
  v_mul_f32 v106, v12, v106
  v_mul_f32 v107, v12, v107
  v_mfma_f32_16x16x32_bf16 v[72:75], v[24:27], v[200:203], v[72:75]
  v_mul_f32 v108, v12, v108
  v_mfma_f32_16x16x32_bf16 v[80:83], v[24:27], v[232:235], v[80:83]
  s_waitcnt lgkmcnt(5)
  v_mul_f32 v109, v12, v109
  v_mfma_f32_16x16x32_bf16 v[60:63], v[28:31], v[136:139], v[60:63]
  ds_read_b128 v[52:55], v251 offset:2304
  v_mul_f32 v110, v12, v110
  v_mfma_f32_16x16x32_bf16 v[68:71], v[28:31], v[168:171], v[68:71]
  v_mul_f32 v111, v12, v111
  v_cvt_pk_bf16_f32 v104, v104, v105
  v_mfma_f32_16x16x32_bf16 v[76:79], v[28:31], v[200:203], v[76:79]
  v_cvt_pk_bf16_f32 v105, v106, v107
  v_mfma_f32_16x16x32_bf16 v[84:87], v[28:31], v[232:235], v[84:87]
  s_waitcnt lgkmcnt(5)
  v_cvt_pk_bf16_f32 v106, v108, v109
  v_mfma_f32_16x16x32_bf16 v[56:59], v[32:35], v[140:143], v[56:59]
  s_waitcnt vmcnt(8)
  s_barrier
  ds_read_b128 v[24:27], v248 offset:16384
  v_cvt_pk_bf16_f32 v107, v110, v111
  v_mfma_f32_16x16x32_bf16 v[64:67], v[32:35], v[172:175], v[64:67]
  v_accvgpr_write_b32 a148, v104
  v_accvgpr_write_b32 a149, v105
  v_mfma_f32_16x16x32_bf16 v[72:75], v[32:35], v[204:207], v[72:75]
  v_accvgpr_write_b32 a150, v106
  v_mfma_f32_16x16x32_bf16 v[80:83], v[32:35], v[236:239], v[80:83]
  s_waitcnt lgkmcnt(5)
  v_accvgpr_write_b32 a151, v107
  v_mfma_f32_16x16x32_bf16 v[60:63], v[36:39], v[140:143], v[60:63]
  ds_read_b128 v[28:31], v248 offset:18432
  v_mul_f32 v112, v12, v112
  v_mfma_f32_16x16x32_bf16 v[68:71], v[36:39], v[172:175], v[68:71]
  v_mul_f32 v113, v12, v113
  v_mul_f32 v114, v12, v114
  v_mfma_f32_16x16x32_bf16 v[76:79], v[36:39], v[204:207], v[76:79]
  v_mul_f32 v115, v12, v115
  v_mfma_f32_16x16x32_bf16 v[84:87], v[36:39], v[236:239], v[84:87]
  s_waitcnt lgkmcnt(5)
  v_mul_f32 v116, v12, v116
  v_mfma_f32_16x16x32_bf16 v[56:59], v[40:43], v[144:147], v[56:59]
  ds_read_b128 v[32:35], v249 offset:16384
  v_mul_f32 v117, v12, v117
  v_mfma_f32_16x16x32_bf16 v[64:67], v[40:43], v[176:179], v[64:67]
  v_mul_f32 v118, v12, v118
  v_mul_f32 v119, v12, v119
  v_mfma_f32_16x16x32_bf16 v[72:75], v[40:43], v[208:211], v[72:75]
  v_cvt_pk_bf16_f32 v112, v112, v113
  v_mfma_f32_16x16x32_bf16 v[80:83], v[40:43], v[240:243], v[80:83]
  s_waitcnt lgkmcnt(5)
  v_cvt_pk_bf16_f32 v113, v114, v115
  v_mfma_f32_16x16x32_bf16 v[60:63], v[44:47], v[144:147], v[60:63]
  ds_read_b128 v[36:39], v249 offset:18432
  v_cvt_pk_bf16_f32 v114, v116, v117
  v_mfma_f32_16x16x32_bf16 v[68:71], v[44:47], v[176:179], v[68:71]
  v_cvt_pk_bf16_f32 v115, v118, v119
  v_accvgpr_write_b32 a204, v112
  v_mfma_f32_16x16x32_bf16 v[76:79], v[44:47], v[208:211], v[76:79]
  v_accvgpr_write_b32 a205, v113
  v_mfma_f32_16x16x32_bf16 v[84:87], v[44:47], v[240:243], v[84:87]
  s_waitcnt lgkmcnt(5)
  v_accvgpr_write_b32 a206, v114
  v_mfma_f32_16x16x32_bf16 v[56:59], v[48:51], v[148:151], v[56:59]
  ds_read_b128 v[40:43], v250 offset:16384
  v_accvgpr_write_b32 a207, v115
  v_mfma_f32_16x16x32_bf16 v[64:67], v[48:51], v[180:183], v[64:67]
  v_mfma_f32_16x16x32_bf16 v[72:75], v[48:51], v[212:215], v[72:75]
  v_mfma_f32_16x16x32_bf16 v[80:83], v[48:51], v[244:247], v[80:83]
  s_waitcnt lgkmcnt(5)
  v_mfma_f32_16x16x32_bf16 v[60:63], v[52:55], v[148:151], v[60:63]
  ds_read_b128 v[44:47], v250 offset:18432
  v_mfma_f32_16x16x32_bf16 v[68:71], v[52:55], v[180:183], v[68:71]
  v_mfma_f32_16x16x32_bf16 v[76:79], v[52:55], v[212:215], v[76:79]
  v_mfma_f32_16x16x32_bf16 v[84:87], v[52:55], v[244:247], v[84:87]
  s_waitcnt lgkmcnt(5)
  v_mfma_f32_16x16x32_bf16 v[88:91], v[24:27], v[120:123], 0
  ds_read_b128 v[48:51], v251 offset:16384
  v_mfma_f32_16x16x32_bf16 v[96:99], v[24:27], v[152:155], 0
  v_mfma_f32_16x16x32_bf16 v[104:107], v[24:27], v[184:187], 0
  buffer_load_dword v13, off, s[12:15], 0 offset:132 sc1
  v_mfma_f32_16x16x32_bf16 v[112:115], v[24:27], v[216:219], 0
  s_waitcnt lgkmcnt(5)
  v_mul_f32 v56, v12, v56
  v_mfma_f32_16x16x32_bf16 v[92:95], v[28:31], v[120:123], 0
  ds_read_b128 v[52:55], v251 offset:18432
  v_mul_f32 v57, v12, v57
  v_mfma_f32_16x16x32_bf16 v[100:103], v[28:31], v[152:155], 0
  v_mul_f32 v58, v12, v58
  v_mul_f32 v59, v12, v59
  v_mfma_f32_16x16x32_bf16 v[108:111], v[28:31], v[184:187], 0
  v_mul_f32 v60, v12, v60
  v_mfma_f32_16x16x32_bf16 v[116:119], v[28:31], v[216:219], 0
  s_waitcnt lgkmcnt(5)
  v_mul_f32 v61, v12, v61
  v_mfma_f32_16x16x32_bf16 v[88:91], v[32:35], v[124:127], v[88:91]
  ds_read_b128 v[24:27], v248 offset:16640
  v_mul_f32 v62, v12, v62
  v_mfma_f32_16x16x32_bf16 v[96:99], v[32:35], v[156:159], v[96:99]
  v_mul_f32 v63, v12, v63
  v_cvt_pk_bf16_f32 v56, v56, v57
  v_mfma_f32_16x16x32_bf16 v[104:107], v[32:35], v[188:191], v[104:107]
  v_cvt_pk_bf16_f32 v57, v58, v59
  v_mfma_f32_16x16x32_bf16 v[112:115], v[32:35], v[220:223], v[112:115]
  s_waitcnt lgkmcnt(5)
  v_cvt_pk_bf16_f32 v58, v60, v61
  v_mfma_f32_16x16x32_bf16 v[92:95], v[36:39], v[124:127], v[92:95]
  ds_read_b128 v[28:31], v248 offset:18688
  v_cvt_pk_bf16_f32 v59, v62, v63
  v_mfma_f32_16x16x32_bf16 v[100:103], v[36:39], v[156:159], v[100:103]
  v_accvgpr_write_b32 a40, v56
  v_accvgpr_write_b32 a41, v57
  v_mfma_f32_16x16x32_bf16 v[108:111], v[36:39], v[188:191], v[108:111]
  v_accvgpr_write_b32 a42, v58
  v_mfma_f32_16x16x32_bf16 v[116:119], v[36:39], v[220:223], v[116:119]
  s_waitcnt lgkmcnt(5)
  v_accvgpr_write_b32 a43, v59
  v_mfma_f32_16x16x32_bf16 v[88:91], v[40:43], v[128:131], v[88:91]
  ds_read_b128 v[32:35], v249 offset:16640
  v_mul_f32 v64, v12, v64
  v_mfma_f32_16x16x32_bf16 v[96:99], v[40:43], v[160:163], v[96:99]
  v_mul_f32 v65, v12, v65
  v_mul_f32 v66, v12, v66
  v_mfma_f32_16x16x32_bf16 v[104:107], v[40:43], v[192:195], v[104:107]
  v_mul_f32 v67, v12, v67
  v_mfma_f32_16x16x32_bf16 v[112:115], v[40:43], v[224:227], v[112:115]
  s_waitcnt lgkmcnt(5)
  v_mul_f32 v68, v12, v68
  v_mfma_f32_16x16x32_bf16 v[92:95], v[44:47], v[128:131], v[92:95]
  ds_read_b128 v[36:39], v249 offset:18688
  v_mul_f32 v69, v12, v69
  v_mfma_f32_16x16x32_bf16 v[100:103], v[44:47], v[160:163], v[100:103]
  v_mul_f32 v70, v12, v70
  v_mul_f32 v71, v12, v71
  v_mfma_f32_16x16x32_bf16 v[108:111], v[44:47], v[192:195], v[108:111]
  v_cvt_pk_bf16_f32 v64, v64, v65
  v_mfma_f32_16x16x32_bf16 v[116:119], v[44:47], v[224:227], v[116:119]
  s_waitcnt lgkmcnt(5)
  v_cvt_pk_bf16_f32 v65, v66, v67
  v_mfma_f32_16x16x32_bf16 v[88:91], v[48:51], v[132:135], v[88:91]
  ds_read_b128 v[40:43], v250 offset:16640
  v_cvt_pk_bf16_f32 v66, v68, v69
  v_mfma_f32_16x16x32_bf16 v[96:99], v[48:51], v[164:167], v[96:99]
  v_cvt_pk_bf16_f32 v67, v70, v71
  v_accvgpr_write_b32 a96, v64
  v_mfma_f32_16x16x32_bf16 v[104:107], v[48:51], v[196:199], v[104:107]
  v_accvgpr_write_b32 a97, v65
  v_mfma_f32_16x16x32_bf16 v[112:115], v[48:51], v[228:231], v[112:115]
  s_waitcnt lgkmcnt(5)
  v_accvgpr_write_b32 a98, v66
  v_mfma_f32_16x16x32_bf16 v[92:95], v[52:55], v[132:135], v[92:95]
  ds_read_b128 v[44:47], v250 offset:18688
  v_accvgpr_write_b32 a99, v67
  v_mfma_f32_16x16x32_bf16 v[100:103], v[52:55], v[164:167], v[100:103]
  v_mul_f32 v72, v12, v72
  v_mul_f32 v73, v12, v73
  v_mfma_f32_16x16x32_bf16 v[108:111], v[52:55], v[196:199], v[108:111]
  v_mul_f32 v74, v12, v74
  v_mfma_f32_16x16x32_bf16 v[116:119], v[52:55], v[228:231], v[116:119]
  s_waitcnt lgkmcnt(5)
  v_mul_f32 v75, v12, v75
  v_mfma_f32_16x16x32_bf16 v[88:91], v[24:27], v[136:139], v[88:91]
  ds_read_b128 v[48:51], v251 offset:16640
  v_mul_f32 v76, v12, v76
  v_mfma_f32_16x16x32_bf16 v[96:99], v[24:27], v[168:171], v[96:99]
  v_mul_f32 v77, v12, v77
  v_mul_f32 v78, v12, v78
  v_mfma_f32_16x16x32_bf16 v[104:107], v[24:27], v[200:203], v[104:107]
  v_mul_f32 v79, v12, v79
  v_mfma_f32_16x16x32_bf16 v[112:115], v[24:27], v[232:235], v[112:115]
  s_waitcnt lgkmcnt(5)
  v_cvt_pk_bf16_f32 v72, v72, v73
  v_mfma_f32_16x16x32_bf16 v[92:95], v[28:31], v[136:139], v[92:95]
  ds_read_b128 v[52:55], v251 offset:18688
  v_cvt_pk_bf16_f32 v73, v74, v75
  v_mfma_f32_16x16x32_bf16 v[100:103], v[28:31], v[168:171], v[100:103]
  v_cvt_pk_bf16_f32 v74, v76, v77
  v_cvt_pk_bf16_f32 v75, v78, v79
  v_mfma_f32_16x16x32_bf16 v[108:111], v[28:31], v[200:203], v[108:111]
  v_accvgpr_write_b32 a152, v72
  v_mfma_f32_16x16x32_bf16 v[116:119], v[28:31], v[232:235], v[116:119]
  s_waitcnt lgkmcnt(5)
  v_accvgpr_write_b32 a153, v73
  v_mfma_f32_16x16x32_bf16 v[88:91], v[32:35], v[140:143], v[88:91]
  s_waitcnt vmcnt(5)
  s_barrier
  ds_read_b128 v[24:27], v248 offset:32768
  v_accvgpr_write_b32 a154, v74
  v_mfma_f32_16x16x32_bf16 v[96:99], v[32:35], v[172:175], v[96:99]
  v_accvgpr_write_b32 a155, v75
  v_mul_f32 v80, v12, v80
  v_mfma_f32_16x16x32_bf16 v[104:107], v[32:35], v[204:207], v[104:107]
  v_mul_f32 v81, v12, v81
  v_mfma_f32_16x16x32_bf16 v[112:115], v[32:35], v[236:239], v[112:115]
  s_waitcnt lgkmcnt(5)
  v_mul_f32 v82, v12, v82
  v_mfma_f32_16x16x32_bf16 v[92:95], v[36:39], v[140:143], v[92:95]
  ds_read_b128 v[28:31], v248 offset:34816
  v_mul_f32 v83, v12, v83
  v_mfma_f32_16x16x32_bf16 v[100:103], v[36:39], v[172:175], v[100:103]
  v_mul_f32 v84, v12, v84
  v_mul_f32 v85, v12, v85
  v_mfma_f32_16x16x32_bf16 v[108:111], v[36:39], v[204:207], v[108:111]
  v_mul_f32 v86, v12, v86
  v_mfma_f32_16x16x32_bf16 v[116:119], v[36:39], v[236:239], v[116:119]
  s_waitcnt lgkmcnt(5)
  v_mul_f32 v87, v12, v87
  v_mfma_f32_16x16x32_bf16 v[88:91], v[40:43], v[144:147], v[88:91]
  ds_read_b128 v[32:35], v249 offset:32768
  v_cvt_pk_bf16_f32 v80, v80, v81
  v_mfma_f32_16x16x32_bf16 v[96:99], v[40:43], v[176:179], v[96:99]
  v_cvt_pk_bf16_f32 v81, v82, v83
  v_cvt_pk_bf16_f32 v82, v84, v85
  v_mfma_f32_16x16x32_bf16 v[104:107], v[40:43], v[208:211], v[104:107]
  v_cvt_pk_bf16_f32 v83, v86, v87
  v_mfma_f32_16x16x32_bf16 v[112:115], v[40:43], v[240:243], v[112:115]
  s_waitcnt lgkmcnt(5)
  v_accvgpr_write_b32 a208, v80
  v_mfma_f32_16x16x32_bf16 v[92:95], v[44:47], v[144:147], v[92:95]
  ds_read_b128 v[36:39], v249 offset:34816
  v_accvgpr_write_b32 a209, v81
  v_mfma_f32_16x16x32_bf16 v[100:103], v[44:47], v[176:179], v[100:103]
  v_accvgpr_write_b32 a210, v82
  v_accvgpr_write_b32 a211, v83
  v_mfma_f32_16x16x32_bf16 v[108:111], v[44:47], v[208:211], v[108:111]
  v_mfma_f32_16x16x32_bf16 v[116:119], v[44:47], v[240:243], v[116:119]
  s_waitcnt lgkmcnt(5)
  v_mfma_f32_16x16x32_bf16 v[88:91], v[48:51], v[148:151], v[88:91]
  ds_read_b128 v[40:43], v250 offset:32768
  v_mfma_f32_16x16x32_bf16 v[96:99], v[48:51], v[180:183], v[96:99]
  v_mfma_f32_16x16x32_bf16 v[104:107], v[48:51], v[212:215], v[104:107]
  v_mfma_f32_16x16x32_bf16 v[112:115], v[48:51], v[244:247], v[112:115]
  s_waitcnt lgkmcnt(5)
  v_mfma_f32_16x16x32_bf16 v[92:95], v[52:55], v[148:151], v[92:95]
  ds_read_b128 v[44:47], v250 offset:34816
  v_mfma_f32_16x16x32_bf16 v[100:103], v[52:55], v[180:183], v[100:103]
  v_mfma_f32_16x16x32_bf16 v[108:111], v[52:55], v[212:215], v[108:111]
  v_mfma_f32_16x16x32_bf16 v[116:119], v[52:55], v[244:247], v[116:119]
  s_waitcnt lgkmcnt(5)
  s_getpc_b64 s[98:99]
  s_add_u32 s98, s98, 4096
  s_addc_u32 s99, s99, 0
  global_load_dword v7, v6, s[98:99]
  v_mfma_f32_16x16x32_bf16 v[56:59], v[24:27], v[120:123], 0
  ds_read_b128 v[48:51], v251 offset:32768
  v_mfma_f32_16x16x32_bf16 v[64:67], v[24:27], v[152:155], 0
  v_mfma_f32_16x16x32_bf16 v[72:75], v[24:27], v[184:187], 0
  v_mfma_f32_16x16x32_bf16 v[80:83], v[24:27], v[216:219], 0
  s_waitcnt lgkmcnt(5)
  v_mul_f32 v88, v12, v88
  v_mfma_f32_16x16x32_bf16 v[60:63], v[28:31], v[120:123], 0
  ds_read_b128 v[52:55], v251 offset:34816
  v_mul_f32 v89, v12, v89
  v_mfma_f32_16x16x32_bf16 v[68:71], v[28:31], v[152:155], 0
  v_mul_f32 v90, v12, v90
  v_mul_f32 v91, v12, v91
  v_mfma_f32_16x16x32_bf16 v[76:79], v[28:31], v[184:187], 0
  v_mul_f32 v92, v12, v92
  v_mfma_f32_16x16x32_bf16 v[84:87], v[28:31], v[216:219], 0
  s_waitcnt lgkmcnt(5)
  v_mul_f32 v93, v12, v93
  v_mfma_f32_16x16x32_bf16 v[56:59], v[32:35], v[124:127], v[56:59]
  ds_read_b128 v[24:27], v248 offset:33024
  v_mul_f32 v94, v12, v94
  v_mfma_f32_16x16x32_bf16 v[64:67], v[32:35], v[156:159], v[64:67]
  v_mul_f32 v95, v12, v95
  v_cvt_pk_bf16_f32 v88, v88, v89
  v_mfma_f32_16x16x32_bf16 v[72:75], v[32:35], v[188:191], v[72:75]
  v_cvt_pk_bf16_f32 v89, v90, v91
  v_mfma_f32_16x16x32_bf16 v[80:83], v[32:35], v[220:223], v[80:83]
  s_waitcnt lgkmcnt(5)
  v_cvt_pk_bf16_f32 v90, v92, v93
  v_mfma_f32_16x16x32_bf16 v[60:63], v[36:39], v[124:127], v[60:63]
  ds_read_b128 v[28:31], v248 offset:35072
  v_cvt_pk_bf16_f32 v91, v94, v95
  v_mfma_f32_16x16x32_bf16 v[68:71], v[36:39], v[156:159], v[68:71]
  v_accvgpr_write_b32 a44, v88
  v_accvgpr_write_b32 a45, v89
  v_mfma_f32_16x16x32_bf16 v[76:79], v[36:39], v[188:191], v[76:79]
  v_accvgpr_write_b32 a46, v90
  v_mfma_f32_16x16x32_bf16 v[84:87], v[36:39], v[220:223], v[84:87]
  s_waitcnt lgkmcnt(5)
  v_accvgpr_write_b32 a47, v91
  v_mfma_f32_16x16x32_bf16 v[56:59], v[40:43], v[128:131], v[56:59]
  ds_read_b128 v[32:35], v249 offset:33024
  v_mul_f32 v96, v12, v96
  v_mfma_f32_16x16x32_bf16 v[64:67], v[40:43], v[160:163], v[64:67]
  v_mul_f32 v97, v12, v97
  v_mul_f32 v98, v12, v98
  v_mfma_f32_16x16x32_bf16 v[72:75], v[40:43], v[192:195], v[72:75]
  v_mul_f32 v99, v12, v99
  v_mfma_f32_16x16x32_bf16 v[80:83], v[40:43], v[224:227], v[80:83]
  s_waitcnt lgkmcnt(5)
  v_mul_f32 v100, v12, v100
  v_mfma_f32_16x16x32_bf16 v[60:63], v[44:47], v[128:131], v[60:63]
  ds_read_b128 v[36:39], v249 offset:35072
  v_mul_f32 v101, v12, v101
  v_mfma_f32_16x16x32_bf16 v[68:71], v[44:47], v[160:163], v[68:71]
  v_mul_f32 v102, v12, v102
  v_mul_f32 v103, v12, v103
  v_mfma_f32_16x16x32_bf16 v[76:79], v[44:47], v[192:195], v[76:79]
  v_cvt_pk_bf16_f32 v96, v96, v97
  v_mfma_f32_16x16x32_bf16 v[84:87], v[44:47], v[224:227], v[84:87]
  s_waitcnt lgkmcnt(5)
  v_cvt_pk_bf16_f32 v97, v98, v99
  v_mfma_f32_16x16x32_bf16 v[56:59], v[48:51], v[132:135], v[56:59]
  ds_read_b128 v[40:43], v250 offset:33024
  v_cvt_pk_bf16_f32 v98, v100, v101
  v_mfma_f32_16x16x32_bf16 v[64:67], v[48:51], v[164:167], v[64:67]
  v_cvt_pk_bf16_f32 v99, v102, v103
  v_accvgpr_write_b32 a100, v96
  v_mfma_f32_16x16x32_bf16 v[72:75], v[48:51], v[196:199], v[72:75]
  v_accvgpr_write_b32 a101, v97
  v_mfma_f32_16x16x32_bf16 v[80:83], v[48:51], v[228:231], v[80:83]
  s_waitcnt lgkmcnt(5)
  v_accvgpr_write_b32 a102, v98
  v_mfma_f32_16x16x32_bf16 v[60:63], v[52:55], v[132:135], v[60:63]
  ds_read_b128 v[44:47], v250 offset:35072
  v_accvgpr_write_b32 a103, v99
  v_mfma_f32_16x16x32_bf16 v[68:71], v[52:55], v[164:167], v[68:71]
  v_mul_f32 v104, v12, v104
  v_mul_f32 v105, v12, v105
  v_mfma_f32_16x16x32_bf16 v[76:79], v[52:55], v[196:199], v[76:79]
  v_mul_f32 v106, v12, v106
  v_mfma_f32_16x16x32_bf16 v[84:87], v[52:55], v[228:231], v[84:87]
  s_waitcnt lgkmcnt(5)
  v_mul_f32 v107, v12, v107
  v_mfma_f32_16x16x32_bf16 v[56:59], v[24:27], v[136:139], v[56:59]
  ds_read_b128 v[48:51], v251 offset:33024
  v_mul_f32 v108, v12, v108
  v_mfma_f32_16x16x32_bf16 v[64:67], v[24:27], v[168:171], v[64:67]
  v_mul_f32 v109, v12, v109
  v_mul_f32 v110, v12, v110
  v_mfma_f32_16x16x32_bf16 v[72:75], v[24:27], v[200:203], v[72:75]
  v_mul_f32 v111, v12, v111
  v_mfma_f32_16x16x32_bf16 v[80:83], v[24:27], v[232:235], v[80:83]
  s_waitcnt lgkmcnt(5)
  v_cvt_pk_bf16_f32 v104, v104, v105
  v_mfma_f32_16x16x32_bf16 v[60:63], v[28:31], v[136:139], v[60:63]
  ds_read_b128 v[52:55], v251 offset:35072
  v_cvt_pk_bf16_f32 v105, v106, v107
  v_mfma_f32_16x16x32_bf16 v[68:71], v[28:31], v[168:171], v[68:71]
  v_cvt_pk_bf16_f32 v106, v108, v109
  v_cvt_pk_bf16_f32 v107, v110, v111
  v_mfma_f32_16x16x32_bf16 v[76:79], v[28:31], v[200:203], v[76:79]
  v_accvgpr_write_b32 a156, v104
  v_mfma_f32_16x16x32_bf16 v[84:87], v[28:31], v[232:235], v[84:87]
  s_waitcnt lgkmcnt(5)
  v_accvgpr_write_b32 a157, v105
  v_mfma_f32_16x16x32_bf16 v[56:59], v[32:35], v[140:143], v[56:59]
  s_waitcnt vmcnt(0)
  s_barrier
  ds_read_b128 v[24:27], v248 offset:49152
  v_accvgpr_write_b32 a158, v106
  v_mfma_f32_16x16x32_bf16 v[64:67], v[32:35], v[172:175], v[64:67]
  v_accvgpr_write_b32 a159, v107
  v_mul_f32 v112, v12, v112
  v_mfma_f32_16x16x32_bf16 v[72:75], v[32:35], v[204:207], v[72:75]
  v_mul_f32 v113, v12, v113
  v_mfma_f32_16x16x32_bf16 v[80:83], v[32:35], v[236:239], v[80:83]
  s_waitcnt lgkmcnt(5)
  v_mul_f32 v114, v12, v114
  v_mfma_f32_16x16x32_bf16 v[60:63], v[36:39], v[140:143], v[60:63]
  ds_read_b128 v[28:31], v248 offset:51200
  v_mul_f32 v115, v12, v115
  v_mfma_f32_16x16x32_bf16 v[68:71], v[36:39], v[172:175], v[68:71]
  v_mul_f32 v116, v12, v116
  v_mul_f32 v117, v12, v117
  v_mfma_f32_16x16x32_bf16 v[76:79], v[36:39], v[204:207], v[76:79]
  v_mul_f32 v118, v12, v118
  v_mfma_f32_16x16x32_bf16 v[84:87], v[36:39], v[236:239], v[84:87]
  s_waitcnt lgkmcnt(5)
  v_mul_f32 v119, v12, v119
  v_mfma_f32_16x16x32_bf16 v[56:59], v[40:43], v[144:147], v[56:59]
  ds_read_b128 v[32:35], v249 offset:49152
  v_cvt_pk_bf16_f32 v112, v112, v113
  v_mfma_f32_16x16x32_bf16 v[64:67], v[40:43], v[176:179], v[64:67]
  v_cvt_pk_bf16_f32 v113, v114, v115
  v_cvt_pk_bf16_f32 v114, v116, v117
  v_mfma_f32_16x16x32_bf16 v[72:75], v[40:43], v[208:211], v[72:75]
  v_cvt_pk_bf16_f32 v115, v118, v119
  v_mfma_f32_16x16x32_bf16 v[80:83], v[40:43], v[240:243], v[80:83]
  s_waitcnt lgkmcnt(5)
  v_accvgpr_write_b32 a212, v112
  v_mfma_f32_16x16x32_bf16 v[60:63], v[44:47], v[144:147], v[60:63]
  ds_read_b128 v[36:39], v249 offset:51200
  v_accvgpr_write_b32 a213, v113
  v_mfma_f32_16x16x32_bf16 v[68:71], v[44:47], v[176:179], v[68:71]
  v_accvgpr_write_b32 a214, v114
  v_accvgpr_write_b32 a215, v115
  v_mfma_f32_16x16x32_bf16 v[76:79], v[44:47], v[208:211], v[76:79]
  v_mfma_f32_16x16x32_bf16 v[84:87], v[44:47], v[240:243], v[84:87]
  s_waitcnt lgkmcnt(5)
  v_mfma_f32_16x16x32_bf16 v[56:59], v[48:51], v[148:151], v[56:59]
  ds_read_b128 v[40:43], v250 offset:49152
  v_mfma_f32_16x16x32_bf16 v[64:67], v[48:51], v[180:183], v[64:67]
  v_mfma_f32_16x16x32_bf16 v[72:75], v[48:51], v[212:215], v[72:75]
  v_mfma_f32_16x16x32_bf16 v[80:83], v[48:51], v[244:247], v[80:83]
  s_waitcnt lgkmcnt(5)
  v_mfma_f32_16x16x32_bf16 v[60:63], v[52:55], v[148:151], v[60:63]
  ds_read_b128 v[44:47], v250 offset:51200
  v_mfma_f32_16x16x32_bf16 v[68:71], v[52:55], v[180:183], v[68:71]
  v_mfma_f32_16x16x32_bf16 v[76:79], v[52:55], v[212:215], v[76:79]
  v_mfma_f32_16x16x32_bf16 v[84:87], v[52:55], v[244:247], v[84:87]
  s_waitcnt lgkmcnt(5)
  v_mfma_f32_16x16x32_bf16 v[88:91], v[24:27], v[120:123], 0
  ds_read_b128 v[48:51], v251 offset:49152
  v_mfma_f32_16x16x32_bf16 v[96:99], v[24:27], v[152:155], 0
  v_mfma_f32_16x16x32_bf16 v[104:107], v[24:27], v[184:187], 0
  v_readfirstlane_b32 s86, v13
  s_lshl_b32 s22, s17, 7
  s_add_u32 s22, s22, 88521216
  s_mov_b32 s23, 88523264
  buffer_load_dword v13, off, s[8:11], s22 sc1
  buffer_load_dword v5, off, s[8:11], s23 sc1
  buffer_load_dword v9, off, s[12:15], 0 sc1
  v_mfma_f32_16x16x32_bf16 v[112:115], v[24:27], v[216:219], 0
  s_waitcnt lgkmcnt(5)
  v_mul_f32 v56, v12, v56
  v_mfma_f32_16x16x32_bf16 v[92:95], v[28:31], v[120:123], 0
  ds_read_b128 v[52:55], v251 offset:51200
  v_mul_f32 v57, v12, v57
  v_mfma_f32_16x16x32_bf16 v[100:103], v[28:31], v[152:155], 0
  v_mul_f32 v58, v12, v58
  v_mul_f32 v59, v12, v59
  v_mfma_f32_16x16x32_bf16 v[108:111], v[28:31], v[184:187], 0
  v_mul_f32 v60, v12, v60
  v_mfma_f32_16x16x32_bf16 v[116:119], v[28:31], v[216:219], 0
  s_waitcnt lgkmcnt(5)
  v_mul_f32 v61, v12, v61
  v_mfma_f32_16x16x32_bf16 v[88:91], v[32:35], v[124:127], v[88:91]
  ds_read_b128 v[24:27], v248 offset:49408
  v_mul_f32 v62, v12, v62
  v_mfma_f32_16x16x32_bf16 v[96:99], v[32:35], v[156:159], v[96:99]
  v_mul_f32 v63, v12, v63
  v_cvt_pk_bf16_f32 v56, v56, v57
  v_mfma_f32_16x16x32_bf16 v[104:107], v[32:35], v[188:191], v[104:107]
  v_cvt_pk_bf16_f32 v57, v58, v59
  v_mfma_f32_16x16x32_bf16 v[112:115], v[32:35], v[220:223], v[112:115]
  s_waitcnt lgkmcnt(5)
  v_cvt_pk_bf16_f32 v58, v60, v61
  v_mfma_f32_16x16x32_bf16 v[92:95], v[36:39], v[124:127], v[92:95]
  ds_read_b128 v[28:31], v248 offset:51456
  v_cvt_pk_bf16_f32 v59, v62, v63
  v_mfma_f32_16x16x32_bf16 v[100:103], v[36:39], v[156:159], v[100:103]
  v_accvgpr_write_b32 a48, v56
  v_accvgpr_write_b32 a49, v57
  v_mfma_f32_16x16x32_bf16 v[108:111], v[36:39], v[188:191], v[108:111]
  v_accvgpr_write_b32 a50, v58
  v_mfma_f32_16x16x32_bf16 v[116:119], v[36:39], v[220:223], v[116:119]
  s_waitcnt lgkmcnt(5)
  v_accvgpr_write_b32 a51, v59
  v_mfma_f32_16x16x32_bf16 v[88:91], v[40:43], v[128:131], v[88:91]
  ds_read_b128 v[32:35], v249 offset:49408
  v_mul_f32 v64, v12, v64
  v_mfma_f32_16x16x32_bf16 v[96:99], v[40:43], v[160:163], v[96:99]
  v_mul_f32 v65, v12, v65
  v_mul_f32 v66, v12, v66
  v_mfma_f32_16x16x32_bf16 v[104:107], v[40:43], v[192:195], v[104:107]
  v_mul_f32 v67, v12, v67
  v_mfma_f32_16x16x32_bf16 v[112:115], v[40:43], v[224:227], v[112:115]
  s_waitcnt lgkmcnt(5)
  v_mul_f32 v68, v12, v68
  v_mfma_f32_16x16x32_bf16 v[92:95], v[44:47], v[128:131], v[92:95]
  ds_read_b128 v[36:39], v249 offset:51456
  v_mul_f32 v69, v12, v69
  v_mfma_f32_16x16x32_bf16 v[100:103], v[44:47], v[160:163], v[100:103]
  v_mul_f32 v70, v12, v70
  v_mul_f32 v71, v12, v71
  v_mfma_f32_16x16x32_bf16 v[108:111], v[44:47], v[192:195], v[108:111]
  v_cvt_pk_bf16_f32 v64, v64, v65
  v_mfma_f32_16x16x32_bf16 v[116:119], v[44:47], v[224:227], v[116:119]
  s_waitcnt lgkmcnt(5)
  v_cvt_pk_bf16_f32 v65, v66, v67
  v_mfma_f32_16x16x32_bf16 v[88:91], v[48:51], v[132:135], v[88:91]
  ds_read_b128 v[40:43], v250 offset:49408
  v_cvt_pk_bf16_f32 v66, v68, v69
  v_mfma_f32_16x16x32_bf16 v[96:99], v[48:51], v[164:167], v[96:99]
  v_cvt_pk_bf16_f32 v67, v70, v71
  v_accvgpr_write_b32 a104, v64
  v_mfma_f32_16x16x32_bf16 v[104:107], v[48:51], v[196:199], v[104:107]
  v_accvgpr_write_b32 a105, v65
  v_mfma_f32_16x16x32_bf16 v[112:115], v[48:51], v[228:231], v[112:115]
  s_waitcnt lgkmcnt(5)
  v_accvgpr_write_b32 a106, v66
  v_mfma_f32_16x16x32_bf16 v[92:95], v[52:55], v[132:135], v[92:95]
  ds_read_b128 v[44:47], v250 offset:51456
  v_accvgpr_write_b32 a107, v67
  v_mfma_f32_16x16x32_bf16 v[100:103], v[52:55], v[164:167], v[100:103]
  v_mul_f32 v72, v12, v72
  v_mul_f32 v73, v12, v73
  v_mfma_f32_16x16x32_bf16 v[108:111], v[52:55], v[196:199], v[108:111]
  v_mul_f32 v74, v12, v74
  v_mfma_f32_16x16x32_bf16 v[116:119], v[52:55], v[228:231], v[116:119]
  s_waitcnt lgkmcnt(5)
  v_mul_f32 v75, v12, v75
  v_mfma_f32_16x16x32_bf16 v[88:91], v[24:27], v[136:139], v[88:91]
  ds_read_b128 v[48:51], v251 offset:49408
  v_mul_f32 v76, v12, v76
  v_mfma_f32_16x16x32_bf16 v[96:99], v[24:27], v[168:171], v[96:99]
  v_mul_f32 v77, v12, v77
  v_mul_f32 v78, v12, v78
  v_mfma_f32_16x16x32_bf16 v[104:107], v[24:27], v[200:203], v[104:107]
  v_mul_f32 v79, v12, v79
  v_mfma_f32_16x16x32_bf16 v[112:115], v[24:27], v[232:235], v[112:115]
  s_waitcnt lgkmcnt(5)
  v_cvt_pk_bf16_f32 v72, v72, v73
  v_mfma_f32_16x16x32_bf16 v[92:95], v[28:31], v[136:139], v[92:95]
  ds_read_b128 v[52:55], v251 offset:51456
  v_cvt_pk_bf16_f32 v73, v74, v75
  v_mfma_f32_16x16x32_bf16 v[100:103], v[28:31], v[168:171], v[100:103]
  v_cvt_pk_bf16_f32 v74, v76, v77
  v_cvt_pk_bf16_f32 v75, v78, v79
  v_mfma_f32_16x16x32_bf16 v[108:111], v[28:31], v[200:203], v[108:111]
  v_accvgpr_write_b32 a160, v72
  v_mfma_f32_16x16x32_bf16 v[116:119], v[28:31], v[232:235], v[116:119]
  s_waitcnt lgkmcnt(5)
  v_accvgpr_write_b32 a161, v73
  v_mfma_f32_16x16x32_bf16 v[88:91], v[32:35], v[140:143], v[88:91]
  v_accvgpr_write_b32 a162, v74
  v_mfma_f32_16x16x32_bf16 v[96:99], v[32:35], v[172:175], v[96:99]
  v_accvgpr_write_b32 a163, v75
  v_mul_f32 v80, v12, v80
  v_mfma_f32_16x16x32_bf16 v[104:107], v[32:35], v[204:207], v[104:107]
  v_mul_f32 v81, v12, v81
  v_mfma_f32_16x16x32_bf16 v[112:115], v[32:35], v[236:239], v[112:115]
  s_waitcnt lgkmcnt(4)
  v_mul_f32 v82, v12, v82
  v_mfma_f32_16x16x32_bf16 v[92:95], v[36:39], v[140:143], v[92:95]
  v_mul_f32 v83, v12, v83
  v_mfma_f32_16x16x32_bf16 v[100:103], v[36:39], v[172:175], v[100:103]
  v_mul_f32 v84, v12, v84
  v_mul_f32 v85, v12, v85
  v_mfma_f32_16x16x32_bf16 v[108:111], v[36:39], v[204:207], v[108:111]
  v_mul_f32 v86, v12, v86
  v_mfma_f32_16x16x32_bf16 v[116:119], v[36:39], v[236:239], v[116:119]
  s_waitcnt lgkmcnt(3)
  v_mul_f32 v87, v12, v87
  v_mfma_f32_16x16x32_bf16 v[88:91], v[40:43], v[144:147], v[88:91]
  v_cvt_pk_bf16_f32 v80, v80, v81
  v_mfma_f32_16x16x32_bf16 v[96:99], v[40:43], v[176:179], v[96:99]
  v_cvt_pk_bf16_f32 v81, v82, v83
  v_cvt_pk_bf16_f32 v82, v84, v85
  v_mfma_f32_16x16x32_bf16 v[104:107], v[40:43], v[208:211], v[104:107]
  v_cvt_pk_bf16_f32 v83, v86, v87
  v_mfma_f32_16x16x32_bf16 v[112:115], v[40:43], v[240:243], v[112:115]
  s_waitcnt lgkmcnt(2)
  v_accvgpr_write_b32 a216, v80
  v_mfma_f32_16x16x32_bf16 v[92:95], v[44:47], v[144:147], v[92:95]
  v_accvgpr_write_b32 a217, v81
  v_mfma_f32_16x16x32_bf16 v[100:103], v[44:47], v[176:179], v[100:103]
  v_accvgpr_write_b32 a218, v82
  v_accvgpr_write_b32 a219, v83
  v_mfma_f32_16x16x32_bf16 v[108:111], v[44:47], v[208:211], v[108:111]
  v_mfma_f32_16x16x32_bf16 v[116:119], v[44:47], v[240:243], v[116:119]
  s_waitcnt lgkmcnt(1)
  v_mfma_f32_16x16x32_bf16 v[88:91], v[48:51], v[148:151], v[88:91]
  v_mfma_f32_16x16x32_bf16 v[96:99], v[48:51], v[180:183], v[96:99]
  v_mfma_f32_16x16x32_bf16 v[104:107], v[48:51], v[212:215], v[104:107]
  v_mfma_f32_16x16x32_bf16 v[112:115], v[48:51], v[244:247], v[112:115]
  s_waitcnt lgkmcnt(0)
  v_mfma_f32_16x16x32_bf16 v[92:95], v[52:55], v[148:151], v[92:95]
  v_mfma_f32_16x16x32_bf16 v[100:103], v[52:55], v[180:183], v[100:103]
  v_mfma_f32_16x16x32_bf16 v[108:111], v[52:55], v[212:215], v[108:111]
  v_mfma_f32_16x16x32_bf16 v[116:119], v[52:55], v[244:247], v[116:119]
  v_mul_f32 v88, v12, v88
  v_mul_f32 v89, v12, v89
  v_mul_f32 v90, v12, v90
  v_mul_f32 v91, v12, v91
  v_mul_f32 v92, v12, v92
  v_mul_f32 v93, v12, v93
  v_mul_f32 v94, v12, v94
  v_mul_f32 v95, v12, v95
  v_cvt_pk_bf16_f32 v88, v88, v89
  v_cvt_pk_bf16_f32 v89, v90, v91
  v_cvt_pk_bf16_f32 v90, v92, v93
  v_cvt_pk_bf16_f32 v91, v94, v95
  v_accvgpr_write_b32 a52, v88
  v_accvgpr_write_b32 a53, v89
  v_accvgpr_write_b32 a54, v90
  v_accvgpr_write_b32 a55, v91
  v_mul_f32 v96, v12, v96
  v_mul_f32 v97, v12, v97
  v_mul_f32 v98, v12, v98
  v_mul_f32 v99, v12, v99
  v_mul_f32 v100, v12, v100
  v_mul_f32 v101, v12, v101
  v_mul_f32 v102, v12, v102
  v_mul_f32 v103, v12, v103
  v_cvt_pk_bf16_f32 v96, v96, v97
  v_cvt_pk_bf16_f32 v97, v98, v99
  v_cvt_pk_bf16_f32 v98, v100, v101
  v_cvt_pk_bf16_f32 v99, v102, v103
  v_accvgpr_write_b32 a108, v96
  v_accvgpr_write_b32 a109, v97
  v_accvgpr_write_b32 a110, v98
  v_accvgpr_write_b32 a111, v99
  v_mul_f32 v104, v12, v104
  v_mul_f32 v105, v12, v105
  v_mul_f32 v106, v12, v106
  v_mul_f32 v107, v12, v107
  v_mul_f32 v108, v12, v108
  v_mul_f32 v109, v12, v109
  v_mul_f32 v110, v12, v110
  v_mul_f32 v111, v12, v111
  v_cvt_pk_bf16_f32 v104, v104, v105
  v_cvt_pk_bf16_f32 v105, v106, v107
  v_cvt_pk_bf16_f32 v106, v108, v109
  v_cvt_pk_bf16_f32 v107, v110, v111
  v_accvgpr_write_b32 a164, v104
  v_accvgpr_write_b32 a165, v105
  v_accvgpr_write_b32 a166, v106
  v_accvgpr_write_b32 a167, v107
  v_mul_f32 v112, v12, v112
  v_mul_f32 v113, v12, v113
  v_mul_f32 v114, v12, v114
  v_mul_f32 v115, v12, v115
  v_mul_f32 v116, v12, v116
  v_mul_f32 v117, v12, v117
  v_mul_f32 v118, v12, v118
  v_mul_f32 v119, v12, v119
  v_cvt_pk_bf16_f32 v112, v112, v113
  v_cvt_pk_bf16_f32 v113, v114, v115
  v_cvt_pk_bf16_f32 v114, v116, v117
  v_cvt_pk_bf16_f32 v115, v118, v119
  v_accvgpr_write_b32 a220, v112
  v_accvgpr_write_b32 a221, v113
  v_accvgpr_write_b32 a222, v114
  v_accvgpr_write_b32 a223, v115
  s_waitcnt vmcnt(0)
  s_barrier
  v_readfirstlane_b32 s84, v13
  v_readfirstlane_b32 s85, v5
  s_cmp_eq_u32 s86, 1
  s_cselect_b32 s84, s84, 0
  v_and_b32 v10, 0xffe0, v9
  v_cmp_eq_u32 vcc, 0, v10
  s_cbranch_vccz ch_md_ok
ch_role2:
  s_mov_b32 s30, 0
ch_md:
  buffer_load_dword v9, off, s[12:15], 0 sc1
  s_waitcnt vmcnt(0)
  v_and_b32 v10, 0xffe0, v9
  v_cmp_eq_u32 vcc, 0, v10
  s_cbranch_vccz ch_md_ok
  s_sleep 4
  s_add_u32 s30, s30, 1
  s_cmp_lt_u32 s30, 1600000
  s_cbranch_scc1 ch_md
  s_branch ch_end
ch_md_ok:
  v_readfirstlane_b32 s88, v9
  s_lshr_b32 s88, s88, 16
  v_and_b32 v1, 63, v0
  v_lshlrev_b32 v2, 4, v1
  v_lshrrev_b32 v116, 4, v1
  v_and_b32 v117, 15, v1
  v_mov_b32 v3, 0x4444
  v_mov_b32 v118, 0xeeee
  v_cmp_lt_u32 vcc, 7, v117
  s_nop 1
  v_cndmask_b32 v3, v3, v118, vcc
  s_mov_b32 s19, 0
  s_mov_b32 s18, 1
  s_mov_b32 s20, 75694080
  s_mov_b32 s21, 75711744
  s_mov_b32 s23, 75698176
  s_lshr_b32 s89, s17, 4
  s_lshl_b32 s89, s89, 2
  s_add_u32 s89, s89, s16
  s_and_b32 s17, s17, 15
  s_cmp_eq_u32 s89, 0
  s_cbranch_scc1 ch_init0
  s_cmp_eq_u32 s89, 1
  s_cbranch_scc1 ch_init1
  s_cmp_eq_u32 s89, 2
  s_cbranch_scc1 ch_init2
  s_cmp_eq_u32 s89, 3
  s_cbranch_scc1 ch_init3
  s_cmp_eq_u32 s89, 4
  s_cbranch_scc1 ch_init4
  s_cmp_eq_u32 s89, 5
  s_cbranch_scc1 ch_init5
  s_cmp_eq_u32 s89, 6
  s_cbranch_scc1 ch_init6
  s_cmp_eq_u32 s89, 7
  s_cbranch_scc1 ch_init7
  s_branch ch_end
ch_init0:
  s_mul_i32 s31, s17, 401408
  s_add_u32 s31, s31, 0
  s_and_b32 s28, s84, 10320
  s_lshl_b32 s22, s85, 16
  s_or_b32 s28, s28, s22
  s_cmp_eq_u32 s28, 4294912080
  s_cbranch_scc1 ch_wx0_ok
  s_mov_b32 s30, 0
ch_wr0:
  buffer_load_dword v9, off, s[12:15], 0 offset:132 sc1
  s_waitcnt vmcnt(0)
  v_cmp_ne_u32 vcc, 1, v9
  s_cbranch_vccz ch_wr0_ok
  s_sleep 8
  s_add_u32 s30, s30, 1
  s_cmp_lt_u32 s30, 400000
  s_cbranch_scc1 ch_wr0
  s_branch cA_abort
ch_wr0_ok:
  s_lshl_b32 s27, s17, 7
  s_add_u32 s27, s27, 88521216
  s_mov_b32 s28, 10320
  s_mov_b32 s30, 0
ch_wb0:
  buffer_load_dword v9, off, s[8:11], s27  sc1
  s_waitcnt vmcnt(0)
  v_and_b32 v10, s28, v9
  v_cmp_ne_u32 vcc, s28, v10
  s_cbranch_vccz ch_wb0_ok
  s_sleep 3
  s_add_u32 s30, s30, 1
  s_cmp_lt_u32 s30, 400000
  s_cbranch_scc1 ch_wb0
  s_branch cA_abort
ch_wb0_ok:
  s_mov_b32 s29, 88523264
  s_mov_b32 s28, 0xffff
  s_mov_b32 s30, 0
ch_wx0:
  buffer_load_dword v9, off, s[8:11], s29  sc1
  s_waitcnt vmcnt(0)
  v_and_b32 v10, s28, v9
  v_cmp_ne_u32 vcc, s28, v10
  s_cbranch_vccz ch_wx0_ok
  s_sleep 8
  s_add_u32 s30, s30, 1
  s_cmp_lt_u32 s30, 400000
  s_cbranch_scc1 ch_wx0
  s_branch cA_abort
ch_wx0_ok:
  s_add_u32 s22, s31, 229376
  buffer_load_dwordx4 a[224:227], v2, s[8:11], s22 offen offset:0 sc1
  buffer_load_dwordx4 a[228:231], v2, s[8:11], s22 offen offset:1024 sc1
  buffer_load_dwordx4 a[232:235], v2, s[8:11], s22 offen offset:2048 sc1
  buffer_load_dwordx4 a[236:239], v2, s[8:11], s22 offen offset:3072 sc1
  s_add_u32 s22, s31, 233472
  buffer_load_dwordx4 a[240:243], v2, s[8:11], s22 offen offset:0 sc1
  buffer_load_dwordx4 a[244:247], v2, s[8:11], s22 offen offset:1024 sc1
  buffer_load_dwordx4 a[248:251], v2, s[8:11], s22 offen offset:2048 sc1
  buffer_load_dwordx4 a[252:255], v2, s[8:11], s22 offen offset:3072 sc1
  s_add_u32 s22, s31, 237568
  buffer_load_dwordx4 v[120:123], v2, s[8:11], s22 offen offset:0 sc1
  buffer_load_dwordx4 v[124:127], v2, s[8:11], s22 offen offset:1024 sc1
  buffer_load_dwordx4 v[128:131], v2, s[8:11], s22 offen offset:2048 sc1
  buffer_load_dwordx4 v[132:135], v2, s[8:11], s22 offen offset:3072 sc1
  s_add_u32 s22, s31, 241664
  buffer_load_dwordx4 v[136:139], v2, s[8:11], s22 offen offset:0 sc1
  buffer_load_dwordx4 v[140:143], v2, s[8:11], s22 offen offset:1024 sc1
  buffer_load_dwordx4 v[144:147], v2, s[8:11], s22 offen offset:2048 sc1
  buffer_load_dwordx4 v[148:151], v2, s[8:11], s22 offen offset:3072 sc1
  s_add_u32 s22, s31, 245760
  buffer_load_dwordx4 v[152:155], v2, s[8:11], s22 offen offset:0 sc1
  buffer_load_dwordx4 v[156:159], v2, s[8:11], s22 offen offset:1024 sc1
  buffer_load_dwordx4 v[160:163], v2, s[8:11], s22 offen offset:2048 sc1
  buffer_load_dwordx4 v[164:167], v2, s[8:11], s22 offen offset:3072 sc1
  s_add_u32 s22, s31, 249856
  buffer_load_dwordx4 v[168:171], v2, s[8:11], s22 offen offset:0 sc1
  buffer_load_dwordx4 v[172:175], v2, s[8:11], s22 offen offset:1024 sc1
  buffer_load_dwordx4 v[176:179], v2, s[8:11], s22 offen offset:2048 sc1
  buffer_load_dwordx4 v[180:183], v2, s[8:11], s22 offen offset:3072 sc1
  s_mov_b32 s24, 72024064
  s_mov_b32 s26, 72038400
  v_and_b32 v64, 7, v117
  v_and_b32 v65, 1, v116
  v_lshlrev_b32 v65, 2, v65
  v_sub_u32 v64, v64, v65
  v_lshrrev_b32 v65, 3, v117
  v_lshl_add_u32 v66, v65, 2, v64
  v_cmp_gt_u32 vcc, 4, v64
  v_mov_b32 v67, 99
  s_nop 0
  v_cndmask_b32 v66, v67, v66, vcc
  v_mov_b32 v68, 0x3f80
  v_mov_b32 v69, 0x3f800000
  v_mov_b32 v4, 0
  v_cmp_eq_u32 vcc, 0, v66
  s_nop 1
  v_cndmask_b32 v4, v4, v68, vcc
  v_cmp_eq_u32 vcc, 1, v66
  s_nop 1
  v_cndmask_b32 v4, v4, v69, vcc
  v_mov_b32 v5, 0
  v_cmp_eq_u32 vcc, 2, v66
  s_nop 1
  v_cndmask_b32 v5, v5, v68, vcc
  v_cmp_eq_u32 vcc, 3, v66
  s_nop 1
  v_cndmask_b32 v5, v5, v69, vcc
  v_mov_b32 v6, 0
  v_cmp_eq_u32 vcc, 4, v66
  s_nop 1
  v_cndmask_b32 v6, v6, v68, vcc
  v_cmp_eq_u32 vcc, 5, v66
  s_nop 1
  v_cndmask_b32 v6, v6, v69, vcc
  v_mov_b32 v7, 0
  v_cmp_eq_u32 vcc, 6, v66
  s_nop 1
  v_cndmask_b32 v7, v7, v68, vcc
  v_cmp_eq_u32 vcc, 7, v66
  s_nop 1
  v_cndmask_b32 v7, v7, v69, vcc
  v_lshrrev_b32 v64, 1, v116
  v_lshrrev_b32 v65, 3, v117
  v_and_b32 v66, 1, v116
  v_and_b32 v68, 7, v117
  v_lshlrev_b32 v67, 8, v65
  v_lshl_add_u32 v67, v68, 5, v67
  v_lshl_add_u32 v67, v66, 4, v67
  v_add_u32 v69, 4096, v67
  v_add_u32 v70, 6400, v67
  v_cmp_eq_u32 vcc, v64, v65
  s_nop 1
  v_cndmask_b32 v113, v70, v69, vcc
  v_and_b32 v74, 3, v117
  v_lshlrev_b32 v74, 1, v74
  v_bfe_u32 v75, v117, 2, 1
  v_or_b32 v74, v74, v75
  v_and_b32 v75, 8, v117
  v_or_b32 v74, v74, v75
  v_lshlrev_b32 v67, 9, v64
  v_lshl_add_u32 v67, v74, 4, v67
  v_lshl_add_u32 v67, v66, 3, v67
  v_add_u32 v114, 0, v67
  v_mul_u32_u24 v67, 1088, v65
  v_lshl_add_u32 v67, v116, 5, v67
  v_and_b32 v75, 1, v117
  v_and_b32 v76, 2, v117
  v_lshl_add_u32 v75, v76, 1, v75
  v_bfe_u32 v76, v117, 2, 1
  v_lshl_add_u32 v75, v76, 1, v75
  v_lshl_add_u32 v67, v75, 2, v67
  v_add_u32 v115, 4096, v67
  v_and_b32 v69, 1, v74
  v_lshlrev_b32 v67, 7, v69
  v_lshl_add_u32 v67, v116, 4, v67
  v_lshl_add_u32 v67, v65, 8, v67
  v_bfe_u32 v69, v74, 1, 2
  v_lshl_add_u32 v67, v69, 2, v67
  s_lshl_b32 s22, s17, 9
  s_add_u32 s22, s22, 9216
  v_add_u32 v72, s22, v67
  v_bfe_u32 v69, v75, 1, 1
  v_lshlrev_b32 v67, 7, v69
  v_lshl_add_u32 v67, v116, 4, v67
  v_and_b32 v69, 4, v75
  v_add_u32 v67, v67, v69
  s_lshr_b32 s22, s17, 1
  s_lshl_b32 s22, s22, 8
  s_and_b32 s27, s17, 1
  s_lshl_b32 s27, s27, 3
  s_add_u32 s22, s22, s27
  s_add_u32 s22, s22, 7168
  v_add_u32 v67, s22, v67
  v_and_b32 v69, 9, v117
  v_mov_b32 v70, 0x40000000
  v_cmp_eq_u32 vcc, 0, v69
  s_nop 1
  v_cndmask_b32 v118, v70, v67, vcc
  v_mov_b32 v119, -1
  v_and_b32 v0, 15, v1
  s_and_b32 s22, s17, 0
  s_lshl_b32 s22, s22, 7
  s_add_u32 s22, s22, 75731456
  v_lshl_add_u32 v0, v0, 2, s22
  v_xor_b32 v69, 256, v2
  v_mul_i32_i24 v70, -4096, v66
  v_add_u32 v69, v69, v70
  v_add_u32 v117, 12288, v69
  v_mov_b32 v116, v73
  v_mov_b32 v112, 0
  s_mul_i32 s35, s17, 28672
  s_add_u32 s35, s35, 44040192
  v_mov_b32 v1, v72
  v_mov_b32 v36, 0
  v_mov_b32 v37, 0
  v_mov_b32 v38, 0
  v_mov_b32 v39, 0
  v_mov_b32 v40, 0
  v_mov_b32 v41, 0
  v_mov_b32 v42, 0
  v_mov_b32 v43, 0
  v_mov_b32 v44, 0
  v_mov_b32 v45, 0
  v_mov_b32 v46, 0
  v_mov_b32 v47, 0
  v_mov_b32 v48, 0
  v_mov_b32 v49, 0
  v_mov_b32 v50, 0
  v_mov_b32 v51, 0
  v_mov_b32 v52, 0
  v_mov_b32 v53, 0
  v_mov_b32 v54, 0
  v_mov_b32 v55, 0
  v_mov_b32 v56, 0
  v_mov_b32 v57, 0
  v_mov_b32 v58, 0
  v_mov_b32 v59, 0
  v_mov_b32 v60, 0
  v_mov_b32 v61, 0
  v_mov_b32 v62, 0
  v_mov_b32 v63, 0
  v_mov_b32 v64, 0
  v_mov_b32 v65, 0
  v_mov_b32 v66, 0
  v_mov_b32 v67, 0
  v_mov_b32 v68, 0
  v_mov_b32 v69, 0
  v_mov_b32 v70, 0
  v_mov_b32 v71, 0
  v_mov_b32 v72, 0
  v_mov_b32 v73, 0
  v_mov_b32 v74, 0
  v_mov_b32 v75, 0
  v_mov_b32 v76, 0
  v_mov_b32 v77, 0
  v_mov_b32 v78, 0
  v_mov_b32 v79, 0
  s_mov_b32 s22, 75694080
  v_lshrrev_b32 v14, 4, v2
  v_add_u32 v14, 0, v14
  v_min_u32 v14, 308, v14
  v_lshlrev_b32 v14, 7, v14
  buffer_load_dword v15, v14, s[8:11], s22 offen sc1
  v_lshrrev_b32 v14, 4, v2
  v_add_u32 v14, 256, v14
  v_min_u32 v14, 308, v14
  v_lshlrev_b32 v14, 7, v14
  buffer_load_dword v15, v14, s[8:11], s22 offen sc1
  buffer_load_dwordx4 v[80:83], v117, s[8:11], s24 offen offset:0 sc1
  buffer_load_dwordx4 v[84:87], v117, s[8:11], s24 offen offset:1024 sc1
  buffer_load_dwordx4 v[88:91], v117, s[8:11], s26 offen offset:0 sc1
  buffer_load_dwordx4 v[92:95], v117, s[8:11], s26 offen offset:1024 sc1
  buffer_load_dwordx4 v[96:99], v2, s[8:11], s24 offen offset:0 sc1
  buffer_load_dwordx4 v[100:103], v2, s[8:11], s24 offen offset:1024 sc1
  buffer_load_dwordx4 v[104:107], v2, s[8:11], s26 offen offset:0 sc1
  buffer_load_dwordx4 v[108:111], v2, s[8:11], s26 offen offset:1024 sc1
  s_add_u32 s22, s31, 253952
  buffer_load_dwordx4 v[184:187], v2, s[8:11], s22 offen offset:0 sc1
  buffer_load_dwordx4 v[188:191], v2, s[8:11], s22 offen offset:1024 sc1
  buffer_load_dwordx4 v[192:195], v2, s[8:11], s22 offen offset:2048 sc1
  buffer_load_dwordx4 v[196:199], v2, s[8:11], s22 offen offset:3072 sc1
  s_add_u32 s22, s31, 372736
  buffer_load_dwordx4 v[200:203], v2, s[8:11], s22 offen offset:0 sc1
  buffer_load_dwordx4 v[204:207], v2, s[8:11], s22 offen offset:1024 sc1
  buffer_load_dwordx4 v[208:211], v2, s[8:11], s22 offen offset:2048 sc1
  buffer_load_dwordx4 v[212:215], v2, s[8:11], s22 offen offset:3072 sc1
  s_add_u32 s22, s31, 376832
  buffer_load_dwordx4 v[216:219], v2, s[8:11], s22 offen offset:0 sc1
  buffer_load_dwordx4 v[220:223], v2, s[8:11], s22 offen offset:1024 sc1
  buffer_load_dwordx4 v[224:227], v2, s[8:11], s22 offen offset:2048 sc1
  buffer_load_dwordx4 v[228:231], v2, s[8:11], s22 offen offset:3072 sc1
  s_add_u32 s22, s31, 380928
  buffer_load_dwordx4 v[232:235], v2, s[8:11], s22 offen offset:0 sc1
  buffer_load_dwordx4 v[236:239], v2, s[8:11], s22 offen offset:1024 sc1
  buffer_load_dwordx4 v[240:243], v2, s[8:11], s22 offen offset:2048 sc1
  buffer_load_dwordx4 v[244:247], v2, s[8:11], s22 offen offset:3072 sc1
  s_add_u32 s22, s31, 385024
  buffer_load_dwordx4 v[248:251], v2, s[8:11], s22 offen offset:0 sc1
  buffer_load_dwordx4 v[252:255], v2, s[8:11], s22 offen offset:1024 sc1
  s_waitcnt vmcnt(0) lgkmcnt(0)
  s_mov_b32 s31, 0
  s_cmp_lg_u32 s88, 0
  s_cbranch_scc1 cB_sc0_loop
  s_branch cA_sc0_loop
ch_init1:
  s_mul_i32 s31, s17, 401408
  s_add_u32 s31, s31, 0
  s_and_b32 s28, s84, 10320
  s_lshl_b32 s22, s85, 16
  s_or_b32 s28, s28, s22
  s_cmp_eq_u32 s28, 4294912080
  s_cbranch_scc1 ch_wx1_ok
  s_mov_b32 s30, 0
ch_wr1:
  buffer_load_dword v9, off, s[12:15], 0 offset:132 sc1
  s_waitcnt vmcnt(0)
  v_cmp_ne_u32 vcc, 1, v9
  s_cbranch_vccz ch_wr1_ok
  s_sleep 8
  s_add_u32 s30, s30, 1
  s_cmp_lt_u32 s30, 400000
  s_cbranch_scc1 ch_wr1
  s_branch cA_abort
ch_wr1_ok:
  s_lshl_b32 s27, s17, 7
  s_add_u32 s27, s27, 88521216
  s_mov_b32 s28, 10320
  s_mov_b32 s30, 0
ch_wb1:
  buffer_load_dword v9, off, s[8:11], s27  sc1
  s_waitcnt vmcnt(0)
  v_and_b32 v10, s28, v9
  v_cmp_ne_u32 vcc, s28, v10
  s_cbranch_vccz ch_wb1_ok
  s_sleep 3
  s_add_u32 s30, s30, 1
  s_cmp_lt_u32 s30, 400000
  s_cbranch_scc1 ch_wb1
  s_branch cA_abort
ch_wb1_ok:
  s_mov_b32 s29, 88523264
  s_mov_b32 s28, 0xffff
  s_mov_b32 s30, 0
ch_wx1:
  buffer_load_dword v9, off, s[8:11], s29  sc1
  s_waitcnt vmcnt(0)
  v_and_b32 v10, s28, v9
  v_cmp_ne_u32 vcc, s28, v10
  s_cbranch_vccz ch_wx1_ok
  s_sleep 8
  s_add_u32 s30, s30, 1
  s_cmp_lt_u32 s30, 400000
  s_cbranch_scc1 ch_wx1
  s_branch cA_abort
ch_wx1_ok:
  s_add_u32 s22, s31, 258048
  buffer_load_dwordx4 a[224:227], v2, s[8:11], s22 offen offset:0 sc1
  buffer_load_dwordx4 a[228:231], v2, s[8:11], s22 offen offset:1024 sc1
  buffer_load_dwordx4 a[232:235], v2, s[8:11], s22 offen offset:2048 sc1
  buffer_load_dwordx4 a[236:239], v2, s[8:11], s22 offen offset:3072 sc1
  s_add_u32 s22, s31, 262144
  buffer_load_dwordx4 a[240:243], v2, s[8:11], s22 offen offset:0 sc1
  buffer_load_dwordx4 a[244:247], v2, s[8:11], s22 offen offset:1024 sc1
  buffer_load_dwordx4 a[248:251], v2, s[8:11], s22 offen offset:2048 sc1
  buffer_load_dwordx4 a[252:255], v2, s[8:11], s22 offen offset:3072 sc1
  s_add_u32 s22, s31, 266240
  buffer_load_dwordx4 v[120:123], v2, s[8:11], s22 offen offset:0 sc1
  buffer_load_dwordx4 v[124:127], v2, s[8:11], s22 offen offset:1024 sc1
  buffer_load_dwordx4 v[128:131], v2, s[8:11], s22 offen offset:2048 sc1
  buffer_load_dwordx4 v[132:135], v2, s[8:11], s22 offen offset:3072 sc1
  s_add_u32 s22, s31, 270336
  buffer_load_dwordx4 v[136:139], v2, s[8:11], s22 offen offset:0 sc1
  buffer_load_dwordx4 v[140:143], v2, s[8:11], s22 offen offset:1024 sc1
  buffer_load_dwordx4 v[144:147], v2, s[8:11], s22 offen offset:2048 sc1
  buffer_load_dwordx4 v[148:151], v2, s[8:11], s22 offen offset:3072 sc1
  s_add_u32 s22, s31, 274432
  buffer_load_dwordx4 v[152:155], v2, s[8:11], s22 offen offset:0 sc1
  buffer_load_dwordx4 v[156:159], v2, s[8:11], s22 offen offset:1024 sc1
  buffer_load_dwordx4 v[160:163], v2, s[8:11], s22 offen offset:2048 sc1
  buffer_load_dwordx4 v[164:167], v2, s[8:11], s22 offen offset:3072 sc1
  s_add_u32 s22, s31, 278528
  buffer_load_dwordx4 v[168:171], v2, s[8:11], s22 offen offset:0 sc1
  buffer_load_dwordx4 v[172:175], v2, s[8:11], s22 offen offset:1024 sc1
  buffer_load_dwordx4 v[176:179], v2, s[8:11], s22 offen offset:2048 sc1
  buffer_load_dwordx4 v[180:183], v2, s[8:11], s22 offen offset:3072 sc1
  s_mov_b32 s24, 72026112
  s_mov_b32 s26, 72040448
  v_and_b32 v64, 7, v117
  v_and_b32 v65, 1, v116
  v_lshlrev_b32 v65, 2, v65
  v_sub_u32 v64, v64, v65
  v_lshrrev_b32 v65, 3, v117
  v_lshl_add_u32 v66, v65, 2, v64
  v_cmp_gt_u32 vcc, 4, v64
  v_mov_b32 v67, 99
  s_nop 0
  v_cndmask_b32 v66, v67, v66, vcc
  v_mov_b32 v68, 0x3f80
  v_mov_b32 v69, 0x3f800000
  v_mov_b32 v4, 0
  v_cmp_eq_u32 vcc, 0, v66
  s_nop 1
  v_cndmask_b32 v4, v4, v68, vcc
  v_cmp_eq_u32 vcc, 1, v66
  s_nop 1
  v_cndmask_b32 v4, v4, v69, vcc
  v_mov_b32 v5, 0
  v_cmp_eq_u32 vcc, 2, v66
  s_nop 1
  v_cndmask_b32 v5, v5, v68, vcc
  v_cmp_eq_u32 vcc, 3, v66
  s_nop 1
  v_cndmask_b32 v5, v5, v69, vcc
  v_mov_b32 v6, 0
  v_cmp_eq_u32 vcc, 4, v66
  s_nop 1
  v_cndmask_b32 v6, v6, v68, vcc
  v_cmp_eq_u32 vcc, 5, v66
  s_nop 1
  v_cndmask_b32 v6, v6, v69, vcc
  v_mov_b32 v7, 0
  v_cmp_eq_u32 vcc, 6, v66
  s_nop 1
  v_cndmask_b32 v7, v7, v68, vcc
  v_cmp_eq_u32 vcc, 7, v66
  s_nop 1
  v_cndmask_b32 v7, v7, v69, vcc
  v_lshrrev_b32 v64, 1, v116
  v_lshrrev_b32 v65, 3, v117
  v_and_b32 v66, 1, v116
  v_and_b32 v68, 7, v117
  v_lshlrev_b32 v67, 8, v65
  v_lshl_add_u32 v67, v68, 5, v67
  v_lshl_add_u32 v67, v66, 4, v67
  v_add_u32 v69, 4608, v67
  v_add_u32 v70, 6400, v67
  v_cmp_eq_u32 vcc, v64, v65
  s_nop 1
  v_cndmask_b32 v113, v70, v69, vcc
  v_and_b32 v74, 3, v117
  v_lshlrev_b32 v74, 1, v74
  v_bfe_u32 v75, v117, 2, 1
  v_or_b32 v74, v74, v75
  v_and_b32 v75, 8, v117
  v_or_b32 v74, v74, v75
  v_lshlrev_b32 v67, 9, v64
  v_lshl_add_u32 v67, v74, 4, v67
  v_lshl_add_u32 v67, v66, 3, v67
  v_add_u32 v114, 256, v67
  v_mul_u32_u24 v67, 1088, v65
  v_lshl_add_u32 v67, v116, 5, v67
  v_and_b32 v75, 1, v117
  v_and_b32 v76, 2, v117
  v_lshl_add_u32 v75, v76, 1, v75
  v_bfe_u32 v76, v117, 2, 1
  v_lshl_add_u32 v75, v76, 1, v75
  v_lshl_add_u32 v67, v75, 2, v67
  v_add_u32 v115, 4224, v67
  v_and_b32 v69, 1, v74
  v_lshlrev_b32 v67, 7, v69
  v_lshl_add_u32 v67, v116, 4, v67
  v_lshl_add_u32 v67, v65, 8, v67
  v_bfe_u32 v69, v74, 1, 2
  v_lshl_add_u32 v67, v69, 2, v67
  s_lshl_b32 s22, s17, 9
  s_add_u32 s22, s22, 9280
  v_add_u32 v72, s22, v67
  v_bfe_u32 v69, v75, 1, 1
  v_lshlrev_b32 v67, 7, v69
  v_lshl_add_u32 v67, v116, 4, v67
  v_and_b32 v69, 4, v75
  v_add_u32 v67, v67, v69
  s_lshr_b32 s22, s17, 1
  s_lshl_b32 s22, s22, 8
  s_and_b32 s27, s17, 1
  s_lshl_b32 s27, s27, 3
  s_add_u32 s22, s22, s27
  s_add_u32 s22, s22, 7232
  v_add_u32 v67, s22, v67
  v_and_b32 v69, 9, v117
  v_mov_b32 v70, 0x40000000
  v_cmp_eq_u32 vcc, 0, v69
  s_nop 1
  v_cndmask_b32 v118, v70, v67, vcc
  v_mov_b32 v119, -1
  s_lshl_b32 s22, s17, 2
  s_add_u32 s22, s22, 75729408
  v_lshl_add_u32 v67, v1, 7, s22
  v_mov_b32 v70, 0x40000000
  v_cmp_gt_u32 vcc, 1, v1
  s_nop 1
  v_cndmask_b32 v73, v70, v67, vcc
  v_mov_b32 v112, 1
  v_and_b32 v0, 15, v1
  s_and_b32 s22, s17, 0
  s_lshl_b32 s22, s22, 7
  s_add_u32 s22, s22, 75731456
  v_lshl_add_u32 v0, v0, 2, s22
  v_xor_b32 v69, 256, v2
  v_mul_i32_i24 v70, 4096, v66
  v_add_u32 v69, v69, v70
  v_add_u32 v117, 6144, v69
  v_mov_b32 v116, v73
  s_mul_i32 s35, s17, 28672
  s_add_u32 s35, s35, 44040192
  v_mov_b32 v1, v72
  v_mov_b32 v36, 0
  v_mov_b32 v37, 0
  v_mov_b32 v38, 0
  v_mov_b32 v39, 0
  v_mov_b32 v40, 0
  v_mov_b32 v41, 0
  v_mov_b32 v42, 0
  v_mov_b32 v43, 0
  v_mov_b32 v44, 0
  v_mov_b32 v45, 0
  v_mov_b32 v46, 0
  v_mov_b32 v47, 0
  v_mov_b32 v48, 0
  v_mov_b32 v49, 0
  v_mov_b32 v50, 0
  v_mov_b32 v51, 0
  v_mov_b32 v52, 0
  v_mov_b32 v53, 0
  v_mov_b32 v54, 0
  v_mov_b32 v55, 0
  v_mov_b32 v56, 0
  v_mov_b32 v57, 0
  v_mov_b32 v58, 0
  v_mov_b32 v59, 0
  v_mov_b32 v60, 0
  v_mov_b32 v61, 0
  v_mov_b32 v62, 0
  v_mov_b32 v63, 0
  v_mov_b32 v64, 0
  v_mov_b32 v65, 0
  v_mov_b32 v66, 0
  v_mov_b32 v67, 0
  v_mov_b32 v68, 0
  v_mov_b32 v69, 0
  v_mov_b32 v70, 0
  v_mov_b32 v71, 0
  v_mov_b32 v72, 0
  v_mov_b32 v73, 0
  v_mov_b32 v74, 0
  v_mov_b32 v75, 0
  v_mov_b32 v76, 0
  v_mov_b32 v77, 0
  v_mov_b32 v78, 0
  v_mov_b32 v79, 0
  s_mov_b32 s22, 75694080
  v_lshrrev_b32 v14, 4, v2
  v_add_u32 v14, 64, v14
  v_min_u32 v14, 308, v14
  v_lshlrev_b32 v14, 7, v14
  buffer_load_dword v15, v14, s[8:11], s22 offen sc1
  buffer_load_dwordx4 v[80:83], v117, s[8:11], s24 offen offset:0 sc1
  buffer_load_dwordx4 v[84:87], v117, s[8:11], s24 offen offset:1024 sc1
  buffer_load_dwordx4 v[88:91], v117, s[8:11], s26 offen offset:0 sc1
  buffer_load_dwordx4 v[92:95], v117, s[8:11], s26 offen offset:1024 sc1
  buffer_load_dwordx4 v[96:99], v2, s[8:11], s24 offen offset:0 sc1
  buffer_load_dwordx4 v[100:103], v2, s[8:11], s24 offen offset:1024 sc1
  buffer_load_dwordx4 v[104:107], v2, s[8:11], s26 offen offset:0 sc1
  buffer_load_dwordx4 v[108:111], v2, s[8:11], s26 offen offset:1024 sc1
  s_add_u32 s22, s31, 282624
  buffer_load_dwordx4 v[184:187], v2, s[8:11], s22 offen offset:0 sc1
  buffer_load_dwordx4 v[188:191], v2, s[8:11], s22 offen offset:1024 sc1
  buffer_load_dwordx4 v[192:195], v2, s[8:11], s22 offen offset:2048 sc1
  buffer_load_dwordx4 v[196:199], v2, s[8:11], s22 offen offset:3072 sc1
  s_add_u32 s22, s31, 344064
  buffer_load_dwordx4 v[200:203], v2, s[8:11], s22 offen offset:0 sc1
  buffer_load_dwordx4 v[204:207], v2, s[8:11], s22 offen offset:1024 sc1
  buffer_load_dwordx4 v[208:211], v2, s[8:11], s22 offen offset:2048 sc1
  buffer_load_dwordx4 v[212:215], v2, s[8:11], s22 offen offset:3072 sc1
  s_add_u32 s22, s31, 348160
  buffer_load_dwordx4 v[216:219], v2, s[8:11], s22 offen offset:0 sc1
  buffer_load_dwordx4 v[220:223], v2, s[8:11], s22 offen offset:1024 sc1
  buffer_load_dwordx4 v[224:227], v2, s[8:11], s22 offen offset:2048 sc1
  buffer_load_dwordx4 v[228:231], v2, s[8:11], s22 offen offset:3072 sc1
  s_add_u32 s22, s31, 352256
  buffer_load_dwordx4 v[232:235], v2, s[8:11], s22 offen offset:0 sc1
  buffer_load_dwordx4 v[236:239], v2, s[8:11], s22 offen offset:1024 sc1
  buffer_load_dwordx4 v[240:243], v2, s[8:11], s22 offen offset:2048 sc1
  buffer_load_dwordx4 v[244:247], v2, s[8:11], s22 offen offset:3072 sc1
  s_add_u32 s22, s31, 356352
  buffer_load_dwordx4 v[248:251], v2, s[8:11], s22 offen offset:0 sc1
  buffer_load_dwordx4 v[252:255], v2, s[8:11], s22 offen offset:1024 sc1
  s_waitcnt vmcnt(0) lgkmcnt(0)
  s_mov_b32 s31, 0
  s_cmp_lg_u32 s88, 0
  s_cbranch_scc1 cB_sc1_loop
  s_branch cA_sc1_loop
ch_init2:
  s_mul_i32 s31, s17, 401408
  s_add_u32 s31, s31, 0
  s_and_b32 s28, s84, 12384
  s_lshl_b32 s22, s85, 16
  s_or_b32 s28, s28, s22
  s_cmp_eq_u32 s28, 4294914144
  s_cbranch_scc1 ch_wx2_ok
  s_mov_b32 s30, 0
ch_wr2:
  buffer_load_dword v9, off, s[12:15], 0 offset:132 sc1
  s_waitcnt vmcnt(0)
  v_cmp_ne_u32 vcc, 1, v9
  s_cbranch_vccz ch_wr2_ok
  s_sleep 8
  s_add_u32 s30, s30, 1
  s_cmp_lt_u32 s30, 400000
  s_cbranch_scc1 ch_wr2
  s_branch cA_abort
ch_wr2_ok:
  s_lshl_b32 s27, s17, 7
  s_add_u32 s27, s27, 88521216
  s_mov_b32 s28, 12384
  s_mov_b32 s30, 0
ch_wb2:
  buffer_load_dword v9, off, s[8:11], s27  sc1
  s_waitcnt vmcnt(0)
  v_and_b32 v10, s28, v9
  v_cmp_ne_u32 vcc, s28, v10
  s_cbranch_vccz ch_wb2_ok
  s_sleep 3
  s_add_u32 s30, s30, 1
  s_cmp_lt_u32 s30, 400000
  s_cbranch_scc1 ch_wb2
  s_branch cA_abort
ch_wb2_ok:
  s_mov_b32 s29, 88523264
  s_mov_b32 s28, 0xffff
  s_mov_b32 s30, 0
ch_wx2:
  buffer_load_dword v9, off, s[8:11], s29  sc1
  s_waitcnt vmcnt(0)
  v_and_b32 v10, s28, v9
  v_cmp_ne_u32 vcc, s28, v10
  s_cbranch_vccz ch_wx2_ok
  s_sleep 8
  s_add_u32 s30, s30, 1
  s_cmp_lt_u32 s30, 400000
  s_cbranch_scc1 ch_wx2
  s_branch cA_abort
ch_wx2_ok:
  s_add_u32 s22, s31, 286720
  buffer_load_dwordx4 a[224:227], v2, s[8:11], s22 offen offset:0 sc1
  buffer_load_dwordx4 a[228:231], v2, s[8:11], s22 offen offset:1024 sc1
  buffer_load_dwordx4 a[232:235], v2, s[8:11], s22 offen offset:2048 sc1
  buffer_load_dwordx4 a[236:239], v2, s[8:11], s22 offen offset:3072 sc1
  s_add_u32 s22, s31, 290816
  buffer_load_dwordx4 a[240:243], v2, s[8:11], s22 offen offset:0 sc1
  buffer_load_dwordx4 a[244:247], v2, s[8:11], s22 offen offset:1024 sc1
  buffer_load_dwordx4 a[248:251], v2, s[8:11], s22 offen offset:2048 sc1
  buffer_load_dwordx4 a[252:255], v2, s[8:11], s22 offen offset:3072 sc1
  s_add_u32 s22, s31, 294912
  buffer_load_dwordx4 v[120:123], v2, s[8:11], s22 offen offset:0 sc1
  buffer_load_dwordx4 v[124:127], v2, s[8:11], s22 offen offset:1024 sc1
  buffer_load_dwordx4 v[128:131], v2, s[8:11], s22 offen offset:2048 sc1
  buffer_load_dwordx4 v[132:135], v2, s[8:11], s22 offen offset:3072 sc1
  s_add_u32 s22, s31, 299008
  buffer_load_dwordx4 v[136:139], v2, s[8:11], s22 offen offset:0 sc1
  buffer_load_dwordx4 v[140:143], v2, s[8:11], s22 offen offset:1024 sc1
  buffer_load_dwordx4 v[144:147], v2, s[8:11], s22 offen offset:2048 sc1
  buffer_load_dwordx4 v[148:151], v2, s[8:11], s22 offen offset:3072 sc1
  s_add_u32 s22, s31, 303104
  buffer_load_dwordx4 v[152:155], v2, s[8:11], s22 offen offset:0 sc1
  buffer_load_dwordx4 v[156:159], v2, s[8:11], s22 offen offset:1024 sc1
  buffer_load_dwordx4 v[160:163], v2, s[8:11], s22 offen offset:2048 sc1
  buffer_load_dwordx4 v[164:167], v2, s[8:11], s22 offen offset:3072 sc1
  s_add_u32 s22, s31, 307200
  buffer_load_dwordx4 v[168:171], v2, s[8:11], s22 offen offset:0 sc1
  buffer_load_dwordx4 v[172:175], v2, s[8:11], s22 offen offset:1024 sc1
  buffer_load_dwordx4 v[176:179], v2, s[8:11], s22 offen offset:2048 sc1
  buffer_load_dwordx4 v[180:183], v2, s[8:11], s22 offen offset:3072 sc1
  s_mov_b32 s24, 72028160
  s_mov_b32 s26, 72042496
  v_and_b32 v64, 7, v117
  v_and_b32 v65, 1, v116
  v_lshlrev_b32 v65, 2, v65
  v_sub_u32 v64, v64, v65
  v_lshrrev_b32 v65, 3, v117
  v_lshl_add_u32 v66, v65, 2, v64
  v_cmp_gt_u32 vcc, 4, v64
  v_mov_b32 v67, 99
  s_nop 0
  v_cndmask_b32 v66, v67, v66, vcc
  v_mov_b32 v68, 0x3f80
  v_mov_b32 v69, 0x3f800000
  v_mov_b32 v4, 0
  v_cmp_eq_u32 vcc, 0, v66
  s_nop 1
  v_cndmask_b32 v4, v4, v68, vcc
  v_cmp_eq_u32 vcc, 1, v66
  s_nop 1
  v_cndmask_b32 v4, v4, v69, vcc
  v_mov_b32 v5, 0
  v_cmp_eq_u32 vcc, 2, v66
  s_nop 1
  v_cndmask_b32 v5, v5, v68, vcc
  v_cmp_eq_u32 vcc, 3, v66
  s_nop 1
  v_cndmask_b32 v5, v5, v69, vcc
  v_mov_b32 v6, 0
  v_cmp_eq_u32 vcc, 4, v66
  s_nop 1
  v_cndmask_b32 v6, v6, v68, vcc
  v_cmp_eq_u32 vcc, 5, v66
  s_nop 1
  v_cndmask_b32 v6, v6, v69, vcc
  v_mov_b32 v7, 0
  v_cmp_eq_u32 vcc, 6, v66
  s_nop 1
  v_cndmask_b32 v7, v7, v68, vcc
  v_cmp_eq_u32 vcc, 7, v66
  s_nop 1
  v_cndmask_b32 v7, v7, v69, vcc
  v_lshrrev_b32 v64, 1, v116
  v_lshrrev_b32 v65, 3, v117
  v_and_b32 v66, 1, v116
  v_and_b32 v68, 7, v117
  v_lshlrev_b32 v67, 8, v65
  v_lshl_add_u32 v67, v68, 5, v67
  v_lshl_add_u32 v67, v66, 4, v67
  v_add_u32 v69, 5184, v67
  v_add_u32 v70, 6400, v67
  v_cmp_eq_u32 vcc, v64, v65
  s_nop 1
  v_cndmask_b32 v113, v70, v69, vcc
  s_lshl_b32 s22, s17, 9
  s_add_u32 s22, s22, 9216
  v_lshl_add_u32 v114, v1, 3, s22
  s_lshr_b32 s22, s17, 1
  s_lshl_b32 s22, s22, 8
  s_and_b32 s27, s17, 1
  s_lshl_b32 s27, s27, 3
  s_add_u32 s22, s22, s27
  s_add_u32 s22, s22, 7168
  v_add_u32 v115, s22, v2
  v_mov_b32 v70, 0x40000000
  v_cmp_gt_u32 vcc, 16, v1
  s_nop 1
  v_cndmask_b32 v115, v70, v115, vcc
  v_mov_b32 v118, -1
  v_mov_b32 v119, -1
  v_and_b32 v0, 15, v1
  s_and_b32 s22, s17, 0
  s_lshl_b32 s22, s22, 7
  s_add_u32 s22, s22, 75731456
  v_lshl_add_u32 v0, v0, 2, s22
  v_xor_b32 v69, 256, v2
  v_mul_i32_i24 v70, -2048, v66
  v_add_u32 v69, v69, v70
  v_add_u32 v117, 8192, v69
  v_mov_b32 v116, v73
  s_mul_i32 s35, s17, 28672
  s_add_u32 s35, s35, 44040192
  v_mov_b32 v36, 0
  v_mov_b32 v37, 0
  v_mov_b32 v38, 0
  v_mov_b32 v39, 0
  v_mov_b32 v40, 0
  v_mov_b32 v41, 0
  v_mov_b32 v42, 0
  v_mov_b32 v43, 0
  v_mov_b32 v44, 0
  v_mov_b32 v45, 0
  v_mov_b32 v46, 0
  v_mov_b32 v47, 0
  v_mov_b32 v48, 0
  v_mov_b32 v49, 0
  v_mov_b32 v50, 0
  v_mov_b32 v51, 0
  v_mov_b32 v52, 0
  v_mov_b32 v53, 0
  v_mov_b32 v54, 0
  v_mov_b32 v55, 0
  v_mov_b32 v56, 0
  v_mov_b32 v57, 0
  v_mov_b32 v58, 0
  v_mov_b32 v59, 0
  v_mov_b32 v60, 0
  v_mov_b32 v61, 0
  v_mov_b32 v62, 0
  v_mov_b32 v63, 0
  v_mov_b32 v64, 0
  v_mov_b32 v65, 0
  v_mov_b32 v66, 0
  v_mov_b32 v67, 0
  v_mov_b32 v68, 0
  v_mov_b32 v69, 0
  v_mov_b32 v70, 0
  v_mov_b32 v71, 0
  v_mov_b32 v72, 0
  v_mov_b32 v73, 0
  v_mov_b32 v74, 0
  v_mov_b32 v75, 0
  v_mov_b32 v76, 0
  v_mov_b32 v77, 0
  v_mov_b32 v78, 0
  v_mov_b32 v79, 0
  s_mov_b32 s22, 75694080
  v_lshrrev_b32 v14, 4, v2
  v_add_u32 v14, 128, v14
  v_min_u32 v14, 308, v14
  v_lshlrev_b32 v14, 7, v14
  buffer_load_dword v15, v14, s[8:11], s22 offen sc1
  buffer_load_dwordx4 v[80:83], v117, s[8:11], s24 offen offset:0 sc1
  buffer_load_dwordx4 v[84:87], v117, s[8:11], s24 offen offset:1024 sc1
  buffer_load_dwordx4 v[88:91], v117, s[8:11], s26 offen offset:0 sc1
  buffer_load_dwordx4 v[92:95], v117, s[8:11], s26 offen offset:1024 sc1
  buffer_load_dwordx4 v[96:99], v2, s[8:11], s24 offen offset:0 sc1
  buffer_load_dwordx4 v[100:103], v2, s[8:11], s24 offen offset:1024 sc1
  buffer_load_dwordx4 v[104:107], v2, s[8:11], s26 offen offset:0 sc1
  buffer_load_dwordx4 v[108:111], v2, s[8:11], s26 offen offset:1024 sc1
  s_add_u32 s22, s31, 311296
  buffer_load_dwordx4 v[184:187], v2, s[8:11], s22 offen offset:0 sc1
  buffer_load_dwordx4 v[188:191], v2, s[8:11], s22 offen offset:1024 sc1
  buffer_load_dwordx4 v[192:195], v2, s[8:11], s22 offen offset:2048 sc1
  buffer_load_dwordx4 v[196:199], v2, s[8:11], s22 offen offset:3072 sc1
  s_add_u32 s22, s31, 385024
  buffer_load_dwordx4 v[200:203], v2, s[8:11], s22 offen offset:2048 sc1
  buffer_load_dwordx4 v[204:207], v2, s[8:11], s22 offen offset:3072 sc1
  s_add_u32 s22, s31, 389120
  buffer_load_dwordx4 v[208:211], v2, s[8:11], s22 offen offset:0 sc1
  buffer_load_dwordx4 v[212:215], v2, s[8:11], s22 offen offset:1024 sc1
  buffer_load_dwordx4 v[216:219], v2, s[8:11], s22 offen offset:2048 sc1
  buffer_load_dwordx4 v[220:223], v2, s[8:11], s22 offen offset:3072 sc1
  s_add_u32 s22, s31, 393216
  buffer_load_dwordx4 v[224:227], v2, s[8:11], s22 offen offset:0 sc1
  buffer_load_dwordx4 v[228:231], v2, s[8:11], s22 offen offset:1024 sc1
  buffer_load_dwordx4 v[232:235], v2, s[8:11], s22 offen offset:2048 sc1
  buffer_load_dwordx4 v[236:239], v2, s[8:11], s22 offen offset:3072 sc1
  s_add_u32 s22, s31, 397312
  buffer_load_dwordx4 v[240:243], v2, s[8:11], s22 offen offset:0 sc1
  buffer_load_dwordx4 v[244:247], v2, s[8:11], s22 offen offset:1024 sc1
  buffer_load_dwordx4 v[248:251], v2, s[8:11], s22 offen offset:2048 sc1
  buffer_load_dwordx4 v[252:255], v2, s[8:11], s22 offen offset:3072 sc1
  s_waitcnt vmcnt(0) lgkmcnt(0)
  s_mov_b32 s31, 0
  s_cmp_lg_u32 s88, 0
  s_cbranch_scc1 cB_sc2_loop
  s_branch cA_sc2_loop
ch_init3:
  s_mul_i32 s31, s17, 401408
  s_add_u32 s31, s31, 0
  s_and_b32 s28, s84, 12384
  s_lshl_b32 s22, s85, 16
  s_or_b32 s28, s28, s22
  s_cmp_eq_u32 s28, 4294914144
  s_cbranch_scc1 ch_wx3_ok
  s_mov_b32 s30, 0
ch_wr3:
  buffer_load_dword v9, off, s[12:15], 0 offset:132 sc1
  s_waitcnt vmcnt(0)
  v_cmp_ne_u32 vcc, 1, v9
  s_cbranch_vccz ch_wr3_ok
  s_sleep 8
  s_add_u32 s30, s30, 1
  s_cmp_lt_u32 s30, 400000
  s_cbranch_scc1 ch_wr3
  s_branch cA_abort
ch_wr3_ok:
  s_lshl_b32 s27, s17, 7
  s_add_u32 s27, s27, 88521216
  s_mov_b32 s28, 12384
  s_mov_b32 s30, 0
ch_wb3:
  buffer_load_dword v9, off, s[8:11], s27  sc1
  s_waitcnt vmcnt(0)
  v_and_b32 v10, s28, v9
  v_cmp_ne_u32 vcc, s28, v10
  s_cbranch_vccz ch_wb3_ok
  s_sleep 3
  s_add_u32 s30, s30, 1
  s_cmp_lt_u32 s30, 400000
  s_cbranch_scc1 ch_wb3
  s_branch cA_abort
ch_wb3_ok:
  s_mov_b32 s29, 88523264
  s_mov_b32 s28, 0xffff
  s_mov_b32 s30, 0
ch_wx3:
  buffer_load_dword v9, off, s[8:11], s29  sc1
  s_waitcnt vmcnt(0)
  v_and_b32 v10, s28, v9
  v_cmp_ne_u32 vcc, s28, v10
  s_cbranch_vccz ch_wx3_ok
  s_sleep 8
  s_add_u32 s30, s30, 1
  s_cmp_lt_u32 s30, 400000
  s_cbranch_scc1 ch_wx3
  s_branch cA_abort
ch_wx3_ok:
  s_add_u32 s22, s31, 315392
  buffer_load_dwordx4 a[224:227], v2, s[8:11], s22 offen offset:0 sc1
  buffer_load_dwordx4 a[228:231], v2, s[8:11], s22 offen offset:1024 sc1
  buffer_load_dwordx4 a[232:235], v2, s[8:11], s22 offen offset:2048 sc1
  buffer_load_dwordx4 a[236:239], v2, s[8:11], s22 offen offset:3072 sc1
  s_add_u32 s22, s31, 319488
  buffer_load_dwordx4 a[240:243], v2, s[8:11], s22 offen offset:0 sc1
  buffer_load_dwordx4 a[244:247], v2, s[8:11], s22 offen offset:1024 sc1
  buffer_load_dwordx4 a[248:251], v2, s[8:11], s22 offen offset:2048 sc1
  buffer_load_dwordx4 a[252:255], v2, s[8:11], s22 offen offset:3072 sc1
  s_add_u32 s22, s31, 323584
  buffer_load_dwordx4 v[120:123], v2, s[8:11], s22 offen offset:0 sc1
  buffer_load_dwordx4 v[124:127], v2, s[8:11], s22 offen offset:1024 sc1
  buffer_load_dwordx4 v[128:131], v2, s[8:11], s22 offen offset:2048 sc1
  buffer_load_dwordx4 v[132:135], v2, s[8:11], s22 offen offset:3072 sc1
  s_add_u32 s22, s31, 327680
  buffer_load_dwordx4 v[136:139], v2, s[8:11], s22 offen offset:0 sc1
  buffer_load_dwordx4 v[140:143], v2, s[8:11], s22 offen offset:1024 sc1
  buffer_load_dwordx4 v[144:147], v2, s[8:11], s22 offen offset:2048 sc1
  buffer_load_dwordx4 v[148:151], v2, s[8:11], s22 offen offset:3072 sc1
  s_add_u32 s22, s31, 331776
  buffer_load_dwordx4 v[152:155], v2, s[8:11], s22 offen offset:0 sc1
  buffer_load_dwordx4 v[156:159], v2, s[8:11], s22 offen offset:1024 sc1
  buffer_load_dwordx4 v[160:163], v2, s[8:11], s22 offen offset:2048 sc1
  buffer_load_dwordx4 v[164:167], v2, s[8:11], s22 offen offset:3072 sc1
  s_add_u32 s22, s31, 335872
  buffer_load_dwordx4 v[168:171], v2, s[8:11], s22 offen offset:0 sc1
  buffer_load_dwordx4 v[172:175], v2, s[8:11], s22 offen offset:1024 sc1
  buffer_load_dwordx4 v[176:179], v2, s[8:11], s22 offen offset:2048 sc1
  buffer_load_dwordx4 v[180:183], v2, s[8:11], s22 offen offset:3072 sc1
  s_mov_b32 s24, 72030208
  s_mov_b32 s26, 72044544
  v_and_b32 v64, 7, v117
  v_and_b32 v65, 1, v116
  v_lshlrev_b32 v65, 2, v65
  v_sub_u32 v64, v64, v65
  v_lshrrev_b32 v65, 3, v117
  v_lshl_add_u32 v66, v65, 2, v64
  v_cmp_gt_u32 vcc, 4, v64
  v_mov_b32 v67, 99
  s_nop 0
  v_cndmask_b32 v66, v67, v66, vcc
  v_mov_b32 v68, 0x3f80
  v_mov_b32 v69, 0x3f800000
  v_mov_b32 v4, 0
  v_cmp_eq_u32 vcc, 0, v66
  s_nop 1
  v_cndmask_b32 v4, v4, v68, vcc
  v_cmp_eq_u32 vcc, 1, v66
  s_nop 1
  v_cndmask_b32 v4, v4, v69, vcc
  v_mov_b32 v5, 0
  v_cmp_eq_u32 vcc, 2, v66
  s_nop 1
  v_cndmask_b32 v5, v5, v68, vcc
  v_cmp_eq_u32 vcc, 3, v66
  s_nop 1
  v_cndmask_b32 v5, v5, v69, vcc
  v_mov_b32 v6, 0
  v_cmp_eq_u32 vcc, 4, v66
  s_nop 1
  v_cndmask_b32 v6, v6, v68, vcc
  v_cmp_eq_u32 vcc, 5, v66
  s_nop 1
  v_cndmask_b32 v6, v6, v69, vcc
  v_mov_b32 v7, 0
  v_cmp_eq_u32 vcc, 6, v66
  s_nop 1
  v_cndmask_b32 v7, v7, v68, vcc
  v_cmp_eq_u32 vcc, 7, v66
  s_nop 1
  v_cndmask_b32 v7, v7, v69, vcc
  v_lshrrev_b32 v64, 1, v116
  v_lshrrev_b32 v65, 3, v117
  v_and_b32 v66, 1, v116
  v_and_b32 v68, 7, v117
  v_lshlrev_b32 v67, 8, v65
  v_lshl_add_u32 v67, v68, 5, v67
  v_lshl_add_u32 v67, v66, 4, v67
  v_add_u32 v69, 5696, v67
  v_add_u32 v70, 6400, v67
  v_cmp_eq_u32 vcc, v64, v65
  s_nop 1
  v_cndmask_b32 v113, v70, v69, vcc
  v_and_b32 v0, 15, v1
  s_and_b32 s22, s17, 0
  s_lshl_b32 s22, s22, 7
  s_add_u32 s22, s22, 75731456
  v_lshl_add_u32 v0, v0, 2, s22
  v_xor_b32 v69, 256, v2
  v_mul_i32_i24 v70, 2048, v66
  v_add_u32 v69, v69, v70
  v_add_u32 v117, 4096, v69
  v_mov_b32 v116, v73
  s_mul_i32 s35, s17, 28672
  s_add_u32 s35, s35, 44040192
  v_mov_b32 v36, 0
  v_mov_b32 v37, 0
  v_mov_b32 v38, 0
  v_mov_b32 v39, 0
  v_mov_b32 v40, 0
  v_mov_b32 v41, 0
  v_mov_b32 v42, 0
  v_mov_b32 v43, 0
  v_mov_b32 v44, 0
  v_mov_b32 v45, 0
  v_mov_b32 v46, 0
  v_mov_b32 v47, 0
  v_mov_b32 v48, 0
  v_mov_b32 v49, 0
  v_mov_b32 v50, 0
  v_mov_b32 v51, 0
  v_mov_b32 v52, 0
  v_mov_b32 v53, 0
  v_mov_b32 v54, 0
  v_mov_b32 v55, 0
  v_mov_b32 v56, 0
  v_mov_b32 v57, 0
  v_mov_b32 v58, 0
  v_mov_b32 v59, 0
  v_mov_b32 v60, 0
  v_mov_b32 v61, 0
  v_mov_b32 v62, 0
  v_mov_b32 v63, 0
  v_mov_b32 v64, 0
  v_mov_b32 v65, 0
  v_mov_b32 v66, 0
  v_mov_b32 v67, 0
  v_mov_b32 v68, 0
  v_mov_b32 v69, 0
  v_mov_b32 v70, 0
  v_mov_b32 v71, 0
  v_mov_b32 v72, 0
  v_mov_b32 v73, 0
  v_mov_b32 v74, 0
  v_mov_b32 v75, 0
  v_mov_b32 v76, 0
  v_mov_b32 v77, 0
  v_mov_b32 v78, 0
  v_mov_b32 v79, 0
  s_mov_b32 s22, 75694080
  v_lshrrev_b32 v14, 4, v2
  v_add_u32 v14, 192, v14
  v_min_u32 v14, 308, v14
  v_lshlrev_b32 v14, 7, v14
  buffer_load_dword v15, v14, s[8:11], s22 offen sc1
  buffer_load_dwordx4 v[80:83], v117, s[8:11], s24 offen offset:0 sc1
  buffer_load_dwordx4 v[84:87], v117, s[8:11], s24 offen offset:1024 sc1
  buffer_load_dwordx4 v[88:91], v117, s[8:11], s26 offen offset:0 sc1
  buffer_load_dwordx4 v[92:95], v117, s[8:11], s26 offen offset:1024 sc1
  buffer_load_dwordx4 v[96:99], v2, s[8:11], s24 offen offset:0 sc1
  buffer_load_dwordx4 v[100:103], v2, s[8:11], s24 offen offset:1024 sc1
  buffer_load_dwordx4 v[104:107], v2, s[8:11], s26 offen offset:0 sc1
  buffer_load_dwordx4 v[108:111], v2, s[8:11], s26 offen offset:1024 sc1
  s_add_u32 s22, s31, 339968
  buffer_load_dwordx4 v[184:187], v2, s[8:11], s22 offen offset:0 sc1
  buffer_load_dwordx4 v[188:191], v2, s[8:11], s22 offen offset:1024 sc1
  buffer_load_dwordx4 v[192:195], v2, s[8:11], s22 offen offset:2048 sc1
  buffer_load_dwordx4 v[196:199], v2, s[8:11], s22 offen offset:3072 sc1
  s_add_u32 s22, s31, 356352
  buffer_load_dwordx4 v[200:203], v2, s[8:11], s22 offen offset:2048 sc1
  buffer_load_dwordx4 v[204:207], v2, s[8:11], s22 offen offset:3072 sc1
  s_add_u32 s22, s31, 360448
  buffer_load_dwordx4 v[208:211], v2, s[8:11], s22 offen offset:0 sc1
  buffer_load_dwordx4 v[212:215], v2, s[8:11], s22 offen offset:1024 sc1
  buffer_load_dwordx4 v[216:219], v2, s[8:11], s22 offen offset:2048 sc1
  buffer_load_dwordx4 v[220:223], v2, s[8:11], s22 offen offset:3072 sc1
  s_add_u32 s22, s31, 364544
  buffer_load_dwordx4 v[224:227], v2, s[8:11], s22 offen offset:0 sc1
  buffer_load_dwordx4 v[228:231], v2, s[8:11], s22 offen offset:1024 sc1
  buffer_load_dwordx4 v[232:235], v2, s[8:11], s22 offen offset:2048 sc1
  buffer_load_dwordx4 v[236:239], v2, s[8:11], s22 offen offset:3072 sc1
  s_add_u32 s22, s31, 368640
  buffer_load_dwordx4 v[240:243], v2, s[8:11], s22 offen offset:0 sc1
  buffer_load_dwordx4 v[244:247], v2, s[8:11], s22 offen offset:1024 sc1
  buffer_load_dwordx4 v[248:251], v2, s[8:11], s22 offen offset:2048 sc1
  buffer_load_dwordx4 v[252:255], v2, s[8:11], s22 offen offset:3072 sc1
  s_waitcnt vmcnt(0) lgkmcnt(0)
  s_mov_b32 s31, 0
  s_cmp_lg_u32 s88, 0
  s_cbranch_scc1 cB_sc3_loop
  s_branch cA_sc3_loop
ch_init4:
  v_mov_b32 v72, v116
  v_mov_b32 v73, v117
  v_lshrrev_b32 v65, 1, v72
  v_and_b32 v66, 1, v72
  v_mov_b32 v36, 0
  v_mov_b32 v37, 0
  v_mov_b32 v38, 0
  v_mov_b32 v39, 0
  v_mov_b32 v40, 0
  v_mov_b32 v41, 0
  v_mov_b32 v42, 0
  v_mov_b32 v43, 0
  v_mov_b32 v44, 0
  v_mov_b32 v45, 0
  v_mov_b32 v46, 0
  v_mov_b32 v47, 0
  v_mov_b32 v48, 0
  v_mov_b32 v49, 0
  v_mov_b32 v50, 0
  v_mov_b32 v51, 0
  v_mov_b32 v52, 0
  v_mov_b32 v53, 0
  v_mov_b32 v54, 0
  v_mov_b32 v55, 0
  v_mov_b32 v56, 0
  v_mov_b32 v57, 0
  v_mov_b32 v58, 0
  v_mov_b32 v59, 0
  v_mov_b32 v60, 0
  v_mov_b32 v61, 0
  v_mov_b32 v62, 0
  v_mov_b32 v63, 0
  v_lshlrev_b32 v75, 2, v65
  v_lshl_add_u32 v75, v66, 3, v75
  v_add_u32 v67, 0, v73
  v_mul_u32_u24 v68, 2341, v67
  v_lshrrev_b32 v68, 16, v68
  v_mul_u32_u24 v69, 28, v68
  v_sub_u32 v69, v67, v69
  v_lshrrev_b32 v70, 4, v69
  v_and_b32 v69, 15, v69
  v_lshlrev_b32 v71, 12, v70
  v_lshl_add_u32 v71, v68, 8, v71
  v_lshl_add_u32 v71, v69, 4, v71
  v_add_u32 v152, v71, v75
  v_add_u32 v67, 16, v73
  v_mul_u32_u24 v68, 2341, v67
  v_lshrrev_b32 v68, 16, v68
  v_mul_u32_u24 v69, 28, v68
  v_sub_u32 v69, v67, v69
  v_lshrrev_b32 v70, 4, v69
  v_and_b32 v69, 15, v69
  v_lshlrev_b32 v71, 12, v70
  v_lshl_add_u32 v71, v68, 8, v71
  v_lshl_add_u32 v71, v69, 4, v71
  v_add_u32 v153, v71, v75
  v_add_u32 v67, 32, v73
  v_mul_u32_u24 v68, 2341, v67
  v_lshrrev_b32 v68, 16, v68
  v_mul_u32_u24 v69, 28, v68
  v_sub_u32 v69, v67, v69
  v_lshrrev_b32 v70, 4, v69
  v_and_b32 v69, 15, v69
  v_lshlrev_b32 v71, 12, v70
  v_lshl_add_u32 v71, v68, 8, v71
  v_lshl_add_u32 v71, v69, 4, v71
  v_add_u32 v154, v71, v75
  v_add_u32 v67, 48, v73
  v_mul_u32_u24 v68, 2341, v67
  v_lshrrev_b32 v68, 16, v68
  v_mul_u32_u24 v69, 28, v68
  v_sub_u32 v69, v67, v69
  v_lshrrev_b32 v70, 4, v69
  v_and_b32 v69, 15, v69
  v_lshlrev_b32 v71, 12, v70
  v_lshl_add_u32 v71, v68, 8, v71
  v_lshl_add_u32 v71, v69, 4, v71
  v_add_u32 v155, v71, v75
  v_add_u32 v67, 64, v73
  v_mul_u32_u24 v68, 2341, v67
  v_lshrrev_b32 v68, 16, v68
  v_mul_u32_u24 v69, 28, v68
  v_sub_u32 v69, v67, v69
  v_lshrrev_b32 v70, 4, v69
  v_and_b32 v69, 15, v69
  v_lshlrev_b32 v71, 12, v70
  v_lshl_add_u32 v71, v68, 8, v71
  v_lshl_add_u32 v71, v69, 4, v71
  v_add_u32 v156, v71, v75
  v_add_u32 v67, 80, v73
  v_mul_u32_u24 v68, 2341, v67
  v_lshrrev_b32 v68, 16, v68
  v_mul_u32_u24 v69, 28, v68
  v_sub_u32 v69, v67, v69
  v_lshrrev_b32 v70, 4, v69
  v_and_b32 v69, 15, v69
  v_lshlrev_b32 v71, 12, v70
  v_lshl_add_u32 v71, v68, 8, v71
  v_lshl_add_u32 v71, v69, 4, v71
  v_add_u32 v157, v71, v75
  v_add_u32 v67, 96, v73
  v_mul_u32_u24 v68, 2341, v67
  v_lshrrev_b32 v68, 16, v68
  v_mul_u32_u24 v69, 28, v68
  v_sub_u32 v69, v67, v69
  v_lshrrev_b32 v70, 4, v69
  v_and_b32 v69, 15, v69
  v_lshlrev_b32 v71, 12, v70
  v_lshl_add_u32 v71, v68, 8, v71
  v_lshl_add_u32 v71, v69, 4, v71
  v_add_u32 v158, v71, v75
  v_mov_b32 v74, 0x40000000
  v_mov_b32 v164, 0
  v_mov_b32 v76, 0
  v_mov_b32 v77, 0
  v_mov_b32 v78, 0
  v_mov_b32 v79, 0
  ds_write_b128 v2, v[76:79] offset:0
  ds_write_b128 v2, v[76:79] offset:1024
  ds_write_b128 v2, v[76:79] offset:2048
  ds_write_b128 v2, v[76:79] offset:3072
  s_and_b32 s22, s17, 0
  s_lshl_b32 s22, s22, 7
  s_add_u32 s22, s22, 75729408
  v_lshl_add_u32 v4, v73, 2, s22
  v_and_b32 v64, 1, v73
  v_mov_b32 v5, 0x05040100
  v_mov_b32 v65, 0x03020706
  v_cmp_eq_u32 vcc, 1, v64
  s_nop 1
  v_cndmask_b32 v5, v5, v65, vcc
  s_lshl_b32 s22, s17, 2
  s_add_u32 s22, s22, 75733504
  v_lshl_add_u32 v7, v1, 7, s22
  v_cmp_gt_u32 vcc, 1, v1
  s_nop 1
  v_cndmask_b32 v7, v74, v7, vcc
  v_mov_b32 v6, v2
  v_lshl_add_u32 v64, v66, 2, v64
  v_and_b32 v65, 2, v72
  v_add_u32 v64, v64, v65
  s_mul_i32 s22, s17, 16
  v_add_u32 v75, s22, v73
  v_lshrrev_b32 v68, 4, v75
  v_lshlrev_b32 v68, 8, v68
  v_bfe_u32 v69, v75, 1, 1
  v_lshl_add_u32 v68, v69, 7, v68
  v_lshl_add_u32 v68, v64, 4, v68
  v_and_b32 v69, 12, v75
  v_add_u32 v1, v68, v69
  s_mul_i32 s22, s17, 28672
  s_add_u32 s25, s22, 42205184
  s_and_b32 s27, s17, 0
  s_xor_b32 s22, s27, 0
  s_mul_i32 s80, s22, 7168
  s_lshl_b32 s22, s22, 11
  s_add_u32 s76, s22, 9216
  s_xor_b32 s22, s27, 1
  s_mul_i32 s81, s22, 7168
  s_lshl_b32 s22, s22, 11
  s_add_u32 s77, s22, 9216
  s_xor_b32 s22, s27, 2
  s_mul_i32 s82, s22, 7168
  s_lshl_b32 s22, s22, 11
  s_add_u32 s78, s22, 9216
  s_xor_b32 s22, s27, 3
  s_mul_i32 s83, s22, 7168
  s_lshl_b32 s22, s22, 11
  s_add_u32 s79, s22, 9216
  v_mov_b32 v162, -1
  s_mov_b32 s38, 0x40000000
  v_add_u32 v0, 16384, v2
  s_mul_i32 s31, s17, 401408
  s_add_u32 s31, s31, 6422528
  s_mov_b32 s30, 0
ch_wr4:
  buffer_load_dword v9, off, s[12:15], 0 offset:128 sc1
  s_waitcnt vmcnt(0)
  v_cmp_ne_u32 vcc, 1, v9
  s_cbranch_vccz ch_wr4_ok
  s_sleep 8
  s_add_u32 s30, s30, 1
  s_cmp_lt_u32 s30, 400000
  s_cbranch_scc1 ch_wr4
  s_branch cA_abort
ch_wr4_ok:
  s_lshr_b32 s22, s17, 2
  s_lshl_b32 s28, 0x81, s22
  s_mul_i32 s27, s17, 12
  s_add_u32 s22, s27, 256
  s_lshr_b32 s22, s22, 6
  s_lshl_b32 s22, 0x81, s22
  s_or_b32 s28, s28, s22
  s_add_u32 s22, s27, 267
  s_lshr_b32 s22, s22, 6
  s_lshl_b32 s22, 0x81, s22
  s_or_b32 s28, s28, s22
  v_lshrrev_b32 v12, 8, v2
  v_lshlrev_b32 v12, 7, v12
  s_mov_b32 s27, 88519168
  s_mov_b32 s30, 0
ch_ww4:
  buffer_load_dword v9, v12, s[8:11], s27 offen sc1
  s_waitcnt vmcnt(0)
  v_and_b32 v10, s28, v9
  v_cmp_ne_u32 vcc, s28, v10
  s_cbranch_vccz ch_ww4_ok
  s_sleep 3
  s_add_u32 s30, s30, 1
  s_cmp_lt_u32 s30, 400000
  s_cbranch_scc1 ch_ww4
  s_branch cA_abort
ch_ww4_ok:
  s_add_u32 s22, s31, 0
  buffer_load_dwordx4 a[0:3], v2, s[8:11], s22 offen offset:0 sc1
  buffer_load_dwordx4 a[4:7], v2, s[8:11], s22 offen offset:1024 sc1
  buffer_load_dwordx4 a[8:11], v2, s[8:11], s22 offen offset:2048 sc1
  buffer_load_dwordx4 a[12:15], v2, s[8:11], s22 offen offset:3072 sc1
  s_add_u32 s22, s31, 4096
  buffer_load_dwordx4 a[16:19], v2, s[8:11], s22 offen offset:0 sc1
  buffer_load_dwordx4 a[20:23], v2, s[8:11], s22 offen offset:1024 sc1
  buffer_load_dwordx4 a[24:27], v2, s[8:11], s22 offen offset:2048 sc1
  buffer_load_dwordx4 a[28:31], v2, s[8:11], s22 offen offset:3072 sc1
  s_add_u32 s22, s31, 8192
  buffer_load_dwordx4 a[32:35], v2, s[8:11], s22 offen offset:0 sc1
  buffer_load_dwordx4 a[36:39], v2, s[8:11], s22 offen offset:1024 sc1
  buffer_load_dwordx4 a[40:43], v2, s[8:11], s22 offen offset:2048 sc1
  buffer_load_dwordx4 a[44:47], v2, s[8:11], s22 offen offset:3072 sc1
  s_add_u32 s22, s31, 12288
  buffer_load_dwordx4 a[48:51], v2, s[8:11], s22 offen offset:0 sc1
  buffer_load_dwordx4 a[52:55], v2, s[8:11], s22 offen offset:1024 sc1
  buffer_load_dwordx4 a[56:59], v2, s[8:11], s22 offen offset:2048 sc1
  buffer_load_dwordx4 a[60:63], v2, s[8:11], s22 offen offset:3072 sc1
  s_add_u32 s22, s31, 16384
  buffer_load_dwordx4 a[64:67], v2, s[8:11], s22 offen offset:0 sc1
  buffer_load_dwordx4 a[68:71], v2, s[8:11], s22 offen offset:1024 sc1
  buffer_load_dwordx4 a[72:75], v2, s[8:11], s22 offen offset:2048 sc1
  buffer_load_dwordx4 a[76:79], v2, s[8:11], s22 offen offset:3072 sc1
  s_add_u32 s22, s31, 20480
  buffer_load_dwordx4 a[80:83], v2, s[8:11], s22 offen offset:0 sc1
  buffer_load_dwordx4 a[84:87], v2, s[8:11], s22 offen offset:1024 sc1
  buffer_load_dwordx4 a[88:91], v2, s[8:11], s22 offen offset:2048 sc1
  buffer_load_dwordx4 a[92:95], v2, s[8:11], s22 offen offset:3072 sc1
  s_add_u32 s22, s31, 24576
  buffer_load_dwordx4 a[96:99], v2, s[8:11], s22 offen offset:0 sc1
  buffer_load_dwordx4 a[100:103], v2, s[8:11], s22 offen offset:1024 sc1
  buffer_load_dwordx4 a[104:107], v2, s[8:11], s22 offen offset:2048 sc1
  buffer_load_dwordx4 a[108:111], v2, s[8:11], s22 offen offset:3072 sc1
  s_add_u32 s22, s31, 28672
  buffer_load_dwordx4 a[112:115], v2, s[8:11], s22 offen offset:0 sc1
  buffer_load_dwordx4 a[116:119], v2, s[8:11], s22 offen offset:1024 sc1
  buffer_load_dwordx4 a[120:123], v2, s[8:11], s22 offen offset:2048 sc1
  buffer_load_dwordx4 a[124:127], v2, s[8:11], s22 offen offset:3072 sc1
  s_waitcnt vmcnt(24)
  s_add_u32 s22, s31, 32768
  buffer_load_dwordx4 a[128:131], v2, s[8:11], s22 offen offset:0 sc1
  buffer_load_dwordx4 a[132:135], v2, s[8:11], s22 offen offset:1024 sc1
  buffer_load_dwordx4 a[136:139], v2, s[8:11], s22 offen offset:2048 sc1
  buffer_load_dwordx4 a[140:143], v2, s[8:11], s22 offen offset:3072 sc1
  s_add_u32 s22, s31, 36864
  buffer_load_dwordx4 a[144:147], v2, s[8:11], s22 offen offset:0 sc1
  buffer_load_dwordx4 a[148:151], v2, s[8:11], s22 offen offset:1024 sc1
  buffer_load_dwordx4 a[152:155], v2, s[8:11], s22 offen offset:2048 sc1
  buffer_load_dwordx4 a[156:159], v2, s[8:11], s22 offen offset:3072 sc1
  s_add_u32 s22, s31, 40960
  buffer_load_dwordx4 a[160:163], v2, s[8:11], s22 offen offset:0 sc1
  buffer_load_dwordx4 a[164:167], v2, s[8:11], s22 offen offset:1024 sc1
  buffer_load_dwordx4 a[168:171], v2, s[8:11], s22 offen offset:2048 sc1
  buffer_load_dwordx4 a[172:175], v2, s[8:11], s22 offen offset:3072 sc1
  s_add_u32 s22, s31, 45056
  buffer_load_dwordx4 a[176:179], v2, s[8:11], s22 offen offset:0 sc1
  buffer_load_dwordx4 a[180:183], v2, s[8:11], s22 offen offset:1024 sc1
  buffer_load_dwordx4 a[184:187], v2, s[8:11], s22 offen offset:2048 sc1
  buffer_load_dwordx4 a[188:191], v2, s[8:11], s22 offen offset:3072 sc1
  s_add_u32 s22, s31, 49152
  buffer_load_dwordx4 a[192:195], v2, s[8:11], s22 offen offset:0 sc1
  buffer_load_dwordx4 a[196:199], v2, s[8:11], s22 offen offset:1024 sc1
  buffer_load_dwordx4 a[200:203], v2, s[8:11], s22 offen offset:2048 sc1
  buffer_load_dwordx4 a[204:207], v2, s[8:11], s22 offen offset:3072 sc1
  s_add_u32 s22, s31, 53248
  buffer_load_dwordx4 a[208:211], v2, s[8:11], s22 offen offset:0 sc1
  buffer_load_dwordx4 a[212:215], v2, s[8:11], s22 offen offset:1024 sc1
  buffer_load_dwordx4 a[216:219], v2, s[8:11], s22 offen offset:2048 sc1
  buffer_load_dwordx4 a[220:223], v2, s[8:11], s22 offen offset:3072 sc1
  s_add_u32 s22, s31, 57344
  buffer_load_dwordx4 a[224:227], v2, s[8:11], s22 offen offset:0 sc1
  buffer_load_dwordx4 a[228:231], v2, s[8:11], s22 offen offset:1024 sc1
  buffer_load_dwordx4 a[232:235], v2, s[8:11], s22 offen offset:2048 sc1
  buffer_load_dwordx4 a[236:239], v2, s[8:11], s22 offen offset:3072 sc1
  s_add_u32 s22, s31, 61440
  buffer_load_dwordx4 a[240:243], v2, s[8:11], s22 offen offset:0 sc1
  buffer_load_dwordx4 a[244:247], v2, s[8:11], s22 offen offset:1024 sc1
  buffer_load_dwordx4 a[248:251], v2, s[8:11], s22 offen offset:2048 sc1
  buffer_load_dwordx4 a[252:255], v2, s[8:11], s22 offen offset:3072 sc1
  s_waitcnt vmcnt(24)
  s_add_u32 s22, s31, 65536
  buffer_load_dwordx4 v[176:179], v2, s[8:11], s22 offen offset:0 sc1
  buffer_load_dwordx4 v[180:183], v2, s[8:11], s22 offen offset:1024 sc1
  buffer_load_dwordx4 v[184:187], v2, s[8:11], s22 offen offset:2048 sc1
  buffer_load_dwordx4 v[188:191], v2, s[8:11], s22 offen offset:3072 sc1
  s_add_u32 s22, s31, 69632
  buffer_load_dwordx4 v[192:195], v2, s[8:11], s22 offen offset:0 sc1
  buffer_load_dwordx4 v[196:199], v2, s[8:11], s22 offen offset:1024 sc1
  buffer_load_dwordx4 v[200:203], v2, s[8:11], s22 offen offset:2048 sc1
  buffer_load_dwordx4 v[204:207], v2, s[8:11], s22 offen offset:3072 sc1
  s_add_u32 s22, s31, 73728
  buffer_load_dwordx4 v[208:211], v2, s[8:11], s22 offen offset:0 sc1
  buffer_load_dwordx4 v[212:215], v2, s[8:11], s22 offen offset:1024 sc1
  buffer_load_dwordx4 v[216:219], v2, s[8:11], s22 offen offset:2048 sc1
  buffer_load_dwordx4 v[220:223], v2, s[8:11], s22 offen offset:3072 sc1
  s_add_u32 s22, s31, 77824
  buffer_load_dwordx4 v[224:227], v2, s[8:11], s22 offen offset:0 sc1
  buffer_load_dwordx4 v[228:231], v2, s[8:11], s22 offen offset:1024 sc1
  buffer_load_dwordx4 v[232:235], v2, s[8:11], s22 offen offset:2048 sc1
  buffer_load_dwordx4 v[236:239], v2, s[8:11], s22 offen offset:3072 sc1
  s_add_u32 s22, s31, 81920
  buffer_load_dwordx4 v[240:243], v2, s[8:11], s22 offen offset:0 sc1
  buffer_load_dwordx4 v[244:247], v2, s[8:11], s22 offen offset:1024 sc1
  buffer_load_dwordx4 v[248:251], v2, s[8:11], s22 offen offset:2048 sc1
  buffer_load_dwordx4 v[252:255], v2, s[8:11], s22 offen offset:3072 sc1
  s_mov_b32 m0, 16384
  s_add_u32 s22, s31, 86016
  buffer_load_dwordx4 v2, s[8:11], s22 offen offset:0 sc1 lds
  buffer_load_dwordx4 v2, s[8:11], s22 offen offset:1024 sc1 lds
  buffer_load_dwordx4 v2, s[8:11], s22 offen offset:2048 sc1 lds
  buffer_load_dwordx4 v2, s[8:11], s22 offen offset:3072 sc1 lds
  s_mov_b32 m0, 20480
  s_add_u32 s22, s31, 90112
  buffer_load_dwordx4 v2, s[8:11], s22 offen offset:0 sc1 lds
  buffer_load_dwordx4 v2, s[8:11], s22 offen offset:1024 sc1 lds
  buffer_load_dwordx4 v2, s[8:11], s22 offen offset:2048 sc1 lds
  buffer_load_dwordx4 v2, s[8:11], s22 offen offset:3072 sc1 lds
  s_mov_b32 m0, 24576
  s_add_u32 s22, s31, 94208
  buffer_load_dwordx4 v2, s[8:11], s22 offen offset:0 sc1 lds
  buffer_load_dwordx4 v2, s[8:11], s22 offen offset:1024 sc1 lds
  buffer_load_dwordx4 v2, s[8:11], s22 offen offset:2048 sc1 lds
  buffer_load_dwordx4 v2, s[8:11], s22 offen offset:3072 sc1 lds
  s_mov_b32 m0, 28672
  s_add_u32 s22, s31, 98304
  buffer_load_dwordx4 v2, s[8:11], s22 offen offset:0 sc1 lds
  buffer_load_dwordx4 v2, s[8:11], s22 offen offset:1024 sc1 lds
  s_mov_b32 s28, s35
  s_waitcnt vmcnt(0) lgkmcnt(0)
  s_mov_b32 s31, 0
  s_cmp_lg_u32 s88, 0
  s_cbranch_scc1 cB_va0_loop
  s_branch cA_va0_loop
ch_init5:
  v_mov_b32 v72, v116
  v_mov_b32 v73, v117
  v_lshrrev_b32 v65, 1, v72
  v_and_b32 v66, 1, v72
  v_mov_b32 v36, 0
  v_mov_b32 v37, 0
  v_mov_b32 v38, 0
  v_mov_b32 v39, 0
  v_mov_b32 v40, 0
  v_mov_b32 v41, 0
  v_mov_b32 v42, 0
  v_mov_b32 v43, 0
  v_mov_b32 v44, 0
  v_mov_b32 v45, 0
  v_mov_b32 v46, 0
  v_mov_b32 v47, 0
  v_mov_b32 v48, 0
  v_mov_b32 v49, 0
  v_mov_b32 v50, 0
  v_mov_b32 v51, 0
  v_mov_b32 v52, 0
  v_mov_b32 v53, 0
  v_mov_b32 v54, 0
  v_mov_b32 v55, 0
  v_mov_b32 v56, 0
  v_mov_b32 v57, 0
  v_mov_b32 v58, 0
  v_mov_b32 v59, 0
  v_mov_b32 v60, 0
  v_mov_b32 v61, 0
  v_mov_b32 v62, 0
  v_mov_b32 v63, 0
  v_lshlrev_b32 v75, 2, v65
  v_lshl_add_u32 v75, v66, 3, v75
  v_add_u32 v67, 112, v73
  v_mul_u32_u24 v68, 2341, v67
  v_lshrrev_b32 v68, 16, v68
  v_mul_u32_u24 v69, 28, v68
  v_sub_u32 v69, v67, v69
  v_lshrrev_b32 v70, 4, v69
  v_and_b32 v69, 15, v69
  v_lshlrev_b32 v71, 12, v70
  v_lshl_add_u32 v71, v68, 8, v71
  v_lshl_add_u32 v71, v69, 4, v71
  v_add_u32 v152, v71, v75
  v_add_u32 v67, 128, v73
  v_mul_u32_u24 v68, 2341, v67
  v_lshrrev_b32 v68, 16, v68
  v_mul_u32_u24 v69, 28, v68
  v_sub_u32 v69, v67, v69
  v_lshrrev_b32 v70, 4, v69
  v_and_b32 v69, 15, v69
  v_lshlrev_b32 v71, 12, v70
  v_lshl_add_u32 v71, v68, 8, v71
  v_lshl_add_u32 v71, v69, 4, v71
  v_add_u32 v153, v71, v75
  v_add_u32 v67, 144, v73
  v_mul_u32_u24 v68, 2341, v67
  v_lshrrev_b32 v68, 16, v68
  v_mul_u32_u24 v69, 28, v68
  v_sub_u32 v69, v67, v69
  v_lshrrev_b32 v70, 4, v69
  v_and_b32 v69, 15, v69
  v_lshlrev_b32 v71, 12, v70
  v_lshl_add_u32 v71, v68, 8, v71
  v_lshl_add_u32 v71, v69, 4, v71
  v_add_u32 v154, v71, v75
  v_add_u32 v67, 160, v73
  v_mul_u32_u24 v68, 2341, v67
  v_lshrrev_b32 v68, 16, v68
  v_mul_u32_u24 v69, 28, v68
  v_sub_u32 v69, v67, v69
  v_lshrrev_b32 v70, 4, v69
  v_and_b32 v69, 15, v69
  v_lshlrev_b32 v71, 12, v70
  v_lshl_add_u32 v71, v68, 8, v71
  v_lshl_add_u32 v71, v69, 4, v71
  v_add_u32 v155, v71, v75
  v_add_u32 v67, 176, v73
  v_mul_u32_u24 v68, 2341, v67
  v_lshrrev_b32 v68, 16, v68
  v_mul_u32_u24 v69, 28, v68
  v_sub_u32 v69, v67, v69
  v_lshrrev_b32 v70, 4, v69
  v_and_b32 v69, 15, v69
  v_lshlrev_b32 v71, 12, v70
  v_lshl_add_u32 v71, v68, 8, v71
  v_lshl_add_u32 v71, v69, 4, v71
  v_add_u32 v156, v71, v75
  v_add_u32 v67, 192, v73
  v_mul_u32_u24 v68, 2341, v67
  v_lshrrev_b32 v68, 16, v68
  v_mul_u32_u24 v69, 28, v68
  v_sub_u32 v69, v67, v69
  v_lshrrev_b32 v70, 4, v69
  v_and_b32 v69, 15, v69
  v_lshlrev_b32 v71, 12, v70
  v_lshl_add_u32 v71, v68, 8, v71
  v_lshl_add_u32 v71, v69, 4, v71
  v_add_u32 v157, v71, v75
  v_add_u32 v67, 208, v73
  v_mul_u32_u24 v68, 2341, v67
  v_lshrrev_b32 v68, 16, v68
  v_mul_u32_u24 v69, 28, v68
  v_sub_u32 v69, v67, v69
  v_lshrrev_b32 v70, 4, v69
  v_and_b32 v69, 15, v69
  v_lshlrev_b32 v71, 12, v70
  v_lshl_add_u32 v71, v68, 8, v71
  v_lshl_add_u32 v71, v69, 4, v71
  v_add_u32 v158, v71, v75
  v_mov_b32 v74, 0x40000000
  v_mov_b32 v164, 0
  v_mov_b32 v76, 0
  v_mov_b32 v77, 0
  v_mov_b32 v78, 0
  v_mov_b32 v79, 0
  ds_write_b128 v2, v[76:79] offset:4096
  ds_write_b128 v2, v[76:79] offset:5120
  ds_write_b128 v2, v[76:79] offset:6144
  ds_write_b128 v2, v[76:79] offset:7168
  s_and_b32 s22, s17, 0
  s_lshl_b32 s22, s22, 7
  s_add_u32 s22, s22, 75729408
  v_lshl_add_u32 v4, v73, 2, s22
  v_and_b32 v64, 1, v73
  v_mov_b32 v5, 0x05040100
  v_mov_b32 v65, 0x03020706
  v_cmp_eq_u32 vcc, 1, v64
  s_nop 1
  v_cndmask_b32 v5, v5, v65, vcc
  s_lshl_b32 s22, s17, 2
  s_add_u32 s22, s22, 75733504
  v_lshl_add_u32 v7, v1, 7, s22
  v_cmp_gt_u32 vcc, 1, v1
  s_nop 1
  v_cndmask_b32 v7, v74, v7, vcc
  v_min_u32 v65, 11, v73
  v_mad_u32_u24 v65, v72, 12, v65
  v_lshlrev_b32 v6, 4, v65
  v_add_u32 v6, 1024, v6
  v_lshl_add_u32 v64, v66, 2, v64
  v_and_b32 v65, 2, v72
  v_add_u32 v64, v64, v65
  s_mul_i32 s22, s17, 12
  s_add_u32 s22, s22, 256
  v_add_u32 v75, s22, v73
  v_lshrrev_b32 v68, 4, v75
  v_lshlrev_b32 v68, 8, v68
  v_bfe_u32 v69, v75, 1, 1
  v_lshl_add_u32 v68, v69, 7, v68
  v_lshl_add_u32 v68, v64, 4, v68
  v_and_b32 v69, 12, v75
  v_add_u32 v1, v68, v69
  v_cmp_gt_u32 vcc, 12, v73
  s_nop 1
  v_cndmask_b32 v1, v74, v1, vcc
  s_mul_i32 s22, s17, 28672
  s_add_u32 s25, s22, 42205184
  s_and_b32 s27, s17, 0
  s_xor_b32 s22, s27, 0
  s_mul_i32 s80, s22, 7168
  s_lshl_b32 s22, s22, 11
  s_add_u32 s76, s22, 9216
  s_xor_b32 s22, s27, 1
  s_mul_i32 s81, s22, 7168
  s_lshl_b32 s22, s22, 11
  s_add_u32 s77, s22, 9216
  s_xor_b32 s22, s27, 2
  s_mul_i32 s82, s22, 7168
  s_lshl_b32 s22, s22, 11
  s_add_u32 s78, s22, 9216
  s_xor_b32 s22, s27, 3
  s_mul_i32 s83, s22, 7168
  s_lshl_b32 s22, s22, 11
  s_add_u32 s79, s22, 9216
  v_mov_b32 v162, -1
  s_mov_b32 s38, 0x40000000
  v_add_u32 v0, 30720, v2
  s_mul_i32 s31, s17, 401408
  s_add_u32 s31, s31, 6522880
  s_mov_b32 s30, 0
ch_wr5:
  buffer_load_dword v9, off, s[12:15], 0 offset:128 sc1
  s_waitcnt vmcnt(0)
  v_cmp_ne_u32 vcc, 1, v9
  s_cbranch_vccz ch_wr5_ok
  s_sleep 8
  s_add_u32 s30, s30, 1
  s_cmp_lt_u32 s30, 400000
  s_cbranch_scc1 ch_wr5
  s_branch cA_abort
ch_wr5_ok:
  s_lshr_b32 s22, s17, 2
  s_lshl_b32 s28, 0x81, s22
  s_mul_i32 s27, s17, 12
  s_add_u32 s22, s27, 256
  s_lshr_b32 s22, s22, 6
  s_lshl_b32 s22, 0x81, s22
  s_or_b32 s28, s28, s22
  s_add_u32 s22, s27, 267
  s_lshr_b32 s22, s22, 6
  s_lshl_b32 s22, 0x81, s22
  s_or_b32 s28, s28, s22
  v_lshrrev_b32 v12, 8, v2
  v_lshlrev_b32 v12, 7, v12
  s_mov_b32 s27, 88519680
  s_mov_b32 s30, 0
ch_ww5:
  buffer_load_dword v9, v12, s[8:11], s27 offen sc1
  s_waitcnt vmcnt(0)
  v_and_b32 v10, s28, v9
  v_cmp_ne_u32 vcc, s28, v10
  s_cbranch_vccz ch_ww5_ok
  s_sleep 3
  s_add_u32 s30, s30, 1
  s_cmp_lt_u32 s30, 400000
  s_cbranch_scc1 ch_ww5
  s_branch cA_abort
ch_ww5_ok:
  s_add_u32 s22, s31, 0
  buffer_load_dwordx4 a[0:3], v2, s[8:11], s22 offen offset:0 sc1
  buffer_load_dwordx4 a[4:7], v2, s[8:11], s22 offen offset:1024 sc1
  buffer_load_dwordx4 a[8:11], v2, s[8:11], s22 offen offset:2048 sc1
  buffer_load_dwordx4 a[12:15], v2, s[8:11], s22 offen offset:3072 sc1
  s_add_u32 s22, s31, 4096
  buffer_load_dwordx4 a[16:19], v2, s[8:11], s22 offen offset:0 sc1
  buffer_load_dwordx4 a[20:23], v2, s[8:11], s22 offen offset:1024 sc1
  buffer_load_dwordx4 a[24:27], v2, s[8:11], s22 offen offset:2048 sc1
  buffer_load_dwordx4 a[28:31], v2, s[8:11], s22 offen offset:3072 sc1
  s_add_u32 s22, s31, 8192
  buffer_load_dwordx4 a[32:35], v2, s[8:11], s22 offen offset:0 sc1
  buffer_load_dwordx4 a[36:39], v2, s[8:11], s22 offen offset:1024 sc1
  buffer_load_dwordx4 a[40:43], v2, s[8:11], s22 offen offset:2048 sc1
  buffer_load_dwordx4 a[44:47], v2, s[8:11], s22 offen offset:3072 sc1
  s_add_u32 s22, s31, 12288
  buffer_load_dwordx4 a[48:51], v2, s[8:11], s22 offen offset:0 sc1
  buffer_load_dwordx4 a[52:55], v2, s[8:11], s22 offen offset:1024 sc1
  buffer_load_dwordx4 a[56:59], v2, s[8:11], s22 offen offset:2048 sc1
  buffer_load_dwordx4 a[60:63], v2, s[8:11], s22 offen offset:3072 sc1
  s_add_u32 s22, s31, 16384
  buffer_load_dwordx4 a[64:67], v2, s[8:11], s22 offen offset:0 sc1
  buffer_load_dwordx4 a[68:71], v2, s[8:11], s22 offen offset:1024 sc1
  buffer_load_dwordx4 a[72:75], v2, s[8:11], s22 offen offset:2048 sc1
  buffer_load_dwordx4 a[76:79], v2, s[8:11], s22 offen offset:3072 sc1
  s_add_u32 s22, s31, 20480
  buffer_load_dwordx4 a[80:83], v2, s[8:11], s22 offen offset:0 sc1
  buffer_load_dwordx4 a[84:87], v2, s[8:11], s22 offen offset:1024 sc1
  buffer_load_dwordx4 a[88:91], v2, s[8:11], s22 offen offset:2048 sc1
  buffer_load_dwordx4 a[92:95], v2, s[8:11], s22 offen offset:3072 sc1
  s_add_u32 s22, s31, 24576
  buffer_load_dwordx4 a[96:99], v2, s[8:11], s22 offen offset:0 sc1
  buffer_load_dwordx4 a[100:103], v2, s[8:11], s22 offen offset:1024 sc1
  buffer_load_dwordx4 a[104:107], v2, s[8:11], s22 offen offset:2048 sc1
  buffer_load_dwordx4 a[108:111], v2, s[8:11], s22 offen offset:3072 sc1
  s_add_u32 s22, s31, 28672
  buffer_load_dwordx4 a[112:115], v2, s[8:11], s22 offen offset:0 sc1
  buffer_load_dwordx4 a[116:119], v2, s[8:11], s22 offen offset:1024 sc1
  buffer_load_dwordx4 a[120:123], v2, s[8:11], s22 offen offset:2048 sc1
  buffer_load_dwordx4 a[124:127], v2, s[8:11], s22 offen offset:3072 sc1
  s_waitcnt vmcnt(24)
  s_add_u32 s22, s31, 32768
  buffer_load_dwordx4 a[128:131], v2, s[8:11], s22 offen offset:0 sc1
  buffer_load_dwordx4 a[132:135], v2, s[8:11], s22 offen offset:1024 sc1
  buffer_load_dwordx4 a[136:139], v2, s[8:11], s22 offen offset:2048 sc1
  buffer_load_dwordx4 a[140:143], v2, s[8:11], s22 offen offset:3072 sc1
  s_add_u32 s22, s31, 36864
  buffer_load_dwordx4 a[144:147], v2, s[8:11], s22 offen offset:0 sc1
  buffer_load_dwordx4 a[148:151], v2, s[8:11], s22 offen offset:1024 sc1
  buffer_load_dwordx4 a[152:155], v2, s[8:11], s22 offen offset:2048 sc1
  buffer_load_dwordx4 a[156:159], v2, s[8:11], s22 offen offset:3072 sc1
  s_add_u32 s22, s31, 40960
  buffer_load_dwordx4 a[160:163], v2, s[8:11], s22 offen offset:0 sc1
  buffer_load_dwordx4 a[164:167], v2, s[8:11], s22 offen offset:1024 sc1
  buffer_load_dwordx4 a[168:171], v2, s[8:11], s22 offen offset:2048 sc1
  buffer_load_dwordx4 a[172:175], v2, s[8:11], s22 offen offset:3072 sc1
  s_add_u32 s22, s31, 45056
  buffer_load_dwordx4 a[176:179], v2, s[8:11], s22 offen offset:0 sc1
  buffer_load_dwordx4 a[180:183], v2, s[8:11], s22 offen offset:1024 sc1
  buffer_load_dwordx4 a[184:187], v2, s[8:11], s22 offen offset:2048 sc1
  buffer_load_dwordx4 a[188:191], v2, s[8:11], s22 offen offset:3072 sc1
  s_add_u32 s22, s31, 49152
  buffer_load_dwordx4 a[192:195], v2, s[8:11], s22 offen offset:0 sc1
  buffer_load_dwordx4 a[196:199], v2, s[8:11], s22 offen offset:1024 sc1
  buffer_load_dwordx4 a[200:203], v2, s[8:11], s22 offen offset:2048 sc1
  buffer_load_dwordx4 a[204:207], v2, s[8:11], s22 offen offset:3072 sc1
  s_add_u32 s22, s31, 53248
  buffer_load_dwordx4 a[208:211], v2, s[8:11], s22 offen offset:0 sc1
  buffer_load_dwordx4 a[212:215], v2, s[8:11], s22 offen offset:1024 sc1
  buffer_load_dwordx4 a[216:219], v2, s[8:11], s22 offen offset:2048 sc1
  buffer_load_dwordx4 a[220:223], v2, s[8:11], s22 offen offset:3072 sc1
  s_add_u32 s22, s31, 57344
  buffer_load_dwordx4 a[224:227], v2, s[8:11], s22 offen offset:0 sc1
  buffer_load_dwordx4 a[228:231], v2, s[8:11], s22 offen offset:1024 sc1
  buffer_load_dwordx4 a[232:235], v2, s[8:11], s22 offen offset:2048 sc1
  buffer_load_dwordx4 a[236:239], v2, s[8:11], s22 offen offset:3072 sc1
  s_add_u32 s22, s31, 61440
  buffer_load_dwordx4 a[240:243], v2, s[8:11], s22 offen offset:0 sc1
  buffer_load_dwordx4 a[244:247], v2, s[8:11], s22 offen offset:1024 sc1
  buffer_load_dwordx4 a[248:251], v2, s[8:11], s22 offen offset:2048 sc1
  buffer_load_dwordx4 a[252:255], v2, s[8:11], s22 offen offset:3072 sc1
  s_waitcnt vmcnt(24)
  s_add_u32 s22, s31, 65536
  buffer_load_dwordx4 v[176:179], v2, s[8:11], s22 offen offset:0 sc1
  buffer_load_dwordx4 v[180:183], v2, s[8:11], s22 offen offset:1024 sc1
  buffer_load_dwordx4 v[184:187], v2, s[8:11], s22 offen offset:2048 sc1
  buffer_load_dwordx4 v[188:191], v2, s[8:11], s22 offen offset:3072 sc1
  s_add_u32 s22, s31, 69632
  buffer_load_dwordx4 v[192:195], v2, s[8:11], s22 offen offset:0 sc1
  buffer_load_dwordx4 v[196:199], v2, s[8:11], s22 offen offset:1024 sc1
  buffer_load_dwordx4 v[200:203], v2, s[8:11], s22 offen offset:2048 sc1
  buffer_load_dwordx4 v[204:207], v2, s[8:11], s22 offen offset:3072 sc1
  s_add_u32 s22, s31, 73728
  buffer_load_dwordx4 v[208:211], v2, s[8:11], s22 offen offset:0 sc1
  buffer_load_dwordx4 v[212:215], v2, s[8:11], s22 offen offset:1024 sc1
  buffer_load_dwordx4 v[216:219], v2, s[8:11], s22 offen offset:2048 sc1
  buffer_load_dwordx4 v[220:223], v2, s[8:11], s22 offen offset:3072 sc1
  s_add_u32 s22, s31, 77824
  buffer_load_dwordx4 v[224:227], v2, s[8:11], s22 offen offset:0 sc1
  buffer_load_dwordx4 v[228:231], v2, s[8:11], s22 offen offset:1024 sc1
  buffer_load_dwordx4 v[232:235], v2, s[8:11], s22 offen offset:2048 sc1
  buffer_load_dwordx4 v[236:239], v2, s[8:11], s22 offen offset:3072 sc1
  s_add_u32 s22, s31, 81920
  buffer_load_dwordx4 v[240:243], v2, s[8:11], s22 offen offset:0 sc1
  buffer_load_dwordx4 v[244:247], v2, s[8:11], s22 offen offset:1024 sc1
  buffer_load_dwordx4 v[248:251], v2, s[8:11], s22 offen offset:2048 sc1
  buffer_load_dwordx4 v[252:255], v2, s[8:11], s22 offen offset:3072 sc1
  s_mov_b32 m0, 30720
  s_add_u32 s22, s31, 86016
  buffer_load_dwordx4 v2, s[8:11], s22 offen offset:0 sc1 lds
  buffer_load_dwordx4 v2, s[8:11], s22 offen offset:1024 sc1 lds
  buffer_load_dwordx4 v2, s[8:11], s22 offen offset:2048 sc1 lds
  buffer_load_dwordx4 v2, s[8:11], s22 offen offset:3072 sc1 lds
  s_mov_b32 m0, 34816
  s_add_u32 s22, s31, 90112
  buffer_load_dwordx4 v2, s[8:11], s22 offen offset:0 sc1 lds
  buffer_load_dwordx4 v2, s[8:11], s22 offen offset:1024 sc1 lds
  buffer_load_dwordx4 v2, s[8:11], s22 offen offset:2048 sc1 lds
  buffer_load_dwordx4 v2, s[8:11], s22 offen offset:3072 sc1 lds
  s_mov_b32 m0, 38912
  s_add_u32 s22, s31, 94208
  buffer_load_dwordx4 v2, s[8:11], s22 offen offset:0 sc1 lds
  buffer_load_dwordx4 v2, s[8:11], s22 offen offset:1024 sc1 lds
  buffer_load_dwordx4 v2, s[8:11], s22 offen offset:2048 sc1 lds
  buffer_load_dwordx4 v2, s[8:11], s22 offen offset:3072 sc1 lds
  s_mov_b32 m0, 43008
  s_add_u32 s22, s31, 98304
  buffer_load_dwordx4 v2, s[8:11], s22 offen offset:0 sc1 lds
  buffer_load_dwordx4 v2, s[8:11], s22 offen offset:1024 sc1 lds
  s_mov_b32 s28, s35
  s_waitcnt vmcnt(0) lgkmcnt(0)
  s_mov_b32 s31, 0
  s_cmp_lg_u32 s88, 0
  s_cbranch_scc1 cB_va1_loop
  s_branch cA_va1_loop
ch_init6:
  v_mov_b32 v72, v116
  v_mov_b32 v73, v117
  v_lshrrev_b32 v65, 1, v72
  v_and_b32 v66, 1, v72
  v_mov_b32 v36, 0
  v_mov_b32 v37, 0
  v_mov_b32 v38, 0
  v_mov_b32 v39, 0
  v_mov_b32 v40, 0
  v_mov_b32 v41, 0
  v_mov_b32 v42, 0
  v_mov_b32 v43, 0
  v_mov_b32 v44, 0
  v_mov_b32 v45, 0
  v_mov_b32 v46, 0
  v_mov_b32 v47, 0
  v_mov_b32 v48, 0
  v_mov_b32 v49, 0
  v_mov_b32 v50, 0
  v_mov_b32 v51, 0
  v_mov_b32 v52, 0
  v_mov_b32 v53, 0
  v_mov_b32 v54, 0
  v_mov_b32 v55, 0
  v_mov_b32 v56, 0
  v_mov_b32 v57, 0
  v_mov_b32 v58, 0
  v_mov_b32 v59, 0
  v_mov_b32 v60, 0
  v_mov_b32 v61, 0
  v_mov_b32 v62, 0
  v_mov_b32 v63, 0
  v_lshlrev_b32 v75, 2, v65
  v_lshl_add_u32 v75, v66, 3, v75
  v_add_u32 v67, 224, v73
  v_mul_u32_u24 v68, 2341, v67
  v_lshrrev_b32 v68, 16, v68
  v_mul_u32_u24 v69, 28, v68
  v_sub_u32 v69, v67, v69
  v_lshrrev_b32 v70, 4, v69
  v_and_b32 v69, 15, v69
  v_lshlrev_b32 v71, 12, v70
  v_lshl_add_u32 v71, v68, 8, v71
  v_lshl_add_u32 v71, v69, 4, v71
  v_add_u32 v104, v71, v75
  v_add_u32 v67, 240, v73
  v_mul_u32_u24 v68, 2341, v67
  v_lshrrev_b32 v68, 16, v68
  v_mul_u32_u24 v69, 28, v68
  v_sub_u32 v69, v67, v69
  v_lshrrev_b32 v70, 4, v69
  v_and_b32 v69, 15, v69
  v_lshlrev_b32 v71, 12, v70
  v_lshl_add_u32 v71, v68, 8, v71
  v_lshl_add_u32 v71, v69, 4, v71
  v_add_u32 v105, v71, v75
  v_add_u32 v67, 256, v73
  v_mul_u32_u24 v68, 2341, v67
  v_lshrrev_b32 v68, 16, v68
  v_mul_u32_u24 v69, 28, v68
  v_sub_u32 v69, v67, v69
  v_lshrrev_b32 v70, 4, v69
  v_and_b32 v69, 15, v69
  v_lshlrev_b32 v71, 12, v70
  v_lshl_add_u32 v71, v68, 8, v71
  v_lshl_add_u32 v71, v69, 4, v71
  v_add_u32 v106, v71, v75
  v_add_u32 v67, 272, v73
  v_mul_u32_u24 v68, 2341, v67
  v_lshrrev_b32 v68, 16, v68
  v_mul_u32_u24 v69, 28, v68
  v_sub_u32 v69, v67, v69
  v_lshrrev_b32 v70, 4, v69
  v_and_b32 v69, 15, v69
  v_lshlrev_b32 v71, 12, v70
  v_lshl_add_u32 v71, v68, 8, v71
  v_lshl_add_u32 v71, v69, 4, v71
  v_add_u32 v107, v71, v75
  v_add_u32 v67, 288, v73
  v_mul_u32_u24 v68, 2341, v67
  v_lshrrev_b32 v68, 16, v68
  v_mul_u32_u24 v69, 28, v68
  v_sub_u32 v69, v67, v69
  v_lshrrev_b32 v70, 4, v69
  v_and_b32 v69, 15, v69
  v_lshlrev_b32 v71, 12, v70
  v_lshl_add_u32 v71, v68, 8, v71
  v_lshl_add_u32 v71, v69, 4, v71
  v_add_u32 v108, v71, v75
  v_add_u32 v67, 304, v73
  v_mul_u32_u24 v68, 2341, v67
  v_lshrrev_b32 v68, 16, v68
  v_mul_u32_u24 v69, 28, v68
  v_sub_u32 v69, v67, v69
  v_lshrrev_b32 v70, 4, v69
  v_and_b32 v69, 15, v69
  v_lshlrev_b32 v71, 12, v70
  v_lshl_add_u32 v71, v68, 8, v71
  v_lshl_add_u32 v71, v69, 4, v71
  v_add_u32 v109, v71, v75
  v_add_u32 v67, 320, v73
  v_mul_u32_u24 v68, 2341, v67
  v_lshrrev_b32 v68, 16, v68
  v_mul_u32_u24 v69, 28, v68
  v_sub_u32 v69, v67, v69
  v_lshrrev_b32 v70, 4, v69
  v_and_b32 v69, 15, v69
  v_lshlrev_b32 v71, 12, v70
  v_lshl_add_u32 v71, v68, 8, v71
  v_lshl_add_u32 v71, v69, 4, v71
  v_add_u32 v110, v71, v75
  v_mov_b32 v74, 0x40000000
  v_mov_b32 v88, 0
  v_and_b32 v119, 15, v1
  s_and_b32 s22, s17, 0
  s_lshl_b32 s22, s22, 7
  s_add_u32 s22, s22, 75733504
  v_lshl_add_u32 v119, v119, 2, s22
  s_lshl_b32 s22, s17, 2
  s_add_u32 s22, s22, 75731456
  v_lshl_add_u32 v118, v1, 7, s22
  v_cmp_gt_u32 vcc, 1, v1
  s_nop 1
  v_cndmask_b32 v118, v74, v118, vcc
  s_lshl_b32 s35, s17, 7
  s_add_u32 s35, s35, 88461312
  v_min_u32 v116, 13, v1
  s_mul_i32 s22, s17, 14
  v_add_u32 v116, s22, v116
  v_lshlrev_b32 v116, 7, v116
  s_mul_i32 s31, s17, 401408
  s_add_u32 s31, s31, 6623232
  s_mov_b32 s30, 0
ch_wr6:
  buffer_load_dword v9, off, s[12:15], 0 offset:132 sc1
  s_waitcnt vmcnt(0)
  v_cmp_ne_u32 vcc, 1, v9
  s_cbranch_vccz ch_wr6_ok
  s_sleep 8
  s_add_u32 s30, s30, 1
  s_cmp_lt_u32 s30, 400000
  s_cbranch_scc1 ch_wr6
  s_branch cA_abort
ch_wr6_ok:
  s_lshr_b32 s22, s17, 2
  s_lshl_b32 s28, 0x81, s22
  s_mul_i32 s27, s17, 12
  s_add_u32 s22, s27, 256
  s_lshr_b32 s22, s22, 6
  s_lshl_b32 s22, 0x81, s22
  s_or_b32 s28, s28, s22
  s_add_u32 s22, s27, 267
  s_lshr_b32 s22, s22, 6
  s_lshl_b32 s22, 0x81, s22
  s_or_b32 s28, s28, s22
  v_lshrrev_b32 v12, 8, v2
  v_lshlrev_b32 v12, 7, v12
  s_mov_b32 s27, 88520192
  s_mov_b32 s30, 0
ch_ww6:
  buffer_load_dword v9, v12, s[8:11], s27 offen sc1
  s_waitcnt vmcnt(0)
  v_and_b32 v10, s28, v9
  v_cmp_ne_u32 vcc, s28, v10
  s_cbranch_vccz ch_ww6_ok
  s_sleep 3
  s_add_u32 s30, s30, 1
  s_cmp_lt_u32 s30, 400000
  s_cbranch_scc1 ch_ww6
  s_branch cA_abort
ch_ww6_ok:
  s_add_u32 s22, s31, 0
  buffer_load_dwordx4 a[0:3], v2, s[8:11], s22 offen offset:0 sc1
  buffer_load_dwordx4 a[4:7], v2, s[8:11], s22 offen offset:1024 sc1
  buffer_load_dwordx4 a[8:11], v2, s[8:11], s22 offen offset:2048 sc1
  buffer_load_dwordx4 a[12:15], v2, s[8:11], s22 offen offset:3072 sc1
  s_add_u32 s22, s31, 4096
  buffer_load_dwordx4 a[16:19], v2, s[8:11], s22 offen offset:0 sc1
  buffer_load_dwordx4 a[20:23], v2, s[8:11], s22 offen offset:1024 sc1
  buffer_load_dwordx4 a[24:27], v2, s[8:11], s22 offen offset:2048 sc1
  buffer_load_dwordx4 a[28:31], v2, s[8:11], s22 offen offset:3072 sc1
  s_add_u32 s22, s31, 8192
  buffer_load_dwordx4 a[32:35], v2, s[8:11], s22 offen offset:0 sc1
  buffer_load_dwordx4 a[36:39], v2, s[8:11], s22 offen offset:1024 sc1
  buffer_load_dwordx4 a[40:43], v2, s[8:11], s22 offen offset:2048 sc1
  buffer_load_dwordx4 a[44:47], v2, s[8:11], s22 offen offset:3072 sc1
  s_add_u32 s22, s31, 12288
  buffer_load_dwordx4 a[48:51], v2, s[8:11], s22 offen offset:0 sc1
  buffer_load_dwordx4 a[52:55], v2, s[8:11], s22 offen offset:1024 sc1
  buffer_load_dwordx4 a[56:59], v2, s[8:11], s22 offen offset:2048 sc1
  buffer_load_dwordx4 a[60:63], v2, s[8:11], s22 offen offset:3072 sc1
  s_add_u32 s22, s31, 16384
  buffer_load_dwordx4 a[64:67], v2, s[8:11], s22 offen offset:0 sc1
  buffer_load_dwordx4 a[68:71], v2, s[8:11], s22 offen offset:1024 sc1
  buffer_load_dwordx4 a[72:75], v2, s[8:11], s22 offen offset:2048 sc1
  buffer_load_dwordx4 a[76:79], v2, s[8:11], s22 offen offset:3072 sc1
  s_add_u32 s22, s31, 20480
  buffer_load_dwordx4 a[80:83], v2, s[8:11], s22 offen offset:0 sc1
  buffer_load_dwordx4 a[84:87], v2, s[8:11], s22 offen offset:1024 sc1
  buffer_load_dwordx4 a[88:91], v2, s[8:11], s22 offen offset:2048 sc1
  buffer_load_dwordx4 a[92:95], v2, s[8:11], s22 offen offset:3072 sc1
  s_add_u32 s22, s31, 24576
  buffer_load_dwordx4 a[96:99], v2, s[8:11], s22 offen offset:0 sc1
  buffer_load_dwordx4 a[100:103], v2, s[8:11], s22 offen offset:1024 sc1
  buffer_load_dwordx4 a[104:107], v2, s[8:11], s22 offen offset:2048 sc1
  buffer_load_dwordx4 a[108:111], v2, s[8:11], s22 offen offset:3072 sc1
  s_add_u32 s22, s31, 28672
  buffer_load_dwordx4 a[112:115], v2, s[8:11], s22 offen offset:0 sc1
  buffer_load_dwordx4 a[116:119], v2, s[8:11], s22 offen offset:1024 sc1
  buffer_load_dwordx4 a[120:123], v2, s[8:11], s22 offen offset:2048 sc1
  buffer_load_dwordx4 a[124:127], v2, s[8:11], s22 offen offset:3072 sc1
  s_waitcnt vmcnt(24)
  s_add_u32 s22, s31, 32768
  buffer_load_dwordx4 a[128:131], v2, s[8:11], s22 offen offset:0 sc1
  buffer_load_dwordx4 a[132:135], v2, s[8:11], s22 offen offset:1024 sc1
  buffer_load_dwordx4 a[136:139], v2, s[8:11], s22 offen offset:2048 sc1
  buffer_load_dwordx4 a[140:143], v2, s[8:11], s22 offen offset:3072 sc1
  s_add_u32 s22, s31, 36864
  buffer_load_dwordx4 a[144:147], v2, s[8:11], s22 offen offset:0 sc1
  buffer_load_dwordx4 a[148:151], v2, s[8:11], s22 offen offset:1024 sc1
  buffer_load_dwordx4 a[152:155], v2, s[8:11], s22 offen offset:2048 sc1
  buffer_load_dwordx4 a[156:159], v2, s[8:11], s22 offen offset:3072 sc1
  s_add_u32 s22, s31, 40960
  buffer_load_dwordx4 a[160:163], v2, s[8:11], s22 offen offset:0 sc1
  buffer_load_dwordx4 a[164:167], v2, s[8:11], s22 offen offset:1024 sc1
  buffer_load_dwordx4 a[168:171], v2, s[8:11], s22 offen offset:2048 sc1
  buffer_load_dwordx4 a[172:175], v2, s[8:11], s22 offen offset:3072 sc1
  s_add_u32 s22, s31, 45056
  buffer_load_dwordx4 a[176:179], v2, s[8:11], s22 offen offset:0 sc1
  buffer_load_dwordx4 a[180:183], v2, s[8:11], s22 offen offset:1024 sc1
  buffer_load_dwordx4 a[184:187], v2, s[8:11], s22 offen offset:2048 sc1
  buffer_load_dwordx4 a[188:191], v2, s[8:11], s22 offen offset:3072 sc1
  s_add_u32 s22, s31, 49152
  buffer_load_dwordx4 a[192:195], v2, s[8:11], s22 offen offset:0 sc1
  buffer_load_dwordx4 a[196:199], v2, s[8:11], s22 offen offset:1024 sc1
  buffer_load_dwordx4 a[200:203], v2, s[8:11], s22 offen offset:2048 sc1
  buffer_load_dwordx4 a[204:207], v2, s[8:11], s22 offen offset:3072 sc1
  s_add_u32 s22, s31, 53248
  buffer_load_dwordx4 a[208:211], v2, s[8:11], s22 offen offset:0 sc1
  buffer_load_dwordx4 a[212:215], v2, s[8:11], s22 offen offset:1024 sc1
  buffer_load_dwordx4 a[216:219], v2, s[8:11], s22 offen offset:2048 sc1
  buffer_load_dwordx4 a[220:223], v2, s[8:11], s22 offen offset:3072 sc1
  s_add_u32 s22, s31, 57344
  buffer_load_dwordx4 a[224:227], v2, s[8:11], s22 offen offset:0 sc1
  buffer_load_dwordx4 a[228:231], v2, s[8:11], s22 offen offset:1024 sc1
  buffer_load_dwordx4 a[232:235], v2, s[8:11], s22 offen offset:2048 sc1
  buffer_load_dwordx4 a[236:239], v2, s[8:11], s22 offen offset:3072 sc1
  s_add_u32 s22, s31, 61440
  buffer_load_dwordx4 a[240:243], v2, s[8:11], s22 offen offset:0 sc1
  buffer_load_dwordx4 a[244:247], v2, s[8:11], s22 offen offset:1024 sc1
  buffer_load_dwordx4 a[248:251], v2, s[8:11], s22 offen offset:2048 sc1
  buffer_load_dwordx4 a[252:255], v2, s[8:11], s22 offen offset:3072 sc1
  s_waitcnt vmcnt(24)
  s_add_u32 s22, s31, 65536
  buffer_load_dwordx4 v[120:123], v2, s[8:11], s22 offen offset:0 sc1
  buffer_load_dwordx4 v[124:127], v2, s[8:11], s22 offen offset:1024 sc1
  buffer_load_dwordx4 v[128:131], v2, s[8:11], s22 offen offset:2048 sc1
  buffer_load_dwordx4 v[132:135], v2, s[8:11], s22 offen offset:3072 sc1
  s_add_u32 s22, s31, 69632
  buffer_load_dwordx4 v[136:139], v2, s[8:11], s22 offen offset:0 sc1
  buffer_load_dwordx4 v[140:143], v2, s[8:11], s22 offen offset:1024 sc1
  buffer_load_dwordx4 v[144:147], v2, s[8:11], s22 offen offset:2048 sc1
  buffer_load_dwordx4 v[148:151], v2, s[8:11], s22 offen offset:3072 sc1
  s_add_u32 s22, s31, 73728
  buffer_load_dwordx4 v[152:155], v2, s[8:11], s22 offen offset:0 sc1
  buffer_load_dwordx4 v[156:159], v2, s[8:11], s22 offen offset:1024 sc1
  buffer_load_dwordx4 v[160:163], v2, s[8:11], s22 offen offset:2048 sc1
  buffer_load_dwordx4 v[164:167], v2, s[8:11], s22 offen offset:3072 sc1
  s_add_u32 s22, s31, 77824
  buffer_load_dwordx4 v[168:171], v2, s[8:11], s22 offen offset:0 sc1
  buffer_load_dwordx4 v[172:175], v2, s[8:11], s22 offen offset:1024 sc1
  buffer_load_dwordx4 v[176:179], v2, s[8:11], s22 offen offset:2048 sc1
  buffer_load_dwordx4 v[180:183], v2, s[8:11], s22 offen offset:3072 sc1
  s_add_u32 s22, s31, 81920
  buffer_load_dwordx4 v[184:187], v2, s[8:11], s22 offen offset:0 sc1
  buffer_load_dwordx4 v[188:191], v2, s[8:11], s22 offen offset:1024 sc1
  buffer_load_dwordx4 v[192:195], v2, s[8:11], s22 offen offset:2048 sc1
  buffer_load_dwordx4 v[196:199], v2, s[8:11], s22 offen offset:3072 sc1
  s_add_u32 s22, s31, 86016
  buffer_load_dwordx4 v[200:203], v2, s[8:11], s22 offen offset:0 sc1
  buffer_load_dwordx4 v[204:207], v2, s[8:11], s22 offen offset:1024 sc1
  buffer_load_dwordx4 v[208:211], v2, s[8:11], s22 offen offset:2048 sc1
  buffer_load_dwordx4 v[212:215], v2, s[8:11], s22 offen offset:3072 sc1
  s_add_u32 s22, s31, 90112
  buffer_load_dwordx4 v[216:219], v2, s[8:11], s22 offen offset:0 sc1
  buffer_load_dwordx4 v[220:223], v2, s[8:11], s22 offen offset:1024 sc1
  buffer_load_dwordx4 v[224:227], v2, s[8:11], s22 offen offset:2048 sc1
  buffer_load_dwordx4 v[228:231], v2, s[8:11], s22 offen offset:3072 sc1
  s_add_u32 s22, s31, 94208
  buffer_load_dwordx4 v[232:235], v2, s[8:11], s22 offen offset:0 sc1
  buffer_load_dwordx4 v[236:239], v2, s[8:11], s22 offen offset:1024 sc1
  buffer_load_dwordx4 v[240:243], v2, s[8:11], s22 offen offset:2048 sc1
  buffer_load_dwordx4 v[244:247], v2, s[8:11], s22 offen offset:3072 sc1
  s_waitcnt vmcnt(24)
  s_add_u32 s22, s31, 98304
  buffer_load_dwordx4 v[248:251], v2, s[8:11], s22 offen offset:0 sc1
  buffer_load_dwordx4 v[252:255], v2, s[8:11], s22 offen offset:1024 sc1
  s_lshl_b32 s27, s17, 7
  s_add_u32 s27, s27, 88461312
  s_mov_b32 s30, 0
ch_vw2:
  buffer_load_dword v9, off, s[8:11], s27 sc1
  s_waitcnt vmcnt(0)
  v_cmp_ne_u32 vcc, 56, v9
  s_cbranch_vccz ch_vw2_d
  s_sleep 2
  s_add_u32 s30, s30, 1
  s_cmp_lt_u32 s30, 400000
  s_cbranch_scc1 ch_vw2
  s_branch cA_abort
ch_vw2_d:
  s_mov_b32 s28, s35
  s_waitcnt vmcnt(0) lgkmcnt(0)
  s_mov_b32 s31, 0
  s_cmp_lg_u32 s88, 0
  s_cbranch_scc1 cB_va2_loop
  s_branch cA_va2_loop
ch_init7:
  v_mov_b32 v72, v116
  v_mov_b32 v73, v117
  v_lshrrev_b32 v65, 1, v72
  v_and_b32 v66, 1, v72
  v_mov_b32 v36, 0
  v_mov_b32 v37, 0
  v_mov_b32 v38, 0
  v_mov_b32 v39, 0
  v_mov_b32 v40, 0
  v_mov_b32 v41, 0
  v_mov_b32 v42, 0
  v_mov_b32 v43, 0
  v_mov_b32 v44, 0
  v_mov_b32 v45, 0
  v_mov_b32 v46, 0
  v_mov_b32 v47, 0
  v_mov_b32 v48, 0
  v_mov_b32 v49, 0
  v_mov_b32 v50, 0
  v_mov_b32 v51, 0
  v_mov_b32 v52, 0
  v_mov_b32 v53, 0
  v_mov_b32 v54, 0
  v_mov_b32 v55, 0
  v_mov_b32 v56, 0
  v_mov_b32 v57, 0
  v_mov_b32 v58, 0
  v_mov_b32 v59, 0
  v_mov_b32 v60, 0
  v_mov_b32 v61, 0
  v_mov_b32 v62, 0
  v_mov_b32 v63, 0
  v_lshlrev_b32 v75, 2, v65
  v_lshl_add_u32 v75, v66, 3, v75
  v_add_u32 v67, 336, v73
  v_mul_u32_u24 v68, 2341, v67
  v_lshrrev_b32 v68, 16, v68
  v_mul_u32_u24 v69, 28, v68
  v_sub_u32 v69, v67, v69
  v_lshrrev_b32 v70, 4, v69
  v_and_b32 v69, 15, v69
  v_lshlrev_b32 v71, 12, v70
  v_lshl_add_u32 v71, v68, 8, v71
  v_lshl_add_u32 v71, v69, 4, v71
  v_add_u32 v104, v71, v75
  v_add_u32 v67, 352, v73
  v_mul_u32_u24 v68, 2341, v67
  v_lshrrev_b32 v68, 16, v68
  v_mul_u32_u24 v69, 28, v68
  v_sub_u32 v69, v67, v69
  v_lshrrev_b32 v70, 4, v69
  v_and_b32 v69, 15, v69
  v_lshlrev_b32 v71, 12, v70
  v_lshl_add_u32 v71, v68, 8, v71
  v_lshl_add_u32 v71, v69, 4, v71
  v_add_u32 v105, v71, v75
  v_add_u32 v67, 368, v73
  v_mul_u32_u24 v68, 2341, v67
  v_lshrrev_b32 v68, 16, v68
  v_mul_u32_u24 v69, 28, v68
  v_sub_u32 v69, v67, v69
  v_lshrrev_b32 v70, 4, v69
  v_and_b32 v69, 15, v69
  v_lshlrev_b32 v71, 12, v70
  v_lshl_add_u32 v71, v68, 8, v71
  v_lshl_add_u32 v71, v69, 4, v71
  v_add_u32 v106, v71, v75
  v_add_u32 v67, 384, v73
  v_mul_u32_u24 v68, 2341, v67
  v_lshrrev_b32 v68, 16, v68
  v_mul_u32_u24 v69, 28, v68
  v_sub_u32 v69, v67, v69
  v_lshrrev_b32 v70, 4, v69
  v_and_b32 v69, 15, v69
  v_lshlrev_b32 v71, 12, v70
  v_lshl_add_u32 v71, v68, 8, v71
  v_lshl_add_u32 v71, v69, 4, v71
  v_add_u32 v107, v71, v75
  v_add_u32 v67, 400, v73
  v_mul_u32_u24 v68, 2341, v67
  v_lshrrev_b32 v68, 16, v68
  v_mul_u32_u24 v69, 28, v68
  v_sub_u32 v69, v67, v69
  v_lshrrev_b32 v70, 4, v69
  v_and_b32 v69, 15, v69
  v_lshlrev_b32 v71, 12, v70
  v_lshl_add_u32 v71, v68, 8, v71
  v_lshl_add_u32 v71, v69, 4, v71
  v_add_u32 v108, v71, v75
  v_add_u32 v67, 416, v73
  v_mul_u32_u24 v68, 2341, v67
  v_lshrrev_b32 v68, 16, v68
  v_mul_u32_u24 v69, 28, v68
  v_sub_u32 v69, v67, v69
  v_lshrrev_b32 v70, 4, v69
  v_and_b32 v69, 15, v69
  v_lshlrev_b32 v71, 12, v70
  v_lshl_add_u32 v71, v68, 8, v71
  v_lshl_add_u32 v71, v69, 4, v71
  v_add_u32 v109, v71, v75
  v_add_u32 v67, 432, v73
  v_mul_u32_u24 v68, 2341, v67
  v_lshrrev_b32 v68, 16, v68
  v_mul_u32_u24 v69, 28, v68
  v_sub_u32 v69, v67, v69
  v_lshrrev_b32 v70, 4, v69
  v_and_b32 v69, 15, v69
  v_lshlrev_b32 v71, 12, v70
  v_lshl_add_u32 v71, v68, 8, v71
  v_lshl_add_u32 v71, v69, 4, v71
  v_add_u32 v110, v71, v75
  v_mov_b32 v74, 0x40000000
  v_mov_b32 v88, 0
  v_and_b32 v119, 15, v1
  s_and_b32 s22, s17, 0
  s_lshl_b32 s22, s22, 7
  s_add_u32 s22, s22, 75733504
  v_lshl_add_u32 v119, v119, 2, s22
  s_lshl_b32 s22, s17, 2
  s_add_u32 s22, s22, 75731456
  v_lshl_add_u32 v118, v1, 7, s22
  v_cmp_gt_u32 vcc, 1, v1
  s_nop 1
  v_cndmask_b32 v118, v74, v118, vcc
  s_lshl_b32 s35, s17, 7
  s_add_u32 s35, s35, 88461312
  v_min_u32 v116, 13, v1
  s_mul_i32 s22, s17, 14
  v_add_u32 v116, s22, v116
  v_lshlrev_b32 v116, 7, v116
  s_mul_i32 s31, s17, 401408
  s_add_u32 s31, s31, 6723584
  s_mov_b32 s30, 0
ch_wr7:
  buffer_load_dword v9, off, s[12:15], 0 offset:132 sc1
  s_waitcnt vmcnt(0)
  v_cmp_ne_u32 vcc, 1, v9
  s_cbranch_vccz ch_wr7_ok
  s_sleep 8
  s_add_u32 s30, s30, 1
  s_cmp_lt_u32 s30, 400000
  s_cbranch_scc1 ch_wr7
  s_branch cA_abort
ch_wr7_ok:
  s_lshr_b32 s22, s17, 2
  s_lshl_b32 s28, 0x81, s22
  s_mul_i32 s27, s17, 12
  s_add_u32 s22, s27, 256
  s_lshr_b32 s22, s22, 6
  s_lshl_b32 s22, 0x81, s22
  s_or_b32 s28, s28, s22
  s_add_u32 s22, s27, 267
  s_lshr_b32 s22, s22, 6
  s_lshl_b32 s22, 0x81, s22
  s_or_b32 s28, s28, s22
  v_lshrrev_b32 v12, 8, v2
  v_lshlrev_b32 v12, 7, v12
  s_mov_b32 s27, 88520704
  s_mov_b32 s30, 0
ch_ww7:
  buffer_load_dword v9, v12, s[8:11], s27 offen sc1
  s_waitcnt vmcnt(0)
  v_and_b32 v10, s28, v9
  v_cmp_ne_u32 vcc, s28, v10
  s_cbranch_vccz ch_ww7_ok
  s_sleep 3
  s_add_u32 s30, s30, 1
  s_cmp_lt_u32 s30, 400000
  s_cbranch_scc1 ch_ww7
  s_branch cA_abort
ch_ww7_ok:
  s_add_u32 s22, s31, 0
  buffer_load_dwordx4 a[0:3], v2, s[8:11], s22 offen offset:0 sc1
  buffer_load_dwordx4 a[4:7], v2, s[8:11], s22 offen offset:1024 sc1
  buffer_load_dwordx4 a[8:11], v2, s[8:11], s22 offen offset:2048 sc1
  buffer_load_dwordx4 a[12:15], v2, s[8:11], s22 offen offset:3072 sc1
  s_add_u32 s22, s31, 4096
  buffer_load_dwordx4 a[16:19], v2, s[8:11], s22 offen offset:0 sc1
  buffer_load_dwordx4 a[20:23], v2, s[8:11], s22 offen offset:1024 sc1
  buffer_load_dwordx4 a[24:27], v2, s[8:11], s22 offen offset:2048 sc1
  buffer_load_dwordx4 a[28:31], v2, s[8:11], s22 offen offset:3072 sc1
  s_add_u32 s22, s31, 8192
  buffer_load_dwordx4 a[32:35], v2, s[8:11], s22 offen offset:0 sc1
  buffer_load_dwordx4 a[36:39], v2, s[8:11], s22 offen offset:1024 sc1
  buffer_load_dwordx4 a[40:43], v2, s[8:11], s22 offen offset:2048 sc1
  buffer_load_dwordx4 a[44:47], v2, s[8:11], s22 offen offset:3072 sc1
  s_add_u32 s22, s31, 12288
  buffer_load_dwordx4 a[48:51], v2, s[8:11], s22 offen offset:0 sc1
  buffer_load_dwordx4 a[52:55], v2, s[8:11], s22 offen offset:1024 sc1
  buffer_load_dwordx4 a[56:59], v2, s[8:11], s22 offen offset:2048 sc1
  buffer_load_dwordx4 a[60:63], v2, s[8:11], s22 offen offset:3072 sc1
  s_add_u32 s22, s31, 16384
  buffer_load_dwordx4 a[64:67], v2, s[8:11], s22 offen offset:0 sc1
  buffer_load_dwordx4 a[68:71], v2, s[8:11], s22 offen offset:1024 sc1
  buffer_load_dwordx4 a[72:75], v2, s[8:11], s22 offen offset:2048 sc1
  buffer_load_dwordx4 a[76:79], v2, s[8:11], s22 offen offset:3072 sc1
  s_add_u32 s22, s31, 20480
  buffer_load_dwordx4 a[80:83], v2, s[8:11], s22 offen offset:0 sc1
  buffer_load_dwordx4 a[84:87], v2, s[8:11], s22 offen offset:1024 sc1
  buffer_load_dwordx4 a[88:91], v2, s[8:11], s22 offen offset:2048 sc1
  buffer_load_dwordx4 a[92:95], v2, s[8:11], s22 offen offset:3072 sc1
  s_add_u32 s22, s31, 24576
  buffer_load_dwordx4 a[96:99], v2, s[8:11], s22 offen offset:0 sc1
  buffer_load_dwordx4 a[100:103], v2, s[8:11], s22 offen offset:1024 sc1
  buffer_load_dwordx4 a[104:107], v2, s[8:11], s22 offen offset:2048 sc1
  buffer_load_dwordx4 a[108:111], v2, s[8:11], s22 offen offset:3072 sc1
  s_add_u32 s22, s31, 28672
  buffer_load_dwordx4 a[112:115], v2, s[8:11], s22 offen offset:0 sc1
  buffer_load_dwordx4 a[116:119], v2, s[8:11], s22 offen offset:1024 sc1
  buffer_load_dwordx4 a[120:123], v2, s[8:11], s22 offen offset:2048 sc1
  buffer_load_dwordx4 a[124:127], v2, s[8:11], s22 offen offset:3072 sc1
  s_waitcnt vmcnt(24)
  s_add_u32 s22, s31, 32768
  buffer_load_dwordx4 a[128:131], v2, s[8:11], s22 offen offset:0 sc1
  buffer_load_dwordx4 a[132:135], v2, s[8:11], s22 offen offset:1024 sc1
  buffer_load_dwordx4 a[136:139], v2, s[8:11], s22 offen offset:2048 sc1
  buffer_load_dwordx4 a[140:143], v2, s[8:11], s22 offen offset:3072 sc1
  s_add_u32 s22, s31, 36864
  buffer_load_dwordx4 a[144:147], v2, s[8:11], s22 offen offset:0 sc1
  buffer_load_dwordx4 a[148:151], v2, s[8:11], s22 offen offset:1024 sc1
  buffer_load_dwordx4 a[152:155], v2, s[8:11], s22 offen offset:2048 sc1
  buffer_load_dwordx4 a[156:159], v2, s[8:11], s22 offen offset:3072 sc1
  s_add_u32 s22, s31, 40960
  buffer_load_dwordx4 a[160:163], v2, s[8:11], s22 offen offset:0 sc1
  buffer_load_dwordx4 a[164:167], v2, s[8:11], s22 offen offset:1024 sc1
  buffer_load_dwordx4 a[168:171], v2, s[8:11], s22 offen offset:2048 sc1
  buffer_load_dwordx4 a[172:175], v2, s[8:11], s22 offen offset:3072 sc1
  s_add_u32 s22, s31, 45056
  buffer_load_dwordx4 a[176:179], v2, s[8:11], s22 offen offset:0 sc1
  buffer_load_dwordx4 a[180:183], v2, s[8:11], s22 offen offset:1024 sc1
  buffer_load_dwordx4 a[184:187], v2, s[8:11], s22 offen offset:2048 sc1
  buffer_load_dwordx4 a[188:191], v2, s[8:11], s22 offen offset:3072 sc1
  s_add_u32 s22, s31, 49152
  buffer_load_dwordx4 a[192:195], v2, s[8:11], s22 offen offset:0 sc1
  buffer_load_dwordx4 a[196:199], v2, s[8:11], s22 offen offset:1024 sc1
  buffer_load_dwordx4 a[200:203], v2, s[8:11], s22 offen offset:2048 sc1
  buffer_load_dwordx4 a[204:207], v2, s[8:11], s22 offen offset:3072 sc1
  s_add_u32 s22, s31, 53248
  buffer_load_dwordx4 a[208:211], v2, s[8:11], s22 offen offset:0 sc1
  buffer_load_dwordx4 a[212:215], v2, s[8:11], s22 offen offset:1024 sc1
  buffer_load_dwordx4 a[216:219], v2, s[8:11], s22 offen offset:2048 sc1
  buffer_load_dwordx4 a[220:223], v2, s[8:11], s22 offen offset:3072 sc1
  s_add_u32 s22, s31, 57344
  buffer_load_dwordx4 a[224:227], v2, s[8:11], s22 offen offset:0 sc1
  buffer_load_dwordx4 a[228:231], v2, s[8:11], s22 offen offset:1024 sc1
  buffer_load_dwordx4 a[232:235], v2, s[8:11], s22 offen offset:2048 sc1
  buffer_load_dwordx4 a[236:239], v2, s[8:11], s22 offen offset:3072 sc1
  s_add_u32 s22, s31, 61440
  buffer_load_dwordx4 a[240:243], v2, s[8:11], s22 offen offset:0 sc1
  buffer_load_dwordx4 a[244:247], v2, s[8:11], s22 offen offset:1024 sc1
  buffer_load_dwordx4 a[248:251], v2, s[8:11], s22 offen offset:2048 sc1
  buffer_load_dwordx4 a[252:255], v2, s[8:11], s22 offen offset:3072 sc1
  s_waitcnt vmcnt(24)
  s_add_u32 s22, s31, 65536
  buffer_load_dwordx4 v[120:123], v2, s[8:11], s22 offen offset:0 sc1
  buffer_load_dwordx4 v[124:127], v2, s[8:11], s22 offen offset:1024 sc1
  buffer_load_dwordx4 v[128:131], v2, s[8:11], s22 offen offset:2048 sc1
  buffer_load_dwordx4 v[132:135], v2, s[8:11], s22 offen offset:3072 sc1
  s_add_u32 s22, s31, 69632
  buffer_load_dwordx4 v[136:139], v2, s[8:11], s22 offen offset:0 sc1
  buffer_load_dwordx4 v[140:143], v2, s[8:11], s22 offen offset:1024 sc1
  buffer_load_dwordx4 v[144:147], v2, s[8:11], s22 offen offset:2048 sc1
  buffer_load_dwordx4 v[148:151], v2, s[8:11], s22 offen offset:3072 sc1
  s_add_u32 s22, s31, 73728
  buffer_load_dwordx4 v[152:155], v2, s[8:11], s22 offen offset:0 sc1
  buffer_load_dwordx4 v[156:159], v2, s[8:11], s22 offen offset:1024 sc1
  buffer_load_dwordx4 v[160:163], v2, s[8:11], s22 offen offset:2048 sc1
  buffer_load_dwordx4 v[164:167], v2, s[8:11], s22 offen offset:3072 sc1
  s_add_u32 s22, s31, 77824
  buffer_load_dwordx4 v[168:171], v2, s[8:11], s22 offen offset:0 sc1
  buffer_load_dwordx4 v[172:175], v2, s[8:11], s22 offen offset:1024 sc1
  buffer_load_dwordx4 v[176:179], v2, s[8:11], s22 offen offset:2048 sc1
  buffer_load_dwordx4 v[180:183], v2, s[8:11], s22 offen offset:3072 sc1
  s_add_u32 s22, s31, 81920
  buffer_load_dwordx4 v[184:187], v2, s[8:11], s22 offen offset:0 sc1
  buffer_load_dwordx4 v[188:191], v2, s[8:11], s22 offen offset:1024 sc1
  buffer_load_dwordx4 v[192:195], v2, s[8:11], s22 offen offset:2048 sc1
  buffer_load_dwordx4 v[196:199], v2, s[8:11], s22 offen offset:3072 sc1
  s_add_u32 s22, s31, 86016
  buffer_load_dwordx4 v[200:203], v2, s[8:11], s22 offen offset:0 sc1
  buffer_load_dwordx4 v[204:207], v2, s[8:11], s22 offen offset:1024 sc1
  buffer_load_dwordx4 v[208:211], v2, s[8:11], s22 offen offset:2048 sc1
  buffer_load_dwordx4 v[212:215], v2, s[8:11], s22 offen offset:3072 sc1
  s_add_u32 s22, s31, 90112
  buffer_load_dwordx4 v[216:219], v2, s[8:11], s22 offen offset:0 sc1
  buffer_load_dwordx4 v[220:223], v2, s[8:11], s22 offen offset:1024 sc1
  buffer_load_dwordx4 v[224:227], v2, s[8:11], s22 offen offset:2048 sc1
  buffer_load_dwordx4 v[228:231], v2, s[8:11], s22 offen offset:3072 sc1
  s_add_u32 s22, s31, 94208
  buffer_load_dwordx4 v[232:235], v2, s[8:11], s22 offen offset:0 sc1
  buffer_load_dwordx4 v[236:239], v2, s[8:11], s22 offen offset:1024 sc1
  buffer_load_dwordx4 v[240:243], v2, s[8:11], s22 offen offset:2048 sc1
  buffer_load_dwordx4 v[244:247], v2, s[8:11], s22 offen offset:3072 sc1
  s_waitcnt vmcnt(24)
  s_add_u32 s22, s31, 98304
  buffer_load_dwordx4 v[248:251], v2, s[8:11], s22 offen offset:0 sc1
  buffer_load_dwordx4 v[252:255], v2, s[8:11], s22 offen offset:1024 sc1
  s_lshl_b32 s27, s17, 7
  s_add_u32 s27, s27, 88461312
  s_mov_b32 s30, 0
ch_vw3:
  buffer_load_dword v9, off, s[8:11], s27 sc1
  s_waitcnt vmcnt(0)
  v_cmp_ne_u32 vcc, 56, v9
  s_cbranch_vccz ch_vw3_d
  s_sleep 2
  s_add_u32 s30, s30, 1
  s_cmp_lt_u32 s30, 400000
  s_cbranch_scc1 ch_vw3
  s_branch cA_abort
ch_vw3_d:
  s_mov_b32 s28, s35
  s_mov_b32 s39, 72052736
  buffer_load_dword v100, v116, s[8:11], s39 offen sc1
  s_mov_b32 s39, 72081408
  s_waitcnt vmcnt(1) lgkmcnt(0)
  s_mov_b32 s31, 0
  s_cmp_lg_u32 s88, 0
  s_cbranch_scc1 cB_va3_loop
  s_branch cA_va3_loop
.p2align 6
cA_sc0_loop:
  s_mov_b32 s30, 0
  s_mov_b32 s62, 0
  s_setprio 3
  s_sleep 6
cA_sc0_fp_l:
  v_cmp_gt_u32 vcc, s19, v112
  buffer_load_dword v112, v0, s[8:11], 0 offen sc1
  s_cbranch_vccz cA_sc0_fp_d
  v_cmp_gt_u32 vcc, s19, v112
  buffer_load_dword v112, v0, s[8:11], 0 offen sc1
  s_cbranch_vccz cA_sc0_fp_d
  v_cmp_gt_u32 vcc, s19, v112
  buffer_load_dword v112, v0, s[8:11], 0 offen sc1
  s_cbranch_vccz cA_sc0_fp_d
  v_cmp_gt_u32 vcc, s19, v112
  buffer_load_dword v112, v0, s[8:11], 0 offen sc1
  s_cbranch_vccz cA_sc0_fp_d
  v_cmp_gt_u32 vcc, s19, v112
  buffer_load_dword v112, v0, s[8:11], 0 offen sc1
  s_cbranch_vccz cA_sc0_fp_d
  v_cmp_gt_u32 vcc, s19, v112
  buffer_load_dword v112, v0, s[8:11], 0 offen sc1
  s_cbranch_vccz cA_sc0_fp_d
  v_cmp_gt_u32 vcc, s19, v112
  buffer_load_dword v112, v0, s[8:11], 0 offen sc1
  s_cbranch_vccz cA_sc0_fp_d
  v_cmp_gt_u32 vcc, s19, v112
  buffer_load_dword v112, v0, s[8:11], 0 offen sc1
  s_cbranch_vccz cA_sc0_fp_d
  v_cmp_gt_u32 vcc, s19, v112
  buffer_load_dword v112, v0, s[8:11], 0 offen sc1
  s_cbranch_vccz cA_sc0_fp_d
  v_cmp_gt_u32 vcc, s19, v112
  buffer_load_dword v112, v0, s[8:11], 0 offen sc1
  s_cbranch_vccz cA_sc0_fp_d
  v_cmp_gt_u32 vcc, s19, v112
  buffer_load_dword v112, v0, s[8:11], 0 offen sc1
  s_cbranch_vccz cA_sc0_fp_d
  v_cmp_gt_u32 vcc, s19, v112
  buffer_load_dword v112, v0, s[8:11], 0 offen sc1
  s_cbranch_vccz cA_sc0_fp_d
  v_cmp_gt_u32 vcc, s19, v112
  buffer_load_dword v112, v0, s[8:11], 0 offen sc1
  s_cbranch_vccz cA_sc0_fp_d
  v_cmp_gt_u32 vcc, s19, v112
  buffer_load_dword v112, v0, s[8:11], 0 offen sc1
  s_cbranch_vccz cA_sc0_fp_d
  v_cmp_gt_u32 vcc, s19, v112
  buffer_load_dword v112, v0, s[8:11], 0 offen sc1
  s_cbranch_vccz cA_sc0_fp_d
  v_cmp_gt_u32 vcc, s19, v112
  buffer_load_dword v112, v0, s[8:11], 0 offen sc1
  s_cbranch_vccz cA_sc0_fp_d
  s_waitcnt vmcnt(24)
  s_add_u32 s30, s30, 1
  s_cmp_lt_u32 s30, 400000
  s_cbranch_scc1 cA_sc0_fp_l
  s_branch cA_abort
cA_sc0_fp_d:
  buffer_load_dwordx4 v[8:11], v2, s[8:11], s20 offen offset:0 sc1
  s_barrier
  s_setprio 2
  buffer_load_dwordx4 v[12:15], v2, s[8:11], s20 offen offset:1024 sc1
  s_setprio 1
  buffer_load_dwordx4 v[16:19], v2, s[8:11], s20 offen offset:2048 sc1
  s_setprio 0
  buffer_load_dwordx4 v[20:23], v2, s[8:11], s20 offen offset:3072 sc1
cA_sc0_go:
  s_waitcnt vmcnt(3)
  v_smfmac_f32_16x16x64_bf16 v[36:39], v[8:11], a[0:7], v3
  buffer_load_dwordx4 v[32:35], v2, s[8:11], s23 offen offset:0 sc1
  v_cmp_eq_u32 vcc, -1, v8
  v_smfmac_f32_16x16x64_bf16 v[40:43], v[8:11], a[56:63], v3
  v_smfmac_f32_16x16x64_bf16 v[44:47], v[8:11], a[112:119], v3
  buffer_load_dwordx4 v[24:27], v2, s[8:11], s23 offen offset:1024 sc1
  s_cbranch_vccnz cA_sc0_r0
  v_smfmac_f32_16x16x64_bf16 v[48:51], v[8:11], a[168:175], v3
  v_smfmac_f32_16x16x64_bf16 v[52:55], v[8:11], a[224:231], v3
  s_waitcnt vmcnt(4)
  v_cmp_eq_u32 vcc, -1, v12
  v_smfmac_f32_16x16x64_bf16 v[56:59], v[8:11], v[144:151], v3
  buffer_load_dwordx4 v[28:31], v2, s[8:11], s23 offen offset:2048 sc1
  v_smfmac_f32_16x16x64_bf16 v[60:63], v[8:11], v[200:207], v3
  s_cbranch_vccnz cA_sc0_r1
cA_sc0_c1:
  v_smfmac_f32_16x16x64_bf16 v[36:39], v[12:15], a[8:15], v3
  v_smfmac_f32_16x16x64_bf16 v[40:43], v[12:15], a[64:71], v3
  v_smfmac_f32_16x16x64_bf16 v[44:47], v[12:15], a[120:127], v3
  v_smfmac_f32_16x16x64_bf16 v[48:51], v[12:15], a[176:183], v3
  v_smfmac_f32_16x16x64_bf16 v[52:55], v[12:15], a[232:239], v3
  s_waitcnt vmcnt(4)
  v_cmp_eq_u32 vcc, -1, v16
  v_smfmac_f32_16x16x64_bf16 v[56:59], v[12:15], v[152:159], v3
  buffer_load_dwordx4 v[88:91], v117, s[8:11], s26 offen offset:0 sc1
  v_smfmac_f32_16x16x64_bf16 v[60:63], v[12:15], v[208:215], v3
  s_cbranch_vccnz cA_sc0_r2
cA_sc0_c2:
  v_smfmac_f32_16x16x64_bf16 v[36:39], v[16:19], a[16:23], v3
  v_smfmac_f32_16x16x64_bf16 v[40:43], v[16:19], a[72:79], v3
  v_smfmac_f32_16x16x64_bf16 v[44:47], v[16:19], a[128:135], v3
  buffer_load_dwordx4 v[92:95], v117, s[8:11], s26 offen offset:1024 sc1
  v_smfmac_f32_16x16x64_bf16 v[48:51], v[16:19], a[184:191], v3
  v_smfmac_f32_16x16x64_bf16 v[52:55], v[16:19], a[240:247], v3
  s_waitcnt vmcnt(5)
  v_cmp_eq_u32 vcc, -1, v20
  v_smfmac_f32_16x16x64_bf16 v[56:59], v[16:19], v[160:167], v3
  v_smfmac_f32_16x16x64_bf16 v[60:63], v[16:19], v[216:223], v3
  buffer_load_dwordx4 v[96:99], v2, s[8:11], s24 offen offset:0 sc1
  s_cbranch_vccnz cA_sc0_r3
cA_sc0_c3:
  v_smfmac_f32_16x16x64_bf16 v[36:39], v[20:23], a[24:31], v3
  v_smfmac_f32_16x16x64_bf16 v[40:43], v[20:23], a[80:87], v3
  s_waitcnt vmcnt(3)
  v_max3_u32 v66, v24, v27, v28
  v_smfmac_f32_16x16x64_bf16 v[44:47], v[20:23], a[136:143], v3
  v_max3_u32 v66, v66, v31, v32
  v_smfmac_f32_16x16x64_bf16 v[48:51], v[20:23], a[192:199], v3
  buffer_load_dwordx4 v[100:103], v2, s[8:11], s24 offen offset:1024 sc1
  v_max_u32 v66, v66, v35
  v_smfmac_f32_16x16x64_bf16 v[52:55], v[20:23], a[248:255], v3
  v_cmp_eq_u32 vcc, -1, v66
  v_smfmac_f32_16x16x64_bf16 v[56:59], v[20:23], v[168:175], v3
  v_smfmac_f32_16x16x64_bf16 v[60:63], v[20:23], v[224:231], v3
  s_cbranch_vccnz cA_sc0_r4
cA_sc0_c4:
  v_smfmac_f32_16x16x64_bf16 v[60:63], v[32:35], v[232:239], v3
  buffer_load_dwordx4 v[104:107], v2, s[8:11], s26 offen offset:0 sc1
  v_smfmac_f32_16x16x64_bf16 v[60:63], v[24:27], v[240:247], v3
  v_smfmac_f32_16x16x64_bf16 v[60:63], v[28:31], v[248:255], v3
  v_smfmac_f32_16x16x64_bf16 v[52:55], v[32:35], v[120:127], v3
  v_smfmac_f32_16x16x64_bf16 v[52:55], v[24:27], v[128:135], v3
  buffer_load_dwordx4 v[108:111], v2, s[8:11], s26 offen offset:1024 sc1
  v_smfmac_f32_16x16x64_bf16 v[52:55], v[28:31], v[136:143], v3
  v_cvt_pk_bf16_f32 v63, v62, v63
  v_smfmac_f32_16x16x64_bf16 v[56:59], v[32:35], v[176:183], v3
  v_cvt_pk_bf16_f32 v62, v60, v61
  v_smfmac_f32_16x16x64_bf16 v[56:59], v[24:27], v[184:191], v3
  v_mfma_f32_16x16x32_bf16 v[12:15], v[62:65], v[4:7], 0
  v_cvt_pk_bf16_f32 v55, v54, v55
  v_smfmac_f32_16x16x64_bf16 v[56:59], v[28:31], v[192:199], v3
  v_cvt_pk_bf16_f32 v54, v52, v53
  v_smfmac_f32_16x16x64_bf16 v[36:39], v[32:35], a[32:39], v3
  s_nop 1
  v_cvt_pk_bf16_f32 v76, v12, v13
  v_smfmac_f32_16x16x64_bf16 v[36:39], v[24:27], a[40:47], v3
  v_cvt_pk_bf16_f32 v77, v14, v15
  v_smfmac_f32_16x16x64_bf16 v[36:39], v[28:31], a[48:55], v3
  v_cvt_pk_bf16_f32 v56, v56, v57
  v_smfmac_f32_16x16x64_bf16 v[40:43], v[32:35], a[88:95], v3
  v_cvt_pk_bf16_f32 v57, v58, v59
  v_smfmac_f32_16x16x64_bf16 v[40:43], v[24:27], a[96:103], v3
  v_mfma_f32_16x16x32_bf16 v[16:19], v[54:57], v[4:7], 0
  v_cvt_pk_bf16_f32 v39, v38, v39
  v_smfmac_f32_16x16x64_bf16 v[40:43], v[28:31], a[104:111], v3
  v_cvt_pk_bf16_f32 v38, v36, v37
  v_smfmac_f32_16x16x64_bf16 v[44:47], v[32:35], a[144:151], v3
  s_nop 1
  v_cvt_pk_bf16_f32 v78, v16, v17
  v_smfmac_f32_16x16x64_bf16 v[44:47], v[24:27], a[152:159], v3
  v_cvt_pk_bf16_f32 v79, v18, v19
  v_smfmac_f32_16x16x64_bf16 v[44:47], v[28:31], a[160:167], v3
  v_cvt_pk_bf16_f32 v40, v40, v41
  v_smfmac_f32_16x16x64_bf16 v[48:51], v[32:35], a[200:207], v3
  v_cvt_pk_bf16_f32 v41, v42, v43
  v_smfmac_f32_16x16x64_bf16 v[48:51], v[24:27], a[208:215], v3
  v_smfmac_f32_16x16x64_bf16 v[48:51], v[28:31], a[216:223], v3
  s_waitcnt vmcnt(4)
  v_cvt_pk_bf16_f32 v47, v46, v47
  v_smfmac_f32_16x16x64_bf16 v[68:71], v[76:79], v[80:87], v3
  v_cvt_pk_bf16_f32 v46, v44, v45
  v_mfma_f32_16x16x32_bf16 v[12:15], v[38:41], v[4:7], 0
  s_nop 1
  v_cvt_pk_bf16_f32 v48, v48, v49
  v_cvt_pk_bf16_f32 v49, v50, v51
  s_nop 1
  v_mfma_f32_16x16x32_bf16 v[16:19], v[46:49], v[4:7], 0
  v_smfmac_f32_16x16x64_bf16 v[72:75], v[76:79], v[88:95], v3
  v_cvt_pk_bf16_f32 v20, v12, v13
  v_mfma_f32_16x16x32_bf16 v[52:55], v[30:33], v[76:79], 0
  s_waitcnt vmcnt(0)
  v_cvt_pk_bf16_f32 v21, v14, v15
  v_cvt_pk_bf16_f32 v22, v16, v17
  v_cvt_pk_bf16_f32 v23, v18, v19
  s_nop 1
  v_mfma_f32_16x16x32_bf16 v[52:55], v[8:11], v[20:23], v[52:55]
  v_smfmac_f32_16x16x64_bf16 v[68:71], v[20:23], v[96:103], v3
  v_smfmac_f32_16x16x64_bf16 v[72:75], v[20:23], v[104:111], v3
  s_nop 1
  ds_write_b128 v113, v[52:55]
  s_nop 1
  v_permlane32_swap_b32 v68, v70
  v_permlane32_swap_b32 v69, v71
  v_add_f32 v56, v68, v70
  v_add_f32 v58, v69, v71
  v_permlane32_swap_b32 v72, v74
  v_permlane32_swap_b32 v73, v75
  v_add_f32 v57, v72, v74
  v_add_f32 v59, v73, v75
  ds_write_b128 v2, v[56:59] offset:0
  v_cmp_u_f32 vcc, v57, v59
  v_mov_b32 v68, 0
  v_mov_b32 v69, 0
  v_mov_b32 v70, 0
  v_mov_b32 v71, 0
  s_cbranch_vccnz cA_sc0_retry
cA_sc0_cont:
  s_add_u32 s24, s24, 28672
  s_add_u32 s26, s26, 28672
  buffer_load_dwordx4 v[80:83], v117, s[8:11], s24 offen offset:0 sc1
  buffer_load_dwordx4 v[84:87], v117, s[8:11], s24 offen offset:1024 sc1
  v_mov_b32 v72, 0
  v_mov_b32 v73, 0
  v_mfma_f32_32x32x16_bf16 v[36:51], v[68:71], v[68:71], 0
  s_waitcnt lgkmcnt(0)
  s_barrier
  ds_read_b64 v[8:9], v114 offset:0
  ds_read_b64 v[10:11], v114 offset:1024
  ds_read_b64 v[12:13], v114 offset:2048
  ds_read_b64 v[14:15], v114 offset:3072
  ds_read2_b32 v[16:17], v115 offset0:0 offset1:64
  ds_read2_b32 v[18:19], v115 offset0:128 offset1:192
  v_mfma_f32_32x32x16_bf16 v[52:67], v[68:71], v[68:71], 0
  s_waitcnt lgkmcnt(0)
  v_pk_add_f32 v[16:17], v[16:17], v[18:19]
  v_pk_add_f32 v[8:9], v[8:9], v[10:11]
  v_pk_add_f32 v[12:13], v[12:13], v[14:15]
  v_add_f32 v20, v16, v17
  v_pk_add_f32 v[8:9], v[8:9], v[12:13]
  v_max_f32 v22, v8, v9
  v_add_f32_dpp v20, v20, v20 row_ror:8 row_mask:0xf bank_mask:0xf
  s_nop 0
  v_max_f32_dpp v22, v22, v22 row_ror:8 row_mask:0xf bank_mask:0xf
  v_max_f32 v22, v22, v20
  s_nop 1
  v_max_f32_dpp v22, v22, v22 quad_perm:[1,0,3,2] row_mask:0xf bank_mask:0xf
  s_nop 1
  v_max_f32_dpp v22, v22, v22 quad_perm:[2,3,0,1] row_mask:0xf bank_mask:0xf
  s_nop 1
  v_max_f32_dpp v22, v22, v22 row_half_mirror row_mask:0xf bank_mask:0xf
  v_pk_add_f32 v[8:9], v[8:9], v[22:23] op_sel_hi:[1,0] neg_lo:[0,1] neg_hi:[0,1]
  v_sub_f32 v20, v20, v22
  v_exp_f32 v8, v8
  v_exp_f32 v9, v9
  v_exp_f32 v20, v20
  v_add_f32 v24, v8, v9
  v_fmac_f32 v24, 0.5, v20
  v_mov_b32_dpp v21, v20 quad_perm:[1,0,3,2] row_mask:0xf bank_mask:0xf
  s_nop 0
  v_add_f32_dpp v24, v24, v24 quad_perm:[1,0,3,2] row_mask:0xf bank_mask:0xf
  s_nop 1
  v_add_f32_dpp v24, v24, v24 quad_perm:[2,3,0,1] row_mask:0xf bank_mask:0xf
  s_nop 1
  v_add_f32_dpp v24, v24, v24 row_half_mirror row_mask:0xf bank_mask:0xf
  s_nop 1
  v_add_f32_dpp v24, v24, v24 row_ror:8 row_mask:0xf bank_mask:0xf
  v_rcp_f32 v24, v24
  s_nop 0
  v_pk_mul_f32 v[8:9], v[8:9], v[24:25] op_sel_hi:[1,0]
  v_pk_mul_f32 v[20:21], v[20:21], v[24:25] op_sel_hi:[1,0]
  v_cvt_pk_bf16_f32 v8, v8, v9
  v_cvt_pk_bf16_f32 v20, v20, v21
  v_min_u32 v8, -2, v8
  buffer_store_dword v8, v1, s[8:11], s20 offen
  v_min_u32 v20, -2, v20
  buffer_store_dword v20, v118, s[8:11], s20 offen
  v_mov_b32 v74, 0
  v_mov_b32 v75, 0
  s_mov_b32 s19, s18
  s_add_u32 s18, s18, 1
  s_mov_b32 s22, s20
  s_mov_b32 s20, s21
  s_mov_b32 s21, s22
  s_add_u32 s23, s20, 4096
  s_cmp_lt_u32 s19, 63
  s_cbranch_scc1 cA_sc0_loop
  s_branch cA_done
cA_sc0_r0:
  s_add_u32 s31, s31, 1
  buffer_load_dwordx4 v[8:11], v2, s[8:11], s20 offen offset:0 sc1
  s_waitcnt vmcnt(0)
  v_cmp_eq_u32 vcc, -1, v8
  v_mov_b32 v36, 0
  v_mov_b32 v37, 0
  v_mov_b32 v38, 0
  v_mov_b32 v39, 0
  v_mov_b32 v40, 0
  v_mov_b32 v41, 0
  v_mov_b32 v42, 0
  v_mov_b32 v43, 0
  v_mov_b32 v44, 0
  v_mov_b32 v45, 0
  v_mov_b32 v46, 0
  v_mov_b32 v47, 0
  v_mov_b32 v48, 0
  v_mov_b32 v49, 0
  v_mov_b32 v50, 0
  v_mov_b32 v51, 0
  s_nop 1
  s_cbranch_vccz cA_sc0_go
  s_add_u32 s30, s30, 1
  s_cmp_lt_u32 s30, 400000
  s_cbranch_scc1 cA_sc0_r0
  s_branch cA_abort
cA_sc0_r1:
  s_add_u32 s31, s31, 1
  buffer_load_dwordx4 v[12:15], v2, s[8:11], s20 offen offset:1024 sc1
  s_waitcnt vmcnt(0)
  v_cmp_eq_u32 vcc, -1, v12
  s_nop 4
  s_cbranch_vccz cA_sc0_c1
  s_add_u32 s30, s30, 1
  s_cmp_lt_u32 s30, 400000
  s_cbranch_scc1 cA_sc0_r1
  s_branch cA_abort
cA_sc0_r2:
  s_add_u32 s31, s31, 1
  buffer_load_dwordx4 v[16:19], v2, s[8:11], s20 offen offset:2048 sc1
  s_waitcnt vmcnt(0)
  v_cmp_eq_u32 vcc, -1, v16
  s_nop 4
  s_cbranch_vccz cA_sc0_c2
  s_add_u32 s30, s30, 1
  s_cmp_lt_u32 s30, 400000
  s_cbranch_scc1 cA_sc0_r2
  s_branch cA_abort
cA_sc0_r3:
  s_add_u32 s31, s31, 1
  buffer_load_dwordx4 v[20:23], v2, s[8:11], s20 offen offset:3072 sc1
  s_waitcnt vmcnt(0)
  v_cmp_eq_u32 vcc, -1, v20
  s_nop 4
  s_cbranch_vccz cA_sc0_c3
  s_add_u32 s30, s30, 1
  s_cmp_lt_u32 s30, 400000
  s_cbranch_scc1 cA_sc0_r3
  s_branch cA_abort
cA_sc0_r4:
  s_add_u32 s31, s31, 1
  buffer_load_dwordx4 v[32:35], v2, s[8:11], s23 offen offset:0 sc1
  buffer_load_dwordx4 v[24:27], v2, s[8:11], s23 offen offset:1024 sc1
  buffer_load_dwordx4 v[28:31], v2, s[8:11], s23 offen offset:2048 sc1
  s_waitcnt vmcnt(0)
  v_max3_u32 v66, v24, v27, v28
  v_max3_u32 v66, v66, v31, v32
  v_max_u32 v66, v66, v35
  v_cmp_eq_u32 vcc, -1, v66
  s_nop 4
  s_cbranch_vccz cA_sc0_c4
  s_add_u32 s30, s30, 1
  s_cmp_lt_u32 s30, 400000
  s_cbranch_scc1 cA_sc0_r4
  s_branch cA_abort
cA_sc0_retry:
  s_cmp_lg_u32 s62, 0
  s_cbranch_scc1 cA_sc0_cont
  s_waitcnt vmcnt(0) lgkmcnt(0)
cA_sc0_rv:
  buffer_load_dwordx4 v[8:11], v2, s[8:11], s20 offen offset:0 sc1
  buffer_load_dwordx4 v[12:15], v2, s[8:11], s20 offen offset:1024 sc1
  buffer_load_dwordx4 v[16:19], v2, s[8:11], s20 offen offset:2048 sc1
  buffer_load_dwordx4 v[20:23], v2, s[8:11], s20 offen offset:3072 sc1
  buffer_load_dwordx4 v[32:35], v2, s[8:11], s23 offen offset:0 sc1
  buffer_load_dwordx4 v[24:27], v2, s[8:11], s23 offen offset:1024 sc1
  buffer_load_dwordx4 v[28:31], v2, s[8:11], s23 offen offset:2048 sc1
  s_waitcnt vmcnt(0)
  v_pk_max_u16 v66, v8, v9
  v_pk_max_u16 v66, v66, v10
  v_pk_max_u16 v66, v66, v11
  v_pk_max_u16 v66, v66, v12
  v_pk_max_u16 v66, v66, v13
  v_pk_max_u16 v66, v66, v14
  v_pk_max_u16 v66, v66, v15
  v_pk_max_u16 v66, v66, v16
  v_pk_max_u16 v66, v66, v17
  v_pk_max_u16 v66, v66, v18
  v_pk_max_u16 v66, v66, v19
  v_pk_max_u16 v66, v66, v20
  v_pk_max_u16 v66, v66, v21
  v_pk_max_u16 v66, v66, v22
  v_pk_max_u16 v66, v66, v23
  v_pk_max_u16 v66, v66, v24
  v_pk_max_u16 v66, v66, v25
  v_pk_max_u16 v66, v66, v26
  v_pk_max_u16 v66, v66, v27
  v_pk_max_u16 v66, v66, v28
  v_pk_max_u16 v66, v66, v29
  v_pk_max_u16 v66, v66, v30
  v_pk_max_u16 v66, v66, v31
  v_pk_max_u16 v66, v66, v32
  v_pk_max_u16 v66, v66, v33
  v_pk_max_u16 v66, v66, v34
  v_pk_max_u16 v66, v66, v35
  v_lshlrev_b32 v67, 16, v66
  v_max_u32 v66, v66, v67
  v_cmp_le_u32 vcc, 0xffff0000, v66
  s_cbranch_vccz cA_sc0_rk
  s_add_u32 s30, s30, 1
  s_cmp_lt_u32 s30, 400000
  s_cbranch_scc1 cA_sc0_rv
  s_branch cA_abort
cA_sc0_rk:
  s_mov_b32 s62, 1
  v_mov_b32 v36, 0
  v_mov_b32 v37, 0
  v_mov_b32 v38, 0
  v_mov_b32 v39, 0
  v_mov_b32 v40, 0
  v_mov_b32 v41, 0
  v_mov_b32 v42, 0
  v_mov_b32 v43, 0
  v_mov_b32 v44, 0
  v_mov_b32 v45, 0
  v_mov_b32 v46, 0
  v_mov_b32 v47, 0
  v_mov_b32 v48, 0
  v_mov_b32 v49, 0
  v_mov_b32 v50, 0
  v_mov_b32 v51, 0
  v_mov_b32 v60, 0
  v_mov_b32 v61, 0
  v_mov_b32 v62, 0
  v_mov_b32 v63, 0
  v_mov_b32 v68, 0
  v_mov_b32 v69, 0
  v_mov_b32 v70, 0
  v_mov_b32 v71, 0
  v_mov_b32 v72, 0
  v_mov_b32 v73, 0
  v_mov_b32 v74, 0
  v_mov_b32 v75, 0
  v_mov_b32 v52, 0
  v_mov_b32 v53, 0
  v_mov_b32 v54, 0
  v_mov_b32 v55, 0
  v_mov_b32 v56, 0
  v_mov_b32 v57, 0
  v_mov_b32 v58, 0
  v_mov_b32 v59, 0
  s_add_u32 s31, s31, 0x100
  s_nop 0
  s_branch cA_sc0_go
.p2align 6
cA_sc1_loop:
  s_mov_b32 s30, 0
  s_mov_b32 s62, 0
  s_setprio 3
  s_barrier
  buffer_load_dwordx4 v[8:11], v2, s[8:11], s20 offen offset:0 sc1
  s_setprio 2
  buffer_load_dwordx4 v[12:15], v2, s[8:11], s20 offen offset:1024 sc1
  s_setprio 1
  buffer_load_dwordx4 v[16:19], v2, s[8:11], s20 offen offset:2048 sc1
  s_setprio 0
  buffer_load_dwordx4 v[20:23], v2, s[8:11], s20 offen offset:3072 sc1
cA_sc1_go:
  s_waitcnt vmcnt(3)
  v_smfmac_f32_16x16x64_bf16 v[36:39], v[8:11], a[0:7], v3
  buffer_load_dwordx4 v[28:31], v2, s[8:11], s23 offen offset:0 sc1
  v_cmp_eq_u32 vcc, -1, v8
  v_smfmac_f32_16x16x64_bf16 v[40:43], v[8:11], a[56:63], v3
  v_smfmac_f32_16x16x64_bf16 v[44:47], v[8:11], a[112:119], v3
  buffer_load_dwordx4 v[24:27], v2, s[8:11], s23 offen offset:1024 sc1
  s_cbranch_vccnz cA_sc1_r0
  v_smfmac_f32_16x16x64_bf16 v[48:51], v[8:11], a[168:175], v3
  v_smfmac_f32_16x16x64_bf16 v[52:55], v[8:11], a[224:231], v3
  s_waitcnt vmcnt(4)
  v_cmp_eq_u32 vcc, -1, v12
  v_smfmac_f32_16x16x64_bf16 v[56:59], v[8:11], v[144:151], v3
  buffer_load_dwordx4 v[32:35], v2, s[8:11], s23 offen offset:2048 sc1
  v_smfmac_f32_16x16x64_bf16 v[60:63], v[8:11], v[200:207], v3
  s_cbranch_vccnz cA_sc1_r1
cA_sc1_c1:
  v_smfmac_f32_16x16x64_bf16 v[36:39], v[12:15], a[8:15], v3
  v_smfmac_f32_16x16x64_bf16 v[40:43], v[12:15], a[64:71], v3
  v_smfmac_f32_16x16x64_bf16 v[44:47], v[12:15], a[120:127], v3
  v_smfmac_f32_16x16x64_bf16 v[48:51], v[12:15], a[176:183], v3
  v_smfmac_f32_16x16x64_bf16 v[52:55], v[12:15], a[232:239], v3
  s_waitcnt vmcnt(4)
  v_cmp_eq_u32 vcc, -1, v16
  v_smfmac_f32_16x16x64_bf16 v[56:59], v[12:15], v[152:159], v3
  buffer_load_dwordx4 v[88:91], v117, s[8:11], s26 offen offset:0 sc1
  v_smfmac_f32_16x16x64_bf16 v[60:63], v[12:15], v[208:215], v3
  s_cbranch_vccnz cA_sc1_r2
cA_sc1_c2:
  v_smfmac_f32_16x16x64_bf16 v[36:39], v[16:19], a[16:23], v3
  v_smfmac_f32_16x16x64_bf16 v[40:43], v[16:19], a[72:79], v3
  v_smfmac_f32_16x16x64_bf16 v[44:47], v[16:19], a[128:135], v3
  buffer_load_dwordx4 v[92:95], v117, s[8:11], s26 offen offset:1024 sc1
  v_smfmac_f32_16x16x64_bf16 v[48:51], v[16:19], a[184:191], v3
  v_smfmac_f32_16x16x64_bf16 v[52:55], v[16:19], a[240:247], v3
  s_waitcnt vmcnt(5)
  v_cmp_eq_u32 vcc, -1, v20
  v_smfmac_f32_16x16x64_bf16 v[56:59], v[16:19], v[160:167], v3
  v_smfmac_f32_16x16x64_bf16 v[60:63], v[16:19], v[216:223], v3
  buffer_load_dwordx4 v[96:99], v2, s[8:11], s24 offen offset:0 sc1
  s_cbranch_vccnz cA_sc1_r3
cA_sc1_c3:
  v_smfmac_f32_16x16x64_bf16 v[36:39], v[20:23], a[24:31], v3
  v_smfmac_f32_16x16x64_bf16 v[40:43], v[20:23], a[80:87], v3
  s_waitcnt vmcnt(3)
  v_max3_u32 v66, v24, v27, v28
  v_smfmac_f32_16x16x64_bf16 v[44:47], v[20:23], a[136:143], v3
  v_max3_u32 v66, v66, v31, v32
  v_smfmac_f32_16x16x64_bf16 v[48:51], v[20:23], a[192:199], v3
  buffer_load_dwordx4 v[100:103], v2, s[8:11], s24 offen offset:1024 sc1
  v_max_u32 v66, v66, v35
  v_smfmac_f32_16x16x64_bf16 v[52:55], v[20:23], a[248:255], v3
  v_cmp_eq_u32 vcc, -1, v66
  v_smfmac_f32_16x16x64_bf16 v[56:59], v[20:23], v[168:175], v3
  v_smfmac_f32_16x16x64_bf16 v[60:63], v[20:23], v[224:231], v3
  s_cbranch_vccnz cA_sc1_r4
cA_sc1_c4:
  v_smfmac_f32_16x16x64_bf16 v[60:63], v[28:31], v[232:239], v3
  buffer_load_dwordx4 v[104:107], v2, s[8:11], s26 offen offset:0 sc1
  v_smfmac_f32_16x16x64_bf16 v[60:63], v[24:27], v[240:247], v3
  v_smfmac_f32_16x16x64_bf16 v[60:63], v[32:35], v[248:255], v3
  v_smfmac_f32_16x16x64_bf16 v[52:55], v[28:31], v[120:127], v3
  v_smfmac_f32_16x16x64_bf16 v[52:55], v[24:27], v[128:135], v3
  buffer_load_dwordx4 v[108:111], v2, s[8:11], s26 offen offset:1024 sc1
  v_smfmac_f32_16x16x64_bf16 v[52:55], v[32:35], v[136:143], v3
  v_cvt_pk_bf16_f32 v63, v62, v63
  v_smfmac_f32_16x16x64_bf16 v[56:59], v[28:31], v[176:183], v3
  v_cvt_pk_bf16_f32 v62, v60, v61
  v_smfmac_f32_16x16x64_bf16 v[56:59], v[24:27], v[184:191], v3
  v_mfma_f32_16x16x32_bf16 v[8:11], v[62:65], v[4:7], 0
  v_cvt_pk_bf16_f32 v55, v54, v55
  v_smfmac_f32_16x16x64_bf16 v[56:59], v[32:35], v[192:199], v3
  v_cvt_pk_bf16_f32 v54, v52, v53
  v_smfmac_f32_16x16x64_bf16 v[36:39], v[28:31], a[32:39], v3
  s_nop 1
  v_cvt_pk_bf16_f32 v78, v8, v9
  v_smfmac_f32_16x16x64_bf16 v[36:39], v[24:27], a[40:47], v3
  v_cvt_pk_bf16_f32 v79, v10, v11
  v_smfmac_f32_16x16x64_bf16 v[36:39], v[32:35], a[48:55], v3
  v_cvt_pk_bf16_f32 v56, v56, v57
  v_smfmac_f32_16x16x64_bf16 v[40:43], v[28:31], a[88:95], v3
  v_cvt_pk_bf16_f32 v57, v58, v59
  v_smfmac_f32_16x16x64_bf16 v[40:43], v[24:27], a[96:103], v3
  v_mfma_f32_16x16x32_bf16 v[16:19], v[54:57], v[4:7], 0
  v_cvt_pk_bf16_f32 v39, v38, v39
  v_smfmac_f32_16x16x64_bf16 v[40:43], v[32:35], a[104:111], v3
  v_cvt_pk_bf16_f32 v38, v36, v37
  v_smfmac_f32_16x16x64_bf16 v[44:47], v[28:31], a[144:151], v3
  s_nop 1
  v_cvt_pk_bf16_f32 v76, v16, v17
  v_smfmac_f32_16x16x64_bf16 v[44:47], v[24:27], a[152:159], v3
  v_cvt_pk_bf16_f32 v77, v18, v19
  v_smfmac_f32_16x16x64_bf16 v[44:47], v[32:35], a[160:167], v3
  v_cvt_pk_bf16_f32 v40, v40, v41
  v_smfmac_f32_16x16x64_bf16 v[48:51], v[28:31], a[200:207], v3
  v_cvt_pk_bf16_f32 v41, v42, v43
  v_smfmac_f32_16x16x64_bf16 v[48:51], v[24:27], a[208:215], v3
  v_smfmac_f32_16x16x64_bf16 v[48:51], v[32:35], a[216:223], v3
  s_waitcnt vmcnt(4)
  v_cvt_pk_bf16_f32 v47, v46, v47
  v_smfmac_f32_16x16x64_bf16 v[68:71], v[76:79], v[80:87], v3
  v_cvt_pk_bf16_f32 v46, v44, v45
  v_mfma_f32_16x16x32_bf16 v[8:11], v[38:41], v[4:7], 0
  s_nop 1
  v_cvt_pk_bf16_f32 v48, v48, v49
  v_cvt_pk_bf16_f32 v49, v50, v51
  s_nop 1
  v_mfma_f32_16x16x32_bf16 v[16:19], v[46:49], v[4:7], 0
  v_smfmac_f32_16x16x64_bf16 v[72:75], v[76:79], v[88:95], v3
  v_cvt_pk_bf16_f32 v20, v8, v9
  v_mfma_f32_16x16x32_bf16 v[52:55], v[30:33], v[76:79], 0
  s_waitcnt vmcnt(0)
  v_cvt_pk_bf16_f32 v21, v10, v11
  v_cvt_pk_bf16_f32 v22, v16, v17
  v_cvt_pk_bf16_f32 v23, v18, v19
  s_nop 1
  v_mfma_f32_16x16x32_bf16 v[52:55], v[12:15], v[20:23], v[52:55]
  v_smfmac_f32_16x16x64_bf16 v[68:71], v[20:23], v[96:103], v3
  v_smfmac_f32_16x16x64_bf16 v[72:75], v[20:23], v[104:111], v3
  s_nop 1
  ds_write_b128 v113, v[52:55]
  s_nop 1
  v_permlane32_swap_b32 v68, v70
  v_permlane32_swap_b32 v69, v71
  v_add_f32 v56, v68, v70
  v_add_f32 v58, v69, v71
  v_permlane32_swap_b32 v72, v74
  v_permlane32_swap_b32 v73, v75
  v_add_f32 v57, v72, v74
  v_add_f32 v59, v73, v75
  ds_write_b128 v2, v[56:59] offset:1024
  v_cmp_u_f32 vcc, v57, v59
  v_mov_b32 v68, 0
  v_mov_b32 v69, 0
  v_mov_b32 v70, 0
  v_mov_b32 v71, 0
  s_cbranch_vccnz cA_sc1_retry
cA_sc1_cont:
  s_add_u32 s24, s24, 28672
  s_add_u32 s26, s26, 28672
  buffer_load_dwordx4 v[80:83], v117, s[8:11], s24 offen offset:0 sc1
  buffer_load_dwordx4 v[84:87], v117, s[8:11], s24 offen offset:1024 sc1
  v_mov_b32 v72, 0
  v_mov_b32 v73, 0
  v_mfma_f32_32x32x16_bf16 v[36:51], v[68:71], v[68:71], 0
  s_waitcnt lgkmcnt(0)
  s_barrier
  ds_read_b64 v[8:9], v114 offset:0
  ds_read_b64 v[10:11], v114 offset:1024
  ds_read_b64 v[12:13], v114 offset:2048
  ds_read_b64 v[14:15], v114 offset:3072
  ds_read2_b32 v[16:17], v115 offset0:0 offset1:64
  ds_read2_b32 v[18:19], v115 offset0:128 offset1:192
  v_mfma_f32_32x32x16_bf16 v[52:67], v[68:71], v[68:71], 0
  s_waitcnt lgkmcnt(0)
  v_pk_add_f32 v[16:17], v[16:17], v[18:19]
  v_pk_add_f32 v[8:9], v[8:9], v[10:11]
  v_pk_add_f32 v[12:13], v[12:13], v[14:15]
  v_add_f32 v20, v16, v17
  v_pk_add_f32 v[8:9], v[8:9], v[12:13]
  v_max_f32 v22, v8, v9
  v_add_f32_dpp v20, v20, v20 row_ror:8 row_mask:0xf bank_mask:0xf
  s_nop 0
  v_max_f32_dpp v22, v22, v22 row_ror:8 row_mask:0xf bank_mask:0xf
  v_max_f32 v22, v22, v20
  buffer_store_dword v112, v116, s[8:11], 0 offen
  s_nop 0
  v_max_f32_dpp v22, v22, v22 quad_perm:[1,0,3,2] row_mask:0xf bank_mask:0xf
  s_nop 1
  v_max_f32_dpp v22, v22, v22 quad_perm:[2,3,0,1] row_mask:0xf bank_mask:0xf
  s_nop 1
  v_max_f32_dpp v22, v22, v22 row_half_mirror row_mask:0xf bank_mask:0xf
  v_pk_add_f32 v[8:9], v[8:9], v[22:23] op_sel_hi:[1,0] neg_lo:[0,1] neg_hi:[0,1]
  v_sub_f32 v20, v20, v22
  v_exp_f32 v8, v8
  v_exp_f32 v9, v9
  v_exp_f32 v20, v20
  v_add_f32 v24, v8, v9
  v_fmac_f32 v24, 0.5, v20
  v_mov_b32_dpp v21, v20 quad_perm:[1,0,3,2] row_mask:0xf bank_mask:0xf
  s_nop 0
  v_add_f32_dpp v24, v24, v24 quad_perm:[1,0,3,2] row_mask:0xf bank_mask:0xf
  s_nop 1
  v_add_f32_dpp v24, v24, v24 quad_perm:[2,3,0,1] row_mask:0xf bank_mask:0xf
  s_nop 1
  v_add_f32_dpp v24, v24, v24 row_half_mirror row_mask:0xf bank_mask:0xf
  s_nop 1
  v_add_f32_dpp v24, v24, v24 row_ror:8 row_mask:0xf bank_mask:0xf
  v_rcp_f32 v24, v24
  s_nop 0
  v_pk_mul_f32 v[8:9], v[8:9], v[24:25] op_sel_hi:[1,0]
  v_pk_mul_f32 v[20:21], v[20:21], v[24:25] op_sel_hi:[1,0]
  v_cvt_pk_bf16_f32 v8, v8, v9
  v_cvt_pk_bf16_f32 v20, v20, v21
  v_min_u32 v8, -2, v8
  buffer_store_dword v8, v1, s[8:11], s20 offen
  v_min_u32 v20, -2, v20
  buffer_store_dword v20, v118, s[8:11], s20 offen
  v_mov_b32 v74, 0
  v_mov_b32 v75, 0
  s_mov_b32 s19, s18
  s_add_u32 s18, s18, 1
  s_mov_b32 s22, s20
  s_mov_b32 s20, s21
  s_mov_b32 s21, s22
  s_add_u32 s23, s20, 4096
  v_mov_b32 v112, s18
  s_cmp_lt_u32 s19, 63
  s_nop 0
  s_cbranch_scc1 cA_sc1_loop
  s_branch cA_done
cA_sc1_r0:
  s_add_u32 s31, s31, 1
  buffer_load_dwordx4 v[8:11], v2, s[8:11], s20 offen offset:0 sc1
  s_waitcnt vmcnt(0)
  v_cmp_eq_u32 vcc, -1, v8
  v_mov_b32 v36, 0
  v_mov_b32 v37, 0
  v_mov_b32 v38, 0
  v_mov_b32 v39, 0
  v_mov_b32 v40, 0
  v_mov_b32 v41, 0
  v_mov_b32 v42, 0
  v_mov_b32 v43, 0
  v_mov_b32 v44, 0
  v_mov_b32 v45, 0
  v_mov_b32 v46, 0
  v_mov_b32 v47, 0
  v_mov_b32 v48, 0
  v_mov_b32 v49, 0
  v_mov_b32 v50, 0
  v_mov_b32 v51, 0
  s_nop 1
  s_cbranch_vccz cA_sc1_go
  s_add_u32 s30, s30, 1
  s_cmp_lt_u32 s30, 400000
  s_cbranch_scc1 cA_sc1_r0
  s_branch cA_abort
cA_sc1_r1:
  s_add_u32 s31, s31, 1
  buffer_load_dwordx4 v[12:15], v2, s[8:11], s20 offen offset:1024 sc1
  s_waitcnt vmcnt(0)
  v_cmp_eq_u32 vcc, -1, v12
  s_nop 4
  s_cbranch_vccz cA_sc1_c1
  s_add_u32 s30, s30, 1
  s_cmp_lt_u32 s30, 400000
  s_cbranch_scc1 cA_sc1_r1
  s_branch cA_abort
cA_sc1_r2:
  s_add_u32 s31, s31, 1
  buffer_load_dwordx4 v[16:19], v2, s[8:11], s20 offen offset:2048 sc1
  s_waitcnt vmcnt(0)
  v_cmp_eq_u32 vcc, -1, v16
  s_nop 4
  s_cbranch_vccz cA_sc1_c2
  s_add_u32 s30, s30, 1
  s_cmp_lt_u32 s30, 400000
  s_cbranch_scc1 cA_sc1_r2
  s_branch cA_abort
cA_sc1_r3:
  s_add_u32 s31, s31, 1
  buffer_load_dwordx4 v[20:23], v2, s[8:11], s20 offen offset:3072 sc1
  s_waitcnt vmcnt(0)
  v_cmp_eq_u32 vcc, -1, v20
  s_nop 4
  s_cbranch_vccz cA_sc1_c3
  s_add_u32 s30, s30, 1
  s_cmp_lt_u32 s30, 400000
  s_cbranch_scc1 cA_sc1_r3
  s_branch cA_abort
cA_sc1_r4:
  s_add_u32 s31, s31, 1
  buffer_load_dwordx4 v[28:31], v2, s[8:11], s23 offen offset:0 sc1
  buffer_load_dwordx4 v[24:27], v2, s[8:11], s23 offen offset:1024 sc1
  buffer_load_dwordx4 v[32:35], v2, s[8:11], s23 offen offset:2048 sc1
  s_waitcnt vmcnt(0)
  v_max3_u32 v66, v24, v27, v28
  v_max3_u32 v66, v66, v31, v32
  v_max_u32 v66, v66, v35
  v_cmp_eq_u32 vcc, -1, v66
  s_nop 4
  s_cbranch_vccz cA_sc1_c4
  s_add_u32 s30, s30, 1
  s_cmp_lt_u32 s30, 400000
  s_cbranch_scc1 cA_sc1_r4
  s_branch cA_abort
cA_sc1_retry:
  s_cmp_lg_u32 s62, 0
  s_cbranch_scc1 cA_sc1_cont
  s_waitcnt vmcnt(0) lgkmcnt(0)
cA_sc1_rv:
  buffer_load_dwordx4 v[8:11], v2, s[8:11], s20 offen offset:0 sc1
  buffer_load_dwordx4 v[12:15], v2, s[8:11], s20 offen offset:1024 sc1
  buffer_load_dwordx4 v[16:19], v2, s[8:11], s20 offen offset:2048 sc1
  buffer_load_dwordx4 v[20:23], v2, s[8:11], s20 offen offset:3072 sc1
  buffer_load_dwordx4 v[28:31], v2, s[8:11], s23 offen offset:0 sc1
  buffer_load_dwordx4 v[24:27], v2, s[8:11], s23 offen offset:1024 sc1
  buffer_load_dwordx4 v[32:35], v2, s[8:11], s23 offen offset:2048 sc1
  s_waitcnt vmcnt(0)
  v_pk_max_u16 v66, v8, v9
  v_pk_max_u16 v66, v66, v10
  v_pk_max_u16 v66, v66, v11
  v_pk_max_u16 v66, v66, v12
  v_pk_max_u16 v66, v66, v13
  v_pk_max_u16 v66, v66, v14
  v_pk_max_u16 v66, v66, v15
  v_pk_max_u16 v66, v66, v16
  v_pk_max_u16 v66, v66, v17
  v_pk_max_u16 v66, v66, v18
  v_pk_max_u16 v66, v66, v19
  v_pk_max_u16 v66, v66, v20
  v_pk_max_u16 v66, v66, v21
  v_pk_max_u16 v66, v66, v22
  v_pk_max_u16 v66, v66, v23
  v_pk_max_u16 v66, v66, v24
  v_pk_max_u16 v66, v66, v25
  v_pk_max_u16 v66, v66, v26
  v_pk_max_u16 v66, v66, v27
  v_pk_max_u16 v66, v66, v28
  v_pk_max_u16 v66, v66, v29
  v_pk_max_u16 v66, v66, v30
  v_pk_max_u16 v66, v66, v31
  v_pk_max_u16 v66, v66, v32
  v_pk_max_u16 v66, v66, v33
  v_pk_max_u16 v66, v66, v34
  v_pk_max_u16 v66, v66, v35
  v_lshlrev_b32 v67, 16, v66
  v_max_u32 v66, v66, v67
  v_cmp_le_u32 vcc, 0xffff0000, v66
  s_cbranch_vccz cA_sc1_rk
  s_add_u32 s30, s30, 1
  s_cmp_lt_u32 s30, 400000
  s_cbranch_scc1 cA_sc1_rv
  s_branch cA_abort
cA_sc1_rk:
  s_mov_b32 s62, 1
  v_mov_b32 v36, 0
  v_mov_b32 v37, 0
  v_mov_b32 v38, 0
  v_mov_b32 v39, 0
  v_mov_b32 v40, 0
  v_mov_b32 v41, 0
  v_mov_b32 v42, 0
  v_mov_b32 v43, 0
  v_mov_b32 v44, 0
  v_mov_b32 v45, 0
  v_mov_b32 v46, 0
  v_mov_b32 v47, 0
  v_mov_b32 v48, 0
  v_mov_b32 v49, 0
  v_mov_b32 v50, 0
  v_mov_b32 v51, 0
  v_mov_b32 v60, 0
  v_mov_b32 v61, 0
  v_mov_b32 v62, 0
  v_mov_b32 v63, 0
  v_mov_b32 v68, 0
  v_mov_b32 v69, 0
  v_mov_b32 v70, 0
  v_mov_b32 v71, 0
  v_mov_b32 v72, 0
  v_mov_b32 v73, 0
  v_mov_b32 v74, 0
  v_mov_b32 v75, 0
  v_mov_b32 v52, 0
  v_mov_b32 v53, 0
  v_mov_b32 v54, 0
  v_mov_b32 v55, 0
  v_mov_b32 v56, 0
  v_mov_b32 v57, 0
  v_mov_b32 v58, 0
  v_mov_b32 v59, 0
  s_add_u32 s31, s31, 0x100
  s_nop 0
  s_branch cA_sc1_go
.p2align 6
cA_sc2_loop:
  s_mov_b32 s30, 0
  s_mov_b32 s62, 0
  s_setprio 3
  s_barrier
  buffer_load_dwordx4 v[8:11], v2, s[8:11], s20 offen offset:0 sc1
  s_setprio 2
  buffer_load_dwordx4 v[12:15], v2, s[8:11], s20 offen offset:1024 sc1
  s_setprio 1
  buffer_load_dwordx4 v[16:19], v2, s[8:11], s20 offen offset:2048 sc1
  s_setprio 0
  buffer_load_dwordx4 v[20:23], v2, s[8:11], s20 offen offset:3072 sc1
cA_sc2_go:
  s_waitcnt vmcnt(3)
  v_smfmac_f32_16x16x64_bf16 v[36:39], v[8:11], a[0:7], v3
  buffer_load_dwordx4 v[24:27], v2, s[8:11], s23 offen offset:0 sc1
  v_cmp_eq_u32 vcc, -1, v8
  v_smfmac_f32_16x16x64_bf16 v[40:43], v[8:11], a[56:63], v3
  v_smfmac_f32_16x16x64_bf16 v[44:47], v[8:11], a[112:119], v3
  buffer_load_dwordx4 v[32:35], v2, s[8:11], s23 offen offset:1024 sc1
  s_cbranch_vccnz cA_sc2_r0
  v_smfmac_f32_16x16x64_bf16 v[48:51], v[8:11], a[168:175], v3
  v_smfmac_f32_16x16x64_bf16 v[52:55], v[8:11], a[224:231], v3
  s_waitcnt vmcnt(4)
  v_cmp_eq_u32 vcc, -1, v12
  v_smfmac_f32_16x16x64_bf16 v[56:59], v[8:11], v[144:151], v3
  buffer_load_dwordx4 v[28:31], v2, s[8:11], s23 offen offset:2048 sc1
  v_smfmac_f32_16x16x64_bf16 v[62:65], v[8:11], v[200:207], v3
  s_cbranch_vccnz cA_sc2_r1
cA_sc2_c1:
  v_smfmac_f32_16x16x64_bf16 v[36:39], v[12:15], a[8:15], v3
  v_smfmac_f32_16x16x64_bf16 v[40:43], v[12:15], a[64:71], v3
  v_smfmac_f32_16x16x64_bf16 v[44:47], v[12:15], a[120:127], v3
  v_smfmac_f32_16x16x64_bf16 v[48:51], v[12:15], a[176:183], v3
  v_smfmac_f32_16x16x64_bf16 v[52:55], v[12:15], a[232:239], v3
  s_waitcnt vmcnt(4)
  v_cmp_eq_u32 vcc, -1, v16
  v_smfmac_f32_16x16x64_bf16 v[56:59], v[12:15], v[152:159], v3
  buffer_load_dwordx4 v[88:91], v117, s[8:11], s26 offen offset:0 sc1
  v_smfmac_f32_16x16x64_bf16 v[62:65], v[12:15], v[208:215], v3
  s_cbranch_vccnz cA_sc2_r2
cA_sc2_c2:
  v_smfmac_f32_16x16x64_bf16 v[36:39], v[16:19], a[16:23], v3
  v_smfmac_f32_16x16x64_bf16 v[40:43], v[16:19], a[72:79], v3
  v_smfmac_f32_16x16x64_bf16 v[44:47], v[16:19], a[128:135], v3
  buffer_load_dwordx4 v[92:95], v117, s[8:11], s26 offen offset:1024 sc1
  v_smfmac_f32_16x16x64_bf16 v[48:51], v[16:19], a[184:191], v3
  v_smfmac_f32_16x16x64_bf16 v[52:55], v[16:19], a[240:247], v3
  s_waitcnt vmcnt(5)
  v_cmp_eq_u32 vcc, -1, v20
  v_smfmac_f32_16x16x64_bf16 v[56:59], v[16:19], v[160:167], v3
  v_smfmac_f32_16x16x64_bf16 v[62:65], v[16:19], v[216:223], v3
  buffer_load_dwordx4 v[96:99], v2, s[8:11], s24 offen offset:0 sc1
  s_cbranch_vccnz cA_sc2_r3
cA_sc2_c3:
  v_smfmac_f32_16x16x64_bf16 v[36:39], v[20:23], a[24:31], v3
  v_smfmac_f32_16x16x64_bf16 v[40:43], v[20:23], a[80:87], v3
  s_waitcnt vmcnt(3)
  v_max3_u32 v66, v24, v27, v28
  v_smfmac_f32_16x16x64_bf16 v[44:47], v[20:23], a[136:143], v3
  v_max3_u32 v66, v66, v31, v32
  v_smfmac_f32_16x16x64_bf16 v[48:51], v[20:23], a[192:199], v3
  buffer_load_dwordx4 v[100:103], v2, s[8:11], s24 offen offset:1024 sc1
  v_max_u32 v66, v66, v35
  v_smfmac_f32_16x16x64_bf16 v[52:55], v[20:23], a[248:255], v3
  v_cmp_eq_u32 vcc, -1, v66
  v_smfmac_f32_16x16x64_bf16 v[56:59], v[20:23], v[168:175], v3
  v_smfmac_f32_16x16x64_bf16 v[62:65], v[20:23], v[224:231], v3
  s_cbranch_vccnz cA_sc2_r4
cA_sc2_c4:
  v_smfmac_f32_16x16x64_bf16 v[62:65], v[24:27], v[232:239], v3
  buffer_load_dwordx4 v[104:107], v2, s[8:11], s26 offen offset:0 sc1
  v_smfmac_f32_16x16x64_bf16 v[62:65], v[32:35], v[240:247], v3
  v_smfmac_f32_16x16x64_bf16 v[62:65], v[28:31], v[248:255], v3
  v_smfmac_f32_16x16x64_bf16 v[52:55], v[24:27], v[120:127], v3
  v_smfmac_f32_16x16x64_bf16 v[52:55], v[32:35], v[128:135], v3
  buffer_load_dwordx4 v[108:111], v2, s[8:11], s26 offen offset:1024 sc1
  v_smfmac_f32_16x16x64_bf16 v[52:55], v[28:31], v[136:143], v3
  v_cvt_pk_bf16_f32 v62, v62, v63
  v_smfmac_f32_16x16x64_bf16 v[56:59], v[24:27], v[176:183], v3
  v_cvt_pk_bf16_f32 v63, v64, v65
  v_smfmac_f32_16x16x64_bf16 v[56:59], v[32:35], v[184:191], v3
  v_mfma_f32_16x16x32_bf16 v[8:11], v[60:63], v[4:7], 0
  v_cvt_pk_bf16_f32 v55, v54, v55
  v_smfmac_f32_16x16x64_bf16 v[56:59], v[28:31], v[192:199], v3
  v_cvt_pk_bf16_f32 v54, v52, v53
  v_smfmac_f32_16x16x64_bf16 v[36:39], v[24:27], a[32:39], v3
  s_nop 1
  v_cvt_pk_bf16_f32 v76, v8, v9
  v_smfmac_f32_16x16x64_bf16 v[36:39], v[32:35], a[40:47], v3
  v_cvt_pk_bf16_f32 v77, v10, v11
  v_smfmac_f32_16x16x64_bf16 v[36:39], v[28:31], a[48:55], v3
  v_cvt_pk_bf16_f32 v56, v56, v57
  v_smfmac_f32_16x16x64_bf16 v[40:43], v[24:27], a[88:95], v3
  v_cvt_pk_bf16_f32 v57, v58, v59
  v_smfmac_f32_16x16x64_bf16 v[40:43], v[32:35], a[96:103], v3
  v_mfma_f32_16x16x32_bf16 v[12:15], v[54:57], v[4:7], 0
  v_cvt_pk_bf16_f32 v39, v38, v39
  v_smfmac_f32_16x16x64_bf16 v[40:43], v[28:31], a[104:111], v3
  v_cvt_pk_bf16_f32 v38, v36, v37
  v_smfmac_f32_16x16x64_bf16 v[44:47], v[24:27], a[144:151], v3
  s_nop 1
  v_cvt_pk_bf16_f32 v78, v12, v13
  v_smfmac_f32_16x16x64_bf16 v[44:47], v[32:35], a[152:159], v3
  v_cvt_pk_bf16_f32 v79, v14, v15
  v_smfmac_f32_16x16x64_bf16 v[44:47], v[28:31], a[160:167], v3
  v_cvt_pk_bf16_f32 v40, v40, v41
  v_smfmac_f32_16x16x64_bf16 v[48:51], v[24:27], a[200:207], v3
  v_cvt_pk_bf16_f32 v41, v42, v43
  v_smfmac_f32_16x16x64_bf16 v[48:51], v[32:35], a[208:215], v3
  v_smfmac_f32_16x16x64_bf16 v[48:51], v[28:31], a[216:223], v3
  s_waitcnt vmcnt(4)
  v_cvt_pk_bf16_f32 v47, v46, v47
  v_smfmac_f32_16x16x64_bf16 v[68:71], v[76:79], v[80:87], v3
  v_cvt_pk_bf16_f32 v46, v44, v45
  v_mfma_f32_16x16x32_bf16 v[8:11], v[38:41], v[4:7], 0
  s_nop 1
  v_cvt_pk_bf16_f32 v48, v48, v49
  v_cvt_pk_bf16_f32 v49, v50, v51
  s_nop 1
  v_mfma_f32_16x16x32_bf16 v[12:15], v[46:49], v[4:7], 0
  v_smfmac_f32_16x16x64_bf16 v[72:75], v[76:79], v[88:95], v3
  v_cvt_pk_bf16_f32 v20, v8, v9
  v_mfma_f32_16x16x32_bf16 v[52:55], v[30:33], v[76:79], 0
  s_waitcnt vmcnt(0)
  v_cvt_pk_bf16_f32 v21, v10, v11
  v_cvt_pk_bf16_f32 v22, v12, v13
  v_cvt_pk_bf16_f32 v23, v14, v15
  s_nop 1
  v_mfma_f32_16x16x32_bf16 v[52:55], v[16:19], v[20:23], v[52:55]
  v_smfmac_f32_16x16x64_bf16 v[68:71], v[20:23], v[96:103], v3
  v_smfmac_f32_16x16x64_bf16 v[72:75], v[20:23], v[104:111], v3
  s_nop 1
  ds_write_b128 v113, v[52:55]
  s_nop 1
  v_permlane32_swap_b32 v68, v70
  v_permlane32_swap_b32 v69, v71
  v_add_f32 v56, v68, v70
  v_add_f32 v58, v69, v71
  v_permlane32_swap_b32 v72, v74
  v_permlane32_swap_b32 v73, v75
  v_add_f32 v57, v72, v74
  v_add_f32 v59, v73, v75
  ds_write_b128 v2, v[56:59] offset:2048
  v_cmp_u_f32 vcc, v57, v59
  v_mov_b32 v68, 0
  v_mov_b32 v69, 0
  v_mov_b32 v70, 0
  v_mov_b32 v71, 0
  s_cbranch_vccnz cA_sc2_retry
cA_sc2_cont:
  s_add_u32 s24, s24, 28672
  s_add_u32 s26, s26, 28672
  buffer_load_dwordx4 v[80:83], v117, s[8:11], s24 offen offset:0 sc1
  buffer_load_dwordx4 v[84:87], v117, s[8:11], s24 offen offset:1024 sc1
  v_mov_b32 v72, 0
  v_mov_b32 v73, 0
  v_mfma_f32_32x32x16_bf16 v[36:51], v[68:71], v[68:71], 0
  s_waitcnt lgkmcnt(0)
  s_barrier
  v_mfma_f32_32x32x16_bf16 v[52:67], v[68:71], v[68:71], 0
  buffer_store_dwordx2 v[118:119], v114, s[8:11], s21 offen
  buffer_store_dwordx2 v[118:119], v115, s[8:11], s21 offen
  s_buffer_load_dword s70, s[8:11], s35
  s_add_u32 s22, s24, 114688
  s_buffer_load_dword s71, s[8:11], s22
  s_mul_i32 s22, s18, 7168
  s_add_u32 s22, s22, 88024064
  s_buffer_load_dword s72, s[8:11], s22
  s_add_u32 s35, s35, 458752
  v_mov_b32 v74, 0
  v_mov_b32 v75, 0
  s_mov_b32 s19, s18
  s_add_u32 s18, s18, 1
  s_mov_b32 s22, s20
  s_mov_b32 s20, s21
  s_mov_b32 s21, s22
  s_add_u32 s23, s20, 4096
  s_cmp_lt_u32 s19, 63
  s_cbranch_scc1 cA_sc2_loop
  s_branch cA_done
cA_sc2_r0:
  s_add_u32 s31, s31, 1
  buffer_load_dwordx4 v[8:11], v2, s[8:11], s20 offen offset:0 sc1
  s_waitcnt vmcnt(0)
  v_cmp_eq_u32 vcc, -1, v8
  v_mov_b32 v36, 0
  v_mov_b32 v37, 0
  v_mov_b32 v38, 0
  v_mov_b32 v39, 0
  v_mov_b32 v40, 0
  v_mov_b32 v41, 0
  v_mov_b32 v42, 0
  v_mov_b32 v43, 0
  v_mov_b32 v44, 0
  v_mov_b32 v45, 0
  v_mov_b32 v46, 0
  v_mov_b32 v47, 0
  v_mov_b32 v48, 0
  v_mov_b32 v49, 0
  v_mov_b32 v50, 0
  v_mov_b32 v51, 0
  s_nop 1
  s_cbranch_vccz cA_sc2_go
  s_add_u32 s30, s30, 1
  s_cmp_lt_u32 s30, 400000
  s_cbranch_scc1 cA_sc2_r0
  s_branch cA_abort
cA_sc2_r1:
  s_add_u32 s31, s31, 1
  buffer_load_dwordx4 v[12:15], v2, s[8:11], s20 offen offset:1024 sc1
  s_waitcnt vmcnt(0)
  v_cmp_eq_u32 vcc, -1, v12
  s_nop 4
  s_cbranch_vccz cA_sc2_c1
  s_add_u32 s30, s30, 1
  s_cmp_lt_u32 s30, 400000
  s_cbranch_scc1 cA_sc2_r1
  s_branch cA_abort
cA_sc2_r2:
  s_add_u32 s31, s31, 1
  buffer_load_dwordx4 v[16:19], v2, s[8:11], s20 offen offset:2048 sc1
  s_waitcnt vmcnt(0)
  v_cmp_eq_u32 vcc, -1, v16
  s_nop 4
  s_cbranch_vccz cA_sc2_c2
  s_add_u32 s30, s30, 1
  s_cmp_lt_u32 s30, 400000
  s_cbranch_scc1 cA_sc2_r2
  s_branch cA_abort
cA_sc2_r3:
  s_add_u32 s31, s31, 1
  buffer_load_dwordx4 v[20:23], v2, s[8:11], s20 offen offset:3072 sc1
  s_waitcnt vmcnt(0)
  v_cmp_eq_u32 vcc, -1, v20
  s_nop 4
  s_cbranch_vccz cA_sc2_c3
  s_add_u32 s30, s30, 1
  s_cmp_lt_u32 s30, 400000
  s_cbranch_scc1 cA_sc2_r3
  s_branch cA_abort
cA_sc2_r4:
  s_add_u32 s31, s31, 1
  buffer_load_dwordx4 v[24:27], v2, s[8:11], s23 offen offset:0 sc1
  buffer_load_dwordx4 v[32:35], v2, s[8:11], s23 offen offset:1024 sc1
  buffer_load_dwordx4 v[28:31], v2, s[8:11], s23 offen offset:2048 sc1
  s_waitcnt vmcnt(0)
  v_max3_u32 v66, v24, v27, v28
  v_max3_u32 v66, v66, v31, v32
  v_max_u32 v66, v66, v35
  v_cmp_eq_u32 vcc, -1, v66
  s_nop 4
  s_cbranch_vccz cA_sc2_c4
  s_add_u32 s30, s30, 1
  s_cmp_lt_u32 s30, 400000
  s_cbranch_scc1 cA_sc2_r4
  s_branch cA_abort
cA_sc2_retry:
  s_cmp_lg_u32 s62, 0
  s_cbranch_scc1 cA_sc2_cont
  s_waitcnt vmcnt(0) lgkmcnt(0)
cA_sc2_rv:
  buffer_load_dwordx4 v[8:11], v2, s[8:11], s20 offen offset:0 sc1
  buffer_load_dwordx4 v[12:15], v2, s[8:11], s20 offen offset:1024 sc1
  buffer_load_dwordx4 v[16:19], v2, s[8:11], s20 offen offset:2048 sc1
  buffer_load_dwordx4 v[20:23], v2, s[8:11], s20 offen offset:3072 sc1
  buffer_load_dwordx4 v[24:27], v2, s[8:11], s23 offen offset:0 sc1
  buffer_load_dwordx4 v[32:35], v2, s[8:11], s23 offen offset:1024 sc1
  buffer_load_dwordx4 v[28:31], v2, s[8:11], s23 offen offset:2048 sc1
  s_waitcnt vmcnt(0)
  v_pk_max_u16 v66, v8, v9
  v_pk_max_u16 v66, v66, v10
  v_pk_max_u16 v66, v66, v11
  v_pk_max_u16 v66, v66, v12
  v_pk_max_u16 v66, v66, v13
  v_pk_max_u16 v66, v66, v14
  v_pk_max_u16 v66, v66, v15
  v_pk_max_u16 v66, v66, v16
  v_pk_max_u16 v66, v66, v17
  v_pk_max_u16 v66, v66, v18
  v_pk_max_u16 v66, v66, v19
  v_pk_max_u16 v66, v66, v20
  v_pk_max_u16 v66, v66, v21
  v_pk_max_u16 v66, v66, v22
  v_pk_max_u16 v66, v66, v23
  v_pk_max_u16 v66, v66, v24
  v_pk_max_u16 v66, v66, v25
  v_pk_max_u16 v66, v66, v26
  v_pk_max_u16 v66, v66, v27
  v_pk_max_u16 v66, v66, v28
  v_pk_max_u16 v66, v66, v29
  v_pk_max_u16 v66, v66, v30
  v_pk_max_u16 v66, v66, v31
  v_pk_max_u16 v66, v66, v32
  v_pk_max_u16 v66, v66, v33
  v_pk_max_u16 v66, v66, v34
  v_pk_max_u16 v66, v66, v35
  v_lshlrev_b32 v67, 16, v66
  v_max_u32 v66, v66, v67
  v_cmp_le_u32 vcc, 0xffff0000, v66
  s_cbranch_vccz cA_sc2_rk
  s_add_u32 s30, s30, 1
  s_cmp_lt_u32 s30, 400000
  s_cbranch_scc1 cA_sc2_rv
  s_branch cA_abort
cA_sc2_rk:
  s_mov_b32 s62, 1
  v_mov_b32 v36, 0
  v_mov_b32 v37, 0
  v_mov_b32 v38, 0
  v_mov_b32 v39, 0
  v_mov_b32 v40, 0
  v_mov_b32 v41, 0
  v_mov_b32 v42, 0
  v_mov_b32 v43, 0
  v_mov_b32 v44, 0
  v_mov_b32 v45, 0
  v_mov_b32 v46, 0
  v_mov_b32 v47, 0
  v_mov_b32 v48, 0
  v_mov_b32 v49, 0
  v_mov_b32 v50, 0
  v_mov_b32 v51, 0
  v_mov_b32 v62, 0
  v_mov_b32 v63, 0
  v_mov_b32 v64, 0
  v_mov_b32 v65, 0
  v_mov_b32 v68, 0
  v_mov_b32 v69, 0
  v_mov_b32 v70, 0
  v_mov_b32 v71, 0
  v_mov_b32 v72, 0
  v_mov_b32 v73, 0
  v_mov_b32 v74, 0
  v_mov_b32 v75, 0
  v_mov_b32 v52, 0
  v_mov_b32 v53, 0
  v_mov_b32 v54, 0
  v_mov_b32 v55, 0
  v_mov_b32 v56, 0
  v_mov_b32 v57, 0
  v_mov_b32 v58, 0
  v_mov_b32 v59, 0
  s_add_u32 s31, s31, 0x100
  s_nop 0
  s_branch cA_sc2_go
.p2align 6
cA_sc3_loop:
  s_mov_b32 s30, 0
  s_mov_b32 s62, 0
  s_setprio 3
  s_barrier
  buffer_load_dwordx4 v[8:11], v2, s[8:11], s20 offen offset:0 sc1
  s_setprio 2
  buffer_load_dwordx4 v[12:15], v2, s[8:11], s20 offen offset:1024 sc1
  s_setprio 1
  buffer_load_dwordx4 v[16:19], v2, s[8:11], s20 offen offset:2048 sc1
  s_setprio 0
  buffer_load_dwordx4 v[20:23], v2, s[8:11], s20 offen offset:3072 sc1
cA_sc3_go:
  s_waitcnt vmcnt(3)
  v_smfmac_f32_16x16x64_bf16 v[36:39], v[8:11], a[0:7], v3
  buffer_load_dwordx4 v[24:27], v2, s[8:11], s23 offen offset:0 sc1
  v_cmp_eq_u32 vcc, -1, v8
  v_smfmac_f32_16x16x64_bf16 v[40:43], v[8:11], a[56:63], v3
  v_smfmac_f32_16x16x64_bf16 v[44:47], v[8:11], a[112:119], v3
  buffer_load_dwordx4 v[28:31], v2, s[8:11], s23 offen offset:1024 sc1
  s_cbranch_vccnz cA_sc3_r0
  v_smfmac_f32_16x16x64_bf16 v[48:51], v[8:11], a[168:175], v3
  v_smfmac_f32_16x16x64_bf16 v[52:55], v[8:11], a[224:231], v3
  s_waitcnt vmcnt(4)
  v_cmp_eq_u32 vcc, -1, v12
  v_smfmac_f32_16x16x64_bf16 v[56:59], v[8:11], v[144:151], v3
  buffer_load_dwordx4 v[32:35], v2, s[8:11], s23 offen offset:2048 sc1
  v_smfmac_f32_16x16x64_bf16 v[62:65], v[8:11], v[200:207], v3
  s_cbranch_vccnz cA_sc3_r1
cA_sc3_c1:
  v_smfmac_f32_16x16x64_bf16 v[36:39], v[12:15], a[8:15], v3
  v_smfmac_f32_16x16x64_bf16 v[40:43], v[12:15], a[64:71], v3
  v_smfmac_f32_16x16x64_bf16 v[44:47], v[12:15], a[120:127], v3
  v_smfmac_f32_16x16x64_bf16 v[48:51], v[12:15], a[176:183], v3
  v_smfmac_f32_16x16x64_bf16 v[52:55], v[12:15], a[232:239], v3
  s_waitcnt vmcnt(4)
  v_cmp_eq_u32 vcc, -1, v16
  v_smfmac_f32_16x16x64_bf16 v[56:59], v[12:15], v[152:159], v3
  buffer_load_dwordx4 v[88:91], v117, s[8:11], s26 offen offset:0 sc1
  v_smfmac_f32_16x16x64_bf16 v[62:65], v[12:15], v[208:215], v3
  s_cbranch_vccnz cA_sc3_r2
cA_sc3_c2:
  v_smfmac_f32_16x16x64_bf16 v[36:39], v[16:19], a[16:23], v3
  v_smfmac_f32_16x16x64_bf16 v[40:43], v[16:19], a[72:79], v3
  v_smfmac_f32_16x16x64_bf16 v[44:47], v[16:19], a[128:135], v3
  buffer_load_dwordx4 v[92:95], v117, s[8:11], s26 offen offset:1024 sc1
  v_smfmac_f32_16x16x64_bf16 v[48:51], v[16:19], a[184:191], v3
  v_smfmac_f32_16x16x64_bf16 v[52:55], v[16:19], a[240:247], v3
  s_waitcnt vmcnt(5)
  v_cmp_eq_u32 vcc, -1, v20
  v_smfmac_f32_16x16x64_bf16 v[56:59], v[16:19], v[160:167], v3
  v_smfmac_f32_16x16x64_bf16 v[62:65], v[16:19], v[216:223], v3
  buffer_load_dwordx4 v[96:99], v2, s[8:11], s24 offen offset:0 sc1
  s_cbranch_vccnz cA_sc3_r3
cA_sc3_c3:
  v_smfmac_f32_16x16x64_bf16 v[36:39], v[20:23], a[24:31], v3
  v_smfmac_f32_16x16x64_bf16 v[40:43], v[20:23], a[80:87], v3
  s_waitcnt vmcnt(3)
  v_max3_u32 v66, v24, v27, v28
  v_smfmac_f32_16x16x64_bf16 v[44:47], v[20:23], a[136:143], v3
  v_max3_u32 v66, v66, v31, v32
  v_smfmac_f32_16x16x64_bf16 v[48:51], v[20:23], a[192:199], v3
  buffer_load_dwordx4 v[100:103], v2, s[8:11], s24 offen offset:1024 sc1
  v_max_u32 v66, v66, v35
  v_smfmac_f32_16x16x64_bf16 v[52:55], v[20:23], a[248:255], v3
  v_cmp_eq_u32 vcc, -1, v66
  v_smfmac_f32_16x16x64_bf16 v[56:59], v[20:23], v[168:175], v3
  v_smfmac_f32_16x16x64_bf16 v[62:65], v[20:23], v[224:231], v3
  s_cbranch_vccnz cA_sc3_r4
cA_sc3_c4:
  v_smfmac_f32_16x16x64_bf16 v[62:65], v[24:27], v[232:239], v3
  buffer_load_dwordx4 v[104:107], v2, s[8:11], s26 offen offset:0 sc1
  v_smfmac_f32_16x16x64_bf16 v[62:65], v[28:31], v[240:247], v3
  v_smfmac_f32_16x16x64_bf16 v[62:65], v[32:35], v[248:255], v3
  v_smfmac_f32_16x16x64_bf16 v[52:55], v[24:27], v[120:127], v3
  v_smfmac_f32_16x16x64_bf16 v[52:55], v[28:31], v[128:135], v3
  buffer_load_dwordx4 v[108:111], v2, s[8:11], s26 offen offset:1024 sc1
  v_smfmac_f32_16x16x64_bf16 v[52:55], v[32:35], v[136:143], v3
  v_cvt_pk_bf16_f32 v62, v62, v63
  v_smfmac_f32_16x16x64_bf16 v[56:59], v[24:27], v[176:183], v3
  v_cvt_pk_bf16_f32 v63, v64, v65
  v_smfmac_f32_16x16x64_bf16 v[56:59], v[28:31], v[184:191], v3
  v_mfma_f32_16x16x32_bf16 v[8:11], v[60:63], v[4:7], 0
  v_cvt_pk_bf16_f32 v55, v54, v55
  v_smfmac_f32_16x16x64_bf16 v[56:59], v[32:35], v[192:199], v3
  v_cvt_pk_bf16_f32 v54, v52, v53
  v_smfmac_f32_16x16x64_bf16 v[36:39], v[24:27], a[32:39], v3
  s_nop 1
  v_cvt_pk_bf16_f32 v78, v8, v9
  v_smfmac_f32_16x16x64_bf16 v[36:39], v[28:31], a[40:47], v3
  v_cvt_pk_bf16_f32 v79, v10, v11
  v_smfmac_f32_16x16x64_bf16 v[36:39], v[32:35], a[48:55], v3
  v_cvt_pk_bf16_f32 v56, v56, v57
  v_smfmac_f32_16x16x64_bf16 v[40:43], v[24:27], a[88:95], v3
  v_cvt_pk_bf16_f32 v57, v58, v59
  v_smfmac_f32_16x16x64_bf16 v[40:43], v[28:31], a[96:103], v3
  v_mfma_f32_16x16x32_bf16 v[12:15], v[54:57], v[4:7], 0
  v_cvt_pk_bf16_f32 v39, v38, v39
  v_smfmac_f32_16x16x64_bf16 v[40:43], v[32:35], a[104:111], v3
  v_cvt_pk_bf16_f32 v38, v36, v37
  v_smfmac_f32_16x16x64_bf16 v[44:47], v[24:27], a[144:151], v3
  s_nop 1
  v_cvt_pk_bf16_f32 v76, v12, v13
  v_smfmac_f32_16x16x64_bf16 v[44:47], v[28:31], a[152:159], v3
  v_cvt_pk_bf16_f32 v77, v14, v15
  v_smfmac_f32_16x16x64_bf16 v[44:47], v[32:35], a[160:167], v3
  v_cvt_pk_bf16_f32 v40, v40, v41
  v_smfmac_f32_16x16x64_bf16 v[48:51], v[24:27], a[200:207], v3
  v_cvt_pk_bf16_f32 v41, v42, v43
  v_smfmac_f32_16x16x64_bf16 v[48:51], v[28:31], a[208:215], v3
  v_smfmac_f32_16x16x64_bf16 v[48:51], v[32:35], a[216:223], v3
  s_waitcnt vmcnt(4)
  v_cvt_pk_bf16_f32 v47, v46, v47
  v_smfmac_f32_16x16x64_bf16 v[68:71], v[76:79], v[80:87], v3
  v_cvt_pk_bf16_f32 v46, v44, v45
  v_mfma_f32_16x16x32_bf16 v[8:11], v[38:41], v[4:7], 0
  s_nop 1
  v_cvt_pk_bf16_f32 v48, v48, v49
  v_cvt_pk_bf16_f32 v49, v50, v51
  s_nop 1
  v_mfma_f32_16x16x32_bf16 v[12:15], v[46:49], v[4:7], 0
  v_smfmac_f32_16x16x64_bf16 v[72:75], v[76:79], v[88:95], v3
  v_cvt_pk_bf16_f32 v16, v8, v9
  v_mfma_f32_16x16x32_bf16 v[52:55], v[30:33], v[76:79], 0
  s_waitcnt vmcnt(0)
  v_cvt_pk_bf16_f32 v17, v10, v11
  v_cvt_pk_bf16_f32 v18, v12, v13
  v_cvt_pk_bf16_f32 v19, v14, v15
  s_nop 1
  v_mfma_f32_16x16x32_bf16 v[52:55], v[20:23], v[16:19], v[52:55]
  v_smfmac_f32_16x16x64_bf16 v[68:71], v[16:19], v[96:103], v3
  v_smfmac_f32_16x16x64_bf16 v[72:75], v[16:19], v[104:111], v3
  s_nop 1
  ds_write_b128 v113, v[52:55]
  s_nop 1
  v_permlane32_swap_b32 v68, v70
  v_permlane32_swap_b32 v69, v71
  v_add_f32 v56, v68, v70
  v_add_f32 v58, v69, v71
  v_permlane32_swap_b32 v72, v74
  v_permlane32_swap_b32 v73, v75
  v_add_f32 v57, v72, v74
  v_add_f32 v59, v73, v75
  ds_write_b128 v2, v[56:59] offset:3072
  v_cmp_u_f32 vcc, v57, v59
  v_mov_b32 v68, 0
  v_mov_b32 v69, 0
  v_mov_b32 v70, 0
  v_mov_b32 v71, 0
  s_cbranch_vccnz cA_sc3_retry
cA_sc3_cont:
  s_add_u32 s24, s24, 28672
  s_add_u32 s26, s26, 28672
  buffer_load_dwordx4 v[80:83], v117, s[8:11], s24 offen offset:0 sc1
  buffer_load_dwordx4 v[84:87], v117, s[8:11], s24 offen offset:1024 sc1
  v_mov_b32 v72, 0
  v_mov_b32 v73, 0
  v_mfma_f32_16x16x32_bf16 v[62:65], v[68:71], v[68:71], 0
  s_waitcnt lgkmcnt(0)
  s_barrier
  v_mov_b32 v52, 0
  v_mov_b32 v53, 0
  v_mov_b32 v54, 0
  v_mov_b32 v55, 0
  v_mov_b32 v56, 0
  v_mov_b32 v57, 0
  v_mov_b32 v58, 0
  v_mov_b32 v59, 0
  v_mfma_f32_32x32x16_bf16 v[36:51], v[68:71], v[68:71], 0
  v_mov_b32 v74, 0
  v_mov_b32 v75, 0
  s_mov_b32 s19, s18
  s_add_u32 s18, s18, 1
  s_mov_b32 s22, s20
  s_mov_b32 s20, s21
  s_mov_b32 s21, s22
  s_add_u32 s23, s20, 4096
  s_cmp_lt_u32 s19, 63
  s_nop 2
  s_cbranch_scc1 cA_sc3_loop
  s_branch cA_done
cA_sc3_r0:
  s_add_u32 s31, s31, 1
  buffer_load_dwordx4 v[8:11], v2, s[8:11], s20 offen offset:0 sc1
  s_waitcnt vmcnt(0)
  v_cmp_eq_u32 vcc, -1, v8
  v_mov_b32 v36, 0
  v_mov_b32 v37, 0
  v_mov_b32 v38, 0
  v_mov_b32 v39, 0
  v_mov_b32 v40, 0
  v_mov_b32 v41, 0
  v_mov_b32 v42, 0
  v_mov_b32 v43, 0
  v_mov_b32 v44, 0
  v_mov_b32 v45, 0
  v_mov_b32 v46, 0
  v_mov_b32 v47, 0
  v_mov_b32 v48, 0
  v_mov_b32 v49, 0
  v_mov_b32 v50, 0
  v_mov_b32 v51, 0
  s_nop 1
  s_cbranch_vccz cA_sc3_go
  s_add_u32 s30, s30, 1
  s_cmp_lt_u32 s30, 400000
  s_cbranch_scc1 cA_sc3_r0
  s_branch cA_abort
cA_sc3_r1:
  s_add_u32 s31, s31, 1
  buffer_load_dwordx4 v[12:15], v2, s[8:11], s20 offen offset:1024 sc1
  s_waitcnt vmcnt(0)
  v_cmp_eq_u32 vcc, -1, v12
  s_nop 4
  s_cbranch_vccz cA_sc3_c1
  s_add_u32 s30, s30, 1
  s_cmp_lt_u32 s30, 400000
  s_cbranch_scc1 cA_sc3_r1
  s_branch cA_abort
cA_sc3_r2:
  s_add_u32 s31, s31, 1
  buffer_load_dwordx4 v[16:19], v2, s[8:11], s20 offen offset:2048 sc1
  s_waitcnt vmcnt(0)
  v_cmp_eq_u32 vcc, -1, v16
  s_nop 4
  s_cbranch_vccz cA_sc3_c2
  s_add_u32 s30, s30, 1
  s_cmp_lt_u32 s30, 400000
  s_cbranch_scc1 cA_sc3_r2
  s_branch cA_abort
cA_sc3_r3:
  s_add_u32 s31, s31, 1
  buffer_load_dwordx4 v[20:23], v2, s[8:11], s20 offen offset:3072 sc1
  s_waitcnt vmcnt(0)
  v_cmp_eq_u32 vcc, -1, v20
  s_nop 4
  s_cbranch_vccz cA_sc3_c3
  s_add_u32 s30, s30, 1
  s_cmp_lt_u32 s30, 400000
  s_cbranch_scc1 cA_sc3_r3
  s_branch cA_abort
cA_sc3_r4:
  s_add_u32 s31, s31, 1
  buffer_load_dwordx4 v[24:27], v2, s[8:11], s23 offen offset:0 sc1
  buffer_load_dwordx4 v[28:31], v2, s[8:11], s23 offen offset:1024 sc1
  buffer_load_dwordx4 v[32:35], v2, s[8:11], s23 offen offset:2048 sc1
  s_waitcnt vmcnt(0)
  v_max3_u32 v66, v24, v27, v28
  v_max3_u32 v66, v66, v31, v32
  v_max_u32 v66, v66, v35
  v_cmp_eq_u32 vcc, -1, v66
  s_nop 4
  s_cbranch_vccz cA_sc3_c4
  s_add_u32 s30, s30, 1
  s_cmp_lt_u32 s30, 400000
  s_cbranch_scc1 cA_sc3_r4
  s_branch cA_abort
cA_sc3_retry:
  s_cmp_lg_u32 s62, 0
  s_cbranch_scc1 cA_sc3_cont
  s_waitcnt vmcnt(0) lgkmcnt(0)
cA_sc3_rv:
  buffer_load_dwordx4 v[8:11], v2, s[8:11], s20 offen offset:0 sc1
  buffer_load_dwordx4 v[12:15], v2, s[8:11], s20 offen offset:1024 sc1
  buffer_load_dwordx4 v[16:19], v2, s[8:11], s20 offen offset:2048 sc1
  buffer_load_dwordx4 v[20:23], v2, s[8:11], s20 offen offset:3072 sc1
  buffer_load_dwordx4 v[24:27], v2, s[8:11], s23 offen offset:0 sc1
  buffer_load_dwordx4 v[28:31], v2, s[8:11], s23 offen offset:1024 sc1
  buffer_load_dwordx4 v[32:35], v2, s[8:11], s23 offen offset:2048 sc1
  s_waitcnt vmcnt(0)
  v_pk_max_u16 v66, v8, v9
  v_pk_max_u16 v66, v66, v10
  v_pk_max_u16 v66, v66, v11
  v_pk_max_u16 v66, v66, v12
  v_pk_max_u16 v66, v66, v13
  v_pk_max_u16 v66, v66, v14
  v_pk_max_u16 v66, v66, v15
  v_pk_max_u16 v66, v66, v16
  v_pk_max_u16 v66, v66, v17
  v_pk_max_u16 v66, v66, v18
  v_pk_max_u16 v66, v66, v19
  v_pk_max_u16 v66, v66, v20
  v_pk_max_u16 v66, v66, v21
  v_pk_max_u16 v66, v66, v22
  v_pk_max_u16 v66, v66, v23
  v_pk_max_u16 v66, v66, v24
  v_pk_max_u16 v66, v66, v25
  v_pk_max_u16 v66, v66, v26
  v_pk_max_u16 v66, v66, v27
  v_pk_max_u16 v66, v66, v28
  v_pk_max_u16 v66, v66, v29
  v_pk_max_u16 v66, v66, v30
  v_pk_max_u16 v66, v66, v31
  v_pk_max_u16 v66, v66, v32
  v_pk_max_u16 v66, v66, v33
  v_pk_max_u16 v66, v66, v34
  v_pk_max_u16 v66, v66, v35
  v_lshlrev_b32 v67, 16, v66
  v_max_u32 v66, v66, v67
  v_cmp_le_u32 vcc, 0xffff0000, v66
  s_cbranch_vccz cA_sc3_rk
  s_add_u32 s30, s30, 1
  s_cmp_lt_u32 s30, 400000
  s_cbranch_scc1 cA_sc3_rv
  s_branch cA_abort
cA_sc3_rk:
  s_mov_b32 s62, 1
  v_mov_b32 v36, 0
  v_mov_b32 v37, 0
  v_mov_b32 v38, 0
  v_mov_b32 v39, 0
  v_mov_b32 v40, 0
  v_mov_b32 v41, 0
  v_mov_b32 v42, 0
  v_mov_b32 v43, 0
  v_mov_b32 v44, 0
  v_mov_b32 v45, 0
  v_mov_b32 v46, 0
  v_mov_b32 v47, 0
  v_mov_b32 v48, 0
  v_mov_b32 v49, 0
  v_mov_b32 v50, 0
  v_mov_b32 v51, 0
  v_mov_b32 v62, 0
  v_mov_b32 v63, 0
  v_mov_b32 v64, 0
  v_mov_b32 v65, 0
  v_mov_b32 v68, 0
  v_mov_b32 v69, 0
  v_mov_b32 v70, 0
  v_mov_b32 v71, 0
  v_mov_b32 v72, 0
  v_mov_b32 v73, 0
  v_mov_b32 v74, 0
  v_mov_b32 v75, 0
  v_mov_b32 v52, 0
  v_mov_b32 v53, 0
  v_mov_b32 v54, 0
  v_mov_b32 v55, 0
  v_mov_b32 v56, 0
  v_mov_b32 v57, 0
  v_mov_b32 v58, 0
  v_mov_b32 v59, 0
  s_add_u32 s31, s31, 0x100
  s_nop 0
  s_branch cA_sc3_go
.p2align 6
cA_va0_loop:
  s_mov_b32 s30, 0
  s_barrier
  buffer_load_dwordx4 v[24:27], v2, s[8:11], s23 offen offset:0 sc1
  buffer_load_dwordx4 v[28:31], v2, s[8:11], s23 offen offset:1024 sc1
  s_barrier
  s_cmp_lt_u32 s19, 58
  s_cbranch_scc1 cA_va0_m1
  buffer_store_dword v160, v1, s[8:11], s38 offen sc1
  s_branch cA_va0_m2
cA_va0_m1:
  buffer_store_dword v160, v1, s[8:11], s38 offen nt
cA_va0_m2:
  s_add_u32 s22, s25, 0
  buffer_load_dwordx4 v[80:83], v6, s[8:11], s22 offen offset:0 sc1
  buffer_load_dwordx4 v[84:87], v6, s[8:11], s22 offen offset:1792 sc1
  s_add_u32 s22, s25, 3584
  buffer_load_dwordx4 v[88:91], v6, s[8:11], s22 offen offset:0 sc1
  buffer_load_dwordx4 v[92:95], v6, s[8:11], s22 offen offset:1792 sc1
  s_add_u32 s22, s25, 7168
  buffer_load_dwordx4 v[96:99], v6, s[8:11], s22 offen offset:0 sc1
  s_mul_i32 s38, s18, 7168
  s_add_u32 s38, s38, 88002560
  s_waitcnt vmcnt(6)
  ds_write_b128 v2, v[24:27] offset:12288
  ds_write_b128 v2, v[28:31] offset:13312
  v_smfmac_f32_16x16x64_bf16 v[36:39], v[24:27], a[32:39], v3
  buffer_load_dwordx4 v[100:103], v6, s[8:11], s22 offen offset:1792 sc1
  v_smfmac_f32_16x16x64_bf16 v[40:43], v[24:27], a[88:95], v3
  s_add_u32 s22, s25, 10752
  buffer_load_dwordx4 v[104:107], v6, s[8:11], s22 offen offset:0 sc1
  v_smfmac_f32_16x16x64_bf16 v[44:47], v[24:27], a[144:151], v3
  buffer_load_dwordx4 v[108:111], v6, s[8:11], s22 offen offset:1792 sc1
  v_smfmac_f32_16x16x64_bf16 v[48:51], v[24:27], a[200:207], v3
  s_add_u32 s22, s25, 14336
  buffer_load_dwordx4 v[112:115], v6, s[8:11], s22 offen offset:0 sc1
  v_smfmac_f32_16x16x64_bf16 v[52:55], v[24:27], v[176:183], v3
  s_waitcnt lgkmcnt(0)
  s_barrier
  ds_read_b128 v[8:11], v2 offset:8192
  ds_read_b128 v[12:15], v2 offset:9216
  ds_read_b128 v[16:19], v2 offset:10240
  ds_read_b128 v[20:23], v2 offset:11264
  ds_read_b128 v[32:35], v2 offset:14336
  buffer_load_dwordx4 v[116:119], v6, s[8:11], s22 offen offset:1792 sc1
  v_smfmac_f32_16x16x64_bf16 v[56:59], v[24:27], v[232:239], v3
  s_add_u32 s22, s25, 17920
  buffer_load_dwordx4 v[120:123], v6, s[8:11], s22 offen offset:0 sc1
  v_smfmac_f32_16x16x64_bf16 v[36:39], v[28:31], a[40:47], v3
  buffer_load_dwordx4 v[124:127], v6, s[8:11], s22 offen offset:1792 sc1
  v_smfmac_f32_16x16x64_bf16 v[40:43], v[28:31], a[96:103], v3
  s_add_u32 s22, s25, 21504
  buffer_load_dwordx4 v[128:131], v6, s[8:11], s22 offen offset:0 sc1
  v_smfmac_f32_16x16x64_bf16 v[44:47], v[28:31], a[152:159], v3
  buffer_load_dwordx4 v[132:135], v6, s[8:11], s22 offen offset:1792 sc1
  v_smfmac_f32_16x16x64_bf16 v[48:51], v[28:31], a[208:215], v3
  s_add_u32 s22, s25, 25088
  buffer_load_dwordx4 v[136:139], v6, s[8:11], s22 offen offset:0 sc1
  v_smfmac_f32_16x16x64_bf16 v[52:55], v[28:31], v[184:191], v3
  ds_read_b128 v[64:67], v0 offset:0
  ds_read_b128 v[68:71], v0 offset:1024
  buffer_load_dwordx4 v[140:143], v6, s[8:11], s22 offen offset:1792 sc1
  v_smfmac_f32_16x16x64_bf16 v[56:59], v[28:31], v[240:247], v3
  s_waitcnt lgkmcnt(6)
  ds_read_b128 v[72:75], v0 offset:2048
  ds_read_b128 v[76:79], v0 offset:3072
  v_smfmac_f32_16x16x64_bf16 v[36:39], v[8:11], a[0:7], v3
  s_waitcnt lgkmcnt(7)
  v_smfmac_f32_16x16x64_bf16 v[36:39], v[12:15], a[8:15], v3
  s_waitcnt lgkmcnt(6)
  v_smfmac_f32_16x16x64_bf16 v[36:39], v[16:19], a[16:23], v3
  s_waitcnt lgkmcnt(2)
  v_smfmac_f32_16x16x64_bf16 v[60:63], v[8:11], v[64:71], v3
  s_waitcnt lgkmcnt(5)
  ds_read_b128 v[144:147], v0 offset:4096
  ds_read_b128 v[148:151], v0 offset:5120
  v_smfmac_f32_16x16x64_bf16 v[36:39], v[20:23], a[24:31], v3
  s_waitcnt lgkmcnt(6)
  v_smfmac_f32_16x16x64_bf16 v[36:39], v[32:35], a[48:55], v3
  v_smfmac_f32_16x16x64_bf16 v[40:43], v[8:11], a[56:63], v3
  s_waitcnt lgkmcnt(2)
  v_smfmac_f32_16x16x64_bf16 v[60:63], v[12:15], v[72:79], v3
  ds_read_b128 v[64:67], v0 offset:6144
  ds_read_b128 v[68:71], v0 offset:7168
  v_smfmac_f32_16x16x64_bf16 v[40:43], v[12:15], a[64:71], v3
  v_permlane32_swap_b32 v36, v38
  v_smfmac_f32_16x16x64_bf16 v[40:43], v[16:19], a[72:79], v3
  v_permlane32_swap_b32 v37, v39
  v_smfmac_f32_16x16x64_bf16 v[40:43], v[20:23], a[80:87], v3
  s_waitcnt lgkmcnt(2)
  v_add_f32 v36, v36, v38
  v_smfmac_f32_16x16x64_bf16 v[60:63], v[16:19], v[144:151], v3
  ds_read_b128 v[72:75], v0 offset:8192
  ds_read_b128 v[76:79], v0 offset:9216
  v_add_f32 v37, v37, v39
  v_smfmac_f32_16x16x64_bf16 v[40:43], v[32:35], a[104:111], v3
  v_cmp_u_f32 vcc, v36, v37
  v_smfmac_f32_16x16x64_bf16 v[44:47], v[8:11], a[112:119], v3
  v_cvt_pk_bf16_f32 v38, v36, v37
  v_smfmac_f32_16x16x64_bf16 v[44:47], v[12:15], a[120:127], v3
  ds_write_b32 v152, v38
  s_waitcnt lgkmcnt(3)
  s_cbranch_vccnz cA_va0_slow
  v_permlane32_swap_b32 v40, v42
  v_smfmac_f32_16x16x64_bf16 v[60:63], v[20:23], v[64:71], v3
  ds_read_b128 v[144:147], v0 offset:10240
  ds_read_b128 v[148:151], v0 offset:11264
  v_permlane32_swap_b32 v41, v43
  v_smfmac_f32_16x16x64_bf16 v[44:47], v[16:19], a[128:135], v3
  buffer_store_dword v162, v1, s[8:11], s21 offen
  v_add_f32 v40, v40, v42
  v_smfmac_f32_16x16x64_bf16 v[44:47], v[20:23], a[136:143], v3
  v_add_f32 v41, v41, v43
  v_smfmac_f32_16x16x64_bf16 v[44:47], v[32:35], a[160:167], v3
  s_waitcnt lgkmcnt(3)
  v_cvt_pk_bf16_f32 v42, v40, v41
  v_smfmac_f32_16x16x64_bf16 v[60:63], v[24:27], v[72:79], v3
  ds_write_b32 v153, v42
  ds_read_b128 v[64:67], v0 offset:12288
  ds_read_b128 v[68:71], v0 offset:13312
  v_smfmac_f32_16x16x64_bf16 v[48:51], v[8:11], a[168:175], v3
  s_nop 0
  v_permlane32_swap_b32 v44, v46
  v_smfmac_f32_16x16x64_bf16 v[48:51], v[12:15], a[176:183], v3
  v_permlane32_swap_b32 v45, v47
  v_smfmac_f32_16x16x64_bf16 v[48:51], v[16:19], a[184:191], v3
  s_waitcnt lgkmcnt(3)
  v_add_f32 v44, v44, v46
  v_smfmac_f32_16x16x64_bf16 v[60:63], v[28:31], v[144:151], v3
  v_add_f32 v45, v45, v47
  v_smfmac_f32_16x16x64_bf16 v[48:51], v[20:23], a[192:199], v3
  buffer_load_dword v164, v4, s[8:11], 0 offen sc1
  v_cvt_pk_bf16_f32 v46, v44, v45
  v_smfmac_f32_16x16x64_bf16 v[48:51], v[32:35], a[216:223], v3
  ds_write_b32 v154, v46
  v_smfmac_f32_16x16x64_bf16 v[52:55], v[8:11], a[224:231], v3
  s_waitcnt lgkmcnt(1)
  v_smfmac_f32_16x16x64_bf16 v[60:63], v[32:35], v[64:71], v3
  buffer_load_dword v164, v4, s[8:11], 0 offen sc1
  v_smfmac_f32_16x16x64_bf16 v[52:55], v[12:15], a[232:239], v3
  v_permlane32_swap_b32 v48, v50
  v_smfmac_f32_16x16x64_bf16 v[52:55], v[16:19], a[240:247], v3
  v_permlane32_swap_b32 v49, v51
  v_smfmac_f32_16x16x64_bf16 v[52:55], v[20:23], a[248:255], v3
  buffer_load_dword v164, v4, s[8:11], 0 offen sc1
  v_add_f32 v48, v48, v50
  v_smfmac_f32_16x16x64_bf16 v[52:55], v[32:35], v[192:199], v3
  v_add_f32 v49, v49, v51
  v_smfmac_f32_16x16x64_bf16 v[56:59], v[8:11], v[200:207], v3
  v_cvt_pk_bf16_f32 v50, v48, v49
  v_smfmac_f32_16x16x64_bf16 v[56:59], v[12:15], v[208:215], v3
  ds_write_b32 v155, v50
  buffer_load_dword v164, v4, s[8:11], 0 offen sc1
  v_permlane32_swap_b32 v60, v62
  v_smfmac_f32_16x16x64_bf16 v[56:59], v[16:19], v[216:223], v3
  v_permlane32_swap_b32 v61, v63
  v_smfmac_f32_16x16x64_bf16 v[56:59], v[20:23], v[224:231], v3
  v_add_f32 v60, v60, v62
  v_smfmac_f32_16x16x64_bf16 v[56:59], v[32:35], v[248:255], v3
  buffer_load_dword v164, v4, s[8:11], 0 offen sc1
  v_add_f32 v61, v61, v63
  v_cvt_pk_bf16_f32 v62, v60, v61
  ds_write_b32 v158, v62
  v_permlane32_swap_b32 v52, v54
  v_permlane32_swap_b32 v53, v55
  v_add_f32 v52, v52, v54
  v_add_f32 v53, v53, v55
  v_cvt_pk_bf16_f32 v54, v52, v53
  ds_write_b32 v156, v54
  v_permlane32_swap_b32 v56, v58
  v_permlane32_swap_b32 v57, v59
  v_add_f32 v56, v56, v58
  v_add_f32 v57, v57, v59
  v_cvt_pk_bf16_f32 v58, v56, v57
  ds_write_b32 v157, v58
cA_va0_t2d:
  s_add_u32 s22, s20, 9216
  s_add_u32 s34, s20, 13312
  s_add_u32 s36, s20, 7168
  s_mov_b32 s37, 0
  v_mov_b32 v48, 0
  v_mov_b32 v49, 0
  v_mov_b32 v50, 0
  v_mov_b32 v51, 0
  v_mov_b32 v163, s18
  s_waitcnt lgkmcnt(0)
  s_setprio 3
cA_va0_fw_l:
  v_cmp_gt_u32 vcc, s18, v164
  buffer_load_dword v164, v4, s[8:11], 0 offen sc1
  s_cbranch_vccz cA_va0_fw_d
  v_cmp_gt_u32 vcc, s18, v164
  buffer_load_dword v164, v4, s[8:11], 0 offen sc1
  s_cbranch_vccz cA_va0_fw_d
  v_cmp_gt_u32 vcc, s18, v164
  buffer_load_dword v164, v4, s[8:11], 0 offen sc1
  s_cbranch_vccz cA_va0_fw_d
  v_cmp_gt_u32 vcc, s18, v164
  buffer_load_dword v164, v4, s[8:11], 0 offen sc1
  s_cbranch_vccz cA_va0_fw_d
  v_cmp_gt_u32 vcc, s18, v164
  buffer_load_dword v164, v4, s[8:11], 0 offen sc1
  s_cbranch_vccz cA_va0_fw_d
  v_cmp_gt_u32 vcc, s18, v164
  buffer_load_dword v164, v4, s[8:11], 0 offen sc1
  s_cbranch_vccz cA_va0_fw_d
  v_cmp_gt_u32 vcc, s18, v164
  buffer_load_dword v164, v4, s[8:11], 0 offen sc1
  s_cbranch_vccz cA_va0_fw_d
  v_cmp_gt_u32 vcc, s18, v164
  buffer_load_dword v164, v4, s[8:11], 0 offen sc1
  s_cbranch_vccz cA_va0_fw_d
  v_cmp_gt_u32 vcc, s18, v164
  buffer_load_dword v164, v4, s[8:11], 0 offen sc1
  s_cbranch_vccz cA_va0_fw_d
  v_cmp_gt_u32 vcc, s18, v164
  buffer_load_dword v164, v4, s[8:11], 0 offen sc1
  s_cbranch_vccz cA_va0_fw_d
  v_cmp_gt_u32 vcc, s18, v164
  buffer_load_dword v164, v4, s[8:11], 0 offen sc1
  s_cbranch_vccz cA_va0_fw_d
  v_cmp_gt_u32 vcc, s18, v164
  buffer_load_dword v164, v4, s[8:11], 0 offen sc1
  s_cbranch_vccz cA_va0_fw_d
  v_cmp_gt_u32 vcc, s18, v164
  buffer_load_dword v164, v4, s[8:11], 0 offen sc1
  s_cbranch_vccz cA_va0_fw_d
  v_cmp_gt_u32 vcc, s18, v164
  buffer_load_dword v164, v4, s[8:11], 0 offen sc1
  s_cbranch_vccz cA_va0_fw_d
  v_cmp_gt_u32 vcc, s18, v164
  buffer_load_dword v164, v4, s[8:11], 0 offen sc1
  s_cbranch_vccz cA_va0_fw_d
  v_cmp_gt_u32 vcc, s18, v164
  buffer_load_dword v164, v4, s[8:11], 0 offen sc1
  s_cbranch_vccz cA_va0_fw_d
  s_waitcnt vmcnt(24)
  s_add_u32 s30, s30, 1
  s_cmp_lt_u32 s30, 400000
  s_cbranch_scc1 cA_va0_fw_l
  s_branch cA_abort
cA_va0_fw_d:
  buffer_load_dwordx4 v[8:11], v2, s[8:11], s22 offen offset:0 sc1
  buffer_load_dwordx4 v[12:15], v2, s[8:11], s22 offen offset:1024 sc1
  buffer_load_dwordx4 v[16:19], v2, s[8:11], s22 offen offset:2048 sc1
  buffer_load_dwordx4 v[20:23], v2, s[8:11], s22 offen offset:3072 sc1
  buffer_load_dwordx4 v[24:27], v2, s[8:11], s34 offen offset:0 sc1
  buffer_load_dwordx4 v[28:31], v2, s[8:11], s34 offen offset:1024 sc1
  buffer_load_dwordx4 v[32:35], v2, s[8:11], s34 offen offset:2048 sc1
  buffer_load_dwordx4 v[36:39], v2, s[8:11], s34 offen offset:3072 sc1
  buffer_load_dwordx4 v[40:43], v2, s[8:11], s36 offen offset:0 sc1
  buffer_load_dwordx4 v[44:47], v2, s[8:11], s36 offen offset:1024 sc1
  s_barrier
  ds_read_b128 v[64:67], v2 offset:0
  ds_read_b128 v[68:71], v2 offset:1024
  ds_read_b128 v[72:75], v2 offset:2048
  ds_read_b128 v[76:79], v2 offset:3072
cA_va0_lp:
  s_waitcnt vmcnt(9)
  v_smfmac_f32_16x16x64_bf16 v[48:51], v[8:11], v[80:87], v3
  s_waitcnt vmcnt(8)
  v_smfmac_f32_16x16x64_bf16 v[48:51], v[12:15], v[88:95], v3
  s_waitcnt vmcnt(7)
  v_smfmac_f32_16x16x64_bf16 v[48:51], v[16:19], v[96:103], v3
  s_waitcnt vmcnt(6)
  v_smfmac_f32_16x16x64_bf16 v[48:51], v[20:23], v[104:111], v3
  s_waitcnt vmcnt(5)
  v_smfmac_f32_16x16x64_bf16 v[48:51], v[24:27], v[112:119], v3
  s_waitcnt vmcnt(4)
  v_smfmac_f32_16x16x64_bf16 v[48:51], v[28:31], v[120:127], v3
  s_waitcnt vmcnt(3)
  v_smfmac_f32_16x16x64_bf16 v[48:51], v[32:35], v[128:135], v3
  s_waitcnt vmcnt(2)
  v_smfmac_f32_16x16x64_bf16 v[48:51], v[36:39], v[136:143], v3
  s_waitcnt vmcnt(1) lgkmcnt(0)
  v_smfmac_f32_16x16x64_bf16 v[48:51], v[40:43], v[64:71], v3
  s_waitcnt vmcnt(0)
  v_smfmac_f32_16x16x64_bf16 v[48:51], v[44:47], v[72:79], v3
  s_nop 7
  v_permlane32_swap_b32 v48, v50
  v_permlane32_swap_b32 v49, v51
  v_add_f32 v48, v48, v50
  v_add_f32 v49, v49, v51
  v_cvt_pk_bf16_f32 v160, v48, v49
  v_cmp_u_f32 vcc, v48, v49
  s_nop 0
  v_mov_b32_dpp v161, v160 quad_perm:[1,0,3,2] row_mask:0xf bank_mask:0xf
  v_perm_b32 v160, v161, v160, v5
  v_min_u32 v160, -2, v160
  s_cbranch_vccnz cA_va0_rp
cA_va0_cont:
  buffer_store_dword v160, v1, s[8:11], s21 offen
  s_setprio 0
  s_cmp_lg_u32 s19, 62
  s_cbranch_scc1 cA_va0_nl
  buffer_store_dword v160, v1, s[8:11], s38 offen sc1
  s_waitcnt vmcnt(0)
  buffer_wbl2 sc1
  s_branch cA_done
cA_va0_nl:
  s_add_u32 s25, s25, 458752
  v_mov_b32 v36, 0
  v_mov_b32 v37, 0
  v_mov_b32 v38, 0
  v_mov_b32 v39, 0
  v_mov_b32 v40, 0
  v_mov_b32 v41, 0
  v_mov_b32 v42, 0
  v_mov_b32 v43, 0
  v_mov_b32 v44, 0
  v_mov_b32 v45, 0
  v_mov_b32 v46, 0
  v_mov_b32 v47, 0
  v_mov_b32 v48, 0
  v_mov_b32 v49, 0
  v_mov_b32 v50, 0
  v_mov_b32 v51, 0
  v_mov_b32 v52, 0
  v_mov_b32 v53, 0
  v_mov_b32 v54, 0
  v_mov_b32 v55, 0
  v_mov_b32 v56, 0
  v_mov_b32 v57, 0
  v_mov_b32 v58, 0
  v_mov_b32 v59, 0
  v_mov_b32 v60, 0
  v_mov_b32 v61, 0
  v_mov_b32 v62, 0
  v_mov_b32 v63, 0
  s_mov_b32 s19, s18
  s_add_u32 s18, s18, 1
  s_mov_b32 s22, s20
  s_mov_b32 s20, s21
  s_mov_b32 s21, s22
  s_add_u32 s23, s20, 4096
  s_branch cA_va0_loop
cA_va0_slow:
  s_waitcnt lgkmcnt(0)
cA_va0_sl1:
  s_add_u32 s31, s31, 0x1000000
  buffer_load_dwordx4 v[8:11], v2, s[8:11], s20 offen offset:0 sc1
  buffer_load_dwordx4 v[12:15], v2, s[8:11], s20 offen offset:1024 sc1
  buffer_load_dwordx4 v[16:19], v2, s[8:11], s20 offen offset:2048 sc1
  buffer_load_dwordx4 v[20:23], v2, s[8:11], s20 offen offset:3072 sc1
  buffer_load_dwordx4 v[24:27], v2, s[8:11], s23 offen offset:0 sc1
  buffer_load_dwordx4 v[28:31], v2, s[8:11], s23 offen offset:1024 sc1
  buffer_load_dwordx4 v[32:35], v2, s[8:11], s23 offen offset:2048 sc1
  s_waitcnt vmcnt(0)
  v_max3_u32 v36, v8, v9, v10
  v_max3_u32 v36, v36, v11, v12
  v_max3_u32 v36, v36, v13, v14
  v_max3_u32 v36, v36, v15, v16
  v_max3_u32 v36, v36, v17, v18
  v_max3_u32 v36, v36, v19, v20
  v_max3_u32 v36, v36, v21, v22
  v_max3_u32 v36, v36, v23, v24
  v_max3_u32 v36, v36, v25, v26
  v_max3_u32 v36, v36, v27, v28
  v_max3_u32 v36, v36, v29, v30
  v_max3_u32 v36, v36, v31, v32
  v_max3_u32 v36, v36, v33, v34
  v_max_u32 v36, v36, v35
  v_cmp_eq_u32 vcc, -1, v36
  s_cbranch_vccz cA_va0_sl2
  s_add_u32 s30, s30, 1
  s_cmp_lt_u32 s30, 400000
  s_cbranch_scc1 cA_va0_sl1
  s_branch cA_abort
cA_va0_sl2:
  v_mov_b32 v36, 0
  v_mov_b32 v37, 0
  v_mov_b32 v38, 0
  v_mov_b32 v39, 0
  v_mov_b32 v40, 0
  v_mov_b32 v41, 0
  v_mov_b32 v42, 0
  v_mov_b32 v43, 0
  v_mov_b32 v44, 0
  v_mov_b32 v45, 0
  v_mov_b32 v46, 0
  v_mov_b32 v47, 0
  v_mov_b32 v48, 0
  v_mov_b32 v49, 0
  v_mov_b32 v50, 0
  v_mov_b32 v51, 0
  v_mov_b32 v52, 0
  v_mov_b32 v53, 0
  v_mov_b32 v54, 0
  v_mov_b32 v55, 0
  v_mov_b32 v56, 0
  v_mov_b32 v57, 0
  v_mov_b32 v58, 0
  v_mov_b32 v59, 0
  v_mov_b32 v60, 0
  v_mov_b32 v61, 0
  v_mov_b32 v62, 0
  v_mov_b32 v63, 0
  buffer_store_dword v162, v1, s[8:11], s21 offen
  ds_read_b128 v[64:67], v0 offset:0
  ds_read_b128 v[68:71], v0 offset:1024
  v_smfmac_f32_16x16x64_bf16 v[36:39], v[8:11], a[0:7], v3
  v_smfmac_f32_16x16x64_bf16 v[40:43], v[8:11], a[56:63], v3
  v_smfmac_f32_16x16x64_bf16 v[44:47], v[8:11], a[112:119], v3
  v_smfmac_f32_16x16x64_bf16 v[48:51], v[8:11], a[168:175], v3
  v_smfmac_f32_16x16x64_bf16 v[52:55], v[8:11], a[224:231], v3
  v_smfmac_f32_16x16x64_bf16 v[56:59], v[8:11], v[200:207], v3
  s_waitcnt lgkmcnt(0)
  v_smfmac_f32_16x16x64_bf16 v[60:63], v[8:11], v[64:71], v3
  ds_read_b128 v[72:75], v0 offset:2048
  ds_read_b128 v[76:79], v0 offset:3072
  v_smfmac_f32_16x16x64_bf16 v[36:39], v[12:15], a[8:15], v3
  v_smfmac_f32_16x16x64_bf16 v[40:43], v[12:15], a[64:71], v3
  v_smfmac_f32_16x16x64_bf16 v[44:47], v[12:15], a[120:127], v3
  v_smfmac_f32_16x16x64_bf16 v[48:51], v[12:15], a[176:183], v3
  v_smfmac_f32_16x16x64_bf16 v[52:55], v[12:15], a[232:239], v3
  v_smfmac_f32_16x16x64_bf16 v[56:59], v[12:15], v[208:215], v3
  s_waitcnt lgkmcnt(0)
  v_smfmac_f32_16x16x64_bf16 v[60:63], v[12:15], v[72:79], v3
  ds_read_b128 v[144:147], v0 offset:4096
  ds_read_b128 v[148:151], v0 offset:5120
  v_smfmac_f32_16x16x64_bf16 v[36:39], v[16:19], a[16:23], v3
  v_smfmac_f32_16x16x64_bf16 v[40:43], v[16:19], a[72:79], v3
  v_smfmac_f32_16x16x64_bf16 v[44:47], v[16:19], a[128:135], v3
  v_smfmac_f32_16x16x64_bf16 v[48:51], v[16:19], a[184:191], v3
  v_smfmac_f32_16x16x64_bf16 v[52:55], v[16:19], a[240:247], v3
  v_smfmac_f32_16x16x64_bf16 v[56:59], v[16:19], v[216:223], v3
  s_waitcnt lgkmcnt(0)
  v_smfmac_f32_16x16x64_bf16 v[60:63], v[16:19], v[144:151], v3
  ds_read_b128 v[64:67], v0 offset:6144
  ds_read_b128 v[68:71], v0 offset:7168
  v_smfmac_f32_16x16x64_bf16 v[36:39], v[20:23], a[24:31], v3
  v_smfmac_f32_16x16x64_bf16 v[40:43], v[20:23], a[80:87], v3
  v_smfmac_f32_16x16x64_bf16 v[44:47], v[20:23], a[136:143], v3
  v_smfmac_f32_16x16x64_bf16 v[48:51], v[20:23], a[192:199], v3
  v_smfmac_f32_16x16x64_bf16 v[52:55], v[20:23], a[248:255], v3
  v_smfmac_f32_16x16x64_bf16 v[56:59], v[20:23], v[224:231], v3
  s_waitcnt lgkmcnt(0)
  v_smfmac_f32_16x16x64_bf16 v[60:63], v[20:23], v[64:71], v3
  ds_read_b128 v[72:75], v0 offset:8192
  ds_read_b128 v[76:79], v0 offset:9216
  v_smfmac_f32_16x16x64_bf16 v[36:39], v[24:27], a[32:39], v3
  v_smfmac_f32_16x16x64_bf16 v[40:43], v[24:27], a[88:95], v3
  v_smfmac_f32_16x16x64_bf16 v[44:47], v[24:27], a[144:151], v3
  v_smfmac_f32_16x16x64_bf16 v[48:51], v[24:27], a[200:207], v3
  v_smfmac_f32_16x16x64_bf16 v[52:55], v[24:27], v[176:183], v3
  v_smfmac_f32_16x16x64_bf16 v[56:59], v[24:27], v[232:239], v3
  s_waitcnt lgkmcnt(0)
  v_smfmac_f32_16x16x64_bf16 v[60:63], v[24:27], v[72:79], v3
  ds_read_b128 v[144:147], v0 offset:10240
  ds_read_b128 v[148:151], v0 offset:11264
  v_smfmac_f32_16x16x64_bf16 v[36:39], v[28:31], a[40:47], v3
  v_smfmac_f32_16x16x64_bf16 v[40:43], v[28:31], a[96:103], v3
  v_smfmac_f32_16x16x64_bf16 v[44:47], v[28:31], a[152:159], v3
  v_smfmac_f32_16x16x64_bf16 v[48:51], v[28:31], a[208:215], v3
  v_smfmac_f32_16x16x64_bf16 v[52:55], v[28:31], v[184:191], v3
  v_smfmac_f32_16x16x64_bf16 v[56:59], v[28:31], v[240:247], v3
  s_waitcnt lgkmcnt(0)
  v_smfmac_f32_16x16x64_bf16 v[60:63], v[28:31], v[144:151], v3
  ds_read_b128 v[64:67], v0 offset:12288
  ds_read_b128 v[68:71], v0 offset:13312
  v_smfmac_f32_16x16x64_bf16 v[36:39], v[32:35], a[48:55], v3
  v_smfmac_f32_16x16x64_bf16 v[40:43], v[32:35], a[104:111], v3
  v_smfmac_f32_16x16x64_bf16 v[44:47], v[32:35], a[160:167], v3
  v_smfmac_f32_16x16x64_bf16 v[48:51], v[32:35], a[216:223], v3
  v_smfmac_f32_16x16x64_bf16 v[52:55], v[32:35], v[192:199], v3
  v_smfmac_f32_16x16x64_bf16 v[56:59], v[32:35], v[248:255], v3
  s_waitcnt lgkmcnt(0)
  v_smfmac_f32_16x16x64_bf16 v[60:63], v[32:35], v[64:71], v3
  v_permlane32_swap_b32 v36, v38
  v_permlane32_swap_b32 v37, v39
  v_add_f32 v36, v36, v38
  v_add_f32 v37, v37, v39
  v_cvt_pk_bf16_f32 v38, v36, v37
  ds_write_b32 v152, v38
  v_permlane32_swap_b32 v40, v42
  v_permlane32_swap_b32 v41, v43
  v_add_f32 v40, v40, v42
  v_add_f32 v41, v41, v43
  v_cvt_pk_bf16_f32 v42, v40, v41
  ds_write_b32 v153, v42
  v_permlane32_swap_b32 v44, v46
  v_permlane32_swap_b32 v45, v47
  v_add_f32 v44, v44, v46
  v_add_f32 v45, v45, v47
  v_cvt_pk_bf16_f32 v46, v44, v45
  ds_write_b32 v154, v46
  v_permlane32_swap_b32 v48, v50
  v_permlane32_swap_b32 v49, v51
  v_add_f32 v48, v48, v50
  v_add_f32 v49, v49, v51
  v_cvt_pk_bf16_f32 v50, v48, v49
  ds_write_b32 v155, v50
  v_permlane32_swap_b32 v52, v54
  v_permlane32_swap_b32 v53, v55
  v_add_f32 v52, v52, v54
  v_add_f32 v53, v53, v55
  v_cvt_pk_bf16_f32 v54, v52, v53
  ds_write_b32 v156, v54
  v_permlane32_swap_b32 v56, v58
  v_permlane32_swap_b32 v57, v59
  v_add_f32 v56, v56, v58
  v_add_f32 v57, v57, v59
  v_cvt_pk_bf16_f32 v58, v56, v57
  ds_write_b32 v157, v58
  v_permlane32_swap_b32 v60, v62
  v_permlane32_swap_b32 v61, v63
  v_add_f32 v60, v60, v62
  v_add_f32 v61, v61, v63
  v_cvt_pk_bf16_f32 v62, v60, v61
  ds_write_b32 v158, v62
  buffer_load_dword v164, v4, s[8:11], 0 offen sc1
  buffer_load_dword v164, v4, s[8:11], 0 offen sc1
  buffer_load_dword v164, v4, s[8:11], 0 offen sc1
  buffer_load_dword v164, v4, s[8:11], 0 offen sc1
  buffer_load_dword v164, v4, s[8:11], 0 offen sc1
  s_branch cA_va0_t2d
cA_va0_rp:
  s_cmp_lg_u32 s37, 0
  s_cbranch_scc1 cA_va0_cont
cA_va0_rv:
  s_add_u32 s31, s31, 0x10000
  buffer_load_dwordx4 v[8:11], v2, s[8:11], s22 offen offset:0 sc1
  buffer_load_dwordx4 v[12:15], v2, s[8:11], s22 offen offset:1024 sc1
  buffer_load_dwordx4 v[16:19], v2, s[8:11], s22 offen offset:2048 sc1
  buffer_load_dwordx4 v[20:23], v2, s[8:11], s22 offen offset:3072 sc1
  buffer_load_dwordx4 v[24:27], v2, s[8:11], s34 offen offset:0 sc1
  buffer_load_dwordx4 v[28:31], v2, s[8:11], s34 offen offset:1024 sc1
  buffer_load_dwordx4 v[32:35], v2, s[8:11], s34 offen offset:2048 sc1
  buffer_load_dwordx4 v[36:39], v2, s[8:11], s34 offen offset:3072 sc1
  buffer_load_dwordx4 v[40:43], v2, s[8:11], s36 offen offset:0 sc1
  buffer_load_dwordx4 v[44:47], v2, s[8:11], s36 offen offset:1024 sc1
  s_waitcnt vmcnt(0)
  v_max3_u32 v52, v8, v9, v10
  v_max3_u32 v52, v52, v11, v12
  v_max3_u32 v52, v52, v13, v14
  v_max3_u32 v52, v52, v15, v16
  v_max3_u32 v52, v52, v17, v18
  v_max3_u32 v52, v52, v19, v20
  v_max3_u32 v52, v52, v21, v22
  v_max3_u32 v52, v52, v23, v24
  v_max3_u32 v52, v52, v25, v26
  v_max3_u32 v52, v52, v27, v28
  v_max3_u32 v52, v52, v29, v30
  v_max3_u32 v52, v52, v31, v32
  v_max3_u32 v52, v52, v33, v34
  v_max3_u32 v52, v52, v35, v36
  v_max3_u32 v52, v52, v37, v38
  v_max3_u32 v52, v52, v39, v40
  v_max3_u32 v52, v52, v41, v42
  v_max3_u32 v52, v52, v43, v44
  v_max3_u32 v52, v52, v45, v46
  v_max_u32 v52, v52, v47
  v_cmp_eq_u32 vcc, -1, v52
  s_mov_b32 s37, 1
  v_mov_b32 v48, 0
  v_mov_b32 v49, 0
  v_mov_b32 v50, 0
  v_mov_b32 v51, 0
  s_nop 1
  s_cbranch_vccz cA_va0_lp
  s_add_u32 s30, s30, 1
  s_cmp_lt_u32 s30, 400000
  s_cbranch_scc1 cA_va0_rv
  s_branch cA_abort
.p2align 6
cA_va1_loop:
  s_mov_b32 s30, 0
  s_barrier
  buffer_load_dwordx4 v[28:31], v2, s[8:11], s23 offen offset:1024 sc1
  buffer_load_dwordx4 v[32:35], v2, s[8:11], s23 offen offset:2048 sc1
  s_barrier
  s_cmp_lt_u32 s19, 58
  s_cbranch_scc1 cA_va1_m1
  buffer_store_dword v160, v1, s[8:11], s38 offen sc1
  s_branch cA_va1_m2
cA_va1_m1:
  buffer_store_dword v160, v1, s[8:11], s38 offen nt
cA_va1_m2:
  s_add_u32 s22, s25, 0
  buffer_load_dwordx4 v[80:83], v6, s[8:11], s22 offen offset:0 sc1
  buffer_load_dwordx4 v[84:87], v6, s[8:11], s22 offen offset:1792 sc1
  s_add_u32 s22, s25, 3584
  buffer_load_dwordx4 v[88:91], v6, s[8:11], s22 offen offset:0 sc1
  buffer_load_dwordx4 v[92:95], v6, s[8:11], s22 offen offset:1792 sc1
  s_add_u32 s22, s25, 7168
  buffer_load_dwordx4 v[96:99], v6, s[8:11], s22 offen offset:0 sc1
  s_mul_i32 s38, s18, 7168
  s_add_u32 s38, s38, 88002560
  s_waitcnt vmcnt(6)
  ds_write_b128 v2, v[32:35] offset:14336
  v_smfmac_f32_16x16x64_bf16 v[36:39], v[28:31], a[40:47], v3
  buffer_load_dwordx4 v[100:103], v6, s[8:11], s22 offen offset:1792 sc1
  v_smfmac_f32_16x16x64_bf16 v[40:43], v[28:31], a[96:103], v3
  s_add_u32 s22, s25, 10752
  buffer_load_dwordx4 v[104:107], v6, s[8:11], s22 offen offset:0 sc1
  v_smfmac_f32_16x16x64_bf16 v[44:47], v[28:31], a[152:159], v3
  buffer_load_dwordx4 v[108:111], v6, s[8:11], s22 offen offset:1792 sc1
  v_smfmac_f32_16x16x64_bf16 v[48:51], v[28:31], a[208:215], v3
  s_add_u32 s22, s25, 14336
  buffer_load_dwordx4 v[112:115], v6, s[8:11], s22 offen offset:0 sc1
  v_smfmac_f32_16x16x64_bf16 v[52:55], v[28:31], v[184:191], v3
  s_waitcnt lgkmcnt(0)
  s_barrier
  ds_read_b128 v[8:11], v2 offset:8192
  ds_read_b128 v[12:15], v2 offset:9216
  ds_read_b128 v[16:19], v2 offset:10240
  ds_read_b128 v[20:23], v2 offset:11264
  ds_read_b128 v[24:27], v2 offset:12288
  buffer_load_dwordx4 v[116:119], v6, s[8:11], s22 offen offset:1792 sc1
  v_smfmac_f32_16x16x64_bf16 v[56:59], v[28:31], v[240:247], v3
  s_add_u32 s22, s25, 17920
  buffer_load_dwordx4 v[120:123], v6, s[8:11], s22 offen offset:0 sc1
  v_smfmac_f32_16x16x64_bf16 v[36:39], v[32:35], a[48:55], v3
  buffer_load_dwordx4 v[124:127], v6, s[8:11], s22 offen offset:1792 sc1
  v_smfmac_f32_16x16x64_bf16 v[40:43], v[32:35], a[104:111], v3
  s_add_u32 s22, s25, 21504
  buffer_load_dwordx4 v[128:131], v6, s[8:11], s22 offen offset:0 sc1
  v_smfmac_f32_16x16x64_bf16 v[44:47], v[32:35], a[160:167], v3
  buffer_load_dwordx4 v[132:135], v6, s[8:11], s22 offen offset:1792 sc1
  v_smfmac_f32_16x16x64_bf16 v[48:51], v[32:35], a[216:223], v3
  s_add_u32 s22, s25, 25088
  buffer_load_dwordx4 v[136:139], v6, s[8:11], s22 offen offset:0 sc1
  v_smfmac_f32_16x16x64_bf16 v[52:55], v[32:35], v[192:199], v3
  ds_read_b128 v[64:67], v0 offset:0
  ds_read_b128 v[68:71], v0 offset:1024
  buffer_load_dwordx4 v[140:143], v6, s[8:11], s22 offen offset:1792 sc1
  v_smfmac_f32_16x16x64_bf16 v[56:59], v[32:35], v[248:255], v3
  s_waitcnt lgkmcnt(6)
  ds_read_b128 v[72:75], v0 offset:2048
  ds_read_b128 v[76:79], v0 offset:3072
  v_smfmac_f32_16x16x64_bf16 v[36:39], v[8:11], a[0:7], v3
  s_waitcnt lgkmcnt(7)
  v_smfmac_f32_16x16x64_bf16 v[36:39], v[12:15], a[8:15], v3
  s_waitcnt lgkmcnt(6)
  v_smfmac_f32_16x16x64_bf16 v[36:39], v[16:19], a[16:23], v3
  s_waitcnt lgkmcnt(2)
  v_smfmac_f32_16x16x64_bf16 v[60:63], v[8:11], v[64:71], v3
  s_waitcnt lgkmcnt(5)
  ds_read_b128 v[144:147], v0 offset:4096
  ds_read_b128 v[148:151], v0 offset:5120
  v_smfmac_f32_16x16x64_bf16 v[36:39], v[20:23], a[24:31], v3
  s_waitcnt lgkmcnt(6)
  v_smfmac_f32_16x16x64_bf16 v[36:39], v[24:27], a[32:39], v3
  v_smfmac_f32_16x16x64_bf16 v[40:43], v[8:11], a[56:63], v3
  s_waitcnt lgkmcnt(2)
  v_smfmac_f32_16x16x64_bf16 v[60:63], v[12:15], v[72:79], v3
  ds_read_b128 v[64:67], v0 offset:6144
  ds_read_b128 v[68:71], v0 offset:7168
  v_smfmac_f32_16x16x64_bf16 v[40:43], v[12:15], a[64:71], v3
  v_permlane32_swap_b32 v36, v38
  v_smfmac_f32_16x16x64_bf16 v[40:43], v[16:19], a[72:79], v3
  v_permlane32_swap_b32 v37, v39
  v_smfmac_f32_16x16x64_bf16 v[40:43], v[20:23], a[80:87], v3
  s_waitcnt lgkmcnt(2)
  v_add_f32 v36, v36, v38
  v_smfmac_f32_16x16x64_bf16 v[60:63], v[16:19], v[144:151], v3
  ds_read_b128 v[72:75], v0 offset:8192
  ds_read_b128 v[76:79], v0 offset:9216
  v_add_f32 v37, v37, v39
  v_smfmac_f32_16x16x64_bf16 v[40:43], v[24:27], a[88:95], v3
  v_cmp_u_f32 vcc, v36, v37
  v_smfmac_f32_16x16x64_bf16 v[44:47], v[8:11], a[112:119], v3
  v_cvt_pk_bf16_f32 v38, v36, v37
  v_smfmac_f32_16x16x64_bf16 v[44:47], v[12:15], a[120:127], v3
  ds_write_b32 v152, v38
  s_waitcnt lgkmcnt(3)
  s_cbranch_vccnz cA_va1_slow
  v_permlane32_swap_b32 v40, v42
  v_smfmac_f32_16x16x64_bf16 v[60:63], v[20:23], v[64:71], v3
  ds_read_b128 v[144:147], v0 offset:10240
  ds_read_b128 v[148:151], v0 offset:11264
  v_permlane32_swap_b32 v41, v43
  v_smfmac_f32_16x16x64_bf16 v[44:47], v[16:19], a[128:135], v3
  buffer_store_dword v162, v1, s[8:11], s21 offen
  v_add_f32 v40, v40, v42
  v_smfmac_f32_16x16x64_bf16 v[44:47], v[20:23], a[136:143], v3
  v_add_f32 v41, v41, v43
  v_smfmac_f32_16x16x64_bf16 v[44:47], v[24:27], a[144:151], v3
  s_waitcnt lgkmcnt(3)
  v_cvt_pk_bf16_f32 v42, v40, v41
  v_smfmac_f32_16x16x64_bf16 v[60:63], v[24:27], v[72:79], v3
  ds_write_b32 v153, v42
  ds_read_b128 v[64:67], v0 offset:12288
  ds_read_b128 v[68:71], v0 offset:13312
  v_smfmac_f32_16x16x64_bf16 v[48:51], v[8:11], a[168:175], v3
  s_nop 0
  v_permlane32_swap_b32 v44, v46
  v_smfmac_f32_16x16x64_bf16 v[48:51], v[12:15], a[176:183], v3
  v_permlane32_swap_b32 v45, v47
  v_smfmac_f32_16x16x64_bf16 v[48:51], v[16:19], a[184:191], v3
  s_waitcnt lgkmcnt(3)
  v_add_f32 v44, v44, v46
  v_smfmac_f32_16x16x64_bf16 v[60:63], v[28:31], v[144:151], v3
  v_add_f32 v45, v45, v47
  v_smfmac_f32_16x16x64_bf16 v[48:51], v[20:23], a[192:199], v3
  v_cvt_pk_bf16_f32 v46, v44, v45
  v_smfmac_f32_16x16x64_bf16 v[48:51], v[24:27], a[200:207], v3
  ds_write_b32 v154, v46
  v_smfmac_f32_16x16x64_bf16 v[52:55], v[8:11], a[224:231], v3
  s_waitcnt lgkmcnt(1)
  v_smfmac_f32_16x16x64_bf16 v[60:63], v[32:35], v[64:71], v3
  v_smfmac_f32_16x16x64_bf16 v[52:55], v[12:15], a[232:239], v3
  v_permlane32_swap_b32 v48, v50
  v_smfmac_f32_16x16x64_bf16 v[52:55], v[16:19], a[240:247], v3
  v_permlane32_swap_b32 v49, v51
  v_smfmac_f32_16x16x64_bf16 v[52:55], v[20:23], a[248:255], v3
  v_add_f32 v48, v48, v50
  v_smfmac_f32_16x16x64_bf16 v[52:55], v[24:27], v[176:183], v3
  v_add_f32 v49, v49, v51
  v_smfmac_f32_16x16x64_bf16 v[56:59], v[8:11], v[200:207], v3
  v_cvt_pk_bf16_f32 v50, v48, v49
  v_smfmac_f32_16x16x64_bf16 v[56:59], v[12:15], v[208:215], v3
  ds_write_b32 v155, v50
  v_permlane32_swap_b32 v60, v62
  v_smfmac_f32_16x16x64_bf16 v[56:59], v[16:19], v[216:223], v3
  v_permlane32_swap_b32 v61, v63
  v_smfmac_f32_16x16x64_bf16 v[56:59], v[20:23], v[224:231], v3
  v_add_f32 v60, v60, v62
  v_smfmac_f32_16x16x64_bf16 v[56:59], v[24:27], v[232:239], v3
  v_add_f32 v61, v61, v63
  v_cvt_pk_bf16_f32 v62, v60, v61
  ds_write_b32 v158, v62
  v_permlane32_swap_b32 v52, v54
  v_permlane32_swap_b32 v53, v55
  v_add_f32 v52, v52, v54
  v_add_f32 v53, v53, v55
  v_cvt_pk_bf16_f32 v54, v52, v53
  ds_write_b32 v156, v54
  v_permlane32_swap_b32 v56, v58
  v_permlane32_swap_b32 v57, v59
  v_add_f32 v56, v56, v58
  v_add_f32 v57, v57, v59
  v_cvt_pk_bf16_f32 v58, v56, v57
  ds_write_b32 v157, v58
cA_va1_t2d:
  s_add_u32 s22, s20, 9216
  s_add_u32 s34, s20, 13312
  s_add_u32 s36, s20, 7168
  s_mov_b32 s37, 0
  v_mov_b32 v48, 0
  v_mov_b32 v49, 0
  v_mov_b32 v50, 0
  v_mov_b32 v51, 0
  v_mov_b32 v163, s18
  s_waitcnt lgkmcnt(0)
  s_barrier
  buffer_load_dwordx4 v[8:11], v2, s[8:11], s22 offen offset:0 sc1
  buffer_load_dwordx4 v[12:15], v2, s[8:11], s22 offen offset:1024 sc1
  buffer_load_dwordx4 v[16:19], v2, s[8:11], s22 offen offset:2048 sc1
  buffer_load_dwordx4 v[20:23], v2, s[8:11], s22 offen offset:3072 sc1
  buffer_load_dwordx4 v[24:27], v2, s[8:11], s34 offen offset:0 sc1
  buffer_load_dwordx4 v[28:31], v2, s[8:11], s34 offen offset:1024 sc1
  buffer_load_dwordx4 v[32:35], v2, s[8:11], s34 offen offset:2048 sc1
  buffer_load_dwordx4 v[36:39], v2, s[8:11], s34 offen offset:3072 sc1
  buffer_load_dwordx4 v[40:43], v2, s[8:11], s36 offen offset:0 sc1
  buffer_load_dwordx4 v[44:47], v2, s[8:11], s36 offen offset:1024 sc1
  ds_read_b128 v[64:67], v2 offset:4096
  ds_read_b128 v[68:71], v2 offset:5120
  ds_read_b128 v[72:75], v2 offset:6144
  ds_read_b128 v[76:79], v2 offset:7168
cA_va1_lp:
  s_waitcnt vmcnt(9)
  v_smfmac_f32_16x16x64_bf16 v[48:51], v[8:11], v[80:87], v3
  s_waitcnt vmcnt(8)
  v_smfmac_f32_16x16x64_bf16 v[48:51], v[12:15], v[88:95], v3
  s_waitcnt vmcnt(7)
  v_smfmac_f32_16x16x64_bf16 v[48:51], v[16:19], v[96:103], v3
  v_max3_u32 v55, v8, v12, v16
  s_waitcnt vmcnt(6)
  v_smfmac_f32_16x16x64_bf16 v[48:51], v[20:23], v[104:111], v3
  v_max_u32 v55, v55, v20
  v_cmp_eq_u32 vcc, -1, v55
  s_waitcnt vmcnt(5)
  v_smfmac_f32_16x16x64_bf16 v[48:51], v[24:27], v[112:119], v3
  s_waitcnt vmcnt(4)
  v_smfmac_f32_16x16x64_bf16 v[48:51], v[28:31], v[120:127], v3
  s_cbranch_vccnz cA_va1_rv
  buffer_store_dword v163, v7, s[8:11], 0 offen
  s_waitcnt vmcnt(4)
  v_smfmac_f32_16x16x64_bf16 v[48:51], v[32:35], v[128:135], v3
  s_waitcnt vmcnt(3)
  v_smfmac_f32_16x16x64_bf16 v[48:51], v[36:39], v[136:143], v3
  s_waitcnt vmcnt(2) lgkmcnt(0)
  v_smfmac_f32_16x16x64_bf16 v[48:51], v[40:43], v[64:71], v3
  s_waitcnt vmcnt(1)
  v_smfmac_f32_16x16x64_bf16 v[48:51], v[44:47], v[72:79], v3
  s_nop 7
  v_permlane32_swap_b32 v48, v50
  v_permlane32_swap_b32 v49, v51
  v_add_f32 v48, v48, v50
  v_add_f32 v49, v49, v51
  v_cvt_pk_bf16_f32 v160, v48, v49
  v_cmp_u_f32 vcc, v48, v49
  s_nop 0
  v_mov_b32_dpp v161, v160 quad_perm:[1,0,3,2] row_mask:0xf bank_mask:0xf
  v_perm_b32 v160, v161, v160, v5
  v_min_u32 v160, -2, v160
  s_cbranch_vccnz cA_va1_rp
cA_va1_cont:
  buffer_store_dword v160, v1, s[8:11], s21 offen
  s_cmp_lg_u32 s19, 62
  s_cbranch_scc1 cA_va1_nl
  buffer_store_dword v160, v1, s[8:11], s38 offen sc1
  s_waitcnt vmcnt(0)
  buffer_wbl2 sc1
  s_branch cA_done
cA_va1_nl:
  s_add_u32 s25, s25, 458752
  v_mov_b32 v36, 0
  v_mov_b32 v37, 0
  v_mov_b32 v38, 0
  v_mov_b32 v39, 0
  v_mov_b32 v40, 0
  v_mov_b32 v41, 0
  v_mov_b32 v42, 0
  v_mov_b32 v43, 0
  v_mov_b32 v44, 0
  v_mov_b32 v45, 0
  v_mov_b32 v46, 0
  v_mov_b32 v47, 0
  v_mov_b32 v48, 0
  v_mov_b32 v49, 0
  v_mov_b32 v50, 0
  v_mov_b32 v51, 0
  v_mov_b32 v52, 0
  v_mov_b32 v53, 0
  v_mov_b32 v54, 0
  v_mov_b32 v55, 0
  v_mov_b32 v56, 0
  v_mov_b32 v57, 0
  v_mov_b32 v58, 0
  v_mov_b32 v59, 0
  v_mov_b32 v60, 0
  v_mov_b32 v61, 0
  v_mov_b32 v62, 0
  v_mov_b32 v63, 0
  s_mov_b32 s19, s18
  s_add_u32 s18, s18, 1
  s_mov_b32 s22, s20
  s_mov_b32 s20, s21
  s_mov_b32 s21, s22
  s_add_u32 s23, s20, 4096
  s_branch cA_va1_loop
cA_va1_slow:
  s_waitcnt lgkmcnt(0)
cA_va1_sl1:
  s_add_u32 s31, s31, 0x1000000
  buffer_load_dwordx4 v[8:11], v2, s[8:11], s20 offen offset:0 sc1
  buffer_load_dwordx4 v[12:15], v2, s[8:11], s20 offen offset:1024 sc1
  buffer_load_dwordx4 v[16:19], v2, s[8:11], s20 offen offset:2048 sc1
  buffer_load_dwordx4 v[20:23], v2, s[8:11], s20 offen offset:3072 sc1
  buffer_load_dwordx4 v[24:27], v2, s[8:11], s23 offen offset:0 sc1
  buffer_load_dwordx4 v[28:31], v2, s[8:11], s23 offen offset:1024 sc1
  buffer_load_dwordx4 v[32:35], v2, s[8:11], s23 offen offset:2048 sc1
  s_waitcnt vmcnt(0)
  v_max3_u32 v36, v8, v9, v10
  v_max3_u32 v36, v36, v11, v12
  v_max3_u32 v36, v36, v13, v14
  v_max3_u32 v36, v36, v15, v16
  v_max3_u32 v36, v36, v17, v18
  v_max3_u32 v36, v36, v19, v20
  v_max3_u32 v36, v36, v21, v22
  v_max3_u32 v36, v36, v23, v24
  v_max3_u32 v36, v36, v25, v26
  v_max3_u32 v36, v36, v27, v28
  v_max3_u32 v36, v36, v29, v30
  v_max3_u32 v36, v36, v31, v32
  v_max3_u32 v36, v36, v33, v34
  v_max_u32 v36, v36, v35
  v_cmp_eq_u32 vcc, -1, v36
  s_cbranch_vccz cA_va1_sl2
  s_add_u32 s30, s30, 1
  s_cmp_lt_u32 s30, 400000
  s_cbranch_scc1 cA_va1_sl1
  s_branch cA_abort
cA_va1_sl2:
  v_mov_b32 v36, 0
  v_mov_b32 v37, 0
  v_mov_b32 v38, 0
  v_mov_b32 v39, 0
  v_mov_b32 v40, 0
  v_mov_b32 v41, 0
  v_mov_b32 v42, 0
  v_mov_b32 v43, 0
  v_mov_b32 v44, 0
  v_mov_b32 v45, 0
  v_mov_b32 v46, 0
  v_mov_b32 v47, 0
  v_mov_b32 v48, 0
  v_mov_b32 v49, 0
  v_mov_b32 v50, 0
  v_mov_b32 v51, 0
  v_mov_b32 v52, 0
  v_mov_b32 v53, 0
  v_mov_b32 v54, 0
  v_mov_b32 v55, 0
  v_mov_b32 v56, 0
  v_mov_b32 v57, 0
  v_mov_b32 v58, 0
  v_mov_b32 v59, 0
  v_mov_b32 v60, 0
  v_mov_b32 v61, 0
  v_mov_b32 v62, 0
  v_mov_b32 v63, 0
  buffer_store_dword v162, v1, s[8:11], s21 offen
  ds_read_b128 v[64:67], v0 offset:0
  ds_read_b128 v[68:71], v0 offset:1024
  v_smfmac_f32_16x16x64_bf16 v[36:39], v[8:11], a[0:7], v3
  v_smfmac_f32_16x16x64_bf16 v[40:43], v[8:11], a[56:63], v3
  v_smfmac_f32_16x16x64_bf16 v[44:47], v[8:11], a[112:119], v3
  v_smfmac_f32_16x16x64_bf16 v[48:51], v[8:11], a[168:175], v3
  v_smfmac_f32_16x16x64_bf16 v[52:55], v[8:11], a[224:231], v3
  v_smfmac_f32_16x16x64_bf16 v[56:59], v[8:11], v[200:207], v3
  s_waitcnt lgkmcnt(0)
  v_smfmac_f32_16x16x64_bf16 v[60:63], v[8:11], v[64:71], v3
  ds_read_b128 v[72:75], v0 offset:2048
  ds_read_b128 v[76:79], v0 offset:3072
  v_smfmac_f32_16x16x64_bf16 v[36:39], v[12:15], a[8:15], v3
  v_smfmac_f32_16x16x64_bf16 v[40:43], v[12:15], a[64:71], v3
  v_smfmac_f32_16x16x64_bf16 v[44:47], v[12:15], a[120:127], v3
  v_smfmac_f32_16x16x64_bf16 v[48:51], v[12:15], a[176:183], v3
  v_smfmac_f32_16x16x64_bf16 v[52:55], v[12:15], a[232:239], v3
  v_smfmac_f32_16x16x64_bf16 v[56:59], v[12:15], v[208:215], v3
  s_waitcnt lgkmcnt(0)
  v_smfmac_f32_16x16x64_bf16 v[60:63], v[12:15], v[72:79], v3
  ds_read_b128 v[144:147], v0 offset:4096
  ds_read_b128 v[148:151], v0 offset:5120
  v_smfmac_f32_16x16x64_bf16 v[36:39], v[16:19], a[16:23], v3
  v_smfmac_f32_16x16x64_bf16 v[40:43], v[16:19], a[72:79], v3
  v_smfmac_f32_16x16x64_bf16 v[44:47], v[16:19], a[128:135], v3
  v_smfmac_f32_16x16x64_bf16 v[48:51], v[16:19], a[184:191], v3
  v_smfmac_f32_16x16x64_bf16 v[52:55], v[16:19], a[240:247], v3
  v_smfmac_f32_16x16x64_bf16 v[56:59], v[16:19], v[216:223], v3
  s_waitcnt lgkmcnt(0)
  v_smfmac_f32_16x16x64_bf16 v[60:63], v[16:19], v[144:151], v3
  ds_read_b128 v[64:67], v0 offset:6144
  ds_read_b128 v[68:71], v0 offset:7168
  v_smfmac_f32_16x16x64_bf16 v[36:39], v[20:23], a[24:31], v3
  v_smfmac_f32_16x16x64_bf16 v[40:43], v[20:23], a[80:87], v3
  v_smfmac_f32_16x16x64_bf16 v[44:47], v[20:23], a[136:143], v3
  v_smfmac_f32_16x16x64_bf16 v[48:51], v[20:23], a[192:199], v3
  v_smfmac_f32_16x16x64_bf16 v[52:55], v[20:23], a[248:255], v3
  v_smfmac_f32_16x16x64_bf16 v[56:59], v[20:23], v[224:231], v3
  s_waitcnt lgkmcnt(0)
  v_smfmac_f32_16x16x64_bf16 v[60:63], v[20:23], v[64:71], v3
  ds_read_b128 v[72:75], v0 offset:8192
  ds_read_b128 v[76:79], v0 offset:9216
  v_smfmac_f32_16x16x64_bf16 v[36:39], v[24:27], a[32:39], v3
  v_smfmac_f32_16x16x64_bf16 v[40:43], v[24:27], a[88:95], v3
  v_smfmac_f32_16x16x64_bf16 v[44:47], v[24:27], a[144:151], v3
  v_smfmac_f32_16x16x64_bf16 v[48:51], v[24:27], a[200:207], v3
  v_smfmac_f32_16x16x64_bf16 v[52:55], v[24:27], v[176:183], v3
  v_smfmac_f32_16x16x64_bf16 v[56:59], v[24:27], v[232:239], v3
  s_waitcnt lgkmcnt(0)
  v_smfmac_f32_16x16x64_bf16 v[60:63], v[24:27], v[72:79], v3
  ds_read_b128 v[144:147], v0 offset:10240
  ds_read_b128 v[148:151], v0 offset:11264
  v_smfmac_f32_16x16x64_bf16 v[36:39], v[28:31], a[40:47], v3
  v_smfmac_f32_16x16x64_bf16 v[40:43], v[28:31], a[96:103], v3
  v_smfmac_f32_16x16x64_bf16 v[44:47], v[28:31], a[152:159], v3
  v_smfmac_f32_16x16x64_bf16 v[48:51], v[28:31], a[208:215], v3
  v_smfmac_f32_16x16x64_bf16 v[52:55], v[28:31], v[184:191], v3
  v_smfmac_f32_16x16x64_bf16 v[56:59], v[28:31], v[240:247], v3
  s_waitcnt lgkmcnt(0)
  v_smfmac_f32_16x16x64_bf16 v[60:63], v[28:31], v[144:151], v3
  ds_read_b128 v[64:67], v0 offset:12288
  ds_read_b128 v[68:71], v0 offset:13312
  v_smfmac_f32_16x16x64_bf16 v[36:39], v[32:35], a[48:55], v3
  v_smfmac_f32_16x16x64_bf16 v[40:43], v[32:35], a[104:111], v3
  v_smfmac_f32_16x16x64_bf16 v[44:47], v[32:35], a[160:167], v3
  v_smfmac_f32_16x16x64_bf16 v[48:51], v[32:35], a[216:223], v3
  v_smfmac_f32_16x16x64_bf16 v[52:55], v[32:35], v[192:199], v3
  v_smfmac_f32_16x16x64_bf16 v[56:59], v[32:35], v[248:255], v3
  s_waitcnt lgkmcnt(0)
  v_smfmac_f32_16x16x64_bf16 v[60:63], v[32:35], v[64:71], v3
  v_permlane32_swap_b32 v36, v38
  v_permlane32_swap_b32 v37, v39
  v_add_f32 v36, v36, v38
  v_add_f32 v37, v37, v39
  v_cvt_pk_bf16_f32 v38, v36, v37
  ds_write_b32 v152, v38
  v_permlane32_swap_b32 v40, v42
  v_permlane32_swap_b32 v41, v43
  v_add_f32 v40, v40, v42
  v_add_f32 v41, v41, v43
  v_cvt_pk_bf16_f32 v42, v40, v41
  ds_write_b32 v153, v42
  v_permlane32_swap_b32 v44, v46
  v_permlane32_swap_b32 v45, v47
  v_add_f32 v44, v44, v46
  v_add_f32 v45, v45, v47
  v_cvt_pk_bf16_f32 v46, v44, v45
  ds_write_b32 v154, v46
  v_permlane32_swap_b32 v48, v50
  v_permlane32_swap_b32 v49, v51
  v_add_f32 v48, v48, v50
  v_add_f32 v49, v49, v51
  v_cvt_pk_bf16_f32 v50, v48, v49
  ds_write_b32 v155, v50
  v_permlane32_swap_b32 v52, v54
  v_permlane32_swap_b32 v53, v55
  v_add_f32 v52, v52, v54
  v_add_f32 v53, v53, v55
  v_cvt_pk_bf16_f32 v54, v52, v53
  ds_write_b32 v156, v54
  v_permlane32_swap_b32 v56, v58
  v_permlane32_swap_b32 v57, v59
  v_add_f32 v56, v56, v58
  v_add_f32 v57, v57, v59
  v_cvt_pk_bf16_f32 v58, v56, v57
  ds_write_b32 v157, v58
  v_permlane32_swap_b32 v60, v62
  v_permlane32_swap_b32 v61, v63
  v_add_f32 v60, v60, v62
  v_add_f32 v61, v61, v63
  v_cvt_pk_bf16_f32 v62, v60, v61
  ds_write_b32 v158, v62
  s_branch cA_va1_t2d
cA_va1_rp:
  s_cmp_lg_u32 s37, 0
  s_cbranch_scc1 cA_va1_cont
cA_va1_rv:
  s_add_u32 s31, s31, 0x10000
  buffer_load_dwordx4 v[8:11], v2, s[8:11], s22 offen offset:0 sc1
  buffer_load_dwordx4 v[12:15], v2, s[8:11], s22 offen offset:1024 sc1
  buffer_load_dwordx4 v[16:19], v2, s[8:11], s22 offen offset:2048 sc1
  buffer_load_dwordx4 v[20:23], v2, s[8:11], s22 offen offset:3072 sc1
  buffer_load_dwordx4 v[24:27], v2, s[8:11], s34 offen offset:0 sc1
  buffer_load_dwordx4 v[28:31], v2, s[8:11], s34 offen offset:1024 sc1
  buffer_load_dwordx4 v[32:35], v2, s[8:11], s34 offen offset:2048 sc1
  buffer_load_dwordx4 v[36:39], v2, s[8:11], s34 offen offset:3072 sc1
  buffer_load_dwordx4 v[40:43], v2, s[8:11], s36 offen offset:0 sc1
  buffer_load_dwordx4 v[44:47], v2, s[8:11], s36 offen offset:1024 sc1
  s_waitcnt vmcnt(0)
  v_max3_u32 v52, v8, v9, v10
  v_max3_u32 v52, v52, v11, v12
  v_max3_u32 v52, v52, v13, v14
  v_max3_u32 v52, v52, v15, v16
  v_max3_u32 v52, v52, v17, v18
  v_max3_u32 v52, v52, v19, v20
  v_max3_u32 v52, v52, v21, v22
  v_max3_u32 v52, v52, v23, v24
  v_max3_u32 v52, v52, v25, v26
  v_max3_u32 v52, v52, v27, v28
  v_max3_u32 v52, v52, v29, v30
  v_max3_u32 v52, v52, v31, v32
  v_max3_u32 v52, v52, v33, v34
  v_max3_u32 v52, v52, v35, v36
  v_max3_u32 v52, v52, v37, v38
  v_max3_u32 v52, v52, v39, v40
  v_max3_u32 v52, v52, v41, v42
  v_max3_u32 v52, v52, v43, v44
  v_max3_u32 v52, v52, v45, v46
  v_max_u32 v52, v52, v47
  v_cmp_eq_u32 vcc, -1, v52
  s_mov_b32 s37, 1
  v_mov_b32 v48, 0
  v_mov_b32 v49, 0
  v_mov_b32 v50, 0
  v_mov_b32 v51, 0
  s_nop 1
  s_cbranch_vccz cA_va1_lp
  s_add_u32 s30, s30, 1
  s_cmp_lt_u32 s30, 400000
  s_cbranch_scc1 cA_va1_rv
  s_branch cA_abort
.p2align 6
cA_va2_loop:
  s_mov_b32 s30, 0
cA_va2_fp_l:
  v_cmp_gt_u32 vcc, s19, v88
  buffer_load_dword v88, v119, s[8:11], 0 offen sc1
  s_cbranch_vccz cA_va2_fp_d
  v_cmp_gt_u32 vcc, s19, v88
  buffer_load_dword v88, v119, s[8:11], 0 offen sc1
  s_cbranch_vccz cA_va2_fp_d
  v_cmp_gt_u32 vcc, s19, v88
  buffer_load_dword v88, v119, s[8:11], 0 offen sc1
  s_cbranch_vccz cA_va2_fp_d
  v_cmp_gt_u32 vcc, s19, v88
  buffer_load_dword v88, v119, s[8:11], 0 offen sc1
  s_cbranch_vccz cA_va2_fp_d
  v_cmp_gt_u32 vcc, s19, v88
  buffer_load_dword v88, v119, s[8:11], 0 offen sc1
  s_cbranch_vccz cA_va2_fp_d
  v_cmp_gt_u32 vcc, s19, v88
  buffer_load_dword v88, v119, s[8:11], 0 offen sc1
  s_cbranch_vccz cA_va2_fp_d
  v_cmp_gt_u32 vcc, s19, v88
  buffer_load_dword v88, v119, s[8:11], 0 offen sc1
  s_cbranch_vccz cA_va2_fp_d
  v_cmp_gt_u32 vcc, s19, v88
  buffer_load_dword v88, v119, s[8:11], 0 offen sc1
  s_cbranch_vccz cA_va2_fp_d
  v_cmp_gt_u32 vcc, s19, v88
  buffer_load_dword v88, v119, s[8:11], 0 offen sc1
  s_cbranch_vccz cA_va2_fp_d
  v_cmp_gt_u32 vcc, s19, v88
  buffer_load_dword v88, v119, s[8:11], 0 offen sc1
  s_cbranch_vccz cA_va2_fp_d
  v_cmp_gt_u32 vcc, s19, v88
  buffer_load_dword v88, v119, s[8:11], 0 offen sc1
  s_cbranch_vccz cA_va2_fp_d
  v_cmp_gt_u32 vcc, s19, v88
  buffer_load_dword v88, v119, s[8:11], 0 offen sc1
  s_cbranch_vccz cA_va2_fp_d
  v_cmp_gt_u32 vcc, s19, v88
  buffer_load_dword v88, v119, s[8:11], 0 offen sc1
  s_cbranch_vccz cA_va2_fp_d
  v_cmp_gt_u32 vcc, s19, v88
  buffer_load_dword v88, v119, s[8:11], 0 offen sc1
  s_cbranch_vccz cA_va2_fp_d
  v_cmp_gt_u32 vcc, s19, v88
  buffer_load_dword v88, v119, s[8:11], 0 offen sc1
  s_cbranch_vccz cA_va2_fp_d
  v_cmp_gt_u32 vcc, s19, v88
  buffer_load_dword v88, v119, s[8:11], 0 offen sc1
  s_cbranch_vccz cA_va2_fp_d
  s_waitcnt vmcnt(24)
  s_add_u32 s30, s30, 1
  s_cmp_lt_u32 s30, 400000
  s_cbranch_scc1 cA_va2_fp_l
  s_branch cA_abort
cA_va2_fp_d:
  buffer_load_dwordx4 v[8:11], v2, s[8:11], s20 offen offset:0 sc1
  buffer_load_dwordx4 v[12:15], v2, s[8:11], s20 offen offset:1024 sc1
  s_barrier
  s_barrier
  s_waitcnt vmcnt(0)
  ds_write_b128 v2, v[8:11] offset:8192
  ds_write_b128 v2, v[12:15] offset:9216
  v_smfmac_f32_16x16x64_bf16 v[36:39], v[8:11], a[0:7], v3
  v_smfmac_f32_16x16x64_bf16 v[40:43], v[8:11], a[56:63], v3
  v_smfmac_f32_16x16x64_bf16 v[44:47], v[8:11], a[112:119], v3
  v_smfmac_f32_16x16x64_bf16 v[48:51], v[8:11], a[168:175], v3
  v_smfmac_f32_16x16x64_bf16 v[52:55], v[8:11], a[224:231], v3
  s_waitcnt lgkmcnt(0)
  s_barrier
  ds_read_b128 v[16:19], v2 offset:10240
  ds_read_b128 v[20:23], v2 offset:11264
  ds_read_b128 v[24:27], v2 offset:12288
  ds_read_b128 v[28:31], v2 offset:13312
  ds_read_b128 v[32:35], v2 offset:14336
  v_smfmac_f32_16x16x64_bf16 v[56:59], v[8:11], v[144:151], v3
  v_smfmac_f32_16x16x64_bf16 v[60:63], v[8:11], v[200:207], v3
  v_smfmac_f32_16x16x64_bf16 v[36:39], v[12:15], a[8:15], v3
  v_smfmac_f32_16x16x64_bf16 v[40:43], v[12:15], a[64:71], v3
  v_smfmac_f32_16x16x64_bf16 v[44:47], v[12:15], a[120:127], v3
  v_smfmac_f32_16x16x64_bf16 v[48:51], v[12:15], a[176:183], v3
  v_smfmac_f32_16x16x64_bf16 v[52:55], v[12:15], a[232:239], v3
  v_smfmac_f32_16x16x64_bf16 v[56:59], v[12:15], v[152:159], v3
  v_smfmac_f32_16x16x64_bf16 v[60:63], v[12:15], v[208:215], v3
  s_waitcnt lgkmcnt(4)
  v_smfmac_f32_16x16x64_bf16 v[36:39], v[16:19], a[16:23], v3
  s_waitcnt lgkmcnt(3)
  v_smfmac_f32_16x16x64_bf16 v[36:39], v[20:23], a[24:31], v3
  s_waitcnt lgkmcnt(2)
  v_smfmac_f32_16x16x64_bf16 v[36:39], v[24:27], a[32:39], v3
  s_waitcnt lgkmcnt(1)
  v_smfmac_f32_16x16x64_bf16 v[36:39], v[28:31], a[40:47], v3
  s_waitcnt lgkmcnt(0)
  v_smfmac_f32_16x16x64_bf16 v[36:39], v[32:35], a[48:55], v3
  v_smfmac_f32_16x16x64_bf16 v[40:43], v[16:19], a[72:79], v3
  v_smfmac_f32_16x16x64_bf16 v[40:43], v[20:23], a[80:87], v3
  v_smfmac_f32_16x16x64_bf16 v[40:43], v[24:27], a[88:95], v3
  v_permlane32_swap_b32 v36, v38
  v_smfmac_f32_16x16x64_bf16 v[40:43], v[28:31], a[96:103], v3
  v_permlane32_swap_b32 v37, v39
  v_smfmac_f32_16x16x64_bf16 v[40:43], v[32:35], a[104:111], v3
  v_add_f32 v36, v36, v38
  v_smfmac_f32_16x16x64_bf16 v[44:47], v[16:19], a[128:135], v3
  v_add_f32 v37, v37, v39
  v_smfmac_f32_16x16x64_bf16 v[44:47], v[20:23], a[136:143], v3
  v_cmp_u_f32 vcc, v36, v37
  v_smfmac_f32_16x16x64_bf16 v[44:47], v[24:27], a[144:151], v3
  v_cvt_pk_bf16_f32 v38, v36, v37
  v_smfmac_f32_16x16x64_bf16 v[44:47], v[28:31], a[152:159], v3
  ds_write_b32 v104, v38
  s_cbranch_vccnz cA_va2_slow
  v_permlane32_swap_b32 v40, v42
  v_smfmac_f32_16x16x64_bf16 v[44:47], v[32:35], a[160:167], v3
  v_permlane32_swap_b32 v41, v43
  v_smfmac_f32_16x16x64_bf16 v[48:51], v[16:19], a[184:191], v3
  v_add_f32 v40, v40, v42
  v_smfmac_f32_16x16x64_bf16 v[48:51], v[20:23], a[192:199], v3
  v_add_f32 v41, v41, v43
  v_smfmac_f32_16x16x64_bf16 v[48:51], v[24:27], a[200:207], v3
  v_cvt_pk_bf16_f32 v42, v40, v41
  v_smfmac_f32_16x16x64_bf16 v[48:51], v[28:31], a[208:215], v3
  ds_write_b32 v105, v42
  v_permlane32_swap_b32 v44, v46
  v_smfmac_f32_16x16x64_bf16 v[48:51], v[32:35], a[216:223], v3
  v_permlane32_swap_b32 v45, v47
  v_smfmac_f32_16x16x64_bf16 v[52:55], v[16:19], a[240:247], v3
  v_add_f32 v44, v44, v46
  v_smfmac_f32_16x16x64_bf16 v[52:55], v[20:23], a[248:255], v3
  v_add_f32 v45, v45, v47
  v_smfmac_f32_16x16x64_bf16 v[52:55], v[24:27], v[120:127], v3
  v_cvt_pk_bf16_f32 v46, v44, v45
  v_smfmac_f32_16x16x64_bf16 v[52:55], v[28:31], v[128:135], v3
  ds_write_b32 v106, v46
  v_permlane32_swap_b32 v48, v50
  v_smfmac_f32_16x16x64_bf16 v[52:55], v[32:35], v[136:143], v3
  v_permlane32_swap_b32 v49, v51
  v_smfmac_f32_16x16x64_bf16 v[56:59], v[16:19], v[160:167], v3
  v_add_f32 v48, v48, v50
  v_smfmac_f32_16x16x64_bf16 v[56:59], v[20:23], v[168:175], v3
  v_add_f32 v49, v49, v51
  v_smfmac_f32_16x16x64_bf16 v[56:59], v[24:27], v[176:183], v3
  v_cvt_pk_bf16_f32 v50, v48, v49
  v_smfmac_f32_16x16x64_bf16 v[56:59], v[28:31], v[184:191], v3
  ds_write_b32 v107, v50
  v_permlane32_swap_b32 v52, v54
  v_smfmac_f32_16x16x64_bf16 v[56:59], v[32:35], v[192:199], v3
  v_permlane32_swap_b32 v53, v55
  v_smfmac_f32_16x16x64_bf16 v[60:63], v[16:19], v[216:223], v3
  v_add_f32 v52, v52, v54
  v_smfmac_f32_16x16x64_bf16 v[60:63], v[20:23], v[224:231], v3
  v_add_f32 v53, v53, v55
  v_smfmac_f32_16x16x64_bf16 v[60:63], v[24:27], v[232:239], v3
  v_cvt_pk_bf16_f32 v54, v52, v53
  v_smfmac_f32_16x16x64_bf16 v[60:63], v[28:31], v[240:247], v3
  ds_write_b32 v108, v54
  v_permlane32_swap_b32 v56, v58
  v_smfmac_f32_16x16x64_bf16 v[60:63], v[32:35], v[248:255], v3
  v_permlane32_swap_b32 v57, v59
  v_add_f32 v56, v56, v58
  v_add_f32 v57, v57, v59
  v_cvt_pk_bf16_f32 v58, v56, v57
  ds_write_b32 v109, v58
  s_nop 2
  v_permlane32_swap_b32 v60, v62
  v_permlane32_swap_b32 v61, v63
  v_add_f32 v60, v60, v62
  v_add_f32 v61, v61, v63
  v_cvt_pk_bf16_f32 v62, v60, v61
  ds_write_b32 v110, v62
cA_va2_t2d:
  v_mov_b32 v117, s18
  s_waitcnt lgkmcnt(0)
  s_barrier
  s_cmp_eq_u32 s19, 62
  s_cbranch_scc1 cA_done
  s_sleep 1
  v_mov_b32 v36, 0
  v_mov_b32 v37, 0
  v_mov_b32 v38, 0
  v_mov_b32 v39, 0
  v_mov_b32 v40, 0
  v_mov_b32 v41, 0
  v_mov_b32 v42, 0
  v_mov_b32 v43, 0
  v_mov_b32 v44, 0
  v_mov_b32 v45, 0
  v_mov_b32 v46, 0
  v_mov_b32 v47, 0
  v_mov_b32 v48, 0
  v_mov_b32 v49, 0
  v_mov_b32 v50, 0
  v_mov_b32 v51, 0
  v_mov_b32 v52, 0
  v_mov_b32 v53, 0
  v_mov_b32 v54, 0
  v_mov_b32 v55, 0
  v_mov_b32 v56, 0
  v_mov_b32 v57, 0
  v_mov_b32 v58, 0
  v_mov_b32 v59, 0
  v_mov_b32 v60, 0
  v_mov_b32 v61, 0
  v_mov_b32 v62, 0
  v_mov_b32 v63, 0
  s_sleep 5
  s_mov_b32 s19, s18
  s_add_u32 s18, s18, 1
  s_mov_b32 s22, s20
  s_mov_b32 s20, s21
  s_mov_b32 s21, s22
  s_add_u32 s23, s20, 4096
  s_branch cA_va2_loop
cA_va2_slow:
  s_waitcnt lgkmcnt(0)
cA_va2_sl1:
  s_add_u32 s31, s31, 0x1000000
  buffer_load_dwordx4 v[8:11], v2, s[8:11], s20 offen offset:0 sc1
  buffer_load_dwordx4 v[12:15], v2, s[8:11], s20 offen offset:1024 sc1
  buffer_load_dwordx4 v[16:19], v2, s[8:11], s20 offen offset:2048 sc1
  buffer_load_dwordx4 v[20:23], v2, s[8:11], s20 offen offset:3072 sc1
  buffer_load_dwordx4 v[24:27], v2, s[8:11], s23 offen offset:0 sc1
  buffer_load_dwordx4 v[28:31], v2, s[8:11], s23 offen offset:1024 sc1
  buffer_load_dwordx4 v[32:35], v2, s[8:11], s23 offen offset:2048 sc1
  s_waitcnt vmcnt(0)
  v_max3_u32 v36, v8, v9, v10
  v_max3_u32 v36, v36, v11, v12
  v_max3_u32 v36, v36, v13, v14
  v_max3_u32 v36, v36, v15, v16
  v_max3_u32 v36, v36, v17, v18
  v_max3_u32 v36, v36, v19, v20
  v_max3_u32 v36, v36, v21, v22
  v_max3_u32 v36, v36, v23, v24
  v_max3_u32 v36, v36, v25, v26
  v_max3_u32 v36, v36, v27, v28
  v_max3_u32 v36, v36, v29, v30
  v_max3_u32 v36, v36, v31, v32
  v_max3_u32 v36, v36, v33, v34
  v_max_u32 v36, v36, v35
  v_cmp_eq_u32 vcc, -1, v36
  s_cbranch_vccz cA_va2_sl2
  s_add_u32 s30, s30, 1
  s_cmp_lt_u32 s30, 400000
  s_cbranch_scc1 cA_va2_sl1
  s_branch cA_abort
cA_va2_sl2:
  v_mov_b32 v36, 0
  v_mov_b32 v37, 0
  v_mov_b32 v38, 0
  v_mov_b32 v39, 0
  v_mov_b32 v40, 0
  v_mov_b32 v41, 0
  v_mov_b32 v42, 0
  v_mov_b32 v43, 0
  v_mov_b32 v44, 0
  v_mov_b32 v45, 0
  v_mov_b32 v46, 0
  v_mov_b32 v47, 0
  v_mov_b32 v48, 0
  v_mov_b32 v49, 0
  v_mov_b32 v50, 0
  v_mov_b32 v51, 0
  v_mov_b32 v52, 0
  v_mov_b32 v53, 0
  v_mov_b32 v54, 0
  v_mov_b32 v55, 0
  v_mov_b32 v56, 0
  v_mov_b32 v57, 0
  v_mov_b32 v58, 0
  v_mov_b32 v59, 0
  v_mov_b32 v60, 0
  v_mov_b32 v61, 0
  v_mov_b32 v62, 0
  v_mov_b32 v63, 0
  v_smfmac_f32_16x16x64_bf16 v[36:39], v[8:11], a[0:7], v3
  v_smfmac_f32_16x16x64_bf16 v[40:43], v[8:11], a[56:63], v3
  v_smfmac_f32_16x16x64_bf16 v[44:47], v[8:11], a[112:119], v3
  v_smfmac_f32_16x16x64_bf16 v[48:51], v[8:11], a[168:175], v3
  v_smfmac_f32_16x16x64_bf16 v[52:55], v[8:11], a[224:231], v3
  v_smfmac_f32_16x16x64_bf16 v[56:59], v[8:11], v[144:151], v3
  v_smfmac_f32_16x16x64_bf16 v[60:63], v[8:11], v[200:207], v3
  v_smfmac_f32_16x16x64_bf16 v[36:39], v[12:15], a[8:15], v3
  v_smfmac_f32_16x16x64_bf16 v[40:43], v[12:15], a[64:71], v3
  v_smfmac_f32_16x16x64_bf16 v[44:47], v[12:15], a[120:127], v3
  v_smfmac_f32_16x16x64_bf16 v[48:51], v[12:15], a[176:183], v3
  v_smfmac_f32_16x16x64_bf16 v[52:55], v[12:15], a[232:239], v3
  v_smfmac_f32_16x16x64_bf16 v[56:59], v[12:15], v[152:159], v3
  v_smfmac_f32_16x16x64_bf16 v[60:63], v[12:15], v[208:215], v3
  v_smfmac_f32_16x16x64_bf16 v[36:39], v[16:19], a[16:23], v3
  v_smfmac_f32_16x16x64_bf16 v[40:43], v[16:19], a[72:79], v3
  v_smfmac_f32_16x16x64_bf16 v[44:47], v[16:19], a[128:135], v3
  v_smfmac_f32_16x16x64_bf16 v[48:51], v[16:19], a[184:191], v3
  v_smfmac_f32_16x16x64_bf16 v[52:55], v[16:19], a[240:247], v3
  v_smfmac_f32_16x16x64_bf16 v[56:59], v[16:19], v[160:167], v3
  v_smfmac_f32_16x16x64_bf16 v[60:63], v[16:19], v[216:223], v3
  v_smfmac_f32_16x16x64_bf16 v[36:39], v[20:23], a[24:31], v3
  v_smfmac_f32_16x16x64_bf16 v[40:43], v[20:23], a[80:87], v3
  v_smfmac_f32_16x16x64_bf16 v[44:47], v[20:23], a[136:143], v3
  v_smfmac_f32_16x16x64_bf16 v[48:51], v[20:23], a[192:199], v3
  v_smfmac_f32_16x16x64_bf16 v[52:55], v[20:23], a[248:255], v3
  v_smfmac_f32_16x16x64_bf16 v[56:59], v[20:23], v[168:175], v3
  v_smfmac_f32_16x16x64_bf16 v[60:63], v[20:23], v[224:231], v3
  v_smfmac_f32_16x16x64_bf16 v[36:39], v[24:27], a[32:39], v3
  v_smfmac_f32_16x16x64_bf16 v[40:43], v[24:27], a[88:95], v3
  v_smfmac_f32_16x16x64_bf16 v[44:47], v[24:27], a[144:151], v3
  v_smfmac_f32_16x16x64_bf16 v[48:51], v[24:27], a[200:207], v3
  v_smfmac_f32_16x16x64_bf16 v[52:55], v[24:27], v[120:127], v3
  v_smfmac_f32_16x16x64_bf16 v[56:59], v[24:27], v[176:183], v3
  v_smfmac_f32_16x16x64_bf16 v[60:63], v[24:27], v[232:239], v3
  v_smfmac_f32_16x16x64_bf16 v[36:39], v[28:31], a[40:47], v3
  v_smfmac_f32_16x16x64_bf16 v[40:43], v[28:31], a[96:103], v3
  v_smfmac_f32_16x16x64_bf16 v[44:47], v[28:31], a[152:159], v3
  v_smfmac_f32_16x16x64_bf16 v[48:51], v[28:31], a[208:215], v3
  v_smfmac_f32_16x16x64_bf16 v[52:55], v[28:31], v[128:135], v3
  v_smfmac_f32_16x16x64_bf16 v[56:59], v[28:31], v[184:191], v3
  v_smfmac_f32_16x16x64_bf16 v[60:63], v[28:31], v[240:247], v3
  v_smfmac_f32_16x16x64_bf16 v[36:39], v[32:35], a[48:55], v3
  v_smfmac_f32_16x16x64_bf16 v[40:43], v[32:35], a[104:111], v3
  v_smfmac_f32_16x16x64_bf16 v[44:47], v[32:35], a[160:167], v3
  v_smfmac_f32_16x16x64_bf16 v[48:51], v[32:35], a[216:223], v3
  v_smfmac_f32_16x16x64_bf16 v[52:55], v[32:35], v[136:143], v3
  v_smfmac_f32_16x16x64_bf16 v[56:59], v[32:35], v[192:199], v3
  v_smfmac_f32_16x16x64_bf16 v[60:63], v[32:35], v[248:255], v3
  v_permlane32_swap_b32 v36, v38
  v_permlane32_swap_b32 v37, v39
  v_add_f32 v36, v36, v38
  v_add_f32 v37, v37, v39
  v_cvt_pk_bf16_f32 v38, v36, v37
  ds_write_b32 v104, v38
  v_permlane32_swap_b32 v40, v42
  v_permlane32_swap_b32 v41, v43
  v_add_f32 v40, v40, v42
  v_add_f32 v41, v41, v43
  v_cvt_pk_bf16_f32 v42, v40, v41
  ds_write_b32 v105, v42
  v_permlane32_swap_b32 v44, v46
  v_permlane32_swap_b32 v45, v47
  v_add_f32 v44, v44, v46
  v_add_f32 v45, v45, v47
  v_cvt_pk_bf16_f32 v46, v44, v45
  ds_write_b32 v106, v46
  v_permlane32_swap_b32 v48, v50
  v_permlane32_swap_b32 v49, v51
  v_add_f32 v48, v48, v50
  v_add_f32 v49, v49, v51
  v_cvt_pk_bf16_f32 v50, v48, v49
  ds_write_b32 v107, v50
  v_permlane32_swap_b32 v52, v54
  v_permlane32_swap_b32 v53, v55
  v_add_f32 v52, v52, v54
  v_add_f32 v53, v53, v55
  v_cvt_pk_bf16_f32 v54, v52, v53
  ds_write_b32 v108, v54
  v_permlane32_swap_b32 v56, v58
  v_permlane32_swap_b32 v57, v59
  v_add_f32 v56, v56, v58
  v_add_f32 v57, v57, v59
  v_cvt_pk_bf16_f32 v58, v56, v57
  ds_write_b32 v109, v58
  v_permlane32_swap_b32 v60, v62
  v_permlane32_swap_b32 v61, v63
  v_add_f32 v60, v60, v62
  v_add_f32 v61, v61, v63
  v_cvt_pk_bf16_f32 v62, v60, v61
  ds_write_b32 v110, v62
  s_branch cA_va2_t2d
.p2align 6
cA_va3_loop:
  s_mov_b32 s30, 0
  s_barrier
  buffer_load_dwordx4 v[16:19], v2, s[8:11], s20 offen offset:2048 sc1
  buffer_load_dwordx4 v[20:23], v2, s[8:11], s20 offen offset:3072 sc1
  s_barrier
  buffer_load_dword v100, v116, s[8:11], s39 offen sc1
  s_add_u32 s27, s19, 2
  s_min_u32 s27, s27, 63
  s_lshr_b32 s27, s27, 3
  s_lshl_b32 s27, s27, 11
  s_add_u32 s27, s27, s35
  s_cmp_eq_u32 s27, s28
  s_cselect_b32 s29, 75729408, s27
  buffer_load_dword v101, off, s[8:11], s29 sc1
  s_add_u32 s39, s39, 28672
  s_waitcnt vmcnt(2)
  ds_write_b128 v2, v[16:19] offset:10240
  ds_write_b128 v2, v[20:23] offset:11264
  v_smfmac_f32_16x16x64_bf16 v[36:39], v[16:19], a[16:23], v3
  v_smfmac_f32_16x16x64_bf16 v[40:43], v[16:19], a[72:79], v3
  v_smfmac_f32_16x16x64_bf16 v[44:47], v[16:19], a[128:135], v3
  v_smfmac_f32_16x16x64_bf16 v[48:51], v[16:19], a[184:191], v3
  v_smfmac_f32_16x16x64_bf16 v[52:55], v[16:19], a[240:247], v3
  s_waitcnt lgkmcnt(0)
  s_barrier
  ds_read_b128 v[8:11], v2 offset:8192
  ds_read_b128 v[12:15], v2 offset:9216
  ds_read_b128 v[24:27], v2 offset:12288
  ds_read_b128 v[28:31], v2 offset:13312
  ds_read_b128 v[32:35], v2 offset:14336
  v_smfmac_f32_16x16x64_bf16 v[56:59], v[16:19], v[160:167], v3
  v_smfmac_f32_16x16x64_bf16 v[60:63], v[16:19], v[216:223], v3
  v_smfmac_f32_16x16x64_bf16 v[36:39], v[20:23], a[24:31], v3
  v_smfmac_f32_16x16x64_bf16 v[40:43], v[20:23], a[80:87], v3
  v_smfmac_f32_16x16x64_bf16 v[44:47], v[20:23], a[136:143], v3
  v_smfmac_f32_16x16x64_bf16 v[48:51], v[20:23], a[192:199], v3
  v_smfmac_f32_16x16x64_bf16 v[52:55], v[20:23], a[248:255], v3
  v_smfmac_f32_16x16x64_bf16 v[56:59], v[20:23], v[168:175], v3
  v_smfmac_f32_16x16x64_bf16 v[60:63], v[20:23], v[224:231], v3
  s_waitcnt lgkmcnt(4)
  v_smfmac_f32_16x16x64_bf16 v[36:39], v[8:11], a[0:7], v3
  s_waitcnt lgkmcnt(3)
  v_smfmac_f32_16x16x64_bf16 v[36:39], v[12:15], a[8:15], v3
  s_waitcnt lgkmcnt(2)
  v_smfmac_f32_16x16x64_bf16 v[36:39], v[24:27], a[32:39], v3
  s_waitcnt lgkmcnt(1)
  v_smfmac_f32_16x16x64_bf16 v[36:39], v[28:31], a[40:47], v3
  s_waitcnt lgkmcnt(0)
  v_smfmac_f32_16x16x64_bf16 v[36:39], v[32:35], a[48:55], v3
  v_smfmac_f32_16x16x64_bf16 v[40:43], v[8:11], a[56:63], v3
  v_smfmac_f32_16x16x64_bf16 v[40:43], v[12:15], a[64:71], v3
  v_smfmac_f32_16x16x64_bf16 v[40:43], v[24:27], a[88:95], v3
  v_permlane32_swap_b32 v36, v38
  v_smfmac_f32_16x16x64_bf16 v[40:43], v[28:31], a[96:103], v3
  v_permlane32_swap_b32 v37, v39
  v_smfmac_f32_16x16x64_bf16 v[40:43], v[32:35], a[104:111], v3
  v_add_f32 v36, v36, v38
  v_smfmac_f32_16x16x64_bf16 v[44:47], v[8:11], a[112:119], v3
  v_add_f32 v37, v37, v39
  v_smfmac_f32_16x16x64_bf16 v[44:47], v[12:15], a[120:127], v3
  v_cmp_u_f32 vcc, v36, v37
  v_smfmac_f32_16x16x64_bf16 v[44:47], v[24:27], a[144:151], v3
  v_cvt_pk_bf16_f32 v38, v36, v37
  v_smfmac_f32_16x16x64_bf16 v[44:47], v[28:31], a[152:159], v3
  ds_write_b32 v104, v38
  s_cbranch_vccnz cA_va3_slow
  v_permlane32_swap_b32 v40, v42
  v_smfmac_f32_16x16x64_bf16 v[44:47], v[32:35], a[160:167], v3
  v_permlane32_swap_b32 v41, v43
  v_smfmac_f32_16x16x64_bf16 v[48:51], v[8:11], a[168:175], v3
  v_add_f32 v40, v40, v42
  v_smfmac_f32_16x16x64_bf16 v[48:51], v[12:15], a[176:183], v3
  v_add_f32 v41, v41, v43
  v_smfmac_f32_16x16x64_bf16 v[48:51], v[24:27], a[200:207], v3
  v_cvt_pk_bf16_f32 v42, v40, v41
  v_smfmac_f32_16x16x64_bf16 v[48:51], v[28:31], a[208:215], v3
  ds_write_b32 v105, v42
  v_permlane32_swap_b32 v44, v46
  v_smfmac_f32_16x16x64_bf16 v[48:51], v[32:35], a[216:223], v3
  v_permlane32_swap_b32 v45, v47
  v_smfmac_f32_16x16x64_bf16 v[52:55], v[8:11], a[224:231], v3
  v_add_f32 v44, v44, v46
  v_smfmac_f32_16x16x64_bf16 v[52:55], v[12:15], a[232:239], v3
  v_add_f32 v45, v45, v47
  v_smfmac_f32_16x16x64_bf16 v[52:55], v[24:27], v[120:127], v3
  v_cvt_pk_bf16_f32 v46, v44, v45
  v_smfmac_f32_16x16x64_bf16 v[52:55], v[28:31], v[128:135], v3
  ds_write_b32 v106, v46
  v_permlane32_swap_b32 v48, v50
  v_smfmac_f32_16x16x64_bf16 v[52:55], v[32:35], v[136:143], v3
  v_permlane32_swap_b32 v49, v51
  v_smfmac_f32_16x16x64_bf16 v[56:59], v[8:11], v[144:151], v3
  v_add_f32 v48, v48, v50
  v_smfmac_f32_16x16x64_bf16 v[56:59], v[12:15], v[152:159], v3
  v_add_f32 v49, v49, v51
  v_smfmac_f32_16x16x64_bf16 v[56:59], v[24:27], v[176:183], v3
  v_cvt_pk_bf16_f32 v50, v48, v49
  v_smfmac_f32_16x16x64_bf16 v[56:59], v[28:31], v[184:191], v3
  ds_write_b32 v107, v50
  v_permlane32_swap_b32 v52, v54
  v_smfmac_f32_16x16x64_bf16 v[56:59], v[32:35], v[192:199], v3
  v_permlane32_swap_b32 v53, v55
  v_smfmac_f32_16x16x64_bf16 v[60:63], v[8:11], v[200:207], v3
  v_add_f32 v52, v52, v54
  v_smfmac_f32_16x16x64_bf16 v[60:63], v[12:15], v[208:215], v3
  v_add_f32 v53, v53, v55
  v_smfmac_f32_16x16x64_bf16 v[60:63], v[24:27], v[232:239], v3
  v_cvt_pk_bf16_f32 v54, v52, v53
  v_smfmac_f32_16x16x64_bf16 v[60:63], v[28:31], v[240:247], v3
  ds_write_b32 v108, v54
  v_permlane32_swap_b32 v56, v58
  v_smfmac_f32_16x16x64_bf16 v[60:63], v[32:35], v[248:255], v3
  v_permlane32_swap_b32 v57, v59
  v_add_f32 v56, v56, v58
  v_add_f32 v57, v57, v59
  v_cvt_pk_bf16_f32 v58, v56, v57
  ds_write_b32 v109, v58
  s_nop 2
  v_permlane32_swap_b32 v60, v62
  v_permlane32_swap_b32 v61, v63
  v_add_f32 v60, v60, v62
  v_add_f32 v61, v61, v63
  v_cvt_pk_bf16_f32 v62, v60, v61
  ds_write_b32 v110, v62
cA_va3_t2d:
  v_mov_b32 v117, s18
  s_cmp_eq_u32 s27, s28
  s_cbranch_scc1 cA_va3_vok
cA_va3_vow:
  s_waitcnt vmcnt(0)
  v_cmp_ne_u32 vcc, 56, v101
  s_cbranch_vccnz cA_va3_vor
  s_mov_b32 s28, s27
cA_va3_vok:
  s_waitcnt lgkmcnt(0)
  s_setprio 3
  s_barrier
  v_mov_b32 v36, 0
  v_mov_b32 v37, 0
  v_mov_b32 v38, 0
  v_mov_b32 v39, 0
  buffer_store_dword v117, v118, s[8:11], 0 offen
  s_setprio 0
  s_cmp_eq_u32 s19, 62
  s_cbranch_scc1 cA_done
  v_mov_b32 v40, 0
  v_mov_b32 v41, 0
  v_mov_b32 v42, 0
  v_mov_b32 v43, 0
  v_mov_b32 v44, 0
  v_mov_b32 v45, 0
  v_mov_b32 v46, 0
  v_mov_b32 v47, 0
  v_mov_b32 v48, 0
  v_mov_b32 v49, 0
  v_mov_b32 v50, 0
  v_mov_b32 v51, 0
  v_mov_b32 v52, 0
  v_mov_b32 v53, 0
  v_mov_b32 v54, 0
  v_mov_b32 v55, 0
  v_mov_b32 v56, 0
  v_mov_b32 v57, 0
  v_mov_b32 v58, 0
  v_mov_b32 v59, 0
  v_mov_b32 v60, 0
  v_mov_b32 v61, 0
  v_mov_b32 v62, 0
  v_mov_b32 v63, 0
  s_mov_b32 s19, s18
  s_add_u32 s18, s18, 1
  s_mov_b32 s22, s20
  s_mov_b32 s20, s21
  s_mov_b32 s21, s22
  s_add_u32 s23, s20, 4096
  s_branch cA_va3_loop
cA_va3_slow:
  s_waitcnt lgkmcnt(0)
cA_va3_sl1:
  s_add_u32 s31, s31, 0x1000000
  buffer_load_dwordx4 v[8:11], v2, s[8:11], s20 offen offset:0 sc1
  buffer_load_dwordx4 v[12:15], v2, s[8:11], s20 offen offset:1024 sc1
  buffer_load_dwordx4 v[16:19], v2, s[8:11], s20 offen offset:2048 sc1
  buffer_load_dwordx4 v[20:23], v2, s[8:11], s20 offen offset:3072 sc1
  buffer_load_dwordx4 v[24:27], v2, s[8:11], s23 offen offset:0 sc1
  buffer_load_dwordx4 v[28:31], v2, s[8:11], s23 offen offset:1024 sc1
  buffer_load_dwordx4 v[32:35], v2, s[8:11], s23 offen offset:2048 sc1
  s_waitcnt vmcnt(0)
  v_max3_u32 v36, v8, v9, v10
  v_max3_u32 v36, v36, v11, v12
  v_max3_u32 v36, v36, v13, v14
  v_max3_u32 v36, v36, v15, v16
  v_max3_u32 v36, v36, v17, v18
  v_max3_u32 v36, v36, v19, v20
  v_max3_u32 v36, v36, v21, v22
  v_max3_u32 v36, v36, v23, v24
  v_max3_u32 v36, v36, v25, v26
  v_max3_u32 v36, v36, v27, v28
  v_max3_u32 v36, v36, v29, v30
  v_max3_u32 v36, v36, v31, v32
  v_max3_u32 v36, v36, v33, v34
  v_max_u32 v36, v36, v35
  v_cmp_eq_u32 vcc, -1, v36
  s_cbranch_vccz cA_va3_sl2
  s_add_u32 s30, s30, 1
  s_cmp_lt_u32 s30, 400000
  s_cbranch_scc1 cA_va3_sl1
  s_branch cA_abort
cA_va3_sl2:
  v_mov_b32 v36, 0
  v_mov_b32 v37, 0
  v_mov_b32 v38, 0
  v_mov_b32 v39, 0
  v_mov_b32 v40, 0
  v_mov_b32 v41, 0
  v_mov_b32 v42, 0
  v_mov_b32 v43, 0
  v_mov_b32 v44, 0
  v_mov_b32 v45, 0
  v_mov_b32 v46, 0
  v_mov_b32 v47, 0
  v_mov_b32 v48, 0
  v_mov_b32 v49, 0
  v_mov_b32 v50, 0
  v_mov_b32 v51, 0
  v_mov_b32 v52, 0
  v_mov_b32 v53, 0
  v_mov_b32 v54, 0
  v_mov_b32 v55, 0
  v_mov_b32 v56, 0
  v_mov_b32 v57, 0
  v_mov_b32 v58, 0
  v_mov_b32 v59, 0
  v_mov_b32 v60, 0
  v_mov_b32 v61, 0
  v_mov_b32 v62, 0
  v_mov_b32 v63, 0
  v_smfmac_f32_16x16x64_bf16 v[36:39], v[8:11], a[0:7], v3
  v_smfmac_f32_16x16x64_bf16 v[40:43], v[8:11], a[56:63], v3
  v_smfmac_f32_16x16x64_bf16 v[44:47], v[8:11], a[112:119], v3
  v_smfmac_f32_16x16x64_bf16 v[48:51], v[8:11], a[168:175], v3
  v_smfmac_f32_16x16x64_bf16 v[52:55], v[8:11], a[224:231], v3
  v_smfmac_f32_16x16x64_bf16 v[56:59], v[8:11], v[144:151], v3
  v_smfmac_f32_16x16x64_bf16 v[60:63], v[8:11], v[200:207], v3
  v_smfmac_f32_16x16x64_bf16 v[36:39], v[12:15], a[8:15], v3
  v_smfmac_f32_16x16x64_bf16 v[40:43], v[12:15], a[64:71], v3
  v_smfmac_f32_16x16x64_bf16 v[44:47], v[12:15], a[120:127], v3
  v_smfmac_f32_16x16x64_bf16 v[48:51], v[12:15], a[176:183], v3
  v_smfmac_f32_16x16x64_bf16 v[52:55], v[12:15], a[232:239], v3
  v_smfmac_f32_16x16x64_bf16 v[56:59], v[12:15], v[152:159], v3
  v_smfmac_f32_16x16x64_bf16 v[60:63], v[12:15], v[208:215], v3
  v_smfmac_f32_16x16x64_bf16 v[36:39], v[16:19], a[16:23], v3
  v_smfmac_f32_16x16x64_bf16 v[40:43], v[16:19], a[72:79], v3
  v_smfmac_f32_16x16x64_bf16 v[44:47], v[16:19], a[128:135], v3
  v_smfmac_f32_16x16x64_bf16 v[48:51], v[16:19], a[184:191], v3
  v_smfmac_f32_16x16x64_bf16 v[52:55], v[16:19], a[240:247], v3
  v_smfmac_f32_16x16x64_bf16 v[56:59], v[16:19], v[160:167], v3
  v_smfmac_f32_16x16x64_bf16 v[60:63], v[16:19], v[216:223], v3
  v_smfmac_f32_16x16x64_bf16 v[36:39], v[20:23], a[24:31], v3
  v_smfmac_f32_16x16x64_bf16 v[40:43], v[20:23], a[80:87], v3
  v_smfmac_f32_16x16x64_bf16 v[44:47], v[20:23], a[136:143], v3
  v_smfmac_f32_16x16x64_bf16 v[48:51], v[20:23], a[192:199], v3
  v_smfmac_f32_16x16x64_bf16 v[52:55], v[20:23], a[248:255], v3
  v_smfmac_f32_16x16x64_bf16 v[56:59], v[20:23], v[168:175], v3
  v_smfmac_f32_16x16x64_bf16 v[60:63], v[20:23], v[224:231], v3
  v_smfmac_f32_16x16x64_bf16 v[36:39], v[24:27], a[32:39], v3
  v_smfmac_f32_16x16x64_bf16 v[40:43], v[24:27], a[88:95], v3
  v_smfmac_f32_16x16x64_bf16 v[44:47], v[24:27], a[144:151], v3
  v_smfmac_f32_16x16x64_bf16 v[48:51], v[24:27], a[200:207], v3
  v_smfmac_f32_16x16x64_bf16 v[52:55], v[24:27], v[120:127], v3
  v_smfmac_f32_16x16x64_bf16 v[56:59], v[24:27], v[176:183], v3
  v_smfmac_f32_16x16x64_bf16 v[60:63], v[24:27], v[232:239], v3
  v_smfmac_f32_16x16x64_bf16 v[36:39], v[28:31], a[40:47], v3
  v_smfmac_f32_16x16x64_bf16 v[40:43], v[28:31], a[96:103], v3
  v_smfmac_f32_16x16x64_bf16 v[44:47], v[28:31], a[152:159], v3
  v_smfmac_f32_16x16x64_bf16 v[48:51], v[28:31], a[208:215], v3
  v_smfmac_f32_16x16x64_bf16 v[52:55], v[28:31], v[128:135], v3
  v_smfmac_f32_16x16x64_bf16 v[56:59], v[28:31], v[184:191], v3
  v_smfmac_f32_16x16x64_bf16 v[60:63], v[28:31], v[240:247], v3
  v_smfmac_f32_16x16x64_bf16 v[36:39], v[32:35], a[48:55], v3
  v_smfmac_f32_16x16x64_bf16 v[40:43], v[32:35], a[104:111], v3
  v_smfmac_f32_16x16x64_bf16 v[44:47], v[32:35], a[160:167], v3
  v_smfmac_f32_16x16x64_bf16 v[48:51], v[32:35], a[216:223], v3
  v_smfmac_f32_16x16x64_bf16 v[52:55], v[32:35], v[136:143], v3
  v_smfmac_f32_16x16x64_bf16 v[56:59], v[32:35], v[192:199], v3
  v_smfmac_f32_16x16x64_bf16 v[60:63], v[32:35], v[248:255], v3
  v_permlane32_swap_b32 v36, v38
  v_permlane32_swap_b32 v37, v39
  v_add_f32 v36, v36, v38
  v_add_f32 v37, v37, v39
  v_cvt_pk_bf16_f32 v38, v36, v37
  ds_write_b32 v104, v38
  v_permlane32_swap_b32 v40, v42
  v_permlane32_swap_b32 v41, v43
  v_add_f32 v40, v40, v42
  v_add_f32 v41, v41, v43
  v_cvt_pk_bf16_f32 v42, v40, v41
  ds_write_b32 v105, v42
  v_permlane32_swap_b32 v44, v46
  v_permlane32_swap_b32 v45, v47
  v_add_f32 v44, v44, v46
  v_add_f32 v45, v45, v47
  v_cvt_pk_bf16_f32 v46, v44, v45
  ds_write_b32 v106, v46
  v_permlane32_swap_b32 v48, v50
  v_permlane32_swap_b32 v49, v51
  v_add_f32 v48, v48, v50
  v_add_f32 v49, v49, v51
  v_cvt_pk_bf16_f32 v50, v48, v49
  ds_write_b32 v107, v50
  v_permlane32_swap_b32 v52, v54
  v_permlane32_swap_b32 v53, v55
  v_add_f32 v52, v52, v54
  v_add_f32 v53, v53, v55
  v_cvt_pk_bf16_f32 v54, v52, v53
  ds_write_b32 v108, v54
  v_permlane32_swap_b32 v56, v58
  v_permlane32_swap_b32 v57, v59
  v_add_f32 v56, v56, v58
  v_add_f32 v57, v57, v59
  v_cvt_pk_bf16_f32 v58, v56, v57
  ds_write_b32 v109, v58
  v_permlane32_swap_b32 v60, v62
  v_permlane32_swap_b32 v61, v63
  v_add_f32 v60, v60, v62
  v_add_f32 v61, v61, v63
  v_cvt_pk_bf16_f32 v62, v60, v61
  ds_write_b32 v110, v62
  s_branch cA_va3_t2d
cA_va3_vor:
  s_sleep 2
  buffer_load_dword v101, off, s[8:11], s27 sc1
  s_add_u32 s30, s30, 1
  s_cmp_lt_u32 s30, 400000
  s_cbranch_scc1 cA_va3_vow
  s_branch cA_abort
cA_abort:
  v_mov_b32 v4, 0xdead
  v_mov_b32 v5, 16
  buffer_store_dword v4, v5, s[12:15], 0 offen
  s_branch ch_end
cA_done:
  s_branch ch_end
.p2align 6
cB_sc0_loop:
  s_mov_b32 s30, 0
  s_mov_b32 s62, 0
  s_setprio 3
  s_sleep 6
cB_sc0_fp_l:
  v_cmp_gt_u32 vcc, s19, v112
  buffer_load_dword v112, v0, s[8:11], 0 offen sc1
  s_cbranch_vccz cB_sc0_fp_d
  v_cmp_gt_u32 vcc, s19, v112
  buffer_load_dword v112, v0, s[8:11], 0 offen sc1
  s_cbranch_vccz cB_sc0_fp_d
  v_cmp_gt_u32 vcc, s19, v112
  buffer_load_dword v112, v0, s[8:11], 0 offen sc1
  s_cbranch_vccz cB_sc0_fp_d
  v_cmp_gt_u32 vcc, s19, v112
  buffer_load_dword v112, v0, s[8:11], 0 offen sc1
  s_cbranch_vccz cB_sc0_fp_d
  v_cmp_gt_u32 vcc, s19, v112
  buffer_load_dword v112, v0, s[8:11], 0 offen sc1
  s_cbranch_vccz cB_sc0_fp_d
  v_cmp_gt_u32 vcc, s19, v112
  buffer_load_dword v112, v0, s[8:11], 0 offen sc1
  s_cbranch_vccz cB_sc0_fp_d
  v_cmp_gt_u32 vcc, s19, v112
  buffer_load_dword v112, v0, s[8:11], 0 offen sc1
  s_cbranch_vccz cB_sc0_fp_d
  v_cmp_gt_u32 vcc, s19, v112
  buffer_load_dword v112, v0, s[8:11], 0 offen sc1
  s_cbranch_vccz cB_sc0_fp_d
  v_cmp_gt_u32 vcc, s19, v112
  buffer_load_dword v112, v0, s[8:11], 0 offen sc1
  s_cbranch_vccz cB_sc0_fp_d
  v_cmp_gt_u32 vcc, s19, v112
  buffer_load_dword v112, v0, s[8:11], 0 offen sc1
  s_cbranch_vccz cB_sc0_fp_d
  v_cmp_gt_u32 vcc, s19, v112
  buffer_load_dword v112, v0, s[8:11], 0 offen sc1
  s_cbranch_vccz cB_sc0_fp_d
  v_cmp_gt_u32 vcc, s19, v112
  buffer_load_dword v112, v0, s[8:11], 0 offen sc1
  s_cbranch_vccz cB_sc0_fp_d
  v_cmp_gt_u32 vcc, s19, v112
  buffer_load_dword v112, v0, s[8:11], 0 offen sc1
  s_cbranch_vccz cB_sc0_fp_d
  v_cmp_gt_u32 vcc, s19, v112
  buffer_load_dword v112, v0, s[8:11], 0 offen sc1
  s_cbranch_vccz cB_sc0_fp_d
  v_cmp_gt_u32 vcc, s19, v112
  buffer_load_dword v112, v0, s[8:11], 0 offen sc1
  s_cbranch_vccz cB_sc0_fp_d
  v_cmp_gt_u32 vcc, s19, v112
  buffer_load_dword v112, v0, s[8:11], 0 offen sc1
  s_cbranch_vccz cB_sc0_fp_d
  s_waitcnt vmcnt(24)
  s_add_u32 s30, s30, 1
  s_cmp_lt_u32 s30, 400000
  s_cbranch_scc1 cB_sc0_fp_l
  s_branch cB_abort
cB_sc0_fp_d:
  buffer_load_dwordx4 v[8:11], v2, s[8:11], s20 offen offset:0 sc1
  s_barrier
  s_setprio 2
  buffer_load_dwordx4 v[12:15], v2, s[8:11], s20 offen offset:1024 sc1
  s_setprio 1
  buffer_load_dwordx4 v[16:19], v2, s[8:11], s20 offen offset:2048 sc1
  s_setprio 0
  buffer_load_dwordx4 v[20:23], v2, s[8:11], s20 offen offset:3072 sc1
cB_sc0_go:
  s_waitcnt vmcnt(3)
  v_smfmac_f32_16x16x64_bf16 v[36:39], v[8:11], a[0:7], v3
  buffer_load_dwordx4 v[32:35], v2, s[8:11], s23 offen offset:0 sc1
  v_cmp_eq_u32 vcc, -1, v8
  v_smfmac_f32_16x16x64_bf16 v[40:43], v[8:11], a[56:63], v3
  v_smfmac_f32_16x16x64_bf16 v[44:47], v[8:11], a[112:119], v3
  buffer_load_dwordx4 v[24:27], v2, s[8:11], s23 offen offset:1024 sc1
  s_cbranch_vccnz cB_sc0_r0
  v_smfmac_f32_16x16x64_bf16 v[48:51], v[8:11], a[168:175], v3
  v_smfmac_f32_16x16x64_bf16 v[52:55], v[8:11], a[224:231], v3
  s_waitcnt vmcnt(4)
  v_cmp_eq_u32 vcc, -1, v12
  v_smfmac_f32_16x16x64_bf16 v[56:59], v[8:11], v[144:151], v3
  buffer_load_dwordx4 v[28:31], v2, s[8:11], s23 offen offset:2048 sc1
  v_smfmac_f32_16x16x64_bf16 v[60:63], v[8:11], v[200:207], v3
  s_cbranch_vccnz cB_sc0_r1
cB_sc0_c1:
  v_smfmac_f32_16x16x64_bf16 v[36:39], v[12:15], a[8:15], v3
  v_smfmac_f32_16x16x64_bf16 v[40:43], v[12:15], a[64:71], v3
  v_smfmac_f32_16x16x64_bf16 v[44:47], v[12:15], a[120:127], v3
  v_smfmac_f32_16x16x64_bf16 v[48:51], v[12:15], a[176:183], v3
  v_smfmac_f32_16x16x64_bf16 v[52:55], v[12:15], a[232:239], v3
  s_waitcnt vmcnt(4)
  v_cmp_eq_u32 vcc, -1, v16
  v_smfmac_f32_16x16x64_bf16 v[56:59], v[12:15], v[152:159], v3
  buffer_load_dwordx4 v[88:91], v117, s[8:11], s26 offen offset:0 sc1
  v_smfmac_f32_16x16x64_bf16 v[60:63], v[12:15], v[208:215], v3
  s_cbranch_vccnz cB_sc0_r2
cB_sc0_c2:
  v_smfmac_f32_16x16x64_bf16 v[36:39], v[16:19], a[16:23], v3
  v_smfmac_f32_16x16x64_bf16 v[40:43], v[16:19], a[72:79], v3
  v_smfmac_f32_16x16x64_bf16 v[44:47], v[16:19], a[128:135], v3
  buffer_load_dwordx4 v[92:95], v117, s[8:11], s26 offen offset:1024 sc1
  v_smfmac_f32_16x16x64_bf16 v[48:51], v[16:19], a[184:191], v3
  v_smfmac_f32_16x16x64_bf16 v[52:55], v[16:19], a[240:247], v3
  s_waitcnt vmcnt(5)
  v_cmp_eq_u32 vcc, -1, v20
  v_smfmac_f32_16x16x64_bf16 v[56:59], v[16:19], v[160:167], v3
  v_smfmac_f32_16x16x64_bf16 v[60:63], v[16:19], v[216:223], v3
  buffer_load_dwordx4 v[96:99], v2, s[8:11], s24 offen offset:0 sc1
  s_cbranch_vccnz cB_sc0_r3
cB_sc0_c3:
  v_smfmac_f32_16x16x64_bf16 v[36:39], v[20:23], a[24:31], v3
  v_smfmac_f32_16x16x64_bf16 v[40:43], v[20:23], a[80:87], v3
  s_waitcnt vmcnt(3)
  v_max3_u32 v66, v24, v27, v28
  v_smfmac_f32_16x16x64_bf16 v[44:47], v[20:23], a[136:143], v3
  v_max3_u32 v66, v66, v31, v32
  v_smfmac_f32_16x16x64_bf16 v[48:51], v[20:23], a[192:199], v3
  buffer_load_dwordx4 v[100:103], v2, s[8:11], s24 offen offset:1024 sc1
  v_max_u32 v66, v66, v35
  v_smfmac_f32_16x16x64_bf16 v[52:55], v[20:23], a[248:255], v3
  v_cmp_eq_u32 vcc, -1, v66
  v_smfmac_f32_16x16x64_bf16 v[56:59], v[20:23], v[168:175], v3
  v_smfmac_f32_16x16x64_bf16 v[60:63], v[20:23], v[224:231], v3
  s_cbranch_vccnz cB_sc0_r4
cB_sc0_c4:
  v_smfmac_f32_16x16x64_bf16 v[60:63], v[32:35], v[232:239], v3
  buffer_load_dwordx4 v[104:107], v2, s[8:11], s26 offen offset:0 sc1
  v_smfmac_f32_16x16x64_bf16 v[60:63], v[24:27], v[240:247], v3
  v_smfmac_f32_16x16x64_bf16 v[60:63], v[28:31], v[248:255], v3
  v_smfmac_f32_16x16x64_bf16 v[52:55], v[32:35], v[120:127], v3
  v_smfmac_f32_16x16x64_bf16 v[52:55], v[24:27], v[128:135], v3
  buffer_load_dwordx4 v[108:111], v2, s[8:11], s26 offen offset:1024 sc1
  v_smfmac_f32_16x16x64_bf16 v[52:55], v[28:31], v[136:143], v3
  v_cvt_pk_bf16_f32 v63, v62, v63
  v_smfmac_f32_16x16x64_bf16 v[56:59], v[32:35], v[176:183], v3
  v_cvt_pk_bf16_f32 v62, v60, v61
  v_smfmac_f32_16x16x64_bf16 v[56:59], v[24:27], v[184:191], v3
  v_mfma_f32_16x16x32_bf16 v[12:15], v[62:65], v[4:7], 0
  v_cvt_pk_bf16_f32 v55, v54, v55
  v_smfmac_f32_16x16x64_bf16 v[56:59], v[28:31], v[192:199], v3
  v_cvt_pk_bf16_f32 v54, v52, v53
  v_smfmac_f32_16x16x64_bf16 v[36:39], v[32:35], a[32:39], v3
  s_nop 1
  v_cvt_pk_bf16_f32 v76, v12, v13
  v_smfmac_f32_16x16x64_bf16 v[36:39], v[24:27], a[40:47], v3
  v_cvt_pk_bf16_f32 v77, v14, v15
  v_smfmac_f32_16x16x64_bf16 v[36:39], v[28:31], a[48:55], v3
  v_cvt_pk_bf16_f32 v56, v56, v57
  v_smfmac_f32_16x16x64_bf16 v[40:43], v[32:35], a[88:95], v3
  v_cvt_pk_bf16_f32 v57, v58, v59
  v_smfmac_f32_16x16x64_bf16 v[40:43], v[24:27], a[96:103], v3
  v_mfma_f32_16x16x32_bf16 v[16:19], v[54:57], v[4:7], 0
  v_cvt_pk_bf16_f32 v39, v38, v39
  v_smfmac_f32_16x16x64_bf16 v[40:43], v[28:31], a[104:111], v3
  v_cvt_pk_bf16_f32 v38, v36, v37
  v_smfmac_f32_16x16x64_bf16 v[44:47], v[32:35], a[144:151], v3
  s_nop 1
  v_cvt_pk_bf16_f32 v78, v16, v17
  v_smfmac_f32_16x16x64_bf16 v[44:47], v[24:27], a[152:159], v3
  v_cvt_pk_bf16_f32 v79, v18, v19
  v_smfmac_f32_16x16x64_bf16 v[44:47], v[28:31], a[160:167], v3
  v_cvt_pk_bf16_f32 v40, v40, v41
  v_smfmac_f32_16x16x64_bf16 v[48:51], v[32:35], a[200:207], v3
  v_cvt_pk_bf16_f32 v41, v42, v43
  v_smfmac_f32_16x16x64_bf16 v[48:51], v[24:27], a[208:215], v3
  v_smfmac_f32_16x16x64_bf16 v[48:51], v[28:31], a[216:223], v3
  s_waitcnt vmcnt(4)
  v_cvt_pk_bf16_f32 v47, v46, v47
  v_smfmac_f32_16x16x64_bf16 v[68:71], v[76:79], v[80:87], v3
  v_cvt_pk_bf16_f32 v46, v44, v45
  v_mfma_f32_16x16x32_bf16 v[12:15], v[38:41], v[4:7], 0
  s_nop 1
  v_cvt_pk_bf16_f32 v48, v48, v49
  v_cvt_pk_bf16_f32 v49, v50, v51
  s_nop 1
  v_mfma_f32_16x16x32_bf16 v[16:19], v[46:49], v[4:7], 0
  v_smfmac_f32_16x16x64_bf16 v[72:75], v[76:79], v[88:95], v3
  v_cvt_pk_bf16_f32 v20, v12, v13
  v_mfma_f32_16x16x32_bf16 v[52:55], v[30:33], v[76:79], 0
  s_waitcnt vmcnt(0)
  v_cvt_pk_bf16_f32 v21, v14, v15
  v_cvt_pk_bf16_f32 v22, v16, v17
  v_cvt_pk_bf16_f32 v23, v18, v19
  s_nop 1
  v_mfma_f32_16x16x32_bf16 v[52:55], v[8:11], v[20:23], v[52:55]
  v_smfmac_f32_16x16x64_bf16 v[68:71], v[20:23], v[96:103], v3
  v_smfmac_f32_16x16x64_bf16 v[72:75], v[20:23], v[104:111], v3
  s_nop 1
  ds_write_b128 v113, v[52:55]
  s_nop 1
  v_permlane32_swap_b32 v68, v70
  v_permlane32_swap_b32 v69, v71
  v_add_f32 v56, v68, v70
  v_add_f32 v58, v69, v71
  v_permlane32_swap_b32 v72, v74
  v_permlane32_swap_b32 v73, v75
  v_add_f32 v57, v72, v74
  v_add_f32 v59, v73, v75
  ds_write_b128 v2, v[56:59] offset:0
  v_cmp_u_f32 vcc, v57, v59
  v_mov_b32 v68, 0
  v_mov_b32 v69, 0
  v_mov_b32 v70, 0
  v_mov_b32 v71, 0
  s_cbranch_vccnz cB_sc0_retry
cB_sc0_cont:
  s_add_u32 s24, s24, 28672
  s_add_u32 s26, s26, 28672
  buffer_load_dwordx4 v[80:83], v117, s[8:11], s24 offen offset:0 sc1
  buffer_load_dwordx4 v[84:87], v117, s[8:11], s24 offen offset:1024 sc1
  v_mov_b32 v72, 0
  v_mov_b32 v73, 0
  v_mfma_f32_32x32x16_bf16 v[36:51], v[68:71], v[68:71], 0
  s_waitcnt lgkmcnt(0)
  s_barrier
  ds_read_b64 v[8:9], v114 offset:0
  ds_read_b64 v[10:11], v114 offset:1024
  ds_read_b64 v[12:13], v114 offset:2048
  ds_read_b64 v[14:15], v114 offset:3072
  ds_read2_b32 v[16:17], v115 offset0:0 offset1:64
  ds_read2_b32 v[18:19], v115 offset0:128 offset1:192
  v_mfma_f32_32x32x16_bf16 v[52:67], v[68:71], v[68:71], 0
  s_waitcnt lgkmcnt(0)
  v_pk_add_f32 v[16:17], v[16:17], v[18:19]
  v_pk_add_f32 v[8:9], v[8:9], v[10:11]
  v_pk_add_f32 v[12:13], v[12:13], v[14:15]
  v_add_f32 v20, v16, v17
  v_pk_add_f32 v[8:9], v[8:9], v[12:13]
  v_max_f32 v22, v8, v9
  v_add_f32_dpp v20, v20, v20 row_ror:8 row_mask:0xf bank_mask:0xf
  s_nop 0
  v_max_f32_dpp v22, v22, v22 row_ror:8 row_mask:0xf bank_mask:0xf
  v_max_f32 v22, v22, v20
  s_nop 1
  v_max_f32_dpp v22, v22, v22 quad_perm:[1,0,3,2] row_mask:0xf bank_mask:0xf
  s_nop 1
  v_max_f32_dpp v22, v22, v22 quad_perm:[2,3,0,1] row_mask:0xf bank_mask:0xf
  s_nop 1
  v_max_f32_dpp v22, v22, v22 row_half_mirror row_mask:0xf bank_mask:0xf
  v_pk_add_f32 v[8:9], v[8:9], v[22:23] op_sel_hi:[1,0] neg_lo:[0,1] neg_hi:[0,1]
  v_sub_f32 v20, v20, v22
  v_exp_f32 v8, v8
  v_exp_f32 v9, v9
  v_exp_f32 v20, v20
  v_add_f32 v24, v8, v9
  v_fmac_f32 v24, 0.5, v20
  v_mov_b32_dpp v21, v20 quad_perm:[1,0,3,2] row_mask:0xf bank_mask:0xf
  s_nop 0
  v_add_f32_dpp v24, v24, v24 quad_perm:[1,0,3,2] row_mask:0xf bank_mask:0xf
  s_nop 1
  v_add_f32_dpp v24, v24, v24 quad_perm:[2,3,0,1] row_mask:0xf bank_mask:0xf
  s_nop 1
  v_add_f32_dpp v24, v24, v24 row_half_mirror row_mask:0xf bank_mask:0xf
  s_nop 1
  v_add_f32_dpp v24, v24, v24 row_ror:8 row_mask:0xf bank_mask:0xf
  v_rcp_f32 v24, v24
  s_nop 0
  v_pk_mul_f32 v[8:9], v[8:9], v[24:25] op_sel_hi:[1,0]
  v_pk_mul_f32 v[20:21], v[20:21], v[24:25] op_sel_hi:[1,0]
  v_cvt_pk_bf16_f32 v8, v8, v9
  v_cvt_pk_bf16_f32 v20, v20, v21
  v_min_u32 v8, -2, v8
  buffer_store_dword v8, v1, s[8:11], s20 offen sc1
  v_min_u32 v20, -2, v20
  buffer_store_dword v20, v118, s[8:11], s20 offen sc1
  v_mov_b32 v74, 0
  v_mov_b32 v75, 0
  s_mov_b32 s19, s18
  s_add_u32 s18, s18, 1
  s_mov_b32 s22, s20
  s_mov_b32 s20, s21
  s_mov_b32 s21, s22
  s_add_u32 s23, s20, 4096
  s_cmp_lt_u32 s19, 63
  s_cbranch_scc1 cB_sc0_loop
  s_branch cB_done
cB_sc0_r0:
  s_add_u32 s31, s31, 1
  buffer_load_dwordx4 v[8:11], v2, s[8:11], s20 offen offset:0 sc1
  s_waitcnt vmcnt(0)
  v_cmp_eq_u32 vcc, -1, v8
  v_mov_b32 v36, 0
  v_mov_b32 v37, 0
  v_mov_b32 v38, 0
  v_mov_b32 v39, 0
  v_mov_b32 v40, 0
  v_mov_b32 v41, 0
  v_mov_b32 v42, 0
  v_mov_b32 v43, 0
  v_mov_b32 v44, 0
  v_mov_b32 v45, 0
  v_mov_b32 v46, 0
  v_mov_b32 v47, 0
  v_mov_b32 v48, 0
  v_mov_b32 v49, 0
  v_mov_b32 v50, 0
  v_mov_b32 v51, 0
  s_nop 1
  s_cbranch_vccz cB_sc0_go
  s_add_u32 s30, s30, 1
  s_cmp_lt_u32 s30, 400000
  s_cbranch_scc1 cB_sc0_r0
  s_branch cB_abort
cB_sc0_r1:
  s_add_u32 s31, s31, 1
  buffer_load_dwordx4 v[12:15], v2, s[8:11], s20 offen offset:1024 sc1
  s_waitcnt vmcnt(0)
  v_cmp_eq_u32 vcc, -1, v12
  s_nop 4
  s_cbranch_vccz cB_sc0_c1
  s_add_u32 s30, s30, 1
  s_cmp_lt_u32 s30, 400000
  s_cbranch_scc1 cB_sc0_r1
  s_branch cB_abort
cB_sc0_r2:
  s_add_u32 s31, s31, 1
  buffer_load_dwordx4 v[16:19], v2, s[8:11], s20 offen offset:2048 sc1
  s_waitcnt vmcnt(0)
  v_cmp_eq_u32 vcc, -1, v16
  s_nop 4
  s_cbranch_vccz cB_sc0_c2
  s_add_u32 s30, s30, 1
  s_cmp_lt_u32 s30, 400000
  s_cbranch_scc1 cB_sc0_r2
  s_branch cB_abort
cB_sc0_r3:
  s_add_u32 s31, s31, 1
  buffer_load_dwordx4 v[20:23], v2, s[8:11], s20 offen offset:3072 sc1
  s_waitcnt vmcnt(0)
  v_cmp_eq_u32 vcc, -1, v20
  s_nop 4
  s_cbranch_vccz cB_sc0_c3
  s_add_u32 s30, s30, 1
  s_cmp_lt_u32 s30, 400000
  s_cbranch_scc1 cB_sc0_r3
  s_branch cB_abort
cB_sc0_r4:
  s_add_u32 s31, s31, 1
  buffer_load_dwordx4 v[32:35], v2, s[8:11], s23 offen offset:0 sc1
  buffer_load_dwordx4 v[24:27], v2, s[8:11], s23 offen offset:1024 sc1
  buffer_load_dwordx4 v[28:31], v2, s[8:11], s23 offen offset:2048 sc1
  s_waitcnt vmcnt(0)
  v_max3_u32 v66, v24, v27, v28
  v_max3_u32 v66, v66, v31, v32
  v_max_u32 v66, v66, v35
  v_cmp_eq_u32 vcc, -1, v66
  s_nop 4
  s_cbranch_vccz cB_sc0_c4
  s_add_u32 s30, s30, 1
  s_cmp_lt_u32 s30, 400000
  s_cbranch_scc1 cB_sc0_r4
  s_branch cB_abort
cB_sc0_retry:
  s_cmp_lg_u32 s62, 0
  s_cbranch_scc1 cB_sc0_cont
  s_waitcnt vmcnt(0) lgkmcnt(0)
cB_sc0_rv:
  buffer_load_dwordx4 v[8:11], v2, s[8:11], s20 offen offset:0 sc1
  buffer_load_dwordx4 v[12:15], v2, s[8:11], s20 offen offset:1024 sc1
  buffer_load_dwordx4 v[16:19], v2, s[8:11], s20 offen offset:2048 sc1
  buffer_load_dwordx4 v[20:23], v2, s[8:11], s20 offen offset:3072 sc1
  buffer_load_dwordx4 v[32:35], v2, s[8:11], s23 offen offset:0 sc1
  buffer_load_dwordx4 v[24:27], v2, s[8:11], s23 offen offset:1024 sc1
  buffer_load_dwordx4 v[28:31], v2, s[8:11], s23 offen offset:2048 sc1
  s_waitcnt vmcnt(0)
  v_pk_max_u16 v66, v8, v9
  v_pk_max_u16 v66, v66, v10
  v_pk_max_u16 v66, v66, v11
  v_pk_max_u16 v66, v66, v12
  v_pk_max_u16 v66, v66, v13
  v_pk_max_u16 v66, v66, v14
  v_pk_max_u16 v66, v66, v15
  v_pk_max_u16 v66, v66, v16
  v_pk_max_u16 v66, v66, v17
  v_pk_max_u16 v66, v66, v18
  v_pk_max_u16 v66, v66, v19
  v_pk_max_u16 v66, v66, v20
  v_pk_max_u16 v66, v66, v21
  v_pk_max_u16 v66, v66, v22
  v_pk_max_u16 v66, v66, v23
  v_pk_max_u16 v66, v66, v24
  v_pk_max_u16 v66, v66, v25
  v_pk_max_u16 v66, v66, v26
  v_pk_max_u16 v66, v66, v27
  v_pk_max_u16 v66, v66, v28
  v_pk_max_u16 v66, v66, v29
  v_pk_max_u16 v66, v66, v30
  v_pk_max_u16 v66, v66, v31
  v_pk_max_u16 v66, v66, v32
  v_pk_max_u16 v66, v66, v33
  v_pk_max_u16 v66, v66, v34
  v_pk_max_u16 v66, v66, v35
  v_lshlrev_b32 v67, 16, v66
  v_max_u32 v66, v66, v67
  v_cmp_le_u32 vcc, 0xffff0000, v66
  s_cbranch_vccz cB_sc0_rk
  s_add_u32 s30, s30, 1
  s_cmp_lt_u32 s30, 400000
  s_cbranch_scc1 cB_sc0_rv
  s_branch cB_abort
cB_sc0_rk:
  s_mov_b32 s62, 1
  v_mov_b32 v36, 0
  v_mov_b32 v37, 0
  v_mov_b32 v38, 0
  v_mov_b32 v39, 0
  v_mov_b32 v40, 0
  v_mov_b32 v41, 0
  v_mov_b32 v42, 0
  v_mov_b32 v43, 0
  v_mov_b32 v44, 0
  v_mov_b32 v45, 0
  v_mov_b32 v46, 0
  v_mov_b32 v47, 0
  v_mov_b32 v48, 0
  v_mov_b32 v49, 0
  v_mov_b32 v50, 0
  v_mov_b32 v51, 0
  v_mov_b32 v60, 0
  v_mov_b32 v61, 0
  v_mov_b32 v62, 0
  v_mov_b32 v63, 0
  v_mov_b32 v68, 0
  v_mov_b32 v69, 0
  v_mov_b32 v70, 0
  v_mov_b32 v71, 0
  v_mov_b32 v72, 0
  v_mov_b32 v73, 0
  v_mov_b32 v74, 0
  v_mov_b32 v75, 0
  v_mov_b32 v52, 0
  v_mov_b32 v53, 0
  v_mov_b32 v54, 0
  v_mov_b32 v55, 0
  v_mov_b32 v56, 0
  v_mov_b32 v57, 0
  v_mov_b32 v58, 0
  v_mov_b32 v59, 0
  s_add_u32 s31, s31, 0x100
  s_nop 0
  s_branch cB_sc0_go
.p2align 6
cB_sc1_loop:
  s_mov_b32 s30, 0
  s_mov_b32 s62, 0
  s_setprio 3
  s_barrier
  buffer_load_dwordx4 v[8:11], v2, s[8:11], s20 offen offset:0 sc1
  s_setprio 2
  buffer_load_dwordx4 v[12:15], v2, s[8:11], s20 offen offset:1024 sc1
  s_setprio 1
  buffer_load_dwordx4 v[16:19], v2, s[8:11], s20 offen offset:2048 sc1
  s_setprio 0
  buffer_load_dwordx4 v[20:23], v2, s[8:11], s20 offen offset:3072 sc1
cB_sc1_go:
  s_waitcnt vmcnt(3)
  v_smfmac_f32_16x16x64_bf16 v[36:39], v[8:11], a[0:7], v3
  buffer_load_dwordx4 v[28:31], v2, s[8:11], s23 offen offset:0 sc1
  v_cmp_eq_u32 vcc, -1, v8
  v_smfmac_f32_16x16x64_bf16 v[40:43], v[8:11], a[56:63], v3
  v_smfmac_f32_16x16x64_bf16 v[44:47], v[8:11], a[112:119], v3
  buffer_load_dwordx4 v[24:27], v2, s[8:11], s23 offen offset:1024 sc1
  s_cbranch_vccnz cB_sc1_r0
  v_smfmac_f32_16x16x64_bf16 v[48:51], v[8:11], a[168:175], v3
  v_smfmac_f32_16x16x64_bf16 v[52:55], v[8:11], a[224:231], v3
  s_waitcnt vmcnt(4)
  v_cmp_eq_u32 vcc, -1, v12
  v_smfmac_f32_16x16x64_bf16 v[56:59], v[8:11], v[144:151], v3
  buffer_load_dwordx4 v[32:35], v2, s[8:11], s23 offen offset:2048 sc1
  v_smfmac_f32_16x16x64_bf16 v[60:63], v[8:11], v[200:207], v3
  s_cbranch_vccnz cB_sc1_r1
cB_sc1_c1:
  v_smfmac_f32_16x16x64_bf16 v[36:39], v[12:15], a[8:15], v3
  v_smfmac_f32_16x16x64_bf16 v[40:43], v[12:15], a[64:71], v3
  v_smfmac_f32_16x16x64_bf16 v[44:47], v[12:15], a[120:127], v3
  v_smfmac_f32_16x16x64_bf16 v[48:51], v[12:15], a[176:183], v3
  v_smfmac_f32_16x16x64_bf16 v[52:55], v[12:15], a[232:239], v3
  s_waitcnt vmcnt(4)
  v_cmp_eq_u32 vcc, -1, v16
  v_smfmac_f32_16x16x64_bf16 v[56:59], v[12:15], v[152:159], v3
  buffer_load_dwordx4 v[88:91], v117, s[8:11], s26 offen offset:0 sc1
  v_smfmac_f32_16x16x64_bf16 v[60:63], v[12:15], v[208:215], v3
  s_cbranch_vccnz cB_sc1_r2
cB_sc1_c2:
  v_smfmac_f32_16x16x64_bf16 v[36:39], v[16:19], a[16:23], v3
  v_smfmac_f32_16x16x64_bf16 v[40:43], v[16:19], a[72:79], v3
  v_smfmac_f32_16x16x64_bf16 v[44:47], v[16:19], a[128:135], v3
  buffer_load_dwordx4 v[92:95], v117, s[8:11], s26 offen offset:1024 sc1
  v_smfmac_f32_16x16x64_bf16 v[48:51], v[16:19], a[184:191], v3
  v_smfmac_f32_16x16x64_bf16 v[52:55], v[16:19], a[240:247], v3
  s_waitcnt vmcnt(5)
  v_cmp_eq_u32 vcc, -1, v20
  v_smfmac_f32_16x16x64_bf16 v[56:59], v[16:19], v[160:167], v3
  v_smfmac_f32_16x16x64_bf16 v[60:63], v[16:19], v[216:223], v3
  buffer_load_dwordx4 v[96:99], v2, s[8:11], s24 offen offset:0 sc1
  s_cbranch_vccnz cB_sc1_r3
cB_sc1_c3:
  v_smfmac_f32_16x16x64_bf16 v[36:39], v[20:23], a[24:31], v3
  v_smfmac_f32_16x16x64_bf16 v[40:43], v[20:23], a[80:87], v3
  s_waitcnt vmcnt(3)
  v_max3_u32 v66, v24, v27, v28
  v_smfmac_f32_16x16x64_bf16 v[44:47], v[20:23], a[136:143], v3
  v_max3_u32 v66, v66, v31, v32
  v_smfmac_f32_16x16x64_bf16 v[48:51], v[20:23], a[192:199], v3
  buffer_load_dwordx4 v[100:103], v2, s[8:11], s24 offen offset:1024 sc1
  v_max_u32 v66, v66, v35
  v_smfmac_f32_16x16x64_bf16 v[52:55], v[20:23], a[248:255], v3
  v_cmp_eq_u32 vcc, -1, v66
  v_smfmac_f32_16x16x64_bf16 v[56:59], v[20:23], v[168:175], v3
  v_smfmac_f32_16x16x64_bf16 v[60:63], v[20:23], v[224:231], v3
  s_cbranch_vccnz cB_sc1_r4
cB_sc1_c4:
  v_smfmac_f32_16x16x64_bf16 v[60:63], v[28:31], v[232:239], v3
  buffer_load_dwordx4 v[104:107], v2, s[8:11], s26 offen offset:0 sc1
  v_smfmac_f32_16x16x64_bf16 v[60:63], v[24:27], v[240:247], v3
  v_smfmac_f32_16x16x64_bf16 v[60:63], v[32:35], v[248:255], v3
  v_smfmac_f32_16x16x64_bf16 v[52:55], v[28:31], v[120:127], v3
  v_smfmac_f32_16x16x64_bf16 v[52:55], v[24:27], v[128:135], v3
  buffer_load_dwordx4 v[108:111], v2, s[8:11], s26 offen offset:1024 sc1
  v_smfmac_f32_16x16x64_bf16 v[52:55], v[32:35], v[136:143], v3
  v_cvt_pk_bf16_f32 v63, v62, v63
  v_smfmac_f32_16x16x64_bf16 v[56:59], v[28:31], v[176:183], v3
  v_cvt_pk_bf16_f32 v62, v60, v61
  v_smfmac_f32_16x16x64_bf16 v[56:59], v[24:27], v[184:191], v3
  v_mfma_f32_16x16x32_bf16 v[8:11], v[62:65], v[4:7], 0
  v_cvt_pk_bf16_f32 v55, v54, v55
  v_smfmac_f32_16x16x64_bf16 v[56:59], v[32:35], v[192:199], v3
  v_cvt_pk_bf16_f32 v54, v52, v53
  v_smfmac_f32_16x16x64_bf16 v[36:39], v[28:31], a[32:39], v3
  s_nop 1
  v_cvt_pk_bf16_f32 v78, v8, v9
  v_smfmac_f32_16x16x64_bf16 v[36:39], v[24:27], a[40:47], v3
  v_cvt_pk_bf16_f32 v79, v10, v11
  v_smfmac_f32_16x16x64_bf16 v[36:39], v[32:35], a[48:55], v3
  v_cvt_pk_bf16_f32 v56, v56, v57
  v_smfmac_f32_16x16x64_bf16 v[40:43], v[28:31], a[88:95], v3
  v_cvt_pk_bf16_f32 v57, v58, v59
  v_smfmac_f32_16x16x64_bf16 v[40:43], v[24:27], a[96:103], v3
  v_mfma_f32_16x16x32_bf16 v[16:19], v[54:57], v[4:7], 0
  v_cvt_pk_bf16_f32 v39, v38, v39
  v_smfmac_f32_16x16x64_bf16 v[40:43], v[32:35], a[104:111], v3
  v_cvt_pk_bf16_f32 v38, v36, v37
  v_smfmac_f32_16x16x64_bf16 v[44:47], v[28:31], a[144:151], v3
  s_nop 1
  v_cvt_pk_bf16_f32 v76, v16, v17
  v_smfmac_f32_16x16x64_bf16 v[44:47], v[24:27], a[152:159], v3
  v_cvt_pk_bf16_f32 v77, v18, v19
  v_smfmac_f32_16x16x64_bf16 v[44:47], v[32:35], a[160:167], v3
  v_cvt_pk_bf16_f32 v40, v40, v41
  v_smfmac_f32_16x16x64_bf16 v[48:51], v[28:31], a[200:207], v3
  v_cvt_pk_bf16_f32 v41, v42, v43
  v_smfmac_f32_16x16x64_bf16 v[48:51], v[24:27], a[208:215], v3
  v_smfmac_f32_16x16x64_bf16 v[48:51], v[32:35], a[216:223], v3
  s_waitcnt vmcnt(4)
  v_cvt_pk_bf16_f32 v47, v46, v47
  v_smfmac_f32_16x16x64_bf16 v[68:71], v[76:79], v[80:87], v3
  v_cvt_pk_bf16_f32 v46, v44, v45
  v_mfma_f32_16x16x32_bf16 v[8:11], v[38:41], v[4:7], 0
  s_nop 1
  v_cvt_pk_bf16_f32 v48, v48, v49
  v_cvt_pk_bf16_f32 v49, v50, v51
  s_nop 1
  v_mfma_f32_16x16x32_bf16 v[16:19], v[46:49], v[4:7], 0
  v_smfmac_f32_16x16x64_bf16 v[72:75], v[76:79], v[88:95], v3
  v_cvt_pk_bf16_f32 v20, v8, v9
  v_mfma_f32_16x16x32_bf16 v[52:55], v[30:33], v[76:79], 0
  s_waitcnt vmcnt(0)
  v_cvt_pk_bf16_f32 v21, v10, v11
  v_cvt_pk_bf16_f32 v22, v16, v17
  v_cvt_pk_bf16_f32 v23, v18, v19
  s_nop 1
  v_mfma_f32_16x16x32_bf16 v[52:55], v[12:15], v[20:23], v[52:55]
  v_smfmac_f32_16x16x64_bf16 v[68:71], v[20:23], v[96:103], v3
  v_smfmac_f32_16x16x64_bf16 v[72:75], v[20:23], v[104:111], v3
  s_nop 1
  ds_write_b128 v113, v[52:55]
  s_nop 1
  v_permlane32_swap_b32 v68, v70
  v_permlane32_swap_b32 v69, v71
  v_add_f32 v56, v68, v70
  v_add_f32 v58, v69, v71
  v_permlane32_swap_b32 v72, v74
  v_permlane32_swap_b32 v73, v75
  v_add_f32 v57, v72, v74
  v_add_f32 v59, v73, v75
  ds_write_b128 v2, v[56:59] offset:1024
  v_cmp_u_f32 vcc, v57, v59
  v_mov_b32 v68, 0
  v_mov_b32 v69, 0
  v_mov_b32 v70, 0
  v_mov_b32 v71, 0
  s_cbranch_vccnz cB_sc1_retry
cB_sc1_cont:
  s_add_u32 s24, s24, 28672
  s_add_u32 s26, s26, 28672
  buffer_load_dwordx4 v[80:83], v117, s[8:11], s24 offen offset:0 sc1
  buffer_load_dwordx4 v[84:87], v117, s[8:11], s24 offen offset:1024 sc1
  v_mov_b32 v72, 0
  v_mov_b32 v73, 0
  v_mfma_f32_32x32x16_bf16 v[36:51], v[68:71], v[68:71], 0
  s_waitcnt lgkmcnt(0)
  s_barrier
  ds_read_b64 v[8:9], v114 offset:0
  ds_read_b64 v[10:11], v114 offset:1024
  ds_read_b64 v[12:13], v114 offset:2048
  ds_read_b64 v[14:15], v114 offset:3072
  ds_read2_b32 v[16:17], v115 offset0:0 offset1:64
  ds_read2_b32 v[18:19], v115 offset0:128 offset1:192
  v_mfma_f32_32x32x16_bf16 v[52:67], v[68:71], v[68:71], 0
  s_waitcnt lgkmcnt(0)
  v_pk_add_f32 v[16:17], v[16:17], v[18:19]
  v_pk_add_f32 v[8:9], v[8:9], v[10:11]
  v_pk_add_f32 v[12:13], v[12:13], v[14:15]
  v_add_f32 v20, v16, v17
  v_pk_add_f32 v[8:9], v[8:9], v[12:13]
  v_max_f32 v22, v8, v9
  v_add_f32_dpp v20, v20, v20 row_ror:8 row_mask:0xf bank_mask:0xf
  s_nop 0
  v_max_f32_dpp v22, v22, v22 row_ror:8 row_mask:0xf bank_mask:0xf
  v_max_f32 v22, v22, v20
  buffer_store_dword v112, v116, s[8:11], 0 offen sc1
  s_nop 0
  v_max_f32_dpp v22, v22, v22 quad_perm:[1,0,3,2] row_mask:0xf bank_mask:0xf
  s_nop 1
  v_max_f32_dpp v22, v22, v22 quad_perm:[2,3,0,1] row_mask:0xf bank_mask:0xf
  s_nop 1
  v_max_f32_dpp v22, v22, v22 row_half_mirror row_mask:0xf bank_mask:0xf
  v_pk_add_f32 v[8:9], v[8:9], v[22:23] op_sel_hi:[1,0] neg_lo:[0,1] neg_hi:[0,1]
  v_sub_f32 v20, v20, v22
  v_exp_f32 v8, v8
  v_exp_f32 v9, v9
  v_exp_f32 v20, v20
  v_add_f32 v24, v8, v9
  v_fmac_f32 v24, 0.5, v20
  v_mov_b32_dpp v21, v20 quad_perm:[1,0,3,2] row_mask:0xf bank_mask:0xf
  s_nop 0
  v_add_f32_dpp v24, v24, v24 quad_perm:[1,0,3,2] row_mask:0xf bank_mask:0xf
  s_nop 1
  v_add_f32_dpp v24, v24, v24 quad_perm:[2,3,0,1] row_mask:0xf bank_mask:0xf
  s_nop 1
  v_add_f32_dpp v24, v24, v24 row_half_mirror row_mask:0xf bank_mask:0xf
  s_nop 1
  v_add_f32_dpp v24, v24, v24 row_ror:8 row_mask:0xf bank_mask:0xf
  v_rcp_f32 v24, v24
  s_nop 0
  v_pk_mul_f32 v[8:9], v[8:9], v[24:25] op_sel_hi:[1,0]
  v_pk_mul_f32 v[20:21], v[20:21], v[24:25] op_sel_hi:[1,0]
  v_cvt_pk_bf16_f32 v8, v8, v9
  v_cvt_pk_bf16_f32 v20, v20, v21
  v_min_u32 v8, -2, v8
  buffer_store_dword v8, v1, s[8:11], s20 offen sc1
  v_min_u32 v20, -2, v20
  buffer_store_dword v20, v118, s[8:11], s20 offen sc1
  v_mov_b32 v74, 0
  v_mov_b32 v75, 0
  s_mov_b32 s19, s18
  s_add_u32 s18, s18, 1
  s_mov_b32 s22, s20
  s_mov_b32 s20, s21
  s_mov_b32 s21, s22
  s_add_u32 s23, s20, 4096
  v_mov_b32 v112, s18
  s_cmp_lt_u32 s19, 63
  s_nop 0
  s_cbranch_scc1 cB_sc1_loop
  s_branch cB_done
cB_sc1_r0:
  s_add_u32 s31, s31, 1
  buffer_load_dwordx4 v[8:11], v2, s[8:11], s20 offen offset:0 sc1
  s_waitcnt vmcnt(0)
  v_cmp_eq_u32 vcc, -1, v8
  v_mov_b32 v36, 0
  v_mov_b32 v37, 0
  v_mov_b32 v38, 0
  v_mov_b32 v39, 0
  v_mov_b32 v40, 0
  v_mov_b32 v41, 0
  v_mov_b32 v42, 0
  v_mov_b32 v43, 0
  v_mov_b32 v44, 0
  v_mov_b32 v45, 0
  v_mov_b32 v46, 0
  v_mov_b32 v47, 0
  v_mov_b32 v48, 0
  v_mov_b32 v49, 0
  v_mov_b32 v50, 0
  v_mov_b32 v51, 0
  s_nop 1
  s_cbranch_vccz cB_sc1_go
  s_add_u32 s30, s30, 1
  s_cmp_lt_u32 s30, 400000
  s_cbranch_scc1 cB_sc1_r0
  s_branch cB_abort
cB_sc1_r1:
  s_add_u32 s31, s31, 1
  buffer_load_dwordx4 v[12:15], v2, s[8:11], s20 offen offset:1024 sc1
  s_waitcnt vmcnt(0)
  v_cmp_eq_u32 vcc, -1, v12
  s_nop 4
  s_cbranch_vccz cB_sc1_c1
  s_add_u32 s30, s30, 1
  s_cmp_lt_u32 s30, 400000
  s_cbranch_scc1 cB_sc1_r1
  s_branch cB_abort
cB_sc1_r2:
  s_add_u32 s31, s31, 1
  buffer_load_dwordx4 v[16:19], v2, s[8:11], s20 offen offset:2048 sc1
  s_waitcnt vmcnt(0)
  v_cmp_eq_u32 vcc, -1, v16
  s_nop 4
  s_cbranch_vccz cB_sc1_c2
  s_add_u32 s30, s30, 1
  s_cmp_lt_u32 s30, 400000
  s_cbranch_scc1 cB_sc1_r2
  s_branch cB_abort
cB_sc1_r3:
  s_add_u32 s31, s31, 1
  buffer_load_dwordx4 v[20:23], v2, s[8:11], s20 offen offset:3072 sc1
  s_waitcnt vmcnt(0)
  v_cmp_eq_u32 vcc, -1, v20
  s_nop 4
  s_cbranch_vccz cB_sc1_c3
  s_add_u32 s30, s30, 1
  s_cmp_lt_u32 s30, 400000
  s_cbranch_scc1 cB_sc1_r3
  s_branch cB_abort
cB_sc1_r4:
  s_add_u32 s31, s31, 1
  buffer_load_dwordx4 v[28:31], v2, s[8:11], s23 offen offset:0 sc1
  buffer_load_dwordx4 v[24:27], v2, s[8:11], s23 offen offset:1024 sc1
  buffer_load_dwordx4 v[32:35], v2, s[8:11], s23 offen offset:2048 sc1
  s_waitcnt vmcnt(0)
  v_max3_u32 v66, v24, v27, v28
  v_max3_u32 v66, v66, v31, v32
  v_max_u32 v66, v66, v35
  v_cmp_eq_u32 vcc, -1, v66
  s_nop 4
  s_cbranch_vccz cB_sc1_c4
  s_add_u32 s30, s30, 1
  s_cmp_lt_u32 s30, 400000
  s_cbranch_scc1 cB_sc1_r4
  s_branch cB_abort
cB_sc1_retry:
  s_cmp_lg_u32 s62, 0
  s_cbranch_scc1 cB_sc1_cont
  s_waitcnt vmcnt(0) lgkmcnt(0)
cB_sc1_rv:
  buffer_load_dwordx4 v[8:11], v2, s[8:11], s20 offen offset:0 sc1
  buffer_load_dwordx4 v[12:15], v2, s[8:11], s20 offen offset:1024 sc1
  buffer_load_dwordx4 v[16:19], v2, s[8:11], s20 offen offset:2048 sc1
  buffer_load_dwordx4 v[20:23], v2, s[8:11], s20 offen offset:3072 sc1
  buffer_load_dwordx4 v[28:31], v2, s[8:11], s23 offen offset:0 sc1
  buffer_load_dwordx4 v[24:27], v2, s[8:11], s23 offen offset:1024 sc1
  buffer_load_dwordx4 v[32:35], v2, s[8:11], s23 offen offset:2048 sc1
  s_waitcnt vmcnt(0)
  v_pk_max_u16 v66, v8, v9
  v_pk_max_u16 v66, v66, v10
  v_pk_max_u16 v66, v66, v11
  v_pk_max_u16 v66, v66, v12
  v_pk_max_u16 v66, v66, v13
  v_pk_max_u16 v66, v66, v14
  v_pk_max_u16 v66, v66, v15
  v_pk_max_u16 v66, v66, v16
  v_pk_max_u16 v66, v66, v17
  v_pk_max_u16 v66, v66, v18
  v_pk_max_u16 v66, v66, v19
  v_pk_max_u16 v66, v66, v20
  v_pk_max_u16 v66, v66, v21
  v_pk_max_u16 v66, v66, v22
  v_pk_max_u16 v66, v66, v23
  v_pk_max_u16 v66, v66, v24
  v_pk_max_u16 v66, v66, v25
  v_pk_max_u16 v66, v66, v26
  v_pk_max_u16 v66, v66, v27
  v_pk_max_u16 v66, v66, v28
  v_pk_max_u16 v66, v66, v29
  v_pk_max_u16 v66, v66, v30
  v_pk_max_u16 v66, v66, v31
  v_pk_max_u16 v66, v66, v32
  v_pk_max_u16 v66, v66, v33
  v_pk_max_u16 v66, v66, v34
  v_pk_max_u16 v66, v66, v35
  v_lshlrev_b32 v67, 16, v66
  v_max_u32 v66, v66, v67
  v_cmp_le_u32 vcc, 0xffff0000, v66
  s_cbranch_vccz cB_sc1_rk
  s_add_u32 s30, s30, 1
  s_cmp_lt_u32 s30, 400000
  s_cbranch_scc1 cB_sc1_rv
  s_branch cB_abort
cB_sc1_rk:
  s_mov_b32 s62, 1
  v_mov_b32 v36, 0
  v_mov_b32 v37, 0
  v_mov_b32 v38, 0
  v_mov_b32 v39, 0
  v_mov_b32 v40, 0
  v_mov_b32 v41, 0
  v_mov_b32 v42, 0
  v_mov_b32 v43, 0
  v_mov_b32 v44, 0
  v_mov_b32 v45, 0
  v_mov_b32 v46, 0
  v_mov_b32 v47, 0
  v_mov_b32 v48, 0
  v_mov_b32 v49, 0
  v_mov_b32 v50, 0
  v_mov_b32 v51, 0
  v_mov_b32 v60, 0
  v_mov_b32 v61, 0
  v_mov_b32 v62, 0
  v_mov_b32 v63, 0
  v_mov_b32 v68, 0
  v_mov_b32 v69, 0
  v_mov_b32 v70, 0
  v_mov_b32 v71, 0
  v_mov_b32 v72, 0
  v_mov_b32 v73, 0
  v_mov_b32 v74, 0
  v_mov_b32 v75, 0
  v_mov_b32 v52, 0
  v_mov_b32 v53, 0
  v_mov_b32 v54, 0
  v_mov_b32 v55, 0
  v_mov_b32 v56, 0
  v_mov_b32 v57, 0
  v_mov_b32 v58, 0
  v_mov_b32 v59, 0
  s_add_u32 s31, s31, 0x100
  s_nop 0
  s_branch cB_sc1_go
.p2align 6
cB_sc2_loop:
  s_mov_b32 s30, 0
  s_mov_b32 s62, 0
  s_setprio 3
  s_barrier
  buffer_load_dwordx4 v[8:11], v2, s[8:11], s20 offen offset:0 sc1
  s_setprio 2
  buffer_load_dwordx4 v[12:15], v2, s[8:11], s20 offen offset:1024 sc1
  s_setprio 1
  buffer_load_dwordx4 v[16:19], v2, s[8:11], s20 offen offset:2048 sc1
  s_setprio 0
  buffer_load_dwordx4 v[20:23], v2, s[8:11], s20 offen offset:3072 sc1
cB_sc2_go:
  s_waitcnt vmcnt(3)
  v_smfmac_f32_16x16x64_bf16 v[36:39], v[8:11], a[0:7], v3
  buffer_load_dwordx4 v[24:27], v2, s[8:11], s23 offen offset:0 sc1
  v_cmp_eq_u32 vcc, -1, v8
  v_smfmac_f32_16x16x64_bf16 v[40:43], v[8:11], a[56:63], v3
  v_smfmac_f32_16x16x64_bf16 v[44:47], v[8:11], a[112:119], v3
  buffer_load_dwordx4 v[32:35], v2, s[8:11], s23 offen offset:1024 sc1
  s_cbranch_vccnz cB_sc2_r0
  v_smfmac_f32_16x16x64_bf16 v[48:51], v[8:11], a[168:175], v3
  v_smfmac_f32_16x16x64_bf16 v[52:55], v[8:11], a[224:231], v3
  s_waitcnt vmcnt(4)
  v_cmp_eq_u32 vcc, -1, v12
  v_smfmac_f32_16x16x64_bf16 v[56:59], v[8:11], v[144:151], v3
  buffer_load_dwordx4 v[28:31], v2, s[8:11], s23 offen offset:2048 sc1
  v_smfmac_f32_16x16x64_bf16 v[62:65], v[8:11], v[200:207], v3
  s_cbranch_vccnz cB_sc2_r1
cB_sc2_c1:
  v_smfmac_f32_16x16x64_bf16 v[36:39], v[12:15], a[8:15], v3
  v_smfmac_f32_16x16x64_bf16 v[40:43], v[12:15], a[64:71], v3
  v_smfmac_f32_16x16x64_bf16 v[44:47], v[12:15], a[120:127], v3
  v_smfmac_f32_16x16x64_bf16 v[48:51], v[12:15], a[176:183], v3
  v_smfmac_f32_16x16x64_bf16 v[52:55], v[12:15], a[232:239], v3
  s_waitcnt vmcnt(4)
  v_cmp_eq_u32 vcc, -1, v16
  v_smfmac_f32_16x16x64_bf16 v[56:59], v[12:15], v[152:159], v3
  buffer_load_dwordx4 v[88:91], v117, s[8:11], s26 offen offset:0 sc1
  v_smfmac_f32_16x16x64_bf16 v[62:65], v[12:15], v[208:215], v3
  s_cbranch_vccnz cB_sc2_r2
cB_sc2_c2:
  v_smfmac_f32_16x16x64_bf16 v[36:39], v[16:19], a[16:23], v3
  v_smfmac_f32_16x16x64_bf16 v[40:43], v[16:19], a[72:79], v3
  v_smfmac_f32_16x16x64_bf16 v[44:47], v[16:19], a[128:135], v3
  buffer_load_dwordx4 v[92:95], v117, s[8:11], s26 offen offset:1024 sc1
  v_smfmac_f32_16x16x64_bf16 v[48:51], v[16:19], a[184:191], v3
  v_smfmac_f32_16x16x64_bf16 v[52:55], v[16:19], a[240:247], v3
  s_waitcnt vmcnt(5)
  v_cmp_eq_u32 vcc, -1, v20
  v_smfmac_f32_16x16x64_bf16 v[56:59], v[16:19], v[160:167], v3
  v_smfmac_f32_16x16x64_bf16 v[62:65], v[16:19], v[216:223], v3
  buffer_load_dwordx4 v[96:99], v2, s[8:11], s24 offen offset:0 sc1
  s_cbranch_vccnz cB_sc2_r3
cB_sc2_c3:
  v_smfmac_f32_16x16x64_bf16 v[36:39], v[20:23], a[24:31], v3
  v_smfmac_f32_16x16x64_bf16 v[40:43], v[20:23], a[80:87], v3
  s_waitcnt vmcnt(3)
  v_max3_u32 v66, v24, v27, v28
  v_smfmac_f32_16x16x64_bf16 v[44:47], v[20:23], a[136:143], v3
  v_max3_u32 v66, v66, v31, v32
  v_smfmac_f32_16x16x64_bf16 v[48:51], v[20:23], a[192:199], v3
  buffer_load_dwordx4 v[100:103], v2, s[8:11], s24 offen offset:1024 sc1
  v_max_u32 v66, v66, v35
  v_smfmac_f32_16x16x64_bf16 v[52:55], v[20:23], a[248:255], v3
  v_cmp_eq_u32 vcc, -1, v66
  v_smfmac_f32_16x16x64_bf16 v[56:59], v[20:23], v[168:175], v3
  v_smfmac_f32_16x16x64_bf16 v[62:65], v[20:23], v[224:231], v3
  s_cbranch_vccnz cB_sc2_r4
cB_sc2_c4:
  v_smfmac_f32_16x16x64_bf16 v[62:65], v[24:27], v[232:239], v3
  buffer_load_dwordx4 v[104:107], v2, s[8:11], s26 offen offset:0 sc1
  v_smfmac_f32_16x16x64_bf16 v[62:65], v[32:35], v[240:247], v3
  v_smfmac_f32_16x16x64_bf16 v[62:65], v[28:31], v[248:255], v3
  v_smfmac_f32_16x16x64_bf16 v[52:55], v[24:27], v[120:127], v3
  v_smfmac_f32_16x16x64_bf16 v[52:55], v[32:35], v[128:135], v3
  buffer_load_dwordx4 v[108:111], v2, s[8:11], s26 offen offset:1024 sc1
  v_smfmac_f32_16x16x64_bf16 v[52:55], v[28:31], v[136:143], v3
  v_cvt_pk_bf16_f32 v62, v62, v63
  v_smfmac_f32_16x16x64_bf16 v[56:59], v[24:27], v[176:183], v3
  v_cvt_pk_bf16_f32 v63, v64, v65
  v_smfmac_f32_16x16x64_bf16 v[56:59], v[32:35], v[184:191], v3
  v_mfma_f32_16x16x32_bf16 v[8:11], v[60:63], v[4:7], 0
  v_cvt_pk_bf16_f32 v55, v54, v55
  v_smfmac_f32_16x16x64_bf16 v[56:59], v[28:31], v[192:199], v3
  v_cvt_pk_bf16_f32 v54, v52, v53
  v_smfmac_f32_16x16x64_bf16 v[36:39], v[24:27], a[32:39], v3
  s_nop 1
  v_cvt_pk_bf16_f32 v76, v8, v9
  v_smfmac_f32_16x16x64_bf16 v[36:39], v[32:35], a[40:47], v3
  v_cvt_pk_bf16_f32 v77, v10, v11
  v_smfmac_f32_16x16x64_bf16 v[36:39], v[28:31], a[48:55], v3
  v_cvt_pk_bf16_f32 v56, v56, v57
  v_smfmac_f32_16x16x64_bf16 v[40:43], v[24:27], a[88:95], v3
  v_cvt_pk_bf16_f32 v57, v58, v59
  v_smfmac_f32_16x16x64_bf16 v[40:43], v[32:35], a[96:103], v3
  v_mfma_f32_16x16x32_bf16 v[12:15], v[54:57], v[4:7], 0
  v_cvt_pk_bf16_f32 v39, v38, v39
  v_smfmac_f32_16x16x64_bf16 v[40:43], v[28:31], a[104:111], v3
  v_cvt_pk_bf16_f32 v38, v36, v37
  v_smfmac_f32_16x16x64_bf16 v[44:47], v[24:27], a[144:151], v3
  s_nop 1
  v_cvt_pk_bf16_f32 v78, v12, v13
  v_smfmac_f32_16x16x64_bf16 v[44:47], v[32:35], a[152:159], v3
  v_cvt_pk_bf16_f32 v79, v14, v15
  v_smfmac_f32_16x16x64_bf16 v[44:47], v[28:31], a[160:167], v3
  v_cvt_pk_bf16_f32 v40, v40, v41
  v_smfmac_f32_16x16x64_bf16 v[48:51], v[24:27], a[200:207], v3
  v_cvt_pk_bf16_f32 v41, v42, v43
  v_smfmac_f32_16x16x64_bf16 v[48:51], v[32:35], a[208:215], v3
  v_smfmac_f32_16x16x64_bf16 v[48:51], v[28:31], a[216:223], v3
  s_waitcnt vmcnt(4)
  v_cvt_pk_bf16_f32 v47, v46, v47
  v_smfmac_f32_16x16x64_bf16 v[68:71], v[76:79], v[80:87], v3
  v_cvt_pk_bf16_f32 v46, v44, v45
  v_mfma_f32_16x16x32_bf16 v[8:11], v[38:41], v[4:7], 0
  s_nop 1
  v_cvt_pk_bf16_f32 v48, v48, v49
  v_cvt_pk_bf16_f32 v49, v50, v51
  s_nop 1
  v_mfma_f32_16x16x32_bf16 v[12:15], v[46:49], v[4:7], 0
  v_smfmac_f32_16x16x64_bf16 v[72:75], v[76:79], v[88:95], v3
  v_cvt_pk_bf16_f32 v20, v8, v9
  v_mfma_f32_16x16x32_bf16 v[52:55], v[30:33], v[76:79], 0
  s_waitcnt vmcnt(0)
  v_cvt_pk_bf16_f32 v21, v10, v11
  v_cvt_pk_bf16_f32 v22, v12, v13
  v_cvt_pk_bf16_f32 v23, v14, v15
  s_nop 1
  v_mfma_f32_16x16x32_bf16 v[52:55], v[16:19], v[20:23], v[52:55]
  v_smfmac_f32_16x16x64_bf16 v[68:71], v[20:23], v[96:103], v3
  v_smfmac_f32_16x16x64_bf16 v[72:75], v[20:23], v[104:111], v3
  s_nop 1
  ds_write_b128 v113, v[52:55]
  s_nop 1
  v_permlane32_swap_b32 v68, v70
  v_permlane32_swap_b32 v69, v71
  v_add_f32 v56, v68, v70
  v_add_f32 v58, v69, v71
  v_permlane32_swap_b32 v72, v74
  v_permlane32_swap_b32 v73, v75
  v_add_f32 v57, v72, v74
  v_add_f32 v59, v73, v75
  ds_write_b128 v2, v[56:59] offset:2048
  v_cmp_u_f32 vcc, v57, v59
  v_mov_b32 v68, 0
  v_mov_b32 v69, 0
  v_mov_b32 v70, 0
  v_mov_b32 v71, 0
  s_cbranch_vccnz cB_sc2_retry
cB_sc2_cont:
  s_add_u32 s24, s24, 28672
  s_add_u32 s26, s26, 28672
  buffer_load_dwordx4 v[80:83], v117, s[8:11], s24 offen offset:0 sc1
  buffer_load_dwordx4 v[84:87], v117, s[8:11], s24 offen offset:1024 sc1
  v_mov_b32 v72, 0
  v_mov_b32 v73, 0
  v_mfma_f32_32x32x16_bf16 v[36:51], v[68:71], v[68:71], 0
  s_waitcnt lgkmcnt(0)
  s_barrier
  v_mfma_f32_32x32x16_bf16 v[52:67], v[68:71], v[68:71], 0
  buffer_store_dwordx2 v[118:119], v114, s[8:11], s21 offen sc1
  buffer_store_dwordx2 v[118:119], v115, s[8:11], s21 offen sc1
  s_buffer_load_dword s70, s[8:11], s35
  s_add_u32 s22, s24, 114688
  s_buffer_load_dword s71, s[8:11], s22
  s_mul_i32 s22, s18, 7168
  s_add_u32 s22, s22, 88024064
  s_buffer_load_dword s72, s[8:11], s22
  s_add_u32 s35, s35, 458752
  v_mov_b32 v74, 0
  v_mov_b32 v75, 0
  s_mov_b32 s19, s18
  s_add_u32 s18, s18, 1
  s_mov_b32 s22, s20
  s_mov_b32 s20, s21
  s_mov_b32 s21, s22
  s_add_u32 s23, s20, 4096
  s_cmp_lt_u32 s19, 63
  s_cbranch_scc1 cB_sc2_loop
  s_branch cB_done
cB_sc2_r0:
  s_add_u32 s31, s31, 1
  buffer_load_dwordx4 v[8:11], v2, s[8:11], s20 offen offset:0 sc1
  s_waitcnt vmcnt(0)
  v_cmp_eq_u32 vcc, -1, v8
  v_mov_b32 v36, 0
  v_mov_b32 v37, 0
  v_mov_b32 v38, 0
  v_mov_b32 v39, 0
  v_mov_b32 v40, 0
  v_mov_b32 v41, 0
  v_mov_b32 v42, 0
  v_mov_b32 v43, 0
  v_mov_b32 v44, 0
  v_mov_b32 v45, 0
  v_mov_b32 v46, 0
  v_mov_b32 v47, 0
  v_mov_b32 v48, 0
  v_mov_b32 v49, 0
  v_mov_b32 v50, 0
  v_mov_b32 v51, 0
  s_nop 1
  s_cbranch_vccz cB_sc2_go
  s_add_u32 s30, s30, 1
  s_cmp_lt_u32 s30, 400000
  s_cbranch_scc1 cB_sc2_r0
  s_branch cB_abort
cB_sc2_r1:
  s_add_u32 s31, s31, 1
  buffer_load_dwordx4 v[12:15], v2, s[8:11], s20 offen offset:1024 sc1
  s_waitcnt vmcnt(0)
  v_cmp_eq_u32 vcc, -1, v12
  s_nop 4
  s_cbranch_vccz cB_sc2_c1
  s_add_u32 s30, s30, 1
  s_cmp_lt_u32 s30, 400000
  s_cbranch_scc1 cB_sc2_r1
  s_branch cB_abort
cB_sc2_r2:
  s_add_u32 s31, s31, 1
  buffer_load_dwordx4 v[16:19], v2, s[8:11], s20 offen offset:2048 sc1
  s_waitcnt vmcnt(0)
  v_cmp_eq_u32 vcc, -1, v16
  s_nop 4
  s_cbranch_vccz cB_sc2_c2
  s_add_u32 s30, s30, 1
  s_cmp_lt_u32 s30, 400000
  s_cbranch_scc1 cB_sc2_r2
  s_branch cB_abort
cB_sc2_r3:
  s_add_u32 s31, s31, 1
  buffer_load_dwordx4 v[20:23], v2, s[8:11], s20 offen offset:3072 sc1
  s_waitcnt vmcnt(0)
  v_cmp_eq_u32 vcc, -1, v20
  s_nop 4
  s_cbranch_vccz cB_sc2_c3
  s_add_u32 s30, s30, 1
  s_cmp_lt_u32 s30, 400000
  s_cbranch_scc1 cB_sc2_r3
  s_branch cB_abort
cB_sc2_r4:
  s_add_u32 s31, s31, 1
  buffer_load_dwordx4 v[24:27], v2, s[8:11], s23 offen offset:0 sc1
  buffer_load_dwordx4 v[32:35], v2, s[8:11], s23 offen offset:1024 sc1
  buffer_load_dwordx4 v[28:31], v2, s[8:11], s23 offen offset:2048 sc1
  s_waitcnt vmcnt(0)
  v_max3_u32 v66, v24, v27, v28
  v_max3_u32 v66, v66, v31, v32
  v_max_u32 v66, v66, v35
  v_cmp_eq_u32 vcc, -1, v66
  s_nop 4
  s_cbranch_vccz cB_sc2_c4
  s_add_u32 s30, s30, 1
  s_cmp_lt_u32 s30, 400000
  s_cbranch_scc1 cB_sc2_r4
  s_branch cB_abort
cB_sc2_retry:
  s_cmp_lg_u32 s62, 0
  s_cbranch_scc1 cB_sc2_cont
  s_waitcnt vmcnt(0) lgkmcnt(0)
cB_sc2_rv:
  buffer_load_dwordx4 v[8:11], v2, s[8:11], s20 offen offset:0 sc1
  buffer_load_dwordx4 v[12:15], v2, s[8:11], s20 offen offset:1024 sc1
  buffer_load_dwordx4 v[16:19], v2, s[8:11], s20 offen offset:2048 sc1
  buffer_load_dwordx4 v[20:23], v2, s[8:11], s20 offen offset:3072 sc1
  buffer_load_dwordx4 v[24:27], v2, s[8:11], s23 offen offset:0 sc1
  buffer_load_dwordx4 v[32:35], v2, s[8:11], s23 offen offset:1024 sc1
  buffer_load_dwordx4 v[28:31], v2, s[8:11], s23 offen offset:2048 sc1
  s_waitcnt vmcnt(0)
  v_pk_max_u16 v66, v8, v9
  v_pk_max_u16 v66, v66, v10
  v_pk_max_u16 v66, v66, v11
  v_pk_max_u16 v66, v66, v12
  v_pk_max_u16 v66, v66, v13
  v_pk_max_u16 v66, v66, v14
  v_pk_max_u16 v66, v66, v15
  v_pk_max_u16 v66, v66, v16
  v_pk_max_u16 v66, v66, v17
  v_pk_max_u16 v66, v66, v18
  v_pk_max_u16 v66, v66, v19
  v_pk_max_u16 v66, v66, v20
  v_pk_max_u16 v66, v66, v21
  v_pk_max_u16 v66, v66, v22
  v_pk_max_u16 v66, v66, v23
  v_pk_max_u16 v66, v66, v24
  v_pk_max_u16 v66, v66, v25
  v_pk_max_u16 v66, v66, v26
  v_pk_max_u16 v66, v66, v27
  v_pk_max_u16 v66, v66, v28
  v_pk_max_u16 v66, v66, v29
  v_pk_max_u16 v66, v66, v30
  v_pk_max_u16 v66, v66, v31
  v_pk_max_u16 v66, v66, v32
  v_pk_max_u16 v66, v66, v33
  v_pk_max_u16 v66, v66, v34
  v_pk_max_u16 v66, v66, v35
  v_lshlrev_b32 v67, 16, v66
  v_max_u32 v66, v66, v67
  v_cmp_le_u32 vcc, 0xffff0000, v66
  s_cbranch_vccz cB_sc2_rk
  s_add_u32 s30, s30, 1
  s_cmp_lt_u32 s30, 400000
  s_cbranch_scc1 cB_sc2_rv
  s_branch cB_abort
cB_sc2_rk:
  s_mov_b32 s62, 1
  v_mov_b32 v36, 0
  v_mov_b32 v37, 0
  v_mov_b32 v38, 0
  v_mov_b32 v39, 0
  v_mov_b32 v40, 0
  v_mov_b32 v41, 0
  v_mov_b32 v42, 0
  v_mov_b32 v43, 0
  v_mov_b32 v44, 0
  v_mov_b32 v45, 0
  v_mov_b32 v46, 0
  v_mov_b32 v47, 0
  v_mov_b32 v48, 0
  v_mov_b32 v49, 0
  v_mov_b32 v50, 0
  v_mov_b32 v51, 0
  v_mov_b32 v62, 0
  v_mov_b32 v63, 0
  v_mov_b32 v64, 0
  v_mov_b32 v65, 0
  v_mov_b32 v68, 0
  v_mov_b32 v69, 0
  v_mov_b32 v70, 0
  v_mov_b32 v71, 0
  v_mov_b32 v72, 0
  v_mov_b32 v73, 0
  v_mov_b32 v74, 0
  v_mov_b32 v75, 0
  v_mov_b32 v52, 0
  v_mov_b32 v53, 0
  v_mov_b32 v54, 0
  v_mov_b32 v55, 0
  v_mov_b32 v56, 0
  v_mov_b32 v57, 0
  v_mov_b32 v58, 0
  v_mov_b32 v59, 0
  s_add_u32 s31, s31, 0x100
  s_nop 0
  s_branch cB_sc2_go
.p2align 6
cB_sc3_loop:
  s_mov_b32 s30, 0
  s_mov_b32 s62, 0
  s_setprio 3
  s_barrier
  buffer_load_dwordx4 v[8:11], v2, s[8:11], s20 offen offset:0 sc1
  s_setprio 2
  buffer_load_dwordx4 v[12:15], v2, s[8:11], s20 offen offset:1024 sc1
  s_setprio 1
  buffer_load_dwordx4 v[16:19], v2, s[8:11], s20 offen offset:2048 sc1
  s_setprio 0
  buffer_load_dwordx4 v[20:23], v2, s[8:11], s20 offen offset:3072 sc1
cB_sc3_go:
  s_waitcnt vmcnt(3)
  v_smfmac_f32_16x16x64_bf16 v[36:39], v[8:11], a[0:7], v3
  buffer_load_dwordx4 v[24:27], v2, s[8:11], s23 offen offset:0 sc1
  v_cmp_eq_u32 vcc, -1, v8
  v_smfmac_f32_16x16x64_bf16 v[40:43], v[8:11], a[56:63], v3
  v_smfmac_f32_16x16x64_bf16 v[44:47], v[8:11], a[112:119], v3
  buffer_load_dwordx4 v[28:31], v2, s[8:11], s23 offen offset:1024 sc1
  s_cbranch_vccnz cB_sc3_r0
  v_smfmac_f32_16x16x64_bf16 v[48:51], v[8:11], a[168:175], v3
  v_smfmac_f32_16x16x64_bf16 v[52:55], v[8:11], a[224:231], v3
  s_waitcnt vmcnt(4)
  v_cmp_eq_u32 vcc, -1, v12
  v_smfmac_f32_16x16x64_bf16 v[56:59], v[8:11], v[144:151], v3
  buffer_load_dwordx4 v[32:35], v2, s[8:11], s23 offen offset:2048 sc1
  v_smfmac_f32_16x16x64_bf16 v[62:65], v[8:11], v[200:207], v3
  s_cbranch_vccnz cB_sc3_r1
cB_sc3_c1:
  v_smfmac_f32_16x16x64_bf16 v[36:39], v[12:15], a[8:15], v3
  v_smfmac_f32_16x16x64_bf16 v[40:43], v[12:15], a[64:71], v3
  v_smfmac_f32_16x16x64_bf16 v[44:47], v[12:15], a[120:127], v3
  v_smfmac_f32_16x16x64_bf16 v[48:51], v[12:15], a[176:183], v3
  v_smfmac_f32_16x16x64_bf16 v[52:55], v[12:15], a[232:239], v3
  s_waitcnt vmcnt(4)
  v_cmp_eq_u32 vcc, -1, v16
  v_smfmac_f32_16x16x64_bf16 v[56:59], v[12:15], v[152:159], v3
  buffer_load_dwordx4 v[88:91], v117, s[8:11], s26 offen offset:0 sc1
  v_smfmac_f32_16x16x64_bf16 v[62:65], v[12:15], v[208:215], v3
  s_cbranch_vccnz cB_sc3_r2
cB_sc3_c2:
  v_smfmac_f32_16x16x64_bf16 v[36:39], v[16:19], a[16:23], v3
  v_smfmac_f32_16x16x64_bf16 v[40:43], v[16:19], a[72:79], v3
  v_smfmac_f32_16x16x64_bf16 v[44:47], v[16:19], a[128:135], v3
  buffer_load_dwordx4 v[92:95], v117, s[8:11], s26 offen offset:1024 sc1
  v_smfmac_f32_16x16x64_bf16 v[48:51], v[16:19], a[184:191], v3
  v_smfmac_f32_16x16x64_bf16 v[52:55], v[16:19], a[240:247], v3
  s_waitcnt vmcnt(5)
  v_cmp_eq_u32 vcc, -1, v20
  v_smfmac_f32_16x16x64_bf16 v[56:59], v[16:19], v[160:167], v3
  v_smfmac_f32_16x16x64_bf16 v[62:65], v[16:19], v[216:223], v3
  buffer_load_dwordx4 v[96:99], v2, s[8:11], s24 offen offset:0 sc1
  s_cbranch_vccnz cB_sc3_r3
cB_sc3_c3:
  v_smfmac_f32_16x16x64_bf16 v[36:39], v[20:23], a[24:31], v3
  v_smfmac_f32_16x16x64_bf16 v[40:43], v[20:23], a[80:87], v3
  s_waitcnt vmcnt(3)
  v_max3_u32 v66, v24, v27, v28
  v_smfmac_f32_16x16x64_bf16 v[44:47], v[20:23], a[136:143], v3
  v_max3_u32 v66, v66, v31, v32
  v_smfmac_f32_16x16x64_bf16 v[48:51], v[20:23], a[192:199], v3
  buffer_load_dwordx4 v[100:103], v2, s[8:11], s24 offen offset:1024 sc1
  v_max_u32 v66, v66, v35
  v_smfmac_f32_16x16x64_bf16 v[52:55], v[20:23], a[248:255], v3
  v_cmp_eq_u32 vcc, -1, v66
  v_smfmac_f32_16x16x64_bf16 v[56:59], v[20:23], v[168:175], v3
  v_smfmac_f32_16x16x64_bf16 v[62:65], v[20:23], v[224:231], v3
  s_cbranch_vccnz cB_sc3_r4
cB_sc3_c4:
  v_smfmac_f32_16x16x64_bf16 v[62:65], v[24:27], v[232:239], v3
  buffer_load_dwordx4 v[104:107], v2, s[8:11], s26 offen offset:0 sc1
  v_smfmac_f32_16x16x64_bf16 v[62:65], v[28:31], v[240:247], v3
  v_smfmac_f32_16x16x64_bf16 v[62:65], v[32:35], v[248:255], v3
  v_smfmac_f32_16x16x64_bf16 v[52:55], v[24:27], v[120:127], v3
  v_smfmac_f32_16x16x64_bf16 v[52:55], v[28:31], v[128:135], v3
  buffer_load_dwordx4 v[108:111], v2, s[8:11], s26 offen offset:1024 sc1
  v_smfmac_f32_16x16x64_bf16 v[52:55], v[32:35], v[136:143], v3
  v_cvt_pk_bf16_f32 v62, v62, v63
  v_smfmac_f32_16x16x64_bf16 v[56:59], v[24:27], v[176:183], v3
  v_cvt_pk_bf16_f32 v63, v64, v65
  v_smfmac_f32_16x16x64_bf16 v[56:59], v[28:31], v[184:191], v3
  v_mfma_f32_16x16x32_bf16 v[8:11], v[60:63], v[4:7], 0
  v_cvt_pk_bf16_f32 v55, v54, v55
  v_smfmac_f32_16x16x64_bf16 v[56:59], v[32:35], v[192:199], v3
  v_cvt_pk_bf16_f32 v54, v52, v53
  v_smfmac_f32_16x16x64_bf16 v[36:39], v[24:27], a[32:39], v3
  s_nop 1
  v_cvt_pk_bf16_f32 v78, v8, v9
  v_smfmac_f32_16x16x64_bf16 v[36:39], v[28:31], a[40:47], v3
  v_cvt_pk_bf16_f32 v79, v10, v11
  v_smfmac_f32_16x16x64_bf16 v[36:39], v[32:35], a[48:55], v3
  v_cvt_pk_bf16_f32 v56, v56, v57
  v_smfmac_f32_16x16x64_bf16 v[40:43], v[24:27], a[88:95], v3
  v_cvt_pk_bf16_f32 v57, v58, v59
  v_smfmac_f32_16x16x64_bf16 v[40:43], v[28:31], a[96:103], v3
  v_mfma_f32_16x16x32_bf16 v[12:15], v[54:57], v[4:7], 0
  v_cvt_pk_bf16_f32 v39, v38, v39
  v_smfmac_f32_16x16x64_bf16 v[40:43], v[32:35], a[104:111], v3
  v_cvt_pk_bf16_f32 v38, v36, v37
  v_smfmac_f32_16x16x64_bf16 v[44:47], v[24:27], a[144:151], v3
  s_nop 1
  v_cvt_pk_bf16_f32 v76, v12, v13
  v_smfmac_f32_16x16x64_bf16 v[44:47], v[28:31], a[152:159], v3
  v_cvt_pk_bf16_f32 v77, v14, v15
  v_smfmac_f32_16x16x64_bf16 v[44:47], v[32:35], a[160:167], v3
  v_cvt_pk_bf16_f32 v40, v40, v41
  v_smfmac_f32_16x16x64_bf16 v[48:51], v[24:27], a[200:207], v3
  v_cvt_pk_bf16_f32 v41, v42, v43
  v_smfmac_f32_16x16x64_bf16 v[48:51], v[28:31], a[208:215], v3
  v_smfmac_f32_16x16x64_bf16 v[48:51], v[32:35], a[216:223], v3
  s_waitcnt vmcnt(4)
  v_cvt_pk_bf16_f32 v47, v46, v47
  v_smfmac_f32_16x16x64_bf16 v[68:71], v[76:79], v[80:87], v3
  v_cvt_pk_bf16_f32 v46, v44, v45
  v_mfma_f32_16x16x32_bf16 v[8:11], v[38:41], v[4:7], 0
  s_nop 1
  v_cvt_pk_bf16_f32 v48, v48, v49
  v_cvt_pk_bf16_f32 v49, v50, v51
  s_nop 1
  v_mfma_f32_16x16x32_bf16 v[12:15], v[46:49], v[4:7], 0
  v_smfmac_f32_16x16x64_bf16 v[72:75], v[76:79], v[88:95], v3
  v_cvt_pk_bf16_f32 v16, v8, v9
  v_mfma_f32_16x16x32_bf16 v[52:55], v[30:33], v[76:79], 0
  s_waitcnt vmcnt(0)
  v_cvt_pk_bf16_f32 v17, v10, v11
  v_cvt_pk_bf16_f32 v18, v12, v13
  v_cvt_pk_bf16_f32 v19, v14, v15
  s_nop 1
  v_mfma_f32_16x16x32_bf16 v[52:55], v[20:23], v[16:19], v[52:55]
  v_smfmac_f32_16x16x64_bf16 v[68:71], v[16:19], v[96:103], v3
  v_smfmac_f32_16x16x64_bf16 v[72:75], v[16:19], v[104:111], v3
  s_nop 1
  ds_write_b128 v113, v[52:55]
  s_nop 1
  v_permlane32_swap_b32 v68, v70
  v_permlane32_swap_b32 v69, v71
  v_add_f32 v56, v68, v70
  v_add_f32 v58, v69, v71
  v_permlane32_swap_b32 v72, v74
  v_permlane32_swap_b32 v73, v75
  v_add_f32 v57, v72, v74
  v_add_f32 v59, v73, v75
  ds_write_b128 v2, v[56:59] offset:3072
  v_cmp_u_f32 vcc, v57, v59
  v_mov_b32 v68, 0
  v_mov_b32 v69, 0
  v_mov_b32 v70, 0
  v_mov_b32 v71, 0
  s_cbranch_vccnz cB_sc3_retry
cB_sc3_cont:
  s_add_u32 s24, s24, 28672
  s_add_u32 s26, s26, 28672
  buffer_load_dwordx4 v[80:83], v117, s[8:11], s24 offen offset:0 sc1
  buffer_load_dwordx4 v[84:87], v117, s[8:11], s24 offen offset:1024 sc1
  v_mov_b32 v72, 0
  v_mov_b32 v73, 0
  v_mfma_f32_16x16x32_bf16 v[62:65], v[68:71], v[68:71], 0
  s_waitcnt lgkmcnt(0)
  s_barrier
  v_mov_b32 v52, 0
  v_mov_b32 v53, 0
  v_mov_b32 v54, 0
  v_mov_b32 v55, 0
  v_mov_b32 v56, 0
  v_mov_b32 v57, 0
  v_mov_b32 v58, 0
  v_mov_b32 v59, 0
  v_mfma_f32_32x32x16_bf16 v[36:51], v[68:71], v[68:71], 0
  v_mov_b32 v74, 0
  v_mov_b32 v75, 0
  s_mov_b32 s19, s18
  s_add_u32 s18, s18, 1
  s_mov_b32 s22, s20
  s_mov_b32 s20, s21
  s_mov_b32 s21, s22
  s_add_u32 s23, s20, 4096
  s_cmp_lt_u32 s19, 63
  s_nop 2
  s_cbranch_scc1 cB_sc3_loop
  s_branch cB_done
cB_sc3_r0:
  s_add_u32 s31, s31, 1
  buffer_load_dwordx4 v[8:11], v2, s[8:11], s20 offen offset:0 sc1
  s_waitcnt vmcnt(0)
  v_cmp_eq_u32 vcc, -1, v8
  v_mov_b32 v36, 0
  v_mov_b32 v37, 0
  v_mov_b32 v38, 0
  v_mov_b32 v39, 0
  v_mov_b32 v40, 0
  v_mov_b32 v41, 0
  v_mov_b32 v42, 0
  v_mov_b32 v43, 0
  v_mov_b32 v44, 0
  v_mov_b32 v45, 0
  v_mov_b32 v46, 0
  v_mov_b32 v47, 0
  v_mov_b32 v48, 0
  v_mov_b32 v49, 0
  v_mov_b32 v50, 0
  v_mov_b32 v51, 0
  s_nop 1
  s_cbranch_vccz cB_sc3_go
  s_add_u32 s30, s30, 1
  s_cmp_lt_u32 s30, 400000
  s_cbranch_scc1 cB_sc3_r0
  s_branch cB_abort
cB_sc3_r1:
  s_add_u32 s31, s31, 1
  buffer_load_dwordx4 v[12:15], v2, s[8:11], s20 offen offset:1024 sc1
  s_waitcnt vmcnt(0)
  v_cmp_eq_u32 vcc, -1, v12
  s_nop 4
  s_cbranch_vccz cB_sc3_c1
  s_add_u32 s30, s30, 1
  s_cmp_lt_u32 s30, 400000
  s_cbranch_scc1 cB_sc3_r1
  s_branch cB_abort
cB_sc3_r2:
  s_add_u32 s31, s31, 1
  buffer_load_dwordx4 v[16:19], v2, s[8:11], s20 offen offset:2048 sc1
  s_waitcnt vmcnt(0)
  v_cmp_eq_u32 vcc, -1, v16
  s_nop 4
  s_cbranch_vccz cB_sc3_c2
  s_add_u32 s30, s30, 1
  s_cmp_lt_u32 s30, 400000
  s_cbranch_scc1 cB_sc3_r2
  s_branch cB_abort
cB_sc3_r3:
  s_add_u32 s31, s31, 1
  buffer_load_dwordx4 v[20:23], v2, s[8:11], s20 offen offset:3072 sc1
  s_waitcnt vmcnt(0)
  v_cmp_eq_u32 vcc, -1, v20
  s_nop 4
  s_cbranch_vccz cB_sc3_c3
  s_add_u32 s30, s30, 1
  s_cmp_lt_u32 s30, 400000
  s_cbranch_scc1 cB_sc3_r3
  s_branch cB_abort
cB_sc3_r4:
  s_add_u32 s31, s31, 1
  buffer_load_dwordx4 v[24:27], v2, s[8:11], s23 offen offset:0 sc1
  buffer_load_dwordx4 v[28:31], v2, s[8:11], s23 offen offset:1024 sc1
  buffer_load_dwordx4 v[32:35], v2, s[8:11], s23 offen offset:2048 sc1
  s_waitcnt vmcnt(0)
  v_max3_u32 v66, v24, v27, v28
  v_max3_u32 v66, v66, v31, v32
  v_max_u32 v66, v66, v35
  v_cmp_eq_u32 vcc, -1, v66
  s_nop 4
  s_cbranch_vccz cB_sc3_c4
  s_add_u32 s30, s30, 1
  s_cmp_lt_u32 s30, 400000
  s_cbranch_scc1 cB_sc3_r4
  s_branch cB_abort
cB_sc3_retry:
  s_cmp_lg_u32 s62, 0
  s_cbranch_scc1 cB_sc3_cont
  s_waitcnt vmcnt(0) lgkmcnt(0)
cB_sc3_rv:
  buffer_load_dwordx4 v[8:11], v2, s[8:11], s20 offen offset:0 sc1
  buffer_load_dwordx4 v[12:15], v2, s[8:11], s20 offen offset:1024 sc1
  buffer_load_dwordx4 v[16:19], v2, s[8:11], s20 offen offset:2048 sc1
  buffer_load_dwordx4 v[20:23], v2, s[8:11], s20 offen offset:3072 sc1
  buffer_load_dwordx4 v[24:27], v2, s[8:11], s23 offen offset:0 sc1
  buffer_load_dwordx4 v[28:31], v2, s[8:11], s23 offen offset:1024 sc1
  buffer_load_dwordx4 v[32:35], v2, s[8:11], s23 offen offset:2048 sc1
  s_waitcnt vmcnt(0)
  v_pk_max_u16 v66, v8, v9
  v_pk_max_u16 v66, v66, v10
  v_pk_max_u16 v66, v66, v11
  v_pk_max_u16 v66, v66, v12
  v_pk_max_u16 v66, v66, v13
  v_pk_max_u16 v66, v66, v14
  v_pk_max_u16 v66, v66, v15
  v_pk_max_u16 v66, v66, v16
  v_pk_max_u16 v66, v66, v17
  v_pk_max_u16 v66, v66, v18
  v_pk_max_u16 v66, v66, v19
  v_pk_max_u16 v66, v66, v20
  v_pk_max_u16 v66, v66, v21
  v_pk_max_u16 v66, v66, v22
  v_pk_max_u16 v66, v66, v23
  v_pk_max_u16 v66, v66, v24
  v_pk_max_u16 v66, v66, v25
  v_pk_max_u16 v66, v66, v26
  v_pk_max_u16 v66, v66, v27
  v_pk_max_u16 v66, v66, v28
  v_pk_max_u16 v66, v66, v29
  v_pk_max_u16 v66, v66, v30
  v_pk_max_u16 v66, v66, v31
  v_pk_max_u16 v66, v66, v32
  v_pk_max_u16 v66, v66, v33
  v_pk_max_u16 v66, v66, v34
  v_pk_max_u16 v66, v66, v35
  v_lshlrev_b32 v67, 16, v66
  v_max_u32 v66, v66, v67
  v_cmp_le_u32 vcc, 0xffff0000, v66
  s_cbranch_vccz cB_sc3_rk
  s_add_u32 s30, s30, 1
  s_cmp_lt_u32 s30, 400000
  s_cbranch_scc1 cB_sc3_rv
  s_branch cB_abort
cB_sc3_rk:
  s_mov_b32 s62, 1
  v_mov_b32 v36, 0
  v_mov_b32 v37, 0
  v_mov_b32 v38, 0
  v_mov_b32 v39, 0
  v_mov_b32 v40, 0
  v_mov_b32 v41, 0
  v_mov_b32 v42, 0
  v_mov_b32 v43, 0
  v_mov_b32 v44, 0
  v_mov_b32 v45, 0
  v_mov_b32 v46, 0
  v_mov_b32 v47, 0
  v_mov_b32 v48, 0
  v_mov_b32 v49, 0
  v_mov_b32 v50, 0
  v_mov_b32 v51, 0
  v_mov_b32 v62, 0
  v_mov_b32 v63, 0
  v_mov_b32 v64, 0
  v_mov_b32 v65, 0
  v_mov_b32 v68, 0
  v_mov_b32 v69, 0
  v_mov_b32 v70, 0
  v_mov_b32 v71, 0
  v_mov_b32 v72, 0
  v_mov_b32 v73, 0
  v_mov_b32 v74, 0
  v_mov_b32 v75, 0
  v_mov_b32 v52, 0
  v_mov_b32 v53, 0
  v_mov_b32 v54, 0
  v_mov_b32 v55, 0
  v_mov_b32 v56, 0
  v_mov_b32 v57, 0
  v_mov_b32 v58, 0
  v_mov_b32 v59, 0
  s_add_u32 s31, s31, 0x100
  s_nop 0
  s_branch cB_sc3_go
.p2align 6
cB_va0_loop:
  s_mov_b32 s30, 0
  s_barrier
  buffer_load_dwordx4 v[24:27], v2, s[8:11], s23 offen offset:0 sc1
  buffer_load_dwordx4 v[28:31], v2, s[8:11], s23 offen offset:1024 sc1
  s_barrier
  buffer_store_dword v160, v1, s[8:11], s38 offen sc1
  s_add_u32 s22, s25, 0
  buffer_load_dwordx4 v[80:83], v6, s[8:11], s22 offen offset:0 sc1
  buffer_load_dwordx4 v[84:87], v6, s[8:11], s22 offen offset:1792 sc1
  s_add_u32 s22, s25, 3584
  buffer_load_dwordx4 v[88:91], v6, s[8:11], s22 offen offset:0 sc1
  buffer_load_dwordx4 v[92:95], v6, s[8:11], s22 offen offset:1792 sc1
  s_add_u32 s22, s25, 7168
  buffer_load_dwordx4 v[96:99], v6, s[8:11], s22 offen offset:0 sc1
  s_mul_i32 s38, s18, 7168
  s_add_u32 s38, s38, 88002560
  s_waitcnt vmcnt(6)
  ds_write_b128 v2, v[24:27] offset:12288
  ds_write_b128 v2, v[28:31] offset:13312
  v_smfmac_f32_16x16x64_bf16 v[36:39], v[24:27], a[32:39], v3
  buffer_load_dwordx4 v[100:103], v6, s[8:11], s22 offen offset:1792 sc1
  v_smfmac_f32_16x16x64_bf16 v[40:43], v[24:27], a[88:95], v3
  s_add_u32 s22, s25, 10752
  buffer_load_dwordx4 v[104:107], v6, s[8:11], s22 offen offset:0 sc1
  v_smfmac_f32_16x16x64_bf16 v[44:47], v[24:27], a[144:151], v3
  buffer_load_dwordx4 v[108:111], v6, s[8:11], s22 offen offset:1792 sc1
  v_smfmac_f32_16x16x64_bf16 v[48:51], v[24:27], a[200:207], v3
  s_add_u32 s22, s25, 14336
  buffer_load_dwordx4 v[112:115], v6, s[8:11], s22 offen offset:0 sc1
  v_smfmac_f32_16x16x64_bf16 v[52:55], v[24:27], v[176:183], v3
  s_waitcnt lgkmcnt(0)
  s_barrier
  ds_read_b128 v[8:11], v2 offset:8192
  ds_read_b128 v[12:15], v2 offset:9216
  ds_read_b128 v[16:19], v2 offset:10240
  ds_read_b128 v[20:23], v2 offset:11264
  ds_read_b128 v[32:35], v2 offset:14336
  buffer_load_dwordx4 v[116:119], v6, s[8:11], s22 offen offset:1792 sc1
  v_smfmac_f32_16x16x64_bf16 v[56:59], v[24:27], v[232:239], v3
  s_add_u32 s22, s25, 17920
  buffer_load_dwordx4 v[120:123], v6, s[8:11], s22 offen offset:0 sc1
  v_smfmac_f32_16x16x64_bf16 v[36:39], v[28:31], a[40:47], v3
  buffer_load_dwordx4 v[124:127], v6, s[8:11], s22 offen offset:1792 sc1
  v_smfmac_f32_16x16x64_bf16 v[40:43], v[28:31], a[96:103], v3
  s_add_u32 s22, s25, 21504
  buffer_load_dwordx4 v[128:131], v6, s[8:11], s22 offen offset:0 sc1
  v_smfmac_f32_16x16x64_bf16 v[44:47], v[28:31], a[152:159], v3
  buffer_load_dwordx4 v[132:135], v6, s[8:11], s22 offen offset:1792 sc1
  v_smfmac_f32_16x16x64_bf16 v[48:51], v[28:31], a[208:215], v3
  s_add_u32 s22, s25, 25088
  buffer_load_dwordx4 v[136:139], v6, s[8:11], s22 offen offset:0 sc1
  v_smfmac_f32_16x16x64_bf16 v[52:55], v[28:31], v[184:191], v3
  ds_read_b128 v[64:67], v0 offset:0
  ds_read_b128 v[68:71], v0 offset:1024
  buffer_load_dwordx4 v[140:143], v6, s[8:11], s22 offen offset:1792 sc1
  v_smfmac_f32_16x16x64_bf16 v[56:59], v[28:31], v[240:247], v3
  s_waitcnt lgkmcnt(6)
  ds_read_b128 v[72:75], v0 offset:2048
  ds_read_b128 v[76:79], v0 offset:3072
  v_smfmac_f32_16x16x64_bf16 v[36:39], v[8:11], a[0:7], v3
  s_waitcnt lgkmcnt(7)
  v_smfmac_f32_16x16x64_bf16 v[36:39], v[12:15], a[8:15], v3
  s_waitcnt lgkmcnt(6)
  v_smfmac_f32_16x16x64_bf16 v[36:39], v[16:19], a[16:23], v3
  s_waitcnt lgkmcnt(2)
  v_smfmac_f32_16x16x64_bf16 v[60:63], v[8:11], v[64:71], v3
  s_waitcnt lgkmcnt(5)
  ds_read_b128 v[144:147], v0 offset:4096
  ds_read_b128 v[148:151], v0 offset:5120
  v_smfmac_f32_16x16x64_bf16 v[36:39], v[20:23], a[24:31], v3
  s_waitcnt lgkmcnt(6)
  v_smfmac_f32_16x16x64_bf16 v[36:39], v[32:35], a[48:55], v3
  v_smfmac_f32_16x16x64_bf16 v[40:43], v[8:11], a[56:63], v3
  s_waitcnt lgkmcnt(2)
  v_smfmac_f32_16x16x64_bf16 v[60:63], v[12:15], v[72:79], v3
  ds_read_b128 v[64:67], v0 offset:6144
  ds_read_b128 v[68:71], v0 offset:7168
  v_smfmac_f32_16x16x64_bf16 v[40:43], v[12:15], a[64:71], v3
  v_permlane32_swap_b32 v36, v38
  v_smfmac_f32_16x16x64_bf16 v[40:43], v[16:19], a[72:79], v3
  v_permlane32_swap_b32 v37, v39
  v_smfmac_f32_16x16x64_bf16 v[40:43], v[20:23], a[80:87], v3
  s_waitcnt lgkmcnt(2)
  v_add_f32 v36, v36, v38
  v_smfmac_f32_16x16x64_bf16 v[60:63], v[16:19], v[144:151], v3
  ds_read_b128 v[72:75], v0 offset:8192
  ds_read_b128 v[76:79], v0 offset:9216
  v_add_f32 v37, v37, v39
  v_smfmac_f32_16x16x64_bf16 v[40:43], v[32:35], a[104:111], v3
  v_cmp_u_f32 vcc, v36, v37
  v_smfmac_f32_16x16x64_bf16 v[44:47], v[8:11], a[112:119], v3
  v_cvt_pk_bf16_f32 v38, v36, v37
  v_smfmac_f32_16x16x64_bf16 v[44:47], v[12:15], a[120:127], v3
  ds_write_b32 v152, v38
  s_waitcnt lgkmcnt(3)
  s_cbranch_vccnz cB_va0_slow
  v_permlane32_swap_b32 v40, v42
  v_smfmac_f32_16x16x64_bf16 v[60:63], v[20:23], v[64:71], v3
  ds_read_b128 v[144:147], v0 offset:10240
  ds_read_b128 v[148:151], v0 offset:11264
  v_permlane32_swap_b32 v41, v43
  v_smfmac_f32_16x16x64_bf16 v[44:47], v[16:19], a[128:135], v3
  buffer_store_dword v162, v1, s[8:11], s21 offen sc1
  v_add_f32 v40, v40, v42
  v_smfmac_f32_16x16x64_bf16 v[44:47], v[20:23], a[136:143], v3
  v_add_f32 v41, v41, v43
  v_smfmac_f32_16x16x64_bf16 v[44:47], v[32:35], a[160:167], v3
  s_waitcnt lgkmcnt(3)
  v_cvt_pk_bf16_f32 v42, v40, v41
  v_smfmac_f32_16x16x64_bf16 v[60:63], v[24:27], v[72:79], v3
  ds_write_b32 v153, v42
  ds_read_b128 v[64:67], v0 offset:12288
  ds_read_b128 v[68:71], v0 offset:13312
  v_smfmac_f32_16x16x64_bf16 v[48:51], v[8:11], a[168:175], v3
  s_nop 0
  v_permlane32_swap_b32 v44, v46
  v_smfmac_f32_16x16x64_bf16 v[48:51], v[12:15], a[176:183], v3
  v_permlane32_swap_b32 v45, v47
  v_smfmac_f32_16x16x64_bf16 v[48:51], v[16:19], a[184:191], v3
  s_waitcnt lgkmcnt(3)
  v_add_f32 v44, v44, v46
  v_smfmac_f32_16x16x64_bf16 v[60:63], v[28:31], v[144:151], v3
  v_add_f32 v45, v45, v47
  v_smfmac_f32_16x16x64_bf16 v[48:51], v[20:23], a[192:199], v3
  buffer_load_dword v164, v4, s[8:11], 0 offen sc1
  v_cvt_pk_bf16_f32 v46, v44, v45
  v_smfmac_f32_16x16x64_bf16 v[48:51], v[32:35], a[216:223], v3
  ds_write_b32 v154, v46
  v_smfmac_f32_16x16x64_bf16 v[52:55], v[8:11], a[224:231], v3
  s_waitcnt lgkmcnt(1)
  v_smfmac_f32_16x16x64_bf16 v[60:63], v[32:35], v[64:71], v3
  buffer_load_dword v164, v4, s[8:11], 0 offen sc1
  v_smfmac_f32_16x16x64_bf16 v[52:55], v[12:15], a[232:239], v3
  v_permlane32_swap_b32 v48, v50
  v_smfmac_f32_16x16x64_bf16 v[52:55], v[16:19], a[240:247], v3
  v_permlane32_swap_b32 v49, v51
  v_smfmac_f32_16x16x64_bf16 v[52:55], v[20:23], a[248:255], v3
  buffer_load_dword v164, v4, s[8:11], 0 offen sc1
  v_add_f32 v48, v48, v50
  v_smfmac_f32_16x16x64_bf16 v[52:55], v[32:35], v[192:199], v3
  v_add_f32 v49, v49, v51
  v_smfmac_f32_16x16x64_bf16 v[56:59], v[8:11], v[200:207], v3
  v_cvt_pk_bf16_f32 v50, v48, v49
  v_smfmac_f32_16x16x64_bf16 v[56:59], v[12:15], v[208:215], v3
  ds_write_b32 v155, v50
  buffer_load_dword v164, v4, s[8:11], 0 offen sc1
  v_permlane32_swap_b32 v60, v62
  v_smfmac_f32_16x16x64_bf16 v[56:59], v[16:19], v[216:223], v3
  v_permlane32_swap_b32 v61, v63
  v_smfmac_f32_16x16x64_bf16 v[56:59], v[20:23], v[224:231], v3
  v_add_f32 v60, v60, v62
  v_smfmac_f32_16x16x64_bf16 v[56:59], v[32:35], v[248:255], v3
  buffer_load_dword v164, v4, s[8:11], 0 offen sc1
  v_add_f32 v61, v61, v63
  v_cvt_pk_bf16_f32 v62, v60, v61
  ds_write_b32 v158, v62
  v_permlane32_swap_b32 v52, v54
  v_permlane32_swap_b32 v53, v55
  v_add_f32 v52, v52, v54
  v_add_f32 v53, v53, v55
  v_cvt_pk_bf16_f32 v54, v52, v53
  ds_write_b32 v156, v54
  v_permlane32_swap_b32 v56, v58
  v_permlane32_swap_b32 v57, v59
  v_add_f32 v56, v56, v58
  v_add_f32 v57, v57, v59
  v_cvt_pk_bf16_f32 v58, v56, v57
  ds_write_b32 v157, v58
cB_va0_t2d:
  s_add_u32 s22, s20, 9216
  s_add_u32 s34, s20, 13312
  s_add_u32 s36, s20, 7168
  s_mov_b32 s37, 0
  v_mov_b32 v48, 0
  v_mov_b32 v49, 0
  v_mov_b32 v50, 0
  v_mov_b32 v51, 0
  v_mov_b32 v163, s18
  s_waitcnt lgkmcnt(0)
  s_setprio 3
cB_va0_fw_l:
  v_cmp_gt_u32 vcc, s18, v164
  buffer_load_dword v164, v4, s[8:11], 0 offen sc1
  s_cbranch_vccz cB_va0_fw_d
  v_cmp_gt_u32 vcc, s18, v164
  buffer_load_dword v164, v4, s[8:11], 0 offen sc1
  s_cbranch_vccz cB_va0_fw_d
  v_cmp_gt_u32 vcc, s18, v164
  buffer_load_dword v164, v4, s[8:11], 0 offen sc1
  s_cbranch_vccz cB_va0_fw_d
  v_cmp_gt_u32 vcc, s18, v164
  buffer_load_dword v164, v4, s[8:11], 0 offen sc1
  s_cbranch_vccz cB_va0_fw_d
  v_cmp_gt_u32 vcc, s18, v164
  buffer_load_dword v164, v4, s[8:11], 0 offen sc1
  s_cbranch_vccz cB_va0_fw_d
  v_cmp_gt_u32 vcc, s18, v164
  buffer_load_dword v164, v4, s[8:11], 0 offen sc1
  s_cbranch_vccz cB_va0_fw_d
  v_cmp_gt_u32 vcc, s18, v164
  buffer_load_dword v164, v4, s[8:11], 0 offen sc1
  s_cbranch_vccz cB_va0_fw_d
  v_cmp_gt_u32 vcc, s18, v164
  buffer_load_dword v164, v4, s[8:11], 0 offen sc1
  s_cbranch_vccz cB_va0_fw_d
  v_cmp_gt_u32 vcc, s18, v164
  buffer_load_dword v164, v4, s[8:11], 0 offen sc1
  s_cbranch_vccz cB_va0_fw_d
  v_cmp_gt_u32 vcc, s18, v164
  buffer_load_dword v164, v4, s[8:11], 0 offen sc1
  s_cbranch_vccz cB_va0_fw_d
  v_cmp_gt_u32 vcc, s18, v164
  buffer_load_dword v164, v4, s[8:11], 0 offen sc1
  s_cbranch_vccz cB_va0_fw_d
  v_cmp_gt_u32 vcc, s18, v164
  buffer_load_dword v164, v4, s[8:11], 0 offen sc1
  s_cbranch_vccz cB_va0_fw_d
  v_cmp_gt_u32 vcc, s18, v164
  buffer_load_dword v164, v4, s[8:11], 0 offen sc1
  s_cbranch_vccz cB_va0_fw_d
  v_cmp_gt_u32 vcc, s18, v164
  buffer_load_dword v164, v4, s[8:11], 0 offen sc1
  s_cbranch_vccz cB_va0_fw_d
  v_cmp_gt_u32 vcc, s18, v164
  buffer_load_dword v164, v4, s[8:11], 0 offen sc1
  s_cbranch_vccz cB_va0_fw_d
  v_cmp_gt_u32 vcc, s18, v164
  buffer_load_dword v164, v4, s[8:11], 0 offen sc1
  s_cbranch_vccz cB_va0_fw_d
  s_waitcnt vmcnt(24)
  s_add_u32 s30, s30, 1
  s_cmp_lt_u32 s30, 400000
  s_cbranch_scc1 cB_va0_fw_l
  s_branch cB_abort
cB_va0_fw_d:
  buffer_load_dwordx4 v[8:11], v2, s[8:11], s22 offen offset:0 sc1
  buffer_load_dwordx4 v[12:15], v2, s[8:11], s22 offen offset:1024 sc1
  buffer_load_dwordx4 v[16:19], v2, s[8:11], s22 offen offset:2048 sc1
  buffer_load_dwordx4 v[20:23], v2, s[8:11], s22 offen offset:3072 sc1
  buffer_load_dwordx4 v[24:27], v2, s[8:11], s34 offen offset:0 sc1
  buffer_load_dwordx4 v[28:31], v2, s[8:11], s34 offen offset:1024 sc1
  buffer_load_dwordx4 v[32:35], v2, s[8:11], s34 offen offset:2048 sc1
  buffer_load_dwordx4 v[36:39], v2, s[8:11], s34 offen offset:3072 sc1
  buffer_load_dwordx4 v[40:43], v2, s[8:11], s36 offen offset:0 sc1
  buffer_load_dwordx4 v[44:47], v2, s[8:11], s36 offen offset:1024 sc1
  s_barrier
  ds_read_b128 v[64:67], v2 offset:0
  ds_read_b128 v[68:71], v2 offset:1024
  ds_read_b128 v[72:75], v2 offset:2048
  ds_read_b128 v[76:79], v2 offset:3072
cB_va0_lp:
  s_waitcnt vmcnt(9)
  v_smfmac_f32_16x16x64_bf16 v[48:51], v[8:11], v[80:87], v3
  s_waitcnt vmcnt(8)
  v_smfmac_f32_16x16x64_bf16 v[48:51], v[12:15], v[88:95], v3
  s_waitcnt vmcnt(7)
  v_smfmac_f32_16x16x64_bf16 v[48:51], v[16:19], v[96:103], v3
  s_waitcnt vmcnt(6)
  v_smfmac_f32_16x16x64_bf16 v[48:51], v[20:23], v[104:111], v3
  s_waitcnt vmcnt(5)
  v_smfmac_f32_16x16x64_bf16 v[48:51], v[24:27], v[112:119], v3
  s_waitcnt vmcnt(4)
  v_smfmac_f32_16x16x64_bf16 v[48:51], v[28:31], v[120:127], v3
  s_waitcnt vmcnt(3)
  v_smfmac_f32_16x16x64_bf16 v[48:51], v[32:35], v[128:135], v3
  s_waitcnt vmcnt(2)
  v_smfmac_f32_16x16x64_bf16 v[48:51], v[36:39], v[136:143], v3
  s_waitcnt vmcnt(1) lgkmcnt(0)
  v_smfmac_f32_16x16x64_bf16 v[48:51], v[40:43], v[64:71], v3
  s_waitcnt vmcnt(0)
  v_smfmac_f32_16x16x64_bf16 v[48:51], v[44:47], v[72:79], v3
  s_nop 7
  v_permlane32_swap_b32 v48, v50
  v_permlane32_swap_b32 v49, v51
  v_add_f32 v48, v48, v50
  v_add_f32 v49, v49, v51
  v_cvt_pk_bf16_f32 v160, v48, v49
  v_cmp_u_f32 vcc, v48, v49
  s_nop 0
  v_mov_b32_dpp v161, v160 quad_perm:[1,0,3,2] row_mask:0xf bank_mask:0xf
  v_perm_b32 v160, v161, v160, v5
  v_min_u32 v160, -2, v160
  s_cbranch_vccnz cB_va0_rp
cB_va0_cont:
  buffer_store_dword v160, v1, s[8:11], s21 offen sc1
  s_setprio 0
  s_cmp_lg_u32 s19, 62
  s_cbranch_scc1 cB_va0_nl
  buffer_store_dword v160, v1, s[8:11], s38 offen sc1
  s_waitcnt vmcnt(0)
  buffer_wbl2 sc1
  s_branch cB_done
cB_va0_nl:
  s_add_u32 s25, s25, 458752
  v_mov_b32 v36, 0
  v_mov_b32 v37, 0
  v_mov_b32 v38, 0
  v_mov_b32 v39, 0
  v_mov_b32 v40, 0
  v_mov_b32 v41, 0
  v_mov_b32 v42, 0
  v_mov_b32 v43, 0
  v_mov_b32 v44, 0
  v_mov_b32 v45, 0
  v_mov_b32 v46, 0
  v_mov_b32 v47, 0
  v_mov_b32 v48, 0
  v_mov_b32 v49, 0
  v_mov_b32 v50, 0
  v_mov_b32 v51, 0
  v_mov_b32 v52, 0
  v_mov_b32 v53, 0
  v_mov_b32 v54, 0
  v_mov_b32 v55, 0
  v_mov_b32 v56, 0
  v_mov_b32 v57, 0
  v_mov_b32 v58, 0
  v_mov_b32 v59, 0
  v_mov_b32 v60, 0
  v_mov_b32 v61, 0
  v_mov_b32 v62, 0
  v_mov_b32 v63, 0
  s_mov_b32 s19, s18
  s_add_u32 s18, s18, 1
  s_mov_b32 s22, s20
  s_mov_b32 s20, s21
  s_mov_b32 s21, s22
  s_add_u32 s23, s20, 4096
  s_branch cB_va0_loop
cB_va0_slow:
  s_waitcnt lgkmcnt(0)
cB_va0_sl1:
  s_add_u32 s31, s31, 0x1000000
  buffer_load_dwordx4 v[8:11], v2, s[8:11], s20 offen offset:0 sc1
  buffer_load_dwordx4 v[12:15], v2, s[8:11], s20 offen offset:1024 sc1
  buffer_load_dwordx4 v[16:19], v2, s[8:11], s20 offen offset:2048 sc1
  buffer_load_dwordx4 v[20:23], v2, s[8:11], s20 offen offset:3072 sc1
  buffer_load_dwordx4 v[24:27], v2, s[8:11], s23 offen offset:0 sc1
  buffer_load_dwordx4 v[28:31], v2, s[8:11], s23 offen offset:1024 sc1
  buffer_load_dwordx4 v[32:35], v2, s[8:11], s23 offen offset:2048 sc1
  s_waitcnt vmcnt(0)
  v_max3_u32 v36, v8, v9, v10
  v_max3_u32 v36, v36, v11, v12
  v_max3_u32 v36, v36, v13, v14
  v_max3_u32 v36, v36, v15, v16
  v_max3_u32 v36, v36, v17, v18
  v_max3_u32 v36, v36, v19, v20
  v_max3_u32 v36, v36, v21, v22
  v_max3_u32 v36, v36, v23, v24
  v_max3_u32 v36, v36, v25, v26
  v_max3_u32 v36, v36, v27, v28
  v_max3_u32 v36, v36, v29, v30
  v_max3_u32 v36, v36, v31, v32
  v_max3_u32 v36, v36, v33, v34
  v_max_u32 v36, v36, v35
  v_cmp_eq_u32 vcc, -1, v36
  s_cbranch_vccz cB_va0_sl2
  s_add_u32 s30, s30, 1
  s_cmp_lt_u32 s30, 400000
  s_cbranch_scc1 cB_va0_sl1
  s_branch cB_abort
cB_va0_sl2:
  v_mov_b32 v36, 0
  v_mov_b32 v37, 0
  v_mov_b32 v38, 0
  v_mov_b32 v39, 0
  v_mov_b32 v40, 0
  v_mov_b32 v41, 0
  v_mov_b32 v42, 0
  v_mov_b32 v43, 0
  v_mov_b32 v44, 0
  v_mov_b32 v45, 0
  v_mov_b32 v46, 0
  v_mov_b32 v47, 0
  v_mov_b32 v48, 0
  v_mov_b32 v49, 0
  v_mov_b32 v50, 0
  v_mov_b32 v51, 0
  v_mov_b32 v52, 0
  v_mov_b32 v53, 0
  v_mov_b32 v54, 0
  v_mov_b32 v55, 0
  v_mov_b32 v56, 0
  v_mov_b32 v57, 0
  v_mov_b32 v58, 0
  v_mov_b32 v59, 0
  v_mov_b32 v60, 0
  v_mov_b32 v61, 0
  v_mov_b32 v62, 0
  v_mov_b32 v63, 0
  buffer_store_dword v162, v1, s[8:11], s21 offen sc1
  ds_read_b128 v[64:67], v0 offset:0
  ds_read_b128 v[68:71], v0 offset:1024
  v_smfmac_f32_16x16x64_bf16 v[36:39], v[8:11], a[0:7], v3
  v_smfmac_f32_16x16x64_bf16 v[40:43], v[8:11], a[56:63], v3
  v_smfmac_f32_16x16x64_bf16 v[44:47], v[8:11], a[112:119], v3
  v_smfmac_f32_16x16x64_bf16 v[48:51], v[8:11], a[168:175], v3
  v_smfmac_f32_16x16x64_bf16 v[52:55], v[8:11], a[224:231], v3
  v_smfmac_f32_16x16x64_bf16 v[56:59], v[8:11], v[200:207], v3
  s_waitcnt lgkmcnt(0)
  v_smfmac_f32_16x16x64_bf16 v[60:63], v[8:11], v[64:71], v3
  ds_read_b128 v[72:75], v0 offset:2048
  ds_read_b128 v[76:79], v0 offset:3072
  v_smfmac_f32_16x16x64_bf16 v[36:39], v[12:15], a[8:15], v3
  v_smfmac_f32_16x16x64_bf16 v[40:43], v[12:15], a[64:71], v3
  v_smfmac_f32_16x16x64_bf16 v[44:47], v[12:15], a[120:127], v3
  v_smfmac_f32_16x16x64_bf16 v[48:51], v[12:15], a[176:183], v3
  v_smfmac_f32_16x16x64_bf16 v[52:55], v[12:15], a[232:239], v3
  v_smfmac_f32_16x16x64_bf16 v[56:59], v[12:15], v[208:215], v3
  s_waitcnt lgkmcnt(0)
  v_smfmac_f32_16x16x64_bf16 v[60:63], v[12:15], v[72:79], v3
  ds_read_b128 v[144:147], v0 offset:4096
  ds_read_b128 v[148:151], v0 offset:5120
  v_smfmac_f32_16x16x64_bf16 v[36:39], v[16:19], a[16:23], v3
  v_smfmac_f32_16x16x64_bf16 v[40:43], v[16:19], a[72:79], v3
  v_smfmac_f32_16x16x64_bf16 v[44:47], v[16:19], a[128:135], v3
  v_smfmac_f32_16x16x64_bf16 v[48:51], v[16:19], a[184:191], v3
  v_smfmac_f32_16x16x64_bf16 v[52:55], v[16:19], a[240:247], v3
  v_smfmac_f32_16x16x64_bf16 v[56:59], v[16:19], v[216:223], v3
  s_waitcnt lgkmcnt(0)
  v_smfmac_f32_16x16x64_bf16 v[60:63], v[16:19], v[144:151], v3
  ds_read_b128 v[64:67], v0 offset:6144
  ds_read_b128 v[68:71], v0 offset:7168
  v_smfmac_f32_16x16x64_bf16 v[36:39], v[20:23], a[24:31], v3
  v_smfmac_f32_16x16x64_bf16 v[40:43], v[20:23], a[80:87], v3
  v_smfmac_f32_16x16x64_bf16 v[44:47], v[20:23], a[136:143], v3
  v_smfmac_f32_16x16x64_bf16 v[48:51], v[20:23], a[192:199], v3
  v_smfmac_f32_16x16x64_bf16 v[52:55], v[20:23], a[248:255], v3
  v_smfmac_f32_16x16x64_bf16 v[56:59], v[20:23], v[224:231], v3
  s_waitcnt lgkmcnt(0)
  v_smfmac_f32_16x16x64_bf16 v[60:63], v[20:23], v[64:71], v3
  ds_read_b128 v[72:75], v0 offset:8192
  ds_read_b128 v[76:79], v0 offset:9216
  v_smfmac_f32_16x16x64_bf16 v[36:39], v[24:27], a[32:39], v3
  v_smfmac_f32_16x16x64_bf16 v[40:43], v[24:27], a[88:95], v3
  v_smfmac_f32_16x16x64_bf16 v[44:47], v[24:27], a[144:151], v3
  v_smfmac_f32_16x16x64_bf16 v[48:51], v[24:27], a[200:207], v3
  v_smfmac_f32_16x16x64_bf16 v[52:55], v[24:27], v[176:183], v3
  v_smfmac_f32_16x16x64_bf16 v[56:59], v[24:27], v[232:239], v3
  s_waitcnt lgkmcnt(0)
  v_smfmac_f32_16x16x64_bf16 v[60:63], v[24:27], v[72:79], v3
  ds_read_b128 v[144:147], v0 offset:10240
  ds_read_b128 v[148:151], v0 offset:11264
  v_smfmac_f32_16x16x64_bf16 v[36:39], v[28:31], a[40:47], v3
  v_smfmac_f32_16x16x64_bf16 v[40:43], v[28:31], a[96:103], v3
  v_smfmac_f32_16x16x64_bf16 v[44:47], v[28:31], a[152:159], v3
  v_smfmac_f32_16x16x64_bf16 v[48:51], v[28:31], a[208:215], v3
  v_smfmac_f32_16x16x64_bf16 v[52:55], v[28:31], v[184:191], v3
  v_smfmac_f32_16x16x64_bf16 v[56:59], v[28:31], v[240:247], v3
  s_waitcnt lgkmcnt(0)
  v_smfmac_f32_16x16x64_bf16 v[60:63], v[28:31], v[144:151], v3
  ds_read_b128 v[64:67], v0 offset:12288
  ds_read_b128 v[68:71], v0 offset:13312
  v_smfmac_f32_16x16x64_bf16 v[36:39], v[32:35], a[48:55], v3
  v_smfmac_f32_16x16x64_bf16 v[40:43], v[32:35], a[104:111], v3
  v_smfmac_f32_16x16x64_bf16 v[44:47], v[32:35], a[160:167], v3
  v_smfmac_f32_16x16x64_bf16 v[48:51], v[32:35], a[216:223], v3
  v_smfmac_f32_16x16x64_bf16 v[52:55], v[32:35], v[192:199], v3
  v_smfmac_f32_16x16x64_bf16 v[56:59], v[32:35], v[248:255], v3
  s_waitcnt lgkmcnt(0)
  v_smfmac_f32_16x16x64_bf16 v[60:63], v[32:35], v[64:71], v3
  v_permlane32_swap_b32 v36, v38
  v_permlane32_swap_b32 v37, v39
  v_add_f32 v36, v36, v38
  v_add_f32 v37, v37, v39
  v_cvt_pk_bf16_f32 v38, v36, v37
  ds_write_b32 v152, v38
  v_permlane32_swap_b32 v40, v42
  v_permlane32_swap_b32 v41, v43
  v_add_f32 v40, v40, v42
  v_add_f32 v41, v41, v43
  v_cvt_pk_bf16_f32 v42, v40, v41
  ds_write_b32 v153, v42
  v_permlane32_swap_b32 v44, v46
  v_permlane32_swap_b32 v45, v47
  v_add_f32 v44, v44, v46
  v_add_f32 v45, v45, v47
  v_cvt_pk_bf16_f32 v46, v44, v45
  ds_write_b32 v154, v46
  v_permlane32_swap_b32 v48, v50
  v_permlane32_swap_b32 v49, v51
  v_add_f32 v48, v48, v50
  v_add_f32 v49, v49, v51
  v_cvt_pk_bf16_f32 v50, v48, v49
  ds_write_b32 v155, v50
  v_permlane32_swap_b32 v52, v54
  v_permlane32_swap_b32 v53, v55
  v_add_f32 v52, v52, v54
  v_add_f32 v53, v53, v55
  v_cvt_pk_bf16_f32 v54, v52, v53
  ds_write_b32 v156, v54
  v_permlane32_swap_b32 v56, v58
  v_permlane32_swap_b32 v57, v59
  v_add_f32 v56, v56, v58
  v_add_f32 v57, v57, v59
  v_cvt_pk_bf16_f32 v58, v56, v57
  ds_write_b32 v157, v58
  v_permlane32_swap_b32 v60, v62
  v_permlane32_swap_b32 v61, v63
  v_add_f32 v60, v60, v62
  v_add_f32 v61, v61, v63
  v_cvt_pk_bf16_f32 v62, v60, v61
  ds_write_b32 v158, v62
  buffer_load_dword v164, v4, s[8:11], 0 offen sc1
  buffer_load_dword v164, v4, s[8:11], 0 offen sc1
  buffer_load_dword v164, v4, s[8:11], 0 offen sc1
  buffer_load_dword v164, v4, s[8:11], 0 offen sc1
  buffer_load_dword v164, v4, s[8:11], 0 offen sc1
  s_branch cB_va0_t2d
cB_va0_rp:
  s_cmp_lg_u32 s37, 0
  s_cbranch_scc1 cB_va0_cont
cB_va0_rv:
  s_add_u32 s31, s31, 0x10000
  buffer_load_dwordx4 v[8:11], v2, s[8:11], s22 offen offset:0 sc1
  buffer_load_dwordx4 v[12:15], v2, s[8:11], s22 offen offset:1024 sc1
  buffer_load_dwordx4 v[16:19], v2, s[8:11], s22 offen offset:2048 sc1
  buffer_load_dwordx4 v[20:23], v2, s[8:11], s22 offen offset:3072 sc1
  buffer_load_dwordx4 v[24:27], v2, s[8:11], s34 offen offset:0 sc1
  buffer_load_dwordx4 v[28:31], v2, s[8:11], s34 offen offset:1024 sc1
  buffer_load_dwordx4 v[32:35], v2, s[8:11], s34 offen offset:2048 sc1
  buffer_load_dwordx4 v[36:39], v2, s[8:11], s34 offen offset:3072 sc1
  buffer_load_dwordx4 v[40:43], v2, s[8:11], s36 offen offset:0 sc1
  buffer_load_dwordx4 v[44:47], v2, s[8:11], s36 offen offset:1024 sc1
  s_waitcnt vmcnt(0)
  v_max3_u32 v52, v8, v9, v10
  v_max3_u32 v52, v52, v11, v12
  v_max3_u32 v52, v52, v13, v14
  v_max3_u32 v52, v52, v15, v16
  v_max3_u32 v52, v52, v17, v18
  v_max3_u32 v52, v52, v19, v20
  v_max3_u32 v52, v52, v21, v22
  v_max3_u32 v52, v52, v23, v24
  v_max3_u32 v52, v52, v25, v26
  v_max3_u32 v52, v52, v27, v28
  v_max3_u32 v52, v52, v29, v30
  v_max3_u32 v52, v52, v31, v32
  v_max3_u32 v52, v52, v33, v34
  v_max3_u32 v52, v52, v35, v36
  v_max3_u32 v52, v52, v37, v38
  v_max3_u32 v52, v52, v39, v40
  v_max3_u32 v52, v52, v41, v42
  v_max3_u32 v52, v52, v43, v44
  v_max3_u32 v52, v52, v45, v46
  v_max_u32 v52, v52, v47
  v_cmp_eq_u32 vcc, -1, v52
  s_mov_b32 s37, 1
  v_mov_b32 v48, 0
  v_mov_b32 v49, 0
  v_mov_b32 v50, 0
  v_mov_b32 v51, 0
  s_nop 1
  s_cbranch_vccz cB_va0_lp
  s_add_u32 s30, s30, 1
  s_cmp_lt_u32 s30, 400000
  s_cbranch_scc1 cB_va0_rv
  s_branch cB_abort
.p2align 6
cB_va1_loop:
  s_mov_b32 s30, 0
  s_barrier
  buffer_load_dwordx4 v[28:31], v2, s[8:11], s23 offen offset:1024 sc1
  buffer_load_dwordx4 v[32:35], v2, s[8:11], s23 offen offset:2048 sc1
  s_barrier
  buffer_store_dword v160, v1, s[8:11], s38 offen sc1
  s_add_u32 s22, s25, 0
  buffer_load_dwordx4 v[80:83], v6, s[8:11], s22 offen offset:0 sc1
  buffer_load_dwordx4 v[84:87], v6, s[8:11], s22 offen offset:1792 sc1
  s_add_u32 s22, s25, 3584
  buffer_load_dwordx4 v[88:91], v6, s[8:11], s22 offen offset:0 sc1
  buffer_load_dwordx4 v[92:95], v6, s[8:11], s22 offen offset:1792 sc1
  s_add_u32 s22, s25, 7168
  buffer_load_dwordx4 v[96:99], v6, s[8:11], s22 offen offset:0 sc1
  s_mul_i32 s38, s18, 7168
  s_add_u32 s38, s38, 88002560
  s_waitcnt vmcnt(6)
  ds_write_b128 v2, v[32:35] offset:14336
  v_smfmac_f32_16x16x64_bf16 v[36:39], v[28:31], a[40:47], v3
  buffer_load_dwordx4 v[100:103], v6, s[8:11], s22 offen offset:1792 sc1
  v_smfmac_f32_16x16x64_bf16 v[40:43], v[28:31], a[96:103], v3
  s_add_u32 s22, s25, 10752
  buffer_load_dwordx4 v[104:107], v6, s[8:11], s22 offen offset:0 sc1
  v_smfmac_f32_16x16x64_bf16 v[44:47], v[28:31], a[152:159], v3
  buffer_load_dwordx4 v[108:111], v6, s[8:11], s22 offen offset:1792 sc1
  v_smfmac_f32_16x16x64_bf16 v[48:51], v[28:31], a[208:215], v3
  s_add_u32 s22, s25, 14336
  buffer_load_dwordx4 v[112:115], v6, s[8:11], s22 offen offset:0 sc1
  v_smfmac_f32_16x16x64_bf16 v[52:55], v[28:31], v[184:191], v3
  s_waitcnt lgkmcnt(0)
  s_barrier
  ds_read_b128 v[8:11], v2 offset:8192
  ds_read_b128 v[12:15], v2 offset:9216
  ds_read_b128 v[16:19], v2 offset:10240
  ds_read_b128 v[20:23], v2 offset:11264
  ds_read_b128 v[24:27], v2 offset:12288
  buffer_load_dwordx4 v[116:119], v6, s[8:11], s22 offen offset:1792 sc1
  v_smfmac_f32_16x16x64_bf16 v[56:59], v[28:31], v[240:247], v3
  s_add_u32 s22, s25, 17920
  buffer_load_dwordx4 v[120:123], v6, s[8:11], s22 offen offset:0 sc1
  v_smfmac_f32_16x16x64_bf16 v[36:39], v[32:35], a[48:55], v3
  buffer_load_dwordx4 v[124:127], v6, s[8:11], s22 offen offset:1792 sc1
  v_smfmac_f32_16x16x64_bf16 v[40:43], v[32:35], a[104:111], v3
  s_add_u32 s22, s25, 21504
  buffer_load_dwordx4 v[128:131], v6, s[8:11], s22 offen offset:0 sc1
  v_smfmac_f32_16x16x64_bf16 v[44:47], v[32:35], a[160:167], v3
  buffer_load_dwordx4 v[132:135], v6, s[8:11], s22 offen offset:1792 sc1
  v_smfmac_f32_16x16x64_bf16 v[48:51], v[32:35], a[216:223], v3
  s_add_u32 s22, s25, 25088
  buffer_load_dwordx4 v[136:139], v6, s[8:11], s22 offen offset:0 sc1
  v_smfmac_f32_16x16x64_bf16 v[52:55], v[32:35], v[192:199], v3
  ds_read_b128 v[64:67], v0 offset:0
  ds_read_b128 v[68:71], v0 offset:1024
  buffer_load_dwordx4 v[140:143], v6, s[8:11], s22 offen offset:1792 sc1
  v_smfmac_f32_16x16x64_bf16 v[56:59], v[32:35], v[248:255], v3
  s_waitcnt lgkmcnt(6)
  ds_read_b128 v[72:75], v0 offset:2048
  ds_read_b128 v[76:79], v0 offset:3072
  v_smfmac_f32_16x16x64_bf16 v[36:39], v[8:11], a[0:7], v3
  s_waitcnt lgkmcnt(7)
  v_smfmac_f32_16x16x64_bf16 v[36:39], v[12:15], a[8:15], v3
  s_waitcnt lgkmcnt(6)
  v_smfmac_f32_16x16x64_bf16 v[36:39], v[16:19], a[16:23], v3
  s_waitcnt lgkmcnt(2)
  v_smfmac_f32_16x16x64_bf16 v[60:63], v[8:11], v[64:71], v3
  s_waitcnt lgkmcnt(5)
  ds_read_b128 v[144:147], v0 offset:4096
  ds_read_b128 v[148:151], v0 offset:5120
  v_smfmac_f32_16x16x64_bf16 v[36:39], v[20:23], a[24:31], v3
  s_waitcnt lgkmcnt(6)
  v_smfmac_f32_16x16x64_bf16 v[36:39], v[24:27], a[32:39], v3
  v_smfmac_f32_16x16x64_bf16 v[40:43], v[8:11], a[56:63], v3
  s_waitcnt lgkmcnt(2)
  v_smfmac_f32_16x16x64_bf16 v[60:63], v[12:15], v[72:79], v3
  ds_read_b128 v[64:67], v0 offset:6144
  ds_read_b128 v[68:71], v0 offset:7168
  v_smfmac_f32_16x16x64_bf16 v[40:43], v[12:15], a[64:71], v3
  v_permlane32_swap_b32 v36, v38
  v_smfmac_f32_16x16x64_bf16 v[40:43], v[16:19], a[72:79], v3
  v_permlane32_swap_b32 v37, v39
  v_smfmac_f32_16x16x64_bf16 v[40:43], v[20:23], a[80:87], v3
  s_waitcnt lgkmcnt(2)
  v_add_f32 v36, v36, v38
  v_smfmac_f32_16x16x64_bf16 v[60:63], v[16:19], v[144:151], v3
  ds_read_b128 v[72:75], v0 offset:8192
  ds_read_b128 v[76:79], v0 offset:9216
  v_add_f32 v37, v37, v39
  v_smfmac_f32_16x16x64_bf16 v[40:43], v[24:27], a[88:95], v3
  v_cmp_u_f32 vcc, v36, v37
  v_smfmac_f32_16x16x64_bf16 v[44:47], v[8:11], a[112:119], v3
  v_cvt_pk_bf16_f32 v38, v36, v37
  v_smfmac_f32_16x16x64_bf16 v[44:47], v[12:15], a[120:127], v3
  ds_write_b32 v152, v38
  s_waitcnt lgkmcnt(3)
  s_cbranch_vccnz cB_va1_slow
  v_permlane32_swap_b32 v40, v42
  v_smfmac_f32_16x16x64_bf16 v[60:63], v[20:23], v[64:71], v3
  ds_read_b128 v[144:147], v0 offset:10240
  ds_read_b128 v[148:151], v0 offset:11264
  v_permlane32_swap_b32 v41, v43
  v_smfmac_f32_16x16x64_bf16 v[44:47], v[16:19], a[128:135], v3
  buffer_store_dword v162, v1, s[8:11], s21 offen sc1
  v_add_f32 v40, v40, v42
  v_smfmac_f32_16x16x64_bf16 v[44:47], v[20:23], a[136:143], v3
  v_add_f32 v41, v41, v43
  v_smfmac_f32_16x16x64_bf16 v[44:47], v[24:27], a[144:151], v3
  s_waitcnt lgkmcnt(3)
  v_cvt_pk_bf16_f32 v42, v40, v41
  v_smfmac_f32_16x16x64_bf16 v[60:63], v[24:27], v[72:79], v3
  ds_write_b32 v153, v42
  ds_read_b128 v[64:67], v0 offset:12288
  ds_read_b128 v[68:71], v0 offset:13312
  v_smfmac_f32_16x16x64_bf16 v[48:51], v[8:11], a[168:175], v3
  s_nop 0
  v_permlane32_swap_b32 v44, v46
  v_smfmac_f32_16x16x64_bf16 v[48:51], v[12:15], a[176:183], v3
  v_permlane32_swap_b32 v45, v47
  v_smfmac_f32_16x16x64_bf16 v[48:51], v[16:19], a[184:191], v3
  s_waitcnt lgkmcnt(3)
  v_add_f32 v44, v44, v46
  v_smfmac_f32_16x16x64_bf16 v[60:63], v[28:31], v[144:151], v3
  v_add_f32 v45, v45, v47
  v_smfmac_f32_16x16x64_bf16 v[48:51], v[20:23], a[192:199], v3
  v_cvt_pk_bf16_f32 v46, v44, v45
  v_smfmac_f32_16x16x64_bf16 v[48:51], v[24:27], a[200:207], v3
  ds_write_b32 v154, v46
  v_smfmac_f32_16x16x64_bf16 v[52:55], v[8:11], a[224:231], v3
  s_waitcnt lgkmcnt(1)
  v_smfmac_f32_16x16x64_bf16 v[60:63], v[32:35], v[64:71], v3
  v_smfmac_f32_16x16x64_bf16 v[52:55], v[12:15], a[232:239], v3
  v_permlane32_swap_b32 v48, v50
  v_smfmac_f32_16x16x64_bf16 v[52:55], v[16:19], a[240:247], v3
  v_permlane32_swap_b32 v49, v51
  v_smfmac_f32_16x16x64_bf16 v[52:55], v[20:23], a[248:255], v3
  v_add_f32 v48, v48, v50
  v_smfmac_f32_16x16x64_bf16 v[52:55], v[24:27], v[176:183], v3
  v_add_f32 v49, v49, v51
  v_smfmac_f32_16x16x64_bf16 v[56:59], v[8:11], v[200:207], v3
  v_cvt_pk_bf16_f32 v50, v48, v49
  v_smfmac_f32_16x16x64_bf16 v[56:59], v[12:15], v[208:215], v3
  ds_write_b32 v155, v50
  v_permlane32_swap_b32 v60, v62
  v_smfmac_f32_16x16x64_bf16 v[56:59], v[16:19], v[216:223], v3
  v_permlane32_swap_b32 v61, v63
  v_smfmac_f32_16x16x64_bf16 v[56:59], v[20:23], v[224:231], v3
  v_add_f32 v60, v60, v62
  v_smfmac_f32_16x16x64_bf16 v[56:59], v[24:27], v[232:239], v3
  v_add_f32 v61, v61, v63
  v_cvt_pk_bf16_f32 v62, v60, v61
  ds_write_b32 v158, v62
  v_permlane32_swap_b32 v52, v54
  v_permlane32_swap_b32 v53, v55
  v_add_f32 v52, v52, v54
  v_add_f32 v53, v53, v55
  v_cvt_pk_bf16_f32 v54, v52, v53
  ds_write_b32 v156, v54
  v_permlane32_swap_b32 v56, v58
  v_permlane32_swap_b32 v57, v59
  v_add_f32 v56, v56, v58
  v_add_f32 v57, v57, v59
  v_cvt_pk_bf16_f32 v58, v56, v57
  ds_write_b32 v157, v58
cB_va1_t2d:
  s_add_u32 s22, s20, 9216
  s_add_u32 s34, s20, 13312
  s_add_u32 s36, s20, 7168
  s_mov_b32 s37, 0
  v_mov_b32 v48, 0
  v_mov_b32 v49, 0
  v_mov_b32 v50, 0
  v_mov_b32 v51, 0
  v_mov_b32 v163, s18
  s_waitcnt lgkmcnt(0)
  s_barrier
  buffer_load_dwordx4 v[8:11], v2, s[8:11], s22 offen offset:0 sc1
  buffer_load_dwordx4 v[12:15], v2, s[8:11], s22 offen offset:1024 sc1
  buffer_load_dwordx4 v[16:19], v2, s[8:11], s22 offen offset:2048 sc1
  buffer_load_dwordx4 v[20:23], v2, s[8:11], s22 offen offset:3072 sc1
  buffer_load_dwordx4 v[24:27], v2, s[8:11], s34 offen offset:0 sc1
  buffer_load_dwordx4 v[28:31], v2, s[8:11], s34 offen offset:1024 sc1
  buffer_load_dwordx4 v[32:35], v2, s[8:11], s34 offen offset:2048 sc1
  buffer_load_dwordx4 v[36:39], v2, s[8:11], s34 offen offset:3072 sc1
  buffer_load_dwordx4 v[40:43], v2, s[8:11], s36 offen offset:0 sc1
  buffer_load_dwordx4 v[44:47], v2, s[8:11], s36 offen offset:1024 sc1
  ds_read_b128 v[64:67], v2 offset:4096
  ds_read_b128 v[68:71], v2 offset:5120
  ds_read_b128 v[72:75], v2 offset:6144
  ds_read_b128 v[76:79], v2 offset:7168
cB_va1_lp:
  s_waitcnt vmcnt(9)
  v_smfmac_f32_16x16x64_bf16 v[48:51], v[8:11], v[80:87], v3
  s_waitcnt vmcnt(8)
  v_smfmac_f32_16x16x64_bf16 v[48:51], v[12:15], v[88:95], v3
  s_waitcnt vmcnt(7)
  v_smfmac_f32_16x16x64_bf16 v[48:51], v[16:19], v[96:103], v3
  v_max3_u32 v55, v8, v12, v16
  s_waitcnt vmcnt(6)
  v_smfmac_f32_16x16x64_bf16 v[48:51], v[20:23], v[104:111], v3
  v_max_u32 v55, v55, v20
  v_cmp_eq_u32 vcc, -1, v55
  s_waitcnt vmcnt(5)
  v_smfmac_f32_16x16x64_bf16 v[48:51], v[24:27], v[112:119], v3
  s_waitcnt vmcnt(4)
  v_smfmac_f32_16x16x64_bf16 v[48:51], v[28:31], v[120:127], v3
  s_cbranch_vccnz cB_va1_rv
  buffer_store_dword v163, v7, s[8:11], 0 offen sc1
  s_waitcnt vmcnt(4)
  v_smfmac_f32_16x16x64_bf16 v[48:51], v[32:35], v[128:135], v3
  s_waitcnt vmcnt(3)
  v_smfmac_f32_16x16x64_bf16 v[48:51], v[36:39], v[136:143], v3
  s_waitcnt vmcnt(2) lgkmcnt(0)
  v_smfmac_f32_16x16x64_bf16 v[48:51], v[40:43], v[64:71], v3
  s_waitcnt vmcnt(1)
  v_smfmac_f32_16x16x64_bf16 v[48:51], v[44:47], v[72:79], v3
  s_nop 7
  v_permlane32_swap_b32 v48, v50
  v_permlane32_swap_b32 v49, v51
  v_add_f32 v48, v48, v50
  v_add_f32 v49, v49, v51
  v_cvt_pk_bf16_f32 v160, v48, v49
  v_cmp_u_f32 vcc, v48, v49
  s_nop 0
  v_mov_b32_dpp v161, v160 quad_perm:[1,0,3,2] row_mask:0xf bank_mask:0xf
  v_perm_b32 v160, v161, v160, v5
  v_min_u32 v160, -2, v160
  s_cbranch_vccnz cB_va1_rp
cB_va1_cont:
  buffer_store_dword v160, v1, s[8:11], s21 offen sc1
  s_cmp_lg_u32 s19, 62
  s_cbranch_scc1 cB_va1_nl
  buffer_store_dword v160, v1, s[8:11], s38 offen sc1
  s_waitcnt vmcnt(0)
  buffer_wbl2 sc1
  s_branch cB_done
cB_va1_nl:
  s_add_u32 s25, s25, 458752
  v_mov_b32 v36, 0
  v_mov_b32 v37, 0
  v_mov_b32 v38, 0
  v_mov_b32 v39, 0
  v_mov_b32 v40, 0
  v_mov_b32 v41, 0
  v_mov_b32 v42, 0
  v_mov_b32 v43, 0
  v_mov_b32 v44, 0
  v_mov_b32 v45, 0
  v_mov_b32 v46, 0
  v_mov_b32 v47, 0
  v_mov_b32 v48, 0
  v_mov_b32 v49, 0
  v_mov_b32 v50, 0
  v_mov_b32 v51, 0
  v_mov_b32 v52, 0
  v_mov_b32 v53, 0
  v_mov_b32 v54, 0
  v_mov_b32 v55, 0
  v_mov_b32 v56, 0
  v_mov_b32 v57, 0
  v_mov_b32 v58, 0
  v_mov_b32 v59, 0
  v_mov_b32 v60, 0
  v_mov_b32 v61, 0
  v_mov_b32 v62, 0
  v_mov_b32 v63, 0
  s_mov_b32 s19, s18
  s_add_u32 s18, s18, 1
  s_mov_b32 s22, s20
  s_mov_b32 s20, s21
  s_mov_b32 s21, s22
  s_add_u32 s23, s20, 4096
  s_branch cB_va1_loop
cB_va1_slow:
  s_waitcnt lgkmcnt(0)
cB_va1_sl1:
  s_add_u32 s31, s31, 0x1000000
  buffer_load_dwordx4 v[8:11], v2, s[8:11], s20 offen offset:0 sc1
  buffer_load_dwordx4 v[12:15], v2, s[8:11], s20 offen offset:1024 sc1
  buffer_load_dwordx4 v[16:19], v2, s[8:11], s20 offen offset:2048 sc1
  buffer_load_dwordx4 v[20:23], v2, s[8:11], s20 offen offset:3072 sc1
  buffer_load_dwordx4 v[24:27], v2, s[8:11], s23 offen offset:0 sc1
  buffer_load_dwordx4 v[28:31], v2, s[8:11], s23 offen offset:1024 sc1
  buffer_load_dwordx4 v[32:35], v2, s[8:11], s23 offen offset:2048 sc1
  s_waitcnt vmcnt(0)
  v_max3_u32 v36, v8, v9, v10
  v_max3_u32 v36, v36, v11, v12
  v_max3_u32 v36, v36, v13, v14
  v_max3_u32 v36, v36, v15, v16
  v_max3_u32 v36, v36, v17, v18
  v_max3_u32 v36, v36, v19, v20
  v_max3_u32 v36, v36, v21, v22
  v_max3_u32 v36, v36, v23, v24
  v_max3_u32 v36, v36, v25, v26
  v_max3_u32 v36, v36, v27, v28
  v_max3_u32 v36, v36, v29, v30
  v_max3_u32 v36, v36, v31, v32
  v_max3_u32 v36, v36, v33, v34
  v_max_u32 v36, v36, v35
  v_cmp_eq_u32 vcc, -1, v36
  s_cbranch_vccz cB_va1_sl2
  s_add_u32 s30, s30, 1
  s_cmp_lt_u32 s30, 400000
  s_cbranch_scc1 cB_va1_sl1
  s_branch cB_abort
cB_va1_sl2:
  v_mov_b32 v36, 0
  v_mov_b32 v37, 0
  v_mov_b32 v38, 0
  v_mov_b32 v39, 0
  v_mov_b32 v40, 0
  v_mov_b32 v41, 0
  v_mov_b32 v42, 0
  v_mov_b32 v43, 0
  v_mov_b32 v44, 0
  v_mov_b32 v45, 0
  v_mov_b32 v46, 0
  v_mov_b32 v47, 0
  v_mov_b32 v48, 0
  v_mov_b32 v49, 0
  v_mov_b32 v50, 0
  v_mov_b32 v51, 0
  v_mov_b32 v52, 0
  v_mov_b32 v53, 0
  v_mov_b32 v54, 0
  v_mov_b32 v55, 0
  v_mov_b32 v56, 0
  v_mov_b32 v57, 0
  v_mov_b32 v58, 0
  v_mov_b32 v59, 0
  v_mov_b32 v60, 0
  v_mov_b32 v61, 0
  v_mov_b32 v62, 0
  v_mov_b32 v63, 0
  buffer_store_dword v162, v1, s[8:11], s21 offen sc1
  ds_read_b128 v[64:67], v0 offset:0
  ds_read_b128 v[68:71], v0 offset:1024
  v_smfmac_f32_16x16x64_bf16 v[36:39], v[8:11], a[0:7], v3
  v_smfmac_f32_16x16x64_bf16 v[40:43], v[8:11], a[56:63], v3
  v_smfmac_f32_16x16x64_bf16 v[44:47], v[8:11], a[112:119], v3
  v_smfmac_f32_16x16x64_bf16 v[48:51], v[8:11], a[168:175], v3
  v_smfmac_f32_16x16x64_bf16 v[52:55], v[8:11], a[224:231], v3
  v_smfmac_f32_16x16x64_bf16 v[56:59], v[8:11], v[200:207], v3
  s_waitcnt lgkmcnt(0)
  v_smfmac_f32_16x16x64_bf16 v[60:63], v[8:11], v[64:71], v3
  ds_read_b128 v[72:75], v0 offset:2048
  ds_read_b128 v[76:79], v0 offset:3072
  v_smfmac_f32_16x16x64_bf16 v[36:39], v[12:15], a[8:15], v3
  v_smfmac_f32_16x16x64_bf16 v[40:43], v[12:15], a[64:71], v3
  v_smfmac_f32_16x16x64_bf16 v[44:47], v[12:15], a[120:127], v3
  v_smfmac_f32_16x16x64_bf16 v[48:51], v[12:15], a[176:183], v3
  v_smfmac_f32_16x16x64_bf16 v[52:55], v[12:15], a[232:239], v3
  v_smfmac_f32_16x16x64_bf16 v[56:59], v[12:15], v[208:215], v3
  s_waitcnt lgkmcnt(0)
  v_smfmac_f32_16x16x64_bf16 v[60:63], v[12:15], v[72:79], v3
  ds_read_b128 v[144:147], v0 offset:4096
  ds_read_b128 v[148:151], v0 offset:5120
  v_smfmac_f32_16x16x64_bf16 v[36:39], v[16:19], a[16:23], v3
  v_smfmac_f32_16x16x64_bf16 v[40:43], v[16:19], a[72:79], v3
  v_smfmac_f32_16x16x64_bf16 v[44:47], v[16:19], a[128:135], v3
  v_smfmac_f32_16x16x64_bf16 v[48:51], v[16:19], a[184:191], v3
  v_smfmac_f32_16x16x64_bf16 v[52:55], v[16:19], a[240:247], v3
  v_smfmac_f32_16x16x64_bf16 v[56:59], v[16:19], v[216:223], v3
  s_waitcnt lgkmcnt(0)
  v_smfmac_f32_16x16x64_bf16 v[60:63], v[16:19], v[144:151], v3
  ds_read_b128 v[64:67], v0 offset:6144
  ds_read_b128 v[68:71], v0 offset:7168
  v_smfmac_f32_16x16x64_bf16 v[36:39], v[20:23], a[24:31], v3
  v_smfmac_f32_16x16x64_bf16 v[40:43], v[20:23], a[80:87], v3
  v_smfmac_f32_16x16x64_bf16 v[44:47], v[20:23], a[136:143], v3
  v_smfmac_f32_16x16x64_bf16 v[48:51], v[20:23], a[192:199], v3
  v_smfmac_f32_16x16x64_bf16 v[52:55], v[20:23], a[248:255], v3
  v_smfmac_f32_16x16x64_bf16 v[56:59], v[20:23], v[224:231], v3
  s_waitcnt lgkmcnt(0)
  v_smfmac_f32_16x16x64_bf16 v[60:63], v[20:23], v[64:71], v3
  ds_read_b128 v[72:75], v0 offset:8192
  ds_read_b128 v[76:79], v0 offset:9216
  v_smfmac_f32_16x16x64_bf16 v[36:39], v[24:27], a[32:39], v3
  v_smfmac_f32_16x16x64_bf16 v[40:43], v[24:27], a[88:95], v3
  v_smfmac_f32_16x16x64_bf16 v[44:47], v[24:27], a[144:151], v3
  v_smfmac_f32_16x16x64_bf16 v[48:51], v[24:27], a[200:207], v3
  v_smfmac_f32_16x16x64_bf16 v[52:55], v[24:27], v[176:183], v3
  v_smfmac_f32_16x16x64_bf16 v[56:59], v[24:27], v[232:239], v3
  s_waitcnt lgkmcnt(0)
  v_smfmac_f32_16x16x64_bf16 v[60:63], v[24:27], v[72:79], v3
  ds_read_b128 v[144:147], v0 offset:10240
  ds_read_b128 v[148:151], v0 offset:11264
  v_smfmac_f32_16x16x64_bf16 v[36:39], v[28:31], a[40:47], v3
  v_smfmac_f32_16x16x64_bf16 v[40:43], v[28:31], a[96:103], v3
  v_smfmac_f32_16x16x64_bf16 v[44:47], v[28:31], a[152:159], v3
  v_smfmac_f32_16x16x64_bf16 v[48:51], v[28:31], a[208:215], v3
  v_smfmac_f32_16x16x64_bf16 v[52:55], v[28:31], v[184:191], v3
  v_smfmac_f32_16x16x64_bf16 v[56:59], v[28:31], v[240:247], v3
  s_waitcnt lgkmcnt(0)
  v_smfmac_f32_16x16x64_bf16 v[60:63], v[28:31], v[144:151], v3
  ds_read_b128 v[64:67], v0 offset:12288
  ds_read_b128 v[68:71], v0 offset:13312
  v_smfmac_f32_16x16x64_bf16 v[36:39], v[32:35], a[48:55], v3
  v_smfmac_f32_16x16x64_bf16 v[40:43], v[32:35], a[104:111], v3
  v_smfmac_f32_16x16x64_bf16 v[44:47], v[32:35], a[160:167], v3
  v_smfmac_f32_16x16x64_bf16 v[48:51], v[32:35], a[216:223], v3
  v_smfmac_f32_16x16x64_bf16 v[52:55], v[32:35], v[192:199], v3
  v_smfmac_f32_16x16x64_bf16 v[56:59], v[32:35], v[248:255], v3
  s_waitcnt lgkmcnt(0)
  v_smfmac_f32_16x16x64_bf16 v[60:63], v[32:35], v[64:71], v3
  v_permlane32_swap_b32 v36, v38
  v_permlane32_swap_b32 v37, v39
  v_add_f32 v36, v36, v38
  v_add_f32 v37, v37, v39
  v_cvt_pk_bf16_f32 v38, v36, v37
  ds_write_b32 v152, v38
  v_permlane32_swap_b32 v40, v42
  v_permlane32_swap_b32 v41, v43
  v_add_f32 v40, v40, v42
  v_add_f32 v41, v41, v43
  v_cvt_pk_bf16_f32 v42, v40, v41
  ds_write_b32 v153, v42
  v_permlane32_swap_b32 v44, v46
  v_permlane32_swap_b32 v45, v47
  v_add_f32 v44, v44, v46
  v_add_f32 v45, v45, v47
  v_cvt_pk_bf16_f32 v46, v44, v45
  ds_write_b32 v154, v46
  v_permlane32_swap_b32 v48, v50
  v_permlane32_swap_b32 v49, v51
  v_add_f32 v48, v48, v50
  v_add_f32 v49, v49, v51
  v_cvt_pk_bf16_f32 v50, v48, v49
  ds_write_b32 v155, v50
  v_permlane32_swap_b32 v52, v54
  v_permlane32_swap_b32 v53, v55
  v_add_f32 v52, v52, v54
  v_add_f32 v53, v53, v55
  v_cvt_pk_bf16_f32 v54, v52, v53
  ds_write_b32 v156, v54
  v_permlane32_swap_b32 v56, v58
  v_permlane32_swap_b32 v57, v59
  v_add_f32 v56, v56, v58
  v_add_f32 v57, v57, v59
  v_cvt_pk_bf16_f32 v58, v56, v57
  ds_write_b32 v157, v58
  v_permlane32_swap_b32 v60, v62
  v_permlane32_swap_b32 v61, v63
  v_add_f32 v60, v60, v62
  v_add_f32 v61, v61, v63
  v_cvt_pk_bf16_f32 v62, v60, v61
  ds_write_b32 v158, v62
  s_branch cB_va1_t2d
cB_va1_rp:
  s_cmp_lg_u32 s37, 0
  s_cbranch_scc1 cB_va1_cont
cB_va1_rv:
  s_add_u32 s31, s31, 0x10000
  buffer_load_dwordx4 v[8:11], v2, s[8:11], s22 offen offset:0 sc1
  buffer_load_dwordx4 v[12:15], v2, s[8:11], s22 offen offset:1024 sc1
  buffer_load_dwordx4 v[16:19], v2, s[8:11], s22 offen offset:2048 sc1
  buffer_load_dwordx4 v[20:23], v2, s[8:11], s22 offen offset:3072 sc1
  buffer_load_dwordx4 v[24:27], v2, s[8:11], s34 offen offset:0 sc1
  buffer_load_dwordx4 v[28:31], v2, s[8:11], s34 offen offset:1024 sc1
  buffer_load_dwordx4 v[32:35], v2, s[8:11], s34 offen offset:2048 sc1
  buffer_load_dwordx4 v[36:39], v2, s[8:11], s34 offen offset:3072 sc1
  buffer_load_dwordx4 v[40:43], v2, s[8:11], s36 offen offset:0 sc1
  buffer_load_dwordx4 v[44:47], v2, s[8:11], s36 offen offset:1024 sc1
  s_waitcnt vmcnt(0)
  v_max3_u32 v52, v8, v9, v10
  v_max3_u32 v52, v52, v11, v12
  v_max3_u32 v52, v52, v13, v14
  v_max3_u32 v52, v52, v15, v16
  v_max3_u32 v52, v52, v17, v18
  v_max3_u32 v52, v52, v19, v20
  v_max3_u32 v52, v52, v21, v22
  v_max3_u32 v52, v52, v23, v24
  v_max3_u32 v52, v52, v25, v26
  v_max3_u32 v52, v52, v27, v28
  v_max3_u32 v52, v52, v29, v30
  v_max3_u32 v52, v52, v31, v32
  v_max3_u32 v52, v52, v33, v34
  v_max3_u32 v52, v52, v35, v36
  v_max3_u32 v52, v52, v37, v38
  v_max3_u32 v52, v52, v39, v40
  v_max3_u32 v52, v52, v41, v42
  v_max3_u32 v52, v52, v43, v44
  v_max3_u32 v52, v52, v45, v46
  v_max_u32 v52, v52, v47
  v_cmp_eq_u32 vcc, -1, v52
  s_mov_b32 s37, 1
  v_mov_b32 v48, 0
  v_mov_b32 v49, 0
  v_mov_b32 v50, 0
  v_mov_b32 v51, 0
  s_nop 1
  s_cbranch_vccz cB_va1_lp
  s_add_u32 s30, s30, 1
  s_cmp_lt_u32 s30, 400000
  s_cbranch_scc1 cB_va1_rv
  s_branch cB_abort
.p2align 6
cB_va2_loop:
  s_mov_b32 s30, 0
cB_va2_fp_l:
  v_cmp_gt_u32 vcc, s19, v88
  buffer_load_dword v88, v119, s[8:11], 0 offen sc1
  s_cbranch_vccz cB_va2_fp_d
  v_cmp_gt_u32 vcc, s19, v88
  buffer_load_dword v88, v119, s[8:11], 0 offen sc1
  s_cbranch_vccz cB_va2_fp_d
  v_cmp_gt_u32 vcc, s19, v88
  buffer_load_dword v88, v119, s[8:11], 0 offen sc1
  s_cbranch_vccz cB_va2_fp_d
  v_cmp_gt_u32 vcc, s19, v88
  buffer_load_dword v88, v119, s[8:11], 0 offen sc1
  s_cbranch_vccz cB_va2_fp_d
  v_cmp_gt_u32 vcc, s19, v88
  buffer_load_dword v88, v119, s[8:11], 0 offen sc1
  s_cbranch_vccz cB_va2_fp_d
  v_cmp_gt_u32 vcc, s19, v88
  buffer_load_dword v88, v119, s[8:11], 0 offen sc1
  s_cbranch_vccz cB_va2_fp_d
  v_cmp_gt_u32 vcc, s19, v88
  buffer_load_dword v88, v119, s[8:11], 0 offen sc1
  s_cbranch_vccz cB_va2_fp_d
  v_cmp_gt_u32 vcc, s19, v88
  buffer_load_dword v88, v119, s[8:11], 0 offen sc1
  s_cbranch_vccz cB_va2_fp_d
  v_cmp_gt_u32 vcc, s19, v88
  buffer_load_dword v88, v119, s[8:11], 0 offen sc1
  s_cbranch_vccz cB_va2_fp_d
  v_cmp_gt_u32 vcc, s19, v88
  buffer_load_dword v88, v119, s[8:11], 0 offen sc1
  s_cbranch_vccz cB_va2_fp_d
  v_cmp_gt_u32 vcc, s19, v88
  buffer_load_dword v88, v119, s[8:11], 0 offen sc1
  s_cbranch_vccz cB_va2_fp_d
  v_cmp_gt_u32 vcc, s19, v88
  buffer_load_dword v88, v119, s[8:11], 0 offen sc1
  s_cbranch_vccz cB_va2_fp_d
  v_cmp_gt_u32 vcc, s19, v88
  buffer_load_dword v88, v119, s[8:11], 0 offen sc1
  s_cbranch_vccz cB_va2_fp_d
  v_cmp_gt_u32 vcc, s19, v88
  buffer_load_dword v88, v119, s[8:11], 0 offen sc1
  s_cbranch_vccz cB_va2_fp_d
  v_cmp_gt_u32 vcc, s19, v88
  buffer_load_dword v88, v119, s[8:11], 0 offen sc1
  s_cbranch_vccz cB_va2_fp_d
  v_cmp_gt_u32 vcc, s19, v88
  buffer_load_dword v88, v119, s[8:11], 0 offen sc1
  s_cbranch_vccz cB_va2_fp_d
  s_waitcnt vmcnt(24)
  s_add_u32 s30, s30, 1
  s_cmp_lt_u32 s30, 400000
  s_cbranch_scc1 cB_va2_fp_l
  s_branch cB_abort
cB_va2_fp_d:
  buffer_load_dwordx4 v[8:11], v2, s[8:11], s20 offen offset:0 sc1
  buffer_load_dwordx4 v[12:15], v2, s[8:11], s20 offen offset:1024 sc1
  s_barrier
  s_barrier
  s_waitcnt vmcnt(0)
  ds_write_b128 v2, v[8:11] offset:8192
  ds_write_b128 v2, v[12:15] offset:9216
  v_smfmac_f32_16x16x64_bf16 v[36:39], v[8:11], a[0:7], v3
  v_smfmac_f32_16x16x64_bf16 v[40:43], v[8:11], a[56:63], v3
  v_smfmac_f32_16x16x64_bf16 v[44:47], v[8:11], a[112:119], v3
  v_smfmac_f32_16x16x64_bf16 v[48:51], v[8:11], a[168:175], v3
  v_smfmac_f32_16x16x64_bf16 v[52:55], v[8:11], a[224:231], v3
  s_waitcnt lgkmcnt(0)
  s_barrier
  ds_read_b128 v[16:19], v2 offset:10240
  ds_read_b128 v[20:23], v2 offset:11264
  ds_read_b128 v[24:27], v2 offset:12288
  ds_read_b128 v[28:31], v2 offset:13312
  ds_read_b128 v[32:35], v2 offset:14336
  v_smfmac_f32_16x16x64_bf16 v[56:59], v[8:11], v[144:151], v3
  v_smfmac_f32_16x16x64_bf16 v[60:63], v[8:11], v[200:207], v3
  v_smfmac_f32_16x16x64_bf16 v[36:39], v[12:15], a[8:15], v3
  v_smfmac_f32_16x16x64_bf16 v[40:43], v[12:15], a[64:71], v3
  v_smfmac_f32_16x16x64_bf16 v[44:47], v[12:15], a[120:127], v3
  v_smfmac_f32_16x16x64_bf16 v[48:51], v[12:15], a[176:183], v3
  v_smfmac_f32_16x16x64_bf16 v[52:55], v[12:15], a[232:239], v3
  v_smfmac_f32_16x16x64_bf16 v[56:59], v[12:15], v[152:159], v3
  v_smfmac_f32_16x16x64_bf16 v[60:63], v[12:15], v[208:215], v3
  s_waitcnt lgkmcnt(4)
  v_smfmac_f32_16x16x64_bf16 v[36:39], v[16:19], a[16:23], v3
  s_waitcnt lgkmcnt(3)
  v_smfmac_f32_16x16x64_bf16 v[36:39], v[20:23], a[24:31], v3
  s_waitcnt lgkmcnt(2)
  v_smfmac_f32_16x16x64_bf16 v[36:39], v[24:27], a[32:39], v3
  s_waitcnt lgkmcnt(1)
  v_smfmac_f32_16x16x64_bf16 v[36:39], v[28:31], a[40:47], v3
  s_waitcnt lgkmcnt(0)
  v_smfmac_f32_16x16x64_bf16 v[36:39], v[32:35], a[48:55], v3
  v_smfmac_f32_16x16x64_bf16 v[40:43], v[16:19], a[72:79], v3
  v_smfmac_f32_16x16x64_bf16 v[40:43], v[20:23], a[80:87], v3
  v_smfmac_f32_16x16x64_bf16 v[40:43], v[24:27], a[88:95], v3
  v_permlane32_swap_b32 v36, v38
  v_smfmac_f32_16x16x64_bf16 v[40:43], v[28:31], a[96:103], v3
  v_permlane32_swap_b32 v37, v39
  v_smfmac_f32_16x16x64_bf16 v[40:43], v[32:35], a[104:111], v3
  v_add_f32 v36, v36, v38
  v_smfmac_f32_16x16x64_bf16 v[44:47], v[16:19], a[128:135], v3
  v_add_f32 v37, v37, v39
  v_smfmac_f32_16x16x64_bf16 v[44:47], v[20:23], a[136:143], v3
  v_cmp_u_f32 vcc, v36, v37
  v_smfmac_f32_16x16x64_bf16 v[44:47], v[24:27], a[144:151], v3
  v_cvt_pk_bf16_f32 v38, v36, v37
  v_smfmac_f32_16x16x64_bf16 v[44:47], v[28:31], a[152:159], v3
  ds_write_b32 v104, v38
  s_cbranch_vccnz cB_va2_slow
  v_permlane32_swap_b32 v40, v42
  v_smfmac_f32_16x16x64_bf16 v[44:47], v[32:35], a[160:167], v3
  v_permlane32_swap_b32 v41, v43
  v_smfmac_f32_16x16x64_bf16 v[48:51], v[16:19], a[184:191], v3
  v_add_f32 v40, v40, v42
  v_smfmac_f32_16x16x64_bf16 v[48:51], v[20:23], a[192:199], v3
  v_add_f32 v41, v41, v43
  v_smfmac_f32_16x16x64_bf16 v[48:51], v[24:27], a[200:207], v3
  v_cvt_pk_bf16_f32 v42, v40, v41
  v_smfmac_f32_16x16x64_bf16 v[48:51], v[28:31], a[208:215], v3
  ds_write_b32 v105, v42
  v_permlane32_swap_b32 v44, v46
  v_smfmac_f32_16x16x64_bf16 v[48:51], v[32:35], a[216:223], v3
  v_permlane32_swap_b32 v45, v47
  v_smfmac_f32_16x16x64_bf16 v[52:55], v[16:19], a[240:247], v3
  v_add_f32 v44, v44, v46
  v_smfmac_f32_16x16x64_bf16 v[52:55], v[20:23], a[248:255], v3
  v_add_f32 v45, v45, v47
  v_smfmac_f32_16x16x64_bf16 v[52:55], v[24:27], v[120:127], v3
  v_cvt_pk_bf16_f32 v46, v44, v45
  v_smfmac_f32_16x16x64_bf16 v[52:55], v[28:31], v[128:135], v3
  ds_write_b32 v106, v46
  v_permlane32_swap_b32 v48, v50
  v_smfmac_f32_16x16x64_bf16 v[52:55], v[32:35], v[136:143], v3
  v_permlane32_swap_b32 v49, v51
  v_smfmac_f32_16x16x64_bf16 v[56:59], v[16:19], v[160:167], v3
  v_add_f32 v48, v48, v50
  v_smfmac_f32_16x16x64_bf16 v[56:59], v[20:23], v[168:175], v3
  v_add_f32 v49, v49, v51
  v_smfmac_f32_16x16x64_bf16 v[56:59], v[24:27], v[176:183], v3
  v_cvt_pk_bf16_f32 v50, v48, v49
  v_smfmac_f32_16x16x64_bf16 v[56:59], v[28:31], v[184:191], v3
  ds_write_b32 v107, v50
  v_permlane32_swap_b32 v52, v54
  v_smfmac_f32_16x16x64_bf16 v[56:59], v[32:35], v[192:199], v3
  v_permlane32_swap_b32 v53, v55
  v_smfmac_f32_16x16x64_bf16 v[60:63], v[16:19], v[216:223], v3
  v_add_f32 v52, v52, v54
  v_smfmac_f32_16x16x64_bf16 v[60:63], v[20:23], v[224:231], v3
  v_add_f32 v53, v53, v55
  v_smfmac_f32_16x16x64_bf16 v[60:63], v[24:27], v[232:239], v3
  v_cvt_pk_bf16_f32 v54, v52, v53
  v_smfmac_f32_16x16x64_bf16 v[60:63], v[28:31], v[240:247], v3
  ds_write_b32 v108, v54
  v_permlane32_swap_b32 v56, v58
  v_smfmac_f32_16x16x64_bf16 v[60:63], v[32:35], v[248:255], v3
  v_permlane32_swap_b32 v57, v59
  v_add_f32 v56, v56, v58
  v_add_f32 v57, v57, v59
  v_cvt_pk_bf16_f32 v58, v56, v57
  ds_write_b32 v109, v58
  s_nop 2
  v_permlane32_swap_b32 v60, v62
  v_permlane32_swap_b32 v61, v63
  v_add_f32 v60, v60, v62
  v_add_f32 v61, v61, v63
  v_cvt_pk_bf16_f32 v62, v60, v61
  ds_write_b32 v110, v62
cB_va2_t2d:
  v_mov_b32 v117, s18
  s_waitcnt lgkmcnt(0)
  s_barrier
  s_cmp_eq_u32 s19, 62
  s_cbranch_scc1 cB_done
  s_sleep 1
  v_mov_b32 v36, 0
  v_mov_b32 v37, 0
  v_mov_b32 v38, 0
  v_mov_b32 v39, 0
  v_mov_b32 v40, 0
  v_mov_b32 v41, 0
  v_mov_b32 v42, 0
  v_mov_b32 v43, 0
  v_mov_b32 v44, 0
  v_mov_b32 v45, 0
  v_mov_b32 v46, 0
  v_mov_b32 v47, 0
  v_mov_b32 v48, 0
  v_mov_b32 v49, 0
  v_mov_b32 v50, 0
  v_mov_b32 v51, 0
  v_mov_b32 v52, 0
  v_mov_b32 v53, 0
  v_mov_b32 v54, 0
  v_mov_b32 v55, 0
  v_mov_b32 v56, 0
  v_mov_b32 v57, 0
  v_mov_b32 v58, 0
  v_mov_b32 v59, 0
  v_mov_b32 v60, 0
  v_mov_b32 v61, 0
  v_mov_b32 v62, 0
  v_mov_b32 v63, 0
  s_sleep 5
  s_mov_b32 s19, s18
  s_add_u32 s18, s18, 1
  s_mov_b32 s22, s20
  s_mov_b32 s20, s21
  s_mov_b32 s21, s22
  s_add_u32 s23, s20, 4096
  s_branch cB_va2_loop
cB_va2_slow:
  s_waitcnt lgkmcnt(0)
cB_va2_sl1:
  s_add_u32 s31, s31, 0x1000000
  buffer_load_dwordx4 v[8:11], v2, s[8:11], s20 offen offset:0 sc1
  buffer_load_dwordx4 v[12:15], v2, s[8:11], s20 offen offset:1024 sc1
  buffer_load_dwordx4 v[16:19], v2, s[8:11], s20 offen offset:2048 sc1
  buffer_load_dwordx4 v[20:23], v2, s[8:11], s20 offen offset:3072 sc1
  buffer_load_dwordx4 v[24:27], v2, s[8:11], s23 offen offset:0 sc1
  buffer_load_dwordx4 v[28:31], v2, s[8:11], s23 offen offset:1024 sc1
  buffer_load_dwordx4 v[32:35], v2, s[8:11], s23 offen offset:2048 sc1
  s_waitcnt vmcnt(0)
  v_max3_u32 v36, v8, v9, v10
  v_max3_u32 v36, v36, v11, v12
  v_max3_u32 v36, v36, v13, v14
  v_max3_u32 v36, v36, v15, v16
  v_max3_u32 v36, v36, v17, v18
  v_max3_u32 v36, v36, v19, v20
  v_max3_u32 v36, v36, v21, v22
  v_max3_u32 v36, v36, v23, v24
  v_max3_u32 v36, v36, v25, v26
  v_max3_u32 v36, v36, v27, v28
  v_max3_u32 v36, v36, v29, v30
  v_max3_u32 v36, v36, v31, v32
  v_max3_u32 v36, v36, v33, v34
  v_max_u32 v36, v36, v35
  v_cmp_eq_u32 vcc, -1, v36
  s_cbranch_vccz cB_va2_sl2
  s_add_u32 s30, s30, 1
  s_cmp_lt_u32 s30, 400000
  s_cbranch_scc1 cB_va2_sl1
  s_branch cB_abort
cB_va2_sl2:
  v_mov_b32 v36, 0
  v_mov_b32 v37, 0
  v_mov_b32 v38, 0
  v_mov_b32 v39, 0
  v_mov_b32 v40, 0
  v_mov_b32 v41, 0
  v_mov_b32 v42, 0
  v_mov_b32 v43, 0
  v_mov_b32 v44, 0
  v_mov_b32 v45, 0
  v_mov_b32 v46, 0
  v_mov_b32 v47, 0
  v_mov_b32 v48, 0
  v_mov_b32 v49, 0
  v_mov_b32 v50, 0
  v_mov_b32 v51, 0
  v_mov_b32 v52, 0
  v_mov_b32 v53, 0
  v_mov_b32 v54, 0
  v_mov_b32 v55, 0
  v_mov_b32 v56, 0
  v_mov_b32 v57, 0
  v_mov_b32 v58, 0
  v_mov_b32 v59, 0
  v_mov_b32 v60, 0
  v_mov_b32 v61, 0
  v_mov_b32 v62, 0
  v_mov_b32 v63, 0
  v_smfmac_f32_16x16x64_bf16 v[36:39], v[8:11], a[0:7], v3
  v_smfmac_f32_16x16x64_bf16 v[40:43], v[8:11], a[56:63], v3
  v_smfmac_f32_16x16x64_bf16 v[44:47], v[8:11], a[112:119], v3
  v_smfmac_f32_16x16x64_bf16 v[48:51], v[8:11], a[168:175], v3
  v_smfmac_f32_16x16x64_bf16 v[52:55], v[8:11], a[224:231], v3
  v_smfmac_f32_16x16x64_bf16 v[56:59], v[8:11], v[144:151], v3
  v_smfmac_f32_16x16x64_bf16 v[60:63], v[8:11], v[200:207], v3
  v_smfmac_f32_16x16x64_bf16 v[36:39], v[12:15], a[8:15], v3
  v_smfmac_f32_16x16x64_bf16 v[40:43], v[12:15], a[64:71], v3
  v_smfmac_f32_16x16x64_bf16 v[44:47], v[12:15], a[120:127], v3
  v_smfmac_f32_16x16x64_bf16 v[48:51], v[12:15], a[176:183], v3
  v_smfmac_f32_16x16x64_bf16 v[52:55], v[12:15], a[232:239], v3
  v_smfmac_f32_16x16x64_bf16 v[56:59], v[12:15], v[152:159], v3
  v_smfmac_f32_16x16x64_bf16 v[60:63], v[12:15], v[208:215], v3
  v_smfmac_f32_16x16x64_bf16 v[36:39], v[16:19], a[16:23], v3
  v_smfmac_f32_16x16x64_bf16 v[40:43], v[16:19], a[72:79], v3
  v_smfmac_f32_16x16x64_bf16 v[44:47], v[16:19], a[128:135], v3
  v_smfmac_f32_16x16x64_bf16 v[48:51], v[16:19], a[184:191], v3
  v_smfmac_f32_16x16x64_bf16 v[52:55], v[16:19], a[240:247], v3
  v_smfmac_f32_16x16x64_bf16 v[56:59], v[16:19], v[160:167], v3
  v_smfmac_f32_16x16x64_bf16 v[60:63], v[16:19], v[216:223], v3
  v_smfmac_f32_16x16x64_bf16 v[36:39], v[20:23], a[24:31], v3
  v_smfmac_f32_16x16x64_bf16 v[40:43], v[20:23], a[80:87], v3
  v_smfmac_f32_16x16x64_bf16 v[44:47], v[20:23], a[136:143], v3
  v_smfmac_f32_16x16x64_bf16 v[48:51], v[20:23], a[192:199], v3
  v_smfmac_f32_16x16x64_bf16 v[52:55], v[20:23], a[248:255], v3
  v_smfmac_f32_16x16x64_bf16 v[56:59], v[20:23], v[168:175], v3
  v_smfmac_f32_16x16x64_bf16 v[60:63], v[20:23], v[224:231], v3
  v_smfmac_f32_16x16x64_bf16 v[36:39], v[24:27], a[32:39], v3
  v_smfmac_f32_16x16x64_bf16 v[40:43], v[24:27], a[88:95], v3
  v_smfmac_f32_16x16x64_bf16 v[44:47], v[24:27], a[144:151], v3
  v_smfmac_f32_16x16x64_bf16 v[48:51], v[24:27], a[200:207], v3
  v_smfmac_f32_16x16x64_bf16 v[52:55], v[24:27], v[120:127], v3
  v_smfmac_f32_16x16x64_bf16 v[56:59], v[24:27], v[176:183], v3
  v_smfmac_f32_16x16x64_bf16 v[60:63], v[24:27], v[232:239], v3
  v_smfmac_f32_16x16x64_bf16 v[36:39], v[28:31], a[40:47], v3
  v_smfmac_f32_16x16x64_bf16 v[40:43], v[28:31], a[96:103], v3
  v_smfmac_f32_16x16x64_bf16 v[44:47], v[28:31], a[152:159], v3
  v_smfmac_f32_16x16x64_bf16 v[48:51], v[28:31], a[208:215], v3
  v_smfmac_f32_16x16x64_bf16 v[52:55], v[28:31], v[128:135], v3
  v_smfmac_f32_16x16x64_bf16 v[56:59], v[28:31], v[184:191], v3
  v_smfmac_f32_16x16x64_bf16 v[60:63], v[28:31], v[240:247], v3
  v_smfmac_f32_16x16x64_bf16 v[36:39], v[32:35], a[48:55], v3
  v_smfmac_f32_16x16x64_bf16 v[40:43], v[32:35], a[104:111], v3
  v_smfmac_f32_16x16x64_bf16 v[44:47], v[32:35], a[160:167], v3
  v_smfmac_f32_16x16x64_bf16 v[48:51], v[32:35], a[216:223], v3
  v_smfmac_f32_16x16x64_bf16 v[52:55], v[32:35], v[136:143], v3
  v_smfmac_f32_16x16x64_bf16 v[56:59], v[32:35], v[192:199], v3
  v_smfmac_f32_16x16x64_bf16 v[60:63], v[32:35], v[248:255], v3
  v_permlane32_swap_b32 v36, v38
  v_permlane32_swap_b32 v37, v39
  v_add_f32 v36, v36, v38
  v_add_f32 v37, v37, v39
  v_cvt_pk_bf16_f32 v38, v36, v37
  ds_write_b32 v104, v38
  v_permlane32_swap_b32 v40, v42
  v_permlane32_swap_b32 v41, v43
  v_add_f32 v40, v40, v42
  v_add_f32 v41, v41, v43
  v_cvt_pk_bf16_f32 v42, v40, v41
  ds_write_b32 v105, v42
  v_permlane32_swap_b32 v44, v46
  v_permlane32_swap_b32 v45, v47
  v_add_f32 v44, v44, v46
  v_add_f32 v45, v45, v47
  v_cvt_pk_bf16_f32 v46, v44, v45
  ds_write_b32 v106, v46
  v_permlane32_swap_b32 v48, v50
  v_permlane32_swap_b32 v49, v51
  v_add_f32 v48, v48, v50
  v_add_f32 v49, v49, v51
  v_cvt_pk_bf16_f32 v50, v48, v49
  ds_write_b32 v107, v50
  v_permlane32_swap_b32 v52, v54
  v_permlane32_swap_b32 v53, v55
  v_add_f32 v52, v52, v54
  v_add_f32 v53, v53, v55
  v_cvt_pk_bf16_f32 v54, v52, v53
  ds_write_b32 v108, v54
  v_permlane32_swap_b32 v56, v58
  v_permlane32_swap_b32 v57, v59
  v_add_f32 v56, v56, v58
  v_add_f32 v57, v57, v59
  v_cvt_pk_bf16_f32 v58, v56, v57
  ds_write_b32 v109, v58
  v_permlane32_swap_b32 v60, v62
  v_permlane32_swap_b32 v61, v63
  v_add_f32 v60, v60, v62
  v_add_f32 v61, v61, v63
  v_cvt_pk_bf16_f32 v62, v60, v61
  ds_write_b32 v110, v62
  s_branch cB_va2_t2d
.p2align 6
cB_va3_loop:
  s_mov_b32 s30, 0
  s_barrier
  buffer_load_dwordx4 v[16:19], v2, s[8:11], s20 offen offset:2048 sc1
  buffer_load_dwordx4 v[20:23], v2, s[8:11], s20 offen offset:3072 sc1
  s_barrier
  buffer_load_dword v100, v116, s[8:11], s39 offen sc1
  s_add_u32 s27, s19, 2
  s_min_u32 s27, s27, 63
  s_lshr_b32 s27, s27, 3
  s_lshl_b32 s27, s27, 11
  s_add_u32 s27, s27, s35
  s_cmp_eq_u32 s27, s28
  s_cselect_b32 s29, 75729408, s27
  buffer_load_dword v101, off, s[8:11], s29 sc1
  s_add_u32 s39, s39, 28672
  s_waitcnt vmcnt(2)
  ds_write_b128 v2, v[16:19] offset:10240
  ds_write_b128 v2, v[20:23] offset:11264
  v_smfmac_f32_16x16x64_bf16 v[36:39], v[16:19], a[16:23], v3
  v_smfmac_f32_16x16x64_bf16 v[40:43], v[16:19], a[72:79], v3
  v_smfmac_f32_16x16x64_bf16 v[44:47], v[16:19], a[128:135], v3
  v_smfmac_f32_16x16x64_bf16 v[48:51], v[16:19], a[184:191], v3
  v_smfmac_f32_16x16x64_bf16 v[52:55], v[16:19], a[240:247], v3
  s_waitcnt lgkmcnt(0)
  s_barrier
  ds_read_b128 v[8:11], v2 offset:8192
  ds_read_b128 v[12:15], v2 offset:9216
  ds_read_b128 v[24:27], v2 offset:12288
  ds_read_b128 v[28:31], v2 offset:13312
  ds_read_b128 v[32:35], v2 offset:14336
  v_smfmac_f32_16x16x64_bf16 v[56:59], v[16:19], v[160:167], v3
  v_smfmac_f32_16x16x64_bf16 v[60:63], v[16:19], v[216:223], v3
  v_smfmac_f32_16x16x64_bf16 v[36:39], v[20:23], a[24:31], v3
  v_smfmac_f32_16x16x64_bf16 v[40:43], v[20:23], a[80:87], v3
  v_smfmac_f32_16x16x64_bf16 v[44:47], v[20:23], a[136:143], v3
  v_smfmac_f32_16x16x64_bf16 v[48:51], v[20:23], a[192:199], v3
  v_smfmac_f32_16x16x64_bf16 v[52:55], v[20:23], a[248:255], v3
  v_smfmac_f32_16x16x64_bf16 v[56:59], v[20:23], v[168:175], v3
  v_smfmac_f32_16x16x64_bf16 v[60:63], v[20:23], v[224:231], v3
  s_waitcnt lgkmcnt(4)
  v_smfmac_f32_16x16x64_bf16 v[36:39], v[8:11], a[0:7], v3
  s_waitcnt lgkmcnt(3)
  v_smfmac_f32_16x16x64_bf16 v[36:39], v[12:15], a[8:15], v3
  s_waitcnt lgkmcnt(2)
  v_smfmac_f32_16x16x64_bf16 v[36:39], v[24:27], a[32:39], v3
  s_waitcnt lgkmcnt(1)
  v_smfmac_f32_16x16x64_bf16 v[36:39], v[28:31], a[40:47], v3
  s_waitcnt lgkmcnt(0)
  v_smfmac_f32_16x16x64_bf16 v[36:39], v[32:35], a[48:55], v3
  v_smfmac_f32_16x16x64_bf16 v[40:43], v[8:11], a[56:63], v3
  v_smfmac_f32_16x16x64_bf16 v[40:43], v[12:15], a[64:71], v3
  v_smfmac_f32_16x16x64_bf16 v[40:43], v[24:27], a[88:95], v3
  v_permlane32_swap_b32 v36, v38
  v_smfmac_f32_16x16x64_bf16 v[40:43], v[28:31], a[96:103], v3
  v_permlane32_swap_b32 v37, v39
  v_smfmac_f32_16x16x64_bf16 v[40:43], v[32:35], a[104:111], v3
  v_add_f32 v36, v36, v38
  v_smfmac_f32_16x16x64_bf16 v[44:47], v[8:11], a[112:119], v3
  v_add_f32 v37, v37, v39
  v_smfmac_f32_16x16x64_bf16 v[44:47], v[12:15], a[120:127], v3
  v_cmp_u_f32 vcc, v36, v37
  v_smfmac_f32_16x16x64_bf16 v[44:47], v[24:27], a[144:151], v3
  v_cvt_pk_bf16_f32 v38, v36, v37
  v_smfmac_f32_16x16x64_bf16 v[44:47], v[28:31], a[152:159], v3
  ds_write_b32 v104, v38
  s_cbranch_vccnz cB_va3_slow
  v_permlane32_swap_b32 v40, v42
  v_smfmac_f32_16x16x64_bf16 v[44:47], v[32:35], a[160:167], v3
  v_permlane32_swap_b32 v41, v43
  v_smfmac_f32_16x16x64_bf16 v[48:51], v[8:11], a[168:175], v3
  v_add_f32 v40, v40, v42
  v_smfmac_f32_16x16x64_bf16 v[48:51], v[12:15], a[176:183], v3
  v_add_f32 v41, v41, v43
  v_smfmac_f32_16x16x64_bf16 v[48:51], v[24:27], a[200:207], v3
  v_cvt_pk_bf16_f32 v42, v40, v41
  v_smfmac_f32_16x16x64_bf16 v[48:51], v[28:31], a[208:215], v3
  ds_write_b32 v105, v42
  v_permlane32_swap_b32 v44, v46
  v_smfmac_f32_16x16x64_bf16 v[48:51], v[32:35], a[216:223], v3
  v_permlane32_swap_b32 v45, v47
  v_smfmac_f32_16x16x64_bf16 v[52:55], v[8:11], a[224:231], v3
  v_add_f32 v44, v44, v46
  v_smfmac_f32_16x16x64_bf16 v[52:55], v[12:15], a[232:239], v3
  v_add_f32 v45, v45, v47
  v_smfmac_f32_16x16x64_bf16 v[52:55], v[24:27], v[120:127], v3
  v_cvt_pk_bf16_f32 v46, v44, v45
  v_smfmac_f32_16x16x64_bf16 v[52:55], v[28:31], v[128:135], v3
  ds_write_b32 v106, v46
  v_permlane32_swap_b32 v48, v50
  v_smfmac_f32_16x16x64_bf16 v[52:55], v[32:35], v[136:143], v3
  v_permlane32_swap_b32 v49, v51
  v_smfmac_f32_16x16x64_bf16 v[56:59], v[8:11], v[144:151], v3
  v_add_f32 v48, v48, v50
  v_smfmac_f32_16x16x64_bf16 v[56:59], v[12:15], v[152:159], v3
  v_add_f32 v49, v49, v51
  v_smfmac_f32_16x16x64_bf16 v[56:59], v[24:27], v[176:183], v3
  v_cvt_pk_bf16_f32 v50, v48, v49
  v_smfmac_f32_16x16x64_bf16 v[56:59], v[28:31], v[184:191], v3
  ds_write_b32 v107, v50
  v_permlane32_swap_b32 v52, v54
  v_smfmac_f32_16x16x64_bf16 v[56:59], v[32:35], v[192:199], v3
  v_permlane32_swap_b32 v53, v55
  v_smfmac_f32_16x16x64_bf16 v[60:63], v[8:11], v[200:207], v3
  v_add_f32 v52, v52, v54
  v_smfmac_f32_16x16x64_bf16 v[60:63], v[12:15], v[208:215], v3
  v_add_f32 v53, v53, v55
  v_smfmac_f32_16x16x64_bf16 v[60:63], v[24:27], v[232:239], v3
  v_cvt_pk_bf16_f32 v54, v52, v53
  v_smfmac_f32_16x16x64_bf16 v[60:63], v[28:31], v[240:247], v3
  ds_write_b32 v108, v54
  v_permlane32_swap_b32 v56, v58
  v_smfmac_f32_16x16x64_bf16 v[60:63], v[32:35], v[248:255], v3
  v_permlane32_swap_b32 v57, v59
  v_add_f32 v56, v56, v58
  v_add_f32 v57, v57, v59
  v_cvt_pk_bf16_f32 v58, v56, v57
  ds_write_b32 v109, v58
  s_nop 2
  v_permlane32_swap_b32 v60, v62
  v_permlane32_swap_b32 v61, v63
  v_add_f32 v60, v60, v62
  v_add_f32 v61, v61, v63
  v_cvt_pk_bf16_f32 v62, v60, v61
  ds_write_b32 v110, v62
cB_va3_t2d:
  v_mov_b32 v117, s18
  s_cmp_eq_u32 s27, s28
  s_cbranch_scc1 cB_va3_vok
cB_va3_vow:
  s_waitcnt vmcnt(0)
  v_cmp_ne_u32 vcc, 56, v101
  s_cbranch_vccnz cB_va3_vor
  s_mov_b32 s28, s27
cB_va3_vok:
  s_waitcnt lgkmcnt(0)
  s_setprio 3
  s_barrier
  v_mov_b32 v36, 0
  v_mov_b32 v37, 0
  v_mov_b32 v38, 0
  v_mov_b32 v39, 0
  buffer_store_dword v117, v118, s[8:11], 0 offen sc1
  s_setprio 0
  s_cmp_eq_u32 s19, 62
  s_cbranch_scc1 cB_done
  v_mov_b32 v40, 0
  v_mov_b32 v41, 0
  v_mov_b32 v42, 0
  v_mov_b32 v43, 0
  v_mov_b32 v44, 0
  v_mov_b32 v45, 0
  v_mov_b32 v46, 0
  v_mov_b32 v47, 0
  v_mov_b32 v48, 0
  v_mov_b32 v49, 0
  v_mov_b32 v50, 0
  v_mov_b32 v51, 0
  v_mov_b32 v52, 0
  v_mov_b32 v53, 0
  v_mov_b32 v54, 0
  v_mov_b32 v55, 0
  v_mov_b32 v56, 0
  v_mov_b32 v57, 0
  v_mov_b32 v58, 0
  v_mov_b32 v59, 0
  v_mov_b32 v60, 0
  v_mov_b32 v61, 0
  v_mov_b32 v62, 0
  v_mov_b32 v63, 0
  s_mov_b32 s19, s18
  s_add_u32 s18, s18, 1
  s_mov_b32 s22, s20
  s_mov_b32 s20, s21
  s_mov_b32 s21, s22
  s_add_u32 s23, s20, 4096
  s_branch cB_va3_loop
cB_va3_slow:
  s_waitcnt lgkmcnt(0)
cB_va3_sl1:
  s_add_u32 s31, s31, 0x1000000
  buffer_load_dwordx4 v[8:11], v2, s[8:11], s20 offen offset:0 sc1
  buffer_load_dwordx4 v[12:15], v2, s[8:11], s20 offen offset:1024 sc1
  buffer_load_dwordx4 v[16:19], v2, s[8:11], s20 offen offset:2048 sc1
  buffer_load_dwordx4 v[20:23], v2, s[8:11], s20 offen offset:3072 sc1
  buffer_load_dwordx4 v[24:27], v2, s[8:11], s23 offen offset:0 sc1
  buffer_load_dwordx4 v[28:31], v2, s[8:11], s23 offen offset:1024 sc1
  buffer_load_dwordx4 v[32:35], v2, s[8:11], s23 offen offset:2048 sc1
  s_waitcnt vmcnt(0)
  v_max3_u32 v36, v8, v9, v10
  v_max3_u32 v36, v36, v11, v12
  v_max3_u32 v36, v36, v13, v14
  v_max3_u32 v36, v36, v15, v16
  v_max3_u32 v36, v36, v17, v18
  v_max3_u32 v36, v36, v19, v20
  v_max3_u32 v36, v36, v21, v22
  v_max3_u32 v36, v36, v23, v24
  v_max3_u32 v36, v36, v25, v26
  v_max3_u32 v36, v36, v27, v28
  v_max3_u32 v36, v36, v29, v30
  v_max3_u32 v36, v36, v31, v32
  v_max3_u32 v36, v36, v33, v34
  v_max_u32 v36, v36, v35
  v_cmp_eq_u32 vcc, -1, v36
  s_cbranch_vccz cB_va3_sl2
  s_add_u32 s30, s30, 1
  s_cmp_lt_u32 s30, 400000
  s_cbranch_scc1 cB_va3_sl1
  s_branch cB_abort
cB_va3_sl2:
  v_mov_b32 v36, 0
  v_mov_b32 v37, 0
  v_mov_b32 v38, 0
  v_mov_b32 v39, 0
  v_mov_b32 v40, 0
  v_mov_b32 v41, 0
  v_mov_b32 v42, 0
  v_mov_b32 v43, 0
  v_mov_b32 v44, 0
  v_mov_b32 v45, 0
  v_mov_b32 v46, 0
  v_mov_b32 v47, 0
  v_mov_b32 v48, 0
  v_mov_b32 v49, 0
  v_mov_b32 v50, 0
  v_mov_b32 v51, 0
  v_mov_b32 v52, 0
  v_mov_b32 v53, 0
  v_mov_b32 v54, 0
  v_mov_b32 v55, 0
  v_mov_b32 v56, 0
  v_mov_b32 v57, 0
  v_mov_b32 v58, 0
  v_mov_b32 v59, 0
  v_mov_b32 v60, 0
  v_mov_b32 v61, 0
  v_mov_b32 v62, 0
  v_mov_b32 v63, 0
  v_smfmac_f32_16x16x64_bf16 v[36:39], v[8:11], a[0:7], v3
  v_smfmac_f32_16x16x64_bf16 v[40:43], v[8:11], a[56:63], v3
  v_smfmac_f32_16x16x64_bf16 v[44:47], v[8:11], a[112:119], v3
  v_smfmac_f32_16x16x64_bf16 v[48:51], v[8:11], a[168:175], v3
  v_smfmac_f32_16x16x64_bf16 v[52:55], v[8:11], a[224:231], v3
  v_smfmac_f32_16x16x64_bf16 v[56:59], v[8:11], v[144:151], v3
  v_smfmac_f32_16x16x64_bf16 v[60:63], v[8:11], v[200:207], v3
  v_smfmac_f32_16x16x64_bf16 v[36:39], v[12:15], a[8:15], v3
  v_smfmac_f32_16x16x64_bf16 v[40:43], v[12:15], a[64:71], v3
  v_smfmac_f32_16x16x64_bf16 v[44:47], v[12:15], a[120:127], v3
  v_smfmac_f32_16x16x64_bf16 v[48:51], v[12:15], a[176:183], v3
  v_smfmac_f32_16x16x64_bf16 v[52:55], v[12:15], a[232:239], v3
  v_smfmac_f32_16x16x64_bf16 v[56:59], v[12:15], v[152:159], v3
  v_smfmac_f32_16x16x64_bf16 v[60:63], v[12:15], v[208:215], v3
  v_smfmac_f32_16x16x64_bf16 v[36:39], v[16:19], a[16:23], v3
  v_smfmac_f32_16x16x64_bf16 v[40:43], v[16:19], a[72:79], v3
  v_smfmac_f32_16x16x64_bf16 v[44:47], v[16:19], a[128:135], v3
  v_smfmac_f32_16x16x64_bf16 v[48:51], v[16:19], a[184:191], v3
  v_smfmac_f32_16x16x64_bf16 v[52:55], v[16:19], a[240:247], v3
  v_smfmac_f32_16x16x64_bf16 v[56:59], v[16:19], v[160:167], v3
  v_smfmac_f32_16x16x64_bf16 v[60:63], v[16:19], v[216:223], v3
  v_smfmac_f32_16x16x64_bf16 v[36:39], v[20:23], a[24:31], v3
  v_smfmac_f32_16x16x64_bf16 v[40:43], v[20:23], a[80:87], v3
  v_smfmac_f32_16x16x64_bf16 v[44:47], v[20:23], a[136:143], v3
  v_smfmac_f32_16x16x64_bf16 v[48:51], v[20:23], a[192:199], v3
  v_smfmac_f32_16x16x64_bf16 v[52:55], v[20:23], a[248:255], v3
  v_smfmac_f32_16x16x64_bf16 v[56:59], v[20:23], v[168:175], v3
  v_smfmac_f32_16x16x64_bf16 v[60:63], v[20:23], v[224:231], v3
  v_smfmac_f32_16x16x64_bf16 v[36:39], v[24:27], a[32:39], v3
  v_smfmac_f32_16x16x64_bf16 v[40:43], v[24:27], a[88:95], v3
  v_smfmac_f32_16x16x64_bf16 v[44:47], v[24:27], a[144:151], v3
  v_smfmac_f32_16x16x64_bf16 v[48:51], v[24:27], a[200:207], v3
  v_smfmac_f32_16x16x64_bf16 v[52:55], v[24:27], v[120:127], v3
  v_smfmac_f32_16x16x64_bf16 v[56:59], v[24:27], v[176:183], v3
  v_smfmac_f32_16x16x64_bf16 v[60:63], v[24:27], v[232:239], v3
  v_smfmac_f32_16x16x64_bf16 v[36:39], v[28:31], a[40:47], v3
  v_smfmac_f32_16x16x64_bf16 v[40:43], v[28:31], a[96:103], v3
  v_smfmac_f32_16x16x64_bf16 v[44:47], v[28:31], a[152:159], v3
  v_smfmac_f32_16x16x64_bf16 v[48:51], v[28:31], a[208:215], v3
  v_smfmac_f32_16x16x64_bf16 v[52:55], v[28:31], v[128:135], v3
  v_smfmac_f32_16x16x64_bf16 v[56:59], v[28:31], v[184:191], v3
  v_smfmac_f32_16x16x64_bf16 v[60:63], v[28:31], v[240:247], v3
  v_smfmac_f32_16x16x64_bf16 v[36:39], v[32:35], a[48:55], v3
  v_smfmac_f32_16x16x64_bf16 v[40:43], v[32:35], a[104:111], v3
  v_smfmac_f32_16x16x64_bf16 v[44:47], v[32:35], a[160:167], v3
  v_smfmac_f32_16x16x64_bf16 v[48:51], v[32:35], a[216:223], v3
  v_smfmac_f32_16x16x64_bf16 v[52:55], v[32:35], v[136:143], v3
  v_smfmac_f32_16x16x64_bf16 v[56:59], v[32:35], v[192:199], v3
  v_smfmac_f32_16x16x64_bf16 v[60:63], v[32:35], v[248:255], v3
  v_permlane32_swap_b32 v36, v38
  v_permlane32_swap_b32 v37, v39
  v_add_f32 v36, v36, v38
  v_add_f32 v37, v37, v39
  v_cvt_pk_bf16_f32 v38, v36, v37
  ds_write_b32 v104, v38
  v_permlane32_swap_b32 v40, v42
  v_permlane32_swap_b32 v41, v43
  v_add_f32 v40, v40, v42
  v_add_f32 v41, v41, v43
  v_cvt_pk_bf16_f32 v42, v40, v41
  ds_write_b32 v105, v42
  v_permlane32_swap_b32 v44, v46
  v_permlane32_swap_b32 v45, v47
  v_add_f32 v44, v44, v46
  v_add_f32 v45, v45, v47
  v_cvt_pk_bf16_f32 v46, v44, v45
  ds_write_b32 v106, v46
  v_permlane32_swap_b32 v48, v50
  v_permlane32_swap_b32 v49, v51
  v_add_f32 v48, v48, v50
  v_add_f32 v49, v49, v51
  v_cvt_pk_bf16_f32 v50, v48, v49
  ds_write_b32 v107, v50
  v_permlane32_swap_b32 v52, v54
  v_permlane32_swap_b32 v53, v55
  v_add_f32 v52, v52, v54
  v_add_f32 v53, v53, v55
  v_cvt_pk_bf16_f32 v54, v52, v53
  ds_write_b32 v108, v54
  v_permlane32_swap_b32 v56, v58
  v_permlane32_swap_b32 v57, v59
  v_add_f32 v56, v56, v58
  v_add_f32 v57, v57, v59
  v_cvt_pk_bf16_f32 v58, v56, v57
  ds_write_b32 v109, v58
  v_permlane32_swap_b32 v60, v62
  v_permlane32_swap_b32 v61, v63
  v_add_f32 v60, v60, v62
  v_add_f32 v61, v61, v63
  v_cvt_pk_bf16_f32 v62, v60, v61
  ds_write_b32 v110, v62
  s_branch cB_va3_t2d
cB_va3_vor:
  s_sleep 2
  buffer_load_dword v101, off, s[8:11], s27 sc1
  s_add_u32 s30, s30, 1
  s_cmp_lt_u32 s30, 400000
  s_cbranch_scc1 cB_va3_vow
  s_branch cB_abort
cB_abort:
  v_mov_b32 v4, 0xdead
  v_mov_b32 v5, 16
  buffer_store_dword v4, v5, s[12:15], 0 offen
  s_branch ch_end
cB_done:
  s_branch ch_end
ch_worker:
  s_sub_u32 s35, s3, 1
  s_and_b32 s35, s35, 7
  s_lshr_b32 s36, s2, 3
  s_lshl_b32 s33, s35, 5
  s_add_u32 s33, s33, s36
  s_mov_b32 s97, 0
  s_mov_b32 s96, 0
  s_mov_b32 s37, 0
  s_mov_b32 s38, 0
  s_mov_b32 s39, 0xffff0000
  s_mov_b32 s101, -1
  v_and_b32 v1, 63, v0
  v_lshlrev_b32 v2, 4, v1
  v_lshrrev_b32 v3, 4, v1
  v_and_b32 v4, 15, v1
  s_cmp_ge_u32 s33, 224
  s_cbranch_scc1 wp_all
  s_mov_b32 s68, s44
  s_and_b32 s69, s45, 0xffff
  s_mov_b32 s70, 3670016
  s_mov_b32 s71, 0x20000
  s_and_b32 s20, s33, 0xe0
  s_mul_i32 s20, s20, 9363
  s_lshr_b32 s20, s20, 16
  s_lshl_b32 s20, s20, 10
  s_and_b32 s21, s33, 31
  s_mul_i32 s21, s21, 192
  s_add_u32 s20, s20, s21
  v_min_u32 v7, 191, v0
  v_add_u32 v7, s20, v7
  v_lshrrev_b32 v8, 11, v7
  v_min_u32 v8, 15, v8
  v_bfe_u32 v9, v7, 2, 9
  v_lshlrev_b32 v9, 13, v9
  v_lshl_add_u32 v9, v8, 9, v9
  v_and_b32 v7, 3, v7
  v_lshl_add_u32 v9, v7, 7, v9
  buffer_load_dword v253, v9, s[68:71], 0 offen
  v_lshrrev_b32 v5, 5, v1
  v_and_b32 v6, 31, v1
  v_xor_b32 v8, v6, v5
  v_lshlrev_b32 v8, 4, v8
  v_lshl_add_u32 v16, v5, 13, v8
  v_xor_b32 v17, 32, v16
  v_xor_b32 v18, 64, v16
  v_xor_b32 v19, 96, v16
  v_xor_b32 v20, 128, v16
  v_xor_b32 v21, 160, v16
  v_xor_b32 v22, 192, v16
  v_xor_b32 v23, 224, v16
  s_lshl_b32 s20, s16, 6
  v_xor_b32 v26, s20, v16
  v_xor_b32 v27, 32, v26
wp_B:
  s_mul_i32 s17, s33, 4682
  s_lshr_b32 s17, s17, 16
  s_mul_i32 s23, s17, 14
  s_sub_u32 s19, s33, s23
  s_cmp_lt_u32 s19, 7
  s_cselect_b32 s18, 0, 7
  s_cselect_b32 s28, 0, 8
  s_sub_u32 s18, s19, s18
  s_add_u32 s28, s28, s16
  s_lshl_b32 s25, s16, 15
  s_add_u32 s25, s25, 32768
  s_lshl_b32 s26, s17, 9
  s_lshl_b32 s20, s33, 2
  s_add_u32 s20, s20, s16
  s_mul_i32 s21, s20, 9363
  s_lshr_b32 s21, s21, 16
  s_mul_i32 s22, s21, 7
  s_sub_u32 s22, s20, s22
  s_mul_i32 s21, s21, 14336
  s_lshl_b32 s20, s22, 7
  s_add_u32 s20, s20, s21
  s_lshl_b32 s22, s22, 11
  s_add_u32 s52, s21, s22
  s_mov_b32 s68, s48
  s_and_b32 s69, s49, 0xffff
  s_mov_b32 s70, 1835008
  s_mov_b32 s71, 0x20000
  v_mul_u32_u24 v7, 896, v4
  v_lshl_add_u32 v7, v3, 5, v7
  buffer_load_dwordx4 v[128:131], v7, s[68:71], s20 offen
  buffer_load_dwordx4 v[132:135], v7, s[68:71], s20 offen offset:16
  s_mov_b32 s60, s44
  s_and_b32 s61, s45, 0xffff
  s_mov_b32 s62, 3670016
  s_mov_b32 s63, 0x20000
  s_mov_b32 s56, s46
  s_and_b32 s57, s47, 0xffff
  s_mov_b32 s58, 3670016
  s_mov_b32 s59, 0x20000
  s_mul_i32 s27, s17, 229376
  s_lshl_b32 s30, s18, 7
  s_add_u32 s27, s27, s30
  s_mul_i32 s30, s16, 57344
  s_add_u32 s27, s27, s30
  v_lshrrev_b32 v7, 3, v1
  v_and_b32 v8, 7, v1
  v_and_b32 v9, 2, v7
  v_xor_b32 v8, v8, v9
  v_mul_u32_u24 v7, 896, v7
  v_lshl_add_u32 v24, v8, 4, v7
  v_xor_b32 v25, 64, v24
  s_lshl_b32 s30, s16, 13
  s_add_u32 m0, s30, 0
  s_nop 0
  buffer_load_dwordx4 v24, s[56:59], s27 offen  lds
  s_add_u32 s27, s27, 7168
  s_add_u32 m0, s30, 1024
  s_nop 0
  buffer_load_dwordx4 v25, s[56:59], s27 offen  lds
  s_add_u32 s27, s27, 7168
  s_add_u32 m0, s30, 2048
  s_nop 0
  buffer_load_dwordx4 v24, s[56:59], s27 offen  lds
  s_add_u32 s27, s27, 7168
  s_add_u32 m0, s30, 3072
  s_nop 0
  buffer_load_dwordx4 v25, s[56:59], s27 offen  lds
  s_add_u32 s27, s27, 7168
  s_add_u32 m0, s30, 4096
  s_nop 0
  buffer_load_dwordx4 v24, s[56:59], s27 offen  lds
  s_add_u32 s27, s27, 7168
  s_add_u32 m0, s30, 5120
  s_nop 0
  buffer_load_dwordx4 v25, s[56:59], s27 offen  lds
  s_add_u32 s27, s27, 7168
  s_add_u32 m0, s30, 6144
  s_nop 0
  buffer_load_dwordx4 v24, s[56:59], s27 offen  lds
  s_add_u32 s27, s27, 7168
  s_add_u32 m0, s30, 7168
  s_nop 0
  buffer_load_dwordx4 v25, s[56:59], s27 offen  lds
  s_add_u32 s27, s27, 7168
  s_add_u32 s27, s28, 0
  s_min_u32 s27, s27, 13
  s_lshl_b32 s27, s27, 18
  s_add_u32 s27, s27, s26
  s_mov_b32 s55, s27
  v_lshrrev_b32 v7, 2, v4
  v_lshlrev_b32 v11, 4, v7
  v_lshlrev_b32 v7, 3, v7
  v_and_b32 v8, 3, v4
  v_add_u32 v7, v7, v8
  v_and_b32 v8, 2, v4
  v_lshl_add_u32 v11, v8, 1, v11
  v_and_b32 v8, 1, v4
  v_add_u32 v11, v11, v8
  v_or_b32 v10, 0, v3
  v_xor_b32 v10, v10, v4
  v_lshlrev_b32 v10, 4, v10
  v_lshl_add_u32 v44, v11, 9, v10
  v_lshl_add_u32 v10, v7, 9, v10
  v_add_u32 v32, s25, v10
  v_or_b32 v10, 4, v3
  v_xor_b32 v10, v10, v4
  v_lshlrev_b32 v10, 4, v10
  v_lshl_add_u32 v45, v11, 9, v10
  v_lshl_add_u32 v10, v7, 9, v10
  v_add_u32 v33, s25, v10
  v_or_b32 v10, 8, v3
  v_xor_b32 v10, v10, v4
  v_lshlrev_b32 v10, 4, v10
  v_lshl_add_u32 v46, v11, 9, v10
  v_lshl_add_u32 v10, v7, 9, v10
  v_add_u32 v34, s25, v10
  v_or_b32 v10, 12, v3
  v_xor_b32 v10, v10, v4
  v_lshlrev_b32 v10, 4, v10
  v_lshl_add_u32 v47, v11, 9, v10
  v_lshl_add_u32 v10, v7, 9, v10
  v_add_u32 v35, s25, v10
  s_mul_i32 s30, s17, 401408
  s_mul_i32 s31, s18, 57344
  s_add_u32 s30, s30, s31
  s_add_u32 s30, s30, 0
  v_add_u32 v28, s30, v2
  s_add_u32 s30, s30, 14336
  v_add_u32 v29, s30, v2
  s_add_u32 s30, s30, 14336
  v_add_u32 v30, s30, v2
  s_add_u32 s30, s30, 14336
  v_add_u32 v31, s30, v2
  s_add_u32 s30, s30, 14336
  v_mov_b32 v48, 1035512379
  v_lshrrev_b32 v7, 2, v4
  v_lshl_add_u32 v7, v3, 3, v7
  v_lshlrev_b32 v7, 7, v7
  v_and_b32 v8, 3, v4
  v_lshl_add_u32 v7, v8, 3, v7
  v_lshrrev_b32 v8, 3, v4
  v_and_b32 v9, 1, v3
  v_lshl_add_u32 v8, v9, 1, v8
  v_lshl_add_u32 v40, v8, 5, v7
  s_mul_i32 s31, s17, 28
  s_mov_b32 s29, 401408
  s_lshl_b32 s30, s18, 6
  s_add_u32 s30, s30, 0
  v_add_u32 v8, s30, v4
  v_subrev_u32 v9, 256, v8
  v_mul_u32_u24 v11, 171, v9
  v_lshrrev_b32 v11, 11, v11
  v_mul_u32_u24 v38, 12, v11
  v_sub_u32 v38, v9, v38
  v_add_u32 v38, 16, v38
  v_lshrrev_b32 v10, 4, v8
  v_cmp_gt_i32 vcc, 0, v9
  s_nop 1
  v_cndmask_b32 v10, v11, v10, vcc
  v_cndmask_b32 v39, v38, v4, vcc
  v_add_u32 v39, s31, v39
  v_lshrrev_b32 v38, 4, v39
  v_and_b32 v39, 15, v39
  v_mul_lo_u32 v10, v10, s29
  v_mul_u32_u24 v38, 14336, v38
  v_add_u32 v10, v10, v38
  v_lshl_add_u32 v10, v3, 8, v10
  v_lshl_add_u32 v10, v39, 4, v10
  v_add_u32 v12, 6422528, v10
  v_xor_b32 v41, 32, v40
  s_lshl_b32 s30, s18, 6
  s_add_u32 s30, s30, 16
  v_add_u32 v8, s30, v4
  v_subrev_u32 v9, 256, v8
  v_mul_u32_u24 v11, 171, v9
  v_lshrrev_b32 v11, 11, v11
  v_mul_u32_u24 v38, 12, v11
  v_sub_u32 v38, v9, v38
  v_add_u32 v38, 16, v38
  v_lshrrev_b32 v10, 4, v8
  v_cmp_gt_i32 vcc, 0, v9
  s_nop 1
  v_cndmask_b32 v10, v11, v10, vcc
  v_cndmask_b32 v39, v38, v4, vcc
  v_add_u32 v39, s31, v39
  v_lshrrev_b32 v38, 4, v39
  v_and_b32 v39, 15, v39
  v_mul_lo_u32 v10, v10, s29
  v_mul_u32_u24 v38, 14336, v38
  v_add_u32 v10, v10, v38
  v_lshl_add_u32 v10, v3, 8, v10
  v_lshl_add_u32 v10, v39, 4, v10
  v_add_u32 v13, 6422528, v10
  v_xor_b32 v42, 64, v40
  s_lshl_b32 s30, s18, 6
  s_add_u32 s30, s30, 32
  v_add_u32 v8, s30, v4
  v_subrev_u32 v9, 256, v8
  v_mul_u32_u24 v11, 171, v9
  v_lshrrev_b32 v11, 11, v11
  v_mul_u32_u24 v38, 12, v11
  v_sub_u32 v38, v9, v38
  v_add_u32 v38, 16, v38
  v_lshrrev_b32 v10, 4, v8
  v_cmp_gt_i32 vcc, 0, v9
  s_nop 1
  v_cndmask_b32 v10, v11, v10, vcc
  v_cndmask_b32 v39, v38, v4, vcc
  v_add_u32 v39, s31, v39
  v_lshrrev_b32 v38, 4, v39
  v_and_b32 v39, 15, v39
  v_mul_lo_u32 v10, v10, s29
  v_mul_u32_u24 v38, 14336, v38
  v_add_u32 v10, v10, v38
  v_lshl_add_u32 v10, v3, 8, v10
  v_lshl_add_u32 v10, v39, 4, v10
  v_add_u32 v14, 6422528, v10
  v_xor_b32 v43, 96, v40
  s_lshl_b32 s30, s18, 6
  s_add_u32 s30, s30, 48
  v_add_u32 v8, s30, v4
  v_subrev_u32 v9, 256, v8
  v_mul_u32_u24 v11, 171, v9
  v_lshrrev_b32 v11, 11, v11
  v_mul_u32_u24 v38, 12, v11
  v_sub_u32 v38, v9, v38
  v_add_u32 v38, 16, v38
  v_lshrrev_b32 v10, 4, v8
  v_cmp_gt_i32 vcc, 0, v9
  s_nop 1
  v_cndmask_b32 v10, v11, v10, vcc
  v_cndmask_b32 v39, v38, v4, vcc
  v_add_u32 v39, s31, v39
  v_lshrrev_b32 v38, 4, v39
  v_and_b32 v39, 15, v39
  v_mul_lo_u32 v10, v10, s29
  v_mul_u32_u24 v38, 14336, v38
  v_add_u32 v10, v10, v38
  v_lshl_add_u32 v10, v3, 8, v10
  v_lshl_add_u32 v10, v39, 4, v10
  v_add_u32 v15, 6422528, v10
  s_mov_b32 s27, s55
  s_add_u32 m0, s25, 0
  s_nop 0
  buffer_load_dwordx4 v16, s[60:63], s27 offen  lds
  s_add_u32 s27, s27, 16384
  s_add_u32 m0, s25, 1024
  s_nop 0
  buffer_load_dwordx4 v17, s[60:63], s27 offen  lds
  s_add_u32 s27, s27, 16384
  s_add_u32 m0, s25, 2048
  s_nop 0
  buffer_load_dwordx4 v16, s[60:63], s27 offen  lds
  s_add_u32 s27, s27, 16384
  s_add_u32 m0, s25, 3072
  s_nop 0
  buffer_load_dwordx4 v17, s[60:63], s27 offen  lds
  s_add_u32 s27, s27, 16384
  s_add_u32 m0, s25, 4096
  s_nop 0
  buffer_load_dwordx4 v18, s[60:63], s27 offen  lds
  s_add_u32 s27, s27, 16384
  s_add_u32 m0, s25, 5120
  s_nop 0
  buffer_load_dwordx4 v19, s[60:63], s27 offen  lds
  s_add_u32 s27, s27, 16384
  s_add_u32 m0, s25, 6144
  s_nop 0
  buffer_load_dwordx4 v18, s[60:63], s27 offen  lds
  s_add_u32 s27, s27, 16384
  s_add_u32 m0, s25, 7168
  s_nop 0
  buffer_load_dwordx4 v19, s[60:63], s27 offen  lds
  s_add_u32 s27, s27, 16384
  s_add_u32 m0, s25, 8192
  s_nop 0
  buffer_load_dwordx4 v20, s[60:63], s27 offen  lds
  s_add_u32 s27, s27, 16384
  s_add_u32 m0, s25, 9216
  s_nop 0
  buffer_load_dwordx4 v21, s[60:63], s27 offen  lds
  s_add_u32 s27, s27, 16384
  s_add_u32 m0, s25, 10240
  s_nop 0
  buffer_load_dwordx4 v20, s[60:63], s27 offen  lds
  s_add_u32 s27, s27, 16384
  s_add_u32 m0, s25, 11264
  s_nop 0
  buffer_load_dwordx4 v21, s[60:63], s27 offen  lds
  s_add_u32 s27, s27, 16384
  s_add_u32 m0, s25, 12288
  s_nop 0
  buffer_load_dwordx4 v22, s[60:63], s27 offen  lds
  s_add_u32 s27, s27, 16384
  s_add_u32 m0, s25, 13312
  s_nop 0
  buffer_load_dwordx4 v23, s[60:63], s27 offen  lds
  s_add_u32 s27, s27, 16384
  s_add_u32 m0, s25, 14336
  s_nop 0
  buffer_load_dwordx4 v22, s[60:63], s27 offen  lds
  s_add_u32 s27, s27, 16384
  s_add_u32 m0, s25, 15360
  s_nop 0
  buffer_load_dwordx4 v23, s[60:63], s27 offen  lds
  s_add_u32 s27, s27, 16384
  s_add_u32 s27, s28, 4
  s_min_u32 s27, s27, 13
  s_lshl_b32 s27, s27, 18
  s_add_u32 s27, s27, s26
  s_add_u32 m0, s25, 16384
  s_nop 0
  buffer_load_dwordx4 v16, s[60:63], s27 offen  lds
  s_add_u32 s27, s27, 16384
  s_add_u32 m0, s25, 17408
  s_nop 0
  buffer_load_dwordx4 v17, s[60:63], s27 offen  lds
  s_add_u32 s27, s27, 16384
  s_add_u32 m0, s25, 18432
  s_nop 0
  buffer_load_dwordx4 v16, s[60:63], s27 offen  lds
  s_add_u32 s27, s27, 16384
  s_add_u32 m0, s25, 19456
  s_nop 0
  buffer_load_dwordx4 v17, s[60:63], s27 offen  lds
  s_add_u32 s27, s27, 16384
  s_add_u32 m0, s25, 20480
  s_nop 0
  buffer_load_dwordx4 v18, s[60:63], s27 offen  lds
  s_add_u32 s27, s27, 16384
  s_add_u32 m0, s25, 21504
  s_nop 0
  buffer_load_dwordx4 v19, s[60:63], s27 offen  lds
  s_add_u32 s27, s27, 16384
  s_add_u32 m0, s25, 22528
  s_nop 0
  buffer_load_dwordx4 v18, s[60:63], s27 offen  lds
  s_add_u32 s27, s27, 16384
  s_add_u32 m0, s25, 23552
  s_nop 0
  buffer_load_dwordx4 v19, s[60:63], s27 offen  lds
  s_add_u32 s27, s27, 16384
  s_add_u32 m0, s25, 24576
  s_nop 0
  buffer_load_dwordx4 v20, s[60:63], s27 offen  lds
  s_add_u32 s27, s27, 16384
  s_add_u32 m0, s25, 25600
  s_nop 0
  buffer_load_dwordx4 v21, s[60:63], s27 offen  lds
  s_add_u32 s27, s27, 16384
  s_add_u32 m0, s25, 26624
  s_nop 0
  buffer_load_dwordx4 v20, s[60:63], s27 offen  lds
  s_add_u32 s27, s27, 16384
  s_add_u32 m0, s25, 27648
  s_nop 0
  buffer_load_dwordx4 v21, s[60:63], s27 offen  lds
  s_add_u32 s27, s27, 16384
  s_add_u32 m0, s25, 28672
  s_nop 0
  buffer_load_dwordx4 v22, s[60:63], s27 offen  lds
  s_add_u32 s27, s27, 16384
  s_add_u32 m0, s25, 29696
  s_nop 0
  buffer_load_dwordx4 v23, s[60:63], s27 offen  lds
  s_add_u32 s27, s27, 16384
  s_add_u32 m0, s25, 30720
  s_nop 0
  buffer_load_dwordx4 v22, s[60:63], s27 offen  lds
  s_add_u32 s27, s27, 16384
  s_add_u32 m0, s25, 31744
  s_nop 0
  buffer_load_dwordx4 v23, s[60:63], s27 offen  lds
  s_add_u32 s27, s27, 16384
  s_cmp_lt_u32 s18, 4
  s_cselect_b32 s34, 1, s97
  s_mov_b32 s68, s40
  s_and_b32 s69, s41, 0xffff
  s_mov_b32 s70, 3670016
  s_mov_b32 s71, 0x20000
  s_and_b32 s20, s33, 0xe0
  s_mul_i32 s20, s20, 9363
  s_lshr_b32 s20, s20, 16
  s_lshl_b32 s20, s20, 10
  s_and_b32 s21, s33, 31
  s_mul_i32 s21, s21, 192
  s_add_u32 s20, s20, s21
  v_min_u32 v7, 191, v0
  v_add_u32 v7, s20, v7
  v_lshrrev_b32 v8, 11, v7
  v_min_u32 v8, 15, v8
  v_bfe_u32 v9, v7, 2, 9
  v_lshlrev_b32 v9, 13, v9
  v_lshl_add_u32 v9, v8, 9, v9
  v_and_b32 v7, 3, v7
  v_lshl_add_u32 v9, v7, 7, v9
  buffer_load_dword v253, v9, s[68:71], 0 offen
  s_mov_b32 s68, s42
  s_and_b32 s69, s43, 0xffff
  s_mov_b32 s70, 3670016
  s_mov_b32 s71, 0x20000
  s_lshl_b32 s27, s18, 19
  s_add_u32 s27, s27, s26
  s_cmp_lg_u32 s34, 0
  s_cselect_b32 s27, 0x40000000, s27
  v_lshrrev_b32 v7, 2, v0
  v_and_b32 v8, 3, v0
  v_lshlrev_b32 v8, 7, v8
  v_lshl_add_u32 v9, v7, 13, v8
  buffer_load_dword v253, v9, s[68:71], s27 offen
  s_lshl_b32 s29, s28, 10
  s_add_u32 s31, s29, 4096
  s_cmp_lt_u32 s28, 10
  s_cselect_b32 s31, s31, 0x40000000
  s_waitcnt vmcnt(2)
  s_barrier
  ds_read_b64_tr_b16 a[0:1], v40 offset:0
  ds_read_b64_tr_b16 a[2:3], v40 offset:512
  ds_read_b64_tr_b16 a[32:33], v41 offset:0
  ds_read_b64_tr_b16 a[34:35], v41 offset:512
  ds_read_b64_tr_b16 a[64:65], v42 offset:0
  ds_read_b64_tr_b16 a[66:67], v42 offset:512
  ds_read_b64_tr_b16 a[96:97], v43 offset:0
  ds_read_b64_tr_b16 a[98:99], v43 offset:512
  ds_read_b128 a[128:131], v32 offset:0
  ds_read_b128 a[160:163], v32 offset:2048
  ds_read_b128 a[192:195], v32 offset:16384
  ds_read_b128 a[224:227], v32 offset:18432
  v_lshlrev_b32 v144, 9, v3
  v_lshl_add_u32 v144, v4, 4, v144
  s_add_u32 s53, s52, 73859072
  s_add_u32 s52, s52, 72024064
  v_mov_b32 v136, v128
  v_mov_b32 v140, v129
  v_mov_b32 v137, v130
  v_mov_b32 v141, v131
  v_mov_b32 v138, v132
  v_mov_b32 v142, v133
  v_mov_b32 v139, v134
  v_mov_b32 v143, v135
  buffer_store_dwordx4 v[128:131], v144, s[8:11], s52 offen sc1
  buffer_store_dwordx4 v[132:135], v144, s[8:11], s52 offen offset:256 sc1
  buffer_store_dwordx4 v[136:139], v2, s[8:11], s53 offen sc1
  buffer_store_dwordx4 v[140:143], v2, s[8:11], s53 offen offset:1024 sc1
  s_waitcnt lgkmcnt(0)
  v_mfma_f32_16x16x32_bf16 v[64:67], a[128:131], a[0:3], 0
  ds_read_b64_tr_b16 a[4:5], v40 offset:4096
  ds_read_b64_tr_b16 a[6:7], v40 offset:4608
  v_mfma_f32_16x16x32_bf16 v[68:71], a[160:163], a[0:3], 0
  ds_read_b64_tr_b16 a[36:37], v41 offset:4096
  ds_read_b64_tr_b16 a[38:39], v41 offset:4608
  v_mfma_f32_16x16x32_bf16 v[72:75], a[128:131], a[32:35], 0
  ds_read_b64_tr_b16 a[68:69], v42 offset:4096
  ds_read_b64_tr_b16 a[70:71], v42 offset:4608
  v_mfma_f32_16x16x32_bf16 v[76:79], a[160:163], a[32:35], 0
  ds_read_b64_tr_b16 a[100:101], v43 offset:4096
  ds_read_b64_tr_b16 a[102:103], v43 offset:4608
  v_mfma_f32_16x16x32_bf16 v[80:83], a[128:131], a[64:67], 0
  ds_read_b128 a[132:135], v33 offset:0
  ds_read_b128 a[164:167], v33 offset:2048
  v_mfma_f32_16x16x32_bf16 v[84:87], a[160:163], a[64:67], 0
  ds_read_b128 a[196:199], v33 offset:16384
  ds_read_b128 a[228:231], v33 offset:18432
  v_mfma_f32_16x16x32_bf16 v[88:91], a[128:131], a[96:99], 0
  v_mfma_f32_16x16x32_bf16 v[92:95], a[160:163], a[96:99], 0
  v_mfma_f32_16x16x32_bf16 v[96:99], a[192:195], a[0:3], 0
  v_mfma_f32_16x16x32_bf16 v[100:103], a[224:227], a[0:3], 0
  v_mfma_f32_16x16x32_bf16 v[104:107], a[192:195], a[32:35], 0
  v_mfma_f32_16x16x32_bf16 v[108:111], a[224:227], a[32:35], 0
  v_mfma_f32_16x16x32_bf16 v[112:115], a[192:195], a[64:67], 0
  v_mfma_f32_16x16x32_bf16 v[116:119], a[224:227], a[64:67], 0
  v_mfma_f32_16x16x32_bf16 v[120:123], a[192:195], a[96:99], 0
  v_mfma_f32_16x16x32_bf16 v[124:127], a[224:227], a[96:99], 0
  s_waitcnt lgkmcnt(0)
  v_mfma_f32_16x16x32_bf16 v[64:67], a[132:135], a[4:7], v[64:67]
  ds_read_b64_tr_b16 a[8:9], v40 offset:8192
  ds_read_b64_tr_b16 a[10:11], v40 offset:8704
  v_mfma_f32_16x16x32_bf16 v[68:71], a[164:167], a[4:7], v[68:71]
  ds_read_b64_tr_b16 a[40:41], v41 offset:8192
  ds_read_b64_tr_b16 a[42:43], v41 offset:8704
  v_mfma_f32_16x16x32_bf16 v[72:75], a[132:135], a[36:39], v[72:75]
  ds_read_b64_tr_b16 a[72:73], v42 offset:8192
  ds_read_b64_tr_b16 a[74:75], v42 offset:8704
  v_mfma_f32_16x16x32_bf16 v[76:79], a[164:167], a[36:39], v[76:79]
  ds_read_b64_tr_b16 a[104:105], v43 offset:8192
  ds_read_b64_tr_b16 a[106:107], v43 offset:8704
  v_mfma_f32_16x16x32_bf16 v[80:83], a[132:135], a[68:71], v[80:83]
  ds_read_b128 a[136:139], v34 offset:0
  ds_read_b128 a[168:171], v34 offset:2048
  v_mfma_f32_16x16x32_bf16 v[84:87], a[164:167], a[68:71], v[84:87]
  ds_read_b128 a[200:203], v34 offset:16384
  ds_read_b128 a[232:235], v34 offset:18432
  v_mfma_f32_16x16x32_bf16 v[88:91], a[132:135], a[100:103], v[88:91]
  v_mfma_f32_16x16x32_bf16 v[92:95], a[164:167], a[100:103], v[92:95]
  v_mfma_f32_16x16x32_bf16 v[96:99], a[196:199], a[4:7], v[96:99]
  v_mfma_f32_16x16x32_bf16 v[100:103], a[228:231], a[4:7], v[100:103]
  v_mfma_f32_16x16x32_bf16 v[104:107], a[196:199], a[36:39], v[104:107]
  v_mfma_f32_16x16x32_bf16 v[108:111], a[228:231], a[36:39], v[108:111]
  v_mfma_f32_16x16x32_bf16 v[112:115], a[196:199], a[68:71], v[112:115]
  v_mfma_f32_16x16x32_bf16 v[116:119], a[228:231], a[68:71], v[116:119]
  v_mfma_f32_16x16x32_bf16 v[120:123], a[196:199], a[100:103], v[120:123]
  v_mfma_f32_16x16x32_bf16 v[124:127], a[228:231], a[100:103], v[124:127]
  s_waitcnt lgkmcnt(0)
  v_mfma_f32_16x16x32_bf16 v[64:67], a[136:139], a[8:11], v[64:67]
  ds_read_b64_tr_b16 a[12:13], v40 offset:12288
  ds_read_b64_tr_b16 a[14:15], v40 offset:12800
  v_mfma_f32_16x16x32_bf16 v[68:71], a[168:171], a[8:11], v[68:71]
  ds_read_b64_tr_b16 a[44:45], v41 offset:12288
  ds_read_b64_tr_b16 a[46:47], v41 offset:12800
  v_mfma_f32_16x16x32_bf16 v[72:75], a[136:139], a[40:43], v[72:75]
  ds_read_b64_tr_b16 a[76:77], v42 offset:12288
  ds_read_b64_tr_b16 a[78:79], v42 offset:12800
  v_mfma_f32_16x16x32_bf16 v[76:79], a[168:171], a[40:43], v[76:79]
  ds_read_b64_tr_b16 a[108:109], v43 offset:12288
  ds_read_b64_tr_b16 a[110:111], v43 offset:12800
  v_mfma_f32_16x16x32_bf16 v[80:83], a[136:139], a[72:75], v[80:83]
  ds_read_b128 a[140:143], v35 offset:0
  ds_read_b128 a[172:175], v35 offset:2048
  v_mfma_f32_16x16x32_bf16 v[84:87], a[168:171], a[72:75], v[84:87]
  ds_read_b128 a[204:207], v35 offset:16384
  ds_read_b128 a[236:239], v35 offset:18432
  v_mfma_f32_16x16x32_bf16 v[88:91], a[136:139], a[104:107], v[88:91]
  v_mfma_f32_16x16x32_bf16 v[92:95], a[168:171], a[104:107], v[92:95]
  v_mfma_f32_16x16x32_bf16 v[96:99], a[200:203], a[8:11], v[96:99]
  v_mfma_f32_16x16x32_bf16 v[100:103], a[232:235], a[8:11], v[100:103]
  v_mfma_f32_16x16x32_bf16 v[104:107], a[200:203], a[40:43], v[104:107]
  v_mfma_f32_16x16x32_bf16 v[108:111], a[232:235], a[40:43], v[108:111]
  v_mfma_f32_16x16x32_bf16 v[112:115], a[200:203], a[72:75], v[112:115]
  v_mfma_f32_16x16x32_bf16 v[116:119], a[232:235], a[72:75], v[116:119]
  v_mfma_f32_16x16x32_bf16 v[120:123], a[200:203], a[104:107], v[120:123]
  v_mfma_f32_16x16x32_bf16 v[124:127], a[232:235], a[104:107], v[124:127]
  s_waitcnt lgkmcnt(0)
  v_mfma_f32_16x16x32_bf16 v[64:67], a[140:143], a[12:15], v[64:67]
  ds_read_b64_tr_b16 a[16:17], v40 offset:16384
  ds_read_b64_tr_b16 a[18:19], v40 offset:16896
  v_mfma_f32_16x16x32_bf16 v[68:71], a[172:175], a[12:15], v[68:71]
  ds_read_b64_tr_b16 a[48:49], v41 offset:16384
  ds_read_b64_tr_b16 a[50:51], v41 offset:16896
  v_mfma_f32_16x16x32_bf16 v[72:75], a[140:143], a[44:47], v[72:75]
  ds_read_b64_tr_b16 a[80:81], v42 offset:16384
  ds_read_b64_tr_b16 a[82:83], v42 offset:16896
  v_mfma_f32_16x16x32_bf16 v[76:79], a[172:175], a[44:47], v[76:79]
  ds_read_b64_tr_b16 a[112:113], v43 offset:16384
  ds_read_b64_tr_b16 a[114:115], v43 offset:16896
  v_mfma_f32_16x16x32_bf16 v[80:83], a[140:143], a[76:79], v[80:83]
  ds_read_b128 a[144:147], v32 offset:256
  ds_read_b128 a[176:179], v32 offset:2304
  v_mfma_f32_16x16x32_bf16 v[84:87], a[172:175], a[76:79], v[84:87]
  ds_read_b128 a[208:211], v32 offset:16640
  ds_read_b128 a[240:243], v32 offset:18688
  v_mfma_f32_16x16x32_bf16 v[88:91], a[140:143], a[108:111], v[88:91]
  v_mfma_f32_16x16x32_bf16 v[92:95], a[172:175], a[108:111], v[92:95]
  v_mfma_f32_16x16x32_bf16 v[96:99], a[204:207], a[12:15], v[96:99]
  v_mfma_f32_16x16x32_bf16 v[100:103], a[236:239], a[12:15], v[100:103]
  v_mfma_f32_16x16x32_bf16 v[104:107], a[204:207], a[44:47], v[104:107]
  v_mfma_f32_16x16x32_bf16 v[108:111], a[236:239], a[44:47], v[108:111]
  v_mfma_f32_16x16x32_bf16 v[112:115], a[204:207], a[76:79], v[112:115]
  v_mfma_f32_16x16x32_bf16 v[116:119], a[236:239], a[76:79], v[116:119]
  v_mfma_f32_16x16x32_bf16 v[120:123], a[204:207], a[108:111], v[120:123]
  v_mfma_f32_16x16x32_bf16 v[124:127], a[236:239], a[108:111], v[124:127]
  s_waitcnt lgkmcnt(0)
  v_mfma_f32_16x16x32_bf16 v[64:67], a[144:147], a[16:19], v[64:67]
  ds_read_b64_tr_b16 a[20:21], v40 offset:20480
  ds_read_b64_tr_b16 a[22:23], v40 offset:20992
  v_mfma_f32_16x16x32_bf16 v[68:71], a[176:179], a[16:19], v[68:71]
  ds_read_b64_tr_b16 a[52:53], v41 offset:20480
  ds_read_b64_tr_b16 a[54:55], v41 offset:20992
  v_mfma_f32_16x16x32_bf16 v[72:75], a[144:147], a[48:51], v[72:75]
  ds_read_b64_tr_b16 a[84:85], v42 offset:20480
  ds_read_b64_tr_b16 a[86:87], v42 offset:20992
  v_mfma_f32_16x16x32_bf16 v[76:79], a[176:179], a[48:51], v[76:79]
  ds_read_b64_tr_b16 a[116:117], v43 offset:20480
  ds_read_b64_tr_b16 a[118:119], v43 offset:20992
  v_mfma_f32_16x16x32_bf16 v[80:83], a[144:147], a[80:83], v[80:83]
  ds_read_b128 a[148:151], v33 offset:256
  ds_read_b128 a[180:183], v33 offset:2304
  v_mfma_f32_16x16x32_bf16 v[84:87], a[176:179], a[80:83], v[84:87]
  ds_read_b128 a[212:215], v33 offset:16640
  ds_read_b128 a[244:247], v33 offset:18688
  v_mfma_f32_16x16x32_bf16 v[88:91], a[144:147], a[112:115], v[88:91]
  v_mfma_f32_16x16x32_bf16 v[92:95], a[176:179], a[112:115], v[92:95]
  v_mfma_f32_16x16x32_bf16 v[96:99], a[208:211], a[16:19], v[96:99]
  v_mfma_f32_16x16x32_bf16 v[100:103], a[240:243], a[16:19], v[100:103]
  v_mfma_f32_16x16x32_bf16 v[104:107], a[208:211], a[48:51], v[104:107]
  v_mfma_f32_16x16x32_bf16 v[108:111], a[240:243], a[48:51], v[108:111]
  v_mfma_f32_16x16x32_bf16 v[112:115], a[208:211], a[80:83], v[112:115]
  v_mfma_f32_16x16x32_bf16 v[116:119], a[240:243], a[80:83], v[116:119]
  v_mfma_f32_16x16x32_bf16 v[120:123], a[208:211], a[112:115], v[120:123]
  v_mfma_f32_16x16x32_bf16 v[124:127], a[240:243], a[112:115], v[124:127]
  s_waitcnt lgkmcnt(0)
  v_mfma_f32_16x16x32_bf16 v[64:67], a[148:151], a[20:23], v[64:67]
  ds_read_b64_tr_b16 a[24:25], v40 offset:24576
  ds_read_b64_tr_b16 a[26:27], v40 offset:25088
  v_mfma_f32_16x16x32_bf16 v[68:71], a[180:183], a[20:23], v[68:71]
  ds_read_b64_tr_b16 a[56:57], v41 offset:24576
  ds_read_b64_tr_b16 a[58:59], v41 offset:25088
  v_mfma_f32_16x16x32_bf16 v[72:75], a[148:151], a[52:55], v[72:75]
  ds_read_b64_tr_b16 a[88:89], v42 offset:24576
  ds_read_b64_tr_b16 a[90:91], v42 offset:25088
  v_mfma_f32_16x16x32_bf16 v[76:79], a[180:183], a[52:55], v[76:79]
  ds_read_b64_tr_b16 a[120:121], v43 offset:24576
  ds_read_b64_tr_b16 a[122:123], v43 offset:25088
  v_mfma_f32_16x16x32_bf16 v[80:83], a[148:151], a[84:87], v[80:83]
  ds_read_b128 a[152:155], v34 offset:256
  ds_read_b128 a[184:187], v34 offset:2304
  v_mfma_f32_16x16x32_bf16 v[84:87], a[180:183], a[84:87], v[84:87]
  ds_read_b128 a[216:219], v34 offset:16640
  ds_read_b128 a[248:251], v34 offset:18688
  v_mfma_f32_16x16x32_bf16 v[88:91], a[148:151], a[116:119], v[88:91]
  v_mfma_f32_16x16x32_bf16 v[92:95], a[180:183], a[116:119], v[92:95]
  v_mfma_f32_16x16x32_bf16 v[96:99], a[212:215], a[20:23], v[96:99]
  v_mfma_f32_16x16x32_bf16 v[100:103], a[244:247], a[20:23], v[100:103]
  v_mfma_f32_16x16x32_bf16 v[104:107], a[212:215], a[52:55], v[104:107]
  v_mfma_f32_16x16x32_bf16 v[108:111], a[244:247], a[52:55], v[108:111]
  v_mfma_f32_16x16x32_bf16 v[112:115], a[212:215], a[84:87], v[112:115]
  v_mfma_f32_16x16x32_bf16 v[116:119], a[244:247], a[84:87], v[116:119]
  v_mfma_f32_16x16x32_bf16 v[120:123], a[212:215], a[116:119], v[120:123]
  v_mfma_f32_16x16x32_bf16 v[124:127], a[244:247], a[116:119], v[124:127]
  s_waitcnt lgkmcnt(0)
  v_mfma_f32_16x16x32_bf16 v[64:67], a[152:155], a[24:27], v[64:67]
  ds_read_b64_tr_b16 a[28:29], v40 offset:28672
  ds_read_b64_tr_b16 a[30:31], v40 offset:29184
  v_mfma_f32_16x16x32_bf16 v[68:71], a[184:187], a[24:27], v[68:71]
  ds_read_b64_tr_b16 a[60:61], v41 offset:28672
  ds_read_b64_tr_b16 a[62:63], v41 offset:29184
  v_mfma_f32_16x16x32_bf16 v[72:75], a[152:155], a[56:59], v[72:75]
  ds_read_b64_tr_b16 a[92:93], v42 offset:28672
  ds_read_b64_tr_b16 a[94:95], v42 offset:29184
  v_mfma_f32_16x16x32_bf16 v[76:79], a[184:187], a[56:59], v[76:79]
  ds_read_b64_tr_b16 a[124:125], v43 offset:28672
  ds_read_b64_tr_b16 a[126:127], v43 offset:29184
  v_mfma_f32_16x16x32_bf16 v[80:83], a[152:155], a[88:91], v[80:83]
  ds_read_b128 a[156:159], v35 offset:256
  ds_read_b128 a[188:191], v35 offset:2304
  v_mfma_f32_16x16x32_bf16 v[84:87], a[184:187], a[88:91], v[84:87]
  ds_read_b128 a[220:223], v35 offset:16640
  ds_read_b128 a[252:255], v35 offset:18688
  v_mfma_f32_16x16x32_bf16 v[88:91], a[152:155], a[120:123], v[88:91]
  v_mfma_f32_16x16x32_bf16 v[92:95], a[184:187], a[120:123], v[92:95]
  v_mfma_f32_16x16x32_bf16 v[96:99], a[216:219], a[24:27], v[96:99]
  v_mfma_f32_16x16x32_bf16 v[100:103], a[248:251], a[24:27], v[100:103]
  v_mfma_f32_16x16x32_bf16 v[104:107], a[216:219], a[56:59], v[104:107]
  v_mfma_f32_16x16x32_bf16 v[108:111], a[248:251], a[56:59], v[108:111]
  v_mfma_f32_16x16x32_bf16 v[112:115], a[216:219], a[88:91], v[112:115]
  v_mfma_f32_16x16x32_bf16 v[116:119], a[248:251], a[88:91], v[116:119]
  v_mfma_f32_16x16x32_bf16 v[120:123], a[216:219], a[120:123], v[120:123]
  v_mfma_f32_16x16x32_bf16 v[124:127], a[248:251], a[120:123], v[124:127]
  s_waitcnt lgkmcnt(0)
  s_barrier
  buffer_load_dwordx2 v[254:255], v252, s[12:15], 0 offen offset:128 sc1
  buffer_load_dword v253, v252, s[12:15], 0 offen sc1
  v_mfma_f32_16x16x32_bf16 v[64:67], a[156:159], a[28:31], v[64:67]
  v_mfma_f32_16x16x32_bf16 v[68:71], a[188:191], a[28:31], v[68:71]
  v_mfma_f32_16x16x32_bf16 v[72:75], a[156:159], a[60:63], v[72:75]
  v_mfma_f32_16x16x32_bf16 v[76:79], a[188:191], a[60:63], v[76:79]
  v_mfma_f32_16x16x32_bf16 v[80:83], a[156:159], a[92:95], v[80:83]
  v_cvt_pk_bf16_f32 v64, v64, v65
  v_cvt_pk_bf16_f32 v65, v66, v67
  v_mfma_f32_16x16x32_bf16 v[84:87], a[188:191], a[92:95], v[84:87]
  v_cvt_pk_bf16_f32 v66, v68, v69
  v_cvt_pk_bf16_f32 v67, v70, v71
  v_mfma_f32_16x16x32_bf16 v[88:91], a[156:159], a[124:127], v[88:91]
  buffer_store_dwordx4 v[64:67], v12, s[8:11], s29 offen sc1
  v_cvt_pk_bf16_f32 v72, v72, v73
  v_mfma_f32_16x16x32_bf16 v[92:95], a[188:191], a[124:127], v[92:95]
  v_cvt_pk_bf16_f32 v73, v74, v75
  v_cvt_pk_bf16_f32 v74, v76, v77
  v_mfma_f32_16x16x32_bf16 v[96:99], a[220:223], a[28:31], v[96:99]
  v_cvt_pk_bf16_f32 v75, v78, v79
  buffer_store_dwordx4 v[72:75], v13, s[8:11], s29 offen sc1
  v_mfma_f32_16x16x32_bf16 v[100:103], a[252:255], a[28:31], v[100:103]
  v_cvt_pk_bf16_f32 v80, v80, v81
  v_cvt_pk_bf16_f32 v81, v82, v83
  v_mfma_f32_16x16x32_bf16 v[104:107], a[220:223], a[60:63], v[104:107]
  v_cvt_pk_bf16_f32 v82, v84, v85
  v_cvt_pk_bf16_f32 v83, v86, v87
  v_mfma_f32_16x16x32_bf16 v[108:111], a[252:255], a[60:63], v[108:111]
  buffer_store_dwordx4 v[80:83], v14, s[8:11], s29 offen sc1
  v_cvt_pk_bf16_f32 v88, v88, v89
  v_mfma_f32_16x16x32_bf16 v[112:115], a[220:223], a[92:95], v[112:115]
  v_cvt_pk_bf16_f32 v89, v90, v91
  v_cvt_pk_bf16_f32 v90, v92, v93
  v_mfma_f32_16x16x32_bf16 v[116:119], a[252:255], a[92:95], v[116:119]
  v_cvt_pk_bf16_f32 v91, v94, v95
  buffer_store_dwordx4 v[88:91], v15, s[8:11], s29 offen sc1
  v_mfma_f32_16x16x32_bf16 v[120:123], a[220:223], a[124:127], v[120:123]
  v_cvt_pk_bf16_f32 v96, v96, v97
  v_cvt_pk_bf16_f32 v97, v98, v99
  v_mfma_f32_16x16x32_bf16 v[124:127], a[252:255], a[124:127], v[124:127]
  v_cvt_pk_bf16_f32 v98, v100, v101
  v_cvt_pk_bf16_f32 v99, v102, v103
  buffer_store_dwordx4 v[96:99], v12, s[8:11], s31 offen sc1
  v_cvt_pk_bf16_f32 v104, v104, v105
  v_cvt_pk_bf16_f32 v105, v106, v107
  v_cvt_pk_bf16_f32 v106, v108, v109
  v_cvt_pk_bf16_f32 v107, v110, v111
  buffer_store_dwordx4 v[104:107], v13, s[8:11], s31 offen sc1
  v_cvt_pk_bf16_f32 v112, v112, v113
  v_cvt_pk_bf16_f32 v113, v114, v115
  v_cvt_pk_bf16_f32 v114, v116, v117
  v_cvt_pk_bf16_f32 v115, v118, v119
  buffer_store_dwordx4 v[112:115], v14, s[8:11], s31 offen sc1
  v_cvt_pk_bf16_f32 v120, v120, v121
  v_cvt_pk_bf16_f32 v121, v122, v123
  v_cvt_pk_bf16_f32 v122, v124, v125
  v_cvt_pk_bf16_f32 v123, v126, v127
  buffer_store_dwordx4 v[120:123], v15, s[8:11], s31 offen sc1
  s_cmp_lg_u32 s34, 0
  s_cbranch_scc1 wp_B2
  s_mov_b32 s60, s40
  s_and_b32 s61, s41, 0xffff
  s_mov_b32 s62, 3670016
  s_mov_b32 s63, 0x20000
  s_mov_b32 s56, s42
  s_and_b32 s57, s43, 0xffff
  s_mov_b32 s58, 3670016
  s_mov_b32 s59, 0x20000
  s_lshl_b32 s27, s18, 2
  s_add_u32 s27, s27, s16
  s_lshl_b32 s27, s27, 17
  s_add_u32 s27, s27, s26
  s_lshl_b32 s30, s16, 13
  s_add_u32 m0, s30, 0
  s_nop 0
  buffer_load_dwordx4 v26, s[56:59], s27 offen  lds
  s_add_u32 s27, s27, 16384
  s_add_u32 m0, s30, 1024
  s_nop 0
  buffer_load_dwordx4 v26, s[56:59], s27 offen  lds
  s_add_u32 s27, s27, 16384
  s_add_u32 m0, s30, 2048
  s_nop 0
  buffer_load_dwordx4 v27, s[56:59], s27 offen  lds
  s_add_u32 s27, s27, 16384
  s_add_u32 m0, s30, 3072
  s_nop 0
  buffer_load_dwordx4 v27, s[56:59], s27 offen  lds
  s_add_u32 s27, s27, 16384
  s_add_u32 m0, s30, 4096
  s_nop 0
  buffer_load_dwordx4 v26, s[56:59], s27 offen  lds
  s_add_u32 s27, s27, 16384
  s_add_u32 m0, s30, 5120
  s_nop 0
  buffer_load_dwordx4 v26, s[56:59], s27 offen  lds
  s_add_u32 s27, s27, 16384
  s_add_u32 m0, s30, 6144
  s_nop 0
  buffer_load_dwordx4 v27, s[56:59], s27 offen  lds
  s_add_u32 s27, s27, 16384
  s_add_u32 m0, s30, 7168
  s_nop 0
  buffer_load_dwordx4 v27, s[56:59], s27 offen  lds
  s_add_u32 s27, s27, 16384
  s_add_u32 s27, s28, 0
  s_min_u32 s27, s27, 13
  s_lshl_b32 s27, s27, 18
  s_add_u32 s27, s27, s26
  s_add_u32 m0, s25, 0
  s_nop 0
  buffer_load_dwordx4 v16, s[60:63], s27 offen  lds
  s_add_u32 s27, s27, 16384
  s_add_u32 m0, s25, 1024
  s_nop 0
  buffer_load_dwordx4 v17, s[60:63], s27 offen  lds
  s_add_u32 s27, s27, 16384
  s_add_u32 m0, s25, 2048
  s_nop 0
  buffer_load_dwordx4 v16, s[60:63], s27 offen  lds
  s_add_u32 s27, s27, 16384
  s_add_u32 m0, s25, 3072
  s_nop 0
  buffer_load_dwordx4 v17, s[60:63], s27 offen  lds
  s_add_u32 s27, s27, 16384
  s_waitcnt vmcnt(12)
  s_barrier
  s_cmp_lg_u32 s16, 0
  s_cbranch_scc1 wp_f1_f
  v_readfirstlane_b32 s20, v254
  s_cmp_eq_u32 s20, 1
  s_cbranch_scc1 wp_f1_w_ok
  s_mov_b32 s30, 0
wp_f1_w:
  buffer_load_dword v254, off, s[12:15], 0 offset:128 sc1
  s_waitcnt vmcnt(0)
  v_cmp_ne_u32 vcc, 1, v254
  s_cbranch_vccz wp_f1_w_ok
  s_sleep 8
  s_add_u32 s30, s30, 1
  s_cmp_lt_u32 s30, 16
  s_cbranch_scc1 wp_f1_w
  s_branch wp_f1_f
wp_f1_w_ok:
  s_lshl_b32 s20, s17, 7
  s_add_u32 s20, s20, 88519168
  s_lshl_b32 s21, 1, s19
  v_mov_b32 v248, s21
  s_mov_b64 exec, 1
  buffer_atomic_or v248, v252, s[8:11], s20 offen sc0
  s_mov_b64 exec, -1
  s_mov_b32 s37, s21
wp_f1_f:
  s_add_u32 m0, s25, 4096
  s_nop 0
  buffer_load_dwordx4 v18, s[60:63], s27 offen  lds
  s_add_u32 s27, s27, 16384
  s_add_u32 m0, s25, 5120
  s_nop 0
  buffer_load_dwordx4 v19, s[60:63], s27 offen  lds
  s_add_u32 s27, s27, 16384
  s_add_u32 m0, s25, 6144
  s_nop 0
  buffer_load_dwordx4 v18, s[60:63], s27 offen  lds
  s_add_u32 s27, s27, 16384
  s_add_u32 m0, s25, 7168
  s_nop 0
  buffer_load_dwordx4 v19, s[60:63], s27 offen  lds
  s_add_u32 s27, s27, 16384
  s_add_u32 m0, s25, 8192
  s_nop 0
  buffer_load_dwordx4 v20, s[60:63], s27 offen  lds
  s_add_u32 s27, s27, 16384
  s_add_u32 m0, s25, 9216
  s_nop 0
  buffer_load_dwordx4 v21, s[60:63], s27 offen  lds
  s_add_u32 s27, s27, 16384
  s_add_u32 m0, s25, 10240
  s_nop 0
  buffer_load_dwordx4 v20, s[60:63], s27 offen  lds
  s_add_u32 s27, s27, 16384
  s_add_u32 m0, s25, 11264
  s_nop 0
  buffer_load_dwordx4 v21, s[60:63], s27 offen  lds
  s_add_u32 s27, s27, 16384
  s_add_u32 m0, s25, 12288
  s_nop 0
  buffer_load_dwordx4 v22, s[60:63], s27 offen  lds
  s_add_u32 s27, s27, 16384
  s_add_u32 m0, s25, 13312
  s_nop 0
  buffer_load_dwordx4 v23, s[60:63], s27 offen  lds
  s_add_u32 s27, s27, 16384
  s_add_u32 m0, s25, 14336
  s_nop 0
  buffer_load_dwordx4 v22, s[60:63], s27 offen  lds
  s_add_u32 s27, s27, 16384
  s_add_u32 m0, s25, 15360
  s_nop 0
  buffer_load_dwordx4 v23, s[60:63], s27 offen  lds
  s_add_u32 s27, s27, 16384
  s_add_u32 s27, s28, 4
  s_min_u32 s27, s27, 13
  s_lshl_b32 s27, s27, 18
  s_add_u32 s27, s27, s26
  s_waitcnt vmcnt(12)
  v_readfirstlane_b32 s20, v248
  s_and_b32 s20, s20, 16383
  s_xor_b32 s20, s20, s37
  s_cmp_lg_u32 s20, 16383
  s_cselect_b32 s20, 0, s37
  s_mov_b32 s37, 0
  s_cmp_eq_u32 s20, 0
  s_cbranch_scc1 wp_g1
  s_lshl_b32 s21, 1, s17
  v_mov_b32 v248, s21
  s_mov_b32 s20, 88523264
  v_lshlrev_b32 v247, 7, v0
  s_mov_b64 exec, 0xff
  buffer_atomic_or v248, v247, s[8:11], s20 offen
  s_mov_b64 exec, -1
wp_g1:
  s_add_u32 m0, s25, 16384
  s_nop 0
  buffer_load_dwordx4 v16, s[60:63], s27 offen  lds
  s_add_u32 s27, s27, 16384
  s_add_u32 m0, s25, 17408
  s_nop 0
  buffer_load_dwordx4 v17, s[60:63], s27 offen  lds
  s_add_u32 s27, s27, 16384
  s_add_u32 m0, s25, 18432
  s_nop 0
  buffer_load_dwordx4 v16, s[60:63], s27 offen  lds
  s_add_u32 s27, s27, 16384
  s_add_u32 m0, s25, 19456
  s_nop 0
  buffer_load_dwordx4 v17, s[60:63], s27 offen  lds
  s_add_u32 s27, s27, 16384
  s_add_u32 m0, s25, 20480
  s_nop 0
  buffer_load_dwordx4 v18, s[60:63], s27 offen  lds
  s_add_u32 s27, s27, 16384
  s_add_u32 m0, s25, 21504
  s_nop 0
  buffer_load_dwordx4 v19, s[60:63], s27 offen  lds
  s_add_u32 s27, s27, 16384
  s_add_u32 m0, s25, 22528
  s_nop 0
  buffer_load_dwordx4 v18, s[60:63], s27 offen  lds
  s_add_u32 s27, s27, 16384
  s_add_u32 m0, s25, 23552
  s_nop 0
  buffer_load_dwordx4 v19, s[60:63], s27 offen  lds
  s_add_u32 s27, s27, 16384
  s_add_u32 m0, s25, 24576
  s_nop 0
  buffer_load_dwordx4 v20, s[60:63], s27 offen  lds
  s_add_u32 s27, s27, 16384
  s_add_u32 m0, s25, 25600
  s_nop 0
  buffer_load_dwordx4 v21, s[60:63], s27 offen  lds
  s_add_u32 s27, s27, 16384
  s_add_u32 m0, s25, 26624
  s_nop 0
  buffer_load_dwordx4 v20, s[60:63], s27 offen  lds
  s_add_u32 s27, s27, 16384
  s_add_u32 m0, s25, 27648
  s_nop 0
  buffer_load_dwordx4 v21, s[60:63], s27 offen  lds
  s_add_u32 s27, s27, 16384
  s_add_u32 m0, s25, 28672
  s_nop 0
  buffer_load_dwordx4 v22, s[60:63], s27 offen  lds
  s_add_u32 s27, s27, 16384
  s_add_u32 m0, s25, 29696
  s_nop 0
  buffer_load_dwordx4 v23, s[60:63], s27 offen  lds
  s_add_u32 s27, s27, 16384
  s_add_u32 m0, s25, 30720
  s_nop 0
  buffer_load_dwordx4 v22, s[60:63], s27 offen  lds
  s_add_u32 s27, s27, 16384
  s_add_u32 m0, s25, 31744
  s_nop 0
  buffer_load_dwordx4 v23, s[60:63], s27 offen  lds
  s_add_u32 s27, s27, 16384
  s_branch wp_A
wp_B2:
  v_lshlrev_b32 v6, 7, v1
  s_getpc_b64 s[98:99]
ct_6:
  s_add_u32 s98, s98, wp_fin-ct_6
  s_addc_u32 s99, s99, 0
  global_load_dword v7, v6, s[98:99]
  s_getpc_b64 s[98:99]
ct_7:
  s_add_u32 s98, s98, wg_vo-ct_7
  s_addc_u32 s99, s99, 0
  global_load_dword v7, v6, s[98:99]
  s_waitcnt vmcnt(2)
  s_barrier
  s_cmp_lg_u32 s16, 0
  s_cbranch_scc1 wp_f2_f
  v_readfirstlane_b32 s20, v254
  s_cmp_eq_u32 s20, 1
  s_cbranch_scc1 wp_f2_w_ok
  s_mov_b32 s30, 0
wp_f2_w:
  buffer_load_dword v254, off, s[12:15], 0 offset:128 sc1
  s_waitcnt vmcnt(0)
  v_cmp_ne_u32 vcc, 1, v254
  s_cbranch_vccz wp_f2_w_ok
  s_sleep 8
  s_add_u32 s30, s30, 1
  s_cmp_lt_u32 s30, 16
  s_cbranch_scc1 wp_f2_w
  s_branch wp_f2_f
wp_f2_w_ok:
  s_lshl_b32 s20, s17, 7
  s_add_u32 s20, s20, 88519168
  s_lshl_b32 s21, 1, s19
  v_mov_b32 v248, s21
  s_mov_b64 exec, 1
  buffer_atomic_or v248, v252, s[8:11], s20 offen sc0
  s_mov_b64 exec, -1
  s_mov_b32 s37, s21
wp_f2_f:
  s_cmp_eq_u32 s97, 0
  s_cselect_b32 s39, -4, s39
  s_branch wp_fin
wp_A0:
  s_mov_b32 s60, s40
  s_and_b32 s61, s41, 0xffff
  s_mov_b32 s62, 3670016
  s_mov_b32 s63, 0x20000
  s_mov_b32 s56, s42
  s_and_b32 s57, s43, 0xffff
  s_mov_b32 s58, 3670016
  s_mov_b32 s59, 0x20000
  s_lshl_b32 s27, s18, 2
  s_add_u32 s27, s27, s16
  s_lshl_b32 s27, s27, 17
  s_add_u32 s27, s27, s26
  s_lshl_b32 s30, s16, 13
  s_add_u32 m0, s30, 0
  s_nop 0
  buffer_load_dwordx4 v26, s[56:59], s27 offen  lds
  s_add_u32 s27, s27, 16384
  s_add_u32 m0, s30, 1024
  s_nop 0
  buffer_load_dwordx4 v26, s[56:59], s27 offen  lds
  s_add_u32 s27, s27, 16384
  s_add_u32 m0, s30, 2048
  s_nop 0
  buffer_load_dwordx4 v27, s[56:59], s27 offen  lds
  s_add_u32 s27, s27, 16384
  s_add_u32 m0, s30, 3072
  s_nop 0
  buffer_load_dwordx4 v27, s[56:59], s27 offen  lds
  s_add_u32 s27, s27, 16384
  s_add_u32 m0, s30, 4096
  s_nop 0
  buffer_load_dwordx4 v26, s[56:59], s27 offen  lds
  s_add_u32 s27, s27, 16384
  s_add_u32 m0, s30, 5120
  s_nop 0
  buffer_load_dwordx4 v26, s[56:59], s27 offen  lds
  s_add_u32 s27, s27, 16384
  s_add_u32 m0, s30, 6144
  s_nop 0
  buffer_load_dwordx4 v27, s[56:59], s27 offen  lds
  s_add_u32 s27, s27, 16384
  s_add_u32 m0, s30, 7168
  s_nop 0
  buffer_load_dwordx4 v27, s[56:59], s27 offen  lds
  s_add_u32 s27, s27, 16384
  s_add_u32 s27, s28, 0
  s_min_u32 s27, s27, 13
  s_lshl_b32 s27, s27, 18
  s_add_u32 s27, s27, s26
  s_add_u32 m0, s25, 0
  s_nop 0
  buffer_load_dwordx4 v16, s[60:63], s27 offen  lds
  s_add_u32 s27, s27, 16384
  s_add_u32 m0, s25, 1024
  s_nop 0
  buffer_load_dwordx4 v17, s[60:63], s27 offen  lds
  s_add_u32 s27, s27, 16384
  s_add_u32 m0, s25, 2048
  s_nop 0
  buffer_load_dwordx4 v16, s[60:63], s27 offen  lds
  s_add_u32 s27, s27, 16384
  s_add_u32 m0, s25, 3072
  s_nop 0
  buffer_load_dwordx4 v17, s[60:63], s27 offen  lds
  s_add_u32 s27, s27, 16384
  s_add_u32 m0, s25, 4096
  s_nop 0
  buffer_load_dwordx4 v18, s[60:63], s27 offen  lds
  s_add_u32 s27, s27, 16384
  s_add_u32 m0, s25, 5120
  s_nop 0
  buffer_load_dwordx4 v19, s[60:63], s27 offen  lds
  s_add_u32 s27, s27, 16384
  s_add_u32 m0, s25, 6144
  s_nop 0
  buffer_load_dwordx4 v18, s[60:63], s27 offen  lds
  s_add_u32 s27, s27, 16384
  s_add_u32 m0, s25, 7168
  s_nop 0
  buffer_load_dwordx4 v19, s[60:63], s27 offen  lds
  s_add_u32 s27, s27, 16384
  s_add_u32 m0, s25, 8192
  s_nop 0
  buffer_load_dwordx4 v20, s[60:63], s27 offen  lds
  s_add_u32 s27, s27, 16384
  s_add_u32 m0, s25, 9216
  s_nop 0
  buffer_load_dwordx4 v21, s[60:63], s27 offen  lds
  s_add_u32 s27, s27, 16384
  s_add_u32 m0, s25, 10240
  s_nop 0
  buffer_load_dwordx4 v20, s[60:63], s27 offen  lds
  s_add_u32 s27, s27, 16384
  s_add_u32 m0, s25, 11264
  s_nop 0
  buffer_load_dwordx4 v21, s[60:63], s27 offen  lds
  s_add_u32 s27, s27, 16384
  s_add_u32 m0, s25, 12288
  s_nop 0
  buffer_load_dwordx4 v22, s[60:63], s27 offen  lds
  s_add_u32 s27, s27, 16384
  s_add_u32 m0, s25, 13312
  s_nop 0
  buffer_load_dwordx4 v23, s[60:63], s27 offen  lds
  s_add_u32 s27, s27, 16384
  s_add_u32 m0, s25, 14336
  s_nop 0
  buffer_load_dwordx4 v22, s[60:63], s27 offen  lds
  s_add_u32 s27, s27, 16384
  s_add_u32 m0, s25, 15360
  s_nop 0
  buffer_load_dwordx4 v23, s[60:63], s27 offen  lds
  s_add_u32 s27, s27, 16384
  s_add_u32 s27, s28, 4
  s_min_u32 s27, s27, 13
  s_lshl_b32 s27, s27, 18
  s_add_u32 s27, s27, s26
  s_add_u32 m0, s25, 16384
  s_nop 0
  buffer_load_dwordx4 v16, s[60:63], s27 offen  lds
  s_add_u32 s27, s27, 16384
  s_add_u32 m0, s25, 17408
  s_nop 0
  buffer_load_dwordx4 v17, s[60:63], s27 offen  lds
  s_add_u32 s27, s27, 16384
  s_add_u32 m0, s25, 18432
  s_nop 0
  buffer_load_dwordx4 v16, s[60:63], s27 offen  lds
  s_add_u32 s27, s27, 16384
  s_add_u32 m0, s25, 19456
  s_nop 0
  buffer_load_dwordx4 v17, s[60:63], s27 offen  lds
  s_add_u32 s27, s27, 16384
  s_add_u32 m0, s25, 20480
  s_nop 0
  buffer_load_dwordx4 v18, s[60:63], s27 offen  lds
  s_add_u32 s27, s27, 16384
  s_add_u32 m0, s25, 21504
  s_nop 0
  buffer_load_dwordx4 v19, s[60:63], s27 offen  lds
  s_add_u32 s27, s27, 16384
  s_add_u32 m0, s25, 22528
  s_nop 0
  buffer_load_dwordx4 v18, s[60:63], s27 offen  lds
  s_add_u32 s27, s27, 16384
  s_add_u32 m0, s25, 23552
  s_nop 0
  buffer_load_dwordx4 v19, s[60:63], s27 offen  lds
  s_add_u32 s27, s27, 16384
  s_add_u32 m0, s25, 24576
  s_nop 0
  buffer_load_dwordx4 v20, s[60:63], s27 offen  lds
  s_add_u32 s27, s27, 16384
  s_add_u32 m0, s25, 25600
  s_nop 0
  buffer_load_dwordx4 v21, s[60:63], s27 offen  lds
  s_add_u32 s27, s27, 16384
  s_add_u32 m0, s25, 26624
  s_nop 0
  buffer_load_dwordx4 v20, s[60:63], s27 offen  lds
  s_add_u32 s27, s27, 16384
  s_add_u32 m0, s25, 27648
  s_nop 0
  buffer_load_dwordx4 v21, s[60:63], s27 offen  lds
  s_add_u32 s27, s27, 16384
  s_add_u32 m0, s25, 28672
  s_nop 0
  buffer_load_dwordx4 v22, s[60:63], s27 offen  lds
  s_add_u32 s27, s27, 16384
  s_add_u32 m0, s25, 29696
  s_nop 0
  buffer_load_dwordx4 v23, s[60:63], s27 offen  lds
  s_add_u32 s27, s27, 16384
  s_add_u32 m0, s25, 30720
  s_nop 0
  buffer_load_dwordx4 v22, s[60:63], s27 offen  lds
  s_add_u32 s27, s27, 16384
  s_add_u32 m0, s25, 31744
  s_nop 0
  buffer_load_dwordx4 v23, s[60:63], s27 offen  lds
  s_add_u32 s27, s27, 16384
  v_lshrrev_b32 v7, 2, v4
  v_lshlrev_b32 v11, 4, v7
  v_lshlrev_b32 v7, 3, v7
  v_and_b32 v8, 3, v4
  v_add_u32 v7, v7, v8
  v_and_b32 v8, 2, v4
  v_lshl_add_u32 v11, v8, 1, v11
  v_and_b32 v8, 1, v4
  v_add_u32 v11, v11, v8
  v_or_b32 v10, 0, v3
  v_xor_b32 v10, v10, v4
  v_lshlrev_b32 v10, 4, v10
  v_lshl_add_u32 v44, v11, 9, v10
  v_lshl_add_u32 v10, v7, 9, v10
  v_add_u32 v32, s25, v10
  v_or_b32 v10, 4, v3
  v_xor_b32 v10, v10, v4
  v_lshlrev_b32 v10, 4, v10
  v_lshl_add_u32 v45, v11, 9, v10
  v_lshl_add_u32 v10, v7, 9, v10
  v_add_u32 v33, s25, v10
  v_or_b32 v10, 8, v3
  v_xor_b32 v10, v10, v4
  v_lshlrev_b32 v10, 4, v10
  v_lshl_add_u32 v46, v11, 9, v10
  v_lshl_add_u32 v10, v7, 9, v10
  v_add_u32 v34, s25, v10
  v_or_b32 v10, 12, v3
  v_xor_b32 v10, v10, v4
  v_lshlrev_b32 v10, 4, v10
  v_lshl_add_u32 v47, v11, 9, v10
  v_lshl_add_u32 v10, v7, 9, v10
  v_add_u32 v35, s25, v10
  s_mul_i32 s30, s17, 401408
  s_mul_i32 s31, s18, 57344
  s_add_u32 s30, s30, s31
  s_add_u32 s30, s30, 0
  v_add_u32 v28, s30, v2
  s_add_u32 s30, s30, 14336
  v_add_u32 v29, s30, v2
  s_add_u32 s30, s30, 14336
  v_add_u32 v30, s30, v2
  s_add_u32 s30, s30, 14336
  v_add_u32 v31, s30, v2
  s_add_u32 s30, s30, 14336
  v_mov_b32 v48, 1035512379
wp_A:
  s_lshl_b32 s29, s28, 10
  s_add_u32 s31, s29, 4096
  s_cmp_lt_u32 s28, 10
  s_cselect_b32 s31, s31, 0x40000000
  s_waitcnt vmcnt(0)
  s_barrier
  ds_read_b128 a[0:3], v44 offset:0
  ds_read_b128 a[32:35], v44 offset:1024
  ds_read_b128 a[64:67], v44 offset:4096
  ds_read_b128 a[96:99], v44 offset:5120
  ds_read_b128 a[128:131], v32 offset:0
  ds_read_b128 a[160:163], v32 offset:2048
  ds_read_b128 a[192:195], v32 offset:16384
  ds_read_b128 a[224:227], v32 offset:18432
  s_waitcnt lgkmcnt(0)
  v_mfma_f32_16x16x32_bf16 v[64:67], a[128:131], a[0:3], 0
  ds_read_b128 a[4:7], v45 offset:0
  ds_read_b128 a[36:39], v45 offset:1024
  v_mfma_f32_16x16x32_bf16 v[68:71], a[160:163], a[0:3], 0
  ds_read_b128 a[68:71], v45 offset:4096
  ds_read_b128 a[100:103], v45 offset:5120
  v_mfma_f32_16x16x32_bf16 v[72:75], a[128:131], a[32:35], 0
  ds_read_b128 a[132:135], v33 offset:0
  ds_read_b128 a[164:167], v33 offset:2048
  v_mfma_f32_16x16x32_bf16 v[76:79], a[160:163], a[32:35], 0
  ds_read_b128 a[196:199], v33 offset:16384
  ds_read_b128 a[228:231], v33 offset:18432
  v_mfma_f32_16x16x32_bf16 v[80:83], a[128:131], a[64:67], 0
  v_mfma_f32_16x16x32_bf16 v[84:87], a[160:163], a[64:67], 0
  v_mfma_f32_16x16x32_bf16 v[88:91], a[128:131], a[96:99], 0
  v_mfma_f32_16x16x32_bf16 v[92:95], a[160:163], a[96:99], 0
  v_mfma_f32_16x16x32_bf16 v[96:99], a[192:195], a[0:3], 0
  v_mfma_f32_16x16x32_bf16 v[100:103], a[224:227], a[0:3], 0
  v_mfma_f32_16x16x32_bf16 v[104:107], a[192:195], a[32:35], 0
  v_mfma_f32_16x16x32_bf16 v[108:111], a[224:227], a[32:35], 0
  v_mfma_f32_16x16x32_bf16 v[112:115], a[192:195], a[64:67], 0
  v_mfma_f32_16x16x32_bf16 v[116:119], a[224:227], a[64:67], 0
  v_mfma_f32_16x16x32_bf16 v[120:123], a[192:195], a[96:99], 0
  v_mfma_f32_16x16x32_bf16 v[124:127], a[224:227], a[96:99], 0
  s_waitcnt lgkmcnt(0)
  v_mfma_f32_16x16x32_bf16 v[64:67], a[132:135], a[4:7], v[64:67]
  ds_read_b128 a[8:11], v46 offset:0
  ds_read_b128 a[40:43], v46 offset:1024
  v_mfma_f32_16x16x32_bf16 v[68:71], a[164:167], a[4:7], v[68:71]
  ds_read_b128 a[72:75], v46 offset:4096
  ds_read_b128 a[104:107], v46 offset:5120
  v_mfma_f32_16x16x32_bf16 v[72:75], a[132:135], a[36:39], v[72:75]
  ds_read_b128 a[136:139], v34 offset:0
  ds_read_b128 a[168:171], v34 offset:2048
  v_mfma_f32_16x16x32_bf16 v[76:79], a[164:167], a[36:39], v[76:79]
  ds_read_b128 a[200:203], v34 offset:16384
  ds_read_b128 a[232:235], v34 offset:18432
  v_mfma_f32_16x16x32_bf16 v[80:83], a[132:135], a[68:71], v[80:83]
  v_mfma_f32_16x16x32_bf16 v[84:87], a[164:167], a[68:71], v[84:87]
  v_mfma_f32_16x16x32_bf16 v[88:91], a[132:135], a[100:103], v[88:91]
  v_mfma_f32_16x16x32_bf16 v[92:95], a[164:167], a[100:103], v[92:95]
  v_mfma_f32_16x16x32_bf16 v[96:99], a[196:199], a[4:7], v[96:99]
  v_mfma_f32_16x16x32_bf16 v[100:103], a[228:231], a[4:7], v[100:103]
  v_mfma_f32_16x16x32_bf16 v[104:107], a[196:199], a[36:39], v[104:107]
  v_mfma_f32_16x16x32_bf16 v[108:111], a[228:231], a[36:39], v[108:111]
  v_mfma_f32_16x16x32_bf16 v[112:115], a[196:199], a[68:71], v[112:115]
  v_mfma_f32_16x16x32_bf16 v[116:119], a[228:231], a[68:71], v[116:119]
  v_mfma_f32_16x16x32_bf16 v[120:123], a[196:199], a[100:103], v[120:123]
  v_mfma_f32_16x16x32_bf16 v[124:127], a[228:231], a[100:103], v[124:127]
  s_waitcnt lgkmcnt(0)
  v_mfma_f32_16x16x32_bf16 v[64:67], a[136:139], a[8:11], v[64:67]
  ds_read_b128 a[12:15], v47 offset:0
  ds_read_b128 a[44:47], v47 offset:1024
  v_mfma_f32_16x16x32_bf16 v[68:71], a[168:171], a[8:11], v[68:71]
  ds_read_b128 a[76:79], v47 offset:4096
  ds_read_b128 a[108:111], v47 offset:5120
  v_mfma_f32_16x16x32_bf16 v[72:75], a[136:139], a[40:43], v[72:75]
  ds_read_b128 a[140:143], v35 offset:0
  ds_read_b128 a[172:175], v35 offset:2048
  v_mfma_f32_16x16x32_bf16 v[76:79], a[168:171], a[40:43], v[76:79]
  ds_read_b128 a[204:207], v35 offset:16384
  ds_read_b128 a[236:239], v35 offset:18432
  v_mfma_f32_16x16x32_bf16 v[80:83], a[136:139], a[72:75], v[80:83]
  v_mfma_f32_16x16x32_bf16 v[84:87], a[168:171], a[72:75], v[84:87]
  v_mfma_f32_16x16x32_bf16 v[88:91], a[136:139], a[104:107], v[88:91]
  v_mfma_f32_16x16x32_bf16 v[92:95], a[168:171], a[104:107], v[92:95]
  v_mfma_f32_16x16x32_bf16 v[96:99], a[200:203], a[8:11], v[96:99]
  v_mfma_f32_16x16x32_bf16 v[100:103], a[232:235], a[8:11], v[100:103]
  v_mfma_f32_16x16x32_bf16 v[104:107], a[200:203], a[40:43], v[104:107]
  v_mfma_f32_16x16x32_bf16 v[108:111], a[232:235], a[40:43], v[108:111]
  v_mfma_f32_16x16x32_bf16 v[112:115], a[200:203], a[72:75], v[112:115]
  v_mfma_f32_16x16x32_bf16 v[116:119], a[232:235], a[72:75], v[116:119]
  v_mfma_f32_16x16x32_bf16 v[120:123], a[200:203], a[104:107], v[120:123]
  v_mfma_f32_16x16x32_bf16 v[124:127], a[232:235], a[104:107], v[124:127]
  s_waitcnt lgkmcnt(0)
  v_mfma_f32_16x16x32_bf16 v[64:67], a[140:143], a[12:15], v[64:67]
  ds_read_b128 a[16:19], v44 offset:256
  ds_read_b128 a[48:51], v44 offset:1280
  v_mfma_f32_16x16x32_bf16 v[68:71], a[172:175], a[12:15], v[68:71]
  ds_read_b128 a[80:83], v44 offset:4352
  ds_read_b128 a[112:115], v44 offset:5376
  v_mfma_f32_16x16x32_bf16 v[72:75], a[140:143], a[44:47], v[72:75]
  ds_read_b128 a[144:147], v32 offset:256
  ds_read_b128 a[176:179], v32 offset:2304
  v_mfma_f32_16x16x32_bf16 v[76:79], a[172:175], a[44:47], v[76:79]
  ds_read_b128 a[208:211], v32 offset:16640
  ds_read_b128 a[240:243], v32 offset:18688
  v_mfma_f32_16x16x32_bf16 v[80:83], a[140:143], a[76:79], v[80:83]
  v_mfma_f32_16x16x32_bf16 v[84:87], a[172:175], a[76:79], v[84:87]
  v_mfma_f32_16x16x32_bf16 v[88:91], a[140:143], a[108:111], v[88:91]
  v_mfma_f32_16x16x32_bf16 v[92:95], a[172:175], a[108:111], v[92:95]
  v_mfma_f32_16x16x32_bf16 v[96:99], a[204:207], a[12:15], v[96:99]
  v_mfma_f32_16x16x32_bf16 v[100:103], a[236:239], a[12:15], v[100:103]
  v_mfma_f32_16x16x32_bf16 v[104:107], a[204:207], a[44:47], v[104:107]
  v_mfma_f32_16x16x32_bf16 v[108:111], a[236:239], a[44:47], v[108:111]
  v_mfma_f32_16x16x32_bf16 v[112:115], a[204:207], a[76:79], v[112:115]
  v_mfma_f32_16x16x32_bf16 v[116:119], a[236:239], a[76:79], v[116:119]
  v_mfma_f32_16x16x32_bf16 v[120:123], a[204:207], a[108:111], v[120:123]
  v_mfma_f32_16x16x32_bf16 v[124:127], a[236:239], a[108:111], v[124:127]
  s_waitcnt lgkmcnt(0)
  v_mfma_f32_16x16x32_bf16 v[64:67], a[144:147], a[16:19], v[64:67]
  ds_read_b128 a[20:23], v45 offset:256
  ds_read_b128 a[52:55], v45 offset:1280
  v_mfma_f32_16x16x32_bf16 v[68:71], a[176:179], a[16:19], v[68:71]
  ds_read_b128 a[84:87], v45 offset:4352
  ds_read_b128 a[116:119], v45 offset:5376
  v_mfma_f32_16x16x32_bf16 v[72:75], a[144:147], a[48:51], v[72:75]
  ds_read_b128 a[148:151], v33 offset:256
  ds_read_b128 a[180:183], v33 offset:2304
  v_mfma_f32_16x16x32_bf16 v[76:79], a[176:179], a[48:51], v[76:79]
  ds_read_b128 a[212:215], v33 offset:16640
  ds_read_b128 a[244:247], v33 offset:18688
  v_mfma_f32_16x16x32_bf16 v[80:83], a[144:147], a[80:83], v[80:83]
  v_mfma_f32_16x16x32_bf16 v[84:87], a[176:179], a[80:83], v[84:87]
  v_mfma_f32_16x16x32_bf16 v[88:91], a[144:147], a[112:115], v[88:91]
  v_mfma_f32_16x16x32_bf16 v[92:95], a[176:179], a[112:115], v[92:95]
  v_mfma_f32_16x16x32_bf16 v[96:99], a[208:211], a[16:19], v[96:99]
  v_mfma_f32_16x16x32_bf16 v[100:103], a[240:243], a[16:19], v[100:103]
  v_mfma_f32_16x16x32_bf16 v[104:107], a[208:211], a[48:51], v[104:107]
  v_mfma_f32_16x16x32_bf16 v[108:111], a[240:243], a[48:51], v[108:111]
  v_mfma_f32_16x16x32_bf16 v[112:115], a[208:211], a[80:83], v[112:115]
  v_mfma_f32_16x16x32_bf16 v[116:119], a[240:243], a[80:83], v[116:119]
  v_mfma_f32_16x16x32_bf16 v[120:123], a[208:211], a[112:115], v[120:123]
  v_mfma_f32_16x16x32_bf16 v[124:127], a[240:243], a[112:115], v[124:127]
  s_waitcnt lgkmcnt(0)
  v_mfma_f32_16x16x32_bf16 v[64:67], a[148:151], a[20:23], v[64:67]
  ds_read_b128 a[24:27], v46 offset:256
  ds_read_b128 a[56:59], v46 offset:1280
  v_mfma_f32_16x16x32_bf16 v[68:71], a[180:183], a[20:23], v[68:71]
  ds_read_b128 a[88:91], v46 offset:4352
  ds_read_b128 a[120:123], v46 offset:5376
  v_mfma_f32_16x16x32_bf16 v[72:75], a[148:151], a[52:55], v[72:75]
  ds_read_b128 a[152:155], v34 offset:256
  ds_read_b128 a[184:187], v34 offset:2304
  v_mfma_f32_16x16x32_bf16 v[76:79], a[180:183], a[52:55], v[76:79]
  ds_read_b128 a[216:219], v34 offset:16640
  ds_read_b128 a[248:251], v34 offset:18688
  v_mfma_f32_16x16x32_bf16 v[80:83], a[148:151], a[84:87], v[80:83]
  v_mfma_f32_16x16x32_bf16 v[84:87], a[180:183], a[84:87], v[84:87]
  v_mfma_f32_16x16x32_bf16 v[88:91], a[148:151], a[116:119], v[88:91]
  v_mfma_f32_16x16x32_bf16 v[92:95], a[180:183], a[116:119], v[92:95]
  v_mfma_f32_16x16x32_bf16 v[96:99], a[212:215], a[20:23], v[96:99]
  v_mfma_f32_16x16x32_bf16 v[100:103], a[244:247], a[20:23], v[100:103]
  v_mfma_f32_16x16x32_bf16 v[104:107], a[212:215], a[52:55], v[104:107]
  v_mfma_f32_16x16x32_bf16 v[108:111], a[244:247], a[52:55], v[108:111]
  v_mfma_f32_16x16x32_bf16 v[112:115], a[212:215], a[84:87], v[112:115]
  v_mfma_f32_16x16x32_bf16 v[116:119], a[244:247], a[84:87], v[116:119]
  v_mfma_f32_16x16x32_bf16 v[120:123], a[212:215], a[116:119], v[120:123]
  v_mfma_f32_16x16x32_bf16 v[124:127], a[244:247], a[116:119], v[124:127]
  s_waitcnt lgkmcnt(0)
  v_mfma_f32_16x16x32_bf16 v[64:67], a[152:155], a[24:27], v[64:67]
  ds_read_b128 a[28:31], v47 offset:256
  ds_read_b128 a[60:63], v47 offset:1280
  v_mfma_f32_16x16x32_bf16 v[68:71], a[184:187], a[24:27], v[68:71]
  ds_read_b128 a[92:95], v47 offset:4352
  ds_read_b128 a[124:127], v47 offset:5376
  v_mfma_f32_16x16x32_bf16 v[72:75], a[152:155], a[56:59], v[72:75]
  ds_read_b128 a[156:159], v35 offset:256
  ds_read_b128 a[188:191], v35 offset:2304
  v_mfma_f32_16x16x32_bf16 v[76:79], a[184:187], a[56:59], v[76:79]
  ds_read_b128 a[220:223], v35 offset:16640
  ds_read_b128 a[252:255], v35 offset:18688
  v_mfma_f32_16x16x32_bf16 v[80:83], a[152:155], a[88:91], v[80:83]
  v_mfma_f32_16x16x32_bf16 v[84:87], a[184:187], a[88:91], v[84:87]
  v_mfma_f32_16x16x32_bf16 v[88:91], a[152:155], a[120:123], v[88:91]
  v_mfma_f32_16x16x32_bf16 v[92:95], a[184:187], a[120:123], v[92:95]
  v_mfma_f32_16x16x32_bf16 v[96:99], a[216:219], a[24:27], v[96:99]
  v_mfma_f32_16x16x32_bf16 v[100:103], a[248:251], a[24:27], v[100:103]
  v_mfma_f32_16x16x32_bf16 v[104:107], a[216:219], a[56:59], v[104:107]
  v_mfma_f32_16x16x32_bf16 v[108:111], a[248:251], a[56:59], v[108:111]
  v_mfma_f32_16x16x32_bf16 v[112:115], a[216:219], a[88:91], v[112:115]
  v_mfma_f32_16x16x32_bf16 v[116:119], a[248:251], a[88:91], v[116:119]
  v_mfma_f32_16x16x32_bf16 v[120:123], a[216:219], a[120:123], v[120:123]
  v_mfma_f32_16x16x32_bf16 v[124:127], a[248:251], a[120:123], v[124:127]
  s_waitcnt lgkmcnt(0)
  s_barrier
  buffer_load_dwordx2 v[254:255], v252, s[12:15], 0 offen offset:128 sc1
  buffer_load_dword v253, v252, s[12:15], 0 offen sc1
  v_mfma_f32_16x16x32_bf16 v[64:67], a[156:159], a[28:31], v[64:67]
  v_mfma_f32_16x16x32_bf16 v[68:71], a[188:191], a[28:31], v[68:71]
  v_mfma_f32_16x16x32_bf16 v[72:75], a[156:159], a[60:63], v[72:75]
  v_mfma_f32_16x16x32_bf16 v[76:79], a[188:191], a[60:63], v[76:79]
  v_mfma_f32_16x16x32_bf16 v[80:83], a[156:159], a[92:95], v[80:83]
  v_pk_mul_f32 v[64:65], v[64:65], v[48:49] op_sel_hi:[1,0]
  v_pk_mul_f32 v[66:67], v[66:67], v[48:49] op_sel_hi:[1,0]
  v_mfma_f32_16x16x32_bf16 v[84:87], a[188:191], a[92:95], v[84:87]
  v_pk_mul_f32 v[68:69], v[68:69], v[48:49] op_sel_hi:[1,0]
  v_pk_mul_f32 v[70:71], v[70:71], v[48:49] op_sel_hi:[1,0]
  v_mfma_f32_16x16x32_bf16 v[88:91], a[156:159], a[124:127], v[88:91]
  v_cvt_pk_bf16_f32 v64, v64, v65
  v_cvt_pk_bf16_f32 v65, v66, v67
  v_mfma_f32_16x16x32_bf16 v[92:95], a[188:191], a[124:127], v[92:95]
  v_cvt_pk_bf16_f32 v66, v68, v69
  v_cvt_pk_bf16_f32 v67, v70, v71
  v_mfma_f32_16x16x32_bf16 v[96:99], a[220:223], a[28:31], v[96:99]
  buffer_store_dwordx4 v[64:67], v28, s[8:11], s29 offen sc1
  v_pk_mul_f32 v[72:73], v[72:73], v[48:49] op_sel_hi:[1,0]
  v_mfma_f32_16x16x32_bf16 v[100:103], a[252:255], a[28:31], v[100:103]
  v_pk_mul_f32 v[74:75], v[74:75], v[48:49] op_sel_hi:[1,0]
  v_pk_mul_f32 v[76:77], v[76:77], v[48:49] op_sel_hi:[1,0]
  v_mfma_f32_16x16x32_bf16 v[104:107], a[220:223], a[60:63], v[104:107]
  v_pk_mul_f32 v[78:79], v[78:79], v[48:49] op_sel_hi:[1,0]
  v_cvt_pk_bf16_f32 v72, v72, v73
  v_mfma_f32_16x16x32_bf16 v[108:111], a[252:255], a[60:63], v[108:111]
  v_cvt_pk_bf16_f32 v73, v74, v75
  v_cvt_pk_bf16_f32 v74, v76, v77
  v_mfma_f32_16x16x32_bf16 v[112:115], a[220:223], a[92:95], v[112:115]
  v_cvt_pk_bf16_f32 v75, v78, v79
  buffer_store_dwordx4 v[72:75], v29, s[8:11], s29 offen sc1
  v_mfma_f32_16x16x32_bf16 v[116:119], a[252:255], a[92:95], v[116:119]
  v_pk_mul_f32 v[80:81], v[80:81], v[48:49] op_sel_hi:[1,0]
  v_pk_mul_f32 v[82:83], v[82:83], v[48:49] op_sel_hi:[1,0]
  v_mfma_f32_16x16x32_bf16 v[120:123], a[220:223], a[124:127], v[120:123]
  v_pk_mul_f32 v[84:85], v[84:85], v[48:49] op_sel_hi:[1,0]
  v_pk_mul_f32 v[86:87], v[86:87], v[48:49] op_sel_hi:[1,0]
  v_mfma_f32_16x16x32_bf16 v[124:127], a[252:255], a[124:127], v[124:127]
  v_cvt_pk_bf16_f32 v80, v80, v81
  v_cvt_pk_bf16_f32 v81, v82, v83
  v_cvt_pk_bf16_f32 v82, v84, v85
  v_cvt_pk_bf16_f32 v83, v86, v87
  buffer_store_dwordx4 v[80:83], v30, s[8:11], s29 offen sc1
  v_pk_mul_f32 v[88:89], v[88:89], v[48:49] op_sel_hi:[1,0]
  v_pk_mul_f32 v[90:91], v[90:91], v[48:49] op_sel_hi:[1,0]
  v_pk_mul_f32 v[92:93], v[92:93], v[48:49] op_sel_hi:[1,0]
  v_pk_mul_f32 v[94:95], v[94:95], v[48:49] op_sel_hi:[1,0]
  v_cvt_pk_bf16_f32 v88, v88, v89
  v_cvt_pk_bf16_f32 v89, v90, v91
  v_cvt_pk_bf16_f32 v90, v92, v93
  v_cvt_pk_bf16_f32 v91, v94, v95
  buffer_store_dwordx4 v[88:91], v31, s[8:11], s29 offen sc1
  v_pk_mul_f32 v[96:97], v[96:97], v[48:49] op_sel_hi:[1,0]
  v_pk_mul_f32 v[98:99], v[98:99], v[48:49] op_sel_hi:[1,0]
  v_pk_mul_f32 v[100:101], v[100:101], v[48:49] op_sel_hi:[1,0]
  v_pk_mul_f32 v[102:103], v[102:103], v[48:49] op_sel_hi:[1,0]
  v_cvt_pk_bf16_f32 v96, v96, v97
  v_cvt_pk_bf16_f32 v97, v98, v99
  v_cvt_pk_bf16_f32 v98, v100, v101
  v_cvt_pk_bf16_f32 v99, v102, v103
  buffer_store_dwordx4 v[96:99], v28, s[8:11], s31 offen sc1
  v_pk_mul_f32 v[104:105], v[104:105], v[48:49] op_sel_hi:[1,0]
  v_pk_mul_f32 v[106:107], v[106:107], v[48:49] op_sel_hi:[1,0]
  v_pk_mul_f32 v[108:109], v[108:109], v[48:49] op_sel_hi:[1,0]
  v_pk_mul_f32 v[110:111], v[110:111], v[48:49] op_sel_hi:[1,0]
  v_cvt_pk_bf16_f32 v104, v104, v105
  v_cvt_pk_bf16_f32 v105, v106, v107
  v_cvt_pk_bf16_f32 v106, v108, v109
  v_cvt_pk_bf16_f32 v107, v110, v111
  buffer_store_dwordx4 v[104:107], v29, s[8:11], s31 offen sc1
  v_pk_mul_f32 v[112:113], v[112:113], v[48:49] op_sel_hi:[1,0]
  v_pk_mul_f32 v[114:115], v[114:115], v[48:49] op_sel_hi:[1,0]
  v_pk_mul_f32 v[116:117], v[116:117], v[48:49] op_sel_hi:[1,0]
  v_pk_mul_f32 v[118:119], v[118:119], v[48:49] op_sel_hi:[1,0]
  v_cvt_pk_bf16_f32 v112, v112, v113
  v_cvt_pk_bf16_f32 v113, v114, v115
  v_cvt_pk_bf16_f32 v114, v116, v117
  v_cvt_pk_bf16_f32 v115, v118, v119
  buffer_store_dwordx4 v[112:115], v30, s[8:11], s31 offen sc1
  v_pk_mul_f32 v[120:121], v[120:121], v[48:49] op_sel_hi:[1,0]
  v_pk_mul_f32 v[122:123], v[122:123], v[48:49] op_sel_hi:[1,0]
  v_pk_mul_f32 v[124:125], v[124:125], v[48:49] op_sel_hi:[1,0]
  v_pk_mul_f32 v[126:127], v[126:127], v[48:49] op_sel_hi:[1,0]
  v_cvt_pk_bf16_f32 v120, v120, v121
  v_cvt_pk_bf16_f32 v121, v122, v123
  v_cvt_pk_bf16_f32 v122, v124, v125
  v_cvt_pk_bf16_f32 v123, v126, v127
  buffer_store_dwordx4 v[120:123], v31, s[8:11], s31 offen sc1
  s_waitcnt vmcnt(0)
  s_barrier
  s_cmp_lg_u32 s16, 0
  s_cbranch_scc1 wp_f3_f
  v_readfirstlane_b32 s20, v254
  s_cmp_eq_u32 s20, 1
  s_cbranch_scc1 wp_f3_w_ok
  s_mov_b32 s30, 0
wp_f3_w:
  buffer_load_dword v254, off, s[12:15], 0 offset:128 sc1
  s_waitcnt vmcnt(0)
  v_cmp_ne_u32 vcc, 1, v254
  s_cbranch_vccz wp_f3_w_ok
  s_sleep 8
  s_add_u32 s30, s30, 1
  s_cmp_lt_u32 s30, 16
  s_cbranch_scc1 wp_f3_w
  s_branch wp_f3_f
wp_f3_w_ok:
  s_lshl_b32 s20, s17, 7
  s_add_u32 s20, s20, 88521216
  s_lshl_b32 s21, 1, s19
  v_mov_b32 v248, s21
  s_mov_b64 exec, 1
  buffer_atomic_or v248, v252, s[8:11], s20 offen sc0
  s_mov_b64 exec, -1
  s_mov_b32 s38, s21
wp_f3_f:
  s_cmp_eq_u32 s97, 3
  s_cbranch_scc1 wk_adone
wp_fin:
  s_cmp_lg_u32 s97, 0
  s_cbranch_scc1 wp_all
  v_readfirstlane_b32 s20, v254
  v_readfirstlane_b32 s21, v253
  s_and_b32 s21, s21, 0xffe0
  s_cselect_b32 s96, s20, 0
  s_cmp_eq_u32 s96, 0
  s_cbranch_scc1 wp_all
  v_mov_b32 v250, 1
  s_mov_b32 s20, 88525312
  s_mov_b64 exec, 1
  buffer_atomic_add v250, v252, s[8:11], s20 offen sc0
  s_mov_b64 exec, -1
wp_all:
  v_mov_b32 v252, 0x40000000
  v_cmp_eq_u32 vcc, 0, v0
  s_nop 1
  v_cndmask_b32 v252, v252, v0, vcc
  s_mov_b32 s34, 0
  s_cmp_lg_u32 s16, 0
  s_cbranch_scc1 wp_w2
  s_getreg_b32 s24, hwreg(HW_REG_XCC_ID)
  s_sub_u32 s24, s24, 0
  s_and_b32 s24, s24, 7
  s_lshl_b32 s24, s24, 7
  s_add_u32 s24, s24, 88523264
  s_cmp_lg_u32 s96, 0
  s_cbranch_scc1 wp_v0
  s_waitcnt vmcnt(0)
wp_v0:
  s_cmp_eq_u32 s97, 0
  s_cbranch_scc1 wp_v1
  s_waitcnt vmcnt(0)
wp_v1:
  s_waitcnt vmcnt(1)
  v_readfirstlane_b32 s20, v248
  s_and_b32 s20, s20, 14448
  s_xor_b32 s20, s20, s38
  s_cmp_lg_u32 s20, 14448
  s_cselect_b32 s20, 0, s38
  s_mov_b32 s38, 0
  s_cmp_eq_u32 s20, 0
  s_cbranch_scc1 wp_g3
  s_lshl_b32 s21, 65536, s17
  v_mov_b32 v248, s21
  s_mov_b32 s20, 88523264
  v_lshlrev_b32 v247, 7, v0
  s_mov_b64 exec, 0xff
  buffer_atomic_or v248, v247, s[8:11], s20 offen
  s_mov_b64 exec, -1
wp_g3:
  v_readfirstlane_b32 s20, v248
  s_and_b32 s20, s20, 16383
  s_xor_b32 s20, s20, s37
  s_cmp_lg_u32 s20, 16383
  s_cselect_b32 s20, 0, s37
  s_mov_b32 s37, 0
  s_cmp_eq_u32 s20, 0
  s_cbranch_scc1 wp_g2
  s_lshl_b32 s21, 1, s17
  v_mov_b32 v248, s21
  s_mov_b32 s20, 88523264
  v_lshlrev_b32 v247, 7, v0
  s_mov_b64 exec, 0xff
  buffer_atomic_or v248, v247, s[8:11], s20 offen
  s_mov_b64 exec, -1
wp_g2:
  s_cmp_lg_u32 s96, 0
  s_cbranch_scc1 wp_v_ok
  s_mov_b32 s30, 0
wp_v:
  buffer_load_dwordx2 v[64:65], off, s[12:15], 0 sc1
  buffer_load_dword v66, off, s[12:15], 0 offset:128 sc1
  s_waitcnt vmcnt(0)
  v_and_b32 v68, 0xffe0, v64
  v_min_u32 v68, v68, v66
  v_cmp_ne_u32 vcc, 1, v68
  s_cbranch_vccz wp_v_ok
  s_sleep 16
  s_add_u32 s30, s30, 1
  s_cmp_lt_u32 s30, 30
  s_cbranch_scc1 wp_v
  s_branch wp_w1
wp_v_ok:
  v_mov_b32 v64, 32
  s_cmp_eq_u32 s97, 2
  s_cselect_b32 s31, 1, 60
  s_mov_b32 s30, 0
wp_w:
  buffer_load_dwordx2 v[66:67], off, s[8:11], s24 sc1
  s_waitcnt vmcnt(0)
  v_or_b32 v66, s39, v66
  v_add_u32 v66, v66, v67
  v_cmp_ne_u32 vcc, 0, v66
  s_cbranch_vccz wp_w_ok
  s_sleep 8
  s_add_u32 s30, s30, 1
  s_cmp_lt_u32 s30, s31
  s_cbranch_scc1 wp_w
  s_branch wp_w1
wp_w_ok:
  s_branch wp_w2
wp_w1:
  v_readfirstlane_b32 s20, v64
  v_readfirstlane_b32 s21, v65
  s_and_b32 s20, s20, 0xffff
  s_cmp_lt_u32 s20, 32
  s_cselect_b32 s34, 2, 1
  s_add_u32 s32, s32, 1
  s_cmp_lt_u32 s32, 4000
  s_cselect_b32 s34, s34, 3
wp_w2:
  v_mov_b32 v6, 160032
  v_mov_b32 v7, s34
  s_barrier
  s_cmp_lg_u32 s16, 0
  s_cbranch_scc1 uni_8
  ds_write_b32 v6, v7
  s_waitcnt lgkmcnt(0)
uni_8:
  s_barrier
  ds_read_b32 v7, v6
  s_waitcnt lgkmcnt(0)
  v_readfirstlane_b32 s34, v7
  s_cmp_lg_u32 s34, 0
  s_cbranch_scc1 wp_bad
  s_cmp_lg_u32 s39, -4
  s_cbranch_scc1 wp_done
  s_mov_b32 s101, 0
  s_lshl_b32 s20, s101, 4
  s_lshr_b32 s21, s2, 3
  s_add_u32 s21, s21, s16
  s_and_b32 s21, s21, 3
  s_lshl_b32 s21, s21, 2
  s_add_u32 s20, s20, s21
  s_mul_i32 s21, s20, 14336
  s_add_u32 s21, s21, 72024064
  s_add_u32 s22, s21, 0
  buffer_load_dwordx4 a[0:3], v2, s[8:11], s22 offen offset:0 sc1
  buffer_load_dwordx4 a[4:7], v2, s[8:11], s22 offen offset:1024 sc1
  buffer_load_dwordx4 a[8:11], v2, s[8:11], s22 offen offset:2048 sc1
  buffer_load_dwordx4 a[12:15], v2, s[8:11], s22 offen offset:3072 sc1
  s_add_u32 s22, s21, 4096
  buffer_load_dwordx4 a[16:19], v2, s[8:11], s22 offen offset:0 sc1
  buffer_load_dwordx4 a[20:23], v2, s[8:11], s22 offen offset:1024 sc1
  buffer_load_dwordx4 a[24:27], v2, s[8:11], s22 offen offset:2048 sc1
  buffer_load_dwordx4 a[28:31], v2, s[8:11], s22 offen offset:3072 sc1
  s_add_u32 s22, s21, 8192
  buffer_load_dwordx4 a[32:35], v2, s[8:11], s22 offen offset:0 sc1
  buffer_load_dwordx4 a[36:39], v2, s[8:11], s22 offen offset:1024 sc1
  buffer_load_dwordx4 a[40:43], v2, s[8:11], s22 offen offset:2048 sc1
  buffer_load_dwordx4 a[44:47], v2, s[8:11], s22 offen offset:3072 sc1
  s_add_u32 s22, s21, 12288
  buffer_load_dwordx4 a[48:51], v2, s[8:11], s22 offen offset:0 sc1
  buffer_load_dwordx4 a[52:55], v2, s[8:11], s22 offen offset:1024 sc1
  buffer_load_dwordx4 a[56:59], v2, s[8:11], s22 offen offset:2048 sc1
  buffer_load_dwordx4 a[60:63], v2, s[8:11], s22 offen offset:3072 sc1
  s_add_u32 s22, s21, 16384
  buffer_load_dwordx4 a[64:67], v2, s[8:11], s22 offen offset:0 sc1
  buffer_load_dwordx4 a[68:71], v2, s[8:11], s22 offen offset:1024 sc1
  buffer_load_dwordx4 a[72:75], v2, s[8:11], s22 offen offset:2048 sc1
  buffer_load_dwordx4 a[76:79], v2, s[8:11], s22 offen offset:3072 sc1
  s_add_u32 s22, s21, 20480
  buffer_load_dwordx4 a[80:83], v2, s[8:11], s22 offen offset:0 sc1
  buffer_load_dwordx4 a[84:87], v2, s[8:11], s22 offen offset:1024 sc1
  buffer_load_dwordx4 a[88:91], v2, s[8:11], s22 offen offset:2048 sc1
  buffer_load_dwordx4 a[92:95], v2, s[8:11], s22 offen offset:3072 sc1
  s_add_u32 s22, s21, 24576
  buffer_load_dwordx4 a[96:99], v2, s[8:11], s22 offen offset:0 sc1
  buffer_load_dwordx4 a[100:103], v2, s[8:11], s22 offen offset:1024 sc1
  buffer_load_dwordx4 a[104:107], v2, s[8:11], s22 offen offset:2048 sc1
  buffer_load_dwordx4 a[108:111], v2, s[8:11], s22 offen offset:3072 sc1
  s_add_u32 s22, s21, 28672
  buffer_load_dwordx4 a[112:115], v2, s[8:11], s22 offen offset:0 sc1
  buffer_load_dwordx4 a[116:119], v2, s[8:11], s22 offen offset:1024 sc1
  buffer_load_dwordx4 a[120:123], v2, s[8:11], s22 offen offset:2048 sc1
  buffer_load_dwordx4 a[124:127], v2, s[8:11], s22 offen offset:3072 sc1
  s_add_u32 s22, s21, 32768
  buffer_load_dwordx4 a[128:131], v2, s[8:11], s22 offen offset:0 sc1
  buffer_load_dwordx4 a[132:135], v2, s[8:11], s22 offen offset:1024 sc1
  buffer_load_dwordx4 a[136:139], v2, s[8:11], s22 offen offset:2048 sc1
  buffer_load_dwordx4 a[140:143], v2, s[8:11], s22 offen offset:3072 sc1
  s_add_u32 s22, s21, 36864
  buffer_load_dwordx4 a[144:147], v2, s[8:11], s22 offen offset:0 sc1
  buffer_load_dwordx4 a[148:151], v2, s[8:11], s22 offen offset:1024 sc1
  buffer_load_dwordx4 a[152:155], v2, s[8:11], s22 offen offset:2048 sc1
  buffer_load_dwordx4 a[156:159], v2, s[8:11], s22 offen offset:3072 sc1
  s_add_u32 s22, s21, 40960
  s_waitcnt vmcnt(40)
  buffer_load_dwordx4 a[160:163], v2, s[8:11], s22 offen offset:0 sc1
  buffer_load_dwordx4 a[164:167], v2, s[8:11], s22 offen offset:1024 sc1
  buffer_load_dwordx4 a[168:171], v2, s[8:11], s22 offen offset:2048 sc1
  buffer_load_dwordx4 a[172:175], v2, s[8:11], s22 offen offset:3072 sc1
  s_add_u32 s22, s21, 45056
  buffer_load_dwordx4 a[176:179], v2, s[8:11], s22 offen offset:0 sc1
  buffer_load_dwordx4 a[180:183], v2, s[8:11], s22 offen offset:1024 sc1
  buffer_load_dwordx4 a[184:187], v2, s[8:11], s22 offen offset:2048 sc1
  buffer_load_dwordx4 a[188:191], v2, s[8:11], s22 offen offset:3072 sc1
  s_add_u32 s22, s21, 49152
  buffer_load_dwordx4 a[192:195], v2, s[8:11], s22 offen offset:0 sc1
  buffer_load_dwordx4 a[196:199], v2, s[8:11], s22 offen offset:1024 sc1
  buffer_load_dwordx4 a[200:203], v2, s[8:11], s22 offen offset:2048 sc1
  buffer_load_dwordx4 a[204:207], v2, s[8:11], s22 offen offset:3072 sc1
  s_add_u32 s22, s21, 53248
  buffer_load_dwordx4 a[208:211], v2, s[8:11], s22 offen offset:0 sc1
  buffer_load_dwordx4 a[212:215], v2, s[8:11], s22 offen offset:1024 sc1
  buffer_load_dwordx4 a[216:219], v2, s[8:11], s22 offen offset:2048 sc1
  buffer_load_dwordx4 a[220:223], v2, s[8:11], s22 offen offset:3072 sc1
  s_mov_b32 s39, 0xffff0000
  s_branch wp_all
wp_bad:
  s_and_b32 s39, s39, 0xffff0000
  s_mov_b32 s97, 1
  s_cmp_eq_u32 s34, 1
  s_cbranch_scc1 wp_rep
  s_cmp_eq_u32 s34, 3
  s_cbranch_scc1 cA_abort
  s_load_dwordx8 s[40:47], s[0:1], 72
  s_load_dwordx4 s[48:51], s[0:1], 56
  s_waitcnt lgkmcnt(0)
  v_mov_b32 v4, 0x10001
  s_mov_b32 s18, 1
  s_branch ch_take
wp_rep:
  s_mov_b32 s101, -1
  s_load_dwordx8 s[40:47], s[0:1], 72
  s_load_dwordx4 s[48:51], s[0:1], 56
  s_waitcnt vmcnt(0) lgkmcnt(0)
  v_mov_b32 v4, 1
  v_mov_b32 v5, 20
  v_mov_b32 v6, 160000
  s_barrier
  s_cmp_lg_u32 s16, 0
  s_cbranch_scc1 wp_el1
  s_mov_b64 exec, 1
  buffer_atomic_add v4, v5, s[12:15], 0 offen sc0
  s_waitcnt vmcnt(0)
  ds_write_b32 v6, v4
  s_waitcnt lgkmcnt(0)
  s_mov_b64 exec, -1
wp_el1:
  s_barrier
  ds_read_b32 v4, v6
  s_waitcnt lgkmcnt(0)
  v_readfirstlane_b32 s33, v4
  v_and_b32 v1, 63, v0
  v_lshlrev_b32 v2, 4, v1
  v_lshrrev_b32 v3, 4, v1
  v_and_b32 v4, 15, v1
  v_lshrrev_b32 v5, 5, v1
  v_and_b32 v6, 31, v1
  v_xor_b32 v8, v6, v5
  v_lshlrev_b32 v8, 4, v8
  v_lshl_add_u32 v16, v5, 13, v8
  v_xor_b32 v17, 32, v16
  v_xor_b32 v18, 64, v16
  v_xor_b32 v19, 96, v16
  v_xor_b32 v20, 128, v16
  v_xor_b32 v21, 160, v16
  v_xor_b32 v22, 192, v16
  v_xor_b32 v23, 224, v16
  s_lshl_b32 s20, s16, 6
  v_xor_b32 v26, s20, v16
  v_xor_b32 v27, 32, v26
  s_and_b32 s33, s33, 511
  s_and_b32 s20, s33, 255
  s_cmp_ge_u32 s20, 224
  s_cselect_b32 s97, 1, 2
  s_cbranch_scc1 wp_all
  s_mul_i32 s17, s20, 4682
  s_lshr_b32 s17, s17, 16
  s_mul_i32 s23, s17, 14
  s_sub_u32 s19, s20, s23
  s_cmp_lt_u32 s19, 7
  s_cselect_b32 s18, 0, 7
  s_cselect_b32 s28, 0, 8
  s_sub_u32 s18, s19, s18
  s_add_u32 s28, s28, s16
  s_lshl_b32 s25, s16, 15
  s_add_u32 s25, s25, 32768
  s_lshl_b32 s26, s17, 9
  s_lshl_b32 s20, s17, 7
  s_lshr_b32 s21, s33, 8
  s_lshl_b32 s21, s21, 11
  s_add_u32 s20, s20, s21
  s_add_u32 s20, s20, 88519168
  buffer_load_dword v5, off, s[8:11], s20 sc1
  s_waitcnt vmcnt(0)
  v_readfirstlane_b32 s34, v5
  v_mov_b32 v6, 160032
  s_nop 0
  v_mov_b32 v7, s34
  s_barrier
  s_cmp_lg_u32 s16, 0
  s_cbranch_scc1 uni_9
  ds_write_b32 v6, v7
  s_waitcnt lgkmcnt(0)
uni_9:
  s_barrier
  ds_read_b32 v7, v6
  s_waitcnt lgkmcnt(0)
  v_readfirstlane_b32 s34, v7
  s_cmp_lt_u32 s33, 256
  s_cselect_b32 s20, 0, 1935
  s_or_b32 s34, s34, s20
  s_bitcmp1_b32 s34, s19
  s_cbranch_scc1 wp_rep
  s_barrier
  s_cmp_lt_u32 s33, 256
  s_cbranch_scc1 wp_B
  s_branch wp_A0
wp_done:
  s_mov_b32 s97, s39
  s_cmp_lg_u32 s96, 0
  s_cbranch_scc1 wk_next
  s_cmp_lg_u32 s16, 0
  s_cbranch_scc1 ask_10
  v_mov_b32 v250, 1
  v_mov_b32 v251, 88525312
  s_mov_b64 exec, 1
  buffer_atomic_add v250, v251, s[8:11], 0 offen sc0
  s_mov_b64 exec, -1
ask_10:
  s_branch wk_next
wk_loop:
  s_waitcnt vmcnt(0) lgkmcnt(0)
wk_ask:
  v_readfirstlane_b32 s22, v250
  s_cmp_ge_u32 s22, 1264
  s_cbranch_scc1 wk_next
  s_cmp_lg_u32 s16, 0
  s_cbranch_scc1 ask_11
  v_mov_b32 v250, 1
  v_mov_b32 v251, 88525312
  s_mov_b64 exec, 1
  buffer_atomic_add v250, v251, s[8:11], 0 offen sc0
  s_mov_b64 exec, -1
ask_11:
wk_next:
  v_mov_b32 v6, 160000
  s_waitcnt vmcnt(0)
  s_barrier
  s_cmp_lg_u32 s16, 0
  s_cbranch_scc1 wk_n1
  s_mov_b64 exec, 1
  ds_write_b32 v6, v250
  s_mov_b64 exec, -1
  s_waitcnt lgkmcnt(0)
wk_n1:
  s_barrier
  ds_read_b32 v4, v6
  s_waitcnt lgkmcnt(0)
  v_readfirstlane_b32 s3, v4
  s_cmp_ge_u32 s3, 1264
  s_cbranch_scc1 wk_done
  v_mov_b32 v250, 0
  v_mov_b32 v251, 88525312
  v_and_b32 v1, 63, v0
  v_lshlrev_b32 v2, 4, v1
  v_lshrrev_b32 v3, 4, v1
  v_and_b32 v4, 15, v1
  s_cmp_lt_u32 s3, 112
  s_cbranch_scc1 wk_n2
  s_cmp_eq_u32 s97, 0
  s_cbranch_scc1 wk_n2
  v_mov_b32 v250, s3
  s_mov_b32 s96, 1
  s_mov_b32 s97, 1
  s_mov_b32 s39, 0
  s_mov_b32 s37, 0
  s_mov_b32 s38, 0
  s_mov_b32 s32, 0
  s_branch wp_all
wk_n2:
  s_cmp_ge_u32 s3, 752
  s_cbranch_scc1 wk_tok
  s_cmp_ge_u32 s3, 640
  s_cbranch_scc1 wk_s4d
  s_cmp_ge_u32 s3, 448
  s_cbranch_scc1 wk_full
  s_cmp_ge_u32 s3, 320
  s_cbranch_scc1 wk_adef
  s_cmp_ge_u32 s3, 288
  s_cbranch_scc1 wk_srv
  s_and_b32 s17, s3, 15
  s_add_u32 s17, s17, 16
  s_cmp_ge_u32 s3, 224
  s_cbranch_scc1 wk_half
  s_cmp_ge_u32 s3, 112
  s_cselect_b32 s18, 1, 0
  s_cselect_b32 s20, 112, 0
  s_sub_u32 s34, s3, s20
  s_lshr_b32 s34, s34, 4
  s_lshl_b32 s34, s34, 1
  s_add_u32 s35, s34, 2
  s_branch wk_gemm
wk_adef:
  s_mov_b32 s101, -1
  s_load_dwordx8 s[40:47], s[0:1], 72
  s_sub_u32 s20, s3, 320
  s_lshr_b32 s33, s20, 2
  s_mul_i32 s33, s33, 7
  s_and_b32 s20, s20, 3
  s_add_u32 s33, s33, s20
  s_mov_b32 s97, 3
  v_mov_b32 v252, 0x40000000
  v_cmp_eq_u32 vcc, 0, v0
  s_nop 1
  v_cndmask_b32 v252, v252, v0, vcc
  v_lshrrev_b32 v5, 5, v1
  v_and_b32 v6, 31, v1
  v_xor_b32 v8, v6, v5
  v_lshlrev_b32 v8, 4, v8
  v_lshl_add_u32 v16, v5, 13, v8
  v_xor_b32 v17, 32, v16
  v_xor_b32 v18, 64, v16
  v_xor_b32 v19, 96, v16
  v_xor_b32 v20, 128, v16
  v_xor_b32 v21, 160, v16
  v_xor_b32 v22, 192, v16
  v_xor_b32 v23, 224, v16
  s_lshl_b32 s20, s16, 6
  v_xor_b32 v26, s20, v16
  v_xor_b32 v27, 32, v26
  s_mul_i32 s17, s33, 4682
  s_lshr_b32 s17, s17, 16
  s_mul_i32 s23, s17, 14
  s_sub_u32 s19, s33, s23
  s_cmp_lt_u32 s19, 7
  s_cselect_b32 s18, 0, 7
  s_cselect_b32 s28, 0, 8
  s_sub_u32 s18, s19, s18
  s_add_u32 s28, s28, s16
  s_lshl_b32 s25, s16, 15
  s_add_u32 s25, s25, 32768
  s_lshl_b32 s26, s17, 9
  s_waitcnt lgkmcnt(0)
  s_barrier
  s_branch wp_A0
wk_adone:
  s_mov_b32 s97, 0
  s_branch wk_loop
wk_half:
  s_sub_u32 s20, s3, 224
  s_lshr_b32 s18, s20, 5
  s_add_u32 s18, s18, 2
  s_bitcmp1_b32 s20, 4
  s_cselect_b32 s34, 7, 0
  s_add_u32 s35, s34, 7
  s_branch wk_gemm
wk_full:
  s_sub_u32 s20, s3, 384
  s_and_b32 s17, s20, 15
  s_lshr_b32 s18, s20, 4
  s_mov_b32 s34, 0
  s_mov_b32 s35, 14
  s_cmp_lt_u32 s18, 8
  s_cselect_b32 s21, 16, 0
  s_add_u32 s17, s17, s21
  s_and_b32 s18, s18, 7
  s_cmp_ge_u32 s17, 16
  s_cbranch_scc1 wk_gemm
  s_lshl_b32 s27, s17, 7
  s_add_u32 s27, s27, 88521216
  s_mov_b32 s28, 16383
  s_mov_b32 s30, 0
wk_aw:
  buffer_load_dword v9, off, s[8:11], s27  sc1
  s_waitcnt vmcnt(0)
  v_and_b32 v10, s28, v9
  v_cmp_ne_u32 vcc, s28, v10
  s_cbranch_vccz wk_aw_ok
  s_sleep 3
  s_add_u32 s30, s30, 1
  s_cmp_lt_u32 s30, 400000
  s_cbranch_scc1 wk_aw
  s_branch cA_abort
wk_aw_ok:
wk_gemm:
  s_lshl_b32 s20, s18, 4
  s_lshr_b32 s21, s2, 3
  s_add_u32 s21, s21, s16
  s_and_b32 s21, s21, 3
  s_lshl_b32 s21, s21, 2
  s_add_u32 s20, s20, s21
  s_mul_i32 s21, s20, 14336
  s_add_u32 s21, s21, 72024064
  s_mul_i32 s23, s17, 401408
  s_and_b32 s22, s16, 1
  s_mul_i32 s22, s22, 7168
  s_add_u32 s23, s23, s22
  s_add_u32 s23, s23, 0
  s_lshr_b32 s22, s16, 1
  s_mul_i32 s22, s22, 14336
  s_add_u32 s23, s23, s22
  s_mul_i32 s27, s16, 7168
  s_lshr_b32 s28, s20, 1
  s_cmp_lt_u32 s17, 16
  s_cbranch_scc0 wg_vo
  s_add_u32 s23, s23, s22
  s_lshl_b32 s29, s28, 4
  s_add_u32 s29, s29, s17
  s_mul_i32 s29, s29, 28672
  s_add_u32 s29, s29, 12845056
  s_mov_b32 s31, 0
  s_lshr_b32 s24, s34, 1
  s_lshl_b32 s24, s24, 2
  s_and_b32 s25, s34, 1
  s_add_u32 s24, s24, s25
  s_mul_i32 s24, s24, 14336
  s_add_u32 s24, s24, s23
  s_add_u32 m0, s31, s27
  s_nop 0
  buffer_load_dwordx4 v2, s[8:11], s24 offen offset:0 sc1 lds
  buffer_load_dwordx4 v2, s[8:11], s24 offen offset:1024 sc1 lds
  buffer_load_dwordx4 v2, s[8:11], s24 offen offset:2048 sc1 lds
  buffer_load_dwordx4 v2, s[8:11], s24 offen offset:3072 sc1 lds
  s_add_u32 m0, m0, 4096
  s_add_u32 s24, s24, 4096
  buffer_load_dwordx4 v2, s[8:11], s24 offen offset:0 sc1 lds
  buffer_load_dwordx4 v2, s[8:11], s24 offen offset:1024 sc1 lds
  buffer_load_dwordx4 v2, s[8:11], s24 offen offset:2048 sc1 lds
  s_sub_u32 s36, s35, 1
  s_add_u32 s30, s34, 1
  s_min_u32 s30, s30, s36
  s_mov_b32 s31, 28672
  s_lshr_b32 s24, s30, 1
  s_lshl_b32 s24, s24, 2
  s_and_b32 s25, s30, 1
  s_add_u32 s24, s24, s25
  s_mul_i32 s24, s24, 14336
  s_add_u32 s24, s24, s23
  s_add_u32 m0, s31, s27
  s_nop 0
  buffer_load_dwordx4 v2, s[8:11], s24 offen offset:0 sc1 lds
  buffer_load_dwordx4 v2, s[8:11], s24 offen offset:1024 sc1 lds
  buffer_load_dwordx4 v2, s[8:11], s24 offen offset:2048 sc1 lds
  buffer_load_dwordx4 v2, s[8:11], s24 offen offset:3072 sc1 lds
  s_add_u32 m0, m0, 4096
  s_add_u32 s24, s24, 4096
  buffer_load_dwordx4 v2, s[8:11], s24 offen offset:0 sc1 lds
  buffer_load_dwordx4 v2, s[8:11], s24 offen offset:1024 sc1 lds
  buffer_load_dwordx4 v2, s[8:11], s24 offen offset:2048 sc1 lds
  s_mov_b32 s19, s34
  s_mov_b32 s32, 0
  s_mov_b32 s33, 57344
  s_cmp_eq_u32 s18, s101
  s_cbranch_scc1 wg_f_hx
  s_add_u32 s22, s21, 0
  buffer_load_dwordx4 a[0:3], v2, s[8:11], s22 offen offset:0 sc1
  buffer_load_dwordx4 a[4:7], v2, s[8:11], s22 offen offset:1024 sc1
  buffer_load_dwordx4 a[8:11], v2, s[8:11], s22 offen offset:2048 sc1
  buffer_load_dwordx4 a[12:15], v2, s[8:11], s22 offen offset:3072 sc1
  s_add_u32 s22, s21, 4096
  buffer_load_dwordx4 a[16:19], v2, s[8:11], s22 offen offset:0 sc1
  buffer_load_dwordx4 a[20:23], v2, s[8:11], s22 offen offset:1024 sc1
  buffer_load_dwordx4 a[24:27], v2, s[8:11], s22 offen offset:2048 sc1
  buffer_load_dwordx4 a[28:31], v2, s[8:11], s22 offen offset:3072 sc1
  s_add_u32 s22, s21, 8192
  buffer_load_dwordx4 a[32:35], v2, s[8:11], s22 offen offset:0 sc1
  buffer_load_dwordx4 a[36:39], v2, s[8:11], s22 offen offset:1024 sc1
  buffer_load_dwordx4 a[40:43], v2, s[8:11], s22 offen offset:2048 sc1
  buffer_load_dwordx4 a[44:47], v2, s[8:11], s22 offen offset:3072 sc1
  s_add_u32 s22, s21, 12288
  buffer_load_dwordx4 a[48:51], v2, s[8:11], s22 offen offset:0 sc1
  buffer_load_dwordx4 a[52:55], v2, s[8:11], s22 offen offset:1024 sc1
  buffer_load_dwordx4 a[56:59], v2, s[8:11], s22 offen offset:2048 sc1
  buffer_load_dwordx4 a[60:63], v2, s[8:11], s22 offen offset:3072 sc1
  s_add_u32 s22, s21, 16384
  buffer_load_dwordx4 a[64:67], v2, s[8:11], s22 offen offset:0 sc1
  buffer_load_dwordx4 a[68:71], v2, s[8:11], s22 offen offset:1024 sc1
  buffer_load_dwordx4 a[72:75], v2, s[8:11], s22 offen offset:2048 sc1
  buffer_load_dwordx4 a[76:79], v2, s[8:11], s22 offen offset:3072 sc1
  s_add_u32 s22, s21, 20480
  buffer_load_dwordx4 a[80:83], v2, s[8:11], s22 offen offset:0 sc1
  buffer_load_dwordx4 a[84:87], v2, s[8:11], s22 offen offset:1024 sc1
  buffer_load_dwordx4 a[88:91], v2, s[8:11], s22 offen offset:2048 sc1
  buffer_load_dwordx4 a[92:95], v2, s[8:11], s22 offen offset:3072 sc1
  s_add_u32 s22, s21, 24576
  buffer_load_dwordx4 a[96:99], v2, s[8:11], s22 offen offset:0 sc1
  buffer_load_dwordx4 a[100:103], v2, s[8:11], s22 offen offset:1024 sc1
  buffer_load_dwordx4 a[104:107], v2, s[8:11], s22 offen offset:2048 sc1
  buffer_load_dwordx4 a[108:111], v2, s[8:11], s22 offen offset:3072 sc1
  s_add_u32 s22, s21, 28672
  buffer_load_dwordx4 a[112:115], v2, s[8:11], s22 offen offset:0 sc1
  buffer_load_dwordx4 a[116:119], v2, s[8:11], s22 offen offset:1024 sc1
  buffer_load_dwordx4 a[120:123], v2, s[8:11], s22 offen offset:2048 sc1
  buffer_load_dwordx4 a[124:127], v2, s[8:11], s22 offen offset:3072 sc1
  s_add_u32 s22, s21, 32768
  buffer_load_dwordx4 a[128:131], v2, s[8:11], s22 offen offset:0 sc1
  buffer_load_dwordx4 a[132:135], v2, s[8:11], s22 offen offset:1024 sc1
  buffer_load_dwordx4 a[136:139], v2, s[8:11], s22 offen offset:2048 sc1
  buffer_load_dwordx4 a[140:143], v2, s[8:11], s22 offen offset:3072 sc1
  s_add_u32 s22, s21, 36864
  buffer_load_dwordx4 a[144:147], v2, s[8:11], s22 offen offset:0 sc1
  buffer_load_dwordx4 a[148:151], v2, s[8:11], s22 offen offset:1024 sc1
  buffer_load_dwordx4 a[152:155], v2, s[8:11], s22 offen offset:2048 sc1
  buffer_load_dwordx4 a[156:159], v2, s[8:11], s22 offen offset:3072 sc1
  s_add_u32 s22, s21, 40960
  s_waitcnt vmcnt(40)
  buffer_load_dwordx4 a[160:163], v2, s[8:11], s22 offen offset:0 sc1
  buffer_load_dwordx4 a[164:167], v2, s[8:11], s22 offen offset:1024 sc1
  buffer_load_dwordx4 a[168:171], v2, s[8:11], s22 offen offset:2048 sc1
  buffer_load_dwordx4 a[172:175], v2, s[8:11], s22 offen offset:3072 sc1
  s_add_u32 s22, s21, 45056
  buffer_load_dwordx4 a[176:179], v2, s[8:11], s22 offen offset:0 sc1
  buffer_load_dwordx4 a[180:183], v2, s[8:11], s22 offen offset:1024 sc1
  buffer_load_dwordx4 a[184:187], v2, s[8:11], s22 offen offset:2048 sc1
  buffer_load_dwordx4 a[188:191], v2, s[8:11], s22 offen offset:3072 sc1
  s_add_u32 s22, s21, 49152
  buffer_load_dwordx4 a[192:195], v2, s[8:11], s22 offen offset:0 sc1
  buffer_load_dwordx4 a[196:199], v2, s[8:11], s22 offen offset:1024 sc1
  buffer_load_dwordx4 a[200:203], v2, s[8:11], s22 offen offset:2048 sc1
  buffer_load_dwordx4 a[204:207], v2, s[8:11], s22 offen offset:3072 sc1
  s_add_u32 s22, s21, 53248
  buffer_load_dwordx4 a[208:211], v2, s[8:11], s22 offen offset:0 sc1
  buffer_load_dwordx4 a[212:215], v2, s[8:11], s22 offen offset:1024 sc1
  buffer_load_dwordx4 a[216:219], v2, s[8:11], s22 offen offset:2048 sc1
  buffer_load_dwordx4 a[220:223], v2, s[8:11], s22 offen offset:3072 sc1
wg_f_hx:
  s_mov_b32 s101, -1
  s_waitcnt vmcnt(0)
  s_branch wg_f_in
wg_f_loop:
  s_waitcnt vmcnt(11)
wg_f_in:
  s_barrier
  s_add_u32 s30, s19, 2
  s_min_u32 s30, s30, s36
  s_lshr_b32 s24, s30, 1
  s_lshl_b32 s24, s24, 2
  s_and_b32 s25, s30, 1
  s_add_u32 s24, s24, s25
  s_mul_i32 s24, s24, 14336
  s_add_u32 s24, s24, s23
  s_add_u32 m0, s33, s27
  s_nop 0
  buffer_load_dwordx4 v2, s[8:11], s24 offen offset:0 sc1 lds
  buffer_load_dwordx4 v2, s[8:11], s24 offen offset:1024 sc1 lds
  buffer_load_dwordx4 v2, s[8:11], s24 offen offset:2048 sc1 lds
  buffer_load_dwordx4 v2, s[8:11], s24 offen offset:3072 sc1 lds
  s_add_u32 m0, m0, 4096
  s_add_u32 s24, s24, 4096
  buffer_load_dwordx4 v2, s[8:11], s24 offen offset:0 sc1 lds
  buffer_load_dwordx4 v2, s[8:11], s24 offen offset:1024 sc1 lds
  buffer_load_dwordx4 v2, s[8:11], s24 offen offset:2048 sc1 lds
  v_add_u32 v5, s32, v2
  ds_read_b128 v[8:11], v5 offset:0
  ds_read_b128 v[12:15], v5 offset:14336
  ds_read_b128 v[16:19], v5 offset:1024
  ds_read_b128 v[20:23], v5 offset:15360
  ds_read_b128 v[24:27], v5 offset:2048
  ds_read_b128 v[28:31], v5 offset:16384
  ds_read_b128 v[32:35], v5 offset:3072
  s_waitcnt lgkmcnt(6)
  v_mfma_f32_16x16x32_bf16 v[40:43], v[8:11], a[0:3], 0
  v_mfma_f32_16x16x32_bf16 v[44:47], v[8:11], a[56:59], 0
  v_mfma_f32_16x16x32_bf16 v[48:51], v[8:11], a[112:115], 0
  v_mfma_f32_16x16x32_bf16 v[52:55], v[8:11], a[168:171], 0
  ds_read_b128 v[36:39], v5 offset:17408
  s_waitcnt lgkmcnt(6)
  v_mfma_f32_16x16x32_bf16 v[56:59], v[12:15], a[0:3], 0
  v_mfma_f32_16x16x32_bf16 v[60:63], v[12:15], a[56:59], 0
  v_mfma_f32_16x16x32_bf16 v[64:67], v[12:15], a[112:115], 0
  v_mfma_f32_16x16x32_bf16 v[68:71], v[12:15], a[168:171], 0
  ds_read_b128 v[8:11], v5 offset:4096
  s_waitcnt lgkmcnt(6)
  v_mfma_f32_16x16x32_bf16 v[40:43], v[16:19], a[4:7], v[40:43]
  v_mfma_f32_16x16x32_bf16 v[44:47], v[16:19], a[60:63], v[44:47]
  v_mfma_f32_16x16x32_bf16 v[48:51], v[16:19], a[116:119], v[48:51]
  v_mfma_f32_16x16x32_bf16 v[52:55], v[16:19], a[172:175], v[52:55]
  ds_read_b128 v[12:15], v5 offset:18432
  s_waitcnt lgkmcnt(6)
  v_mfma_f32_16x16x32_bf16 v[56:59], v[20:23], a[4:7], v[56:59]
  v_mfma_f32_16x16x32_bf16 v[60:63], v[20:23], a[60:63], v[60:63]
  v_mfma_f32_16x16x32_bf16 v[64:67], v[20:23], a[116:119], v[64:67]
  v_mfma_f32_16x16x32_bf16 v[68:71], v[20:23], a[172:175], v[68:71]
  ds_read_b128 v[16:19], v5 offset:5120
  s_waitcnt lgkmcnt(6)
  v_mfma_f32_16x16x32_bf16 v[40:43], v[24:27], a[8:11], v[40:43]
  v_mfma_f32_16x16x32_bf16 v[44:47], v[24:27], a[64:67], v[44:47]
  v_mfma_f32_16x16x32_bf16 v[48:51], v[24:27], a[120:123], v[48:51]
  v_mfma_f32_16x16x32_bf16 v[52:55], v[24:27], a[176:179], v[52:55]
  ds_read_b128 v[20:23], v5 offset:19456
  s_waitcnt lgkmcnt(6)
  v_mfma_f32_16x16x32_bf16 v[56:59], v[28:31], a[8:11], v[56:59]
  v_mfma_f32_16x16x32_bf16 v[60:63], v[28:31], a[64:67], v[60:63]
  v_mfma_f32_16x16x32_bf16 v[64:67], v[28:31], a[120:123], v[64:67]
  v_mfma_f32_16x16x32_bf16 v[68:71], v[28:31], a[176:179], v[68:71]
  ds_read_b128 v[24:27], v5 offset:6144
  s_waitcnt lgkmcnt(6)
  v_mfma_f32_16x16x32_bf16 v[40:43], v[32:35], a[12:15], v[40:43]
  v_mfma_f32_16x16x32_bf16 v[44:47], v[32:35], a[68:71], v[44:47]
  v_mfma_f32_16x16x32_bf16 v[48:51], v[32:35], a[124:127], v[48:51]
  v_mfma_f32_16x16x32_bf16 v[52:55], v[32:35], a[180:183], v[52:55]
  ds_read_b128 v[28:31], v5 offset:20480
  s_waitcnt lgkmcnt(6)
  v_mfma_f32_16x16x32_bf16 v[56:59], v[36:39], a[12:15], v[56:59]
  v_mfma_f32_16x16x32_bf16 v[60:63], v[36:39], a[68:71], v[60:63]
  v_mfma_f32_16x16x32_bf16 v[64:67], v[36:39], a[124:127], v[64:67]
  v_mfma_f32_16x16x32_bf16 v[68:71], v[36:39], a[180:183], v[68:71]
  ds_read_b128 v[32:35], v5 offset:7168
  s_waitcnt lgkmcnt(6)
  v_mfma_f32_16x16x32_bf16 v[40:43], v[8:11], a[16:19], v[40:43]
  v_mfma_f32_16x16x32_bf16 v[44:47], v[8:11], a[72:75], v[44:47]
  v_mfma_f32_16x16x32_bf16 v[48:51], v[8:11], a[128:131], v[48:51]
  v_mfma_f32_16x16x32_bf16 v[52:55], v[8:11], a[184:187], v[52:55]
  ds_read_b128 v[36:39], v5 offset:21504
  s_waitcnt lgkmcnt(6)
  v_mfma_f32_16x16x32_bf16 v[56:59], v[12:15], a[16:19], v[56:59]
  v_mfma_f32_16x16x32_bf16 v[60:63], v[12:15], a[72:75], v[60:63]
  v_mfma_f32_16x16x32_bf16 v[64:67], v[12:15], a[128:131], v[64:67]
  v_mfma_f32_16x16x32_bf16 v[68:71], v[12:15], a[184:187], v[68:71]
  ds_read_b128 v[8:11], v5 offset:8192
  s_waitcnt lgkmcnt(6)
  v_mfma_f32_16x16x32_bf16 v[40:43], v[16:19], a[20:23], v[40:43]
  v_mfma_f32_16x16x32_bf16 v[44:47], v[16:19], a[76:79], v[44:47]
  v_mfma_f32_16x16x32_bf16 v[48:51], v[16:19], a[132:135], v[48:51]
  v_mfma_f32_16x16x32_bf16 v[52:55], v[16:19], a[188:191], v[52:55]
  ds_read_b128 v[12:15], v5 offset:22528
  s_waitcnt lgkmcnt(6)
  v_mfma_f32_16x16x32_bf16 v[56:59], v[20:23], a[20:23], v[56:59]
  v_mfma_f32_16x16x32_bf16 v[60:63], v[20:23], a[76:79], v[60:63]
  v_mfma_f32_16x16x32_bf16 v[64:67], v[20:23], a[132:135], v[64:67]
  v_mfma_f32_16x16x32_bf16 v[68:71], v[20:23], a[188:191], v[68:71]
  ds_read_b128 v[16:19], v5 offset:9216
  s_waitcnt lgkmcnt(6)
  v_mfma_f32_16x16x32_bf16 v[40:43], v[24:27], a[24:27], v[40:43]
  v_mfma_f32_16x16x32_bf16 v[44:47], v[24:27], a[80:83], v[44:47]
  v_mfma_f32_16x16x32_bf16 v[48:51], v[24:27], a[136:139], v[48:51]
  v_mfma_f32_16x16x32_bf16 v[52:55], v[24:27], a[192:195], v[52:55]
  ds_read_b128 v[20:23], v5 offset:23552
  s_waitcnt lgkmcnt(6)
  v_mfma_f32_16x16x32_bf16 v[56:59], v[28:31], a[24:27], v[56:59]
  v_mfma_f32_16x16x32_bf16 v[60:63], v[28:31], a[80:83], v[60:63]
  v_mfma_f32_16x16x32_bf16 v[64:67], v[28:31], a[136:139], v[64:67]
  v_mfma_f32_16x16x32_bf16 v[68:71], v[28:31], a[192:195], v[68:71]
  ds_read_b128 v[24:27], v5 offset:10240
  s_waitcnt lgkmcnt(6)
  v_mfma_f32_16x16x32_bf16 v[40:43], v[32:35], a[28:31], v[40:43]
  v_mfma_f32_16x16x32_bf16 v[44:47], v[32:35], a[84:87], v[44:47]
  v_mfma_f32_16x16x32_bf16 v[48:51], v[32:35], a[140:143], v[48:51]
  v_mfma_f32_16x16x32_bf16 v[52:55], v[32:35], a[196:199], v[52:55]
  ds_read_b128 v[28:31], v5 offset:24576
  s_waitcnt lgkmcnt(6)
  v_mfma_f32_16x16x32_bf16 v[56:59], v[36:39], a[28:31], v[56:59]
  v_mfma_f32_16x16x32_bf16 v[60:63], v[36:39], a[84:87], v[60:63]
  v_mfma_f32_16x16x32_bf16 v[64:67], v[36:39], a[140:143], v[64:67]
  v_mfma_f32_16x16x32_bf16 v[68:71], v[36:39], a[196:199], v[68:71]
  ds_read_b128 v[32:35], v5 offset:11264
  s_waitcnt lgkmcnt(6)
  v_mfma_f32_16x16x32_bf16 v[40:43], v[8:11], a[32:35], v[40:43]
  v_mfma_f32_16x16x32_bf16 v[44:47], v[8:11], a[88:91], v[44:47]
  v_mfma_f32_16x16x32_bf16 v[48:51], v[8:11], a[144:147], v[48:51]
  v_mfma_f32_16x16x32_bf16 v[52:55], v[8:11], a[200:203], v[52:55]
  ds_read_b128 v[36:39], v5 offset:25600
  s_waitcnt lgkmcnt(6)
  v_mfma_f32_16x16x32_bf16 v[56:59], v[12:15], a[32:35], v[56:59]
  v_mfma_f32_16x16x32_bf16 v[60:63], v[12:15], a[88:91], v[60:63]
  v_mfma_f32_16x16x32_bf16 v[64:67], v[12:15], a[144:147], v[64:67]
  v_mfma_f32_16x16x32_bf16 v[68:71], v[12:15], a[200:203], v[68:71]
  ds_read_b128 v[8:11], v5 offset:12288
  s_waitcnt lgkmcnt(6)
  v_mfma_f32_16x16x32_bf16 v[40:43], v[16:19], a[36:39], v[40:43]
  v_mfma_f32_16x16x32_bf16 v[44:47], v[16:19], a[92:95], v[44:47]
  v_mfma_f32_16x16x32_bf16 v[48:51], v[16:19], a[148:151], v[48:51]
  v_mfma_f32_16x16x32_bf16 v[52:55], v[16:19], a[204:207], v[52:55]
  ds_read_b128 v[12:15], v5 offset:26624
  s_waitcnt lgkmcnt(6)
  v_mfma_f32_16x16x32_bf16 v[56:59], v[20:23], a[36:39], v[56:59]
  v_mfma_f32_16x16x32_bf16 v[60:63], v[20:23], a[92:95], v[60:63]
  v_mfma_f32_16x16x32_bf16 v[64:67], v[20:23], a[148:151], v[64:67]
  v_mfma_f32_16x16x32_bf16 v[68:71], v[20:23], a[204:207], v[68:71]
  ds_read_b128 v[16:19], v5 offset:13312
  s_waitcnt lgkmcnt(6)
  v_mfma_f32_16x16x32_bf16 v[40:43], v[24:27], a[40:43], v[40:43]
  v_mfma_f32_16x16x32_bf16 v[44:47], v[24:27], a[96:99], v[44:47]
  v_mfma_f32_16x16x32_bf16 v[48:51], v[24:27], a[152:155], v[48:51]
  v_mfma_f32_16x16x32_bf16 v[52:55], v[24:27], a[208:211], v[52:55]
  ds_read_b128 v[20:23], v5 offset:27648
  s_waitcnt lgkmcnt(6)
  v_mfma_f32_16x16x32_bf16 v[56:59], v[28:31], a[40:43], v[56:59]
  v_mfma_f32_16x16x32_bf16 v[60:63], v[28:31], a[96:99], v[60:63]
  v_mfma_f32_16x16x32_bf16 v[64:67], v[28:31], a[152:155], v[64:67]
  v_mfma_f32_16x16x32_bf16 v[68:71], v[28:31], a[208:211], v[68:71]
  s_waitcnt lgkmcnt(5)
  v_mfma_f32_16x16x32_bf16 v[40:43], v[32:35], a[44:47], v[40:43]
  v_mfma_f32_16x16x32_bf16 v[44:47], v[32:35], a[100:103], v[44:47]
  v_mfma_f32_16x16x32_bf16 v[48:51], v[32:35], a[156:159], v[48:51]
  v_mfma_f32_16x16x32_bf16 v[52:55], v[32:35], a[212:215], v[52:55]
  s_waitcnt lgkmcnt(4)
  v_mfma_f32_16x16x32_bf16 v[56:59], v[36:39], a[44:47], v[56:59]
  v_mfma_f32_16x16x32_bf16 v[60:63], v[36:39], a[100:103], v[60:63]
  v_mfma_f32_16x16x32_bf16 v[64:67], v[36:39], a[156:159], v[64:67]
  v_mfma_f32_16x16x32_bf16 v[68:71], v[36:39], a[212:215], v[68:71]
  s_waitcnt lgkmcnt(3)
  v_mfma_f32_16x16x32_bf16 v[40:43], v[8:11], a[48:51], v[40:43]
  v_mfma_f32_16x16x32_bf16 v[44:47], v[8:11], a[104:107], v[44:47]
  v_mfma_f32_16x16x32_bf16 v[48:51], v[8:11], a[160:163], v[48:51]
  v_mfma_f32_16x16x32_bf16 v[52:55], v[8:11], a[216:219], v[52:55]
  s_waitcnt lgkmcnt(2)
  v_mfma_f32_16x16x32_bf16 v[56:59], v[12:15], a[48:51], v[56:59]
  v_mfma_f32_16x16x32_bf16 v[60:63], v[12:15], a[104:107], v[60:63]
  v_mfma_f32_16x16x32_bf16 v[64:67], v[12:15], a[160:163], v[64:67]
  v_mfma_f32_16x16x32_bf16 v[68:71], v[12:15], a[216:219], v[68:71]
  s_waitcnt lgkmcnt(1)
  v_mfma_f32_16x16x32_bf16 v[40:43], v[16:19], a[52:55], v[40:43]
  v_mfma_f32_16x16x32_bf16 v[44:47], v[16:19], a[108:111], v[44:47]
  v_mfma_f32_16x16x32_bf16 v[48:51], v[16:19], a[164:167], v[48:51]
  v_mfma_f32_16x16x32_bf16 v[52:55], v[16:19], a[220:223], v[52:55]
  s_waitcnt lgkmcnt(0)
  v_mfma_f32_16x16x32_bf16 v[56:59], v[20:23], a[52:55], v[56:59]
  v_mfma_f32_16x16x32_bf16 v[60:63], v[20:23], a[108:111], v[60:63]
  v_mfma_f32_16x16x32_bf16 v[64:67], v[20:23], a[164:167], v[64:67]
  v_mfma_f32_16x16x32_bf16 v[68:71], v[20:23], a[220:223], v[68:71]
  s_lshl_b32 s24, s19, 10
  s_add_u32 s24, s24, s29
  v_cvt_pk_bf16_f32 v72, v40, v41
  v_cvt_pk_bf16_f32 v73, v42, v43
  v_cvt_pk_bf16_f32 v74, v56, v57
  v_cvt_pk_bf16_f32 v75, v58, v59
  s_add_u32 s25, s24, 0
  buffer_store_dwordx4 v[72:75], v2, s[8:11], s25 offen sc1
  v_cvt_pk_bf16_f32 v76, v44, v45
  v_cvt_pk_bf16_f32 v77, v46, v47
  v_cvt_pk_bf16_f32 v78, v60, v61
  v_cvt_pk_bf16_f32 v79, v62, v63
  s_add_u32 s25, s24, 14336
  buffer_store_dwordx4 v[76:79], v2, s[8:11], s25 offen sc1
  v_cvt_pk_bf16_f32 v80, v48, v49
  v_cvt_pk_bf16_f32 v81, v50, v51
  v_cvt_pk_bf16_f32 v82, v64, v65
  v_cvt_pk_bf16_f32 v83, v66, v67
  s_add_u32 s25, s24, 458752
  buffer_store_dwordx4 v[80:83], v2, s[8:11], s25 offen sc1
  v_cvt_pk_bf16_f32 v84, v52, v53
  v_cvt_pk_bf16_f32 v85, v54, v55
  v_cvt_pk_bf16_f32 v86, v68, v69
  v_cvt_pk_bf16_f32 v87, v70, v71
  s_add_u32 s25, s24, 473088
  buffer_store_dwordx4 v[84:87], v2, s[8:11], s25 offen sc1
  s_mov_b32 s33, s32
  s_add_u32 s32, s32, 28672
  s_cmp_eq_u32 s32, 86016
  s_cselect_b32 s32, 0, s32
  s_add_u32 s19, s19, 1
  s_cmp_lt_u32 s19, s35
  s_cbranch_scc1 wg_f_loop
  s_branch wg_done
wg_vo:
  s_sub_u32 s29, s17, 16
  s_mul_i32 s29, s29, 28672
  s_mul_i32 s24, s28, 458752
  s_add_u32 s29, s29, s24
  s_add_u32 s29, s29, 42205184
  v_lshlrev_b32 v6, 4, v3
  v_mul_u32_u24 v7, 12, v3
  v_add_u32 v7, 48, v7
  s_mov_b32 s31, 0
  s_lshl_b32 s24, s34, 1
  s_mul_i32 s24, s24, 14336
  s_add_u32 s24, s24, s23
  s_add_u32 m0, s31, s27
  s_nop 0
  buffer_load_dwordx4 v2, s[8:11], s24 offen offset:0 sc1 lds
  buffer_load_dwordx4 v2, s[8:11], s24 offen offset:1024 sc1 lds
  buffer_load_dwordx4 v2, s[8:11], s24 offen offset:2048 sc1 lds
  buffer_load_dwordx4 v2, s[8:11], s24 offen offset:3072 sc1 lds
  s_add_u32 m0, m0, 4096
  s_add_u32 s24, s24, 4096
  buffer_load_dwordx4 v2, s[8:11], s24 offen offset:0 sc1 lds
  buffer_load_dwordx4 v2, s[8:11], s24 offen offset:1024 sc1 lds
  buffer_load_dwordx4 v2, s[8:11], s24 offen offset:2048 sc1 lds
  s_sub_u32 s36, s35, 1
  s_add_u32 s30, s34, 1
  s_min_u32 s30, s30, s36
  s_mov_b32 s31, 28672
  s_lshl_b32 s24, s30, 1
  s_mul_i32 s24, s24, 14336
  s_add_u32 s24, s24, s23
  s_add_u32 m0, s31, s27
  s_nop 0
  buffer_load_dwordx4 v2, s[8:11], s24 offen offset:0 sc1 lds
  buffer_load_dwordx4 v2, s[8:11], s24 offen offset:1024 sc1 lds
  buffer_load_dwordx4 v2, s[8:11], s24 offen offset:2048 sc1 lds
  buffer_load_dwordx4 v2, s[8:11], s24 offen offset:3072 sc1 lds
  s_add_u32 m0, m0, 4096
  s_add_u32 s24, s24, 4096
  buffer_load_dwordx4 v2, s[8:11], s24 offen offset:0 sc1 lds
  buffer_load_dwordx4 v2, s[8:11], s24 offen offset:1024 sc1 lds
  buffer_load_dwordx4 v2, s[8:11], s24 offen offset:2048 sc1 lds
  s_mov_b32 s19, s34
  s_mov_b32 s32, 0
  s_mov_b32 s33, 57344
  s_cmp_eq_u32 s18, s101
  s_cbranch_scc1 wg_vo_hx
  s_add_u32 s22, s21, 0
  buffer_load_dwordx4 a[0:3], v2, s[8:11], s22 offen offset:0 sc1
  buffer_load_dwordx4 a[4:7], v2, s[8:11], s22 offen offset:1024 sc1
  buffer_load_dwordx4 a[8:11], v2, s[8:11], s22 offen offset:2048 sc1
  buffer_load_dwordx4 a[12:15], v2, s[8:11], s22 offen offset:3072 sc1
  s_add_u32 s22, s21, 4096
  buffer_load_dwordx4 a[16:19], v2, s[8:11], s22 offen offset:0 sc1
  buffer_load_dwordx4 a[20:23], v2, s[8:11], s22 offen offset:1024 sc1
  buffer_load_dwordx4 a[24:27], v2, s[8:11], s22 offen offset:2048 sc1
  buffer_load_dwordx4 a[28:31], v2, s[8:11], s22 offen offset:3072 sc1
  s_add_u32 s22, s21, 8192
  buffer_load_dwordx4 a[32:35], v2, s[8:11], s22 offen offset:0 sc1
  buffer_load_dwordx4 a[36:39], v2, s[8:11], s22 offen offset:1024 sc1
  buffer_load_dwordx4 a[40:43], v2, s[8:11], s22 offen offset:2048 sc1
  buffer_load_dwordx4 a[44:47], v2, s[8:11], s22 offen offset:3072 sc1
  s_add_u32 s22, s21, 12288
  buffer_load_dwordx4 a[48:51], v2, s[8:11], s22 offen offset:0 sc1
  buffer_load_dwordx4 a[52:55], v2, s[8:11], s22 offen offset:1024 sc1
  buffer_load_dwordx4 a[56:59], v2, s[8:11], s22 offen offset:2048 sc1
  buffer_load_dwordx4 a[60:63], v2, s[8:11], s22 offen offset:3072 sc1
  s_add_u32 s22, s21, 16384
  buffer_load_dwordx4 a[64:67], v2, s[8:11], s22 offen offset:0 sc1
  buffer_load_dwordx4 a[68:71], v2, s[8:11], s22 offen offset:1024 sc1
  buffer_load_dwordx4 a[72:75], v2, s[8:11], s22 offen offset:2048 sc1
  buffer_load_dwordx4 a[76:79], v2, s[8:11], s22 offen offset:3072 sc1
  s_add_u32 s22, s21, 20480
  buffer_load_dwordx4 a[80:83], v2, s[8:11], s22 offen offset:0 sc1
  buffer_load_dwordx4 a[84:87], v2, s[8:11], s22 offen offset:1024 sc1
  buffer_load_dwordx4 a[88:91], v2, s[8:11], s22 offen offset:2048 sc1
  buffer_load_dwordx4 a[92:95], v2, s[8:11], s22 offen offset:3072 sc1
  s_add_u32 s22, s21, 24576
  buffer_load_dwordx4 a[96:99], v2, s[8:11], s22 offen offset:0 sc1
  buffer_load_dwordx4 a[100:103], v2, s[8:11], s22 offen offset:1024 sc1
  buffer_load_dwordx4 a[104:107], v2, s[8:11], s22 offen offset:2048 sc1
  buffer_load_dwordx4 a[108:111], v2, s[8:11], s22 offen offset:3072 sc1
  s_add_u32 s22, s21, 28672
  buffer_load_dwordx4 a[112:115], v2, s[8:11], s22 offen offset:0 sc1
  buffer_load_dwordx4 a[116:119], v2, s[8:11], s22 offen offset:1024 sc1
  buffer_load_dwordx4 a[120:123], v2, s[8:11], s22 offen offset:2048 sc1
  buffer_load_dwordx4 a[124:127], v2, s[8:11], s22 offen offset:3072 sc1
  s_add_u32 s22, s21, 32768
  buffer_load_dwordx4 a[128:131], v2, s[8:11], s22 offen offset:0 sc1
  buffer_load_dwordx4 a[132:135], v2, s[8:11], s22 offen offset:1024 sc1
  buffer_load_dwordx4 a[136:139], v2, s[8:11], s22 offen offset:2048 sc1
  buffer_load_dwordx4 a[140:143], v2, s[8:11], s22 offen offset:3072 sc1
  s_add_u32 s22, s21, 36864
  buffer_load_dwordx4 a[144:147], v2, s[8:11], s22 offen offset:0 sc1
  buffer_load_dwordx4 a[148:151], v2, s[8:11], s22 offen offset:1024 sc1
  buffer_load_dwordx4 a[152:155], v2, s[8:11], s22 offen offset:2048 sc1
  buffer_load_dwordx4 a[156:159], v2, s[8:11], s22 offen offset:3072 sc1
  s_add_u32 s22, s21, 40960
  s_waitcnt vmcnt(40)
  buffer_load_dwordx4 a[160:163], v2, s[8:11], s22 offen offset:0 sc1
  buffer_load_dwordx4 a[164:167], v2, s[8:11], s22 offen offset:1024 sc1
  buffer_load_dwordx4 a[168:171], v2, s[8:11], s22 offen offset:2048 sc1
  buffer_load_dwordx4 a[172:175], v2, s[8:11], s22 offen offset:3072 sc1
  s_add_u32 s22, s21, 45056
  buffer_load_dwordx4 a[176:179], v2, s[8:11], s22 offen offset:0 sc1
  buffer_load_dwordx4 a[180:183], v2, s[8:11], s22 offen offset:1024 sc1
  buffer_load_dwordx4 a[184:187], v2, s[8:11], s22 offen offset:2048 sc1
  buffer_load_dwordx4 a[188:191], v2, s[8:11], s22 offen offset:3072 sc1
  s_add_u32 s22, s21, 49152
  buffer_load_dwordx4 a[192:195], v2, s[8:11], s22 offen offset:0 sc1
  buffer_load_dwordx4 a[196:199], v2, s[8:11], s22 offen offset:1024 sc1
  buffer_load_dwordx4 a[200:203], v2, s[8:11], s22 offen offset:2048 sc1
  buffer_load_dwordx4 a[204:207], v2, s[8:11], s22 offen offset:3072 sc1
  s_add_u32 s22, s21, 53248
  buffer_load_dwordx4 a[208:211], v2, s[8:11], s22 offen offset:0 sc1
  buffer_load_dwordx4 a[212:215], v2, s[8:11], s22 offen offset:1024 sc1
  buffer_load_dwordx4 a[216:219], v2, s[8:11], s22 offen offset:2048 sc1
  buffer_load_dwordx4 a[220:223], v2, s[8:11], s22 offen offset:3072 sc1
wg_vo_hx:
  s_mov_b32 s101, -1
  s_waitcnt vmcnt(0)
  s_branch wg_vo_in
wg_vo_loop:
  s_waitcnt vmcnt(11)
wg_vo_in:
  s_barrier
  s_add_u32 s30, s19, 2
  s_min_u32 s30, s30, s36
  s_lshl_b32 s24, s30, 1
  s_mul_i32 s24, s24, 14336
  s_add_u32 s24, s24, s23
  s_add_u32 m0, s33, s27
  s_nop 0
  buffer_load_dwordx4 v2, s[8:11], s24 offen offset:0 sc1 lds
  buffer_load_dwordx4 v2, s[8:11], s24 offen offset:1024 sc1 lds
  buffer_load_dwordx4 v2, s[8:11], s24 offen offset:2048 sc1 lds
  buffer_load_dwordx4 v2, s[8:11], s24 offen offset:3072 sc1 lds
  s_add_u32 m0, m0, 4096
  s_add_u32 s24, s24, 4096
  buffer_load_dwordx4 v2, s[8:11], s24 offen offset:0 sc1 lds
  buffer_load_dwordx4 v2, s[8:11], s24 offen offset:1024 sc1 lds
  buffer_load_dwordx4 v2, s[8:11], s24 offen offset:2048 sc1 lds
  v_add_u32 v5, s32, v2
  ds_read_b128 v[8:11], v5 offset:0
  ds_read_b128 v[12:15], v5 offset:14336
  ds_read_b128 v[16:19], v5 offset:1024
  ds_read_b128 v[20:23], v5 offset:15360
  ds_read_b128 v[24:27], v5 offset:2048
  ds_read_b128 v[28:31], v5 offset:16384
  ds_read_b128 v[32:35], v5 offset:3072
  s_waitcnt lgkmcnt(6)
  v_mfma_f32_16x16x32_bf16 v[40:43], a[0:3], v[8:11], 0
  v_mfma_f32_16x16x32_bf16 v[44:47], a[56:59], v[8:11], 0
  v_mfma_f32_16x16x32_bf16 v[48:51], a[112:115], v[8:11], 0
  v_mfma_f32_16x16x32_bf16 v[52:55], a[168:171], v[8:11], 0
  ds_read_b128 v[36:39], v5 offset:17408
  s_waitcnt lgkmcnt(6)
  v_mfma_f32_16x16x32_bf16 v[56:59], a[0:3], v[12:15], 0
  v_mfma_f32_16x16x32_bf16 v[60:63], a[56:59], v[12:15], 0
  v_mfma_f32_16x16x32_bf16 v[64:67], a[112:115], v[12:15], 0
  v_mfma_f32_16x16x32_bf16 v[68:71], a[168:171], v[12:15], 0
  ds_read_b128 v[8:11], v5 offset:4096
  s_waitcnt lgkmcnt(6)
  v_mfma_f32_16x16x32_bf16 v[40:43], a[4:7], v[16:19], v[40:43]
  v_mfma_f32_16x16x32_bf16 v[44:47], a[60:63], v[16:19], v[44:47]
  v_mfma_f32_16x16x32_bf16 v[48:51], a[116:119], v[16:19], v[48:51]
  v_mfma_f32_16x16x32_bf16 v[52:55], a[172:175], v[16:19], v[52:55]
  ds_read_b128 v[12:15], v5 offset:18432
  s_waitcnt lgkmcnt(6)
  v_mfma_f32_16x16x32_bf16 v[56:59], a[4:7], v[20:23], v[56:59]
  v_mfma_f32_16x16x32_bf16 v[60:63], a[60:63], v[20:23], v[60:63]
  v_mfma_f32_16x16x32_bf16 v[64:67], a[116:119], v[20:23], v[64:67]
  v_mfma_f32_16x16x32_bf16 v[68:71], a[172:175], v[20:23], v[68:71]
  ds_read_b128 v[16:19], v5 offset:5120
  s_waitcnt lgkmcnt(6)
  v_mfma_f32_16x16x32_bf16 v[40:43], a[8:11], v[24:27], v[40:43]
  v_mfma_f32_16x16x32_bf16 v[44:47], a[64:67], v[24:27], v[44:47]
  v_mfma_f32_16x16x32_bf16 v[48:51], a[120:123], v[24:27], v[48:51]
  v_mfma_f32_16x16x32_bf16 v[52:55], a[176:179], v[24:27], v[52:55]
  ds_read_b128 v[20:23], v5 offset:19456
  s_waitcnt lgkmcnt(6)
  v_mfma_f32_16x16x32_bf16 v[56:59], a[8:11], v[28:31], v[56:59]
  v_mfma_f32_16x16x32_bf16 v[60:63], a[64:67], v[28:31], v[60:63]
  v_mfma_f32_16x16x32_bf16 v[64:67], a[120:123], v[28:31], v[64:67]
  v_mfma_f32_16x16x32_bf16 v[68:71], a[176:179], v[28:31], v[68:71]
  ds_read_b128 v[24:27], v5 offset:6144
  s_waitcnt lgkmcnt(6)
  v_mfma_f32_16x16x32_bf16 v[40:43], a[12:15], v[32:35], v[40:43]
  v_mfma_f32_16x16x32_bf16 v[44:47], a[68:71], v[32:35], v[44:47]
  v_mfma_f32_16x16x32_bf16 v[48:51], a[124:127], v[32:35], v[48:51]
  v_mfma_f32_16x16x32_bf16 v[52:55], a[180:183], v[32:35], v[52:55]
  ds_read_b128 v[28:31], v5 offset:20480
  s_waitcnt lgkmcnt(6)
  v_mfma_f32_16x16x32_bf16 v[56:59], a[12:15], v[36:39], v[56:59]
  v_mfma_f32_16x16x32_bf16 v[60:63], a[68:71], v[36:39], v[60:63]
  v_mfma_f32_16x16x32_bf16 v[64:67], a[124:127], v[36:39], v[64:67]
  v_mfma_f32_16x16x32_bf16 v[68:71], a[180:183], v[36:39], v[68:71]
  ds_read_b128 v[32:35], v5 offset:7168
  s_waitcnt lgkmcnt(6)
  v_mfma_f32_16x16x32_bf16 v[40:43], a[16:19], v[8:11], v[40:43]
  v_mfma_f32_16x16x32_bf16 v[44:47], a[72:75], v[8:11], v[44:47]
  v_mfma_f32_16x16x32_bf16 v[48:51], a[128:131], v[8:11], v[48:51]
  v_mfma_f32_16x16x32_bf16 v[52:55], a[184:187], v[8:11], v[52:55]
  ds_read_b128 v[36:39], v5 offset:21504
  s_waitcnt lgkmcnt(6)
  v_mfma_f32_16x16x32_bf16 v[56:59], a[16:19], v[12:15], v[56:59]
  v_mfma_f32_16x16x32_bf16 v[60:63], a[72:75], v[12:15], v[60:63]
  v_mfma_f32_16x16x32_bf16 v[64:67], a[128:131], v[12:15], v[64:67]
  v_mfma_f32_16x16x32_bf16 v[68:71], a[184:187], v[12:15], v[68:71]
  ds_read_b128 v[8:11], v5 offset:8192
  s_waitcnt lgkmcnt(6)
  v_mfma_f32_16x16x32_bf16 v[40:43], a[20:23], v[16:19], v[40:43]
  v_mfma_f32_16x16x32_bf16 v[44:47], a[76:79], v[16:19], v[44:47]
  v_mfma_f32_16x16x32_bf16 v[48:51], a[132:135], v[16:19], v[48:51]
  v_mfma_f32_16x16x32_bf16 v[52:55], a[188:191], v[16:19], v[52:55]
  ds_read_b128 v[12:15], v5 offset:22528
  s_waitcnt lgkmcnt(6)
  v_mfma_f32_16x16x32_bf16 v[56:59], a[20:23], v[20:23], v[56:59]
  v_mfma_f32_16x16x32_bf16 v[60:63], a[76:79], v[20:23], v[60:63]
  v_mfma_f32_16x16x32_bf16 v[64:67], a[132:135], v[20:23], v[64:67]
  v_mfma_f32_16x16x32_bf16 v[68:71], a[188:191], v[20:23], v[68:71]
  ds_read_b128 v[16:19], v5 offset:9216
  s_waitcnt lgkmcnt(6)
  v_mfma_f32_16x16x32_bf16 v[40:43], a[24:27], v[24:27], v[40:43]
  v_mfma_f32_16x16x32_bf16 v[44:47], a[80:83], v[24:27], v[44:47]
  v_mfma_f32_16x16x32_bf16 v[48:51], a[136:139], v[24:27], v[48:51]
  v_mfma_f32_16x16x32_bf16 v[52:55], a[192:195], v[24:27], v[52:55]
  ds_read_b128 v[20:23], v5 offset:23552
  s_waitcnt lgkmcnt(6)
  v_mfma_f32_16x16x32_bf16 v[56:59], a[24:27], v[28:31], v[56:59]
  v_mfma_f32_16x16x32_bf16 v[60:63], a[80:83], v[28:31], v[60:63]
  v_mfma_f32_16x16x32_bf16 v[64:67], a[136:139], v[28:31], v[64:67]
  v_mfma_f32_16x16x32_bf16 v[68:71], a[192:195], v[28:31], v[68:71]
  ds_read_b128 v[24:27], v5 offset:10240
  s_waitcnt lgkmcnt(6)
  v_mfma_f32_16x16x32_bf16 v[40:43], a[28:31], v[32:35], v[40:43]
  v_mfma_f32_16x16x32_bf16 v[44:47], a[84:87], v[32:35], v[44:47]
  v_mfma_f32_16x16x32_bf16 v[48:51], a[140:143], v[32:35], v[48:51]
  v_mfma_f32_16x16x32_bf16 v[52:55], a[196:199], v[32:35], v[52:55]
  ds_read_b128 v[28:31], v5 offset:24576
  s_waitcnt lgkmcnt(6)
  v_mfma_f32_16x16x32_bf16 v[56:59], a[28:31], v[36:39], v[56:59]
  v_mfma_f32_16x16x32_bf16 v[60:63], a[84:87], v[36:39], v[60:63]
  v_mfma_f32_16x16x32_bf16 v[64:67], a[140:143], v[36:39], v[64:67]
  v_mfma_f32_16x16x32_bf16 v[68:71], a[196:199], v[36:39], v[68:71]
  ds_read_b128 v[32:35], v5 offset:11264
  s_waitcnt lgkmcnt(6)
  v_mfma_f32_16x16x32_bf16 v[40:43], a[32:35], v[8:11], v[40:43]
  v_mfma_f32_16x16x32_bf16 v[44:47], a[88:91], v[8:11], v[44:47]
  v_mfma_f32_16x16x32_bf16 v[48:51], a[144:147], v[8:11], v[48:51]
  v_mfma_f32_16x16x32_bf16 v[52:55], a[200:203], v[8:11], v[52:55]
  ds_read_b128 v[36:39], v5 offset:25600
  s_waitcnt lgkmcnt(6)
  v_mfma_f32_16x16x32_bf16 v[56:59], a[32:35], v[12:15], v[56:59]
  v_mfma_f32_16x16x32_bf16 v[60:63], a[88:91], v[12:15], v[60:63]
  v_mfma_f32_16x16x32_bf16 v[64:67], a[144:147], v[12:15], v[64:67]
  v_mfma_f32_16x16x32_bf16 v[68:71], a[200:203], v[12:15], v[68:71]
  ds_read_b128 v[8:11], v5 offset:12288
  s_waitcnt lgkmcnt(6)
  v_mfma_f32_16x16x32_bf16 v[40:43], a[36:39], v[16:19], v[40:43]
  v_mfma_f32_16x16x32_bf16 v[44:47], a[92:95], v[16:19], v[44:47]
  v_mfma_f32_16x16x32_bf16 v[48:51], a[148:151], v[16:19], v[48:51]
  v_mfma_f32_16x16x32_bf16 v[52:55], a[204:207], v[16:19], v[52:55]
  ds_read_b128 v[12:15], v5 offset:26624
  s_waitcnt lgkmcnt(6)
  v_mfma_f32_16x16x32_bf16 v[56:59], a[36:39], v[20:23], v[56:59]
  v_mfma_f32_16x16x32_bf16 v[60:63], a[92:95], v[20:23], v[60:63]
  v_mfma_f32_16x16x32_bf16 v[64:67], a[148:151], v[20:23], v[64:67]
  v_mfma_f32_16x16x32_bf16 v[68:71], a[204:207], v[20:23], v[68:71]
  ds_read_b128 v[16:19], v5 offset:13312
  s_waitcnt lgkmcnt(6)
  v_mfma_f32_16x16x32_bf16 v[40:43], a[40:43], v[24:27], v[40:43]
  v_mfma_f32_16x16x32_bf16 v[44:47], a[96:99], v[24:27], v[44:47]
  v_mfma_f32_16x16x32_bf16 v[48:51], a[152:155], v[24:27], v[48:51]
  v_mfma_f32_16x16x32_bf16 v[52:55], a[208:211], v[24:27], v[52:55]
  ds_read_b128 v[20:23], v5 offset:27648
  s_waitcnt lgkmcnt(6)
  v_mfma_f32_16x16x32_bf16 v[56:59], a[40:43], v[28:31], v[56:59]
  v_mfma_f32_16x16x32_bf16 v[60:63], a[96:99], v[28:31], v[60:63]
  v_mfma_f32_16x16x32_bf16 v[64:67], a[152:155], v[28:31], v[64:67]
  v_mfma_f32_16x16x32_bf16 v[68:71], a[208:211], v[28:31], v[68:71]
  s_waitcnt lgkmcnt(5)
  v_mfma_f32_16x16x32_bf16 v[40:43], a[44:47], v[32:35], v[40:43]
  v_mfma_f32_16x16x32_bf16 v[44:47], a[100:103], v[32:35], v[44:47]
  v_mfma_f32_16x16x32_bf16 v[48:51], a[156:159], v[32:35], v[48:51]
  v_mfma_f32_16x16x32_bf16 v[52:55], a[212:215], v[32:35], v[52:55]
  s_waitcnt lgkmcnt(4)
  v_mfma_f32_16x16x32_bf16 v[56:59], a[44:47], v[36:39], v[56:59]
  v_mfma_f32_16x16x32_bf16 v[60:63], a[100:103], v[36:39], v[60:63]
  v_mfma_f32_16x16x32_bf16 v[64:67], a[156:159], v[36:39], v[64:67]
  v_mfma_f32_16x16x32_bf16 v[68:71], a[212:215], v[36:39], v[68:71]
  s_waitcnt lgkmcnt(3)
  v_mfma_f32_16x16x32_bf16 v[40:43], a[48:51], v[8:11], v[40:43]
  v_mfma_f32_16x16x32_bf16 v[44:47], a[104:107], v[8:11], v[44:47]
  v_mfma_f32_16x16x32_bf16 v[48:51], a[160:163], v[8:11], v[48:51]
  v_mfma_f32_16x16x32_bf16 v[52:55], a[216:219], v[8:11], v[52:55]
  s_waitcnt lgkmcnt(2)
  v_mfma_f32_16x16x32_bf16 v[56:59], a[48:51], v[12:15], v[56:59]
  v_mfma_f32_16x16x32_bf16 v[60:63], a[104:107], v[12:15], v[60:63]
  v_mfma_f32_16x16x32_bf16 v[64:67], a[160:163], v[12:15], v[64:67]
  v_mfma_f32_16x16x32_bf16 v[68:71], a[216:219], v[12:15], v[68:71]
  s_waitcnt lgkmcnt(1)
  v_mfma_f32_16x16x32_bf16 v[40:43], a[52:55], v[16:19], v[40:43]
  v_mfma_f32_16x16x32_bf16 v[44:47], a[108:111], v[16:19], v[44:47]
  v_mfma_f32_16x16x32_bf16 v[48:51], a[164:167], v[16:19], v[48:51]
  v_mfma_f32_16x16x32_bf16 v[52:55], a[220:223], v[16:19], v[52:55]
  s_waitcnt lgkmcnt(0)
  v_mfma_f32_16x16x32_bf16 v[56:59], a[52:55], v[20:23], v[56:59]
  v_mfma_f32_16x16x32_bf16 v[60:63], a[108:111], v[20:23], v[60:63]
  v_mfma_f32_16x16x32_bf16 v[64:67], a[164:167], v[20:23], v[64:67]
  v_mfma_f32_16x16x32_bf16 v[68:71], a[220:223], v[20:23], v[68:71]
  s_add_u32 s25, s29, 458752
  s_lshl_b32 s24, s19, 5
  s_add_u32 s24, s24, 0
  v_add_u32 v88, s24, v4
  v_mul_u32_u24 v89, 2341, v88
  v_lshrrev_b32 v89, 16, v89
  v_mul_u32_u24 v92, 28, v89
  v_sub_u32 v92, v88, v92
  v_cmp_gt_u32 vcc, 16, v92
  v_mul_u32_u24 v89, 84, v89
  s_nop 0
  v_cndmask_b32 v92, v7, v6, vcc
  v_add3_u32 v88, v88, v89, v92
  v_lshlrev_b32 v90, 4, v88
  v_cvt_pk_bf16_f32 v72, v40, v44
  v_cvt_pk_bf16_f32 v73, v41, v45
  v_cvt_pk_bf16_f32 v74, v42, v46
  v_cvt_pk_bf16_f32 v75, v43, v47
  buffer_store_dwordx4 v[72:75], v90, s[8:11], s29 offen sc1
  v_cvt_pk_bf16_f32 v76, v48, v52
  v_cvt_pk_bf16_f32 v77, v49, v53
  v_cvt_pk_bf16_f32 v78, v50, v54
  v_cvt_pk_bf16_f32 v79, v51, v55
  buffer_store_dwordx4 v[76:79], v90, s[8:11], s25 offen sc1
  s_lshl_b32 s24, s19, 5
  s_add_u32 s24, s24, 16
  v_add_u32 v88, s24, v4
  v_mul_u32_u24 v89, 2341, v88
  v_lshrrev_b32 v89, 16, v89
  v_mul_u32_u24 v92, 28, v89
  v_sub_u32 v92, v88, v92
  v_cmp_gt_u32 vcc, 16, v92
  v_mul_u32_u24 v89, 84, v89
  s_nop 0
  v_cndmask_b32 v92, v7, v6, vcc
  v_add3_u32 v88, v88, v89, v92
  v_lshlrev_b32 v91, 4, v88
  v_cvt_pk_bf16_f32 v80, v56, v60
  v_cvt_pk_bf16_f32 v81, v57, v61
  v_cvt_pk_bf16_f32 v82, v58, v62
  v_cvt_pk_bf16_f32 v83, v59, v63
  buffer_store_dwordx4 v[80:83], v91, s[8:11], s29 offen sc1
  v_cvt_pk_bf16_f32 v84, v64, v68
  v_cvt_pk_bf16_f32 v85, v65, v69
  v_cvt_pk_bf16_f32 v86, v66, v70
  v_cvt_pk_bf16_f32 v87, v67, v71
  buffer_store_dwordx4 v[84:87], v91, s[8:11], s25 offen sc1
  s_mov_b32 s33, s32
  s_add_u32 s32, s32, 28672
  s_cmp_eq_u32 s32, 86016
  s_cselect_b32 s32, 0, s32
  s_add_u32 s19, s19, 1
  s_cmp_lt_u32 s19, s35
  s_cbranch_scc1 wg_vo_loop
  s_branch wg_done
wg_done:
  s_lshl_b32 s20, s18, 4
  s_and_b32 s21, s17, 15
  s_add_u32 s20, s20, s21
  s_lshl_b32 s20, s20, 7
  s_cmp_lt_u32 s17, 16
  s_cselect_b32 s21, 16384, 0
  s_add_u32 s20, s20, s21
  s_add_u32 s20, s20, 88461312
  s_sub_u32 s21, s35, s34
  s_lshl_b32 s21, s21, 2
  v_mov_b32 v5, s21
  v_mov_b32 v6, 0
  s_waitcnt vmcnt(0)
  s_barrier
  s_cmp_lg_u32 s16, 0
  s_cbranch_scc1 wg_sg
  s_mov_b64 exec, 1
  buffer_atomic_add v5, v6, s[8:11], s20 offen
  s_mov_b64 exec, -1
wg_sg:
  s_branch wk_loop
wk_srv:
  s_and_b32 s18, s3, 15
  s_lshr_b32 s19, s3, 4
  s_and_b32 s19, s19, 1
  s_mul_i32 s20, s18, 401408
  s_mul_i32 s21, s16, 100352
  s_add_u32 s20, s20, s21
  s_add_u32 s20, s20, 6422528
  s_add_u32 s22, s20, 0
  buffer_load_dwordx4 a[0:3], v2, s[8:11], s22 offen offset:0 sc1
  buffer_load_dwordx4 a[4:7], v2, s[8:11], s22 offen offset:1024 sc1
  buffer_load_dwordx4 a[8:11], v2, s[8:11], s22 offen offset:2048 sc1
  buffer_load_dwordx4 a[12:15], v2, s[8:11], s22 offen offset:3072 sc1
  s_add_u32 s22, s20, 4096
  buffer_load_dwordx4 a[16:19], v2, s[8:11], s22 offen offset:0 sc1
  buffer_load_dwordx4 a[20:23], v2, s[8:11], s22 offen offset:1024 sc1
  buffer_load_dwordx4 a[24:27], v2, s[8:11], s22 offen offset:2048 sc1
  buffer_load_dwordx4 a[28:31], v2, s[8:11], s22 offen offset:3072 sc1
  s_add_u32 s22, s20, 8192
  buffer_load_dwordx4 a[32:35], v2, s[8:11], s22 offen offset:0 sc1
  buffer_load_dwordx4 a[36:39], v2, s[8:11], s22 offen offset:1024 sc1
  buffer_load_dwordx4 a[40:43], v2, s[8:11], s22 offen offset:2048 sc1
  buffer_load_dwordx4 a[44:47], v2, s[8:11], s22 offen offset:3072 sc1
  s_add_u32 s22, s20, 12288
  buffer_load_dwordx4 a[48:51], v2, s[8:11], s22 offen offset:0 sc1
  buffer_load_dwordx4 a[52:55], v2, s[8:11], s22 offen offset:1024 sc1
  buffer_load_dwordx4 a[56:59], v2, s[8:11], s22 offen offset:2048 sc1
  buffer_load_dwordx4 a[60:63], v2, s[8:11], s22 offen offset:3072 sc1
  s_add_u32 s22, s20, 16384
  buffer_load_dwordx4 a[64:67], v2, s[8:11], s22 offen offset:0 sc1
  buffer_load_dwordx4 a[68:71], v2, s[8:11], s22 offen offset:1024 sc1
  buffer_load_dwordx4 a[72:75], v2, s[8:11], s22 offen offset:2048 sc1
  buffer_load_dwordx4 a[76:79], v2, s[8:11], s22 offen offset:3072 sc1
  s_add_u32 s22, s20, 20480
  buffer_load_dwordx4 a[80:83], v2, s[8:11], s22 offen offset:0 sc1
  buffer_load_dwordx4 a[84:87], v2, s[8:11], s22 offen offset:1024 sc1
  buffer_load_dwordx4 a[88:91], v2, s[8:11], s22 offen offset:2048 sc1
  buffer_load_dwordx4 a[92:95], v2, s[8:11], s22 offen offset:3072 sc1
  s_add_u32 s22, s20, 24576
  buffer_load_dwordx4 a[96:99], v2, s[8:11], s22 offen offset:0 sc1
  buffer_load_dwordx4 a[100:103], v2, s[8:11], s22 offen offset:1024 sc1
  buffer_load_dwordx4 a[104:107], v2, s[8:11], s22 offen offset:2048 sc1
  buffer_load_dwordx4 a[108:111], v2, s[8:11], s22 offen offset:3072 sc1
  s_add_u32 s22, s20, 28672
  buffer_load_dwordx4 a[112:115], v2, s[8:11], s22 offen offset:0 sc1
  buffer_load_dwordx4 a[116:119], v2, s[8:11], s22 offen offset:1024 sc1
  buffer_load_dwordx4 a[120:123], v2, s[8:11], s22 offen offset:2048 sc1
  buffer_load_dwordx4 a[124:127], v2, s[8:11], s22 offen offset:3072 sc1
  s_waitcnt vmcnt(24)
  s_add_u32 s22, s20, 32768
  buffer_load_dwordx4 a[128:131], v2, s[8:11], s22 offen offset:0 sc1
  buffer_load_dwordx4 a[132:135], v2, s[8:11], s22 offen offset:1024 sc1
  buffer_load_dwordx4 a[136:139], v2, s[8:11], s22 offen offset:2048 sc1
  buffer_load_dwordx4 a[140:143], v2, s[8:11], s22 offen offset:3072 sc1
  s_add_u32 s22, s20, 36864
  buffer_load_dwordx4 a[144:147], v2, s[8:11], s22 offen offset:0 sc1
  buffer_load_dwordx4 a[148:151], v2, s[8:11], s22 offen offset:1024 sc1
  buffer_load_dwordx4 a[152:155], v2, s[8:11], s22 offen offset:2048 sc1
  buffer_load_dwordx4 a[156:159], v2, s[8:11], s22 offen offset:3072 sc1
  s_add_u32 s22, s20, 40960
  buffer_load_dwordx4 a[160:163], v2, s[8:11], s22 offen offset:0 sc1
  buffer_load_dwordx4 a[164:167], v2, s[8:11], s22 offen offset:1024 sc1
  buffer_load_dwordx4 a[168:171], v2, s[8:11], s22 offen offset:2048 sc1
  buffer_load_dwordx4 a[172:175], v2, s[8:11], s22 offen offset:3072 sc1
  s_add_u32 s22, s20, 45056
  buffer_load_dwordx4 a[176:179], v2, s[8:11], s22 offen offset:0 sc1
  buffer_load_dwordx4 a[180:183], v2, s[8:11], s22 offen offset:1024 sc1
  buffer_load_dwordx4 a[184:187], v2, s[8:11], s22 offen offset:2048 sc1
  buffer_load_dwordx4 a[188:191], v2, s[8:11], s22 offen offset:3072 sc1
  s_add_u32 s22, s20, 49152
  buffer_load_dwordx4 a[192:195], v2, s[8:11], s22 offen offset:0 sc1
  buffer_load_dwordx4 a[196:199], v2, s[8:11], s22 offen offset:1024 sc1
  buffer_load_dwordx4 a[200:203], v2, s[8:11], s22 offen offset:2048 sc1
  buffer_load_dwordx4 a[204:207], v2, s[8:11], s22 offen offset:3072 sc1
  s_add_u32 s22, s20, 53248
  buffer_load_dwordx4 a[208:211], v2, s[8:11], s22 offen offset:0 sc1
  buffer_load_dwordx4 a[212:215], v2, s[8:11], s22 offen offset:1024 sc1
  buffer_load_dwordx4 a[216:219], v2, s[8:11], s22 offen offset:2048 sc1
  buffer_load_dwordx4 a[220:223], v2, s[8:11], s22 offen offset:3072 sc1
  s_add_u32 s22, s20, 57344
  buffer_load_dwordx4 a[224:227], v2, s[8:11], s22 offen offset:0 sc1
  buffer_load_dwordx4 a[228:231], v2, s[8:11], s22 offen offset:1024 sc1
  buffer_load_dwordx4 a[232:235], v2, s[8:11], s22 offen offset:2048 sc1
  buffer_load_dwordx4 a[236:239], v2, s[8:11], s22 offen offset:3072 sc1
  s_add_u32 s22, s20, 61440
  buffer_load_dwordx4 a[240:243], v2, s[8:11], s22 offen offset:0 sc1
  buffer_load_dwordx4 a[244:247], v2, s[8:11], s22 offen offset:1024 sc1
  buffer_load_dwordx4 a[248:251], v2, s[8:11], s22 offen offset:2048 sc1
  buffer_load_dwordx4 a[252:255], v2, s[8:11], s22 offen offset:3072 sc1
  s_waitcnt vmcnt(24)
  s_add_u32 s22, s20, 65536
  buffer_load_dwordx4 v[120:123], v2, s[8:11], s22 offen offset:0 sc1
  buffer_load_dwordx4 v[124:127], v2, s[8:11], s22 offen offset:1024 sc1
  buffer_load_dwordx4 v[128:131], v2, s[8:11], s22 offen offset:2048 sc1
  buffer_load_dwordx4 v[132:135], v2, s[8:11], s22 offen offset:3072 sc1
  s_add_u32 s22, s20, 69632
  buffer_load_dwordx4 v[136:139], v2, s[8:11], s22 offen offset:0 sc1
  buffer_load_dwordx4 v[140:143], v2, s[8:11], s22 offen offset:1024 sc1
  buffer_load_dwordx4 v[144:147], v2, s[8:11], s22 offen offset:2048 sc1
  buffer_load_dwordx4 v[148:151], v2, s[8:11], s22 offen offset:3072 sc1
  s_add_u32 s22, s20, 73728
  buffer_load_dwordx4 v[152:155], v2, s[8:11], s22 offen offset:0 sc1
  buffer_load_dwordx4 v[156:159], v2, s[8:11], s22 offen offset:1024 sc1
  buffer_load_dwordx4 v[160:163], v2, s[8:11], s22 offen offset:2048 sc1
  buffer_load_dwordx4 v[164:167], v2, s[8:11], s22 offen offset:3072 sc1
  s_add_u32 s22, s20, 77824
  buffer_load_dwordx4 v[168:171], v2, s[8:11], s22 offen offset:0 sc1
  buffer_load_dwordx4 v[172:175], v2, s[8:11], s22 offen offset:1024 sc1
  buffer_load_dwordx4 v[176:179], v2, s[8:11], s22 offen offset:2048 sc1
  buffer_load_dwordx4 v[180:183], v2, s[8:11], s22 offen offset:3072 sc1
  s_add_u32 s22, s20, 81920
  buffer_load_dwordx4 v[184:187], v2, s[8:11], s22 offen offset:0 sc1
  buffer_load_dwordx4 v[188:191], v2, s[8:11], s22 offen offset:1024 sc1
  buffer_load_dwordx4 v[192:195], v2, s[8:11], s22 offen offset:2048 sc1
  buffer_load_dwordx4 v[196:199], v2, s[8:11], s22 offen offset:3072 sc1
  s_add_u32 s22, s20, 86016
  buffer_load_dwordx4 v[200:203], v2, s[8:11], s22 offen offset:0 sc1
  buffer_load_dwordx4 v[204:207], v2, s[8:11], s22 offen offset:1024 sc1
  buffer_load_dwordx4 v[208:211], v2, s[8:11], s22 offen offset:2048 sc1
  buffer_load_dwordx4 v[212:215], v2, s[8:11], s22 offen offset:3072 sc1
  s_add_u32 s22, s20, 90112
  buffer_load_dwordx4 v[216:219], v2, s[8:11], s22 offen offset:0 sc1
  buffer_load_dwordx4 v[220:223], v2, s[8:11], s22 offen offset:1024 sc1
  buffer_load_dwordx4 v[224:227], v2, s[8:11], s22 offen offset:2048 sc1
  buffer_load_dwordx4 v[228:231], v2, s[8:11], s22 offen offset:3072 sc1
  s_add_u32 s22, s20, 94208
  buffer_load_dwordx4 v[232:235], v2, s[8:11], s22 offen offset:0 sc1
  buffer_load_dwordx4 v[236:239], v2, s[8:11], s22 offen offset:1024 sc1
  buffer_load_dwordx4 v[240:243], v2, s[8:11], s22 offen offset:2048 sc1
  buffer_load_dwordx4 v[244:247], v2, s[8:11], s22 offen offset:3072 sc1
  s_waitcnt vmcnt(24)
  s_add_u32 s22, s20, 98304
  buffer_load_dwordx4 v[248:251], v2, s[8:11], s22 offen offset:0 sc1
  buffer_load_dwordx4 v[252:255], v2, s[8:11], s22 offen offset:1024 sc1
  v_mov_b32 v5, 0x4444
  v_mov_b32 v6, 0xeeee
  v_cmp_lt_u32 vcc, 7, v4
  s_nop 1
  v_cndmask_b32 v5, v5, v6, vcc
  s_lshl_b32 s23, s16, 11
  v_lshrrev_b32 v80, 1, v3
  v_and_b32 v81, 1, v3
  v_add_u32 v82, 0, v80
  v_lshl_add_u32 v82, v82, 4, v4
  v_mul_u32_u24 v83, 2341, v82
  v_lshrrev_b32 v83, 16, v83
  v_mul_u32_u24 v84, 28, v83
  v_sub_u32 v84, v82, v84
  v_lshrrev_b32 v85, 4, v84
  v_and_b32 v84, 15, v84
  v_lshlrev_b32 v86, 10, v85
  v_lshl_add_u32 v86, v83, 8, v86
  v_lshl_add_u32 v86, v84, 4, v86
  v_lshl_add_u32 v86, v81, 3, v86
  v_add_u32 v72, s23, v86
  v_add_u32 v82, 2, v80
  v_lshl_add_u32 v82, v82, 4, v4
  v_mul_u32_u24 v83, 2341, v82
  v_lshrrev_b32 v83, 16, v83
  v_mul_u32_u24 v84, 28, v83
  v_sub_u32 v84, v82, v84
  v_lshrrev_b32 v85, 4, v84
  v_and_b32 v84, 15, v84
  v_lshlrev_b32 v86, 10, v85
  v_lshl_add_u32 v86, v83, 8, v86
  v_lshl_add_u32 v86, v84, 4, v86
  v_lshl_add_u32 v86, v81, 3, v86
  v_add_u32 v73, s23, v86
  v_add_u32 v82, 4, v80
  v_lshl_add_u32 v82, v82, 4, v4
  v_mul_u32_u24 v83, 2341, v82
  v_lshrrev_b32 v83, 16, v83
  v_mul_u32_u24 v84, 28, v83
  v_sub_u32 v84, v82, v84
  v_lshrrev_b32 v85, 4, v84
  v_and_b32 v84, 15, v84
  v_lshlrev_b32 v86, 10, v85
  v_lshl_add_u32 v86, v83, 8, v86
  v_lshl_add_u32 v86, v84, 4, v86
  v_lshl_add_u32 v86, v81, 3, v86
  v_add_u32 v74, s23, v86
  v_mov_b32 v82, 6
  v_lshl_add_u32 v82, v82, 4, v4
  v_mul_u32_u24 v83, 2341, v82
  v_lshrrev_b32 v83, 16, v83
  v_mul_u32_u24 v84, 28, v83
  v_sub_u32 v84, v82, v84
  v_lshrrev_b32 v85, 4, v84
  v_and_b32 v84, 15, v84
  v_lshlrev_b32 v86, 10, v85
  v_lshl_add_u32 v86, v83, 8, v86
  v_lshl_add_u32 v86, v84, 4, v86
  v_lshl_add_u32 v86, v81, 3, v86
  v_add_u32 v75, s23, v86
  v_add_u32 v76, s23, v2
  s_mul_i32 s27, s18, 448
  v_mov_b32 v77, s27
  v_mov_b32 v78, 1
  s_mov_b32 s17, s19
  s_mul_i32 s24, s19, 7168
  s_add_u32 s24, s24, 88002560
  s_mul_i32 s25, s18, 65
  s_add_u32 s25, s25, s19
  s_lshl_b32 s25, s25, 13
  s_add_u32 s25, s25, s23
  s_add_u32 s25, s25, 76869632
  s_lshl_b32 s26, s18, 6
  s_add_u32 s26, s26, s19
  s_lshl_b32 s26, s26, 4
  s_lshl_b32 s27, s16, 2
  s_add_u32 s26, s26, s27
  s_add_u32 s26, s26, 88502272
  v_mov_b32 v88, 0
  v_mov_b32 v89, 0
  v_mov_b32 v90, 0
  v_mov_b32 v91, 0
  v_mov_b32 v92, -1
  v_mov_b32 v93, -1
  v_mov_b32 v94, -1
  v_mov_b32 v95, -1
  ds_write_b128 v76, v[88:91]
  ds_write_b128 v76, v[88:91] offset:1024
  s_branch ws_arm
ws_loop:
  v_mov_b32 v36, 0
  v_mov_b32 v37, 0
  v_mov_b32 v38, 0
  v_mov_b32 v39, 0
  v_mov_b32 v40, 0
  v_mov_b32 v41, 0
  v_mov_b32 v42, 0
  v_mov_b32 v43, 0
  v_mov_b32 v44, 0
  v_mov_b32 v45, 0
  v_mov_b32 v46, 0
  v_mov_b32 v47, 0
  v_mov_b32 v48, 0
  v_mov_b32 v49, 0
  v_mov_b32 v50, 0
  v_mov_b32 v51, 0
  v_mov_b32 v52, 0
  v_mov_b32 v53, 0
  v_mov_b32 v54, 0
  v_mov_b32 v55, 0
  v_mov_b32 v56, 0
  v_mov_b32 v57, 0
  v_mov_b32 v58, 0
  v_mov_b32 v59, 0
  v_mov_b32 v60, 0
  v_mov_b32 v61, 0
  v_mov_b32 v62, 0
  v_mov_b32 v63, 0
  s_mov_b32 s30, 0
  s_branch ws_fl
ws_pm:
  s_cmp_ge_u32 s17, 64
  s_cbranch_scc1 ws_fl
  buffer_load_dword v79, v77, s[8:11], s24 offen sc1
  s_waitcnt vmcnt(0)
  v_cmp_eq_u32 vcc, -1, v79
  s_cbranch_vccnz ws_pr
ws_fl:
  s_add_u32 s22, s24, 4096
  buffer_load_dwordx4 v[8:11], v2, s[8:11], s24 offen offset:0 sc1
  buffer_load_dwordx4 v[12:15], v2, s[8:11], s24 offen offset:1024 sc1
  buffer_load_dwordx4 v[16:19], v2, s[8:11], s24 offen offset:2048 sc1
  buffer_load_dwordx4 v[20:23], v2, s[8:11], s24 offen offset:3072 sc1
  buffer_load_dwordx4 v[24:27], v2, s[8:11], s22 offen offset:0 sc1
  buffer_load_dwordx4 v[28:31], v2, s[8:11], s22 offen offset:1024 sc1
  buffer_load_dwordx4 v[32:35], v2, s[8:11], s22 offen offset:2048 sc1
  s_waitcnt vmcnt(0)
  v_max_u32 v79, v8, v9
  v_max3_u32 v79, v79, v10, v11
  v_max3_u32 v79, v79, v12, v13
  v_max3_u32 v79, v79, v14, v15
  v_max3_u32 v79, v79, v16, v17
  v_max3_u32 v79, v79, v18, v19
  v_max3_u32 v79, v79, v20, v21
  v_max3_u32 v79, v79, v22, v23
  v_max3_u32 v79, v79, v24, v25
  v_max3_u32 v79, v79, v26, v27
  v_max3_u32 v79, v79, v28, v29
  v_max3_u32 v79, v79, v30, v31
  v_max3_u32 v79, v79, v32, v33
  v_max3_u32 v79, v79, v34, v35
  v_cmp_eq_u32 vcc, -1, v79
  s_cbranch_vccz ws_pk
ws_pr:
  s_sleep 6
  s_add_u32 s30, s30, 1
  s_cmp_lt_u32 s30, 2000000
  s_cbranch_scc1 ws_pm
  s_branch cA_abort
ws_pk:
  v_smfmac_f32_16x16x64_bf16 v[36:39], v[8:11], a[0:7], v5
  v_smfmac_f32_16x16x64_bf16 v[36:39], v[12:15], a[8:15], v5
  v_smfmac_f32_16x16x64_bf16 v[36:39], v[16:19], a[16:23], v5
  v_smfmac_f32_16x16x64_bf16 v[36:39], v[20:23], a[24:31], v5
  v_smfmac_f32_16x16x64_bf16 v[36:39], v[24:27], a[32:39], v5
  v_smfmac_f32_16x16x64_bf16 v[36:39], v[28:31], a[40:47], v5
  v_smfmac_f32_16x16x64_bf16 v[36:39], v[32:35], a[48:55], v5
  v_smfmac_f32_16x16x64_bf16 v[40:43], v[8:11], a[56:63], v5
  v_smfmac_f32_16x16x64_bf16 v[40:43], v[12:15], a[64:71], v5
  v_smfmac_f32_16x16x64_bf16 v[40:43], v[16:19], a[72:79], v5
  v_smfmac_f32_16x16x64_bf16 v[40:43], v[20:23], a[80:87], v5
  v_smfmac_f32_16x16x64_bf16 v[40:43], v[24:27], a[88:95], v5
  v_smfmac_f32_16x16x64_bf16 v[40:43], v[28:31], a[96:103], v5
  v_smfmac_f32_16x16x64_bf16 v[40:43], v[32:35], a[104:111], v5
  v_smfmac_f32_16x16x64_bf16 v[44:47], v[8:11], a[112:119], v5
  v_smfmac_f32_16x16x64_bf16 v[44:47], v[12:15], a[120:127], v5
  v_smfmac_f32_16x16x64_bf16 v[44:47], v[16:19], a[128:135], v5
  v_smfmac_f32_16x16x64_bf16 v[44:47], v[20:23], a[136:143], v5
  v_smfmac_f32_16x16x64_bf16 v[44:47], v[24:27], a[144:151], v5
  v_smfmac_f32_16x16x64_bf16 v[44:47], v[28:31], a[152:159], v5
  v_smfmac_f32_16x16x64_bf16 v[44:47], v[32:35], a[160:167], v5
  v_smfmac_f32_16x16x64_bf16 v[48:51], v[8:11], a[168:175], v5
  v_smfmac_f32_16x16x64_bf16 v[48:51], v[12:15], a[176:183], v5
  v_smfmac_f32_16x16x64_bf16 v[48:51], v[16:19], a[184:191], v5
  v_smfmac_f32_16x16x64_bf16 v[48:51], v[20:23], a[192:199], v5
  v_smfmac_f32_16x16x64_bf16 v[48:51], v[24:27], a[200:207], v5
  v_smfmac_f32_16x16x64_bf16 v[48:51], v[28:31], a[208:215], v5
  v_smfmac_f32_16x16x64_bf16 v[48:51], v[32:35], a[216:223], v5
  v_smfmac_f32_16x16x64_bf16 v[52:55], v[8:11], a[224:231], v5
  v_smfmac_f32_16x16x64_bf16 v[52:55], v[12:15], a[232:239], v5
  v_smfmac_f32_16x16x64_bf16 v[52:55], v[16:19], a[240:247], v5
  v_smfmac_f32_16x16x64_bf16 v[52:55], v[20:23], a[248:255], v5
  v_smfmac_f32_16x16x64_bf16 v[52:55], v[24:27], v[120:127], v5
  v_smfmac_f32_16x16x64_bf16 v[52:55], v[28:31], v[128:135], v5
  v_smfmac_f32_16x16x64_bf16 v[52:55], v[32:35], v[136:143], v5
  v_smfmac_f32_16x16x64_bf16 v[56:59], v[8:11], v[144:151], v5
  v_smfmac_f32_16x16x64_bf16 v[56:59], v[12:15], v[152:159], v5
  v_smfmac_f32_16x16x64_bf16 v[56:59], v[16:19], v[160:167], v5
  v_smfmac_f32_16x16x64_bf16 v[56:59], v[20:23], v[168:175], v5
  v_smfmac_f32_16x16x64_bf16 v[56:59], v[24:27], v[176:183], v5
  v_smfmac_f32_16x16x64_bf16 v[56:59], v[28:31], v[184:191], v5
  v_smfmac_f32_16x16x64_bf16 v[56:59], v[32:35], v[192:199], v5
  v_smfmac_f32_16x16x64_bf16 v[60:63], v[8:11], v[200:207], v5
  v_smfmac_f32_16x16x64_bf16 v[60:63], v[12:15], v[208:215], v5
  v_smfmac_f32_16x16x64_bf16 v[60:63], v[16:19], v[216:223], v5
  v_smfmac_f32_16x16x64_bf16 v[60:63], v[20:23], v[224:231], v5
  v_smfmac_f32_16x16x64_bf16 v[60:63], v[24:27], v[232:239], v5
  v_smfmac_f32_16x16x64_bf16 v[60:63], v[28:31], v[240:247], v5
  v_smfmac_f32_16x16x64_bf16 v[60:63], v[32:35], v[248:255], v5
  v_permlane32_swap_b32 v36, v40
  v_permlane32_swap_b32 v37, v41
  v_permlane32_swap_b32 v38, v42
  v_permlane32_swap_b32 v39, v43
  v_add_f32 v36, v36, v40
  v_add_f32 v37, v37, v41
  v_add_f32 v38, v38, v42
  v_add_f32 v39, v39, v43
  v_cvt_pk_bf16_f32 v40, v36, v37
  v_cvt_pk_bf16_f32 v41, v38, v39
  v_min_u32 v40, -2, v40
  v_min_u32 v41, -2, v41
  ds_write_b64 v72, v[40:41]
  v_permlane32_swap_b32 v44, v48
  v_permlane32_swap_b32 v45, v49
  v_permlane32_swap_b32 v46, v50
  v_permlane32_swap_b32 v47, v51
  v_add_f32 v44, v44, v48
  v_add_f32 v45, v45, v49
  v_add_f32 v46, v46, v50
  v_add_f32 v47, v47, v51
  v_cvt_pk_bf16_f32 v48, v44, v45
  v_cvt_pk_bf16_f32 v49, v46, v47
  v_min_u32 v48, -2, v48
  v_min_u32 v49, -2, v49
  ds_write_b64 v73, v[48:49]
  v_permlane32_swap_b32 v52, v56
  v_permlane32_swap_b32 v53, v57
  v_permlane32_swap_b32 v54, v58
  v_permlane32_swap_b32 v55, v59
  v_add_f32 v52, v52, v56
  v_add_f32 v53, v53, v57
  v_add_f32 v54, v54, v58
  v_add_f32 v55, v55, v59
  v_cvt_pk_bf16_f32 v56, v52, v53
  v_cvt_pk_bf16_f32 v57, v54, v55
  v_min_u32 v56, -2, v56
  v_min_u32 v57, -2, v57
  ds_write_b64 v74, v[56:57]
  v_mov_b32 v64, v60
  v_mov_b32 v65, v61
  v_mov_b32 v66, v62
  v_mov_b32 v67, v63
  v_permlane32_swap_b32 v60, v64
  v_permlane32_swap_b32 v61, v65
  v_permlane32_swap_b32 v62, v66
  v_permlane32_swap_b32 v63, v67
  v_add_f32 v60, v60, v64
  v_add_f32 v61, v61, v65
  v_add_f32 v62, v62, v66
  v_add_f32 v63, v63, v67
  v_cvt_pk_bf16_f32 v64, v60, v61
  v_cvt_pk_bf16_f32 v65, v62, v63
  v_min_u32 v64, -2, v64
  v_min_u32 v65, -2, v65
  ds_write_b64 v75, v[64:65]
  s_waitcnt lgkmcnt(0)
  ds_read_b128 v[64:67], v76
  ds_read_b128 v[68:71], v76 offset:1024
  s_waitcnt lgkmcnt(0)
  buffer_store_dwordx4 v[64:67], v2, s[8:11], s25 offen sc1
  buffer_store_dwordx4 v[68:71], v2, s[8:11], s25 offen offset:1024 sc1
  s_add_u32 s24, s24, 14336
  s_add_u32 s25, s25, 16384
  s_add_u32 s26, s26, 32
  s_add_u32 s17, s17, 2
  s_cmp_ge_u32 s17, 64
  s_cbranch_scc1 ws_end
ws_arm:
  buffer_store_dwordx4 v[92:95], v2, s[8:11], s25 offen sc1
  buffer_store_dwordx4 v[92:95], v2, s[8:11], s25 offen offset:1024 sc1
  s_waitcnt vmcnt(0)
  s_mov_b64 exec, 1
  buffer_store_dword v78, v2, s[8:11], s26 offen sc1
  s_mov_b64 exec, -1
  s_branch ws_loop
ws_end:
  v_mov_b32 v250, 0
  s_branch wk_loop
wk_s4d:
  s_sub_u32 s3, s3, 640
  s_load_dwordx8 s[40:47], s[0:1], 0
  s_load_dwordx4 s[48:51], s[0:1], 32
  s_load_dwordx2 s[52:53], s[0:1], 48
  s_load_dwordx2 s[54:55], s[0:1], 112
  v_lshrrev_b32 v1, 6, v0
  s_nop 0
  v_readfirstlane_b32 s16, v1
  v_and_b32 v1, 63, v0
  v_lshrrev_b32 v3, 4, v1
  v_and_b32 v4, 15, v1
  s_mul_i32 s17, s16, 24576
  s_waitcnt lgkmcnt(0)
  s_mov_b32 s60, s40
  s_and_b32 s61, s41, 0xffff
  s_mov_b32 s62, 1835008
  s_mov_b32 s63, 0x20000
  s_mov_b32 s64, s42
  s_and_b32 s65, s43, 0xffff
  s_mov_b32 s66, 229376
  s_mov_b32 s67, 0x20000
  s_mov_b32 s68, s44
  s_and_b32 s69, s45, 0xffff
  s_mov_b32 s70, 229376
  s_mov_b32 s71, 0x20000
  s_mov_b32 s72, s46
  s_and_b32 s73, s47, 0xffff
  s_mov_b32 s74, 229376
  s_mov_b32 s75, 0x20000
  s_mov_b32 s76, s48
  s_and_b32 s77, s49, 0xffff
  s_mov_b32 s78, 229376
  s_mov_b32 s79, 0x20000
  s_mov_b32 s80, s50
  s_and_b32 s81, s51, 0xffff
  s_mov_b32 s82, 896
  s_mov_b32 s83, 0x20000
  s_mov_b32 s84, s52
  s_and_b32 s85, s53, 0xffff
  s_mov_b32 s86, 896
  s_mov_b32 s87, 0x20000
  s_mov_b32 s88, s54
  s_and_b32 s89, s55, 0xffff
  s_mov_b32 s90, 3670016
  s_mov_b32 s91, 0x20000
  v_lshlrev_b32 v5, 5, v1
  v_sub_u32 v5, 2047, v5
  s_add_u32 s18, s17, 13056
  v_subrev_u32 v6, 0, v5
  v_max_i32 v7, 0, v6
  v_cvt_f32_u32 v7, v7
  v_cvt_pk_bf16_f32 v8, v7, v7
  v_and_b32 v7, 0xffff0000, v8
  v_lshrrev_b32 v8, 23, v7
  v_subrev_u32 v8, 134, v8
  v_max_i32 v8, 0, v8
  v_cvt_u32_f32 v7, v7
  v_lshrrev_b32 v7, v8, v7
  v_lshl_add_u32 v7, v8, 8, v7
  v_lshl_add_u32 v200, v7, 2, s18
  v_subrev_u32 v6, 1, v5
  v_max_i32 v7, 0, v6
  v_cvt_f32_u32 v7, v7
  v_cvt_pk_bf16_f32 v8, v7, v7
  v_and_b32 v7, 0xffff0000, v8
  v_lshrrev_b32 v8, 23, v7
  v_subrev_u32 v8, 134, v8
  v_max_i32 v8, 0, v8
  v_cvt_u32_f32 v7, v7
  v_lshrrev_b32 v7, v8, v7
  v_lshl_add_u32 v7, v8, 8, v7
  v_lshl_add_u32 v201, v7, 2, s18
  v_subrev_u32 v6, 2, v5
  v_max_i32 v7, 0, v6
  v_cvt_f32_u32 v7, v7
  v_cvt_pk_bf16_f32 v8, v7, v7
  v_and_b32 v7, 0xffff0000, v8
  v_lshrrev_b32 v8, 23, v7
  v_subrev_u32 v8, 134, v8
  v_max_i32 v8, 0, v8
  v_cvt_u32_f32 v7, v7
  v_lshrrev_b32 v7, v8, v7
  v_lshl_add_u32 v7, v8, 8, v7
  v_lshl_add_u32 v202, v7, 2, s18
  v_subrev_u32 v6, 3, v5
  v_max_i32 v7, 0, v6
  v_cvt_f32_u32 v7, v7
  v_cvt_pk_bf16_f32 v8, v7, v7
  v_and_b32 v7, 0xffff0000, v8
  v_lshrrev_b32 v8, 23, v7
  v_subrev_u32 v8, 134, v8
  v_max_i32 v8, 0, v8
  v_cvt_u32_f32 v7, v7
  v_lshrrev_b32 v7, v8, v7
  v_lshl_add_u32 v7, v8, 8, v7
  v_lshl_add_u32 v203, v7, 2, s18
  v_subrev_u32 v6, 4, v5
  v_max_i32 v7, 0, v6
  v_cvt_f32_u32 v7, v7
  v_cvt_pk_bf16_f32 v8, v7, v7
  v_and_b32 v7, 0xffff0000, v8
  v_lshrrev_b32 v8, 23, v7
  v_subrev_u32 v8, 134, v8
  v_max_i32 v8, 0, v8
  v_cvt_u32_f32 v7, v7
  v_lshrrev_b32 v7, v8, v7
  v_lshl_add_u32 v7, v8, 8, v7
  v_lshl_add_u32 v204, v7, 2, s18
  v_subrev_u32 v6, 5, v5
  v_max_i32 v7, 0, v6
  v_cvt_f32_u32 v7, v7
  v_cvt_pk_bf16_f32 v8, v7, v7
  v_and_b32 v7, 0xffff0000, v8
  v_lshrrev_b32 v8, 23, v7
  v_subrev_u32 v8, 134, v8
  v_max_i32 v8, 0, v8
  v_cvt_u32_f32 v7, v7
  v_lshrrev_b32 v7, v8, v7
  v_lshl_add_u32 v7, v8, 8, v7
  v_lshl_add_u32 v205, v7, 2, s18
  v_subrev_u32 v6, 6, v5
  v_max_i32 v7, 0, v6
  v_cvt_f32_u32 v7, v7
  v_cvt_pk_bf16_f32 v8, v7, v7
  v_and_b32 v7, 0xffff0000, v8
  v_lshrrev_b32 v8, 23, v7
  v_subrev_u32 v8, 134, v8
  v_max_i32 v8, 0, v8
  v_cvt_u32_f32 v7, v7
  v_lshrrev_b32 v7, v8, v7
  v_lshl_add_u32 v7, v8, 8, v7
  v_lshl_add_u32 v206, v7, 2, s18
  v_subrev_u32 v6, 7, v5
  v_max_i32 v7, 0, v6
  v_cvt_f32_u32 v7, v7
  v_cvt_pk_bf16_f32 v8, v7, v7
  v_and_b32 v7, 0xffff0000, v8
  v_lshrrev_b32 v8, 23, v7
  v_subrev_u32 v8, 134, v8
  v_max_i32 v8, 0, v8
  v_cvt_u32_f32 v7, v7
  v_lshrrev_b32 v7, v8, v7
  v_lshl_add_u32 v7, v8, 8, v7
  v_lshl_add_u32 v207, v7, 2, s18
  v_subrev_u32 v6, 8, v5
  v_max_i32 v7, 0, v6
  v_cvt_f32_u32 v7, v7
  v_cvt_pk_bf16_f32 v8, v7, v7
  v_and_b32 v7, 0xffff0000, v8
  v_lshrrev_b32 v8, 23, v7
  v_subrev_u32 v8, 134, v8
  v_max_i32 v8, 0, v8
  v_cvt_u32_f32 v7, v7
  v_lshrrev_b32 v7, v8, v7
  v_lshl_add_u32 v7, v8, 8, v7
  v_lshl_add_u32 v208, v7, 2, s18
  v_subrev_u32 v6, 9, v5
  v_max_i32 v7, 0, v6
  v_cvt_f32_u32 v7, v7
  v_cvt_pk_bf16_f32 v8, v7, v7
  v_and_b32 v7, 0xffff0000, v8
  v_lshrrev_b32 v8, 23, v7
  v_subrev_u32 v8, 134, v8
  v_max_i32 v8, 0, v8
  v_cvt_u32_f32 v7, v7
  v_lshrrev_b32 v7, v8, v7
  v_lshl_add_u32 v7, v8, 8, v7
  v_lshl_add_u32 v209, v7, 2, s18
  v_subrev_u32 v6, 10, v5
  v_max_i32 v7, 0, v6
  v_cvt_f32_u32 v7, v7
  v_cvt_pk_bf16_f32 v8, v7, v7
  v_and_b32 v7, 0xffff0000, v8
  v_lshrrev_b32 v8, 23, v7
  v_subrev_u32 v8, 134, v8
  v_max_i32 v8, 0, v8
  v_cvt_u32_f32 v7, v7
  v_lshrrev_b32 v7, v8, v7
  v_lshl_add_u32 v7, v8, 8, v7
  v_lshl_add_u32 v210, v7, 2, s18
  v_subrev_u32 v6, 11, v5
  v_max_i32 v7, 0, v6
  v_cvt_f32_u32 v7, v7
  v_cvt_pk_bf16_f32 v8, v7, v7
  v_and_b32 v7, 0xffff0000, v8
  v_lshrrev_b32 v8, 23, v7
  v_subrev_u32 v8, 134, v8
  v_max_i32 v8, 0, v8
  v_cvt_u32_f32 v7, v7
  v_lshrrev_b32 v7, v8, v7
  v_lshl_add_u32 v7, v8, 8, v7
  v_lshl_add_u32 v211, v7, 2, s18
  v_subrev_u32 v6, 12, v5
  v_max_i32 v7, 0, v6
  v_cvt_f32_u32 v7, v7
  v_cvt_pk_bf16_f32 v8, v7, v7
  v_and_b32 v7, 0xffff0000, v8
  v_lshrrev_b32 v8, 23, v7
  v_subrev_u32 v8, 134, v8
  v_max_i32 v8, 0, v8
  v_cvt_u32_f32 v7, v7
  v_lshrrev_b32 v7, v8, v7
  v_lshl_add_u32 v7, v8, 8, v7
  v_lshl_add_u32 v212, v7, 2, s18
  v_subrev_u32 v6, 13, v5
  v_max_i32 v7, 0, v6
  v_cvt_f32_u32 v7, v7
  v_cvt_pk_bf16_f32 v8, v7, v7
  v_and_b32 v7, 0xffff0000, v8
  v_lshrrev_b32 v8, 23, v7
  v_subrev_u32 v8, 134, v8
  v_max_i32 v8, 0, v8
  v_cvt_u32_f32 v7, v7
  v_lshrrev_b32 v7, v8, v7
  v_lshl_add_u32 v7, v8, 8, v7
  v_lshl_add_u32 v213, v7, 2, s18
  v_subrev_u32 v6, 14, v5
  v_max_i32 v7, 0, v6
  v_cvt_f32_u32 v7, v7
  v_cvt_pk_bf16_f32 v8, v7, v7
  v_and_b32 v7, 0xffff0000, v8
  v_lshrrev_b32 v8, 23, v7
  v_subrev_u32 v8, 134, v8
  v_max_i32 v8, 0, v8
  v_cvt_u32_f32 v7, v7
  v_lshrrev_b32 v7, v8, v7
  v_lshl_add_u32 v7, v8, 8, v7
  v_lshl_add_u32 v214, v7, 2, s18
  v_subrev_u32 v6, 15, v5
  v_max_i32 v7, 0, v6
  v_cvt_f32_u32 v7, v7
  v_cvt_pk_bf16_f32 v8, v7, v7
  v_and_b32 v7, 0xffff0000, v8
  v_lshrrev_b32 v8, 23, v7
  v_subrev_u32 v8, 134, v8
  v_max_i32 v8, 0, v8
  v_cvt_u32_f32 v7, v7
  v_lshrrev_b32 v7, v8, v7
  v_lshl_add_u32 v7, v8, 8, v7
  v_lshl_add_u32 v215, v7, 2, s18
  v_subrev_u32 v6, 16, v5
  v_max_i32 v7, 0, v6
  v_cvt_f32_u32 v7, v7
  v_cvt_pk_bf16_f32 v8, v7, v7
  v_and_b32 v7, 0xffff0000, v8
  v_lshrrev_b32 v8, 23, v7
  v_subrev_u32 v8, 134, v8
  v_max_i32 v8, 0, v8
  v_cvt_u32_f32 v7, v7
  v_lshrrev_b32 v7, v8, v7
  v_lshl_add_u32 v7, v8, 8, v7
  v_lshl_add_u32 v216, v7, 2, s18
  v_subrev_u32 v6, 17, v5
  v_max_i32 v7, 0, v6
  v_cvt_f32_u32 v7, v7
  v_cvt_pk_bf16_f32 v8, v7, v7
  v_and_b32 v7, 0xffff0000, v8
  v_lshrrev_b32 v8, 23, v7
  v_subrev_u32 v8, 134, v8
  v_max_i32 v8, 0, v8
  v_cvt_u32_f32 v7, v7
  v_lshrrev_b32 v7, v8, v7
  v_lshl_add_u32 v7, v8, 8, v7
  v_lshl_add_u32 v217, v7, 2, s18
  v_subrev_u32 v6, 18, v5
  v_max_i32 v7, 0, v6
  v_cvt_f32_u32 v7, v7
  v_cvt_pk_bf16_f32 v8, v7, v7
  v_and_b32 v7, 0xffff0000, v8
  v_lshrrev_b32 v8, 23, v7
  v_subrev_u32 v8, 134, v8
  v_max_i32 v8, 0, v8
  v_cvt_u32_f32 v7, v7
  v_lshrrev_b32 v7, v8, v7
  v_lshl_add_u32 v7, v8, 8, v7
  v_lshl_add_u32 v218, v7, 2, s18
  v_subrev_u32 v6, 19, v5
  v_max_i32 v7, 0, v6
  v_cvt_f32_u32 v7, v7
  v_cvt_pk_bf16_f32 v8, v7, v7
  v_and_b32 v7, 0xffff0000, v8
  v_lshrrev_b32 v8, 23, v7
  v_subrev_u32 v8, 134, v8
  v_max_i32 v8, 0, v8
  v_cvt_u32_f32 v7, v7
  v_lshrrev_b32 v7, v8, v7
  v_lshl_add_u32 v7, v8, 8, v7
  v_lshl_add_u32 v219, v7, 2, s18
  v_subrev_u32 v6, 20, v5
  v_max_i32 v7, 0, v6
  v_cvt_f32_u32 v7, v7
  v_cvt_pk_bf16_f32 v8, v7, v7
  v_and_b32 v7, 0xffff0000, v8
  v_lshrrev_b32 v8, 23, v7
  v_subrev_u32 v8, 134, v8
  v_max_i32 v8, 0, v8
  v_cvt_u32_f32 v7, v7
  v_lshrrev_b32 v7, v8, v7
  v_lshl_add_u32 v7, v8, 8, v7
  v_lshl_add_u32 v220, v7, 2, s18
  v_subrev_u32 v6, 21, v5
  v_max_i32 v7, 0, v6
  v_cvt_f32_u32 v7, v7
  v_cvt_pk_bf16_f32 v8, v7, v7
  v_and_b32 v7, 0xffff0000, v8
  v_lshrrev_b32 v8, 23, v7
  v_subrev_u32 v8, 134, v8
  v_max_i32 v8, 0, v8
  v_cvt_u32_f32 v7, v7
  v_lshrrev_b32 v7, v8, v7
  v_lshl_add_u32 v7, v8, 8, v7
  v_lshl_add_u32 v221, v7, 2, s18
  v_subrev_u32 v6, 22, v5
  v_max_i32 v7, 0, v6
  v_cvt_f32_u32 v7, v7
  v_cvt_pk_bf16_f32 v8, v7, v7
  v_and_b32 v7, 0xffff0000, v8
  v_lshrrev_b32 v8, 23, v7
  v_subrev_u32 v8, 134, v8
  v_max_i32 v8, 0, v8
  v_cvt_u32_f32 v7, v7
  v_lshrrev_b32 v7, v8, v7
  v_lshl_add_u32 v7, v8, 8, v7
  v_lshl_add_u32 v222, v7, 2, s18
  v_subrev_u32 v6, 23, v5
  v_max_i32 v7, 0, v6
  v_cvt_f32_u32 v7, v7
  v_cvt_pk_bf16_f32 v8, v7, v7
  v_and_b32 v7, 0xffff0000, v8
  v_lshrrev_b32 v8, 23, v7
  v_subrev_u32 v8, 134, v8
  v_max_i32 v8, 0, v8
  v_cvt_u32_f32 v7, v7
  v_lshrrev_b32 v7, v8, v7
  v_lshl_add_u32 v7, v8, 8, v7
  v_lshl_add_u32 v223, v7, 2, s18
  v_subrev_u32 v6, 24, v5
  v_max_i32 v7, 0, v6
  v_cvt_f32_u32 v7, v7
  v_cvt_pk_bf16_f32 v8, v7, v7
  v_and_b32 v7, 0xffff0000, v8
  v_lshrrev_b32 v8, 23, v7
  v_subrev_u32 v8, 134, v8
  v_max_i32 v8, 0, v8
  v_cvt_u32_f32 v7, v7
  v_lshrrev_b32 v7, v8, v7
  v_lshl_add_u32 v7, v8, 8, v7
  v_lshl_add_u32 v224, v7, 2, s18
  v_subrev_u32 v6, 25, v5
  v_max_i32 v7, 0, v6
  v_cvt_f32_u32 v7, v7
  v_cvt_pk_bf16_f32 v8, v7, v7
  v_and_b32 v7, 0xffff0000, v8
  v_lshrrev_b32 v8, 23, v7
  v_subrev_u32 v8, 134, v8
  v_max_i32 v8, 0, v8
  v_cvt_u32_f32 v7, v7
  v_lshrrev_b32 v7, v8, v7
  v_lshl_add_u32 v7, v8, 8, v7
  v_lshl_add_u32 v225, v7, 2, s18
  v_subrev_u32 v6, 26, v5
  v_max_i32 v7, 0, v6
  v_cvt_f32_u32 v7, v7
  v_cvt_pk_bf16_f32 v8, v7, v7
  v_and_b32 v7, 0xffff0000, v8
  v_lshrrev_b32 v8, 23, v7
  v_subrev_u32 v8, 134, v8
  v_max_i32 v8, 0, v8
  v_cvt_u32_f32 v7, v7
  v_lshrrev_b32 v7, v8, v7
  v_lshl_add_u32 v7, v8, 8, v7
  v_lshl_add_u32 v226, v7, 2, s18
  v_subrev_u32 v6, 27, v5
  v_max_i32 v7, 0, v6
  v_cvt_f32_u32 v7, v7
  v_cvt_pk_bf16_f32 v8, v7, v7
  v_and_b32 v7, 0xffff0000, v8
  v_lshrrev_b32 v8, 23, v7
  v_subrev_u32 v8, 134, v8
  v_max_i32 v8, 0, v8
  v_cvt_u32_f32 v7, v7
  v_lshrrev_b32 v7, v8, v7
  v_lshl_add_u32 v7, v8, 8, v7
  v_lshl_add_u32 v227, v7, 2, s18
  v_subrev_u32 v6, 28, v5
  v_max_i32 v7, 0, v6
  v_cvt_f32_u32 v7, v7
  v_cvt_pk_bf16_f32 v8, v7, v7
  v_and_b32 v7, 0xffff0000, v8
  v_lshrrev_b32 v8, 23, v7
  v_subrev_u32 v8, 134, v8
  v_max_i32 v8, 0, v8
  v_cvt_u32_f32 v7, v7
  v_lshrrev_b32 v7, v8, v7
  v_lshl_add_u32 v7, v8, 8, v7
  v_lshl_add_u32 v228, v7, 2, s18
  v_subrev_u32 v6, 29, v5
  v_max_i32 v7, 0, v6
  v_cvt_f32_u32 v7, v7
  v_cvt_pk_bf16_f32 v8, v7, v7
  v_and_b32 v7, 0xffff0000, v8
  v_lshrrev_b32 v8, 23, v7
  v_subrev_u32 v8, 134, v8
  v_max_i32 v8, 0, v8
  v_cvt_u32_f32 v7, v7
  v_lshrrev_b32 v7, v8, v7
  v_lshl_add_u32 v7, v8, 8, v7
  v_lshl_add_u32 v229, v7, 2, s18
  v_subrev_u32 v6, 30, v5
  v_max_i32 v7, 0, v6
  v_cvt_f32_u32 v7, v7
  v_cvt_pk_bf16_f32 v8, v7, v7
  v_and_b32 v7, 0xffff0000, v8
  v_lshrrev_b32 v8, 23, v7
  v_subrev_u32 v8, 134, v8
  v_max_i32 v8, 0, v8
  v_cvt_u32_f32 v7, v7
  v_lshrrev_b32 v7, v8, v7
  v_lshl_add_u32 v7, v8, 8, v7
  v_lshl_add_u32 v230, v7, 2, s18
  v_subrev_u32 v6, 31, v5
  v_max_i32 v7, 0, v6
  v_cvt_f32_u32 v7, v7
  v_cvt_pk_bf16_f32 v8, v7, v7
  v_and_b32 v7, 0xffff0000, v8
  v_lshrrev_b32 v8, 23, v7
  v_subrev_u32 v8, 134, v8
  v_max_i32 v8, 0, v8
  v_cvt_u32_f32 v7, v7
  v_lshrrev_b32 v7, v8, v7
  v_lshl_add_u32 v7, v8, 8, v7
  v_lshl_add_u32 v231, v7, 2, s18
  v_subrev_u32 v6, 32, v5
  v_max_i32 v7, 0, v6
  v_cvt_f32_u32 v7, v7
  v_cvt_pk_bf16_f32 v8, v7, v7
  v_and_b32 v7, 0xffff0000, v8
  v_lshrrev_b32 v8, 23, v7
  v_subrev_u32 v8, 134, v8
  v_max_i32 v8, 0, v8
  v_cvt_u32_f32 v7, v7
  v_lshrrev_b32 v7, v8, v7
  v_lshl_add_u32 v7, v8, 8, v7
  v_mov_b32 v8, 1280
  v_cmp_gt_i32 vcc, 0, v6
  s_nop 1
  v_cndmask_b32 v7, v7, v8, vcc
  v_lshl_add_u32 v232, v7, 2, s18
  v_mov_b32 v8, 0
  v_mov_b32 v9, 0
  v_lshlrev_b32 v5, 3, v1
  v_add_u32 v5, s17, v5
  ds_write_b64 v5, v[8:9]
  v_and_b32 v6, 15, v1
  v_lshlrev_b32 v6, 3, v6
  v_add_u32 v6, s17, v6
  ds_write_b64 v6, v[8:9] offset:8704
  ds_write_b64 v6, v[8:9] offset:12928
  v_mov_b32 v6, s17
  ds_write_b64 v6, v[8:9] offset:18176
  s_lshl_b32 s19, s3, 2
  s_add_u32 s20, s19, s16
  s_lshl_b32 s21, s3, 3
  v_mul_u32_u24 v5, 3584, v0
  s_add_u32 s22, s21, 0
  buffer_load_dwordx2 v[8:9], v5, s[60:63], s22 offen offset:0
  buffer_load_dwordx2 v[10:11], v5, s[60:63], s22 offen offset:896
  buffer_load_dwordx2 v[12:13], v5, s[60:63], s22 offen offset:1792
  buffer_load_dwordx2 v[14:15], v5, s[60:63], s22 offen offset:2688
  s_add_u32 s22, s21, 917504
  buffer_load_dwordx2 v[16:17], v5, s[60:63], s22 offen offset:0
  buffer_load_dwordx2 v[18:19], v5, s[60:63], s22 offen offset:896
  buffer_load_dwordx2 v[20:21], v5, s[60:63], s22 offen offset:1792
  buffer_load_dwordx2 v[22:23], v5, s[60:63], s22 offen offset:2688
  s_lshl_b32 s22, s20, 9
  v_lshlrev_b32 v6, 3, v1
  buffer_load_dwordx2 v[24:25], v6, s[64:67], s22 offen
  buffer_load_dwordx2 v[26:27], v6, s[68:71], s22 offen
  buffer_load_dwordx2 v[28:29], v6, s[72:75], s22 offen
  buffer_load_dwordx2 v[30:31], v6, s[76:79], s22 offen
  s_lshl_b32 s22, s20, 1
  v_mov_b32 v7, 0
  buffer_load_ushort v32, v7, s[80:83], s22 offen
  buffer_load_ushort v33, v7, s[84:87], s22 offen
  s_mov_b32 s24, 0x05040100
  s_mov_b32 s25, 0x07060302
  s_barrier
  s_waitcnt vmcnt(6)
  v_lshlrev_b32 v6, 3, v0
  v_perm_b32 v34, v10, v8, s24
  v_perm_b32 v35, v14, v12, s24
  v_add_u32 v36, 512, v6
  ds_write_b64 v36, v[34:35]
  v_perm_b32 v34, v10, v8, s25
  v_perm_b32 v35, v14, v12, s25
  v_add_u32 v36, 25088, v6
  ds_write_b64 v36, v[34:35]
  v_perm_b32 v34, v11, v9, s24
  v_perm_b32 v35, v15, v13, s24
  v_add_u32 v36, 49664, v6
  ds_write_b64 v36, v[34:35]
  v_perm_b32 v34, v11, v9, s25
  v_perm_b32 v35, v15, v13, s25
  v_add_u32 v36, 74240, v6
  ds_write_b64 v36, v[34:35]
  v_perm_b32 v34, v18, v16, s24
  v_perm_b32 v35, v22, v20, s24
  v_add_u32 v36, 2560, v6
  ds_write_b64 v36, v[34:35]
  v_perm_b32 v34, v18, v16, s25
  v_perm_b32 v35, v22, v20, s25
  v_add_u32 v36, 27136, v6
  ds_write_b64 v36, v[34:35]
  v_perm_b32 v34, v19, v17, s24
  v_perm_b32 v35, v23, v21, s24
  v_add_u32 v36, 51712, v6
  ds_write_b64 v36, v[34:35]
  v_perm_b32 v34, v19, v17, s25
  v_perm_b32 v35, v23, v21, s25
  v_add_u32 v36, 76288, v6
  ds_write_b64 v36, v[34:35]
  s_waitcnt vmcnt(0)
  s_mov_b32 s26, 1069066811
  s_mov_b32 s27, 1042479491
  v_lshlrev_b32 v32, 16, v32
  v_lshlrev_b32 v33, 16, v33
  v_mul_f32 v32, s26, v32
  v_exp_f32 v32, v32
  s_nop 0
  v_cvt_pk_bf16_f32 v34, v32, v32
  v_and_b32 v32, 0xffff0000, v34
  v_lshlrev_b32 v37, 6, v1
  v_add_u32 v37, s17, v37
  v_lshlrev_b32 v40, 16, v24
  v_lshlrev_b32 v41, 16, v26
  v_lshlrev_b32 v42, 16, v28
  v_lshlrev_b32 v43, 16, v30
  v_mul_f32 v40, s26, v40
  v_exp_f32 v40, v40
  s_nop 0
  v_cvt_pk_bf16_f32 v34, v40, v40
  v_and_b32 v40, 0xffff0000, v34
  v_mul_f32 v40, v40, v32
  v_mul_f32 v40, s26, v40
  v_sub_f32 v40, 0, v40
  v_mul_f32 v41, v41, v32
  v_mul_f32 v41, s27, v41
  v_mul_f32 v42, v42, v32
  v_mul_f32 v43, v43, v32
  v_add_f32 v42, v42, v42
  v_add_f32 v43, v43, v43
  ds_write_b128 v37, v[40:43] offset:18240
  v_and_b32 v40, 0xffff0000, v24
  v_and_b32 v41, 0xffff0000, v26
  v_and_b32 v42, 0xffff0000, v28
  v_and_b32 v43, 0xffff0000, v30
  v_mul_f32 v40, s26, v40
  v_exp_f32 v40, v40
  s_nop 0
  v_cvt_pk_bf16_f32 v34, v40, v40
  v_and_b32 v40, 0xffff0000, v34
  v_mul_f32 v40, v40, v32
  v_mul_f32 v40, s26, v40
  v_sub_f32 v40, 0, v40
  v_mul_f32 v41, v41, v32
  v_mul_f32 v41, s27, v41
  v_mul_f32 v42, v42, v32
  v_mul_f32 v43, v43, v32
  v_add_f32 v42, v42, v42
  v_add_f32 v43, v43, v43
  ds_write_b128 v37, v[40:43] offset:18256
  v_lshlrev_b32 v40, 16, v25
  v_lshlrev_b32 v41, 16, v27
  v_lshlrev_b32 v42, 16, v29
  v_lshlrev_b32 v43, 16, v31
  v_mul_f32 v40, s26, v40
  v_exp_f32 v40, v40
  s_nop 0
  v_cvt_pk_bf16_f32 v34, v40, v40
  v_and_b32 v40, 0xffff0000, v34
  v_mul_f32 v40, v40, v32
  v_mul_f32 v40, s26, v40
  v_sub_f32 v40, 0, v40
  v_mul_f32 v41, v41, v32
  v_mul_f32 v41, s27, v41
  v_mul_f32 v42, v42, v32
  v_mul_f32 v43, v43, v32
  v_add_f32 v42, v42, v42
  v_add_f32 v43, v43, v43
  ds_write_b128 v37, v[40:43] offset:18272
  v_and_b32 v40, 0xffff0000, v25
  v_and_b32 v41, 0xffff0000, v27
  v_and_b32 v42, 0xffff0000, v29
  v_and_b32 v43, 0xffff0000, v31
  v_mul_f32 v40, s26, v40
  v_exp_f32 v40, v40
  s_nop 0
  v_cvt_pk_bf16_f32 v34, v40, v40
  v_and_b32 v40, 0xffff0000, v34
  v_mul_f32 v40, v40, v32
  v_mul_f32 v40, s26, v40
  v_sub_f32 v40, 0, v40
  v_mul_f32 v41, v41, v32
  v_mul_f32 v41, s27, v41
  v_mul_f32 v42, v42, v32
  v_mul_f32 v43, v43, v32
  v_add_f32 v42, v42, v42
  v_add_f32 v43, v43, v43
  ds_write_b128 v37, v[40:43] offset:18288
  v_cvt_f32_u32 v44, v4
  v_lshlrev_b32 v45, 4, v4
  v_cvt_f32_u32 v45, v45
  v_lshlrev_b32 v46, 4, v3
  v_add_u32 v46, s17, v46
  v_mov_b32 v48, 0
  v_mov_b32 v49, 0
  v_mov_b32 v50, 0
  v_mov_b32 v51, 0
  v_mov_b32 v52, 0
  v_mov_b32 v53, 0
  v_mov_b32 v54, 0
  v_mov_b32 v55, 0
  v_mov_b32 v56, 0
  v_mov_b32 v57, 0
  v_mov_b32 v58, 0
  v_mov_b32 v59, 0
  v_mov_b32 v60, 0
  v_mov_b32 v61, 0
  v_mov_b32 v62, 0
  v_mov_b32 v63, 0
  v_mov_b32 v64, 0
  v_mov_b32 v65, 0
  v_mov_b32 v66, 0
  v_mov_b32 v67, 0
  s_mov_b32 s28, 0
  s_waitcnt lgkmcnt(0)
  ds_read_b128 v[68:71], v46 offset:18240
wk_kl:
  s_waitcnt lgkmcnt(0)
  v_mov_b32 v72, v68
  v_mov_b32 v73, v69
  v_mov_b32 v74, v70
  v_mov_b32 v75, v71
  v_add_u32 v46, 64, v46
  ds_read_b128 v[68:71], v46 offset:18240
  v_mul_f32 v80, v72, v45
  v_mul_f32 v81, v73, v45
  v_exp_f32 v80, v80
  v_fract_f32 v81, v81
  v_cos_f32 v76, v81
  v_sin_f32 v77, v81
  v_mul_f32 v76, v76, v80
  v_mul_f32 v77, v77, v80
  v_mul_f32 v80, v72, v44
  v_mul_f32 v81, v73, v44
  v_exp_f32 v80, v80
  v_fract_f32 v81, v81
  v_cos_f32 v78, v81
  v_sin_f32 v79, v81
  v_mul_f32 v78, v78, v80
  v_mul_f32 v79, v79, v80
  v_mul_f32 v82, v74, v76
  v_mul_f32 v83, v74, v77
  v_fma_f32 v82, -v75, v77, v82
  v_fma_f32 v83, -v75, v76, -v83
  v_mul_f32 v86, v76, v76
  v_mul_f32 v87, v76, v77
  v_fma_f32 v86, -v77, v77, v86
  v_add_f32 v87, v87, v87
  v_mfma_f32_16x16x4_f32 v[48:51], v82, v78, v[48:51]
  v_mul_f32 v88, v78, v78
  v_mul_f32 v89, v78, v79
  v_fma_f32 v88, -v79, v79, v88
  v_add_f32 v89, v89, v89
  v_mfma_f32_16x16x4_f32 v[48:51], v83, v79, v[48:51]
  v_mul_f32 v84, v74, v86
  v_mul_f32 v85, v74, v87
  v_fma_f32 v84, -v75, v87, v84
  v_fma_f32 v85, -v75, v86, -v85
  v_mul_f32 v76, v86, v86
  v_mul_f32 v77, v86, v87
  v_fma_f32 v76, -v87, v87, v76
  v_add_f32 v77, v77, v77
  v_mfma_f32_16x16x4_f32 v[52:55], v84, v88, v[52:55]
  v_mul_f32 v78, v88, v88
  v_mul_f32 v79, v88, v89
  v_fma_f32 v78, -v89, v89, v78
  v_add_f32 v79, v79, v79
  v_mfma_f32_16x16x4_f32 v[52:55], v85, v89, v[52:55]
  v_mul_f32 v82, v74, v76
  v_mul_f32 v83, v74, v77
  v_fma_f32 v82, -v75, v77, v82
  v_fma_f32 v83, -v75, v76, -v83
  v_mul_f32 v86, v76, v76
  v_mul_f32 v87, v76, v77
  v_fma_f32 v86, -v77, v77, v86
  v_add_f32 v87, v87, v87
  v_mfma_f32_16x16x4_f32 v[56:59], v82, v78, v[56:59]
  v_mul_f32 v88, v78, v78
  v_mul_f32 v89, v78, v79
  v_fma_f32 v88, -v79, v79, v88
  v_add_f32 v89, v89, v89
  v_mfma_f32_16x16x4_f32 v[56:59], v83, v79, v[56:59]
  v_mul_f32 v84, v74, v86
  v_mul_f32 v85, v74, v87
  v_fma_f32 v84, -v75, v87, v84
  v_fma_f32 v85, -v75, v86, -v85
  v_mul_f32 v76, v86, v86
  v_mul_f32 v77, v86, v87
  v_fma_f32 v76, -v87, v87, v76
  v_add_f32 v77, v77, v77
  v_mfma_f32_16x16x4_f32 v[60:63], v84, v88, v[60:63]
  v_mfma_f32_16x16x4_f32 v[60:63], v85, v89, v[60:63]
  v_mul_f32 v82, v74, v76
  v_fma_f32 v82, -v75, v77, v82
  s_nop 1
  v_mfma_f32_16x16x4_f32 v[64:67], v82, v88, v[64:67]
  s_add_u32 s28, s28, 1
  s_cmp_lt_u32 s28, 64
  s_cbranch_scc1 wk_kl
  s_nop 15
  s_nop 3
  v_lshlrev_b32 v46, 8, v3
  v_lshl_add_u32 v46, v4, 2, v46
  v_add_u32 v46, s17, v46
  ds_write_b32 v46, v48 offset:13056
  ds_write_b32 v46, v49 offset:13120
  ds_write_b32 v46, v50 offset:13184
  ds_write_b32 v46, v51 offset:13248
  s_waitcnt lgkmcnt(8)
  ds_write_b32 v46, v52 offset:14080
  ds_write_b32 v46, v53 offset:14144
  ds_write_b32 v46, v54 offset:14208
  ds_write_b32 v46, v55 offset:14272
  s_waitcnt lgkmcnt(8)
  ds_write_b32 v46, v56 offset:15104
  ds_write_b32 v46, v57 offset:15168
  ds_write_b32 v46, v58 offset:15232
  ds_write_b32 v46, v59 offset:15296
  s_waitcnt lgkmcnt(8)
  ds_write_b32 v46, v60 offset:16128
  ds_write_b32 v46, v61 offset:16192
  ds_write_b32 v46, v62 offset:16256
  ds_write_b32 v46, v63 offset:16320
  s_waitcnt lgkmcnt(8)
  ds_write_b32 v46, v64 offset:17152
  ds_write_b32 v46, v65 offset:17216
  ds_write_b32 v46, v66 offset:17280
  ds_write_b32 v46, v67 offset:17344
  s_waitcnt lgkmcnt(8)
  s_waitcnt lgkmcnt(0)
  ds_read_b32 v48, v200
  ds_read_b32 v49, v201
  ds_read_b32 v50, v202
  ds_read_b32 v51, v203
  ds_read_b32 v52, v204
  ds_read_b32 v53, v205
  ds_read_b32 v54, v206
  ds_read_b32 v55, v207
  s_waitcnt lgkmcnt(4)
  ds_read_b32 v56, v208
  ds_read_b32 v57, v209
  ds_read_b32 v58, v210
  ds_read_b32 v59, v211
  ds_read_b32 v60, v212
  ds_read_b32 v61, v213
  ds_read_b32 v62, v214
  ds_read_b32 v63, v215
  s_waitcnt lgkmcnt(4)
  ds_read_b32 v64, v216
  ds_read_b32 v65, v217
  ds_read_b32 v66, v218
  ds_read_b32 v67, v219
  ds_read_b32 v68, v220
  ds_read_b32 v69, v221
  ds_read_b32 v70, v222
  ds_read_b32 v71, v223
  s_waitcnt lgkmcnt(4)
  ds_read_b32 v72, v224
  ds_read_b32 v73, v225
  ds_read_b32 v74, v226
  ds_read_b32 v75, v227
  ds_read_b32 v76, v228
  ds_read_b32 v77, v229
  ds_read_b32 v78, v230
  ds_read_b32 v79, v231
  s_waitcnt lgkmcnt(4)
  ds_read_b32 v80, v232
  s_waitcnt lgkmcnt(0)
  v_lshlrev_b32 v46, 6, v1
  v_add_u32 v46, s17, v46
  v_cvt_pk_bf16_f32 v84, v48, v49
  v_cvt_pk_bf16_f32 v88, v49, v50
  v_cvt_pk_bf16_f32 v85, v50, v51
  v_cvt_pk_bf16_f32 v89, v51, v52
  v_cvt_pk_bf16_f32 v86, v52, v53
  v_cvt_pk_bf16_f32 v90, v53, v54
  v_cvt_pk_bf16_f32 v87, v54, v55
  v_cvt_pk_bf16_f32 v91, v55, v56
  ds_write_b128 v46, v[84:87] offset:4608
  ds_write_b128 v46, v[88:91] offset:8832
  s_waitcnt lgkmcnt(0)
  v_cvt_pk_bf16_f32 v84, v56, v57
  v_cvt_pk_bf16_f32 v88, v57, v58
  v_cvt_pk_bf16_f32 v85, v58, v59
  v_cvt_pk_bf16_f32 v89, v59, v60
  v_cvt_pk_bf16_f32 v86, v60, v61
  v_cvt_pk_bf16_f32 v90, v61, v62
  v_cvt_pk_bf16_f32 v87, v62, v63
  v_cvt_pk_bf16_f32 v91, v63, v64
  ds_write_b128 v46, v[84:87] offset:4624
  ds_write_b128 v46, v[88:91] offset:8848
  s_waitcnt lgkmcnt(0)
  v_cvt_pk_bf16_f32 v84, v64, v65
  v_cvt_pk_bf16_f32 v88, v65, v66
  v_cvt_pk_bf16_f32 v85, v66, v67
  v_cvt_pk_bf16_f32 v89, v67, v68
  v_cvt_pk_bf16_f32 v86, v68, v69
  v_cvt_pk_bf16_f32 v90, v69, v70
  v_cvt_pk_bf16_f32 v87, v70, v71
  v_cvt_pk_bf16_f32 v91, v71, v72
  ds_write_b128 v46, v[84:87] offset:4640
  ds_write_b128 v46, v[88:91] offset:8864
  s_waitcnt lgkmcnt(0)
  v_cvt_pk_bf16_f32 v84, v72, v73
  v_cvt_pk_bf16_f32 v88, v73, v74
  v_cvt_pk_bf16_f32 v85, v74, v75
  v_cvt_pk_bf16_f32 v89, v75, v76
  v_cvt_pk_bf16_f32 v86, v76, v77
  v_cvt_pk_bf16_f32 v90, v77, v78
  v_cvt_pk_bf16_f32 v87, v78, v79
  v_cvt_pk_bf16_f32 v91, v79, v80
  ds_write_b128 v46, v[84:87] offset:4656
  ds_write_b128 v46, v[88:91] offset:8880
  s_waitcnt lgkmcnt(0)
  s_barrier
  v_lshrrev_b32 v47, 1, v3
  v_sub_u32 v46, v4, v47
  v_add_u32 v46, 1, v46
  v_lshlrev_b32 v46, 5, v46
  v_and_b32 v48, 1, v3
  v_lshl_add_u32 v46, v48, 4, v46
  v_add_u32 v46, s17, v46
  ds_read_b128 a[0:3], v46 offset:32
  ds_read_b128 a[4:7], v46 offset:96
  ds_read_b128 a[8:11], v46 offset:160
  ds_read_b128 a[12:15], v46 offset:224
  ds_read_b128 a[16:19], v46 offset:288
  ds_read_b128 a[20:23], v46 offset:352
  ds_read_b128 a[24:27], v46 offset:416
  ds_read_b128 a[28:31], v46 offset:480
  s_waitcnt lgkmcnt(4)
  ds_read_b128 a[32:35], v46 offset:544
  ds_read_b128 a[36:39], v46 offset:608
  ds_read_b128 a[40:43], v46 offset:672
  ds_read_b128 a[44:47], v46 offset:736
  ds_read_b128 a[48:51], v46 offset:800
  ds_read_b128 a[52:55], v46 offset:864
  ds_read_b128 a[56:59], v46 offset:928
  ds_read_b128 a[60:63], v46 offset:992
  s_waitcnt lgkmcnt(4)
  ds_read_b128 a[64:67], v46 offset:1056
  ds_read_b128 a[68:71], v46 offset:1120
  ds_read_b128 a[72:75], v46 offset:1184
  ds_read_b128 a[76:79], v46 offset:1248
  ds_read_b128 a[80:83], v46 offset:1312
  ds_read_b128 a[84:87], v46 offset:1376
  ds_read_b128 a[88:91], v46 offset:1440
  ds_read_b128 a[92:95], v46 offset:1504
  s_waitcnt lgkmcnt(4)
  ds_read_b128 a[96:99], v46 offset:1568
  ds_read_b128 a[100:103], v46 offset:1632
  ds_read_b128 a[104:107], v46 offset:1696
  ds_read_b128 a[108:111], v46 offset:1760
  ds_read_b128 a[112:115], v46 offset:1824
  ds_read_b128 a[116:119], v46 offset:1888
  ds_read_b128 a[120:123], v46 offset:1952
  ds_read_b128 a[124:127], v46 offset:2016
  s_waitcnt lgkmcnt(4)
  ds_read_b128 a[128:131], v46 offset:2080
  ds_read_b128 a[132:135], v46 offset:2144
  ds_read_b128 a[136:139], v46 offset:2208
  ds_read_b128 a[140:143], v46 offset:2272
  ds_read_b128 a[144:147], v46 offset:2336
  ds_read_b128 a[148:151], v46 offset:2400
  ds_read_b128 a[152:155], v46 offset:2464
  ds_read_b128 a[156:159], v46 offset:2528
  s_waitcnt lgkmcnt(4)
  ds_read_b128 a[160:163], v46 offset:2592
  ds_read_b128 a[164:167], v46 offset:2656
  ds_read_b128 a[168:171], v46 offset:2720
  ds_read_b128 a[172:175], v46 offset:2784
  ds_read_b128 a[176:179], v46 offset:2848
  ds_read_b128 a[180:183], v46 offset:2912
  ds_read_b128 a[184:187], v46 offset:2976
  ds_read_b128 a[188:191], v46 offset:3040
  s_waitcnt lgkmcnt(4)
  ds_read_b128 a[192:195], v46 offset:3104
  ds_read_b128 a[196:199], v46 offset:3168
  ds_read_b128 a[200:203], v46 offset:3232
  ds_read_b128 a[204:207], v46 offset:3296
  ds_read_b128 a[208:211], v46 offset:3360
  ds_read_b128 a[212:215], v46 offset:3424
  ds_read_b128 a[216:219], v46 offset:3488
  ds_read_b128 a[220:223], v46 offset:3552
  s_waitcnt lgkmcnt(4)
  ds_read_b128 a[224:227], v46 offset:3616
  ds_read_b128 a[228:231], v46 offset:3680
  ds_read_b128 a[232:235], v46 offset:3744
  ds_read_b128 a[236:239], v46 offset:3808
  ds_read_b128 a[240:243], v46 offset:3872
  ds_read_b128 a[244:247], v46 offset:3936
  ds_read_b128 a[248:251], v46 offset:4000
  ds_read_b128 a[252:255], v46 offset:4064
  s_waitcnt lgkmcnt(4)
  v_lshlrev_b32 v49, 4, v47
  v_add_u32 v49, v49, v4
  v_sub_u32 v49, 2047, v49
  v_lshl_add_u32 v49, v48, 3, v49
  v_and_b32 v50, 1, v49
  v_lshrrev_b32 v49, 1, v49
  v_lshlrev_b32 v49, 2, v49
  v_mul_u32_u24 v50, 4224, v50
  v_add3_u32 v49, v49, v50, s17
  v_add_u32 v49, 4608, v49
  v_subrev_u32 v52, 896, v49
  v_subrev_u32 v53, 1856, v49
  v_subrev_u32 v54, 2816, v49
  v_subrev_u32 v55, 3776, v49
  v_subrev_u32 v56, 4736, v49
  s_waitcnt lgkmcnt(0)
  ds_read2_b32 v[92:93], v52 offset0:224 offset1:225
  ds_read2_b32 v[94:95], v52 offset0:226 offset1:227
  ds_read2_b32 v[96:97], v52 offset0:208 offset1:209
  ds_read2_b32 v[98:99], v52 offset0:210 offset1:211
  ds_read2_b32 v[100:101], v52 offset0:192 offset1:193
  ds_read2_b32 v[102:103], v52 offset0:194 offset1:195
  ds_read2_b32 v[104:105], v52 offset0:176 offset1:177
  ds_read2_b32 v[106:107], v52 offset0:178 offset1:179
  s_waitcnt lgkmcnt(6)
  v_mfma_f32_16x16x32_bf16 v[60:63], v[92:95], a[28:31], 0
  v_mfma_f32_16x16x32_bf16 v[64:67], v[92:95], a[60:63], 0
  v_mfma_f32_16x16x32_bf16 v[68:71], v[92:95], a[92:95], 0
  v_mfma_f32_16x16x32_bf16 v[72:75], v[92:95], a[124:127], 0
  v_mfma_f32_16x16x32_bf16 v[76:79], v[92:95], a[156:159], 0
  v_mfma_f32_16x16x32_bf16 v[80:83], v[92:95], a[188:191], 0
  v_mfma_f32_16x16x32_bf16 v[84:87], v[92:95], a[220:223], 0
  v_mfma_f32_16x16x32_bf16 v[88:91], v[92:95], a[252:255], 0
  ds_read2_b32 v[92:93], v52 offset0:160 offset1:161
  ds_read2_b32 v[94:95], v52 offset0:162 offset1:163
  s_waitcnt lgkmcnt(6)
  v_mfma_f32_16x16x32_bf16 v[60:63], v[96:99], a[24:27], v[60:63]
  v_mfma_f32_16x16x32_bf16 v[64:67], v[96:99], a[56:59], v[64:67]
  v_mfma_f32_16x16x32_bf16 v[68:71], v[96:99], a[88:91], v[68:71]
  v_mfma_f32_16x16x32_bf16 v[72:75], v[96:99], a[120:123], v[72:75]
  v_mfma_f32_16x16x32_bf16 v[76:79], v[96:99], a[152:155], v[76:79]
  v_mfma_f32_16x16x32_bf16 v[80:83], v[96:99], a[184:187], v[80:83]
  v_mfma_f32_16x16x32_bf16 v[84:87], v[96:99], a[216:219], v[84:87]
  v_mfma_f32_16x16x32_bf16 v[88:91], v[96:99], a[248:251], v[88:91]
  ds_read2_b32 v[96:97], v52 offset0:144 offset1:145
  ds_read2_b32 v[98:99], v52 offset0:146 offset1:147
  s_waitcnt lgkmcnt(6)
  v_mfma_f32_16x16x32_bf16 v[60:63], v[100:103], a[20:23], v[60:63]
  v_mfma_f32_16x16x32_bf16 v[64:67], v[100:103], a[52:55], v[64:67]
  v_mfma_f32_16x16x32_bf16 v[68:71], v[100:103], a[84:87], v[68:71]
  v_mfma_f32_16x16x32_bf16 v[72:75], v[100:103], a[116:119], v[72:75]
  v_mfma_f32_16x16x32_bf16 v[76:79], v[100:103], a[148:151], v[76:79]
  v_mfma_f32_16x16x32_bf16 v[80:83], v[100:103], a[180:183], v[80:83]
  v_mfma_f32_16x16x32_bf16 v[84:87], v[100:103], a[212:215], v[84:87]
  v_mfma_f32_16x16x32_bf16 v[88:91], v[100:103], a[244:247], v[88:91]
  ds_read2_b32 v[100:101], v52 offset0:128 offset1:129
  ds_read2_b32 v[102:103], v52 offset0:130 offset1:131
  s_waitcnt lgkmcnt(6)
  v_mfma_f32_16x16x32_bf16 v[60:63], v[104:107], a[16:19], v[60:63]
  v_mfma_f32_16x16x32_bf16 v[64:67], v[104:107], a[48:51], v[64:67]
  v_mfma_f32_16x16x32_bf16 v[68:71], v[104:107], a[80:83], v[68:71]
  v_mfma_f32_16x16x32_bf16 v[72:75], v[104:107], a[112:115], v[72:75]
  v_mfma_f32_16x16x32_bf16 v[76:79], v[104:107], a[144:147], v[76:79]
  v_mfma_f32_16x16x32_bf16 v[80:83], v[104:107], a[176:179], v[80:83]
  v_mfma_f32_16x16x32_bf16 v[84:87], v[104:107], a[208:211], v[84:87]
  v_mfma_f32_16x16x32_bf16 v[88:91], v[104:107], a[240:243], v[88:91]
  ds_read2_b32 v[104:105], v52 offset0:112 offset1:113
  ds_read2_b32 v[106:107], v52 offset0:114 offset1:115
  s_waitcnt lgkmcnt(6)
  v_mfma_f32_16x16x32_bf16 v[60:63], v[92:95], a[12:15], v[60:63]
  v_mfma_f32_16x16x32_bf16 v[64:67], v[92:95], a[44:47], v[64:67]
  v_mfma_f32_16x16x32_bf16 v[68:71], v[92:95], a[76:79], v[68:71]
  v_mfma_f32_16x16x32_bf16 v[72:75], v[92:95], a[108:111], v[72:75]
  v_mfma_f32_16x16x32_bf16 v[76:79], v[92:95], a[140:143], v[76:79]
  v_mfma_f32_16x16x32_bf16 v[80:83], v[92:95], a[172:175], v[80:83]
  v_mfma_f32_16x16x32_bf16 v[84:87], v[92:95], a[204:207], v[84:87]
  v_mfma_f32_16x16x32_bf16 v[88:91], v[92:95], a[236:239], v[88:91]
  ds_read2_b32 v[92:93], v52 offset0:96 offset1:97
  ds_read2_b32 v[94:95], v52 offset0:98 offset1:99
  s_waitcnt lgkmcnt(6)
  v_mfma_f32_16x16x32_bf16 v[60:63], v[96:99], a[8:11], v[60:63]
  v_mfma_f32_16x16x32_bf16 v[64:67], v[96:99], a[40:43], v[64:67]
  v_mfma_f32_16x16x32_bf16 v[68:71], v[96:99], a[72:75], v[68:71]
  v_mfma_f32_16x16x32_bf16 v[72:75], v[96:99], a[104:107], v[72:75]
  v_mfma_f32_16x16x32_bf16 v[76:79], v[96:99], a[136:139], v[76:79]
  v_mfma_f32_16x16x32_bf16 v[80:83], v[96:99], a[168:171], v[80:83]
  v_mfma_f32_16x16x32_bf16 v[84:87], v[96:99], a[200:203], v[84:87]
  v_mfma_f32_16x16x32_bf16 v[88:91], v[96:99], a[232:235], v[88:91]
  ds_read2_b32 v[96:97], v52 offset0:80 offset1:81
  ds_read2_b32 v[98:99], v52 offset0:82 offset1:83
  s_waitcnt lgkmcnt(6)
  v_mfma_f32_16x16x32_bf16 v[60:63], v[100:103], a[4:7], v[60:63]
  v_mfma_f32_16x16x32_bf16 v[64:67], v[100:103], a[36:39], v[64:67]
  v_mfma_f32_16x16x32_bf16 v[68:71], v[100:103], a[68:71], v[68:71]
  v_mfma_f32_16x16x32_bf16 v[72:75], v[100:103], a[100:103], v[72:75]
  v_mfma_f32_16x16x32_bf16 v[76:79], v[100:103], a[132:135], v[76:79]
  v_mfma_f32_16x16x32_bf16 v[80:83], v[100:103], a[164:167], v[80:83]
  v_mfma_f32_16x16x32_bf16 v[84:87], v[100:103], a[196:199], v[84:87]
  v_mfma_f32_16x16x32_bf16 v[88:91], v[100:103], a[228:231], v[88:91]
  ds_read2_b32 v[100:101], v52 offset0:64 offset1:65
  ds_read2_b32 v[102:103], v52 offset0:66 offset1:67
  s_waitcnt lgkmcnt(6)
  v_mfma_f32_16x16x32_bf16 v[60:63], v[104:107], a[0:3], v[60:63]
  v_mfma_f32_16x16x32_bf16 v[64:67], v[104:107], a[32:35], v[64:67]
  v_mfma_f32_16x16x32_bf16 v[68:71], v[104:107], a[64:67], v[68:71]
  v_mfma_f32_16x16x32_bf16 v[72:75], v[104:107], a[96:99], v[72:75]
  v_mfma_f32_16x16x32_bf16 v[76:79], v[104:107], a[128:131], v[76:79]
  v_mfma_f32_16x16x32_bf16 v[80:83], v[104:107], a[160:163], v[80:83]
  v_mfma_f32_16x16x32_bf16 v[84:87], v[104:107], a[192:195], v[84:87]
  v_mfma_f32_16x16x32_bf16 v[88:91], v[104:107], a[224:227], v[88:91]
  ds_read2_b32 v[104:105], v52 offset0:48 offset1:49
  ds_read2_b32 v[106:107], v52 offset0:50 offset1:51
  s_waitcnt lgkmcnt(6)
  v_mfma_f32_16x16x32_bf16 v[64:67], v[92:95], a[28:31], v[64:67]
  v_mfma_f32_16x16x32_bf16 v[68:71], v[92:95], a[60:63], v[68:71]
  v_mfma_f32_16x16x32_bf16 v[72:75], v[92:95], a[92:95], v[72:75]
  v_mfma_f32_16x16x32_bf16 v[76:79], v[92:95], a[124:127], v[76:79]
  v_mfma_f32_16x16x32_bf16 v[80:83], v[92:95], a[156:159], v[80:83]
  v_mfma_f32_16x16x32_bf16 v[84:87], v[92:95], a[188:191], v[84:87]
  v_mfma_f32_16x16x32_bf16 v[88:91], v[92:95], a[220:223], v[88:91]
  ds_read2_b32 v[92:93], v52 offset0:32 offset1:33
  ds_read2_b32 v[94:95], v52 offset0:34 offset1:35
  s_waitcnt lgkmcnt(6)
  v_mfma_f32_16x16x32_bf16 v[64:67], v[96:99], a[24:27], v[64:67]
  v_mfma_f32_16x16x32_bf16 v[68:71], v[96:99], a[56:59], v[68:71]
  v_mfma_f32_16x16x32_bf16 v[72:75], v[96:99], a[88:91], v[72:75]
  v_mfma_f32_16x16x32_bf16 v[76:79], v[96:99], a[120:123], v[76:79]
  v_mfma_f32_16x16x32_bf16 v[80:83], v[96:99], a[152:155], v[80:83]
  v_mfma_f32_16x16x32_bf16 v[84:87], v[96:99], a[184:187], v[84:87]
  v_mfma_f32_16x16x32_bf16 v[88:91], v[96:99], a[216:219], v[88:91]
  ds_read2_b32 v[96:97], v52 offset0:16 offset1:17
  ds_read2_b32 v[98:99], v52 offset0:18 offset1:19
  s_waitcnt lgkmcnt(6)
  v_mfma_f32_16x16x32_bf16 v[64:67], v[100:103], a[20:23], v[64:67]
  v_mfma_f32_16x16x32_bf16 v[68:71], v[100:103], a[52:55], v[68:71]
  v_mfma_f32_16x16x32_bf16 v[72:75], v[100:103], a[84:87], v[72:75]
  v_mfma_f32_16x16x32_bf16 v[76:79], v[100:103], a[116:119], v[76:79]
  v_mfma_f32_16x16x32_bf16 v[80:83], v[100:103], a[148:151], v[80:83]
  v_mfma_f32_16x16x32_bf16 v[84:87], v[100:103], a[180:183], v[84:87]
  v_mfma_f32_16x16x32_bf16 v[88:91], v[100:103], a[212:215], v[88:91]
  ds_read2_b32 v[100:101], v52 offset0:0 offset1:1
  ds_read2_b32 v[102:103], v52 offset0:2 offset1:3
  s_waitcnt lgkmcnt(6)
  v_mfma_f32_16x16x32_bf16 v[64:67], v[104:107], a[16:19], v[64:67]
  v_mfma_f32_16x16x32_bf16 v[68:71], v[104:107], a[48:51], v[68:71]
  v_mfma_f32_16x16x32_bf16 v[72:75], v[104:107], a[80:83], v[72:75]
  v_mfma_f32_16x16x32_bf16 v[76:79], v[104:107], a[112:115], v[76:79]
  v_mfma_f32_16x16x32_bf16 v[80:83], v[104:107], a[144:147], v[80:83]
  v_mfma_f32_16x16x32_bf16 v[84:87], v[104:107], a[176:179], v[84:87]
  v_mfma_f32_16x16x32_bf16 v[88:91], v[104:107], a[208:211], v[88:91]
  ds_read2_b32 v[104:105], v53 offset0:224 offset1:225
  ds_read2_b32 v[106:107], v53 offset0:226 offset1:227
  s_waitcnt lgkmcnt(6)
  v_mfma_f32_16x16x32_bf16 v[64:67], v[92:95], a[12:15], v[64:67]
  v_mfma_f32_16x16x32_bf16 v[68:71], v[92:95], a[44:47], v[68:71]
  v_mfma_f32_16x16x32_bf16 v[72:75], v[92:95], a[76:79], v[72:75]
  v_mfma_f32_16x16x32_bf16 v[76:79], v[92:95], a[108:111], v[76:79]
  v_mfma_f32_16x16x32_bf16 v[80:83], v[92:95], a[140:143], v[80:83]
  v_mfma_f32_16x16x32_bf16 v[84:87], v[92:95], a[172:175], v[84:87]
  v_mfma_f32_16x16x32_bf16 v[88:91], v[92:95], a[204:207], v[88:91]
  ds_read2_b32 v[92:93], v53 offset0:208 offset1:209
  ds_read2_b32 v[94:95], v53 offset0:210 offset1:211
  s_waitcnt lgkmcnt(6)
  v_mfma_f32_16x16x32_bf16 v[64:67], v[96:99], a[8:11], v[64:67]
  v_mfma_f32_16x16x32_bf16 v[68:71], v[96:99], a[40:43], v[68:71]
  v_mfma_f32_16x16x32_bf16 v[72:75], v[96:99], a[72:75], v[72:75]
  v_mfma_f32_16x16x32_bf16 v[76:79], v[96:99], a[104:107], v[76:79]
  v_mfma_f32_16x16x32_bf16 v[80:83], v[96:99], a[136:139], v[80:83]
  v_mfma_f32_16x16x32_bf16 v[84:87], v[96:99], a[168:171], v[84:87]
  v_mfma_f32_16x16x32_bf16 v[88:91], v[96:99], a[200:203], v[88:91]
  ds_read2_b32 v[96:97], v53 offset0:192 offset1:193
  ds_read2_b32 v[98:99], v53 offset0:194 offset1:195
  s_waitcnt lgkmcnt(6)
  v_mfma_f32_16x16x32_bf16 v[64:67], v[100:103], a[4:7], v[64:67]
  v_mfma_f32_16x16x32_bf16 v[68:71], v[100:103], a[36:39], v[68:71]
  v_mfma_f32_16x16x32_bf16 v[72:75], v[100:103], a[68:71], v[72:75]
  v_mfma_f32_16x16x32_bf16 v[76:79], v[100:103], a[100:103], v[76:79]
  v_mfma_f32_16x16x32_bf16 v[80:83], v[100:103], a[132:135], v[80:83]
  v_mfma_f32_16x16x32_bf16 v[84:87], v[100:103], a[164:167], v[84:87]
  v_mfma_f32_16x16x32_bf16 v[88:91], v[100:103], a[196:199], v[88:91]
  ds_read2_b32 v[100:101], v53 offset0:176 offset1:177
  ds_read2_b32 v[102:103], v53 offset0:178 offset1:179
  s_waitcnt lgkmcnt(6)
  v_mfma_f32_16x16x32_bf16 v[64:67], v[104:107], a[0:3], v[64:67]
  v_mfma_f32_16x16x32_bf16 v[68:71], v[104:107], a[32:35], v[68:71]
  v_mfma_f32_16x16x32_bf16 v[72:75], v[104:107], a[64:67], v[72:75]
  v_mfma_f32_16x16x32_bf16 v[76:79], v[104:107], a[96:99], v[76:79]
  v_mfma_f32_16x16x32_bf16 v[80:83], v[104:107], a[128:131], v[80:83]
  v_mfma_f32_16x16x32_bf16 v[84:87], v[104:107], a[160:163], v[84:87]
  v_mfma_f32_16x16x32_bf16 v[88:91], v[104:107], a[192:195], v[88:91]
  ds_read2_b32 v[104:105], v53 offset0:160 offset1:161
  ds_read2_b32 v[106:107], v53 offset0:162 offset1:163
  s_waitcnt lgkmcnt(6)
  v_mfma_f32_16x16x32_bf16 v[68:71], v[92:95], a[28:31], v[68:71]
  v_mfma_f32_16x16x32_bf16 v[72:75], v[92:95], a[60:63], v[72:75]
  v_mfma_f32_16x16x32_bf16 v[76:79], v[92:95], a[92:95], v[76:79]
  v_mfma_f32_16x16x32_bf16 v[80:83], v[92:95], a[124:127], v[80:83]
  v_mfma_f32_16x16x32_bf16 v[84:87], v[92:95], a[156:159], v[84:87]
  v_mfma_f32_16x16x32_bf16 v[88:91], v[92:95], a[188:191], v[88:91]
  ds_read2_b32 v[92:93], v53 offset0:144 offset1:145
  ds_read2_b32 v[94:95], v53 offset0:146 offset1:147
  s_waitcnt lgkmcnt(6)
  v_mfma_f32_16x16x32_bf16 v[68:71], v[96:99], a[24:27], v[68:71]
  v_mfma_f32_16x16x32_bf16 v[72:75], v[96:99], a[56:59], v[72:75]
  v_mfma_f32_16x16x32_bf16 v[76:79], v[96:99], a[88:91], v[76:79]
  v_mfma_f32_16x16x32_bf16 v[80:83], v[96:99], a[120:123], v[80:83]
  v_mfma_f32_16x16x32_bf16 v[84:87], v[96:99], a[152:155], v[84:87]
  v_mfma_f32_16x16x32_bf16 v[88:91], v[96:99], a[184:187], v[88:91]
  ds_read2_b32 v[96:97], v53 offset0:128 offset1:129
  ds_read2_b32 v[98:99], v53 offset0:130 offset1:131
  s_waitcnt lgkmcnt(6)
  v_mfma_f32_16x16x32_bf16 v[68:71], v[100:103], a[20:23], v[68:71]
  v_mfma_f32_16x16x32_bf16 v[72:75], v[100:103], a[52:55], v[72:75]
  v_mfma_f32_16x16x32_bf16 v[76:79], v[100:103], a[84:87], v[76:79]
  v_mfma_f32_16x16x32_bf16 v[80:83], v[100:103], a[116:119], v[80:83]
  v_mfma_f32_16x16x32_bf16 v[84:87], v[100:103], a[148:151], v[84:87]
  v_mfma_f32_16x16x32_bf16 v[88:91], v[100:103], a[180:183], v[88:91]
  ds_read2_b32 v[100:101], v53 offset0:112 offset1:113
  ds_read2_b32 v[102:103], v53 offset0:114 offset1:115
  s_waitcnt lgkmcnt(6)
  v_mfma_f32_16x16x32_bf16 v[68:71], v[104:107], a[16:19], v[68:71]
  v_mfma_f32_16x16x32_bf16 v[72:75], v[104:107], a[48:51], v[72:75]
  v_mfma_f32_16x16x32_bf16 v[76:79], v[104:107], a[80:83], v[76:79]
  v_mfma_f32_16x16x32_bf16 v[80:83], v[104:107], a[112:115], v[80:83]
  v_mfma_f32_16x16x32_bf16 v[84:87], v[104:107], a[144:147], v[84:87]
  v_mfma_f32_16x16x32_bf16 v[88:91], v[104:107], a[176:179], v[88:91]
  ds_read2_b32 v[104:105], v53 offset0:96 offset1:97
  ds_read2_b32 v[106:107], v53 offset0:98 offset1:99
  s_waitcnt lgkmcnt(6)
  v_mfma_f32_16x16x32_bf16 v[68:71], v[92:95], a[12:15], v[68:71]
  v_mfma_f32_16x16x32_bf16 v[72:75], v[92:95], a[44:47], v[72:75]
  v_mfma_f32_16x16x32_bf16 v[76:79], v[92:95], a[76:79], v[76:79]
  v_mfma_f32_16x16x32_bf16 v[80:83], v[92:95], a[108:111], v[80:83]
  v_mfma_f32_16x16x32_bf16 v[84:87], v[92:95], a[140:143], v[84:87]
  v_mfma_f32_16x16x32_bf16 v[88:91], v[92:95], a[172:175], v[88:91]
  ds_read2_b32 v[92:93], v53 offset0:80 offset1:81
  ds_read2_b32 v[94:95], v53 offset0:82 offset1:83
  s_waitcnt lgkmcnt(6)
  v_mfma_f32_16x16x32_bf16 v[68:71], v[96:99], a[8:11], v[68:71]
  v_mfma_f32_16x16x32_bf16 v[72:75], v[96:99], a[40:43], v[72:75]
  v_mfma_f32_16x16x32_bf16 v[76:79], v[96:99], a[72:75], v[76:79]
  v_mfma_f32_16x16x32_bf16 v[80:83], v[96:99], a[104:107], v[80:83]
  v_mfma_f32_16x16x32_bf16 v[84:87], v[96:99], a[136:139], v[84:87]
  v_mfma_f32_16x16x32_bf16 v[88:91], v[96:99], a[168:171], v[88:91]
  ds_read2_b32 v[96:97], v53 offset0:64 offset1:65
  ds_read2_b32 v[98:99], v53 offset0:66 offset1:67
  s_waitcnt lgkmcnt(6)
  v_mfma_f32_16x16x32_bf16 v[68:71], v[100:103], a[4:7], v[68:71]
  v_mfma_f32_16x16x32_bf16 v[72:75], v[100:103], a[36:39], v[72:75]
  v_mfma_f32_16x16x32_bf16 v[76:79], v[100:103], a[68:71], v[76:79]
  v_mfma_f32_16x16x32_bf16 v[80:83], v[100:103], a[100:103], v[80:83]
  v_mfma_f32_16x16x32_bf16 v[84:87], v[100:103], a[132:135], v[84:87]
  v_mfma_f32_16x16x32_bf16 v[88:91], v[100:103], a[164:167], v[88:91]
  ds_read2_b32 v[100:101], v53 offset0:48 offset1:49
  ds_read2_b32 v[102:103], v53 offset0:50 offset1:51
  s_waitcnt lgkmcnt(6)
  v_mfma_f32_16x16x32_bf16 v[68:71], v[104:107], a[0:3], v[68:71]
  v_mfma_f32_16x16x32_bf16 v[72:75], v[104:107], a[32:35], v[72:75]
  v_mfma_f32_16x16x32_bf16 v[76:79], v[104:107], a[64:67], v[76:79]
  v_mfma_f32_16x16x32_bf16 v[80:83], v[104:107], a[96:99], v[80:83]
  v_mfma_f32_16x16x32_bf16 v[84:87], v[104:107], a[128:131], v[84:87]
  v_mfma_f32_16x16x32_bf16 v[88:91], v[104:107], a[160:163], v[88:91]
  ds_read2_b32 v[104:105], v53 offset0:32 offset1:33
  ds_read2_b32 v[106:107], v53 offset0:34 offset1:35
  s_waitcnt lgkmcnt(6)
  v_mfma_f32_16x16x32_bf16 v[72:75], v[92:95], a[28:31], v[72:75]
  v_mfma_f32_16x16x32_bf16 v[76:79], v[92:95], a[60:63], v[76:79]
  v_mfma_f32_16x16x32_bf16 v[80:83], v[92:95], a[92:95], v[80:83]
  v_mfma_f32_16x16x32_bf16 v[84:87], v[92:95], a[124:127], v[84:87]
  v_mfma_f32_16x16x32_bf16 v[88:91], v[92:95], a[156:159], v[88:91]
  ds_read2_b32 v[92:93], v53 offset0:16 offset1:17
  ds_read2_b32 v[94:95], v53 offset0:18 offset1:19
  s_waitcnt lgkmcnt(6)
  v_mfma_f32_16x16x32_bf16 v[72:75], v[96:99], a[24:27], v[72:75]
  v_mfma_f32_16x16x32_bf16 v[76:79], v[96:99], a[56:59], v[76:79]
  v_mfma_f32_16x16x32_bf16 v[80:83], v[96:99], a[88:91], v[80:83]
  v_mfma_f32_16x16x32_bf16 v[84:87], v[96:99], a[120:123], v[84:87]
  v_mfma_f32_16x16x32_bf16 v[88:91], v[96:99], a[152:155], v[88:91]
  ds_read2_b32 v[96:97], v53 offset0:0 offset1:1
  ds_read2_b32 v[98:99], v53 offset0:2 offset1:3
  s_waitcnt lgkmcnt(6)
  v_mfma_f32_16x16x32_bf16 v[72:75], v[100:103], a[20:23], v[72:75]
  v_mfma_f32_16x16x32_bf16 v[76:79], v[100:103], a[52:55], v[76:79]
  v_mfma_f32_16x16x32_bf16 v[80:83], v[100:103], a[84:87], v[80:83]
  v_mfma_f32_16x16x32_bf16 v[84:87], v[100:103], a[116:119], v[84:87]
  v_mfma_f32_16x16x32_bf16 v[88:91], v[100:103], a[148:151], v[88:91]
  ds_read2_b32 v[100:101], v54 offset0:224 offset1:225
  ds_read2_b32 v[102:103], v54 offset0:226 offset1:227
  s_waitcnt lgkmcnt(6)
  v_mfma_f32_16x16x32_bf16 v[72:75], v[104:107], a[16:19], v[72:75]
  v_mfma_f32_16x16x32_bf16 v[76:79], v[104:107], a[48:51], v[76:79]
  v_mfma_f32_16x16x32_bf16 v[80:83], v[104:107], a[80:83], v[80:83]
  v_mfma_f32_16x16x32_bf16 v[84:87], v[104:107], a[112:115], v[84:87]
  v_mfma_f32_16x16x32_bf16 v[88:91], v[104:107], a[144:147], v[88:91]
  ds_read2_b32 v[104:105], v54 offset0:208 offset1:209
  ds_read2_b32 v[106:107], v54 offset0:210 offset1:211
  s_waitcnt lgkmcnt(6)
  v_mfma_f32_16x16x32_bf16 v[72:75], v[92:95], a[12:15], v[72:75]
  v_mfma_f32_16x16x32_bf16 v[76:79], v[92:95], a[44:47], v[76:79]
  v_mfma_f32_16x16x32_bf16 v[80:83], v[92:95], a[76:79], v[80:83]
  v_mfma_f32_16x16x32_bf16 v[84:87], v[92:95], a[108:111], v[84:87]
  v_mfma_f32_16x16x32_bf16 v[88:91], v[92:95], a[140:143], v[88:91]
  ds_read2_b32 v[92:93], v54 offset0:192 offset1:193
  ds_read2_b32 v[94:95], v54 offset0:194 offset1:195
  s_waitcnt lgkmcnt(6)
  v_mfma_f32_16x16x32_bf16 v[72:75], v[96:99], a[8:11], v[72:75]
  v_mfma_f32_16x16x32_bf16 v[76:79], v[96:99], a[40:43], v[76:79]
  v_mfma_f32_16x16x32_bf16 v[80:83], v[96:99], a[72:75], v[80:83]
  v_mfma_f32_16x16x32_bf16 v[84:87], v[96:99], a[104:107], v[84:87]
  v_mfma_f32_16x16x32_bf16 v[88:91], v[96:99], a[136:139], v[88:91]
  ds_read2_b32 v[96:97], v54 offset0:176 offset1:177
  ds_read2_b32 v[98:99], v54 offset0:178 offset1:179
  s_waitcnt lgkmcnt(6)
  v_mfma_f32_16x16x32_bf16 v[72:75], v[100:103], a[4:7], v[72:75]
  v_mfma_f32_16x16x32_bf16 v[76:79], v[100:103], a[36:39], v[76:79]
  v_mfma_f32_16x16x32_bf16 v[80:83], v[100:103], a[68:71], v[80:83]
  v_mfma_f32_16x16x32_bf16 v[84:87], v[100:103], a[100:103], v[84:87]
  v_mfma_f32_16x16x32_bf16 v[88:91], v[100:103], a[132:135], v[88:91]
  ds_read2_b32 v[100:101], v54 offset0:160 offset1:161
  ds_read2_b32 v[102:103], v54 offset0:162 offset1:163
  s_waitcnt lgkmcnt(6)
  v_mfma_f32_16x16x32_bf16 v[72:75], v[104:107], a[0:3], v[72:75]
  v_mfma_f32_16x16x32_bf16 v[76:79], v[104:107], a[32:35], v[76:79]
  v_mfma_f32_16x16x32_bf16 v[80:83], v[104:107], a[64:67], v[80:83]
  v_mfma_f32_16x16x32_bf16 v[84:87], v[104:107], a[96:99], v[84:87]
  v_mfma_f32_16x16x32_bf16 v[88:91], v[104:107], a[128:131], v[88:91]
  ds_read2_b32 v[104:105], v54 offset0:144 offset1:145
  ds_read2_b32 v[106:107], v54 offset0:146 offset1:147
  s_waitcnt lgkmcnt(6)
  v_mfma_f32_16x16x32_bf16 v[76:79], v[92:95], a[28:31], v[76:79]
  v_mfma_f32_16x16x32_bf16 v[80:83], v[92:95], a[60:63], v[80:83]
  v_mfma_f32_16x16x32_bf16 v[84:87], v[92:95], a[92:95], v[84:87]
  v_mfma_f32_16x16x32_bf16 v[88:91], v[92:95], a[124:127], v[88:91]
  ds_read2_b32 v[92:93], v54 offset0:128 offset1:129
  ds_read2_b32 v[94:95], v54 offset0:130 offset1:131
  s_waitcnt lgkmcnt(6)
  v_mfma_f32_16x16x32_bf16 v[76:79], v[96:99], a[24:27], v[76:79]
  v_mfma_f32_16x16x32_bf16 v[80:83], v[96:99], a[56:59], v[80:83]
  v_mfma_f32_16x16x32_bf16 v[84:87], v[96:99], a[88:91], v[84:87]
  v_mfma_f32_16x16x32_bf16 v[88:91], v[96:99], a[120:123], v[88:91]
  ds_read2_b32 v[96:97], v54 offset0:112 offset1:113
  ds_read2_b32 v[98:99], v54 offset0:114 offset1:115
  s_waitcnt lgkmcnt(6)
  v_mfma_f32_16x16x32_bf16 v[76:79], v[100:103], a[20:23], v[76:79]
  v_mfma_f32_16x16x32_bf16 v[80:83], v[100:103], a[52:55], v[80:83]
  v_mfma_f32_16x16x32_bf16 v[84:87], v[100:103], a[84:87], v[84:87]
  v_mfma_f32_16x16x32_bf16 v[88:91], v[100:103], a[116:119], v[88:91]
  ds_read2_b32 v[100:101], v54 offset0:96 offset1:97
  ds_read2_b32 v[102:103], v54 offset0:98 offset1:99
  s_waitcnt lgkmcnt(6)
  v_mfma_f32_16x16x32_bf16 v[76:79], v[104:107], a[16:19], v[76:79]
  v_mfma_f32_16x16x32_bf16 v[80:83], v[104:107], a[48:51], v[80:83]
  v_mfma_f32_16x16x32_bf16 v[84:87], v[104:107], a[80:83], v[84:87]
  v_mfma_f32_16x16x32_bf16 v[88:91], v[104:107], a[112:115], v[88:91]
  ds_read2_b32 v[104:105], v54 offset0:80 offset1:81
  ds_read2_b32 v[106:107], v54 offset0:82 offset1:83
  s_waitcnt lgkmcnt(6)
  v_mfma_f32_16x16x32_bf16 v[76:79], v[92:95], a[12:15], v[76:79]
  v_mfma_f32_16x16x32_bf16 v[80:83], v[92:95], a[44:47], v[80:83]
  v_mfma_f32_16x16x32_bf16 v[84:87], v[92:95], a[76:79], v[84:87]
  v_mfma_f32_16x16x32_bf16 v[88:91], v[92:95], a[108:111], v[88:91]
  ds_read2_b32 v[92:93], v54 offset0:64 offset1:65
  ds_read2_b32 v[94:95], v54 offset0:66 offset1:67
  s_waitcnt lgkmcnt(6)
  v_mfma_f32_16x16x32_bf16 v[76:79], v[96:99], a[8:11], v[76:79]
  v_mfma_f32_16x16x32_bf16 v[80:83], v[96:99], a[40:43], v[80:83]
  v_mfma_f32_16x16x32_bf16 v[84:87], v[96:99], a[72:75], v[84:87]
  v_mfma_f32_16x16x32_bf16 v[88:91], v[96:99], a[104:107], v[88:91]
  ds_read2_b32 v[96:97], v54 offset0:48 offset1:49
  ds_read2_b32 v[98:99], v54 offset0:50 offset1:51
  s_waitcnt lgkmcnt(6)
  v_mfma_f32_16x16x32_bf16 v[76:79], v[100:103], a[4:7], v[76:79]
  v_mfma_f32_16x16x32_bf16 v[80:83], v[100:103], a[36:39], v[80:83]
  v_mfma_f32_16x16x32_bf16 v[84:87], v[100:103], a[68:71], v[84:87]
  v_mfma_f32_16x16x32_bf16 v[88:91], v[100:103], a[100:103], v[88:91]
  ds_read2_b32 v[100:101], v54 offset0:32 offset1:33
  ds_read2_b32 v[102:103], v54 offset0:34 offset1:35
  s_waitcnt lgkmcnt(6)
  v_mfma_f32_16x16x32_bf16 v[76:79], v[104:107], a[0:3], v[76:79]
  v_mfma_f32_16x16x32_bf16 v[80:83], v[104:107], a[32:35], v[80:83]
  v_mfma_f32_16x16x32_bf16 v[84:87], v[104:107], a[64:67], v[84:87]
  v_mfma_f32_16x16x32_bf16 v[88:91], v[104:107], a[96:99], v[88:91]
  ds_read2_b32 v[104:105], v54 offset0:16 offset1:17
  ds_read2_b32 v[106:107], v54 offset0:18 offset1:19
  s_waitcnt lgkmcnt(6)
  v_mfma_f32_16x16x32_bf16 v[80:83], v[92:95], a[28:31], v[80:83]
  v_mfma_f32_16x16x32_bf16 v[84:87], v[92:95], a[60:63], v[84:87]
  v_mfma_f32_16x16x32_bf16 v[88:91], v[92:95], a[92:95], v[88:91]
  ds_read2_b32 v[92:93], v54 offset0:0 offset1:1
  ds_read2_b32 v[94:95], v54 offset0:2 offset1:3
  s_waitcnt lgkmcnt(6)
  v_mfma_f32_16x16x32_bf16 v[80:83], v[96:99], a[24:27], v[80:83]
  v_mfma_f32_16x16x32_bf16 v[84:87], v[96:99], a[56:59], v[84:87]
  v_mfma_f32_16x16x32_bf16 v[88:91], v[96:99], a[88:91], v[88:91]
  ds_read2_b32 v[96:97], v55 offset0:224 offset1:225
  ds_read2_b32 v[98:99], v55 offset0:226 offset1:227
  s_waitcnt lgkmcnt(6)
  v_mfma_f32_16x16x32_bf16 v[80:83], v[100:103], a[20:23], v[80:83]
  v_mfma_f32_16x16x32_bf16 v[84:87], v[100:103], a[52:55], v[84:87]
  v_mfma_f32_16x16x32_bf16 v[88:91], v[100:103], a[84:87], v[88:91]
  ds_read2_b32 v[100:101], v55 offset0:208 offset1:209
  ds_read2_b32 v[102:103], v55 offset0:210 offset1:211
  s_waitcnt lgkmcnt(6)
  v_mfma_f32_16x16x32_bf16 v[80:83], v[104:107], a[16:19], v[80:83]
  v_mfma_f32_16x16x32_bf16 v[84:87], v[104:107], a[48:51], v[84:87]
  v_mfma_f32_16x16x32_bf16 v[88:91], v[104:107], a[80:83], v[88:91]
  ds_read2_b32 v[104:105], v55 offset0:192 offset1:193
  ds_read2_b32 v[106:107], v55 offset0:194 offset1:195
  s_waitcnt lgkmcnt(6)
  v_mfma_f32_16x16x32_bf16 v[80:83], v[92:95], a[12:15], v[80:83]
  v_mfma_f32_16x16x32_bf16 v[84:87], v[92:95], a[44:47], v[84:87]
  v_mfma_f32_16x16x32_bf16 v[88:91], v[92:95], a[76:79], v[88:91]
  ds_read2_b32 v[92:93], v55 offset0:176 offset1:177
  ds_read2_b32 v[94:95], v55 offset0:178 offset1:179
  s_waitcnt lgkmcnt(6)
  v_mfma_f32_16x16x32_bf16 v[80:83], v[96:99], a[8:11], v[80:83]
  v_mfma_f32_16x16x32_bf16 v[84:87], v[96:99], a[40:43], v[84:87]
  v_mfma_f32_16x16x32_bf16 v[88:91], v[96:99], a[72:75], v[88:91]
  ds_read2_b32 v[96:97], v55 offset0:160 offset1:161
  ds_read2_b32 v[98:99], v55 offset0:162 offset1:163
  s_waitcnt lgkmcnt(6)
  v_mfma_f32_16x16x32_bf16 v[80:83], v[100:103], a[4:7], v[80:83]
  v_mfma_f32_16x16x32_bf16 v[84:87], v[100:103], a[36:39], v[84:87]
  v_mfma_f32_16x16x32_bf16 v[88:91], v[100:103], a[68:71], v[88:91]
  ds_read2_b32 v[100:101], v55 offset0:144 offset1:145
  ds_read2_b32 v[102:103], v55 offset0:146 offset1:147
  s_waitcnt lgkmcnt(6)
  v_mfma_f32_16x16x32_bf16 v[80:83], v[104:107], a[0:3], v[80:83]
  v_mfma_f32_16x16x32_bf16 v[84:87], v[104:107], a[32:35], v[84:87]
  v_mfma_f32_16x16x32_bf16 v[88:91], v[104:107], a[64:67], v[88:91]
  ds_read2_b32 v[104:105], v55 offset0:128 offset1:129
  ds_read2_b32 v[106:107], v55 offset0:130 offset1:131
  s_waitcnt lgkmcnt(6)
  v_mfma_f32_16x16x32_bf16 v[84:87], v[92:95], a[28:31], v[84:87]
  v_mfma_f32_16x16x32_bf16 v[88:91], v[92:95], a[60:63], v[88:91]
  ds_read2_b32 v[92:93], v55 offset0:112 offset1:113
  ds_read2_b32 v[94:95], v55 offset0:114 offset1:115
  s_waitcnt lgkmcnt(6)
  v_mfma_f32_16x16x32_bf16 v[84:87], v[96:99], a[24:27], v[84:87]
  v_mfma_f32_16x16x32_bf16 v[88:91], v[96:99], a[56:59], v[88:91]
  ds_read2_b32 v[96:97], v55 offset0:96 offset1:97
  ds_read2_b32 v[98:99], v55 offset0:98 offset1:99
  s_waitcnt lgkmcnt(6)
  v_mfma_f32_16x16x32_bf16 v[84:87], v[100:103], a[20:23], v[84:87]
  v_mfma_f32_16x16x32_bf16 v[88:91], v[100:103], a[52:55], v[88:91]
  ds_read2_b32 v[100:101], v55 offset0:80 offset1:81
  ds_read2_b32 v[102:103], v55 offset0:82 offset1:83
  s_waitcnt lgkmcnt(6)
  v_mfma_f32_16x16x32_bf16 v[84:87], v[104:107], a[16:19], v[84:87]
  v_mfma_f32_16x16x32_bf16 v[88:91], v[104:107], a[48:51], v[88:91]
  ds_read2_b32 v[104:105], v55 offset0:64 offset1:65
  ds_read2_b32 v[106:107], v55 offset0:66 offset1:67
  s_waitcnt lgkmcnt(6)
  v_mfma_f32_16x16x32_bf16 v[84:87], v[92:95], a[12:15], v[84:87]
  v_mfma_f32_16x16x32_bf16 v[88:91], v[92:95], a[44:47], v[88:91]
  ds_read2_b32 v[92:93], v55 offset0:48 offset1:49
  ds_read2_b32 v[94:95], v55 offset0:50 offset1:51
  s_waitcnt lgkmcnt(6)
  v_mfma_f32_16x16x32_bf16 v[84:87], v[96:99], a[8:11], v[84:87]
  v_mfma_f32_16x16x32_bf16 v[88:91], v[96:99], a[40:43], v[88:91]
  ds_read2_b32 v[96:97], v55 offset0:32 offset1:33
  ds_read2_b32 v[98:99], v55 offset0:34 offset1:35
  s_waitcnt lgkmcnt(6)
  v_mfma_f32_16x16x32_bf16 v[84:87], v[100:103], a[4:7], v[84:87]
  v_mfma_f32_16x16x32_bf16 v[88:91], v[100:103], a[36:39], v[88:91]
  ds_read2_b32 v[100:101], v55 offset0:16 offset1:17
  ds_read2_b32 v[102:103], v55 offset0:18 offset1:19
  s_waitcnt lgkmcnt(6)
  v_mfma_f32_16x16x32_bf16 v[84:87], v[104:107], a[0:3], v[84:87]
  v_mfma_f32_16x16x32_bf16 v[88:91], v[104:107], a[32:35], v[88:91]
  ds_read2_b32 v[104:105], v55 offset0:0 offset1:1
  ds_read2_b32 v[106:107], v55 offset0:2 offset1:3
  s_waitcnt lgkmcnt(6)
  v_mfma_f32_16x16x32_bf16 v[88:91], v[92:95], a[28:31], v[88:91]
  ds_read2_b32 v[92:93], v56 offset0:224 offset1:225
  ds_read2_b32 v[94:95], v56 offset0:226 offset1:227
  s_waitcnt lgkmcnt(6)
  v_mfma_f32_16x16x32_bf16 v[88:91], v[96:99], a[24:27], v[88:91]
  ds_read2_b32 v[96:97], v56 offset0:208 offset1:209
  ds_read2_b32 v[98:99], v56 offset0:210 offset1:211
  s_waitcnt lgkmcnt(6)
  v_mfma_f32_16x16x32_bf16 v[88:91], v[100:103], a[20:23], v[88:91]
  ds_read2_b32 v[100:101], v56 offset0:192 offset1:193
  ds_read2_b32 v[102:103], v56 offset0:194 offset1:195
  s_waitcnt lgkmcnt(6)
  v_mfma_f32_16x16x32_bf16 v[88:91], v[104:107], a[16:19], v[88:91]
  ds_read2_b32 v[104:105], v56 offset0:176 offset1:177
  ds_read2_b32 v[106:107], v56 offset0:178 offset1:179
  s_waitcnt lgkmcnt(6)
  v_mfma_f32_16x16x32_bf16 v[88:91], v[92:95], a[12:15], v[88:91]
  s_waitcnt lgkmcnt(4)
  v_mfma_f32_16x16x32_bf16 v[88:91], v[96:99], a[8:11], v[88:91]
  s_waitcnt lgkmcnt(2)
  v_mfma_f32_16x16x32_bf16 v[88:91], v[100:103], a[4:7], v[88:91]
  s_waitcnt lgkmcnt(0)
  v_mfma_f32_16x16x32_bf16 v[88:91], v[104:107], a[0:3], v[88:91]
  v_lshlrev_b32 v46, 5, v4
  v_lshl_add_u32 v46, v3, 3, v46
  v_add_u32 v46, s17, v46
  ds_read_b64 v[108:109], v46 offset:512
  ds_read_b64 v[110:111], v46 offset:1024
  ds_read_b64 v[112:113], v46 offset:1536
  ds_read_b64 v[114:115], v46 offset:2048
  ds_read_b64 v[116:117], v46 offset:2560
  ds_read_b64 v[118:119], v46 offset:3072
  ds_read_b64 v[120:121], v46 offset:3584
  ds_read_b64 v[122:123], v46 offset:4096
  s_waitcnt lgkmcnt(0)
  v_lshlrev_b32 v124, 16, v108
  v_and_b32 v125, 0xffff0000, v108
  v_lshlrev_b32 v126, 16, v109
  v_and_b32 v127, 0xffff0000, v109
  v_mul_f32 v124, v124, v33
  v_mul_f32 v125, v125, v33
  v_mul_f32 v126, v126, v33
  v_mul_f32 v127, v127, v33
  v_cvt_pk_bf16_f32 v128, v124, v125
  v_cvt_pk_bf16_f32 v129, v126, v127
  v_cvt_pk_bf16_f32 v130, v60, v61
  v_cvt_pk_bf16_f32 v131, v62, v63
  v_lshlrev_b32 v124, 16, v128
  v_and_b32 v125, 0xffff0000, v128
  v_lshlrev_b32 v132, 16, v130
  v_and_b32 v133, 0xffff0000, v130
  v_lshlrev_b32 v126, 16, v129
  v_and_b32 v127, 0xffff0000, v129
  v_lshlrev_b32 v134, 16, v131
  v_and_b32 v135, 0xffff0000, v131
  v_add_f32 v124, v124, v132
  v_add_f32 v125, v125, v133
  v_add_f32 v126, v126, v134
  v_add_f32 v127, v127, v135
  v_cvt_pk_bf16_f32 v108, v124, v125
  v_cvt_pk_bf16_f32 v109, v126, v127
  ds_write_b64 v46, v[108:109] offset:512
  v_lshlrev_b32 v124, 16, v110
  v_and_b32 v125, 0xffff0000, v110
  v_lshlrev_b32 v126, 16, v111
  v_and_b32 v127, 0xffff0000, v111
  v_mul_f32 v124, v124, v33
  v_mul_f32 v125, v125, v33
  v_mul_f32 v126, v126, v33
  v_mul_f32 v127, v127, v33
  v_cvt_pk_bf16_f32 v128, v124, v125
  v_cvt_pk_bf16_f32 v129, v126, v127
  v_cvt_pk_bf16_f32 v130, v64, v65
  v_cvt_pk_bf16_f32 v131, v66, v67
  v_lshlrev_b32 v124, 16, v128
  v_and_b32 v125, 0xffff0000, v128
  v_lshlrev_b32 v132, 16, v130
  v_and_b32 v133, 0xffff0000, v130
  v_lshlrev_b32 v126, 16, v129
  v_and_b32 v127, 0xffff0000, v129
  v_lshlrev_b32 v134, 16, v131
  v_and_b32 v135, 0xffff0000, v131
  v_add_f32 v124, v124, v132
  v_add_f32 v125, v125, v133
  v_add_f32 v126, v126, v134
  v_add_f32 v127, v127, v135
  v_cvt_pk_bf16_f32 v110, v124, v125
  v_cvt_pk_bf16_f32 v111, v126, v127
  ds_write_b64 v46, v[110:111] offset:1024
  v_lshlrev_b32 v124, 16, v112
  v_and_b32 v125, 0xffff0000, v112
  v_lshlrev_b32 v126, 16, v113
  v_and_b32 v127, 0xffff0000, v113
  v_mul_f32 v124, v124, v33
  v_mul_f32 v125, v125, v33
  v_mul_f32 v126, v126, v33
  v_mul_f32 v127, v127, v33
  v_cvt_pk_bf16_f32 v128, v124, v125
  v_cvt_pk_bf16_f32 v129, v126, v127
  v_cvt_pk_bf16_f32 v130, v68, v69
  v_cvt_pk_bf16_f32 v131, v70, v71
  v_lshlrev_b32 v124, 16, v128
  v_and_b32 v125, 0xffff0000, v128
  v_lshlrev_b32 v132, 16, v130
  v_and_b32 v133, 0xffff0000, v130
  v_lshlrev_b32 v126, 16, v129
  v_and_b32 v127, 0xffff0000, v129
  v_lshlrev_b32 v134, 16, v131
  v_and_b32 v135, 0xffff0000, v131
  v_add_f32 v124, v124, v132
  v_add_f32 v125, v125, v133
  v_add_f32 v126, v126, v134
  v_add_f32 v127, v127, v135
  v_cvt_pk_bf16_f32 v112, v124, v125
  v_cvt_pk_bf16_f32 v113, v126, v127
  ds_write_b64 v46, v[112:113] offset:1536
  v_lshlrev_b32 v124, 16, v114
  v_and_b32 v125, 0xffff0000, v114
  v_lshlrev_b32 v126, 16, v115
  v_and_b32 v127, 0xffff0000, v115
  v_mul_f32 v124, v124, v33
  v_mul_f32 v125, v125, v33
  v_mul_f32 v126, v126, v33
  v_mul_f32 v127, v127, v33
  v_cvt_pk_bf16_f32 v128, v124, v125
  v_cvt_pk_bf16_f32 v129, v126, v127
  v_cvt_pk_bf16_f32 v130, v72, v73
  v_cvt_pk_bf16_f32 v131, v74, v75
  v_lshlrev_b32 v124, 16, v128
  v_and_b32 v125, 0xffff0000, v128
  v_lshlrev_b32 v132, 16, v130
  v_and_b32 v133, 0xffff0000, v130
  v_lshlrev_b32 v126, 16, v129
  v_and_b32 v127, 0xffff0000, v129
  v_lshlrev_b32 v134, 16, v131
  v_and_b32 v135, 0xffff0000, v131
  v_add_f32 v124, v124, v132
  v_add_f32 v125, v125, v133
  v_add_f32 v126, v126, v134
  v_add_f32 v127, v127, v135
  v_cvt_pk_bf16_f32 v114, v124, v125
  v_cvt_pk_bf16_f32 v115, v126, v127
  ds_write_b64 v46, v[114:115] offset:2048
  v_lshlrev_b32 v124, 16, v116
  v_and_b32 v125, 0xffff0000, v116
  v_lshlrev_b32 v126, 16, v117
  v_and_b32 v127, 0xffff0000, v117
  v_mul_f32 v124, v124, v33
  v_mul_f32 v125, v125, v33
  v_mul_f32 v126, v126, v33
  v_mul_f32 v127, v127, v33
  v_cvt_pk_bf16_f32 v128, v124, v125
  v_cvt_pk_bf16_f32 v129, v126, v127
  v_cvt_pk_bf16_f32 v130, v76, v77
  v_cvt_pk_bf16_f32 v131, v78, v79
  v_lshlrev_b32 v124, 16, v128
  v_and_b32 v125, 0xffff0000, v128
  v_lshlrev_b32 v132, 16, v130
  v_and_b32 v133, 0xffff0000, v130
  v_lshlrev_b32 v126, 16, v129
  v_and_b32 v127, 0xffff0000, v129
  v_lshlrev_b32 v134, 16, v131
  v_and_b32 v135, 0xffff0000, v131
  v_add_f32 v124, v124, v132
  v_add_f32 v125, v125, v133
  v_add_f32 v126, v126, v134
  v_add_f32 v127, v127, v135
  v_cvt_pk_bf16_f32 v116, v124, v125
  v_cvt_pk_bf16_f32 v117, v126, v127
  ds_write_b64 v46, v[116:117] offset:2560
  v_lshlrev_b32 v124, 16, v118
  v_and_b32 v125, 0xffff0000, v118
  v_lshlrev_b32 v126, 16, v119
  v_and_b32 v127, 0xffff0000, v119
  v_mul_f32 v124, v124, v33
  v_mul_f32 v125, v125, v33
  v_mul_f32 v126, v126, v33
  v_mul_f32 v127, v127, v33
  v_cvt_pk_bf16_f32 v128, v124, v125
  v_cvt_pk_bf16_f32 v129, v126, v127
  v_cvt_pk_bf16_f32 v130, v80, v81
  v_cvt_pk_bf16_f32 v131, v82, v83
  v_lshlrev_b32 v124, 16, v128
  v_and_b32 v125, 0xffff0000, v128
  v_lshlrev_b32 v132, 16, v130
  v_and_b32 v133, 0xffff0000, v130
  v_lshlrev_b32 v126, 16, v129
  v_and_b32 v127, 0xffff0000, v129
  v_lshlrev_b32 v134, 16, v131
  v_and_b32 v135, 0xffff0000, v131
  v_add_f32 v124, v124, v132
  v_add_f32 v125, v125, v133
  v_add_f32 v126, v126, v134
  v_add_f32 v127, v127, v135
  v_cvt_pk_bf16_f32 v118, v124, v125
  v_cvt_pk_bf16_f32 v119, v126, v127
  ds_write_b64 v46, v[118:119] offset:3072
  v_lshlrev_b32 v124, 16, v120
  v_and_b32 v125, 0xffff0000, v120
  v_lshlrev_b32 v126, 16, v121
  v_and_b32 v127, 0xffff0000, v121
  v_mul_f32 v124, v124, v33
  v_mul_f32 v125, v125, v33
  v_mul_f32 v126, v126, v33
  v_mul_f32 v127, v127, v33
  v_cvt_pk_bf16_f32 v128, v124, v125
  v_cvt_pk_bf16_f32 v129, v126, v127
  v_cvt_pk_bf16_f32 v130, v84, v85
  v_cvt_pk_bf16_f32 v131, v86, v87
  v_lshlrev_b32 v124, 16, v128
  v_and_b32 v125, 0xffff0000, v128
  v_lshlrev_b32 v132, 16, v130
  v_and_b32 v133, 0xffff0000, v130
  v_lshlrev_b32 v126, 16, v129
  v_and_b32 v127, 0xffff0000, v129
  v_lshlrev_b32 v134, 16, v131
  v_and_b32 v135, 0xffff0000, v131
  v_add_f32 v124, v124, v132
  v_add_f32 v125, v125, v133
  v_add_f32 v126, v126, v134
  v_add_f32 v127, v127, v135
  v_cvt_pk_bf16_f32 v120, v124, v125
  v_cvt_pk_bf16_f32 v121, v126, v127
  ds_write_b64 v46, v[120:121] offset:3584
  v_lshlrev_b32 v124, 16, v122
  v_and_b32 v125, 0xffff0000, v122
  v_lshlrev_b32 v126, 16, v123
  v_and_b32 v127, 0xffff0000, v123
  v_mul_f32 v124, v124, v33
  v_mul_f32 v125, v125, v33
  v_mul_f32 v126, v126, v33
  v_mul_f32 v127, v127, v33
  v_cvt_pk_bf16_f32 v128, v124, v125
  v_cvt_pk_bf16_f32 v129, v126, v127
  v_cvt_pk_bf16_f32 v130, v88, v89
  v_cvt_pk_bf16_f32 v131, v90, v91
  v_lshlrev_b32 v124, 16, v128
  v_and_b32 v125, 0xffff0000, v128
  v_lshlrev_b32 v132, 16, v130
  v_and_b32 v133, 0xffff0000, v130
  v_lshlrev_b32 v126, 16, v129
  v_and_b32 v127, 0xffff0000, v129
  v_lshlrev_b32 v134, 16, v131
  v_and_b32 v135, 0xffff0000, v131
  v_add_f32 v124, v124, v132
  v_add_f32 v125, v125, v133
  v_add_f32 v126, v126, v134
  v_add_f32 v127, v127, v135
  v_cvt_pk_bf16_f32 v122, v124, v125
  v_cvt_pk_bf16_f32 v123, v126, v127
  ds_write_b64 v46, v[122:123] offset:4096
  s_waitcnt lgkmcnt(0)
  s_barrier
  v_lshlrev_b32 v6, 3, v0
  v_mul_u32_u24 v5, 7168, v0
  v_add_u32 v36, 512, v6
  ds_read_b64 v[8:9], v36
  v_add_u32 v36, 25088, v6
  ds_read_b64 v[10:11], v36
  v_add_u32 v36, 49664, v6
  ds_read_b64 v[12:13], v36
  v_add_u32 v36, 74240, v6
  ds_read_b64 v[14:15], v36
  s_waitcnt lgkmcnt(0)
  s_add_u32 s22, s21, 0
  s_add_u32 s23, s22, 3584
  v_perm_b32 v16, v10, v8, s24
  v_perm_b32 v17, v14, v12, s24
  buffer_store_dwordx2 v[16:17], v5, s[88:91], s22 offen offset:0
  v_perm_b32 v18, v10, v8, s25
  v_perm_b32 v19, v14, v12, s25
  buffer_store_dwordx2 v[18:19], v5, s[88:91], s22 offen offset:1792
  v_perm_b32 v20, v11, v9, s24
  v_perm_b32 v21, v15, v13, s24
  buffer_store_dwordx2 v[20:21], v5, s[88:91], s23 offen offset:0
  v_perm_b32 v22, v11, v9, s25
  v_perm_b32 v23, v15, v13, s25
  buffer_store_dwordx2 v[22:23], v5, s[88:91], s23 offen offset:1792
  v_add_u32 v36, 2560, v6
  ds_read_b64 v[8:9], v36
  v_add_u32 v36, 27136, v6
  ds_read_b64 v[10:11], v36
  v_add_u32 v36, 51712, v6
  ds_read_b64 v[12:13], v36
  v_add_u32 v36, 76288, v6
  ds_read_b64 v[14:15], v36
  s_waitcnt lgkmcnt(0)
  s_add_u32 s22, s21, 1835008
  s_add_u32 s23, s22, 3584
  v_perm_b32 v24, v10, v8, s24
  v_perm_b32 v25, v14, v12, s24
  buffer_store_dwordx2 v[24:25], v5, s[88:91], s22 offen offset:0
  v_perm_b32 v26, v10, v8, s25
  v_perm_b32 v27, v14, v12, s25
  buffer_store_dwordx2 v[26:27], v5, s[88:91], s22 offen offset:1792
  v_perm_b32 v28, v11, v9, s24
  v_perm_b32 v29, v15, v13, s24
  buffer_store_dwordx2 v[28:29], v5, s[88:91], s23 offen offset:0
  v_perm_b32 v30, v11, v9, s25
  v_perm_b32 v31, v15, v13, s25
  buffer_store_dwordx2 v[30:31], v5, s[88:91], s23 offen offset:1792
  s_branch wk_loop
wk_tok:
  s_sub_u32 s3, s3, 752
  s_cmp_ge_u32 s3, 512
  s_cbranch_scc1 wk_done
  s_lshr_b32 s17, s3, 3
  s_and_b32 s18, s3, 3
  s_bitcmp1_b32 s3, 2
  s_cbranch_scc1 wk_toko
  s_lshl_b32 s20, s18, 2
  s_add_u32 s20, s20, s16
  s_lshl_b32 s21, s17, 4
  s_add_u32 s21, s21, s20
  s_mul_i32 s21, s21, 28672
  s_add_u32 s21, s21, 12845056
  s_mul_i32 s23, s17, 28672
  s_add_u32 s23, s23, 73859072
  s_mul_i32 s24, s17, 7168
  s_add_u32 s24, s24, 88002560
  s_lshr_b32 s25, s17, 3
  s_lshl_b32 s25, s25, 4
  s_add_u32 s25, s25, s20
  s_lshl_b32 s25, s25, 7
  s_add_u32 s25, s25, 88477696
  v_mov_b32 v60, 0
  s_mov_b32 s30, 0
wp_wf:
  buffer_load_dword v61, v60, s[8:11], s25 offen sc1
  s_waitcnt vmcnt(0)
  v_cmp_ne_u32 vcc, 56, v61
  s_cbranch_vccz wp_wf_ok
  s_sleep 4
  s_cmp_ge_u32 s17, 56
  s_cbranch_scc1 wp_wf_bo
  s_sleep 127
wp_wf_bo:
  s_add_u32 s30, s30, 1
  s_cmp_lt_u32 s30, 2000000
  s_cbranch_scc1 wp_wf
  s_branch wp_abort
wp_wf_ok:
  s_lshl_b32 s25, s17, 1
  s_mul_i32 s25, s25, 20480
  s_add_u32 s25, s25, 85381120
  s_lshl_b32 s26, s20, 10
  s_add_u32 s26, s26, s25
  s_lshl_b32 s27, s18, 10
  s_add_u32 s27, s27, s25
  s_lshr_b32 s28, s16, 1
  s_lshl_b32 s28, s28, 3
  s_add_u32 s27, s27, s28
  s_add_u32 s27, s27, 16384
  s_and_b32 s28, s16, 1
  s_cmp_eq_u32 s28, 0
  s_cselect_b32 s50, -1, 0
  s_cselect_b32 s51, 0, -1
  v_mov_b32 v44, -1
  v_mov_b32 v45, -1
  v_mov_b32 v46, -1
  v_mov_b32 v47, -1
  s_add_u32 s28, s26, 0
  s_add_u32 s29, s27, 0
  buffer_store_dwordx4 v[44:47], v2, s[8:11], s28 offen sc1
  s_mov_b64 exec, s[50:51]
  buffer_store_dwordx2 v[44:45], v2, s[8:11], s29 offen sc1
  s_mov_b64 exec, -1
  s_add_u32 s28, s26, 20480
  s_add_u32 s29, s27, 20480
  buffer_store_dwordx4 v[44:47], v2, s[8:11], s28 offen sc1
  s_mov_b64 exec, s[50:51]
  buffer_store_dwordx2 v[44:45], v2, s[8:11], s29 offen sc1
  s_mov_b64 exec, -1
  s_add_u32 s22, s21, 0
  buffer_load_dwordx4 a[0:3], v2, s[8:11], s22 offen offset:0 sc1
  buffer_load_dwordx4 a[4:7], v2, s[8:11], s22 offen offset:1024 sc1
  buffer_load_dwordx4 a[8:11], v2, s[8:11], s22 offen offset:2048 sc1
  buffer_load_dwordx4 a[12:15], v2, s[8:11], s22 offen offset:3072 sc1
  s_add_u32 s22, s21, 4096
  buffer_load_dwordx4 a[16:19], v2, s[8:11], s22 offen offset:0 sc1
  buffer_load_dwordx4 a[20:23], v2, s[8:11], s22 offen offset:1024 sc1
  buffer_load_dwordx4 a[24:27], v2, s[8:11], s22 offen offset:2048 sc1
  buffer_load_dwordx4 a[28:31], v2, s[8:11], s22 offen offset:3072 sc1
  s_add_u32 s22, s21, 8192
  buffer_load_dwordx4 a[32:35], v2, s[8:11], s22 offen offset:0 sc1
  buffer_load_dwordx4 a[36:39], v2, s[8:11], s22 offen offset:1024 sc1
  buffer_load_dwordx4 a[40:43], v2, s[8:11], s22 offen offset:2048 sc1
  buffer_load_dwordx4 a[44:47], v2, s[8:11], s22 offen offset:3072 sc1
  s_add_u32 s22, s21, 12288
  buffer_load_dwordx4 a[48:51], v2, s[8:11], s22 offen offset:0 sc1
  buffer_load_dwordx4 a[52:55], v2, s[8:11], s22 offen offset:1024 sc1
  buffer_load_dwordx4 a[56:59], v2, s[8:11], s22 offen offset:2048 sc1
  buffer_load_dwordx4 a[60:63], v2, s[8:11], s22 offen offset:3072 sc1
  s_add_u32 s22, s21, 16384
  buffer_load_dwordx4 a[64:67], v2, s[8:11], s22 offen offset:0 sc1
  buffer_load_dwordx4 a[68:71], v2, s[8:11], s22 offen offset:1024 sc1
  buffer_load_dwordx4 a[72:75], v2, s[8:11], s22 offen offset:2048 sc1
  buffer_load_dwordx4 a[76:79], v2, s[8:11], s22 offen offset:3072 sc1
  s_add_u32 s22, s21, 20480
  buffer_load_dwordx4 a[80:83], v2, s[8:11], s22 offen offset:0 sc1
  buffer_load_dwordx4 a[84:87], v2, s[8:11], s22 offen offset:1024 sc1
  buffer_load_dwordx4 a[88:91], v2, s[8:11], s22 offen offset:2048 sc1
  buffer_load_dwordx4 a[92:95], v2, s[8:11], s22 offen offset:3072 sc1
  s_add_u32 s22, s21, 24576
  buffer_load_dwordx4 a[96:99], v2, s[8:11], s22 offen offset:0 sc1
  buffer_load_dwordx4 a[100:103], v2, s[8:11], s22 offen offset:1024 sc1
  buffer_load_dwordx4 a[104:107], v2, s[8:11], s22 offen offset:2048 sc1
  buffer_load_dwordx4 a[108:111], v2, s[8:11], s22 offen offset:3072 sc1
  s_add_u32 s22, s23, 0
  buffer_load_dwordx4 a[112:115], v2, s[8:11], s22 offen offset:0 sc1
  buffer_load_dwordx4 a[116:119], v2, s[8:11], s22 offen offset:1024 sc1
  buffer_load_dwordx4 a[120:123], v2, s[8:11], s22 offen offset:2048 sc1
  buffer_load_dwordx4 a[124:127], v2, s[8:11], s22 offen offset:3072 sc1
  s_add_u32 s22, s23, 4096
  buffer_load_dwordx4 a[128:131], v2, s[8:11], s22 offen offset:0 sc1
  buffer_load_dwordx4 a[132:135], v2, s[8:11], s22 offen offset:1024 sc1
  buffer_load_dwordx4 a[136:139], v2, s[8:11], s22 offen offset:2048 sc1
  buffer_load_dwordx4 a[140:143], v2, s[8:11], s22 offen offset:3072 sc1
  s_add_u32 s22, s23, 8192
  buffer_load_dwordx4 a[144:147], v2, s[8:11], s22 offen offset:0 sc1
  buffer_load_dwordx4 a[148:151], v2, s[8:11], s22 offen offset:1024 sc1
  buffer_load_dwordx4 a[152:155], v2, s[8:11], s22 offen offset:2048 sc1
  buffer_load_dwordx4 a[156:159], v2, s[8:11], s22 offen offset:3072 sc1
  s_add_u32 s22, s23, 12288
  buffer_load_dwordx4 a[160:163], v2, s[8:11], s22 offen offset:0 sc1
  buffer_load_dwordx4 a[164:167], v2, s[8:11], s22 offen offset:1024 sc1
  buffer_load_dwordx4 a[168:171], v2, s[8:11], s22 offen offset:2048 sc1
  buffer_load_dwordx4 a[172:175], v2, s[8:11], s22 offen offset:3072 sc1
  s_add_u32 s22, s23, 16384
  buffer_load_dwordx4 a[176:179], v2, s[8:11], s22 offen offset:0 sc1
  buffer_load_dwordx4 a[180:183], v2, s[8:11], s22 offen offset:1024 sc1
  buffer_load_dwordx4 a[184:187], v2, s[8:11], s22 offen offset:2048 sc1
  buffer_load_dwordx4 a[188:191], v2, s[8:11], s22 offen offset:3072 sc1
  s_add_u32 s22, s23, 20480
  buffer_load_dwordx4 a[192:195], v2, s[8:11], s22 offen offset:0 sc1
  buffer_load_dwordx4 a[196:199], v2, s[8:11], s22 offen offset:1024 sc1
  buffer_load_dwordx4 a[200:203], v2, s[8:11], s22 offen offset:2048 sc1
  buffer_load_dwordx4 a[204:207], v2, s[8:11], s22 offen offset:3072 sc1
  s_add_u32 s22, s23, 24576
  buffer_load_dwordx4 a[208:211], v2, s[8:11], s22 offen offset:0 sc1
  buffer_load_dwordx4 a[212:215], v2, s[8:11], s22 offen offset:1024 sc1
  buffer_load_dwordx4 a[216:219], v2, s[8:11], s22 offen offset:2048 sc1
  buffer_load_dwordx4 a[220:223], v2, s[8:11], s22 offen offset:3072 sc1
  v_lshl_add_u32 v5, v3, 2, 0
  v_cmp_le_u32 s[40:41], v5, v4
  v_lshl_add_u32 v5, v3, 2, 1
  v_cmp_le_u32 s[42:43], v5, v4
  v_lshl_add_u32 v5, v3, 2, 2
  v_cmp_le_u32 s[44:45], v5, v4
  v_lshl_add_u32 v5, v3, 2, 3
  v_cmp_le_u32 s[46:47], v5, v4
  v_cmp_gt_u32 s[48:49], 2, v3
  v_mov_b32 v6, 0xff800000
  s_waitcnt vmcnt(0)
  s_lshl_b32 s25, s17, 7
  s_add_u32 s25, s25, 88494080
  v_mov_b32 v5, 1
  v_mov_b32 v7, 0
  s_waitcnt vmcnt(0)
  s_mov_b64 exec, 1
  buffer_atomic_add v5, v7, s[8:11], s25 offen
  s_mov_b64 exec, -1
  v_mfma_f32_16x16x32_bf16 v[8:11], a[112:115], a[0:3], 0
  v_mfma_f32_16x16x32_bf16 v[12:15], a[112:115], a[56:59], 0
  v_mfma_f32_16x16x32_bf16 v[16:19], a[168:171], a[56:59], 0
  v_mfma_f32_16x16x32_bf16 v[8:11], a[116:119], a[4:7], v[8:11]
  v_mfma_f32_16x16x32_bf16 v[12:15], a[116:119], a[60:63], v[12:15]
  v_mfma_f32_16x16x32_bf16 v[16:19], a[172:175], a[60:63], v[16:19]
  v_mfma_f32_16x16x32_bf16 v[8:11], a[120:123], a[8:11], v[8:11]
  v_mfma_f32_16x16x32_bf16 v[12:15], a[120:123], a[64:67], v[12:15]
  v_mfma_f32_16x16x32_bf16 v[16:19], a[176:179], a[64:67], v[16:19]
  v_mfma_f32_16x16x32_bf16 v[8:11], a[124:127], a[12:15], v[8:11]
  v_mfma_f32_16x16x32_bf16 v[12:15], a[124:127], a[68:71], v[12:15]
  v_mfma_f32_16x16x32_bf16 v[16:19], a[180:183], a[68:71], v[16:19]
  v_mfma_f32_16x16x32_bf16 v[8:11], a[128:131], a[16:19], v[8:11]
  v_mfma_f32_16x16x32_bf16 v[12:15], a[128:131], a[72:75], v[12:15]
  v_mfma_f32_16x16x32_bf16 v[16:19], a[184:187], a[72:75], v[16:19]
  v_mfma_f32_16x16x32_bf16 v[8:11], a[132:135], a[20:23], v[8:11]
  v_mfma_f32_16x16x32_bf16 v[12:15], a[132:135], a[76:79], v[12:15]
  v_mfma_f32_16x16x32_bf16 v[16:19], a[188:191], a[76:79], v[16:19]
  v_mfma_f32_16x16x32_bf16 v[8:11], a[136:139], a[24:27], v[8:11]
  v_mfma_f32_16x16x32_bf16 v[12:15], a[136:139], a[80:83], v[12:15]
  v_mfma_f32_16x16x32_bf16 v[16:19], a[192:195], a[80:83], v[16:19]
  v_mfma_f32_16x16x32_bf16 v[8:11], a[140:143], a[28:31], v[8:11]
  v_mfma_f32_16x16x32_bf16 v[12:15], a[140:143], a[84:87], v[12:15]
  v_mfma_f32_16x16x32_bf16 v[16:19], a[196:199], a[84:87], v[16:19]
  v_mfma_f32_16x16x32_bf16 v[8:11], a[144:147], a[32:35], v[8:11]
  v_mfma_f32_16x16x32_bf16 v[12:15], a[144:147], a[88:91], v[12:15]
  v_mfma_f32_16x16x32_bf16 v[16:19], a[200:203], a[88:91], v[16:19]
  v_mfma_f32_16x16x32_bf16 v[8:11], a[148:151], a[36:39], v[8:11]
  v_mfma_f32_16x16x32_bf16 v[12:15], a[148:151], a[92:95], v[12:15]
  v_mfma_f32_16x16x32_bf16 v[16:19], a[204:207], a[92:95], v[16:19]
  v_mfma_f32_16x16x32_bf16 v[8:11], a[152:155], a[40:43], v[8:11]
  v_mfma_f32_16x16x32_bf16 v[12:15], a[152:155], a[96:99], v[12:15]
  v_mfma_f32_16x16x32_bf16 v[16:19], a[208:211], a[96:99], v[16:19]
  v_mfma_f32_16x16x32_bf16 v[8:11], a[156:159], a[44:47], v[8:11]
  v_mfma_f32_16x16x32_bf16 v[12:15], a[156:159], a[100:103], v[12:15]
  v_mfma_f32_16x16x32_bf16 v[16:19], a[212:215], a[100:103], v[16:19]
  v_mfma_f32_16x16x32_bf16 v[8:11], a[160:163], a[48:51], v[8:11]
  v_mfma_f32_16x16x32_bf16 v[12:15], a[160:163], a[104:107], v[12:15]
  v_mfma_f32_16x16x32_bf16 v[16:19], a[216:219], a[104:107], v[16:19]
  v_mfma_f32_16x16x32_bf16 v[8:11], a[164:167], a[52:55], v[8:11]
  v_mfma_f32_16x16x32_bf16 v[12:15], a[164:167], a[108:111], v[12:15]
  v_mfma_f32_16x16x32_bf16 v[16:19], a[220:223], a[108:111], v[16:19]
  s_mul_i32 s22, s20, 448
  v_mov_b32 v62, s22
  s_mov_b32 s30, 0
wp_pm:
  s_cmp_ge_u32 s17, 64
  s_cbranch_scc1 wp_pf
  buffer_load_dword v61, v62, s[8:11], s24 offen sc1
  s_waitcnt vmcnt(0)
  v_cmp_eq_u32 vcc, -1, v61
  s_cbranch_vccnz wp_pr
wp_pf:
  s_add_u32 s22, s24, 4096
  buffer_load_dwordx4 v[64:67], v2, s[8:11], s24 offen offset:0 sc1
  buffer_load_dwordx4 v[68:71], v2, s[8:11], s24 offen offset:1024 sc1
  buffer_load_dwordx4 v[72:75], v2, s[8:11], s24 offen offset:2048 sc1
  buffer_load_dwordx4 v[76:79], v2, s[8:11], s24 offen offset:3072 sc1
  buffer_load_dwordx4 v[80:83], v2, s[8:11], s22 offen offset:0 sc1
  buffer_load_dwordx4 v[84:87], v2, s[8:11], s22 offen offset:1024 sc1
  buffer_load_dwordx4 v[88:91], v2, s[8:11], s22 offen offset:2048 sc1
  s_waitcnt vmcnt(0)
  v_max_u32 v61, v64, v65
  v_max3_u32 v61, v61, v66, v67
  v_max3_u32 v61, v61, v68, v69
  v_max3_u32 v61, v61, v70, v71
  v_max3_u32 v61, v61, v72, v73
  v_max3_u32 v61, v61, v74, v75
  v_max3_u32 v61, v61, v76, v77
  v_max3_u32 v61, v61, v78, v79
  v_max3_u32 v61, v61, v80, v81
  v_max3_u32 v61, v61, v82, v83
  v_max3_u32 v61, v61, v84, v85
  v_max3_u32 v61, v61, v86, v87
  v_max3_u32 v61, v61, v88, v89
  v_max3_u32 v61, v61, v90, v91
  v_cmp_eq_u32 vcc, -1, v61
  s_cbranch_vccz wp_pk
wp_pr:
  s_sleep 4
  s_cmp_ge_u32 s17, 56
  s_cbranch_scc1 wp_pm_bo
  s_sleep 127
wp_pm_bo:
  s_add_u32 s30, s30, 1
  s_cmp_lt_u32 s30, 2000000
  s_cbranch_scc1 wp_pm
  s_branch wp_abort
wp_pk:
  buffer_load_dword v250, v251, s[8:11], 0 offen sc1
  v_mfma_f32_16x16x32_bf16 v[20:23], v[64:67], a[0:3], 0
  v_mfma_f32_16x16x32_bf16 v[24:27], v[64:67], a[4:7], 0
  v_mfma_f32_16x16x32_bf16 v[28:31], v[64:67], a[56:59], 0
  v_mfma_f32_16x16x32_bf16 v[32:35], v[64:67], a[60:63], 0
  v_mfma_f32_16x16x32_bf16 v[20:23], v[68:71], a[8:11], v[20:23]
  v_mfma_f32_16x16x32_bf16 v[24:27], v[68:71], a[12:15], v[24:27]
  v_mfma_f32_16x16x32_bf16 v[28:31], v[68:71], a[64:67], v[28:31]
  v_mfma_f32_16x16x32_bf16 v[32:35], v[68:71], a[68:71], v[32:35]
  v_mfma_f32_16x16x32_bf16 v[20:23], v[72:75], a[16:19], v[20:23]
  v_mfma_f32_16x16x32_bf16 v[24:27], v[72:75], a[20:23], v[24:27]
  v_mfma_f32_16x16x32_bf16 v[28:31], v[72:75], a[72:75], v[28:31]
  v_mfma_f32_16x16x32_bf16 v[32:35], v[72:75], a[76:79], v[32:35]
  v_mfma_f32_16x16x32_bf16 v[20:23], v[76:79], a[24:27], v[20:23]
  v_mfma_f32_16x16x32_bf16 v[24:27], v[76:79], a[28:31], v[24:27]
  v_mfma_f32_16x16x32_bf16 v[28:31], v[76:79], a[80:83], v[28:31]
  v_mfma_f32_16x16x32_bf16 v[32:35], v[76:79], a[84:87], v[32:35]
  v_mfma_f32_16x16x32_bf16 v[20:23], v[80:83], a[32:35], v[20:23]
  v_mfma_f32_16x16x32_bf16 v[24:27], v[80:83], a[36:39], v[24:27]
  v_mfma_f32_16x16x32_bf16 v[28:31], v[80:83], a[88:91], v[28:31]
  v_mfma_f32_16x16x32_bf16 v[32:35], v[80:83], a[92:95], v[32:35]
  v_mfma_f32_16x16x32_bf16 v[20:23], v[84:87], a[40:43], v[20:23]
  v_mfma_f32_16x16x32_bf16 v[24:27], v[84:87], a[44:47], v[24:27]
  v_mfma_f32_16x16x32_bf16 v[28:31], v[84:87], a[96:99], v[28:31]
  v_mfma_f32_16x16x32_bf16 v[32:35], v[84:87], a[100:103], v[32:35]
  v_mfma_f32_16x16x32_bf16 v[20:23], v[88:91], a[48:51], v[20:23]
  v_mfma_f32_16x16x32_bf16 v[24:27], v[88:91], a[52:55], v[24:27]
  v_mfma_f32_16x16x32_bf16 v[28:31], v[88:91], a[104:107], v[28:31]
  v_mfma_f32_16x16x32_bf16 v[32:35], v[88:91], a[108:111], v[32:35]
  v_cndmask_b32 v8, v6, v8, s[40:41]
  v_cndmask_b32 v9, v6, v9, s[42:43]
  v_cndmask_b32 v10, v6, v10, s[44:45]
  v_cndmask_b32 v11, v6, v11, s[46:47]
  v_cndmask_b32 v20, v24, v20, s[48:49]
  v_cndmask_b32 v21, v25, v21, s[48:49]
  v_cndmask_b32 v22, v26, v22, s[48:49]
  v_cndmask_b32 v23, v27, v23, s[48:49]
  v_mov_b32 v24, v20
  v_mov_b32 v25, v21
  v_mov_b32 v26, v22
  v_mov_b32 v27, v23
  v_permlane32_swap_b32 v20, v24
  v_permlane32_swap_b32 v21, v25
  v_permlane32_swap_b32 v22, v26
  v_permlane32_swap_b32 v23, v27
  v_add_f32 v20, v20, v24
  v_add_f32 v21, v21, v25
  v_add_f32 v22, v22, v26
  v_add_f32 v23, v23, v27
  v_max3_f32 v40, v8, v9, v10
  v_max3_f32 v40, v40, v11, v20
  v_max3_f32 v40, v40, v21, v22
  v_max_f32 v40, v40, v23
  v_mov_b32 v41, v40
  s_nop 1
  v_permlane16_swap_b32 v40, v41
  v_max_f32 v40, v40, v41
  v_mov_b32 v41, v40
  s_nop 1
  v_permlane32_swap_b32 v40, v41
  v_max_f32 v40, v40, v41
  v_sub_f32 v8, v8, v40
  v_sub_f32 v9, v9, v40
  v_sub_f32 v10, v10, v40
  v_sub_f32 v11, v11, v40
  v_sub_f32 v20, v20, v40
  v_sub_f32 v21, v21, v40
  v_sub_f32 v22, v22, v40
  v_sub_f32 v23, v23, v40
  v_exp_f32 v8, v8
  v_exp_f32 v9, v9
  v_exp_f32 v10, v10
  v_exp_f32 v11, v11
  v_exp_f32 v20, v20
  v_exp_f32 v21, v21
  v_exp_f32 v22, v22
  v_exp_f32 v23, v23
  v_add_f32 v42, v20, v21
  v_add_f32 v43, v22, v23
  v_add_f32 v42, v42, v43
  v_mul_f32 v42, 0.5, v42
  v_add_f32 v42, v42, v8
  v_add_f32 v42, v42, v9
  v_add_f32 v42, v42, v10
  v_add_f32 v42, v42, v11
  v_mov_b32 v41, v42
  s_nop 1
  v_permlane16_swap_b32 v42, v41
  v_add_f32 v42, v42, v41
  v_mov_b32 v41, v42
  s_nop 1
  v_permlane32_swap_b32 v42, v41
  v_add_f32 v42, v42, v41
  v_rcp_f32 v42, v42
  s_nop 0
  v_mul_f32 v8, v8, v42
  v_mul_f32 v9, v9, v42
  v_mul_f32 v10, v10, v42
  v_mul_f32 v11, v11, v42
  v_mul_f32 v20, v20, v42
  v_mul_f32 v21, v21, v42
  v_mul_f32 v22, v22, v42
  v_mul_f32 v23, v23, v42
  v_cvt_pk_bf16_f32 v44, v8, 0
  v_cvt_pk_bf16_f32 v45, v9, 0
  v_cvt_pk_bf16_f32 v46, v10, 0
  v_cvt_pk_bf16_f32 v47, v11, 0
  v_cvt_pk_bf16_f32 v48, v20, v21
  v_cvt_pk_bf16_f32 v49, v22, v23
  v_min_u32 v44, -2, v44
  v_min_u32 v45, -2, v45
  v_min_u32 v46, -2, v46
  v_min_u32 v47, -2, v47
  v_min_u32 v48, -2, v48
  v_min_u32 v49, -2, v49
  buffer_store_dwordx4 v[44:47], v2, s[8:11], s26 offen sc1
  s_mov_b64 exec, s[50:51]
  buffer_store_dwordx2 v[48:49], v2, s[8:11], s27 offen sc1
  s_mov_b64 exec, -1
  s_add_u32 s26, s26, 20480
  s_add_u32 s27, s27, 20480
  v_cndmask_b32 v16, v6, v16, s[40:41]
  v_cndmask_b32 v17, v6, v17, s[42:43]
  v_cndmask_b32 v18, v6, v18, s[44:45]
  v_cndmask_b32 v19, v6, v19, s[46:47]
  v_cndmask_b32 v28, v32, v28, s[48:49]
  v_cndmask_b32 v29, v33, v29, s[48:49]
  v_cndmask_b32 v30, v34, v30, s[48:49]
  v_cndmask_b32 v31, v35, v31, s[48:49]
  v_mov_b32 v32, v28
  v_mov_b32 v33, v29
  v_mov_b32 v34, v30
  v_mov_b32 v35, v31
  v_permlane32_swap_b32 v28, v32
  v_permlane32_swap_b32 v29, v33
  v_permlane32_swap_b32 v30, v34
  v_permlane32_swap_b32 v31, v35
  v_add_f32 v28, v28, v32
  v_add_f32 v29, v29, v33
  v_add_f32 v30, v30, v34
  v_add_f32 v31, v31, v35
  v_max3_f32 v40, v12, v13, v14
  v_max3_f32 v40, v40, v15, v16
  v_max3_f32 v40, v40, v17, v18
  v_max3_f32 v40, v40, v19, v28
  v_max3_f32 v40, v40, v29, v30
  v_max_f32 v40, v40, v31
  v_mov_b32 v41, v40
  s_nop 1
  v_permlane16_swap_b32 v40, v41
  v_max_f32 v40, v40, v41
  v_mov_b32 v41, v40
  s_nop 1
  v_permlane32_swap_b32 v40, v41
  v_max_f32 v40, v40, v41
  v_sub_f32 v12, v12, v40
  v_sub_f32 v13, v13, v40
  v_sub_f32 v14, v14, v40
  v_sub_f32 v15, v15, v40
  v_sub_f32 v16, v16, v40
  v_sub_f32 v17, v17, v40
  v_sub_f32 v18, v18, v40
  v_sub_f32 v19, v19, v40
  v_sub_f32 v28, v28, v40
  v_sub_f32 v29, v29, v40
  v_sub_f32 v30, v30, v40
  v_sub_f32 v31, v31, v40
  v_exp_f32 v12, v12
  v_exp_f32 v13, v13
  v_exp_f32 v14, v14
  v_exp_f32 v15, v15
  v_exp_f32 v16, v16
  v_exp_f32 v17, v17
  v_exp_f32 v18, v18
  v_exp_f32 v19, v19
  v_exp_f32 v28, v28
  v_exp_f32 v29, v29
  v_exp_f32 v30, v30
  v_exp_f32 v31, v31
  v_add_f32 v42, v28, v29
  v_add_f32 v43, v30, v31
  v_add_f32 v42, v42, v43
  v_mul_f32 v42, 0.5, v42
  v_add_f32 v42, v42, v12
  v_add_f32 v42, v42, v13
  v_add_f32 v42, v42, v14
  v_add_f32 v42, v42, v15
  v_add_f32 v42, v42, v16
  v_add_f32 v42, v42, v17
  v_add_f32 v42, v42, v18
  v_add_f32 v42, v42, v19
  v_mov_b32 v41, v42
  s_nop 1
  v_permlane16_swap_b32 v42, v41
  v_add_f32 v42, v42, v41
  v_mov_b32 v41, v42
  s_nop 1
  v_permlane32_swap_b32 v42, v41
  v_add_f32 v42, v42, v41
  v_rcp_f32 v42, v42
  s_nop 0
  v_mul_f32 v12, v12, v42
  v_mul_f32 v13, v13, v42
  v_mul_f32 v14, v14, v42
  v_mul_f32 v15, v15, v42
  v_mul_f32 v16, v16, v42
  v_mul_f32 v17, v17, v42
  v_mul_f32 v18, v18, v42
  v_mul_f32 v19, v19, v42
  v_mul_f32 v28, v28, v42
  v_mul_f32 v29, v29, v42
  v_mul_f32 v30, v30, v42
  v_mul_f32 v31, v31, v42
  v_cvt_pk_bf16_f32 v52, v12, v16
  v_cvt_pk_bf16_f32 v53, v13, v17
  v_cvt_pk_bf16_f32 v54, v14, v18
  v_cvt_pk_bf16_f32 v55, v15, v19
  v_cvt_pk_bf16_f32 v56, v28, v29
  v_cvt_pk_bf16_f32 v57, v30, v31
  v_min_u32 v52, -2, v52
  v_min_u32 v53, -2, v53
  v_min_u32 v54, -2, v54
  v_min_u32 v55, -2, v55
  v_min_u32 v56, -2, v56
  v_min_u32 v57, -2, v57
  buffer_store_dwordx4 v[52:55], v2, s[8:11], s26 offen sc1
  s_mov_b64 exec, s[50:51]
  buffer_store_dwordx2 v[56:57], v2, s[8:11], s27 offen sc1
  s_mov_b64 exec, -1
  s_branch wk_loop
wk_toko:
  s_load_dwordx2 s[36:37], s[0:1], 112
  s_waitcnt lgkmcnt(0)
  s_mov_b32 s92, s36
  s_and_b32 s93, s37, 0xffff
  s_mov_b32 s94, 3670016
  s_mov_b32 s95, 0x20000
  s_lshl_b32 s20, s18, 2
  s_add_u32 s20, s20, s16
  s_mul_i32 s24, s20, 65
  s_add_u32 s24, s24, s17
  s_lshl_b32 s24, s24, 13
  s_add_u32 s24, s24, 76869632
  s_mul_i32 s21, s20, 28672
  s_mul_i32 s22, s17, 458752
  s_add_u32 s21, s21, s22
  s_add_u32 s21, s21, 42205184
  s_lshl_b32 s25, s17, 1
  s_mul_i32 s25, s25, 20480
  s_add_u32 s25, s25, 85381120
  v_mov_b32 v5, v2
  v_min_u32 v6, 11, v4
  v_mad_u32_u24 v6, v3, 12, v6
  v_lshlrev_b32 v6, 4, v6
  v_add_u32 v6, 1024, v6
  v_lshrrev_b32 v8, 1, v3
  v_lshl_add_u32 v8, v8, 4, v4
  v_lshlrev_b32 v8, 4, v8
  v_and_b32 v9, 1, v3
  v_lshl_add_u32 v7, v9, 3, v8
  s_lshr_b32 s26, s17, 3
  s_lshl_b32 s26, s26, 4
  s_add_u32 s26, s26, s20
  s_lshl_b32 s26, s26, 7
  s_add_u32 s26, s26, 88461312
  v_mov_b32 v60, 0
  s_mov_b32 s30, 0
wo_wv:
  buffer_load_dword v61, v60, s[8:11], s26 offen sc1
  s_waitcnt vmcnt(0)
  v_cmp_ne_u32 vcc, 56, v61
  s_cbranch_vccz wo_wv_ok
  s_sleep 4
  s_cmp_ge_u32 s17, 56
  s_cbranch_scc1 wo_wv_bo
  s_sleep 127
wo_wv_bo:
  s_add_u32 s30, s30, 1
  s_cmp_lt_u32 s30, 2000000
  s_cbranch_scc1 wo_wv
  s_branch wo_abort
wo_wv_ok:
  s_add_u32 s22, s21, 0
  buffer_load_dwordx4 a[0:3], v5, s[8:11], s22 offen offset:0 sc1
  buffer_load_dwordx4 a[4:7], v6, s[8:11], s22 offen offset:0 sc1
  buffer_load_dwordx4 a[8:11], v5, s[8:11], s22 offen offset:1792 sc1
  buffer_load_dwordx4 a[12:15], v6, s[8:11], s22 offen offset:1792 sc1
  s_add_u32 s22, s21, 3584
  buffer_load_dwordx4 a[16:19], v5, s[8:11], s22 offen offset:0 sc1
  buffer_load_dwordx4 a[20:23], v6, s[8:11], s22 offen offset:0 sc1
  buffer_load_dwordx4 a[24:27], v5, s[8:11], s22 offen offset:1792 sc1
  buffer_load_dwordx4 a[28:31], v6, s[8:11], s22 offen offset:1792 sc1
  s_add_u32 s22, s21, 7168
  buffer_load_dwordx4 a[32:35], v5, s[8:11], s22 offen offset:0 sc1
  buffer_load_dwordx4 a[36:39], v6, s[8:11], s22 offen offset:0 sc1
  buffer_load_dwordx4 a[40:43], v5, s[8:11], s22 offen offset:1792 sc1
  buffer_load_dwordx4 a[44:47], v6, s[8:11], s22 offen offset:1792 sc1
  s_add_u32 s22, s21, 10752
  buffer_load_dwordx4 a[48:51], v5, s[8:11], s22 offen offset:0 sc1
  buffer_load_dwordx4 a[52:55], v6, s[8:11], s22 offen offset:0 sc1
  buffer_load_dwordx4 a[56:59], v5, s[8:11], s22 offen offset:1792 sc1
  buffer_load_dwordx4 a[60:63], v6, s[8:11], s22 offen offset:1792 sc1
  s_add_u32 s22, s21, 14336
  buffer_load_dwordx4 a[64:67], v5, s[8:11], s22 offen offset:0 sc1
  buffer_load_dwordx4 a[68:71], v6, s[8:11], s22 offen offset:0 sc1
  buffer_load_dwordx4 a[72:75], v5, s[8:11], s22 offen offset:1792 sc1
  buffer_load_dwordx4 a[76:79], v6, s[8:11], s22 offen offset:1792 sc1
  s_add_u32 s22, s21, 17920
  buffer_load_dwordx4 a[80:83], v5, s[8:11], s22 offen offset:0 sc1
  buffer_load_dwordx4 a[84:87], v6, s[8:11], s22 offen offset:0 sc1
  buffer_load_dwordx4 a[88:91], v5, s[8:11], s22 offen offset:1792 sc1
  buffer_load_dwordx4 a[92:95], v6, s[8:11], s22 offen offset:1792 sc1
  s_add_u32 s22, s21, 21504
  buffer_load_dwordx4 a[96:99], v5, s[8:11], s22 offen offset:0 sc1
  buffer_load_dwordx4 a[100:103], v6, s[8:11], s22 offen offset:0 sc1
  buffer_load_dwordx4 a[104:107], v5, s[8:11], s22 offen offset:1792 sc1
  buffer_load_dwordx4 a[108:111], v6, s[8:11], s22 offen offset:1792 sc1
  s_add_u32 s22, s21, 25088
  buffer_load_dwordx4 a[112:115], v5, s[8:11], s22 offen offset:0 sc1
  buffer_load_dwordx4 a[116:119], v6, s[8:11], s22 offen offset:0 sc1
  buffer_load_dwordx4 a[120:123], v5, s[8:11], s22 offen offset:1792 sc1
  buffer_load_dwordx4 a[124:127], v6, s[8:11], s22 offen offset:1792 sc1
  s_lshl_b32 s26, s20, 6
  s_add_u32 s26, s26, s17
  s_lshl_b32 s26, s26, 4
  s_add_u32 s26, s26, 88502272
  v_lshlrev_b32 v60, 2, v3
  s_mov_b32 s30, 0
wo_wt:
  buffer_load_dword v61, v60, s[8:11], s26 offen sc1
  s_waitcnt vmcnt(0)
  v_cmp_ne_u32 vcc, 1, v61
  s_cbranch_vccz wo_wt_ok
  s_sleep 4
  s_cmp_ge_u32 s17, 56
  s_cbranch_scc1 wo_wt_bo
  s_sleep 127
wo_wt_bo:
  s_add_u32 s30, s30, 1
  s_cmp_lt_u32 s30, 2000000
  s_cbranch_scc1 wo_wt
  s_branch wo_abort
wo_wt_ok:
  s_lshl_b32 s26, s17, 7
  s_add_u32 s26, s26, 88494080
  v_mov_b32 v60, 0
  s_mov_b32 s30, 0
wo_wp:
  buffer_load_dword v61, v60, s[8:11], s26 offen sc1
  s_waitcnt vmcnt(0)
  v_cmp_ne_u32 vcc, 16, v61
  s_cbranch_vccz wo_wp_ok
  s_sleep 4
  s_cmp_ge_u32 s17, 56
  s_cbranch_scc1 wo_wp_bo
  s_sleep 127
wo_wp_bo:
  s_add_u32 s30, s30, 1
  s_cmp_lt_u32 s30, 2000000
  s_cbranch_scc1 wo_wp
  s_branch wo_abort
wo_wp_ok:
  s_lshl_b32 s28, s16, 12
  s_add_u32 s26, s25, s28
  s_add_u32 s27, s26, 20480
  s_lshl_b32 s28, s16, 10
  s_add_u32 s28, s28, s25
  s_add_u32 s28, s28, 16384
  s_add_u32 s29, s28, 20480
  s_add_u32 s23, s24, 4096
  s_mov_b32 s30, 0
wo_pl:
  buffer_load_dwordx4 v[64:67], v2, s[8:11], s26 offen offset:0 sc1
  buffer_load_dwordx4 v[68:71], v2, s[8:11], s26 offen offset:1024 sc1
  buffer_load_dwordx4 v[72:75], v2, s[8:11], s26 offen offset:2048 sc1
  buffer_load_dwordx4 v[76:79], v2, s[8:11], s26 offen offset:3072 sc1
  buffer_load_dwordx4 v[80:83], v2, s[8:11], s28 offen sc1
  buffer_load_dwordx4 v[84:87], v2, s[8:11], s27 offen offset:0 sc1
  buffer_load_dwordx4 v[88:91], v2, s[8:11], s27 offen offset:1024 sc1
  buffer_load_dwordx4 v[92:95], v2, s[8:11], s27 offen offset:2048 sc1
  buffer_load_dwordx4 v[96:99], v2, s[8:11], s27 offen offset:3072 sc1
  buffer_load_dwordx4 v[100:103], v2, s[8:11], s29 offen sc1
  buffer_load_dwordx2 v[28:29], v7, s[8:11], s24 offen offset:0 sc1
  buffer_load_dwordx2 v[30:31], v7, s[8:11], s24 offen offset:512 sc1
  buffer_load_dwordx2 v[32:33], v7, s[8:11], s24 offen offset:1024 sc1
  buffer_load_dwordx2 v[34:35], v7, s[8:11], s24 offen offset:1536 sc1
  buffer_load_dwordx2 v[36:37], v7, s[8:11], s24 offen offset:2048 sc1
  buffer_load_dwordx2 v[38:39], v7, s[8:11], s24 offen offset:2560 sc1
  buffer_load_dwordx2 v[40:41], v7, s[8:11], s24 offen offset:3072 sc1
  buffer_load_dwordx2 v[42:43], v7, s[8:11], s24 offen offset:3584 sc1
  buffer_load_dwordx2 v[44:45], v7, s[8:11], s23 offen offset:0 sc1
  buffer_load_dwordx2 v[46:47], v7, s[8:11], s23 offen offset:512 sc1
  buffer_load_dwordx2 v[48:49], v7, s[8:11], s23 offen offset:1024 sc1
  buffer_load_dwordx2 v[50:51], v7, s[8:11], s23 offen offset:1536 sc1
  buffer_load_dwordx2 v[52:53], v7, s[8:11], s23 offen offset:2048 sc1
  buffer_load_dwordx2 v[54:55], v7, s[8:11], s23 offen offset:2560 sc1
  buffer_load_dwordx2 v[56:57], v7, s[8:11], s23 offen offset:3072 sc1
  buffer_load_dwordx2 v[58:59], v7, s[8:11], s23 offen offset:3584 sc1
  s_waitcnt vmcnt(16)
  v_max_u32 v61, v64, v65
  v_max3_u32 v61, v61, v66, v67
  v_max3_u32 v61, v61, v68, v69
  v_max3_u32 v61, v61, v70, v71
  v_max3_u32 v61, v61, v72, v73
  v_max3_u32 v61, v61, v74, v75
  v_max3_u32 v61, v61, v76, v77
  v_max3_u32 v61, v61, v78, v79
  v_max3_u32 v61, v61, v80, v81
  v_max3_u32 v61, v61, v82, v83
  v_max3_u32 v61, v61, v84, v85
  v_max3_u32 v61, v61, v86, v87
  v_max3_u32 v61, v61, v88, v89
  v_max3_u32 v61, v61, v90, v91
  v_max3_u32 v61, v61, v92, v93
  v_max3_u32 v61, v61, v94, v95
  v_max3_u32 v61, v61, v96, v97
  v_max3_u32 v61, v61, v98, v99
  v_max3_u32 v61, v61, v100, v101
  v_max3_u32 v61, v61, v102, v103
  s_mul_i32 s22, s16, 10240
  v_add_u32 v62, s22, v2
  ds_write_b128 v62, v[64:67] offset:0
  ds_write_b128 v62, v[68:71] offset:1024
  ds_write_b128 v62, v[72:75] offset:2048
  ds_write_b128 v62, v[76:79] offset:3072
  ds_write_b128 v62, v[80:83] offset:4096
  ds_write_b128 v62, v[84:87] offset:5120
  ds_write_b128 v62, v[88:91] offset:6144
  ds_write_b128 v62, v[92:95] offset:7168
  ds_write_b128 v62, v[96:99] offset:8192
  ds_write_b128 v62, v[100:103] offset:9216
  s_waitcnt vmcnt(0)
  v_max3_u32 v61, v61, v28, v29
  v_max3_u32 v61, v61, v30, v31
  v_max3_u32 v61, v61, v32, v33
  v_max3_u32 v61, v61, v34, v35
  v_max3_u32 v61, v61, v36, v37
  v_max3_u32 v61, v61, v38, v39
  v_max3_u32 v61, v61, v40, v41
  v_max3_u32 v61, v61, v42, v43
  v_max3_u32 v61, v61, v44, v45
  v_max3_u32 v61, v61, v46, v47
  v_max3_u32 v61, v61, v48, v49
  v_max3_u32 v61, v61, v50, v51
  v_max3_u32 v61, v61, v52, v53
  v_max3_u32 v61, v61, v54, v55
  v_max3_u32 v61, v61, v56, v57
  v_max3_u32 v61, v61, v58, v59
  v_cmp_eq_u32 vcc, -1, v61
  s_cbranch_vccz wo_pk
  s_waitcnt lgkmcnt(0)
  s_sleep 1
  s_cmp_ge_u32 s17, 56
  s_cbranch_scc1 wo_pl_bo
  s_sleep 127
wo_pl_bo:
  s_add_u32 s30, s30, 1
  s_cmp_lt_u32 s30, 2000000
  s_cbranch_scc1 wo_pl
  s_branch wo_abort
wo_pk:
  buffer_load_dword v250, v251, s[8:11], 0 offen sc1
  s_waitcnt lgkmcnt(0)
  s_barrier
  ds_read_b128 v[64:67], v2 offset:0
  ds_read_b128 v[68:71], v2 offset:5120
  ds_read_b128 v[72:75], v2 offset:1024
  ds_read_b128 v[76:79], v2 offset:6144
  ds_read_b128 v[80:83], v2 offset:2048
  ds_read_b128 v[84:87], v2 offset:7168
  ds_read_b128 v[88:91], v2 offset:3072
  ds_read_b128 v[92:95], v2 offset:8192
  s_waitcnt lgkmcnt(7)
  v_mfma_f32_16x16x32_bf16 v[12:15], a[0:3], v[64:67], 0
  ds_read_b128 v[96:99], v2 offset:4096
  v_mfma_f32_16x16x32_bf16 v[20:23], a[4:7], v[64:67], 0
  s_waitcnt lgkmcnt(7)
  v_mfma_f32_16x16x32_bf16 v[16:19], a[0:3], v[68:71], 0
  ds_read_b128 v[100:103], v2 offset:9216
  v_mfma_f32_16x16x32_bf16 v[24:27], a[4:7], v[68:71], 0
  s_waitcnt lgkmcnt(7)
  v_mfma_f32_16x16x32_bf16 v[12:15], a[8:11], v[72:75], v[12:15]
  ds_read_b128 v[64:67], v2 offset:10240
  v_mfma_f32_16x16x32_bf16 v[20:23], a[12:15], v[72:75], v[20:23]
  s_waitcnt lgkmcnt(7)
  v_mfma_f32_16x16x32_bf16 v[16:19], a[8:11], v[76:79], v[16:19]
  ds_read_b128 v[68:71], v2 offset:15360
  v_mfma_f32_16x16x32_bf16 v[24:27], a[12:15], v[76:79], v[24:27]
  s_waitcnt lgkmcnt(7)
  v_mfma_f32_16x16x32_bf16 v[12:15], a[16:19], v[80:83], v[12:15]
  ds_read_b128 v[72:75], v2 offset:11264
  v_mfma_f32_16x16x32_bf16 v[20:23], a[20:23], v[80:83], v[20:23]
  s_waitcnt lgkmcnt(7)
  v_mfma_f32_16x16x32_bf16 v[16:19], a[16:19], v[84:87], v[16:19]
  ds_read_b128 v[76:79], v2 offset:16384
  v_mfma_f32_16x16x32_bf16 v[24:27], a[20:23], v[84:87], v[24:27]
  s_waitcnt lgkmcnt(7)
  v_mfma_f32_16x16x32_bf16 v[12:15], a[24:27], v[88:91], v[12:15]
  ds_read_b128 v[80:83], v2 offset:12288
  v_mfma_f32_16x16x32_bf16 v[20:23], a[28:31], v[88:91], v[20:23]
  s_waitcnt lgkmcnt(7)
  v_mfma_f32_16x16x32_bf16 v[16:19], a[24:27], v[92:95], v[16:19]
  ds_read_b128 v[84:87], v2 offset:17408
  v_mfma_f32_16x16x32_bf16 v[24:27], a[28:31], v[92:95], v[24:27]
  s_waitcnt lgkmcnt(7)
  v_mfma_f32_16x16x32_bf16 v[12:15], v[28:31], v[96:99], v[12:15]
  ds_read_b128 v[88:91], v2 offset:13312
  v_mfma_f32_16x16x32_bf16 v[20:23], v[32:35], v[96:99], v[20:23]
  s_waitcnt lgkmcnt(7)
  v_mfma_f32_16x16x32_bf16 v[16:19], v[28:31], v[100:103], v[16:19]
  ds_read_b128 v[92:95], v2 offset:18432
  v_mfma_f32_16x16x32_bf16 v[24:27], v[32:35], v[100:103], v[24:27]
  s_waitcnt lgkmcnt(7)
  v_mfma_f32_16x16x32_bf16 v[12:15], a[32:35], v[64:67], v[12:15]
  ds_read_b128 v[96:99], v2 offset:14336
  v_mfma_f32_16x16x32_bf16 v[20:23], a[36:39], v[64:67], v[20:23]
  s_waitcnt lgkmcnt(7)
  v_mfma_f32_16x16x32_bf16 v[16:19], a[32:35], v[68:71], v[16:19]
  ds_read_b128 v[100:103], v2 offset:19456
  v_mfma_f32_16x16x32_bf16 v[24:27], a[36:39], v[68:71], v[24:27]
  s_waitcnt lgkmcnt(7)
  v_mfma_f32_16x16x32_bf16 v[12:15], a[40:43], v[72:75], v[12:15]
  ds_read_b128 v[64:67], v2 offset:20480
  v_mfma_f32_16x16x32_bf16 v[20:23], a[44:47], v[72:75], v[20:23]
  s_waitcnt lgkmcnt(7)
  v_mfma_f32_16x16x32_bf16 v[16:19], a[40:43], v[76:79], v[16:19]
  ds_read_b128 v[68:71], v2 offset:25600
  v_mfma_f32_16x16x32_bf16 v[24:27], a[44:47], v[76:79], v[24:27]
  s_waitcnt lgkmcnt(7)
  v_mfma_f32_16x16x32_bf16 v[12:15], a[48:51], v[80:83], v[12:15]
  ds_read_b128 v[72:75], v2 offset:21504
  v_mfma_f32_16x16x32_bf16 v[20:23], a[52:55], v[80:83], v[20:23]
  s_waitcnt lgkmcnt(7)
  v_mfma_f32_16x16x32_bf16 v[16:19], a[48:51], v[84:87], v[16:19]
  ds_read_b128 v[76:79], v2 offset:26624
  v_mfma_f32_16x16x32_bf16 v[24:27], a[52:55], v[84:87], v[24:27]
  s_waitcnt lgkmcnt(7)
  v_mfma_f32_16x16x32_bf16 v[12:15], a[56:59], v[88:91], v[12:15]
  ds_read_b128 v[80:83], v2 offset:22528
  v_mfma_f32_16x16x32_bf16 v[20:23], a[60:63], v[88:91], v[20:23]
  s_waitcnt lgkmcnt(7)
  v_mfma_f32_16x16x32_bf16 v[16:19], a[56:59], v[92:95], v[16:19]
  ds_read_b128 v[84:87], v2 offset:27648
  v_mfma_f32_16x16x32_bf16 v[24:27], a[60:63], v[92:95], v[24:27]
  s_waitcnt lgkmcnt(7)
  v_mfma_f32_16x16x32_bf16 v[12:15], v[36:39], v[96:99], v[12:15]
  ds_read_b128 v[88:91], v2 offset:23552
  v_mfma_f32_16x16x32_bf16 v[20:23], v[40:43], v[96:99], v[20:23]
  s_waitcnt lgkmcnt(7)
  v_mfma_f32_16x16x32_bf16 v[16:19], v[36:39], v[100:103], v[16:19]
  ds_read_b128 v[92:95], v2 offset:28672
  v_mfma_f32_16x16x32_bf16 v[24:27], v[40:43], v[100:103], v[24:27]
  s_waitcnt lgkmcnt(7)
  v_mfma_f32_16x16x32_bf16 v[12:15], a[64:67], v[64:67], v[12:15]
  ds_read_b128 v[96:99], v2 offset:24576
  v_mfma_f32_16x16x32_bf16 v[20:23], a[68:71], v[64:67], v[20:23]
  s_waitcnt lgkmcnt(7)
  v_mfma_f32_16x16x32_bf16 v[16:19], a[64:67], v[68:71], v[16:19]
  ds_read_b128 v[100:103], v2 offset:29696
  v_mfma_f32_16x16x32_bf16 v[24:27], a[68:71], v[68:71], v[24:27]
  s_waitcnt lgkmcnt(7)
  v_mfma_f32_16x16x32_bf16 v[12:15], a[72:75], v[72:75], v[12:15]
  ds_read_b128 v[64:67], v2 offset:30720
  v_mfma_f32_16x16x32_bf16 v[20:23], a[76:79], v[72:75], v[20:23]
  s_waitcnt lgkmcnt(7)
  v_mfma_f32_16x16x32_bf16 v[16:19], a[72:75], v[76:79], v[16:19]
  ds_read_b128 v[68:71], v2 offset:35840
  v_mfma_f32_16x16x32_bf16 v[24:27], a[76:79], v[76:79], v[24:27]
  s_waitcnt lgkmcnt(7)
  v_mfma_f32_16x16x32_bf16 v[12:15], a[80:83], v[80:83], v[12:15]
  ds_read_b128 v[72:75], v2 offset:31744
  v_mfma_f32_16x16x32_bf16 v[20:23], a[84:87], v[80:83], v[20:23]
  s_waitcnt lgkmcnt(7)
  v_mfma_f32_16x16x32_bf16 v[16:19], a[80:83], v[84:87], v[16:19]
  ds_read_b128 v[76:79], v2 offset:36864
  v_mfma_f32_16x16x32_bf16 v[24:27], a[84:87], v[84:87], v[24:27]
  s_waitcnt lgkmcnt(7)
  v_mfma_f32_16x16x32_bf16 v[12:15], a[88:91], v[88:91], v[12:15]
  ds_read_b128 v[80:83], v2 offset:32768
  v_mfma_f32_16x16x32_bf16 v[20:23], a[92:95], v[88:91], v[20:23]
  s_waitcnt lgkmcnt(7)
  v_mfma_f32_16x16x32_bf16 v[16:19], a[88:91], v[92:95], v[16:19]
  ds_read_b128 v[84:87], v2 offset:37888
  v_mfma_f32_16x16x32_bf16 v[24:27], a[92:95], v[92:95], v[24:27]
  s_waitcnt lgkmcnt(7)
  v_mfma_f32_16x16x32_bf16 v[12:15], v[44:47], v[96:99], v[12:15]
  ds_read_b128 v[88:91], v2 offset:33792
  v_mfma_f32_16x16x32_bf16 v[20:23], v[48:51], v[96:99], v[20:23]
  s_waitcnt lgkmcnt(7)
  v_mfma_f32_16x16x32_bf16 v[16:19], v[44:47], v[100:103], v[16:19]
  ds_read_b128 v[92:95], v2 offset:38912
  v_mfma_f32_16x16x32_bf16 v[24:27], v[48:51], v[100:103], v[24:27]
  s_waitcnt lgkmcnt(7)
  v_mfma_f32_16x16x32_bf16 v[12:15], a[96:99], v[64:67], v[12:15]
  ds_read_b128 v[96:99], v2 offset:34816
  v_mfma_f32_16x16x32_bf16 v[20:23], a[100:103], v[64:67], v[20:23]
  s_waitcnt lgkmcnt(7)
  v_mfma_f32_16x16x32_bf16 v[16:19], a[96:99], v[68:71], v[16:19]
  ds_read_b128 v[100:103], v2 offset:39936
  v_mfma_f32_16x16x32_bf16 v[24:27], a[100:103], v[68:71], v[24:27]
  s_waitcnt lgkmcnt(7)
  v_mfma_f32_16x16x32_bf16 v[12:15], a[104:107], v[72:75], v[12:15]
  v_mfma_f32_16x16x32_bf16 v[20:23], a[108:111], v[72:75], v[20:23]
  s_waitcnt lgkmcnt(6)
  v_mfma_f32_16x16x32_bf16 v[16:19], a[104:107], v[76:79], v[16:19]
  v_mfma_f32_16x16x32_bf16 v[24:27], a[108:111], v[76:79], v[24:27]
  s_waitcnt lgkmcnt(5)
  v_mfma_f32_16x16x32_bf16 v[12:15], a[112:115], v[80:83], v[12:15]
  v_mfma_f32_16x16x32_bf16 v[20:23], a[116:119], v[80:83], v[20:23]
  s_waitcnt lgkmcnt(4)
  v_mfma_f32_16x16x32_bf16 v[16:19], a[112:115], v[84:87], v[16:19]
  v_mfma_f32_16x16x32_bf16 v[24:27], a[116:119], v[84:87], v[24:27]
  s_waitcnt lgkmcnt(3)
  v_mfma_f32_16x16x32_bf16 v[12:15], a[120:123], v[88:91], v[12:15]
  v_mfma_f32_16x16x32_bf16 v[20:23], a[124:127], v[88:91], v[20:23]
  s_waitcnt lgkmcnt(2)
  v_mfma_f32_16x16x32_bf16 v[16:19], a[120:123], v[92:95], v[16:19]
  v_mfma_f32_16x16x32_bf16 v[24:27], a[124:127], v[92:95], v[24:27]
  s_waitcnt lgkmcnt(1)
  v_mfma_f32_16x16x32_bf16 v[12:15], v[52:55], v[96:99], v[12:15]
  v_mfma_f32_16x16x32_bf16 v[20:23], v[56:59], v[96:99], v[20:23]
  s_waitcnt lgkmcnt(0)
  v_mfma_f32_16x16x32_bf16 v[16:19], v[52:55], v[100:103], v[16:19]
  v_mfma_f32_16x16x32_bf16 v[24:27], v[56:59], v[100:103], v[24:27]
  v_mul_u32_u24 v9, 1792, v4
  v_lshl_add_u32 v9, v3, 3, v9
  s_lshl_b32 s22, s20, 5
  v_add_u32 v8, s22, v9
  s_mul_i32 s22, s20, 24
  s_add_u32 s22, s22, 512
  v_add_u32 v9, s22, v9
  v_mov_b32 v10, 0x40000000
  v_cmp_eq_u32 vcc, 3, v3
  s_nop 1
  v_cndmask_b32 v9, v9, v10, vcc
  s_mul_i32 s26, s17, 57344
  s_add_u32 s26, s26, 896
  s_add_u32 s27, s26, 28672
  v_cvt_pk_bf16_f32 v108, v12, v13
  v_cvt_pk_bf16_f32 v109, v14, v15
  buffer_store_dwordx2 v[108:109], v8, s[92:95], s26 offen
  v_cvt_pk_bf16_f32 v110, v20, v21
  v_cvt_pk_bf16_f32 v111, v22, v23
  buffer_store_dwordx2 v[110:111], v9, s[92:95], s26 offen
  v_cvt_pk_bf16_f32 v112, v16, v17
  v_cvt_pk_bf16_f32 v113, v18, v19
  buffer_store_dwordx2 v[112:113], v8, s[92:95], s27 offen
  v_cvt_pk_bf16_f32 v114, v24, v25
  v_cvt_pk_bf16_f32 v115, v26, v27
  buffer_store_dwordx2 v[114:115], v9, s[92:95], s27 offen
  s_branch wk_loop
wp_abort:
wo_abort:
  s_branch cA_abort
wk_done:
ch_end:
  s_endpgm

.section .rodata,"a"
.p2align 6
.amdhsa_kernel main_kernel
  .amdhsa_next_free_vgpr 512
  .amdhsa_next_free_sgpr 102
  .amdhsa_accum_offset 256
  .amdhsa_group_segment_fixed_size 0
  .amdhsa_kernarg_size 136
  .amdhsa_user_sgpr_count 2
  .amdhsa_user_sgpr_kernarg_segment_ptr 1
  .amdhsa_system_sgpr_workgroup_id_x 1
.end_amdhsa_kernel
```

```asm
; @launch kernel=main_kernel grid=(256,1,1) block=(256,1,1) lds=163840
.amdgcn_target "amdgcn-amd-amdhsa--gfx950"
.text
.globl main_kernel
.p2align 8
.type main_kernel,@function
main_kernel:
  s_cmp_ge_u32 s2, 256
  s_cbranch_scc1 ch_end
  s_load_dwordx2 s[4:5], s[0:1], 120
  s_load_dwordx2 s[6:7], s[0:1], 128
  s_load_dwordx8 s[40:47], s[0:1], 72
  s_load_dwordx4 s[48:51], s[0:1], 56
  s_mov_b32 s32, 0
  s_getreg_b32 s3, hwreg(HW_REG_XCC_ID)
  s_and_b32 s3, s3, 15
  s_cmp_lg_u32 s3, 0
  s_cbranch_scc1 ch_pf
  s_cmp_lt_u32 s2, 224
  s_cbranch_scc1 ch_npf
ch_pf:
  s_getpc_b64 s[98:99]
pf_main_kernel_1:
  s_sub_u32 s98, s98, pf_main_kernel_1-main_kernel
  s_subb_u32 s99, s99, 0
  v_lshlrev_b32 v60, 7, v0
  v_min_u32 v61, ch_end-main_kernel-4, v60
  global_load_dword v62, v61, s[98:99]
  v_add_u32 v60, 32768, v60
  v_min_u32 v61, ch_end-main_kernel-4, v60
  global_load_dword v62, v61, s[98:99]
  v_add_u32 v60, 32768, v60
  v_min_u32 v61, ch_end-main_kernel-4, v60
  global_load_dword v62, v61, s[98:99]
  v_add_u32 v60, 32768, v60
  v_min_u32 v61, ch_end-main_kernel-4, v60
  global_load_dword v62, v61, s[98:99]
  v_add_u32 v60, 32768, v60
  v_min_u32 v61, ch_end-main_kernel-4, v60
  global_load_dword v62, v61, s[98:99]
  v_add_u32 v60, 32768, v60
ch_npf:
  v_lshrrev_b32 v1, 6, v0
  s_nop 0
  v_readfirstlane_b32 s16, v1
  s_waitcnt lgkmcnt(0)
  s_mov_b32 s8, s6
  s_and_b32 s9, s7, 0xffff
  s_mov_b32 s10, 0x10000000
  s_mov_b32 s11, 0x20000
  s_mov_b32 s12, s4
  s_and_b32 s13, s5, 0xffff
  s_mov_b32 s14, 256
  s_mov_b32 s15, 0x20000
  v_mov_b32 v252, 0x40000000
  v_cmp_eq_u32 vcc, 0, v0
  s_nop 1
  v_cndmask_b32 v252, v252, v0, vcc
  s_cmp_lg_u32 s3, 0
  s_cbranch_scc1 ch_worker
  s_mov_b32 s18, 0
  v_mov_b32 v249, 1
  s_mov_b64 exec, 1
  buffer_atomic_add v249, v252, s[12:15], 0 offen sc0
  s_mov_b64 exec, -1
  v_and_b32 v1, 63, v0
  v_lshlrev_b32 v2, 4, v1
  v_lshrrev_b32 v3, 4, v1
  v_and_b32 v4, 15, v1
  s_lshr_b32 s33, s2, 3
  s_lshl_b32 s27, s33, 2
  s_add_u32 s27, s27, s16
  s_lshl_b32 s27, s27, 13
  v_lshlrev_b32 v12, 7, v1
  s_mov_b32 s64, s42
  s_and_b32 s65, s43, 0xffff
  s_mov_b32 s66, 2097152
  s_mov_b32 s67, 0x20000
  s_mov_b32 s28, s27
  buffer_load_dword v13, v12, s[64:67], s28 offen
  s_add_u32 s28, s28, 1048576
  buffer_load_dword v13, v12, s[64:67], s28 offen
  s_add_u32 s28, s28, 1048576
  s_waitcnt vmcnt(2)
  v_readfirstlane_b32 s17, v249
  v_mov_b32 v6, 160032
  s_nop 0
  v_mov_b32 v7, s17
  s_barrier
  s_cmp_lg_u32 s16, 0
  s_cbranch_scc1 uni_2
  ds_write_b32 v6, v7
  s_waitcnt lgkmcnt(0)
uni_2:
  s_barrier
  ds_read_b32 v7, v6
  s_waitcnt lgkmcnt(0)
  v_readfirstlane_b32 s17, v7
  s_branch ch_got
ch_take:
  v_mov_b32 v5, 0
  v_mov_b32 v6, 160000
  s_barrier
  s_cmp_lg_u32 s16, 0
  s_cbranch_scc1 ch_el1
  s_mov_b64 exec, 1
  buffer_atomic_add v4, v5, s[12:15], 0 offen sc0
  s_waitcnt vmcnt(0)
  ds_write_b32 v6, v4
  s_waitcnt lgkmcnt(0)
  s_mov_b64 exec, -1
ch_el1:
  s_barrier
  ds_read_b32 v4, v6
  s_waitcnt lgkmcnt(0)
  v_readfirstlane_b32 s17, v4
ch_got:
  s_and_b32 s17, s17, 0xffff
  s_cmp_lt_u32 s17, 32
  s_cbranch_scc1 ch_role
  s_cmp_eq_u32 s18, 0
  s_cbranch_scc1 ch_worker
  v_and_b32 v1, 63, v0
  v_lshlrev_b32 v2, 4, v1
  v_lshrrev_b32 v3, 4, v1
  v_and_b32 v4, 15, v1
  s_branch wp_all
ch_role:
  v_and_b32 v1, 63, v0
  v_lshlrev_b32 v2, 4, v1
  v_lshrrev_b32 v3, 4, v1
  v_and_b32 v4, 15, v1
  s_cmp_lt_u32 s17, 16
  s_cbranch_scc1 ch_self
  s_cmp_lt_u32 s17, 28
  s_cbranch_scc1 ch_tch
  s_sub_u32 s33, s17, 28
  v_mov_b32 v10, 0x40000000
  v_mov_b32 v5, 1
  v_mov_b32 v148, 0
  v_mov_b32 v149, 0
  v_mov_b32 v150, 0
  v_mov_b32 v151, 0
  v_mov_b32 v152, -1
  v_mov_b32 v153, -1
  v_mov_b32 v154, -1
  v_mov_b32 v155, -1
  v_lshlrev_b32 v8, 4, v0
  s_cmp_lg_u32 s33, 0
  s_cbranch_scc1 ch_ij_1
  s_mov_b32 s23, 88519168
  buffer_store_dwordx4 v[148:151], v8, s[8:11], s23 offen sc1
  s_mov_b32 s23, 88523264
  buffer_store_dwordx4 v[148:151], v8, s[8:11], s23 offen sc1
  s_waitcnt vmcnt(0)
  s_barrier
  buffer_store_dword v5, v252, s[12:15], 0 offen offset:128 sc1
ch_ij_1:
  s_mov_b32 s68, s50
  s_and_b32 s69, s51, 0xffff
  s_mov_b32 s70, 7168
  s_mov_b32 s71, 0x20000
  v_lshrrev_b32 v6, 3, v0
  v_min_u32 v6, 27, v6
  v_and_b32 v7, 7, v0
  v_mul_u32_u24 v9, 896, v7
  v_lshl_add_u32 v9, v6, 5, v9
  buffer_load_dwordx4 v[176:179], v9, s[68:71], 0 offen
  buffer_load_dwordx4 v[180:183], v9, s[68:71], 0 offen offset:16
  s_lshl_b32 s20, s33, 12
  v_add_u32 v8, s20, v8
  s_mov_b32 s23, 88461312
ch_ijlp_3:
  buffer_store_dwordx4 v[148:151], v8, s[8:11], s23 offen sc1
  s_add_u32 s23, s23, 16384
  s_cmp_lt_u32 s23, 88510464
  s_cbranch_scc1 ch_ijlp_3
  v_cmp_gt_u32 vcc, 8704, v8
  s_nop 1
  v_cndmask_b32 v9, v10, v8, vcc
  buffer_store_dwordx4 v[148:151], v9, s[8:11], s23 offen sc1
  s_mov_b32 s23, 75729408
  v_cmp_gt_u32 vcc, 6144, v8
  s_nop 1
  v_cndmask_b32 v9, v10, v8, vcc
  buffer_store_dwordx4 v[148:151], v9, s[8:11], s23 offen sc1
  s_mov_b32 s23, 75701248
ch_ijlp_4:
  buffer_store_dwordx4 v[152:155], v8, s[8:11], s23 offen sc1
  s_add_u32 s23, s23, 16384
  s_cmp_lt_u32 s23, 75717632
  s_cbranch_scc1 ch_ijlp_4
  v_cmp_gt_u32 vcc, 11776, v8
  s_nop 1
  v_cndmask_b32 v9, v10, v8, vcc
  buffer_store_dwordx4 v[152:155], v9, s[8:11], s23 offen sc1
  s_mov_b32 s23, 88009728
ch_ijlp_5:
  buffer_store_dwordx4 v[152:155], v8, s[8:11], s23 offen sc1
  s_add_u32 s23, s23, 16384
  s_cmp_lt_u32 s23, 88452096
  s_cbranch_scc1 ch_ijlp_5
  v_cmp_gt_u32 vcc, 9216, v8
  s_nop 1
  v_cndmask_b32 v9, v10, v8, vcc
  buffer_store_dwordx4 v[152:155], v9, s[8:11], s23 offen sc1
  s_cmp_lg_u32 s33, 1
  s_cbranch_scc1 ch_ij_nm
  v_lshrrev_b32 v6, 3, v0
  v_and_b32 v7, 7, v0
  v_lshlrev_b32 v8, 8, v6
  v_lshl_add_u32 v8, v7, 4, v8
  v_cmp_gt_u32 vcc, 28, v6
  s_nop 1
  v_cndmask_b32 v8, v10, v8, vcc
  s_waitcnt vmcnt(4)
  v_mov_b32 v184, v176
  v_mov_b32 v188, v177
  v_mov_b32 v185, v178
  v_mov_b32 v189, v179
  v_mov_b32 v186, v180
  v_mov_b32 v190, v181
  v_mov_b32 v187, v182
  v_mov_b32 v191, v183
  s_mov_b32 s23, 75694080
  buffer_store_dwordx4 v[184:187], v8, s[8:11], s23 offen sc1
  buffer_store_dwordx4 v[188:191], v8, s[8:11], s23 offen offset:128 sc1
  s_mov_b32 s23, 88002560
  buffer_store_dwordx4 v[184:187], v8, s[8:11], s23 offen sc1
  buffer_store_dwordx4 v[188:191], v8, s[8:11], s23 offen offset:128 sc1
ch_ij_nm:
  s_waitcnt vmcnt(0)
  s_barrier
  s_cmp_lg_u32 s16, 0
  s_cbranch_scc1 ch_ij_e
  v_mov_b32 v6, 1
  s_mov_b64 exec, 1
  buffer_atomic_add v6, v252, s[12:15], 0 offen offset:12 sc0
  s_waitcnt vmcnt(0)
  v_readfirstlane_b32 s20, v6
  s_cmp_lg_u32 s20, 3
  s_cbranch_scc1 ch_ij_e0
  buffer_store_dword v5, v252, s[12:15], 0 offen offset:132 sc1
  s_mov_b64 exec, 0xff
  v_lshlrev_b32 v6, 7, v0
  s_mov_b32 s20, 88523264
  buffer_store_dword v5, v6, s[8:11], s20 offen offset:4 sc1
ch_ij_e0:
  s_mov_b64 exec, -1
ch_ij_e:
  s_branch ch_role2
ch_tch:
  s_sub_u32 s33, s17, 16
  s_lshl_b32 s27, s33, 2
  s_add_u32 s27, s27, s16
  s_lshl_b32 s27, s27, 13
  v_lshlrev_b32 v12, 7, v1
  s_mov_b32 s64, s40
  s_and_b32 s65, s41, 0xffff
  s_mov_b32 s66, 3670016
  s_mov_b32 s67, 0x20000
  s_mov_b32 s28, s27
  buffer_load_dword v13, v12, s[64:67], s28 offen
  s_add_u32 s28, s28, 393216
  buffer_load_dword v13, v12, s[64:67], s28 offen
  s_add_u32 s28, s28, 393216
  buffer_load_dword v13, v12, s[64:67], s28 offen
  s_add_u32 s28, s28, 393216
  buffer_load_dword v13, v12, s[64:67], s28 offen
  s_add_u32 s28, s28, 393216
  buffer_load_dword v13, v12, s[64:67], s28 offen
  s_add_u32 s28, s28, 393216
  buffer_load_dword v13, v12, s[64:67], s28 offen
  s_add_u32 s28, s28, 393216
  buffer_load_dword v13, v12, s[64:67], s28 offen
  s_add_u32 s28, s28, 393216
  buffer_load_dword v13, v12, s[64:67], s28 offen
  s_add_u32 s28, s28, 393216
  buffer_load_dword v13, v12, s[64:67], s28 offen
  s_add_u32 s28, s28, 393216
  buffer_load_dword v13, v12, s[64:67], s28 offen
  s_add_u32 s28, s28, 393216
  s_branch ch_role2
ch_self:
  v_lshrrev_b32 v5, 5, v1
  v_and_b32 v6, 31, v1
  v_xor_b32 v8, v6, v5
  v_lshlrev_b32 v8, 4, v8
  v_lshl_add_u32 v16, v5, 13, v8
  v_xor_b32 v17, 32, v16
  v_xor_b32 v18, 64, v16
  v_xor_b32 v19, 96, v16
  v_xor_b32 v20, 128, v16
  v_xor_b32 v21, 160, v16
  v_xor_b32 v22, 192, v16
  v_xor_b32 v23, 224, v16
  s_lshl_b32 s20, s16, 6
  v_xor_b32 v26, s20, v16
  v_xor_b32 v27, 32, v26
  s_mov_b32 s60, s40
  s_and_b32 s61, s41, 0xffff
  s_mov_b32 s62, 3670016
  s_mov_b32 s63, 0x20000
  s_mov_b32 s56, s42
  s_and_b32 s57, s43, 0xffff
  s_mov_b32 s58, 3670016
  s_mov_b32 s59, 0x20000
  s_lshl_b32 s26, s17, 9
  s_lshl_b32 s27, s16, 19
  s_add_u32 s27, s27, s26
  s_lshl_b32 s25, s16, 15
  s_add_u32 s25, s25, 32768
  s_barrier
  s_add_u32 m0, s25, 0
  s_nop 0
  buffer_load_dwordx4 v16, s[56:59], s27 offen lds
  s_add_u32 s27, s27, 16384
  s_add_u32 m0, s25, 1024
  s_nop 0
  buffer_load_dwordx4 v16, s[56:59], s27 offen lds
  s_add_u32 s27, s27, 16384
  s_add_u32 m0, s25, 2048
  s_nop 0
  buffer_load_dwordx4 v17, s[56:59], s27 offen lds
  s_add_u32 s27, s27, 16384
  s_add_u32 m0, s25, 3072
  s_nop 0
  buffer_load_dwordx4 v17, s[56:59], s27 offen lds
  s_add_u32 s27, s27, 16384
  s_add_u32 m0, s25, 4096
  s_nop 0
  buffer_load_dwordx4 v16, s[56:59], s27 offen lds
  s_add_u32 s27, s27, 16384
  s_add_u32 m0, s25, 5120
  s_nop 0
  buffer_load_dwordx4 v16, s[56:59], s27 offen lds
  s_add_u32 s27, s27, 16384
  s_add_u32 m0, s25, 6144
  s_nop 0
  buffer_load_dwordx4 v17, s[56:59], s27 offen lds
  s_add_u32 s27, s27, 16384
  s_add_u32 m0, s25, 7168
  s_nop 0
  buffer_load_dwordx4 v17, s[56:59], s27 offen lds
  s_add_u32 s27, s27, 16384
  s_add_u32 m0, s25, 8192
  s_nop 0
  buffer_load_dwordx4 v18, s[56:59], s27 offen lds
  s_add_u32 s27, s27, 16384
  s_add_u32 m0, s25, 9216
  s_nop 0
  buffer_load_dwordx4 v18, s[56:59], s27 offen lds
  s_add_u32 s27, s27, 16384
  s_add_u32 m0, s25, 10240
  s_nop 0
  buffer_load_dwordx4 v19, s[56:59], s27 offen lds
  s_add_u32 s27, s27, 16384
  s_add_u32 m0, s25, 11264
  s_nop 0
  buffer_load_dwordx4 v19, s[56:59], s27 offen lds
  s_add_u32 s27, s27, 16384
  s_add_u32 m0, s25, 12288
  s_nop 0
  buffer_load_dwordx4 v18, s[56:59], s27 offen lds
  s_add_u32 s27, s27, 16384
  s_add_u32 m0, s25, 13312
  s_nop 0
  buffer_load_dwordx4 v18, s[56:59], s27 offen lds
  s_add_u32 s27, s27, 16384
  s_add_u32 m0, s25, 14336
  s_nop 0
  buffer_load_dwordx4 v19, s[56:59], s27 offen lds
  s_add_u32 s27, s27, 16384
  s_add_u32 m0, s25, 15360
  s_nop 0
  buffer_load_dwordx4 v19, s[56:59], s27 offen lds
  s_add_u32 s27, s27, 16384
  s_add_u32 m0, s25, 16384
  s_nop 0
  buffer_load_dwordx4 v20, s[56:59], s27 offen lds
  s_add_u32 s27, s27, 16384
  s_add_u32 m0, s25, 17408
  s_nop 0
  buffer_load_dwordx4 v20, s[56:59], s27 offen lds
  s_add_u32 s27, s27, 16384
  s_add_u32 m0, s25, 18432
  s_nop 0
  buffer_load_dwordx4 v21, s[56:59], s27 offen lds
  s_add_u32 s27, s27, 16384
  s_add_u32 m0, s25, 19456
  s_nop 0
  buffer_load_dwordx4 v21, s[56:59], s27 offen lds
  s_add_u32 s27, s27, 16384
  s_add_u32 m0, s25, 20480
  s_nop 0
  buffer_load_dwordx4 v20, s[56:59], s27 offen lds
  s_add_u32 s27, s27, 16384
  s_add_u32 m0, s25, 21504
  s_nop 0
  buffer_load_dwordx4 v20, s[56:59], s27 offen lds
  s_add_u32 s27, s27, 16384
  s_add_u32 m0, s25, 22528
  s_nop 0
  buffer_load_dwordx4 v21, s[56:59], s27 offen lds
  s_add_u32 s27, s27, 16384
  s_add_u32 m0, s25, 23552
  s_nop 0
  buffer_load_dwordx4 v21, s[56:59], s27 offen lds
  s_add_u32 s27, s27, 16384
  s_add_u32 m0, s25, 24576
  s_nop 0
  buffer_load_dwordx4 v22, s[56:59], s27 offen lds
  s_add_u32 s27, s27, 16384
  s_add_u32 m0, s25, 25600
  s_nop 0
  buffer_load_dwordx4 v22, s[56:59], s27 offen lds
  s_add_u32 s27, s27, 16384
  s_add_u32 m0, s25, 26624
  s_nop 0
  buffer_load_dwordx4 v23, s[56:59], s27 offen lds
  s_add_u32 s27, s27, 16384
  s_add_u32 m0, s25, 27648
  s_nop 0
  buffer_load_dwordx4 v23, s[56:59], s27 offen lds
  s_add_u32 s27, s27, 16384
  s_add_u32 m0, s25, 28672
  s_nop 0
  buffer_load_dwordx4 v22, s[56:59], s27 offen lds
  s_add_u32 s27, s27, 16384
  s_add_u32 m0, s25, 29696
  s_nop 0
  buffer_load_dwordx4 v22, s[56:59], s27 offen lds
  s_add_u32 s27, s27, 16384
  s_add_u32 m0, s25, 30720
  s_nop 0
  buffer_load_dwordx4 v23, s[56:59], s27 offen lds
  s_add_u32 s27, s27, 16384
  s_add_u32 m0, s25, 31744
  s_nop 0
  buffer_load_dwordx4 v23, s[56:59], s27 offen lds
  s_add_u32 s27, s27, 16384
  v_mov_b32 v14, v26
  v_mov_b32 v15, v27
  s_lshl_b32 s28, s16, 16
  s_add_u32 s28, s28, s26
  s_lshl_b32 s29, s16, 12
  s_add_u32 m0, s29, 0
  s_add_u32 s27, s28, 0
  buffer_load_dwordx4 v14, s[60:63], s27 offen lds
  s_add_u32 m0, s29, 1024
  s_add_u32 s27, s28, 16384
  buffer_load_dwordx4 v15, s[60:63], s27 offen lds
  s_add_u32 m0, s29, 2048
  s_add_u32 s27, s28, 32768
  buffer_load_dwordx4 v14, s[60:63], s27 offen lds
  s_add_u32 m0, s29, 3072
  s_add_u32 s27, s28, 49152
  buffer_load_dwordx4 v15, s[60:63], s27 offen lds
  s_add_u32 m0, s29, 16384
  s_add_u32 s27, s28, 262144
  buffer_load_dwordx4 v14, s[60:63], s27 offen lds
  s_add_u32 m0, s29, 17408
  s_add_u32 s27, s28, 278528
  buffer_load_dwordx4 v15, s[60:63], s27 offen lds
  s_add_u32 m0, s29, 18432
  s_add_u32 s27, s28, 294912
  buffer_load_dwordx4 v14, s[60:63], s27 offen lds
  s_add_u32 m0, s29, 19456
  s_add_u32 s27, s28, 311296
  buffer_load_dwordx4 v15, s[60:63], s27 offen lds
  v_lshrrev_b32 v7, 2, v4
  v_lshlrev_b32 v11, 4, v7
  v_lshlrev_b32 v7, 3, v7
  v_and_b32 v8, 3, v4
  v_add_u32 v7, v7, v8
  v_and_b32 v8, 2, v4
  v_lshl_add_u32 v11, v8, 1, v11
  v_and_b32 v8, 1, v4
  v_add_u32 v11, v11, v8
  v_or_b32 v10, 0, v3
  v_xor_b32 v10, v10, v4
  v_lshlrev_b32 v10, 4, v10
  v_lshl_add_u32 v248, v7, 9, v10
  v_add_u32 v252, 65536, v248
  v_add_u32 v16, 131072, v248
  v_lshl_add_u32 v10, v11, 9, v10
  v_add_u32 v20, s25, v10
  v_or_b32 v10, 4, v3
  v_xor_b32 v10, v10, v4
  v_lshlrev_b32 v10, 4, v10
  v_lshl_add_u32 v249, v7, 9, v10
  v_add_u32 v253, 65536, v249
  v_add_u32 v17, 131072, v249
  v_lshl_add_u32 v10, v11, 9, v10
  v_add_u32 v21, s25, v10
  v_or_b32 v10, 8, v3
  v_xor_b32 v10, v10, v4
  v_lshlrev_b32 v10, 4, v10
  v_lshl_add_u32 v250, v7, 9, v10
  v_add_u32 v254, 65536, v250
  v_add_u32 v18, 131072, v250
  v_lshl_add_u32 v10, v11, 9, v10
  v_add_u32 v22, s25, v10
  v_or_b32 v10, 12, v3
  v_xor_b32 v10, v10, v4
  v_lshlrev_b32 v10, 4, v10
  v_lshl_add_u32 v251, v7, 9, v10
  v_add_u32 v255, 65536, v251
  v_add_u32 v19, 131072, v251
  v_lshl_add_u32 v10, v11, 9, v10
  v_add_u32 v23, s25, v10
  v_mov_b32 v12, 1035512379
  v_lshlrev_b32 v6, 7, v1
  s_getpc_b64 s[98:99]
  global_load_dword v7, v6, s[98:99]
  s_waitcnt vmcnt(9)
  ds_read_b128 v[120:123], v20 offset:0
  ds_read_b128 v[124:127], v21 offset:0
  ds_read_b128 v[128:131], v22 offset:0
  ds_read_b128 v[132:135], v23 offset:0
  ds_read_b128 v[136:139], v20 offset:256
  ds_read_b128 v[140:143], v21 offset:256
  ds_read_b128 v[144:147], v22 offset:256
  ds_read_b128 v[148:151], v23 offset:256
  s_waitcnt lgkmcnt(8)
  ds_read_b128 v[152:155], v20 offset:1024
  ds_read_b128 v[156:159], v21 offset:1024
  ds_read_b128 v[160:163], v22 offset:1024
  ds_read_b128 v[164:167], v23 offset:1024
  ds_read_b128 v[168:171], v20 offset:1280
  ds_read_b128 v[172:175], v21 offset:1280
  ds_read_b128 v[176:179], v22 offset:1280
  ds_read_b128 v[180:183], v23 offset:1280
  s_waitcnt lgkmcnt(8)
  ds_read_b128 v[184:187], v20 offset:4096
  ds_read_b128 v[188:191], v21 offset:4096
  ds_read_b128 v[192:195], v22 offset:4096
  ds_read_b128 v[196:199], v23 offset:4096
  ds_read_b128 v[200:203], v20 offset:4352
  ds_read_b128 v[204:207], v21 offset:4352
  ds_read_b128 v[208:211], v22 offset:4352
  ds_read_b128 v[212:215], v23 offset:4352
  s_waitcnt lgkmcnt(8)
  ds_read_b128 v[216:219], v20 offset:5120
  ds_read_b128 v[220:223], v21 offset:5120
  ds_read_b128 v[224:227], v22 offset:5120
  ds_read_b128 v[228:231], v23 offset:5120
  ds_read_b128 v[232:235], v20 offset:5376
  ds_read_b128 v[236:239], v21 offset:5376
  ds_read_b128 v[240:243], v22 offset:5376
  ds_read_b128 v[244:247], v23 offset:5376
  s_waitcnt lgkmcnt(8)
  s_waitcnt vmcnt(4) lgkmcnt(0)
  s_barrier
  s_add_u32 m0, s29, 32768
  s_add_u32 s27, s28, 524288
  buffer_load_dwordx4 v14, s[60:63], s27 offen lds
  s_add_u32 m0, s29, 33792
  s_add_u32 s27, s28, 540672
  buffer_load_dwordx4 v15, s[60:63], s27 offen lds
  s_add_u32 m0, s29, 34816
  s_add_u32 s27, s28, 557056
  buffer_load_dwordx4 v14, s[60:63], s27 offen lds
  s_add_u32 m0, s29, 35840
  s_add_u32 s27, s28, 573440
  buffer_load_dwordx4 v15, s[60:63], s27 offen lds
  ds_read_b128 v[24:27], v248 offset:0
  ds_read_b128 v[28:31], v248 offset:2048
  ds_read_b128 v[32:35], v249 offset:0
  ds_read_b128 v[36:39], v249 offset:2048
  ds_read_b128 v[40:43], v250 offset:0
  ds_read_b128 v[44:47], v250 offset:2048
  s_waitcnt lgkmcnt(5)
  s_getpc_b64 s[98:99]
  s_add_u32 s98, s98, 4096
  s_addc_u32 s99, s99, 0
  global_load_dword v7, v6, s[98:99]
  v_mfma_f32_16x16x32_bf16 v[56:59], v[24:27], v[120:123], 0
  ds_read_b128 v[48:51], v251 offset:0
  v_mfma_f32_16x16x32_bf16 v[64:67], v[24:27], v[152:155], 0
  v_mfma_f32_16x16x32_bf16 v[72:75], v[24:27], v[184:187], 0
  s_add_u32 m0, s29, 49152
  s_add_u32 s27, s28, 786432
  buffer_load_dwordx4 v14, s[60:63], s27 offen lds
  v_mfma_f32_16x16x32_bf16 v[80:83], v[24:27], v[216:219], 0
  s_waitcnt lgkmcnt(5)
  v_mfma_f32_16x16x32_bf16 v[60:63], v[28:31], v[120:123], 0
  ds_read_b128 v[52:55], v251 offset:2048
  v_mfma_f32_16x16x32_bf16 v[68:71], v[28:31], v[152:155], 0
  v_mfma_f32_16x16x32_bf16 v[76:79], v[28:31], v[184:187], 0
  v_mfma_f32_16x16x32_bf16 v[84:87], v[28:31], v[216:219], 0
  s_waitcnt lgkmcnt(5)
  v_mfma_f32_16x16x32_bf16 v[56:59], v[32:35], v[124:127], v[56:59]
  ds_read_b128 v[24:27], v248 offset:256
  v_mfma_f32_16x16x32_bf16 v[64:67], v[32:35], v[156:159], v[64:67]
  v_mfma_f32_16x16x32_bf16 v[72:75], v[32:35], v[188:191], v[72:75]
  s_add_u32 m0, s29, 50176
  s_add_u32 s27, s28, 802816
  buffer_load_dwordx4 v15, s[60:63], s27 offen lds
  v_mfma_f32_16x16x32_bf16 v[80:83], v[32:35], v[220:223], v[80:83]
  s_waitcnt lgkmcnt(5)
  v_mfma_f32_16x16x32_bf16 v[60:63], v[36:39], v[124:127], v[60:63]
  ds_read_b128 v[28:31], v248 offset:2304
  v_mfma_f32_16x16x32_bf16 v[68:71], v[36:39], v[156:159], v[68:71]
  v_mfma_f32_16x16x32_bf16 v[76:79], v[36:39], v[188:191], v[76:79]
  v_mfma_f32_16x16x32_bf16 v[84:87], v[36:39], v[220:223], v[84:87]
  s_waitcnt lgkmcnt(5)
  v_mfma_f32_16x16x32_bf16 v[56:59], v[40:43], v[128:131], v[56:59]
  ds_read_b128 v[32:35], v249 offset:256
  v_mfma_f32_16x16x32_bf16 v[64:67], v[40:43], v[160:163], v[64:67]
  v_mfma_f32_16x16x32_bf16 v[72:75], v[40:43], v[192:195], v[72:75]
  s_add_u32 m0, s29, 51200
  s_add_u32 s27, s28, 819200
  buffer_load_dwordx4 v14, s[60:63], s27 offen lds
  v_mfma_f32_16x16x32_bf16 v[80:83], v[40:43], v[224:227], v[80:83]
  s_waitcnt lgkmcnt(5)
  v_mfma_f32_16x16x32_bf16 v[60:63], v[44:47], v[128:131], v[60:63]
  ds_read_b128 v[36:39], v249 offset:2304
  v_mfma_f32_16x16x32_bf16 v[68:71], v[44:47], v[160:163], v[68:71]
  v_mfma_f32_16x16x32_bf16 v[76:79], v[44:47], v[192:195], v[76:79]
  v_mfma_f32_16x16x32_bf16 v[84:87], v[44:47], v[224:227], v[84:87]
  s_waitcnt lgkmcnt(5)
  v_mfma_f32_16x16x32_bf16 v[56:59], v[48:51], v[132:135], v[56:59]
  ds_read_b128 v[40:43], v250 offset:256
  v_mfma_f32_16x16x32_bf16 v[64:67], v[48:51], v[164:167], v[64:67]
  v_mfma_f32_16x16x32_bf16 v[72:75], v[48:51], v[196:199], v[72:75]
  s_add_u32 m0, s29, 52224
  s_add_u32 s27, s28, 835584
  buffer_load_dwordx4 v15, s[60:63], s27 offen lds
  v_mfma_f32_16x16x32_bf16 v[80:83], v[48:51], v[228:231], v[80:83]
  s_waitcnt lgkmcnt(5)
  v_mfma_f32_16x16x32_bf16 v[60:63], v[52:55], v[132:135], v[60:63]
  ds_read_b128 v[44:47], v250 offset:2304
  v_mfma_f32_16x16x32_bf16 v[68:71], v[52:55], v[164:167], v[68:71]
  v_mfma_f32_16x16x32_bf16 v[76:79], v[52:55], v[196:199], v[76:79]
  v_mfma_f32_16x16x32_bf16 v[84:87], v[52:55], v[228:231], v[84:87]
  s_waitcnt lgkmcnt(5)
  v_mfma_f32_16x16x32_bf16 v[56:59], v[24:27], v[136:139], v[56:59]
  ds_read_b128 v[48:51], v251 offset:256
  v_mfma_f32_16x16x32_bf16 v[64:67], v[24:27], v[168:171], v[64:67]
  v_mfma_f32_16x16x32_bf16 v[72:75], v[24:27], v[200:203], v[72:75]
  v_mfma_f32_16x16x32_bf16 v[80:83], v[24:27], v[232:235], v[80:83]
  s_waitcnt lgkmcnt(5)
  v_mfma_f32_16x16x32_bf16 v[60:63], v[28:31], v[136:139], v[60:63]
  ds_read_b128 v[52:55], v251 offset:2304
  v_mfma_f32_16x16x32_bf16 v[68:71], v[28:31], v[168:171], v[68:71]
  v_mfma_f32_16x16x32_bf16 v[76:79], v[28:31], v[200:203], v[76:79]
  v_mfma_f32_16x16x32_bf16 v[84:87], v[28:31], v[232:235], v[84:87]
  s_waitcnt lgkmcnt(5)
  v_mfma_f32_16x16x32_bf16 v[56:59], v[32:35], v[140:143], v[56:59]
  s_waitcnt vmcnt(8)
  s_barrier
  ds_read_b128 v[24:27], v248 offset:16384
  v_mfma_f32_16x16x32_bf16 v[64:67], v[32:35], v[172:175], v[64:67]
  v_mfma_f32_16x16x32_bf16 v[72:75], v[32:35], v[204:207], v[72:75]
  v_mfma_f32_16x16x32_bf16 v[80:83], v[32:35], v[236:239], v[80:83]
  s_waitcnt lgkmcnt(5)
  v_mfma_f32_16x16x32_bf16 v[60:63], v[36:39], v[140:143], v[60:63]
  ds_read_b128 v[28:31], v248 offset:18432
  v_mfma_f32_16x16x32_bf16 v[68:71], v[36:39], v[172:175], v[68:71]
  v_mfma_f32_16x16x32_bf16 v[76:79], v[36:39], v[204:207], v[76:79]
  v_mfma_f32_16x16x32_bf16 v[84:87], v[36:39], v[236:239], v[84:87]
  s_waitcnt lgkmcnt(5)
  v_mfma_f32_16x16x32_bf16 v[56:59], v[40:43], v[144:147], v[56:59]
  ds_read_b128 v[32:35], v249 offset:16384
  v_mfma_f32_16x16x32_bf16 v[64:67], v[40:43], v[176:179], v[64:67]
  v_mfma_f32_16x16x32_bf16 v[72:75], v[40:43], v[208:211], v[72:75]
  v_mfma_f32_16x16x32_bf16 v[80:83], v[40:43], v[240:243], v[80:83]
  s_waitcnt lgkmcnt(5)
  v_mfma_f32_16x16x32_bf16 v[60:63], v[44:47], v[144:147], v[60:63]
  ds_read_b128 v[36:39], v249 offset:18432
  v_mfma_f32_16x16x32_bf16 v[68:71], v[44:47], v[176:179], v[68:71]
  v_mfma_f32_16x16x32_bf16 v[76:79], v[44:47], v[208:211], v[76:79]
  v_mfma_f32_16x16x32_bf16 v[84:87], v[44:47], v[240:243], v[84:87]
  s_waitcnt lgkmcnt(5)
  v_mfma_f32_16x16x32_bf16 v[56:59], v[48:51], v[148:151], v[56:59]
  ds_read_b128 v[40:43], v250 offset:16384
  v_mfma_f32_16x16x32_bf16 v[64:67], v[48:51], v[180:183], v[64:67]
  v_mfma_f32_16x16x32_bf16 v[72:75], v[48:51], v[212:215], v[72:75]
  v_mfma_f32_16x16x32_bf16 v[80:83], v[48:51], v[244:247], v[80:83]
  s_waitcnt lgkmcnt(5)
  v_mfma_f32_16x16x32_bf16 v[60:63], v[52:55], v[148:151], v[60:63]
  ds_read_b128 v[44:47], v250 offset:18432
  v_mfma_f32_16x16x32_bf16 v[68:71], v[52:55], v[180:183], v[68:71]
  v_mfma_f32_16x16x32_bf16 v[76:79], v[52:55], v[212:215], v[76:79]
  v_mfma_f32_16x16x32_bf16 v[84:87], v[52:55], v[244:247], v[84:87]
  s_waitcnt lgkmcnt(5)
  v_mfma_f32_16x16x32_bf16 v[88:91], v[24:27], v[120:123], 0
  ds_read_b128 v[48:51], v251 offset:16384
  v_mfma_f32_16x16x32_bf16 v[96:99], v[24:27], v[152:155], 0
  v_mfma_f32_16x16x32_bf16 v[104:107], v[24:27], v[184:187], 0
  s_add_u32 m0, s29, 65536
  s_add_u32 s27, s28, 1048576
  buffer_load_dwordx4 v14, s[60:63], s27 offen lds
  v_mfma_f32_16x16x32_bf16 v[112:115], v[24:27], v[216:219], 0
  s_waitcnt lgkmcnt(5)
  v_mul_f32 v56, v12, v56
  v_mfma_f32_16x16x32_bf16 v[92:95], v[28:31], v[120:123], 0
  ds_read_b128 v[52:55], v251 offset:18432
  v_mul_f32 v57, v12, v57
  v_mfma_f32_16x16x32_bf16 v[100:103], v[28:31], v[152:155], 0
  v_mul_f32 v58, v12, v58
  v_mul_f32 v59, v12, v59
  v_mfma_f32_16x16x32_bf16 v[108:111], v[28:31], v[184:187], 0
  v_mul_f32 v60, v12, v60
  v_mfma_f32_16x16x32_bf16 v[116:119], v[28:31], v[216:219], 0
  s_waitcnt lgkmcnt(5)
  v_mul_f32 v61, v12, v61
  v_mfma_f32_16x16x32_bf16 v[88:91], v[32:35], v[124:127], v[88:91]
  ds_read_b128 v[24:27], v248 offset:16640
  v_mul_f32 v62, v12, v62
  v_mfma_f32_16x16x32_bf16 v[96:99], v[32:35], v[156:159], v[96:99]
  v_mul_f32 v63, v12, v63
  v_cvt_pk_bf16_f32 v56, v56, v57
  v_mfma_f32_16x16x32_bf16 v[104:107], v[32:35], v[188:191], v[104:107]
  s_add_u32 m0, s29, 66560
  s_add_u32 s27, s28, 1064960
  buffer_load_dwordx4 v15, s[60:63], s27 offen lds
  v_mfma_f32_16x16x32_bf16 v[112:115], v[32:35], v[220:223], v[112:115]
  s_waitcnt lgkmcnt(5)
  v_cvt_pk_bf16_f32 v57, v58, v59
  v_mfma_f32_16x16x32_bf16 v[92:95], v[36:39], v[124:127], v[92:95]
  ds_read_b128 v[28:31], v248 offset:18688
  v_cvt_pk_bf16_f32 v58, v60, v61
  v_mfma_f32_16x16x32_bf16 v[100:103], v[36:39], v[156:159], v[100:103]
  v_cvt_pk_bf16_f32 v59, v62, v63
  v_accvgpr_write_b32 a0, v56
  v_mfma_f32_16x16x32_bf16 v[108:111], v[36:39], v[188:191], v[108:111]
  v_accvgpr_write_b32 a1, v57
  v_mfma_f32_16x16x32_bf16 v[116:119], v[36:39], v[220:223], v[116:119]
  s_waitcnt lgkmcnt(5)
  v_accvgpr_write_b32 a2, v58
  v_mfma_f32_16x16x32_bf16 v[88:91], v[40:43], v[128:131], v[88:91]
  ds_read_b128 v[32:35], v249 offset:16640
  v_accvgpr_write_b32 a3, v59
  v_mfma_f32_16x16x32_bf16 v[96:99], v[40:43], v[160:163], v[96:99]
  v_mul_f32 v64, v12, v64
  v_mul_f32 v65, v12, v65
  v_mfma_f32_16x16x32_bf16 v[104:107], v[40:43], v[192:195], v[104:107]
  s_add_u32 m0, s29, 67584
  s_add_u32 s27, s28, 1081344
  buffer_load_dwordx4 v14, s[60:63], s27 offen lds
  v_mfma_f32_16x16x32_bf16 v[112:115], v[40:43], v[224:227], v[112:115]
  s_waitcnt lgkmcnt(5)
  v_mul_f32 v66, v12, v66
  v_mfma_f32_16x16x32_bf16 v[92:95], v[44:47], v[128:131], v[92:95]
  ds_read_b128 v[36:39], v249 offset:18688
  v_mul_f32 v67, v12, v67
  v_mfma_f32_16x16x32_bf16 v[100:103], v[44:47], v[160:163], v[100:103]
  v_mul_f32 v68, v12, v68
  v_mul_f32 v69, v12, v69
  v_mfma_f32_16x16x32_bf16 v[108:111], v[44:47], v[192:195], v[108:111]
  v_mul_f32 v70, v12, v70
  v_mfma_f32_16x16x32_bf16 v[116:119], v[44:47], v[224:227], v[116:119]
  s_waitcnt lgkmcnt(5)
  v_mul_f32 v71, v12, v71
  v_mfma_f32_16x16x32_bf16 v[88:91], v[48:51], v[132:135], v[88:91]
  ds_read_b128 v[40:43], v250 offset:16640
  v_cvt_pk_bf16_f32 v64, v64, v65
  v_mfma_f32_16x16x32_bf16 v[96:99], v[48:51], v[164:167], v[96:99]
  v_cvt_pk_bf16_f32 v65, v66, v67
  v_cvt_pk_bf16_f32 v66, v68, v69
  v_mfma_f32_16x16x32_bf16 v[104:107], v[48:51], v[196:199], v[104:107]
  s_add_u32 m0, s29, 68608
  s_add_u32 s27, s28, 1097728
  buffer_load_dwordx4 v15, s[60:63], s27 offen lds
  v_mfma_f32_16x16x32_bf16 v[112:115], v[48:51], v[228:231], v[112:115]
  s_waitcnt lgkmcnt(5)
  v_cvt_pk_bf16_f32 v67, v70, v71
  v_mfma_f32_16x16x32_bf16 v[92:95], v[52:55], v[132:135], v[92:95]
  ds_read_b128 v[44:47], v250 offset:18688
  v_accvgpr_write_b32 a56, v64
  v_mfma_f32_16x16x32_bf16 v[100:103], v[52:55], v[164:167], v[100:103]
  v_accvgpr_write_b32 a57, v65
  v_accvgpr_write_b32 a58, v66
  v_mfma_f32_16x16x32_bf16 v[108:111], v[52:55], v[196:199], v[108:111]
  v_accvgpr_write_b32 a59, v67
  v_mfma_f32_16x16x32_bf16 v[116:119], v[52:55], v[228:231], v[116:119]
  s_waitcnt lgkmcnt(5)
  v_mul_f32 v72, v12, v72
  v_mfma_f32_16x16x32_bf16 v[88:91], v[24:27], v[136:139], v[88:91]
  ds_read_b128 v[48:51], v251 offset:16640
  v_mul_f32 v73, v12, v73
  v_mfma_f32_16x16x32_bf16 v[96:99], v[24:27], v[168:171], v[96:99]
  v_mul_f32 v74, v12, v74
  v_mul_f32 v75, v12, v75
  v_mfma_f32_16x16x32_bf16 v[104:107], v[24:27], v[200:203], v[104:107]
  v_mul_f32 v76, v12, v76
  v_mfma_f32_16x16x32_bf16 v[112:115], v[24:27], v[232:235], v[112:115]
  s_waitcnt lgkmcnt(5)
  v_mul_f32 v77, v12, v77
  v_mfma_f32_16x16x32_bf16 v[92:95], v[28:31], v[136:139], v[92:95]
  ds_read_b128 v[52:55], v251 offset:18688
  v_mul_f32 v78, v12, v78
  v_mfma_f32_16x16x32_bf16 v[100:103], v[28:31], v[168:171], v[100:103]
  v_mul_f32 v79, v12, v79
  v_cvt_pk_bf16_f32 v72, v72, v73
  v_mfma_f32_16x16x32_bf16 v[108:111], v[28:31], v[200:203], v[108:111]
  v_cvt_pk_bf16_f32 v73, v74, v75
  v_mfma_f32_16x16x32_bf16 v[116:119], v[28:31], v[232:235], v[116:119]
  s_waitcnt lgkmcnt(5)
  v_cvt_pk_bf16_f32 v74, v76, v77
  v_mfma_f32_16x16x32_bf16 v[88:91], v[32:35], v[140:143], v[88:91]
  s_waitcnt vmcnt(8)
  s_barrier
  ds_read_b128 v[24:27], v248 offset:32768
  v_cvt_pk_bf16_f32 v75, v78, v79
  v_mfma_f32_16x16x32_bf16 v[96:99], v[32:35], v[172:175], v[96:99]
  v_accvgpr_write_b32 a112, v72
  v_accvgpr_write_b32 a113, v73
  v_mfma_f32_16x16x32_bf16 v[104:107], v[32:35], v[204:207], v[104:107]
  v_accvgpr_write_b32 a114, v74
  v_mfma_f32_16x16x32_bf16 v[112:115], v[32:35], v[236:239], v[112:115]
  s_waitcnt lgkmcnt(5)
  v_accvgpr_write_b32 a115, v75
  v_mfma_f32_16x16x32_bf16 v[92:95], v[36:39], v[140:143], v[92:95]
  ds_read_b128 v[28:31], v248 offset:34816
  v_mul_f32 v80, v12, v80
  v_mfma_f32_16x16x32_bf16 v[100:103], v[36:39], v[172:175], v[100:103]
  v_mul_f32 v81, v12, v81
  v_mul_f32 v82, v12, v82
  v_mfma_f32_16x16x32_bf16 v[108:111], v[36:39], v[204:207], v[108:111]
  v_mul_f32 v83, v12, v83
  v_mfma_f32_16x16x32_bf16 v[116:119], v[36:39], v[236:239], v[116:119]
  s_waitcnt lgkmcnt(5)
  v_mul_f32 v84, v12, v84
  v_mfma_f32_16x16x32_bf16 v[88:91], v[40:43], v[144:147], v[88:91]
  ds_read_b128 v[32:35], v249 offset:32768
  v_mul_f32 v85, v12, v85
  v_mfma_f32_16x16x32_bf16 v[96:99], v[40:43], v[176:179], v[96:99]
  v_mul_f32 v86, v12, v86
  v_mul_f32 v87, v12, v87
  v_mfma_f32_16x16x32_bf16 v[104:107], v[40:43], v[208:211], v[104:107]
  v_cvt_pk_bf16_f32 v80, v80, v81
  v_mfma_f32_16x16x32_bf16 v[112:115], v[40:43], v[240:243], v[112:115]
  s_waitcnt lgkmcnt(5)
  v_cvt_pk_bf16_f32 v81, v82, v83
  v_mfma_f32_16x16x32_bf16 v[92:95], v[44:47], v[144:147], v[92:95]
  ds_read_b128 v[36:39], v249 offset:34816
  v_cvt_pk_bf16_f32 v82, v84, v85
  v_mfma_f32_16x16x32_bf16 v[100:103], v[44:47], v[176:179], v[100:103]
  v_cvt_pk_bf16_f32 v83, v86, v87
  v_accvgpr_write_b32 a168, v80
  v_mfma_f32_16x16x32_bf16 v[108:111], v[44:47], v[208:211], v[108:111]
  v_accvgpr_write_b32 a169, v81
  v_mfma_f32_16x16x32_bf16 v[116:119], v[44:47], v[240:243], v[116:119]
  s_waitcnt lgkmcnt(5)
  v_accvgpr_write_b32 a170, v82
  v_mfma_f32_16x16x32_bf16 v[88:91], v[48:51], v[148:151], v[88:91]
  ds_read_b128 v[40:43], v250 offset:32768
  v_accvgpr_write_b32 a171, v83
  v_mfma_f32_16x16x32_bf16 v[96:99], v[48:51], v[180:183], v[96:99]
  v_mfma_f32_16x16x32_bf16 v[104:107], v[48:51], v[212:215], v[104:107]
  v_mfma_f32_16x16x32_bf16 v[112:115], v[48:51], v[244:247], v[112:115]
  s_waitcnt lgkmcnt(5)
  v_mfma_f32_16x16x32_bf16 v[92:95], v[52:55], v[148:151], v[92:95]
  ds_read_b128 v[44:47], v250 offset:34816
  v_mfma_f32_16x16x32_bf16 v[100:103], v[52:55], v[180:183], v[100:103]
  v_mfma_f32_16x16x32_bf16 v[108:111], v[52:55], v[212:215], v[108:111]
  v_mfma_f32_16x16x32_bf16 v[116:119], v[52:55], v[244:247], v[116:119]
  s_waitcnt lgkmcnt(5)
  v_mfma_f32_16x16x32_bf16 v[56:59], v[24:27], v[120:123], 0
  ds_read_b128 v[48:51], v251 offset:32768
  v_mfma_f32_16x16x32_bf16 v[64:67], v[24:27], v[152:155], 0
  v_mfma_f32_16x16x32_bf16 v[72:75], v[24:27], v[184:187], 0
  s_add_u32 m0, s29, 81920
  s_add_u32 s27, s28, 1310720
  buffer_load_dwordx4 v14, s[60:63], s27 offen lds
  v_mfma_f32_16x16x32_bf16 v[80:83], v[24:27], v[216:219], 0
  s_waitcnt lgkmcnt(5)
  v_mul_f32 v88, v12, v88
  v_mfma_f32_16x16x32_bf16 v[60:63], v[28:31], v[120:123], 0
  ds_read_b128 v[52:55], v251 offset:34816
  v_mul_f32 v89, v12, v89
  v_mfma_f32_16x16x32_bf16 v[68:71], v[28:31], v[152:155], 0
  v_mul_f32 v90, v12, v90
  v_mul_f32 v91, v12, v91
  v_mfma_f32_16x16x32_bf16 v[76:79], v[28:31], v[184:187], 0
  v_mul_f32 v92, v12, v92
  v_mfma_f32_16x16x32_bf16 v[84:87], v[28:31], v[216:219], 0
  s_waitcnt lgkmcnt(5)
  v_mul_f32 v93, v12, v93
  v_mfma_f32_16x16x32_bf16 v[56:59], v[32:35], v[124:127], v[56:59]
  ds_read_b128 v[24:27], v248 offset:33024
  v_mul_f32 v94, v12, v94
  v_mfma_f32_16x16x32_bf16 v[64:67], v[32:35], v[156:159], v[64:67]
  v_mul_f32 v95, v12, v95
  v_cvt_pk_bf16_f32 v88, v88, v89
  v_mfma_f32_16x16x32_bf16 v[72:75], v[32:35], v[188:191], v[72:75]
  s_add_u32 m0, s29, 82944
  s_add_u32 s27, s28, 1327104
  buffer_load_dwordx4 v15, s[60:63], s27 offen lds
  v_mfma_f32_16x16x32_bf16 v[80:83], v[32:35], v[220:223], v[80:83]
  s_waitcnt lgkmcnt(5)
  v_cvt_pk_bf16_f32 v89, v90, v91
  v_mfma_f32_16x16x32_bf16 v[60:63], v[36:39], v[124:127], v[60:63]
  ds_read_b128 v[28:31], v248 offset:35072
  v_cvt_pk_bf16_f32 v90, v92, v93
  v_mfma_f32_16x16x32_bf16 v[68:71], v[36:39], v[156:159], v[68:71]
  v_cvt_pk_bf16_f32 v91, v94, v95
  v_accvgpr_write_b32 a4, v88
  v_mfma_f32_16x16x32_bf16 v[76:79], v[36:39], v[188:191], v[76:79]
  v_accvgpr_write_b32 a5, v89
  v_mfma_f32_16x16x32_bf16 v[84:87], v[36:39], v[220:223], v[84:87]
  s_waitcnt lgkmcnt(5)
  v_accvgpr_write_b32 a6, v90
  v_mfma_f32_16x16x32_bf16 v[56:59], v[40:43], v[128:131], v[56:59]
  ds_read_b128 v[32:35], v249 offset:33024
  v_accvgpr_write_b32 a7, v91
  v_mfma_f32_16x16x32_bf16 v[64:67], v[40:43], v[160:163], v[64:67]
  v_mul_f32 v96, v12, v96
  v_mul_f32 v97, v12, v97
  v_mfma_f32_16x16x32_bf16 v[72:75], v[40:43], v[192:195], v[72:75]
  s_add_u32 m0, s29, 83968
  s_add_u32 s27, s28, 1343488
  buffer_load_dwordx4 v14, s[60:63], s27 offen lds
  v_mfma_f32_16x16x32_bf16 v[80:83], v[40:43], v[224:227], v[80:83]
  s_waitcnt lgkmcnt(5)
  v_mul_f32 v98, v12, v98
  v_mfma_f32_16x16x32_bf16 v[60:63], v[44:47], v[128:131], v[60:63]
  ds_read_b128 v[36:39], v249 offset:35072
  v_mul_f32 v99, v12, v99
  v_mfma_f32_16x16x32_bf16 v[68:71], v[44:47], v[160:163], v[68:71]
  v_mul_f32 v100, v12, v100
  v_mul_f32 v101, v12, v101
  v_mfma_f32_16x16x32_bf16 v[76:79], v[44:47], v[192:195], v[76:79]
  v_mul_f32 v102, v12, v102
  v_mfma_f32_16x16x32_bf16 v[84:87], v[44:47], v[224:227], v[84:87]
  s_waitcnt lgkmcnt(5)
  v_mul_f32 v103, v12, v103
  v_mfma_f32_16x16x32_bf16 v[56:59], v[48:51], v[132:135], v[56:59]
  ds_read_b128 v[40:43], v250 offset:33024
  v_cvt_pk_bf16_f32 v96, v96, v97
  v_mfma_f32_16x16x32_bf16 v[64:67], v[48:51], v[164:167], v[64:67]
  v_cvt_pk_bf16_f32 v97, v98, v99
  v_cvt_pk_bf16_f32 v98, v100, v101
  v_mfma_f32_16x16x32_bf16 v[72:75], v[48:51], v[196:199], v[72:75]
  s_add_u32 m0, s29, 84992
  s_add_u32 s27, s28, 1359872
  buffer_load_dwordx4 v15, s[60:63], s27 offen lds
  v_mfma_f32_16x16x32_bf16 v[80:83], v[48:51], v[228:231], v[80:83]
  s_waitcnt lgkmcnt(5)
  v_cvt_pk_bf16_f32 v99, v102, v103
  v_mfma_f32_16x16x32_bf16 v[60:63], v[52:55], v[132:135], v[60:63]
  ds_read_b128 v[44:47], v250 offset:35072
  v_accvgpr_write_b32 a60, v96
  v_mfma_f32_16x16x32_bf16 v[68:71], v[52:55], v[164:167], v[68:71]
  v_accvgpr_write_b32 a61, v97
  v_accvgpr_write_b32 a62, v98
  v_mfma_f32_16x16x32_bf16 v[76:79], v[52:55], v[196:199], v[76:79]
  v_accvgpr_write_b32 a63, v99
  v_mfma_f32_16x16x32_bf16 v[84:87], v[52:55], v[228:231], v[84:87]
  s_waitcnt lgkmcnt(5)
  v_mul_f32 v104, v12, v104
  v_mfma_f32_16x16x32_bf16 v[56:59], v[24:27], v[136:139], v[56:59]
  ds_read_b128 v[48:51], v251 offset:33024
  v_mul_f32 v105, v12, v105
  v_mfma_f32_16x16x32_bf16 v[64:67], v[24:27], v[168:171], v[64:67]
  v_mul_f32 v106, v12, v106
  v_mul_f32 v107, v12, v107
  v_mfma_f32_16x16x32_bf16 v[72:75], v[24:27], v[200:203], v[72:75]
  v_mul_f32 v108, v12, v108
  v_mfma_f32_16x16x32_bf16 v[80:83], v[24:27], v[232:235], v[80:83]
  s_waitcnt lgkmcnt(5)
  v_mul_f32 v109, v12, v109
  v_mfma_f32_16x16x32_bf16 v[60:63], v[28:31], v[136:139], v[60:63]
  ds_read_b128 v[52:55], v251 offset:35072
  v_mul_f32 v110, v12, v110
  v_mfma_f32_16x16x32_bf16 v[68:71], v[28:31], v[168:171], v[68:71]
  v_mul_f32 v111, v12, v111
  v_cvt_pk_bf16_f32 v104, v104, v105
  v_mfma_f32_16x16x32_bf16 v[76:79], v[28:31], v[200:203], v[76:79]
  v_cvt_pk_bf16_f32 v105, v106, v107
  v_mfma_f32_16x16x32_bf16 v[84:87], v[28:31], v[232:235], v[84:87]
  s_waitcnt lgkmcnt(5)
  v_cvt_pk_bf16_f32 v106, v108, v109
  v_mfma_f32_16x16x32_bf16 v[56:59], v[32:35], v[140:143], v[56:59]
  s_waitcnt vmcnt(8)
  s_barrier
  ds_read_b128 v[24:27], v248 offset:49152
  v_cvt_pk_bf16_f32 v107, v110, v111
  v_mfma_f32_16x16x32_bf16 v[64:67], v[32:35], v[172:175], v[64:67]
  v_accvgpr_write_b32 a116, v104
  v_accvgpr_write_b32 a117, v105
  v_mfma_f32_16x16x32_bf16 v[72:75], v[32:35], v[204:207], v[72:75]
  v_accvgpr_write_b32 a118, v106
  v_mfma_f32_16x16x32_bf16 v[80:83], v[32:35], v[236:239], v[80:83]
  s_waitcnt lgkmcnt(5)
  v_accvgpr_write_b32 a119, v107
  v_mfma_f32_16x16x32_bf16 v[60:63], v[36:39], v[140:143], v[60:63]
  ds_read_b128 v[28:31], v248 offset:51200
  v_mul_f32 v112, v12, v112
  v_mfma_f32_16x16x32_bf16 v[68:71], v[36:39], v[172:175], v[68:71]
  v_mul_f32 v113, v12, v113
  v_mul_f32 v114, v12, v114
  v_mfma_f32_16x16x32_bf16 v[76:79], v[36:39], v[204:207], v[76:79]
  v_mul_f32 v115, v12, v115
  v_mfma_f32_16x16x32_bf16 v[84:87], v[36:39], v[236:239], v[84:87]
  s_waitcnt lgkmcnt(5)
  v_mul_f32 v116, v12, v116
  v_mfma_f32_16x16x32_bf16 v[56:59], v[40:43], v[144:147], v[56:59]
  ds_read_b128 v[32:35], v249 offset:49152
  v_mul_f32 v117, v12, v117
  v_mfma_f32_16x16x32_bf16 v[64:67], v[40:43], v[176:179], v[64:67]
  v_mul_f32 v118, v12, v118
  v_mul_f32 v119, v12, v119
  v_mfma_f32_16x16x32_bf16 v[72:75], v[40:43], v[208:211], v[72:75]
  v_cvt_pk_bf16_f32 v112, v112, v113
  v_mfma_f32_16x16x32_bf16 v[80:83], v[40:43], v[240:243], v[80:83]
  s_waitcnt lgkmcnt(5)
  v_cvt_pk_bf16_f32 v113, v114, v115
  v_mfma_f32_16x16x32_bf16 v[60:63], v[44:47], v[144:147], v[60:63]
  ds_read_b128 v[36:39], v249 offset:51200
  v_cvt_pk_bf16_f32 v114, v116, v117
  v_mfma_f32_16x16x32_bf16 v[68:71], v[44:47], v[176:179], v[68:71]
  v_cvt_pk_bf16_f32 v115, v118, v119
  v_accvgpr_write_b32 a172, v112
  v_mfma_f32_16x16x32_bf16 v[76:79], v[44:47], v[208:211], v[76:79]
  v_accvgpr_write_b32 a173, v113
  v_mfma_f32_16x16x32_bf16 v[84:87], v[44:47], v[240:243], v[84:87]
  s_waitcnt lgkmcnt(5)
  v_accvgpr_write_b32 a174, v114
  v_mfma_f32_16x16x32_bf16 v[56:59], v[48:51], v[148:151], v[56:59]
  ds_read_b128 v[40:43], v250 offset:49152
  v_accvgpr_write_b32 a175, v115
  v_mfma_f32_16x16x32_bf16 v[64:67], v[48:51], v[180:183], v[64:67]
  v_mfma_f32_16x16x32_bf16 v[72:75], v[48:51], v[212:215], v[72:75]
  v_mfma_f32_16x16x32_bf16 v[80:83], v[48:51], v[244:247], v[80:83]
  s_waitcnt lgkmcnt(5)
  v_mfma_f32_16x16x32_bf16 v[60:63], v[52:55], v[148:151], v[60:63]
  ds_read_b128 v[44:47], v250 offset:51200
  v_mfma_f32_16x16x32_bf16 v[68:71], v[52:55], v[180:183], v[68:71]
  v_mfma_f32_16x16x32_bf16 v[76:79], v[52:55], v[212:215], v[76:79]
  v_mfma_f32_16x16x32_bf16 v[84:87], v[52:55], v[244:247], v[84:87]
  s_waitcnt lgkmcnt(5)
  s_getpc_b64 s[98:99]
  s_add_u32 s98, s98, 4096
  s_addc_u32 s99, s99, 0
  global_load_dword v7, v6, s[98:99]
  v_mfma_f32_16x16x32_bf16 v[88:91], v[24:27], v[120:123], 0
  ds_read_b128 v[48:51], v251 offset:49152
  v_mfma_f32_16x16x32_bf16 v[96:99], v[24:27], v[152:155], 0
  v_mfma_f32_16x16x32_bf16 v[104:107], v[24:27], v[184:187], 0
  s_add_u32 m0, s29, 98304
  s_add_u32 s27, s28, 1572864
  buffer_load_dwordx4 v14, s[60:63], s27 offen lds
  v_mfma_f32_16x16x32_bf16 v[112:115], v[24:27], v[216:219], 0
  s_waitcnt lgkmcnt(5)
  v_mul_f32 v56, v12, v56
  v_mfma_f32_16x16x32_bf16 v[92:95], v[28:31], v[120:123], 0
  ds_read_b128 v[52:55], v251 offset:51200
  v_mul_f32 v57, v12, v57
  v_mfma_f32_16x16x32_bf16 v[100:103], v[28:31], v[152:155], 0
  v_mul_f32 v58, v12, v58
  v_mul_f32 v59, v12, v59
  v_mfma_f32_16x16x32_bf16 v[108:111], v[28:31], v[184:187], 0
  v_mul_f32 v60, v12, v60
  v_mfma_f32_16x16x32_bf16 v[116:119], v[28:31], v[216:219], 0
  s_waitcnt lgkmcnt(5)
  v_mul_f32 v61, v12, v61
  v_mfma_f32_16x16x32_bf16 v[88:91], v[32:35], v[124:127], v[88:91]
  ds_read_b128 v[24:27], v248 offset:49408
  v_mul_f32 v62, v12, v62
  v_mfma_f32_16x16x32_bf16 v[96:99], v[32:35], v[156:159], v[96:99]
  v_mul_f32 v63, v12, v63
  v_cvt_pk_bf16_f32 v56, v56, v57
  v_mfma_f32_16x16x32_bf16 v[104:107], v[32:35], v[188:191], v[104:107]
  s_add_u32 m0, s29, 99328
  s_add_u32 s27, s28, 1589248
  buffer_load_dwordx4 v15, s[60:63], s27 offen lds
  v_mfma_f32_16x16x32_bf16 v[112:115], v[32:35], v[220:223], v[112:115]
  s_waitcnt lgkmcnt(5)
  v_cvt_pk_bf16_f32 v57, v58, v59
  v_mfma_f32_16x16x32_bf16 v[92:95], v[36:39], v[124:127], v[92:95]
  ds_read_b128 v[28:31], v248 offset:51456
  v_cvt_pk_bf16_f32 v58, v60, v61
  v_mfma_f32_16x16x32_bf16 v[100:103], v[36:39], v[156:159], v[100:103]
  v_cvt_pk_bf16_f32 v59, v62, v63
  v_accvgpr_write_b32 a8, v56
  v_mfma_f32_16x16x32_bf16 v[108:111], v[36:39], v[188:191], v[108:111]
  v_accvgpr_write_b32 a9, v57
  v_mfma_f32_16x16x32_bf16 v[116:119], v[36:39], v[220:223], v[116:119]
  s_waitcnt lgkmcnt(5)
  v_accvgpr_write_b32 a10, v58
  v_mfma_f32_16x16x32_bf16 v[88:91], v[40:43], v[128:131], v[88:91]
  ds_read_b128 v[32:35], v249 offset:49408
  v_accvgpr_write_b32 a11, v59
  v_mfma_f32_16x16x32_bf16 v[96:99], v[40:43], v[160:163], v[96:99]
  v_mul_f32 v64, v12, v64
  v_mul_f32 v65, v12, v65
  v_mfma_f32_16x16x32_bf16 v[104:107], v[40:43], v[192:195], v[104:107]
  s_add_u32 m0, s29, 100352
  s_add_u32 s27, s28, 1605632
  buffer_load_dwordx4 v14, s[60:63], s27 offen lds
  v_mfma_f32_16x16x32_bf16 v[112:115], v[40:43], v[224:227], v[112:115]
  s_waitcnt lgkmcnt(5)
  v_mul_f32 v66, v12, v66
  v_mfma_f32_16x16x32_bf16 v[92:95], v[44:47], v[128:131], v[92:95]
  ds_read_b128 v[36:39], v249 offset:51456
  v_mul_f32 v67, v12, v67
  v_mfma_f32_16x16x32_bf16 v[100:103], v[44:47], v[160:163], v[100:103]
  v_mul_f32 v68, v12, v68
  v_mul_f32 v69, v12, v69
  v_mfma_f32_16x16x32_bf16 v[108:111], v[44:47], v[192:195], v[108:111]
  v_mul_f32 v70, v12, v70
  v_mfma_f32_16x16x32_bf16 v[116:119], v[44:47], v[224:227], v[116:119]
  s_waitcnt lgkmcnt(5)
  v_mul_f32 v71, v12, v71
  v_mfma_f32_16x16x32_bf16 v[88:91], v[48:51], v[132:135], v[88:91]
  ds_read_b128 v[40:43], v250 offset:49408
  v_cvt_pk_bf16_f32 v64, v64, v65
  v_mfma_f32_16x16x32_bf16 v[96:99], v[48:51], v[164:167], v[96:99]
  v_cvt_pk_bf16_f32 v65, v66, v67
  v_cvt_pk_bf16_f32 v66, v68, v69
  v_mfma_f32_16x16x32_bf16 v[104:107], v[48:51], v[196:199], v[104:107]
  s_add_u32 m0, s29, 101376
  s_add_u32 s27, s28, 1622016
  buffer_load_dwordx4 v15, s[60:63], s27 offen lds
  v_mfma_f32_16x16x32_bf16 v[112:115], v[48:51], v[228:231], v[112:115]
  s_waitcnt lgkmcnt(5)
  v_cvt_pk_bf16_f32 v67, v70, v71
  v_mfma_f32_16x16x32_bf16 v[92:95], v[52:55], v[132:135], v[92:95]
  ds_read_b128 v[44:47], v250 offset:51456
  v_accvgpr_write_b32 a64, v64
  v_mfma_f32_16x16x32_bf16 v[100:103], v[52:55], v[164:167], v[100:103]
  v_accvgpr_write_b32 a65, v65
  v_accvgpr_write_b32 a66, v66
  v_mfma_f32_16x16x32_bf16 v[108:111], v[52:55], v[196:199], v[108:111]
  v_accvgpr_write_b32 a67, v67
  v_mfma_f32_16x16x32_bf16 v[116:119], v[52:55], v[228:231], v[116:119]
  s_waitcnt lgkmcnt(5)
  v_mul_f32 v72, v12, v72
  v_mfma_f32_16x16x32_bf16 v[88:91], v[24:27], v[136:139], v[88:91]
  ds_read_b128 v[48:51], v251 offset:49408
  v_mul_f32 v73, v12, v73
  v_mfma_f32_16x16x32_bf16 v[96:99], v[24:27], v[168:171], v[96:99]
  v_mul_f32 v74, v12, v74
  v_mul_f32 v75, v12, v75
  v_mfma_f32_16x16x32_bf16 v[104:107], v[24:27], v[200:203], v[104:107]
  v_mul_f32 v76, v12, v76
  v_mfma_f32_16x16x32_bf16 v[112:115], v[24:27], v[232:235], v[112:115]
  s_waitcnt lgkmcnt(5)
  v_mul_f32 v77, v12, v77
  v_mfma_f32_16x16x32_bf16 v[92:95], v[28:31], v[136:139], v[92:95]
  ds_read_b128 v[52:55], v251 offset:51456
  v_mul_f32 v78, v12, v78
  v_mfma_f32_16x16x32_bf16 v[100:103], v[28:31], v[168:171], v[100:103]
  v_mul_f32 v79, v12, v79
  v_cvt_pk_bf16_f32 v72, v72, v73
  v_mfma_f32_16x16x32_bf16 v[108:111], v[28:31], v[200:203], v[108:111]
  v_cvt_pk_bf16_f32 v73, v74, v75
  v_mfma_f32_16x16x32_bf16 v[116:119], v[28:31], v[232:235], v[116:119]
  s_waitcnt lgkmcnt(5)
  v_cvt_pk_bf16_f32 v74, v76, v77
  v_mfma_f32_16x16x32_bf16 v[88:91], v[32:35], v[140:143], v[88:91]
  s_waitcnt vmcnt(8)
  s_barrier
  ds_read_b128 v[24:27], v252 offset:0
  v_cvt_pk_bf16_f32 v75, v78, v79
  v_mfma_f32_16x16x32_bf16 v[96:99], v[32:35], v[172:175], v[96:99]
  v_accvgpr_write_b32 a120, v72
  v_accvgpr_write_b32 a121, v73
  v_mfma_f32_16x16x32_bf16 v[104:107], v[32:35], v[204:207], v[104:107]
  v_accvgpr_write_b32 a122, v74
  v_mfma_f32_16x16x32_bf16 v[112:115], v[32:35], v[236:239], v[112:115]
  s_waitcnt lgkmcnt(5)
  v_accvgpr_write_b32 a123, v75
  v_mfma_f32_16x16x32_bf16 v[92:95], v[36:39], v[140:143], v[92:95]
  ds_read_b128 v[28:31], v252 offset:2048
  v_mul_f32 v80, v12, v80
  v_mfma_f32_16x16x32_bf16 v[100:103], v[36:39], v[172:175], v[100:103]
  v_mul_f32 v81, v12, v81
  v_mul_f32 v82, v12, v82
  v_mfma_f32_16x16x32_bf16 v[108:111], v[36:39], v[204:207], v[108:111]
  v_mul_f32 v83, v12, v83
  v_mfma_f32_16x16x32_bf16 v[116:119], v[36:39], v[236:239], v[116:119]
  s_waitcnt lgkmcnt(5)
  v_mul_f32 v84, v12, v84
  v_mfma_f32_16x16x32_bf16 v[88:91], v[40:43], v[144:147], v[88:91]
  ds_read_b128 v[32:35], v253 offset:0
  v_mul_f32 v85, v12, v85
  v_mfma_f32_16x16x32_bf16 v[96:99], v[40:43], v[176:179], v[96:99]
  v_mul_f32 v86, v12, v86
  v_mul_f32 v87, v12, v87
  v_mfma_f32_16x16x32_bf16 v[104:107], v[40:43], v[208:211], v[104:107]
  v_cvt_pk_bf16_f32 v80, v80, v81
  v_mfma_f32_16x16x32_bf16 v[112:115], v[40:43], v[240:243], v[112:115]
  s_waitcnt lgkmcnt(5)
  v_cvt_pk_bf16_f32 v81, v82, v83
  v_mfma_f32_16x16x32_bf16 v[92:95], v[44:47], v[144:147], v[92:95]
  ds_read_b128 v[36:39], v253 offset:2048
  v_cvt_pk_bf16_f32 v82, v84, v85
  v_mfma_f32_16x16x32_bf16 v[100:103], v[44:47], v[176:179], v[100:103]
  v_cvt_pk_bf16_f32 v83, v86, v87
  v_accvgpr_write_b32 a176, v80
  v_mfma_f32_16x16x32_bf16 v[108:111], v[44:47], v[208:211], v[108:111]
  v_accvgpr_write_b32 a177, v81
  v_mfma_f32_16x16x32_bf16 v[116:119], v[44:47], v[240:243], v[116:119]
  s_waitcnt lgkmcnt(5)
  v_accvgpr_write_b32 a178, v82
  v_mfma_f32_16x16x32_bf16 v[88:91], v[48:51], v[148:151], v[88:91]
  ds_read_b128 v[40:43], v254 offset:0
  v_accvgpr_write_b32 a179, v83
  v_mfma_f32_16x16x32_bf16 v[96:99], v[48:51], v[180:183], v[96:99]
  v_mfma_f32_16x16x32_bf16 v[104:107], v[48:51], v[212:215], v[104:107]
  v_mfma_f32_16x16x32_bf16 v[112:115], v[48:51], v[244:247], v[112:115]
  s_waitcnt lgkmcnt(5)
  v_mfma_f32_16x16x32_bf16 v[92:95], v[52:55], v[148:151], v[92:95]
  ds_read_b128 v[44:47], v254 offset:2048
  v_mfma_f32_16x16x32_bf16 v[100:103], v[52:55], v[180:183], v[100:103]
  v_mfma_f32_16x16x32_bf16 v[108:111], v[52:55], v[212:215], v[108:111]
  v_mfma_f32_16x16x32_bf16 v[116:119], v[52:55], v[244:247], v[116:119]
  s_waitcnt lgkmcnt(5)
  v_mfma_f32_16x16x32_bf16 v[56:59], v[24:27], v[120:123], 0
  ds_read_b128 v[48:51], v255 offset:0
  v_mfma_f32_16x16x32_bf16 v[64:67], v[24:27], v[152:155], 0
  v_mfma_f32_16x16x32_bf16 v[72:75], v[24:27], v[184:187], 0
  s_add_u32 m0, s29, 114688
  s_add_u32 s27, s28, 1835008
  buffer_load_dwordx4 v14, s[60:63], s27 offen lds
  v_mfma_f32_16x16x32_bf16 v[80:83], v[24:27], v[216:219], 0
  s_waitcnt lgkmcnt(5)
  v_mul_f32 v88, v12, v88
  v_mfma_f32_16x16x32_bf16 v[60:63], v[28:31], v[120:123], 0
  ds_read_b128 v[52:55], v255 offset:2048
  v_mul_f32 v89, v12, v89
  v_mfma_f32_16x16x32_bf16 v[68:71], v[28:31], v[152:155], 0
  v_mul_f32 v90, v12, v90
  v_mul_f32 v91, v12, v91
  v_mfma_f32_16x16x32_bf16 v[76:79], v[28:31], v[184:187], 0
  v_mul_f32 v92, v12, v92
  v_mfma_f32_16x16x32_bf16 v[84:87], v[28:31], v[216:219], 0
  s_waitcnt lgkmcnt(5)
  v_mul_f32 v93, v12, v93
  v_mfma_f32_16x16x32_bf16 v[56:59], v[32:35], v[124:127], v[56:59]
  ds_read_b128 v[24:27], v252 offset:256
  v_mul_f32 v94, v12, v94
  v_mfma_f32_16x16x32_bf16 v[64:67], v[32:35], v[156:159], v[64:67]
  v_mul_f32 v95, v12, v95
  v_cvt_pk_bf16_f32 v88, v88, v89
  v_mfma_f32_16x16x32_bf16 v[72:75], v[32:35], v[188:191], v[72:75]
  s_add_u32 m0, s29, 115712
  s_add_u32 s27, s28, 1851392
  buffer_load_dwordx4 v15, s[60:63], s27 offen lds
  v_mfma_f32_16x16x32_bf16 v[80:83], v[32:35], v[220:223], v[80:83]
  s_waitcnt lgkmcnt(5)
  v_cvt_pk_bf16_f32 v89, v90, v91
  v_mfma_f32_16x16x32_bf16 v[60:63], v[36:39], v[124:127], v[60:63]
  ds_read_b128 v[28:31], v252 offset:2304
  v_cvt_pk_bf16_f32 v90, v92, v93
  v_mfma_f32_16x16x32_bf16 v[68:71], v[36:39], v[156:159], v[68:71]
  v_cvt_pk_bf16_f32 v91, v94, v95
  v_accvgpr_write_b32 a12, v88
  v_mfma_f32_16x16x32_bf16 v[76:79], v[36:39], v[188:191], v[76:79]
  v_accvgpr_write_b32 a13, v89
  v_mfma_f32_16x16x32_bf16 v[84:87], v[36:39], v[220:223], v[84:87]
  s_waitcnt lgkmcnt(5)
  v_accvgpr_write_b32 a14, v90
  v_mfma_f32_16x16x32_bf16 v[56:59], v[40:43], v[128:131], v[56:59]
  ds_read_b128 v[32:35], v253 offset:256
  v_accvgpr_write_b32 a15, v91
  v_mfma_f32_16x16x32_bf16 v[64:67], v[40:43], v[160:163], v[64:67]
  v_mul_f32 v96, v12, v96
  v_mul_f32 v97, v12, v97
  v_mfma_f32_16x16x32_bf16 v[72:75], v[40:43], v[192:195], v[72:75]
  s_add_u32 m0, s29, 116736
  s_add_u32 s27, s28, 1867776
  buffer_load_dwordx4 v14, s[60:63], s27 offen lds
  v_mfma_f32_16x16x32_bf16 v[80:83], v[40:43], v[224:227], v[80:83]
  s_waitcnt lgkmcnt(5)
  v_mul_f32 v98, v12, v98
  v_mfma_f32_16x16x32_bf16 v[60:63], v[44:47], v[128:131], v[60:63]
  ds_read_b128 v[36:39], v253 offset:2304
  v_mul_f32 v99, v12, v99
  v_mfma_f32_16x16x32_bf16 v[68:71], v[44:47], v[160:163], v[68:71]
  v_mul_f32 v100, v12, v100
  v_mul_f32 v101, v12, v101
  v_mfma_f32_16x16x32_bf16 v[76:79], v[44:47], v[192:195], v[76:79]
  v_mul_f32 v102, v12, v102
  v_mfma_f32_16x16x32_bf16 v[84:87], v[44:47], v[224:227], v[84:87]
  s_waitcnt lgkmcnt(5)
  v_mul_f32 v103, v12, v103
  v_mfma_f32_16x16x32_bf16 v[56:59], v[48:51], v[132:135], v[56:59]
  ds_read_b128 v[40:43], v254 offset:256
  v_cvt_pk_bf16_f32 v96, v96, v97
  v_mfma_f32_16x16x32_bf16 v[64:67], v[48:51], v[164:167], v[64:67]
  v_cvt_pk_bf16_f32 v97, v98, v99
  v_cvt_pk_bf16_f32 v98, v100, v101
  v_mfma_f32_16x16x32_bf16 v[72:75], v[48:51], v[196:199], v[72:75]
  s_add_u32 m0, s29, 117760
  s_add_u32 s27, s28, 1884160
  buffer_load_dwordx4 v15, s[60:63], s27 offen lds
  v_mfma_f32_16x16x32_bf16 v[80:83], v[48:51], v[228:231], v[80:83]
  s_waitcnt lgkmcnt(5)
  v_cvt_pk_bf16_f32 v99, v102, v103
  v_mfma_f32_16x16x32_bf16 v[60:63], v[52:55], v[132:135], v[60:63]
  ds_read_b128 v[44:47], v254 offset:2304
  v_accvgpr_write_b32 a68, v96
  v_mfma_f32_16x16x32_bf16 v[68:71], v[52:55], v[164:167], v[68:71]
  v_accvgpr_write_b32 a69, v97
  v_accvgpr_write_b32 a70, v98
  v_mfma_f32_16x16x32_bf16 v[76:79], v[52:55], v[196:199], v[76:79]
  v_accvgpr_write_b32 a71, v99
  v_mfma_f32_16x16x32_bf16 v[84:87], v[52:55], v[228:231], v[84:87]
  s_waitcnt lgkmcnt(5)
  v_mul_f32 v104, v12, v104
  v_mfma_f32_16x16x32_bf16 v[56:59], v[24:27], v[136:139], v[56:59]
  ds_read_b128 v[48:51], v255 offset:256
  v_mul_f32 v105, v12, v105
  v_mfma_f32_16x16x32_bf16 v[64:67], v[24:27], v[168:171], v[64:67]
  v_mul_f32 v106, v12, v106
  v_mul_f32 v107, v12, v107
  v_mfma_f32_16x16x32_bf16 v[72:75], v[24:27], v[200:203], v[72:75]
  v_mul_f32 v108, v12, v108
  v_mfma_f32_16x16x32_bf16 v[80:83], v[24:27], v[232:235], v[80:83]
  s_waitcnt lgkmcnt(5)
  v_mul_f32 v109, v12, v109
  v_mfma_f32_16x16x32_bf16 v[60:63], v[28:31], v[136:139], v[60:63]
  ds_read_b128 v[52:55], v255 offset:2304
  v_mul_f32 v110, v12, v110
  v_mfma_f32_16x16x32_bf16 v[68:71], v[28:31], v[168:171], v[68:71]
  v_mul_f32 v111, v12, v111
  v_cvt_pk_bf16_f32 v104, v104, v105
  v_mfma_f32_16x16x32_bf16 v[76:79], v[28:31], v[200:203], v[76:79]
  v_cvt_pk_bf16_f32 v105, v106, v107
  v_mfma_f32_16x16x32_bf16 v[84:87], v[28:31], v[232:235], v[84:87]
  s_waitcnt lgkmcnt(5)
  v_cvt_pk_bf16_f32 v106, v108, v109
  v_mfma_f32_16x16x32_bf16 v[56:59], v[32:35], v[140:143], v[56:59]
  s_waitcnt vmcnt(8)
  s_barrier
  ds_read_b128 v[24:27], v252 offset:16384
  v_cvt_pk_bf16_f32 v107, v110, v111
  v_mfma_f32_16x16x32_bf16 v[64:67], v[32:35], v[172:175], v[64:67]
  v_accvgpr_write_b32 a124, v104
  v_accvgpr_write_b32 a125, v105
  v_mfma_f32_16x16x32_bf16 v[72:75], v[32:35], v[204:207], v[72:75]
  v_accvgpr_write_b32 a126, v106
  v_mfma_f32_16x16x32_bf16 v[80:83], v[32:35], v[236:239], v[80:83]
  s_waitcnt lgkmcnt(5)
  v_accvgpr_write_b32 a127, v107
  v_mfma_f32_16x16x32_bf16 v[60:63], v[36:39], v[140:143], v[60:63]
  ds_read_b128 v[28:31], v252 offset:18432
  v_mul_f32 v112, v12, v112
  v_mfma_f32_16x16x32_bf16 v[68:71], v[36:39], v[172:175], v[68:71]
  v_mul_f32 v113, v12, v113
  v_mul_f32 v114, v12, v114
  v_mfma_f32_16x16x32_bf16 v[76:79], v[36:39], v[204:207], v[76:79]
  v_mul_f32 v115, v12, v115
  v_mfma_f32_16x16x32_bf16 v[84:87], v[36:39], v[236:239], v[84:87]
  s_waitcnt lgkmcnt(5)
  v_mul_f32 v116, v12, v116
  v_mfma_f32_16x16x32_bf16 v[56:59], v[40:43], v[144:147], v[56:59]
  ds_read_b128 v[32:35], v253 offset:16384
  v_mul_f32 v117, v12, v117
  v_mfma_f32_16x16x32_bf16 v[64:67], v[40:43], v[176:179], v[64:67]
  v_mul_f32 v118, v12, v118
  v_mul_f32 v119, v12, v119
  v_mfma_f32_16x16x32_bf16 v[72:75], v[40:43], v[208:211], v[72:75]
  v_cvt_pk_bf16_f32 v112, v112, v113
  v_mfma_f32_16x16x32_bf16 v[80:83], v[40:43], v[240:243], v[80:83]
  s_waitcnt lgkmcnt(5)
  v_cvt_pk_bf16_f32 v113, v114, v115
  v_mfma_f32_16x16x32_bf16 v[60:63], v[44:47], v[144:147], v[60:63]
  ds_read_b128 v[36:39], v253 offset:18432
  v_cvt_pk_bf16_f32 v114, v116, v117
  v_mfma_f32_16x16x32_bf16 v[68:71], v[44:47], v[176:179], v[68:71]
  v_cvt_pk_bf16_f32 v115, v118, v119
  v_accvgpr_write_b32 a180, v112
  v_mfma_f32_16x16x32_bf16 v[76:79], v[44:47], v[208:211], v[76:79]
  v_accvgpr_write_b32 a181, v113
  v_mfma_f32_16x16x32_bf16 v[84:87], v[44:47], v[240:243], v[84:87]
  s_waitcnt lgkmcnt(5)
  v_accvgpr_write_b32 a182, v114
  v_mfma_f32_16x16x32_bf16 v[56:59], v[48:51], v[148:151], v[56:59]
  ds_read_b128 v[40:43], v254 offset:16384
  v_accvgpr_write_b32 a183, v115
  v_mfma_f32_16x16x32_bf16 v[64:67], v[48:51], v[180:183], v[64:67]
  v_mfma_f32_16x16x32_bf16 v[72:75], v[48:51], v[212:215], v[72:75]
  v_mfma_f32_16x16x32_bf16 v[80:83], v[48:51], v[244:247], v[80:83]
  s_waitcnt lgkmcnt(5)
  v_mfma_f32_16x16x32_bf16 v[60:63], v[52:55], v[148:151], v[60:63]
  ds_read_b128 v[44:47], v254 offset:18432
  v_mfma_f32_16x16x32_bf16 v[68:71], v[52:55], v[180:183], v[68:71]
  v_mfma_f32_16x16x32_bf16 v[76:79], v[52:55], v[212:215], v[76:79]
  v_mfma_f32_16x16x32_bf16 v[84:87], v[52:55], v[244:247], v[84:87]
  s_waitcnt lgkmcnt(5)
  v_mfma_f32_16x16x32_bf16 v[88:91], v[24:27], v[120:123], 0
  ds_read_b128 v[48:51], v255 offset:16384
  v_mfma_f32_16x16x32_bf16 v[96:99], v[24:27], v[152:155], 0
  v_mfma_f32_16x16x32_bf16 v[104:107], v[24:27], v[184:187], 0
  s_add_u32 m0, s29, 131072
  s_add_u32 s27, s28, 2097152
  buffer_load_dwordx4 v14, s[60:63], s27 offen lds
  v_mfma_f32_16x16x32_bf16 v[112:115], v[24:27], v[216:219], 0
  s_waitcnt lgkmcnt(5)
  v_mul_f32 v56, v12, v56
  v_mfma_f32_16x16x32_bf16 v[92:95], v[28:31], v[120:123], 0
  ds_read_b128 v[52:55], v255 offset:18432
  v_mul_f32 v57, v12, v57
  v_mfma_f32_16x16x32_bf16 v[100:103], v[28:31], v[152:155], 0
  v_mul_f32 v58, v12, v58
  v_mul_f32 v59, v12, v59
  v_mfma_f32_16x16x32_bf16 v[108:111], v[28:31], v[184:187], 0
  v_mul_f32 v60, v12, v60
  v_mfma_f32_16x16x32_bf16 v[116:119], v[28:31], v[216:219], 0
  s_waitcnt lgkmcnt(5)
  v_mul_f32 v61, v12, v61
  v_mfma_f32_16x16x32_bf16 v[88:91], v[32:35], v[124:127], v[88:91]
  ds_read_b128 v[24:27], v252 offset:16640
  v_mul_f32 v62, v12, v62
  v_mfma_f32_16x16x32_bf16 v[96:99], v[32:35], v[156:159], v[96:99]
  v_mul_f32 v63, v12, v63
  v_cvt_pk_bf16_f32 v56, v56, v57
  v_mfma_f32_16x16x32_bf16 v[104:107], v[32:35], v[188:191], v[104:107]
  s_add_u32 m0, s29, 132096
  s_add_u32 s27, s28, 2113536
  buffer_load_dwordx4 v15, s[60:63], s27 offen lds
  v_mfma_f32_16x16x32_bf16 v[112:115], v[32:35], v[220:223], v[112:115]
  s_waitcnt lgkmcnt(5)
  v_cvt_pk_bf16_f32 v57, v58, v59
  v_mfma_f32_16x16x32_bf16 v[92:95], v[36:39], v[124:127], v[92:95]
  ds_read_b128 v[28:31], v252 offset:18688
  v_cvt_pk_bf16_f32 v58, v60, v61
  v_mfma_f32_16x16x32_bf16 v[100:103], v[36:39], v[156:159], v[100:103]
  v_cvt_pk_bf16_f32 v59, v62, v63
  v_accvgpr_write_b32 a16, v56
  v_mfma_f32_16x16x32_bf16 v[108:111], v[36:39], v[188:191], v[108:111]
  v_accvgpr_write_b32 a17, v57
  v_mfma_f32_16x16x32_bf16 v[116:119], v[36:39], v[220:223], v[116:119]
  s_waitcnt lgkmcnt(5)
  v_accvgpr_write_b32 a18, v58
  v_mfma_f32_16x16x32_bf16 v[88:91], v[40:43], v[128:131], v[88:91]
  ds_read_b128 v[32:35], v253 offset:16640
  v_accvgpr_write_b32 a19, v59
  v_mfma_f32_16x16x32_bf16 v[96:99], v[40:43], v[160:163], v[96:99]
  v_mul_f32 v64, v12, v64
  v_mul_f32 v65, v12, v65
  v_mfma_f32_16x16x32_bf16 v[104:107], v[40:43], v[192:195], v[104:107]
  s_add_u32 m0, s29, 133120
  s_add_u32 s27, s28, 2129920
  buffer_load_dwordx4 v14, s[60:63], s27 offen lds
  v_mfma_f32_16x16x32_bf16 v[112:115], v[40:43], v[224:227], v[112:115]
  s_waitcnt lgkmcnt(5)
  v_mul_f32 v66, v12, v66
  v_mfma_f32_16x16x32_bf16 v[92:95], v[44:47], v[128:131], v[92:95]
  ds_read_b128 v[36:39], v253 offset:18688
  v_mul_f32 v67, v12, v67
  v_mfma_f32_16x16x32_bf16 v[100:103], v[44:47], v[160:163], v[100:103]
  v_mul_f32 v68, v12, v68
  v_mul_f32 v69, v12, v69
  v_mfma_f32_16x16x32_bf16 v[108:111], v[44:47], v[192:195], v[108:111]
  v_mul_f32 v70, v12, v70
  v_mfma_f32_16x16x32_bf16 v[116:119], v[44:47], v[224:227], v[116:119]
  s_waitcnt lgkmcnt(5)
  v_mul_f32 v71, v12, v71
  v_mfma_f32_16x16x32_bf16 v[88:91], v[48:51], v[132:135], v[88:91]
  ds_read_b128 v[40:43], v254 offset:16640
  v_cvt_pk_bf16_f32 v64, v64, v65
  v_mfma_f32_16x16x32_bf16 v[96:99], v[48:51], v[164:167], v[96:99]
  v_cvt_pk_bf16_f32 v65, v66, v67
  v_cvt_pk_bf16_f32 v66, v68, v69
  v_mfma_f32_16x16x32_bf16 v[104:107], v[48:51], v[196:199], v[104:107]
  s_add_u32 m0, s29, 134144
  s_add_u32 s27, s28, 2146304
  buffer_load_dwordx4 v15, s[60:63], s27 offen lds
  v_mfma_f32_16x16x32_bf16 v[112:115], v[48:51], v[228:231], v[112:115]
  s_waitcnt lgkmcnt(5)
  v_cvt_pk_bf16_f32 v67, v70, v71
  v_mfma_f32_16x16x32_bf16 v[92:95], v[52:55], v[132:135], v[92:95]
  ds_read_b128 v[44:47], v254 offset:18688
  v_accvgpr_write_b32 a72, v64
  v_mfma_f32_16x16x32_bf16 v[100:103], v[52:55], v[164:167], v[100:103]
  v_accvgpr_write_b32 a73, v65
  v_accvgpr_write_b32 a74, v66
  v_mfma_f32_16x16x32_bf16 v[108:111], v[52:55], v[196:199], v[108:111]
  v_accvgpr_write_b32 a75, v67
  v_mfma_f32_16x16x32_bf16 v[116:119], v[52:55], v[228:231], v[116:119]
  s_waitcnt lgkmcnt(5)
  v_mul_f32 v72, v12, v72
  v_mfma_f32_16x16x32_bf16 v[88:91], v[24:27], v[136:139], v[88:91]
  ds_read_b128 v[48:51], v255 offset:16640
  v_mul_f32 v73, v12, v73
  v_mfma_f32_16x16x32_bf16 v[96:99], v[24:27], v[168:171], v[96:99]
  v_mul_f32 v74, v12, v74
  v_mul_f32 v75, v12, v75
  v_mfma_f32_16x16x32_bf16 v[104:107], v[24:27], v[200:203], v[104:107]
  v_mul_f32 v76, v12, v76
  v_mfma_f32_16x16x32_bf16 v[112:115], v[24:27], v[232:235], v[112:115]
  s_waitcnt lgkmcnt(5)
  v_mul_f32 v77, v12, v77
  v_mfma_f32_16x16x32_bf16 v[92:95], v[28:31], v[136:139], v[92:95]
  ds_read_b128 v[52:55], v255 offset:18688
  v_mul_f32 v78, v12, v78
  v_mfma_f32_16x16x32_bf16 v[100:103], v[28:31], v[168:171], v[100:103]
  v_mul_f32 v79, v12, v79
  v_cvt_pk_bf16_f32 v72, v72, v73
  v_mfma_f32_16x16x32_bf16 v[108:111], v[28:31], v[200:203], v[108:111]
  v_cvt_pk_bf16_f32 v73, v74, v75
  v_mfma_f32_16x16x32_bf16 v[116:119], v[28:31], v[232:235], v[116:119]
  s_waitcnt lgkmcnt(5)
  v_cvt_pk_bf16_f32 v74, v76, v77
  v_mfma_f32_16x16x32_bf16 v[88:91], v[32:35], v[140:143], v[88:91]
  s_waitcnt vmcnt(8)
  s_barrier
  ds_read_b128 v[24:27], v252 offset:32768
  v_cvt_pk_bf16_f32 v75, v78, v79
  v_mfma_f32_16x16x32_bf16 v[96:99], v[32:35], v[172:175], v[96:99]
  v_accvgpr_write_b32 a128, v72
  v_accvgpr_write_b32 a129, v73
  v_mfma_f32_16x16x32_bf16 v[104:107], v[32:35], v[204:207], v[104:107]
  v_accvgpr_write_b32 a130, v74
  v_mfma_f32_16x16x32_bf16 v[112:115], v[32:35], v[236:239], v[112:115]
  s_waitcnt lgkmcnt(5)
  v_accvgpr_write_b32 a131, v75
  v_mfma_f32_16x16x32_bf16 v[92:95], v[36:39], v[140:143], v[92:95]
  ds_read_b128 v[28:31], v252 offset:34816
  v_mul_f32 v80, v12, v80
  v_mfma_f32_16x16x32_bf16 v[100:103], v[36:39], v[172:175], v[100:103]
  v_mul_f32 v81, v12, v81
  v_mul_f32 v82, v12, v82
  v_mfma_f32_16x16x32_bf16 v[108:111], v[36:39], v[204:207], v[108:111]
  v_mul_f32 v83, v12, v83
  v_mfma_f32_16x16x32_bf16 v[116:119], v[36:39], v[236:239], v[116:119]
  s_waitcnt lgkmcnt(5)
  v_mul_f32 v84, v12, v84
  v_mfma_f32_16x16x32_bf16 v[88:91], v[40:43], v[144:147], v[88:91]
  ds_read_b128 v[32:35], v253 offset:32768
  v_mul_f32 v85, v12, v85
  v_mfma_f32_16x16x32_bf16 v[96:99], v[40:43], v[176:179], v[96:99]
  v_mul_f32 v86, v12, v86
  v_mul_f32 v87, v12, v87
  v_mfma_f32_16x16x32_bf16 v[104:107], v[40:43], v[208:211], v[104:107]
  v_cvt_pk_bf16_f32 v80, v80, v81
  v_mfma_f32_16x16x32_bf16 v[112:115], v[40:43], v[240:243], v[112:115]
  s_waitcnt lgkmcnt(5)
  v_cvt_pk_bf16_f32 v81, v82, v83
  v_mfma_f32_16x16x32_bf16 v[92:95], v[44:47], v[144:147], v[92:95]
  ds_read_b128 v[36:39], v253 offset:34816
  v_cvt_pk_bf16_f32 v82, v84, v85
  v_mfma_f32_16x16x32_bf16 v[100:103], v[44:47], v[176:179], v[100:103]
  v_cvt_pk_bf16_f32 v83, v86, v87
  v_accvgpr_write_b32 a184, v80
  v_mfma_f32_16x16x32_bf16 v[108:111], v[44:47], v[208:211], v[108:111]
  v_accvgpr_write_b32 a185, v81
  v_mfma_f32_16x16x32_bf16 v[116:119], v[44:47], v[240:243], v[116:119]
  s_waitcnt lgkmcnt(5)
  v_accvgpr_write_b32 a186, v82
  v_mfma_f32_16x16x32_bf16 v[88:91], v[48:51], v[148:151], v[88:91]
  ds_read_b128 v[40:43], v254 offset:32768
  v_accvgpr_write_b32 a187, v83
  v_mfma_f32_16x16x32_bf16 v[96:99], v[48:51], v[180:183], v[96:99]
  v_mfma_f32_16x16x32_bf16 v[104:107], v[48:51], v[212:215], v[104:107]
  v_mfma_f32_16x16x32_bf16 v[112:115], v[48:51], v[244:247], v[112:115]
  s_waitcnt lgkmcnt(5)
  v_mfma_f32_16x16x32_bf16 v[92:95], v[52:55], v[148:151], v[92:95]
  ds_read_b128 v[44:47], v254 offset:34816
  v_mfma_f32_16x16x32_bf16 v[100:103], v[52:55], v[180:183], v[100:103]
  v_mfma_f32_16x16x32_bf16 v[108:111], v[52:55], v[212:215], v[108:111]
  v_mfma_f32_16x16x32_bf16 v[116:119], v[52:55], v[244:247], v[116:119]
  s_waitcnt lgkmcnt(5)
  s_getpc_b64 s[98:99]
  s_add_u32 s98, s98, 4096
  s_addc_u32 s99, s99, 0
  global_load_dword v7, v6, s[98:99]
  v_mfma_f32_16x16x32_bf16 v[56:59], v[24:27], v[120:123], 0
  ds_read_b128 v[48:51], v255 offset:32768
  v_mfma_f32_16x16x32_bf16 v[64:67], v[24:27], v[152:155], 0
  v_mfma_f32_16x16x32_bf16 v[72:75], v[24:27], v[184:187], 0
  s_add_u32 m0, s29, 147456
  s_add_u32 s27, s28, 2359296
  buffer_load_dwordx4 v14, s[60:63], s27 offen lds
  v_mfma_f32_16x16x32_bf16 v[80:83], v[24:27], v[216:219], 0
  s_waitcnt lgkmcnt(5)
  v_mul_f32 v88, v12, v88
  v_mfma_f32_16x16x32_bf16 v[60:63], v[28:31], v[120:123], 0
  ds_read_b128 v[52:55], v255 offset:34816
  v_mul_f32 v89, v12, v89
  v_mfma_f32_16x16x32_bf16 v[68:71], v[28:31], v[152:155], 0
  v_mul_f32 v90, v12, v90
  v_mul_f32 v91, v12, v91
  v_mfma_f32_16x16x32_bf16 v[76:79], v[28:31], v[184:187], 0
  v_mul_f32 v92, v12, v92
  v_mfma_f32_16x16x32_bf16 v[84:87], v[28:31], v[216:219], 0
  s_waitcnt lgkmcnt(5)
  v_mul_f32 v93, v12, v93
  v_mfma_f32_16x16x32_bf16 v[56:59], v[32:35], v[124:127], v[56:59]
  ds_read_b128 v[24:27], v252 offset:33024
  v_mul_f32 v94, v12, v94
  v_mfma_f32_16x16x32_bf16 v[64:67], v[32:35], v[156:159], v[64:67]
  v_mul_f32 v95, v12, v95
  v_cvt_pk_bf16_f32 v88, v88, v89
  v_mfma_f32_16x16x32_bf16 v[72:75], v[32:35], v[188:191], v[72:75]
  s_add_u32 m0, s29, 148480
  s_add_u32 s27, s28, 2375680
  buffer_load_dwordx4 v15, s[60:63], s27 offen lds
  v_mfma_f32_16x16x32_bf16 v[80:83], v[32:35], v[220:223], v[80:83]
  s_waitcnt lgkmcnt(5)
  v_cvt_pk_bf16_f32 v89, v90, v91
  v_mfma_f32_16x16x32_bf16 v[60:63], v[36:39], v[124:127], v[60:63]
  ds_read_b128 v[28:31], v252 offset:35072
  v_cvt_pk_bf16_f32 v90, v92, v93
  v_mfma_f32_16x16x32_bf16 v[68:71], v[36:39], v[156:159], v[68:71]
  v_cvt_pk_bf16_f32 v91, v94, v95
  v_accvgpr_write_b32 a20, v88
  v_mfma_f32_16x16x32_bf16 v[76:79], v[36:39], v[188:191], v[76:79]
  v_accvgpr_write_b32 a21, v89
  v_mfma_f32_16x16x32_bf16 v[84:87], v[36:39], v[220:223], v[84:87]
  s_waitcnt lgkmcnt(5)
  v_accvgpr_write_b32 a22, v90
  v_mfma_f32_16x16x32_bf16 v[56:59], v[40:43], v[128:131], v[56:59]
  ds_read_b128 v[32:35], v253 offset:33024
  v_accvgpr_write_b32 a23, v91
  v_mfma_f32_16x16x32_bf16 v[64:67], v[40:43], v[160:163], v[64:67]
  v_mul_f32 v96, v12, v96
  v_mul_f32 v97, v12, v97
  v_mfma_f32_16x16x32_bf16 v[72:75], v[40:43], v[192:195], v[72:75]
  s_add_u32 m0, s29, 149504
  s_add_u32 s27, s28, 2392064
  buffer_load_dwordx4 v14, s[60:63], s27 offen lds
  v_mfma_f32_16x16x32_bf16 v[80:83], v[40:43], v[224:227], v[80:83]
  s_waitcnt lgkmcnt(5)
  v_mul_f32 v98, v12, v98
  v_mfma_f32_16x16x32_bf16 v[60:63], v[44:47], v[128:131], v[60:63]
  ds_read_b128 v[36:39], v253 offset:35072
  v_mul_f32 v99, v12, v99
  v_mfma_f32_16x16x32_bf16 v[68:71], v[44:47], v[160:163], v[68:71]
  v_mul_f32 v100, v12, v100
  v_mul_f32 v101, v12, v101
  v_mfma_f32_16x16x32_bf16 v[76:79], v[44:47], v[192:195], v[76:79]
  v_mul_f32 v102, v12, v102
  v_mfma_f32_16x16x32_bf16 v[84:87], v[44:47], v[224:227], v[84:87]
  s_waitcnt lgkmcnt(5)
  v_mul_f32 v103, v12, v103
  v_mfma_f32_16x16x32_bf16 v[56:59], v[48:51], v[132:135], v[56:59]
  ds_read_b128 v[40:43], v254 offset:33024
  v_cvt_pk_bf16_f32 v96, v96, v97
  v_mfma_f32_16x16x32_bf16 v[64:67], v[48:51], v[164:167], v[64:67]
  v_cvt_pk_bf16_f32 v97, v98, v99
  v_cvt_pk_bf16_f32 v98, v100, v101
  v_mfma_f32_16x16x32_bf16 v[72:75], v[48:51], v[196:199], v[72:75]
  s_add_u32 m0, s29, 150528
  s_add_u32 s27, s28, 2408448
  buffer_load_dwordx4 v15, s[60:63], s27 offen lds
  v_mfma_f32_16x16x32_bf16 v[80:83], v[48:51], v[228:231], v[80:83]
  s_waitcnt lgkmcnt(5)
  v_cvt_pk_bf16_f32 v99, v102, v103
  v_mfma_f32_16x16x32_bf16 v[60:63], v[52:55], v[132:135], v[60:63]
  ds_read_b128 v[44:47], v254 offset:35072
  v_accvgpr_write_b32 a76, v96
  v_mfma_f32_16x16x32_bf16 v[68:71], v[52:55], v[164:167], v[68:71]
  v_accvgpr_write_b32 a77, v97
  v_accvgpr_write_b32 a78, v98
  v_mfma_f32_16x16x32_bf16 v[76:79], v[52:55], v[196:199], v[76:79]
  v_accvgpr_write_b32 a79, v99
  v_mfma_f32_16x16x32_bf16 v[84:87], v[52:55], v[228:231], v[84:87]
  s_waitcnt lgkmcnt(5)
  v_mul_f32 v104, v12, v104
  v_mfma_f32_16x16x32_bf16 v[56:59], v[24:27], v[136:139], v[56:59]
  ds_read_b128 v[48:51], v255 offset:33024
  v_mul_f32 v105, v12, v105
  v_mfma_f32_16x16x32_bf16 v[64:67], v[24:27], v[168:171], v[64:67]
  v_mul_f32 v106, v12, v106
  v_mul_f32 v107, v12, v107
  v_mfma_f32_16x16x32_bf16 v[72:75], v[24:27], v[200:203], v[72:75]
  v_mul_f32 v108, v12, v108
  v_mfma_f32_16x16x32_bf16 v[80:83], v[24:27], v[232:235], v[80:83]
  s_waitcnt lgkmcnt(5)
  v_mul_f32 v109, v12, v109
  v_mfma_f32_16x16x32_bf16 v[60:63], v[28:31], v[136:139], v[60:63]
  ds_read_b128 v[52:55], v255 offset:35072
  v_mul_f32 v110, v12, v110
  v_mfma_f32_16x16x32_bf16 v[68:71], v[28:31], v[168:171], v[68:71]
  v_mul_f32 v111, v12, v111
  v_cvt_pk_bf16_f32 v104, v104, v105
  v_mfma_f32_16x16x32_bf16 v[76:79], v[28:31], v[200:203], v[76:79]
  v_cvt_pk_bf16_f32 v105, v106, v107
  v_mfma_f32_16x16x32_bf16 v[84:87], v[28:31], v[232:235], v[84:87]
  s_waitcnt lgkmcnt(5)
  v_cvt_pk_bf16_f32 v106, v108, v109
  v_mfma_f32_16x16x32_bf16 v[56:59], v[32:35], v[140:143], v[56:59]
  s_waitcnt vmcnt(8)
  s_barrier
  ds_read_b128 v[24:27], v252 offset:49152
  v_cvt_pk_bf16_f32 v107, v110, v111
  v_mfma_f32_16x16x32_bf16 v[64:67], v[32:35], v[172:175], v[64:67]
  v_accvgpr_write_b32 a132, v104
  v_accvgpr_write_b32 a133, v105
  v_mfma_f32_16x16x32_bf16 v[72:75], v[32:35], v[204:207], v[72:75]
  v_accvgpr_write_b32 a134, v106
  v_mfma_f32_16x16x32_bf16 v[80:83], v[32:35], v[236:239], v[80:83]
  s_waitcnt lgkmcnt(5)
  v_accvgpr_write_b32 a135, v107
  v_mfma_f32_16x16x32_bf16 v[60:63], v[36:39], v[140:143], v[60:63]
  ds_read_b128 v[28:31], v252 offset:51200
  v_mul_f32 v112, v12, v112
  v_mfma_f32_16x16x32_bf16 v[68:71], v[36:39], v[172:175], v[68:71]
  v_mul_f32 v113, v12, v113
  v_mul_f32 v114, v12, v114
  v_mfma_f32_16x16x32_bf16 v[76:79], v[36:39], v[204:207], v[76:79]
  v_mul_f32 v115, v12, v115
  v_mfma_f32_16x16x32_bf16 v[84:87], v[36:39], v[236:239], v[84:87]
  s_waitcnt lgkmcnt(5)
  v_mul_f32 v116, v12, v116
  v_mfma_f32_16x16x32_bf16 v[56:59], v[40:43], v[144:147], v[56:59]
  ds_read_b128 v[32:35], v253 offset:49152
  v_mul_f32 v117, v12, v117
  v_mfma_f32_16x16x32_bf16 v[64:67], v[40:43], v[176:179], v[64:67]
  v_mul_f32 v118, v12, v118
  v_mul_f32 v119, v12, v119
  v_mfma_f32_16x16x32_bf16 v[72:75], v[40:43], v[208:211], v[72:75]
  v_cvt_pk_bf16_f32 v112, v112, v113
  v_mfma_f32_16x16x32_bf16 v[80:83], v[40:43], v[240:243], v[80:83]
  s_waitcnt lgkmcnt(5)
  v_cvt_pk_bf16_f32 v113, v114, v115
  v_mfma_f32_16x16x32_bf16 v[60:63], v[44:47], v[144:147], v[60:63]
  ds_read_b128 v[36:39], v253 offset:51200
  v_cvt_pk_bf16_f32 v114, v116, v117
  v_mfma_f32_16x16x32_bf16 v[68:71], v[44:47], v[176:179], v[68:71]
  v_cvt_pk_bf16_f32 v115, v118, v119
  v_accvgpr_write_b32 a188, v112
  v_mfma_f32_16x16x32_bf16 v[76:79], v[44:47], v[208:211], v[76:79]
  v_accvgpr_write_b32 a189, v113
  v_mfma_f32_16x16x32_bf16 v[84:87], v[44:47], v[240:243], v[84:87]
  s_waitcnt lgkmcnt(5)
  v_accvgpr_write_b32 a190, v114
  v_mfma_f32_16x16x32_bf16 v[56:59], v[48:51], v[148:151], v[56:59]
  ds_read_b128 v[40:43], v254 offset:49152
  v_accvgpr_write_b32 a191, v115
  v_mfma_f32_16x16x32_bf16 v[64:67], v[48:51], v[180:183], v[64:67]
  v_mfma_f32_16x16x32_bf16 v[72:75], v[48:51], v[212:215], v[72:75]
  v_mfma_f32_16x16x32_bf16 v[80:83], v[48:51], v[244:247], v[80:83]
  s_waitcnt lgkmcnt(5)
  v_mfma_f32_16x16x32_bf16 v[60:63], v[52:55], v[148:151], v[60:63]
  ds_read_b128 v[44:47], v254 offset:51200
  v_mfma_f32_16x16x32_bf16 v[68:71], v[52:55], v[180:183], v[68:71]
  v_mfma_f32_16x16x32_bf16 v[76:79], v[52:55], v[212:215], v[76:79]
  v_mfma_f32_16x16x32_bf16 v[84:87], v[52:55], v[244:247], v[84:87]
  s_waitcnt lgkmcnt(5)
  v_mfma_f32_16x16x32_bf16 v[88:91], v[24:27], v[120:123], 0
  ds_read_b128 v[48:51], v255 offset:49152
  v_mfma_f32_16x16x32_bf16 v[96:99], v[24:27], v[152:155], 0
  v_mfma_f32_16x16x32_bf16 v[104:107], v[24:27], v[184:187], 0
  s_add_u32 m0, s29, 0
  s_add_u32 s27, s28, 2621440
  buffer_load_dwordx4 v14, s[60:63], s27 offen lds
  v_mfma_f32_16x16x32_bf16 v[112:115], v[24:27], v[216:219], 0
  s_waitcnt lgkmcnt(5)
  v_mul_f32 v56, v12, v56
  v_mfma_f32_16x16x32_bf16 v[92:95], v[28:31], v[120:123], 0
  ds_read_b128 v[52:55], v255 offset:51200
  v_mul_f32 v57, v12, v57
  v_mfma_f32_16x16x32_bf16 v[100:103], v[28:31], v[152:155], 0
  v_mul_f32 v58, v12, v58
  v_mul_f32 v59, v12, v59
  v_mfma_f32_16x16x32_bf16 v[108:111], v[28:31], v[184:187], 0
  v_mul_f32 v60, v12, v60
  v_mfma_f32_16x16x32_bf16 v[116:119], v[28:31], v[216:219], 0
  s_waitcnt lgkmcnt(5)
  v_mul_f32 v61, v12, v61
  v_mfma_f32_16x16x32_bf16 v[88:91], v[32:35], v[124:127], v[88:91]
  ds_read_b128 v[24:27], v252 offset:49408
  v_mul_f32 v62, v12, v62
  v_mfma_f32_16x16x32_bf16 v[96:99], v[32:35], v[156:159], v[96:99]
  v_mul_f32 v63, v12, v63
  v_cvt_pk_bf16_f32 v56, v56, v57
  v_mfma_f32_16x16x32_bf16 v[104:107], v[32:35], v[188:191], v[104:107]
  s_add_u32 m0, s29, 1024
  s_add_u32 s27, s28, 2637824
  buffer_load_dwordx4 v15, s[60:63], s27 offen lds
  v_mfma_f32_16x16x32_bf16 v[112:115], v[32:35], v[220:223], v[112:115]
  s_waitcnt lgkmcnt(5)
  v_cvt_pk_bf16_f32 v57, v58, v59
  v_mfma_f32_16x16x32_bf16 v[92:95], v[36:39], v[124:127], v[92:95]
  ds_read_b128 v[28:31], v252 offset:51456
  v_cvt_pk_bf16_f32 v58, v60, v61
  v_mfma_f32_16x16x32_bf16 v[100:103], v[36:39], v[156:159], v[100:103]
  v_cvt_pk_bf16_f32 v59, v62, v63
  v_accvgpr_write_b32 a24, v56
  v_mfma_f32_16x16x32_bf16 v[108:111], v[36:39], v[188:191], v[108:111]
  v_accvgpr_write_b32 a25, v57
  v_mfma_f32_16x16x32_bf16 v[116:119], v[36:39], v[220:223], v[116:119]
  s_waitcnt lgkmcnt(5)
  v_accvgpr_write_b32 a26, v58
  v_mfma_f32_16x16x32_bf16 v[88:91], v[40:43], v[128:131], v[88:91]
  ds_read_b128 v[32:35], v253 offset:49408
  v_accvgpr_write_b32 a27, v59
  v_mfma_f32_16x16x32_bf16 v[96:99], v[40:43], v[160:163], v[96:99]
  v_mul_f32 v64, v12, v64
  v_mul_f32 v65, v12, v65
  v_mfma_f32_16x16x32_bf16 v[104:107], v[40:43], v[192:195], v[104:107]
  s_add_u32 m0, s29, 2048
  s_add_u32 s27, s28, 2654208
  buffer_load_dwordx4 v14, s[60:63], s27 offen lds
  v_mfma_f32_16x16x32_bf16 v[112:115], v[40:43], v[224:227], v[112:115]
  s_waitcnt lgkmcnt(5)
  v_mul_f32 v66, v12, v66
  v_mfma_f32_16x16x32_bf16 v[92:95], v[44:47], v[128:131], v[92:95]
  ds_read_b128 v[36:39], v253 offset:51456
  v_mul_f32 v67, v12, v67
  v_mfma_f32_16x16x32_bf16 v[100:103], v[44:47], v[160:163], v[100:103]
  v_mul_f32 v68, v12, v68
  v_mul_f32 v69, v12, v69
  v_mfma_f32_16x16x32_bf16 v[108:111], v[44:47], v[192:195], v[108:111]
  v_mul_f32 v70, v12, v70
  v_mfma_f32_16x16x32_bf16 v[116:119], v[44:47], v[224:227], v[116:119]
  s_waitcnt lgkmcnt(5)
  v_mul_f32 v71, v12, v71
  v_mfma_f32_16x16x32_bf16 v[88:91], v[48:51], v[132:135], v[88:91]
  ds_read_b128 v[40:43], v254 offset:49408
  v_cvt_pk_bf16_f32 v64, v64, v65
  v_mfma_f32_16x16x32_bf16 v[96:99], v[48:51], v[164:167], v[96:99]
  v_cvt_pk_bf16_f32 v65, v66, v67
  v_cvt_pk_bf16_f32 v66, v68, v69
  v_mfma_f32_16x16x32_bf16 v[104:107], v[48:51], v[196:199], v[104:107]
  s_add_u32 m0, s29, 3072
  s_add_u32 s27, s28, 2670592
  buffer_load_dwordx4 v15, s[60:63], s27 offen lds
  v_mfma_f32_16x16x32_bf16 v[112:115], v[48:51], v[228:231], v[112:115]
  s_waitcnt lgkmcnt(5)
  v_cvt_pk_bf16_f32 v67, v70, v71
  v_mfma_f32_16x16x32_bf16 v[92:95], v[52:55], v[132:135], v[92:95]
  ds_read_b128 v[44:47], v254 offset:51456
  v_accvgpr_write_b32 a80, v64
  v_mfma_f32_16x16x32_bf16 v[100:103], v[52:55], v[164:167], v[100:103]
  v_accvgpr_write_b32 a81, v65
  v_accvgpr_write_b32 a82, v66
  v_mfma_f32_16x16x32_bf16 v[108:111], v[52:55], v[196:199], v[108:111]
  v_accvgpr_write_b32 a83, v67
  v_mfma_f32_16x16x32_bf16 v[116:119], v[52:55], v[228:231], v[116:119]
  s_waitcnt lgkmcnt(5)
  v_mul_f32 v72, v12, v72
  v_mfma_f32_16x16x32_bf16 v[88:91], v[24:27], v[136:139], v[88:91]
  ds_read_b128 v[48:51], v255 offset:49408
  v_mul_f32 v73, v12, v73
  v_mfma_f32_16x16x32_bf16 v[96:99], v[24:27], v[168:171], v[96:99]
  v_mul_f32 v74, v12, v74
  v_mul_f32 v75, v12, v75
  v_mfma_f32_16x16x32_bf16 v[104:107], v[24:27], v[200:203], v[104:107]
  v_mul_f32 v76, v12, v76
  v_mfma_f32_16x16x32_bf16 v[112:115], v[24:27], v[232:235], v[112:115]
  s_waitcnt lgkmcnt(5)
  v_mul_f32 v77, v12, v77
  v_mfma_f32_16x16x32_bf16 v[92:95], v[28:31], v[136:139], v[92:95]
  ds_read_b128 v[52:55], v255 offset:51456
  v_mul_f32 v78, v12, v78
  v_mfma_f32_16x16x32_bf16 v[100:103], v[28:31], v[168:171], v[100:103]
  v_mul_f32 v79, v12, v79
  v_cvt_pk_bf16_f32 v72, v72, v73
  v_mfma_f32_16x16x32_bf16 v[108:111], v[28:31], v[200:203], v[108:111]
  v_cvt_pk_bf16_f32 v73, v74, v75
  v_mfma_f32_16x16x32_bf16 v[116:119], v[28:31], v[232:235], v[116:119]
  s_waitcnt lgkmcnt(5)
  v_cvt_pk_bf16_f32 v74, v76, v77
  v_mfma_f32_16x16x32_bf16 v[88:91], v[32:35], v[140:143], v[88:91]
  s_waitcnt vmcnt(8)
  s_barrier
  ds_read_b128 v[24:27], v16 offset:0
  v_cvt_pk_bf16_f32 v75, v78, v79
  v_mfma_f32_16x16x32_bf16 v[96:99], v[32:35], v[172:175], v[96:99]
  v_accvgpr_write_b32 a136, v72
  v_accvgpr_write_b32 a137, v73
  v_mfma_f32_16x16x32_bf16 v[104:107], v[32:35], v[204:207], v[104:107]
  v_accvgpr_write_b32 a138, v74
  v_mfma_f32_16x16x32_bf16 v[112:115], v[32:35], v[236:239], v[112:115]
  s_waitcnt lgkmcnt(5)
  v_accvgpr_write_b32 a139, v75
  v_mfma_f32_16x16x32_bf16 v[92:95], v[36:39], v[140:143], v[92:95]
  ds_read_b128 v[28:31], v16 offset:2048
  v_mul_f32 v80, v12, v80
  v_mfma_f32_16x16x32_bf16 v[100:103], v[36:39], v[172:175], v[100:103]
  v_mul_f32 v81, v12, v81
  v_mul_f32 v82, v12, v82
  v_mfma_f32_16x16x32_bf16 v[108:111], v[36:39], v[204:207], v[108:111]
  v_mul_f32 v83, v12, v83
  v_mfma_f32_16x16x32_bf16 v[116:119], v[36:39], v[236:239], v[116:119]
  s_waitcnt lgkmcnt(5)
  v_mul_f32 v84, v12, v84
  v_mfma_f32_16x16x32_bf16 v[88:91], v[40:43], v[144:147], v[88:91]
  ds_read_b128 v[32:35], v17 offset:0
  v_mul_f32 v85, v12, v85
  v_mfma_f32_16x16x32_bf16 v[96:99], v[40:43], v[176:179], v[96:99]
  v_mul_f32 v86, v12, v86
  v_mul_f32 v87, v12, v87
  v_mfma_f32_16x16x32_bf16 v[104:107], v[40:43], v[208:211], v[104:107]
  v_cvt_pk_bf16_f32 v80, v80, v81
  v_mfma_f32_16x16x32_bf16 v[112:115], v[40:43], v[240:243], v[112:115]
  s_waitcnt lgkmcnt(5)
  v_cvt_pk_bf16_f32 v81, v82, v83
  v_mfma_f32_16x16x32_bf16 v[92:95], v[44:47], v[144:147], v[92:95]
  ds_read_b128 v[36:39], v17 offset:2048
  v_cvt_pk_bf16_f32 v82, v84, v85
  v_mfma_f32_16x16x32_bf16 v[100:103], v[44:47], v[176:179], v[100:103]
  v_cvt_pk_bf16_f32 v83, v86, v87
  v_accvgpr_write_b32 a192, v80
  v_mfma_f32_16x16x32_bf16 v[108:111], v[44:47], v[208:211], v[108:111]
  v_accvgpr_write_b32 a193, v81
  v_mfma_f32_16x16x32_bf16 v[116:119], v[44:47], v[240:243], v[116:119]
  s_waitcnt lgkmcnt(5)
  v_accvgpr_write_b32 a194, v82
  v_mfma_f32_16x16x32_bf16 v[88:91], v[48:51], v[148:151], v[88:91]
  ds_read_b128 v[40:43], v18 offset:0
  v_accvgpr_write_b32 a195, v83
  v_mfma_f32_16x16x32_bf16 v[96:99], v[48:51], v[180:183], v[96:99]
  v_mfma_f32_16x16x32_bf16 v[104:107], v[48:51], v[212:215], v[104:107]
  v_mfma_f32_16x16x32_bf16 v[112:115], v[48:51], v[244:247], v[112:115]
  s_waitcnt lgkmcnt(5)
  v_mfma_f32_16x16x32_bf16 v[92:95], v[52:55], v[148:151], v[92:95]
  ds_read_b128 v[44:47], v18 offset:2048
  v_mfma_f32_16x16x32_bf16 v[100:103], v[52:55], v[180:183], v[100:103]
  v_mfma_f32_16x16x32_bf16 v[108:111], v[52:55], v[212:215], v[108:111]
  v_mfma_f32_16x16x32_bf16 v[116:119], v[52:55], v[244:247], v[116:119]
  s_waitcnt lgkmcnt(5)
  v_mfma_f32_16x16x32_bf16 v[56:59], v[24:27], v[120:123], 0
  ds_read_b128 v[48:51], v19 offset:0
  v_mfma_f32_16x16x32_bf16 v[64:67], v[24:27], v[152:155], 0
  v_mfma_f32_16x16x32_bf16 v[72:75], v[24:27], v[184:187], 0
  s_add_u32 m0, s29, 16384
  s_add_u32 s27, s28, 2883584
  buffer_load_dwordx4 v14, s[60:63], s27 offen lds
  v_mfma_f32_16x16x32_bf16 v[80:83], v[24:27], v[216:219], 0
  s_waitcnt lgkmcnt(5)
  v_mul_f32 v88, v12, v88
  v_mfma_f32_16x16x32_bf16 v[60:63], v[28:31], v[120:123], 0
  ds_read_b128 v[52:55], v19 offset:2048
  v_mul_f32 v89, v12, v89
  v_mfma_f32_16x16x32_bf16 v[68:71], v[28:31], v[152:155], 0
  v_mul_f32 v90, v12, v90
  v_mul_f32 v91, v12, v91
  v_mfma_f32_16x16x32_bf16 v[76:79], v[28:31], v[184:187], 0
  v_mul_f32 v92, v12, v92
  v_mfma_f32_16x16x32_bf16 v[84:87], v[28:31], v[216:219], 0
  s_waitcnt lgkmcnt(5)
  v_mul_f32 v93, v12, v93
  v_mfma_f32_16x16x32_bf16 v[56:59], v[32:35], v[124:127], v[56:59]
  ds_read_b128 v[24:27], v16 offset:256
  v_mul_f32 v94, v12, v94
  v_mfma_f32_16x16x32_bf16 v[64:67], v[32:35], v[156:159], v[64:67]
  v_mul_f32 v95, v12, v95
  v_cvt_pk_bf16_f32 v88, v88, v89
  v_mfma_f32_16x16x32_bf16 v[72:75], v[32:35], v[188:191], v[72:75]
  s_add_u32 m0, s29, 17408
  s_add_u32 s27, s28, 2899968
  buffer_load_dwordx4 v15, s[60:63], s27 offen lds
  v_mfma_f32_16x16x32_bf16 v[80:83], v[32:35], v[220:223], v[80:83]
  s_waitcnt lgkmcnt(5)
  v_cvt_pk_bf16_f32 v89, v90, v91
  v_mfma_f32_16x16x32_bf16 v[60:63], v[36:39], v[124:127], v[60:63]
  ds_read_b128 v[28:31], v16 offset:2304
  v_cvt_pk_bf16_f32 v90, v92, v93
  v_mfma_f32_16x16x32_bf16 v[68:71], v[36:39], v[156:159], v[68:71]
  v_cvt_pk_bf16_f32 v91, v94, v95
  v_accvgpr_write_b32 a28, v88
  v_mfma_f32_16x16x32_bf16 v[76:79], v[36:39], v[188:191], v[76:79]
  v_accvgpr_write_b32 a29, v89
  v_mfma_f32_16x16x32_bf16 v[84:87], v[36:39], v[220:223], v[84:87]
  s_waitcnt lgkmcnt(5)
  v_accvgpr_write_b32 a30, v90
  v_mfma_f32_16x16x32_bf16 v[56:59], v[40:43], v[128:131], v[56:59]
  ds_read_b128 v[32:35], v17 offset:256
  v_accvgpr_write_b32 a31, v91
  v_mfma_f32_16x16x32_bf16 v[64:67], v[40:43], v[160:163], v[64:67]
  v_mul_f32 v96, v12, v96
  v_mul_f32 v97, v12, v97
  v_mfma_f32_16x16x32_bf16 v[72:75], v[40:43], v[192:195], v[72:75]
  s_add_u32 m0, s29, 18432
  s_add_u32 s27, s28, 2916352
  buffer_load_dwordx4 v14, s[60:63], s27 offen lds
  v_mfma_f32_16x16x32_bf16 v[80:83], v[40:43], v[224:227], v[80:83]
  s_waitcnt lgkmcnt(5)
  v_mul_f32 v98, v12, v98
  v_mfma_f32_16x16x32_bf16 v[60:63], v[44:47], v[128:131], v[60:63]
  ds_read_b128 v[36:39], v17 offset:2304
  v_mul_f32 v99, v12, v99
  v_mfma_f32_16x16x32_bf16 v[68:71], v[44:47], v[160:163], v[68:71]
  v_mul_f32 v100, v12, v100
  v_mul_f32 v101, v12, v101
  v_mfma_f32_16x16x32_bf16 v[76:79], v[44:47], v[192:195], v[76:79]
  v_mul_f32 v102, v12, v102
  v_mfma_f32_16x16x32_bf16 v[84:87], v[44:47], v[224:227], v[84:87]
  s_waitcnt lgkmcnt(5)
  v_mul_f32 v103, v12, v103
  v_mfma_f32_16x16x32_bf16 v[56:59], v[48:51], v[132:135], v[56:59]
  ds_read_b128 v[40:43], v18 offset:256
  v_cvt_pk_bf16_f32 v96, v96, v97
  v_mfma_f32_16x16x32_bf16 v[64:67], v[48:51], v[164:167], v[64:67]
  v_cvt_pk_bf16_f32 v97, v98, v99
  v_cvt_pk_bf16_f32 v98, v100, v101
  v_mfma_f32_16x16x32_bf16 v[72:75], v[48:51], v[196:199], v[72:75]
  s_add_u32 m0, s29, 19456
  s_add_u32 s27, s28, 2932736
  buffer_load_dwordx4 v15, s[60:63], s27 offen lds
  v_mfma_f32_16x16x32_bf16 v[80:83], v[48:51], v[228:231], v[80:83]
  s_waitcnt lgkmcnt(5)
  v_cvt_pk_bf16_f32 v99, v102, v103
  v_mfma_f32_16x16x32_bf16 v[60:63], v[52:55], v[132:135], v[60:63]
  ds_read_b128 v[44:47], v18 offset:2304
  v_accvgpr_write_b32 a84, v96
  v_mfma_f32_16x16x32_bf16 v[68:71], v[52:55], v[164:167], v[68:71]
  v_accvgpr_write_b32 a85, v97
  v_accvgpr_write_b32 a86, v98
  v_mfma_f32_16x16x32_bf16 v[76:79], v[52:55], v[196:199], v[76:79]
  v_accvgpr_write_b32 a87, v99
  v_mfma_f32_16x16x32_bf16 v[84:87], v[52:55], v[228:231], v[84:87]
  s_waitcnt lgkmcnt(5)
  v_mul_f32 v104, v12, v104
  v_mfma_f32_16x16x32_bf16 v[56:59], v[24:27], v[136:139], v[56:59]
  ds_read_b128 v[48:51], v19 offset:256
  v_mul_f32 v105, v12, v105
  v_mfma_f32_16x16x32_bf16 v[64:67], v[24:27], v[168:171], v[64:67]
  v_mul_f32 v106, v12, v106
  v_mul_f32 v107, v12, v107
  v_mfma_f32_16x16x32_bf16 v[72:75], v[24:27], v[200:203], v[72:75]
  v_mul_f32 v108, v12, v108
  v_mfma_f32_16x16x32_bf16 v[80:83], v[24:27], v[232:235], v[80:83]
  s_waitcnt lgkmcnt(5)
  v_mul_f32 v109, v12, v109
  v_mfma_f32_16x16x32_bf16 v[60:63], v[28:31], v[136:139], v[60:63]
  ds_read_b128 v[52:55], v19 offset:2304
  v_mul_f32 v110, v12, v110
  v_mfma_f32_16x16x32_bf16 v[68:71], v[28:31], v[168:171], v[68:71]
  v_mul_f32 v111, v12, v111
  v_cvt_pk_bf16_f32 v104, v104, v105
  v_mfma_f32_16x16x32_bf16 v[76:79], v[28:31], v[200:203], v[76:79]
  v_cvt_pk_bf16_f32 v105, v106, v107
  v_mfma_f32_16x16x32_bf16 v[84:87], v[28:31], v[232:235], v[84:87]
  s_waitcnt lgkmcnt(5)
  v_cvt_pk_bf16_f32 v106, v108, v109
  v_mfma_f32_16x16x32_bf16 v[56:59], v[32:35], v[140:143], v[56:59]
  s_waitcnt vmcnt(8)
  s_barrier
  ds_read_b128 v[24:27], v16 offset:16384
  v_cvt_pk_bf16_f32 v107, v110, v111
  v_mfma_f32_16x16x32_bf16 v[64:67], v[32:35], v[172:175], v[64:67]
  v_accvgpr_write_b32 a140, v104
  v_accvgpr_write_b32 a141, v105
  v_mfma_f32_16x16x32_bf16 v[72:75], v[32:35], v[204:207], v[72:75]
  v_accvgpr_write_b32 a142, v106
  v_mfma_f32_16x16x32_bf16 v[80:83], v[32:35], v[236:239], v[80:83]
  s_waitcnt lgkmcnt(5)
  v_accvgpr_write_b32 a143, v107
  v_mfma_f32_16x16x32_bf16 v[60:63], v[36:39], v[140:143], v[60:63]
  ds_read_b128 v[28:31], v16 offset:18432
  v_mul_f32 v112, v12, v112
  v_mfma_f32_16x16x32_bf16 v[68:71], v[36:39], v[172:175], v[68:71]
  v_mul_f32 v113, v12, v113
  v_mul_f32 v114, v12, v114
  v_mfma_f32_16x16x32_bf16 v[76:79], v[36:39], v[204:207], v[76:79]
  v_mul_f32 v115, v12, v115
  v_mfma_f32_16x16x32_bf16 v[84:87], v[36:39], v[236:239], v[84:87]
  s_waitcnt lgkmcnt(5)
  v_mul_f32 v116, v12, v116
  v_mfma_f32_16x16x32_bf16 v[56:59], v[40:43], v[144:147], v[56:59]
  ds_read_b128 v[32:35], v17 offset:16384
  v_mul_f32 v117, v12, v117
  v_mfma_f32_16x16x32_bf16 v[64:67], v[40:43], v[176:179], v[64:67]
  v_mul_f32 v118, v12, v118
  v_mul_f32 v119, v12, v119
  v_mfma_f32_16x16x32_bf16 v[72:75], v[40:43], v[208:211], v[72:75]
  v_cvt_pk_bf16_f32 v112, v112, v113
  v_mfma_f32_16x16x32_bf16 v[80:83], v[40:43], v[240:243], v[80:83]
  s_waitcnt lgkmcnt(5)
  v_cvt_pk_bf16_f32 v113, v114, v115
  v_mfma_f32_16x16x32_bf16 v[60:63], v[44:47], v[144:147], v[60:63]
  ds_read_b128 v[36:39], v17 offset:18432
  v_cvt_pk_bf16_f32 v114, v116, v117
  v_mfma_f32_16x16x32_bf16 v[68:71], v[44:47], v[176:179], v[68:71]
  v_cvt_pk_bf16_f32 v115, v118, v119
  v_accvgpr_write_b32 a196, v112
  v_mfma_f32_16x16x32_bf16 v[76:79], v[44:47], v[208:211], v[76:79]
  v_accvgpr_write_b32 a197, v113
  v_mfma_f32_16x16x32_bf16 v[84:87], v[44:47], v[240:243], v[84:87]
  s_waitcnt lgkmcnt(5)
  v_accvgpr_write_b32 a198, v114
  v_mfma_f32_16x16x32_bf16 v[56:59], v[48:51], v[148:151], v[56:59]
  ds_read_b128 v[40:43], v18 offset:16384
  v_accvgpr_write_b32 a199, v115
  v_mfma_f32_16x16x32_bf16 v[64:67], v[48:51], v[180:183], v[64:67]
  v_mfma_f32_16x16x32_bf16 v[72:75], v[48:51], v[212:215], v[72:75]
  v_mfma_f32_16x16x32_bf16 v[80:83], v[48:51], v[244:247], v[80:83]
  s_waitcnt lgkmcnt(5)
  v_mfma_f32_16x16x32_bf16 v[60:63], v[52:55], v[148:151], v[60:63]
  ds_read_b128 v[44:47], v18 offset:18432
  v_mfma_f32_16x16x32_bf16 v[68:71], v[52:55], v[180:183], v[68:71]
  v_mfma_f32_16x16x32_bf16 v[76:79], v[52:55], v[212:215], v[76:79]
  v_mfma_f32_16x16x32_bf16 v[84:87], v[52:55], v[244:247], v[84:87]
  s_waitcnt lgkmcnt(5)
  s_getpc_b64 s[98:99]
  s_add_u32 s98, s98, 4096
  s_addc_u32 s99, s99, 0
  global_load_dword v7, v6, s[98:99]
  v_mfma_f32_16x16x32_bf16 v[88:91], v[24:27], v[120:123], 0
  ds_read_b128 v[48:51], v19 offset:16384
  v_mfma_f32_16x16x32_bf16 v[96:99], v[24:27], v[152:155], 0
  v_mfma_f32_16x16x32_bf16 v[104:107], v[24:27], v[184:187], 0
  s_add_u32 m0, s29, 32768
  s_add_u32 s27, s28, 3145728
  buffer_load_dwordx4 v14, s[60:63], s27 offen lds
  v_mfma_f32_16x16x32_bf16 v[112:115], v[24:27], v[216:219], 0
  s_waitcnt lgkmcnt(5)
  v_mul_f32 v56, v12, v56
  v_mfma_f32_16x16x32_bf16 v[92:95], v[28:31], v[120:123], 0
  ds_read_b128 v[52:55], v19 offset:18432
  v_mul_f32 v57, v12, v57
  v_mfma_f32_16x16x32_bf16 v[100:103], v[28:31], v[152:155], 0
  v_mul_f32 v58, v12, v58
  v_mul_f32 v59, v12, v59
  v_mfma_f32_16x16x32_bf16 v[108:111], v[28:31], v[184:187], 0
  v_mul_f32 v60, v12, v60
  v_mfma_f32_16x16x32_bf16 v[116:119], v[28:31], v[216:219], 0
  s_waitcnt lgkmcnt(5)
  v_mul_f32 v61, v12, v61
  v_mfma_f32_16x16x32_bf16 v[88:91], v[32:35], v[124:127], v[88:91]
  ds_read_b128 v[24:27], v16 offset:16640
  v_mul_f32 v62, v12, v62
  v_mfma_f32_16x16x32_bf16 v[96:99], v[32:35], v[156:159], v[96:99]
  v_mul_f32 v63, v12, v63
  v_cvt_pk_bf16_f32 v56, v56, v57
  v_mfma_f32_16x16x32_bf16 v[104:107], v[32:35], v[188:191], v[104:107]
  s_add_u32 m0, s29, 33792
  s_add_u32 s27, s28, 3162112
  buffer_load_dwordx4 v15, s[60:63], s27 offen lds
  v_mfma_f32_16x16x32_bf16 v[112:115], v[32:35], v[220:223], v[112:115]
  s_waitcnt lgkmcnt(5)
  v_cvt_pk_bf16_f32 v57, v58, v59
  v_mfma_f32_16x16x32_bf16 v[92:95], v[36:39], v[124:127], v[92:95]
  ds_read_b128 v[28:31], v16 offset:18688
  v_cvt_pk_bf16_f32 v58, v60, v61
  v_mfma_f32_16x16x32_bf16 v[100:103], v[36:39], v[156:159], v[100:103]
  v_cvt_pk_bf16_f32 v59, v62, v63
  v_accvgpr_write_b32 a32, v56
  v_mfma_f32_16x16x32_bf16 v[108:111], v[36:39], v[188:191], v[108:111]
  v_accvgpr_write_b32 a33, v57
  v_mfma_f32_16x16x32_bf16 v[116:119], v[36:39], v[220:223], v[116:119]
  s_waitcnt lgkmcnt(5)
  v_accvgpr_write_b32 a34, v58
  v_mfma_f32_16x16x32_bf16 v[88:91], v[40:43], v[128:131], v[88:91]
  ds_read_b128 v[32:35], v17 offset:16640
  v_accvgpr_write_b32 a35, v59
  v_mfma_f32_16x16x32_bf16 v[96:99], v[40:43], v[160:163], v[96:99]
  v_mul_f32 v64, v12, v64
  v_mul_f32 v65, v12, v65
  v_mfma_f32_16x16x32_bf16 v[104:107], v[40:43], v[192:195], v[104:107]
  s_add_u32 m0, s29, 34816
  s_add_u32 s27, s28, 3178496
  buffer_load_dwordx4 v14, s[60:63], s27 offen lds
  v_mfma_f32_16x16x32_bf16 v[112:115], v[40:43], v[224:227], v[112:115]
  s_waitcnt lgkmcnt(5)
  v_mul_f32 v66, v12, v66
  v_mfma_f32_16x16x32_bf16 v[92:95], v[44:47], v[128:131], v[92:95]
  ds_read_b128 v[36:39], v17 offset:18688
  v_mul_f32 v67, v12, v67
  v_mfma_f32_16x16x32_bf16 v[100:103], v[44:47], v[160:163], v[100:103]
  v_mul_f32 v68, v12, v68
  v_mul_f32 v69, v12, v69
  v_mfma_f32_16x16x32_bf16 v[108:111], v[44:47], v[192:195], v[108:111]
  v_mul_f32 v70, v12, v70
  v_mfma_f32_16x16x32_bf16 v[116:119], v[44:47], v[224:227], v[116:119]
  s_waitcnt lgkmcnt(5)
  v_mul_f32 v71, v12, v71
  v_mfma_f32_16x16x32_bf16 v[88:91], v[48:51], v[132:135], v[88:91]
  ds_read_b128 v[40:43], v18 offset:16640
  v_cvt_pk_bf16_f32 v64, v64, v65
  v_mfma_f32_16x16x32_bf16 v[96:99], v[48:51], v[164:167], v[96:99]
  v_cvt_pk_bf16_f32 v65, v66, v67
  v_cvt_pk_bf16_f32 v66, v68, v69
  v_mfma_f32_16x16x32_bf16 v[104:107], v[48:51], v[196:199], v[104:107]
  s_add_u32 m0, s29, 35840
  s_add_u32 s27, s28, 3194880
  buffer_load_dwordx4 v15, s[60:63], s27 offen lds
  v_mfma_f32_16x16x32_bf16 v[112:115], v[48:51], v[228:231], v[112:115]
  s_waitcnt lgkmcnt(5)
  v_cvt_pk_bf16_f32 v67, v70, v71
  v_mfma_f32_16x16x32_bf16 v[92:95], v[52:55], v[132:135], v[92:95]
  ds_read_b128 v[44:47], v18 offset:18688
  v_accvgpr_write_b32 a88, v64
  v_mfma_f32_16x16x32_bf16 v[100:103], v[52:55], v[164:167], v[100:103]
  v_accvgpr_write_b32 a89, v65
  v_accvgpr_write_b32 a90, v66
  v_mfma_f32_16x16x32_bf16 v[108:111], v[52:55], v[196:199], v[108:111]
  v_accvgpr_write_b32 a91, v67
  v_mfma_f32_16x16x32_bf16 v[116:119], v[52:55], v[228:231], v[116:119]
  s_waitcnt lgkmcnt(5)
  v_mul_f32 v72, v12, v72
  v_mfma_f32_16x16x32_bf16 v[88:91], v[24:27], v[136:139], v[88:91]
  ds_read_b128 v[48:51], v19 offset:16640
  v_mul_f32 v73, v12, v73
  v_mfma_f32_16x16x32_bf16 v[96:99], v[24:27], v[168:171], v[96:99]
  v_mul_f32 v74, v12, v74
  v_mul_f32 v75, v12, v75
  v_mfma_f32_16x16x32_bf16 v[104:107], v[24:27], v[200:203], v[104:107]
  v_mul_f32 v76, v12, v76
  v_mfma_f32_16x16x32_bf16 v[112:115], v[24:27], v[232:235], v[112:115]
  s_waitcnt lgkmcnt(5)
  v_mul_f32 v77, v12, v77
  v_mfma_f32_16x16x32_bf16 v[92:95], v[28:31], v[136:139], v[92:95]
  ds_read_b128 v[52:55], v19 offset:18688
  v_mul_f32 v78, v12, v78
  v_mfma_f32_16x16x32_bf16 v[100:103], v[28:31], v[168:171], v[100:103]
  v_mul_f32 v79, v12, v79
  v_cvt_pk_bf16_f32 v72, v72, v73
  v_mfma_f32_16x16x32_bf16 v[108:111], v[28:31], v[200:203], v[108:111]
  v_cvt_pk_bf16_f32 v73, v74, v75
  v_mfma_f32_16x16x32_bf16 v[116:119], v[28:31], v[232:235], v[116:119]
  s_waitcnt lgkmcnt(5)
  v_cvt_pk_bf16_f32 v74, v76, v77
  v_mfma_f32_16x16x32_bf16 v[88:91], v[32:35], v[140:143], v[88:91]
  s_waitcnt vmcnt(8)
  s_barrier
  ds_read_b128 v[24:27], v248 offset:0
  v_cvt_pk_bf16_f32 v75, v78, v79
  v_mfma_f32_16x16x32_bf16 v[96:99], v[32:35], v[172:175], v[96:99]
  v_accvgpr_write_b32 a144, v72
  v_accvgpr_write_b32 a145, v73
  v_mfma_f32_16x16x32_bf16 v[104:107], v[32:35], v[204:207], v[104:107]
  v_accvgpr_write_b32 a146, v74
  v_mfma_f32_16x16x32_bf16 v[112:115], v[32:35], v[236:239], v[112:115]
  s_waitcnt lgkmcnt(5)
  v_accvgpr_write_b32 a147, v75
  v_mfma_f32_16x16x32_bf16 v[92:95], v[36:39], v[140:143], v[92:95]
  ds_read_b128 v[28:31], v248 offset:2048
  v_mul_f32 v80, v12, v80
  v_mfma_f32_16x16x32_bf16 v[100:103], v[36:39], v[172:175], v[100:103]
  v_mul_f32 v81, v12, v81
  v_mul_f32 v82, v12, v82
  v_mfma_f32_16x16x32_bf16 v[108:111], v[36:39], v[204:207], v[108:111]
  v_mul_f32 v83, v12, v83
  v_mfma_f32_16x16x32_bf16 v[116:119], v[36:39], v[236:239], v[116:119]
  s_waitcnt lgkmcnt(5)
  v_mul_f32 v84, v12, v84
  v_mfma_f32_16x16x32_bf16 v[88:91], v[40:43], v[144:147], v[88:91]
  ds_read_b128 v[32:35], v249 offset:0
  v_mul_f32 v85, v12, v85
  v_mfma_f32_16x16x32_bf16 v[96:99], v[40:43], v[176:179], v[96:99]
  v_mul_f32 v86, v12, v86
  v_mul_f32 v87, v12, v87
  v_mfma_f32_16x16x32_bf16 v[104:107], v[40:43], v[208:211], v[104:107]
  v_cvt_pk_bf16_f32 v80, v80, v81
  v_mfma_f32_16x16x32_bf16 v[112:115], v[40:43], v[240:243], v[112:115]
  s_waitcnt lgkmcnt(5)
  v_cvt_pk_bf16_f32 v81, v82, v83
  v_mfma_f32_16x16x32_bf16 v[92:95], v[44:47], v[144:147], v[92:95]
  ds_read_b128 v[36:39], v249 offset:2048
  v_cvt_pk_bf16_f32 v82, v84, v85
  v_mfma_f32_16x16x32_bf16 v[100:103], v[44:47], v[176:179], v[100:103]
  v_cvt_pk_bf16_f32 v83, v86, v87
  v_accvgpr_write_b32 a200, v80
  v_mfma_f32_16x16x32_bf16 v[108:111], v[44:47], v[208:211], v[108:111]
  v_accvgpr_write_b32 a201, v81
  v_mfma_f32_16x16x32_bf16 v[116:119], v[44:47], v[240:243], v[116:119]
  s_waitcnt lgkmcnt(5)
  v_accvgpr_write_b32 a202, v82
  v_mfma_f32_16x16x32_bf16 v[88:91], v[48:51], v[148:151], v[88:91]
  ds_read_b128 v[40:43], v250 offset:0
  v_accvgpr_write_b32 a203, v83
  v_mfma_f32_16x16x32_bf16 v[96:99], v[48:51], v[180:183], v[96:99]
  v_mfma_f32_16x16x32_bf16 v[104:107], v[48:51], v[212:215], v[104:107]
  v_mfma_f32_16x16x32_bf16 v[112:115], v[48:51], v[244:247], v[112:115]
  s_waitcnt lgkmcnt(5)
  v_mfma_f32_16x16x32_bf16 v[92:95], v[52:55], v[148:151], v[92:95]
  ds_read_b128 v[44:47], v250 offset:2048
  v_mfma_f32_16x16x32_bf16 v[100:103], v[52:55], v[180:183], v[100:103]
  v_mfma_f32_16x16x32_bf16 v[108:111], v[52:55], v[212:215], v[108:111]
  v_mfma_f32_16x16x32_bf16 v[116:119], v[52:55], v[244:247], v[116:119]
  s_waitcnt lgkmcnt(5)
  v_mfma_f32_16x16x32_bf16 v[56:59], v[24:27], v[120:123], 0
  ds_read_b128 v[48:51], v251 offset:0
  v_mfma_f32_16x16x32_bf16 v[64:67], v[24:27], v[152:155], 0
  v_mfma_f32_16x16x32_bf16 v[72:75], v[24:27], v[184:187], 0
  s_add_u32 m0, s29, 49152
  s_add_u32 s27, s28, 3407872
  buffer_load_dwordx4 v14, s[60:63], s27 offen lds
  v_mfma_f32_16x16x32_bf16 v[80:83], v[24:27], v[216:219], 0
  s_waitcnt lgkmcnt(5)
  v_mul_f32 v88, v12, v88
  v_mfma_f32_16x16x32_bf16 v[60:63], v[28:31], v[120:123], 0
  ds_read_b128 v[52:55], v251 offset:2048
  v_mul_f32 v89, v12, v89
  v_mfma_f32_16x16x32_bf16 v[68:71], v[28:31], v[152:155], 0
  v_mul_f32 v90, v12, v90
  v_mul_f32 v91, v12, v91
  v_mfma_f32_16x16x32_bf16 v[76:79], v[28:31], v[184:187], 0
  v_mul_f32 v92, v12, v92
  v_mfma_f32_16x16x32_bf16 v[84:87], v[28:31], v[216:219], 0
  s_waitcnt lgkmcnt(5)
  v_mul_f32 v93, v12, v93
  v_mfma_f32_16x16x32_bf16 v[56:59], v[32:35], v[124:127], v[56:59]
  ds_read_b128 v[24:27], v248 offset:256
  v_mul_f32 v94, v12, v94
  v_mfma_f32_16x16x32_bf16 v[64:67], v[32:35], v[156:159], v[64:67]
  v_mul_f32 v95, v12, v95
  v_cvt_pk_bf16_f32 v88, v88, v89
  v_mfma_f32_16x16x32_bf16 v[72:75], v[32:35], v[188:191], v[72:75]
  s_add_u32 m0, s29, 50176
  s_add_u32 s27, s28, 3424256
  buffer_load_dwordx4 v15, s[60:63], s27 offen lds
  v_mfma_f32_16x16x32_bf16 v[80:83], v[32:35], v[220:223], v[80:83]
  s_waitcnt lgkmcnt(5)
  v_cvt_pk_bf16_f32 v89, v90, v91
  v_mfma_f32_16x16x32_bf16 v[60:63], v[36:39], v[124:127], v[60:63]
  ds_read_b128 v[28:31], v248 offset:2304
  v_cvt_pk_bf16_f32 v90, v92, v93
  v_mfma_f32_16x16x32_bf16 v[68:71], v[36:39], v[156:159], v[68:71]
  v_cvt_pk_bf16_f32 v91, v94, v95
  v_accvgpr_write_b32 a36, v88
  v_mfma_f32_16x16x32_bf16 v[76:79], v[36:39], v[188:191], v[76:79]
  v_accvgpr_write_b32 a37, v89
  v_mfma_f32_16x16x32_bf16 v[84:87], v[36:39], v[220:223], v[84:87]
  s_waitcnt lgkmcnt(5)
  v_accvgpr_write_b32 a38, v90
  v_mfma_f32_16x16x32_bf16 v[56:59], v[40:43], v[128:131], v[56:59]
  ds_read_b128 v[32:35], v249 offset:256
  v_accvgpr_write_b32 a39, v91
  v_mfma_f32_16x16x32_bf16 v[64:67], v[40:43], v[160:163], v[64:67]
  v_mul_f32 v96, v12, v96
  v_mul_f32 v97, v12, v97
  v_mfma_f32_16x16x32_bf16 v[72:75], v[40:43], v[192:195], v[72:75]
  s_add_u32 m0, s29, 51200
  s_add_u32 s27, s28, 3440640
  buffer_load_dwordx4 v14, s[60:63], s27 offen lds
  v_mfma_f32_16x16x32_bf16 v[80:83], v[40:43], v[224:227], v[80:83]
  s_waitcnt lgkmcnt(5)
  v_mul_f32 v98, v12, v98
  v_mfma_f32_16x16x32_bf16 v[60:63], v[44:47], v[128:131], v[60:63]
  ds_read_b128 v[36:39], v249 offset:2304
  v_mul_f32 v99, v12, v99
  v_mfma_f32_16x16x32_bf16 v[68:71], v[44:47], v[160:163], v[68:71]
  v_mul_f32 v100, v12, v100
  v_mul_f32 v101, v12, v101
  v_mfma_f32_16x16x32_bf16 v[76:79], v[44:47], v[192:195], v[76:79]
  v_mul_f32 v102, v12, v102
  v_mfma_f32_16x16x32_bf16 v[84:87], v[44:47], v[224:227], v[84:87]
  s_waitcnt lgkmcnt(5)
  v_mul_f32 v103, v12, v103
  v_mfma_f32_16x16x32_bf16 v[56:59], v[48:51], v[132:135], v[56:59]
  ds_read_b128 v[40:43], v250 offset:256
  v_cvt_pk_bf16_f32 v96, v96, v97
  v_mfma_f32_16x16x32_bf16 v[64:67], v[48:51], v[164:167], v[64:67]
  v_cvt_pk_bf16_f32 v97, v98, v99
  v_cvt_pk_bf16_f32 v98, v100, v101
  v_mfma_f32_16x16x32_bf16 v[72:75], v[48:51], v[196:199], v[72:75]
  s_add_u32 m0, s29, 52224
  s_add_u32 s27, s28, 3457024
  buffer_load_dwordx4 v15, s[60:63], s27 offen lds
  v_mfma_f32_16x16x32_bf16 v[80:83], v[48:51], v[228:231], v[80:83]
  s_waitcnt lgkmcnt(5)
  v_cvt_pk_bf16_f32 v99, v102, v103
  v_mfma_f32_16x16x32_bf16 v[60:63], v[52:55], v[132:135], v[60:63]
  ds_read_b128 v[44:47], v250 offset:2304
  v_accvgpr_write_b32 a92, v96
  v_mfma_f32_16x16x32_bf16 v[68:71], v[52:55], v[164:167], v[68:71]
  v_accvgpr_write_b32 a93, v97
  v_accvgpr_write_b32 a94, v98
  v_mfma_f32_16x16x32_bf16 v[76:79], v[52:55], v[196:199], v[76:79]
  v_accvgpr_write_b32 a95, v99
  v_mfma_f32_16x16x32_bf16 v[84:87], v[52:55], v[228:231], v[84:87]
  s_waitcnt lgkmcnt(5)
  v_mul_f32 v104, v12, v104
  v_mfma_f32_16x16x32_bf16 v[56:59], v[24:27], v[136:139], v[56:59]
  ds_read_b128 v[48:51], v251 offset:256
  v_mul_f32 v105, v12, v105
  v_mfma_f32_16x16x32_bf16 v[64:67], v[24:27], v[168:171], v[64:67]
  v_mul_f32 v106, v12, v106
  v_mul_f32 v107, v12, v107
  v_mfma_f32_16x16x32_bf16 v[72:75], v[24:27], v[200:203], v[72:75]
  v_mul_f32 v108, v12, v108
  v_mfma_f32_16x16x32_bf16 v[80:83], v[24:27], v[232:235], v[80:83]
  s_waitcnt lgkmcnt(5)
  v_mul_f32 v109, v12, v109
  v_mfma_f32_16x16x32_bf16 v[60:63], v[28:31], v[136:139], v[60:63]
  ds_read_b128 v[52:55], v251 offset:2304
  v_mul_f32 v110, v12, v110
  v_mfma_f32_16x16x32_bf16 v[68:71], v[28:31], v[168:171], v[68:71]
  v_mul_f32 v111, v12, v111
  v_cvt_pk_bf16_f32 v104, v104, v105
  v_mfma_f32_16x16x32_bf16 v[76:79], v[28:31], v[200:203], v[76:79]
  v_cvt_pk_bf16_f32 v105, v106, v107
  v_mfma_f32_16x16x32_bf16 v[84:87], v[28:31], v[232:235], v[84:87]
  s_waitcnt lgkmcnt(5)
  v_cvt_pk_bf16_f32 v106, v108, v109
  v_mfma_f32_16x16x32_bf16 v[56:59], v[32:35], v[140:143], v[56:59]
  s_waitcnt vmcnt(8)
  s_barrier
  ds_read_b128 v[24:27], v248 offset:16384
  v_cvt_pk_bf16_f32 v107, v110, v111
  v_mfma_f32_16x16x32_bf16 v[64:67], v[32:35], v[172:175], v[64:67]
  v_accvgpr_write_b32 a148, v104
  v_accvgpr_write_b32 a149, v105
  v_mfma_f32_16x16x32_bf16 v[72:75], v[32:35], v[204:207], v[72:75]
  v_accvgpr_write_b32 a150, v106
  v_mfma_f32_16x16x32_bf16 v[80:83], v[32:35], v[236:239], v[80:83]
  s_waitcnt lgkmcnt(5)
  v_accvgpr_write_b32 a151, v107
  v_mfma_f32_16x16x32_bf16 v[60:63], v[36:39], v[140:143], v[60:63]
  ds_read_b128 v[28:31], v248 offset:18432
  v_mul_f32 v112, v12, v112
  v_mfma_f32_16x16x32_bf16 v[68:71], v[36:39], v[172:175], v[68:71]
  v_mul_f32 v113, v12, v113
  v_mul_f32 v114, v12, v114
  v_mfma_f32_16x16x32_bf16 v[76:79], v[36:39], v[204:207], v[76:79]
  v_mul_f32 v115, v12, v115
  v_mfma_f32_16x16x32_bf16 v[84:87], v[36:39], v[236:239], v[84:87]
  s_waitcnt lgkmcnt(5)
  v_mul_f32 v116, v12, v116
  v_mfma_f32_16x16x32_bf16 v[56:59], v[40:43], v[144:147], v[56:59]
  ds_read_b128 v[32:35], v249 offset:16384
  v_mul_f32 v117, v12, v117
  v_mfma_f32_16x16x32_bf16 v[64:67], v[40:43], v[176:179], v[64:67]
  v_mul_f32 v118, v12, v118
  v_mul_f32 v119, v12, v119
  v_mfma_f32_16x16x32_bf16 v[72:75], v[40:43], v[208:211], v[72:75]
  v_cvt_pk_bf16_f32 v112, v112, v113
  v_mfma_f32_16x16x32_bf16 v[80:83], v[40:43], v[240:243], v[80:83]
  s_waitcnt lgkmcnt(5)
  v_cvt_pk_bf16_f32 v113, v114, v115
  v_mfma_f32_16x16x32_bf16 v[60:63], v[44:47], v[144:147], v[60:63]
  ds_read_b128 v[36:39], v249 offset:18432
  v_cvt_pk_bf16_f32 v114, v116, v117
  v_mfma_f32_16x16x32_bf16 v[68:71], v[44:47], v[176:179], v[68:71]
  v_cvt_pk_bf16_f32 v115, v118, v119
  v_accvgpr_write_b32 a204, v112
  v_mfma_f32_16x16x32_bf16 v[76:79], v[44:47], v[208:211], v[76:79]
  v_accvgpr_write_b32 a205, v113
  v_mfma_f32_16x16x32_bf16 v[84:87], v[44:47], v[240:243], v[84:87]
  s_waitcnt lgkmcnt(5)
  v_accvgpr_write_b32 a206, v114
  v_mfma_f32_16x16x32_bf16 v[56:59], v[48:51], v[148:151], v[56:59]
  ds_read_b128 v[40:43], v250 offset:16384
  v_accvgpr_write_b32 a207, v115
  v_mfma_f32_16x16x32_bf16 v[64:67], v[48:51], v[180:183], v[64:67]
  v_mfma_f32_16x16x32_bf16 v[72:75], v[48:51], v[212:215], v[72:75]
  v_mfma_f32_16x16x32_bf16 v[80:83], v[48:51], v[244:247], v[80:83]
  s_waitcnt lgkmcnt(5)
  v_mfma_f32_16x16x32_bf16 v[60:63], v[52:55], v[148:151], v[60:63]
  ds_read_b128 v[44:47], v250 offset:18432
  v_mfma_f32_16x16x32_bf16 v[68:71], v[52:55], v[180:183], v[68:71]
  v_mfma_f32_16x16x32_bf16 v[76:79], v[52:55], v[212:215], v[76:79]
  v_mfma_f32_16x16x32_bf16 v[84:87], v[52:55], v[244:247], v[84:87]
  s_waitcnt lgkmcnt(5)
  v_mfma_f32_16x16x32_bf16 v[88:91], v[24:27], v[120:123], 0
  ds_read_b128 v[48:51], v251 offset:16384
  v_mfma_f32_16x16x32_bf16 v[96:99], v[24:27], v[152:155], 0
  v_mfma_f32_16x16x32_bf16 v[104:107], v[24:27], v[184:187], 0
  buffer_load_dword v13, off, s[12:15], 0 offset:132 sc1
  v_mfma_f32_16x16x32_bf16 v[112:115], v[24:27], v[216:219], 0
  s_waitcnt lgkmcnt(5)
  v_mul_f32 v56, v12, v56
  v_mfma_f32_16x16x32_bf16 v[92:95], v[28:31], v[120:123], 0
  ds_read_b128 v[52:55], v251 offset:18432
  v_mul_f32 v57, v12, v57
  v_mfma_f32_16x16x32_bf16 v[100:103], v[28:31], v[152:155], 0
  v_mul_f32 v58, v12, v58
  v_mul_f32 v59, v12, v59
  v_mfma_f32_16x16x32_bf16 v[108:111], v[28:31], v[184:187], 0
  v_mul_f32 v60, v12, v60
  v_mfma_f32_16x16x32_bf16 v[116:119], v[28:31], v[216:219], 0
  s_waitcnt lgkmcnt(5)
  v_mul_f32 v61, v12, v61
  v_mfma_f32_16x16x32_bf16 v[88:91], v[32:35], v[124:127], v[88:91]
  ds_read_b128 v[24:27], v248 offset:16640
  v_mul_f32 v62, v12, v62
  v_mfma_f32_16x16x32_bf16 v[96:99], v[32:35], v[156:159], v[96:99]
  v_mul_f32 v63, v12, v63
  v_cvt_pk_bf16_f32 v56, v56, v57
  v_mfma_f32_16x16x32_bf16 v[104:107], v[32:35], v[188:191], v[104:107]
  v_cvt_pk_bf16_f32 v57, v58, v59
  v_mfma_f32_16x16x32_bf16 v[112:115], v[32:35], v[220:223], v[112:115]
  s_waitcnt lgkmcnt(5)
  v_cvt_pk_bf16_f32 v58, v60, v61
  v_mfma_f32_16x16x32_bf16 v[92:95], v[36:39], v[124:127], v[92:95]
  ds_read_b128 v[28:31], v248 offset:18688
  v_cvt_pk_bf16_f32 v59, v62, v63
  v_mfma_f32_16x16x32_bf16 v[100:103], v[36:39], v[156:159], v[100:103]
  v_accvgpr_write_b32 a40, v56
  v_accvgpr_write_b32 a41, v57
  v_mfma_f32_16x16x32_bf16 v[108:111], v[36:39], v[188:191], v[108:111]
  v_accvgpr_write_b32 a42, v58
  v_mfma_f32_16x16x32_bf16 v[116:119], v[36:39], v[220:223], v[116:119]
  s_waitcnt lgkmcnt(5)
  v_accvgpr_write_b32 a43, v59
  v_mfma_f32_16x16x32_bf16 v[88:91], v[40:43], v[128:131], v[88:91]
  ds_read_b128 v[32:35], v249 offset:16640
  v_mul_f32 v64, v12, v64
  v_mfma_f32_16x16x32_bf16 v[96:99], v[40:43], v[160:163], v[96:99]
  v_mul_f32 v65, v12, v65
  v_mul_f32 v66, v12, v66
  v_mfma_f32_16x16x32_bf16 v[104:107], v[40:43], v[192:195], v[104:107]
  v_mul_f32 v67, v12, v67
  v_mfma_f32_16x16x32_bf16 v[112:115], v[40:43], v[224:227], v[112:115]
  s_waitcnt lgkmcnt(5)
  v_mul_f32 v68, v12, v68
  v_mfma_f32_16x16x32_bf16 v[92:95], v[44:47], v[128:131], v[92:95]
  ds_read_b128 v[36:39], v249 offset:18688
  v_mul_f32 v69, v12, v69
  v_mfma_f32_16x16x32_bf16 v[100:103], v[44:47], v[160:163], v[100:103]
  v_mul_f32 v70, v12, v70
  v_mul_f32 v71, v12, v71
  v_mfma_f32_16x16x32_bf16 v[108:111], v[44:47], v[192:195], v[108:111]
  v_cvt_pk_bf16_f32 v64, v64, v65
  v_mfma_f32_16x16x32_bf16 v[116:119], v[44:47], v[224:227], v[116:119]
  s_waitcnt lgkmcnt(5)
  v_cvt_pk_bf16_f32 v65, v66, v67
  v_mfma_f32_16x16x32_bf16 v[88:91], v[48:51], v[132:135], v[88:91]
  ds_read_b128 v[40:43], v250 offset:16640
  v_cvt_pk_bf16_f32 v66, v68, v69
  v_mfma_f32_16x16x32_bf16 v[96:99], v[48:51], v[164:167], v[96:99]
  v_cvt_pk_bf16_f32 v67, v70, v71
  v_accvgpr_write_b32 a96, v64
  v_mfma_f32_16x16x32_bf16 v[104:107], v[48:51], v[196:199], v[104:107]
  v_accvgpr_write_b32 a97, v65
  v_mfma_f32_16x16x32_bf16 v[112:115], v[48:51], v[228:231], v[112:115]
  s_waitcnt lgkmcnt(5)
  v_accvgpr_write_b32 a98, v66
  v_mfma_f32_16x16x32_bf16 v[92:95], v[52:55], v[132:135], v[92:95]
  ds_read_b128 v[44:47], v250 offset:18688
  v_accvgpr_write_b32 a99, v67
  v_mfma_f32_16x16x32_bf16 v[100:103], v[52:55], v[164:167], v[100:103]
  v_mul_f32 v72, v12, v72
  v_mul_f32 v73, v12, v73
  v_mfma_f32_16x16x32_bf16 v[108:111], v[52:55], v[196:199], v[108:111]
  v_mul_f32 v74, v12, v74
  v_mfma_f32_16x16x32_bf16 v[116:119], v[52:55], v[228:231], v[116:119]
  s_waitcnt lgkmcnt(5)
  v_mul_f32 v75, v12, v75
  v_mfma_f32_16x16x32_bf16 v[88:91], v[24:27], v[136:139], v[88:91]
  ds_read_b128 v[48:51], v251 offset:16640
  v_mul_f32 v76, v12, v76
  v_mfma_f32_16x16x32_bf16 v[96:99], v[24:27], v[168:171], v[96:99]
  v_mul_f32 v77, v12, v77
  v_mul_f32 v78, v12, v78
  v_mfma_f32_16x16x32_bf16 v[104:107], v[24:27], v[200:203], v[104:107]
  v_mul_f32 v79, v12, v79
  v_mfma_f32_16x16x32_bf16 v[112:115], v[24:27], v[232:235], v[112:115]
  s_waitcnt lgkmcnt(5)
  v_cvt_pk_bf16_f32 v72, v72, v73
  v_mfma_f32_16x16x32_bf16 v[92:95], v[28:31], v[136:139], v[92:95]
  ds_read_b128 v[52:55], v251 offset:18688
  v_cvt_pk_bf16_f32 v73, v74, v75
  v_mfma_f32_16x16x32_bf16 v[100:103], v[28:31], v[168:171], v[100:103]
  v_cvt_pk_bf16_f32 v74, v76, v77
  v_cvt_pk_bf16_f32 v75, v78, v79
  v_mfma_f32_16x16x32_bf16 v[108:111], v[28:31], v[200:203], v[108:111]
  v_accvgpr_write_b32 a152, v72
  v_mfma_f32_16x16x32_bf16 v[116:119], v[28:31], v[232:235], v[116:119]
  s_waitcnt lgkmcnt(5)
  v_accvgpr_write_b32 a153, v73
  v_mfma_f32_16x16x32_bf16 v[88:91], v[32:35], v[140:143], v[88:91]
  s_waitcnt vmcnt(5)
  s_barrier
  ds_read_b128 v[24:27], v248 offset:32768
  v_accvgpr_write_b32 a154, v74
  v_mfma_f32_16x16x32_bf16 v[96:99], v[32:35], v[172:175], v[96:99]
  v_accvgpr_write_b32 a155, v75
  v_mul_f32 v80, v12, v80
  v_mfma_f32_16x16x32_bf16 v[104:107], v[32:35], v[204:207], v[104:107]
  v_mul_f32 v81, v12, v81
  v_mfma_f32_16x16x32_bf16 v[112:115], v[32:35], v[236:239], v[112:115]
  s_waitcnt lgkmcnt(5)
  v_mul_f32 v82, v12, v82
  v_mfma_f32_16x16x32_bf16 v[92:95], v[36:39], v[140:143], v[92:95]
  ds_read_b128 v[28:31], v248 offset:34816
  v_mul_f32 v83, v12, v83
  v_mfma_f32_16x16x32_bf16 v[100:103], v[36:39], v[172:175], v[100:103]
  v_mul_f32 v84, v12, v84
  v_mul_f32 v85, v12, v85
  v_mfma_f32_16x16x32_bf16 v[108:111], v[36:39], v[204:207], v[108:111]
  v_mul_f32 v86, v12, v86
  v_mfma_f32_16x16x32_bf16 v[116:119], v[36:39], v[236:239], v[116:119]
  s_waitcnt lgkmcnt(5)
  v_mul_f32 v87, v12, v87
  v_mfma_f32_16x16x32_bf16 v[88:91], v[40:43], v[144:147], v[88:91]
  ds_read_b128 v[32:35], v249 offset:32768
  v_cvt_pk_bf16_f32 v80, v80, v81
  v_mfma_f32_16x16x32_bf16 v[96:99], v[40:43], v[176:179], v[96:99]
  v_cvt_pk_bf16_f32 v81, v82, v83
  v_cvt_pk_bf16_f32 v82, v84, v85
  v_mfma_f32_16x16x32_bf16 v[104:107], v[40:43], v[208:211], v[104:107]
  v_cvt_pk_bf16_f32 v83, v86, v87
  v_mfma_f32_16x16x32_bf16 v[112:115], v[40:43], v[240:243], v[112:115]
  s_waitcnt lgkmcnt(5)
  v_accvgpr_write_b32 a208, v80
  v_mfma_f32_16x16x32_bf16 v[92:95], v[44:47], v[144:147], v[92:95]
  ds_read_b128 v[36:39], v249 offset:34816
  v_accvgpr_write_b32 a209, v81
  v_mfma_f32_16x16x32_bf16 v[100:103], v[44:47], v[176:179], v[100:103]
  v_accvgpr_write_b32 a210, v82
  v_accvgpr_write_b32 a211, v83
  v_mfma_f32_16x16x32_bf16 v[108:111], v[44:47], v[208:211], v[108:111]
  v_mfma_f32_16x16x32_bf16 v[116:119], v[44:47], v[240:243], v[116:119]
  s_waitcnt lgkmcnt(5)
  v_mfma_f32_16x16x32_bf16 v[88:91], v[48:51], v[148:151], v[88:91]
  ds_read_b128 v[40:43], v250 offset:32768
  v_mfma_f32_16x16x32_bf16 v[96:99], v[48:51], v[180:183], v[96:99]
  v_mfma_f32_16x16x32_bf16 v[104:107], v[48:51], v[212:215], v[104:107]
  v_mfma_f32_16x16x32_bf16 v[112:115], v[48:51], v[244:247], v[112:115]
  s_waitcnt lgkmcnt(5)
  v_mfma_f32_16x16x32_bf16 v[92:95], v[52:55], v[148:151], v[92:95]
  ds_read_b128 v[44:47], v250 offset:34816
  v_mfma_f32_16x16x32_bf16 v[100:103], v[52:55], v[180:183], v[100:103]
  v_mfma_f32_16x16x32_bf16 v[108:111], v[52:55], v[212:215], v[108:111]
  v_mfma_f32_16x16x32_bf16 v[116:119], v[52:55], v[244:247], v[116:119]
  s_waitcnt lgkmcnt(5)
  s_getpc_b64 s[98:99]
  s_add_u32 s98, s98, 4096
  s_addc_u32 s99, s99, 0
  global_load_dword v7, v6, s[98:99]
  v_mfma_f32_16x16x32_bf16 v[56:59], v[24:27], v[120:123], 0
  ds_read_b128 v[48:51], v251 offset:32768
  v_mfma_f32_16x16x32_bf16 v[64:67], v[24:27], v[152:155], 0
  v_mfma_f32_16x16x32_bf16 v[72:75], v[24:27], v[184:187], 0
  v_mfma_f32_16x16x32_bf16 v[80:83], v[24:27], v[216:219], 0
  s_waitcnt lgkmcnt(5)
  v_mul_f32 v88, v12, v88
  v_mfma_f32_16x16x32_bf16 v[60:63], v[28:31], v[120:123], 0
  ds_read_b128 v[52:55], v251 offset:34816
  v_mul_f32 v89, v12, v89
  v_mfma_f32_16x16x32_bf16 v[68:71], v[28:31], v[152:155], 0
  v_mul_f32 v90, v12, v90
  v_mul_f32 v91, v12, v91
  v_mfma_f32_16x16x32_bf16 v[76:79], v[28:31], v[184:187], 0
  v_mul_f32 v92, v12, v92
  v_mfma_f32_16x16x32_bf16 v[84:87], v[28:31], v[216:219], 0
  s_waitcnt lgkmcnt(5)
  v_mul_f32 v93, v12, v93
  v_mfma_f32_16x16x32_bf16 v[56:59], v[32:35], v[124:127], v[56:59]
  ds_read_b128 v[24:27], v248 offset:33024
  v_mul_f32 v94, v12, v94
  v_mfma_f32_16x16x32_bf16 v[64:67], v[32:35], v[156:159], v[64:67]
  v_mul_f32 v95, v12, v95
  v_cvt_pk_bf16_f32 v88, v88, v89
  v_mfma_f32_16x16x32_bf16 v[72:75], v[32:35], v[188:191], v[72:75]
  v_cvt_pk_bf16_f32 v89, v90, v91
  v_mfma_f32_16x16x32_bf16 v[80:83], v[32:35], v[220:223], v[80:83]
  s_waitcnt lgkmcnt(5)
  v_cvt_pk_bf16_f32 v90, v92, v93
  v_mfma_f32_16x16x32_bf16 v[60:63], v[36:39], v[124:127], v[60:63]
  ds_read_b128 v[28:31], v248 offset:35072
  v_cvt_pk_bf16_f32 v91, v94, v95
  v_mfma_f32_16x16x32_bf16 v[68:71], v[36:39], v[156:159], v[68:71]
  v_accvgpr_write_b32 a44, v88
  v_accvgpr_write_b32 a45, v89
  v_mfma_f32_16x16x32_bf16 v[76:79], v[36:39], v[188:191], v[76:79]
  v_accvgpr_write_b32 a46, v90
  v_mfma_f32_16x16x32_bf16 v[84:87], v[36:39], v[220:223], v[84:87]
  s_waitcnt lgkmcnt(5)
  v_accvgpr_write_b32 a47, v91
  v_mfma_f32_16x16x32_bf16 v[56:59], v[40:43], v[128:131], v[56:59]
  ds_read_b128 v[32:35], v249 offset:33024
  v_mul_f32 v96, v12, v96
  v_mfma_f32_16x16x32_bf16 v[64:67], v[40:43], v[160:163], v[64:67]
  v_mul_f32 v97, v12, v97
  v_mul_f32 v98, v12, v98
  v_mfma_f32_16x16x32_bf16 v[72:75], v[40:43], v[192:195], v[72:75]
  v_mul_f32 v99, v12, v99
  v_mfma_f32_16x16x32_bf16 v[80:83], v[40:43], v[224:227], v[80:83]
  s_waitcnt lgkmcnt(5)
  v_mul_f32 v100, v12, v100
  v_mfma_f32_16x16x32_bf16 v[60:63], v[44:47], v[128:131], v[60:63]
  ds_read_b128 v[36:39], v249 offset:35072
  v_mul_f32 v101, v12, v101
  v_mfma_f32_16x16x32_bf16 v[68:71], v[44:47], v[160:163], v[68:71]
  v_mul_f32 v102, v12, v102
  v_mul_f32 v103, v12, v103
  v_mfma_f32_16x16x32_bf16 v[76:79], v[44:47], v[192:195], v[76:79]
  v_cvt_pk_bf16_f32 v96, v96, v97
  v_mfma_f32_16x16x32_bf16 v[84:87], v[44:47], v[224:227], v[84:87]
  s_waitcnt lgkmcnt(5)
  v_cvt_pk_bf16_f32 v97, v98, v99
  v_mfma_f32_16x16x32_bf16 v[56:59], v[48:51], v[132:135], v[56:59]
  ds_read_b128 v[40:43], v250 offset:33024
  v_cvt_pk_bf16_f32 v98, v100, v101
  v_mfma_f32_16x16x32_bf16 v[64:67], v[48:51], v[164:167], v[64:67]
  v_cvt_pk_bf16_f32 v99, v102, v103
  v_accvgpr_write_b32 a100, v96
  v_mfma_f32_16x16x32_bf16 v[72:75], v[48:51], v[196:199], v[72:75]
  v_accvgpr_write_b32 a101, v97
  v_mfma_f32_16x16x32_bf16 v[80:83], v[48:51], v[228:231], v[80:83]
  s_waitcnt lgkmcnt(5)
  v_accvgpr_write_b32 a102, v98
  v_mfma_f32_16x16x32_bf16 v[60:63], v[52:55], v[132:135], v[60:63]
  ds_read_b128 v[44:47], v250 offset:35072
  v_accvgpr_write_b32 a103, v99
  v_mfma_f32_16x16x32_bf16 v[68:71], v[52:55], v[164:167], v[68:71]
  v_mul_f32 v104, v12, v104
  v_mul_f32 v105, v12, v105
  v_mfma_f32_16x16x32_bf16 v[76:79], v[52:55], v[196:199], v[76:79]
  v_mul_f32 v106, v12, v106
  v_mfma_f32_16x16x32_bf16 v[84:87], v[52:55], v[228:231], v[84:87]
  s_waitcnt lgkmcnt(5)
  v_mul_f32 v107, v12, v107
  v_mfma_f32_16x16x32_bf16 v[56:59], v[24:27], v[136:139], v[56:59]
  ds_read_b128 v[48:51], v251 offset:33024
  v_mul_f32 v108, v12, v108
  v_mfma_f32_16x16x32_bf16 v[64:67], v[24:27], v[168:171], v[64:67]
  v_mul_f32 v109, v12, v109
  v_mul_f32 v110, v12, v110
  v_mfma_f32_16x16x32_bf16 v[72:75], v[24:27], v[200:203], v[72:75]
  v_mul_f32 v111, v12, v111
  v_mfma_f32_16x16x32_bf16 v[80:83], v[24:27], v[232:235], v[80:83]
  s_waitcnt lgkmcnt(5)
  v_cvt_pk_bf16_f32 v104, v104, v105
  v_mfma_f32_16x16x32_bf16 v[60:63], v[28:31], v[136:139], v[60:63]
  ds_read_b128 v[52:55], v251 offset:35072
  v_cvt_pk_bf16_f32 v105, v106, v107
  v_mfma_f32_16x16x32_bf16 v[68:71], v[28:31], v[168:171], v[68:71]
  v_cvt_pk_bf16_f32 v106, v108, v109
  v_cvt_pk_bf16_f32 v107, v110, v111
  v_mfma_f32_16x16x32_bf16 v[76:79], v[28:31], v[200:203], v[76:79]
  v_accvgpr_write_b32 a156, v104
  v_mfma_f32_16x16x32_bf16 v[84:87], v[28:31], v[232:235], v[84:87]
  s_waitcnt lgkmcnt(5)
  v_accvgpr_write_b32 a157, v105
  v_mfma_f32_16x16x32_bf16 v[56:59], v[32:35], v[140:143], v[56:59]
  s_waitcnt vmcnt(0)
  s_barrier
  ds_read_b128 v[24:27], v248 offset:49152
  v_accvgpr_write_b32 a158, v106
  v_mfma_f32_16x16x32_bf16 v[64:67], v[32:35], v[172:175], v[64:67]
  v_accvgpr_write_b32 a159, v107
  v_mul_f32 v112, v12, v112
  v_mfma_f32_16x16x32_bf16 v[72:75], v[32:35], v[204:207], v[72:75]
  v_mul_f32 v113, v12, v113
  v_mfma_f32_16x16x32_bf16 v[80:83], v[32:35], v[236:239], v[80:83]
  s_waitcnt lgkmcnt(5)
  v_mul_f32 v114, v12, v114
  v_mfma_f32_16x16x32_bf16 v[60:63], v[36:39], v[140:143], v[60:63]
  ds_read_b128 v[28:31], v248 offset:51200
  v_mul_f32 v115, v12, v115
  v_mfma_f32_16x16x32_bf16 v[68:71], v[36:39], v[172:175], v[68:71]
  v_mul_f32 v116, v12, v116
  v_mul_f32 v117, v12, v117
  v_mfma_f32_16x16x32_bf16 v[76:79], v[36:39], v[204:207], v[76:79]
  v_mul_f32 v118, v12, v118
  v_mfma_f32_16x16x32_bf16 v[84:87], v[36:39], v[236:239], v[84:87]
  s_waitcnt lgkmcnt(5)
  v_mul_f32 v119, v12, v119
  v_mfma_f32_16x16x32_bf16 v[56:59], v[40:43], v[144:147], v[56:59]
  ds_read_b128 v[32:35], v249 offset:49152
  v_cvt_pk_bf16_f32 v112, v112, v113
  v_mfma_f32_16x16x32_bf16 v[64:67], v[40:43], v[176:179], v[64:67]
  v_cvt_pk_bf16_f32 v113, v114, v115
  v_cvt_pk_bf16_f32 v114, v116, v117
  v_mfma_f32_16x16x32_bf16 v[72:75], v[40:43], v[208:211], v[72:75]
  v_cvt_pk_bf16_f32 v115, v118, v119
  v_mfma_f32_16x16x32_bf16 v[80:83], v[40:43], v[240:243], v[80:83]
  s_waitcnt lgkmcnt(5)
  v_accvgpr_write_b32 a212, v112
  v_mfma_f32_16x16x32_bf16 v[60:63], v[44:47], v[144:147], v[60:63]
  ds_read_b128 v[36:39], v249 offset:51200
  v_accvgpr_write_b32 a213, v113
  v_mfma_f32_16x16x32_bf16 v[68:71], v[44:47], v[176:179], v[68:71]
  v_accvgpr_write_b32 a214, v114
  v_accvgpr_write_b32 a215, v115
  v_mfma_f32_16x16x32_bf16 v[76:79], v[44:47], v[208:211], v[76:79]
  v_mfma_f32_16x16x32_bf16 v[84:87], v[44:47], v[240:243], v[84:87]
  s_waitcnt lgkmcnt(5)
  v_mfma_f32_16x16x32_bf16 v[56:59], v[48:51], v[148:151], v[56:59]
  ds_read_b128 v[40:43], v250 offset:49152
  v_mfma_f32_16x16x32_bf16 v[64:67], v[48:51], v[180:183], v[64:67]
  v_mfma_f32_16x16x32_bf16 v[72:75], v[48:51], v[212:215], v[72:75]
  v_mfma_f32_16x16x32_bf16 v[80:83], v[48:51], v[244:247], v[80:83]
  s_waitcnt lgkmcnt(5)
  v_mfma_f32_16x16x32_bf16 v[60:63], v[52:55], v[148:151], v[60:63]
  ds_read_b128 v[44:47], v250 offset:51200
  v_mfma_f32_16x16x32_bf16 v[68:71], v[52:55], v[180:183], v[68:71]
  v_mfma_f32_16x16x32_bf16 v[76:79], v[52:55], v[212:215], v[76:79]
  v_mfma_f32_16x16x32_bf16 v[84:87], v[52:55], v[244:247], v[84:87]
  s_waitcnt lgkmcnt(5)
  v_mfma_f32_16x16x32_bf16 v[88:91], v[24:27], v[120:123], 0
  ds_read_b128 v[48:51], v251 offset:49152
  v_mfma_f32_16x16x32_bf16 v[96:99], v[24:27], v[152:155], 0
  v_mfma_f32_16x16x32_bf16 v[104:107], v[24:27], v[184:187], 0
  v_readfirstlane_b32 s86, v13
  s_lshl_b32 s22, s17, 7
  s_add_u32 s22, s22, 88521216
  s_mov_b32 s23, 88523264
  buffer_load_dword v13, off, s[8:11], s22 sc1
  buffer_load_dword v5, off, s[8:11], s23 sc1
  buffer_load_dword v9, off, s[12:15], 0 sc1
  v_mfma_f32_16x16x32_bf16 v[112:115], v[24:27], v[216:219], 0
  s_waitcnt lgkmcnt(5)
  v_mul_f32 v56, v12, v56
  v_mfma_f32_16x16x32_bf16 v[92:95], v[28:31], v[120:123], 0
  ds_read_b128 v[52:55], v251 offset:51200
  v_mul_f32 v57, v12, v57
  v_mfma_f32_16x16x32_bf16 v[100:103], v[28:31], v[152:155], 0
  v_mul_f32 v58, v12, v58
  v_mul_f32 v59, v12, v59
  v_mfma_f32_16x16x32_bf16 v[108:111], v[28:31], v[184:187], 0
  v_mul_f32 v60, v12, v60
  v_mfma_f32_16x16x32_bf16 v[116:119], v[28:31], v[216:219], 0
  s_waitcnt lgkmcnt(5)
  v_mul_f32 v61, v12, v61
  v_mfma_f32_16x16x32_bf16 v[88:91], v[32:35], v[124:127], v[88:91]
  ds_read_b128 v[24:27], v248 offset:49408
  v_mul_f32 v62, v12, v62
  v_mfma_f32_16x16x32_bf16 v[96:99], v[32:35], v[156:159], v[96:99]
  v_mul_f32 v63, v12, v63
  v_cvt_pk_bf16_f32 v56, v56, v57
  v_mfma_f32_16x16x32_bf16 v[104:107], v[32:35], v[188:191], v[104:107]
  v_cvt_pk_bf16_f32 v57, v58, v59
  v_mfma_f32_16x16x32_bf16 v[112:115], v[32:35], v[220:223], v[112:115]
  s_waitcnt lgkmcnt(5)
  v_cvt_pk_bf16_f32 v58, v60, v61
  v_mfma_f32_16x16x32_bf16 v[92:95], v[36:39], v[124:127], v[92:95]
  ds_read_b128 v[28:31], v248 offset:51456
  v_cvt_pk_bf16_f32 v59, v62, v63
  v_mfma_f32_16x16x32_bf16 v[100:103], v[36:39], v[156:159], v[100:103]
  v_accvgpr_write_b32 a48, v56
  v_accvgpr_write_b32 a49, v57
  v_mfma_f32_16x16x32_bf16 v[108:111], v[36:39], v[188:191], v[108:111]
  v_accvgpr_write_b32 a50, v58
  v_mfma_f32_16x16x32_bf16 v[116:119], v[36:39], v[220:223], v[116:119]
  s_waitcnt lgkmcnt(5)
  v_accvgpr_write_b32 a51, v59
  v_mfma_f32_16x16x32_bf16 v[88:91], v[40:43], v[128:131], v[88:91]
  ds_read_b128 v[32:35], v249 offset:49408
  v_mul_f32 v64, v12, v64
  v_mfma_f32_16x16x32_bf16 v[96:99], v[40:43], v[160:163], v[96:99]
  v_mul_f32 v65, v12, v65
  v_mul_f32 v66, v12, v66
  v_mfma_f32_16x16x32_bf16 v[104:107], v[40:43], v[192:195], v[104:107]
  v_mul_f32 v67, v12, v67
  v_mfma_f32_16x16x32_bf16 v[112:115], v[40:43], v[224:227], v[112:115]
  s_waitcnt lgkmcnt(5)
  v_mul_f32 v68, v12, v68
  v_mfma_f32_16x16x32_bf16 v[92:95], v[44:47], v[128:131], v[92:95]
  ds_read_b128 v[36:39], v249 offset:51456
  v_mul_f32 v69, v12, v69
  v_mfma_f32_16x16x32_bf16 v[100:103], v[44:47], v[160:163], v[100:103]
  v_mul_f32 v70, v12, v70
  v_mul_f32 v71, v12, v71
  v_mfma_f32_16x16x32_bf16 v[108:111], v[44:47], v[192:195], v[108:111]
  v_cvt_pk_bf16_f32 v64, v64, v65
  v_mfma_f32_16x16x32_bf16 v[116:119], v[44:47], v[224:227], v[116:119]
  s_waitcnt lgkmcnt(5)
  v_cvt_pk_bf16_f32 v65, v66, v67
  v_mfma_f32_16x16x32_bf16 v[88:91], v[48:51], v[132:135], v[88:91]
  ds_read_b128 v[40:43], v250 offset:49408
  v_cvt_pk_bf16_f32 v66, v68, v69
  v_mfma_f32_16x16x32_bf16 v[96:99], v[48:51], v[164:167], v[96:99]
  v_cvt_pk_bf16_f32 v67, v70, v71
  v_accvgpr_write_b32 a104, v64
  v_mfma_f32_16x16x32_bf16 v[104:107], v[48:51], v[196:199], v[104:107]
  v_accvgpr_write_b32 a105, v65
  v_mfma_f32_16x16x32_bf16 v[112:115], v[48:51], v[228:231], v[112:115]
  s_waitcnt lgkmcnt(5)
  v_accvgpr_write_b32 a106, v66
  v_mfma_f32_16x16x32_bf16 v[92:95], v[52:55], v[132:135], v[92:95]
  ds_read_b128 v[44:47], v250 offset:51456
  v_accvgpr_write_b32 a107, v67
  v_mfma_f32_16x16x32_bf16 v[100:103], v[52:55], v[164:167], v[100:103]
  v_mul_f32 v72, v12, v72
  v_mul_f32 v73, v12, v73
  v_mfma_f32_16x16x32_bf16 v[108:111], v[52:55], v[196:199], v[108:111]
  v_mul_f32 v74, v12, v74
  v_mfma_f32_16x16x32_bf16 v[116:119], v[52:55], v[228:231], v[116:119]
  s_waitcnt lgkmcnt(5)
  v_mul_f32 v75, v12, v75
  v_mfma_f32_16x16x32_bf16 v[88:91], v[24:27], v[136:139], v[88:91]
  ds_read_b128 v[48:51], v251 offset:49408
  v_mul_f32 v76, v12, v76
  v_mfma_f32_16x16x32_bf16 v[96:99], v[24:27], v[168:171], v[96:99]
  v_mul_f32 v77, v12, v77
  v_mul_f32 v78, v12, v78
  v_mfma_f32_16x16x32_bf16 v[104:107], v[24:27], v[200:203], v[104:107]
  v_mul_f32 v79, v12, v79
  v_mfma_f32_16x16x32_bf16 v[112:115], v[24:27], v[232:235], v[112:115]
  s_waitcnt lgkmcnt(5)
  v_cvt_pk_bf16_f32 v72, v72, v73
  v_mfma_f32_16x16x32_bf16 v[92:95], v[28:31], v[136:139], v[92:95]
  ds_read_b128 v[52:55], v251 offset:51456
  v_cvt_pk_bf16_f32 v73, v74, v75
  v_mfma_f32_16x16x32_bf16 v[100:103], v[28:31], v[168:171], v[100:103]
  v_cvt_pk_bf16_f32 v74, v76, v77
  v_cvt_pk_bf16_f32 v75, v78, v79
  v_mfma_f32_16x16x32_bf16 v[108:111], v[28:31], v[200:203], v[108:111]
  v_accvgpr_write_b32 a160, v72
  v_mfma_f32_16x16x32_bf16 v[116:119], v[28:31], v[232:235], v[116:119]
  s_waitcnt lgkmcnt(5)
  v_accvgpr_write_b32 a161, v73
  v_mfma_f32_16x16x32_bf16 v[88:91], v[32:35], v[140:143], v[88:91]
  v_accvgpr_write_b32 a162, v74
  v_mfma_f32_16x16x32_bf16 v[96:99], v[32:35], v[172:175], v[96:99]
  v_accvgpr_write_b32 a163, v75
  v_mul_f32 v80, v12, v80
  v_mfma_f32_16x16x32_bf16 v[104:107], v[32:35], v[204:207], v[104:107]
  v_mul_f32 v81, v12, v81
  v_mfma_f32_16x16x32_bf16 v[112:115], v[32:35], v[236:239], v[112:115]
  s_waitcnt lgkmcnt(4)
  v_mul_f32 v82, v12, v82
  v_mfma_f32_16x16x32_bf16 v[92:95], v[36:39], v[140:143], v[92:95]
  v_mul_f32 v83, v12, v83
  v_mfma_f32_16x16x32_bf16 v[100:103], v[36:39], v[172:175], v[100:103]
  v_mul_f32 v84, v12, v84
  v_mul_f32 v85, v12, v85
  v_mfma_f32_16x16x32_bf16 v[108:111], v[36:39], v[204:207], v[108:111]
  v_mul_f32 v86, v12, v86
  v_mfma_f32_16x16x32_bf16 v[116:119], v[36:39], v[236:239], v[116:119]
  s_waitcnt lgkmcnt(3)
  v_mul_f32 v87, v12, v87
  v_mfma_f32_16x16x32_bf16 v[88:91], v[40:43], v[144:147], v[88:91]
  v_cvt_pk_bf16_f32 v80, v80, v81
  v_mfma_f32_16x16x32_bf16 v[96:99], v[40:43], v[176:179], v[96:99]
  v_cvt_pk_bf16_f32 v81, v82, v83
  v_cvt_pk_bf16_f32 v82, v84, v85
  v_mfma_f32_16x16x32_bf16 v[104:107], v[40:43], v[208:211], v[104:107]
  v_cvt_pk_bf16_f32 v83, v86, v87
  v_mfma_f32_16x16x32_bf16 v[112:115], v[40:43], v[240:243], v[112:115]
  s_waitcnt lgkmcnt(2)
  v_accvgpr_write_b32 a216, v80
  v_mfma_f32_16x16x32_bf16 v[92:95], v[44:47], v[144:147], v[92:95]
  v_accvgpr_write_b32 a217, v81
  v_mfma_f32_16x16x32_bf16 v[100:103], v[44:47], v[176:179], v[100:103]
  v_accvgpr_write_b32 a218, v82
  v_accvgpr_write_b32 a219, v83
  v_mfma_f32_16x16x32_bf16 v[108:111], v[44:47], v[208:211], v[108:111]
  v_mfma_f32_16x16x32_bf16 v[116:119], v[44:47], v[240:243], v[116:119]
  s_waitcnt lgkmcnt(1)
  v_mfma_f32_16x16x32_bf16 v[88:91], v[48:51], v[148:151], v[88:91]
  v_mfma_f32_16x16x32_bf16 v[96:99], v[48:51], v[180:183], v[96:99]
  v_mfma_f32_16x16x32_bf16 v[104:107], v[48:51], v[212:215], v[104:107]
  v_mfma_f32_16x16x32_bf16 v[112:115], v[48:51], v[244:247], v[112:115]
  s_waitcnt lgkmcnt(0)
  v_mfma_f32_16x16x32_bf16 v[92:95], v[52:55], v[148:151], v[92:95]
  v_mfma_f32_16x16x32_bf16 v[100:103], v[52:55], v[180:183], v[100:103]
  v_mfma_f32_16x16x32_bf16 v[108:111], v[52:55], v[212:215], v[108:111]
  v_mfma_f32_16x16x32_bf16 v[116:119], v[52:55], v[244:247], v[116:119]
  v_mul_f32 v88, v12, v88
  v_mul_f32 v89, v12, v89
  v_mul_f32 v90, v12, v90
  v_mul_f32 v91, v12, v91
  v_mul_f32 v92, v12, v92
  v_mul_f32 v93, v12, v93
  v_mul_f32 v94, v12, v94
  v_mul_f32 v95, v12, v95
  v_cvt_pk_bf16_f32 v88, v88, v89
  v_cvt_pk_bf16_f32 v89, v90, v91
  v_cvt_pk_bf16_f32 v90, v92, v93
  v_cvt_pk_bf16_f32 v91, v94, v95
  v_accvgpr_write_b32 a52, v88
  v_accvgpr_write_b32 a53, v89
  v_accvgpr_write_b32 a54, v90
  v_accvgpr_write_b32 a55, v91
  v_mul_f32 v96, v12, v96
  v_mul_f32 v97, v12, v97
  v_mul_f32 v98, v12, v98
  v_mul_f32 v99, v12, v99
  v_mul_f32 v100, v12, v100
  v_mul_f32 v101, v12, v101
  v_mul_f32 v102, v12, v102
  v_mul_f32 v103, v12, v103
  v_cvt_pk_bf16_f32 v96, v96, v97
  v_cvt_pk_bf16_f32 v97, v98, v99
  v_cvt_pk_bf16_f32 v98, v100, v101
  v_cvt_pk_bf16_f32 v99, v102, v103
  v_accvgpr_write_b32 a108, v96
  v_accvgpr_write_b32 a109, v97
  v_accvgpr_write_b32 a110, v98
  v_accvgpr_write_b32 a111, v99
  v_mul_f32 v104, v12, v104
  v_mul_f32 v105, v12, v105
  v_mul_f32 v106, v12, v106
  v_mul_f32 v107, v12, v107
  v_mul_f32 v108, v12, v108
  v_mul_f32 v109, v12, v109
  v_mul_f32 v110, v12, v110
  v_mul_f32 v111, v12, v111
  v_cvt_pk_bf16_f32 v104, v104, v105
  v_cvt_pk_bf16_f32 v105, v106, v107
  v_cvt_pk_bf16_f32 v106, v108, v109
  v_cvt_pk_bf16_f32 v107, v110, v111
  v_accvgpr_write_b32 a164, v104
  v_accvgpr_write_b32 a165, v105
  v_accvgpr_write_b32 a166, v106
  v_accvgpr_write_b32 a167, v107
  v_mul_f32 v112, v12, v112
  v_mul_f32 v113, v12, v113
  v_mul_f32 v114, v12, v114
  v_mul_f32 v115, v12, v115
  v_mul_f32 v116, v12, v116
  v_mul_f32 v117, v12, v117
  v_mul_f32 v118, v12, v118
  v_mul_f32 v119, v12, v119
  v_cvt_pk_bf16_f32 v112, v112, v113
  v_cvt_pk_bf16_f32 v113, v114, v115
  v_cvt_pk_bf16_f32 v114, v116, v117
  v_cvt_pk_bf16_f32 v115, v118, v119
  v_accvgpr_write_b32 a220, v112
  v_accvgpr_write_b32 a221, v113
  v_accvgpr_write_b32 a222, v114
  v_accvgpr_write_b32 a223, v115
  s_waitcnt vmcnt(0)
  s_barrier
  v_readfirstlane_b32 s84, v13
  v_readfirstlane_b32 s85, v5
  s_cmp_eq_u32 s86, 1
  s_cselect_b32 s84, s84, 0
  v_and_b32 v10, 0xffe0, v9
  v_cmp_eq_u32 vcc, 0, v10
  s_cbranch_vccz ch_md_ok
ch_role2:
  s_mov_b32 s30, 0
ch_md:
  buffer_load_dword v9, off, s[12:15], 0 sc1
  s_waitcnt vmcnt(0)
  v_and_b32 v10, 0xffe0, v9
  v_cmp_eq_u32 vcc, 0, v10
  s_cbranch_vccz ch_md_ok
  s_sleep 4
  s_add_u32 s30, s30, 1
  s_cmp_lt_u32 s30, 1600000
  s_cbranch_scc1 ch_md
  s_branch ch_end
ch_md_ok:
  v_readfirstlane_b32 s88, v9
  s_lshr_b32 s88, s88, 16
  v_and_b32 v1, 63, v0
  v_lshlrev_b32 v2, 4, v1
  v_lshrrev_b32 v116, 4, v1
  v_and_b32 v117, 15, v1
  v_mov_b32 v3, 0x4444
  v_mov_b32 v118, 0xeeee
  v_cmp_lt_u32 vcc, 7, v117
  s_nop 1
  v_cndmask_b32 v3, v3, v118, vcc
  s_mov_b32 s19, 0
  s_mov_b32 s18, 1
  s_mov_b32 s20, 75694080
  s_mov_b32 s21, 75711744
  s_mov_b32 s23, 75698176
  s_lshr_b32 s89, s17, 4
  s_lshl_b32 s89, s89, 2
  s_add_u32 s89, s89, s16
  s_and_b32 s17, s17, 15
  s_cmp_eq_u32 s89, 0
  s_cbranch_scc1 ch_init0
  s_cmp_eq_u32 s89, 1
  s_cbranch_scc1 ch_init1
  s_cmp_eq_u32 s89, 2
  s_cbranch_scc1 ch_init2
  s_cmp_eq_u32 s89, 3
  s_cbranch_scc1 ch_init3
  s_cmp_eq_u32 s89, 4
  s_cbranch_scc1 ch_init4
  s_cmp_eq_u32 s89, 5
  s_cbranch_scc1 ch_init5
  s_cmp_eq_u32 s89, 6
  s_cbranch_scc1 ch_init6
  s_cmp_eq_u32 s89, 7
  s_cbranch_scc1 ch_init7
  s_branch ch_end
ch_init0:
  s_mul_i32 s31, s17, 401408
  s_add_u32 s31, s31, 0
  s_and_b32 s28, s84, 10320
  s_lshl_b32 s22, s85, 16
  s_or_b32 s28, s28, s22
  s_cmp_eq_u32 s28, 4294912080
  s_cbranch_scc1 ch_wx0_ok
  s_mov_b32 s30, 0
ch_wr0:
  buffer_load_dword v9, off, s[12:15], 0 offset:132 sc1
  s_waitcnt vmcnt(0)
  v_cmp_ne_u32 vcc, 1, v9
  s_cbranch_vccz ch_wr0_ok
  s_sleep 8
  s_add_u32 s30, s30, 1
  s_cmp_lt_u32 s30, 400000
  s_cbranch_scc1 ch_wr0
  s_branch cA_abort
ch_wr0_ok:
  s_lshl_b32 s27, s17, 7
  s_add_u32 s27, s27, 88521216
  s_mov_b32 s28, 10320
  s_mov_b32 s30, 0
ch_wb0:
  buffer_load_dword v9, off, s[8:11], s27  sc1
  s_waitcnt vmcnt(0)
  v_and_b32 v10, s28, v9
  v_cmp_ne_u32 vcc, s28, v10
  s_cbranch_vccz ch_wb0_ok
  s_sleep 3
  s_add_u32 s30, s30, 1
  s_cmp_lt_u32 s30, 400000
  s_cbranch_scc1 ch_wb0
  s_branch cA_abort
ch_wb0_ok:
  s_mov_b32 s29, 88523264
  s_mov_b32 s28, 0xffff
  s_mov_b32 s30, 0
ch_wx0:
  buffer_load_dword v9, off, s[8:11], s29  sc1
  s_waitcnt vmcnt(0)
  v_and_b32 v10, s28, v9
  v_cmp_ne_u32 vcc, s28, v10
  s_cbranch_vccz ch_wx0_ok
  s_sleep 8
  s_add_u32 s30, s30, 1
  s_cmp_lt_u32 s30, 400000
  s_cbranch_scc1 ch_wx0
  s_branch cA_abort
ch_wx0_ok:
  s_add_u32 s22, s31, 229376
  buffer_load_dwordx4 a[224:227], v2, s[8:11], s22 offen offset:0 sc1
  buffer_load_dwordx4 a[228:231], v2, s[8:11], s22 offen offset:1024 sc1
  buffer_load_dwordx4 a[232:235], v2, s[8:11], s22 offen offset:2048 sc1
  buffer_load_dwordx4 a[236:239], v2, s[8:11], s22 offen offset:3072 sc1
  s_add_u32 s22, s31, 233472
  buffer_load_dwordx4 a[240:243], v2, s[8:11], s22 offen offset:0 sc1
  buffer_load_dwordx4 a[244:247], v2, s[8:11], s22 offen offset:1024 sc1
  buffer_load_dwordx4 a[248:251], v2, s[8:11], s22 offen offset:2048 sc1
  buffer_load_dwordx4 a[252:255], v2, s[8:11], s22 offen offset:3072 sc1
  s_add_u32 s22, s31, 237568
  buffer_load_dwordx4 v[120:123], v2, s[8:11], s22 offen offset:0 sc1
  buffer_load_dwordx4 v[124:127], v2, s[8:11], s22 offen offset:1024 sc1
  buffer_load_dwordx4 v[128:131], v2, s[8:11], s22 offen offset:2048 sc1
  buffer_load_dwordx4 v[132:135], v2, s[8:11], s22 offen offset:3072 sc1
  s_add_u32 s22, s31, 241664
  buffer_load_dwordx4 v[136:139], v2, s[8:11], s22 offen offset:0 sc1
  buffer_load_dwordx4 v[140:143], v2, s[8:11], s22 offen offset:1024 sc1
  buffer_load_dwordx4 v[144:147], v2, s[8:11], s22 offen offset:2048 sc1
  buffer_load_dwordx4 v[148:151], v2, s[8:11], s22 offen offset:3072 sc1
  s_add_u32 s22, s31, 245760
  buffer_load_dwordx4 v[152:155], v2, s[8:11], s22 offen offset:0 sc1
  buffer_load_dwordx4 v[156:159], v2, s[8:11], s22 offen offset:1024 sc1
  buffer_load_dwordx4 v[160:163], v2, s[8:11], s22 offen offset:2048 sc1
  buffer_load_dwordx4 v[164:167], v2, s[8:11], s22 offen offset:3072 sc1
  s_add_u32 s22, s31, 249856
  buffer_load_dwordx4 v[168:171], v2, s[8:11], s22 offen offset:0 sc1
  buffer_load_dwordx4 v[172:175], v2, s[8:11], s22 offen offset:1024 sc1
  buffer_load_dwordx4 v[176:179], v2, s[8:11], s22 offen offset:2048 sc1
  buffer_load_dwordx4 v[180:183], v2, s[8:11], s22 offen offset:3072 sc1
  s_mov_b32 s24, 72024064
  s_mov_b32 s26, 72038400
  v_and_b32 v64, 7, v117
  v_and_b32 v65, 1, v116
  v_lshlrev_b32 v65, 2, v65
  v_sub_u32 v64, v64, v65
  v_lshrrev_b32 v65, 3, v117
  v_lshl_add_u32 v66, v65, 2, v64
  v_cmp_gt_u32 vcc, 4, v64
  v_mov_b32 v67, 99
  s_nop 0
  v_cndmask_b32 v66, v67, v66, vcc
  v_mov_b32 v68, 0x3f80
  v_mov_b32 v69, 0x3f800000
  v_mov_b32 v4, 0
  v_cmp_eq_u32 vcc, 0, v66
  s_nop 1
  v_cndmask_b32 v4, v4, v68, vcc
  v_cmp_eq_u32 vcc, 1, v66
  s_nop 1
  v_cndmask_b32 v4, v4, v69, vcc
  v_mov_b32 v5, 0
  v_cmp_eq_u32 vcc, 2, v66
  s_nop 1
  v_cndmask_b32 v5, v5, v68, vcc
  v_cmp_eq_u32 vcc, 3, v66
  s_nop 1
  v_cndmask_b32 v5, v5, v69, vcc
  v_mov_b32 v6, 0
  v_cmp_eq_u32 vcc, 4, v66
  s_nop 1
  v_cndmask_b32 v6, v6, v68, vcc
  v_cmp_eq_u32 vcc, 5, v66
  s_nop 1
  v_cndmask_b32 v6, v6, v69, vcc
  v_mov_b32 v7, 0
  v_cmp_eq_u32 vcc, 6, v66
  s_nop 1
  v_cndmask_b32 v7, v7, v68, vcc
  v_cmp_eq_u32 vcc, 7, v66
  s_nop 1
  v_cndmask_b32 v7, v7, v69, vcc
  v_lshrrev_b32 v64, 1, v116
  v_lshrrev_b32 v65, 3, v117
  v_and_b32 v66, 1, v116
  v_and_b32 v68, 7, v117
  v_lshlrev_b32 v67, 8, v65
  v_lshl_add_u32 v67, v68, 5, v67
  v_lshl_add_u32 v67, v66, 4, v67
  v_add_u32 v69, 4096, v67
  v_add_u32 v70, 6400, v67
  v_cmp_eq_u32 vcc, v64, v65
  s_nop 1
  v_cndmask_b32 v113, v70, v69, vcc
  v_and_b32 v74, 3, v117
  v_lshlrev_b32 v74, 1, v74
  v_bfe_u32 v75, v117, 2, 1
  v_or_b32 v74, v74, v75
  v_and_b32 v75, 8, v117
  v_or_b32 v74, v74, v75
  v_lshlrev_b32 v67, 9, v64
  v_lshl_add_u32 v67, v74, 4, v67
  v_lshl_add_u32 v67, v66, 3, v67
  v_add_u32 v114, 0, v67
  v_mul_u32_u24 v67, 1088, v65
  v_lshl_add_u32 v67, v116, 5, v67
  v_and_b32 v75, 1, v117
  v_and_b32 v76, 2, v117
  v_lshl_add_u32 v75, v76, 1, v75
  v_bfe_u32 v76, v117, 2, 1
  v_lshl_add_u32 v75, v76, 1, v75
  v_lshl_add_u32 v67, v75, 2, v67
  v_add_u32 v115, 4096, v67
  v_and_b32 v69, 1, v74
  v_lshlrev_b32 v67, 7, v69
  v_lshl_add_u32 v67, v116, 4, v67
  v_lshl_add_u32 v67, v65, 8, v67
  v_bfe_u32 v69, v74, 1, 2
  v_lshl_add_u32 v67, v69, 2, v67
  s_lshl_b32 s22, s17, 9
  s_add_u32 s22, s22, 9216
  v_add_u32 v72, s22, v67
  v_bfe_u32 v69, v75, 1, 1
  v_lshlrev_b32 v67, 7, v69
  v_lshl_add_u32 v67, v116, 4, v67
  v_and_b32 v69, 4, v75
  v_add_u32 v67, v67, v69
  s_lshr_b32 s22, s17, 1
  s_lshl_b32 s22, s22, 8
  s_and_b32 s27, s17, 1
  s_lshl_b32 s27, s27, 3
  s_add_u32 s22, s22, s27
  s_add_u32 s22, s22, 7168
  v_add_u32 v67, s22, v67
  v_and_b32 v69, 9, v117
  v_mov_b32 v70, 0x40000000
  v_cmp_eq_u32 vcc, 0, v69
  s_nop 1
  v_cndmask_b32 v118, v70, v67, vcc
  v_mov_b32 v119, -1
  v_and_b32 v0, 15, v1
  s_and_b32 s22, s17, 0
  s_lshl_b32 s22, s22, 7
  s_add_u32 s22, s22, 75731456
  v_lshl_add_u32 v0, v0, 2, s22
  v_xor_b32 v69, 256, v2
  v_mul_i32_i24 v70, -4096, v66
  v_add_u32 v69, v69, v70
  v_add_u32 v117, 12288, v69
  v_mov_b32 v116, v73
  v_mov_b32 v112, 0
  s_mul_i32 s35, s17, 28672
  s_add_u32 s35, s35, 44040192
  v_mov_b32 v1, v72
  v_mov_b32 v36, 0
  v_mov_b32 v37, 0
  v_mov_b32 v38, 0
  v_mov_b32 v39, 0
  v_mov_b32 v40, 0
  v_mov_b32 v41, 0
  v_mov_b32 v42, 0
  v_mov_b32 v43, 0
  v_mov_b32 v44, 0
  v_mov_b32 v45, 0
  v_mov_b32 v46, 0
  v_mov_b32 v47, 0
  v_mov_b32 v48, 0
  v_mov_b32 v49, 0
  v_mov_b32 v50, 0
  v_mov_b32 v51, 0
  v_mov_b32 v52, 0
  v_mov_b32 v53, 0
  v_mov_b32 v54, 0
  v_mov_b32 v55, 0
  v_mov_b32 v56, 0
  v_mov_b32 v57, 0
  v_mov_b32 v58, 0
  v_mov_b32 v59, 0
  v_mov_b32 v60, 0
  v_mov_b32 v61, 0
  v_mov_b32 v62, 0
  v_mov_b32 v63, 0
  v_mov_b32 v64, 0
  v_mov_b32 v65, 0
  v_mov_b32 v66, 0
  v_mov_b32 v67, 0
  v_mov_b32 v68, 0
  v_mov_b32 v69, 0
  v_mov_b32 v70, 0
  v_mov_b32 v71, 0
  v_mov_b32 v72, 0
  v_mov_b32 v73, 0
  v_mov_b32 v74, 0
  v_mov_b32 v75, 0
  v_mov_b32 v76, 0
  v_mov_b32 v77, 0
  v_mov_b32 v78, 0
  v_mov_b32 v79, 0
  s_mov_b32 s22, 75694080
  v_lshrrev_b32 v14, 4, v2
  v_add_u32 v14, 0, v14
  v_min_u32 v14, 308, v14
  v_lshlrev_b32 v14, 7, v14
  buffer_load_dword v15, v14, s[8:11], s22 offen sc1
  v_lshrrev_b32 v14, 4, v2
  v_add_u32 v14, 256, v14
  v_min_u32 v14, 308, v14
  v_lshlrev_b32 v14, 7, v14
  buffer_load_dword v15, v14, s[8:11], s22 offen sc1
  buffer_load_dwordx4 v[80:83], v117, s[8:11], s24 offen offset:0 sc1
  buffer_load_dwordx4 v[84:87], v117, s[8:11], s24 offen offset:1024 sc1
  buffer_load_dwordx4 v[88:91], v117, s[8:11], s26 offen offset:0 sc1
  buffer_load_dwordx4 v[92:95], v117, s[8:11], s26 offen offset:1024 sc1
  buffer_load_dwordx4 v[96:99], v2, s[8:11], s24 offen offset:0 sc1
  buffer_load_dwordx4 v[100:103], v2, s[8:11], s24 offen offset:1024 sc1
  buffer_load_dwordx4 v[104:107], v2, s[8:11], s26 offen offset:0 sc1
  buffer_load_dwordx4 v[108:111], v2, s[8:11], s26 offen offset:1024 sc1
  s_add_u32 s22, s31, 253952
  buffer_load_dwordx4 v[184:187], v2, s[8:11], s22 offen offset:0 sc1
  buffer_load_dwordx4 v[188:191], v2, s[8:11], s22 offen offset:1024 sc1
  buffer_load_dwordx4 v[192:195], v2, s[8:11], s22 offen offset:2048 sc1
  buffer_load_dwordx4 v[196:199], v2, s[8:11], s22 offen offset:3072 sc1
  s_add_u32 s22, s31, 372736
  buffer_load_dwordx4 v[200:203], v2, s[8:11], s22 offen offset:0 sc1
  buffer_load_dwordx4 v[204:207], v2, s[8:11], s22 offen offset:1024 sc1
  buffer_load_dwordx4 v[208:211], v2, s[8:11], s22 offen offset:2048 sc1
  buffer_load_dwordx4 v[212:215], v2, s[8:11], s22 offen offset:3072 sc1
  s_add_u32 s22, s31, 376832
  buffer_load_dwordx4 v[216:219], v2, s[8:11], s22 offen offset:0 sc1
  buffer_load_dwordx4 v[220:223], v2, s[8:11], s22 offen offset:1024 sc1
  buffer_load_dwordx4 v[224:227], v2, s[8:11], s22 offen offset:2048 sc1
  buffer_load_dwordx4 v[228:231], v2, s[8:11], s22 offen offset:3072 sc1
  s_add_u32 s22, s31, 380928
  buffer_load_dwordx4 v[232:235], v2, s[8:11], s22 offen offset:0 sc1
  buffer_load_dwordx4 v[236:239], v2, s[8:11], s22 offen offset:1024 sc1
  buffer_load_dwordx4 v[240:243], v2, s[8:11], s22 offen offset:2048 sc1
  buffer_load_dwordx4 v[244:247], v2, s[8:11], s22 offen offset:3072 sc1
  s_add_u32 s22, s31, 385024
  buffer_load_dwordx4 v[248:251], v2, s[8:11], s22 offen offset:0 sc1
  buffer_load_dwordx4 v[252:255], v2, s[8:11], s22 offen offset:1024 sc1
  s_waitcnt vmcnt(0) lgkmcnt(0)
  s_mov_b32 s31, 0
  s_cmp_lg_u32 s88, 0
  s_cbranch_scc1 cB_sc0_loop
  s_branch cA_sc0_loop
ch_init1:
  s_mul_i32 s31, s17, 401408
  s_add_u32 s31, s31, 0
  s_and_b32 s28, s84, 10320
  s_lshl_b32 s22, s85, 16
  s_or_b32 s28, s28, s22
  s_cmp_eq_u32 s28, 4294912080
  s_cbranch_scc1 ch_wx1_ok
  s_mov_b32 s30, 0
ch_wr1:
  buffer_load_dword v9, off, s[12:15], 0 offset:132 sc1
  s_waitcnt vmcnt(0)
  v_cmp_ne_u32 vcc, 1, v9
  s_cbranch_vccz ch_wr1_ok
  s_sleep 8
  s_add_u32 s30, s30, 1
  s_cmp_lt_u32 s30, 400000
  s_cbranch_scc1 ch_wr1
  s_branch cA_abort
ch_wr1_ok:
  s_lshl_b32 s27, s17, 7
  s_add_u32 s27, s27, 88521216
  s_mov_b32 s28, 10320
  s_mov_b32 s30, 0
ch_wb1:
  buffer_load_dword v9, off, s[8:11], s27  sc1
  s_waitcnt vmcnt(0)
  v_and_b32 v10, s28, v9
  v_cmp_ne_u32 vcc, s28, v10
  s_cbranch_vccz ch_wb1_ok
  s_sleep 3
  s_add_u32 s30, s30, 1
  s_cmp_lt_u32 s30, 400000
  s_cbranch_scc1 ch_wb1
  s_branch cA_abort
ch_wb1_ok:
  s_mov_b32 s29, 88523264
  s_mov_b32 s28, 0xffff
  s_mov_b32 s30, 0
ch_wx1:
  buffer_load_dword v9, off, s[8:11], s29  sc1
  s_waitcnt vmcnt(0)
  v_and_b32 v10, s28, v9
  v_cmp_ne_u32 vcc, s28, v10
  s_cbranch_vccz ch_wx1_ok
  s_sleep 8
  s_add_u32 s30, s30, 1
  s_cmp_lt_u32 s30, 400000
  s_cbranch_scc1 ch_wx1
  s_branch cA_abort
ch_wx1_ok:
  s_add_u32 s22, s31, 258048
  buffer_load_dwordx4 a[224:227], v2, s[8:11], s22 offen offset:0 sc1
  buffer_load_dwordx4 a[228:231], v2, s[8:11], s22 offen offset:1024 sc1
  buffer_load_dwordx4 a[232:235], v2, s[8:11], s22 offen offset:2048 sc1
  buffer_load_dwordx4 a[236:239], v2, s[8:11], s22 offen offset:3072 sc1
  s_add_u32 s22, s31, 262144
  buffer_load_dwordx4 a[240:243], v2, s[8:11], s22 offen offset:0 sc1
  buffer_load_dwordx4 a[244:247], v2, s[8:11], s22 offen offset:1024 sc1
  buffer_load_dwordx4 a[248:251], v2, s[8:11], s22 offen offset:2048 sc1
  buffer_load_dwordx4 a[252:255], v2, s[8:11], s22 offen offset:3072 sc1
  s_add_u32 s22, s31, 266240
  buffer_load_dwordx4 v[120:123], v2, s[8:11], s22 offen offset:0 sc1
  buffer_load_dwordx4 v[124:127], v2, s[8:11], s22 offen offset:1024 sc1
  buffer_load_dwordx4 v[128:131], v2, s[8:11], s22 offen offset:2048 sc1
  buffer_load_dwordx4 v[132:135], v2, s[8:11], s22 offen offset:3072 sc1
  s_add_u32 s22, s31, 270336
  buffer_load_dwordx4 v[136:139], v2, s[8:11], s22 offen offset:0 sc1
  buffer_load_dwordx4 v[140:143], v2, s[8:11], s22 offen offset:1024 sc1
  buffer_load_dwordx4 v[144:147], v2, s[8:11], s22 offen offset:2048 sc1
  buffer_load_dwordx4 v[148:151], v2, s[8:11], s22 offen offset:3072 sc1
  s_add_u32 s22, s31, 274432
  buffer_load_dwordx4 v[152:155], v2, s[8:11], s22 offen offset:0 sc1
  buffer_load_dwordx4 v[156:159], v2, s[8:11], s22 offen offset:1024 sc1
  buffer_load_dwordx4 v[160:163], v2, s[8:11], s22 offen offset:2048 sc1
  buffer_load_dwordx4 v[164:167], v2, s[8:11], s22 offen offset:3072 sc1
  s_add_u32 s22, s31, 278528
  buffer_load_dwordx4 v[168:171], v2, s[8:11], s22 offen offset:0 sc1
  buffer_load_dwordx4 v[172:175], v2, s[8:11], s22 offen offset:1024 sc1
  buffer_load_dwordx4 v[176:179], v2, s[8:11], s22 offen offset:2048 sc1
  buffer_load_dwordx4 v[180:183], v2, s[8:11], s22 offen offset:3072 sc1
  s_mov_b32 s24, 72026112
  s_mov_b32 s26, 72040448
  v_and_b32 v64, 7, v117
  v_and_b32 v65, 1, v116
  v_lshlrev_b32 v65, 2, v65
  v_sub_u32 v64, v64, v65
  v_lshrrev_b32 v65, 3, v117
  v_lshl_add_u32 v66, v65, 2, v64
  v_cmp_gt_u32 vcc, 4, v64
  v_mov_b32 v67, 99
  s_nop 0
  v_cndmask_b32 v66, v67, v66, vcc
  v_mov_b32 v68, 0x3f80
  v_mov_b32 v69, 0x3f800000
  v_mov_b32 v4, 0
  v_cmp_eq_u32 vcc, 0, v66
  s_nop 1
  v_cndmask_b32 v4, v4, v68, vcc
  v_cmp_eq_u32 vcc, 1, v66
  s_nop 1
  v_cndmask_b32 v4, v4, v69, vcc
  v_mov_b32 v5, 0
  v_cmp_eq_u32 vcc, 2, v66
  s_nop 1
  v_cndmask_b32 v5, v5, v68, vcc
  v_cmp_eq_u32 vcc, 3, v66
  s_nop 1
  v_cndmask_b32 v5, v5, v69, vcc
  v_mov_b32 v6, 0
  v_cmp_eq_u32 vcc, 4, v66
  s_nop 1
  v_cndmask_b32 v6, v6, v68, vcc
  v_cmp_eq_u32 vcc, 5, v66
  s_nop 1
  v_cndmask_b32 v6, v6, v69, vcc
  v_mov_b32 v7, 0
  v_cmp_eq_u32 vcc, 6, v66
  s_nop 1
  v_cndmask_b32 v7, v7, v68, vcc
  v_cmp_eq_u32 vcc, 7, v66
  s_nop 1
  v_cndmask_b32 v7, v7, v69, vcc
  v_lshrrev_b32 v64, 1, v116
  v_lshrrev_b32 v65, 3, v117
  v_and_b32 v66, 1, v116
  v_and_b32 v68, 7, v117
  v_lshlrev_b32 v67, 8, v65
  v_lshl_add_u32 v67, v68, 5, v67
  v_lshl_add_u32 v67, v66, 4, v67
  v_add_u32 v69, 4608, v67
  v_add_u32 v70, 6400, v67
  v_cmp_eq_u32 vcc, v64, v65
  s_nop 1
  v_cndmask_b32 v113, v70, v69, vcc
  v_and_b32 v74, 3, v117
  v_lshlrev_b32 v74, 1, v74
  v_bfe_u32 v75, v117, 2, 1
  v_or_b32 v74, v74, v75
  v_and_b32 v75, 8, v117
  v_or_b32 v74, v74, v75
  v_lshlrev_b32 v67, 9, v64
  v_lshl_add_u32 v67, v74, 4, v67
  v_lshl_add_u32 v67, v66, 3, v67
  v_add_u32 v114, 256, v67
  v_mul_u32_u24 v67, 1088, v65
  v_lshl_add_u32 v67, v116, 5, v67
  v_and_b32 v75, 1, v117
  v_and_b32 v76, 2, v117
  v_lshl_add_u32 v75, v76, 1, v75
  v_bfe_u32 v76, v117, 2, 1
  v_lshl_add_u32 v75, v76, 1, v75
  v_lshl_add_u32 v67, v75, 2, v67
  v_add_u32 v115, 4224, v67
  v_and_b32 v69, 1, v74
  v_lshlrev_b32 v67, 7, v69
  v_lshl_add_u32 v67, v116, 4, v67
  v_lshl_add_u32 v67, v65, 8, v67
  v_bfe_u32 v69, v74, 1, 2
  v_lshl_add_u32 v67, v69, 2, v67
  s_lshl_b32 s22, s17, 9
  s_add_u32 s22, s22, 9280
  v_add_u32 v72, s22, v67
  v_bfe_u32 v69, v75, 1, 1
  v_lshlrev_b32 v67, 7, v69
  v_lshl_add_u32 v67, v116, 4, v67
  v_and_b32 v69, 4, v75
  v_add_u32 v67, v67, v69
  s_lshr_b32 s22, s17, 1
  s_lshl_b32 s22, s22, 8
  s_and_b32 s27, s17, 1
  s_lshl_b32 s27, s27, 3
  s_add_u32 s22, s22, s27
  s_add_u32 s22, s22, 7232
  v_add_u32 v67, s22, v67
  v_and_b32 v69, 9, v117
  v_mov_b32 v70, 0x40000000
  v_cmp_eq_u32 vcc, 0, v69
  s_nop 1
  v_cndmask_b32 v118, v70, v67, vcc
  v_mov_b32 v119, -1
  s_lshl_b32 s22, s17, 2
  s_add_u32 s22, s22, 75729408
  v_lshl_add_u32 v67, v1, 7, s22
  v_mov_b32 v70, 0x40000000
  v_cmp_gt_u32 vcc, 1, v1
  s_nop 1
  v_cndmask_b32 v73, v70, v67, vcc
  v_mov_b32 v112, 1
  v_and_b32 v0, 15, v1
  s_and_b32 s22, s17, 0
  s_lshl_b32 s22, s22, 7
  s_add_u32 s22, s22, 75731456
  v_lshl_add_u32 v0, v0, 2, s22
  v_xor_b32 v69, 256, v2
  v_mul_i32_i24 v70, 4096, v66
  v_add_u32 v69, v69, v70
  v_add_u32 v117, 6144, v69
  v_mov_b32 v116, v73
  s_mul_i32 s35, s17, 28672
  s_add_u32 s35, s35, 44040192
  v_mov_b32 v1, v72
  v_mov_b32 v36, 0
  v_mov_b32 v37, 0
  v_mov_b32 v38, 0
  v_mov_b32 v39, 0
  v_mov_b32 v40, 0
  v_mov_b32 v41, 0
  v_mov_b32 v42, 0
  v_mov_b32 v43, 0
  v_mov_b32 v44, 0
  v_mov_b32 v45, 0
  v_mov_b32 v46, 0
  v_mov_b32 v47, 0
  v_mov_b32 v48, 0
  v_mov_b32 v49, 0
  v_mov_b32 v50, 0
  v_mov_b32 v51, 0
  v_mov_b32 v52, 0
  v_mov_b32 v53, 0
  v_mov_b32 v54, 0
  v_mov_b32 v55, 0
  v_mov_b32 v56, 0
  v_mov_b32 v57, 0
  v_mov_b32 v58, 0
  v_mov_b32 v59, 0
  v_mov_b32 v60, 0
  v_mov_b32 v61, 0
  v_mov_b32 v62, 0
  v_mov_b32 v63, 0
  v_mov_b32 v64, 0
  v_mov_b32 v65, 0
  v_mov_b32 v66, 0
  v_mov_b32 v67, 0
  v_mov_b32 v68, 0
  v_mov_b32 v69, 0
  v_mov_b32 v70, 0
  v_mov_b32 v71, 0
  v_mov_b32 v72, 0
  v_mov_b32 v73, 0
  v_mov_b32 v74, 0
  v_mov_b32 v75, 0
  v_mov_b32 v76, 0
  v_mov_b32 v77, 0
  v_mov_b32 v78, 0
  v_mov_b32 v79, 0
  s_mov_b32 s22, 75694080
  v_lshrrev_b32 v14, 4, v2
  v_add_u32 v14, 64, v14
  v_min_u32 v14, 308, v14
  v_lshlrev_b32 v14, 7, v14
  buffer_load_dword v15, v14, s[8:11], s22 offen sc1
  buffer_load_dwordx4 v[80:83], v117, s[8:11], s24 offen offset:0 sc1
  buffer_load_dwordx4 v[84:87], v117, s[8:11], s24 offen offset:1024 sc1
  buffer_load_dwordx4 v[88:91], v117, s[8:11], s26 offen offset:0 sc1
  buffer_load_dwordx4 v[92:95], v117, s[8:11], s26 offen offset:1024 sc1
  buffer_load_dwordx4 v[96:99], v2, s[8:11], s24 offen offset:0 sc1
  buffer_load_dwordx4 v[100:103], v2, s[8:11], s24 offen offset:1024 sc1
  buffer_load_dwordx4 v[104:107], v2, s[8:11], s26 offen offset:0 sc1
  buffer_load_dwordx4 v[108:111], v2, s[8:11], s26 offen offset:1024 sc1
  s_add_u32 s22, s31, 282624
  buffer_load_dwordx4 v[184:187], v2, s[8:11], s22 offen offset:0 sc1
  buffer_load_dwordx4 v[188:191], v2, s[8:11], s22 offen offset:1024 sc1
  buffer_load_dwordx4 v[192:195], v2, s[8:11], s22 offen offset:2048 sc1
  buffer_load_dwordx4 v[196:199], v2, s[8:11], s22 offen offset:3072 sc1
  s_add_u32 s22, s31, 344064
  buffer_load_dwordx4 v[200:203], v2, s[8:11], s22 offen offset:0 sc1
  buffer_load_dwordx4 v[204:207], v2, s[8:11], s22 offen offset:1024 sc1
  buffer_load_dwordx4 v[208:211], v2, s[8:11], s22 offen offset:2048 sc1
  buffer_load_dwordx4 v[212:215], v2, s[8:11], s22 offen offset:3072 sc1
  s_add_u32 s22, s31, 348160
  buffer_load_dwordx4 v[216:219], v2, s[8:11], s22 offen offset:0 sc1
  buffer_load_dwordx4 v[220:223], v2, s[8:11], s22 offen offset:1024 sc1
  buffer_load_dwordx4 v[224:227], v2, s[8:11], s22 offen offset:2048 sc1
  buffer_load_dwordx4 v[228:231], v2, s[8:11], s22 offen offset:3072 sc1
  s_add_u32 s22, s31, 352256
  buffer_load_dwordx4 v[232:235], v2, s[8:11], s22 offen offset:0 sc1
  buffer_load_dwordx4 v[236:239], v2, s[8:11], s22 offen offset:1024 sc1
  buffer_load_dwordx4 v[240:243], v2, s[8:11], s22 offen offset:2048 sc1
  buffer_load_dwordx4 v[244:247], v2, s[8:11], s22 offen offset:3072 sc1
  s_add_u32 s22, s31, 356352
  buffer_load_dwordx4 v[248:251], v2, s[8:11], s22 offen offset:0 sc1
  buffer_load_dwordx4 v[252:255], v2, s[8:11], s22 offen offset:1024 sc1
  s_waitcnt vmcnt(0) lgkmcnt(0)
  s_mov_b32 s31, 0
  s_cmp_lg_u32 s88, 0
  s_cbranch_scc1 cB_sc1_loop
  s_branch cA_sc1_loop
ch_init2:
  s_mul_i32 s31, s17, 401408
  s_add_u32 s31, s31, 0
  s_and_b32 s28, s84, 12384
  s_lshl_b32 s22, s85, 16
  s_or_b32 s28, s28, s22
  s_cmp_eq_u32 s28, 4294914144
  s_cbranch_scc1 ch_wx2_ok
  s_mov_b32 s30, 0
ch_wr2:
  buffer_load_dword v9, off, s[12:15], 0 offset:132 sc1
  s_waitcnt vmcnt(0)
  v_cmp_ne_u32 vcc, 1, v9
  s_cbranch_vccz ch_wr2_ok
  s_sleep 8
  s_add_u32 s30, s30, 1
  s_cmp_lt_u32 s30, 400000
  s_cbranch_scc1 ch_wr2
  s_branch cA_abort
ch_wr2_ok:
  s_lshl_b32 s27, s17, 7
  s_add_u32 s27, s27, 88521216
  s_mov_b32 s28, 12384
  s_mov_b32 s30, 0
ch_wb2:
  buffer_load_dword v9, off, s[8:11], s27  sc1
  s_waitcnt vmcnt(0)
  v_and_b32 v10, s28, v9
  v_cmp_ne_u32 vcc, s28, v10
  s_cbranch_vccz ch_wb2_ok
  s_sleep 3
  s_add_u32 s30, s30, 1
  s_cmp_lt_u32 s30, 400000
  s_cbranch_scc1 ch_wb2
  s_branch cA_abort
ch_wb2_ok:
  s_mov_b32 s29, 88523264
  s_mov_b32 s28, 0xffff
  s_mov_b32 s30, 0
ch_wx2:
  buffer_load_dword v9, off, s[8:11], s29  sc1
  s_waitcnt vmcnt(0)
  v_and_b32 v10, s28, v9
  v_cmp_ne_u32 vcc, s28, v10
  s_cbranch_vccz ch_wx2_ok
  s_sleep 8
  s_add_u32 s30, s30, 1
  s_cmp_lt_u32 s30, 400000
  s_cbranch_scc1 ch_wx2
  s_branch cA_abort
ch_wx2_ok:
  s_add_u32 s22, s31, 286720
  buffer_load_dwordx4 a[224:227], v2, s[8:11], s22 offen offset:0 sc1
  buffer_load_dwordx4 a[228:231], v2, s[8:11], s22 offen offset:1024 sc1
  buffer_load_dwordx4 a[232:235], v2, s[8:11], s22 offen offset:2048 sc1
  buffer_load_dwordx4 a[236:239], v2, s[8:11], s22 offen offset:3072 sc1
  s_add_u32 s22, s31, 290816
  buffer_load_dwordx4 a[240:243], v2, s[8:11], s22 offen offset:0 sc1
  buffer_load_dwordx4 a[244:247], v2, s[8:11], s22 offen offset:1024 sc1
  buffer_load_dwordx4 a[248:251], v2, s[8:11], s22 offen offset:2048 sc1
  buffer_load_dwordx4 a[252:255], v2, s[8:11], s22 offen offset:3072 sc1
  s_add_u32 s22, s31, 294912
  buffer_load_dwordx4 v[120:123], v2, s[8:11], s22 offen offset:0 sc1
  buffer_load_dwordx4 v[124:127], v2, s[8:11], s22 offen offset:1024 sc1
  buffer_load_dwordx4 v[128:131], v2, s[8:11], s22 offen offset:2048 sc1
  buffer_load_dwordx4 v[132:135], v2, s[8:11], s22 offen offset:3072 sc1
  s_add_u32 s22, s31, 299008
  buffer_load_dwordx4 v[136:139], v2, s[8:11], s22 offen offset:0 sc1
  buffer_load_dwordx4 v[140:143], v2, s[8:11], s22 offen offset:1024 sc1
  buffer_load_dwordx4 v[144:147], v2, s[8:11], s22 offen offset:2048 sc1
  buffer_load_dwordx4 v[148:151], v2, s[8:11], s22 offen offset:3072 sc1
  s_add_u32 s22, s31, 303104
  buffer_load_dwordx4 v[152:155], v2, s[8:11], s22 offen offset:0 sc1
  buffer_load_dwordx4 v[156:159], v2, s[8:11], s22 offen offset:1024 sc1
  buffer_load_dwordx4 v[160:163], v2, s[8:11], s22 offen offset:2048 sc1
  buffer_load_dwordx4 v[164:167], v2, s[8:11], s22 offen offset:3072 sc1
  s_add_u32 s22, s31, 307200
  buffer_load_dwordx4 v[168:171], v2, s[8:11], s22 offen offset:0 sc1
  buffer_load_dwordx4 v[172:175], v2, s[8:11], s22 offen offset:1024 sc1
  buffer_load_dwordx4 v[176:179], v2, s[8:11], s22 offen offset:2048 sc1
  buffer_load_dwordx4 v[180:183], v2, s[8:11], s22 offen offset:3072 sc1
  s_mov_b32 s24, 72028160
  s_mov_b32 s26, 72042496
  v_and_b32 v64, 7, v117
  v_and_b32 v65, 1, v116
  v_lshlrev_b32 v65, 2, v65
  v_sub_u32 v64, v64, v65
  v_lshrrev_b32 v65, 3, v117
  v_lshl_add_u32 v66, v65, 2, v64
  v_cmp_gt_u32 vcc, 4, v64
  v_mov_b32 v67, 99
  s_nop 0
  v_cndmask_b32 v66, v67, v66, vcc
  v_mov_b32 v68, 0x3f80
  v_mov_b32 v69, 0x3f800000
  v_mov_b32 v4, 0
  v_cmp_eq_u32 vcc, 0, v66
  s_nop 1
  v_cndmask_b32 v4, v4, v68, vcc
  v_cmp_eq_u32 vcc, 1, v66
  s_nop 1
  v_cndmask_b32 v4, v4, v69, vcc
  v_mov_b32 v5, 0
  v_cmp_eq_u32 vcc, 2, v66
  s_nop 1
  v_cndmask_b32 v5, v5, v68, vcc
  v_cmp_eq_u32 vcc, 3, v66
  s_nop 1
  v_cndmask_b32 v5, v5, v69, vcc
  v_mov_b32 v6, 0
  v_cmp_eq_u32 vcc, 4, v66
  s_nop 1
  v_cndmask_b32 v6, v6, v68, vcc
  v_cmp_eq_u32 vcc, 5, v66
  s_nop 1
  v_cndmask_b32 v6, v6, v69, vcc
  v_mov_b32 v7, 0
  v_cmp_eq_u32 vcc, 6, v66
  s_nop 1
  v_cndmask_b32 v7, v7, v68, vcc
  v_cmp_eq_u32 vcc, 7, v66
  s_nop 1
  v_cndmask_b32 v7, v7, v69, vcc
  v_lshrrev_b32 v64, 1, v116
  v_lshrrev_b32 v65, 3, v117
  v_and_b32 v66, 1, v116
  v_and_b32 v68, 7, v117
  v_lshlrev_b32 v67, 8, v65
  v_lshl_add_u32 v67, v68, 5, v67
  v_lshl_add_u32 v67, v66, 4, v67
  v_add_u32 v69, 5184, v67
  v_add_u32 v70, 6400, v67
  v_cmp_eq_u32 vcc, v64, v65
  s_nop 1
  v_cndmask_b32 v113, v70, v69, vcc
  s_lshl_b32 s22, s17, 9
  s_add_u32 s22, s22, 9216
  v_lshl_add_u32 v114, v1, 3, s22
  s_lshr_b32 s22, s17, 1
  s_lshl_b32 s22, s22, 8
  s_and_b32 s27, s17, 1
  s_lshl_b32 s27, s27, 3
  s_add_u32 s22, s22, s27
  s_add_u32 s22, s22, 7168
  v_add_u32 v115, s22, v2
  v_mov_b32 v70, 0x40000000
  v_cmp_gt_u32 vcc, 16, v1
  s_nop 1
  v_cndmask_b32 v115, v70, v115, vcc
  v_mov_b32 v118, -1
  v_mov_b32 v119, -1
  v_and_b32 v0, 15, v1
  s_and_b32 s22, s17, 0
  s_lshl_b32 s22, s22, 7
  s_add_u32 s22, s22, 75731456
  v_lshl_add_u32 v0, v0, 2, s22
  v_xor_b32 v69, 256, v2
  v_mul_i32_i24 v70, -2048, v66
  v_add_u32 v69, v69, v70
  v_add_u32 v117, 8192, v69
  v_mov_b32 v116, v73
  s_mul_i32 s35, s17, 28672
  s_add_u32 s35, s35, 44040192
  v_mov_b32 v36, 0
  v_mov_b32 v37, 0
  v_mov_b32 v38, 0
  v_mov_b32 v39, 0
  v_mov_b32 v40, 0
  v_mov_b32 v41, 0
  v_mov_b32 v42, 0
  v_mov_b32 v43, 0
  v_mov_b32 v44, 0
  v_mov_b32 v45, 0
  v_mov_b32 v46, 0
  v_mov_b32 v47, 0
  v_mov_b32 v48, 0
  v_mov_b32 v49, 0
  v_mov_b32 v50, 0
  v_mov_b32 v51, 0
  v_mov_b32 v52, 0
  v_mov_b32 v53, 0
  v_mov_b32 v54, 0
  v_mov_b32 v55, 0
  v_mov_b32 v56, 0
  v_mov_b32 v57, 0
  v_mov_b32 v58, 0
  v_mov_b32 v59, 0
  v_mov_b32 v60, 0
  v_mov_b32 v61, 0
  v_mov_b32 v62, 0
  v_mov_b32 v63, 0
  v_mov_b32 v64, 0
  v_mov_b32 v65, 0
  v_mov_b32 v66, 0
  v_mov_b32 v67, 0
  v_mov_b32 v68, 0
  v_mov_b32 v69, 0
  v_mov_b32 v70, 0
  v_mov_b32 v71, 0
  v_mov_b32 v72, 0
  v_mov_b32 v73, 0
  v_mov_b32 v74, 0
  v_mov_b32 v75, 0
  v_mov_b32 v76, 0
  v_mov_b32 v77, 0
  v_mov_b32 v78, 0
  v_mov_b32 v79, 0
  s_mov_b32 s22, 75694080
  v_lshrrev_b32 v14, 4, v2
  v_add_u32 v14, 128, v14
  v_min_u32 v14, 308, v14
  v_lshlrev_b32 v14, 7, v14
  buffer_load_dword v15, v14, s[8:11], s22 offen sc1
  buffer_load_dwordx4 v[80:83], v117, s[8:11], s24 offen offset:0 sc1
  buffer_load_dwordx4 v[84:87], v117, s[8:11], s24 offen offset:1024 sc1
  buffer_load_dwordx4 v[88:91], v117, s[8:11], s26 offen offset:0 sc1
  buffer_load_dwordx4 v[92:95], v117, s[8:11], s26 offen offset:1024 sc1
  buffer_load_dwordx4 v[96:99], v2, s[8:11], s24 offen offset:0 sc1
  buffer_load_dwordx4 v[100:103], v2, s[8:11], s24 offen offset:1024 sc1
  buffer_load_dwordx4 v[104:107], v2, s[8:11], s26 offen offset:0 sc1
  buffer_load_dwordx4 v[108:111], v2, s[8:11], s26 offen offset:1024 sc1
  s_add_u32 s22, s31, 311296
  buffer_load_dwordx4 v[184:187], v2, s[8:11], s22 offen offset:0 sc1
  buffer_load_dwordx4 v[188:191], v2, s[8:11], s22 offen offset:1024 sc1
  buffer_load_dwordx4 v[192:195], v2, s[8:11], s22 offen offset:2048 sc1
  buffer_load_dwordx4 v[196:199], v2, s[8:11], s22 offen offset:3072 sc1
  s_add_u32 s22, s31, 385024
  buffer_load_dwordx4 v[200:203], v2, s[8:11], s22 offen offset:2048 sc1
  buffer_load_dwordx4 v[204:207], v2, s[8:11], s22 offen offset:3072 sc1
  s_add_u32 s22, s31, 389120
  buffer_load_dwordx4 v[208:211], v2, s[8:11], s22 offen offset:0 sc1
  buffer_load_dwordx4 v[212:215], v2, s[8:11], s22 offen offset:1024 sc1
  buffer_load_dwordx4 v[216:219], v2, s[8:11], s22 offen offset:2048 sc1
  buffer_load_dwordx4 v[220:223], v2, s[8:11], s22 offen offset:3072 sc1
  s_add_u32 s22, s31, 393216
  buffer_load_dwordx4 v[224:227], v2, s[8:11], s22 offen offset:0 sc1
  buffer_load_dwordx4 v[228:231], v2, s[8:11], s22 offen offset:1024 sc1
  buffer_load_dwordx4 v[232:235], v2, s[8:11], s22 offen offset:2048 sc1
  buffer_load_dwordx4 v[236:239], v2, s[8:11], s22 offen offset:3072 sc1
  s_add_u32 s22, s31, 397312
  buffer_load_dwordx4 v[240:243], v2, s[8:11], s22 offen offset:0 sc1
  buffer_load_dwordx4 v[244:247], v2, s[8:11], s22 offen offset:1024 sc1
  buffer_load_dwordx4 v[248:251], v2, s[8:11], s22 offen offset:2048 sc1
  buffer_load_dwordx4 v[252:255], v2, s[8:11], s22 offen offset:3072 sc1
  s_waitcnt vmcnt(0) lgkmcnt(0)
  s_mov_b32 s31, 0
  s_cmp_lg_u32 s88, 0
  s_cbranch_scc1 cB_sc2_loop
  s_branch cA_sc2_loop
ch_init3:
  s_mul_i32 s31, s17, 401408
  s_add_u32 s31, s31, 0
  s_and_b32 s28, s84, 12384
  s_lshl_b32 s22, s85, 16
  s_or_b32 s28, s28, s22
  s_cmp_eq_u32 s28, 4294914144
  s_cbranch_scc1 ch_wx3_ok
  s_mov_b32 s30, 0
ch_wr3:
  buffer_load_dword v9, off, s[12:15], 0 offset:132 sc1
  s_waitcnt vmcnt(0)
  v_cmp_ne_u32 vcc, 1, v9
  s_cbranch_vccz ch_wr3_ok
  s_sleep 8
  s_add_u32 s30, s30, 1
  s_cmp_lt_u32 s30, 400000
  s_cbranch_scc1 ch_wr3
  s_branch cA_abort
ch_wr3_ok:
  s_lshl_b32 s27, s17, 7
  s_add_u32 s27, s27, 88521216
  s_mov_b32 s28, 12384
  s_mov_b32 s30, 0
ch_wb3:
  buffer_load_dword v9, off, s[8:11], s27  sc1
  s_waitcnt vmcnt(0)
  v_and_b32 v10, s28, v9
  v_cmp_ne_u32 vcc, s28, v10
  s_cbranch_vccz ch_wb3_ok
  s_sleep 3
  s_add_u32 s30, s30, 1
  s_cmp_lt_u32 s30, 400000
  s_cbranch_scc1 ch_wb3
  s_branch cA_abort
ch_wb3_ok:
  s_mov_b32 s29, 88523264
  s_mov_b32 s28, 0xffff
  s_mov_b32 s30, 0
ch_wx3:
  buffer_load_dword v9, off, s[8:11], s29  sc1
  s_waitcnt vmcnt(0)
  v_and_b32 v10, s28, v9
  v_cmp_ne_u32 vcc, s28, v10
  s_cbranch_vccz ch_wx3_ok
  s_sleep 8
  s_add_u32 s30, s30, 1
  s_cmp_lt_u32 s30, 400000
  s_cbranch_scc1 ch_wx3
  s_branch cA_abort
ch_wx3_ok:
  s_add_u32 s22, s31, 315392
  buffer_load_dwordx4 a[224:227], v2, s[8:11], s22 offen offset:0 sc1
  buffer_load_dwordx4 a[228:231], v2, s[8:11], s22 offen offset:1024 sc1
  buffer_load_dwordx4 a[232:235], v2, s[8:11], s22 offen offset:2048 sc1
  buffer_load_dwordx4 a[236:239], v2, s[8:11], s22 offen offset:3072 sc1
  s_add_u32 s22, s31, 319488
  buffer_load_dwordx4 a[240:243], v2, s[8:11], s22 offen offset:0 sc1
  buffer_load_dwordx4 a[244:247], v2, s[8:11], s22 offen offset:1024 sc1
  buffer_load_dwordx4 a[248:251], v2, s[8:11], s22 offen offset:2048 sc1
  buffer_load_dwordx4 a[252:255], v2, s[8:11], s22 offen offset:3072 sc1
  s_add_u32 s22, s31, 323584
  buffer_load_dwordx4 v[120:123], v2, s[8:11], s22 offen offset:0 sc1
  buffer_load_dwordx4 v[124:127], v2, s[8:11], s22 offen offset:1024 sc1
  buffer_load_dwordx4 v[128:131], v2, s[8:11], s22 offen offset:2048 sc1
  buffer_load_dwordx4 v[132:135], v2, s[8:11], s22 offen offset:3072 sc1
  s_add_u32 s22, s31, 327680
  buffer_load_dwordx4 v[136:139], v2, s[8:11], s22 offen offset:0 sc1
  buffer_load_dwordx4 v[140:143], v2, s[8:11], s22 offen offset:1024 sc1
  buffer_load_dwordx4 v[144:147], v2, s[8:11], s22 offen offset:2048 sc1
  buffer_load_dwordx4 v[148:151], v2, s[8:11], s22 offen offset:3072 sc1
  s_add_u32 s22, s31, 331776
  buffer_load_dwordx4 v[152:155], v2, s[8:11], s22 offen offset:0 sc1
  buffer_load_dwordx4 v[156:159], v2, s[8:11], s22 offen offset:1024 sc1
  buffer_load_dwordx4 v[160:163], v2, s[8:11], s22 offen offset:2048 sc1
  buffer_load_dwordx4 v[164:167], v2, s[8:11], s22 offen offset:3072 sc1
  s_add_u32 s22, s31, 335872
  buffer_load_dwordx4 v[168:171], v2, s[8:11], s22 offen offset:0 sc1
  buffer_load_dwordx4 v[172:175], v2, s[8:11], s22 offen offset:1024 sc1
  buffer_load_dwordx4 v[176:179], v2, s[8:11], s22 offen offset:2048 sc1
  buffer_load_dwordx4 v[180:183], v2, s[8:11], s22 offen offset:3072 sc1
  s_mov_b32 s24, 72030208
  s_mov_b32 s26, 72044544
  v_and_b32 v64, 7, v117
  v_and_b32 v65, 1, v116
  v_lshlrev_b32 v65, 2, v65
  v_sub_u32 v64, v64, v65
  v_lshrrev_b32 v65, 3, v117
  v_lshl_add_u32 v66, v65, 2, v64
  v_cmp_gt_u32 vcc, 4, v64
  v_mov_b32 v67, 99
  s_nop 0
  v_cndmask_b32 v66, v67, v66, vcc
  v_mov_b32 v68, 0x3f80
  v_mov_b32 v69, 0x3f800000
  v_mov_b32 v4, 0
  v_cmp_eq_u32 vcc, 0, v66
  s_nop 1
  v_cndmask_b32 v4, v4, v68, vcc
  v_cmp_eq_u32 vcc, 1, v66
  s_nop 1
  v_cndmask_b32 v4, v4, v69, vcc
  v_mov_b32 v5, 0
  v_cmp_eq_u32 vcc, 2, v66
  s_nop 1
  v_cndmask_b32 v5, v5, v68, vcc
  v_cmp_eq_u32 vcc, 3, v66
  s_nop 1
  v_cndmask_b32 v5, v5, v69, vcc
  v_mov_b32 v6, 0
  v_cmp_eq_u32 vcc, 4, v66
  s_nop 1
  v_cndmask_b32 v6, v6, v68, vcc
  v_cmp_eq_u32 vcc, 5, v66
  s_nop 1
  v_cndmask_b32 v6, v6, v69, vcc
  v_mov_b32 v7, 0
  v_cmp_eq_u32 vcc, 6, v66
  s_nop 1
  v_cndmask_b32 v7, v7, v68, vcc
  v_cmp_eq_u32 vcc, 7, v66
  s_nop 1
  v_cndmask_b32 v7, v7, v69, vcc
  v_lshrrev_b32 v64, 1, v116
  v_lshrrev_b32 v65, 3, v117
  v_and_b32 v66, 1, v116
  v_and_b32 v68, 7, v117
  v_lshlrev_b32 v67, 8, v65
  v_lshl_add_u32 v67, v68, 5, v67
  v_lshl_add_u32 v67, v66, 4, v67
  v_add_u32 v69, 5696, v67
  v_add_u32 v70, 6400, v67
  v_cmp_eq_u32 vcc, v64, v65
  s_nop 1
  v_cndmask_b32 v113, v70, v69, vcc
  v_and_b32 v0, 15, v1
  s_and_b32 s22, s17, 0
  s_lshl_b32 s22, s22, 7
  s_add_u32 s22, s22, 75731456
  v_lshl_add_u32 v0, v0, 2, s22
  v_xor_b32 v69, 256, v2
  v_mul_i32_i24 v70, 2048, v66
  v_add_u32 v69, v69, v70
  v_add_u32 v117, 4096, v69
  v_mov_b32 v116, v73
  s_mul_i32 s35, s17, 28672
  s_add_u32 s35, s35, 44040192
  v_mov_b32 v36, 0
  v_mov_b32 v37, 0
  v_mov_b32 v38, 0
  v_mov_b32 v39, 0
  v_mov_b32 v40, 0
  v_mov_b32 v41, 0
  v_mov_b32 v42, 0
  v_mov_b32 v43, 0
  v_mov_b32 v44, 0
  v_mov_b32 v45, 0
  v_mov_b32 v46, 0
  v_mov_b32 v47, 0
  v_mov_b32 v48, 0
  v_mov_b32 v49, 0
  v_mov_b32 v50, 0
  v_mov_b32 v51, 0
  v_mov_b32 v52, 0
  v_mov_b32 v53, 0
  v_mov_b32 v54, 0
  v_mov_b32 v55, 0
  v_mov_b32 v56, 0
  v_mov_b32 v57, 0
  v_mov_b32 v58, 0
  v_mov_b32 v59, 0
  v_mov_b32 v60, 0
  v_mov_b32 v61, 0
  v_mov_b32 v62, 0
  v_mov_b32 v63, 0
  v_mov_b32 v64, 0
  v_mov_b32 v65, 0
  v_mov_b32 v66, 0
  v_mov_b32 v67, 0
  v_mov_b32 v68, 0
  v_mov_b32 v69, 0
  v_mov_b32 v70, 0
  v_mov_b32 v71, 0
  v_mov_b32 v72, 0
  v_mov_b32 v73, 0
  v_mov_b32 v74, 0
  v_mov_b32 v75, 0
  v_mov_b32 v76, 0
  v_mov_b32 v77, 0
  v_mov_b32 v78, 0
  v_mov_b32 v79, 0
  s_mov_b32 s22, 75694080
  v_lshrrev_b32 v14, 4, v2
  v_add_u32 v14, 192, v14
  v_min_u32 v14, 308, v14
  v_lshlrev_b32 v14, 7, v14
  buffer_load_dword v15, v14, s[8:11], s22 offen sc1
  buffer_load_dwordx4 v[80:83], v117, s[8:11], s24 offen offset:0 sc1
  buffer_load_dwordx4 v[84:87], v117, s[8:11], s24 offen offset:1024 sc1
  buffer_load_dwordx4 v[88:91], v117, s[8:11], s26 offen offset:0 sc1
  buffer_load_dwordx4 v[92:95], v117, s[8:11], s26 offen offset:1024 sc1
  buffer_load_dwordx4 v[96:99], v2, s[8:11], s24 offen offset:0 sc1
  buffer_load_dwordx4 v[100:103], v2, s[8:11], s24 offen offset:1024 sc1
  buffer_load_dwordx4 v[104:107], v2, s[8:11], s26 offen offset:0 sc1
  buffer_load_dwordx4 v[108:111], v2, s[8:11], s26 offen offset:1024 sc1
  s_add_u32 s22, s31, 339968
  buffer_load_dwordx4 v[184:187], v2, s[8:11], s22 offen offset:0 sc1
  buffer_load_dwordx4 v[188:191], v2, s[8:11], s22 offen offset:1024 sc1
  buffer_load_dwordx4 v[192:195], v2, s[8:11], s22 offen offset:2048 sc1
  buffer_load_dwordx4 v[196:199], v2, s[8:11], s22 offen offset:3072 sc1
  s_add_u32 s22, s31, 356352
  buffer_load_dwordx4 v[200:203], v2, s[8:11], s22 offen offset:2048 sc1
  buffer_load_dwordx4 v[204:207], v2, s[8:11], s22 offen offset:3072 sc1
  s_add_u32 s22, s31, 360448
  buffer_load_dwordx4 v[208:211], v2, s[8:11], s22 offen offset:0 sc1
  buffer_load_dwordx4 v[212:215], v2, s[8:11], s22 offen offset:1024 sc1
  buffer_load_dwordx4 v[216:219], v2, s[8:11], s22 offen offset:2048 sc1
  buffer_load_dwordx4 v[220:223], v2, s[8:11], s22 offen offset:3072 sc1
  s_add_u32 s22, s31, 364544
  buffer_load_dwordx4 v[224:227], v2, s[8:11], s22 offen offset:0 sc1
  buffer_load_dwordx4 v[228:231], v2, s[8:11], s22 offen offset:1024 sc1
  buffer_load_dwordx4 v[232:235], v2, s[8:11], s22 offen offset:2048 sc1
  buffer_load_dwordx4 v[236:239], v2, s[8:11], s22 offen offset:3072 sc1
  s_add_u32 s22, s31, 368640
  buffer_load_dwordx4 v[240:243], v2, s[8:11], s22 offen offset:0 sc1
  buffer_load_dwordx4 v[244:247], v2, s[8:11], s22 offen offset:1024 sc1
  buffer_load_dwordx4 v[248:251], v2, s[8:11], s22 offen offset:2048 sc1
  buffer_load_dwordx4 v[252:255], v2, s[8:11], s22 offen offset:3072 sc1
  s_waitcnt vmcnt(0) lgkmcnt(0)
  s_mov_b32 s31, 0
  s_cmp_lg_u32 s88, 0
  s_cbranch_scc1 cB_sc3_loop
  s_branch cA_sc3_loop
ch_init4:
  v_mov_b32 v72, v116
  v_mov_b32 v73, v117
  v_lshrrev_b32 v65, 1, v72
  v_and_b32 v66, 1, v72
  v_mov_b32 v36, 0
  v_mov_b32 v37, 0
  v_mov_b32 v38, 0
  v_mov_b32 v39, 0
  v_mov_b32 v40, 0
  v_mov_b32 v41, 0
  v_mov_b32 v42, 0
  v_mov_b32 v43, 0
  v_mov_b32 v44, 0
  v_mov_b32 v45, 0
  v_mov_b32 v46, 0
  v_mov_b32 v47, 0
  v_mov_b32 v48, 0
  v_mov_b32 v49, 0
  v_mov_b32 v50, 0
  v_mov_b32 v51, 0
  v_mov_b32 v52, 0
  v_mov_b32 v53, 0
  v_mov_b32 v54, 0
  v_mov_b32 v55, 0
  v_mov_b32 v56, 0
  v_mov_b32 v57, 0
  v_mov_b32 v58, 0
  v_mov_b32 v59, 0
  v_mov_b32 v60, 0
  v_mov_b32 v61, 0
  v_mov_b32 v62, 0
  v_mov_b32 v63, 0
  v_lshlrev_b32 v75, 2, v65
  v_lshl_add_u32 v75, v66, 3, v75
  v_add_u32 v67, 0, v73
  v_mul_u32_u24 v68, 2341, v67
  v_lshrrev_b32 v68, 16, v68
  v_mul_u32_u24 v69, 28, v68
  v_sub_u32 v69, v67, v69
  v_lshrrev_b32 v70, 4, v69
  v_and_b32 v69, 15, v69
  v_lshlrev_b32 v71, 12, v70
  v_lshl_add_u32 v71, v68, 8, v71
  v_lshl_add_u32 v71, v69, 4, v71
  v_add_u32 v152, v71, v75
  v_add_u32 v67, 16, v73
  v_mul_u32_u24 v68, 2341, v67
  v_lshrrev_b32 v68, 16, v68
  v_mul_u32_u24 v69, 28, v68
  v_sub_u32 v69, v67, v69
  v_lshrrev_b32 v70, 4, v69
  v_and_b32 v69, 15, v69
  v_lshlrev_b32 v71, 12, v70
  v_lshl_add_u32 v71, v68, 8, v71
  v_lshl_add_u32 v71, v69, 4, v71
  v_add_u32 v153, v71, v75
  v_add_u32 v67, 32, v73
  v_mul_u32_u24 v68, 2341, v67
  v_lshrrev_b32 v68, 16, v68
  v_mul_u32_u24 v69, 28, v68
  v_sub_u32 v69, v67, v69
  v_lshrrev_b32 v70, 4, v69
  v_and_b32 v69, 15, v69
  v_lshlrev_b32 v71, 12, v70
  v_lshl_add_u32 v71, v68, 8, v71
  v_lshl_add_u32 v71, v69, 4, v71
  v_add_u32 v154, v71, v75
  v_add_u32 v67, 48, v73
  v_mul_u32_u24 v68, 2341, v67
  v_lshrrev_b32 v68, 16, v68
  v_mul_u32_u24 v69, 28, v68
  v_sub_u32 v69, v67, v69
  v_lshrrev_b32 v70, 4, v69
  v_and_b32 v69, 15, v69
  v_lshlrev_b32 v71, 12, v70
  v_lshl_add_u32 v71, v68, 8, v71
  v_lshl_add_u32 v71, v69, 4, v71
  v_add_u32 v155, v71, v75
  v_add_u32 v67, 64, v73
  v_mul_u32_u24 v68, 2341, v67
  v_lshrrev_b32 v68, 16, v68
  v_mul_u32_u24 v69, 28, v68
  v_sub_u32 v69, v67, v69
  v_lshrrev_b32 v70, 4, v69
  v_and_b32 v69, 15, v69
  v_lshlrev_b32 v71, 12, v70
  v_lshl_add_u32 v71, v68, 8, v71
  v_lshl_add_u32 v71, v69, 4, v71
  v_add_u32 v156, v71, v75
  v_add_u32 v67, 80, v73
  v_mul_u32_u24 v68, 2341, v67
  v_lshrrev_b32 v68, 16, v68
  v_mul_u32_u24 v69, 28, v68
  v_sub_u32 v69, v67, v69
  v_lshrrev_b32 v70, 4, v69
  v_and_b32 v69, 15, v69
  v_lshlrev_b32 v71, 12, v70
  v_lshl_add_u32 v71, v68, 8, v71
  v_lshl_add_u32 v71, v69, 4, v71
  v_add_u32 v157, v71, v75
  v_mov_b32 v74, 0x40000000
  v_mov_b32 v164, 0
  v_mov_b32 v76, 0
  v_mov_b32 v77, 0
  v_mov_b32 v78, 0
  v_mov_b32 v79, 0
  ds_write_b128 v2, v[76:79] offset:0
  ds_write_b128 v2, v[76:79] offset:1024
  ds_write_b128 v2, v[76:79] offset:2048
  ds_write_b128 v2, v[76:79] offset:3072
  s_and_b32 s22, s17, 0
  s_lshl_b32 s22, s22, 7
  s_add_u32 s22, s22, 75729408
  v_lshl_add_u32 v4, v73, 2, s22
  v_and_b32 v64, 1, v73
  v_mov_b32 v5, 0x05040100
  v_mov_b32 v65, 0x03020706
  v_cmp_eq_u32 vcc, 1, v64
  s_nop 1
  v_cndmask_b32 v5, v5, v65, vcc
  s_lshl_b32 s22, s17, 2
  s_add_u32 s22, s22, 75731456
  v_lshl_add_u32 v7, v1, 7, s22
  v_cmp_gt_u32 vcc, 1, v1
  s_nop 1
  v_cndmask_b32 v7, v74, v7, vcc
  v_mov_b32 v6, v2
  v_lshl_add_u32 v64, v66, 2, v64
  v_and_b32 v65, 2, v72
  v_add_u32 v64, v64, v65
  s_mul_i32 s22, s17, 16
  v_add_u32 v75, s22, v73
  v_lshrrev_b32 v68, 4, v75
  v_lshlrev_b32 v68, 8, v68
  v_bfe_u32 v69, v75, 1, 1
  v_lshl_add_u32 v68, v69, 7, v68
  v_lshl_add_u32 v68, v64, 4, v68
  v_and_b32 v69, 12, v75
  v_add_u32 v1, v68, v69
  s_mul_i32 s22, s17, 28672
  s_add_u32 s25, s22, 42205184
  s_and_b32 s27, s17, 0
  s_xor_b32 s22, s27, 0
  s_mul_i32 s80, s22, 7168
  s_lshl_b32 s22, s22, 11
  s_add_u32 s76, s22, 9216
  s_xor_b32 s22, s27, 1
  s_mul_i32 s81, s22, 7168
  s_lshl_b32 s22, s22, 11
  s_add_u32 s77, s22, 9216
  s_xor_b32 s22, s27, 2
  s_mul_i32 s82, s22, 7168
  s_lshl_b32 s22, s22, 11
  s_add_u32 s78, s22, 9216
  s_xor_b32 s22, s27, 3
  s_mul_i32 s83, s22, 7168
  s_lshl_b32 s22, s22, 11
  s_add_u32 s79, s22, 9216
  v_mov_b32 v162, -1
  s_mov_b32 s38, 0x40000000
  s_mul_i32 s31, s17, 401408
  s_add_u32 s31, s31, 6422528
  s_mov_b32 s30, 0
ch_wr4:
  buffer_load_dword v9, off, s[12:15], 0 offset:132 sc1
  s_waitcnt vmcnt(0)
  v_cmp_ne_u32 vcc, 1, v9
  s_cbranch_vccz ch_wr4_ok
  s_sleep 8
  s_add_u32 s30, s30, 1
  s_cmp_lt_u32 s30, 400000
  s_cbranch_scc1 ch_wr4
  s_branch cA_abort
ch_wr4_ok:
  s_mul_i32 s33, s17, 532480
  s_add_u32 s33, s33, 77377536
  v_mov_b32 v12, -1
  v_mov_b32 v13, -1
  v_mov_b32 v14, -1
  v_mov_b32 v15, -1
  s_add_u32 s22, s33, 0
  buffer_store_dwordx4 v[12:15], v2, s[8:11], s22 offen sc1
  s_add_u32 s22, s33, 2048
  buffer_store_dwordx4 v[12:15], v2, s[8:11], s22 offen sc1
  s_add_u32 s22, s33, 4096
  buffer_store_dwordx4 v[12:15], v2, s[8:11], s22 offen sc1
  s_add_u32 s22, s33, 6144
  buffer_store_dwordx4 v[12:15], v2, s[8:11], s22 offen sc1
  s_add_u32 s22, s33, 8192
  buffer_store_dwordx4 v[12:15], v2, s[8:11], s22 offen sc1
  s_add_u32 s22, s33, 10240
  buffer_store_dwordx4 v[12:15], v2, s[8:11], s22 offen sc1
  s_add_u32 s22, s33, 12288
  buffer_store_dwordx4 v[12:15], v2, s[8:11], s22 offen sc1
  s_add_u32 s22, s33, 14336
  buffer_store_dwordx4 v[12:15], v2, s[8:11], s22 offen sc1
  v_mov_b32 v16, 1
  v_mov_b32 v17, 1
  s_lshl_b32 s22, s17, 10
  s_add_u32 s22, s22, 88503264
  s_waitcnt vmcnt(0)
  s_mov_b64 exec, 3
  buffer_store_dwordx2 v[16:17], v2, s[8:11], s22 offen sc1
  s_mov_b64 exec, -1
  s_lshr_b32 s22, s17, 2
  s_lshl_b32 s28, 0x81, s22
  s_mul_i32 s27, s17, 12
  s_add_u32 s22, s27, 256
  s_lshr_b32 s22, s22, 6
  s_lshl_b32 s22, 0x81, s22
  s_or_b32 s28, s28, s22
  s_add_u32 s22, s27, 267
  s_lshr_b32 s22, s22, 6
  s_lshl_b32 s22, 0x81, s22
  s_or_b32 s28, s28, s22
  v_lshrrev_b32 v12, 8, v2
  v_lshlrev_b32 v12, 7, v12
  s_mov_b32 s27, 88519168
  s_mov_b32 s30, 0
ch_ww4:
  buffer_load_dword v9, v12, s[8:11], s27 offen sc1
  s_waitcnt vmcnt(0)
  v_and_b32 v10, s28, v9
  v_cmp_ne_u32 vcc, s28, v10
  s_cbranch_vccz ch_ww4_ok
  s_sleep 3
  s_add_u32 s30, s30, 1
  s_cmp_lt_u32 s30, 400000
  s_cbranch_scc1 ch_ww4
  s_branch cA_abort
ch_ww4_ok:
  s_add_u32 s22, s31, 0
  buffer_load_dwordx4 a[0:3], v2, s[8:11], s22 offen offset:0 sc1
  buffer_load_dwordx4 a[4:7], v2, s[8:11], s22 offen offset:1024 sc1
  buffer_load_dwordx4 a[8:11], v2, s[8:11], s22 offen offset:2048 sc1
  buffer_load_dwordx4 a[12:15], v2, s[8:11], s22 offen offset:3072 sc1
  s_add_u32 s22, s31, 4096
  buffer_load_dwordx4 a[16:19], v2, s[8:11], s22 offen offset:0 sc1
  buffer_load_dwordx4 a[20:23], v2, s[8:11], s22 offen offset:1024 sc1
  buffer_load_dwordx4 a[24:27], v2, s[8:11], s22 offen offset:2048 sc1
  buffer_load_dwordx4 a[28:31], v2, s[8:11], s22 offen offset:3072 sc1
  s_add_u32 s22, s31, 8192
  buffer_load_dwordx4 a[32:35], v2, s[8:11], s22 offen offset:0 sc1
  buffer_load_dwordx4 a[36:39], v2, s[8:11], s22 offen offset:1024 sc1
  buffer_load_dwordx4 a[40:43], v2, s[8:11], s22 offen offset:2048 sc1
  buffer_load_dwordx4 a[44:47], v2, s[8:11], s22 offen offset:3072 sc1
  s_add_u32 s22, s31, 12288
  buffer_load_dwordx4 a[48:51], v2, s[8:11], s22 offen offset:0 sc1
  buffer_load_dwordx4 a[52:55], v2, s[8:11], s22 offen offset:1024 sc1
  buffer_load_dwordx4 a[56:59], v2, s[8:11], s22 offen offset:2048 sc1
  buffer_load_dwordx4 a[60:63], v2, s[8:11], s22 offen offset:3072 sc1
  s_add_u32 s22, s31, 16384
  buffer_load_dwordx4 a[64:67], v2, s[8:11], s22 offen offset:0 sc1
  buffer_load_dwordx4 a[68:71], v2, s[8:11], s22 offen offset:1024 sc1
  buffer_load_dwordx4 a[72:75], v2, s[8:11], s22 offen offset:2048 sc1
  buffer_load_dwordx4 a[76:79], v2, s[8:11], s22 offen offset:3072 sc1
  s_add_u32 s22, s31, 20480
  buffer_load_dwordx4 a[80:83], v2, s[8:11], s22 offen offset:0 sc1
  buffer_load_dwordx4 a[84:87], v2, s[8:11], s22 offen offset:1024 sc1
  buffer_load_dwordx4 a[88:91], v2, s[8:11], s22 offen offset:2048 sc1
  buffer_load_dwordx4 a[92:95], v2, s[8:11], s22 offen offset:3072 sc1
  s_add_u32 s22, s31, 24576
  buffer_load_dwordx4 a[96:99], v2, s[8:11], s22 offen offset:0 sc1
  buffer_load_dwordx4 a[100:103], v2, s[8:11], s22 offen offset:1024 sc1
  buffer_load_dwordx4 a[104:107], v2, s[8:11], s22 offen offset:2048 sc1
  buffer_load_dwordx4 a[108:111], v2, s[8:11], s22 offen offset:3072 sc1
  s_add_u32 s22, s31, 28672
  buffer_load_dwordx4 a[112:115], v2, s[8:11], s22 offen offset:0 sc1
  buffer_load_dwordx4 a[116:119], v2, s[8:11], s22 offen offset:1024 sc1
  buffer_load_dwordx4 a[120:123], v2, s[8:11], s22 offen offset:2048 sc1
  buffer_load_dwordx4 a[124:127], v2, s[8:11], s22 offen offset:3072 sc1
  s_waitcnt vmcnt(24)
  s_add_u32 s22, s31, 32768
  buffer_load_dwordx4 a[128:131], v2, s[8:11], s22 offen offset:0 sc1
  buffer_load_dwordx4 a[132:135], v2, s[8:11], s22 offen offset:1024 sc1
  buffer_load_dwordx4 a[136:139], v2, s[8:11], s22 offen offset:2048 sc1
  buffer_load_dwordx4 a[140:143], v2, s[8:11], s22 offen offset:3072 sc1
  s_add_u32 s22, s31, 36864
  buffer_load_dwordx4 a[144:147], v2, s[8:11], s22 offen offset:0 sc1
  buffer_load_dwordx4 a[148:151], v2, s[8:11], s22 offen offset:1024 sc1
  buffer_load_dwordx4 a[152:155], v2, s[8:11], s22 offen offset:2048 sc1
  buffer_load_dwordx4 a[156:159], v2, s[8:11], s22 offen offset:3072 sc1
  s_add_u32 s22, s31, 40960
  buffer_load_dwordx4 a[160:163], v2, s[8:11], s22 offen offset:0 sc1
  buffer_load_dwordx4 a[164:167], v2, s[8:11], s22 offen offset:1024 sc1
  buffer_load_dwordx4 a[168:171], v2, s[8:11], s22 offen offset:2048 sc1
  buffer_load_dwordx4 a[172:175], v2, s[8:11], s22 offen offset:3072 sc1
  s_add_u32 s22, s31, 45056
  buffer_load_dwordx4 a[176:179], v2, s[8:11], s22 offen offset:0 sc1
  buffer_load_dwordx4 a[180:183], v2, s[8:11], s22 offen offset:1024 sc1
  buffer_load_dwordx4 a[184:187], v2, s[8:11], s22 offen offset:2048 sc1
  buffer_load_dwordx4 a[188:191], v2, s[8:11], s22 offen offset:3072 sc1
  s_add_u32 s22, s31, 49152
  buffer_load_dwordx4 a[192:195], v2, s[8:11], s22 offen offset:0 sc1
  buffer_load_dwordx4 a[196:199], v2, s[8:11], s22 offen offset:1024 sc1
  buffer_load_dwordx4 a[200:203], v2, s[8:11], s22 offen offset:2048 sc1
  buffer_load_dwordx4 a[204:207], v2, s[8:11], s22 offen offset:3072 sc1
  s_add_u32 s22, s31, 53248
  buffer_load_dwordx4 a[208:211], v2, s[8:11], s22 offen offset:0 sc1
  buffer_load_dwordx4 a[212:215], v2, s[8:11], s22 offen offset:1024 sc1
  buffer_load_dwordx4 a[216:219], v2, s[8:11], s22 offen offset:2048 sc1
  buffer_load_dwordx4 a[220:223], v2, s[8:11], s22 offen offset:3072 sc1
  s_add_u32 s22, s31, 57344
  buffer_load_dwordx4 a[224:227], v2, s[8:11], s22 offen offset:0 sc1
  buffer_load_dwordx4 a[228:231], v2, s[8:11], s22 offen offset:1024 sc1
  buffer_load_dwordx4 a[232:235], v2, s[8:11], s22 offen offset:2048 sc1
  buffer_load_dwordx4 a[236:239], v2, s[8:11], s22 offen offset:3072 sc1
  s_add_u32 s22, s31, 61440
  buffer_load_dwordx4 a[240:243], v2, s[8:11], s22 offen offset:0 sc1
  buffer_load_dwordx4 a[244:247], v2, s[8:11], s22 offen offset:1024 sc1
  buffer_load_dwordx4 a[248:251], v2, s[8:11], s22 offen offset:2048 sc1
  buffer_load_dwordx4 a[252:255], v2, s[8:11], s22 offen offset:3072 sc1
  s_waitcnt vmcnt(24)
  s_add_u32 s22, s31, 65536
  buffer_load_dwordx4 v[176:179], v2, s[8:11], s22 offen offset:0 sc1
  buffer_load_dwordx4 v[180:183], v2, s[8:11], s22 offen offset:1024 sc1
  buffer_load_dwordx4 v[184:187], v2, s[8:11], s22 offen offset:2048 sc1
  buffer_load_dwordx4 v[188:191], v2, s[8:11], s22 offen offset:3072 sc1
  s_add_u32 s22, s31, 69632
  buffer_load_dwordx4 v[192:195], v2, s[8:11], s22 offen offset:0 sc1
  buffer_load_dwordx4 v[196:199], v2, s[8:11], s22 offen offset:1024 sc1
  buffer_load_dwordx4 v[200:203], v2, s[8:11], s22 offen offset:2048 sc1
  buffer_load_dwordx4 v[204:207], v2, s[8:11], s22 offen offset:3072 sc1
  s_add_u32 s22, s31, 73728
  buffer_load_dwordx4 v[208:211], v2, s[8:11], s22 offen offset:0 sc1
  buffer_load_dwordx4 v[212:215], v2, s[8:11], s22 offen offset:1024 sc1
  buffer_load_dwordx4 v[216:219], v2, s[8:11], s22 offen offset:2048 sc1
  buffer_load_dwordx4 v[220:223], v2, s[8:11], s22 offen offset:3072 sc1
  s_add_u32 s22, s31, 77824
  buffer_load_dwordx4 v[224:227], v2, s[8:11], s22 offen offset:0 sc1
  buffer_load_dwordx4 v[228:231], v2, s[8:11], s22 offen offset:1024 sc1
  buffer_load_dwordx4 v[232:235], v2, s[8:11], s22 offen offset:2048 sc1
  buffer_load_dwordx4 v[236:239], v2, s[8:11], s22 offen offset:3072 sc1
  s_add_u32 s22, s31, 81920
  buffer_load_dwordx4 v[240:243], v2, s[8:11], s22 offen offset:0 sc1
  buffer_load_dwordx4 v[244:247], v2, s[8:11], s22 offen offset:1024 sc1
  buffer_load_dwordx4 v[248:251], v2, s[8:11], s22 offen offset:2048 sc1
  buffer_load_dwordx4 v[252:255], v2, s[8:11], s22 offen offset:3072 sc1
  s_mov_b32 m0, 16384
  s_add_u32 s22, s31, 86016
  buffer_load_dwordx4 v2, s[8:11], s22 offen offset:0 sc1 lds
  buffer_load_dwordx4 v2, s[8:11], s22 offen offset:1024 sc1 lds
  buffer_load_dwordx4 v2, s[8:11], s22 offen offset:2048 sc1 lds
  buffer_load_dwordx4 v2, s[8:11], s22 offen offset:3072 sc1 lds
  s_mov_b32 m0, 20480
  s_add_u32 s22, s31, 90112
  buffer_load_dwordx4 v2, s[8:11], s22 offen offset:0 sc1 lds
  buffer_load_dwordx4 v2, s[8:11], s22 offen offset:1024 sc1 lds
  buffer_load_dwordx4 v2, s[8:11], s22 offen offset:2048 sc1 lds
  buffer_load_dwordx4 v2, s[8:11], s22 offen offset:3072 sc1 lds
  s_mov_b32 m0, 24576
  s_add_u32 s22, s31, 94208
  buffer_load_dwordx4 v2, s[8:11], s22 offen offset:0 sc1 lds
  buffer_load_dwordx4 v2, s[8:11], s22 offen offset:1024 sc1 lds
  buffer_load_dwordx4 v2, s[8:11], s22 offen offset:2048 sc1 lds
  buffer_load_dwordx4 v2, s[8:11], s22 offen offset:3072 sc1 lds
  s_mov_b32 m0, 28672
  s_add_u32 s22, s31, 98304
  buffer_load_dwordx4 v2, s[8:11], s22 offen offset:0 sc1 lds
  buffer_load_dwordx4 v2, s[8:11], s22 offen offset:1024 sc1 lds
  s_mov_b32 s28, s35
  s_waitcnt vmcnt(0) lgkmcnt(0)
  s_mov_b32 s31, 0
  s_cmp_lg_u32 s88, 0
  s_cbranch_scc1 cB_va0_loop
  s_branch cA_va0_loop
ch_init5:
  v_mov_b32 v72, v116
  v_mov_b32 v73, v117
  v_lshrrev_b32 v65, 1, v72
  v_and_b32 v66, 1, v72
  v_mov_b32 v36, 0
  v_mov_b32 v37, 0
  v_mov_b32 v38, 0
  v_mov_b32 v39, 0
  v_mov_b32 v40, 0
  v_mov_b32 v41, 0
  v_mov_b32 v42, 0
  v_mov_b32 v43, 0
  v_mov_b32 v44, 0
  v_mov_b32 v45, 0
  v_mov_b32 v46, 0
  v_mov_b32 v47, 0
  v_mov_b32 v48, 0
  v_mov_b32 v49, 0
  v_mov_b32 v50, 0
  v_mov_b32 v51, 0
  v_mov_b32 v52, 0
  v_mov_b32 v53, 0
  v_mov_b32 v54, 0
  v_mov_b32 v55, 0
  v_mov_b32 v56, 0
  v_mov_b32 v57, 0
  v_mov_b32 v58, 0
  v_mov_b32 v59, 0
  v_mov_b32 v60, 0
  v_mov_b32 v61, 0
  v_mov_b32 v62, 0
  v_mov_b32 v63, 0
  v_lshlrev_b32 v75, 2, v65
  v_lshl_add_u32 v75, v66, 3, v75
  v_add_u32 v67, 112, v73
  v_mul_u32_u24 v68, 2341, v67
  v_lshrrev_b32 v68, 16, v68
  v_mul_u32_u24 v69, 28, v68
  v_sub_u32 v69, v67, v69
  v_lshrrev_b32 v70, 4, v69
  v_and_b32 v69, 15, v69
  v_lshlrev_b32 v71, 12, v70
  v_lshl_add_u32 v71, v68, 8, v71
  v_lshl_add_u32 v71, v69, 4, v71
  v_add_u32 v152, v71, v75
  v_add_u32 v67, 128, v73
  v_mul_u32_u24 v68, 2341, v67
  v_lshrrev_b32 v68, 16, v68
  v_mul_u32_u24 v69, 28, v68
  v_sub_u32 v69, v67, v69
  v_lshrrev_b32 v70, 4, v69
  v_and_b32 v69, 15, v69
  v_lshlrev_b32 v71, 12, v70
  v_lshl_add_u32 v71, v68, 8, v71
  v_lshl_add_u32 v71, v69, 4, v71
  v_add_u32 v153, v71, v75
  v_add_u32 v67, 144, v73
  v_mul_u32_u24 v68, 2341, v67
  v_lshrrev_b32 v68, 16, v68
  v_mul_u32_u24 v69, 28, v68
  v_sub_u32 v69, v67, v69
  v_lshrrev_b32 v70, 4, v69
  v_and_b32 v69, 15, v69
  v_lshlrev_b32 v71, 12, v70
  v_lshl_add_u32 v71, v68, 8, v71
  v_lshl_add_u32 v71, v69, 4, v71
  v_add_u32 v154, v71, v75
  v_add_u32 v67, 160, v73
  v_mul_u32_u24 v68, 2341, v67
  v_lshrrev_b32 v68, 16, v68
  v_mul_u32_u24 v69, 28, v68
  v_sub_u32 v69, v67, v69
  v_lshrrev_b32 v70, 4, v69
  v_and_b32 v69, 15, v69
  v_lshlrev_b32 v71, 12, v70
  v_lshl_add_u32 v71, v68, 8, v71
  v_lshl_add_u32 v71, v69, 4, v71
  v_add_u32 v155, v71, v75
  v_add_u32 v67, 176, v73
  v_mul_u32_u24 v68, 2341, v67
  v_lshrrev_b32 v68, 16, v68
  v_mul_u32_u24 v69, 28, v68
  v_sub_u32 v69, v67, v69
  v_lshrrev_b32 v70, 4, v69
  v_and_b32 v69, 15, v69
  v_lshlrev_b32 v71, 12, v70
  v_lshl_add_u32 v71, v68, 8, v71
  v_lshl_add_u32 v71, v69, 4, v71
  v_add_u32 v156, v71, v75
  v_add_u32 v67, 192, v73
  v_mul_u32_u24 v68, 2341, v67
  v_lshrrev_b32 v68, 16, v68
  v_mul_u32_u24 v69, 28, v68
  v_sub_u32 v69, v67, v69
  v_lshrrev_b32 v70, 4, v69
  v_and_b32 v69, 15, v69
  v_lshlrev_b32 v71, 12, v70
  v_lshl_add_u32 v71, v68, 8, v71
  v_lshl_add_u32 v71, v69, 4, v71
  v_add_u32 v157, v71, v75
  v_add_u32 v67, 208, v73
  v_mul_u32_u24 v68, 2341, v67
  v_lshrrev_b32 v68, 16, v68
  v_mul_u32_u24 v69, 28, v68
  v_sub_u32 v69, v67, v69
  v_lshrrev_b32 v70, 4, v69
  v_and_b32 v69, 15, v69
  v_lshlrev_b32 v71, 12, v70
  v_lshl_add_u32 v71, v68, 8, v71
  v_lshl_add_u32 v71, v69, 4, v71
  v_add_u32 v158, v71, v75
  v_mov_b32 v74, 0x40000000
  v_mov_b32 v164, 0
  v_add_u32 v0, 30720, v2
  v_mov_b32 v76, 0
  v_mov_b32 v77, 0
  v_mov_b32 v78, 0
  v_mov_b32 v79, 0
  ds_write_b128 v2, v[76:79] offset:4096
  ds_write_b128 v2, v[76:79] offset:5120
  ds_write_b128 v2, v[76:79] offset:6144
  ds_write_b128 v2, v[76:79] offset:7168
  s_and_b32 s22, s17, 0
  s_lshl_b32 s22, s22, 7
  s_add_u32 s22, s22, 75729408
  v_lshl_add_u32 v4, v73, 2, s22
  v_and_b32 v64, 1, v73
  v_mov_b32 v5, 0x05040100
  v_mov_b32 v65, 0x03020706
  v_cmp_eq_u32 vcc, 1, v64
  s_nop 1
  v_cndmask_b32 v5, v5, v65, vcc
  s_lshl_b32 s22, s17, 2
  s_add_u32 s22, s22, 75733504
  v_lshl_add_u32 v7, v1, 7, s22
  v_cmp_gt_u32 vcc, 1, v1
  s_nop 1
  v_cndmask_b32 v7, v74, v7, vcc
  v_min_u32 v65, 11, v73
  v_mad_u32_u24 v65, v72, 12, v65
  v_lshlrev_b32 v6, 4, v65
  v_add_u32 v6, 1024, v6
  v_lshl_add_u32 v64, v66, 2, v64
  v_and_b32 v65, 2, v72
  v_add_u32 v64, v64, v65
  s_mul_i32 s22, s17, 12
  s_add_u32 s22, s22, 256
  v_add_u32 v75, s22, v73
  v_lshrrev_b32 v68, 4, v75
  v_lshlrev_b32 v68, 8, v68
  v_bfe_u32 v69, v75, 1, 1
  v_lshl_add_u32 v68, v69, 7, v68
  v_lshl_add_u32 v68, v64, 4, v68
  v_and_b32 v69, 12, v75
  v_add_u32 v1, v68, v69
  v_cmp_gt_u32 vcc, 12, v73
  s_nop 1
  v_cndmask_b32 v1, v74, v1, vcc
  s_mul_i32 s22, s17, 28672
  s_add_u32 s25, s22, 42205184
  s_and_b32 s27, s17, 0
  s_xor_b32 s22, s27, 0
  s_mul_i32 s80, s22, 7168
  s_lshl_b32 s22, s22, 11
  s_add_u32 s76, s22, 9216
  s_xor_b32 s22, s27, 1
  s_mul_i32 s81, s22, 7168
  s_lshl_b32 s22, s22, 11
  s_add_u32 s77, s22, 9216
  s_xor_b32 s22, s27, 2
  s_mul_i32 s82, s22, 7168
  s_lshl_b32 s22, s22, 11
  s_add_u32 s78, s22, 9216
  s_xor_b32 s22, s27, 3
  s_mul_i32 s83, s22, 7168
  s_lshl_b32 s22, s22, 11
  s_add_u32 s79, s22, 9216
  v_mov_b32 v162, -1
  s_mov_b32 s38, 0x40000000
  s_mul_i32 s31, s17, 401408
  s_add_u32 s31, s31, 6522880
  s_mov_b32 s30, 0
ch_wr5:
  buffer_load_dword v9, off, s[12:15], 0 offset:132 sc1
  s_waitcnt vmcnt(0)
  v_cmp_ne_u32 vcc, 1, v9
  s_cbranch_vccz ch_wr5_ok
  s_sleep 8
  s_add_u32 s30, s30, 1
  s_cmp_lt_u32 s30, 400000
  s_cbranch_scc1 ch_wr5
  s_branch cA_abort
ch_wr5_ok:
  s_mul_i32 s33, s17, 532480
  s_add_u32 s33, s33, 77378560
  v_mov_b32 v12, -1
  v_mov_b32 v13, -1
  v_mov_b32 v14, -1
  v_mov_b32 v15, -1
  s_add_u32 s22, s33, 0
  buffer_store_dwordx4 v[12:15], v2, s[8:11], s22 offen sc1
  s_add_u32 s22, s33, 2048
  buffer_store_dwordx4 v[12:15], v2, s[8:11], s22 offen sc1
  s_add_u32 s22, s33, 4096
  buffer_store_dwordx4 v[12:15], v2, s[8:11], s22 offen sc1
  s_add_u32 s22, s33, 6144
  buffer_store_dwordx4 v[12:15], v2, s[8:11], s22 offen sc1
  s_add_u32 s22, s33, 8192
  buffer_store_dwordx4 v[12:15], v2, s[8:11], s22 offen sc1
  s_add_u32 s22, s33, 10240
  buffer_store_dwordx4 v[12:15], v2, s[8:11], s22 offen sc1
  s_add_u32 s22, s33, 12288
  buffer_store_dwordx4 v[12:15], v2, s[8:11], s22 offen sc1
  s_add_u32 s22, s33, 14336
  buffer_store_dwordx4 v[12:15], v2, s[8:11], s22 offen sc1
  v_mov_b32 v16, 1
  v_mov_b32 v17, 1
  s_lshl_b32 s22, s17, 10
  s_add_u32 s22, s22, 88503272
  s_waitcnt vmcnt(0)
  s_mov_b64 exec, 3
  buffer_store_dwordx2 v[16:17], v2, s[8:11], s22 offen sc1
  s_mov_b64 exec, -1
  s_lshr_b32 s22, s17, 2
  s_lshl_b32 s28, 0x81, s22
  s_mul_i32 s27, s17, 12
  s_add_u32 s22, s27, 256
  s_lshr_b32 s22, s22, 6
  s_lshl_b32 s22, 0x81, s22
  s_or_b32 s28, s28, s22
  s_add_u32 s22, s27, 267
  s_lshr_b32 s22, s22, 6
  s_lshl_b32 s22, 0x81, s22
  s_or_b32 s28, s28, s22
  v_lshrrev_b32 v12, 8, v2
  v_lshlrev_b32 v12, 7, v12
  s_mov_b32 s27, 88519680
  s_mov_b32 s30, 0
ch_ww5:
  buffer_load_dword v9, v12, s[8:11], s27 offen sc1
  s_waitcnt vmcnt(0)
  v_and_b32 v10, s28, v9
  v_cmp_ne_u32 vcc, s28, v10
  s_cbranch_vccz ch_ww5_ok
  s_sleep 3
  s_add_u32 s30, s30, 1
  s_cmp_lt_u32 s30, 400000
  s_cbranch_scc1 ch_ww5
  s_branch cA_abort
ch_ww5_ok:
  s_add_u32 s22, s31, 0
  buffer_load_dwordx4 a[0:3], v2, s[8:11], s22 offen offset:0 sc1
  buffer_load_dwordx4 a[4:7], v2, s[8:11], s22 offen offset:1024 sc1
  buffer_load_dwordx4 a[8:11], v2, s[8:11], s22 offen offset:2048 sc1
  buffer_load_dwordx4 a[12:15], v2, s[8:11], s22 offen offset:3072 sc1
  s_add_u32 s22, s31, 4096
  buffer_load_dwordx4 a[16:19], v2, s[8:11], s22 offen offset:0 sc1
  buffer_load_dwordx4 a[20:23], v2, s[8:11], s22 offen offset:1024 sc1
  buffer_load_dwordx4 a[24:27], v2, s[8:11], s22 offen offset:2048 sc1
  buffer_load_dwordx4 a[28:31], v2, s[8:11], s22 offen offset:3072 sc1
  s_add_u32 s22, s31, 8192
  buffer_load_dwordx4 a[32:35], v2, s[8:11], s22 offen offset:0 sc1
  buffer_load_dwordx4 a[36:39], v2, s[8:11], s22 offen offset:1024 sc1
  buffer_load_dwordx4 a[40:43], v2, s[8:11], s22 offen offset:2048 sc1
  buffer_load_dwordx4 a[44:47], v2, s[8:11], s22 offen offset:3072 sc1
  s_add_u32 s22, s31, 12288
  buffer_load_dwordx4 a[48:51], v2, s[8:11], s22 offen offset:0 sc1
  buffer_load_dwordx4 a[52:55], v2, s[8:11], s22 offen offset:1024 sc1
  buffer_load_dwordx4 a[56:59], v2, s[8:11], s22 offen offset:2048 sc1
  buffer_load_dwordx4 a[60:63], v2, s[8:11], s22 offen offset:3072 sc1
  s_add_u32 s22, s31, 16384
  buffer_load_dwordx4 a[64:67], v2, s[8:11], s22 offen offset:0 sc1
  buffer_load_dwordx4 a[68:71], v2, s[8:11], s22 offen offset:1024 sc1
  buffer_load_dwordx4 a[72:75], v2, s[8:11], s22 offen offset:2048 sc1
  buffer_load_dwordx4 a[76:79], v2, s[8:11], s22 offen offset:3072 sc1
  s_add_u32 s22, s31, 20480
  buffer_load_dwordx4 a[80:83], v2, s[8:11], s22 offen offset:0 sc1
  buffer_load_dwordx4 a[84:87], v2, s[8:11], s22 offen offset:1024 sc1
  buffer_load_dwordx4 a[88:91], v2, s[8:11], s22 offen offset:2048 sc1
  buffer_load_dwordx4 a[92:95], v2, s[8:11], s22 offen offset:3072 sc1
  s_add_u32 s22, s31, 24576
  buffer_load_dwordx4 a[96:99], v2, s[8:11], s22 offen offset:0 sc1
  buffer_load_dwordx4 a[100:103], v2, s[8:11], s22 offen offset:1024 sc1
  buffer_load_dwordx4 a[104:107], v2, s[8:11], s22 offen offset:2048 sc1
  buffer_load_dwordx4 a[108:111], v2, s[8:11], s22 offen offset:3072 sc1
  s_add_u32 s22, s31, 28672
  buffer_load_dwordx4 a[112:115], v2, s[8:11], s22 offen offset:0 sc1
  buffer_load_dwordx4 a[116:119], v2, s[8:11], s22 offen offset:1024 sc1
  buffer_load_dwordx4 a[120:123], v2, s[8:11], s22 offen offset:2048 sc1
  buffer_load_dwordx4 a[124:127], v2, s[8:11], s22 offen offset:3072 sc1
  s_waitcnt vmcnt(24)
  s_add_u32 s22, s31, 32768
  buffer_load_dwordx4 a[128:131], v2, s[8:11], s22 offen offset:0 sc1
  buffer_load_dwordx4 a[132:135], v2, s[8:11], s22 offen offset:1024 sc1
  buffer_load_dwordx4 a[136:139], v2, s[8:11], s22 offen offset:2048 sc1
  buffer_load_dwordx4 a[140:143], v2, s[8:11], s22 offen offset:3072 sc1
  s_add_u32 s22, s31, 36864
  buffer_load_dwordx4 a[144:147], v2, s[8:11], s22 offen offset:0 sc1
  buffer_load_dwordx4 a[148:151], v2, s[8:11], s22 offen offset:1024 sc1
  buffer_load_dwordx4 a[152:155], v2, s[8:11], s22 offen offset:2048 sc1
  buffer_load_dwordx4 a[156:159], v2, s[8:11], s22 offen offset:3072 sc1
  s_add_u32 s22, s31, 40960
  buffer_load_dwordx4 a[160:163], v2, s[8:11], s22 offen offset:0 sc1
  buffer_load_dwordx4 a[164:167], v2, s[8:11], s22 offen offset:1024 sc1
  buffer_load_dwordx4 a[168:171], v2, s[8:11], s22 offen offset:2048 sc1
  buffer_load_dwordx4 a[172:175], v2, s[8:11], s22 offen offset:3072 sc1
  s_add_u32 s22, s31, 45056
  buffer_load_dwordx4 a[176:179], v2, s[8:11], s22 offen offset:0 sc1
  buffer_load_dwordx4 a[180:183], v2, s[8:11], s22 offen offset:1024 sc1
  buffer_load_dwordx4 a[184:187], v2, s[8:11], s22 offen offset:2048 sc1
  buffer_load_dwordx4 a[188:191], v2, s[8:11], s22 offen offset:3072 sc1
  s_add_u32 s22, s31, 49152
  buffer_load_dwordx4 a[192:195], v2, s[8:11], s22 offen offset:0 sc1
  buffer_load_dwordx4 a[196:199], v2, s[8:11], s22 offen offset:1024 sc1
  buffer_load_dwordx4 a[200:203], v2, s[8:11], s22 offen offset:2048 sc1
  buffer_load_dwordx4 a[204:207], v2, s[8:11], s22 offen offset:3072 sc1
  s_add_u32 s22, s31, 53248
  buffer_load_dwordx4 a[208:211], v2, s[8:11], s22 offen offset:0 sc1
  buffer_load_dwordx4 a[212:215], v2, s[8:11], s22 offen offset:1024 sc1
  buffer_load_dwordx4 a[216:219], v2, s[8:11], s22 offen offset:2048 sc1
  buffer_load_dwordx4 a[220:223], v2, s[8:11], s22 offen offset:3072 sc1
  s_add_u32 s22, s31, 57344
  buffer_load_dwordx4 a[224:227], v2, s[8:11], s22 offen offset:0 sc1
  buffer_load_dwordx4 a[228:231], v2, s[8:11], s22 offen offset:1024 sc1
  buffer_load_dwordx4 a[232:235], v2, s[8:11], s22 offen offset:2048 sc1
  buffer_load_dwordx4 a[236:239], v2, s[8:11], s22 offen offset:3072 sc1
  s_add_u32 s22, s31, 61440
  buffer_load_dwordx4 a[240:243], v2, s[8:11], s22 offen offset:0 sc1
  buffer_load_dwordx4 a[244:247], v2, s[8:11], s22 offen offset:1024 sc1
  buffer_load_dwordx4 a[248:251], v2, s[8:11], s22 offen offset:2048 sc1
  buffer_load_dwordx4 a[252:255], v2, s[8:11], s22 offen offset:3072 sc1
  s_waitcnt vmcnt(24)
  s_add_u32 s22, s31, 65536
  buffer_load_dwordx4 v[176:179], v2, s[8:11], s22 offen offset:0 sc1
  buffer_load_dwordx4 v[180:183], v2, s[8:11], s22 offen offset:1024 sc1
  buffer_load_dwordx4 v[184:187], v2, s[8:11], s22 offen offset:2048 sc1
  buffer_load_dwordx4 v[188:191], v2, s[8:11], s22 offen offset:3072 sc1
  s_add_u32 s22, s31, 69632
  buffer_load_dwordx4 v[192:195], v2, s[8:11], s22 offen offset:0 sc1
  buffer_load_dwordx4 v[196:199], v2, s[8:11], s22 offen offset:1024 sc1
  buffer_load_dwordx4 v[200:203], v2, s[8:11], s22 offen offset:2048 sc1
  buffer_load_dwordx4 v[204:207], v2, s[8:11], s22 offen offset:3072 sc1
  s_add_u32 s22, s31, 73728
  buffer_load_dwordx4 v[208:211], v2, s[8:11], s22 offen offset:0 sc1
  buffer_load_dwordx4 v[212:215], v2, s[8:11], s22 offen offset:1024 sc1
  buffer_load_dwordx4 v[216:219], v2, s[8:11], s22 offen offset:2048 sc1
  buffer_load_dwordx4 v[220:223], v2, s[8:11], s22 offen offset:3072 sc1
  s_add_u32 s22, s31, 77824
  buffer_load_dwordx4 v[224:227], v2, s[8:11], s22 offen offset:0 sc1
  buffer_load_dwordx4 v[228:231], v2, s[8:11], s22 offen offset:1024 sc1
  buffer_load_dwordx4 v[232:235], v2, s[8:11], s22 offen offset:2048 sc1
  buffer_load_dwordx4 v[236:239], v2, s[8:11], s22 offen offset:3072 sc1
  s_add_u32 s22, s31, 81920
  buffer_load_dwordx4 v[240:243], v2, s[8:11], s22 offen offset:0 sc1
  buffer_load_dwordx4 v[244:247], v2, s[8:11], s22 offen offset:1024 sc1
  buffer_load_dwordx4 v[248:251], v2, s[8:11], s22 offen offset:2048 sc1
  buffer_load_dwordx4 v[252:255], v2, s[8:11], s22 offen offset:3072 sc1
  s_mov_b32 m0, 30720
  s_add_u32 s22, s31, 86016
  buffer_load_dwordx4 v2, s[8:11], s22 offen offset:0 sc1 lds
  buffer_load_dwordx4 v2, s[8:11], s22 offen offset:1024 sc1 lds
  buffer_load_dwordx4 v2, s[8:11], s22 offen offset:2048 sc1 lds
  buffer_load_dwordx4 v2, s[8:11], s22 offen offset:3072 sc1 lds
  s_mov_b32 m0, 34816
  s_add_u32 s22, s31, 90112
  buffer_load_dwordx4 v2, s[8:11], s22 offen offset:0 sc1 lds
  buffer_load_dwordx4 v2, s[8:11], s22 offen offset:1024 sc1 lds
  buffer_load_dwordx4 v2, s[8:11], s22 offen offset:2048 sc1 lds
  buffer_load_dwordx4 v2, s[8:11], s22 offen offset:3072 sc1 lds
  s_mov_b32 m0, 38912
  s_add_u32 s22, s31, 94208
  buffer_load_dwordx4 v2, s[8:11], s22 offen offset:0 sc1 lds
  buffer_load_dwordx4 v2, s[8:11], s22 offen offset:1024 sc1 lds
  buffer_load_dwordx4 v2, s[8:11], s22 offen offset:2048 sc1 lds
  buffer_load_dwordx4 v2, s[8:11], s22 offen offset:3072 sc1 lds
  s_mov_b32 m0, 43008
  s_add_u32 s22, s31, 98304
  buffer_load_dwordx4 v2, s[8:11], s22 offen offset:0 sc1 lds
  buffer_load_dwordx4 v2, s[8:11], s22 offen offset:1024 sc1 lds
  s_mov_b32 s28, s35
  s_waitcnt vmcnt(0) lgkmcnt(0)
  s_mov_b32 s31, 0
  s_cmp_lg_u32 s88, 0
  s_cbranch_scc1 cB_va1_loop
  s_branch cA_va1_loop
ch_init6:
  v_mov_b32 v72, v116
  v_mov_b32 v73, v117
  v_lshrrev_b32 v65, 1, v72
  v_and_b32 v66, 1, v72
  v_mov_b32 v36, 0
  v_mov_b32 v37, 0
  v_mov_b32 v38, 0
  v_mov_b32 v39, 0
  v_mov_b32 v40, 0
  v_mov_b32 v41, 0
  v_mov_b32 v42, 0
  v_mov_b32 v43, 0
  v_mov_b32 v44, 0
  v_mov_b32 v45, 0
  v_mov_b32 v46, 0
  v_mov_b32 v47, 0
  v_mov_b32 v48, 0
  v_mov_b32 v49, 0
  v_mov_b32 v50, 0
  v_mov_b32 v51, 0
  v_mov_b32 v52, 0
  v_mov_b32 v53, 0
  v_mov_b32 v54, 0
  v_mov_b32 v55, 0
  v_mov_b32 v56, 0
  v_mov_b32 v57, 0
  v_mov_b32 v58, 0
  v_mov_b32 v59, 0
  v_mov_b32 v60, 0
  v_mov_b32 v61, 0
  v_mov_b32 v62, 0
  v_mov_b32 v63, 0
  v_lshlrev_b32 v75, 2, v65
  v_lshl_add_u32 v75, v66, 3, v75
  v_add_u32 v67, 224, v73
  v_mul_u32_u24 v68, 2341, v67
  v_lshrrev_b32 v68, 16, v68
  v_mul_u32_u24 v69, 28, v68
  v_sub_u32 v69, v67, v69
  v_lshrrev_b32 v70, 4, v69
  v_and_b32 v69, 15, v69
  v_lshlrev_b32 v71, 12, v70
  v_lshl_add_u32 v71, v68, 8, v71
  v_lshl_add_u32 v71, v69, 4, v71
  v_add_u32 v104, v71, v75
  v_add_u32 v67, 240, v73
  v_mul_u32_u24 v68, 2341, v67
  v_lshrrev_b32 v68, 16, v68
  v_mul_u32_u24 v69, 28, v68
  v_sub_u32 v69, v67, v69
  v_lshrrev_b32 v70, 4, v69
  v_and_b32 v69, 15, v69
  v_lshlrev_b32 v71, 12, v70
  v_lshl_add_u32 v71, v68, 8, v71
  v_lshl_add_u32 v71, v69, 4, v71
  v_add_u32 v105, v71, v75
  v_add_u32 v67, 256, v73
  v_mul_u32_u24 v68, 2341, v67
  v_lshrrev_b32 v68, 16, v68
  v_mul_u32_u24 v69, 28, v68
  v_sub_u32 v69, v67, v69
  v_lshrrev_b32 v70, 4, v69
  v_and_b32 v69, 15, v69
  v_lshlrev_b32 v71, 12, v70
  v_lshl_add_u32 v71, v68, 8, v71
  v_lshl_add_u32 v71, v69, 4, v71
  v_add_u32 v106, v71, v75
  v_add_u32 v67, 272, v73
  v_mul_u32_u24 v68, 2341, v67
  v_lshrrev_b32 v68, 16, v68
  v_mul_u32_u24 v69, 28, v68
  v_sub_u32 v69, v67, v69
  v_lshrrev_b32 v70, 4, v69
  v_and_b32 v69, 15, v69
  v_lshlrev_b32 v71, 12, v70
  v_lshl_add_u32 v71, v68, 8, v71
  v_lshl_add_u32 v71, v69, 4, v71
  v_add_u32 v107, v71, v75
  v_add_u32 v67, 288, v73
  v_mul_u32_u24 v68, 2341, v67
  v_lshrrev_b32 v68, 16, v68
  v_mul_u32_u24 v69, 28, v68
  v_sub_u32 v69, v67, v69
  v_lshrrev_b32 v70, 4, v69
  v_and_b32 v69, 15, v69
  v_lshlrev_b32 v71, 12, v70
  v_lshl_add_u32 v71, v68, 8, v71
  v_lshl_add_u32 v71, v69, 4, v71
  v_add_u32 v108, v71, v75
  v_add_u32 v67, 304, v73
  v_mul_u32_u24 v68, 2341, v67
  v_lshrrev_b32 v68, 16, v68
  v_mul_u32_u24 v69, 28, v68
  v_sub_u32 v69, v67, v69
  v_lshrrev_b32 v70, 4, v69
  v_and_b32 v69, 15, v69
  v_lshlrev_b32 v71, 12, v70
  v_lshl_add_u32 v71, v68, 8, v71
  v_lshl_add_u32 v71, v69, 4, v71
  v_add_u32 v109, v71, v75
  v_add_u32 v67, 320, v73
  v_mul_u32_u24 v68, 2341, v67
  v_lshrrev_b32 v68, 16, v68
  v_mul_u32_u24 v69, 28, v68
  v_sub_u32 v69, v67, v69
  v_lshrrev_b32 v70, 4, v69
  v_and_b32 v69, 15, v69
  v_lshlrev_b32 v71, 12, v70
  v_lshl_add_u32 v71, v68, 8, v71
  v_lshl_add_u32 v71, v69, 4, v71
  v_add_u32 v110, v71, v75
  v_add_u32 v67, 96, v73
  v_mul_u32_u24 v68, 2341, v67
  v_lshrrev_b32 v68, 16, v68
  v_mul_u32_u24 v69, 28, v68
  v_sub_u32 v69, v67, v69
  v_lshrrev_b32 v70, 4, v69
  v_and_b32 v69, 15, v69
  v_lshlrev_b32 v71, 12, v70
  v_lshl_add_u32 v71, v68, 8, v71
  v_lshl_add_u32 v71, v69, 4, v71
  v_add_u32 v111, v71, v75
  v_mov_b32 v74, 0x40000000
  v_mov_b32 v96, 0
  v_add_u32 v0, 16384, v2
  v_and_b32 v119, 15, v1
  s_and_b32 s22, s17, 0
  s_lshl_b32 s22, s22, 7
  s_add_u32 s22, s22, 75733504
  v_lshl_add_u32 v119, v119, 2, s22
  s_lshl_b32 s22, s17, 2
  s_add_u32 s22, s22, 75731456
  v_lshl_add_u32 v118, v1, 7, s22
  v_cmp_gt_u32 vcc, 1, v1
  s_nop 1
  v_cndmask_b32 v118, v74, v118, vcc
  s_lshl_b32 s35, s17, 7
  s_add_u32 s35, s35, 88461312
  v_mov_b32 v64, 0
  v_mov_b32 v65, 0
  v_mov_b32 v66, 0
  v_mov_b32 v67, 0
  v_min_u32 v116, 13, v1
  s_mul_i32 s22, s17, 14
  v_add_u32 v116, s22, v116
  v_lshlrev_b32 v116, 7, v116
  s_mul_i32 s31, s17, 401408
  s_add_u32 s31, s31, 6623232
  s_mov_b32 s30, 0
ch_wr6:
  buffer_load_dword v9, off, s[12:15], 0 offset:132 sc1
  s_waitcnt vmcnt(0)
  v_cmp_ne_u32 vcc, 1, v9
  s_cbranch_vccz ch_wr6_ok
  s_sleep 8
  s_add_u32 s30, s30, 1
  s_cmp_lt_u32 s30, 400000
  s_cbranch_scc1 ch_wr6
  s_branch cA_abort
ch_wr6_ok:
  s_lshr_b32 s22, s17, 2
  s_lshl_b32 s28, 0x81, s22
  s_mul_i32 s27, s17, 12
  s_add_u32 s22, s27, 256
  s_lshr_b32 s22, s22, 6
  s_lshl_b32 s22, 0x81, s22
  s_or_b32 s28, s28, s22
  s_add_u32 s22, s27, 267
  s_lshr_b32 s22, s22, 6
  s_lshl_b32 s22, 0x81, s22
  s_or_b32 s28, s28, s22
  v_lshrrev_b32 v12, 8, v2
  v_lshlrev_b32 v12, 7, v12
  s_mov_b32 s27, 88520192
  s_mov_b32 s30, 0
ch_ww6:
  buffer_load_dword v9, v12, s[8:11], s27 offen sc1
  s_waitcnt vmcnt(0)
  v_and_b32 v10, s28, v9
  v_cmp_ne_u32 vcc, s28, v10
  s_cbranch_vccz ch_ww6_ok
  s_sleep 3
  s_add_u32 s30, s30, 1
  s_cmp_lt_u32 s30, 400000
  s_cbranch_scc1 ch_ww6
  s_branch cA_abort
ch_ww6_ok:
  s_add_u32 s22, s31, 0
  buffer_load_dwordx4 a[0:3], v2, s[8:11], s22 offen offset:0 sc1
  buffer_load_dwordx4 a[4:7], v2, s[8:11], s22 offen offset:1024 sc1
  buffer_load_dwordx4 a[8:11], v2, s[8:11], s22 offen offset:2048 sc1
  buffer_load_dwordx4 a[12:15], v2, s[8:11], s22 offen offset:3072 sc1
  s_add_u32 s22, s31, 4096
  buffer_load_dwordx4 a[16:19], v2, s[8:11], s22 offen offset:0 sc1
  buffer_load_dwordx4 a[20:23], v2, s[8:11], s22 offen offset:1024 sc1
  buffer_load_dwordx4 a[24:27], v2, s[8:11], s22 offen offset:2048 sc1
  buffer_load_dwordx4 a[28:31], v2, s[8:11], s22 offen offset:3072 sc1
  s_add_u32 s22, s31, 8192
  buffer_load_dwordx4 a[32:35], v2, s[8:11], s22 offen offset:0 sc1
  buffer_load_dwordx4 a[36:39], v2, s[8:11], s22 offen offset:1024 sc1
  buffer_load_dwordx4 a[40:43], v2, s[8:11], s22 offen offset:2048 sc1
  buffer_load_dwordx4 a[44:47], v2, s[8:11], s22 offen offset:3072 sc1
  s_add_u32 s22, s31, 12288
  buffer_load_dwordx4 a[48:51], v2, s[8:11], s22 offen offset:0 sc1
  buffer_load_dwordx4 a[52:55], v2, s[8:11], s22 offen offset:1024 sc1
  buffer_load_dwordx4 a[56:59], v2, s[8:11], s22 offen offset:2048 sc1
  buffer_load_dwordx4 a[60:63], v2, s[8:11], s22 offen offset:3072 sc1
  s_add_u32 s22, s31, 16384
  buffer_load_dwordx4 a[64:67], v2, s[8:11], s22 offen offset:0 sc1
  buffer_load_dwordx4 a[68:71], v2, s[8:11], s22 offen offset:1024 sc1
  buffer_load_dwordx4 a[72:75], v2, s[8:11], s22 offen offset:2048 sc1
  buffer_load_dwordx4 a[76:79], v2, s[8:11], s22 offen offset:3072 sc1
  s_add_u32 s22, s31, 20480
  buffer_load_dwordx4 a[80:83], v2, s[8:11], s22 offen offset:0 sc1
  buffer_load_dwordx4 a[84:87], v2, s[8:11], s22 offen offset:1024 sc1
  buffer_load_dwordx4 a[88:91], v2, s[8:11], s22 offen offset:2048 sc1
  buffer_load_dwordx4 a[92:95], v2, s[8:11], s22 offen offset:3072 sc1
  s_add_u32 s22, s31, 24576
  buffer_load_dwordx4 a[96:99], v2, s[8:11], s22 offen offset:0 sc1
  buffer_load_dwordx4 a[100:103], v2, s[8:11], s22 offen offset:1024 sc1
  buffer_load_dwordx4 a[104:107], v2, s[8:11], s22 offen offset:2048 sc1
  buffer_load_dwordx4 a[108:111], v2, s[8:11], s22 offen offset:3072 sc1
  s_add_u32 s22, s31, 28672
  buffer_load_dwordx4 a[112:115], v2, s[8:11], s22 offen offset:0 sc1
  buffer_load_dwordx4 a[116:119], v2, s[8:11], s22 offen offset:1024 sc1
  buffer_load_dwordx4 a[120:123], v2, s[8:11], s22 offen offset:2048 sc1
  buffer_load_dwordx4 a[124:127], v2, s[8:11], s22 offen offset:3072 sc1
  s_waitcnt vmcnt(24)
  s_add_u32 s22, s31, 32768
  buffer_load_dwordx4 a[128:131], v2, s[8:11], s22 offen offset:0 sc1
  buffer_load_dwordx4 a[132:135], v2, s[8:11], s22 offen offset:1024 sc1
  buffer_load_dwordx4 a[136:139], v2, s[8:11], s22 offen offset:2048 sc1
  buffer_load_dwordx4 a[140:143], v2, s[8:11], s22 offen offset:3072 sc1
  s_add_u32 s22, s31, 36864
  buffer_load_dwordx4 a[144:147], v2, s[8:11], s22 offen offset:0 sc1
  buffer_load_dwordx4 a[148:151], v2, s[8:11], s22 offen offset:1024 sc1
  buffer_load_dwordx4 a[152:155], v2, s[8:11], s22 offen offset:2048 sc1
  buffer_load_dwordx4 a[156:159], v2, s[8:11], s22 offen offset:3072 sc1
  s_add_u32 s22, s31, 40960
  buffer_load_dwordx4 a[160:163], v2, s[8:11], s22 offen offset:0 sc1
  buffer_load_dwordx4 a[164:167], v2, s[8:11], s22 offen offset:1024 sc1
  buffer_load_dwordx4 a[168:171], v2, s[8:11], s22 offen offset:2048 sc1
  buffer_load_dwordx4 a[172:175], v2, s[8:11], s22 offen offset:3072 sc1
  s_add_u32 s22, s31, 45056
  buffer_load_dwordx4 a[176:179], v2, s[8:11], s22 offen offset:0 sc1
  buffer_load_dwordx4 a[180:183], v2, s[8:11], s22 offen offset:1024 sc1
  buffer_load_dwordx4 a[184:187], v2, s[8:11], s22 offen offset:2048 sc1
  buffer_load_dwordx4 a[188:191], v2, s[8:11], s22 offen offset:3072 sc1
  s_add_u32 s22, s31, 49152
  buffer_load_dwordx4 a[192:195], v2, s[8:11], s22 offen offset:0 sc1
  buffer_load_dwordx4 a[196:199], v2, s[8:11], s22 offen offset:1024 sc1
  buffer_load_dwordx4 a[200:203], v2, s[8:11], s22 offen offset:2048 sc1
  buffer_load_dwordx4 a[204:207], v2, s[8:11], s22 offen offset:3072 sc1
  s_add_u32 s22, s31, 53248
  buffer_load_dwordx4 a[208:211], v2, s[8:11], s22 offen offset:0 sc1
  buffer_load_dwordx4 a[212:215], v2, s[8:11], s22 offen offset:1024 sc1
  buffer_load_dwordx4 a[216:219], v2, s[8:11], s22 offen offset:2048 sc1
  buffer_load_dwordx4 a[220:223], v2, s[8:11], s22 offen offset:3072 sc1
  s_add_u32 s22, s31, 57344
  buffer_load_dwordx4 a[224:227], v2, s[8:11], s22 offen offset:0 sc1
  buffer_load_dwordx4 a[228:231], v2, s[8:11], s22 offen offset:1024 sc1
  buffer_load_dwordx4 a[232:235], v2, s[8:11], s22 offen offset:2048 sc1
  buffer_load_dwordx4 a[236:239], v2, s[8:11], s22 offen offset:3072 sc1
  s_add_u32 s22, s31, 61440
  buffer_load_dwordx4 a[240:243], v2, s[8:11], s22 offen offset:0 sc1
  buffer_load_dwordx4 a[244:247], v2, s[8:11], s22 offen offset:1024 sc1
  buffer_load_dwordx4 a[248:251], v2, s[8:11], s22 offen offset:2048 sc1
  buffer_load_dwordx4 a[252:255], v2, s[8:11], s22 offen offset:3072 sc1
  s_waitcnt vmcnt(24)
  s_add_u32 s22, s31, 65536
  buffer_load_dwordx4 v[120:123], v2, s[8:11], s22 offen offset:0 sc1
  buffer_load_dwordx4 v[124:127], v2, s[8:11], s22 offen offset:1024 sc1
  buffer_load_dwordx4 v[128:131], v2, s[8:11], s22 offen offset:2048 sc1
  buffer_load_dwordx4 v[132:135], v2, s[8:11], s22 offen offset:3072 sc1
  s_add_u32 s22, s31, 69632
  buffer_load_dwordx4 v[136:139], v2, s[8:11], s22 offen offset:0 sc1
  buffer_load_dwordx4 v[140:143], v2, s[8:11], s22 offen offset:1024 sc1
  buffer_load_dwordx4 v[144:147], v2, s[8:11], s22 offen offset:2048 sc1
  buffer_load_dwordx4 v[148:151], v2, s[8:11], s22 offen offset:3072 sc1
  s_add_u32 s22, s31, 73728
  buffer_load_dwordx4 v[152:155], v2, s[8:11], s22 offen offset:0 sc1
  buffer_load_dwordx4 v[156:159], v2, s[8:11], s22 offen offset:1024 sc1
  buffer_load_dwordx4 v[160:163], v2, s[8:11], s22 offen offset:2048 sc1
  buffer_load_dwordx4 v[164:167], v2, s[8:11], s22 offen offset:3072 sc1
  s_add_u32 s22, s31, 77824
  buffer_load_dwordx4 v[168:171], v2, s[8:11], s22 offen offset:0 sc1
  buffer_load_dwordx4 v[172:175], v2, s[8:11], s22 offen offset:1024 sc1
  buffer_load_dwordx4 v[176:179], v2, s[8:11], s22 offen offset:2048 sc1
  buffer_load_dwordx4 v[180:183], v2, s[8:11], s22 offen offset:3072 sc1
  s_add_u32 s22, s31, 81920
  buffer_load_dwordx4 v[184:187], v2, s[8:11], s22 offen offset:0 sc1
  buffer_load_dwordx4 v[188:191], v2, s[8:11], s22 offen offset:1024 sc1
  buffer_load_dwordx4 v[192:195], v2, s[8:11], s22 offen offset:2048 sc1
  buffer_load_dwordx4 v[196:199], v2, s[8:11], s22 offen offset:3072 sc1
  s_add_u32 s22, s31, 86016
  buffer_load_dwordx4 v[200:203], v2, s[8:11], s22 offen offset:0 sc1
  buffer_load_dwordx4 v[204:207], v2, s[8:11], s22 offen offset:1024 sc1
  buffer_load_dwordx4 v[208:211], v2, s[8:11], s22 offen offset:2048 sc1
  buffer_load_dwordx4 v[212:215], v2, s[8:11], s22 offen offset:3072 sc1
  s_add_u32 s22, s31, 90112
  buffer_load_dwordx4 v[216:219], v2, s[8:11], s22 offen offset:0 sc1
  buffer_load_dwordx4 v[220:223], v2, s[8:11], s22 offen offset:1024 sc1
  buffer_load_dwordx4 v[224:227], v2, s[8:11], s22 offen offset:2048 sc1
  buffer_load_dwordx4 v[228:231], v2, s[8:11], s22 offen offset:3072 sc1
  s_add_u32 s22, s31, 94208
  buffer_load_dwordx4 v[232:235], v2, s[8:11], s22 offen offset:0 sc1
  buffer_load_dwordx4 v[236:239], v2, s[8:11], s22 offen offset:1024 sc1
  buffer_load_dwordx4 v[240:243], v2, s[8:11], s22 offen offset:2048 sc1
  buffer_load_dwordx4 v[244:247], v2, s[8:11], s22 offen offset:3072 sc1
  s_waitcnt vmcnt(24)
  s_add_u32 s22, s31, 98304
  buffer_load_dwordx4 v[248:251], v2, s[8:11], s22 offen offset:0 sc1
  buffer_load_dwordx4 v[252:255], v2, s[8:11], s22 offen offset:1024 sc1
  s_lshl_b32 s27, s17, 7
  s_add_u32 s27, s27, 88461312
  s_mov_b32 s30, 0
ch_vw2:
  buffer_load_dword v9, off, s[8:11], s27 sc1
  s_waitcnt vmcnt(0)
  v_cmp_ne_u32 vcc, 56, v9
  s_cbranch_vccz ch_vw2_d
  s_sleep 2
  s_add_u32 s30, s30, 1
  s_cmp_lt_u32 s30, 400000
  s_cbranch_scc1 ch_vw2
  s_branch cA_abort
ch_vw2_d:
  s_mov_b32 s28, s35
  s_waitcnt vmcnt(0) lgkmcnt(0)
  s_mov_b32 s31, 0
  s_cmp_lg_u32 s88, 0
  s_cbranch_scc1 cB_va2_loop
  s_branch cA_va2_loop
ch_init7:
  v_mov_b32 v72, v116
  v_mov_b32 v73, v117
  v_lshrrev_b32 v65, 1, v72
  v_and_b32 v66, 1, v72
  v_mov_b32 v36, 0
  v_mov_b32 v37, 0
  v_mov_b32 v38, 0
  v_mov_b32 v39, 0
  v_mov_b32 v40, 0
  v_mov_b32 v41, 0
  v_mov_b32 v42, 0
  v_mov_b32 v43, 0
  v_mov_b32 v44, 0
  v_mov_b32 v45, 0
  v_mov_b32 v46, 0
  v_mov_b32 v47, 0
  v_mov_b32 v48, 0
  v_mov_b32 v49, 0
  v_mov_b32 v50, 0
  v_mov_b32 v51, 0
  v_mov_b32 v52, 0
  v_mov_b32 v53, 0
  v_mov_b32 v54, 0
  v_mov_b32 v55, 0
  v_mov_b32 v56, 0
  v_mov_b32 v57, 0
  v_mov_b32 v58, 0
  v_mov_b32 v59, 0
  v_mov_b32 v60, 0
  v_mov_b32 v61, 0
  v_mov_b32 v62, 0
  v_mov_b32 v63, 0
  v_lshlrev_b32 v75, 2, v65
  v_lshl_add_u32 v75, v66, 3, v75
  v_add_u32 v67, 336, v73
  v_mul_u32_u24 v68, 2341, v67
  v_lshrrev_b32 v68, 16, v68
  v_mul_u32_u24 v69, 28, v68
  v_sub_u32 v69, v67, v69
  v_lshrrev_b32 v70, 4, v69
  v_and_b32 v69, 15, v69
  v_lshlrev_b32 v71, 12, v70
  v_lshl_add_u32 v71, v68, 8, v71
  v_lshl_add_u32 v71, v69, 4, v71
  v_add_u32 v104, v71, v75
  v_add_u32 v67, 352, v73
  v_mul_u32_u24 v68, 2341, v67
  v_lshrrev_b32 v68, 16, v68
  v_mul_u32_u24 v69, 28, v68
  v_sub_u32 v69, v67, v69
  v_lshrrev_b32 v70, 4, v69
  v_and_b32 v69, 15, v69
  v_lshlrev_b32 v71, 12, v70
  v_lshl_add_u32 v71, v68, 8, v71
  v_lshl_add_u32 v71, v69, 4, v71
  v_add_u32 v105, v71, v75
  v_add_u32 v67, 368, v73
  v_mul_u32_u24 v68, 2341, v67
  v_lshrrev_b32 v68, 16, v68
  v_mul_u32_u24 v69, 28, v68
  v_sub_u32 v69, v67, v69
  v_lshrrev_b32 v70, 4, v69
  v_and_b32 v69, 15, v69
  v_lshlrev_b32 v71, 12, v70
  v_lshl_add_u32 v71, v68, 8, v71
  v_lshl_add_u32 v71, v69, 4, v71
  v_add_u32 v106, v71, v75
  v_add_u32 v67, 384, v73
  v_mul_u32_u24 v68, 2341, v67
  v_lshrrev_b32 v68, 16, v68
  v_mul_u32_u24 v69, 28, v68
  v_sub_u32 v69, v67, v69
  v_lshrrev_b32 v70, 4, v69
  v_and_b32 v69, 15, v69
  v_lshlrev_b32 v71, 12, v70
  v_lshl_add_u32 v71, v68, 8, v71
  v_lshl_add_u32 v71, v69, 4, v71
  v_add_u32 v107, v71, v75
  v_add_u32 v67, 400, v73
  v_mul_u32_u24 v68, 2341, v67
  v_lshrrev_b32 v68, 16, v68
  v_mul_u32_u24 v69, 28, v68
  v_sub_u32 v69, v67, v69
  v_lshrrev_b32 v70, 4, v69
  v_and_b32 v69, 15, v69
  v_lshlrev_b32 v71, 12, v70
  v_lshl_add_u32 v71, v68, 8, v71
  v_lshl_add_u32 v71, v69, 4, v71
  v_add_u32 v108, v71, v75
  v_add_u32 v67, 416, v73
  v_mul_u32_u24 v68, 2341, v67
  v_lshrrev_b32 v68, 16, v68
  v_mul_u32_u24 v69, 28, v68
  v_sub_u32 v69, v67, v69
  v_lshrrev_b32 v70, 4, v69
  v_and_b32 v69, 15, v69
  v_lshlrev_b32 v71, 12, v70
  v_lshl_add_u32 v71, v68, 8, v71
  v_lshl_add_u32 v71, v69, 4, v71
  v_add_u32 v109, v71, v75
  v_add_u32 v67, 432, v73
  v_mul_u32_u24 v68, 2341, v67
  v_lshrrev_b32 v68, 16, v68
  v_mul_u32_u24 v69, 28, v68
  v_sub_u32 v69, v67, v69
  v_lshrrev_b32 v70, 4, v69
  v_and_b32 v69, 15, v69
  v_lshlrev_b32 v71, 12, v70
  v_lshl_add_u32 v71, v68, 8, v71
  v_lshl_add_u32 v71, v69, 4, v71
  v_add_u32 v110, v71, v75
  v_mov_b32 v74, 0x40000000
  v_mov_b32 v96, 0
  v_and_b32 v119, 15, v1
  s_and_b32 s22, s17, 0
  s_lshl_b32 s22, s22, 7
  s_add_u32 s22, s22, 75733504
  v_lshl_add_u32 v119, v119, 2, s22
  s_lshl_b32 s22, s17, 2
  s_add_u32 s22, s22, 75731456
  v_lshl_add_u32 v118, v1, 7, s22
  v_cmp_gt_u32 vcc, 1, v1
  s_nop 1
  v_cndmask_b32 v118, v74, v118, vcc
  s_lshl_b32 s35, s17, 7
  s_add_u32 s35, s35, 88461312
  v_mov_b32 v64, 0
  v_mov_b32 v65, 0
  v_mov_b32 v66, 0
  v_mov_b32 v67, 0
  v_min_u32 v116, 13, v1
  s_mul_i32 s22, s17, 14
  v_add_u32 v116, s22, v116
  v_lshlrev_b32 v116, 7, v116
  s_mul_i32 s31, s17, 401408
  s_add_u32 s31, s31, 6723584
  s_mov_b32 s30, 0
ch_wr7:
  buffer_load_dword v9, off, s[12:15], 0 offset:132 sc1
  s_waitcnt vmcnt(0)
  v_cmp_ne_u32 vcc, 1, v9
  s_cbranch_vccz ch_wr7_ok
  s_sleep 8
  s_add_u32 s30, s30, 1
  s_cmp_lt_u32 s30, 400000
  s_cbranch_scc1 ch_wr7
  s_branch cA_abort
ch_wr7_ok:
  s_lshr_b32 s22, s17, 2
  s_lshl_b32 s28, 0x81, s22
  s_mul_i32 s27, s17, 12
  s_add_u32 s22, s27, 256
  s_lshr_b32 s22, s22, 6
  s_lshl_b32 s22, 0x81, s22
  s_or_b32 s28, s28, s22
  s_add_u32 s22, s27, 267
  s_lshr_b32 s22, s22, 6
  s_lshl_b32 s22, 0x81, s22
  s_or_b32 s28, s28, s22
  v_lshrrev_b32 v12, 8, v2
  v_lshlrev_b32 v12, 7, v12
  s_mov_b32 s27, 88520704
  s_mov_b32 s30, 0
ch_ww7:
  buffer_load_dword v9, v12, s[8:11], s27 offen sc1
  s_waitcnt vmcnt(0)
  v_and_b32 v10, s28, v9
  v_cmp_ne_u32 vcc, s28, v10
  s_cbranch_vccz ch_ww7_ok
  s_sleep 3
  s_add_u32 s30, s30, 1
  s_cmp_lt_u32 s30, 400000
  s_cbranch_scc1 ch_ww7
  s_branch cA_abort
ch_ww7_ok:
  s_add_u32 s22, s31, 0
  buffer_load_dwordx4 a[0:3], v2, s[8:11], s22 offen offset:0 sc1
  buffer_load_dwordx4 a[4:7], v2, s[8:11], s22 offen offset:1024 sc1
  buffer_load_dwordx4 a[8:11], v2, s[8:11], s22 offen offset:2048 sc1
  buffer_load_dwordx4 a[12:15], v2, s[8:11], s22 offen offset:3072 sc1
  s_add_u32 s22, s31, 4096
  buffer_load_dwordx4 a[16:19], v2, s[8:11], s22 offen offset:0 sc1
  buffer_load_dwordx4 a[20:23], v2, s[8:11], s22 offen offset:1024 sc1
  buffer_load_dwordx4 a[24:27], v2, s[8:11], s22 offen offset:2048 sc1
  buffer_load_dwordx4 a[28:31], v2, s[8:11], s22 offen offset:3072 sc1
  s_add_u32 s22, s31, 8192
  buffer_load_dwordx4 a[32:35], v2, s[8:11], s22 offen offset:0 sc1
  buffer_load_dwordx4 a[36:39], v2, s[8:11], s22 offen offset:1024 sc1
  buffer_load_dwordx4 a[40:43], v2, s[8:11], s22 offen offset:2048 sc1
  buffer_load_dwordx4 a[44:47], v2, s[8:11], s22 offen offset:3072 sc1
  s_add_u32 s22, s31, 12288
  buffer_load_dwordx4 a[48:51], v2, s[8:11], s22 offen offset:0 sc1
  buffer_load_dwordx4 a[52:55], v2, s[8:11], s22 offen offset:1024 sc1
  buffer_load_dwordx4 a[56:59], v2, s[8:11], s22 offen offset:2048 sc1
  buffer_load_dwordx4 a[60:63], v2, s[8:11], s22 offen offset:3072 sc1
  s_add_u32 s22, s31, 16384
  buffer_load_dwordx4 a[64:67], v2, s[8:11], s22 offen offset:0 sc1
  buffer_load_dwordx4 a[68:71], v2, s[8:11], s22 offen offset:1024 sc1
  buffer_load_dwordx4 a[72:75], v2, s[8:11], s22 offen offset:2048 sc1
  buffer_load_dwordx4 a[76:79], v2, s[8:11], s22 offen offset:3072 sc1
  s_add_u32 s22, s31, 20480
  buffer_load_dwordx4 a[80:83], v2, s[8:11], s22 offen offset:0 sc1
  buffer_load_dwordx4 a[84:87], v2, s[8:11], s22 offen offset:1024 sc1
  buffer_load_dwordx4 a[88:91], v2, s[8:11], s22 offen offset:2048 sc1
  buffer_load_dwordx4 a[92:95], v2, s[8:11], s22 offen offset:3072 sc1
  s_add_u32 s22, s31, 24576
  buffer_load_dwordx4 a[96:99], v2, s[8:11], s22 offen offset:0 sc1
  buffer_load_dwordx4 a[100:103], v2, s[8:11], s22 offen offset:1024 sc1
  buffer_load_dwordx4 a[104:107], v2, s[8:11], s22 offen offset:2048 sc1
  buffer_load_dwordx4 a[108:111], v2, s[8:11], s22 offen offset:3072 sc1
  s_add_u32 s22, s31, 28672
  buffer_load_dwordx4 a[112:115], v2, s[8:11], s22 offen offset:0 sc1
  buffer_load_dwordx4 a[116:119], v2, s[8:11], s22 offen offset:1024 sc1
  buffer_load_dwordx4 a[120:123], v2, s[8:11], s22 offen offset:2048 sc1
  buffer_load_dwordx4 a[124:127], v2, s[8:11], s22 offen offset:3072 sc1
  s_waitcnt vmcnt(24)
  s_add_u32 s22, s31, 32768
  buffer_load_dwordx4 a[128:131], v2, s[8:11], s22 offen offset:0 sc1
  buffer_load_dwordx4 a[132:135], v2, s[8:11], s22 offen offset:1024 sc1
  buffer_load_dwordx4 a[136:139], v2, s[8:11], s22 offen offset:2048 sc1
  buffer_load_dwordx4 a[140:143], v2, s[8:11], s22 offen offset:3072 sc1
  s_add_u32 s22, s31, 36864
  buffer_load_dwordx4 a[144:147], v2, s[8:11], s22 offen offset:0 sc1
  buffer_load_dwordx4 a[148:151], v2, s[8:11], s22 offen offset:1024 sc1
  buffer_load_dwordx4 a[152:155], v2, s[8:11], s22 offen offset:2048 sc1
  buffer_load_dwordx4 a[156:159], v2, s[8:11], s22 offen offset:3072 sc1
  s_add_u32 s22, s31, 40960
  buffer_load_dwordx4 a[160:163], v2, s[8:11], s22 offen offset:0 sc1
  buffer_load_dwordx4 a[164:167], v2, s[8:11], s22 offen offset:1024 sc1
  buffer_load_dwordx4 a[168:171], v2, s[8:11], s22 offen offset:2048 sc1
  buffer_load_dwordx4 a[172:175], v2, s[8:11], s22 offen offset:3072 sc1
  s_add_u32 s22, s31, 45056
  buffer_load_dwordx4 a[176:179], v2, s[8:11], s22 offen offset:0 sc1
  buffer_load_dwordx4 a[180:183], v2, s[8:11], s22 offen offset:1024 sc1
  buffer_load_dwordx4 a[184:187], v2, s[8:11], s22 offen offset:2048 sc1
  buffer_load_dwordx4 a[188:191], v2, s[8:11], s22 offen offset:3072 sc1
  s_add_u32 s22, s31, 49152
  buffer_load_dwordx4 a[192:195], v2, s[8:11], s22 offen offset:0 sc1
  buffer_load_dwordx4 a[196:199], v2, s[8:11], s22 offen offset:1024 sc1
  buffer_load_dwordx4 a[200:203], v2, s[8:11], s22 offen offset:2048 sc1
  buffer_load_dwordx4 a[204:207], v2, s[8:11], s22 offen offset:3072 sc1
  s_add_u32 s22, s31, 53248
  buffer_load_dwordx4 a[208:211], v2, s[8:11], s22 offen offset:0 sc1
  buffer_load_dwordx4 a[212:215], v2, s[8:11], s22 offen offset:1024 sc1
  buffer_load_dwordx4 a[216:219], v2, s[8:11], s22 offen offset:2048 sc1
  buffer_load_dwordx4 a[220:223], v2, s[8:11], s22 offen offset:3072 sc1
  s_add_u32 s22, s31, 57344
  buffer_load_dwordx4 a[224:227], v2, s[8:11], s22 offen offset:0 sc1
  buffer_load_dwordx4 a[228:231], v2, s[8:11], s22 offen offset:1024 sc1
  buffer_load_dwordx4 a[232:235], v2, s[8:11], s22 offen offset:2048 sc1
  buffer_load_dwordx4 a[236:239], v2, s[8:11], s22 offen offset:3072 sc1
  s_add_u32 s22, s31, 61440
  buffer_load_dwordx4 a[240:243], v2, s[8:11], s22 offen offset:0 sc1
  buffer_load_dwordx4 a[244:247], v2, s[8:11], s22 offen offset:1024 sc1
  buffer_load_dwordx4 a[248:251], v2, s[8:11], s22 offen offset:2048 sc1
  buffer_load_dwordx4 a[252:255], v2, s[8:11], s22 offen offset:3072 sc1
  s_waitcnt vmcnt(24)
  s_add_u32 s22, s31, 65536
  buffer_load_dwordx4 v[120:123], v2, s[8:11], s22 offen offset:0 sc1
  buffer_load_dwordx4 v[124:127], v2, s[8:11], s22 offen offset:1024 sc1
  buffer_load_dwordx4 v[128:131], v2, s[8:11], s22 offen offset:2048 sc1
  buffer_load_dwordx4 v[132:135], v2, s[8:11], s22 offen offset:3072 sc1
  s_add_u32 s22, s31, 69632
  buffer_load_dwordx4 v[136:139], v2, s[8:11], s22 offen offset:0 sc1
  buffer_load_dwordx4 v[140:143], v2, s[8:11], s22 offen offset:1024 sc1
  buffer_load_dwordx4 v[144:147], v2, s[8:11], s22 offen offset:2048 sc1
  buffer_load_dwordx4 v[148:151], v2, s[8:11], s22 offen offset:3072 sc1
  s_add_u32 s22, s31, 73728
  buffer_load_dwordx4 v[152:155], v2, s[8:11], s22 offen offset:0 sc1
  buffer_load_dwordx4 v[156:159], v2, s[8:11], s22 offen offset:1024 sc1
  buffer_load_dwordx4 v[160:163], v2, s[8:11], s22 offen offset:2048 sc1
  buffer_load_dwordx4 v[164:167], v2, s[8:11], s22 offen offset:3072 sc1
  s_add_u32 s22, s31, 77824
  buffer_load_dwordx4 v[168:171], v2, s[8:11], s22 offen offset:0 sc1
  buffer_load_dwordx4 v[172:175], v2, s[8:11], s22 offen offset:1024 sc1
  buffer_load_dwordx4 v[176:179], v2, s[8:11], s22 offen offset:2048 sc1
  buffer_load_dwordx4 v[180:183], v2, s[8:11], s22 offen offset:3072 sc1
  s_add_u32 s22, s31, 81920
  buffer_load_dwordx4 v[184:187], v2, s[8:11], s22 offen offset:0 sc1
  buffer_load_dwordx4 v[188:191], v2, s[8:11], s22 offen offset:1024 sc1
  buffer_load_dwordx4 v[192:195], v2, s[8:11], s22 offen offset:2048 sc1
  buffer_load_dwordx4 v[196:199], v2, s[8:11], s22 offen offset:3072 sc1
  s_add_u32 s22, s31, 86016
  buffer_load_dwordx4 v[200:203], v2, s[8:11], s22 offen offset:0 sc1
  buffer_load_dwordx4 v[204:207], v2, s[8:11], s22 offen offset:1024 sc1
  buffer_load_dwordx4 v[208:211], v2, s[8:11], s22 offen offset:2048 sc1
  buffer_load_dwordx4 v[212:215], v2, s[8:11], s22 offen offset:3072 sc1
  s_add_u32 s22, s31, 90112
  buffer_load_dwordx4 v[216:219], v2, s[8:11], s22 offen offset:0 sc1
  buffer_load_dwordx4 v[220:223], v2, s[8:11], s22 offen offset:1024 sc1
  buffer_load_dwordx4 v[224:227], v2, s[8:11], s22 offen offset:2048 sc1
  buffer_load_dwordx4 v[228:231], v2, s[8:11], s22 offen offset:3072 sc1
  s_add_u32 s22, s31, 94208
  buffer_load_dwordx4 v[232:235], v2, s[8:11], s22 offen offset:0 sc1
  buffer_load_dwordx4 v[236:239], v2, s[8:11], s22 offen offset:1024 sc1
  buffer_load_dwordx4 v[240:243], v2, s[8:11], s22 offen offset:2048 sc1
  buffer_load_dwordx4 v[244:247], v2, s[8:11], s22 offen offset:3072 sc1
  s_waitcnt vmcnt(24)
  s_add_u32 s22, s31, 98304
  buffer_load_dwordx4 v[248:251], v2, s[8:11], s22 offen offset:0 sc1
  buffer_load_dwordx4 v[252:255], v2, s[8:11], s22 offen offset:1024 sc1
  s_lshl_b32 s27, s17, 7
  s_add_u32 s27, s27, 88461312
  s_mov_b32 s30, 0
ch_vw3:
  buffer_load_dword v9, off, s[8:11], s27 sc1
  s_waitcnt vmcnt(0)
  v_cmp_ne_u32 vcc, 56, v9
  s_cbranch_vccz ch_vw3_d
  s_sleep 2
  s_add_u32 s30, s30, 1
  s_cmp_lt_u32 s30, 400000
  s_cbranch_scc1 ch_vw3
  s_branch cA_abort
ch_vw3_d:
  s_mov_b32 s28, s35
  s_mov_b32 s39, 72052736
  buffer_load_dword v100, v116, s[8:11], s39 offen sc1
  s_mov_b32 s39, 72081408
  s_waitcnt vmcnt(1) lgkmcnt(0)
  s_mov_b32 s31, 0
  s_cmp_lg_u32 s88, 0
  s_cbranch_scc1 cB_va3_loop
  s_branch cA_va3_loop
.p2align 6
cA_sc0_loop:
  s_mov_b32 s30, 0
  s_mov_b32 s62, 0
  s_setprio 3
  s_sleep 6
cA_sc0_fp_l:
  v_cmp_gt_u32 vcc, s19, v112
  buffer_load_dword v112, v0, s[8:11], 0 offen sc1
  s_cbranch_vccz cA_sc0_fp_d
  v_cmp_gt_u32 vcc, s19, v112
  buffer_load_dword v112, v0, s[8:11], 0 offen sc1
  s_cbranch_vccz cA_sc0_fp_d
  v_cmp_gt_u32 vcc, s19, v112
  buffer_load_dword v112, v0, s[8:11], 0 offen sc1
  s_cbranch_vccz cA_sc0_fp_d
  v_cmp_gt_u32 vcc, s19, v112
  buffer_load_dword v112, v0, s[8:11], 0 offen sc1
  s_cbranch_vccz cA_sc0_fp_d
  v_cmp_gt_u32 vcc, s19, v112
  buffer_load_dword v112, v0, s[8:11], 0 offen sc1
  s_cbranch_vccz cA_sc0_fp_d
  v_cmp_gt_u32 vcc, s19, v112
  buffer_load_dword v112, v0, s[8:11], 0 offen sc1
  s_cbranch_vccz cA_sc0_fp_d
  v_cmp_gt_u32 vcc, s19, v112
  buffer_load_dword v112, v0, s[8:11], 0 offen sc1
  s_cbranch_vccz cA_sc0_fp_d
  v_cmp_gt_u32 vcc, s19, v112
  buffer_load_dword v112, v0, s[8:11], 0 offen sc1
  s_cbranch_vccz cA_sc0_fp_d
  v_cmp_gt_u32 vcc, s19, v112
  buffer_load_dword v112, v0, s[8:11], 0 offen sc1
  s_cbranch_vccz cA_sc0_fp_d
  v_cmp_gt_u32 vcc, s19, v112
  buffer_load_dword v112, v0, s[8:11], 0 offen sc1
  s_cbranch_vccz cA_sc0_fp_d
  v_cmp_gt_u32 vcc, s19, v112
  buffer_load_dword v112, v0, s[8:11], 0 offen sc1
  s_cbranch_vccz cA_sc0_fp_d
  v_cmp_gt_u32 vcc, s19, v112
  buffer_load_dword v112, v0, s[8:11], 0 offen sc1
  s_cbranch_vccz cA_sc0_fp_d
  v_cmp_gt_u32 vcc, s19, v112
  buffer_load_dword v112, v0, s[8:11], 0 offen sc1
  s_cbranch_vccz cA_sc0_fp_d
  v_cmp_gt_u32 vcc, s19, v112
  buffer_load_dword v112, v0, s[8:11], 0 offen sc1
  s_cbranch_vccz cA_sc0_fp_d
  v_cmp_gt_u32 vcc, s19, v112
  buffer_load_dword v112, v0, s[8:11], 0 offen sc1
  s_cbranch_vccz cA_sc0_fp_d
  v_cmp_gt_u32 vcc, s19, v112
  buffer_load_dword v112, v0, s[8:11], 0 offen sc1
  s_cbranch_vccz cA_sc0_fp_d
  s_waitcnt vmcnt(24)
  s_add_u32 s30, s30, 1
  s_cmp_lt_u32 s30, 400000
  s_cbranch_scc1 cA_sc0_fp_l
  s_branch cA_abort
cA_sc0_fp_d:
  buffer_load_dwordx4 v[8:11], v2, s[8:11], s20 offen offset:0 sc1
  s_barrier
  s_setprio 2
  buffer_load_dwordx4 v[12:15], v2, s[8:11], s20 offen offset:1024 sc1
  s_setprio 1
  buffer_load_dwordx4 v[16:19], v2, s[8:11], s20 offen offset:2048 sc1
  s_setprio 0
  buffer_load_dwordx4 v[20:23], v2, s[8:11], s20 offen offset:3072 sc1
cA_sc0_go:
  s_waitcnt vmcnt(3)
  v_smfmac_f32_16x16x64_bf16 v[36:39], v[8:11], a[0:7], v3
  buffer_load_dwordx4 v[32:35], v2, s[8:11], s23 offen offset:0 sc1
  v_cmp_eq_u32 vcc, -1, v8
  v_smfmac_f32_16x16x64_bf16 v[40:43], v[8:11], a[56:63], v3
  v_smfmac_f32_16x16x64_bf16 v[44:47], v[8:11], a[112:119], v3
  buffer_load_dwordx4 v[24:27], v2, s[8:11], s23 offen offset:1024 sc1
  s_cbranch_vccnz cA_sc0_r0
  v_smfmac_f32_16x16x64_bf16 v[48:51], v[8:11], a[168:175], v3
  v_smfmac_f32_16x16x64_bf16 v[52:55], v[8:11], a[224:231], v3
  s_waitcnt vmcnt(4)
  v_cmp_eq_u32 vcc, -1, v12
  v_smfmac_f32_16x16x64_bf16 v[56:59], v[8:11], v[144:151], v3
  buffer_load_dwordx4 v[28:31], v2, s[8:11], s23 offen offset:2048 sc1
  v_smfmac_f32_16x16x64_bf16 v[60:63], v[8:11], v[200:207], v3
  s_cbranch_vccnz cA_sc0_r1
cA_sc0_c1:
  v_smfmac_f32_16x16x64_bf16 v[36:39], v[12:15], a[8:15], v3
  v_smfmac_f32_16x16x64_bf16 v[40:43], v[12:15], a[64:71], v3
  v_smfmac_f32_16x16x64_bf16 v[44:47], v[12:15], a[120:127], v3
  v_smfmac_f32_16x16x64_bf16 v[48:51], v[12:15], a[176:183], v3
  v_smfmac_f32_16x16x64_bf16 v[52:55], v[12:15], a[232:239], v3
  s_waitcnt vmcnt(4)
  v_cmp_eq_u32 vcc, -1, v16
  v_smfmac_f32_16x16x64_bf16 v[56:59], v[12:15], v[152:159], v3
  buffer_load_dwordx4 v[88:91], v117, s[8:11], s26 offen offset:0 sc1
  v_smfmac_f32_16x16x64_bf16 v[60:63], v[12:15], v[208:215], v3
  s_cbranch_vccnz cA_sc0_r2
cA_sc0_c2:
  v_smfmac_f32_16x16x64_bf16 v[36:39], v[16:19], a[16:23], v3
  v_smfmac_f32_16x16x64_bf16 v[40:43], v[16:19], a[72:79], v3
  v_smfmac_f32_16x16x64_bf16 v[44:47], v[16:19], a[128:135], v3
  buffer_load_dwordx4 v[92:95], v117, s[8:11], s26 offen offset:1024 sc1
  v_smfmac_f32_16x16x64_bf16 v[48:51], v[16:19], a[184:191], v3
  v_smfmac_f32_16x16x64_bf16 v[52:55], v[16:19], a[240:247], v3
  s_waitcnt vmcnt(5)
  v_cmp_eq_u32 vcc, -1, v20
  v_smfmac_f32_16x16x64_bf16 v[56:59], v[16:19], v[160:167], v3
  v_smfmac_f32_16x16x64_bf16 v[60:63], v[16:19], v[216:223], v3
  buffer_load_dwordx4 v[96:99], v2, s[8:11], s24 offen offset:0 sc1
  s_cbranch_vccnz cA_sc0_r3
cA_sc0_c3:
  v_smfmac_f32_16x16x64_bf16 v[36:39], v[20:23], a[24:31], v3
  v_smfmac_f32_16x16x64_bf16 v[40:43], v[20:23], a[80:87], v3
  s_waitcnt vmcnt(3)
  v_max3_u32 v66, v24, v27, v28
  v_smfmac_f32_16x16x64_bf16 v[44:47], v[20:23], a[136:143], v3
  v_max3_u32 v66, v66, v31, v32
  v_smfmac_f32_16x16x64_bf16 v[48:51], v[20:23], a[192:199], v3
  buffer_load_dwordx4 v[100:103], v2, s[8:11], s24 offen offset:1024 sc1
  v_max_u32 v66, v66, v35
  v_smfmac_f32_16x16x64_bf16 v[52:55], v[20:23], a[248:255], v3
  v_cmp_eq_u32 vcc, -1, v66
  v_smfmac_f32_16x16x64_bf16 v[56:59], v[20:23], v[168:175], v3
  v_smfmac_f32_16x16x64_bf16 v[60:63], v[20:23], v[224:231], v3
  s_cbranch_vccnz cA_sc0_r4
cA_sc0_c4:
  v_smfmac_f32_16x16x64_bf16 v[60:63], v[32:35], v[232:239], v3
  buffer_load_dwordx4 v[104:107], v2, s[8:11], s26 offen offset:0 sc1
  v_smfmac_f32_16x16x64_bf16 v[60:63], v[24:27], v[240:247], v3
  v_smfmac_f32_16x16x64_bf16 v[60:63], v[28:31], v[248:255], v3
  v_smfmac_f32_16x16x64_bf16 v[52:55], v[32:35], v[120:127], v3
  v_smfmac_f32_16x16x64_bf16 v[52:55], v[24:27], v[128:135], v3
  buffer_load_dwordx4 v[108:111], v2, s[8:11], s26 offen offset:1024 sc1
  v_smfmac_f32_16x16x64_bf16 v[52:55], v[28:31], v[136:143], v3
  v_cvt_pk_bf16_f32 v63, v62, v63
  v_smfmac_f32_16x16x64_bf16 v[56:59], v[32:35], v[176:183], v3
  v_cvt_pk_bf16_f32 v62, v60, v61
  v_smfmac_f32_16x16x64_bf16 v[56:59], v[24:27], v[184:191], v3
  v_mfma_f32_16x16x32_bf16 v[12:15], v[62:65], v[4:7], 0
  v_cvt_pk_bf16_f32 v55, v54, v55
  v_smfmac_f32_16x16x64_bf16 v[56:59], v[28:31], v[192:199], v3
  v_cvt_pk_bf16_f32 v54, v52, v53
  v_smfmac_f32_16x16x64_bf16 v[36:39], v[32:35], a[32:39], v3
  s_nop 1
  v_cvt_pk_bf16_f32 v76, v12, v13
  v_smfmac_f32_16x16x64_bf16 v[36:39], v[24:27], a[40:47], v3
  v_cvt_pk_bf16_f32 v77, v14, v15
  v_smfmac_f32_16x16x64_bf16 v[36:39], v[28:31], a[48:55], v3
  v_cvt_pk_bf16_f32 v56, v56, v57
  v_smfmac_f32_16x16x64_bf16 v[40:43], v[32:35], a[88:95], v3
  v_cvt_pk_bf16_f32 v57, v58, v59
  v_smfmac_f32_16x16x64_bf16 v[40:43], v[24:27], a[96:103], v3
  v_mfma_f32_16x16x32_bf16 v[16:19], v[54:57], v[4:7], 0
  v_cvt_pk_bf16_f32 v39, v38, v39
  v_smfmac_f32_16x16x64_bf16 v[40:43], v[28:31], a[104:111], v3
  v_cvt_pk_bf16_f32 v38, v36, v37
  v_smfmac_f32_16x16x64_bf16 v[44:47], v[32:35], a[144:151], v3
  s_nop 1
  v_cvt_pk_bf16_f32 v78, v16, v17
  v_smfmac_f32_16x16x64_bf16 v[44:47], v[24:27], a[152:159], v3
  v_cvt_pk_bf16_f32 v79, v18, v19
  v_smfmac_f32_16x16x64_bf16 v[44:47], v[28:31], a[160:167], v3
  v_cvt_pk_bf16_f32 v40, v40, v41
  v_smfmac_f32_16x16x64_bf16 v[48:51], v[32:35], a[200:207], v3
  v_cvt_pk_bf16_f32 v41, v42, v43
  v_smfmac_f32_16x16x64_bf16 v[48:51], v[24:27], a[208:215], v3
  v_smfmac_f32_16x16x64_bf16 v[48:51], v[28:31], a[216:223], v3
  s_waitcnt vmcnt(4)
  v_cvt_pk_bf16_f32 v47, v46, v47
  v_smfmac_f32_16x16x64_bf16 v[68:71], v[76:79], v[80:87], v3
  v_cvt_pk_bf16_f32 v46, v44, v45
  v_mfma_f32_16x16x32_bf16 v[12:15], v[38:41], v[4:7], 0
  s_nop 1
  v_cvt_pk_bf16_f32 v48, v48, v49
  v_cvt_pk_bf16_f32 v49, v50, v51
  s_nop 1
  v_mfma_f32_16x16x32_bf16 v[16:19], v[46:49], v[4:7], 0
  v_smfmac_f32_16x16x64_bf16 v[72:75], v[76:79], v[88:95], v3
  v_cvt_pk_bf16_f32 v20, v12, v13
  v_mfma_f32_16x16x32_bf16 v[52:55], v[30:33], v[76:79], 0
  s_waitcnt vmcnt(0)
  v_cvt_pk_bf16_f32 v21, v14, v15
  v_cvt_pk_bf16_f32 v22, v16, v17
  v_cvt_pk_bf16_f32 v23, v18, v19
  s_nop 1
  v_mfma_f32_16x16x32_bf16 v[52:55], v[8:11], v[20:23], v[52:55]
  v_smfmac_f32_16x16x64_bf16 v[68:71], v[20:23], v[96:103], v3
  v_smfmac_f32_16x16x64_bf16 v[72:75], v[20:23], v[104:111], v3
  s_nop 1
  ds_write_b128 v113, v[52:55]
  s_nop 1
  v_permlane32_swap_b32 v68, v70
  v_permlane32_swap_b32 v69, v71
  v_add_f32 v56, v68, v70
  v_add_f32 v58, v69, v71
  v_permlane32_swap_b32 v72, v74
  v_permlane32_swap_b32 v73, v75
  v_add_f32 v57, v72, v74
  v_add_f32 v59, v73, v75
  ds_write_b128 v2, v[56:59] offset:0
  v_cmp_u_f32 vcc, v57, v59
  v_mov_b32 v68, 0
  v_mov_b32 v69, 0
  v_mov_b32 v70, 0
  v_mov_b32 v71, 0
  s_cbranch_vccnz cA_sc0_retry
cA_sc0_cont:
  s_add_u32 s24, s24, 28672
  s_add_u32 s26, s26, 28672
  buffer_load_dwordx4 v[80:83], v117, s[8:11], s24 offen offset:0 sc1
  buffer_load_dwordx4 v[84:87], v117, s[8:11], s24 offen offset:1024 sc1
  v_mov_b32 v72, 0
  v_mov_b32 v73, 0
  v_mfma_f32_32x32x16_bf16 v[36:51], v[68:71], v[68:71], 0
  s_waitcnt lgkmcnt(0)
  s_barrier
  ds_read_b64 v[8:9], v114 offset:0
  ds_read_b64 v[10:11], v114 offset:1024
  ds_read_b64 v[12:13], v114 offset:2048
  ds_read_b64 v[14:15], v114 offset:3072
  ds_read2_b32 v[16:17], v115 offset0:0 offset1:64
  ds_read2_b32 v[18:19], v115 offset0:128 offset1:192
  v_mfma_f32_32x32x16_bf16 v[52:67], v[68:71], v[68:71], 0
  s_waitcnt lgkmcnt(0)
  v_pk_add_f32 v[16:17], v[16:17], v[18:19]
  v_pk_add_f32 v[8:9], v[8:9], v[10:11]
  v_pk_add_f32 v[12:13], v[12:13], v[14:15]
  v_add_f32 v20, v16, v17
  v_pk_add_f32 v[8:9], v[8:9], v[12:13]
  v_max_f32 v22, v8, v9
  v_add_f32_dpp v20, v20, v20 row_ror:8 row_mask:0xf bank_mask:0xf
  s_nop 0
  v_max_f32_dpp v22, v22, v22 row_ror:8 row_mask:0xf bank_mask:0xf
  v_max_f32 v22, v22, v20
  s_nop 1
  v_max_f32_dpp v22, v22, v22 quad_perm:[1,0,3,2] row_mask:0xf bank_mask:0xf
  s_nop 1
  v_max_f32_dpp v22, v22, v22 quad_perm:[2,3,0,1] row_mask:0xf bank_mask:0xf
  s_nop 1
  v_max_f32_dpp v22, v22, v22 row_half_mirror row_mask:0xf bank_mask:0xf
  v_pk_add_f32 v[8:9], v[8:9], v[22:23] op_sel_hi:[1,0] neg_lo:[0,1] neg_hi:[0,1]
  v_sub_f32 v20, v20, v22
  v_exp_f32 v8, v8
  v_exp_f32 v9, v9
  v_exp_f32 v20, v20
  v_add_f32 v24, v8, v9
  v_fmac_f32 v24, 0.5, v20
  v_mov_b32_dpp v21, v20 quad_perm:[1,0,3,2] row_mask:0xf bank_mask:0xf
  s_nop 0
  v_add_f32_dpp v24, v24, v24 quad_perm:[1,0,3,2] row_mask:0xf bank_mask:0xf
  s_nop 1
  v_add_f32_dpp v24, v24, v24 quad_perm:[2,3,0,1] row_mask:0xf bank_mask:0xf
  s_nop 1
  v_add_f32_dpp v24, v24, v24 row_half_mirror row_mask:0xf bank_mask:0xf
  s_nop 1
  v_add_f32_dpp v24, v24, v24 row_ror:8 row_mask:0xf bank_mask:0xf
  v_rcp_f32 v24, v24
  s_nop 0
  v_pk_mul_f32 v[8:9], v[8:9], v[24:25] op_sel_hi:[1,0]
  v_cvt_pk_bf16_f32 v8, abs(v8), abs(v9)
  buffer_store_dword v8, v1, s[8:11], s20 offen
  v_pk_mul_f32 v[20:21], v[20:21], v[24:25] op_sel_hi:[1,0]
  v_cvt_pk_bf16_f32 v20, abs(v20), abs(v21)
  buffer_store_dword v20, v118, s[8:11], s20 offen
  v_mov_b32 v74, 0
  v_mov_b32 v75, 0
  s_mov_b32 s19, s18
  s_add_u32 s18, s18, 1
  s_mov_b32 s22, s20
  s_mov_b32 s20, s21
  s_mov_b32 s21, s22
  s_add_u32 s23, s20, 4096
  s_cmp_lt_u32 s19, 63
  s_cbranch_scc1 cA_sc0_loop
  s_branch cA_done
cA_sc0_r0:
  s_add_u32 s31, s31, 1
  buffer_load_dwordx4 v[8:11], v2, s[8:11], s20 offen offset:0 sc1
  s_waitcnt vmcnt(0)
  v_cmp_eq_u32 vcc, -1, v8
  v_mov_b32 v36, 0
  v_mov_b32 v37, 0
  v_mov_b32 v38, 0
  v_mov_b32 v39, 0
  v_mov_b32 v40, 0
  v_mov_b32 v41, 0
  v_mov_b32 v42, 0
  v_mov_b32 v43, 0
  v_mov_b32 v44, 0
  v_mov_b32 v45, 0
  v_mov_b32 v46, 0
  v_mov_b32 v47, 0
  v_mov_b32 v48, 0
  v_mov_b32 v49, 0
  v_mov_b32 v50, 0
  v_mov_b32 v51, 0
  s_nop 1
  s_cbranch_vccz cA_sc0_go
  s_add_u32 s30, s30, 1
  s_cmp_lt_u32 s30, 400000
  s_cbranch_scc1 cA_sc0_r0
  s_branch cA_abort
cA_sc0_r1:
  s_add_u32 s31, s31, 1
  buffer_load_dwordx4 v[12:15], v2, s[8:11], s20 offen offset:1024 sc1
  s_waitcnt vmcnt(0)
  v_cmp_eq_u32 vcc, -1, v12
  s_nop 4
  s_cbranch_vccz cA_sc0_c1
  s_add_u32 s30, s30, 1
  s_cmp_lt_u32 s30, 400000
  s_cbranch_scc1 cA_sc0_r1
  s_branch cA_abort
cA_sc0_r2:
  s_add_u32 s31, s31, 1
  buffer_load_dwordx4 v[16:19], v2, s[8:11], s20 offen offset:2048 sc1
  s_waitcnt vmcnt(0)
  v_cmp_eq_u32 vcc, -1, v16
  s_nop 4
  s_cbranch_vccz cA_sc0_c2
  s_add_u32 s30, s30, 1
  s_cmp_lt_u32 s30, 400000
  s_cbranch_scc1 cA_sc0_r2
  s_branch cA_abort
cA_sc0_r3:
  s_add_u32 s31, s31, 1
  buffer_load_dwordx4 v[20:23], v2, s[8:11], s20 offen offset:3072 sc1
  s_waitcnt vmcnt(0)
  v_cmp_eq_u32 vcc, -1, v20
  s_nop 4
  s_cbranch_vccz cA_sc0_c3
  s_add_u32 s30, s30, 1
  s_cmp_lt_u32 s30, 400000
  s_cbranch_scc1 cA_sc0_r3
  s_branch cA_abort
cA_sc0_r4:
  s_add_u32 s31, s31, 1
  buffer_load_dwordx4 v[32:35], v2, s[8:11], s23 offen offset:0 sc1
  buffer_load_dwordx4 v[24:27], v2, s[8:11], s23 offen offset:1024 sc1
  buffer_load_dwordx4 v[28:31], v2, s[8:11], s23 offen offset:2048 sc1
  s_waitcnt vmcnt(0)
  v_max3_u32 v66, v24, v27, v28
  v_max3_u32 v66, v66, v31, v32
  v_max_u32 v66, v66, v35
  v_cmp_eq_u32 vcc, -1, v66
  s_nop 4
  s_cbranch_vccz cA_sc0_c4
  s_add_u32 s30, s30, 1
  s_cmp_lt_u32 s30, 400000
  s_cbranch_scc1 cA_sc0_r4
  s_branch cA_abort
cA_sc0_retry:
  s_cmp_lg_u32 s62, 0
  s_cbranch_scc1 cA_sc0_cont
  s_waitcnt vmcnt(0) lgkmcnt(0)
cA_sc0_rv:
  buffer_load_dwordx4 v[8:11], v2, s[8:11], s20 offen offset:0 sc1
  buffer_load_dwordx4 v[12:15], v2, s[8:11], s20 offen offset:1024 sc1
  buffer_load_dwordx4 v[16:19], v2, s[8:11], s20 offen offset:2048 sc1
  buffer_load_dwordx4 v[20:23], v2, s[8:11], s20 offen offset:3072 sc1
  buffer_load_dwordx4 v[32:35], v2, s[8:11], s23 offen offset:0 sc1
  buffer_load_dwordx4 v[24:27], v2, s[8:11], s23 offen offset:1024 sc1
  buffer_load_dwordx4 v[28:31], v2, s[8:11], s23 offen offset:2048 sc1
  s_waitcnt vmcnt(0)
  v_max3_u32 v66, v8, v9, v10
  v_max3_u32 v66, v66, v11, v12
  v_max3_u32 v66, v66, v13, v14
  v_max3_u32 v66, v66, v15, v16
  v_max3_u32 v66, v66, v17, v18
  v_max3_u32 v66, v66, v19, v20
  v_max3_u32 v66, v66, v21, v22
  v_max3_u32 v66, v66, v23, v24
  v_max3_u32 v66, v66, v25, v26
  v_max3_u32 v66, v66, v27, v28
  v_max3_u32 v66, v66, v29, v30
  v_max3_u32 v66, v66, v31, v32
  v_max3_u32 v66, v66, v33, v34
  v_max_u32 v66, v66, v35
  v_cmp_eq_u32 vcc, -1, v66
  s_cbranch_vccz cA_sc0_rk
  s_add_u32 s30, s30, 1
  s_cmp_lt_u32 s30, 400000
  s_cbranch_scc1 cA_sc0_rv
  s_branch cA_abort
cA_sc0_rk:
  s_mov_b32 s62, 1
  v_mov_b32 v36, 0
  v_mov_b32 v37, 0
  v_mov_b32 v38, 0
  v_mov_b32 v39, 0
  v_mov_b32 v40, 0
  v_mov_b32 v41, 0
  v_mov_b32 v42, 0
  v_mov_b32 v43, 0
  v_mov_b32 v44, 0
  v_mov_b32 v45, 0
  v_mov_b32 v46, 0
  v_mov_b32 v47, 0
  v_mov_b32 v48, 0
  v_mov_b32 v49, 0
  v_mov_b32 v50, 0
  v_mov_b32 v51, 0
  v_mov_b32 v60, 0
  v_mov_b32 v61, 0
  v_mov_b32 v62, 0
  v_mov_b32 v63, 0
  v_mov_b32 v68, 0
  v_mov_b32 v69, 0
  v_mov_b32 v70, 0
  v_mov_b32 v71, 0
  v_mov_b32 v72, 0
  v_mov_b32 v73, 0
  v_mov_b32 v74, 0
  v_mov_b32 v75, 0
  v_mov_b32 v52, 0
  v_mov_b32 v53, 0
  v_mov_b32 v54, 0
  v_mov_b32 v55, 0
  v_mov_b32 v56, 0
  v_mov_b32 v57, 0
  v_mov_b32 v58, 0
  v_mov_b32 v59, 0
  s_add_u32 s31, s31, 0x100
  s_nop 0
  s_branch cA_sc0_go
.p2align 6
cA_sc1_loop:
  s_mov_b32 s30, 0
  s_mov_b32 s62, 0
  s_setprio 3
  s_barrier
  buffer_load_dwordx4 v[8:11], v2, s[8:11], s20 offen offset:0 sc1
  s_setprio 2
  buffer_load_dwordx4 v[12:15], v2, s[8:11], s20 offen offset:1024 sc1
  s_setprio 1
  buffer_load_dwordx4 v[16:19], v2, s[8:11], s20 offen offset:2048 sc1
  s_setprio 0
  buffer_load_dwordx4 v[20:23], v2, s[8:11], s20 offen offset:3072 sc1
cA_sc1_go:
  s_waitcnt vmcnt(3)
  v_smfmac_f32_16x16x64_bf16 v[36:39], v[8:11], a[0:7], v3
  buffer_load_dwordx4 v[28:31], v2, s[8:11], s23 offen offset:0 sc1
  v_cmp_eq_u32 vcc, -1, v8
  v_smfmac_f32_16x16x64_bf16 v[40:43], v[8:11], a[56:63], v3
  v_smfmac_f32_16x16x64_bf16 v[44:47], v[8:11], a[112:119], v3
  buffer_load_dwordx4 v[24:27], v2, s[8:11], s23 offen offset:1024 sc1
  s_cbranch_vccnz cA_sc1_r0
  v_smfmac_f32_16x16x64_bf16 v[48:51], v[8:11], a[168:175], v3
  v_smfmac_f32_16x16x64_bf16 v[52:55], v[8:11], a[224:231], v3
  s_waitcnt vmcnt(4)
  v_cmp_eq_u32 vcc, -1, v12
  v_smfmac_f32_16x16x64_bf16 v[56:59], v[8:11], v[144:151], v3
  buffer_load_dwordx4 v[32:35], v2, s[8:11], s23 offen offset:2048 sc1
  v_smfmac_f32_16x16x64_bf16 v[60:63], v[8:11], v[200:207], v3
  s_cbranch_vccnz cA_sc1_r1
cA_sc1_c1:
  v_smfmac_f32_16x16x64_bf16 v[36:39], v[12:15], a[8:15], v3
  v_smfmac_f32_16x16x64_bf16 v[40:43], v[12:15], a[64:71], v3
  v_smfmac_f32_16x16x64_bf16 v[44:47], v[12:15], a[120:127], v3
  v_smfmac_f32_16x16x64_bf16 v[48:51], v[12:15], a[176:183], v3
  v_smfmac_f32_16x16x64_bf16 v[52:55], v[12:15], a[232:239], v3
  s_waitcnt vmcnt(4)
  v_cmp_eq_u32 vcc, -1, v16
  v_smfmac_f32_16x16x64_bf16 v[56:59], v[12:15], v[152:159], v3
  buffer_load_dwordx4 v[88:91], v117, s[8:11], s26 offen offset:0 sc1
  v_smfmac_f32_16x16x64_bf16 v[60:63], v[12:15], v[208:215], v3
  s_cbranch_vccnz cA_sc1_r2
cA_sc1_c2:
  v_smfmac_f32_16x16x64_bf16 v[36:39], v[16:19], a[16:23], v3
  v_smfmac_f32_16x16x64_bf16 v[40:43], v[16:19], a[72:79], v3
  v_smfmac_f32_16x16x64_bf16 v[44:47], v[16:19], a[128:135], v3
  buffer_load_dwordx4 v[92:95], v117, s[8:11], s26 offen offset:1024 sc1
  v_smfmac_f32_16x16x64_bf16 v[48:51], v[16:19], a[184:191], v3
  v_smfmac_f32_16x16x64_bf16 v[52:55], v[16:19], a[240:247], v3
  s_waitcnt vmcnt(5)
  v_cmp_eq_u32 vcc, -1, v20
  v_smfmac_f32_16x16x64_bf16 v[56:59], v[16:19], v[160:167], v3
  v_smfmac_f32_16x16x64_bf16 v[60:63], v[16:19], v[216:223], v3
  buffer_load_dwordx4 v[96:99], v2, s[8:11], s24 offen offset:0 sc1
  s_cbranch_vccnz cA_sc1_r3
cA_sc1_c3:
  v_smfmac_f32_16x16x64_bf16 v[36:39], v[20:23], a[24:31], v3
  v_smfmac_f32_16x16x64_bf16 v[40:43], v[20:23], a[80:87], v3
  s_waitcnt vmcnt(3)
  v_max3_u32 v66, v24, v27, v28
  v_smfmac_f32_16x16x64_bf16 v[44:47], v[20:23], a[136:143], v3
  v_max3_u32 v66, v66, v31, v32
  v_smfmac_f32_16x16x64_bf16 v[48:51], v[20:23], a[192:199], v3
  buffer_load_dwordx4 v[100:103], v2, s[8:11], s24 offen offset:1024 sc1
  v_max_u32 v66, v66, v35
  v_smfmac_f32_16x16x64_bf16 v[52:55], v[20:23], a[248:255], v3
  v_cmp_eq_u32 vcc, -1, v66
  v_smfmac_f32_16x16x64_bf16 v[56:59], v[20:23], v[168:175], v3
  v_smfmac_f32_16x16x64_bf16 v[60:63], v[20:23], v[224:231], v3
  s_cbranch_vccnz cA_sc1_r4
cA_sc1_c4:
  v_smfmac_f32_16x16x64_bf16 v[60:63], v[28:31], v[232:239], v3
  buffer_load_dwordx4 v[104:107], v2, s[8:11], s26 offen offset:0 sc1
  v_smfmac_f32_16x16x64_bf16 v[60:63], v[24:27], v[240:247], v3
  v_smfmac_f32_16x16x64_bf16 v[60:63], v[32:35], v[248:255], v3
  v_smfmac_f32_16x16x64_bf16 v[52:55], v[28:31], v[120:127], v3
  v_smfmac_f32_16x16x64_bf16 v[52:55], v[24:27], v[128:135], v3
  buffer_load_dwordx4 v[108:111], v2, s[8:11], s26 offen offset:1024 sc1
  v_smfmac_f32_16x16x64_bf16 v[52:55], v[32:35], v[136:143], v3
  v_cvt_pk_bf16_f32 v63, v62, v63
  v_smfmac_f32_16x16x64_bf16 v[56:59], v[28:31], v[176:183], v3
  v_cvt_pk_bf16_f32 v62, v60, v61
  v_smfmac_f32_16x16x64_bf16 v[56:59], v[24:27], v[184:191], v3
  v_mfma_f32_16x16x32_bf16 v[8:11], v[62:65], v[4:7], 0
  v_cvt_pk_bf16_f32 v55, v54, v55
  v_smfmac_f32_16x16x64_bf16 v[56:59], v[32:35], v[192:199], v3
  v_cvt_pk_bf16_f32 v54, v52, v53
  v_smfmac_f32_16x16x64_bf16 v[36:39], v[28:31], a[32:39], v3
  s_nop 1
  v_cvt_pk_bf16_f32 v78, v8, v9
  v_smfmac_f32_16x16x64_bf16 v[36:39], v[24:27], a[40:47], v3
  v_cvt_pk_bf16_f32 v79, v10, v11
  v_smfmac_f32_16x16x64_bf16 v[36:39], v[32:35], a[48:55], v3
  v_cvt_pk_bf16_f32 v56, v56, v57
  v_smfmac_f32_16x16x64_bf16 v[40:43], v[28:31], a[88:95], v3
  v_cvt_pk_bf16_f32 v57, v58, v59
  v_smfmac_f32_16x16x64_bf16 v[40:43], v[24:27], a[96:103], v3
  v_mfma_f32_16x16x32_bf16 v[16:19], v[54:57], v[4:7], 0
  v_cvt_pk_bf16_f32 v39, v38, v39
  v_smfmac_f32_16x16x64_bf16 v[40:43], v[32:35], a[104:111], v3
  v_cvt_pk_bf16_f32 v38, v36, v37
  v_smfmac_f32_16x16x64_bf16 v[44:47], v[28:31], a[144:151], v3
  s_nop 1
  v_cvt_pk_bf16_f32 v76, v16, v17
  v_smfmac_f32_16x16x64_bf16 v[44:47], v[24:27], a[152:159], v3
  v_cvt_pk_bf16_f32 v77, v18, v19
  v_smfmac_f32_16x16x64_bf16 v[44:47], v[32:35], a[160:167], v3
  v_cvt_pk_bf16_f32 v40, v40, v41
  v_smfmac_f32_16x16x64_bf16 v[48:51], v[28:31], a[200:207], v3
  v_cvt_pk_bf16_f32 v41, v42, v43
  v_smfmac_f32_16x16x64_bf16 v[48:51], v[24:27], a[208:215], v3
  v_smfmac_f32_16x16x64_bf16 v[48:51], v[32:35], a[216:223], v3
  s_waitcnt vmcnt(4)
  v_cvt_pk_bf16_f32 v47, v46, v47
  v_smfmac_f32_16x16x64_bf16 v[68:71], v[76:79], v[80:87], v3
  v_cvt_pk_bf16_f32 v46, v44, v45
  v_mfma_f32_16x16x32_bf16 v[8:11], v[38:41], v[4:7], 0
  s_nop 1
  v_cvt_pk_bf16_f32 v48, v48, v49
  v_cvt_pk_bf16_f32 v49, v50, v51
  s_nop 1
  v_mfma_f32_16x16x32_bf16 v[16:19], v[46:49], v[4:7], 0
  v_smfmac_f32_16x16x64_bf16 v[72:75], v[76:79], v[88:95], v3
  v_cvt_pk_bf16_f32 v20, v8, v9
  v_mfma_f32_16x16x32_bf16 v[52:55], v[30:33], v[76:79], 0
  s_waitcnt vmcnt(0)
  v_cvt_pk_bf16_f32 v21, v10, v11
  v_cvt_pk_bf16_f32 v22, v16, v17
  v_cvt_pk_bf16_f32 v23, v18, v19
  s_nop 1
  v_mfma_f32_16x16x32_bf16 v[52:55], v[12:15], v[20:23], v[52:55]
  v_smfmac_f32_16x16x64_bf16 v[68:71], v[20:23], v[96:103], v3
  v_smfmac_f32_16x16x64_bf16 v[72:75], v[20:23], v[104:111], v3
  s_nop 1
  ds_write_b128 v113, v[52:55]
  s_nop 1
  v_permlane32_swap_b32 v68, v70
  v_permlane32_swap_b32 v69, v71
  v_add_f32 v56, v68, v70
  v_add_f32 v58, v69, v71
  v_permlane32_swap_b32 v72, v74
  v_permlane32_swap_b32 v73, v75
  v_add_f32 v57, v72, v74
  v_add_f32 v59, v73, v75
  ds_write_b128 v2, v[56:59] offset:1024
  v_cmp_u_f32 vcc, v57, v59
  v_mov_b32 v68, 0
  v_mov_b32 v69, 0
  v_mov_b32 v70, 0
  v_mov_b32 v71, 0
  s_cbranch_vccnz cA_sc1_retry
cA_sc1_cont:
  s_add_u32 s24, s24, 28672
  s_add_u32 s26, s26, 28672
  buffer_load_dwordx4 v[80:83], v117, s[8:11], s24 offen offset:0 sc1
  buffer_load_dwordx4 v[84:87], v117, s[8:11], s24 offen offset:1024 sc1
  v_mov_b32 v72, 0
  v_mov_b32 v73, 0
  v_mfma_f32_32x32x16_bf16 v[36:51], v[68:71], v[68:71], 0
  s_waitcnt lgkmcnt(0)
  s_barrier
  ds_read_b64 v[8:9], v114 offset:0
  ds_read_b64 v[10:11], v114 offset:1024
  ds_read_b64 v[12:13], v114 offset:2048
  ds_read_b64 v[14:15], v114 offset:3072
  ds_read2_b32 v[16:17], v115 offset0:0 offset1:64
  ds_read2_b32 v[18:19], v115 offset0:128 offset1:192
  v_mfma_f32_32x32x16_bf16 v[52:67], v[68:71], v[68:71], 0
  s_waitcnt lgkmcnt(0)
  v_pk_add_f32 v[16:17], v[16:17], v[18:19]
  v_pk_add_f32 v[8:9], v[8:9], v[10:11]
  v_pk_add_f32 v[12:13], v[12:13], v[14:15]
  v_add_f32 v20, v16, v17
  v_pk_add_f32 v[8:9], v[8:9], v[12:13]
  v_max_f32 v22, v8, v9
  v_add_f32_dpp v20, v20, v20 row_ror:8 row_mask:0xf bank_mask:0xf
  s_nop 0
  v_max_f32_dpp v22, v22, v22 row_ror:8 row_mask:0xf bank_mask:0xf
  v_max_f32 v22, v22, v20
  buffer_store_dword v112, v116, s[8:11], 0 offen
  s_nop 0
  v_max_f32_dpp v22, v22, v22 quad_perm:[1,0,3,2] row_mask:0xf bank_mask:0xf
  s_nop 1
  v_max_f32_dpp v22, v22, v22 quad_perm:[2,3,0,1] row_mask:0xf bank_mask:0xf
  s_nop 1
  v_max_f32_dpp v22, v22, v22 row_half_mirror row_mask:0xf bank_mask:0xf
  v_pk_add_f32 v[8:9], v[8:9], v[22:23] op_sel_hi:[1,0] neg_lo:[0,1] neg_hi:[0,1]
  v_sub_f32 v20, v20, v22
  v_exp_f32 v8, v8
  v_exp_f32 v9, v9
  v_exp_f32 v20, v20
  v_add_f32 v24, v8, v9
  v_fmac_f32 v24, 0.5, v20
  v_mov_b32_dpp v21, v20 quad_perm:[1,0,3,2] row_mask:0xf bank_mask:0xf
  s_nop 0
  v_add_f32_dpp v24, v24, v24 quad_perm:[1,0,3,2] row_mask:0xf bank_mask:0xf
  s_nop 1
  v_add_f32_dpp v24, v24, v24 quad_perm:[2,3,0,1] row_mask:0xf bank_mask:0xf
  s_nop 1
  v_add_f32_dpp v24, v24, v24 row_half_mirror row_mask:0xf bank_mask:0xf
  s_nop 1
  v_add_f32_dpp v24, v24, v24 row_ror:8 row_mask:0xf bank_mask:0xf
  v_rcp_f32 v24, v24
  s_nop 0
  v_pk_mul_f32 v[8:9], v[8:9], v[24:25] op_sel_hi:[1,0]
  v_cvt_pk_bf16_f32 v8, abs(v8), abs(v9)
  buffer_store_dword v8, v1, s[8:11], s20 offen
  v_pk_mul_f32 v[20:21], v[20:21], v[24:25] op_sel_hi:[1,0]
  v_cvt_pk_bf16_f32 v20, abs(v20), abs(v21)
  buffer_store_dword v20, v118, s[8:11], s20 offen
  v_mov_b32 v74, 0
  v_mov_b32 v75, 0
  s_mov_b32 s19, s18
  s_add_u32 s18, s18, 1
  s_mov_b32 s22, s20
  s_mov_b32 s20, s21
  s_mov_b32 s21, s22
  s_add_u32 s23, s20, 4096
  v_mov_b32 v112, s18
  s_cmp_lt_u32 s19, 63
  s_nop 0
  s_cbranch_scc1 cA_sc1_loop
  s_branch cA_done
cA_sc1_r0:
  s_add_u32 s31, s31, 1
  buffer_load_dwordx4 v[8:11], v2, s[8:11], s20 offen offset:0 sc1
  s_waitcnt vmcnt(0)
  v_cmp_eq_u32 vcc, -1, v8
  v_mov_b32 v36, 0
  v_mov_b32 v37, 0
  v_mov_b32 v38, 0
  v_mov_b32 v39, 0
  v_mov_b32 v40, 0
  v_mov_b32 v41, 0
  v_mov_b32 v42, 0
  v_mov_b32 v43, 0
  v_mov_b32 v44, 0
  v_mov_b32 v45, 0
  v_mov_b32 v46, 0
  v_mov_b32 v47, 0
  v_mov_b32 v48, 0
  v_mov_b32 v49, 0
  v_mov_b32 v50, 0
  v_mov_b32 v51, 0
  s_nop 1
  s_cbranch_vccz cA_sc1_go
  s_add_u32 s30, s30, 1
  s_cmp_lt_u32 s30, 400000
  s_cbranch_scc1 cA_sc1_r0
  s_branch cA_abort
cA_sc1_r1:
  s_add_u32 s31, s31, 1
  buffer_load_dwordx4 v[12:15], v2, s[8:11], s20 offen offset:1024 sc1
  s_waitcnt vmcnt(0)
  v_cmp_eq_u32 vcc, -1, v12
  s_nop 4
  s_cbranch_vccz cA_sc1_c1
  s_add_u32 s30, s30, 1
  s_cmp_lt_u32 s30, 400000
  s_cbranch_scc1 cA_sc1_r1
  s_branch cA_abort
cA_sc1_r2:
  s_add_u32 s31, s31, 1
  buffer_load_dwordx4 v[16:19], v2, s[8:11], s20 offen offset:2048 sc1
  s_waitcnt vmcnt(0)
  v_cmp_eq_u32 vcc, -1, v16
  s_nop 4
  s_cbranch_vccz cA_sc1_c2
  s_add_u32 s30, s30, 1
  s_cmp_lt_u32 s30, 400000
  s_cbranch_scc1 cA_sc1_r2
  s_branch cA_abort
cA_sc1_r3:
  s_add_u32 s31, s31, 1
  buffer_load_dwordx4 v[20:23], v2, s[8:11], s20 offen offset:3072 sc1
  s_waitcnt vmcnt(0)
  v_cmp_eq_u32 vcc, -1, v20
  s_nop 4
  s_cbranch_vccz cA_sc1_c3
  s_add_u32 s30, s30, 1
  s_cmp_lt_u32 s30, 400000
  s_cbranch_scc1 cA_sc1_r3
  s_branch cA_abort
cA_sc1_r4:
  s_add_u32 s31, s31, 1
  buffer_load_dwordx4 v[28:31], v2, s[8:11], s23 offen offset:0 sc1
  buffer_load_dwordx4 v[24:27], v2, s[8:11], s23 offen offset:1024 sc1
  buffer_load_dwordx4 v[32:35], v2, s[8:11], s23 offen offset:2048 sc1
  s_waitcnt vmcnt(0)
  v_max3_u32 v66, v24, v27, v28
  v_max3_u32 v66, v66, v31, v32
  v_max_u32 v66, v66, v35
  v_cmp_eq_u32 vcc, -1, v66
  s_nop 4
  s_cbranch_vccz cA_sc1_c4
  s_add_u32 s30, s30, 1
  s_cmp_lt_u32 s30, 400000
  s_cbranch_scc1 cA_sc1_r4
  s_branch cA_abort
cA_sc1_retry:
  s_cmp_lg_u32 s62, 0
  s_cbranch_scc1 cA_sc1_cont
  s_waitcnt vmcnt(0) lgkmcnt(0)
cA_sc1_rv:
  buffer_load_dwordx4 v[8:11], v2, s[8:11], s20 offen offset:0 sc1
  buffer_load_dwordx4 v[12:15], v2, s[8:11], s20 offen offset:1024 sc1
  buffer_load_dwordx4 v[16:19], v2, s[8:11], s20 offen offset:2048 sc1
  buffer_load_dwordx4 v[20:23], v2, s[8:11], s20 offen offset:3072 sc1
  buffer_load_dwordx4 v[28:31], v2, s[8:11], s23 offen offset:0 sc1
  buffer_load_dwordx4 v[24:27], v2, s[8:11], s23 offen offset:1024 sc1
  buffer_load_dwordx4 v[32:35], v2, s[8:11], s23 offen offset:2048 sc1
  s_waitcnt vmcnt(0)
  v_max3_u32 v66, v8, v9, v10
  v_max3_u32 v66, v66, v11, v12
  v_max3_u32 v66, v66, v13, v14
  v_max3_u32 v66, v66, v15, v16
  v_max3_u32 v66, v66, v17, v18
  v_max3_u32 v66, v66, v19, v20
  v_max3_u32 v66, v66, v21, v22
  v_max3_u32 v66, v66, v23, v24
  v_max3_u32 v66, v66, v25, v26
  v_max3_u32 v66, v66, v27, v28
  v_max3_u32 v66, v66, v29, v30
  v_max3_u32 v66, v66, v31, v32
  v_max3_u32 v66, v66, v33, v34
  v_max_u32 v66, v66, v35
  v_cmp_eq_u32 vcc, -1, v66
  s_cbranch_vccz cA_sc1_rk
  s_add_u32 s30, s30, 1
  s_cmp_lt_u32 s30, 400000
  s_cbranch_scc1 cA_sc1_rv
  s_branch cA_abort
cA_sc1_rk:
  s_mov_b32 s62, 1
  v_mov_b32 v36, 0
  v_mov_b32 v37, 0
  v_mov_b32 v38, 0
  v_mov_b32 v39, 0
  v_mov_b32 v40, 0
  v_mov_b32 v41, 0
  v_mov_b32 v42, 0
  v_mov_b32 v43, 0
  v_mov_b32 v44, 0
  v_mov_b32 v45, 0
  v_mov_b32 v46, 0
  v_mov_b32 v47, 0
  v_mov_b32 v48, 0
  v_mov_b32 v49, 0
  v_mov_b32 v50, 0
  v_mov_b32 v51, 0
  v_mov_b32 v60, 0
  v_mov_b32 v61, 0
  v_mov_b32 v62, 0
  v_mov_b32 v63, 0
  v_mov_b32 v68, 0
  v_mov_b32 v69, 0
  v_mov_b32 v70, 0
  v_mov_b32 v71, 0
  v_mov_b32 v72, 0
  v_mov_b32 v73, 0
  v_mov_b32 v74, 0
  v_mov_b32 v75, 0
  v_mov_b32 v52, 0
  v_mov_b32 v53, 0
  v_mov_b32 v54, 0
  v_mov_b32 v55, 0
  v_mov_b32 v56, 0
  v_mov_b32 v57, 0
  v_mov_b32 v58, 0
  v_mov_b32 v59, 0
  s_add_u32 s31, s31, 0x100
  s_nop 0
  s_branch cA_sc1_go
.p2align 6
cA_sc2_loop:
  s_mov_b32 s30, 0
  s_mov_b32 s62, 0
  s_setprio 3
  s_barrier
  buffer_load_dwordx4 v[8:11], v2, s[8:11], s20 offen offset:0 sc1
  s_setprio 2
  buffer_load_dwordx4 v[12:15], v2, s[8:11], s20 offen offset:1024 sc1
  s_setprio 1
  buffer_load_dwordx4 v[16:19], v2, s[8:11], s20 offen offset:2048 sc1
  s_setprio 0
  buffer_load_dwordx4 v[20:23], v2, s[8:11], s20 offen offset:3072 sc1
cA_sc2_go:
  s_waitcnt vmcnt(3)
  v_smfmac_f32_16x16x64_bf16 v[36:39], v[8:11], a[0:7], v3
  buffer_load_dwordx4 v[24:27], v2, s[8:11], s23 offen offset:0 sc1
  v_cmp_eq_u32 vcc, -1, v8
  v_smfmac_f32_16x16x64_bf16 v[40:43], v[8:11], a[56:63], v3
  v_smfmac_f32_16x16x64_bf16 v[44:47], v[8:11], a[112:119], v3
  buffer_load_dwordx4 v[32:35], v2, s[8:11], s23 offen offset:1024 sc1
  s_cbranch_vccnz cA_sc2_r0
  v_smfmac_f32_16x16x64_bf16 v[48:51], v[8:11], a[168:175], v3
  v_smfmac_f32_16x16x64_bf16 v[52:55], v[8:11], a[224:231], v3
  s_waitcnt vmcnt(4)
  v_cmp_eq_u32 vcc, -1, v12
  v_smfmac_f32_16x16x64_bf16 v[56:59], v[8:11], v[144:151], v3
  buffer_load_dwordx4 v[28:31], v2, s[8:11], s23 offen offset:2048 sc1
  v_smfmac_f32_16x16x64_bf16 v[62:65], v[8:11], v[200:207], v3
  s_cbranch_vccnz cA_sc2_r1
cA_sc2_c1:
  v_smfmac_f32_16x16x64_bf16 v[36:39], v[12:15], a[8:15], v3
  v_smfmac_f32_16x16x64_bf16 v[40:43], v[12:15], a[64:71], v3
  v_smfmac_f32_16x16x64_bf16 v[44:47], v[12:15], a[120:127], v3
  v_smfmac_f32_16x16x64_bf16 v[48:51], v[12:15], a[176:183], v3
  v_smfmac_f32_16x16x64_bf16 v[52:55], v[12:15], a[232:239], v3
  s_waitcnt vmcnt(4)
  v_cmp_eq_u32 vcc, -1, v16
  v_smfmac_f32_16x16x64_bf16 v[56:59], v[12:15], v[152:159], v3
  buffer_load_dwordx4 v[88:91], v117, s[8:11], s26 offen offset:0 sc1
  v_smfmac_f32_16x16x64_bf16 v[62:65], v[12:15], v[208:215], v3
  s_cbranch_vccnz cA_sc2_r2
cA_sc2_c2:
  v_smfmac_f32_16x16x64_bf16 v[36:39], v[16:19], a[16:23], v3
  v_smfmac_f32_16x16x64_bf16 v[40:43], v[16:19], a[72:79], v3
  v_smfmac_f32_16x16x64_bf16 v[44:47], v[16:19], a[128:135], v3
  buffer_load_dwordx4 v[92:95], v117, s[8:11], s26 offen offset:1024 sc1
  v_smfmac_f32_16x16x64_bf16 v[48:51], v[16:19], a[184:191], v3
  v_smfmac_f32_16x16x64_bf16 v[52:55], v[16:19], a[240:247], v3
  s_waitcnt vmcnt(5)
  v_cmp_eq_u32 vcc, -1, v20
  v_smfmac_f32_16x16x64_bf16 v[56:59], v[16:19], v[160:167], v3
  v_smfmac_f32_16x16x64_bf16 v[62:65], v[16:19], v[216:223], v3
  buffer_load_dwordx4 v[96:99], v2, s[8:11], s24 offen offset:0 sc1
  s_cbranch_vccnz cA_sc2_r3
cA_sc2_c3:
  v_smfmac_f32_16x16x64_bf16 v[36:39], v[20:23], a[24:31], v3
  v_smfmac_f32_16x16x64_bf16 v[40:43], v[20:23], a[80:87], v3
  s_waitcnt vmcnt(3)
  v_max3_u32 v66, v24, v27, v28
  v_smfmac_f32_16x16x64_bf16 v[44:47], v[20:23], a[136:143], v3
  v_max3_u32 v66, v66, v31, v32
  v_smfmac_f32_16x16x64_bf16 v[48:51], v[20:23], a[192:199], v3
  buffer_load_dwordx4 v[100:103], v2, s[8:11], s24 offen offset:1024 sc1
  v_max_u32 v66, v66, v35
  v_smfmac_f32_16x16x64_bf16 v[52:55], v[20:23], a[248:255], v3
  v_cmp_eq_u32 vcc, -1, v66
  v_smfmac_f32_16x16x64_bf16 v[56:59], v[20:23], v[168:175], v3
  v_smfmac_f32_16x16x64_bf16 v[62:65], v[20:23], v[224:231], v3
  s_cbranch_vccnz cA_sc2_r4
cA_sc2_c4:
  v_smfmac_f32_16x16x64_bf16 v[62:65], v[24:27], v[232:239], v3
  buffer_load_dwordx4 v[104:107], v2, s[8:11], s26 offen offset:0 sc1
  v_smfmac_f32_16x16x64_bf16 v[62:65], v[32:35], v[240:247], v3
  v_smfmac_f32_16x16x64_bf16 v[62:65], v[28:31], v[248:255], v3
  v_smfmac_f32_16x16x64_bf16 v[52:55], v[24:27], v[120:127], v3
  v_smfmac_f32_16x16x64_bf16 v[52:55], v[32:35], v[128:135], v3
  buffer_load_dwordx4 v[108:111], v2, s[8:11], s26 offen offset:1024 sc1
  v_smfmac_f32_16x16x64_bf16 v[52:55], v[28:31], v[136:143], v3
  v_cvt_pk_bf16_f32 v62, v62, v63
  v_smfmac_f32_16x16x64_bf16 v[56:59], v[24:27], v[176:183], v3
  v_cvt_pk_bf16_f32 v63, v64, v65
  v_smfmac_f32_16x16x64_bf16 v[56:59], v[32:35], v[184:191], v3
  v_mfma_f32_16x16x32_bf16 v[8:11], v[60:63], v[4:7], 0
  v_cvt_pk_bf16_f32 v55, v54, v55
  v_smfmac_f32_16x16x64_bf16 v[56:59], v[28:31], v[192:199], v3
  v_cvt_pk_bf16_f32 v54, v52, v53
  v_smfmac_f32_16x16x64_bf16 v[36:39], v[24:27], a[32:39], v3
  s_nop 1
  v_cvt_pk_bf16_f32 v76, v8, v9
  v_smfmac_f32_16x16x64_bf16 v[36:39], v[32:35], a[40:47], v3
  v_cvt_pk_bf16_f32 v77, v10, v11
  v_smfmac_f32_16x16x64_bf16 v[36:39], v[28:31], a[48:55], v3
  v_cvt_pk_bf16_f32 v56, v56, v57
  v_smfmac_f32_16x16x64_bf16 v[40:43], v[24:27], a[88:95], v3
  v_cvt_pk_bf16_f32 v57, v58, v59
  v_smfmac_f32_16x16x64_bf16 v[40:43], v[32:35], a[96:103], v3
  v_mfma_f32_16x16x32_bf16 v[12:15], v[54:57], v[4:7], 0
  v_cvt_pk_bf16_f32 v39, v38, v39
  v_smfmac_f32_16x16x64_bf16 v[40:43], v[28:31], a[104:111], v3
  v_cvt_pk_bf16_f32 v38, v36, v37
  v_smfmac_f32_16x16x64_bf16 v[44:47], v[24:27], a[144:151], v3
  s_nop 1
  v_cvt_pk_bf16_f32 v78, v12, v13
  v_smfmac_f32_16x16x64_bf16 v[44:47], v[32:35], a[152:159], v3
  v_cvt_pk_bf16_f32 v79, v14, v15
  v_smfmac_f32_16x16x64_bf16 v[44:47], v[28:31], a[160:167], v3
  v_cvt_pk_bf16_f32 v40, v40, v41
  v_smfmac_f32_16x16x64_bf16 v[48:51], v[24:27], a[200:207], v3
  v_cvt_pk_bf16_f32 v41, v42, v43
  v_smfmac_f32_16x16x64_bf16 v[48:51], v[32:35], a[208:215], v3
  v_smfmac_f32_16x16x64_bf16 v[48:51], v[28:31], a[216:223], v3
  s_waitcnt vmcnt(4)
  v_cvt_pk_bf16_f32 v47, v46, v47
  v_smfmac_f32_16x16x64_bf16 v[68:71], v[76:79], v[80:87], v3
  v_cvt_pk_bf16_f32 v46, v44, v45
  v_mfma_f32_16x16x32_bf16 v[8:11], v[38:41], v[4:7], 0
  s_nop 1
  v_cvt_pk_bf16_f32 v48, v48, v49
  v_cvt_pk_bf16_f32 v49, v50, v51
  s_nop 1
  v_mfma_f32_16x16x32_bf16 v[12:15], v[46:49], v[4:7], 0
  v_smfmac_f32_16x16x64_bf16 v[72:75], v[76:79], v[88:95], v3
  v_cvt_pk_bf16_f32 v20, v8, v9
  v_mfma_f32_16x16x32_bf16 v[52:55], v[30:33], v[76:79], 0
  s_waitcnt vmcnt(0)
  v_cvt_pk_bf16_f32 v21, v10, v11
  v_cvt_pk_bf16_f32 v22, v12, v13
  v_cvt_pk_bf16_f32 v23, v14, v15
  s_nop 1
  v_mfma_f32_16x16x32_bf16 v[52:55], v[16:19], v[20:23], v[52:55]
  v_smfmac_f32_16x16x64_bf16 v[68:71], v[20:23], v[96:103], v3
  v_smfmac_f32_16x16x64_bf16 v[72:75], v[20:23], v[104:111], v3
  s_nop 1
  ds_write_b128 v113, v[52:55]
  s_nop 1
  v_permlane32_swap_b32 v68, v70
  v_permlane32_swap_b32 v69, v71
  v_add_f32 v56, v68, v70
  v_add_f32 v58, v69, v71
  v_permlane32_swap_b32 v72, v74
  v_permlane32_swap_b32 v73, v75
  v_add_f32 v57, v72, v74
  v_add_f32 v59, v73, v75
  ds_write_b128 v2, v[56:59] offset:2048
  v_cmp_u_f32 vcc, v57, v59
  v_mov_b32 v68, 0
  v_mov_b32 v69, 0
  v_mov_b32 v70, 0
  v_mov_b32 v71, 0
  s_cbranch_vccnz cA_sc2_retry
cA_sc2_cont:
  s_add_u32 s24, s24, 28672
  s_add_u32 s26, s26, 28672
  buffer_load_dwordx4 v[80:83], v117, s[8:11], s24 offen offset:0 sc1
  buffer_load_dwordx4 v[84:87], v117, s[8:11], s24 offen offset:1024 sc1
  v_mov_b32 v72, 0
  v_mov_b32 v73, 0
  v_mfma_f32_32x32x16_bf16 v[36:51], v[68:71], v[68:71], 0
  s_waitcnt lgkmcnt(0)
  s_barrier
  v_mfma_f32_32x32x16_bf16 v[52:67], v[68:71], v[68:71], 0
  buffer_store_dwordx2 v[118:119], v114, s[8:11], s21 offen
  buffer_store_dwordx2 v[118:119], v115, s[8:11], s21 offen
  s_buffer_load_dword s70, s[8:11], s35
  s_add_u32 s22, s24, 114688
  s_buffer_load_dword s71, s[8:11], s22
  s_mul_i32 s22, s18, 7168
  s_add_u32 s22, s22, 88024064
  s_buffer_load_dword s72, s[8:11], s22
  s_add_u32 s35, s35, 458752
  v_mov_b32 v74, 0
  v_mov_b32 v75, 0
  s_mov_b32 s19, s18
  s_add_u32 s18, s18, 1
  s_mov_b32 s22, s20
  s_mov_b32 s20, s21
  s_mov_b32 s21, s22
  s_add_u32 s23, s20, 4096
  s_cmp_lt_u32 s19, 63
  s_cbranch_scc1 cA_sc2_loop
  s_branch cA_done
cA_sc2_r0:
  s_add_u32 s31, s31, 1
  buffer_load_dwordx4 v[8:11], v2, s[8:11], s20 offen offset:0 sc1
  s_waitcnt vmcnt(0)
  v_cmp_eq_u32 vcc, -1, v8
  v_mov_b32 v36, 0
  v_mov_b32 v37, 0
  v_mov_b32 v38, 0
  v_mov_b32 v39, 0
  v_mov_b32 v40, 0
  v_mov_b32 v41, 0
  v_mov_b32 v42, 0
  v_mov_b32 v43, 0
  v_mov_b32 v44, 0
  v_mov_b32 v45, 0
  v_mov_b32 v46, 0
  v_mov_b32 v47, 0
  v_mov_b32 v48, 0
  v_mov_b32 v49, 0
  v_mov_b32 v50, 0
  v_mov_b32 v51, 0
  s_nop 1
  s_cbranch_vccz cA_sc2_go
  s_add_u32 s30, s30, 1
  s_cmp_lt_u32 s30, 400000
  s_cbranch_scc1 cA_sc2_r0
  s_branch cA_abort
cA_sc2_r1:
  s_add_u32 s31, s31, 1
  buffer_load_dwordx4 v[12:15], v2, s[8:11], s20 offen offset:1024 sc1
  s_waitcnt vmcnt(0)
  v_cmp_eq_u32 vcc, -1, v12
  s_nop 4
  s_cbranch_vccz cA_sc2_c1
  s_add_u32 s30, s30, 1
  s_cmp_lt_u32 s30, 400000
  s_cbranch_scc1 cA_sc2_r1
  s_branch cA_abort
cA_sc2_r2:
  s_add_u32 s31, s31, 1
  buffer_load_dwordx4 v[16:19], v2, s[8:11], s20 offen offset:2048 sc1
  s_waitcnt vmcnt(0)
  v_cmp_eq_u32 vcc, -1, v16
  s_nop 4
  s_cbranch_vccz cA_sc2_c2
  s_add_u32 s30, s30, 1
  s_cmp_lt_u32 s30, 400000
  s_cbranch_scc1 cA_sc2_r2
  s_branch cA_abort
cA_sc2_r3:
  s_add_u32 s31, s31, 1
  buffer_load_dwordx4 v[20:23], v2, s[8:11], s20 offen offset:3072 sc1
  s_waitcnt vmcnt(0)
  v_cmp_eq_u32 vcc, -1, v20
  s_nop 4
  s_cbranch_vccz cA_sc2_c3
  s_add_u32 s30, s30, 1
  s_cmp_lt_u32 s30, 400000
  s_cbranch_scc1 cA_sc2_r3
  s_branch cA_abort
cA_sc2_r4:
  s_add_u32 s31, s31, 1
  buffer_load_dwordx4 v[24:27], v2, s[8:11], s23 offen offset:0 sc1
  buffer_load_dwordx4 v[32:35], v2, s[8:11], s23 offen offset:1024 sc1
  buffer_load_dwordx4 v[28:31], v2, s[8:11], s23 offen offset:2048 sc1
  s_waitcnt vmcnt(0)
  v_max3_u32 v66, v24, v27, v28
  v_max3_u32 v66, v66, v31, v32
  v_max_u32 v66, v66, v35
  v_cmp_eq_u32 vcc, -1, v66
  s_nop 4
  s_cbranch_vccz cA_sc2_c4
  s_add_u32 s30, s30, 1
  s_cmp_lt_u32 s30, 400000
  s_cbranch_scc1 cA_sc2_r4
  s_branch cA_abort
cA_sc2_retry:
  s_cmp_lg_u32 s62, 0
  s_cbranch_scc1 cA_sc2_cont
  s_waitcnt vmcnt(0) lgkmcnt(0)
cA_sc2_rv:
  buffer_load_dwordx4 v[8:11], v2, s[8:11], s20 offen offset:0 sc1
  buffer_load_dwordx4 v[12:15], v2, s[8:11], s20 offen offset:1024 sc1
  buffer_load_dwordx4 v[16:19], v2, s[8:11], s20 offen offset:2048 sc1
  buffer_load_dwordx4 v[20:23], v2, s[8:11], s20 offen offset:3072 sc1
  buffer_load_dwordx4 v[24:27], v2, s[8:11], s23 offen offset:0 sc1
  buffer_load_dwordx4 v[32:35], v2, s[8:11], s23 offen offset:1024 sc1
  buffer_load_dwordx4 v[28:31], v2, s[8:11], s23 offen offset:2048 sc1
  s_waitcnt vmcnt(0)
  v_max3_u32 v66, v8, v9, v10
  v_max3_u32 v66, v66, v11, v12
  v_max3_u32 v66, v66, v13, v14
  v_max3_u32 v66, v66, v15, v16
  v_max3_u32 v66, v66, v17, v18
  v_max3_u32 v66, v66, v19, v20
  v_max3_u32 v66, v66, v21, v22
  v_max3_u32 v66, v66, v23, v24
  v_max3_u32 v66, v66, v25, v26
  v_max3_u32 v66, v66, v27, v28
  v_max3_u32 v66, v66, v29, v30
  v_max3_u32 v66, v66, v31, v32
  v_max3_u32 v66, v66, v33, v34
  v_max_u32 v66, v66, v35
  v_cmp_eq_u32 vcc, -1, v66
  s_cbranch_vccz cA_sc2_rk
  s_add_u32 s30, s30, 1
  s_cmp_lt_u32 s30, 400000
  s_cbranch_scc1 cA_sc2_rv
  s_branch cA_abort
cA_sc2_rk:
  s_mov_b32 s62, 1
  v_mov_b32 v36, 0
  v_mov_b32 v37, 0
  v_mov_b32 v38, 0
  v_mov_b32 v39, 0
  v_mov_b32 v40, 0
  v_mov_b32 v41, 0
  v_mov_b32 v42, 0
  v_mov_b32 v43, 0
  v_mov_b32 v44, 0
  v_mov_b32 v45, 0
  v_mov_b32 v46, 0
  v_mov_b32 v47, 0
  v_mov_b32 v48, 0
  v_mov_b32 v49, 0
  v_mov_b32 v50, 0
  v_mov_b32 v51, 0
  v_mov_b32 v62, 0
  v_mov_b32 v63, 0
  v_mov_b32 v64, 0
  v_mov_b32 v65, 0
  v_mov_b32 v68, 0
  v_mov_b32 v69, 0
  v_mov_b32 v70, 0
  v_mov_b32 v71, 0
  v_mov_b32 v72, 0
  v_mov_b32 v73, 0
  v_mov_b32 v74, 0
  v_mov_b32 v75, 0
  v_mov_b32 v52, 0
  v_mov_b32 v53, 0
  v_mov_b32 v54, 0
  v_mov_b32 v55, 0
  v_mov_b32 v56, 0
  v_mov_b32 v57, 0
  v_mov_b32 v58, 0
  v_mov_b32 v59, 0
  s_add_u32 s31, s31, 0x100
  s_nop 0
  s_branch cA_sc2_go
.p2align 6
cA_sc3_loop:
  s_mov_b32 s30, 0
  s_mov_b32 s62, 0
  s_setprio 3
  s_barrier
  buffer_load_dwordx4 v[8:11], v2, s[8:11], s20 offen offset:0 sc1
  s_setprio 2
  buffer_load_dwordx4 v[12:15], v2, s[8:11], s20 offen offset:1024 sc1
  s_setprio 1
  buffer_load_dwordx4 v[16:19], v2, s[8:11], s20 offen offset:2048 sc1
  s_setprio 0
  buffer_load_dwordx4 v[20:23], v2, s[8:11], s20 offen offset:3072 sc1
cA_sc3_go:
  s_waitcnt vmcnt(3)
  v_smfmac_f32_16x16x64_bf16 v[36:39], v[8:11], a[0:7], v3
  buffer_load_dwordx4 v[24:27], v2, s[8:11], s23 offen offset:0 sc1
  v_cmp_eq_u32 vcc, -1, v8
  v_smfmac_f32_16x16x64_bf16 v[40:43], v[8:11], a[56:63], v3
  v_smfmac_f32_16x16x64_bf16 v[44:47], v[8:11], a[112:119], v3
  buffer_load_dwordx4 v[28:31], v2, s[8:11], s23 offen offset:1024 sc1
  s_cbranch_vccnz cA_sc3_r0
  v_smfmac_f32_16x16x64_bf16 v[48:51], v[8:11], a[168:175], v3
  v_smfmac_f32_16x16x64_bf16 v[52:55], v[8:11], a[224:231], v3
  s_waitcnt vmcnt(4)
  v_cmp_eq_u32 vcc, -1, v12
  v_smfmac_f32_16x16x64_bf16 v[56:59], v[8:11], v[144:151], v3
  buffer_load_dwordx4 v[32:35], v2, s[8:11], s23 offen offset:2048 sc1
  v_smfmac_f32_16x16x64_bf16 v[62:65], v[8:11], v[200:207], v3
  s_cbranch_vccnz cA_sc3_r1
cA_sc3_c1:
  v_smfmac_f32_16x16x64_bf16 v[36:39], v[12:15], a[8:15], v3
  v_smfmac_f32_16x16x64_bf16 v[40:43], v[12:15], a[64:71], v3
  v_smfmac_f32_16x16x64_bf16 v[44:47], v[12:15], a[120:127], v3
  v_smfmac_f32_16x16x64_bf16 v[48:51], v[12:15], a[176:183], v3
  v_smfmac_f32_16x16x64_bf16 v[52:55], v[12:15], a[232:239], v3
  s_waitcnt vmcnt(4)
  v_cmp_eq_u32 vcc, -1, v16
  v_smfmac_f32_16x16x64_bf16 v[56:59], v[12:15], v[152:159], v3
  buffer_load_dwordx4 v[88:91], v117, s[8:11], s26 offen offset:0 sc1
  v_smfmac_f32_16x16x64_bf16 v[62:65], v[12:15], v[208:215], v3
  s_cbranch_vccnz cA_sc3_r2
cA_sc3_c2:
  v_smfmac_f32_16x16x64_bf16 v[36:39], v[16:19], a[16:23], v3
  v_smfmac_f32_16x16x64_bf16 v[40:43], v[16:19], a[72:79], v3
  v_smfmac_f32_16x16x64_bf16 v[44:47], v[16:19], a[128:135], v3
  buffer_load_dwordx4 v[92:95], v117, s[8:11], s26 offen offset:1024 sc1
  v_smfmac_f32_16x16x64_bf16 v[48:51], v[16:19], a[184:191], v3
  v_smfmac_f32_16x16x64_bf16 v[52:55], v[16:19], a[240:247], v3
  s_waitcnt vmcnt(5)
  v_cmp_eq_u32 vcc, -1, v20
  v_smfmac_f32_16x16x64_bf16 v[56:59], v[16:19], v[160:167], v3
  v_smfmac_f32_16x16x64_bf16 v[62:65], v[16:19], v[216:223], v3
  buffer_load_dwordx4 v[96:99], v2, s[8:11], s24 offen offset:0 sc1
  s_cbranch_vccnz cA_sc3_r3
cA_sc3_c3:
  v_smfmac_f32_16x16x64_bf16 v[36:39], v[20:23], a[24:31], v3
  v_smfmac_f32_16x16x64_bf16 v[40:43], v[20:23], a[80:87], v3
  s_waitcnt vmcnt(3)
  v_max3_u32 v66, v24, v27, v28
  v_smfmac_f32_16x16x64_bf16 v[44:47], v[20:23], a[136:143], v3
  v_max3_u32 v66, v66, v31, v32
  v_smfmac_f32_16x16x64_bf16 v[48:51], v[20:23], a[192:199], v3
  buffer_load_dwordx4 v[100:103], v2, s[8:11], s24 offen offset:1024 sc1
  v_max_u32 v66, v66, v35
  v_smfmac_f32_16x16x64_bf16 v[52:55], v[20:23], a[248:255], v3
  v_cmp_eq_u32 vcc, -1, v66
  v_smfmac_f32_16x16x64_bf16 v[56:59], v[20:23], v[168:175], v3
  v_smfmac_f32_16x16x64_bf16 v[62:65], v[20:23], v[224:231], v3
  s_cbranch_vccnz cA_sc3_r4
cA_sc3_c4:
  v_smfmac_f32_16x16x64_bf16 v[62:65], v[24:27], v[232:239], v3
  buffer_load_dwordx4 v[104:107], v2, s[8:11], s26 offen offset:0 sc1
  v_smfmac_f32_16x16x64_bf16 v[62:65], v[28:31], v[240:247], v3
  v_smfmac_f32_16x16x64_bf16 v[62:65], v[32:35], v[248:255], v3
  v_smfmac_f32_16x16x64_bf16 v[52:55], v[24:27], v[120:127], v3
  v_smfmac_f32_16x16x64_bf16 v[52:55], v[28:31], v[128:135], v3
  buffer_load_dwordx4 v[108:111], v2, s[8:11], s26 offen offset:1024 sc1
  v_smfmac_f32_16x16x64_bf16 v[52:55], v[32:35], v[136:143], v3
  v_cvt_pk_bf16_f32 v62, v62, v63
  v_smfmac_f32_16x16x64_bf16 v[56:59], v[24:27], v[176:183], v3
  v_cvt_pk_bf16_f32 v63, v64, v65
  v_smfmac_f32_16x16x64_bf16 v[56:59], v[28:31], v[184:191], v3
  v_mfma_f32_16x16x32_bf16 v[8:11], v[60:63], v[4:7], 0
  v_cvt_pk_bf16_f32 v55, v54, v55
  v_smfmac_f32_16x16x64_bf16 v[56:59], v[32:35], v[192:199], v3
  v_cvt_pk_bf16_f32 v54, v52, v53
  v_smfmac_f32_16x16x64_bf16 v[36:39], v[24:27], a[32:39], v3
  s_nop 1
  v_cvt_pk_bf16_f32 v78, v8, v9
  v_smfmac_f32_16x16x64_bf16 v[36:39], v[28:31], a[40:47], v3
  v_cvt_pk_bf16_f32 v79, v10, v11
  v_smfmac_f32_16x16x64_bf16 v[36:39], v[32:35], a[48:55], v3
  v_cvt_pk_bf16_f32 v56, v56, v57
  v_smfmac_f32_16x16x64_bf16 v[40:43], v[24:27], a[88:95], v3
  v_cvt_pk_bf16_f32 v57, v58, v59
  v_smfmac_f32_16x16x64_bf16 v[40:43], v[28:31], a[96:103], v3
  v_mfma_f32_16x16x32_bf16 v[12:15], v[54:57], v[4:7], 0
  v_cvt_pk_bf16_f32 v39, v38, v39
  v_smfmac_f32_16x16x64_bf16 v[40:43], v[32:35], a[104:111], v3
  v_cvt_pk_bf16_f32 v38, v36, v37
  v_smfmac_f32_16x16x64_bf16 v[44:47], v[24:27], a[144:151], v3
  s_nop 1
  v_cvt_pk_bf16_f32 v76, v12, v13
  v_smfmac_f32_16x16x64_bf16 v[44:47], v[28:31], a[152:159], v3
  v_cvt_pk_bf16_f32 v77, v14, v15
  v_smfmac_f32_16x16x64_bf16 v[44:47], v[32:35], a[160:167], v3
  v_cvt_pk_bf16_f32 v40, v40, v41
  v_smfmac_f32_16x16x64_bf16 v[48:51], v[24:27], a[200:207], v3
  v_cvt_pk_bf16_f32 v41, v42, v43
  v_smfmac_f32_16x16x64_bf16 v[48:51], v[28:31], a[208:215], v3
  v_smfmac_f32_16x16x64_bf16 v[48:51], v[32:35], a[216:223], v3
  s_waitcnt vmcnt(4)
  v_cvt_pk_bf16_f32 v47, v46, v47
  v_smfmac_f32_16x16x64_bf16 v[68:71], v[76:79], v[80:87], v3
  v_cvt_pk_bf16_f32 v46, v44, v45
  v_mfma_f32_16x16x32_bf16 v[8:11], v[38:41], v[4:7], 0
  s_nop 1
  v_cvt_pk_bf16_f32 v48, v48, v49
  v_cvt_pk_bf16_f32 v49, v50, v51
  s_nop 1
  v_mfma_f32_16x16x32_bf16 v[12:15], v[46:49], v[4:7], 0
  v_smfmac_f32_16x16x64_bf16 v[72:75], v[76:79], v[88:95], v3
  v_cvt_pk_bf16_f32 v16, v8, v9
  v_mfma_f32_16x16x32_bf16 v[52:55], v[30:33], v[76:79], 0
  s_waitcnt vmcnt(0)
  v_cvt_pk_bf16_f32 v17, v10, v11
  v_cvt_pk_bf16_f32 v18, v12, v13
  v_cvt_pk_bf16_f32 v19, v14, v15
  s_nop 1
  v_mfma_f32_16x16x32_bf16 v[52:55], v[20:23], v[16:19], v[52:55]
  v_smfmac_f32_16x16x64_bf16 v[68:71], v[16:19], v[96:103], v3
  v_smfmac_f32_16x16x64_bf16 v[72:75], v[16:19], v[104:111], v3
  s_nop 1
  ds_write_b128 v113, v[52:55]
  s_nop 1
  v_permlane32_swap_b32 v68, v70
  v_permlane32_swap_b32 v69, v71
  v_add_f32 v56, v68, v70
  v_add_f32 v58, v69, v71
  v_permlane32_swap_b32 v72, v74
  v_permlane32_swap_b32 v73, v75
  v_add_f32 v57, v72, v74
  v_add_f32 v59, v73, v75
  ds_write_b128 v2, v[56:59] offset:3072
  v_cmp_u_f32 vcc, v57, v59
  v_mov_b32 v68, 0
  v_mov_b32 v69, 0
  v_mov_b32 v70, 0
  v_mov_b32 v71, 0
  s_cbranch_vccnz cA_sc3_retry
cA_sc3_cont:
  s_add_u32 s24, s24, 28672
  s_add_u32 s26, s26, 28672
  buffer_load_dwordx4 v[80:83], v117, s[8:11], s24 offen offset:0 sc1
  buffer_load_dwordx4 v[84:87], v117, s[8:11], s24 offen offset:1024 sc1
  v_mov_b32 v72, 0
  v_mov_b32 v73, 0
  v_mfma_f32_16x16x32_bf16 v[62:65], v[68:71], v[68:71], 0
  s_waitcnt lgkmcnt(0)
  s_barrier
  v_mov_b32 v52, 0
  v_mov_b32 v53, 0
  v_mov_b32 v54, 0
  v_mov_b32 v55, 0
  v_mov_b32 v56, 0
  v_mov_b32 v57, 0
  v_mov_b32 v58, 0
  v_mov_b32 v59, 0
  v_mfma_f32_32x32x16_bf16 v[36:51], v[68:71], v[68:71], 0
  v_mov_b32 v74, 0
  v_mov_b32 v75, 0
  s_mov_b32 s19, s18
  s_add_u32 s18, s18, 1
  s_mov_b32 s22, s20
  s_mov_b32 s20, s21
  s_mov_b32 s21, s22
  s_add_u32 s23, s20, 4096
  s_cmp_lt_u32 s19, 63
  s_nop 2
  s_cbranch_scc1 cA_sc3_loop
  s_branch cA_done
cA_sc3_r0:
  s_add_u32 s31, s31, 1
  buffer_load_dwordx4 v[8:11], v2, s[8:11], s20 offen offset:0 sc1
  s_waitcnt vmcnt(0)
  v_cmp_eq_u32 vcc, -1, v8
  v_mov_b32 v36, 0
  v_mov_b32 v37, 0
  v_mov_b32 v38, 0
  v_mov_b32 v39, 0
  v_mov_b32 v40, 0
  v_mov_b32 v41, 0
  v_mov_b32 v42, 0
  v_mov_b32 v43, 0
  v_mov_b32 v44, 0
  v_mov_b32 v45, 0
  v_mov_b32 v46, 0
  v_mov_b32 v47, 0
  v_mov_b32 v48, 0
  v_mov_b32 v49, 0
  v_mov_b32 v50, 0
  v_mov_b32 v51, 0
  s_nop 1
  s_cbranch_vccz cA_sc3_go
  s_add_u32 s30, s30, 1
  s_cmp_lt_u32 s30, 400000
  s_cbranch_scc1 cA_sc3_r0
  s_branch cA_abort
cA_sc3_r1:
  s_add_u32 s31, s31, 1
  buffer_load_dwordx4 v[12:15], v2, s[8:11], s20 offen offset:1024 sc1
  s_waitcnt vmcnt(0)
  v_cmp_eq_u32 vcc, -1, v12
  s_nop 4
  s_cbranch_vccz cA_sc3_c1
  s_add_u32 s30, s30, 1
  s_cmp_lt_u32 s30, 400000
  s_cbranch_scc1 cA_sc3_r1
  s_branch cA_abort
cA_sc3_r2:
  s_add_u32 s31, s31, 1
  buffer_load_dwordx4 v[16:19], v2, s[8:11], s20 offen offset:2048 sc1
  s_waitcnt vmcnt(0)
  v_cmp_eq_u32 vcc, -1, v16
  s_nop 4
  s_cbranch_vccz cA_sc3_c2
  s_add_u32 s30, s30, 1
  s_cmp_lt_u32 s30, 400000
  s_cbranch_scc1 cA_sc3_r2
  s_branch cA_abort
cA_sc3_r3:
  s_add_u32 s31, s31, 1
  buffer_load_dwordx4 v[20:23], v2, s[8:11], s20 offen offset:3072 sc1
  s_waitcnt vmcnt(0)
  v_cmp_eq_u32 vcc, -1, v20
  s_nop 4
  s_cbranch_vccz cA_sc3_c3
  s_add_u32 s30, s30, 1
  s_cmp_lt_u32 s30, 400000
  s_cbranch_scc1 cA_sc3_r3
  s_branch cA_abort
cA_sc3_r4:
  s_add_u32 s31, s31, 1
  buffer_load_dwordx4 v[24:27], v2, s[8:11], s23 offen offset:0 sc1
  buffer_load_dwordx4 v[28:31], v2, s[8:11], s23 offen offset:1024 sc1
  buffer_load_dwordx4 v[32:35], v2, s[8:11], s23 offen offset:2048 sc1
  s_waitcnt vmcnt(0)
  v_max3_u32 v66, v24, v27, v28
  v_max3_u32 v66, v66, v31, v32
  v_max_u32 v66, v66, v35
  v_cmp_eq_u32 vcc, -1, v66
  s_nop 4
  s_cbranch_vccz cA_sc3_c4
  s_add_u32 s30, s30, 1
  s_cmp_lt_u32 s30, 400000
  s_cbranch_scc1 cA_sc3_r4
  s_branch cA_abort
cA_sc3_retry:
  s_cmp_lg_u32 s62, 0
  s_cbranch_scc1 cA_sc3_cont
  s_waitcnt vmcnt(0) lgkmcnt(0)
cA_sc3_rv:
  buffer_load_dwordx4 v[8:11], v2, s[8:11], s20 offen offset:0 sc1
  buffer_load_dwordx4 v[12:15], v2, s[8:11], s20 offen offset:1024 sc1
  buffer_load_dwordx4 v[16:19], v2, s[8:11], s20 offen offset:2048 sc1
  buffer_load_dwordx4 v[20:23], v2, s[8:11], s20 offen offset:3072 sc1
  buffer_load_dwordx4 v[24:27], v2, s[8:11], s23 offen offset:0 sc1
  buffer_load_dwordx4 v[28:31], v2, s[8:11], s23 offen offset:1024 sc1
  buffer_load_dwordx4 v[32:35], v2, s[8:11], s23 offen offset:2048 sc1
  s_waitcnt vmcnt(0)
  v_max3_u32 v66, v8, v9, v10
  v_max3_u32 v66, v66, v11, v12
  v_max3_u32 v66, v66, v13, v14
  v_max3_u32 v66, v66, v15, v16
  v_max3_u32 v66, v66, v17, v18
  v_max3_u32 v66, v66, v19, v20
  v_max3_u32 v66, v66, v21, v22
  v_max3_u32 v66, v66, v23, v24
  v_max3_u32 v66, v66, v25, v26
  v_max3_u32 v66, v66, v27, v28
  v_max3_u32 v66, v66, v29, v30
  v_max3_u32 v66, v66, v31, v32
  v_max3_u32 v66, v66, v33, v34
  v_max_u32 v66, v66, v35
  v_cmp_eq_u32 vcc, -1, v66
  s_cbranch_vccz cA_sc3_rk
  s_add_u32 s30, s30, 1
  s_cmp_lt_u32 s30, 400000
  s_cbranch_scc1 cA_sc3_rv
  s_branch cA_abort
cA_sc3_rk:
  s_mov_b32 s62, 1
  v_mov_b32 v36, 0
  v_mov_b32 v37, 0
  v_mov_b32 v38, 0
  v_mov_b32 v39, 0
  v_mov_b32 v40, 0
  v_mov_b32 v41, 0
  v_mov_b32 v42, 0
  v_mov_b32 v43, 0
  v_mov_b32 v44, 0
  v_mov_b32 v45, 0
  v_mov_b32 v46, 0
  v_mov_b32 v47, 0
  v_mov_b32 v48, 0
  v_mov_b32 v49, 0
  v_mov_b32 v50, 0
  v_mov_b32 v51, 0
  v_mov_b32 v62, 0
  v_mov_b32 v63, 0
  v_mov_b32 v64, 0
  v_mov_b32 v65, 0
  v_mov_b32 v68, 0
  v_mov_b32 v69, 0
  v_mov_b32 v70, 0
  v_mov_b32 v71, 0
  v_mov_b32 v72, 0
  v_mov_b32 v73, 0
  v_mov_b32 v74, 0
  v_mov_b32 v75, 0
  v_mov_b32 v52, 0
  v_mov_b32 v53, 0
  v_mov_b32 v54, 0
  v_mov_b32 v55, 0
  v_mov_b32 v56, 0
  v_mov_b32 v57, 0
  v_mov_b32 v58, 0
  v_mov_b32 v59, 0
  s_add_u32 s31, s31, 0x100
  s_nop 0
  s_branch cA_sc3_go
.p2align 6
cA_va0_loop:
  s_mov_b32 s30, 0
  s_barrier
  buffer_load_dwordx4 v[24:27], v2, s[8:11], s23 offen offset:0 sc1
  buffer_load_dwordx4 v[28:31], v2, s[8:11], s23 offen offset:1024 sc1
  s_barrier
  s_cmp_lt_u32 s19, 59
  s_cbranch_scc1 cA_va0_m1
  buffer_store_dword v160, v1, s[8:11], s38 offen sc1
  s_cmp_lg_u32 s19, 63
  s_cbranch_scc1 cA_va0_m2
  v_min_u32 v64, -2, v64
  v_min_u32 v65, -2, v65
  v_min_u32 v66, -2, v66
  v_min_u32 v67, -2, v67
  v_min_u32 v68, -2, v68
  v_min_u32 v69, -2, v69
  v_min_u32 v70, -2, v70
  v_min_u32 v71, -2, v71
  v_min_u32 v72, -2, v72
  v_min_u32 v73, -2, v73
  v_min_u32 v74, -2, v74
  v_min_u32 v75, -2, v75
  v_min_u32 v76, -2, v76
  v_min_u32 v77, -2, v77
  v_min_u32 v78, -2, v78
  v_min_u32 v79, -2, v79
  buffer_store_dwordx4 v[64:67], v2, s[8:11], s33 offen offset:0 sc1
  buffer_store_dwordx4 v[68:71], v2, s[8:11], s33 offen offset:2048 sc1
  s_add_u32 s33, s33, 4096
  buffer_store_dwordx4 v[72:75], v2, s[8:11], s33 offen offset:0 sc1
  buffer_store_dwordx4 v[76:79], v2, s[8:11], s33 offen offset:2048 sc1
  s_add_u32 s33, s33, 4096
  s_waitcnt vmcnt(5)
  s_branch cA_va0_m3
cA_va0_m1:
  buffer_store_dword v160, v1, s[8:11], s38 offen nt
cA_va0_m2:
  s_add_u32 s22, s25, 0
  buffer_load_dwordx4 v[80:83], v6, s[8:11], s22 offen offset:0 sc1
  buffer_load_dwordx4 v[84:87], v6, s[8:11], s22 offen offset:1792 sc1
  s_add_u32 s22, s25, 3584
  buffer_load_dwordx4 v[88:91], v6, s[8:11], s22 offen offset:0 sc1
  buffer_load_dwordx4 v[92:95], v6, s[8:11], s22 offen offset:1792 sc1
  s_add_u32 s22, s25, 7168
  buffer_load_dwordx4 v[96:99], v6, s[8:11], s22 offen offset:0 sc1
  s_mul_i32 s38, s18, 7168
  s_add_u32 s38, s38, 88002560
  s_waitcnt vmcnt(6)
cA_va0_m3:
  ds_write_b128 v2, v[24:27] offset:12288
  ds_write_b128 v2, v[28:31] offset:13312
  v_smfmac_f32_16x16x64_bf16 v[36:39], v[24:27], a[32:39], v3
  buffer_load_dwordx4 v[100:103], v6, s[8:11], s22 offen offset:1792 sc1
  v_smfmac_f32_16x16x64_bf16 v[40:43], v[24:27], a[88:95], v3
  s_add_u32 s22, s25, 10752
  buffer_load_dwordx4 v[104:107], v6, s[8:11], s22 offen offset:0 sc1
  v_smfmac_f32_16x16x64_bf16 v[44:47], v[24:27], a[144:151], v3
  buffer_load_dwordx4 v[108:111], v6, s[8:11], s22 offen offset:1792 sc1
  v_smfmac_f32_16x16x64_bf16 v[48:51], v[24:27], a[200:207], v3
  s_add_u32 s22, s25, 14336
  buffer_load_dwordx4 v[112:115], v6, s[8:11], s22 offen offset:0 sc1
  v_smfmac_f32_16x16x64_bf16 v[52:55], v[24:27], v[176:183], v3
  s_waitcnt lgkmcnt(0)
  s_barrier
  ds_read_b128 v[8:11], v2 offset:8192
  ds_read_b128 v[12:15], v2 offset:9216
  ds_read_b128 v[16:19], v2 offset:10240
  ds_read_b128 v[20:23], v2 offset:11264
  ds_read_b128 v[32:35], v2 offset:14336
  buffer_load_dwordx4 v[116:119], v6, s[8:11], s22 offen offset:1792 sc1
  v_smfmac_f32_16x16x64_bf16 v[56:59], v[24:27], v[232:239], v3
  s_add_u32 s22, s25, 17920
  buffer_load_dwordx4 v[120:123], v6, s[8:11], s22 offen offset:0 sc1
  v_smfmac_f32_16x16x64_bf16 v[36:39], v[28:31], a[40:47], v3
  buffer_load_dwordx4 v[124:127], v6, s[8:11], s22 offen offset:1792 sc1
  v_smfmac_f32_16x16x64_bf16 v[40:43], v[28:31], a[96:103], v3
  s_add_u32 s22, s25, 21504
  buffer_load_dwordx4 v[128:131], v6, s[8:11], s22 offen offset:0 sc1
  v_smfmac_f32_16x16x64_bf16 v[44:47], v[28:31], a[152:159], v3
  buffer_load_dwordx4 v[132:135], v6, s[8:11], s22 offen offset:1792 sc1
  v_smfmac_f32_16x16x64_bf16 v[48:51], v[28:31], a[208:215], v3
  s_add_u32 s22, s25, 25088
  buffer_load_dwordx4 v[136:139], v6, s[8:11], s22 offen offset:0 sc1
  v_smfmac_f32_16x16x64_bf16 v[52:55], v[28:31], v[184:191], v3
  buffer_load_dwordx4 v[140:143], v6, s[8:11], s22 offen offset:1792 sc1
  v_smfmac_f32_16x16x64_bf16 v[56:59], v[28:31], v[240:247], v3
  s_waitcnt lgkmcnt(4)
  v_smfmac_f32_16x16x64_bf16 v[36:39], v[8:11], a[0:7], v3
  s_waitcnt lgkmcnt(3)
  v_smfmac_f32_16x16x64_bf16 v[36:39], v[12:15], a[8:15], v3
  s_waitcnt lgkmcnt(2)
  v_smfmac_f32_16x16x64_bf16 v[36:39], v[16:19], a[16:23], v3
  s_waitcnt lgkmcnt(1)
  v_smfmac_f32_16x16x64_bf16 v[36:39], v[20:23], a[24:31], v3
  s_waitcnt lgkmcnt(0)
  v_smfmac_f32_16x16x64_bf16 v[36:39], v[32:35], a[48:55], v3
  v_smfmac_f32_16x16x64_bf16 v[40:43], v[8:11], a[56:63], v3
  v_smfmac_f32_16x16x64_bf16 v[40:43], v[12:15], a[64:71], v3
  v_smfmac_f32_16x16x64_bf16 v[40:43], v[16:19], a[72:79], v3
  v_permlane32_swap_b32 v36, v38
  v_smfmac_f32_16x16x64_bf16 v[40:43], v[20:23], a[80:87], v3
  v_permlane32_swap_b32 v37, v39
  v_smfmac_f32_16x16x64_bf16 v[40:43], v[32:35], a[104:111], v3
  v_add_f32 v36, v36, v38
  v_smfmac_f32_16x16x64_bf16 v[44:47], v[8:11], a[112:119], v3
  v_add_f32 v37, v37, v39
  v_smfmac_f32_16x16x64_bf16 v[44:47], v[12:15], a[120:127], v3
  v_cmp_u_f32 vcc, v36, v37
  v_smfmac_f32_16x16x64_bf16 v[44:47], v[16:19], a[128:135], v3
  v_cvt_pk_bf16_f32 v38, v36, v37
  v_smfmac_f32_16x16x64_bf16 v[44:47], v[20:23], a[136:143], v3
  ds_write_b32 v152, v38
  s_cbranch_vccnz cA_va0_slow
  v_permlane32_swap_b32 v40, v42
  v_smfmac_f32_16x16x64_bf16 v[44:47], v[32:35], a[160:167], v3
  v_permlane32_swap_b32 v41, v43
  v_smfmac_f32_16x16x64_bf16 v[48:51], v[8:11], a[168:175], v3
  buffer_store_dword v162, v1, s[8:11], s21 offen
  v_add_f32 v40, v40, v42
  v_smfmac_f32_16x16x64_bf16 v[48:51], v[12:15], a[176:183], v3
  v_add_f32 v41, v41, v43
  v_smfmac_f32_16x16x64_bf16 v[48:51], v[16:19], a[184:191], v3
  buffer_load_dword v164, v4, s[8:11], 0 offen sc1
  v_cvt_pk_bf16_f32 v42, v40, v41
  v_smfmac_f32_16x16x64_bf16 v[48:51], v[20:23], a[192:199], v3
  ds_write_b32 v153, v42
  v_permlane32_swap_b32 v44, v46
  v_smfmac_f32_16x16x64_bf16 v[48:51], v[32:35], a[216:223], v3
  v_permlane32_swap_b32 v45, v47
  v_smfmac_f32_16x16x64_bf16 v[52:55], v[8:11], a[224:231], v3
  buffer_load_dword v164, v4, s[8:11], 0 offen sc1
  v_add_f32 v44, v44, v46
  v_smfmac_f32_16x16x64_bf16 v[52:55], v[12:15], a[232:239], v3
  v_add_f32 v45, v45, v47
  v_smfmac_f32_16x16x64_bf16 v[52:55], v[16:19], a[240:247], v3
  v_cvt_pk_bf16_f32 v46, v44, v45
  v_smfmac_f32_16x16x64_bf16 v[52:55], v[20:23], a[248:255], v3
  ds_write_b32 v154, v46
  buffer_load_dword v164, v4, s[8:11], 0 offen sc1
  v_permlane32_swap_b32 v48, v50
  v_smfmac_f32_16x16x64_bf16 v[52:55], v[32:35], v[192:199], v3
  v_permlane32_swap_b32 v49, v51
  v_smfmac_f32_16x16x64_bf16 v[56:59], v[8:11], v[200:207], v3
  v_add_f32 v48, v48, v50
  v_smfmac_f32_16x16x64_bf16 v[56:59], v[12:15], v[208:215], v3
  buffer_load_dword v164, v4, s[8:11], 0 offen sc1
  v_add_f32 v49, v49, v51
  v_smfmac_f32_16x16x64_bf16 v[56:59], v[16:19], v[216:223], v3
  v_cvt_pk_bf16_f32 v50, v48, v49
  v_smfmac_f32_16x16x64_bf16 v[56:59], v[20:23], v[224:231], v3
  ds_write_b32 v155, v50
  v_permlane32_swap_b32 v52, v54
  v_smfmac_f32_16x16x64_bf16 v[56:59], v[32:35], v[248:255], v3
  buffer_load_dword v164, v4, s[8:11], 0 offen sc1
  v_permlane32_swap_b32 v53, v55
  v_add_f32 v52, v52, v54
  v_add_f32 v53, v53, v55
  v_cvt_pk_bf16_f32 v54, v52, v53
  ds_write_b32 v156, v54
  s_nop 1
  v_permlane32_swap_b32 v56, v58
  v_permlane32_swap_b32 v57, v59
  v_add_f32 v56, v56, v58
  v_add_f32 v57, v57, v59
  v_cvt_pk_bf16_f32 v58, v56, v57
  ds_write_b32 v157, v58
cA_va0_t2d:
  s_add_u32 s22, s20, 9216
  s_add_u32 s34, s20, 13312
  s_add_u32 s36, s20, 7168
  s_mov_b32 s37, 0
  v_mov_b32 v48, 0
  v_mov_b32 v49, 0
  v_mov_b32 v50, 0
  v_mov_b32 v51, 0
  v_mov_b32 v163, s18
  s_cmp_eq_u32 s19, 63
  s_waitcnt lgkmcnt(0)
  s_cbranch_scc1 cA_va0_last
  s_setprio 3
cA_va0_fw_l:
  v_cmp_gt_u32 vcc, s18, v164
  buffer_load_dword v164, v4, s[8:11], 0 offen sc1
  s_cbranch_vccz cA_va0_fw_d
  v_cmp_gt_u32 vcc, s18, v164
  buffer_load_dword v164, v4, s[8:11], 0 offen sc1
  s_cbranch_vccz cA_va0_fw_d
  v_cmp_gt_u32 vcc, s18, v164
  buffer_load_dword v164, v4, s[8:11], 0 offen sc1
  s_cbranch_vccz cA_va0_fw_d
  v_cmp_gt_u32 vcc, s18, v164
  buffer_load_dword v164, v4, s[8:11], 0 offen sc1
  s_cbranch_vccz cA_va0_fw_d
  v_cmp_gt_u32 vcc, s18, v164
  buffer_load_dword v164, v4, s[8:11], 0 offen sc1
  s_cbranch_vccz cA_va0_fw_d
  v_cmp_gt_u32 vcc, s18, v164
  buffer_load_dword v164, v4, s[8:11], 0 offen sc1
  s_cbranch_vccz cA_va0_fw_d
  v_cmp_gt_u32 vcc, s18, v164
  buffer_load_dword v164, v4, s[8:11], 0 offen sc1
  s_cbranch_vccz cA_va0_fw_d
  v_cmp_gt_u32 vcc, s18, v164
  buffer_load_dword v164, v4, s[8:11], 0 offen sc1
  s_cbranch_vccz cA_va0_fw_d
  v_cmp_gt_u32 vcc, s18, v164
  buffer_load_dword v164, v4, s[8:11], 0 offen sc1
  s_cbranch_vccz cA_va0_fw_d
  v_cmp_gt_u32 vcc, s18, v164
  buffer_load_dword v164, v4, s[8:11], 0 offen sc1
  s_cbranch_vccz cA_va0_fw_d
  v_cmp_gt_u32 vcc, s18, v164
  buffer_load_dword v164, v4, s[8:11], 0 offen sc1
  s_cbranch_vccz cA_va0_fw_d
  v_cmp_gt_u32 vcc, s18, v164
  buffer_load_dword v164, v4, s[8:11], 0 offen sc1
  s_cbranch_vccz cA_va0_fw_d
  v_cmp_gt_u32 vcc, s18, v164
  buffer_load_dword v164, v4, s[8:11], 0 offen sc1
  s_cbranch_vccz cA_va0_fw_d
  v_cmp_gt_u32 vcc, s18, v164
  buffer_load_dword v164, v4, s[8:11], 0 offen sc1
  s_cbranch_vccz cA_va0_fw_d
  v_cmp_gt_u32 vcc, s18, v164
  buffer_load_dword v164, v4, s[8:11], 0 offen sc1
  s_cbranch_vccz cA_va0_fw_d
  v_cmp_gt_u32 vcc, s18, v164
  buffer_load_dword v164, v4, s[8:11], 0 offen sc1
  s_cbranch_vccz cA_va0_fw_d
  s_waitcnt vmcnt(24)
  s_add_u32 s30, s30, 1
  s_cmp_lt_u32 s30, 400000
  s_cbranch_scc1 cA_va0_fw_l
  s_branch cA_abort
cA_va0_fw_d:
  buffer_load_dwordx4 v[8:11], v2, s[8:11], s22 offen offset:0 sc1
  buffer_load_dwordx4 v[12:15], v2, s[8:11], s22 offen offset:1024 sc1
  buffer_load_dwordx4 v[16:19], v2, s[8:11], s22 offen offset:2048 sc1
  buffer_load_dwordx4 v[20:23], v2, s[8:11], s22 offen offset:3072 sc1
  buffer_load_dwordx4 v[24:27], v2, s[8:11], s34 offen offset:0 sc1
  buffer_load_dwordx4 v[28:31], v2, s[8:11], s34 offen offset:1024 sc1
  buffer_load_dwordx4 v[32:35], v2, s[8:11], s34 offen offset:2048 sc1
  buffer_load_dwordx4 v[36:39], v2, s[8:11], s34 offen offset:3072 sc1
  buffer_load_dwordx4 v[40:43], v2, s[8:11], s36 offen offset:0 sc1
  buffer_load_dwordx4 v[44:47], v2, s[8:11], s36 offen offset:1024 sc1
  s_barrier
  ds_read_b128 v[64:67], v2 offset:0
  ds_read_b128 v[68:71], v2 offset:1024
  ds_read_b128 v[72:75], v2 offset:2048
  ds_read_b128 v[76:79], v2 offset:3072
cA_va0_lp:
  s_waitcnt vmcnt(9)
  v_smfmac_f32_16x16x64_bf16 v[48:51], v[8:11], v[80:87], v3
  s_waitcnt vmcnt(8)
  v_smfmac_f32_16x16x64_bf16 v[48:51], v[12:15], v[88:95], v3
  s_waitcnt vmcnt(7)
  v_smfmac_f32_16x16x64_bf16 v[48:51], v[16:19], v[96:103], v3
  s_waitcnt vmcnt(6)
  v_smfmac_f32_16x16x64_bf16 v[48:51], v[20:23], v[104:111], v3
  s_waitcnt vmcnt(5)
  v_smfmac_f32_16x16x64_bf16 v[48:51], v[24:27], v[112:119], v3
  s_waitcnt vmcnt(4)
  v_smfmac_f32_16x16x64_bf16 v[48:51], v[28:31], v[120:127], v3
  s_waitcnt vmcnt(3)
  v_smfmac_f32_16x16x64_bf16 v[48:51], v[32:35], v[128:135], v3
  s_waitcnt vmcnt(2)
  v_smfmac_f32_16x16x64_bf16 v[48:51], v[36:39], v[136:143], v3
  s_waitcnt vmcnt(1) lgkmcnt(0)
  v_smfmac_f32_16x16x64_bf16 v[48:51], v[40:43], v[64:71], v3
  s_waitcnt vmcnt(0)
  v_smfmac_f32_16x16x64_bf16 v[48:51], v[44:47], v[72:79], v3
  s_nop 7
  v_permlane32_swap_b32 v48, v50
  v_permlane32_swap_b32 v49, v51
  v_pk_add_f32 v[48:49], v[48:49], v[50:51]
  v_cvt_pk_bf16_f32 v160, v48, v49
  v_cmp_u_f32 vcc, v48, v49
  s_nop 0
  v_mov_b32_dpp v161, v160 quad_perm:[1,0,3,2] row_mask:0xf bank_mask:0xf
  v_perm_b32 v160, v161, v160, v5
  v_cndmask_b32 v161, v160, v162, vcc
  buffer_store_dword v161, v1, s[8:11], s21 offen
  s_cbranch_vccnz cA_va0_rp
cA_va0_cont:
  s_setprio 0
  s_cmp_lg_u32 s19, 62
  s_cbranch_scc1 cA_va0_nl
  s_sleep 4
  buffer_store_dword v160, v1, s[8:11], s38 offen sc1
  s_mov_b32 s38, 0x40000000
  s_mov_b32 s25, 0x40000000
cA_va0_nl:
  s_add_u32 s25, s25, 458752
  v_mov_b32 v36, 0
  v_mov_b32 v37, 0
  v_mov_b32 v38, 0
  v_mov_b32 v39, 0
  v_mov_b32 v40, 0
  v_mov_b32 v41, 0
  v_mov_b32 v42, 0
  v_mov_b32 v43, 0
  v_mov_b32 v44, 0
  v_mov_b32 v45, 0
  v_mov_b32 v46, 0
  v_mov_b32 v47, 0
  v_mov_b32 v48, 0
  v_mov_b32 v49, 0
  v_mov_b32 v50, 0
  v_mov_b32 v51, 0
  v_mov_b32 v52, 0
  v_mov_b32 v53, 0
  v_mov_b32 v54, 0
  v_mov_b32 v55, 0
  v_mov_b32 v56, 0
  v_mov_b32 v57, 0
  v_mov_b32 v58, 0
  v_mov_b32 v59, 0
  v_mov_b32 v60, 0
  v_mov_b32 v61, 0
  v_mov_b32 v62, 0
  v_mov_b32 v63, 0
  s_mov_b32 s19, s18
  s_add_u32 s18, s18, 1
  s_mov_b32 s22, s20
  s_mov_b32 s20, s21
  s_mov_b32 s21, s22
  s_add_u32 s23, s20, 4096
  s_branch cA_va0_loop
cA_va0_slow:
  s_waitcnt lgkmcnt(0)
cA_va0_sl1:
  s_add_u32 s31, s31, 0x1000000
  buffer_load_dwordx4 v[8:11], v2, s[8:11], s20 offen offset:0 sc1
  buffer_load_dwordx4 v[12:15], v2, s[8:11], s20 offen offset:1024 sc1
  buffer_load_dwordx4 v[16:19], v2, s[8:11], s20 offen offset:2048 sc1
  buffer_load_dwordx4 v[20:23], v2, s[8:11], s20 offen offset:3072 sc1
  buffer_load_dwordx4 v[24:27], v2, s[8:11], s23 offen offset:0 sc1
  buffer_load_dwordx4 v[28:31], v2, s[8:11], s23 offen offset:1024 sc1
  buffer_load_dwordx4 v[32:35], v2, s[8:11], s23 offen offset:2048 sc1
  s_waitcnt vmcnt(0)
  v_max3_u32 v36, v8, v9, v10
  v_max3_u32 v36, v36, v11, v12
  v_max3_u32 v36, v36, v13, v14
  v_max3_u32 v36, v36, v15, v16
  v_max3_u32 v36, v36, v17, v18
  v_max3_u32 v36, v36, v19, v20
  v_max3_u32 v36, v36, v21, v22
  v_max3_u32 v36, v36, v23, v24
  v_max3_u32 v36, v36, v25, v26
  v_max3_u32 v36, v36, v27, v28
  v_max3_u32 v36, v36, v29, v30
  v_max3_u32 v36, v36, v31, v32
  v_max3_u32 v36, v36, v33, v34
  v_max_u32 v36, v36, v35
  v_cmp_eq_u32 vcc, -1, v36
  s_cbranch_vccz cA_va0_sl2
  s_add_u32 s30, s30, 1
  s_cmp_lt_u32 s30, 400000
  s_cbranch_scc1 cA_va0_sl1
  s_branch cA_abort
cA_va0_sl2:
  v_mov_b32 v36, 0
  v_mov_b32 v37, 0
  v_mov_b32 v38, 0
  v_mov_b32 v39, 0
  v_mov_b32 v40, 0
  v_mov_b32 v41, 0
  v_mov_b32 v42, 0
  v_mov_b32 v43, 0
  v_mov_b32 v44, 0
  v_mov_b32 v45, 0
  v_mov_b32 v46, 0
  v_mov_b32 v47, 0
  v_mov_b32 v48, 0
  v_mov_b32 v49, 0
  v_mov_b32 v50, 0
  v_mov_b32 v51, 0
  v_mov_b32 v52, 0
  v_mov_b32 v53, 0
  v_mov_b32 v54, 0
  v_mov_b32 v55, 0
  v_mov_b32 v56, 0
  v_mov_b32 v57, 0
  v_mov_b32 v58, 0
  v_mov_b32 v59, 0
  v_mov_b32 v60, 0
  v_mov_b32 v61, 0
  v_mov_b32 v62, 0
  v_mov_b32 v63, 0
  buffer_store_dword v162, v1, s[8:11], s21 offen
  v_smfmac_f32_16x16x64_bf16 v[36:39], v[8:11], a[0:7], v3
  v_smfmac_f32_16x16x64_bf16 v[40:43], v[8:11], a[56:63], v3
  v_smfmac_f32_16x16x64_bf16 v[44:47], v[8:11], a[112:119], v3
  v_smfmac_f32_16x16x64_bf16 v[48:51], v[8:11], a[168:175], v3
  v_smfmac_f32_16x16x64_bf16 v[52:55], v[8:11], a[224:231], v3
  v_smfmac_f32_16x16x64_bf16 v[56:59], v[8:11], v[200:207], v3
  v_smfmac_f32_16x16x64_bf16 v[36:39], v[12:15], a[8:15], v3
  v_smfmac_f32_16x16x64_bf16 v[40:43], v[12:15], a[64:71], v3
  v_smfmac_f32_16x16x64_bf16 v[44:47], v[12:15], a[120:127], v3
  v_smfmac_f32_16x16x64_bf16 v[48:51], v[12:15], a[176:183], v3
  v_smfmac_f32_16x16x64_bf16 v[52:55], v[12:15], a[232:239], v3
  v_smfmac_f32_16x16x64_bf16 v[56:59], v[12:15], v[208:215], v3
  v_smfmac_f32_16x16x64_bf16 v[36:39], v[16:19], a[16:23], v3
  v_smfmac_f32_16x16x64_bf16 v[40:43], v[16:19], a[72:79], v3
  v_smfmac_f32_16x16x64_bf16 v[44:47], v[16:19], a[128:135], v3
  v_smfmac_f32_16x16x64_bf16 v[48:51], v[16:19], a[184:191], v3
  v_smfmac_f32_16x16x64_bf16 v[52:55], v[16:19], a[240:247], v3
  v_smfmac_f32_16x16x64_bf16 v[56:59], v[16:19], v[216:223], v3
  v_smfmac_f32_16x16x64_bf16 v[36:39], v[20:23], a[24:31], v3
  v_smfmac_f32_16x16x64_bf16 v[40:43], v[20:23], a[80:87], v3
  v_smfmac_f32_16x16x64_bf16 v[44:47], v[20:23], a[136:143], v3
  v_smfmac_f32_16x16x64_bf16 v[48:51], v[20:23], a[192:199], v3
  v_smfmac_f32_16x16x64_bf16 v[52:55], v[20:23], a[248:255], v3
  v_smfmac_f32_16x16x64_bf16 v[56:59], v[20:23], v[224:231], v3
  v_smfmac_f32_16x16x64_bf16 v[36:39], v[24:27], a[32:39], v3
  v_smfmac_f32_16x16x64_bf16 v[40:43], v[24:27], a[88:95], v3
  v_smfmac_f32_16x16x64_bf16 v[44:47], v[24:27], a[144:151], v3
  v_smfmac_f32_16x16x64_bf16 v[48:51], v[24:27], a[200:207], v3
  v_smfmac_f32_16x16x64_bf16 v[52:55], v[24:27], v[176:183], v3
  v_smfmac_f32_16x16x64_bf16 v[56:59], v[24:27], v[232:239], v3
  v_smfmac_f32_16x16x64_bf16 v[36:39], v[28:31], a[40:47], v3
  v_smfmac_f32_16x16x64_bf16 v[40:43], v[28:31], a[96:103], v3
  v_smfmac_f32_16x16x64_bf16 v[44:47], v[28:31], a[152:159], v3
  v_smfmac_f32_16x16x64_bf16 v[48:51], v[28:31], a[208:215], v3
  v_smfmac_f32_16x16x64_bf16 v[52:55], v[28:31], v[184:191], v3
  v_smfmac_f32_16x16x64_bf16 v[56:59], v[28:31], v[240:247], v3
  v_smfmac_f32_16x16x64_bf16 v[36:39], v[32:35], a[48:55], v3
  v_smfmac_f32_16x16x64_bf16 v[40:43], v[32:35], a[104:111], v3
  v_smfmac_f32_16x16x64_bf16 v[44:47], v[32:35], a[160:167], v3
  v_smfmac_f32_16x16x64_bf16 v[48:51], v[32:35], a[216:223], v3
  v_smfmac_f32_16x16x64_bf16 v[52:55], v[32:35], v[192:199], v3
  v_smfmac_f32_16x16x64_bf16 v[56:59], v[32:35], v[248:255], v3
  v_permlane32_swap_b32 v36, v38
  v_permlane32_swap_b32 v37, v39
  v_add_f32 v36, v36, v38
  v_add_f32 v37, v37, v39
  v_cvt_pk_bf16_f32 v38, v36, v37
  ds_write_b32 v152, v38
  v_permlane32_swap_b32 v40, v42
  v_permlane32_swap_b32 v41, v43
  v_add_f32 v40, v40, v42
  v_add_f32 v41, v41, v43
  v_cvt_pk_bf16_f32 v42, v40, v41
  ds_write_b32 v153, v42
  v_permlane32_swap_b32 v44, v46
  v_permlane32_swap_b32 v45, v47
  v_add_f32 v44, v44, v46
  v_add_f32 v45, v45, v47
  v_cvt_pk_bf16_f32 v46, v44, v45
  ds_write_b32 v154, v46
  v_permlane32_swap_b32 v48, v50
  v_permlane32_swap_b32 v49, v51
  v_add_f32 v48, v48, v50
  v_add_f32 v49, v49, v51
  v_cvt_pk_bf16_f32 v50, v48, v49
  ds_write_b32 v155, v50
  v_permlane32_swap_b32 v52, v54
  v_permlane32_swap_b32 v53, v55
  v_add_f32 v52, v52, v54
  v_add_f32 v53, v53, v55
  v_cvt_pk_bf16_f32 v54, v52, v53
  ds_write_b32 v156, v54
  v_permlane32_swap_b32 v56, v58
  v_permlane32_swap_b32 v57, v59
  v_add_f32 v56, v56, v58
  v_add_f32 v57, v57, v59
  v_cvt_pk_bf16_f32 v58, v56, v57
  ds_write_b32 v157, v58
  buffer_load_dword v164, v4, s[8:11], 0 offen sc1
  buffer_load_dword v164, v4, s[8:11], 0 offen sc1
  buffer_load_dword v164, v4, s[8:11], 0 offen sc1
  buffer_load_dword v164, v4, s[8:11], 0 offen sc1
  buffer_load_dword v164, v4, s[8:11], 0 offen sc1
  s_branch cA_va0_t2d
cA_va0_last:
  s_barrier
  ds_read_b128 v[64:67], v2 offset:0
  ds_read_b128 v[68:71], v2 offset:1024
  ds_read_b128 v[72:75], v2 offset:2048
  ds_read_b128 v[76:79], v2 offset:3072
  s_waitcnt lgkmcnt(0)
  v_min_u32 v64, -2, v64
  v_min_u32 v65, -2, v65
  v_min_u32 v66, -2, v66
  v_min_u32 v67, -2, v67
  v_min_u32 v68, -2, v68
  v_min_u32 v69, -2, v69
  v_min_u32 v70, -2, v70
  v_min_u32 v71, -2, v71
  v_min_u32 v72, -2, v72
  v_min_u32 v73, -2, v73
  v_min_u32 v74, -2, v74
  v_min_u32 v75, -2, v75
  v_min_u32 v76, -2, v76
  v_min_u32 v77, -2, v77
  v_min_u32 v78, -2, v78
  v_min_u32 v79, -2, v79
  buffer_store_dwordx4 v[64:67], v2, s[8:11], s33 offen offset:0 sc1
  buffer_store_dwordx4 v[68:71], v2, s[8:11], s33 offen offset:2048 sc1
  s_add_u32 s33, s33, 4096
  buffer_store_dwordx4 v[72:75], v2, s[8:11], s33 offen offset:0 sc1
  buffer_store_dwordx4 v[76:79], v2, s[8:11], s33 offen offset:2048 sc1
  s_add_u32 s33, s33, 4096
  s_waitcnt vmcnt(0)
  buffer_wbl2 sc1
  s_branch cA_done
cA_va0_rp:
  s_cmp_eq_u32 s37, 0
  s_cbranch_scc1 cA_va0_rv
  v_min_u32 v160, -2, v160
  buffer_store_dword v160, v1, s[8:11], s21 offen
  s_branch cA_va0_cont
cA_va0_rv:
  s_add_u32 s31, s31, 0x10000
  buffer_load_dwordx4 v[8:11], v2, s[8:11], s22 offen offset:0 sc1
  buffer_load_dwordx4 v[12:15], v2, s[8:11], s22 offen offset:1024 sc1
  buffer_load_dwordx4 v[16:19], v2, s[8:11], s22 offen offset:2048 sc1
  buffer_load_dwordx4 v[20:23], v2, s[8:11], s22 offen offset:3072 sc1
  buffer_load_dwordx4 v[24:27], v2, s[8:11], s34 offen offset:0 sc1
  buffer_load_dwordx4 v[28:31], v2, s[8:11], s34 offen offset:1024 sc1
  buffer_load_dwordx4 v[32:35], v2, s[8:11], s34 offen offset:2048 sc1
  buffer_load_dwordx4 v[36:39], v2, s[8:11], s34 offen offset:3072 sc1
  buffer_load_dwordx4 v[40:43], v2, s[8:11], s36 offen offset:0 sc1
  buffer_load_dwordx4 v[44:47], v2, s[8:11], s36 offen offset:1024 sc1
  s_waitcnt vmcnt(0)
  v_max3_u32 v52, v8, v9, v10
  v_max3_u32 v52, v52, v11, v12
  v_max3_u32 v52, v52, v13, v14
  v_max3_u32 v52, v52, v15, v16
  v_max3_u32 v52, v52, v17, v18
  v_max3_u32 v52, v52, v19, v20
  v_max3_u32 v52, v52, v21, v22
  v_max3_u32 v52, v52, v23, v24
  v_max3_u32 v52, v52, v25, v26
  v_max3_u32 v52, v52, v27, v28
  v_max3_u32 v52, v52, v29, v30
  v_max3_u32 v52, v52, v31, v32
  v_max3_u32 v52, v52, v33, v34
  v_max3_u32 v52, v52, v35, v36
  v_max3_u32 v52, v52, v37, v38
  v_max3_u32 v52, v52, v39, v40
  v_max3_u32 v52, v52, v41, v42
  v_max3_u32 v52, v52, v43, v44
  v_max3_u32 v52, v52, v45, v46
  v_max_u32 v52, v52, v47
  v_cmp_eq_u32 vcc, -1, v52
  s_mov_b32 s37, 1
  v_mov_b32 v48, 0
  v_mov_b32 v49, 0
  v_mov_b32 v50, 0
  v_mov_b32 v51, 0
  s_nop 1
  s_cbranch_vccz cA_va0_lp
  s_add_u32 s30, s30, 1
  s_cmp_lt_u32 s30, 400000
  s_cbranch_scc1 cA_va0_rv
  s_branch cA_abort
.p2align 6
cA_va1_loop:
  s_mov_b32 s30, 0
  s_barrier
  buffer_load_dwordx4 v[28:31], v2, s[8:11], s23 offen offset:1024 sc1
  buffer_load_dwordx4 v[32:35], v2, s[8:11], s23 offen offset:2048 sc1
  s_barrier
  s_cmp_lt_u32 s19, 59
  s_cbranch_scc1 cA_va1_m1
  buffer_store_dword v160, v1, s[8:11], s38 offen sc1
  s_cmp_lg_u32 s19, 63
  s_cbranch_scc1 cA_va1_m2
  v_min_u32 v64, -2, v64
  v_min_u32 v65, -2, v65
  v_min_u32 v66, -2, v66
  v_min_u32 v67, -2, v67
  v_min_u32 v68, -2, v68
  v_min_u32 v69, -2, v69
  v_min_u32 v70, -2, v70
  v_min_u32 v71, -2, v71
  v_min_u32 v72, -2, v72
  v_min_u32 v73, -2, v73
  v_min_u32 v74, -2, v74
  v_min_u32 v75, -2, v75
  v_min_u32 v76, -2, v76
  v_min_u32 v77, -2, v77
  v_min_u32 v78, -2, v78
  v_min_u32 v79, -2, v79
  buffer_store_dwordx4 v[64:67], v2, s[8:11], s33 offen offset:0 sc1
  buffer_store_dwordx4 v[68:71], v2, s[8:11], s33 offen offset:2048 sc1
  s_add_u32 s33, s33, 4096
  buffer_store_dwordx4 v[72:75], v2, s[8:11], s33 offen offset:0 sc1
  buffer_store_dwordx4 v[76:79], v2, s[8:11], s33 offen offset:2048 sc1
  s_add_u32 s33, s33, 4096
  s_waitcnt vmcnt(5)
  s_branch cA_va1_m3
cA_va1_m1:
  buffer_store_dword v160, v1, s[8:11], s38 offen nt
cA_va1_m2:
  s_add_u32 s22, s25, 0
  buffer_load_dwordx4 v[80:83], v6, s[8:11], s22 offen offset:0 sc1
  buffer_load_dwordx4 v[84:87], v6, s[8:11], s22 offen offset:1792 sc1
  s_add_u32 s22, s25, 3584
  buffer_load_dwordx4 v[88:91], v6, s[8:11], s22 offen offset:0 sc1
  buffer_load_dwordx4 v[92:95], v6, s[8:11], s22 offen offset:1792 sc1
  s_add_u32 s22, s25, 7168
  buffer_load_dwordx4 v[96:99], v6, s[8:11], s22 offen offset:0 sc1
  s_mul_i32 s38, s18, 7168
  s_add_u32 s38, s38, 88002560
  s_waitcnt vmcnt(6)
cA_va1_m3:
  ds_write_b128 v2, v[32:35] offset:14336
  v_smfmac_f32_16x16x64_bf16 v[36:39], v[28:31], a[40:47], v3
  buffer_load_dwordx4 v[100:103], v6, s[8:11], s22 offen offset:1792 sc1
  v_smfmac_f32_16x16x64_bf16 v[40:43], v[28:31], a[96:103], v3
  s_add_u32 s22, s25, 10752
  buffer_load_dwordx4 v[104:107], v6, s[8:11], s22 offen offset:0 sc1
  v_smfmac_f32_16x16x64_bf16 v[44:47], v[28:31], a[152:159], v3
  buffer_load_dwordx4 v[108:111], v6, s[8:11], s22 offen offset:1792 sc1
  v_smfmac_f32_16x16x64_bf16 v[48:51], v[28:31], a[208:215], v3
  s_add_u32 s22, s25, 14336
  buffer_load_dwordx4 v[112:115], v6, s[8:11], s22 offen offset:0 sc1
  v_smfmac_f32_16x16x64_bf16 v[52:55], v[28:31], v[184:191], v3
  s_waitcnt lgkmcnt(0)
  s_barrier
  ds_read_b128 v[8:11], v2 offset:8192
  ds_read_b128 v[12:15], v2 offset:9216
  ds_read_b128 v[16:19], v2 offset:10240
  ds_read_b128 v[20:23], v2 offset:11264
  ds_read_b128 v[24:27], v2 offset:12288
  buffer_load_dwordx4 v[116:119], v6, s[8:11], s22 offen offset:1792 sc1
  v_smfmac_f32_16x16x64_bf16 v[56:59], v[28:31], v[240:247], v3
  s_add_u32 s22, s25, 17920
  buffer_load_dwordx4 v[120:123], v6, s[8:11], s22 offen offset:0 sc1
  v_smfmac_f32_16x16x64_bf16 v[36:39], v[32:35], a[48:55], v3
  buffer_load_dwordx4 v[124:127], v6, s[8:11], s22 offen offset:1792 sc1
  v_smfmac_f32_16x16x64_bf16 v[40:43], v[32:35], a[104:111], v3
  s_add_u32 s22, s25, 21504
  buffer_load_dwordx4 v[128:131], v6, s[8:11], s22 offen offset:0 sc1
  v_smfmac_f32_16x16x64_bf16 v[44:47], v[32:35], a[160:167], v3
  buffer_load_dwordx4 v[132:135], v6, s[8:11], s22 offen offset:1792 sc1
  v_smfmac_f32_16x16x64_bf16 v[48:51], v[32:35], a[216:223], v3
  s_add_u32 s22, s25, 25088
  buffer_load_dwordx4 v[136:139], v6, s[8:11], s22 offen offset:0 sc1
  v_smfmac_f32_16x16x64_bf16 v[52:55], v[32:35], v[192:199], v3
  ds_read_b128 v[64:67], v0 offset:0
  ds_read_b128 v[68:71], v0 offset:1024
  buffer_load_dwordx4 v[140:143], v6, s[8:11], s22 offen offset:1792 sc1
  v_smfmac_f32_16x16x64_bf16 v[56:59], v[32:35], v[248:255], v3
  s_waitcnt lgkmcnt(6)
  ds_read_b128 v[72:75], v0 offset:2048
  ds_read_b128 v[76:79], v0 offset:3072
  v_smfmac_f32_16x16x64_bf16 v[36:39], v[8:11], a[0:7], v3
  s_waitcnt lgkmcnt(7)
  v_smfmac_f32_16x16x64_bf16 v[36:39], v[12:15], a[8:15], v3
  s_waitcnt lgkmcnt(6)
  v_smfmac_f32_16x16x64_bf16 v[36:39], v[16:19], a[16:23], v3
  s_waitcnt lgkmcnt(2)
  v_smfmac_f32_16x16x64_bf16 v[60:63], v[8:11], v[64:71], v3
  s_waitcnt lgkmcnt(5)
  ds_read_b128 v[144:147], v0 offset:4096
  ds_read_b128 v[148:151], v0 offset:5120
  v_smfmac_f32_16x16x64_bf16 v[36:39], v[20:23], a[24:31], v3
  s_waitcnt lgkmcnt(6)
  v_smfmac_f32_16x16x64_bf16 v[36:39], v[24:27], a[32:39], v3
  v_smfmac_f32_16x16x64_bf16 v[40:43], v[8:11], a[56:63], v3
  s_waitcnt lgkmcnt(2)
  v_smfmac_f32_16x16x64_bf16 v[60:63], v[12:15], v[72:79], v3
  ds_read_b128 v[64:67], v0 offset:6144
  ds_read_b128 v[68:71], v0 offset:7168
  v_smfmac_f32_16x16x64_bf16 v[40:43], v[12:15], a[64:71], v3
  v_permlane32_swap_b32 v36, v38
  v_smfmac_f32_16x16x64_bf16 v[40:43], v[16:19], a[72:79], v3
  v_permlane32_swap_b32 v37, v39
  v_smfmac_f32_16x16x64_bf16 v[40:43], v[20:23], a[80:87], v3
  s_waitcnt lgkmcnt(2)
  v_add_f32 v36, v36, v38
  v_smfmac_f32_16x16x64_bf16 v[60:63], v[16:19], v[144:151], v3
  ds_read_b128 v[72:75], v0 offset:8192
  ds_read_b128 v[76:79], v0 offset:9216
  v_add_f32 v37, v37, v39
  v_smfmac_f32_16x16x64_bf16 v[40:43], v[24:27], a[88:95], v3
  v_cmp_u_f32 vcc, v36, v37
  v_smfmac_f32_16x16x64_bf16 v[44:47], v[8:11], a[112:119], v3
  v_cvt_pk_bf16_f32 v38, v36, v37
  v_smfmac_f32_16x16x64_bf16 v[44:47], v[12:15], a[120:127], v3
  ds_write_b32 v152, v38
  s_waitcnt lgkmcnt(3)
  s_cbranch_vccnz cA_va1_slow
  v_permlane32_swap_b32 v40, v42
  v_smfmac_f32_16x16x64_bf16 v[60:63], v[20:23], v[64:71], v3
  ds_read_b128 v[144:147], v0 offset:10240
  ds_read_b128 v[148:151], v0 offset:11264
  v_permlane32_swap_b32 v41, v43
  v_smfmac_f32_16x16x64_bf16 v[44:47], v[16:19], a[128:135], v3
  buffer_store_dword v162, v1, s[8:11], s21 offen
  v_add_f32 v40, v40, v42
  v_smfmac_f32_16x16x64_bf16 v[44:47], v[20:23], a[136:143], v3
  v_add_f32 v41, v41, v43
  v_smfmac_f32_16x16x64_bf16 v[44:47], v[24:27], a[144:151], v3
  s_waitcnt lgkmcnt(3)
  v_cvt_pk_bf16_f32 v42, v40, v41
  v_smfmac_f32_16x16x64_bf16 v[60:63], v[24:27], v[72:79], v3
  ds_write_b32 v153, v42
  ds_read_b128 v[64:67], v0 offset:12288
  ds_read_b128 v[68:71], v0 offset:13312
  v_smfmac_f32_16x16x64_bf16 v[48:51], v[8:11], a[168:175], v3
  s_nop 0
  v_permlane32_swap_b32 v44, v46
  v_smfmac_f32_16x16x64_bf16 v[48:51], v[12:15], a[176:183], v3
  v_permlane32_swap_b32 v45, v47
  v_smfmac_f32_16x16x64_bf16 v[48:51], v[16:19], a[184:191], v3
  s_waitcnt lgkmcnt(3)
  v_add_f32 v44, v44, v46
  v_smfmac_f32_16x16x64_bf16 v[60:63], v[28:31], v[144:151], v3
  v_add_f32 v45, v45, v47
  v_smfmac_f32_16x16x64_bf16 v[48:51], v[20:23], a[192:199], v3
  v_cvt_pk_bf16_f32 v46, v44, v45
  v_smfmac_f32_16x16x64_bf16 v[48:51], v[24:27], a[200:207], v3
  ds_write_b32 v154, v46
  v_smfmac_f32_16x16x64_bf16 v[52:55], v[8:11], a[224:231], v3
  s_waitcnt lgkmcnt(1)
  v_smfmac_f32_16x16x64_bf16 v[60:63], v[32:35], v[64:71], v3
  v_smfmac_f32_16x16x64_bf16 v[52:55], v[12:15], a[232:239], v3
  v_permlane32_swap_b32 v48, v50
  v_smfmac_f32_16x16x64_bf16 v[52:55], v[16:19], a[240:247], v3
  v_permlane32_swap_b32 v49, v51
  v_smfmac_f32_16x16x64_bf16 v[52:55], v[20:23], a[248:255], v3
  v_add_f32 v48, v48, v50
  v_smfmac_f32_16x16x64_bf16 v[52:55], v[24:27], v[176:183], v3
  v_add_f32 v49, v49, v51
  v_smfmac_f32_16x16x64_bf16 v[56:59], v[8:11], v[200:207], v3
  v_cvt_pk_bf16_f32 v50, v48, v49
  v_smfmac_f32_16x16x64_bf16 v[56:59], v[12:15], v[208:215], v3
  ds_write_b32 v155, v50
  v_permlane32_swap_b32 v60, v62
  v_smfmac_f32_16x16x64_bf16 v[56:59], v[16:19], v[216:223], v3
  v_permlane32_swap_b32 v61, v63
  v_smfmac_f32_16x16x64_bf16 v[56:59], v[20:23], v[224:231], v3
  v_add_f32 v60, v60, v62
  v_smfmac_f32_16x16x64_bf16 v[56:59], v[24:27], v[232:239], v3
  v_add_f32 v61, v61, v63
  v_cvt_pk_bf16_f32 v62, v60, v61
  ds_write_b32 v158, v62
  v_permlane32_swap_b32 v52, v54
  v_permlane32_swap_b32 v53, v55
  v_add_f32 v52, v52, v54
  v_add_f32 v53, v53, v55
  v_cvt_pk_bf16_f32 v54, v52, v53
  ds_write_b32 v156, v54
  v_permlane32_swap_b32 v56, v58
  v_permlane32_swap_b32 v57, v59
  v_add_f32 v56, v56, v58
  v_add_f32 v57, v57, v59
  v_cvt_pk_bf16_f32 v58, v56, v57
  ds_write_b32 v157, v58
cA_va1_t2d:
  s_add_u32 s22, s20, 9216
  s_add_u32 s34, s20, 13312
  s_add_u32 s36, s20, 7168
  s_mov_b32 s37, 0
  v_mov_b32 v48, 0
  v_mov_b32 v49, 0
  v_mov_b32 v50, 0
  v_mov_b32 v51, 0
  v_mov_b32 v163, s18
  s_cmp_eq_u32 s19, 63
  s_waitcnt lgkmcnt(0)
  s_cbranch_scc1 cA_va1_last
  s_barrier
  buffer_load_dwordx4 v[8:11], v2, s[8:11], s22 offen offset:0 sc1
  buffer_load_dwordx4 v[12:15], v2, s[8:11], s22 offen offset:1024 sc1
  buffer_load_dwordx4 v[16:19], v2, s[8:11], s22 offen offset:2048 sc1
  buffer_load_dwordx4 v[20:23], v2, s[8:11], s22 offen offset:3072 sc1
  buffer_load_dwordx4 v[24:27], v2, s[8:11], s34 offen offset:0 sc1
  buffer_load_dwordx4 v[28:31], v2, s[8:11], s34 offen offset:1024 sc1
  buffer_load_dwordx4 v[32:35], v2, s[8:11], s34 offen offset:2048 sc1
  buffer_load_dwordx4 v[36:39], v2, s[8:11], s34 offen offset:3072 sc1
  buffer_load_dwordx4 v[40:43], v2, s[8:11], s36 offen offset:0 sc1
  buffer_load_dwordx4 v[44:47], v2, s[8:11], s36 offen offset:1024 sc1
  ds_read_b128 v[64:67], v2 offset:4096
  ds_read_b128 v[68:71], v2 offset:5120
  ds_read_b128 v[72:75], v2 offset:6144
  ds_read_b128 v[76:79], v2 offset:7168
cA_va1_lp:
  s_waitcnt vmcnt(9)
  v_smfmac_f32_16x16x64_bf16 v[48:51], v[8:11], v[80:87], v3
  s_waitcnt vmcnt(8)
  v_smfmac_f32_16x16x64_bf16 v[48:51], v[12:15], v[88:95], v3
  s_waitcnt vmcnt(7)
  v_smfmac_f32_16x16x64_bf16 v[48:51], v[16:19], v[96:103], v3
  v_max3_u32 v55, v8, v12, v16
  s_waitcnt vmcnt(6)
  v_smfmac_f32_16x16x64_bf16 v[48:51], v[20:23], v[104:111], v3
  v_max_u32 v55, v55, v20
  v_cmp_eq_u32 vcc, -1, v55
  s_waitcnt vmcnt(5)
  v_smfmac_f32_16x16x64_bf16 v[48:51], v[24:27], v[112:119], v3
  s_waitcnt vmcnt(4)
  v_smfmac_f32_16x16x64_bf16 v[48:51], v[28:31], v[120:127], v3
  s_cbranch_vccnz cA_va1_rv
  buffer_store_dword v163, v7, s[8:11], 0 offen
  s_waitcnt vmcnt(4)
  v_smfmac_f32_16x16x64_bf16 v[48:51], v[32:35], v[128:135], v3
  s_waitcnt vmcnt(3)
  v_smfmac_f32_16x16x64_bf16 v[48:51], v[36:39], v[136:143], v3
  s_waitcnt vmcnt(2) lgkmcnt(0)
  v_smfmac_f32_16x16x64_bf16 v[48:51], v[40:43], v[64:71], v3
  s_waitcnt vmcnt(1)
  v_smfmac_f32_16x16x64_bf16 v[48:51], v[44:47], v[72:79], v3
  s_nop 7
  v_permlane32_swap_b32 v48, v50
  v_permlane32_swap_b32 v49, v51
  v_pk_add_f32 v[48:49], v[48:49], v[50:51]
  v_cvt_pk_bf16_f32 v160, v48, v49
  v_cmp_u_f32 vcc, v48, v49
  s_nop 0
  v_mov_b32_dpp v161, v160 quad_perm:[1,0,3,2] row_mask:0xf bank_mask:0xf
  v_perm_b32 v160, v161, v160, v5
  v_cndmask_b32 v161, v160, v162, vcc
  buffer_store_dword v161, v1, s[8:11], s21 offen
  s_cbranch_vccnz cA_va1_rp
cA_va1_cont:
  s_cmp_lg_u32 s19, 62
  s_cbranch_scc1 cA_va1_nl
  buffer_store_dword v160, v1, s[8:11], s38 offen sc1
  s_mov_b32 s38, 0x40000000
  s_mov_b32 s25, 0x40000000
cA_va1_nl:
  s_add_u32 s25, s25, 458752
  v_mov_b32 v36, 0
  v_mov_b32 v37, 0
  v_mov_b32 v38, 0
  v_mov_b32 v39, 0
  v_mov_b32 v40, 0
  v_mov_b32 v41, 0
  v_mov_b32 v42, 0
  v_mov_b32 v43, 0
  v_mov_b32 v44, 0
  v_mov_b32 v45, 0
  v_mov_b32 v46, 0
  v_mov_b32 v47, 0
  v_mov_b32 v48, 0
  v_mov_b32 v49, 0
  v_mov_b32 v50, 0
  v_mov_b32 v51, 0
  v_mov_b32 v52, 0
  v_mov_b32 v53, 0
  v_mov_b32 v54, 0
  v_mov_b32 v55, 0
  v_mov_b32 v56, 0
  v_mov_b32 v57, 0
  v_mov_b32 v58, 0
  v_mov_b32 v59, 0
  v_mov_b32 v60, 0
  v_mov_b32 v61, 0
  v_mov_b32 v62, 0
  v_mov_b32 v63, 0
  s_mov_b32 s19, s18
  s_add_u32 s18, s18, 1
  s_mov_b32 s22, s20
  s_mov_b32 s20, s21
  s_mov_b32 s21, s22
  s_add_u32 s23, s20, 4096
  s_branch cA_va1_loop
cA_va1_slow:
  s_waitcnt lgkmcnt(0)
cA_va1_sl1:
  s_add_u32 s31, s31, 0x1000000
  buffer_load_dwordx4 v[8:11], v2, s[8:11], s20 offen offset:0 sc1
  buffer_load_dwordx4 v[12:15], v2, s[8:11], s20 offen offset:1024 sc1
  buffer_load_dwordx4 v[16:19], v2, s[8:11], s20 offen offset:2048 sc1
  buffer_load_dwordx4 v[20:23], v2, s[8:11], s20 offen offset:3072 sc1
  buffer_load_dwordx4 v[24:27], v2, s[8:11], s23 offen offset:0 sc1
  buffer_load_dwordx4 v[28:31], v2, s[8:11], s23 offen offset:1024 sc1
  buffer_load_dwordx4 v[32:35], v2, s[8:11], s23 offen offset:2048 sc1
  s_waitcnt vmcnt(0)
  v_max3_u32 v36, v8, v9, v10
  v_max3_u32 v36, v36, v11, v12
  v_max3_u32 v36, v36, v13, v14
  v_max3_u32 v36, v36, v15, v16
  v_max3_u32 v36, v36, v17, v18
  v_max3_u32 v36, v36, v19, v20
  v_max3_u32 v36, v36, v21, v22
  v_max3_u32 v36, v36, v23, v24
  v_max3_u32 v36, v36, v25, v26
  v_max3_u32 v36, v36, v27, v28
  v_max3_u32 v36, v36, v29, v30
  v_max3_u32 v36, v36, v31, v32
  v_max3_u32 v36, v36, v33, v34
  v_max_u32 v36, v36, v35
  v_cmp_eq_u32 vcc, -1, v36
  s_cbranch_vccz cA_va1_sl2
  s_add_u32 s30, s30, 1
  s_cmp_lt_u32 s30, 400000
  s_cbranch_scc1 cA_va1_sl1
  s_branch cA_abort
cA_va1_sl2:
  v_mov_b32 v36, 0
  v_mov_b32 v37, 0
  v_mov_b32 v38, 0
  v_mov_b32 v39, 0
  v_mov_b32 v40, 0
  v_mov_b32 v41, 0
  v_mov_b32 v42, 0
  v_mov_b32 v43, 0
  v_mov_b32 v44, 0
  v_mov_b32 v45, 0
  v_mov_b32 v46, 0
  v_mov_b32 v47, 0
  v_mov_b32 v48, 0
  v_mov_b32 v49, 0
  v_mov_b32 v50, 0
  v_mov_b32 v51, 0
  v_mov_b32 v52, 0
  v_mov_b32 v53, 0
  v_mov_b32 v54, 0
  v_mov_b32 v55, 0
  v_mov_b32 v56, 0
  v_mov_b32 v57, 0
  v_mov_b32 v58, 0
  v_mov_b32 v59, 0
  v_mov_b32 v60, 0
  v_mov_b32 v61, 0
  v_mov_b32 v62, 0
  v_mov_b32 v63, 0
  buffer_store_dword v162, v1, s[8:11], s21 offen
  ds_read_b128 v[64:67], v0 offset:0
  ds_read_b128 v[68:71], v0 offset:1024
  v_smfmac_f32_16x16x64_bf16 v[36:39], v[8:11], a[0:7], v3
  v_smfmac_f32_16x16x64_bf16 v[40:43], v[8:11], a[56:63], v3
  v_smfmac_f32_16x16x64_bf16 v[44:47], v[8:11], a[112:119], v3
  v_smfmac_f32_16x16x64_bf16 v[48:51], v[8:11], a[168:175], v3
  v_smfmac_f32_16x16x64_bf16 v[52:55], v[8:11], a[224:231], v3
  v_smfmac_f32_16x16x64_bf16 v[56:59], v[8:11], v[200:207], v3
  s_waitcnt lgkmcnt(0)
  v_smfmac_f32_16x16x64_bf16 v[60:63], v[8:11], v[64:71], v3
  ds_read_b128 v[72:75], v0 offset:2048
  ds_read_b128 v[76:79], v0 offset:3072
  v_smfmac_f32_16x16x64_bf16 v[36:39], v[12:15], a[8:15], v3
  v_smfmac_f32_16x16x64_bf16 v[40:43], v[12:15], a[64:71], v3
  v_smfmac_f32_16x16x64_bf16 v[44:47], v[12:15], a[120:127], v3
  v_smfmac_f32_16x16x64_bf16 v[48:51], v[12:15], a[176:183], v3
  v_smfmac_f32_16x16x64_bf16 v[52:55], v[12:15], a[232:239], v3
  v_smfmac_f32_16x16x64_bf16 v[56:59], v[12:15], v[208:215], v3
  s_waitcnt lgkmcnt(0)
  v_smfmac_f32_16x16x64_bf16 v[60:63], v[12:15], v[72:79], v3
  ds_read_b128 v[144:147], v0 offset:4096
  ds_read_b128 v[148:151], v0 offset:5120
  v_smfmac_f32_16x16x64_bf16 v[36:39], v[16:19], a[16:23], v3
  v_smfmac_f32_16x16x64_bf16 v[40:43], v[16:19], a[72:79], v3
  v_smfmac_f32_16x16x64_bf16 v[44:47], v[16:19], a[128:135], v3
  v_smfmac_f32_16x16x64_bf16 v[48:51], v[16:19], a[184:191], v3
  v_smfmac_f32_16x16x64_bf16 v[52:55], v[16:19], a[240:247], v3
  v_smfmac_f32_16x16x64_bf16 v[56:59], v[16:19], v[216:223], v3
  s_waitcnt lgkmcnt(0)
  v_smfmac_f32_16x16x64_bf16 v[60:63], v[16:19], v[144:151], v3
  ds_read_b128 v[64:67], v0 offset:6144
  ds_read_b128 v[68:71], v0 offset:7168
  v_smfmac_f32_16x16x64_bf16 v[36:39], v[20:23], a[24:31], v3
  v_smfmac_f32_16x16x64_bf16 v[40:43], v[20:23], a[80:87], v3
  v_smfmac_f32_16x16x64_bf16 v[44:47], v[20:23], a[136:143], v3
  v_smfmac_f32_16x16x64_bf16 v[48:51], v[20:23], a[192:199], v3
  v_smfmac_f32_16x16x64_bf16 v[52:55], v[20:23], a[248:255], v3
  v_smfmac_f32_16x16x64_bf16 v[56:59], v[20:23], v[224:231], v3
  s_waitcnt lgkmcnt(0)
  v_smfmac_f32_16x16x64_bf16 v[60:63], v[20:23], v[64:71], v3
  ds_read_b128 v[72:75], v0 offset:8192
  ds_read_b128 v[76:79], v0 offset:9216
  v_smfmac_f32_16x16x64_bf16 v[36:39], v[24:27], a[32:39], v3
  v_smfmac_f32_16x16x64_bf16 v[40:43], v[24:27], a[88:95], v3
  v_smfmac_f32_16x16x64_bf16 v[44:47], v[24:27], a[144:151], v3
  v_smfmac_f32_16x16x64_bf16 v[48:51], v[24:27], a[200:207], v3
  v_smfmac_f32_16x16x64_bf16 v[52:55], v[24:27], v[176:183], v3
  v_smfmac_f32_16x16x64_bf16 v[56:59], v[24:27], v[232:239], v3
  s_waitcnt lgkmcnt(0)
  v_smfmac_f32_16x16x64_bf16 v[60:63], v[24:27], v[72:79], v3
  ds_read_b128 v[144:147], v0 offset:10240
  ds_read_b128 v[148:151], v0 offset:11264
  v_smfmac_f32_16x16x64_bf16 v[36:39], v[28:31], a[40:47], v3
  v_smfmac_f32_16x16x64_bf16 v[40:43], v[28:31], a[96:103], v3
  v_smfmac_f32_16x16x64_bf16 v[44:47], v[28:31], a[152:159], v3
  v_smfmac_f32_16x16x64_bf16 v[48:51], v[28:31], a[208:215], v3
  v_smfmac_f32_16x16x64_bf16 v[52:55], v[28:31], v[184:191], v3
  v_smfmac_f32_16x16x64_bf16 v[56:59], v[28:31], v[240:247], v3
  s_waitcnt lgkmcnt(0)
  v_smfmac_f32_16x16x64_bf16 v[60:63], v[28:31], v[144:151], v3
  ds_read_b128 v[64:67], v0 offset:12288
  ds_read_b128 v[68:71], v0 offset:13312
  v_smfmac_f32_16x16x64_bf16 v[36:39], v[32:35], a[48:55], v3
  v_smfmac_f32_16x16x64_bf16 v[40:43], v[32:35], a[104:111], v3
  v_smfmac_f32_16x16x64_bf16 v[44:47], v[32:35], a[160:167], v3
  v_smfmac_f32_16x16x64_bf16 v[48:51], v[32:35], a[216:223], v3
  v_smfmac_f32_16x16x64_bf16 v[52:55], v[32:35], v[192:199], v3
  v_smfmac_f32_16x16x64_bf16 v[56:59], v[32:35], v[248:255], v3
  s_waitcnt lgkmcnt(0)
  v_smfmac_f32_16x16x64_bf16 v[60:63], v[32:35], v[64:71], v3
  v_permlane32_swap_b32 v36, v38
  v_permlane32_swap_b32 v37, v39
  v_add_f32 v36, v36, v38
  v_add_f32 v37, v37, v39
  v_cvt_pk_bf16_f32 v38, v36, v37
  ds_write_b32 v152, v38
  v_permlane32_swap_b32 v40, v42
  v_permlane32_swap_b32 v41, v43
  v_add_f32 v40, v40, v42
  v_add_f32 v41, v41, v43
  v_cvt_pk_bf16_f32 v42, v40, v41
  ds_write_b32 v153, v42
  v_permlane32_swap_b32 v44, v46
  v_permlane32_swap_b32 v45, v47
  v_add_f32 v44, v44, v46
  v_add_f32 v45, v45, v47
  v_cvt_pk_bf16_f32 v46, v44, v45
  ds_write_b32 v154, v46
  v_permlane32_swap_b32 v48, v50
  v_permlane32_swap_b32 v49, v51
  v_add_f32 v48, v48, v50
  v_add_f32 v49, v49, v51
  v_cvt_pk_bf16_f32 v50, v48, v49
  ds_write_b32 v155, v50
  v_permlane32_swap_b32 v52, v54
  v_permlane32_swap_b32 v53, v55
  v_add_f32 v52, v52, v54
  v_add_f32 v53, v53, v55
  v_cvt_pk_bf16_f32 v54, v52, v53
  ds_write_b32 v156, v54
  v_permlane32_swap_b32 v56, v58
  v_permlane32_swap_b32 v57, v59
  v_add_f32 v56, v56, v58
  v_add_f32 v57, v57, v59
  v_cvt_pk_bf16_f32 v58, v56, v57
  ds_write_b32 v157, v58
  v_permlane32_swap_b32 v60, v62
  v_permlane32_swap_b32 v61, v63
  v_add_f32 v60, v60, v62
  v_add_f32 v61, v61, v63
  v_cvt_pk_bf16_f32 v62, v60, v61
  ds_write_b32 v158, v62
  s_branch cA_va1_t2d
cA_va1_last:
  s_barrier
  ds_read_b128 v[64:67], v2 offset:4096
  ds_read_b128 v[68:71], v2 offset:5120
  ds_read_b128 v[72:75], v2 offset:6144
  ds_read_b128 v[76:79], v2 offset:7168
  s_waitcnt lgkmcnt(0)
  v_min_u32 v64, -2, v64
  v_min_u32 v65, -2, v65
  v_min_u32 v66, -2, v66
  v_min_u32 v67, -2, v67
  v_min_u32 v68, -2, v68
  v_min_u32 v69, -2, v69
  v_min_u32 v70, -2, v70
  v_min_u32 v71, -2, v71
  v_min_u32 v72, -2, v72
  v_min_u32 v73, -2, v73
  v_min_u32 v74, -2, v74
  v_min_u32 v75, -2, v75
  v_min_u32 v76, -2, v76
  v_min_u32 v77, -2, v77
  v_min_u32 v78, -2, v78
  v_min_u32 v79, -2, v79
  buffer_store_dwordx4 v[64:67], v2, s[8:11], s33 offen offset:0 sc1
  buffer_store_dwordx4 v[68:71], v2, s[8:11], s33 offen offset:2048 sc1
  s_add_u32 s33, s33, 4096
  buffer_store_dwordx4 v[72:75], v2, s[8:11], s33 offen offset:0 sc1
  buffer_store_dwordx4 v[76:79], v2, s[8:11], s33 offen offset:2048 sc1
  s_add_u32 s33, s33, 4096
  s_waitcnt vmcnt(0)
  buffer_wbl2 sc1
  s_branch cA_done
cA_va1_rp:
  s_cmp_eq_u32 s37, 0
  s_cbranch_scc1 cA_va1_rv
  v_min_u32 v160, -2, v160
  buffer_store_dword v160, v1, s[8:11], s21 offen
  s_branch cA_va1_cont
cA_va1_rv:
  s_add_u32 s31, s31, 0x10000
  buffer_load_dwordx4 v[8:11], v2, s[8:11], s22 offen offset:0 sc1
  buffer_load_dwordx4 v[12:15], v2, s[8:11], s22 offen offset:1024 sc1
  buffer_load_dwordx4 v[16:19], v2, s[8:11], s22 offen offset:2048 sc1
  buffer_load_dwordx4 v[20:23], v2, s[8:11], s22 offen offset:3072 sc1
  buffer_load_dwordx4 v[24:27], v2, s[8:11], s34 offen offset:0 sc1
  buffer_load_dwordx4 v[28:31], v2, s[8:11], s34 offen offset:1024 sc1
  buffer_load_dwordx4 v[32:35], v2, s[8:11], s34 offen offset:2048 sc1
  buffer_load_dwordx4 v[36:39], v2, s[8:11], s34 offen offset:3072 sc1
  buffer_load_dwordx4 v[40:43], v2, s[8:11], s36 offen offset:0 sc1
  buffer_load_dwordx4 v[44:47], v2, s[8:11], s36 offen offset:1024 sc1
  s_waitcnt vmcnt(0)
  v_max3_u32 v52, v8, v9, v10
  v_max3_u32 v52, v52, v11, v12
  v_max3_u32 v52, v52, v13, v14
  v_max3_u32 v52, v52, v15, v16
  v_max3_u32 v52, v52, v17, v18
  v_max3_u32 v52, v52, v19, v20
  v_max3_u32 v52, v52, v21, v22
  v_max3_u32 v52, v52, v23, v24
  v_max3_u32 v52, v52, v25, v26
  v_max3_u32 v52, v52, v27, v28
  v_max3_u32 v52, v52, v29, v30
  v_max3_u32 v52, v52, v31, v32
  v_max3_u32 v52, v52, v33, v34
  v_max3_u32 v52, v52, v35, v36
  v_max3_u32 v52, v52, v37, v38
  v_max3_u32 v52, v52, v39, v40
  v_max3_u32 v52, v52, v41, v42
  v_max3_u32 v52, v52, v43, v44
  v_max3_u32 v52, v52, v45, v46
  v_max_u32 v52, v52, v47
  v_cmp_eq_u32 vcc, -1, v52
  s_mov_b32 s37, 1
  v_mov_b32 v48, 0
  v_mov_b32 v49, 0
  v_mov_b32 v50, 0
  v_mov_b32 v51, 0
  s_nop 1
  s_cbranch_vccz cA_va1_lp
  s_add_u32 s30, s30, 1
  s_cmp_lt_u32 s30, 400000
  s_cbranch_scc1 cA_va1_rv
  s_branch cA_abort
.p2align 6
cA_va2_loop:
  s_mov_b32 s30, 0
cA_va2_fp_l:
  v_cmp_gt_u32 vcc, s19, v96
  buffer_load_dword v96, v119, s[8:11], 0 offen sc1
  s_cbranch_vccz cA_va2_fp_d
  v_cmp_gt_u32 vcc, s19, v96
  buffer_load_dword v96, v119, s[8:11], 0 offen sc1
  s_cbranch_vccz cA_va2_fp_d
  v_cmp_gt_u32 vcc, s19, v96
  buffer_load_dword v96, v119, s[8:11], 0 offen sc1
  s_cbranch_vccz cA_va2_fp_d
  v_cmp_gt_u32 vcc, s19, v96
  buffer_load_dword v96, v119, s[8:11], 0 offen sc1
  s_cbranch_vccz cA_va2_fp_d
  v_cmp_gt_u32 vcc, s19, v96
  buffer_load_dword v96, v119, s[8:11], 0 offen sc1
  s_cbranch_vccz cA_va2_fp_d
  v_cmp_gt_u32 vcc, s19, v96
  buffer_load_dword v96, v119, s[8:11], 0 offen sc1
  s_cbranch_vccz cA_va2_fp_d
  v_cmp_gt_u32 vcc, s19, v96
  buffer_load_dword v96, v119, s[8:11], 0 offen sc1
  s_cbranch_vccz cA_va2_fp_d
  v_cmp_gt_u32 vcc, s19, v96
  buffer_load_dword v96, v119, s[8:11], 0 offen sc1
  s_cbranch_vccz cA_va2_fp_d
  v_cmp_gt_u32 vcc, s19, v96
  buffer_load_dword v96, v119, s[8:11], 0 offen sc1
  s_cbranch_vccz cA_va2_fp_d
  v_cmp_gt_u32 vcc, s19, v96
  buffer_load_dword v96, v119, s[8:11], 0 offen sc1
  s_cbranch_vccz cA_va2_fp_d
  v_cmp_gt_u32 vcc, s19, v96
  buffer_load_dword v96, v119, s[8:11], 0 offen sc1
  s_cbranch_vccz cA_va2_fp_d
  v_cmp_gt_u32 vcc, s19, v96
  buffer_load_dword v96, v119, s[8:11], 0 offen sc1
  s_cbranch_vccz cA_va2_fp_d
  v_cmp_gt_u32 vcc, s19, v96
  buffer_load_dword v96, v119, s[8:11], 0 offen sc1
  s_cbranch_vccz cA_va2_fp_d
  v_cmp_gt_u32 vcc, s19, v96
  buffer_load_dword v96, v119, s[8:11], 0 offen sc1
  s_cbranch_vccz cA_va2_fp_d
  v_cmp_gt_u32 vcc, s19, v96
  buffer_load_dword v96, v119, s[8:11], 0 offen sc1
  s_cbranch_vccz cA_va2_fp_d
  v_cmp_gt_u32 vcc, s19, v96
  buffer_load_dword v96, v119, s[8:11], 0 offen sc1
  s_cbranch_vccz cA_va2_fp_d
  s_waitcnt vmcnt(24)
  s_add_u32 s30, s30, 1
  s_cmp_lt_u32 s30, 400000
  s_cbranch_scc1 cA_va2_fp_l
  s_branch cA_abort
cA_va2_fp_d:
  buffer_load_dwordx4 v[8:11], v2, s[8:11], s20 offen offset:0 sc1
  buffer_load_dwordx4 v[12:15], v2, s[8:11], s20 offen offset:1024 sc1
  s_barrier
  s_barrier
  s_waitcnt vmcnt(0)
  ds_write_b128 v2, v[8:11] offset:8192
  ds_write_b128 v2, v[12:15] offset:9216
  v_smfmac_f32_16x16x64_bf16 v[36:39], v[8:11], a[0:7], v3
  v_smfmac_f32_16x16x64_bf16 v[40:43], v[8:11], a[56:63], v3
  v_smfmac_f32_16x16x64_bf16 v[44:47], v[8:11], a[112:119], v3
  v_smfmac_f32_16x16x64_bf16 v[48:51], v[8:11], a[168:175], v3
  v_smfmac_f32_16x16x64_bf16 v[52:55], v[8:11], a[224:231], v3
  s_waitcnt lgkmcnt(0)
  s_barrier
  ds_read_b128 v[16:19], v2 offset:10240
  ds_read_b128 v[20:23], v2 offset:11264
  ds_read_b128 v[24:27], v2 offset:12288
  ds_read_b128 v[28:31], v2 offset:13312
  ds_read_b128 v[32:35], v2 offset:14336
  v_smfmac_f32_16x16x64_bf16 v[56:59], v[8:11], v[144:151], v3
  v_smfmac_f32_16x16x64_bf16 v[60:63], v[8:11], v[200:207], v3
  v_smfmac_f32_16x16x64_bf16 v[36:39], v[12:15], a[8:15], v3
  v_smfmac_f32_16x16x64_bf16 v[40:43], v[12:15], a[64:71], v3
  v_smfmac_f32_16x16x64_bf16 v[44:47], v[12:15], a[120:127], v3
  v_smfmac_f32_16x16x64_bf16 v[48:51], v[12:15], a[176:183], v3
  v_smfmac_f32_16x16x64_bf16 v[52:55], v[12:15], a[232:239], v3
  v_smfmac_f32_16x16x64_bf16 v[56:59], v[12:15], v[152:159], v3
  ds_read_b128 v[68:71], v0 offset:0
  ds_read_b128 v[72:75], v0 offset:1024
  v_smfmac_f32_16x16x64_bf16 v[60:63], v[12:15], v[208:215], v3
  s_waitcnt lgkmcnt(6)
  ds_read_b128 v[76:79], v0 offset:2048
  ds_read_b128 v[80:83], v0 offset:3072
  v_smfmac_f32_16x16x64_bf16 v[36:39], v[16:19], a[16:23], v3
  s_waitcnt lgkmcnt(7)
  v_smfmac_f32_16x16x64_bf16 v[36:39], v[20:23], a[24:31], v3
  s_waitcnt lgkmcnt(6)
  v_smfmac_f32_16x16x64_bf16 v[36:39], v[24:27], a[32:39], v3
  s_waitcnt lgkmcnt(2)
  v_smfmac_f32_16x16x64_bf16 v[64:67], v[8:11], v[68:75], v3
  s_waitcnt lgkmcnt(5)
  ds_read_b128 v[84:87], v0 offset:4096
  ds_read_b128 v[88:91], v0 offset:5120
  v_smfmac_f32_16x16x64_bf16 v[36:39], v[28:31], a[40:47], v3
  s_waitcnt lgkmcnt(6)
  v_smfmac_f32_16x16x64_bf16 v[36:39], v[32:35], a[48:55], v3
  v_smfmac_f32_16x16x64_bf16 v[40:43], v[16:19], a[72:79], v3
  s_waitcnt lgkmcnt(2)
  v_smfmac_f32_16x16x64_bf16 v[64:67], v[12:15], v[76:83], v3
  ds_read_b128 v[68:71], v0 offset:6144
  ds_read_b128 v[72:75], v0 offset:7168
  v_smfmac_f32_16x16x64_bf16 v[40:43], v[20:23], a[80:87], v3
  v_permlane32_swap_b32 v36, v38
  v_smfmac_f32_16x16x64_bf16 v[40:43], v[24:27], a[88:95], v3
  v_permlane32_swap_b32 v37, v39
  v_smfmac_f32_16x16x64_bf16 v[40:43], v[28:31], a[96:103], v3
  s_waitcnt lgkmcnt(2)
  v_add_f32 v36, v36, v38
  v_smfmac_f32_16x16x64_bf16 v[64:67], v[16:19], v[84:91], v3
  ds_read_b128 v[76:79], v0 offset:8192
  ds_read_b128 v[80:83], v0 offset:9216
  v_add_f32 v37, v37, v39
  v_smfmac_f32_16x16x64_bf16 v[40:43], v[32:35], a[104:111], v3
  v_cmp_u_f32 vcc, v36, v37
  v_smfmac_f32_16x16x64_bf16 v[44:47], v[16:19], a[128:135], v3
  v_cvt_pk_bf16_f32 v38, v36, v37
  v_smfmac_f32_16x16x64_bf16 v[44:47], v[20:23], a[136:143], v3
  ds_write_b32 v104, v38
  s_waitcnt lgkmcnt(3)
  s_cbranch_vccnz cA_va2_slow
  v_permlane32_swap_b32 v40, v42
  v_smfmac_f32_16x16x64_bf16 v[64:67], v[20:23], v[68:75], v3
  ds_read_b128 v[84:87], v0 offset:10240
  ds_read_b128 v[88:91], v0 offset:11264
  v_permlane32_swap_b32 v41, v43
  v_smfmac_f32_16x16x64_bf16 v[44:47], v[24:27], a[144:151], v3
  v_add_f32 v40, v40, v42
  v_smfmac_f32_16x16x64_bf16 v[44:47], v[28:31], a[152:159], v3
  v_add_f32 v41, v41, v43
  v_smfmac_f32_16x16x64_bf16 v[44:47], v[32:35], a[160:167], v3
  s_waitcnt lgkmcnt(3)
  v_cvt_pk_bf16_f32 v42, v40, v41
  v_smfmac_f32_16x16x64_bf16 v[64:67], v[24:27], v[76:83], v3
  ds_write_b32 v105, v42
  ds_read_b128 v[68:71], v0 offset:12288
  ds_read_b128 v[72:75], v0 offset:13312
  v_smfmac_f32_16x16x64_bf16 v[48:51], v[16:19], a[184:191], v3
  s_nop 0
  v_permlane32_swap_b32 v44, v46
  v_smfmac_f32_16x16x64_bf16 v[48:51], v[20:23], a[192:199], v3
  v_permlane32_swap_b32 v45, v47
  v_smfmac_f32_16x16x64_bf16 v[48:51], v[24:27], a[200:207], v3
  s_waitcnt lgkmcnt(3)
  v_add_f32 v44, v44, v46
  v_smfmac_f32_16x16x64_bf16 v[64:67], v[28:31], v[84:91], v3
  v_add_f32 v45, v45, v47
  v_smfmac_f32_16x16x64_bf16 v[48:51], v[28:31], a[208:215], v3
  v_cvt_pk_bf16_f32 v46, v44, v45
  v_smfmac_f32_16x16x64_bf16 v[48:51], v[32:35], a[216:223], v3
  ds_write_b32 v106, v46
  v_smfmac_f32_16x16x64_bf16 v[52:55], v[16:19], a[240:247], v3
  s_waitcnt lgkmcnt(1)
  v_smfmac_f32_16x16x64_bf16 v[64:67], v[32:35], v[68:75], v3
  v_smfmac_f32_16x16x64_bf16 v[52:55], v[20:23], a[248:255], v3
  v_permlane32_swap_b32 v48, v50
  v_smfmac_f32_16x16x64_bf16 v[52:55], v[24:27], v[120:127], v3
  v_permlane32_swap_b32 v49, v51
  v_smfmac_f32_16x16x64_bf16 v[52:55], v[28:31], v[128:135], v3
  v_add_f32 v48, v48, v50
  v_smfmac_f32_16x16x64_bf16 v[52:55], v[32:35], v[136:143], v3
  v_add_f32 v49, v49, v51
  v_smfmac_f32_16x16x64_bf16 v[56:59], v[16:19], v[160:167], v3
  v_cvt_pk_bf16_f32 v50, v48, v49
  v_smfmac_f32_16x16x64_bf16 v[56:59], v[20:23], v[168:175], v3
  ds_write_b32 v107, v50
  v_permlane32_swap_b32 v64, v66
  v_smfmac_f32_16x16x64_bf16 v[56:59], v[24:27], v[176:183], v3
  v_permlane32_swap_b32 v65, v67
  v_smfmac_f32_16x16x64_bf16 v[56:59], v[28:31], v[184:191], v3
  v_add_f32 v64, v64, v66
  v_smfmac_f32_16x16x64_bf16 v[56:59], v[32:35], v[192:199], v3
  v_add_f32 v65, v65, v67
  v_smfmac_f32_16x16x64_bf16 v[60:63], v[16:19], v[216:223], v3
  v_cvt_pk_bf16_f32 v66, v64, v65
  v_smfmac_f32_16x16x64_bf16 v[60:63], v[20:23], v[224:231], v3
  ds_write_b32 v111, v66
  v_permlane32_swap_b32 v52, v54
  v_smfmac_f32_16x16x64_bf16 v[60:63], v[24:27], v[232:239], v3
  v_permlane32_swap_b32 v53, v55
  v_smfmac_f32_16x16x64_bf16 v[60:63], v[28:31], v[240:247], v3
  v_add_f32 v52, v52, v54
  v_smfmac_f32_16x16x64_bf16 v[60:63], v[32:35], v[248:255], v3
  v_add_f32 v53, v53, v55
  v_cvt_pk_bf16_f32 v54, v52, v53
  ds_write_b32 v108, v54
  v_permlane32_swap_b32 v56, v58
  v_permlane32_swap_b32 v57, v59
  v_add_f32 v56, v56, v58
  v_add_f32 v57, v57, v59
  v_cvt_pk_bf16_f32 v58, v56, v57
  ds_write_b32 v109, v58
  v_permlane32_swap_b32 v60, v62
  v_permlane32_swap_b32 v61, v63
  v_add_f32 v60, v60, v62
  v_add_f32 v61, v61, v63
  v_cvt_pk_bf16_f32 v62, v60, v61
  ds_write_b32 v110, v62
cA_va2_t2d:
  v_mov_b32 v117, s18
  s_waitcnt lgkmcnt(0)
  s_barrier
  s_cmp_eq_u32 s19, 63
  s_cbranch_scc1 cA_done
  s_sleep 1
  v_mov_b32 v36, 0
  v_mov_b32 v37, 0
  v_mov_b32 v38, 0
  v_mov_b32 v39, 0
  v_mov_b32 v40, 0
  v_mov_b32 v41, 0
  v_mov_b32 v42, 0
  v_mov_b32 v43, 0
  v_mov_b32 v44, 0
  v_mov_b32 v45, 0
  v_mov_b32 v46, 0
  v_mov_b32 v47, 0
  v_mov_b32 v48, 0
  v_mov_b32 v49, 0
  v_mov_b32 v50, 0
  v_mov_b32 v51, 0
  v_mov_b32 v52, 0
  v_mov_b32 v53, 0
  v_mov_b32 v54, 0
  v_mov_b32 v55, 0
  v_mov_b32 v56, 0
  v_mov_b32 v57, 0
  v_mov_b32 v58, 0
  v_mov_b32 v59, 0
  v_mov_b32 v60, 0
  v_mov_b32 v61, 0
  v_mov_b32 v62, 0
  v_mov_b32 v63, 0
  v_mov_b32 v64, 0
  v_mov_b32 v65, 0
  v_mov_b32 v66, 0
  v_mov_b32 v67, 0
  s_sleep 5
  s_mov_b32 s19, s18
  s_add_u32 s18, s18, 1
  s_mov_b32 s22, s20
  s_mov_b32 s20, s21
  s_mov_b32 s21, s22
  s_add_u32 s23, s20, 4096
  s_branch cA_va2_loop
cA_va2_slow:
  s_waitcnt lgkmcnt(0)
cA_va2_sl1:
  s_add_u32 s31, s31, 0x1000000
  buffer_load_dwordx4 v[8:11], v2, s[8:11], s20 offen offset:0 sc1
  buffer_load_dwordx4 v[12:15], v2, s[8:11], s20 offen offset:1024 sc1
  buffer_load_dwordx4 v[16:19], v2, s[8:11], s20 offen offset:2048 sc1
  buffer_load_dwordx4 v[20:23], v2, s[8:11], s20 offen offset:3072 sc1
  buffer_load_dwordx4 v[24:27], v2, s[8:11], s23 offen offset:0 sc1
  buffer_load_dwordx4 v[28:31], v2, s[8:11], s23 offen offset:1024 sc1
  buffer_load_dwordx4 v[32:35], v2, s[8:11], s23 offen offset:2048 sc1
  s_waitcnt vmcnt(0)
  v_max3_u32 v36, v8, v9, v10
  v_max3_u32 v36, v36, v11, v12
  v_max3_u32 v36, v36, v13, v14
  v_max3_u32 v36, v36, v15, v16
  v_max3_u32 v36, v36, v17, v18
  v_max3_u32 v36, v36, v19, v20
  v_max3_u32 v36, v36, v21, v22
  v_max3_u32 v36, v36, v23, v24
  v_max3_u32 v36, v36, v25, v26
  v_max3_u32 v36, v36, v27, v28
  v_max3_u32 v36, v36, v29, v30
  v_max3_u32 v36, v36, v31, v32
  v_max3_u32 v36, v36, v33, v34
  v_max_u32 v36, v36, v35
  v_cmp_eq_u32 vcc, -1, v36
  s_cbranch_vccz cA_va2_sl2
  s_add_u32 s30, s30, 1
  s_cmp_lt_u32 s30, 400000
  s_cbranch_scc1 cA_va2_sl1
  s_branch cA_abort
cA_va2_sl2:
  v_mov_b32 v36, 0
  v_mov_b32 v37, 0
  v_mov_b32 v38, 0
  v_mov_b32 v39, 0
  v_mov_b32 v40, 0
  v_mov_b32 v41, 0
  v_mov_b32 v42, 0
  v_mov_b32 v43, 0
  v_mov_b32 v44, 0
  v_mov_b32 v45, 0
  v_mov_b32 v46, 0
  v_mov_b32 v47, 0
  v_mov_b32 v48, 0
  v_mov_b32 v49, 0
  v_mov_b32 v50, 0
  v_mov_b32 v51, 0
  v_mov_b32 v52, 0
  v_mov_b32 v53, 0
  v_mov_b32 v54, 0
  v_mov_b32 v55, 0
  v_mov_b32 v56, 0
  v_mov_b32 v57, 0
  v_mov_b32 v58, 0
  v_mov_b32 v59, 0
  v_mov_b32 v60, 0
  v_mov_b32 v61, 0
  v_mov_b32 v62, 0
  v_mov_b32 v63, 0
  v_mov_b32 v64, 0
  v_mov_b32 v65, 0
  v_mov_b32 v66, 0
  v_mov_b32 v67, 0
  ds_read_b128 v[68:71], v0 offset:0
  ds_read_b128 v[72:75], v0 offset:1024
  v_smfmac_f32_16x16x64_bf16 v[36:39], v[8:11], a[0:7], v3
  v_smfmac_f32_16x16x64_bf16 v[40:43], v[8:11], a[56:63], v3
  v_smfmac_f32_16x16x64_bf16 v[44:47], v[8:11], a[112:119], v3
  v_smfmac_f32_16x16x64_bf16 v[48:51], v[8:11], a[168:175], v3
  v_smfmac_f32_16x16x64_bf16 v[52:55], v[8:11], a[224:231], v3
  v_smfmac_f32_16x16x64_bf16 v[56:59], v[8:11], v[144:151], v3
  v_smfmac_f32_16x16x64_bf16 v[60:63], v[8:11], v[200:207], v3
  s_waitcnt lgkmcnt(0)
  v_smfmac_f32_16x16x64_bf16 v[64:67], v[8:11], v[68:75], v3
  ds_read_b128 v[76:79], v0 offset:2048
  ds_read_b128 v[80:83], v0 offset:3072
  v_smfmac_f32_16x16x64_bf16 v[36:39], v[12:15], a[8:15], v3
  v_smfmac_f32_16x16x64_bf16 v[40:43], v[12:15], a[64:71], v3
  v_smfmac_f32_16x16x64_bf16 v[44:47], v[12:15], a[120:127], v3
  v_smfmac_f32_16x16x64_bf16 v[48:51], v[12:15], a[176:183], v3
  v_smfmac_f32_16x16x64_bf16 v[52:55], v[12:15], a[232:239], v3
  v_smfmac_f32_16x16x64_bf16 v[56:59], v[12:15], v[152:159], v3
  v_smfmac_f32_16x16x64_bf16 v[60:63], v[12:15], v[208:215], v3
  s_waitcnt lgkmcnt(0)
  v_smfmac_f32_16x16x64_bf16 v[64:67], v[12:15], v[76:83], v3
  ds_read_b128 v[84:87], v0 offset:4096
  ds_read_b128 v[88:91], v0 offset:5120
  v_smfmac_f32_16x16x64_bf16 v[36:39], v[16:19], a[16:23], v3
  v_smfmac_f32_16x16x64_bf16 v[40:43], v[16:19], a[72:79], v3
  v_smfmac_f32_16x16x64_bf16 v[44:47], v[16:19], a[128:135], v3
  v_smfmac_f32_16x16x64_bf16 v[48:51], v[16:19], a[184:191], v3
  v_smfmac_f32_16x16x64_bf16 v[52:55], v[16:19], a[240:247], v3
  v_smfmac_f32_16x16x64_bf16 v[56:59], v[16:19], v[160:167], v3
  v_smfmac_f32_16x16x64_bf16 v[60:63], v[16:19], v[216:223], v3
  s_waitcnt lgkmcnt(0)
  v_smfmac_f32_16x16x64_bf16 v[64:67], v[16:19], v[84:91], v3
  ds_read_b128 v[68:71], v0 offset:6144
  ds_read_b128 v[72:75], v0 offset:7168
  v_smfmac_f32_16x16x64_bf16 v[36:39], v[20:23], a[24:31], v3
  v_smfmac_f32_16x16x64_bf16 v[40:43], v[20:23], a[80:87], v3
  v_smfmac_f32_16x16x64_bf16 v[44:47], v[20:23], a[136:143], v3
  v_smfmac_f32_16x16x64_bf16 v[48:51], v[20:23], a[192:199], v3
  v_smfmac_f32_16x16x64_bf16 v[52:55], v[20:23], a[248:255], v3
  v_smfmac_f32_16x16x64_bf16 v[56:59], v[20:23], v[168:175], v3
  v_smfmac_f32_16x16x64_bf16 v[60:63], v[20:23], v[224:231], v3
  s_waitcnt lgkmcnt(0)
  v_smfmac_f32_16x16x64_bf16 v[64:67], v[20:23], v[68:75], v3
  ds_read_b128 v[76:79], v0 offset:8192
  ds_read_b128 v[80:83], v0 offset:9216
  v_smfmac_f32_16x16x64_bf16 v[36:39], v[24:27], a[32:39], v3
  v_smfmac_f32_16x16x64_bf16 v[40:43], v[24:27], a[88:95], v3
  v_smfmac_f32_16x16x64_bf16 v[44:47], v[24:27], a[144:151], v3
  v_smfmac_f32_16x16x64_bf16 v[48:51], v[24:27], a[200:207], v3
  v_smfmac_f32_16x16x64_bf16 v[52:55], v[24:27], v[120:127], v3
  v_smfmac_f32_16x16x64_bf16 v[56:59], v[24:27], v[176:183], v3
  v_smfmac_f32_16x16x64_bf16 v[60:63], v[24:27], v[232:239], v3
  s_waitcnt lgkmcnt(0)
  v_smfmac_f32_16x16x64_bf16 v[64:67], v[24:27], v[76:83], v3
  ds_read_b128 v[84:87], v0 offset:10240
  ds_read_b128 v[88:91], v0 offset:11264
  v_smfmac_f32_16x16x64_bf16 v[36:39], v[28:31], a[40:47], v3
  v_smfmac_f32_16x16x64_bf16 v[40:43], v[28:31], a[96:103], v3
  v_smfmac_f32_16x16x64_bf16 v[44:47], v[28:31], a[152:159], v3
  v_smfmac_f32_16x16x64_bf16 v[48:51], v[28:31], a[208:215], v3
  v_smfmac_f32_16x16x64_bf16 v[52:55], v[28:31], v[128:135], v3
  v_smfmac_f32_16x16x64_bf16 v[56:59], v[28:31], v[184:191], v3
  v_smfmac_f32_16x16x64_bf16 v[60:63], v[28:31], v[240:247], v3
  s_waitcnt lgkmcnt(0)
  v_smfmac_f32_16x16x64_bf16 v[64:67], v[28:31], v[84:91], v3
  ds_read_b128 v[68:71], v0 offset:12288
  ds_read_b128 v[72:75], v0 offset:13312
  v_smfmac_f32_16x16x64_bf16 v[36:39], v[32:35], a[48:55], v3
  v_smfmac_f32_16x16x64_bf16 v[40:43], v[32:35], a[104:111], v3
  v_smfmac_f32_16x16x64_bf16 v[44:47], v[32:35], a[160:167], v3
  v_smfmac_f32_16x16x64_bf16 v[48:51], v[32:35], a[216:223], v3
  v_smfmac_f32_16x16x64_bf16 v[52:55], v[32:35], v[136:143], v3
  v_smfmac_f32_16x16x64_bf16 v[56:59], v[32:35], v[192:199], v3
  v_smfmac_f32_16x16x64_bf16 v[60:63], v[32:35], v[248:255], v3
  s_waitcnt lgkmcnt(0)
  v_smfmac_f32_16x16x64_bf16 v[64:67], v[32:35], v[68:75], v3
  v_permlane32_swap_b32 v36, v38
  v_permlane32_swap_b32 v37, v39
  v_add_f32 v36, v36, v38
  v_add_f32 v37, v37, v39
  v_cvt_pk_bf16_f32 v38, v36, v37
  ds_write_b32 v104, v38
  v_permlane32_swap_b32 v40, v42
  v_permlane32_swap_b32 v41, v43
  v_add_f32 v40, v40, v42
  v_add_f32 v41, v41, v43
  v_cvt_pk_bf16_f32 v42, v40, v41
  ds_write_b32 v105, v42
  v_permlane32_swap_b32 v44, v46
  v_permlane32_swap_b32 v45, v47
  v_add_f32 v44, v44, v46
  v_add_f32 v45, v45, v47
  v_cvt_pk_bf16_f32 v46, v44, v45
  ds_write_b32 v106, v46
  v_permlane32_swap_b32 v48, v50
  v_permlane32_swap_b32 v49, v51
  v_add_f32 v48, v48, v50
  v_add_f32 v49, v49, v51
  v_cvt_pk_bf16_f32 v50, v48, v49
  ds_write_b32 v107, v50
  v_permlane32_swap_b32 v52, v54
  v_permlane32_swap_b32 v53, v55
  v_add_f32 v52, v52, v54
  v_add_f32 v53, v53, v55
  v_cvt_pk_bf16_f32 v54, v52, v53
  ds_write_b32 v108, v54
  v_permlane32_swap_b32 v56, v58
  v_permlane32_swap_b32 v57, v59
  v_add_f32 v56, v56, v58
  v_add_f32 v57, v57, v59
  v_cvt_pk_bf16_f32 v58, v56, v57
  ds_write_b32 v109, v58
  v_permlane32_swap_b32 v60, v62
  v_permlane32_swap_b32 v61, v63
  v_add_f32 v60, v60, v62
  v_add_f32 v61, v61, v63
  v_cvt_pk_bf16_f32 v62, v60, v61
  ds_write_b32 v110, v62
  v_permlane32_swap_b32 v64, v66
  v_permlane32_swap_b32 v65, v67
  v_add_f32 v64, v64, v66
  v_add_f32 v65, v65, v67
  v_cvt_pk_bf16_f32 v66, v64, v65
  ds_write_b32 v111, v66
  s_branch cA_va2_t2d
.p2align 6
cA_va3_loop:
  s_mov_b32 s30, 0
  s_barrier
  buffer_load_dwordx4 v[16:19], v2, s[8:11], s20 offen offset:2048 sc1
  buffer_load_dwordx4 v[20:23], v2, s[8:11], s20 offen offset:3072 sc1
  s_barrier
  buffer_load_dword v100, v116, s[8:11], s39 offen sc1
  s_add_u32 s27, s19, 2
  s_min_u32 s27, s27, 63
  s_lshr_b32 s27, s27, 3
  s_lshl_b32 s27, s27, 11
  s_add_u32 s27, s27, s35
  s_cmp_eq_u32 s27, s28
  s_cselect_b32 s29, 75729408, s27
  buffer_load_dword v101, off, s[8:11], s29 sc1
  s_add_u32 s39, s39, 28672
  s_waitcnt vmcnt(2)
  ds_write_b128 v2, v[16:19] offset:10240
  ds_write_b128 v2, v[20:23] offset:11264
  v_smfmac_f32_16x16x64_bf16 v[36:39], v[16:19], a[16:23], v3
  v_smfmac_f32_16x16x64_bf16 v[40:43], v[16:19], a[72:79], v3
  v_smfmac_f32_16x16x64_bf16 v[44:47], v[16:19], a[128:135], v3
  v_smfmac_f32_16x16x64_bf16 v[48:51], v[16:19], a[184:191], v3
  v_smfmac_f32_16x16x64_bf16 v[52:55], v[16:19], a[240:247], v3
  s_waitcnt lgkmcnt(0)
  s_barrier
  ds_read_b128 v[8:11], v2 offset:8192
  ds_read_b128 v[12:15], v2 offset:9216
  ds_read_b128 v[24:27], v2 offset:12288
  ds_read_b128 v[28:31], v2 offset:13312
  ds_read_b128 v[32:35], v2 offset:14336
  v_smfmac_f32_16x16x64_bf16 v[56:59], v[16:19], v[160:167], v3
  v_smfmac_f32_16x16x64_bf16 v[60:63], v[16:19], v[216:223], v3
  v_smfmac_f32_16x16x64_bf16 v[36:39], v[20:23], a[24:31], v3
  v_smfmac_f32_16x16x64_bf16 v[40:43], v[20:23], a[80:87], v3
  v_smfmac_f32_16x16x64_bf16 v[44:47], v[20:23], a[136:143], v3
  v_smfmac_f32_16x16x64_bf16 v[48:51], v[20:23], a[192:199], v3
  v_smfmac_f32_16x16x64_bf16 v[52:55], v[20:23], a[248:255], v3
  v_smfmac_f32_16x16x64_bf16 v[56:59], v[20:23], v[168:175], v3
  v_smfmac_f32_16x16x64_bf16 v[60:63], v[20:23], v[224:231], v3
  s_waitcnt lgkmcnt(4)
  v_smfmac_f32_16x16x64_bf16 v[36:39], v[8:11], a[0:7], v3
  s_waitcnt lgkmcnt(3)
  v_smfmac_f32_16x16x64_bf16 v[36:39], v[12:15], a[8:15], v3
  s_waitcnt lgkmcnt(2)
  v_smfmac_f32_16x16x64_bf16 v[36:39], v[24:27], a[32:39], v3
  s_waitcnt lgkmcnt(1)
  v_smfmac_f32_16x16x64_bf16 v[36:39], v[28:31], a[40:47], v3
  s_waitcnt lgkmcnt(0)
  v_smfmac_f32_16x16x64_bf16 v[36:39], v[32:35], a[48:55], v3
  v_smfmac_f32_16x16x64_bf16 v[40:43], v[8:11], a[56:63], v3
  v_smfmac_f32_16x16x64_bf16 v[40:43], v[12:15], a[64:71], v3
  v_smfmac_f32_16x16x64_bf16 v[40:43], v[24:27], a[88:95], v3
  v_permlane32_swap_b32 v36, v38
  v_smfmac_f32_16x16x64_bf16 v[40:43], v[28:31], a[96:103], v3
  v_permlane32_swap_b32 v37, v39
  v_smfmac_f32_16x16x64_bf16 v[40:43], v[32:35], a[104:111], v3
  v_add_f32 v36, v36, v38
  v_smfmac_f32_16x16x64_bf16 v[44:47], v[8:11], a[112:119], v3
  v_add_f32 v37, v37, v39
  v_smfmac_f32_16x16x64_bf16 v[44:47], v[12:15], a[120:127], v3
  v_cmp_u_f32 vcc, v36, v37
  v_smfmac_f32_16x16x64_bf16 v[44:47], v[24:27], a[144:151], v3
  v_cvt_pk_bf16_f32 v38, v36, v37
  v_smfmac_f32_16x16x64_bf16 v[44:47], v[28:31], a[152:159], v3
  ds_write_b32 v104, v38
  s_cbranch_vccnz cA_va3_slow
  v_permlane32_swap_b32 v40, v42
  v_smfmac_f32_16x16x64_bf16 v[44:47], v[32:35], a[160:167], v3
  v_permlane32_swap_b32 v41, v43
  v_smfmac_f32_16x16x64_bf16 v[48:51], v[8:11], a[168:175], v3
  v_add_f32 v40, v40, v42
  v_smfmac_f32_16x16x64_bf16 v[48:51], v[12:15], a[176:183], v3
  v_add_f32 v41, v41, v43
  v_smfmac_f32_16x16x64_bf16 v[48:51], v[24:27], a[200:207], v3
  v_cvt_pk_bf16_f32 v42, v40, v41
  v_smfmac_f32_16x16x64_bf16 v[48:51], v[28:31], a[208:215], v3
  ds_write_b32 v105, v42
  v_permlane32_swap_b32 v44, v46
  v_smfmac_f32_16x16x64_bf16 v[48:51], v[32:35], a[216:223], v3
  v_permlane32_swap_b32 v45, v47
  v_smfmac_f32_16x16x64_bf16 v[52:55], v[8:11], a[224:231], v3
  v_add_f32 v44, v44, v46
  v_smfmac_f32_16x16x64_bf16 v[52:55], v[12:15], a[232:239], v3
  v_add_f32 v45, v45, v47
  v_smfmac_f32_16x16x64_bf16 v[52:55], v[24:27], v[120:127], v3
  v_cvt_pk_bf16_f32 v46, v44, v45
  v_smfmac_f32_16x16x64_bf16 v[52:55], v[28:31], v[128:135], v3
  ds_write_b32 v106, v46
  v_permlane32_swap_b32 v48, v50
  v_smfmac_f32_16x16x64_bf16 v[52:55], v[32:35], v[136:143], v3
  v_permlane32_swap_b32 v49, v51
  v_smfmac_f32_16x16x64_bf16 v[56:59], v[8:11], v[144:151], v3
  v_add_f32 v48, v48, v50
  v_smfmac_f32_16x16x64_bf16 v[56:59], v[12:15], v[152:159], v3
  v_add_f32 v49, v49, v51
  v_smfmac_f32_16x16x64_bf16 v[56:59], v[24:27], v[176:183], v3
  v_cvt_pk_bf16_f32 v50, v48, v49
  v_smfmac_f32_16x16x64_bf16 v[56:59], v[28:31], v[184:191], v3
  ds_write_b32 v107, v50
  v_permlane32_swap_b32 v52, v54
  v_smfmac_f32_16x16x64_bf16 v[56:59], v[32:35], v[192:199], v3
  v_permlane32_swap_b32 v53, v55
  v_smfmac_f32_16x16x64_bf16 v[60:63], v[8:11], v[200:207], v3
  v_add_f32 v52, v52, v54
  v_smfmac_f32_16x16x64_bf16 v[60:63], v[12:15], v[208:215], v3
  v_add_f32 v53, v53, v55
  v_smfmac_f32_16x16x64_bf16 v[60:63], v[24:27], v[232:239], v3
  v_cvt_pk_bf16_f32 v54, v52, v53
  v_smfmac_f32_16x16x64_bf16 v[60:63], v[28:31], v[240:247], v3
  ds_write_b32 v108, v54
  v_permlane32_swap_b32 v56, v58
  v_smfmac_f32_16x16x64_bf16 v[60:63], v[32:35], v[248:255], v3
  v_permlane32_swap_b32 v57, v59
  v_add_f32 v56, v56, v58
  v_add_f32 v57, v57, v59
  v_cvt_pk_bf16_f32 v58, v56, v57
  ds_write_b32 v109, v58
  s_nop 2
  v_permlane32_swap_b32 v60, v62
  v_permlane32_swap_b32 v61, v63
  v_add_f32 v60, v60, v62
  v_add_f32 v61, v61, v63
  v_cvt_pk_bf16_f32 v62, v60, v61
  ds_write_b32 v110, v62
cA_va3_t2d:
  v_mov_b32 v117, s18
  s_cmp_eq_u32 s27, s28
  s_cbranch_scc1 cA_va3_vok
cA_va3_vow:
  s_waitcnt vmcnt(0)
  v_cmp_ne_u32 vcc, 56, v101
  s_cbranch_vccnz cA_va3_vor
  s_mov_b32 s28, s27
cA_va3_vok:
  s_waitcnt lgkmcnt(0)
  s_setprio 3
  s_barrier
  v_mov_b32 v36, 0
  v_mov_b32 v37, 0
  buffer_store_dword v117, v118, s[8:11], 0 offen
  s_setprio 0
  s_cmp_eq_u32 s19, 63
  s_cbranch_scc1 cA_done
  v_mov_b32 v38, 0
  v_mov_b32 v39, 0
  v_mov_b32 v40, 0
  v_mov_b32 v41, 0
  v_mov_b32 v42, 0
  v_mov_b32 v43, 0
  v_mov_b32 v44, 0
  v_mov_b32 v45, 0
  v_mov_b32 v46, 0
  v_mov_b32 v47, 0
  v_mov_b32 v48, 0
  v_mov_b32 v49, 0
  v_mov_b32 v50, 0
  v_mov_b32 v51, 0
  v_mov_b32 v52, 0
  v_mov_b32 v53, 0
  v_mov_b32 v54, 0
  v_mov_b32 v55, 0
  v_mov_b32 v56, 0
  v_mov_b32 v57, 0
  v_mov_b32 v58, 0
  v_mov_b32 v59, 0
  v_mov_b32 v60, 0
  v_mov_b32 v61, 0
  v_mov_b32 v62, 0
  v_mov_b32 v63, 0
  s_mov_b32 s19, s18
  s_add_u32 s18, s18, 1
  s_mov_b32 s22, s20
  s_mov_b32 s20, s21
  s_mov_b32 s21, s22
  s_add_u32 s23, s20, 4096
  s_branch cA_va3_loop
cA_va3_slow:
  s_waitcnt lgkmcnt(0)
cA_va3_sl1:
  s_add_u32 s31, s31, 0x1000000
  buffer_load_dwordx4 v[8:11], v2, s[8:11], s20 offen offset:0 sc1
  buffer_load_dwordx4 v[12:15], v2, s[8:11], s20 offen offset:1024 sc1
  buffer_load_dwordx4 v[16:19], v2, s[8:11], s20 offen offset:2048 sc1
  buffer_load_dwordx4 v[20:23], v2, s[8:11], s20 offen offset:3072 sc1
  buffer_load_dwordx4 v[24:27], v2, s[8:11], s23 offen offset:0 sc1
  buffer_load_dwordx4 v[28:31], v2, s[8:11], s23 offen offset:1024 sc1
  buffer_load_dwordx4 v[32:35], v2, s[8:11], s23 offen offset:2048 sc1
  s_waitcnt vmcnt(0)
  v_max3_u32 v36, v8, v9, v10
  v_max3_u32 v36, v36, v11, v12
  v_max3_u32 v36, v36, v13, v14
  v_max3_u32 v36, v36, v15, v16
  v_max3_u32 v36, v36, v17, v18
  v_max3_u32 v36, v36, v19, v20
  v_max3_u32 v36, v36, v21, v22
  v_max3_u32 v36, v36, v23, v24
  v_max3_u32 v36, v36, v25, v26
  v_max3_u32 v36, v36, v27, v28
  v_max3_u32 v36, v36, v29, v30
  v_max3_u32 v36, v36, v31, v32
  v_max3_u32 v36, v36, v33, v34
  v_max_u32 v36, v36, v35
  v_cmp_eq_u32 vcc, -1, v36
  s_cbranch_vccz cA_va3_sl2
  s_add_u32 s30, s30, 1
  s_cmp_lt_u32 s30, 400000
  s_cbranch_scc1 cA_va3_sl1
  s_branch cA_abort
cA_va3_sl2:
  v_mov_b32 v36, 0
  v_mov_b32 v37, 0
  v_mov_b32 v38, 0
  v_mov_b32 v39, 0
  v_mov_b32 v40, 0
  v_mov_b32 v41, 0
  v_mov_b32 v42, 0
  v_mov_b32 v43, 0
  v_mov_b32 v44, 0
  v_mov_b32 v45, 0
  v_mov_b32 v46, 0
  v_mov_b32 v47, 0
  v_mov_b32 v48, 0
  v_mov_b32 v49, 0
  v_mov_b32 v50, 0
  v_mov_b32 v51, 0
  v_mov_b32 v52, 0
  v_mov_b32 v53, 0
  v_mov_b32 v54, 0
  v_mov_b32 v55, 0
  v_mov_b32 v56, 0
  v_mov_b32 v57, 0
  v_mov_b32 v58, 0
  v_mov_b32 v59, 0
  v_mov_b32 v60, 0
  v_mov_b32 v61, 0
  v_mov_b32 v62, 0
  v_mov_b32 v63, 0
  v_smfmac_f32_16x16x64_bf16 v[36:39], v[8:11], a[0:7], v3
  v_smfmac_f32_16x16x64_bf16 v[40:43], v[8:11], a[56:63], v3
  v_smfmac_f32_16x16x64_bf16 v[44:47], v[8:11], a[112:119], v3
  v_smfmac_f32_16x16x64_bf16 v[48:51], v[8:11], a[168:175], v3
  v_smfmac_f32_16x16x64_bf16 v[52:55], v[8:11], a[224:231], v3
  v_smfmac_f32_16x16x64_bf16 v[56:59], v[8:11], v[144:151], v3
  v_smfmac_f32_16x16x64_bf16 v[60:63], v[8:11], v[200:207], v3
  v_smfmac_f32_16x16x64_bf16 v[36:39], v[12:15], a[8:15], v3
  v_smfmac_f32_16x16x64_bf16 v[40:43], v[12:15], a[64:71], v3
  v_smfmac_f32_16x16x64_bf16 v[44:47], v[12:15], a[120:127], v3
  v_smfmac_f32_16x16x64_bf16 v[48:51], v[12:15], a[176:183], v3
  v_smfmac_f32_16x16x64_bf16 v[52:55], v[12:15], a[232:239], v3
  v_smfmac_f32_16x16x64_bf16 v[56:59], v[12:15], v[152:159], v3
  v_smfmac_f32_16x16x64_bf16 v[60:63], v[12:15], v[208:215], v3
  v_smfmac_f32_16x16x64_bf16 v[36:39], v[16:19], a[16:23], v3
  v_smfmac_f32_16x16x64_bf16 v[40:43], v[16:19], a[72:79], v3
  v_smfmac_f32_16x16x64_bf16 v[44:47], v[16:19], a[128:135], v3
  v_smfmac_f32_16x16x64_bf16 v[48:51], v[16:19], a[184:191], v3
  v_smfmac_f32_16x16x64_bf16 v[52:55], v[16:19], a[240:247], v3
  v_smfmac_f32_16x16x64_bf16 v[56:59], v[16:19], v[160:167], v3
  v_smfmac_f32_16x16x64_bf16 v[60:63], v[16:19], v[216:223], v3
  v_smfmac_f32_16x16x64_bf16 v[36:39], v[20:23], a[24:31], v3
  v_smfmac_f32_16x16x64_bf16 v[40:43], v[20:23], a[80:87], v3
  v_smfmac_f32_16x16x64_bf16 v[44:47], v[20:23], a[136:143], v3
  v_smfmac_f32_16x16x64_bf16 v[48:51], v[20:23], a[192:199], v3
  v_smfmac_f32_16x16x64_bf16 v[52:55], v[20:23], a[248:255], v3
  v_smfmac_f32_16x16x64_bf16 v[56:59], v[20:23], v[168:175], v3
  v_smfmac_f32_16x16x64_bf16 v[60:63], v[20:23], v[224:231], v3
  v_smfmac_f32_16x16x64_bf16 v[36:39], v[24:27], a[32:39], v3
  v_smfmac_f32_16x16x64_bf16 v[40:43], v[24:27], a[88:95], v3
  v_smfmac_f32_16x16x64_bf16 v[44:47], v[24:27], a[144:151], v3
  v_smfmac_f32_16x16x64_bf16 v[48:51], v[24:27], a[200:207], v3
  v_smfmac_f32_16x16x64_bf16 v[52:55], v[24:27], v[120:127], v3
  v_smfmac_f32_16x16x64_bf16 v[56:59], v[24:27], v[176:183], v3
  v_smfmac_f32_16x16x64_bf16 v[60:63], v[24:27], v[232:239], v3
  v_smfmac_f32_16x16x64_bf16 v[36:39], v[28:31], a[40:47], v3
  v_smfmac_f32_16x16x64_bf16 v[40:43], v[28:31], a[96:103], v3
  v_smfmac_f32_16x16x64_bf16 v[44:47], v[28:31], a[152:159], v3
  v_smfmac_f32_16x16x64_bf16 v[48:51], v[28:31], a[208:215], v3
  v_smfmac_f32_16x16x64_bf16 v[52:55], v[28:31], v[128:135], v3
  v_smfmac_f32_16x16x64_bf16 v[56:59], v[28:31], v[184:191], v3
  v_smfmac_f32_16x16x64_bf16 v[60:63], v[28:31], v[240:247], v3
  v_smfmac_f32_16x16x64_bf16 v[36:39], v[32:35], a[48:55], v3
  v_smfmac_f32_16x16x64_bf16 v[40:43], v[32:35], a[104:111], v3
  v_smfmac_f32_16x16x64_bf16 v[44:47], v[32:35], a[160:167], v3
  v_smfmac_f32_16x16x64_bf16 v[48:51], v[32:35], a[216:223], v3
  v_smfmac_f32_16x16x64_bf16 v[52:55], v[32:35], v[136:143], v3
  v_smfmac_f32_16x16x64_bf16 v[56:59], v[32:35], v[192:199], v3
  v_smfmac_f32_16x16x64_bf16 v[60:63], v[32:35], v[248:255], v3
  v_permlane32_swap_b32 v36, v38
  v_permlane32_swap_b32 v37, v39
  v_add_f32 v36, v36, v38
  v_add_f32 v37, v37, v39
  v_cvt_pk_bf16_f32 v38, v36, v37
  ds_write_b32 v104, v38
  v_permlane32_swap_b32 v40, v42
  v_permlane32_swap_b32 v41, v43
  v_add_f32 v40, v40, v42
  v_add_f32 v41, v41, v43
  v_cvt_pk_bf16_f32 v42, v40, v41
  ds_write_b32 v105, v42
  v_permlane32_swap_b32 v44, v46
  v_permlane32_swap_b32 v45, v47
  v_add_f32 v44, v44, v46
  v_add_f32 v45, v45, v47
  v_cvt_pk_bf16_f32 v46, v44, v45
  ds_write_b32 v106, v46
  v_permlane32_swap_b32 v48, v50
  v_permlane32_swap_b32 v49, v51
  v_add_f32 v48, v48, v50
  v_add_f32 v49, v49, v51
  v_cvt_pk_bf16_f32 v50, v48, v49
  ds_write_b32 v107, v50
  v_permlane32_swap_b32 v52, v54
  v_permlane32_swap_b32 v53, v55
  v_add_f32 v52, v52, v54
  v_add_f32 v53, v53, v55
  v_cvt_pk_bf16_f32 v54, v52, v53
  ds_write_b32 v108, v54
  v_permlane32_swap_b32 v56, v58
  v_permlane32_swap_b32 v57, v59
  v_add_f32 v56, v56, v58
  v_add_f32 v57, v57, v59
  v_cvt_pk_bf16_f32 v58, v56, v57
  ds_write_b32 v109, v58
  v_permlane32_swap_b32 v60, v62
  v_permlane32_swap_b32 v61, v63
  v_add_f32 v60, v60, v62
  v_add_f32 v61, v61, v63
  v_cvt_pk_bf16_f32 v62, v60, v61
  ds_write_b32 v110, v62
  s_branch cA_va3_t2d
cA_va3_vor:
  s_sleep 2
  buffer_load_dword v101, off, s[8:11], s27 sc1
  s_add_u32 s30, s30, 1
  s_cmp_lt_u32 s30, 400000
  s_cbranch_scc1 cA_va3_vow
  s_branch cA_abort
cA_abort:
  v_mov_b32 v4, 0xdead
  v_mov_b32 v5, 16
  buffer_store_dword v4, v5, s[12:15], 0 offen
  s_branch ch_end
cA_done:
  s_branch ch_end
.p2align 6
cB_sc0_loop:
  s_mov_b32 s30, 0
  s_mov_b32 s62, 0
  s_setprio 3
  s_sleep 6
cB_sc0_fp_l:
  v_cmp_gt_u32 vcc, s19, v112
  buffer_load_dword v112, v0, s[8:11], 0 offen sc1
  s_cbranch_vccz cB_sc0_fp_d
  v_cmp_gt_u32 vcc, s19, v112
  buffer_load_dword v112, v0, s[8:11], 0 offen sc1
  s_cbranch_vccz cB_sc0_fp_d
  v_cmp_gt_u32 vcc, s19, v112
  buffer_load_dword v112, v0, s[8:11], 0 offen sc1
  s_cbranch_vccz cB_sc0_fp_d
  v_cmp_gt_u32 vcc, s19, v112
  buffer_load_dword v112, v0, s[8:11], 0 offen sc1
  s_cbranch_vccz cB_sc0_fp_d
  v_cmp_gt_u32 vcc, s19, v112
  buffer_load_dword v112, v0, s[8:11], 0 offen sc1
  s_cbranch_vccz cB_sc0_fp_d
  v_cmp_gt_u32 vcc, s19, v112
  buffer_load_dword v112, v0, s[8:11], 0 offen sc1
  s_cbranch_vccz cB_sc0_fp_d
  v_cmp_gt_u32 vcc, s19, v112
  buffer_load_dword v112, v0, s[8:11], 0 offen sc1
  s_cbranch_vccz cB_sc0_fp_d
  v_cmp_gt_u32 vcc, s19, v112
  buffer_load_dword v112, v0, s[8:11], 0 offen sc1
  s_cbranch_vccz cB_sc0_fp_d
  v_cmp_gt_u32 vcc, s19, v112
  buffer_load_dword v112, v0, s[8:11], 0 offen sc1
  s_cbranch_vccz cB_sc0_fp_d
  v_cmp_gt_u32 vcc, s19, v112
  buffer_load_dword v112, v0, s[8:11], 0 offen sc1
  s_cbranch_vccz cB_sc0_fp_d
  v_cmp_gt_u32 vcc, s19, v112
  buffer_load_dword v112, v0, s[8:11], 0 offen sc1
  s_cbranch_vccz cB_sc0_fp_d
  v_cmp_gt_u32 vcc, s19, v112
  buffer_load_dword v112, v0, s[8:11], 0 offen sc1
  s_cbranch_vccz cB_sc0_fp_d
  v_cmp_gt_u32 vcc, s19, v112
  buffer_load_dword v112, v0, s[8:11], 0 offen sc1
  s_cbranch_vccz cB_sc0_fp_d
  v_cmp_gt_u32 vcc, s19, v112
  buffer_load_dword v112, v0, s[8:11], 0 offen sc1
  s_cbranch_vccz cB_sc0_fp_d
  v_cmp_gt_u32 vcc, s19, v112
  buffer_load_dword v112, v0, s[8:11], 0 offen sc1
  s_cbranch_vccz cB_sc0_fp_d
  v_cmp_gt_u32 vcc, s19, v112
  buffer_load_dword v112, v0, s[8:11], 0 offen sc1
  s_cbranch_vccz cB_sc0_fp_d
  s_waitcnt vmcnt(24)
  s_add_u32 s30, s30, 1
  s_cmp_lt_u32 s30, 400000
  s_cbranch_scc1 cB_sc0_fp_l
  s_branch cB_abort
cB_sc0_fp_d:
  buffer_load_dwordx4 v[8:11], v2, s[8:11], s20 offen offset:0 sc1
  s_barrier
  s_setprio 2
  buffer_load_dwordx4 v[12:15], v2, s[8:11], s20 offen offset:1024 sc1
  s_setprio 1
  buffer_load_dwordx4 v[16:19], v2, s[8:11], s20 offen offset:2048 sc1
  s_setprio 0
  buffer_load_dwordx4 v[20:23], v2, s[8:11], s20 offen offset:3072 sc1
cB_sc0_go:
  s_waitcnt vmcnt(3)
  v_smfmac_f32_16x16x64_bf16 v[36:39], v[8:11], a[0:7], v3
  buffer_load_dwordx4 v[32:35], v2, s[8:11], s23 offen offset:0 sc1
  v_cmp_eq_u32 vcc, -1, v8
  v_smfmac_f32_16x16x64_bf16 v[40:43], v[8:11], a[56:63], v3
  v_smfmac_f32_16x16x64_bf16 v[44:47], v[8:11], a[112:119], v3
  buffer_load_dwordx4 v[24:27], v2, s[8:11], s23 offen offset:1024 sc1
  s_cbranch_vccnz cB_sc0_r0
  v_smfmac_f32_16x16x64_bf16 v[48:51], v[8:11], a[168:175], v3
  v_smfmac_f32_16x16x64_bf16 v[52:55], v[8:11], a[224:231], v3
  s_waitcnt vmcnt(4)
  v_cmp_eq_u32 vcc, -1, v12
  v_smfmac_f32_16x16x64_bf16 v[56:59], v[8:11], v[144:151], v3
  buffer_load_dwordx4 v[28:31], v2, s[8:11], s23 offen offset:2048 sc1
  v_smfmac_f32_16x16x64_bf16 v[60:63], v[8:11], v[200:207], v3
  s_cbranch_vccnz cB_sc0_r1
cB_sc0_c1:
  v_smfmac_f32_16x16x64_bf16 v[36:39], v[12:15], a[8:15], v3
  v_smfmac_f32_16x16x64_bf16 v[40:43], v[12:15], a[64:71], v3
  v_smfmac_f32_16x16x64_bf16 v[44:47], v[12:15], a[120:127], v3
  v_smfmac_f32_16x16x64_bf16 v[48:51], v[12:15], a[176:183], v3
  v_smfmac_f32_16x16x64_bf16 v[52:55], v[12:15], a[232:239], v3
  s_waitcnt vmcnt(4)
  v_cmp_eq_u32 vcc, -1, v16
  v_smfmac_f32_16x16x64_bf16 v[56:59], v[12:15], v[152:159], v3
  buffer_load_dwordx4 v[88:91], v117, s[8:11], s26 offen offset:0 sc1
  v_smfmac_f32_16x16x64_bf16 v[60:63], v[12:15], v[208:215], v3
  s_cbranch_vccnz cB_sc0_r2
cB_sc0_c2:
  v_smfmac_f32_16x16x64_bf16 v[36:39], v[16:19], a[16:23], v3
  v_smfmac_f32_16x16x64_bf16 v[40:43], v[16:19], a[72:79], v3
  v_smfmac_f32_16x16x64_bf16 v[44:47], v[16:19], a[128:135], v3
  buffer_load_dwordx4 v[92:95], v117, s[8:11], s26 offen offset:1024 sc1
  v_smfmac_f32_16x16x64_bf16 v[48:51], v[16:19], a[184:191], v3
  v_smfmac_f32_16x16x64_bf16 v[52:55], v[16:19], a[240:247], v3
  s_waitcnt vmcnt(5)
  v_cmp_eq_u32 vcc, -1, v20
  v_smfmac_f32_16x16x64_bf16 v[56:59], v[16:19], v[160:167], v3
  v_smfmac_f32_16x16x64_bf16 v[60:63], v[16:19], v[216:223], v3
  buffer_load_dwordx4 v[96:99], v2, s[8:11], s24 offen offset:0 sc1
  s_cbranch_vccnz cB_sc0_r3
cB_sc0_c3:
  v_smfmac_f32_16x16x64_bf16 v[36:39], v[20:23], a[24:31], v3
  v_smfmac_f32_16x16x64_bf16 v[40:43], v[20:23], a[80:87], v3
  s_waitcnt vmcnt(3)
  v_max3_u32 v66, v24, v27, v28
  v_smfmac_f32_16x16x64_bf16 v[44:47], v[20:23], a[136:143], v3
  v_max3_u32 v66, v66, v31, v32
  v_smfmac_f32_16x16x64_bf16 v[48:51], v[20:23], a[192:199], v3
  buffer_load_dwordx4 v[100:103], v2, s[8:11], s24 offen offset:1024 sc1
  v_max_u32 v66, v66, v35
  v_smfmac_f32_16x16x64_bf16 v[52:55], v[20:23], a[248:255], v3
  v_cmp_eq_u32 vcc, -1, v66
  v_smfmac_f32_16x16x64_bf16 v[56:59], v[20:23], v[168:175], v3
  v_smfmac_f32_16x16x64_bf16 v[60:63], v[20:23], v[224:231], v3
  s_cbranch_vccnz cB_sc0_r4
cB_sc0_c4:
  v_smfmac_f32_16x16x64_bf16 v[60:63], v[32:35], v[232:239], v3
  buffer_load_dwordx4 v[104:107], v2, s[8:11], s26 offen offset:0 sc1
  v_smfmac_f32_16x16x64_bf16 v[60:63], v[24:27], v[240:247], v3
  v_smfmac_f32_16x16x64_bf16 v[60:63], v[28:31], v[248:255], v3
  v_smfmac_f32_16x16x64_bf16 v[52:55], v[32:35], v[120:127], v3
  v_smfmac_f32_16x16x64_bf16 v[52:55], v[24:27], v[128:135], v3
  buffer_load_dwordx4 v[108:111], v2, s[8:11], s26 offen offset:1024 sc1
  v_smfmac_f32_16x16x64_bf16 v[52:55], v[28:31], v[136:143], v3
  v_cvt_pk_bf16_f32 v63, v62, v63
  v_smfmac_f32_16x16x64_bf16 v[56:59], v[32:35], v[176:183], v3
  v_cvt_pk_bf16_f32 v62, v60, v61
  v_smfmac_f32_16x16x64_bf16 v[56:59], v[24:27], v[184:191], v3
  v_mfma_f32_16x16x32_bf16 v[12:15], v[62:65], v[4:7], 0
  v_cvt_pk_bf16_f32 v55, v54, v55
  v_smfmac_f32_16x16x64_bf16 v[56:59], v[28:31], v[192:199], v3
  v_cvt_pk_bf16_f32 v54, v52, v53
  v_smfmac_f32_16x16x64_bf16 v[36:39], v[32:35], a[32:39], v3
  s_nop 1
  v_cvt_pk_bf16_f32 v76, v12, v13
  v_smfmac_f32_16x16x64_bf16 v[36:39], v[24:27], a[40:47], v3
  v_cvt_pk_bf16_f32 v77, v14, v15
  v_smfmac_f32_16x16x64_bf16 v[36:39], v[28:31], a[48:55], v3
  v_cvt_pk_bf16_f32 v56, v56, v57
  v_smfmac_f32_16x16x64_bf16 v[40:43], v[32:35], a[88:95], v3
  v_cvt_pk_bf16_f32 v57, v58, v59
  v_smfmac_f32_16x16x64_bf16 v[40:43], v[24:27], a[96:103], v3
  v_mfma_f32_16x16x32_bf16 v[16:19], v[54:57], v[4:7], 0
  v_cvt_pk_bf16_f32 v39, v38, v39
  v_smfmac_f32_16x16x64_bf16 v[40:43], v[28:31], a[104:111], v3
  v_cvt_pk_bf16_f32 v38, v36, v37
  v_smfmac_f32_16x16x64_bf16 v[44:47], v[32:35], a[144:151], v3
  s_nop 1
  v_cvt_pk_bf16_f32 v78, v16, v17
  v_smfmac_f32_16x16x64_bf16 v[44:47], v[24:27], a[152:159], v3
  v_cvt_pk_bf16_f32 v79, v18, v19
  v_smfmac_f32_16x16x64_bf16 v[44:47], v[28:31], a[160:167], v3
  v_cvt_pk_bf16_f32 v40, v40, v41
  v_smfmac_f32_16x16x64_bf16 v[48:51], v[32:35], a[200:207], v3
  v_cvt_pk_bf16_f32 v41, v42, v43
  v_smfmac_f32_16x16x64_bf16 v[48:51], v[24:27], a[208:215], v3
  v_smfmac_f32_16x16x64_bf16 v[48:51], v[28:31], a[216:223], v3
  s_waitcnt vmcnt(4)
  v_cvt_pk_bf16_f32 v47, v46, v47
  v_smfmac_f32_16x16x64_bf16 v[68:71], v[76:79], v[80:87], v3
  v_cvt_pk_bf16_f32 v46, v44, v45
  v_mfma_f32_16x16x32_bf16 v[12:15], v[38:41], v[4:7], 0
  s_nop 1
  v_cvt_pk_bf16_f32 v48, v48, v49
  v_cvt_pk_bf16_f32 v49, v50, v51
  s_nop 1
  v_mfma_f32_16x16x32_bf16 v[16:19], v[46:49], v[4:7], 0
  v_smfmac_f32_16x16x64_bf16 v[72:75], v[76:79], v[88:95], v3
  v_cvt_pk_bf16_f32 v20, v12, v13
  v_mfma_f32_16x16x32_bf16 v[52:55], v[30:33], v[76:79], 0
  s_waitcnt vmcnt(0)
  v_cvt_pk_bf16_f32 v21, v14, v15
  v_cvt_pk_bf16_f32 v22, v16, v17
  v_cvt_pk_bf16_f32 v23, v18, v19
  s_nop 1
  v_mfma_f32_16x16x32_bf16 v[52:55], v[8:11], v[20:23], v[52:55]
  v_smfmac_f32_16x16x64_bf16 v[68:71], v[20:23], v[96:103], v3
  v_smfmac_f32_16x16x64_bf16 v[72:75], v[20:23], v[104:111], v3
  s_nop 1
  ds_write_b128 v113, v[52:55]
  s_nop 1
  v_permlane32_swap_b32 v68, v70
  v_permlane32_swap_b32 v69, v71
  v_add_f32 v56, v68, v70
  v_add_f32 v58, v69, v71
  v_permlane32_swap_b32 v72, v74
  v_permlane32_swap_b32 v73, v75
  v_add_f32 v57, v72, v74
  v_add_f32 v59, v73, v75
  ds_write_b128 v2, v[56:59] offset:0
  v_cmp_u_f32 vcc, v57, v59
  v_mov_b32 v68, 0
  v_mov_b32 v69, 0
  v_mov_b32 v70, 0
  v_mov_b32 v71, 0
  s_cbranch_vccnz cB_sc0_retry
cB_sc0_cont:
  s_add_u32 s24, s24, 28672
  s_add_u32 s26, s26, 28672
  buffer_load_dwordx4 v[80:83], v117, s[8:11], s24 offen offset:0 sc1
  buffer_load_dwordx4 v[84:87], v117, s[8:11], s24 offen offset:1024 sc1
  v_mov_b32 v72, 0
  v_mov_b32 v73, 0
  v_mfma_f32_32x32x16_bf16 v[36:51], v[68:71], v[68:71], 0
  s_waitcnt lgkmcnt(0)
  s_barrier
  ds_read_b64 v[8:9], v114 offset:0
  ds_read_b64 v[10:11], v114 offset:1024
  ds_read_b64 v[12:13], v114 offset:2048
  ds_read_b64 v[14:15], v114 offset:3072
  ds_read2_b32 v[16:17], v115 offset0:0 offset1:64
  ds_read2_b32 v[18:19], v115 offset0:128 offset1:192
  v_mfma_f32_32x32x16_bf16 v[52:67], v[68:71], v[68:71], 0
  s_waitcnt lgkmcnt(0)
  v_pk_add_f32 v[16:17], v[16:17], v[18:19]
  v_pk_add_f32 v[8:9], v[8:9], v[10:11]
  v_pk_add_f32 v[12:13], v[12:13], v[14:15]
  v_add_f32 v20, v16, v17
  v_pk_add_f32 v[8:9], v[8:9], v[12:13]
  v_max_f32 v22, v8, v9
  v_add_f32_dpp v20, v20, v20 row_ror:8 row_mask:0xf bank_mask:0xf
  s_nop 0
  v_max_f32_dpp v22, v22, v22 row_ror:8 row_mask:0xf bank_mask:0xf
  v_max_f32 v22, v22, v20
  s_nop 1
  v_max_f32_dpp v22, v22, v22 quad_perm:[1,0,3,2] row_mask:0xf bank_mask:0xf
  s_nop 1
  v_max_f32_dpp v22, v22, v22 quad_perm:[2,3,0,1] row_mask:0xf bank_mask:0xf
  s_nop 1
  v_max_f32_dpp v22, v22, v22 row_half_mirror row_mask:0xf bank_mask:0xf
  v_pk_add_f32 v[8:9], v[8:9], v[22:23] op_sel_hi:[1,0] neg_lo:[0,1] neg_hi:[0,1]
  v_sub_f32 v20, v20, v22
  v_exp_f32 v8, v8
  v_exp_f32 v9, v9
  v_exp_f32 v20, v20
  v_add_f32 v24, v8, v9
  v_fmac_f32 v24, 0.5, v20
  v_mov_b32_dpp v21, v20 quad_perm:[1,0,3,2] row_mask:0xf bank_mask:0xf
  s_nop 0
  v_add_f32_dpp v24, v24, v24 quad_perm:[1,0,3,2] row_mask:0xf bank_mask:0xf
  s_nop 1
  v_add_f32_dpp v24, v24, v24 quad_perm:[2,3,0,1] row_mask:0xf bank_mask:0xf
  s_nop 1
  v_add_f32_dpp v24, v24, v24 row_half_mirror row_mask:0xf bank_mask:0xf
  s_nop 1
  v_add_f32_dpp v24, v24, v24 row_ror:8 row_mask:0xf bank_mask:0xf
  v_rcp_f32 v24, v24
  s_nop 0
  v_pk_mul_f32 v[8:9], v[8:9], v[24:25] op_sel_hi:[1,0]
  v_cvt_pk_bf16_f32 v8, abs(v8), abs(v9)
  buffer_store_dword v8, v1, s[8:11], s20 offen sc1
  v_pk_mul_f32 v[20:21], v[20:21], v[24:25] op_sel_hi:[1,0]
  v_cvt_pk_bf16_f32 v20, abs(v20), abs(v21)
  buffer_store_dword v20, v118, s[8:11], s20 offen sc1
  v_mov_b32 v74, 0
  v_mov_b32 v75, 0
  s_mov_b32 s19, s18
  s_add_u32 s18, s18, 1
  s_mov_b32 s22, s20
  s_mov_b32 s20, s21
  s_mov_b32 s21, s22
  s_add_u32 s23, s20, 4096
  s_cmp_lt_u32 s19, 63
  s_cbranch_scc1 cB_sc0_loop
  s_branch cB_done
cB_sc0_r0:
  s_add_u32 s31, s31, 1
  buffer_load_dwordx4 v[8:11], v2, s[8:11], s20 offen offset:0 sc1
  s_waitcnt vmcnt(0)
  v_cmp_eq_u32 vcc, -1, v8
  v_mov_b32 v36, 0
  v_mov_b32 v37, 0
  v_mov_b32 v38, 0
  v_mov_b32 v39, 0
  v_mov_b32 v40, 0
  v_mov_b32 v41, 0
  v_mov_b32 v42, 0
  v_mov_b32 v43, 0
  v_mov_b32 v44, 0
  v_mov_b32 v45, 0
  v_mov_b32 v46, 0
  v_mov_b32 v47, 0
  v_mov_b32 v48, 0
  v_mov_b32 v49, 0
  v_mov_b32 v50, 0
  v_mov_b32 v51, 0
  s_nop 1
  s_cbranch_vccz cB_sc0_go
  s_add_u32 s30, s30, 1
  s_cmp_lt_u32 s30, 400000
  s_cbranch_scc1 cB_sc0_r0
  s_branch cB_abort
cB_sc0_r1:
  s_add_u32 s31, s31, 1
  buffer_load_dwordx4 v[12:15], v2, s[8:11], s20 offen offset:1024 sc1
  s_waitcnt vmcnt(0)
  v_cmp_eq_u32 vcc, -1, v12
  s_nop 4
  s_cbranch_vccz cB_sc0_c1
  s_add_u32 s30, s30, 1
  s_cmp_lt_u32 s30, 400000
  s_cbranch_scc1 cB_sc0_r1
  s_branch cB_abort
cB_sc0_r2:
  s_add_u32 s31, s31, 1
  buffer_load_dwordx4 v[16:19], v2, s[8:11], s20 offen offset:2048 sc1
  s_waitcnt vmcnt(0)
  v_cmp_eq_u32 vcc, -1, v16
  s_nop 4
  s_cbranch_vccz cB_sc0_c2
  s_add_u32 s30, s30, 1
  s_cmp_lt_u32 s30, 400000
  s_cbranch_scc1 cB_sc0_r2
  s_branch cB_abort
cB_sc0_r3:
  s_add_u32 s31, s31, 1
  buffer_load_dwordx4 v[20:23], v2, s[8:11], s20 offen offset:3072 sc1
  s_waitcnt vmcnt(0)
  v_cmp_eq_u32 vcc, -1, v20
  s_nop 4
  s_cbranch_vccz cB_sc0_c3
  s_add_u32 s30, s30, 1
  s_cmp_lt_u32 s30, 400000
  s_cbranch_scc1 cB_sc0_r3
  s_branch cB_abort
cB_sc0_r4:
  s_add_u32 s31, s31, 1
  buffer_load_dwordx4 v[32:35], v2, s[8:11], s23 offen offset:0 sc1
  buffer_load_dwordx4 v[24:27], v2, s[8:11], s23 offen offset:1024 sc1
  buffer_load_dwordx4 v[28:31], v2, s[8:11], s23 offen offset:2048 sc1
  s_waitcnt vmcnt(0)
  v_max3_u32 v66, v24, v27, v28
  v_max3_u32 v66, v66, v31, v32
  v_max_u32 v66, v66, v35
  v_cmp_eq_u32 vcc, -1, v66
  s_nop 4
  s_cbranch_vccz cB_sc0_c4
  s_add_u32 s30, s30, 1
  s_cmp_lt_u32 s30, 400000
  s_cbranch_scc1 cB_sc0_r4
  s_branch cB_abort
cB_sc0_retry:
  s_cmp_lg_u32 s62, 0
  s_cbranch_scc1 cB_sc0_cont
  s_waitcnt vmcnt(0) lgkmcnt(0)
cB_sc0_rv:
  buffer_load_dwordx4 v[8:11], v2, s[8:11], s20 offen offset:0 sc1
  buffer_load_dwordx4 v[12:15], v2, s[8:11], s20 offen offset:1024 sc1
  buffer_load_dwordx4 v[16:19], v2, s[8:11], s20 offen offset:2048 sc1
  buffer_load_dwordx4 v[20:23], v2, s[8:11], s20 offen offset:3072 sc1
  buffer_load_dwordx4 v[32:35], v2, s[8:11], s23 offen offset:0 sc1
  buffer_load_dwordx4 v[24:27], v2, s[8:11], s23 offen offset:1024 sc1
  buffer_load_dwordx4 v[28:31], v2, s[8:11], s23 offen offset:2048 sc1
  s_waitcnt vmcnt(0)
  v_max3_u32 v66, v8, v9, v10
  v_max3_u32 v66, v66, v11, v12
  v_max3_u32 v66, v66, v13, v14
  v_max3_u32 v66, v66, v15, v16
  v_max3_u32 v66, v66, v17, v18
  v_max3_u32 v66, v66, v19, v20
  v_max3_u32 v66, v66, v21, v22
  v_max3_u32 v66, v66, v23, v24
  v_max3_u32 v66, v66, v25, v26
  v_max3_u32 v66, v66, v27, v28
  v_max3_u32 v66, v66, v29, v30
  v_max3_u32 v66, v66, v31, v32
  v_max3_u32 v66, v66, v33, v34
  v_max_u32 v66, v66, v35
  v_cmp_eq_u32 vcc, -1, v66
  s_cbranch_vccz cB_sc0_rk
  s_add_u32 s30, s30, 1
  s_cmp_lt_u32 s30, 400000
  s_cbranch_scc1 cB_sc0_rv
  s_branch cB_abort
cB_sc0_rk:
  s_mov_b32 s62, 1
  v_mov_b32 v36, 0
  v_mov_b32 v37, 0
  v_mov_b32 v38, 0
  v_mov_b32 v39, 0
  v_mov_b32 v40, 0
  v_mov_b32 v41, 0
  v_mov_b32 v42, 0
  v_mov_b32 v43, 0
  v_mov_b32 v44, 0
  v_mov_b32 v45, 0
  v_mov_b32 v46, 0
  v_mov_b32 v47, 0
  v_mov_b32 v48, 0
  v_mov_b32 v49, 0
  v_mov_b32 v50, 0
  v_mov_b32 v51, 0
  v_mov_b32 v60, 0
  v_mov_b32 v61, 0
  v_mov_b32 v62, 0
  v_mov_b32 v63, 0
  v_mov_b32 v68, 0
  v_mov_b32 v69, 0
  v_mov_b32 v70, 0
  v_mov_b32 v71, 0
  v_mov_b32 v72, 0
  v_mov_b32 v73, 0
  v_mov_b32 v74, 0
  v_mov_b32 v75, 0
  v_mov_b32 v52, 0
  v_mov_b32 v53, 0
  v_mov_b32 v54, 0
  v_mov_b32 v55, 0
  v_mov_b32 v56, 0
  v_mov_b32 v57, 0
  v_mov_b32 v58, 0
  v_mov_b32 v59, 0
  s_add_u32 s31, s31, 0x100
  s_nop 0
  s_branch cB_sc0_go
.p2align 6
cB_sc1_loop:
  s_mov_b32 s30, 0
  s_mov_b32 s62, 0
  s_setprio 3
  s_barrier
  buffer_load_dwordx4 v[8:11], v2, s[8:11], s20 offen offset:0 sc1
  s_setprio 2
  buffer_load_dwordx4 v[12:15], v2, s[8:11], s20 offen offset:1024 sc1
  s_setprio 1
  buffer_load_dwordx4 v[16:19], v2, s[8:11], s20 offen offset:2048 sc1
  s_setprio 0
  buffer_load_dwordx4 v[20:23], v2, s[8:11], s20 offen offset:3072 sc1
cB_sc1_go:
  s_waitcnt vmcnt(3)
  v_smfmac_f32_16x16x64_bf16 v[36:39], v[8:11], a[0:7], v3
  buffer_load_dwordx4 v[28:31], v2, s[8:11], s23 offen offset:0 sc1
  v_cmp_eq_u32 vcc, -1, v8
  v_smfmac_f32_16x16x64_bf16 v[40:43], v[8:11], a[56:63], v3
  v_smfmac_f32_16x16x64_bf16 v[44:47], v[8:11], a[112:119], v3
  buffer_load_dwordx4 v[24:27], v2, s[8:11], s23 offen offset:1024 sc1
  s_cbranch_vccnz cB_sc1_r0
  v_smfmac_f32_16x16x64_bf16 v[48:51], v[8:11], a[168:175], v3
  v_smfmac_f32_16x16x64_bf16 v[52:55], v[8:11], a[224:231], v3
  s_waitcnt vmcnt(4)
  v_cmp_eq_u32 vcc, -1, v12
  v_smfmac_f32_16x16x64_bf16 v[56:59], v[8:11], v[144:151], v3
  buffer_load_dwordx4 v[32:35], v2, s[8:11], s23 offen offset:2048 sc1
  v_smfmac_f32_16x16x64_bf16 v[60:63], v[8:11], v[200:207], v3
  s_cbranch_vccnz cB_sc1_r1
cB_sc1_c1:
  v_smfmac_f32_16x16x64_bf16 v[36:39], v[12:15], a[8:15], v3
  v_smfmac_f32_16x16x64_bf16 v[40:43], v[12:15], a[64:71], v3
  v_smfmac_f32_16x16x64_bf16 v[44:47], v[12:15], a[120:127], v3
  v_smfmac_f32_16x16x64_bf16 v[48:51], v[12:15], a[176:183], v3
  v_smfmac_f32_16x16x64_bf16 v[52:55], v[12:15], a[232:239], v3
  s_waitcnt vmcnt(4)
  v_cmp_eq_u32 vcc, -1, v16
  v_smfmac_f32_16x16x64_bf16 v[56:59], v[12:15], v[152:159], v3
  buffer_load_dwordx4 v[88:91], v117, s[8:11], s26 offen offset:0 sc1
  v_smfmac_f32_16x16x64_bf16 v[60:63], v[12:15], v[208:215], v3
  s_cbranch_vccnz cB_sc1_r2
cB_sc1_c2:
  v_smfmac_f32_16x16x64_bf16 v[36:39], v[16:19], a[16:23], v3
  v_smfmac_f32_16x16x64_bf16 v[40:43], v[16:19], a[72:79], v3
  v_smfmac_f32_16x16x64_bf16 v[44:47], v[16:19], a[128:135], v3
  buffer_load_dwordx4 v[92:95], v117, s[8:11], s26 offen offset:1024 sc1
  v_smfmac_f32_16x16x64_bf16 v[48:51], v[16:19], a[184:191], v3
  v_smfmac_f32_16x16x64_bf16 v[52:55], v[16:19], a[240:247], v3
  s_waitcnt vmcnt(5)
  v_cmp_eq_u32 vcc, -1, v20
  v_smfmac_f32_16x16x64_bf16 v[56:59], v[16:19], v[160:167], v3
  v_smfmac_f32_16x16x64_bf16 v[60:63], v[16:19], v[216:223], v3
  buffer_load_dwordx4 v[96:99], v2, s[8:11], s24 offen offset:0 sc1
  s_cbranch_vccnz cB_sc1_r3
cB_sc1_c3:
  v_smfmac_f32_16x16x64_bf16 v[36:39], v[20:23], a[24:31], v3
  v_smfmac_f32_16x16x64_bf16 v[40:43], v[20:23], a[80:87], v3
  s_waitcnt vmcnt(3)
  v_max3_u32 v66, v24, v27, v28
  v_smfmac_f32_16x16x64_bf16 v[44:47], v[20:23], a[136:143], v3
  v_max3_u32 v66, v66, v31, v32
  v_smfmac_f32_16x16x64_bf16 v[48:51], v[20:23], a[192:199], v3
  buffer_load_dwordx4 v[100:103], v2, s[8:11], s24 offen offset:1024 sc1
  v_max_u32 v66, v66, v35
  v_smfmac_f32_16x16x64_bf16 v[52:55], v[20:23], a[248:255], v3
  v_cmp_eq_u32 vcc, -1, v66
  v_smfmac_f32_16x16x64_bf16 v[56:59], v[20:23], v[168:175], v3
  v_smfmac_f32_16x16x64_bf16 v[60:63], v[20:23], v[224:231], v3
  s_cbranch_vccnz cB_sc1_r4
cB_sc1_c4:
  v_smfmac_f32_16x16x64_bf16 v[60:63], v[28:31], v[232:239], v3
  buffer_load_dwordx4 v[104:107], v2, s[8:11], s26 offen offset:0 sc1
  v_smfmac_f32_16x16x64_bf16 v[60:63], v[24:27], v[240:247], v3
  v_smfmac_f32_16x16x64_bf16 v[60:63], v[32:35], v[248:255], v3
  v_smfmac_f32_16x16x64_bf16 v[52:55], v[28:31], v[120:127], v3
  v_smfmac_f32_16x16x64_bf16 v[52:55], v[24:27], v[128:135], v3
  buffer_load_dwordx4 v[108:111], v2, s[8:11], s26 offen offset:1024 sc1
  v_smfmac_f32_16x16x64_bf16 v[52:55], v[32:35], v[136:143], v3
  v_cvt_pk_bf16_f32 v63, v62, v63
  v_smfmac_f32_16x16x64_bf16 v[56:59], v[28:31], v[176:183], v3
  v_cvt_pk_bf16_f32 v62, v60, v61
  v_smfmac_f32_16x16x64_bf16 v[56:59], v[24:27], v[184:191], v3
  v_mfma_f32_16x16x32_bf16 v[8:11], v[62:65], v[4:7], 0
  v_cvt_pk_bf16_f32 v55, v54, v55
  v_smfmac_f32_16x16x64_bf16 v[56:59], v[32:35], v[192:199], v3
  v_cvt_pk_bf16_f32 v54, v52, v53
  v_smfmac_f32_16x16x64_bf16 v[36:39], v[28:31], a[32:39], v3
  s_nop 1
  v_cvt_pk_bf16_f32 v78, v8, v9
  v_smfmac_f32_16x16x64_bf16 v[36:39], v[24:27], a[40:47], v3
  v_cvt_pk_bf16_f32 v79, v10, v11
  v_smfmac_f32_16x16x64_bf16 v[36:39], v[32:35], a[48:55], v3
  v_cvt_pk_bf16_f32 v56, v56, v57
  v_smfmac_f32_16x16x64_bf16 v[40:43], v[28:31], a[88:95], v3
  v_cvt_pk_bf16_f32 v57, v58, v59
  v_smfmac_f32_16x16x64_bf16 v[40:43], v[24:27], a[96:103], v3
  v_mfma_f32_16x16x32_bf16 v[16:19], v[54:57], v[4:7], 0
  v_cvt_pk_bf16_f32 v39, v38, v39
  v_smfmac_f32_16x16x64_bf16 v[40:43], v[32:35], a[104:111], v3
  v_cvt_pk_bf16_f32 v38, v36, v37
  v_smfmac_f32_16x16x64_bf16 v[44:47], v[28:31], a[144:151], v3
  s_nop 1
  v_cvt_pk_bf16_f32 v76, v16, v17
  v_smfmac_f32_16x16x64_bf16 v[44:47], v[24:27], a[152:159], v3
  v_cvt_pk_bf16_f32 v77, v18, v19
  v_smfmac_f32_16x16x64_bf16 v[44:47], v[32:35], a[160:167], v3
  v_cvt_pk_bf16_f32 v40, v40, v41
  v_smfmac_f32_16x16x64_bf16 v[48:51], v[28:31], a[200:207], v3
  v_cvt_pk_bf16_f32 v41, v42, v43
  v_smfmac_f32_16x16x64_bf16 v[48:51], v[24:27], a[208:215], v3
  v_smfmac_f32_16x16x64_bf16 v[48:51], v[32:35], a[216:223], v3
  s_waitcnt vmcnt(4)
  v_cvt_pk_bf16_f32 v47, v46, v47
  v_smfmac_f32_16x16x64_bf16 v[68:71], v[76:79], v[80:87], v3
  v_cvt_pk_bf16_f32 v46, v44, v45
  v_mfma_f32_16x16x32_bf16 v[8:11], v[38:41], v[4:7], 0
  s_nop 1
  v_cvt_pk_bf16_f32 v48, v48, v49
  v_cvt_pk_bf16_f32 v49, v50, v51
  s_nop 1
  v_mfma_f32_16x16x32_bf16 v[16:19], v[46:49], v[4:7], 0
  v_smfmac_f32_16x16x64_bf16 v[72:75], v[76:79], v[88:95], v3
  v_cvt_pk_bf16_f32 v20, v8, v9
  v_mfma_f32_16x16x32_bf16 v[52:55], v[30:33], v[76:79], 0
  s_waitcnt vmcnt(0)
  v_cvt_pk_bf16_f32 v21, v10, v11
  v_cvt_pk_bf16_f32 v22, v16, v17
  v_cvt_pk_bf16_f32 v23, v18, v19
  s_nop 1
  v_mfma_f32_16x16x32_bf16 v[52:55], v[12:15], v[20:23], v[52:55]
  v_smfmac_f32_16x16x64_bf16 v[68:71], v[20:23], v[96:103], v3
  v_smfmac_f32_16x16x64_bf16 v[72:75], v[20:23], v[104:111], v3
  s_nop 1
  ds_write_b128 v113, v[52:55]
  s_nop 1
  v_permlane32_swap_b32 v68, v70
  v_permlane32_swap_b32 v69, v71
  v_add_f32 v56, v68, v70
  v_add_f32 v58, v69, v71
  v_permlane32_swap_b32 v72, v74
  v_permlane32_swap_b32 v73, v75
  v_add_f32 v57, v72, v74
  v_add_f32 v59, v73, v75
  ds_write_b128 v2, v[56:59] offset:1024
  v_cmp_u_f32 vcc, v57, v59
  v_mov_b32 v68, 0
  v_mov_b32 v69, 0
  v_mov_b32 v70, 0
  v_mov_b32 v71, 0
  s_cbranch_vccnz cB_sc1_retry
cB_sc1_cont:
  s_add_u32 s24, s24, 28672
  s_add_u32 s26, s26, 28672
  buffer_load_dwordx4 v[80:83], v117, s[8:11], s24 offen offset:0 sc1
  buffer_load_dwordx4 v[84:87], v117, s[8:11], s24 offen offset:1024 sc1
  v_mov_b32 v72, 0
  v_mov_b32 v73, 0
  v_mfma_f32_32x32x16_bf16 v[36:51], v[68:71], v[68:71], 0
  s_waitcnt lgkmcnt(0)
  s_barrier
  ds_read_b64 v[8:9], v114 offset:0
  ds_read_b64 v[10:11], v114 offset:1024
  ds_read_b64 v[12:13], v114 offset:2048
  ds_read_b64 v[14:15], v114 offset:3072
  ds_read2_b32 v[16:17], v115 offset0:0 offset1:64
  ds_read2_b32 v[18:19], v115 offset0:128 offset1:192
  v_mfma_f32_32x32x16_bf16 v[52:67], v[68:71], v[68:71], 0
  s_waitcnt lgkmcnt(0)
  v_pk_add_f32 v[16:17], v[16:17], v[18:19]
  v_pk_add_f32 v[8:9], v[8:9], v[10:11]
  v_pk_add_f32 v[12:13], v[12:13], v[14:15]
  v_add_f32 v20, v16, v17
  v_pk_add_f32 v[8:9], v[8:9], v[12:13]
  v_max_f32 v22, v8, v9
  v_add_f32_dpp v20, v20, v20 row_ror:8 row_mask:0xf bank_mask:0xf
  s_nop 0
  v_max_f32_dpp v22, v22, v22 row_ror:8 row_mask:0xf bank_mask:0xf
  v_max_f32 v22, v22, v20
  buffer_store_dword v112, v116, s[8:11], 0 offen sc1
  s_nop 0
  v_max_f32_dpp v22, v22, v22 quad_perm:[1,0,3,2] row_mask:0xf bank_mask:0xf
  s_nop 1
  v_max_f32_dpp v22, v22, v22 quad_perm:[2,3,0,1] row_mask:0xf bank_mask:0xf
  s_nop 1
  v_max_f32_dpp v22, v22, v22 row_half_mirror row_mask:0xf bank_mask:0xf
  v_pk_add_f32 v[8:9], v[8:9], v[22:23] op_sel_hi:[1,0] neg_lo:[0,1] neg_hi:[0,1]
  v_sub_f32 v20, v20, v22
  v_exp_f32 v8, v8
  v_exp_f32 v9, v9
  v_exp_f32 v20, v20
  v_add_f32 v24, v8, v9
  v_fmac_f32 v24, 0.5, v20
  v_mov_b32_dpp v21, v20 quad_perm:[1,0,3,2] row_mask:0xf bank_mask:0xf
  s_nop 0
  v_add_f32_dpp v24, v24, v24 quad_perm:[1,0,3,2] row_mask:0xf bank_mask:0xf
  s_nop 1
  v_add_f32_dpp v24, v24, v24 quad_perm:[2,3,0,1] row_mask:0xf bank_mask:0xf
  s_nop 1
  v_add_f32_dpp v24, v24, v24 row_half_mirror row_mask:0xf bank_mask:0xf
  s_nop 1
  v_add_f32_dpp v24, v24, v24 row_ror:8 row_mask:0xf bank_mask:0xf
  v_rcp_f32 v24, v24
  s_nop 0
  v_pk_mul_f32 v[8:9], v[8:9], v[24:25] op_sel_hi:[1,0]
  v_cvt_pk_bf16_f32 v8, abs(v8), abs(v9)
  buffer_store_dword v8, v1, s[8:11], s20 offen sc1
  v_pk_mul_f32 v[20:21], v[20:21], v[24:25] op_sel_hi:[1,0]
  v_cvt_pk_bf16_f32 v20, abs(v20), abs(v21)
  buffer_store_dword v20, v118, s[8:11], s20 offen sc1
  v_mov_b32 v74, 0
  v_mov_b32 v75, 0
  s_mov_b32 s19, s18
  s_add_u32 s18, s18, 1
  s_mov_b32 s22, s20
  s_mov_b32 s20, s21
  s_mov_b32 s21, s22
  s_add_u32 s23, s20, 4096
  v_mov_b32 v112, s18
  s_cmp_lt_u32 s19, 63
  s_nop 0
  s_cbranch_scc1 cB_sc1_loop
  s_branch cB_done
cB_sc1_r0:
  s_add_u32 s31, s31, 1
  buffer_load_dwordx4 v[8:11], v2, s[8:11], s20 offen offset:0 sc1
  s_waitcnt vmcnt(0)
  v_cmp_eq_u32 vcc, -1, v8
  v_mov_b32 v36, 0
  v_mov_b32 v37, 0
  v_mov_b32 v38, 0
  v_mov_b32 v39, 0
  v_mov_b32 v40, 0
  v_mov_b32 v41, 0
  v_mov_b32 v42, 0
  v_mov_b32 v43, 0
  v_mov_b32 v44, 0
  v_mov_b32 v45, 0
  v_mov_b32 v46, 0
  v_mov_b32 v47, 0
  v_mov_b32 v48, 0
  v_mov_b32 v49, 0
  v_mov_b32 v50, 0
  v_mov_b32 v51, 0
  s_nop 1
  s_cbranch_vccz cB_sc1_go
  s_add_u32 s30, s30, 1
  s_cmp_lt_u32 s30, 400000
  s_cbranch_scc1 cB_sc1_r0
  s_branch cB_abort
cB_sc1_r1:
  s_add_u32 s31, s31, 1
  buffer_load_dwordx4 v[12:15], v2, s[8:11], s20 offen offset:1024 sc1
  s_waitcnt vmcnt(0)
  v_cmp_eq_u32 vcc, -1, v12
  s_nop 4
  s_cbranch_vccz cB_sc1_c1
  s_add_u32 s30, s30, 1
  s_cmp_lt_u32 s30, 400000
  s_cbranch_scc1 cB_sc1_r1
  s_branch cB_abort
cB_sc1_r2:
  s_add_u32 s31, s31, 1
  buffer_load_dwordx4 v[16:19], v2, s[8:11], s20 offen offset:2048 sc1
  s_waitcnt vmcnt(0)
  v_cmp_eq_u32 vcc, -1, v16
  s_nop 4
  s_cbranch_vccz cB_sc1_c2
  s_add_u32 s30, s30, 1
  s_cmp_lt_u32 s30, 400000
  s_cbranch_scc1 cB_sc1_r2
  s_branch cB_abort
cB_sc1_r3:
  s_add_u32 s31, s31, 1
  buffer_load_dwordx4 v[20:23], v2, s[8:11], s20 offen offset:3072 sc1
  s_waitcnt vmcnt(0)
  v_cmp_eq_u32 vcc, -1, v20
  s_nop 4
  s_cbranch_vccz cB_sc1_c3
  s_add_u32 s30, s30, 1
  s_cmp_lt_u32 s30, 400000
  s_cbranch_scc1 cB_sc1_r3
  s_branch cB_abort
cB_sc1_r4:
  s_add_u32 s31, s31, 1
  buffer_load_dwordx4 v[28:31], v2, s[8:11], s23 offen offset:0 sc1
  buffer_load_dwordx4 v[24:27], v2, s[8:11], s23 offen offset:1024 sc1
  buffer_load_dwordx4 v[32:35], v2, s[8:11], s23 offen offset:2048 sc1
  s_waitcnt vmcnt(0)
  v_max3_u32 v66, v24, v27, v28
  v_max3_u32 v66, v66, v31, v32
  v_max_u32 v66, v66, v35
  v_cmp_eq_u32 vcc, -1, v66
  s_nop 4
  s_cbranch_vccz cB_sc1_c4
  s_add_u32 s30, s30, 1
  s_cmp_lt_u32 s30, 400000
  s_cbranch_scc1 cB_sc1_r4
  s_branch cB_abort
cB_sc1_retry:
  s_cmp_lg_u32 s62, 0
  s_cbranch_scc1 cB_sc1_cont
  s_waitcnt vmcnt(0) lgkmcnt(0)
cB_sc1_rv:
  buffer_load_dwordx4 v[8:11], v2, s[8:11], s20 offen offset:0 sc1
  buffer_load_dwordx4 v[12:15], v2, s[8:11], s20 offen offset:1024 sc1
  buffer_load_dwordx4 v[16:19], v2, s[8:11], s20 offen offset:2048 sc1
  buffer_load_dwordx4 v[20:23], v2, s[8:11], s20 offen offset:3072 sc1
  buffer_load_dwordx4 v[28:31], v2, s[8:11], s23 offen offset:0 sc1
  buffer_load_dwordx4 v[24:27], v2, s[8:11], s23 offen offset:1024 sc1
  buffer_load_dwordx4 v[32:35], v2, s[8:11], s23 offen offset:2048 sc1
  s_waitcnt vmcnt(0)
  v_max3_u32 v66, v8, v9, v10
  v_max3_u32 v66, v66, v11, v12
  v_max3_u32 v66, v66, v13, v14
  v_max3_u32 v66, v66, v15, v16
  v_max3_u32 v66, v66, v17, v18
  v_max3_u32 v66, v66, v19, v20
  v_max3_u32 v66, v66, v21, v22
  v_max3_u32 v66, v66, v23, v24
  v_max3_u32 v66, v66, v25, v26
  v_max3_u32 v66, v66, v27, v28
  v_max3_u32 v66, v66, v29, v30
  v_max3_u32 v66, v66, v31, v32
  v_max3_u32 v66, v66, v33, v34
  v_max_u32 v66, v66, v35
  v_cmp_eq_u32 vcc, -1, v66
  s_cbranch_vccz cB_sc1_rk
  s_add_u32 s30, s30, 1
  s_cmp_lt_u32 s30, 400000
  s_cbranch_scc1 cB_sc1_rv
  s_branch cB_abort
cB_sc1_rk:
  s_mov_b32 s62, 1
  v_mov_b32 v36, 0
  v_mov_b32 v37, 0
  v_mov_b32 v38, 0
  v_mov_b32 v39, 0
  v_mov_b32 v40, 0
  v_mov_b32 v41, 0
  v_mov_b32 v42, 0
  v_mov_b32 v43, 0
  v_mov_b32 v44, 0
  v_mov_b32 v45, 0
  v_mov_b32 v46, 0
  v_mov_b32 v47, 0
  v_mov_b32 v48, 0
  v_mov_b32 v49, 0
  v_mov_b32 v50, 0
  v_mov_b32 v51, 0
  v_mov_b32 v60, 0
  v_mov_b32 v61, 0
  v_mov_b32 v62, 0
  v_mov_b32 v63, 0
  v_mov_b32 v68, 0
  v_mov_b32 v69, 0
  v_mov_b32 v70, 0
  v_mov_b32 v71, 0
  v_mov_b32 v72, 0
  v_mov_b32 v73, 0
  v_mov_b32 v74, 0
  v_mov_b32 v75, 0
  v_mov_b32 v52, 0
  v_mov_b32 v53, 0
  v_mov_b32 v54, 0
  v_mov_b32 v55, 0
  v_mov_b32 v56, 0
  v_mov_b32 v57, 0
  v_mov_b32 v58, 0
  v_mov_b32 v59, 0
  s_add_u32 s31, s31, 0x100
  s_nop 0
  s_branch cB_sc1_go
.p2align 6
cB_sc2_loop:
  s_mov_b32 s30, 0
  s_mov_b32 s62, 0
  s_setprio 3
  s_barrier
  buffer_load_dwordx4 v[8:11], v2, s[8:11], s20 offen offset:0 sc1
  s_setprio 2
  buffer_load_dwordx4 v[12:15], v2, s[8:11], s20 offen offset:1024 sc1
  s_setprio 1
  buffer_load_dwordx4 v[16:19], v2, s[8:11], s20 offen offset:2048 sc1
  s_setprio 0
  buffer_load_dwordx4 v[20:23], v2, s[8:11], s20 offen offset:3072 sc1
cB_sc2_go:
  s_waitcnt vmcnt(3)
  v_smfmac_f32_16x16x64_bf16 v[36:39], v[8:11], a[0:7], v3
  buffer_load_dwordx4 v[24:27], v2, s[8:11], s23 offen offset:0 sc1
  v_cmp_eq_u32 vcc, -1, v8
  v_smfmac_f32_16x16x64_bf16 v[40:43], v[8:11], a[56:63], v3
  v_smfmac_f32_16x16x64_bf16 v[44:47], v[8:11], a[112:119], v3
  buffer_load_dwordx4 v[32:35], v2, s[8:11], s23 offen offset:1024 sc1
  s_cbranch_vccnz cB_sc2_r0
  v_smfmac_f32_16x16x64_bf16 v[48:51], v[8:11], a[168:175], v3
  v_smfmac_f32_16x16x64_bf16 v[52:55], v[8:11], a[224:231], v3
  s_waitcnt vmcnt(4)
  v_cmp_eq_u32 vcc, -1, v12
  v_smfmac_f32_16x16x64_bf16 v[56:59], v[8:11], v[144:151], v3
  buffer_load_dwordx4 v[28:31], v2, s[8:11], s23 offen offset:2048 sc1
  v_smfmac_f32_16x16x64_bf16 v[62:65], v[8:11], v[200:207], v3
  s_cbranch_vccnz cB_sc2_r1
cB_sc2_c1:
  v_smfmac_f32_16x16x64_bf16 v[36:39], v[12:15], a[8:15], v3
  v_smfmac_f32_16x16x64_bf16 v[40:43], v[12:15], a[64:71], v3
  v_smfmac_f32_16x16x64_bf16 v[44:47], v[12:15], a[120:127], v3
  v_smfmac_f32_16x16x64_bf16 v[48:51], v[12:15], a[176:183], v3
  v_smfmac_f32_16x16x64_bf16 v[52:55], v[12:15], a[232:239], v3
  s_waitcnt vmcnt(4)
  v_cmp_eq_u32 vcc, -1, v16
  v_smfmac_f32_16x16x64_bf16 v[56:59], v[12:15], v[152:159], v3
  buffer_load_dwordx4 v[88:91], v117, s[8:11], s26 offen offset:0 sc1
  v_smfmac_f32_16x16x64_bf16 v[62:65], v[12:15], v[208:215], v3
  s_cbranch_vccnz cB_sc2_r2
cB_sc2_c2:
  v_smfmac_f32_16x16x64_bf16 v[36:39], v[16:19], a[16:23], v3
  v_smfmac_f32_16x16x64_bf16 v[40:43], v[16:19], a[72:79], v3
  v_smfmac_f32_16x16x64_bf16 v[44:47], v[16:19], a[128:135], v3
  buffer_load_dwordx4 v[92:95], v117, s[8:11], s26 offen offset:1024 sc1
  v_smfmac_f32_16x16x64_bf16 v[48:51], v[16:19], a[184:191], v3
  v_smfmac_f32_16x16x64_bf16 v[52:55], v[16:19], a[240:247], v3
  s_waitcnt vmcnt(5)
  v_cmp_eq_u32 vcc, -1, v20
  v_smfmac_f32_16x16x64_bf16 v[56:59], v[16:19], v[160:167], v3
  v_smfmac_f32_16x16x64_bf16 v[62:65], v[16:19], v[216:223], v3
  buffer_load_dwordx4 v[96:99], v2, s[8:11], s24 offen offset:0 sc1
  s_cbranch_vccnz cB_sc2_r3
cB_sc2_c3:
  v_smfmac_f32_16x16x64_bf16 v[36:39], v[20:23], a[24:31], v3
  v_smfmac_f32_16x16x64_bf16 v[40:43], v[20:23], a[80:87], v3
  s_waitcnt vmcnt(3)
  v_max3_u32 v66, v24, v27, v28
  v_smfmac_f32_16x16x64_bf16 v[44:47], v[20:23], a[136:143], v3
  v_max3_u32 v66, v66, v31, v32
  v_smfmac_f32_16x16x64_bf16 v[48:51], v[20:23], a[192:199], v3
  buffer_load_dwordx4 v[100:103], v2, s[8:11], s24 offen offset:1024 sc1
  v_max_u32 v66, v66, v35
  v_smfmac_f32_16x16x64_bf16 v[52:55], v[20:23], a[248:255], v3
  v_cmp_eq_u32 vcc, -1, v66
  v_smfmac_f32_16x16x64_bf16 v[56:59], v[20:23], v[168:175], v3
  v_smfmac_f32_16x16x64_bf16 v[62:65], v[20:23], v[224:231], v3
  s_cbranch_vccnz cB_sc2_r4
cB_sc2_c4:
  v_smfmac_f32_16x16x64_bf16 v[62:65], v[24:27], v[232:239], v3
  buffer_load_dwordx4 v[104:107], v2, s[8:11], s26 offen offset:0 sc1
  v_smfmac_f32_16x16x64_bf16 v[62:65], v[32:35], v[240:247], v3
  v_smfmac_f32_16x16x64_bf16 v[62:65], v[28:31], v[248:255], v3
  v_smfmac_f32_16x16x64_bf16 v[52:55], v[24:27], v[120:127], v3
  v_smfmac_f32_16x16x64_bf16 v[52:55], v[32:35], v[128:135], v3
  buffer_load_dwordx4 v[108:111], v2, s[8:11], s26 offen offset:1024 sc1
  v_smfmac_f32_16x16x64_bf16 v[52:55], v[28:31], v[136:143], v3
  v_cvt_pk_bf16_f32 v62, v62, v63
  v_smfmac_f32_16x16x64_bf16 v[56:59], v[24:27], v[176:183], v3
  v_cvt_pk_bf16_f32 v63, v64, v65
  v_smfmac_f32_16x16x64_bf16 v[56:59], v[32:35], v[184:191], v3
  v_mfma_f32_16x16x32_bf16 v[8:11], v[60:63], v[4:7], 0
  v_cvt_pk_bf16_f32 v55, v54, v55
  v_smfmac_f32_16x16x64_bf16 v[56:59], v[28:31], v[192:199], v3
  v_cvt_pk_bf16_f32 v54, v52, v53
  v_smfmac_f32_16x16x64_bf16 v[36:39], v[24:27], a[32:39], v3
  s_nop 1
  v_cvt_pk_bf16_f32 v76, v8, v9
  v_smfmac_f32_16x16x64_bf16 v[36:39], v[32:35], a[40:47], v3
  v_cvt_pk_bf16_f32 v77, v10, v11
  v_smfmac_f32_16x16x64_bf16 v[36:39], v[28:31], a[48:55], v3
  v_cvt_pk_bf16_f32 v56, v56, v57
  v_smfmac_f32_16x16x64_bf16 v[40:43], v[24:27], a[88:95], v3
  v_cvt_pk_bf16_f32 v57, v58, v59
  v_smfmac_f32_16x16x64_bf16 v[40:43], v[32:35], a[96:103], v3
  v_mfma_f32_16x16x32_bf16 v[12:15], v[54:57], v[4:7], 0
  v_cvt_pk_bf16_f32 v39, v38, v39
  v_smfmac_f32_16x16x64_bf16 v[40:43], v[28:31], a[104:111], v3
  v_cvt_pk_bf16_f32 v38, v36, v37
  v_smfmac_f32_16x16x64_bf16 v[44:47], v[24:27], a[144:151], v3
  s_nop 1
  v_cvt_pk_bf16_f32 v78, v12, v13
  v_smfmac_f32_16x16x64_bf16 v[44:47], v[32:35], a[152:159], v3
  v_cvt_pk_bf16_f32 v79, v14, v15
  v_smfmac_f32_16x16x64_bf16 v[44:47], v[28:31], a[160:167], v3
  v_cvt_pk_bf16_f32 v40, v40, v41
  v_smfmac_f32_16x16x64_bf16 v[48:51], v[24:27], a[200:207], v3
  v_cvt_pk_bf16_f32 v41, v42, v43
  v_smfmac_f32_16x16x64_bf16 v[48:51], v[32:35], a[208:215], v3
  v_smfmac_f32_16x16x64_bf16 v[48:51], v[28:31], a[216:223], v3
  s_waitcnt vmcnt(4)
  v_cvt_pk_bf16_f32 v47, v46, v47
  v_smfmac_f32_16x16x64_bf16 v[68:71], v[76:79], v[80:87], v3
  v_cvt_pk_bf16_f32 v46, v44, v45
  v_mfma_f32_16x16x32_bf16 v[8:11], v[38:41], v[4:7], 0
  s_nop 1
  v_cvt_pk_bf16_f32 v48, v48, v49
  v_cvt_pk_bf16_f32 v49, v50, v51
  s_nop 1
  v_mfma_f32_16x16x32_bf16 v[12:15], v[46:49], v[4:7], 0
  v_smfmac_f32_16x16x64_bf16 v[72:75], v[76:79], v[88:95], v3
  v_cvt_pk_bf16_f32 v20, v8, v9
  v_mfma_f32_16x16x32_bf16 v[52:55], v[30:33], v[76:79], 0
  s_waitcnt vmcnt(0)
  v_cvt_pk_bf16_f32 v21, v10, v11
  v_cvt_pk_bf16_f32 v22, v12, v13
  v_cvt_pk_bf16_f32 v23, v14, v15
  s_nop 1
  v_mfma_f32_16x16x32_bf16 v[52:55], v[16:19], v[20:23], v[52:55]
  v_smfmac_f32_16x16x64_bf16 v[68:71], v[20:23], v[96:103], v3
  v_smfmac_f32_16x16x64_bf16 v[72:75], v[20:23], v[104:111], v3
  s_nop 1
  ds_write_b128 v113, v[52:55]
  s_nop 1
  v_permlane32_swap_b32 v68, v70
  v_permlane32_swap_b32 v69, v71
  v_add_f32 v56, v68, v70
  v_add_f32 v58, v69, v71
  v_permlane32_swap_b32 v72, v74
  v_permlane32_swap_b32 v73, v75
  v_add_f32 v57, v72, v74
  v_add_f32 v59, v73, v75
  ds_write_b128 v2, v[56:59] offset:2048
  v_cmp_u_f32 vcc, v57, v59
  v_mov_b32 v68, 0
  v_mov_b32 v69, 0
  v_mov_b32 v70, 0
  v_mov_b32 v71, 0
  s_cbranch_vccnz cB_sc2_retry
cB_sc2_cont:
  s_add_u32 s24, s24, 28672
  s_add_u32 s26, s26, 28672
  buffer_load_dwordx4 v[80:83], v117, s[8:11], s24 offen offset:0 sc1
  buffer_load_dwordx4 v[84:87], v117, s[8:11], s24 offen offset:1024 sc1
  v_mov_b32 v72, 0
  v_mov_b32 v73, 0
  v_mfma_f32_32x32x16_bf16 v[36:51], v[68:71], v[68:71], 0
  s_waitcnt lgkmcnt(0)
  s_barrier
  v_mfma_f32_32x32x16_bf16 v[52:67], v[68:71], v[68:71], 0
  buffer_store_dwordx2 v[118:119], v114, s[8:11], s21 offen sc1
  buffer_store_dwordx2 v[118:119], v115, s[8:11], s21 offen sc1
  s_buffer_load_dword s70, s[8:11], s35
  s_add_u32 s22, s24, 114688
  s_buffer_load_dword s71, s[8:11], s22
  s_mul_i32 s22, s18, 7168
  s_add_u32 s22, s22, 88024064
  s_buffer_load_dword s72, s[8:11], s22
  s_add_u32 s35, s35, 458752
  v_mov_b32 v74, 0
  v_mov_b32 v75, 0
  s_mov_b32 s19, s18
  s_add_u32 s18, s18, 1
  s_mov_b32 s22, s20
  s_mov_b32 s20, s21
  s_mov_b32 s21, s22
  s_add_u32 s23, s20, 4096
  s_cmp_lt_u32 s19, 63
  s_cbranch_scc1 cB_sc2_loop
  s_branch cB_done
cB_sc2_r0:
  s_add_u32 s31, s31, 1
  buffer_load_dwordx4 v[8:11], v2, s[8:11], s20 offen offset:0 sc1
  s_waitcnt vmcnt(0)
  v_cmp_eq_u32 vcc, -1, v8
  v_mov_b32 v36, 0
  v_mov_b32 v37, 0
  v_mov_b32 v38, 0
  v_mov_b32 v39, 0
  v_mov_b32 v40, 0
  v_mov_b32 v41, 0
  v_mov_b32 v42, 0
  v_mov_b32 v43, 0
  v_mov_b32 v44, 0
  v_mov_b32 v45, 0
  v_mov_b32 v46, 0
  v_mov_b32 v47, 0
  v_mov_b32 v48, 0
  v_mov_b32 v49, 0
  v_mov_b32 v50, 0
  v_mov_b32 v51, 0
  s_nop 1
  s_cbranch_vccz cB_sc2_go
  s_add_u32 s30, s30, 1
  s_cmp_lt_u32 s30, 400000
  s_cbranch_scc1 cB_sc2_r0
  s_branch cB_abort
cB_sc2_r1:
  s_add_u32 s31, s31, 1
  buffer_load_dwordx4 v[12:15], v2, s[8:11], s20 offen offset:1024 sc1
  s_waitcnt vmcnt(0)
  v_cmp_eq_u32 vcc, -1, v12
  s_nop 4
  s_cbranch_vccz cB_sc2_c1
  s_add_u32 s30, s30, 1
  s_cmp_lt_u32 s30, 400000
  s_cbranch_scc1 cB_sc2_r1
  s_branch cB_abort
cB_sc2_r2:
  s_add_u32 s31, s31, 1
  buffer_load_dwordx4 v[16:19], v2, s[8:11], s20 offen offset:2048 sc1
  s_waitcnt vmcnt(0)
  v_cmp_eq_u32 vcc, -1, v16
  s_nop 4
  s_cbranch_vccz cB_sc2_c2
  s_add_u32 s30, s30, 1
  s_cmp_lt_u32 s30, 400000
  s_cbranch_scc1 cB_sc2_r2
  s_branch cB_abort
cB_sc2_r3:
  s_add_u32 s31, s31, 1
  buffer_load_dwordx4 v[20:23], v2, s[8:11], s20 offen offset:3072 sc1
  s_waitcnt vmcnt(0)
  v_cmp_eq_u32 vcc, -1, v20
  s_nop 4
  s_cbranch_vccz cB_sc2_c3
  s_add_u32 s30, s30, 1
  s_cmp_lt_u32 s30, 400000
  s_cbranch_scc1 cB_sc2_r3
  s_branch cB_abort
cB_sc2_r4:
  s_add_u32 s31, s31, 1
  buffer_load_dwordx4 v[24:27], v2, s[8:11], s23 offen offset:0 sc1
  buffer_load_dwordx4 v[32:35], v2, s[8:11], s23 offen offset:1024 sc1
  buffer_load_dwordx4 v[28:31], v2, s[8:11], s23 offen offset:2048 sc1
  s_waitcnt vmcnt(0)
  v_max3_u32 v66, v24, v27, v28
  v_max3_u32 v66, v66, v31, v32
  v_max_u32 v66, v66, v35
  v_cmp_eq_u32 vcc, -1, v66
  s_nop 4
  s_cbranch_vccz cB_sc2_c4
  s_add_u32 s30, s30, 1
  s_cmp_lt_u32 s30, 400000
  s_cbranch_scc1 cB_sc2_r4
  s_branch cB_abort
cB_sc2_retry:
  s_cmp_lg_u32 s62, 0
  s_cbranch_scc1 cB_sc2_cont
  s_waitcnt vmcnt(0) lgkmcnt(0)
cB_sc2_rv:
  buffer_load_dwordx4 v[8:11], v2, s[8:11], s20 offen offset:0 sc1
  buffer_load_dwordx4 v[12:15], v2, s[8:11], s20 offen offset:1024 sc1
  buffer_load_dwordx4 v[16:19], v2, s[8:11], s20 offen offset:2048 sc1
  buffer_load_dwordx4 v[20:23], v2, s[8:11], s20 offen offset:3072 sc1
  buffer_load_dwordx4 v[24:27], v2, s[8:11], s23 offen offset:0 sc1
  buffer_load_dwordx4 v[32:35], v2, s[8:11], s23 offen offset:1024 sc1
  buffer_load_dwordx4 v[28:31], v2, s[8:11], s23 offen offset:2048 sc1
  s_waitcnt vmcnt(0)
  v_max3_u32 v66, v8, v9, v10
  v_max3_u32 v66, v66, v11, v12
  v_max3_u32 v66, v66, v13, v14
  v_max3_u32 v66, v66, v15, v16
  v_max3_u32 v66, v66, v17, v18
  v_max3_u32 v66, v66, v19, v20
  v_max3_u32 v66, v66, v21, v22
  v_max3_u32 v66, v66, v23, v24
  v_max3_u32 v66, v66, v25, v26
  v_max3_u32 v66, v66, v27, v28
  v_max3_u32 v66, v66, v29, v30
  v_max3_u32 v66, v66, v31, v32
  v_max3_u32 v66, v66, v33, v34
  v_max_u32 v66, v66, v35
  v_cmp_eq_u32 vcc, -1, v66
  s_cbranch_vccz cB_sc2_rk
  s_add_u32 s30, s30, 1
  s_cmp_lt_u32 s30, 400000
  s_cbranch_scc1 cB_sc2_rv
  s_branch cB_abort
cB_sc2_rk:
  s_mov_b32 s62, 1
  v_mov_b32 v36, 0
  v_mov_b32 v37, 0
  v_mov_b32 v38, 0
  v_mov_b32 v39, 0
  v_mov_b32 v40, 0
  v_mov_b32 v41, 0
  v_mov_b32 v42, 0
  v_mov_b32 v43, 0
  v_mov_b32 v44, 0
  v_mov_b32 v45, 0
  v_mov_b32 v46, 0
  v_mov_b32 v47, 0
  v_mov_b32 v48, 0
  v_mov_b32 v49, 0
  v_mov_b32 v50, 0
  v_mov_b32 v51, 0
  v_mov_b32 v62, 0
  v_mov_b32 v63, 0
  v_mov_b32 v64, 0
  v_mov_b32 v65, 0
  v_mov_b32 v68, 0
  v_mov_b32 v69, 0
  v_mov_b32 v70, 0
  v_mov_b32 v71, 0
  v_mov_b32 v72, 0
  v_mov_b32 v73, 0
  v_mov_b32 v74, 0
  v_mov_b32 v75, 0
  v_mov_b32 v52, 0
  v_mov_b32 v53, 0
  v_mov_b32 v54, 0
  v_mov_b32 v55, 0
  v_mov_b32 v56, 0
  v_mov_b32 v57, 0
  v_mov_b32 v58, 0
  v_mov_b32 v59, 0
  s_add_u32 s31, s31, 0x100
  s_nop 0
  s_branch cB_sc2_go
.p2align 6
cB_sc3_loop:
  s_mov_b32 s30, 0
  s_mov_b32 s62, 0
  s_setprio 3
  s_barrier
  buffer_load_dwordx4 v[8:11], v2, s[8:11], s20 offen offset:0 sc1
  s_setprio 2
  buffer_load_dwordx4 v[12:15], v2, s[8:11], s20 offen offset:1024 sc1
  s_setprio 1
  buffer_load_dwordx4 v[16:19], v2, s[8:11], s20 offen offset:2048 sc1
  s_setprio 0
  buffer_load_dwordx4 v[20:23], v2, s[8:11], s20 offen offset:3072 sc1
cB_sc3_go:
  s_waitcnt vmcnt(3)
  v_smfmac_f32_16x16x64_bf16 v[36:39], v[8:11], a[0:7], v3
  buffer_load_dwordx4 v[24:27], v2, s[8:11], s23 offen offset:0 sc1
  v_cmp_eq_u32 vcc, -1, v8
  v_smfmac_f32_16x16x64_bf16 v[40:43], v[8:11], a[56:63], v3
  v_smfmac_f32_16x16x64_bf16 v[44:47], v[8:11], a[112:119], v3
  buffer_load_dwordx4 v[28:31], v2, s[8:11], s23 offen offset:1024 sc1
  s_cbranch_vccnz cB_sc3_r0
  v_smfmac_f32_16x16x64_bf16 v[48:51], v[8:11], a[168:175], v3
  v_smfmac_f32_16x16x64_bf16 v[52:55], v[8:11], a[224:231], v3
  s_waitcnt vmcnt(4)
  v_cmp_eq_u32 vcc, -1, v12
  v_smfmac_f32_16x16x64_bf16 v[56:59], v[8:11], v[144:151], v3
  buffer_load_dwordx4 v[32:35], v2, s[8:11], s23 offen offset:2048 sc1
  v_smfmac_f32_16x16x64_bf16 v[62:65], v[8:11], v[200:207], v3
  s_cbranch_vccnz cB_sc3_r1
cB_sc3_c1:
  v_smfmac_f32_16x16x64_bf16 v[36:39], v[12:15], a[8:15], v3
  v_smfmac_f32_16x16x64_bf16 v[40:43], v[12:15], a[64:71], v3
  v_smfmac_f32_16x16x64_bf16 v[44:47], v[12:15], a[120:127], v3
  v_smfmac_f32_16x16x64_bf16 v[48:51], v[12:15], a[176:183], v3
  v_smfmac_f32_16x16x64_bf16 v[52:55], v[12:15], a[232:239], v3
  s_waitcnt vmcnt(4)
  v_cmp_eq_u32 vcc, -1, v16
  v_smfmac_f32_16x16x64_bf16 v[56:59], v[12:15], v[152:159], v3
  buffer_load_dwordx4 v[88:91], v117, s[8:11], s26 offen offset:0 sc1
  v_smfmac_f32_16x16x64_bf16 v[62:65], v[12:15], v[208:215], v3
  s_cbranch_vccnz cB_sc3_r2
cB_sc3_c2:
  v_smfmac_f32_16x16x64_bf16 v[36:39], v[16:19], a[16:23], v3
  v_smfmac_f32_16x16x64_bf16 v[40:43], v[16:19], a[72:79], v3
  v_smfmac_f32_16x16x64_bf16 v[44:47], v[16:19], a[128:135], v3
  buffer_load_dwordx4 v[92:95], v117, s[8:11], s26 offen offset:1024 sc1
  v_smfmac_f32_16x16x64_bf16 v[48:51], v[16:19], a[184:191], v3
  v_smfmac_f32_16x16x64_bf16 v[52:55], v[16:19], a[240:247], v3
  s_waitcnt vmcnt(5)
  v_cmp_eq_u32 vcc, -1, v20
  v_smfmac_f32_16x16x64_bf16 v[56:59], v[16:19], v[160:167], v3
  v_smfmac_f32_16x16x64_bf16 v[62:65], v[16:19], v[216:223], v3
  buffer_load_dwordx4 v[96:99], v2, s[8:11], s24 offen offset:0 sc1
  s_cbranch_vccnz cB_sc3_r3
cB_sc3_c3:
  v_smfmac_f32_16x16x64_bf16 v[36:39], v[20:23], a[24:31], v3
  v_smfmac_f32_16x16x64_bf16 v[40:43], v[20:23], a[80:87], v3
  s_waitcnt vmcnt(3)
  v_max3_u32 v66, v24, v27, v28
  v_smfmac_f32_16x16x64_bf16 v[44:47], v[20:23], a[136:143], v3
  v_max3_u32 v66, v66, v31, v32
  v_smfmac_f32_16x16x64_bf16 v[48:51], v[20:23], a[192:199], v3
  buffer_load_dwordx4 v[100:103], v2, s[8:11], s24 offen offset:1024 sc1
  v_max_u32 v66, v66, v35
  v_smfmac_f32_16x16x64_bf16 v[52:55], v[20:23], a[248:255], v3
  v_cmp_eq_u32 vcc, -1, v66
  v_smfmac_f32_16x16x64_bf16 v[56:59], v[20:23], v[168:175], v3
  v_smfmac_f32_16x16x64_bf16 v[62:65], v[20:23], v[224:231], v3
  s_cbranch_vccnz cB_sc3_r4
cB_sc3_c4:
  v_smfmac_f32_16x16x64_bf16 v[62:65], v[24:27], v[232:239], v3
  buffer_load_dwordx4 v[104:107], v2, s[8:11], s26 offen offset:0 sc1
  v_smfmac_f32_16x16x64_bf16 v[62:65], v[28:31], v[240:247], v3
  v_smfmac_f32_16x16x64_bf16 v[62:65], v[32:35], v[248:255], v3
  v_smfmac_f32_16x16x64_bf16 v[52:55], v[24:27], v[120:127], v3
  v_smfmac_f32_16x16x64_bf16 v[52:55], v[28:31], v[128:135], v3
  buffer_load_dwordx4 v[108:111], v2, s[8:11], s26 offen offset:1024 sc1
  v_smfmac_f32_16x16x64_bf16 v[52:55], v[32:35], v[136:143], v3
  v_cvt_pk_bf16_f32 v62, v62, v63
  v_smfmac_f32_16x16x64_bf16 v[56:59], v[24:27], v[176:183], v3
  v_cvt_pk_bf16_f32 v63, v64, v65
  v_smfmac_f32_16x16x64_bf16 v[56:59], v[28:31], v[184:191], v3
  v_mfma_f32_16x16x32_bf16 v[8:11], v[60:63], v[4:7], 0
  v_cvt_pk_bf16_f32 v55, v54, v55
  v_smfmac_f32_16x16x64_bf16 v[56:59], v[32:35], v[192:199], v3
  v_cvt_pk_bf16_f32 v54, v52, v53
  v_smfmac_f32_16x16x64_bf16 v[36:39], v[24:27], a[32:39], v3
  s_nop 1
  v_cvt_pk_bf16_f32 v78, v8, v9
  v_smfmac_f32_16x16x64_bf16 v[36:39], v[28:31], a[40:47], v3
  v_cvt_pk_bf16_f32 v79, v10, v11
  v_smfmac_f32_16x16x64_bf16 v[36:39], v[32:35], a[48:55], v3
  v_cvt_pk_bf16_f32 v56, v56, v57
  v_smfmac_f32_16x16x64_bf16 v[40:43], v[24:27], a[88:95], v3
  v_cvt_pk_bf16_f32 v57, v58, v59
  v_smfmac_f32_16x16x64_bf16 v[40:43], v[28:31], a[96:103], v3
  v_mfma_f32_16x16x32_bf16 v[12:15], v[54:57], v[4:7], 0
  v_cvt_pk_bf16_f32 v39, v38, v39
  v_smfmac_f32_16x16x64_bf16 v[40:43], v[32:35], a[104:111], v3
  v_cvt_pk_bf16_f32 v38, v36, v37
  v_smfmac_f32_16x16x64_bf16 v[44:47], v[24:27], a[144:151], v3
  s_nop 1
  v_cvt_pk_bf16_f32 v76, v12, v13
  v_smfmac_f32_16x16x64_bf16 v[44:47], v[28:31], a[152:159], v3
  v_cvt_pk_bf16_f32 v77, v14, v15
  v_smfmac_f32_16x16x64_bf16 v[44:47], v[32:35], a[160:167], v3
  v_cvt_pk_bf16_f32 v40, v40, v41
  v_smfmac_f32_16x16x64_bf16 v[48:51], v[24:27], a[200:207], v3
  v_cvt_pk_bf16_f32 v41, v42, v43
  v_smfmac_f32_16x16x64_bf16 v[48:51], v[28:31], a[208:215], v3
  v_smfmac_f32_16x16x64_bf16 v[48:51], v[32:35], a[216:223], v3
  s_waitcnt vmcnt(4)
  v_cvt_pk_bf16_f32 v47, v46, v47
  v_smfmac_f32_16x16x64_bf16 v[68:71], v[76:79], v[80:87], v3
  v_cvt_pk_bf16_f32 v46, v44, v45
  v_mfma_f32_16x16x32_bf16 v[8:11], v[38:41], v[4:7], 0
  s_nop 1
  v_cvt_pk_bf16_f32 v48, v48, v49
  v_cvt_pk_bf16_f32 v49, v50, v51
  s_nop 1
  v_mfma_f32_16x16x32_bf16 v[12:15], v[46:49], v[4:7], 0
  v_smfmac_f32_16x16x64_bf16 v[72:75], v[76:79], v[88:95], v3
  v_cvt_pk_bf16_f32 v16, v8, v9
  v_mfma_f32_16x16x32_bf16 v[52:55], v[30:33], v[76:79], 0
  s_waitcnt vmcnt(0)
  v_cvt_pk_bf16_f32 v17, v10, v11
  v_cvt_pk_bf16_f32 v18, v12, v13
  v_cvt_pk_bf16_f32 v19, v14, v15
  s_nop 1
  v_mfma_f32_16x16x32_bf16 v[52:55], v[20:23], v[16:19], v[52:55]
  v_smfmac_f32_16x16x64_bf16 v[68:71], v[16:19], v[96:103], v3
  v_smfmac_f32_16x16x64_bf16 v[72:75], v[16:19], v[104:111], v3
  s_nop 1
  ds_write_b128 v113, v[52:55]
  s_nop 1
  v_permlane32_swap_b32 v68, v70
  v_permlane32_swap_b32 v69, v71
  v_add_f32 v56, v68, v70
  v_add_f32 v58, v69, v71
  v_permlane32_swap_b32 v72, v74
  v_permlane32_swap_b32 v73, v75
  v_add_f32 v57, v72, v74
  v_add_f32 v59, v73, v75
  ds_write_b128 v2, v[56:59] offset:3072
  v_cmp_u_f32 vcc, v57, v59
  v_mov_b32 v68, 0
  v_mov_b32 v69, 0
  v_mov_b32 v70, 0
  v_mov_b32 v71, 0
  s_cbranch_vccnz cB_sc3_retry
cB_sc3_cont:
  s_add_u32 s24, s24, 28672
  s_add_u32 s26, s26, 28672
  buffer_load_dwordx4 v[80:83], v117, s[8:11], s24 offen offset:0 sc1
  buffer_load_dwordx4 v[84:87], v117, s[8:11], s24 offen offset:1024 sc1
  v_mov_b32 v72, 0
  v_mov_b32 v73, 0
  v_mfma_f32_16x16x32_bf16 v[62:65], v[68:71], v[68:71], 0
  s_waitcnt lgkmcnt(0)
  s_barrier
  v_mov_b32 v52, 0
  v_mov_b32 v53, 0
  v_mov_b32 v54, 0
  v_mov_b32 v55, 0
  v_mov_b32 v56, 0
  v_mov_b32 v57, 0
  v_mov_b32 v58, 0
  v_mov_b32 v59, 0
  v_mfma_f32_32x32x16_bf16 v[36:51], v[68:71], v[68:71], 0
  v_mov_b32 v74, 0
  v_mov_b32 v75, 0
  s_mov_b32 s19, s18
  s_add_u32 s18, s18, 1
  s_mov_b32 s22, s20
  s_mov_b32 s20, s21
  s_mov_b32 s21, s22
  s_add_u32 s23, s20, 4096
  s_cmp_lt_u32 s19, 63
  s_nop 2
  s_cbranch_scc1 cB_sc3_loop
  s_branch cB_done
cB_sc3_r0:
  s_add_u32 s31, s31, 1
  buffer_load_dwordx4 v[8:11], v2, s[8:11], s20 offen offset:0 sc1
  s_waitcnt vmcnt(0)
  v_cmp_eq_u32 vcc, -1, v8
  v_mov_b32 v36, 0
  v_mov_b32 v37, 0
  v_mov_b32 v38, 0
  v_mov_b32 v39, 0
  v_mov_b32 v40, 0
  v_mov_b32 v41, 0
  v_mov_b32 v42, 0
  v_mov_b32 v43, 0
  v_mov_b32 v44, 0
  v_mov_b32 v45, 0
  v_mov_b32 v46, 0
  v_mov_b32 v47, 0
  v_mov_b32 v48, 0
  v_mov_b32 v49, 0
  v_mov_b32 v50, 0
  v_mov_b32 v51, 0
  s_nop 1
  s_cbranch_vccz cB_sc3_go
  s_add_u32 s30, s30, 1
  s_cmp_lt_u32 s30, 400000
  s_cbranch_scc1 cB_sc3_r0
  s_branch cB_abort
cB_sc3_r1:
  s_add_u32 s31, s31, 1
  buffer_load_dwordx4 v[12:15], v2, s[8:11], s20 offen offset:1024 sc1
  s_waitcnt vmcnt(0)
  v_cmp_eq_u32 vcc, -1, v12
  s_nop 4
  s_cbranch_vccz cB_sc3_c1
  s_add_u32 s30, s30, 1
  s_cmp_lt_u32 s30, 400000
  s_cbranch_scc1 cB_sc3_r1
  s_branch cB_abort
cB_sc3_r2:
  s_add_u32 s31, s31, 1
  buffer_load_dwordx4 v[16:19], v2, s[8:11], s20 offen offset:2048 sc1
  s_waitcnt vmcnt(0)
  v_cmp_eq_u32 vcc, -1, v16
  s_nop 4
  s_cbranch_vccz cB_sc3_c2
  s_add_u32 s30, s30, 1
  s_cmp_lt_u32 s30, 400000
  s_cbranch_scc1 cB_sc3_r2
  s_branch cB_abort
cB_sc3_r3:
  s_add_u32 s31, s31, 1
  buffer_load_dwordx4 v[20:23], v2, s[8:11], s20 offen offset:3072 sc1
  s_waitcnt vmcnt(0)
  v_cmp_eq_u32 vcc, -1, v20
  s_nop 4
  s_cbranch_vccz cB_sc3_c3
  s_add_u32 s30, s30, 1
  s_cmp_lt_u32 s30, 400000
  s_cbranch_scc1 cB_sc3_r3
  s_branch cB_abort
cB_sc3_r4:
  s_add_u32 s31, s31, 1
  buffer_load_dwordx4 v[24:27], v2, s[8:11], s23 offen offset:0 sc1
  buffer_load_dwordx4 v[28:31], v2, s[8:11], s23 offen offset:1024 sc1
  buffer_load_dwordx4 v[32:35], v2, s[8:11], s23 offen offset:2048 sc1
  s_waitcnt vmcnt(0)
  v_max3_u32 v66, v24, v27, v28
  v_max3_u32 v66, v66, v31, v32
  v_max_u32 v66, v66, v35
  v_cmp_eq_u32 vcc, -1, v66
  s_nop 4
  s_cbranch_vccz cB_sc3_c4
  s_add_u32 s30, s30, 1
  s_cmp_lt_u32 s30, 400000
  s_cbranch_scc1 cB_sc3_r4
  s_branch cB_abort
cB_sc3_retry:
  s_cmp_lg_u32 s62, 0
  s_cbranch_scc1 cB_sc3_cont
  s_waitcnt vmcnt(0) lgkmcnt(0)
cB_sc3_rv:
  buffer_load_dwordx4 v[8:11], v2, s[8:11], s20 offen offset:0 sc1
  buffer_load_dwordx4 v[12:15], v2, s[8:11], s20 offen offset:1024 sc1
  buffer_load_dwordx4 v[16:19], v2, s[8:11], s20 offen offset:2048 sc1
  buffer_load_dwordx4 v[20:23], v2, s[8:11], s20 offen offset:3072 sc1
  buffer_load_dwordx4 v[24:27], v2, s[8:11], s23 offen offset:0 sc1
  buffer_load_dwordx4 v[28:31], v2, s[8:11], s23 offen offset:1024 sc1
  buffer_load_dwordx4 v[32:35], v2, s[8:11], s23 offen offset:2048 sc1
  s_waitcnt vmcnt(0)
  v_max3_u32 v66, v8, v9, v10
  v_max3_u32 v66, v66, v11, v12
  v_max3_u32 v66, v66, v13, v14
  v_max3_u32 v66, v66, v15, v16
  v_max3_u32 v66, v66, v17, v18
  v_max3_u32 v66, v66, v19, v20
  v_max3_u32 v66, v66, v21, v22
  v_max3_u32 v66, v66, v23, v24
  v_max3_u32 v66, v66, v25, v26
  v_max3_u32 v66, v66, v27, v28
  v_max3_u32 v66, v66, v29, v30
  v_max3_u32 v66, v66, v31, v32
  v_max3_u32 v66, v66, v33, v34
  v_max_u32 v66, v66, v35
  v_cmp_eq_u32 vcc, -1, v66
  s_cbranch_vccz cB_sc3_rk
  s_add_u32 s30, s30, 1
  s_cmp_lt_u32 s30, 400000
  s_cbranch_scc1 cB_sc3_rv
  s_branch cB_abort
cB_sc3_rk:
  s_mov_b32 s62, 1
  v_mov_b32 v36, 0
  v_mov_b32 v37, 0
  v_mov_b32 v38, 0
  v_mov_b32 v39, 0
  v_mov_b32 v40, 0
  v_mov_b32 v41, 0
  v_mov_b32 v42, 0
  v_mov_b32 v43, 0
  v_mov_b32 v44, 0
  v_mov_b32 v45, 0
  v_mov_b32 v46, 0
  v_mov_b32 v47, 0
  v_mov_b32 v48, 0
  v_mov_b32 v49, 0
  v_mov_b32 v50, 0
  v_mov_b32 v51, 0
  v_mov_b32 v62, 0
  v_mov_b32 v63, 0
  v_mov_b32 v64, 0
  v_mov_b32 v65, 0
  v_mov_b32 v68, 0
  v_mov_b32 v69, 0
  v_mov_b32 v70, 0
  v_mov_b32 v71, 0
  v_mov_b32 v72, 0
  v_mov_b32 v73, 0
  v_mov_b32 v74, 0
  v_mov_b32 v75, 0
  v_mov_b32 v52, 0
  v_mov_b32 v53, 0
  v_mov_b32 v54, 0
  v_mov_b32 v55, 0
  v_mov_b32 v56, 0
  v_mov_b32 v57, 0
  v_mov_b32 v58, 0
  v_mov_b32 v59, 0
  s_add_u32 s31, s31, 0x100
  s_nop 0
  s_branch cB_sc3_go
.p2align 6
cB_va0_loop:
  s_mov_b32 s30, 0
  s_barrier
  buffer_load_dwordx4 v[24:27], v2, s[8:11], s23 offen offset:0 sc1
  buffer_load_dwordx4 v[28:31], v2, s[8:11], s23 offen offset:1024 sc1
  s_barrier
  s_cmp_lt_u32 s19, 59
  s_cbranch_scc1 cB_va0_m1
  buffer_store_dword v160, v1, s[8:11], s38 offen sc1
  s_cmp_lg_u32 s19, 63
  s_cbranch_scc1 cB_va0_m2
  v_min_u32 v64, -2, v64
  v_min_u32 v65, -2, v65
  v_min_u32 v66, -2, v66
  v_min_u32 v67, -2, v67
  v_min_u32 v68, -2, v68
  v_min_u32 v69, -2, v69
  v_min_u32 v70, -2, v70
  v_min_u32 v71, -2, v71
  v_min_u32 v72, -2, v72
  v_min_u32 v73, -2, v73
  v_min_u32 v74, -2, v74
  v_min_u32 v75, -2, v75
  v_min_u32 v76, -2, v76
  v_min_u32 v77, -2, v77
  v_min_u32 v78, -2, v78
  v_min_u32 v79, -2, v79
  buffer_store_dwordx4 v[64:67], v2, s[8:11], s33 offen offset:0 sc1
  buffer_store_dwordx4 v[68:71], v2, s[8:11], s33 offen offset:2048 sc1
  s_add_u32 s33, s33, 4096
  buffer_store_dwordx4 v[72:75], v2, s[8:11], s33 offen offset:0 sc1
  buffer_store_dwordx4 v[76:79], v2, s[8:11], s33 offen offset:2048 sc1
  s_add_u32 s33, s33, 4096
  s_waitcnt vmcnt(5)
  s_branch cB_va0_m3
cB_va0_m1:
  buffer_store_dword v160, v1, s[8:11], s38 offen sc1
cB_va0_m2:
  s_add_u32 s22, s25, 0
  buffer_load_dwordx4 v[80:83], v6, s[8:11], s22 offen offset:0 sc1
  buffer_load_dwordx4 v[84:87], v6, s[8:11], s22 offen offset:1792 sc1
  s_add_u32 s22, s25, 3584
  buffer_load_dwordx4 v[88:91], v6, s[8:11], s22 offen offset:0 sc1
  buffer_load_dwordx4 v[92:95], v6, s[8:11], s22 offen offset:1792 sc1
  s_add_u32 s22, s25, 7168
  buffer_load_dwordx4 v[96:99], v6, s[8:11], s22 offen offset:0 sc1
  s_mul_i32 s38, s18, 7168
  s_add_u32 s38, s38, 88002560
  s_waitcnt vmcnt(6)
cB_va0_m3:
  ds_write_b128 v2, v[24:27] offset:12288
  ds_write_b128 v2, v[28:31] offset:13312
  v_smfmac_f32_16x16x64_bf16 v[36:39], v[24:27], a[32:39], v3
  buffer_load_dwordx4 v[100:103], v6, s[8:11], s22 offen offset:1792 sc1
  v_smfmac_f32_16x16x64_bf16 v[40:43], v[24:27], a[88:95], v3
  s_add_u32 s22, s25, 10752
  buffer_load_dwordx4 v[104:107], v6, s[8:11], s22 offen offset:0 sc1
  v_smfmac_f32_16x16x64_bf16 v[44:47], v[24:27], a[144:151], v3
  buffer_load_dwordx4 v[108:111], v6, s[8:11], s22 offen offset:1792 sc1
  v_smfmac_f32_16x16x64_bf16 v[48:51], v[24:27], a[200:207], v3
  s_add_u32 s22, s25, 14336
  buffer_load_dwordx4 v[112:115], v6, s[8:11], s22 offen offset:0 sc1
  v_smfmac_f32_16x16x64_bf16 v[52:55], v[24:27], v[176:183], v3
  s_waitcnt lgkmcnt(0)
  s_barrier
  ds_read_b128 v[8:11], v2 offset:8192
  ds_read_b128 v[12:15], v2 offset:9216
  ds_read_b128 v[16:19], v2 offset:10240
  ds_read_b128 v[20:23], v2 offset:11264
  ds_read_b128 v[32:35], v2 offset:14336
  buffer_load_dwordx4 v[116:119], v6, s[8:11], s22 offen offset:1792 sc1
  v_smfmac_f32_16x16x64_bf16 v[56:59], v[24:27], v[232:239], v3
  s_add_u32 s22, s25, 17920
  buffer_load_dwordx4 v[120:123], v6, s[8:11], s22 offen offset:0 sc1
  v_smfmac_f32_16x16x64_bf16 v[36:39], v[28:31], a[40:47], v3
  buffer_load_dwordx4 v[124:127], v6, s[8:11], s22 offen offset:1792 sc1
  v_smfmac_f32_16x16x64_bf16 v[40:43], v[28:31], a[96:103], v3
  s_add_u32 s22, s25, 21504
  buffer_load_dwordx4 v[128:131], v6, s[8:11], s22 offen offset:0 sc1
  v_smfmac_f32_16x16x64_bf16 v[44:47], v[28:31], a[152:159], v3
  buffer_load_dwordx4 v[132:135], v6, s[8:11], s22 offen offset:1792 sc1
  v_smfmac_f32_16x16x64_bf16 v[48:51], v[28:31], a[208:215], v3
  s_add_u32 s22, s25, 25088
  buffer_load_dwordx4 v[136:139], v6, s[8:11], s22 offen offset:0 sc1
  v_smfmac_f32_16x16x64_bf16 v[52:55], v[28:31], v[184:191], v3
  buffer_load_dwordx4 v[140:143], v6, s[8:11], s22 offen offset:1792 sc1
  v_smfmac_f32_16x16x64_bf16 v[56:59], v[28:31], v[240:247], v3
  s_waitcnt lgkmcnt(4)
  v_smfmac_f32_16x16x64_bf16 v[36:39], v[8:11], a[0:7], v3
  s_waitcnt lgkmcnt(3)
  v_smfmac_f32_16x16x64_bf16 v[36:39], v[12:15], a[8:15], v3
  s_waitcnt lgkmcnt(2)
  v_smfmac_f32_16x16x64_bf16 v[36:39], v[16:19], a[16:23], v3
  s_waitcnt lgkmcnt(1)
  v_smfmac_f32_16x16x64_bf16 v[36:39], v[20:23], a[24:31], v3
  s_waitcnt lgkmcnt(0)
  v_smfmac_f32_16x16x64_bf16 v[36:39], v[32:35], a[48:55], v3
  v_smfmac_f32_16x16x64_bf16 v[40:43], v[8:11], a[56:63], v3
  v_smfmac_f32_16x16x64_bf16 v[40:43], v[12:15], a[64:71], v3
  v_smfmac_f32_16x16x64_bf16 v[40:43], v[16:19], a[72:79], v3
  v_permlane32_swap_b32 v36, v38
  v_smfmac_f32_16x16x64_bf16 v[40:43], v[20:23], a[80:87], v3
  v_permlane32_swap_b32 v37, v39
  v_smfmac_f32_16x16x64_bf16 v[40:43], v[32:35], a[104:111], v3
  v_add_f32 v36, v36, v38
  v_smfmac_f32_16x16x64_bf16 v[44:47], v[8:11], a[112:119], v3
  v_add_f32 v37, v37, v39
  v_smfmac_f32_16x16x64_bf16 v[44:47], v[12:15], a[120:127], v3
  v_cmp_u_f32 vcc, v36, v37
  v_smfmac_f32_16x16x64_bf16 v[44:47], v[16:19], a[128:135], v3
  v_cvt_pk_bf16_f32 v38, v36, v37
  v_smfmac_f32_16x16x64_bf16 v[44:47], v[20:23], a[136:143], v3
  ds_write_b32 v152, v38
  s_cbranch_vccnz cB_va0_slow
  v_permlane32_swap_b32 v40, v42
  v_smfmac_f32_16x16x64_bf16 v[44:47], v[32:35], a[160:167], v3
  v_permlane32_swap_b32 v41, v43
  v_smfmac_f32_16x16x64_bf16 v[48:51], v[8:11], a[168:175], v3
  buffer_store_dword v162, v1, s[8:11], s21 offen sc1
  v_add_f32 v40, v40, v42
  v_smfmac_f32_16x16x64_bf16 v[48:51], v[12:15], a[176:183], v3
  v_add_f32 v41, v41, v43
  v_smfmac_f32_16x16x64_bf16 v[48:51], v[16:19], a[184:191], v3
  buffer_load_dword v164, v4, s[8:11], 0 offen sc1
  v_cvt_pk_bf16_f32 v42, v40, v41
  v_smfmac_f32_16x16x64_bf16 v[48:51], v[20:23], a[192:199], v3
  ds_write_b32 v153, v42
  v_permlane32_swap_b32 v44, v46
  v_smfmac_f32_16x16x64_bf16 v[48:51], v[32:35], a[216:223], v3
  v_permlane32_swap_b32 v45, v47
  v_smfmac_f32_16x16x64_bf16 v[52:55], v[8:11], a[224:231], v3
  buffer_load_dword v164, v4, s[8:11], 0 offen sc1
  v_add_f32 v44, v44, v46
  v_smfmac_f32_16x16x64_bf16 v[52:55], v[12:15], a[232:239], v3
  v_add_f32 v45, v45, v47
  v_smfmac_f32_16x16x64_bf16 v[52:55], v[16:19], a[240:247], v3
  v_cvt_pk_bf16_f32 v46, v44, v45
  v_smfmac_f32_16x16x64_bf16 v[52:55], v[20:23], a[248:255], v3
  ds_write_b32 v154, v46
  buffer_load_dword v164, v4, s[8:11], 0 offen sc1
  v_permlane32_swap_b32 v48, v50
  v_smfmac_f32_16x16x64_bf16 v[52:55], v[32:35], v[192:199], v3
  v_permlane32_swap_b32 v49, v51
  v_smfmac_f32_16x16x64_bf16 v[56:59], v[8:11], v[200:207], v3
  v_add_f32 v48, v48, v50
  v_smfmac_f32_16x16x64_bf16 v[56:59], v[12:15], v[208:215], v3
  buffer_load_dword v164, v4, s[8:11], 0 offen sc1
  v_add_f32 v49, v49, v51
  v_smfmac_f32_16x16x64_bf16 v[56:59], v[16:19], v[216:223], v3
  v_cvt_pk_bf16_f32 v50, v48, v49
  v_smfmac_f32_16x16x64_bf16 v[56:59], v[20:23], v[224:231], v3
  ds_write_b32 v155, v50
  v_permlane32_swap_b32 v52, v54
  v_smfmac_f32_16x16x64_bf16 v[56:59], v[32:35], v[248:255], v3
  buffer_load_dword v164, v4, s[8:11], 0 offen sc1
  v_permlane32_swap_b32 v53, v55
  v_add_f32 v52, v52, v54
  v_add_f32 v53, v53, v55
  v_cvt_pk_bf16_f32 v54, v52, v53
  ds_write_b32 v156, v54
  s_nop 1
  v_permlane32_swap_b32 v56, v58
  v_permlane32_swap_b32 v57, v59
  v_add_f32 v56, v56, v58
  v_add_f32 v57, v57, v59
  v_cvt_pk_bf16_f32 v58, v56, v57
  ds_write_b32 v157, v58
cB_va0_t2d:
  s_add_u32 s22, s20, 9216
  s_add_u32 s34, s20, 13312
  s_add_u32 s36, s20, 7168
  s_mov_b32 s37, 0
  v_mov_b32 v48, 0
  v_mov_b32 v49, 0
  v_mov_b32 v50, 0
  v_mov_b32 v51, 0
  v_mov_b32 v163, s18
  s_cmp_eq_u32 s19, 63
  s_waitcnt lgkmcnt(0)
  s_cbranch_scc1 cB_va0_last
  s_setprio 3
cB_va0_fw_l:
  v_cmp_gt_u32 vcc, s18, v164
  buffer_load_dword v164, v4, s[8:11], 0 offen sc1
  s_cbranch_vccz cB_va0_fw_d
  v_cmp_gt_u32 vcc, s18, v164
  buffer_load_dword v164, v4, s[8:11], 0 offen sc1
  s_cbranch_vccz cB_va0_fw_d
  v_cmp_gt_u32 vcc, s18, v164
  buffer_load_dword v164, v4, s[8:11], 0 offen sc1
  s_cbranch_vccz cB_va0_fw_d
  v_cmp_gt_u32 vcc, s18, v164
  buffer_load_dword v164, v4, s[8:11], 0 offen sc1
  s_cbranch_vccz cB_va0_fw_d
  v_cmp_gt_u32 vcc, s18, v164
  buffer_load_dword v164, v4, s[8:11], 0 offen sc1
  s_cbranch_vccz cB_va0_fw_d
  v_cmp_gt_u32 vcc, s18, v164
  buffer_load_dword v164, v4, s[8:11], 0 offen sc1
  s_cbranch_vccz cB_va0_fw_d
  v_cmp_gt_u32 vcc, s18, v164
  buffer_load_dword v164, v4, s[8:11], 0 offen sc1
  s_cbranch_vccz cB_va0_fw_d
  v_cmp_gt_u32 vcc, s18, v164
  buffer_load_dword v164, v4, s[8:11], 0 offen sc1
  s_cbranch_vccz cB_va0_fw_d
  v_cmp_gt_u32 vcc, s18, v164
  buffer_load_dword v164, v4, s[8:11], 0 offen sc1
  s_cbranch_vccz cB_va0_fw_d
  v_cmp_gt_u32 vcc, s18, v164
  buffer_load_dword v164, v4, s[8:11], 0 offen sc1
  s_cbranch_vccz cB_va0_fw_d
  v_cmp_gt_u32 vcc, s18, v164
  buffer_load_dword v164, v4, s[8:11], 0 offen sc1
  s_cbranch_vccz cB_va0_fw_d
  v_cmp_gt_u32 vcc, s18, v164
  buffer_load_dword v164, v4, s[8:11], 0 offen sc1
  s_cbranch_vccz cB_va0_fw_d
  v_cmp_gt_u32 vcc, s18, v164
  buffer_load_dword v164, v4, s[8:11], 0 offen sc1
  s_cbranch_vccz cB_va0_fw_d
  v_cmp_gt_u32 vcc, s18, v164
  buffer_load_dword v164, v4, s[8:11], 0 offen sc1
  s_cbranch_vccz cB_va0_fw_d
  v_cmp_gt_u32 vcc, s18, v164
  buffer_load_dword v164, v4, s[8:11], 0 offen sc1
  s_cbranch_vccz cB_va0_fw_d
  v_cmp_gt_u32 vcc, s18, v164
  buffer_load_dword v164, v4, s[8:11], 0 offen sc1
  s_cbranch_vccz cB_va0_fw_d
  s_waitcnt vmcnt(24)
  s_add_u32 s30, s30, 1
  s_cmp_lt_u32 s30, 400000
  s_cbranch_scc1 cB_va0_fw_l
  s_branch cB_abort
cB_va0_fw_d:
  buffer_load_dwordx4 v[8:11], v2, s[8:11], s22 offen offset:0 sc1
  buffer_load_dwordx4 v[12:15], v2, s[8:11], s22 offen offset:1024 sc1
  buffer_load_dwordx4 v[16:19], v2, s[8:11], s22 offen offset:2048 sc1
  buffer_load_dwordx4 v[20:23], v2, s[8:11], s22 offen offset:3072 sc1
  buffer_load_dwordx4 v[24:27], v2, s[8:11], s34 offen offset:0 sc1
  buffer_load_dwordx4 v[28:31], v2, s[8:11], s34 offen offset:1024 sc1
  buffer_load_dwordx4 v[32:35], v2, s[8:11], s34 offen offset:2048 sc1
  buffer_load_dwordx4 v[36:39], v2, s[8:11], s34 offen offset:3072 sc1
  buffer_load_dwordx4 v[40:43], v2, s[8:11], s36 offen offset:0 sc1
  buffer_load_dwordx4 v[44:47], v2, s[8:11], s36 offen offset:1024 sc1
  s_barrier
  ds_read_b128 v[64:67], v2 offset:0
  ds_read_b128 v[68:71], v2 offset:1024
  ds_read_b128 v[72:75], v2 offset:2048
  ds_read_b128 v[76:79], v2 offset:3072
cB_va0_lp:
  s_waitcnt vmcnt(9)
  v_smfmac_f32_16x16x64_bf16 v[48:51], v[8:11], v[80:87], v3
  s_waitcnt vmcnt(8)
  v_smfmac_f32_16x16x64_bf16 v[48:51], v[12:15], v[88:95], v3
  s_waitcnt vmcnt(7)
  v_smfmac_f32_16x16x64_bf16 v[48:51], v[16:19], v[96:103], v3
  s_waitcnt vmcnt(6)
  v_smfmac_f32_16x16x64_bf16 v[48:51], v[20:23], v[104:111], v3
  s_waitcnt vmcnt(5)
  v_smfmac_f32_16x16x64_bf16 v[48:51], v[24:27], v[112:119], v3
  s_waitcnt vmcnt(4)
  v_smfmac_f32_16x16x64_bf16 v[48:51], v[28:31], v[120:127], v3
  s_waitcnt vmcnt(3)
  v_smfmac_f32_16x16x64_bf16 v[48:51], v[32:35], v[128:135], v3
  s_waitcnt vmcnt(2)
  v_smfmac_f32_16x16x64_bf16 v[48:51], v[36:39], v[136:143], v3
  s_waitcnt vmcnt(1) lgkmcnt(0)
  v_smfmac_f32_16x16x64_bf16 v[48:51], v[40:43], v[64:71], v3
  s_waitcnt vmcnt(0)
  v_smfmac_f32_16x16x64_bf16 v[48:51], v[44:47], v[72:79], v3
  s_nop 7
  v_permlane32_swap_b32 v48, v50
  v_permlane32_swap_b32 v49, v51
  v_pk_add_f32 v[48:49], v[48:49], v[50:51]
  v_cvt_pk_bf16_f32 v160, v48, v49
  v_cmp_u_f32 vcc, v48, v49
  s_nop 0
  v_mov_b32_dpp v161, v160 quad_perm:[1,0,3,2] row_mask:0xf bank_mask:0xf
  v_perm_b32 v160, v161, v160, v5
  v_cndmask_b32 v161, v160, v162, vcc
  buffer_store_dword v161, v1, s[8:11], s21 offen sc1
  s_cbranch_vccnz cB_va0_rp
cB_va0_cont:
  s_setprio 0
  s_cmp_lg_u32 s19, 62
  s_cbranch_scc1 cB_va0_nl
  s_sleep 4
  buffer_store_dword v160, v1, s[8:11], s38 offen sc1
  s_mov_b32 s38, 0x40000000
  s_mov_b32 s25, 0x40000000
cB_va0_nl:
  s_add_u32 s25, s25, 458752
  v_mov_b32 v36, 0
  v_mov_b32 v37, 0
  v_mov_b32 v38, 0
  v_mov_b32 v39, 0
  v_mov_b32 v40, 0
  v_mov_b32 v41, 0
  v_mov_b32 v42, 0
  v_mov_b32 v43, 0
  v_mov_b32 v44, 0
  v_mov_b32 v45, 0
  v_mov_b32 v46, 0
  v_mov_b32 v47, 0
  v_mov_b32 v48, 0
  v_mov_b32 v49, 0
  v_mov_b32 v50, 0
  v_mov_b32 v51, 0
  v_mov_b32 v52, 0
  v_mov_b32 v53, 0
  v_mov_b32 v54, 0
  v_mov_b32 v55, 0
  v_mov_b32 v56, 0
  v_mov_b32 v57, 0
  v_mov_b32 v58, 0
  v_mov_b32 v59, 0
  v_mov_b32 v60, 0
  v_mov_b32 v61, 0
  v_mov_b32 v62, 0
  v_mov_b32 v63, 0
  s_mov_b32 s19, s18
  s_add_u32 s18, s18, 1
  s_mov_b32 s22, s20
  s_mov_b32 s20, s21
  s_mov_b32 s21, s22
  s_add_u32 s23, s20, 4096
  s_branch cB_va0_loop
cB_va0_slow:
  s_waitcnt lgkmcnt(0)
cB_va0_sl1:
  s_add_u32 s31, s31, 0x1000000
  buffer_load_dwordx4 v[8:11], v2, s[8:11], s20 offen offset:0 sc1
  buffer_load_dwordx4 v[12:15], v2, s[8:11], s20 offen offset:1024 sc1
  buffer_load_dwordx4 v[16:19], v2, s[8:11], s20 offen offset:2048 sc1
  buffer_load_dwordx4 v[20:23], v2, s[8:11], s20 offen offset:3072 sc1
  buffer_load_dwordx4 v[24:27], v2, s[8:11], s23 offen offset:0 sc1
  buffer_load_dwordx4 v[28:31], v2, s[8:11], s23 offen offset:1024 sc1
  buffer_load_dwordx4 v[32:35], v2, s[8:11], s23 offen offset:2048 sc1
  s_waitcnt vmcnt(0)
  v_max3_u32 v36, v8, v9, v10
  v_max3_u32 v36, v36, v11, v12
  v_max3_u32 v36, v36, v13, v14
  v_max3_u32 v36, v36, v15, v16
  v_max3_u32 v36, v36, v17, v18
  v_max3_u32 v36, v36, v19, v20
  v_max3_u32 v36, v36, v21, v22
  v_max3_u32 v36, v36, v23, v24
  v_max3_u32 v36, v36, v25, v26
  v_max3_u32 v36, v36, v27, v28
  v_max3_u32 v36, v36, v29, v30
  v_max3_u32 v36, v36, v31, v32
  v_max3_u32 v36, v36, v33, v34
  v_max_u32 v36, v36, v35
  v_cmp_eq_u32 vcc, -1, v36
  s_cbranch_vccz cB_va0_sl2
  s_add_u32 s30, s30, 1
  s_cmp_lt_u32 s30, 400000
  s_cbranch_scc1 cB_va0_sl1
  s_branch cB_abort
cB_va0_sl2:
  v_mov_b32 v36, 0
  v_mov_b32 v37, 0
  v_mov_b32 v38, 0
  v_mov_b32 v39, 0
  v_mov_b32 v40, 0
  v_mov_b32 v41, 0
  v_mov_b32 v42, 0
  v_mov_b32 v43, 0
  v_mov_b32 v44, 0
  v_mov_b32 v45, 0
  v_mov_b32 v46, 0
  v_mov_b32 v47, 0
  v_mov_b32 v48, 0
  v_mov_b32 v49, 0
  v_mov_b32 v50, 0
  v_mov_b32 v51, 0
  v_mov_b32 v52, 0
  v_mov_b32 v53, 0
  v_mov_b32 v54, 0
  v_mov_b32 v55, 0
  v_mov_b32 v56, 0
  v_mov_b32 v57, 0
  v_mov_b32 v58, 0
  v_mov_b32 v59, 0
  v_mov_b32 v60, 0
  v_mov_b32 v61, 0
  v_mov_b32 v62, 0
  v_mov_b32 v63, 0
  buffer_store_dword v162, v1, s[8:11], s21 offen sc1
  v_smfmac_f32_16x16x64_bf16 v[36:39], v[8:11], a[0:7], v3
  v_smfmac_f32_16x16x64_bf16 v[40:43], v[8:11], a[56:63], v3
  v_smfmac_f32_16x16x64_bf16 v[44:47], v[8:11], a[112:119], v3
  v_smfmac_f32_16x16x64_bf16 v[48:51], v[8:11], a[168:175], v3
  v_smfmac_f32_16x16x64_bf16 v[52:55], v[8:11], a[224:231], v3
  v_smfmac_f32_16x16x64_bf16 v[56:59], v[8:11], v[200:207], v3
  v_smfmac_f32_16x16x64_bf16 v[36:39], v[12:15], a[8:15], v3
  v_smfmac_f32_16x16x64_bf16 v[40:43], v[12:15], a[64:71], v3
  v_smfmac_f32_16x16x64_bf16 v[44:47], v[12:15], a[120:127], v3
  v_smfmac_f32_16x16x64_bf16 v[48:51], v[12:15], a[176:183], v3
  v_smfmac_f32_16x16x64_bf16 v[52:55], v[12:15], a[232:239], v3
  v_smfmac_f32_16x16x64_bf16 v[56:59], v[12:15], v[208:215], v3
  v_smfmac_f32_16x16x64_bf16 v[36:39], v[16:19], a[16:23], v3
  v_smfmac_f32_16x16x64_bf16 v[40:43], v[16:19], a[72:79], v3
  v_smfmac_f32_16x16x64_bf16 v[44:47], v[16:19], a[128:135], v3
  v_smfmac_f32_16x16x64_bf16 v[48:51], v[16:19], a[184:191], v3
  v_smfmac_f32_16x16x64_bf16 v[52:55], v[16:19], a[240:247], v3
  v_smfmac_f32_16x16x64_bf16 v[56:59], v[16:19], v[216:223], v3
  v_smfmac_f32_16x16x64_bf16 v[36:39], v[20:23], a[24:31], v3
  v_smfmac_f32_16x16x64_bf16 v[40:43], v[20:23], a[80:87], v3
  v_smfmac_f32_16x16x64_bf16 v[44:47], v[20:23], a[136:143], v3
  v_smfmac_f32_16x16x64_bf16 v[48:51], v[20:23], a[192:199], v3
  v_smfmac_f32_16x16x64_bf16 v[52:55], v[20:23], a[248:255], v3
  v_smfmac_f32_16x16x64_bf16 v[56:59], v[20:23], v[224:231], v3
  v_smfmac_f32_16x16x64_bf16 v[36:39], v[24:27], a[32:39], v3
  v_smfmac_f32_16x16x64_bf16 v[40:43], v[24:27], a[88:95], v3
  v_smfmac_f32_16x16x64_bf16 v[44:47], v[24:27], a[144:151], v3
  v_smfmac_f32_16x16x64_bf16 v[48:51], v[24:27], a[200:207], v3
  v_smfmac_f32_16x16x64_bf16 v[52:55], v[24:27], v[176:183], v3
  v_smfmac_f32_16x16x64_bf16 v[56:59], v[24:27], v[232:239], v3
  v_smfmac_f32_16x16x64_bf16 v[36:39], v[28:31], a[40:47], v3
  v_smfmac_f32_16x16x64_bf16 v[40:43], v[28:31], a[96:103], v3
  v_smfmac_f32_16x16x64_bf16 v[44:47], v[28:31], a[152:159], v3
  v_smfmac_f32_16x16x64_bf16 v[48:51], v[28:31], a[208:215], v3
  v_smfmac_f32_16x16x64_bf16 v[52:55], v[28:31], v[184:191], v3
  v_smfmac_f32_16x16x64_bf16 v[56:59], v[28:31], v[240:247], v3
  v_smfmac_f32_16x16x64_bf16 v[36:39], v[32:35], a[48:55], v3
  v_smfmac_f32_16x16x64_bf16 v[40:43], v[32:35], a[104:111], v3
  v_smfmac_f32_16x16x64_bf16 v[44:47], v[32:35], a[160:167], v3
  v_smfmac_f32_16x16x64_bf16 v[48:51], v[32:35], a[216:223], v3
  v_smfmac_f32_16x16x64_bf16 v[52:55], v[32:35], v[192:199], v3
  v_smfmac_f32_16x16x64_bf16 v[56:59], v[32:35], v[248:255], v3
  v_permlane32_swap_b32 v36, v38
  v_permlane32_swap_b32 v37, v39
  v_add_f32 v36, v36, v38
  v_add_f32 v37, v37, v39
  v_cvt_pk_bf16_f32 v38, v36, v37
  ds_write_b32 v152, v38
  v_permlane32_swap_b32 v40, v42
  v_permlane32_swap_b32 v41, v43
  v_add_f32 v40, v40, v42
  v_add_f32 v41, v41, v43
  v_cvt_pk_bf16_f32 v42, v40, v41
  ds_write_b32 v153, v42
  v_permlane32_swap_b32 v44, v46
  v_permlane32_swap_b32 v45, v47
  v_add_f32 v44, v44, v46
  v_add_f32 v45, v45, v47
  v_cvt_pk_bf16_f32 v46, v44, v45
  ds_write_b32 v154, v46
  v_permlane32_swap_b32 v48, v50
  v_permlane32_swap_b32 v49, v51
  v_add_f32 v48, v48, v50
  v_add_f32 v49, v49, v51
  v_cvt_pk_bf16_f32 v50, v48, v49
  ds_write_b32 v155, v50
  v_permlane32_swap_b32 v52, v54
  v_permlane32_swap_b32 v53, v55
  v_add_f32 v52, v52, v54
  v_add_f32 v53, v53, v55
  v_cvt_pk_bf16_f32 v54, v52, v53
  ds_write_b32 v156, v54
  v_permlane32_swap_b32 v56, v58
  v_permlane32_swap_b32 v57, v59
  v_add_f32 v56, v56, v58
  v_add_f32 v57, v57, v59
  v_cvt_pk_bf16_f32 v58, v56, v57
  ds_write_b32 v157, v58
  buffer_load_dword v164, v4, s[8:11], 0 offen sc1
  buffer_load_dword v164, v4, s[8:11], 0 offen sc1
  buffer_load_dword v164, v4, s[8:11], 0 offen sc1
  buffer_load_dword v164, v4, s[8:11], 0 offen sc1
  buffer_load_dword v164, v4, s[8:11], 0 offen sc1
  s_branch cB_va0_t2d
cB_va0_last:
  s_barrier
  ds_read_b128 v[64:67], v2 offset:0
  ds_read_b128 v[68:71], v2 offset:1024
  ds_read_b128 v[72:75], v2 offset:2048
  ds_read_b128 v[76:79], v2 offset:3072
  s_waitcnt lgkmcnt(0)
  v_min_u32 v64, -2, v64
  v_min_u32 v65, -2, v65
  v_min_u32 v66, -2, v66
  v_min_u32 v67, -2, v67
  v_min_u32 v68, -2, v68
  v_min_u32 v69, -2, v69
  v_min_u32 v70, -2, v70
  v_min_u32 v71, -2, v71
  v_min_u32 v72, -2, v72
  v_min_u32 v73, -2, v73
  v_min_u32 v74, -2, v74
  v_min_u32 v75, -2, v75
  v_min_u32 v76, -2, v76
  v_min_u32 v77, -2, v77
  v_min_u32 v78, -2, v78
  v_min_u32 v79, -2, v79
  buffer_store_dwordx4 v[64:67], v2, s[8:11], s33 offen offset:0 sc1
  buffer_store_dwordx4 v[68:71], v2, s[8:11], s33 offen offset:2048 sc1
  s_add_u32 s33, s33, 4096
  buffer_store_dwordx4 v[72:75], v2, s[8:11], s33 offen offset:0 sc1
  buffer_store_dwordx4 v[76:79], v2, s[8:11], s33 offen offset:2048 sc1
  s_add_u32 s33, s33, 4096
  s_waitcnt vmcnt(0)
  buffer_wbl2 sc1
  s_branch cB_done
cB_va0_rp:
  s_cmp_eq_u32 s37, 0
  s_cbranch_scc1 cB_va0_rv
  v_min_u32 v160, -2, v160
  buffer_store_dword v160, v1, s[8:11], s21 offen sc1
  s_branch cB_va0_cont
cB_va0_rv:
  s_add_u32 s31, s31, 0x10000
  buffer_load_dwordx4 v[8:11], v2, s[8:11], s22 offen offset:0 sc1
  buffer_load_dwordx4 v[12:15], v2, s[8:11], s22 offen offset:1024 sc1
  buffer_load_dwordx4 v[16:19], v2, s[8:11], s22 offen offset:2048 sc1
  buffer_load_dwordx4 v[20:23], v2, s[8:11], s22 offen offset:3072 sc1
  buffer_load_dwordx4 v[24:27], v2, s[8:11], s34 offen offset:0 sc1
  buffer_load_dwordx4 v[28:31], v2, s[8:11], s34 offen offset:1024 sc1
  buffer_load_dwordx4 v[32:35], v2, s[8:11], s34 offen offset:2048 sc1
  buffer_load_dwordx4 v[36:39], v2, s[8:11], s34 offen offset:3072 sc1
  buffer_load_dwordx4 v[40:43], v2, s[8:11], s36 offen offset:0 sc1
  buffer_load_dwordx4 v[44:47], v2, s[8:11], s36 offen offset:1024 sc1
  s_waitcnt vmcnt(0)
  v_max3_u32 v52, v8, v9, v10
  v_max3_u32 v52, v52, v11, v12
  v_max3_u32 v52, v52, v13, v14
  v_max3_u32 v52, v52, v15, v16
  v_max3_u32 v52, v52, v17, v18
  v_max3_u32 v52, v52, v19, v20
  v_max3_u32 v52, v52, v21, v22
  v_max3_u32 v52, v52, v23, v24
  v_max3_u32 v52, v52, v25, v26
  v_max3_u32 v52, v52, v27, v28
  v_max3_u32 v52, v52, v29, v30
  v_max3_u32 v52, v52, v31, v32
  v_max3_u32 v52, v52, v33, v34
  v_max3_u32 v52, v52, v35, v36
  v_max3_u32 v52, v52, v37, v38
  v_max3_u32 v52, v52, v39, v40
  v_max3_u32 v52, v52, v41, v42
  v_max3_u32 v52, v52, v43, v44
  v_max3_u32 v52, v52, v45, v46
  v_max_u32 v52, v52, v47
  v_cmp_eq_u32 vcc, -1, v52
  s_mov_b32 s37, 1
  v_mov_b32 v48, 0
  v_mov_b32 v49, 0
  v_mov_b32 v50, 0
  v_mov_b32 v51, 0
  s_nop 1
  s_cbranch_vccz cB_va0_lp
  s_add_u32 s30, s30, 1
  s_cmp_lt_u32 s30, 400000
  s_cbranch_scc1 cB_va0_rv
  s_branch cB_abort
.p2align 6
cB_va1_loop:
  s_mov_b32 s30, 0
  s_barrier
  buffer_load_dwordx4 v[28:31], v2, s[8:11], s23 offen offset:1024 sc1
  buffer_load_dwordx4 v[32:35], v2, s[8:11], s23 offen offset:2048 sc1
  s_barrier
  s_cmp_lt_u32 s19, 59
  s_cbranch_scc1 cB_va1_m1
  buffer_store_dword v160, v1, s[8:11], s38 offen sc1
  s_cmp_lg_u32 s19, 63
  s_cbranch_scc1 cB_va1_m2
  v_min_u32 v64, -2, v64
  v_min_u32 v65, -2, v65
  v_min_u32 v66, -2, v66
  v_min_u32 v67, -2, v67
  v_min_u32 v68, -2, v68
  v_min_u32 v69, -2, v69
  v_min_u32 v70, -2, v70
  v_min_u32 v71, -2, v71
  v_min_u32 v72, -2, v72
  v_min_u32 v73, -2, v73
  v_min_u32 v74, -2, v74
  v_min_u32 v75, -2, v75
  v_min_u32 v76, -2, v76
  v_min_u32 v77, -2, v77
  v_min_u32 v78, -2, v78
  v_min_u32 v79, -2, v79
  buffer_store_dwordx4 v[64:67], v2, s[8:11], s33 offen offset:0 sc1
  buffer_store_dwordx4 v[68:71], v2, s[8:11], s33 offen offset:2048 sc1
  s_add_u32 s33, s33, 4096
  buffer_store_dwordx4 v[72:75], v2, s[8:11], s33 offen offset:0 sc1
  buffer_store_dwordx4 v[76:79], v2, s[8:11], s33 offen offset:2048 sc1
  s_add_u32 s33, s33, 4096
  s_waitcnt vmcnt(5)
  s_branch cB_va1_m3
cB_va1_m1:
  buffer_store_dword v160, v1, s[8:11], s38 offen sc1
cB_va1_m2:
  s_add_u32 s22, s25, 0
  buffer_load_dwordx4 v[80:83], v6, s[8:11], s22 offen offset:0 sc1
  buffer_load_dwordx4 v[84:87], v6, s[8:11], s22 offen offset:1792 sc1
  s_add_u32 s22, s25, 3584
  buffer_load_dwordx4 v[88:91], v6, s[8:11], s22 offen offset:0 sc1
  buffer_load_dwordx4 v[92:95], v6, s[8:11], s22 offen offset:1792 sc1
  s_add_u32 s22, s25, 7168
  buffer_load_dwordx4 v[96:99], v6, s[8:11], s22 offen offset:0 sc1
  s_mul_i32 s38, s18, 7168
  s_add_u32 s38, s38, 88002560
  s_waitcnt vmcnt(6)
cB_va1_m3:
  ds_write_b128 v2, v[32:35] offset:14336
  v_smfmac_f32_16x16x64_bf16 v[36:39], v[28:31], a[40:47], v3
  buffer_load_dwordx4 v[100:103], v6, s[8:11], s22 offen offset:1792 sc1
  v_smfmac_f32_16x16x64_bf16 v[40:43], v[28:31], a[96:103], v3
  s_add_u32 s22, s25, 10752
  buffer_load_dwordx4 v[104:107], v6, s[8:11], s22 offen offset:0 sc1
  v_smfmac_f32_16x16x64_bf16 v[44:47], v[28:31], a[152:159], v3
  buffer_load_dwordx4 v[108:111], v6, s[8:11], s22 offen offset:1792 sc1
  v_smfmac_f32_16x16x64_bf16 v[48:51], v[28:31], a[208:215], v3
  s_add_u32 s22, s25, 14336
  buffer_load_dwordx4 v[112:115], v6, s[8:11], s22 offen offset:0 sc1
  v_smfmac_f32_16x16x64_bf16 v[52:55], v[28:31], v[184:191], v3
  s_waitcnt lgkmcnt(0)
  s_barrier
  ds_read_b128 v[8:11], v2 offset:8192
  ds_read_b128 v[12:15], v2 offset:9216
  ds_read_b128 v[16:19], v2 offset:10240
  ds_read_b128 v[20:23], v2 offset:11264
  ds_read_b128 v[24:27], v2 offset:12288
  buffer_load_dwordx4 v[116:119], v6, s[8:11], s22 offen offset:1792 sc1
  v_smfmac_f32_16x16x64_bf16 v[56:59], v[28:31], v[240:247], v3
  s_add_u32 s22, s25, 17920
  buffer_load_dwordx4 v[120:123], v6, s[8:11], s22 offen offset:0 sc1
  v_smfmac_f32_16x16x64_bf16 v[36:39], v[32:35], a[48:55], v3
  buffer_load_dwordx4 v[124:127], v6, s[8:11], s22 offen offset:1792 sc1
  v_smfmac_f32_16x16x64_bf16 v[40:43], v[32:35], a[104:111], v3
  s_add_u32 s22, s25, 21504
  buffer_load_dwordx4 v[128:131], v6, s[8:11], s22 offen offset:0 sc1
  v_smfmac_f32_16x16x64_bf16 v[44:47], v[32:35], a[160:167], v3
  buffer_load_dwordx4 v[132:135], v6, s[8:11], s22 offen offset:1792 sc1
  v_smfmac_f32_16x16x64_bf16 v[48:51], v[32:35], a[216:223], v3
  s_add_u32 s22, s25, 25088
  buffer_load_dwordx4 v[136:139], v6, s[8:11], s22 offen offset:0 sc1
  v_smfmac_f32_16x16x64_bf16 v[52:55], v[32:35], v[192:199], v3
  ds_read_b128 v[64:67], v0 offset:0
  ds_read_b128 v[68:71], v0 offset:1024
  buffer_load_dwordx4 v[140:143], v6, s[8:11], s22 offen offset:1792 sc1
  v_smfmac_f32_16x16x64_bf16 v[56:59], v[32:35], v[248:255], v3
  s_waitcnt lgkmcnt(6)
  ds_read_b128 v[72:75], v0 offset:2048
  ds_read_b128 v[76:79], v0 offset:3072
  v_smfmac_f32_16x16x64_bf16 v[36:39], v[8:11], a[0:7], v3
  s_waitcnt lgkmcnt(7)
  v_smfmac_f32_16x16x64_bf16 v[36:39], v[12:15], a[8:15], v3
  s_waitcnt lgkmcnt(6)
  v_smfmac_f32_16x16x64_bf16 v[36:39], v[16:19], a[16:23], v3
  s_waitcnt lgkmcnt(2)
  v_smfmac_f32_16x16x64_bf16 v[60:63], v[8:11], v[64:71], v3
  s_waitcnt lgkmcnt(5)
  ds_read_b128 v[144:147], v0 offset:4096
  ds_read_b128 v[148:151], v0 offset:5120
  v_smfmac_f32_16x16x64_bf16 v[36:39], v[20:23], a[24:31], v3
  s_waitcnt lgkmcnt(6)
  v_smfmac_f32_16x16x64_bf16 v[36:39], v[24:27], a[32:39], v3
  v_smfmac_f32_16x16x64_bf16 v[40:43], v[8:11], a[56:63], v3
  s_waitcnt lgkmcnt(2)
  v_smfmac_f32_16x16x64_bf16 v[60:63], v[12:15], v[72:79], v3
  ds_read_b128 v[64:67], v0 offset:6144
  ds_read_b128 v[68:71], v0 offset:7168
  v_smfmac_f32_16x16x64_bf16 v[40:43], v[12:15], a[64:71], v3
  v_permlane32_swap_b32 v36, v38
  v_smfmac_f32_16x16x64_bf16 v[40:43], v[16:19], a[72:79], v3
  v_permlane32_swap_b32 v37, v39
  v_smfmac_f32_16x16x64_bf16 v[40:43], v[20:23], a[80:87], v3
  s_waitcnt lgkmcnt(2)
  v_add_f32 v36, v36, v38
  v_smfmac_f32_16x16x64_bf16 v[60:63], v[16:19], v[144:151], v3
  ds_read_b128 v[72:75], v0 offset:8192
  ds_read_b128 v[76:79], v0 offset:9216
  v_add_f32 v37, v37, v39
  v_smfmac_f32_16x16x64_bf16 v[40:43], v[24:27], a[88:95], v3
  v_cmp_u_f32 vcc, v36, v37
  v_smfmac_f32_16x16x64_bf16 v[44:47], v[8:11], a[112:119], v3
  v_cvt_pk_bf16_f32 v38, v36, v37
  v_smfmac_f32_16x16x64_bf16 v[44:47], v[12:15], a[120:127], v3
  ds_write_b32 v152, v38
  s_waitcnt lgkmcnt(3)
  s_cbranch_vccnz cB_va1_slow
  v_permlane32_swap_b32 v40, v42
  v_smfmac_f32_16x16x64_bf16 v[60:63], v[20:23], v[64:71], v3
  ds_read_b128 v[144:147], v0 offset:10240
  ds_read_b128 v[148:151], v0 offset:11264
  v_permlane32_swap_b32 v41, v43
  v_smfmac_f32_16x16x64_bf16 v[44:47], v[16:19], a[128:135], v3
  buffer_store_dword v162, v1, s[8:11], s21 offen sc1
  v_add_f32 v40, v40, v42
  v_smfmac_f32_16x16x64_bf16 v[44:47], v[20:23], a[136:143], v3
  v_add_f32 v41, v41, v43
  v_smfmac_f32_16x16x64_bf16 v[44:47], v[24:27], a[144:151], v3
  s_waitcnt lgkmcnt(3)
  v_cvt_pk_bf16_f32 v42, v40, v41
  v_smfmac_f32_16x16x64_bf16 v[60:63], v[24:27], v[72:79], v3
  ds_write_b32 v153, v42
  ds_read_b128 v[64:67], v0 offset:12288
  ds_read_b128 v[68:71], v0 offset:13312
  v_smfmac_f32_16x16x64_bf16 v[48:51], v[8:11], a[168:175], v3
  s_nop 0
  v_permlane32_swap_b32 v44, v46
  v_smfmac_f32_16x16x64_bf16 v[48:51], v[12:15], a[176:183], v3
  v_permlane32_swap_b32 v45, v47
  v_smfmac_f32_16x16x64_bf16 v[48:51], v[16:19], a[184:191], v3
  s_waitcnt lgkmcnt(3)
  v_add_f32 v44, v44, v46
  v_smfmac_f32_16x16x64_bf16 v[60:63], v[28:31], v[144:151], v3
  v_add_f32 v45, v45, v47
  v_smfmac_f32_16x16x64_bf16 v[48:51], v[20:23], a[192:199], v3
  v_cvt_pk_bf16_f32 v46, v44, v45
  v_smfmac_f32_16x16x64_bf16 v[48:51], v[24:27], a[200:207], v3
  ds_write_b32 v154, v46
  v_smfmac_f32_16x16x64_bf16 v[52:55], v[8:11], a[224:231], v3
  s_waitcnt lgkmcnt(1)
  v_smfmac_f32_16x16x64_bf16 v[60:63], v[32:35], v[64:71], v3
  v_smfmac_f32_16x16x64_bf16 v[52:55], v[12:15], a[232:239], v3
  v_permlane32_swap_b32 v48, v50
  v_smfmac_f32_16x16x64_bf16 v[52:55], v[16:19], a[240:247], v3
  v_permlane32_swap_b32 v49, v51
  v_smfmac_f32_16x16x64_bf16 v[52:55], v[20:23], a[248:255], v3
  v_add_f32 v48, v48, v50
  v_smfmac_f32_16x16x64_bf16 v[52:55], v[24:27], v[176:183], v3
  v_add_f32 v49, v49, v51
  v_smfmac_f32_16x16x64_bf16 v[56:59], v[8:11], v[200:207], v3
  v_cvt_pk_bf16_f32 v50, v48, v49
  v_smfmac_f32_16x16x64_bf16 v[56:59], v[12:15], v[208:215], v3
  ds_write_b32 v155, v50
  v_permlane32_swap_b32 v60, v62
  v_smfmac_f32_16x16x64_bf16 v[56:59], v[16:19], v[216:223], v3
  v_permlane32_swap_b32 v61, v63
  v_smfmac_f32_16x16x64_bf16 v[56:59], v[20:23], v[224:231], v3
  v_add_f32 v60, v60, v62
  v_smfmac_f32_16x16x64_bf16 v[56:59], v[24:27], v[232:239], v3
  v_add_f32 v61, v61, v63
  v_cvt_pk_bf16_f32 v62, v60, v61
  ds_write_b32 v158, v62
  v_permlane32_swap_b32 v52, v54
  v_permlane32_swap_b32 v53, v55
  v_add_f32 v52, v52, v54
  v_add_f32 v53, v53, v55
  v_cvt_pk_bf16_f32 v54, v52, v53
  ds_write_b32 v156, v54
  v_permlane32_swap_b32 v56, v58
  v_permlane32_swap_b32 v57, v59
  v_add_f32 v56, v56, v58
  v_add_f32 v57, v57, v59
  v_cvt_pk_bf16_f32 v58, v56, v57
  ds_write_b32 v157, v58
cB_va1_t2d:
  s_add_u32 s22, s20, 9216
  s_add_u32 s34, s20, 13312
  s_add_u32 s36, s20, 7168
  s_mov_b32 s37, 0
  v_mov_b32 v48, 0
  v_mov_b32 v49, 0
  v_mov_b32 v50, 0
  v_mov_b32 v51, 0
  v_mov_b32 v163, s18
  s_cmp_eq_u32 s19, 63
  s_waitcnt lgkmcnt(0)
  s_cbranch_scc1 cB_va1_last
  s_barrier
  buffer_load_dwordx4 v[8:11], v2, s[8:11], s22 offen offset:0 sc1
  buffer_load_dwordx4 v[12:15], v2, s[8:11], s22 offen offset:1024 sc1
  buffer_load_dwordx4 v[16:19], v2, s[8:11], s22 offen offset:2048 sc1
  buffer_load_dwordx4 v[20:23], v2, s[8:11], s22 offen offset:3072 sc1
  buffer_load_dwordx4 v[24:27], v2, s[8:11], s34 offen offset:0 sc1
  buffer_load_dwordx4 v[28:31], v2, s[8:11], s34 offen offset:1024 sc1
  buffer_load_dwordx4 v[32:35], v2, s[8:11], s34 offen offset:2048 sc1
  buffer_load_dwordx4 v[36:39], v2, s[8:11], s34 offen offset:3072 sc1
  buffer_load_dwordx4 v[40:43], v2, s[8:11], s36 offen offset:0 sc1
  buffer_load_dwordx4 v[44:47], v2, s[8:11], s36 offen offset:1024 sc1
  ds_read_b128 v[64:67], v2 offset:4096
  ds_read_b128 v[68:71], v2 offset:5120
  ds_read_b128 v[72:75], v2 offset:6144
  ds_read_b128 v[76:79], v2 offset:7168
cB_va1_lp:
  s_waitcnt vmcnt(9)
  v_smfmac_f32_16x16x64_bf16 v[48:51], v[8:11], v[80:87], v3
  s_waitcnt vmcnt(8)
  v_smfmac_f32_16x16x64_bf16 v[48:51], v[12:15], v[88:95], v3
  s_waitcnt vmcnt(7)
  v_smfmac_f32_16x16x64_bf16 v[48:51], v[16:19], v[96:103], v3
  v_max3_u32 v55, v8, v12, v16
  s_waitcnt vmcnt(6)
  v_smfmac_f32_16x16x64_bf16 v[48:51], v[20:23], v[104:111], v3
  v_max_u32 v55, v55, v20
  v_cmp_eq_u32 vcc, -1, v55
  s_waitcnt vmcnt(5)
  v_smfmac_f32_16x16x64_bf16 v[48:51], v[24:27], v[112:119], v3
  s_waitcnt vmcnt(4)
  v_smfmac_f32_16x16x64_bf16 v[48:51], v[28:31], v[120:127], v3
  s_cbranch_vccnz cB_va1_rv
  buffer_store_dword v163, v7, s[8:11], 0 offen sc1
  s_waitcnt vmcnt(4)
  v_smfmac_f32_16x16x64_bf16 v[48:51], v[32:35], v[128:135], v3
  s_waitcnt vmcnt(3)
  v_smfmac_f32_16x16x64_bf16 v[48:51], v[36:39], v[136:143], v3
  s_waitcnt vmcnt(2) lgkmcnt(0)
  v_smfmac_f32_16x16x64_bf16 v[48:51], v[40:43], v[64:71], v3
  s_waitcnt vmcnt(1)
  v_smfmac_f32_16x16x64_bf16 v[48:51], v[44:47], v[72:79], v3
  s_nop 7
  v_permlane32_swap_b32 v48, v50
  v_permlane32_swap_b32 v49, v51
  v_pk_add_f32 v[48:49], v[48:49], v[50:51]
  v_cvt_pk_bf16_f32 v160, v48, v49
  v_cmp_u_f32 vcc, v48, v49
  s_nop 0
  v_mov_b32_dpp v161, v160 quad_perm:[1,0,3,2] row_mask:0xf bank_mask:0xf
  v_perm_b32 v160, v161, v160, v5
  v_cndmask_b32 v161, v160, v162, vcc
  buffer_store_dword v161, v1, s[8:11], s21 offen sc1
  s_cbranch_vccnz cB_va1_rp
cB_va1_cont:
  s_cmp_lg_u32 s19, 62
  s_cbranch_scc1 cB_va1_nl
  buffer_store_dword v160, v1, s[8:11], s38 offen sc1
  s_mov_b32 s38, 0x40000000
  s_mov_b32 s25, 0x40000000
cB_va1_nl:
  s_add_u32 s25, s25, 458752
  v_mov_b32 v36, 0
  v_mov_b32 v37, 0
  v_mov_b32 v38, 0
  v_mov_b32 v39, 0
  v_mov_b32 v40, 0
  v_mov_b32 v41, 0
  v_mov_b32 v42, 0
  v_mov_b32 v43, 0
  v_mov_b32 v44, 0
  v_mov_b32 v45, 0
  v_mov_b32 v46, 0
  v_mov_b32 v47, 0
  v_mov_b32 v48, 0
  v_mov_b32 v49, 0
  v_mov_b32 v50, 0
  v_mov_b32 v51, 0
  v_mov_b32 v52, 0
  v_mov_b32 v53, 0
  v_mov_b32 v54, 0
  v_mov_b32 v55, 0
  v_mov_b32 v56, 0
  v_mov_b32 v57, 0
  v_mov_b32 v58, 0
  v_mov_b32 v59, 0
  v_mov_b32 v60, 0
  v_mov_b32 v61, 0
  v_mov_b32 v62, 0
  v_mov_b32 v63, 0
  s_mov_b32 s19, s18
  s_add_u32 s18, s18, 1
  s_mov_b32 s22, s20
  s_mov_b32 s20, s21
  s_mov_b32 s21, s22
  s_add_u32 s23, s20, 4096
  s_branch cB_va1_loop
cB_va1_slow:
  s_waitcnt lgkmcnt(0)
cB_va1_sl1:
  s_add_u32 s31, s31, 0x1000000
  buffer_load_dwordx4 v[8:11], v2, s[8:11], s20 offen offset:0 sc1
  buffer_load_dwordx4 v[12:15], v2, s[8:11], s20 offen offset:1024 sc1
  buffer_load_dwordx4 v[16:19], v2, s[8:11], s20 offen offset:2048 sc1
  buffer_load_dwordx4 v[20:23], v2, s[8:11], s20 offen offset:3072 sc1
  buffer_load_dwordx4 v[24:27], v2, s[8:11], s23 offen offset:0 sc1
  buffer_load_dwordx4 v[28:31], v2, s[8:11], s23 offen offset:1024 sc1
  buffer_load_dwordx4 v[32:35], v2, s[8:11], s23 offen offset:2048 sc1
  s_waitcnt vmcnt(0)
  v_max3_u32 v36, v8, v9, v10
  v_max3_u32 v36, v36, v11, v12
  v_max3_u32 v36, v36, v13, v14
  v_max3_u32 v36, v36, v15, v16
  v_max3_u32 v36, v36, v17, v18
  v_max3_u32 v36, v36, v19, v20
  v_max3_u32 v36, v36, v21, v22
  v_max3_u32 v36, v36, v23, v24
  v_max3_u32 v36, v36, v25, v26
  v_max3_u32 v36, v36, v27, v28
  v_max3_u32 v36, v36, v29, v30
  v_max3_u32 v36, v36, v31, v32
  v_max3_u32 v36, v36, v33, v34
  v_max_u32 v36, v36, v35
  v_cmp_eq_u32 vcc, -1, v36
  s_cbranch_vccz cB_va1_sl2
  s_add_u32 s30, s30, 1
  s_cmp_lt_u32 s30, 400000
  s_cbranch_scc1 cB_va1_sl1
  s_branch cB_abort
cB_va1_sl2:
  v_mov_b32 v36, 0
  v_mov_b32 v37, 0
  v_mov_b32 v38, 0
  v_mov_b32 v39, 0
  v_mov_b32 v40, 0
  v_mov_b32 v41, 0
  v_mov_b32 v42, 0
  v_mov_b32 v43, 0
  v_mov_b32 v44, 0
  v_mov_b32 v45, 0
  v_mov_b32 v46, 0
  v_mov_b32 v47, 0
  v_mov_b32 v48, 0
  v_mov_b32 v49, 0
  v_mov_b32 v50, 0
  v_mov_b32 v51, 0
  v_mov_b32 v52, 0
  v_mov_b32 v53, 0
  v_mov_b32 v54, 0
  v_mov_b32 v55, 0
  v_mov_b32 v56, 0
  v_mov_b32 v57, 0
  v_mov_b32 v58, 0
  v_mov_b32 v59, 0
  v_mov_b32 v60, 0
  v_mov_b32 v61, 0
  v_mov_b32 v62, 0
  v_mov_b32 v63, 0
  buffer_store_dword v162, v1, s[8:11], s21 offen sc1
  ds_read_b128 v[64:67], v0 offset:0
  ds_read_b128 v[68:71], v0 offset:1024
  v_smfmac_f32_16x16x64_bf16 v[36:39], v[8:11], a[0:7], v3
  v_smfmac_f32_16x16x64_bf16 v[40:43], v[8:11], a[56:63], v3
  v_smfmac_f32_16x16x64_bf16 v[44:47], v[8:11], a[112:119], v3
  v_smfmac_f32_16x16x64_bf16 v[48:51], v[8:11], a[168:175], v3
  v_smfmac_f32_16x16x64_bf16 v[52:55], v[8:11], a[224:231], v3
  v_smfmac_f32_16x16x64_bf16 v[56:59], v[8:11], v[200:207], v3
  s_waitcnt lgkmcnt(0)
  v_smfmac_f32_16x16x64_bf16 v[60:63], v[8:11], v[64:71], v3
  ds_read_b128 v[72:75], v0 offset:2048
  ds_read_b128 v[76:79], v0 offset:3072
  v_smfmac_f32_16x16x64_bf16 v[36:39], v[12:15], a[8:15], v3
  v_smfmac_f32_16x16x64_bf16 v[40:43], v[12:15], a[64:71], v3
  v_smfmac_f32_16x16x64_bf16 v[44:47], v[12:15], a[120:127], v3
  v_smfmac_f32_16x16x64_bf16 v[48:51], v[12:15], a[176:183], v3
  v_smfmac_f32_16x16x64_bf16 v[52:55], v[12:15], a[232:239], v3
  v_smfmac_f32_16x16x64_bf16 v[56:59], v[12:15], v[208:215], v3
  s_waitcnt lgkmcnt(0)
  v_smfmac_f32_16x16x64_bf16 v[60:63], v[12:15], v[72:79], v3
  ds_read_b128 v[144:147], v0 offset:4096
  ds_read_b128 v[148:151], v0 offset:5120
  v_smfmac_f32_16x16x64_bf16 v[36:39], v[16:19], a[16:23], v3
  v_smfmac_f32_16x16x64_bf16 v[40:43], v[16:19], a[72:79], v3
  v_smfmac_f32_16x16x64_bf16 v[44:47], v[16:19], a[128:135], v3
  v_smfmac_f32_16x16x64_bf16 v[48:51], v[16:19], a[184:191], v3
  v_smfmac_f32_16x16x64_bf16 v[52:55], v[16:19], a[240:247], v3
  v_smfmac_f32_16x16x64_bf16 v[56:59], v[16:19], v[216:223], v3
  s_waitcnt lgkmcnt(0)
  v_smfmac_f32_16x16x64_bf16 v[60:63], v[16:19], v[144:151], v3
  ds_read_b128 v[64:67], v0 offset:6144
  ds_read_b128 v[68:71], v0 offset:7168
  v_smfmac_f32_16x16x64_bf16 v[36:39], v[20:23], a[24:31], v3
  v_smfmac_f32_16x16x64_bf16 v[40:43], v[20:23], a[80:87], v3
  v_smfmac_f32_16x16x64_bf16 v[44:47], v[20:23], a[136:143], v3
  v_smfmac_f32_16x16x64_bf16 v[48:51], v[20:23], a[192:199], v3
  v_smfmac_f32_16x16x64_bf16 v[52:55], v[20:23], a[248:255], v3
  v_smfmac_f32_16x16x64_bf16 v[56:59], v[20:23], v[224:231], v3
  s_waitcnt lgkmcnt(0)
  v_smfmac_f32_16x16x64_bf16 v[60:63], v[20:23], v[64:71], v3
  ds_read_b128 v[72:75], v0 offset:8192
  ds_read_b128 v[76:79], v0 offset:9216
  v_smfmac_f32_16x16x64_bf16 v[36:39], v[24:27], a[32:39], v3
  v_smfmac_f32_16x16x64_bf16 v[40:43], v[24:27], a[88:95], v3
  v_smfmac_f32_16x16x64_bf16 v[44:47], v[24:27], a[144:151], v3
  v_smfmac_f32_16x16x64_bf16 v[48:51], v[24:27], a[200:207], v3
  v_smfmac_f32_16x16x64_bf16 v[52:55], v[24:27], v[176:183], v3
  v_smfmac_f32_16x16x64_bf16 v[56:59], v[24:27], v[232:239], v3
  s_waitcnt lgkmcnt(0)
  v_smfmac_f32_16x16x64_bf16 v[60:63], v[24:27], v[72:79], v3
  ds_read_b128 v[144:147], v0 offset:10240
  ds_read_b128 v[148:151], v0 offset:11264
  v_smfmac_f32_16x16x64_bf16 v[36:39], v[28:31], a[40:47], v3
  v_smfmac_f32_16x16x64_bf16 v[40:43], v[28:31], a[96:103], v3
  v_smfmac_f32_16x16x64_bf16 v[44:47], v[28:31], a[152:159], v3
  v_smfmac_f32_16x16x64_bf16 v[48:51], v[28:31], a[208:215], v3
  v_smfmac_f32_16x16x64_bf16 v[52:55], v[28:31], v[184:191], v3
  v_smfmac_f32_16x16x64_bf16 v[56:59], v[28:31], v[240:247], v3
  s_waitcnt lgkmcnt(0)
  v_smfmac_f32_16x16x64_bf16 v[60:63], v[28:31], v[144:151], v3
  ds_read_b128 v[64:67], v0 offset:12288
  ds_read_b128 v[68:71], v0 offset:13312
  v_smfmac_f32_16x16x64_bf16 v[36:39], v[32:35], a[48:55], v3
  v_smfmac_f32_16x16x64_bf16 v[40:43], v[32:35], a[104:111], v3
  v_smfmac_f32_16x16x64_bf16 v[44:47], v[32:35], a[160:167], v3
  v_smfmac_f32_16x16x64_bf16 v[48:51], v[32:35], a[216:223], v3
  v_smfmac_f32_16x16x64_bf16 v[52:55], v[32:35], v[192:199], v3
  v_smfmac_f32_16x16x64_bf16 v[56:59], v[32:35], v[248:255], v3
  s_waitcnt lgkmcnt(0)
  v_smfmac_f32_16x16x64_bf16 v[60:63], v[32:35], v[64:71], v3
  v_permlane32_swap_b32 v36, v38
  v_permlane32_swap_b32 v37, v39
  v_add_f32 v36, v36, v38
  v_add_f32 v37, v37, v39
  v_cvt_pk_bf16_f32 v38, v36, v37
  ds_write_b32 v152, v38
  v_permlane32_swap_b32 v40, v42
  v_permlane32_swap_b32 v41, v43
  v_add_f32 v40, v40, v42
  v_add_f32 v41, v41, v43
  v_cvt_pk_bf16_f32 v42, v40, v41
  ds_write_b32 v153, v42
  v_permlane32_swap_b32 v44, v46
  v_permlane32_swap_b32 v45, v47
  v_add_f32 v44, v44, v46
  v_add_f32 v45, v45, v47
  v_cvt_pk_bf16_f32 v46, v44, v45
  ds_write_b32 v154, v46
  v_permlane32_swap_b32 v48, v50
  v_permlane32_swap_b32 v49, v51
  v_add_f32 v48, v48, v50
  v_add_f32 v49, v49, v51
  v_cvt_pk_bf16_f32 v50, v48, v49
  ds_write_b32 v155, v50
  v_permlane32_swap_b32 v52, v54
  v_permlane32_swap_b32 v53, v55
  v_add_f32 v52, v52, v54
  v_add_f32 v53, v53, v55
  v_cvt_pk_bf16_f32 v54, v52, v53
  ds_write_b32 v156, v54
  v_permlane32_swap_b32 v56, v58
  v_permlane32_swap_b32 v57, v59
  v_add_f32 v56, v56, v58
  v_add_f32 v57, v57, v59
  v_cvt_pk_bf16_f32 v58, v56, v57
  ds_write_b32 v157, v58
  v_permlane32_swap_b32 v60, v62
  v_permlane32_swap_b32 v61, v63
  v_add_f32 v60, v60, v62
  v_add_f32 v61, v61, v63
  v_cvt_pk_bf16_f32 v62, v60, v61
  ds_write_b32 v158, v62
  s_branch cB_va1_t2d
cB_va1_last:
  s_barrier
  ds_read_b128 v[64:67], v2 offset:4096
  ds_read_b128 v[68:71], v2 offset:5120
  ds_read_b128 v[72:75], v2 offset:6144
  ds_read_b128 v[76:79], v2 offset:7168
  s_waitcnt lgkmcnt(0)
  v_min_u32 v64, -2, v64
  v_min_u32 v65, -2, v65
  v_min_u32 v66, -2, v66
  v_min_u32 v67, -2, v67
  v_min_u32 v68, -2, v68
  v_min_u32 v69, -2, v69
  v_min_u32 v70, -2, v70
  v_min_u32 v71, -2, v71
  v_min_u32 v72, -2, v72
  v_min_u32 v73, -2, v73
  v_min_u32 v74, -2, v74
  v_min_u32 v75, -2, v75
  v_min_u32 v76, -2, v76
  v_min_u32 v77, -2, v77
  v_min_u32 v78, -2, v78
  v_min_u32 v79, -2, v79
  buffer_store_dwordx4 v[64:67], v2, s[8:11], s33 offen offset:0 sc1
  buffer_store_dwordx4 v[68:71], v2, s[8:11], s33 offen offset:2048 sc1
  s_add_u32 s33, s33, 4096
  buffer_store_dwordx4 v[72:75], v2, s[8:11], s33 offen offset:0 sc1
  buffer_store_dwordx4 v[76:79], v2, s[8:11], s33 offen offset:2048 sc1
  s_add_u32 s33, s33, 4096
  s_waitcnt vmcnt(0)
  buffer_wbl2 sc1
  s_branch cB_done
cB_va1_rp:
  s_cmp_eq_u32 s37, 0
  s_cbranch_scc1 cB_va1_rv
  v_min_u32 v160, -2, v160
  buffer_store_dword v160, v1, s[8:11], s21 offen sc1
  s_branch cB_va1_cont
cB_va1_rv:
  s_add_u32 s31, s31, 0x10000
  buffer_load_dwordx4 v[8:11], v2, s[8:11], s22 offen offset:0 sc1
  buffer_load_dwordx4 v[12:15], v2, s[8:11], s22 offen offset:1024 sc1
  buffer_load_dwordx4 v[16:19], v2, s[8:11], s22 offen offset:2048 sc1
  buffer_load_dwordx4 v[20:23], v2, s[8:11], s22 offen offset:3072 sc1
  buffer_load_dwordx4 v[24:27], v2, s[8:11], s34 offen offset:0 sc1
  buffer_load_dwordx4 v[28:31], v2, s[8:11], s34 offen offset:1024 sc1
  buffer_load_dwordx4 v[32:35], v2, s[8:11], s34 offen offset:2048 sc1
  buffer_load_dwordx4 v[36:39], v2, s[8:11], s34 offen offset:3072 sc1
  buffer_load_dwordx4 v[40:43], v2, s[8:11], s36 offen offset:0 sc1
  buffer_load_dwordx4 v[44:47], v2, s[8:11], s36 offen offset:1024 sc1
  s_waitcnt vmcnt(0)
  v_max3_u32 v52, v8, v9, v10
  v_max3_u32 v52, v52, v11, v12
  v_max3_u32 v52, v52, v13, v14
  v_max3_u32 v52, v52, v15, v16
  v_max3_u32 v52, v52, v17, v18
  v_max3_u32 v52, v52, v19, v20
  v_max3_u32 v52, v52, v21, v22
  v_max3_u32 v52, v52, v23, v24
  v_max3_u32 v52, v52, v25, v26
  v_max3_u32 v52, v52, v27, v28
  v_max3_u32 v52, v52, v29, v30
  v_max3_u32 v52, v52, v31, v32
  v_max3_u32 v52, v52, v33, v34
  v_max3_u32 v52, v52, v35, v36
  v_max3_u32 v52, v52, v37, v38
  v_max3_u32 v52, v52, v39, v40
  v_max3_u32 v52, v52, v41, v42
  v_max3_u32 v52, v52, v43, v44
  v_max3_u32 v52, v52, v45, v46
  v_max_u32 v52, v52, v47
  v_cmp_eq_u32 vcc, -1, v52
  s_mov_b32 s37, 1
  v_mov_b32 v48, 0
  v_mov_b32 v49, 0
  v_mov_b32 v50, 0
  v_mov_b32 v51, 0
  s_nop 1
  s_cbranch_vccz cB_va1_lp
  s_add_u32 s30, s30, 1
  s_cmp_lt_u32 s30, 400000
  s_cbranch_scc1 cB_va1_rv
  s_branch cB_abort
.p2align 6
cB_va2_loop:
  s_mov_b32 s30, 0
cB_va2_fp_l:
  v_cmp_gt_u32 vcc, s19, v96
  buffer_load_dword v96, v119, s[8:11], 0 offen sc1
  s_cbranch_vccz cB_va2_fp_d
  v_cmp_gt_u32 vcc, s19, v96
  buffer_load_dword v96, v119, s[8:11], 0 offen sc1
  s_cbranch_vccz cB_va2_fp_d
  v_cmp_gt_u32 vcc, s19, v96
  buffer_load_dword v96, v119, s[8:11], 0 offen sc1
  s_cbranch_vccz cB_va2_fp_d
  v_cmp_gt_u32 vcc, s19, v96
  buffer_load_dword v96, v119, s[8:11], 0 offen sc1
  s_cbranch_vccz cB_va2_fp_d
  v_cmp_gt_u32 vcc, s19, v96
  buffer_load_dword v96, v119, s[8:11], 0 offen sc1
  s_cbranch_vccz cB_va2_fp_d
  v_cmp_gt_u32 vcc, s19, v96
  buffer_load_dword v96, v119, s[8:11], 0 offen sc1
  s_cbranch_vccz cB_va2_fp_d
  v_cmp_gt_u32 vcc, s19, v96
  buffer_load_dword v96, v119, s[8:11], 0 offen sc1
  s_cbranch_vccz cB_va2_fp_d
  v_cmp_gt_u32 vcc, s19, v96
  buffer_load_dword v96, v119, s[8:11], 0 offen sc1
  s_cbranch_vccz cB_va2_fp_d
  v_cmp_gt_u32 vcc, s19, v96
  buffer_load_dword v96, v119, s[8:11], 0 offen sc1
  s_cbranch_vccz cB_va2_fp_d
  v_cmp_gt_u32 vcc, s19, v96
  buffer_load_dword v96, v119, s[8:11], 0 offen sc1
  s_cbranch_vccz cB_va2_fp_d
  v_cmp_gt_u32 vcc, s19, v96
  buffer_load_dword v96, v119, s[8:11], 0 offen sc1
  s_cbranch_vccz cB_va2_fp_d
  v_cmp_gt_u32 vcc, s19, v96
  buffer_load_dword v96, v119, s[8:11], 0 offen sc1
  s_cbranch_vccz cB_va2_fp_d
  v_cmp_gt_u32 vcc, s19, v96
  buffer_load_dword v96, v119, s[8:11], 0 offen sc1
  s_cbranch_vccz cB_va2_fp_d
  v_cmp_gt_u32 vcc, s19, v96
  buffer_load_dword v96, v119, s[8:11], 0 offen sc1
  s_cbranch_vccz cB_va2_fp_d
  v_cmp_gt_u32 vcc, s19, v96
  buffer_load_dword v96, v119, s[8:11], 0 offen sc1
  s_cbranch_vccz cB_va2_fp_d
  v_cmp_gt_u32 vcc, s19, v96
  buffer_load_dword v96, v119, s[8:11], 0 offen sc1
  s_cbranch_vccz cB_va2_fp_d
  s_waitcnt vmcnt(24)
  s_add_u32 s30, s30, 1
  s_cmp_lt_u32 s30, 400000
  s_cbranch_scc1 cB_va2_fp_l
  s_branch cB_abort
cB_va2_fp_d:
  buffer_load_dwordx4 v[8:11], v2, s[8:11], s20 offen offset:0 sc1
  buffer_load_dwordx4 v[12:15], v2, s[8:11], s20 offen offset:1024 sc1
  s_barrier
  s_barrier
  s_waitcnt vmcnt(0)
  ds_write_b128 v2, v[8:11] offset:8192
  ds_write_b128 v2, v[12:15] offset:9216
  v_smfmac_f32_16x16x64_bf16 v[36:39], v[8:11], a[0:7], v3
  v_smfmac_f32_16x16x64_bf16 v[40:43], v[8:11], a[56:63], v3
  v_smfmac_f32_16x16x64_bf16 v[44:47], v[8:11], a[112:119], v3
  v_smfmac_f32_16x16x64_bf16 v[48:51], v[8:11], a[168:175], v3
  v_smfmac_f32_16x16x64_bf16 v[52:55], v[8:11], a[224:231], v3
  s_waitcnt lgkmcnt(0)
  s_barrier
  ds_read_b128 v[16:19], v2 offset:10240
  ds_read_b128 v[20:23], v2 offset:11264
  ds_read_b128 v[24:27], v2 offset:12288
  ds_read_b128 v[28:31], v2 offset:13312
  ds_read_b128 v[32:35], v2 offset:14336
  v_smfmac_f32_16x16x64_bf16 v[56:59], v[8:11], v[144:151], v3
  v_smfmac_f32_16x16x64_bf16 v[60:63], v[8:11], v[200:207], v3
  v_smfmac_f32_16x16x64_bf16 v[36:39], v[12:15], a[8:15], v3
  v_smfmac_f32_16x16x64_bf16 v[40:43], v[12:15], a[64:71], v3
  v_smfmac_f32_16x16x64_bf16 v[44:47], v[12:15], a[120:127], v3
  v_smfmac_f32_16x16x64_bf16 v[48:51], v[12:15], a[176:183], v3
  v_smfmac_f32_16x16x64_bf16 v[52:55], v[12:15], a[232:239], v3
  v_smfmac_f32_16x16x64_bf16 v[56:59], v[12:15], v[152:159], v3
  ds_read_b128 v[68:71], v0 offset:0
  ds_read_b128 v[72:75], v0 offset:1024
  v_smfmac_f32_16x16x64_bf16 v[60:63], v[12:15], v[208:215], v3
  s_waitcnt lgkmcnt(6)
  ds_read_b128 v[76:79], v0 offset:2048
  ds_read_b128 v[80:83], v0 offset:3072
  v_smfmac_f32_16x16x64_bf16 v[36:39], v[16:19], a[16:23], v3
  s_waitcnt lgkmcnt(7)
  v_smfmac_f32_16x16x64_bf16 v[36:39], v[20:23], a[24:31], v3
  s_waitcnt lgkmcnt(6)
  v_smfmac_f32_16x16x64_bf16 v[36:39], v[24:27], a[32:39], v3
  s_waitcnt lgkmcnt(2)
  v_smfmac_f32_16x16x64_bf16 v[64:67], v[8:11], v[68:75], v3
  s_waitcnt lgkmcnt(5)
  ds_read_b128 v[84:87], v0 offset:4096
  ds_read_b128 v[88:91], v0 offset:5120
  v_smfmac_f32_16x16x64_bf16 v[36:39], v[28:31], a[40:47], v3
  s_waitcnt lgkmcnt(6)
  v_smfmac_f32_16x16x64_bf16 v[36:39], v[32:35], a[48:55], v3
  v_smfmac_f32_16x16x64_bf16 v[40:43], v[16:19], a[72:79], v3
  s_waitcnt lgkmcnt(2)
  v_smfmac_f32_16x16x64_bf16 v[64:67], v[12:15], v[76:83], v3
  ds_read_b128 v[68:71], v0 offset:6144
  ds_read_b128 v[72:75], v0 offset:7168
  v_smfmac_f32_16x16x64_bf16 v[40:43], v[20:23], a[80:87], v3
  v_permlane32_swap_b32 v36, v38
  v_smfmac_f32_16x16x64_bf16 v[40:43], v[24:27], a[88:95], v3
  v_permlane32_swap_b32 v37, v39
  v_smfmac_f32_16x16x64_bf16 v[40:43], v[28:31], a[96:103], v3
  s_waitcnt lgkmcnt(2)
  v_add_f32 v36, v36, v38
  v_smfmac_f32_16x16x64_bf16 v[64:67], v[16:19], v[84:91], v3
  ds_read_b128 v[76:79], v0 offset:8192
  ds_read_b128 v[80:83], v0 offset:9216
  v_add_f32 v37, v37, v39
  v_smfmac_f32_16x16x64_bf16 v[40:43], v[32:35], a[104:111], v3
  v_cmp_u_f32 vcc, v36, v37
  v_smfmac_f32_16x16x64_bf16 v[44:47], v[16:19], a[128:135], v3
  v_cvt_pk_bf16_f32 v38, v36, v37
  v_smfmac_f32_16x16x64_bf16 v[44:47], v[20:23], a[136:143], v3
  ds_write_b32 v104, v38
  s_waitcnt lgkmcnt(3)
  s_cbranch_vccnz cB_va2_slow
  v_permlane32_swap_b32 v40, v42
  v_smfmac_f32_16x16x64_bf16 v[64:67], v[20:23], v[68:75], v3
  ds_read_b128 v[84:87], v0 offset:10240
  ds_read_b128 v[88:91], v0 offset:11264
  v_permlane32_swap_b32 v41, v43
  v_smfmac_f32_16x16x64_bf16 v[44:47], v[24:27], a[144:151], v3
  v_add_f32 v40, v40, v42
  v_smfmac_f32_16x16x64_bf16 v[44:47], v[28:31], a[152:159], v3
  v_add_f32 v41, v41, v43
  v_smfmac_f32_16x16x64_bf16 v[44:47], v[32:35], a[160:167], v3
  s_waitcnt lgkmcnt(3)
  v_cvt_pk_bf16_f32 v42, v40, v41
  v_smfmac_f32_16x16x64_bf16 v[64:67], v[24:27], v[76:83], v3
  ds_write_b32 v105, v42
  ds_read_b128 v[68:71], v0 offset:12288
  ds_read_b128 v[72:75], v0 offset:13312
  v_smfmac_f32_16x16x64_bf16 v[48:51], v[16:19], a[184:191], v3
  s_nop 0
  v_permlane32_swap_b32 v44, v46
  v_smfmac_f32_16x16x64_bf16 v[48:51], v[20:23], a[192:199], v3
  v_permlane32_swap_b32 v45, v47
  v_smfmac_f32_16x16x64_bf16 v[48:51], v[24:27], a[200:207], v3
  s_waitcnt lgkmcnt(3)
  v_add_f32 v44, v44, v46
  v_smfmac_f32_16x16x64_bf16 v[64:67], v[28:31], v[84:91], v3
  v_add_f32 v45, v45, v47
  v_smfmac_f32_16x16x64_bf16 v[48:51], v[28:31], a[208:215], v3
  v_cvt_pk_bf16_f32 v46, v44, v45
  v_smfmac_f32_16x16x64_bf16 v[48:51], v[32:35], a[216:223], v3
  ds_write_b32 v106, v46
  v_smfmac_f32_16x16x64_bf16 v[52:55], v[16:19], a[240:247], v3
  s_waitcnt lgkmcnt(1)
  v_smfmac_f32_16x16x64_bf16 v[64:67], v[32:35], v[68:75], v3
  v_smfmac_f32_16x16x64_bf16 v[52:55], v[20:23], a[248:255], v3
  v_permlane32_swap_b32 v48, v50
  v_smfmac_f32_16x16x64_bf16 v[52:55], v[24:27], v[120:127], v3
  v_permlane32_swap_b32 v49, v51
  v_smfmac_f32_16x16x64_bf16 v[52:55], v[28:31], v[128:135], v3
  v_add_f32 v48, v48, v50
  v_smfmac_f32_16x16x64_bf16 v[52:55], v[32:35], v[136:143], v3
  v_add_f32 v49, v49, v51
  v_smfmac_f32_16x16x64_bf16 v[56:59], v[16:19], v[160:167], v3
  v_cvt_pk_bf16_f32 v50, v48, v49
  v_smfmac_f32_16x16x64_bf16 v[56:59], v[20:23], v[168:175], v3
  ds_write_b32 v107, v50
  v_permlane32_swap_b32 v64, v66
  v_smfmac_f32_16x16x64_bf16 v[56:59], v[24:27], v[176:183], v3
  v_permlane32_swap_b32 v65, v67
  v_smfmac_f32_16x16x64_bf16 v[56:59], v[28:31], v[184:191], v3
  v_add_f32 v64, v64, v66
  v_smfmac_f32_16x16x64_bf16 v[56:59], v[32:35], v[192:199], v3
  v_add_f32 v65, v65, v67
  v_smfmac_f32_16x16x64_bf16 v[60:63], v[16:19], v[216:223], v3
  v_cvt_pk_bf16_f32 v66, v64, v65
  v_smfmac_f32_16x16x64_bf16 v[60:63], v[20:23], v[224:231], v3
  ds_write_b32 v111, v66
  v_permlane32_swap_b32 v52, v54
  v_smfmac_f32_16x16x64_bf16 v[60:63], v[24:27], v[232:239], v3
  v_permlane32_swap_b32 v53, v55
  v_smfmac_f32_16x16x64_bf16 v[60:63], v[28:31], v[240:247], v3
  v_add_f32 v52, v52, v54
  v_smfmac_f32_16x16x64_bf16 v[60:63], v[32:35], v[248:255], v3
  v_add_f32 v53, v53, v55
  v_cvt_pk_bf16_f32 v54, v52, v53
  ds_write_b32 v108, v54
  v_permlane32_swap_b32 v56, v58
  v_permlane32_swap_b32 v57, v59
  v_add_f32 v56, v56, v58
  v_add_f32 v57, v57, v59
  v_cvt_pk_bf16_f32 v58, v56, v57
  ds_write_b32 v109, v58
  v_permlane32_swap_b32 v60, v62
  v_permlane32_swap_b32 v61, v63
  v_add_f32 v60, v60, v62
  v_add_f32 v61, v61, v63
  v_cvt_pk_bf16_f32 v62, v60, v61
  ds_write_b32 v110, v62
cB_va2_t2d:
  v_mov_b32 v117, s18
  s_waitcnt lgkmcnt(0)
  s_barrier
  s_cmp_eq_u32 s19, 63
  s_cbranch_scc1 cB_done
  s_sleep 1
  v_mov_b32 v36, 0
  v_mov_b32 v37, 0
  v_mov_b32 v38, 0
  v_mov_b32 v39, 0
  v_mov_b32 v40, 0
  v_mov_b32 v41, 0
  v_mov_b32 v42, 0
  v_mov_b32 v43, 0
  v_mov_b32 v44, 0
  v_mov_b32 v45, 0
  v_mov_b32 v46, 0
  v_mov_b32 v47, 0
  v_mov_b32 v48, 0
  v_mov_b32 v49, 0
  v_mov_b32 v50, 0
  v_mov_b32 v51, 0
  v_mov_b32 v52, 0
  v_mov_b32 v53, 0
  v_mov_b32 v54, 0
  v_mov_b32 v55, 0
  v_mov_b32 v56, 0
  v_mov_b32 v57, 0
  v_mov_b32 v58, 0
  v_mov_b32 v59, 0
  v_mov_b32 v60, 0
  v_mov_b32 v61, 0
  v_mov_b32 v62, 0
  v_mov_b32 v63, 0
  v_mov_b32 v64, 0
  v_mov_b32 v65, 0
  v_mov_b32 v66, 0
  v_mov_b32 v67, 0
  s_sleep 5
  s_mov_b32 s19, s18
  s_add_u32 s18, s18, 1
  s_mov_b32 s22, s20
  s_mov_b32 s20, s21
  s_mov_b32 s21, s22
  s_add_u32 s23, s20, 4096
  s_branch cB_va2_loop
cB_va2_slow:
  s_waitcnt lgkmcnt(0)
cB_va2_sl1:
  s_add_u32 s31, s31, 0x1000000
  buffer_load_dwordx4 v[8:11], v2, s[8:11], s20 offen offset:0 sc1
  buffer_load_dwordx4 v[12:15], v2, s[8:11], s20 offen offset:1024 sc1
  buffer_load_dwordx4 v[16:19], v2, s[8:11], s20 offen offset:2048 sc1
  buffer_load_dwordx4 v[20:23], v2, s[8:11], s20 offen offset:3072 sc1
  buffer_load_dwordx4 v[24:27], v2, s[8:11], s23 offen offset:0 sc1
  buffer_load_dwordx4 v[28:31], v2, s[8:11], s23 offen offset:1024 sc1
  buffer_load_dwordx4 v[32:35], v2, s[8:11], s23 offen offset:2048 sc1
  s_waitcnt vmcnt(0)
  v_max3_u32 v36, v8, v9, v10
  v_max3_u32 v36, v36, v11, v12
  v_max3_u32 v36, v36, v13, v14
  v_max3_u32 v36, v36, v15, v16
  v_max3_u32 v36, v36, v17, v18
  v_max3_u32 v36, v36, v19, v20
  v_max3_u32 v36, v36, v21, v22
  v_max3_u32 v36, v36, v23, v24
  v_max3_u32 v36, v36, v25, v26
  v_max3_u32 v36, v36, v27, v28
  v_max3_u32 v36, v36, v29, v30
  v_max3_u32 v36, v36, v31, v32
  v_max3_u32 v36, v36, v33, v34
  v_max_u32 v36, v36, v35
  v_cmp_eq_u32 vcc, -1, v36
  s_cbranch_vccz cB_va2_sl2
  s_add_u32 s30, s30, 1
  s_cmp_lt_u32 s30, 400000
  s_cbranch_scc1 cB_va2_sl1
  s_branch cB_abort
cB_va2_sl2:
  v_mov_b32 v36, 0
  v_mov_b32 v37, 0
  v_mov_b32 v38, 0
  v_mov_b32 v39, 0
  v_mov_b32 v40, 0
  v_mov_b32 v41, 0
  v_mov_b32 v42, 0
  v_mov_b32 v43, 0
  v_mov_b32 v44, 0
  v_mov_b32 v45, 0
  v_mov_b32 v46, 0
  v_mov_b32 v47, 0
  v_mov_b32 v48, 0
  v_mov_b32 v49, 0
  v_mov_b32 v50, 0
  v_mov_b32 v51, 0
  v_mov_b32 v52, 0
  v_mov_b32 v53, 0
  v_mov_b32 v54, 0
  v_mov_b32 v55, 0
  v_mov_b32 v56, 0
  v_mov_b32 v57, 0
  v_mov_b32 v58, 0
  v_mov_b32 v59, 0
  v_mov_b32 v60, 0
  v_mov_b32 v61, 0
  v_mov_b32 v62, 0
  v_mov_b32 v63, 0
  v_mov_b32 v64, 0
  v_mov_b32 v65, 0
  v_mov_b32 v66, 0
  v_mov_b32 v67, 0
  ds_read_b128 v[68:71], v0 offset:0
  ds_read_b128 v[72:75], v0 offset:1024
  v_smfmac_f32_16x16x64_bf16 v[36:39], v[8:11], a[0:7], v3
  v_smfmac_f32_16x16x64_bf16 v[40:43], v[8:11], a[56:63], v3
  v_smfmac_f32_16x16x64_bf16 v[44:47], v[8:11], a[112:119], v3
  v_smfmac_f32_16x16x64_bf16 v[48:51], v[8:11], a[168:175], v3
  v_smfmac_f32_16x16x64_bf16 v[52:55], v[8:11], a[224:231], v3
  v_smfmac_f32_16x16x64_bf16 v[56:59], v[8:11], v[144:151], v3
  v_smfmac_f32_16x16x64_bf16 v[60:63], v[8:11], v[200:207], v3
  s_waitcnt lgkmcnt(0)
  v_smfmac_f32_16x16x64_bf16 v[64:67], v[8:11], v[68:75], v3
  ds_read_b128 v[76:79], v0 offset:2048
  ds_read_b128 v[80:83], v0 offset:3072
  v_smfmac_f32_16x16x64_bf16 v[36:39], v[12:15], a[8:15], v3
  v_smfmac_f32_16x16x64_bf16 v[40:43], v[12:15], a[64:71], v3
  v_smfmac_f32_16x16x64_bf16 v[44:47], v[12:15], a[120:127], v3
  v_smfmac_f32_16x16x64_bf16 v[48:51], v[12:15], a[176:183], v3
  v_smfmac_f32_16x16x64_bf16 v[52:55], v[12:15], a[232:239], v3
  v_smfmac_f32_16x16x64_bf16 v[56:59], v[12:15], v[152:159], v3
  v_smfmac_f32_16x16x64_bf16 v[60:63], v[12:15], v[208:215], v3
  s_waitcnt lgkmcnt(0)
  v_smfmac_f32_16x16x64_bf16 v[64:67], v[12:15], v[76:83], v3
  ds_read_b128 v[84:87], v0 offset:4096
  ds_read_b128 v[88:91], v0 offset:5120
  v_smfmac_f32_16x16x64_bf16 v[36:39], v[16:19], a[16:23], v3
  v_smfmac_f32_16x16x64_bf16 v[40:43], v[16:19], a[72:79], v3
  v_smfmac_f32_16x16x64_bf16 v[44:47], v[16:19], a[128:135], v3
  v_smfmac_f32_16x16x64_bf16 v[48:51], v[16:19], a[184:191], v3
  v_smfmac_f32_16x16x64_bf16 v[52:55], v[16:19], a[240:247], v3
  v_smfmac_f32_16x16x64_bf16 v[56:59], v[16:19], v[160:167], v3
  v_smfmac_f32_16x16x64_bf16 v[60:63], v[16:19], v[216:223], v3
  s_waitcnt lgkmcnt(0)
  v_smfmac_f32_16x16x64_bf16 v[64:67], v[16:19], v[84:91], v3
  ds_read_b128 v[68:71], v0 offset:6144
  ds_read_b128 v[72:75], v0 offset:7168
  v_smfmac_f32_16x16x64_bf16 v[36:39], v[20:23], a[24:31], v3
  v_smfmac_f32_16x16x64_bf16 v[40:43], v[20:23], a[80:87], v3
  v_smfmac_f32_16x16x64_bf16 v[44:47], v[20:23], a[136:143], v3
  v_smfmac_f32_16x16x64_bf16 v[48:51], v[20:23], a[192:199], v3
  v_smfmac_f32_16x16x64_bf16 v[52:55], v[20:23], a[248:255], v3
  v_smfmac_f32_16x16x64_bf16 v[56:59], v[20:23], v[168:175], v3
  v_smfmac_f32_16x16x64_bf16 v[60:63], v[20:23], v[224:231], v3
  s_waitcnt lgkmcnt(0)
  v_smfmac_f32_16x16x64_bf16 v[64:67], v[20:23], v[68:75], v3
  ds_read_b128 v[76:79], v0 offset:8192
  ds_read_b128 v[80:83], v0 offset:9216
  v_smfmac_f32_16x16x64_bf16 v[36:39], v[24:27], a[32:39], v3
  v_smfmac_f32_16x16x64_bf16 v[40:43], v[24:27], a[88:95], v3
  v_smfmac_f32_16x16x64_bf16 v[44:47], v[24:27], a[144:151], v3
  v_smfmac_f32_16x16x64_bf16 v[48:51], v[24:27], a[200:207], v3
  v_smfmac_f32_16x16x64_bf16 v[52:55], v[24:27], v[120:127], v3
  v_smfmac_f32_16x16x64_bf16 v[56:59], v[24:27], v[176:183], v3
  v_smfmac_f32_16x16x64_bf16 v[60:63], v[24:27], v[232:239], v3
  s_waitcnt lgkmcnt(0)
  v_smfmac_f32_16x16x64_bf16 v[64:67], v[24:27], v[76:83], v3
  ds_read_b128 v[84:87], v0 offset:10240
  ds_read_b128 v[88:91], v0 offset:11264
  v_smfmac_f32_16x16x64_bf16 v[36:39], v[28:31], a[40:47], v3
  v_smfmac_f32_16x16x64_bf16 v[40:43], v[28:31], a[96:103], v3
  v_smfmac_f32_16x16x64_bf16 v[44:47], v[28:31], a[152:159], v3
  v_smfmac_f32_16x16x64_bf16 v[48:51], v[28:31], a[208:215], v3
  v_smfmac_f32_16x16x64_bf16 v[52:55], v[28:31], v[128:135], v3
  v_smfmac_f32_16x16x64_bf16 v[56:59], v[28:31], v[184:191], v3
  v_smfmac_f32_16x16x64_bf16 v[60:63], v[28:31], v[240:247], v3
  s_waitcnt lgkmcnt(0)
  v_smfmac_f32_16x16x64_bf16 v[64:67], v[28:31], v[84:91], v3
  ds_read_b128 v[68:71], v0 offset:12288
  ds_read_b128 v[72:75], v0 offset:13312
  v_smfmac_f32_16x16x64_bf16 v[36:39], v[32:35], a[48:55], v3
  v_smfmac_f32_16x16x64_bf16 v[40:43], v[32:35], a[104:111], v3
  v_smfmac_f32_16x16x64_bf16 v[44:47], v[32:35], a[160:167], v3
  v_smfmac_f32_16x16x64_bf16 v[48:51], v[32:35], a[216:223], v3
  v_smfmac_f32_16x16x64_bf16 v[52:55], v[32:35], v[136:143], v3
  v_smfmac_f32_16x16x64_bf16 v[56:59], v[32:35], v[192:199], v3
  v_smfmac_f32_16x16x64_bf16 v[60:63], v[32:35], v[248:255], v3
  s_waitcnt lgkmcnt(0)
  v_smfmac_f32_16x16x64_bf16 v[64:67], v[32:35], v[68:75], v3
  v_permlane32_swap_b32 v36, v38
  v_permlane32_swap_b32 v37, v39
  v_add_f32 v36, v36, v38
  v_add_f32 v37, v37, v39
  v_cvt_pk_bf16_f32 v38, v36, v37
  ds_write_b32 v104, v38
  v_permlane32_swap_b32 v40, v42
  v_permlane32_swap_b32 v41, v43
  v_add_f32 v40, v40, v42
  v_add_f32 v41, v41, v43
  v_cvt_pk_bf16_f32 v42, v40, v41
  ds_write_b32 v105, v42
  v_permlane32_swap_b32 v44, v46
  v_permlane32_swap_b32 v45, v47
  v_add_f32 v44, v44, v46
  v_add_f32 v45, v45, v47
  v_cvt_pk_bf16_f32 v46, v44, v45
  ds_write_b32 v106, v46
  v_permlane32_swap_b32 v48, v50
  v_permlane32_swap_b32 v49, v51
  v_add_f32 v48, v48, v50
  v_add_f32 v49, v49, v51
  v_cvt_pk_bf16_f32 v50, v48, v49
  ds_write_b32 v107, v50
  v_permlane32_swap_b32 v52, v54
  v_permlane32_swap_b32 v53, v55
  v_add_f32 v52, v52, v54
  v_add_f32 v53, v53, v55
  v_cvt_pk_bf16_f32 v54, v52, v53
  ds_write_b32 v108, v54
  v_permlane32_swap_b32 v56, v58
  v_permlane32_swap_b32 v57, v59
  v_add_f32 v56, v56, v58
  v_add_f32 v57, v57, v59
  v_cvt_pk_bf16_f32 v58, v56, v57
  ds_write_b32 v109, v58
  v_permlane32_swap_b32 v60, v62
  v_permlane32_swap_b32 v61, v63
  v_add_f32 v60, v60, v62
  v_add_f32 v61, v61, v63
  v_cvt_pk_bf16_f32 v62, v60, v61
  ds_write_b32 v110, v62
  v_permlane32_swap_b32 v64, v66
  v_permlane32_swap_b32 v65, v67
  v_add_f32 v64, v64, v66
  v_add_f32 v65, v65, v67
  v_cvt_pk_bf16_f32 v66, v64, v65
  ds_write_b32 v111, v66
  s_branch cB_va2_t2d
.p2align 6
cB_va3_loop:
  s_mov_b32 s30, 0
  s_barrier
  buffer_load_dwordx4 v[16:19], v2, s[8:11], s20 offen offset:2048 sc1
  buffer_load_dwordx4 v[20:23], v2, s[8:11], s20 offen offset:3072 sc1
  s_barrier
  buffer_load_dword v100, v116, s[8:11], s39 offen sc1
  s_add_u32 s27, s19, 2
  s_min_u32 s27, s27, 63
  s_lshr_b32 s27, s27, 3
  s_lshl_b32 s27, s27, 11
  s_add_u32 s27, s27, s35
  s_cmp_eq_u32 s27, s28
  s_cselect_b32 s29, 75729408, s27
  buffer_load_dword v101, off, s[8:11], s29 sc1
  s_add_u32 s39, s39, 28672
  s_waitcnt vmcnt(2)
  ds_write_b128 v2, v[16:19] offset:10240
  ds_write_b128 v2, v[20:23] offset:11264
  v_smfmac_f32_16x16x64_bf16 v[36:39], v[16:19], a[16:23], v3
  v_smfmac_f32_16x16x64_bf16 v[40:43], v[16:19], a[72:79], v3
  v_smfmac_f32_16x16x64_bf16 v[44:47], v[16:19], a[128:135], v3
  v_smfmac_f32_16x16x64_bf16 v[48:51], v[16:19], a[184:191], v3
  v_smfmac_f32_16x16x64_bf16 v[52:55], v[16:19], a[240:247], v3
  s_waitcnt lgkmcnt(0)
  s_barrier
  ds_read_b128 v[8:11], v2 offset:8192
  ds_read_b128 v[12:15], v2 offset:9216
  ds_read_b128 v[24:27], v2 offset:12288
  ds_read_b128 v[28:31], v2 offset:13312
  ds_read_b128 v[32:35], v2 offset:14336
  v_smfmac_f32_16x16x64_bf16 v[56:59], v[16:19], v[160:167], v3
  v_smfmac_f32_16x16x64_bf16 v[60:63], v[16:19], v[216:223], v3
  v_smfmac_f32_16x16x64_bf16 v[36:39], v[20:23], a[24:31], v3
  v_smfmac_f32_16x16x64_bf16 v[40:43], v[20:23], a[80:87], v3
  v_smfmac_f32_16x16x64_bf16 v[44:47], v[20:23], a[136:143], v3
  v_smfmac_f32_16x16x64_bf16 v[48:51], v[20:23], a[192:199], v3
  v_smfmac_f32_16x16x64_bf16 v[52:55], v[20:23], a[248:255], v3
  v_smfmac_f32_16x16x64_bf16 v[56:59], v[20:23], v[168:175], v3
  v_smfmac_f32_16x16x64_bf16 v[60:63], v[20:23], v[224:231], v3
  s_waitcnt lgkmcnt(4)
  v_smfmac_f32_16x16x64_bf16 v[36:39], v[8:11], a[0:7], v3
  s_waitcnt lgkmcnt(3)
  v_smfmac_f32_16x16x64_bf16 v[36:39], v[12:15], a[8:15], v3
  s_waitcnt lgkmcnt(2)
  v_smfmac_f32_16x16x64_bf16 v[36:39], v[24:27], a[32:39], v3
  s_waitcnt lgkmcnt(1)
  v_smfmac_f32_16x16x64_bf16 v[36:39], v[28:31], a[40:47], v3
  s_waitcnt lgkmcnt(0)
  v_smfmac_f32_16x16x64_bf16 v[36:39], v[32:35], a[48:55], v3
  v_smfmac_f32_16x16x64_bf16 v[40:43], v[8:11], a[56:63], v3
  v_smfmac_f32_16x16x64_bf16 v[40:43], v[12:15], a[64:71], v3
  v_smfmac_f32_16x16x64_bf16 v[40:43], v[24:27], a[88:95], v3
  v_permlane32_swap_b32 v36, v38
  v_smfmac_f32_16x16x64_bf16 v[40:43], v[28:31], a[96:103], v3
  v_permlane32_swap_b32 v37, v39
  v_smfmac_f32_16x16x64_bf16 v[40:43], v[32:35], a[104:111], v3
  v_add_f32 v36, v36, v38
  v_smfmac_f32_16x16x64_bf16 v[44:47], v[8:11], a[112:119], v3
  v_add_f32 v37, v37, v39
  v_smfmac_f32_16x16x64_bf16 v[44:47], v[12:15], a[120:127], v3
  v_cmp_u_f32 vcc, v36, v37
  v_smfmac_f32_16x16x64_bf16 v[44:47], v[24:27], a[144:151], v3
  v_cvt_pk_bf16_f32 v38, v36, v37
  v_smfmac_f32_16x16x64_bf16 v[44:47], v[28:31], a[152:159], v3
  ds_write_b32 v104, v38
  s_cbranch_vccnz cB_va3_slow
  v_permlane32_swap_b32 v40, v42
  v_smfmac_f32_16x16x64_bf16 v[44:47], v[32:35], a[160:167], v3
  v_permlane32_swap_b32 v41, v43
  v_smfmac_f32_16x16x64_bf16 v[48:51], v[8:11], a[168:175], v3
  v_add_f32 v40, v40, v42
  v_smfmac_f32_16x16x64_bf16 v[48:51], v[12:15], a[176:183], v3
  v_add_f32 v41, v41, v43
  v_smfmac_f32_16x16x64_bf16 v[48:51], v[24:27], a[200:207], v3
  v_cvt_pk_bf16_f32 v42, v40, v41
  v_smfmac_f32_16x16x64_bf16 v[48:51], v[28:31], a[208:215], v3
  ds_write_b32 v105, v42
  v_permlane32_swap_b32 v44, v46
  v_smfmac_f32_16x16x64_bf16 v[48:51], v[32:35], a[216:223], v3
  v_permlane32_swap_b32 v45, v47
  v_smfmac_f32_16x16x64_bf16 v[52:55], v[8:11], a[224:231], v3
  v_add_f32 v44, v44, v46
  v_smfmac_f32_16x16x64_bf16 v[52:55], v[12:15], a[232:239], v3
  v_add_f32 v45, v45, v47
  v_smfmac_f32_16x16x64_bf16 v[52:55], v[24:27], v[120:127], v3
  v_cvt_pk_bf16_f32 v46, v44, v45
  v_smfmac_f32_16x16x64_bf16 v[52:55], v[28:31], v[128:135], v3
  ds_write_b32 v106, v46
  v_permlane32_swap_b32 v48, v50
  v_smfmac_f32_16x16x64_bf16 v[52:55], v[32:35], v[136:143], v3
  v_permlane32_swap_b32 v49, v51
  v_smfmac_f32_16x16x64_bf16 v[56:59], v[8:11], v[144:151], v3
  v_add_f32 v48, v48, v50
  v_smfmac_f32_16x16x64_bf16 v[56:59], v[12:15], v[152:159], v3
  v_add_f32 v49, v49, v51
  v_smfmac_f32_16x16x64_bf16 v[56:59], v[24:27], v[176:183], v3
  v_cvt_pk_bf16_f32 v50, v48, v49
  v_smfmac_f32_16x16x64_bf16 v[56:59], v[28:31], v[184:191], v3
  ds_write_b32 v107, v50
  v_permlane32_swap_b32 v52, v54
  v_smfmac_f32_16x16x64_bf16 v[56:59], v[32:35], v[192:199], v3
  v_permlane32_swap_b32 v53, v55
  v_smfmac_f32_16x16x64_bf16 v[60:63], v[8:11], v[200:207], v3
  v_add_f32 v52, v52, v54
  v_smfmac_f32_16x16x64_bf16 v[60:63], v[12:15], v[208:215], v3
  v_add_f32 v53, v53, v55
  v_smfmac_f32_16x16x64_bf16 v[60:63], v[24:27], v[232:239], v3
  v_cvt_pk_bf16_f32 v54, v52, v53
  v_smfmac_f32_16x16x64_bf16 v[60:63], v[28:31], v[240:247], v3
  ds_write_b32 v108, v54
  v_permlane32_swap_b32 v56, v58
  v_smfmac_f32_16x16x64_bf16 v[60:63], v[32:35], v[248:255], v3
  v_permlane32_swap_b32 v57, v59
  v_add_f32 v56, v56, v58
  v_add_f32 v57, v57, v59
  v_cvt_pk_bf16_f32 v58, v56, v57
  ds_write_b32 v109, v58
  s_nop 2
  v_permlane32_swap_b32 v60, v62
  v_permlane32_swap_b32 v61, v63
  v_add_f32 v60, v60, v62
  v_add_f32 v61, v61, v63
  v_cvt_pk_bf16_f32 v62, v60, v61
  ds_write_b32 v110, v62
cB_va3_t2d:
  v_mov_b32 v117, s18
  s_cmp_eq_u32 s27, s28
  s_cbranch_scc1 cB_va3_vok
cB_va3_vow:
  s_waitcnt vmcnt(0)
  v_cmp_ne_u32 vcc, 56, v101
  s_cbranch_vccnz cB_va3_vor
  s_mov_b32 s28, s27
cB_va3_vok:
  s_waitcnt lgkmcnt(0)
  s_setprio 3
  s_barrier
  v_mov_b32 v36, 0
  v_mov_b32 v37, 0
  buffer_store_dword v117, v118, s[8:11], 0 offen sc1
  s_setprio 0
  s_cmp_eq_u32 s19, 63
  s_cbranch_scc1 cB_done
  v_mov_b32 v38, 0
  v_mov_b32 v39, 0
  v_mov_b32 v40, 0
  v_mov_b32 v41, 0
  v_mov_b32 v42, 0
  v_mov_b32 v43, 0
  v_mov_b32 v44, 0
  v_mov_b32 v45, 0
  v_mov_b32 v46, 0
  v_mov_b32 v47, 0
  v_mov_b32 v48, 0
  v_mov_b32 v49, 0
  v_mov_b32 v50, 0
  v_mov_b32 v51, 0
  v_mov_b32 v52, 0
  v_mov_b32 v53, 0
  v_mov_b32 v54, 0
  v_mov_b32 v55, 0
  v_mov_b32 v56, 0
  v_mov_b32 v57, 0
  v_mov_b32 v58, 0
  v_mov_b32 v59, 0
  v_mov_b32 v60, 0
  v_mov_b32 v61, 0
  v_mov_b32 v62, 0
  v_mov_b32 v63, 0
  s_mov_b32 s19, s18
  s_add_u32 s18, s18, 1
  s_mov_b32 s22, s20
  s_mov_b32 s20, s21
  s_mov_b32 s21, s22
  s_add_u32 s23, s20, 4096
  s_branch cB_va3_loop
cB_va3_slow:
  s_waitcnt lgkmcnt(0)
cB_va3_sl1:
  s_add_u32 s31, s31, 0x1000000
  buffer_load_dwordx4 v[8:11], v2, s[8:11], s20 offen offset:0 sc1
  buffer_load_dwordx4 v[12:15], v2, s[8:11], s20 offen offset:1024 sc1
  buffer_load_dwordx4 v[16:19], v2, s[8:11], s20 offen offset:2048 sc1
  buffer_load_dwordx4 v[20:23], v2, s[8:11], s20 offen offset:3072 sc1
  buffer_load_dwordx4 v[24:27], v2, s[8:11], s23 offen offset:0 sc1
  buffer_load_dwordx4 v[28:31], v2, s[8:11], s23 offen offset:1024 sc1
  buffer_load_dwordx4 v[32:35], v2, s[8:11], s23 offen offset:2048 sc1
  s_waitcnt vmcnt(0)
  v_max3_u32 v36, v8, v9, v10
  v_max3_u32 v36, v36, v11, v12
  v_max3_u32 v36, v36, v13, v14
  v_max3_u32 v36, v36, v15, v16
  v_max3_u32 v36, v36, v17, v18
  v_max3_u32 v36, v36, v19, v20
  v_max3_u32 v36, v36, v21, v22
  v_max3_u32 v36, v36, v23, v24
  v_max3_u32 v36, v36, v25, v26
  v_max3_u32 v36, v36, v27, v28
  v_max3_u32 v36, v36, v29, v30
  v_max3_u32 v36, v36, v31, v32
  v_max3_u32 v36, v36, v33, v34
  v_max_u32 v36, v36, v35
  v_cmp_eq_u32 vcc, -1, v36
  s_cbranch_vccz cB_va3_sl2
  s_add_u32 s30, s30, 1
  s_cmp_lt_u32 s30, 400000
  s_cbranch_scc1 cB_va3_sl1
  s_branch cB_abort
cB_va3_sl2:
  v_mov_b32 v36, 0
  v_mov_b32 v37, 0
  v_mov_b32 v38, 0
  v_mov_b32 v39, 0
  v_mov_b32 v40, 0
  v_mov_b32 v41, 0
  v_mov_b32 v42, 0
  v_mov_b32 v43, 0
  v_mov_b32 v44, 0
  v_mov_b32 v45, 0
  v_mov_b32 v46, 0
  v_mov_b32 v47, 0
  v_mov_b32 v48, 0
  v_mov_b32 v49, 0
  v_mov_b32 v50, 0
  v_mov_b32 v51, 0
  v_mov_b32 v52, 0
  v_mov_b32 v53, 0
  v_mov_b32 v54, 0
  v_mov_b32 v55, 0
  v_mov_b32 v56, 0
  v_mov_b32 v57, 0
  v_mov_b32 v58, 0
  v_mov_b32 v59, 0
  v_mov_b32 v60, 0
  v_mov_b32 v61, 0
  v_mov_b32 v62, 0
  v_mov_b32 v63, 0
  v_smfmac_f32_16x16x64_bf16 v[36:39], v[8:11], a[0:7], v3
  v_smfmac_f32_16x16x64_bf16 v[40:43], v[8:11], a[56:63], v3
  v_smfmac_f32_16x16x64_bf16 v[44:47], v[8:11], a[112:119], v3
  v_smfmac_f32_16x16x64_bf16 v[48:51], v[8:11], a[168:175], v3
  v_smfmac_f32_16x16x64_bf16 v[52:55], v[8:11], a[224:231], v3
  v_smfmac_f32_16x16x64_bf16 v[56:59], v[8:11], v[144:151], v3
  v_smfmac_f32_16x16x64_bf16 v[60:63], v[8:11], v[200:207], v3
  v_smfmac_f32_16x16x64_bf16 v[36:39], v[12:15], a[8:15], v3
  v_smfmac_f32_16x16x64_bf16 v[40:43], v[12:15], a[64:71], v3
  v_smfmac_f32_16x16x64_bf16 v[44:47], v[12:15], a[120:127], v3
  v_smfmac_f32_16x16x64_bf16 v[48:51], v[12:15], a[176:183], v3
  v_smfmac_f32_16x16x64_bf16 v[52:55], v[12:15], a[232:239], v3
  v_smfmac_f32_16x16x64_bf16 v[56:59], v[12:15], v[152:159], v3
  v_smfmac_f32_16x16x64_bf16 v[60:63], v[12:15], v[208:215], v3
  v_smfmac_f32_16x16x64_bf16 v[36:39], v[16:19], a[16:23], v3
  v_smfmac_f32_16x16x64_bf16 v[40:43], v[16:19], a[72:79], v3
  v_smfmac_f32_16x16x64_bf16 v[44:47], v[16:19], a[128:135], v3
  v_smfmac_f32_16x16x64_bf16 v[48:51], v[16:19], a[184:191], v3
  v_smfmac_f32_16x16x64_bf16 v[52:55], v[16:19], a[240:247], v3
  v_smfmac_f32_16x16x64_bf16 v[56:59], v[16:19], v[160:167], v3
  v_smfmac_f32_16x16x64_bf16 v[60:63], v[16:19], v[216:223], v3
  v_smfmac_f32_16x16x64_bf16 v[36:39], v[20:23], a[24:31], v3
  v_smfmac_f32_16x16x64_bf16 v[40:43], v[20:23], a[80:87], v3
  v_smfmac_f32_16x16x64_bf16 v[44:47], v[20:23], a[136:143], v3
  v_smfmac_f32_16x16x64_bf16 v[48:51], v[20:23], a[192:199], v3
  v_smfmac_f32_16x16x64_bf16 v[52:55], v[20:23], a[248:255], v3
  v_smfmac_f32_16x16x64_bf16 v[56:59], v[20:23], v[168:175], v3
  v_smfmac_f32_16x16x64_bf16 v[60:63], v[20:23], v[224:231], v3
  v_smfmac_f32_16x16x64_bf16 v[36:39], v[24:27], a[32:39], v3
  v_smfmac_f32_16x16x64_bf16 v[40:43], v[24:27], a[88:95], v3
  v_smfmac_f32_16x16x64_bf16 v[44:47], v[24:27], a[144:151], v3
  v_smfmac_f32_16x16x64_bf16 v[48:51], v[24:27], a[200:207], v3
  v_smfmac_f32_16x16x64_bf16 v[52:55], v[24:27], v[120:127], v3
  v_smfmac_f32_16x16x64_bf16 v[56:59], v[24:27], v[176:183], v3
  v_smfmac_f32_16x16x64_bf16 v[60:63], v[24:27], v[232:239], v3
  v_smfmac_f32_16x16x64_bf16 v[36:39], v[28:31], a[40:47], v3
  v_smfmac_f32_16x16x64_bf16 v[40:43], v[28:31], a[96:103], v3
  v_smfmac_f32_16x16x64_bf16 v[44:47], v[28:31], a[152:159], v3
  v_smfmac_f32_16x16x64_bf16 v[48:51], v[28:31], a[208:215], v3
  v_smfmac_f32_16x16x64_bf16 v[52:55], v[28:31], v[128:135], v3
  v_smfmac_f32_16x16x64_bf16 v[56:59], v[28:31], v[184:191], v3
  v_smfmac_f32_16x16x64_bf16 v[60:63], v[28:31], v[240:247], v3
  v_smfmac_f32_16x16x64_bf16 v[36:39], v[32:35], a[48:55], v3
  v_smfmac_f32_16x16x64_bf16 v[40:43], v[32:35], a[104:111], v3
  v_smfmac_f32_16x16x64_bf16 v[44:47], v[32:35], a[160:167], v3
  v_smfmac_f32_16x16x64_bf16 v[48:51], v[32:35], a[216:223], v3
  v_smfmac_f32_16x16x64_bf16 v[52:55], v[32:35], v[136:143], v3
  v_smfmac_f32_16x16x64_bf16 v[56:59], v[32:35], v[192:199], v3
  v_smfmac_f32_16x16x64_bf16 v[60:63], v[32:35], v[248:255], v3
  v_permlane32_swap_b32 v36, v38
  v_permlane32_swap_b32 v37, v39
  v_add_f32 v36, v36, v38
  v_add_f32 v37, v37, v39
  v_cvt_pk_bf16_f32 v38, v36, v37
  ds_write_b32 v104, v38
  v_permlane32_swap_b32 v40, v42
  v_permlane32_swap_b32 v41, v43
  v_add_f32 v40, v40, v42
  v_add_f32 v41, v41, v43
  v_cvt_pk_bf16_f32 v42, v40, v41
  ds_write_b32 v105, v42
  v_permlane32_swap_b32 v44, v46
  v_permlane32_swap_b32 v45, v47
  v_add_f32 v44, v44, v46
  v_add_f32 v45, v45, v47
  v_cvt_pk_bf16_f32 v46, v44, v45
  ds_write_b32 v106, v46
  v_permlane32_swap_b32 v48, v50
  v_permlane32_swap_b32 v49, v51
  v_add_f32 v48, v48, v50
  v_add_f32 v49, v49, v51
  v_cvt_pk_bf16_f32 v50, v48, v49
  ds_write_b32 v107, v50
  v_permlane32_swap_b32 v52, v54
  v_permlane32_swap_b32 v53, v55
  v_add_f32 v52, v52, v54
  v_add_f32 v53, v53, v55
  v_cvt_pk_bf16_f32 v54, v52, v53
  ds_write_b32 v108, v54
  v_permlane32_swap_b32 v56, v58
  v_permlane32_swap_b32 v57, v59
  v_add_f32 v56, v56, v58
  v_add_f32 v57, v57, v59
  v_cvt_pk_bf16_f32 v58, v56, v57
  ds_write_b32 v109, v58
  v_permlane32_swap_b32 v60, v62
  v_permlane32_swap_b32 v61, v63
  v_add_f32 v60, v60, v62
  v_add_f32 v61, v61, v63
  v_cvt_pk_bf16_f32 v62, v60, v61
  ds_write_b32 v110, v62
  s_branch cB_va3_t2d
cB_va3_vor:
  s_sleep 2
  buffer_load_dword v101, off, s[8:11], s27 sc1
  s_add_u32 s30, s30, 1
  s_cmp_lt_u32 s30, 400000
  s_cbranch_scc1 cB_va3_vow
  s_branch cB_abort
cB_abort:
  v_mov_b32 v4, 0xdead
  v_mov_b32 v5, 16
  buffer_store_dword v4, v5, s[12:15], 0 offen
  s_branch ch_end
cB_done:
  s_branch ch_end
ch_worker:
  s_sub_u32 s35, s3, 1
  s_and_b32 s35, s35, 7
  s_lshr_b32 s36, s2, 3
  s_lshl_b32 s33, s35, 5
  s_add_u32 s33, s33, s36
  s_mov_b32 s97, 0
  s_mov_b32 s96, 0
  s_mov_b32 s37, 0
  s_mov_b32 s38, 0
  s_mov_b32 s39, 0xffff0000
  s_mov_b32 s101, -1
  v_and_b32 v1, 63, v0
  v_lshlrev_b32 v2, 4, v1
  v_lshrrev_b32 v3, 4, v1
  v_and_b32 v4, 15, v1
  s_cmp_ge_u32 s33, 224
  s_cbranch_scc1 wp_all
  s_mov_b32 s68, s44
  s_and_b32 s69, s45, 0xffff
  s_mov_b32 s70, 3670016
  s_mov_b32 s71, 0x20000
  s_and_b32 s20, s33, 0xe0
  s_mul_i32 s20, s20, 9363
  s_lshr_b32 s20, s20, 16
  s_lshl_b32 s20, s20, 10
  s_and_b32 s21, s33, 31
  s_mul_i32 s21, s21, 192
  s_add_u32 s20, s20, s21
  v_min_u32 v7, 191, v0
  v_add_u32 v7, s20, v7
  v_lshrrev_b32 v8, 11, v7
  v_min_u32 v8, 15, v8
  v_bfe_u32 v9, v7, 2, 9
  v_lshlrev_b32 v9, 13, v9
  v_lshl_add_u32 v9, v8, 9, v9
  v_and_b32 v7, 3, v7
  v_lshl_add_u32 v9, v7, 7, v9
  buffer_load_dword v253, v9, s[68:71], 0 offen
  v_lshrrev_b32 v5, 5, v1
  v_and_b32 v6, 31, v1
  v_xor_b32 v8, v6, v5
  v_lshlrev_b32 v8, 4, v8
  v_lshl_add_u32 v16, v5, 13, v8
  v_xor_b32 v17, 32, v16
  v_xor_b32 v18, 64, v16
  v_xor_b32 v19, 96, v16
  v_xor_b32 v20, 128, v16
  v_xor_b32 v21, 160, v16
  v_xor_b32 v22, 192, v16
  v_xor_b32 v23, 224, v16
  s_lshl_b32 s20, s16, 6
  v_xor_b32 v26, s20, v16
  v_xor_b32 v27, 32, v26
wp_B:
  s_mul_i32 s17, s33, 4682
  s_lshr_b32 s17, s17, 16
  s_mul_i32 s23, s17, 14
  s_sub_u32 s19, s33, s23
  s_cmp_lt_u32 s19, 7
  s_cselect_b32 s18, 0, 7
  s_cselect_b32 s28, 0, 8
  s_sub_u32 s18, s19, s18
  s_add_u32 s28, s28, s16
  s_lshl_b32 s25, s16, 15
  s_add_u32 s25, s25, 32768
  s_lshl_b32 s26, s17, 9
  s_lshl_b32 s20, s33, 2
  s_add_u32 s20, s20, s16
  s_mul_i32 s21, s20, 9363
  s_lshr_b32 s21, s21, 16
  s_mul_i32 s22, s21, 7
  s_sub_u32 s22, s20, s22
  s_mul_i32 s21, s21, 14336
  s_lshl_b32 s20, s22, 7
  s_add_u32 s20, s20, s21
  s_lshl_b32 s22, s22, 11
  s_add_u32 s52, s21, s22
  s_mov_b32 s68, s48
  s_and_b32 s69, s49, 0xffff
  s_mov_b32 s70, 1835008
  s_mov_b32 s71, 0x20000
  v_mul_u32_u24 v7, 896, v4
  v_lshl_add_u32 v7, v3, 5, v7
  buffer_load_dwordx4 v[128:131], v7, s[68:71], s20 offen
  buffer_load_dwordx4 v[132:135], v7, s[68:71], s20 offen offset:16
  s_mov_b32 s60, s44
  s_and_b32 s61, s45, 0xffff
  s_mov_b32 s62, 3670016
  s_mov_b32 s63, 0x20000
  s_mov_b32 s56, s46
  s_and_b32 s57, s47, 0xffff
  s_mov_b32 s58, 3670016
  s_mov_b32 s59, 0x20000
  s_mul_i32 s27, s17, 229376
  s_lshl_b32 s30, s18, 7
  s_add_u32 s27, s27, s30
  s_mul_i32 s30, s16, 57344
  s_add_u32 s27, s27, s30
  v_lshrrev_b32 v7, 3, v1
  v_and_b32 v8, 7, v1
  v_and_b32 v9, 2, v7
  v_xor_b32 v8, v8, v9
  v_mul_u32_u24 v7, 896, v7
  v_lshl_add_u32 v24, v8, 4, v7
  v_xor_b32 v25, 64, v24
  s_lshl_b32 s30, s16, 13
  s_add_u32 m0, s30, 0
  s_nop 0
  buffer_load_dwordx4 v24, s[56:59], s27 offen  lds
  s_add_u32 s27, s27, 7168
  s_add_u32 m0, s30, 1024
  s_nop 0
  buffer_load_dwordx4 v25, s[56:59], s27 offen  lds
  s_add_u32 s27, s27, 7168
  s_add_u32 m0, s30, 2048
  s_nop 0
  buffer_load_dwordx4 v24, s[56:59], s27 offen  lds
  s_add_u32 s27, s27, 7168
  s_add_u32 m0, s30, 3072
  s_nop 0
  buffer_load_dwordx4 v25, s[56:59], s27 offen  lds
  s_add_u32 s27, s27, 7168
  s_add_u32 m0, s30, 4096
  s_nop 0
  buffer_load_dwordx4 v24, s[56:59], s27 offen  lds
  s_add_u32 s27, s27, 7168
  s_add_u32 m0, s30, 5120
  s_nop 0
  buffer_load_dwordx4 v25, s[56:59], s27 offen  lds
  s_add_u32 s27, s27, 7168
  s_add_u32 m0, s30, 6144
  s_nop 0
  buffer_load_dwordx4 v24, s[56:59], s27 offen  lds
  s_add_u32 s27, s27, 7168
  s_add_u32 m0, s30, 7168
  s_nop 0
  buffer_load_dwordx4 v25, s[56:59], s27 offen  lds
  s_add_u32 s27, s27, 7168
  s_add_u32 s27, s28, 0
  s_min_u32 s27, s27, 13
  s_lshl_b32 s27, s27, 18
  s_add_u32 s27, s27, s26
  s_mov_b32 s55, s27
  v_lshrrev_b32 v7, 2, v4
  v_lshlrev_b32 v11, 4, v7
  v_lshlrev_b32 v7, 3, v7
  v_and_b32 v8, 3, v4
  v_add_u32 v7, v7, v8
  v_and_b32 v8, 2, v4
  v_lshl_add_u32 v11, v8, 1, v11
  v_and_b32 v8, 1, v4
  v_add_u32 v11, v11, v8
  v_or_b32 v10, 0, v3
  v_xor_b32 v10, v10, v4
  v_lshlrev_b32 v10, 4, v10
  v_lshl_add_u32 v44, v11, 9, v10
  v_lshl_add_u32 v10, v7, 9, v10
  v_add_u32 v32, s25, v10
  v_or_b32 v10, 4, v3
  v_xor_b32 v10, v10, v4
  v_lshlrev_b32 v10, 4, v10
  v_lshl_add_u32 v45, v11, 9, v10
  v_lshl_add_u32 v10, v7, 9, v10
  v_add_u32 v33, s25, v10
  v_or_b32 v10, 8, v3
  v_xor_b32 v10, v10, v4
  v_lshlrev_b32 v10, 4, v10
  v_lshl_add_u32 v46, v11, 9, v10
  v_lshl_add_u32 v10, v7, 9, v10
  v_add_u32 v34, s25, v10
  v_or_b32 v10, 12, v3
  v_xor_b32 v10, v10, v4
  v_lshlrev_b32 v10, 4, v10
  v_lshl_add_u32 v47, v11, 9, v10
  v_lshl_add_u32 v10, v7, 9, v10
  v_add_u32 v35, s25, v10
  s_mul_i32 s30, s17, 401408
  s_mul_i32 s31, s18, 57344
  s_add_u32 s30, s30, s31
  s_add_u32 s30, s30, 0
  v_add_u32 v28, s30, v2
  s_add_u32 s30, s30, 14336
  v_add_u32 v29, s30, v2
  s_add_u32 s30, s30, 14336
  v_add_u32 v30, s30, v2
  s_add_u32 s30, s30, 14336
  v_add_u32 v31, s30, v2
  s_add_u32 s30, s30, 14336
  v_mov_b32 v48, 1035512379
  v_lshrrev_b32 v7, 2, v4
  v_lshl_add_u32 v7, v3, 3, v7
  v_lshlrev_b32 v7, 7, v7
  v_and_b32 v8, 3, v4
  v_lshl_add_u32 v7, v8, 3, v7
  v_lshrrev_b32 v8, 3, v4
  v_and_b32 v9, 1, v3
  v_lshl_add_u32 v8, v9, 1, v8
  v_lshl_add_u32 v40, v8, 5, v7
  s_mul_i32 s31, s17, 28
  s_mov_b32 s29, 401408
  s_lshl_b32 s30, s18, 6
  s_add_u32 s30, s30, 0
  v_add_u32 v8, s30, v4
  v_subrev_u32 v9, 256, v8
  v_mul_u32_u24 v11, 171, v9
  v_lshrrev_b32 v11, 11, v11
  v_mul_u32_u24 v38, 12, v11
  v_sub_u32 v38, v9, v38
  v_add_u32 v38, 16, v38
  v_lshrrev_b32 v10, 4, v8
  v_cmp_gt_i32 vcc, 0, v9
  s_nop 1
  v_cndmask_b32 v10, v11, v10, vcc
  v_cndmask_b32 v39, v38, v4, vcc
  v_add_u32 v39, s31, v39
  v_lshrrev_b32 v38, 4, v39
  v_and_b32 v39, 15, v39
  v_mul_lo_u32 v10, v10, s29
  v_mul_u32_u24 v38, 14336, v38
  v_add_u32 v10, v10, v38
  v_lshl_add_u32 v10, v3, 8, v10
  v_lshl_add_u32 v10, v39, 4, v10
  v_add_u32 v12, 6422528, v10
  v_xor_b32 v41, 32, v40
  s_lshl_b32 s30, s18, 6
  s_add_u32 s30, s30, 16
  v_add_u32 v8, s30, v4
  v_subrev_u32 v9, 256, v8
  v_mul_u32_u24 v11, 171, v9
  v_lshrrev_b32 v11, 11, v11
  v_mul_u32_u24 v38, 12, v11
  v_sub_u32 v38, v9, v38
  v_add_u32 v38, 16, v38
  v_lshrrev_b32 v10, 4, v8
  v_cmp_gt_i32 vcc, 0, v9
  s_nop 1
  v_cndmask_b32 v10, v11, v10, vcc
  v_cndmask_b32 v39, v38, v4, vcc
  v_add_u32 v39, s31, v39
  v_lshrrev_b32 v38, 4, v39
  v_and_b32 v39, 15, v39
  v_mul_lo_u32 v10, v10, s29
  v_mul_u32_u24 v38, 14336, v38
  v_add_u32 v10, v10, v38
  v_lshl_add_u32 v10, v3, 8, v10
  v_lshl_add_u32 v10, v39, 4, v10
  v_add_u32 v13, 6422528, v10
  v_xor_b32 v42, 64, v40
  s_lshl_b32 s30, s18, 6
  s_add_u32 s30, s30, 32
  v_add_u32 v8, s30, v4
  v_subrev_u32 v9, 256, v8
  v_mul_u32_u24 v11, 171, v9
  v_lshrrev_b32 v11, 11, v11
  v_mul_u32_u24 v38, 12, v11
  v_sub_u32 v38, v9, v38
  v_add_u32 v38, 16, v38
  v_lshrrev_b32 v10, 4, v8
  v_cmp_gt_i32 vcc, 0, v9
  s_nop 1
  v_cndmask_b32 v10, v11, v10, vcc
  v_cndmask_b32 v39, v38, v4, vcc
  v_add_u32 v39, s31, v39
  v_lshrrev_b32 v38, 4, v39
  v_and_b32 v39, 15, v39
  v_mul_lo_u32 v10, v10, s29
  v_mul_u32_u24 v38, 14336, v38
  v_add_u32 v10, v10, v38
  v_lshl_add_u32 v10, v3, 8, v10
  v_lshl_add_u32 v10, v39, 4, v10
  v_add_u32 v14, 6422528, v10
  v_xor_b32 v43, 96, v40
  s_lshl_b32 s30, s18, 6
  s_add_u32 s30, s30, 48
  v_add_u32 v8, s30, v4
  v_subrev_u32 v9, 256, v8
  v_mul_u32_u24 v11, 171, v9
  v_lshrrev_b32 v11, 11, v11
  v_mul_u32_u24 v38, 12, v11
  v_sub_u32 v38, v9, v38
  v_add_u32 v38, 16, v38
  v_lshrrev_b32 v10, 4, v8
  v_cmp_gt_i32 vcc, 0, v9
  s_nop 1
  v_cndmask_b32 v10, v11, v10, vcc
  v_cndmask_b32 v39, v38, v4, vcc
  v_add_u32 v39, s31, v39
  v_lshrrev_b32 v38, 4, v39
  v_and_b32 v39, 15, v39
  v_mul_lo_u32 v10, v10, s29
  v_mul_u32_u24 v38, 14336, v38
  v_add_u32 v10, v10, v38
  v_lshl_add_u32 v10, v3, 8, v10
  v_lshl_add_u32 v10, v39, 4, v10
  v_add_u32 v15, 6422528, v10
  s_mov_b32 s27, s55
  s_add_u32 m0, s25, 0
  s_nop 0
  buffer_load_dwordx4 v16, s[60:63], s27 offen  lds
  s_add_u32 s27, s27, 16384
  s_add_u32 m0, s25, 1024
  s_nop 0
  buffer_load_dwordx4 v17, s[60:63], s27 offen  lds
  s_add_u32 s27, s27, 16384
  s_add_u32 m0, s25, 2048
  s_nop 0
  buffer_load_dwordx4 v16, s[60:63], s27 offen  lds
  s_add_u32 s27, s27, 16384
  s_add_u32 m0, s25, 3072
  s_nop 0
  buffer_load_dwordx4 v17, s[60:63], s27 offen  lds
  s_add_u32 s27, s27, 16384
  s_add_u32 m0, s25, 4096
  s_nop 0
  buffer_load_dwordx4 v18, s[60:63], s27 offen  lds
  s_add_u32 s27, s27, 16384
  s_add_u32 m0, s25, 5120
  s_nop 0
  buffer_load_dwordx4 v19, s[60:63], s27 offen  lds
  s_add_u32 s27, s27, 16384
  s_add_u32 m0, s25, 6144
  s_nop 0
  buffer_load_dwordx4 v18, s[60:63], s27 offen  lds
  s_add_u32 s27, s27, 16384
  s_add_u32 m0, s25, 7168
  s_nop 0
  buffer_load_dwordx4 v19, s[60:63], s27 offen  lds
  s_add_u32 s27, s27, 16384
  s_add_u32 m0, s25, 8192
  s_nop 0
  buffer_load_dwordx4 v20, s[60:63], s27 offen  lds
  s_add_u32 s27, s27, 16384
  s_add_u32 m0, s25, 9216
  s_nop 0
  buffer_load_dwordx4 v21, s[60:63], s27 offen  lds
  s_add_u32 s27, s27, 16384
  s_add_u32 m0, s25, 10240
  s_nop 0
  buffer_load_dwordx4 v20, s[60:63], s27 offen  lds
  s_add_u32 s27, s27, 16384
  s_add_u32 m0, s25, 11264
  s_nop 0
  buffer_load_dwordx4 v21, s[60:63], s27 offen  lds
  s_add_u32 s27, s27, 16384
  s_add_u32 m0, s25, 12288
  s_nop 0
  buffer_load_dwordx4 v22, s[60:63], s27 offen  lds
  s_add_u32 s27, s27, 16384
  s_add_u32 m0, s25, 13312
  s_nop 0
  buffer_load_dwordx4 v23, s[60:63], s27 offen  lds
  s_add_u32 s27, s27, 16384
  s_add_u32 m0, s25, 14336
  s_nop 0
  buffer_load_dwordx4 v22, s[60:63], s27 offen  lds
  s_add_u32 s27, s27, 16384
  s_add_u32 m0, s25, 15360
  s_nop 0
  buffer_load_dwordx4 v23, s[60:63], s27 offen  lds
  s_add_u32 s27, s27, 16384
  s_add_u32 s27, s28, 4
  s_min_u32 s27, s27, 13
  s_lshl_b32 s27, s27, 18
  s_add_u32 s27, s27, s26
  s_add_u32 m0, s25, 16384
  s_nop 0
  buffer_load_dwordx4 v16, s[60:63], s27 offen  lds
  s_add_u32 s27, s27, 16384
  s_add_u32 m0, s25, 17408
  s_nop 0
  buffer_load_dwordx4 v17, s[60:63], s27 offen  lds
  s_add_u32 s27, s27, 16384
  s_add_u32 m0, s25, 18432
  s_nop 0
  buffer_load_dwordx4 v16, s[60:63], s27 offen  lds
  s_add_u32 s27, s27, 16384
  s_add_u32 m0, s25, 19456
  s_nop 0
  buffer_load_dwordx4 v17, s[60:63], s27 offen  lds
  s_add_u32 s27, s27, 16384
  s_add_u32 m0, s25, 20480
  s_nop 0
  buffer_load_dwordx4 v18, s[60:63], s27 offen  lds
  s_add_u32 s27, s27, 16384
  s_add_u32 m0, s25, 21504
  s_nop 0
  buffer_load_dwordx4 v19, s[60:63], s27 offen  lds
  s_add_u32 s27, s27, 16384
  s_add_u32 m0, s25, 22528
  s_nop 0
  buffer_load_dwordx4 v18, s[60:63], s27 offen  lds
  s_add_u32 s27, s27, 16384
  s_add_u32 m0, s25, 23552
  s_nop 0
  buffer_load_dwordx4 v19, s[60:63], s27 offen  lds
  s_add_u32 s27, s27, 16384
  s_add_u32 m0, s25, 24576
  s_nop 0
  buffer_load_dwordx4 v20, s[60:63], s27 offen  lds
  s_add_u32 s27, s27, 16384
  s_add_u32 m0, s25, 25600
  s_nop 0
  buffer_load_dwordx4 v21, s[60:63], s27 offen  lds
  s_add_u32 s27, s27, 16384
  s_add_u32 m0, s25, 26624
  s_nop 0
  buffer_load_dwordx4 v20, s[60:63], s27 offen  lds
  s_add_u32 s27, s27, 16384
  s_add_u32 m0, s25, 27648
  s_nop 0
  buffer_load_dwordx4 v21, s[60:63], s27 offen  lds
  s_add_u32 s27, s27, 16384
  s_add_u32 m0, s25, 28672
  s_nop 0
  buffer_load_dwordx4 v22, s[60:63], s27 offen  lds
  s_add_u32 s27, s27, 16384
  s_add_u32 m0, s25, 29696
  s_nop 0
  buffer_load_dwordx4 v23, s[60:63], s27 offen  lds
  s_add_u32 s27, s27, 16384
  s_add_u32 m0, s25, 30720
  s_nop 0
  buffer_load_dwordx4 v22, s[60:63], s27 offen  lds
  s_add_u32 s27, s27, 16384
  s_add_u32 m0, s25, 31744
  s_nop 0
  buffer_load_dwordx4 v23, s[60:63], s27 offen  lds
  s_add_u32 s27, s27, 16384
  s_cmp_lt_u32 s18, 4
  s_cselect_b32 s34, 1, s97
  s_mov_b32 s68, s40
  s_and_b32 s69, s41, 0xffff
  s_mov_b32 s70, 3670016
  s_mov_b32 s71, 0x20000
  s_and_b32 s20, s33, 0xe0
  s_mul_i32 s20, s20, 9363
  s_lshr_b32 s20, s20, 16
  s_lshl_b32 s20, s20, 10
  s_and_b32 s21, s33, 31
  s_mul_i32 s21, s21, 192
  s_add_u32 s20, s20, s21
  v_min_u32 v7, 191, v0
  v_add_u32 v7, s20, v7
  v_lshrrev_b32 v8, 11, v7
  v_min_u32 v8, 15, v8
  v_bfe_u32 v9, v7, 2, 9
  v_lshlrev_b32 v9, 13, v9
  v_lshl_add_u32 v9, v8, 9, v9
  v_and_b32 v7, 3, v7
  v_lshl_add_u32 v9, v7, 7, v9
  buffer_load_dword v253, v9, s[68:71], 0 offen
  s_mov_b32 s68, s42
  s_and_b32 s69, s43, 0xffff
  s_mov_b32 s70, 3670016
  s_mov_b32 s71, 0x20000
  s_lshl_b32 s27, s18, 19
  s_add_u32 s27, s27, s26
  s_cmp_lg_u32 s34, 0
  s_cselect_b32 s27, 0x40000000, s27
  v_lshrrev_b32 v7, 2, v0
  v_and_b32 v8, 3, v0
  v_lshlrev_b32 v8, 7, v8
  v_lshl_add_u32 v9, v7, 13, v8
  buffer_load_dword v253, v9, s[68:71], s27 offen
  s_lshl_b32 s29, s28, 10
  s_add_u32 s31, s29, 4096
  s_cmp_lt_u32 s28, 10
  s_cselect_b32 s31, s31, 0x40000000
  s_waitcnt vmcnt(2)
  s_barrier
  ds_read_b64_tr_b16 a[0:1], v40 offset:0
  ds_read_b64_tr_b16 a[2:3], v40 offset:512
  ds_read_b64_tr_b16 a[32:33], v41 offset:0
  ds_read_b64_tr_b16 a[34:35], v41 offset:512
  ds_read_b64_tr_b16 a[64:65], v42 offset:0
  ds_read_b64_tr_b16 a[66:67], v42 offset:512
  ds_read_b64_tr_b16 a[96:97], v43 offset:0
  ds_read_b64_tr_b16 a[98:99], v43 offset:512
  ds_read_b128 a[128:131], v32 offset:0
  ds_read_b128 a[160:163], v32 offset:2048
  ds_read_b128 a[192:195], v32 offset:16384
  ds_read_b128 a[224:227], v32 offset:18432
  v_lshlrev_b32 v144, 9, v3
  v_lshl_add_u32 v144, v4, 4, v144
  s_add_u32 s53, s52, 73859072
  s_add_u32 s52, s52, 72024064
  v_mov_b32 v136, v128
  v_mov_b32 v140, v129
  v_mov_b32 v137, v130
  v_mov_b32 v141, v131
  v_mov_b32 v138, v132
  v_mov_b32 v142, v133
  v_mov_b32 v139, v134
  v_mov_b32 v143, v135
  buffer_store_dwordx4 v[128:131], v144, s[8:11], s52 offen sc1
  buffer_store_dwordx4 v[132:135], v144, s[8:11], s52 offen offset:256 sc1
  buffer_store_dwordx4 v[136:139], v2, s[8:11], s53 offen sc1
  buffer_store_dwordx4 v[140:143], v2, s[8:11], s53 offen offset:1024 sc1
  s_waitcnt lgkmcnt(0)
  v_mfma_f32_16x16x32_bf16 v[64:67], a[128:131], a[0:3], 0
  ds_read_b64_tr_b16 a[4:5], v40 offset:4096
  ds_read_b64_tr_b16 a[6:7], v40 offset:4608
  v_mfma_f32_16x16x32_bf16 v[68:71], a[160:163], a[0:3], 0
  ds_read_b64_tr_b16 a[36:37], v41 offset:4096
  ds_read_b64_tr_b16 a[38:39], v41 offset:4608
  v_mfma_f32_16x16x32_bf16 v[72:75], a[128:131], a[32:35], 0
  ds_read_b64_tr_b16 a[68:69], v42 offset:4096
  ds_read_b64_tr_b16 a[70:71], v42 offset:4608
  v_mfma_f32_16x16x32_bf16 v[76:79], a[160:163], a[32:35], 0
  ds_read_b64_tr_b16 a[100:101], v43 offset:4096
  ds_read_b64_tr_b16 a[102:103], v43 offset:4608
  v_mfma_f32_16x16x32_bf16 v[80:83], a[128:131], a[64:67], 0
  ds_read_b128 a[132:135], v33 offset:0
  ds_read_b128 a[164:167], v33 offset:2048
  v_mfma_f32_16x16x32_bf16 v[84:87], a[160:163], a[64:67], 0
  ds_read_b128 a[196:199], v33 offset:16384
  ds_read_b128 a[228:231], v33 offset:18432
  v_mfma_f32_16x16x32_bf16 v[88:91], a[128:131], a[96:99], 0
  v_mfma_f32_16x16x32_bf16 v[92:95], a[160:163], a[96:99], 0
  v_mfma_f32_16x16x32_bf16 v[96:99], a[192:195], a[0:3], 0
  v_mfma_f32_16x16x32_bf16 v[100:103], a[224:227], a[0:3], 0
  v_mfma_f32_16x16x32_bf16 v[104:107], a[192:195], a[32:35], 0
  v_mfma_f32_16x16x32_bf16 v[108:111], a[224:227], a[32:35], 0
  v_mfma_f32_16x16x32_bf16 v[112:115], a[192:195], a[64:67], 0
  v_mfma_f32_16x16x32_bf16 v[116:119], a[224:227], a[64:67], 0
  v_mfma_f32_16x16x32_bf16 v[120:123], a[192:195], a[96:99], 0
  v_mfma_f32_16x16x32_bf16 v[124:127], a[224:227], a[96:99], 0
  s_waitcnt lgkmcnt(0)
  v_mfma_f32_16x16x32_bf16 v[64:67], a[132:135], a[4:7], v[64:67]
  ds_read_b64_tr_b16 a[8:9], v40 offset:8192
  ds_read_b64_tr_b16 a[10:11], v40 offset:8704
  v_mfma_f32_16x16x32_bf16 v[68:71], a[164:167], a[4:7], v[68:71]
  ds_read_b64_tr_b16 a[40:41], v41 offset:8192
  ds_read_b64_tr_b16 a[42:43], v41 offset:8704
  v_mfma_f32_16x16x32_bf16 v[72:75], a[132:135], a[36:39], v[72:75]
  ds_read_b64_tr_b16 a[72:73], v42 offset:8192
  ds_read_b64_tr_b16 a[74:75], v42 offset:8704
  v_mfma_f32_16x16x32_bf16 v[76:79], a[164:167], a[36:39], v[76:79]
  ds_read_b64_tr_b16 a[104:105], v43 offset:8192
  ds_read_b64_tr_b16 a[106:107], v43 offset:8704
  v_mfma_f32_16x16x32_bf16 v[80:83], a[132:135], a[68:71], v[80:83]
  ds_read_b128 a[136:139], v34 offset:0
  ds_read_b128 a[168:171], v34 offset:2048
  v_mfma_f32_16x16x32_bf16 v[84:87], a[164:167], a[68:71], v[84:87]
  ds_read_b128 a[200:203], v34 offset:16384
  ds_read_b128 a[232:235], v34 offset:18432
  v_mfma_f32_16x16x32_bf16 v[88:91], a[132:135], a[100:103], v[88:91]
  v_mfma_f32_16x16x32_bf16 v[92:95], a[164:167], a[100:103], v[92:95]
  v_mfma_f32_16x16x32_bf16 v[96:99], a[196:199], a[4:7], v[96:99]
  v_mfma_f32_16x16x32_bf16 v[100:103], a[228:231], a[4:7], v[100:103]
  v_mfma_f32_16x16x32_bf16 v[104:107], a[196:199], a[36:39], v[104:107]
  v_mfma_f32_16x16x32_bf16 v[108:111], a[228:231], a[36:39], v[108:111]
  v_mfma_f32_16x16x32_bf16 v[112:115], a[196:199], a[68:71], v[112:115]
  v_mfma_f32_16x16x32_bf16 v[116:119], a[228:231], a[68:71], v[116:119]
  v_mfma_f32_16x16x32_bf16 v[120:123], a[196:199], a[100:103], v[120:123]
  v_mfma_f32_16x16x32_bf16 v[124:127], a[228:231], a[100:103], v[124:127]
  s_waitcnt lgkmcnt(0)
  v_mfma_f32_16x16x32_bf16 v[64:67], a[136:139], a[8:11], v[64:67]
  ds_read_b64_tr_b16 a[12:13], v40 offset:12288
  ds_read_b64_tr_b16 a[14:15], v40 offset:12800
  v_mfma_f32_16x16x32_bf16 v[68:71], a[168:171], a[8:11], v[68:71]
  ds_read_b64_tr_b16 a[44:45], v41 offset:12288
  ds_read_b64_tr_b16 a[46:47], v41 offset:12800
  v_mfma_f32_16x16x32_bf16 v[72:75], a[136:139], a[40:43], v[72:75]
  ds_read_b64_tr_b16 a[76:77], v42 offset:12288
  ds_read_b64_tr_b16 a[78:79], v42 offset:12800
  v_mfma_f32_16x16x32_bf16 v[76:79], a[168:171], a[40:43], v[76:79]
  ds_read_b64_tr_b16 a[108:109], v43 offset:12288
  ds_read_b64_tr_b16 a[110:111], v43 offset:12800
  v_mfma_f32_16x16x32_bf16 v[80:83], a[136:139], a[72:75], v[80:83]
  ds_read_b128 a[140:143], v35 offset:0
  ds_read_b128 a[172:175], v35 offset:2048
  v_mfma_f32_16x16x32_bf16 v[84:87], a[168:171], a[72:75], v[84:87]
  ds_read_b128 a[204:207], v35 offset:16384
  ds_read_b128 a[236:239], v35 offset:18432
  v_mfma_f32_16x16x32_bf16 v[88:91], a[136:139], a[104:107], v[88:91]
  v_mfma_f32_16x16x32_bf16 v[92:95], a[168:171], a[104:107], v[92:95]
  v_mfma_f32_16x16x32_bf16 v[96:99], a[200:203], a[8:11], v[96:99]
  v_mfma_f32_16x16x32_bf16 v[100:103], a[232:235], a[8:11], v[100:103]
  v_mfma_f32_16x16x32_bf16 v[104:107], a[200:203], a[40:43], v[104:107]
  v_mfma_f32_16x16x32_bf16 v[108:111], a[232:235], a[40:43], v[108:111]
  v_mfma_f32_16x16x32_bf16 v[112:115], a[200:203], a[72:75], v[112:115]
  v_mfma_f32_16x16x32_bf16 v[116:119], a[232:235], a[72:75], v[116:119]
  v_mfma_f32_16x16x32_bf16 v[120:123], a[200:203], a[104:107], v[120:123]
  v_mfma_f32_16x16x32_bf16 v[124:127], a[232:235], a[104:107], v[124:127]
  s_waitcnt lgkmcnt(0)
  v_mfma_f32_16x16x32_bf16 v[64:67], a[140:143], a[12:15], v[64:67]
  ds_read_b64_tr_b16 a[16:17], v40 offset:16384
  ds_read_b64_tr_b16 a[18:19], v40 offset:16896
  v_mfma_f32_16x16x32_bf16 v[68:71], a[172:175], a[12:15], v[68:71]
  ds_read_b64_tr_b16 a[48:49], v41 offset:16384
  ds_read_b64_tr_b16 a[50:51], v41 offset:16896
  v_mfma_f32_16x16x32_bf16 v[72:75], a[140:143], a[44:47], v[72:75]
  ds_read_b64_tr_b16 a[80:81], v42 offset:16384
  ds_read_b64_tr_b16 a[82:83], v42 offset:16896
  v_mfma_f32_16x16x32_bf16 v[76:79], a[172:175], a[44:47], v[76:79]
  ds_read_b64_tr_b16 a[112:113], v43 offset:16384
  ds_read_b64_tr_b16 a[114:115], v43 offset:16896
  v_mfma_f32_16x16x32_bf16 v[80:83], a[140:143], a[76:79], v[80:83]
  ds_read_b128 a[144:147], v32 offset:256
  ds_read_b128 a[176:179], v32 offset:2304
  v_mfma_f32_16x16x32_bf16 v[84:87], a[172:175], a[76:79], v[84:87]
  ds_read_b128 a[208:211], v32 offset:16640
  ds_read_b128 a[240:243], v32 offset:18688
  v_mfma_f32_16x16x32_bf16 v[88:91], a[140:143], a[108:111], v[88:91]
  v_mfma_f32_16x16x32_bf16 v[92:95], a[172:175], a[108:111], v[92:95]
  v_mfma_f32_16x16x32_bf16 v[96:99], a[204:207], a[12:15], v[96:99]
  v_mfma_f32_16x16x32_bf16 v[100:103], a[236:239], a[12:15], v[100:103]
  v_mfma_f32_16x16x32_bf16 v[104:107], a[204:207], a[44:47], v[104:107]
  v_mfma_f32_16x16x32_bf16 v[108:111], a[236:239], a[44:47], v[108:111]
  v_mfma_f32_16x16x32_bf16 v[112:115], a[204:207], a[76:79], v[112:115]
  v_mfma_f32_16x16x32_bf16 v[116:119], a[236:239], a[76:79], v[116:119]
  v_mfma_f32_16x16x32_bf16 v[120:123], a[204:207], a[108:111], v[120:123]
  v_mfma_f32_16x16x32_bf16 v[124:127], a[236:239], a[108:111], v[124:127]
  s_waitcnt lgkmcnt(0)
  v_mfma_f32_16x16x32_bf16 v[64:67], a[144:147], a[16:19], v[64:67]
  ds_read_b64_tr_b16 a[20:21], v40 offset:20480
  ds_read_b64_tr_b16 a[22:23], v40 offset:20992
  v_mfma_f32_16x16x32_bf16 v[68:71], a[176:179], a[16:19], v[68:71]
  ds_read_b64_tr_b16 a[52:53], v41 offset:20480
  ds_read_b64_tr_b16 a[54:55], v41 offset:20992
  v_mfma_f32_16x16x32_bf16 v[72:75], a[144:147], a[48:51], v[72:75]
  ds_read_b64_tr_b16 a[84:85], v42 offset:20480
  ds_read_b64_tr_b16 a[86:87], v42 offset:20992
  v_mfma_f32_16x16x32_bf16 v[76:79], a[176:179], a[48:51], v[76:79]
  ds_read_b64_tr_b16 a[116:117], v43 offset:20480
  ds_read_b64_tr_b16 a[118:119], v43 offset:20992
  v_mfma_f32_16x16x32_bf16 v[80:83], a[144:147], a[80:83], v[80:83]
  ds_read_b128 a[148:151], v33 offset:256
  ds_read_b128 a[180:183], v33 offset:2304
  v_mfma_f32_16x16x32_bf16 v[84:87], a[176:179], a[80:83], v[84:87]
  ds_read_b128 a[212:215], v33 offset:16640
  ds_read_b128 a[244:247], v33 offset:18688
  v_mfma_f32_16x16x32_bf16 v[88:91], a[144:147], a[112:115], v[88:91]
  v_mfma_f32_16x16x32_bf16 v[92:95], a[176:179], a[112:115], v[92:95]
  v_mfma_f32_16x16x32_bf16 v[96:99], a[208:211], a[16:19], v[96:99]
  v_mfma_f32_16x16x32_bf16 v[100:103], a[240:243], a[16:19], v[100:103]
  v_mfma_f32_16x16x32_bf16 v[104:107], a[208:211], a[48:51], v[104:107]
  v_mfma_f32_16x16x32_bf16 v[108:111], a[240:243], a[48:51], v[108:111]
  v_mfma_f32_16x16x32_bf16 v[112:115], a[208:211], a[80:83], v[112:115]
  v_mfma_f32_16x16x32_bf16 v[116:119], a[240:243], a[80:83], v[116:119]
  v_mfma_f32_16x16x32_bf16 v[120:123], a[208:211], a[112:115], v[120:123]
  v_mfma_f32_16x16x32_bf16 v[124:127], a[240:243], a[112:115], v[124:127]
  s_waitcnt lgkmcnt(0)
  v_mfma_f32_16x16x32_bf16 v[64:67], a[148:151], a[20:23], v[64:67]
  ds_read_b64_tr_b16 a[24:25], v40 offset:24576
  ds_read_b64_tr_b16 a[26:27], v40 offset:25088
  v_mfma_f32_16x16x32_bf16 v[68:71], a[180:183], a[20:23], v[68:71]
  ds_read_b64_tr_b16 a[56:57], v41 offset:24576
  ds_read_b64_tr_b16 a[58:59], v41 offset:25088
  v_mfma_f32_16x16x32_bf16 v[72:75], a[148:151], a[52:55], v[72:75]
  ds_read_b64_tr_b16 a[88:89], v42 offset:24576
  ds_read_b64_tr_b16 a[90:91], v42 offset:25088
  v_mfma_f32_16x16x32_bf16 v[76:79], a[180:183], a[52:55], v[76:79]
  ds_read_b64_tr_b16 a[120:121], v43 offset:24576
  ds_read_b64_tr_b16 a[122:123], v43 offset:25088
  v_mfma_f32_16x16x32_bf16 v[80:83], a[148:151], a[84:87], v[80:83]
  ds_read_b128 a[152:155], v34 offset:256
  ds_read_b128 a[184:187], v34 offset:2304
  v_mfma_f32_16x16x32_bf16 v[84:87], a[180:183], a[84:87], v[84:87]
  ds_read_b128 a[216:219], v34 offset:16640
  ds_read_b128 a[248:251], v34 offset:18688
  v_mfma_f32_16x16x32_bf16 v[88:91], a[148:151], a[116:119], v[88:91]
  v_mfma_f32_16x16x32_bf16 v[92:95], a[180:183], a[116:119], v[92:95]
  v_mfma_f32_16x16x32_bf16 v[96:99], a[212:215], a[20:23], v[96:99]
  v_mfma_f32_16x16x32_bf16 v[100:103], a[244:247], a[20:23], v[100:103]
  v_mfma_f32_16x16x32_bf16 v[104:107], a[212:215], a[52:55], v[104:107]
  v_mfma_f32_16x16x32_bf16 v[108:111], a[244:247], a[52:55], v[108:111]
  v_mfma_f32_16x16x32_bf16 v[112:115], a[212:215], a[84:87], v[112:115]
  v_mfma_f32_16x16x32_bf16 v[116:119], a[244:247], a[84:87], v[116:119]
  v_mfma_f32_16x16x32_bf16 v[120:123], a[212:215], a[116:119], v[120:123]
  v_mfma_f32_16x16x32_bf16 v[124:127], a[244:247], a[116:119], v[124:127]
  s_waitcnt lgkmcnt(0)
  v_mfma_f32_16x16x32_bf16 v[64:67], a[152:155], a[24:27], v[64:67]
  ds_read_b64_tr_b16 a[28:29], v40 offset:28672
  ds_read_b64_tr_b16 a[30:31], v40 offset:29184
  v_mfma_f32_16x16x32_bf16 v[68:71], a[184:187], a[24:27], v[68:71]
  ds_read_b64_tr_b16 a[60:61], v41 offset:28672
  ds_read_b64_tr_b16 a[62:63], v41 offset:29184
  v_mfma_f32_16x16x32_bf16 v[72:75], a[152:155], a[56:59], v[72:75]
  ds_read_b64_tr_b16 a[92:93], v42 offset:28672
  ds_read_b64_tr_b16 a[94:95], v42 offset:29184
  v_mfma_f32_16x16x32_bf16 v[76:79], a[184:187], a[56:59], v[76:79]
  ds_read_b64_tr_b16 a[124:125], v43 offset:28672
  ds_read_b64_tr_b16 a[126:127], v43 offset:29184
  v_mfma_f32_16x16x32_bf16 v[80:83], a[152:155], a[88:91], v[80:83]
  ds_read_b128 a[156:159], v35 offset:256
  ds_read_b128 a[188:191], v35 offset:2304
  v_mfma_f32_16x16x32_bf16 v[84:87], a[184:187], a[88:91], v[84:87]
  ds_read_b128 a[220:223], v35 offset:16640
  ds_read_b128 a[252:255], v35 offset:18688
  v_mfma_f32_16x16x32_bf16 v[88:91], a[152:155], a[120:123], v[88:91]
  v_mfma_f32_16x16x32_bf16 v[92:95], a[184:187], a[120:123], v[92:95]
  v_mfma_f32_16x16x32_bf16 v[96:99], a[216:219], a[24:27], v[96:99]
  v_mfma_f32_16x16x32_bf16 v[100:103], a[248:251], a[24:27], v[100:103]
  v_mfma_f32_16x16x32_bf16 v[104:107], a[216:219], a[56:59], v[104:107]
  v_mfma_f32_16x16x32_bf16 v[108:111], a[248:251], a[56:59], v[108:111]
  v_mfma_f32_16x16x32_bf16 v[112:115], a[216:219], a[88:91], v[112:115]
  v_mfma_f32_16x16x32_bf16 v[116:119], a[248:251], a[88:91], v[116:119]
  v_mfma_f32_16x16x32_bf16 v[120:123], a[216:219], a[120:123], v[120:123]
  v_mfma_f32_16x16x32_bf16 v[124:127], a[248:251], a[120:123], v[124:127]
  s_waitcnt lgkmcnt(0)
  s_barrier
  buffer_load_dwordx2 v[254:255], v252, s[12:15], 0 offen offset:128 sc1
  buffer_load_dword v253, v252, s[12:15], 0 offen sc1
  v_mfma_f32_16x16x32_bf16 v[64:67], a[156:159], a[28:31], v[64:67]
  v_mfma_f32_16x16x32_bf16 v[68:71], a[188:191], a[28:31], v[68:71]
  v_mfma_f32_16x16x32_bf16 v[72:75], a[156:159], a[60:63], v[72:75]
  v_mfma_f32_16x16x32_bf16 v[76:79], a[188:191], a[60:63], v[76:79]
  v_mfma_f32_16x16x32_bf16 v[80:83], a[156:159], a[92:95], v[80:83]
  v_cvt_pk_bf16_f32 v64, v64, v65
  v_cvt_pk_bf16_f32 v65, v66, v67
  v_mfma_f32_16x16x32_bf16 v[84:87], a[188:191], a[92:95], v[84:87]
  v_cvt_pk_bf16_f32 v66, v68, v69
  v_cvt_pk_bf16_f32 v67, v70, v71
  v_mfma_f32_16x16x32_bf16 v[88:91], a[156:159], a[124:127], v[88:91]
  buffer_store_dwordx4 v[64:67], v12, s[8:11], s29 offen sc1
  v_cvt_pk_bf16_f32 v72, v72, v73
  v_mfma_f32_16x16x32_bf16 v[92:95], a[188:191], a[124:127], v[92:95]
  v_cvt_pk_bf16_f32 v73, v74, v75
  v_cvt_pk_bf16_f32 v74, v76, v77
  v_mfma_f32_16x16x32_bf16 v[96:99], a[220:223], a[28:31], v[96:99]
  v_cvt_pk_bf16_f32 v75, v78, v79
  buffer_store_dwordx4 v[72:75], v13, s[8:11], s29 offen sc1
  v_mfma_f32_16x16x32_bf16 v[100:103], a[252:255], a[28:31], v[100:103]
  v_cvt_pk_bf16_f32 v80, v80, v81
  v_cvt_pk_bf16_f32 v81, v82, v83
  v_mfma_f32_16x16x32_bf16 v[104:107], a[220:223], a[60:63], v[104:107]
  v_cvt_pk_bf16_f32 v82, v84, v85
  v_cvt_pk_bf16_f32 v83, v86, v87
  v_mfma_f32_16x16x32_bf16 v[108:111], a[252:255], a[60:63], v[108:111]
  buffer_store_dwordx4 v[80:83], v14, s[8:11], s29 offen sc1
  v_cvt_pk_bf16_f32 v88, v88, v89
  v_mfma_f32_16x16x32_bf16 v[112:115], a[220:223], a[92:95], v[112:115]
  v_cvt_pk_bf16_f32 v89, v90, v91
  v_cvt_pk_bf16_f32 v90, v92, v93
  v_mfma_f32_16x16x32_bf16 v[116:119], a[252:255], a[92:95], v[116:119]
  v_cvt_pk_bf16_f32 v91, v94, v95
  buffer_store_dwordx4 v[88:91], v15, s[8:11], s29 offen sc1
  v_mfma_f32_16x16x32_bf16 v[120:123], a[220:223], a[124:127], v[120:123]
  v_cvt_pk_bf16_f32 v96, v96, v97
  v_cvt_pk_bf16_f32 v97, v98, v99
  v_mfma_f32_16x16x32_bf16 v[124:127], a[252:255], a[124:127], v[124:127]
  v_cvt_pk_bf16_f32 v98, v100, v101
  v_cvt_pk_bf16_f32 v99, v102, v103
  buffer_store_dwordx4 v[96:99], v12, s[8:11], s31 offen sc1
  v_cvt_pk_bf16_f32 v104, v104, v105
  v_cvt_pk_bf16_f32 v105, v106, v107
  v_cvt_pk_bf16_f32 v106, v108, v109
  v_cvt_pk_bf16_f32 v107, v110, v111
  buffer_store_dwordx4 v[104:107], v13, s[8:11], s31 offen sc1
  v_cvt_pk_bf16_f32 v112, v112, v113
  v_cvt_pk_bf16_f32 v113, v114, v115
  v_cvt_pk_bf16_f32 v114, v116, v117
  v_cvt_pk_bf16_f32 v115, v118, v119
  buffer_store_dwordx4 v[112:115], v14, s[8:11], s31 offen sc1
  v_cvt_pk_bf16_f32 v120, v120, v121
  v_cvt_pk_bf16_f32 v121, v122, v123
  v_cvt_pk_bf16_f32 v122, v124, v125
  v_cvt_pk_bf16_f32 v123, v126, v127
  buffer_store_dwordx4 v[120:123], v15, s[8:11], s31 offen sc1
  s_cmp_lg_u32 s34, 0
  s_cbranch_scc1 wp_B2
  s_mov_b32 s60, s40
  s_and_b32 s61, s41, 0xffff
  s_mov_b32 s62, 3670016
  s_mov_b32 s63, 0x20000
  s_mov_b32 s56, s42
  s_and_b32 s57, s43, 0xffff
  s_mov_b32 s58, 3670016
  s_mov_b32 s59, 0x20000
  s_lshl_b32 s27, s18, 2
  s_add_u32 s27, s27, s16
  s_lshl_b32 s27, s27, 17
  s_add_u32 s27, s27, s26
  s_lshl_b32 s30, s16, 13
  s_add_u32 m0, s30, 0
  s_nop 0
  buffer_load_dwordx4 v26, s[56:59], s27 offen  lds
  s_add_u32 s27, s27, 16384
  s_add_u32 m0, s30, 1024
  s_nop 0
  buffer_load_dwordx4 v26, s[56:59], s27 offen  lds
  s_add_u32 s27, s27, 16384
  s_add_u32 m0, s30, 2048
  s_nop 0
  buffer_load_dwordx4 v27, s[56:59], s27 offen  lds
  s_add_u32 s27, s27, 16384
  s_add_u32 m0, s30, 3072
  s_nop 0
  buffer_load_dwordx4 v27, s[56:59], s27 offen  lds
  s_add_u32 s27, s27, 16384
  s_add_u32 m0, s30, 4096
  s_nop 0
  buffer_load_dwordx4 v26, s[56:59], s27 offen  lds
  s_add_u32 s27, s27, 16384
  s_add_u32 m0, s30, 5120
  s_nop 0
  buffer_load_dwordx4 v26, s[56:59], s27 offen  lds
  s_add_u32 s27, s27, 16384
  s_add_u32 m0, s30, 6144
  s_nop 0
  buffer_load_dwordx4 v27, s[56:59], s27 offen  lds
  s_add_u32 s27, s27, 16384
  s_add_u32 m0, s30, 7168
  s_nop 0
  buffer_load_dwordx4 v27, s[56:59], s27 offen  lds
  s_add_u32 s27, s27, 16384
  s_add_u32 s27, s28, 0
  s_min_u32 s27, s27, 13
  s_lshl_b32 s27, s27, 18
  s_add_u32 s27, s27, s26
  s_add_u32 m0, s25, 0
  s_nop 0
  buffer_load_dwordx4 v16, s[60:63], s27 offen  lds
  s_add_u32 s27, s27, 16384
  s_add_u32 m0, s25, 1024
  s_nop 0
  buffer_load_dwordx4 v17, s[60:63], s27 offen  lds
  s_add_u32 s27, s27, 16384
  s_add_u32 m0, s25, 2048
  s_nop 0
  buffer_load_dwordx4 v16, s[60:63], s27 offen  lds
  s_add_u32 s27, s27, 16384
  s_add_u32 m0, s25, 3072
  s_nop 0
  buffer_load_dwordx4 v17, s[60:63], s27 offen  lds
  s_add_u32 s27, s27, 16384
  s_waitcnt vmcnt(12)
  s_barrier
  s_cmp_lg_u32 s16, 0
  s_cbranch_scc1 wp_f1_f
  v_readfirstlane_b32 s20, v254
  s_cmp_eq_u32 s20, 1
  s_cbranch_scc1 wp_f1_w_ok
  s_mov_b32 s30, 0
wp_f1_w:
  buffer_load_dword v254, off, s[12:15], 0 offset:128 sc1
  s_waitcnt vmcnt(0)
  v_cmp_ne_u32 vcc, 1, v254
  s_cbranch_vccz wp_f1_w_ok
  s_sleep 8
  s_add_u32 s30, s30, 1
  s_cmp_lt_u32 s30, 16
  s_cbranch_scc1 wp_f1_w
  s_branch wp_f1_f
wp_f1_w_ok:
  s_lshl_b32 s20, s17, 7
  s_add_u32 s20, s20, 88519168
  s_lshl_b32 s21, 1, s19
  v_mov_b32 v248, s21
  s_mov_b64 exec, 1
  buffer_atomic_or v248, v252, s[8:11], s20 offen sc0
  s_mov_b64 exec, -1
  s_mov_b32 s37, s21
wp_f1_f:
  s_add_u32 m0, s25, 4096
  s_nop 0
  buffer_load_dwordx4 v18, s[60:63], s27 offen  lds
  s_add_u32 s27, s27, 16384
  s_add_u32 m0, s25, 5120
  s_nop 0
  buffer_load_dwordx4 v19, s[60:63], s27 offen  lds
  s_add_u32 s27, s27, 16384
  s_add_u32 m0, s25, 6144
  s_nop 0
  buffer_load_dwordx4 v18, s[60:63], s27 offen  lds
  s_add_u32 s27, s27, 16384
  s_add_u32 m0, s25, 7168
  s_nop 0
  buffer_load_dwordx4 v19, s[60:63], s27 offen  lds
  s_add_u32 s27, s27, 16384
  s_add_u32 m0, s25, 8192
  s_nop 0
  buffer_load_dwordx4 v20, s[60:63], s27 offen  lds
  s_add_u32 s27, s27, 16384
  s_add_u32 m0, s25, 9216
  s_nop 0
  buffer_load_dwordx4 v21, s[60:63], s27 offen  lds
  s_add_u32 s27, s27, 16384
  s_add_u32 m0, s25, 10240
  s_nop 0
  buffer_load_dwordx4 v20, s[60:63], s27 offen  lds
  s_add_u32 s27, s27, 16384
  s_add_u32 m0, s25, 11264
  s_nop 0
  buffer_load_dwordx4 v21, s[60:63], s27 offen  lds
  s_add_u32 s27, s27, 16384
  s_add_u32 m0, s25, 12288
  s_nop 0
  buffer_load_dwordx4 v22, s[60:63], s27 offen  lds
  s_add_u32 s27, s27, 16384
  s_add_u32 m0, s25, 13312
  s_nop 0
  buffer_load_dwordx4 v23, s[60:63], s27 offen  lds
  s_add_u32 s27, s27, 16384
  s_add_u32 m0, s25, 14336
  s_nop 0
  buffer_load_dwordx4 v22, s[60:63], s27 offen  lds
  s_add_u32 s27, s27, 16384
  s_add_u32 m0, s25, 15360
  s_nop 0
  buffer_load_dwordx4 v23, s[60:63], s27 offen  lds
  s_add_u32 s27, s27, 16384
  s_add_u32 s27, s28, 4
  s_min_u32 s27, s27, 13
  s_lshl_b32 s27, s27, 18
  s_add_u32 s27, s27, s26
  s_waitcnt vmcnt(12)
  v_readfirstlane_b32 s20, v248
  s_and_b32 s20, s20, 16383
  s_xor_b32 s20, s20, s37
  s_cmp_lg_u32 s20, 16383
  s_cselect_b32 s20, 0, s37
  s_mov_b32 s37, 0
  s_cmp_eq_u32 s20, 0
  s_cbranch_scc1 wp_g1
  s_lshl_b32 s21, 1, s17
  v_mov_b32 v248, s21
  s_mov_b32 s20, 88523264
  v_lshlrev_b32 v247, 7, v0
  s_mov_b64 exec, 0xff
  buffer_atomic_or v248, v247, s[8:11], s20 offen
  s_mov_b64 exec, -1
wp_g1:
  s_add_u32 m0, s25, 16384
  s_nop 0
  buffer_load_dwordx4 v16, s[60:63], s27 offen  lds
  s_add_u32 s27, s27, 16384
  s_add_u32 m0, s25, 17408
  s_nop 0
  buffer_load_dwordx4 v17, s[60:63], s27 offen  lds
  s_add_u32 s27, s27, 16384
  s_add_u32 m0, s25, 18432
  s_nop 0
  buffer_load_dwordx4 v16, s[60:63], s27 offen  lds
  s_add_u32 s27, s27, 16384
  s_add_u32 m0, s25, 19456
  s_nop 0
  buffer_load_dwordx4 v17, s[60:63], s27 offen  lds
  s_add_u32 s27, s27, 16384
  s_add_u32 m0, s25, 20480
  s_nop 0
  buffer_load_dwordx4 v18, s[60:63], s27 offen  lds
  s_add_u32 s27, s27, 16384
  s_add_u32 m0, s25, 21504
  s_nop 0
  buffer_load_dwordx4 v19, s[60:63], s27 offen  lds
  s_add_u32 s27, s27, 16384
  s_add_u32 m0, s25, 22528
  s_nop 0
  buffer_load_dwordx4 v18, s[60:63], s27 offen  lds
  s_add_u32 s27, s27, 16384
  s_add_u32 m0, s25, 23552
  s_nop 0
  buffer_load_dwordx4 v19, s[60:63], s27 offen  lds
  s_add_u32 s27, s27, 16384
  s_add_u32 m0, s25, 24576
  s_nop 0
  buffer_load_dwordx4 v20, s[60:63], s27 offen  lds
  s_add_u32 s27, s27, 16384
  s_add_u32 m0, s25, 25600
  s_nop 0
  buffer_load_dwordx4 v21, s[60:63], s27 offen  lds
  s_add_u32 s27, s27, 16384
  s_add_u32 m0, s25, 26624
  s_nop 0
  buffer_load_dwordx4 v20, s[60:63], s27 offen  lds
  s_add_u32 s27, s27, 16384
  s_add_u32 m0, s25, 27648
  s_nop 0
  buffer_load_dwordx4 v21, s[60:63], s27 offen  lds
  s_add_u32 s27, s27, 16384
  s_add_u32 m0, s25, 28672
  s_nop 0
  buffer_load_dwordx4 v22, s[60:63], s27 offen  lds
  s_add_u32 s27, s27, 16384
  s_add_u32 m0, s25, 29696
  s_nop 0
  buffer_load_dwordx4 v23, s[60:63], s27 offen  lds
  s_add_u32 s27, s27, 16384
  s_add_u32 m0, s25, 30720
  s_nop 0
  buffer_load_dwordx4 v22, s[60:63], s27 offen  lds
  s_add_u32 s27, s27, 16384
  s_add_u32 m0, s25, 31744
  s_nop 0
  buffer_load_dwordx4 v23, s[60:63], s27 offen  lds
  s_add_u32 s27, s27, 16384
  s_branch wp_A
wp_B2:
  v_lshlrev_b32 v6, 7, v1
  s_getpc_b64 s[98:99]
ct_6:
  s_add_u32 s98, s98, wp_fin-ct_6
  s_addc_u32 s99, s99, 0
  global_load_dword v7, v6, s[98:99]
  s_getpc_b64 s[98:99]
ct_7:
  s_add_u32 s98, s98, wg_vo-ct_7
  s_addc_u32 s99, s99, 0
  global_load_dword v7, v6, s[98:99]
  s_waitcnt vmcnt(2)
  s_barrier
  s_cmp_lg_u32 s16, 0
  s_cbranch_scc1 wp_f2_f
  v_readfirstlane_b32 s20, v254
  s_cmp_eq_u32 s20, 1
  s_cbranch_scc1 wp_f2_w_ok
  s_mov_b32 s30, 0
wp_f2_w:
  buffer_load_dword v254, off, s[12:15], 0 offset:128 sc1
  s_waitcnt vmcnt(0)
  v_cmp_ne_u32 vcc, 1, v254
  s_cbranch_vccz wp_f2_w_ok
  s_sleep 8
  s_add_u32 s30, s30, 1
  s_cmp_lt_u32 s30, 16
  s_cbranch_scc1 wp_f2_w
  s_branch wp_f2_f
wp_f2_w_ok:
  s_lshl_b32 s20, s17, 7
  s_add_u32 s20, s20, 88519168
  s_lshl_b32 s21, 1, s19
  v_mov_b32 v248, s21
  s_mov_b64 exec, 1
  buffer_atomic_or v248, v252, s[8:11], s20 offen sc0
  s_mov_b64 exec, -1
  s_mov_b32 s37, s21
wp_f2_f:
  s_cmp_eq_u32 s97, 0
  s_cselect_b32 s39, -4, s39
  s_branch wp_fin
wp_A0:
  s_mov_b32 s60, s40
  s_and_b32 s61, s41, 0xffff
  s_mov_b32 s62, 3670016
  s_mov_b32 s63, 0x20000
  s_mov_b32 s56, s42
  s_and_b32 s57, s43, 0xffff
  s_mov_b32 s58, 3670016
  s_mov_b32 s59, 0x20000
  s_lshl_b32 s27, s18, 2
  s_add_u32 s27, s27, s16
  s_lshl_b32 s27, s27, 17
  s_add_u32 s27, s27, s26
  s_lshl_b32 s30, s16, 13
  s_add_u32 m0, s30, 0
  s_nop 0
  buffer_load_dwordx4 v26, s[56:59], s27 offen  lds
  s_add_u32 s27, s27, 16384
  s_add_u32 m0, s30, 1024
  s_nop 0
  buffer_load_dwordx4 v26, s[56:59], s27 offen  lds
  s_add_u32 s27, s27, 16384
  s_add_u32 m0, s30, 2048
  s_nop 0
  buffer_load_dwordx4 v27, s[56:59], s27 offen  lds
  s_add_u32 s27, s27, 16384
  s_add_u32 m0, s30, 3072
  s_nop 0
  buffer_load_dwordx4 v27, s[56:59], s27 offen  lds
  s_add_u32 s27, s27, 16384
  s_add_u32 m0, s30, 4096
  s_nop 0
  buffer_load_dwordx4 v26, s[56:59], s27 offen  lds
  s_add_u32 s27, s27, 16384
  s_add_u32 m0, s30, 5120
  s_nop 0
  buffer_load_dwordx4 v26, s[56:59], s27 offen  lds
  s_add_u32 s27, s27, 16384
  s_add_u32 m0, s30, 6144
  s_nop 0
  buffer_load_dwordx4 v27, s[56:59], s27 offen  lds
  s_add_u32 s27, s27, 16384
  s_add_u32 m0, s30, 7168
  s_nop 0
  buffer_load_dwordx4 v27, s[56:59], s27 offen  lds
  s_add_u32 s27, s27, 16384
  s_add_u32 s27, s28, 0
  s_min_u32 s27, s27, 13
  s_lshl_b32 s27, s27, 18
  s_add_u32 s27, s27, s26
  s_add_u32 m0, s25, 0
  s_nop 0
  buffer_load_dwordx4 v16, s[60:63], s27 offen  lds
  s_add_u32 s27, s27, 16384
  s_add_u32 m0, s25, 1024
  s_nop 0
  buffer_load_dwordx4 v17, s[60:63], s27 offen  lds
  s_add_u32 s27, s27, 16384
  s_add_u32 m0, s25, 2048
  s_nop 0
  buffer_load_dwordx4 v16, s[60:63], s27 offen  lds
  s_add_u32 s27, s27, 16384
  s_add_u32 m0, s25, 3072
  s_nop 0
  buffer_load_dwordx4 v17, s[60:63], s27 offen  lds
  s_add_u32 s27, s27, 16384
  s_add_u32 m0, s25, 4096
  s_nop 0
  buffer_load_dwordx4 v18, s[60:63], s27 offen  lds
  s_add_u32 s27, s27, 16384
  s_add_u32 m0, s25, 5120
  s_nop 0
  buffer_load_dwordx4 v19, s[60:63], s27 offen  lds
  s_add_u32 s27, s27, 16384
  s_add_u32 m0, s25, 6144
  s_nop 0
  buffer_load_dwordx4 v18, s[60:63], s27 offen  lds
  s_add_u32 s27, s27, 16384
  s_add_u32 m0, s25, 7168
  s_nop 0
  buffer_load_dwordx4 v19, s[60:63], s27 offen  lds
  s_add_u32 s27, s27, 16384
  s_add_u32 m0, s25, 8192
  s_nop 0
  buffer_load_dwordx4 v20, s[60:63], s27 offen  lds
  s_add_u32 s27, s27, 16384
  s_add_u32 m0, s25, 9216
  s_nop 0
  buffer_load_dwordx4 v21, s[60:63], s27 offen  lds
  s_add_u32 s27, s27, 16384
  s_add_u32 m0, s25, 10240
  s_nop 0
  buffer_load_dwordx4 v20, s[60:63], s27 offen  lds
  s_add_u32 s27, s27, 16384
  s_add_u32 m0, s25, 11264
  s_nop 0
  buffer_load_dwordx4 v21, s[60:63], s27 offen  lds
  s_add_u32 s27, s27, 16384
  s_add_u32 m0, s25, 12288
  s_nop 0
  buffer_load_dwordx4 v22, s[60:63], s27 offen  lds
  s_add_u32 s27, s27, 16384
  s_add_u32 m0, s25, 13312
  s_nop 0
  buffer_load_dwordx4 v23, s[60:63], s27 offen  lds
  s_add_u32 s27, s27, 16384
  s_add_u32 m0, s25, 14336
  s_nop 0
  buffer_load_dwordx4 v22, s[60:63], s27 offen  lds
  s_add_u32 s27, s27, 16384
  s_add_u32 m0, s25, 15360
  s_nop 0
  buffer_load_dwordx4 v23, s[60:63], s27 offen  lds
  s_add_u32 s27, s27, 16384
  s_add_u32 s27, s28, 4
  s_min_u32 s27, s27, 13
  s_lshl_b32 s27, s27, 18
  s_add_u32 s27, s27, s26
  s_add_u32 m0, s25, 16384
  s_nop 0
  buffer_load_dwordx4 v16, s[60:63], s27 offen  lds
  s_add_u32 s27, s27, 16384
  s_add_u32 m0, s25, 17408
  s_nop 0
  buffer_load_dwordx4 v17, s[60:63], s27 offen  lds
  s_add_u32 s27, s27, 16384
  s_add_u32 m0, s25, 18432
  s_nop 0
  buffer_load_dwordx4 v16, s[60:63], s27 offen  lds
  s_add_u32 s27, s27, 16384
  s_add_u32 m0, s25, 19456
  s_nop 0
  buffer_load_dwordx4 v17, s[60:63], s27 offen  lds
  s_add_u32 s27, s27, 16384
  s_add_u32 m0, s25, 20480
  s_nop 0
  buffer_load_dwordx4 v18, s[60:63], s27 offen  lds
  s_add_u32 s27, s27, 16384
  s_add_u32 m0, s25, 21504
  s_nop 0
  buffer_load_dwordx4 v19, s[60:63], s27 offen  lds
  s_add_u32 s27, s27, 16384
  s_add_u32 m0, s25, 22528
  s_nop 0
  buffer_load_dwordx4 v18, s[60:63], s27 offen  lds
  s_add_u32 s27, s27, 16384
  s_add_u32 m0, s25, 23552
  s_nop 0
  buffer_load_dwordx4 v19, s[60:63], s27 offen  lds
  s_add_u32 s27, s27, 16384
  s_add_u32 m0, s25, 24576
  s_nop 0
  buffer_load_dwordx4 v20, s[60:63], s27 offen  lds
  s_add_u32 s27, s27, 16384
  s_add_u32 m0, s25, 25600
  s_nop 0
  buffer_load_dwordx4 v21, s[60:63], s27 offen  lds
  s_add_u32 s27, s27, 16384
  s_add_u32 m0, s25, 26624
  s_nop 0
  buffer_load_dwordx4 v20, s[60:63], s27 offen  lds
  s_add_u32 s27, s27, 16384
  s_add_u32 m0, s25, 27648
  s_nop 0
  buffer_load_dwordx4 v21, s[60:63], s27 offen  lds
  s_add_u32 s27, s27, 16384
  s_add_u32 m0, s25, 28672
  s_nop 0
  buffer_load_dwordx4 v22, s[60:63], s27 offen  lds
  s_add_u32 s27, s27, 16384
  s_add_u32 m0, s25, 29696
  s_nop 0
  buffer_load_dwordx4 v23, s[60:63], s27 offen  lds
  s_add_u32 s27, s27, 16384
  s_add_u32 m0, s25, 30720
  s_nop 0
  buffer_load_dwordx4 v22, s[60:63], s27 offen  lds
  s_add_u32 s27, s27, 16384
  s_add_u32 m0, s25, 31744
  s_nop 0
  buffer_load_dwordx4 v23, s[60:63], s27 offen  lds
  s_add_u32 s27, s27, 16384
  v_lshrrev_b32 v7, 2, v4
  v_lshlrev_b32 v11, 4, v7
  v_lshlrev_b32 v7, 3, v7
  v_and_b32 v8, 3, v4
  v_add_u32 v7, v7, v8
  v_and_b32 v8, 2, v4
  v_lshl_add_u32 v11, v8, 1, v11
  v_and_b32 v8, 1, v4
  v_add_u32 v11, v11, v8
  v_or_b32 v10, 0, v3
  v_xor_b32 v10, v10, v4
  v_lshlrev_b32 v10, 4, v10
  v_lshl_add_u32 v44, v11, 9, v10
  v_lshl_add_u32 v10, v7, 9, v10
  v_add_u32 v32, s25, v10
  v_or_b32 v10, 4, v3
  v_xor_b32 v10, v10, v4
  v_lshlrev_b32 v10, 4, v10
  v_lshl_add_u32 v45, v11, 9, v10
  v_lshl_add_u32 v10, v7, 9, v10
  v_add_u32 v33, s25, v10
  v_or_b32 v10, 8, v3
  v_xor_b32 v10, v10, v4
  v_lshlrev_b32 v10, 4, v10
  v_lshl_add_u32 v46, v11, 9, v10
  v_lshl_add_u32 v10, v7, 9, v10
  v_add_u32 v34, s25, v10
  v_or_b32 v10, 12, v3
  v_xor_b32 v10, v10, v4
  v_lshlrev_b32 v10, 4, v10
  v_lshl_add_u32 v47, v11, 9, v10
  v_lshl_add_u32 v10, v7, 9, v10
  v_add_u32 v35, s25, v10
  s_mul_i32 s30, s17, 401408
  s_mul_i32 s31, s18, 57344
  s_add_u32 s30, s30, s31
  s_add_u32 s30, s30, 0
  v_add_u32 v28, s30, v2
  s_add_u32 s30, s30, 14336
  v_add_u32 v29, s30, v2
  s_add_u32 s30, s30, 14336
  v_add_u32 v30, s30, v2
  s_add_u32 s30, s30, 14336
  v_add_u32 v31, s30, v2
  s_add_u32 s30, s30, 14336
  v_mov_b32 v48, 1035512379
wp_A:
  s_lshl_b32 s29, s28, 10
  s_add_u32 s31, s29, 4096
  s_cmp_lt_u32 s28, 10
  s_cselect_b32 s31, s31, 0x40000000
  s_waitcnt vmcnt(0)
  s_barrier
  ds_read_b128 a[0:3], v44 offset:0
  ds_read_b128 a[32:35], v44 offset:1024
  ds_read_b128 a[64:67], v44 offset:4096
  ds_read_b128 a[96:99], v44 offset:5120
  ds_read_b128 a[128:131], v32 offset:0
  ds_read_b128 a[160:163], v32 offset:2048
  ds_read_b128 a[192:195], v32 offset:16384
  ds_read_b128 a[224:227], v32 offset:18432
  s_waitcnt lgkmcnt(0)
  v_mfma_f32_16x16x32_bf16 v[64:67], a[128:131], a[0:3], 0
  ds_read_b128 a[4:7], v45 offset:0
  ds_read_b128 a[36:39], v45 offset:1024
  v_mfma_f32_16x16x32_bf16 v[68:71], a[160:163], a[0:3], 0
  ds_read_b128 a[68:71], v45 offset:4096
  ds_read_b128 a[100:103], v45 offset:5120
  v_mfma_f32_16x16x32_bf16 v[72:75], a[128:131], a[32:35], 0
  ds_read_b128 a[132:135], v33 offset:0
  ds_read_b128 a[164:167], v33 offset:2048
  v_mfma_f32_16x16x32_bf16 v[76:79], a[160:163], a[32:35], 0
  ds_read_b128 a[196:199], v33 offset:16384
  ds_read_b128 a[228:231], v33 offset:18432
  v_mfma_f32_16x16x32_bf16 v[80:83], a[128:131], a[64:67], 0
  v_mfma_f32_16x16x32_bf16 v[84:87], a[160:163], a[64:67], 0
  v_mfma_f32_16x16x32_bf16 v[88:91], a[128:131], a[96:99], 0
  v_mfma_f32_16x16x32_bf16 v[92:95], a[160:163], a[96:99], 0
  v_mfma_f32_16x16x32_bf16 v[96:99], a[192:195], a[0:3], 0
  v_mfma_f32_16x16x32_bf16 v[100:103], a[224:227], a[0:3], 0
  v_mfma_f32_16x16x32_bf16 v[104:107], a[192:195], a[32:35], 0
  v_mfma_f32_16x16x32_bf16 v[108:111], a[224:227], a[32:35], 0
  v_mfma_f32_16x16x32_bf16 v[112:115], a[192:195], a[64:67], 0
  v_mfma_f32_16x16x32_bf16 v[116:119], a[224:227], a[64:67], 0
  v_mfma_f32_16x16x32_bf16 v[120:123], a[192:195], a[96:99], 0
  v_mfma_f32_16x16x32_bf16 v[124:127], a[224:227], a[96:99], 0
  s_waitcnt lgkmcnt(0)
  v_mfma_f32_16x16x32_bf16 v[64:67], a[132:135], a[4:7], v[64:67]
  ds_read_b128 a[8:11], v46 offset:0
  ds_read_b128 a[40:43], v46 offset:1024
  v_mfma_f32_16x16x32_bf16 v[68:71], a[164:167], a[4:7], v[68:71]
  ds_read_b128 a[72:75], v46 offset:4096
  ds_read_b128 a[104:107], v46 offset:5120
  v_mfma_f32_16x16x32_bf16 v[72:75], a[132:135], a[36:39], v[72:75]
  ds_read_b128 a[136:139], v34 offset:0
  ds_read_b128 a[168:171], v34 offset:2048
  v_mfma_f32_16x16x32_bf16 v[76:79], a[164:167], a[36:39], v[76:79]
  ds_read_b128 a[200:203], v34 offset:16384
  ds_read_b128 a[232:235], v34 offset:18432
  v_mfma_f32_16x16x32_bf16 v[80:83], a[132:135], a[68:71], v[80:83]
  v_mfma_f32_16x16x32_bf16 v[84:87], a[164:167], a[68:71], v[84:87]
  v_mfma_f32_16x16x32_bf16 v[88:91], a[132:135], a[100:103], v[88:91]
  v_mfma_f32_16x16x32_bf16 v[92:95], a[164:167], a[100:103], v[92:95]
  v_mfma_f32_16x16x32_bf16 v[96:99], a[196:199], a[4:7], v[96:99]
  v_mfma_f32_16x16x32_bf16 v[100:103], a[228:231], a[4:7], v[100:103]
  v_mfma_f32_16x16x32_bf16 v[104:107], a[196:199], a[36:39], v[104:107]
  v_mfma_f32_16x16x32_bf16 v[108:111], a[228:231], a[36:39], v[108:111]
  v_mfma_f32_16x16x32_bf16 v[112:115], a[196:199], a[68:71], v[112:115]
  v_mfma_f32_16x16x32_bf16 v[116:119], a[228:231], a[68:71], v[116:119]
  v_mfma_f32_16x16x32_bf16 v[120:123], a[196:199], a[100:103], v[120:123]
  v_mfma_f32_16x16x32_bf16 v[124:127], a[228:231], a[100:103], v[124:127]
  s_waitcnt lgkmcnt(0)
  v_mfma_f32_16x16x32_bf16 v[64:67], a[136:139], a[8:11], v[64:67]
  ds_read_b128 a[12:15], v47 offset:0
  ds_read_b128 a[44:47], v47 offset:1024
  v_mfma_f32_16x16x32_bf16 v[68:71], a[168:171], a[8:11], v[68:71]
  ds_read_b128 a[76:79], v47 offset:4096
  ds_read_b128 a[108:111], v47 offset:5120
  v_mfma_f32_16x16x32_bf16 v[72:75], a[136:139], a[40:43], v[72:75]
  ds_read_b128 a[140:143], v35 offset:0
  ds_read_b128 a[172:175], v35 offset:2048
  v_mfma_f32_16x16x32_bf16 v[76:79], a[168:171], a[40:43], v[76:79]
  ds_read_b128 a[204:207], v35 offset:16384
  ds_read_b128 a[236:239], v35 offset:18432
  v_mfma_f32_16x16x32_bf16 v[80:83], a[136:139], a[72:75], v[80:83]
  v_mfma_f32_16x16x32_bf16 v[84:87], a[168:171], a[72:75], v[84:87]
  v_mfma_f32_16x16x32_bf16 v[88:91], a[136:139], a[104:107], v[88:91]
  v_mfma_f32_16x16x32_bf16 v[92:95], a[168:171], a[104:107], v[92:95]
  v_mfma_f32_16x16x32_bf16 v[96:99], a[200:203], a[8:11], v[96:99]
  v_mfma_f32_16x16x32_bf16 v[100:103], a[232:235], a[8:11], v[100:103]
  v_mfma_f32_16x16x32_bf16 v[104:107], a[200:203], a[40:43], v[104:107]
  v_mfma_f32_16x16x32_bf16 v[108:111], a[232:235], a[40:43], v[108:111]
  v_mfma_f32_16x16x32_bf16 v[112:115], a[200:203], a[72:75], v[112:115]
  v_mfma_f32_16x16x32_bf16 v[116:119], a[232:235], a[72:75], v[116:119]
  v_mfma_f32_16x16x32_bf16 v[120:123], a[200:203], a[104:107], v[120:123]
  v_mfma_f32_16x16x32_bf16 v[124:127], a[232:235], a[104:107], v[124:127]
  s_waitcnt lgkmcnt(0)
  v_mfma_f32_16x16x32_bf16 v[64:67], a[140:143], a[12:15], v[64:67]
  ds_read_b128 a[16:19], v44 offset:256
  ds_read_b128 a[48:51], v44 offset:1280
  v_mfma_f32_16x16x32_bf16 v[68:71], a[172:175], a[12:15], v[68:71]
  ds_read_b128 a[80:83], v44 offset:4352
  ds_read_b128 a[112:115], v44 offset:5376
  v_mfma_f32_16x16x32_bf16 v[72:75], a[140:143], a[44:47], v[72:75]
  ds_read_b128 a[144:147], v32 offset:256
  ds_read_b128 a[176:179], v32 offset:2304
  v_mfma_f32_16x16x32_bf16 v[76:79], a[172:175], a[44:47], v[76:79]
  ds_read_b128 a[208:211], v32 offset:16640
  ds_read_b128 a[240:243], v32 offset:18688
  v_mfma_f32_16x16x32_bf16 v[80:83], a[140:143], a[76:79], v[80:83]
  v_mfma_f32_16x16x32_bf16 v[84:87], a[172:175], a[76:79], v[84:87]
  v_mfma_f32_16x16x32_bf16 v[88:91], a[140:143], a[108:111], v[88:91]
  v_mfma_f32_16x16x32_bf16 v[92:95], a[172:175], a[108:111], v[92:95]
  v_mfma_f32_16x16x32_bf16 v[96:99], a[204:207], a[12:15], v[96:99]
  v_mfma_f32_16x16x32_bf16 v[100:103], a[236:239], a[12:15], v[100:103]
  v_mfma_f32_16x16x32_bf16 v[104:107], a[204:207], a[44:47], v[104:107]
  v_mfma_f32_16x16x32_bf16 v[108:111], a[236:239], a[44:47], v[108:111]
  v_mfma_f32_16x16x32_bf16 v[112:115], a[204:207], a[76:79], v[112:115]
  v_mfma_f32_16x16x32_bf16 v[116:119], a[236:239], a[76:79], v[116:119]
  v_mfma_f32_16x16x32_bf16 v[120:123], a[204:207], a[108:111], v[120:123]
  v_mfma_f32_16x16x32_bf16 v[124:127], a[236:239], a[108:111], v[124:127]
  s_waitcnt lgkmcnt(0)
  v_mfma_f32_16x16x32_bf16 v[64:67], a[144:147], a[16:19], v[64:67]
  ds_read_b128 a[20:23], v45 offset:256
  ds_read_b128 a[52:55], v45 offset:1280
  v_mfma_f32_16x16x32_bf16 v[68:71], a[176:179], a[16:19], v[68:71]
  ds_read_b128 a[84:87], v45 offset:4352
  ds_read_b128 a[116:119], v45 offset:5376
  v_mfma_f32_16x16x32_bf16 v[72:75], a[144:147], a[48:51], v[72:75]
  ds_read_b128 a[148:151], v33 offset:256
  ds_read_b128 a[180:183], v33 offset:2304
  v_mfma_f32_16x16x32_bf16 v[76:79], a[176:179], a[48:51], v[76:79]
  ds_read_b128 a[212:215], v33 offset:16640
  ds_read_b128 a[244:247], v33 offset:18688
  v_mfma_f32_16x16x32_bf16 v[80:83], a[144:147], a[80:83], v[80:83]
  v_mfma_f32_16x16x32_bf16 v[84:87], a[176:179], a[80:83], v[84:87]
  v_mfma_f32_16x16x32_bf16 v[88:91], a[144:147], a[112:115], v[88:91]
  v_mfma_f32_16x16x32_bf16 v[92:95], a[176:179], a[112:115], v[92:95]
  v_mfma_f32_16x16x32_bf16 v[96:99], a[208:211], a[16:19], v[96:99]
  v_mfma_f32_16x16x32_bf16 v[100:103], a[240:243], a[16:19], v[100:103]
  v_mfma_f32_16x16x32_bf16 v[104:107], a[208:211], a[48:51], v[104:107]
  v_mfma_f32_16x16x32_bf16 v[108:111], a[240:243], a[48:51], v[108:111]
  v_mfma_f32_16x16x32_bf16 v[112:115], a[208:211], a[80:83], v[112:115]
  v_mfma_f32_16x16x32_bf16 v[116:119], a[240:243], a[80:83], v[116:119]
  v_mfma_f32_16x16x32_bf16 v[120:123], a[208:211], a[112:115], v[120:123]
  v_mfma_f32_16x16x32_bf16 v[124:127], a[240:243], a[112:115], v[124:127]
  s_waitcnt lgkmcnt(0)
  v_mfma_f32_16x16x32_bf16 v[64:67], a[148:151], a[20:23], v[64:67]
  ds_read_b128 a[24:27], v46 offset:256
  ds_read_b128 a[56:59], v46 offset:1280
  v_mfma_f32_16x16x32_bf16 v[68:71], a[180:183], a[20:23], v[68:71]
  ds_read_b128 a[88:91], v46 offset:4352
  ds_read_b128 a[120:123], v46 offset:5376
  v_mfma_f32_16x16x32_bf16 v[72:75], a[148:151], a[52:55], v[72:75]
  ds_read_b128 a[152:155], v34 offset:256
  ds_read_b128 a[184:187], v34 offset:2304
  v_mfma_f32_16x16x32_bf16 v[76:79], a[180:183], a[52:55], v[76:79]
  ds_read_b128 a[216:219], v34 offset:16640
  ds_read_b128 a[248:251], v34 offset:18688
  v_mfma_f32_16x16x32_bf16 v[80:83], a[148:151], a[84:87], v[80:83]
  v_mfma_f32_16x16x32_bf16 v[84:87], a[180:183], a[84:87], v[84:87]
  v_mfma_f32_16x16x32_bf16 v[88:91], a[148:151], a[116:119], v[88:91]
  v_mfma_f32_16x16x32_bf16 v[92:95], a[180:183], a[116:119], v[92:95]
  v_mfma_f32_16x16x32_bf16 v[96:99], a[212:215], a[20:23], v[96:99]
  v_mfma_f32_16x16x32_bf16 v[100:103], a[244:247], a[20:23], v[100:103]
  v_mfma_f32_16x16x32_bf16 v[104:107], a[212:215], a[52:55], v[104:107]
  v_mfma_f32_16x16x32_bf16 v[108:111], a[244:247], a[52:55], v[108:111]
  v_mfma_f32_16x16x32_bf16 v[112:115], a[212:215], a[84:87], v[112:115]
  v_mfma_f32_16x16x32_bf16 v[116:119], a[244:247], a[84:87], v[116:119]
  v_mfma_f32_16x16x32_bf16 v[120:123], a[212:215], a[116:119], v[120:123]
  v_mfma_f32_16x16x32_bf16 v[124:127], a[244:247], a[116:119], v[124:127]
  s_waitcnt lgkmcnt(0)
  v_mfma_f32_16x16x32_bf16 v[64:67], a[152:155], a[24:27], v[64:67]
  ds_read_b128 a[28:31], v47 offset:256
  ds_read_b128 a[60:63], v47 offset:1280
  v_mfma_f32_16x16x32_bf16 v[68:71], a[184:187], a[24:27], v[68:71]
  ds_read_b128 a[92:95], v47 offset:4352
  ds_read_b128 a[124:127], v47 offset:5376
  v_mfma_f32_16x16x32_bf16 v[72:75], a[152:155], a[56:59], v[72:75]
  ds_read_b128 a[156:159], v35 offset:256
  ds_read_b128 a[188:191], v35 offset:2304
  v_mfma_f32_16x16x32_bf16 v[76:79], a[184:187], a[56:59], v[76:79]
  ds_read_b128 a[220:223], v35 offset:16640
  ds_read_b128 a[252:255], v35 offset:18688
  v_mfma_f32_16x16x32_bf16 v[80:83], a[152:155], a[88:91], v[80:83]
  v_mfma_f32_16x16x32_bf16 v[84:87], a[184:187], a[88:91], v[84:87]
  v_mfma_f32_16x16x32_bf16 v[88:91], a[152:155], a[120:123], v[88:91]
  v_mfma_f32_16x16x32_bf16 v[92:95], a[184:187], a[120:123], v[92:95]
  v_mfma_f32_16x16x32_bf16 v[96:99], a[216:219], a[24:27], v[96:99]
  v_mfma_f32_16x16x32_bf16 v[100:103], a[248:251], a[24:27], v[100:103]
  v_mfma_f32_16x16x32_bf16 v[104:107], a[216:219], a[56:59], v[104:107]
  v_mfma_f32_16x16x32_bf16 v[108:111], a[248:251], a[56:59], v[108:111]
  v_mfma_f32_16x16x32_bf16 v[112:115], a[216:219], a[88:91], v[112:115]
  v_mfma_f32_16x16x32_bf16 v[116:119], a[248:251], a[88:91], v[116:119]
  v_mfma_f32_16x16x32_bf16 v[120:123], a[216:219], a[120:123], v[120:123]
  v_mfma_f32_16x16x32_bf16 v[124:127], a[248:251], a[120:123], v[124:127]
  s_waitcnt lgkmcnt(0)
  s_barrier
  buffer_load_dwordx2 v[254:255], v252, s[12:15], 0 offen offset:128 sc1
  buffer_load_dword v253, v252, s[12:15], 0 offen sc1
  v_mfma_f32_16x16x32_bf16 v[64:67], a[156:159], a[28:31], v[64:67]
  v_mfma_f32_16x16x32_bf16 v[68:71], a[188:191], a[28:31], v[68:71]
  v_mfma_f32_16x16x32_bf16 v[72:75], a[156:159], a[60:63], v[72:75]
  v_mfma_f32_16x16x32_bf16 v[76:79], a[188:191], a[60:63], v[76:79]
  v_mfma_f32_16x16x32_bf16 v[80:83], a[156:159], a[92:95], v[80:83]
  v_pk_mul_f32 v[64:65], v[64:65], v[48:49] op_sel_hi:[1,0]
  v_pk_mul_f32 v[66:67], v[66:67], v[48:49] op_sel_hi:[1,0]
  v_mfma_f32_16x16x32_bf16 v[84:87], a[188:191], a[92:95], v[84:87]
  v_pk_mul_f32 v[68:69], v[68:69], v[48:49] op_sel_hi:[1,0]
  v_pk_mul_f32 v[70:71], v[70:71], v[48:49] op_sel_hi:[1,0]
  v_mfma_f32_16x16x32_bf16 v[88:91], a[156:159], a[124:127], v[88:91]
  v_cvt_pk_bf16_f32 v64, v64, v65
  v_cvt_pk_bf16_f32 v65, v66, v67
  v_mfma_f32_16x16x32_bf16 v[92:95], a[188:191], a[124:127], v[92:95]
  v_cvt_pk_bf16_f32 v66, v68, v69
  v_cvt_pk_bf16_f32 v67, v70, v71
  v_mfma_f32_16x16x32_bf16 v[96:99], a[220:223], a[28:31], v[96:99]
  buffer_store_dwordx4 v[64:67], v28, s[8:11], s29 offen sc1
  v_pk_mul_f32 v[72:73], v[72:73], v[48:49] op_sel_hi:[1,0]
  v_mfma_f32_16x16x32_bf16 v[100:103], a[252:255], a[28:31], v[100:103]
  v_pk_mul_f32 v[74:75], v[74:75], v[48:49] op_sel_hi:[1,0]
  v_pk_mul_f32 v[76:77], v[76:77], v[48:49] op_sel_hi:[1,0]
  v_mfma_f32_16x16x32_bf16 v[104:107], a[220:223], a[60:63], v[104:107]
  v_pk_mul_f32 v[78:79], v[78:79], v[48:49] op_sel_hi:[1,0]
  v_cvt_pk_bf16_f32 v72, v72, v73
  v_mfma_f32_16x16x32_bf16 v[108:111], a[252:255], a[60:63], v[108:111]
  v_cvt_pk_bf16_f32 v73, v74, v75
  v_cvt_pk_bf16_f32 v74, v76, v77
  v_mfma_f32_16x16x32_bf16 v[112:115], a[220:223], a[92:95], v[112:115]
  v_cvt_pk_bf16_f32 v75, v78, v79
  buffer_store_dwordx4 v[72:75], v29, s[8:11], s29 offen sc1
  v_mfma_f32_16x16x32_bf16 v[116:119], a[252:255], a[92:95], v[116:119]
  v_pk_mul_f32 v[80:81], v[80:81], v[48:49] op_sel_hi:[1,0]
  v_pk_mul_f32 v[82:83], v[82:83], v[48:49] op_sel_hi:[1,0]
  v_mfma_f32_16x16x32_bf16 v[120:123], a[220:223], a[124:127], v[120:123]
  v_pk_mul_f32 v[84:85], v[84:85], v[48:49] op_sel_hi:[1,0]
  v_pk_mul_f32 v[86:87], v[86:87], v[48:49] op_sel_hi:[1,0]
  v_mfma_f32_16x16x32_bf16 v[124:127], a[252:255], a[124:127], v[124:127]
  v_cvt_pk_bf16_f32 v80, v80, v81
  v_cvt_pk_bf16_f32 v81, v82, v83
  v_cvt_pk_bf16_f32 v82, v84, v85
  v_cvt_pk_bf16_f32 v83, v86, v87
  buffer_store_dwordx4 v[80:83], v30, s[8:11], s29 offen sc1
  v_pk_mul_f32 v[88:89], v[88:89], v[48:49] op_sel_hi:[1,0]
  v_pk_mul_f32 v[90:91], v[90:91], v[48:49] op_sel_hi:[1,0]
  v_pk_mul_f32 v[92:93], v[92:93], v[48:49] op_sel_hi:[1,0]
  v_pk_mul_f32 v[94:95], v[94:95], v[48:49] op_sel_hi:[1,0]
  v_cvt_pk_bf16_f32 v88, v88, v89
  v_cvt_pk_bf16_f32 v89, v90, v91
  v_cvt_pk_bf16_f32 v90, v92, v93
  v_cvt_pk_bf16_f32 v91, v94, v95
  buffer_store_dwordx4 v[88:91], v31, s[8:11], s29 offen sc1
  v_pk_mul_f32 v[96:97], v[96:97], v[48:49] op_sel_hi:[1,0]
  v_pk_mul_f32 v[98:99], v[98:99], v[48:49] op_sel_hi:[1,0]
  v_pk_mul_f32 v[100:101], v[100:101], v[48:49] op_sel_hi:[1,0]
  v_pk_mul_f32 v[102:103], v[102:103], v[48:49] op_sel_hi:[1,0]
  v_cvt_pk_bf16_f32 v96, v96, v97
  v_cvt_pk_bf16_f32 v97, v98, v99
  v_cvt_pk_bf16_f32 v98, v100, v101
  v_cvt_pk_bf16_f32 v99, v102, v103
  buffer_store_dwordx4 v[96:99], v28, s[8:11], s31 offen sc1
  v_pk_mul_f32 v[104:105], v[104:105], v[48:49] op_sel_hi:[1,0]
  v_pk_mul_f32 v[106:107], v[106:107], v[48:49] op_sel_hi:[1,0]
  v_pk_mul_f32 v[108:109], v[108:109], v[48:49] op_sel_hi:[1,0]
  v_pk_mul_f32 v[110:111], v[110:111], v[48:49] op_sel_hi:[1,0]
  v_cvt_pk_bf16_f32 v104, v104, v105
  v_cvt_pk_bf16_f32 v105, v106, v107
  v_cvt_pk_bf16_f32 v106, v108, v109
  v_cvt_pk_bf16_f32 v107, v110, v111
  buffer_store_dwordx4 v[104:107], v29, s[8:11], s31 offen sc1
  v_pk_mul_f32 v[112:113], v[112:113], v[48:49] op_sel_hi:[1,0]
  v_pk_mul_f32 v[114:115], v[114:115], v[48:49] op_sel_hi:[1,0]
  v_pk_mul_f32 v[116:117], v[116:117], v[48:49] op_sel_hi:[1,0]
  v_pk_mul_f32 v[118:119], v[118:119], v[48:49] op_sel_hi:[1,0]
  v_cvt_pk_bf16_f32 v112, v112, v113
  v_cvt_pk_bf16_f32 v113, v114, v115
  v_cvt_pk_bf16_f32 v114, v116, v117
  v_cvt_pk_bf16_f32 v115, v118, v119
  buffer_store_dwordx4 v[112:115], v30, s[8:11], s31 offen sc1
  v_pk_mul_f32 v[120:121], v[120:121], v[48:49] op_sel_hi:[1,0]
  v_pk_mul_f32 v[122:123], v[122:123], v[48:49] op_sel_hi:[1,0]
  v_pk_mul_f32 v[124:125], v[124:125], v[48:49] op_sel_hi:[1,0]
  v_pk_mul_f32 v[126:127], v[126:127], v[48:49] op_sel_hi:[1,0]
  v_cvt_pk_bf16_f32 v120, v120, v121
  v_cvt_pk_bf16_f32 v121, v122, v123
  v_cvt_pk_bf16_f32 v122, v124, v125
  v_cvt_pk_bf16_f32 v123, v126, v127
  buffer_store_dwordx4 v[120:123], v31, s[8:11], s31 offen sc1
  s_waitcnt vmcnt(0)
  s_barrier
  s_cmp_lg_u32 s16, 0
  s_cbranch_scc1 wp_f3_f
  v_readfirstlane_b32 s20, v254
  s_cmp_eq_u32 s20, 1
  s_cbranch_scc1 wp_f3_w_ok
  s_mov_b32 s30, 0
wp_f3_w:
  buffer_load_dword v254, off, s[12:15], 0 offset:128 sc1
  s_waitcnt vmcnt(0)
  v_cmp_ne_u32 vcc, 1, v254
  s_cbranch_vccz wp_f3_w_ok
  s_sleep 8
  s_add_u32 s30, s30, 1
  s_cmp_lt_u32 s30, 16
  s_cbranch_scc1 wp_f3_w
  s_branch wp_f3_f
wp_f3_w_ok:
  s_lshl_b32 s20, s17, 7
  s_add_u32 s20, s20, 88521216
  s_lshl_b32 s21, 1, s19
  v_mov_b32 v248, s21
  s_mov_b64 exec, 1
  buffer_atomic_or v248, v252, s[8:11], s20 offen sc0
  s_mov_b64 exec, -1
  s_mov_b32 s38, s21
wp_f3_f:
  s_cmp_eq_u32 s97, 3
  s_cbranch_scc1 wk_adone
wp_fin:
  s_cmp_lg_u32 s97, 0
  s_cbranch_scc1 wp_all
  v_readfirstlane_b32 s20, v254
  v_readfirstlane_b32 s21, v253
  s_and_b32 s21, s21, 0xffe0
  s_cselect_b32 s96, s20, 0
  s_cmp_eq_u32 s96, 0
  s_cbranch_scc1 wp_all
  v_mov_b32 v250, 1
  s_mov_b32 s20, 88525312
  s_mov_b64 exec, 1
  buffer_atomic_add v250, v252, s[8:11], s20 offen sc0
  s_mov_b64 exec, -1
wp_all:
  v_mov_b32 v252, 0x40000000
  v_cmp_eq_u32 vcc, 0, v0
  s_nop 1
  v_cndmask_b32 v252, v252, v0, vcc
  s_mov_b32 s34, 0
  s_cmp_lg_u32 s16, 0
  s_cbranch_scc1 wp_w2
  s_getreg_b32 s24, hwreg(HW_REG_XCC_ID)
  s_sub_u32 s24, s24, 0
  s_and_b32 s24, s24, 7
  s_lshl_b32 s24, s24, 7
  s_add_u32 s24, s24, 88523264
  s_cmp_lg_u32 s96, 0
  s_cbranch_scc1 wp_v0
  s_waitcnt vmcnt(0)
wp_v0:
  s_cmp_eq_u32 s97, 0
  s_cbranch_scc1 wp_v1
  s_waitcnt vmcnt(0)
wp_v1:
  s_waitcnt vmcnt(1)
  v_readfirstlane_b32 s20, v248
  s_and_b32 s20, s20, 14448
  s_xor_b32 s20, s20, s38
  s_cmp_lg_u32 s20, 14448
  s_cselect_b32 s20, 0, s38
  s_mov_b32 s38, 0
  s_cmp_eq_u32 s20, 0
  s_cbranch_scc1 wp_g3
  s_lshl_b32 s21, 65536, s17
  v_mov_b32 v248, s21
  s_mov_b32 s20, 88523264
  v_lshlrev_b32 v247, 7, v0
  s_mov_b64 exec, 0xff
  buffer_atomic_or v248, v247, s[8:11], s20 offen
  s_mov_b64 exec, -1
wp_g3:
  v_readfirstlane_b32 s20, v248
  s_and_b32 s20, s20, 16383
  s_xor_b32 s20, s20, s37
  s_cmp_lg_u32 s20, 16383
  s_cselect_b32 s20, 0, s37
  s_mov_b32 s37, 0
  s_cmp_eq_u32 s20, 0
  s_cbranch_scc1 wp_g2
  s_lshl_b32 s21, 1, s17
  v_mov_b32 v248, s21
  s_mov_b32 s20, 88523264
  v_lshlrev_b32 v247, 7, v0
  s_mov_b64 exec, 0xff
  buffer_atomic_or v248, v247, s[8:11], s20 offen
  s_mov_b64 exec, -1
wp_g2:
  s_cmp_lg_u32 s96, 0
  s_cbranch_scc1 wp_v_ok
  s_mov_b32 s30, 0
wp_v:
  buffer_load_dwordx2 v[64:65], off, s[12:15], 0 sc1
  buffer_load_dword v66, off, s[12:15], 0 offset:128 sc1
  s_waitcnt vmcnt(0)
  v_and_b32 v68, 0xffe0, v64
  v_min_u32 v68, v68, v66
  v_cmp_ne_u32 vcc, 1, v68
  s_cbranch_vccz wp_v_ok
  s_sleep 16
  s_add_u32 s30, s30, 1
  s_cmp_lt_u32 s30, 30
  s_cbranch_scc1 wp_v
  s_branch wp_w1
wp_v_ok:
  v_mov_b32 v64, 32
  s_cmp_eq_u32 s97, 2
  s_cselect_b32 s31, 1, 60
  s_mov_b32 s30, 0
wp_w:
  buffer_load_dwordx2 v[66:67], off, s[8:11], s24 sc1
  s_waitcnt vmcnt(0)
  v_or_b32 v66, s39, v66
  v_add_u32 v66, v66, v67
  v_cmp_ne_u32 vcc, 0, v66
  s_cbranch_vccz wp_w_ok
  s_sleep 8
  s_add_u32 s30, s30, 1
  s_cmp_lt_u32 s30, s31
  s_cbranch_scc1 wp_w
  s_branch wp_w1
wp_w_ok:
  s_branch wp_w2
wp_w1:
  v_readfirstlane_b32 s20, v64
  v_readfirstlane_b32 s21, v65
  s_and_b32 s20, s20, 0xffff
  s_cmp_lt_u32 s20, 32
  s_cselect_b32 s34, 2, 1
  s_add_u32 s32, s32, 1
  s_cmp_lt_u32 s32, 4000
  s_cselect_b32 s34, s34, 3
wp_w2:
  v_mov_b32 v6, 160032
  v_mov_b32 v7, s34
  s_barrier
  s_cmp_lg_u32 s16, 0
  s_cbranch_scc1 uni_8
  ds_write_b32 v6, v7
  s_waitcnt lgkmcnt(0)
uni_8:
  s_barrier
  ds_read_b32 v7, v6
  s_waitcnt lgkmcnt(0)
  v_readfirstlane_b32 s34, v7
  s_cmp_lg_u32 s34, 0
  s_cbranch_scc1 wp_bad
  s_cmp_lg_u32 s39, -4
  s_cbranch_scc1 wp_done
  s_mov_b32 s101, 0
  s_lshl_b32 s20, s101, 4
  s_lshr_b32 s21, s2, 3
  s_add_u32 s21, s21, s16
  s_and_b32 s21, s21, 3
  s_lshl_b32 s21, s21, 2
  s_add_u32 s20, s20, s21
  s_mul_i32 s21, s20, 14336
  s_add_u32 s21, s21, 72024064
  s_add_u32 s22, s21, 0
  buffer_load_dwordx4 a[0:3], v2, s[8:11], s22 offen offset:0 sc1
  buffer_load_dwordx4 a[4:7], v2, s[8:11], s22 offen offset:1024 sc1
  buffer_load_dwordx4 a[8:11], v2, s[8:11], s22 offen offset:2048 sc1
  buffer_load_dwordx4 a[12:15], v2, s[8:11], s22 offen offset:3072 sc1
  s_add_u32 s22, s21, 4096
  buffer_load_dwordx4 a[16:19], v2, s[8:11], s22 offen offset:0 sc1
  buffer_load_dwordx4 a[20:23], v2, s[8:11], s22 offen offset:1024 sc1
  buffer_load_dwordx4 a[24:27], v2, s[8:11], s22 offen offset:2048 sc1
  buffer_load_dwordx4 a[28:31], v2, s[8:11], s22 offen offset:3072 sc1
  s_add_u32 s22, s21, 8192
  buffer_load_dwordx4 a[32:35], v2, s[8:11], s22 offen offset:0 sc1
  buffer_load_dwordx4 a[36:39], v2, s[8:11], s22 offen offset:1024 sc1
  buffer_load_dwordx4 a[40:43], v2, s[8:11], s22 offen offset:2048 sc1
  buffer_load_dwordx4 a[44:47], v2, s[8:11], s22 offen offset:3072 sc1
  s_add_u32 s22, s21, 12288
  buffer_load_dwordx4 a[48:51], v2, s[8:11], s22 offen offset:0 sc1
  buffer_load_dwordx4 a[52:55], v2, s[8:11], s22 offen offset:1024 sc1
  buffer_load_dwordx4 a[56:59], v2, s[8:11], s22 offen offset:2048 sc1
  buffer_load_dwordx4 a[60:63], v2, s[8:11], s22 offen offset:3072 sc1
  s_add_u32 s22, s21, 16384
  buffer_load_dwordx4 a[64:67], v2, s[8:11], s22 offen offset:0 sc1
  buffer_load_dwordx4 a[68:71], v2, s[8:11], s22 offen offset:1024 sc1
  buffer_load_dwordx4 a[72:75], v2, s[8:11], s22 offen offset:2048 sc1
  buffer_load_dwordx4 a[76:79], v2, s[8:11], s22 offen offset:3072 sc1
  s_add_u32 s22, s21, 20480
  buffer_load_dwordx4 a[80:83], v2, s[8:11], s22 offen offset:0 sc1
  buffer_load_dwordx4 a[84:87], v2, s[8:11], s22 offen offset:1024 sc1
  buffer_load_dwordx4 a[88:91], v2, s[8:11], s22 offen offset:2048 sc1
  buffer_load_dwordx4 a[92:95], v2, s[8:11], s22 offen offset:3072 sc1
  s_add_u32 s22, s21, 24576
  buffer_load_dwordx4 a[96:99], v2, s[8:11], s22 offen offset:0 sc1
  buffer_load_dwordx4 a[100:103], v2, s[8:11], s22 offen offset:1024 sc1
  buffer_load_dwordx4 a[104:107], v2, s[8:11], s22 offen offset:2048 sc1
  buffer_load_dwordx4 a[108:111], v2, s[8:11], s22 offen offset:3072 sc1
  s_add_u32 s22, s21, 28672
  buffer_load_dwordx4 a[112:115], v2, s[8:11], s22 offen offset:0 sc1
  buffer_load_dwordx4 a[116:119], v2, s[8:11], s22 offen offset:1024 sc1
  buffer_load_dwordx4 a[120:123], v2, s[8:11], s22 offen offset:2048 sc1
  buffer_load_dwordx4 a[124:127], v2, s[8:11], s22 offen offset:3072 sc1
  s_add_u32 s22, s21, 32768
  buffer_load_dwordx4 a[128:131], v2, s[8:11], s22 offen offset:0 sc1
  buffer_load_dwordx4 a[132:135], v2, s[8:11], s22 offen offset:1024 sc1
  buffer_load_dwordx4 a[136:139], v2, s[8:11], s22 offen offset:2048 sc1
  buffer_load_dwordx4 a[140:143], v2, s[8:11], s22 offen offset:3072 sc1
  s_add_u32 s22, s21, 36864
  buffer_load_dwordx4 a[144:147], v2, s[8:11], s22 offen offset:0 sc1
  buffer_load_dwordx4 a[148:151], v2, s[8:11], s22 offen offset:1024 sc1
  buffer_load_dwordx4 a[152:155], v2, s[8:11], s22 offen offset:2048 sc1
  buffer_load_dwordx4 a[156:159], v2, s[8:11], s22 offen offset:3072 sc1
  s_add_u32 s22, s21, 40960
  s_waitcnt vmcnt(40)
  buffer_load_dwordx4 a[160:163], v2, s[8:11], s22 offen offset:0 sc1
  buffer_load_dwordx4 a[164:167], v2, s[8:11], s22 offen offset:1024 sc1
  buffer_load_dwordx4 a[168:171], v2, s[8:11], s22 offen offset:2048 sc1
  buffer_load_dwordx4 a[172:175], v2, s[8:11], s22 offen offset:3072 sc1
  s_add_u32 s22, s21, 45056
  buffer_load_dwordx4 a[176:179], v2, s[8:11], s22 offen offset:0 sc1
  buffer_load_dwordx4 a[180:183], v2, s[8:11], s22 offen offset:1024 sc1
  buffer_load_dwordx4 a[184:187], v2, s[8:11], s22 offen offset:2048 sc1
  buffer_load_dwordx4 a[188:191], v2, s[8:11], s22 offen offset:3072 sc1
  s_add_u32 s22, s21, 49152
  buffer_load_dwordx4 a[192:195], v2, s[8:11], s22 offen offset:0 sc1
  buffer_load_dwordx4 a[196:199], v2, s[8:11], s22 offen offset:1024 sc1
  buffer_load_dwordx4 a[200:203], v2, s[8:11], s22 offen offset:2048 sc1
  buffer_load_dwordx4 a[204:207], v2, s[8:11], s22 offen offset:3072 sc1
  s_add_u32 s22, s21, 53248
  buffer_load_dwordx4 a[208:211], v2, s[8:11], s22 offen offset:0 sc1
  buffer_load_dwordx4 a[212:215], v2, s[8:11], s22 offen offset:1024 sc1
  buffer_load_dwordx4 a[216:219], v2, s[8:11], s22 offen offset:2048 sc1
  buffer_load_dwordx4 a[220:223], v2, s[8:11], s22 offen offset:3072 sc1
  s_mov_b32 s39, 0xffff0000
  s_branch wp_all
wp_bad:
  s_and_b32 s39, s39, 0xffff0000
  s_mov_b32 s97, 1
  s_cmp_eq_u32 s34, 1
  s_cbranch_scc1 wp_rep
  s_cmp_eq_u32 s34, 3
  s_cbranch_scc1 cA_abort
  s_load_dwordx8 s[40:47], s[0:1], 72
  s_load_dwordx4 s[48:51], s[0:1], 56
  s_waitcnt lgkmcnt(0)
  v_mov_b32 v4, 0x10001
  s_mov_b32 s18, 1
  s_branch ch_take
wp_rep:
  s_mov_b32 s101, -1
  s_load_dwordx8 s[40:47], s[0:1], 72
  s_load_dwordx4 s[48:51], s[0:1], 56
  s_waitcnt vmcnt(0) lgkmcnt(0)
  v_mov_b32 v4, 1
  v_mov_b32 v5, 20
  v_mov_b32 v6, 160000
  s_barrier
  s_cmp_lg_u32 s16, 0
  s_cbranch_scc1 wp_el1
  s_mov_b64 exec, 1
  buffer_atomic_add v4, v5, s[12:15], 0 offen sc0
  s_waitcnt vmcnt(0)
  ds_write_b32 v6, v4
  s_waitcnt lgkmcnt(0)
  s_mov_b64 exec, -1
wp_el1:
  s_barrier
  ds_read_b32 v4, v6
  s_waitcnt lgkmcnt(0)
  v_readfirstlane_b32 s33, v4
  v_and_b32 v1, 63, v0
  v_lshlrev_b32 v2, 4, v1
  v_lshrrev_b32 v3, 4, v1
  v_and_b32 v4, 15, v1
  v_lshrrev_b32 v5, 5, v1
  v_and_b32 v6, 31, v1
  v_xor_b32 v8, v6, v5
  v_lshlrev_b32 v8, 4, v8
  v_lshl_add_u32 v16, v5, 13, v8
  v_xor_b32 v17, 32, v16
  v_xor_b32 v18, 64, v16
  v_xor_b32 v19, 96, v16
  v_xor_b32 v20, 128, v16
  v_xor_b32 v21, 160, v16
  v_xor_b32 v22, 192, v16
  v_xor_b32 v23, 224, v16
  s_lshl_b32 s20, s16, 6
  v_xor_b32 v26, s20, v16
  v_xor_b32 v27, 32, v26
  s_and_b32 s33, s33, 511
  s_and_b32 s20, s33, 255
  s_cmp_ge_u32 s20, 224
  s_cselect_b32 s97, 1, 2
  s_cbranch_scc1 wp_all
  s_mul_i32 s17, s20, 4682
  s_lshr_b32 s17, s17, 16
  s_mul_i32 s23, s17, 14
  s_sub_u32 s19, s20, s23
  s_cmp_lt_u32 s19, 7
  s_cselect_b32 s18, 0, 7
  s_cselect_b32 s28, 0, 8
  s_sub_u32 s18, s19, s18
  s_add_u32 s28, s28, s16
  s_lshl_b32 s25, s16, 15
  s_add_u32 s25, s25, 32768
  s_lshl_b32 s26, s17, 9
  s_lshl_b32 s20, s17, 7
  s_lshr_b32 s21, s33, 8
  s_lshl_b32 s21, s21, 11
  s_add_u32 s20, s20, s21
  s_add_u32 s20, s20, 88519168
  buffer_load_dword v5, off, s[8:11], s20 sc1
  s_waitcnt vmcnt(0)
  v_readfirstlane_b32 s34, v5
  v_mov_b32 v6, 160032
  s_nop 0
  v_mov_b32 v7, s34
  s_barrier
  s_cmp_lg_u32 s16, 0
  s_cbranch_scc1 uni_9
  ds_write_b32 v6, v7
  s_waitcnt lgkmcnt(0)
uni_9:
  s_barrier
  ds_read_b32 v7, v6
  s_waitcnt lgkmcnt(0)
  v_readfirstlane_b32 s34, v7
  s_cmp_lt_u32 s33, 256
  s_cselect_b32 s20, 0, 1935
  s_or_b32 s34, s34, s20
  s_bitcmp1_b32 s34, s19
  s_cbranch_scc1 wp_rep
  s_barrier
  s_cmp_lt_u32 s33, 256
  s_cbranch_scc1 wp_B
  s_branch wp_A0
wp_done:
  s_mov_b32 s97, s39
  s_cmp_lg_u32 s96, 0
  s_cbranch_scc1 wk_next
  s_cmp_lg_u32 s16, 0
  s_cbranch_scc1 ask_10
  v_mov_b32 v250, 1
  v_mov_b32 v251, 88525312
  s_mov_b64 exec, 1
  buffer_atomic_add v250, v251, s[8:11], 0 offen sc0
  s_mov_b64 exec, -1
ask_10:
  s_branch wk_next
wk_loop:
  s_waitcnt vmcnt(0) lgkmcnt(0)
wk_ask:
  v_readfirstlane_b32 s22, v250
  s_cmp_ge_u32 s22, 1264
  s_cbranch_scc1 wk_next
  s_cmp_lg_u32 s16, 0
  s_cbranch_scc1 ask_11
  v_mov_b32 v250, 1
  v_mov_b32 v251, 88525312
  s_mov_b64 exec, 1
  buffer_atomic_add v250, v251, s[8:11], 0 offen sc0
  s_mov_b64 exec, -1
ask_11:
wk_next:
  v_mov_b32 v6, 160000
  s_waitcnt vmcnt(0)
  s_barrier
  s_cmp_lg_u32 s16, 0
  s_cbranch_scc1 wk_n1
  s_mov_b64 exec, 1
  ds_write_b32 v6, v250
  s_mov_b64 exec, -1
  s_waitcnt lgkmcnt(0)
wk_n1:
  s_barrier
  ds_read_b32 v4, v6
  s_waitcnt lgkmcnt(0)
  v_readfirstlane_b32 s3, v4
  s_cmp_ge_u32 s3, 1264
  s_cbranch_scc1 wk_done
  v_mov_b32 v250, 0
  v_mov_b32 v251, 88525312
  v_and_b32 v1, 63, v0
  v_lshlrev_b32 v2, 4, v1
  v_lshrrev_b32 v3, 4, v1
  v_and_b32 v4, 15, v1
  s_cmp_lt_u32 s3, 112
  s_cbranch_scc1 wk_n2
  s_cmp_eq_u32 s97, 0
  s_cbranch_scc1 wk_n2
  v_mov_b32 v250, s3
  s_mov_b32 s96, 1
  s_mov_b32 s97, 1
  s_mov_b32 s39, 0
  s_mov_b32 s37, 0
  s_mov_b32 s38, 0
  s_mov_b32 s32, 0
  s_branch wp_all
wk_n2:
  s_cmp_ge_u32 s3, 752
  s_cbranch_scc1 wk_tok
  s_cmp_ge_u32 s3, 640
  s_cbranch_scc1 wk_s4d
  s_cmp_ge_u32 s3, 448
  s_cbranch_scc1 wk_full
  s_cmp_ge_u32 s3, 320
  s_cbranch_scc1 wk_adef
  s_cmp_ge_u32 s3, 288
  s_cbranch_scc1 wk_srv
  s_and_b32 s17, s3, 15
  s_add_u32 s17, s17, 16
  s_cmp_ge_u32 s3, 224
  s_cbranch_scc1 wk_half
  s_cmp_ge_u32 s3, 112
  s_cselect_b32 s18, 1, 0
  s_cselect_b32 s20, 112, 0
  s_sub_u32 s34, s3, s20
  s_lshr_b32 s34, s34, 4
  s_lshl_b32 s34, s34, 1
  s_add_u32 s35, s34, 2
  s_branch wk_gemm
wk_adef:
  s_mov_b32 s101, -1
  s_load_dwordx8 s[40:47], s[0:1], 72
  s_sub_u32 s20, s3, 320
  s_lshr_b32 s33, s20, 2
  s_mul_i32 s33, s33, 7
  s_and_b32 s20, s20, 3
  s_add_u32 s33, s33, s20
  s_mov_b32 s97, 3
  v_mov_b32 v252, 0x40000000
  v_cmp_eq_u32 vcc, 0, v0
  s_nop 1
  v_cndmask_b32 v252, v252, v0, vcc
  v_lshrrev_b32 v5, 5, v1
  v_and_b32 v6, 31, v1
  v_xor_b32 v8, v6, v5
  v_lshlrev_b32 v8, 4, v8
  v_lshl_add_u32 v16, v5, 13, v8
  v_xor_b32 v17, 32, v16
  v_xor_b32 v18, 64, v16
  v_xor_b32 v19, 96, v16
  v_xor_b32 v20, 128, v16
  v_xor_b32 v21, 160, v16
  v_xor_b32 v22, 192, v16
  v_xor_b32 v23, 224, v16
  s_lshl_b32 s20, s16, 6
  v_xor_b32 v26, s20, v16
  v_xor_b32 v27, 32, v26
  s_mul_i32 s17, s33, 4682
  s_lshr_b32 s17, s17, 16
  s_mul_i32 s23, s17, 14
  s_sub_u32 s19, s33, s23
  s_cmp_lt_u32 s19, 7
  s_cselect_b32 s18, 0, 7
  s_cselect_b32 s28, 0, 8
  s_sub_u32 s18, s19, s18
  s_add_u32 s28, s28, s16
  s_lshl_b32 s25, s16, 15
  s_add_u32 s25, s25, 32768
  s_lshl_b32 s26, s17, 9
  s_waitcnt lgkmcnt(0)
  s_barrier
  s_branch wp_A0
wk_adone:
  s_mov_b32 s97, 0
  s_branch wk_loop
wk_half:
  s_sub_u32 s20, s3, 224
  s_lshr_b32 s18, s20, 5
  s_add_u32 s18, s18, 2
  s_bitcmp1_b32 s20, 4
  s_cselect_b32 s34, 7, 0
  s_add_u32 s35, s34, 7
  s_branch wk_gemm
wk_full:
  s_sub_u32 s20, s3, 384
  s_and_b32 s17, s20, 15
  s_lshr_b32 s18, s20, 4
  s_mov_b32 s34, 0
  s_mov_b32 s35, 14
  s_cmp_lt_u32 s18, 8
  s_cselect_b32 s21, 16, 0
  s_add_u32 s17, s17, s21
  s_and_b32 s18, s18, 7
  s_cmp_ge_u32 s17, 16
  s_cbranch_scc1 wk_gemm
  s_lshl_b32 s27, s17, 7
  s_add_u32 s27, s27, 88521216
  s_mov_b32 s28, 16383
  s_mov_b32 s30, 0
wk_aw:
  buffer_load_dword v9, off, s[8:11], s27  sc1
  s_waitcnt vmcnt(0)
  v_and_b32 v10, s28, v9
  v_cmp_ne_u32 vcc, s28, v10
  s_cbranch_vccz wk_aw_ok
  s_sleep 3
  s_add_u32 s30, s30, 1
  s_cmp_lt_u32 s30, 400000
  s_cbranch_scc1 wk_aw
  s_branch cA_abort
wk_aw_ok:
wk_gemm:
  s_lshl_b32 s20, s18, 4
  s_lshr_b32 s21, s2, 3
  s_add_u32 s21, s21, s16
  s_and_b32 s21, s21, 3
  s_lshl_b32 s21, s21, 2
  s_add_u32 s20, s20, s21
  s_mul_i32 s21, s20, 14336
  s_add_u32 s21, s21, 72024064
  s_mul_i32 s23, s17, 401408
  s_and_b32 s22, s16, 1
  s_mul_i32 s22, s22, 7168
  s_add_u32 s23, s23, s22
  s_add_u32 s23, s23, 0
  s_lshr_b32 s22, s16, 1
  s_mul_i32 s22, s22, 14336
  s_add_u32 s23, s23, s22
  s_mul_i32 s27, s16, 7168
  s_lshr_b32 s28, s20, 1
  s_cmp_lt_u32 s17, 16
  s_cbranch_scc0 wg_vo
  s_add_u32 s23, s23, s22
  s_lshl_b32 s29, s28, 4
  s_add_u32 s29, s29, s17
  s_mul_i32 s29, s29, 28672
  s_add_u32 s29, s29, 12845056
  s_mov_b32 s31, 0
  s_lshr_b32 s24, s34, 1
  s_lshl_b32 s24, s24, 2
  s_and_b32 s25, s34, 1
  s_add_u32 s24, s24, s25
  s_mul_i32 s24, s24, 14336
  s_add_u32 s24, s24, s23
  s_add_u32 m0, s31, s27
  s_nop 0
  buffer_load_dwordx4 v2, s[8:11], s24 offen offset:0 sc1 lds
  buffer_load_dwordx4 v2, s[8:11], s24 offen offset:1024 sc1 lds
  buffer_load_dwordx4 v2, s[8:11], s24 offen offset:2048 sc1 lds
  buffer_load_dwordx4 v2, s[8:11], s24 offen offset:3072 sc1 lds
  s_add_u32 m0, m0, 4096
  s_add_u32 s24, s24, 4096
  buffer_load_dwordx4 v2, s[8:11], s24 offen offset:0 sc1 lds
  buffer_load_dwordx4 v2, s[8:11], s24 offen offset:1024 sc1 lds
  buffer_load_dwordx4 v2, s[8:11], s24 offen offset:2048 sc1 lds
  s_sub_u32 s36, s35, 1
  s_add_u32 s30, s34, 1
  s_min_u32 s30, s30, s36
  s_mov_b32 s31, 28672
  s_lshr_b32 s24, s30, 1
  s_lshl_b32 s24, s24, 2
  s_and_b32 s25, s30, 1
  s_add_u32 s24, s24, s25
  s_mul_i32 s24, s24, 14336
  s_add_u32 s24, s24, s23
  s_add_u32 m0, s31, s27
  s_nop 0
  buffer_load_dwordx4 v2, s[8:11], s24 offen offset:0 sc1 lds
  buffer_load_dwordx4 v2, s[8:11], s24 offen offset:1024 sc1 lds
  buffer_load_dwordx4 v2, s[8:11], s24 offen offset:2048 sc1 lds
  buffer_load_dwordx4 v2, s[8:11], s24 offen offset:3072 sc1 lds
  s_add_u32 m0, m0, 4096
  s_add_u32 s24, s24, 4096
  buffer_load_dwordx4 v2, s[8:11], s24 offen offset:0 sc1 lds
  buffer_load_dwordx4 v2, s[8:11], s24 offen offset:1024 sc1 lds
  buffer_load_dwordx4 v2, s[8:11], s24 offen offset:2048 sc1 lds
  s_mov_b32 s19, s34
  s_mov_b32 s32, 0
  s_mov_b32 s33, 57344
  s_cmp_eq_u32 s18, s101
  s_cbranch_scc1 wg_f_hx
  s_add_u32 s22, s21, 0
  buffer_load_dwordx4 a[0:3], v2, s[8:11], s22 offen offset:0 sc1
  buffer_load_dwordx4 a[4:7], v2, s[8:11], s22 offen offset:1024 sc1
  buffer_load_dwordx4 a[8:11], v2, s[8:11], s22 offen offset:2048 sc1
  buffer_load_dwordx4 a[12:15], v2, s[8:11], s22 offen offset:3072 sc1
  s_add_u32 s22, s21, 4096
  buffer_load_dwordx4 a[16:19], v2, s[8:11], s22 offen offset:0 sc1
  buffer_load_dwordx4 a[20:23], v2, s[8:11], s22 offen offset:1024 sc1
  buffer_load_dwordx4 a[24:27], v2, s[8:11], s22 offen offset:2048 sc1
  buffer_load_dwordx4 a[28:31], v2, s[8:11], s22 offen offset:3072 sc1
  s_add_u32 s22, s21, 8192
  buffer_load_dwordx4 a[32:35], v2, s[8:11], s22 offen offset:0 sc1
  buffer_load_dwordx4 a[36:39], v2, s[8:11], s22 offen offset:1024 sc1
  buffer_load_dwordx4 a[40:43], v2, s[8:11], s22 offen offset:2048 sc1
  buffer_load_dwordx4 a[44:47], v2, s[8:11], s22 offen offset:3072 sc1
  s_add_u32 s22, s21, 12288
  buffer_load_dwordx4 a[48:51], v2, s[8:11], s22 offen offset:0 sc1
  buffer_load_dwordx4 a[52:55], v2, s[8:11], s22 offen offset:1024 sc1
  buffer_load_dwordx4 a[56:59], v2, s[8:11], s22 offen offset:2048 sc1
  buffer_load_dwordx4 a[60:63], v2, s[8:11], s22 offen offset:3072 sc1
  s_add_u32 s22, s21, 16384
  buffer_load_dwordx4 a[64:67], v2, s[8:11], s22 offen offset:0 sc1
  buffer_load_dwordx4 a[68:71], v2, s[8:11], s22 offen offset:1024 sc1
  buffer_load_dwordx4 a[72:75], v2, s[8:11], s22 offen offset:2048 sc1
  buffer_load_dwordx4 a[76:79], v2, s[8:11], s22 offen offset:3072 sc1
  s_add_u32 s22, s21, 20480
  buffer_load_dwordx4 a[80:83], v2, s[8:11], s22 offen offset:0 sc1
  buffer_load_dwordx4 a[84:87], v2, s[8:11], s22 offen offset:1024 sc1
  buffer_load_dwordx4 a[88:91], v2, s[8:11], s22 offen offset:2048 sc1
  buffer_load_dwordx4 a[92:95], v2, s[8:11], s22 offen offset:3072 sc1
  s_add_u32 s22, s21, 24576
  buffer_load_dwordx4 a[96:99], v2, s[8:11], s22 offen offset:0 sc1
  buffer_load_dwordx4 a[100:103], v2, s[8:11], s22 offen offset:1024 sc1
  buffer_load_dwordx4 a[104:107], v2, s[8:11], s22 offen offset:2048 sc1
  buffer_load_dwordx4 a[108:111], v2, s[8:11], s22 offen offset:3072 sc1
  s_add_u32 s22, s21, 28672
  buffer_load_dwordx4 a[112:115], v2, s[8:11], s22 offen offset:0 sc1
  buffer_load_dwordx4 a[116:119], v2, s[8:11], s22 offen offset:1024 sc1
  buffer_load_dwordx4 a[120:123], v2, s[8:11], s22 offen offset:2048 sc1
  buffer_load_dwordx4 a[124:127], v2, s[8:11], s22 offen offset:3072 sc1
  s_add_u32 s22, s21, 32768
  buffer_load_dwordx4 a[128:131], v2, s[8:11], s22 offen offset:0 sc1
  buffer_load_dwordx4 a[132:135], v2, s[8:11], s22 offen offset:1024 sc1
  buffer_load_dwordx4 a[136:139], v2, s[8:11], s22 offen offset:2048 sc1
  buffer_load_dwordx4 a[140:143], v2, s[8:11], s22 offen offset:3072 sc1
  s_add_u32 s22, s21, 36864
  buffer_load_dwordx4 a[144:147], v2, s[8:11], s22 offen offset:0 sc1
  buffer_load_dwordx4 a[148:151], v2, s[8:11], s22 offen offset:1024 sc1
  buffer_load_dwordx4 a[152:155], v2, s[8:11], s22 offen offset:2048 sc1
  buffer_load_dwordx4 a[156:159], v2, s[8:11], s22 offen offset:3072 sc1
  s_add_u32 s22, s21, 40960
  s_waitcnt vmcnt(40)
  buffer_load_dwordx4 a[160:163], v2, s[8:11], s22 offen offset:0 sc1
  buffer_load_dwordx4 a[164:167], v2, s[8:11], s22 offen offset:1024 sc1
  buffer_load_dwordx4 a[168:171], v2, s[8:11], s22 offen offset:2048 sc1
  buffer_load_dwordx4 a[172:175], v2, s[8:11], s22 offen offset:3072 sc1
  s_add_u32 s22, s21, 45056
  buffer_load_dwordx4 a[176:179], v2, s[8:11], s22 offen offset:0 sc1
  buffer_load_dwordx4 a[180:183], v2, s[8:11], s22 offen offset:1024 sc1
  buffer_load_dwordx4 a[184:187], v2, s[8:11], s22 offen offset:2048 sc1
  buffer_load_dwordx4 a[188:191], v2, s[8:11], s22 offen offset:3072 sc1
  s_add_u32 s22, s21, 49152
  buffer_load_dwordx4 a[192:195], v2, s[8:11], s22 offen offset:0 sc1
  buffer_load_dwordx4 a[196:199], v2, s[8:11], s22 offen offset:1024 sc1
  buffer_load_dwordx4 a[200:203], v2, s[8:11], s22 offen offset:2048 sc1
  buffer_load_dwordx4 a[204:207], v2, s[8:11], s22 offen offset:3072 sc1
  s_add_u32 s22, s21, 53248
  buffer_load_dwordx4 a[208:211], v2, s[8:11], s22 offen offset:0 sc1
  buffer_load_dwordx4 a[212:215], v2, s[8:11], s22 offen offset:1024 sc1
  buffer_load_dwordx4 a[216:219], v2, s[8:11], s22 offen offset:2048 sc1
  buffer_load_dwordx4 a[220:223], v2, s[8:11], s22 offen offset:3072 sc1
wg_f_hx:
  s_mov_b32 s101, -1
  s_waitcnt vmcnt(0)
  s_branch wg_f_in
wg_f_loop:
  s_waitcnt vmcnt(11)
wg_f_in:
  s_barrier
  s_add_u32 s30, s19, 2
  s_min_u32 s30, s30, s36
  s_lshr_b32 s24, s30, 1
  s_lshl_b32 s24, s24, 2
  s_and_b32 s25, s30, 1
  s_add_u32 s24, s24, s25
  s_mul_i32 s24, s24, 14336
  s_add_u32 s24, s24, s23
  s_add_u32 m0, s33, s27
  s_nop 0
  buffer_load_dwordx4 v2, s[8:11], s24 offen offset:0 sc1 lds
  buffer_load_dwordx4 v2, s[8:11], s24 offen offset:1024 sc1 lds
  buffer_load_dwordx4 v2, s[8:11], s24 offen offset:2048 sc1 lds
  buffer_load_dwordx4 v2, s[8:11], s24 offen offset:3072 sc1 lds
  s_add_u32 m0, m0, 4096
  s_add_u32 s24, s24, 4096
  buffer_load_dwordx4 v2, s[8:11], s24 offen offset:0 sc1 lds
  buffer_load_dwordx4 v2, s[8:11], s24 offen offset:1024 sc1 lds
  buffer_load_dwordx4 v2, s[8:11], s24 offen offset:2048 sc1 lds
  v_add_u32 v5, s32, v2
  ds_read_b128 v[8:11], v5 offset:0
  ds_read_b128 v[12:15], v5 offset:14336
  ds_read_b128 v[16:19], v5 offset:1024
  ds_read_b128 v[20:23], v5 offset:15360
  ds_read_b128 v[24:27], v5 offset:2048
  ds_read_b128 v[28:31], v5 offset:16384
  ds_read_b128 v[32:35], v5 offset:3072
  s_waitcnt lgkmcnt(6)
  v_mfma_f32_16x16x32_bf16 v[40:43], v[8:11], a[0:3], 0
  v_mfma_f32_16x16x32_bf16 v[44:47], v[8:11], a[56:59], 0
  v_mfma_f32_16x16x32_bf16 v[48:51], v[8:11], a[112:115], 0
  v_mfma_f32_16x16x32_bf16 v[52:55], v[8:11], a[168:171], 0
  ds_read_b128 v[36:39], v5 offset:17408
  s_waitcnt lgkmcnt(6)
  v_mfma_f32_16x16x32_bf16 v[56:59], v[12:15], a[0:3], 0
  v_mfma_f32_16x16x32_bf16 v[60:63], v[12:15], a[56:59], 0
  v_mfma_f32_16x16x32_bf16 v[64:67], v[12:15], a[112:115], 0
  v_mfma_f32_16x16x32_bf16 v[68:71], v[12:15], a[168:171], 0
  ds_read_b128 v[8:11], v5 offset:4096
  s_waitcnt lgkmcnt(6)
  v_mfma_f32_16x16x32_bf16 v[40:43], v[16:19], a[4:7], v[40:43]
  v_mfma_f32_16x16x32_bf16 v[44:47], v[16:19], a[60:63], v[44:47]
  v_mfma_f32_16x16x32_bf16 v[48:51], v[16:19], a[116:119], v[48:51]
  v_mfma_f32_16x16x32_bf16 v[52:55], v[16:19], a[172:175], v[52:55]
  ds_read_b128 v[12:15], v5 offset:18432
  s_waitcnt lgkmcnt(6)
  v_mfma_f32_16x16x32_bf16 v[56:59], v[20:23], a[4:7], v[56:59]
  v_mfma_f32_16x16x32_bf16 v[60:63], v[20:23], a[60:63], v[60:63]
  v_mfma_f32_16x16x32_bf16 v[64:67], v[20:23], a[116:119], v[64:67]
  v_mfma_f32_16x16x32_bf16 v[68:71], v[20:23], a[172:175], v[68:71]
  ds_read_b128 v[16:19], v5 offset:5120
  s_waitcnt lgkmcnt(6)
  v_mfma_f32_16x16x32_bf16 v[40:43], v[24:27], a[8:11], v[40:43]
  v_mfma_f32_16x16x32_bf16 v[44:47], v[24:27], a[64:67], v[44:47]
  v_mfma_f32_16x16x32_bf16 v[48:51], v[24:27], a[120:123], v[48:51]
  v_mfma_f32_16x16x32_bf16 v[52:55], v[24:27], a[176:179], v[52:55]
  ds_read_b128 v[20:23], v5 offset:19456
  s_waitcnt lgkmcnt(6)
  v_mfma_f32_16x16x32_bf16 v[56:59], v[28:31], a[8:11], v[56:59]
  v_mfma_f32_16x16x32_bf16 v[60:63], v[28:31], a[64:67], v[60:63]
  v_mfma_f32_16x16x32_bf16 v[64:67], v[28:31], a[120:123], v[64:67]
  v_mfma_f32_16x16x32_bf16 v[68:71], v[28:31], a[176:179], v[68:71]
  ds_read_b128 v[24:27], v5 offset:6144
  s_waitcnt lgkmcnt(6)
  v_mfma_f32_16x16x32_bf16 v[40:43], v[32:35], a[12:15], v[40:43]
  v_mfma_f32_16x16x32_bf16 v[44:47], v[32:35], a[68:71], v[44:47]
  v_mfma_f32_16x16x32_bf16 v[48:51], v[32:35], a[124:127], v[48:51]
  v_mfma_f32_16x16x32_bf16 v[52:55], v[32:35], a[180:183], v[52:55]
  ds_read_b128 v[28:31], v5 offset:20480
  s_waitcnt lgkmcnt(6)
  v_mfma_f32_16x16x32_bf16 v[56:59], v[36:39], a[12:15], v[56:59]
  v_mfma_f32_16x16x32_bf16 v[60:63], v[36:39], a[68:71], v[60:63]
  v_mfma_f32_16x16x32_bf16 v[64:67], v[36:39], a[124:127], v[64:67]
  v_mfma_f32_16x16x32_bf16 v[68:71], v[36:39], a[180:183], v[68:71]
  ds_read_b128 v[32:35], v5 offset:7168
  s_waitcnt lgkmcnt(6)
  v_mfma_f32_16x16x32_bf16 v[40:43], v[8:11], a[16:19], v[40:43]
  v_mfma_f32_16x16x32_bf16 v[44:47], v[8:11], a[72:75], v[44:47]
  v_mfma_f32_16x16x32_bf16 v[48:51], v[8:11], a[128:131], v[48:51]
  v_mfma_f32_16x16x32_bf16 v[52:55], v[8:11], a[184:187], v[52:55]
  ds_read_b128 v[36:39], v5 offset:21504
  s_waitcnt lgkmcnt(6)
  v_mfma_f32_16x16x32_bf16 v[56:59], v[12:15], a[16:19], v[56:59]
  v_mfma_f32_16x16x32_bf16 v[60:63], v[12:15], a[72:75], v[60:63]
  v_mfma_f32_16x16x32_bf16 v[64:67], v[12:15], a[128:131], v[64:67]
  v_mfma_f32_16x16x32_bf16 v[68:71], v[12:15], a[184:187], v[68:71]
  ds_read_b128 v[8:11], v5 offset:8192
  s_waitcnt lgkmcnt(6)
  v_mfma_f32_16x16x32_bf16 v[40:43], v[16:19], a[20:23], v[40:43]
  v_mfma_f32_16x16x32_bf16 v[44:47], v[16:19], a[76:79], v[44:47]
  v_mfma_f32_16x16x32_bf16 v[48:51], v[16:19], a[132:135], v[48:51]
  v_mfma_f32_16x16x32_bf16 v[52:55], v[16:19], a[188:191], v[52:55]
  ds_read_b128 v[12:15], v5 offset:22528
  s_waitcnt lgkmcnt(6)
  v_mfma_f32_16x16x32_bf16 v[56:59], v[20:23], a[20:23], v[56:59]
  v_mfma_f32_16x16x32_bf16 v[60:63], v[20:23], a[76:79], v[60:63]
  v_mfma_f32_16x16x32_bf16 v[64:67], v[20:23], a[132:135], v[64:67]
  v_mfma_f32_16x16x32_bf16 v[68:71], v[20:23], a[188:191], v[68:71]
  ds_read_b128 v[16:19], v5 offset:9216
  s_waitcnt lgkmcnt(6)
  v_mfma_f32_16x16x32_bf16 v[40:43], v[24:27], a[24:27], v[40:43]
  v_mfma_f32_16x16x32_bf16 v[44:47], v[24:27], a[80:83], v[44:47]
  v_mfma_f32_16x16x32_bf16 v[48:51], v[24:27], a[136:139], v[48:51]
  v_mfma_f32_16x16x32_bf16 v[52:55], v[24:27], a[192:195], v[52:55]
  ds_read_b128 v[20:23], v5 offset:23552
  s_waitcnt lgkmcnt(6)
  v_mfma_f32_16x16x32_bf16 v[56:59], v[28:31], a[24:27], v[56:59]
  v_mfma_f32_16x16x32_bf16 v[60:63], v[28:31], a[80:83], v[60:63]
  v_mfma_f32_16x16x32_bf16 v[64:67], v[28:31], a[136:139], v[64:67]
  v_mfma_f32_16x16x32_bf16 v[68:71], v[28:31], a[192:195], v[68:71]
  ds_read_b128 v[24:27], v5 offset:10240
  s_waitcnt lgkmcnt(6)
  v_mfma_f32_16x16x32_bf16 v[40:43], v[32:35], a[28:31], v[40:43]
  v_mfma_f32_16x16x32_bf16 v[44:47], v[32:35], a[84:87], v[44:47]
  v_mfma_f32_16x16x32_bf16 v[48:51], v[32:35], a[140:143], v[48:51]
  v_mfma_f32_16x16x32_bf16 v[52:55], v[32:35], a[196:199], v[52:55]
  ds_read_b128 v[28:31], v5 offset:24576
  s_waitcnt lgkmcnt(6)
  v_mfma_f32_16x16x32_bf16 v[56:59], v[36:39], a[28:31], v[56:59]
  v_mfma_f32_16x16x32_bf16 v[60:63], v[36:39], a[84:87], v[60:63]
  v_mfma_f32_16x16x32_bf16 v[64:67], v[36:39], a[140:143], v[64:67]
  v_mfma_f32_16x16x32_bf16 v[68:71], v[36:39], a[196:199], v[68:71]
  ds_read_b128 v[32:35], v5 offset:11264
  s_waitcnt lgkmcnt(6)
  v_mfma_f32_16x16x32_bf16 v[40:43], v[8:11], a[32:35], v[40:43]
  v_mfma_f32_16x16x32_bf16 v[44:47], v[8:11], a[88:91], v[44:47]
  v_mfma_f32_16x16x32_bf16 v[48:51], v[8:11], a[144:147], v[48:51]
  v_mfma_f32_16x16x32_bf16 v[52:55], v[8:11], a[200:203], v[52:55]
  ds_read_b128 v[36:39], v5 offset:25600
  s_waitcnt lgkmcnt(6)
  v_mfma_f32_16x16x32_bf16 v[56:59], v[12:15], a[32:35], v[56:59]
  v_mfma_f32_16x16x32_bf16 v[60:63], v[12:15], a[88:91], v[60:63]
  v_mfma_f32_16x16x32_bf16 v[64:67], v[12:15], a[144:147], v[64:67]
  v_mfma_f32_16x16x32_bf16 v[68:71], v[12:15], a[200:203], v[68:71]
  ds_read_b128 v[8:11], v5 offset:12288
  s_waitcnt lgkmcnt(6)
  v_mfma_f32_16x16x32_bf16 v[40:43], v[16:19], a[36:39], v[40:43]
  v_mfma_f32_16x16x32_bf16 v[44:47], v[16:19], a[92:95], v[44:47]
  v_mfma_f32_16x16x32_bf16 v[48:51], v[16:19], a[148:151], v[48:51]
  v_mfma_f32_16x16x32_bf16 v[52:55], v[16:19], a[204:207], v[52:55]
  ds_read_b128 v[12:15], v5 offset:26624
  s_waitcnt lgkmcnt(6)
  v_mfma_f32_16x16x32_bf16 v[56:59], v[20:23], a[36:39], v[56:59]
  v_mfma_f32_16x16x32_bf16 v[60:63], v[20:23], a[92:95], v[60:63]
  v_mfma_f32_16x16x32_bf16 v[64:67], v[20:23], a[148:151], v[64:67]
  v_mfma_f32_16x16x32_bf16 v[68:71], v[20:23], a[204:207], v[68:71]
  ds_read_b128 v[16:19], v5 offset:13312
  s_waitcnt lgkmcnt(6)
  v_mfma_f32_16x16x32_bf16 v[40:43], v[24:27], a[40:43], v[40:43]
  v_mfma_f32_16x16x32_bf16 v[44:47], v[24:27], a[96:99], v[44:47]
  v_mfma_f32_16x16x32_bf16 v[48:51], v[24:27], a[152:155], v[48:51]
  v_mfma_f32_16x16x32_bf16 v[52:55], v[24:27], a[208:211], v[52:55]
  ds_read_b128 v[20:23], v5 offset:27648
  s_waitcnt lgkmcnt(6)
  v_mfma_f32_16x16x32_bf16 v[56:59], v[28:31], a[40:43], v[56:59]
  v_mfma_f32_16x16x32_bf16 v[60:63], v[28:31], a[96:99], v[60:63]
  v_mfma_f32_16x16x32_bf16 v[64:67], v[28:31], a[152:155], v[64:67]
  v_mfma_f32_16x16x32_bf16 v[68:71], v[28:31], a[208:211], v[68:71]
  s_waitcnt lgkmcnt(5)
  v_mfma_f32_16x16x32_bf16 v[40:43], v[32:35], a[44:47], v[40:43]
  v_mfma_f32_16x16x32_bf16 v[44:47], v[32:35], a[100:103], v[44:47]
  v_mfma_f32_16x16x32_bf16 v[48:51], v[32:35], a[156:159], v[48:51]
  v_mfma_f32_16x16x32_bf16 v[52:55], v[32:35], a[212:215], v[52:55]
  s_waitcnt lgkmcnt(4)
  v_mfma_f32_16x16x32_bf16 v[56:59], v[36:39], a[44:47], v[56:59]
  v_mfma_f32_16x16x32_bf16 v[60:63], v[36:39], a[100:103], v[60:63]
  v_mfma_f32_16x16x32_bf16 v[64:67], v[36:39], a[156:159], v[64:67]
  v_mfma_f32_16x16x32_bf16 v[68:71], v[36:39], a[212:215], v[68:71]
  s_waitcnt lgkmcnt(3)
  v_mfma_f32_16x16x32_bf16 v[40:43], v[8:11], a[48:51], v[40:43]
  v_mfma_f32_16x16x32_bf16 v[44:47], v[8:11], a[104:107], v[44:47]
  v_mfma_f32_16x16x32_bf16 v[48:51], v[8:11], a[160:163], v[48:51]
  v_mfma_f32_16x16x32_bf16 v[52:55], v[8:11], a[216:219], v[52:55]
  s_waitcnt lgkmcnt(2)
  v_mfma_f32_16x16x32_bf16 v[56:59], v[12:15], a[48:51], v[56:59]
  v_mfma_f32_16x16x32_bf16 v[60:63], v[12:15], a[104:107], v[60:63]
  v_mfma_f32_16x16x32_bf16 v[64:67], v[12:15], a[160:163], v[64:67]
  v_mfma_f32_16x16x32_bf16 v[68:71], v[12:15], a[216:219], v[68:71]
  s_waitcnt lgkmcnt(1)
  v_mfma_f32_16x16x32_bf16 v[40:43], v[16:19], a[52:55], v[40:43]
  v_mfma_f32_16x16x32_bf16 v[44:47], v[16:19], a[108:111], v[44:47]
  v_mfma_f32_16x16x32_bf16 v[48:51], v[16:19], a[164:167], v[48:51]
  v_mfma_f32_16x16x32_bf16 v[52:55], v[16:19], a[220:223], v[52:55]
  s_waitcnt lgkmcnt(0)
  v_mfma_f32_16x16x32_bf16 v[56:59], v[20:23], a[52:55], v[56:59]
  v_mfma_f32_16x16x32_bf16 v[60:63], v[20:23], a[108:111], v[60:63]
  v_mfma_f32_16x16x32_bf16 v[64:67], v[20:23], a[164:167], v[64:67]
  v_mfma_f32_16x16x32_bf16 v[68:71], v[20:23], a[220:223], v[68:71]
  s_lshl_b32 s24, s19, 10
  s_add_u32 s24, s24, s29
  v_cvt_pk_bf16_f32 v72, v40, v41
  v_cvt_pk_bf16_f32 v73, v42, v43
  v_cvt_pk_bf16_f32 v74, v56, v57
  v_cvt_pk_bf16_f32 v75, v58, v59
  s_add_u32 s25, s24, 0
  buffer_store_dwordx4 v[72:75], v2, s[8:11], s25 offen sc1
  v_cvt_pk_bf16_f32 v76, v44, v45
  v_cvt_pk_bf16_f32 v77, v46, v47
  v_cvt_pk_bf16_f32 v78, v60, v61
  v_cvt_pk_bf16_f32 v79, v62, v63
  s_add_u32 s25, s24, 14336
  buffer_store_dwordx4 v[76:79], v2, s[8:11], s25 offen sc1
  v_cvt_pk_bf16_f32 v80, v48, v49
  v_cvt_pk_bf16_f32 v81, v50, v51
  v_cvt_pk_bf16_f32 v82, v64, v65
  v_cvt_pk_bf16_f32 v83, v66, v67
  s_add_u32 s25, s24, 458752
  buffer_store_dwordx4 v[80:83], v2, s[8:11], s25 offen sc1
  v_cvt_pk_bf16_f32 v84, v52, v53
  v_cvt_pk_bf16_f32 v85, v54, v55
  v_cvt_pk_bf16_f32 v86, v68, v69
  v_cvt_pk_bf16_f32 v87, v70, v71
  s_add_u32 s25, s24, 473088
  buffer_store_dwordx4 v[84:87], v2, s[8:11], s25 offen sc1
  s_mov_b32 s33, s32
  s_add_u32 s32, s32, 28672
  s_cmp_eq_u32 s32, 86016
  s_cselect_b32 s32, 0, s32
  s_add_u32 s19, s19, 1
  s_cmp_lt_u32 s19, s35
  s_cbranch_scc1 wg_f_loop
  s_branch wg_done
wg_vo:
  s_sub_u32 s29, s17, 16
  s_mul_i32 s29, s29, 28672
  s_mul_i32 s24, s28, 458752
  s_add_u32 s29, s29, s24
  s_add_u32 s29, s29, 42205184
  v_lshlrev_b32 v6, 4, v3
  v_mul_u32_u24 v7, 12, v3
  v_add_u32 v7, 48, v7
  s_mov_b32 s31, 0
  s_lshl_b32 s24, s34, 1
  s_mul_i32 s24, s24, 14336
  s_add_u32 s24, s24, s23
  s_add_u32 m0, s31, s27
  s_nop 0
  buffer_load_dwordx4 v2, s[8:11], s24 offen offset:0 sc1 lds
  buffer_load_dwordx4 v2, s[8:11], s24 offen offset:1024 sc1 lds
  buffer_load_dwordx4 v2, s[8:11], s24 offen offset:2048 sc1 lds
  buffer_load_dwordx4 v2, s[8:11], s24 offen offset:3072 sc1 lds
  s_add_u32 m0, m0, 4096
  s_add_u32 s24, s24, 4096
  buffer_load_dwordx4 v2, s[8:11], s24 offen offset:0 sc1 lds
  buffer_load_dwordx4 v2, s[8:11], s24 offen offset:1024 sc1 lds
  buffer_load_dwordx4 v2, s[8:11], s24 offen offset:2048 sc1 lds
  s_sub_u32 s36, s35, 1
  s_add_u32 s30, s34, 1
  s_min_u32 s30, s30, s36
  s_mov_b32 s31, 28672
  s_lshl_b32 s24, s30, 1
  s_mul_i32 s24, s24, 14336
  s_add_u32 s24, s24, s23
  s_add_u32 m0, s31, s27
  s_nop 0
  buffer_load_dwordx4 v2, s[8:11], s24 offen offset:0 sc1 lds
  buffer_load_dwordx4 v2, s[8:11], s24 offen offset:1024 sc1 lds
  buffer_load_dwordx4 v2, s[8:11], s24 offen offset:2048 sc1 lds
  buffer_load_dwordx4 v2, s[8:11], s24 offen offset:3072 sc1 lds
  s_add_u32 m0, m0, 4096
  s_add_u32 s24, s24, 4096
  buffer_load_dwordx4 v2, s[8:11], s24 offen offset:0 sc1 lds
  buffer_load_dwordx4 v2, s[8:11], s24 offen offset:1024 sc1 lds
  buffer_load_dwordx4 v2, s[8:11], s24 offen offset:2048 sc1 lds
  s_mov_b32 s19, s34
  s_mov_b32 s32, 0
  s_mov_b32 s33, 57344
  s_cmp_eq_u32 s18, s101
  s_cbranch_scc1 wg_vo_hx
  s_add_u32 s22, s21, 0
  buffer_load_dwordx4 a[0:3], v2, s[8:11], s22 offen offset:0 sc1
  buffer_load_dwordx4 a[4:7], v2, s[8:11], s22 offen offset:1024 sc1
  buffer_load_dwordx4 a[8:11], v2, s[8:11], s22 offen offset:2048 sc1
  buffer_load_dwordx4 a[12:15], v2, s[8:11], s22 offen offset:3072 sc1
  s_add_u32 s22, s21, 4096
  buffer_load_dwordx4 a[16:19], v2, s[8:11], s22 offen offset:0 sc1
  buffer_load_dwordx4 a[20:23], v2, s[8:11], s22 offen offset:1024 sc1
  buffer_load_dwordx4 a[24:27], v2, s[8:11], s22 offen offset:2048 sc1
  buffer_load_dwordx4 a[28:31], v2, s[8:11], s22 offen offset:3072 sc1
  s_add_u32 s22, s21, 8192
  buffer_load_dwordx4 a[32:35], v2, s[8:11], s22 offen offset:0 sc1
  buffer_load_dwordx4 a[36:39], v2, s[8:11], s22 offen offset:1024 sc1
  buffer_load_dwordx4 a[40:43], v2, s[8:11], s22 offen offset:2048 sc1
  buffer_load_dwordx4 a[44:47], v2, s[8:11], s22 offen offset:3072 sc1
  s_add_u32 s22, s21, 12288
  buffer_load_dwordx4 a[48:51], v2, s[8:11], s22 offen offset:0 sc1
  buffer_load_dwordx4 a[52:55], v2, s[8:11], s22 offen offset:1024 sc1
  buffer_load_dwordx4 a[56:59], v2, s[8:11], s22 offen offset:2048 sc1
  buffer_load_dwordx4 a[60:63], v2, s[8:11], s22 offen offset:3072 sc1
  s_add_u32 s22, s21, 16384
  buffer_load_dwordx4 a[64:67], v2, s[8:11], s22 offen offset:0 sc1
  buffer_load_dwordx4 a[68:71], v2, s[8:11], s22 offen offset:1024 sc1
  buffer_load_dwordx4 a[72:75], v2, s[8:11], s22 offen offset:2048 sc1
  buffer_load_dwordx4 a[76:79], v2, s[8:11], s22 offen offset:3072 sc1
  s_add_u32 s22, s21, 20480
  buffer_load_dwordx4 a[80:83], v2, s[8:11], s22 offen offset:0 sc1
  buffer_load_dwordx4 a[84:87], v2, s[8:11], s22 offen offset:1024 sc1
  buffer_load_dwordx4 a[88:91], v2, s[8:11], s22 offen offset:2048 sc1
  buffer_load_dwordx4 a[92:95], v2, s[8:11], s22 offen offset:3072 sc1
  s_add_u32 s22, s21, 24576
  buffer_load_dwordx4 a[96:99], v2, s[8:11], s22 offen offset:0 sc1
  buffer_load_dwordx4 a[100:103], v2, s[8:11], s22 offen offset:1024 sc1
  buffer_load_dwordx4 a[104:107], v2, s[8:11], s22 offen offset:2048 sc1
  buffer_load_dwordx4 a[108:111], v2, s[8:11], s22 offen offset:3072 sc1
  s_add_u32 s22, s21, 28672
  buffer_load_dwordx4 a[112:115], v2, s[8:11], s22 offen offset:0 sc1
  buffer_load_dwordx4 a[116:119], v2, s[8:11], s22 offen offset:1024 sc1
  buffer_load_dwordx4 a[120:123], v2, s[8:11], s22 offen offset:2048 sc1
  buffer_load_dwordx4 a[124:127], v2, s[8:11], s22 offen offset:3072 sc1
  s_add_u32 s22, s21, 32768
  buffer_load_dwordx4 a[128:131], v2, s[8:11], s22 offen offset:0 sc1
  buffer_load_dwordx4 a[132:135], v2, s[8:11], s22 offen offset:1024 sc1
  buffer_load_dwordx4 a[136:139], v2, s[8:11], s22 offen offset:2048 sc1
  buffer_load_dwordx4 a[140:143], v2, s[8:11], s22 offen offset:3072 sc1
  s_add_u32 s22, s21, 36864
  buffer_load_dwordx4 a[144:147], v2, s[8:11], s22 offen offset:0 sc1
  buffer_load_dwordx4 a[148:151], v2, s[8:11], s22 offen offset:1024 sc1
  buffer_load_dwordx4 a[152:155], v2, s[8:11], s22 offen offset:2048 sc1
  buffer_load_dwordx4 a[156:159], v2, s[8:11], s22 offen offset:3072 sc1
  s_add_u32 s22, s21, 40960
  s_waitcnt vmcnt(40)
  buffer_load_dwordx4 a[160:163], v2, s[8:11], s22 offen offset:0 sc1
  buffer_load_dwordx4 a[164:167], v2, s[8:11], s22 offen offset:1024 sc1
  buffer_load_dwordx4 a[168:171], v2, s[8:11], s22 offen offset:2048 sc1
  buffer_load_dwordx4 a[172:175], v2, s[8:11], s22 offen offset:3072 sc1
  s_add_u32 s22, s21, 45056
  buffer_load_dwordx4 a[176:179], v2, s[8:11], s22 offen offset:0 sc1
  buffer_load_dwordx4 a[180:183], v2, s[8:11], s22 offen offset:1024 sc1
  buffer_load_dwordx4 a[184:187], v2, s[8:11], s22 offen offset:2048 sc1
  buffer_load_dwordx4 a[188:191], v2, s[8:11], s22 offen offset:3072 sc1
  s_add_u32 s22, s21, 49152
  buffer_load_dwordx4 a[192:195], v2, s[8:11], s22 offen offset:0 sc1
  buffer_load_dwordx4 a[196:199], v2, s[8:11], s22 offen offset:1024 sc1
  buffer_load_dwordx4 a[200:203], v2, s[8:11], s22 offen offset:2048 sc1
  buffer_load_dwordx4 a[204:207], v2, s[8:11], s22 offen offset:3072 sc1
  s_add_u32 s22, s21, 53248
  buffer_load_dwordx4 a[208:211], v2, s[8:11], s22 offen offset:0 sc1
  buffer_load_dwordx4 a[212:215], v2, s[8:11], s22 offen offset:1024 sc1
  buffer_load_dwordx4 a[216:219], v2, s[8:11], s22 offen offset:2048 sc1
  buffer_load_dwordx4 a[220:223], v2, s[8:11], s22 offen offset:3072 sc1
wg_vo_hx:
  s_mov_b32 s101, -1
  s_waitcnt vmcnt(0)
  s_branch wg_vo_in
wg_vo_loop:
  s_waitcnt vmcnt(11)
wg_vo_in:
  s_barrier
  s_add_u32 s30, s19, 2
  s_min_u32 s30, s30, s36
  s_lshl_b32 s24, s30, 1
  s_mul_i32 s24, s24, 14336
  s_add_u32 s24, s24, s23
  s_add_u32 m0, s33, s27
  s_nop 0
  buffer_load_dwordx4 v2, s[8:11], s24 offen offset:0 sc1 lds
  buffer_load_dwordx4 v2, s[8:11], s24 offen offset:1024 sc1 lds
  buffer_load_dwordx4 v2, s[8:11], s24 offen offset:2048 sc1 lds
  buffer_load_dwordx4 v2, s[8:11], s24 offen offset:3072 sc1 lds
  s_add_u32 m0, m0, 4096
  s_add_u32 s24, s24, 4096
  buffer_load_dwordx4 v2, s[8:11], s24 offen offset:0 sc1 lds
  buffer_load_dwordx4 v2, s[8:11], s24 offen offset:1024 sc1 lds
  buffer_load_dwordx4 v2, s[8:11], s24 offen offset:2048 sc1 lds
  v_add_u32 v5, s32, v2
  ds_read_b128 v[8:11], v5 offset:0
  ds_read_b128 v[12:15], v5 offset:14336
  ds_read_b128 v[16:19], v5 offset:1024
  ds_read_b128 v[20:23], v5 offset:15360
  ds_read_b128 v[24:27], v5 offset:2048
  ds_read_b128 v[28:31], v5 offset:16384
  ds_read_b128 v[32:35], v5 offset:3072
  s_waitcnt lgkmcnt(6)
  v_mfma_f32_16x16x32_bf16 v[40:43], a[0:3], v[8:11], 0
  v_mfma_f32_16x16x32_bf16 v[44:47], a[56:59], v[8:11], 0
  v_mfma_f32_16x16x32_bf16 v[48:51], a[112:115], v[8:11], 0
  v_mfma_f32_16x16x32_bf16 v[52:55], a[168:171], v[8:11], 0
  ds_read_b128 v[36:39], v5 offset:17408
  s_waitcnt lgkmcnt(6)
  v_mfma_f32_16x16x32_bf16 v[56:59], a[0:3], v[12:15], 0
  v_mfma_f32_16x16x32_bf16 v[60:63], a[56:59], v[12:15], 0
  v_mfma_f32_16x16x32_bf16 v[64:67], a[112:115], v[12:15], 0
  v_mfma_f32_16x16x32_bf16 v[68:71], a[168:171], v[12:15], 0
  ds_read_b128 v[8:11], v5 offset:4096
  s_waitcnt lgkmcnt(6)
  v_mfma_f32_16x16x32_bf16 v[40:43], a[4:7], v[16:19], v[40:43]
  v_mfma_f32_16x16x32_bf16 v[44:47], a[60:63], v[16:19], v[44:47]
  v_mfma_f32_16x16x32_bf16 v[48:51], a[116:119], v[16:19], v[48:51]
  v_mfma_f32_16x16x32_bf16 v[52:55], a[172:175], v[16:19], v[52:55]
  ds_read_b128 v[12:15], v5 offset:18432
  s_waitcnt lgkmcnt(6)
  v_mfma_f32_16x16x32_bf16 v[56:59], a[4:7], v[20:23], v[56:59]
  v_mfma_f32_16x16x32_bf16 v[60:63], a[60:63], v[20:23], v[60:63]
  v_mfma_f32_16x16x32_bf16 v[64:67], a[116:119], v[20:23], v[64:67]
  v_mfma_f32_16x16x32_bf16 v[68:71], a[172:175], v[20:23], v[68:71]
  ds_read_b128 v[16:19], v5 offset:5120
  s_waitcnt lgkmcnt(6)
  v_mfma_f32_16x16x32_bf16 v[40:43], a[8:11], v[24:27], v[40:43]
  v_mfma_f32_16x16x32_bf16 v[44:47], a[64:67], v[24:27], v[44:47]
  v_mfma_f32_16x16x32_bf16 v[48:51], a[120:123], v[24:27], v[48:51]
  v_mfma_f32_16x16x32_bf16 v[52:55], a[176:179], v[24:27], v[52:55]
  ds_read_b128 v[20:23], v5 offset:19456
  s_waitcnt lgkmcnt(6)
  v_mfma_f32_16x16x32_bf16 v[56:59], a[8:11], v[28:31], v[56:59]
  v_mfma_f32_16x16x32_bf16 v[60:63], a[64:67], v[28:31], v[60:63]
  v_mfma_f32_16x16x32_bf16 v[64:67], a[120:123], v[28:31], v[64:67]
  v_mfma_f32_16x16x32_bf16 v[68:71], a[176:179], v[28:31], v[68:71]
  ds_read_b128 v[24:27], v5 offset:6144
  s_waitcnt lgkmcnt(6)
  v_mfma_f32_16x16x32_bf16 v[40:43], a[12:15], v[32:35], v[40:43]
  v_mfma_f32_16x16x32_bf16 v[44:47], a[68:71], v[32:35], v[44:47]
  v_mfma_f32_16x16x32_bf16 v[48:51], a[124:127], v[32:35], v[48:51]
  v_mfma_f32_16x16x32_bf16 v[52:55], a[180:183], v[32:35], v[52:55]
  ds_read_b128 v[28:31], v5 offset:20480
  s_waitcnt lgkmcnt(6)
  v_mfma_f32_16x16x32_bf16 v[56:59], a[12:15], v[36:39], v[56:59]
  v_mfma_f32_16x16x32_bf16 v[60:63], a[68:71], v[36:39], v[60:63]
  v_mfma_f32_16x16x32_bf16 v[64:67], a[124:127], v[36:39], v[64:67]
  v_mfma_f32_16x16x32_bf16 v[68:71], a[180:183], v[36:39], v[68:71]
  ds_read_b128 v[32:35], v5 offset:7168
  s_waitcnt lgkmcnt(6)
  v_mfma_f32_16x16x32_bf16 v[40:43], a[16:19], v[8:11], v[40:43]
  v_mfma_f32_16x16x32_bf16 v[44:47], a[72:75], v[8:11], v[44:47]
  v_mfma_f32_16x16x32_bf16 v[48:51], a[128:131], v[8:11], v[48:51]
  v_mfma_f32_16x16x32_bf16 v[52:55], a[184:187], v[8:11], v[52:55]
  ds_read_b128 v[36:39], v5 offset:21504
  s_waitcnt lgkmcnt(6)
  v_mfma_f32_16x16x32_bf16 v[56:59], a[16:19], v[12:15], v[56:59]
  v_mfma_f32_16x16x32_bf16 v[60:63], a[72:75], v[12:15], v[60:63]
  v_mfma_f32_16x16x32_bf16 v[64:67], a[128:131], v[12:15], v[64:67]
  v_mfma_f32_16x16x32_bf16 v[68:71], a[184:187], v[12:15], v[68:71]
  ds_read_b128 v[8:11], v5 offset:8192
  s_waitcnt lgkmcnt(6)
  v_mfma_f32_16x16x32_bf16 v[40:43], a[20:23], v[16:19], v[40:43]
  v_mfma_f32_16x16x32_bf16 v[44:47], a[76:79], v[16:19], v[44:47]
  v_mfma_f32_16x16x32_bf16 v[48:51], a[132:135], v[16:19], v[48:51]
  v_mfma_f32_16x16x32_bf16 v[52:55], a[188:191], v[16:19], v[52:55]
  ds_read_b128 v[12:15], v5 offset:22528
  s_waitcnt lgkmcnt(6)
  v_mfma_f32_16x16x32_bf16 v[56:59], a[20:23], v[20:23], v[56:59]
  v_mfma_f32_16x16x32_bf16 v[60:63], a[76:79], v[20:23], v[60:63]
  v_mfma_f32_16x16x32_bf16 v[64:67], a[132:135], v[20:23], v[64:67]
  v_mfma_f32_16x16x32_bf16 v[68:71], a[188:191], v[20:23], v[68:71]
  ds_read_b128 v[16:19], v5 offset:9216
  s_waitcnt lgkmcnt(6)
  v_mfma_f32_16x16x32_bf16 v[40:43], a[24:27], v[24:27], v[40:43]
  v_mfma_f32_16x16x32_bf16 v[44:47], a[80:83], v[24:27], v[44:47]
  v_mfma_f32_16x16x32_bf16 v[48:51], a[136:139], v[24:27], v[48:51]
  v_mfma_f32_16x16x32_bf16 v[52:55], a[192:195], v[24:27], v[52:55]
  ds_read_b128 v[20:23], v5 offset:23552
  s_waitcnt lgkmcnt(6)
  v_mfma_f32_16x16x32_bf16 v[56:59], a[24:27], v[28:31], v[56:59]
  v_mfma_f32_16x16x32_bf16 v[60:63], a[80:83], v[28:31], v[60:63]
  v_mfma_f32_16x16x32_bf16 v[64:67], a[136:139], v[28:31], v[64:67]
  v_mfma_f32_16x16x32_bf16 v[68:71], a[192:195], v[28:31], v[68:71]
  ds_read_b128 v[24:27], v5 offset:10240
  s_waitcnt lgkmcnt(6)
  v_mfma_f32_16x16x32_bf16 v[40:43], a[28:31], v[32:35], v[40:43]
  v_mfma_f32_16x16x32_bf16 v[44:47], a[84:87], v[32:35], v[44:47]
  v_mfma_f32_16x16x32_bf16 v[48:51], a[140:143], v[32:35], v[48:51]
  v_mfma_f32_16x16x32_bf16 v[52:55], a[196:199], v[32:35], v[52:55]
  ds_read_b128 v[28:31], v5 offset:24576
  s_waitcnt lgkmcnt(6)
  v_mfma_f32_16x16x32_bf16 v[56:59], a[28:31], v[36:39], v[56:59]
  v_mfma_f32_16x16x32_bf16 v[60:63], a[84:87], v[36:39], v[60:63]
  v_mfma_f32_16x16x32_bf16 v[64:67], a[140:143], v[36:39], v[64:67]
  v_mfma_f32_16x16x32_bf16 v[68:71], a[196:199], v[36:39], v[68:71]
  ds_read_b128 v[32:35], v5 offset:11264
  s_waitcnt lgkmcnt(6)
  v_mfma_f32_16x16x32_bf16 v[40:43], a[32:35], v[8:11], v[40:43]
  v_mfma_f32_16x16x32_bf16 v[44:47], a[88:91], v[8:11], v[44:47]
  v_mfma_f32_16x16x32_bf16 v[48:51], a[144:147], v[8:11], v[48:51]
  v_mfma_f32_16x16x32_bf16 v[52:55], a[200:203], v[8:11], v[52:55]
  ds_read_b128 v[36:39], v5 offset:25600
  s_waitcnt lgkmcnt(6)
  v_mfma_f32_16x16x32_bf16 v[56:59], a[32:35], v[12:15], v[56:59]
  v_mfma_f32_16x16x32_bf16 v[60:63], a[88:91], v[12:15], v[60:63]
  v_mfma_f32_16x16x32_bf16 v[64:67], a[144:147], v[12:15], v[64:67]
  v_mfma_f32_16x16x32_bf16 v[68:71], a[200:203], v[12:15], v[68:71]
  ds_read_b128 v[8:11], v5 offset:12288
  s_waitcnt lgkmcnt(6)
  v_mfma_f32_16x16x32_bf16 v[40:43], a[36:39], v[16:19], v[40:43]
  v_mfma_f32_16x16x32_bf16 v[44:47], a[92:95], v[16:19], v[44:47]
  v_mfma_f32_16x16x32_bf16 v[48:51], a[148:151], v[16:19], v[48:51]
  v_mfma_f32_16x16x32_bf16 v[52:55], a[204:207], v[16:19], v[52:55]
  ds_read_b128 v[12:15], v5 offset:26624
  s_waitcnt lgkmcnt(6)
  v_mfma_f32_16x16x32_bf16 v[56:59], a[36:39], v[20:23], v[56:59]
  v_mfma_f32_16x16x32_bf16 v[60:63], a[92:95], v[20:23], v[60:63]
  v_mfma_f32_16x16x32_bf16 v[64:67], a[148:151], v[20:23], v[64:67]
  v_mfma_f32_16x16x32_bf16 v[68:71], a[204:207], v[20:23], v[68:71]
  ds_read_b128 v[16:19], v5 offset:13312
  s_waitcnt lgkmcnt(6)
  v_mfma_f32_16x16x32_bf16 v[40:43], a[40:43], v[24:27], v[40:43]
  v_mfma_f32_16x16x32_bf16 v[44:47], a[96:99], v[24:27], v[44:47]
  v_mfma_f32_16x16x32_bf16 v[48:51], a[152:155], v[24:27], v[48:51]
  v_mfma_f32_16x16x32_bf16 v[52:55], a[208:211], v[24:27], v[52:55]
  ds_read_b128 v[20:23], v5 offset:27648
  s_waitcnt lgkmcnt(6)
  v_mfma_f32_16x16x32_bf16 v[56:59], a[40:43], v[28:31], v[56:59]
  v_mfma_f32_16x16x32_bf16 v[60:63], a[96:99], v[28:31], v[60:63]
  v_mfma_f32_16x16x32_bf16 v[64:67], a[152:155], v[28:31], v[64:67]
  v_mfma_f32_16x16x32_bf16 v[68:71], a[208:211], v[28:31], v[68:71]
  s_waitcnt lgkmcnt(5)
  v_mfma_f32_16x16x32_bf16 v[40:43], a[44:47], v[32:35], v[40:43]
  v_mfma_f32_16x16x32_bf16 v[44:47], a[100:103], v[32:35], v[44:47]
  v_mfma_f32_16x16x32_bf16 v[48:51], a[156:159], v[32:35], v[48:51]
  v_mfma_f32_16x16x32_bf16 v[52:55], a[212:215], v[32:35], v[52:55]
  s_waitcnt lgkmcnt(4)
  v_mfma_f32_16x16x32_bf16 v[56:59], a[44:47], v[36:39], v[56:59]
  v_mfma_f32_16x16x32_bf16 v[60:63], a[100:103], v[36:39], v[60:63]
  v_mfma_f32_16x16x32_bf16 v[64:67], a[156:159], v[36:39], v[64:67]
  v_mfma_f32_16x16x32_bf16 v[68:71], a[212:215], v[36:39], v[68:71]
  s_waitcnt lgkmcnt(3)
  v_mfma_f32_16x16x32_bf16 v[40:43], a[48:51], v[8:11], v[40:43]
  v_mfma_f32_16x16x32_bf16 v[44:47], a[104:107], v[8:11], v[44:47]
  v_mfma_f32_16x16x32_bf16 v[48:51], a[160:163], v[8:11], v[48:51]
  v_mfma_f32_16x16x32_bf16 v[52:55], a[216:219], v[8:11], v[52:55]
  s_waitcnt lgkmcnt(2)
  v_mfma_f32_16x16x32_bf16 v[56:59], a[48:51], v[12:15], v[56:59]
  v_mfma_f32_16x16x32_bf16 v[60:63], a[104:107], v[12:15], v[60:63]
  v_mfma_f32_16x16x32_bf16 v[64:67], a[160:163], v[12:15], v[64:67]
  v_mfma_f32_16x16x32_bf16 v[68:71], a[216:219], v[12:15], v[68:71]
  s_waitcnt lgkmcnt(1)
  v_mfma_f32_16x16x32_bf16 v[40:43], a[52:55], v[16:19], v[40:43]
  v_mfma_f32_16x16x32_bf16 v[44:47], a[108:111], v[16:19], v[44:47]
  v_mfma_f32_16x16x32_bf16 v[48:51], a[164:167], v[16:19], v[48:51]
  v_mfma_f32_16x16x32_bf16 v[52:55], a[220:223], v[16:19], v[52:55]
  s_waitcnt lgkmcnt(0)
  v_mfma_f32_16x16x32_bf16 v[56:59], a[52:55], v[20:23], v[56:59]
  v_mfma_f32_16x16x32_bf16 v[60:63], a[108:111], v[20:23], v[60:63]
  v_mfma_f32_16x16x32_bf16 v[64:67], a[164:167], v[20:23], v[64:67]
  v_mfma_f32_16x16x32_bf16 v[68:71], a[220:223], v[20:23], v[68:71]
  s_add_u32 s25, s29, 458752
  s_lshl_b32 s24, s19, 5
  s_add_u32 s24, s24, 0
  v_add_u32 v88, s24, v4
  v_mul_u32_u24 v89, 2341, v88
  v_lshrrev_b32 v89, 16, v89
  v_mul_u32_u24 v92, 28, v89
  v_sub_u32 v92, v88, v92
  v_cmp_gt_u32 vcc, 16, v92
  v_mul_u32_u24 v89, 84, v89
  s_nop 0
  v_cndmask_b32 v92, v7, v6, vcc
  v_add3_u32 v88, v88, v89, v92
  v_lshlrev_b32 v90, 4, v88
  v_cvt_pk_bf16_f32 v72, v40, v44
  v_cvt_pk_bf16_f32 v73, v41, v45
  v_cvt_pk_bf16_f32 v74, v42, v46
  v_cvt_pk_bf16_f32 v75, v43, v47
  buffer_store_dwordx4 v[72:75], v90, s[8:11], s29 offen sc1
  v_cvt_pk_bf16_f32 v76, v48, v52
  v_cvt_pk_bf16_f32 v77, v49, v53
  v_cvt_pk_bf16_f32 v78, v50, v54
  v_cvt_pk_bf16_f32 v79, v51, v55
  buffer_store_dwordx4 v[76:79], v90, s[8:11], s25 offen sc1
  s_lshl_b32 s24, s19, 5
  s_add_u32 s24, s24, 16
  v_add_u32 v88, s24, v4
  v_mul_u32_u24 v89, 2341, v88
  v_lshrrev_b32 v89, 16, v89
  v_mul_u32_u24 v92, 28, v89
  v_sub_u32 v92, v88, v92
  v_cmp_gt_u32 vcc, 16, v92
  v_mul_u32_u24 v89, 84, v89
  s_nop 0
  v_cndmask_b32 v92, v7, v6, vcc
  v_add3_u32 v88, v88, v89, v92
  v_lshlrev_b32 v91, 4, v88
  v_cvt_pk_bf16_f32 v80, v56, v60
  v_cvt_pk_bf16_f32 v81, v57, v61
  v_cvt_pk_bf16_f32 v82, v58, v62
  v_cvt_pk_bf16_f32 v83, v59, v63
  buffer_store_dwordx4 v[80:83], v91, s[8:11], s29 offen sc1
  v_cvt_pk_bf16_f32 v84, v64, v68
  v_cvt_pk_bf16_f32 v85, v65, v69
  v_cvt_pk_bf16_f32 v86, v66, v70
  v_cvt_pk_bf16_f32 v87, v67, v71
  buffer_store_dwordx4 v[84:87], v91, s[8:11], s25 offen sc1
  s_mov_b32 s33, s32
  s_add_u32 s32, s32, 28672
  s_cmp_eq_u32 s32, 86016
  s_cselect_b32 s32, 0, s32
  s_add_u32 s19, s19, 1
  s_cmp_lt_u32 s19, s35
  s_cbranch_scc1 wg_vo_loop
  s_branch wg_done
wg_done:
  s_lshl_b32 s20, s18, 4
  s_and_b32 s21, s17, 15
  s_add_u32 s20, s20, s21
  s_lshl_b32 s20, s20, 7
  s_cmp_lt_u32 s17, 16
  s_cselect_b32 s21, 16384, 0
  s_add_u32 s20, s20, s21
  s_add_u32 s20, s20, 88461312
  s_sub_u32 s21, s35, s34
  s_lshl_b32 s21, s21, 2
  v_mov_b32 v5, s21
  v_mov_b32 v6, 0
  s_waitcnt vmcnt(0)
  s_barrier
  s_cmp_lg_u32 s16, 0
  s_cbranch_scc1 wg_sg
  s_mov_b64 exec, 1
  buffer_atomic_add v5, v6, s[8:11], s20 offen
  s_mov_b64 exec, -1
wg_sg:
  s_branch wk_loop
wk_srv:
  s_and_b32 s18, s3, 15
  s_lshr_b32 s19, s3, 4
  s_and_b32 s19, s19, 1
  s_mul_i32 s20, s18, 401408
  s_mul_i32 s21, s16, 100352
  s_add_u32 s20, s20, s21
  s_add_u32 s20, s20, 6422528
  s_add_u32 s22, s20, 0
  buffer_load_dwordx4 a[0:3], v2, s[8:11], s22 offen offset:0 sc1
  buffer_load_dwordx4 a[4:7], v2, s[8:11], s22 offen offset:1024 sc1
  buffer_load_dwordx4 a[8:11], v2, s[8:11], s22 offen offset:2048 sc1
  buffer_load_dwordx4 a[12:15], v2, s[8:11], s22 offen offset:3072 sc1
  s_add_u32 s22, s20, 4096
  buffer_load_dwordx4 a[16:19], v2, s[8:11], s22 offen offset:0 sc1
  buffer_load_dwordx4 a[20:23], v2, s[8:11], s22 offen offset:1024 sc1
  buffer_load_dwordx4 a[24:27], v2, s[8:11], s22 offen offset:2048 sc1
  buffer_load_dwordx4 a[28:31], v2, s[8:11], s22 offen offset:3072 sc1
  s_add_u32 s22, s20, 8192
  buffer_load_dwordx4 a[32:35], v2, s[8:11], s22 offen offset:0 sc1
  buffer_load_dwordx4 a[36:39], v2, s[8:11], s22 offen offset:1024 sc1
  s_waitcnt vmcnt(8)
  buffer_load_dwordx4 a[40:43], v2, s[8:11], s22 offen offset:2048 sc1
  buffer_load_dwordx4 a[44:47], v2, s[8:11], s22 offen offset:3072 sc1
  s_waitcnt vmcnt(8)
  s_add_u32 s22, s20, 12288
  buffer_load_dwordx4 a[48:51], v2, s[8:11], s22 offen offset:0 sc1
  buffer_load_dwordx4 a[52:55], v2, s[8:11], s22 offen offset:1024 sc1
  s_waitcnt vmcnt(8)
  buffer_load_dwordx4 a[56:59], v2, s[8:11], s22 offen offset:2048 sc1
  buffer_load_dwordx4 a[60:63], v2, s[8:11], s22 offen offset:3072 sc1
  s_waitcnt vmcnt(8)
  s_add_u32 s22, s20, 16384
  buffer_load_dwordx4 a[64:67], v2, s[8:11], s22 offen offset:0 sc1
  buffer_load_dwordx4 a[68:71], v2, s[8:11], s22 offen offset:1024 sc1
  s_waitcnt vmcnt(8)
  buffer_load_dwordx4 a[72:75], v2, s[8:11], s22 offen offset:2048 sc1
  buffer_load_dwordx4 a[76:79], v2, s[8:11], s22 offen offset:3072 sc1
  s_waitcnt vmcnt(8)
  s_add_u32 s22, s20, 20480
  buffer_load_dwordx4 a[80:83], v2, s[8:11], s22 offen offset:0 sc1
  buffer_load_dwordx4 a[84:87], v2, s[8:11], s22 offen offset:1024 sc1
  s_waitcnt vmcnt(8)
  buffer_load_dwordx4 a[88:91], v2, s[8:11], s22 offen offset:2048 sc1
  buffer_load_dwordx4 a[92:95], v2, s[8:11], s22 offen offset:3072 sc1
  s_waitcnt vmcnt(8)
  s_add_u32 s22, s20, 24576
  buffer_load_dwordx4 a[96:99], v2, s[8:11], s22 offen offset:0 sc1
  buffer_load_dwordx4 a[100:103], v2, s[8:11], s22 offen offset:1024 sc1
  s_waitcnt vmcnt(8)
  buffer_load_dwordx4 a[104:107], v2, s[8:11], s22 offen offset:2048 sc1
  buffer_load_dwordx4 a[108:111], v2, s[8:11], s22 offen offset:3072 sc1
  s_waitcnt vmcnt(8)
  s_add_u32 s22, s20, 28672
  buffer_load_dwordx4 a[112:115], v2, s[8:11], s22 offen offset:0 sc1
  buffer_load_dwordx4 a[116:119], v2, s[8:11], s22 offen offset:1024 sc1
  s_waitcnt vmcnt(8)
  buffer_load_dwordx4 a[120:123], v2, s[8:11], s22 offen offset:2048 sc1
  buffer_load_dwordx4 a[124:127], v2, s[8:11], s22 offen offset:3072 sc1
  s_waitcnt vmcnt(8)
  s_add_u32 s22, s20, 32768
  buffer_load_dwordx4 a[128:131], v2, s[8:11], s22 offen offset:0 sc1
  buffer_load_dwordx4 a[132:135], v2, s[8:11], s22 offen offset:1024 sc1
  s_waitcnt vmcnt(8)
  buffer_load_dwordx4 a[136:139], v2, s[8:11], s22 offen offset:2048 sc1
  buffer_load_dwordx4 a[140:143], v2, s[8:11], s22 offen offset:3072 sc1
  s_waitcnt vmcnt(8)
  s_add_u32 s22, s20, 36864
  buffer_load_dwordx4 a[144:147], v2, s[8:11], s22 offen offset:0 sc1
  buffer_load_dwordx4 a[148:151], v2, s[8:11], s22 offen offset:1024 sc1
  s_waitcnt vmcnt(8)
  buffer_load_dwordx4 a[152:155], v2, s[8:11], s22 offen offset:2048 sc1
  buffer_load_dwordx4 a[156:159], v2, s[8:11], s22 offen offset:3072 sc1
  s_waitcnt vmcnt(8)
  s_add_u32 s22, s20, 40960
  buffer_load_dwordx4 a[160:163], v2, s[8:11], s22 offen offset:0 sc1
  buffer_load_dwordx4 a[164:167], v2, s[8:11], s22 offen offset:1024 sc1
  s_waitcnt vmcnt(8)
  buffer_load_dwordx4 a[168:171], v2, s[8:11], s22 offen offset:2048 sc1
  buffer_load_dwordx4 a[172:175], v2, s[8:11], s22 offen offset:3072 sc1
  s_waitcnt vmcnt(8)
  s_add_u32 s22, s20, 45056
  buffer_load_dwordx4 a[176:179], v2, s[8:11], s22 offen offset:0 sc1
  buffer_load_dwordx4 a[180:183], v2, s[8:11], s22 offen offset:1024 sc1
  s_waitcnt vmcnt(8)
  buffer_load_dwordx4 a[184:187], v2, s[8:11], s22 offen offset:2048 sc1
  buffer_load_dwordx4 a[188:191], v2, s[8:11], s22 offen offset:3072 sc1
  s_waitcnt vmcnt(8)
  s_add_u32 s22, s20, 49152
  buffer_load_dwordx4 a[192:195], v2, s[8:11], s22 offen offset:0 sc1
  buffer_load_dwordx4 a[196:199], v2, s[8:11], s22 offen offset:1024 sc1
  s_waitcnt vmcnt(8)
  buffer_load_dwordx4 a[200:203], v2, s[8:11], s22 offen offset:2048 sc1
  buffer_load_dwordx4 a[204:207], v2, s[8:11], s22 offen offset:3072 sc1
  s_waitcnt vmcnt(8)
  s_add_u32 s22, s20, 53248
  buffer_load_dwordx4 a[208:211], v2, s[8:11], s22 offen offset:0 sc1
  buffer_load_dwordx4 a[212:215], v2, s[8:11], s22 offen offset:1024 sc1
  s_waitcnt vmcnt(8)
  buffer_load_dwordx4 a[216:219], v2, s[8:11], s22 offen offset:2048 sc1
  buffer_load_dwordx4 a[220:223], v2, s[8:11], s22 offen offset:3072 sc1
  s_waitcnt vmcnt(8)
  s_add_u32 s22, s20, 57344
  buffer_load_dwordx4 a[224:227], v2, s[8:11], s22 offen offset:0 sc1
  buffer_load_dwordx4 a[228:231], v2, s[8:11], s22 offen offset:1024 sc1
  s_waitcnt vmcnt(8)
  buffer_load_dwordx4 a[232:235], v2, s[8:11], s22 offen offset:2048 sc1
  buffer_load_dwordx4 a[236:239], v2, s[8:11], s22 offen offset:3072 sc1
  s_waitcnt vmcnt(8)
  s_add_u32 s22, s20, 61440
  buffer_load_dwordx4 a[240:243], v2, s[8:11], s22 offen offset:0 sc1
  buffer_load_dwordx4 a[244:247], v2, s[8:11], s22 offen offset:1024 sc1
  s_waitcnt vmcnt(8)
  buffer_load_dwordx4 a[248:251], v2, s[8:11], s22 offen offset:2048 sc1
  buffer_load_dwordx4 a[252:255], v2, s[8:11], s22 offen offset:3072 sc1
  s_waitcnt vmcnt(8)
  s_add_u32 s22, s20, 65536
  buffer_load_dwordx4 v[120:123], v2, s[8:11], s22 offen offset:0 sc1
  buffer_load_dwordx4 v[124:127], v2, s[8:11], s22 offen offset:1024 sc1
  s_waitcnt vmcnt(8)
  buffer_load_dwordx4 v[128:131], v2, s[8:11], s22 offen offset:2048 sc1
  buffer_load_dwordx4 v[132:135], v2, s[8:11], s22 offen offset:3072 sc1
  s_waitcnt vmcnt(8)
  s_add_u32 s22, s20, 69632
  buffer_load_dwordx4 v[136:139], v2, s[8:11], s22 offen offset:0 sc1
  buffer_load_dwordx4 v[140:143], v2, s[8:11], s22 offen offset:1024 sc1
  s_waitcnt vmcnt(8)
  buffer_load_dwordx4 v[144:147], v2, s[8:11], s22 offen offset:2048 sc1
  buffer_load_dwordx4 v[148:151], v2, s[8:11], s22 offen offset:3072 sc1
  s_waitcnt vmcnt(8)
  s_add_u32 s22, s20, 73728
  buffer_load_dwordx4 v[152:155], v2, s[8:11], s22 offen offset:0 sc1
  buffer_load_dwordx4 v[156:159], v2, s[8:11], s22 offen offset:1024 sc1
  s_waitcnt vmcnt(8)
  buffer_load_dwordx4 v[160:163], v2, s[8:11], s22 offen offset:2048 sc1
  buffer_load_dwordx4 v[164:167], v2, s[8:11], s22 offen offset:3072 sc1
  s_waitcnt vmcnt(8)
  s_add_u32 s22, s20, 77824
  buffer_load_dwordx4 v[168:171], v2, s[8:11], s22 offen offset:0 sc1
  buffer_load_dwordx4 v[172:175], v2, s[8:11], s22 offen offset:1024 sc1
  s_waitcnt vmcnt(8)
  buffer_load_dwordx4 v[176:179], v2, s[8:11], s22 offen offset:2048 sc1
  buffer_load_dwordx4 v[180:183], v2, s[8:11], s22 offen offset:3072 sc1
  s_waitcnt vmcnt(8)
  s_add_u32 s22, s20, 81920
  buffer_load_dwordx4 v[184:187], v2, s[8:11], s22 offen offset:0 sc1
  buffer_load_dwordx4 v[188:191], v2, s[8:11], s22 offen offset:1024 sc1
  s_waitcnt vmcnt(8)
  buffer_load_dwordx4 v[192:195], v2, s[8:11], s22 offen offset:2048 sc1
  buffer_load_dwordx4 v[196:199], v2, s[8:11], s22 offen offset:3072 sc1
  s_waitcnt vmcnt(8)
  s_add_u32 s22, s20, 86016
  buffer_load_dwordx4 v[200:203], v2, s[8:11], s22 offen offset:0 sc1
  buffer_load_dwordx4 v[204:207], v2, s[8:11], s22 offen offset:1024 sc1
  s_waitcnt vmcnt(8)
  buffer_load_dwordx4 v[208:211], v2, s[8:11], s22 offen offset:2048 sc1
  buffer_load_dwordx4 v[212:215], v2, s[8:11], s22 offen offset:3072 sc1
  s_waitcnt vmcnt(8)
  s_add_u32 s22, s20, 90112
  buffer_load_dwordx4 v[216:219], v2, s[8:11], s22 offen offset:0 sc1
  buffer_load_dwordx4 v[220:223], v2, s[8:11], s22 offen offset:1024 sc1
  s_waitcnt vmcnt(8)
  buffer_load_dwordx4 v[224:227], v2, s[8:11], s22 offen offset:2048 sc1
  buffer_load_dwordx4 v[228:231], v2, s[8:11], s22 offen offset:3072 sc1
  s_waitcnt vmcnt(8)
  s_add_u32 s22, s20, 94208
  buffer_load_dwordx4 v[232:235], v2, s[8:11], s22 offen offset:0 sc1
  buffer_load_dwordx4 v[236:239], v2, s[8:11], s22 offen offset:1024 sc1
  s_waitcnt vmcnt(8)
  buffer_load_dwordx4 v[240:243], v2, s[8:11], s22 offen offset:2048 sc1
  buffer_load_dwordx4 v[244:247], v2, s[8:11], s22 offen offset:3072 sc1
  s_waitcnt vmcnt(8)
  s_add_u32 s22, s20, 98304
  buffer_load_dwordx4 v[248:251], v2, s[8:11], s22 offen offset:0 sc1
  buffer_load_dwordx4 v[252:255], v2, s[8:11], s22 offen offset:1024 sc1
  s_waitcnt vmcnt(8)
  v_mov_b32 v5, 0x4444
  v_mov_b32 v6, 0xeeee
  v_cmp_lt_u32 vcc, 7, v4
  s_nop 1
  v_cndmask_b32 v5, v5, v6, vcc
  s_lshl_b32 s23, s16, 11
  v_lshrrev_b32 v80, 1, v3
  v_and_b32 v81, 1, v3
  v_add_u32 v82, 0, v80
  v_lshl_add_u32 v82, v82, 4, v4
  v_mul_u32_u24 v83, 2341, v82
  v_lshrrev_b32 v83, 16, v83
  v_mul_u32_u24 v84, 28, v83
  v_sub_u32 v84, v82, v84
  v_lshrrev_b32 v85, 4, v84
  v_and_b32 v84, 15, v84
  v_lshlrev_b32 v86, 10, v85
  v_lshl_add_u32 v86, v83, 8, v86
  v_lshl_add_u32 v86, v84, 4, v86
  v_lshl_add_u32 v86, v81, 3, v86
  v_add_u32 v72, s23, v86
  v_add_u32 v82, 2, v80
  v_lshl_add_u32 v82, v82, 4, v4
  v_mul_u32_u24 v83, 2341, v82
  v_lshrrev_b32 v83, 16, v83
  v_mul_u32_u24 v84, 28, v83
  v_sub_u32 v84, v82, v84
  v_lshrrev_b32 v85, 4, v84
  v_and_b32 v84, 15, v84
  v_lshlrev_b32 v86, 10, v85
  v_lshl_add_u32 v86, v83, 8, v86
  v_lshl_add_u32 v86, v84, 4, v86
  v_lshl_add_u32 v86, v81, 3, v86
  v_add_u32 v73, s23, v86
  v_add_u32 v82, 4, v80
  v_lshl_add_u32 v82, v82, 4, v4
  v_mul_u32_u24 v83, 2341, v82
  v_lshrrev_b32 v83, 16, v83
  v_mul_u32_u24 v84, 28, v83
  v_sub_u32 v84, v82, v84
  v_lshrrev_b32 v85, 4, v84
  v_and_b32 v84, 15, v84
  v_lshlrev_b32 v86, 10, v85
  v_lshl_add_u32 v86, v83, 8, v86
  v_lshl_add_u32 v86, v84, 4, v86
  v_lshl_add_u32 v86, v81, 3, v86
  v_add_u32 v74, s23, v86
  v_mov_b32 v82, 6
  v_lshl_add_u32 v82, v82, 4, v4
  v_mul_u32_u24 v83, 2341, v82
  v_lshrrev_b32 v83, 16, v83
  v_mul_u32_u24 v84, 28, v83
  v_sub_u32 v84, v82, v84
  v_lshrrev_b32 v85, 4, v84
  v_and_b32 v84, 15, v84
  v_lshlrev_b32 v86, 10, v85
  v_lshl_add_u32 v86, v83, 8, v86
  v_lshl_add_u32 v86, v84, 4, v86
  v_lshl_add_u32 v86, v81, 3, v86
  v_add_u32 v75, s23, v86
  v_add_u32 v76, s23, v2
  s_mul_i32 s27, s18, 448
  v_mov_b32 v77, s27
  v_mov_b32 v78, 1
  s_mov_b32 s17, s19
  s_mul_i32 s24, s19, 7168
  s_add_u32 s24, s24, 88002560
  s_mul_i32 s25, s18, 65
  s_add_u32 s25, s25, s19
  s_lshl_b32 s25, s25, 13
  s_add_u32 s25, s25, s23
  s_add_u32 s25, s25, 76869632
  s_lshl_b32 s26, s18, 6
  s_add_u32 s26, s26, s19
  s_lshl_b32 s26, s26, 4
  s_lshl_b32 s27, s16, 2
  s_add_u32 s26, s26, s27
  s_add_u32 s26, s26, 88502272
  v_mov_b32 v88, 0
  v_mov_b32 v89, 0
  v_mov_b32 v90, 0
  v_mov_b32 v91, 0
  v_mov_b32 v92, -1
  v_mov_b32 v93, -1
  v_mov_b32 v94, -1
  v_mov_b32 v95, -1
  ds_write_b128 v76, v[88:91]
  ds_write_b128 v76, v[88:91] offset:1024
  s_branch ws_arm
ws_loop:
  v_mov_b32 v36, 0
  v_mov_b32 v37, 0
  v_mov_b32 v38, 0
  v_mov_b32 v39, 0
  v_mov_b32 v40, 0
  v_mov_b32 v41, 0
  v_mov_b32 v42, 0
  v_mov_b32 v43, 0
  v_mov_b32 v44, 0
  v_mov_b32 v45, 0
  v_mov_b32 v46, 0
  v_mov_b32 v47, 0
  v_mov_b32 v48, 0
  v_mov_b32 v49, 0
  v_mov_b32 v50, 0
  v_mov_b32 v51, 0
  v_mov_b32 v52, 0
  v_mov_b32 v53, 0
  v_mov_b32 v54, 0
  v_mov_b32 v55, 0
  v_mov_b32 v56, 0
  v_mov_b32 v57, 0
  v_mov_b32 v58, 0
  v_mov_b32 v59, 0
  v_mov_b32 v60, 0
  v_mov_b32 v61, 0
  v_mov_b32 v62, 0
  v_mov_b32 v63, 0
  s_mov_b32 s30, 0
  s_branch ws_fl
ws_pm:
  s_cmp_ge_u32 s17, 64
  s_cbranch_scc1 ws_fl
  buffer_load_dword v79, v77, s[8:11], s24 offen sc1
  s_waitcnt vmcnt(0)
  v_cmp_eq_u32 vcc, -1, v79
  s_cbranch_vccnz ws_pr
ws_fl:
  s_add_u32 s22, s24, 4096
  buffer_load_dwordx4 v[8:11], v2, s[8:11], s24 offen offset:0 sc1
  buffer_load_dwordx4 v[12:15], v2, s[8:11], s24 offen offset:1024 sc1
  buffer_load_dwordx4 v[16:19], v2, s[8:11], s24 offen offset:2048 sc1
  buffer_load_dwordx4 v[20:23], v2, s[8:11], s24 offen offset:3072 sc1
  buffer_load_dwordx4 v[24:27], v2, s[8:11], s22 offen offset:0 sc1
  buffer_load_dwordx4 v[28:31], v2, s[8:11], s22 offen offset:1024 sc1
  buffer_load_dwordx4 v[32:35], v2, s[8:11], s22 offen offset:2048 sc1
  s_waitcnt vmcnt(0)
  s_mov_b64 exec, 1
  buffer_store_dword v78, v2, s[8:11], s28 offen sc1
  s_mov_b64 exec, -1
  s_mov_b32 s28, 0x40000000
  v_max_u32 v79, v8, v9
  v_max3_u32 v79, v79, v10, v11
  v_max3_u32 v79, v79, v12, v13
  v_max3_u32 v79, v79, v14, v15
  v_max3_u32 v79, v79, v16, v17
  v_max3_u32 v79, v79, v18, v19
  v_max3_u32 v79, v79, v20, v21
  v_max3_u32 v79, v79, v22, v23
  v_max3_u32 v79, v79, v24, v25
  v_max3_u32 v79, v79, v26, v27
  v_max3_u32 v79, v79, v28, v29
  v_max3_u32 v79, v79, v30, v31
  v_max3_u32 v79, v79, v32, v33
  v_max3_u32 v79, v79, v34, v35
  v_cmp_eq_u32 vcc, -1, v79
  s_cbranch_vccz ws_pk
ws_pr:
  s_sleep 6
  s_add_u32 s30, s30, 1
  s_cmp_lt_u32 s30, 2000000
  s_cbranch_scc1 ws_pm
  s_branch cA_abort
ws_pk:
  v_smfmac_f32_16x16x64_bf16 v[36:39], v[8:11], a[0:7], v5
  v_smfmac_f32_16x16x64_bf16 v[36:39], v[12:15], a[8:15], v5
  v_smfmac_f32_16x16x64_bf16 v[36:39], v[16:19], a[16:23], v5
  v_smfmac_f32_16x16x64_bf16 v[36:39], v[20:23], a[24:31], v5
  v_smfmac_f32_16x16x64_bf16 v[36:39], v[24:27], a[32:39], v5
  v_smfmac_f32_16x16x64_bf16 v[36:39], v[28:31], a[40:47], v5
  v_smfmac_f32_16x16x64_bf16 v[36:39], v[32:35], a[48:55], v5
  v_smfmac_f32_16x16x64_bf16 v[40:43], v[8:11], a[56:63], v5
  v_smfmac_f32_16x16x64_bf16 v[40:43], v[12:15], a[64:71], v5
  v_smfmac_f32_16x16x64_bf16 v[40:43], v[16:19], a[72:79], v5
  v_smfmac_f32_16x16x64_bf16 v[40:43], v[20:23], a[80:87], v5
  v_smfmac_f32_16x16x64_bf16 v[40:43], v[24:27], a[88:95], v5
  v_smfmac_f32_16x16x64_bf16 v[40:43], v[28:31], a[96:103], v5
  v_smfmac_f32_16x16x64_bf16 v[40:43], v[32:35], a[104:111], v5
  v_smfmac_f32_16x16x64_bf16 v[44:47], v[8:11], a[112:119], v5
  v_smfmac_f32_16x16x64_bf16 v[44:47], v[12:15], a[120:127], v5
  v_smfmac_f32_16x16x64_bf16 v[44:47], v[16:19], a[128:135], v5
  v_smfmac_f32_16x16x64_bf16 v[44:47], v[20:23], a[136:143], v5
  v_smfmac_f32_16x16x64_bf16 v[44:47], v[24:27], a[144:151], v5
  v_smfmac_f32_16x16x64_bf16 v[44:47], v[28:31], a[152:159], v5
  v_smfmac_f32_16x16x64_bf16 v[44:47], v[32:35], a[160:167], v5
  v_smfmac_f32_16x16x64_bf16 v[48:51], v[8:11], a[168:175], v5
  v_smfmac_f32_16x16x64_bf16 v[48:51], v[12:15], a[176:183], v5
  v_smfmac_f32_16x16x64_bf16 v[48:51], v[16:19], a[184:191], v5
  v_smfmac_f32_16x16x64_bf16 v[48:51], v[20:23], a[192:199], v5
  v_smfmac_f32_16x16x64_bf16 v[48:51], v[24:27], a[200:207], v5
  v_smfmac_f32_16x16x64_bf16 v[48:51], v[28:31], a[208:215], v5
  v_smfmac_f32_16x16x64_bf16 v[48:51], v[32:35], a[216:223], v5
  v_smfmac_f32_16x16x64_bf16 v[52:55], v[8:11], a[224:231], v5
  v_smfmac_f32_16x16x64_bf16 v[52:55], v[12:15], a[232:239], v5
  v_smfmac_f32_16x16x64_bf16 v[52:55], v[16:19], a[240:247], v5
  v_smfmac_f32_16x16x64_bf16 v[52:55], v[20:23], a[248:255], v5
  v_smfmac_f32_16x16x64_bf16 v[52:55], v[24:27], v[120:127], v5
  v_smfmac_f32_16x16x64_bf16 v[52:55], v[28:31], v[128:135], v5
  v_smfmac_f32_16x16x64_bf16 v[52:55], v[32:35], v[136:143], v5
  v_smfmac_f32_16x16x64_bf16 v[56:59], v[8:11], v[144:151], v5
  v_smfmac_f32_16x16x64_bf16 v[56:59], v[12:15], v[152:159], v5
  v_smfmac_f32_16x16x64_bf16 v[56:59], v[16:19], v[160:167], v5
  v_smfmac_f32_16x16x64_bf16 v[56:59], v[20:23], v[168:175], v5
  v_smfmac_f32_16x16x64_bf16 v[56:59], v[24:27], v[176:183], v5
  v_smfmac_f32_16x16x64_bf16 v[56:59], v[28:31], v[184:191], v5
  v_smfmac_f32_16x16x64_bf16 v[56:59], v[32:35], v[192:199], v5
  v_smfmac_f32_16x16x64_bf16 v[60:63], v[8:11], v[200:207], v5
  v_smfmac_f32_16x16x64_bf16 v[60:63], v[12:15], v[208:215], v5
  v_smfmac_f32_16x16x64_bf16 v[60:63], v[16:19], v[216:223], v5
  v_smfmac_f32_16x16x64_bf16 v[60:63], v[20:23], v[224:231], v5
  v_smfmac_f32_16x16x64_bf16 v[60:63], v[24:27], v[232:239], v5
  v_smfmac_f32_16x16x64_bf16 v[60:63], v[28:31], v[240:247], v5
  v_smfmac_f32_16x16x64_bf16 v[60:63], v[32:35], v[248:255], v5
  v_permlane32_swap_b32 v36, v40
  v_permlane32_swap_b32 v37, v41
  v_permlane32_swap_b32 v38, v42
  v_permlane32_swap_b32 v39, v43
  v_add_f32 v36, v36, v40
  v_add_f32 v37, v37, v41
  v_add_f32 v38, v38, v42
  v_add_f32 v39, v39, v43
  v_cvt_pk_bf16_f32 v40, v36, v37
  v_cvt_pk_bf16_f32 v41, v38, v39
  v_min_u32 v40, -2, v40
  v_min_u32 v41, -2, v41
  ds_write_b64 v72, v[40:41]
  v_permlane32_swap_b32 v44, v48
  v_permlane32_swap_b32 v45, v49
  v_permlane32_swap_b32 v46, v50
  v_permlane32_swap_b32 v47, v51
  v_add_f32 v44, v44, v48
  v_add_f32 v45, v45, v49
  v_add_f32 v46, v46, v50
  v_add_f32 v47, v47, v51
  v_cvt_pk_bf16_f32 v48, v44, v45
  v_cvt_pk_bf16_f32 v49, v46, v47
  v_min_u32 v48, -2, v48
  v_min_u32 v49, -2, v49
  ds_write_b64 v73, v[48:49]
  v_permlane32_swap_b32 v52, v56
  v_permlane32_swap_b32 v53, v57
  v_permlane32_swap_b32 v54, v58
  v_permlane32_swap_b32 v55, v59
  v_add_f32 v52, v52, v56
  v_add_f32 v53, v53, v57
  v_add_f32 v54, v54, v58
  v_add_f32 v55, v55, v59
  v_cvt_pk_bf16_f32 v56, v52, v53
  v_cvt_pk_bf16_f32 v57, v54, v55
  v_min_u32 v56, -2, v56
  v_min_u32 v57, -2, v57
  ds_write_b64 v74, v[56:57]
  v_mov_b32 v64, v60
  v_mov_b32 v65, v61
  v_mov_b32 v66, v62
  v_mov_b32 v67, v63
  v_permlane32_swap_b32 v60, v64
  v_permlane32_swap_b32 v61, v65
  v_permlane32_swap_b32 v62, v66
  v_permlane32_swap_b32 v63, v67
  v_add_f32 v60, v60, v64
  v_add_f32 v61, v61, v65
  v_add_f32 v62, v62, v66
  v_add_f32 v63, v63, v67
  v_cvt_pk_bf16_f32 v64, v60, v61
  v_cvt_pk_bf16_f32 v65, v62, v63
  v_min_u32 v64, -2, v64
  v_min_u32 v65, -2, v65
  ds_write_b64 v75, v[64:65]
  s_waitcnt lgkmcnt(0)
  ds_read_b128 v[64:67], v76
  ds_read_b128 v[68:71], v76 offset:1024
  s_waitcnt lgkmcnt(0)
  buffer_store_dwordx4 v[64:67], v2, s[8:11], s25 offen sc1
  buffer_store_dwordx4 v[68:71], v2, s[8:11], s25 offen offset:1024 sc1
  s_add_u32 s24, s24, 14336
  s_add_u32 s25, s25, 16384
  s_add_u32 s26, s26, 32
  s_add_u32 s17, s17, 2
  s_cmp_ge_u32 s17, 62
  s_cbranch_scc1 ws_end
ws_arm:
  buffer_store_dwordx4 v[92:95], v2, s[8:11], s25 offen sc1
  buffer_store_dwordx4 v[92:95], v2, s[8:11], s25 offen offset:1024 sc1
  s_mov_b32 s28, s26
  s_branch ws_loop
ws_end:
  v_mov_b32 v250, 0
  s_branch wk_loop
wk_s4d:
  s_sub_u32 s3, s3, 640
  s_load_dwordx8 s[40:47], s[0:1], 0
  s_load_dwordx4 s[48:51], s[0:1], 32
  s_load_dwordx2 s[52:53], s[0:1], 48
  s_load_dwordx2 s[54:55], s[0:1], 112
  v_lshrrev_b32 v1, 6, v0
  s_nop 0
  v_readfirstlane_b32 s16, v1
  v_and_b32 v1, 63, v0
  v_lshrrev_b32 v3, 4, v1
  v_and_b32 v4, 15, v1
  s_mul_i32 s17, s16, 24576
  s_waitcnt lgkmcnt(0)
  s_mov_b32 s60, s40
  s_and_b32 s61, s41, 0xffff
  s_mov_b32 s62, 1835008
  s_mov_b32 s63, 0x20000
  s_mov_b32 s64, s42
  s_and_b32 s65, s43, 0xffff
  s_mov_b32 s66, 229376
  s_mov_b32 s67, 0x20000
  s_mov_b32 s68, s44
  s_and_b32 s69, s45, 0xffff
  s_mov_b32 s70, 229376
  s_mov_b32 s71, 0x20000
  s_mov_b32 s72, s46
  s_and_b32 s73, s47, 0xffff
  s_mov_b32 s74, 229376
  s_mov_b32 s75, 0x20000
  s_mov_b32 s76, s48
  s_and_b32 s77, s49, 0xffff
  s_mov_b32 s78, 229376
  s_mov_b32 s79, 0x20000
  s_mov_b32 s80, s50
  s_and_b32 s81, s51, 0xffff
  s_mov_b32 s82, 896
  s_mov_b32 s83, 0x20000
  s_mov_b32 s84, s52
  s_and_b32 s85, s53, 0xffff
  s_mov_b32 s86, 896
  s_mov_b32 s87, 0x20000
  s_mov_b32 s88, s54
  s_and_b32 s89, s55, 0xffff
  s_mov_b32 s90, 3670016
  s_mov_b32 s91, 0x20000
  v_lshlrev_b32 v5, 5, v1
  v_sub_u32 v5, 2047, v5
  s_add_u32 s18, s17, 13056
  v_subrev_u32 v6, 0, v5
  v_max_i32 v7, 0, v6
  v_cvt_f32_u32 v7, v7
  v_cvt_pk_bf16_f32 v8, v7, v7
  v_and_b32 v7, 0xffff0000, v8
  v_lshrrev_b32 v8, 23, v7
  v_subrev_u32 v8, 134, v8
  v_max_i32 v8, 0, v8
  v_cvt_u32_f32 v7, v7
  v_lshrrev_b32 v7, v8, v7
  v_lshl_add_u32 v7, v8, 8, v7
  v_lshl_add_u32 v200, v7, 2, s18
  v_subrev_u32 v6, 1, v5
  v_max_i32 v7, 0, v6
  v_cvt_f32_u32 v7, v7
  v_cvt_pk_bf16_f32 v8, v7, v7
  v_and_b32 v7, 0xffff0000, v8
  v_lshrrev_b32 v8, 23, v7
  v_subrev_u32 v8, 134, v8
  v_max_i32 v8, 0, v8
  v_cvt_u32_f32 v7, v7
  v_lshrrev_b32 v7, v8, v7
  v_lshl_add_u32 v7, v8, 8, v7
  v_lshl_add_u32 v201, v7, 2, s18
  v_subrev_u32 v6, 2, v5
  v_max_i32 v7, 0, v6
  v_cvt_f32_u32 v7, v7
  v_cvt_pk_bf16_f32 v8, v7, v7
  v_and_b32 v7, 0xffff0000, v8
  v_lshrrev_b32 v8, 23, v7
  v_subrev_u32 v8, 134, v8
  v_max_i32 v8, 0, v8
  v_cvt_u32_f32 v7, v7
  v_lshrrev_b32 v7, v8, v7
  v_lshl_add_u32 v7, v8, 8, v7
  v_lshl_add_u32 v202, v7, 2, s18
  v_subrev_u32 v6, 3, v5
  v_max_i32 v7, 0, v6
  v_cvt_f32_u32 v7, v7
  v_cvt_pk_bf16_f32 v8, v7, v7
  v_and_b32 v7, 0xffff0000, v8
  v_lshrrev_b32 v8, 23, v7
  v_subrev_u32 v8, 134, v8
  v_max_i32 v8, 0, v8
  v_cvt_u32_f32 v7, v7
  v_lshrrev_b32 v7, v8, v7
  v_lshl_add_u32 v7, v8, 8, v7
  v_lshl_add_u32 v203, v7, 2, s18
  v_subrev_u32 v6, 4, v5
  v_max_i32 v7, 0, v6
  v_cvt_f32_u32 v7, v7
  v_cvt_pk_bf16_f32 v8, v7, v7
  v_and_b32 v7, 0xffff0000, v8
  v_lshrrev_b32 v8, 23, v7
  v_subrev_u32 v8, 134, v8
  v_max_i32 v8, 0, v8
  v_cvt_u32_f32 v7, v7
  v_lshrrev_b32 v7, v8, v7
  v_lshl_add_u32 v7, v8, 8, v7
  v_lshl_add_u32 v204, v7, 2, s18
  v_subrev_u32 v6, 5, v5
  v_max_i32 v7, 0, v6
  v_cvt_f32_u32 v7, v7
  v_cvt_pk_bf16_f32 v8, v7, v7
  v_and_b32 v7, 0xffff0000, v8
  v_lshrrev_b32 v8, 23, v7
  v_subrev_u32 v8, 134, v8
  v_max_i32 v8, 0, v8
  v_cvt_u32_f32 v7, v7
  v_lshrrev_b32 v7, v8, v7
  v_lshl_add_u32 v7, v8, 8, v7
  v_lshl_add_u32 v205, v7, 2, s18
  v_subrev_u32 v6, 6, v5
  v_max_i32 v7, 0, v6
  v_cvt_f32_u32 v7, v7
  v_cvt_pk_bf16_f32 v8, v7, v7
  v_and_b32 v7, 0xffff0000, v8
  v_lshrrev_b32 v8, 23, v7
  v_subrev_u32 v8, 134, v8
  v_max_i32 v8, 0, v8
  v_cvt_u32_f32 v7, v7
  v_lshrrev_b32 v7, v8, v7
  v_lshl_add_u32 v7, v8, 8, v7
  v_lshl_add_u32 v206, v7, 2, s18
  v_subrev_u32 v6, 7, v5
  v_max_i32 v7, 0, v6
  v_cvt_f32_u32 v7, v7
  v_cvt_pk_bf16_f32 v8, v7, v7
  v_and_b32 v7, 0xffff0000, v8
  v_lshrrev_b32 v8, 23, v7
  v_subrev_u32 v8, 134, v8
  v_max_i32 v8, 0, v8
  v_cvt_u32_f32 v7, v7
  v_lshrrev_b32 v7, v8, v7
  v_lshl_add_u32 v7, v8, 8, v7
  v_lshl_add_u32 v207, v7, 2, s18
  v_subrev_u32 v6, 8, v5
  v_max_i32 v7, 0, v6
  v_cvt_f32_u32 v7, v7
  v_cvt_pk_bf16_f32 v8, v7, v7
  v_and_b32 v7, 0xffff0000, v8
  v_lshrrev_b32 v8, 23, v7
  v_subrev_u32 v8, 134, v8
  v_max_i32 v8, 0, v8
  v_cvt_u32_f32 v7, v7
  v_lshrrev_b32 v7, v8, v7
  v_lshl_add_u32 v7, v8, 8, v7
  v_lshl_add_u32 v208, v7, 2, s18
  v_subrev_u32 v6, 9, v5
  v_max_i32 v7, 0, v6
  v_cvt_f32_u32 v7, v7
  v_cvt_pk_bf16_f32 v8, v7, v7
  v_and_b32 v7, 0xffff0000, v8
  v_lshrrev_b32 v8, 23, v7
  v_subrev_u32 v8, 134, v8
  v_max_i32 v8, 0, v8
  v_cvt_u32_f32 v7, v7
  v_lshrrev_b32 v7, v8, v7
  v_lshl_add_u32 v7, v8, 8, v7
  v_lshl_add_u32 v209, v7, 2, s18
  v_subrev_u32 v6, 10, v5
  v_max_i32 v7, 0, v6
  v_cvt_f32_u32 v7, v7
  v_cvt_pk_bf16_f32 v8, v7, v7
  v_and_b32 v7, 0xffff0000, v8
  v_lshrrev_b32 v8, 23, v7
  v_subrev_u32 v8, 134, v8
  v_max_i32 v8, 0, v8
  v_cvt_u32_f32 v7, v7
  v_lshrrev_b32 v7, v8, v7
  v_lshl_add_u32 v7, v8, 8, v7
  v_lshl_add_u32 v210, v7, 2, s18
  v_subrev_u32 v6, 11, v5
  v_max_i32 v7, 0, v6
  v_cvt_f32_u32 v7, v7
  v_cvt_pk_bf16_f32 v8, v7, v7
  v_and_b32 v7, 0xffff0000, v8
  v_lshrrev_b32 v8, 23, v7
  v_subrev_u32 v8, 134, v8
  v_max_i32 v8, 0, v8
  v_cvt_u32_f32 v7, v7
  v_lshrrev_b32 v7, v8, v7
  v_lshl_add_u32 v7, v8, 8, v7
  v_lshl_add_u32 v211, v7, 2, s18
  v_subrev_u32 v6, 12, v5
  v_max_i32 v7, 0, v6
  v_cvt_f32_u32 v7, v7
  v_cvt_pk_bf16_f32 v8, v7, v7
  v_and_b32 v7, 0xffff0000, v8
  v_lshrrev_b32 v8, 23, v7
  v_subrev_u32 v8, 134, v8
  v_max_i32 v8, 0, v8
  v_cvt_u32_f32 v7, v7
  v_lshrrev_b32 v7, v8, v7
  v_lshl_add_u32 v7, v8, 8, v7
  v_lshl_add_u32 v212, v7, 2, s18
  v_subrev_u32 v6, 13, v5
  v_max_i32 v7, 0, v6
  v_cvt_f32_u32 v7, v7
  v_cvt_pk_bf16_f32 v8, v7, v7
  v_and_b32 v7, 0xffff0000, v8
  v_lshrrev_b32 v8, 23, v7
  v_subrev_u32 v8, 134, v8
  v_max_i32 v8, 0, v8
  v_cvt_u32_f32 v7, v7
  v_lshrrev_b32 v7, v8, v7
  v_lshl_add_u32 v7, v8, 8, v7
  v_lshl_add_u32 v213, v7, 2, s18
  v_subrev_u32 v6, 14, v5
  v_max_i32 v7, 0, v6
  v_cvt_f32_u32 v7, v7
  v_cvt_pk_bf16_f32 v8, v7, v7
  v_and_b32 v7, 0xffff0000, v8
  v_lshrrev_b32 v8, 23, v7
  v_subrev_u32 v8, 134, v8
  v_max_i32 v8, 0, v8
  v_cvt_u32_f32 v7, v7
  v_lshrrev_b32 v7, v8, v7
  v_lshl_add_u32 v7, v8, 8, v7
  v_lshl_add_u32 v214, v7, 2, s18
  v_subrev_u32 v6, 15, v5
  v_max_i32 v7, 0, v6
  v_cvt_f32_u32 v7, v7
  v_cvt_pk_bf16_f32 v8, v7, v7
  v_and_b32 v7, 0xffff0000, v8
  v_lshrrev_b32 v8, 23, v7
  v_subrev_u32 v8, 134, v8
  v_max_i32 v8, 0, v8
  v_cvt_u32_f32 v7, v7
  v_lshrrev_b32 v7, v8, v7
  v_lshl_add_u32 v7, v8, 8, v7
  v_lshl_add_u32 v215, v7, 2, s18
  v_subrev_u32 v6, 16, v5
  v_max_i32 v7, 0, v6
  v_cvt_f32_u32 v7, v7
  v_cvt_pk_bf16_f32 v8, v7, v7
  v_and_b32 v7, 0xffff0000, v8
  v_lshrrev_b32 v8, 23, v7
  v_subrev_u32 v8, 134, v8
  v_max_i32 v8, 0, v8
  v_cvt_u32_f32 v7, v7
  v_lshrrev_b32 v7, v8, v7
  v_lshl_add_u32 v7, v8, 8, v7
  v_lshl_add_u32 v216, v7, 2, s18
  v_subrev_u32 v6, 17, v5
  v_max_i32 v7, 0, v6
  v_cvt_f32_u32 v7, v7
  v_cvt_pk_bf16_f32 v8, v7, v7
  v_and_b32 v7, 0xffff0000, v8
  v_lshrrev_b32 v8, 23, v7
  v_subrev_u32 v8, 134, v8
  v_max_i32 v8, 0, v8
  v_cvt_u32_f32 v7, v7
  v_lshrrev_b32 v7, v8, v7
  v_lshl_add_u32 v7, v8, 8, v7
  v_lshl_add_u32 v217, v7, 2, s18
  v_subrev_u32 v6, 18, v5
  v_max_i32 v7, 0, v6
  v_cvt_f32_u32 v7, v7
  v_cvt_pk_bf16_f32 v8, v7, v7
  v_and_b32 v7, 0xffff0000, v8
  v_lshrrev_b32 v8, 23, v7
  v_subrev_u32 v8, 134, v8
  v_max_i32 v8, 0, v8
  v_cvt_u32_f32 v7, v7
  v_lshrrev_b32 v7, v8, v7
  v_lshl_add_u32 v7, v8, 8, v7
  v_lshl_add_u32 v218, v7, 2, s18
  v_subrev_u32 v6, 19, v5
  v_max_i32 v7, 0, v6
  v_cvt_f32_u32 v7, v7
  v_cvt_pk_bf16_f32 v8, v7, v7
  v_and_b32 v7, 0xffff0000, v8
  v_lshrrev_b32 v8, 23, v7
  v_subrev_u32 v8, 134, v8
  v_max_i32 v8, 0, v8
  v_cvt_u32_f32 v7, v7
  v_lshrrev_b32 v7, v8, v7
  v_lshl_add_u32 v7, v8, 8, v7
  v_lshl_add_u32 v219, v7, 2, s18
  v_subrev_u32 v6, 20, v5
  v_max_i32 v7, 0, v6
  v_cvt_f32_u32 v7, v7
  v_cvt_pk_bf16_f32 v8, v7, v7
  v_and_b32 v7, 0xffff0000, v8
  v_lshrrev_b32 v8, 23, v7
  v_subrev_u32 v8, 134, v8
  v_max_i32 v8, 0, v8
  v_cvt_u32_f32 v7, v7
  v_lshrrev_b32 v7, v8, v7
  v_lshl_add_u32 v7, v8, 8, v7
  v_lshl_add_u32 v220, v7, 2, s18
  v_subrev_u32 v6, 21, v5
  v_max_i32 v7, 0, v6
  v_cvt_f32_u32 v7, v7
  v_cvt_pk_bf16_f32 v8, v7, v7
  v_and_b32 v7, 0xffff0000, v8
  v_lshrrev_b32 v8, 23, v7
  v_subrev_u32 v8, 134, v8
  v_max_i32 v8, 0, v8
  v_cvt_u32_f32 v7, v7
  v_lshrrev_b32 v7, v8, v7
  v_lshl_add_u32 v7, v8, 8, v7
  v_lshl_add_u32 v221, v7, 2, s18
  v_subrev_u32 v6, 22, v5
  v_max_i32 v7, 0, v6
  v_cvt_f32_u32 v7, v7
  v_cvt_pk_bf16_f32 v8, v7, v7
  v_and_b32 v7, 0xffff0000, v8
  v_lshrrev_b32 v8, 23, v7
  v_subrev_u32 v8, 134, v8
  v_max_i32 v8, 0, v8
  v_cvt_u32_f32 v7, v7
  v_lshrrev_b32 v7, v8, v7
  v_lshl_add_u32 v7, v8, 8, v7
  v_lshl_add_u32 v222, v7, 2, s18
  v_subrev_u32 v6, 23, v5
  v_max_i32 v7, 0, v6
  v_cvt_f32_u32 v7, v7
  v_cvt_pk_bf16_f32 v8, v7, v7
  v_and_b32 v7, 0xffff0000, v8
  v_lshrrev_b32 v8, 23, v7
  v_subrev_u32 v8, 134, v8
  v_max_i32 v8, 0, v8
  v_cvt_u32_f32 v7, v7
  v_lshrrev_b32 v7, v8, v7
  v_lshl_add_u32 v7, v8, 8, v7
  v_lshl_add_u32 v223, v7, 2, s18
  v_subrev_u32 v6, 24, v5
  v_max_i32 v7, 0, v6
  v_cvt_f32_u32 v7, v7
  v_cvt_pk_bf16_f32 v8, v7, v7
  v_and_b32 v7, 0xffff0000, v8
  v_lshrrev_b32 v8, 23, v7
  v_subrev_u32 v8, 134, v8
  v_max_i32 v8, 0, v8
  v_cvt_u32_f32 v7, v7
  v_lshrrev_b32 v7, v8, v7
  v_lshl_add_u32 v7, v8, 8, v7
  v_lshl_add_u32 v224, v7, 2, s18
  v_subrev_u32 v6, 25, v5
  v_max_i32 v7, 0, v6
  v_cvt_f32_u32 v7, v7
  v_cvt_pk_bf16_f32 v8, v7, v7
  v_and_b32 v7, 0xffff0000, v8
  v_lshrrev_b32 v8, 23, v7
  v_subrev_u32 v8, 134, v8
  v_max_i32 v8, 0, v8
  v_cvt_u32_f32 v7, v7
  v_lshrrev_b32 v7, v8, v7
  v_lshl_add_u32 v7, v8, 8, v7
  v_lshl_add_u32 v225, v7, 2, s18
  v_subrev_u32 v6, 26, v5
  v_max_i32 v7, 0, v6
  v_cvt_f32_u32 v7, v7
  v_cvt_pk_bf16_f32 v8, v7, v7
  v_and_b32 v7, 0xffff0000, v8
  v_lshrrev_b32 v8, 23, v7
  v_subrev_u32 v8, 134, v8
  v_max_i32 v8, 0, v8
  v_cvt_u32_f32 v7, v7
  v_lshrrev_b32 v7, v8, v7
  v_lshl_add_u32 v7, v8, 8, v7
  v_lshl_add_u32 v226, v7, 2, s18
  v_subrev_u32 v6, 27, v5
  v_max_i32 v7, 0, v6
  v_cvt_f32_u32 v7, v7
  v_cvt_pk_bf16_f32 v8, v7, v7
  v_and_b32 v7, 0xffff0000, v8
  v_lshrrev_b32 v8, 23, v7
  v_subrev_u32 v8, 134, v8
  v_max_i32 v8, 0, v8
  v_cvt_u32_f32 v7, v7
  v_lshrrev_b32 v7, v8, v7
  v_lshl_add_u32 v7, v8, 8, v7
  v_lshl_add_u32 v227, v7, 2, s18
  v_subrev_u32 v6, 28, v5
  v_max_i32 v7, 0, v6
  v_cvt_f32_u32 v7, v7
  v_cvt_pk_bf16_f32 v8, v7, v7
  v_and_b32 v7, 0xffff0000, v8
  v_lshrrev_b32 v8, 23, v7
  v_subrev_u32 v8, 134, v8
  v_max_i32 v8, 0, v8
  v_cvt_u32_f32 v7, v7
  v_lshrrev_b32 v7, v8, v7
  v_lshl_add_u32 v7, v8, 8, v7
  v_lshl_add_u32 v228, v7, 2, s18
  v_subrev_u32 v6, 29, v5
  v_max_i32 v7, 0, v6
  v_cvt_f32_u32 v7, v7
  v_cvt_pk_bf16_f32 v8, v7, v7
  v_and_b32 v7, 0xffff0000, v8
  v_lshrrev_b32 v8, 23, v7
  v_subrev_u32 v8, 134, v8
  v_max_i32 v8, 0, v8
  v_cvt_u32_f32 v7, v7
  v_lshrrev_b32 v7, v8, v7
  v_lshl_add_u32 v7, v8, 8, v7
  v_lshl_add_u32 v229, v7, 2, s18
  v_subrev_u32 v6, 30, v5
  v_max_i32 v7, 0, v6
  v_cvt_f32_u32 v7, v7
  v_cvt_pk_bf16_f32 v8, v7, v7
  v_and_b32 v7, 0xffff0000, v8
  v_lshrrev_b32 v8, 23, v7
  v_subrev_u32 v8, 134, v8
  v_max_i32 v8, 0, v8
  v_cvt_u32_f32 v7, v7
  v_lshrrev_b32 v7, v8, v7
  v_lshl_add_u32 v7, v8, 8, v7
  v_lshl_add_u32 v230, v7, 2, s18
  v_subrev_u32 v6, 31, v5
  v_max_i32 v7, 0, v6
  v_cvt_f32_u32 v7, v7
  v_cvt_pk_bf16_f32 v8, v7, v7
  v_and_b32 v7, 0xffff0000, v8
  v_lshrrev_b32 v8, 23, v7
  v_subrev_u32 v8, 134, v8
  v_max_i32 v8, 0, v8
  v_cvt_u32_f32 v7, v7
  v_lshrrev_b32 v7, v8, v7
  v_lshl_add_u32 v7, v8, 8, v7
  v_lshl_add_u32 v231, v7, 2, s18
  v_subrev_u32 v6, 32, v5
  v_max_i32 v7, 0, v6
  v_cvt_f32_u32 v7, v7
  v_cvt_pk_bf16_f32 v8, v7, v7
  v_and_b32 v7, 0xffff0000, v8
  v_lshrrev_b32 v8, 23, v7
  v_subrev_u32 v8, 134, v8
  v_max_i32 v8, 0, v8
  v_cvt_u32_f32 v7, v7
  v_lshrrev_b32 v7, v8, v7
  v_lshl_add_u32 v7, v8, 8, v7
  v_mov_b32 v8, 1280
  v_cmp_gt_i32 vcc, 0, v6
  s_nop 1
  v_cndmask_b32 v7, v7, v8, vcc
  v_lshl_add_u32 v232, v7, 2, s18
  v_mov_b32 v8, 0
  v_mov_b32 v9, 0
  v_lshlrev_b32 v5, 3, v1
  v_add_u32 v5, s17, v5
  ds_write_b64 v5, v[8:9]
  v_and_b32 v6, 15, v1
  v_lshlrev_b32 v6, 3, v6
  v_add_u32 v6, s17, v6
  ds_write_b64 v6, v[8:9] offset:8704
  ds_write_b64 v6, v[8:9] offset:12928
  v_mov_b32 v6, s17
  ds_write_b64 v6, v[8:9] offset:18176
  s_lshl_b32 s19, s3, 2
  s_add_u32 s20, s19, s16
  s_lshl_b32 s21, s3, 3
  v_mul_u32_u24 v5, 3584, v0
  s_add_u32 s22, s21, 0
  buffer_load_dwordx2 v[8:9], v5, s[60:63], s22 offen offset:0
  buffer_load_dwordx2 v[10:11], v5, s[60:63], s22 offen offset:896
  buffer_load_dwordx2 v[12:13], v5, s[60:63], s22 offen offset:1792
  buffer_load_dwordx2 v[14:15], v5, s[60:63], s22 offen offset:2688
  s_add_u32 s22, s21, 917504
  buffer_load_dwordx2 v[16:17], v5, s[60:63], s22 offen offset:0
  buffer_load_dwordx2 v[18:19], v5, s[60:63], s22 offen offset:896
  buffer_load_dwordx2 v[20:21], v5, s[60:63], s22 offen offset:1792
  buffer_load_dwordx2 v[22:23], v5, s[60:63], s22 offen offset:2688
  s_lshl_b32 s22, s20, 9
  v_lshlrev_b32 v6, 3, v1
  buffer_load_dwordx2 v[24:25], v6, s[64:67], s22 offen
  buffer_load_dwordx2 v[26:27], v6, s[68:71], s22 offen
  buffer_load_dwordx2 v[28:29], v6, s[72:75], s22 offen
  buffer_load_dwordx2 v[30:31], v6, s[76:79], s22 offen
  s_lshl_b32 s22, s20, 1
  v_mov_b32 v7, 0
  buffer_load_ushort v32, v7, s[80:83], s22 offen
  buffer_load_ushort v33, v7, s[84:87], s22 offen
  s_mov_b32 s24, 0x05040100
  s_mov_b32 s25, 0x07060302
  s_barrier
  s_waitcnt vmcnt(6)
  v_lshlrev_b32 v6, 3, v0
  v_perm_b32 v34, v10, v8, s24
  v_perm_b32 v35, v14, v12, s24
  v_add_u32 v36, 512, v6
  ds_write_b64 v36, v[34:35]
  v_perm_b32 v34, v10, v8, s25
  v_perm_b32 v35, v14, v12, s25
  v_add_u32 v36, 25088, v6
  ds_write_b64 v36, v[34:35]
  v_perm_b32 v34, v11, v9, s24
  v_perm_b32 v35, v15, v13, s24
  v_add_u32 v36, 49664, v6
  ds_write_b64 v36, v[34:35]
  v_perm_b32 v34, v11, v9, s25
  v_perm_b32 v35, v15, v13, s25
  v_add_u32 v36, 74240, v6
  ds_write_b64 v36, v[34:35]
  v_perm_b32 v34, v18, v16, s24
  v_perm_b32 v35, v22, v20, s24
  v_add_u32 v36, 2560, v6
  ds_write_b64 v36, v[34:35]
  v_perm_b32 v34, v18, v16, s25
  v_perm_b32 v35, v22, v20, s25
  v_add_u32 v36, 27136, v6
  ds_write_b64 v36, v[34:35]
  v_perm_b32 v34, v19, v17, s24
  v_perm_b32 v35, v23, v21, s24
  v_add_u32 v36, 51712, v6
  ds_write_b64 v36, v[34:35]
  v_perm_b32 v34, v19, v17, s25
  v_perm_b32 v35, v23, v21, s25
  v_add_u32 v36, 76288, v6
  ds_write_b64 v36, v[34:35]
  s_waitcnt vmcnt(0)
  s_mov_b32 s26, 1069066811
  s_mov_b32 s27, 1042479491
  v_lshlrev_b32 v32, 16, v32
  v_lshlrev_b32 v33, 16, v33
  v_mul_f32 v32, s26, v32
  v_exp_f32 v32, v32
  s_nop 0
  v_cvt_pk_bf16_f32 v34, v32, v32
  v_and_b32 v32, 0xffff0000, v34
  v_lshlrev_b32 v37, 6, v1
  v_add_u32 v37, s17, v37
  v_lshlrev_b32 v40, 16, v24
  v_lshlrev_b32 v41, 16, v26
  v_lshlrev_b32 v42, 16, v28
  v_lshlrev_b32 v43, 16, v30
  v_mul_f32 v40, s26, v40
  v_exp_f32 v40, v40
  s_nop 0
  v_cvt_pk_bf16_f32 v34, v40, v40
  v_and_b32 v40, 0xffff0000, v34
  v_mul_f32 v40, v40, v32
  v_mul_f32 v40, s26, v40
  v_sub_f32 v40, 0, v40
  v_mul_f32 v41, v41, v32
  v_mul_f32 v41, s27, v41
  v_mul_f32 v42, v42, v32
  v_mul_f32 v43, v43, v32
  v_add_f32 v42, v42, v42
  v_add_f32 v43, v43, v43
  ds_write_b128 v37, v[40:43] offset:18240
  v_and_b32 v40, 0xffff0000, v24
  v_and_b32 v41, 0xffff0000, v26
  v_and_b32 v42, 0xffff0000, v28
  v_and_b32 v43, 0xffff0000, v30
  v_mul_f32 v40, s26, v40
  v_exp_f32 v40, v40
  s_nop 0
  v_cvt_pk_bf16_f32 v34, v40, v40
  v_and_b32 v40, 0xffff0000, v34
  v_mul_f32 v40, v40, v32
  v_mul_f32 v40, s26, v40
  v_sub_f32 v40, 0, v40
  v_mul_f32 v41, v41, v32
  v_mul_f32 v41, s27, v41
  v_mul_f32 v42, v42, v32
  v_mul_f32 v43, v43, v32
  v_add_f32 v42, v42, v42
  v_add_f32 v43, v43, v43
  ds_write_b128 v37, v[40:43] offset:18256
  v_lshlrev_b32 v40, 16, v25
  v_lshlrev_b32 v41, 16, v27
  v_lshlrev_b32 v42, 16, v29
  v_lshlrev_b32 v43, 16, v31
  v_mul_f32 v40, s26, v40
  v_exp_f32 v40, v40
  s_nop 0
  v_cvt_pk_bf16_f32 v34, v40, v40
  v_and_b32 v40, 0xffff0000, v34
  v_mul_f32 v40, v40, v32
  v_mul_f32 v40, s26, v40
  v_sub_f32 v40, 0, v40
  v_mul_f32 v41, v41, v32
  v_mul_f32 v41, s27, v41
  v_mul_f32 v42, v42, v32
  v_mul_f32 v43, v43, v32
  v_add_f32 v42, v42, v42
  v_add_f32 v43, v43, v43
  ds_write_b128 v37, v[40:43] offset:18272
  v_and_b32 v40, 0xffff0000, v25
  v_and_b32 v41, 0xffff0000, v27
  v_and_b32 v42, 0xffff0000, v29
  v_and_b32 v43, 0xffff0000, v31
  v_mul_f32 v40, s26, v40
  v_exp_f32 v40, v40
  s_nop 0
  v_cvt_pk_bf16_f32 v34, v40, v40
  v_and_b32 v40, 0xffff0000, v34
  v_mul_f32 v40, v40, v32
  v_mul_f32 v40, s26, v40
  v_sub_f32 v40, 0, v40
  v_mul_f32 v41, v41, v32
  v_mul_f32 v41, s27, v41
  v_mul_f32 v42, v42, v32
  v_mul_f32 v43, v43, v32
  v_add_f32 v42, v42, v42
  v_add_f32 v43, v43, v43
  ds_write_b128 v37, v[40:43] offset:18288
  v_cvt_f32_u32 v44, v4
  v_lshlrev_b32 v45, 4, v4
  v_cvt_f32_u32 v45, v45
  v_lshlrev_b32 v46, 4, v3
  v_add_u32 v46, s17, v46
  v_mov_b32 v48, 0
  v_mov_b32 v49, 0
  v_mov_b32 v50, 0
  v_mov_b32 v51, 0
  v_mov_b32 v52, 0
  v_mov_b32 v53, 0
  v_mov_b32 v54, 0
  v_mov_b32 v55, 0
  v_mov_b32 v56, 0
  v_mov_b32 v57, 0
  v_mov_b32 v58, 0
  v_mov_b32 v59, 0
  v_mov_b32 v60, 0
  v_mov_b32 v61, 0
  v_mov_b32 v62, 0
  v_mov_b32 v63, 0
  v_mov_b32 v64, 0
  v_mov_b32 v65, 0
  v_mov_b32 v66, 0
  v_mov_b32 v67, 0
  s_mov_b32 s28, 0
  s_waitcnt lgkmcnt(0)
  ds_read_b128 v[68:71], v46 offset:18240
wk_kl:
  s_waitcnt lgkmcnt(0)
  v_mov_b32 v72, v68
  v_mov_b32 v73, v69
  v_mov_b32 v74, v70
  v_mov_b32 v75, v71
  v_add_u32 v46, 64, v46
  ds_read_b128 v[68:71], v46 offset:18240
  v_mul_f32 v80, v72, v45
  v_mul_f32 v81, v73, v45
  v_exp_f32 v80, v80
  v_fract_f32 v81, v81
  v_cos_f32 v76, v81
  v_sin_f32 v77, v81
  v_mul_f32 v76, v76, v80
  v_mul_f32 v77, v77, v80
  v_mul_f32 v80, v72, v44
  v_mul_f32 v81, v73, v44
  v_exp_f32 v80, v80
  v_fract_f32 v81, v81
  v_cos_f32 v78, v81
  v_sin_f32 v79, v81
  v_mul_f32 v78, v78, v80
  v_mul_f32 v79, v79, v80
  v_mul_f32 v82, v74, v76
  v_mul_f32 v83, v74, v77
  v_fma_f32 v82, -v75, v77, v82
  v_fma_f32 v83, -v75, v76, -v83
  v_mul_f32 v86, v76, v76
  v_mul_f32 v87, v76, v77
  v_fma_f32 v86, -v77, v77, v86
  v_add_f32 v87, v87, v87
  v_mfma_f32_16x16x4_f32 v[48:51], v82, v78, v[48:51]
  v_mul_f32 v88, v78, v78
  v_mul_f32 v89, v78, v79
  v_fma_f32 v88, -v79, v79, v88
  v_add_f32 v89, v89, v89
  v_mfma_f32_16x16x4_f32 v[48:51], v83, v79, v[48:51]
  v_mul_f32 v84, v74, v86
  v_mul_f32 v85, v74, v87
  v_fma_f32 v84, -v75, v87, v84
  v_fma_f32 v85, -v75, v86, -v85
  v_mul_f32 v76, v86, v86
  v_mul_f32 v77, v86, v87
  v_fma_f32 v76, -v87, v87, v76
  v_add_f32 v77, v77, v77
  v_mfma_f32_16x16x4_f32 v[52:55], v84, v88, v[52:55]
  v_mul_f32 v78, v88, v88
  v_mul_f32 v79, v88, v89
  v_fma_f32 v78, -v89, v89, v78
  v_add_f32 v79, v79, v79
  v_mfma_f32_16x16x4_f32 v[52:55], v85, v89, v[52:55]
  v_mul_f32 v82, v74, v76
  v_mul_f32 v83, v74, v77
  v_fma_f32 v82, -v75, v77, v82
  v_fma_f32 v83, -v75, v76, -v83
  v_mul_f32 v86, v76, v76
  v_mul_f32 v87, v76, v77
  v_fma_f32 v86, -v77, v77, v86
  v_add_f32 v87, v87, v87
  v_mfma_f32_16x16x4_f32 v[56:59], v82, v78, v[56:59]
  v_mul_f32 v88, v78, v78
  v_mul_f32 v89, v78, v79
  v_fma_f32 v88, -v79, v79, v88
  v_add_f32 v89, v89, v89
  v_mfma_f32_16x16x4_f32 v[56:59], v83, v79, v[56:59]
  v_mul_f32 v84, v74, v86
  v_mul_f32 v85, v74, v87
  v_fma_f32 v84, -v75, v87, v84
  v_fma_f32 v85, -v75, v86, -v85
  v_mul_f32 v76, v86, v86
  v_mul_f32 v77, v86, v87
  v_fma_f32 v76, -v87, v87, v76
  v_add_f32 v77, v77, v77
  v_mfma_f32_16x16x4_f32 v[60:63], v84, v88, v[60:63]
  v_mfma_f32_16x16x4_f32 v[60:63], v85, v89, v[60:63]
  v_mul_f32 v82, v74, v76
  v_fma_f32 v82, -v75, v77, v82
  s_nop 1
  v_mfma_f32_16x16x4_f32 v[64:67], v82, v88, v[64:67]
  s_add_u32 s28, s28, 1
  s_cmp_lt_u32 s28, 64
  s_cbranch_scc1 wk_kl
  s_nop 15
  s_nop 3
  v_lshlrev_b32 v46, 8, v3
  v_lshl_add_u32 v46, v4, 2, v46
  v_add_u32 v46, s17, v46
  ds_write_b32 v46, v48 offset:13056
  ds_write_b32 v46, v49 offset:13120
  ds_write_b32 v46, v50 offset:13184
  ds_write_b32 v46, v51 offset:13248
  s_waitcnt lgkmcnt(8)
  ds_write_b32 v46, v52 offset:14080
  ds_write_b32 v46, v53 offset:14144
  ds_write_b32 v46, v54 offset:14208
  ds_write_b32 v46, v55 offset:14272
  s_waitcnt lgkmcnt(8)
  ds_write_b32 v46, v56 offset:15104
  ds_write_b32 v46, v57 offset:15168
  ds_write_b32 v46, v58 offset:15232
  ds_write_b32 v46, v59 offset:15296
  s_waitcnt lgkmcnt(8)
  ds_write_b32 v46, v60 offset:16128
  ds_write_b32 v46, v61 offset:16192
  ds_write_b32 v46, v62 offset:16256
  ds_write_b32 v46, v63 offset:16320
  s_waitcnt lgkmcnt(8)
  ds_write_b32 v46, v64 offset:17152
  ds_write_b32 v46, v65 offset:17216
  ds_write_b32 v46, v66 offset:17280
  ds_write_b32 v46, v67 offset:17344
  s_waitcnt lgkmcnt(8)
  s_waitcnt lgkmcnt(0)
  ds_read_b32 v48, v200
  ds_read_b32 v49, v201
  ds_read_b32 v50, v202
  ds_read_b32 v51, v203
  ds_read_b32 v52, v204
  ds_read_b32 v53, v205
  ds_read_b32 v54, v206
  ds_read_b32 v55, v207
  s_waitcnt lgkmcnt(4)
  ds_read_b32 v56, v208
  ds_read_b32 v57, v209
  ds_read_b32 v58, v210
  ds_read_b32 v59, v211
  ds_read_b32 v60, v212
  ds_read_b32 v61, v213
  ds_read_b32 v62, v214
  ds_read_b32 v63, v215
  s_waitcnt lgkmcnt(4)
  ds_read_b32 v64, v216
  ds_read_b32 v65, v217
  ds_read_b32 v66, v218
  ds_read_b32 v67, v219
  ds_read_b32 v68, v220
  ds_read_b32 v69, v221
  ds_read_b32 v70, v222
  ds_read_b32 v71, v223
  s_waitcnt lgkmcnt(4)
  ds_read_b32 v72, v224
  ds_read_b32 v73, v225
  ds_read_b32 v74, v226
  ds_read_b32 v75, v227
  ds_read_b32 v76, v228
  ds_read_b32 v77, v229
  ds_read_b32 v78, v230
  ds_read_b32 v79, v231
  s_waitcnt lgkmcnt(4)
  ds_read_b32 v80, v232
  s_waitcnt lgkmcnt(0)
  v_lshlrev_b32 v46, 6, v1
  v_add_u32 v46, s17, v46
  v_cvt_pk_bf16_f32 v84, v48, v49
  v_cvt_pk_bf16_f32 v88, v49, v50
  v_cvt_pk_bf16_f32 v85, v50, v51
  v_cvt_pk_bf16_f32 v89, v51, v52
  v_cvt_pk_bf16_f32 v86, v52, v53
  v_cvt_pk_bf16_f32 v90, v53, v54
  v_cvt_pk_bf16_f32 v87, v54, v55
  v_cvt_pk_bf16_f32 v91, v55, v56
  ds_write_b128 v46, v[84:87] offset:4608
  ds_write_b128 v46, v[88:91] offset:8832
  s_waitcnt lgkmcnt(0)
  v_cvt_pk_bf16_f32 v84, v56, v57
  v_cvt_pk_bf16_f32 v88, v57, v58
  v_cvt_pk_bf16_f32 v85, v58, v59
  v_cvt_pk_bf16_f32 v89, v59, v60
  v_cvt_pk_bf16_f32 v86, v60, v61
  v_cvt_pk_bf16_f32 v90, v61, v62
  v_cvt_pk_bf16_f32 v87, v62, v63
  v_cvt_pk_bf16_f32 v91, v63, v64
  ds_write_b128 v46, v[84:87] offset:4624
  ds_write_b128 v46, v[88:91] offset:8848
  s_waitcnt lgkmcnt(0)
  v_cvt_pk_bf16_f32 v84, v64, v65
  v_cvt_pk_bf16_f32 v88, v65, v66
  v_cvt_pk_bf16_f32 v85, v66, v67
  v_cvt_pk_bf16_f32 v89, v67, v68
  v_cvt_pk_bf16_f32 v86, v68, v69
  v_cvt_pk_bf16_f32 v90, v69, v70
  v_cvt_pk_bf16_f32 v87, v70, v71
  v_cvt_pk_bf16_f32 v91, v71, v72
  ds_write_b128 v46, v[84:87] offset:4640
  ds_write_b128 v46, v[88:91] offset:8864
  s_waitcnt lgkmcnt(0)
  v_cvt_pk_bf16_f32 v84, v72, v73
  v_cvt_pk_bf16_f32 v88, v73, v74
  v_cvt_pk_bf16_f32 v85, v74, v75
  v_cvt_pk_bf16_f32 v89, v75, v76
  v_cvt_pk_bf16_f32 v86, v76, v77
  v_cvt_pk_bf16_f32 v90, v77, v78
  v_cvt_pk_bf16_f32 v87, v78, v79
  v_cvt_pk_bf16_f32 v91, v79, v80
  ds_write_b128 v46, v[84:87] offset:4656
  ds_write_b128 v46, v[88:91] offset:8880
  s_waitcnt lgkmcnt(0)
  s_barrier
  v_lshrrev_b32 v47, 1, v3
  v_sub_u32 v46, v4, v47
  v_add_u32 v46, 1, v46
  v_lshlrev_b32 v46, 5, v46
  v_and_b32 v48, 1, v3
  v_lshl_add_u32 v46, v48, 4, v46
  v_add_u32 v46, s17, v46
  ds_read_b128 a[0:3], v46 offset:32
  ds_read_b128 a[4:7], v46 offset:96
  ds_read_b128 a[8:11], v46 offset:160
  ds_read_b128 a[12:15], v46 offset:224
  ds_read_b128 a[16:19], v46 offset:288
  ds_read_b128 a[20:23], v46 offset:352
  ds_read_b128 a[24:27], v46 offset:416
  ds_read_b128 a[28:31], v46 offset:480
  s_waitcnt lgkmcnt(4)
  ds_read_b128 a[32:35], v46 offset:544
  ds_read_b128 a[36:39], v46 offset:608
  ds_read_b128 a[40:43], v46 offset:672
  ds_read_b128 a[44:47], v46 offset:736
  ds_read_b128 a[48:51], v46 offset:800
  ds_read_b128 a[52:55], v46 offset:864
  ds_read_b128 a[56:59], v46 offset:928
  ds_read_b128 a[60:63], v46 offset:992
  s_waitcnt lgkmcnt(4)
  ds_read_b128 a[64:67], v46 offset:1056
  ds_read_b128 a[68:71], v46 offset:1120
  ds_read_b128 a[72:75], v46 offset:1184
  ds_read_b128 a[76:79], v46 offset:1248
  ds_read_b128 a[80:83], v46 offset:1312
  ds_read_b128 a[84:87], v46 offset:1376
  ds_read_b128 a[88:91], v46 offset:1440
  ds_read_b128 a[92:95], v46 offset:1504
  s_waitcnt lgkmcnt(4)
  ds_read_b128 a[96:99], v46 offset:1568
  ds_read_b128 a[100:103], v46 offset:1632
  ds_read_b128 a[104:107], v46 offset:1696
  ds_read_b128 a[108:111], v46 offset:1760
  ds_read_b128 a[112:115], v46 offset:1824
  ds_read_b128 a[116:119], v46 offset:1888
  ds_read_b128 a[120:123], v46 offset:1952
  ds_read_b128 a[124:127], v46 offset:2016
  s_waitcnt lgkmcnt(4)
  ds_read_b128 a[128:131], v46 offset:2080
  ds_read_b128 a[132:135], v46 offset:2144
  ds_read_b128 a[136:139], v46 offset:2208
  ds_read_b128 a[140:143], v46 offset:2272
  ds_read_b128 a[144:147], v46 offset:2336
  ds_read_b128 a[148:151], v46 offset:2400
  ds_read_b128 a[152:155], v46 offset:2464
  ds_read_b128 a[156:159], v46 offset:2528
  s_waitcnt lgkmcnt(4)
  ds_read_b128 a[160:163], v46 offset:2592
  ds_read_b128 a[164:167], v46 offset:2656
  ds_read_b128 a[168:171], v46 offset:2720
  ds_read_b128 a[172:175], v46 offset:2784
  ds_read_b128 a[176:179], v46 offset:2848
  ds_read_b128 a[180:183], v46 offset:2912
  ds_read_b128 a[184:187], v46 offset:2976
  ds_read_b128 a[188:191], v46 offset:3040
  s_waitcnt lgkmcnt(4)
  ds_read_b128 a[192:195], v46 offset:3104
  ds_read_b128 a[196:199], v46 offset:3168
  ds_read_b128 a[200:203], v46 offset:3232
  ds_read_b128 a[204:207], v46 offset:3296
  ds_read_b128 a[208:211], v46 offset:3360
  ds_read_b128 a[212:215], v46 offset:3424
  ds_read_b128 a[216:219], v46 offset:3488
  ds_read_b128 a[220:223], v46 offset:3552
  s_waitcnt lgkmcnt(4)
  ds_read_b128 a[224:227], v46 offset:3616
  ds_read_b128 a[228:231], v46 offset:3680
  ds_read_b128 a[232:235], v46 offset:3744
  ds_read_b128 a[236:239], v46 offset:3808
  ds_read_b128 a[240:243], v46 offset:3872
  ds_read_b128 a[244:247], v46 offset:3936
  ds_read_b128 a[248:251], v46 offset:4000
  ds_read_b128 a[252:255], v46 offset:4064
  s_waitcnt lgkmcnt(4)
  v_lshlrev_b32 v49, 4, v47
  v_add_u32 v49, v49, v4
  v_sub_u32 v49, 2047, v49
  v_lshl_add_u32 v49, v48, 3, v49
  v_and_b32 v50, 1, v49
  v_lshrrev_b32 v49, 1, v49
  v_lshlrev_b32 v49, 2, v49
  v_mul_u32_u24 v50, 4224, v50
  v_add3_u32 v49, v49, v50, s17
  v_add_u32 v49, 4608, v49
  v_subrev_u32 v52, 896, v49
  v_subrev_u32 v53, 1856, v49
  v_subrev_u32 v54, 2816, v49
  v_subrev_u32 v55, 3776, v49
  v_subrev_u32 v56, 4736, v49
  s_waitcnt lgkmcnt(0)
  ds_read2_b32 v[92:93], v52 offset0:224 offset1:225
  ds_read2_b32 v[94:95], v52 offset0:226 offset1:227
  ds_read2_b32 v[96:97], v52 offset0:208 offset1:209
  ds_read2_b32 v[98:99], v52 offset0:210 offset1:211
  ds_read2_b32 v[100:101], v52 offset0:192 offset1:193
  ds_read2_b32 v[102:103], v52 offset0:194 offset1:195
  ds_read2_b32 v[104:105], v52 offset0:176 offset1:177
  ds_read2_b32 v[106:107], v52 offset0:178 offset1:179
  s_waitcnt lgkmcnt(6)
  v_mfma_f32_16x16x32_bf16 v[60:63], v[92:95], a[28:31], 0
  v_mfma_f32_16x16x32_bf16 v[64:67], v[92:95], a[60:63], 0
  v_mfma_f32_16x16x32_bf16 v[68:71], v[92:95], a[92:95], 0
  v_mfma_f32_16x16x32_bf16 v[72:75], v[92:95], a[124:127], 0
  v_mfma_f32_16x16x32_bf16 v[76:79], v[92:95], a[156:159], 0
  v_mfma_f32_16x16x32_bf16 v[80:83], v[92:95], a[188:191], 0
  v_mfma_f32_16x16x32_bf16 v[84:87], v[92:95], a[220:223], 0
  v_mfma_f32_16x16x32_bf16 v[88:91], v[92:95], a[252:255], 0
  ds_read2_b32 v[92:93], v52 offset0:160 offset1:161
  ds_read2_b32 v[94:95], v52 offset0:162 offset1:163
  s_waitcnt lgkmcnt(6)
  v_mfma_f32_16x16x32_bf16 v[60:63], v[96:99], a[24:27], v[60:63]
  v_mfma_f32_16x16x32_bf16 v[64:67], v[96:99], a[56:59], v[64:67]
  v_mfma_f32_16x16x32_bf16 v[68:71], v[96:99], a[88:91], v[68:71]
  v_mfma_f32_16x16x32_bf16 v[72:75], v[96:99], a[120:123], v[72:75]
  v_mfma_f32_16x16x32_bf16 v[76:79], v[96:99], a[152:155], v[76:79]
  v_mfma_f32_16x16x32_bf16 v[80:83], v[96:99], a[184:187], v[80:83]
  v_mfma_f32_16x16x32_bf16 v[84:87], v[96:99], a[216:219], v[84:87]
  v_mfma_f32_16x16x32_bf16 v[88:91], v[96:99], a[248:251], v[88:91]
  ds_read2_b32 v[96:97], v52 offset0:144 offset1:145
  ds_read2_b32 v[98:99], v52 offset0:146 offset1:147
  s_waitcnt lgkmcnt(6)
  v_mfma_f32_16x16x32_bf16 v[60:63], v[100:103], a[20:23], v[60:63]
  v_mfma_f32_16x16x32_bf16 v[64:67], v[100:103], a[52:55], v[64:67]
  v_mfma_f32_16x16x32_bf16 v[68:71], v[100:103], a[84:87], v[68:71]
  v_mfma_f32_16x16x32_bf16 v[72:75], v[100:103], a[116:119], v[72:75]
  v_mfma_f32_16x16x32_bf16 v[76:79], v[100:103], a[148:151], v[76:79]
  v_mfma_f32_16x16x32_bf16 v[80:83], v[100:103], a[180:183], v[80:83]
  v_mfma_f32_16x16x32_bf16 v[84:87], v[100:103], a[212:215], v[84:87]
  v_mfma_f32_16x16x32_bf16 v[88:91], v[100:103], a[244:247], v[88:91]
  ds_read2_b32 v[100:101], v52 offset0:128 offset1:129
  ds_read2_b32 v[102:103], v52 offset0:130 offset1:131
  s_waitcnt lgkmcnt(6)
  v_mfma_f32_16x16x32_bf16 v[60:63], v[104:107], a[16:19], v[60:63]
  v_mfma_f32_16x16x32_bf16 v[64:67], v[104:107], a[48:51], v[64:67]
  v_mfma_f32_16x16x32_bf16 v[68:71], v[104:107], a[80:83], v[68:71]
  v_mfma_f32_16x16x32_bf16 v[72:75], v[104:107], a[112:115], v[72:75]
  v_mfma_f32_16x16x32_bf16 v[76:79], v[104:107], a[144:147], v[76:79]
  v_mfma_f32_16x16x32_bf16 v[80:83], v[104:107], a[176:179], v[80:83]
  v_mfma_f32_16x16x32_bf16 v[84:87], v[104:107], a[208:211], v[84:87]
  v_mfma_f32_16x16x32_bf16 v[88:91], v[104:107], a[240:243], v[88:91]
  ds_read2_b32 v[104:105], v52 offset0:112 offset1:113
  ds_read2_b32 v[106:107], v52 offset0:114 offset1:115
  s_waitcnt lgkmcnt(6)
  v_mfma_f32_16x16x32_bf16 v[60:63], v[92:95], a[12:15], v[60:63]
  v_mfma_f32_16x16x32_bf16 v[64:67], v[92:95], a[44:47], v[64:67]
  v_mfma_f32_16x16x32_bf16 v[68:71], v[92:95], a[76:79], v[68:71]
  v_mfma_f32_16x16x32_bf16 v[72:75], v[92:95], a[108:111], v[72:75]
  v_mfma_f32_16x16x32_bf16 v[76:79], v[92:95], a[140:143], v[76:79]
  v_mfma_f32_16x16x32_bf16 v[80:83], v[92:95], a[172:175], v[80:83]
  v_mfma_f32_16x16x32_bf16 v[84:87], v[92:95], a[204:207], v[84:87]
  v_mfma_f32_16x16x32_bf16 v[88:91], v[92:95], a[236:239], v[88:91]
  ds_read2_b32 v[92:93], v52 offset0:96 offset1:97
  ds_read2_b32 v[94:95], v52 offset0:98 offset1:99
  s_waitcnt lgkmcnt(6)
  v_mfma_f32_16x16x32_bf16 v[60:63], v[96:99], a[8:11], v[60:63]
  v_mfma_f32_16x16x32_bf16 v[64:67], v[96:99], a[40:43], v[64:67]
  v_mfma_f32_16x16x32_bf16 v[68:71], v[96:99], a[72:75], v[68:71]
  v_mfma_f32_16x16x32_bf16 v[72:75], v[96:99], a[104:107], v[72:75]
  v_mfma_f32_16x16x32_bf16 v[76:79], v[96:99], a[136:139], v[76:79]
  v_mfma_f32_16x16x32_bf16 v[80:83], v[96:99], a[168:171], v[80:83]
  v_mfma_f32_16x16x32_bf16 v[84:87], v[96:99], a[200:203], v[84:87]
  v_mfma_f32_16x16x32_bf16 v[88:91], v[96:99], a[232:235], v[88:91]
  ds_read2_b32 v[96:97], v52 offset0:80 offset1:81
  ds_read2_b32 v[98:99], v52 offset0:82 offset1:83
  s_waitcnt lgkmcnt(6)
  v_mfma_f32_16x16x32_bf16 v[60:63], v[100:103], a[4:7], v[60:63]
  v_mfma_f32_16x16x32_bf16 v[64:67], v[100:103], a[36:39], v[64:67]
  v_mfma_f32_16x16x32_bf16 v[68:71], v[100:103], a[68:71], v[68:71]
  v_mfma_f32_16x16x32_bf16 v[72:75], v[100:103], a[100:103], v[72:75]
  v_mfma_f32_16x16x32_bf16 v[76:79], v[100:103], a[132:135], v[76:79]
  v_mfma_f32_16x16x32_bf16 v[80:83], v[100:103], a[164:167], v[80:83]
  v_mfma_f32_16x16x32_bf16 v[84:87], v[100:103], a[196:199], v[84:87]
  v_mfma_f32_16x16x32_bf16 v[88:91], v[100:103], a[228:231], v[88:91]
  ds_read2_b32 v[100:101], v52 offset0:64 offset1:65
  ds_read2_b32 v[102:103], v52 offset0:66 offset1:67
  s_waitcnt lgkmcnt(6)
  v_mfma_f32_16x16x32_bf16 v[60:63], v[104:107], a[0:3], v[60:63]
  v_mfma_f32_16x16x32_bf16 v[64:67], v[104:107], a[32:35], v[64:67]
  v_mfma_f32_16x16x32_bf16 v[68:71], v[104:107], a[64:67], v[68:71]
  v_mfma_f32_16x16x32_bf16 v[72:75], v[104:107], a[96:99], v[72:75]
  v_mfma_f32_16x16x32_bf16 v[76:79], v[104:107], a[128:131], v[76:79]
  v_mfma_f32_16x16x32_bf16 v[80:83], v[104:107], a[160:163], v[80:83]
  v_mfma_f32_16x16x32_bf16 v[84:87], v[104:107], a[192:195], v[84:87]
  v_mfma_f32_16x16x32_bf16 v[88:91], v[104:107], a[224:227], v[88:91]
  ds_read2_b32 v[104:105], v52 offset0:48 offset1:49
  ds_read2_b32 v[106:107], v52 offset0:50 offset1:51
  s_waitcnt lgkmcnt(6)
  v_mfma_f32_16x16x32_bf16 v[64:67], v[92:95], a[28:31], v[64:67]
  v_mfma_f32_16x16x32_bf16 v[68:71], v[92:95], a[60:63], v[68:71]
  v_mfma_f32_16x16x32_bf16 v[72:75], v[92:95], a[92:95], v[72:75]
  v_mfma_f32_16x16x32_bf16 v[76:79], v[92:95], a[124:127], v[76:79]
  v_mfma_f32_16x16x32_bf16 v[80:83], v[92:95], a[156:159], v[80:83]
  v_mfma_f32_16x16x32_bf16 v[84:87], v[92:95], a[188:191], v[84:87]
  v_mfma_f32_16x16x32_bf16 v[88:91], v[92:95], a[220:223], v[88:91]
  ds_read2_b32 v[92:93], v52 offset0:32 offset1:33
  ds_read2_b32 v[94:95], v52 offset0:34 offset1:35
  s_waitcnt lgkmcnt(6)
  v_mfma_f32_16x16x32_bf16 v[64:67], v[96:99], a[24:27], v[64:67]
  v_mfma_f32_16x16x32_bf16 v[68:71], v[96:99], a[56:59], v[68:71]
  v_mfma_f32_16x16x32_bf16 v[72:75], v[96:99], a[88:91], v[72:75]
  v_mfma_f32_16x16x32_bf16 v[76:79], v[96:99], a[120:123], v[76:79]
  v_mfma_f32_16x16x32_bf16 v[80:83], v[96:99], a[152:155], v[80:83]
  v_mfma_f32_16x16x32_bf16 v[84:87], v[96:99], a[184:187], v[84:87]
  v_mfma_f32_16x16x32_bf16 v[88:91], v[96:99], a[216:219], v[88:91]
  ds_read2_b32 v[96:97], v52 offset0:16 offset1:17
  ds_read2_b32 v[98:99], v52 offset0:18 offset1:19
  s_waitcnt lgkmcnt(6)
  v_mfma_f32_16x16x32_bf16 v[64:67], v[100:103], a[20:23], v[64:67]
  v_mfma_f32_16x16x32_bf16 v[68:71], v[100:103], a[52:55], v[68:71]
  v_mfma_f32_16x16x32_bf16 v[72:75], v[100:103], a[84:87], v[72:75]
  v_mfma_f32_16x16x32_bf16 v[76:79], v[100:103], a[116:119], v[76:79]
  v_mfma_f32_16x16x32_bf16 v[80:83], v[100:103], a[148:151], v[80:83]
  v_mfma_f32_16x16x32_bf16 v[84:87], v[100:103], a[180:183], v[84:87]
  v_mfma_f32_16x16x32_bf16 v[88:91], v[100:103], a[212:215], v[88:91]
  ds_read2_b32 v[100:101], v52 offset0:0 offset1:1
  ds_read2_b32 v[102:103], v52 offset0:2 offset1:3
  s_waitcnt lgkmcnt(6)
  v_mfma_f32_16x16x32_bf16 v[64:67], v[104:107], a[16:19], v[64:67]
  v_mfma_f32_16x16x32_bf16 v[68:71], v[104:107], a[48:51], v[68:71]
  v_mfma_f32_16x16x32_bf16 v[72:75], v[104:107], a[80:83], v[72:75]
  v_mfma_f32_16x16x32_bf16 v[76:79], v[104:107], a[112:115], v[76:79]
  v_mfma_f32_16x16x32_bf16 v[80:83], v[104:107], a[144:147], v[80:83]
  v_mfma_f32_16x16x32_bf16 v[84:87], v[104:107], a[176:179], v[84:87]
  v_mfma_f32_16x16x32_bf16 v[88:91], v[104:107], a[208:211], v[88:91]
  ds_read2_b32 v[104:105], v53 offset0:224 offset1:225
  ds_read2_b32 v[106:107], v53 offset0:226 offset1:227
  s_waitcnt lgkmcnt(6)
  v_mfma_f32_16x16x32_bf16 v[64:67], v[92:95], a[12:15], v[64:67]
  v_mfma_f32_16x16x32_bf16 v[68:71], v[92:95], a[44:47], v[68:71]
  v_mfma_f32_16x16x32_bf16 v[72:75], v[92:95], a[76:79], v[72:75]
  v_mfma_f32_16x16x32_bf16 v[76:79], v[92:95], a[108:111], v[76:79]
  v_mfma_f32_16x16x32_bf16 v[80:83], v[92:95], a[140:143], v[80:83]
  v_mfma_f32_16x16x32_bf16 v[84:87], v[92:95], a[172:175], v[84:87]
  v_mfma_f32_16x16x32_bf16 v[88:91], v[92:95], a[204:207], v[88:91]
  ds_read2_b32 v[92:93], v53 offset0:208 offset1:209
  ds_read2_b32 v[94:95], v53 offset0:210 offset1:211
  s_waitcnt lgkmcnt(6)
  v_mfma_f32_16x16x32_bf16 v[64:67], v[96:99], a[8:11], v[64:67]
  v_mfma_f32_16x16x32_bf16 v[68:71], v[96:99], a[40:43], v[68:71]
  v_mfma_f32_16x16x32_bf16 v[72:75], v[96:99], a[72:75], v[72:75]
  v_mfma_f32_16x16x32_bf16 v[76:79], v[96:99], a[104:107], v[76:79]
  v_mfma_f32_16x16x32_bf16 v[80:83], v[96:99], a[136:139], v[80:83]
  v_mfma_f32_16x16x32_bf16 v[84:87], v[96:99], a[168:171], v[84:87]
  v_mfma_f32_16x16x32_bf16 v[88:91], v[96:99], a[200:203], v[88:91]
  ds_read2_b32 v[96:97], v53 offset0:192 offset1:193
  ds_read2_b32 v[98:99], v53 offset0:194 offset1:195
  s_waitcnt lgkmcnt(6)
  v_mfma_f32_16x16x32_bf16 v[64:67], v[100:103], a[4:7], v[64:67]
  v_mfma_f32_16x16x32_bf16 v[68:71], v[100:103], a[36:39], v[68:71]
  v_mfma_f32_16x16x32_bf16 v[72:75], v[100:103], a[68:71], v[72:75]
  v_mfma_f32_16x16x32_bf16 v[76:79], v[100:103], a[100:103], v[76:79]
  v_mfma_f32_16x16x32_bf16 v[80:83], v[100:103], a[132:135], v[80:83]
  v_mfma_f32_16x16x32_bf16 v[84:87], v[100:103], a[164:167], v[84:87]
  v_mfma_f32_16x16x32_bf16 v[88:91], v[100:103], a[196:199], v[88:91]
  ds_read2_b32 v[100:101], v53 offset0:176 offset1:177
  ds_read2_b32 v[102:103], v53 offset0:178 offset1:179
  s_waitcnt lgkmcnt(6)
  v_mfma_f32_16x16x32_bf16 v[64:67], v[104:107], a[0:3], v[64:67]
  v_mfma_f32_16x16x32_bf16 v[68:71], v[104:107], a[32:35], v[68:71]
  v_mfma_f32_16x16x32_bf16 v[72:75], v[104:107], a[64:67], v[72:75]
  v_mfma_f32_16x16x32_bf16 v[76:79], v[104:107], a[96:99], v[76:79]
  v_mfma_f32_16x16x32_bf16 v[80:83], v[104:107], a[128:131], v[80:83]
  v_mfma_f32_16x16x32_bf16 v[84:87], v[104:107], a[160:163], v[84:87]
  v_mfma_f32_16x16x32_bf16 v[88:91], v[104:107], a[192:195], v[88:91]
  ds_read2_b32 v[104:105], v53 offset0:160 offset1:161
  ds_read2_b32 v[106:107], v53 offset0:162 offset1:163
  s_waitcnt lgkmcnt(6)
  v_mfma_f32_16x16x32_bf16 v[68:71], v[92:95], a[28:31], v[68:71]
  v_mfma_f32_16x16x32_bf16 v[72:75], v[92:95], a[60:63], v[72:75]
  v_mfma_f32_16x16x32_bf16 v[76:79], v[92:95], a[92:95], v[76:79]
  v_mfma_f32_16x16x32_bf16 v[80:83], v[92:95], a[124:127], v[80:83]
  v_mfma_f32_16x16x32_bf16 v[84:87], v[92:95], a[156:159], v[84:87]
  v_mfma_f32_16x16x32_bf16 v[88:91], v[92:95], a[188:191], v[88:91]
  ds_read2_b32 v[92:93], v53 offset0:144 offset1:145
  ds_read2_b32 v[94:95], v53 offset0:146 offset1:147
  s_waitcnt lgkmcnt(6)
  v_mfma_f32_16x16x32_bf16 v[68:71], v[96:99], a[24:27], v[68:71]
  v_mfma_f32_16x16x32_bf16 v[72:75], v[96:99], a[56:59], v[72:75]
  v_mfma_f32_16x16x32_bf16 v[76:79], v[96:99], a[88:91], v[76:79]
  v_mfma_f32_16x16x32_bf16 v[80:83], v[96:99], a[120:123], v[80:83]
  v_mfma_f32_16x16x32_bf16 v[84:87], v[96:99], a[152:155], v[84:87]
  v_mfma_f32_16x16x32_bf16 v[88:91], v[96:99], a[184:187], v[88:91]
  ds_read2_b32 v[96:97], v53 offset0:128 offset1:129
  ds_read2_b32 v[98:99], v53 offset0:130 offset1:131
  s_waitcnt lgkmcnt(6)
  v_mfma_f32_16x16x32_bf16 v[68:71], v[100:103], a[20:23], v[68:71]
  v_mfma_f32_16x16x32_bf16 v[72:75], v[100:103], a[52:55], v[72:75]
  v_mfma_f32_16x16x32_bf16 v[76:79], v[100:103], a[84:87], v[76:79]
  v_mfma_f32_16x16x32_bf16 v[80:83], v[100:103], a[116:119], v[80:83]
  v_mfma_f32_16x16x32_bf16 v[84:87], v[100:103], a[148:151], v[84:87]
  v_mfma_f32_16x16x32_bf16 v[88:91], v[100:103], a[180:183], v[88:91]
  ds_read2_b32 v[100:101], v53 offset0:112 offset1:113
  ds_read2_b32 v[102:103], v53 offset0:114 offset1:115
  s_waitcnt lgkmcnt(6)
  v_mfma_f32_16x16x32_bf16 v[68:71], v[104:107], a[16:19], v[68:71]
  v_mfma_f32_16x16x32_bf16 v[72:75], v[104:107], a[48:51], v[72:75]
  v_mfma_f32_16x16x32_bf16 v[76:79], v[104:107], a[80:83], v[76:79]
  v_mfma_f32_16x16x32_bf16 v[80:83], v[104:107], a[112:115], v[80:83]
  v_mfma_f32_16x16x32_bf16 v[84:87], v[104:107], a[144:147], v[84:87]
  v_mfma_f32_16x16x32_bf16 v[88:91], v[104:107], a[176:179], v[88:91]
  ds_read2_b32 v[104:105], v53 offset0:96 offset1:97
  ds_read2_b32 v[106:107], v53 offset0:98 offset1:99
  s_waitcnt lgkmcnt(6)
  v_mfma_f32_16x16x32_bf16 v[68:71], v[92:95], a[12:15], v[68:71]
  v_mfma_f32_16x16x32_bf16 v[72:75], v[92:95], a[44:47], v[72:75]
  v_mfma_f32_16x16x32_bf16 v[76:79], v[92:95], a[76:79], v[76:79]
  v_mfma_f32_16x16x32_bf16 v[80:83], v[92:95], a[108:111], v[80:83]
  v_mfma_f32_16x16x32_bf16 v[84:87], v[92:95], a[140:143], v[84:87]
  v_mfma_f32_16x16x32_bf16 v[88:91], v[92:95], a[172:175], v[88:91]
  ds_read2_b32 v[92:93], v53 offset0:80 offset1:81
  ds_read2_b32 v[94:95], v53 offset0:82 offset1:83
  s_waitcnt lgkmcnt(6)
  v_mfma_f32_16x16x32_bf16 v[68:71], v[96:99], a[8:11], v[68:71]
  v_mfma_f32_16x16x32_bf16 v[72:75], v[96:99], a[40:43], v[72:75]
  v_mfma_f32_16x16x32_bf16 v[76:79], v[96:99], a[72:75], v[76:79]
  v_mfma_f32_16x16x32_bf16 v[80:83], v[96:99], a[104:107], v[80:83]
  v_mfma_f32_16x16x32_bf16 v[84:87], v[96:99], a[136:139], v[84:87]
  v_mfma_f32_16x16x32_bf16 v[88:91], v[96:99], a[168:171], v[88:91]
  ds_read2_b32 v[96:97], v53 offset0:64 offset1:65
  ds_read2_b32 v[98:99], v53 offset0:66 offset1:67
  s_waitcnt lgkmcnt(6)
  v_mfma_f32_16x16x32_bf16 v[68:71], v[100:103], a[4:7], v[68:71]
  v_mfma_f32_16x16x32_bf16 v[72:75], v[100:103], a[36:39], v[72:75]
  v_mfma_f32_16x16x32_bf16 v[76:79], v[100:103], a[68:71], v[76:79]
  v_mfma_f32_16x16x32_bf16 v[80:83], v[100:103], a[100:103], v[80:83]
  v_mfma_f32_16x16x32_bf16 v[84:87], v[100:103], a[132:135], v[84:87]
  v_mfma_f32_16x16x32_bf16 v[88:91], v[100:103], a[164:167], v[88:91]
  ds_read2_b32 v[100:101], v53 offset0:48 offset1:49
  ds_read2_b32 v[102:103], v53 offset0:50 offset1:51
  s_waitcnt lgkmcnt(6)
  v_mfma_f32_16x16x32_bf16 v[68:71], v[104:107], a[0:3], v[68:71]
  v_mfma_f32_16x16x32_bf16 v[72:75], v[104:107], a[32:35], v[72:75]
  v_mfma_f32_16x16x32_bf16 v[76:79], v[104:107], a[64:67], v[76:79]
  v_mfma_f32_16x16x32_bf16 v[80:83], v[104:107], a[96:99], v[80:83]
  v_mfma_f32_16x16x32_bf16 v[84:87], v[104:107], a[128:131], v[84:87]
  v_mfma_f32_16x16x32_bf16 v[88:91], v[104:107], a[160:163], v[88:91]
  ds_read2_b32 v[104:105], v53 offset0:32 offset1:33
  ds_read2_b32 v[106:107], v53 offset0:34 offset1:35
  s_waitcnt lgkmcnt(6)
  v_mfma_f32_16x16x32_bf16 v[72:75], v[92:95], a[28:31], v[72:75]
  v_mfma_f32_16x16x32_bf16 v[76:79], v[92:95], a[60:63], v[76:79]
  v_mfma_f32_16x16x32_bf16 v[80:83], v[92:95], a[92:95], v[80:83]
  v_mfma_f32_16x16x32_bf16 v[84:87], v[92:95], a[124:127], v[84:87]
  v_mfma_f32_16x16x32_bf16 v[88:91], v[92:95], a[156:159], v[88:91]
  ds_read2_b32 v[92:93], v53 offset0:16 offset1:17
  ds_read2_b32 v[94:95], v53 offset0:18 offset1:19
  s_waitcnt lgkmcnt(6)
  v_mfma_f32_16x16x32_bf16 v[72:75], v[96:99], a[24:27], v[72:75]
  v_mfma_f32_16x16x32_bf16 v[76:79], v[96:99], a[56:59], v[76:79]
  v_mfma_f32_16x16x32_bf16 v[80:83], v[96:99], a[88:91], v[80:83]
  v_mfma_f32_16x16x32_bf16 v[84:87], v[96:99], a[120:123], v[84:87]
  v_mfma_f32_16x16x32_bf16 v[88:91], v[96:99], a[152:155], v[88:91]
  ds_read2_b32 v[96:97], v53 offset0:0 offset1:1
  ds_read2_b32 v[98:99], v53 offset0:2 offset1:3
  s_waitcnt lgkmcnt(6)
  v_mfma_f32_16x16x32_bf16 v[72:75], v[100:103], a[20:23], v[72:75]
  v_mfma_f32_16x16x32_bf16 v[76:79], v[100:103], a[52:55], v[76:79]
  v_mfma_f32_16x16x32_bf16 v[80:83], v[100:103], a[84:87], v[80:83]
  v_mfma_f32_16x16x32_bf16 v[84:87], v[100:103], a[116:119], v[84:87]
  v_mfma_f32_16x16x32_bf16 v[88:91], v[100:103], a[148:151], v[88:91]
  ds_read2_b32 v[100:101], v54 offset0:224 offset1:225
  ds_read2_b32 v[102:103], v54 offset0:226 offset1:227
  s_waitcnt lgkmcnt(6)
  v_mfma_f32_16x16x32_bf16 v[72:75], v[104:107], a[16:19], v[72:75]
  v_mfma_f32_16x16x32_bf16 v[76:79], v[104:107], a[48:51], v[76:79]
  v_mfma_f32_16x16x32_bf16 v[80:83], v[104:107], a[80:83], v[80:83]
  v_mfma_f32_16x16x32_bf16 v[84:87], v[104:107], a[112:115], v[84:87]
  v_mfma_f32_16x16x32_bf16 v[88:91], v[104:107], a[144:147], v[88:91]
  ds_read2_b32 v[104:105], v54 offset0:208 offset1:209
  ds_read2_b32 v[106:107], v54 offset0:210 offset1:211
  s_waitcnt lgkmcnt(6)
  v_mfma_f32_16x16x32_bf16 v[72:75], v[92:95], a[12:15], v[72:75]
  v_mfma_f32_16x16x32_bf16 v[76:79], v[92:95], a[44:47], v[76:79]
  v_mfma_f32_16x16x32_bf16 v[80:83], v[92:95], a[76:79], v[80:83]
  v_mfma_f32_16x16x32_bf16 v[84:87], v[92:95], a[108:111], v[84:87]
  v_mfma_f32_16x16x32_bf16 v[88:91], v[92:95], a[140:143], v[88:91]
  ds_read2_b32 v[92:93], v54 offset0:192 offset1:193
  ds_read2_b32 v[94:95], v54 offset0:194 offset1:195
  s_waitcnt lgkmcnt(6)
  v_mfma_f32_16x16x32_bf16 v[72:75], v[96:99], a[8:11], v[72:75]
  v_mfma_f32_16x16x32_bf16 v[76:79], v[96:99], a[40:43], v[76:79]
  v_mfma_f32_16x16x32_bf16 v[80:83], v[96:99], a[72:75], v[80:83]
  v_mfma_f32_16x16x32_bf16 v[84:87], v[96:99], a[104:107], v[84:87]
  v_mfma_f32_16x16x32_bf16 v[88:91], v[96:99], a[136:139], v[88:91]
  ds_read2_b32 v[96:97], v54 offset0:176 offset1:177
  ds_read2_b32 v[98:99], v54 offset0:178 offset1:179
  s_waitcnt lgkmcnt(6)
  v_mfma_f32_16x16x32_bf16 v[72:75], v[100:103], a[4:7], v[72:75]
  v_mfma_f32_16x16x32_bf16 v[76:79], v[100:103], a[36:39], v[76:79]
  v_mfma_f32_16x16x32_bf16 v[80:83], v[100:103], a[68:71], v[80:83]
  v_mfma_f32_16x16x32_bf16 v[84:87], v[100:103], a[100:103], v[84:87]
  v_mfma_f32_16x16x32_bf16 v[88:91], v[100:103], a[132:135], v[88:91]
  ds_read2_b32 v[100:101], v54 offset0:160 offset1:161
  ds_read2_b32 v[102:103], v54 offset0:162 offset1:163
  s_waitcnt lgkmcnt(6)
  v_mfma_f32_16x16x32_bf16 v[72:75], v[104:107], a[0:3], v[72:75]
  v_mfma_f32_16x16x32_bf16 v[76:79], v[104:107], a[32:35], v[76:79]
  v_mfma_f32_16x16x32_bf16 v[80:83], v[104:107], a[64:67], v[80:83]
  v_mfma_f32_16x16x32_bf16 v[84:87], v[104:107], a[96:99], v[84:87]
  v_mfma_f32_16x16x32_bf16 v[88:91], v[104:107], a[128:131], v[88:91]
  ds_read2_b32 v[104:105], v54 offset0:144 offset1:145
  ds_read2_b32 v[106:107], v54 offset0:146 offset1:147
  s_waitcnt lgkmcnt(6)
  v_mfma_f32_16x16x32_bf16 v[76:79], v[92:95], a[28:31], v[76:79]
  v_mfma_f32_16x16x32_bf16 v[80:83], v[92:95], a[60:63], v[80:83]
  v_mfma_f32_16x16x32_bf16 v[84:87], v[92:95], a[92:95], v[84:87]
  v_mfma_f32_16x16x32_bf16 v[88:91], v[92:95], a[124:127], v[88:91]
  ds_read2_b32 v[92:93], v54 offset0:128 offset1:129
  ds_read2_b32 v[94:95], v54 offset0:130 offset1:131
  s_waitcnt lgkmcnt(6)
  v_mfma_f32_16x16x32_bf16 v[76:79], v[96:99], a[24:27], v[76:79]
  v_mfma_f32_16x16x32_bf16 v[80:83], v[96:99], a[56:59], v[80:83]
  v_mfma_f32_16x16x32_bf16 v[84:87], v[96:99], a[88:91], v[84:87]
  v_mfma_f32_16x16x32_bf16 v[88:91], v[96:99], a[120:123], v[88:91]
  ds_read2_b32 v[96:97], v54 offset0:112 offset1:113
  ds_read2_b32 v[98:99], v54 offset0:114 offset1:115
  s_waitcnt lgkmcnt(6)
  v_mfma_f32_16x16x32_bf16 v[76:79], v[100:103], a[20:23], v[76:79]
  v_mfma_f32_16x16x32_bf16 v[80:83], v[100:103], a[52:55], v[80:83]
  v_mfma_f32_16x16x32_bf16 v[84:87], v[100:103], a[84:87], v[84:87]
  v_mfma_f32_16x16x32_bf16 v[88:91], v[100:103], a[116:119], v[88:91]
  ds_read2_b32 v[100:101], v54 offset0:96 offset1:97
  ds_read2_b32 v[102:103], v54 offset0:98 offset1:99
  s_waitcnt lgkmcnt(6)
  v_mfma_f32_16x16x32_bf16 v[76:79], v[104:107], a[16:19], v[76:79]
  v_mfma_f32_16x16x32_bf16 v[80:83], v[104:107], a[48:51], v[80:83]
  v_mfma_f32_16x16x32_bf16 v[84:87], v[104:107], a[80:83], v[84:87]
  v_mfma_f32_16x16x32_bf16 v[88:91], v[104:107], a[112:115], v[88:91]
  ds_read2_b32 v[104:105], v54 offset0:80 offset1:81
  ds_read2_b32 v[106:107], v54 offset0:82 offset1:83
  s_waitcnt lgkmcnt(6)
  v_mfma_f32_16x16x32_bf16 v[76:79], v[92:95], a[12:15], v[76:79]
  v_mfma_f32_16x16x32_bf16 v[80:83], v[92:95], a[44:47], v[80:83]
  v_mfma_f32_16x16x32_bf16 v[84:87], v[92:95], a[76:79], v[84:87]
  v_mfma_f32_16x16x32_bf16 v[88:91], v[92:95], a[108:111], v[88:91]
  ds_read2_b32 v[92:93], v54 offset0:64 offset1:65
  ds_read2_b32 v[94:95], v54 offset0:66 offset1:67
  s_waitcnt lgkmcnt(6)
  v_mfma_f32_16x16x32_bf16 v[76:79], v[96:99], a[8:11], v[76:79]
  v_mfma_f32_16x16x32_bf16 v[80:83], v[96:99], a[40:43], v[80:83]
  v_mfma_f32_16x16x32_bf16 v[84:87], v[96:99], a[72:75], v[84:87]
  v_mfma_f32_16x16x32_bf16 v[88:91], v[96:99], a[104:107], v[88:91]
  ds_read2_b32 v[96:97], v54 offset0:48 offset1:49
  ds_read2_b32 v[98:99], v54 offset0:50 offset1:51
  s_waitcnt lgkmcnt(6)
  v_mfma_f32_16x16x32_bf16 v[76:79], v[100:103], a[4:7], v[76:79]
  v_mfma_f32_16x16x32_bf16 v[80:83], v[100:103], a[36:39], v[80:83]
  v_mfma_f32_16x16x32_bf16 v[84:87], v[100:103], a[68:71], v[84:87]
  v_mfma_f32_16x16x32_bf16 v[88:91], v[100:103], a[100:103], v[88:91]
  ds_read2_b32 v[100:101], v54 offset0:32 offset1:33
  ds_read2_b32 v[102:103], v54 offset0:34 offset1:35
  s_waitcnt lgkmcnt(6)
  v_mfma_f32_16x16x32_bf16 v[76:79], v[104:107], a[0:3], v[76:79]
  v_mfma_f32_16x16x32_bf16 v[80:83], v[104:107], a[32:35], v[80:83]
  v_mfma_f32_16x16x32_bf16 v[84:87], v[104:107], a[64:67], v[84:87]
  v_mfma_f32_16x16x32_bf16 v[88:91], v[104:107], a[96:99], v[88:91]
  ds_read2_b32 v[104:105], v54 offset0:16 offset1:17
  ds_read2_b32 v[106:107], v54 offset0:18 offset1:19
  s_waitcnt lgkmcnt(6)
  v_mfma_f32_16x16x32_bf16 v[80:83], v[92:95], a[28:31], v[80:83]
  v_mfma_f32_16x16x32_bf16 v[84:87], v[92:95], a[60:63], v[84:87]
  v_mfma_f32_16x16x32_bf16 v[88:91], v[92:95], a[92:95], v[88:91]
  ds_read2_b32 v[92:93], v54 offset0:0 offset1:1
  ds_read2_b32 v[94:95], v54 offset0:2 offset1:3
  s_waitcnt lgkmcnt(6)
  v_mfma_f32_16x16x32_bf16 v[80:83], v[96:99], a[24:27], v[80:83]
  v_mfma_f32_16x16x32_bf16 v[84:87], v[96:99], a[56:59], v[84:87]
  v_mfma_f32_16x16x32_bf16 v[88:91], v[96:99], a[88:91], v[88:91]
  ds_read2_b32 v[96:97], v55 offset0:224 offset1:225
  ds_read2_b32 v[98:99], v55 offset0:226 offset1:227
  s_waitcnt lgkmcnt(6)
  v_mfma_f32_16x16x32_bf16 v[80:83], v[100:103], a[20:23], v[80:83]
  v_mfma_f32_16x16x32_bf16 v[84:87], v[100:103], a[52:55], v[84:87]
  v_mfma_f32_16x16x32_bf16 v[88:91], v[100:103], a[84:87], v[88:91]
  ds_read2_b32 v[100:101], v55 offset0:208 offset1:209
  ds_read2_b32 v[102:103], v55 offset0:210 offset1:211
  s_waitcnt lgkmcnt(6)
  v_mfma_f32_16x16x32_bf16 v[80:83], v[104:107], a[16:19], v[80:83]
  v_mfma_f32_16x16x32_bf16 v[84:87], v[104:107], a[48:51], v[84:87]
  v_mfma_f32_16x16x32_bf16 v[88:91], v[104:107], a[80:83], v[88:91]
  ds_read2_b32 v[104:105], v55 offset0:192 offset1:193
  ds_read2_b32 v[106:107], v55 offset0:194 offset1:195
  s_waitcnt lgkmcnt(6)
  v_mfma_f32_16x16x32_bf16 v[80:83], v[92:95], a[12:15], v[80:83]
  v_mfma_f32_16x16x32_bf16 v[84:87], v[92:95], a[44:47], v[84:87]
  v_mfma_f32_16x16x32_bf16 v[88:91], v[92:95], a[76:79], v[88:91]
  ds_read2_b32 v[92:93], v55 offset0:176 offset1:177
  ds_read2_b32 v[94:95], v55 offset0:178 offset1:179
  s_waitcnt lgkmcnt(6)
  v_mfma_f32_16x16x32_bf16 v[80:83], v[96:99], a[8:11], v[80:83]
  v_mfma_f32_16x16x32_bf16 v[84:87], v[96:99], a[40:43], v[84:87]
  v_mfma_f32_16x16x32_bf16 v[88:91], v[96:99], a[72:75], v[88:91]
  ds_read2_b32 v[96:97], v55 offset0:160 offset1:161
  ds_read2_b32 v[98:99], v55 offset0:162 offset1:163
  s_waitcnt lgkmcnt(6)
  v_mfma_f32_16x16x32_bf16 v[80:83], v[100:103], a[4:7], v[80:83]
  v_mfma_f32_16x16x32_bf16 v[84:87], v[100:103], a[36:39], v[84:87]
  v_mfma_f32_16x16x32_bf16 v[88:91], v[100:103], a[68:71], v[88:91]
  ds_read2_b32 v[100:101], v55 offset0:144 offset1:145
  ds_read2_b32 v[102:103], v55 offset0:146 offset1:147
  s_waitcnt lgkmcnt(6)
  v_mfma_f32_16x16x32_bf16 v[80:83], v[104:107], a[0:3], v[80:83]
  v_mfma_f32_16x16x32_bf16 v[84:87], v[104:107], a[32:35], v[84:87]
  v_mfma_f32_16x16x32_bf16 v[88:91], v[104:107], a[64:67], v[88:91]
  ds_read2_b32 v[104:105], v55 offset0:128 offset1:129
  ds_read2_b32 v[106:107], v55 offset0:130 offset1:131
  s_waitcnt lgkmcnt(6)
  v_mfma_f32_16x16x32_bf16 v[84:87], v[92:95], a[28:31], v[84:87]
  v_mfma_f32_16x16x32_bf16 v[88:91], v[92:95], a[60:63], v[88:91]
  ds_read2_b32 v[92:93], v55 offset0:112 offset1:113
  ds_read2_b32 v[94:95], v55 offset0:114 offset1:115
  s_waitcnt lgkmcnt(6)
  v_mfma_f32_16x16x32_bf16 v[84:87], v[96:99], a[24:27], v[84:87]
  v_mfma_f32_16x16x32_bf16 v[88:91], v[96:99], a[56:59], v[88:91]
  ds_read2_b32 v[96:97], v55 offset0:96 offset1:97
  ds_read2_b32 v[98:99], v55 offset0:98 offset1:99
  s_waitcnt lgkmcnt(6)
  v_mfma_f32_16x16x32_bf16 v[84:87], v[100:103], a[20:23], v[84:87]
  v_mfma_f32_16x16x32_bf16 v[88:91], v[100:103], a[52:55], v[88:91]
  ds_read2_b32 v[100:101], v55 offset0:80 offset1:81
  ds_read2_b32 v[102:103], v55 offset0:82 offset1:83
  s_waitcnt lgkmcnt(6)
  v_mfma_f32_16x16x32_bf16 v[84:87], v[104:107], a[16:19], v[84:87]
  v_mfma_f32_16x16x32_bf16 v[88:91], v[104:107], a[48:51], v[88:91]
  ds_read2_b32 v[104:105], v55 offset0:64 offset1:65
  ds_read2_b32 v[106:107], v55 offset0:66 offset1:67
  s_waitcnt lgkmcnt(6)
  v_mfma_f32_16x16x32_bf16 v[84:87], v[92:95], a[12:15], v[84:87]
  v_mfma_f32_16x16x32_bf16 v[88:91], v[92:95], a[44:47], v[88:91]
  ds_read2_b32 v[92:93], v55 offset0:48 offset1:49
  ds_read2_b32 v[94:95], v55 offset0:50 offset1:51
  s_waitcnt lgkmcnt(6)
  v_mfma_f32_16x16x32_bf16 v[84:87], v[96:99], a[8:11], v[84:87]
  v_mfma_f32_16x16x32_bf16 v[88:91], v[96:99], a[40:43], v[88:91]
  ds_read2_b32 v[96:97], v55 offset0:32 offset1:33
  ds_read2_b32 v[98:99], v55 offset0:34 offset1:35
  s_waitcnt lgkmcnt(6)
  v_mfma_f32_16x16x32_bf16 v[84:87], v[100:103], a[4:7], v[84:87]
  v_mfma_f32_16x16x32_bf16 v[88:91], v[100:103], a[36:39], v[88:91]
  ds_read2_b32 v[100:101], v55 offset0:16 offset1:17
  ds_read2_b32 v[102:103], v55 offset0:18 offset1:19
  s_waitcnt lgkmcnt(6)
  v_mfma_f32_16x16x32_bf16 v[84:87], v[104:107], a[0:3], v[84:87]
  v_mfma_f32_16x16x32_bf16 v[88:91], v[104:107], a[32:35], v[88:91]
  ds_read2_b32 v[104:105], v55 offset0:0 offset1:1
  ds_read2_b32 v[106:107], v55 offset0:2 offset1:3
  s_waitcnt lgkmcnt(6)
  v_mfma_f32_16x16x32_bf16 v[88:91], v[92:95], a[28:31], v[88:91]
  ds_read2_b32 v[92:93], v56 offset0:224 offset1:225
  ds_read2_b32 v[94:95], v56 offset0:226 offset1:227
  s_waitcnt lgkmcnt(6)
  v_mfma_f32_16x16x32_bf16 v[88:91], v[96:99], a[24:27], v[88:91]
  ds_read2_b32 v[96:97], v56 offset0:208 offset1:209
  ds_read2_b32 v[98:99], v56 offset0:210 offset1:211
  s_waitcnt lgkmcnt(6)
  v_mfma_f32_16x16x32_bf16 v[88:91], v[100:103], a[20:23], v[88:91]
  ds_read2_b32 v[100:101], v56 offset0:192 offset1:193
  ds_read2_b32 v[102:103], v56 offset0:194 offset1:195
  s_waitcnt lgkmcnt(6)
  v_mfma_f32_16x16x32_bf16 v[88:91], v[104:107], a[16:19], v[88:91]
  ds_read2_b32 v[104:105], v56 offset0:176 offset1:177
  ds_read2_b32 v[106:107], v56 offset0:178 offset1:179
  s_waitcnt lgkmcnt(6)
  v_mfma_f32_16x16x32_bf16 v[88:91], v[92:95], a[12:15], v[88:91]
  s_waitcnt lgkmcnt(4)
  v_mfma_f32_16x16x32_bf16 v[88:91], v[96:99], a[8:11], v[88:91]
  s_waitcnt lgkmcnt(2)
  v_mfma_f32_16x16x32_bf16 v[88:91], v[100:103], a[4:7], v[88:91]
  s_waitcnt lgkmcnt(0)
  v_mfma_f32_16x16x32_bf16 v[88:91], v[104:107], a[0:3], v[88:91]
  v_lshlrev_b32 v46, 5, v4
  v_lshl_add_u32 v46, v3, 3, v46
  v_add_u32 v46, s17, v46
  ds_read_b64 v[108:109], v46 offset:512
  ds_read_b64 v[110:111], v46 offset:1024
  ds_read_b64 v[112:113], v46 offset:1536
  ds_read_b64 v[114:115], v46 offset:2048
  ds_read_b64 v[116:117], v46 offset:2560
  ds_read_b64 v[118:119], v46 offset:3072
  ds_read_b64 v[120:121], v46 offset:3584
  ds_read_b64 v[122:123], v46 offset:4096
  s_waitcnt lgkmcnt(0)
  v_lshlrev_b32 v124, 16, v108
  v_and_b32 v125, 0xffff0000, v108
  v_lshlrev_b32 v126, 16, v109
  v_and_b32 v127, 0xffff0000, v109
  v_mul_f32 v124, v124, v33
  v_mul_f32 v125, v125, v33
  v_mul_f32 v126, v126, v33
  v_mul_f32 v127, v127, v33
  v_cvt_pk_bf16_f32 v128, v124, v125
  v_cvt_pk_bf16_f32 v129, v126, v127
  v_cvt_pk_bf16_f32 v130, v60, v61
  v_cvt_pk_bf16_f32 v131, v62, v63
  v_lshlrev_b32 v124, 16, v128
  v_and_b32 v125, 0xffff0000, v128
  v_lshlrev_b32 v132, 16, v130
  v_and_b32 v133, 0xffff0000, v130
  v_lshlrev_b32 v126, 16, v129
  v_and_b32 v127, 0xffff0000, v129
  v_lshlrev_b32 v134, 16, v131
  v_and_b32 v135, 0xffff0000, v131
  v_add_f32 v124, v124, v132
  v_add_f32 v125, v125, v133
  v_add_f32 v126, v126, v134
  v_add_f32 v127, v127, v135
  v_cvt_pk_bf16_f32 v108, v124, v125
  v_cvt_pk_bf16_f32 v109, v126, v127
  ds_write_b64 v46, v[108:109] offset:512
  v_lshlrev_b32 v124, 16, v110
  v_and_b32 v125, 0xffff0000, v110
  v_lshlrev_b32 v126, 16, v111
  v_and_b32 v127, 0xffff0000, v111
  v_mul_f32 v124, v124, v33
  v_mul_f32 v125, v125, v33
  v_mul_f32 v126, v126, v33
  v_mul_f32 v127, v127, v33
  v_cvt_pk_bf16_f32 v128, v124, v125
  v_cvt_pk_bf16_f32 v129, v126, v127
  v_cvt_pk_bf16_f32 v130, v64, v65
  v_cvt_pk_bf16_f32 v131, v66, v67
  v_lshlrev_b32 v124, 16, v128
  v_and_b32 v125, 0xffff0000, v128
  v_lshlrev_b32 v132, 16, v130
  v_and_b32 v133, 0xffff0000, v130
  v_lshlrev_b32 v126, 16, v129
  v_and_b32 v127, 0xffff0000, v129
  v_lshlrev_b32 v134, 16, v131
  v_and_b32 v135, 0xffff0000, v131
  v_add_f32 v124, v124, v132
  v_add_f32 v125, v125, v133
  v_add_f32 v126, v126, v134
  v_add_f32 v127, v127, v135
  v_cvt_pk_bf16_f32 v110, v124, v125
  v_cvt_pk_bf16_f32 v111, v126, v127
  ds_write_b64 v46, v[110:111] offset:1024
  v_lshlrev_b32 v124, 16, v112
  v_and_b32 v125, 0xffff0000, v112
  v_lshlrev_b32 v126, 16, v113
  v_and_b32 v127, 0xffff0000, v113
  v_mul_f32 v124, v124, v33
  v_mul_f32 v125, v125, v33
  v_mul_f32 v126, v126, v33
  v_mul_f32 v127, v127, v33
  v_cvt_pk_bf16_f32 v128, v124, v125
  v_cvt_pk_bf16_f32 v129, v126, v127
  v_cvt_pk_bf16_f32 v130, v68, v69
  v_cvt_pk_bf16_f32 v131, v70, v71
  v_lshlrev_b32 v124, 16, v128
  v_and_b32 v125, 0xffff0000, v128
  v_lshlrev_b32 v132, 16, v130
  v_and_b32 v133, 0xffff0000, v130
  v_lshlrev_b32 v126, 16, v129
  v_and_b32 v127, 0xffff0000, v129
  v_lshlrev_b32 v134, 16, v131
  v_and_b32 v135, 0xffff0000, v131
  v_add_f32 v124, v124, v132
  v_add_f32 v125, v125, v133
  v_add_f32 v126, v126, v134
  v_add_f32 v127, v127, v135
  v_cvt_pk_bf16_f32 v112, v124, v125
  v_cvt_pk_bf16_f32 v113, v126, v127
  ds_write_b64 v46, v[112:113] offset:1536
  v_lshlrev_b32 v124, 16, v114
  v_and_b32 v125, 0xffff0000, v114
  v_lshlrev_b32 v126, 16, v115
  v_and_b32 v127, 0xffff0000, v115
  v_mul_f32 v124, v124, v33
  v_mul_f32 v125, v125, v33
  v_mul_f32 v126, v126, v33
  v_mul_f32 v127, v127, v33
  v_cvt_pk_bf16_f32 v128, v124, v125
  v_cvt_pk_bf16_f32 v129, v126, v127
  v_cvt_pk_bf16_f32 v130, v72, v73
  v_cvt_pk_bf16_f32 v131, v74, v75
  v_lshlrev_b32 v124, 16, v128
  v_and_b32 v125, 0xffff0000, v128
  v_lshlrev_b32 v132, 16, v130
  v_and_b32 v133, 0xffff0000, v130
  v_lshlrev_b32 v126, 16, v129
  v_and_b32 v127, 0xffff0000, v129
  v_lshlrev_b32 v134, 16, v131
  v_and_b32 v135, 0xffff0000, v131
  v_add_f32 v124, v124, v132
  v_add_f32 v125, v125, v133
  v_add_f32 v126, v126, v134
  v_add_f32 v127, v127, v135
  v_cvt_pk_bf16_f32 v114, v124, v125
  v_cvt_pk_bf16_f32 v115, v126, v127
  ds_write_b64 v46, v[114:115] offset:2048
  v_lshlrev_b32 v124, 16, v116
  v_and_b32 v125, 0xffff0000, v116
  v_lshlrev_b32 v126, 16, v117
  v_and_b32 v127, 0xffff0000, v117
  v_mul_f32 v124, v124, v33
  v_mul_f32 v125, v125, v33
  v_mul_f32 v126, v126, v33
  v_mul_f32 v127, v127, v33
  v_cvt_pk_bf16_f32 v128, v124, v125
  v_cvt_pk_bf16_f32 v129, v126, v127
  v_cvt_pk_bf16_f32 v130, v76, v77
  v_cvt_pk_bf16_f32 v131, v78, v79
  v_lshlrev_b32 v124, 16, v128
  v_and_b32 v125, 0xffff0000, v128
  v_lshlrev_b32 v132, 16, v130
  v_and_b32 v133, 0xffff0000, v130
  v_lshlrev_b32 v126, 16, v129
  v_and_b32 v127, 0xffff0000, v129
  v_lshlrev_b32 v134, 16, v131
  v_and_b32 v135, 0xffff0000, v131
  v_add_f32 v124, v124, v132
  v_add_f32 v125, v125, v133
  v_add_f32 v126, v126, v134
  v_add_f32 v127, v127, v135
  v_cvt_pk_bf16_f32 v116, v124, v125
  v_cvt_pk_bf16_f32 v117, v126, v127
  ds_write_b64 v46, v[116:117] offset:2560
  v_lshlrev_b32 v124, 16, v118
  v_and_b32 v125, 0xffff0000, v118
  v_lshlrev_b32 v126, 16, v119
  v_and_b32 v127, 0xffff0000, v119
  v_mul_f32 v124, v124, v33
  v_mul_f32 v125, v125, v33
  v_mul_f32 v126, v126, v33
  v_mul_f32 v127, v127, v33
  v_cvt_pk_bf16_f32 v128, v124, v125
  v_cvt_pk_bf16_f32 v129, v126, v127
  v_cvt_pk_bf16_f32 v130, v80, v81
  v_cvt_pk_bf16_f32 v131, v82, v83
  v_lshlrev_b32 v124, 16, v128
  v_and_b32 v125, 0xffff0000, v128
  v_lshlrev_b32 v132, 16, v130
  v_and_b32 v133, 0xffff0000, v130
  v_lshlrev_b32 v126, 16, v129
  v_and_b32 v127, 0xffff0000, v129
  v_lshlrev_b32 v134, 16, v131
  v_and_b32 v135, 0xffff0000, v131
  v_add_f32 v124, v124, v132
  v_add_f32 v125, v125, v133
  v_add_f32 v126, v126, v134
  v_add_f32 v127, v127, v135
  v_cvt_pk_bf16_f32 v118, v124, v125
  v_cvt_pk_bf16_f32 v119, v126, v127
  ds_write_b64 v46, v[118:119] offset:3072
  v_lshlrev_b32 v124, 16, v120
  v_and_b32 v125, 0xffff0000, v120
  v_lshlrev_b32 v126, 16, v121
  v_and_b32 v127, 0xffff0000, v121
  v_mul_f32 v124, v124, v33
  v_mul_f32 v125, v125, v33
  v_mul_f32 v126, v126, v33
  v_mul_f32 v127, v127, v33
  v_cvt_pk_bf16_f32 v128, v124, v125
  v_cvt_pk_bf16_f32 v129, v126, v127
  v_cvt_pk_bf16_f32 v130, v84, v85
  v_cvt_pk_bf16_f32 v131, v86, v87
  v_lshlrev_b32 v124, 16, v128
  v_and_b32 v125, 0xffff0000, v128
  v_lshlrev_b32 v132, 16, v130
  v_and_b32 v133, 0xffff0000, v130
  v_lshlrev_b32 v126, 16, v129
  v_and_b32 v127, 0xffff0000, v129
  v_lshlrev_b32 v134, 16, v131
  v_and_b32 v135, 0xffff0000, v131
  v_add_f32 v124, v124, v132
  v_add_f32 v125, v125, v133
  v_add_f32 v126, v126, v134
  v_add_f32 v127, v127, v135
  v_cvt_pk_bf16_f32 v120, v124, v125
  v_cvt_pk_bf16_f32 v121, v126, v127
  ds_write_b64 v46, v[120:121] offset:3584
  v_lshlrev_b32 v124, 16, v122
  v_and_b32 v125, 0xffff0000, v122
  v_lshlrev_b32 v126, 16, v123
  v_and_b32 v127, 0xffff0000, v123
  v_mul_f32 v124, v124, v33
  v_mul_f32 v125, v125, v33
  v_mul_f32 v126, v126, v33
  v_mul_f32 v127, v127, v33
  v_cvt_pk_bf16_f32 v128, v124, v125
  v_cvt_pk_bf16_f32 v129, v126, v127
  v_cvt_pk_bf16_f32 v130, v88, v89
  v_cvt_pk_bf16_f32 v131, v90, v91
  v_lshlrev_b32 v124, 16, v128
  v_and_b32 v125, 0xffff0000, v128
  v_lshlrev_b32 v132, 16, v130
  v_and_b32 v133, 0xffff0000, v130
  v_lshlrev_b32 v126, 16, v129
  v_and_b32 v127, 0xffff0000, v129
  v_lshlrev_b32 v134, 16, v131
  v_and_b32 v135, 0xffff0000, v131
  v_add_f32 v124, v124, v132
  v_add_f32 v125, v125, v133
  v_add_f32 v126, v126, v134
  v_add_f32 v127, v127, v135
  v_cvt_pk_bf16_f32 v122, v124, v125
  v_cvt_pk_bf16_f32 v123, v126, v127
  ds_write_b64 v46, v[122:123] offset:4096
  s_waitcnt lgkmcnt(0)
  s_barrier
  v_lshlrev_b32 v6, 3, v0
  v_mul_u32_u24 v5, 7168, v0
  v_add_u32 v36, 512, v6
  ds_read_b64 v[8:9], v36
  v_add_u32 v36, 25088, v6
  ds_read_b64 v[10:11], v36
  v_add_u32 v36, 49664, v6
  ds_read_b64 v[12:13], v36
  v_add_u32 v36, 74240, v6
  ds_read_b64 v[14:15], v36
  s_waitcnt lgkmcnt(0)
  s_add_u32 s22, s21, 0
  s_add_u32 s23, s22, 3584
  v_perm_b32 v16, v10, v8, s24
  v_perm_b32 v17, v14, v12, s24
  buffer_store_dwordx2 v[16:17], v5, s[88:91], s22 offen offset:0
  v_perm_b32 v18, v10, v8, s25
  v_perm_b32 v19, v14, v12, s25
  buffer_store_dwordx2 v[18:19], v5, s[88:91], s22 offen offset:1792
  v_perm_b32 v20, v11, v9, s24
  v_perm_b32 v21, v15, v13, s24
  buffer_store_dwordx2 v[20:21], v5, s[88:91], s23 offen offset:0
  v_perm_b32 v22, v11, v9, s25
  v_perm_b32 v23, v15, v13, s25
  buffer_store_dwordx2 v[22:23], v5, s[88:91], s23 offen offset:1792
  v_add_u32 v36, 2560, v6
  ds_read_b64 v[8:9], v36
  v_add_u32 v36, 27136, v6
  ds_read_b64 v[10:11], v36
  v_add_u32 v36, 51712, v6
  ds_read_b64 v[12:13], v36
  v_add_u32 v36, 76288, v6
  ds_read_b64 v[14:15], v36
  s_waitcnt lgkmcnt(0)
  s_add_u32 s22, s21, 1835008
  s_add_u32 s23, s22, 3584
  v_perm_b32 v24, v10, v8, s24
  v_perm_b32 v25, v14, v12, s24
  buffer_store_dwordx2 v[24:25], v5, s[88:91], s22 offen offset:0
  v_perm_b32 v26, v10, v8, s25
  v_perm_b32 v27, v14, v12, s25
  buffer_store_dwordx2 v[26:27], v5, s[88:91], s22 offen offset:1792
  v_perm_b32 v28, v11, v9, s24
  v_perm_b32 v29, v15, v13, s24
  buffer_store_dwordx2 v[28:29], v5, s[88:91], s23 offen offset:0
  v_perm_b32 v30, v11, v9, s25
  v_perm_b32 v31, v15, v13, s25
  buffer_store_dwordx2 v[30:31], v5, s[88:91], s23 offen offset:1792
  s_branch wk_loop
wk_tok:
  s_sub_u32 s3, s3, 752
  s_cmp_ge_u32 s3, 512
  s_cbranch_scc1 wk_done
  s_lshr_b32 s17, s3, 3
  s_and_b32 s18, s3, 3
  s_bitcmp1_b32 s3, 2
  s_cbranch_scc1 wk_toko
  s_lshl_b32 s20, s18, 2
  s_add_u32 s20, s20, s16
  s_lshl_b32 s21, s17, 4
  s_add_u32 s21, s21, s20
  s_mul_i32 s21, s21, 28672
  s_add_u32 s21, s21, 12845056
  s_mul_i32 s23, s17, 28672
  s_add_u32 s23, s23, 73859072
  s_mul_i32 s24, s17, 7168
  s_add_u32 s24, s24, 88002560
  s_lshr_b32 s25, s17, 3
  s_lshl_b32 s25, s25, 4
  s_add_u32 s25, s25, s20
  s_lshl_b32 s25, s25, 7
  s_add_u32 s25, s25, 88477696
  v_mov_b32 v60, 0
  s_mov_b32 s30, 0
wp_wf:
  buffer_load_dword v61, v60, s[8:11], s25 offen sc1
  s_waitcnt vmcnt(0)
  v_cmp_ne_u32 vcc, 56, v61
  s_cbranch_vccz wp_wf_ok
  s_sleep 4
  s_cmp_ge_u32 s17, 50
  s_cbranch_scc1 wp_wf_bo
  s_sleep 127
wp_wf_bo:
  s_add_u32 s30, s30, 1
  s_cmp_lt_u32 s30, 2000000
  s_cbranch_scc1 wp_wf
  s_branch wp_abort
wp_wf_ok:
  s_lshl_b32 s25, s17, 1
  s_mul_i32 s25, s25, 20480
  s_add_u32 s25, s25, 85381120
  s_lshl_b32 s26, s20, 10
  s_add_u32 s26, s26, s25
  s_lshl_b32 s27, s18, 10
  s_add_u32 s27, s27, s25
  s_lshr_b32 s28, s16, 1
  s_lshl_b32 s28, s28, 3
  s_add_u32 s27, s27, s28
  s_add_u32 s27, s27, 16384
  s_and_b32 s28, s16, 1
  s_cmp_eq_u32 s28, 0
  s_cselect_b32 s50, -1, 0
  s_cselect_b32 s51, 0, -1
  v_mov_b32 v44, -1
  v_mov_b32 v45, -1
  v_mov_b32 v46, -1
  v_mov_b32 v47, -1
  s_add_u32 s28, s26, 0
  s_add_u32 s29, s27, 0
  buffer_store_dwordx4 v[44:47], v2, s[8:11], s28 offen sc1
  s_mov_b64 exec, s[50:51]
  buffer_store_dwordx2 v[44:45], v2, s[8:11], s29 offen sc1
  s_mov_b64 exec, -1
  s_add_u32 s28, s26, 20480
  s_add_u32 s29, s27, 20480
  buffer_store_dwordx4 v[44:47], v2, s[8:11], s28 offen sc1
  s_mov_b64 exec, s[50:51]
  buffer_store_dwordx2 v[44:45], v2, s[8:11], s29 offen sc1
  s_mov_b64 exec, -1
  s_add_u32 s22, s21, 0
  buffer_load_dwordx4 a[0:3], v2, s[8:11], s22 offen offset:0 sc1
  buffer_load_dwordx4 a[4:7], v2, s[8:11], s22 offen offset:1024 sc1
  buffer_load_dwordx4 a[8:11], v2, s[8:11], s22 offen offset:2048 sc1
  buffer_load_dwordx4 a[12:15], v2, s[8:11], s22 offen offset:3072 sc1
  s_add_u32 s22, s21, 4096
  buffer_load_dwordx4 a[16:19], v2, s[8:11], s22 offen offset:0 sc1
  buffer_load_dwordx4 a[20:23], v2, s[8:11], s22 offen offset:1024 sc1
  buffer_load_dwordx4 a[24:27], v2, s[8:11], s22 offen offset:2048 sc1
  buffer_load_dwordx4 a[28:31], v2, s[8:11], s22 offen offset:3072 sc1
  s_add_u32 s22, s21, 8192
  buffer_load_dwordx4 a[32:35], v2, s[8:11], s22 offen offset:0 sc1
  buffer_load_dwordx4 a[36:39], v2, s[8:11], s22 offen offset:1024 sc1
  buffer_load_dwordx4 a[40:43], v2, s[8:11], s22 offen offset:2048 sc1
  buffer_load_dwordx4 a[44:47], v2, s[8:11], s22 offen offset:3072 sc1
  s_add_u32 s22, s21, 12288
  buffer_load_dwordx4 a[48:51], v2, s[8:11], s22 offen offset:0 sc1
  buffer_load_dwordx4 a[52:55], v2, s[8:11], s22 offen offset:1024 sc1
  buffer_load_dwordx4 a[56:59], v2, s[8:11], s22 offen offset:2048 sc1
  buffer_load_dwordx4 a[60:63], v2, s[8:11], s22 offen offset:3072 sc1
  s_add_u32 s22, s21, 16384
  buffer_load_dwordx4 a[64:67], v2, s[8:11], s22 offen offset:0 sc1
  buffer_load_dwordx4 a[68:71], v2, s[8:11], s22 offen offset:1024 sc1
  buffer_load_dwordx4 a[72:75], v2, s[8:11], s22 offen offset:2048 sc1
  buffer_load_dwordx4 a[76:79], v2, s[8:11], s22 offen offset:3072 sc1
  s_add_u32 s22, s21, 20480
  buffer_load_dwordx4 a[80:83], v2, s[8:11], s22 offen offset:0 sc1
  buffer_load_dwordx4 a[84:87], v2, s[8:11], s22 offen offset:1024 sc1
  buffer_load_dwordx4 a[88:91], v2, s[8:11], s22 offen offset:2048 sc1
  buffer_load_dwordx4 a[92:95], v2, s[8:11], s22 offen offset:3072 sc1
  s_add_u32 s22, s21, 24576
  buffer_load_dwordx4 a[96:99], v2, s[8:11], s22 offen offset:0 sc1
  buffer_load_dwordx4 a[100:103], v2, s[8:11], s22 offen offset:1024 sc1
  buffer_load_dwordx4 a[104:107], v2, s[8:11], s22 offen offset:2048 sc1
  buffer_load_dwordx4 a[108:111], v2, s[8:11], s22 offen offset:3072 sc1
  s_add_u32 s22, s23, 0
  buffer_load_dwordx4 a[112:115], v2, s[8:11], s22 offen offset:0 sc1
  buffer_load_dwordx4 a[116:119], v2, s[8:11], s22 offen offset:1024 sc1
  buffer_load_dwordx4 a[120:123], v2, s[8:11], s22 offen offset:2048 sc1
  buffer_load_dwordx4 a[124:127], v2, s[8:11], s22 offen offset:3072 sc1
  s_add_u32 s22, s23, 4096
  buffer_load_dwordx4 a[128:131], v2, s[8:11], s22 offen offset:0 sc1
  buffer_load_dwordx4 a[132:135], v2, s[8:11], s22 offen offset:1024 sc1
  buffer_load_dwordx4 a[136:139], v2, s[8:11], s22 offen offset:2048 sc1
  buffer_load_dwordx4 a[140:143], v2, s[8:11], s22 offen offset:3072 sc1
  s_add_u32 s22, s23, 8192
  buffer_load_dwordx4 a[144:147], v2, s[8:11], s22 offen offset:0 sc1
  buffer_load_dwordx4 a[148:151], v2, s[8:11], s22 offen offset:1024 sc1
  buffer_load_dwordx4 a[152:155], v2, s[8:11], s22 offen offset:2048 sc1
  buffer_load_dwordx4 a[156:159], v2, s[8:11], s22 offen offset:3072 sc1
  s_add_u32 s22, s23, 12288
  buffer_load_dwordx4 a[160:163], v2, s[8:11], s22 offen offset:0 sc1
  buffer_load_dwordx4 a[164:167], v2, s[8:11], s22 offen offset:1024 sc1
  buffer_load_dwordx4 a[168:171], v2, s[8:11], s22 offen offset:2048 sc1
  buffer_load_dwordx4 a[172:175], v2, s[8:11], s22 offen offset:3072 sc1
  s_add_u32 s22, s23, 16384
  buffer_load_dwordx4 a[176:179], v2, s[8:11], s22 offen offset:0 sc1
  buffer_load_dwordx4 a[180:183], v2, s[8:11], s22 offen offset:1024 sc1
  buffer_load_dwordx4 a[184:187], v2, s[8:11], s22 offen offset:2048 sc1
  buffer_load_dwordx4 a[188:191], v2, s[8:11], s22 offen offset:3072 sc1
  s_add_u32 s22, s23, 20480
  buffer_load_dwordx4 a[192:195], v2, s[8:11], s22 offen offset:0 sc1
  buffer_load_dwordx4 a[196:199], v2, s[8:11], s22 offen offset:1024 sc1
  buffer_load_dwordx4 a[200:203], v2, s[8:11], s22 offen offset:2048 sc1
  buffer_load_dwordx4 a[204:207], v2, s[8:11], s22 offen offset:3072 sc1
  s_add_u32 s22, s23, 24576
  buffer_load_dwordx4 a[208:211], v2, s[8:11], s22 offen offset:0 sc1
  buffer_load_dwordx4 a[212:215], v2, s[8:11], s22 offen offset:1024 sc1
  buffer_load_dwordx4 a[216:219], v2, s[8:11], s22 offen offset:2048 sc1
  buffer_load_dwordx4 a[220:223], v2, s[8:11], s22 offen offset:3072 sc1
  v_lshl_add_u32 v5, v3, 2, 0
  v_cmp_le_u32 s[40:41], v5, v4
  v_lshl_add_u32 v5, v3, 2, 1
  v_cmp_le_u32 s[42:43], v5, v4
  v_lshl_add_u32 v5, v3, 2, 2
  v_cmp_le_u32 s[44:45], v5, v4
  v_lshl_add_u32 v5, v3, 2, 3
  v_cmp_le_u32 s[46:47], v5, v4
  v_cmp_gt_u32 s[48:49], 2, v3
  v_mov_b32 v6, 0xff800000
  s_waitcnt vmcnt(0)
  s_lshl_b32 s25, s17, 7
  s_add_u32 s25, s25, 88494080
  v_mov_b32 v5, 1
  v_mov_b32 v7, 0
  s_waitcnt vmcnt(0)
  s_mov_b64 exec, 1
  buffer_atomic_add v5, v7, s[8:11], s25 offen
  s_mov_b64 exec, -1
  v_mfma_f32_16x16x32_bf16 v[8:11], a[112:115], a[0:3], 0
  v_mfma_f32_16x16x32_bf16 v[12:15], a[112:115], a[56:59], 0
  v_mfma_f32_16x16x32_bf16 v[16:19], a[168:171], a[56:59], 0
  v_mfma_f32_16x16x32_bf16 v[8:11], a[116:119], a[4:7], v[8:11]
  v_mfma_f32_16x16x32_bf16 v[12:15], a[116:119], a[60:63], v[12:15]
  v_mfma_f32_16x16x32_bf16 v[16:19], a[172:175], a[60:63], v[16:19]
  v_mfma_f32_16x16x32_bf16 v[8:11], a[120:123], a[8:11], v[8:11]
  v_mfma_f32_16x16x32_bf16 v[12:15], a[120:123], a[64:67], v[12:15]
  v_mfma_f32_16x16x32_bf16 v[16:19], a[176:179], a[64:67], v[16:19]
  v_mfma_f32_16x16x32_bf16 v[8:11], a[124:127], a[12:15], v[8:11]
  v_mfma_f32_16x16x32_bf16 v[12:15], a[124:127], a[68:71], v[12:15]
  v_mfma_f32_16x16x32_bf16 v[16:19], a[180:183], a[68:71], v[16:19]
  v_mfma_f32_16x16x32_bf16 v[8:11], a[128:131], a[16:19], v[8:11]
  v_mfma_f32_16x16x32_bf16 v[12:15], a[128:131], a[72:75], v[12:15]
  v_mfma_f32_16x16x32_bf16 v[16:19], a[184:187], a[72:75], v[16:19]
  v_mfma_f32_16x16x32_bf16 v[8:11], a[132:135], a[20:23], v[8:11]
  v_mfma_f32_16x16x32_bf16 v[12:15], a[132:135], a[76:79], v[12:15]
  v_mfma_f32_16x16x32_bf16 v[16:19], a[188:191], a[76:79], v[16:19]
  v_mfma_f32_16x16x32_bf16 v[8:11], a[136:139], a[24:27], v[8:11]
  v_mfma_f32_16x16x32_bf16 v[12:15], a[136:139], a[80:83], v[12:15]
  v_mfma_f32_16x16x32_bf16 v[16:19], a[192:195], a[80:83], v[16:19]
  v_mfma_f32_16x16x32_bf16 v[8:11], a[140:143], a[28:31], v[8:11]
  v_mfma_f32_16x16x32_bf16 v[12:15], a[140:143], a[84:87], v[12:15]
  v_mfma_f32_16x16x32_bf16 v[16:19], a[196:199], a[84:87], v[16:19]
  v_mfma_f32_16x16x32_bf16 v[8:11], a[144:147], a[32:35], v[8:11]
  v_mfma_f32_16x16x32_bf16 v[12:15], a[144:147], a[88:91], v[12:15]
  v_mfma_f32_16x16x32_bf16 v[16:19], a[200:203], a[88:91], v[16:19]
  v_mfma_f32_16x16x32_bf16 v[8:11], a[148:151], a[36:39], v[8:11]
  v_mfma_f32_16x16x32_bf16 v[12:15], a[148:151], a[92:95], v[12:15]
  v_mfma_f32_16x16x32_bf16 v[16:19], a[204:207], a[92:95], v[16:19]
  v_mfma_f32_16x16x32_bf16 v[8:11], a[152:155], a[40:43], v[8:11]
  v_mfma_f32_16x16x32_bf16 v[12:15], a[152:155], a[96:99], v[12:15]
  v_mfma_f32_16x16x32_bf16 v[16:19], a[208:211], a[96:99], v[16:19]
  v_mfma_f32_16x16x32_bf16 v[8:11], a[156:159], a[44:47], v[8:11]
  v_mfma_f32_16x16x32_bf16 v[12:15], a[156:159], a[100:103], v[12:15]
  v_mfma_f32_16x16x32_bf16 v[16:19], a[212:215], a[100:103], v[16:19]
  v_mfma_f32_16x16x32_bf16 v[8:11], a[160:163], a[48:51], v[8:11]
  v_mfma_f32_16x16x32_bf16 v[12:15], a[160:163], a[104:107], v[12:15]
  v_mfma_f32_16x16x32_bf16 v[16:19], a[216:219], a[104:107], v[16:19]
  v_mfma_f32_16x16x32_bf16 v[8:11], a[164:167], a[52:55], v[8:11]
  v_mfma_f32_16x16x32_bf16 v[12:15], a[164:167], a[108:111], v[12:15]
  v_mfma_f32_16x16x32_bf16 v[16:19], a[220:223], a[108:111], v[16:19]
  s_mul_i32 s22, s20, 448
  v_mov_b32 v62, s22
  s_mov_b32 s30, 0
wp_pm:
  s_cmp_ge_u32 s17, 64
  s_cbranch_scc1 wp_pf
  buffer_load_dword v61, v62, s[8:11], s24 offen sc1
  s_waitcnt vmcnt(0)
  v_cmp_eq_u32 vcc, -1, v61
  s_cbranch_vccnz wp_pr
wp_pf:
  s_add_u32 s22, s24, 4096
  buffer_load_dwordx4 v[64:67], v2, s[8:11], s24 offen offset:0 sc1
  buffer_load_dwordx4 v[68:71], v2, s[8:11], s24 offen offset:1024 sc1
  buffer_load_dwordx4 v[72:75], v2, s[8:11], s24 offen offset:2048 sc1
  buffer_load_dwordx4 v[76:79], v2, s[8:11], s24 offen offset:3072 sc1
  buffer_load_dwordx4 v[80:83], v2, s[8:11], s22 offen offset:0 sc1
  buffer_load_dwordx4 v[84:87], v2, s[8:11], s22 offen offset:1024 sc1
  buffer_load_dwordx4 v[88:91], v2, s[8:11], s22 offen offset:2048 sc1
  s_waitcnt vmcnt(0)
  v_max_u32 v61, v64, v65
  v_max3_u32 v61, v61, v66, v67
  v_max3_u32 v61, v61, v68, v69
  v_max3_u32 v61, v61, v70, v71
  v_max3_u32 v61, v61, v72, v73
  v_max3_u32 v61, v61, v74, v75
  v_max3_u32 v61, v61, v76, v77
  v_max3_u32 v61, v61, v78, v79
  v_max3_u32 v61, v61, v80, v81
  v_max3_u32 v61, v61, v82, v83
  v_max3_u32 v61, v61, v84, v85
  v_max3_u32 v61, v61, v86, v87
  v_max3_u32 v61, v61, v88, v89
  v_max3_u32 v61, v61, v90, v91
  v_cmp_eq_u32 vcc, -1, v61
  s_cbranch_vccz wp_pk
wp_pr:
  s_sleep 4
  s_cmp_ge_u32 s17, 50
  s_cbranch_scc1 wp_pm_bo
  s_sleep 127
wp_pm_bo:
  s_add_u32 s30, s30, 1
  s_cmp_lt_u32 s30, 2000000
  s_cbranch_scc1 wp_pm
  s_branch wp_abort
wp_pk:
  buffer_load_dword v250, v251, s[8:11], 0 offen sc1
  v_mfma_f32_16x16x32_bf16 v[20:23], v[64:67], a[0:3], 0
  v_mfma_f32_16x16x32_bf16 v[24:27], v[64:67], a[4:7], 0
  v_mfma_f32_16x16x32_bf16 v[28:31], v[64:67], a[56:59], 0
  v_mfma_f32_16x16x32_bf16 v[32:35], v[64:67], a[60:63], 0
  v_mfma_f32_16x16x32_bf16 v[20:23], v[68:71], a[8:11], v[20:23]
  v_mfma_f32_16x16x32_bf16 v[24:27], v[68:71], a[12:15], v[24:27]
  v_mfma_f32_16x16x32_bf16 v[28:31], v[68:71], a[64:67], v[28:31]
  v_mfma_f32_16x16x32_bf16 v[32:35], v[68:71], a[68:71], v[32:35]
  v_mfma_f32_16x16x32_bf16 v[20:23], v[72:75], a[16:19], v[20:23]
  v_mfma_f32_16x16x32_bf16 v[24:27], v[72:75], a[20:23], v[24:27]
  v_mfma_f32_16x16x32_bf16 v[28:31], v[72:75], a[72:75], v[28:31]
  v_mfma_f32_16x16x32_bf16 v[32:35], v[72:75], a[76:79], v[32:35]
  v_mfma_f32_16x16x32_bf16 v[20:23], v[76:79], a[24:27], v[20:23]
  v_mfma_f32_16x16x32_bf16 v[24:27], v[76:79], a[28:31], v[24:27]
  v_mfma_f32_16x16x32_bf16 v[28:31], v[76:79], a[80:83], v[28:31]
  v_mfma_f32_16x16x32_bf16 v[32:35], v[76:79], a[84:87], v[32:35]
  v_mfma_f32_16x16x32_bf16 v[20:23], v[80:83], a[32:35], v[20:23]
  v_mfma_f32_16x16x32_bf16 v[24:27], v[80:83], a[36:39], v[24:27]
  v_mfma_f32_16x16x32_bf16 v[28:31], v[80:83], a[88:91], v[28:31]
  v_mfma_f32_16x16x32_bf16 v[32:35], v[80:83], a[92:95], v[32:35]
  v_mfma_f32_16x16x32_bf16 v[20:23], v[84:87], a[40:43], v[20:23]
  v_mfma_f32_16x16x32_bf16 v[24:27], v[84:87], a[44:47], v[24:27]
  v_mfma_f32_16x16x32_bf16 v[28:31], v[84:87], a[96:99], v[28:31]
  v_mfma_f32_16x16x32_bf16 v[32:35], v[84:87], a[100:103], v[32:35]
  v_mfma_f32_16x16x32_bf16 v[20:23], v[88:91], a[48:51], v[20:23]
  v_mfma_f32_16x16x32_bf16 v[24:27], v[88:91], a[52:55], v[24:27]
  v_mfma_f32_16x16x32_bf16 v[28:31], v[88:91], a[104:107], v[28:31]
  v_mfma_f32_16x16x32_bf16 v[32:35], v[88:91], a[108:111], v[32:35]
  v_cndmask_b32 v8, v6, v8, s[40:41]
  v_cndmask_b32 v9, v6, v9, s[42:43]
  v_cndmask_b32 v10, v6, v10, s[44:45]
  v_cndmask_b32 v11, v6, v11, s[46:47]
  v_cndmask_b32 v20, v24, v20, s[48:49]
  v_cndmask_b32 v21, v25, v21, s[48:49]
  v_cndmask_b32 v22, v26, v22, s[48:49]
  v_cndmask_b32 v23, v27, v23, s[48:49]
  v_mov_b32 v24, v20
  v_mov_b32 v25, v21
  v_mov_b32 v26, v22
  v_mov_b32 v27, v23
  v_permlane32_swap_b32 v20, v24
  v_permlane32_swap_b32 v21, v25
  v_permlane32_swap_b32 v22, v26
  v_permlane32_swap_b32 v23, v27
  v_add_f32 v20, v20, v24
  v_add_f32 v21, v21, v25
  v_add_f32 v22, v22, v26
  v_add_f32 v23, v23, v27
  v_max3_f32 v40, v8, v9, v10
  v_max3_f32 v40, v40, v11, v20
  v_max3_f32 v40, v40, v21, v22
  v_max_f32 v40, v40, v23
  v_mov_b32 v41, v40
  s_nop 1
  v_permlane16_swap_b32 v40, v41
  v_max_f32 v40, v40, v41
  v_mov_b32 v41, v40
  s_nop 1
  v_permlane32_swap_b32 v40, v41
  v_max_f32 v40, v40, v41
  v_sub_f32 v8, v8, v40
  v_sub_f32 v9, v9, v40
  v_sub_f32 v10, v10, v40
  v_sub_f32 v11, v11, v40
  v_sub_f32 v20, v20, v40
  v_sub_f32 v21, v21, v40
  v_sub_f32 v22, v22, v40
  v_sub_f32 v23, v23, v40
  v_exp_f32 v8, v8
  v_exp_f32 v9, v9
  v_exp_f32 v10, v10
  v_exp_f32 v11, v11
  v_exp_f32 v20, v20
  v_exp_f32 v21, v21
  v_exp_f32 v22, v22
  v_exp_f32 v23, v23
  v_add_f32 v42, v20, v21
  v_add_f32 v43, v22, v23
  v_add_f32 v42, v42, v43
  v_mul_f32 v42, 0.5, v42
  v_add_f32 v42, v42, v8
  v_add_f32 v42, v42, v9
  v_add_f32 v42, v42, v10
  v_add_f32 v42, v42, v11
  v_mov_b32 v41, v42
  s_nop 1
  v_permlane16_swap_b32 v42, v41
  v_add_f32 v42, v42, v41
  v_mov_b32 v41, v42
  s_nop 1
  v_permlane32_swap_b32 v42, v41
  v_add_f32 v42, v42, v41
  v_rcp_f32 v42, v42
  s_nop 0
  v_mul_f32 v8, v8, v42
  v_mul_f32 v9, v9, v42
  v_mul_f32 v10, v10, v42
  v_mul_f32 v11, v11, v42
  v_mul_f32 v20, v20, v42
  v_mul_f32 v21, v21, v42
  v_mul_f32 v22, v22, v42
  v_mul_f32 v23, v23, v42
  v_cvt_pk_bf16_f32 v44, v8, 0
  v_cvt_pk_bf16_f32 v45, v9, 0
  v_cvt_pk_bf16_f32 v46, v10, 0
  v_cvt_pk_bf16_f32 v47, v11, 0
  v_cvt_pk_bf16_f32 v48, v20, v21
  v_cvt_pk_bf16_f32 v49, v22, v23
  v_min_u32 v44, -2, v44
  v_min_u32 v45, -2, v45
  v_min_u32 v46, -2, v46
  v_min_u32 v47, -2, v47
  v_min_u32 v48, -2, v48
  v_min_u32 v49, -2, v49
  buffer_store_dwordx4 v[44:47], v2, s[8:11], s26 offen sc1
  s_mov_b64 exec, s[50:51]
  buffer_store_dwordx2 v[48:49], v2, s[8:11], s27 offen sc1
  s_mov_b64 exec, -1
  s_add_u32 s26, s26, 20480
  s_add_u32 s27, s27, 20480
  v_cndmask_b32 v16, v6, v16, s[40:41]
  v_cndmask_b32 v17, v6, v17, s[42:43]
  v_cndmask_b32 v18, v6, v18, s[44:45]
  v_cndmask_b32 v19, v6, v19, s[46:47]
  v_cndmask_b32 v28, v32, v28, s[48:49]
  v_cndmask_b32 v29, v33, v29, s[48:49]
  v_cndmask_b32 v30, v34, v30, s[48:49]
  v_cndmask_b32 v31, v35, v31, s[48:49]
  v_mov_b32 v32, v28
  v_mov_b32 v33, v29
  v_mov_b32 v34, v30
  v_mov_b32 v35, v31
  v_permlane32_swap_b32 v28, v32
  v_permlane32_swap_b32 v29, v33
  v_permlane32_swap_b32 v30, v34
  v_permlane32_swap_b32 v31, v35
  v_add_f32 v28, v28, v32
  v_add_f32 v29, v29, v33
  v_add_f32 v30, v30, v34
  v_add_f32 v31, v31, v35
  v_max3_f32 v40, v12, v13, v14
  v_max3_f32 v40, v40, v15, v16
  v_max3_f32 v40, v40, v17, v18
  v_max3_f32 v40, v40, v19, v28
  v_max3_f32 v40, v40, v29, v30
  v_max_f32 v40, v40, v31
  v_mov_b32 v41, v40
  s_nop 1
  v_permlane16_swap_b32 v40, v41
  v_max_f32 v40, v40, v41
  v_mov_b32 v41, v40
  s_nop 1
  v_permlane32_swap_b32 v40, v41
  v_max_f32 v40, v40, v41
  v_sub_f32 v12, v12, v40
  v_sub_f32 v13, v13, v40
  v_sub_f32 v14, v14, v40
  v_sub_f32 v15, v15, v40
  v_sub_f32 v16, v16, v40
  v_sub_f32 v17, v17, v40
  v_sub_f32 v18, v18, v40
  v_sub_f32 v19, v19, v40
  v_sub_f32 v28, v28, v40
  v_sub_f32 v29, v29, v40
  v_sub_f32 v30, v30, v40
  v_sub_f32 v31, v31, v40
  v_exp_f32 v12, v12
  v_exp_f32 v13, v13
  v_exp_f32 v14, v14
  v_exp_f32 v15, v15
  v_exp_f32 v16, v16
  v_exp_f32 v17, v17
  v_exp_f32 v18, v18
  v_exp_f32 v19, v19
  v_exp_f32 v28, v28
  v_exp_f32 v29, v29
  v_exp_f32 v30, v30
  v_exp_f32 v31, v31
  v_add_f32 v42, v28, v29
  v_add_f32 v43, v30, v31
  v_add_f32 v42, v42, v43
  v_mul_f32 v42, 0.5, v42
  v_add_f32 v42, v42, v12
  v_add_f32 v42, v42, v13
  v_add_f32 v42, v42, v14
  v_add_f32 v42, v42, v15
  v_add_f32 v42, v42, v16
  v_add_f32 v42, v42, v17
  v_add_f32 v42, v42, v18
  v_add_f32 v42, v42, v19
  v_mov_b32 v41, v42
  s_nop 1
  v_permlane16_swap_b32 v42, v41
  v_add_f32 v42, v42, v41
  v_mov_b32 v41, v42
  s_nop 1
  v_permlane32_swap_b32 v42, v41
  v_add_f32 v42, v42, v41
  v_rcp_f32 v42, v42
  s_nop 0
  v_mul_f32 v12, v12, v42
  v_mul_f32 v13, v13, v42
  v_mul_f32 v14, v14, v42
  v_mul_f32 v15, v15, v42
  v_mul_f32 v16, v16, v42
  v_mul_f32 v17, v17, v42
  v_mul_f32 v18, v18, v42
  v_mul_f32 v19, v19, v42
  v_mul_f32 v28, v28, v42
  v_mul_f32 v29, v29, v42
  v_mul_f32 v30, v30, v42
  v_mul_f32 v31, v31, v42
  v_cvt_pk_bf16_f32 v52, v12, v16
  v_cvt_pk_bf16_f32 v53, v13, v17
  v_cvt_pk_bf16_f32 v54, v14, v18
  v_cvt_pk_bf16_f32 v55, v15, v19
  v_cvt_pk_bf16_f32 v56, v28, v29
  v_cvt_pk_bf16_f32 v57, v30, v31
  v_min_u32 v52, -2, v52
  v_min_u32 v53, -2, v53
  v_min_u32 v54, -2, v54
  v_min_u32 v55, -2, v55
  v_min_u32 v56, -2, v56
  v_min_u32 v57, -2, v57
  buffer_store_dwordx4 v[52:55], v2, s[8:11], s26 offen sc1
  s_mov_b64 exec, s[50:51]
  buffer_store_dwordx2 v[56:57], v2, s[8:11], s27 offen sc1
  s_mov_b64 exec, -1
  s_branch wk_loop
wk_toko:
  s_load_dwordx2 s[36:37], s[0:1], 112
  s_waitcnt lgkmcnt(0)
  s_mov_b32 s92, s36
  s_and_b32 s93, s37, 0xffff
  s_mov_b32 s94, 3670016
  s_mov_b32 s95, 0x20000
  s_lshl_b32 s20, s18, 2
  s_add_u32 s20, s20, s16
  s_mul_i32 s24, s20, 65
  s_add_u32 s24, s24, s17
  s_lshl_b32 s24, s24, 13
  s_add_u32 s24, s24, 76869632
  s_mul_i32 s21, s20, 28672
  s_mul_i32 s22, s17, 458752
  s_add_u32 s21, s21, s22
  s_add_u32 s21, s21, 42205184
  s_lshl_b32 s25, s17, 1
  s_mul_i32 s25, s25, 20480
  s_add_u32 s25, s25, 85381120
  v_mov_b32 v5, v2
  v_min_u32 v6, 11, v4
  v_mad_u32_u24 v6, v3, 12, v6
  v_lshlrev_b32 v6, 4, v6
  v_add_u32 v6, 1024, v6
  v_lshrrev_b32 v8, 1, v3
  v_lshl_add_u32 v8, v8, 4, v4
  v_lshlrev_b32 v8, 4, v8
  v_and_b32 v9, 1, v3
  v_lshl_add_u32 v7, v9, 3, v8
  s_lshr_b32 s26, s17, 3
  s_lshl_b32 s26, s26, 4
  s_add_u32 s26, s26, s20
  s_lshl_b32 s26, s26, 7
  s_add_u32 s26, s26, 88461312
  v_mov_b32 v60, 0
  s_mov_b32 s30, 0
wo_wv:
  buffer_load_dword v61, v60, s[8:11], s26 offen sc1
  s_waitcnt vmcnt(0)
  v_cmp_ne_u32 vcc, 56, v61
  s_cbranch_vccz wo_wv_ok
  s_sleep 4
  s_cmp_ge_u32 s17, 50
  s_cbranch_scc1 wo_wv_bo
  s_sleep 127
wo_wv_bo:
  s_add_u32 s30, s30, 1
  s_cmp_lt_u32 s30, 2000000
  s_cbranch_scc1 wo_wv
  s_branch wo_abort
wo_wv_ok:
  s_add_u32 s22, s21, 0
  buffer_load_dwordx4 a[0:3], v5, s[8:11], s22 offen offset:0 sc1
  buffer_load_dwordx4 a[4:7], v6, s[8:11], s22 offen offset:0 sc1
  buffer_load_dwordx4 a[8:11], v5, s[8:11], s22 offen offset:1792 sc1
  buffer_load_dwordx4 a[12:15], v6, s[8:11], s22 offen offset:1792 sc1
  s_add_u32 s22, s21, 3584
  buffer_load_dwordx4 a[16:19], v5, s[8:11], s22 offen offset:0 sc1
  buffer_load_dwordx4 a[20:23], v6, s[8:11], s22 offen offset:0 sc1
  buffer_load_dwordx4 a[24:27], v5, s[8:11], s22 offen offset:1792 sc1
  buffer_load_dwordx4 a[28:31], v6, s[8:11], s22 offen offset:1792 sc1
  s_add_u32 s22, s21, 7168
  buffer_load_dwordx4 a[32:35], v5, s[8:11], s22 offen offset:0 sc1
  buffer_load_dwordx4 a[36:39], v6, s[8:11], s22 offen offset:0 sc1
  buffer_load_dwordx4 a[40:43], v5, s[8:11], s22 offen offset:1792 sc1
  buffer_load_dwordx4 a[44:47], v6, s[8:11], s22 offen offset:1792 sc1
  s_add_u32 s22, s21, 10752
  buffer_load_dwordx4 a[48:51], v5, s[8:11], s22 offen offset:0 sc1
  buffer_load_dwordx4 a[52:55], v6, s[8:11], s22 offen offset:0 sc1
  buffer_load_dwordx4 a[56:59], v5, s[8:11], s22 offen offset:1792 sc1
  buffer_load_dwordx4 a[60:63], v6, s[8:11], s22 offen offset:1792 sc1
  s_add_u32 s22, s21, 14336
  buffer_load_dwordx4 a[64:67], v5, s[8:11], s22 offen offset:0 sc1
  buffer_load_dwordx4 a[68:71], v6, s[8:11], s22 offen offset:0 sc1
  buffer_load_dwordx4 a[72:75], v5, s[8:11], s22 offen offset:1792 sc1
  buffer_load_dwordx4 a[76:79], v6, s[8:11], s22 offen offset:1792 sc1
  s_add_u32 s22, s21, 17920
  buffer_load_dwordx4 a[80:83], v5, s[8:11], s22 offen offset:0 sc1
  buffer_load_dwordx4 a[84:87], v6, s[8:11], s22 offen offset:0 sc1
  buffer_load_dwordx4 a[88:91], v5, s[8:11], s22 offen offset:1792 sc1
  buffer_load_dwordx4 a[92:95], v6, s[8:11], s22 offen offset:1792 sc1
  s_add_u32 s22, s21, 21504
  buffer_load_dwordx4 a[96:99], v5, s[8:11], s22 offen offset:0 sc1
  buffer_load_dwordx4 a[100:103], v6, s[8:11], s22 offen offset:0 sc1
  buffer_load_dwordx4 a[104:107], v5, s[8:11], s22 offen offset:1792 sc1
  buffer_load_dwordx4 a[108:111], v6, s[8:11], s22 offen offset:1792 sc1
  s_add_u32 s22, s21, 25088
  buffer_load_dwordx4 a[112:115], v5, s[8:11], s22 offen offset:0 sc1
  buffer_load_dwordx4 a[116:119], v6, s[8:11], s22 offen offset:0 sc1
  buffer_load_dwordx4 a[120:123], v5, s[8:11], s22 offen offset:1792 sc1
  buffer_load_dwordx4 a[124:127], v6, s[8:11], s22 offen offset:1792 sc1
  s_lshl_b32 s26, s20, 6
  s_add_u32 s26, s26, s17
  s_lshl_b32 s26, s26, 4
  s_add_u32 s26, s26, 88502272
  v_lshlrev_b32 v60, 2, v3
  s_mov_b32 s30, 0
wo_wt:
  buffer_load_dword v61, v60, s[8:11], s26 offen sc1
  s_waitcnt vmcnt(0)
  v_cmp_ne_u32 vcc, 1, v61
  s_cbranch_vccz wo_wt_ok
  s_sleep 4
  s_cmp_ge_u32 s17, 50
  s_cbranch_scc1 wo_wt_bo
  s_sleep 127
wo_wt_bo:
  s_add_u32 s30, s30, 1
  s_cmp_lt_u32 s30, 2000000
  s_cbranch_scc1 wo_wt
  s_branch wo_abort
wo_wt_ok:
  s_sub_u32 s27, s17, 61
  s_max_i32 s27, s27, 0
  s_lshl_b32 s27, s27, 4
  s_sub_u32 s26, s26, s27
  v_lshlrev_b32 v60, 2, v3
  s_mov_b32 s30, 0
wo_wu:
  buffer_load_dword v61, v60, s[8:11], s26 offen sc1
  s_waitcnt vmcnt(0)
  v_cmp_ne_u32 vcc, 1, v61
  s_cbranch_vccz wo_wu_ok
  s_sleep 4
  s_cmp_ge_u32 s17, 50
  s_cbranch_scc1 wo_wu_bo
  s_sleep 127
wo_wu_bo:
  s_add_u32 s30, s30, 1
  s_cmp_lt_u32 s30, 2000000
  s_cbranch_scc1 wo_wu
  s_branch wo_abort
wo_wu_ok:
  s_lshl_b32 s26, s17, 7
  s_add_u32 s26, s26, 88494080
  v_mov_b32 v60, 0
  s_mov_b32 s30, 0
wo_wp:
  buffer_load_dword v61, v60, s[8:11], s26 offen sc1
  s_waitcnt vmcnt(0)
  v_cmp_ne_u32 vcc, 16, v61
  s_cbranch_vccz wo_wp_ok
  s_sleep 4
  s_cmp_ge_u32 s17, 50
  s_cbranch_scc1 wo_wp_bo
  s_sleep 127
wo_wp_bo:
  s_add_u32 s30, s30, 1
  s_cmp_lt_u32 s30, 2000000
  s_cbranch_scc1 wo_wp
  s_branch wo_abort
wo_wp_ok:
  s_lshl_b32 s28, s16, 12
  s_add_u32 s26, s25, s28
  s_add_u32 s27, s26, 20480
  s_lshl_b32 s28, s16, 10
  s_add_u32 s28, s28, s25
  s_add_u32 s28, s28, 16384
  s_add_u32 s29, s28, 20480
  s_add_u32 s23, s24, 4096
  s_mov_b32 s30, 0
wo_pl:
  buffer_load_dwordx4 v[64:67], v2, s[8:11], s26 offen offset:0 sc1
  buffer_load_dwordx4 v[68:71], v2, s[8:11], s26 offen offset:1024 sc1
  buffer_load_dwordx4 v[72:75], v2, s[8:11], s26 offen offset:2048 sc1
  buffer_load_dwordx4 v[76:79], v2, s[8:11], s26 offen offset:3072 sc1
  buffer_load_dwordx4 v[80:83], v2, s[8:11], s28 offen sc1
  buffer_load_dwordx4 v[84:87], v2, s[8:11], s27 offen offset:0 sc1
  buffer_load_dwordx4 v[88:91], v2, s[8:11], s27 offen offset:1024 sc1
  buffer_load_dwordx4 v[92:95], v2, s[8:11], s27 offen offset:2048 sc1
  buffer_load_dwordx4 v[96:99], v2, s[8:11], s27 offen offset:3072 sc1
  buffer_load_dwordx4 v[100:103], v2, s[8:11], s29 offen sc1
  buffer_load_dwordx2 v[28:29], v7, s[8:11], s24 offen offset:0 sc1
  buffer_load_dwordx2 v[30:31], v7, s[8:11], s24 offen offset:512 sc1
  buffer_load_dwordx2 v[32:33], v7, s[8:11], s24 offen offset:1024 sc1
  buffer_load_dwordx2 v[34:35], v7, s[8:11], s24 offen offset:1536 sc1
  buffer_load_dwordx2 v[36:37], v7, s[8:11], s24 offen offset:2048 sc1
  buffer_load_dwordx2 v[38:39], v7, s[8:11], s24 offen offset:2560 sc1
  buffer_load_dwordx2 v[40:41], v7, s[8:11], s24 offen offset:3072 sc1
  buffer_load_dwordx2 v[42:43], v7, s[8:11], s24 offen offset:3584 sc1
  buffer_load_dwordx2 v[44:45], v7, s[8:11], s23 offen offset:0 sc1
  buffer_load_dwordx2 v[46:47], v7, s[8:11], s23 offen offset:512 sc1
  buffer_load_dwordx2 v[48:49], v7, s[8:11], s23 offen offset:1024 sc1
  buffer_load_dwordx2 v[50:51], v7, s[8:11], s23 offen offset:1536 sc1
  buffer_load_dwordx2 v[52:53], v7, s[8:11], s23 offen offset:2048 sc1
  buffer_load_dwordx2 v[54:55], v7, s[8:11], s23 offen offset:2560 sc1
  buffer_load_dwordx2 v[56:57], v7, s[8:11], s23 offen offset:3072 sc1
  buffer_load_dwordx2 v[58:59], v7, s[8:11], s23 offen offset:3584 sc1
  s_waitcnt vmcnt(16)
  v_max_u32 v61, v64, v65
  v_max3_u32 v61, v61, v66, v67
  v_max3_u32 v61, v61, v68, v69
  v_max3_u32 v61, v61, v70, v71
  v_max3_u32 v61, v61, v72, v73
  v_max3_u32 v61, v61, v74, v75
  v_max3_u32 v61, v61, v76, v77
  v_max3_u32 v61, v61, v78, v79
  v_max3_u32 v61, v61, v80, v81
  v_max3_u32 v61, v61, v82, v83
  v_max3_u32 v61, v61, v84, v85
  v_max3_u32 v61, v61, v86, v87
  v_max3_u32 v61, v61, v88, v89
  v_max3_u32 v61, v61, v90, v91
  v_max3_u32 v61, v61, v92, v93
  v_max3_u32 v61, v61, v94, v95
  v_max3_u32 v61, v61, v96, v97
  v_max3_u32 v61, v61, v98, v99
  v_max3_u32 v61, v61, v100, v101
  v_max3_u32 v61, v61, v102, v103
  s_mul_i32 s22, s16, 10240
  v_add_u32 v62, s22, v2
  ds_write_b128 v62, v[64:67] offset:0
  ds_write_b128 v62, v[68:71] offset:1024
  ds_write_b128 v62, v[72:75] offset:2048
  ds_write_b128 v62, v[76:79] offset:3072
  ds_write_b128 v62, v[80:83] offset:4096
  ds_write_b128 v62, v[84:87] offset:5120
  ds_write_b128 v62, v[88:91] offset:6144
  ds_write_b128 v62, v[92:95] offset:7168
  ds_write_b128 v62, v[96:99] offset:8192
  ds_write_b128 v62, v[100:103] offset:9216
  s_waitcnt vmcnt(0)
  v_max3_u32 v61, v61, v28, v29
  v_max3_u32 v61, v61, v30, v31
  v_max3_u32 v61, v61, v32, v33
  v_max3_u32 v61, v61, v34, v35
  v_max3_u32 v61, v61, v36, v37
  v_max3_u32 v61, v61, v38, v39
  v_max3_u32 v61, v61, v40, v41
  v_max3_u32 v61, v61, v42, v43
  v_max3_u32 v61, v61, v44, v45
  v_max3_u32 v61, v61, v46, v47
  v_max3_u32 v61, v61, v48, v49
  v_max3_u32 v61, v61, v50, v51
  v_max3_u32 v61, v61, v52, v53
  v_max3_u32 v61, v61, v54, v55
  v_max3_u32 v61, v61, v56, v57
  v_max3_u32 v61, v61, v58, v59
  v_cmp_eq_u32 vcc, -1, v61
  s_cbranch_vccz wo_pk
  s_waitcnt lgkmcnt(0)
  s_sleep 1
  s_cmp_ge_u32 s17, 50
  s_cbranch_scc1 wo_pl_bo
  s_sleep 127
wo_pl_bo:
  s_add_u32 s30, s30, 1
  s_cmp_lt_u32 s30, 2000000
  s_cbranch_scc1 wo_pl
  s_branch wo_abort
wo_pk:
  buffer_load_dword v250, v251, s[8:11], 0 offen sc1
  s_waitcnt lgkmcnt(0)
  s_barrier
  ds_read_b128 v[64:67], v2 offset:0
  ds_read_b128 v[68:71], v2 offset:5120
  ds_read_b128 v[72:75], v2 offset:1024
  ds_read_b128 v[76:79], v2 offset:6144
  ds_read_b128 v[80:83], v2 offset:2048
  ds_read_b128 v[84:87], v2 offset:7168
  ds_read_b128 v[88:91], v2 offset:3072
  ds_read_b128 v[92:95], v2 offset:8192
  s_waitcnt lgkmcnt(7)
  v_mfma_f32_16x16x32_bf16 v[12:15], a[0:3], v[64:67], 0
  ds_read_b128 v[96:99], v2 offset:4096
  v_mfma_f32_16x16x32_bf16 v[20:23], a[4:7], v[64:67], 0
  s_waitcnt lgkmcnt(7)
  v_mfma_f32_16x16x32_bf16 v[16:19], a[0:3], v[68:71], 0
  ds_read_b128 v[100:103], v2 offset:9216
  v_mfma_f32_16x16x32_bf16 v[24:27], a[4:7], v[68:71], 0
  s_waitcnt lgkmcnt(7)
  v_mfma_f32_16x16x32_bf16 v[12:15], a[8:11], v[72:75], v[12:15]
  ds_read_b128 v[64:67], v2 offset:10240
  v_mfma_f32_16x16x32_bf16 v[20:23], a[12:15], v[72:75], v[20:23]
  s_waitcnt lgkmcnt(7)
  v_mfma_f32_16x16x32_bf16 v[16:19], a[8:11], v[76:79], v[16:19]
  ds_read_b128 v[68:71], v2 offset:15360
  v_mfma_f32_16x16x32_bf16 v[24:27], a[12:15], v[76:79], v[24:27]
  s_waitcnt lgkmcnt(7)
  v_mfma_f32_16x16x32_bf16 v[12:15], a[16:19], v[80:83], v[12:15]
  ds_read_b128 v[72:75], v2 offset:11264
  v_mfma_f32_16x16x32_bf16 v[20:23], a[20:23], v[80:83], v[20:23]
  s_waitcnt lgkmcnt(7)
  v_mfma_f32_16x16x32_bf16 v[16:19], a[16:19], v[84:87], v[16:19]
  ds_read_b128 v[76:79], v2 offset:16384
  v_mfma_f32_16x16x32_bf16 v[24:27], a[20:23], v[84:87], v[24:27]
  s_waitcnt lgkmcnt(7)
  v_mfma_f32_16x16x32_bf16 v[12:15], a[24:27], v[88:91], v[12:15]
  ds_read_b128 v[80:83], v2 offset:12288
  v_mfma_f32_16x16x32_bf16 v[20:23], a[28:31], v[88:91], v[20:23]
  s_waitcnt lgkmcnt(7)
  v_mfma_f32_16x16x32_bf16 v[16:19], a[24:27], v[92:95], v[16:19]
  ds_read_b128 v[84:87], v2 offset:17408
  v_mfma_f32_16x16x32_bf16 v[24:27], a[28:31], v[92:95], v[24:27]
  s_waitcnt lgkmcnt(7)
  v_mfma_f32_16x16x32_bf16 v[12:15], v[28:31], v[96:99], v[12:15]
  ds_read_b128 v[88:91], v2 offset:13312
  v_mfma_f32_16x16x32_bf16 v[20:23], v[32:35], v[96:99], v[20:23]
  s_waitcnt lgkmcnt(7)
  v_mfma_f32_16x16x32_bf16 v[16:19], v[28:31], v[100:103], v[16:19]
  ds_read_b128 v[92:95], v2 offset:18432
  v_mfma_f32_16x16x32_bf16 v[24:27], v[32:35], v[100:103], v[24:27]
  s_waitcnt lgkmcnt(7)
  v_mfma_f32_16x16x32_bf16 v[12:15], a[32:35], v[64:67], v[12:15]
  ds_read_b128 v[96:99], v2 offset:14336
  v_mfma_f32_16x16x32_bf16 v[20:23], a[36:39], v[64:67], v[20:23]
  s_waitcnt lgkmcnt(7)
  v_mfma_f32_16x16x32_bf16 v[16:19], a[32:35], v[68:71], v[16:19]
  ds_read_b128 v[100:103], v2 offset:19456
  v_mfma_f32_16x16x32_bf16 v[24:27], a[36:39], v[68:71], v[24:27]
  s_waitcnt lgkmcnt(7)
  v_mfma_f32_16x16x32_bf16 v[12:15], a[40:43], v[72:75], v[12:15]
  ds_read_b128 v[64:67], v2 offset:20480
  v_mfma_f32_16x16x32_bf16 v[20:23], a[44:47], v[72:75], v[20:23]
  s_waitcnt lgkmcnt(7)
  v_mfma_f32_16x16x32_bf16 v[16:19], a[40:43], v[76:79], v[16:19]
  ds_read_b128 v[68:71], v2 offset:25600
  v_mfma_f32_16x16x32_bf16 v[24:27], a[44:47], v[76:79], v[24:27]
  s_waitcnt lgkmcnt(7)
  v_mfma_f32_16x16x32_bf16 v[12:15], a[48:51], v[80:83], v[12:15]
  ds_read_b128 v[72:75], v2 offset:21504
  v_mfma_f32_16x16x32_bf16 v[20:23], a[52:55], v[80:83], v[20:23]
  s_waitcnt lgkmcnt(7)
  v_mfma_f32_16x16x32_bf16 v[16:19], a[48:51], v[84:87], v[16:19]
  ds_read_b128 v[76:79], v2 offset:26624
  v_mfma_f32_16x16x32_bf16 v[24:27], a[52:55], v[84:87], v[24:27]
  s_waitcnt lgkmcnt(7)
  v_mfma_f32_16x16x32_bf16 v[12:15], a[56:59], v[88:91], v[12:15]
  ds_read_b128 v[80:83], v2 offset:22528
  v_mfma_f32_16x16x32_bf16 v[20:23], a[60:63], v[88:91], v[20:23]
  s_waitcnt lgkmcnt(7)
  v_mfma_f32_16x16x32_bf16 v[16:19], a[56:59], v[92:95], v[16:19]
  ds_read_b128 v[84:87], v2 offset:27648
  v_mfma_f32_16x16x32_bf16 v[24:27], a[60:63], v[92:95], v[24:27]
  s_waitcnt lgkmcnt(7)
  v_mfma_f32_16x16x32_bf16 v[12:15], v[36:39], v[96:99], v[12:15]
  ds_read_b128 v[88:91], v2 offset:23552
  v_mfma_f32_16x16x32_bf16 v[20:23], v[40:43], v[96:99], v[20:23]
  s_waitcnt lgkmcnt(7)
  v_mfma_f32_16x16x32_bf16 v[16:19], v[36:39], v[100:103], v[16:19]
  ds_read_b128 v[92:95], v2 offset:28672
  v_mfma_f32_16x16x32_bf16 v[24:27], v[40:43], v[100:103], v[24:27]
  s_waitcnt lgkmcnt(7)
  v_mfma_f32_16x16x32_bf16 v[12:15], a[64:67], v[64:67], v[12:15]
  ds_read_b128 v[96:99], v2 offset:24576
  v_mfma_f32_16x16x32_bf16 v[20:23], a[68:71], v[64:67], v[20:23]
  s_waitcnt lgkmcnt(7)
  v_mfma_f32_16x16x32_bf16 v[16:19], a[64:67], v[68:71], v[16:19]
  ds_read_b128 v[100:103], v2 offset:29696
  v_mfma_f32_16x16x32_bf16 v[24:27], a[68:71], v[68:71], v[24:27]
  s_waitcnt lgkmcnt(7)
  v_mfma_f32_16x16x32_bf16 v[12:15], a[72:75], v[72:75], v[12:15]
  ds_read_b128 v[64:67], v2 offset:30720
  v_mfma_f32_16x16x32_bf16 v[20:23], a[76:79], v[72:75], v[20:23]
  s_waitcnt lgkmcnt(7)
  v_mfma_f32_16x16x32_bf16 v[16:19], a[72:75], v[76:79], v[16:19]
  ds_read_b128 v[68:71], v2 offset:35840
  v_mfma_f32_16x16x32_bf16 v[24:27], a[76:79], v[76:79], v[24:27]
  s_waitcnt lgkmcnt(7)
  v_mfma_f32_16x16x32_bf16 v[12:15], a[80:83], v[80:83], v[12:15]
  ds_read_b128 v[72:75], v2 offset:31744
  v_mfma_f32_16x16x32_bf16 v[20:23], a[84:87], v[80:83], v[20:23]
  s_waitcnt lgkmcnt(7)
  v_mfma_f32_16x16x32_bf16 v[16:19], a[80:83], v[84:87], v[16:19]
  ds_read_b128 v[76:79], v2 offset:36864
  v_mfma_f32_16x16x32_bf16 v[24:27], a[84:87], v[84:87], v[24:27]
  s_waitcnt lgkmcnt(7)
  v_mfma_f32_16x16x32_bf16 v[12:15], a[88:91], v[88:91], v[12:15]
  ds_read_b128 v[80:83], v2 offset:32768
  v_mfma_f32_16x16x32_bf16 v[20:23], a[92:95], v[88:91], v[20:23]
  s_waitcnt lgkmcnt(7)
  v_mfma_f32_16x16x32_bf16 v[16:19], a[88:91], v[92:95], v[16:19]
  ds_read_b128 v[84:87], v2 offset:37888
  v_mfma_f32_16x16x32_bf16 v[24:27], a[92:95], v[92:95], v[24:27]
  s_waitcnt lgkmcnt(7)
  v_mfma_f32_16x16x32_bf16 v[12:15], v[44:47], v[96:99], v[12:15]
  ds_read_b128 v[88:91], v2 offset:33792
  v_mfma_f32_16x16x32_bf16 v[20:23], v[48:51], v[96:99], v[20:23]
  s_waitcnt lgkmcnt(7)
  v_mfma_f32_16x16x32_bf16 v[16:19], v[44:47], v[100:103], v[16:19]
  ds_read_b128 v[92:95], v2 offset:38912
  v_mfma_f32_16x16x32_bf16 v[24:27], v[48:51], v[100:103], v[24:27]
  s_waitcnt lgkmcnt(7)
  v_mfma_f32_16x16x32_bf16 v[12:15], a[96:99], v[64:67], v[12:15]
  ds_read_b128 v[96:99], v2 offset:34816
  v_mfma_f32_16x16x32_bf16 v[20:23], a[100:103], v[64:67], v[20:23]
  s_waitcnt lgkmcnt(7)
  v_mfma_f32_16x16x32_bf16 v[16:19], a[96:99], v[68:71], v[16:19]
  ds_read_b128 v[100:103], v2 offset:39936
  v_mfma_f32_16x16x32_bf16 v[24:27], a[100:103], v[68:71], v[24:27]
  s_waitcnt lgkmcnt(7)
  v_mfma_f32_16x16x32_bf16 v[12:15], a[104:107], v[72:75], v[12:15]
  v_mfma_f32_16x16x32_bf16 v[20:23], a[108:111], v[72:75], v[20:23]
  s_waitcnt lgkmcnt(6)
  v_mfma_f32_16x16x32_bf16 v[16:19], a[104:107], v[76:79], v[16:19]
  v_mfma_f32_16x16x32_bf16 v[24:27], a[108:111], v[76:79], v[24:27]
  s_waitcnt lgkmcnt(5)
  v_mfma_f32_16x16x32_bf16 v[12:15], a[112:115], v[80:83], v[12:15]
  v_mfma_f32_16x16x32_bf16 v[20:23], a[116:119], v[80:83], v[20:23]
  s_waitcnt lgkmcnt(4)
  v_mfma_f32_16x16x32_bf16 v[16:19], a[112:115], v[84:87], v[16:19]
  v_mfma_f32_16x16x32_bf16 v[24:27], a[116:119], v[84:87], v[24:27]
  s_waitcnt lgkmcnt(3)
  v_mfma_f32_16x16x32_bf16 v[12:15], a[120:123], v[88:91], v[12:15]
  v_mfma_f32_16x16x32_bf16 v[20:23], a[124:127], v[88:91], v[20:23]
  s_waitcnt lgkmcnt(2)
  v_mfma_f32_16x16x32_bf16 v[16:19], a[120:123], v[92:95], v[16:19]
  v_mfma_f32_16x16x32_bf16 v[24:27], a[124:127], v[92:95], v[24:27]
  s_waitcnt lgkmcnt(1)
  v_mfma_f32_16x16x32_bf16 v[12:15], v[52:55], v[96:99], v[12:15]
  v_mfma_f32_16x16x32_bf16 v[20:23], v[56:59], v[96:99], v[20:23]
  s_waitcnt lgkmcnt(0)
  v_mfma_f32_16x16x32_bf16 v[16:19], v[52:55], v[100:103], v[16:19]
  v_mfma_f32_16x16x32_bf16 v[24:27], v[56:59], v[100:103], v[24:27]
  v_mul_u32_u24 v9, 1792, v4
  v_lshl_add_u32 v9, v3, 3, v9
  s_lshl_b32 s22, s20, 5
  v_add_u32 v8, s22, v9
  s_mul_i32 s22, s20, 24
  s_add_u32 s22, s22, 512
  v_add_u32 v9, s22, v9
  v_mov_b32 v10, 0x40000000
  v_cmp_eq_u32 vcc, 3, v3
  s_nop 1
  v_cndmask_b32 v9, v9, v10, vcc
  s_mul_i32 s26, s17, 57344
  s_add_u32 s26, s26, 896
  s_add_u32 s27, s26, 28672
  v_cvt_pk_bf16_f32 v108, v12, v13
  v_cvt_pk_bf16_f32 v109, v14, v15
  buffer_store_dwordx2 v[108:109], v8, s[92:95], s26 offen
  v_cvt_pk_bf16_f32 v110, v20, v21
  v_cvt_pk_bf16_f32 v111, v22, v23
  buffer_store_dwordx2 v[110:111], v9, s[92:95], s26 offen
  v_cvt_pk_bf16_f32 v112, v16, v17
  v_cvt_pk_bf16_f32 v113, v18, v19
  buffer_store_dwordx2 v[112:113], v8, s[92:95], s27 offen
  v_cvt_pk_bf16_f32 v114, v24, v25
  v_cvt_pk_bf16_f32 v115, v26, v27
  buffer_store_dwordx2 v[114:115], v9, s[92:95], s27 offen
  s_branch wk_loop
wp_abort:
wo_abort:
  s_branch cA_abort
wk_done:
ch_end:
  s_endpgm

.section .rodata,"a"
.p2align 6
.amdhsa_kernel main_kernel
  .amdhsa_next_free_vgpr 512
  .amdhsa_next_free_sgpr 102
  .amdhsa_accum_offset 256
  .amdhsa_group_segment_fixed_size 0
  .amdhsa_kernarg_size 136
  .amdhsa_user_sgpr_count 2
  .amdhsa_user_sgpr_kernarg_segment_ptr 1
  .amdhsa_system_sgpr_workgroup_id_x 1
.end_amdhsa_kernel
```

```asm
; @launch kernel=main_kernel grid=(256,1,1) block=(256,1,1) lds=163840
.amdgcn_target "amdgcn-amd-amdhsa--gfx950"
.text
.globl main_kernel
.p2align 8
.type main_kernel,@function
main_kernel:
  s_cmp_ge_u32 s2, 256
  s_cbranch_scc1 ch_end
  s_load_dwordx2 s[4:5], s[0:1], 120
  s_load_dwordx2 s[6:7], s[0:1], 128
  s_load_dwordx8 s[40:47], s[0:1], 72
  s_load_dwordx4 s[48:51], s[0:1], 56
  s_mov_b32 s32, 0
  s_getreg_b32 s3, hwreg(HW_REG_XCC_ID)
  s_and_b32 s3, s3, 15
  s_cmp_lg_u32 s3, 1
  s_cbranch_scc1 ch_pf
  s_cmp_lt_u32 s2, 224
  s_cbranch_scc1 ch_npf
ch_pf:
  s_getpc_b64 s[98:99]
pf_main_kernel_1:
  s_sub_u32 s98, s98, pf_main_kernel_1-main_kernel
  s_subb_u32 s99, s99, 0
  v_lshlrev_b32 v60, 7, v0
  v_min_u32 v61, ch_end-main_kernel-4, v60
  global_load_dword v62, v61, s[98:99]
  v_add_u32 v60, 32768, v60
  v_min_u32 v61, ch_end-main_kernel-4, v60
  global_load_dword v62, v61, s[98:99]
  v_add_u32 v60, 32768, v60
  v_min_u32 v61, ch_end-main_kernel-4, v60
  global_load_dword v62, v61, s[98:99]
  v_add_u32 v60, 32768, v60
  v_min_u32 v61, ch_end-main_kernel-4, v60
  global_load_dword v62, v61, s[98:99]
  v_add_u32 v60, 32768, v60
  v_min_u32 v61, ch_end-main_kernel-4, v60
  global_load_dword v62, v61, s[98:99]
  v_add_u32 v60, 32768, v60
ch_npf:
  v_lshrrev_b32 v1, 6, v0
  s_nop 0
  v_readfirstlane_b32 s16, v1
  s_waitcnt lgkmcnt(0)
  s_mov_b32 s8, s6
  s_and_b32 s9, s7, 0xffff
  s_mov_b32 s10, 0x10000000
  s_mov_b32 s11, 0x20000
  s_mov_b32 s12, s4
  s_and_b32 s13, s5, 0xffff
  s_mov_b32 s14, 256
  s_mov_b32 s15, 0x20000
  v_mov_b32 v252, 0x40000000
  v_cmp_eq_u32 vcc, 0, v0
  s_nop 1
  v_cndmask_b32 v252, v252, v0, vcc
  s_cmp_lg_u32 s3, 1
  s_cbranch_scc1 ch_worker
  s_mov_b32 s18, 0
  v_mov_b32 v249, 1
  s_mov_b64 exec, 1
  buffer_atomic_add v249, v252, s[12:15], 0 offen sc0
  s_mov_b64 exec, -1
  v_and_b32 v1, 63, v0
  v_lshlrev_b32 v2, 4, v1
  v_lshrrev_b32 v3, 4, v1
  v_and_b32 v4, 15, v1
  s_lshr_b32 s33, s2, 3
  s_lshl_b32 s27, s33, 2
  s_add_u32 s27, s27, s16
  s_lshl_b32 s27, s27, 13
  v_lshlrev_b32 v12, 7, v1
  s_mov_b32 s64, s42
  s_and_b32 s65, s43, 0xffff
  s_mov_b32 s66, 2097152
  s_mov_b32 s67, 0x20000
  s_mov_b32 s28, s27
  buffer_load_dword v13, v12, s[64:67], s28 offen
  s_add_u32 s28, s28, 1048576
  buffer_load_dword v13, v12, s[64:67], s28 offen
  s_add_u32 s28, s28, 1048576
  s_waitcnt vmcnt(2)
  v_readfirstlane_b32 s17, v249
  v_mov_b32 v6, 160032
  s_nop 0
  v_mov_b32 v7, s17
  s_barrier
  s_cmp_lg_u32 s16, 0
  s_cbranch_scc1 uni_2
  ds_write_b32 v6, v7
  s_waitcnt lgkmcnt(0)
uni_2:
  s_barrier
  ds_read_b32 v7, v6
  s_waitcnt lgkmcnt(0)
  v_readfirstlane_b32 s17, v7
  s_branch ch_got
ch_take:
  v_mov_b32 v5, 0
  v_mov_b32 v6, 160000
  s_barrier
  s_cmp_lg_u32 s16, 0
  s_cbranch_scc1 ch_el1
  s_mov_b64 exec, 1
  buffer_atomic_add v4, v5, s[12:15], 0 offen sc0
  s_waitcnt vmcnt(0)
  ds_write_b32 v6, v4
  s_waitcnt lgkmcnt(0)
  s_mov_b64 exec, -1
ch_el1:
  s_barrier
  ds_read_b32 v4, v6
  s_waitcnt lgkmcnt(0)
  v_readfirstlane_b32 s17, v4
ch_got:
  s_and_b32 s17, s17, 0xffff
  s_cmp_lt_u32 s17, 32
  s_cbranch_scc1 ch_role
  s_cmp_eq_u32 s18, 0
  s_cbranch_scc1 ch_worker
  v_and_b32 v1, 63, v0
  v_lshlrev_b32 v2, 4, v1
  v_lshrrev_b32 v3, 4, v1
  v_and_b32 v4, 15, v1
  s_branch wp_all
ch_role:
  v_and_b32 v1, 63, v0
  v_lshlrev_b32 v2, 4, v1
  v_lshrrev_b32 v3, 4, v1
  v_and_b32 v4, 15, v1
  s_cmp_lt_u32 s17, 16
  s_cbranch_scc1 ch_self
  s_cmp_lt_u32 s17, 24
  s_cbranch_scc1 ch_tch
  s_sub_u32 s33, s17, 24
  v_mov_b32 v10, 0x40000000
  v_mov_b32 v5, 1
  v_mov_b32 v148, 0
  v_mov_b32 v149, 0
  v_mov_b32 v150, 0
  v_mov_b32 v151, 0
  v_mov_b32 v152, -1
  v_mov_b32 v153, -1
  v_mov_b32 v154, -1
  v_mov_b32 v155, -1
  v_lshlrev_b32 v8, 4, v0
  s_mov_b32 s64, s48
  s_and_b32 s65, s49, 0xffff
  s_mov_b32 s66, 1835008
  s_mov_b32 s67, 0x20000
  s_lshl_b32 s21, s33, 2
  s_add_u32 s21, s21, s16
  s_lshr_b32 s22, s21, 1
  s_mul_i32 s22, s22, 14336
  s_and_b32 s24, s21, 1
  s_mul_i32 s24, s24, 448
  s_add_u32 s22, s22, s24
  s_mul_i32 s21, s21, 7168
  v_mul_u32_u24 v7, 896, v4
  v_lshl_add_u32 v7, v3, 4, v7
  buffer_load_dwordx4 v[64:67], v7, s[64:67], s22 offen offset:0
  buffer_load_dwordx4 v[68:71], v7, s[64:67], s22 offen offset:64
  buffer_load_dwordx4 v[72:75], v7, s[64:67], s22 offen offset:128
  buffer_load_dwordx4 v[76:79], v7, s[64:67], s22 offen offset:192
  buffer_load_dwordx4 v[80:83], v7, s[64:67], s22 offen offset:256
  buffer_load_dwordx4 v[84:87], v7, s[64:67], s22 offen offset:320
  buffer_load_dwordx4 v[88:91], v7, s[64:67], s22 offen offset:384
  s_mov_b32 s68, s50
  s_and_b32 s69, s51, 0xffff
  s_mov_b32 s70, 7168
  s_mov_b32 s71, 0x20000
  v_lshrrev_b32 v6, 3, v0
  v_min_u32 v6, 27, v6
  v_and_b32 v7, 7, v0
  v_mul_u32_u24 v9, 896, v7
  v_lshl_add_u32 v9, v6, 5, v9
  buffer_load_dwordx4 v[176:179], v9, s[68:71], 0 offen
  buffer_load_dwordx4 v[180:183], v9, s[68:71], 0 offen offset:16
  s_cmp_lg_u32 s33, 0
  s_cbranch_scc1 ch_ij_1
  s_mov_b32 s23, 582144
  buffer_store_dwordx4 v[148:151], v8, s[8:11], s23 offen sc1
  s_mov_b32 s23, 586240
  buffer_store_dwordx4 v[148:151], v8, s[8:11], s23 offen sc1
  s_waitcnt vmcnt(0)
  s_barrier
  buffer_store_dword v5, v252, s[12:15], 0 offen offset:128 sc1
ch_ij_1:
  s_waitcnt vmcnt(1)
  s_add_u32 s23, s21, 655360
  buffer_store_dwordx4 v[64:67], v2, s[8:11], s23 offen offset:0 sc1
  buffer_store_dwordx4 v[68:71], v2, s[8:11], s23 offen offset:1024 sc1
  buffer_store_dwordx4 v[72:75], v2, s[8:11], s23 offen offset:2048 sc1
  buffer_store_dwordx4 v[76:79], v2, s[8:11], s23 offen offset:3072 sc1
  s_add_u32 s23, s21, 659456
  buffer_store_dwordx4 v[80:83], v2, s[8:11], s23 offen offset:0 sc1
  buffer_store_dwordx4 v[84:87], v2, s[8:11], s23 offen offset:1024 sc1
  buffer_store_dwordx4 v[88:91], v2, s[8:11], s23 offen offset:2048 sc1
  s_waitcnt vmcnt(0)
  s_barrier
  s_cmp_lg_u32 s16, 0
  s_cbranch_scc1 ch_ij_x_e
  v_mov_b32 v6, 1
  s_mov_b64 exec, 1
  buffer_atomic_add v6, v252, s[12:15], 0 offen offset:4 sc0
  s_waitcnt vmcnt(0)
  v_readfirstlane_b32 s20, v6
  s_cmp_lg_u32 s20, 7
  s_cbranch_scc1 ch_ij_x_e0
  s_mov_b64 exec, 0xff
  v_lshlrev_b32 v6, 7, v0
  s_mov_b32 s20, 586240
  buffer_store_dword v5, v6, s[8:11], s20 offen offset:8 sc1
ch_ij_x_e0:
  s_mov_b64 exec, -1
ch_ij_x_e:
  s_lshl_b32 s20, s33, 12
  v_add_u32 v8, s20, v8
  s_mov_b32 s23, 524288
ch_ijlp_3:
  buffer_store_dwordx4 v[148:151], v8, s[8:11], s23 offen sc1
  s_add_u32 s23, s23, 32768
  s_cmp_lt_u32 s23, 557056
  s_cbranch_scc1 ch_ijlp_3
  v_cmp_gt_u32 vcc, 25088, v8
  s_nop 1
  v_cndmask_b32 v9, v10, v8, vcc
  buffer_store_dwordx4 v[148:151], v9, s[8:11], s23 offen sc1
  s_mov_b32 s23, 35328
  v_cmp_gt_u32 vcc, 6144, v8
  s_nop 1
  v_cndmask_b32 v9, v10, v8, vcc
  buffer_store_dwordx4 v[148:151], v9, s[8:11], s23 offen sc1
  s_mov_b32 s23, 7168
  v_cmp_gt_u32 vcc, 28160, v8
  s_nop 1
  v_cndmask_b32 v9, v10, v8, vcc
  buffer_store_dwordx4 v[152:155], v9, s[8:11], s23 offen sc1
  s_mov_b32 s23, 72704
ch_ijlp_4:
  buffer_store_dwordx4 v[152:155], v8, s[8:11], s23 offen sc1
  s_add_u32 s23, s23, 32768
  s_cmp_lt_u32 s23, 498688
  s_cbranch_scc1 ch_ijlp_4
  v_cmp_gt_u32 vcc, 25600, v8
  s_nop 1
  v_cndmask_b32 v9, v10, v8, vcc
  buffer_store_dwordx4 v[152:155], v9, s[8:11], s23 offen sc1
  s_cmp_lg_u32 s33, 1
  s_cbranch_scc1 ch_ij_nm
  v_lshrrev_b32 v6, 3, v0
  v_and_b32 v7, 7, v0
  v_lshlrev_b32 v8, 8, v6
  v_lshl_add_u32 v8, v7, 4, v8
  v_cmp_gt_u32 vcc, 28, v6
  s_nop 1
  v_cndmask_b32 v8, v10, v8, vcc
  s_waitcnt vmcnt(4)
  v_mov_b32 v184, v176
  v_mov_b32 v188, v177
  v_mov_b32 v185, v178
  v_mov_b32 v189, v179
  v_mov_b32 v186, v180
  v_mov_b32 v190, v181
  v_mov_b32 v187, v182
  v_mov_b32 v191, v183
  s_mov_b32 s23, 0
  buffer_store_dwordx4 v[184:187], v8, s[8:11], s23 offen sc1
  buffer_store_dwordx4 v[188:191], v8, s[8:11], s23 offen offset:128 sc1
  s_mov_b32 s23, 65536
  buffer_store_dwordx4 v[184:187], v8, s[8:11], s23 offen sc1
  buffer_store_dwordx4 v[188:191], v8, s[8:11], s23 offen offset:128 sc1
ch_ij_nm:
  s_waitcnt vmcnt(0)
  s_barrier
  s_cmp_lg_u32 s16, 0
  s_cbranch_scc1 ch_ij_e
  v_mov_b32 v6, 1
  s_mov_b64 exec, 1
  buffer_atomic_add v6, v252, s[12:15], 0 offen offset:12 sc0
  s_waitcnt vmcnt(0)
  v_readfirstlane_b32 s20, v6
  s_cmp_lg_u32 s20, 7
  s_cbranch_scc1 ch_ij_e0
  buffer_store_dword v5, v252, s[12:15], 0 offen offset:132 sc1
  s_mov_b64 exec, 0xff
  v_lshlrev_b32 v6, 7, v0
  s_mov_b32 s20, 586240
  buffer_store_dword v5, v6, s[8:11], s20 offen offset:4 sc1
ch_ij_e0:
  s_mov_b64 exec, -1
ch_ij_e:
  s_branch ch_role2
ch_tch:
  s_sub_u32 s33, s17, 16
  s_lshl_b32 s27, s33, 2
  s_add_u32 s27, s27, s16
  s_lshl_b32 s27, s27, 13
  v_lshlrev_b32 v12, 7, v1
  s_mov_b32 s64, s40
  s_and_b32 s65, s41, 0xffff
  s_mov_b32 s66, 2097152
  s_mov_b32 s67, 0x20000
  s_mov_b32 s28, s27
  buffer_load_dword v13, v12, s[64:67], s28 offen
  s_add_u32 s28, s28, 262144
  buffer_load_dword v13, v12, s[64:67], s28 offen
  s_add_u32 s28, s28, 262144
  buffer_load_dword v13, v12, s[64:67], s28 offen
  s_add_u32 s28, s28, 262144
  buffer_load_dword v13, v12, s[64:67], s28 offen
  s_add_u32 s28, s28, 262144
  buffer_load_dword v13, v12, s[64:67], s28 offen
  s_add_u32 s28, s28, 262144
  buffer_load_dword v13, v12, s[64:67], s28 offen
  s_add_u32 s28, s28, 262144
  buffer_load_dword v13, v12, s[64:67], s28 offen
  s_add_u32 s28, s28, 262144
  buffer_load_dword v13, v12, s[64:67], s28 offen
  s_add_u32 s28, s28, 262144
  s_branch ch_role2
ch_self:
  v_lshrrev_b32 v5, 5, v1
  v_and_b32 v6, 31, v1
  v_xor_b32 v8, v6, v5
  v_lshlrev_b32 v8, 4, v8
  v_lshl_add_u32 v16, v5, 13, v8
  v_xor_b32 v17, 32, v16
  v_xor_b32 v18, 64, v16
  v_xor_b32 v19, 96, v16
  v_xor_b32 v20, 128, v16
  v_xor_b32 v21, 160, v16
  v_xor_b32 v22, 192, v16
  v_xor_b32 v23, 224, v16
  s_lshl_b32 s20, s16, 6
  v_xor_b32 v26, s20, v16
  v_xor_b32 v27, 32, v26
  s_mov_b32 s60, s40
  s_and_b32 s61, s41, 0xffff
  s_mov_b32 s62, 3670016
  s_mov_b32 s63, 0x20000
  s_mov_b32 s56, s42
  s_and_b32 s57, s43, 0xffff
  s_mov_b32 s58, 3670016
  s_mov_b32 s59, 0x20000
  s_lshl_b32 s26, s17, 9
  s_lshl_b32 s27, s16, 19
  s_add_u32 s27, s27, s26
  s_lshl_b32 s25, s16, 15
  s_add_u32 s25, s25, 32768
  s_barrier
  s_add_u32 m0, s25, 0
  s_nop 0
  buffer_load_dwordx4 v16, s[56:59], s27 offen lds
  s_add_u32 s27, s27, 16384
  s_add_u32 m0, s25, 1024
  s_nop 0
  buffer_load_dwordx4 v16, s[56:59], s27 offen lds
  s_add_u32 s27, s27, 16384
  s_add_u32 m0, s25, 2048
  s_nop 0
  buffer_load_dwordx4 v17, s[56:59], s27 offen lds
  s_add_u32 s27, s27, 16384
  s_add_u32 m0, s25, 3072
  s_nop 0
  buffer_load_dwordx4 v17, s[56:59], s27 offen lds
  s_add_u32 s27, s27, 16384
  s_add_u32 m0, s25, 4096
  s_nop 0
  buffer_load_dwordx4 v16, s[56:59], s27 offen lds
  s_add_u32 s27, s27, 16384
  s_add_u32 m0, s25, 5120
  s_nop 0
  buffer_load_dwordx4 v16, s[56:59], s27 offen lds
  s_add_u32 s27, s27, 16384
  s_add_u32 m0, s25, 6144
  s_nop 0
  buffer_load_dwordx4 v17, s[56:59], s27 offen lds
  s_add_u32 s27, s27, 16384
  s_add_u32 m0, s25, 7168
  s_nop 0
  buffer_load_dwordx4 v17, s[56:59], s27 offen lds
  s_add_u32 s27, s27, 16384
  s_add_u32 m0, s25, 8192
  s_nop 0
  buffer_load_dwordx4 v18, s[56:59], s27 offen lds
  s_add_u32 s27, s27, 16384
  s_add_u32 m0, s25, 9216
  s_nop 0
  buffer_load_dwordx4 v18, s[56:59], s27 offen lds
  s_add_u32 s27, s27, 16384
  s_add_u32 m0, s25, 10240
  s_nop 0
  buffer_load_dwordx4 v19, s[56:59], s27 offen lds
  s_add_u32 s27, s27, 16384
  s_add_u32 m0, s25, 11264
  s_nop 0
  buffer_load_dwordx4 v19, s[56:59], s27 offen lds
  s_add_u32 s27, s27, 16384
  s_add_u32 m0, s25, 12288
  s_nop 0
  buffer_load_dwordx4 v18, s[56:59], s27 offen lds
  s_add_u32 s27, s27, 16384
  s_add_u32 m0, s25, 13312
  s_nop 0
  buffer_load_dwordx4 v18, s[56:59], s27 offen lds
  s_add_u32 s27, s27, 16384
  s_add_u32 m0, s25, 14336
  s_nop 0
  buffer_load_dwordx4 v19, s[56:59], s27 offen lds
  s_add_u32 s27, s27, 16384
  s_add_u32 m0, s25, 15360
  s_nop 0
  buffer_load_dwordx4 v19, s[56:59], s27 offen lds
  s_add_u32 s27, s27, 16384
  s_add_u32 m0, s25, 16384
  s_nop 0
  buffer_load_dwordx4 v20, s[56:59], s27 offen lds
  s_add_u32 s27, s27, 16384
  s_add_u32 m0, s25, 17408
  s_nop 0
  buffer_load_dwordx4 v20, s[56:59], s27 offen lds
  s_add_u32 s27, s27, 16384
  s_add_u32 m0, s25, 18432
  s_nop 0
  buffer_load_dwordx4 v21, s[56:59], s27 offen lds
  s_add_u32 s27, s27, 16384
  s_add_u32 m0, s25, 19456
  s_nop 0
  buffer_load_dwordx4 v21, s[56:59], s27 offen lds
  s_add_u32 s27, s27, 16384
  s_add_u32 m0, s25, 20480
  s_nop 0
  buffer_load_dwordx4 v20, s[56:59], s27 offen lds
  s_add_u32 s27, s27, 16384
  s_add_u32 m0, s25, 21504
  s_nop 0
  buffer_load_dwordx4 v20, s[56:59], s27 offen lds
  s_add_u32 s27, s27, 16384
  s_add_u32 m0, s25, 22528
  s_nop 0
  buffer_load_dwordx4 v21, s[56:59], s27 offen lds
  s_add_u32 s27, s27, 16384
  s_add_u32 m0, s25, 23552
  s_nop 0
  buffer_load_dwordx4 v21, s[56:59], s27 offen lds
  s_add_u32 s27, s27, 16384
  s_add_u32 m0, s25, 24576
  s_nop 0
  buffer_load_dwordx4 v22, s[56:59], s27 offen lds
  s_add_u32 s27, s27, 16384
  s_add_u32 m0, s25, 25600
  s_nop 0
  buffer_load_dwordx4 v22, s[56:59], s27 offen lds
  s_add_u32 s27, s27, 16384
  s_add_u32 m0, s25, 26624
  s_nop 0
  buffer_load_dwordx4 v23, s[56:59], s27 offen lds
  s_add_u32 s27, s27, 16384
  s_add_u32 m0, s25, 27648
  s_nop 0
  buffer_load_dwordx4 v23, s[56:59], s27 offen lds
  s_add_u32 s27, s27, 16384
  s_add_u32 m0, s25, 28672
  s_nop 0
  buffer_load_dwordx4 v22, s[56:59], s27 offen lds
  s_add_u32 s27, s27, 16384
  s_add_u32 m0, s25, 29696
  s_nop 0
  buffer_load_dwordx4 v22, s[56:59], s27 offen lds
  s_add_u32 s27, s27, 16384
  s_add_u32 m0, s25, 30720
  s_nop 0
  buffer_load_dwordx4 v23, s[56:59], s27 offen lds
  s_add_u32 s27, s27, 16384
  s_add_u32 m0, s25, 31744
  s_nop 0
  buffer_load_dwordx4 v23, s[56:59], s27 offen lds
  s_add_u32 s27, s27, 16384
  v_mov_b32 v14, v26
  v_mov_b32 v15, v27
  s_lshl_b32 s28, s16, 16
  s_add_u32 s28, s28, s26
  s_lshl_b32 s29, s16, 12
  s_add_u32 m0, s29, 0
  s_add_u32 s27, s28, 0
  buffer_load_dwordx4 v14, s[60:63], s27 offen lds
  s_add_u32 m0, s29, 1024
  s_add_u32 s27, s28, 16384
  buffer_load_dwordx4 v15, s[60:63], s27 offen lds
  s_add_u32 m0, s29, 2048
  s_add_u32 s27, s28, 32768
  buffer_load_dwordx4 v14, s[60:63], s27 offen lds
  s_add_u32 m0, s29, 3072
  s_add_u32 s27, s28, 49152
  buffer_load_dwordx4 v15, s[60:63], s27 offen lds
  s_add_u32 m0, s29, 16384
  s_add_u32 s27, s28, 262144
  buffer_load_dwordx4 v14, s[60:63], s27 offen lds
  s_add_u32 m0, s29, 17408
  s_add_u32 s27, s28, 278528
  buffer_load_dwordx4 v15, s[60:63], s27 offen lds
  s_add_u32 m0, s29, 18432
  s_add_u32 s27, s28, 294912
  buffer_load_dwordx4 v14, s[60:63], s27 offen lds
  s_add_u32 m0, s29, 19456
  s_add_u32 s27, s28, 311296
  buffer_load_dwordx4 v15, s[60:63], s27 offen lds
  v_lshrrev_b32 v7, 2, v4
  v_lshlrev_b32 v11, 4, v7
  v_lshlrev_b32 v7, 3, v7
  v_and_b32 v8, 3, v4
  v_add_u32 v7, v7, v8
  v_and_b32 v8, 2, v4
  v_lshl_add_u32 v11, v8, 1, v11
  v_and_b32 v8, 1, v4
  v_add_u32 v11, v11, v8
  v_or_b32 v10, 0, v3
  v_xor_b32 v10, v10, v4
  v_lshlrev_b32 v10, 4, v10
  v_lshl_add_u32 v248, v7, 9, v10
  v_add_u32 v252, 65536, v248
  v_add_u32 v16, 131072, v248
  v_lshl_add_u32 v10, v11, 9, v10
  v_add_u32 v20, s25, v10
  v_or_b32 v10, 4, v3
  v_xor_b32 v10, v10, v4
  v_lshlrev_b32 v10, 4, v10
  v_lshl_add_u32 v249, v7, 9, v10
  v_add_u32 v253, 65536, v249
  v_add_u32 v17, 131072, v249
  v_lshl_add_u32 v10, v11, 9, v10
  v_add_u32 v21, s25, v10
  v_or_b32 v10, 8, v3
  v_xor_b32 v10, v10, v4
  v_lshlrev_b32 v10, 4, v10
  v_lshl_add_u32 v250, v7, 9, v10
  v_add_u32 v254, 65536, v250
  v_add_u32 v18, 131072, v250
  v_lshl_add_u32 v10, v11, 9, v10
  v_add_u32 v22, s25, v10
  v_or_b32 v10, 12, v3
  v_xor_b32 v10, v10, v4
  v_lshlrev_b32 v10, 4, v10
  v_lshl_add_u32 v251, v7, 9, v10
  v_add_u32 v255, 65536, v251
  v_add_u32 v19, 131072, v251
  v_lshl_add_u32 v10, v11, 9, v10
  v_add_u32 v23, s25, v10
  v_mov_b32 v12, 1035512379
  v_lshlrev_b32 v6, 7, v1
  s_getpc_b64 s[98:99]
  global_load_dword v7, v6, s[98:99]
  s_waitcnt vmcnt(9)
  ds_read_b128 v[120:123], v20 offset:0
  ds_read_b128 v[124:127], v21 offset:0
  ds_read_b128 v[128:131], v22 offset:0
  ds_read_b128 v[132:135], v23 offset:0
  ds_read_b128 v[136:139], v20 offset:256
  ds_read_b128 v[140:143], v21 offset:256
  ds_read_b128 v[144:147], v22 offset:256
  ds_read_b128 v[148:151], v23 offset:256
  s_waitcnt lgkmcnt(8)
  ds_read_b128 v[152:155], v20 offset:1024
  ds_read_b128 v[156:159], v21 offset:1024
  ds_read_b128 v[160:163], v22 offset:1024
  ds_read_b128 v[164:167], v23 offset:1024
  ds_read_b128 v[168:171], v20 offset:1280
  ds_read_b128 v[172:175], v21 offset:1280
  ds_read_b128 v[176:179], v22 offset:1280
  ds_read_b128 v[180:183], v23 offset:1280
  s_waitcnt lgkmcnt(8)
  ds_read_b128 v[184:187], v20 offset:4096
  ds_read_b128 v[188:191], v21 offset:4096
  ds_read_b128 v[192:195], v22 offset:4096
  ds_read_b128 v[196:199], v23 offset:4096
  ds_read_b128 v[200:203], v20 offset:4352
  ds_read_b128 v[204:207], v21 offset:4352
  ds_read_b128 v[208:211], v22 offset:4352
  ds_read_b128 v[212:215], v23 offset:4352
  s_waitcnt lgkmcnt(8)
  ds_read_b128 v[216:219], v20 offset:5120
  ds_read_b128 v[220:223], v21 offset:5120
  ds_read_b128 v[224:227], v22 offset:5120
  ds_read_b128 v[228:231], v23 offset:5120
  ds_read_b128 v[232:235], v20 offset:5376
  ds_read_b128 v[236:239], v21 offset:5376
  ds_read_b128 v[240:243], v22 offset:5376
  ds_read_b128 v[244:247], v23 offset:5376
  s_waitcnt lgkmcnt(8)
  s_waitcnt vmcnt(4) lgkmcnt(0)
  s_barrier
  s_add_u32 m0, s29, 32768
  s_add_u32 s27, s28, 524288
  buffer_load_dwordx4 v14, s[60:63], s27 offen lds
  s_add_u32 m0, s29, 33792
  s_add_u32 s27, s28, 540672
  buffer_load_dwordx4 v15, s[60:63], s27 offen lds
  s_add_u32 m0, s29, 34816
  s_add_u32 s27, s28, 557056
  buffer_load_dwordx4 v14, s[60:63], s27 offen lds
  s_add_u32 m0, s29, 35840
  s_add_u32 s27, s28, 573440
  buffer_load_dwordx4 v15, s[60:63], s27 offen lds
  s_add_u32 m0, s29, 49152
  s_add_u32 s27, s28, 786432
  buffer_load_dwordx4 v14, s[60:63], s27 offen lds
  s_add_u32 m0, s29, 50176
  s_add_u32 s27, s28, 802816
  buffer_load_dwordx4 v15, s[60:63], s27 offen lds
  s_add_u32 m0, s29, 51200
  s_add_u32 s27, s28, 819200
  buffer_load_dwordx4 v14, s[60:63], s27 offen lds
  s_add_u32 m0, s29, 52224
  s_add_u32 s27, s28, 835584
  buffer_load_dwordx4 v15, s[60:63], s27 offen lds
  s_add_u32 m0, s29, 65536
  s_add_u32 s27, s28, 1048576
  buffer_load_dwordx4 v14, s[60:63], s27 offen lds
  s_add_u32 m0, s29, 66560
  s_add_u32 s27, s28, 1064960
  buffer_load_dwordx4 v15, s[60:63], s27 offen lds
  s_add_u32 m0, s29, 67584
  s_add_u32 s27, s28, 1081344
  buffer_load_dwordx4 v14, s[60:63], s27 offen lds
  s_add_u32 m0, s29, 68608
  s_add_u32 s27, s28, 1097728
  buffer_load_dwordx4 v15, s[60:63], s27 offen lds
  s_add_u32 m0, s29, 81920
  s_add_u32 s27, s28, 1310720
  buffer_load_dwordx4 v14, s[60:63], s27 offen lds
  s_add_u32 m0, s29, 82944
  s_add_u32 s27, s28, 1327104
  buffer_load_dwordx4 v15, s[60:63], s27 offen lds
  s_add_u32 m0, s29, 83968
  s_add_u32 s27, s28, 1343488
  buffer_load_dwordx4 v14, s[60:63], s27 offen lds
  s_add_u32 m0, s29, 84992
  s_add_u32 s27, s28, 1359872
  buffer_load_dwordx4 v15, s[60:63], s27 offen lds
  ds_read_b128 v[24:27], v248 offset:0
  ds_read_b128 v[28:31], v248 offset:2048
  ds_read_b128 v[32:35], v249 offset:0
  ds_read_b128 v[36:39], v249 offset:2048
  ds_read_b128 v[40:43], v250 offset:0
  ds_read_b128 v[44:47], v250 offset:2048
  s_waitcnt lgkmcnt(5)
  s_getpc_b64 s[98:99]
  s_add_u32 s98, s98, 4096
  s_addc_u32 s99, s99, 0
  global_load_dword v7, v6, s[98:99]
  v_mfma_f32_16x16x32_bf16 v[56:59], v[24:27], v[120:123], 0
  ds_read_b128 v[48:51], v251 offset:0
  v_mfma_f32_16x16x32_bf16 v[64:67], v[24:27], v[152:155], 0
  v_mfma_f32_16x16x32_bf16 v[72:75], v[24:27], v[184:187], 0
  s_add_u32 m0, s29, 98304
  s_add_u32 s27, s28, 1572864
  buffer_load_dwordx4 v14, s[60:63], s27 offen lds
  v_mfma_f32_16x16x32_bf16 v[80:83], v[24:27], v[216:219], 0
  s_waitcnt lgkmcnt(5)
  v_mfma_f32_16x16x32_bf16 v[60:63], v[28:31], v[120:123], 0
  ds_read_b128 v[52:55], v251 offset:2048
  v_mfma_f32_16x16x32_bf16 v[68:71], v[28:31], v[152:155], 0
  v_mfma_f32_16x16x32_bf16 v[76:79], v[28:31], v[184:187], 0
  v_mfma_f32_16x16x32_bf16 v[84:87], v[28:31], v[216:219], 0
  s_waitcnt lgkmcnt(5)
  v_mfma_f32_16x16x32_bf16 v[56:59], v[32:35], v[124:127], v[56:59]
  ds_read_b128 v[24:27], v248 offset:256
  v_mfma_f32_16x16x32_bf16 v[64:67], v[32:35], v[156:159], v[64:67]
  v_mfma_f32_16x16x32_bf16 v[72:75], v[32:35], v[188:191], v[72:75]
  s_add_u32 m0, s29, 99328
  s_add_u32 s27, s28, 1589248
  buffer_load_dwordx4 v15, s[60:63], s27 offen lds
  v_mfma_f32_16x16x32_bf16 v[80:83], v[32:35], v[220:223], v[80:83]
  s_waitcnt lgkmcnt(5)
  v_mfma_f32_16x16x32_bf16 v[60:63], v[36:39], v[124:127], v[60:63]
  ds_read_b128 v[28:31], v248 offset:2304
  v_mfma_f32_16x16x32_bf16 v[68:71], v[36:39], v[156:159], v[68:71]
  v_mfma_f32_16x16x32_bf16 v[76:79], v[36:39], v[188:191], v[76:79]
  v_mfma_f32_16x16x32_bf16 v[84:87], v[36:39], v[220:223], v[84:87]
  s_waitcnt lgkmcnt(5)
  v_mfma_f32_16x16x32_bf16 v[56:59], v[40:43], v[128:131], v[56:59]
  ds_read_b128 v[32:35], v249 offset:256
  v_mfma_f32_16x16x32_bf16 v[64:67], v[40:43], v[160:163], v[64:67]
  v_mfma_f32_16x16x32_bf16 v[72:75], v[40:43], v[192:195], v[72:75]
  s_add_u32 m0, s29, 100352
  s_add_u32 s27, s28, 1605632
  buffer_load_dwordx4 v14, s[60:63], s27 offen lds
  v_mfma_f32_16x16x32_bf16 v[80:83], v[40:43], v[224:227], v[80:83]
  s_waitcnt lgkmcnt(5)
  v_mfma_f32_16x16x32_bf16 v[60:63], v[44:47], v[128:131], v[60:63]
  ds_read_b128 v[36:39], v249 offset:2304
  v_mfma_f32_16x16x32_bf16 v[68:71], v[44:47], v[160:163], v[68:71]
  v_mfma_f32_16x16x32_bf16 v[76:79], v[44:47], v[192:195], v[76:79]
  v_mfma_f32_16x16x32_bf16 v[84:87], v[44:47], v[224:227], v[84:87]
  s_waitcnt lgkmcnt(5)
  v_mfma_f32_16x16x32_bf16 v[56:59], v[48:51], v[132:135], v[56:59]
  ds_read_b128 v[40:43], v250 offset:256
  v_mfma_f32_16x16x32_bf16 v[64:67], v[48:51], v[164:167], v[64:67]
  v_mfma_f32_16x16x32_bf16 v[72:75], v[48:51], v[196:199], v[72:75]
  s_add_u32 m0, s29, 101376
  s_add_u32 s27, s28, 1622016
  buffer_load_dwordx4 v15, s[60:63], s27 offen lds
  v_mfma_f32_16x16x32_bf16 v[80:83], v[48:51], v[228:231], v[80:83]
  s_waitcnt lgkmcnt(5)
  v_mfma_f32_16x16x32_bf16 v[60:63], v[52:55], v[132:135], v[60:63]
  ds_read_b128 v[44:47], v250 offset:2304
  v_mfma_f32_16x16x32_bf16 v[68:71], v[52:55], v[164:167], v[68:71]
  v_mfma_f32_16x16x32_bf16 v[76:79], v[52:55], v[196:199], v[76:79]
  v_mfma_f32_16x16x32_bf16 v[84:87], v[52:55], v[228:231], v[84:87]
  s_waitcnt lgkmcnt(5)
  v_mfma_f32_16x16x32_bf16 v[56:59], v[24:27], v[136:139], v[56:59]
  ds_read_b128 v[48:51], v251 offset:256
  v_mfma_f32_16x16x32_bf16 v[64:67], v[24:27], v[168:171], v[64:67]
  v_mfma_f32_16x16x32_bf16 v[72:75], v[24:27], v[200:203], v[72:75]
  v_mfma_f32_16x16x32_bf16 v[80:83], v[24:27], v[232:235], v[80:83]
  s_waitcnt lgkmcnt(5)
  v_mfma_f32_16x16x32_bf16 v[60:63], v[28:31], v[136:139], v[60:63]
  ds_read_b128 v[52:55], v251 offset:2304
  v_mfma_f32_16x16x32_bf16 v[68:71], v[28:31], v[168:171], v[68:71]
  v_mfma_f32_16x16x32_bf16 v[76:79], v[28:31], v[200:203], v[76:79]
  v_mfma_f32_16x16x32_bf16 v[84:87], v[28:31], v[232:235], v[84:87]
  s_waitcnt lgkmcnt(5)
  v_mfma_f32_16x16x32_bf16 v[56:59], v[32:35], v[140:143], v[56:59]
  s_waitcnt vmcnt(20)
  s_barrier
  ds_read_b128 v[24:27], v248 offset:16384
  v_mfma_f32_16x16x32_bf16 v[64:67], v[32:35], v[172:175], v[64:67]
  v_mfma_f32_16x16x32_bf16 v[72:75], v[32:35], v[204:207], v[72:75]
  v_mfma_f32_16x16x32_bf16 v[80:83], v[32:35], v[236:239], v[80:83]
  s_waitcnt lgkmcnt(5)
  v_mfma_f32_16x16x32_bf16 v[60:63], v[36:39], v[140:143], v[60:63]
  ds_read_b128 v[28:31], v248 offset:18432
  v_mfma_f32_16x16x32_bf16 v[68:71], v[36:39], v[172:175], v[68:71]
  v_mfma_f32_16x16x32_bf16 v[76:79], v[36:39], v[204:207], v[76:79]
  v_mfma_f32_16x16x32_bf16 v[84:87], v[36:39], v[236:239], v[84:87]
  s_waitcnt lgkmcnt(5)
  v_mfma_f32_16x16x32_bf16 v[56:59], v[40:43], v[144:147], v[56:59]
  ds_read_b128 v[32:35], v249 offset:16384
  v_mfma_f32_16x16x32_bf16 v[64:67], v[40:43], v[176:179], v[64:67]
  v_mfma_f32_16x16x32_bf16 v[72:75], v[40:43], v[208:211], v[72:75]
  v_mfma_f32_16x16x32_bf16 v[80:83], v[40:43], v[240:243], v[80:83]
  s_waitcnt lgkmcnt(5)
  v_mfma_f32_16x16x32_bf16 v[60:63], v[44:47], v[144:147], v[60:63]
  ds_read_b128 v[36:39], v249 offset:18432
  v_mfma_f32_16x16x32_bf16 v[68:71], v[44:47], v[176:179], v[68:71]
  v_mfma_f32_16x16x32_bf16 v[76:79], v[44:47], v[208:211], v[76:79]
  v_mfma_f32_16x16x32_bf16 v[84:87], v[44:47], v[240:243], v[84:87]
  s_waitcnt lgkmcnt(5)
  v_mfma_f32_16x16x32_bf16 v[56:59], v[48:51], v[148:151], v[56:59]
  ds_read_b128 v[40:43], v250 offset:16384
  v_mfma_f32_16x16x32_bf16 v[64:67], v[48:51], v[180:183], v[64:67]
  v_mfma_f32_16x16x32_bf16 v[72:75], v[48:51], v[212:215], v[72:75]
  v_mfma_f32_16x16x32_bf16 v[80:83], v[48:51], v[244:247], v[80:83]
  s_waitcnt lgkmcnt(5)
  v_mfma_f32_16x16x32_bf16 v[60:63], v[52:55], v[148:151], v[60:63]
  ds_read_b128 v[44:47], v250 offset:18432
  v_mfma_f32_16x16x32_bf16 v[68:71], v[52:55], v[180:183], v[68:71]
  v_mfma_f32_16x16x32_bf16 v[76:79], v[52:55], v[212:215], v[76:79]
  v_mfma_f32_16x16x32_bf16 v[84:87], v[52:55], v[244:247], v[84:87]
  s_waitcnt lgkmcnt(5)
  v_mfma_f32_16x16x32_bf16 v[88:91], v[24:27], v[120:123], 0
  ds_read_b128 v[48:51], v251 offset:16384
  v_mfma_f32_16x16x32_bf16 v[96:99], v[24:27], v[152:155], 0
  v_mfma_f32_16x16x32_bf16 v[104:107], v[24:27], v[184:187], 0
  s_add_u32 m0, s29, 114688
  s_add_u32 s27, s28, 1835008
  buffer_load_dwordx4 v14, s[60:63], s27 offen lds
  v_mfma_f32_16x16x32_bf16 v[112:115], v[24:27], v[216:219], 0
  s_waitcnt lgkmcnt(5)
  v_mul_f32 v56, v12, v56
  v_mfma_f32_16x16x32_bf16 v[92:95], v[28:31], v[120:123], 0
  ds_read_b128 v[52:55], v251 offset:18432
  v_mul_f32 v57, v12, v57
  v_mfma_f32_16x16x32_bf16 v[100:103], v[28:31], v[152:155], 0
  v_mul_f32 v58, v12, v58
  v_mul_f32 v59, v12, v59
  v_mfma_f32_16x16x32_bf16 v[108:111], v[28:31], v[184:187], 0
  v_mul_f32 v60, v12, v60
  v_mfma_f32_16x16x32_bf16 v[116:119], v[28:31], v[216:219], 0
  s_waitcnt lgkmcnt(5)
  v_mul_f32 v61, v12, v61
  v_mfma_f32_16x16x32_bf16 v[88:91], v[32:35], v[124:127], v[88:91]
  ds_read_b128 v[24:27], v248 offset:16640
  v_mul_f32 v62, v12, v62
  v_mfma_f32_16x16x32_bf16 v[96:99], v[32:35], v[156:159], v[96:99]
  v_mul_f32 v63, v12, v63
  v_cvt_pk_bf16_f32 v56, v56, v57
  v_mfma_f32_16x16x32_bf16 v[104:107], v[32:35], v[188:191], v[104:107]
  s_add_u32 m0, s29, 115712
  s_add_u32 s27, s28, 1851392
  buffer_load_dwordx4 v15, s[60:63], s27 offen lds
  v_mfma_f32_16x16x32_bf16 v[112:115], v[32:35], v[220:223], v[112:115]
  s_waitcnt lgkmcnt(5)
  v_cvt_pk_bf16_f32 v57, v58, v59
  v_mfma_f32_16x16x32_bf16 v[92:95], v[36:39], v[124:127], v[92:95]
  ds_read_b128 v[28:31], v248 offset:18688
  v_cvt_pk_bf16_f32 v58, v60, v61
  v_mfma_f32_16x16x32_bf16 v[100:103], v[36:39], v[156:159], v[100:103]
  v_cvt_pk_bf16_f32 v59, v62, v63
  v_accvgpr_write_b32 a0, v56
  v_mfma_f32_16x16x32_bf16 v[108:111], v[36:39], v[188:191], v[108:111]
  v_accvgpr_write_b32 a1, v57
  v_mfma_f32_16x16x32_bf16 v[116:119], v[36:39], v[220:223], v[116:119]
  s_waitcnt lgkmcnt(5)
  v_accvgpr_write_b32 a2, v58
  v_mfma_f32_16x16x32_bf16 v[88:91], v[40:43], v[128:131], v[88:91]
  ds_read_b128 v[32:35], v249 offset:16640
  v_accvgpr_write_b32 a3, v59
  v_mfma_f32_16x16x32_bf16 v[96:99], v[40:43], v[160:163], v[96:99]
  v_mul_f32 v64, v12, v64
  v_mul_f32 v65, v12, v65
  v_mfma_f32_16x16x32_bf16 v[104:107], v[40:43], v[192:195], v[104:107]
  s_add_u32 m0, s29, 116736
  s_add_u32 s27, s28, 1867776
  buffer_load_dwordx4 v14, s[60:63], s27 offen lds
  v_mfma_f32_16x16x32_bf16 v[112:115], v[40:43], v[224:227], v[112:115]
  s_waitcnt lgkmcnt(5)
  v_mul_f32 v66, v12, v66
  v_mfma_f32_16x16x32_bf16 v[92:95], v[44:47], v[128:131], v[92:95]
  ds_read_b128 v[36:39], v249 offset:18688
  v_mul_f32 v67, v12, v67
  v_mfma_f32_16x16x32_bf16 v[100:103], v[44:47], v[160:163], v[100:103]
  v_mul_f32 v68, v12, v68
  v_mul_f32 v69, v12, v69
  v_mfma_f32_16x16x32_bf16 v[108:111], v[44:47], v[192:195], v[108:111]
  v_mul_f32 v70, v12, v70
  v_mfma_f32_16x16x32_bf16 v[116:119], v[44:47], v[224:227], v[116:119]
  s_waitcnt lgkmcnt(5)
  v_mul_f32 v71, v12, v71
  v_mfma_f32_16x16x32_bf16 v[88:91], v[48:51], v[132:135], v[88:91]
  ds_read_b128 v[40:43], v250 offset:16640
  v_cvt_pk_bf16_f32 v64, v64, v65
  v_mfma_f32_16x16x32_bf16 v[96:99], v[48:51], v[164:167], v[96:99]
  v_cvt_pk_bf16_f32 v65, v66, v67
  v_cvt_pk_bf16_f32 v66, v68, v69
  v_mfma_f32_16x16x32_bf16 v[104:107], v[48:51], v[196:199], v[104:107]
  s_add_u32 m0, s29, 117760
  s_add_u32 s27, s28, 1884160
  buffer_load_dwordx4 v15, s[60:63], s27 offen lds
  v_mfma_f32_16x16x32_bf16 v[112:115], v[48:51], v[228:231], v[112:115]
  s_waitcnt lgkmcnt(5)
  v_cvt_pk_bf16_f32 v67, v70, v71
  v_mfma_f32_16x16x32_bf16 v[92:95], v[52:55], v[132:135], v[92:95]
  ds_read_b128 v[44:47], v250 offset:18688
  v_accvgpr_write_b32 a56, v64
  v_mfma_f32_16x16x32_bf16 v[100:103], v[52:55], v[164:167], v[100:103]
  v_accvgpr_write_b32 a57, v65
  v_accvgpr_write_b32 a58, v66
  v_mfma_f32_16x16x32_bf16 v[108:111], v[52:55], v[196:199], v[108:111]
  v_accvgpr_write_b32 a59, v67
  v_mfma_f32_16x16x32_bf16 v[116:119], v[52:55], v[228:231], v[116:119]
  s_waitcnt lgkmcnt(5)
  v_mul_f32 v72, v12, v72
  v_mfma_f32_16x16x32_bf16 v[88:91], v[24:27], v[136:139], v[88:91]
  ds_read_b128 v[48:51], v251 offset:16640
  v_mul_f32 v73, v12, v73
  v_mfma_f32_16x16x32_bf16 v[96:99], v[24:27], v[168:171], v[96:99]
  v_mul_f32 v74, v12, v74
  v_mul_f32 v75, v12, v75
  v_mfma_f32_16x16x32_bf16 v[104:107], v[24:27], v[200:203], v[104:107]
  v_mul_f32 v76, v12, v76
  v_mfma_f32_16x16x32_bf16 v[112:115], v[24:27], v[232:235], v[112:115]
  s_waitcnt lgkmcnt(5)
  v_mul_f32 v77, v12, v77
  v_mfma_f32_16x16x32_bf16 v[92:95], v[28:31], v[136:139], v[92:95]
  ds_read_b128 v[52:55], v251 offset:18688
  v_mul_f32 v78, v12, v78
  v_mfma_f32_16x16x32_bf16 v[100:103], v[28:31], v[168:171], v[100:103]
  v_mul_f32 v79, v12, v79
  v_cvt_pk_bf16_f32 v72, v72, v73
  v_mfma_f32_16x16x32_bf16 v[108:111], v[28:31], v[200:203], v[108:111]
  v_cvt_pk_bf16_f32 v73, v74, v75
  v_mfma_f32_16x16x32_bf16 v[116:119], v[28:31], v[232:235], v[116:119]
  s_waitcnt lgkmcnt(5)
  v_cvt_pk_bf16_f32 v74, v76, v77
  v_mfma_f32_16x16x32_bf16 v[88:91], v[32:35], v[140:143], v[88:91]
  s_waitcnt vmcnt(20)
  s_barrier
  ds_read_b128 v[24:27], v248 offset:32768
  v_cvt_pk_bf16_f32 v75, v78, v79
  v_mfma_f32_16x16x32_bf16 v[96:99], v[32:35], v[172:175], v[96:99]
  v_accvgpr_write_b32 a112, v72
  v_accvgpr_write_b32 a113, v73
  v_mfma_f32_16x16x32_bf16 v[104:107], v[32:35], v[204:207], v[104:107]
  v_accvgpr_write_b32 a114, v74
  v_mfma_f32_16x16x32_bf16 v[112:115], v[32:35], v[236:239], v[112:115]
  s_waitcnt lgkmcnt(5)
  v_accvgpr_write_b32 a115, v75
  v_mfma_f32_16x16x32_bf16 v[92:95], v[36:39], v[140:143], v[92:95]
  ds_read_b128 v[28:31], v248 offset:34816
  v_mul_f32 v80, v12, v80
  v_mfma_f32_16x16x32_bf16 v[100:103], v[36:39], v[172:175], v[100:103]
  v_mul_f32 v81, v12, v81
  v_mul_f32 v82, v12, v82
  v_mfma_f32_16x16x32_bf16 v[108:111], v[36:39], v[204:207], v[108:111]
  v_mul_f32 v83, v12, v83
  v_mfma_f32_16x16x32_bf16 v[116:119], v[36:39], v[236:239], v[116:119]
  s_waitcnt lgkmcnt(5)
  v_mul_f32 v84, v12, v84
  v_mfma_f32_16x16x32_bf16 v[88:91], v[40:43], v[144:147], v[88:91]
  ds_read_b128 v[32:35], v249 offset:32768
  v_mul_f32 v85, v12, v85
  v_mfma_f32_16x16x32_bf16 v[96:99], v[40:43], v[176:179], v[96:99]
  v_mul_f32 v86, v12, v86
  v_mul_f32 v87, v12, v87
  v_mfma_f32_16x16x32_bf16 v[104:107], v[40:43], v[208:211], v[104:107]
  v_cvt_pk_bf16_f32 v80, v80, v81
  v_mfma_f32_16x16x32_bf16 v[112:115], v[40:43], v[240:243], v[112:115]
  s_waitcnt lgkmcnt(5)
  v_cvt_pk_bf16_f32 v81, v82, v83
  v_mfma_f32_16x16x32_bf16 v[92:95], v[44:47], v[144:147], v[92:95]
  ds_read_b128 v[36:39], v249 offset:34816
  v_cvt_pk_bf16_f32 v82, v84, v85
  v_mfma_f32_16x16x32_bf16 v[100:103], v[44:47], v[176:179], v[100:103]
  v_cvt_pk_bf16_f32 v83, v86, v87
  v_accvgpr_write_b32 a168, v80
  v_mfma_f32_16x16x32_bf16 v[108:111], v[44:47], v[208:211], v[108:111]
  v_accvgpr_write_b32 a169, v81
  v_mfma_f32_16x16x32_bf16 v[116:119], v[44:47], v[240:243], v[116:119]
  s_waitcnt lgkmcnt(5)
  v_accvgpr_write_b32 a170, v82
  v_mfma_f32_16x16x32_bf16 v[88:91], v[48:51], v[148:151], v[88:91]
  ds_read_b128 v[40:43], v250 offset:32768
  v_accvgpr_write_b32 a171, v83
  v_mfma_f32_16x16x32_bf16 v[96:99], v[48:51], v[180:183], v[96:99]
  v_mfma_f32_16x16x32_bf16 v[104:107], v[48:51], v[212:215], v[104:107]
  v_mfma_f32_16x16x32_bf16 v[112:115], v[48:51], v[244:247], v[112:115]
  s_waitcnt lgkmcnt(5)
  v_mfma_f32_16x16x32_bf16 v[92:95], v[52:55], v[148:151], v[92:95]
  ds_read_b128 v[44:47], v250 offset:34816
  v_mfma_f32_16x16x32_bf16 v[100:103], v[52:55], v[180:183], v[100:103]
  v_mfma_f32_16x16x32_bf16 v[108:111], v[52:55], v[212:215], v[108:111]
  v_mfma_f32_16x16x32_bf16 v[116:119], v[52:55], v[244:247], v[116:119]
  s_waitcnt lgkmcnt(5)
  v_mfma_f32_16x16x32_bf16 v[56:59], v[24:27], v[120:123], 0
  ds_read_b128 v[48:51], v251 offset:32768
  v_mfma_f32_16x16x32_bf16 v[64:67], v[24:27], v[152:155], 0
  v_mfma_f32_16x16x32_bf16 v[72:75], v[24:27], v[184:187], 0
  s_add_u32 m0, s29, 131072
  s_add_u32 s27, s28, 2097152
  buffer_load_dwordx4 v14, s[60:63], s27 offen lds
  v_mfma_f32_16x16x32_bf16 v[80:83], v[24:27], v[216:219], 0
  s_waitcnt lgkmcnt(5)
  v_mul_f32 v88, v12, v88
  v_mfma_f32_16x16x32_bf16 v[60:63], v[28:31], v[120:123], 0
  ds_read_b128 v[52:55], v251 offset:34816
  v_mul_f32 v89, v12, v89
  v_mfma_f32_16x16x32_bf16 v[68:71], v[28:31], v[152:155], 0
  v_mul_f32 v90, v12, v90
  v_mul_f32 v91, v12, v91
  v_mfma_f32_16x16x32_bf16 v[76:79], v[28:31], v[184:187], 0
  v_mul_f32 v92, v12, v92
  v_mfma_f32_16x16x32_bf16 v[84:87], v[28:31], v[216:219], 0
  s_waitcnt lgkmcnt(5)
  v_mul_f32 v93, v12, v93
  v_mfma_f32_16x16x32_bf16 v[56:59], v[32:35], v[124:127], v[56:59]
  ds_read_b128 v[24:27], v248 offset:33024
  v_mul_f32 v94, v12, v94
  v_mfma_f32_16x16x32_bf16 v[64:67], v[32:35], v[156:159], v[64:67]
  v_mul_f32 v95, v12, v95
  v_cvt_pk_bf16_f32 v88, v88, v89
  v_mfma_f32_16x16x32_bf16 v[72:75], v[32:35], v[188:191], v[72:75]
  s_add_u32 m0, s29, 132096
  s_add_u32 s27, s28, 2113536
  buffer_load_dwordx4 v15, s[60:63], s27 offen lds
  v_mfma_f32_16x16x32_bf16 v[80:83], v[32:35], v[220:223], v[80:83]
  s_waitcnt lgkmcnt(5)
  v_cvt_pk_bf16_f32 v89, v90, v91
  v_mfma_f32_16x16x32_bf16 v[60:63], v[36:39], v[124:127], v[60:63]
  ds_read_b128 v[28:31], v248 offset:35072
  v_cvt_pk_bf16_f32 v90, v92, v93
  v_mfma_f32_16x16x32_bf16 v[68:71], v[36:39], v[156:159], v[68:71]
  v_cvt_pk_bf16_f32 v91, v94, v95
  v_accvgpr_write_b32 a4, v88
  v_mfma_f32_16x16x32_bf16 v[76:79], v[36:39], v[188:191], v[76:79]
  v_accvgpr_write_b32 a5, v89
  v_mfma_f32_16x16x32_bf16 v[84:87], v[36:39], v[220:223], v[84:87]
  s_waitcnt lgkmcnt(5)
  v_accvgpr_write_b32 a6, v90
  v_mfma_f32_16x16x32_bf16 v[56:59], v[40:43], v[128:131], v[56:59]
  ds_read_b128 v[32:35], v249 offset:33024
  v_accvgpr_write_b32 a7, v91
  v_mfma_f32_16x16x32_bf16 v[64:67], v[40:43], v[160:163], v[64:67]
  v_mul_f32 v96, v12, v96
  v_mul_f32 v97, v12, v97
  v_mfma_f32_16x16x32_bf16 v[72:75], v[40:43], v[192:195], v[72:75]
  s_add_u32 m0, s29, 133120
  s_add_u32 s27, s28, 2129920
  buffer_load_dwordx4 v14, s[60:63], s27 offen lds
  v_mfma_f32_16x16x32_bf16 v[80:83], v[40:43], v[224:227], v[80:83]
  s_waitcnt lgkmcnt(5)
  v_mul_f32 v98, v12, v98
  v_mfma_f32_16x16x32_bf16 v[60:63], v[44:47], v[128:131], v[60:63]
  ds_read_b128 v[36:39], v249 offset:35072
  v_mul_f32 v99, v12, v99
  v_mfma_f32_16x16x32_bf16 v[68:71], v[44:47], v[160:163], v[68:71]
  v_mul_f32 v100, v12, v100
  v_mul_f32 v101, v12, v101
  v_mfma_f32_16x16x32_bf16 v[76:79], v[44:47], v[192:195], v[76:79]
  v_mul_f32 v102, v12, v102
  v_mfma_f32_16x16x32_bf16 v[84:87], v[44:47], v[224:227], v[84:87]
  s_waitcnt lgkmcnt(5)
  v_mul_f32 v103, v12, v103
  v_mfma_f32_16x16x32_bf16 v[56:59], v[48:51], v[132:135], v[56:59]
  ds_read_b128 v[40:43], v250 offset:33024
  v_cvt_pk_bf16_f32 v96, v96, v97
  v_mfma_f32_16x16x32_bf16 v[64:67], v[48:51], v[164:167], v[64:67]
  v_cvt_pk_bf16_f32 v97, v98, v99
  v_cvt_pk_bf16_f32 v98, v100, v101
  v_mfma_f32_16x16x32_bf16 v[72:75], v[48:51], v[196:199], v[72:75]
  s_add_u32 m0, s29, 134144
  s_add_u32 s27, s28, 2146304
  buffer_load_dwordx4 v15, s[60:63], s27 offen lds
  v_mfma_f32_16x16x32_bf16 v[80:83], v[48:51], v[228:231], v[80:83]
  s_waitcnt lgkmcnt(5)
  v_cvt_pk_bf16_f32 v99, v102, v103
  v_mfma_f32_16x16x32_bf16 v[60:63], v[52:55], v[132:135], v[60:63]
  ds_read_b128 v[44:47], v250 offset:35072
  v_accvgpr_write_b32 a60, v96
  v_mfma_f32_16x16x32_bf16 v[68:71], v[52:55], v[164:167], v[68:71]
  v_accvgpr_write_b32 a61, v97
  v_accvgpr_write_b32 a62, v98
  v_mfma_f32_16x16x32_bf16 v[76:79], v[52:55], v[196:199], v[76:79]
  v_accvgpr_write_b32 a63, v99
  v_mfma_f32_16x16x32_bf16 v[84:87], v[52:55], v[228:231], v[84:87]
  s_waitcnt lgkmcnt(5)
  v_mul_f32 v104, v12, v104
  v_mfma_f32_16x16x32_bf16 v[56:59], v[24:27], v[136:139], v[56:59]
  ds_read_b128 v[48:51], v251 offset:33024
  v_mul_f32 v105, v12, v105
  v_mfma_f32_16x16x32_bf16 v[64:67], v[24:27], v[168:171], v[64:67]
  v_mul_f32 v106, v12, v106
  v_mul_f32 v107, v12, v107
  v_mfma_f32_16x16x32_bf16 v[72:75], v[24:27], v[200:203], v[72:75]
  v_mul_f32 v108, v12, v108
  v_mfma_f32_16x16x32_bf16 v[80:83], v[24:27], v[232:235], v[80:83]
  s_waitcnt lgkmcnt(5)
  v_mul_f32 v109, v12, v109
  v_mfma_f32_16x16x32_bf16 v[60:63], v[28:31], v[136:139], v[60:63]
  ds_read_b128 v[52:55], v251 offset:35072
  v_mul_f32 v110, v12, v110
  v_mfma_f32_16x16x32_bf16 v[68:71], v[28:31], v[168:171], v[68:71]
  v_mul_f32 v111, v12, v111
  v_cvt_pk_bf16_f32 v104, v104, v105
  v_mfma_f32_16x16x32_bf16 v[76:79], v[28:31], v[200:203], v[76:79]
  v_cvt_pk_bf16_f32 v105, v106, v107
  v_mfma_f32_16x16x32_bf16 v[84:87], v[28:31], v[232:235], v[84:87]
  s_waitcnt lgkmcnt(5)
  v_cvt_pk_bf16_f32 v106, v108, v109
  v_mfma_f32_16x16x32_bf16 v[56:59], v[32:35], v[140:143], v[56:59]
  s_waitcnt vmcnt(20)
  s_barrier
  ds_read_b128 v[24:27], v248 offset:49152
  v_cvt_pk_bf16_f32 v107, v110, v111
  v_mfma_f32_16x16x32_bf16 v[64:67], v[32:35], v[172:175], v[64:67]
  v_accvgpr_write_b32 a116, v104
  v_accvgpr_write_b32 a117, v105
  v_mfma_f32_16x16x32_bf16 v[72:75], v[32:35], v[204:207], v[72:75]
  v_accvgpr_write_b32 a118, v106
  v_mfma_f32_16x16x32_bf16 v[80:83], v[32:35], v[236:239], v[80:83]
  s_waitcnt lgkmcnt(5)
  v_accvgpr_write_b32 a119, v107
  v_mfma_f32_16x16x32_bf16 v[60:63], v[36:39], v[140:143], v[60:63]
  ds_read_b128 v[28:31], v248 offset:51200
  v_mul_f32 v112, v12, v112
  v_mfma_f32_16x16x32_bf16 v[68:71], v[36:39], v[172:175], v[68:71]
  v_mul_f32 v113, v12, v113
  v_mul_f32 v114, v12, v114
  v_mfma_f32_16x16x32_bf16 v[76:79], v[36:39], v[204:207], v[76:79]
  v_mul_f32 v115, v12, v115
  v_mfma_f32_16x16x32_bf16 v[84:87], v[36:39], v[236:239], v[84:87]
  s_waitcnt lgkmcnt(5)
  v_mul_f32 v116, v12, v116
  v_mfma_f32_16x16x32_bf16 v[56:59], v[40:43], v[144:147], v[56:59]
  ds_read_b128 v[32:35], v249 offset:49152
  v_mul_f32 v117, v12, v117
  v_mfma_f32_16x16x32_bf16 v[64:67], v[40:43], v[176:179], v[64:67]
  v_mul_f32 v118, v12, v118
  v_mul_f32 v119, v12, v119
  v_mfma_f32_16x16x32_bf16 v[72:75], v[40:43], v[208:211], v[72:75]
  v_cvt_pk_bf16_f32 v112, v112, v113
  v_mfma_f32_16x16x32_bf16 v[80:83], v[40:43], v[240:243], v[80:83]
  s_waitcnt lgkmcnt(5)
  v_cvt_pk_bf16_f32 v113, v114, v115
  v_mfma_f32_16x16x32_bf16 v[60:63], v[44:47], v[144:147], v[60:63]
  ds_read_b128 v[36:39], v249 offset:51200
  v_cvt_pk_bf16_f32 v114, v116, v117
  v_mfma_f32_16x16x32_bf16 v[68:71], v[44:47], v[176:179], v[68:71]
  v_cvt_pk_bf16_f32 v115, v118, v119
  v_accvgpr_write_b32 a172, v112
  v_mfma_f32_16x16x32_bf16 v[76:79], v[44:47], v[208:211], v[76:79]
  v_accvgpr_write_b32 a173, v113
  v_mfma_f32_16x16x32_bf16 v[84:87], v[44:47], v[240:243], v[84:87]
  s_waitcnt lgkmcnt(5)
  v_accvgpr_write_b32 a174, v114
  v_mfma_f32_16x16x32_bf16 v[56:59], v[48:51], v[148:151], v[56:59]
  ds_read_b128 v[40:43], v250 offset:49152
  v_accvgpr_write_b32 a175, v115
  v_mfma_f32_16x16x32_bf16 v[64:67], v[48:51], v[180:183], v[64:67]
  v_mfma_f32_16x16x32_bf16 v[72:75], v[48:51], v[212:215], v[72:75]
  v_mfma_f32_16x16x32_bf16 v[80:83], v[48:51], v[244:247], v[80:83]
  s_waitcnt lgkmcnt(5)
  v_mfma_f32_16x16x32_bf16 v[60:63], v[52:55], v[148:151], v[60:63]
  ds_read_b128 v[44:47], v250 offset:51200
  v_mfma_f32_16x16x32_bf16 v[68:71], v[52:55], v[180:183], v[68:71]
  v_mfma_f32_16x16x32_bf16 v[76:79], v[52:55], v[212:215], v[76:79]
  v_mfma_f32_16x16x32_bf16 v[84:87], v[52:55], v[244:247], v[84:87]
  s_waitcnt lgkmcnt(5)
  s_getpc_b64 s[98:99]
  s_add_u32 s98, s98, 4096
  s_addc_u32 s99, s99, 0
  global_load_dword v7, v6, s[98:99]
  v_mfma_f32_16x16x32_bf16 v[88:91], v[24:27], v[120:123], 0
  ds_read_b128 v[48:51], v251 offset:49152
  v_mfma_f32_16x16x32_bf16 v[96:99], v[24:27], v[152:155], 0
  v_mfma_f32_16x16x32_bf16 v[104:107], v[24:27], v[184:187], 0
  buffer_load_dword v13, off, s[12:15], 0 offset:128 sc1
  buffer_load_dword v9, off, s[12:15], 0 sc1
  s_add_u32 m0, s29, 147456
  s_add_u32 s27, s28, 2359296
  buffer_load_dwordx4 v14, s[60:63], s27 offen lds
  v_mfma_f32_16x16x32_bf16 v[112:115], v[24:27], v[216:219], 0
  s_waitcnt lgkmcnt(5)
  v_mul_f32 v56, v12, v56
  v_mfma_f32_16x16x32_bf16 v[92:95], v[28:31], v[120:123], 0
  ds_read_b128 v[52:55], v251 offset:51200
  v_mul_f32 v57, v12, v57
  v_mfma_f32_16x16x32_bf16 v[100:103], v[28:31], v[152:155], 0
  v_mul_f32 v58, v12, v58
  v_mul_f32 v59, v12, v59
  v_mfma_f32_16x16x32_bf16 v[108:111], v[28:31], v[184:187], 0
  v_mul_f32 v60, v12, v60
  v_mfma_f32_16x16x32_bf16 v[116:119], v[28:31], v[216:219], 0
  s_waitcnt lgkmcnt(5)
  v_mul_f32 v61, v12, v61
  v_mfma_f32_16x16x32_bf16 v[88:91], v[32:35], v[124:127], v[88:91]
  ds_read_b128 v[24:27], v248 offset:49408
  v_mul_f32 v62, v12, v62
  v_mfma_f32_16x16x32_bf16 v[96:99], v[32:35], v[156:159], v[96:99]
  v_mul_f32 v63, v12, v63
  v_cvt_pk_bf16_f32 v56, v56, v57
  v_mfma_f32_16x16x32_bf16 v[104:107], v[32:35], v[188:191], v[104:107]
  s_add_u32 m0, s29, 148480
  s_add_u32 s27, s28, 2375680
  buffer_load_dwordx4 v15, s[60:63], s27 offen lds
  v_mfma_f32_16x16x32_bf16 v[112:115], v[32:35], v[220:223], v[112:115]
  s_waitcnt lgkmcnt(5)
  v_cvt_pk_bf16_f32 v57, v58, v59
  v_mfma_f32_16x16x32_bf16 v[92:95], v[36:39], v[124:127], v[92:95]
  ds_read_b128 v[28:31], v248 offset:51456
  v_cvt_pk_bf16_f32 v58, v60, v61
  v_mfma_f32_16x16x32_bf16 v[100:103], v[36:39], v[156:159], v[100:103]
  v_cvt_pk_bf16_f32 v59, v62, v63
  v_accvgpr_write_b32 a8, v56
  v_mfma_f32_16x16x32_bf16 v[108:111], v[36:39], v[188:191], v[108:111]
  v_accvgpr_write_b32 a9, v57
  v_mfma_f32_16x16x32_bf16 v[116:119], v[36:39], v[220:223], v[116:119]
  s_waitcnt lgkmcnt(5)
  v_accvgpr_write_b32 a10, v58
  v_mfma_f32_16x16x32_bf16 v[88:91], v[40:43], v[128:131], v[88:91]
  ds_read_b128 v[32:35], v249 offset:49408
  v_accvgpr_write_b32 a11, v59
  v_mfma_f32_16x16x32_bf16 v[96:99], v[40:43], v[160:163], v[96:99]
  v_mul_f32 v64, v12, v64
  v_mul_f32 v65, v12, v65
  v_mfma_f32_16x16x32_bf16 v[104:107], v[40:43], v[192:195], v[104:107]
  s_add_u32 m0, s29, 149504
  s_add_u32 s27, s28, 2392064
  buffer_load_dwordx4 v14, s[60:63], s27 offen lds
  v_mfma_f32_16x16x32_bf16 v[112:115], v[40:43], v[224:227], v[112:115]
  s_waitcnt lgkmcnt(5)
  v_mul_f32 v66, v12, v66
  v_mfma_f32_16x16x32_bf16 v[92:95], v[44:47], v[128:131], v[92:95]
  ds_read_b128 v[36:39], v249 offset:51456
  v_mul_f32 v67, v12, v67
  v_mfma_f32_16x16x32_bf16 v[100:103], v[44:47], v[160:163], v[100:103]
  v_mul_f32 v68, v12, v68
  v_mul_f32 v69, v12, v69
  v_mfma_f32_16x16x32_bf16 v[108:111], v[44:47], v[192:195], v[108:111]
  v_mul_f32 v70, v12, v70
  v_mfma_f32_16x16x32_bf16 v[116:119], v[44:47], v[224:227], v[116:119]
  s_waitcnt lgkmcnt(5)
  v_mul_f32 v71, v12, v71
  v_mfma_f32_16x16x32_bf16 v[88:91], v[48:51], v[132:135], v[88:91]
  ds_read_b128 v[40:43], v250 offset:49408
  v_cvt_pk_bf16_f32 v64, v64, v65
  v_mfma_f32_16x16x32_bf16 v[96:99], v[48:51], v[164:167], v[96:99]
  v_cvt_pk_bf16_f32 v65, v66, v67
  v_cvt_pk_bf16_f32 v66, v68, v69
  v_mfma_f32_16x16x32_bf16 v[104:107], v[48:51], v[196:199], v[104:107]
  s_add_u32 m0, s29, 150528
  s_add_u32 s27, s28, 2408448
  buffer_load_dwordx4 v15, s[60:63], s27 offen lds
  v_mfma_f32_16x16x32_bf16 v[112:115], v[48:51], v[228:231], v[112:115]
  s_waitcnt lgkmcnt(5)
  v_cvt_pk_bf16_f32 v67, v70, v71
  v_mfma_f32_16x16x32_bf16 v[92:95], v[52:55], v[132:135], v[92:95]
  ds_read_b128 v[44:47], v250 offset:51456
  v_accvgpr_write_b32 a64, v64
  v_mfma_f32_16x16x32_bf16 v[100:103], v[52:55], v[164:167], v[100:103]
  v_accvgpr_write_b32 a65, v65
  v_accvgpr_write_b32 a66, v66
  v_mfma_f32_16x16x32_bf16 v[108:111], v[52:55], v[196:199], v[108:111]
  v_accvgpr_write_b32 a67, v67
  v_mfma_f32_16x16x32_bf16 v[116:119], v[52:55], v[228:231], v[116:119]
  s_waitcnt lgkmcnt(5)
  v_mul_f32 v72, v12, v72
  v_mfma_f32_16x16x32_bf16 v[88:91], v[24:27], v[136:139], v[88:91]
  ds_read_b128 v[48:51], v251 offset:49408
  v_mul_f32 v73, v12, v73
  v_mfma_f32_16x16x32_bf16 v[96:99], v[24:27], v[168:171], v[96:99]
  v_mul_f32 v74, v12, v74
  v_mul_f32 v75, v12, v75
  v_mfma_f32_16x16x32_bf16 v[104:107], v[24:27], v[200:203], v[104:107]
  v_mul_f32 v76, v12, v76
  v_mfma_f32_16x16x32_bf16 v[112:115], v[24:27], v[232:235], v[112:115]
  s_waitcnt lgkmcnt(5)
  v_mul_f32 v77, v12, v77
  v_mfma_f32_16x16x32_bf16 v[92:95], v[28:31], v[136:139], v[92:95]
  ds_read_b128 v[52:55], v251 offset:51456
  v_mul_f32 v78, v12, v78
  v_mfma_f32_16x16x32_bf16 v[100:103], v[28:31], v[168:171], v[100:103]
  v_mul_f32 v79, v12, v79
  v_cvt_pk_bf16_f32 v72, v72, v73
  v_mfma_f32_16x16x32_bf16 v[108:111], v[28:31], v[200:203], v[108:111]
  v_cvt_pk_bf16_f32 v73, v74, v75
  v_mfma_f32_16x16x32_bf16 v[116:119], v[28:31], v[232:235], v[116:119]
  s_waitcnt lgkmcnt(5)
  v_cvt_pk_bf16_f32 v74, v76, v77
  v_mfma_f32_16x16x32_bf16 v[88:91], v[32:35], v[140:143], v[88:91]
  s_waitcnt vmcnt(20)
  s_barrier
  ds_read_b128 v[24:27], v252 offset:0
  v_cvt_pk_bf16_f32 v75, v78, v79
  v_mfma_f32_16x16x32_bf16 v[96:99], v[32:35], v[172:175], v[96:99]
  v_accvgpr_write_b32 a120, v72
  v_accvgpr_write_b32 a121, v73
  v_mfma_f32_16x16x32_bf16 v[104:107], v[32:35], v[204:207], v[104:107]
  v_accvgpr_write_b32 a122, v74
  v_mfma_f32_16x16x32_bf16 v[112:115], v[32:35], v[236:239], v[112:115]
  s_waitcnt lgkmcnt(5)
  v_accvgpr_write_b32 a123, v75
  v_mfma_f32_16x16x32_bf16 v[92:95], v[36:39], v[140:143], v[92:95]
  ds_read_b128 v[28:31], v252 offset:2048
  v_mul_f32 v80, v12, v80
  v_mfma_f32_16x16x32_bf16 v[100:103], v[36:39], v[172:175], v[100:103]
  v_mul_f32 v81, v12, v81
  v_mul_f32 v82, v12, v82
  v_mfma_f32_16x16x32_bf16 v[108:111], v[36:39], v[204:207], v[108:111]
  v_mul_f32 v83, v12, v83
  v_mfma_f32_16x16x32_bf16 v[116:119], v[36:39], v[236:239], v[116:119]
  s_waitcnt lgkmcnt(5)
  v_mul_f32 v84, v12, v84
  v_mfma_f32_16x16x32_bf16 v[88:91], v[40:43], v[144:147], v[88:91]
  ds_read_b128 v[32:35], v253 offset:0
  v_mul_f32 v85, v12, v85
  v_mfma_f32_16x16x32_bf16 v[96:99], v[40:43], v[176:179], v[96:99]
  v_mul_f32 v86, v12, v86
  v_mul_f32 v87, v12, v87
  v_mfma_f32_16x16x32_bf16 v[104:107], v[40:43], v[208:211], v[104:107]
  v_cvt_pk_bf16_f32 v80, v80, v81
  v_mfma_f32_16x16x32_bf16 v[112:115], v[40:43], v[240:243], v[112:115]
  s_waitcnt lgkmcnt(5)
  v_cvt_pk_bf16_f32 v81, v82, v83
  v_mfma_f32_16x16x32_bf16 v[92:95], v[44:47], v[144:147], v[92:95]
  ds_read_b128 v[36:39], v253 offset:2048
  v_cvt_pk_bf16_f32 v82, v84, v85
  v_mfma_f32_16x16x32_bf16 v[100:103], v[44:47], v[176:179], v[100:103]
  v_cvt_pk_bf16_f32 v83, v86, v87
  v_accvgpr_write_b32 a176, v80
  v_mfma_f32_16x16x32_bf16 v[108:111], v[44:47], v[208:211], v[108:111]
  v_accvgpr_write_b32 a177, v81
  v_mfma_f32_16x16x32_bf16 v[116:119], v[44:47], v[240:243], v[116:119]
  s_waitcnt lgkmcnt(5)
  v_accvgpr_write_b32 a178, v82
  v_mfma_f32_16x16x32_bf16 v[88:91], v[48:51], v[148:151], v[88:91]
  ds_read_b128 v[40:43], v254 offset:0
  v_accvgpr_write_b32 a179, v83
  v_mfma_f32_16x16x32_bf16 v[96:99], v[48:51], v[180:183], v[96:99]
  v_mfma_f32_16x16x32_bf16 v[104:107], v[48:51], v[212:215], v[104:107]
  v_mfma_f32_16x16x32_bf16 v[112:115], v[48:51], v[244:247], v[112:115]
  s_waitcnt lgkmcnt(5)
  v_mfma_f32_16x16x32_bf16 v[92:95], v[52:55], v[148:151], v[92:95]
  ds_read_b128 v[44:47], v254 offset:2048
  v_mfma_f32_16x16x32_bf16 v[100:103], v[52:55], v[180:183], v[100:103]
  v_mfma_f32_16x16x32_bf16 v[108:111], v[52:55], v[212:215], v[108:111]
  v_mfma_f32_16x16x32_bf16 v[116:119], v[52:55], v[244:247], v[116:119]
  s_waitcnt lgkmcnt(5)
  v_mfma_f32_16x16x32_bf16 v[56:59], v[24:27], v[120:123], 0
  ds_read_b128 v[48:51], v255 offset:0
  v_mfma_f32_16x16x32_bf16 v[64:67], v[24:27], v[152:155], 0
  v_mfma_f32_16x16x32_bf16 v[72:75], v[24:27], v[184:187], 0
  s_add_u32 m0, s29, 0
  s_add_u32 s27, s28, 2621440
  buffer_load_dwordx4 v14, s[60:63], s27 offen lds
  v_mfma_f32_16x16x32_bf16 v[80:83], v[24:27], v[216:219], 0
  s_waitcnt lgkmcnt(5)
  v_mul_f32 v88, v12, v88
  v_mfma_f32_16x16x32_bf16 v[60:63], v[28:31], v[120:123], 0
  ds_read_b128 v[52:55], v255 offset:2048
  v_mul_f32 v89, v12, v89
  v_mfma_f32_16x16x32_bf16 v[68:71], v[28:31], v[152:155], 0
  v_mul_f32 v90, v12, v90
  v_mul_f32 v91, v12, v91
  v_mfma_f32_16x16x32_bf16 v[76:79], v[28:31], v[184:187], 0
  v_mul_f32 v92, v12, v92
  v_mfma_f32_16x16x32_bf16 v[84:87], v[28:31], v[216:219], 0
  s_waitcnt lgkmcnt(5)
  v_mul_f32 v93, v12, v93
  v_mfma_f32_16x16x32_bf16 v[56:59], v[32:35], v[124:127], v[56:59]
  ds_read_b128 v[24:27], v252 offset:256
  v_mul_f32 v94, v12, v94
  v_mfma_f32_16x16x32_bf16 v[64:67], v[32:35], v[156:159], v[64:67]
  v_mul_f32 v95, v12, v95
  v_cvt_pk_bf16_f32 v88, v88, v89
  v_mfma_f32_16x16x32_bf16 v[72:75], v[32:35], v[188:191], v[72:75]
  s_add_u32 m0, s29, 1024
  s_add_u32 s27, s28, 2637824
  buffer_load_dwordx4 v15, s[60:63], s27 offen lds
  v_mfma_f32_16x16x32_bf16 v[80:83], v[32:35], v[220:223], v[80:83]
  s_waitcnt lgkmcnt(5)
  v_cvt_pk_bf16_f32 v89, v90, v91
  v_mfma_f32_16x16x32_bf16 v[60:63], v[36:39], v[124:127], v[60:63]
  ds_read_b128 v[28:31], v252 offset:2304
  v_cvt_pk_bf16_f32 v90, v92, v93
  v_mfma_f32_16x16x32_bf16 v[68:71], v[36:39], v[156:159], v[68:71]
  v_cvt_pk_bf16_f32 v91, v94, v95
  v_accvgpr_write_b32 a12, v88
  v_mfma_f32_16x16x32_bf16 v[76:79], v[36:39], v[188:191], v[76:79]
  v_accvgpr_write_b32 a13, v89
  v_mfma_f32_16x16x32_bf16 v[84:87], v[36:39], v[220:223], v[84:87]
  s_waitcnt lgkmcnt(5)
  v_accvgpr_write_b32 a14, v90
  v_mfma_f32_16x16x32_bf16 v[56:59], v[40:43], v[128:131], v[56:59]
  ds_read_b128 v[32:35], v253 offset:256
  v_accvgpr_write_b32 a15, v91
  v_mfma_f32_16x16x32_bf16 v[64:67], v[40:43], v[160:163], v[64:67]
  v_mul_f32 v96, v12, v96
  v_mul_f32 v97, v12, v97
  v_mfma_f32_16x16x32_bf16 v[72:75], v[40:43], v[192:195], v[72:75]
  s_add_u32 m0, s29, 2048
  s_add_u32 s27, s28, 2654208
  buffer_load_dwordx4 v14, s[60:63], s27 offen lds
  v_mfma_f32_16x16x32_bf16 v[80:83], v[40:43], v[224:227], v[80:83]
  s_waitcnt lgkmcnt(5)
  v_mul_f32 v98, v12, v98
  v_mfma_f32_16x16x32_bf16 v[60:63], v[44:47], v[128:131], v[60:63]
  ds_read_b128 v[36:39], v253 offset:2304
  v_mul_f32 v99, v12, v99
  v_mfma_f32_16x16x32_bf16 v[68:71], v[44:47], v[160:163], v[68:71]
  v_mul_f32 v100, v12, v100
  v_mul_f32 v101, v12, v101
  v_mfma_f32_16x16x32_bf16 v[76:79], v[44:47], v[192:195], v[76:79]
  v_mul_f32 v102, v12, v102
  v_mfma_f32_16x16x32_bf16 v[84:87], v[44:47], v[224:227], v[84:87]
  s_waitcnt lgkmcnt(5)
  v_mul_f32 v103, v12, v103
  v_mfma_f32_16x16x32_bf16 v[56:59], v[48:51], v[132:135], v[56:59]
  ds_read_b128 v[40:43], v254 offset:256
  v_cvt_pk_bf16_f32 v96, v96, v97
  v_mfma_f32_16x16x32_bf16 v[64:67], v[48:51], v[164:167], v[64:67]
  v_cvt_pk_bf16_f32 v97, v98, v99
  v_cvt_pk_bf16_f32 v98, v100, v101
  v_mfma_f32_16x16x32_bf16 v[72:75], v[48:51], v[196:199], v[72:75]
  s_add_u32 m0, s29, 3072
  s_add_u32 s27, s28, 2670592
  buffer_load_dwordx4 v15, s[60:63], s27 offen lds
  v_mfma_f32_16x16x32_bf16 v[80:83], v[48:51], v[228:231], v[80:83]
  s_waitcnt lgkmcnt(5)
  v_cvt_pk_bf16_f32 v99, v102, v103
  v_mfma_f32_16x16x32_bf16 v[60:63], v[52:55], v[132:135], v[60:63]
  ds_read_b128 v[44:47], v254 offset:2304
  v_accvgpr_write_b32 a68, v96
  v_mfma_f32_16x16x32_bf16 v[68:71], v[52:55], v[164:167], v[68:71]
  v_accvgpr_write_b32 a69, v97
  v_accvgpr_write_b32 a70, v98
  v_mfma_f32_16x16x32_bf16 v[76:79], v[52:55], v[196:199], v[76:79]
  v_accvgpr_write_b32 a71, v99
  v_mfma_f32_16x16x32_bf16 v[84:87], v[52:55], v[228:231], v[84:87]
  s_waitcnt lgkmcnt(5)
  v_mul_f32 v104, v12, v104
  v_mfma_f32_16x16x32_bf16 v[56:59], v[24:27], v[136:139], v[56:59]
  ds_read_b128 v[48:51], v255 offset:256
  v_mul_f32 v105, v12, v105
  v_mfma_f32_16x16x32_bf16 v[64:67], v[24:27], v[168:171], v[64:67]
  v_mul_f32 v106, v12, v106
  v_mul_f32 v107, v12, v107
  v_mfma_f32_16x16x32_bf16 v[72:75], v[24:27], v[200:203], v[72:75]
  v_mul_f32 v108, v12, v108
  v_mfma_f32_16x16x32_bf16 v[80:83], v[24:27], v[232:235], v[80:83]
  s_waitcnt lgkmcnt(5)
  v_mul_f32 v109, v12, v109
  v_mfma_f32_16x16x32_bf16 v[60:63], v[28:31], v[136:139], v[60:63]
  ds_read_b128 v[52:55], v255 offset:2304
  v_mul_f32 v110, v12, v110
  v_mfma_f32_16x16x32_bf16 v[68:71], v[28:31], v[168:171], v[68:71]
  v_mul_f32 v111, v12, v111
  v_cvt_pk_bf16_f32 v104, v104, v105
  v_mfma_f32_16x16x32_bf16 v[76:79], v[28:31], v[200:203], v[76:79]
  v_cvt_pk_bf16_f32 v105, v106, v107
  v_mfma_f32_16x16x32_bf16 v[84:87], v[28:31], v[232:235], v[84:87]
  s_waitcnt lgkmcnt(5)
  v_cvt_pk_bf16_f32 v106, v108, v109
  v_mfma_f32_16x16x32_bf16 v[56:59], v[32:35], v[140:143], v[56:59]
  s_waitcnt vmcnt(20)
  s_barrier
  ds_read_b128 v[24:27], v252 offset:16384
  v_cvt_pk_bf16_f32 v107, v110, v111
  v_mfma_f32_16x16x32_bf16 v[64:67], v[32:35], v[172:175], v[64:67]
  v_accvgpr_write_b32 a124, v104
  v_accvgpr_write_b32 a125, v105
  v_mfma_f32_16x16x32_bf16 v[72:75], v[32:35], v[204:207], v[72:75]
  v_accvgpr_write_b32 a126, v106
  v_mfma_f32_16x16x32_bf16 v[80:83], v[32:35], v[236:239], v[80:83]
  s_waitcnt lgkmcnt(5)
  v_accvgpr_write_b32 a127, v107
  v_mfma_f32_16x16x32_bf16 v[60:63], v[36:39], v[140:143], v[60:63]
  ds_read_b128 v[28:31], v252 offset:18432
  v_mul_f32 v112, v12, v112
  v_mfma_f32_16x16x32_bf16 v[68:71], v[36:39], v[172:175], v[68:71]
  v_mul_f32 v113, v12, v113
  v_mul_f32 v114, v12, v114
  v_mfma_f32_16x16x32_bf16 v[76:79], v[36:39], v[204:207], v[76:79]
  v_mul_f32 v115, v12, v115
  v_mfma_f32_16x16x32_bf16 v[84:87], v[36:39], v[236:239], v[84:87]
  s_waitcnt lgkmcnt(5)
  v_mul_f32 v116, v12, v116
  v_mfma_f32_16x16x32_bf16 v[56:59], v[40:43], v[144:147], v[56:59]
  ds_read_b128 v[32:35], v253 offset:16384
  v_mul_f32 v117, v12, v117
  v_mfma_f32_16x16x32_bf16 v[64:67], v[40:43], v[176:179], v[64:67]
  v_mul_f32 v118, v12, v118
  v_mul_f32 v119, v12, v119
  v_mfma_f32_16x16x32_bf16 v[72:75], v[40:43], v[208:211], v[72:75]
  v_cvt_pk_bf16_f32 v112, v112, v113
  v_mfma_f32_16x16x32_bf16 v[80:83], v[40:43], v[240:243], v[80:83]
  s_waitcnt lgkmcnt(5)
  v_cvt_pk_bf16_f32 v113, v114, v115
  v_mfma_f32_16x16x32_bf16 v[60:63], v[44:47], v[144:147], v[60:63]
  ds_read_b128 v[36:39], v253 offset:18432
  v_cvt_pk_bf16_f32 v114, v116, v117
  v_mfma_f32_16x16x32_bf16 v[68:71], v[44:47], v[176:179], v[68:71]
  v_cvt_pk_bf16_f32 v115, v118, v119
  v_accvgpr_write_b32 a180, v112
  v_mfma_f32_16x16x32_bf16 v[76:79], v[44:47], v[208:211], v[76:79]
  v_accvgpr_write_b32 a181, v113
  v_mfma_f32_16x16x32_bf16 v[84:87], v[44:47], v[240:243], v[84:87]
  s_waitcnt lgkmcnt(5)
  v_accvgpr_write_b32 a182, v114
  v_mfma_f32_16x16x32_bf16 v[56:59], v[48:51], v[148:151], v[56:59]
  ds_read_b128 v[40:43], v254 offset:16384
  v_accvgpr_write_b32 a183, v115
  v_mfma_f32_16x16x32_bf16 v[64:67], v[48:51], v[180:183], v[64:67]
  v_mfma_f32_16x16x32_bf16 v[72:75], v[48:51], v[212:215], v[72:75]
  v_mfma_f32_16x16x32_bf16 v[80:83], v[48:51], v[244:247], v[80:83]
  s_waitcnt lgkmcnt(5)
  v_mfma_f32_16x16x32_bf16 v[60:63], v[52:55], v[148:151], v[60:63]
  ds_read_b128 v[44:47], v254 offset:18432
  v_mfma_f32_16x16x32_bf16 v[68:71], v[52:55], v[180:183], v[68:71]
  v_mfma_f32_16x16x32_bf16 v[76:79], v[52:55], v[212:215], v[76:79]
  v_mfma_f32_16x16x32_bf16 v[84:87], v[52:55], v[244:247], v[84:87]
  s_waitcnt lgkmcnt(5)
  v_mfma_f32_16x16x32_bf16 v[88:91], v[24:27], v[120:123], 0
  ds_read_b128 v[48:51], v255 offset:16384
  v_mfma_f32_16x16x32_bf16 v[96:99], v[24:27], v[152:155], 0
  v_mfma_f32_16x16x32_bf16 v[104:107], v[24:27], v[184:187], 0
  s_add_u32 m0, s29, 16384
  s_add_u32 s27, s28, 2883584
  buffer_load_dwordx4 v14, s[60:63], s27 offen lds
  v_mfma_f32_16x16x32_bf16 v[112:115], v[24:27], v[216:219], 0
  s_waitcnt lgkmcnt(5)
  v_mul_f32 v56, v12, v56
  v_mfma_f32_16x16x32_bf16 v[92:95], v[28:31], v[120:123], 0
  ds_read_b128 v[52:55], v255 offset:18432
  v_mul_f32 v57, v12, v57
  v_mfma_f32_16x16x32_bf16 v[100:103], v[28:31], v[152:155], 0
  v_mul_f32 v58, v12, v58
  v_mul_f32 v59, v12, v59
  v_mfma_f32_16x16x32_bf16 v[108:111], v[28:31], v[184:187], 0
  v_mul_f32 v60, v12, v60
  v_mfma_f32_16x16x32_bf16 v[116:119], v[28:31], v[216:219], 0
  s_waitcnt lgkmcnt(5)
  v_mul_f32 v61, v12, v61
  v_mfma_f32_16x16x32_bf16 v[88:91], v[32:35], v[124:127], v[88:91]
  ds_read_b128 v[24:27], v252 offset:16640
  v_mul_f32 v62, v12, v62
  v_mfma_f32_16x16x32_bf16 v[96:99], v[32:35], v[156:159], v[96:99]
  v_mul_f32 v63, v12, v63
  v_cvt_pk_bf16_f32 v56, v56, v57
  v_mfma_f32_16x16x32_bf16 v[104:107], v[32:35], v[188:191], v[104:107]
  s_add_u32 m0, s29, 17408
  s_add_u32 s27, s28, 2899968
  buffer_load_dwordx4 v15, s[60:63], s27 offen lds
  v_mfma_f32_16x16x32_bf16 v[112:115], v[32:35], v[220:223], v[112:115]
  s_waitcnt lgkmcnt(5)
  v_cvt_pk_bf16_f32 v57, v58, v59
  v_mfma_f32_16x16x32_bf16 v[92:95], v[36:39], v[124:127], v[92:95]
  ds_read_b128 v[28:31], v252 offset:18688
  v_cvt_pk_bf16_f32 v58, v60, v61
  v_mfma_f32_16x16x32_bf16 v[100:103], v[36:39], v[156:159], v[100:103]
  v_cvt_pk_bf16_f32 v59, v62, v63
  v_accvgpr_write_b32 a16, v56
  v_mfma_f32_16x16x32_bf16 v[108:111], v[36:39], v[188:191], v[108:111]
  v_accvgpr_write_b32 a17, v57
  v_mfma_f32_16x16x32_bf16 v[116:119], v[36:39], v[220:223], v[116:119]
  s_waitcnt lgkmcnt(5)
  v_accvgpr_write_b32 a18, v58
  v_mfma_f32_16x16x32_bf16 v[88:91], v[40:43], v[128:131], v[88:91]
  ds_read_b128 v[32:35], v253 offset:16640
  v_accvgpr_write_b32 a19, v59
  v_mfma_f32_16x16x32_bf16 v[96:99], v[40:43], v[160:163], v[96:99]
  v_mul_f32 v64, v12, v64
  v_mul_f32 v65, v12, v65
  v_mfma_f32_16x16x32_bf16 v[104:107], v[40:43], v[192:195], v[104:107]
  s_add_u32 m0, s29, 18432
  s_add_u32 s27, s28, 2916352
  buffer_load_dwordx4 v14, s[60:63], s27 offen lds
  v_mfma_f32_16x16x32_bf16 v[112:115], v[40:43], v[224:227], v[112:115]
  s_waitcnt lgkmcnt(5)
  v_mul_f32 v66, v12, v66
  v_mfma_f32_16x16x32_bf16 v[92:95], v[44:47], v[128:131], v[92:95]
  ds_read_b128 v[36:39], v253 offset:18688
  v_mul_f32 v67, v12, v67
  v_mfma_f32_16x16x32_bf16 v[100:103], v[44:47], v[160:163], v[100:103]
  v_mul_f32 v68, v12, v68
  v_mul_f32 v69, v12, v69
  v_mfma_f32_16x16x32_bf16 v[108:111], v[44:47], v[192:195], v[108:111]
  v_mul_f32 v70, v12, v70
  v_mfma_f32_16x16x32_bf16 v[116:119], v[44:47], v[224:227], v[116:119]
  s_waitcnt lgkmcnt(5)
  v_mul_f32 v71, v12, v71
  v_mfma_f32_16x16x32_bf16 v[88:91], v[48:51], v[132:135], v[88:91]
  ds_read_b128 v[40:43], v254 offset:16640
  v_cvt_pk_bf16_f32 v64, v64, v65
  v_mfma_f32_16x16x32_bf16 v[96:99], v[48:51], v[164:167], v[96:99]
  v_cvt_pk_bf16_f32 v65, v66, v67
  v_cvt_pk_bf16_f32 v66, v68, v69
  v_mfma_f32_16x16x32_bf16 v[104:107], v[48:51], v[196:199], v[104:107]
  s_add_u32 m0, s29, 19456
  s_add_u32 s27, s28, 2932736
  buffer_load_dwordx4 v15, s[60:63], s27 offen lds
  v_mfma_f32_16x16x32_bf16 v[112:115], v[48:51], v[228:231], v[112:115]
  s_waitcnt lgkmcnt(5)
  v_cvt_pk_bf16_f32 v67, v70, v71
  v_mfma_f32_16x16x32_bf16 v[92:95], v[52:55], v[132:135], v[92:95]
  ds_read_b128 v[44:47], v254 offset:18688
  v_accvgpr_write_b32 a72, v64
  v_mfma_f32_16x16x32_bf16 v[100:103], v[52:55], v[164:167], v[100:103]
  v_accvgpr_write_b32 a73, v65
  v_accvgpr_write_b32 a74, v66
  v_mfma_f32_16x16x32_bf16 v[108:111], v[52:55], v[196:199], v[108:111]
  v_accvgpr_write_b32 a75, v67
  v_mfma_f32_16x16x32_bf16 v[116:119], v[52:55], v[228:231], v[116:119]
  s_waitcnt lgkmcnt(5)
  v_mul_f32 v72, v12, v72
  v_mfma_f32_16x16x32_bf16 v[88:91], v[24:27], v[136:139], v[88:91]
  ds_read_b128 v[48:51], v255 offset:16640
  v_mul_f32 v73, v12, v73
  v_mfma_f32_16x16x32_bf16 v[96:99], v[24:27], v[168:171], v[96:99]
  v_mul_f32 v74, v12, v74
  v_mul_f32 v75, v12, v75
  v_mfma_f32_16x16x32_bf16 v[104:107], v[24:27], v[200:203], v[104:107]
  v_mul_f32 v76, v12, v76
  v_mfma_f32_16x16x32_bf16 v[112:115], v[24:27], v[232:235], v[112:115]
  s_waitcnt lgkmcnt(5)
  v_mul_f32 v77, v12, v77
  v_mfma_f32_16x16x32_bf16 v[92:95], v[28:31], v[136:139], v[92:95]
  ds_read_b128 v[52:55], v255 offset:18688
  v_mul_f32 v78, v12, v78
  v_mfma_f32_16x16x32_bf16 v[100:103], v[28:31], v[168:171], v[100:103]
  v_mul_f32 v79, v12, v79
  v_cvt_pk_bf16_f32 v72, v72, v73
  v_mfma_f32_16x16x32_bf16 v[108:111], v[28:31], v[200:203], v[108:111]
  v_cvt_pk_bf16_f32 v73, v74, v75
  v_mfma_f32_16x16x32_bf16 v[116:119], v[28:31], v[232:235], v[116:119]
  s_waitcnt lgkmcnt(5)
  v_cvt_pk_bf16_f32 v74, v76, v77
  v_mfma_f32_16x16x32_bf16 v[88:91], v[32:35], v[140:143], v[88:91]
  s_waitcnt vmcnt(20)
  s_barrier
  ds_read_b128 v[24:27], v252 offset:32768
  v_cvt_pk_bf16_f32 v75, v78, v79
  v_mfma_f32_16x16x32_bf16 v[96:99], v[32:35], v[172:175], v[96:99]
  v_accvgpr_write_b32 a128, v72
  v_accvgpr_write_b32 a129, v73
  v_mfma_f32_16x16x32_bf16 v[104:107], v[32:35], v[204:207], v[104:107]
  v_accvgpr_write_b32 a130, v74
  v_mfma_f32_16x16x32_bf16 v[112:115], v[32:35], v[236:239], v[112:115]
  s_waitcnt lgkmcnt(5)
  v_accvgpr_write_b32 a131, v75
  v_mfma_f32_16x16x32_bf16 v[92:95], v[36:39], v[140:143], v[92:95]
  ds_read_b128 v[28:31], v252 offset:34816
  v_mul_f32 v80, v12, v80
  v_mfma_f32_16x16x32_bf16 v[100:103], v[36:39], v[172:175], v[100:103]
  v_mul_f32 v81, v12, v81
  v_mul_f32 v82, v12, v82
  v_mfma_f32_16x16x32_bf16 v[108:111], v[36:39], v[204:207], v[108:111]
  v_mul_f32 v83, v12, v83
  v_mfma_f32_16x16x32_bf16 v[116:119], v[36:39], v[236:239], v[116:119]
  s_waitcnt lgkmcnt(5)
  v_mul_f32 v84, v12, v84
  v_mfma_f32_16x16x32_bf16 v[88:91], v[40:43], v[144:147], v[88:91]
  ds_read_b128 v[32:35], v253 offset:32768
  v_mul_f32 v85, v12, v85
  v_mfma_f32_16x16x32_bf16 v[96:99], v[40:43], v[176:179], v[96:99]
  v_mul_f32 v86, v12, v86
  v_mul_f32 v87, v12, v87
  v_mfma_f32_16x16x32_bf16 v[104:107], v[40:43], v[208:211], v[104:107]
  v_cvt_pk_bf16_f32 v80, v80, v81
  v_mfma_f32_16x16x32_bf16 v[112:115], v[40:43], v[240:243], v[112:115]
  s_waitcnt lgkmcnt(5)
  v_cvt_pk_bf16_f32 v81, v82, v83
  v_mfma_f32_16x16x32_bf16 v[92:95], v[44:47], v[144:147], v[92:95]
  ds_read_b128 v[36:39], v253 offset:34816
  v_cvt_pk_bf16_f32 v82, v84, v85
  v_mfma_f32_16x16x32_bf16 v[100:103], v[44:47], v[176:179], v[100:103]
  v_cvt_pk_bf16_f32 v83, v86, v87
  v_accvgpr_write_b32 a184, v80
  v_mfma_f32_16x16x32_bf16 v[108:111], v[44:47], v[208:211], v[108:111]
  v_accvgpr_write_b32 a185, v81
  v_mfma_f32_16x16x32_bf16 v[116:119], v[44:47], v[240:243], v[116:119]
  s_waitcnt lgkmcnt(5)
  v_accvgpr_write_b32 a186, v82
  v_mfma_f32_16x16x32_bf16 v[88:91], v[48:51], v[148:151], v[88:91]
  ds_read_b128 v[40:43], v254 offset:32768
  v_accvgpr_write_b32 a187, v83
  v_mfma_f32_16x16x32_bf16 v[96:99], v[48:51], v[180:183], v[96:99]
  v_mfma_f32_16x16x32_bf16 v[104:107], v[48:51], v[212:215], v[104:107]
  v_mfma_f32_16x16x32_bf16 v[112:115], v[48:51], v[244:247], v[112:115]
  s_waitcnt lgkmcnt(5)
  v_mfma_f32_16x16x32_bf16 v[92:95], v[52:55], v[148:151], v[92:95]
  ds_read_b128 v[44:47], v254 offset:34816
  v_mfma_f32_16x16x32_bf16 v[100:103], v[52:55], v[180:183], v[100:103]
  v_mfma_f32_16x16x32_bf16 v[108:111], v[52:55], v[212:215], v[108:111]
  v_mfma_f32_16x16x32_bf16 v[116:119], v[52:55], v[244:247], v[116:119]
  s_waitcnt lgkmcnt(5)
  s_getpc_b64 s[98:99]
  s_add_u32 s98, s98, 4096
  s_addc_u32 s99, s99, 0
  global_load_dword v7, v6, s[98:99]
  v_mfma_f32_16x16x32_bf16 v[56:59], v[24:27], v[120:123], 0
  ds_read_b128 v[48:51], v255 offset:32768
  v_mfma_f32_16x16x32_bf16 v[64:67], v[24:27], v[152:155], 0
  v_mfma_f32_16x16x32_bf16 v[72:75], v[24:27], v[184:187], 0
  s_add_u32 m0, s29, 32768
  s_add_u32 s27, s28, 3145728
  buffer_load_dwordx4 v14, s[60:63], s27 offen lds
  v_mfma_f32_16x16x32_bf16 v[80:83], v[24:27], v[216:219], 0
  s_waitcnt lgkmcnt(5)
  v_mul_f32 v88, v12, v88
  v_mfma_f32_16x16x32_bf16 v[60:63], v[28:31], v[120:123], 0
  ds_read_b128 v[52:55], v255 offset:34816
  v_mul_f32 v89, v12, v89
  v_mfma_f32_16x16x32_bf16 v[68:71], v[28:31], v[152:155], 0
  v_mul_f32 v90, v12, v90
  v_mul_f32 v91, v12, v91
  v_mfma_f32_16x16x32_bf16 v[76:79], v[28:31], v[184:187], 0
  v_mul_f32 v92, v12, v92
  v_mfma_f32_16x16x32_bf16 v[84:87], v[28:31], v[216:219], 0
  s_waitcnt lgkmcnt(5)
  v_mul_f32 v93, v12, v93
  v_mfma_f32_16x16x32_bf16 v[56:59], v[32:35], v[124:127], v[56:59]
  ds_read_b128 v[24:27], v252 offset:33024
  v_mul_f32 v94, v12, v94
  v_mfma_f32_16x16x32_bf16 v[64:67], v[32:35], v[156:159], v[64:67]
  v_mul_f32 v95, v12, v95
  v_cvt_pk_bf16_f32 v88, v88, v89
  v_mfma_f32_16x16x32_bf16 v[72:75], v[32:35], v[188:191], v[72:75]
  s_add_u32 m0, s29, 33792
  s_add_u32 s27, s28, 3162112
  buffer_load_dwordx4 v15, s[60:63], s27 offen lds
  v_mfma_f32_16x16x32_bf16 v[80:83], v[32:35], v[220:223], v[80:83]
  s_waitcnt lgkmcnt(5)
  v_cvt_pk_bf16_f32 v89, v90, v91
  v_mfma_f32_16x16x32_bf16 v[60:63], v[36:39], v[124:127], v[60:63]
  ds_read_b128 v[28:31], v252 offset:35072
  v_cvt_pk_bf16_f32 v90, v92, v93
  v_mfma_f32_16x16x32_bf16 v[68:71], v[36:39], v[156:159], v[68:71]
  v_cvt_pk_bf16_f32 v91, v94, v95
  v_accvgpr_write_b32 a20, v88
  v_mfma_f32_16x16x32_bf16 v[76:79], v[36:39], v[188:191], v[76:79]
  v_accvgpr_write_b32 a21, v89
  v_mfma_f32_16x16x32_bf16 v[84:87], v[36:39], v[220:223], v[84:87]
  s_waitcnt lgkmcnt(5)
  v_accvgpr_write_b32 a22, v90
  v_mfma_f32_16x16x32_bf16 v[56:59], v[40:43], v[128:131], v[56:59]
  ds_read_b128 v[32:35], v253 offset:33024
  v_accvgpr_write_b32 a23, v91
  v_mfma_f32_16x16x32_bf16 v[64:67], v[40:43], v[160:163], v[64:67]
  v_mul_f32 v96, v12, v96
  v_mul_f32 v97, v12, v97
  v_mfma_f32_16x16x32_bf16 v[72:75], v[40:43], v[192:195], v[72:75]
  s_add_u32 m0, s29, 34816
  s_add_u32 s27, s28, 3178496
  buffer_load_dwordx4 v14, s[60:63], s27 offen lds
  v_mfma_f32_16x16x32_bf16 v[80:83], v[40:43], v[224:227], v[80:83]
  s_waitcnt lgkmcnt(5)
  v_mul_f32 v98, v12, v98
  v_mfma_f32_16x16x32_bf16 v[60:63], v[44:47], v[128:131], v[60:63]
  ds_read_b128 v[36:39], v253 offset:35072
  v_mul_f32 v99, v12, v99
  v_mfma_f32_16x16x32_bf16 v[68:71], v[44:47], v[160:163], v[68:71]
  v_mul_f32 v100, v12, v100
  v_mul_f32 v101, v12, v101
  v_mfma_f32_16x16x32_bf16 v[76:79], v[44:47], v[192:195], v[76:79]
  v_mul_f32 v102, v12, v102
  v_mfma_f32_16x16x32_bf16 v[84:87], v[44:47], v[224:227], v[84:87]
  s_waitcnt lgkmcnt(5)
  v_mul_f32 v103, v12, v103
  v_mfma_f32_16x16x32_bf16 v[56:59], v[48:51], v[132:135], v[56:59]
  ds_read_b128 v[40:43], v254 offset:33024
  v_cvt_pk_bf16_f32 v96, v96, v97
  v_mfma_f32_16x16x32_bf16 v[64:67], v[48:51], v[164:167], v[64:67]
  v_cvt_pk_bf16_f32 v97, v98, v99
  v_cvt_pk_bf16_f32 v98, v100, v101
  v_mfma_f32_16x16x32_bf16 v[72:75], v[48:51], v[196:199], v[72:75]
  s_add_u32 m0, s29, 35840
  s_add_u32 s27, s28, 3194880
  buffer_load_dwordx4 v15, s[60:63], s27 offen lds
  v_mfma_f32_16x16x32_bf16 v[80:83], v[48:51], v[228:231], v[80:83]
  s_waitcnt lgkmcnt(5)
  v_cvt_pk_bf16_f32 v99, v102, v103
  v_mfma_f32_16x16x32_bf16 v[60:63], v[52:55], v[132:135], v[60:63]
  ds_read_b128 v[44:47], v254 offset:35072
  v_accvgpr_write_b32 a76, v96
  v_mfma_f32_16x16x32_bf16 v[68:71], v[52:55], v[164:167], v[68:71]
  v_accvgpr_write_b32 a77, v97
  v_accvgpr_write_b32 a78, v98
  v_mfma_f32_16x16x32_bf16 v[76:79], v[52:55], v[196:199], v[76:79]
  v_accvgpr_write_b32 a79, v99
  v_mfma_f32_16x16x32_bf16 v[84:87], v[52:55], v[228:231], v[84:87]
  s_waitcnt lgkmcnt(5)
  v_mul_f32 v104, v12, v104
  v_mfma_f32_16x16x32_bf16 v[56:59], v[24:27], v[136:139], v[56:59]
  ds_read_b128 v[48:51], v255 offset:33024
  v_mul_f32 v105, v12, v105
  v_mfma_f32_16x16x32_bf16 v[64:67], v[24:27], v[168:171], v[64:67]
  v_mul_f32 v106, v12, v106
  v_mul_f32 v107, v12, v107
  v_mfma_f32_16x16x32_bf16 v[72:75], v[24:27], v[200:203], v[72:75]
  v_mul_f32 v108, v12, v108
  v_mfma_f32_16x16x32_bf16 v[80:83], v[24:27], v[232:235], v[80:83]
  s_waitcnt lgkmcnt(5)
  v_mul_f32 v109, v12, v109
  v_mfma_f32_16x16x32_bf16 v[60:63], v[28:31], v[136:139], v[60:63]
  ds_read_b128 v[52:55], v255 offset:35072
  v_mul_f32 v110, v12, v110
  v_mfma_f32_16x16x32_bf16 v[68:71], v[28:31], v[168:171], v[68:71]
  v_mul_f32 v111, v12, v111
  v_cvt_pk_bf16_f32 v104, v104, v105
  v_mfma_f32_16x16x32_bf16 v[76:79], v[28:31], v[200:203], v[76:79]
  v_cvt_pk_bf16_f32 v105, v106, v107
  v_mfma_f32_16x16x32_bf16 v[84:87], v[28:31], v[232:235], v[84:87]
  s_waitcnt lgkmcnt(5)
  v_cvt_pk_bf16_f32 v106, v108, v109
  v_mfma_f32_16x16x32_bf16 v[56:59], v[32:35], v[140:143], v[56:59]
  s_waitcnt vmcnt(20)
  s_barrier
  ds_read_b128 v[24:27], v252 offset:49152
  v_cvt_pk_bf16_f32 v107, v110, v111
  v_mfma_f32_16x16x32_bf16 v[64:67], v[32:35], v[172:175], v[64:67]
  v_accvgpr_write_b32 a132, v104
  v_accvgpr_write_b32 a133, v105
  v_mfma_f32_16x16x32_bf16 v[72:75], v[32:35], v[204:207], v[72:75]
  v_accvgpr_write_b32 a134, v106
  v_mfma_f32_16x16x32_bf16 v[80:83], v[32:35], v[236:239], v[80:83]
  s_waitcnt lgkmcnt(5)
  v_accvgpr_write_b32 a135, v107
  v_mfma_f32_16x16x32_bf16 v[60:63], v[36:39], v[140:143], v[60:63]
  ds_read_b128 v[28:31], v252 offset:51200
  v_mul_f32 v112, v12, v112
  v_mfma_f32_16x16x32_bf16 v[68:71], v[36:39], v[172:175], v[68:71]
  v_mul_f32 v113, v12, v113
  v_mul_f32 v114, v12, v114
  v_mfma_f32_16x16x32_bf16 v[76:79], v[36:39], v[204:207], v[76:79]
  v_mul_f32 v115, v12, v115
  v_mfma_f32_16x16x32_bf16 v[84:87], v[36:39], v[236:239], v[84:87]
  s_waitcnt lgkmcnt(5)
  v_mul_f32 v116, v12, v116
  v_mfma_f32_16x16x32_bf16 v[56:59], v[40:43], v[144:147], v[56:59]
  ds_read_b128 v[32:35], v253 offset:49152
  v_mul_f32 v117, v12, v117
  v_mfma_f32_16x16x32_bf16 v[64:67], v[40:43], v[176:179], v[64:67]
  v_mul_f32 v118, v12, v118
  v_mul_f32 v119, v12, v119
  v_mfma_f32_16x16x32_bf16 v[72:75], v[40:43], v[208:211], v[72:75]
  v_cvt_pk_bf16_f32 v112, v112, v113
  v_mfma_f32_16x16x32_bf16 v[80:83], v[40:43], v[240:243], v[80:83]
  s_waitcnt lgkmcnt(5)
  v_cvt_pk_bf16_f32 v113, v114, v115
  v_mfma_f32_16x16x32_bf16 v[60:63], v[44:47], v[144:147], v[60:63]
  ds_read_b128 v[36:39], v253 offset:51200
  v_cvt_pk_bf16_f32 v114, v116, v117
  v_mfma_f32_16x16x32_bf16 v[68:71], v[44:47], v[176:179], v[68:71]
  v_cvt_pk_bf16_f32 v115, v118, v119
  v_accvgpr_write_b32 a188, v112
  v_mfma_f32_16x16x32_bf16 v[76:79], v[44:47], v[208:211], v[76:79]
  v_accvgpr_write_b32 a189, v113
  v_mfma_f32_16x16x32_bf16 v[84:87], v[44:47], v[240:243], v[84:87]
  s_waitcnt lgkmcnt(5)
  v_accvgpr_write_b32 a190, v114
  v_mfma_f32_16x16x32_bf16 v[56:59], v[48:51], v[148:151], v[56:59]
  ds_read_b128 v[40:43], v254 offset:49152
  v_accvgpr_write_b32 a191, v115
  v_mfma_f32_16x16x32_bf16 v[64:67], v[48:51], v[180:183], v[64:67]
  v_mfma_f32_16x16x32_bf16 v[72:75], v[48:51], v[212:215], v[72:75]
  v_mfma_f32_16x16x32_bf16 v[80:83], v[48:51], v[244:247], v[80:83]
  s_waitcnt lgkmcnt(5)
  v_mfma_f32_16x16x32_bf16 v[60:63], v[52:55], v[148:151], v[60:63]
  ds_read_b128 v[44:47], v254 offset:51200
  v_mfma_f32_16x16x32_bf16 v[68:71], v[52:55], v[180:183], v[68:71]
  v_mfma_f32_16x16x32_bf16 v[76:79], v[52:55], v[212:215], v[76:79]
  v_mfma_f32_16x16x32_bf16 v[84:87], v[52:55], v[244:247], v[84:87]
  s_waitcnt lgkmcnt(5)
  v_mfma_f32_16x16x32_bf16 v[88:91], v[24:27], v[120:123], 0
  ds_read_b128 v[48:51], v255 offset:49152
  v_mfma_f32_16x16x32_bf16 v[96:99], v[24:27], v[152:155], 0
  v_mfma_f32_16x16x32_bf16 v[104:107], v[24:27], v[184:187], 0
  s_add_u32 m0, s29, 49152
  s_add_u32 s27, s28, 3407872
  buffer_load_dwordx4 v14, s[60:63], s27 offen lds
  v_mfma_f32_16x16x32_bf16 v[112:115], v[24:27], v[216:219], 0
  s_waitcnt lgkmcnt(5)
  v_mul_f32 v56, v12, v56
  v_mfma_f32_16x16x32_bf16 v[92:95], v[28:31], v[120:123], 0
  ds_read_b128 v[52:55], v255 offset:51200
  v_mul_f32 v57, v12, v57
  v_mfma_f32_16x16x32_bf16 v[100:103], v[28:31], v[152:155], 0
  v_mul_f32 v58, v12, v58
  v_mul_f32 v59, v12, v59
  v_mfma_f32_16x16x32_bf16 v[108:111], v[28:31], v[184:187], 0
  v_mul_f32 v60, v12, v60
  v_mfma_f32_16x16x32_bf16 v[116:119], v[28:31], v[216:219], 0
  s_waitcnt lgkmcnt(5)
  v_mul_f32 v61, v12, v61
  v_mfma_f32_16x16x32_bf16 v[88:91], v[32:35], v[124:127], v[88:91]
  ds_read_b128 v[24:27], v252 offset:49408
  v_mul_f32 v62, v12, v62
  v_mfma_f32_16x16x32_bf16 v[96:99], v[32:35], v[156:159], v[96:99]
  v_mul_f32 v63, v12, v63
  v_cvt_pk_bf16_f32 v56, v56, v57
  v_mfma_f32_16x16x32_bf16 v[104:107], v[32:35], v[188:191], v[104:107]
  s_add_u32 m0, s29, 50176
  s_add_u32 s27, s28, 3424256
  buffer_load_dwordx4 v15, s[60:63], s27 offen lds
  v_mfma_f32_16x16x32_bf16 v[112:115], v[32:35], v[220:223], v[112:115]
  s_waitcnt lgkmcnt(5)
  v_cvt_pk_bf16_f32 v57, v58, v59
  v_mfma_f32_16x16x32_bf16 v[92:95], v[36:39], v[124:127], v[92:95]
  ds_read_b128 v[28:31], v252 offset:51456
  v_cvt_pk_bf16_f32 v58, v60, v61
  v_mfma_f32_16x16x32_bf16 v[100:103], v[36:39], v[156:159], v[100:103]
  v_cvt_pk_bf16_f32 v59, v62, v63
  v_accvgpr_write_b32 a24, v56
  v_mfma_f32_16x16x32_bf16 v[108:111], v[36:39], v[188:191], v[108:111]
  v_accvgpr_write_b32 a25, v57
  v_mfma_f32_16x16x32_bf16 v[116:119], v[36:39], v[220:223], v[116:119]
  s_waitcnt lgkmcnt(5)
  v_accvgpr_write_b32 a26, v58
  v_mfma_f32_16x16x32_bf16 v[88:91], v[40:43], v[128:131], v[88:91]
  ds_read_b128 v[32:35], v253 offset:49408
  v_accvgpr_write_b32 a27, v59
  v_mfma_f32_16x16x32_bf16 v[96:99], v[40:43], v[160:163], v[96:99]
  v_mul_f32 v64, v12, v64
  v_mul_f32 v65, v12, v65
  v_mfma_f32_16x16x32_bf16 v[104:107], v[40:43], v[192:195], v[104:107]
  s_add_u32 m0, s29, 51200
  s_add_u32 s27, s28, 3440640
  buffer_load_dwordx4 v14, s[60:63], s27 offen lds
  v_mfma_f32_16x16x32_bf16 v[112:115], v[40:43], v[224:227], v[112:115]
  s_waitcnt lgkmcnt(5)
  v_mul_f32 v66, v12, v66
  v_mfma_f32_16x16x32_bf16 v[92:95], v[44:47], v[128:131], v[92:95]
  ds_read_b128 v[36:39], v253 offset:51456
  v_mul_f32 v67, v12, v67
  v_mfma_f32_16x16x32_bf16 v[100:103], v[44:47], v[160:163], v[100:103]
  v_mul_f32 v68, v12, v68
  v_mul_f32 v69, v12, v69
  v_mfma_f32_16x16x32_bf16 v[108:111], v[44:47], v[192:195], v[108:111]
  v_mul_f32 v70, v12, v70
  v_mfma_f32_16x16x32_bf16 v[116:119], v[44:47], v[224:227], v[116:119]
  s_waitcnt lgkmcnt(5)
  v_mul_f32 v71, v12, v71
  v_mfma_f32_16x16x32_bf16 v[88:91], v[48:51], v[132:135], v[88:91]
  ds_read_b128 v[40:43], v254 offset:49408
  v_cvt_pk_bf16_f32 v64, v64, v65
  v_mfma_f32_16x16x32_bf16 v[96:99], v[48:51], v[164:167], v[96:99]
  v_cvt_pk_bf16_f32 v65, v66, v67
  v_cvt_pk_bf16_f32 v66, v68, v69
  v_mfma_f32_16x16x32_bf16 v[104:107], v[48:51], v[196:199], v[104:107]
  s_add_u32 m0, s29, 52224
  s_add_u32 s27, s28, 3457024
  buffer_load_dwordx4 v15, s[60:63], s27 offen lds
  v_mfma_f32_16x16x32_bf16 v[112:115], v[48:51], v[228:231], v[112:115]
  s_waitcnt lgkmcnt(5)
  v_cvt_pk_bf16_f32 v67, v70, v71
  v_mfma_f32_16x16x32_bf16 v[92:95], v[52:55], v[132:135], v[92:95]
  ds_read_b128 v[44:47], v254 offset:51456
  v_accvgpr_write_b32 a80, v64
  v_mfma_f32_16x16x32_bf16 v[100:103], v[52:55], v[164:167], v[100:103]
  v_accvgpr_write_b32 a81, v65
  v_accvgpr_write_b32 a82, v66
  v_mfma_f32_16x16x32_bf16 v[108:111], v[52:55], v[196:199], v[108:111]
  v_accvgpr_write_b32 a83, v67
  v_mfma_f32_16x16x32_bf16 v[116:119], v[52:55], v[228:231], v[116:119]
  s_waitcnt lgkmcnt(5)
  v_mul_f32 v72, v12, v72
  v_mfma_f32_16x16x32_bf16 v[88:91], v[24:27], v[136:139], v[88:91]
  ds_read_b128 v[48:51], v255 offset:49408
  v_mul_f32 v73, v12, v73
  v_mfma_f32_16x16x32_bf16 v[96:99], v[24:27], v[168:171], v[96:99]
  v_mul_f32 v74, v12, v74
  v_mul_f32 v75, v12, v75
  v_mfma_f32_16x16x32_bf16 v[104:107], v[24:27], v[200:203], v[104:107]
  v_mul_f32 v76, v12, v76
  v_mfma_f32_16x16x32_bf16 v[112:115], v[24:27], v[232:235], v[112:115]
  s_waitcnt lgkmcnt(5)
  v_mul_f32 v77, v12, v77
  v_mfma_f32_16x16x32_bf16 v[92:95], v[28:31], v[136:139], v[92:95]
  ds_read_b128 v[52:55], v255 offset:51456
  v_mul_f32 v78, v12, v78
  v_mfma_f32_16x16x32_bf16 v[100:103], v[28:31], v[168:171], v[100:103]
  v_mul_f32 v79, v12, v79
  v_cvt_pk_bf16_f32 v72, v72, v73
  v_mfma_f32_16x16x32_bf16 v[108:111], v[28:31], v[200:203], v[108:111]
  v_cvt_pk_bf16_f32 v73, v74, v75
  v_mfma_f32_16x16x32_bf16 v[116:119], v[28:31], v[232:235], v[116:119]
  s_waitcnt lgkmcnt(5)
  v_cvt_pk_bf16_f32 v74, v76, v77
  v_mfma_f32_16x16x32_bf16 v[88:91], v[32:35], v[140:143], v[88:91]
  s_waitcnt vmcnt(20)
  s_barrier
  ds_read_b128 v[24:27], v16 offset:0
  v_cvt_pk_bf16_f32 v75, v78, v79
  v_mfma_f32_16x16x32_bf16 v[96:99], v[32:35], v[172:175], v[96:99]
  v_accvgpr_write_b32 a136, v72
  v_accvgpr_write_b32 a137, v73
  v_mfma_f32_16x16x32_bf16 v[104:107], v[32:35], v[204:207], v[104:107]
  v_accvgpr_write_b32 a138, v74
  v_mfma_f32_16x16x32_bf16 v[112:115], v[32:35], v[236:239], v[112:115]
  s_waitcnt lgkmcnt(5)
  v_accvgpr_write_b32 a139, v75
  v_mfma_f32_16x16x32_bf16 v[92:95], v[36:39], v[140:143], v[92:95]
  ds_read_b128 v[28:31], v16 offset:2048
  v_mul_f32 v80, v12, v80
  v_mfma_f32_16x16x32_bf16 v[100:103], v[36:39], v[172:175], v[100:103]
  v_mul_f32 v81, v12, v81
  v_mul_f32 v82, v12, v82
  v_mfma_f32_16x16x32_bf16 v[108:111], v[36:39], v[204:207], v[108:111]
  v_mul_f32 v83, v12, v83
  v_mfma_f32_16x16x32_bf16 v[116:119], v[36:39], v[236:239], v[116:119]
  s_waitcnt lgkmcnt(5)
  v_mul_f32 v84, v12, v84
  v_mfma_f32_16x16x32_bf16 v[88:91], v[40:43], v[144:147], v[88:91]
  ds_read_b128 v[32:35], v17 offset:0
  v_mul_f32 v85, v12, v85
  v_mfma_f32_16x16x32_bf16 v[96:99], v[40:43], v[176:179], v[96:99]
  v_mul_f32 v86, v12, v86
  v_mul_f32 v87, v12, v87
  v_mfma_f32_16x16x32_bf16 v[104:107], v[40:43], v[208:211], v[104:107]
  v_cvt_pk_bf16_f32 v80, v80, v81
  v_mfma_f32_16x16x32_bf16 v[112:115], v[40:43], v[240:243], v[112:115]
  s_waitcnt lgkmcnt(5)
  v_cvt_pk_bf16_f32 v81, v82, v83
  v_mfma_f32_16x16x32_bf16 v[92:95], v[44:47], v[144:147], v[92:95]
  ds_read_b128 v[36:39], v17 offset:2048
  v_cvt_pk_bf16_f32 v82, v84, v85
  v_mfma_f32_16x16x32_bf16 v[100:103], v[44:47], v[176:179], v[100:103]
  v_cvt_pk_bf16_f32 v83, v86, v87
  v_accvgpr_write_b32 a192, v80
  v_mfma_f32_16x16x32_bf16 v[108:111], v[44:47], v[208:211], v[108:111]
  v_accvgpr_write_b32 a193, v81
  v_mfma_f32_16x16x32_bf16 v[116:119], v[44:47], v[240:243], v[116:119]
  s_waitcnt lgkmcnt(5)
  v_accvgpr_write_b32 a194, v82
  v_mfma_f32_16x16x32_bf16 v[88:91], v[48:51], v[148:151], v[88:91]
  ds_read_b128 v[40:43], v18 offset:0
  v_accvgpr_write_b32 a195, v83
  v_mfma_f32_16x16x32_bf16 v[96:99], v[48:51], v[180:183], v[96:99]
  v_mfma_f32_16x16x32_bf16 v[104:107], v[48:51], v[212:215], v[104:107]
  v_mfma_f32_16x16x32_bf16 v[112:115], v[48:51], v[244:247], v[112:115]
  s_waitcnt lgkmcnt(5)
  v_mfma_f32_16x16x32_bf16 v[92:95], v[52:55], v[148:151], v[92:95]
  ds_read_b128 v[44:47], v18 offset:2048
  v_mfma_f32_16x16x32_bf16 v[100:103], v[52:55], v[180:183], v[100:103]
  v_mfma_f32_16x16x32_bf16 v[108:111], v[52:55], v[212:215], v[108:111]
  v_mfma_f32_16x16x32_bf16 v[116:119], v[52:55], v[244:247], v[116:119]
  s_waitcnt lgkmcnt(5)
  v_mfma_f32_16x16x32_bf16 v[56:59], v[24:27], v[120:123], 0
  ds_read_b128 v[48:51], v19 offset:0
  v_mfma_f32_16x16x32_bf16 v[64:67], v[24:27], v[152:155], 0
  v_mfma_f32_16x16x32_bf16 v[72:75], v[24:27], v[184:187], 0
  v_mfma_f32_16x16x32_bf16 v[80:83], v[24:27], v[216:219], 0
  s_waitcnt lgkmcnt(5)
  v_mul_f32 v88, v12, v88
  v_mfma_f32_16x16x32_bf16 v[60:63], v[28:31], v[120:123], 0
  ds_read_b128 v[52:55], v19 offset:2048
  v_mul_f32 v89, v12, v89
  v_mfma_f32_16x16x32_bf16 v[68:71], v[28:31], v[152:155], 0
  v_mul_f32 v90, v12, v90
  v_mul_f32 v91, v12, v91
  v_mfma_f32_16x16x32_bf16 v[76:79], v[28:31], v[184:187], 0
  v_mul_f32 v92, v12, v92
  v_mfma_f32_16x16x32_bf16 v[84:87], v[28:31], v[216:219], 0
  s_waitcnt lgkmcnt(5)
  v_mul_f32 v93, v12, v93
  v_mfma_f32_16x16x32_bf16 v[56:59], v[32:35], v[124:127], v[56:59]
  ds_read_b128 v[24:27], v16 offset:256
  v_mul_f32 v94, v12, v94
  v_mfma_f32_16x16x32_bf16 v[64:67], v[32:35], v[156:159], v[64:67]
  v_mul_f32 v95, v12, v95
  v_cvt_pk_bf16_f32 v88, v88, v89
  v_mfma_f32_16x16x32_bf16 v[72:75], v[32:35], v[188:191], v[72:75]
  v_cvt_pk_bf16_f32 v89, v90, v91
  v_mfma_f32_16x16x32_bf16 v[80:83], v[32:35], v[220:223], v[80:83]
  s_waitcnt lgkmcnt(5)
  v_cvt_pk_bf16_f32 v90, v92, v93
  v_mfma_f32_16x16x32_bf16 v[60:63], v[36:39], v[124:127], v[60:63]
  ds_read_b128 v[28:31], v16 offset:2304
  v_cvt_pk_bf16_f32 v91, v94, v95
  v_mfma_f32_16x16x32_bf16 v[68:71], v[36:39], v[156:159], v[68:71]
  v_accvgpr_write_b32 a28, v88
  v_accvgpr_write_b32 a29, v89
  v_mfma_f32_16x16x32_bf16 v[76:79], v[36:39], v[188:191], v[76:79]
  v_accvgpr_write_b32 a30, v90
  v_mfma_f32_16x16x32_bf16 v[84:87], v[36:39], v[220:223], v[84:87]
  s_waitcnt lgkmcnt(5)
  v_accvgpr_write_b32 a31, v91
  v_mfma_f32_16x16x32_bf16 v[56:59], v[40:43], v[128:131], v[56:59]
  ds_read_b128 v[32:35], v17 offset:256
  v_mul_f32 v96, v12, v96
  v_mfma_f32_16x16x32_bf16 v[64:67], v[40:43], v[160:163], v[64:67]
  v_mul_f32 v97, v12, v97
  v_mul_f32 v98, v12, v98
  v_mfma_f32_16x16x32_bf16 v[72:75], v[40:43], v[192:195], v[72:75]
  v_mul_f32 v99, v12, v99
  v_mfma_f32_16x16x32_bf16 v[80:83], v[40:43], v[224:227], v[80:83]
  s_waitcnt lgkmcnt(5)
  v_mul_f32 v100, v12, v100
  v_mfma_f32_16x16x32_bf16 v[60:63], v[44:47], v[128:131], v[60:63]
  ds_read_b128 v[36:39], v17 offset:2304
  v_mul_f32 v101, v12, v101
  v_mfma_f32_16x16x32_bf16 v[68:71], v[44:47], v[160:163], v[68:71]
  v_mul_f32 v102, v12, v102
  v_mul_f32 v103, v12, v103
  v_mfma_f32_16x16x32_bf16 v[76:79], v[44:47], v[192:195], v[76:79]
  v_cvt_pk_bf16_f32 v96, v96, v97
  v_mfma_f32_16x16x32_bf16 v[84:87], v[44:47], v[224:227], v[84:87]
  s_waitcnt lgkmcnt(5)
  v_cvt_pk_bf16_f32 v97, v98, v99
  v_mfma_f32_16x16x32_bf16 v[56:59], v[48:51], v[132:135], v[56:59]
  ds_read_b128 v[40:43], v18 offset:256
  v_cvt_pk_bf16_f32 v98, v100, v101
  v_mfma_f32_16x16x32_bf16 v[64:67], v[48:51], v[164:167], v[64:67]
  v_cvt_pk_bf16_f32 v99, v102, v103
  v_accvgpr_write_b32 a84, v96
  v_mfma_f32_16x16x32_bf16 v[72:75], v[48:51], v[196:199], v[72:75]
  v_accvgpr_write_b32 a85, v97
  v_mfma_f32_16x16x32_bf16 v[80:83], v[48:51], v[228:231], v[80:83]
  s_waitcnt lgkmcnt(5)
  v_accvgpr_write_b32 a86, v98
  v_mfma_f32_16x16x32_bf16 v[60:63], v[52:55], v[132:135], v[60:63]
  ds_read_b128 v[44:47], v18 offset:2304
  v_accvgpr_write_b32 a87, v99
  v_mfma_f32_16x16x32_bf16 v[68:71], v[52:55], v[164:167], v[68:71]
  v_mul_f32 v104, v12, v104
  v_mul_f32 v105, v12, v105
  v_mfma_f32_16x16x32_bf16 v[76:79], v[52:55], v[196:199], v[76:79]
  v_mul_f32 v106, v12, v106
  v_mfma_f32_16x16x32_bf16 v[84:87], v[52:55], v[228:231], v[84:87]
  s_waitcnt lgkmcnt(5)
  v_mul_f32 v107, v12, v107
  v_mfma_f32_16x16x32_bf16 v[56:59], v[24:27], v[136:139], v[56:59]
  ds_read_b128 v[48:51], v19 offset:256
  v_mul_f32 v108, v12, v108
  v_mfma_f32_16x16x32_bf16 v[64:67], v[24:27], v[168:171], v[64:67]
  v_mul_f32 v109, v12, v109
  v_mul_f32 v110, v12, v110
  v_mfma_f32_16x16x32_bf16 v[72:75], v[24:27], v[200:203], v[72:75]
  v_mul_f32 v111, v12, v111
  v_mfma_f32_16x16x32_bf16 v[80:83], v[24:27], v[232:235], v[80:83]
  s_waitcnt lgkmcnt(5)
  v_cvt_pk_bf16_f32 v104, v104, v105
  v_mfma_f32_16x16x32_bf16 v[60:63], v[28:31], v[136:139], v[60:63]
  ds_read_b128 v[52:55], v19 offset:2304
  v_cvt_pk_bf16_f32 v105, v106, v107
  v_mfma_f32_16x16x32_bf16 v[68:71], v[28:31], v[168:171], v[68:71]
  v_cvt_pk_bf16_f32 v106, v108, v109
  v_cvt_pk_bf16_f32 v107, v110, v111
  v_mfma_f32_16x16x32_bf16 v[76:79], v[28:31], v[200:203], v[76:79]
  v_accvgpr_write_b32 a140, v104
  v_mfma_f32_16x16x32_bf16 v[84:87], v[28:31], v[232:235], v[84:87]
  s_waitcnt lgkmcnt(5)
  v_accvgpr_write_b32 a141, v105
  v_mfma_f32_16x16x32_bf16 v[56:59], v[32:35], v[140:143], v[56:59]
  s_waitcnt vmcnt(16)
  s_barrier
  ds_read_b128 v[24:27], v16 offset:16384
  v_accvgpr_write_b32 a142, v106
  v_mfma_f32_16x16x32_bf16 v[64:67], v[32:35], v[172:175], v[64:67]
  v_accvgpr_write_b32 a143, v107
  v_mul_f32 v112, v12, v112
  v_mfma_f32_16x16x32_bf16 v[72:75], v[32:35], v[204:207], v[72:75]
  v_mul_f32 v113, v12, v113
  v_mfma_f32_16x16x32_bf16 v[80:83], v[32:35], v[236:239], v[80:83]
  s_waitcnt lgkmcnt(5)
  v_mul_f32 v114, v12, v114
  v_mfma_f32_16x16x32_bf16 v[60:63], v[36:39], v[140:143], v[60:63]
  ds_read_b128 v[28:31], v16 offset:18432
  v_mul_f32 v115, v12, v115
  v_mfma_f32_16x16x32_bf16 v[68:71], v[36:39], v[172:175], v[68:71]
  v_mul_f32 v116, v12, v116
  v_mul_f32 v117, v12, v117
  v_mfma_f32_16x16x32_bf16 v[76:79], v[36:39], v[204:207], v[76:79]
  v_mul_f32 v118, v12, v118
  v_mfma_f32_16x16x32_bf16 v[84:87], v[36:39], v[236:239], v[84:87]
  s_waitcnt lgkmcnt(5)
  v_mul_f32 v119, v12, v119
  v_mfma_f32_16x16x32_bf16 v[56:59], v[40:43], v[144:147], v[56:59]
  ds_read_b128 v[32:35], v17 offset:16384
  v_cvt_pk_bf16_f32 v112, v112, v113
  v_mfma_f32_16x16x32_bf16 v[64:67], v[40:43], v[176:179], v[64:67]
  v_cvt_pk_bf16_f32 v113, v114, v115
  v_cvt_pk_bf16_f32 v114, v116, v117
  v_mfma_f32_16x16x32_bf16 v[72:75], v[40:43], v[208:211], v[72:75]
  v_cvt_pk_bf16_f32 v115, v118, v119
  v_mfma_f32_16x16x32_bf16 v[80:83], v[40:43], v[240:243], v[80:83]
  s_waitcnt lgkmcnt(5)
  v_accvgpr_write_b32 a196, v112
  v_mfma_f32_16x16x32_bf16 v[60:63], v[44:47], v[144:147], v[60:63]
  ds_read_b128 v[36:39], v17 offset:18432
  v_accvgpr_write_b32 a197, v113
  v_mfma_f32_16x16x32_bf16 v[68:71], v[44:47], v[176:179], v[68:71]
  v_accvgpr_write_b32 a198, v114
  v_accvgpr_write_b32 a199, v115
  v_mfma_f32_16x16x32_bf16 v[76:79], v[44:47], v[208:211], v[76:79]
  v_mfma_f32_16x16x32_bf16 v[84:87], v[44:47], v[240:243], v[84:87]
  s_waitcnt lgkmcnt(5)
  v_mfma_f32_16x16x32_bf16 v[56:59], v[48:51], v[148:151], v[56:59]
  ds_read_b128 v[40:43], v18 offset:16384
  v_mfma_f32_16x16x32_bf16 v[64:67], v[48:51], v[180:183], v[64:67]
  v_mfma_f32_16x16x32_bf16 v[72:75], v[48:51], v[212:215], v[72:75]
  v_mfma_f32_16x16x32_bf16 v[80:83], v[48:51], v[244:247], v[80:83]
  s_waitcnt lgkmcnt(5)
  v_mfma_f32_16x16x32_bf16 v[60:63], v[52:55], v[148:151], v[60:63]
  ds_read_b128 v[44:47], v18 offset:18432
  v_mfma_f32_16x16x32_bf16 v[68:71], v[52:55], v[180:183], v[68:71]
  v_mfma_f32_16x16x32_bf16 v[76:79], v[52:55], v[212:215], v[76:79]
  v_mfma_f32_16x16x32_bf16 v[84:87], v[52:55], v[244:247], v[84:87]
  s_waitcnt lgkmcnt(5)
  s_getpc_b64 s[98:99]
  s_add_u32 s98, s98, 4096
  s_addc_u32 s99, s99, 0
  global_load_dword v7, v6, s[98:99]
  v_mfma_f32_16x16x32_bf16 v[88:91], v[24:27], v[120:123], 0
  ds_read_b128 v[48:51], v19 offset:16384
  v_mfma_f32_16x16x32_bf16 v[96:99], v[24:27], v[152:155], 0
  v_mfma_f32_16x16x32_bf16 v[104:107], v[24:27], v[184:187], 0
  v_mfma_f32_16x16x32_bf16 v[112:115], v[24:27], v[216:219], 0
  s_waitcnt lgkmcnt(5)
  v_mul_f32 v56, v12, v56
  v_mfma_f32_16x16x32_bf16 v[92:95], v[28:31], v[120:123], 0
  ds_read_b128 v[52:55], v19 offset:18432
  v_mul_f32 v57, v12, v57
  v_mfma_f32_16x16x32_bf16 v[100:103], v[28:31], v[152:155], 0
  v_mul_f32 v58, v12, v58
  v_mul_f32 v59, v12, v59
  v_mfma_f32_16x16x32_bf16 v[108:111], v[28:31], v[184:187], 0
  v_mul_f32 v60, v12, v60
  v_mfma_f32_16x16x32_bf16 v[116:119], v[28:31], v[216:219], 0
  s_waitcnt lgkmcnt(5)
  v_mul_f32 v61, v12, v61
  v_mfma_f32_16x16x32_bf16 v[88:91], v[32:35], v[124:127], v[88:91]
  ds_read_b128 v[24:27], v16 offset:16640
  v_mul_f32 v62, v12, v62
  v_mfma_f32_16x16x32_bf16 v[96:99], v[32:35], v[156:159], v[96:99]
  v_mul_f32 v63, v12, v63
  v_cvt_pk_bf16_f32 v56, v56, v57
  v_mfma_f32_16x16x32_bf16 v[104:107], v[32:35], v[188:191], v[104:107]
  v_cvt_pk_bf16_f32 v57, v58, v59
  v_mfma_f32_16x16x32_bf16 v[112:115], v[32:35], v[220:223], v[112:115]
  s_waitcnt lgkmcnt(5)
  v_cvt_pk_bf16_f32 v58, v60, v61
  v_mfma_f32_16x16x32_bf16 v[92:95], v[36:39], v[124:127], v[92:95]
  ds_read_b128 v[28:31], v16 offset:18688
  v_cvt_pk_bf16_f32 v59, v62, v63
  v_mfma_f32_16x16x32_bf16 v[100:103], v[36:39], v[156:159], v[100:103]
  v_accvgpr_write_b32 a32, v56
  v_accvgpr_write_b32 a33, v57
  v_mfma_f32_16x16x32_bf16 v[108:111], v[36:39], v[188:191], v[108:111]
  v_accvgpr_write_b32 a34, v58
  v_mfma_f32_16x16x32_bf16 v[116:119], v[36:39], v[220:223], v[116:119]
  s_waitcnt lgkmcnt(5)
  v_accvgpr_write_b32 a35, v59
  v_mfma_f32_16x16x32_bf16 v[88:91], v[40:43], v[128:131], v[88:91]
  ds_read_b128 v[32:35], v17 offset:16640
  v_mul_f32 v64, v12, v64
  v_mfma_f32_16x16x32_bf16 v[96:99], v[40:43], v[160:163], v[96:99]
  v_mul_f32 v65, v12, v65
  v_mul_f32 v66, v12, v66
  v_mfma_f32_16x16x32_bf16 v[104:107], v[40:43], v[192:195], v[104:107]
  v_mul_f32 v67, v12, v67
  v_mfma_f32_16x16x32_bf16 v[112:115], v[40:43], v[224:227], v[112:115]
  s_waitcnt lgkmcnt(5)
  v_mul_f32 v68, v12, v68
  v_mfma_f32_16x16x32_bf16 v[92:95], v[44:47], v[128:131], v[92:95]
  ds_read_b128 v[36:39], v17 offset:18688
  v_mul_f32 v69, v12, v69
  v_mfma_f32_16x16x32_bf16 v[100:103], v[44:47], v[160:163], v[100:103]
  v_mul_f32 v70, v12, v70
  v_mul_f32 v71, v12, v71
  v_mfma_f32_16x16x32_bf16 v[108:111], v[44:47], v[192:195], v[108:111]
  v_cvt_pk_bf16_f32 v64, v64, v65
  v_mfma_f32_16x16x32_bf16 v[116:119], v[44:47], v[224:227], v[116:119]
  s_waitcnt lgkmcnt(5)
  v_cvt_pk_bf16_f32 v65, v66, v67
  v_mfma_f32_16x16x32_bf16 v[88:91], v[48:51], v[132:135], v[88:91]
  ds_read_b128 v[40:43], v18 offset:16640
  v_cvt_pk_bf16_f32 v66, v68, v69
  v_mfma_f32_16x16x32_bf16 v[96:99], v[48:51], v[164:167], v[96:99]
  v_cvt_pk_bf16_f32 v67, v70, v71
  v_accvgpr_write_b32 a88, v64
  v_mfma_f32_16x16x32_bf16 v[104:107], v[48:51], v[196:199], v[104:107]
  v_accvgpr_write_b32 a89, v65
  v_mfma_f32_16x16x32_bf16 v[112:115], v[48:51], v[228:231], v[112:115]
  s_waitcnt lgkmcnt(5)
  v_accvgpr_write_b32 a90, v66
  v_mfma_f32_16x16x32_bf16 v[92:95], v[52:55], v[132:135], v[92:95]
  ds_read_b128 v[44:47], v18 offset:18688
  v_accvgpr_write_b32 a91, v67
  v_mfma_f32_16x16x32_bf16 v[100:103], v[52:55], v[164:167], v[100:103]
  v_mul_f32 v72, v12, v72
  v_mul_f32 v73, v12, v73
  v_mfma_f32_16x16x32_bf16 v[108:111], v[52:55], v[196:199], v[108:111]
  v_mul_f32 v74, v12, v74
  v_mfma_f32_16x16x32_bf16 v[116:119], v[52:55], v[228:231], v[116:119]
  s_waitcnt lgkmcnt(5)
  v_mul_f32 v75, v12, v75
  v_mfma_f32_16x16x32_bf16 v[88:91], v[24:27], v[136:139], v[88:91]
  ds_read_b128 v[48:51], v19 offset:16640
  v_mul_f32 v76, v12, v76
  v_mfma_f32_16x16x32_bf16 v[96:99], v[24:27], v[168:171], v[96:99]
  v_mul_f32 v77, v12, v77
  v_mul_f32 v78, v12, v78
  v_mfma_f32_16x16x32_bf16 v[104:107], v[24:27], v[200:203], v[104:107]
  v_mul_f32 v79, v12, v79
  v_mfma_f32_16x16x32_bf16 v[112:115], v[24:27], v[232:235], v[112:115]
  s_waitcnt lgkmcnt(5)
  v_cvt_pk_bf16_f32 v72, v72, v73
  v_mfma_f32_16x16x32_bf16 v[92:95], v[28:31], v[136:139], v[92:95]
  ds_read_b128 v[52:55], v19 offset:18688
  v_cvt_pk_bf16_f32 v73, v74, v75
  v_mfma_f32_16x16x32_bf16 v[100:103], v[28:31], v[168:171], v[100:103]
  v_cvt_pk_bf16_f32 v74, v76, v77
  v_cvt_pk_bf16_f32 v75, v78, v79
  v_mfma_f32_16x16x32_bf16 v[108:111], v[28:31], v[200:203], v[108:111]
  v_accvgpr_write_b32 a144, v72
  v_mfma_f32_16x16x32_bf16 v[116:119], v[28:31], v[232:235], v[116:119]
  s_waitcnt lgkmcnt(5)
  v_accvgpr_write_b32 a145, v73
  v_mfma_f32_16x16x32_bf16 v[88:91], v[32:35], v[140:143], v[88:91]
  s_waitcnt vmcnt(12)
  s_barrier
  ds_read_b128 v[24:27], v248 offset:0
  v_accvgpr_write_b32 a146, v74
  v_mfma_f32_16x16x32_bf16 v[96:99], v[32:35], v[172:175], v[96:99]
  v_accvgpr_write_b32 a147, v75
  v_mul_f32 v80, v12, v80
  v_mfma_f32_16x16x32_bf16 v[104:107], v[32:35], v[204:207], v[104:107]
  v_mul_f32 v81, v12, v81
  v_mfma_f32_16x16x32_bf16 v[112:115], v[32:35], v[236:239], v[112:115]
  s_waitcnt lgkmcnt(5)
  v_mul_f32 v82, v12, v82
  v_mfma_f32_16x16x32_bf16 v[92:95], v[36:39], v[140:143], v[92:95]
  ds_read_b128 v[28:31], v248 offset:2048
  v_mul_f32 v83, v12, v83
  v_mfma_f32_16x16x32_bf16 v[100:103], v[36:39], v[172:175], v[100:103]
  v_mul_f32 v84, v12, v84
  v_mul_f32 v85, v12, v85
  v_mfma_f32_16x16x32_bf16 v[108:111], v[36:39], v[204:207], v[108:111]
  v_mul_f32 v86, v12, v86
  v_mfma_f32_16x16x32_bf16 v[116:119], v[36:39], v[236:239], v[116:119]
  s_waitcnt lgkmcnt(5)
  v_mul_f32 v87, v12, v87
  v_mfma_f32_16x16x32_bf16 v[88:91], v[40:43], v[144:147], v[88:91]
  ds_read_b128 v[32:35], v249 offset:0
  v_cvt_pk_bf16_f32 v80, v80, v81
  v_mfma_f32_16x16x32_bf16 v[96:99], v[40:43], v[176:179], v[96:99]
  v_cvt_pk_bf16_f32 v81, v82, v83
  v_cvt_pk_bf16_f32 v82, v84, v85
  v_mfma_f32_16x16x32_bf16 v[104:107], v[40:43], v[208:211], v[104:107]
  v_cvt_pk_bf16_f32 v83, v86, v87
  v_mfma_f32_16x16x32_bf16 v[112:115], v[40:43], v[240:243], v[112:115]
  s_waitcnt lgkmcnt(5)
  v_accvgpr_write_b32 a200, v80
  v_mfma_f32_16x16x32_bf16 v[92:95], v[44:47], v[144:147], v[92:95]
  ds_read_b128 v[36:39], v249 offset:2048
  v_accvgpr_write_b32 a201, v81
  v_mfma_f32_16x16x32_bf16 v[100:103], v[44:47], v[176:179], v[100:103]
  v_accvgpr_write_b32 a202, v82
  v_accvgpr_write_b32 a203, v83
  v_mfma_f32_16x16x32_bf16 v[108:111], v[44:47], v[208:211], v[108:111]
  v_mfma_f32_16x16x32_bf16 v[116:119], v[44:47], v[240:243], v[116:119]
  s_waitcnt lgkmcnt(5)
  v_mfma_f32_16x16x32_bf16 v[88:91], v[48:51], v[148:151], v[88:91]
  ds_read_b128 v[40:43], v250 offset:0
  v_mfma_f32_16x16x32_bf16 v[96:99], v[48:51], v[180:183], v[96:99]
  v_mfma_f32_16x16x32_bf16 v[104:107], v[48:51], v[212:215], v[104:107]
  v_mfma_f32_16x16x32_bf16 v[112:115], v[48:51], v[244:247], v[112:115]
  s_waitcnt lgkmcnt(5)
  v_mfma_f32_16x16x32_bf16 v[92:95], v[52:55], v[148:151], v[92:95]
  ds_read_b128 v[44:47], v250 offset:2048
  v_mfma_f32_16x16x32_bf16 v[100:103], v[52:55], v[180:183], v[100:103]
  v_mfma_f32_16x16x32_bf16 v[108:111], v[52:55], v[212:215], v[108:111]
  v_mfma_f32_16x16x32_bf16 v[116:119], v[52:55], v[244:247], v[116:119]
  s_waitcnt lgkmcnt(5)
  v_mfma_f32_16x16x32_bf16 v[56:59], v[24:27], v[120:123], 0
  ds_read_b128 v[48:51], v251 offset:0
  v_mfma_f32_16x16x32_bf16 v[64:67], v[24:27], v[152:155], 0
  v_mfma_f32_16x16x32_bf16 v[72:75], v[24:27], v[184:187], 0
  v_mfma_f32_16x16x32_bf16 v[80:83], v[24:27], v[216:219], 0
  s_waitcnt lgkmcnt(5)
  v_mul_f32 v88, v12, v88
  v_mfma_f32_16x16x32_bf16 v[60:63], v[28:31], v[120:123], 0
  ds_read_b128 v[52:55], v251 offset:2048
  v_mul_f32 v89, v12, v89
  v_mfma_f32_16x16x32_bf16 v[68:71], v[28:31], v[152:155], 0
  v_mul_f32 v90, v12, v90
  v_mul_f32 v91, v12, v91
  v_mfma_f32_16x16x32_bf16 v[76:79], v[28:31], v[184:187], 0
  v_mul_f32 v92, v12, v92
  v_mfma_f32_16x16x32_bf16 v[84:87], v[28:31], v[216:219], 0
  s_waitcnt lgkmcnt(5)
  v_mul_f32 v93, v12, v93
  v_mfma_f32_16x16x32_bf16 v[56:59], v[32:35], v[124:127], v[56:59]
  ds_read_b128 v[24:27], v248 offset:256
  v_mul_f32 v94, v12, v94
  v_mfma_f32_16x16x32_bf16 v[64:67], v[32:35], v[156:159], v[64:67]
  v_mul_f32 v95, v12, v95
  v_cvt_pk_bf16_f32 v88, v88, v89
  v_mfma_f32_16x16x32_bf16 v[72:75], v[32:35], v[188:191], v[72:75]
  v_cvt_pk_bf16_f32 v89, v90, v91
  v_mfma_f32_16x16x32_bf16 v[80:83], v[32:35], v[220:223], v[80:83]
  s_waitcnt lgkmcnt(5)
  v_cvt_pk_bf16_f32 v90, v92, v93
  v_mfma_f32_16x16x32_bf16 v[60:63], v[36:39], v[124:127], v[60:63]
  ds_read_b128 v[28:31], v248 offset:2304
  v_cvt_pk_bf16_f32 v91, v94, v95
  v_mfma_f32_16x16x32_bf16 v[68:71], v[36:39], v[156:159], v[68:71]
  v_accvgpr_write_b32 a36, v88
  v_accvgpr_write_b32 a37, v89
  v_mfma_f32_16x16x32_bf16 v[76:79], v[36:39], v[188:191], v[76:79]
  v_accvgpr_write_b32 a38, v90
  v_mfma_f32_16x16x32_bf16 v[84:87], v[36:39], v[220:223], v[84:87]
  s_waitcnt lgkmcnt(5)
  v_accvgpr_write_b32 a39, v91
  v_mfma_f32_16x16x32_bf16 v[56:59], v[40:43], v[128:131], v[56:59]
  ds_read_b128 v[32:35], v249 offset:256
  v_mul_f32 v96, v12, v96
  v_mfma_f32_16x16x32_bf16 v[64:67], v[40:43], v[160:163], v[64:67]
  v_mul_f32 v97, v12, v97
  v_mul_f32 v98, v12, v98
  v_mfma_f32_16x16x32_bf16 v[72:75], v[40:43], v[192:195], v[72:75]
  v_mul_f32 v99, v12, v99
  v_mfma_f32_16x16x32_bf16 v[80:83], v[40:43], v[224:227], v[80:83]
  s_waitcnt lgkmcnt(5)
  v_mul_f32 v100, v12, v100
  v_mfma_f32_16x16x32_bf16 v[60:63], v[44:47], v[128:131], v[60:63]
  ds_read_b128 v[36:39], v249 offset:2304
  v_mul_f32 v101, v12, v101
  v_mfma_f32_16x16x32_bf16 v[68:71], v[44:47], v[160:163], v[68:71]
  v_mul_f32 v102, v12, v102
  v_mul_f32 v103, v12, v103
  v_mfma_f32_16x16x32_bf16 v[76:79], v[44:47], v[192:195], v[76:79]
  v_cvt_pk_bf16_f32 v96, v96, v97
  v_mfma_f32_16x16x32_bf16 v[84:87], v[44:47], v[224:227], v[84:87]
  s_waitcnt lgkmcnt(5)
  v_cvt_pk_bf16_f32 v97, v98, v99
  v_mfma_f32_16x16x32_bf16 v[56:59], v[48:51], v[132:135], v[56:59]
  ds_read_b128 v[40:43], v250 offset:256
  v_cvt_pk_bf16_f32 v98, v100, v101
  v_mfma_f32_16x16x32_bf16 v[64:67], v[48:51], v[164:167], v[64:67]
  v_cvt_pk_bf16_f32 v99, v102, v103
  v_accvgpr_write_b32 a92, v96
  v_mfma_f32_16x16x32_bf16 v[72:75], v[48:51], v[196:199], v[72:75]
  v_accvgpr_write_b32 a93, v97
  v_mfma_f32_16x16x32_bf16 v[80:83], v[48:51], v[228:231], v[80:83]
  s_waitcnt lgkmcnt(5)
  v_accvgpr_write_b32 a94, v98
  v_mfma_f32_16x16x32_bf16 v[60:63], v[52:55], v[132:135], v[60:63]
  ds_read_b128 v[44:47], v250 offset:2304
  v_accvgpr_write_b32 a95, v99
  v_mfma_f32_16x16x32_bf16 v[68:71], v[52:55], v[164:167], v[68:71]
  v_mul_f32 v104, v12, v104
  v_mul_f32 v105, v12, v105
  v_mfma_f32_16x16x32_bf16 v[76:79], v[52:55], v[196:199], v[76:79]
  v_mul_f32 v106, v12, v106
  v_mfma_f32_16x16x32_bf16 v[84:87], v[52:55], v[228:231], v[84:87]
  s_waitcnt lgkmcnt(5)
  v_mul_f32 v107, v12, v107
  v_mfma_f32_16x16x32_bf16 v[56:59], v[24:27], v[136:139], v[56:59]
  ds_read_b128 v[48:51], v251 offset:256
  v_mul_f32 v108, v12, v108
  v_mfma_f32_16x16x32_bf16 v[64:67], v[24:27], v[168:171], v[64:67]
  v_mul_f32 v109, v12, v109
  v_mul_f32 v110, v12, v110
  v_mfma_f32_16x16x32_bf16 v[72:75], v[24:27], v[200:203], v[72:75]
  v_mul_f32 v111, v12, v111
  v_mfma_f32_16x16x32_bf16 v[80:83], v[24:27], v[232:235], v[80:83]
  s_waitcnt lgkmcnt(5)
  v_cvt_pk_bf16_f32 v104, v104, v105
  v_mfma_f32_16x16x32_bf16 v[60:63], v[28:31], v[136:139], v[60:63]
  ds_read_b128 v[52:55], v251 offset:2304
  v_cvt_pk_bf16_f32 v105, v106, v107
  v_mfma_f32_16x16x32_bf16 v[68:71], v[28:31], v[168:171], v[68:71]
  v_cvt_pk_bf16_f32 v106, v108, v109
  v_cvt_pk_bf16_f32 v107, v110, v111
  v_mfma_f32_16x16x32_bf16 v[76:79], v[28:31], v[200:203], v[76:79]
  v_accvgpr_write_b32 a148, v104
  v_mfma_f32_16x16x32_bf16 v[84:87], v[28:31], v[232:235], v[84:87]
  s_waitcnt lgkmcnt(5)
  v_accvgpr_write_b32 a149, v105
  v_mfma_f32_16x16x32_bf16 v[56:59], v[32:35], v[140:143], v[56:59]
  s_waitcnt vmcnt(8)
  s_barrier
  ds_read_b128 v[24:27], v248 offset:16384
  v_accvgpr_write_b32 a150, v106
  v_mfma_f32_16x16x32_bf16 v[64:67], v[32:35], v[172:175], v[64:67]
  v_accvgpr_write_b32 a151, v107
  v_mul_f32 v112, v12, v112
  v_mfma_f32_16x16x32_bf16 v[72:75], v[32:35], v[204:207], v[72:75]
  v_mul_f32 v113, v12, v113
  v_mfma_f32_16x16x32_bf16 v[80:83], v[32:35], v[236:239], v[80:83]
  s_waitcnt lgkmcnt(5)
  v_mul_f32 v114, v12, v114
  v_mfma_f32_16x16x32_bf16 v[60:63], v[36:39], v[140:143], v[60:63]
  ds_read_b128 v[28:31], v248 offset:18432
  v_mul_f32 v115, v12, v115
  v_mfma_f32_16x16x32_bf16 v[68:71], v[36:39], v[172:175], v[68:71]
  v_mul_f32 v116, v12, v116
  v_mul_f32 v117, v12, v117
  v_mfma_f32_16x16x32_bf16 v[76:79], v[36:39], v[204:207], v[76:79]
  v_mul_f32 v118, v12, v118
  v_mfma_f32_16x16x32_bf16 v[84:87], v[36:39], v[236:239], v[84:87]
  s_waitcnt lgkmcnt(5)
  v_mul_f32 v119, v12, v119
  v_mfma_f32_16x16x32_bf16 v[56:59], v[40:43], v[144:147], v[56:59]
  ds_read_b128 v[32:35], v249 offset:16384
  v_cvt_pk_bf16_f32 v112, v112, v113
  v_mfma_f32_16x16x32_bf16 v[64:67], v[40:43], v[176:179], v[64:67]
  v_cvt_pk_bf16_f32 v113, v114, v115
  v_cvt_pk_bf16_f32 v114, v116, v117
  v_mfma_f32_16x16x32_bf16 v[72:75], v[40:43], v[208:211], v[72:75]
  v_cvt_pk_bf16_f32 v115, v118, v119
  v_mfma_f32_16x16x32_bf16 v[80:83], v[40:43], v[240:243], v[80:83]
  s_waitcnt lgkmcnt(5)
  v_accvgpr_write_b32 a204, v112
  v_mfma_f32_16x16x32_bf16 v[60:63], v[44:47], v[144:147], v[60:63]
  ds_read_b128 v[36:39], v249 offset:18432
  v_accvgpr_write_b32 a205, v113
  v_mfma_f32_16x16x32_bf16 v[68:71], v[44:47], v[176:179], v[68:71]
  v_accvgpr_write_b32 a206, v114
  v_accvgpr_write_b32 a207, v115
  v_mfma_f32_16x16x32_bf16 v[76:79], v[44:47], v[208:211], v[76:79]
  v_mfma_f32_16x16x32_bf16 v[84:87], v[44:47], v[240:243], v[84:87]
  s_waitcnt lgkmcnt(5)
  v_mfma_f32_16x16x32_bf16 v[56:59], v[48:51], v[148:151], v[56:59]
  ds_read_b128 v[40:43], v250 offset:16384
  v_mfma_f32_16x16x32_bf16 v[64:67], v[48:51], v[180:183], v[64:67]
  v_mfma_f32_16x16x32_bf16 v[72:75], v[48:51], v[212:215], v[72:75]
  v_mfma_f32_16x16x32_bf16 v[80:83], v[48:51], v[244:247], v[80:83]
  s_waitcnt lgkmcnt(5)
  v_mfma_f32_16x16x32_bf16 v[60:63], v[52:55], v[148:151], v[60:63]
  ds_read_b128 v[44:47], v250 offset:18432
  v_mfma_f32_16x16x32_bf16 v[68:71], v[52:55], v[180:183], v[68:71]
  v_mfma_f32_16x16x32_bf16 v[76:79], v[52:55], v[212:215], v[76:79]
  v_mfma_f32_16x16x32_bf16 v[84:87], v[52:55], v[244:247], v[84:87]
  s_waitcnt lgkmcnt(5)
  v_mfma_f32_16x16x32_bf16 v[88:91], v[24:27], v[120:123], 0
  ds_read_b128 v[48:51], v251 offset:16384
  v_mfma_f32_16x16x32_bf16 v[96:99], v[24:27], v[152:155], 0
  v_mfma_f32_16x16x32_bf16 v[104:107], v[24:27], v[184:187], 0
  v_mfma_f32_16x16x32_bf16 v[112:115], v[24:27], v[216:219], 0
  s_waitcnt lgkmcnt(5)
  v_mul_f32 v56, v12, v56
  v_mfma_f32_16x16x32_bf16 v[92:95], v[28:31], v[120:123], 0
  ds_read_b128 v[52:55], v251 offset:18432
  v_mul_f32 v57, v12, v57
  v_mfma_f32_16x16x32_bf16 v[100:103], v[28:31], v[152:155], 0
  v_mul_f32 v58, v12, v58
  v_mul_f32 v59, v12, v59
  v_mfma_f32_16x16x32_bf16 v[108:111], v[28:31], v[184:187], 0
  v_mul_f32 v60, v12, v60
  v_mfma_f32_16x16x32_bf16 v[116:119], v[28:31], v[216:219], 0
  s_waitcnt lgkmcnt(5)
  v_mul_f32 v61, v12, v61
  v_mfma_f32_16x16x32_bf16 v[88:91], v[32:35], v[124:127], v[88:91]
  ds_read_b128 v[24:27], v248 offset:16640
  v_mul_f32 v62, v12, v62
  v_mfma_f32_16x16x32_bf16 v[96:99], v[32:35], v[156:159], v[96:99]
  v_mul_f32 v63, v12, v63
  v_cvt_pk_bf16_f32 v56, v56, v57
  v_mfma_f32_16x16x32_bf16 v[104:107], v[32:35], v[188:191], v[104:107]
  v_cvt_pk_bf16_f32 v57, v58, v59
  v_mfma_f32_16x16x32_bf16 v[112:115], v[32:35], v[220:223], v[112:115]
  s_waitcnt lgkmcnt(5)
  v_cvt_pk_bf16_f32 v58, v60, v61
  v_mfma_f32_16x16x32_bf16 v[92:95], v[36:39], v[124:127], v[92:95]
  ds_read_b128 v[28:31], v248 offset:18688
  v_cvt_pk_bf16_f32 v59, v62, v63
  v_mfma_f32_16x16x32_bf16 v[100:103], v[36:39], v[156:159], v[100:103]
  v_accvgpr_write_b32 a40, v56
  v_accvgpr_write_b32 a41, v57
  v_mfma_f32_16x16x32_bf16 v[108:111], v[36:39], v[188:191], v[108:111]
  v_accvgpr_write_b32 a42, v58
  v_mfma_f32_16x16x32_bf16 v[116:119], v[36:39], v[220:223], v[116:119]
  s_waitcnt lgkmcnt(5)
  v_accvgpr_write_b32 a43, v59
  v_mfma_f32_16x16x32_bf16 v[88:91], v[40:43], v[128:131], v[88:91]
  ds_read_b128 v[32:35], v249 offset:16640
  v_mul_f32 v64, v12, v64
  v_mfma_f32_16x16x32_bf16 v[96:99], v[40:43], v[160:163], v[96:99]
  v_mul_f32 v65, v12, v65
  v_mul_f32 v66, v12, v66
  v_mfma_f32_16x16x32_bf16 v[104:107], v[40:43], v[192:195], v[104:107]
  v_mul_f32 v67, v12, v67
  v_mfma_f32_16x16x32_bf16 v[112:115], v[40:43], v[224:227], v[112:115]
  s_waitcnt lgkmcnt(5)
  v_mul_f32 v68, v12, v68
  v_mfma_f32_16x16x32_bf16 v[92:95], v[44:47], v[128:131], v[92:95]
  ds_read_b128 v[36:39], v249 offset:18688
  v_mul_f32 v69, v12, v69
  v_mfma_f32_16x16x32_bf16 v[100:103], v[44:47], v[160:163], v[100:103]
  v_mul_f32 v70, v12, v70
  v_mul_f32 v71, v12, v71
  v_mfma_f32_16x16x32_bf16 v[108:111], v[44:47], v[192:195], v[108:111]
  v_cvt_pk_bf16_f32 v64, v64, v65
  v_mfma_f32_16x16x32_bf16 v[116:119], v[44:47], v[224:227], v[116:119]
  s_waitcnt lgkmcnt(5)
  v_cvt_pk_bf16_f32 v65, v66, v67
  v_mfma_f32_16x16x32_bf16 v[88:91], v[48:51], v[132:135], v[88:91]
  ds_read_b128 v[40:43], v250 offset:16640
  v_cvt_pk_bf16_f32 v66, v68, v69
  v_mfma_f32_16x16x32_bf16 v[96:99], v[48:51], v[164:167], v[96:99]
  v_cvt_pk_bf16_f32 v67, v70, v71
  v_accvgpr_write_b32 a96, v64
  v_mfma_f32_16x16x32_bf16 v[104:107], v[48:51], v[196:199], v[104:107]
  v_accvgpr_write_b32 a97, v65
  v_mfma_f32_16x16x32_bf16 v[112:115], v[48:51], v[228:231], v[112:115]
  s_waitcnt lgkmcnt(5)
  v_accvgpr_write_b32 a98, v66
  v_mfma_f32_16x16x32_bf16 v[92:95], v[52:55], v[132:135], v[92:95]
  ds_read_b128 v[44:47], v250 offset:18688
  v_accvgpr_write_b32 a99, v67
  v_mfma_f32_16x16x32_bf16 v[100:103], v[52:55], v[164:167], v[100:103]
  v_mul_f32 v72, v12, v72
  v_mul_f32 v73, v12, v73
  v_mfma_f32_16x16x32_bf16 v[108:111], v[52:55], v[196:199], v[108:111]
  v_mul_f32 v74, v12, v74
  v_mfma_f32_16x16x32_bf16 v[116:119], v[52:55], v[228:231], v[116:119]
  s_waitcnt lgkmcnt(5)
  v_mul_f32 v75, v12, v75
  v_mfma_f32_16x16x32_bf16 v[88:91], v[24:27], v[136:139], v[88:91]
  ds_read_b128 v[48:51], v251 offset:16640
  v_mul_f32 v76, v12, v76
  v_mfma_f32_16x16x32_bf16 v[96:99], v[24:27], v[168:171], v[96:99]
  v_mul_f32 v77, v12, v77
  v_mul_f32 v78, v12, v78
  v_mfma_f32_16x16x32_bf16 v[104:107], v[24:27], v[200:203], v[104:107]
  v_mul_f32 v79, v12, v79
  v_mfma_f32_16x16x32_bf16 v[112:115], v[24:27], v[232:235], v[112:115]
  s_waitcnt lgkmcnt(5)
  v_cvt_pk_bf16_f32 v72, v72, v73
  v_mfma_f32_16x16x32_bf16 v[92:95], v[28:31], v[136:139], v[92:95]
  ds_read_b128 v[52:55], v251 offset:18688
  v_cvt_pk_bf16_f32 v73, v74, v75
  v_mfma_f32_16x16x32_bf16 v[100:103], v[28:31], v[168:171], v[100:103]
  v_cvt_pk_bf16_f32 v74, v76, v77
  v_cvt_pk_bf16_f32 v75, v78, v79
  v_mfma_f32_16x16x32_bf16 v[108:111], v[28:31], v[200:203], v[108:111]
  v_accvgpr_write_b32 a152, v72
  v_mfma_f32_16x16x32_bf16 v[116:119], v[28:31], v[232:235], v[116:119]
  s_waitcnt lgkmcnt(5)
  v_accvgpr_write_b32 a153, v73
  v_mfma_f32_16x16x32_bf16 v[88:91], v[32:35], v[140:143], v[88:91]
  s_waitcnt vmcnt(4)
  s_barrier
  ds_read_b128 v[24:27], v248 offset:32768
  v_accvgpr_write_b32 a154, v74
  v_mfma_f32_16x16x32_bf16 v[96:99], v[32:35], v[172:175], v[96:99]
  v_accvgpr_write_b32 a155, v75
  v_mul_f32 v80, v12, v80
  v_mfma_f32_16x16x32_bf16 v[104:107], v[32:35], v[204:207], v[104:107]
  v_mul_f32 v81, v12, v81
  v_mfma_f32_16x16x32_bf16 v[112:115], v[32:35], v[236:239], v[112:115]
  s_waitcnt lgkmcnt(5)
  v_mul_f32 v82, v12, v82
  v_mfma_f32_16x16x32_bf16 v[92:95], v[36:39], v[140:143], v[92:95]
  ds_read_b128 v[28:31], v248 offset:34816
  v_mul_f32 v83, v12, v83
  v_mfma_f32_16x16x32_bf16 v[100:103], v[36:39], v[172:175], v[100:103]
  v_mul_f32 v84, v12, v84
  v_mul_f32 v85, v12, v85
  v_mfma_f32_16x16x32_bf16 v[108:111], v[36:39], v[204:207], v[108:111]
  v_mul_f32 v86, v12, v86
  v_mfma_f32_16x16x32_bf16 v[116:119], v[36:39], v[236:239], v[116:119]
  s_waitcnt lgkmcnt(5)
  v_mul_f32 v87, v12, v87
  v_mfma_f32_16x16x32_bf16 v[88:91], v[40:43], v[144:147], v[88:91]
  ds_read_b128 v[32:35], v249 offset:32768
  v_cvt_pk_bf16_f32 v80, v80, v81
  v_mfma_f32_16x16x32_bf16 v[96:99], v[40:43], v[176:179], v[96:99]
  v_cvt_pk_bf16_f32 v81, v82, v83
  v_cvt_pk_bf16_f32 v82, v84, v85
  v_mfma_f32_16x16x32_bf16 v[104:107], v[40:43], v[208:211], v[104:107]
  v_cvt_pk_bf16_f32 v83, v86, v87
  v_mfma_f32_16x16x32_bf16 v[112:115], v[40:43], v[240:243], v[112:115]
  s_waitcnt lgkmcnt(5)
  v_accvgpr_write_b32 a208, v80
  v_mfma_f32_16x16x32_bf16 v[92:95], v[44:47], v[144:147], v[92:95]
  ds_read_b128 v[36:39], v249 offset:34816
  v_accvgpr_write_b32 a209, v81
  v_mfma_f32_16x16x32_bf16 v[100:103], v[44:47], v[176:179], v[100:103]
  v_accvgpr_write_b32 a210, v82
  v_accvgpr_write_b32 a211, v83
  v_mfma_f32_16x16x32_bf16 v[108:111], v[44:47], v[208:211], v[108:111]
  v_mfma_f32_16x16x32_bf16 v[116:119], v[44:47], v[240:243], v[116:119]
  s_waitcnt lgkmcnt(5)
  v_mfma_f32_16x16x32_bf16 v[88:91], v[48:51], v[148:151], v[88:91]
  ds_read_b128 v[40:43], v250 offset:32768
  v_mfma_f32_16x16x32_bf16 v[96:99], v[48:51], v[180:183], v[96:99]
  v_mfma_f32_16x16x32_bf16 v[104:107], v[48:51], v[212:215], v[104:107]
  v_mfma_f32_16x16x32_bf16 v[112:115], v[48:51], v[244:247], v[112:115]
  s_waitcnt lgkmcnt(5)
  v_mfma_f32_16x16x32_bf16 v[92:95], v[52:55], v[148:151], v[92:95]
  ds_read_b128 v[44:47], v250 offset:34816
  v_mfma_f32_16x16x32_bf16 v[100:103], v[52:55], v[180:183], v[100:103]
  v_mfma_f32_16x16x32_bf16 v[108:111], v[52:55], v[212:215], v[108:111]
  v_mfma_f32_16x16x32_bf16 v[116:119], v[52:55], v[244:247], v[116:119]
  s_waitcnt lgkmcnt(5)
  v_mfma_f32_16x16x32_bf16 v[56:59], v[24:27], v[120:123], 0
  ds_read_b128 v[48:51], v251 offset:32768
  v_mfma_f32_16x16x32_bf16 v[64:67], v[24:27], v[152:155], 0
  v_mfma_f32_16x16x32_bf16 v[72:75], v[24:27], v[184:187], 0
  v_mfma_f32_16x16x32_bf16 v[80:83], v[24:27], v[216:219], 0
  s_waitcnt lgkmcnt(5)
  v_mul_f32 v88, v12, v88
  v_mfma_f32_16x16x32_bf16 v[60:63], v[28:31], v[120:123], 0
  ds_read_b128 v[52:55], v251 offset:34816
  v_mul_f32 v89, v12, v89
  v_mfma_f32_16x16x32_bf16 v[68:71], v[28:31], v[152:155], 0
  v_mul_f32 v90, v12, v90
  v_mul_f32 v91, v12, v91
  v_mfma_f32_16x16x32_bf16 v[76:79], v[28:31], v[184:187], 0
  v_mul_f32 v92, v12, v92
  v_mfma_f32_16x16x32_bf16 v[84:87], v[28:31], v[216:219], 0
  s_waitcnt lgkmcnt(5)
  v_mul_f32 v93, v12, v93
  v_mfma_f32_16x16x32_bf16 v[56:59], v[32:35], v[124:127], v[56:59]
  ds_read_b128 v[24:27], v248 offset:33024
  v_mul_f32 v94, v12, v94
  v_mfma_f32_16x16x32_bf16 v[64:67], v[32:35], v[156:159], v[64:67]
  v_mul_f32 v95, v12, v95
  v_cvt_pk_bf16_f32 v88, v88, v89
  v_mfma_f32_16x16x32_bf16 v[72:75], v[32:35], v[188:191], v[72:75]
  v_mfma_f32_16x16x32_bf16 v[80:83], v[32:35], v[220:223], v[80:83]
  s_waitcnt lgkmcnt(5)
  v_cvt_pk_bf16_f32 v89, v90, v91
  v_mfma_f32_16x16x32_bf16 v[60:63], v[36:39], v[124:127], v[60:63]
  ds_read_b128 v[28:31], v248 offset:35072
  v_cvt_pk_bf16_f32 v90, v92, v93
  v_mfma_f32_16x16x32_bf16 v[68:71], v[36:39], v[156:159], v[68:71]
  v_cvt_pk_bf16_f32 v91, v94, v95
  v_accvgpr_write_b32 a44, v88
  v_mfma_f32_16x16x32_bf16 v[76:79], v[36:39], v[188:191], v[76:79]
  v_accvgpr_write_b32 a45, v89
  v_mfma_f32_16x16x32_bf16 v[84:87], v[36:39], v[220:223], v[84:87]
  s_waitcnt lgkmcnt(5)
  v_accvgpr_write_b32 a46, v90
  v_mfma_f32_16x16x32_bf16 v[56:59], v[40:43], v[128:131], v[56:59]
  ds_read_b128 v[32:35], v249 offset:33024
  v_accvgpr_write_b32 a47, v91
  v_mfma_f32_16x16x32_bf16 v[64:67], v[40:43], v[160:163], v[64:67]
  v_mul_f32 v96, v12, v96
  v_mul_f32 v97, v12, v97
  v_mfma_f32_16x16x32_bf16 v[72:75], v[40:43], v[192:195], v[72:75]
  v_mfma_f32_16x16x32_bf16 v[80:83], v[40:43], v[224:227], v[80:83]
  s_waitcnt lgkmcnt(5)
  v_mul_f32 v98, v12, v98
  v_mfma_f32_16x16x32_bf16 v[60:63], v[44:47], v[128:131], v[60:63]
  ds_read_b128 v[36:39], v249 offset:35072
  v_mul_f32 v99, v12, v99
  v_mfma_f32_16x16x32_bf16 v[68:71], v[44:47], v[160:163], v[68:71]
  v_mul_f32 v100, v12, v100
  v_mul_f32 v101, v12, v101
  v_mfma_f32_16x16x32_bf16 v[76:79], v[44:47], v[192:195], v[76:79]
  v_mul_f32 v102, v12, v102
  v_mfma_f32_16x16x32_bf16 v[84:87], v[44:47], v[224:227], v[84:87]
  s_waitcnt lgkmcnt(5)
  v_mul_f32 v103, v12, v103
  v_mfma_f32_16x16x32_bf16 v[56:59], v[48:51], v[132:135], v[56:59]
  ds_read_b128 v[40:43], v250 offset:33024
  v_cvt_pk_bf16_f32 v96, v96, v97
  v_mfma_f32_16x16x32_bf16 v[64:67], v[48:51], v[164:167], v[64:67]
  v_cvt_pk_bf16_f32 v97, v98, v99
  v_cvt_pk_bf16_f32 v98, v100, v101
  v_mfma_f32_16x16x32_bf16 v[72:75], v[48:51], v[196:199], v[72:75]
  v_mfma_f32_16x16x32_bf16 v[80:83], v[48:51], v[228:231], v[80:83]
  s_waitcnt lgkmcnt(5)
  v_cvt_pk_bf16_f32 v99, v102, v103
  v_mfma_f32_16x16x32_bf16 v[60:63], v[52:55], v[132:135], v[60:63]
  ds_read_b128 v[44:47], v250 offset:35072
  v_accvgpr_write_b32 a100, v96
  v_mfma_f32_16x16x32_bf16 v[68:71], v[52:55], v[164:167], v[68:71]
  v_accvgpr_write_b32 a101, v97
  v_accvgpr_write_b32 a102, v98
  v_mfma_f32_16x16x32_bf16 v[76:79], v[52:55], v[196:199], v[76:79]
  v_accvgpr_write_b32 a103, v99
  v_mfma_f32_16x16x32_bf16 v[84:87], v[52:55], v[228:231], v[84:87]
  s_waitcnt lgkmcnt(5)
  v_mul_f32 v104, v12, v104
  v_mfma_f32_16x16x32_bf16 v[56:59], v[24:27], v[136:139], v[56:59]
  ds_read_b128 v[48:51], v251 offset:33024
  v_mul_f32 v105, v12, v105
  v_mfma_f32_16x16x32_bf16 v[64:67], v[24:27], v[168:171], v[64:67]
  v_mul_f32 v106, v12, v106
  v_mul_f32 v107, v12, v107
  v_mfma_f32_16x16x32_bf16 v[72:75], v[24:27], v[200:203], v[72:75]
  v_mfma_f32_16x16x32_bf16 v[80:83], v[24:27], v[232:235], v[80:83]
  s_waitcnt lgkmcnt(5)
  v_mul_f32 v108, v12, v108
  v_mfma_f32_16x16x32_bf16 v[60:63], v[28:31], v[136:139], v[60:63]
  ds_read_b128 v[52:55], v251 offset:35072
  v_mul_f32 v109, v12, v109
  v_mfma_f32_16x16x32_bf16 v[68:71], v[28:31], v[168:171], v[68:71]
  v_mul_f32 v110, v12, v110
  v_mul_f32 v111, v12, v111
  v_mfma_f32_16x16x32_bf16 v[76:79], v[28:31], v[200:203], v[76:79]
  v_cvt_pk_bf16_f32 v104, v104, v105
  v_mfma_f32_16x16x32_bf16 v[84:87], v[28:31], v[232:235], v[84:87]
  s_waitcnt lgkmcnt(5)
  v_cvt_pk_bf16_f32 v105, v106, v107
  v_mfma_f32_16x16x32_bf16 v[56:59], v[32:35], v[140:143], v[56:59]
  s_waitcnt vmcnt(0)
  s_barrier
  ds_read_b128 v[24:27], v248 offset:49152
  v_cvt_pk_bf16_f32 v106, v108, v109
  v_mfma_f32_16x16x32_bf16 v[64:67], v[32:35], v[172:175], v[64:67]
  v_cvt_pk_bf16_f32 v107, v110, v111
  v_accvgpr_write_b32 a156, v104
  v_mfma_f32_16x16x32_bf16 v[72:75], v[32:35], v[204:207], v[72:75]
  v_mfma_f32_16x16x32_bf16 v[80:83], v[32:35], v[236:239], v[80:83]
  s_waitcnt lgkmcnt(5)
  v_accvgpr_write_b32 a157, v105
  v_mfma_f32_16x16x32_bf16 v[60:63], v[36:39], v[140:143], v[60:63]
  ds_read_b128 v[28:31], v248 offset:51200
  v_accvgpr_write_b32 a158, v106
  v_mfma_f32_16x16x32_bf16 v[68:71], v[36:39], v[172:175], v[68:71]
  v_accvgpr_write_b32 a159, v107
  v_mul_f32 v112, v12, v112
  v_mfma_f32_16x16x32_bf16 v[76:79], v[36:39], v[204:207], v[76:79]
  v_mul_f32 v113, v12, v113
  v_mfma_f32_16x16x32_bf16 v[84:87], v[36:39], v[236:239], v[84:87]
  s_waitcnt lgkmcnt(5)
  v_mul_f32 v114, v12, v114
  v_mfma_f32_16x16x32_bf16 v[56:59], v[40:43], v[144:147], v[56:59]
  ds_read_b128 v[32:35], v249 offset:49152
  v_mul_f32 v115, v12, v115
  v_mfma_f32_16x16x32_bf16 v[64:67], v[40:43], v[176:179], v[64:67]
  v_mul_f32 v116, v12, v116
  v_mul_f32 v117, v12, v117
  v_mfma_f32_16x16x32_bf16 v[72:75], v[40:43], v[208:211], v[72:75]
  v_readfirstlane_b32 s86, v13
  s_lshl_b32 s22, s17, 7
  s_add_u32 s22, s22, 584192
  s_mov_b32 s23, 586240
  buffer_load_dword v13, off, s[8:11], s22 sc1
  buffer_load_dwordx2 v[10:11], off, s[8:11], s23 sc1
  v_mfma_f32_16x16x32_bf16 v[80:83], v[40:43], v[240:243], v[80:83]
  s_waitcnt lgkmcnt(5)
  v_mul_f32 v118, v12, v118
  v_mfma_f32_16x16x32_bf16 v[60:63], v[44:47], v[144:147], v[60:63]
  ds_read_b128 v[36:39], v249 offset:51200
  v_mul_f32 v119, v12, v119
  v_mfma_f32_16x16x32_bf16 v[68:71], v[44:47], v[176:179], v[68:71]
  v_cvt_pk_bf16_f32 v112, v112, v113
  v_cvt_pk_bf16_f32 v113, v114, v115
  v_mfma_f32_16x16x32_bf16 v[76:79], v[44:47], v[208:211], v[76:79]
  v_cvt_pk_bf16_f32 v114, v116, v117
  v_mfma_f32_16x16x32_bf16 v[84:87], v[44:47], v[240:243], v[84:87]
  s_waitcnt lgkmcnt(5)
  v_cvt_pk_bf16_f32 v115, v118, v119
  v_mfma_f32_16x16x32_bf16 v[56:59], v[48:51], v[148:151], v[56:59]
  ds_read_b128 v[40:43], v250 offset:49152
  v_accvgpr_write_b32 a212, v112
  v_mfma_f32_16x16x32_bf16 v[64:67], v[48:51], v[180:183], v[64:67]
  v_accvgpr_write_b32 a213, v113
  v_accvgpr_write_b32 a214, v114
  v_mfma_f32_16x16x32_bf16 v[72:75], v[48:51], v[212:215], v[72:75]
  v_accvgpr_write_b32 a215, v115
  v_mfma_f32_16x16x32_bf16 v[80:83], v[48:51], v[244:247], v[80:83]
  s_waitcnt lgkmcnt(5)
  v_mfma_f32_16x16x32_bf16 v[60:63], v[52:55], v[148:151], v[60:63]
  ds_read_b128 v[44:47], v250 offset:51200
  v_mfma_f32_16x16x32_bf16 v[68:71], v[52:55], v[180:183], v[68:71]
  v_mfma_f32_16x16x32_bf16 v[76:79], v[52:55], v[212:215], v[76:79]
  v_mfma_f32_16x16x32_bf16 v[84:87], v[52:55], v[244:247], v[84:87]
  s_waitcnt lgkmcnt(5)
  v_mfma_f32_16x16x32_bf16 v[88:91], v[24:27], v[120:123], 0
  ds_read_b128 v[48:51], v251 offset:49152
  v_mfma_f32_16x16x32_bf16 v[96:99], v[24:27], v[152:155], 0
  v_mfma_f32_16x16x32_bf16 v[104:107], v[24:27], v[184:187], 0
  v_mfma_f32_16x16x32_bf16 v[112:115], v[24:27], v[216:219], 0
  s_waitcnt lgkmcnt(5)
  v_mul_f32 v56, v12, v56
  v_mfma_f32_16x16x32_bf16 v[92:95], v[28:31], v[120:123], 0
  ds_read_b128 v[52:55], v251 offset:51200
  v_mul_f32 v57, v12, v57
  v_mfma_f32_16x16x32_bf16 v[100:103], v[28:31], v[152:155], 0
  v_mul_f32 v58, v12, v58
  v_mul_f32 v59, v12, v59
  v_mfma_f32_16x16x32_bf16 v[108:111], v[28:31], v[184:187], 0
  v_mul_f32 v60, v12, v60
  v_mfma_f32_16x16x32_bf16 v[116:119], v[28:31], v[216:219], 0
  s_waitcnt lgkmcnt(5)
  v_mul_f32 v61, v12, v61
  v_mfma_f32_16x16x32_bf16 v[88:91], v[32:35], v[124:127], v[88:91]
  ds_read_b128 v[24:27], v248 offset:49408
  v_mul_f32 v62, v12, v62
  v_mfma_f32_16x16x32_bf16 v[96:99], v[32:35], v[156:159], v[96:99]
  v_mul_f32 v63, v12, v63
  v_cvt_pk_bf16_f32 v56, v56, v57
  v_mfma_f32_16x16x32_bf16 v[104:107], v[32:35], v[188:191], v[104:107]
  v_cvt_pk_bf16_f32 v57, v58, v59
  v_mfma_f32_16x16x32_bf16 v[112:115], v[32:35], v[220:223], v[112:115]
  s_waitcnt lgkmcnt(5)
  v_cvt_pk_bf16_f32 v58, v60, v61
  v_mfma_f32_16x16x32_bf16 v[92:95], v[36:39], v[124:127], v[92:95]
  ds_read_b128 v[28:31], v248 offset:51456
  v_cvt_pk_bf16_f32 v59, v62, v63
  v_mfma_f32_16x16x32_bf16 v[100:103], v[36:39], v[156:159], v[100:103]
  v_accvgpr_write_b32 a48, v56
  v_accvgpr_write_b32 a49, v57
  v_mfma_f32_16x16x32_bf16 v[108:111], v[36:39], v[188:191], v[108:111]
  v_accvgpr_write_b32 a50, v58
  v_mfma_f32_16x16x32_bf16 v[116:119], v[36:39], v[220:223], v[116:119]
  s_waitcnt lgkmcnt(5)
  v_accvgpr_write_b32 a51, v59
  v_mfma_f32_16x16x32_bf16 v[88:91], v[40:43], v[128:131], v[88:91]
  ds_read_b128 v[32:35], v249 offset:49408
  v_mul_f32 v64, v12, v64
  v_mfma_f32_16x16x32_bf16 v[96:99], v[40:43], v[160:163], v[96:99]
  v_mul_f32 v65, v12, v65
  v_mul_f32 v66, v12, v66
  v_mfma_f32_16x16x32_bf16 v[104:107], v[40:43], v[192:195], v[104:107]
  v_mul_f32 v67, v12, v67
  v_mfma_f32_16x16x32_bf16 v[112:115], v[40:43], v[224:227], v[112:115]
  s_waitcnt lgkmcnt(5)
  v_mul_f32 v68, v12, v68
  v_mfma_f32_16x16x32_bf16 v[92:95], v[44:47], v[128:131], v[92:95]
  ds_read_b128 v[36:39], v249 offset:51456
  v_mul_f32 v69, v12, v69
  v_mfma_f32_16x16x32_bf16 v[100:103], v[44:47], v[160:163], v[100:103]
  v_mul_f32 v70, v12, v70
  v_mul_f32 v71, v12, v71
  v_mfma_f32_16x16x32_bf16 v[108:111], v[44:47], v[192:195], v[108:111]
  v_cvt_pk_bf16_f32 v64, v64, v65
  v_mfma_f32_16x16x32_bf16 v[116:119], v[44:47], v[224:227], v[116:119]
  s_waitcnt lgkmcnt(5)
  v_cvt_pk_bf16_f32 v65, v66, v67
  v_mfma_f32_16x16x32_bf16 v[88:91], v[48:51], v[132:135], v[88:91]
  ds_read_b128 v[40:43], v250 offset:49408
  v_cvt_pk_bf16_f32 v66, v68, v69
  v_mfma_f32_16x16x32_bf16 v[96:99], v[48:51], v[164:167], v[96:99]
  v_cvt_pk_bf16_f32 v67, v70, v71
  v_accvgpr_write_b32 a104, v64
  v_mfma_f32_16x16x32_bf16 v[104:107], v[48:51], v[196:199], v[104:107]
  v_accvgpr_write_b32 a105, v65
  v_mfma_f32_16x16x32_bf16 v[112:115], v[48:51], v[228:231], v[112:115]
  s_waitcnt lgkmcnt(5)
  v_accvgpr_write_b32 a106, v66
  v_mfma_f32_16x16x32_bf16 v[92:95], v[52:55], v[132:135], v[92:95]
  ds_read_b128 v[44:47], v250 offset:51456
  v_accvgpr_write_b32 a107, v67
  v_mfma_f32_16x16x32_bf16 v[100:103], v[52:55], v[164:167], v[100:103]
  v_mul_f32 v72, v12, v72
  v_mul_f32 v73, v12, v73
  v_mfma_f32_16x16x32_bf16 v[108:111], v[52:55], v[196:199], v[108:111]
  v_mul_f32 v74, v12, v74
  v_mfma_f32_16x16x32_bf16 v[116:119], v[52:55], v[228:231], v[116:119]
  s_waitcnt lgkmcnt(5)
  v_mul_f32 v75, v12, v75
  v_mfma_f32_16x16x32_bf16 v[88:91], v[24:27], v[136:139], v[88:91]
  ds_read_b128 v[48:51], v251 offset:49408
  v_mul_f32 v76, v12, v76
  v_mfma_f32_16x16x32_bf16 v[96:99], v[24:27], v[168:171], v[96:99]
  v_mul_f32 v77, v12, v77
  v_mul_f32 v78, v12, v78
  v_mfma_f32_16x16x32_bf16 v[104:107], v[24:27], v[200:203], v[104:107]
  v_mul_f32 v79, v12, v79
  v_mfma_f32_16x16x32_bf16 v[112:115], v[24:27], v[232:235], v[112:115]
  s_waitcnt lgkmcnt(5)
  v_cvt_pk_bf16_f32 v72, v72, v73
  v_mfma_f32_16x16x32_bf16 v[92:95], v[28:31], v[136:139], v[92:95]
  ds_read_b128 v[52:55], v251 offset:51456
  v_cvt_pk_bf16_f32 v73, v74, v75
  v_mfma_f32_16x16x32_bf16 v[100:103], v[28:31], v[168:171], v[100:103]
  v_cvt_pk_bf16_f32 v74, v76, v77
  v_cvt_pk_bf16_f32 v75, v78, v79
  v_mfma_f32_16x16x32_bf16 v[108:111], v[28:31], v[200:203], v[108:111]
  v_accvgpr_write_b32 a160, v72
  v_mfma_f32_16x16x32_bf16 v[116:119], v[28:31], v[232:235], v[116:119]
  s_waitcnt lgkmcnt(5)
  v_accvgpr_write_b32 a161, v73
  v_mfma_f32_16x16x32_bf16 v[88:91], v[32:35], v[140:143], v[88:91]
  v_accvgpr_write_b32 a162, v74
  v_mfma_f32_16x16x32_bf16 v[96:99], v[32:35], v[172:175], v[96:99]
  v_accvgpr_write_b32 a163, v75
  v_mul_f32 v80, v12, v80
  v_mfma_f32_16x16x32_bf16 v[104:107], v[32:35], v[204:207], v[104:107]
  v_mul_f32 v81, v12, v81
  v_mfma_f32_16x16x32_bf16 v[112:115], v[32:35], v[236:239], v[112:115]
  s_waitcnt lgkmcnt(4)
  v_mul_f32 v82, v12, v82
  v_mfma_f32_16x16x32_bf16 v[92:95], v[36:39], v[140:143], v[92:95]
  v_mul_f32 v83, v12, v83
  v_mfma_f32_16x16x32_bf16 v[100:103], v[36:39], v[172:175], v[100:103]
  v_mul_f32 v84, v12, v84
  v_mul_f32 v85, v12, v85
  v_mfma_f32_16x16x32_bf16 v[108:111], v[36:39], v[204:207], v[108:111]
  v_mul_f32 v86, v12, v86
  v_mfma_f32_16x16x32_bf16 v[116:119], v[36:39], v[236:239], v[116:119]
  s_waitcnt lgkmcnt(3)
  v_mul_f32 v87, v12, v87
  v_mfma_f32_16x16x32_bf16 v[88:91], v[40:43], v[144:147], v[88:91]
  v_cvt_pk_bf16_f32 v80, v80, v81
  v_mfma_f32_16x16x32_bf16 v[96:99], v[40:43], v[176:179], v[96:99]
  v_cvt_pk_bf16_f32 v81, v82, v83
  v_cvt_pk_bf16_f32 v82, v84, v85
  v_mfma_f32_16x16x32_bf16 v[104:107], v[40:43], v[208:211], v[104:107]
  v_cvt_pk_bf16_f32 v83, v86, v87
  v_mfma_f32_16x16x32_bf16 v[112:115], v[40:43], v[240:243], v[112:115]
  s_waitcnt lgkmcnt(2)
  v_accvgpr_write_b32 a216, v80
  v_mfma_f32_16x16x32_bf16 v[92:95], v[44:47], v[144:147], v[92:95]
  v_accvgpr_write_b32 a217, v81
  v_mfma_f32_16x16x32_bf16 v[100:103], v[44:47], v[176:179], v[100:103]
  v_accvgpr_write_b32 a218, v82
  v_accvgpr_write_b32 a219, v83
  v_mfma_f32_16x16x32_bf16 v[108:111], v[44:47], v[208:211], v[108:111]
  v_mfma_f32_16x16x32_bf16 v[116:119], v[44:47], v[240:243], v[116:119]
  s_waitcnt lgkmcnt(1)
  v_mfma_f32_16x16x32_bf16 v[88:91], v[48:51], v[148:151], v[88:91]
  v_mfma_f32_16x16x32_bf16 v[96:99], v[48:51], v[180:183], v[96:99]
  v_mfma_f32_16x16x32_bf16 v[104:107], v[48:51], v[212:215], v[104:107]
  v_mfma_f32_16x16x32_bf16 v[112:115], v[48:51], v[244:247], v[112:115]
  s_waitcnt lgkmcnt(0)
  v_mfma_f32_16x16x32_bf16 v[92:95], v[52:55], v[148:151], v[92:95]
  v_mfma_f32_16x16x32_bf16 v[100:103], v[52:55], v[180:183], v[100:103]
  v_mfma_f32_16x16x32_bf16 v[108:111], v[52:55], v[212:215], v[108:111]
  v_mfma_f32_16x16x32_bf16 v[116:119], v[52:55], v[244:247], v[116:119]
  v_mul_f32 v88, v12, v88
  v_mul_f32 v89, v12, v89
  v_mul_f32 v90, v12, v90
  v_mul_f32 v91, v12, v91
  v_mul_f32 v92, v12, v92
  v_mul_f32 v93, v12, v93
  v_mul_f32 v94, v12, v94
  v_mul_f32 v95, v12, v95
  v_cvt_pk_bf16_f32 v88, v88, v89
  v_cvt_pk_bf16_f32 v89, v90, v91
  v_cvt_pk_bf16_f32 v90, v92, v93
  v_cvt_pk_bf16_f32 v91, v94, v95
  v_accvgpr_write_b32 a52, v88
  v_accvgpr_write_b32 a53, v89
  v_accvgpr_write_b32 a54, v90
  v_accvgpr_write_b32 a55, v91
  v_mul_f32 v96, v12, v96
  v_mul_f32 v97, v12, v97
  v_mul_f32 v98, v12, v98
  v_mul_f32 v99, v12, v99
  v_mul_f32 v100, v12, v100
  v_mul_f32 v101, v12, v101
  v_mul_f32 v102, v12, v102
  v_mul_f32 v103, v12, v103
  v_cvt_pk_bf16_f32 v96, v96, v97
  v_cvt_pk_bf16_f32 v97, v98, v99
  v_cvt_pk_bf16_f32 v98, v100, v101
  v_cvt_pk_bf16_f32 v99, v102, v103
  v_accvgpr_write_b32 a108, v96
  v_accvgpr_write_b32 a109, v97
  v_accvgpr_write_b32 a110, v98
  v_accvgpr_write_b32 a111, v99
  v_mul_f32 v104, v12, v104
  v_mul_f32 v105, v12, v105
  v_mul_f32 v106, v12, v106
  v_mul_f32 v107, v12, v107
  v_mul_f32 v108, v12, v108
  v_mul_f32 v109, v12, v109
  v_mul_f32 v110, v12, v110
  v_mul_f32 v111, v12, v111
  v_cvt_pk_bf16_f32 v104, v104, v105
  v_cvt_pk_bf16_f32 v105, v106, v107
  v_cvt_pk_bf16_f32 v106, v108, v109
  v_cvt_pk_bf16_f32 v107, v110, v111
  v_accvgpr_write_b32 a164, v104
  v_accvgpr_write_b32 a165, v105
  v_accvgpr_write_b32 a166, v106
  v_accvgpr_write_b32 a167, v107
  v_mul_f32 v112, v12, v112
  v_mul_f32 v113, v12, v113
  v_mul_f32 v114, v12, v114
  v_mul_f32 v115, v12, v115
  v_mul_f32 v116, v12, v116
  v_mul_f32 v117, v12, v117
  v_mul_f32 v118, v12, v118
  v_mul_f32 v119, v12, v119
  v_cvt_pk_bf16_f32 v112, v112, v113
  v_cvt_pk_bf16_f32 v113, v114, v115
  v_cvt_pk_bf16_f32 v114, v116, v117
  v_cvt_pk_bf16_f32 v115, v118, v119
  v_accvgpr_write_b32 a220, v112
  v_accvgpr_write_b32 a221, v113
  v_accvgpr_write_b32 a222, v114
  v_accvgpr_write_b32 a223, v115
  s_waitcnt vmcnt(0)
  s_barrier
  v_readfirstlane_b32 s84, v13
  v_readfirstlane_b32 s85, v10
  v_readfirstlane_b32 s22, v11
  s_and_b32 s86, s86, s22
  s_cmp_eq_u32 s86, 1
  s_cselect_b32 s84, s84, 0
  v_and_b32 v10, 0xffe0, v9
  v_cmp_eq_u32 vcc, 0, v10
  s_cbranch_vccz ch_md_ok
ch_role2:
  s_mov_b32 s30, 0
ch_md:
  buffer_load_dword v9, off, s[12:15], 0 sc1
  s_waitcnt vmcnt(0)
  v_and_b32 v10, 0xffe0, v9
  v_cmp_eq_u32 vcc, 0, v10
  s_cbranch_vccz ch_md_ok
  s_sleep 4
  s_add_u32 s30, s30, 1
  s_cmp_lt_u32 s30, 1600000
  s_cbranch_scc1 ch_md
  s_branch ch_end
ch_md_ok:
  v_readfirstlane_b32 s88, v9
  s_lshr_b32 s88, s88, 16
  v_and_b32 v1, 63, v0
  v_lshlrev_b32 v2, 4, v1
  v_lshrrev_b32 v116, 4, v1
  v_and_b32 v117, 15, v1
  v_mov_b32 v3, 0x4444
  v_mov_b32 v118, 0xeeee
  v_cmp_lt_u32 vcc, 7, v117
  s_nop 1
  v_cndmask_b32 v3, v3, v118, vcc
  s_mov_b32 s19, 0
  s_mov_b32 s18, 1
  s_mov_b32 s20, 0
  s_mov_b32 s21, 17664
  s_mov_b32 s23, 4096
  s_lshr_b32 s89, s17, 4
  s_lshl_b32 s89, s89, 2
  s_add_u32 s89, s89, s16
  s_and_b32 s17, s17, 15
  s_cmp_eq_u32 s89, 0
  s_cbranch_scc1 ch_init0
  s_cmp_eq_u32 s89, 1
  s_cbranch_scc1 ch_init1
  s_cmp_eq_u32 s89, 2
  s_cbranch_scc1 ch_init2
  s_cmp_eq_u32 s89, 3
  s_cbranch_scc1 ch_init3
  s_cmp_eq_u32 s89, 4
  s_cbranch_scc1 ch_init4
  s_cmp_eq_u32 s89, 5
  s_cbranch_scc1 ch_init5
  s_cmp_eq_u32 s89, 6
  s_cbranch_scc1 ch_init6
  s_cmp_eq_u32 s89, 7
  s_cbranch_scc1 ch_init7
  s_branch ch_end
ch_init0:
  s_mul_i32 s31, s17, 401408
  s_add_u32 s31, s31, 33554432
  s_and_b32 s28, s84, 10320
  s_lshl_b32 s22, s85, 16
  s_or_b32 s28, s28, s22
  s_cmp_eq_u32 s28, 4294912080
  s_cbranch_scc1 ch_wx0_ok
  s_mov_b32 s30, 0
ch_wr0:
  buffer_load_dword v9, off, s[12:15], 0 offset:132 sc1
  s_waitcnt vmcnt(0)
  v_cmp_ne_u32 vcc, 1, v9
  s_cbranch_vccz ch_wr0_ok
  s_sleep 8
  s_add_u32 s30, s30, 1
  s_cmp_lt_u32 s30, 400000
  s_cbranch_scc1 ch_wr0
  s_branch cA_abort
ch_wr0_ok:
  s_lshl_b32 s27, s17, 7
  s_add_u32 s27, s27, 584192
  s_mov_b32 s28, 10320
  s_mov_b32 s30, 0
ch_wb0:
  buffer_load_dword v9, off, s[8:11], s27  sc1
  s_waitcnt vmcnt(0)
  v_and_b32 v10, s28, v9
  v_cmp_ne_u32 vcc, s28, v10
  s_cbranch_vccz ch_wb0_ok
  s_sleep 3
  s_add_u32 s30, s30, 1
  s_cmp_lt_u32 s30, 400000
  s_cbranch_scc1 ch_wb0
  s_branch cA_abort
ch_wb0_ok:
  s_mov_b32 s29, 586240
  s_mov_b32 s28, 0xffff
  s_mov_b32 s30, 0
ch_wx0:
  buffer_load_dword v9, off, s[8:11], s29  sc1
  s_waitcnt vmcnt(0)
  v_and_b32 v10, s28, v9
  v_cmp_ne_u32 vcc, s28, v10
  s_cbranch_vccz ch_wx0_ok
  s_sleep 8
  s_add_u32 s30, s30, 1
  s_cmp_lt_u32 s30, 400000
  s_cbranch_scc1 ch_wx0
  s_branch cA_abort
ch_wx0_ok:
  s_add_u32 s22, s31, 229376
  buffer_load_dwordx4 a[224:227], v2, s[8:11], s22 offen offset:0 sc1
  buffer_load_dwordx4 a[228:231], v2, s[8:11], s22 offen offset:1024 sc1
  buffer_load_dwordx4 a[232:235], v2, s[8:11], s22 offen offset:2048 sc1
  buffer_load_dwordx4 a[236:239], v2, s[8:11], s22 offen offset:3072 sc1
  s_add_u32 s22, s31, 233472
  buffer_load_dwordx4 a[240:243], v2, s[8:11], s22 offen offset:0 sc1
  buffer_load_dwordx4 a[244:247], v2, s[8:11], s22 offen offset:1024 sc1
  buffer_load_dwordx4 a[248:251], v2, s[8:11], s22 offen offset:2048 sc1
  buffer_load_dwordx4 a[252:255], v2, s[8:11], s22 offen offset:3072 sc1
  s_add_u32 s22, s31, 237568
  buffer_load_dwordx4 v[120:123], v2, s[8:11], s22 offen offset:0 sc1
  buffer_load_dwordx4 v[124:127], v2, s[8:11], s22 offen offset:1024 sc1
  buffer_load_dwordx4 v[128:131], v2, s[8:11], s22 offen offset:2048 sc1
  buffer_load_dwordx4 v[132:135], v2, s[8:11], s22 offen offset:3072 sc1
  s_add_u32 s22, s31, 241664
  buffer_load_dwordx4 v[136:139], v2, s[8:11], s22 offen offset:0 sc1
  buffer_load_dwordx4 v[140:143], v2, s[8:11], s22 offen offset:1024 sc1
  buffer_load_dwordx4 v[144:147], v2, s[8:11], s22 offen offset:2048 sc1
  buffer_load_dwordx4 v[148:151], v2, s[8:11], s22 offen offset:3072 sc1
  s_add_u32 s22, s31, 245760
  buffer_load_dwordx4 v[152:155], v2, s[8:11], s22 offen offset:0 sc1
  buffer_load_dwordx4 v[156:159], v2, s[8:11], s22 offen offset:1024 sc1
  buffer_load_dwordx4 v[160:163], v2, s[8:11], s22 offen offset:2048 sc1
  buffer_load_dwordx4 v[164:167], v2, s[8:11], s22 offen offset:3072 sc1
  s_add_u32 s22, s31, 249856
  buffer_load_dwordx4 v[168:171], v2, s[8:11], s22 offen offset:0 sc1
  buffer_load_dwordx4 v[172:175], v2, s[8:11], s22 offen offset:1024 sc1
  buffer_load_dwordx4 v[176:179], v2, s[8:11], s22 offen offset:2048 sc1
  buffer_load_dwordx4 v[180:183], v2, s[8:11], s22 offen offset:3072 sc1
  s_mov_b32 s24, 655360
  s_mov_b32 s26, 669696
  v_and_b32 v64, 7, v117
  v_and_b32 v65, 1, v116
  v_lshlrev_b32 v65, 2, v65
  v_sub_u32 v64, v64, v65
  v_lshrrev_b32 v65, 3, v117
  v_lshl_add_u32 v66, v65, 2, v64
  v_cmp_gt_u32 vcc, 4, v64
  v_mov_b32 v67, 99
  s_nop 0
  v_cndmask_b32 v66, v67, v66, vcc
  v_mov_b32 v68, 0x3f80
  v_mov_b32 v69, 0x3f800000
  v_mov_b32 v4, 0
  v_cmp_eq_u32 vcc, 0, v66
  s_nop 1
  v_cndmask_b32 v4, v4, v68, vcc
  v_cmp_eq_u32 vcc, 1, v66
  s_nop 1
  v_cndmask_b32 v4, v4, v69, vcc
  v_mov_b32 v5, 0
  v_cmp_eq_u32 vcc, 2, v66
  s_nop 1
  v_cndmask_b32 v5, v5, v68, vcc
  v_cmp_eq_u32 vcc, 3, v66
  s_nop 1
  v_cndmask_b32 v5, v5, v69, vcc
  v_mov_b32 v6, 0
  v_cmp_eq_u32 vcc, 4, v66
  s_nop 1
  v_cndmask_b32 v6, v6, v68, vcc
  v_cmp_eq_u32 vcc, 5, v66
  s_nop 1
  v_cndmask_b32 v6, v6, v69, vcc
  v_mov_b32 v7, 0
  v_cmp_eq_u32 vcc, 6, v66
  s_nop 1
  v_cndmask_b32 v7, v7, v68, vcc
  v_cmp_eq_u32 vcc, 7, v66
  s_nop 1
  v_cndmask_b32 v7, v7, v69, vcc
  v_lshrrev_b32 v64, 1, v116
  v_lshrrev_b32 v65, 3, v117
  v_and_b32 v66, 1, v116
  v_and_b32 v68, 7, v117
  v_lshlrev_b32 v67, 8, v65
  v_lshl_add_u32 v67, v68, 5, v67
  v_lshl_add_u32 v67, v66, 4, v67
  v_add_u32 v69, 4096, v67
  v_add_u32 v70, 6400, v67
  v_cmp_eq_u32 vcc, v64, v65
  s_nop 1
  v_cndmask_b32 v113, v70, v69, vcc
  v_and_b32 v74, 3, v117
  v_lshlrev_b32 v74, 1, v74
  v_bfe_u32 v75, v117, 2, 1
  v_or_b32 v74, v74, v75
  v_and_b32 v75, 8, v117
  v_or_b32 v74, v74, v75
  v_lshlrev_b32 v67, 9, v64
  v_lshl_add_u32 v67, v74, 4, v67
  v_lshl_add_u32 v67, v66, 3, v67
  v_add_u32 v114, 0, v67
  v_mul_u32_u24 v67, 1088, v65
  v_lshl_add_u32 v67, v116, 5, v67
  v_and_b32 v75, 1, v117
  v_and_b32 v76, 2, v117
  v_lshl_add_u32 v75, v76, 1, v75
  v_bfe_u32 v76, v117, 2, 1
  v_lshl_add_u32 v75, v76, 1, v75
  v_lshl_add_u32 v67, v75, 2, v67
  v_add_u32 v115, 4096, v67
  v_and_b32 v69, 1, v74
  v_lshlrev_b32 v67, 7, v69
  v_lshl_add_u32 v67, v116, 4, v67
  v_lshl_add_u32 v67, v65, 8, v67
  v_bfe_u32 v69, v74, 1, 2
  v_lshl_add_u32 v67, v69, 2, v67
  s_lshl_b32 s22, s17, 9
  s_add_u32 s22, s22, 9216
  v_add_u32 v72, s22, v67
  v_bfe_u32 v69, v75, 1, 1
  v_lshlrev_b32 v67, 7, v69
  v_lshl_add_u32 v67, v116, 4, v67
  v_and_b32 v69, 4, v75
  v_add_u32 v67, v67, v69
  s_lshr_b32 s22, s17, 1
  s_lshl_b32 s22, s22, 8
  s_and_b32 s27, s17, 1
  s_lshl_b32 s27, s27, 3
  s_add_u32 s22, s22, s27
  s_add_u32 s22, s22, 7168
  v_add_u32 v67, s22, v67
  v_and_b32 v69, 9, v117
  v_mov_b32 v70, 0x40000000
  v_cmp_eq_u32 vcc, 0, v69
  s_nop 1
  v_cndmask_b32 v118, v70, v67, vcc
  v_mov_b32 v119, -1
  v_and_b32 v0, 15, v1
  s_and_b32 s22, s17, 0
  s_lshl_b32 s22, s22, 7
  s_add_u32 s22, s22, 37376
  v_lshl_add_u32 v0, v0, 2, s22
  v_xor_b32 v69, 256, v2
  v_mul_i32_i24 v70, -4096, v66
  v_add_u32 v69, v69, v70
  v_add_u32 v117, 12288, v69
  v_mov_b32 v116, v73
  v_mov_b32 v112, 0
  s_mul_i32 s35, s17, 28672
  s_add_u32 s35, s35, 4325376
  v_mov_b32 v1, v72
  v_mov_b32 v36, 0
  v_mov_b32 v37, 0
  v_mov_b32 v38, 0
  v_mov_b32 v39, 0
  v_mov_b32 v40, 0
  v_mov_b32 v41, 0
  v_mov_b32 v42, 0
  v_mov_b32 v43, 0
  v_mov_b32 v44, 0
  v_mov_b32 v45, 0
  v_mov_b32 v46, 0
  v_mov_b32 v47, 0
  v_mov_b32 v48, 0
  v_mov_b32 v49, 0
  v_mov_b32 v50, 0
  v_mov_b32 v51, 0
  v_mov_b32 v52, 0
  v_mov_b32 v53, 0
  v_mov_b32 v54, 0
  v_mov_b32 v55, 0
  v_mov_b32 v56, 0
  v_mov_b32 v57, 0
  v_mov_b32 v58, 0
  v_mov_b32 v59, 0
  v_mov_b32 v60, 0
  v_mov_b32 v61, 0
  v_mov_b32 v62, 0
  v_mov_b32 v63, 0
  v_mov_b32 v64, 0
  v_mov_b32 v65, 0
  v_mov_b32 v66, 0
  v_mov_b32 v67, 0
  v_mov_b32 v68, 0
  v_mov_b32 v69, 0
  v_mov_b32 v70, 0
  v_mov_b32 v71, 0
  v_mov_b32 v72, 0
  v_mov_b32 v73, 0
  v_mov_b32 v74, 0
  v_mov_b32 v75, 0
  v_mov_b32 v76, 0
  v_mov_b32 v77, 0
  v_mov_b32 v78, 0
  v_mov_b32 v79, 0
  s_mov_b32 s22, 0
  v_lshrrev_b32 v14, 4, v2
  v_add_u32 v14, 0, v14
  v_min_u32 v14, 308, v14
  v_lshlrev_b32 v14, 7, v14
  buffer_load_dword v15, v14, s[8:11], s22 offen sc1
  v_lshrrev_b32 v14, 4, v2
  v_add_u32 v14, 256, v14
  v_min_u32 v14, 308, v14
  v_lshlrev_b32 v14, 7, v14
  buffer_load_dword v15, v14, s[8:11], s22 offen sc1
  buffer_load_dwordx4 v[80:83], v117, s[8:11], s24 offen offset:0 sc1
  buffer_load_dwordx4 v[84:87], v117, s[8:11], s24 offen offset:1024 sc1
  buffer_load_dwordx4 v[88:91], v117, s[8:11], s26 offen offset:0 sc1
  buffer_load_dwordx4 v[92:95], v117, s[8:11], s26 offen offset:1024 sc1
  buffer_load_dwordx4 v[96:99], v2, s[8:11], s24 offen offset:0 sc1
  buffer_load_dwordx4 v[100:103], v2, s[8:11], s24 offen offset:1024 sc1
  buffer_load_dwordx4 v[104:107], v2, s[8:11], s26 offen offset:0 sc1
  buffer_load_dwordx4 v[108:111], v2, s[8:11], s26 offen offset:1024 sc1
  s_add_u32 s22, s31, 253952
  buffer_load_dwordx4 v[184:187], v2, s[8:11], s22 offen offset:0 sc1
  buffer_load_dwordx4 v[188:191], v2, s[8:11], s22 offen offset:1024 sc1
  buffer_load_dwordx4 v[192:195], v2, s[8:11], s22 offen offset:2048 sc1
  buffer_load_dwordx4 v[196:199], v2, s[8:11], s22 offen offset:3072 sc1
  s_add_u32 s22, s31, 372736
  buffer_load_dwordx4 v[200:203], v2, s[8:11], s22 offen offset:0 sc1
  buffer_load_dwordx4 v[204:207], v2, s[8:11], s22 offen offset:1024 sc1
  buffer_load_dwordx4 v[208:211], v2, s[8:11], s22 offen offset:2048 sc1
  buffer_load_dwordx4 v[212:215], v2, s[8:11], s22 offen offset:3072 sc1
  s_add_u32 s22, s31, 376832
  buffer_load_dwordx4 v[216:219], v2, s[8:11], s22 offen offset:0 sc1
  buffer_load_dwordx4 v[220:223], v2, s[8:11], s22 offen offset:1024 sc1
  buffer_load_dwordx4 v[224:227], v2, s[8:11], s22 offen offset:2048 sc1
  buffer_load_dwordx4 v[228:231], v2, s[8:11], s22 offen offset:3072 sc1
  s_add_u32 s22, s31, 380928
  buffer_load_dwordx4 v[232:235], v2, s[8:11], s22 offen offset:0 sc1
  buffer_load_dwordx4 v[236:239], v2, s[8:11], s22 offen offset:1024 sc1
  buffer_load_dwordx4 v[240:243], v2, s[8:11], s22 offen offset:2048 sc1
  buffer_load_dwordx4 v[244:247], v2, s[8:11], s22 offen offset:3072 sc1
  s_add_u32 s22, s31, 385024
  buffer_load_dwordx4 v[248:251], v2, s[8:11], s22 offen offset:0 sc1
  buffer_load_dwordx4 v[252:255], v2, s[8:11], s22 offen offset:1024 sc1
  s_waitcnt vmcnt(0) lgkmcnt(0)
  s_mov_b32 s31, 0
  s_cmp_lg_u32 s88, 0
  s_cbranch_scc1 cB_sc0_loop
  s_branch cA_sc0_loop
ch_init1:
  s_mul_i32 s31, s17, 401408
  s_add_u32 s31, s31, 33554432
  s_and_b32 s28, s84, 10320
  s_lshl_b32 s22, s85, 16
  s_or_b32 s28, s28, s22
  s_cmp_eq_u32 s28, 4294912080
  s_cbranch_scc1 ch_wx1_ok
  s_mov_b32 s30, 0
ch_wr1:
  buffer_load_dword v9, off, s[12:15], 0 offset:132 sc1
  s_waitcnt vmcnt(0)
  v_cmp_ne_u32 vcc, 1, v9
  s_cbranch_vccz ch_wr1_ok
  s_sleep 8
  s_add_u32 s30, s30, 1
  s_cmp_lt_u32 s30, 400000
  s_cbranch_scc1 ch_wr1
  s_branch cA_abort
ch_wr1_ok:
  s_lshl_b32 s27, s17, 7
  s_add_u32 s27, s27, 584192
  s_mov_b32 s28, 10320
  s_mov_b32 s30, 0
ch_wb1:
  buffer_load_dword v9, off, s[8:11], s27  sc1
  s_waitcnt vmcnt(0)
  v_and_b32 v10, s28, v9
  v_cmp_ne_u32 vcc, s28, v10
  s_cbranch_vccz ch_wb1_ok
  s_sleep 3
  s_add_u32 s30, s30, 1
  s_cmp_lt_u32 s30, 400000
  s_cbranch_scc1 ch_wb1
  s_branch cA_abort
ch_wb1_ok:
  s_mov_b32 s29, 586240
  s_mov_b32 s28, 0xffff
  s_mov_b32 s30, 0
ch_wx1:
  buffer_load_dword v9, off, s[8:11], s29  sc1
  s_waitcnt vmcnt(0)
  v_and_b32 v10, s28, v9
  v_cmp_ne_u32 vcc, s28, v10
  s_cbranch_vccz ch_wx1_ok
  s_sleep 8
  s_add_u32 s30, s30, 1
  s_cmp_lt_u32 s30, 400000
  s_cbranch_scc1 ch_wx1
  s_branch cA_abort
ch_wx1_ok:
  s_add_u32 s22, s31, 258048
  buffer_load_dwordx4 a[224:227], v2, s[8:11], s22 offen offset:0 sc1
  buffer_load_dwordx4 a[228:231], v2, s[8:11], s22 offen offset:1024 sc1
  buffer_load_dwordx4 a[232:235], v2, s[8:11], s22 offen offset:2048 sc1
  buffer_load_dwordx4 a[236:239], v2, s[8:11], s22 offen offset:3072 sc1
  s_add_u32 s22, s31, 262144
  buffer_load_dwordx4 a[240:243], v2, s[8:11], s22 offen offset:0 sc1
  buffer_load_dwordx4 a[244:247], v2, s[8:11], s22 offen offset:1024 sc1
  buffer_load_dwordx4 a[248:251], v2, s[8:11], s22 offen offset:2048 sc1
  buffer_load_dwordx4 a[252:255], v2, s[8:11], s22 offen offset:3072 sc1
  s_add_u32 s22, s31, 266240
  buffer_load_dwordx4 v[120:123], v2, s[8:11], s22 offen offset:0 sc1
  buffer_load_dwordx4 v[124:127], v2, s[8:11], s22 offen offset:1024 sc1
  buffer_load_dwordx4 v[128:131], v2, s[8:11], s22 offen offset:2048 sc1
  buffer_load_dwordx4 v[132:135], v2, s[8:11], s22 offen offset:3072 sc1
  s_add_u32 s22, s31, 270336
  buffer_load_dwordx4 v[136:139], v2, s[8:11], s22 offen offset:0 sc1
  buffer_load_dwordx4 v[140:143], v2, s[8:11], s22 offen offset:1024 sc1
  buffer_load_dwordx4 v[144:147], v2, s[8:11], s22 offen offset:2048 sc1
  buffer_load_dwordx4 v[148:151], v2, s[8:11], s22 offen offset:3072 sc1
  s_add_u32 s22, s31, 274432
  buffer_load_dwordx4 v[152:155], v2, s[8:11], s22 offen offset:0 sc1
  buffer_load_dwordx4 v[156:159], v2, s[8:11], s22 offen offset:1024 sc1
  buffer_load_dwordx4 v[160:163], v2, s[8:11], s22 offen offset:2048 sc1
  buffer_load_dwordx4 v[164:167], v2, s[8:11], s22 offen offset:3072 sc1
  s_add_u32 s22, s31, 278528
  buffer_load_dwordx4 v[168:171], v2, s[8:11], s22 offen offset:0 sc1
  buffer_load_dwordx4 v[172:175], v2, s[8:11], s22 offen offset:1024 sc1
  buffer_load_dwordx4 v[176:179], v2, s[8:11], s22 offen offset:2048 sc1
  buffer_load_dwordx4 v[180:183], v2, s[8:11], s22 offen offset:3072 sc1
  s_mov_b32 s24, 657408
  s_mov_b32 s26, 671744
  v_and_b32 v64, 7, v117
  v_and_b32 v65, 1, v116
  v_lshlrev_b32 v65, 2, v65
  v_sub_u32 v64, v64, v65
  v_lshrrev_b32 v65, 3, v117
  v_lshl_add_u32 v66, v65, 2, v64
  v_cmp_gt_u32 vcc, 4, v64
  v_mov_b32 v67, 99
  s_nop 0
  v_cndmask_b32 v66, v67, v66, vcc
  v_mov_b32 v68, 0x3f80
  v_mov_b32 v69, 0x3f800000
  v_mov_b32 v4, 0
  v_cmp_eq_u32 vcc, 0, v66
  s_nop 1
  v_cndmask_b32 v4, v4, v68, vcc
  v_cmp_eq_u32 vcc, 1, v66
  s_nop 1
  v_cndmask_b32 v4, v4, v69, vcc
  v_mov_b32 v5, 0
  v_cmp_eq_u32 vcc, 2, v66
  s_nop 1
  v_cndmask_b32 v5, v5, v68, vcc
  v_cmp_eq_u32 vcc, 3, v66
  s_nop 1
  v_cndmask_b32 v5, v5, v69, vcc
  v_mov_b32 v6, 0
  v_cmp_eq_u32 vcc, 4, v66
  s_nop 1
  v_cndmask_b32 v6, v6, v68, vcc
  v_cmp_eq_u32 vcc, 5, v66
  s_nop 1
  v_cndmask_b32 v6, v6, v69, vcc
  v_mov_b32 v7, 0
  v_cmp_eq_u32 vcc, 6, v66
  s_nop 1
  v_cndmask_b32 v7, v7, v68, vcc
  v_cmp_eq_u32 vcc, 7, v66
  s_nop 1
  v_cndmask_b32 v7, v7, v69, vcc
  v_lshrrev_b32 v64, 1, v116
  v_lshrrev_b32 v65, 3, v117
  v_and_b32 v66, 1, v116
  v_and_b32 v68, 7, v117
  v_lshlrev_b32 v67, 8, v65
  v_lshl_add_u32 v67, v68, 5, v67
  v_lshl_add_u32 v67, v66, 4, v67
  v_add_u32 v69, 4608, v67
  v_add_u32 v70, 6400, v67
  v_cmp_eq_u32 vcc, v64, v65
  s_nop 1
  v_cndmask_b32 v113, v70, v69, vcc
  v_and_b32 v74, 3, v117
  v_lshlrev_b32 v74, 1, v74
  v_bfe_u32 v75, v117, 2, 1
  v_or_b32 v74, v74, v75
  v_and_b32 v75, 8, v117
  v_or_b32 v74, v74, v75
  v_lshlrev_b32 v67, 9, v64
  v_lshl_add_u32 v67, v74, 4, v67
  v_lshl_add_u32 v67, v66, 3, v67
  v_add_u32 v114, 256, v67
  v_mul_u32_u24 v67, 1088, v65
  v_lshl_add_u32 v67, v116, 5, v67
  v_and_b32 v75, 1, v117
  v_and_b32 v76, 2, v117
  v_lshl_add_u32 v75, v76, 1, v75
  v_bfe_u32 v76, v117, 2, 1
  v_lshl_add_u32 v75, v76, 1, v75
  v_lshl_add_u32 v67, v75, 2, v67
  v_add_u32 v115, 4224, v67
  v_and_b32 v69, 1, v74
  v_lshlrev_b32 v67, 7, v69
  v_lshl_add_u32 v67, v116, 4, v67
  v_lshl_add_u32 v67, v65, 8, v67
  v_bfe_u32 v69, v74, 1, 2
  v_lshl_add_u32 v67, v69, 2, v67
  s_lshl_b32 s22, s17, 9
  s_add_u32 s22, s22, 9280
  v_add_u32 v72, s22, v67
  v_bfe_u32 v69, v75, 1, 1
  v_lshlrev_b32 v67, 7, v69
  v_lshl_add_u32 v67, v116, 4, v67
  v_and_b32 v69, 4, v75
  v_add_u32 v67, v67, v69
  s_lshr_b32 s22, s17, 1
  s_lshl_b32 s22, s22, 8
  s_and_b32 s27, s17, 1
  s_lshl_b32 s27, s27, 3
  s_add_u32 s22, s22, s27
  s_add_u32 s22, s22, 7232
  v_add_u32 v67, s22, v67
  v_and_b32 v69, 9, v117
  v_mov_b32 v70, 0x40000000
  v_cmp_eq_u32 vcc, 0, v69
  s_nop 1
  v_cndmask_b32 v118, v70, v67, vcc
  v_mov_b32 v119, -1
  s_lshl_b32 s22, s17, 2
  s_add_u32 s22, s22, 35328
  v_lshl_add_u32 v67, v1, 7, s22
  v_mov_b32 v70, 0x40000000
  v_cmp_gt_u32 vcc, 1, v1
  s_nop 1
  v_cndmask_b32 v73, v70, v67, vcc
  v_mov_b32 v112, 1
  v_and_b32 v0, 15, v1
  s_and_b32 s22, s17, 0
  s_lshl_b32 s22, s22, 7
  s_add_u32 s22, s22, 37376
  v_lshl_add_u32 v0, v0, 2, s22
  v_xor_b32 v69, 256, v2
  v_mul_i32_i24 v70, 4096, v66
  v_add_u32 v69, v69, v70
  v_add_u32 v117, 6144, v69
  v_mov_b32 v116, v73
  s_mul_i32 s35, s17, 28672
  s_add_u32 s35, s35, 4325376
  v_mov_b32 v1, v72
  v_mov_b32 v36, 0
  v_mov_b32 v37, 0
  v_mov_b32 v38, 0
  v_mov_b32 v39, 0
  v_mov_b32 v40, 0
  v_mov_b32 v41, 0
  v_mov_b32 v42, 0
  v_mov_b32 v43, 0
  v_mov_b32 v44, 0
  v_mov_b32 v45, 0
  v_mov_b32 v46, 0
  v_mov_b32 v47, 0
  v_mov_b32 v48, 0
  v_mov_b32 v49, 0
  v_mov_b32 v50, 0
  v_mov_b32 v51, 0
  v_mov_b32 v52, 0
  v_mov_b32 v53, 0
  v_mov_b32 v54, 0
  v_mov_b32 v55, 0
  v_mov_b32 v56, 0
  v_mov_b32 v57, 0
  v_mov_b32 v58, 0
  v_mov_b32 v59, 0
  v_mov_b32 v60, 0
  v_mov_b32 v61, 0
  v_mov_b32 v62, 0
  v_mov_b32 v63, 0
  v_mov_b32 v64, 0
  v_mov_b32 v65, 0
  v_mov_b32 v66, 0
  v_mov_b32 v67, 0
  v_mov_b32 v68, 0
  v_mov_b32 v69, 0
  v_mov_b32 v70, 0
  v_mov_b32 v71, 0
  v_mov_b32 v72, 0
  v_mov_b32 v73, 0
  v_mov_b32 v74, 0
  v_mov_b32 v75, 0
  v_mov_b32 v76, 0
  v_mov_b32 v77, 0
  v_mov_b32 v78, 0
  v_mov_b32 v79, 0
  s_mov_b32 s22, 0
  v_lshrrev_b32 v14, 4, v2
  v_add_u32 v14, 64, v14
  v_min_u32 v14, 308, v14
  v_lshlrev_b32 v14, 7, v14
  buffer_load_dword v15, v14, s[8:11], s22 offen sc1
  buffer_load_dwordx4 v[80:83], v117, s[8:11], s24 offen offset:0 sc1
  buffer_load_dwordx4 v[84:87], v117, s[8:11], s24 offen offset:1024 sc1
  buffer_load_dwordx4 v[88:91], v117, s[8:11], s26 offen offset:0 sc1
  buffer_load_dwordx4 v[92:95], v117, s[8:11], s26 offen offset:1024 sc1
  buffer_load_dwordx4 v[96:99], v2, s[8:11], s24 offen offset:0 sc1
  buffer_load_dwordx4 v[100:103], v2, s[8:11], s24 offen offset:1024 sc1
  buffer_load_dwordx4 v[104:107], v2, s[8:11], s26 offen offset:0 sc1
  buffer_load_dwordx4 v[108:111], v2, s[8:11], s26 offen offset:1024 sc1
  s_add_u32 s22, s31, 282624
  buffer_load_dwordx4 v[184:187], v2, s[8:11], s22 offen offset:0 sc1
  buffer_load_dwordx4 v[188:191], v2, s[8:11], s22 offen offset:1024 sc1
  buffer_load_dwordx4 v[192:195], v2, s[8:11], s22 offen offset:2048 sc1
  buffer_load_dwordx4 v[196:199], v2, s[8:11], s22 offen offset:3072 sc1
  s_add_u32 s22, s31, 344064
  buffer_load_dwordx4 v[200:203], v2, s[8:11], s22 offen offset:0 sc1
  buffer_load_dwordx4 v[204:207], v2, s[8:11], s22 offen offset:1024 sc1
  buffer_load_dwordx4 v[208:211], v2, s[8:11], s22 offen offset:2048 sc1
  buffer_load_dwordx4 v[212:215], v2, s[8:11], s22 offen offset:3072 sc1
  s_add_u32 s22, s31, 348160
  buffer_load_dwordx4 v[216:219], v2, s[8:11], s22 offen offset:0 sc1
  buffer_load_dwordx4 v[220:223], v2, s[8:11], s22 offen offset:1024 sc1
  buffer_load_dwordx4 v[224:227], v2, s[8:11], s22 offen offset:2048 sc1
  buffer_load_dwordx4 v[228:231], v2, s[8:11], s22 offen offset:3072 sc1
  s_add_u32 s22, s31, 352256
  buffer_load_dwordx4 v[232:235], v2, s[8:11], s22 offen offset:0 sc1
  buffer_load_dwordx4 v[236:239], v2, s[8:11], s22 offen offset:1024 sc1
  buffer_load_dwordx4 v[240:243], v2, s[8:11], s22 offen offset:2048 sc1
  buffer_load_dwordx4 v[244:247], v2, s[8:11], s22 offen offset:3072 sc1
  s_add_u32 s22, s31, 356352
  buffer_load_dwordx4 v[248:251], v2, s[8:11], s22 offen offset:0 sc1
  buffer_load_dwordx4 v[252:255], v2, s[8:11], s22 offen offset:1024 sc1
  s_waitcnt vmcnt(0) lgkmcnt(0)
  s_mov_b32 s31, 0
  s_cmp_lg_u32 s88, 0
  s_cbranch_scc1 cB_sc1_loop
  s_branch cA_sc1_loop
ch_init2:
  s_mul_i32 s31, s17, 401408
  s_add_u32 s31, s31, 33554432
  s_and_b32 s28, s84, 12384
  s_lshl_b32 s22, s85, 16
  s_or_b32 s28, s28, s22
  s_cmp_eq_u32 s28, 4294914144
  s_cbranch_scc1 ch_wx2_ok
  s_mov_b32 s30, 0
ch_wr2:
  buffer_load_dword v9, off, s[12:15], 0 offset:132 sc1
  s_waitcnt vmcnt(0)
  v_cmp_ne_u32 vcc, 1, v9
  s_cbranch_vccz ch_wr2_ok
  s_sleep 8
  s_add_u32 s30, s30, 1
  s_cmp_lt_u32 s30, 400000
  s_cbranch_scc1 ch_wr2
  s_branch cA_abort
ch_wr2_ok:
  s_lshl_b32 s27, s17, 7
  s_add_u32 s27, s27, 584192
  s_mov_b32 s28, 12384
  s_mov_b32 s30, 0
ch_wb2:
  buffer_load_dword v9, off, s[8:11], s27  sc1
  s_waitcnt vmcnt(0)
  v_and_b32 v10, s28, v9
  v_cmp_ne_u32 vcc, s28, v10
  s_cbranch_vccz ch_wb2_ok
  s_sleep 3
  s_add_u32 s30, s30, 1
  s_cmp_lt_u32 s30, 400000
  s_cbranch_scc1 ch_wb2
  s_branch cA_abort
ch_wb2_ok:
  s_mov_b32 s29, 586240
  s_mov_b32 s28, 0xffff
  s_mov_b32 s30, 0
ch_wx2:
  buffer_load_dword v9, off, s[8:11], s29  sc1
  s_waitcnt vmcnt(0)
  v_and_b32 v10, s28, v9
  v_cmp_ne_u32 vcc, s28, v10
  s_cbranch_vccz ch_wx2_ok
  s_sleep 8
  s_add_u32 s30, s30, 1
  s_cmp_lt_u32 s30, 400000
  s_cbranch_scc1 ch_wx2
  s_branch cA_abort
ch_wx2_ok:
  s_add_u32 s22, s31, 286720
  buffer_load_dwordx4 a[224:227], v2, s[8:11], s22 offen offset:0 sc1
  buffer_load_dwordx4 a[228:231], v2, s[8:11], s22 offen offset:1024 sc1
  buffer_load_dwordx4 a[232:235], v2, s[8:11], s22 offen offset:2048 sc1
  buffer_load_dwordx4 a[236:239], v2, s[8:11], s22 offen offset:3072 sc1
  s_add_u32 s22, s31, 290816
  buffer_load_dwordx4 a[240:243], v2, s[8:11], s22 offen offset:0 sc1
  buffer_load_dwordx4 a[244:247], v2, s[8:11], s22 offen offset:1024 sc1
  buffer_load_dwordx4 a[248:251], v2, s[8:11], s22 offen offset:2048 sc1
  buffer_load_dwordx4 a[252:255], v2, s[8:11], s22 offen offset:3072 sc1
  s_add_u32 s22, s31, 294912
  buffer_load_dwordx4 v[120:123], v2, s[8:11], s22 offen offset:0 sc1
  buffer_load_dwordx4 v[124:127], v2, s[8:11], s22 offen offset:1024 sc1
  buffer_load_dwordx4 v[128:131], v2, s[8:11], s22 offen offset:2048 sc1
  buffer_load_dwordx4 v[132:135], v2, s[8:11], s22 offen offset:3072 sc1
  s_add_u32 s22, s31, 299008
  buffer_load_dwordx4 v[136:139], v2, s[8:11], s22 offen offset:0 sc1
  buffer_load_dwordx4 v[140:143], v2, s[8:11], s22 offen offset:1024 sc1
  buffer_load_dwordx4 v[144:147], v2, s[8:11], s22 offen offset:2048 sc1
  buffer_load_dwordx4 v[148:151], v2, s[8:11], s22 offen offset:3072 sc1
  s_add_u32 s22, s31, 303104
  buffer_load_dwordx4 v[152:155], v2, s[8:11], s22 offen offset:0 sc1
  buffer_load_dwordx4 v[156:159], v2, s[8:11], s22 offen offset:1024 sc1
  buffer_load_dwordx4 v[160:163], v2, s[8:11], s22 offen offset:2048 sc1
  buffer_load_dwordx4 v[164:167], v2, s[8:11], s22 offen offset:3072 sc1
  s_add_u32 s22, s31, 307200
  buffer_load_dwordx4 v[168:171], v2, s[8:11], s22 offen offset:0 sc1
  buffer_load_dwordx4 v[172:175], v2, s[8:11], s22 offen offset:1024 sc1
  buffer_load_dwordx4 v[176:179], v2, s[8:11], s22 offen offset:2048 sc1
  buffer_load_dwordx4 v[180:183], v2, s[8:11], s22 offen offset:3072 sc1
  s_mov_b32 s24, 659456
  s_mov_b32 s26, 673792
  v_and_b32 v64, 7, v117
  v_and_b32 v65, 1, v116
  v_lshlrev_b32 v65, 2, v65
  v_sub_u32 v64, v64, v65
  v_lshrrev_b32 v65, 3, v117
  v_lshl_add_u32 v66, v65, 2, v64
  v_cmp_gt_u32 vcc, 4, v64
  v_mov_b32 v67, 99
  s_nop 0
  v_cndmask_b32 v66, v67, v66, vcc
  v_mov_b32 v68, 0x3f80
  v_mov_b32 v69, 0x3f800000
  v_mov_b32 v4, 0
  v_cmp_eq_u32 vcc, 0, v66
  s_nop 1
  v_cndmask_b32 v4, v4, v68, vcc
  v_cmp_eq_u32 vcc, 1, v66
  s_nop 1
  v_cndmask_b32 v4, v4, v69, vcc
  v_mov_b32 v5, 0
  v_cmp_eq_u32 vcc, 2, v66
  s_nop 1
  v_cndmask_b32 v5, v5, v68, vcc
  v_cmp_eq_u32 vcc, 3, v66
  s_nop 1
  v_cndmask_b32 v5, v5, v69, vcc
  v_mov_b32 v6, 0
  v_cmp_eq_u32 vcc, 4, v66
  s_nop 1
  v_cndmask_b32 v6, v6, v68, vcc
  v_cmp_eq_u32 vcc, 5, v66
  s_nop 1
  v_cndmask_b32 v6, v6, v69, vcc
  v_mov_b32 v7, 0
  v_cmp_eq_u32 vcc, 6, v66
  s_nop 1
  v_cndmask_b32 v7, v7, v68, vcc
  v_cmp_eq_u32 vcc, 7, v66
  s_nop 1
  v_cndmask_b32 v7, v7, v69, vcc
  v_lshrrev_b32 v64, 1, v116
  v_lshrrev_b32 v65, 3, v117
  v_and_b32 v66, 1, v116
  v_and_b32 v68, 7, v117
  v_lshlrev_b32 v67, 8, v65
  v_lshl_add_u32 v67, v68, 5, v67
  v_lshl_add_u32 v67, v66, 4, v67
  v_add_u32 v69, 5184, v67
  v_add_u32 v70, 6400, v67
  v_cmp_eq_u32 vcc, v64, v65
  s_nop 1
  v_cndmask_b32 v113, v70, v69, vcc
  s_lshl_b32 s22, s17, 9
  s_add_u32 s22, s22, 9216
  v_lshl_add_u32 v114, v1, 3, s22
  s_lshr_b32 s22, s17, 1
  s_lshl_b32 s22, s22, 8
  s_and_b32 s27, s17, 1
  s_lshl_b32 s27, s27, 3
  s_add_u32 s22, s22, s27
  s_add_u32 s22, s22, 7168
  v_add_u32 v115, s22, v2
  v_mov_b32 v70, 0x40000000
  v_cmp_gt_u32 vcc, 16, v1
  s_nop 1
  v_cndmask_b32 v115, v70, v115, vcc
  v_mov_b32 v118, -1
  v_mov_b32 v119, -1
  v_and_b32 v0, 15, v1
  s_and_b32 s22, s17, 0
  s_lshl_b32 s22, s22, 7
  s_add_u32 s22, s22, 37376
  v_lshl_add_u32 v0, v0, 2, s22
  v_xor_b32 v69, 256, v2
  v_mul_i32_i24 v70, -2048, v66
  v_add_u32 v69, v69, v70
  v_add_u32 v117, 8192, v69
  v_mov_b32 v116, v73
  s_mul_i32 s35, s17, 28672
  s_add_u32 s35, s35, 4325376
  v_mov_b32 v36, 0
  v_mov_b32 v37, 0
  v_mov_b32 v38, 0
  v_mov_b32 v39, 0
  v_mov_b32 v40, 0
  v_mov_b32 v41, 0
  v_mov_b32 v42, 0
  v_mov_b32 v43, 0
  v_mov_b32 v44, 0
  v_mov_b32 v45, 0
  v_mov_b32 v46, 0
  v_mov_b32 v47, 0
  v_mov_b32 v48, 0
  v_mov_b32 v49, 0
  v_mov_b32 v50, 0
  v_mov_b32 v51, 0
  v_mov_b32 v52, 0
  v_mov_b32 v53, 0
  v_mov_b32 v54, 0
  v_mov_b32 v55, 0
  v_mov_b32 v56, 0
  v_mov_b32 v57, 0
  v_mov_b32 v58, 0
  v_mov_b32 v59, 0
  v_mov_b32 v60, 0
  v_mov_b32 v61, 0
  v_mov_b32 v62, 0
  v_mov_b32 v63, 0
  v_mov_b32 v64, 0
  v_mov_b32 v65, 0
  v_mov_b32 v66, 0
  v_mov_b32 v67, 0
  v_mov_b32 v68, 0
  v_mov_b32 v69, 0
  v_mov_b32 v70, 0
  v_mov_b32 v71, 0
  v_mov_b32 v72, 0
  v_mov_b32 v73, 0
  v_mov_b32 v74, 0
  v_mov_b32 v75, 0
  v_mov_b32 v76, 0
  v_mov_b32 v77, 0
  v_mov_b32 v78, 0
  v_mov_b32 v79, 0
  s_mov_b32 s22, 0
  v_lshrrev_b32 v14, 4, v2
  v_add_u32 v14, 128, v14
  v_min_u32 v14, 308, v14
  v_lshlrev_b32 v14, 7, v14
  buffer_load_dword v15, v14, s[8:11], s22 offen sc1
  buffer_load_dwordx4 v[80:83], v117, s[8:11], s24 offen offset:0 sc1
  buffer_load_dwordx4 v[84:87], v117, s[8:11], s24 offen offset:1024 sc1
  buffer_load_dwordx4 v[88:91], v117, s[8:11], s26 offen offset:0 sc1
  buffer_load_dwordx4 v[92:95], v117, s[8:11], s26 offen offset:1024 sc1
  buffer_load_dwordx4 v[96:99], v2, s[8:11], s24 offen offset:0 sc1
  buffer_load_dwordx4 v[100:103], v2, s[8:11], s24 offen offset:1024 sc1
  buffer_load_dwordx4 v[104:107], v2, s[8:11], s26 offen offset:0 sc1
  buffer_load_dwordx4 v[108:111], v2, s[8:11], s26 offen offset:1024 sc1
  s_add_u32 s22, s31, 311296
  buffer_load_dwordx4 v[184:187], v2, s[8:11], s22 offen offset:0 sc1
  buffer_load_dwordx4 v[188:191], v2, s[8:11], s22 offen offset:1024 sc1
  buffer_load_dwordx4 v[192:195], v2, s[8:11], s22 offen offset:2048 sc1
  buffer_load_dwordx4 v[196:199], v2, s[8:11], s22 offen offset:3072 sc1
  s_add_u32 s22, s31, 385024
  buffer_load_dwordx4 v[200:203], v2, s[8:11], s22 offen offset:2048 sc1
  buffer_load_dwordx4 v[204:207], v2, s[8:11], s22 offen offset:3072 sc1
  s_add_u32 s22, s31, 389120
  buffer_load_dwordx4 v[208:211], v2, s[8:11], s22 offen offset:0 sc1
  buffer_load_dwordx4 v[212:215], v2, s[8:11], s22 offen offset:1024 sc1
  buffer_load_dwordx4 v[216:219], v2, s[8:11], s22 offen offset:2048 sc1
  buffer_load_dwordx4 v[220:223], v2, s[8:11], s22 offen offset:3072 sc1
  s_add_u32 s22, s31, 393216
  buffer_load_dwordx4 v[224:227], v2, s[8:11], s22 offen offset:0 sc1
  buffer_load_dwordx4 v[228:231], v2, s[8:11], s22 offen offset:1024 sc1
  buffer_load_dwordx4 v[232:235], v2, s[8:11], s22 offen offset:2048 sc1
  buffer_load_dwordx4 v[236:239], v2, s[8:11], s22 offen offset:3072 sc1
  s_add_u32 s22, s31, 397312
  buffer_load_dwordx4 v[240:243], v2, s[8:11], s22 offen offset:0 sc1
  buffer_load_dwordx4 v[244:247], v2, s[8:11], s22 offen offset:1024 sc1
  buffer_load_dwordx4 v[248:251], v2, s[8:11], s22 offen offset:2048 sc1
  buffer_load_dwordx4 v[252:255], v2, s[8:11], s22 offen offset:3072 sc1
  s_waitcnt vmcnt(0) lgkmcnt(0)
  s_mov_b32 s31, 0
  s_cmp_lg_u32 s88, 0
  s_cbranch_scc1 cB_sc2_loop
  s_branch cA_sc2_loop
ch_init3:
  s_mul_i32 s31, s17, 401408
  s_add_u32 s31, s31, 33554432
  s_and_b32 s28, s84, 12384
  s_lshl_b32 s22, s85, 16
  s_or_b32 s28, s28, s22
  s_cmp_eq_u32 s28, 4294914144
  s_cbranch_scc1 ch_wx3_ok
  s_mov_b32 s30, 0
ch_wr3:
  buffer_load_dword v9, off, s[12:15], 0 offset:132 sc1
  s_waitcnt vmcnt(0)
  v_cmp_ne_u32 vcc, 1, v9
  s_cbranch_vccz ch_wr3_ok
  s_sleep 8
  s_add_u32 s30, s30, 1
  s_cmp_lt_u32 s30, 400000
  s_cbranch_scc1 ch_wr3
  s_branch cA_abort
ch_wr3_ok:
  s_lshl_b32 s27, s17, 7
  s_add_u32 s27, s27, 584192
  s_mov_b32 s28, 12384
  s_mov_b32 s30, 0
ch_wb3:
  buffer_load_dword v9, off, s[8:11], s27  sc1
  s_waitcnt vmcnt(0)
  v_and_b32 v10, s28, v9
  v_cmp_ne_u32 vcc, s28, v10
  s_cbranch_vccz ch_wb3_ok
  s_sleep 3
  s_add_u32 s30, s30, 1
  s_cmp_lt_u32 s30, 400000
  s_cbranch_scc1 ch_wb3
  s_branch cA_abort
ch_wb3_ok:
  s_mov_b32 s29, 586240
  s_mov_b32 s28, 0xffff
  s_mov_b32 s30, 0
ch_wx3:
  buffer_load_dword v9, off, s[8:11], s29  sc1
  s_waitcnt vmcnt(0)
  v_and_b32 v10, s28, v9
  v_cmp_ne_u32 vcc, s28, v10
  s_cbranch_vccz ch_wx3_ok
  s_sleep 8
  s_add_u32 s30, s30, 1
  s_cmp_lt_u32 s30, 400000
  s_cbranch_scc1 ch_wx3
  s_branch cA_abort
ch_wx3_ok:
  s_add_u32 s22, s31, 315392
  buffer_load_dwordx4 a[224:227], v2, s[8:11], s22 offen offset:0 sc1
  buffer_load_dwordx4 a[228:231], v2, s[8:11], s22 offen offset:1024 sc1
  buffer_load_dwordx4 a[232:235], v2, s[8:11], s22 offen offset:2048 sc1
  buffer_load_dwordx4 a[236:239], v2, s[8:11], s22 offen offset:3072 sc1
  s_add_u32 s22, s31, 319488
  buffer_load_dwordx4 a[240:243], v2, s[8:11], s22 offen offset:0 sc1
  buffer_load_dwordx4 a[244:247], v2, s[8:11], s22 offen offset:1024 sc1
  buffer_load_dwordx4 a[248:251], v2, s[8:11], s22 offen offset:2048 sc1
  buffer_load_dwordx4 a[252:255], v2, s[8:11], s22 offen offset:3072 sc1
  s_add_u32 s22, s31, 323584
  buffer_load_dwordx4 v[120:123], v2, s[8:11], s22 offen offset:0 sc1
  buffer_load_dwordx4 v[124:127], v2, s[8:11], s22 offen offset:1024 sc1
  buffer_load_dwordx4 v[128:131], v2, s[8:11], s22 offen offset:2048 sc1
  buffer_load_dwordx4 v[132:135], v2, s[8:11], s22 offen offset:3072 sc1
  s_add_u32 s22, s31, 327680
  buffer_load_dwordx4 v[136:139], v2, s[8:11], s22 offen offset:0 sc1
  buffer_load_dwordx4 v[140:143], v2, s[8:11], s22 offen offset:1024 sc1
  buffer_load_dwordx4 v[144:147], v2, s[8:11], s22 offen offset:2048 sc1
  buffer_load_dwordx4 v[148:151], v2, s[8:11], s22 offen offset:3072 sc1
  s_add_u32 s22, s31, 331776
  buffer_load_dwordx4 v[152:155], v2, s[8:11], s22 offen offset:0 sc1
  buffer_load_dwordx4 v[156:159], v2, s[8:11], s22 offen offset:1024 sc1
  buffer_load_dwordx4 v[160:163], v2, s[8:11], s22 offen offset:2048 sc1
  buffer_load_dwordx4 v[164:167], v2, s[8:11], s22 offen offset:3072 sc1
  s_add_u32 s22, s31, 335872
  buffer_load_dwordx4 v[168:171], v2, s[8:11], s22 offen offset:0 sc1
  buffer_load_dwordx4 v[172:175], v2, s[8:11], s22 offen offset:1024 sc1
  buffer_load_dwordx4 v[176:179], v2, s[8:11], s22 offen offset:2048 sc1
  buffer_load_dwordx4 v[180:183], v2, s[8:11], s22 offen offset:3072 sc1
  s_mov_b32 s24, 661504
  s_mov_b32 s26, 675840
  v_and_b32 v64, 7, v117
  v_and_b32 v65, 1, v116
  v_lshlrev_b32 v65, 2, v65
  v_sub_u32 v64, v64, v65
  v_lshrrev_b32 v65, 3, v117
  v_lshl_add_u32 v66, v65, 2, v64
  v_cmp_gt_u32 vcc, 4, v64
  v_mov_b32 v67, 99
  s_nop 0
  v_cndmask_b32 v66, v67, v66, vcc
  v_mov_b32 v68, 0x3f80
  v_mov_b32 v69, 0x3f800000
  v_mov_b32 v4, 0
  v_cmp_eq_u32 vcc, 0, v66
  s_nop 1
  v_cndmask_b32 v4, v4, v68, vcc
  v_cmp_eq_u32 vcc, 1, v66
  s_nop 1
  v_cndmask_b32 v4, v4, v69, vcc
  v_mov_b32 v5, 0
  v_cmp_eq_u32 vcc, 2, v66
  s_nop 1
  v_cndmask_b32 v5, v5, v68, vcc
  v_cmp_eq_u32 vcc, 3, v66
  s_nop 1
  v_cndmask_b32 v5, v5, v69, vcc
  v_mov_b32 v6, 0
  v_cmp_eq_u32 vcc, 4, v66
  s_nop 1
  v_cndmask_b32 v6, v6, v68, vcc
  v_cmp_eq_u32 vcc, 5, v66
  s_nop 1
  v_cndmask_b32 v6, v6, v69, vcc
  v_mov_b32 v7, 0
  v_cmp_eq_u32 vcc, 6, v66
  s_nop 1
  v_cndmask_b32 v7, v7, v68, vcc
  v_cmp_eq_u32 vcc, 7, v66
  s_nop 1
  v_cndmask_b32 v7, v7, v69, vcc
  v_lshrrev_b32 v64, 1, v116
  v_lshrrev_b32 v65, 3, v117
  v_and_b32 v66, 1, v116
  v_and_b32 v68, 7, v117
  v_lshlrev_b32 v67, 8, v65
  v_lshl_add_u32 v67, v68, 5, v67
  v_lshl_add_u32 v67, v66, 4, v67
  v_add_u32 v69, 5696, v67
  v_add_u32 v70, 6400, v67
  v_cmp_eq_u32 vcc, v64, v65
  s_nop 1
  v_cndmask_b32 v113, v70, v69, vcc
  v_and_b32 v0, 15, v1
  s_and_b32 s22, s17, 0
  s_lshl_b32 s22, s22, 7
  s_add_u32 s22, s22, 37376
  v_lshl_add_u32 v0, v0, 2, s22
  v_xor_b32 v69, 256, v2
  v_mul_i32_i24 v70, 2048, v66
  v_add_u32 v69, v69, v70
  v_add_u32 v117, 4096, v69
  v_mov_b32 v116, v73
  s_mul_i32 s35, s17, 28672
  s_add_u32 s35, s35, 4325376
  v_mov_b32 v36, 0
  v_mov_b32 v37, 0
  v_mov_b32 v38, 0
  v_mov_b32 v39, 0
  v_mov_b32 v40, 0
  v_mov_b32 v41, 0
  v_mov_b32 v42, 0
  v_mov_b32 v43, 0
  v_mov_b32 v44, 0
  v_mov_b32 v45, 0
  v_mov_b32 v46, 0
  v_mov_b32 v47, 0
  v_mov_b32 v48, 0
  v_mov_b32 v49, 0
  v_mov_b32 v50, 0
  v_mov_b32 v51, 0
  v_mov_b32 v52, 0
  v_mov_b32 v53, 0
  v_mov_b32 v54, 0
  v_mov_b32 v55, 0
  v_mov_b32 v56, 0
  v_mov_b32 v57, 0
  v_mov_b32 v58, 0
  v_mov_b32 v59, 0
  v_mov_b32 v60, 0
  v_mov_b32 v61, 0
  v_mov_b32 v62, 0
  v_mov_b32 v63, 0
  v_mov_b32 v64, 0
  v_mov_b32 v65, 0
  v_mov_b32 v66, 0
  v_mov_b32 v67, 0
  v_mov_b32 v68, 0
  v_mov_b32 v69, 0
  v_mov_b32 v70, 0
  v_mov_b32 v71, 0
  v_mov_b32 v72, 0
  v_mov_b32 v73, 0
  v_mov_b32 v74, 0
  v_mov_b32 v75, 0
  v_mov_b32 v76, 0
  v_mov_b32 v77, 0
  v_mov_b32 v78, 0
  v_mov_b32 v79, 0
  s_mov_b32 s22, 0
  v_lshrrev_b32 v14, 4, v2
  v_add_u32 v14, 192, v14
  v_min_u32 v14, 308, v14
  v_lshlrev_b32 v14, 7, v14
  buffer_load_dword v15, v14, s[8:11], s22 offen sc1
  buffer_load_dwordx4 v[80:83], v117, s[8:11], s24 offen offset:0 sc1
  buffer_load_dwordx4 v[84:87], v117, s[8:11], s24 offen offset:1024 sc1
  buffer_load_dwordx4 v[88:91], v117, s[8:11], s26 offen offset:0 sc1
  buffer_load_dwordx4 v[92:95], v117, s[8:11], s26 offen offset:1024 sc1
  buffer_load_dwordx4 v[96:99], v2, s[8:11], s24 offen offset:0 sc1
  buffer_load_dwordx4 v[100:103], v2, s[8:11], s24 offen offset:1024 sc1
  buffer_load_dwordx4 v[104:107], v2, s[8:11], s26 offen offset:0 sc1
  buffer_load_dwordx4 v[108:111], v2, s[8:11], s26 offen offset:1024 sc1
  s_add_u32 s22, s31, 339968
  buffer_load_dwordx4 v[184:187], v2, s[8:11], s22 offen offset:0 sc1
  buffer_load_dwordx4 v[188:191], v2, s[8:11], s22 offen offset:1024 sc1
  buffer_load_dwordx4 v[192:195], v2, s[8:11], s22 offen offset:2048 sc1
  buffer_load_dwordx4 v[196:199], v2, s[8:11], s22 offen offset:3072 sc1
  s_add_u32 s22, s31, 356352
  buffer_load_dwordx4 v[200:203], v2, s[8:11], s22 offen offset:2048 sc1
  buffer_load_dwordx4 v[204:207], v2, s[8:11], s22 offen offset:3072 sc1
  s_add_u32 s22, s31, 360448
  buffer_load_dwordx4 v[208:211], v2, s[8:11], s22 offen offset:0 sc1
  buffer_load_dwordx4 v[212:215], v2, s[8:11], s22 offen offset:1024 sc1
  buffer_load_dwordx4 v[216:219], v2, s[8:11], s22 offen offset:2048 sc1
  buffer_load_dwordx4 v[220:223], v2, s[8:11], s22 offen offset:3072 sc1
  s_add_u32 s22, s31, 364544
  buffer_load_dwordx4 v[224:227], v2, s[8:11], s22 offen offset:0 sc1
  buffer_load_dwordx4 v[228:231], v2, s[8:11], s22 offen offset:1024 sc1
  buffer_load_dwordx4 v[232:235], v2, s[8:11], s22 offen offset:2048 sc1
  buffer_load_dwordx4 v[236:239], v2, s[8:11], s22 offen offset:3072 sc1
  s_add_u32 s22, s31, 368640
  buffer_load_dwordx4 v[240:243], v2, s[8:11], s22 offen offset:0 sc1
  buffer_load_dwordx4 v[244:247], v2, s[8:11], s22 offen offset:1024 sc1
  buffer_load_dwordx4 v[248:251], v2, s[8:11], s22 offen offset:2048 sc1
  buffer_load_dwordx4 v[252:255], v2, s[8:11], s22 offen offset:3072 sc1
  s_waitcnt vmcnt(0) lgkmcnt(0)
  s_mov_b32 s31, 0
  s_cmp_lg_u32 s88, 0
  s_cbranch_scc1 cB_sc3_loop
  s_branch cA_sc3_loop
ch_init4:
  v_mov_b32 v72, v116
  v_mov_b32 v73, v117
  v_lshrrev_b32 v65, 1, v72
  v_and_b32 v66, 1, v72
  v_mov_b32 v36, 0
  v_mov_b32 v37, 0
  v_mov_b32 v38, 0
  v_mov_b32 v39, 0
  v_mov_b32 v40, 0
  v_mov_b32 v41, 0
  v_mov_b32 v42, 0
  v_mov_b32 v43, 0
  v_mov_b32 v44, 0
  v_mov_b32 v45, 0
  v_mov_b32 v46, 0
  v_mov_b32 v47, 0
  v_mov_b32 v48, 0
  v_mov_b32 v49, 0
  v_mov_b32 v50, 0
  v_mov_b32 v51, 0
  v_mov_b32 v52, 0
  v_mov_b32 v53, 0
  v_mov_b32 v54, 0
  v_mov_b32 v55, 0
  v_mov_b32 v56, 0
  v_mov_b32 v57, 0
  v_mov_b32 v58, 0
  v_mov_b32 v59, 0
  v_mov_b32 v60, 0
  v_mov_b32 v61, 0
  v_mov_b32 v62, 0
  v_mov_b32 v63, 0
  v_lshlrev_b32 v75, 2, v65
  v_lshl_add_u32 v75, v66, 3, v75
  v_add_u32 v67, 0, v73
  v_mul_u32_u24 v68, 2341, v67
  v_lshrrev_b32 v68, 16, v68
  v_mul_u32_u24 v69, 28, v68
  v_sub_u32 v69, v67, v69
  v_lshrrev_b32 v70, 4, v69
  v_and_b32 v69, 15, v69
  v_lshlrev_b32 v71, 12, v70
  v_lshl_add_u32 v71, v68, 8, v71
  v_lshl_add_u32 v71, v69, 4, v71
  v_add_u32 v152, v71, v75
  v_add_u32 v67, 16, v73
  v_mul_u32_u24 v68, 2341, v67
  v_lshrrev_b32 v68, 16, v68
  v_mul_u32_u24 v69, 28, v68
  v_sub_u32 v69, v67, v69
  v_lshrrev_b32 v70, 4, v69
  v_and_b32 v69, 15, v69
  v_lshlrev_b32 v71, 12, v70
  v_lshl_add_u32 v71, v68, 8, v71
  v_lshl_add_u32 v71, v69, 4, v71
  v_add_u32 v153, v71, v75
  v_add_u32 v67, 32, v73
  v_mul_u32_u24 v68, 2341, v67
  v_lshrrev_b32 v68, 16, v68
  v_mul_u32_u24 v69, 28, v68
  v_sub_u32 v69, v67, v69
  v_lshrrev_b32 v70, 4, v69
  v_and_b32 v69, 15, v69
  v_lshlrev_b32 v71, 12, v70
  v_lshl_add_u32 v71, v68, 8, v71
  v_lshl_add_u32 v71, v69, 4, v71
  v_add_u32 v154, v71, v75
  v_add_u32 v67, 48, v73
  v_mul_u32_u24 v68, 2341, v67
  v_lshrrev_b32 v68, 16, v68
  v_mul_u32_u24 v69, 28, v68
  v_sub_u32 v69, v67, v69
  v_lshrrev_b32 v70, 4, v69
  v_and_b32 v69, 15, v69
  v_lshlrev_b32 v71, 12, v70
  v_lshl_add_u32 v71, v68, 8, v71
  v_lshl_add_u32 v71, v69, 4, v71
  v_add_u32 v155, v71, v75
  v_add_u32 v67, 64, v73
  v_mul_u32_u24 v68, 2341, v67
  v_lshrrev_b32 v68, 16, v68
  v_mul_u32_u24 v69, 28, v68
  v_sub_u32 v69, v67, v69
  v_lshrrev_b32 v70, 4, v69
  v_and_b32 v69, 15, v69
  v_lshlrev_b32 v71, 12, v70
  v_lshl_add_u32 v71, v68, 8, v71
  v_lshl_add_u32 v71, v69, 4, v71
  v_add_u32 v156, v71, v75
  v_add_u32 v67, 80, v73
  v_mul_u32_u24 v68, 2341, v67
  v_lshrrev_b32 v68, 16, v68
  v_mul_u32_u24 v69, 28, v68
  v_sub_u32 v69, v67, v69
  v_lshrrev_b32 v70, 4, v69
  v_and_b32 v69, 15, v69
  v_lshlrev_b32 v71, 12, v70
  v_lshl_add_u32 v71, v68, 8, v71
  v_lshl_add_u32 v71, v69, 4, v71
  v_add_u32 v157, v71, v75
  v_mov_b32 v74, 0x40000000
  v_mov_b32 v164, 0
  v_mov_b32 v76, 0
  v_mov_b32 v77, 0
  v_mov_b32 v78, 0
  v_mov_b32 v79, 0
  ds_write_b128 v2, v[76:79] offset:0
  ds_write_b128 v2, v[76:79] offset:1024
  ds_write_b128 v2, v[76:79] offset:2048
  ds_write_b128 v2, v[76:79] offset:3072
  s_and_b32 s22, s17, 0
  s_lshl_b32 s22, s22, 7
  s_add_u32 s22, s22, 35328
  v_lshl_add_u32 v4, v73, 2, s22
  v_and_b32 v64, 1, v73
  v_mov_b32 v5, 0x05040100
  v_mov_b32 v65, 0x03020706
  v_cmp_eq_u32 vcc, 1, v64
  s_nop 1
  v_cndmask_b32 v5, v5, v65, vcc
  s_lshl_b32 s22, s17, 2
  s_add_u32 s22, s22, 37376
  v_lshl_add_u32 v7, v1, 7, s22
  v_cmp_gt_u32 vcc, 1, v1
  s_nop 1
  v_cndmask_b32 v7, v74, v7, vcc
  v_mov_b32 v6, v2
  v_lshl_add_u32 v64, v66, 2, v64
  v_and_b32 v65, 2, v72
  v_add_u32 v64, v64, v65
  s_mul_i32 s22, s17, 16
  v_add_u32 v75, s22, v73
  v_lshrrev_b32 v68, 4, v75
  v_lshlrev_b32 v68, 8, v68
  v_bfe_u32 v69, v75, 1, 1
  v_lshl_add_u32 v68, v69, 7, v68
  v_lshl_add_u32 v68, v64, 4, v68
  v_and_b32 v69, 12, v75
  v_add_u32 v1, v68, v69
  s_mul_i32 s22, s17, 28672
  s_add_u32 s25, s22, 2490368
  s_and_b32 s27, s17, 0
  s_xor_b32 s22, s27, 0
  s_mul_i32 s80, s22, 7168
  s_lshl_b32 s22, s22, 11
  s_add_u32 s76, s22, 9216
  s_xor_b32 s22, s27, 1
  s_mul_i32 s81, s22, 7168
  s_lshl_b32 s22, s22, 11
  s_add_u32 s77, s22, 9216
  s_xor_b32 s22, s27, 2
  s_mul_i32 s82, s22, 7168
  s_lshl_b32 s22, s22, 11
  s_add_u32 s78, s22, 9216
  s_xor_b32 s22, s27, 3
  s_mul_i32 s83, s22, 7168
  s_lshl_b32 s22, s22, 11
  s_add_u32 s79, s22, 9216
  v_mov_b32 v162, -1
  s_mov_b32 s38, 0x40000000
  s_mul_i32 s31, s17, 401408
  s_add_u32 s31, s31, 39976960
  s_mov_b32 s30, 0
ch_wr4:
  buffer_load_dword v9, off, s[12:15], 0 offset:128 sc1
  s_waitcnt vmcnt(0)
  v_cmp_ne_u32 vcc, 1, v9
  s_cbranch_vccz ch_wr4_ok
  s_sleep 8
  s_add_u32 s30, s30, 1
  s_cmp_lt_u32 s30, 400000
  s_cbranch_scc1 ch_wr4
  s_branch cA_abort
ch_wr4_ok:
  s_lshr_b32 s22, s17, 2
  s_lshl_b32 s28, 0x81, s22
  s_mul_i32 s27, s17, 12
  s_add_u32 s22, s27, 256
  s_lshr_b32 s22, s22, 6
  s_lshl_b32 s22, 0x81, s22
  s_or_b32 s28, s28, s22
  s_add_u32 s22, s27, 267
  s_lshr_b32 s22, s22, 6
  s_lshl_b32 s22, 0x81, s22
  s_or_b32 s28, s28, s22
  v_lshrrev_b32 v12, 8, v2
  v_lshlrev_b32 v12, 7, v12
  s_mov_b32 s27, 582144
  s_mov_b32 s30, 0
ch_ww4:
  buffer_load_dword v9, v12, s[8:11], s27 offen sc1
  s_waitcnt vmcnt(0)
  v_and_b32 v10, s28, v9
  v_cmp_ne_u32 vcc, s28, v10
  s_cbranch_vccz ch_ww4_ok
  s_sleep 3
  s_add_u32 s30, s30, 1
  s_cmp_lt_u32 s30, 400000
  s_cbranch_scc1 ch_ww4
  s_branch cA_abort
ch_ww4_ok:
  s_add_u32 s22, s31, 0
  buffer_load_dwordx4 a[0:3], v2, s[8:11], s22 offen offset:0 sc1
  buffer_load_dwordx4 a[4:7], v2, s[8:11], s22 offen offset:1024 sc1
  buffer_load_dwordx4 a[8:11], v2, s[8:11], s22 offen offset:2048 sc1
  buffer_load_dwordx4 a[12:15], v2, s[8:11], s22 offen offset:3072 sc1
  s_add_u32 s22, s31, 4096
  buffer_load_dwordx4 a[16:19], v2, s[8:11], s22 offen offset:0 sc1
  buffer_load_dwordx4 a[20:23], v2, s[8:11], s22 offen offset:1024 sc1
  buffer_load_dwordx4 a[24:27], v2, s[8:11], s22 offen offset:2048 sc1
  buffer_load_dwordx4 a[28:31], v2, s[8:11], s22 offen offset:3072 sc1
  s_add_u32 s22, s31, 8192
  buffer_load_dwordx4 a[32:35], v2, s[8:11], s22 offen offset:0 sc1
  buffer_load_dwordx4 a[36:39], v2, s[8:11], s22 offen offset:1024 sc1
  buffer_load_dwordx4 a[40:43], v2, s[8:11], s22 offen offset:2048 sc1
  buffer_load_dwordx4 a[44:47], v2, s[8:11], s22 offen offset:3072 sc1
  s_add_u32 s22, s31, 12288
  buffer_load_dwordx4 a[48:51], v2, s[8:11], s22 offen offset:0 sc1
  buffer_load_dwordx4 a[52:55], v2, s[8:11], s22 offen offset:1024 sc1
  buffer_load_dwordx4 a[56:59], v2, s[8:11], s22 offen offset:2048 sc1
  buffer_load_dwordx4 a[60:63], v2, s[8:11], s22 offen offset:3072 sc1
  s_add_u32 s22, s31, 16384
  buffer_load_dwordx4 a[64:67], v2, s[8:11], s22 offen offset:0 sc1
  buffer_load_dwordx4 a[68:71], v2, s[8:11], s22 offen offset:1024 sc1
  buffer_load_dwordx4 a[72:75], v2, s[8:11], s22 offen offset:2048 sc1
  buffer_load_dwordx4 a[76:79], v2, s[8:11], s22 offen offset:3072 sc1
  s_add_u32 s22, s31, 20480
  buffer_load_dwordx4 a[80:83], v2, s[8:11], s22 offen offset:0 sc1
  buffer_load_dwordx4 a[84:87], v2, s[8:11], s22 offen offset:1024 sc1
  buffer_load_dwordx4 a[88:91], v2, s[8:11], s22 offen offset:2048 sc1
  buffer_load_dwordx4 a[92:95], v2, s[8:11], s22 offen offset:3072 sc1
  s_add_u32 s22, s31, 24576
  buffer_load_dwordx4 a[96:99], v2, s[8:11], s22 offen offset:0 sc1
  buffer_load_dwordx4 a[100:103], v2, s[8:11], s22 offen offset:1024 sc1
  buffer_load_dwordx4 a[104:107], v2, s[8:11], s22 offen offset:2048 sc1
  buffer_load_dwordx4 a[108:111], v2, s[8:11], s22 offen offset:3072 sc1
  s_add_u32 s22, s31, 28672
  buffer_load_dwordx4 a[112:115], v2, s[8:11], s22 offen offset:0 sc1
  buffer_load_dwordx4 a[116:119], v2, s[8:11], s22 offen offset:1024 sc1
  buffer_load_dwordx4 a[120:123], v2, s[8:11], s22 offen offset:2048 sc1
  buffer_load_dwordx4 a[124:127], v2, s[8:11], s22 offen offset:3072 sc1
  s_waitcnt vmcnt(24)
  s_add_u32 s22, s31, 32768
  buffer_load_dwordx4 a[128:131], v2, s[8:11], s22 offen offset:0 sc1
  buffer_load_dwordx4 a[132:135], v2, s[8:11], s22 offen offset:1024 sc1
  buffer_load_dwordx4 a[136:139], v2, s[8:11], s22 offen offset:2048 sc1
  buffer_load_dwordx4 a[140:143], v2, s[8:11], s22 offen offset:3072 sc1
  s_add_u32 s22, s31, 36864
  buffer_load_dwordx4 a[144:147], v2, s[8:11], s22 offen offset:0 sc1
  buffer_load_dwordx4 a[148:151], v2, s[8:11], s22 offen offset:1024 sc1
  buffer_load_dwordx4 a[152:155], v2, s[8:11], s22 offen offset:2048 sc1
  buffer_load_dwordx4 a[156:159], v2, s[8:11], s22 offen offset:3072 sc1
  s_add_u32 s22, s31, 40960
  buffer_load_dwordx4 a[160:163], v2, s[8:11], s22 offen offset:0 sc1
  buffer_load_dwordx4 a[164:167], v2, s[8:11], s22 offen offset:1024 sc1
  buffer_load_dwordx4 a[168:171], v2, s[8:11], s22 offen offset:2048 sc1
  buffer_load_dwordx4 a[172:175], v2, s[8:11], s22 offen offset:3072 sc1
  s_add_u32 s22, s31, 45056
  buffer_load_dwordx4 a[176:179], v2, s[8:11], s22 offen offset:0 sc1
  buffer_load_dwordx4 a[180:183], v2, s[8:11], s22 offen offset:1024 sc1
  buffer_load_dwordx4 a[184:187], v2, s[8:11], s22 offen offset:2048 sc1
  buffer_load_dwordx4 a[188:191], v2, s[8:11], s22 offen offset:3072 sc1
  s_add_u32 s22, s31, 49152
  buffer_load_dwordx4 a[192:195], v2, s[8:11], s22 offen offset:0 sc1
  buffer_load_dwordx4 a[196:199], v2, s[8:11], s22 offen offset:1024 sc1
  buffer_load_dwordx4 a[200:203], v2, s[8:11], s22 offen offset:2048 sc1
  buffer_load_dwordx4 a[204:207], v2, s[8:11], s22 offen offset:3072 sc1
  s_add_u32 s22, s31, 53248
  buffer_load_dwordx4 a[208:211], v2, s[8:11], s22 offen offset:0 sc1
  buffer_load_dwordx4 a[212:215], v2, s[8:11], s22 offen offset:1024 sc1
  buffer_load_dwordx4 a[216:219], v2, s[8:11], s22 offen offset:2048 sc1
  buffer_load_dwordx4 a[220:223], v2, s[8:11], s22 offen offset:3072 sc1
  s_add_u32 s22, s31, 57344
  buffer_load_dwordx4 a[224:227], v2, s[8:11], s22 offen offset:0 sc1
  buffer_load_dwordx4 a[228:231], v2, s[8:11], s22 offen offset:1024 sc1
  buffer_load_dwordx4 a[232:235], v2, s[8:11], s22 offen offset:2048 sc1
  buffer_load_dwordx4 a[236:239], v2, s[8:11], s22 offen offset:3072 sc1
  s_add_u32 s22, s31, 61440
  buffer_load_dwordx4 a[240:243], v2, s[8:11], s22 offen offset:0 sc1
  buffer_load_dwordx4 a[244:247], v2, s[8:11], s22 offen offset:1024 sc1
  buffer_load_dwordx4 a[248:251], v2, s[8:11], s22 offen offset:2048 sc1
  buffer_load_dwordx4 a[252:255], v2, s[8:11], s22 offen offset:3072 sc1
  s_waitcnt vmcnt(24)
  s_add_u32 s22, s31, 65536
  buffer_load_dwordx4 v[176:179], v2, s[8:11], s22 offen offset:0 sc1
  buffer_load_dwordx4 v[180:183], v2, s[8:11], s22 offen offset:1024 sc1
  buffer_load_dwordx4 v[184:187], v2, s[8:11], s22 offen offset:2048 sc1
  buffer_load_dwordx4 v[188:191], v2, s[8:11], s22 offen offset:3072 sc1
  s_add_u32 s22, s31, 69632
  buffer_load_dwordx4 v[192:195], v2, s[8:11], s22 offen offset:0 sc1
  buffer_load_dwordx4 v[196:199], v2, s[8:11], s22 offen offset:1024 sc1
  buffer_load_dwordx4 v[200:203], v2, s[8:11], s22 offen offset:2048 sc1
  buffer_load_dwordx4 v[204:207], v2, s[8:11], s22 offen offset:3072 sc1
  s_add_u32 s22, s31, 73728
  buffer_load_dwordx4 v[208:211], v2, s[8:11], s22 offen offset:0 sc1
  buffer_load_dwordx4 v[212:215], v2, s[8:11], s22 offen offset:1024 sc1
  buffer_load_dwordx4 v[216:219], v2, s[8:11], s22 offen offset:2048 sc1
  buffer_load_dwordx4 v[220:223], v2, s[8:11], s22 offen offset:3072 sc1
  s_add_u32 s22, s31, 77824
  buffer_load_dwordx4 v[224:227], v2, s[8:11], s22 offen offset:0 sc1
  buffer_load_dwordx4 v[228:231], v2, s[8:11], s22 offen offset:1024 sc1
  buffer_load_dwordx4 v[232:235], v2, s[8:11], s22 offen offset:2048 sc1
  buffer_load_dwordx4 v[236:239], v2, s[8:11], s22 offen offset:3072 sc1
  s_add_u32 s22, s31, 81920
  buffer_load_dwordx4 v[240:243], v2, s[8:11], s22 offen offset:0 sc1
  buffer_load_dwordx4 v[244:247], v2, s[8:11], s22 offen offset:1024 sc1
  buffer_load_dwordx4 v[248:251], v2, s[8:11], s22 offen offset:2048 sc1
  buffer_load_dwordx4 v[252:255], v2, s[8:11], s22 offen offset:3072 sc1
  s_mov_b32 m0, 16384
  s_add_u32 s22, s31, 86016
  buffer_load_dwordx4 v2, s[8:11], s22 offen offset:0 sc1 lds
  buffer_load_dwordx4 v2, s[8:11], s22 offen offset:1024 sc1 lds
  buffer_load_dwordx4 v2, s[8:11], s22 offen offset:2048 sc1 lds
  buffer_load_dwordx4 v2, s[8:11], s22 offen offset:3072 sc1 lds
  s_mov_b32 m0, 20480
  s_add_u32 s22, s31, 90112
  buffer_load_dwordx4 v2, s[8:11], s22 offen offset:0 sc1 lds
  buffer_load_dwordx4 v2, s[8:11], s22 offen offset:1024 sc1 lds
  buffer_load_dwordx4 v2, s[8:11], s22 offen offset:2048 sc1 lds
  buffer_load_dwordx4 v2, s[8:11], s22 offen offset:3072 sc1 lds
  s_mov_b32 m0, 24576
  s_add_u32 s22, s31, 94208
  buffer_load_dwordx4 v2, s[8:11], s22 offen offset:0 sc1 lds
  buffer_load_dwordx4 v2, s[8:11], s22 offen offset:1024 sc1 lds
  buffer_load_dwordx4 v2, s[8:11], s22 offen offset:2048 sc1 lds
  buffer_load_dwordx4 v2, s[8:11], s22 offen offset:3072 sc1 lds
  s_mov_b32 m0, 28672
  s_add_u32 s22, s31, 98304
  buffer_load_dwordx4 v2, s[8:11], s22 offen offset:0 sc1 lds
  buffer_load_dwordx4 v2, s[8:11], s22 offen offset:1024 sc1 lds
  s_mov_b32 s30, 0
ch_ws4:
  buffer_load_dword v9, off, s[12:15], 0 offset:132 sc1
  s_waitcnt vmcnt(0)
  v_cmp_ne_u32 vcc, 1, v9
  s_cbranch_vccz ch_ws4_ok
  s_sleep 8
  s_add_u32 s30, s30, 1
  s_cmp_lt_u32 s30, 400000
  s_cbranch_scc1 ch_ws4
  s_branch cA_abort
ch_ws4_ok:
  s_mul_i32 s33, s17, 532480
  s_add_u32 s33, s33, 78110720
  v_mov_b32 v12, -1
  v_mov_b32 v13, -1
  v_mov_b32 v14, -1
  v_mov_b32 v15, -1
  s_add_u32 s22, s33, 0
  buffer_store_dwordx4 v[12:15], v2, s[8:11], s22 offen sc1
  s_add_u32 s22, s33, 2048
  buffer_store_dwordx4 v[12:15], v2, s[8:11], s22 offen sc1
  s_add_u32 s22, s33, 4096
  buffer_store_dwordx4 v[12:15], v2, s[8:11], s22 offen sc1
  s_add_u32 s22, s33, 6144
  buffer_store_dwordx4 v[12:15], v2, s[8:11], s22 offen sc1
  s_add_u32 s22, s33, 8192
  buffer_store_dwordx4 v[12:15], v2, s[8:11], s22 offen sc1
  s_add_u32 s22, s33, 10240
  buffer_store_dwordx4 v[12:15], v2, s[8:11], s22 offen sc1
  s_add_u32 s22, s33, 12288
  buffer_store_dwordx4 v[12:15], v2, s[8:11], s22 offen sc1
  s_add_u32 s22, s33, 14336
  buffer_store_dwordx4 v[12:15], v2, s[8:11], s22 offen sc1
  v_mov_b32 v16, 1
  v_mov_b32 v17, 1
  s_lshl_b32 s22, s17, 10
  s_add_u32 s22, s22, 566240
  s_waitcnt vmcnt(0)
  s_mov_b64 exec, 3
  buffer_store_dwordx2 v[16:17], v2, s[8:11], s22 offen sc1
  s_mov_b64 exec, -1
  s_mov_b32 s28, s35
  s_waitcnt vmcnt(0) lgkmcnt(0)
  s_mov_b32 s31, 0
  s_cmp_lg_u32 s88, 0
  s_cbranch_scc1 cB_va0_loop
  s_branch cA_va0_loop
ch_init5:
  v_mov_b32 v72, v116
  v_mov_b32 v73, v117
  v_lshrrev_b32 v65, 1, v72
  v_and_b32 v66, 1, v72
  v_mov_b32 v36, 0
  v_mov_b32 v37, 0
  v_mov_b32 v38, 0
  v_mov_b32 v39, 0
  v_mov_b32 v40, 0
  v_mov_b32 v41, 0
  v_mov_b32 v42, 0
  v_mov_b32 v43, 0
  v_mov_b32 v44, 0
  v_mov_b32 v45, 0
  v_mov_b32 v46, 0
  v_mov_b32 v47, 0
  v_mov_b32 v48, 0
  v_mov_b32 v49, 0
  v_mov_b32 v50, 0
  v_mov_b32 v51, 0
  v_mov_b32 v52, 0
  v_mov_b32 v53, 0
  v_mov_b32 v54, 0
  v_mov_b32 v55, 0
  v_mov_b32 v56, 0
  v_mov_b32 v57, 0
  v_mov_b32 v58, 0
  v_mov_b32 v59, 0
  v_mov_b32 v60, 0
  v_mov_b32 v61, 0
  v_mov_b32 v62, 0
  v_mov_b32 v63, 0
  v_lshlrev_b32 v75, 2, v65
  v_lshl_add_u32 v75, v66, 3, v75
  v_add_u32 v67, 112, v73
  v_mul_u32_u24 v68, 2341, v67
  v_lshrrev_b32 v68, 16, v68
  v_mul_u32_u24 v69, 28, v68
  v_sub_u32 v69, v67, v69
  v_lshrrev_b32 v70, 4, v69
  v_and_b32 v69, 15, v69
  v_lshlrev_b32 v71, 12, v70
  v_lshl_add_u32 v71, v68, 8, v71
  v_lshl_add_u32 v71, v69, 4, v71
  v_add_u32 v152, v71, v75
  v_add_u32 v67, 128, v73
  v_mul_u32_u24 v68, 2341, v67
  v_lshrrev_b32 v68, 16, v68
  v_mul_u32_u24 v69, 28, v68
  v_sub_u32 v69, v67, v69
  v_lshrrev_b32 v70, 4, v69
  v_and_b32 v69, 15, v69
  v_lshlrev_b32 v71, 12, v70
  v_lshl_add_u32 v71, v68, 8, v71
  v_lshl_add_u32 v71, v69, 4, v71
  v_add_u32 v153, v71, v75
  v_add_u32 v67, 144, v73
  v_mul_u32_u24 v68, 2341, v67
  v_lshrrev_b32 v68, 16, v68
  v_mul_u32_u24 v69, 28, v68
  v_sub_u32 v69, v67, v69
  v_lshrrev_b32 v70, 4, v69
  v_and_b32 v69, 15, v69
  v_lshlrev_b32 v71, 12, v70
  v_lshl_add_u32 v71, v68, 8, v71
  v_lshl_add_u32 v71, v69, 4, v71
  v_add_u32 v154, v71, v75
  v_add_u32 v67, 160, v73
  v_mul_u32_u24 v68, 2341, v67
  v_lshrrev_b32 v68, 16, v68
  v_mul_u32_u24 v69, 28, v68
  v_sub_u32 v69, v67, v69
  v_lshrrev_b32 v70, 4, v69
  v_and_b32 v69, 15, v69
  v_lshlrev_b32 v71, 12, v70
  v_lshl_add_u32 v71, v68, 8, v71
  v_lshl_add_u32 v71, v69, 4, v71
  v_add_u32 v155, v71, v75
  v_add_u32 v67, 176, v73
  v_mul_u32_u24 v68, 2341, v67
  v_lshrrev_b32 v68, 16, v68
  v_mul_u32_u24 v69, 28, v68
  v_sub_u32 v69, v67, v69
  v_lshrrev_b32 v70, 4, v69
  v_and_b32 v69, 15, v69
  v_lshlrev_b32 v71, 12, v70
  v_lshl_add_u32 v71, v68, 8, v71
  v_lshl_add_u32 v71, v69, 4, v71
  v_add_u32 v156, v71, v75
  v_add_u32 v67, 192, v73
  v_mul_u32_u24 v68, 2341, v67
  v_lshrrev_b32 v68, 16, v68
  v_mul_u32_u24 v69, 28, v68
  v_sub_u32 v69, v67, v69
  v_lshrrev_b32 v70, 4, v69
  v_and_b32 v69, 15, v69
  v_lshlrev_b32 v71, 12, v70
  v_lshl_add_u32 v71, v68, 8, v71
  v_lshl_add_u32 v71, v69, 4, v71
  v_add_u32 v157, v71, v75
  v_add_u32 v67, 208, v73
  v_mul_u32_u24 v68, 2341, v67
  v_lshrrev_b32 v68, 16, v68
  v_mul_u32_u24 v69, 28, v68
  v_sub_u32 v69, v67, v69
  v_lshrrev_b32 v70, 4, v69
  v_and_b32 v69, 15, v69
  v_lshlrev_b32 v71, 12, v70
  v_lshl_add_u32 v71, v68, 8, v71
  v_lshl_add_u32 v71, v69, 4, v71
  v_add_u32 v158, v71, v75
  v_mov_b32 v74, 0x40000000
  v_mov_b32 v164, 0
  v_add_u32 v0, 30720, v2
  v_mov_b32 v76, 0
  v_mov_b32 v77, 0
  v_mov_b32 v78, 0
  v_mov_b32 v79, 0
  ds_write_b128 v2, v[76:79] offset:4096
  ds_write_b128 v2, v[76:79] offset:5120
  ds_write_b128 v2, v[76:79] offset:6144
  ds_write_b128 v2, v[76:79] offset:7168
  s_and_b32 s22, s17, 0
  s_lshl_b32 s22, s22, 7
  s_add_u32 s22, s22, 35328
  v_lshl_add_u32 v4, v73, 2, s22
  v_and_b32 v64, 1, v73
  v_mov_b32 v5, 0x05040100
  v_mov_b32 v65, 0x03020706
  v_cmp_eq_u32 vcc, 1, v64
  s_nop 1
  v_cndmask_b32 v5, v5, v65, vcc
  s_lshl_b32 s22, s17, 2
  s_add_u32 s22, s22, 39424
  v_lshl_add_u32 v7, v1, 7, s22
  v_cmp_gt_u32 vcc, 1, v1
  s_nop 1
  v_cndmask_b32 v7, v74, v7, vcc
  v_min_u32 v65, 11, v73
  v_mad_u32_u24 v65, v72, 12, v65
  v_lshlrev_b32 v6, 4, v65
  v_add_u32 v6, 1024, v6
  v_lshl_add_u32 v64, v66, 2, v64
  v_and_b32 v65, 2, v72
  v_add_u32 v64, v64, v65
  s_mul_i32 s22, s17, 12
  s_add_u32 s22, s22, 256
  v_add_u32 v75, s22, v73
  v_lshrrev_b32 v68, 4, v75
  v_lshlrev_b32 v68, 8, v68
  v_bfe_u32 v69, v75, 1, 1
  v_lshl_add_u32 v68, v69, 7, v68
  v_lshl_add_u32 v68, v64, 4, v68
  v_and_b32 v69, 12, v75
  v_add_u32 v1, v68, v69
  v_cmp_gt_u32 vcc, 12, v73
  s_nop 1
  v_cndmask_b32 v1, v74, v1, vcc
  s_mul_i32 s22, s17, 28672
  s_add_u32 s25, s22, 2490368
  s_and_b32 s27, s17, 0
  s_xor_b32 s22, s27, 0
  s_mul_i32 s80, s22, 7168
  s_lshl_b32 s22, s22, 11
  s_add_u32 s76, s22, 9216
  s_xor_b32 s22, s27, 1
  s_mul_i32 s81, s22, 7168
  s_lshl_b32 s22, s22, 11
  s_add_u32 s77, s22, 9216
  s_xor_b32 s22, s27, 2
  s_mul_i32 s82, s22, 7168
  s_lshl_b32 s22, s22, 11
  s_add_u32 s78, s22, 9216
  s_xor_b32 s22, s27, 3
  s_mul_i32 s83, s22, 7168
  s_lshl_b32 s22, s22, 11
  s_add_u32 s79, s22, 9216
  v_mov_b32 v162, -1
  s_mov_b32 s38, 0x40000000
  s_mul_i32 s31, s17, 401408
  s_add_u32 s31, s31, 40077312
  s_mov_b32 s30, 0
ch_wr5:
  buffer_load_dword v9, off, s[12:15], 0 offset:128 sc1
  s_waitcnt vmcnt(0)
  v_cmp_ne_u32 vcc, 1, v9
  s_cbranch_vccz ch_wr5_ok
  s_sleep 8
  s_add_u32 s30, s30, 1
  s_cmp_lt_u32 s30, 400000
  s_cbranch_scc1 ch_wr5
  s_branch cA_abort
ch_wr5_ok:
  s_lshr_b32 s22, s17, 2
  s_lshl_b32 s28, 0x81, s22
  s_mul_i32 s27, s17, 12
  s_add_u32 s22, s27, 256
  s_lshr_b32 s22, s22, 6
  s_lshl_b32 s22, 0x81, s22
  s_or_b32 s28, s28, s22
  s_add_u32 s22, s27, 267
  s_lshr_b32 s22, s22, 6
  s_lshl_b32 s22, 0x81, s22
  s_or_b32 s28, s28, s22
  v_lshrrev_b32 v12, 8, v2
  v_lshlrev_b32 v12, 7, v12
  s_mov_b32 s27, 582656
  s_mov_b32 s30, 0
ch_ww5:
  buffer_load_dword v9, v12, s[8:11], s27 offen sc1
  s_waitcnt vmcnt(0)
  v_and_b32 v10, s28, v9
  v_cmp_ne_u32 vcc, s28, v10
  s_cbranch_vccz ch_ww5_ok
  s_sleep 3
  s_add_u32 s30, s30, 1
  s_cmp_lt_u32 s30, 400000
  s_cbranch_scc1 ch_ww5
  s_branch cA_abort
ch_ww5_ok:
  s_add_u32 s22, s31, 0
  buffer_load_dwordx4 a[0:3], v2, s[8:11], s22 offen offset:0 sc1
  buffer_load_dwordx4 a[4:7], v2, s[8:11], s22 offen offset:1024 sc1
  buffer_load_dwordx4 a[8:11], v2, s[8:11], s22 offen offset:2048 sc1
  buffer_load_dwordx4 a[12:15], v2, s[8:11], s22 offen offset:3072 sc1
  s_add_u32 s22, s31, 4096
  buffer_load_dwordx4 a[16:19], v2, s[8:11], s22 offen offset:0 sc1
  buffer_load_dwordx4 a[20:23], v2, s[8:11], s22 offen offset:1024 sc1
  buffer_load_dwordx4 a[24:27], v2, s[8:11], s22 offen offset:2048 sc1
  buffer_load_dwordx4 a[28:31], v2, s[8:11], s22 offen offset:3072 sc1
  s_add_u32 s22, s31, 8192
  buffer_load_dwordx4 a[32:35], v2, s[8:11], s22 offen offset:0 sc1
  buffer_load_dwordx4 a[36:39], v2, s[8:11], s22 offen offset:1024 sc1
  buffer_load_dwordx4 a[40:43], v2, s[8:11], s22 offen offset:2048 sc1
  buffer_load_dwordx4 a[44:47], v2, s[8:11], s22 offen offset:3072 sc1
  s_add_u32 s22, s31, 12288
  buffer_load_dwordx4 a[48:51], v2, s[8:11], s22 offen offset:0 sc1
  buffer_load_dwordx4 a[52:55], v2, s[8:11], s22 offen offset:1024 sc1
  buffer_load_dwordx4 a[56:59], v2, s[8:11], s22 offen offset:2048 sc1
  buffer_load_dwordx4 a[60:63], v2, s[8:11], s22 offen offset:3072 sc1
  s_add_u32 s22, s31, 16384
  buffer_load_dwordx4 a[64:67], v2, s[8:11], s22 offen offset:0 sc1
  buffer_load_dwordx4 a[68:71], v2, s[8:11], s22 offen offset:1024 sc1
  buffer_load_dwordx4 a[72:75], v2, s[8:11], s22 offen offset:2048 sc1
  buffer_load_dwordx4 a[76:79], v2, s[8:11], s22 offen offset:3072 sc1
  s_add_u32 s22, s31, 20480
  buffer_load_dwordx4 a[80:83], v2, s[8:11], s22 offen offset:0 sc1
  buffer_load_dwordx4 a[84:87], v2, s[8:11], s22 offen offset:1024 sc1
  buffer_load_dwordx4 a[88:91], v2, s[8:11], s22 offen offset:2048 sc1
  buffer_load_dwordx4 a[92:95], v2, s[8:11], s22 offen offset:3072 sc1
  s_add_u32 s22, s31, 24576
  buffer_load_dwordx4 a[96:99], v2, s[8:11], s22 offen offset:0 sc1
  buffer_load_dwordx4 a[100:103], v2, s[8:11], s22 offen offset:1024 sc1
  buffer_load_dwordx4 a[104:107], v2, s[8:11], s22 offen offset:2048 sc1
  buffer_load_dwordx4 a[108:111], v2, s[8:11], s22 offen offset:3072 sc1
  s_add_u32 s22, s31, 28672
  buffer_load_dwordx4 a[112:115], v2, s[8:11], s22 offen offset:0 sc1
  buffer_load_dwordx4 a[116:119], v2, s[8:11], s22 offen offset:1024 sc1
  buffer_load_dwordx4 a[120:123], v2, s[8:11], s22 offen offset:2048 sc1
  buffer_load_dwordx4 a[124:127], v2, s[8:11], s22 offen offset:3072 sc1
  s_waitcnt vmcnt(24)
  s_add_u32 s22, s31, 32768
  buffer_load_dwordx4 a[128:131], v2, s[8:11], s22 offen offset:0 sc1
  buffer_load_dwordx4 a[132:135], v2, s[8:11], s22 offen offset:1024 sc1
  buffer_load_dwordx4 a[136:139], v2, s[8:11], s22 offen offset:2048 sc1
  buffer_load_dwordx4 a[140:143], v2, s[8:11], s22 offen offset:3072 sc1
  s_add_u32 s22, s31, 36864
  buffer_load_dwordx4 a[144:147], v2, s[8:11], s22 offen offset:0 sc1
  buffer_load_dwordx4 a[148:151], v2, s[8:11], s22 offen offset:1024 sc1
  buffer_load_dwordx4 a[152:155], v2, s[8:11], s22 offen offset:2048 sc1
  buffer_load_dwordx4 a[156:159], v2, s[8:11], s22 offen offset:3072 sc1
  s_add_u32 s22, s31, 40960
  buffer_load_dwordx4 a[160:163], v2, s[8:11], s22 offen offset:0 sc1
  buffer_load_dwordx4 a[164:167], v2, s[8:11], s22 offen offset:1024 sc1
  buffer_load_dwordx4 a[168:171], v2, s[8:11], s22 offen offset:2048 sc1
  buffer_load_dwordx4 a[172:175], v2, s[8:11], s22 offen offset:3072 sc1
  s_add_u32 s22, s31, 45056
  buffer_load_dwordx4 a[176:179], v2, s[8:11], s22 offen offset:0 sc1
  buffer_load_dwordx4 a[180:183], v2, s[8:11], s22 offen offset:1024 sc1
  buffer_load_dwordx4 a[184:187], v2, s[8:11], s22 offen offset:2048 sc1
  buffer_load_dwordx4 a[188:191], v2, s[8:11], s22 offen offset:3072 sc1
  s_add_u32 s22, s31, 49152
  buffer_load_dwordx4 a[192:195], v2, s[8:11], s22 offen offset:0 sc1
  buffer_load_dwordx4 a[196:199], v2, s[8:11], s22 offen offset:1024 sc1
  buffer_load_dwordx4 a[200:203], v2, s[8:11], s22 offen offset:2048 sc1
  buffer_load_dwordx4 a[204:207], v2, s[8:11], s22 offen offset:3072 sc1
  s_add_u32 s22, s31, 53248
  buffer_load_dwordx4 a[208:211], v2, s[8:11], s22 offen offset:0 sc1
  buffer_load_dwordx4 a[212:215], v2, s[8:11], s22 offen offset:1024 sc1
  buffer_load_dwordx4 a[216:219], v2, s[8:11], s22 offen offset:2048 sc1
  buffer_load_dwordx4 a[220:223], v2, s[8:11], s22 offen offset:3072 sc1
  s_add_u32 s22, s31, 57344
  buffer_load_dwordx4 a[224:227], v2, s[8:11], s22 offen offset:0 sc1
  buffer_load_dwordx4 a[228:231], v2, s[8:11], s22 offen offset:1024 sc1
  buffer_load_dwordx4 a[232:235], v2, s[8:11], s22 offen offset:2048 sc1
  buffer_load_dwordx4 a[236:239], v2, s[8:11], s22 offen offset:3072 sc1
  s_add_u32 s22, s31, 61440
  buffer_load_dwordx4 a[240:243], v2, s[8:11], s22 offen offset:0 sc1
  buffer_load_dwordx4 a[244:247], v2, s[8:11], s22 offen offset:1024 sc1
  buffer_load_dwordx4 a[248:251], v2, s[8:11], s22 offen offset:2048 sc1
  buffer_load_dwordx4 a[252:255], v2, s[8:11], s22 offen offset:3072 sc1
  s_waitcnt vmcnt(24)
  s_add_u32 s22, s31, 65536
  buffer_load_dwordx4 v[176:179], v2, s[8:11], s22 offen offset:0 sc1
  buffer_load_dwordx4 v[180:183], v2, s[8:11], s22 offen offset:1024 sc1
  buffer_load_dwordx4 v[184:187], v2, s[8:11], s22 offen offset:2048 sc1
  buffer_load_dwordx4 v[188:191], v2, s[8:11], s22 offen offset:3072 sc1
  s_add_u32 s22, s31, 69632
  buffer_load_dwordx4 v[192:195], v2, s[8:11], s22 offen offset:0 sc1
  buffer_load_dwordx4 v[196:199], v2, s[8:11], s22 offen offset:1024 sc1
  buffer_load_dwordx4 v[200:203], v2, s[8:11], s22 offen offset:2048 sc1
  buffer_load_dwordx4 v[204:207], v2, s[8:11], s22 offen offset:3072 sc1
  s_add_u32 s22, s31, 73728
  buffer_load_dwordx4 v[208:211], v2, s[8:11], s22 offen offset:0 sc1
  buffer_load_dwordx4 v[212:215], v2, s[8:11], s22 offen offset:1024 sc1
  buffer_load_dwordx4 v[216:219], v2, s[8:11], s22 offen offset:2048 sc1
  buffer_load_dwordx4 v[220:223], v2, s[8:11], s22 offen offset:3072 sc1
  s_add_u32 s22, s31, 77824
  buffer_load_dwordx4 v[224:227], v2, s[8:11], s22 offen offset:0 sc1
  buffer_load_dwordx4 v[228:231], v2, s[8:11], s22 offen offset:1024 sc1
  buffer_load_dwordx4 v[232:235], v2, s[8:11], s22 offen offset:2048 sc1
  buffer_load_dwordx4 v[236:239], v2, s[8:11], s22 offen offset:3072 sc1
  s_add_u32 s22, s31, 81920
  buffer_load_dwordx4 v[240:243], v2, s[8:11], s22 offen offset:0 sc1
  buffer_load_dwordx4 v[244:247], v2, s[8:11], s22 offen offset:1024 sc1
  buffer_load_dwordx4 v[248:251], v2, s[8:11], s22 offen offset:2048 sc1
  buffer_load_dwordx4 v[252:255], v2, s[8:11], s22 offen offset:3072 sc1
  s_mov_b32 m0, 30720
  s_add_u32 s22, s31, 86016
  buffer_load_dwordx4 v2, s[8:11], s22 offen offset:0 sc1 lds
  buffer_load_dwordx4 v2, s[8:11], s22 offen offset:1024 sc1 lds
  buffer_load_dwordx4 v2, s[8:11], s22 offen offset:2048 sc1 lds
  buffer_load_dwordx4 v2, s[8:11], s22 offen offset:3072 sc1 lds
  s_mov_b32 m0, 34816
  s_add_u32 s22, s31, 90112
  buffer_load_dwordx4 v2, s[8:11], s22 offen offset:0 sc1 lds
  buffer_load_dwordx4 v2, s[8:11], s22 offen offset:1024 sc1 lds
  buffer_load_dwordx4 v2, s[8:11], s22 offen offset:2048 sc1 lds
  buffer_load_dwordx4 v2, s[8:11], s22 offen offset:3072 sc1 lds
  s_mov_b32 m0, 38912
  s_add_u32 s22, s31, 94208
  buffer_load_dwordx4 v2, s[8:11], s22 offen offset:0 sc1 lds
  buffer_load_dwordx4 v2, s[8:11], s22 offen offset:1024 sc1 lds
  buffer_load_dwordx4 v2, s[8:11], s22 offen offset:2048 sc1 lds
  buffer_load_dwordx4 v2, s[8:11], s22 offen offset:3072 sc1 lds
  s_mov_b32 m0, 43008
  s_add_u32 s22, s31, 98304
  buffer_load_dwordx4 v2, s[8:11], s22 offen offset:0 sc1 lds
  buffer_load_dwordx4 v2, s[8:11], s22 offen offset:1024 sc1 lds
  s_mov_b32 s30, 0
ch_ws5:
  buffer_load_dword v9, off, s[12:15], 0 offset:132 sc1
  s_waitcnt vmcnt(0)
  v_cmp_ne_u32 vcc, 1, v9
  s_cbranch_vccz ch_ws5_ok
  s_sleep 8
  s_add_u32 s30, s30, 1
  s_cmp_lt_u32 s30, 400000
  s_cbranch_scc1 ch_ws5
  s_branch cA_abort
ch_ws5_ok:
  s_mul_i32 s33, s17, 532480
  s_add_u32 s33, s33, 78111744
  v_mov_b32 v12, -1
  v_mov_b32 v13, -1
  v_mov_b32 v14, -1
  v_mov_b32 v15, -1
  s_add_u32 s22, s33, 0
  buffer_store_dwordx4 v[12:15], v2, s[8:11], s22 offen sc1
  s_add_u32 s22, s33, 2048
  buffer_store_dwordx4 v[12:15], v2, s[8:11], s22 offen sc1
  s_add_u32 s22, s33, 4096
  buffer_store_dwordx4 v[12:15], v2, s[8:11], s22 offen sc1
  s_add_u32 s22, s33, 6144
  buffer_store_dwordx4 v[12:15], v2, s[8:11], s22 offen sc1
  s_add_u32 s22, s33, 8192
  buffer_store_dwordx4 v[12:15], v2, s[8:11], s22 offen sc1
  s_add_u32 s22, s33, 10240
  buffer_store_dwordx4 v[12:15], v2, s[8:11], s22 offen sc1
  s_add_u32 s22, s33, 12288
  buffer_store_dwordx4 v[12:15], v2, s[8:11], s22 offen sc1
  s_add_u32 s22, s33, 14336
  buffer_store_dwordx4 v[12:15], v2, s[8:11], s22 offen sc1
  v_mov_b32 v16, 1
  v_mov_b32 v17, 1
  s_lshl_b32 s22, s17, 10
  s_add_u32 s22, s22, 566248
  s_waitcnt vmcnt(0)
  s_mov_b64 exec, 3
  buffer_store_dwordx2 v[16:17], v2, s[8:11], s22 offen sc1
  s_mov_b64 exec, -1
  s_mov_b32 s28, s35
  s_waitcnt vmcnt(0) lgkmcnt(0)
  s_mov_b32 s31, 0
  s_cmp_lg_u32 s88, 0
  s_cbranch_scc1 cB_va1_loop
  s_branch cA_va1_loop
ch_init6:
  v_mov_b32 v72, v116
  v_mov_b32 v73, v117
  v_lshrrev_b32 v65, 1, v72
  v_and_b32 v66, 1, v72
  v_mov_b32 v36, 0
  v_mov_b32 v37, 0
  v_mov_b32 v38, 0
  v_mov_b32 v39, 0
  v_mov_b32 v40, 0
  v_mov_b32 v41, 0
  v_mov_b32 v42, 0
  v_mov_b32 v43, 0
  v_mov_b32 v44, 0
  v_mov_b32 v45, 0
  v_mov_b32 v46, 0
  v_mov_b32 v47, 0
  v_mov_b32 v48, 0
  v_mov_b32 v49, 0
  v_mov_b32 v50, 0
  v_mov_b32 v51, 0
  v_mov_b32 v52, 0
  v_mov_b32 v53, 0
  v_mov_b32 v54, 0
  v_mov_b32 v55, 0
  v_mov_b32 v56, 0
  v_mov_b32 v57, 0
  v_mov_b32 v58, 0
  v_mov_b32 v59, 0
  v_mov_b32 v60, 0
  v_mov_b32 v61, 0
  v_mov_b32 v62, 0
  v_mov_b32 v63, 0
  v_lshlrev_b32 v75, 2, v65
  v_lshl_add_u32 v75, v66, 3, v75
  v_add_u32 v67, 224, v73
  v_mul_u32_u24 v68, 2341, v67
  v_lshrrev_b32 v68, 16, v68
  v_mul_u32_u24 v69, 28, v68
  v_sub_u32 v69, v67, v69
  v_lshrrev_b32 v70, 4, v69
  v_and_b32 v69, 15, v69
  v_lshlrev_b32 v71, 12, v70
  v_lshl_add_u32 v71, v68, 8, v71
  v_lshl_add_u32 v71, v69, 4, v71
  v_add_u32 v104, v71, v75
  v_add_u32 v67, 240, v73
  v_mul_u32_u24 v68, 2341, v67
  v_lshrrev_b32 v68, 16, v68
  v_mul_u32_u24 v69, 28, v68
  v_sub_u32 v69, v67, v69
  v_lshrrev_b32 v70, 4, v69
  v_and_b32 v69, 15, v69
  v_lshlrev_b32 v71, 12, v70
  v_lshl_add_u32 v71, v68, 8, v71
  v_lshl_add_u32 v71, v69, 4, v71
  v_add_u32 v105, v71, v75
  v_add_u32 v67, 256, v73
  v_mul_u32_u24 v68, 2341, v67
  v_lshrrev_b32 v68, 16, v68
  v_mul_u32_u24 v69, 28, v68
  v_sub_u32 v69, v67, v69
  v_lshrrev_b32 v70, 4, v69
  v_and_b32 v69, 15, v69
  v_lshlrev_b32 v71, 12, v70
  v_lshl_add_u32 v71, v68, 8, v71
  v_lshl_add_u32 v71, v69, 4, v71
  v_add_u32 v106, v71, v75
  v_add_u32 v67, 272, v73
  v_mul_u32_u24 v68, 2341, v67
  v_lshrrev_b32 v68, 16, v68
  v_mul_u32_u24 v69, 28, v68
  v_sub_u32 v69, v67, v69
  v_lshrrev_b32 v70, 4, v69
  v_and_b32 v69, 15, v69
  v_lshlrev_b32 v71, 12, v70
  v_lshl_add_u32 v71, v68, 8, v71
  v_lshl_add_u32 v71, v69, 4, v71
  v_add_u32 v107, v71, v75
  v_add_u32 v67, 288, v73
  v_mul_u32_u24 v68, 2341, v67
  v_lshrrev_b32 v68, 16, v68
  v_mul_u32_u24 v69, 28, v68
  v_sub_u32 v69, v67, v69
  v_lshrrev_b32 v70, 4, v69
  v_and_b32 v69, 15, v69
  v_lshlrev_b32 v71, 12, v70
  v_lshl_add_u32 v71, v68, 8, v71
  v_lshl_add_u32 v71, v69, 4, v71
  v_add_u32 v108, v71, v75
  v_add_u32 v67, 304, v73
  v_mul_u32_u24 v68, 2341, v67
  v_lshrrev_b32 v68, 16, v68
  v_mul_u32_u24 v69, 28, v68
  v_sub_u32 v69, v67, v69
  v_lshrrev_b32 v70, 4, v69
  v_and_b32 v69, 15, v69
  v_lshlrev_b32 v71, 12, v70
  v_lshl_add_u32 v71, v68, 8, v71
  v_lshl_add_u32 v71, v69, 4, v71
  v_add_u32 v109, v71, v75
  v_add_u32 v67, 320, v73
  v_mul_u32_u24 v68, 2341, v67
  v_lshrrev_b32 v68, 16, v68
  v_mul_u32_u24 v69, 28, v68
  v_sub_u32 v69, v67, v69
  v_lshrrev_b32 v70, 4, v69
  v_and_b32 v69, 15, v69
  v_lshlrev_b32 v71, 12, v70
  v_lshl_add_u32 v71, v68, 8, v71
  v_lshl_add_u32 v71, v69, 4, v71
  v_add_u32 v110, v71, v75
  v_add_u32 v67, 96, v73
  v_mul_u32_u24 v68, 2341, v67
  v_lshrrev_b32 v68, 16, v68
  v_mul_u32_u24 v69, 28, v68
  v_sub_u32 v69, v67, v69
  v_lshrrev_b32 v70, 4, v69
  v_and_b32 v69, 15, v69
  v_lshlrev_b32 v71, 12, v70
  v_lshl_add_u32 v71, v68, 8, v71
  v_lshl_add_u32 v71, v69, 4, v71
  v_add_u32 v111, v71, v75
  v_mov_b32 v74, 0x40000000
  v_mov_b32 v96, 0
  v_add_u32 v0, 16384, v2
  v_and_b32 v119, 15, v1
  s_and_b32 s22, s17, 0
  s_lshl_b32 s22, s22, 7
  s_add_u32 s22, s22, 39424
  v_lshl_add_u32 v119, v119, 2, s22
  s_lshl_b32 s22, s17, 2
  s_add_u32 s22, s22, 37376
  v_lshl_add_u32 v118, v1, 7, s22
  v_cmp_gt_u32 vcc, 1, v1
  s_nop 1
  v_cndmask_b32 v118, v74, v118, vcc
  s_lshl_b32 s35, s17, 7
  s_add_u32 s35, s35, 524288
  v_mov_b32 v64, 0
  v_mov_b32 v65, 0
  v_mov_b32 v66, 0
  v_mov_b32 v67, 0
  v_min_u32 v116, 13, v1
  s_mul_i32 s22, s17, 14
  v_add_u32 v116, s22, v116
  v_lshlrev_b32 v116, 7, v116
  s_mul_i32 s31, s17, 401408
  s_add_u32 s31, s31, 40177664
  s_mov_b32 s30, 0
ch_wr6:
  buffer_load_dword v9, off, s[12:15], 0 offset:128 sc1
  s_waitcnt vmcnt(0)
  v_cmp_ne_u32 vcc, 1, v9
  s_cbranch_vccz ch_wr6_ok
  s_sleep 8
  s_add_u32 s30, s30, 1
  s_cmp_lt_u32 s30, 400000
  s_cbranch_scc1 ch_wr6
  s_branch cA_abort
ch_wr6_ok:
  s_lshr_b32 s22, s17, 2
  s_lshl_b32 s28, 0x81, s22
  s_mul_i32 s27, s17, 12
  s_add_u32 s22, s27, 256
  s_lshr_b32 s22, s22, 6
  s_lshl_b32 s22, 0x81, s22
  s_or_b32 s28, s28, s22
  s_add_u32 s22, s27, 267
  s_lshr_b32 s22, s22, 6
  s_lshl_b32 s22, 0x81, s22
  s_or_b32 s28, s28, s22
  v_lshrrev_b32 v12, 8, v2
  v_lshlrev_b32 v12, 7, v12
  s_mov_b32 s27, 583168
  s_mov_b32 s30, 0
ch_ww6:
  buffer_load_dword v9, v12, s[8:11], s27 offen sc1
  s_waitcnt vmcnt(0)
  v_and_b32 v10, s28, v9
  v_cmp_ne_u32 vcc, s28, v10
  s_cbranch_vccz ch_ww6_ok
  s_sleep 3
  s_add_u32 s30, s30, 1
  s_cmp_lt_u32 s30, 400000
  s_cbranch_scc1 ch_ww6
  s_branch cA_abort
ch_ww6_ok:
  s_add_u32 s22, s31, 0
  buffer_load_dwordx4 a[0:3], v2, s[8:11], s22 offen offset:0 sc1
  buffer_load_dwordx4 a[4:7], v2, s[8:11], s22 offen offset:1024 sc1
  buffer_load_dwordx4 a[8:11], v2, s[8:11], s22 offen offset:2048 sc1
  buffer_load_dwordx4 a[12:15], v2, s[8:11], s22 offen offset:3072 sc1
  s_add_u32 s22, s31, 4096
  buffer_load_dwordx4 a[16:19], v2, s[8:11], s22 offen offset:0 sc1
  buffer_load_dwordx4 a[20:23], v2, s[8:11], s22 offen offset:1024 sc1
  buffer_load_dwordx4 a[24:27], v2, s[8:11], s22 offen offset:2048 sc1
  buffer_load_dwordx4 a[28:31], v2, s[8:11], s22 offen offset:3072 sc1
  s_add_u32 s22, s31, 8192
  buffer_load_dwordx4 a[32:35], v2, s[8:11], s22 offen offset:0 sc1
  buffer_load_dwordx4 a[36:39], v2, s[8:11], s22 offen offset:1024 sc1
  buffer_load_dwordx4 a[40:43], v2, s[8:11], s22 offen offset:2048 sc1
  buffer_load_dwordx4 a[44:47], v2, s[8:11], s22 offen offset:3072 sc1
  s_add_u32 s22, s31, 12288
  buffer_load_dwordx4 a[48:51], v2, s[8:11], s22 offen offset:0 sc1
  buffer_load_dwordx4 a[52:55], v2, s[8:11], s22 offen offset:1024 sc1
  buffer_load_dwordx4 a[56:59], v2, s[8:11], s22 offen offset:2048 sc1
  buffer_load_dwordx4 a[60:63], v2, s[8:11], s22 offen offset:3072 sc1
  s_add_u32 s22, s31, 16384
  buffer_load_dwordx4 a[64:67], v2, s[8:11], s22 offen offset:0 sc1
  buffer_load_dwordx4 a[68:71], v2, s[8:11], s22 offen offset:1024 sc1
  buffer_load_dwordx4 a[72:75], v2, s[8:11], s22 offen offset:2048 sc1
  buffer_load_dwordx4 a[76:79], v2, s[8:11], s22 offen offset:3072 sc1
  s_add_u32 s22, s31, 20480
  buffer_load_dwordx4 a[80:83], v2, s[8:11], s22 offen offset:0 sc1
  buffer_load_dwordx4 a[84:87], v2, s[8:11], s22 offen offset:1024 sc1
  buffer_load_dwordx4 a[88:91], v2, s[8:11], s22 offen offset:2048 sc1
  buffer_load_dwordx4 a[92:95], v2, s[8:11], s22 offen offset:3072 sc1
  s_add_u32 s22, s31, 24576
  buffer_load_dwordx4 a[96:99], v2, s[8:11], s22 offen offset:0 sc1
  buffer_load_dwordx4 a[100:103], v2, s[8:11], s22 offen offset:1024 sc1
  buffer_load_dwordx4 a[104:107], v2, s[8:11], s22 offen offset:2048 sc1
  buffer_load_dwordx4 a[108:111], v2, s[8:11], s22 offen offset:3072 sc1
  s_add_u32 s22, s31, 28672
  buffer_load_dwordx4 a[112:115], v2, s[8:11], s22 offen offset:0 sc1
  buffer_load_dwordx4 a[116:119], v2, s[8:11], s22 offen offset:1024 sc1
  buffer_load_dwordx4 a[120:123], v2, s[8:11], s22 offen offset:2048 sc1
  buffer_load_dwordx4 a[124:127], v2, s[8:11], s22 offen offset:3072 sc1
  s_waitcnt vmcnt(24)
  s_add_u32 s22, s31, 32768
  buffer_load_dwordx4 a[128:131], v2, s[8:11], s22 offen offset:0 sc1
  buffer_load_dwordx4 a[132:135], v2, s[8:11], s22 offen offset:1024 sc1
  buffer_load_dwordx4 a[136:139], v2, s[8:11], s22 offen offset:2048 sc1
  buffer_load_dwordx4 a[140:143], v2, s[8:11], s22 offen offset:3072 sc1
  s_add_u32 s22, s31, 36864
  buffer_load_dwordx4 a[144:147], v2, s[8:11], s22 offen offset:0 sc1
  buffer_load_dwordx4 a[148:151], v2, s[8:11], s22 offen offset:1024 sc1
  buffer_load_dwordx4 a[152:155], v2, s[8:11], s22 offen offset:2048 sc1
  buffer_load_dwordx4 a[156:159], v2, s[8:11], s22 offen offset:3072 sc1
  s_add_u32 s22, s31, 40960
  buffer_load_dwordx4 a[160:163], v2, s[8:11], s22 offen offset:0 sc1
  buffer_load_dwordx4 a[164:167], v2, s[8:11], s22 offen offset:1024 sc1
  buffer_load_dwordx4 a[168:171], v2, s[8:11], s22 offen offset:2048 sc1
  buffer_load_dwordx4 a[172:175], v2, s[8:11], s22 offen offset:3072 sc1
  s_add_u32 s22, s31, 45056
  buffer_load_dwordx4 a[176:179], v2, s[8:11], s22 offen offset:0 sc1
  buffer_load_dwordx4 a[180:183], v2, s[8:11], s22 offen offset:1024 sc1
  buffer_load_dwordx4 a[184:187], v2, s[8:11], s22 offen offset:2048 sc1
  buffer_load_dwordx4 a[188:191], v2, s[8:11], s22 offen offset:3072 sc1
  s_add_u32 s22, s31, 49152
  buffer_load_dwordx4 a[192:195], v2, s[8:11], s22 offen offset:0 sc1
  buffer_load_dwordx4 a[196:199], v2, s[8:11], s22 offen offset:1024 sc1
  buffer_load_dwordx4 a[200:203], v2, s[8:11], s22 offen offset:2048 sc1
  buffer_load_dwordx4 a[204:207], v2, s[8:11], s22 offen offset:3072 sc1
  s_add_u32 s22, s31, 53248
  buffer_load_dwordx4 a[208:211], v2, s[8:11], s22 offen offset:0 sc1
  buffer_load_dwordx4 a[212:215], v2, s[8:11], s22 offen offset:1024 sc1
  buffer_load_dwordx4 a[216:219], v2, s[8:11], s22 offen offset:2048 sc1
  buffer_load_dwordx4 a[220:223], v2, s[8:11], s22 offen offset:3072 sc1
  s_add_u32 s22, s31, 57344
  buffer_load_dwordx4 a[224:227], v2, s[8:11], s22 offen offset:0 sc1
  buffer_load_dwordx4 a[228:231], v2, s[8:11], s22 offen offset:1024 sc1
  buffer_load_dwordx4 a[232:235], v2, s[8:11], s22 offen offset:2048 sc1
  buffer_load_dwordx4 a[236:239], v2, s[8:11], s22 offen offset:3072 sc1
  s_add_u32 s22, s31, 61440
  buffer_load_dwordx4 a[240:243], v2, s[8:11], s22 offen offset:0 sc1
  buffer_load_dwordx4 a[244:247], v2, s[8:11], s22 offen offset:1024 sc1
  buffer_load_dwordx4 a[248:251], v2, s[8:11], s22 offen offset:2048 sc1
  buffer_load_dwordx4 a[252:255], v2, s[8:11], s22 offen offset:3072 sc1
  s_waitcnt vmcnt(24)
  s_add_u32 s22, s31, 65536
  buffer_load_dwordx4 v[120:123], v2, s[8:11], s22 offen offset:0 sc1
  buffer_load_dwordx4 v[124:127], v2, s[8:11], s22 offen offset:1024 sc1
  buffer_load_dwordx4 v[128:131], v2, s[8:11], s22 offen offset:2048 sc1
  buffer_load_dwordx4 v[132:135], v2, s[8:11], s22 offen offset:3072 sc1
  s_add_u32 s22, s31, 69632
  buffer_load_dwordx4 v[136:139], v2, s[8:11], s22 offen offset:0 sc1
  buffer_load_dwordx4 v[140:143], v2, s[8:11], s22 offen offset:1024 sc1
  buffer_load_dwordx4 v[144:147], v2, s[8:11], s22 offen offset:2048 sc1
  buffer_load_dwordx4 v[148:151], v2, s[8:11], s22 offen offset:3072 sc1
  s_add_u32 s22, s31, 73728
  buffer_load_dwordx4 v[152:155], v2, s[8:11], s22 offen offset:0 sc1
  buffer_load_dwordx4 v[156:159], v2, s[8:11], s22 offen offset:1024 sc1
  buffer_load_dwordx4 v[160:163], v2, s[8:11], s22 offen offset:2048 sc1
  buffer_load_dwordx4 v[164:167], v2, s[8:11], s22 offen offset:3072 sc1
  s_add_u32 s22, s31, 77824
  buffer_load_dwordx4 v[168:171], v2, s[8:11], s22 offen offset:0 sc1
  buffer_load_dwordx4 v[172:175], v2, s[8:11], s22 offen offset:1024 sc1
  buffer_load_dwordx4 v[176:179], v2, s[8:11], s22 offen offset:2048 sc1
  buffer_load_dwordx4 v[180:183], v2, s[8:11], s22 offen offset:3072 sc1
  s_add_u32 s22, s31, 81920
  buffer_load_dwordx4 v[184:187], v2, s[8:11], s22 offen offset:0 sc1
  buffer_load_dwordx4 v[188:191], v2, s[8:11], s22 offen offset:1024 sc1
  buffer_load_dwordx4 v[192:195], v2, s[8:11], s22 offen offset:2048 sc1
  buffer_load_dwordx4 v[196:199], v2, s[8:11], s22 offen offset:3072 sc1
  s_add_u32 s22, s31, 86016
  buffer_load_dwordx4 v[200:203], v2, s[8:11], s22 offen offset:0 sc1
  buffer_load_dwordx4 v[204:207], v2, s[8:11], s22 offen offset:1024 sc1
  buffer_load_dwordx4 v[208:211], v2, s[8:11], s22 offen offset:2048 sc1
  buffer_load_dwordx4 v[212:215], v2, s[8:11], s22 offen offset:3072 sc1
  s_add_u32 s22, s31, 90112
  buffer_load_dwordx4 v[216:219], v2, s[8:11], s22 offen offset:0 sc1
  buffer_load_dwordx4 v[220:223], v2, s[8:11], s22 offen offset:1024 sc1
  buffer_load_dwordx4 v[224:227], v2, s[8:11], s22 offen offset:2048 sc1
  buffer_load_dwordx4 v[228:231], v2, s[8:11], s22 offen offset:3072 sc1
  s_add_u32 s22, s31, 94208
  buffer_load_dwordx4 v[232:235], v2, s[8:11], s22 offen offset:0 sc1
  buffer_load_dwordx4 v[236:239], v2, s[8:11], s22 offen offset:1024 sc1
  buffer_load_dwordx4 v[240:243], v2, s[8:11], s22 offen offset:2048 sc1
  buffer_load_dwordx4 v[244:247], v2, s[8:11], s22 offen offset:3072 sc1
  s_waitcnt vmcnt(24)
  s_add_u32 s22, s31, 98304
  buffer_load_dwordx4 v[248:251], v2, s[8:11], s22 offen offset:0 sc1
  buffer_load_dwordx4 v[252:255], v2, s[8:11], s22 offen offset:1024 sc1
  s_mov_b32 s30, 0
ch_ws6:
  buffer_load_dword v9, off, s[12:15], 0 offset:132 sc1
  s_waitcnt vmcnt(0)
  v_cmp_ne_u32 vcc, 1, v9
  s_cbranch_vccz ch_ws6_ok
  s_sleep 8
  s_add_u32 s30, s30, 1
  s_cmp_lt_u32 s30, 400000
  s_cbranch_scc1 ch_ws6
  s_branch cA_abort
ch_ws6_ok:
  s_lshl_b32 s27, s17, 7
  s_add_u32 s27, s27, 524288
  s_mov_b32 s30, 0
ch_vw2:
  buffer_load_dword v9, off, s[8:11], s27 sc1
  s_waitcnt vmcnt(0)
  v_cmp_ne_u32 vcc, 56, v9
  s_cbranch_vccz ch_vw2_d
  s_sleep 2
  s_add_u32 s30, s30, 1
  s_cmp_lt_u32 s30, 400000
  s_cbranch_scc1 ch_vw2
  s_branch cA_abort
ch_vw2_d:
  s_mov_b32 s28, s35
  s_waitcnt vmcnt(0) lgkmcnt(0)
  s_mov_b32 s31, 0
  s_cmp_lg_u32 s88, 0
  s_cbranch_scc1 cB_va2_loop
  s_branch cA_va2_loop
ch_init7:
  v_mov_b32 v72, v116
  v_mov_b32 v73, v117
  v_lshrrev_b32 v65, 1, v72
  v_and_b32 v66, 1, v72
  v_mov_b32 v36, 0
  v_mov_b32 v37, 0
  v_mov_b32 v38, 0
  v_mov_b32 v39, 0
  v_mov_b32 v40, 0
  v_mov_b32 v41, 0
  v_mov_b32 v42, 0
  v_mov_b32 v43, 0
  v_mov_b32 v44, 0
  v_mov_b32 v45, 0
  v_mov_b32 v46, 0
  v_mov_b32 v47, 0
  v_mov_b32 v48, 0
  v_mov_b32 v49, 0
  v_mov_b32 v50, 0
  v_mov_b32 v51, 0
  v_mov_b32 v52, 0
  v_mov_b32 v53, 0
  v_mov_b32 v54, 0
  v_mov_b32 v55, 0
  v_mov_b32 v56, 0
  v_mov_b32 v57, 0
  v_mov_b32 v58, 0
  v_mov_b32 v59, 0
  v_mov_b32 v60, 0
  v_mov_b32 v61, 0
  v_mov_b32 v62, 0
  v_mov_b32 v63, 0
  v_lshlrev_b32 v75, 2, v65
  v_lshl_add_u32 v75, v66, 3, v75
  v_add_u32 v67, 336, v73
  v_mul_u32_u24 v68, 2341, v67
  v_lshrrev_b32 v68, 16, v68
  v_mul_u32_u24 v69, 28, v68
  v_sub_u32 v69, v67, v69
  v_lshrrev_b32 v70, 4, v69
  v_and_b32 v69, 15, v69
  v_lshlrev_b32 v71, 12, v70
  v_lshl_add_u32 v71, v68, 8, v71
  v_lshl_add_u32 v71, v69, 4, v71
  v_add_u32 v104, v71, v75
  v_add_u32 v67, 352, v73
  v_mul_u32_u24 v68, 2341, v67
  v_lshrrev_b32 v68, 16, v68
  v_mul_u32_u24 v69, 28, v68
  v_sub_u32 v69, v67, v69
  v_lshrrev_b32 v70, 4, v69
  v_and_b32 v69, 15, v69
  v_lshlrev_b32 v71, 12, v70
  v_lshl_add_u32 v71, v68, 8, v71
  v_lshl_add_u32 v71, v69, 4, v71
  v_add_u32 v105, v71, v75
  v_add_u32 v67, 368, v73
  v_mul_u32_u24 v68, 2341, v67
  v_lshrrev_b32 v68, 16, v68
  v_mul_u32_u24 v69, 28, v68
  v_sub_u32 v69, v67, v69
  v_lshrrev_b32 v70, 4, v69
  v_and_b32 v69, 15, v69
  v_lshlrev_b32 v71, 12, v70
  v_lshl_add_u32 v71, v68, 8, v71
  v_lshl_add_u32 v71, v69, 4, v71
  v_add_u32 v106, v71, v75
  v_add_u32 v67, 384, v73
  v_mul_u32_u24 v68, 2341, v67
  v_lshrrev_b32 v68, 16, v68
  v_mul_u32_u24 v69, 28, v68
  v_sub_u32 v69, v67, v69
  v_lshrrev_b32 v70, 4, v69
  v_and_b32 v69, 15, v69
  v_lshlrev_b32 v71, 12, v70
  v_lshl_add_u32 v71, v68, 8, v71
  v_lshl_add_u32 v71, v69, 4, v71
  v_add_u32 v107, v71, v75
  v_add_u32 v67, 400, v73
  v_mul_u32_u24 v68, 2341, v67
  v_lshrrev_b32 v68, 16, v68
  v_mul_u32_u24 v69, 28, v68
  v_sub_u32 v69, v67, v69
  v_lshrrev_b32 v70, 4, v69
  v_and_b32 v69, 15, v69
  v_lshlrev_b32 v71, 12, v70
  v_lshl_add_u32 v71, v68, 8, v71
  v_lshl_add_u32 v71, v69, 4, v71
  v_add_u32 v108, v71, v75
  v_add_u32 v67, 416, v73
  v_mul_u32_u24 v68, 2341, v67
  v_lshrrev_b32 v68, 16, v68
  v_mul_u32_u24 v69, 28, v68
  v_sub_u32 v69, v67, v69
  v_lshrrev_b32 v70, 4, v69
  v_and_b32 v69, 15, v69
  v_lshlrev_b32 v71, 12, v70
  v_lshl_add_u32 v71, v68, 8, v71
  v_lshl_add_u32 v71, v69, 4, v71
  v_add_u32 v109, v71, v75
  v_add_u32 v67, 432, v73
  v_mul_u32_u24 v68, 2341, v67
  v_lshrrev_b32 v68, 16, v68
  v_mul_u32_u24 v69, 28, v68
  v_sub_u32 v69, v67, v69
  v_lshrrev_b32 v70, 4, v69
  v_and_b32 v69, 15, v69
  v_lshlrev_b32 v71, 12, v70
  v_lshl_add_u32 v71, v68, 8, v71
  v_lshl_add_u32 v71, v69, 4, v71
  v_add_u32 v110, v71, v75
  v_mov_b32 v74, 0x40000000
  v_mov_b32 v96, 0
  v_and_b32 v119, 15, v1
  s_and_b32 s22, s17, 0
  s_lshl_b32 s22, s22, 7
  s_add_u32 s22, s22, 39424
  v_lshl_add_u32 v119, v119, 2, s22
  s_lshl_b32 s22, s17, 2
  s_add_u32 s22, s22, 37376
  v_lshl_add_u32 v118, v1, 7, s22
  v_cmp_gt_u32 vcc, 1, v1
  s_nop 1
  v_cndmask_b32 v118, v74, v118, vcc
  s_lshl_b32 s35, s17, 7
  s_add_u32 s35, s35, 524288
  v_mov_b32 v64, 0
  v_mov_b32 v65, 0
  v_mov_b32 v66, 0
  v_mov_b32 v67, 0
  v_min_u32 v116, 13, v1
  s_mul_i32 s22, s17, 14
  v_add_u32 v116, s22, v116
  v_lshlrev_b32 v116, 7, v116
  s_mul_i32 s31, s17, 401408
  s_add_u32 s31, s31, 40278016
  s_mov_b32 s30, 0
ch_wr7:
  buffer_load_dword v9, off, s[12:15], 0 offset:128 sc1
  s_waitcnt vmcnt(0)
  v_cmp_ne_u32 vcc, 1, v9
  s_cbranch_vccz ch_wr7_ok
  s_sleep 8
  s_add_u32 s30, s30, 1
  s_cmp_lt_u32 s30, 400000
  s_cbranch_scc1 ch_wr7
  s_branch cA_abort
ch_wr7_ok:
  s_lshr_b32 s22, s17, 2
  s_lshl_b32 s28, 0x81, s22
  s_mul_i32 s27, s17, 12
  s_add_u32 s22, s27, 256
  s_lshr_b32 s22, s22, 6
  s_lshl_b32 s22, 0x81, s22
  s_or_b32 s28, s28, s22
  s_add_u32 s22, s27, 267
  s_lshr_b32 s22, s22, 6
  s_lshl_b32 s22, 0x81, s22
  s_or_b32 s28, s28, s22
  v_lshrrev_b32 v12, 8, v2
  v_lshlrev_b32 v12, 7, v12
  s_mov_b32 s27, 583680
  s_mov_b32 s30, 0
ch_ww7:
  buffer_load_dword v9, v12, s[8:11], s27 offen sc1
  s_waitcnt vmcnt(0)
  v_and_b32 v10, s28, v9
  v_cmp_ne_u32 vcc, s28, v10
  s_cbranch_vccz ch_ww7_ok
  s_sleep 3
  s_add_u32 s30, s30, 1
  s_cmp_lt_u32 s30, 400000
  s_cbranch_scc1 ch_ww7
  s_branch cA_abort
ch_ww7_ok:
  s_add_u32 s22, s31, 0
  buffer_load_dwordx4 a[0:3], v2, s[8:11], s22 offen offset:0 sc1
  buffer_load_dwordx4 a[4:7], v2, s[8:11], s22 offen offset:1024 sc1
  buffer_load_dwordx4 a[8:11], v2, s[8:11], s22 offen offset:2048 sc1
  buffer_load_dwordx4 a[12:15], v2, s[8:11], s22 offen offset:3072 sc1
  s_add_u32 s22, s31, 4096
  buffer_load_dwordx4 a[16:19], v2, s[8:11], s22 offen offset:0 sc1
  buffer_load_dwordx4 a[20:23], v2, s[8:11], s22 offen offset:1024 sc1
  buffer_load_dwordx4 a[24:27], v2, s[8:11], s22 offen offset:2048 sc1
  buffer_load_dwordx4 a[28:31], v2, s[8:11], s22 offen offset:3072 sc1
  s_add_u32 s22, s31, 8192
  buffer_load_dwordx4 a[32:35], v2, s[8:11], s22 offen offset:0 sc1
  buffer_load_dwordx4 a[36:39], v2, s[8:11], s22 offen offset:1024 sc1
  buffer_load_dwordx4 a[40:43], v2, s[8:11], s22 offen offset:2048 sc1
  buffer_load_dwordx4 a[44:47], v2, s[8:11], s22 offen offset:3072 sc1
  s_add_u32 s22, s31, 12288
  buffer_load_dwordx4 a[48:51], v2, s[8:11], s22 offen offset:0 sc1
  buffer_load_dwordx4 a[52:55], v2, s[8:11], s22 offen offset:1024 sc1
  buffer_load_dwordx4 a[56:59], v2, s[8:11], s22 offen offset:2048 sc1
  buffer_load_dwordx4 a[60:63], v2, s[8:11], s22 offen offset:3072 sc1
  s_add_u32 s22, s31, 16384
  buffer_load_dwordx4 a[64:67], v2, s[8:11], s22 offen offset:0 sc1
  buffer_load_dwordx4 a[68:71], v2, s[8:11], s22 offen offset:1024 sc1
  buffer_load_dwordx4 a[72:75], v2, s[8:11], s22 offen offset:2048 sc1
  buffer_load_dwordx4 a[76:79], v2, s[8:11], s22 offen offset:3072 sc1
  s_add_u32 s22, s31, 20480
  buffer_load_dwordx4 a[80:83], v2, s[8:11], s22 offen offset:0 sc1
  buffer_load_dwordx4 a[84:87], v2, s[8:11], s22 offen offset:1024 sc1
  buffer_load_dwordx4 a[88:91], v2, s[8:11], s22 offen offset:2048 sc1
  buffer_load_dwordx4 a[92:95], v2, s[8:11], s22 offen offset:3072 sc1
  s_add_u32 s22, s31, 24576
  buffer_load_dwordx4 a[96:99], v2, s[8:11], s22 offen offset:0 sc1
  buffer_load_dwordx4 a[100:103], v2, s[8:11], s22 offen offset:1024 sc1
  buffer_load_dwordx4 a[104:107], v2, s[8:11], s22 offen offset:2048 sc1
  buffer_load_dwordx4 a[108:111], v2, s[8:11], s22 offen offset:3072 sc1
  s_add_u32 s22, s31, 28672
  buffer_load_dwordx4 a[112:115], v2, s[8:11], s22 offen offset:0 sc1
  buffer_load_dwordx4 a[116:119], v2, s[8:11], s22 offen offset:1024 sc1
  buffer_load_dwordx4 a[120:123], v2, s[8:11], s22 offen offset:2048 sc1
  buffer_load_dwordx4 a[124:127], v2, s[8:11], s22 offen offset:3072 sc1
  s_waitcnt vmcnt(24)
  s_add_u32 s22, s31, 32768
  buffer_load_dwordx4 a[128:131], v2, s[8:11], s22 offen offset:0 sc1
  buffer_load_dwordx4 a[132:135], v2, s[8:11], s22 offen offset:1024 sc1
  buffer_load_dwordx4 a[136:139], v2, s[8:11], s22 offen offset:2048 sc1
  buffer_load_dwordx4 a[140:143], v2, s[8:11], s22 offen offset:3072 sc1
  s_add_u32 s22, s31, 36864
  buffer_load_dwordx4 a[144:147], v2, s[8:11], s22 offen offset:0 sc1
  buffer_load_dwordx4 a[148:151], v2, s[8:11], s22 offen offset:1024 sc1
  buffer_load_dwordx4 a[152:155], v2, s[8:11], s22 offen offset:2048 sc1
  buffer_load_dwordx4 a[156:159], v2, s[8:11], s22 offen offset:3072 sc1
  s_add_u32 s22, s31, 40960
  buffer_load_dwordx4 a[160:163], v2, s[8:11], s22 offen offset:0 sc1
  buffer_load_dwordx4 a[164:167], v2, s[8:11], s22 offen offset:1024 sc1
  buffer_load_dwordx4 a[168:171], v2, s[8:11], s22 offen offset:2048 sc1
  buffer_load_dwordx4 a[172:175], v2, s[8:11], s22 offen offset:3072 sc1
  s_add_u32 s22, s31, 45056
  buffer_load_dwordx4 a[176:179], v2, s[8:11], s22 offen offset:0 sc1
  buffer_load_dwordx4 a[180:183], v2, s[8:11], s22 offen offset:1024 sc1
  buffer_load_dwordx4 a[184:187], v2, s[8:11], s22 offen offset:2048 sc1
  buffer_load_dwordx4 a[188:191], v2, s[8:11], s22 offen offset:3072 sc1
  s_add_u32 s22, s31, 49152
  buffer_load_dwordx4 a[192:195], v2, s[8:11], s22 offen offset:0 sc1
  buffer_load_dwordx4 a[196:199], v2, s[8:11], s22 offen offset:1024 sc1
  buffer_load_dwordx4 a[200:203], v2, s[8:11], s22 offen offset:2048 sc1
  buffer_load_dwordx4 a[204:207], v2, s[8:11], s22 offen offset:3072 sc1
  s_add_u32 s22, s31, 53248
  buffer_load_dwordx4 a[208:211], v2, s[8:11], s22 offen offset:0 sc1
  buffer_load_dwordx4 a[212:215], v2, s[8:11], s22 offen offset:1024 sc1
  buffer_load_dwordx4 a[216:219], v2, s[8:11], s22 offen offset:2048 sc1
  buffer_load_dwordx4 a[220:223], v2, s[8:11], s22 offen offset:3072 sc1
  s_add_u32 s22, s31, 57344
  buffer_load_dwordx4 a[224:227], v2, s[8:11], s22 offen offset:0 sc1
  buffer_load_dwordx4 a[228:231], v2, s[8:11], s22 offen offset:1024 sc1
  buffer_load_dwordx4 a[232:235], v2, s[8:11], s22 offen offset:2048 sc1
  buffer_load_dwordx4 a[236:239], v2, s[8:11], s22 offen offset:3072 sc1
  s_add_u32 s22, s31, 61440
  buffer_load_dwordx4 a[240:243], v2, s[8:11], s22 offen offset:0 sc1
  buffer_load_dwordx4 a[244:247], v2, s[8:11], s22 offen offset:1024 sc1
  buffer_load_dwordx4 a[248:251], v2, s[8:11], s22 offen offset:2048 sc1
  buffer_load_dwordx4 a[252:255], v2, s[8:11], s22 offen offset:3072 sc1
  s_waitcnt vmcnt(24)
  s_add_u32 s22, s31, 65536
  buffer_load_dwordx4 v[120:123], v2, s[8:11], s22 offen offset:0 sc1
  buffer_load_dwordx4 v[124:127], v2, s[8:11], s22 offen offset:1024 sc1
  buffer_load_dwordx4 v[128:131], v2, s[8:11], s22 offen offset:2048 sc1
  buffer_load_dwordx4 v[132:135], v2, s[8:11], s22 offen offset:3072 sc1
  s_add_u32 s22, s31, 69632
  buffer_load_dwordx4 v[136:139], v2, s[8:11], s22 offen offset:0 sc1
  buffer_load_dwordx4 v[140:143], v2, s[8:11], s22 offen offset:1024 sc1
  buffer_load_dwordx4 v[144:147], v2, s[8:11], s22 offen offset:2048 sc1
  buffer_load_dwordx4 v[148:151], v2, s[8:11], s22 offen offset:3072 sc1
  s_add_u32 s22, s31, 73728
  buffer_load_dwordx4 v[152:155], v2, s[8:11], s22 offen offset:0 sc1
  buffer_load_dwordx4 v[156:159], v2, s[8:11], s22 offen offset:1024 sc1
  buffer_load_dwordx4 v[160:163], v2, s[8:11], s22 offen offset:2048 sc1
  buffer_load_dwordx4 v[164:167], v2, s[8:11], s22 offen offset:3072 sc1
  s_add_u32 s22, s31, 77824
  buffer_load_dwordx4 v[168:171], v2, s[8:11], s22 offen offset:0 sc1
  buffer_load_dwordx4 v[172:175], v2, s[8:11], s22 offen offset:1024 sc1
  buffer_load_dwordx4 v[176:179], v2, s[8:11], s22 offen offset:2048 sc1
  buffer_load_dwordx4 v[180:183], v2, s[8:11], s22 offen offset:3072 sc1
  s_add_u32 s22, s31, 81920
  buffer_load_dwordx4 v[184:187], v2, s[8:11], s22 offen offset:0 sc1
  buffer_load_dwordx4 v[188:191], v2, s[8:11], s22 offen offset:1024 sc1
  buffer_load_dwordx4 v[192:195], v2, s[8:11], s22 offen offset:2048 sc1
  buffer_load_dwordx4 v[196:199], v2, s[8:11], s22 offen offset:3072 sc1
  s_add_u32 s22, s31, 86016
  buffer_load_dwordx4 v[200:203], v2, s[8:11], s22 offen offset:0 sc1
  buffer_load_dwordx4 v[204:207], v2, s[8:11], s22 offen offset:1024 sc1
  buffer_load_dwordx4 v[208:211], v2, s[8:11], s22 offen offset:2048 sc1
  buffer_load_dwordx4 v[212:215], v2, s[8:11], s22 offen offset:3072 sc1
  s_add_u32 s22, s31, 90112
  buffer_load_dwordx4 v[216:219], v2, s[8:11], s22 offen offset:0 sc1
  buffer_load_dwordx4 v[220:223], v2, s[8:11], s22 offen offset:1024 sc1
  buffer_load_dwordx4 v[224:227], v2, s[8:11], s22 offen offset:2048 sc1
  buffer_load_dwordx4 v[228:231], v2, s[8:11], s22 offen offset:3072 sc1
  s_add_u32 s22, s31, 94208
  buffer_load_dwordx4 v[232:235], v2, s[8:11], s22 offen offset:0 sc1
  buffer_load_dwordx4 v[236:239], v2, s[8:11], s22 offen offset:1024 sc1
  buffer_load_dwordx4 v[240:243], v2, s[8:11], s22 offen offset:2048 sc1
  buffer_load_dwordx4 v[244:247], v2, s[8:11], s22 offen offset:3072 sc1
  s_waitcnt vmcnt(24)
  s_add_u32 s22, s31, 98304
  buffer_load_dwordx4 v[248:251], v2, s[8:11], s22 offen offset:0 sc1
  buffer_load_dwordx4 v[252:255], v2, s[8:11], s22 offen offset:1024 sc1
  s_mov_b32 s30, 0
ch_ws7:
  buffer_load_dword v9, off, s[12:15], 0 offset:132 sc1
  s_waitcnt vmcnt(0)
  v_cmp_ne_u32 vcc, 1, v9
  s_cbranch_vccz ch_ws7_ok
  s_sleep 8
  s_add_u32 s30, s30, 1
  s_cmp_lt_u32 s30, 400000
  s_cbranch_scc1 ch_ws7
  s_branch cA_abort
ch_ws7_ok:
  s_lshl_b32 s27, s17, 7
  s_add_u32 s27, s27, 524288
  s_mov_b32 s30, 0
ch_vw3:
  buffer_load_dword v9, off, s[8:11], s27 sc1
  s_waitcnt vmcnt(0)
  v_cmp_ne_u32 vcc, 56, v9
  s_cbranch_vccz ch_vw3_d
  s_sleep 2
  s_add_u32 s30, s30, 1
  s_cmp_lt_u32 s30, 400000
  s_cbranch_scc1 ch_vw3
  s_branch cA_abort
ch_vw3_d:
  s_mov_b32 s28, s35
  s_mov_b32 s39, 684032
  buffer_load_dword v100, v116, s[8:11], s39 offen sc1
  s_mov_b32 s39, 712704
  s_waitcnt vmcnt(1) lgkmcnt(0)
  s_mov_b32 s31, 0
  s_cmp_lg_u32 s88, 0
  s_cbranch_scc1 cB_va3_loop
  s_branch cA_va3_loop
.p2align 6
cA_sc0_loop:
  s_mov_b32 s30, 0
  s_mov_b32 s62, 0
  s_setprio 3
  s_sleep 6
cA_sc0_fp_l:
  v_cmp_gt_u32 vcc, s19, v112
  buffer_load_dword v112, v0, s[8:11], 0 offen sc1
  s_cbranch_vccz cA_sc0_fp_d
  v_cmp_gt_u32 vcc, s19, v112
  buffer_load_dword v112, v0, s[8:11], 0 offen sc1
  s_cbranch_vccz cA_sc0_fp_d
  v_cmp_gt_u32 vcc, s19, v112
  buffer_load_dword v112, v0, s[8:11], 0 offen sc1
  s_cbranch_vccz cA_sc0_fp_d
  v_cmp_gt_u32 vcc, s19, v112
  buffer_load_dword v112, v0, s[8:11], 0 offen sc1
  s_cbranch_vccz cA_sc0_fp_d
  v_cmp_gt_u32 vcc, s19, v112
  buffer_load_dword v112, v0, s[8:11], 0 offen sc1
  s_cbranch_vccz cA_sc0_fp_d
  v_cmp_gt_u32 vcc, s19, v112
  buffer_load_dword v112, v0, s[8:11], 0 offen sc1
  s_cbranch_vccz cA_sc0_fp_d
  v_cmp_gt_u32 vcc, s19, v112
  buffer_load_dword v112, v0, s[8:11], 0 offen sc1
  s_cbranch_vccz cA_sc0_fp_d
  v_cmp_gt_u32 vcc, s19, v112
  buffer_load_dword v112, v0, s[8:11], 0 offen sc1
  s_cbranch_vccz cA_sc0_fp_d
  v_cmp_gt_u32 vcc, s19, v112
  buffer_load_dword v112, v0, s[8:11], 0 offen sc1
  s_cbranch_vccz cA_sc0_fp_d
  v_cmp_gt_u32 vcc, s19, v112
  buffer_load_dword v112, v0, s[8:11], 0 offen sc1
  s_cbranch_vccz cA_sc0_fp_d
  v_cmp_gt_u32 vcc, s19, v112
  buffer_load_dword v112, v0, s[8:11], 0 offen sc1
  s_cbranch_vccz cA_sc0_fp_d
  v_cmp_gt_u32 vcc, s19, v112
  buffer_load_dword v112, v0, s[8:11], 0 offen sc1
  s_cbranch_vccz cA_sc0_fp_d
  v_cmp_gt_u32 vcc, s19, v112
  buffer_load_dword v112, v0, s[8:11], 0 offen sc1
  s_cbranch_vccz cA_sc0_fp_d
  v_cmp_gt_u32 vcc, s19, v112
  buffer_load_dword v112, v0, s[8:11], 0 offen sc1
  s_cbranch_vccz cA_sc0_fp_d
  v_cmp_gt_u32 vcc, s19, v112
  buffer_load_dword v112, v0, s[8:11], 0 offen sc1
  s_cbranch_vccz cA_sc0_fp_d
  v_cmp_gt_u32 vcc, s19, v112
  buffer_load_dword v112, v0, s[8:11], 0 offen sc1
  s_cbranch_vccz cA_sc0_fp_d
  s_waitcnt vmcnt(24)
  s_add_u32 s30, s30, 1
  s_cmp_lt_u32 s30, 400000
  s_cbranch_scc1 cA_sc0_fp_l
  s_branch cA_abort
cA_sc0_fp_d:
  buffer_load_dwordx4 v[8:11], v2, s[8:11], s20 offen offset:0 sc1
  s_barrier
  s_setprio 2
  buffer_load_dwordx4 v[12:15], v2, s[8:11], s20 offen offset:1024 sc1
  s_setprio 1
  buffer_load_dwordx4 v[16:19], v2, s[8:11], s20 offen offset:2048 sc1
  s_setprio 0
  buffer_load_dwordx4 v[20:23], v2, s[8:11], s20 offen offset:3072 sc1
cA_sc0_go:
  s_waitcnt vmcnt(3)
  v_smfmac_f32_16x16x64_bf16 v[36:39], v[8:11], a[0:7], v3
  buffer_load_dwordx4 v[32:35], v2, s[8:11], s23 offen offset:0 sc1
  v_cmp_eq_u32 vcc, -1, v8
  v_smfmac_f32_16x16x64_bf16 v[40:43], v[8:11], a[56:63], v3
  v_smfmac_f32_16x16x64_bf16 v[44:47], v[8:11], a[112:119], v3
  buffer_load_dwordx4 v[24:27], v2, s[8:11], s23 offen offset:1024 sc1
  s_cbranch_vccnz cA_sc0_r0
  v_smfmac_f32_16x16x64_bf16 v[48:51], v[8:11], a[168:175], v3
  v_smfmac_f32_16x16x64_bf16 v[52:55], v[8:11], a[224:231], v3
  s_waitcnt vmcnt(4)
  v_cmp_eq_u32 vcc, -1, v12
  v_smfmac_f32_16x16x64_bf16 v[56:59], v[8:11], v[144:151], v3
  buffer_load_dwordx4 v[28:31], v2, s[8:11], s23 offen offset:2048 sc1
  v_smfmac_f32_16x16x64_bf16 v[60:63], v[8:11], v[200:207], v3
  s_cbranch_vccnz cA_sc0_r1
cA_sc0_c1:
  v_smfmac_f32_16x16x64_bf16 v[36:39], v[12:15], a[8:15], v3
  v_smfmac_f32_16x16x64_bf16 v[40:43], v[12:15], a[64:71], v3
  v_smfmac_f32_16x16x64_bf16 v[44:47], v[12:15], a[120:127], v3
  v_smfmac_f32_16x16x64_bf16 v[48:51], v[12:15], a[176:183], v3
  v_smfmac_f32_16x16x64_bf16 v[52:55], v[12:15], a[232:239], v3
  s_waitcnt vmcnt(4)
  v_cmp_eq_u32 vcc, -1, v16
  v_smfmac_f32_16x16x64_bf16 v[56:59], v[12:15], v[152:159], v3
  buffer_load_dwordx4 v[88:91], v117, s[8:11], s26 offen offset:0 sc1
  v_smfmac_f32_16x16x64_bf16 v[60:63], v[12:15], v[208:215], v3
  s_cbranch_vccnz cA_sc0_r2
cA_sc0_c2:
  v_smfmac_f32_16x16x64_bf16 v[36:39], v[16:19], a[16:23], v3
  v_smfmac_f32_16x16x64_bf16 v[40:43], v[16:19], a[72:79], v3
  v_smfmac_f32_16x16x64_bf16 v[44:47], v[16:19], a[128:135], v3
  buffer_load_dwordx4 v[92:95], v117, s[8:11], s26 offen offset:1024 sc1
  v_smfmac_f32_16x16x64_bf16 v[48:51], v[16:19], a[184:191], v3
  v_smfmac_f32_16x16x64_bf16 v[52:55], v[16:19], a[240:247], v3
  s_waitcnt vmcnt(5)
  v_cmp_eq_u32 vcc, -1, v20
  v_smfmac_f32_16x16x64_bf16 v[56:59], v[16:19], v[160:167], v3
  v_smfmac_f32_16x16x64_bf16 v[60:63], v[16:19], v[216:223], v3
  buffer_load_dwordx4 v[96:99], v2, s[8:11], s24 offen offset:0 sc1
  s_cbranch_vccnz cA_sc0_r3
cA_sc0_c3:
  v_smfmac_f32_16x16x64_bf16 v[36:39], v[20:23], a[24:31], v3
  v_smfmac_f32_16x16x64_bf16 v[40:43], v[20:23], a[80:87], v3
  s_waitcnt vmcnt(3)
  v_max3_u32 v66, v24, v27, v28
  v_smfmac_f32_16x16x64_bf16 v[44:47], v[20:23], a[136:143], v3
  v_max3_u32 v66, v66, v31, v32
  v_smfmac_f32_16x16x64_bf16 v[48:51], v[20:23], a[192:199], v3
  buffer_load_dwordx4 v[100:103], v2, s[8:11], s24 offen offset:1024 sc1
  v_max_u32 v66, v66, v35
  v_smfmac_f32_16x16x64_bf16 v[52:55], v[20:23], a[248:255], v3
  v_cmp_eq_u32 vcc, -1, v66
  v_smfmac_f32_16x16x64_bf16 v[56:59], v[20:23], v[168:175], v3
  v_smfmac_f32_16x16x64_bf16 v[60:63], v[20:23], v[224:231], v3
  s_cbranch_vccnz cA_sc0_r4
cA_sc0_c4:
  v_smfmac_f32_16x16x64_bf16 v[60:63], v[32:35], v[232:239], v3
  buffer_load_dwordx4 v[104:107], v2, s[8:11], s26 offen offset:0 sc1
  v_smfmac_f32_16x16x64_bf16 v[60:63], v[24:27], v[240:247], v3
  v_smfmac_f32_16x16x64_bf16 v[60:63], v[28:31], v[248:255], v3
  v_smfmac_f32_16x16x64_bf16 v[52:55], v[32:35], v[120:127], v3
  v_smfmac_f32_16x16x64_bf16 v[52:55], v[24:27], v[128:135], v3
  buffer_load_dwordx4 v[108:111], v2, s[8:11], s26 offen offset:1024 sc1
  v_smfmac_f32_16x16x64_bf16 v[52:55], v[28:31], v[136:143], v3
  v_cvt_pk_bf16_f32 v63, v62, v63
  v_smfmac_f32_16x16x64_bf16 v[56:59], v[32:35], v[176:183], v3
  v_cvt_pk_bf16_f32 v62, v60, v61
  v_smfmac_f32_16x16x64_bf16 v[56:59], v[24:27], v[184:191], v3
  v_mfma_f32_16x16x32_bf16 v[12:15], v[62:65], v[4:7], 0
  v_cvt_pk_bf16_f32 v55, v54, v55
  v_smfmac_f32_16x16x64_bf16 v[56:59], v[28:31], v[192:199], v3
  v_cvt_pk_bf16_f32 v54, v52, v53
  v_smfmac_f32_16x16x64_bf16 v[36:39], v[32:35], a[32:39], v3
  s_nop 1
  v_cvt_pk_bf16_f32 v76, v12, v13
  v_smfmac_f32_16x16x64_bf16 v[36:39], v[24:27], a[40:47], v3
  v_cvt_pk_bf16_f32 v77, v14, v15
  v_smfmac_f32_16x16x64_bf16 v[36:39], v[28:31], a[48:55], v3
  v_cvt_pk_bf16_f32 v56, v56, v57
  v_smfmac_f32_16x16x64_bf16 v[40:43], v[32:35], a[88:95], v3
  v_cvt_pk_bf16_f32 v57, v58, v59
  v_smfmac_f32_16x16x64_bf16 v[40:43], v[24:27], a[96:103], v3
  v_mfma_f32_16x16x32_bf16 v[16:19], v[54:57], v[4:7], 0
  v_cvt_pk_bf16_f32 v39, v38, v39
  v_smfmac_f32_16x16x64_bf16 v[40:43], v[28:31], a[104:111], v3
  v_cvt_pk_bf16_f32 v38, v36, v37
  v_smfmac_f32_16x16x64_bf16 v[44:47], v[32:35], a[144:151], v3
  s_nop 1
  v_cvt_pk_bf16_f32 v78, v16, v17
  v_smfmac_f32_16x16x64_bf16 v[44:47], v[24:27], a[152:159], v3
  v_cvt_pk_bf16_f32 v79, v18, v19
  v_smfmac_f32_16x16x64_bf16 v[44:47], v[28:31], a[160:167], v3
  v_cvt_pk_bf16_f32 v40, v40, v41
  v_smfmac_f32_16x16x64_bf16 v[48:51], v[32:35], a[200:207], v3
  v_cvt_pk_bf16_f32 v41, v42, v43
  v_smfmac_f32_16x16x64_bf16 v[48:51], v[24:27], a[208:215], v3
  v_smfmac_f32_16x16x64_bf16 v[48:51], v[28:31], a[216:223], v3
  s_waitcnt vmcnt(4)
  v_cvt_pk_bf16_f32 v47, v46, v47
  v_smfmac_f32_16x16x64_bf16 v[68:71], v[76:79], v[80:87], v3
  v_cvt_pk_bf16_f32 v46, v44, v45
  v_mfma_f32_16x16x32_bf16 v[12:15], v[38:41], v[4:7], 0
  s_nop 1
  v_cvt_pk_bf16_f32 v48, v48, v49
  v_cvt_pk_bf16_f32 v49, v50, v51
  s_nop 1
  v_mfma_f32_16x16x32_bf16 v[16:19], v[46:49], v[4:7], 0
  v_smfmac_f32_16x16x64_bf16 v[72:75], v[76:79], v[88:95], v3
  v_cvt_pk_bf16_f32 v20, v12, v13
  v_mfma_f32_16x16x32_bf16 v[52:55], v[30:33], v[76:79], 0
  s_waitcnt vmcnt(0)
  v_cvt_pk_bf16_f32 v21, v14, v15
  v_cvt_pk_bf16_f32 v22, v16, v17
  v_cvt_pk_bf16_f32 v23, v18, v19
  s_nop 1
  v_mfma_f32_16x16x32_bf16 v[52:55], v[8:11], v[20:23], v[52:55]
  v_smfmac_f32_16x16x64_bf16 v[68:71], v[20:23], v[96:103], v3
  v_smfmac_f32_16x16x64_bf16 v[72:75], v[20:23], v[104:111], v3
  s_nop 1
  ds_write_b128 v113, v[52:55]
  s_nop 1
  v_permlane32_swap_b32 v68, v70
  v_permlane32_swap_b32 v69, v71
  v_add_f32 v56, v68, v70
  v_add_f32 v58, v69, v71
  v_permlane32_swap_b32 v72, v74
  v_permlane32_swap_b32 v73, v75
  v_add_f32 v57, v72, v74
  v_add_f32 v59, v73, v75
  ds_write_b128 v2, v[56:59] offset:0
  v_cmp_u_f32 vcc, v57, v59
  v_mov_b32 v68, 0
  v_mov_b32 v69, 0
  v_mov_b32 v70, 0
  v_mov_b32 v71, 0
  s_cbranch_vccnz cA_sc0_retry
cA_sc0_cont:
  s_add_u32 s24, s24, 28672
  s_add_u32 s26, s26, 28672
  buffer_load_dwordx4 v[80:83], v117, s[8:11], s24 offen offset:0 sc1
  buffer_load_dwordx4 v[84:87], v117, s[8:11], s24 offen offset:1024 sc1
  v_mov_b32 v72, 0
  v_mov_b32 v73, 0
  v_mfma_f32_32x32x16_bf16 v[36:51], v[68:71], v[68:71], 0
  s_waitcnt lgkmcnt(0)
  s_barrier
  ds_read_b64 v[8:9], v114 offset:0
  ds_read_b64 v[10:11], v114 offset:1024
  ds_read_b64 v[12:13], v114 offset:2048
  ds_read_b64 v[14:15], v114 offset:3072
  ds_read2_b32 v[16:17], v115 offset0:0 offset1:64
  ds_read2_b32 v[18:19], v115 offset0:128 offset1:192
  v_mfma_f32_32x32x16_bf16 v[52:67], v[68:71], v[68:71], 0
  s_waitcnt lgkmcnt(0)
  v_pk_add_f32 v[16:17], v[16:17], v[18:19]
  v_pk_add_f32 v[8:9], v[8:9], v[10:11]
  v_pk_add_f32 v[12:13], v[12:13], v[14:15]
  v_add_f32 v20, v16, v17
  v_pk_add_f32 v[8:9], v[8:9], v[12:13]
  v_max_f32 v22, v8, v9
  v_add_f32_dpp v20, v20, v20 row_ror:8 row_mask:0xf bank_mask:0xf
  s_nop 0
  v_max_f32_dpp v22, v22, v22 row_ror:8 row_mask:0xf bank_mask:0xf
  v_max_f32 v22, v22, v20
  s_nop 1
  v_max_f32_dpp v22, v22, v22 quad_perm:[1,0,3,2] row_mask:0xf bank_mask:0xf
  s_nop 1
  v_max_f32_dpp v22, v22, v22 quad_perm:[2,3,0,1] row_mask:0xf bank_mask:0xf
  s_nop 1
  v_max_f32_dpp v22, v22, v22 row_half_mirror row_mask:0xf bank_mask:0xf
  v_pk_add_f32 v[8:9], v[8:9], v[22:23] op_sel_hi:[1,0] neg_lo:[0,1] neg_hi:[0,1]
  v_sub_f32 v20, v20, v22
  v_exp_f32 v8, v8
  v_exp_f32 v9, v9
  v_exp_f32 v20, v20
  v_add_f32 v24, v8, v9
  v_fmac_f32 v24, 0.5, v20
  v_mov_b32_dpp v21, v20 quad_perm:[1,0,3,2] row_mask:0xf bank_mask:0xf
  s_nop 0
  v_add_f32_dpp v24, v24, v24 quad_perm:[1,0,3,2] row_mask:0xf bank_mask:0xf
  s_nop 1
  v_add_f32_dpp v24, v24, v24 quad_perm:[2,3,0,1] row_mask:0xf bank_mask:0xf
  s_nop 1
  v_add_f32_dpp v24, v24, v24 row_half_mirror row_mask:0xf bank_mask:0xf
  s_nop 1
  v_add_f32_dpp v24, v24, v24 row_ror:8 row_mask:0xf bank_mask:0xf
  v_rcp_f32 v24, v24
  s_nop 0
  v_pk_mul_f32 v[8:9], v[8:9], v[24:25] op_sel_hi:[1,0]
  v_cvt_pk_bf16_f32 v8, abs(v8), abs(v9)
  buffer_store_dword v8, v1, s[8:11], s20 offen
  v_pk_mul_f32 v[20:21], v[20:21], v[24:25] op_sel_hi:[1,0]
  v_cvt_pk_bf16_f32 v20, abs(v20), abs(v21)
  buffer_store_dword v20, v118, s[8:11], s20 offen
  v_mov_b32 v74, 0
  v_mov_b32 v75, 0
  s_mov_b32 s19, s18
  s_add_u32 s18, s18, 1
  s_mov_b32 s22, s20
  s_mov_b32 s20, s21
  s_mov_b32 s21, s22
  s_add_u32 s23, s20, 4096
  s_cmp_lt_u32 s19, 63
  s_cbranch_scc1 cA_sc0_loop
  s_branch cA_done
cA_sc0_r0:
  s_add_u32 s31, s31, 1
  buffer_load_dwordx4 v[8:11], v2, s[8:11], s20 offen offset:0 sc1
  s_waitcnt vmcnt(0)
  v_cmp_eq_u32 vcc, -1, v8
  v_mov_b32 v36, 0
  v_mov_b32 v37, 0
  v_mov_b32 v38, 0
  v_mov_b32 v39, 0
  v_mov_b32 v40, 0
  v_mov_b32 v41, 0
  v_mov_b32 v42, 0
  v_mov_b32 v43, 0
  v_mov_b32 v44, 0
  v_mov_b32 v45, 0
  v_mov_b32 v46, 0
  v_mov_b32 v47, 0
  v_mov_b32 v48, 0
  v_mov_b32 v49, 0
  v_mov_b32 v50, 0
  v_mov_b32 v51, 0
  s_nop 1
  s_cbranch_vccz cA_sc0_go
  s_add_u32 s30, s30, 1
  s_cmp_lt_u32 s30, 400000
  s_cbranch_scc1 cA_sc0_r0
  s_branch cA_abort
cA_sc0_r1:
  s_add_u32 s31, s31, 1
  buffer_load_dwordx4 v[12:15], v2, s[8:11], s20 offen offset:1024 sc1
  s_waitcnt vmcnt(0)
  v_cmp_eq_u32 vcc, -1, v12
  s_nop 4
  s_cbranch_vccz cA_sc0_c1
  s_add_u32 s30, s30, 1
  s_cmp_lt_u32 s30, 400000
  s_cbranch_scc1 cA_sc0_r1
  s_branch cA_abort
cA_sc0_r2:
  s_add_u32 s31, s31, 1
  buffer_load_dwordx4 v[16:19], v2, s[8:11], s20 offen offset:2048 sc1
  s_waitcnt vmcnt(0)
  v_cmp_eq_u32 vcc, -1, v16
  s_nop 4
  s_cbranch_vccz cA_sc0_c2
  s_add_u32 s30, s30, 1
  s_cmp_lt_u32 s30, 400000
  s_cbranch_scc1 cA_sc0_r2
  s_branch cA_abort
cA_sc0_r3:
  s_add_u32 s31, s31, 1
  buffer_load_dwordx4 v[20:23], v2, s[8:11], s20 offen offset:3072 sc1
  s_waitcnt vmcnt(0)
  v_cmp_eq_u32 vcc, -1, v20
  s_nop 4
  s_cbranch_vccz cA_sc0_c3
  s_add_u32 s30, s30, 1
  s_cmp_lt_u32 s30, 400000
  s_cbranch_scc1 cA_sc0_r3
  s_branch cA_abort
cA_sc0_r4:
  s_add_u32 s31, s31, 1
  buffer_load_dwordx4 v[32:35], v2, s[8:11], s23 offen offset:0 sc1
  buffer_load_dwordx4 v[24:27], v2, s[8:11], s23 offen offset:1024 sc1
  buffer_load_dwordx4 v[28:31], v2, s[8:11], s23 offen offset:2048 sc1
  s_waitcnt vmcnt(0)
  v_max3_u32 v66, v24, v27, v28
  v_max3_u32 v66, v66, v31, v32
  v_max_u32 v66, v66, v35
  v_cmp_eq_u32 vcc, -1, v66
  s_nop 4
  s_cbranch_vccz cA_sc0_c4
  s_add_u32 s30, s30, 1
  s_cmp_lt_u32 s30, 400000
  s_cbranch_scc1 cA_sc0_r4
  s_branch cA_abort
cA_sc0_retry:
  s_cmp_lg_u32 s62, 0
  s_cbranch_scc1 cA_sc0_cont
  s_waitcnt vmcnt(0) lgkmcnt(0)
cA_sc0_rv:
  buffer_load_dwordx4 v[8:11], v2, s[8:11], s20 offen offset:0 sc1
  buffer_load_dwordx4 v[12:15], v2, s[8:11], s20 offen offset:1024 sc1
  buffer_load_dwordx4 v[16:19], v2, s[8:11], s20 offen offset:2048 sc1
  buffer_load_dwordx4 v[20:23], v2, s[8:11], s20 offen offset:3072 sc1
  buffer_load_dwordx4 v[32:35], v2, s[8:11], s23 offen offset:0 sc1
  buffer_load_dwordx4 v[24:27], v2, s[8:11], s23 offen offset:1024 sc1
  buffer_load_dwordx4 v[28:31], v2, s[8:11], s23 offen offset:2048 sc1
  s_waitcnt vmcnt(0)
  v_max3_u32 v66, v8, v9, v10
  v_max3_u32 v66, v66, v11, v12
  v_max3_u32 v66, v66, v13, v14
  v_max3_u32 v66, v66, v15, v16
  v_max3_u32 v66, v66, v17, v18
  v_max3_u32 v66, v66, v19, v20
  v_max3_u32 v66, v66, v21, v22
  v_max3_u32 v66, v66, v23, v24
  v_max3_u32 v66, v66, v25, v26
  v_max3_u32 v66, v66, v27, v28
  v_max3_u32 v66, v66, v29, v30
  v_max3_u32 v66, v66, v31, v32
  v_max3_u32 v66, v66, v33, v34
  v_max_u32 v66, v66, v35
  v_cmp_eq_u32 vcc, -1, v66
  s_cbranch_vccz cA_sc0_rk
  s_add_u32 s30, s30, 1
  s_cmp_lt_u32 s30, 400000
  s_cbranch_scc1 cA_sc0_rv
  s_branch cA_abort
cA_sc0_rk:
  s_mov_b32 s62, 1
  v_mov_b32 v36, 0
  v_mov_b32 v37, 0
  v_mov_b32 v38, 0
  v_mov_b32 v39, 0
  v_mov_b32 v40, 0
  v_mov_b32 v41, 0
  v_mov_b32 v42, 0
  v_mov_b32 v43, 0
  v_mov_b32 v44, 0
  v_mov_b32 v45, 0
  v_mov_b32 v46, 0
  v_mov_b32 v47, 0
  v_mov_b32 v48, 0
  v_mov_b32 v49, 0
  v_mov_b32 v50, 0
  v_mov_b32 v51, 0
  v_mov_b32 v60, 0
  v_mov_b32 v61, 0
  v_mov_b32 v62, 0
  v_mov_b32 v63, 0
  v_mov_b32 v68, 0
  v_mov_b32 v69, 0
  v_mov_b32 v70, 0
  v_mov_b32 v71, 0
  v_mov_b32 v72, 0
  v_mov_b32 v73, 0
  v_mov_b32 v74, 0
  v_mov_b32 v75, 0
  v_mov_b32 v52, 0
  v_mov_b32 v53, 0
  v_mov_b32 v54, 0
  v_mov_b32 v55, 0
  v_mov_b32 v56, 0
  v_mov_b32 v57, 0
  v_mov_b32 v58, 0
  v_mov_b32 v59, 0
  s_add_u32 s31, s31, 0x100
  s_nop 0
  s_branch cA_sc0_go
.p2align 6
cA_sc1_loop:
  s_mov_b32 s30, 0
  s_mov_b32 s62, 0
  s_setprio 3
  s_barrier
  buffer_load_dwordx4 v[8:11], v2, s[8:11], s20 offen offset:0 sc1
  s_setprio 2
  buffer_load_dwordx4 v[12:15], v2, s[8:11], s20 offen offset:1024 sc1
  s_setprio 1
  buffer_load_dwordx4 v[16:19], v2, s[8:11], s20 offen offset:2048 sc1
  s_setprio 0
  buffer_load_dwordx4 v[20:23], v2, s[8:11], s20 offen offset:3072 sc1
cA_sc1_go:
  s_waitcnt vmcnt(3)
  v_smfmac_f32_16x16x64_bf16 v[36:39], v[8:11], a[0:7], v3
  buffer_load_dwordx4 v[28:31], v2, s[8:11], s23 offen offset:0 sc1
  v_cmp_eq_u32 vcc, -1, v8
  v_smfmac_f32_16x16x64_bf16 v[40:43], v[8:11], a[56:63], v3
  v_smfmac_f32_16x16x64_bf16 v[44:47], v[8:11], a[112:119], v3
  buffer_load_dwordx4 v[24:27], v2, s[8:11], s23 offen offset:1024 sc1
  s_cbranch_vccnz cA_sc1_r0
  v_smfmac_f32_16x16x64_bf16 v[48:51], v[8:11], a[168:175], v3
  v_smfmac_f32_16x16x64_bf16 v[52:55], v[8:11], a[224:231], v3
  s_waitcnt vmcnt(4)
  v_cmp_eq_u32 vcc, -1, v12
  v_smfmac_f32_16x16x64_bf16 v[56:59], v[8:11], v[144:151], v3
  buffer_load_dwordx4 v[32:35], v2, s[8:11], s23 offen offset:2048 sc1
  v_smfmac_f32_16x16x64_bf16 v[60:63], v[8:11], v[200:207], v3
  s_cbranch_vccnz cA_sc1_r1
cA_sc1_c1:
  v_smfmac_f32_16x16x64_bf16 v[36:39], v[12:15], a[8:15], v3
  v_smfmac_f32_16x16x64_bf16 v[40:43], v[12:15], a[64:71], v3
  v_smfmac_f32_16x16x64_bf16 v[44:47], v[12:15], a[120:127], v3
  v_smfmac_f32_16x16x64_bf16 v[48:51], v[12:15], a[176:183], v3
  v_smfmac_f32_16x16x64_bf16 v[52:55], v[12:15], a[232:239], v3
  s_waitcnt vmcnt(4)
  v_cmp_eq_u32 vcc, -1, v16
  v_smfmac_f32_16x16x64_bf16 v[56:59], v[12:15], v[152:159], v3
  buffer_load_dwordx4 v[88:91], v117, s[8:11], s26 offen offset:0 sc1
  v_smfmac_f32_16x16x64_bf16 v[60:63], v[12:15], v[208:215], v3
  s_cbranch_vccnz cA_sc1_r2
cA_sc1_c2:
  v_smfmac_f32_16x16x64_bf16 v[36:39], v[16:19], a[16:23], v3
  v_smfmac_f32_16x16x64_bf16 v[40:43], v[16:19], a[72:79], v3
  v_smfmac_f32_16x16x64_bf16 v[44:47], v[16:19], a[128:135], v3
  buffer_load_dwordx4 v[92:95], v117, s[8:11], s26 offen offset:1024 sc1
  v_smfmac_f32_16x16x64_bf16 v[48:51], v[16:19], a[184:191], v3
  v_smfmac_f32_16x16x64_bf16 v[52:55], v[16:19], a[240:247], v3
  s_waitcnt vmcnt(5)
  v_cmp_eq_u32 vcc, -1, v20
  v_smfmac_f32_16x16x64_bf16 v[56:59], v[16:19], v[160:167], v3
  v_smfmac_f32_16x16x64_bf16 v[60:63], v[16:19], v[216:223], v3
  buffer_load_dwordx4 v[96:99], v2, s[8:11], s24 offen offset:0 sc1
  s_cbranch_vccnz cA_sc1_r3
cA_sc1_c3:
  v_smfmac_f32_16x16x64_bf16 v[36:39], v[20:23], a[24:31], v3
  v_smfmac_f32_16x16x64_bf16 v[40:43], v[20:23], a[80:87], v3
  s_waitcnt vmcnt(3)
  v_max3_u32 v66, v24, v27, v28
  v_smfmac_f32_16x16x64_bf16 v[44:47], v[20:23], a[136:143], v3
  v_max3_u32 v66, v66, v31, v32
  v_smfmac_f32_16x16x64_bf16 v[48:51], v[20:23], a[192:199], v3
  buffer_load_dwordx4 v[100:103], v2, s[8:11], s24 offen offset:1024 sc1
  v_max_u32 v66, v66, v35
  v_smfmac_f32_16x16x64_bf16 v[52:55], v[20:23], a[248:255], v3
  v_cmp_eq_u32 vcc, -1, v66
  v_smfmac_f32_16x16x64_bf16 v[56:59], v[20:23], v[168:175], v3
  v_smfmac_f32_16x16x64_bf16 v[60:63], v[20:23], v[224:231], v3
  s_cbranch_vccnz cA_sc1_r4
cA_sc1_c4:
  v_smfmac_f32_16x16x64_bf16 v[60:63], v[28:31], v[232:239], v3
  buffer_load_dwordx4 v[104:107], v2, s[8:11], s26 offen offset:0 sc1
  v_smfmac_f32_16x16x64_bf16 v[60:63], v[24:27], v[240:247], v3
  v_smfmac_f32_16x16x64_bf16 v[60:63], v[32:35], v[248:255], v3
  v_smfmac_f32_16x16x64_bf16 v[52:55], v[28:31], v[120:127], v3
  v_smfmac_f32_16x16x64_bf16 v[52:55], v[24:27], v[128:135], v3
  buffer_load_dwordx4 v[108:111], v2, s[8:11], s26 offen offset:1024 sc1
  v_smfmac_f32_16x16x64_bf16 v[52:55], v[32:35], v[136:143], v3
  v_cvt_pk_bf16_f32 v63, v62, v63
  v_smfmac_f32_16x16x64_bf16 v[56:59], v[28:31], v[176:183], v3
  v_cvt_pk_bf16_f32 v62, v60, v61
  v_smfmac_f32_16x16x64_bf16 v[56:59], v[24:27], v[184:191], v3
  v_mfma_f32_16x16x32_bf16 v[8:11], v[62:65], v[4:7], 0
  v_cvt_pk_bf16_f32 v55, v54, v55
  v_smfmac_f32_16x16x64_bf16 v[56:59], v[32:35], v[192:199], v3
  v_cvt_pk_bf16_f32 v54, v52, v53
  v_smfmac_f32_16x16x64_bf16 v[36:39], v[28:31], a[32:39], v3
  s_nop 1
  v_cvt_pk_bf16_f32 v78, v8, v9
  v_smfmac_f32_16x16x64_bf16 v[36:39], v[24:27], a[40:47], v3
  v_cvt_pk_bf16_f32 v79, v10, v11
  v_smfmac_f32_16x16x64_bf16 v[36:39], v[32:35], a[48:55], v3
  v_cvt_pk_bf16_f32 v56, v56, v57
  v_smfmac_f32_16x16x64_bf16 v[40:43], v[28:31], a[88:95], v3
  v_cvt_pk_bf16_f32 v57, v58, v59
  v_smfmac_f32_16x16x64_bf16 v[40:43], v[24:27], a[96:103], v3
  v_mfma_f32_16x16x32_bf16 v[16:19], v[54:57], v[4:7], 0
  v_cvt_pk_bf16_f32 v39, v38, v39
  v_smfmac_f32_16x16x64_bf16 v[40:43], v[32:35], a[104:111], v3
  v_cvt_pk_bf16_f32 v38, v36, v37
  v_smfmac_f32_16x16x64_bf16 v[44:47], v[28:31], a[144:151], v3
  s_nop 1
  v_cvt_pk_bf16_f32 v76, v16, v17
  v_smfmac_f32_16x16x64_bf16 v[44:47], v[24:27], a[152:159], v3
  v_cvt_pk_bf16_f32 v77, v18, v19
  v_smfmac_f32_16x16x64_bf16 v[44:47], v[32:35], a[160:167], v3
  v_cvt_pk_bf16_f32 v40, v40, v41
  v_smfmac_f32_16x16x64_bf16 v[48:51], v[28:31], a[200:207], v3
  v_cvt_pk_bf16_f32 v41, v42, v43
  v_smfmac_f32_16x16x64_bf16 v[48:51], v[24:27], a[208:215], v3
  v_smfmac_f32_16x16x64_bf16 v[48:51], v[32:35], a[216:223], v3
  s_waitcnt vmcnt(4)
  v_cvt_pk_bf16_f32 v47, v46, v47
  v_smfmac_f32_16x16x64_bf16 v[68:71], v[76:79], v[80:87], v3
  v_cvt_pk_bf16_f32 v46, v44, v45
  v_mfma_f32_16x16x32_bf16 v[8:11], v[38:41], v[4:7], 0
  s_nop 1
  v_cvt_pk_bf16_f32 v48, v48, v49
  v_cvt_pk_bf16_f32 v49, v50, v51
  s_nop 1
  v_mfma_f32_16x16x32_bf16 v[16:19], v[46:49], v[4:7], 0
  v_smfmac_f32_16x16x64_bf16 v[72:75], v[76:79], v[88:95], v3
  v_cvt_pk_bf16_f32 v20, v8, v9
  v_mfma_f32_16x16x32_bf16 v[52:55], v[30:33], v[76:79], 0
  s_waitcnt vmcnt(0)
  v_cvt_pk_bf16_f32 v21, v10, v11
  v_cvt_pk_bf16_f32 v22, v16, v17
  v_cvt_pk_bf16_f32 v23, v18, v19
  s_nop 1
  v_mfma_f32_16x16x32_bf16 v[52:55], v[12:15], v[20:23], v[52:55]
  v_smfmac_f32_16x16x64_bf16 v[68:71], v[20:23], v[96:103], v3
  v_smfmac_f32_16x16x64_bf16 v[72:75], v[20:23], v[104:111], v3
  s_nop 1
  ds_write_b128 v113, v[52:55]
  s_nop 1
  v_permlane32_swap_b32 v68, v70
  v_permlane32_swap_b32 v69, v71
  v_add_f32 v56, v68, v70
  v_add_f32 v58, v69, v71
  v_permlane32_swap_b32 v72, v74
  v_permlane32_swap_b32 v73, v75
  v_add_f32 v57, v72, v74
  v_add_f32 v59, v73, v75
  ds_write_b128 v2, v[56:59] offset:1024
  v_cmp_u_f32 vcc, v57, v59
  v_mov_b32 v68, 0
  v_mov_b32 v69, 0
  v_mov_b32 v70, 0
  v_mov_b32 v71, 0
  s_cbranch_vccnz cA_sc1_retry
cA_sc1_cont:
  s_add_u32 s24, s24, 28672
  s_add_u32 s26, s26, 28672
  buffer_load_dwordx4 v[80:83], v117, s[8:11], s24 offen offset:0 sc1
  buffer_load_dwordx4 v[84:87], v117, s[8:11], s24 offen offset:1024 sc1
  v_mov_b32 v72, 0
  v_mov_b32 v73, 0
  v_mfma_f32_32x32x16_bf16 v[36:51], v[68:71], v[68:71], 0
  s_waitcnt lgkmcnt(0)
  s_barrier
  ds_read_b64 v[8:9], v114 offset:0
  ds_read_b64 v[10:11], v114 offset:1024
  ds_read_b64 v[12:13], v114 offset:2048
  ds_read_b64 v[14:15], v114 offset:3072
  ds_read2_b32 v[16:17], v115 offset0:0 offset1:64
  ds_read2_b32 v[18:19], v115 offset0:128 offset1:192
  v_mfma_f32_32x32x16_bf16 v[52:67], v[68:71], v[68:71], 0
  s_waitcnt lgkmcnt(0)
  v_pk_add_f32 v[16:17], v[16:17], v[18:19]
  v_pk_add_f32 v[8:9], v[8:9], v[10:11]
  v_pk_add_f32 v[12:13], v[12:13], v[14:15]
  v_add_f32 v20, v16, v17
  v_pk_add_f32 v[8:9], v[8:9], v[12:13]
  v_max_f32 v22, v8, v9
  v_add_f32_dpp v20, v20, v20 row_ror:8 row_mask:0xf bank_mask:0xf
  s_nop 0
  v_max_f32_dpp v22, v22, v22 row_ror:8 row_mask:0xf bank_mask:0xf
  v_max_f32 v22, v22, v20
  buffer_store_dword v112, v116, s[8:11], 0 offen
  s_nop 0
  v_max_f32_dpp v22, v22, v22 quad_perm:[1,0,3,2] row_mask:0xf bank_mask:0xf
  s_nop 1
  v_max_f32_dpp v22, v22, v22 quad_perm:[2,3,0,1] row_mask:0xf bank_mask:0xf
  s_nop 1
  v_max_f32_dpp v22, v22, v22 row_half_mirror row_mask:0xf bank_mask:0xf
  v_pk_add_f32 v[8:9], v[8:9], v[22:23] op_sel_hi:[1,0] neg_lo:[0,1] neg_hi:[0,1]
  v_sub_f32 v20, v20, v22
  v_exp_f32 v8, v8
  v_exp_f32 v9, v9
  v_exp_f32 v20, v20
  v_add_f32 v24, v8, v9
  v_fmac_f32 v24, 0.5, v20
  v_mov_b32_dpp v21, v20 quad_perm:[1,0,3,2] row_mask:0xf bank_mask:0xf
  s_nop 0
  v_add_f32_dpp v24, v24, v24 quad_perm:[1,0,3,2] row_mask:0xf bank_mask:0xf
  s_nop 1
  v_add_f32_dpp v24, v24, v24 quad_perm:[2,3,0,1] row_mask:0xf bank_mask:0xf
  s_nop 1
  v_add_f32_dpp v24, v24, v24 row_half_mirror row_mask:0xf bank_mask:0xf
  s_nop 1
  v_add_f32_dpp v24, v24, v24 row_ror:8 row_mask:0xf bank_mask:0xf
  v_rcp_f32 v24, v24
  s_nop 0
  v_pk_mul_f32 v[8:9], v[8:9], v[24:25] op_sel_hi:[1,0]
  v_cvt_pk_bf16_f32 v8, abs(v8), abs(v9)
  buffer_store_dword v8, v1, s[8:11], s20 offen
  v_pk_mul_f32 v[20:21], v[20:21], v[24:25] op_sel_hi:[1,0]
  v_cvt_pk_bf16_f32 v20, abs(v20), abs(v21)
  buffer_store_dword v20, v118, s[8:11], s20 offen
  v_mov_b32 v74, 0
  v_mov_b32 v75, 0
  s_mov_b32 s19, s18
  s_add_u32 s18, s18, 1
  s_mov_b32 s22, s20
  s_mov_b32 s20, s21
  s_mov_b32 s21, s22
  s_add_u32 s23, s20, 4096
  v_mov_b32 v112, s18
  s_cmp_lt_u32 s19, 63
  s_nop 0
  s_cbranch_scc1 cA_sc1_loop
  s_branch cA_done
cA_sc1_r0:
  s_add_u32 s31, s31, 1
  buffer_load_dwordx4 v[8:11], v2, s[8:11], s20 offen offset:0 sc1
  s_waitcnt vmcnt(0)
  v_cmp_eq_u32 vcc, -1, v8
  v_mov_b32 v36, 0
  v_mov_b32 v37, 0
  v_mov_b32 v38, 0
  v_mov_b32 v39, 0
  v_mov_b32 v40, 0
  v_mov_b32 v41, 0
  v_mov_b32 v42, 0
  v_mov_b32 v43, 0
  v_mov_b32 v44, 0
  v_mov_b32 v45, 0
  v_mov_b32 v46, 0
  v_mov_b32 v47, 0
  v_mov_b32 v48, 0
  v_mov_b32 v49, 0
  v_mov_b32 v50, 0
  v_mov_b32 v51, 0
  s_nop 1
  s_cbranch_vccz cA_sc1_go
  s_add_u32 s30, s30, 1
  s_cmp_lt_u32 s30, 400000
  s_cbranch_scc1 cA_sc1_r0
  s_branch cA_abort
cA_sc1_r1:
  s_add_u32 s31, s31, 1
  buffer_load_dwordx4 v[12:15], v2, s[8:11], s20 offen offset:1024 sc1
  s_waitcnt vmcnt(0)
  v_cmp_eq_u32 vcc, -1, v12
  s_nop 4
  s_cbranch_vccz cA_sc1_c1
  s_add_u32 s30, s30, 1
  s_cmp_lt_u32 s30, 400000
  s_cbranch_scc1 cA_sc1_r1
  s_branch cA_abort
cA_sc1_r2:
  s_add_u32 s31, s31, 1
  buffer_load_dwordx4 v[16:19], v2, s[8:11], s20 offen offset:2048 sc1
  s_waitcnt vmcnt(0)
  v_cmp_eq_u32 vcc, -1, v16
  s_nop 4
  s_cbranch_vccz cA_sc1_c2
  s_add_u32 s30, s30, 1
  s_cmp_lt_u32 s30, 400000
  s_cbranch_scc1 cA_sc1_r2
  s_branch cA_abort
cA_sc1_r3:
  s_add_u32 s31, s31, 1
  buffer_load_dwordx4 v[20:23], v2, s[8:11], s20 offen offset:3072 sc1
  s_waitcnt vmcnt(0)
  v_cmp_eq_u32 vcc, -1, v20
  s_nop 4
  s_cbranch_vccz cA_sc1_c3
  s_add_u32 s30, s30, 1
  s_cmp_lt_u32 s30, 400000
  s_cbranch_scc1 cA_sc1_r3
  s_branch cA_abort
cA_sc1_r4:
  s_add_u32 s31, s31, 1
  buffer_load_dwordx4 v[28:31], v2, s[8:11], s23 offen offset:0 sc1
  buffer_load_dwordx4 v[24:27], v2, s[8:11], s23 offen offset:1024 sc1
  buffer_load_dwordx4 v[32:35], v2, s[8:11], s23 offen offset:2048 sc1
  s_waitcnt vmcnt(0)
  v_max3_u32 v66, v24, v27, v28
  v_max3_u32 v66, v66, v31, v32
  v_max_u32 v66, v66, v35
  v_cmp_eq_u32 vcc, -1, v66
  s_nop 4
  s_cbranch_vccz cA_sc1_c4
  s_add_u32 s30, s30, 1
  s_cmp_lt_u32 s30, 400000
  s_cbranch_scc1 cA_sc1_r4
  s_branch cA_abort
cA_sc1_retry:
  s_cmp_lg_u32 s62, 0
  s_cbranch_scc1 cA_sc1_cont
  s_waitcnt vmcnt(0) lgkmcnt(0)
cA_sc1_rv:
  buffer_load_dwordx4 v[8:11], v2, s[8:11], s20 offen offset:0 sc1
  buffer_load_dwordx4 v[12:15], v2, s[8:11], s20 offen offset:1024 sc1
  buffer_load_dwordx4 v[16:19], v2, s[8:11], s20 offen offset:2048 sc1
  buffer_load_dwordx4 v[20:23], v2, s[8:11], s20 offen offset:3072 sc1
  buffer_load_dwordx4 v[28:31], v2, s[8:11], s23 offen offset:0 sc1
  buffer_load_dwordx4 v[24:27], v2, s[8:11], s23 offen offset:1024 sc1
  buffer_load_dwordx4 v[32:35], v2, s[8:11], s23 offen offset:2048 sc1
  s_waitcnt vmcnt(0)
  v_max3_u32 v66, v8, v9, v10
  v_max3_u32 v66, v66, v11, v12
  v_max3_u32 v66, v66, v13, v14
  v_max3_u32 v66, v66, v15, v16
  v_max3_u32 v66, v66, v17, v18
  v_max3_u32 v66, v66, v19, v20
  v_max3_u32 v66, v66, v21, v22
  v_max3_u32 v66, v66, v23, v24
  v_max3_u32 v66, v66, v25, v26
  v_max3_u32 v66, v66, v27, v28
  v_max3_u32 v66, v66, v29, v30
  v_max3_u32 v66, v66, v31, v32
  v_max3_u32 v66, v66, v33, v34
  v_max_u32 v66, v66, v35
  v_cmp_eq_u32 vcc, -1, v66
  s_cbranch_vccz cA_sc1_rk
  s_add_u32 s30, s30, 1
  s_cmp_lt_u32 s30, 400000
  s_cbranch_scc1 cA_sc1_rv
  s_branch cA_abort
cA_sc1_rk:
  s_mov_b32 s62, 1
  v_mov_b32 v36, 0
  v_mov_b32 v37, 0
  v_mov_b32 v38, 0
  v_mov_b32 v39, 0
  v_mov_b32 v40, 0
  v_mov_b32 v41, 0
  v_mov_b32 v42, 0
  v_mov_b32 v43, 0
  v_mov_b32 v44, 0
  v_mov_b32 v45, 0
  v_mov_b32 v46, 0
  v_mov_b32 v47, 0
  v_mov_b32 v48, 0
  v_mov_b32 v49, 0
  v_mov_b32 v50, 0
  v_mov_b32 v51, 0
  v_mov_b32 v60, 0
  v_mov_b32 v61, 0
  v_mov_b32 v62, 0
  v_mov_b32 v63, 0
  v_mov_b32 v68, 0
  v_mov_b32 v69, 0
  v_mov_b32 v70, 0
  v_mov_b32 v71, 0
  v_mov_b32 v72, 0
  v_mov_b32 v73, 0
  v_mov_b32 v74, 0
  v_mov_b32 v75, 0
  v_mov_b32 v52, 0
  v_mov_b32 v53, 0
  v_mov_b32 v54, 0
  v_mov_b32 v55, 0
  v_mov_b32 v56, 0
  v_mov_b32 v57, 0
  v_mov_b32 v58, 0
  v_mov_b32 v59, 0
  s_add_u32 s31, s31, 0x100
  s_nop 0
  s_branch cA_sc1_go
.p2align 6
cA_sc2_loop:
  s_mov_b32 s30, 0
  s_mov_b32 s62, 0
  s_setprio 3
  s_barrier
  buffer_load_dwordx4 v[8:11], v2, s[8:11], s20 offen offset:0 sc1
  s_setprio 2
  buffer_load_dwordx4 v[12:15], v2, s[8:11], s20 offen offset:1024 sc1
  s_setprio 1
  buffer_load_dwordx4 v[16:19], v2, s[8:11], s20 offen offset:2048 sc1
  s_setprio 0
  buffer_load_dwordx4 v[20:23], v2, s[8:11], s20 offen offset:3072 sc1
cA_sc2_go:
  s_waitcnt vmcnt(3)
  v_smfmac_f32_16x16x64_bf16 v[36:39], v[8:11], a[0:7], v3
  buffer_load_dwordx4 v[24:27], v2, s[8:11], s23 offen offset:0 sc1
  v_cmp_eq_u32 vcc, -1, v8
  v_smfmac_f32_16x16x64_bf16 v[40:43], v[8:11], a[56:63], v3
  v_smfmac_f32_16x16x64_bf16 v[44:47], v[8:11], a[112:119], v3
  buffer_load_dwordx4 v[32:35], v2, s[8:11], s23 offen offset:1024 sc1
  s_cbranch_vccnz cA_sc2_r0
  v_smfmac_f32_16x16x64_bf16 v[48:51], v[8:11], a[168:175], v3
  v_smfmac_f32_16x16x64_bf16 v[52:55], v[8:11], a[224:231], v3
  s_waitcnt vmcnt(4)
  v_cmp_eq_u32 vcc, -1, v12
  v_smfmac_f32_16x16x64_bf16 v[56:59], v[8:11], v[144:151], v3
  buffer_load_dwordx4 v[28:31], v2, s[8:11], s23 offen offset:2048 sc1
  v_smfmac_f32_16x16x64_bf16 v[62:65], v[8:11], v[200:207], v3
  s_cbranch_vccnz cA_sc2_r1
cA_sc2_c1:
  v_smfmac_f32_16x16x64_bf16 v[36:39], v[12:15], a[8:15], v3
  v_smfmac_f32_16x16x64_bf16 v[40:43], v[12:15], a[64:71], v3
  v_smfmac_f32_16x16x64_bf16 v[44:47], v[12:15], a[120:127], v3
  v_smfmac_f32_16x16x64_bf16 v[48:51], v[12:15], a[176:183], v3
  v_smfmac_f32_16x16x64_bf16 v[52:55], v[12:15], a[232:239], v3
  s_waitcnt vmcnt(4)
  v_cmp_eq_u32 vcc, -1, v16
  v_smfmac_f32_16x16x64_bf16 v[56:59], v[12:15], v[152:159], v3
  buffer_load_dwordx4 v[88:91], v117, s[8:11], s26 offen offset:0 sc1
  v_smfmac_f32_16x16x64_bf16 v[62:65], v[12:15], v[208:215], v3
  s_cbranch_vccnz cA_sc2_r2
cA_sc2_c2:
  v_smfmac_f32_16x16x64_bf16 v[36:39], v[16:19], a[16:23], v3
  v_smfmac_f32_16x16x64_bf16 v[40:43], v[16:19], a[72:79], v3
  v_smfmac_f32_16x16x64_bf16 v[44:47], v[16:19], a[128:135], v3
  buffer_load_dwordx4 v[92:95], v117, s[8:11], s26 offen offset:1024 sc1
  v_smfmac_f32_16x16x64_bf16 v[48:51], v[16:19], a[184:191], v3
  v_smfmac_f32_16x16x64_bf16 v[52:55], v[16:19], a[240:247], v3
  s_waitcnt vmcnt(5)
  v_cmp_eq_u32 vcc, -1, v20
  v_smfmac_f32_16x16x64_bf16 v[56:59], v[16:19], v[160:167], v3
  v_smfmac_f32_16x16x64_bf16 v[62:65], v[16:19], v[216:223], v3
  buffer_load_dwordx4 v[96:99], v2, s[8:11], s24 offen offset:0 sc1
  s_cbranch_vccnz cA_sc2_r3
cA_sc2_c3:
  v_smfmac_f32_16x16x64_bf16 v[36:39], v[20:23], a[24:31], v3
  v_smfmac_f32_16x16x64_bf16 v[40:43], v[20:23], a[80:87], v3
  s_waitcnt vmcnt(3)
  v_max3_u32 v66, v24, v27, v28
  v_smfmac_f32_16x16x64_bf16 v[44:47], v[20:23], a[136:143], v3
  v_max3_u32 v66, v66, v31, v32
  v_smfmac_f32_16x16x64_bf16 v[48:51], v[20:23], a[192:199], v3
  buffer_load_dwordx4 v[100:103], v2, s[8:11], s24 offen offset:1024 sc1
  v_max_u32 v66, v66, v35
  v_smfmac_f32_16x16x64_bf16 v[52:55], v[20:23], a[248:255], v3
  v_cmp_eq_u32 vcc, -1, v66
  v_smfmac_f32_16x16x64_bf16 v[56:59], v[20:23], v[168:175], v3
  v_smfmac_f32_16x16x64_bf16 v[62:65], v[20:23], v[224:231], v3
  s_cbranch_vccnz cA_sc2_r4
cA_sc2_c4:
  v_smfmac_f32_16x16x64_bf16 v[62:65], v[24:27], v[232:239], v3
  buffer_load_dwordx4 v[104:107], v2, s[8:11], s26 offen offset:0 sc1
  v_smfmac_f32_16x16x64_bf16 v[62:65], v[32:35], v[240:247], v3
  v_smfmac_f32_16x16x64_bf16 v[62:65], v[28:31], v[248:255], v3
  v_smfmac_f32_16x16x64_bf16 v[52:55], v[24:27], v[120:127], v3
  v_smfmac_f32_16x16x64_bf16 v[52:55], v[32:35], v[128:135], v3
  buffer_load_dwordx4 v[108:111], v2, s[8:11], s26 offen offset:1024 sc1
  v_smfmac_f32_16x16x64_bf16 v[52:55], v[28:31], v[136:143], v3
  v_cvt_pk_bf16_f32 v62, v62, v63
  v_smfmac_f32_16x16x64_bf16 v[56:59], v[24:27], v[176:183], v3
  v_cvt_pk_bf16_f32 v63, v64, v65
  v_smfmac_f32_16x16x64_bf16 v[56:59], v[32:35], v[184:191], v3
  v_mfma_f32_16x16x32_bf16 v[8:11], v[60:63], v[4:7], 0
  v_cvt_pk_bf16_f32 v55, v54, v55
  v_smfmac_f32_16x16x64_bf16 v[56:59], v[28:31], v[192:199], v3
  v_cvt_pk_bf16_f32 v54, v52, v53
  v_smfmac_f32_16x16x64_bf16 v[36:39], v[24:27], a[32:39], v3
  s_nop 1
  v_cvt_pk_bf16_f32 v76, v8, v9
  v_smfmac_f32_16x16x64_bf16 v[36:39], v[32:35], a[40:47], v3
  v_cvt_pk_bf16_f32 v77, v10, v11
  v_smfmac_f32_16x16x64_bf16 v[36:39], v[28:31], a[48:55], v3
  v_cvt_pk_bf16_f32 v56, v56, v57
  v_smfmac_f32_16x16x64_bf16 v[40:43], v[24:27], a[88:95], v3
  v_cvt_pk_bf16_f32 v57, v58, v59
  v_smfmac_f32_16x16x64_bf16 v[40:43], v[32:35], a[96:103], v3
  v_mfma_f32_16x16x32_bf16 v[12:15], v[54:57], v[4:7], 0
  v_cvt_pk_bf16_f32 v39, v38, v39
  v_smfmac_f32_16x16x64_bf16 v[40:43], v[28:31], a[104:111], v3
  v_cvt_pk_bf16_f32 v38, v36, v37
  v_smfmac_f32_16x16x64_bf16 v[44:47], v[24:27], a[144:151], v3
  s_nop 1
  v_cvt_pk_bf16_f32 v78, v12, v13
  v_smfmac_f32_16x16x64_bf16 v[44:47], v[32:35], a[152:159], v3
  v_cvt_pk_bf16_f32 v79, v14, v15
  v_smfmac_f32_16x16x64_bf16 v[44:47], v[28:31], a[160:167], v3
  v_cvt_pk_bf16_f32 v40, v40, v41
  v_smfmac_f32_16x16x64_bf16 v[48:51], v[24:27], a[200:207], v3
  v_cvt_pk_bf16_f32 v41, v42, v43
  v_smfmac_f32_16x16x64_bf16 v[48:51], v[32:35], a[208:215], v3
  v_smfmac_f32_16x16x64_bf16 v[48:51], v[28:31], a[216:223], v3
  s_waitcnt vmcnt(4)
  v_cvt_pk_bf16_f32 v47, v46, v47
  v_smfmac_f32_16x16x64_bf16 v[68:71], v[76:79], v[80:87], v3
  v_cvt_pk_bf16_f32 v46, v44, v45
  v_mfma_f32_16x16x32_bf16 v[8:11], v[38:41], v[4:7], 0
  s_nop 1
  v_cvt_pk_bf16_f32 v48, v48, v49
  v_cvt_pk_bf16_f32 v49, v50, v51
  s_nop 1
  v_mfma_f32_16x16x32_bf16 v[12:15], v[46:49], v[4:7], 0
  v_smfmac_f32_16x16x64_bf16 v[72:75], v[76:79], v[88:95], v3
  v_cvt_pk_bf16_f32 v20, v8, v9
  v_mfma_f32_16x16x32_bf16 v[52:55], v[30:33], v[76:79], 0
  s_waitcnt vmcnt(0)
  v_cvt_pk_bf16_f32 v21, v10, v11
  v_cvt_pk_bf16_f32 v22, v12, v13
  v_cvt_pk_bf16_f32 v23, v14, v15
  s_nop 1
  v_mfma_f32_16x16x32_bf16 v[52:55], v[16:19], v[20:23], v[52:55]
  v_smfmac_f32_16x16x64_bf16 v[68:71], v[20:23], v[96:103], v3
  v_smfmac_f32_16x16x64_bf16 v[72:75], v[20:23], v[104:111], v3
  s_nop 1
  ds_write_b128 v113, v[52:55]
  s_nop 1
  v_permlane32_swap_b32 v68, v70
  v_permlane32_swap_b32 v69, v71
  v_add_f32 v56, v68, v70
  v_add_f32 v58, v69, v71
  v_permlane32_swap_b32 v72, v74
  v_permlane32_swap_b32 v73, v75
  v_add_f32 v57, v72, v74
  v_add_f32 v59, v73, v75
  ds_write_b128 v2, v[56:59] offset:2048
  v_cmp_u_f32 vcc, v57, v59
  v_mov_b32 v68, 0
  v_mov_b32 v69, 0
  v_mov_b32 v70, 0
  v_mov_b32 v71, 0
  s_cbranch_vccnz cA_sc2_retry
cA_sc2_cont:
  s_add_u32 s24, s24, 28672
  s_add_u32 s26, s26, 28672
  buffer_load_dwordx4 v[80:83], v117, s[8:11], s24 offen offset:0 sc1
  buffer_load_dwordx4 v[84:87], v117, s[8:11], s24 offen offset:1024 sc1
  v_mov_b32 v72, 0
  v_mov_b32 v73, 0
  v_mfma_f32_32x32x16_bf16 v[36:51], v[68:71], v[68:71], 0
  s_waitcnt lgkmcnt(0)
  s_barrier
  v_mfma_f32_32x32x16_bf16 v[52:67], v[68:71], v[68:71], 0
  buffer_store_dwordx2 v[118:119], v114, s[8:11], s21 offen
  buffer_store_dwordx2 v[118:119], v115, s[8:11], s21 offen
  s_buffer_load_dword s70, s[8:11], s35
  s_add_u32 s22, s24, 114688
  s_buffer_load_dword s71, s[8:11], s22
  s_mul_i32 s22, s18, 7168
  s_add_u32 s22, s22, 87040
  s_buffer_load_dword s72, s[8:11], s22
  s_add_u32 s35, s35, 458752
  v_mov_b32 v74, 0
  v_mov_b32 v75, 0
  s_mov_b32 s19, s18
  s_add_u32 s18, s18, 1
  s_mov_b32 s22, s20
  s_mov_b32 s20, s21
  s_mov_b32 s21, s22
  s_add_u32 s23, s20, 4096
  s_cmp_lt_u32 s19, 63
  s_cbranch_scc1 cA_sc2_loop
  s_branch cA_done
cA_sc2_r0:
  s_add_u32 s31, s31, 1
  buffer_load_dwordx4 v[8:11], v2, s[8:11], s20 offen offset:0 sc1
  s_waitcnt vmcnt(0)
  v_cmp_eq_u32 vcc, -1, v8
  v_mov_b32 v36, 0
  v_mov_b32 v37, 0
  v_mov_b32 v38, 0
  v_mov_b32 v39, 0
  v_mov_b32 v40, 0
  v_mov_b32 v41, 0
  v_mov_b32 v42, 0
  v_mov_b32 v43, 0
  v_mov_b32 v44, 0
  v_mov_b32 v45, 0
  v_mov_b32 v46, 0
  v_mov_b32 v47, 0
  v_mov_b32 v48, 0
  v_mov_b32 v49, 0
  v_mov_b32 v50, 0
  v_mov_b32 v51, 0
  s_nop 1
  s_cbranch_vccz cA_sc2_go
  s_add_u32 s30, s30, 1
  s_cmp_lt_u32 s30, 400000
  s_cbranch_scc1 cA_sc2_r0
  s_branch cA_abort
cA_sc2_r1:
  s_add_u32 s31, s31, 1
  buffer_load_dwordx4 v[12:15], v2, s[8:11], s20 offen offset:1024 sc1
  s_waitcnt vmcnt(0)
  v_cmp_eq_u32 vcc, -1, v12
  s_nop 4
  s_cbranch_vccz cA_sc2_c1
  s_add_u32 s30, s30, 1
  s_cmp_lt_u32 s30, 400000
  s_cbranch_scc1 cA_sc2_r1
  s_branch cA_abort
cA_sc2_r2:
  s_add_u32 s31, s31, 1
  buffer_load_dwordx4 v[16:19], v2, s[8:11], s20 offen offset:2048 sc1
  s_waitcnt vmcnt(0)
  v_cmp_eq_u32 vcc, -1, v16
  s_nop 4
  s_cbranch_vccz cA_sc2_c2
  s_add_u32 s30, s30, 1
  s_cmp_lt_u32 s30, 400000
  s_cbranch_scc1 cA_sc2_r2
  s_branch cA_abort
cA_sc2_r3:
  s_add_u32 s31, s31, 1
  buffer_load_dwordx4 v[20:23], v2, s[8:11], s20 offen offset:3072 sc1
  s_waitcnt vmcnt(0)
  v_cmp_eq_u32 vcc, -1, v20
  s_nop 4
  s_cbranch_vccz cA_sc2_c3
  s_add_u32 s30, s30, 1
  s_cmp_lt_u32 s30, 400000
  s_cbranch_scc1 cA_sc2_r3
  s_branch cA_abort
cA_sc2_r4:
  s_add_u32 s31, s31, 1
  buffer_load_dwordx4 v[24:27], v2, s[8:11], s23 offen offset:0 sc1
  buffer_load_dwordx4 v[32:35], v2, s[8:11], s23 offen offset:1024 sc1
  buffer_load_dwordx4 v[28:31], v2, s[8:11], s23 offen offset:2048 sc1
  s_waitcnt vmcnt(0)
  v_max3_u32 v66, v24, v27, v28
  v_max3_u32 v66, v66, v31, v32
  v_max_u32 v66, v66, v35
  v_cmp_eq_u32 vcc, -1, v66
  s_nop 4
  s_cbranch_vccz cA_sc2_c4
  s_add_u32 s30, s30, 1
  s_cmp_lt_u32 s30, 400000
  s_cbranch_scc1 cA_sc2_r4
  s_branch cA_abort
cA_sc2_retry:
  s_cmp_lg_u32 s62, 0
  s_cbranch_scc1 cA_sc2_cont
  s_waitcnt vmcnt(0) lgkmcnt(0)
cA_sc2_rv:
  buffer_load_dwordx4 v[8:11], v2, s[8:11], s20 offen offset:0 sc1
  buffer_load_dwordx4 v[12:15], v2, s[8:11], s20 offen offset:1024 sc1
  buffer_load_dwordx4 v[16:19], v2, s[8:11], s20 offen offset:2048 sc1
  buffer_load_dwordx4 v[20:23], v2, s[8:11], s20 offen offset:3072 sc1
  buffer_load_dwordx4 v[24:27], v2, s[8:11], s23 offen offset:0 sc1
  buffer_load_dwordx4 v[32:35], v2, s[8:11], s23 offen offset:1024 sc1
  buffer_load_dwordx4 v[28:31], v2, s[8:11], s23 offen offset:2048 sc1
  s_waitcnt vmcnt(0)
  v_max3_u32 v66, v8, v9, v10
  v_max3_u32 v66, v66, v11, v12
  v_max3_u32 v66, v66, v13, v14
  v_max3_u32 v66, v66, v15, v16
  v_max3_u32 v66, v66, v17, v18
  v_max3_u32 v66, v66, v19, v20
  v_max3_u32 v66, v66, v21, v22
  v_max3_u32 v66, v66, v23, v24
  v_max3_u32 v66, v66, v25, v26
  v_max3_u32 v66, v66, v27, v28
  v_max3_u32 v66, v66, v29, v30
  v_max3_u32 v66, v66, v31, v32
  v_max3_u32 v66, v66, v33, v34
  v_max_u32 v66, v66, v35
  v_cmp_eq_u32 vcc, -1, v66
  s_cbranch_vccz cA_sc2_rk
  s_add_u32 s30, s30, 1
  s_cmp_lt_u32 s30, 400000
  s_cbranch_scc1 cA_sc2_rv
  s_branch cA_abort
cA_sc2_rk:
  s_mov_b32 s62, 1
  v_mov_b32 v36, 0
  v_mov_b32 v37, 0
  v_mov_b32 v38, 0
  v_mov_b32 v39, 0
  v_mov_b32 v40, 0
  v_mov_b32 v41, 0
  v_mov_b32 v42, 0
  v_mov_b32 v43, 0
  v_mov_b32 v44, 0
  v_mov_b32 v45, 0
  v_mov_b32 v46, 0
  v_mov_b32 v47, 0
  v_mov_b32 v48, 0
  v_mov_b32 v49, 0
  v_mov_b32 v50, 0
  v_mov_b32 v51, 0
  v_mov_b32 v62, 0
  v_mov_b32 v63, 0
  v_mov_b32 v64, 0
  v_mov_b32 v65, 0
  v_mov_b32 v68, 0
  v_mov_b32 v69, 0
  v_mov_b32 v70, 0
  v_mov_b32 v71, 0
  v_mov_b32 v72, 0
  v_mov_b32 v73, 0
  v_mov_b32 v74, 0
  v_mov_b32 v75, 0
  v_mov_b32 v52, 0
  v_mov_b32 v53, 0
  v_mov_b32 v54, 0
  v_mov_b32 v55, 0
  v_mov_b32 v56, 0
  v_mov_b32 v57, 0
  v_mov_b32 v58, 0
  v_mov_b32 v59, 0
  s_add_u32 s31, s31, 0x100
  s_nop 0
  s_branch cA_sc2_go
.p2align 6
cA_sc3_loop:
  s_mov_b32 s30, 0
  s_mov_b32 s62, 0
  s_setprio 3
  s_barrier
  buffer_load_dwordx4 v[8:11], v2, s[8:11], s20 offen offset:0 sc1
  s_setprio 2
  buffer_load_dwordx4 v[12:15], v2, s[8:11], s20 offen offset:1024 sc1
  s_setprio 1
  buffer_load_dwordx4 v[16:19], v2, s[8:11], s20 offen offset:2048 sc1
  s_setprio 0
  buffer_load_dwordx4 v[20:23], v2, s[8:11], s20 offen offset:3072 sc1
cA_sc3_go:
  s_waitcnt vmcnt(3)
  v_smfmac_f32_16x16x64_bf16 v[36:39], v[8:11], a[0:7], v3
  buffer_load_dwordx4 v[24:27], v2, s[8:11], s23 offen offset:0 sc1
  v_cmp_eq_u32 vcc, -1, v8
  v_smfmac_f32_16x16x64_bf16 v[40:43], v[8:11], a[56:63], v3
  v_smfmac_f32_16x16x64_bf16 v[44:47], v[8:11], a[112:119], v3
  buffer_load_dwordx4 v[28:31], v2, s[8:11], s23 offen offset:1024 sc1
  s_cbranch_vccnz cA_sc3_r0
  v_smfmac_f32_16x16x64_bf16 v[48:51], v[8:11], a[168:175], v3
  v_smfmac_f32_16x16x64_bf16 v[52:55], v[8:11], a[224:231], v3
  s_waitcnt vmcnt(4)
  v_cmp_eq_u32 vcc, -1, v12
  v_smfmac_f32_16x16x64_bf16 v[56:59], v[8:11], v[144:151], v3
  buffer_load_dwordx4 v[32:35], v2, s[8:11], s23 offen offset:2048 sc1
  v_smfmac_f32_16x16x64_bf16 v[62:65], v[8:11], v[200:207], v3
  s_cbranch_vccnz cA_sc3_r1
cA_sc3_c1:
  v_smfmac_f32_16x16x64_bf16 v[36:39], v[12:15], a[8:15], v3
  v_smfmac_f32_16x16x64_bf16 v[40:43], v[12:15], a[64:71], v3
  v_smfmac_f32_16x16x64_bf16 v[44:47], v[12:15], a[120:127], v3
  v_smfmac_f32_16x16x64_bf16 v[48:51], v[12:15], a[176:183], v3
  v_smfmac_f32_16x16x64_bf16 v[52:55], v[12:15], a[232:239], v3
  s_waitcnt vmcnt(4)
  v_cmp_eq_u32 vcc, -1, v16
  v_smfmac_f32_16x16x64_bf16 v[56:59], v[12:15], v[152:159], v3
  buffer_load_dwordx4 v[88:91], v117, s[8:11], s26 offen offset:0 sc1
  v_smfmac_f32_16x16x64_bf16 v[62:65], v[12:15], v[208:215], v3
  s_cbranch_vccnz cA_sc3_r2
cA_sc3_c2:
  v_smfmac_f32_16x16x64_bf16 v[36:39], v[16:19], a[16:23], v3
  v_smfmac_f32_16x16x64_bf16 v[40:43], v[16:19], a[72:79], v3
  v_smfmac_f32_16x16x64_bf16 v[44:47], v[16:19], a[128:135], v3
  buffer_load_dwordx4 v[92:95], v117, s[8:11], s26 offen offset:1024 sc1
  v_smfmac_f32_16x16x64_bf16 v[48:51], v[16:19], a[184:191], v3
  v_smfmac_f32_16x16x64_bf16 v[52:55], v[16:19], a[240:247], v3
  s_waitcnt vmcnt(5)
  v_cmp_eq_u32 vcc, -1, v20
  v_smfmac_f32_16x16x64_bf16 v[56:59], v[16:19], v[160:167], v3
  v_smfmac_f32_16x16x64_bf16 v[62:65], v[16:19], v[216:223], v3
  buffer_load_dwordx4 v[96:99], v2, s[8:11], s24 offen offset:0 sc1
  s_cbranch_vccnz cA_sc3_r3
cA_sc3_c3:
  v_smfmac_f32_16x16x64_bf16 v[36:39], v[20:23], a[24:31], v3
  v_smfmac_f32_16x16x64_bf16 v[40:43], v[20:23], a[80:87], v3
  s_waitcnt vmcnt(3)
  v_max3_u32 v66, v24, v27, v28
  v_smfmac_f32_16x16x64_bf16 v[44:47], v[20:23], a[136:143], v3
  v_max3_u32 v66, v66, v31, v32
  v_smfmac_f32_16x16x64_bf16 v[48:51], v[20:23], a[192:199], v3
  buffer_load_dwordx4 v[100:103], v2, s[8:11], s24 offen offset:1024 sc1
  v_max_u32 v66, v66, v35
  v_smfmac_f32_16x16x64_bf16 v[52:55], v[20:23], a[248:255], v3
  v_cmp_eq_u32 vcc, -1, v66
  v_smfmac_f32_16x16x64_bf16 v[56:59], v[20:23], v[168:175], v3
  v_smfmac_f32_16x16x64_bf16 v[62:65], v[20:23], v[224:231], v3
  s_cbranch_vccnz cA_sc3_r4
cA_sc3_c4:
  v_smfmac_f32_16x16x64_bf16 v[62:65], v[24:27], v[232:239], v3
  buffer_load_dwordx4 v[104:107], v2, s[8:11], s26 offen offset:0 sc1
  v_smfmac_f32_16x16x64_bf16 v[62:65], v[28:31], v[240:247], v3
  v_smfmac_f32_16x16x64_bf16 v[62:65], v[32:35], v[248:255], v3
  v_smfmac_f32_16x16x64_bf16 v[52:55], v[24:27], v[120:127], v3
  v_smfmac_f32_16x16x64_bf16 v[52:55], v[28:31], v[128:135], v3
  buffer_load_dwordx4 v[108:111], v2, s[8:11], s26 offen offset:1024 sc1
  v_smfmac_f32_16x16x64_bf16 v[52:55], v[32:35], v[136:143], v3
  v_cvt_pk_bf16_f32 v62, v62, v63
  v_smfmac_f32_16x16x64_bf16 v[56:59], v[24:27], v[176:183], v3
  v_cvt_pk_bf16_f32 v63, v64, v65
  v_smfmac_f32_16x16x64_bf16 v[56:59], v[28:31], v[184:191], v3
  v_mfma_f32_16x16x32_bf16 v[8:11], v[60:63], v[4:7], 0
  v_cvt_pk_bf16_f32 v55, v54, v55
  v_smfmac_f32_16x16x64_bf16 v[56:59], v[32:35], v[192:199], v3
  v_cvt_pk_bf16_f32 v54, v52, v53
  v_smfmac_f32_16x16x64_bf16 v[36:39], v[24:27], a[32:39], v3
  s_nop 1
  v_cvt_pk_bf16_f32 v78, v8, v9
  v_smfmac_f32_16x16x64_bf16 v[36:39], v[28:31], a[40:47], v3
  v_cvt_pk_bf16_f32 v79, v10, v11
  v_smfmac_f32_16x16x64_bf16 v[36:39], v[32:35], a[48:55], v3
  v_cvt_pk_bf16_f32 v56, v56, v57
  v_smfmac_f32_16x16x64_bf16 v[40:43], v[24:27], a[88:95], v3
  v_cvt_pk_bf16_f32 v57, v58, v59
  v_smfmac_f32_16x16x64_bf16 v[40:43], v[28:31], a[96:103], v3
  v_mfma_f32_16x16x32_bf16 v[12:15], v[54:57], v[4:7], 0
  v_cvt_pk_bf16_f32 v39, v38, v39
  v_smfmac_f32_16x16x64_bf16 v[40:43], v[32:35], a[104:111], v3
  v_cvt_pk_bf16_f32 v38, v36, v37
  v_smfmac_f32_16x16x64_bf16 v[44:47], v[24:27], a[144:151], v3
  s_nop 1
  v_cvt_pk_bf16_f32 v76, v12, v13
  v_smfmac_f32_16x16x64_bf16 v[44:47], v[28:31], a[152:159], v3
  v_cvt_pk_bf16_f32 v77, v14, v15
  v_smfmac_f32_16x16x64_bf16 v[44:47], v[32:35], a[160:167], v3
  v_cvt_pk_bf16_f32 v40, v40, v41
  v_smfmac_f32_16x16x64_bf16 v[48:51], v[24:27], a[200:207], v3
  v_cvt_pk_bf16_f32 v41, v42, v43
  v_smfmac_f32_16x16x64_bf16 v[48:51], v[28:31], a[208:215], v3
  v_smfmac_f32_16x16x64_bf16 v[48:51], v[32:35], a[216:223], v3
  s_waitcnt vmcnt(4)
  v_cvt_pk_bf16_f32 v47, v46, v47
  v_smfmac_f32_16x16x64_bf16 v[68:71], v[76:79], v[80:87], v3
  v_cvt_pk_bf16_f32 v46, v44, v45
  v_mfma_f32_16x16x32_bf16 v[8:11], v[38:41], v[4:7], 0
  s_nop 1
  v_cvt_pk_bf16_f32 v48, v48, v49
  v_cvt_pk_bf16_f32 v49, v50, v51
  s_nop 1
  v_mfma_f32_16x16x32_bf16 v[12:15], v[46:49], v[4:7], 0
  v_smfmac_f32_16x16x64_bf16 v[72:75], v[76:79], v[88:95], v3
  v_cvt_pk_bf16_f32 v16, v8, v9
  v_mfma_f32_16x16x32_bf16 v[52:55], v[30:33], v[76:79], 0
  s_waitcnt vmcnt(0)
  v_cvt_pk_bf16_f32 v17, v10, v11
  v_cvt_pk_bf16_f32 v18, v12, v13
  v_cvt_pk_bf16_f32 v19, v14, v15
  s_nop 1
  v_mfma_f32_16x16x32_bf16 v[52:55], v[20:23], v[16:19], v[52:55]
  v_smfmac_f32_16x16x64_bf16 v[68:71], v[16:19], v[96:103], v3
  v_smfmac_f32_16x16x64_bf16 v[72:75], v[16:19], v[104:111], v3
  s_nop 1
  ds_write_b128 v113, v[52:55]
  s_nop 1
  v_permlane32_swap_b32 v68, v70
  v_permlane32_swap_b32 v69, v71
  v_add_f32 v56, v68, v70
  v_add_f32 v58, v69, v71
  v_permlane32_swap_b32 v72, v74
  v_permlane32_swap_b32 v73, v75
  v_add_f32 v57, v72, v74
  v_add_f32 v59, v73, v75
  ds_write_b128 v2, v[56:59] offset:3072
  v_cmp_u_f32 vcc, v57, v59
  v_mov_b32 v68, 0
  v_mov_b32 v69, 0
  v_mov_b32 v70, 0
  v_mov_b32 v71, 0
  s_cbranch_vccnz cA_sc3_retry
cA_sc3_cont:
  s_add_u32 s24, s24, 28672
  s_add_u32 s26, s26, 28672
  buffer_load_dwordx4 v[80:83], v117, s[8:11], s24 offen offset:0 sc1
  buffer_load_dwordx4 v[84:87], v117, s[8:11], s24 offen offset:1024 sc1
  v_mov_b32 v72, 0
  v_mov_b32 v73, 0
  v_mfma_f32_16x16x32_bf16 v[62:65], v[68:71], v[68:71], 0
  s_waitcnt lgkmcnt(0)
  s_barrier
  v_mov_b32 v52, 0
  v_mov_b32 v53, 0
  v_mov_b32 v54, 0
  v_mov_b32 v55, 0
  v_mov_b32 v56, 0
  v_mov_b32 v57, 0
  v_mov_b32 v58, 0
  v_mov_b32 v59, 0
  v_mfma_f32_32x32x16_bf16 v[36:51], v[68:71], v[68:71], 0
  v_mov_b32 v74, 0
  v_mov_b32 v75, 0
  s_mov_b32 s19, s18
  s_add_u32 s18, s18, 1
  s_mov_b32 s22, s20
  s_mov_b32 s20, s21
  s_mov_b32 s21, s22
  s_add_u32 s23, s20, 4096
  s_cmp_lt_u32 s19, 63
  s_nop 2
  s_cbranch_scc1 cA_sc3_loop
  s_branch cA_done
cA_sc3_r0:
  s_add_u32 s31, s31, 1
  buffer_load_dwordx4 v[8:11], v2, s[8:11], s20 offen offset:0 sc1
  s_waitcnt vmcnt(0)
  v_cmp_eq_u32 vcc, -1, v8
  v_mov_b32 v36, 0
  v_mov_b32 v37, 0
  v_mov_b32 v38, 0
  v_mov_b32 v39, 0
  v_mov_b32 v40, 0
  v_mov_b32 v41, 0
  v_mov_b32 v42, 0
  v_mov_b32 v43, 0
  v_mov_b32 v44, 0
  v_mov_b32 v45, 0
  v_mov_b32 v46, 0
  v_mov_b32 v47, 0
  v_mov_b32 v48, 0
  v_mov_b32 v49, 0
  v_mov_b32 v50, 0
  v_mov_b32 v51, 0
  s_nop 1
  s_cbranch_vccz cA_sc3_go
  s_add_u32 s30, s30, 1
  s_cmp_lt_u32 s30, 400000
  s_cbranch_scc1 cA_sc3_r0
  s_branch cA_abort
cA_sc3_r1:
  s_add_u32 s31, s31, 1
  buffer_load_dwordx4 v[12:15], v2, s[8:11], s20 offen offset:1024 sc1
  s_waitcnt vmcnt(0)
  v_cmp_eq_u32 vcc, -1, v12
  s_nop 4
  s_cbranch_vccz cA_sc3_c1
  s_add_u32 s30, s30, 1
  s_cmp_lt_u32 s30, 400000
  s_cbranch_scc1 cA_sc3_r1
  s_branch cA_abort
cA_sc3_r2:
  s_add_u32 s31, s31, 1
  buffer_load_dwordx4 v[16:19], v2, s[8:11], s20 offen offset:2048 sc1
  s_waitcnt vmcnt(0)
  v_cmp_eq_u32 vcc, -1, v16
  s_nop 4
  s_cbranch_vccz cA_sc3_c2
  s_add_u32 s30, s30, 1
  s_cmp_lt_u32 s30, 400000
  s_cbranch_scc1 cA_sc3_r2
  s_branch cA_abort
cA_sc3_r3:
  s_add_u32 s31, s31, 1
  buffer_load_dwordx4 v[20:23], v2, s[8:11], s20 offen offset:3072 sc1
  s_waitcnt vmcnt(0)
  v_cmp_eq_u32 vcc, -1, v20
  s_nop 4
  s_cbranch_vccz cA_sc3_c3
  s_add_u32 s30, s30, 1
  s_cmp_lt_u32 s30, 400000
  s_cbranch_scc1 cA_sc3_r3
  s_branch cA_abort
cA_sc3_r4:
  s_add_u32 s31, s31, 1
  buffer_load_dwordx4 v[24:27], v2, s[8:11], s23 offen offset:0 sc1
  buffer_load_dwordx4 v[28:31], v2, s[8:11], s23 offen offset:1024 sc1
  buffer_load_dwordx4 v[32:35], v2, s[8:11], s23 offen offset:2048 sc1
  s_waitcnt vmcnt(0)
  v_max3_u32 v66, v24, v27, v28
  v_max3_u32 v66, v66, v31, v32
  v_max_u32 v66, v66, v35
  v_cmp_eq_u32 vcc, -1, v66
  s_nop 4
  s_cbranch_vccz cA_sc3_c4
  s_add_u32 s30, s30, 1
  s_cmp_lt_u32 s30, 400000
  s_cbranch_scc1 cA_sc3_r4
  s_branch cA_abort
cA_sc3_retry:
  s_cmp_lg_u32 s62, 0
  s_cbranch_scc1 cA_sc3_cont
  s_waitcnt vmcnt(0) lgkmcnt(0)
cA_sc3_rv:
  buffer_load_dwordx4 v[8:11], v2, s[8:11], s20 offen offset:0 sc1
  buffer_load_dwordx4 v[12:15], v2, s[8:11], s20 offen offset:1024 sc1
  buffer_load_dwordx4 v[16:19], v2, s[8:11], s20 offen offset:2048 sc1
  buffer_load_dwordx4 v[20:23], v2, s[8:11], s20 offen offset:3072 sc1
  buffer_load_dwordx4 v[24:27], v2, s[8:11], s23 offen offset:0 sc1
  buffer_load_dwordx4 v[28:31], v2, s[8:11], s23 offen offset:1024 sc1
  buffer_load_dwordx4 v[32:35], v2, s[8:11], s23 offen offset:2048 sc1
  s_waitcnt vmcnt(0)
  v_max3_u32 v66, v8, v9, v10
  v_max3_u32 v66, v66, v11, v12
  v_max3_u32 v66, v66, v13, v14
  v_max3_u32 v66, v66, v15, v16
  v_max3_u32 v66, v66, v17, v18
  v_max3_u32 v66, v66, v19, v20
  v_max3_u32 v66, v66, v21, v22
  v_max3_u32 v66, v66, v23, v24
  v_max3_u32 v66, v66, v25, v26
  v_max3_u32 v66, v66, v27, v28
  v_max3_u32 v66, v66, v29, v30
  v_max3_u32 v66, v66, v31, v32
  v_max3_u32 v66, v66, v33, v34
  v_max_u32 v66, v66, v35
  v_cmp_eq_u32 vcc, -1, v66
  s_cbranch_vccz cA_sc3_rk
  s_add_u32 s30, s30, 1
  s_cmp_lt_u32 s30, 400000
  s_cbranch_scc1 cA_sc3_rv
  s_branch cA_abort
cA_sc3_rk:
  s_mov_b32 s62, 1
  v_mov_b32 v36, 0
  v_mov_b32 v37, 0
  v_mov_b32 v38, 0
  v_mov_b32 v39, 0
  v_mov_b32 v40, 0
  v_mov_b32 v41, 0
  v_mov_b32 v42, 0
  v_mov_b32 v43, 0
  v_mov_b32 v44, 0
  v_mov_b32 v45, 0
  v_mov_b32 v46, 0
  v_mov_b32 v47, 0
  v_mov_b32 v48, 0
  v_mov_b32 v49, 0
  v_mov_b32 v50, 0
  v_mov_b32 v51, 0
  v_mov_b32 v62, 0
  v_mov_b32 v63, 0
  v_mov_b32 v64, 0
  v_mov_b32 v65, 0
  v_mov_b32 v68, 0
  v_mov_b32 v69, 0
  v_mov_b32 v70, 0
  v_mov_b32 v71, 0
  v_mov_b32 v72, 0
  v_mov_b32 v73, 0
  v_mov_b32 v74, 0
  v_mov_b32 v75, 0
  v_mov_b32 v52, 0
  v_mov_b32 v53, 0
  v_mov_b32 v54, 0
  v_mov_b32 v55, 0
  v_mov_b32 v56, 0
  v_mov_b32 v57, 0
  v_mov_b32 v58, 0
  v_mov_b32 v59, 0
  s_add_u32 s31, s31, 0x100
  s_nop 0
  s_branch cA_sc3_go
.p2align 6
cA_va0_loop:
  s_mov_b32 s30, 0
  s_barrier
  buffer_load_dwordx4 v[24:27], v2, s[8:11], s23 offen offset:0 sc1
  buffer_load_dwordx4 v[28:31], v2, s[8:11], s23 offen offset:1024 sc1
  s_barrier
  s_cmp_lt_u32 s19, 60
  s_cbranch_scc1 cA_va0_m1
  buffer_store_dword v160, v1, s[8:11], s38 offen sc1
  s_cmp_lg_u32 s19, 63
  s_cbranch_scc1 cA_va0_m2
  v_min_u32 v64, -2, v64
  v_min_u32 v65, -2, v65
  v_min_u32 v66, -2, v66
  v_min_u32 v67, -2, v67
  v_min_u32 v68, -2, v68
  v_min_u32 v69, -2, v69
  v_min_u32 v70, -2, v70
  v_min_u32 v71, -2, v71
  v_min_u32 v72, -2, v72
  v_min_u32 v73, -2, v73
  v_min_u32 v74, -2, v74
  v_min_u32 v75, -2, v75
  v_min_u32 v76, -2, v76
  v_min_u32 v77, -2, v77
  v_min_u32 v78, -2, v78
  v_min_u32 v79, -2, v79
  buffer_store_dwordx4 v[64:67], v2, s[8:11], s33 offen offset:0 sc1
  buffer_store_dwordx4 v[68:71], v2, s[8:11], s33 offen offset:2048 sc1
  s_add_u32 s33, s33, 4096
  buffer_store_dwordx4 v[72:75], v2, s[8:11], s33 offen offset:0 sc1
  buffer_store_dwordx4 v[76:79], v2, s[8:11], s33 offen offset:2048 sc1
  s_add_u32 s33, s33, 4096
  s_waitcnt vmcnt(5)
  s_branch cA_va0_m3
cA_va0_m1:
  buffer_store_dword v160, v1, s[8:11], s38 offen nt
cA_va0_m2:
  s_add_u32 s22, s25, 0
  buffer_load_dwordx4 v[80:83], v6, s[8:11], s22 offen offset:0 sc1
  buffer_load_dwordx4 v[84:87], v6, s[8:11], s22 offen offset:1792 sc1
  s_add_u32 s22, s25, 3584
  buffer_load_dwordx4 v[88:91], v6, s[8:11], s22 offen offset:0 sc1
  buffer_load_dwordx4 v[92:95], v6, s[8:11], s22 offen offset:1792 sc1
  s_add_u32 s22, s25, 7168
  buffer_load_dwordx4 v[96:99], v6, s[8:11], s22 offen offset:0 sc1
  s_mul_i32 s38, s18, 7168
  s_add_u32 s38, s38, 65536
  s_waitcnt vmcnt(6)
cA_va0_m3:
  ds_write_b128 v2, v[24:27] offset:12288
  ds_write_b128 v2, v[28:31] offset:13312
  v_smfmac_f32_16x16x64_bf16 v[36:39], v[24:27], a[32:39], v3
  buffer_load_dwordx4 v[100:103], v6, s[8:11], s22 offen offset:1792 sc1
  v_smfmac_f32_16x16x64_bf16 v[40:43], v[24:27], a[88:95], v3
  s_add_u32 s22, s25, 10752
  buffer_load_dwordx4 v[104:107], v6, s[8:11], s22 offen offset:0 sc1
  v_smfmac_f32_16x16x64_bf16 v[44:47], v[24:27], a[144:151], v3
  buffer_load_dwordx4 v[108:111], v6, s[8:11], s22 offen offset:1792 sc1
  v_smfmac_f32_16x16x64_bf16 v[48:51], v[24:27], a[200:207], v3
  s_add_u32 s22, s25, 14336
  buffer_load_dwordx4 v[112:115], v6, s[8:11], s22 offen offset:0 sc1
  v_smfmac_f32_16x16x64_bf16 v[52:55], v[24:27], v[176:183], v3
  s_waitcnt lgkmcnt(0)
  s_barrier
  ds_read_b128 v[8:11], v2 offset:8192
  ds_read_b128 v[12:15], v2 offset:9216
  ds_read_b128 v[16:19], v2 offset:10240
  ds_read_b128 v[20:23], v2 offset:11264
  ds_read_b128 v[32:35], v2 offset:14336
  buffer_load_dwordx4 v[116:119], v6, s[8:11], s22 offen offset:1792 sc1
  v_smfmac_f32_16x16x64_bf16 v[56:59], v[24:27], v[232:239], v3
  s_add_u32 s22, s25, 17920
  buffer_load_dwordx4 v[120:123], v6, s[8:11], s22 offen offset:0 sc1
  v_smfmac_f32_16x16x64_bf16 v[36:39], v[28:31], a[40:47], v3
  buffer_load_dwordx4 v[124:127], v6, s[8:11], s22 offen offset:1792 sc1
  v_smfmac_f32_16x16x64_bf16 v[40:43], v[28:31], a[96:103], v3
  s_add_u32 s22, s25, 21504
  buffer_load_dwordx4 v[128:131], v6, s[8:11], s22 offen offset:0 sc1
  v_smfmac_f32_16x16x64_bf16 v[44:47], v[28:31], a[152:159], v3
  buffer_load_dwordx4 v[132:135], v6, s[8:11], s22 offen offset:1792 sc1
  v_smfmac_f32_16x16x64_bf16 v[48:51], v[28:31], a[208:215], v3
  s_add_u32 s22, s25, 25088
  buffer_load_dwordx4 v[136:139], v6, s[8:11], s22 offen offset:0 sc1
  v_smfmac_f32_16x16x64_bf16 v[52:55], v[28:31], v[184:191], v3
  buffer_load_dwordx4 v[140:143], v6, s[8:11], s22 offen offset:1792 sc1
  v_smfmac_f32_16x16x64_bf16 v[56:59], v[28:31], v[240:247], v3
  s_waitcnt lgkmcnt(4)
  v_smfmac_f32_16x16x64_bf16 v[36:39], v[8:11], a[0:7], v3
  s_waitcnt lgkmcnt(3)
  v_smfmac_f32_16x16x64_bf16 v[36:39], v[12:15], a[8:15], v3
  s_waitcnt lgkmcnt(2)
  v_smfmac_f32_16x16x64_bf16 v[36:39], v[16:19], a[16:23], v3
  s_waitcnt lgkmcnt(1)
  v_smfmac_f32_16x16x64_bf16 v[36:39], v[20:23], a[24:31], v3
  s_waitcnt lgkmcnt(0)
  v_smfmac_f32_16x16x64_bf16 v[36:39], v[32:35], a[48:55], v3
  v_smfmac_f32_16x16x64_bf16 v[40:43], v[8:11], a[56:63], v3
  v_smfmac_f32_16x16x64_bf16 v[40:43], v[12:15], a[64:71], v3
  v_smfmac_f32_16x16x64_bf16 v[40:43], v[16:19], a[72:79], v3
  v_permlane32_swap_b32 v36, v38
  v_smfmac_f32_16x16x64_bf16 v[40:43], v[20:23], a[80:87], v3
  v_permlane32_swap_b32 v37, v39
  v_smfmac_f32_16x16x64_bf16 v[40:43], v[32:35], a[104:111], v3
  v_add_f32 v36, v36, v38
  v_smfmac_f32_16x16x64_bf16 v[44:47], v[8:11], a[112:119], v3
  v_add_f32 v37, v37, v39
  v_smfmac_f32_16x16x64_bf16 v[44:47], v[12:15], a[120:127], v3
  v_cmp_u_f32 vcc, v36, v37
  v_smfmac_f32_16x16x64_bf16 v[44:47], v[16:19], a[128:135], v3
  v_cvt_pk_bf16_f32 v38, v36, v37
  v_smfmac_f32_16x16x64_bf16 v[44:47], v[20:23], a[136:143], v3
  ds_write_b32 v152, v38
  s_cbranch_vccnz cA_va0_slow
  v_permlane32_swap_b32 v40, v42
  v_smfmac_f32_16x16x64_bf16 v[44:47], v[32:35], a[160:167], v3
  v_permlane32_swap_b32 v41, v43
  v_smfmac_f32_16x16x64_bf16 v[48:51], v[8:11], a[168:175], v3
  buffer_store_dword v162, v1, s[8:11], s21 offen
  v_add_f32 v40, v40, v42
  v_smfmac_f32_16x16x64_bf16 v[48:51], v[12:15], a[176:183], v3
  v_add_f32 v41, v41, v43
  v_smfmac_f32_16x16x64_bf16 v[48:51], v[16:19], a[184:191], v3
  buffer_load_dword v164, v4, s[8:11], 0 offen sc1
  v_cvt_pk_bf16_f32 v42, v40, v41
  v_smfmac_f32_16x16x64_bf16 v[48:51], v[20:23], a[192:199], v3
  ds_write_b32 v153, v42
  v_permlane32_swap_b32 v44, v46
  v_smfmac_f32_16x16x64_bf16 v[48:51], v[32:35], a[216:223], v3
  v_permlane32_swap_b32 v45, v47
  v_smfmac_f32_16x16x64_bf16 v[52:55], v[8:11], a[224:231], v3
  buffer_load_dword v164, v4, s[8:11], 0 offen sc1
  v_add_f32 v44, v44, v46
  v_smfmac_f32_16x16x64_bf16 v[52:55], v[12:15], a[232:239], v3
  v_add_f32 v45, v45, v47
  v_smfmac_f32_16x16x64_bf16 v[52:55], v[16:19], a[240:247], v3
  v_cvt_pk_bf16_f32 v46, v44, v45
  v_smfmac_f32_16x16x64_bf16 v[52:55], v[20:23], a[248:255], v3
  ds_write_b32 v154, v46
  buffer_load_dword v164, v4, s[8:11], 0 offen sc1
  v_permlane32_swap_b32 v48, v50
  v_smfmac_f32_16x16x64_bf16 v[52:55], v[32:35], v[192:199], v3
  v_permlane32_swap_b32 v49, v51
  v_smfmac_f32_16x16x64_bf16 v[56:59], v[8:11], v[200:207], v3
  v_add_f32 v48, v48, v50
  v_smfmac_f32_16x16x64_bf16 v[56:59], v[12:15], v[208:215], v3
  buffer_load_dword v164, v4, s[8:11], 0 offen sc1
  v_add_f32 v49, v49, v51
  v_smfmac_f32_16x16x64_bf16 v[56:59], v[16:19], v[216:223], v3
  v_cvt_pk_bf16_f32 v50, v48, v49
  v_smfmac_f32_16x16x64_bf16 v[56:59], v[20:23], v[224:231], v3
  ds_write_b32 v155, v50
  v_permlane32_swap_b32 v52, v54
  v_smfmac_f32_16x16x64_bf16 v[56:59], v[32:35], v[248:255], v3
  buffer_load_dword v164, v4, s[8:11], 0 offen sc1
  v_permlane32_swap_b32 v53, v55
  v_add_f32 v52, v52, v54
  v_add_f32 v53, v53, v55
  v_cvt_pk_bf16_f32 v54, v52, v53
  ds_write_b32 v156, v54
  s_nop 1
  v_permlane32_swap_b32 v56, v58
  v_permlane32_swap_b32 v57, v59
  v_add_f32 v56, v56, v58
  v_add_f32 v57, v57, v59
  v_cvt_pk_bf16_f32 v58, v56, v57
  ds_write_b32 v157, v58
cA_va0_t2d:
  s_add_u32 s22, s20, 9216
  s_add_u32 s34, s20, 13312
  s_add_u32 s36, s20, 7168
  s_mov_b32 s37, 0
  v_mov_b32 v48, 0
  v_mov_b32 v49, 0
  v_mov_b32 v50, 0
  v_mov_b32 v51, 0
  v_mov_b32 v163, s18
  s_cmp_eq_u32 s19, 63
  s_waitcnt lgkmcnt(0)
  s_cbranch_scc1 cA_va0_last
  s_setprio 3
cA_va0_fw_l:
  v_cmp_gt_u32 vcc, s18, v164
  buffer_load_dword v164, v4, s[8:11], 0 offen sc1
  s_cbranch_vccz cA_va0_fw_d
  v_cmp_gt_u32 vcc, s18, v164
  buffer_load_dword v164, v4, s[8:11], 0 offen sc1
  s_cbranch_vccz cA_va0_fw_d
  v_cmp_gt_u32 vcc, s18, v164
  buffer_load_dword v164, v4, s[8:11], 0 offen sc1
  s_cbranch_vccz cA_va0_fw_d
  v_cmp_gt_u32 vcc, s18, v164
  buffer_load_dword v164, v4, s[8:11], 0 offen sc1
  s_cbranch_vccz cA_va0_fw_d
  v_cmp_gt_u32 vcc, s18, v164
  buffer_load_dword v164, v4, s[8:11], 0 offen sc1
  s_cbranch_vccz cA_va0_fw_d
  v_cmp_gt_u32 vcc, s18, v164
  buffer_load_dword v164, v4, s[8:11], 0 offen sc1
  s_cbranch_vccz cA_va0_fw_d
  v_cmp_gt_u32 vcc, s18, v164
  buffer_load_dword v164, v4, s[8:11], 0 offen sc1
  s_cbranch_vccz cA_va0_fw_d
  v_cmp_gt_u32 vcc, s18, v164
  buffer_load_dword v164, v4, s[8:11], 0 offen sc1
  s_cbranch_vccz cA_va0_fw_d
  v_cmp_gt_u32 vcc, s18, v164
  buffer_load_dword v164, v4, s[8:11], 0 offen sc1
  s_cbranch_vccz cA_va0_fw_d
  v_cmp_gt_u32 vcc, s18, v164
  buffer_load_dword v164, v4, s[8:11], 0 offen sc1
  s_cbranch_vccz cA_va0_fw_d
  v_cmp_gt_u32 vcc, s18, v164
  buffer_load_dword v164, v4, s[8:11], 0 offen sc1
  s_cbranch_vccz cA_va0_fw_d
  v_cmp_gt_u32 vcc, s18, v164
  buffer_load_dword v164, v4, s[8:11], 0 offen sc1
  s_cbranch_vccz cA_va0_fw_d
  v_cmp_gt_u32 vcc, s18, v164
  buffer_load_dword v164, v4, s[8:11], 0 offen sc1
  s_cbranch_vccz cA_va0_fw_d
  v_cmp_gt_u32 vcc, s18, v164
  buffer_load_dword v164, v4, s[8:11], 0 offen sc1
  s_cbranch_vccz cA_va0_fw_d
  v_cmp_gt_u32 vcc, s18, v164
  buffer_load_dword v164, v4, s[8:11], 0 offen sc1
  s_cbranch_vccz cA_va0_fw_d
  v_cmp_gt_u32 vcc, s18, v164
  buffer_load_dword v164, v4, s[8:11], 0 offen sc1
  s_cbranch_vccz cA_va0_fw_d
  s_waitcnt vmcnt(24)
  s_add_u32 s30, s30, 1
  s_cmp_lt_u32 s30, 400000
  s_cbranch_scc1 cA_va0_fw_l
  s_branch cA_abort
cA_va0_fw_d:
  buffer_load_dwordx4 v[8:11], v2, s[8:11], s22 offen offset:0 sc1
  buffer_load_dwordx4 v[12:15], v2, s[8:11], s22 offen offset:1024 sc1
  buffer_load_dwordx4 v[16:19], v2, s[8:11], s22 offen offset:2048 sc1
  buffer_load_dwordx4 v[20:23], v2, s[8:11], s22 offen offset:3072 sc1
  buffer_load_dwordx4 v[24:27], v2, s[8:11], s34 offen offset:0 sc1
  buffer_load_dwordx4 v[28:31], v2, s[8:11], s34 offen offset:1024 sc1
  buffer_load_dwordx4 v[32:35], v2, s[8:11], s34 offen offset:2048 sc1
  buffer_load_dwordx4 v[36:39], v2, s[8:11], s34 offen offset:3072 sc1
  buffer_load_dwordx4 v[40:43], v2, s[8:11], s36 offen offset:0 sc1
  buffer_load_dwordx4 v[44:47], v2, s[8:11], s36 offen offset:1024 sc1
  s_barrier
  ds_read_b128 v[64:67], v2 offset:0
  ds_read_b128 v[68:71], v2 offset:1024
  ds_read_b128 v[72:75], v2 offset:2048
  ds_read_b128 v[76:79], v2 offset:3072
cA_va0_lp:
  s_waitcnt vmcnt(9)
  v_smfmac_f32_16x16x64_bf16 v[48:51], v[8:11], v[80:87], v3
  s_waitcnt vmcnt(8)
  v_smfmac_f32_16x16x64_bf16 v[48:51], v[12:15], v[88:95], v3
  s_waitcnt vmcnt(7)
  v_smfmac_f32_16x16x64_bf16 v[48:51], v[16:19], v[96:103], v3
  s_waitcnt vmcnt(6)
  v_smfmac_f32_16x16x64_bf16 v[48:51], v[20:23], v[104:111], v3
  s_waitcnt vmcnt(5)
  v_smfmac_f32_16x16x64_bf16 v[48:51], v[24:27], v[112:119], v3
  s_waitcnt vmcnt(4)
  v_smfmac_f32_16x16x64_bf16 v[48:51], v[28:31], v[120:127], v3
  s_waitcnt vmcnt(3)
  v_smfmac_f32_16x16x64_bf16 v[48:51], v[32:35], v[128:135], v3
  s_waitcnt vmcnt(2)
  v_smfmac_f32_16x16x64_bf16 v[48:51], v[36:39], v[136:143], v3
  s_waitcnt vmcnt(1) lgkmcnt(0)
  v_smfmac_f32_16x16x64_bf16 v[48:51], v[40:43], v[64:71], v3
  s_waitcnt vmcnt(0)
  v_smfmac_f32_16x16x64_bf16 v[48:51], v[44:47], v[72:79], v3
  s_nop 7
  v_permlane32_swap_b32 v48, v50
  v_permlane32_swap_b32 v49, v51
  v_pk_add_f32 v[48:49], v[48:49], v[50:51]
  v_cvt_pk_bf16_f32 v160, v48, v49
  v_cmp_u_f32 vcc, v48, v49
  s_nop 0
  v_mov_b32_dpp v161, v160 quad_perm:[1,0,3,2] row_mask:0xf bank_mask:0xf
  v_perm_b32 v160, v161, v160, v5
  v_cndmask_b32 v161, v160, v162, vcc
  buffer_store_dword v161, v1, s[8:11], s21 offen
  s_cbranch_vccnz cA_va0_rp
cA_va0_cont:
  s_setprio 0
  s_cmp_lg_u32 s19, 62
  s_cbranch_scc1 cA_va0_nl
  s_sleep 4
  buffer_store_dword v160, v1, s[8:11], s38 offen sc1
  s_mov_b32 s38, 0x40000000
  s_mov_b32 s25, 0x40000000
cA_va0_nl:
  s_add_u32 s25, s25, 458752
  v_mov_b32 v36, 0
  v_mov_b32 v37, 0
  v_mov_b32 v38, 0
  v_mov_b32 v39, 0
  v_mov_b32 v40, 0
  v_mov_b32 v41, 0
  v_mov_b32 v42, 0
  v_mov_b32 v43, 0
  v_mov_b32 v44, 0
  v_mov_b32 v45, 0
  v_mov_b32 v46, 0
  v_mov_b32 v47, 0
  v_mov_b32 v48, 0
  v_mov_b32 v49, 0
  v_mov_b32 v50, 0
  v_mov_b32 v51, 0
  v_mov_b32 v52, 0
  v_mov_b32 v53, 0
  v_mov_b32 v54, 0
  v_mov_b32 v55, 0
  v_mov_b32 v56, 0
  v_mov_b32 v57, 0
  v_mov_b32 v58, 0
  v_mov_b32 v59, 0
  v_mov_b32 v60, 0
  v_mov_b32 v61, 0
  v_mov_b32 v62, 0
  v_mov_b32 v63, 0
  s_mov_b32 s19, s18
  s_add_u32 s18, s18, 1
  s_mov_b32 s22, s20
  s_mov_b32 s20, s21
  s_mov_b32 s21, s22
  s_add_u32 s23, s20, 4096
  s_branch cA_va0_loop
cA_va0_slow:
  s_waitcnt lgkmcnt(0)
cA_va0_sl1:
  s_add_u32 s31, s31, 0x1000000
  buffer_load_dwordx4 v[8:11], v2, s[8:11], s20 offen offset:0 sc1
  buffer_load_dwordx4 v[12:15], v2, s[8:11], s20 offen offset:1024 sc1
  buffer_load_dwordx4 v[16:19], v2, s[8:11], s20 offen offset:2048 sc1
  buffer_load_dwordx4 v[20:23], v2, s[8:11], s20 offen offset:3072 sc1
  buffer_load_dwordx4 v[24:27], v2, s[8:11], s23 offen offset:0 sc1
  buffer_load_dwordx4 v[28:31], v2, s[8:11], s23 offen offset:1024 sc1
  buffer_load_dwordx4 v[32:35], v2, s[8:11], s23 offen offset:2048 sc1
  s_waitcnt vmcnt(0)
  v_max3_u32 v36, v8, v9, v10
  v_max3_u32 v36, v36, v11, v12
  v_max3_u32 v36, v36, v13, v14
  v_max3_u32 v36, v36, v15, v16
  v_max3_u32 v36, v36, v17, v18
  v_max3_u32 v36, v36, v19, v20
  v_max3_u32 v36, v36, v21, v22
  v_max3_u32 v36, v36, v23, v24
  v_max3_u32 v36, v36, v25, v26
  v_max3_u32 v36, v36, v27, v28
  v_max3_u32 v36, v36, v29, v30
  v_max3_u32 v36, v36, v31, v32
  v_max3_u32 v36, v36, v33, v34
  v_max_u32 v36, v36, v35
  v_cmp_eq_u32 vcc, -1, v36
  s_cbranch_vccz cA_va0_sl2
  s_add_u32 s30, s30, 1
  s_cmp_lt_u32 s30, 400000
  s_cbranch_scc1 cA_va0_sl1
  s_branch cA_abort
cA_va0_sl2:
  v_mov_b32 v36, 0
  v_mov_b32 v37, 0
  v_mov_b32 v38, 0
  v_mov_b32 v39, 0
  v_mov_b32 v40, 0
  v_mov_b32 v41, 0
  v_mov_b32 v42, 0
  v_mov_b32 v43, 0
  v_mov_b32 v44, 0
  v_mov_b32 v45, 0
  v_mov_b32 v46, 0
  v_mov_b32 v47, 0
  v_mov_b32 v48, 0
  v_mov_b32 v49, 0
  v_mov_b32 v50, 0
  v_mov_b32 v51, 0
  v_mov_b32 v52, 0
  v_mov_b32 v53, 0
  v_mov_b32 v54, 0
  v_mov_b32 v55, 0
  v_mov_b32 v56, 0
  v_mov_b32 v57, 0
  v_mov_b32 v58, 0
  v_mov_b32 v59, 0
  v_mov_b32 v60, 0
  v_mov_b32 v61, 0
  v_mov_b32 v62, 0
  v_mov_b32 v63, 0
  buffer_store_dword v162, v1, s[8:11], s21 offen
  v_smfmac_f32_16x16x64_bf16 v[36:39], v[8:11], a[0:7], v3
  v_smfmac_f32_16x16x64_bf16 v[40:43], v[8:11], a[56:63], v3
  v_smfmac_f32_16x16x64_bf16 v[44:47], v[8:11], a[112:119], v3
  v_smfmac_f32_16x16x64_bf16 v[48:51], v[8:11], a[168:175], v3
  v_smfmac_f32_16x16x64_bf16 v[52:55], v[8:11], a[224:231], v3
  v_smfmac_f32_16x16x64_bf16 v[56:59], v[8:11], v[200:207], v3
  v_smfmac_f32_16x16x64_bf16 v[36:39], v[12:15], a[8:15], v3
  v_smfmac_f32_16x16x64_bf16 v[40:43], v[12:15], a[64:71], v3
  v_smfmac_f32_16x16x64_bf16 v[44:47], v[12:15], a[120:127], v3
  v_smfmac_f32_16x16x64_bf16 v[48:51], v[12:15], a[176:183], v3
  v_smfmac_f32_16x16x64_bf16 v[52:55], v[12:15], a[232:239], v3
  v_smfmac_f32_16x16x64_bf16 v[56:59], v[12:15], v[208:215], v3
  v_smfmac_f32_16x16x64_bf16 v[36:39], v[16:19], a[16:23], v3
  v_smfmac_f32_16x16x64_bf16 v[40:43], v[16:19], a[72:79], v3
  v_smfmac_f32_16x16x64_bf16 v[44:47], v[16:19], a[128:135], v3
  v_smfmac_f32_16x16x64_bf16 v[48:51], v[16:19], a[184:191], v3
  v_smfmac_f32_16x16x64_bf16 v[52:55], v[16:19], a[240:247], v3
  v_smfmac_f32_16x16x64_bf16 v[56:59], v[16:19], v[216:223], v3
  v_smfmac_f32_16x16x64_bf16 v[36:39], v[20:23], a[24:31], v3
  v_smfmac_f32_16x16x64_bf16 v[40:43], v[20:23], a[80:87], v3
  v_smfmac_f32_16x16x64_bf16 v[44:47], v[20:23], a[136:143], v3
  v_smfmac_f32_16x16x64_bf16 v[48:51], v[20:23], a[192:199], v3
  v_smfmac_f32_16x16x64_bf16 v[52:55], v[20:23], a[248:255], v3
  v_smfmac_f32_16x16x64_bf16 v[56:59], v[20:23], v[224:231], v3
  v_smfmac_f32_16x16x64_bf16 v[36:39], v[24:27], a[32:39], v3
  v_smfmac_f32_16x16x64_bf16 v[40:43], v[24:27], a[88:95], v3
  v_smfmac_f32_16x16x64_bf16 v[44:47], v[24:27], a[144:151], v3
  v_smfmac_f32_16x16x64_bf16 v[48:51], v[24:27], a[200:207], v3
  v_smfmac_f32_16x16x64_bf16 v[52:55], v[24:27], v[176:183], v3
  v_smfmac_f32_16x16x64_bf16 v[56:59], v[24:27], v[232:239], v3
  v_smfmac_f32_16x16x64_bf16 v[36:39], v[28:31], a[40:47], v3
  v_smfmac_f32_16x16x64_bf16 v[40:43], v[28:31], a[96:103], v3
  v_smfmac_f32_16x16x64_bf16 v[44:47], v[28:31], a[152:159], v3
  v_smfmac_f32_16x16x64_bf16 v[48:51], v[28:31], a[208:215], v3
  v_smfmac_f32_16x16x64_bf16 v[52:55], v[28:31], v[184:191], v3
  v_smfmac_f32_16x16x64_bf16 v[56:59], v[28:31], v[240:247], v3
  v_smfmac_f32_16x16x64_bf16 v[36:39], v[32:35], a[48:55], v3
  v_smfmac_f32_16x16x64_bf16 v[40:43], v[32:35], a[104:111], v3
  v_smfmac_f32_16x16x64_bf16 v[44:47], v[32:35], a[160:167], v3
  v_smfmac_f32_16x16x64_bf16 v[48:51], v[32:35], a[216:223], v3
  v_smfmac_f32_16x16x64_bf16 v[52:55], v[32:35], v[192:199], v3
  v_smfmac_f32_16x16x64_bf16 v[56:59], v[32:35], v[248:255], v3
  v_permlane32_swap_b32 v36, v38
  v_permlane32_swap_b32 v37, v39
  v_add_f32 v36, v36, v38
  v_add_f32 v37, v37, v39
  v_cvt_pk_bf16_f32 v38, v36, v37
  ds_write_b32 v152, v38
  v_permlane32_swap_b32 v40, v42
  v_permlane32_swap_b32 v41, v43
  v_add_f32 v40, v40, v42
  v_add_f32 v41, v41, v43
  v_cvt_pk_bf16_f32 v42, v40, v41
  ds_write_b32 v153, v42
  v_permlane32_swap_b32 v44, v46
  v_permlane32_swap_b32 v45, v47
  v_add_f32 v44, v44, v46
  v_add_f32 v45, v45, v47
  v_cvt_pk_bf16_f32 v46, v44, v45
  ds_write_b32 v154, v46
  v_permlane32_swap_b32 v48, v50
  v_permlane32_swap_b32 v49, v51
  v_add_f32 v48, v48, v50
  v_add_f32 v49, v49, v51
  v_cvt_pk_bf16_f32 v50, v48, v49
  ds_write_b32 v155, v50
  v_permlane32_swap_b32 v52, v54
  v_permlane32_swap_b32 v53, v55
  v_add_f32 v52, v52, v54
  v_add_f32 v53, v53, v55
  v_cvt_pk_bf16_f32 v54, v52, v53
  ds_write_b32 v156, v54
  v_permlane32_swap_b32 v56, v58
  v_permlane32_swap_b32 v57, v59
  v_add_f32 v56, v56, v58
  v_add_f32 v57, v57, v59
  v_cvt_pk_bf16_f32 v58, v56, v57
  ds_write_b32 v157, v58
  buffer_load_dword v164, v4, s[8:11], 0 offen sc1
  buffer_load_dword v164, v4, s[8:11], 0 offen sc1
  buffer_load_dword v164, v4, s[8:11], 0 offen sc1
  buffer_load_dword v164, v4, s[8:11], 0 offen sc1
  buffer_load_dword v164, v4, s[8:11], 0 offen sc1
  s_branch cA_va0_t2d
cA_va0_last:
  s_barrier
  ds_read_b128 v[64:67], v2 offset:0
  ds_read_b128 v[68:71], v2 offset:1024
  ds_read_b128 v[72:75], v2 offset:2048
  ds_read_b128 v[76:79], v2 offset:3072
  s_waitcnt lgkmcnt(0)
  v_min_u32 v64, -2, v64
  v_min_u32 v65, -2, v65
  v_min_u32 v66, -2, v66
  v_min_u32 v67, -2, v67
  v_min_u32 v68, -2, v68
  v_min_u32 v69, -2, v69
  v_min_u32 v70, -2, v70
  v_min_u32 v71, -2, v71
  v_min_u32 v72, -2, v72
  v_min_u32 v73, -2, v73
  v_min_u32 v74, -2, v74
  v_min_u32 v75, -2, v75
  v_min_u32 v76, -2, v76
  v_min_u32 v77, -2, v77
  v_min_u32 v78, -2, v78
  v_min_u32 v79, -2, v79
  buffer_store_dwordx4 v[64:67], v2, s[8:11], s33 offen offset:0 sc1
  buffer_store_dwordx4 v[68:71], v2, s[8:11], s33 offen offset:2048 sc1
  s_add_u32 s33, s33, 4096
  buffer_store_dwordx4 v[72:75], v2, s[8:11], s33 offen offset:0 sc1
  buffer_store_dwordx4 v[76:79], v2, s[8:11], s33 offen offset:2048 sc1
  s_add_u32 s33, s33, 4096
  s_waitcnt vmcnt(0)
  buffer_wbl2 sc1
  s_branch cA_done
cA_va0_rp:
  s_cmp_eq_u32 s37, 0
  s_cbranch_scc1 cA_va0_rv
  v_min_u32 v160, -2, v160
  buffer_store_dword v160, v1, s[8:11], s21 offen
  s_branch cA_va0_cont
cA_va0_rv:
  s_add_u32 s31, s31, 0x10000
  buffer_load_dwordx4 v[8:11], v2, s[8:11], s22 offen offset:0 sc1
  buffer_load_dwordx4 v[12:15], v2, s[8:11], s22 offen offset:1024 sc1
  buffer_load_dwordx4 v[16:19], v2, s[8:11], s22 offen offset:2048 sc1
  buffer_load_dwordx4 v[20:23], v2, s[8:11], s22 offen offset:3072 sc1
  buffer_load_dwordx4 v[24:27], v2, s[8:11], s34 offen offset:0 sc1
  buffer_load_dwordx4 v[28:31], v2, s[8:11], s34 offen offset:1024 sc1
  buffer_load_dwordx4 v[32:35], v2, s[8:11], s34 offen offset:2048 sc1
  buffer_load_dwordx4 v[36:39], v2, s[8:11], s34 offen offset:3072 sc1
  buffer_load_dwordx4 v[40:43], v2, s[8:11], s36 offen offset:0 sc1
  buffer_load_dwordx4 v[44:47], v2, s[8:11], s36 offen offset:1024 sc1
  s_waitcnt vmcnt(0)
  v_max3_u32 v52, v8, v9, v10
  v_max3_u32 v52, v52, v11, v12
  v_max3_u32 v52, v52, v13, v14
  v_max3_u32 v52, v52, v15, v16
  v_max3_u32 v52, v52, v17, v18
  v_max3_u32 v52, v52, v19, v20
  v_max3_u32 v52, v52, v21, v22
  v_max3_u32 v52, v52, v23, v24
  v_max3_u32 v52, v52, v25, v26
  v_max3_u32 v52, v52, v27, v28
  v_max3_u32 v52, v52, v29, v30
  v_max3_u32 v52, v52, v31, v32
  v_max3_u32 v52, v52, v33, v34
  v_max3_u32 v52, v52, v35, v36
  v_max3_u32 v52, v52, v37, v38
  v_max3_u32 v52, v52, v39, v40
  v_max3_u32 v52, v52, v41, v42
  v_max3_u32 v52, v52, v43, v44
  v_max3_u32 v52, v52, v45, v46
  v_max_u32 v52, v52, v47
  v_cmp_eq_u32 vcc, -1, v52
  s_mov_b32 s37, 1
  v_mov_b32 v48, 0
  v_mov_b32 v49, 0
  v_mov_b32 v50, 0
  v_mov_b32 v51, 0
  s_nop 1
  s_cbranch_vccz cA_va0_lp
  s_add_u32 s30, s30, 1
  s_cmp_lt_u32 s30, 400000
  s_cbranch_scc1 cA_va0_rv
  s_branch cA_abort
.p2align 6
cA_va1_loop:
  s_mov_b32 s30, 0
  s_barrier
  buffer_load_dwordx4 v[28:31], v2, s[8:11], s23 offen offset:1024 sc1
  buffer_load_dwordx4 v[32:35], v2, s[8:11], s23 offen offset:2048 sc1
  s_barrier
  s_cmp_lt_u32 s19, 60
  s_cbranch_scc1 cA_va1_m1
  buffer_store_dword v160, v1, s[8:11], s38 offen sc1
  s_cmp_lg_u32 s19, 63
  s_cbranch_scc1 cA_va1_m2
  v_min_u32 v64, -2, v64
  v_min_u32 v65, -2, v65
  v_min_u32 v66, -2, v66
  v_min_u32 v67, -2, v67
  v_min_u32 v68, -2, v68
  v_min_u32 v69, -2, v69
  v_min_u32 v70, -2, v70
  v_min_u32 v71, -2, v71
  v_min_u32 v72, -2, v72
  v_min_u32 v73, -2, v73
  v_min_u32 v74, -2, v74
  v_min_u32 v75, -2, v75
  v_min_u32 v76, -2, v76
  v_min_u32 v77, -2, v77
  v_min_u32 v78, -2, v78
  v_min_u32 v79, -2, v79
  buffer_store_dwordx4 v[64:67], v2, s[8:11], s33 offen offset:0 sc1
  buffer_store_dwordx4 v[68:71], v2, s[8:11], s33 offen offset:2048 sc1
  s_add_u32 s33, s33, 4096
  buffer_store_dwordx4 v[72:75], v2, s[8:11], s33 offen offset:0 sc1
  buffer_store_dwordx4 v[76:79], v2, s[8:11], s33 offen offset:2048 sc1
  s_add_u32 s33, s33, 4096
  s_waitcnt vmcnt(5)
  s_branch cA_va1_m3
cA_va1_m1:
  buffer_store_dword v160, v1, s[8:11], s38 offen nt
cA_va1_m2:
  s_add_u32 s22, s25, 0
  buffer_load_dwordx4 v[80:83], v6, s[8:11], s22 offen offset:0 sc1
  buffer_load_dwordx4 v[84:87], v6, s[8:11], s22 offen offset:1792 sc1
  s_add_u32 s22, s25, 3584
  buffer_load_dwordx4 v[88:91], v6, s[8:11], s22 offen offset:0 sc1
  buffer_load_dwordx4 v[92:95], v6, s[8:11], s22 offen offset:1792 sc1
  s_add_u32 s22, s25, 7168
  buffer_load_dwordx4 v[96:99], v6, s[8:11], s22 offen offset:0 sc1
  s_mul_i32 s38, s18, 7168
  s_add_u32 s38, s38, 65536
  s_waitcnt vmcnt(6)
cA_va1_m3:
  ds_write_b128 v2, v[32:35] offset:14336
  v_smfmac_f32_16x16x64_bf16 v[36:39], v[28:31], a[40:47], v3
  buffer_load_dwordx4 v[100:103], v6, s[8:11], s22 offen offset:1792 sc1
  v_smfmac_f32_16x16x64_bf16 v[40:43], v[28:31], a[96:103], v3
  s_add_u32 s22, s25, 10752
  buffer_load_dwordx4 v[104:107], v6, s[8:11], s22 offen offset:0 sc1
  v_smfmac_f32_16x16x64_bf16 v[44:47], v[28:31], a[152:159], v3
  buffer_load_dwordx4 v[108:111], v6, s[8:11], s22 offen offset:1792 sc1
  v_smfmac_f32_16x16x64_bf16 v[48:51], v[28:31], a[208:215], v3
  s_add_u32 s22, s25, 14336
  buffer_load_dwordx4 v[112:115], v6, s[8:11], s22 offen offset:0 sc1
  v_smfmac_f32_16x16x64_bf16 v[52:55], v[28:31], v[184:191], v3
  s_waitcnt lgkmcnt(0)
  s_barrier
  ds_read_b128 v[8:11], v2 offset:8192
  ds_read_b128 v[12:15], v2 offset:9216
  ds_read_b128 v[16:19], v2 offset:10240
  ds_read_b128 v[20:23], v2 offset:11264
  ds_read_b128 v[24:27], v2 offset:12288
  buffer_load_dwordx4 v[116:119], v6, s[8:11], s22 offen offset:1792 sc1
  v_smfmac_f32_16x16x64_bf16 v[56:59], v[28:31], v[240:247], v3
  s_add_u32 s22, s25, 17920
  buffer_load_dwordx4 v[120:123], v6, s[8:11], s22 offen offset:0 sc1
  v_smfmac_f32_16x16x64_bf16 v[36:39], v[32:35], a[48:55], v3
  buffer_load_dwordx4 v[124:127], v6, s[8:11], s22 offen offset:1792 sc1
  v_smfmac_f32_16x16x64_bf16 v[40:43], v[32:35], a[104:111], v3
  s_add_u32 s22, s25, 21504
  buffer_load_dwordx4 v[128:131], v6, s[8:11], s22 offen offset:0 sc1
  v_smfmac_f32_16x16x64_bf16 v[44:47], v[32:35], a[160:167], v3
  buffer_load_dwordx4 v[132:135], v6, s[8:11], s22 offen offset:1792 sc1
  v_smfmac_f32_16x16x64_bf16 v[48:51], v[32:35], a[216:223], v3
  s_add_u32 s22, s25, 25088
  buffer_load_dwordx4 v[136:139], v6, s[8:11], s22 offen offset:0 sc1
  v_smfmac_f32_16x16x64_bf16 v[52:55], v[32:35], v[192:199], v3
  ds_read_b128 v[64:67], v0 offset:0
  ds_read_b128 v[68:71], v0 offset:1024
  buffer_load_dwordx4 v[140:143], v6, s[8:11], s22 offen offset:1792 sc1
  v_smfmac_f32_16x16x64_bf16 v[56:59], v[32:35], v[248:255], v3
  s_waitcnt lgkmcnt(6)
  ds_read_b128 v[72:75], v0 offset:2048
  ds_read_b128 v[76:79], v0 offset:3072
  v_smfmac_f32_16x16x64_bf16 v[36:39], v[8:11], a[0:7], v3
  s_waitcnt lgkmcnt(7)
  v_smfmac_f32_16x16x64_bf16 v[36:39], v[12:15], a[8:15], v3
  s_waitcnt lgkmcnt(6)
  v_smfmac_f32_16x16x64_bf16 v[36:39], v[16:19], a[16:23], v3
  s_waitcnt lgkmcnt(2)
  v_smfmac_f32_16x16x64_bf16 v[60:63], v[8:11], v[64:71], v3
  s_waitcnt lgkmcnt(5)
  ds_read_b128 v[144:147], v0 offset:4096
  ds_read_b128 v[148:151], v0 offset:5120
  v_smfmac_f32_16x16x64_bf16 v[36:39], v[20:23], a[24:31], v3
  s_waitcnt lgkmcnt(6)
  v_smfmac_f32_16x16x64_bf16 v[36:39], v[24:27], a[32:39], v3
  v_smfmac_f32_16x16x64_bf16 v[40:43], v[8:11], a[56:63], v3
  s_waitcnt lgkmcnt(2)
  v_smfmac_f32_16x16x64_bf16 v[60:63], v[12:15], v[72:79], v3
  ds_read_b128 v[64:67], v0 offset:6144
  ds_read_b128 v[68:71], v0 offset:7168
  v_smfmac_f32_16x16x64_bf16 v[40:43], v[12:15], a[64:71], v3
  v_permlane32_swap_b32 v36, v38
  v_smfmac_f32_16x16x64_bf16 v[40:43], v[16:19], a[72:79], v3
  v_permlane32_swap_b32 v37, v39
  v_smfmac_f32_16x16x64_bf16 v[40:43], v[20:23], a[80:87], v3
  s_waitcnt lgkmcnt(2)
  v_add_f32 v36, v36, v38
  v_smfmac_f32_16x16x64_bf16 v[60:63], v[16:19], v[144:151], v3
  ds_read_b128 v[72:75], v0 offset:8192
  ds_read_b128 v[76:79], v0 offset:9216
  v_add_f32 v37, v37, v39
  v_smfmac_f32_16x16x64_bf16 v[40:43], v[24:27], a[88:95], v3
  v_cmp_u_f32 vcc, v36, v37
  v_smfmac_f32_16x16x64_bf16 v[44:47], v[8:11], a[112:119], v3
  v_cvt_pk_bf16_f32 v38, v36, v37
  v_smfmac_f32_16x16x64_bf16 v[44:47], v[12:15], a[120:127], v3
  ds_write_b32 v152, v38
  s_waitcnt lgkmcnt(3)
  s_cbranch_vccnz cA_va1_slow
  v_permlane32_swap_b32 v40, v42
  v_smfmac_f32_16x16x64_bf16 v[60:63], v[20:23], v[64:71], v3
  ds_read_b128 v[144:147], v0 offset:10240
  ds_read_b128 v[148:151], v0 offset:11264
  v_permlane32_swap_b32 v41, v43
  v_smfmac_f32_16x16x64_bf16 v[44:47], v[16:19], a[128:135], v3
  buffer_store_dword v162, v1, s[8:11], s21 offen
  v_add_f32 v40, v40, v42
  v_smfmac_f32_16x16x64_bf16 v[44:47], v[20:23], a[136:143], v3
  v_add_f32 v41, v41, v43
  v_smfmac_f32_16x16x64_bf16 v[44:47], v[24:27], a[144:151], v3
  s_waitcnt lgkmcnt(3)
  v_cvt_pk_bf16_f32 v42, v40, v41
  v_smfmac_f32_16x16x64_bf16 v[60:63], v[24:27], v[72:79], v3
  ds_write_b32 v153, v42
  ds_read_b128 v[64:67], v0 offset:12288
  ds_read_b128 v[68:71], v0 offset:13312
  v_smfmac_f32_16x16x64_bf16 v[48:51], v[8:11], a[168:175], v3
  s_nop 0
  v_permlane32_swap_b32 v44, v46
  v_smfmac_f32_16x16x64_bf16 v[48:51], v[12:15], a[176:183], v3
  v_permlane32_swap_b32 v45, v47
  v_smfmac_f32_16x16x64_bf16 v[48:51], v[16:19], a[184:191], v3
  s_waitcnt lgkmcnt(3)
  v_add_f32 v44, v44, v46
  v_smfmac_f32_16x16x64_bf16 v[60:63], v[28:31], v[144:151], v3
  v_add_f32 v45, v45, v47
  v_smfmac_f32_16x16x64_bf16 v[48:51], v[20:23], a[192:199], v3
  v_cvt_pk_bf16_f32 v46, v44, v45
  v_smfmac_f32_16x16x64_bf16 v[48:51], v[24:27], a[200:207], v3
  ds_write_b32 v154, v46
  v_smfmac_f32_16x16x64_bf16 v[52:55], v[8:11], a[224:231], v3
  s_waitcnt lgkmcnt(1)
  v_smfmac_f32_16x16x64_bf16 v[60:63], v[32:35], v[64:71], v3
  v_smfmac_f32_16x16x64_bf16 v[52:55], v[12:15], a[232:239], v3
  v_permlane32_swap_b32 v48, v50
  v_smfmac_f32_16x16x64_bf16 v[52:55], v[16:19], a[240:247], v3
  v_permlane32_swap_b32 v49, v51
  v_smfmac_f32_16x16x64_bf16 v[52:55], v[20:23], a[248:255], v3
  v_add_f32 v48, v48, v50
  v_smfmac_f32_16x16x64_bf16 v[52:55], v[24:27], v[176:183], v3
  v_add_f32 v49, v49, v51
  v_smfmac_f32_16x16x64_bf16 v[56:59], v[8:11], v[200:207], v3
  v_cvt_pk_bf16_f32 v50, v48, v49
  v_smfmac_f32_16x16x64_bf16 v[56:59], v[12:15], v[208:215], v3
  ds_write_b32 v155, v50
  v_permlane32_swap_b32 v60, v62
  v_smfmac_f32_16x16x64_bf16 v[56:59], v[16:19], v[216:223], v3
  v_permlane32_swap_b32 v61, v63
  v_smfmac_f32_16x16x64_bf16 v[56:59], v[20:23], v[224:231], v3
  v_add_f32 v60, v60, v62
  v_smfmac_f32_16x16x64_bf16 v[56:59], v[24:27], v[232:239], v3
  v_add_f32 v61, v61, v63
  v_cvt_pk_bf16_f32 v62, v60, v61
  ds_write_b32 v158, v62
  v_permlane32_swap_b32 v52, v54
  v_permlane32_swap_b32 v53, v55
  v_add_f32 v52, v52, v54
  v_add_f32 v53, v53, v55
  v_cvt_pk_bf16_f32 v54, v52, v53
  ds_write_b32 v156, v54
  v_permlane32_swap_b32 v56, v58
  v_permlane32_swap_b32 v57, v59
  v_add_f32 v56, v56, v58
  v_add_f32 v57, v57, v59
  v_cvt_pk_bf16_f32 v58, v56, v57
  ds_write_b32 v157, v58
cA_va1_t2d:
  s_add_u32 s22, s20, 9216
  s_add_u32 s34, s20, 13312
  s_add_u32 s36, s20, 7168
  s_mov_b32 s37, 0
  v_mov_b32 v48, 0
  v_mov_b32 v49, 0
  v_mov_b32 v50, 0
  v_mov_b32 v51, 0
  v_mov_b32 v163, s18
  s_cmp_eq_u32 s19, 63
  s_waitcnt lgkmcnt(0)
  s_cbranch_scc1 cA_va1_last
  s_barrier
  buffer_load_dwordx4 v[8:11], v2, s[8:11], s22 offen offset:0 sc1
  buffer_load_dwordx4 v[12:15], v2, s[8:11], s22 offen offset:1024 sc1
  buffer_load_dwordx4 v[16:19], v2, s[8:11], s22 offen offset:2048 sc1
  buffer_load_dwordx4 v[20:23], v2, s[8:11], s22 offen offset:3072 sc1
  buffer_load_dwordx4 v[24:27], v2, s[8:11], s34 offen offset:0 sc1
  buffer_load_dwordx4 v[28:31], v2, s[8:11], s34 offen offset:1024 sc1
  buffer_load_dwordx4 v[32:35], v2, s[8:11], s34 offen offset:2048 sc1
  buffer_load_dwordx4 v[36:39], v2, s[8:11], s34 offen offset:3072 sc1
  buffer_load_dwordx4 v[40:43], v2, s[8:11], s36 offen offset:0 sc1
  buffer_load_dwordx4 v[44:47], v2, s[8:11], s36 offen offset:1024 sc1
  ds_read_b128 v[64:67], v2 offset:4096
  ds_read_b128 v[68:71], v2 offset:5120
  ds_read_b128 v[72:75], v2 offset:6144
  ds_read_b128 v[76:79], v2 offset:7168
cA_va1_lp:
  s_waitcnt vmcnt(9)
  v_smfmac_f32_16x16x64_bf16 v[48:51], v[8:11], v[80:87], v3
  s_waitcnt vmcnt(8)
  v_smfmac_f32_16x16x64_bf16 v[48:51], v[12:15], v[88:95], v3
  s_waitcnt vmcnt(7)
  v_smfmac_f32_16x16x64_bf16 v[48:51], v[16:19], v[96:103], v3
  v_max3_u32 v55, v8, v12, v16
  s_waitcnt vmcnt(6)
  v_smfmac_f32_16x16x64_bf16 v[48:51], v[20:23], v[104:111], v3
  v_max_u32 v55, v55, v20
  v_cmp_eq_u32 vcc, -1, v55
  s_waitcnt vmcnt(5)
  v_smfmac_f32_16x16x64_bf16 v[48:51], v[24:27], v[112:119], v3
  s_waitcnt vmcnt(4)
  v_smfmac_f32_16x16x64_bf16 v[48:51], v[28:31], v[120:127], v3
  s_cbranch_vccnz cA_va1_rv
  buffer_store_dword v163, v7, s[8:11], 0 offen
  s_waitcnt vmcnt(4)
  v_smfmac_f32_16x16x64_bf16 v[48:51], v[32:35], v[128:135], v3
  s_waitcnt vmcnt(3)
  v_smfmac_f32_16x16x64_bf16 v[48:51], v[36:39], v[136:143], v3
  s_waitcnt vmcnt(2) lgkmcnt(0)
  v_smfmac_f32_16x16x64_bf16 v[48:51], v[40:43], v[64:71], v3
  s_waitcnt vmcnt(1)
  v_smfmac_f32_16x16x64_bf16 v[48:51], v[44:47], v[72:79], v3
  s_nop 7
  v_permlane32_swap_b32 v48, v50
  v_permlane32_swap_b32 v49, v51
  v_pk_add_f32 v[48:49], v[48:49], v[50:51]
  v_cvt_pk_bf16_f32 v160, v48, v49
  v_cmp_u_f32 vcc, v48, v49
  s_nop 0
  v_mov_b32_dpp v161, v160 quad_perm:[1,0,3,2] row_mask:0xf bank_mask:0xf
  v_perm_b32 v160, v161, v160, v5
  v_cndmask_b32 v161, v160, v162, vcc
  buffer_store_dword v161, v1, s[8:11], s21 offen
  s_cbranch_vccnz cA_va1_rp
cA_va1_cont:
  s_cmp_lg_u32 s19, 62
  s_cbranch_scc1 cA_va1_nl
  buffer_store_dword v160, v1, s[8:11], s38 offen sc1
  s_mov_b32 s38, 0x40000000
  s_mov_b32 s25, 0x40000000
cA_va1_nl:
  s_add_u32 s25, s25, 458752
  v_mov_b32 v36, 0
  v_mov_b32 v37, 0
  v_mov_b32 v38, 0
  v_mov_b32 v39, 0
  v_mov_b32 v40, 0
  v_mov_b32 v41, 0
  v_mov_b32 v42, 0
  v_mov_b32 v43, 0
  v_mov_b32 v44, 0
  v_mov_b32 v45, 0
  v_mov_b32 v46, 0
  v_mov_b32 v47, 0
  v_mov_b32 v48, 0
  v_mov_b32 v49, 0
  v_mov_b32 v50, 0
  v_mov_b32 v51, 0
  v_mov_b32 v52, 0
  v_mov_b32 v53, 0
  v_mov_b32 v54, 0
  v_mov_b32 v55, 0
  v_mov_b32 v56, 0
  v_mov_b32 v57, 0
  v_mov_b32 v58, 0
  v_mov_b32 v59, 0
  v_mov_b32 v60, 0
  v_mov_b32 v61, 0
  v_mov_b32 v62, 0
  v_mov_b32 v63, 0
  s_mov_b32 s19, s18
  s_add_u32 s18, s18, 1
  s_mov_b32 s22, s20
  s_mov_b32 s20, s21
  s_mov_b32 s21, s22
  s_add_u32 s23, s20, 4096
  s_branch cA_va1_loop
cA_va1_slow:
  s_waitcnt lgkmcnt(0)
cA_va1_sl1:
  s_add_u32 s31, s31, 0x1000000
  buffer_load_dwordx4 v[8:11], v2, s[8:11], s20 offen offset:0 sc1
  buffer_load_dwordx4 v[12:15], v2, s[8:11], s20 offen offset:1024 sc1
  buffer_load_dwordx4 v[16:19], v2, s[8:11], s20 offen offset:2048 sc1
  buffer_load_dwordx4 v[20:23], v2, s[8:11], s20 offen offset:3072 sc1
  buffer_load_dwordx4 v[24:27], v2, s[8:11], s23 offen offset:0 sc1
  buffer_load_dwordx4 v[28:31], v2, s[8:11], s23 offen offset:1024 sc1
  buffer_load_dwordx4 v[32:35], v2, s[8:11], s23 offen offset:2048 sc1
  s_waitcnt vmcnt(0)
  v_max3_u32 v36, v8, v9, v10
  v_max3_u32 v36, v36, v11, v12
  v_max3_u32 v36, v36, v13, v14
  v_max3_u32 v36, v36, v15, v16
  v_max3_u32 v36, v36, v17, v18
  v_max3_u32 v36, v36, v19, v20
  v_max3_u32 v36, v36, v21, v22
  v_max3_u32 v36, v36, v23, v24
  v_max3_u32 v36, v36, v25, v26
  v_max3_u32 v36, v36, v27, v28
  v_max3_u32 v36, v36, v29, v30
  v_max3_u32 v36, v36, v31, v32
  v_max3_u32 v36, v36, v33, v34
  v_max_u32 v36, v36, v35
  v_cmp_eq_u32 vcc, -1, v36
  s_cbranch_vccz cA_va1_sl2
  s_add_u32 s30, s30, 1
  s_cmp_lt_u32 s30, 400000
  s_cbranch_scc1 cA_va1_sl1
  s_branch cA_abort
cA_va1_sl2:
  v_mov_b32 v36, 0
  v_mov_b32 v37, 0
  v_mov_b32 v38, 0
  v_mov_b32 v39, 0
  v_mov_b32 v40, 0
  v_mov_b32 v41, 0
  v_mov_b32 v42, 0
  v_mov_b32 v43, 0
  v_mov_b32 v44, 0
  v_mov_b32 v45, 0
  v_mov_b32 v46, 0
  v_mov_b32 v47, 0
  v_mov_b32 v48, 0
  v_mov_b32 v49, 0
  v_mov_b32 v50, 0
  v_mov_b32 v51, 0
  v_mov_b32 v52, 0
  v_mov_b32 v53, 0
  v_mov_b32 v54, 0
  v_mov_b32 v55, 0
  v_mov_b32 v56, 0
  v_mov_b32 v57, 0
  v_mov_b32 v58, 0
  v_mov_b32 v59, 0
  v_mov_b32 v60, 0
  v_mov_b32 v61, 0
  v_mov_b32 v62, 0
  v_mov_b32 v63, 0
  buffer_store_dword v162, v1, s[8:11], s21 offen
  ds_read_b128 v[64:67], v0 offset:0
  ds_read_b128 v[68:71], v0 offset:1024
  v_smfmac_f32_16x16x64_bf16 v[36:39], v[8:11], a[0:7], v3
  v_smfmac_f32_16x16x64_bf16 v[40:43], v[8:11], a[56:63], v3
  v_smfmac_f32_16x16x64_bf16 v[44:47], v[8:11], a[112:119], v3
  v_smfmac_f32_16x16x64_bf16 v[48:51], v[8:11], a[168:175], v3
  v_smfmac_f32_16x16x64_bf16 v[52:55], v[8:11], a[224:231], v3
  v_smfmac_f32_16x16x64_bf16 v[56:59], v[8:11], v[200:207], v3
  s_waitcnt lgkmcnt(0)
  v_smfmac_f32_16x16x64_bf16 v[60:63], v[8:11], v[64:71], v3
  ds_read_b128 v[72:75], v0 offset:2048
  ds_read_b128 v[76:79], v0 offset:3072
  v_smfmac_f32_16x16x64_bf16 v[36:39], v[12:15], a[8:15], v3
  v_smfmac_f32_16x16x64_bf16 v[40:43], v[12:15], a[64:71], v3
  v_smfmac_f32_16x16x64_bf16 v[44:47], v[12:15], a[120:127], v3
  v_smfmac_f32_16x16x64_bf16 v[48:51], v[12:15], a[176:183], v3
  v_smfmac_f32_16x16x64_bf16 v[52:55], v[12:15], a[232:239], v3
  v_smfmac_f32_16x16x64_bf16 v[56:59], v[12:15], v[208:215], v3
  s_waitcnt lgkmcnt(0)
  v_smfmac_f32_16x16x64_bf16 v[60:63], v[12:15], v[72:79], v3
  ds_read_b128 v[144:147], v0 offset:4096
  ds_read_b128 v[148:151], v0 offset:5120
  v_smfmac_f32_16x16x64_bf16 v[36:39], v[16:19], a[16:23], v3
  v_smfmac_f32_16x16x64_bf16 v[40:43], v[16:19], a[72:79], v3
  v_smfmac_f32_16x16x64_bf16 v[44:47], v[16:19], a[128:135], v3
  v_smfmac_f32_16x16x64_bf16 v[48:51], v[16:19], a[184:191], v3
  v_smfmac_f32_16x16x64_bf16 v[52:55], v[16:19], a[240:247], v3
  v_smfmac_f32_16x16x64_bf16 v[56:59], v[16:19], v[216:223], v3
  s_waitcnt lgkmcnt(0)
  v_smfmac_f32_16x16x64_bf16 v[60:63], v[16:19], v[144:151], v3
  ds_read_b128 v[64:67], v0 offset:6144
  ds_read_b128 v[68:71], v0 offset:7168
  v_smfmac_f32_16x16x64_bf16 v[36:39], v[20:23], a[24:31], v3
  v_smfmac_f32_16x16x64_bf16 v[40:43], v[20:23], a[80:87], v3
  v_smfmac_f32_16x16x64_bf16 v[44:47], v[20:23], a[136:143], v3
  v_smfmac_f32_16x16x64_bf16 v[48:51], v[20:23], a[192:199], v3
  v_smfmac_f32_16x16x64_bf16 v[52:55], v[20:23], a[248:255], v3
  v_smfmac_f32_16x16x64_bf16 v[56:59], v[20:23], v[224:231], v3
  s_waitcnt lgkmcnt(0)
  v_smfmac_f32_16x16x64_bf16 v[60:63], v[20:23], v[64:71], v3
  ds_read_b128 v[72:75], v0 offset:8192
  ds_read_b128 v[76:79], v0 offset:9216
  v_smfmac_f32_16x16x64_bf16 v[36:39], v[24:27], a[32:39], v3
  v_smfmac_f32_16x16x64_bf16 v[40:43], v[24:27], a[88:95], v3
  v_smfmac_f32_16x16x64_bf16 v[44:47], v[24:27], a[144:151], v3
  v_smfmac_f32_16x16x64_bf16 v[48:51], v[24:27], a[200:207], v3
  v_smfmac_f32_16x16x64_bf16 v[52:55], v[24:27], v[176:183], v3
  v_smfmac_f32_16x16x64_bf16 v[56:59], v[24:27], v[232:239], v3
  s_waitcnt lgkmcnt(0)
  v_smfmac_f32_16x16x64_bf16 v[60:63], v[24:27], v[72:79], v3
  ds_read_b128 v[144:147], v0 offset:10240
  ds_read_b128 v[148:151], v0 offset:11264
  v_smfmac_f32_16x16x64_bf16 v[36:39], v[28:31], a[40:47], v3
  v_smfmac_f32_16x16x64_bf16 v[40:43], v[28:31], a[96:103], v3
  v_smfmac_f32_16x16x64_bf16 v[44:47], v[28:31], a[152:159], v3
  v_smfmac_f32_16x16x64_bf16 v[48:51], v[28:31], a[208:215], v3
  v_smfmac_f32_16x16x64_bf16 v[52:55], v[28:31], v[184:191], v3
  v_smfmac_f32_16x16x64_bf16 v[56:59], v[28:31], v[240:247], v3
  s_waitcnt lgkmcnt(0)
  v_smfmac_f32_16x16x64_bf16 v[60:63], v[28:31], v[144:151], v3
  ds_read_b128 v[64:67], v0 offset:12288
  ds_read_b128 v[68:71], v0 offset:13312
  v_smfmac_f32_16x16x64_bf16 v[36:39], v[32:35], a[48:55], v3
  v_smfmac_f32_16x16x64_bf16 v[40:43], v[32:35], a[104:111], v3
  v_smfmac_f32_16x16x64_bf16 v[44:47], v[32:35], a[160:167], v3
  v_smfmac_f32_16x16x64_bf16 v[48:51], v[32:35], a[216:223], v3
  v_smfmac_f32_16x16x64_bf16 v[52:55], v[32:35], v[192:199], v3
  v_smfmac_f32_16x16x64_bf16 v[56:59], v[32:35], v[248:255], v3
  s_waitcnt lgkmcnt(0)
  v_smfmac_f32_16x16x64_bf16 v[60:63], v[32:35], v[64:71], v3
  v_permlane32_swap_b32 v36, v38
  v_permlane32_swap_b32 v37, v39
  v_add_f32 v36, v36, v38
  v_add_f32 v37, v37, v39
  v_cvt_pk_bf16_f32 v38, v36, v37
  ds_write_b32 v152, v38
  v_permlane32_swap_b32 v40, v42
  v_permlane32_swap_b32 v41, v43
  v_add_f32 v40, v40, v42
  v_add_f32 v41, v41, v43
  v_cvt_pk_bf16_f32 v42, v40, v41
  ds_write_b32 v153, v42
  v_permlane32_swap_b32 v44, v46
  v_permlane32_swap_b32 v45, v47
  v_add_f32 v44, v44, v46
  v_add_f32 v45, v45, v47
  v_cvt_pk_bf16_f32 v46, v44, v45
  ds_write_b32 v154, v46
  v_permlane32_swap_b32 v48, v50
  v_permlane32_swap_b32 v49, v51
  v_add_f32 v48, v48, v50
  v_add_f32 v49, v49, v51
  v_cvt_pk_bf16_f32 v50, v48, v49
  ds_write_b32 v155, v50
  v_permlane32_swap_b32 v52, v54
  v_permlane32_swap_b32 v53, v55
  v_add_f32 v52, v52, v54
  v_add_f32 v53, v53, v55
  v_cvt_pk_bf16_f32 v54, v52, v53
  ds_write_b32 v156, v54
  v_permlane32_swap_b32 v56, v58
  v_permlane32_swap_b32 v57, v59
  v_add_f32 v56, v56, v58
  v_add_f32 v57, v57, v59
  v_cvt_pk_bf16_f32 v58, v56, v57
  ds_write_b32 v157, v58
  v_permlane32_swap_b32 v60, v62
  v_permlane32_swap_b32 v61, v63
  v_add_f32 v60, v60, v62
  v_add_f32 v61, v61, v63
  v_cvt_pk_bf16_f32 v62, v60, v61
  ds_write_b32 v158, v62
  s_branch cA_va1_t2d
cA_va1_last:
  s_barrier
  ds_read_b128 v[64:67], v2 offset:4096
  ds_read_b128 v[68:71], v2 offset:5120
  ds_read_b128 v[72:75], v2 offset:6144
  ds_read_b128 v[76:79], v2 offset:7168
  s_waitcnt lgkmcnt(0)
  v_min_u32 v64, -2, v64
  v_min_u32 v65, -2, v65
  v_min_u32 v66, -2, v66
  v_min_u32 v67, -2, v67
  v_min_u32 v68, -2, v68
  v_min_u32 v69, -2, v69
  v_min_u32 v70, -2, v70
  v_min_u32 v71, -2, v71
  v_min_u32 v72, -2, v72
  v_min_u32 v73, -2, v73
  v_min_u32 v74, -2, v74
  v_min_u32 v75, -2, v75
  v_min_u32 v76, -2, v76
  v_min_u32 v77, -2, v77
  v_min_u32 v78, -2, v78
  v_min_u32 v79, -2, v79
  buffer_store_dwordx4 v[64:67], v2, s[8:11], s33 offen offset:0 sc1
  buffer_store_dwordx4 v[68:71], v2, s[8:11], s33 offen offset:2048 sc1
  s_add_u32 s33, s33, 4096
  buffer_store_dwordx4 v[72:75], v2, s[8:11], s33 offen offset:0 sc1
  buffer_store_dwordx4 v[76:79], v2, s[8:11], s33 offen offset:2048 sc1
  s_add_u32 s33, s33, 4096
  s_waitcnt vmcnt(0)
  buffer_wbl2 sc1
  s_branch cA_done
cA_va1_rp:
  s_cmp_eq_u32 s37, 0
  s_cbranch_scc1 cA_va1_rv
  v_min_u32 v160, -2, v160
  buffer_store_dword v160, v1, s[8:11], s21 offen
  s_branch cA_va1_cont
cA_va1_rv:
  s_add_u32 s31, s31, 0x10000
  buffer_load_dwordx4 v[8:11], v2, s[8:11], s22 offen offset:0 sc1
  buffer_load_dwordx4 v[12:15], v2, s[8:11], s22 offen offset:1024 sc1
  buffer_load_dwordx4 v[16:19], v2, s[8:11], s22 offen offset:2048 sc1
  buffer_load_dwordx4 v[20:23], v2, s[8:11], s22 offen offset:3072 sc1
  buffer_load_dwordx4 v[24:27], v2, s[8:11], s34 offen offset:0 sc1
  buffer_load_dwordx4 v[28:31], v2, s[8:11], s34 offen offset:1024 sc1
  buffer_load_dwordx4 v[32:35], v2, s[8:11], s34 offen offset:2048 sc1
  buffer_load_dwordx4 v[36:39], v2, s[8:11], s34 offen offset:3072 sc1
  buffer_load_dwordx4 v[40:43], v2, s[8:11], s36 offen offset:0 sc1
  buffer_load_dwordx4 v[44:47], v2, s[8:11], s36 offen offset:1024 sc1
  s_waitcnt vmcnt(0)
  v_max3_u32 v52, v8, v9, v10
  v_max3_u32 v52, v52, v11, v12
  v_max3_u32 v52, v52, v13, v14
  v_max3_u32 v52, v52, v15, v16
  v_max3_u32 v52, v52, v17, v18
  v_max3_u32 v52, v52, v19, v20
  v_max3_u32 v52, v52, v21, v22
  v_max3_u32 v52, v52, v23, v24
  v_max3_u32 v52, v52, v25, v26
  v_max3_u32 v52, v52, v27, v28
  v_max3_u32 v52, v52, v29, v30
  v_max3_u32 v52, v52, v31, v32
  v_max3_u32 v52, v52, v33, v34
  v_max3_u32 v52, v52, v35, v36
  v_max3_u32 v52, v52, v37, v38
  v_max3_u32 v52, v52, v39, v40
  v_max3_u32 v52, v52, v41, v42
  v_max3_u32 v52, v52, v43, v44
  v_max3_u32 v52, v52, v45, v46
  v_max_u32 v52, v52, v47
  v_cmp_eq_u32 vcc, -1, v52
  s_mov_b32 s37, 1
  v_mov_b32 v48, 0
  v_mov_b32 v49, 0
  v_mov_b32 v50, 0
  v_mov_b32 v51, 0
  s_nop 1
  s_cbranch_vccz cA_va1_lp
  s_add_u32 s30, s30, 1
  s_cmp_lt_u32 s30, 400000
  s_cbranch_scc1 cA_va1_rv
  s_branch cA_abort
.p2align 6
cA_va2_loop:
  s_mov_b32 s30, 0
cA_va2_fp_l:
  v_cmp_gt_u32 vcc, s19, v96
  buffer_load_dword v96, v119, s[8:11], 0 offen sc1
  s_cbranch_vccz cA_va2_fp_d
  v_cmp_gt_u32 vcc, s19, v96
  buffer_load_dword v96, v119, s[8:11], 0 offen sc1
  s_cbranch_vccz cA_va2_fp_d
  v_cmp_gt_u32 vcc, s19, v96
  buffer_load_dword v96, v119, s[8:11], 0 offen sc1
  s_cbranch_vccz cA_va2_fp_d
  v_cmp_gt_u32 vcc, s19, v96
  buffer_load_dword v96, v119, s[8:11], 0 offen sc1
  s_cbranch_vccz cA_va2_fp_d
  v_cmp_gt_u32 vcc, s19, v96
  buffer_load_dword v96, v119, s[8:11], 0 offen sc1
  s_cbranch_vccz cA_va2_fp_d
  v_cmp_gt_u32 vcc, s19, v96
  buffer_load_dword v96, v119, s[8:11], 0 offen sc1
  s_cbranch_vccz cA_va2_fp_d
  v_cmp_gt_u32 vcc, s19, v96
  buffer_load_dword v96, v119, s[8:11], 0 offen sc1
  s_cbranch_vccz cA_va2_fp_d
  v_cmp_gt_u32 vcc, s19, v96
  buffer_load_dword v96, v119, s[8:11], 0 offen sc1
  s_cbranch_vccz cA_va2_fp_d
  v_cmp_gt_u32 vcc, s19, v96
  buffer_load_dword v96, v119, s[8:11], 0 offen sc1
  s_cbranch_vccz cA_va2_fp_d
  v_cmp_gt_u32 vcc, s19, v96
  buffer_load_dword v96, v119, s[8:11], 0 offen sc1
  s_cbranch_vccz cA_va2_fp_d
  v_cmp_gt_u32 vcc, s19, v96
  buffer_load_dword v96, v119, s[8:11], 0 offen sc1
  s_cbranch_vccz cA_va2_fp_d
  v_cmp_gt_u32 vcc, s19, v96
  buffer_load_dword v96, v119, s[8:11], 0 offen sc1
  s_cbranch_vccz cA_va2_fp_d
  v_cmp_gt_u32 vcc, s19, v96
  buffer_load_dword v96, v119, s[8:11], 0 offen sc1
  s_cbranch_vccz cA_va2_fp_d
  v_cmp_gt_u32 vcc, s19, v96
  buffer_load_dword v96, v119, s[8:11], 0 offen sc1
  s_cbranch_vccz cA_va2_fp_d
  v_cmp_gt_u32 vcc, s19, v96
  buffer_load_dword v96, v119, s[8:11], 0 offen sc1
  s_cbranch_vccz cA_va2_fp_d
  v_cmp_gt_u32 vcc, s19, v96
  buffer_load_dword v96, v119, s[8:11], 0 offen sc1
  s_cbranch_vccz cA_va2_fp_d
  s_waitcnt vmcnt(24)
  s_add_u32 s30, s30, 1
  s_cmp_lt_u32 s30, 400000
  s_cbranch_scc1 cA_va2_fp_l
  s_branch cA_abort
cA_va2_fp_d:
  buffer_load_dwordx4 v[8:11], v2, s[8:11], s20 offen offset:0 sc1
  buffer_load_dwordx4 v[12:15], v2, s[8:11], s20 offen offset:1024 sc1
  s_barrier
  s_barrier
  s_waitcnt vmcnt(0)
  ds_write_b128 v2, v[8:11] offset:8192
  ds_write_b128 v2, v[12:15] offset:9216
  v_smfmac_f32_16x16x64_bf16 v[36:39], v[8:11], a[0:7], v3
  v_smfmac_f32_16x16x64_bf16 v[40:43], v[8:11], a[56:63], v3
  v_smfmac_f32_16x16x64_bf16 v[44:47], v[8:11], a[112:119], v3
  v_smfmac_f32_16x16x64_bf16 v[48:51], v[8:11], a[168:175], v3
  v_smfmac_f32_16x16x64_bf16 v[52:55], v[8:11], a[224:231], v3
  s_waitcnt lgkmcnt(0)
  s_barrier
  ds_read_b128 v[16:19], v2 offset:10240
  ds_read_b128 v[20:23], v2 offset:11264
  ds_read_b128 v[24:27], v2 offset:12288
  ds_read_b128 v[28:31], v2 offset:13312
  ds_read_b128 v[32:35], v2 offset:14336
  v_smfmac_f32_16x16x64_bf16 v[56:59], v[8:11], v[144:151], v3
  v_smfmac_f32_16x16x64_bf16 v[60:63], v[8:11], v[200:207], v3
  v_smfmac_f32_16x16x64_bf16 v[36:39], v[12:15], a[8:15], v3
  v_smfmac_f32_16x16x64_bf16 v[40:43], v[12:15], a[64:71], v3
  v_smfmac_f32_16x16x64_bf16 v[44:47], v[12:15], a[120:127], v3
  v_smfmac_f32_16x16x64_bf16 v[48:51], v[12:15], a[176:183], v3
  v_smfmac_f32_16x16x64_bf16 v[52:55], v[12:15], a[232:239], v3
  v_smfmac_f32_16x16x64_bf16 v[56:59], v[12:15], v[152:159], v3
  ds_read_b128 v[68:71], v0 offset:0
  ds_read_b128 v[72:75], v0 offset:1024
  v_smfmac_f32_16x16x64_bf16 v[60:63], v[12:15], v[208:215], v3
  s_waitcnt lgkmcnt(6)
  ds_read_b128 v[76:79], v0 offset:2048
  ds_read_b128 v[80:83], v0 offset:3072
  v_smfmac_f32_16x16x64_bf16 v[36:39], v[16:19], a[16:23], v3
  s_waitcnt lgkmcnt(7)
  v_smfmac_f32_16x16x64_bf16 v[36:39], v[20:23], a[24:31], v3
  s_waitcnt lgkmcnt(6)
  v_smfmac_f32_16x16x64_bf16 v[36:39], v[24:27], a[32:39], v3
  s_waitcnt lgkmcnt(2)
  v_smfmac_f32_16x16x64_bf16 v[64:67], v[8:11], v[68:75], v3
  s_waitcnt lgkmcnt(5)
  ds_read_b128 v[84:87], v0 offset:4096
  ds_read_b128 v[88:91], v0 offset:5120
  v_smfmac_f32_16x16x64_bf16 v[36:39], v[28:31], a[40:47], v3
  s_waitcnt lgkmcnt(6)
  v_smfmac_f32_16x16x64_bf16 v[36:39], v[32:35], a[48:55], v3
  v_smfmac_f32_16x16x64_bf16 v[40:43], v[16:19], a[72:79], v3
  s_waitcnt lgkmcnt(2)
  v_smfmac_f32_16x16x64_bf16 v[64:67], v[12:15], v[76:83], v3
  ds_read_b128 v[68:71], v0 offset:6144
  ds_read_b128 v[72:75], v0 offset:7168
  v_smfmac_f32_16x16x64_bf16 v[40:43], v[20:23], a[80:87], v3
  v_permlane32_swap_b32 v36, v38
  v_smfmac_f32_16x16x64_bf16 v[40:43], v[24:27], a[88:95], v3
  v_permlane32_swap_b32 v37, v39
  v_smfmac_f32_16x16x64_bf16 v[40:43], v[28:31], a[96:103], v3
  s_waitcnt lgkmcnt(2)
  v_add_f32 v36, v36, v38
  v_smfmac_f32_16x16x64_bf16 v[64:67], v[16:19], v[84:91], v3
  ds_read_b128 v[76:79], v0 offset:8192
  ds_read_b128 v[80:83], v0 offset:9216
  v_add_f32 v37, v37, v39
  v_smfmac_f32_16x16x64_bf16 v[40:43], v[32:35], a[104:111], v3
  v_cmp_u_f32 vcc, v36, v37
  v_smfmac_f32_16x16x64_bf16 v[44:47], v[16:19], a[128:135], v3
  v_cvt_pk_bf16_f32 v38, v36, v37
  v_smfmac_f32_16x16x64_bf16 v[44:47], v[20:23], a[136:143], v3
  ds_write_b32 v104, v38
  s_waitcnt lgkmcnt(3)
  s_cbranch_vccnz cA_va2_slow
  v_permlane32_swap_b32 v40, v42
  v_smfmac_f32_16x16x64_bf16 v[64:67], v[20:23], v[68:75], v3
  ds_read_b128 v[84:87], v0 offset:10240
  ds_read_b128 v[88:91], v0 offset:11264
  v_permlane32_swap_b32 v41, v43
  v_smfmac_f32_16x16x64_bf16 v[44:47], v[24:27], a[144:151], v3
  v_add_f32 v40, v40, v42
  v_smfmac_f32_16x16x64_bf16 v[44:47], v[28:31], a[152:159], v3
  v_add_f32 v41, v41, v43
  v_smfmac_f32_16x16x64_bf16 v[44:47], v[32:35], a[160:167], v3
  s_waitcnt lgkmcnt(3)
  v_cvt_pk_bf16_f32 v42, v40, v41
  v_smfmac_f32_16x16x64_bf16 v[64:67], v[24:27], v[76:83], v3
  ds_write_b32 v105, v42
  ds_read_b128 v[68:71], v0 offset:12288
  ds_read_b128 v[72:75], v0 offset:13312
  v_smfmac_f32_16x16x64_bf16 v[48:51], v[16:19], a[184:191], v3
  s_nop 0
  v_permlane32_swap_b32 v44, v46
  v_smfmac_f32_16x16x64_bf16 v[48:51], v[20:23], a[192:199], v3
  v_permlane32_swap_b32 v45, v47
  v_smfmac_f32_16x16x64_bf16 v[48:51], v[24:27], a[200:207], v3
  s_waitcnt lgkmcnt(3)
  v_add_f32 v44, v44, v46
  v_smfmac_f32_16x16x64_bf16 v[64:67], v[28:31], v[84:91], v3
  v_add_f32 v45, v45, v47
  v_smfmac_f32_16x16x64_bf16 v[48:51], v[28:31], a[208:215], v3
  v_cvt_pk_bf16_f32 v46, v44, v45
  v_smfmac_f32_16x16x64_bf16 v[48:51], v[32:35], a[216:223], v3
  ds_write_b32 v106, v46
  v_smfmac_f32_16x16x64_bf16 v[52:55], v[16:19], a[240:247], v3
  s_waitcnt lgkmcnt(1)
  v_smfmac_f32_16x16x64_bf16 v[64:67], v[32:35], v[68:75], v3
  v_smfmac_f32_16x16x64_bf16 v[52:55], v[20:23], a[248:255], v3
  v_permlane32_swap_b32 v48, v50
  v_smfmac_f32_16x16x64_bf16 v[52:55], v[24:27], v[120:127], v3
  v_permlane32_swap_b32 v49, v51
  v_smfmac_f32_16x16x64_bf16 v[52:55], v[28:31], v[128:135], v3
  v_add_f32 v48, v48, v50
  v_smfmac_f32_16x16x64_bf16 v[52:55], v[32:35], v[136:143], v3
  v_add_f32 v49, v49, v51
  v_smfmac_f32_16x16x64_bf16 v[56:59], v[16:19], v[160:167], v3
  v_cvt_pk_bf16_f32 v50, v48, v49
  v_smfmac_f32_16x16x64_bf16 v[56:59], v[20:23], v[168:175], v3
  ds_write_b32 v107, v50
  v_permlane32_swap_b32 v64, v66
  v_smfmac_f32_16x16x64_bf16 v[56:59], v[24:27], v[176:183], v3
  v_permlane32_swap_b32 v65, v67
  v_smfmac_f32_16x16x64_bf16 v[56:59], v[28:31], v[184:191], v3
  v_add_f32 v64, v64, v66
  v_smfmac_f32_16x16x64_bf16 v[56:59], v[32:35], v[192:199], v3
  v_add_f32 v65, v65, v67
  v_smfmac_f32_16x16x64_bf16 v[60:63], v[16:19], v[216:223], v3
  v_cvt_pk_bf16_f32 v66, v64, v65
  v_smfmac_f32_16x16x64_bf16 v[60:63], v[20:23], v[224:231], v3
  ds_write_b32 v111, v66
  v_permlane32_swap_b32 v52, v54
  v_smfmac_f32_16x16x64_bf16 v[60:63], v[24:27], v[232:239], v3
  v_permlane32_swap_b32 v53, v55
  v_smfmac_f32_16x16x64_bf16 v[60:63], v[28:31], v[240:247], v3
  v_add_f32 v52, v52, v54
  v_smfmac_f32_16x16x64_bf16 v[60:63], v[32:35], v[248:255], v3
  v_add_f32 v53, v53, v55
  v_cvt_pk_bf16_f32 v54, v52, v53
  ds_write_b32 v108, v54
  v_permlane32_swap_b32 v56, v58
  v_permlane32_swap_b32 v57, v59
  v_add_f32 v56, v56, v58
  v_add_f32 v57, v57, v59
  v_cvt_pk_bf16_f32 v58, v56, v57
  ds_write_b32 v109, v58
  v_permlane32_swap_b32 v60, v62
  v_permlane32_swap_b32 v61, v63
  v_add_f32 v60, v60, v62
  v_add_f32 v61, v61, v63
  v_cvt_pk_bf16_f32 v62, v60, v61
  ds_write_b32 v110, v62
cA_va2_t2d:
  v_mov_b32 v117, s18
  s_waitcnt lgkmcnt(0)
  s_barrier
  s_cmp_eq_u32 s19, 63
  s_cbranch_scc1 cA_done
  s_sleep 1
  v_mov_b32 v36, 0
  v_mov_b32 v37, 0
  v_mov_b32 v38, 0
  v_mov_b32 v39, 0
  v_mov_b32 v40, 0
  v_mov_b32 v41, 0
  v_mov_b32 v42, 0
  v_mov_b32 v43, 0
  v_mov_b32 v44, 0
  v_mov_b32 v45, 0
  v_mov_b32 v46, 0
  v_mov_b32 v47, 0
  v_mov_b32 v48, 0
  v_mov_b32 v49, 0
  v_mov_b32 v50, 0
  v_mov_b32 v51, 0
  v_mov_b32 v52, 0
  v_mov_b32 v53, 0
  v_mov_b32 v54, 0
  v_mov_b32 v55, 0
  v_mov_b32 v56, 0
  v_mov_b32 v57, 0
  v_mov_b32 v58, 0
  v_mov_b32 v59, 0
  v_mov_b32 v60, 0
  v_mov_b32 v61, 0
  v_mov_b32 v62, 0
  v_mov_b32 v63, 0
  v_mov_b32 v64, 0
  v_mov_b32 v65, 0
  v_mov_b32 v66, 0
  v_mov_b32 v67, 0
  s_sleep 5
  s_mov_b32 s19, s18
  s_add_u32 s18, s18, 1
  s_mov_b32 s22, s20
  s_mov_b32 s20, s21
  s_mov_b32 s21, s22
  s_add_u32 s23, s20, 4096
  s_branch cA_va2_loop
cA_va2_slow:
  s_waitcnt lgkmcnt(0)
cA_va2_sl1:
  s_add_u32 s31, s31, 0x1000000
  buffer_load_dwordx4 v[8:11], v2, s[8:11], s20 offen offset:0 sc1
  buffer_load_dwordx4 v[12:15], v2, s[8:11], s20 offen offset:1024 sc1
  buffer_load_dwordx4 v[16:19], v2, s[8:11], s20 offen offset:2048 sc1
  buffer_load_dwordx4 v[20:23], v2, s[8:11], s20 offen offset:3072 sc1
  buffer_load_dwordx4 v[24:27], v2, s[8:11], s23 offen offset:0 sc1
  buffer_load_dwordx4 v[28:31], v2, s[8:11], s23 offen offset:1024 sc1
  buffer_load_dwordx4 v[32:35], v2, s[8:11], s23 offen offset:2048 sc1
  s_waitcnt vmcnt(0)
  v_max3_u32 v36, v8, v9, v10
  v_max3_u32 v36, v36, v11, v12
  v_max3_u32 v36, v36, v13, v14
  v_max3_u32 v36, v36, v15, v16
  v_max3_u32 v36, v36, v17, v18
  v_max3_u32 v36, v36, v19, v20
  v_max3_u32 v36, v36, v21, v22
  v_max3_u32 v36, v36, v23, v24
  v_max3_u32 v36, v36, v25, v26
  v_max3_u32 v36, v36, v27, v28
  v_max3_u32 v36, v36, v29, v30
  v_max3_u32 v36, v36, v31, v32
  v_max3_u32 v36, v36, v33, v34
  v_max_u32 v36, v36, v35
  v_cmp_eq_u32 vcc, -1, v36
  s_cbranch_vccz cA_va2_sl2
  s_add_u32 s30, s30, 1
  s_cmp_lt_u32 s30, 400000
  s_cbranch_scc1 cA_va2_sl1
  s_branch cA_abort
cA_va2_sl2:
  v_mov_b32 v36, 0
  v_mov_b32 v37, 0
  v_mov_b32 v38, 0
  v_mov_b32 v39, 0
  v_mov_b32 v40, 0
  v_mov_b32 v41, 0
  v_mov_b32 v42, 0
  v_mov_b32 v43, 0
  v_mov_b32 v44, 0
  v_mov_b32 v45, 0
  v_mov_b32 v46, 0
  v_mov_b32 v47, 0
  v_mov_b32 v48, 0
  v_mov_b32 v49, 0
  v_mov_b32 v50, 0
  v_mov_b32 v51, 0
  v_mov_b32 v52, 0
  v_mov_b32 v53, 0
  v_mov_b32 v54, 0
  v_mov_b32 v55, 0
  v_mov_b32 v56, 0
  v_mov_b32 v57, 0
  v_mov_b32 v58, 0
  v_mov_b32 v59, 0
  v_mov_b32 v60, 0
  v_mov_b32 v61, 0
  v_mov_b32 v62, 0
  v_mov_b32 v63, 0
  v_mov_b32 v64, 0
  v_mov_b32 v65, 0
  v_mov_b32 v66, 0
  v_mov_b32 v67, 0
  ds_read_b128 v[68:71], v0 offset:0
  ds_read_b128 v[72:75], v0 offset:1024
  v_smfmac_f32_16x16x64_bf16 v[36:39], v[8:11], a[0:7], v3
  v_smfmac_f32_16x16x64_bf16 v[40:43], v[8:11], a[56:63], v3
  v_smfmac_f32_16x16x64_bf16 v[44:47], v[8:11], a[112:119], v3
  v_smfmac_f32_16x16x64_bf16 v[48:51], v[8:11], a[168:175], v3
  v_smfmac_f32_16x16x64_bf16 v[52:55], v[8:11], a[224:231], v3
  v_smfmac_f32_16x16x64_bf16 v[56:59], v[8:11], v[144:151], v3
  v_smfmac_f32_16x16x64_bf16 v[60:63], v[8:11], v[200:207], v3
  s_waitcnt lgkmcnt(0)
  v_smfmac_f32_16x16x64_bf16 v[64:67], v[8:11], v[68:75], v3
  ds_read_b128 v[76:79], v0 offset:2048
  ds_read_b128 v[80:83], v0 offset:3072
  v_smfmac_f32_16x16x64_bf16 v[36:39], v[12:15], a[8:15], v3
  v_smfmac_f32_16x16x64_bf16 v[40:43], v[12:15], a[64:71], v3
  v_smfmac_f32_16x16x64_bf16 v[44:47], v[12:15], a[120:127], v3
  v_smfmac_f32_16x16x64_bf16 v[48:51], v[12:15], a[176:183], v3
  v_smfmac_f32_16x16x64_bf16 v[52:55], v[12:15], a[232:239], v3
  v_smfmac_f32_16x16x64_bf16 v[56:59], v[12:15], v[152:159], v3
  v_smfmac_f32_16x16x64_bf16 v[60:63], v[12:15], v[208:215], v3
  s_waitcnt lgkmcnt(0)
  v_smfmac_f32_16x16x64_bf16 v[64:67], v[12:15], v[76:83], v3
  ds_read_b128 v[84:87], v0 offset:4096
  ds_read_b128 v[88:91], v0 offset:5120
  v_smfmac_f32_16x16x64_bf16 v[36:39], v[16:19], a[16:23], v3
  v_smfmac_f32_16x16x64_bf16 v[40:43], v[16:19], a[72:79], v3
  v_smfmac_f32_16x16x64_bf16 v[44:47], v[16:19], a[128:135], v3
  v_smfmac_f32_16x16x64_bf16 v[48:51], v[16:19], a[184:191], v3
  v_smfmac_f32_16x16x64_bf16 v[52:55], v[16:19], a[240:247], v3
  v_smfmac_f32_16x16x64_bf16 v[56:59], v[16:19], v[160:167], v3
  v_smfmac_f32_16x16x64_bf16 v[60:63], v[16:19], v[216:223], v3
  s_waitcnt lgkmcnt(0)
  v_smfmac_f32_16x16x64_bf16 v[64:67], v[16:19], v[84:91], v3
  ds_read_b128 v[68:71], v0 offset:6144
  ds_read_b128 v[72:75], v0 offset:7168
  v_smfmac_f32_16x16x64_bf16 v[36:39], v[20:23], a[24:31], v3
  v_smfmac_f32_16x16x64_bf16 v[40:43], v[20:23], a[80:87], v3
  v_smfmac_f32_16x16x64_bf16 v[44:47], v[20:23], a[136:143], v3
  v_smfmac_f32_16x16x64_bf16 v[48:51], v[20:23], a[192:199], v3
  v_smfmac_f32_16x16x64_bf16 v[52:55], v[20:23], a[248:255], v3
  v_smfmac_f32_16x16x64_bf16 v[56:59], v[20:23], v[168:175], v3
  v_smfmac_f32_16x16x64_bf16 v[60:63], v[20:23], v[224:231], v3
  s_waitcnt lgkmcnt(0)
  v_smfmac_f32_16x16x64_bf16 v[64:67], v[20:23], v[68:75], v3
  ds_read_b128 v[76:79], v0 offset:8192
  ds_read_b128 v[80:83], v0 offset:9216
  v_smfmac_f32_16x16x64_bf16 v[36:39], v[24:27], a[32:39], v3
  v_smfmac_f32_16x16x64_bf16 v[40:43], v[24:27], a[88:95], v3
  v_smfmac_f32_16x16x64_bf16 v[44:47], v[24:27], a[144:151], v3
  v_smfmac_f32_16x16x64_bf16 v[48:51], v[24:27], a[200:207], v3
  v_smfmac_f32_16x16x64_bf16 v[52:55], v[24:27], v[120:127], v3
  v_smfmac_f32_16x16x64_bf16 v[56:59], v[24:27], v[176:183], v3
  v_smfmac_f32_16x16x64_bf16 v[60:63], v[24:27], v[232:239], v3
  s_waitcnt lgkmcnt(0)
  v_smfmac_f32_16x16x64_bf16 v[64:67], v[24:27], v[76:83], v3
  ds_read_b128 v[84:87], v0 offset:10240
  ds_read_b128 v[88:91], v0 offset:11264
  v_smfmac_f32_16x16x64_bf16 v[36:39], v[28:31], a[40:47], v3
  v_smfmac_f32_16x16x64_bf16 v[40:43], v[28:31], a[96:103], v3
  v_smfmac_f32_16x16x64_bf16 v[44:47], v[28:31], a[152:159], v3
  v_smfmac_f32_16x16x64_bf16 v[48:51], v[28:31], a[208:215], v3
  v_smfmac_f32_16x16x64_bf16 v[52:55], v[28:31], v[128:135], v3
  v_smfmac_f32_16x16x64_bf16 v[56:59], v[28:31], v[184:191], v3
  v_smfmac_f32_16x16x64_bf16 v[60:63], v[28:31], v[240:247], v3
  s_waitcnt lgkmcnt(0)
  v_smfmac_f32_16x16x64_bf16 v[64:67], v[28:31], v[84:91], v3
  ds_read_b128 v[68:71], v0 offset:12288
  ds_read_b128 v[72:75], v0 offset:13312
  v_smfmac_f32_16x16x64_bf16 v[36:39], v[32:35], a[48:55], v3
  v_smfmac_f32_16x16x64_bf16 v[40:43], v[32:35], a[104:111], v3
  v_smfmac_f32_16x16x64_bf16 v[44:47], v[32:35], a[160:167], v3
  v_smfmac_f32_16x16x64_bf16 v[48:51], v[32:35], a[216:223], v3
  v_smfmac_f32_16x16x64_bf16 v[52:55], v[32:35], v[136:143], v3
  v_smfmac_f32_16x16x64_bf16 v[56:59], v[32:35], v[192:199], v3
  v_smfmac_f32_16x16x64_bf16 v[60:63], v[32:35], v[248:255], v3
  s_waitcnt lgkmcnt(0)
  v_smfmac_f32_16x16x64_bf16 v[64:67], v[32:35], v[68:75], v3
  v_permlane32_swap_b32 v36, v38
  v_permlane32_swap_b32 v37, v39
  v_add_f32 v36, v36, v38
  v_add_f32 v37, v37, v39
  v_cvt_pk_bf16_f32 v38, v36, v37
  ds_write_b32 v104, v38
  v_permlane32_swap_b32 v40, v42
  v_permlane32_swap_b32 v41, v43
  v_add_f32 v40, v40, v42
  v_add_f32 v41, v41, v43
  v_cvt_pk_bf16_f32 v42, v40, v41
  ds_write_b32 v105, v42
  v_permlane32_swap_b32 v44, v46
  v_permlane32_swap_b32 v45, v47
  v_add_f32 v44, v44, v46
  v_add_f32 v45, v45, v47
  v_cvt_pk_bf16_f32 v46, v44, v45
  ds_write_b32 v106, v46
  v_permlane32_swap_b32 v48, v50
  v_permlane32_swap_b32 v49, v51
  v_add_f32 v48, v48, v50
  v_add_f32 v49, v49, v51
  v_cvt_pk_bf16_f32 v50, v48, v49
  ds_write_b32 v107, v50
  v_permlane32_swap_b32 v52, v54
  v_permlane32_swap_b32 v53, v55
  v_add_f32 v52, v52, v54
  v_add_f32 v53, v53, v55
  v_cvt_pk_bf16_f32 v54, v52, v53
  ds_write_b32 v108, v54
  v_permlane32_swap_b32 v56, v58
  v_permlane32_swap_b32 v57, v59
  v_add_f32 v56, v56, v58
  v_add_f32 v57, v57, v59
  v_cvt_pk_bf16_f32 v58, v56, v57
  ds_write_b32 v109, v58
  v_permlane32_swap_b32 v60, v62
  v_permlane32_swap_b32 v61, v63
  v_add_f32 v60, v60, v62
  v_add_f32 v61, v61, v63
  v_cvt_pk_bf16_f32 v62, v60, v61
  ds_write_b32 v110, v62
  v_permlane32_swap_b32 v64, v66
  v_permlane32_swap_b32 v65, v67
  v_add_f32 v64, v64, v66
  v_add_f32 v65, v65, v67
  v_cvt_pk_bf16_f32 v66, v64, v65
  ds_write_b32 v111, v66
  s_branch cA_va2_t2d
.p2align 6
cA_va3_loop:
  s_mov_b32 s30, 0
  s_barrier
  buffer_load_dwordx4 v[16:19], v2, s[8:11], s20 offen offset:2048 sc1
  buffer_load_dwordx4 v[20:23], v2, s[8:11], s20 offen offset:3072 sc1
  s_barrier
  buffer_load_dword v100, v116, s[8:11], s39 offen sc1
  s_add_u32 s27, s19, 2
  s_min_u32 s27, s27, 63
  s_lshr_b32 s27, s27, 3
  s_lshl_b32 s27, s27, 11
  s_add_u32 s27, s27, s35
  s_cmp_eq_u32 s27, s28
  s_cselect_b32 s29, 35328, s27
  buffer_load_dword v101, off, s[8:11], s29 sc1
  s_add_u32 s39, s39, 28672
  s_waitcnt vmcnt(2)
  ds_write_b128 v2, v[16:19] offset:10240
  ds_write_b128 v2, v[20:23] offset:11264
  v_smfmac_f32_16x16x64_bf16 v[36:39], v[16:19], a[16:23], v3
  v_smfmac_f32_16x16x64_bf16 v[40:43], v[16:19], a[72:79], v3
  v_smfmac_f32_16x16x64_bf16 v[44:47], v[16:19], a[128:135], v3
  v_smfmac_f32_16x16x64_bf16 v[48:51], v[16:19], a[184:191], v3
  v_smfmac_f32_16x16x64_bf16 v[52:55], v[16:19], a[240:247], v3
  s_waitcnt lgkmcnt(0)
  s_barrier
  ds_read_b128 v[8:11], v2 offset:8192
  ds_read_b128 v[12:15], v2 offset:9216
  ds_read_b128 v[24:27], v2 offset:12288
  ds_read_b128 v[28:31], v2 offset:13312
  ds_read_b128 v[32:35], v2 offset:14336
  v_smfmac_f32_16x16x64_bf16 v[56:59], v[16:19], v[160:167], v3
  v_smfmac_f32_16x16x64_bf16 v[60:63], v[16:19], v[216:223], v3
  v_smfmac_f32_16x16x64_bf16 v[36:39], v[20:23], a[24:31], v3
  v_smfmac_f32_16x16x64_bf16 v[40:43], v[20:23], a[80:87], v3
  v_smfmac_f32_16x16x64_bf16 v[44:47], v[20:23], a[136:143], v3
  v_smfmac_f32_16x16x64_bf16 v[48:51], v[20:23], a[192:199], v3
  v_smfmac_f32_16x16x64_bf16 v[52:55], v[20:23], a[248:255], v3
  v_smfmac_f32_16x16x64_bf16 v[56:59], v[20:23], v[168:175], v3
  v_smfmac_f32_16x16x64_bf16 v[60:63], v[20:23], v[224:231], v3
  s_waitcnt lgkmcnt(4)
  v_smfmac_f32_16x16x64_bf16 v[36:39], v[8:11], a[0:7], v3
  s_waitcnt lgkmcnt(3)
  v_smfmac_f32_16x16x64_bf16 v[36:39], v[12:15], a[8:15], v3
  s_waitcnt lgkmcnt(2)
  v_smfmac_f32_16x16x64_bf16 v[36:39], v[24:27], a[32:39], v3
  s_waitcnt lgkmcnt(1)
  v_smfmac_f32_16x16x64_bf16 v[36:39], v[28:31], a[40:47], v3
  s_waitcnt lgkmcnt(0)
  v_smfmac_f32_16x16x64_bf16 v[36:39], v[32:35], a[48:55], v3
  v_smfmac_f32_16x16x64_bf16 v[40:43], v[8:11], a[56:63], v3
  v_smfmac_f32_16x16x64_bf16 v[40:43], v[12:15], a[64:71], v3
  v_smfmac_f32_16x16x64_bf16 v[40:43], v[24:27], a[88:95], v3
  v_permlane32_swap_b32 v36, v38
  v_smfmac_f32_16x16x64_bf16 v[40:43], v[28:31], a[96:103], v3
  v_permlane32_swap_b32 v37, v39
  v_smfmac_f32_16x16x64_bf16 v[40:43], v[32:35], a[104:111], v3
  v_add_f32 v36, v36, v38
  v_smfmac_f32_16x16x64_bf16 v[44:47], v[8:11], a[112:119], v3
  v_add_f32 v37, v37, v39
  v_smfmac_f32_16x16x64_bf16 v[44:47], v[12:15], a[120:127], v3
  v_cmp_u_f32 vcc, v36, v37
  v_smfmac_f32_16x16x64_bf16 v[44:47], v[24:27], a[144:151], v3
  v_cvt_pk_bf16_f32 v38, v36, v37
  v_smfmac_f32_16x16x64_bf16 v[44:47], v[28:31], a[152:159], v3
  ds_write_b32 v104, v38
  s_cbranch_vccnz cA_va3_slow
  v_permlane32_swap_b32 v40, v42
  v_smfmac_f32_16x16x64_bf16 v[44:47], v[32:35], a[160:167], v3
  v_permlane32_swap_b32 v41, v43
  v_smfmac_f32_16x16x64_bf16 v[48:51], v[8:11], a[168:175], v3
  v_add_f32 v40, v40, v42
  v_smfmac_f32_16x16x64_bf16 v[48:51], v[12:15], a[176:183], v3
  v_add_f32 v41, v41, v43
  v_smfmac_f32_16x16x64_bf16 v[48:51], v[24:27], a[200:207], v3
  v_cvt_pk_bf16_f32 v42, v40, v41
  v_smfmac_f32_16x16x64_bf16 v[48:51], v[28:31], a[208:215], v3
  ds_write_b32 v105, v42
  v_permlane32_swap_b32 v44, v46
  v_smfmac_f32_16x16x64_bf16 v[48:51], v[32:35], a[216:223], v3
  v_permlane32_swap_b32 v45, v47
  v_smfmac_f32_16x16x64_bf16 v[52:55], v[8:11], a[224:231], v3
  v_add_f32 v44, v44, v46
  v_smfmac_f32_16x16x64_bf16 v[52:55], v[12:15], a[232:239], v3
  v_add_f32 v45, v45, v47
  v_smfmac_f32_16x16x64_bf16 v[52:55], v[24:27], v[120:127], v3
  v_cvt_pk_bf16_f32 v46, v44, v45
  v_smfmac_f32_16x16x64_bf16 v[52:55], v[28:31], v[128:135], v3
  ds_write_b32 v106, v46
  v_permlane32_swap_b32 v48, v50
  v_smfmac_f32_16x16x64_bf16 v[52:55], v[32:35], v[136:143], v3
  v_permlane32_swap_b32 v49, v51
  v_smfmac_f32_16x16x64_bf16 v[56:59], v[8:11], v[144:151], v3
  v_add_f32 v48, v48, v50
  v_smfmac_f32_16x16x64_bf16 v[56:59], v[12:15], v[152:159], v3
  v_add_f32 v49, v49, v51
  v_smfmac_f32_16x16x64_bf16 v[56:59], v[24:27], v[176:183], v3
  v_cvt_pk_bf16_f32 v50, v48, v49
  v_smfmac_f32_16x16x64_bf16 v[56:59], v[28:31], v[184:191], v3
  ds_write_b32 v107, v50
  v_permlane32_swap_b32 v52, v54
  v_smfmac_f32_16x16x64_bf16 v[56:59], v[32:35], v[192:199], v3
  v_permlane32_swap_b32 v53, v55
  v_smfmac_f32_16x16x64_bf16 v[60:63], v[8:11], v[200:207], v3
  v_add_f32 v52, v52, v54
  v_smfmac_f32_16x16x64_bf16 v[60:63], v[12:15], v[208:215], v3
  v_add_f32 v53, v53, v55
  v_smfmac_f32_16x16x64_bf16 v[60:63], v[24:27], v[232:239], v3
  v_cvt_pk_bf16_f32 v54, v52, v53
  v_smfmac_f32_16x16x64_bf16 v[60:63], v[28:31], v[240:247], v3
  ds_write_b32 v108, v54
  v_permlane32_swap_b32 v56, v58
  v_smfmac_f32_16x16x64_bf16 v[60:63], v[32:35], v[248:255], v3
  v_permlane32_swap_b32 v57, v59
  v_add_f32 v56, v56, v58
  v_add_f32 v57, v57, v59
  v_cvt_pk_bf16_f32 v58, v56, v57
  ds_write_b32 v109, v58
  s_nop 2
  v_permlane32_swap_b32 v60, v62
  v_permlane32_swap_b32 v61, v63
  v_add_f32 v60, v60, v62
  v_add_f32 v61, v61, v63
  v_cvt_pk_bf16_f32 v62, v60, v61
  ds_write_b32 v110, v62
cA_va3_t2d:
  v_mov_b32 v117, s18
  s_cmp_eq_u32 s27, s28
  s_cbranch_scc1 cA_va3_vok
cA_va3_vow:
  s_waitcnt vmcnt(0)
  v_cmp_ne_u32 vcc, 56, v101
  s_cbranch_vccnz cA_va3_vor
  s_mov_b32 s28, s27
cA_va3_vok:
  s_waitcnt lgkmcnt(0)
  s_setprio 3
  s_barrier
  v_mov_b32 v36, 0
  v_mov_b32 v37, 0
  buffer_store_dword v117, v118, s[8:11], 0 offen
  s_setprio 0
  s_cmp_eq_u32 s19, 63
  s_cbranch_scc1 cA_done
  v_mov_b32 v38, 0
  v_mov_b32 v39, 0
  v_mov_b32 v40, 0
  v_mov_b32 v41, 0
  v_mov_b32 v42, 0
  v_mov_b32 v43, 0
  v_mov_b32 v44, 0
  v_mov_b32 v45, 0
  v_mov_b32 v46, 0
  v_mov_b32 v47, 0
  v_mov_b32 v48, 0
  v_mov_b32 v49, 0
  v_mov_b32 v50, 0
  v_mov_b32 v51, 0
  v_mov_b32 v52, 0
  v_mov_b32 v53, 0
  v_mov_b32 v54, 0
  v_mov_b32 v55, 0
  v_mov_b32 v56, 0
  v_mov_b32 v57, 0
  v_mov_b32 v58, 0
  v_mov_b32 v59, 0
  v_mov_b32 v60, 0
  v_mov_b32 v61, 0
  v_mov_b32 v62, 0
  v_mov_b32 v63, 0
  s_mov_b32 s19, s18
  s_add_u32 s18, s18, 1
  s_mov_b32 s22, s20
  s_mov_b32 s20, s21
  s_mov_b32 s21, s22
  s_add_u32 s23, s20, 4096
  s_branch cA_va3_loop
cA_va3_slow:
  s_waitcnt lgkmcnt(0)
cA_va3_sl1:
  s_add_u32 s31, s31, 0x1000000
  buffer_load_dwordx4 v[8:11], v2, s[8:11], s20 offen offset:0 sc1
  buffer_load_dwordx4 v[12:15], v2, s[8:11], s20 offen offset:1024 sc1
  buffer_load_dwordx4 v[16:19], v2, s[8:11], s20 offen offset:2048 sc1
  buffer_load_dwordx4 v[20:23], v2, s[8:11], s20 offen offset:3072 sc1
  buffer_load_dwordx4 v[24:27], v2, s[8:11], s23 offen offset:0 sc1
  buffer_load_dwordx4 v[28:31], v2, s[8:11], s23 offen offset:1024 sc1
  buffer_load_dwordx4 v[32:35], v2, s[8:11], s23 offen offset:2048 sc1
  s_waitcnt vmcnt(0)
  v_max3_u32 v36, v8, v9, v10
  v_max3_u32 v36, v36, v11, v12
  v_max3_u32 v36, v36, v13, v14
  v_max3_u32 v36, v36, v15, v16
  v_max3_u32 v36, v36, v17, v18
  v_max3_u32 v36, v36, v19, v20
  v_max3_u32 v36, v36, v21, v22
  v_max3_u32 v36, v36, v23, v24
  v_max3_u32 v36, v36, v25, v26
  v_max3_u32 v36, v36, v27, v28
  v_max3_u32 v36, v36, v29, v30
  v_max3_u32 v36, v36, v31, v32
  v_max3_u32 v36, v36, v33, v34
  v_max_u32 v36, v36, v35
  v_cmp_eq_u32 vcc, -1, v36
  s_cbranch_vccz cA_va3_sl2
  s_add_u32 s30, s30, 1
  s_cmp_lt_u32 s30, 400000
  s_cbranch_scc1 cA_va3_sl1
  s_branch cA_abort
cA_va3_sl2:
  v_mov_b32 v36, 0
  v_mov_b32 v37, 0
  v_mov_b32 v38, 0
  v_mov_b32 v39, 0
  v_mov_b32 v40, 0
  v_mov_b32 v41, 0
  v_mov_b32 v42, 0
  v_mov_b32 v43, 0
  v_mov_b32 v44, 0
  v_mov_b32 v45, 0
  v_mov_b32 v46, 0
  v_mov_b32 v47, 0
  v_mov_b32 v48, 0
  v_mov_b32 v49, 0
  v_mov_b32 v50, 0
  v_mov_b32 v51, 0
  v_mov_b32 v52, 0
  v_mov_b32 v53, 0
  v_mov_b32 v54, 0
  v_mov_b32 v55, 0
  v_mov_b32 v56, 0
  v_mov_b32 v57, 0
  v_mov_b32 v58, 0
  v_mov_b32 v59, 0
  v_mov_b32 v60, 0
  v_mov_b32 v61, 0
  v_mov_b32 v62, 0
  v_mov_b32 v63, 0
  v_smfmac_f32_16x16x64_bf16 v[36:39], v[8:11], a[0:7], v3
  v_smfmac_f32_16x16x64_bf16 v[40:43], v[8:11], a[56:63], v3
  v_smfmac_f32_16x16x64_bf16 v[44:47], v[8:11], a[112:119], v3
  v_smfmac_f32_16x16x64_bf16 v[48:51], v[8:11], a[168:175], v3
  v_smfmac_f32_16x16x64_bf16 v[52:55], v[8:11], a[224:231], v3
  v_smfmac_f32_16x16x64_bf16 v[56:59], v[8:11], v[144:151], v3
  v_smfmac_f32_16x16x64_bf16 v[60:63], v[8:11], v[200:207], v3
  v_smfmac_f32_16x16x64_bf16 v[36:39], v[12:15], a[8:15], v3
  v_smfmac_f32_16x16x64_bf16 v[40:43], v[12:15], a[64:71], v3
  v_smfmac_f32_16x16x64_bf16 v[44:47], v[12:15], a[120:127], v3
  v_smfmac_f32_16x16x64_bf16 v[48:51], v[12:15], a[176:183], v3
  v_smfmac_f32_16x16x64_bf16 v[52:55], v[12:15], a[232:239], v3
  v_smfmac_f32_16x16x64_bf16 v[56:59], v[12:15], v[152:159], v3
  v_smfmac_f32_16x16x64_bf16 v[60:63], v[12:15], v[208:215], v3
  v_smfmac_f32_16x16x64_bf16 v[36:39], v[16:19], a[16:23], v3
  v_smfmac_f32_16x16x64_bf16 v[40:43], v[16:19], a[72:79], v3
  v_smfmac_f32_16x16x64_bf16 v[44:47], v[16:19], a[128:135], v3
  v_smfmac_f32_16x16x64_bf16 v[48:51], v[16:19], a[184:191], v3
  v_smfmac_f32_16x16x64_bf16 v[52:55], v[16:19], a[240:247], v3
  v_smfmac_f32_16x16x64_bf16 v[56:59], v[16:19], v[160:167], v3
  v_smfmac_f32_16x16x64_bf16 v[60:63], v[16:19], v[216:223], v3
  v_smfmac_f32_16x16x64_bf16 v[36:39], v[20:23], a[24:31], v3
  v_smfmac_f32_16x16x64_bf16 v[40:43], v[20:23], a[80:87], v3
  v_smfmac_f32_16x16x64_bf16 v[44:47], v[20:23], a[136:143], v3
  v_smfmac_f32_16x16x64_bf16 v[48:51], v[20:23], a[192:199], v3
  v_smfmac_f32_16x16x64_bf16 v[52:55], v[20:23], a[248:255], v3
  v_smfmac_f32_16x16x64_bf16 v[56:59], v[20:23], v[168:175], v3
  v_smfmac_f32_16x16x64_bf16 v[60:63], v[20:23], v[224:231], v3
  v_smfmac_f32_16x16x64_bf16 v[36:39], v[24:27], a[32:39], v3
  v_smfmac_f32_16x16x64_bf16 v[40:43], v[24:27], a[88:95], v3
  v_smfmac_f32_16x16x64_bf16 v[44:47], v[24:27], a[144:151], v3
  v_smfmac_f32_16x16x64_bf16 v[48:51], v[24:27], a[200:207], v3
  v_smfmac_f32_16x16x64_bf16 v[52:55], v[24:27], v[120:127], v3
  v_smfmac_f32_16x16x64_bf16 v[56:59], v[24:27], v[176:183], v3
  v_smfmac_f32_16x16x64_bf16 v[60:63], v[24:27], v[232:239], v3
  v_smfmac_f32_16x16x64_bf16 v[36:39], v[28:31], a[40:47], v3
  v_smfmac_f32_16x16x64_bf16 v[40:43], v[28:31], a[96:103], v3
  v_smfmac_f32_16x16x64_bf16 v[44:47], v[28:31], a[152:159], v3
  v_smfmac_f32_16x16x64_bf16 v[48:51], v[28:31], a[208:215], v3
  v_smfmac_f32_16x16x64_bf16 v[52:55], v[28:31], v[128:135], v3
  v_smfmac_f32_16x16x64_bf16 v[56:59], v[28:31], v[184:191], v3
  v_smfmac_f32_16x16x64_bf16 v[60:63], v[28:31], v[240:247], v3
  v_smfmac_f32_16x16x64_bf16 v[36:39], v[32:35], a[48:55], v3
  v_smfmac_f32_16x16x64_bf16 v[40:43], v[32:35], a[104:111], v3
  v_smfmac_f32_16x16x64_bf16 v[44:47], v[32:35], a[160:167], v3
  v_smfmac_f32_16x16x64_bf16 v[48:51], v[32:35], a[216:223], v3
  v_smfmac_f32_16x16x64_bf16 v[52:55], v[32:35], v[136:143], v3
  v_smfmac_f32_16x16x64_bf16 v[56:59], v[32:35], v[192:199], v3
  v_smfmac_f32_16x16x64_bf16 v[60:63], v[32:35], v[248:255], v3
  v_permlane32_swap_b32 v36, v38
  v_permlane32_swap_b32 v37, v39
  v_add_f32 v36, v36, v38
  v_add_f32 v37, v37, v39
  v_cvt_pk_bf16_f32 v38, v36, v37
  ds_write_b32 v104, v38
  v_permlane32_swap_b32 v40, v42
  v_permlane32_swap_b32 v41, v43
  v_add_f32 v40, v40, v42
  v_add_f32 v41, v41, v43
  v_cvt_pk_bf16_f32 v42, v40, v41
  ds_write_b32 v105, v42
  v_permlane32_swap_b32 v44, v46
  v_permlane32_swap_b32 v45, v47
  v_add_f32 v44, v44, v46
  v_add_f32 v45, v45, v47
  v_cvt_pk_bf16_f32 v46, v44, v45
  ds_write_b32 v106, v46
  v_permlane32_swap_b32 v48, v50
  v_permlane32_swap_b32 v49, v51
  v_add_f32 v48, v48, v50
  v_add_f32 v49, v49, v51
  v_cvt_pk_bf16_f32 v50, v48, v49
  ds_write_b32 v107, v50
  v_permlane32_swap_b32 v52, v54
  v_permlane32_swap_b32 v53, v55
  v_add_f32 v52, v52, v54
  v_add_f32 v53, v53, v55
  v_cvt_pk_bf16_f32 v54, v52, v53
  ds_write_b32 v108, v54
  v_permlane32_swap_b32 v56, v58
  v_permlane32_swap_b32 v57, v59
  v_add_f32 v56, v56, v58
  v_add_f32 v57, v57, v59
  v_cvt_pk_bf16_f32 v58, v56, v57
  ds_write_b32 v109, v58
  v_permlane32_swap_b32 v60, v62
  v_permlane32_swap_b32 v61, v63
  v_add_f32 v60, v60, v62
  v_add_f32 v61, v61, v63
  v_cvt_pk_bf16_f32 v62, v60, v61
  ds_write_b32 v110, v62
  s_branch cA_va3_t2d
cA_va3_vor:
  s_sleep 2
  buffer_load_dword v101, off, s[8:11], s27 sc1
  s_add_u32 s30, s30, 1
  s_cmp_lt_u32 s30, 400000
  s_cbranch_scc1 cA_va3_vow
  s_branch cA_abort
cA_abort:
  v_mov_b32 v4, 0xdead
  v_mov_b32 v5, 16
  buffer_store_dword v4, v5, s[12:15], 0 offen
  s_branch ch_end
cA_done:
  s_branch ch_end
.p2align 6
cB_sc0_loop:
  s_mov_b32 s30, 0
  s_mov_b32 s62, 0
  s_setprio 3
  s_sleep 6
cB_sc0_fp_l:
  v_cmp_gt_u32 vcc, s19, v112
  buffer_load_dword v112, v0, s[8:11], 0 offen sc1
  s_cbranch_vccz cB_sc0_fp_d
  v_cmp_gt_u32 vcc, s19, v112
  buffer_load_dword v112, v0, s[8:11], 0 offen sc1
  s_cbranch_vccz cB_sc0_fp_d
  v_cmp_gt_u32 vcc, s19, v112
  buffer_load_dword v112, v0, s[8:11], 0 offen sc1
  s_cbranch_vccz cB_sc0_fp_d
  v_cmp_gt_u32 vcc, s19, v112
  buffer_load_dword v112, v0, s[8:11], 0 offen sc1
  s_cbranch_vccz cB_sc0_fp_d
  v_cmp_gt_u32 vcc, s19, v112
  buffer_load_dword v112, v0, s[8:11], 0 offen sc1
  s_cbranch_vccz cB_sc0_fp_d
  v_cmp_gt_u32 vcc, s19, v112
  buffer_load_dword v112, v0, s[8:11], 0 offen sc1
  s_cbranch_vccz cB_sc0_fp_d
  v_cmp_gt_u32 vcc, s19, v112
  buffer_load_dword v112, v0, s[8:11], 0 offen sc1
  s_cbranch_vccz cB_sc0_fp_d
  v_cmp_gt_u32 vcc, s19, v112
  buffer_load_dword v112, v0, s[8:11], 0 offen sc1
  s_cbranch_vccz cB_sc0_fp_d
  v_cmp_gt_u32 vcc, s19, v112
  buffer_load_dword v112, v0, s[8:11], 0 offen sc1
  s_cbranch_vccz cB_sc0_fp_d
  v_cmp_gt_u32 vcc, s19, v112
  buffer_load_dword v112, v0, s[8:11], 0 offen sc1
  s_cbranch_vccz cB_sc0_fp_d
  v_cmp_gt_u32 vcc, s19, v112
  buffer_load_dword v112, v0, s[8:11], 0 offen sc1
  s_cbranch_vccz cB_sc0_fp_d
  v_cmp_gt_u32 vcc, s19, v112
  buffer_load_dword v112, v0, s[8:11], 0 offen sc1
  s_cbranch_vccz cB_sc0_fp_d
  v_cmp_gt_u32 vcc, s19, v112
  buffer_load_dword v112, v0, s[8:11], 0 offen sc1
  s_cbranch_vccz cB_sc0_fp_d
  v_cmp_gt_u32 vcc, s19, v112
  buffer_load_dword v112, v0, s[8:11], 0 offen sc1
  s_cbranch_vccz cB_sc0_fp_d
  v_cmp_gt_u32 vcc, s19, v112
  buffer_load_dword v112, v0, s[8:11], 0 offen sc1
  s_cbranch_vccz cB_sc0_fp_d
  v_cmp_gt_u32 vcc, s19, v112
  buffer_load_dword v112, v0, s[8:11], 0 offen sc1
  s_cbranch_vccz cB_sc0_fp_d
  s_waitcnt vmcnt(24)
  s_add_u32 s30, s30, 1
  s_cmp_lt_u32 s30, 400000
  s_cbranch_scc1 cB_sc0_fp_l
  s_branch cB_abort
cB_sc0_fp_d:
  buffer_load_dwordx4 v[8:11], v2, s[8:11], s20 offen offset:0 sc1
  s_barrier
  s_setprio 2
  buffer_load_dwordx4 v[12:15], v2, s[8:11], s20 offen offset:1024 sc1
  s_setprio 1
  buffer_load_dwordx4 v[16:19], v2, s[8:11], s20 offen offset:2048 sc1
  s_setprio 0
  buffer_load_dwordx4 v[20:23], v2, s[8:11], s20 offen offset:3072 sc1
cB_sc0_go:
  s_waitcnt vmcnt(3)
  v_smfmac_f32_16x16x64_bf16 v[36:39], v[8:11], a[0:7], v3
  buffer_load_dwordx4 v[32:35], v2, s[8:11], s23 offen offset:0 sc1
  v_cmp_eq_u32 vcc, -1, v8
  v_smfmac_f32_16x16x64_bf16 v[40:43], v[8:11], a[56:63], v3
  v_smfmac_f32_16x16x64_bf16 v[44:47], v[8:11], a[112:119], v3
  buffer_load_dwordx4 v[24:27], v2, s[8:11], s23 offen offset:1024 sc1
  s_cbranch_vccnz cB_sc0_r0
  v_smfmac_f32_16x16x64_bf16 v[48:51], v[8:11], a[168:175], v3
  v_smfmac_f32_16x16x64_bf16 v[52:55], v[8:11], a[224:231], v3
  s_waitcnt vmcnt(4)
  v_cmp_eq_u32 vcc, -1, v12
  v_smfmac_f32_16x16x64_bf16 v[56:59], v[8:11], v[144:151], v3
  buffer_load_dwordx4 v[28:31], v2, s[8:11], s23 offen offset:2048 sc1
  v_smfmac_f32_16x16x64_bf16 v[60:63], v[8:11], v[200:207], v3
  s_cbranch_vccnz cB_sc0_r1
cB_sc0_c1:
  v_smfmac_f32_16x16x64_bf16 v[36:39], v[12:15], a[8:15], v3
  v_smfmac_f32_16x16x64_bf16 v[40:43], v[12:15], a[64:71], v3
  v_smfmac_f32_16x16x64_bf16 v[44:47], v[12:15], a[120:127], v3
  v_smfmac_f32_16x16x64_bf16 v[48:51], v[12:15], a[176:183], v3
  v_smfmac_f32_16x16x64_bf16 v[52:55], v[12:15], a[232:239], v3
  s_waitcnt vmcnt(4)
  v_cmp_eq_u32 vcc, -1, v16
  v_smfmac_f32_16x16x64_bf16 v[56:59], v[12:15], v[152:159], v3
  buffer_load_dwordx4 v[88:91], v117, s[8:11], s26 offen offset:0 sc1
  v_smfmac_f32_16x16x64_bf16 v[60:63], v[12:15], v[208:215], v3
  s_cbranch_vccnz cB_sc0_r2
cB_sc0_c2:
  v_smfmac_f32_16x16x64_bf16 v[36:39], v[16:19], a[16:23], v3
  v_smfmac_f32_16x16x64_bf16 v[40:43], v[16:19], a[72:79], v3
  v_smfmac_f32_16x16x64_bf16 v[44:47], v[16:19], a[128:135], v3
  buffer_load_dwordx4 v[92:95], v117, s[8:11], s26 offen offset:1024 sc1
  v_smfmac_f32_16x16x64_bf16 v[48:51], v[16:19], a[184:191], v3
  v_smfmac_f32_16x16x64_bf16 v[52:55], v[16:19], a[240:247], v3
  s_waitcnt vmcnt(5)
  v_cmp_eq_u32 vcc, -1, v20
  v_smfmac_f32_16x16x64_bf16 v[56:59], v[16:19], v[160:167], v3
  v_smfmac_f32_16x16x64_bf16 v[60:63], v[16:19], v[216:223], v3
  buffer_load_dwordx4 v[96:99], v2, s[8:11], s24 offen offset:0 sc1
  s_cbranch_vccnz cB_sc0_r3
cB_sc0_c3:
  v_smfmac_f32_16x16x64_bf16 v[36:39], v[20:23], a[24:31], v3
  v_smfmac_f32_16x16x64_bf16 v[40:43], v[20:23], a[80:87], v3
  s_waitcnt vmcnt(3)
  v_max3_u32 v66, v24, v27, v28
  v_smfmac_f32_16x16x64_bf16 v[44:47], v[20:23], a[136:143], v3
  v_max3_u32 v66, v66, v31, v32
  v_smfmac_f32_16x16x64_bf16 v[48:51], v[20:23], a[192:199], v3
  buffer_load_dwordx4 v[100:103], v2, s[8:11], s24 offen offset:1024 sc1
  v_max_u32 v66, v66, v35
  v_smfmac_f32_16x16x64_bf16 v[52:55], v[20:23], a[248:255], v3
  v_cmp_eq_u32 vcc, -1, v66
  v_smfmac_f32_16x16x64_bf16 v[56:59], v[20:23], v[168:175], v3
  v_smfmac_f32_16x16x64_bf16 v[60:63], v[20:23], v[224:231], v3
  s_cbranch_vccnz cB_sc0_r4
cB_sc0_c4:
  v_smfmac_f32_16x16x64_bf16 v[60:63], v[32:35], v[232:239], v3
  buffer_load_dwordx4 v[104:107], v2, s[8:11], s26 offen offset:0 sc1
  v_smfmac_f32_16x16x64_bf16 v[60:63], v[24:27], v[240:247], v3
  v_smfmac_f32_16x16x64_bf16 v[60:63], v[28:31], v[248:255], v3
  v_smfmac_f32_16x16x64_bf16 v[52:55], v[32:35], v[120:127], v3
  v_smfmac_f32_16x16x64_bf16 v[52:55], v[24:27], v[128:135], v3
  buffer_load_dwordx4 v[108:111], v2, s[8:11], s26 offen offset:1024 sc1
  v_smfmac_f32_16x16x64_bf16 v[52:55], v[28:31], v[136:143], v3
  v_cvt_pk_bf16_f32 v63, v62, v63
  v_smfmac_f32_16x16x64_bf16 v[56:59], v[32:35], v[176:183], v3
  v_cvt_pk_bf16_f32 v62, v60, v61
  v_smfmac_f32_16x16x64_bf16 v[56:59], v[24:27], v[184:191], v3
  v_mfma_f32_16x16x32_bf16 v[12:15], v[62:65], v[4:7], 0
  v_cvt_pk_bf16_f32 v55, v54, v55
  v_smfmac_f32_16x16x64_bf16 v[56:59], v[28:31], v[192:199], v3
  v_cvt_pk_bf16_f32 v54, v52, v53
  v_smfmac_f32_16x16x64_bf16 v[36:39], v[32:35], a[32:39], v3
  s_nop 1
  v_cvt_pk_bf16_f32 v76, v12, v13
  v_smfmac_f32_16x16x64_bf16 v[36:39], v[24:27], a[40:47], v3
  v_cvt_pk_bf16_f32 v77, v14, v15
  v_smfmac_f32_16x16x64_bf16 v[36:39], v[28:31], a[48:55], v3
  v_cvt_pk_bf16_f32 v56, v56, v57
  v_smfmac_f32_16x16x64_bf16 v[40:43], v[32:35], a[88:95], v3
  v_cvt_pk_bf16_f32 v57, v58, v59
  v_smfmac_f32_16x16x64_bf16 v[40:43], v[24:27], a[96:103], v3
  v_mfma_f32_16x16x32_bf16 v[16:19], v[54:57], v[4:7], 0
  v_cvt_pk_bf16_f32 v39, v38, v39
  v_smfmac_f32_16x16x64_bf16 v[40:43], v[28:31], a[104:111], v3
  v_cvt_pk_bf16_f32 v38, v36, v37
  v_smfmac_f32_16x16x64_bf16 v[44:47], v[32:35], a[144:151], v3
  s_nop 1
  v_cvt_pk_bf16_f32 v78, v16, v17
  v_smfmac_f32_16x16x64_bf16 v[44:47], v[24:27], a[152:159], v3
  v_cvt_pk_bf16_f32 v79, v18, v19
  v_smfmac_f32_16x16x64_bf16 v[44:47], v[28:31], a[160:167], v3
  v_cvt_pk_bf16_f32 v40, v40, v41
  v_smfmac_f32_16x16x64_bf16 v[48:51], v[32:35], a[200:207], v3
  v_cvt_pk_bf16_f32 v41, v42, v43
  v_smfmac_f32_16x16x64_bf16 v[48:51], v[24:27], a[208:215], v3
  v_smfmac_f32_16x16x64_bf16 v[48:51], v[28:31], a[216:223], v3
  s_waitcnt vmcnt(4)
  v_cvt_pk_bf16_f32 v47, v46, v47
  v_smfmac_f32_16x16x64_bf16 v[68:71], v[76:79], v[80:87], v3
  v_cvt_pk_bf16_f32 v46, v44, v45
  v_mfma_f32_16x16x32_bf16 v[12:15], v[38:41], v[4:7], 0
  s_nop 1
  v_cvt_pk_bf16_f32 v48, v48, v49
  v_cvt_pk_bf16_f32 v49, v50, v51
  s_nop 1
  v_mfma_f32_16x16x32_bf16 v[16:19], v[46:49], v[4:7], 0
  v_smfmac_f32_16x16x64_bf16 v[72:75], v[76:79], v[88:95], v3
  v_cvt_pk_bf16_f32 v20, v12, v13
  v_mfma_f32_16x16x32_bf16 v[52:55], v[30:33], v[76:79], 0
  s_waitcnt vmcnt(0)
  v_cvt_pk_bf16_f32 v21, v14, v15
  v_cvt_pk_bf16_f32 v22, v16, v17
  v_cvt_pk_bf16_f32 v23, v18, v19
  s_nop 1
  v_mfma_f32_16x16x32_bf16 v[52:55], v[8:11], v[20:23], v[52:55]
  v_smfmac_f32_16x16x64_bf16 v[68:71], v[20:23], v[96:103], v3
  v_smfmac_f32_16x16x64_bf16 v[72:75], v[20:23], v[104:111], v3
  s_nop 1
  ds_write_b128 v113, v[52:55]
  s_nop 1
  v_permlane32_swap_b32 v68, v70
  v_permlane32_swap_b32 v69, v71
  v_add_f32 v56, v68, v70
  v_add_f32 v58, v69, v71
  v_permlane32_swap_b32 v72, v74
  v_permlane32_swap_b32 v73, v75
  v_add_f32 v57, v72, v74
  v_add_f32 v59, v73, v75
  ds_write_b128 v2, v[56:59] offset:0
  v_cmp_u_f32 vcc, v57, v59
  v_mov_b32 v68, 0
  v_mov_b32 v69, 0
  v_mov_b32 v70, 0
  v_mov_b32 v71, 0
  s_cbranch_vccnz cB_sc0_retry
cB_sc0_cont:
  s_add_u32 s24, s24, 28672
  s_add_u32 s26, s26, 28672
  buffer_load_dwordx4 v[80:83], v117, s[8:11], s24 offen offset:0 sc1
  buffer_load_dwordx4 v[84:87], v117, s[8:11], s24 offen offset:1024 sc1
  v_mov_b32 v72, 0
  v_mov_b32 v73, 0
  v_mfma_f32_32x32x16_bf16 v[36:51], v[68:71], v[68:71], 0
  s_waitcnt lgkmcnt(0)
  s_barrier
  ds_read_b64 v[8:9], v114 offset:0
  ds_read_b64 v[10:11], v114 offset:1024
  ds_read_b64 v[12:13], v114 offset:2048
  ds_read_b64 v[14:15], v114 offset:3072
  ds_read2_b32 v[16:17], v115 offset0:0 offset1:64
  ds_read2_b32 v[18:19], v115 offset0:128 offset1:192
  v_mfma_f32_32x32x16_bf16 v[52:67], v[68:71], v[68:71], 0
  s_waitcnt lgkmcnt(0)
  v_pk_add_f32 v[16:17], v[16:17], v[18:19]
  v_pk_add_f32 v[8:9], v[8:9], v[10:11]
  v_pk_add_f32 v[12:13], v[12:13], v[14:15]
  v_add_f32 v20, v16, v17
  v_pk_add_f32 v[8:9], v[8:9], v[12:13]
  v_max_f32 v22, v8, v9
  v_add_f32_dpp v20, v20, v20 row_ror:8 row_mask:0xf bank_mask:0xf
  s_nop 0
  v_max_f32_dpp v22, v22, v22 row_ror:8 row_mask:0xf bank_mask:0xf
  v_max_f32 v22, v22, v20
  s_nop 1
  v_max_f32_dpp v22, v22, v22 quad_perm:[1,0,3,2] row_mask:0xf bank_mask:0xf
  s_nop 1
  v_max_f32_dpp v22, v22, v22 quad_perm:[2,3,0,1] row_mask:0xf bank_mask:0xf
  s_nop 1
  v_max_f32_dpp v22, v22, v22 row_half_mirror row_mask:0xf bank_mask:0xf
  v_pk_add_f32 v[8:9], v[8:9], v[22:23] op_sel_hi:[1,0] neg_lo:[0,1] neg_hi:[0,1]
  v_sub_f32 v20, v20, v22
  v_exp_f32 v8, v8
  v_exp_f32 v9, v9
  v_exp_f32 v20, v20
  v_add_f32 v24, v8, v9
  v_fmac_f32 v24, 0.5, v20
  v_mov_b32_dpp v21, v20 quad_perm:[1,0,3,2] row_mask:0xf bank_mask:0xf
  s_nop 0
  v_add_f32_dpp v24, v24, v24 quad_perm:[1,0,3,2] row_mask:0xf bank_mask:0xf
  s_nop 1
  v_add_f32_dpp v24, v24, v24 quad_perm:[2,3,0,1] row_mask:0xf bank_mask:0xf
  s_nop 1
  v_add_f32_dpp v24, v24, v24 row_half_mirror row_mask:0xf bank_mask:0xf
  s_nop 1
  v_add_f32_dpp v24, v24, v24 row_ror:8 row_mask:0xf bank_mask:0xf
  v_rcp_f32 v24, v24
  s_nop 0
  v_pk_mul_f32 v[8:9], v[8:9], v[24:25] op_sel_hi:[1,0]
  v_cvt_pk_bf16_f32 v8, abs(v8), abs(v9)
  buffer_store_dword v8, v1, s[8:11], s20 offen sc1
  v_pk_mul_f32 v[20:21], v[20:21], v[24:25] op_sel_hi:[1,0]
  v_cvt_pk_bf16_f32 v20, abs(v20), abs(v21)
  buffer_store_dword v20, v118, s[8:11], s20 offen sc1
  v_mov_b32 v74, 0
  v_mov_b32 v75, 0
  s_mov_b32 s19, s18
  s_add_u32 s18, s18, 1
  s_mov_b32 s22, s20
  s_mov_b32 s20, s21
  s_mov_b32 s21, s22
  s_add_u32 s23, s20, 4096
  s_cmp_lt_u32 s19, 63
  s_cbranch_scc1 cB_sc0_loop
  s_branch cB_done
cB_sc0_r0:
  s_add_u32 s31, s31, 1
  buffer_load_dwordx4 v[8:11], v2, s[8:11], s20 offen offset:0 sc1
  s_waitcnt vmcnt(0)
  v_cmp_eq_u32 vcc, -1, v8
  v_mov_b32 v36, 0
  v_mov_b32 v37, 0
  v_mov_b32 v38, 0
  v_mov_b32 v39, 0
  v_mov_b32 v40, 0
  v_mov_b32 v41, 0
  v_mov_b32 v42, 0
  v_mov_b32 v43, 0
  v_mov_b32 v44, 0
  v_mov_b32 v45, 0
  v_mov_b32 v46, 0
  v_mov_b32 v47, 0
  v_mov_b32 v48, 0
  v_mov_b32 v49, 0
  v_mov_b32 v50, 0
  v_mov_b32 v51, 0
  s_nop 1
  s_cbranch_vccz cB_sc0_go
  s_add_u32 s30, s30, 1
  s_cmp_lt_u32 s30, 400000
  s_cbranch_scc1 cB_sc0_r0
  s_branch cB_abort
cB_sc0_r1:
  s_add_u32 s31, s31, 1
  buffer_load_dwordx4 v[12:15], v2, s[8:11], s20 offen offset:1024 sc1
  s_waitcnt vmcnt(0)
  v_cmp_eq_u32 vcc, -1, v12
  s_nop 4
  s_cbranch_vccz cB_sc0_c1
  s_add_u32 s30, s30, 1
  s_cmp_lt_u32 s30, 400000
  s_cbranch_scc1 cB_sc0_r1
  s_branch cB_abort
cB_sc0_r2:
  s_add_u32 s31, s31, 1
  buffer_load_dwordx4 v[16:19], v2, s[8:11], s20 offen offset:2048 sc1
  s_waitcnt vmcnt(0)
  v_cmp_eq_u32 vcc, -1, v16
  s_nop 4
  s_cbranch_vccz cB_sc0_c2
  s_add_u32 s30, s30, 1
  s_cmp_lt_u32 s30, 400000
  s_cbranch_scc1 cB_sc0_r2
  s_branch cB_abort
cB_sc0_r3:
  s_add_u32 s31, s31, 1
  buffer_load_dwordx4 v[20:23], v2, s[8:11], s20 offen offset:3072 sc1
  s_waitcnt vmcnt(0)
  v_cmp_eq_u32 vcc, -1, v20
  s_nop 4
  s_cbranch_vccz cB_sc0_c3
  s_add_u32 s30, s30, 1
  s_cmp_lt_u32 s30, 400000
  s_cbranch_scc1 cB_sc0_r3
  s_branch cB_abort
cB_sc0_r4:
  s_add_u32 s31, s31, 1
  buffer_load_dwordx4 v[32:35], v2, s[8:11], s23 offen offset:0 sc1
  buffer_load_dwordx4 v[24:27], v2, s[8:11], s23 offen offset:1024 sc1
  buffer_load_dwordx4 v[28:31], v2, s[8:11], s23 offen offset:2048 sc1
  s_waitcnt vmcnt(0)
  v_max3_u32 v66, v24, v27, v28
  v_max3_u32 v66, v66, v31, v32
  v_max_u32 v66, v66, v35
  v_cmp_eq_u32 vcc, -1, v66
  s_nop 4
  s_cbranch_vccz cB_sc0_c4
  s_add_u32 s30, s30, 1
  s_cmp_lt_u32 s30, 400000
  s_cbranch_scc1 cB_sc0_r4
  s_branch cB_abort
cB_sc0_retry:
  s_cmp_lg_u32 s62, 0
  s_cbranch_scc1 cB_sc0_cont
  s_waitcnt vmcnt(0) lgkmcnt(0)
cB_sc0_rv:
  buffer_load_dwordx4 v[8:11], v2, s[8:11], s20 offen offset:0 sc1
  buffer_load_dwordx4 v[12:15], v2, s[8:11], s20 offen offset:1024 sc1
  buffer_load_dwordx4 v[16:19], v2, s[8:11], s20 offen offset:2048 sc1
  buffer_load_dwordx4 v[20:23], v2, s[8:11], s20 offen offset:3072 sc1
  buffer_load_dwordx4 v[32:35], v2, s[8:11], s23 offen offset:0 sc1
  buffer_load_dwordx4 v[24:27], v2, s[8:11], s23 offen offset:1024 sc1
  buffer_load_dwordx4 v[28:31], v2, s[8:11], s23 offen offset:2048 sc1
  s_waitcnt vmcnt(0)
  v_max3_u32 v66, v8, v9, v10
  v_max3_u32 v66, v66, v11, v12
  v_max3_u32 v66, v66, v13, v14
  v_max3_u32 v66, v66, v15, v16
  v_max3_u32 v66, v66, v17, v18
  v_max3_u32 v66, v66, v19, v20
  v_max3_u32 v66, v66, v21, v22
  v_max3_u32 v66, v66, v23, v24
  v_max3_u32 v66, v66, v25, v26
  v_max3_u32 v66, v66, v27, v28
  v_max3_u32 v66, v66, v29, v30
  v_max3_u32 v66, v66, v31, v32
  v_max3_u32 v66, v66, v33, v34
  v_max_u32 v66, v66, v35
  v_cmp_eq_u32 vcc, -1, v66
  s_cbranch_vccz cB_sc0_rk
  s_add_u32 s30, s30, 1
  s_cmp_lt_u32 s30, 400000
  s_cbranch_scc1 cB_sc0_rv
  s_branch cB_abort
cB_sc0_rk:
  s_mov_b32 s62, 1
  v_mov_b32 v36, 0
  v_mov_b32 v37, 0
  v_mov_b32 v38, 0
  v_mov_b32 v39, 0
  v_mov_b32 v40, 0
  v_mov_b32 v41, 0
  v_mov_b32 v42, 0
  v_mov_b32 v43, 0
  v_mov_b32 v44, 0
  v_mov_b32 v45, 0
  v_mov_b32 v46, 0
  v_mov_b32 v47, 0
  v_mov_b32 v48, 0
  v_mov_b32 v49, 0
  v_mov_b32 v50, 0
  v_mov_b32 v51, 0
  v_mov_b32 v60, 0
  v_mov_b32 v61, 0
  v_mov_b32 v62, 0
  v_mov_b32 v63, 0
  v_mov_b32 v68, 0
  v_mov_b32 v69, 0
  v_mov_b32 v70, 0
  v_mov_b32 v71, 0
  v_mov_b32 v72, 0
  v_mov_b32 v73, 0
  v_mov_b32 v74, 0
  v_mov_b32 v75, 0
  v_mov_b32 v52, 0
  v_mov_b32 v53, 0
  v_mov_b32 v54, 0
  v_mov_b32 v55, 0
  v_mov_b32 v56, 0
  v_mov_b32 v57, 0
  v_mov_b32 v58, 0
  v_mov_b32 v59, 0
  s_add_u32 s31, s31, 0x100
  s_nop 0
  s_branch cB_sc0_go
.p2align 6
cB_sc1_loop:
  s_mov_b32 s30, 0
  s_mov_b32 s62, 0
  s_setprio 3
  s_barrier
  buffer_load_dwordx4 v[8:11], v2, s[8:11], s20 offen offset:0 sc1
  s_setprio 2
  buffer_load_dwordx4 v[12:15], v2, s[8:11], s20 offen offset:1024 sc1
  s_setprio 1
  buffer_load_dwordx4 v[16:19], v2, s[8:11], s20 offen offset:2048 sc1
  s_setprio 0
  buffer_load_dwordx4 v[20:23], v2, s[8:11], s20 offen offset:3072 sc1
cB_sc1_go:
  s_waitcnt vmcnt(3)
  v_smfmac_f32_16x16x64_bf16 v[36:39], v[8:11], a[0:7], v3
  buffer_load_dwordx4 v[28:31], v2, s[8:11], s23 offen offset:0 sc1
  v_cmp_eq_u32 vcc, -1, v8
  v_smfmac_f32_16x16x64_bf16 v[40:43], v[8:11], a[56:63], v3
  v_smfmac_f32_16x16x64_bf16 v[44:47], v[8:11], a[112:119], v3
  buffer_load_dwordx4 v[24:27], v2, s[8:11], s23 offen offset:1024 sc1
  s_cbranch_vccnz cB_sc1_r0
  v_smfmac_f32_16x16x64_bf16 v[48:51], v[8:11], a[168:175], v3
  v_smfmac_f32_16x16x64_bf16 v[52:55], v[8:11], a[224:231], v3
  s_waitcnt vmcnt(4)
  v_cmp_eq_u32 vcc, -1, v12
  v_smfmac_f32_16x16x64_bf16 v[56:59], v[8:11], v[144:151], v3
  buffer_load_dwordx4 v[32:35], v2, s[8:11], s23 offen offset:2048 sc1
  v_smfmac_f32_16x16x64_bf16 v[60:63], v[8:11], v[200:207], v3
  s_cbranch_vccnz cB_sc1_r1
cB_sc1_c1:
  v_smfmac_f32_16x16x64_bf16 v[36:39], v[12:15], a[8:15], v3
  v_smfmac_f32_16x16x64_bf16 v[40:43], v[12:15], a[64:71], v3
  v_smfmac_f32_16x16x64_bf16 v[44:47], v[12:15], a[120:127], v3
  v_smfmac_f32_16x16x64_bf16 v[48:51], v[12:15], a[176:183], v3
  v_smfmac_f32_16x16x64_bf16 v[52:55], v[12:15], a[232:239], v3
  s_waitcnt vmcnt(4)
  v_cmp_eq_u32 vcc, -1, v16
  v_smfmac_f32_16x16x64_bf16 v[56:59], v[12:15], v[152:159], v3
  buffer_load_dwordx4 v[88:91], v117, s[8:11], s26 offen offset:0 sc1
  v_smfmac_f32_16x16x64_bf16 v[60:63], v[12:15], v[208:215], v3
  s_cbranch_vccnz cB_sc1_r2
cB_sc1_c2:
  v_smfmac_f32_16x16x64_bf16 v[36:39], v[16:19], a[16:23], v3
  v_smfmac_f32_16x16x64_bf16 v[40:43], v[16:19], a[72:79], v3
  v_smfmac_f32_16x16x64_bf16 v[44:47], v[16:19], a[128:135], v3
  buffer_load_dwordx4 v[92:95], v117, s[8:11], s26 offen offset:1024 sc1
  v_smfmac_f32_16x16x64_bf16 v[48:51], v[16:19], a[184:191], v3
  v_smfmac_f32_16x16x64_bf16 v[52:55], v[16:19], a[240:247], v3
  s_waitcnt vmcnt(5)
  v_cmp_eq_u32 vcc, -1, v20
  v_smfmac_f32_16x16x64_bf16 v[56:59], v[16:19], v[160:167], v3
  v_smfmac_f32_16x16x64_bf16 v[60:63], v[16:19], v[216:223], v3
  buffer_load_dwordx4 v[96:99], v2, s[8:11], s24 offen offset:0 sc1
  s_cbranch_vccnz cB_sc1_r3
cB_sc1_c3:
  v_smfmac_f32_16x16x64_bf16 v[36:39], v[20:23], a[24:31], v3
  v_smfmac_f32_16x16x64_bf16 v[40:43], v[20:23], a[80:87], v3
  s_waitcnt vmcnt(3)
  v_max3_u32 v66, v24, v27, v28
  v_smfmac_f32_16x16x64_bf16 v[44:47], v[20:23], a[136:143], v3
  v_max3_u32 v66, v66, v31, v32
  v_smfmac_f32_16x16x64_bf16 v[48:51], v[20:23], a[192:199], v3
  buffer_load_dwordx4 v[100:103], v2, s[8:11], s24 offen offset:1024 sc1
  v_max_u32 v66, v66, v35
  v_smfmac_f32_16x16x64_bf16 v[52:55], v[20:23], a[248:255], v3
  v_cmp_eq_u32 vcc, -1, v66
  v_smfmac_f32_16x16x64_bf16 v[56:59], v[20:23], v[168:175], v3
  v_smfmac_f32_16x16x64_bf16 v[60:63], v[20:23], v[224:231], v3
  s_cbranch_vccnz cB_sc1_r4
cB_sc1_c4:
  v_smfmac_f32_16x16x64_bf16 v[60:63], v[28:31], v[232:239], v3
  buffer_load_dwordx4 v[104:107], v2, s[8:11], s26 offen offset:0 sc1
  v_smfmac_f32_16x16x64_bf16 v[60:63], v[24:27], v[240:247], v3
  v_smfmac_f32_16x16x64_bf16 v[60:63], v[32:35], v[248:255], v3
  v_smfmac_f32_16x16x64_bf16 v[52:55], v[28:31], v[120:127], v3
  v_smfmac_f32_16x16x64_bf16 v[52:55], v[24:27], v[128:135], v3
  buffer_load_dwordx4 v[108:111], v2, s[8:11], s26 offen offset:1024 sc1
  v_smfmac_f32_16x16x64_bf16 v[52:55], v[32:35], v[136:143], v3
  v_cvt_pk_bf16_f32 v63, v62, v63
  v_smfmac_f32_16x16x64_bf16 v[56:59], v[28:31], v[176:183], v3
  v_cvt_pk_bf16_f32 v62, v60, v61
  v_smfmac_f32_16x16x64_bf16 v[56:59], v[24:27], v[184:191], v3
  v_mfma_f32_16x16x32_bf16 v[8:11], v[62:65], v[4:7], 0
  v_cvt_pk_bf16_f32 v55, v54, v55
  v_smfmac_f32_16x16x64_bf16 v[56:59], v[32:35], v[192:199], v3
  v_cvt_pk_bf16_f32 v54, v52, v53
  v_smfmac_f32_16x16x64_bf16 v[36:39], v[28:31], a[32:39], v3
  s_nop 1
  v_cvt_pk_bf16_f32 v78, v8, v9
  v_smfmac_f32_16x16x64_bf16 v[36:39], v[24:27], a[40:47], v3
  v_cvt_pk_bf16_f32 v79, v10, v11
  v_smfmac_f32_16x16x64_bf16 v[36:39], v[32:35], a[48:55], v3
  v_cvt_pk_bf16_f32 v56, v56, v57
  v_smfmac_f32_16x16x64_bf16 v[40:43], v[28:31], a[88:95], v3
  v_cvt_pk_bf16_f32 v57, v58, v59
  v_smfmac_f32_16x16x64_bf16 v[40:43], v[24:27], a[96:103], v3
  v_mfma_f32_16x16x32_bf16 v[16:19], v[54:57], v[4:7], 0
  v_cvt_pk_bf16_f32 v39, v38, v39
  v_smfmac_f32_16x16x64_bf16 v[40:43], v[32:35], a[104:111], v3
  v_cvt_pk_bf16_f32 v38, v36, v37
  v_smfmac_f32_16x16x64_bf16 v[44:47], v[28:31], a[144:151], v3
  s_nop 1
  v_cvt_pk_bf16_f32 v76, v16, v17
  v_smfmac_f32_16x16x64_bf16 v[44:47], v[24:27], a[152:159], v3
  v_cvt_pk_bf16_f32 v77, v18, v19
  v_smfmac_f32_16x16x64_bf16 v[44:47], v[32:35], a[160:167], v3
  v_cvt_pk_bf16_f32 v40, v40, v41
  v_smfmac_f32_16x16x64_bf16 v[48:51], v[28:31], a[200:207], v3
  v_cvt_pk_bf16_f32 v41, v42, v43
  v_smfmac_f32_16x16x64_bf16 v[48:51], v[24:27], a[208:215], v3
  v_smfmac_f32_16x16x64_bf16 v[48:51], v[32:35], a[216:223], v3
  s_waitcnt vmcnt(4)
  v_cvt_pk_bf16_f32 v47, v46, v47
  v_smfmac_f32_16x16x64_bf16 v[68:71], v[76:79], v[80:87], v3
  v_cvt_pk_bf16_f32 v46, v44, v45
  v_mfma_f32_16x16x32_bf16 v[8:11], v[38:41], v[4:7], 0
  s_nop 1
  v_cvt_pk_bf16_f32 v48, v48, v49
  v_cvt_pk_bf16_f32 v49, v50, v51
  s_nop 1
  v_mfma_f32_16x16x32_bf16 v[16:19], v[46:49], v[4:7], 0
  v_smfmac_f32_16x16x64_bf16 v[72:75], v[76:79], v[88:95], v3
  v_cvt_pk_bf16_f32 v20, v8, v9
  v_mfma_f32_16x16x32_bf16 v[52:55], v[30:33], v[76:79], 0
  s_waitcnt vmcnt(0)
  v_cvt_pk_bf16_f32 v21, v10, v11
  v_cvt_pk_bf16_f32 v22, v16, v17
  v_cvt_pk_bf16_f32 v23, v18, v19
  s_nop 1
  v_mfma_f32_16x16x32_bf16 v[52:55], v[12:15], v[20:23], v[52:55]
  v_smfmac_f32_16x16x64_bf16 v[68:71], v[20:23], v[96:103], v3
  v_smfmac_f32_16x16x64_bf16 v[72:75], v[20:23], v[104:111], v3
  s_nop 1
  ds_write_b128 v113, v[52:55]
  s_nop 1
  v_permlane32_swap_b32 v68, v70
  v_permlane32_swap_b32 v69, v71
  v_add_f32 v56, v68, v70
  v_add_f32 v58, v69, v71
  v_permlane32_swap_b32 v72, v74
  v_permlane32_swap_b32 v73, v75
  v_add_f32 v57, v72, v74
  v_add_f32 v59, v73, v75
  ds_write_b128 v2, v[56:59] offset:1024
  v_cmp_u_f32 vcc, v57, v59
  v_mov_b32 v68, 0
  v_mov_b32 v69, 0
  v_mov_b32 v70, 0
  v_mov_b32 v71, 0
  s_cbranch_vccnz cB_sc1_retry
cB_sc1_cont:
  s_add_u32 s24, s24, 28672
  s_add_u32 s26, s26, 28672
  buffer_load_dwordx4 v[80:83], v117, s[8:11], s24 offen offset:0 sc1
  buffer_load_dwordx4 v[84:87], v117, s[8:11], s24 offen offset:1024 sc1
  v_mov_b32 v72, 0
  v_mov_b32 v73, 0
  v_mfma_f32_32x32x16_bf16 v[36:51], v[68:71], v[68:71], 0
  s_waitcnt lgkmcnt(0)
  s_barrier
  ds_read_b64 v[8:9], v114 offset:0
  ds_read_b64 v[10:11], v114 offset:1024
  ds_read_b64 v[12:13], v114 offset:2048
  ds_read_b64 v[14:15], v114 offset:3072
  ds_read2_b32 v[16:17], v115 offset0:0 offset1:64
  ds_read2_b32 v[18:19], v115 offset0:128 offset1:192
  v_mfma_f32_32x32x16_bf16 v[52:67], v[68:71], v[68:71], 0
  s_waitcnt lgkmcnt(0)
  v_pk_add_f32 v[16:17], v[16:17], v[18:19]
  v_pk_add_f32 v[8:9], v[8:9], v[10:11]
  v_pk_add_f32 v[12:13], v[12:13], v[14:15]
  v_add_f32 v20, v16, v17
  v_pk_add_f32 v[8:9], v[8:9], v[12:13]
  v_max_f32 v22, v8, v9
  v_add_f32_dpp v20, v20, v20 row_ror:8 row_mask:0xf bank_mask:0xf
  s_nop 0
  v_max_f32_dpp v22, v22, v22 row_ror:8 row_mask:0xf bank_mask:0xf
  v_max_f32 v22, v22, v20
  buffer_store_dword v112, v116, s[8:11], 0 offen sc1
  s_nop 0
  v_max_f32_dpp v22, v22, v22 quad_perm:[1,0,3,2] row_mask:0xf bank_mask:0xf
  s_nop 1
  v_max_f32_dpp v22, v22, v22 quad_perm:[2,3,0,1] row_mask:0xf bank_mask:0xf
  s_nop 1
  v_max_f32_dpp v22, v22, v22 row_half_mirror row_mask:0xf bank_mask:0xf
  v_pk_add_f32 v[8:9], v[8:9], v[22:23] op_sel_hi:[1,0] neg_lo:[0,1] neg_hi:[0,1]
  v_sub_f32 v20, v20, v22
  v_exp_f32 v8, v8
  v_exp_f32 v9, v9
  v_exp_f32 v20, v20
  v_add_f32 v24, v8, v9
  v_fmac_f32 v24, 0.5, v20
  v_mov_b32_dpp v21, v20 quad_perm:[1,0,3,2] row_mask:0xf bank_mask:0xf
  s_nop 0
  v_add_f32_dpp v24, v24, v24 quad_perm:[1,0,3,2] row_mask:0xf bank_mask:0xf
  s_nop 1
  v_add_f32_dpp v24, v24, v24 quad_perm:[2,3,0,1] row_mask:0xf bank_mask:0xf
  s_nop 1
  v_add_f32_dpp v24, v24, v24 row_half_mirror row_mask:0xf bank_mask:0xf
  s_nop 1
  v_add_f32_dpp v24, v24, v24 row_ror:8 row_mask:0xf bank_mask:0xf
  v_rcp_f32 v24, v24
  s_nop 0
  v_pk_mul_f32 v[8:9], v[8:9], v[24:25] op_sel_hi:[1,0]
  v_cvt_pk_bf16_f32 v8, abs(v8), abs(v9)
  buffer_store_dword v8, v1, s[8:11], s20 offen sc1
  v_pk_mul_f32 v[20:21], v[20:21], v[24:25] op_sel_hi:[1,0]
  v_cvt_pk_bf16_f32 v20, abs(v20), abs(v21)
  buffer_store_dword v20, v118, s[8:11], s20 offen sc1
  v_mov_b32 v74, 0
  v_mov_b32 v75, 0
  s_mov_b32 s19, s18
  s_add_u32 s18, s18, 1
  s_mov_b32 s22, s20
  s_mov_b32 s20, s21
  s_mov_b32 s21, s22
  s_add_u32 s23, s20, 4096
  v_mov_b32 v112, s18
  s_cmp_lt_u32 s19, 63
  s_nop 0
  s_cbranch_scc1 cB_sc1_loop
  s_branch cB_done
cB_sc1_r0:
  s_add_u32 s31, s31, 1
  buffer_load_dwordx4 v[8:11], v2, s[8:11], s20 offen offset:0 sc1
  s_waitcnt vmcnt(0)
  v_cmp_eq_u32 vcc, -1, v8
  v_mov_b32 v36, 0
  v_mov_b32 v37, 0
  v_mov_b32 v38, 0
  v_mov_b32 v39, 0
  v_mov_b32 v40, 0
  v_mov_b32 v41, 0
  v_mov_b32 v42, 0
  v_mov_b32 v43, 0
  v_mov_b32 v44, 0
  v_mov_b32 v45, 0
  v_mov_b32 v46, 0
  v_mov_b32 v47, 0
  v_mov_b32 v48, 0
  v_mov_b32 v49, 0
  v_mov_b32 v50, 0
  v_mov_b32 v51, 0
  s_nop 1
  s_cbranch_vccz cB_sc1_go
  s_add_u32 s30, s30, 1
  s_cmp_lt_u32 s30, 400000
  s_cbranch_scc1 cB_sc1_r0
  s_branch cB_abort
cB_sc1_r1:
  s_add_u32 s31, s31, 1
  buffer_load_dwordx4 v[12:15], v2, s[8:11], s20 offen offset:1024 sc1
  s_waitcnt vmcnt(0)
  v_cmp_eq_u32 vcc, -1, v12
  s_nop 4
  s_cbranch_vccz cB_sc1_c1
  s_add_u32 s30, s30, 1
  s_cmp_lt_u32 s30, 400000
  s_cbranch_scc1 cB_sc1_r1
  s_branch cB_abort
cB_sc1_r2:
  s_add_u32 s31, s31, 1
  buffer_load_dwordx4 v[16:19], v2, s[8:11], s20 offen offset:2048 sc1
  s_waitcnt vmcnt(0)
  v_cmp_eq_u32 vcc, -1, v16
  s_nop 4
  s_cbranch_vccz cB_sc1_c2
  s_add_u32 s30, s30, 1
  s_cmp_lt_u32 s30, 400000
  s_cbranch_scc1 cB_sc1_r2
  s_branch cB_abort
cB_sc1_r3:
  s_add_u32 s31, s31, 1
  buffer_load_dwordx4 v[20:23], v2, s[8:11], s20 offen offset:3072 sc1
  s_waitcnt vmcnt(0)
  v_cmp_eq_u32 vcc, -1, v20
  s_nop 4
  s_cbranch_vccz cB_sc1_c3
  s_add_u32 s30, s30, 1
  s_cmp_lt_u32 s30, 400000
  s_cbranch_scc1 cB_sc1_r3
  s_branch cB_abort
cB_sc1_r4:
  s_add_u32 s31, s31, 1
  buffer_load_dwordx4 v[28:31], v2, s[8:11], s23 offen offset:0 sc1
  buffer_load_dwordx4 v[24:27], v2, s[8:11], s23 offen offset:1024 sc1
  buffer_load_dwordx4 v[32:35], v2, s[8:11], s23 offen offset:2048 sc1
  s_waitcnt vmcnt(0)
  v_max3_u32 v66, v24, v27, v28
  v_max3_u32 v66, v66, v31, v32
  v_max_u32 v66, v66, v35
  v_cmp_eq_u32 vcc, -1, v66
  s_nop 4
  s_cbranch_vccz cB_sc1_c4
  s_add_u32 s30, s30, 1
  s_cmp_lt_u32 s30, 400000
  s_cbranch_scc1 cB_sc1_r4
  s_branch cB_abort
cB_sc1_retry:
  s_cmp_lg_u32 s62, 0
  s_cbranch_scc1 cB_sc1_cont
  s_waitcnt vmcnt(0) lgkmcnt(0)
cB_sc1_rv:
  buffer_load_dwordx4 v[8:11], v2, s[8:11], s20 offen offset:0 sc1
  buffer_load_dwordx4 v[12:15], v2, s[8:11], s20 offen offset:1024 sc1
  buffer_load_dwordx4 v[16:19], v2, s[8:11], s20 offen offset:2048 sc1
  buffer_load_dwordx4 v[20:23], v2, s[8:11], s20 offen offset:3072 sc1
  buffer_load_dwordx4 v[28:31], v2, s[8:11], s23 offen offset:0 sc1
  buffer_load_dwordx4 v[24:27], v2, s[8:11], s23 offen offset:1024 sc1
  buffer_load_dwordx4 v[32:35], v2, s[8:11], s23 offen offset:2048 sc1
  s_waitcnt vmcnt(0)
  v_max3_u32 v66, v8, v9, v10
  v_max3_u32 v66, v66, v11, v12
  v_max3_u32 v66, v66, v13, v14
  v_max3_u32 v66, v66, v15, v16
  v_max3_u32 v66, v66, v17, v18
  v_max3_u32 v66, v66, v19, v20
  v_max3_u32 v66, v66, v21, v22
  v_max3_u32 v66, v66, v23, v24
  v_max3_u32 v66, v66, v25, v26
  v_max3_u32 v66, v66, v27, v28
  v_max3_u32 v66, v66, v29, v30
  v_max3_u32 v66, v66, v31, v32
  v_max3_u32 v66, v66, v33, v34
  v_max_u32 v66, v66, v35
  v_cmp_eq_u32 vcc, -1, v66
  s_cbranch_vccz cB_sc1_rk
  s_add_u32 s30, s30, 1
  s_cmp_lt_u32 s30, 400000
  s_cbranch_scc1 cB_sc1_rv
  s_branch cB_abort
cB_sc1_rk:
  s_mov_b32 s62, 1
  v_mov_b32 v36, 0
  v_mov_b32 v37, 0
  v_mov_b32 v38, 0
  v_mov_b32 v39, 0
  v_mov_b32 v40, 0
  v_mov_b32 v41, 0
  v_mov_b32 v42, 0
  v_mov_b32 v43, 0
  v_mov_b32 v44, 0
  v_mov_b32 v45, 0
  v_mov_b32 v46, 0
  v_mov_b32 v47, 0
  v_mov_b32 v48, 0
  v_mov_b32 v49, 0
  v_mov_b32 v50, 0
  v_mov_b32 v51, 0
  v_mov_b32 v60, 0
  v_mov_b32 v61, 0
  v_mov_b32 v62, 0
  v_mov_b32 v63, 0
  v_mov_b32 v68, 0
  v_mov_b32 v69, 0
  v_mov_b32 v70, 0
  v_mov_b32 v71, 0
  v_mov_b32 v72, 0
  v_mov_b32 v73, 0
  v_mov_b32 v74, 0
  v_mov_b32 v75, 0
  v_mov_b32 v52, 0
  v_mov_b32 v53, 0
  v_mov_b32 v54, 0
  v_mov_b32 v55, 0
  v_mov_b32 v56, 0
  v_mov_b32 v57, 0
  v_mov_b32 v58, 0
  v_mov_b32 v59, 0
  s_add_u32 s31, s31, 0x100
  s_nop 0
  s_branch cB_sc1_go
.p2align 6
cB_sc2_loop:
  s_mov_b32 s30, 0
  s_mov_b32 s62, 0
  s_setprio 3
  s_barrier
  buffer_load_dwordx4 v[8:11], v2, s[8:11], s20 offen offset:0 sc1
  s_setprio 2
  buffer_load_dwordx4 v[12:15], v2, s[8:11], s20 offen offset:1024 sc1
  s_setprio 1
  buffer_load_dwordx4 v[16:19], v2, s[8:11], s20 offen offset:2048 sc1
  s_setprio 0
  buffer_load_dwordx4 v[20:23], v2, s[8:11], s20 offen offset:3072 sc1
cB_sc2_go:
  s_waitcnt vmcnt(3)
  v_smfmac_f32_16x16x64_bf16 v[36:39], v[8:11], a[0:7], v3
  buffer_load_dwordx4 v[24:27], v2, s[8:11], s23 offen offset:0 sc1
  v_cmp_eq_u32 vcc, -1, v8
  v_smfmac_f32_16x16x64_bf16 v[40:43], v[8:11], a[56:63], v3
  v_smfmac_f32_16x16x64_bf16 v[44:47], v[8:11], a[112:119], v3
  buffer_load_dwordx4 v[32:35], v2, s[8:11], s23 offen offset:1024 sc1
  s_cbranch_vccnz cB_sc2_r0
  v_smfmac_f32_16x16x64_bf16 v[48:51], v[8:11], a[168:175], v3
  v_smfmac_f32_16x16x64_bf16 v[52:55], v[8:11], a[224:231], v3
  s_waitcnt vmcnt(4)
  v_cmp_eq_u32 vcc, -1, v12
  v_smfmac_f32_16x16x64_bf16 v[56:59], v[8:11], v[144:151], v3
  buffer_load_dwordx4 v[28:31], v2, s[8:11], s23 offen offset:2048 sc1
  v_smfmac_f32_16x16x64_bf16 v[62:65], v[8:11], v[200:207], v3
  s_cbranch_vccnz cB_sc2_r1
cB_sc2_c1:
  v_smfmac_f32_16x16x64_bf16 v[36:39], v[12:15], a[8:15], v3
  v_smfmac_f32_16x16x64_bf16 v[40:43], v[12:15], a[64:71], v3
  v_smfmac_f32_16x16x64_bf16 v[44:47], v[12:15], a[120:127], v3
  v_smfmac_f32_16x16x64_bf16 v[48:51], v[12:15], a[176:183], v3
  v_smfmac_f32_16x16x64_bf16 v[52:55], v[12:15], a[232:239], v3
  s_waitcnt vmcnt(4)
  v_cmp_eq_u32 vcc, -1, v16
  v_smfmac_f32_16x16x64_bf16 v[56:59], v[12:15], v[152:159], v3
  buffer_load_dwordx4 v[88:91], v117, s[8:11], s26 offen offset:0 sc1
  v_smfmac_f32_16x16x64_bf16 v[62:65], v[12:15], v[208:215], v3
  s_cbranch_vccnz cB_sc2_r2
cB_sc2_c2:
  v_smfmac_f32_16x16x64_bf16 v[36:39], v[16:19], a[16:23], v3
  v_smfmac_f32_16x16x64_bf16 v[40:43], v[16:19], a[72:79], v3
  v_smfmac_f32_16x16x64_bf16 v[44:47], v[16:19], a[128:135], v3
  buffer_load_dwordx4 v[92:95], v117, s[8:11], s26 offen offset:1024 sc1
  v_smfmac_f32_16x16x64_bf16 v[48:51], v[16:19], a[184:191], v3
  v_smfmac_f32_16x16x64_bf16 v[52:55], v[16:19], a[240:247], v3
  s_waitcnt vmcnt(5)
  v_cmp_eq_u32 vcc, -1, v20
  v_smfmac_f32_16x16x64_bf16 v[56:59], v[16:19], v[160:167], v3
  v_smfmac_f32_16x16x64_bf16 v[62:65], v[16:19], v[216:223], v3
  buffer_load_dwordx4 v[96:99], v2, s[8:11], s24 offen offset:0 sc1
  s_cbranch_vccnz cB_sc2_r3
cB_sc2_c3:
  v_smfmac_f32_16x16x64_bf16 v[36:39], v[20:23], a[24:31], v3
  v_smfmac_f32_16x16x64_bf16 v[40:43], v[20:23], a[80:87], v3
  s_waitcnt vmcnt(3)
  v_max3_u32 v66, v24, v27, v28
  v_smfmac_f32_16x16x64_bf16 v[44:47], v[20:23], a[136:143], v3
  v_max3_u32 v66, v66, v31, v32
  v_smfmac_f32_16x16x64_bf16 v[48:51], v[20:23], a[192:199], v3
  buffer_load_dwordx4 v[100:103], v2, s[8:11], s24 offen offset:1024 sc1
  v_max_u32 v66, v66, v35
  v_smfmac_f32_16x16x64_bf16 v[52:55], v[20:23], a[248:255], v3
  v_cmp_eq_u32 vcc, -1, v66
  v_smfmac_f32_16x16x64_bf16 v[56:59], v[20:23], v[168:175], v3
  v_smfmac_f32_16x16x64_bf16 v[62:65], v[20:23], v[224:231], v3
  s_cbranch_vccnz cB_sc2_r4
cB_sc2_c4:
  v_smfmac_f32_16x16x64_bf16 v[62:65], v[24:27], v[232:239], v3
  buffer_load_dwordx4 v[104:107], v2, s[8:11], s26 offen offset:0 sc1
  v_smfmac_f32_16x16x64_bf16 v[62:65], v[32:35], v[240:247], v3
  v_smfmac_f32_16x16x64_bf16 v[62:65], v[28:31], v[248:255], v3
  v_smfmac_f32_16x16x64_bf16 v[52:55], v[24:27], v[120:127], v3
  v_smfmac_f32_16x16x64_bf16 v[52:55], v[32:35], v[128:135], v3
  buffer_load_dwordx4 v[108:111], v2, s[8:11], s26 offen offset:1024 sc1
  v_smfmac_f32_16x16x64_bf16 v[52:55], v[28:31], v[136:143], v3
  v_cvt_pk_bf16_f32 v62, v62, v63
  v_smfmac_f32_16x16x64_bf16 v[56:59], v[24:27], v[176:183], v3
  v_cvt_pk_bf16_f32 v63, v64, v65
  v_smfmac_f32_16x16x64_bf16 v[56:59], v[32:35], v[184:191], v3
  v_mfma_f32_16x16x32_bf16 v[8:11], v[60:63], v[4:7], 0
  v_cvt_pk_bf16_f32 v55, v54, v55
  v_smfmac_f32_16x16x64_bf16 v[56:59], v[28:31], v[192:199], v3
  v_cvt_pk_bf16_f32 v54, v52, v53
  v_smfmac_f32_16x16x64_bf16 v[36:39], v[24:27], a[32:39], v3
  s_nop 1
  v_cvt_pk_bf16_f32 v76, v8, v9
  v_smfmac_f32_16x16x64_bf16 v[36:39], v[32:35], a[40:47], v3
  v_cvt_pk_bf16_f32 v77, v10, v11
  v_smfmac_f32_16x16x64_bf16 v[36:39], v[28:31], a[48:55], v3
  v_cvt_pk_bf16_f32 v56, v56, v57
  v_smfmac_f32_16x16x64_bf16 v[40:43], v[24:27], a[88:95], v3
  v_cvt_pk_bf16_f32 v57, v58, v59
  v_smfmac_f32_16x16x64_bf16 v[40:43], v[32:35], a[96:103], v3
  v_mfma_f32_16x16x32_bf16 v[12:15], v[54:57], v[4:7], 0
  v_cvt_pk_bf16_f32 v39, v38, v39
  v_smfmac_f32_16x16x64_bf16 v[40:43], v[28:31], a[104:111], v3
  v_cvt_pk_bf16_f32 v38, v36, v37
  v_smfmac_f32_16x16x64_bf16 v[44:47], v[24:27], a[144:151], v3
  s_nop 1
  v_cvt_pk_bf16_f32 v78, v12, v13
  v_smfmac_f32_16x16x64_bf16 v[44:47], v[32:35], a[152:159], v3
  v_cvt_pk_bf16_f32 v79, v14, v15
  v_smfmac_f32_16x16x64_bf16 v[44:47], v[28:31], a[160:167], v3
  v_cvt_pk_bf16_f32 v40, v40, v41
  v_smfmac_f32_16x16x64_bf16 v[48:51], v[24:27], a[200:207], v3
  v_cvt_pk_bf16_f32 v41, v42, v43
  v_smfmac_f32_16x16x64_bf16 v[48:51], v[32:35], a[208:215], v3
  v_smfmac_f32_16x16x64_bf16 v[48:51], v[28:31], a[216:223], v3
  s_waitcnt vmcnt(4)
  v_cvt_pk_bf16_f32 v47, v46, v47
  v_smfmac_f32_16x16x64_bf16 v[68:71], v[76:79], v[80:87], v3
  v_cvt_pk_bf16_f32 v46, v44, v45
  v_mfma_f32_16x16x32_bf16 v[8:11], v[38:41], v[4:7], 0
  s_nop 1
  v_cvt_pk_bf16_f32 v48, v48, v49
  v_cvt_pk_bf16_f32 v49, v50, v51
  s_nop 1
  v_mfma_f32_16x16x32_bf16 v[12:15], v[46:49], v[4:7], 0
  v_smfmac_f32_16x16x64_bf16 v[72:75], v[76:79], v[88:95], v3
  v_cvt_pk_bf16_f32 v20, v8, v9
  v_mfma_f32_16x16x32_bf16 v[52:55], v[30:33], v[76:79], 0
  s_waitcnt vmcnt(0)
  v_cvt_pk_bf16_f32 v21, v10, v11
  v_cvt_pk_bf16_f32 v22, v12, v13
  v_cvt_pk_bf16_f32 v23, v14, v15
  s_nop 1
  v_mfma_f32_16x16x32_bf16 v[52:55], v[16:19], v[20:23], v[52:55]
  v_smfmac_f32_16x16x64_bf16 v[68:71], v[20:23], v[96:103], v3
  v_smfmac_f32_16x16x64_bf16 v[72:75], v[20:23], v[104:111], v3
  s_nop 1
  ds_write_b128 v113, v[52:55]
  s_nop 1
  v_permlane32_swap_b32 v68, v70
  v_permlane32_swap_b32 v69, v71
  v_add_f32 v56, v68, v70
  v_add_f32 v58, v69, v71
  v_permlane32_swap_b32 v72, v74
  v_permlane32_swap_b32 v73, v75
  v_add_f32 v57, v72, v74
  v_add_f32 v59, v73, v75
  ds_write_b128 v2, v[56:59] offset:2048
  v_cmp_u_f32 vcc, v57, v59
  v_mov_b32 v68, 0
  v_mov_b32 v69, 0
  v_mov_b32 v70, 0
  v_mov_b32 v71, 0
  s_cbranch_vccnz cB_sc2_retry
cB_sc2_cont:
  s_add_u32 s24, s24, 28672
  s_add_u32 s26, s26, 28672
  buffer_load_dwordx4 v[80:83], v117, s[8:11], s24 offen offset:0 sc1
  buffer_load_dwordx4 v[84:87], v117, s[8:11], s24 offen offset:1024 sc1
  v_mov_b32 v72, 0
  v_mov_b32 v73, 0
  v_mfma_f32_32x32x16_bf16 v[36:51], v[68:71], v[68:71], 0
  s_waitcnt lgkmcnt(0)
  s_barrier
  v_mfma_f32_32x32x16_bf16 v[52:67], v[68:71], v[68:71], 0
  buffer_store_dwordx2 v[118:119], v114, s[8:11], s21 offen sc1
  buffer_store_dwordx2 v[118:119], v115, s[8:11], s21 offen sc1
  s_buffer_load_dword s70, s[8:11], s35
  s_add_u32 s22, s24, 114688
  s_buffer_load_dword s71, s[8:11], s22
  s_mul_i32 s22, s18, 7168
  s_add_u32 s22, s22, 87040
  s_buffer_load_dword s72, s[8:11], s22
  s_add_u32 s35, s35, 458752
  v_mov_b32 v74, 0
  v_mov_b32 v75, 0
  s_mov_b32 s19, s18
  s_add_u32 s18, s18, 1
  s_mov_b32 s22, s20
  s_mov_b32 s20, s21
  s_mov_b32 s21, s22
  s_add_u32 s23, s20, 4096
  s_cmp_lt_u32 s19, 63
  s_cbranch_scc1 cB_sc2_loop
  s_branch cB_done
cB_sc2_r0:
  s_add_u32 s31, s31, 1
  buffer_load_dwordx4 v[8:11], v2, s[8:11], s20 offen offset:0 sc1
  s_waitcnt vmcnt(0)
  v_cmp_eq_u32 vcc, -1, v8
  v_mov_b32 v36, 0
  v_mov_b32 v37, 0
  v_mov_b32 v38, 0
  v_mov_b32 v39, 0
  v_mov_b32 v40, 0
  v_mov_b32 v41, 0
  v_mov_b32 v42, 0
  v_mov_b32 v43, 0
  v_mov_b32 v44, 0
  v_mov_b32 v45, 0
  v_mov_b32 v46, 0
  v_mov_b32 v47, 0
  v_mov_b32 v48, 0
  v_mov_b32 v49, 0
  v_mov_b32 v50, 0
  v_mov_b32 v51, 0
  s_nop 1
  s_cbranch_vccz cB_sc2_go
  s_add_u32 s30, s30, 1
  s_cmp_lt_u32 s30, 400000
  s_cbranch_scc1 cB_sc2_r0
  s_branch cB_abort
cB_sc2_r1:
  s_add_u32 s31, s31, 1
  buffer_load_dwordx4 v[12:15], v2, s[8:11], s20 offen offset:1024 sc1
  s_waitcnt vmcnt(0)
  v_cmp_eq_u32 vcc, -1, v12
  s_nop 4
  s_cbranch_vccz cB_sc2_c1
  s_add_u32 s30, s30, 1
  s_cmp_lt_u32 s30, 400000
  s_cbranch_scc1 cB_sc2_r1
  s_branch cB_abort
cB_sc2_r2:
  s_add_u32 s31, s31, 1
  buffer_load_dwordx4 v[16:19], v2, s[8:11], s20 offen offset:2048 sc1
  s_waitcnt vmcnt(0)
  v_cmp_eq_u32 vcc, -1, v16
  s_nop 4
  s_cbranch_vccz cB_sc2_c2
  s_add_u32 s30, s30, 1
  s_cmp_lt_u32 s30, 400000
  s_cbranch_scc1 cB_sc2_r2
  s_branch cB_abort
cB_sc2_r3:
  s_add_u32 s31, s31, 1
  buffer_load_dwordx4 v[20:23], v2, s[8:11], s20 offen offset:3072 sc1
  s_waitcnt vmcnt(0)
  v_cmp_eq_u32 vcc, -1, v20
  s_nop 4
  s_cbranch_vccz cB_sc2_c3
  s_add_u32 s30, s30, 1
  s_cmp_lt_u32 s30, 400000
  s_cbranch_scc1 cB_sc2_r3
  s_branch cB_abort
cB_sc2_r4:
  s_add_u32 s31, s31, 1
  buffer_load_dwordx4 v[24:27], v2, s[8:11], s23 offen offset:0 sc1
  buffer_load_dwordx4 v[32:35], v2, s[8:11], s23 offen offset:1024 sc1
  buffer_load_dwordx4 v[28:31], v2, s[8:11], s23 offen offset:2048 sc1
  s_waitcnt vmcnt(0)
  v_max3_u32 v66, v24, v27, v28
  v_max3_u32 v66, v66, v31, v32
  v_max_u32 v66, v66, v35
  v_cmp_eq_u32 vcc, -1, v66
  s_nop 4
  s_cbranch_vccz cB_sc2_c4
  s_add_u32 s30, s30, 1
  s_cmp_lt_u32 s30, 400000
  s_cbranch_scc1 cB_sc2_r4
  s_branch cB_abort
cB_sc2_retry:
  s_cmp_lg_u32 s62, 0
  s_cbranch_scc1 cB_sc2_cont
  s_waitcnt vmcnt(0) lgkmcnt(0)
cB_sc2_rv:
  buffer_load_dwordx4 v[8:11], v2, s[8:11], s20 offen offset:0 sc1
  buffer_load_dwordx4 v[12:15], v2, s[8:11], s20 offen offset:1024 sc1
  buffer_load_dwordx4 v[16:19], v2, s[8:11], s20 offen offset:2048 sc1
  buffer_load_dwordx4 v[20:23], v2, s[8:11], s20 offen offset:3072 sc1
  buffer_load_dwordx4 v[24:27], v2, s[8:11], s23 offen offset:0 sc1
  buffer_load_dwordx4 v[32:35], v2, s[8:11], s23 offen offset:1024 sc1
  buffer_load_dwordx4 v[28:31], v2, s[8:11], s23 offen offset:2048 sc1
  s_waitcnt vmcnt(0)
  v_max3_u32 v66, v8, v9, v10
  v_max3_u32 v66, v66, v11, v12
  v_max3_u32 v66, v66, v13, v14
  v_max3_u32 v66, v66, v15, v16
  v_max3_u32 v66, v66, v17, v18
  v_max3_u32 v66, v66, v19, v20
  v_max3_u32 v66, v66, v21, v22
  v_max3_u32 v66, v66, v23, v24
  v_max3_u32 v66, v66, v25, v26
  v_max3_u32 v66, v66, v27, v28
  v_max3_u32 v66, v66, v29, v30
  v_max3_u32 v66, v66, v31, v32
  v_max3_u32 v66, v66, v33, v34
  v_max_u32 v66, v66, v35
  v_cmp_eq_u32 vcc, -1, v66
  s_cbranch_vccz cB_sc2_rk
  s_add_u32 s30, s30, 1
  s_cmp_lt_u32 s30, 400000
  s_cbranch_scc1 cB_sc2_rv
  s_branch cB_abort
cB_sc2_rk:
  s_mov_b32 s62, 1
  v_mov_b32 v36, 0
  v_mov_b32 v37, 0
  v_mov_b32 v38, 0
  v_mov_b32 v39, 0
  v_mov_b32 v40, 0
  v_mov_b32 v41, 0
  v_mov_b32 v42, 0
  v_mov_b32 v43, 0
  v_mov_b32 v44, 0
  v_mov_b32 v45, 0
  v_mov_b32 v46, 0
  v_mov_b32 v47, 0
  v_mov_b32 v48, 0
  v_mov_b32 v49, 0
  v_mov_b32 v50, 0
  v_mov_b32 v51, 0
  v_mov_b32 v62, 0
  v_mov_b32 v63, 0
  v_mov_b32 v64, 0
  v_mov_b32 v65, 0
  v_mov_b32 v68, 0
  v_mov_b32 v69, 0
  v_mov_b32 v70, 0
  v_mov_b32 v71, 0
  v_mov_b32 v72, 0
  v_mov_b32 v73, 0
  v_mov_b32 v74, 0
  v_mov_b32 v75, 0
  v_mov_b32 v52, 0
  v_mov_b32 v53, 0
  v_mov_b32 v54, 0
  v_mov_b32 v55, 0
  v_mov_b32 v56, 0
  v_mov_b32 v57, 0
  v_mov_b32 v58, 0
  v_mov_b32 v59, 0
  s_add_u32 s31, s31, 0x100
  s_nop 0
  s_branch cB_sc2_go
.p2align 6
cB_sc3_loop:
  s_mov_b32 s30, 0
  s_mov_b32 s62, 0
  s_setprio 3
  s_barrier
  buffer_load_dwordx4 v[8:11], v2, s[8:11], s20 offen offset:0 sc1
  s_setprio 2
  buffer_load_dwordx4 v[12:15], v2, s[8:11], s20 offen offset:1024 sc1
  s_setprio 1
  buffer_load_dwordx4 v[16:19], v2, s[8:11], s20 offen offset:2048 sc1
  s_setprio 0
  buffer_load_dwordx4 v[20:23], v2, s[8:11], s20 offen offset:3072 sc1
cB_sc3_go:
  s_waitcnt vmcnt(3)
  v_smfmac_f32_16x16x64_bf16 v[36:39], v[8:11], a[0:7], v3
  buffer_load_dwordx4 v[24:27], v2, s[8:11], s23 offen offset:0 sc1
  v_cmp_eq_u32 vcc, -1, v8
  v_smfmac_f32_16x16x64_bf16 v[40:43], v[8:11], a[56:63], v3
  v_smfmac_f32_16x16x64_bf16 v[44:47], v[8:11], a[112:119], v3
  buffer_load_dwordx4 v[28:31], v2, s[8:11], s23 offen offset:1024 sc1
  s_cbranch_vccnz cB_sc3_r0
  v_smfmac_f32_16x16x64_bf16 v[48:51], v[8:11], a[168:175], v3
  v_smfmac_f32_16x16x64_bf16 v[52:55], v[8:11], a[224:231], v3
  s_waitcnt vmcnt(4)
  v_cmp_eq_u32 vcc, -1, v12
  v_smfmac_f32_16x16x64_bf16 v[56:59], v[8:11], v[144:151], v3
  buffer_load_dwordx4 v[32:35], v2, s[8:11], s23 offen offset:2048 sc1
  v_smfmac_f32_16x16x64_bf16 v[62:65], v[8:11], v[200:207], v3
  s_cbranch_vccnz cB_sc3_r1
cB_sc3_c1:
  v_smfmac_f32_16x16x64_bf16 v[36:39], v[12:15], a[8:15], v3
  v_smfmac_f32_16x16x64_bf16 v[40:43], v[12:15], a[64:71], v3
  v_smfmac_f32_16x16x64_bf16 v[44:47], v[12:15], a[120:127], v3
  v_smfmac_f32_16x16x64_bf16 v[48:51], v[12:15], a[176:183], v3
  v_smfmac_f32_16x16x64_bf16 v[52:55], v[12:15], a[232:239], v3
  s_waitcnt vmcnt(4)
  v_cmp_eq_u32 vcc, -1, v16
  v_smfmac_f32_16x16x64_bf16 v[56:59], v[12:15], v[152:159], v3
  buffer_load_dwordx4 v[88:91], v117, s[8:11], s26 offen offset:0 sc1
  v_smfmac_f32_16x16x64_bf16 v[62:65], v[12:15], v[208:215], v3
  s_cbranch_vccnz cB_sc3_r2
cB_sc3_c2:
  v_smfmac_f32_16x16x64_bf16 v[36:39], v[16:19], a[16:23], v3
  v_smfmac_f32_16x16x64_bf16 v[40:43], v[16:19], a[72:79], v3
  v_smfmac_f32_16x16x64_bf16 v[44:47], v[16:19], a[128:135], v3
  buffer_load_dwordx4 v[92:95], v117, s[8:11], s26 offen offset:1024 sc1
  v_smfmac_f32_16x16x64_bf16 v[48:51], v[16:19], a[184:191], v3
  v_smfmac_f32_16x16x64_bf16 v[52:55], v[16:19], a[240:247], v3
  s_waitcnt vmcnt(5)
  v_cmp_eq_u32 vcc, -1, v20
  v_smfmac_f32_16x16x64_bf16 v[56:59], v[16:19], v[160:167], v3
  v_smfmac_f32_16x16x64_bf16 v[62:65], v[16:19], v[216:223], v3
  buffer_load_dwordx4 v[96:99], v2, s[8:11], s24 offen offset:0 sc1
  s_cbranch_vccnz cB_sc3_r3
cB_sc3_c3:
  v_smfmac_f32_16x16x64_bf16 v[36:39], v[20:23], a[24:31], v3
  v_smfmac_f32_16x16x64_bf16 v[40:43], v[20:23], a[80:87], v3
  s_waitcnt vmcnt(3)
  v_max3_u32 v66, v24, v27, v28
  v_smfmac_f32_16x16x64_bf16 v[44:47], v[20:23], a[136:143], v3
  v_max3_u32 v66, v66, v31, v32
  v_smfmac_f32_16x16x64_bf16 v[48:51], v[20:23], a[192:199], v3
  buffer_load_dwordx4 v[100:103], v2, s[8:11], s24 offen offset:1024 sc1
  v_max_u32 v66, v66, v35
  v_smfmac_f32_16x16x64_bf16 v[52:55], v[20:23], a[248:255], v3
  v_cmp_eq_u32 vcc, -1, v66
  v_smfmac_f32_16x16x64_bf16 v[56:59], v[20:23], v[168:175], v3
  v_smfmac_f32_16x16x64_bf16 v[62:65], v[20:23], v[224:231], v3
  s_cbranch_vccnz cB_sc3_r4
cB_sc3_c4:
  v_smfmac_f32_16x16x64_bf16 v[62:65], v[24:27], v[232:239], v3
  buffer_load_dwordx4 v[104:107], v2, s[8:11], s26 offen offset:0 sc1
  v_smfmac_f32_16x16x64_bf16 v[62:65], v[28:31], v[240:247], v3
  v_smfmac_f32_16x16x64_bf16 v[62:65], v[32:35], v[248:255], v3
  v_smfmac_f32_16x16x64_bf16 v[52:55], v[24:27], v[120:127], v3
  v_smfmac_f32_16x16x64_bf16 v[52:55], v[28:31], v[128:135], v3
  buffer_load_dwordx4 v[108:111], v2, s[8:11], s26 offen offset:1024 sc1
  v_smfmac_f32_16x16x64_bf16 v[52:55], v[32:35], v[136:143], v3
  v_cvt_pk_bf16_f32 v62, v62, v63
  v_smfmac_f32_16x16x64_bf16 v[56:59], v[24:27], v[176:183], v3
  v_cvt_pk_bf16_f32 v63, v64, v65
  v_smfmac_f32_16x16x64_bf16 v[56:59], v[28:31], v[184:191], v3
  v_mfma_f32_16x16x32_bf16 v[8:11], v[60:63], v[4:7], 0
  v_cvt_pk_bf16_f32 v55, v54, v55
  v_smfmac_f32_16x16x64_bf16 v[56:59], v[32:35], v[192:199], v3
  v_cvt_pk_bf16_f32 v54, v52, v53
  v_smfmac_f32_16x16x64_bf16 v[36:39], v[24:27], a[32:39], v3
  s_nop 1
  v_cvt_pk_bf16_f32 v78, v8, v9
  v_smfmac_f32_16x16x64_bf16 v[36:39], v[28:31], a[40:47], v3
  v_cvt_pk_bf16_f32 v79, v10, v11
  v_smfmac_f32_16x16x64_bf16 v[36:39], v[32:35], a[48:55], v3
  v_cvt_pk_bf16_f32 v56, v56, v57
  v_smfmac_f32_16x16x64_bf16 v[40:43], v[24:27], a[88:95], v3
  v_cvt_pk_bf16_f32 v57, v58, v59
  v_smfmac_f32_16x16x64_bf16 v[40:43], v[28:31], a[96:103], v3
  v_mfma_f32_16x16x32_bf16 v[12:15], v[54:57], v[4:7], 0
  v_cvt_pk_bf16_f32 v39, v38, v39
  v_smfmac_f32_16x16x64_bf16 v[40:43], v[32:35], a[104:111], v3
  v_cvt_pk_bf16_f32 v38, v36, v37
  v_smfmac_f32_16x16x64_bf16 v[44:47], v[24:27], a[144:151], v3
  s_nop 1
  v_cvt_pk_bf16_f32 v76, v12, v13
  v_smfmac_f32_16x16x64_bf16 v[44:47], v[28:31], a[152:159], v3
  v_cvt_pk_bf16_f32 v77, v14, v15
  v_smfmac_f32_16x16x64_bf16 v[44:47], v[32:35], a[160:167], v3
  v_cvt_pk_bf16_f32 v40, v40, v41
  v_smfmac_f32_16x16x64_bf16 v[48:51], v[24:27], a[200:207], v3
  v_cvt_pk_bf16_f32 v41, v42, v43
  v_smfmac_f32_16x16x64_bf16 v[48:51], v[28:31], a[208:215], v3
  v_smfmac_f32_16x16x64_bf16 v[48:51], v[32:35], a[216:223], v3
  s_waitcnt vmcnt(4)
  v_cvt_pk_bf16_f32 v47, v46, v47
  v_smfmac_f32_16x16x64_bf16 v[68:71], v[76:79], v[80:87], v3
  v_cvt_pk_bf16_f32 v46, v44, v45
  v_mfma_f32_16x16x32_bf16 v[8:11], v[38:41], v[4:7], 0
  s_nop 1
  v_cvt_pk_bf16_f32 v48, v48, v49
  v_cvt_pk_bf16_f32 v49, v50, v51
  s_nop 1
  v_mfma_f32_16x16x32_bf16 v[12:15], v[46:49], v[4:7], 0
  v_smfmac_f32_16x16x64_bf16 v[72:75], v[76:79], v[88:95], v3
  v_cvt_pk_bf16_f32 v16, v8, v9
  v_mfma_f32_16x16x32_bf16 v[52:55], v[30:33], v[76:79], 0
  s_waitcnt vmcnt(0)
  v_cvt_pk_bf16_f32 v17, v10, v11
  v_cvt_pk_bf16_f32 v18, v12, v13
  v_cvt_pk_bf16_f32 v19, v14, v15
  s_nop 1
  v_mfma_f32_16x16x32_bf16 v[52:55], v[20:23], v[16:19], v[52:55]
  v_smfmac_f32_16x16x64_bf16 v[68:71], v[16:19], v[96:103], v3
  v_smfmac_f32_16x16x64_bf16 v[72:75], v[16:19], v[104:111], v3
  s_nop 1
  ds_write_b128 v113, v[52:55]
  s_nop 1
  v_permlane32_swap_b32 v68, v70
  v_permlane32_swap_b32 v69, v71
  v_add_f32 v56, v68, v70
  v_add_f32 v58, v69, v71
  v_permlane32_swap_b32 v72, v74
  v_permlane32_swap_b32 v73, v75
  v_add_f32 v57, v72, v74
  v_add_f32 v59, v73, v75
  ds_write_b128 v2, v[56:59] offset:3072
  v_cmp_u_f32 vcc, v57, v59
  v_mov_b32 v68, 0
  v_mov_b32 v69, 0
  v_mov_b32 v70, 0
  v_mov_b32 v71, 0
  s_cbranch_vccnz cB_sc3_retry
cB_sc3_cont:
  s_add_u32 s24, s24, 28672
  s_add_u32 s26, s26, 28672
  buffer_load_dwordx4 v[80:83], v117, s[8:11], s24 offen offset:0 sc1
  buffer_load_dwordx4 v[84:87], v117, s[8:11], s24 offen offset:1024 sc1
  v_mov_b32 v72, 0
  v_mov_b32 v73, 0
  v_mfma_f32_16x16x32_bf16 v[62:65], v[68:71], v[68:71], 0
  s_waitcnt lgkmcnt(0)
  s_barrier
  v_mov_b32 v52, 0
  v_mov_b32 v53, 0
  v_mov_b32 v54, 0
  v_mov_b32 v55, 0
  v_mov_b32 v56, 0
  v_mov_b32 v57, 0
  v_mov_b32 v58, 0
  v_mov_b32 v59, 0
  v_mfma_f32_32x32x16_bf16 v[36:51], v[68:71], v[68:71], 0
  v_mov_b32 v74, 0
  v_mov_b32 v75, 0
  s_mov_b32 s19, s18
  s_add_u32 s18, s18, 1
  s_mov_b32 s22, s20
  s_mov_b32 s20, s21
  s_mov_b32 s21, s22
  s_add_u32 s23, s20, 4096
  s_cmp_lt_u32 s19, 63
  s_nop 2
  s_cbranch_scc1 cB_sc3_loop
  s_branch cB_done
cB_sc3_r0:
  s_add_u32 s31, s31, 1
  buffer_load_dwordx4 v[8:11], v2, s[8:11], s20 offen offset:0 sc1
  s_waitcnt vmcnt(0)
  v_cmp_eq_u32 vcc, -1, v8
  v_mov_b32 v36, 0
  v_mov_b32 v37, 0
  v_mov_b32 v38, 0
  v_mov_b32 v39, 0
  v_mov_b32 v40, 0
  v_mov_b32 v41, 0
  v_mov_b32 v42, 0
  v_mov_b32 v43, 0
  v_mov_b32 v44, 0
  v_mov_b32 v45, 0
  v_mov_b32 v46, 0
  v_mov_b32 v47, 0
  v_mov_b32 v48, 0
  v_mov_b32 v49, 0
  v_mov_b32 v50, 0
  v_mov_b32 v51, 0
  s_nop 1
  s_cbranch_vccz cB_sc3_go
  s_add_u32 s30, s30, 1
  s_cmp_lt_u32 s30, 400000
  s_cbranch_scc1 cB_sc3_r0
  s_branch cB_abort
cB_sc3_r1:
  s_add_u32 s31, s31, 1
  buffer_load_dwordx4 v[12:15], v2, s[8:11], s20 offen offset:1024 sc1
  s_waitcnt vmcnt(0)
  v_cmp_eq_u32 vcc, -1, v12
  s_nop 4
  s_cbranch_vccz cB_sc3_c1
  s_add_u32 s30, s30, 1
  s_cmp_lt_u32 s30, 400000
  s_cbranch_scc1 cB_sc3_r1
  s_branch cB_abort
cB_sc3_r2:
  s_add_u32 s31, s31, 1
  buffer_load_dwordx4 v[16:19], v2, s[8:11], s20 offen offset:2048 sc1
  s_waitcnt vmcnt(0)
  v_cmp_eq_u32 vcc, -1, v16
  s_nop 4
  s_cbranch_vccz cB_sc3_c2
  s_add_u32 s30, s30, 1
  s_cmp_lt_u32 s30, 400000
  s_cbranch_scc1 cB_sc3_r2
  s_branch cB_abort
cB_sc3_r3:
  s_add_u32 s31, s31, 1
  buffer_load_dwordx4 v[20:23], v2, s[8:11], s20 offen offset:3072 sc1
  s_waitcnt vmcnt(0)
  v_cmp_eq_u32 vcc, -1, v20
  s_nop 4
  s_cbranch_vccz cB_sc3_c3
  s_add_u32 s30, s30, 1
  s_cmp_lt_u32 s30, 400000
  s_cbranch_scc1 cB_sc3_r3
  s_branch cB_abort
cB_sc3_r4:
  s_add_u32 s31, s31, 1
  buffer_load_dwordx4 v[24:27], v2, s[8:11], s23 offen offset:0 sc1
  buffer_load_dwordx4 v[28:31], v2, s[8:11], s23 offen offset:1024 sc1
  buffer_load_dwordx4 v[32:35], v2, s[8:11], s23 offen offset:2048 sc1
  s_waitcnt vmcnt(0)
  v_max3_u32 v66, v24, v27, v28
  v_max3_u32 v66, v66, v31, v32
  v_max_u32 v66, v66, v35
  v_cmp_eq_u32 vcc, -1, v66
  s_nop 4
  s_cbranch_vccz cB_sc3_c4
  s_add_u32 s30, s30, 1
  s_cmp_lt_u32 s30, 400000
  s_cbranch_scc1 cB_sc3_r4
  s_branch cB_abort
cB_sc3_retry:
  s_cmp_lg_u32 s62, 0
  s_cbranch_scc1 cB_sc3_cont
  s_waitcnt vmcnt(0) lgkmcnt(0)
cB_sc3_rv:
  buffer_load_dwordx4 v[8:11], v2, s[8:11], s20 offen offset:0 sc1
  buffer_load_dwordx4 v[12:15], v2, s[8:11], s20 offen offset:1024 sc1
  buffer_load_dwordx4 v[16:19], v2, s[8:11], s20 offen offset:2048 sc1
  buffer_load_dwordx4 v[20:23], v2, s[8:11], s20 offen offset:3072 sc1
  buffer_load_dwordx4 v[24:27], v2, s[8:11], s23 offen offset:0 sc1
  buffer_load_dwordx4 v[28:31], v2, s[8:11], s23 offen offset:1024 sc1
  buffer_load_dwordx4 v[32:35], v2, s[8:11], s23 offen offset:2048 sc1
  s_waitcnt vmcnt(0)
  v_max3_u32 v66, v8, v9, v10
  v_max3_u32 v66, v66, v11, v12
  v_max3_u32 v66, v66, v13, v14
  v_max3_u32 v66, v66, v15, v16
  v_max3_u32 v66, v66, v17, v18
  v_max3_u32 v66, v66, v19, v20
  v_max3_u32 v66, v66, v21, v22
  v_max3_u32 v66, v66, v23, v24
  v_max3_u32 v66, v66, v25, v26
  v_max3_u32 v66, v66, v27, v28
  v_max3_u32 v66, v66, v29, v30
  v_max3_u32 v66, v66, v31, v32
  v_max3_u32 v66, v66, v33, v34
  v_max_u32 v66, v66, v35
  v_cmp_eq_u32 vcc, -1, v66
  s_cbranch_vccz cB_sc3_rk
  s_add_u32 s30, s30, 1
  s_cmp_lt_u32 s30, 400000
  s_cbranch_scc1 cB_sc3_rv
  s_branch cB_abort
cB_sc3_rk:
  s_mov_b32 s62, 1
  v_mov_b32 v36, 0
  v_mov_b32 v37, 0
  v_mov_b32 v38, 0
  v_mov_b32 v39, 0
  v_mov_b32 v40, 0
  v_mov_b32 v41, 0
  v_mov_b32 v42, 0
  v_mov_b32 v43, 0
  v_mov_b32 v44, 0
  v_mov_b32 v45, 0
  v_mov_b32 v46, 0
  v_mov_b32 v47, 0
  v_mov_b32 v48, 0
  v_mov_b32 v49, 0
  v_mov_b32 v50, 0
  v_mov_b32 v51, 0
  v_mov_b32 v62, 0
  v_mov_b32 v63, 0
  v_mov_b32 v64, 0
  v_mov_b32 v65, 0
  v_mov_b32 v68, 0
  v_mov_b32 v69, 0
  v_mov_b32 v70, 0
  v_mov_b32 v71, 0
  v_mov_b32 v72, 0
  v_mov_b32 v73, 0
  v_mov_b32 v74, 0
  v_mov_b32 v75, 0
  v_mov_b32 v52, 0
  v_mov_b32 v53, 0
  v_mov_b32 v54, 0
  v_mov_b32 v55, 0
  v_mov_b32 v56, 0
  v_mov_b32 v57, 0
  v_mov_b32 v58, 0
  v_mov_b32 v59, 0
  s_add_u32 s31, s31, 0x100
  s_nop 0
  s_branch cB_sc3_go
.p2align 6
cB_va0_loop:
  s_mov_b32 s30, 0
  s_barrier
  buffer_load_dwordx4 v[24:27], v2, s[8:11], s23 offen offset:0 sc1
  buffer_load_dwordx4 v[28:31], v2, s[8:11], s23 offen offset:1024 sc1
  s_barrier
  s_cmp_lt_u32 s19, 60
  s_cbranch_scc1 cB_va0_m1
  buffer_store_dword v160, v1, s[8:11], s38 offen sc1
  s_cmp_lg_u32 s19, 63
  s_cbranch_scc1 cB_va0_m2
  v_min_u32 v64, -2, v64
  v_min_u32 v65, -2, v65
  v_min_u32 v66, -2, v66
  v_min_u32 v67, -2, v67
  v_min_u32 v68, -2, v68
  v_min_u32 v69, -2, v69
  v_min_u32 v70, -2, v70
  v_min_u32 v71, -2, v71
  v_min_u32 v72, -2, v72
  v_min_u32 v73, -2, v73
  v_min_u32 v74, -2, v74
  v_min_u32 v75, -2, v75
  v_min_u32 v76, -2, v76
  v_min_u32 v77, -2, v77
  v_min_u32 v78, -2, v78
  v_min_u32 v79, -2, v79
  buffer_store_dwordx4 v[64:67], v2, s[8:11], s33 offen offset:0 sc1
  buffer_store_dwordx4 v[68:71], v2, s[8:11], s33 offen offset:2048 sc1
  s_add_u32 s33, s33, 4096
  buffer_store_dwordx4 v[72:75], v2, s[8:11], s33 offen offset:0 sc1
  buffer_store_dwordx4 v[76:79], v2, s[8:11], s33 offen offset:2048 sc1
  s_add_u32 s33, s33, 4096
  s_waitcnt vmcnt(5)
  s_branch cB_va0_m3
cB_va0_m1:
  buffer_store_dword v160, v1, s[8:11], s38 offen sc1
cB_va0_m2:
  s_add_u32 s22, s25, 0
  buffer_load_dwordx4 v[80:83], v6, s[8:11], s22 offen offset:0 sc1
  buffer_load_dwordx4 v[84:87], v6, s[8:11], s22 offen offset:1792 sc1
  s_add_u32 s22, s25, 3584
  buffer_load_dwordx4 v[88:91], v6, s[8:11], s22 offen offset:0 sc1
  buffer_load_dwordx4 v[92:95], v6, s[8:11], s22 offen offset:1792 sc1
  s_add_u32 s22, s25, 7168
  buffer_load_dwordx4 v[96:99], v6, s[8:11], s22 offen offset:0 sc1
  s_mul_i32 s38, s18, 7168
  s_add_u32 s38, s38, 65536
  s_waitcnt vmcnt(6)
cB_va0_m3:
  ds_write_b128 v2, v[24:27] offset:12288
  ds_write_b128 v2, v[28:31] offset:13312
  v_smfmac_f32_16x16x64_bf16 v[36:39], v[24:27], a[32:39], v3
  buffer_load_dwordx4 v[100:103], v6, s[8:11], s22 offen offset:1792 sc1
  v_smfmac_f32_16x16x64_bf16 v[40:43], v[24:27], a[88:95], v3
  s_add_u32 s22, s25, 10752
  buffer_load_dwordx4 v[104:107], v6, s[8:11], s22 offen offset:0 sc1
  v_smfmac_f32_16x16x64_bf16 v[44:47], v[24:27], a[144:151], v3
  buffer_load_dwordx4 v[108:111], v6, s[8:11], s22 offen offset:1792 sc1
  v_smfmac_f32_16x16x64_bf16 v[48:51], v[24:27], a[200:207], v3
  s_add_u32 s22, s25, 14336
  buffer_load_dwordx4 v[112:115], v6, s[8:11], s22 offen offset:0 sc1
  v_smfmac_f32_16x16x64_bf16 v[52:55], v[24:27], v[176:183], v3
  s_waitcnt lgkmcnt(0)
  s_barrier
  ds_read_b128 v[8:11], v2 offset:8192
  ds_read_b128 v[12:15], v2 offset:9216
  ds_read_b128 v[16:19], v2 offset:10240
  ds_read_b128 v[20:23], v2 offset:11264
  ds_read_b128 v[32:35], v2 offset:14336
  buffer_load_dwordx4 v[116:119], v6, s[8:11], s22 offen offset:1792 sc1
  v_smfmac_f32_16x16x64_bf16 v[56:59], v[24:27], v[232:239], v3
  s_add_u32 s22, s25, 17920
  buffer_load_dwordx4 v[120:123], v6, s[8:11], s22 offen offset:0 sc1
  v_smfmac_f32_16x16x64_bf16 v[36:39], v[28:31], a[40:47], v3
  buffer_load_dwordx4 v[124:127], v6, s[8:11], s22 offen offset:1792 sc1
  v_smfmac_f32_16x16x64_bf16 v[40:43], v[28:31], a[96:103], v3
  s_add_u32 s22, s25, 21504
  buffer_load_dwordx4 v[128:131], v6, s[8:11], s22 offen offset:0 sc1
  v_smfmac_f32_16x16x64_bf16 v[44:47], v[28:31], a[152:159], v3
  buffer_load_dwordx4 v[132:135], v6, s[8:11], s22 offen offset:1792 sc1
  v_smfmac_f32_16x16x64_bf16 v[48:51], v[28:31], a[208:215], v3
  s_add_u32 s22, s25, 25088
  buffer_load_dwordx4 v[136:139], v6, s[8:11], s22 offen offset:0 sc1
  v_smfmac_f32_16x16x64_bf16 v[52:55], v[28:31], v[184:191], v3
  buffer_load_dwordx4 v[140:143], v6, s[8:11], s22 offen offset:1792 sc1
  v_smfmac_f32_16x16x64_bf16 v[56:59], v[28:31], v[240:247], v3
  s_waitcnt lgkmcnt(4)
  v_smfmac_f32_16x16x64_bf16 v[36:39], v[8:11], a[0:7], v3
  s_waitcnt lgkmcnt(3)
  v_smfmac_f32_16x16x64_bf16 v[36:39], v[12:15], a[8:15], v3
  s_waitcnt lgkmcnt(2)
  v_smfmac_f32_16x16x64_bf16 v[36:39], v[16:19], a[16:23], v3
  s_waitcnt lgkmcnt(1)
  v_smfmac_f32_16x16x64_bf16 v[36:39], v[20:23], a[24:31], v3
  s_waitcnt lgkmcnt(0)
  v_smfmac_f32_16x16x64_bf16 v[36:39], v[32:35], a[48:55], v3
  v_smfmac_f32_16x16x64_bf16 v[40:43], v[8:11], a[56:63], v3
  v_smfmac_f32_16x16x64_bf16 v[40:43], v[12:15], a[64:71], v3
  v_smfmac_f32_16x16x64_bf16 v[40:43], v[16:19], a[72:79], v3
  v_permlane32_swap_b32 v36, v38
  v_smfmac_f32_16x16x64_bf16 v[40:43], v[20:23], a[80:87], v3
  v_permlane32_swap_b32 v37, v39
  v_smfmac_f32_16x16x64_bf16 v[40:43], v[32:35], a[104:111], v3
  v_add_f32 v36, v36, v38
  v_smfmac_f32_16x16x64_bf16 v[44:47], v[8:11], a[112:119], v3
  v_add_f32 v37, v37, v39
  v_smfmac_f32_16x16x64_bf16 v[44:47], v[12:15], a[120:127], v3
  v_cmp_u_f32 vcc, v36, v37
  v_smfmac_f32_16x16x64_bf16 v[44:47], v[16:19], a[128:135], v3
  v_cvt_pk_bf16_f32 v38, v36, v37
  v_smfmac_f32_16x16x64_bf16 v[44:47], v[20:23], a[136:143], v3
  ds_write_b32 v152, v38
  s_cbranch_vccnz cB_va0_slow
  v_permlane32_swap_b32 v40, v42
  v_smfmac_f32_16x16x64_bf16 v[44:47], v[32:35], a[160:167], v3
  v_permlane32_swap_b32 v41, v43
  v_smfmac_f32_16x16x64_bf16 v[48:51], v[8:11], a[168:175], v3
  buffer_store_dword v162, v1, s[8:11], s21 offen sc1
  v_add_f32 v40, v40, v42
  v_smfmac_f32_16x16x64_bf16 v[48:51], v[12:15], a[176:183], v3
  v_add_f32 v41, v41, v43
  v_smfmac_f32_16x16x64_bf16 v[48:51], v[16:19], a[184:191], v3
  buffer_load_dword v164, v4, s[8:11], 0 offen sc1
  v_cvt_pk_bf16_f32 v42, v40, v41
  v_smfmac_f32_16x16x64_bf16 v[48:51], v[20:23], a[192:199], v3
  ds_write_b32 v153, v42
  v_permlane32_swap_b32 v44, v46
  v_smfmac_f32_16x16x64_bf16 v[48:51], v[32:35], a[216:223], v3
  v_permlane32_swap_b32 v45, v47
  v_smfmac_f32_16x16x64_bf16 v[52:55], v[8:11], a[224:231], v3
  buffer_load_dword v164, v4, s[8:11], 0 offen sc1
  v_add_f32 v44, v44, v46
  v_smfmac_f32_16x16x64_bf16 v[52:55], v[12:15], a[232:239], v3
  v_add_f32 v45, v45, v47
  v_smfmac_f32_16x16x64_bf16 v[52:55], v[16:19], a[240:247], v3
  v_cvt_pk_bf16_f32 v46, v44, v45
  v_smfmac_f32_16x16x64_bf16 v[52:55], v[20:23], a[248:255], v3
  ds_write_b32 v154, v46
  buffer_load_dword v164, v4, s[8:11], 0 offen sc1
  v_permlane32_swap_b32 v48, v50
  v_smfmac_f32_16x16x64_bf16 v[52:55], v[32:35], v[192:199], v3
  v_permlane32_swap_b32 v49, v51
  v_smfmac_f32_16x16x64_bf16 v[56:59], v[8:11], v[200:207], v3
  v_add_f32 v48, v48, v50
  v_smfmac_f32_16x16x64_bf16 v[56:59], v[12:15], v[208:215], v3
  buffer_load_dword v164, v4, s[8:11], 0 offen sc1
  v_add_f32 v49, v49, v51
  v_smfmac_f32_16x16x64_bf16 v[56:59], v[16:19], v[216:223], v3
  v_cvt_pk_bf16_f32 v50, v48, v49
  v_smfmac_f32_16x16x64_bf16 v[56:59], v[20:23], v[224:231], v3
  ds_write_b32 v155, v50
  v_permlane32_swap_b32 v52, v54
  v_smfmac_f32_16x16x64_bf16 v[56:59], v[32:35], v[248:255], v3
  buffer_load_dword v164, v4, s[8:11], 0 offen sc1
  v_permlane32_swap_b32 v53, v55
  v_add_f32 v52, v52, v54
  v_add_f32 v53, v53, v55
  v_cvt_pk_bf16_f32 v54, v52, v53
  ds_write_b32 v156, v54
  s_nop 1
  v_permlane32_swap_b32 v56, v58
  v_permlane32_swap_b32 v57, v59
  v_add_f32 v56, v56, v58
  v_add_f32 v57, v57, v59
  v_cvt_pk_bf16_f32 v58, v56, v57
  ds_write_b32 v157, v58
cB_va0_t2d:
  s_add_u32 s22, s20, 9216
  s_add_u32 s34, s20, 13312
  s_add_u32 s36, s20, 7168
  s_mov_b32 s37, 0
  v_mov_b32 v48, 0
  v_mov_b32 v49, 0
  v_mov_b32 v50, 0
  v_mov_b32 v51, 0
  v_mov_b32 v163, s18
  s_cmp_eq_u32 s19, 63
  s_waitcnt lgkmcnt(0)
  s_cbranch_scc1 cB_va0_last
  s_setprio 3
cB_va0_fw_l:
  v_cmp_gt_u32 vcc, s18, v164
  buffer_load_dword v164, v4, s[8:11], 0 offen sc1
  s_cbranch_vccz cB_va0_fw_d
  v_cmp_gt_u32 vcc, s18, v164
  buffer_load_dword v164, v4, s[8:11], 0 offen sc1
  s_cbranch_vccz cB_va0_fw_d
  v_cmp_gt_u32 vcc, s18, v164
  buffer_load_dword v164, v4, s[8:11], 0 offen sc1
  s_cbranch_vccz cB_va0_fw_d
  v_cmp_gt_u32 vcc, s18, v164
  buffer_load_dword v164, v4, s[8:11], 0 offen sc1
  s_cbranch_vccz cB_va0_fw_d
  v_cmp_gt_u32 vcc, s18, v164
  buffer_load_dword v164, v4, s[8:11], 0 offen sc1
  s_cbranch_vccz cB_va0_fw_d
  v_cmp_gt_u32 vcc, s18, v164
  buffer_load_dword v164, v4, s[8:11], 0 offen sc1
  s_cbranch_vccz cB_va0_fw_d
  v_cmp_gt_u32 vcc, s18, v164
  buffer_load_dword v164, v4, s[8:11], 0 offen sc1
  s_cbranch_vccz cB_va0_fw_d
  v_cmp_gt_u32 vcc, s18, v164
  buffer_load_dword v164, v4, s[8:11], 0 offen sc1
  s_cbranch_vccz cB_va0_fw_d
  v_cmp_gt_u32 vcc, s18, v164
  buffer_load_dword v164, v4, s[8:11], 0 offen sc1
  s_cbranch_vccz cB_va0_fw_d
  v_cmp_gt_u32 vcc, s18, v164
  buffer_load_dword v164, v4, s[8:11], 0 offen sc1
  s_cbranch_vccz cB_va0_fw_d
  v_cmp_gt_u32 vcc, s18, v164
  buffer_load_dword v164, v4, s[8:11], 0 offen sc1
  s_cbranch_vccz cB_va0_fw_d
  v_cmp_gt_u32 vcc, s18, v164
  buffer_load_dword v164, v4, s[8:11], 0 offen sc1
  s_cbranch_vccz cB_va0_fw_d
  v_cmp_gt_u32 vcc, s18, v164
  buffer_load_dword v164, v4, s[8:11], 0 offen sc1
  s_cbranch_vccz cB_va0_fw_d
  v_cmp_gt_u32 vcc, s18, v164
  buffer_load_dword v164, v4, s[8:11], 0 offen sc1
  s_cbranch_vccz cB_va0_fw_d
  v_cmp_gt_u32 vcc, s18, v164
  buffer_load_dword v164, v4, s[8:11], 0 offen sc1
  s_cbranch_vccz cB_va0_fw_d
  v_cmp_gt_u32 vcc, s18, v164
  buffer_load_dword v164, v4, s[8:11], 0 offen sc1
  s_cbranch_vccz cB_va0_fw_d
  s_waitcnt vmcnt(24)
  s_add_u32 s30, s30, 1
  s_cmp_lt_u32 s30, 400000
  s_cbranch_scc1 cB_va0_fw_l
  s_branch cB_abort
cB_va0_fw_d:
  buffer_load_dwordx4 v[8:11], v2, s[8:11], s22 offen offset:0 sc1
  buffer_load_dwordx4 v[12:15], v2, s[8:11], s22 offen offset:1024 sc1
  buffer_load_dwordx4 v[16:19], v2, s[8:11], s22 offen offset:2048 sc1
  buffer_load_dwordx4 v[20:23], v2, s[8:11], s22 offen offset:3072 sc1
  buffer_load_dwordx4 v[24:27], v2, s[8:11], s34 offen offset:0 sc1
  buffer_load_dwordx4 v[28:31], v2, s[8:11], s34 offen offset:1024 sc1
  buffer_load_dwordx4 v[32:35], v2, s[8:11], s34 offen offset:2048 sc1
  buffer_load_dwordx4 v[36:39], v2, s[8:11], s34 offen offset:3072 sc1
  buffer_load_dwordx4 v[40:43], v2, s[8:11], s36 offen offset:0 sc1
  buffer_load_dwordx4 v[44:47], v2, s[8:11], s36 offen offset:1024 sc1
  s_barrier
  ds_read_b128 v[64:67], v2 offset:0
  ds_read_b128 v[68:71], v2 offset:1024
  ds_read_b128 v[72:75], v2 offset:2048
  ds_read_b128 v[76:79], v2 offset:3072
cB_va0_lp:
  s_waitcnt vmcnt(9)
  v_smfmac_f32_16x16x64_bf16 v[48:51], v[8:11], v[80:87], v3
  s_waitcnt vmcnt(8)
  v_smfmac_f32_16x16x64_bf16 v[48:51], v[12:15], v[88:95], v3
  s_waitcnt vmcnt(7)
  v_smfmac_f32_16x16x64_bf16 v[48:51], v[16:19], v[96:103], v3
  s_waitcnt vmcnt(6)
  v_smfmac_f32_16x16x64_bf16 v[48:51], v[20:23], v[104:111], v3
  s_waitcnt vmcnt(5)
  v_smfmac_f32_16x16x64_bf16 v[48:51], v[24:27], v[112:119], v3
  s_waitcnt vmcnt(4)
  v_smfmac_f32_16x16x64_bf16 v[48:51], v[28:31], v[120:127], v3
  s_waitcnt vmcnt(3)
  v_smfmac_f32_16x16x64_bf16 v[48:51], v[32:35], v[128:135], v3
  s_waitcnt vmcnt(2)
  v_smfmac_f32_16x16x64_bf16 v[48:51], v[36:39], v[136:143], v3
  s_waitcnt vmcnt(1) lgkmcnt(0)
  v_smfmac_f32_16x16x64_bf16 v[48:51], v[40:43], v[64:71], v3
  s_waitcnt vmcnt(0)
  v_smfmac_f32_16x16x64_bf16 v[48:51], v[44:47], v[72:79], v3
  s_nop 7
  v_permlane32_swap_b32 v48, v50
  v_permlane32_swap_b32 v49, v51
  v_pk_add_f32 v[48:49], v[48:49], v[50:51]
  v_cvt_pk_bf16_f32 v160, v48, v49
  v_cmp_u_f32 vcc, v48, v49
  s_nop 0
  v_mov_b32_dpp v161, v160 quad_perm:[1,0,3,2] row_mask:0xf bank_mask:0xf
  v_perm_b32 v160, v161, v160, v5
  v_cndmask_b32 v161, v160, v162, vcc
  buffer_store_dword v161, v1, s[8:11], s21 offen sc1
  s_cbranch_vccnz cB_va0_rp
cB_va0_cont:
  s_setprio 0
  s_cmp_lg_u32 s19, 62
  s_cbranch_scc1 cB_va0_nl
  s_sleep 4
  buffer_store_dword v160, v1, s[8:11], s38 offen sc1
  s_mov_b32 s38, 0x40000000
  s_mov_b32 s25, 0x40000000
cB_va0_nl:
  s_add_u32 s25, s25, 458752
  v_mov_b32 v36, 0
  v_mov_b32 v37, 0
  v_mov_b32 v38, 0
  v_mov_b32 v39, 0
  v_mov_b32 v40, 0
  v_mov_b32 v41, 0
  v_mov_b32 v42, 0
  v_mov_b32 v43, 0
  v_mov_b32 v44, 0
  v_mov_b32 v45, 0
  v_mov_b32 v46, 0
  v_mov_b32 v47, 0
  v_mov_b32 v48, 0
  v_mov_b32 v49, 0
  v_mov_b32 v50, 0
  v_mov_b32 v51, 0
  v_mov_b32 v52, 0
  v_mov_b32 v53, 0
  v_mov_b32 v54, 0
  v_mov_b32 v55, 0
  v_mov_b32 v56, 0
  v_mov_b32 v57, 0
  v_mov_b32 v58, 0
  v_mov_b32 v59, 0
  v_mov_b32 v60, 0
  v_mov_b32 v61, 0
  v_mov_b32 v62, 0
  v_mov_b32 v63, 0
  s_mov_b32 s19, s18
  s_add_u32 s18, s18, 1
  s_mov_b32 s22, s20
  s_mov_b32 s20, s21
  s_mov_b32 s21, s22
  s_add_u32 s23, s20, 4096
  s_branch cB_va0_loop
cB_va0_slow:
  s_waitcnt lgkmcnt(0)
cB_va0_sl1:
  s_add_u32 s31, s31, 0x1000000
  buffer_load_dwordx4 v[8:11], v2, s[8:11], s20 offen offset:0 sc1
  buffer_load_dwordx4 v[12:15], v2, s[8:11], s20 offen offset:1024 sc1
  buffer_load_dwordx4 v[16:19], v2, s[8:11], s20 offen offset:2048 sc1
  buffer_load_dwordx4 v[20:23], v2, s[8:11], s20 offen offset:3072 sc1
  buffer_load_dwordx4 v[24:27], v2, s[8:11], s23 offen offset:0 sc1
  buffer_load_dwordx4 v[28:31], v2, s[8:11], s23 offen offset:1024 sc1
  buffer_load_dwordx4 v[32:35], v2, s[8:11], s23 offen offset:2048 sc1
  s_waitcnt vmcnt(0)
  v_max3_u32 v36, v8, v9, v10
  v_max3_u32 v36, v36, v11, v12
  v_max3_u32 v36, v36, v13, v14
  v_max3_u32 v36, v36, v15, v16
  v_max3_u32 v36, v36, v17, v18
  v_max3_u32 v36, v36, v19, v20
  v_max3_u32 v36, v36, v21, v22
  v_max3_u32 v36, v36, v23, v24
  v_max3_u32 v36, v36, v25, v26
  v_max3_u32 v36, v36, v27, v28
  v_max3_u32 v36, v36, v29, v30
  v_max3_u32 v36, v36, v31, v32
  v_max3_u32 v36, v36, v33, v34
  v_max_u32 v36, v36, v35
  v_cmp_eq_u32 vcc, -1, v36
  s_cbranch_vccz cB_va0_sl2
  s_add_u32 s30, s30, 1
  s_cmp_lt_u32 s30, 400000
  s_cbranch_scc1 cB_va0_sl1
  s_branch cB_abort
cB_va0_sl2:
  v_mov_b32 v36, 0
  v_mov_b32 v37, 0
  v_mov_b32 v38, 0
  v_mov_b32 v39, 0
  v_mov_b32 v40, 0
  v_mov_b32 v41, 0
  v_mov_b32 v42, 0
  v_mov_b32 v43, 0
  v_mov_b32 v44, 0
  v_mov_b32 v45, 0
  v_mov_b32 v46, 0
  v_mov_b32 v47, 0
  v_mov_b32 v48, 0
  v_mov_b32 v49, 0
  v_mov_b32 v50, 0
  v_mov_b32 v51, 0
  v_mov_b32 v52, 0
  v_mov_b32 v53, 0
  v_mov_b32 v54, 0
  v_mov_b32 v55, 0
  v_mov_b32 v56, 0
  v_mov_b32 v57, 0
  v_mov_b32 v58, 0
  v_mov_b32 v59, 0
  v_mov_b32 v60, 0
  v_mov_b32 v61, 0
  v_mov_b32 v62, 0
  v_mov_b32 v63, 0
  buffer_store_dword v162, v1, s[8:11], s21 offen sc1
  v_smfmac_f32_16x16x64_bf16 v[36:39], v[8:11], a[0:7], v3
  v_smfmac_f32_16x16x64_bf16 v[40:43], v[8:11], a[56:63], v3
  v_smfmac_f32_16x16x64_bf16 v[44:47], v[8:11], a[112:119], v3
  v_smfmac_f32_16x16x64_bf16 v[48:51], v[8:11], a[168:175], v3
  v_smfmac_f32_16x16x64_bf16 v[52:55], v[8:11], a[224:231], v3
  v_smfmac_f32_16x16x64_bf16 v[56:59], v[8:11], v[200:207], v3
  v_smfmac_f32_16x16x64_bf16 v[36:39], v[12:15], a[8:15], v3
  v_smfmac_f32_16x16x64_bf16 v[40:43], v[12:15], a[64:71], v3
  v_smfmac_f32_16x16x64_bf16 v[44:47], v[12:15], a[120:127], v3
  v_smfmac_f32_16x16x64_bf16 v[48:51], v[12:15], a[176:183], v3
  v_smfmac_f32_16x16x64_bf16 v[52:55], v[12:15], a[232:239], v3
  v_smfmac_f32_16x16x64_bf16 v[56:59], v[12:15], v[208:215], v3
  v_smfmac_f32_16x16x64_bf16 v[36:39], v[16:19], a[16:23], v3
  v_smfmac_f32_16x16x64_bf16 v[40:43], v[16:19], a[72:79], v3
  v_smfmac_f32_16x16x64_bf16 v[44:47], v[16:19], a[128:135], v3
  v_smfmac_f32_16x16x64_bf16 v[48:51], v[16:19], a[184:191], v3
  v_smfmac_f32_16x16x64_bf16 v[52:55], v[16:19], a[240:247], v3
  v_smfmac_f32_16x16x64_bf16 v[56:59], v[16:19], v[216:223], v3
  v_smfmac_f32_16x16x64_bf16 v[36:39], v[20:23], a[24:31], v3
  v_smfmac_f32_16x16x64_bf16 v[40:43], v[20:23], a[80:87], v3
  v_smfmac_f32_16x16x64_bf16 v[44:47], v[20:23], a[136:143], v3
  v_smfmac_f32_16x16x64_bf16 v[48:51], v[20:23], a[192:199], v3
  v_smfmac_f32_16x16x64_bf16 v[52:55], v[20:23], a[248:255], v3
  v_smfmac_f32_16x16x64_bf16 v[56:59], v[20:23], v[224:231], v3
  v_smfmac_f32_16x16x64_bf16 v[36:39], v[24:27], a[32:39], v3
  v_smfmac_f32_16x16x64_bf16 v[40:43], v[24:27], a[88:95], v3
  v_smfmac_f32_16x16x64_bf16 v[44:47], v[24:27], a[144:151], v3
  v_smfmac_f32_16x16x64_bf16 v[48:51], v[24:27], a[200:207], v3
  v_smfmac_f32_16x16x64_bf16 v[52:55], v[24:27], v[176:183], v3
  v_smfmac_f32_16x16x64_bf16 v[56:59], v[24:27], v[232:239], v3
  v_smfmac_f32_16x16x64_bf16 v[36:39], v[28:31], a[40:47], v3
  v_smfmac_f32_16x16x64_bf16 v[40:43], v[28:31], a[96:103], v3
  v_smfmac_f32_16x16x64_bf16 v[44:47], v[28:31], a[152:159], v3
  v_smfmac_f32_16x16x64_bf16 v[48:51], v[28:31], a[208:215], v3
  v_smfmac_f32_16x16x64_bf16 v[52:55], v[28:31], v[184:191], v3
  v_smfmac_f32_16x16x64_bf16 v[56:59], v[28:31], v[240:247], v3
  v_smfmac_f32_16x16x64_bf16 v[36:39], v[32:35], a[48:55], v3
  v_smfmac_f32_16x16x64_bf16 v[40:43], v[32:35], a[104:111], v3
  v_smfmac_f32_16x16x64_bf16 v[44:47], v[32:35], a[160:167], v3
  v_smfmac_f32_16x16x64_bf16 v[48:51], v[32:35], a[216:223], v3
  v_smfmac_f32_16x16x64_bf16 v[52:55], v[32:35], v[192:199], v3
  v_smfmac_f32_16x16x64_bf16 v[56:59], v[32:35], v[248:255], v3
  v_permlane32_swap_b32 v36, v38
  v_permlane32_swap_b32 v37, v39
  v_add_f32 v36, v36, v38
  v_add_f32 v37, v37, v39
  v_cvt_pk_bf16_f32 v38, v36, v37
  ds_write_b32 v152, v38
  v_permlane32_swap_b32 v40, v42
  v_permlane32_swap_b32 v41, v43
  v_add_f32 v40, v40, v42
  v_add_f32 v41, v41, v43
  v_cvt_pk_bf16_f32 v42, v40, v41
  ds_write_b32 v153, v42
  v_permlane32_swap_b32 v44, v46
  v_permlane32_swap_b32 v45, v47
  v_add_f32 v44, v44, v46
  v_add_f32 v45, v45, v47
  v_cvt_pk_bf16_f32 v46, v44, v45
  ds_write_b32 v154, v46
  v_permlane32_swap_b32 v48, v50
  v_permlane32_swap_b32 v49, v51
  v_add_f32 v48, v48, v50
  v_add_f32 v49, v49, v51
  v_cvt_pk_bf16_f32 v50, v48, v49
  ds_write_b32 v155, v50
  v_permlane32_swap_b32 v52, v54
  v_permlane32_swap_b32 v53, v55
  v_add_f32 v52, v52, v54
  v_add_f32 v53, v53, v55
  v_cvt_pk_bf16_f32 v54, v52, v53
  ds_write_b32 v156, v54
  v_permlane32_swap_b32 v56, v58
  v_permlane32_swap_b32 v57, v59
  v_add_f32 v56, v56, v58
  v_add_f32 v57, v57, v59
  v_cvt_pk_bf16_f32 v58, v56, v57
  ds_write_b32 v157, v58
  buffer_load_dword v164, v4, s[8:11], 0 offen sc1
  buffer_load_dword v164, v4, s[8:11], 0 offen sc1
  buffer_load_dword v164, v4, s[8:11], 0 offen sc1
  buffer_load_dword v164, v4, s[8:11], 0 offen sc1
  buffer_load_dword v164, v4, s[8:11], 0 offen sc1
  s_branch cB_va0_t2d
cB_va0_last:
  s_barrier
  ds_read_b128 v[64:67], v2 offset:0
  ds_read_b128 v[68:71], v2 offset:1024
  ds_read_b128 v[72:75], v2 offset:2048
  ds_read_b128 v[76:79], v2 offset:3072
  s_waitcnt lgkmcnt(0)
  v_min_u32 v64, -2, v64
  v_min_u32 v65, -2, v65
  v_min_u32 v66, -2, v66
  v_min_u32 v67, -2, v67
  v_min_u32 v68, -2, v68
  v_min_u32 v69, -2, v69
  v_min_u32 v70, -2, v70
  v_min_u32 v71, -2, v71
  v_min_u32 v72, -2, v72
  v_min_u32 v73, -2, v73
  v_min_u32 v74, -2, v74
  v_min_u32 v75, -2, v75
  v_min_u32 v76, -2, v76
  v_min_u32 v77, -2, v77
  v_min_u32 v78, -2, v78
  v_min_u32 v79, -2, v79
  buffer_store_dwordx4 v[64:67], v2, s[8:11], s33 offen offset:0 sc1
  buffer_store_dwordx4 v[68:71], v2, s[8:11], s33 offen offset:2048 sc1
  s_add_u32 s33, s33, 4096
  buffer_store_dwordx4 v[72:75], v2, s[8:11], s33 offen offset:0 sc1
  buffer_store_dwordx4 v[76:79], v2, s[8:11], s33 offen offset:2048 sc1
  s_add_u32 s33, s33, 4096
  s_waitcnt vmcnt(0)
  buffer_wbl2 sc1
  s_branch cB_done
cB_va0_rp:
  s_cmp_eq_u32 s37, 0
  s_cbranch_scc1 cB_va0_rv
  v_min_u32 v160, -2, v160
  buffer_store_dword v160, v1, s[8:11], s21 offen sc1
  s_branch cB_va0_cont
cB_va0_rv:
  s_add_u32 s31, s31, 0x10000
  buffer_load_dwordx4 v[8:11], v2, s[8:11], s22 offen offset:0 sc1
  buffer_load_dwordx4 v[12:15], v2, s[8:11], s22 offen offset:1024 sc1
  buffer_load_dwordx4 v[16:19], v2, s[8:11], s22 offen offset:2048 sc1
  buffer_load_dwordx4 v[20:23], v2, s[8:11], s22 offen offset:3072 sc1
  buffer_load_dwordx4 v[24:27], v2, s[8:11], s34 offen offset:0 sc1
  buffer_load_dwordx4 v[28:31], v2, s[8:11], s34 offen offset:1024 sc1
  buffer_load_dwordx4 v[32:35], v2, s[8:11], s34 offen offset:2048 sc1
  buffer_load_dwordx4 v[36:39], v2, s[8:11], s34 offen offset:3072 sc1
  buffer_load_dwordx4 v[40:43], v2, s[8:11], s36 offen offset:0 sc1
  buffer_load_dwordx4 v[44:47], v2, s[8:11], s36 offen offset:1024 sc1
  s_waitcnt vmcnt(0)
  v_max3_u32 v52, v8, v9, v10
  v_max3_u32 v52, v52, v11, v12
  v_max3_u32 v52, v52, v13, v14
  v_max3_u32 v52, v52, v15, v16
  v_max3_u32 v52, v52, v17, v18
  v_max3_u32 v52, v52, v19, v20
  v_max3_u32 v52, v52, v21, v22
  v_max3_u32 v52, v52, v23, v24
  v_max3_u32 v52, v52, v25, v26
  v_max3_u32 v52, v52, v27, v28
  v_max3_u32 v52, v52, v29, v30
  v_max3_u32 v52, v52, v31, v32
  v_max3_u32 v52, v52, v33, v34
  v_max3_u32 v52, v52, v35, v36
  v_max3_u32 v52, v52, v37, v38
  v_max3_u32 v52, v52, v39, v40
  v_max3_u32 v52, v52, v41, v42
  v_max3_u32 v52, v52, v43, v44
  v_max3_u32 v52, v52, v45, v46
  v_max_u32 v52, v52, v47
  v_cmp_eq_u32 vcc, -1, v52
  s_mov_b32 s37, 1
  v_mov_b32 v48, 0
  v_mov_b32 v49, 0
  v_mov_b32 v50, 0
  v_mov_b32 v51, 0
  s_nop 1
  s_cbranch_vccz cB_va0_lp
  s_add_u32 s30, s30, 1
  s_cmp_lt_u32 s30, 400000
  s_cbranch_scc1 cB_va0_rv
  s_branch cB_abort
.p2align 6
cB_va1_loop:
  s_mov_b32 s30, 0
  s_barrier
  buffer_load_dwordx4 v[28:31], v2, s[8:11], s23 offen offset:1024 sc1
  buffer_load_dwordx4 v[32:35], v2, s[8:11], s23 offen offset:2048 sc1
  s_barrier
  s_cmp_lt_u32 s19, 60
  s_cbranch_scc1 cB_va1_m1
  buffer_store_dword v160, v1, s[8:11], s38 offen sc1
  s_cmp_lg_u32 s19, 63
  s_cbranch_scc1 cB_va1_m2
  v_min_u32 v64, -2, v64
  v_min_u32 v65, -2, v65
  v_min_u32 v66, -2, v66
  v_min_u32 v67, -2, v67
  v_min_u32 v68, -2, v68
  v_min_u32 v69, -2, v69
  v_min_u32 v70, -2, v70
  v_min_u32 v71, -2, v71
  v_min_u32 v72, -2, v72
  v_min_u32 v73, -2, v73
  v_min_u32 v74, -2, v74
  v_min_u32 v75, -2, v75
  v_min_u32 v76, -2, v76
  v_min_u32 v77, -2, v77
  v_min_u32 v78, -2, v78
  v_min_u32 v79, -2, v79
  buffer_store_dwordx4 v[64:67], v2, s[8:11], s33 offen offset:0 sc1
  buffer_store_dwordx4 v[68:71], v2, s[8:11], s33 offen offset:2048 sc1
  s_add_u32 s33, s33, 4096
  buffer_store_dwordx4 v[72:75], v2, s[8:11], s33 offen offset:0 sc1
  buffer_store_dwordx4 v[76:79], v2, s[8:11], s33 offen offset:2048 sc1
  s_add_u32 s33, s33, 4096
  s_waitcnt vmcnt(5)
  s_branch cB_va1_m3
cB_va1_m1:
  buffer_store_dword v160, v1, s[8:11], s38 offen sc1
cB_va1_m2:
  s_add_u32 s22, s25, 0
  buffer_load_dwordx4 v[80:83], v6, s[8:11], s22 offen offset:0 sc1
  buffer_load_dwordx4 v[84:87], v6, s[8:11], s22 offen offset:1792 sc1
  s_add_u32 s22, s25, 3584
  buffer_load_dwordx4 v[88:91], v6, s[8:11], s22 offen offset:0 sc1
  buffer_load_dwordx4 v[92:95], v6, s[8:11], s22 offen offset:1792 sc1
  s_add_u32 s22, s25, 7168
  buffer_load_dwordx4 v[96:99], v6, s[8:11], s22 offen offset:0 sc1
  s_mul_i32 s38, s18, 7168
  s_add_u32 s38, s38, 65536
  s_waitcnt vmcnt(6)
cB_va1_m3:
  ds_write_b128 v2, v[32:35] offset:14336
  v_smfmac_f32_16x16x64_bf16 v[36:39], v[28:31], a[40:47], v3
  buffer_load_dwordx4 v[100:103], v6, s[8:11], s22 offen offset:1792 sc1
  v_smfmac_f32_16x16x64_bf16 v[40:43], v[28:31], a[96:103], v3
  s_add_u32 s22, s25, 10752
  buffer_load_dwordx4 v[104:107], v6, s[8:11], s22 offen offset:0 sc1
  v_smfmac_f32_16x16x64_bf16 v[44:47], v[28:31], a[152:159], v3
  buffer_load_dwordx4 v[108:111], v6, s[8:11], s22 offen offset:1792 sc1
  v_smfmac_f32_16x16x64_bf16 v[48:51], v[28:31], a[208:215], v3
  s_add_u32 s22, s25, 14336
  buffer_load_dwordx4 v[112:115], v6, s[8:11], s22 offen offset:0 sc1
  v_smfmac_f32_16x16x64_bf16 v[52:55], v[28:31], v[184:191], v3
  s_waitcnt lgkmcnt(0)
  s_barrier
  ds_read_b128 v[8:11], v2 offset:8192
  ds_read_b128 v[12:15], v2 offset:9216
  ds_read_b128 v[16:19], v2 offset:10240
  ds_read_b128 v[20:23], v2 offset:11264
  ds_read_b128 v[24:27], v2 offset:12288
  buffer_load_dwordx4 v[116:119], v6, s[8:11], s22 offen offset:1792 sc1
  v_smfmac_f32_16x16x64_bf16 v[56:59], v[28:31], v[240:247], v3
  s_add_u32 s22, s25, 17920
  buffer_load_dwordx4 v[120:123], v6, s[8:11], s22 offen offset:0 sc1
  v_smfmac_f32_16x16x64_bf16 v[36:39], v[32:35], a[48:55], v3
  buffer_load_dwordx4 v[124:127], v6, s[8:11], s22 offen offset:1792 sc1
  v_smfmac_f32_16x16x64_bf16 v[40:43], v[32:35], a[104:111], v3
  s_add_u32 s22, s25, 21504
  buffer_load_dwordx4 v[128:131], v6, s[8:11], s22 offen offset:0 sc1
  v_smfmac_f32_16x16x64_bf16 v[44:47], v[32:35], a[160:167], v3
  buffer_load_dwordx4 v[132:135], v6, s[8:11], s22 offen offset:1792 sc1
  v_smfmac_f32_16x16x64_bf16 v[48:51], v[32:35], a[216:223], v3
  s_add_u32 s22, s25, 25088
  buffer_load_dwordx4 v[136:139], v6, s[8:11], s22 offen offset:0 sc1
  v_smfmac_f32_16x16x64_bf16 v[52:55], v[32:35], v[192:199], v3
  ds_read_b128 v[64:67], v0 offset:0
  ds_read_b128 v[68:71], v0 offset:1024
  buffer_load_dwordx4 v[140:143], v6, s[8:11], s22 offen offset:1792 sc1
  v_smfmac_f32_16x16x64_bf16 v[56:59], v[32:35], v[248:255], v3
  s_waitcnt lgkmcnt(6)
  ds_read_b128 v[72:75], v0 offset:2048
  ds_read_b128 v[76:79], v0 offset:3072
  v_smfmac_f32_16x16x64_bf16 v[36:39], v[8:11], a[0:7], v3
  s_waitcnt lgkmcnt(7)
  v_smfmac_f32_16x16x64_bf16 v[36:39], v[12:15], a[8:15], v3
  s_waitcnt lgkmcnt(6)
  v_smfmac_f32_16x16x64_bf16 v[36:39], v[16:19], a[16:23], v3
  s_waitcnt lgkmcnt(2)
  v_smfmac_f32_16x16x64_bf16 v[60:63], v[8:11], v[64:71], v3
  s_waitcnt lgkmcnt(5)
  ds_read_b128 v[144:147], v0 offset:4096
  ds_read_b128 v[148:151], v0 offset:5120
  v_smfmac_f32_16x16x64_bf16 v[36:39], v[20:23], a[24:31], v3
  s_waitcnt lgkmcnt(6)
  v_smfmac_f32_16x16x64_bf16 v[36:39], v[24:27], a[32:39], v3
  v_smfmac_f32_16x16x64_bf16 v[40:43], v[8:11], a[56:63], v3
  s_waitcnt lgkmcnt(2)
  v_smfmac_f32_16x16x64_bf16 v[60:63], v[12:15], v[72:79], v3
  ds_read_b128 v[64:67], v0 offset:6144
  ds_read_b128 v[68:71], v0 offset:7168
  v_smfmac_f32_16x16x64_bf16 v[40:43], v[12:15], a[64:71], v3
  v_permlane32_swap_b32 v36, v38
  v_smfmac_f32_16x16x64_bf16 v[40:43], v[16:19], a[72:79], v3
  v_permlane32_swap_b32 v37, v39
  v_smfmac_f32_16x16x64_bf16 v[40:43], v[20:23], a[80:87], v3
  s_waitcnt lgkmcnt(2)
  v_add_f32 v36, v36, v38
  v_smfmac_f32_16x16x64_bf16 v[60:63], v[16:19], v[144:151], v3
  ds_read_b128 v[72:75], v0 offset:8192
  ds_read_b128 v[76:79], v0 offset:9216
  v_add_f32 v37, v37, v39
  v_smfmac_f32_16x16x64_bf16 v[40:43], v[24:27], a[88:95], v3
  v_cmp_u_f32 vcc, v36, v37
  v_smfmac_f32_16x16x64_bf16 v[44:47], v[8:11], a[112:119], v3
  v_cvt_pk_bf16_f32 v38, v36, v37
  v_smfmac_f32_16x16x64_bf16 v[44:47], v[12:15], a[120:127], v3
  ds_write_b32 v152, v38
  s_waitcnt lgkmcnt(3)
  s_cbranch_vccnz cB_va1_slow
  v_permlane32_swap_b32 v40, v42
  v_smfmac_f32_16x16x64_bf16 v[60:63], v[20:23], v[64:71], v3
  ds_read_b128 v[144:147], v0 offset:10240
  ds_read_b128 v[148:151], v0 offset:11264
  v_permlane32_swap_b32 v41, v43
  v_smfmac_f32_16x16x64_bf16 v[44:47], v[16:19], a[128:135], v3
  buffer_store_dword v162, v1, s[8:11], s21 offen sc1
  v_add_f32 v40, v40, v42
  v_smfmac_f32_16x16x64_bf16 v[44:47], v[20:23], a[136:143], v3
  v_add_f32 v41, v41, v43
  v_smfmac_f32_16x16x64_bf16 v[44:47], v[24:27], a[144:151], v3
  s_waitcnt lgkmcnt(3)
  v_cvt_pk_bf16_f32 v42, v40, v41
  v_smfmac_f32_16x16x64_bf16 v[60:63], v[24:27], v[72:79], v3
  ds_write_b32 v153, v42
  ds_read_b128 v[64:67], v0 offset:12288
  ds_read_b128 v[68:71], v0 offset:13312
  v_smfmac_f32_16x16x64_bf16 v[48:51], v[8:11], a[168:175], v3
  s_nop 0
  v_permlane32_swap_b32 v44, v46
  v_smfmac_f32_16x16x64_bf16 v[48:51], v[12:15], a[176:183], v3
  v_permlane32_swap_b32 v45, v47
  v_smfmac_f32_16x16x64_bf16 v[48:51], v[16:19], a[184:191], v3
  s_waitcnt lgkmcnt(3)
  v_add_f32 v44, v44, v46
  v_smfmac_f32_16x16x64_bf16 v[60:63], v[28:31], v[144:151], v3
  v_add_f32 v45, v45, v47
  v_smfmac_f32_16x16x64_bf16 v[48:51], v[20:23], a[192:199], v3
  v_cvt_pk_bf16_f32 v46, v44, v45
  v_smfmac_f32_16x16x64_bf16 v[48:51], v[24:27], a[200:207], v3
  ds_write_b32 v154, v46
  v_smfmac_f32_16x16x64_bf16 v[52:55], v[8:11], a[224:231], v3
  s_waitcnt lgkmcnt(1)
  v_smfmac_f32_16x16x64_bf16 v[60:63], v[32:35], v[64:71], v3
  v_smfmac_f32_16x16x64_bf16 v[52:55], v[12:15], a[232:239], v3
  v_permlane32_swap_b32 v48, v50
  v_smfmac_f32_16x16x64_bf16 v[52:55], v[16:19], a[240:247], v3
  v_permlane32_swap_b32 v49, v51
  v_smfmac_f32_16x16x64_bf16 v[52:55], v[20:23], a[248:255], v3
  v_add_f32 v48, v48, v50
  v_smfmac_f32_16x16x64_bf16 v[52:55], v[24:27], v[176:183], v3
  v_add_f32 v49, v49, v51
  v_smfmac_f32_16x16x64_bf16 v[56:59], v[8:11], v[200:207], v3
  v_cvt_pk_bf16_f32 v50, v48, v49
  v_smfmac_f32_16x16x64_bf16 v[56:59], v[12:15], v[208:215], v3
  ds_write_b32 v155, v50
  v_permlane32_swap_b32 v60, v62
  v_smfmac_f32_16x16x64_bf16 v[56:59], v[16:19], v[216:223], v3
  v_permlane32_swap_b32 v61, v63
  v_smfmac_f32_16x16x64_bf16 v[56:59], v[20:23], v[224:231], v3
  v_add_f32 v60, v60, v62
  v_smfmac_f32_16x16x64_bf16 v[56:59], v[24:27], v[232:239], v3
  v_add_f32 v61, v61, v63
  v_cvt_pk_bf16_f32 v62, v60, v61
  ds_write_b32 v158, v62
  v_permlane32_swap_b32 v52, v54
  v_permlane32_swap_b32 v53, v55
  v_add_f32 v52, v52, v54
  v_add_f32 v53, v53, v55
  v_cvt_pk_bf16_f32 v54, v52, v53
  ds_write_b32 v156, v54
  v_permlane32_swap_b32 v56, v58
  v_permlane32_swap_b32 v57, v59
  v_add_f32 v56, v56, v58
  v_add_f32 v57, v57, v59
  v_cvt_pk_bf16_f32 v58, v56, v57
  ds_write_b32 v157, v58
cB_va1_t2d:
  s_add_u32 s22, s20, 9216
  s_add_u32 s34, s20, 13312
  s_add_u32 s36, s20, 7168
  s_mov_b32 s37, 0
  v_mov_b32 v48, 0
  v_mov_b32 v49, 0
  v_mov_b32 v50, 0
  v_mov_b32 v51, 0
  v_mov_b32 v163, s18
  s_cmp_eq_u32 s19, 63
  s_waitcnt lgkmcnt(0)
  s_cbranch_scc1 cB_va1_last
  s_barrier
  buffer_load_dwordx4 v[8:11], v2, s[8:11], s22 offen offset:0 sc1
  buffer_load_dwordx4 v[12:15], v2, s[8:11], s22 offen offset:1024 sc1
  buffer_load_dwordx4 v[16:19], v2, s[8:11], s22 offen offset:2048 sc1
  buffer_load_dwordx4 v[20:23], v2, s[8:11], s22 offen offset:3072 sc1
  buffer_load_dwordx4 v[24:27], v2, s[8:11], s34 offen offset:0 sc1
  buffer_load_dwordx4 v[28:31], v2, s[8:11], s34 offen offset:1024 sc1
  buffer_load_dwordx4 v[32:35], v2, s[8:11], s34 offen offset:2048 sc1
  buffer_load_dwordx4 v[36:39], v2, s[8:11], s34 offen offset:3072 sc1
  buffer_load_dwordx4 v[40:43], v2, s[8:11], s36 offen offset:0 sc1
  buffer_load_dwordx4 v[44:47], v2, s[8:11], s36 offen offset:1024 sc1
  ds_read_b128 v[64:67], v2 offset:4096
  ds_read_b128 v[68:71], v2 offset:5120
  ds_read_b128 v[72:75], v2 offset:6144
  ds_read_b128 v[76:79], v2 offset:7168
cB_va1_lp:
  s_waitcnt vmcnt(9)
  v_smfmac_f32_16x16x64_bf16 v[48:51], v[8:11], v[80:87], v3
  s_waitcnt vmcnt(8)
  v_smfmac_f32_16x16x64_bf16 v[48:51], v[12:15], v[88:95], v3
  s_waitcnt vmcnt(7)
  v_smfmac_f32_16x16x64_bf16 v[48:51], v[16:19], v[96:103], v3
  v_max3_u32 v55, v8, v12, v16
  s_waitcnt vmcnt(6)
  v_smfmac_f32_16x16x64_bf16 v[48:51], v[20:23], v[104:111], v3
  v_max_u32 v55, v55, v20
  v_cmp_eq_u32 vcc, -1, v55
  s_waitcnt vmcnt(5)
  v_smfmac_f32_16x16x64_bf16 v[48:51], v[24:27], v[112:119], v3
  s_waitcnt vmcnt(4)
  v_smfmac_f32_16x16x64_bf16 v[48:51], v[28:31], v[120:127], v3
  s_cbranch_vccnz cB_va1_rv
  buffer_store_dword v163, v7, s[8:11], 0 offen sc1
  s_waitcnt vmcnt(4)
  v_smfmac_f32_16x16x64_bf16 v[48:51], v[32:35], v[128:135], v3
  s_waitcnt vmcnt(3)
  v_smfmac_f32_16x16x64_bf16 v[48:51], v[36:39], v[136:143], v3
  s_waitcnt vmcnt(2) lgkmcnt(0)
  v_smfmac_f32_16x16x64_bf16 v[48:51], v[40:43], v[64:71], v3
  s_waitcnt vmcnt(1)
  v_smfmac_f32_16x16x64_bf16 v[48:51], v[44:47], v[72:79], v3
  s_nop 7
  v_permlane32_swap_b32 v48, v50
  v_permlane32_swap_b32 v49, v51
  v_pk_add_f32 v[48:49], v[48:49], v[50:51]
  v_cvt_pk_bf16_f32 v160, v48, v49
  v_cmp_u_f32 vcc, v48, v49
  s_nop 0
  v_mov_b32_dpp v161, v160 quad_perm:[1,0,3,2] row_mask:0xf bank_mask:0xf
  v_perm_b32 v160, v161, v160, v5
  v_cndmask_b32 v161, v160, v162, vcc
  buffer_store_dword v161, v1, s[8:11], s21 offen sc1
  s_cbranch_vccnz cB_va1_rp
cB_va1_cont:
  s_cmp_lg_u32 s19, 62
  s_cbranch_scc1 cB_va1_nl
  buffer_store_dword v160, v1, s[8:11], s38 offen sc1
  s_mov_b32 s38, 0x40000000
  s_mov_b32 s25, 0x40000000
cB_va1_nl:
  s_add_u32 s25, s25, 458752
  v_mov_b32 v36, 0
  v_mov_b32 v37, 0
  v_mov_b32 v38, 0
  v_mov_b32 v39, 0
  v_mov_b32 v40, 0
  v_mov_b32 v41, 0
  v_mov_b32 v42, 0
  v_mov_b32 v43, 0
  v_mov_b32 v44, 0
  v_mov_b32 v45, 0
  v_mov_b32 v46, 0
  v_mov_b32 v47, 0
  v_mov_b32 v48, 0
  v_mov_b32 v49, 0
  v_mov_b32 v50, 0
  v_mov_b32 v51, 0
  v_mov_b32 v52, 0
  v_mov_b32 v53, 0
  v_mov_b32 v54, 0
  v_mov_b32 v55, 0
  v_mov_b32 v56, 0
  v_mov_b32 v57, 0
  v_mov_b32 v58, 0
  v_mov_b32 v59, 0
  v_mov_b32 v60, 0
  v_mov_b32 v61, 0
  v_mov_b32 v62, 0
  v_mov_b32 v63, 0
  s_mov_b32 s19, s18
  s_add_u32 s18, s18, 1
  s_mov_b32 s22, s20
  s_mov_b32 s20, s21
  s_mov_b32 s21, s22
  s_add_u32 s23, s20, 4096
  s_branch cB_va1_loop
cB_va1_slow:
  s_waitcnt lgkmcnt(0)
cB_va1_sl1:
  s_add_u32 s31, s31, 0x1000000
  buffer_load_dwordx4 v[8:11], v2, s[8:11], s20 offen offset:0 sc1
  buffer_load_dwordx4 v[12:15], v2, s[8:11], s20 offen offset:1024 sc1
  buffer_load_dwordx4 v[16:19], v2, s[8:11], s20 offen offset:2048 sc1
  buffer_load_dwordx4 v[20:23], v2, s[8:11], s20 offen offset:3072 sc1
  buffer_load_dwordx4 v[24:27], v2, s[8:11], s23 offen offset:0 sc1
  buffer_load_dwordx4 v[28:31], v2, s[8:11], s23 offen offset:1024 sc1
  buffer_load_dwordx4 v[32:35], v2, s[8:11], s23 offen offset:2048 sc1
  s_waitcnt vmcnt(0)
  v_max3_u32 v36, v8, v9, v10
  v_max3_u32 v36, v36, v11, v12
  v_max3_u32 v36, v36, v13, v14
  v_max3_u32 v36, v36, v15, v16
  v_max3_u32 v36, v36, v17, v18
  v_max3_u32 v36, v36, v19, v20
  v_max3_u32 v36, v36, v21, v22
  v_max3_u32 v36, v36, v23, v24
  v_max3_u32 v36, v36, v25, v26
  v_max3_u32 v36, v36, v27, v28
  v_max3_u32 v36, v36, v29, v30
  v_max3_u32 v36, v36, v31, v32
  v_max3_u32 v36, v36, v33, v34
  v_max_u32 v36, v36, v35
  v_cmp_eq_u32 vcc, -1, v36
  s_cbranch_vccz cB_va1_sl2
  s_add_u32 s30, s30, 1
  s_cmp_lt_u32 s30, 400000
  s_cbranch_scc1 cB_va1_sl1
  s_branch cB_abort
cB_va1_sl2:
  v_mov_b32 v36, 0
  v_mov_b32 v37, 0
  v_mov_b32 v38, 0
  v_mov_b32 v39, 0
  v_mov_b32 v40, 0
  v_mov_b32 v41, 0
  v_mov_b32 v42, 0
  v_mov_b32 v43, 0
  v_mov_b32 v44, 0
  v_mov_b32 v45, 0
  v_mov_b32 v46, 0
  v_mov_b32 v47, 0
  v_mov_b32 v48, 0
  v_mov_b32 v49, 0
  v_mov_b32 v50, 0
  v_mov_b32 v51, 0
  v_mov_b32 v52, 0
  v_mov_b32 v53, 0
  v_mov_b32 v54, 0
  v_mov_b32 v55, 0
  v_mov_b32 v56, 0
  v_mov_b32 v57, 0
  v_mov_b32 v58, 0
  v_mov_b32 v59, 0
  v_mov_b32 v60, 0
  v_mov_b32 v61, 0
  v_mov_b32 v62, 0
  v_mov_b32 v63, 0
  buffer_store_dword v162, v1, s[8:11], s21 offen sc1
  ds_read_b128 v[64:67], v0 offset:0
  ds_read_b128 v[68:71], v0 offset:1024
  v_smfmac_f32_16x16x64_bf16 v[36:39], v[8:11], a[0:7], v3
  v_smfmac_f32_16x16x64_bf16 v[40:43], v[8:11], a[56:63], v3
  v_smfmac_f32_16x16x64_bf16 v[44:47], v[8:11], a[112:119], v3
  v_smfmac_f32_16x16x64_bf16 v[48:51], v[8:11], a[168:175], v3
  v_smfmac_f32_16x16x64_bf16 v[52:55], v[8:11], a[224:231], v3
  v_smfmac_f32_16x16x64_bf16 v[56:59], v[8:11], v[200:207], v3
  s_waitcnt lgkmcnt(0)
  v_smfmac_f32_16x16x64_bf16 v[60:63], v[8:11], v[64:71], v3
  ds_read_b128 v[72:75], v0 offset:2048
  ds_read_b128 v[76:79], v0 offset:3072
  v_smfmac_f32_16x16x64_bf16 v[36:39], v[12:15], a[8:15], v3
  v_smfmac_f32_16x16x64_bf16 v[40:43], v[12:15], a[64:71], v3
  v_smfmac_f32_16x16x64_bf16 v[44:47], v[12:15], a[120:127], v3
  v_smfmac_f32_16x16x64_bf16 v[48:51], v[12:15], a[176:183], v3
  v_smfmac_f32_16x16x64_bf16 v[52:55], v[12:15], a[232:239], v3
  v_smfmac_f32_16x16x64_bf16 v[56:59], v[12:15], v[208:215], v3
  s_waitcnt lgkmcnt(0)
  v_smfmac_f32_16x16x64_bf16 v[60:63], v[12:15], v[72:79], v3
  ds_read_b128 v[144:147], v0 offset:4096
  ds_read_b128 v[148:151], v0 offset:5120
  v_smfmac_f32_16x16x64_bf16 v[36:39], v[16:19], a[16:23], v3
  v_smfmac_f32_16x16x64_bf16 v[40:43], v[16:19], a[72:79], v3
  v_smfmac_f32_16x16x64_bf16 v[44:47], v[16:19], a[128:135], v3
  v_smfmac_f32_16x16x64_bf16 v[48:51], v[16:19], a[184:191], v3
  v_smfmac_f32_16x16x64_bf16 v[52:55], v[16:19], a[240:247], v3
  v_smfmac_f32_16x16x64_bf16 v[56:59], v[16:19], v[216:223], v3
  s_waitcnt lgkmcnt(0)
  v_smfmac_f32_16x16x64_bf16 v[60:63], v[16:19], v[144:151], v3
  ds_read_b128 v[64:67], v0 offset:6144
  ds_read_b128 v[68:71], v0 offset:7168
  v_smfmac_f32_16x16x64_bf16 v[36:39], v[20:23], a[24:31], v3
  v_smfmac_f32_16x16x64_bf16 v[40:43], v[20:23], a[80:87], v3
  v_smfmac_f32_16x16x64_bf16 v[44:47], v[20:23], a[136:143], v3
  v_smfmac_f32_16x16x64_bf16 v[48:51], v[20:23], a[192:199], v3
  v_smfmac_f32_16x16x64_bf16 v[52:55], v[20:23], a[248:255], v3
  v_smfmac_f32_16x16x64_bf16 v[56:59], v[20:23], v[224:231], v3
  s_waitcnt lgkmcnt(0)
  v_smfmac_f32_16x16x64_bf16 v[60:63], v[20:23], v[64:71], v3
  ds_read_b128 v[72:75], v0 offset:8192
  ds_read_b128 v[76:79], v0 offset:9216
  v_smfmac_f32_16x16x64_bf16 v[36:39], v[24:27], a[32:39], v3
  v_smfmac_f32_16x16x64_bf16 v[40:43], v[24:27], a[88:95], v3
  v_smfmac_f32_16x16x64_bf16 v[44:47], v[24:27], a[144:151], v3
  v_smfmac_f32_16x16x64_bf16 v[48:51], v[24:27], a[200:207], v3
  v_smfmac_f32_16x16x64_bf16 v[52:55], v[24:27], v[176:183], v3
  v_smfmac_f32_16x16x64_bf16 v[56:59], v[24:27], v[232:239], v3
  s_waitcnt lgkmcnt(0)
  v_smfmac_f32_16x16x64_bf16 v[60:63], v[24:27], v[72:79], v3
  ds_read_b128 v[144:147], v0 offset:10240
  ds_read_b128 v[148:151], v0 offset:11264
  v_smfmac_f32_16x16x64_bf16 v[36:39], v[28:31], a[40:47], v3
  v_smfmac_f32_16x16x64_bf16 v[40:43], v[28:31], a[96:103], v3
  v_smfmac_f32_16x16x64_bf16 v[44:47], v[28:31], a[152:159], v3
  v_smfmac_f32_16x16x64_bf16 v[48:51], v[28:31], a[208:215], v3
  v_smfmac_f32_16x16x64_bf16 v[52:55], v[28:31], v[184:191], v3
  v_smfmac_f32_16x16x64_bf16 v[56:59], v[28:31], v[240:247], v3
  s_waitcnt lgkmcnt(0)
  v_smfmac_f32_16x16x64_bf16 v[60:63], v[28:31], v[144:151], v3
  ds_read_b128 v[64:67], v0 offset:12288
  ds_read_b128 v[68:71], v0 offset:13312
  v_smfmac_f32_16x16x64_bf16 v[36:39], v[32:35], a[48:55], v3
  v_smfmac_f32_16x16x64_bf16 v[40:43], v[32:35], a[104:111], v3
  v_smfmac_f32_16x16x64_bf16 v[44:47], v[32:35], a[160:167], v3
  v_smfmac_f32_16x16x64_bf16 v[48:51], v[32:35], a[216:223], v3
  v_smfmac_f32_16x16x64_bf16 v[52:55], v[32:35], v[192:199], v3
  v_smfmac_f32_16x16x64_bf16 v[56:59], v[32:35], v[248:255], v3
  s_waitcnt lgkmcnt(0)
  v_smfmac_f32_16x16x64_bf16 v[60:63], v[32:35], v[64:71], v3
  v_permlane32_swap_b32 v36, v38
  v_permlane32_swap_b32 v37, v39
  v_add_f32 v36, v36, v38
  v_add_f32 v37, v37, v39
  v_cvt_pk_bf16_f32 v38, v36, v37
  ds_write_b32 v152, v38
  v_permlane32_swap_b32 v40, v42
  v_permlane32_swap_b32 v41, v43
  v_add_f32 v40, v40, v42
  v_add_f32 v41, v41, v43
  v_cvt_pk_bf16_f32 v42, v40, v41
  ds_write_b32 v153, v42
  v_permlane32_swap_b32 v44, v46
  v_permlane32_swap_b32 v45, v47
  v_add_f32 v44, v44, v46
  v_add_f32 v45, v45, v47
  v_cvt_pk_bf16_f32 v46, v44, v45
  ds_write_b32 v154, v46
  v_permlane32_swap_b32 v48, v50
  v_permlane32_swap_b32 v49, v51
  v_add_f32 v48, v48, v50
  v_add_f32 v49, v49, v51
  v_cvt_pk_bf16_f32 v50, v48, v49
  ds_write_b32 v155, v50
  v_permlane32_swap_b32 v52, v54
  v_permlane32_swap_b32 v53, v55
  v_add_f32 v52, v52, v54
  v_add_f32 v53, v53, v55
  v_cvt_pk_bf16_f32 v54, v52, v53
  ds_write_b32 v156, v54
  v_permlane32_swap_b32 v56, v58
  v_permlane32_swap_b32 v57, v59
  v_add_f32 v56, v56, v58
  v_add_f32 v57, v57, v59
  v_cvt_pk_bf16_f32 v58, v56, v57
  ds_write_b32 v157, v58
  v_permlane32_swap_b32 v60, v62
  v_permlane32_swap_b32 v61, v63
  v_add_f32 v60, v60, v62
  v_add_f32 v61, v61, v63
  v_cvt_pk_bf16_f32 v62, v60, v61
  ds_write_b32 v158, v62
  s_branch cB_va1_t2d
cB_va1_last:
  s_barrier
  ds_read_b128 v[64:67], v2 offset:4096
  ds_read_b128 v[68:71], v2 offset:5120
  ds_read_b128 v[72:75], v2 offset:6144
  ds_read_b128 v[76:79], v2 offset:7168
  s_waitcnt lgkmcnt(0)
  v_min_u32 v64, -2, v64
  v_min_u32 v65, -2, v65
  v_min_u32 v66, -2, v66
  v_min_u32 v67, -2, v67
  v_min_u32 v68, -2, v68
  v_min_u32 v69, -2, v69
  v_min_u32 v70, -2, v70
  v_min_u32 v71, -2, v71
  v_min_u32 v72, -2, v72
  v_min_u32 v73, -2, v73
  v_min_u32 v74, -2, v74
  v_min_u32 v75, -2, v75
  v_min_u32 v76, -2, v76
  v_min_u32 v77, -2, v77
  v_min_u32 v78, -2, v78
  v_min_u32 v79, -2, v79
  buffer_store_dwordx4 v[64:67], v2, s[8:11], s33 offen offset:0 sc1
  buffer_store_dwordx4 v[68:71], v2, s[8:11], s33 offen offset:2048 sc1
  s_add_u32 s33, s33, 4096
  buffer_store_dwordx4 v[72:75], v2, s[8:11], s33 offen offset:0 sc1
  buffer_store_dwordx4 v[76:79], v2, s[8:11], s33 offen offset:2048 sc1
  s_add_u32 s33, s33, 4096
  s_waitcnt vmcnt(0)
  buffer_wbl2 sc1
  s_branch cB_done
cB_va1_rp:
  s_cmp_eq_u32 s37, 0
  s_cbranch_scc1 cB_va1_rv
  v_min_u32 v160, -2, v160
  buffer_store_dword v160, v1, s[8:11], s21 offen sc1
  s_branch cB_va1_cont
cB_va1_rv:
  s_add_u32 s31, s31, 0x10000
  buffer_load_dwordx4 v[8:11], v2, s[8:11], s22 offen offset:0 sc1
  buffer_load_dwordx4 v[12:15], v2, s[8:11], s22 offen offset:1024 sc1
  buffer_load_dwordx4 v[16:19], v2, s[8:11], s22 offen offset:2048 sc1
  buffer_load_dwordx4 v[20:23], v2, s[8:11], s22 offen offset:3072 sc1
  buffer_load_dwordx4 v[24:27], v2, s[8:11], s34 offen offset:0 sc1
  buffer_load_dwordx4 v[28:31], v2, s[8:11], s34 offen offset:1024 sc1
  buffer_load_dwordx4 v[32:35], v2, s[8:11], s34 offen offset:2048 sc1
  buffer_load_dwordx4 v[36:39], v2, s[8:11], s34 offen offset:3072 sc1
  buffer_load_dwordx4 v[40:43], v2, s[8:11], s36 offen offset:0 sc1
  buffer_load_dwordx4 v[44:47], v2, s[8:11], s36 offen offset:1024 sc1
  s_waitcnt vmcnt(0)
  v_max3_u32 v52, v8, v9, v10
  v_max3_u32 v52, v52, v11, v12
  v_max3_u32 v52, v52, v13, v14
  v_max3_u32 v52, v52, v15, v16
  v_max3_u32 v52, v52, v17, v18
  v_max3_u32 v52, v52, v19, v20
  v_max3_u32 v52, v52, v21, v22
  v_max3_u32 v52, v52, v23, v24
  v_max3_u32 v52, v52, v25, v26
  v_max3_u32 v52, v52, v27, v28
  v_max3_u32 v52, v52, v29, v30
  v_max3_u32 v52, v52, v31, v32
  v_max3_u32 v52, v52, v33, v34
  v_max3_u32 v52, v52, v35, v36
  v_max3_u32 v52, v52, v37, v38
  v_max3_u32 v52, v52, v39, v40
  v_max3_u32 v52, v52, v41, v42
  v_max3_u32 v52, v52, v43, v44
  v_max3_u32 v52, v52, v45, v46
  v_max_u32 v52, v52, v47
  v_cmp_eq_u32 vcc, -1, v52
  s_mov_b32 s37, 1
  v_mov_b32 v48, 0
  v_mov_b32 v49, 0
  v_mov_b32 v50, 0
  v_mov_b32 v51, 0
  s_nop 1
  s_cbranch_vccz cB_va1_lp
  s_add_u32 s30, s30, 1
  s_cmp_lt_u32 s30, 400000
  s_cbranch_scc1 cB_va1_rv
  s_branch cB_abort
.p2align 6
cB_va2_loop:
  s_mov_b32 s30, 0
cB_va2_fp_l:
  v_cmp_gt_u32 vcc, s19, v96
  buffer_load_dword v96, v119, s[8:11], 0 offen sc1
  s_cbranch_vccz cB_va2_fp_d
  v_cmp_gt_u32 vcc, s19, v96
  buffer_load_dword v96, v119, s[8:11], 0 offen sc1
  s_cbranch_vccz cB_va2_fp_d
  v_cmp_gt_u32 vcc, s19, v96
  buffer_load_dword v96, v119, s[8:11], 0 offen sc1
  s_cbranch_vccz cB_va2_fp_d
  v_cmp_gt_u32 vcc, s19, v96
  buffer_load_dword v96, v119, s[8:11], 0 offen sc1
  s_cbranch_vccz cB_va2_fp_d
  v_cmp_gt_u32 vcc, s19, v96
  buffer_load_dword v96, v119, s[8:11], 0 offen sc1
  s_cbranch_vccz cB_va2_fp_d
  v_cmp_gt_u32 vcc, s19, v96
  buffer_load_dword v96, v119, s[8:11], 0 offen sc1
  s_cbranch_vccz cB_va2_fp_d
  v_cmp_gt_u32 vcc, s19, v96
  buffer_load_dword v96, v119, s[8:11], 0 offen sc1
  s_cbranch_vccz cB_va2_fp_d
  v_cmp_gt_u32 vcc, s19, v96
  buffer_load_dword v96, v119, s[8:11], 0 offen sc1
  s_cbranch_vccz cB_va2_fp_d
  v_cmp_gt_u32 vcc, s19, v96
  buffer_load_dword v96, v119, s[8:11], 0 offen sc1
  s_cbranch_vccz cB_va2_fp_d
  v_cmp_gt_u32 vcc, s19, v96
  buffer_load_dword v96, v119, s[8:11], 0 offen sc1
  s_cbranch_vccz cB_va2_fp_d
  v_cmp_gt_u32 vcc, s19, v96
  buffer_load_dword v96, v119, s[8:11], 0 offen sc1
  s_cbranch_vccz cB_va2_fp_d
  v_cmp_gt_u32 vcc, s19, v96
  buffer_load_dword v96, v119, s[8:11], 0 offen sc1
  s_cbranch_vccz cB_va2_fp_d
  v_cmp_gt_u32 vcc, s19, v96
  buffer_load_dword v96, v119, s[8:11], 0 offen sc1
  s_cbranch_vccz cB_va2_fp_d
  v_cmp_gt_u32 vcc, s19, v96
  buffer_load_dword v96, v119, s[8:11], 0 offen sc1
  s_cbranch_vccz cB_va2_fp_d
  v_cmp_gt_u32 vcc, s19, v96
  buffer_load_dword v96, v119, s[8:11], 0 offen sc1
  s_cbranch_vccz cB_va2_fp_d
  v_cmp_gt_u32 vcc, s19, v96
  buffer_load_dword v96, v119, s[8:11], 0 offen sc1
  s_cbranch_vccz cB_va2_fp_d
  s_waitcnt vmcnt(24)
  s_add_u32 s30, s30, 1
  s_cmp_lt_u32 s30, 400000
  s_cbranch_scc1 cB_va2_fp_l
  s_branch cB_abort
cB_va2_fp_d:
  buffer_load_dwordx4 v[8:11], v2, s[8:11], s20 offen offset:0 sc1
  buffer_load_dwordx4 v[12:15], v2, s[8:11], s20 offen offset:1024 sc1
  s_barrier
  s_barrier
  s_waitcnt vmcnt(0)
  ds_write_b128 v2, v[8:11] offset:8192
  ds_write_b128 v2, v[12:15] offset:9216
  v_smfmac_f32_16x16x64_bf16 v[36:39], v[8:11], a[0:7], v3
  v_smfmac_f32_16x16x64_bf16 v[40:43], v[8:11], a[56:63], v3
  v_smfmac_f32_16x16x64_bf16 v[44:47], v[8:11], a[112:119], v3
  v_smfmac_f32_16x16x64_bf16 v[48:51], v[8:11], a[168:175], v3
  v_smfmac_f32_16x16x64_bf16 v[52:55], v[8:11], a[224:231], v3
  s_waitcnt lgkmcnt(0)
  s_barrier
  ds_read_b128 v[16:19], v2 offset:10240
  ds_read_b128 v[20:23], v2 offset:11264
  ds_read_b128 v[24:27], v2 offset:12288
  ds_read_b128 v[28:31], v2 offset:13312
  ds_read_b128 v[32:35], v2 offset:14336
  v_smfmac_f32_16x16x64_bf16 v[56:59], v[8:11], v[144:151], v3
  v_smfmac_f32_16x16x64_bf16 v[60:63], v[8:11], v[200:207], v3
  v_smfmac_f32_16x16x64_bf16 v[36:39], v[12:15], a[8:15], v3
  v_smfmac_f32_16x16x64_bf16 v[40:43], v[12:15], a[64:71], v3
  v_smfmac_f32_16x16x64_bf16 v[44:47], v[12:15], a[120:127], v3
  v_smfmac_f32_16x16x64_bf16 v[48:51], v[12:15], a[176:183], v3
  v_smfmac_f32_16x16x64_bf16 v[52:55], v[12:15], a[232:239], v3
  v_smfmac_f32_16x16x64_bf16 v[56:59], v[12:15], v[152:159], v3
  ds_read_b128 v[68:71], v0 offset:0
  ds_read_b128 v[72:75], v0 offset:1024
  v_smfmac_f32_16x16x64_bf16 v[60:63], v[12:15], v[208:215], v3
  s_waitcnt lgkmcnt(6)
  ds_read_b128 v[76:79], v0 offset:2048
  ds_read_b128 v[80:83], v0 offset:3072
  v_smfmac_f32_16x16x64_bf16 v[36:39], v[16:19], a[16:23], v3
  s_waitcnt lgkmcnt(7)
  v_smfmac_f32_16x16x64_bf16 v[36:39], v[20:23], a[24:31], v3
  s_waitcnt lgkmcnt(6)
  v_smfmac_f32_16x16x64_bf16 v[36:39], v[24:27], a[32:39], v3
  s_waitcnt lgkmcnt(2)
  v_smfmac_f32_16x16x64_bf16 v[64:67], v[8:11], v[68:75], v3
  s_waitcnt lgkmcnt(5)
  ds_read_b128 v[84:87], v0 offset:4096
  ds_read_b128 v[88:91], v0 offset:5120
  v_smfmac_f32_16x16x64_bf16 v[36:39], v[28:31], a[40:47], v3
  s_waitcnt lgkmcnt(6)
  v_smfmac_f32_16x16x64_bf16 v[36:39], v[32:35], a[48:55], v3
  v_smfmac_f32_16x16x64_bf16 v[40:43], v[16:19], a[72:79], v3
  s_waitcnt lgkmcnt(2)
  v_smfmac_f32_16x16x64_bf16 v[64:67], v[12:15], v[76:83], v3
  ds_read_b128 v[68:71], v0 offset:6144
  ds_read_b128 v[72:75], v0 offset:7168
  v_smfmac_f32_16x16x64_bf16 v[40:43], v[20:23], a[80:87], v3
  v_permlane32_swap_b32 v36, v38
  v_smfmac_f32_16x16x64_bf16 v[40:43], v[24:27], a[88:95], v3
  v_permlane32_swap_b32 v37, v39
  v_smfmac_f32_16x16x64_bf16 v[40:43], v[28:31], a[96:103], v3
  s_waitcnt lgkmcnt(2)
  v_add_f32 v36, v36, v38
  v_smfmac_f32_16x16x64_bf16 v[64:67], v[16:19], v[84:91], v3
  ds_read_b128 v[76:79], v0 offset:8192
  ds_read_b128 v[80:83], v0 offset:9216
  v_add_f32 v37, v37, v39
  v_smfmac_f32_16x16x64_bf16 v[40:43], v[32:35], a[104:111], v3
  v_cmp_u_f32 vcc, v36, v37
  v_smfmac_f32_16x16x64_bf16 v[44:47], v[16:19], a[128:135], v3
  v_cvt_pk_bf16_f32 v38, v36, v37
  v_smfmac_f32_16x16x64_bf16 v[44:47], v[20:23], a[136:143], v3
  ds_write_b32 v104, v38
  s_waitcnt lgkmcnt(3)
  s_cbranch_vccnz cB_va2_slow
  v_permlane32_swap_b32 v40, v42
  v_smfmac_f32_16x16x64_bf16 v[64:67], v[20:23], v[68:75], v3
  ds_read_b128 v[84:87], v0 offset:10240
  ds_read_b128 v[88:91], v0 offset:11264
  v_permlane32_swap_b32 v41, v43
  v_smfmac_f32_16x16x64_bf16 v[44:47], v[24:27], a[144:151], v3
  v_add_f32 v40, v40, v42
  v_smfmac_f32_16x16x64_bf16 v[44:47], v[28:31], a[152:159], v3
  v_add_f32 v41, v41, v43
  v_smfmac_f32_16x16x64_bf16 v[44:47], v[32:35], a[160:167], v3
  s_waitcnt lgkmcnt(3)
  v_cvt_pk_bf16_f32 v42, v40, v41
  v_smfmac_f32_16x16x64_bf16 v[64:67], v[24:27], v[76:83], v3
  ds_write_b32 v105, v42
  ds_read_b128 v[68:71], v0 offset:12288
  ds_read_b128 v[72:75], v0 offset:13312
  v_smfmac_f32_16x16x64_bf16 v[48:51], v[16:19], a[184:191], v3
  s_nop 0
  v_permlane32_swap_b32 v44, v46
  v_smfmac_f32_16x16x64_bf16 v[48:51], v[20:23], a[192:199], v3
  v_permlane32_swap_b32 v45, v47
  v_smfmac_f32_16x16x64_bf16 v[48:51], v[24:27], a[200:207], v3
  s_waitcnt lgkmcnt(3)
  v_add_f32 v44, v44, v46
  v_smfmac_f32_16x16x64_bf16 v[64:67], v[28:31], v[84:91], v3
  v_add_f32 v45, v45, v47
  v_smfmac_f32_16x16x64_bf16 v[48:51], v[28:31], a[208:215], v3
  v_cvt_pk_bf16_f32 v46, v44, v45
  v_smfmac_f32_16x16x64_bf16 v[48:51], v[32:35], a[216:223], v3
  ds_write_b32 v106, v46
  v_smfmac_f32_16x16x64_bf16 v[52:55], v[16:19], a[240:247], v3
  s_waitcnt lgkmcnt(1)
  v_smfmac_f32_16x16x64_bf16 v[64:67], v[32:35], v[68:75], v3
  v_smfmac_f32_16x16x64_bf16 v[52:55], v[20:23], a[248:255], v3
  v_permlane32_swap_b32 v48, v50
  v_smfmac_f32_16x16x64_bf16 v[52:55], v[24:27], v[120:127], v3
  v_permlane32_swap_b32 v49, v51
  v_smfmac_f32_16x16x64_bf16 v[52:55], v[28:31], v[128:135], v3
  v_add_f32 v48, v48, v50
  v_smfmac_f32_16x16x64_bf16 v[52:55], v[32:35], v[136:143], v3
  v_add_f32 v49, v49, v51
  v_smfmac_f32_16x16x64_bf16 v[56:59], v[16:19], v[160:167], v3
  v_cvt_pk_bf16_f32 v50, v48, v49
  v_smfmac_f32_16x16x64_bf16 v[56:59], v[20:23], v[168:175], v3
  ds_write_b32 v107, v50
  v_permlane32_swap_b32 v64, v66
  v_smfmac_f32_16x16x64_bf16 v[56:59], v[24:27], v[176:183], v3
  v_permlane32_swap_b32 v65, v67
  v_smfmac_f32_16x16x64_bf16 v[56:59], v[28:31], v[184:191], v3
  v_add_f32 v64, v64, v66
  v_smfmac_f32_16x16x64_bf16 v[56:59], v[32:35], v[192:199], v3
  v_add_f32 v65, v65, v67
  v_smfmac_f32_16x16x64_bf16 v[60:63], v[16:19], v[216:223], v3
  v_cvt_pk_bf16_f32 v66, v64, v65
  v_smfmac_f32_16x16x64_bf16 v[60:63], v[20:23], v[224:231], v3
  ds_write_b32 v111, v66
  v_permlane32_swap_b32 v52, v54
  v_smfmac_f32_16x16x64_bf16 v[60:63], v[24:27], v[232:239], v3
  v_permlane32_swap_b32 v53, v55
  v_smfmac_f32_16x16x64_bf16 v[60:63], v[28:31], v[240:247], v3
  v_add_f32 v52, v52, v54
  v_smfmac_f32_16x16x64_bf16 v[60:63], v[32:35], v[248:255], v3
  v_add_f32 v53, v53, v55
  v_cvt_pk_bf16_f32 v54, v52, v53
  ds_write_b32 v108, v54
  v_permlane32_swap_b32 v56, v58
  v_permlane32_swap_b32 v57, v59
  v_add_f32 v56, v56, v58
  v_add_f32 v57, v57, v59
  v_cvt_pk_bf16_f32 v58, v56, v57
  ds_write_b32 v109, v58
  v_permlane32_swap_b32 v60, v62
  v_permlane32_swap_b32 v61, v63
  v_add_f32 v60, v60, v62
  v_add_f32 v61, v61, v63
  v_cvt_pk_bf16_f32 v62, v60, v61
  ds_write_b32 v110, v62
cB_va2_t2d:
  v_mov_b32 v117, s18
  s_waitcnt lgkmcnt(0)
  s_barrier
  s_cmp_eq_u32 s19, 63
  s_cbranch_scc1 cB_done
  s_sleep 1
  v_mov_b32 v36, 0
  v_mov_b32 v37, 0
  v_mov_b32 v38, 0
  v_mov_b32 v39, 0
  v_mov_b32 v40, 0
  v_mov_b32 v41, 0
  v_mov_b32 v42, 0
  v_mov_b32 v43, 0
  v_mov_b32 v44, 0
  v_mov_b32 v45, 0
  v_mov_b32 v46, 0
  v_mov_b32 v47, 0
  v_mov_b32 v48, 0
  v_mov_b32 v49, 0
  v_mov_b32 v50, 0
  v_mov_b32 v51, 0
  v_mov_b32 v52, 0
  v_mov_b32 v53, 0
  v_mov_b32 v54, 0
  v_mov_b32 v55, 0
  v_mov_b32 v56, 0
  v_mov_b32 v57, 0
  v_mov_b32 v58, 0
  v_mov_b32 v59, 0
  v_mov_b32 v60, 0
  v_mov_b32 v61, 0
  v_mov_b32 v62, 0
  v_mov_b32 v63, 0
  v_mov_b32 v64, 0
  v_mov_b32 v65, 0
  v_mov_b32 v66, 0
  v_mov_b32 v67, 0
  s_sleep 5
  s_mov_b32 s19, s18
  s_add_u32 s18, s18, 1
  s_mov_b32 s22, s20
  s_mov_b32 s20, s21
  s_mov_b32 s21, s22
  s_add_u32 s23, s20, 4096
  s_branch cB_va2_loop
cB_va2_slow:
  s_waitcnt lgkmcnt(0)
cB_va2_sl1:
  s_add_u32 s31, s31, 0x1000000
  buffer_load_dwordx4 v[8:11], v2, s[8:11], s20 offen offset:0 sc1
  buffer_load_dwordx4 v[12:15], v2, s[8:11], s20 offen offset:1024 sc1
  buffer_load_dwordx4 v[16:19], v2, s[8:11], s20 offen offset:2048 sc1
  buffer_load_dwordx4 v[20:23], v2, s[8:11], s20 offen offset:3072 sc1
  buffer_load_dwordx4 v[24:27], v2, s[8:11], s23 offen offset:0 sc1
  buffer_load_dwordx4 v[28:31], v2, s[8:11], s23 offen offset:1024 sc1
  buffer_load_dwordx4 v[32:35], v2, s[8:11], s23 offen offset:2048 sc1
  s_waitcnt vmcnt(0)
  v_max3_u32 v36, v8, v9, v10
  v_max3_u32 v36, v36, v11, v12
  v_max3_u32 v36, v36, v13, v14
  v_max3_u32 v36, v36, v15, v16
  v_max3_u32 v36, v36, v17, v18
  v_max3_u32 v36, v36, v19, v20
  v_max3_u32 v36, v36, v21, v22
  v_max3_u32 v36, v36, v23, v24
  v_max3_u32 v36, v36, v25, v26
  v_max3_u32 v36, v36, v27, v28
  v_max3_u32 v36, v36, v29, v30
  v_max3_u32 v36, v36, v31, v32
  v_max3_u32 v36, v36, v33, v34
  v_max_u32 v36, v36, v35
  v_cmp_eq_u32 vcc, -1, v36
  s_cbranch_vccz cB_va2_sl2
  s_add_u32 s30, s30, 1
  s_cmp_lt_u32 s30, 400000
  s_cbranch_scc1 cB_va2_sl1
  s_branch cB_abort
cB_va2_sl2:
  v_mov_b32 v36, 0
  v_mov_b32 v37, 0
  v_mov_b32 v38, 0
  v_mov_b32 v39, 0
  v_mov_b32 v40, 0
  v_mov_b32 v41, 0
  v_mov_b32 v42, 0
  v_mov_b32 v43, 0
  v_mov_b32 v44, 0
  v_mov_b32 v45, 0
  v_mov_b32 v46, 0
  v_mov_b32 v47, 0
  v_mov_b32 v48, 0
  v_mov_b32 v49, 0
  v_mov_b32 v50, 0
  v_mov_b32 v51, 0
  v_mov_b32 v52, 0
  v_mov_b32 v53, 0
  v_mov_b32 v54, 0
  v_mov_b32 v55, 0
  v_mov_b32 v56, 0
  v_mov_b32 v57, 0
  v_mov_b32 v58, 0
  v_mov_b32 v59, 0
  v_mov_b32 v60, 0
  v_mov_b32 v61, 0
  v_mov_b32 v62, 0
  v_mov_b32 v63, 0
  v_mov_b32 v64, 0
  v_mov_b32 v65, 0
  v_mov_b32 v66, 0
  v_mov_b32 v67, 0
  ds_read_b128 v[68:71], v0 offset:0
  ds_read_b128 v[72:75], v0 offset:1024
  v_smfmac_f32_16x16x64_bf16 v[36:39], v[8:11], a[0:7], v3
  v_smfmac_f32_16x16x64_bf16 v[40:43], v[8:11], a[56:63], v3
  v_smfmac_f32_16x16x64_bf16 v[44:47], v[8:11], a[112:119], v3
  v_smfmac_f32_16x16x64_bf16 v[48:51], v[8:11], a[168:175], v3
  v_smfmac_f32_16x16x64_bf16 v[52:55], v[8:11], a[224:231], v3
  v_smfmac_f32_16x16x64_bf16 v[56:59], v[8:11], v[144:151], v3
  v_smfmac_f32_16x16x64_bf16 v[60:63], v[8:11], v[200:207], v3
  s_waitcnt lgkmcnt(0)
  v_smfmac_f32_16x16x64_bf16 v[64:67], v[8:11], v[68:75], v3
  ds_read_b128 v[76:79], v0 offset:2048
  ds_read_b128 v[80:83], v0 offset:3072
  v_smfmac_f32_16x16x64_bf16 v[36:39], v[12:15], a[8:15], v3
  v_smfmac_f32_16x16x64_bf16 v[40:43], v[12:15], a[64:71], v3
  v_smfmac_f32_16x16x64_bf16 v[44:47], v[12:15], a[120:127], v3
  v_smfmac_f32_16x16x64_bf16 v[48:51], v[12:15], a[176:183], v3
  v_smfmac_f32_16x16x64_bf16 v[52:55], v[12:15], a[232:239], v3
  v_smfmac_f32_16x16x64_bf16 v[56:59], v[12:15], v[152:159], v3
  v_smfmac_f32_16x16x64_bf16 v[60:63], v[12:15], v[208:215], v3
  s_waitcnt lgkmcnt(0)
  v_smfmac_f32_16x16x64_bf16 v[64:67], v[12:15], v[76:83], v3
  ds_read_b128 v[84:87], v0 offset:4096
  ds_read_b128 v[88:91], v0 offset:5120
  v_smfmac_f32_16x16x64_bf16 v[36:39], v[16:19], a[16:23], v3
  v_smfmac_f32_16x16x64_bf16 v[40:43], v[16:19], a[72:79], v3
  v_smfmac_f32_16x16x64_bf16 v[44:47], v[16:19], a[128:135], v3
  v_smfmac_f32_16x16x64_bf16 v[48:51], v[16:19], a[184:191], v3
  v_smfmac_f32_16x16x64_bf16 v[52:55], v[16:19], a[240:247], v3
  v_smfmac_f32_16x16x64_bf16 v[56:59], v[16:19], v[160:167], v3
  v_smfmac_f32_16x16x64_bf16 v[60:63], v[16:19], v[216:223], v3
  s_waitcnt lgkmcnt(0)
  v_smfmac_f32_16x16x64_bf16 v[64:67], v[16:19], v[84:91], v3
  ds_read_b128 v[68:71], v0 offset:6144
  ds_read_b128 v[72:75], v0 offset:7168
  v_smfmac_f32_16x16x64_bf16 v[36:39], v[20:23], a[24:31], v3
  v_smfmac_f32_16x16x64_bf16 v[40:43], v[20:23], a[80:87], v3
  v_smfmac_f32_16x16x64_bf16 v[44:47], v[20:23], a[136:143], v3
  v_smfmac_f32_16x16x64_bf16 v[48:51], v[20:23], a[192:199], v3
  v_smfmac_f32_16x16x64_bf16 v[52:55], v[20:23], a[248:255], v3
  v_smfmac_f32_16x16x64_bf16 v[56:59], v[20:23], v[168:175], v3
  v_smfmac_f32_16x16x64_bf16 v[60:63], v[20:23], v[224:231], v3
  s_waitcnt lgkmcnt(0)
  v_smfmac_f32_16x16x64_bf16 v[64:67], v[20:23], v[68:75], v3
  ds_read_b128 v[76:79], v0 offset:8192
  ds_read_b128 v[80:83], v0 offset:9216
  v_smfmac_f32_16x16x64_bf16 v[36:39], v[24:27], a[32:39], v3
  v_smfmac_f32_16x16x64_bf16 v[40:43], v[24:27], a[88:95], v3
  v_smfmac_f32_16x16x64_bf16 v[44:47], v[24:27], a[144:151], v3
  v_smfmac_f32_16x16x64_bf16 v[48:51], v[24:27], a[200:207], v3
  v_smfmac_f32_16x16x64_bf16 v[52:55], v[24:27], v[120:127], v3
  v_smfmac_f32_16x16x64_bf16 v[56:59], v[24:27], v[176:183], v3
  v_smfmac_f32_16x16x64_bf16 v[60:63], v[24:27], v[232:239], v3
  s_waitcnt lgkmcnt(0)
  v_smfmac_f32_16x16x64_bf16 v[64:67], v[24:27], v[76:83], v3
  ds_read_b128 v[84:87], v0 offset:10240
  ds_read_b128 v[88:91], v0 offset:11264
  v_smfmac_f32_16x16x64_bf16 v[36:39], v[28:31], a[40:47], v3
  v_smfmac_f32_16x16x64_bf16 v[40:43], v[28:31], a[96:103], v3
  v_smfmac_f32_16x16x64_bf16 v[44:47], v[28:31], a[152:159], v3
  v_smfmac_f32_16x16x64_bf16 v[48:51], v[28:31], a[208:215], v3
  v_smfmac_f32_16x16x64_bf16 v[52:55], v[28:31], v[128:135], v3
  v_smfmac_f32_16x16x64_bf16 v[56:59], v[28:31], v[184:191], v3
  v_smfmac_f32_16x16x64_bf16 v[60:63], v[28:31], v[240:247], v3
  s_waitcnt lgkmcnt(0)
  v_smfmac_f32_16x16x64_bf16 v[64:67], v[28:31], v[84:91], v3
  ds_read_b128 v[68:71], v0 offset:12288
  ds_read_b128 v[72:75], v0 offset:13312
  v_smfmac_f32_16x16x64_bf16 v[36:39], v[32:35], a[48:55], v3
  v_smfmac_f32_16x16x64_bf16 v[40:43], v[32:35], a[104:111], v3
  v_smfmac_f32_16x16x64_bf16 v[44:47], v[32:35], a[160:167], v3
  v_smfmac_f32_16x16x64_bf16 v[48:51], v[32:35], a[216:223], v3
  v_smfmac_f32_16x16x64_bf16 v[52:55], v[32:35], v[136:143], v3
  v_smfmac_f32_16x16x64_bf16 v[56:59], v[32:35], v[192:199], v3
  v_smfmac_f32_16x16x64_bf16 v[60:63], v[32:35], v[248:255], v3
  s_waitcnt lgkmcnt(0)
  v_smfmac_f32_16x16x64_bf16 v[64:67], v[32:35], v[68:75], v3
  v_permlane32_swap_b32 v36, v38
  v_permlane32_swap_b32 v37, v39
  v_add_f32 v36, v36, v38
  v_add_f32 v37, v37, v39
  v_cvt_pk_bf16_f32 v38, v36, v37
  ds_write_b32 v104, v38
  v_permlane32_swap_b32 v40, v42
  v_permlane32_swap_b32 v41, v43
  v_add_f32 v40, v40, v42
  v_add_f32 v41, v41, v43
  v_cvt_pk_bf16_f32 v42, v40, v41
  ds_write_b32 v105, v42
  v_permlane32_swap_b32 v44, v46
  v_permlane32_swap_b32 v45, v47
  v_add_f32 v44, v44, v46
  v_add_f32 v45, v45, v47
  v_cvt_pk_bf16_f32 v46, v44, v45
  ds_write_b32 v106, v46
  v_permlane32_swap_b32 v48, v50
  v_permlane32_swap_b32 v49, v51
  v_add_f32 v48, v48, v50
  v_add_f32 v49, v49, v51
  v_cvt_pk_bf16_f32 v50, v48, v49
  ds_write_b32 v107, v50
  v_permlane32_swap_b32 v52, v54
  v_permlane32_swap_b32 v53, v55
  v_add_f32 v52, v52, v54
  v_add_f32 v53, v53, v55
  v_cvt_pk_bf16_f32 v54, v52, v53
  ds_write_b32 v108, v54
  v_permlane32_swap_b32 v56, v58
  v_permlane32_swap_b32 v57, v59
  v_add_f32 v56, v56, v58
  v_add_f32 v57, v57, v59
  v_cvt_pk_bf16_f32 v58, v56, v57
  ds_write_b32 v109, v58
  v_permlane32_swap_b32 v60, v62
  v_permlane32_swap_b32 v61, v63
  v_add_f32 v60, v60, v62
  v_add_f32 v61, v61, v63
  v_cvt_pk_bf16_f32 v62, v60, v61
  ds_write_b32 v110, v62
  v_permlane32_swap_b32 v64, v66
  v_permlane32_swap_b32 v65, v67
  v_add_f32 v64, v64, v66
  v_add_f32 v65, v65, v67
  v_cvt_pk_bf16_f32 v66, v64, v65
  ds_write_b32 v111, v66
  s_branch cB_va2_t2d
.p2align 6
cB_va3_loop:
  s_mov_b32 s30, 0
  s_barrier
  buffer_load_dwordx4 v[16:19], v2, s[8:11], s20 offen offset:2048 sc1
  buffer_load_dwordx4 v[20:23], v2, s[8:11], s20 offen offset:3072 sc1
  s_barrier
  buffer_load_dword v100, v116, s[8:11], s39 offen sc1
  s_add_u32 s27, s19, 2
  s_min_u32 s27, s27, 63
  s_lshr_b32 s27, s27, 3
  s_lshl_b32 s27, s27, 11
  s_add_u32 s27, s27, s35
  s_cmp_eq_u32 s27, s28
  s_cselect_b32 s29, 35328, s27
  buffer_load_dword v101, off, s[8:11], s29 sc1
  s_add_u32 s39, s39, 28672
  s_waitcnt vmcnt(2)
  ds_write_b128 v2, v[16:19] offset:10240
  ds_write_b128 v2, v[20:23] offset:11264
  v_smfmac_f32_16x16x64_bf16 v[36:39], v[16:19], a[16:23], v3
  v_smfmac_f32_16x16x64_bf16 v[40:43], v[16:19], a[72:79], v3
  v_smfmac_f32_16x16x64_bf16 v[44:47], v[16:19], a[128:135], v3
  v_smfmac_f32_16x16x64_bf16 v[48:51], v[16:19], a[184:191], v3
  v_smfmac_f32_16x16x64_bf16 v[52:55], v[16:19], a[240:247], v3
  s_waitcnt lgkmcnt(0)
  s_barrier
  ds_read_b128 v[8:11], v2 offset:8192
  ds_read_b128 v[12:15], v2 offset:9216
  ds_read_b128 v[24:27], v2 offset:12288
  ds_read_b128 v[28:31], v2 offset:13312
  ds_read_b128 v[32:35], v2 offset:14336
  v_smfmac_f32_16x16x64_bf16 v[56:59], v[16:19], v[160:167], v3
  v_smfmac_f32_16x16x64_bf16 v[60:63], v[16:19], v[216:223], v3
  v_smfmac_f32_16x16x64_bf16 v[36:39], v[20:23], a[24:31], v3
  v_smfmac_f32_16x16x64_bf16 v[40:43], v[20:23], a[80:87], v3
  v_smfmac_f32_16x16x64_bf16 v[44:47], v[20:23], a[136:143], v3
  v_smfmac_f32_16x16x64_bf16 v[48:51], v[20:23], a[192:199], v3
  v_smfmac_f32_16x16x64_bf16 v[52:55], v[20:23], a[248:255], v3
  v_smfmac_f32_16x16x64_bf16 v[56:59], v[20:23], v[168:175], v3
  v_smfmac_f32_16x16x64_bf16 v[60:63], v[20:23], v[224:231], v3
  s_waitcnt lgkmcnt(4)
  v_smfmac_f32_16x16x64_bf16 v[36:39], v[8:11], a[0:7], v3
  s_waitcnt lgkmcnt(3)
  v_smfmac_f32_16x16x64_bf16 v[36:39], v[12:15], a[8:15], v3
  s_waitcnt lgkmcnt(2)
  v_smfmac_f32_16x16x64_bf16 v[36:39], v[24:27], a[32:39], v3
  s_waitcnt lgkmcnt(1)
  v_smfmac_f32_16x16x64_bf16 v[36:39], v[28:31], a[40:47], v3
  s_waitcnt lgkmcnt(0)
  v_smfmac_f32_16x16x64_bf16 v[36:39], v[32:35], a[48:55], v3
  v_smfmac_f32_16x16x64_bf16 v[40:43], v[8:11], a[56:63], v3
  v_smfmac_f32_16x16x64_bf16 v[40:43], v[12:15], a[64:71], v3
  v_smfmac_f32_16x16x64_bf16 v[40:43], v[24:27], a[88:95], v3
  v_permlane32_swap_b32 v36, v38
  v_smfmac_f32_16x16x64_bf16 v[40:43], v[28:31], a[96:103], v3
  v_permlane32_swap_b32 v37, v39
  v_smfmac_f32_16x16x64_bf16 v[40:43], v[32:35], a[104:111], v3
  v_add_f32 v36, v36, v38
  v_smfmac_f32_16x16x64_bf16 v[44:47], v[8:11], a[112:119], v3
  v_add_f32 v37, v37, v39
  v_smfmac_f32_16x16x64_bf16 v[44:47], v[12:15], a[120:127], v3
  v_cmp_u_f32 vcc, v36, v37
  v_smfmac_f32_16x16x64_bf16 v[44:47], v[24:27], a[144:151], v3
  v_cvt_pk_bf16_f32 v38, v36, v37
  v_smfmac_f32_16x16x64_bf16 v[44:47], v[28:31], a[152:159], v3
  ds_write_b32 v104, v38
  s_cbranch_vccnz cB_va3_slow
  v_permlane32_swap_b32 v40, v42
  v_smfmac_f32_16x16x64_bf16 v[44:47], v[32:35], a[160:167], v3
  v_permlane32_swap_b32 v41, v43
  v_smfmac_f32_16x16x64_bf16 v[48:51], v[8:11], a[168:175], v3
  v_add_f32 v40, v40, v42
  v_smfmac_f32_16x16x64_bf16 v[48:51], v[12:15], a[176:183], v3
  v_add_f32 v41, v41, v43
  v_smfmac_f32_16x16x64_bf16 v[48:51], v[24:27], a[200:207], v3
  v_cvt_pk_bf16_f32 v42, v40, v41
  v_smfmac_f32_16x16x64_bf16 v[48:51], v[28:31], a[208:215], v3
  ds_write_b32 v105, v42
  v_permlane32_swap_b32 v44, v46
  v_smfmac_f32_16x16x64_bf16 v[48:51], v[32:35], a[216:223], v3
  v_permlane32_swap_b32 v45, v47
  v_smfmac_f32_16x16x64_bf16 v[52:55], v[8:11], a[224:231], v3
  v_add_f32 v44, v44, v46
  v_smfmac_f32_16x16x64_bf16 v[52:55], v[12:15], a[232:239], v3
  v_add_f32 v45, v45, v47
  v_smfmac_f32_16x16x64_bf16 v[52:55], v[24:27], v[120:127], v3
  v_cvt_pk_bf16_f32 v46, v44, v45
  v_smfmac_f32_16x16x64_bf16 v[52:55], v[28:31], v[128:135], v3
  ds_write_b32 v106, v46
  v_permlane32_swap_b32 v48, v50
  v_smfmac_f32_16x16x64_bf16 v[52:55], v[32:35], v[136:143], v3
  v_permlane32_swap_b32 v49, v51
  v_smfmac_f32_16x16x64_bf16 v[56:59], v[8:11], v[144:151], v3
  v_add_f32 v48, v48, v50
  v_smfmac_f32_16x16x64_bf16 v[56:59], v[12:15], v[152:159], v3
  v_add_f32 v49, v49, v51
  v_smfmac_f32_16x16x64_bf16 v[56:59], v[24:27], v[176:183], v3
  v_cvt_pk_bf16_f32 v50, v48, v49
  v_smfmac_f32_16x16x64_bf16 v[56:59], v[28:31], v[184:191], v3
  ds_write_b32 v107, v50
  v_permlane32_swap_b32 v52, v54
  v_smfmac_f32_16x16x64_bf16 v[56:59], v[32:35], v[192:199], v3
  v_permlane32_swap_b32 v53, v55
  v_smfmac_f32_16x16x64_bf16 v[60:63], v[8:11], v[200:207], v3
  v_add_f32 v52, v52, v54
  v_smfmac_f32_16x16x64_bf16 v[60:63], v[12:15], v[208:215], v3
  v_add_f32 v53, v53, v55
  v_smfmac_f32_16x16x64_bf16 v[60:63], v[24:27], v[232:239], v3
  v_cvt_pk_bf16_f32 v54, v52, v53
  v_smfmac_f32_16x16x64_bf16 v[60:63], v[28:31], v[240:247], v3
  ds_write_b32 v108, v54
  v_permlane32_swap_b32 v56, v58
  v_smfmac_f32_16x16x64_bf16 v[60:63], v[32:35], v[248:255], v3
  v_permlane32_swap_b32 v57, v59
  v_add_f32 v56, v56, v58
  v_add_f32 v57, v57, v59
  v_cvt_pk_bf16_f32 v58, v56, v57
  ds_write_b32 v109, v58
  s_nop 2
  v_permlane32_swap_b32 v60, v62
  v_permlane32_swap_b32 v61, v63
  v_add_f32 v60, v60, v62
  v_add_f32 v61, v61, v63
  v_cvt_pk_bf16_f32 v62, v60, v61
  ds_write_b32 v110, v62
cB_va3_t2d:
  v_mov_b32 v117, s18
  s_cmp_eq_u32 s27, s28
  s_cbranch_scc1 cB_va3_vok
cB_va3_vow:
  s_waitcnt vmcnt(0)
  v_cmp_ne_u32 vcc, 56, v101
  s_cbranch_vccnz cB_va3_vor
  s_mov_b32 s28, s27
cB_va3_vok:
  s_waitcnt lgkmcnt(0)
  s_setprio 3
  s_barrier
  v_mov_b32 v36, 0
  v_mov_b32 v37, 0
  buffer_store_dword v117, v118, s[8:11], 0 offen sc1
  s_setprio 0
  s_cmp_eq_u32 s19, 63
  s_cbranch_scc1 cB_done
  v_mov_b32 v38, 0
  v_mov_b32 v39, 0
  v_mov_b32 v40, 0
  v_mov_b32 v41, 0
  v_mov_b32 v42, 0
  v_mov_b32 v43, 0
  v_mov_b32 v44, 0
  v_mov_b32 v45, 0
  v_mov_b32 v46, 0
  v_mov_b32 v47, 0
  v_mov_b32 v48, 0
  v_mov_b32 v49, 0
  v_mov_b32 v50, 0
  v_mov_b32 v51, 0
  v_mov_b32 v52, 0
  v_mov_b32 v53, 0
  v_mov_b32 v54, 0
  v_mov_b32 v55, 0
  v_mov_b32 v56, 0
  v_mov_b32 v57, 0
  v_mov_b32 v58, 0
  v_mov_b32 v59, 0
  v_mov_b32 v60, 0
  v_mov_b32 v61, 0
  v_mov_b32 v62, 0
  v_mov_b32 v63, 0
  s_mov_b32 s19, s18
  s_add_u32 s18, s18, 1
  s_mov_b32 s22, s20
  s_mov_b32 s20, s21
  s_mov_b32 s21, s22
  s_add_u32 s23, s20, 4096
  s_branch cB_va3_loop
cB_va3_slow:
  s_waitcnt lgkmcnt(0)
cB_va3_sl1:
  s_add_u32 s31, s31, 0x1000000
  buffer_load_dwordx4 v[8:11], v2, s[8:11], s20 offen offset:0 sc1
  buffer_load_dwordx4 v[12:15], v2, s[8:11], s20 offen offset:1024 sc1
  buffer_load_dwordx4 v[16:19], v2, s[8:11], s20 offen offset:2048 sc1
  buffer_load_dwordx4 v[20:23], v2, s[8:11], s20 offen offset:3072 sc1
  buffer_load_dwordx4 v[24:27], v2, s[8:11], s23 offen offset:0 sc1
  buffer_load_dwordx4 v[28:31], v2, s[8:11], s23 offen offset:1024 sc1
  buffer_load_dwordx4 v[32:35], v2, s[8:11], s23 offen offset:2048 sc1
  s_waitcnt vmcnt(0)
  v_max3_u32 v36, v8, v9, v10
  v_max3_u32 v36, v36, v11, v12
  v_max3_u32 v36, v36, v13, v14
  v_max3_u32 v36, v36, v15, v16
  v_max3_u32 v36, v36, v17, v18
  v_max3_u32 v36, v36, v19, v20
  v_max3_u32 v36, v36, v21, v22
  v_max3_u32 v36, v36, v23, v24
  v_max3_u32 v36, v36, v25, v26
  v_max3_u32 v36, v36, v27, v28
  v_max3_u32 v36, v36, v29, v30
  v_max3_u32 v36, v36, v31, v32
  v_max3_u32 v36, v36, v33, v34
  v_max_u32 v36, v36, v35
  v_cmp_eq_u32 vcc, -1, v36
  s_cbranch_vccz cB_va3_sl2
  s_add_u32 s30, s30, 1
  s_cmp_lt_u32 s30, 400000
  s_cbranch_scc1 cB_va3_sl1
  s_branch cB_abort
cB_va3_sl2:
  v_mov_b32 v36, 0
  v_mov_b32 v37, 0
  v_mov_b32 v38, 0
  v_mov_b32 v39, 0
  v_mov_b32 v40, 0
  v_mov_b32 v41, 0
  v_mov_b32 v42, 0
  v_mov_b32 v43, 0
  v_mov_b32 v44, 0
  v_mov_b32 v45, 0
  v_mov_b32 v46, 0
  v_mov_b32 v47, 0
  v_mov_b32 v48, 0
  v_mov_b32 v49, 0
  v_mov_b32 v50, 0
  v_mov_b32 v51, 0
  v_mov_b32 v52, 0
  v_mov_b32 v53, 0
  v_mov_b32 v54, 0
  v_mov_b32 v55, 0
  v_mov_b32 v56, 0
  v_mov_b32 v57, 0
  v_mov_b32 v58, 0
  v_mov_b32 v59, 0
  v_mov_b32 v60, 0
  v_mov_b32 v61, 0
  v_mov_b32 v62, 0
  v_mov_b32 v63, 0
  v_smfmac_f32_16x16x64_bf16 v[36:39], v[8:11], a[0:7], v3
  v_smfmac_f32_16x16x64_bf16 v[40:43], v[8:11], a[56:63], v3
  v_smfmac_f32_16x16x64_bf16 v[44:47], v[8:11], a[112:119], v3
  v_smfmac_f32_16x16x64_bf16 v[48:51], v[8:11], a[168:175], v3
  v_smfmac_f32_16x16x64_bf16 v[52:55], v[8:11], a[224:231], v3
  v_smfmac_f32_16x16x64_bf16 v[56:59], v[8:11], v[144:151], v3
  v_smfmac_f32_16x16x64_bf16 v[60:63], v[8:11], v[200:207], v3
  v_smfmac_f32_16x16x64_bf16 v[36:39], v[12:15], a[8:15], v3
  v_smfmac_f32_16x16x64_bf16 v[40:43], v[12:15], a[64:71], v3
  v_smfmac_f32_16x16x64_bf16 v[44:47], v[12:15], a[120:127], v3
  v_smfmac_f32_16x16x64_bf16 v[48:51], v[12:15], a[176:183], v3
  v_smfmac_f32_16x16x64_bf16 v[52:55], v[12:15], a[232:239], v3
  v_smfmac_f32_16x16x64_bf16 v[56:59], v[12:15], v[152:159], v3
  v_smfmac_f32_16x16x64_bf16 v[60:63], v[12:15], v[208:215], v3
  v_smfmac_f32_16x16x64_bf16 v[36:39], v[16:19], a[16:23], v3
  v_smfmac_f32_16x16x64_bf16 v[40:43], v[16:19], a[72:79], v3
  v_smfmac_f32_16x16x64_bf16 v[44:47], v[16:19], a[128:135], v3
  v_smfmac_f32_16x16x64_bf16 v[48:51], v[16:19], a[184:191], v3
  v_smfmac_f32_16x16x64_bf16 v[52:55], v[16:19], a[240:247], v3
  v_smfmac_f32_16x16x64_bf16 v[56:59], v[16:19], v[160:167], v3
  v_smfmac_f32_16x16x64_bf16 v[60:63], v[16:19], v[216:223], v3
  v_smfmac_f32_16x16x64_bf16 v[36:39], v[20:23], a[24:31], v3
  v_smfmac_f32_16x16x64_bf16 v[40:43], v[20:23], a[80:87], v3
  v_smfmac_f32_16x16x64_bf16 v[44:47], v[20:23], a[136:143], v3
  v_smfmac_f32_16x16x64_bf16 v[48:51], v[20:23], a[192:199], v3
  v_smfmac_f32_16x16x64_bf16 v[52:55], v[20:23], a[248:255], v3
  v_smfmac_f32_16x16x64_bf16 v[56:59], v[20:23], v[168:175], v3
  v_smfmac_f32_16x16x64_bf16 v[60:63], v[20:23], v[224:231], v3
  v_smfmac_f32_16x16x64_bf16 v[36:39], v[24:27], a[32:39], v3
  v_smfmac_f32_16x16x64_bf16 v[40:43], v[24:27], a[88:95], v3
  v_smfmac_f32_16x16x64_bf16 v[44:47], v[24:27], a[144:151], v3
  v_smfmac_f32_16x16x64_bf16 v[48:51], v[24:27], a[200:207], v3
  v_smfmac_f32_16x16x64_bf16 v[52:55], v[24:27], v[120:127], v3
  v_smfmac_f32_16x16x64_bf16 v[56:59], v[24:27], v[176:183], v3
  v_smfmac_f32_16x16x64_bf16 v[60:63], v[24:27], v[232:239], v3
  v_smfmac_f32_16x16x64_bf16 v[36:39], v[28:31], a[40:47], v3
  v_smfmac_f32_16x16x64_bf16 v[40:43], v[28:31], a[96:103], v3
  v_smfmac_f32_16x16x64_bf16 v[44:47], v[28:31], a[152:159], v3
  v_smfmac_f32_16x16x64_bf16 v[48:51], v[28:31], a[208:215], v3
  v_smfmac_f32_16x16x64_bf16 v[52:55], v[28:31], v[128:135], v3
  v_smfmac_f32_16x16x64_bf16 v[56:59], v[28:31], v[184:191], v3
  v_smfmac_f32_16x16x64_bf16 v[60:63], v[28:31], v[240:247], v3
  v_smfmac_f32_16x16x64_bf16 v[36:39], v[32:35], a[48:55], v3
  v_smfmac_f32_16x16x64_bf16 v[40:43], v[32:35], a[104:111], v3
  v_smfmac_f32_16x16x64_bf16 v[44:47], v[32:35], a[160:167], v3
  v_smfmac_f32_16x16x64_bf16 v[48:51], v[32:35], a[216:223], v3
  v_smfmac_f32_16x16x64_bf16 v[52:55], v[32:35], v[136:143], v3
  v_smfmac_f32_16x16x64_bf16 v[56:59], v[32:35], v[192:199], v3
  v_smfmac_f32_16x16x64_bf16 v[60:63], v[32:35], v[248:255], v3
  v_permlane32_swap_b32 v36, v38
  v_permlane32_swap_b32 v37, v39
  v_add_f32 v36, v36, v38
  v_add_f32 v37, v37, v39
  v_cvt_pk_bf16_f32 v38, v36, v37
  ds_write_b32 v104, v38
  v_permlane32_swap_b32 v40, v42
  v_permlane32_swap_b32 v41, v43
  v_add_f32 v40, v40, v42
  v_add_f32 v41, v41, v43
  v_cvt_pk_bf16_f32 v42, v40, v41
  ds_write_b32 v105, v42
  v_permlane32_swap_b32 v44, v46
  v_permlane32_swap_b32 v45, v47
  v_add_f32 v44, v44, v46
  v_add_f32 v45, v45, v47
  v_cvt_pk_bf16_f32 v46, v44, v45
  ds_write_b32 v106, v46
  v_permlane32_swap_b32 v48, v50
  v_permlane32_swap_b32 v49, v51
  v_add_f32 v48, v48, v50
  v_add_f32 v49, v49, v51
  v_cvt_pk_bf16_f32 v50, v48, v49
  ds_write_b32 v107, v50
  v_permlane32_swap_b32 v52, v54
  v_permlane32_swap_b32 v53, v55
  v_add_f32 v52, v52, v54
  v_add_f32 v53, v53, v55
  v_cvt_pk_bf16_f32 v54, v52, v53
  ds_write_b32 v108, v54
  v_permlane32_swap_b32 v56, v58
  v_permlane32_swap_b32 v57, v59
  v_add_f32 v56, v56, v58
  v_add_f32 v57, v57, v59
  v_cvt_pk_bf16_f32 v58, v56, v57
  ds_write_b32 v109, v58
  v_permlane32_swap_b32 v60, v62
  v_permlane32_swap_b32 v61, v63
  v_add_f32 v60, v60, v62
  v_add_f32 v61, v61, v63
  v_cvt_pk_bf16_f32 v62, v60, v61
  ds_write_b32 v110, v62
  s_branch cB_va3_t2d
cB_va3_vor:
  s_sleep 2
  buffer_load_dword v101, off, s[8:11], s27 sc1
  s_add_u32 s30, s30, 1
  s_cmp_lt_u32 s30, 400000
  s_cbranch_scc1 cB_va3_vow
  s_branch cB_abort
cB_abort:
  v_mov_b32 v4, 0xdead
  v_mov_b32 v5, 16
  buffer_store_dword v4, v5, s[12:15], 0 offen
  s_branch ch_end
cB_done:
  s_branch ch_end
ch_worker:
  s_sub_u32 s35, s3, 2
  s_and_b32 s35, s35, 7
  s_lshr_b32 s36, s2, 3
  s_lshl_b32 s33, s35, 5
  s_add_u32 s33, s33, s36
  s_mov_b32 s97, 0
  s_mov_b32 s96, 0
  s_mov_b32 s37, 0
  s_mov_b32 s38, 0
  s_mov_b32 s39, 0xffff0000
  s_mov_b32 s101, -1
  v_and_b32 v1, 63, v0
  v_lshlrev_b32 v2, 4, v1
  v_lshrrev_b32 v3, 4, v1
  v_and_b32 v4, 15, v1
  s_cmp_ge_u32 s33, 224
  s_cbranch_scc1 wp_all
  s_mov_b32 s68, s44
  s_and_b32 s69, s45, 0xffff
  s_mov_b32 s70, 3670016
  s_mov_b32 s71, 0x20000
  s_and_b32 s20, s33, 0xe0
  s_mul_i32 s20, s20, 9363
  s_lshr_b32 s20, s20, 16
  s_lshl_b32 s20, s20, 10
  s_and_b32 s21, s33, 31
  s_mul_i32 s21, s21, 192
  s_add_u32 s20, s20, s21
  v_min_u32 v7, 191, v0
  v_add_u32 v7, s20, v7
  v_lshrrev_b32 v8, 11, v7
  v_min_u32 v8, 15, v8
  v_bfe_u32 v9, v7, 2, 9
  v_lshlrev_b32 v9, 13, v9
  v_lshl_add_u32 v9, v8, 9, v9
  v_and_b32 v7, 3, v7
  v_lshl_add_u32 v9, v7, 7, v9
  buffer_load_dword v253, v9, s[68:71], 0 offen
  s_mov_b32 s68, s40
  s_and_b32 s69, s41, 0xffff
  s_mov_b32 s70, 3670016
  s_mov_b32 s71, 0x20000
  s_and_b32 s20, s33, 0xe0
  s_mul_i32 s20, s20, 9363
  s_lshr_b32 s20, s20, 16
  s_lshl_b32 s20, s20, 10
  s_and_b32 s21, s33, 31
  s_mul_i32 s21, s21, 192
  s_add_u32 s20, s20, s21
  v_min_u32 v7, 191, v0
  v_add_u32 v7, s20, v7
  v_lshrrev_b32 v8, 11, v7
  v_min_u32 v8, 15, v8
  v_bfe_u32 v9, v7, 2, 9
  v_lshlrev_b32 v9, 13, v9
  v_lshl_add_u32 v9, v8, 9, v9
  v_and_b32 v7, 3, v7
  v_lshl_add_u32 v9, v7, 7, v9
  buffer_load_dword v253, v9, s[68:71], 0 offen
  v_lshrrev_b32 v5, 5, v1
  v_and_b32 v6, 31, v1
  v_xor_b32 v8, v6, v5
  v_lshlrev_b32 v8, 4, v8
  v_lshl_add_u32 v16, v5, 13, v8
  v_xor_b32 v17, 32, v16
  v_xor_b32 v18, 64, v16
  v_xor_b32 v19, 96, v16
  v_xor_b32 v20, 128, v16
  v_xor_b32 v21, 160, v16
  v_xor_b32 v22, 192, v16
  v_xor_b32 v23, 224, v16
  s_lshl_b32 s20, s16, 6
  v_xor_b32 v26, s20, v16
  v_xor_b32 v27, 32, v26
wp_B:
  s_mul_i32 s17, s33, 4682
  s_lshr_b32 s17, s17, 16
  s_mul_i32 s23, s17, 14
  s_sub_u32 s19, s33, s23
  s_cmp_lt_u32 s19, 7
  s_cselect_b32 s18, 0, 7
  s_cselect_b32 s28, 0, 8
  s_sub_u32 s18, s19, s18
  s_add_u32 s28, s28, s16
  s_lshl_b32 s25, s16, 15
  s_add_u32 s25, s25, 32768
  s_lshl_b32 s26, s17, 9
  s_lshl_b32 s20, s33, 2
  s_add_u32 s20, s20, s16
  s_mul_i32 s21, s20, 9363
  s_lshr_b32 s21, s21, 16
  s_mul_i32 s22, s21, 7
  s_sub_u32 s22, s20, s22
  s_mul_i32 s21, s21, 14336
  s_lshl_b32 s20, s22, 7
  s_add_u32 s20, s20, s21
  s_lshl_b32 s22, s22, 11
  s_add_u32 s52, s21, s22
  s_mov_b32 s68, s48
  s_and_b32 s69, s49, 0xffff
  s_mov_b32 s70, 1835008
  s_mov_b32 s71, 0x20000
  v_mul_u32_u24 v7, 896, v4
  v_lshl_add_u32 v7, v3, 5, v7
  buffer_load_dwordx4 v[128:131], v7, s[68:71], s20 offen
  buffer_load_dwordx4 v[132:135], v7, s[68:71], s20 offen offset:16
  s_mov_b32 s60, s44
  s_and_b32 s61, s45, 0xffff
  s_mov_b32 s62, 3670016
  s_mov_b32 s63, 0x20000
  s_mov_b32 s56, s46
  s_and_b32 s57, s47, 0xffff
  s_mov_b32 s58, 3670016
  s_mov_b32 s59, 0x20000
  s_mul_i32 s27, s17, 229376
  s_lshl_b32 s30, s18, 7
  s_add_u32 s27, s27, s30
  s_mul_i32 s30, s16, 57344
  s_add_u32 s27, s27, s30
  v_lshrrev_b32 v7, 3, v1
  v_and_b32 v8, 7, v1
  v_and_b32 v9, 2, v7
  v_xor_b32 v8, v8, v9
  v_mul_u32_u24 v7, 896, v7
  v_lshl_add_u32 v24, v8, 4, v7
  v_xor_b32 v25, 64, v24
  s_lshl_b32 s30, s16, 13
  s_add_u32 m0, s30, 0
  s_nop 0
  buffer_load_dwordx4 v24, s[56:59], s27 offen  lds
  s_add_u32 s27, s27, 7168
  s_add_u32 m0, s30, 1024
  s_nop 0
  buffer_load_dwordx4 v25, s[56:59], s27 offen  lds
  s_add_u32 s27, s27, 7168
  s_add_u32 m0, s30, 2048
  s_nop 0
  buffer_load_dwordx4 v24, s[56:59], s27 offen  lds
  s_add_u32 s27, s27, 7168
  s_add_u32 m0, s30, 3072
  s_nop 0
  buffer_load_dwordx4 v25, s[56:59], s27 offen  lds
  s_add_u32 s27, s27, 7168
  s_add_u32 m0, s30, 4096
  s_nop 0
  buffer_load_dwordx4 v24, s[56:59], s27 offen  lds
  s_add_u32 s27, s27, 7168
  s_add_u32 m0, s30, 5120
  s_nop 0
  buffer_load_dwordx4 v25, s[56:59], s27 offen  lds
  s_add_u32 s27, s27, 7168
  s_add_u32 m0, s30, 6144
  s_nop 0
  buffer_load_dwordx4 v24, s[56:59], s27 offen  lds
  s_add_u32 s27, s27, 7168
  s_add_u32 m0, s30, 7168
  s_nop 0
  buffer_load_dwordx4 v25, s[56:59], s27 offen  lds
  s_add_u32 s27, s27, 7168
  s_add_u32 s27, s28, 0
  s_min_u32 s27, s27, 13
  s_lshl_b32 s27, s27, 18
  s_add_u32 s27, s27, s26
  s_mov_b32 s55, s27
  v_lshrrev_b32 v7, 2, v4
  v_lshlrev_b32 v11, 4, v7
  v_lshlrev_b32 v7, 3, v7
  v_and_b32 v8, 3, v4
  v_add_u32 v7, v7, v8
  v_and_b32 v8, 2, v4
  v_lshl_add_u32 v11, v8, 1, v11
  v_and_b32 v8, 1, v4
  v_add_u32 v11, v11, v8
  v_or_b32 v10, 0, v3
  v_xor_b32 v10, v10, v4
  v_lshlrev_b32 v10, 4, v10
  v_lshl_add_u32 v44, v11, 9, v10
  v_lshl_add_u32 v10, v7, 9, v10
  v_add_u32 v32, s25, v10
  v_or_b32 v10, 4, v3
  v_xor_b32 v10, v10, v4
  v_lshlrev_b32 v10, 4, v10
  v_lshl_add_u32 v45, v11, 9, v10
  v_lshl_add_u32 v10, v7, 9, v10
  v_add_u32 v33, s25, v10
  v_or_b32 v10, 8, v3
  v_xor_b32 v10, v10, v4
  v_lshlrev_b32 v10, 4, v10
  v_lshl_add_u32 v46, v11, 9, v10
  v_lshl_add_u32 v10, v7, 9, v10
  v_add_u32 v34, s25, v10
  v_or_b32 v10, 12, v3
  v_xor_b32 v10, v10, v4
  v_lshlrev_b32 v10, 4, v10
  v_lshl_add_u32 v47, v11, 9, v10
  v_lshl_add_u32 v10, v7, 9, v10
  v_add_u32 v35, s25, v10
  s_mul_i32 s30, s17, 401408
  s_mul_i32 s31, s18, 57344
  s_add_u32 s30, s30, s31
  s_add_u32 s30, s30, 33554432
  v_add_u32 v28, s30, v2
  s_add_u32 s30, s30, 14336
  v_add_u32 v29, s30, v2
  s_add_u32 s30, s30, 14336
  v_add_u32 v30, s30, v2
  s_add_u32 s30, s30, 14336
  v_add_u32 v31, s30, v2
  s_add_u32 s30, s30, 14336
  v_mov_b32 v48, 1035512379
  v_lshrrev_b32 v7, 2, v4
  v_lshl_add_u32 v7, v3, 3, v7
  v_lshlrev_b32 v7, 7, v7
  v_and_b32 v8, 3, v4
  v_lshl_add_u32 v7, v8, 3, v7
  v_lshrrev_b32 v8, 3, v4
  v_and_b32 v9, 1, v3
  v_lshl_add_u32 v8, v9, 1, v8
  v_lshl_add_u32 v40, v8, 5, v7
  s_mul_i32 s31, s17, 28
  s_mov_b32 s29, 401408
  s_lshl_b32 s30, s18, 6
  s_add_u32 s30, s30, 0
  v_add_u32 v8, s30, v4
  v_subrev_u32 v9, 256, v8
  v_mul_u32_u24 v11, 171, v9
  v_lshrrev_b32 v11, 11, v11
  v_mul_u32_u24 v38, 12, v11
  v_sub_u32 v38, v9, v38
  v_add_u32 v38, 16, v38
  v_lshrrev_b32 v10, 4, v8
  v_cmp_gt_i32 vcc, 0, v9
  s_nop 1
  v_cndmask_b32 v10, v11, v10, vcc
  v_cndmask_b32 v39, v38, v4, vcc
  v_add_u32 v39, s31, v39
  v_lshrrev_b32 v38, 4, v39
  v_and_b32 v39, 15, v39
  v_mul_lo_u32 v10, v10, s29
  v_mul_u32_u24 v38, 14336, v38
  v_add_u32 v10, v10, v38
  v_lshl_add_u32 v10, v3, 8, v10
  v_lshl_add_u32 v10, v39, 4, v10
  v_add_u32 v12, 39976960, v10
  v_xor_b32 v41, 32, v40
  s_lshl_b32 s30, s18, 6
  s_add_u32 s30, s30, 16
  v_add_u32 v8, s30, v4
  v_subrev_u32 v9, 256, v8
  v_mul_u32_u24 v11, 171, v9
  v_lshrrev_b32 v11, 11, v11
  v_mul_u32_u24 v38, 12, v11
  v_sub_u32 v38, v9, v38
  v_add_u32 v38, 16, v38
  v_lshrrev_b32 v10, 4, v8
  v_cmp_gt_i32 vcc, 0, v9
  s_nop 1
  v_cndmask_b32 v10, v11, v10, vcc
  v_cndmask_b32 v39, v38, v4, vcc
  v_add_u32 v39, s31, v39
  v_lshrrev_b32 v38, 4, v39
  v_and_b32 v39, 15, v39
  v_mul_lo_u32 v10, v10, s29
  v_mul_u32_u24 v38, 14336, v38
  v_add_u32 v10, v10, v38
  v_lshl_add_u32 v10, v3, 8, v10
  v_lshl_add_u32 v10, v39, 4, v10
  v_add_u32 v13, 39976960, v10
  v_xor_b32 v42, 64, v40
  s_lshl_b32 s30, s18, 6
  s_add_u32 s30, s30, 32
  v_add_u32 v8, s30, v4
  v_subrev_u32 v9, 256, v8
  v_mul_u32_u24 v11, 171, v9
  v_lshrrev_b32 v11, 11, v11
  v_mul_u32_u24 v38, 12, v11
  v_sub_u32 v38, v9, v38
  v_add_u32 v38, 16, v38
  v_lshrrev_b32 v10, 4, v8
  v_cmp_gt_i32 vcc, 0, v9
  s_nop 1
  v_cndmask_b32 v10, v11, v10, vcc
  v_cndmask_b32 v39, v38, v4, vcc
  v_add_u32 v39, s31, v39
  v_lshrrev_b32 v38, 4, v39
  v_and_b32 v39, 15, v39
  v_mul_lo_u32 v10, v10, s29
  v_mul_u32_u24 v38, 14336, v38
  v_add_u32 v10, v10, v38
  v_lshl_add_u32 v10, v3, 8, v10
  v_lshl_add_u32 v10, v39, 4, v10
  v_add_u32 v14, 39976960, v10
  v_xor_b32 v43, 96, v40
  s_lshl_b32 s30, s18, 6
  s_add_u32 s30, s30, 48
  v_add_u32 v8, s30, v4
  v_subrev_u32 v9, 256, v8
  v_mul_u32_u24 v11, 171, v9
  v_lshrrev_b32 v11, 11, v11
  v_mul_u32_u24 v38, 12, v11
  v_sub_u32 v38, v9, v38
  v_add_u32 v38, 16, v38
  v_lshrrev_b32 v10, 4, v8
  v_cmp_gt_i32 vcc, 0, v9
  s_nop 1
  v_cndmask_b32 v10, v11, v10, vcc
  v_cndmask_b32 v39, v38, v4, vcc
  v_add_u32 v39, s31, v39
  v_lshrrev_b32 v38, 4, v39
  v_and_b32 v39, 15, v39
  v_mul_lo_u32 v10, v10, s29
  v_mul_u32_u24 v38, 14336, v38
  v_add_u32 v10, v10, v38
  v_lshl_add_u32 v10, v3, 8, v10
  v_lshl_add_u32 v10, v39, 4, v10
  v_add_u32 v15, 39976960, v10
  s_mov_b32 s27, s55
  s_add_u32 m0, s25, 0
  s_nop 0
  buffer_load_dwordx4 v16, s[60:63], s27 offen  lds
  s_add_u32 s27, s27, 16384
  s_add_u32 m0, s25, 1024
  s_nop 0
  buffer_load_dwordx4 v17, s[60:63], s27 offen  lds
  s_add_u32 s27, s27, 16384
  s_add_u32 m0, s25, 2048
  s_nop 0
  buffer_load_dwordx4 v16, s[60:63], s27 offen  lds
  s_add_u32 s27, s27, 16384
  s_add_u32 m0, s25, 3072
  s_nop 0
  buffer_load_dwordx4 v17, s[60:63], s27 offen  lds
  s_add_u32 s27, s27, 16384
  s_add_u32 m0, s25, 4096
  s_nop 0
  buffer_load_dwordx4 v18, s[60:63], s27 offen  lds
  s_add_u32 s27, s27, 16384
  s_add_u32 m0, s25, 5120
  s_nop 0
  buffer_load_dwordx4 v19, s[60:63], s27 offen  lds
  s_add_u32 s27, s27, 16384
  s_add_u32 m0, s25, 6144
  s_nop 0
  buffer_load_dwordx4 v18, s[60:63], s27 offen  lds
  s_add_u32 s27, s27, 16384
  s_add_u32 m0, s25, 7168
  s_nop 0
  buffer_load_dwordx4 v19, s[60:63], s27 offen  lds
  s_add_u32 s27, s27, 16384
  s_add_u32 m0, s25, 8192
  s_nop 0
  buffer_load_dwordx4 v20, s[60:63], s27 offen  lds
  s_add_u32 s27, s27, 16384
  s_add_u32 m0, s25, 9216
  s_nop 0
  buffer_load_dwordx4 v21, s[60:63], s27 offen  lds
  s_add_u32 s27, s27, 16384
  s_add_u32 m0, s25, 10240
  s_nop 0
  buffer_load_dwordx4 v20, s[60:63], s27 offen  lds
  s_add_u32 s27, s27, 16384
  s_add_u32 m0, s25, 11264
  s_nop 0
  buffer_load_dwordx4 v21, s[60:63], s27 offen  lds
  s_add_u32 s27, s27, 16384
  s_add_u32 m0, s25, 12288
  s_nop 0
  buffer_load_dwordx4 v22, s[60:63], s27 offen  lds
  s_add_u32 s27, s27, 16384
  s_add_u32 m0, s25, 13312
  s_nop 0
  buffer_load_dwordx4 v23, s[60:63], s27 offen  lds
  s_add_u32 s27, s27, 16384
  s_add_u32 m0, s25, 14336
  s_nop 0
  buffer_load_dwordx4 v22, s[60:63], s27 offen  lds
  s_add_u32 s27, s27, 16384
  s_add_u32 m0, s25, 15360
  s_nop 0
  buffer_load_dwordx4 v23, s[60:63], s27 offen  lds
  s_add_u32 s27, s27, 16384
  s_add_u32 s27, s28, 4
  s_min_u32 s27, s27, 13
  s_lshl_b32 s27, s27, 18
  s_add_u32 s27, s27, s26
  s_add_u32 m0, s25, 16384
  s_nop 0
  buffer_load_dwordx4 v16, s[60:63], s27 offen  lds
  s_add_u32 s27, s27, 16384
  s_add_u32 m0, s25, 17408
  s_nop 0
  buffer_load_dwordx4 v17, s[60:63], s27 offen  lds
  s_add_u32 s27, s27, 16384
  s_add_u32 m0, s25, 18432
  s_nop 0
  buffer_load_dwordx4 v16, s[60:63], s27 offen  lds
  s_add_u32 s27, s27, 16384
  s_add_u32 m0, s25, 19456
  s_nop 0
  buffer_load_dwordx4 v17, s[60:63], s27 offen  lds
  s_add_u32 s27, s27, 16384
  s_add_u32 m0, s25, 20480
  s_nop 0
  buffer_load_dwordx4 v18, s[60:63], s27 offen  lds
  s_add_u32 s27, s27, 16384
  s_add_u32 m0, s25, 21504
  s_nop 0
  buffer_load_dwordx4 v19, s[60:63], s27 offen  lds
  s_add_u32 s27, s27, 16384
  s_add_u32 m0, s25, 22528
  s_nop 0
  buffer_load_dwordx4 v18, s[60:63], s27 offen  lds
  s_add_u32 s27, s27, 16384
  s_add_u32 m0, s25, 23552
  s_nop 0
  buffer_load_dwordx4 v19, s[60:63], s27 offen  lds
  s_add_u32 s27, s27, 16384
  s_add_u32 m0, s25, 24576
  s_nop 0
  buffer_load_dwordx4 v20, s[60:63], s27 offen  lds
  s_add_u32 s27, s27, 16384
  s_add_u32 m0, s25, 25600
  s_nop 0
  buffer_load_dwordx4 v21, s[60:63], s27 offen  lds
  s_add_u32 s27, s27, 16384
  s_add_u32 m0, s25, 26624
  s_nop 0
  buffer_load_dwordx4 v20, s[60:63], s27 offen  lds
  s_add_u32 s27, s27, 16384
  s_add_u32 m0, s25, 27648
  s_nop 0
  buffer_load_dwordx4 v21, s[60:63], s27 offen  lds
  s_add_u32 s27, s27, 16384
  s_add_u32 m0, s25, 28672
  s_nop 0
  buffer_load_dwordx4 v22, s[60:63], s27 offen  lds
  s_add_u32 s27, s27, 16384
  s_add_u32 m0, s25, 29696
  s_nop 0
  buffer_load_dwordx4 v23, s[60:63], s27 offen  lds
  s_add_u32 s27, s27, 16384
  s_add_u32 m0, s25, 30720
  s_nop 0
  buffer_load_dwordx4 v22, s[60:63], s27 offen  lds
  s_add_u32 s27, s27, 16384
  s_add_u32 m0, s25, 31744
  s_nop 0
  buffer_load_dwordx4 v23, s[60:63], s27 offen  lds
  s_add_u32 s27, s27, 16384
  s_cmp_lt_u32 s18, 4
  s_cselect_b32 s34, 1, s97
  s_mov_b32 s68, s42
  s_and_b32 s69, s43, 0xffff
  s_mov_b32 s70, 3670016
  s_mov_b32 s71, 0x20000
  s_lshl_b32 s27, s18, 19
  s_add_u32 s27, s27, s26
  s_cmp_lg_u32 s34, 0
  s_cselect_b32 s27, 0x40000000, s27
  v_lshrrev_b32 v7, 2, v0
  v_and_b32 v8, 3, v0
  v_lshlrev_b32 v8, 7, v8
  v_lshl_add_u32 v9, v7, 13, v8
  buffer_load_dword v253, v9, s[68:71], s27 offen
  s_lshl_b32 s29, s28, 10
  s_add_u32 s31, s29, 4096
  s_cmp_lt_u32 s28, 10
  s_cselect_b32 s31, s31, 0x40000000
  s_waitcnt vmcnt(1)
  s_barrier
  ds_read_b64_tr_b16 a[0:1], v40 offset:0
  ds_read_b64_tr_b16 a[2:3], v40 offset:512
  ds_read_b64_tr_b16 a[32:33], v41 offset:0
  ds_read_b64_tr_b16 a[34:35], v41 offset:512
  ds_read_b64_tr_b16 a[64:65], v42 offset:0
  ds_read_b64_tr_b16 a[66:67], v42 offset:512
  ds_read_b64_tr_b16 a[96:97], v43 offset:0
  ds_read_b64_tr_b16 a[98:99], v43 offset:512
  ds_read_b128 a[128:131], v32 offset:0
  ds_read_b128 a[160:163], v32 offset:2048
  ds_read_b128 a[192:195], v32 offset:16384
  ds_read_b128 a[224:227], v32 offset:18432
  v_lshlrev_b32 v144, 9, v3
  v_lshl_add_u32 v144, v4, 4, v144
  s_add_u32 s53, s52, 75759616
  s_add_u32 s52, s52, 655360
  v_mov_b32 v136, v128
  v_mov_b32 v140, v129
  v_mov_b32 v137, v130
  v_mov_b32 v141, v131
  v_mov_b32 v138, v132
  v_mov_b32 v142, v133
  v_mov_b32 v139, v134
  v_mov_b32 v143, v135
  buffer_store_dwordx4 v[128:131], v144, s[8:11], s52 offen sc1
  buffer_store_dwordx4 v[132:135], v144, s[8:11], s52 offen offset:256 sc1
  buffer_store_dwordx4 v[136:139], v2, s[8:11], s53 offen sc1
  buffer_store_dwordx4 v[140:143], v2, s[8:11], s53 offen offset:1024 sc1
  s_waitcnt lgkmcnt(0)
  v_mfma_f32_16x16x32_bf16 v[64:67], a[128:131], a[0:3], 0
  ds_read_b64_tr_b16 a[4:5], v40 offset:4096
  ds_read_b64_tr_b16 a[6:7], v40 offset:4608
  v_mfma_f32_16x16x32_bf16 v[68:71], a[160:163], a[0:3], 0
  ds_read_b64_tr_b16 a[36:37], v41 offset:4096
  ds_read_b64_tr_b16 a[38:39], v41 offset:4608
  v_mfma_f32_16x16x32_bf16 v[72:75], a[128:131], a[32:35], 0
  ds_read_b64_tr_b16 a[68:69], v42 offset:4096
  ds_read_b64_tr_b16 a[70:71], v42 offset:4608
  v_mfma_f32_16x16x32_bf16 v[76:79], a[160:163], a[32:35], 0
  ds_read_b64_tr_b16 a[100:101], v43 offset:4096
  ds_read_b64_tr_b16 a[102:103], v43 offset:4608
  v_mfma_f32_16x16x32_bf16 v[80:83], a[128:131], a[64:67], 0
  ds_read_b128 a[132:135], v33 offset:0
  ds_read_b128 a[164:167], v33 offset:2048
  v_mfma_f32_16x16x32_bf16 v[84:87], a[160:163], a[64:67], 0
  ds_read_b128 a[196:199], v33 offset:16384
  ds_read_b128 a[228:231], v33 offset:18432
  v_mfma_f32_16x16x32_bf16 v[88:91], a[128:131], a[96:99], 0
  v_mfma_f32_16x16x32_bf16 v[92:95], a[160:163], a[96:99], 0
  v_mfma_f32_16x16x32_bf16 v[96:99], a[192:195], a[0:3], 0
  v_mfma_f32_16x16x32_bf16 v[100:103], a[224:227], a[0:3], 0
  v_mfma_f32_16x16x32_bf16 v[104:107], a[192:195], a[32:35], 0
  v_mfma_f32_16x16x32_bf16 v[108:111], a[224:227], a[32:35], 0
  v_mfma_f32_16x16x32_bf16 v[112:115], a[192:195], a[64:67], 0
  v_mfma_f32_16x16x32_bf16 v[116:119], a[224:227], a[64:67], 0
  v_mfma_f32_16x16x32_bf16 v[120:123], a[192:195], a[96:99], 0
  v_mfma_f32_16x16x32_bf16 v[124:127], a[224:227], a[96:99], 0
  s_waitcnt lgkmcnt(0)
  v_mfma_f32_16x16x32_bf16 v[64:67], a[132:135], a[4:7], v[64:67]
  ds_read_b64_tr_b16 a[8:9], v40 offset:8192
  ds_read_b64_tr_b16 a[10:11], v40 offset:8704
  v_mfma_f32_16x16x32_bf16 v[68:71], a[164:167], a[4:7], v[68:71]
  ds_read_b64_tr_b16 a[40:41], v41 offset:8192
  ds_read_b64_tr_b16 a[42:43], v41 offset:8704
  v_mfma_f32_16x16x32_bf16 v[72:75], a[132:135], a[36:39], v[72:75]
  ds_read_b64_tr_b16 a[72:73], v42 offset:8192
  ds_read_b64_tr_b16 a[74:75], v42 offset:8704
  v_mfma_f32_16x16x32_bf16 v[76:79], a[164:167], a[36:39], v[76:79]
  ds_read_b64_tr_b16 a[104:105], v43 offset:8192
  ds_read_b64_tr_b16 a[106:107], v43 offset:8704
  v_mfma_f32_16x16x32_bf16 v[80:83], a[132:135], a[68:71], v[80:83]
  ds_read_b128 a[136:139], v34 offset:0
  ds_read_b128 a[168:171], v34 offset:2048
  v_mfma_f32_16x16x32_bf16 v[84:87], a[164:167], a[68:71], v[84:87]
  ds_read_b128 a[200:203], v34 offset:16384
  ds_read_b128 a[232:235], v34 offset:18432
  v_mfma_f32_16x16x32_bf16 v[88:91], a[132:135], a[100:103], v[88:91]
  v_mfma_f32_16x16x32_bf16 v[92:95], a[164:167], a[100:103], v[92:95]
  v_mfma_f32_16x16x32_bf16 v[96:99], a[196:199], a[4:7], v[96:99]
  v_mfma_f32_16x16x32_bf16 v[100:103], a[228:231], a[4:7], v[100:103]
  v_mfma_f32_16x16x32_bf16 v[104:107], a[196:199], a[36:39], v[104:107]
  v_mfma_f32_16x16x32_bf16 v[108:111], a[228:231], a[36:39], v[108:111]
  v_mfma_f32_16x16x32_bf16 v[112:115], a[196:199], a[68:71], v[112:115]
  v_mfma_f32_16x16x32_bf16 v[116:119], a[228:231], a[68:71], v[116:119]
  v_mfma_f32_16x16x32_bf16 v[120:123], a[196:199], a[100:103], v[120:123]
  v_mfma_f32_16x16x32_bf16 v[124:127], a[228:231], a[100:103], v[124:127]
  s_waitcnt lgkmcnt(0)
  v_mfma_f32_16x16x32_bf16 v[64:67], a[136:139], a[8:11], v[64:67]
  ds_read_b64_tr_b16 a[12:13], v40 offset:12288
  ds_read_b64_tr_b16 a[14:15], v40 offset:12800
  v_mfma_f32_16x16x32_bf16 v[68:71], a[168:171], a[8:11], v[68:71]
  ds_read_b64_tr_b16 a[44:45], v41 offset:12288
  ds_read_b64_tr_b16 a[46:47], v41 offset:12800
  v_mfma_f32_16x16x32_bf16 v[72:75], a[136:139], a[40:43], v[72:75]
  ds_read_b64_tr_b16 a[76:77], v42 offset:12288
  ds_read_b64_tr_b16 a[78:79], v42 offset:12800
  v_mfma_f32_16x16x32_bf16 v[76:79], a[168:171], a[40:43], v[76:79]
  ds_read_b64_tr_b16 a[108:109], v43 offset:12288
  ds_read_b64_tr_b16 a[110:111], v43 offset:12800
  v_mfma_f32_16x16x32_bf16 v[80:83], a[136:139], a[72:75], v[80:83]
  ds_read_b128 a[140:143], v35 offset:0
  ds_read_b128 a[172:175], v35 offset:2048
  v_mfma_f32_16x16x32_bf16 v[84:87], a[168:171], a[72:75], v[84:87]
  ds_read_b128 a[204:207], v35 offset:16384
  ds_read_b128 a[236:239], v35 offset:18432
  v_mfma_f32_16x16x32_bf16 v[88:91], a[136:139], a[104:107], v[88:91]
  v_mfma_f32_16x16x32_bf16 v[92:95], a[168:171], a[104:107], v[92:95]
  v_mfma_f32_16x16x32_bf16 v[96:99], a[200:203], a[8:11], v[96:99]
  v_mfma_f32_16x16x32_bf16 v[100:103], a[232:235], a[8:11], v[100:103]
  v_mfma_f32_16x16x32_bf16 v[104:107], a[200:203], a[40:43], v[104:107]
  v_mfma_f32_16x16x32_bf16 v[108:111], a[232:235], a[40:43], v[108:111]
  v_mfma_f32_16x16x32_bf16 v[112:115], a[200:203], a[72:75], v[112:115]
  v_mfma_f32_16x16x32_bf16 v[116:119], a[232:235], a[72:75], v[116:119]
  v_mfma_f32_16x16x32_bf16 v[120:123], a[200:203], a[104:107], v[120:123]
  v_mfma_f32_16x16x32_bf16 v[124:127], a[232:235], a[104:107], v[124:127]
  s_waitcnt lgkmcnt(0)
  v_mfma_f32_16x16x32_bf16 v[64:67], a[140:143], a[12:15], v[64:67]
  ds_read_b64_tr_b16 a[16:17], v40 offset:16384
  ds_read_b64_tr_b16 a[18:19], v40 offset:16896
  v_mfma_f32_16x16x32_bf16 v[68:71], a[172:175], a[12:15], v[68:71]
  ds_read_b64_tr_b16 a[48:49], v41 offset:16384
  ds_read_b64_tr_b16 a[50:51], v41 offset:16896
  v_mfma_f32_16x16x32_bf16 v[72:75], a[140:143], a[44:47], v[72:75]
  ds_read_b64_tr_b16 a[80:81], v42 offset:16384
  ds_read_b64_tr_b16 a[82:83], v42 offset:16896
  v_mfma_f32_16x16x32_bf16 v[76:79], a[172:175], a[44:47], v[76:79]
  ds_read_b64_tr_b16 a[112:113], v43 offset:16384
  ds_read_b64_tr_b16 a[114:115], v43 offset:16896
  v_mfma_f32_16x16x32_bf16 v[80:83], a[140:143], a[76:79], v[80:83]
  ds_read_b128 a[144:147], v32 offset:256
  ds_read_b128 a[176:179], v32 offset:2304
  v_mfma_f32_16x16x32_bf16 v[84:87], a[172:175], a[76:79], v[84:87]
  ds_read_b128 a[208:211], v32 offset:16640
  ds_read_b128 a[240:243], v32 offset:18688
  v_mfma_f32_16x16x32_bf16 v[88:91], a[140:143], a[108:111], v[88:91]
  v_mfma_f32_16x16x32_bf16 v[92:95], a[172:175], a[108:111], v[92:95]
  v_mfma_f32_16x16x32_bf16 v[96:99], a[204:207], a[12:15], v[96:99]
  v_mfma_f32_16x16x32_bf16 v[100:103], a[236:239], a[12:15], v[100:103]
  v_mfma_f32_16x16x32_bf16 v[104:107], a[204:207], a[44:47], v[104:107]
  v_mfma_f32_16x16x32_bf16 v[108:111], a[236:239], a[44:47], v[108:111]
  v_mfma_f32_16x16x32_bf16 v[112:115], a[204:207], a[76:79], v[112:115]
  v_mfma_f32_16x16x32_bf16 v[116:119], a[236:239], a[76:79], v[116:119]
  v_mfma_f32_16x16x32_bf16 v[120:123], a[204:207], a[108:111], v[120:123]
  v_mfma_f32_16x16x32_bf16 v[124:127], a[236:239], a[108:111], v[124:127]
  s_waitcnt lgkmcnt(0)
  v_mfma_f32_16x16x32_bf16 v[64:67], a[144:147], a[16:19], v[64:67]
  ds_read_b64_tr_b16 a[20:21], v40 offset:20480
  ds_read_b64_tr_b16 a[22:23], v40 offset:20992
  v_mfma_f32_16x16x32_bf16 v[68:71], a[176:179], a[16:19], v[68:71]
  ds_read_b64_tr_b16 a[52:53], v41 offset:20480
  ds_read_b64_tr_b16 a[54:55], v41 offset:20992
  v_mfma_f32_16x16x32_bf16 v[72:75], a[144:147], a[48:51], v[72:75]
  ds_read_b64_tr_b16 a[84:85], v42 offset:20480
  ds_read_b64_tr_b16 a[86:87], v42 offset:20992
  v_mfma_f32_16x16x32_bf16 v[76:79], a[176:179], a[48:51], v[76:79]
  ds_read_b64_tr_b16 a[116:117], v43 offset:20480
  ds_read_b64_tr_b16 a[118:119], v43 offset:20992
  v_mfma_f32_16x16x32_bf16 v[80:83], a[144:147], a[80:83], v[80:83]
  ds_read_b128 a[148:151], v33 offset:256
  ds_read_b128 a[180:183], v33 offset:2304
  v_mfma_f32_16x16x32_bf16 v[84:87], a[176:179], a[80:83], v[84:87]
  ds_read_b128 a[212:215], v33 offset:16640
  ds_read_b128 a[244:247], v33 offset:18688
  v_mfma_f32_16x16x32_bf16 v[88:91], a[144:147], a[112:115], v[88:91]
  v_mfma_f32_16x16x32_bf16 v[92:95], a[176:179], a[112:115], v[92:95]
  v_mfma_f32_16x16x32_bf16 v[96:99], a[208:211], a[16:19], v[96:99]
  v_mfma_f32_16x16x32_bf16 v[100:103], a[240:243], a[16:19], v[100:103]
  v_mfma_f32_16x16x32_bf16 v[104:107], a[208:211], a[48:51], v[104:107]
  v_mfma_f32_16x16x32_bf16 v[108:111], a[240:243], a[48:51], v[108:111]
  v_mfma_f32_16x16x32_bf16 v[112:115], a[208:211], a[80:83], v[112:115]
  v_mfma_f32_16x16x32_bf16 v[116:119], a[240:243], a[80:83], v[116:119]
  v_mfma_f32_16x16x32_bf16 v[120:123], a[208:211], a[112:115], v[120:123]
  v_mfma_f32_16x16x32_bf16 v[124:127], a[240:243], a[112:115], v[124:127]
  s_waitcnt lgkmcnt(0)
  v_mfma_f32_16x16x32_bf16 v[64:67], a[148:151], a[20:23], v[64:67]
  ds_read_b64_tr_b16 a[24:25], v40 offset:24576
  ds_read_b64_tr_b16 a[26:27], v40 offset:25088
  v_mfma_f32_16x16x32_bf16 v[68:71], a[180:183], a[20:23], v[68:71]
  ds_read_b64_tr_b16 a[56:57], v41 offset:24576
  ds_read_b64_tr_b16 a[58:59], v41 offset:25088
  v_mfma_f32_16x16x32_bf16 v[72:75], a[148:151], a[52:55], v[72:75]
  ds_read_b64_tr_b16 a[88:89], v42 offset:24576
  ds_read_b64_tr_b16 a[90:91], v42 offset:25088
  v_mfma_f32_16x16x32_bf16 v[76:79], a[180:183], a[52:55], v[76:79]
  ds_read_b64_tr_b16 a[120:121], v43 offset:24576
  ds_read_b64_tr_b16 a[122:123], v43 offset:25088
  v_mfma_f32_16x16x32_bf16 v[80:83], a[148:151], a[84:87], v[80:83]
  ds_read_b128 a[152:155], v34 offset:256
  ds_read_b128 a[184:187], v34 offset:2304
  v_mfma_f32_16x16x32_bf16 v[84:87], a[180:183], a[84:87], v[84:87]
  ds_read_b128 a[216:219], v34 offset:16640
  ds_read_b128 a[248:251], v34 offset:18688
  v_mfma_f32_16x16x32_bf16 v[88:91], a[148:151], a[116:119], v[88:91]
  v_mfma_f32_16x16x32_bf16 v[92:95], a[180:183], a[116:119], v[92:95]
  v_mfma_f32_16x16x32_bf16 v[96:99], a[212:215], a[20:23], v[96:99]
  v_mfma_f32_16x16x32_bf16 v[100:103], a[244:247], a[20:23], v[100:103]
  v_mfma_f32_16x16x32_bf16 v[104:107], a[212:215], a[52:55], v[104:107]
  v_mfma_f32_16x16x32_bf16 v[108:111], a[244:247], a[52:55], v[108:111]
  v_mfma_f32_16x16x32_bf16 v[112:115], a[212:215], a[84:87], v[112:115]
  v_mfma_f32_16x16x32_bf16 v[116:119], a[244:247], a[84:87], v[116:119]
  v_mfma_f32_16x16x32_bf16 v[120:123], a[212:215], a[116:119], v[120:123]
  v_mfma_f32_16x16x32_bf16 v[124:127], a[244:247], a[116:119], v[124:127]
  s_waitcnt lgkmcnt(0)
  v_mfma_f32_16x16x32_bf16 v[64:67], a[152:155], a[24:27], v[64:67]
  ds_read_b64_tr_b16 a[28:29], v40 offset:28672
  ds_read_b64_tr_b16 a[30:31], v40 offset:29184
  v_mfma_f32_16x16x32_bf16 v[68:71], a[184:187], a[24:27], v[68:71]
  ds_read_b64_tr_b16 a[60:61], v41 offset:28672
  ds_read_b64_tr_b16 a[62:63], v41 offset:29184
  v_mfma_f32_16x16x32_bf16 v[72:75], a[152:155], a[56:59], v[72:75]
  ds_read_b64_tr_b16 a[92:93], v42 offset:28672
  ds_read_b64_tr_b16 a[94:95], v42 offset:29184
  v_mfma_f32_16x16x32_bf16 v[76:79], a[184:187], a[56:59], v[76:79]
  ds_read_b64_tr_b16 a[124:125], v43 offset:28672
  ds_read_b64_tr_b16 a[126:127], v43 offset:29184
  v_mfma_f32_16x16x32_bf16 v[80:83], a[152:155], a[88:91], v[80:83]
  ds_read_b128 a[156:159], v35 offset:256
  ds_read_b128 a[188:191], v35 offset:2304
  v_mfma_f32_16x16x32_bf16 v[84:87], a[184:187], a[88:91], v[84:87]
  ds_read_b128 a[220:223], v35 offset:16640
  ds_read_b128 a[252:255], v35 offset:18688
  v_mfma_f32_16x16x32_bf16 v[88:91], a[152:155], a[120:123], v[88:91]
  v_mfma_f32_16x16x32_bf16 v[92:95], a[184:187], a[120:123], v[92:95]
  v_mfma_f32_16x16x32_bf16 v[96:99], a[216:219], a[24:27], v[96:99]
  v_mfma_f32_16x16x32_bf16 v[100:103], a[248:251], a[24:27], v[100:103]
  v_mfma_f32_16x16x32_bf16 v[104:107], a[216:219], a[56:59], v[104:107]
  v_mfma_f32_16x16x32_bf16 v[108:111], a[248:251], a[56:59], v[108:111]
  v_mfma_f32_16x16x32_bf16 v[112:115], a[216:219], a[88:91], v[112:115]
  v_mfma_f32_16x16x32_bf16 v[116:119], a[248:251], a[88:91], v[116:119]
  v_mfma_f32_16x16x32_bf16 v[120:123], a[216:219], a[120:123], v[120:123]
  v_mfma_f32_16x16x32_bf16 v[124:127], a[248:251], a[120:123], v[124:127]
  s_waitcnt lgkmcnt(0)
  s_barrier
  buffer_load_dwordx2 v[254:255], v252, s[12:15], 0 offen offset:128 sc1
  buffer_load_dword v253, v252, s[12:15], 0 offen sc1
  v_mfma_f32_16x16x32_bf16 v[64:67], a[156:159], a[28:31], v[64:67]
  v_mfma_f32_16x16x32_bf16 v[68:71], a[188:191], a[28:31], v[68:71]
  v_mfma_f32_16x16x32_bf16 v[72:75], a[156:159], a[60:63], v[72:75]
  v_mfma_f32_16x16x32_bf16 v[76:79], a[188:191], a[60:63], v[76:79]
  v_mfma_f32_16x16x32_bf16 v[80:83], a[156:159], a[92:95], v[80:83]
  v_cvt_pk_bf16_f32 v64, v64, v65
  v_cvt_pk_bf16_f32 v65, v66, v67
  v_mfma_f32_16x16x32_bf16 v[84:87], a[188:191], a[92:95], v[84:87]
  v_cvt_pk_bf16_f32 v66, v68, v69
  v_cvt_pk_bf16_f32 v67, v70, v71
  v_mfma_f32_16x16x32_bf16 v[88:91], a[156:159], a[124:127], v[88:91]
  buffer_store_dwordx4 v[64:67], v12, s[8:11], s29 offen sc1
  v_cvt_pk_bf16_f32 v72, v72, v73
  v_mfma_f32_16x16x32_bf16 v[92:95], a[188:191], a[124:127], v[92:95]
  v_cvt_pk_bf16_f32 v73, v74, v75
  v_cvt_pk_bf16_f32 v74, v76, v77
  v_mfma_f32_16x16x32_bf16 v[96:99], a[220:223], a[28:31], v[96:99]
  v_cvt_pk_bf16_f32 v75, v78, v79
  buffer_store_dwordx4 v[72:75], v13, s[8:11], s29 offen sc1
  v_mfma_f32_16x16x32_bf16 v[100:103], a[252:255], a[28:31], v[100:103]
  v_cvt_pk_bf16_f32 v80, v80, v81
  v_cvt_pk_bf16_f32 v81, v82, v83
  v_mfma_f32_16x16x32_bf16 v[104:107], a[220:223], a[60:63], v[104:107]
  v_cvt_pk_bf16_f32 v82, v84, v85
  v_cvt_pk_bf16_f32 v83, v86, v87
  v_mfma_f32_16x16x32_bf16 v[108:111], a[252:255], a[60:63], v[108:111]
  buffer_store_dwordx4 v[80:83], v14, s[8:11], s29 offen sc1
  v_cvt_pk_bf16_f32 v88, v88, v89
  v_mfma_f32_16x16x32_bf16 v[112:115], a[220:223], a[92:95], v[112:115]
  v_cvt_pk_bf16_f32 v89, v90, v91
  v_cvt_pk_bf16_f32 v90, v92, v93
  v_mfma_f32_16x16x32_bf16 v[116:119], a[252:255], a[92:95], v[116:119]
  v_cvt_pk_bf16_f32 v91, v94, v95
  buffer_store_dwordx4 v[88:91], v15, s[8:11], s29 offen sc1
  v_mfma_f32_16x16x32_bf16 v[120:123], a[220:223], a[124:127], v[120:123]
  v_cvt_pk_bf16_f32 v96, v96, v97
  v_cvt_pk_bf16_f32 v97, v98, v99
  v_mfma_f32_16x16x32_bf16 v[124:127], a[252:255], a[124:127], v[124:127]
  v_cvt_pk_bf16_f32 v98, v100, v101
  v_cvt_pk_bf16_f32 v99, v102, v103
  buffer_store_dwordx4 v[96:99], v12, s[8:11], s31 offen sc1
  v_cvt_pk_bf16_f32 v104, v104, v105
  v_cvt_pk_bf16_f32 v105, v106, v107
  v_cvt_pk_bf16_f32 v106, v108, v109
  v_cvt_pk_bf16_f32 v107, v110, v111
  buffer_store_dwordx4 v[104:107], v13, s[8:11], s31 offen sc1
  v_cvt_pk_bf16_f32 v112, v112, v113
  v_cvt_pk_bf16_f32 v113, v114, v115
  v_cvt_pk_bf16_f32 v114, v116, v117
  v_cvt_pk_bf16_f32 v115, v118, v119
  buffer_store_dwordx4 v[112:115], v14, s[8:11], s31 offen sc1
  v_cvt_pk_bf16_f32 v120, v120, v121
  v_cvt_pk_bf16_f32 v121, v122, v123
  v_cvt_pk_bf16_f32 v122, v124, v125
  v_cvt_pk_bf16_f32 v123, v126, v127
  buffer_store_dwordx4 v[120:123], v15, s[8:11], s31 offen sc1
  s_cmp_lg_u32 s34, 0
  s_cbranch_scc1 wp_B2
  s_mov_b32 s60, s40
  s_and_b32 s61, s41, 0xffff
  s_mov_b32 s62, 3670016
  s_mov_b32 s63, 0x20000
  s_mov_b32 s56, s42
  s_and_b32 s57, s43, 0xffff
  s_mov_b32 s58, 3670016
  s_mov_b32 s59, 0x20000
  s_lshl_b32 s27, s18, 2
  s_add_u32 s27, s27, s16
  s_lshl_b32 s27, s27, 17
  s_add_u32 s27, s27, s26
  s_lshl_b32 s30, s16, 13
  s_add_u32 m0, s30, 0
  s_nop 0
  buffer_load_dwordx4 v26, s[56:59], s27 offen  lds
  s_add_u32 s27, s27, 16384
  s_add_u32 m0, s30, 1024
  s_nop 0
  buffer_load_dwordx4 v26, s[56:59], s27 offen  lds
  s_add_u32 s27, s27, 16384
  s_add_u32 m0, s30, 2048
  s_nop 0
  buffer_load_dwordx4 v27, s[56:59], s27 offen  lds
  s_add_u32 s27, s27, 16384
  s_add_u32 m0, s30, 3072
  s_nop 0
  buffer_load_dwordx4 v27, s[56:59], s27 offen  lds
  s_add_u32 s27, s27, 16384
  s_add_u32 m0, s30, 4096
  s_nop 0
  buffer_load_dwordx4 v26, s[56:59], s27 offen  lds
  s_add_u32 s27, s27, 16384
  s_add_u32 m0, s30, 5120
  s_nop 0
  buffer_load_dwordx4 v26, s[56:59], s27 offen  lds
  s_add_u32 s27, s27, 16384
  s_add_u32 m0, s30, 6144
  s_nop 0
  buffer_load_dwordx4 v27, s[56:59], s27 offen  lds
  s_add_u32 s27, s27, 16384
  s_add_u32 m0, s30, 7168
  s_nop 0
  buffer_load_dwordx4 v27, s[56:59], s27 offen  lds
  s_add_u32 s27, s27, 16384
  s_add_u32 s27, s28, 0
  s_min_u32 s27, s27, 13
  s_lshl_b32 s27, s27, 18
  s_add_u32 s27, s27, s26
  s_add_u32 m0, s25, 0
  s_nop 0
  buffer_load_dwordx4 v16, s[60:63], s27 offen  lds
  s_add_u32 s27, s27, 16384
  s_add_u32 m0, s25, 1024
  s_nop 0
  buffer_load_dwordx4 v17, s[60:63], s27 offen  lds
  s_add_u32 s27, s27, 16384
  s_add_u32 m0, s25, 2048
  s_nop 0
  buffer_load_dwordx4 v16, s[60:63], s27 offen  lds
  s_add_u32 s27, s27, 16384
  s_add_u32 m0, s25, 3072
  s_nop 0
  buffer_load_dwordx4 v17, s[60:63], s27 offen  lds
  s_add_u32 s27, s27, 16384
  s_waitcnt vmcnt(12)
  s_barrier
  s_cmp_lg_u32 s16, 0
  s_cbranch_scc1 wp_f1_f
  v_readfirstlane_b32 s20, v254
  s_cmp_eq_u32 s20, 1
  s_cbranch_scc1 wp_f1_w_ok
  s_mov_b32 s30, 0
wp_f1_w:
  buffer_load_dword v254, off, s[12:15], 0 offset:128 sc1
  s_waitcnt vmcnt(0)
  v_cmp_ne_u32 vcc, 1, v254
  s_cbranch_vccz wp_f1_w_ok
  s_sleep 8
  s_add_u32 s30, s30, 1
  s_cmp_lt_u32 s30, 16
  s_cbranch_scc1 wp_f1_w
  s_branch wp_f1_f
wp_f1_w_ok:
  s_lshl_b32 s20, s17, 7
  s_add_u32 s20, s20, 582144
  s_lshl_b32 s21, 1, s19
  v_mov_b32 v248, s21
  s_mov_b64 exec, 1
  buffer_atomic_or v248, v252, s[8:11], s20 offen sc0
  s_mov_b64 exec, -1
  s_mov_b32 s37, s21
wp_f1_f:
  s_add_u32 m0, s25, 4096
  s_nop 0
  buffer_load_dwordx4 v18, s[60:63], s27 offen  lds
  s_add_u32 s27, s27, 16384
  s_add_u32 m0, s25, 5120
  s_nop 0
  buffer_load_dwordx4 v19, s[60:63], s27 offen  lds
  s_add_u32 s27, s27, 16384
  s_add_u32 m0, s25, 6144
  s_nop 0
  buffer_load_dwordx4 v18, s[60:63], s27 offen  lds
  s_add_u32 s27, s27, 16384
  s_add_u32 m0, s25, 7168
  s_nop 0
  buffer_load_dwordx4 v19, s[60:63], s27 offen  lds
  s_add_u32 s27, s27, 16384
  s_add_u32 m0, s25, 8192
  s_nop 0
  buffer_load_dwordx4 v20, s[60:63], s27 offen  lds
  s_add_u32 s27, s27, 16384
  s_add_u32 m0, s25, 9216
  s_nop 0
  buffer_load_dwordx4 v21, s[60:63], s27 offen  lds
  s_add_u32 s27, s27, 16384
  s_add_u32 m0, s25, 10240
  s_nop 0
  buffer_load_dwordx4 v20, s[60:63], s27 offen  lds
  s_add_u32 s27, s27, 16384
  s_add_u32 m0, s25, 11264
  s_nop 0
  buffer_load_dwordx4 v21, s[60:63], s27 offen  lds
  s_add_u32 s27, s27, 16384
  s_add_u32 m0, s25, 12288
  s_nop 0
  buffer_load_dwordx4 v22, s[60:63], s27 offen  lds
  s_add_u32 s27, s27, 16384
  s_add_u32 m0, s25, 13312
  s_nop 0
  buffer_load_dwordx4 v23, s[60:63], s27 offen  lds
  s_add_u32 s27, s27, 16384
  s_add_u32 m0, s25, 14336
  s_nop 0
  buffer_load_dwordx4 v22, s[60:63], s27 offen  lds
  s_add_u32 s27, s27, 16384
  s_add_u32 m0, s25, 15360
  s_nop 0
  buffer_load_dwordx4 v23, s[60:63], s27 offen  lds
  s_add_u32 s27, s27, 16384
  s_add_u32 s27, s28, 4
  s_min_u32 s27, s27, 13
  s_lshl_b32 s27, s27, 18
  s_add_u32 s27, s27, s26
  s_waitcnt vmcnt(12)
  v_readfirstlane_b32 s20, v248
  s_and_b32 s20, s20, 16383
  s_xor_b32 s20, s20, s37
  s_cmp_lg_u32 s20, 16383
  s_cselect_b32 s20, 0, s37
  s_mov_b32 s37, 0
  s_cmp_eq_u32 s20, 0
  s_cbranch_scc1 wp_g1
  s_lshl_b32 s21, 1, s17
  v_mov_b32 v248, s21
  s_mov_b32 s20, 586240
  v_lshlrev_b32 v247, 7, v0
  s_mov_b64 exec, 0xff
  buffer_atomic_or v248, v247, s[8:11], s20 offen
  s_mov_b64 exec, -1
wp_g1:
  s_add_u32 m0, s25, 16384
  s_nop 0
  buffer_load_dwordx4 v16, s[60:63], s27 offen  lds
  s_add_u32 s27, s27, 16384
  s_add_u32 m0, s25, 17408
  s_nop 0
  buffer_load_dwordx4 v17, s[60:63], s27 offen  lds
  s_add_u32 s27, s27, 16384
  s_add_u32 m0, s25, 18432
  s_nop 0
  buffer_load_dwordx4 v16, s[60:63], s27 offen  lds
  s_add_u32 s27, s27, 16384
  s_add_u32 m0, s25, 19456
  s_nop 0
  buffer_load_dwordx4 v17, s[60:63], s27 offen  lds
  s_add_u32 s27, s27, 16384
  s_add_u32 m0, s25, 20480
  s_nop 0
  buffer_load_dwordx4 v18, s[60:63], s27 offen  lds
  s_add_u32 s27, s27, 16384
  s_add_u32 m0, s25, 21504
  s_nop 0
  buffer_load_dwordx4 v19, s[60:63], s27 offen  lds
  s_add_u32 s27, s27, 16384
  s_add_u32 m0, s25, 22528
  s_nop 0
  buffer_load_dwordx4 v18, s[60:63], s27 offen  lds
  s_add_u32 s27, s27, 16384
  s_add_u32 m0, s25, 23552
  s_nop 0
  buffer_load_dwordx4 v19, s[60:63], s27 offen  lds
  s_add_u32 s27, s27, 16384
  s_add_u32 m0, s25, 24576
  s_nop 0
  buffer_load_dwordx4 v20, s[60:63], s27 offen  lds
  s_add_u32 s27, s27, 16384
  s_add_u32 m0, s25, 25600
  s_nop 0
  buffer_load_dwordx4 v21, s[60:63], s27 offen  lds
  s_add_u32 s27, s27, 16384
  s_add_u32 m0, s25, 26624
  s_nop 0
  buffer_load_dwordx4 v20, s[60:63], s27 offen  lds
  s_add_u32 s27, s27, 16384
  s_add_u32 m0, s25, 27648
  s_nop 0
  buffer_load_dwordx4 v21, s[60:63], s27 offen  lds
  s_add_u32 s27, s27, 16384
  s_add_u32 m0, s25, 28672
  s_nop 0
  buffer_load_dwordx4 v22, s[60:63], s27 offen  lds
  s_add_u32 s27, s27, 16384
  s_add_u32 m0, s25, 29696
  s_nop 0
  buffer_load_dwordx4 v23, s[60:63], s27 offen  lds
  s_add_u32 s27, s27, 16384
  s_add_u32 m0, s25, 30720
  s_nop 0
  buffer_load_dwordx4 v22, s[60:63], s27 offen  lds
  s_add_u32 s27, s27, 16384
  s_add_u32 m0, s25, 31744
  s_nop 0
  buffer_load_dwordx4 v23, s[60:63], s27 offen  lds
  s_add_u32 s27, s27, 16384
  s_branch wp_A
wp_B2:
  v_lshlrev_b32 v6, 7, v1
  s_getpc_b64 s[98:99]
ct_5:
  s_add_u32 s98, s98, wp_fin-ct_5
  s_addc_u32 s99, s99, 0
  global_load_dword v7, v6, s[98:99]
  s_getpc_b64 s[98:99]
ct_6:
  s_add_u32 s98, s98, wg_vo-ct_6
  s_addc_u32 s99, s99, 0
  global_load_dword v7, v6, s[98:99]
  s_waitcnt vmcnt(2)
  s_barrier
  s_cmp_lg_u32 s16, 0
  s_cbranch_scc1 wp_f2_f
  v_readfirstlane_b32 s20, v254
  s_cmp_eq_u32 s20, 1
  s_cbranch_scc1 wp_f2_w_ok
  s_mov_b32 s30, 0
wp_f2_w:
  buffer_load_dword v254, off, s[12:15], 0 offset:128 sc1
  s_waitcnt vmcnt(0)
  v_cmp_ne_u32 vcc, 1, v254
  s_cbranch_vccz wp_f2_w_ok
  s_sleep 8
  s_add_u32 s30, s30, 1
  s_cmp_lt_u32 s30, 16
  s_cbranch_scc1 wp_f2_w
  s_branch wp_f2_f
wp_f2_w_ok:
  s_lshl_b32 s20, s17, 7
  s_add_u32 s20, s20, 582144
  s_lshl_b32 s21, 1, s19
  v_mov_b32 v248, s21
  s_mov_b64 exec, 1
  buffer_atomic_or v248, v252, s[8:11], s20 offen sc0
  s_mov_b64 exec, -1
  s_mov_b32 s37, s21
wp_f2_f:
  s_cmp_eq_u32 s97, 0
  s_cselect_b32 s39, -1, s39
  s_branch wp_fin
wp_A0:
  s_mov_b32 s60, s40
  s_and_b32 s61, s41, 0xffff
  s_mov_b32 s62, 3670016
  s_mov_b32 s63, 0x20000
  s_mov_b32 s56, s42
  s_and_b32 s57, s43, 0xffff
  s_mov_b32 s58, 3670016
  s_mov_b32 s59, 0x20000
  s_lshl_b32 s27, s18, 2
  s_add_u32 s27, s27, s16
  s_lshl_b32 s27, s27, 17
  s_add_u32 s27, s27, s26
  s_lshl_b32 s30, s16, 13
  s_add_u32 m0, s30, 0
  s_nop 0
  buffer_load_dwordx4 v26, s[56:59], s27 offen  lds
  s_add_u32 s27, s27, 16384
  s_add_u32 m0, s30, 1024
  s_nop 0
  buffer_load_dwordx4 v26, s[56:59], s27 offen  lds
  s_add_u32 s27, s27, 16384
  s_add_u32 m0, s30, 2048
  s_nop 0
  buffer_load_dwordx4 v27, s[56:59], s27 offen  lds
  s_add_u32 s27, s27, 16384
  s_add_u32 m0, s30, 3072
  s_nop 0
  buffer_load_dwordx4 v27, s[56:59], s27 offen  lds
  s_add_u32 s27, s27, 16384
  s_add_u32 m0, s30, 4096
  s_nop 0
  buffer_load_dwordx4 v26, s[56:59], s27 offen  lds
  s_add_u32 s27, s27, 16384
  s_add_u32 m0, s30, 5120
  s_nop 0
  buffer_load_dwordx4 v26, s[56:59], s27 offen  lds
  s_add_u32 s27, s27, 16384
  s_add_u32 m0, s30, 6144
  s_nop 0
  buffer_load_dwordx4 v27, s[56:59], s27 offen  lds
  s_add_u32 s27, s27, 16384
  s_add_u32 m0, s30, 7168
  s_nop 0
  buffer_load_dwordx4 v27, s[56:59], s27 offen  lds
  s_add_u32 s27, s27, 16384
  s_add_u32 s27, s28, 0
  s_min_u32 s27, s27, 13
  s_lshl_b32 s27, s27, 18
  s_add_u32 s27, s27, s26
  s_add_u32 m0, s25, 0
  s_nop 0
  buffer_load_dwordx4 v16, s[60:63], s27 offen  lds
  s_add_u32 s27, s27, 16384
  s_add_u32 m0, s25, 1024
  s_nop 0
  buffer_load_dwordx4 v17, s[60:63], s27 offen  lds
  s_add_u32 s27, s27, 16384
  s_add_u32 m0, s25, 2048
  s_nop 0
  buffer_load_dwordx4 v16, s[60:63], s27 offen  lds
  s_add_u32 s27, s27, 16384
  s_add_u32 m0, s25, 3072
  s_nop 0
  buffer_load_dwordx4 v17, s[60:63], s27 offen  lds
  s_add_u32 s27, s27, 16384
  s_add_u32 m0, s25, 4096
  s_nop 0
  buffer_load_dwordx4 v18, s[60:63], s27 offen  lds
  s_add_u32 s27, s27, 16384
  s_add_u32 m0, s25, 5120
  s_nop 0
  buffer_load_dwordx4 v19, s[60:63], s27 offen  lds
  s_add_u32 s27, s27, 16384
  s_add_u32 m0, s25, 6144
  s_nop 0
  buffer_load_dwordx4 v18, s[60:63], s27 offen  lds
  s_add_u32 s27, s27, 16384
  s_add_u32 m0, s25, 7168
  s_nop 0
  buffer_load_dwordx4 v19, s[60:63], s27 offen  lds
  s_add_u32 s27, s27, 16384
  s_add_u32 m0, s25, 8192
  s_nop 0
  buffer_load_dwordx4 v20, s[60:63], s27 offen  lds
  s_add_u32 s27, s27, 16384
  s_add_u32 m0, s25, 9216
  s_nop 0
  buffer_load_dwordx4 v21, s[60:63], s27 offen  lds
  s_add_u32 s27, s27, 16384
  s_add_u32 m0, s25, 10240
  s_nop 0
  buffer_load_dwordx4 v20, s[60:63], s27 offen  lds
  s_add_u32 s27, s27, 16384
  s_add_u32 m0, s25, 11264
  s_nop 0
  buffer_load_dwordx4 v21, s[60:63], s27 offen  lds
  s_add_u32 s27, s27, 16384
  s_add_u32 m0, s25, 12288
  s_nop 0
  buffer_load_dwordx4 v22, s[60:63], s27 offen  lds
  s_add_u32 s27, s27, 16384
  s_add_u32 m0, s25, 13312
  s_nop 0
  buffer_load_dwordx4 v23, s[60:63], s27 offen  lds
  s_add_u32 s27, s27, 16384
  s_add_u32 m0, s25, 14336
  s_nop 0
  buffer_load_dwordx4 v22, s[60:63], s27 offen  lds
  s_add_u32 s27, s27, 16384
  s_add_u32 m0, s25, 15360
  s_nop 0
  buffer_load_dwordx4 v23, s[60:63], s27 offen  lds
  s_add_u32 s27, s27, 16384
  s_add_u32 s27, s28, 4
  s_min_u32 s27, s27, 13
  s_lshl_b32 s27, s27, 18
  s_add_u32 s27, s27, s26
  s_add_u32 m0, s25, 16384
  s_nop 0
  buffer_load_dwordx4 v16, s[60:63], s27 offen  lds
  s_add_u32 s27, s27, 16384
  s_add_u32 m0, s25, 17408
  s_nop 0
  buffer_load_dwordx4 v17, s[60:63], s27 offen  lds
  s_add_u32 s27, s27, 16384
  s_add_u32 m0, s25, 18432
  s_nop 0
  buffer_load_dwordx4 v16, s[60:63], s27 offen  lds
  s_add_u32 s27, s27, 16384
  s_add_u32 m0, s25, 19456
  s_nop 0
  buffer_load_dwordx4 v17, s[60:63], s27 offen  lds
  s_add_u32 s27, s27, 16384
  s_add_u32 m0, s25, 20480
  s_nop 0
  buffer_load_dwordx4 v18, s[60:63], s27 offen  lds
  s_add_u32 s27, s27, 16384
  s_add_u32 m0, s25, 21504
  s_nop 0
  buffer_load_dwordx4 v19, s[60:63], s27 offen  lds
  s_add_u32 s27, s27, 16384
  s_add_u32 m0, s25, 22528
  s_nop 0
  buffer_load_dwordx4 v18, s[60:63], s27 offen  lds
  s_add_u32 s27, s27, 16384
  s_add_u32 m0, s25, 23552
  s_nop 0
  buffer_load_dwordx4 v19, s[60:63], s27 offen  lds
  s_add_u32 s27, s27, 16384
  s_add_u32 m0, s25, 24576
  s_nop 0
  buffer_load_dwordx4 v20, s[60:63], s27 offen  lds
  s_add_u32 s27, s27, 16384
  s_add_u32 m0, s25, 25600
  s_nop 0
  buffer_load_dwordx4 v21, s[60:63], s27 offen  lds
  s_add_u32 s27, s27, 16384
  s_add_u32 m0, s25, 26624
  s_nop 0
  buffer_load_dwordx4 v20, s[60:63], s27 offen  lds
  s_add_u32 s27, s27, 16384
  s_add_u32 m0, s25, 27648
  s_nop 0
  buffer_load_dwordx4 v21, s[60:63], s27 offen  lds
  s_add_u32 s27, s27, 16384
  s_add_u32 m0, s25, 28672
  s_nop 0
  buffer_load_dwordx4 v22, s[60:63], s27 offen  lds
  s_add_u32 s27, s27, 16384
  s_add_u32 m0, s25, 29696
  s_nop 0
  buffer_load_dwordx4 v23, s[60:63], s27 offen  lds
  s_add_u32 s27, s27, 16384
  s_add_u32 m0, s25, 30720
  s_nop 0
  buffer_load_dwordx4 v22, s[60:63], s27 offen  lds
  s_add_u32 s27, s27, 16384
  s_add_u32 m0, s25, 31744
  s_nop 0
  buffer_load_dwordx4 v23, s[60:63], s27 offen  lds
  s_add_u32 s27, s27, 16384
  v_lshrrev_b32 v7, 2, v4
  v_lshlrev_b32 v11, 4, v7
  v_lshlrev_b32 v7, 3, v7
  v_and_b32 v8, 3, v4
  v_add_u32 v7, v7, v8
  v_and_b32 v8, 2, v4
  v_lshl_add_u32 v11, v8, 1, v11
  v_and_b32 v8, 1, v4
  v_add_u32 v11, v11, v8
  v_or_b32 v10, 0, v3
  v_xor_b32 v10, v10, v4
  v_lshlrev_b32 v10, 4, v10
  v_lshl_add_u32 v44, v11, 9, v10
  v_lshl_add_u32 v10, v7, 9, v10
  v_add_u32 v32, s25, v10
  v_or_b32 v10, 4, v3
  v_xor_b32 v10, v10, v4
  v_lshlrev_b32 v10, 4, v10
  v_lshl_add_u32 v45, v11, 9, v10
  v_lshl_add_u32 v10, v7, 9, v10
  v_add_u32 v33, s25, v10
  v_or_b32 v10, 8, v3
  v_xor_b32 v10, v10, v4
  v_lshlrev_b32 v10, 4, v10
  v_lshl_add_u32 v46, v11, 9, v10
  v_lshl_add_u32 v10, v7, 9, v10
  v_add_u32 v34, s25, v10
  v_or_b32 v10, 12, v3
  v_xor_b32 v10, v10, v4
  v_lshlrev_b32 v10, 4, v10
  v_lshl_add_u32 v47, v11, 9, v10
  v_lshl_add_u32 v10, v7, 9, v10
  v_add_u32 v35, s25, v10
  s_mul_i32 s30, s17, 401408
  s_mul_i32 s31, s18, 57344
  s_add_u32 s30, s30, s31
  s_add_u32 s30, s30, 33554432
  v_add_u32 v28, s30, v2
  s_add_u32 s30, s30, 14336
  v_add_u32 v29, s30, v2
  s_add_u32 s30, s30, 14336
  v_add_u32 v30, s30, v2
  s_add_u32 s30, s30, 14336
  v_add_u32 v31, s30, v2
  s_add_u32 s30, s30, 14336
  v_mov_b32 v48, 1035512379
wp_A:
  s_lshl_b32 s29, s28, 10
  s_add_u32 s31, s29, 4096
  s_cmp_lt_u32 s28, 10
  s_cselect_b32 s31, s31, 0x40000000
  s_waitcnt vmcnt(0)
  s_barrier
  ds_read_b128 a[0:3], v44 offset:0
  ds_read_b128 a[32:35], v44 offset:1024
  ds_read_b128 a[64:67], v44 offset:4096
  ds_read_b128 a[96:99], v44 offset:5120
  ds_read_b128 a[128:131], v32 offset:0
  ds_read_b128 a[160:163], v32 offset:2048
  ds_read_b128 a[192:195], v32 offset:16384
  ds_read_b128 a[224:227], v32 offset:18432
  s_waitcnt lgkmcnt(0)
  v_mfma_f32_16x16x32_bf16 v[64:67], a[128:131], a[0:3], 0
  ds_read_b128 a[4:7], v45 offset:0
  ds_read_b128 a[36:39], v45 offset:1024
  v_mfma_f32_16x16x32_bf16 v[68:71], a[160:163], a[0:3], 0
  ds_read_b128 a[68:71], v45 offset:4096
  ds_read_b128 a[100:103], v45 offset:5120
  v_mfma_f32_16x16x32_bf16 v[72:75], a[128:131], a[32:35], 0
  ds_read_b128 a[132:135], v33 offset:0
  ds_read_b128 a[164:167], v33 offset:2048
  v_mfma_f32_16x16x32_bf16 v[76:79], a[160:163], a[32:35], 0
  ds_read_b128 a[196:199], v33 offset:16384
  ds_read_b128 a[228:231], v33 offset:18432
  v_mfma_f32_16x16x32_bf16 v[80:83], a[128:131], a[64:67], 0
  v_mfma_f32_16x16x32_bf16 v[84:87], a[160:163], a[64:67], 0
  v_mfma_f32_16x16x32_bf16 v[88:91], a[128:131], a[96:99], 0
  v_mfma_f32_16x16x32_bf16 v[92:95], a[160:163], a[96:99], 0
  v_mfma_f32_16x16x32_bf16 v[96:99], a[192:195], a[0:3], 0
  v_mfma_f32_16x16x32_bf16 v[100:103], a[224:227], a[0:3], 0
  v_mfma_f32_16x16x32_bf16 v[104:107], a[192:195], a[32:35], 0
  v_mfma_f32_16x16x32_bf16 v[108:111], a[224:227], a[32:35], 0
  v_mfma_f32_16x16x32_bf16 v[112:115], a[192:195], a[64:67], 0
  v_mfma_f32_16x16x32_bf16 v[116:119], a[224:227], a[64:67], 0
  v_mfma_f32_16x16x32_bf16 v[120:123], a[192:195], a[96:99], 0
  v_mfma_f32_16x16x32_bf16 v[124:127], a[224:227], a[96:99], 0
  s_waitcnt lgkmcnt(0)
  v_mfma_f32_16x16x32_bf16 v[64:67], a[132:135], a[4:7], v[64:67]
  ds_read_b128 a[8:11], v46 offset:0
  ds_read_b128 a[40:43], v46 offset:1024
  v_mfma_f32_16x16x32_bf16 v[68:71], a[164:167], a[4:7], v[68:71]
  ds_read_b128 a[72:75], v46 offset:4096
  ds_read_b128 a[104:107], v46 offset:5120
  v_mfma_f32_16x16x32_bf16 v[72:75], a[132:135], a[36:39], v[72:75]
  ds_read_b128 a[136:139], v34 offset:0
  ds_read_b128 a[168:171], v34 offset:2048
  v_mfma_f32_16x16x32_bf16 v[76:79], a[164:167], a[36:39], v[76:79]
  ds_read_b128 a[200:203], v34 offset:16384
  ds_read_b128 a[232:235], v34 offset:18432
  v_mfma_f32_16x16x32_bf16 v[80:83], a[132:135], a[68:71], v[80:83]
  v_mfma_f32_16x16x32_bf16 v[84:87], a[164:167], a[68:71], v[84:87]
  v_mfma_f32_16x16x32_bf16 v[88:91], a[132:135], a[100:103], v[88:91]
  v_mfma_f32_16x16x32_bf16 v[92:95], a[164:167], a[100:103], v[92:95]
  v_mfma_f32_16x16x32_bf16 v[96:99], a[196:199], a[4:7], v[96:99]
  v_mfma_f32_16x16x32_bf16 v[100:103], a[228:231], a[4:7], v[100:103]
  v_mfma_f32_16x16x32_bf16 v[104:107], a[196:199], a[36:39], v[104:107]
  v_mfma_f32_16x16x32_bf16 v[108:111], a[228:231], a[36:39], v[108:111]
  v_mfma_f32_16x16x32_bf16 v[112:115], a[196:199], a[68:71], v[112:115]
  v_mfma_f32_16x16x32_bf16 v[116:119], a[228:231], a[68:71], v[116:119]
  v_mfma_f32_16x16x32_bf16 v[120:123], a[196:199], a[100:103], v[120:123]
  v_mfma_f32_16x16x32_bf16 v[124:127], a[228:231], a[100:103], v[124:127]
  s_waitcnt lgkmcnt(0)
  v_mfma_f32_16x16x32_bf16 v[64:67], a[136:139], a[8:11], v[64:67]
  ds_read_b128 a[12:15], v47 offset:0
  ds_read_b128 a[44:47], v47 offset:1024
  v_mfma_f32_16x16x32_bf16 v[68:71], a[168:171], a[8:11], v[68:71]
  ds_read_b128 a[76:79], v47 offset:4096
  ds_read_b128 a[108:111], v47 offset:5120
  v_mfma_f32_16x16x32_bf16 v[72:75], a[136:139], a[40:43], v[72:75]
  ds_read_b128 a[140:143], v35 offset:0
  ds_read_b128 a[172:175], v35 offset:2048
  v_mfma_f32_16x16x32_bf16 v[76:79], a[168:171], a[40:43], v[76:79]
  ds_read_b128 a[204:207], v35 offset:16384
  ds_read_b128 a[236:239], v35 offset:18432
  v_mfma_f32_16x16x32_bf16 v[80:83], a[136:139], a[72:75], v[80:83]
  v_mfma_f32_16x16x32_bf16 v[84:87], a[168:171], a[72:75], v[84:87]
  v_mfma_f32_16x16x32_bf16 v[88:91], a[136:139], a[104:107], v[88:91]
  v_mfma_f32_16x16x32_bf16 v[92:95], a[168:171], a[104:107], v[92:95]
  v_mfma_f32_16x16x32_bf16 v[96:99], a[200:203], a[8:11], v[96:99]
  v_mfma_f32_16x16x32_bf16 v[100:103], a[232:235], a[8:11], v[100:103]
  v_mfma_f32_16x16x32_bf16 v[104:107], a[200:203], a[40:43], v[104:107]
  v_mfma_f32_16x16x32_bf16 v[108:111], a[232:235], a[40:43], v[108:111]
  v_mfma_f32_16x16x32_bf16 v[112:115], a[200:203], a[72:75], v[112:115]
  v_mfma_f32_16x16x32_bf16 v[116:119], a[232:235], a[72:75], v[116:119]
  v_mfma_f32_16x16x32_bf16 v[120:123], a[200:203], a[104:107], v[120:123]
  v_mfma_f32_16x16x32_bf16 v[124:127], a[232:235], a[104:107], v[124:127]
  s_waitcnt lgkmcnt(0)
  v_mfma_f32_16x16x32_bf16 v[64:67], a[140:143], a[12:15], v[64:67]
  ds_read_b128 a[16:19], v44 offset:256
  ds_read_b128 a[48:51], v44 offset:1280
  v_mfma_f32_16x16x32_bf16 v[68:71], a[172:175], a[12:15], v[68:71]
  ds_read_b128 a[80:83], v44 offset:4352
  ds_read_b128 a[112:115], v44 offset:5376
  v_mfma_f32_16x16x32_bf16 v[72:75], a[140:143], a[44:47], v[72:75]
  ds_read_b128 a[144:147], v32 offset:256
  ds_read_b128 a[176:179], v32 offset:2304
  v_mfma_f32_16x16x32_bf16 v[76:79], a[172:175], a[44:47], v[76:79]
  ds_read_b128 a[208:211], v32 offset:16640
  ds_read_b128 a[240:243], v32 offset:18688
  v_mfma_f32_16x16x32_bf16 v[80:83], a[140:143], a[76:79], v[80:83]
  v_mfma_f32_16x16x32_bf16 v[84:87], a[172:175], a[76:79], v[84:87]
  v_mfma_f32_16x16x32_bf16 v[88:91], a[140:143], a[108:111], v[88:91]
  v_mfma_f32_16x16x32_bf16 v[92:95], a[172:175], a[108:111], v[92:95]
  v_mfma_f32_16x16x32_bf16 v[96:99], a[204:207], a[12:15], v[96:99]
  v_mfma_f32_16x16x32_bf16 v[100:103], a[236:239], a[12:15], v[100:103]
  v_mfma_f32_16x16x32_bf16 v[104:107], a[204:207], a[44:47], v[104:107]
  v_mfma_f32_16x16x32_bf16 v[108:111], a[236:239], a[44:47], v[108:111]
  v_mfma_f32_16x16x32_bf16 v[112:115], a[204:207], a[76:79], v[112:115]
  v_mfma_f32_16x16x32_bf16 v[116:119], a[236:239], a[76:79], v[116:119]
  v_mfma_f32_16x16x32_bf16 v[120:123], a[204:207], a[108:111], v[120:123]
  v_mfma_f32_16x16x32_bf16 v[124:127], a[236:239], a[108:111], v[124:127]
  s_waitcnt lgkmcnt(0)
  v_mfma_f32_16x16x32_bf16 v[64:67], a[144:147], a[16:19], v[64:67]
  ds_read_b128 a[20:23], v45 offset:256
  ds_read_b128 a[52:55], v45 offset:1280
  v_mfma_f32_16x16x32_bf16 v[68:71], a[176:179], a[16:19], v[68:71]
  ds_read_b128 a[84:87], v45 offset:4352
  ds_read_b128 a[116:119], v45 offset:5376
  v_mfma_f32_16x16x32_bf16 v[72:75], a[144:147], a[48:51], v[72:75]
  ds_read_b128 a[148:151], v33 offset:256
  ds_read_b128 a[180:183], v33 offset:2304
  v_mfma_f32_16x16x32_bf16 v[76:79], a[176:179], a[48:51], v[76:79]
  ds_read_b128 a[212:215], v33 offset:16640
  ds_read_b128 a[244:247], v33 offset:18688
  v_mfma_f32_16x16x32_bf16 v[80:83], a[144:147], a[80:83], v[80:83]
  v_mfma_f32_16x16x32_bf16 v[84:87], a[176:179], a[80:83], v[84:87]
  v_mfma_f32_16x16x32_bf16 v[88:91], a[144:147], a[112:115], v[88:91]
  v_mfma_f32_16x16x32_bf16 v[92:95], a[176:179], a[112:115], v[92:95]
  v_mfma_f32_16x16x32_bf16 v[96:99], a[208:211], a[16:19], v[96:99]
  v_mfma_f32_16x16x32_bf16 v[100:103], a[240:243], a[16:19], v[100:103]
  v_mfma_f32_16x16x32_bf16 v[104:107], a[208:211], a[48:51], v[104:107]
  v_mfma_f32_16x16x32_bf16 v[108:111], a[240:243], a[48:51], v[108:111]
  v_mfma_f32_16x16x32_bf16 v[112:115], a[208:211], a[80:83], v[112:115]
  v_mfma_f32_16x16x32_bf16 v[116:119], a[240:243], a[80:83], v[116:119]
  v_mfma_f32_16x16x32_bf16 v[120:123], a[208:211], a[112:115], v[120:123]
  v_mfma_f32_16x16x32_bf16 v[124:127], a[240:243], a[112:115], v[124:127]
  s_waitcnt lgkmcnt(0)
  v_mfma_f32_16x16x32_bf16 v[64:67], a[148:151], a[20:23], v[64:67]
  ds_read_b128 a[24:27], v46 offset:256
  ds_read_b128 a[56:59], v46 offset:1280
  v_mfma_f32_16x16x32_bf16 v[68:71], a[180:183], a[20:23], v[68:71]
  ds_read_b128 a[88:91], v46 offset:4352
  ds_read_b128 a[120:123], v46 offset:5376
  v_mfma_f32_16x16x32_bf16 v[72:75], a[148:151], a[52:55], v[72:75]
  ds_read_b128 a[152:155], v34 offset:256
  ds_read_b128 a[184:187], v34 offset:2304
  v_mfma_f32_16x16x32_bf16 v[76:79], a[180:183], a[52:55], v[76:79]
  ds_read_b128 a[216:219], v34 offset:16640
  ds_read_b128 a[248:251], v34 offset:18688
  v_mfma_f32_16x16x32_bf16 v[80:83], a[148:151], a[84:87], v[80:83]
  v_mfma_f32_16x16x32_bf16 v[84:87], a[180:183], a[84:87], v[84:87]
  v_mfma_f32_16x16x32_bf16 v[88:91], a[148:151], a[116:119], v[88:91]
  v_mfma_f32_16x16x32_bf16 v[92:95], a[180:183], a[116:119], v[92:95]
  v_mfma_f32_16x16x32_bf16 v[96:99], a[212:215], a[20:23], v[96:99]
  v_mfma_f32_16x16x32_bf16 v[100:103], a[244:247], a[20:23], v[100:103]
  v_mfma_f32_16x16x32_bf16 v[104:107], a[212:215], a[52:55], v[104:107]
  v_mfma_f32_16x16x32_bf16 v[108:111], a[244:247], a[52:55], v[108:111]
  v_mfma_f32_16x16x32_bf16 v[112:115], a[212:215], a[84:87], v[112:115]
  v_mfma_f32_16x16x32_bf16 v[116:119], a[244:247], a[84:87], v[116:119]
  v_mfma_f32_16x16x32_bf16 v[120:123], a[212:215], a[116:119], v[120:123]
  v_mfma_f32_16x16x32_bf16 v[124:127], a[244:247], a[116:119], v[124:127]
  s_waitcnt lgkmcnt(0)
  v_mfma_f32_16x16x32_bf16 v[64:67], a[152:155], a[24:27], v[64:67]
  ds_read_b128 a[28:31], v47 offset:256
  ds_read_b128 a[60:63], v47 offset:1280
  v_mfma_f32_16x16x32_bf16 v[68:71], a[184:187], a[24:27], v[68:71]
  ds_read_b128 a[92:95], v47 offset:4352
  ds_read_b128 a[124:127], v47 offset:5376
  v_mfma_f32_16x16x32_bf16 v[72:75], a[152:155], a[56:59], v[72:75]
  ds_read_b128 a[156:159], v35 offset:256
  ds_read_b128 a[188:191], v35 offset:2304
  v_mfma_f32_16x16x32_bf16 v[76:79], a[184:187], a[56:59], v[76:79]
  ds_read_b128 a[220:223], v35 offset:16640
  ds_read_b128 a[252:255], v35 offset:18688
  v_mfma_f32_16x16x32_bf16 v[80:83], a[152:155], a[88:91], v[80:83]
  v_mfma_f32_16x16x32_bf16 v[84:87], a[184:187], a[88:91], v[84:87]
  v_mfma_f32_16x16x32_bf16 v[88:91], a[152:155], a[120:123], v[88:91]
  v_mfma_f32_16x16x32_bf16 v[92:95], a[184:187], a[120:123], v[92:95]
  v_mfma_f32_16x16x32_bf16 v[96:99], a[216:219], a[24:27], v[96:99]
  v_mfma_f32_16x16x32_bf16 v[100:103], a[248:251], a[24:27], v[100:103]
  v_mfma_f32_16x16x32_bf16 v[104:107], a[216:219], a[56:59], v[104:107]
  v_mfma_f32_16x16x32_bf16 v[108:111], a[248:251], a[56:59], v[108:111]
  v_mfma_f32_16x16x32_bf16 v[112:115], a[216:219], a[88:91], v[112:115]
  v_mfma_f32_16x16x32_bf16 v[116:119], a[248:251], a[88:91], v[116:119]
  v_mfma_f32_16x16x32_bf16 v[120:123], a[216:219], a[120:123], v[120:123]
  v_mfma_f32_16x16x32_bf16 v[124:127], a[248:251], a[120:123], v[124:127]
  s_waitcnt lgkmcnt(0)
  s_barrier
  buffer_load_dwordx2 v[254:255], v252, s[12:15], 0 offen offset:128 sc1
  buffer_load_dword v253, v252, s[12:15], 0 offen sc1
  v_mfma_f32_16x16x32_bf16 v[64:67], a[156:159], a[28:31], v[64:67]
  v_mfma_f32_16x16x32_bf16 v[68:71], a[188:191], a[28:31], v[68:71]
  v_mfma_f32_16x16x32_bf16 v[72:75], a[156:159], a[60:63], v[72:75]
  v_mfma_f32_16x16x32_bf16 v[76:79], a[188:191], a[60:63], v[76:79]
  v_mfma_f32_16x16x32_bf16 v[80:83], a[156:159], a[92:95], v[80:83]
  v_pk_mul_f32 v[64:65], v[64:65], v[48:49] op_sel_hi:[1,0]
  v_pk_mul_f32 v[66:67], v[66:67], v[48:49] op_sel_hi:[1,0]
  v_mfma_f32_16x16x32_bf16 v[84:87], a[188:191], a[92:95], v[84:87]
  v_pk_mul_f32 v[68:69], v[68:69], v[48:49] op_sel_hi:[1,0]
  v_pk_mul_f32 v[70:71], v[70:71], v[48:49] op_sel_hi:[1,0]
  v_mfma_f32_16x16x32_bf16 v[88:91], a[156:159], a[124:127], v[88:91]
  v_cvt_pk_bf16_f32 v64, v64, v65
  v_cvt_pk_bf16_f32 v65, v66, v67
  v_mfma_f32_16x16x32_bf16 v[92:95], a[188:191], a[124:127], v[92:95]
  v_cvt_pk_bf16_f32 v66, v68, v69
  v_cvt_pk_bf16_f32 v67, v70, v71
  v_mfma_f32_16x16x32_bf16 v[96:99], a[220:223], a[28:31], v[96:99]
  buffer_store_dwordx4 v[64:67], v28, s[8:11], s29 offen sc1
  v_pk_mul_f32 v[72:73], v[72:73], v[48:49] op_sel_hi:[1,0]
  v_mfma_f32_16x16x32_bf16 v[100:103], a[252:255], a[28:31], v[100:103]
  v_pk_mul_f32 v[74:75], v[74:75], v[48:49] op_sel_hi:[1,0]
  v_pk_mul_f32 v[76:77], v[76:77], v[48:49] op_sel_hi:[1,0]
  v_mfma_f32_16x16x32_bf16 v[104:107], a[220:223], a[60:63], v[104:107]
  v_pk_mul_f32 v[78:79], v[78:79], v[48:49] op_sel_hi:[1,0]
  v_cvt_pk_bf16_f32 v72, v72, v73
  v_mfma_f32_16x16x32_bf16 v[108:111], a[252:255], a[60:63], v[108:111]
  v_cvt_pk_bf16_f32 v73, v74, v75
  v_cvt_pk_bf16_f32 v74, v76, v77
  v_mfma_f32_16x16x32_bf16 v[112:115], a[220:223], a[92:95], v[112:115]
  v_cvt_pk_bf16_f32 v75, v78, v79
  buffer_store_dwordx4 v[72:75], v29, s[8:11], s29 offen sc1
  v_mfma_f32_16x16x32_bf16 v[116:119], a[252:255], a[92:95], v[116:119]
  v_pk_mul_f32 v[80:81], v[80:81], v[48:49] op_sel_hi:[1,0]
  v_pk_mul_f32 v[82:83], v[82:83], v[48:49] op_sel_hi:[1,0]
  v_mfma_f32_16x16x32_bf16 v[120:123], a[220:223], a[124:127], v[120:123]
  v_pk_mul_f32 v[84:85], v[84:85], v[48:49] op_sel_hi:[1,0]
  v_pk_mul_f32 v[86:87], v[86:87], v[48:49] op_sel_hi:[1,0]
  v_mfma_f32_16x16x32_bf16 v[124:127], a[252:255], a[124:127], v[124:127]
  v_cvt_pk_bf16_f32 v80, v80, v81
  v_cvt_pk_bf16_f32 v81, v82, v83
  v_cvt_pk_bf16_f32 v82, v84, v85
  v_cvt_pk_bf16_f32 v83, v86, v87
  buffer_store_dwordx4 v[80:83], v30, s[8:11], s29 offen sc1
  v_pk_mul_f32 v[88:89], v[88:89], v[48:49] op_sel_hi:[1,0]
  v_pk_mul_f32 v[90:91], v[90:91], v[48:49] op_sel_hi:[1,0]
  v_pk_mul_f32 v[92:93], v[92:93], v[48:49] op_sel_hi:[1,0]
  v_pk_mul_f32 v[94:95], v[94:95], v[48:49] op_sel_hi:[1,0]
  v_cvt_pk_bf16_f32 v88, v88, v89
  v_cvt_pk_bf16_f32 v89, v90, v91
  v_cvt_pk_bf16_f32 v90, v92, v93
  v_cvt_pk_bf16_f32 v91, v94, v95
  buffer_store_dwordx4 v[88:91], v31, s[8:11], s29 offen sc1
  v_pk_mul_f32 v[96:97], v[96:97], v[48:49] op_sel_hi:[1,0]
  v_pk_mul_f32 v[98:99], v[98:99], v[48:49] op_sel_hi:[1,0]
  v_pk_mul_f32 v[100:101], v[100:101], v[48:49] op_sel_hi:[1,0]
  v_pk_mul_f32 v[102:103], v[102:103], v[48:49] op_sel_hi:[1,0]
  v_cvt_pk_bf16_f32 v96, v96, v97
  v_cvt_pk_bf16_f32 v97, v98, v99
  v_cvt_pk_bf16_f32 v98, v100, v101
  v_cvt_pk_bf16_f32 v99, v102, v103
  buffer_store_dwordx4 v[96:99], v28, s[8:11], s31 offen sc1
  v_pk_mul_f32 v[104:105], v[104:105], v[48:49] op_sel_hi:[1,0]
  v_pk_mul_f32 v[106:107], v[106:107], v[48:49] op_sel_hi:[1,0]
  v_pk_mul_f32 v[108:109], v[108:109], v[48:49] op_sel_hi:[1,0]
  v_pk_mul_f32 v[110:111], v[110:111], v[48:49] op_sel_hi:[1,0]
  v_cvt_pk_bf16_f32 v104, v104, v105
  v_cvt_pk_bf16_f32 v105, v106, v107
  v_cvt_pk_bf16_f32 v106, v108, v109
  v_cvt_pk_bf16_f32 v107, v110, v111
  buffer_store_dwordx4 v[104:107], v29, s[8:11], s31 offen sc1
  v_pk_mul_f32 v[112:113], v[112:113], v[48:49] op_sel_hi:[1,0]
  v_pk_mul_f32 v[114:115], v[114:115], v[48:49] op_sel_hi:[1,0]
  v_pk_mul_f32 v[116:117], v[116:117], v[48:49] op_sel_hi:[1,0]
  v_pk_mul_f32 v[118:119], v[118:119], v[48:49] op_sel_hi:[1,0]
  v_cvt_pk_bf16_f32 v112, v112, v113
  v_cvt_pk_bf16_f32 v113, v114, v115
  v_cvt_pk_bf16_f32 v114, v116, v117
  v_cvt_pk_bf16_f32 v115, v118, v119
  buffer_store_dwordx4 v[112:115], v30, s[8:11], s31 offen sc1
  v_pk_mul_f32 v[120:121], v[120:121], v[48:49] op_sel_hi:[1,0]
  v_pk_mul_f32 v[122:123], v[122:123], v[48:49] op_sel_hi:[1,0]
  v_pk_mul_f32 v[124:125], v[124:125], v[48:49] op_sel_hi:[1,0]
  v_pk_mul_f32 v[126:127], v[126:127], v[48:49] op_sel_hi:[1,0]
  v_cvt_pk_bf16_f32 v120, v120, v121
  v_cvt_pk_bf16_f32 v121, v122, v123
  v_cvt_pk_bf16_f32 v122, v124, v125
  v_cvt_pk_bf16_f32 v123, v126, v127
  buffer_store_dwordx4 v[120:123], v31, s[8:11], s31 offen sc1
  s_waitcnt vmcnt(0)
  s_barrier
  s_cmp_lg_u32 s16, 0
  s_cbranch_scc1 wp_f3_f
  v_readfirstlane_b32 s20, v254
  s_cmp_eq_u32 s20, 1
  s_cbranch_scc1 wp_f3_w_ok
  s_mov_b32 s30, 0
wp_f3_w:
  buffer_load_dword v254, off, s[12:15], 0 offset:128 sc1
  s_waitcnt vmcnt(0)
  v_cmp_ne_u32 vcc, 1, v254
  s_cbranch_vccz wp_f3_w_ok
  s_sleep 8
  s_add_u32 s30, s30, 1
  s_cmp_lt_u32 s30, 16
  s_cbranch_scc1 wp_f3_w
  s_branch wp_f3_f
wp_f3_w_ok:
  s_lshl_b32 s20, s17, 7
  s_add_u32 s20, s20, 584192
  s_lshl_b32 s21, 1, s19
  v_mov_b32 v248, s21
  s_mov_b64 exec, 1
  buffer_atomic_or v248, v252, s[8:11], s20 offen sc0
  s_mov_b64 exec, -1
  s_mov_b32 s38, s21
wp_f3_f:
  s_cmp_eq_u32 s97, 3
  s_cbranch_scc1 wk_adone
wp_fin:
  s_cmp_lg_u32 s97, 0
  s_cbranch_scc1 wp_all
  v_readfirstlane_b32 s20, v254
  v_readfirstlane_b32 s21, v253
  s_and_b32 s21, s21, 0xffe0
  s_cselect_b32 s96, s20, 0
  s_cmp_eq_u32 s96, 0
  s_cbranch_scc1 wp_all
  v_mov_b32 v250, 1
  s_mov_b32 s20, 588288
  s_mov_b64 exec, 1
  buffer_atomic_add v250, v252, s[8:11], s20 offen sc0
  s_mov_b64 exec, -1
wp_all:
  v_mov_b32 v252, 0x40000000
  v_cmp_eq_u32 vcc, 0, v0
  s_nop 1
  v_cndmask_b32 v252, v252, v0, vcc
  s_mov_b32 s34, 0
  s_cmp_lg_u32 s16, 0
  s_cbranch_scc1 wp_w2
  s_getreg_b32 s24, hwreg(HW_REG_XCC_ID)
  s_sub_u32 s24, s24, 1
  s_and_b32 s24, s24, 7
  s_lshl_b32 s24, s24, 7
  s_add_u32 s24, s24, 586240
  s_cmp_lg_u32 s96, 0
  s_cbranch_scc1 wp_v0
  s_waitcnt vmcnt(0)
wp_v0:
  s_cmp_eq_u32 s97, 0
  s_cbranch_scc1 wp_v1
  s_waitcnt vmcnt(0)
wp_v1:
  s_waitcnt vmcnt(1)
  v_readfirstlane_b32 s20, v248
  s_and_b32 s20, s20, 14448
  s_xor_b32 s20, s20, s38
  s_cmp_lg_u32 s20, 14448
  s_cselect_b32 s20, 0, s38
  s_mov_b32 s38, 0
  s_cmp_eq_u32 s20, 0
  s_cbranch_scc1 wp_g3
  s_lshl_b32 s21, 65536, s17
  v_mov_b32 v248, s21
  s_mov_b32 s20, 586240
  v_lshlrev_b32 v247, 7, v0
  s_mov_b64 exec, 0xff
  buffer_atomic_or v248, v247, s[8:11], s20 offen
  s_mov_b64 exec, -1
wp_g3:
  v_readfirstlane_b32 s20, v248
  s_and_b32 s20, s20, 16383
  s_xor_b32 s20, s20, s37
  s_cmp_lg_u32 s20, 16383
  s_cselect_b32 s20, 0, s37
  s_mov_b32 s37, 0
  s_cmp_eq_u32 s20, 0
  s_cbranch_scc1 wp_g2
  s_lshl_b32 s21, 1, s17
  v_mov_b32 v248, s21
  s_mov_b32 s20, 586240
  v_lshlrev_b32 v247, 7, v0
  s_mov_b64 exec, 0xff
  buffer_atomic_or v248, v247, s[8:11], s20 offen
  s_mov_b64 exec, -1
wp_g2:
  s_cmp_lg_u32 s96, 0
  s_cbranch_scc1 wp_v_ok
  s_mov_b32 s30, 0
wp_v:
  buffer_load_dwordx2 v[64:65], off, s[12:15], 0 sc1
  buffer_load_dword v66, off, s[12:15], 0 offset:128 sc1
  s_waitcnt vmcnt(0)
  v_and_b32 v68, 0xffe0, v64
  v_min_u32 v68, v68, v66
  v_cmp_ne_u32 vcc, 1, v68
  s_cbranch_vccz wp_v_ok
  s_sleep 16
  s_add_u32 s30, s30, 1
  s_cmp_lt_u32 s30, 30
  s_cbranch_scc1 wp_v
  s_branch wp_w1
wp_v_ok:
  v_mov_b32 v64, 32
  s_cmp_eq_u32 s97, 2
  s_cselect_b32 s31, 1, 60
  s_cmp_eq_u32 s39, -1
  s_cselect_b32 s20, 4, 0
  s_add_u32 s24, s24, s20
  s_mov_b32 s30, 0
wp_w:
  buffer_load_dword v66, off, s[8:11], s24 sc1
  buffer_load_dword v67, off, s[8:11], s24 offset:4 sc1
  s_waitcnt vmcnt(0)
  v_or_b32 v66, s39, v66
  v_add_u32 v66, v66, v67
  v_cmp_ne_u32 vcc, 0, v66
  s_cbranch_vccz wp_w_ok
  s_sleep 8
  s_add_u32 s30, s30, 1
  s_cmp_lt_u32 s30, s31
  s_cbranch_scc1 wp_w
  s_branch wp_w1
wp_w_ok:
  s_branch wp_w2
wp_w1:
  v_readfirstlane_b32 s20, v64
  v_readfirstlane_b32 s21, v65
  s_and_b32 s20, s20, 0xffff
  s_cmp_lt_u32 s20, 32
  s_cselect_b32 s34, 2, 1
  s_add_u32 s32, s32, 1
  s_cmp_lt_u32 s32, 4000
  s_cselect_b32 s34, s34, 3
wp_w2:
  v_mov_b32 v6, 160032
  v_mov_b32 v7, s34
  s_barrier
  s_cmp_lg_u32 s16, 0
  s_cbranch_scc1 uni_7
  ds_write_b32 v6, v7
  s_waitcnt lgkmcnt(0)
uni_7:
  s_barrier
  ds_read_b32 v7, v6
  s_waitcnt lgkmcnt(0)
  v_readfirstlane_b32 s34, v7
  s_cmp_lg_u32 s34, 0
  s_cbranch_scc1 wp_bad
  s_cmp_lg_u32 s39, -1
  s_cbranch_scc1 wp_done
  s_mov_b32 s101, 0
  s_lshl_b32 s20, s101, 4
  s_lshr_b32 s21, s2, 3
  s_add_u32 s21, s21, s16
  s_and_b32 s21, s21, 3
  s_lshl_b32 s21, s21, 2
  s_add_u32 s20, s20, s21
  s_mul_i32 s21, s20, 14336
  s_add_u32 s21, s21, 655360
  s_add_u32 s22, s21, 0
  buffer_load_dwordx4 a[0:3], v2, s[8:11], s22 offen offset:0 sc1
  buffer_load_dwordx4 a[4:7], v2, s[8:11], s22 offen offset:1024 sc1
  buffer_load_dwordx4 a[8:11], v2, s[8:11], s22 offen offset:2048 sc1
  buffer_load_dwordx4 a[12:15], v2, s[8:11], s22 offen offset:3072 sc1
  s_add_u32 s22, s21, 4096
  buffer_load_dwordx4 a[16:19], v2, s[8:11], s22 offen offset:0 sc1
  buffer_load_dwordx4 a[20:23], v2, s[8:11], s22 offen offset:1024 sc1
  buffer_load_dwordx4 a[24:27], v2, s[8:11], s22 offen offset:2048 sc1
  buffer_load_dwordx4 a[28:31], v2, s[8:11], s22 offen offset:3072 sc1
  s_add_u32 s22, s21, 8192
  buffer_load_dwordx4 a[32:35], v2, s[8:11], s22 offen offset:0 sc1
  buffer_load_dwordx4 a[36:39], v2, s[8:11], s22 offen offset:1024 sc1
  buffer_load_dwordx4 a[40:43], v2, s[8:11], s22 offen offset:2048 sc1
  buffer_load_dwordx4 a[44:47], v2, s[8:11], s22 offen offset:3072 sc1
  s_add_u32 s22, s21, 12288
  buffer_load_dwordx4 a[48:51], v2, s[8:11], s22 offen offset:0 sc1
  buffer_load_dwordx4 a[52:55], v2, s[8:11], s22 offen offset:1024 sc1
  buffer_load_dwordx4 a[56:59], v2, s[8:11], s22 offen offset:2048 sc1
  buffer_load_dwordx4 a[60:63], v2, s[8:11], s22 offen offset:3072 sc1
  s_add_u32 s22, s21, 16384
  buffer_load_dwordx4 a[64:67], v2, s[8:11], s22 offen offset:0 sc1
  buffer_load_dwordx4 a[68:71], v2, s[8:11], s22 offen offset:1024 sc1
  buffer_load_dwordx4 a[72:75], v2, s[8:11], s22 offen offset:2048 sc1
  buffer_load_dwordx4 a[76:79], v2, s[8:11], s22 offen offset:3072 sc1
  s_add_u32 s22, s21, 20480
  buffer_load_dwordx4 a[80:83], v2, s[8:11], s22 offen offset:0 sc1
  buffer_load_dwordx4 a[84:87], v2, s[8:11], s22 offen offset:1024 sc1
  buffer_load_dwordx4 a[88:91], v2, s[8:11], s22 offen offset:2048 sc1
  buffer_load_dwordx4 a[92:95], v2, s[8:11], s22 offen offset:3072 sc1
  s_add_u32 s22, s21, 24576
  buffer_load_dwordx4 a[96:99], v2, s[8:11], s22 offen offset:0 sc1
  buffer_load_dwordx4 a[100:103], v2, s[8:11], s22 offen offset:1024 sc1
  buffer_load_dwordx4 a[104:107], v2, s[8:11], s22 offen offset:2048 sc1
  buffer_load_dwordx4 a[108:111], v2, s[8:11], s22 offen offset:3072 sc1
  s_add_u32 s22, s21, 28672
  buffer_load_dwordx4 a[112:115], v2, s[8:11], s22 offen offset:0 sc1
  buffer_load_dwordx4 a[116:119], v2, s[8:11], s22 offen offset:1024 sc1
  buffer_load_dwordx4 a[120:123], v2, s[8:11], s22 offen offset:2048 sc1
  buffer_load_dwordx4 a[124:127], v2, s[8:11], s22 offen offset:3072 sc1
  s_add_u32 s22, s21, 32768
  buffer_load_dwordx4 a[128:131], v2, s[8:11], s22 offen offset:0 sc1
  buffer_load_dwordx4 a[132:135], v2, s[8:11], s22 offen offset:1024 sc1
  buffer_load_dwordx4 a[136:139], v2, s[8:11], s22 offen offset:2048 sc1
  buffer_load_dwordx4 a[140:143], v2, s[8:11], s22 offen offset:3072 sc1
  s_add_u32 s22, s21, 36864
  buffer_load_dwordx4 a[144:147], v2, s[8:11], s22 offen offset:0 sc1
  buffer_load_dwordx4 a[148:151], v2, s[8:11], s22 offen offset:1024 sc1
  buffer_load_dwordx4 a[152:155], v2, s[8:11], s22 offen offset:2048 sc1
  buffer_load_dwordx4 a[156:159], v2, s[8:11], s22 offen offset:3072 sc1
  s_add_u32 s22, s21, 40960
  s_waitcnt vmcnt(40)
  buffer_load_dwordx4 a[160:163], v2, s[8:11], s22 offen offset:0 sc1
  buffer_load_dwordx4 a[164:167], v2, s[8:11], s22 offen offset:1024 sc1
  buffer_load_dwordx4 a[168:171], v2, s[8:11], s22 offen offset:2048 sc1
  buffer_load_dwordx4 a[172:175], v2, s[8:11], s22 offen offset:3072 sc1
  s_add_u32 s22, s21, 45056
  buffer_load_dwordx4 a[176:179], v2, s[8:11], s22 offen offset:0 sc1
  buffer_load_dwordx4 a[180:183], v2, s[8:11], s22 offen offset:1024 sc1
  buffer_load_dwordx4 a[184:187], v2, s[8:11], s22 offen offset:2048 sc1
  buffer_load_dwordx4 a[188:191], v2, s[8:11], s22 offen offset:3072 sc1
  s_add_u32 s22, s21, 49152
  buffer_load_dwordx4 a[192:195], v2, s[8:11], s22 offen offset:0 sc1
  buffer_load_dwordx4 a[196:199], v2, s[8:11], s22 offen offset:1024 sc1
  buffer_load_dwordx4 a[200:203], v2, s[8:11], s22 offen offset:2048 sc1
  buffer_load_dwordx4 a[204:207], v2, s[8:11], s22 offen offset:3072 sc1
  s_add_u32 s22, s21, 53248
  buffer_load_dwordx4 a[208:211], v2, s[8:11], s22 offen offset:0 sc1
  buffer_load_dwordx4 a[212:215], v2, s[8:11], s22 offen offset:1024 sc1
  buffer_load_dwordx4 a[216:219], v2, s[8:11], s22 offen offset:2048 sc1
  buffer_load_dwordx4 a[220:223], v2, s[8:11], s22 offen offset:3072 sc1
  s_mov_b32 s39, 0xffff0000
  s_branch wp_all
wp_bad:
  s_and_b32 s39, s39, 0xffff0000
  s_mov_b32 s97, 1
  s_cmp_eq_u32 s34, 1
  s_cbranch_scc1 wp_rep
  s_cmp_eq_u32 s34, 3
  s_cbranch_scc1 cA_abort
  s_load_dwordx8 s[40:47], s[0:1], 72
  s_load_dwordx4 s[48:51], s[0:1], 56
  s_waitcnt lgkmcnt(0)
  v_mov_b32 v4, 0x10001
  s_mov_b32 s18, 1
  s_branch ch_take
wp_rep:
  s_mov_b32 s101, -1
  s_load_dwordx8 s[40:47], s[0:1], 72
  s_load_dwordx4 s[48:51], s[0:1], 56
  s_waitcnt vmcnt(0) lgkmcnt(0)
  v_mov_b32 v4, 1
  v_mov_b32 v5, 20
  v_mov_b32 v6, 160000
  s_barrier
  s_cmp_lg_u32 s16, 0
  s_cbranch_scc1 wp_el1
  s_mov_b64 exec, 1
  buffer_atomic_add v4, v5, s[12:15], 0 offen sc0
  s_waitcnt vmcnt(0)
  ds_write_b32 v6, v4
  s_waitcnt lgkmcnt(0)
  s_mov_b64 exec, -1
wp_el1:
  s_barrier
  ds_read_b32 v4, v6
  s_waitcnt lgkmcnt(0)
  v_readfirstlane_b32 s33, v4
  v_and_b32 v1, 63, v0
  v_lshlrev_b32 v2, 4, v1
  v_lshrrev_b32 v3, 4, v1
  v_and_b32 v4, 15, v1
  v_lshrrev_b32 v5, 5, v1
  v_and_b32 v6, 31, v1
  v_xor_b32 v8, v6, v5
  v_lshlrev_b32 v8, 4, v8
  v_lshl_add_u32 v16, v5, 13, v8
  v_xor_b32 v17, 32, v16
  v_xor_b32 v18, 64, v16
  v_xor_b32 v19, 96, v16
  v_xor_b32 v20, 128, v16
  v_xor_b32 v21, 160, v16
  v_xor_b32 v22, 192, v16
  v_xor_b32 v23, 224, v16
  s_lshl_b32 s20, s16, 6
  v_xor_b32 v26, s20, v16
  v_xor_b32 v27, 32, v26
  s_and_b32 s33, s33, 511
  s_and_b32 s20, s33, 255
  s_cmp_ge_u32 s20, 224
  s_cselect_b32 s97, 1, 2
  s_cbranch_scc1 wp_all
  s_mul_i32 s17, s20, 4682
  s_lshr_b32 s17, s17, 16
  s_mul_i32 s23, s17, 14
  s_sub_u32 s19, s20, s23
  s_cmp_lt_u32 s19, 7
  s_cselect_b32 s18, 0, 7
  s_cselect_b32 s28, 0, 8
  s_sub_u32 s18, s19, s18
  s_add_u32 s28, s28, s16
  s_lshl_b32 s25, s16, 15
  s_add_u32 s25, s25, 32768
  s_lshl_b32 s26, s17, 9
  s_lshl_b32 s20, s17, 7
  s_lshr_b32 s21, s33, 8
  s_lshl_b32 s21, s21, 11
  s_add_u32 s20, s20, s21
  s_add_u32 s20, s20, 582144
  buffer_load_dword v5, off, s[8:11], s20 sc1
  s_waitcnt vmcnt(0)
  v_readfirstlane_b32 s34, v5
  v_mov_b32 v6, 160032
  s_nop 0
  v_mov_b32 v7, s34
  s_barrier
  s_cmp_lg_u32 s16, 0
  s_cbranch_scc1 uni_8
  ds_write_b32 v6, v7
  s_waitcnt lgkmcnt(0)
uni_8:
  s_barrier
  ds_read_b32 v7, v6
  s_waitcnt lgkmcnt(0)
  v_readfirstlane_b32 s34, v7
  s_cmp_lt_u32 s33, 256
  s_cselect_b32 s20, 0, 1935
  s_or_b32 s34, s34, s20
  s_bitcmp1_b32 s34, s19
  s_cbranch_scc1 wp_rep
  s_barrier
  s_cmp_lt_u32 s33, 256
  s_cbranch_scc1 wp_B
  s_branch wp_A0
wp_done:
  s_mov_b32 s97, s39
  s_cmp_lg_u32 s96, 0
  s_cbranch_scc1 wk_next
  s_cmp_lg_u32 s16, 0
  s_cbranch_scc1 ask_9
  v_mov_b32 v250, 1
  v_mov_b32 v251, 588288
  s_mov_b64 exec, 1
  buffer_atomic_add v250, v251, s[8:11], 0 offen sc0
  s_mov_b64 exec, -1
ask_9:
  s_branch wk_next
wk_loop:
  s_waitcnt vmcnt(0) lgkmcnt(0)
wk_ask:
  v_readfirstlane_b32 s22, v250
  s_cmp_ge_u32 s22, 1264
  s_cbranch_scc1 wk_next
  s_cmp_lg_u32 s16, 0
  s_cbranch_scc1 ask_10
  v_mov_b32 v250, 1
  v_mov_b32 v251, 588288
  s_mov_b64 exec, 1
  buffer_atomic_add v250, v251, s[8:11], 0 offen sc0
  s_mov_b64 exec, -1
ask_10:
wk_next:
  v_mov_b32 v6, 160000
  s_waitcnt vmcnt(0)
  s_barrier
  s_cmp_lg_u32 s16, 0
  s_cbranch_scc1 wk_n1
  s_mov_b64 exec, 1
  ds_write_b32 v6, v250
  s_mov_b64 exec, -1
  s_waitcnt lgkmcnt(0)
wk_n1:
  s_barrier
  ds_read_b32 v4, v6
  s_waitcnt lgkmcnt(0)
  v_readfirstlane_b32 s3, v4
  s_cmp_ge_u32 s3, 1264
  s_cbranch_scc1 wk_done
  v_mov_b32 v250, 0
  v_mov_b32 v251, 588288
  v_and_b32 v1, 63, v0
  v_lshlrev_b32 v2, 4, v1
  v_lshrrev_b32 v3, 4, v1
  v_and_b32 v4, 15, v1
  s_cmp_lt_u32 s3, 112
  s_cbranch_scc1 wk_n2
  s_cmp_eq_u32 s97, 0
  s_cbranch_scc1 wk_n2
  v_mov_b32 v250, s3
  s_mov_b32 s96, 1
  s_mov_b32 s97, 1
  s_mov_b32 s39, 0
  s_mov_b32 s37, 0
  s_mov_b32 s38, 0
  s_mov_b32 s32, 0
  s_branch wp_all
wk_n2:
  s_cmp_ge_u32 s3, 752
  s_cbranch_scc1 wk_tok
  s_cmp_ge_u32 s3, 640
  s_cbranch_scc1 wk_s4d
  s_cmp_ge_u32 s3, 448
  s_cbranch_scc1 wk_full
  s_cmp_ge_u32 s3, 320
  s_cbranch_scc1 wk_adef
  s_cmp_ge_u32 s3, 288
  s_cbranch_scc1 wk_srv
  s_and_b32 s17, s3, 15
  s_add_u32 s17, s17, 16
  s_cmp_ge_u32 s3, 224
  s_cbranch_scc1 wk_half
  s_cmp_ge_u32 s3, 112
  s_cselect_b32 s18, 1, 0
  s_cselect_b32 s20, 112, 0
  s_sub_u32 s34, s3, s20
  s_lshr_b32 s34, s34, 4
  s_lshl_b32 s34, s34, 1
  s_add_u32 s35, s34, 2
  s_branch wk_gemm
wk_adef:
  s_mov_b32 s101, -1
  s_load_dwordx8 s[40:47], s[0:1], 72
  s_sub_u32 s20, s3, 320
  s_getreg_b32 s33, hwreg(HW_REG_XCC_ID)
  s_sub_u32 s33, s33, 2
  s_and_b32 s33, s33, 7
  s_min_u32 s33, s33, 7
  s_mov_b32 s35, 7
wk_adc:
  s_lshl_b32 s34, s33, 7
  s_add_u32 s34, s34, 589312
  v_mov_b32 v4, 1
  v_mov_b32 v5, s34
  v_mov_b32 v6, 160000
  s_barrier
  s_cmp_lg_u32 s16, 0
  s_cbranch_scc1 wk_ade1
  s_mov_b64 exec, 1
  buffer_atomic_add v4, v5, s[8:11], 0 offen sc0
  s_waitcnt vmcnt(0)
  ds_write_b32 v6, v4
  s_waitcnt lgkmcnt(0)
  s_mov_b64 exec, -1
wk_ade1:
  s_barrier
  ds_read_b32 v4, v6
  s_waitcnt lgkmcnt(0)
  v_readfirstlane_b32 s20, v4
  s_cmp_lt_u32 s20, 16
  s_cbranch_scc1 wk_adg
  s_mov_b32 s33, s35
  s_sub_u32 s35, s35, 1
  s_max_i32 s35, s35, 0
  s_branch wk_adc
wk_adg:
  s_lshl_b32 s33, s33, 4
  s_add_u32 s20, s20, s33
  v_and_b32 v1, 63, v0
  v_lshlrev_b32 v2, 4, v1
  v_lshrrev_b32 v3, 4, v1
  v_and_b32 v4, 15, v1
  s_lshr_b32 s33, s20, 2
  s_mul_i32 s33, s33, 7
  s_and_b32 s20, s20, 3
  s_add_u32 s33, s33, s20
  s_mov_b32 s97, 3
  v_mov_b32 v252, 0x40000000
  v_cmp_eq_u32 vcc, 0, v0
  s_nop 1
  v_cndmask_b32 v252, v252, v0, vcc
  v_lshrrev_b32 v5, 5, v1
  v_and_b32 v6, 31, v1
  v_xor_b32 v8, v6, v5
  v_lshlrev_b32 v8, 4, v8
  v_lshl_add_u32 v16, v5, 13, v8
  v_xor_b32 v17, 32, v16
  v_xor_b32 v18, 64, v16
  v_xor_b32 v19, 96, v16
  v_xor_b32 v20, 128, v16
  v_xor_b32 v21, 160, v16
  v_xor_b32 v22, 192, v16
  v_xor_b32 v23, 224, v16
  s_lshl_b32 s20, s16, 6
  v_xor_b32 v26, s20, v16
  v_xor_b32 v27, 32, v26
  s_mul_i32 s17, s33, 4682
  s_lshr_b32 s17, s17, 16
  s_mul_i32 s23, s17, 14
  s_sub_u32 s19, s33, s23
  s_cmp_lt_u32 s19, 7
  s_cselect_b32 s18, 0, 7
  s_cselect_b32 s28, 0, 8
  s_sub_u32 s18, s19, s18
  s_add_u32 s28, s28, s16
  s_lshl_b32 s25, s16, 15
  s_add_u32 s25, s25, 32768
  s_lshl_b32 s26, s17, 9
  s_waitcnt lgkmcnt(0)
  s_barrier
  s_branch wp_A0
wk_adone:
  s_mov_b32 s97, 0
  s_branch wk_loop
wk_half:
  s_sub_u32 s20, s3, 224
  s_lshr_b32 s18, s20, 5
  s_add_u32 s18, s18, 2
  s_bitcmp1_b32 s20, 4
  s_cselect_b32 s34, 7, 0
  s_add_u32 s35, s34, 7
  s_branch wk_gemm
wk_full:
  s_sub_u32 s20, s3, 384
  s_and_b32 s17, s20, 15
  s_lshr_b32 s18, s20, 4
  s_mov_b32 s34, 0
  s_mov_b32 s35, 14
  s_cmp_lt_u32 s18, 8
  s_cselect_b32 s21, 16, 0
  s_add_u32 s17, s17, s21
  s_and_b32 s18, s18, 7
  s_cmp_ge_u32 s17, 16
  s_cbranch_scc1 wk_gemm
  s_load_dwordx8 s[40:47], s[0:1], 0
  s_load_dwordx2 s[48:49], s[0:1], 32
  s_sub_u32 s21, s3, 512
  v_min_u32 v12, 111, v0
  v_lshlrev_b32 v12, 7, v12
  v_min_u32 v13, 13, v0
  v_lshlrev_b32 v13, 7, v13
  s_mul_i32 s22, s21, 14336
  s_mul_i32 s21, s21, 1792
  s_waitcnt lgkmcnt(0)
  s_cmp_ge_u32 s16, 2
  s_cbranch_scc1 wk_up
  s_mov_b32 s60, s40
  s_and_b32 s61, s41, 0xffff
  s_mov_b32 s62, 1835008
  s_mov_b32 s63, 0x20000
  buffer_load_dword v14, v12, s[60:63], s22 offen
  s_mov_b32 s60, s42
  s_and_b32 s61, s43, 0xffff
  s_mov_b32 s62, 229376
  s_mov_b32 s63, 0x20000
  buffer_load_dword v14, v13, s[60:63], s21 offen
  s_mov_b32 s60, s44
  s_and_b32 s61, s45, 0xffff
  s_mov_b32 s62, 229376
  s_mov_b32 s63, 0x20000
  buffer_load_dword v14, v13, s[60:63], s21 offen
  s_mov_b32 s60, s46
  s_and_b32 s61, s47, 0xffff
  s_mov_b32 s62, 229376
  s_mov_b32 s63, 0x20000
  buffer_load_dword v14, v13, s[60:63], s21 offen
  s_mov_b32 s60, s48
  s_and_b32 s61, s49, 0xffff
  s_mov_b32 s62, 229376
  s_mov_b32 s63, 0x20000
  buffer_load_dword v14, v13, s[60:63], s21 offen
wk_up:
  s_lshl_b32 s27, s17, 7
  s_add_u32 s27, s27, 584192
  s_mov_b32 s28, 16383
  s_mov_b32 s30, 0
wk_aw:
  buffer_load_dword v9, off, s[8:11], s27  sc1
  s_waitcnt vmcnt(0)
  v_and_b32 v10, s28, v9
  v_cmp_ne_u32 vcc, s28, v10
  s_cbranch_vccz wk_aw_ok
  s_sleep 3
  s_add_u32 s30, s30, 1
  s_cmp_lt_u32 s30, 400000
  s_cbranch_scc1 wk_aw
  s_branch cA_abort
wk_aw_ok:
wk_gemm:
  s_lshl_b32 s20, s18, 4
  s_lshr_b32 s21, s2, 3
  s_add_u32 s21, s21, s16
  s_and_b32 s21, s21, 3
  s_lshl_b32 s21, s21, 2
  s_add_u32 s20, s20, s21
  s_mul_i32 s21, s20, 14336
  s_add_u32 s21, s21, 655360
  s_mul_i32 s23, s17, 401408
  s_and_b32 s22, s16, 1
  s_mul_i32 s22, s22, 7168
  s_add_u32 s23, s23, s22
  s_add_u32 s23, s23, 33554432
  s_lshr_b32 s22, s16, 1
  s_mul_i32 s22, s22, 14336
  s_add_u32 s23, s23, s22
  s_mul_i32 s27, s16, 7168
  s_lshr_b32 s28, s20, 1
  s_cmp_lt_u32 s17, 16
  s_cbranch_scc0 wg_vo
  s_add_u32 s23, s23, s22
  s_lshl_b32 s29, s28, 4
  s_add_u32 s29, s29, s17
  s_mul_i32 s29, s29, 28672
  s_add_u32 s29, s29, 46399488
  s_mov_b32 s31, 0
  s_lshr_b32 s24, s34, 1
  s_lshl_b32 s24, s24, 2
  s_and_b32 s25, s34, 1
  s_add_u32 s24, s24, s25
  s_mul_i32 s24, s24, 14336
  s_add_u32 s24, s24, s23
  s_add_u32 m0, s31, s27
  s_nop 0
  buffer_load_dwordx4 v2, s[8:11], s24 offen offset:0 sc1 lds
  buffer_load_dwordx4 v2, s[8:11], s24 offen offset:1024 sc1 lds
  buffer_load_dwordx4 v2, s[8:11], s24 offen offset:2048 sc1 lds
  buffer_load_dwordx4 v2, s[8:11], s24 offen offset:3072 sc1 lds
  s_add_u32 m0, m0, 4096
  s_add_u32 s24, s24, 4096
  buffer_load_dwordx4 v2, s[8:11], s24 offen offset:0 sc1 lds
  buffer_load_dwordx4 v2, s[8:11], s24 offen offset:1024 sc1 lds
  buffer_load_dwordx4 v2, s[8:11], s24 offen offset:2048 sc1 lds
  s_sub_u32 s36, s35, 1
  s_add_u32 s30, s34, 1
  s_min_u32 s30, s30, s36
  s_mov_b32 s31, 28672
  s_lshr_b32 s24, s30, 1
  s_lshl_b32 s24, s24, 2
  s_and_b32 s25, s30, 1
  s_add_u32 s24, s24, s25
  s_mul_i32 s24, s24, 14336
  s_add_u32 s24, s24, s23
  s_add_u32 m0, s31, s27
  s_nop 0
  buffer_load_dwordx4 v2, s[8:11], s24 offen offset:0 sc1 lds
  buffer_load_dwordx4 v2, s[8:11], s24 offen offset:1024 sc1 lds
  buffer_load_dwordx4 v2, s[8:11], s24 offen offset:2048 sc1 lds
  buffer_load_dwordx4 v2, s[8:11], s24 offen offset:3072 sc1 lds
  s_add_u32 m0, m0, 4096
  s_add_u32 s24, s24, 4096
  buffer_load_dwordx4 v2, s[8:11], s24 offen offset:0 sc1 lds
  buffer_load_dwordx4 v2, s[8:11], s24 offen offset:1024 sc1 lds
  buffer_load_dwordx4 v2, s[8:11], s24 offen offset:2048 sc1 lds
  s_mov_b32 s19, s34
  s_mov_b32 s32, 0
  s_mov_b32 s33, 57344
  s_cmp_eq_u32 s18, s101
  s_cbranch_scc1 wg_f_hx
  s_add_u32 s22, s21, 0
  buffer_load_dwordx4 a[0:3], v2, s[8:11], s22 offen offset:0 sc1
  buffer_load_dwordx4 a[4:7], v2, s[8:11], s22 offen offset:1024 sc1
  buffer_load_dwordx4 a[8:11], v2, s[8:11], s22 offen offset:2048 sc1
  buffer_load_dwordx4 a[12:15], v2, s[8:11], s22 offen offset:3072 sc1
  s_add_u32 s22, s21, 4096
  buffer_load_dwordx4 a[16:19], v2, s[8:11], s22 offen offset:0 sc1
  buffer_load_dwordx4 a[20:23], v2, s[8:11], s22 offen offset:1024 sc1
  buffer_load_dwordx4 a[24:27], v2, s[8:11], s22 offen offset:2048 sc1
  buffer_load_dwordx4 a[28:31], v2, s[8:11], s22 offen offset:3072 sc1
  s_add_u32 s22, s21, 8192
  buffer_load_dwordx4 a[32:35], v2, s[8:11], s22 offen offset:0 sc1
  buffer_load_dwordx4 a[36:39], v2, s[8:11], s22 offen offset:1024 sc1
  buffer_load_dwordx4 a[40:43], v2, s[8:11], s22 offen offset:2048 sc1
  buffer_load_dwordx4 a[44:47], v2, s[8:11], s22 offen offset:3072 sc1
  s_add_u32 s22, s21, 12288
  buffer_load_dwordx4 a[48:51], v2, s[8:11], s22 offen offset:0 sc1
  buffer_load_dwordx4 a[52:55], v2, s[8:11], s22 offen offset:1024 sc1
  buffer_load_dwordx4 a[56:59], v2, s[8:11], s22 offen offset:2048 sc1
  buffer_load_dwordx4 a[60:63], v2, s[8:11], s22 offen offset:3072 sc1
  s_add_u32 s22, s21, 16384
  buffer_load_dwordx4 a[64:67], v2, s[8:11], s22 offen offset:0 sc1
  buffer_load_dwordx4 a[68:71], v2, s[8:11], s22 offen offset:1024 sc1
  buffer_load_dwordx4 a[72:75], v2, s[8:11], s22 offen offset:2048 sc1
  buffer_load_dwordx4 a[76:79], v2, s[8:11], s22 offen offset:3072 sc1
  s_add_u32 s22, s21, 20480
  buffer_load_dwordx4 a[80:83], v2, s[8:11], s22 offen offset:0 sc1
  buffer_load_dwordx4 a[84:87], v2, s[8:11], s22 offen offset:1024 sc1
  buffer_load_dwordx4 a[88:91], v2, s[8:11], s22 offen offset:2048 sc1
  buffer_load_dwordx4 a[92:95], v2, s[8:11], s22 offen offset:3072 sc1
  s_add_u32 s22, s21, 24576
  buffer_load_dwordx4 a[96:99], v2, s[8:11], s22 offen offset:0 sc1
  buffer_load_dwordx4 a[100:103], v2, s[8:11], s22 offen offset:1024 sc1
  buffer_load_dwordx4 a[104:107], v2, s[8:11], s22 offen offset:2048 sc1
  buffer_load_dwordx4 a[108:111], v2, s[8:11], s22 offen offset:3072 sc1
  s_add_u32 s22, s21, 28672
  buffer_load_dwordx4 a[112:115], v2, s[8:11], s22 offen offset:0 sc1
  buffer_load_dwordx4 a[116:119], v2, s[8:11], s22 offen offset:1024 sc1
  buffer_load_dwordx4 a[120:123], v2, s[8:11], s22 offen offset:2048 sc1
  buffer_load_dwordx4 a[124:127], v2, s[8:11], s22 offen offset:3072 sc1
  s_add_u32 s22, s21, 32768
  buffer_load_dwordx4 a[128:131], v2, s[8:11], s22 offen offset:0 sc1
  buffer_load_dwordx4 a[132:135], v2, s[8:11], s22 offen offset:1024 sc1
  buffer_load_dwordx4 a[136:139], v2, s[8:11], s22 offen offset:2048 sc1
  buffer_load_dwordx4 a[140:143], v2, s[8:11], s22 offen offset:3072 sc1
  s_add_u32 s22, s21, 36864
  buffer_load_dwordx4 a[144:147], v2, s[8:11], s22 offen offset:0 sc1
  buffer_load_dwordx4 a[148:151], v2, s[8:11], s22 offen offset:1024 sc1
  buffer_load_dwordx4 a[152:155], v2, s[8:11], s22 offen offset:2048 sc1
  buffer_load_dwordx4 a[156:159], v2, s[8:11], s22 offen offset:3072 sc1
  s_add_u32 s22, s21, 40960
  s_waitcnt vmcnt(40)
  buffer_load_dwordx4 a[160:163], v2, s[8:11], s22 offen offset:0 sc1
  buffer_load_dwordx4 a[164:167], v2, s[8:11], s22 offen offset:1024 sc1
  buffer_load_dwordx4 a[168:171], v2, s[8:11], s22 offen offset:2048 sc1
  buffer_load_dwordx4 a[172:175], v2, s[8:11], s22 offen offset:3072 sc1
  s_add_u32 s22, s21, 45056
  buffer_load_dwordx4 a[176:179], v2, s[8:11], s22 offen offset:0 sc1
  buffer_load_dwordx4 a[180:183], v2, s[8:11], s22 offen offset:1024 sc1
  buffer_load_dwordx4 a[184:187], v2, s[8:11], s22 offen offset:2048 sc1
  buffer_load_dwordx4 a[188:191], v2, s[8:11], s22 offen offset:3072 sc1
  s_add_u32 s22, s21, 49152
  buffer_load_dwordx4 a[192:195], v2, s[8:11], s22 offen offset:0 sc1
  buffer_load_dwordx4 a[196:199], v2, s[8:11], s22 offen offset:1024 sc1
  buffer_load_dwordx4 a[200:203], v2, s[8:11], s22 offen offset:2048 sc1
  buffer_load_dwordx4 a[204:207], v2, s[8:11], s22 offen offset:3072 sc1
  s_add_u32 s22, s21, 53248
  buffer_load_dwordx4 a[208:211], v2, s[8:11], s22 offen offset:0 sc1
  buffer_load_dwordx4 a[212:215], v2, s[8:11], s22 offen offset:1024 sc1
  buffer_load_dwordx4 a[216:219], v2, s[8:11], s22 offen offset:2048 sc1
  buffer_load_dwordx4 a[220:223], v2, s[8:11], s22 offen offset:3072 sc1
wg_f_hx:
  s_mov_b32 s101, -1
  s_waitcnt vmcnt(0)
  s_barrier
  s_mov_b32 s40, 0
  s_mov_b32 s41, 0x40000000
  v_mov_b32 v5, v2
  ds_read_b128 v[8:11], v5 offset:0
  ds_read_b128 v[12:15], v5 offset:14336
  ds_read_b128 v[16:19], v5 offset:1024
  ds_read_b128 v[20:23], v5 offset:15360
  ds_read_b128 v[24:27], v5 offset:2048
  s_waitcnt lgkmcnt(4)
.p2align 6
wg_f_loop:
  v_mfma_f32_16x16x32_bf16 v[40:43], v[8:11], a[0:3], 0
  ds_read_b128 v[28:31], v5 offset:16384
  v_mfma_f32_16x16x32_bf16 v[44:47], v[8:11], a[56:59], 0
  v_mfma_f32_16x16x32_bf16 v[48:51], v[8:11], a[112:115], 0
  v_mfma_f32_16x16x32_bf16 v[52:55], v[8:11], a[168:171], 0
  s_waitcnt lgkmcnt(4)
  s_lshl_b32 s42, s40, 10
  v_mfma_f32_16x16x32_bf16 v[56:59], v[12:15], a[0:3], 0
  ds_read_b128 v[32:35], v5 offset:3072
  v_mfma_f32_16x16x32_bf16 v[60:63], v[12:15], a[56:59], 0
  s_add_u32 s42, s42, s41
  v_cvt_pk_bf16_f32 v72, v96, v97
  v_mfma_f32_16x16x32_bf16 v[64:67], v[12:15], a[112:115], 0
  v_cvt_pk_bf16_f32 v73, v98, v99
  v_cvt_pk_bf16_f32 v74, v112, v113
  v_mfma_f32_16x16x32_bf16 v[68:71], v[12:15], a[168:171], 0
  s_waitcnt lgkmcnt(4)
  v_cvt_pk_bf16_f32 v75, v114, v115
  v_mfma_f32_16x16x32_bf16 v[40:43], v[16:19], a[4:7], v[40:43]
  ds_read_b128 v[8:11], v5 offset:17408
  v_mfma_f32_16x16x32_bf16 v[44:47], v[16:19], a[60:63], v[44:47]
  s_add_u32 s43, s42, 0
  v_mfma_f32_16x16x32_bf16 v[48:51], v[16:19], a[116:119], v[48:51]
  buffer_store_dwordx4 v[72:75], v2, s[8:11], s43 offen sc1
  v_cvt_pk_bf16_f32 v76, v100, v101
  v_mfma_f32_16x16x32_bf16 v[52:55], v[16:19], a[172:175], v[52:55]
  s_waitcnt lgkmcnt(4)
  v_cvt_pk_bf16_f32 v77, v102, v103
  v_mfma_f32_16x16x32_bf16 v[56:59], v[20:23], a[4:7], v[56:59]
  ds_read_b128 v[12:15], v5 offset:4096
  v_mfma_f32_16x16x32_bf16 v[60:63], v[20:23], a[60:63], v[60:63]
  v_cvt_pk_bf16_f32 v78, v116, v117
  v_cvt_pk_bf16_f32 v79, v118, v119
  v_mfma_f32_16x16x32_bf16 v[64:67], v[20:23], a[116:119], v[64:67]
  s_add_u32 s43, s42, 14336
  v_mfma_f32_16x16x32_bf16 v[68:71], v[20:23], a[172:175], v[68:71]
  s_waitcnt lgkmcnt(4)
  buffer_store_dwordx4 v[76:79], v2, s[8:11], s43 offen sc1
  v_mfma_f32_16x16x32_bf16 v[40:43], v[24:27], a[8:11], v[40:43]
  ds_read_b128 v[16:19], v5 offset:18432
  v_mfma_f32_16x16x32_bf16 v[44:47], v[24:27], a[64:67], v[44:47]
  v_cvt_pk_bf16_f32 v80, v104, v105
  v_cvt_pk_bf16_f32 v81, v106, v107
  v_mfma_f32_16x16x32_bf16 v[48:51], v[24:27], a[120:123], v[48:51]
  v_cvt_pk_bf16_f32 v82, v120, v121
  v_cvt_pk_bf16_f32 v83, v122, v123
  v_mfma_f32_16x16x32_bf16 v[52:55], v[24:27], a[176:179], v[52:55]
  s_waitcnt lgkmcnt(4)
  s_add_u32 s43, s42, 458752
  v_mfma_f32_16x16x32_bf16 v[56:59], v[28:31], a[8:11], v[56:59]
  ds_read_b128 v[20:23], v5 offset:5120
  v_mfma_f32_16x16x32_bf16 v[60:63], v[28:31], a[64:67], v[60:63]
  buffer_store_dwordx4 v[80:83], v2, s[8:11], s43 offen sc1
  v_cvt_pk_bf16_f32 v84, v108, v109
  v_mfma_f32_16x16x32_bf16 v[64:67], v[28:31], a[120:123], v[64:67]
  v_cvt_pk_bf16_f32 v85, v110, v111
  v_cvt_pk_bf16_f32 v86, v124, v125
  v_mfma_f32_16x16x32_bf16 v[68:71], v[28:31], a[176:179], v[68:71]
  s_waitcnt lgkmcnt(4)
  v_cvt_pk_bf16_f32 v87, v126, v127
  v_mfma_f32_16x16x32_bf16 v[40:43], v[32:35], a[12:15], v[40:43]
  ds_read_b128 v[24:27], v5 offset:19456
  v_mfma_f32_16x16x32_bf16 v[44:47], v[32:35], a[68:71], v[44:47]
  s_add_u32 s43, s42, 473088
  v_mfma_f32_16x16x32_bf16 v[48:51], v[32:35], a[124:127], v[48:51]
  buffer_store_dwordx4 v[84:87], v2, s[8:11], s43 offen sc1
  v_mfma_f32_16x16x32_bf16 v[52:55], v[32:35], a[180:183], v[52:55]
  s_waitcnt lgkmcnt(4)
  s_add_u32 s30, s19, 2
  s_lshr_b32 s24, s30, 1
  s_lshl_b32 s24, s24, 2
  s_and_b32 s25, s30, 1
  s_add_u32 s24, s24, s25
  s_mul_i32 s24, s24, 14336
  v_mfma_f32_16x16x32_bf16 v[56:59], v[8:11], a[12:15], v[56:59]
  ds_read_b128 v[28:31], v5 offset:6144
  v_mfma_f32_16x16x32_bf16 v[60:63], v[8:11], a[68:71], v[60:63]
  s_add_u32 s24, s24, s23
  s_cmp_lt_u32 s30, s35
  s_cselect_b32 s24, s24, 0x40000000
  v_mfma_f32_16x16x32_bf16 v[64:67], v[8:11], a[124:127], v[64:67]
  s_add_u32 m0, s33, s27
  s_nop 0
  buffer_load_dwordx4 v2, s[8:11], s24 offen offset:0 sc1 lds
  v_mfma_f32_16x16x32_bf16 v[68:71], v[8:11], a[180:183], v[68:71]
  s_waitcnt lgkmcnt(4)
  v_mfma_f32_16x16x32_bf16 v[40:43], v[12:15], a[16:19], v[40:43]
  ds_read_b128 v[32:35], v5 offset:20480
  v_mfma_f32_16x16x32_bf16 v[44:47], v[12:15], a[72:75], v[44:47]
  v_mfma_f32_16x16x32_bf16 v[48:51], v[12:15], a[128:131], v[48:51]
  v_mfma_f32_16x16x32_bf16 v[52:55], v[12:15], a[184:187], v[52:55]
  s_waitcnt lgkmcnt(4)
  buffer_load_dwordx4 v2, s[8:11], s24 offen offset:1024 sc1 lds
  v_mfma_f32_16x16x32_bf16 v[56:59], v[16:19], a[16:19], v[56:59]
  ds_read_b128 v[8:11], v5 offset:7168
  v_mfma_f32_16x16x32_bf16 v[60:63], v[16:19], a[72:75], v[60:63]
  v_mfma_f32_16x16x32_bf16 v[64:67], v[16:19], a[128:131], v[64:67]
  v_mfma_f32_16x16x32_bf16 v[68:71], v[16:19], a[184:187], v[68:71]
  s_waitcnt lgkmcnt(4)
  v_mfma_f32_16x16x32_bf16 v[40:43], v[20:23], a[20:23], v[40:43]
  ds_read_b128 v[12:15], v5 offset:21504
  v_mfma_f32_16x16x32_bf16 v[44:47], v[20:23], a[76:79], v[44:47]
  buffer_load_dwordx4 v2, s[8:11], s24 offen offset:2048 sc1 lds
  v_mfma_f32_16x16x32_bf16 v[48:51], v[20:23], a[132:135], v[48:51]
  v_mfma_f32_16x16x32_bf16 v[52:55], v[20:23], a[188:191], v[52:55]
  s_waitcnt lgkmcnt(4)
  v_mfma_f32_16x16x32_bf16 v[56:59], v[24:27], a[20:23], v[56:59]
  ds_read_b128 v[16:19], v5 offset:8192
  v_mfma_f32_16x16x32_bf16 v[60:63], v[24:27], a[76:79], v[60:63]
  v_mfma_f32_16x16x32_bf16 v[64:67], v[24:27], a[132:135], v[64:67]
  buffer_load_dwordx4 v2, s[8:11], s24 offen offset:3072 sc1 lds
  v_mfma_f32_16x16x32_bf16 v[68:71], v[24:27], a[188:191], v[68:71]
  s_waitcnt lgkmcnt(4)
  v_mfma_f32_16x16x32_bf16 v[40:43], v[28:31], a[24:27], v[40:43]
  ds_read_b128 v[20:23], v5 offset:22528
  v_mfma_f32_16x16x32_bf16 v[44:47], v[28:31], a[80:83], v[44:47]
  v_mfma_f32_16x16x32_bf16 v[48:51], v[28:31], a[136:139], v[48:51]
  v_mfma_f32_16x16x32_bf16 v[52:55], v[28:31], a[192:195], v[52:55]
  s_waitcnt lgkmcnt(4)
  s_add_u32 m0, m0, 4096
  s_add_u32 s24, s24, 4096
  buffer_load_dwordx4 v2, s[8:11], s24 offen offset:0 sc1 lds
  v_mfma_f32_16x16x32_bf16 v[56:59], v[32:35], a[24:27], v[56:59]
  ds_read_b128 v[24:27], v5 offset:9216
  v_mfma_f32_16x16x32_bf16 v[60:63], v[32:35], a[80:83], v[60:63]
  v_mfma_f32_16x16x32_bf16 v[64:67], v[32:35], a[136:139], v[64:67]
  v_mfma_f32_16x16x32_bf16 v[68:71], v[32:35], a[192:195], v[68:71]
  s_waitcnt lgkmcnt(4)
  v_mfma_f32_16x16x32_bf16 v[40:43], v[8:11], a[28:31], v[40:43]
  ds_read_b128 v[28:31], v5 offset:23552
  v_mfma_f32_16x16x32_bf16 v[44:47], v[8:11], a[84:87], v[44:47]
  buffer_load_dwordx4 v2, s[8:11], s24 offen offset:1024 sc1 lds
  v_mfma_f32_16x16x32_bf16 v[48:51], v[8:11], a[140:143], v[48:51]
  v_mfma_f32_16x16x32_bf16 v[52:55], v[8:11], a[196:199], v[52:55]
  s_waitcnt lgkmcnt(4)
  v_mfma_f32_16x16x32_bf16 v[56:59], v[12:15], a[28:31], v[56:59]
  ds_read_b128 v[32:35], v5 offset:10240
  v_mfma_f32_16x16x32_bf16 v[60:63], v[12:15], a[84:87], v[60:63]
  v_mfma_f32_16x16x32_bf16 v[64:67], v[12:15], a[140:143], v[64:67]
  buffer_load_dwordx4 v2, s[8:11], s24 offen offset:2048 sc1 lds
  v_mfma_f32_16x16x32_bf16 v[68:71], v[12:15], a[196:199], v[68:71]
  s_waitcnt lgkmcnt(4)
  v_mfma_f32_16x16x32_bf16 v[40:43], v[16:19], a[32:35], v[40:43]
  ds_read_b128 v[8:11], v5 offset:24576
  v_mfma_f32_16x16x32_bf16 v[44:47], v[16:19], a[88:91], v[44:47]
  v_mfma_f32_16x16x32_bf16 v[48:51], v[16:19], a[144:147], v[48:51]
  v_mfma_f32_16x16x32_bf16 v[52:55], v[16:19], a[200:203], v[52:55]
  s_waitcnt lgkmcnt(4)
  s_add_u32 s33, s33, 28672
  s_cmp_eq_u32 s33, 114688
  s_cselect_b32 s33, 0, s33
  v_mfma_f32_16x16x32_bf16 v[56:59], v[20:23], a[32:35], v[56:59]
  ds_read_b128 v[12:15], v5 offset:11264
  v_mfma_f32_16x16x32_bf16 v[60:63], v[20:23], a[88:91], v[60:63]
  s_add_u32 s32, s32, 28672
  s_cmp_eq_u32 s32, 114688
  s_cselect_b32 s32, 0, s32
  v_mfma_f32_16x16x32_bf16 v[64:67], v[20:23], a[144:147], v[64:67]
  v_add_u32 v128, s32, v2
  v_mfma_f32_16x16x32_bf16 v[68:71], v[20:23], a[200:203], v[68:71]
  s_waitcnt lgkmcnt(4)
  v_mfma_f32_16x16x32_bf16 v[40:43], v[24:27], a[36:39], v[40:43]
  ds_read_b128 v[16:19], v5 offset:25600
  v_mfma_f32_16x16x32_bf16 v[44:47], v[24:27], a[92:95], v[44:47]
  v_mfma_f32_16x16x32_bf16 v[48:51], v[24:27], a[148:151], v[48:51]
  v_mfma_f32_16x16x32_bf16 v[52:55], v[24:27], a[204:207], v[52:55]
  s_waitcnt lgkmcnt(4)
  v_mfma_f32_16x16x32_bf16 v[56:59], v[28:31], a[36:39], v[56:59]
  ds_read_b128 v[20:23], v5 offset:12288
  v_mfma_f32_16x16x32_bf16 v[60:63], v[28:31], a[92:95], v[60:63]
  v_mfma_f32_16x16x32_bf16 v[64:67], v[28:31], a[148:151], v[64:67]
  v_mfma_f32_16x16x32_bf16 v[68:71], v[28:31], a[204:207], v[68:71]
  s_waitcnt lgkmcnt(4)
  v_mfma_f32_16x16x32_bf16 v[40:43], v[32:35], a[40:43], v[40:43]
  ds_read_b128 v[24:27], v5 offset:26624
  v_mfma_f32_16x16x32_bf16 v[44:47], v[32:35], a[96:99], v[44:47]
  v_mfma_f32_16x16x32_bf16 v[48:51], v[32:35], a[152:155], v[48:51]
  v_mfma_f32_16x16x32_bf16 v[52:55], v[32:35], a[208:211], v[52:55]
  s_waitcnt lgkmcnt(4)
  v_mfma_f32_16x16x32_bf16 v[56:59], v[8:11], a[40:43], v[56:59]
  ds_read_b128 v[28:31], v5 offset:13312
  v_mfma_f32_16x16x32_bf16 v[60:63], v[8:11], a[96:99], v[60:63]
  v_mfma_f32_16x16x32_bf16 v[64:67], v[8:11], a[152:155], v[64:67]
  v_mfma_f32_16x16x32_bf16 v[68:71], v[8:11], a[208:211], v[68:71]
  s_waitcnt lgkmcnt(4)
  v_mfma_f32_16x16x32_bf16 v[40:43], v[12:15], a[44:47], v[40:43]
  ds_read_b128 v[32:35], v5 offset:27648
  v_mfma_f32_16x16x32_bf16 v[44:47], v[12:15], a[100:103], v[44:47]
  v_mfma_f32_16x16x32_bf16 v[48:51], v[12:15], a[156:159], v[48:51]
  v_mfma_f32_16x16x32_bf16 v[52:55], v[12:15], a[212:215], v[52:55]
  s_waitcnt lgkmcnt(4)
  v_mfma_f32_16x16x32_bf16 v[56:59], v[16:19], a[44:47], v[56:59]
  s_waitcnt vmcnt(11)
  s_barrier
  ds_read_b128 v[8:11], v128 offset:0
  v_mfma_f32_16x16x32_bf16 v[60:63], v[16:19], a[100:103], v[60:63]
  v_mfma_f32_16x16x32_bf16 v[64:67], v[16:19], a[156:159], v[64:67]
  v_mfma_f32_16x16x32_bf16 v[68:71], v[16:19], a[212:215], v[68:71]
  s_waitcnt lgkmcnt(4)
  v_mfma_f32_16x16x32_bf16 v[40:43], v[20:23], a[48:51], v[40:43]
  ds_read_b128 v[12:15], v128 offset:14336
  v_mfma_f32_16x16x32_bf16 v[44:47], v[20:23], a[104:107], v[44:47]
  v_mfma_f32_16x16x32_bf16 v[48:51], v[20:23], a[160:163], v[48:51]
  v_mfma_f32_16x16x32_bf16 v[52:55], v[20:23], a[216:219], v[52:55]
  s_waitcnt lgkmcnt(4)
  v_mfma_f32_16x16x32_bf16 v[56:59], v[24:27], a[48:51], v[56:59]
  ds_read_b128 v[16:19], v128 offset:1024
  v_mfma_f32_16x16x32_bf16 v[60:63], v[24:27], a[104:107], v[60:63]
  v_mfma_f32_16x16x32_bf16 v[64:67], v[24:27], a[160:163], v[64:67]
  v_mfma_f32_16x16x32_bf16 v[68:71], v[24:27], a[216:219], v[68:71]
  s_waitcnt lgkmcnt(4)
  v_mfma_f32_16x16x32_bf16 v[40:43], v[28:31], a[52:55], v[40:43]
  ds_read_b128 v[20:23], v128 offset:15360
  v_mfma_f32_16x16x32_bf16 v[44:47], v[28:31], a[108:111], v[44:47]
  v_mfma_f32_16x16x32_bf16 v[48:51], v[28:31], a[164:167], v[48:51]
  v_mfma_f32_16x16x32_bf16 v[52:55], v[28:31], a[220:223], v[52:55]
  s_waitcnt lgkmcnt(4)
  v_mfma_f32_16x16x32_bf16 v[56:59], v[32:35], a[52:55], v[56:59]
  ds_read_b128 v[24:27], v128 offset:2048
  v_mfma_f32_16x16x32_bf16 v[60:63], v[32:35], a[108:111], v[60:63]
  v_mfma_f32_16x16x32_bf16 v[64:67], v[32:35], a[164:167], v[64:67]
  v_mfma_f32_16x16x32_bf16 v[68:71], v[32:35], a[220:223], v[68:71]
  s_waitcnt lgkmcnt(4)
  s_mov_b32 s40, s19
  s_mov_b32 s41, s29
  s_add_u32 s19, s19, 1
  s_cmp_lt_u32 s19, s35
  s_cbranch_scc0 wg_f_e0
  v_mfma_f32_16x16x32_bf16 v[96:99], v[8:11], a[0:3], 0
  ds_read_b128 v[28:31], v128 offset:16384
  v_mfma_f32_16x16x32_bf16 v[100:103], v[8:11], a[56:59], 0
  v_mfma_f32_16x16x32_bf16 v[104:107], v[8:11], a[112:115], 0
  v_mfma_f32_16x16x32_bf16 v[108:111], v[8:11], a[168:171], 0
  s_waitcnt lgkmcnt(4)
  s_lshl_b32 s42, s40, 10
  v_mfma_f32_16x16x32_bf16 v[112:115], v[12:15], a[0:3], 0
  ds_read_b128 v[32:35], v128 offset:3072
  v_mfma_f32_16x16x32_bf16 v[116:119], v[12:15], a[56:59], 0
  s_add_u32 s42, s42, s41
  v_cvt_pk_bf16_f32 v72, v40, v41
  v_mfma_f32_16x16x32_bf16 v[120:123], v[12:15], a[112:115], 0
  v_cvt_pk_bf16_f32 v73, v42, v43
  v_cvt_pk_bf16_f32 v74, v56, v57
  v_mfma_f32_16x16x32_bf16 v[124:127], v[12:15], a[168:171], 0
  s_waitcnt lgkmcnt(4)
  v_cvt_pk_bf16_f32 v75, v58, v59
  v_mfma_f32_16x16x32_bf16 v[96:99], v[16:19], a[4:7], v[96:99]
  ds_read_b128 v[8:11], v128 offset:17408
  v_mfma_f32_16x16x32_bf16 v[100:103], v[16:19], a[60:63], v[100:103]
  s_add_u32 s43, s42, 0
  v_mfma_f32_16x16x32_bf16 v[104:107], v[16:19], a[116:119], v[104:107]
  buffer_store_dwordx4 v[72:75], v2, s[8:11], s43 offen sc1
  v_cvt_pk_bf16_f32 v76, v44, v45
  v_mfma_f32_16x16x32_bf16 v[108:111], v[16:19], a[172:175], v[108:111]
  s_waitcnt lgkmcnt(4)
  v_cvt_pk_bf16_f32 v77, v46, v47
  v_mfma_f32_16x16x32_bf16 v[112:115], v[20:23], a[4:7], v[112:115]
  ds_read_b128 v[12:15], v128 offset:4096
  v_mfma_f32_16x16x32_bf16 v[116:119], v[20:23], a[60:63], v[116:119]
  v_cvt_pk_bf16_f32 v78, v60, v61
  v_cvt_pk_bf16_f32 v79, v62, v63
  v_mfma_f32_16x16x32_bf16 v[120:123], v[20:23], a[116:119], v[120:123]
  s_add_u32 s43, s42, 14336
  v_mfma_f32_16x16x32_bf16 v[124:127], v[20:23], a[172:175], v[124:127]
  s_waitcnt lgkmcnt(4)
  buffer_store_dwordx4 v[76:79], v2, s[8:11], s43 offen sc1
  v_mfma_f32_16x16x32_bf16 v[96:99], v[24:27], a[8:11], v[96:99]
  ds_read_b128 v[16:19], v128 offset:18432
  v_mfma_f32_16x16x32_bf16 v[100:103], v[24:27], a[64:67], v[100:103]
  v_cvt_pk_bf16_f32 v80, v48, v49
  v_cvt_pk_bf16_f32 v81, v50, v51
  v_mfma_f32_16x16x32_bf16 v[104:107], v[24:27], a[120:123], v[104:107]
  v_cvt_pk_bf16_f32 v82, v64, v65
  v_cvt_pk_bf16_f32 v83, v66, v67
  v_mfma_f32_16x16x32_bf16 v[108:111], v[24:27], a[176:179], v[108:111]
  s_waitcnt lgkmcnt(4)
  s_add_u32 s43, s42, 458752
  v_mfma_f32_16x16x32_bf16 v[112:115], v[28:31], a[8:11], v[112:115]
  ds_read_b128 v[20:23], v128 offset:5120
  v_mfma_f32_16x16x32_bf16 v[116:119], v[28:31], a[64:67], v[116:119]
  buffer_store_dwordx4 v[80:83], v2, s[8:11], s43 offen sc1
  v_cvt_pk_bf16_f32 v84, v52, v53
  v_mfma_f32_16x16x32_bf16 v[120:123], v[28:31], a[120:123], v[120:123]
  v_cvt_pk_bf16_f32 v85, v54, v55
  v_cvt_pk_bf16_f32 v86, v68, v69
  v_mfma_f32_16x16x32_bf16 v[124:127], v[28:31], a[176:179], v[124:127]
  s_waitcnt lgkmcnt(4)
  v_cvt_pk_bf16_f32 v87, v70, v71
  v_mfma_f32_16x16x32_bf16 v[96:99], v[32:35], a[12:15], v[96:99]
  ds_read_b128 v[24:27], v128 offset:19456
  v_mfma_f32_16x16x32_bf16 v[100:103], v[32:35], a[68:71], v[100:103]
  s_add_u32 s43, s42, 473088
  v_mfma_f32_16x16x32_bf16 v[104:107], v[32:35], a[124:127], v[104:107]
  buffer_store_dwordx4 v[84:87], v2, s[8:11], s43 offen sc1
  v_mfma_f32_16x16x32_bf16 v[108:111], v[32:35], a[180:183], v[108:111]
  s_waitcnt lgkmcnt(4)
  s_add_u32 s30, s19, 2
  s_lshr_b32 s24, s30, 1
  s_lshl_b32 s24, s24, 2
  s_and_b32 s25, s30, 1
  s_add_u32 s24, s24, s25
  s_mul_i32 s24, s24, 14336
  v_mfma_f32_16x16x32_bf16 v[112:115], v[8:11], a[12:15], v[112:115]
  ds_read_b128 v[28:31], v128 offset:6144
  v_mfma_f32_16x16x32_bf16 v[116:119], v[8:11], a[68:71], v[116:119]
  s_add_u32 s24, s24, s23
  s_cmp_lt_u32 s30, s35
  s_cselect_b32 s24, s24, 0x40000000
  v_mfma_f32_16x16x32_bf16 v[120:123], v[8:11], a[124:127], v[120:123]
  s_add_u32 m0, s33, s27
  s_nop 0
  buffer_load_dwordx4 v2, s[8:11], s24 offen offset:0 sc1 lds
  v_mfma_f32_16x16x32_bf16 v[124:127], v[8:11], a[180:183], v[124:127]
  s_waitcnt lgkmcnt(4)
  v_mfma_f32_16x16x32_bf16 v[96:99], v[12:15], a[16:19], v[96:99]
  ds_read_b128 v[32:35], v128 offset:20480
  v_mfma_f32_16x16x32_bf16 v[100:103], v[12:15], a[72:75], v[100:103]
  v_mfma_f32_16x16x32_bf16 v[104:107], v[12:15], a[128:131], v[104:107]
  v_mfma_f32_16x16x32_bf16 v[108:111], v[12:15], a[184:187], v[108:111]
  s_waitcnt lgkmcnt(4)
  buffer_load_dwordx4 v2, s[8:11], s24 offen offset:1024 sc1 lds
  v_mfma_f32_16x16x32_bf16 v[112:115], v[16:19], a[16:19], v[112:115]
  ds_read_b128 v[8:11], v128 offset:7168
  v_mfma_f32_16x16x32_bf16 v[116:119], v[16:19], a[72:75], v[116:119]
  v_mfma_f32_16x16x32_bf16 v[120:123], v[16:19], a[128:131], v[120:123]
  v_mfma_f32_16x16x32_bf16 v[124:127], v[16:19], a[184:187], v[124:127]
  s_waitcnt lgkmcnt(4)
  v_mfma_f32_16x16x32_bf16 v[96:99], v[20:23], a[20:23], v[96:99]
  ds_read_b128 v[12:15], v128 offset:21504
  v_mfma_f32_16x16x32_bf16 v[100:103], v[20:23], a[76:79], v[100:103]
  buffer_load_dwordx4 v2, s[8:11], s24 offen offset:2048 sc1 lds
  v_mfma_f32_16x16x32_bf16 v[104:107], v[20:23], a[132:135], v[104:107]
  v_mfma_f32_16x16x32_bf16 v[108:111], v[20:23], a[188:191], v[108:111]
  s_waitcnt lgkmcnt(4)
  v_mfma_f32_16x16x32_bf16 v[112:115], v[24:27], a[20:23], v[112:115]
  ds_read_b128 v[16:19], v128 offset:8192
  v_mfma_f32_16x16x32_bf16 v[116:119], v[24:27], a[76:79], v[116:119]
  v_mfma_f32_16x16x32_bf16 v[120:123], v[24:27], a[132:135], v[120:123]
  buffer_load_dwordx4 v2, s[8:11], s24 offen offset:3072 sc1 lds
  v_mfma_f32_16x16x32_bf16 v[124:127], v[24:27], a[188:191], v[124:127]
  s_waitcnt lgkmcnt(4)
  v_mfma_f32_16x16x32_bf16 v[96:99], v[28:31], a[24:27], v[96:99]
  ds_read_b128 v[20:23], v128 offset:22528
  v_mfma_f32_16x16x32_bf16 v[100:103], v[28:31], a[80:83], v[100:103]
  v_mfma_f32_16x16x32_bf16 v[104:107], v[28:31], a[136:139], v[104:107]
  v_mfma_f32_16x16x32_bf16 v[108:111], v[28:31], a[192:195], v[108:111]
  s_waitcnt lgkmcnt(4)
  s_add_u32 m0, m0, 4096
  s_add_u32 s24, s24, 4096
  buffer_load_dwordx4 v2, s[8:11], s24 offen offset:0 sc1 lds
  v_mfma_f32_16x16x32_bf16 v[112:115], v[32:35], a[24:27], v[112:115]
  ds_read_b128 v[24:27], v128 offset:9216
  v_mfma_f32_16x16x32_bf16 v[116:119], v[32:35], a[80:83], v[116:119]
  v_mfma_f32_16x16x32_bf16 v[120:123], v[32:35], a[136:139], v[120:123]
  v_mfma_f32_16x16x32_bf16 v[124:127], v[32:35], a[192:195], v[124:127]
  s_waitcnt lgkmcnt(4)
  v_mfma_f32_16x16x32_bf16 v[96:99], v[8:11], a[28:31], v[96:99]
  ds_read_b128 v[28:31], v128 offset:23552
  v_mfma_f32_16x16x32_bf16 v[100:103], v[8:11], a[84:87], v[100:103]
  buffer_load_dwordx4 v2, s[8:11], s24 offen offset:1024 sc1 lds
  v_mfma_f32_16x16x32_bf16 v[104:107], v[8:11], a[140:143], v[104:107]
  v_mfma_f32_16x16x32_bf16 v[108:111], v[8:11], a[196:199], v[108:111]
  s_waitcnt lgkmcnt(4)
  v_mfma_f32_16x16x32_bf16 v[112:115], v[12:15], a[28:31], v[112:115]
  ds_read_b128 v[32:35], v128 offset:10240
  v_mfma_f32_16x16x32_bf16 v[116:119], v[12:15], a[84:87], v[116:119]
  v_mfma_f32_16x16x32_bf16 v[120:123], v[12:15], a[140:143], v[120:123]
  buffer_load_dwordx4 v2, s[8:11], s24 offen offset:2048 sc1 lds
  v_mfma_f32_16x16x32_bf16 v[124:127], v[12:15], a[196:199], v[124:127]
  s_waitcnt lgkmcnt(4)
  v_mfma_f32_16x16x32_bf16 v[96:99], v[16:19], a[32:35], v[96:99]
  ds_read_b128 v[8:11], v128 offset:24576
  v_mfma_f32_16x16x32_bf16 v[100:103], v[16:19], a[88:91], v[100:103]
  v_mfma_f32_16x16x32_bf16 v[104:107], v[16:19], a[144:147], v[104:107]
  v_mfma_f32_16x16x32_bf16 v[108:111], v[16:19], a[200:203], v[108:111]
  s_waitcnt lgkmcnt(4)
  s_add_u32 s33, s33, 28672
  s_cmp_eq_u32 s33, 114688
  s_cselect_b32 s33, 0, s33
  v_mfma_f32_16x16x32_bf16 v[112:115], v[20:23], a[32:35], v[112:115]
  ds_read_b128 v[12:15], v128 offset:11264
  v_mfma_f32_16x16x32_bf16 v[116:119], v[20:23], a[88:91], v[116:119]
  s_add_u32 s32, s32, 28672
  s_cmp_eq_u32 s32, 114688
  s_cselect_b32 s32, 0, s32
  v_mfma_f32_16x16x32_bf16 v[120:123], v[20:23], a[144:147], v[120:123]
  v_add_u32 v5, s32, v2
  v_mfma_f32_16x16x32_bf16 v[124:127], v[20:23], a[200:203], v[124:127]
  s_waitcnt lgkmcnt(4)
  v_mfma_f32_16x16x32_bf16 v[96:99], v[24:27], a[36:39], v[96:99]
  ds_read_b128 v[16:19], v128 offset:25600
  v_mfma_f32_16x16x32_bf16 v[100:103], v[24:27], a[92:95], v[100:103]
  v_mfma_f32_16x16x32_bf16 v[104:107], v[24:27], a[148:151], v[104:107]
  v_mfma_f32_16x16x32_bf16 v[108:111], v[24:27], a[204:207], v[108:111]
  s_waitcnt lgkmcnt(4)
  v_mfma_f32_16x16x32_bf16 v[112:115], v[28:31], a[36:39], v[112:115]
  ds_read_b128 v[20:23], v128 offset:12288
  v_mfma_f32_16x16x32_bf16 v[116:119], v[28:31], a[92:95], v[116:119]
  v_mfma_f32_16x16x32_bf16 v[120:123], v[28:31], a[148:151], v[120:123]
  v_mfma_f32_16x16x32_bf16 v[124:127], v[28:31], a[204:207], v[124:127]
  s_waitcnt lgkmcnt(4)
  v_mfma_f32_16x16x32_bf16 v[96:99], v[32:35], a[40:43], v[96:99]
  ds_read_b128 v[24:27], v128 offset:26624
  v_mfma_f32_16x16x32_bf16 v[100:103], v[32:35], a[96:99], v[100:103]
  v_mfma_f32_16x16x32_bf16 v[104:107], v[32:35], a[152:155], v[104:107]
  v_mfma_f32_16x16x32_bf16 v[108:111], v[32:35], a[208:211], v[108:111]
  s_waitcnt lgkmcnt(4)
  v_mfma_f32_16x16x32_bf16 v[112:115], v[8:11], a[40:43], v[112:115]
  ds_read_b128 v[28:31], v128 offset:13312
  v_mfma_f32_16x16x32_bf16 v[116:119], v[8:11], a[96:99], v[116:119]
  v_mfma_f32_16x16x32_bf16 v[120:123], v[8:11], a[152:155], v[120:123]
  v_mfma_f32_16x16x32_bf16 v[124:127], v[8:11], a[208:211], v[124:127]
  s_waitcnt lgkmcnt(4)
  v_mfma_f32_16x16x32_bf16 v[96:99], v[12:15], a[44:47], v[96:99]
  ds_read_b128 v[32:35], v128 offset:27648
  v_mfma_f32_16x16x32_bf16 v[100:103], v[12:15], a[100:103], v[100:103]
  v_mfma_f32_16x16x32_bf16 v[104:107], v[12:15], a[156:159], v[104:107]
  v_mfma_f32_16x16x32_bf16 v[108:111], v[12:15], a[212:215], v[108:111]
  s_waitcnt lgkmcnt(4)
  v_mfma_f32_16x16x32_bf16 v[112:115], v[16:19], a[44:47], v[112:115]
  s_waitcnt vmcnt(11)
  s_barrier
  ds_read_b128 v[8:11], v5 offset:0
  v_mfma_f32_16x16x32_bf16 v[116:119], v[16:19], a[100:103], v[116:119]
  v_mfma_f32_16x16x32_bf16 v[120:123], v[16:19], a[156:159], v[120:123]
  v_mfma_f32_16x16x32_bf16 v[124:127], v[16:19], a[212:215], v[124:127]
  s_waitcnt lgkmcnt(4)
  v_mfma_f32_16x16x32_bf16 v[96:99], v[20:23], a[48:51], v[96:99]
  ds_read_b128 v[12:15], v5 offset:14336
  v_mfma_f32_16x16x32_bf16 v[100:103], v[20:23], a[104:107], v[100:103]
  v_mfma_f32_16x16x32_bf16 v[104:107], v[20:23], a[160:163], v[104:107]
  v_mfma_f32_16x16x32_bf16 v[108:111], v[20:23], a[216:219], v[108:111]
  s_waitcnt lgkmcnt(4)
  v_mfma_f32_16x16x32_bf16 v[112:115], v[24:27], a[48:51], v[112:115]
  ds_read_b128 v[16:19], v5 offset:1024
  v_mfma_f32_16x16x32_bf16 v[116:119], v[24:27], a[104:107], v[116:119]
  v_mfma_f32_16x16x32_bf16 v[120:123], v[24:27], a[160:163], v[120:123]
  v_mfma_f32_16x16x32_bf16 v[124:127], v[24:27], a[216:219], v[124:127]
  s_waitcnt lgkmcnt(4)
  v_mfma_f32_16x16x32_bf16 v[96:99], v[28:31], a[52:55], v[96:99]
  ds_read_b128 v[20:23], v5 offset:15360
  v_mfma_f32_16x16x32_bf16 v[100:103], v[28:31], a[108:111], v[100:103]
  v_mfma_f32_16x16x32_bf16 v[104:107], v[28:31], a[164:167], v[104:107]
  v_mfma_f32_16x16x32_bf16 v[108:111], v[28:31], a[220:223], v[108:111]
  s_waitcnt lgkmcnt(4)
  v_mfma_f32_16x16x32_bf16 v[112:115], v[32:35], a[52:55], v[112:115]
  ds_read_b128 v[24:27], v5 offset:2048
  v_mfma_f32_16x16x32_bf16 v[116:119], v[32:35], a[108:111], v[116:119]
  v_mfma_f32_16x16x32_bf16 v[120:123], v[32:35], a[164:167], v[120:123]
  v_mfma_f32_16x16x32_bf16 v[124:127], v[32:35], a[220:223], v[124:127]
  s_waitcnt lgkmcnt(4)
  s_mov_b32 s40, s19
  s_mov_b32 s41, s29
  s_add_u32 s19, s19, 1
  s_cmp_lt_u32 s19, s35
  s_cbranch_scc1 wg_f_loop
  s_nop 3
  s_lshl_b32 s42, s40, 10
  s_add_u32 s42, s42, s41
  v_cvt_pk_bf16_f32 v72, v96, v97
  v_cvt_pk_bf16_f32 v73, v98, v99
  v_cvt_pk_bf16_f32 v74, v112, v113
  v_cvt_pk_bf16_f32 v75, v114, v115
  s_add_u32 s43, s42, 0
  buffer_store_dwordx4 v[72:75], v2, s[8:11], s43 offen sc1
  v_cvt_pk_bf16_f32 v76, v100, v101
  v_cvt_pk_bf16_f32 v77, v102, v103
  v_cvt_pk_bf16_f32 v78, v116, v117
  v_cvt_pk_bf16_f32 v79, v118, v119
  s_add_u32 s43, s42, 14336
  buffer_store_dwordx4 v[76:79], v2, s[8:11], s43 offen sc1
  v_cvt_pk_bf16_f32 v80, v104, v105
  v_cvt_pk_bf16_f32 v81, v106, v107
  v_cvt_pk_bf16_f32 v82, v120, v121
  v_cvt_pk_bf16_f32 v83, v122, v123
  s_add_u32 s43, s42, 458752
  buffer_store_dwordx4 v[80:83], v2, s[8:11], s43 offen sc1
  v_cvt_pk_bf16_f32 v84, v108, v109
  v_cvt_pk_bf16_f32 v85, v110, v111
  v_cvt_pk_bf16_f32 v86, v124, v125
  v_cvt_pk_bf16_f32 v87, v126, v127
  s_add_u32 s43, s42, 473088
  buffer_store_dwordx4 v[84:87], v2, s[8:11], s43 offen sc1
  s_branch wg_done
wg_f_e0:
  s_nop 7
  s_lshl_b32 s42, s40, 10
  s_add_u32 s42, s42, s41
  v_cvt_pk_bf16_f32 v72, v40, v41
  v_cvt_pk_bf16_f32 v73, v42, v43
  v_cvt_pk_bf16_f32 v74, v56, v57
  v_cvt_pk_bf16_f32 v75, v58, v59
  s_add_u32 s43, s42, 0
  buffer_store_dwordx4 v[72:75], v2, s[8:11], s43 offen sc1
  v_cvt_pk_bf16_f32 v76, v44, v45
  v_cvt_pk_bf16_f32 v77, v46, v47
  v_cvt_pk_bf16_f32 v78, v60, v61
  v_cvt_pk_bf16_f32 v79, v62, v63
  s_add_u32 s43, s42, 14336
  buffer_store_dwordx4 v[76:79], v2, s[8:11], s43 offen sc1
  v_cvt_pk_bf16_f32 v80, v48, v49
  v_cvt_pk_bf16_f32 v81, v50, v51
  v_cvt_pk_bf16_f32 v82, v64, v65
  v_cvt_pk_bf16_f32 v83, v66, v67
  s_add_u32 s43, s42, 458752
  buffer_store_dwordx4 v[80:83], v2, s[8:11], s43 offen sc1
  v_cvt_pk_bf16_f32 v84, v52, v53
  v_cvt_pk_bf16_f32 v85, v54, v55
  v_cvt_pk_bf16_f32 v86, v68, v69
  v_cvt_pk_bf16_f32 v87, v70, v71
  s_add_u32 s43, s42, 473088
  buffer_store_dwordx4 v[84:87], v2, s[8:11], s43 offen sc1
  s_branch wg_done
wg_vo:
  s_sub_u32 s29, s17, 16
  s_mul_i32 s29, s29, 28672
  s_mul_i32 s24, s28, 458752
  s_add_u32 s29, s29, s24
  s_add_u32 s29, s29, 2490368
  v_lshlrev_b32 v6, 4, v3
  v_mul_u32_u24 v7, 12, v3
  v_add_u32 v7, 48, v7
  s_mov_b32 s31, 0
  s_lshl_b32 s24, s34, 1
  s_mul_i32 s24, s24, 14336
  s_add_u32 s24, s24, s23
  s_add_u32 m0, s31, s27
  s_nop 0
  buffer_load_dwordx4 v2, s[8:11], s24 offen offset:0 sc1 lds
  buffer_load_dwordx4 v2, s[8:11], s24 offen offset:1024 sc1 lds
  buffer_load_dwordx4 v2, s[8:11], s24 offen offset:2048 sc1 lds
  buffer_load_dwordx4 v2, s[8:11], s24 offen offset:3072 sc1 lds
  s_add_u32 m0, m0, 4096
  s_add_u32 s24, s24, 4096
  buffer_load_dwordx4 v2, s[8:11], s24 offen offset:0 sc1 lds
  buffer_load_dwordx4 v2, s[8:11], s24 offen offset:1024 sc1 lds
  buffer_load_dwordx4 v2, s[8:11], s24 offen offset:2048 sc1 lds
  s_sub_u32 s36, s35, 1
  s_add_u32 s30, s34, 1
  s_min_u32 s30, s30, s36
  s_mov_b32 s31, 28672
  s_lshl_b32 s24, s30, 1
  s_mul_i32 s24, s24, 14336
  s_add_u32 s24, s24, s23
  s_add_u32 m0, s31, s27
  s_nop 0
  buffer_load_dwordx4 v2, s[8:11], s24 offen offset:0 sc1 lds
  buffer_load_dwordx4 v2, s[8:11], s24 offen offset:1024 sc1 lds
  buffer_load_dwordx4 v2, s[8:11], s24 offen offset:2048 sc1 lds
  buffer_load_dwordx4 v2, s[8:11], s24 offen offset:3072 sc1 lds
  s_add_u32 m0, m0, 4096
  s_add_u32 s24, s24, 4096
  buffer_load_dwordx4 v2, s[8:11], s24 offen offset:0 sc1 lds
  buffer_load_dwordx4 v2, s[8:11], s24 offen offset:1024 sc1 lds
  buffer_load_dwordx4 v2, s[8:11], s24 offen offset:2048 sc1 lds
  s_mov_b32 s19, s34
  s_mov_b32 s32, 0
  s_mov_b32 s33, 57344
  s_cmp_eq_u32 s18, s101
  s_cbranch_scc1 wg_vo_hx
  s_add_u32 s22, s21, 0
  buffer_load_dwordx4 a[0:3], v2, s[8:11], s22 offen offset:0 sc1
  buffer_load_dwordx4 a[4:7], v2, s[8:11], s22 offen offset:1024 sc1
  buffer_load_dwordx4 a[8:11], v2, s[8:11], s22 offen offset:2048 sc1
  buffer_load_dwordx4 a[12:15], v2, s[8:11], s22 offen offset:3072 sc1
  s_add_u32 s22, s21, 4096
  buffer_load_dwordx4 a[16:19], v2, s[8:11], s22 offen offset:0 sc1
  buffer_load_dwordx4 a[20:23], v2, s[8:11], s22 offen offset:1024 sc1
  buffer_load_dwordx4 a[24:27], v2, s[8:11], s22 offen offset:2048 sc1
  buffer_load_dwordx4 a[28:31], v2, s[8:11], s22 offen offset:3072 sc1
  s_add_u32 s22, s21, 8192
  buffer_load_dwordx4 a[32:35], v2, s[8:11], s22 offen offset:0 sc1
  buffer_load_dwordx4 a[36:39], v2, s[8:11], s22 offen offset:1024 sc1
  buffer_load_dwordx4 a[40:43], v2, s[8:11], s22 offen offset:2048 sc1
  buffer_load_dwordx4 a[44:47], v2, s[8:11], s22 offen offset:3072 sc1
  s_add_u32 s22, s21, 12288
  buffer_load_dwordx4 a[48:51], v2, s[8:11], s22 offen offset:0 sc1
  buffer_load_dwordx4 a[52:55], v2, s[8:11], s22 offen offset:1024 sc1
  buffer_load_dwordx4 a[56:59], v2, s[8:11], s22 offen offset:2048 sc1
  buffer_load_dwordx4 a[60:63], v2, s[8:11], s22 offen offset:3072 sc1
  s_add_u32 s22, s21, 16384
  buffer_load_dwordx4 a[64:67], v2, s[8:11], s22 offen offset:0 sc1
  buffer_load_dwordx4 a[68:71], v2, s[8:11], s22 offen offset:1024 sc1
  buffer_load_dwordx4 a[72:75], v2, s[8:11], s22 offen offset:2048 sc1
  buffer_load_dwordx4 a[76:79], v2, s[8:11], s22 offen offset:3072 sc1
  s_add_u32 s22, s21, 20480
  buffer_load_dwordx4 a[80:83], v2, s[8:11], s22 offen offset:0 sc1
  buffer_load_dwordx4 a[84:87], v2, s[8:11], s22 offen offset:1024 sc1
  buffer_load_dwordx4 a[88:91], v2, s[8:11], s22 offen offset:2048 sc1
  buffer_load_dwordx4 a[92:95], v2, s[8:11], s22 offen offset:3072 sc1
  s_add_u32 s22, s21, 24576
  buffer_load_dwordx4 a[96:99], v2, s[8:11], s22 offen offset:0 sc1
  buffer_load_dwordx4 a[100:103], v2, s[8:11], s22 offen offset:1024 sc1
  buffer_load_dwordx4 a[104:107], v2, s[8:11], s22 offen offset:2048 sc1
  buffer_load_dwordx4 a[108:111], v2, s[8:11], s22 offen offset:3072 sc1
  s_add_u32 s22, s21, 28672
  buffer_load_dwordx4 a[112:115], v2, s[8:11], s22 offen offset:0 sc1
  buffer_load_dwordx4 a[116:119], v2, s[8:11], s22 offen offset:1024 sc1
  buffer_load_dwordx4 a[120:123], v2, s[8:11], s22 offen offset:2048 sc1
  buffer_load_dwordx4 a[124:127], v2, s[8:11], s22 offen offset:3072 sc1
  s_add_u32 s22, s21, 32768
  buffer_load_dwordx4 a[128:131], v2, s[8:11], s22 offen offset:0 sc1
  buffer_load_dwordx4 a[132:135], v2, s[8:11], s22 offen offset:1024 sc1
  buffer_load_dwordx4 a[136:139], v2, s[8:11], s22 offen offset:2048 sc1
  buffer_load_dwordx4 a[140:143], v2, s[8:11], s22 offen offset:3072 sc1
  s_add_u32 s22, s21, 36864
  buffer_load_dwordx4 a[144:147], v2, s[8:11], s22 offen offset:0 sc1
  buffer_load_dwordx4 a[148:151], v2, s[8:11], s22 offen offset:1024 sc1
  buffer_load_dwordx4 a[152:155], v2, s[8:11], s22 offen offset:2048 sc1
  buffer_load_dwordx4 a[156:159], v2, s[8:11], s22 offen offset:3072 sc1
  s_add_u32 s22, s21, 40960
  s_waitcnt vmcnt(40)
  buffer_load_dwordx4 a[160:163], v2, s[8:11], s22 offen offset:0 sc1
  buffer_load_dwordx4 a[164:167], v2, s[8:11], s22 offen offset:1024 sc1
  buffer_load_dwordx4 a[168:171], v2, s[8:11], s22 offen offset:2048 sc1
  buffer_load_dwordx4 a[172:175], v2, s[8:11], s22 offen offset:3072 sc1
  s_add_u32 s22, s21, 45056
  buffer_load_dwordx4 a[176:179], v2, s[8:11], s22 offen offset:0 sc1
  buffer_load_dwordx4 a[180:183], v2, s[8:11], s22 offen offset:1024 sc1
  buffer_load_dwordx4 a[184:187], v2, s[8:11], s22 offen offset:2048 sc1
  buffer_load_dwordx4 a[188:191], v2, s[8:11], s22 offen offset:3072 sc1
  s_add_u32 s22, s21, 49152
  buffer_load_dwordx4 a[192:195], v2, s[8:11], s22 offen offset:0 sc1
  buffer_load_dwordx4 a[196:199], v2, s[8:11], s22 offen offset:1024 sc1
  buffer_load_dwordx4 a[200:203], v2, s[8:11], s22 offen offset:2048 sc1
  buffer_load_dwordx4 a[204:207], v2, s[8:11], s22 offen offset:3072 sc1
  s_add_u32 s22, s21, 53248
  buffer_load_dwordx4 a[208:211], v2, s[8:11], s22 offen offset:0 sc1
  buffer_load_dwordx4 a[212:215], v2, s[8:11], s22 offen offset:1024 sc1
  buffer_load_dwordx4 a[216:219], v2, s[8:11], s22 offen offset:2048 sc1
  buffer_load_dwordx4 a[220:223], v2, s[8:11], s22 offen offset:3072 sc1
wg_vo_hx:
  s_mov_b32 s101, -1
  s_waitcnt vmcnt(0)
  s_barrier
  s_mov_b32 s40, 0
  s_mov_b32 s41, 0x40000000
  v_mov_b32 v5, v2
  ds_read_b128 v[8:11], v5 offset:0
  ds_read_b128 v[12:15], v5 offset:14336
  ds_read_b128 v[16:19], v5 offset:1024
  ds_read_b128 v[20:23], v5 offset:15360
  ds_read_b128 v[24:27], v5 offset:2048
  s_waitcnt lgkmcnt(4)
.p2align 6
wg_vo_loop:
  v_mfma_f32_16x16x32_bf16 v[40:43], a[0:3], v[8:11], 0
  ds_read_b128 v[28:31], v5 offset:16384
  v_mfma_f32_16x16x32_bf16 v[44:47], a[56:59], v[8:11], 0
  v_mfma_f32_16x16x32_bf16 v[48:51], a[112:115], v[8:11], 0
  v_mfma_f32_16x16x32_bf16 v[52:55], a[168:171], v[8:11], 0
  s_waitcnt lgkmcnt(4)
  s_add_u32 s43, s41, 458752
  v_mfma_f32_16x16x32_bf16 v[56:59], a[0:3], v[12:15], 0
  ds_read_b128 v[32:35], v5 offset:3072
  v_mfma_f32_16x16x32_bf16 v[60:63], a[56:59], v[12:15], 0
  s_lshl_b32 s42, s40, 5
  s_add_u32 s42, s42, 0
  v_mfma_f32_16x16x32_bf16 v[64:67], a[112:115], v[12:15], 0
  v_add_u32 v88, s42, v4
  v_mul_u32_u24 v89, 2341, v88
  v_mfma_f32_16x16x32_bf16 v[68:71], a[168:171], v[12:15], 0
  s_waitcnt lgkmcnt(4)
  v_lshrrev_b32 v89, 16, v89
  v_mfma_f32_16x16x32_bf16 v[40:43], a[4:7], v[16:19], v[40:43]
  ds_read_b128 v[8:11], v5 offset:17408
  v_mfma_f32_16x16x32_bf16 v[44:47], a[60:63], v[16:19], v[44:47]
  v_mul_u32_u24 v92, 28, v89
  v_sub_u32 v92, v88, v92
  v_mfma_f32_16x16x32_bf16 v[48:51], a[116:119], v[16:19], v[48:51]
  v_cmp_gt_u32 vcc, 16, v92
  v_mul_u32_u24 v89, 84, v89
  v_mfma_f32_16x16x32_bf16 v[52:55], a[172:175], v[16:19], v[52:55]
  s_waitcnt lgkmcnt(4)
  v_cndmask_b32 v92, v7, v6, vcc
  v_mfma_f32_16x16x32_bf16 v[56:59], a[4:7], v[20:23], v[56:59]
  ds_read_b128 v[12:15], v5 offset:4096
  v_mfma_f32_16x16x32_bf16 v[60:63], a[60:63], v[20:23], v[60:63]
  v_add3_u32 v88, v88, v89, v92
  v_lshlrev_b32 v90, 4, v88
  v_mfma_f32_16x16x32_bf16 v[64:67], a[116:119], v[20:23], v[64:67]
  v_cvt_pk_bf16_f32 v72, v96, v100
  v_cvt_pk_bf16_f32 v73, v97, v101
  v_mfma_f32_16x16x32_bf16 v[68:71], a[172:175], v[20:23], v[68:71]
  s_waitcnt lgkmcnt(4)
  v_cvt_pk_bf16_f32 v74, v98, v102
  v_mfma_f32_16x16x32_bf16 v[40:43], a[8:11], v[24:27], v[40:43]
  ds_read_b128 v[16:19], v5 offset:18432
  v_mfma_f32_16x16x32_bf16 v[44:47], a[64:67], v[24:27], v[44:47]
  v_cvt_pk_bf16_f32 v75, v99, v103
  v_mfma_f32_16x16x32_bf16 v[48:51], a[120:123], v[24:27], v[48:51]
  buffer_store_dwordx4 v[72:75], v90, s[8:11], s41 offen sc1
  v_cvt_pk_bf16_f32 v76, v104, v108
  v_mfma_f32_16x16x32_bf16 v[52:55], a[176:179], v[24:27], v[52:55]
  s_waitcnt lgkmcnt(4)
  v_cvt_pk_bf16_f32 v77, v105, v109
  v_mfma_f32_16x16x32_bf16 v[56:59], a[8:11], v[28:31], v[56:59]
  ds_read_b128 v[20:23], v5 offset:5120
  v_mfma_f32_16x16x32_bf16 v[60:63], a[64:67], v[28:31], v[60:63]
  v_cvt_pk_bf16_f32 v78, v106, v110
  v_cvt_pk_bf16_f32 v79, v107, v111
  v_mfma_f32_16x16x32_bf16 v[64:67], a[120:123], v[28:31], v[64:67]
  buffer_store_dwordx4 v[76:79], v90, s[8:11], s43 offen sc1
  s_lshl_b32 s42, s40, 5
  v_mfma_f32_16x16x32_bf16 v[68:71], a[176:179], v[28:31], v[68:71]
  s_waitcnt lgkmcnt(4)
  s_add_u32 s42, s42, 16
  v_mfma_f32_16x16x32_bf16 v[40:43], a[12:15], v[32:35], v[40:43]
  ds_read_b128 v[24:27], v5 offset:19456
  v_mfma_f32_16x16x32_bf16 v[44:47], a[68:71], v[32:35], v[44:47]
  v_add_u32 v88, s42, v4
  v_mul_u32_u24 v89, 2341, v88
  v_mfma_f32_16x16x32_bf16 v[48:51], a[124:127], v[32:35], v[48:51]
  v_lshrrev_b32 v89, 16, v89
  v_mul_u32_u24 v92, 28, v89
  v_mfma_f32_16x16x32_bf16 v[52:55], a[180:183], v[32:35], v[52:55]
  s_waitcnt lgkmcnt(4)
  v_sub_u32 v92, v88, v92
  v_mfma_f32_16x16x32_bf16 v[56:59], a[12:15], v[8:11], v[56:59]
  ds_read_b128 v[28:31], v5 offset:6144
  v_mfma_f32_16x16x32_bf16 v[60:63], a[68:71], v[8:11], v[60:63]
  v_cmp_gt_u32 vcc, 16, v92
  v_mul_u32_u24 v89, 84, v89
  v_mfma_f32_16x16x32_bf16 v[64:67], a[124:127], v[8:11], v[64:67]
  v_cndmask_b32 v92, v7, v6, vcc
  v_add3_u32 v88, v88, v89, v92
  v_mfma_f32_16x16x32_bf16 v[68:71], a[180:183], v[8:11], v[68:71]
  s_waitcnt lgkmcnt(4)
  v_lshlrev_b32 v91, 4, v88
  v_mfma_f32_16x16x32_bf16 v[40:43], a[16:19], v[12:15], v[40:43]
  ds_read_b128 v[32:35], v5 offset:20480
  v_mfma_f32_16x16x32_bf16 v[44:47], a[72:75], v[12:15], v[44:47]
  v_cvt_pk_bf16_f32 v80, v112, v116
  v_cvt_pk_bf16_f32 v81, v113, v117
  v_mfma_f32_16x16x32_bf16 v[48:51], a[128:131], v[12:15], v[48:51]
  v_cvt_pk_bf16_f32 v82, v114, v118
  v_cvt_pk_bf16_f32 v83, v115, v119
  v_mfma_f32_16x16x32_bf16 v[52:55], a[184:187], v[12:15], v[52:55]
  s_waitcnt lgkmcnt(4)
  buffer_store_dwordx4 v[80:83], v91, s[8:11], s41 offen sc1
  v_mfma_f32_16x16x32_bf16 v[56:59], a[16:19], v[16:19], v[56:59]
  ds_read_b128 v[8:11], v5 offset:7168
  v_mfma_f32_16x16x32_bf16 v[60:63], a[72:75], v[16:19], v[60:63]
  v_cvt_pk_bf16_f32 v84, v120, v124
  v_cvt_pk_bf16_f32 v85, v121, v125
  v_mfma_f32_16x16x32_bf16 v[64:67], a[128:131], v[16:19], v[64:67]
  v_cvt_pk_bf16_f32 v86, v122, v126
  v_cvt_pk_bf16_f32 v87, v123, v127
  v_mfma_f32_16x16x32_bf16 v[68:71], a[184:187], v[16:19], v[68:71]
  s_waitcnt lgkmcnt(4)
  buffer_store_dwordx4 v[84:87], v91, s[8:11], s43 offen sc1
  v_mfma_f32_16x16x32_bf16 v[40:43], a[20:23], v[20:23], v[40:43]
  ds_read_b128 v[12:15], v5 offset:21504
  v_mfma_f32_16x16x32_bf16 v[44:47], a[76:79], v[20:23], v[44:47]
  s_add_u32 s30, s19, 2
  s_lshl_b32 s24, s30, 1
  s_mul_i32 s24, s24, 14336
  v_mfma_f32_16x16x32_bf16 v[48:51], a[132:135], v[20:23], v[48:51]
  s_add_u32 s24, s24, s23
  s_cmp_lt_u32 s30, s35
  s_cselect_b32 s24, s24, 0x40000000
  v_mfma_f32_16x16x32_bf16 v[52:55], a[188:191], v[20:23], v[52:55]
  s_waitcnt lgkmcnt(4)
  s_add_u32 m0, s33, s27
  s_nop 0
  buffer_load_dwordx4 v2, s[8:11], s24 offen offset:0 sc1 lds
  v_mfma_f32_16x16x32_bf16 v[56:59], a[20:23], v[24:27], v[56:59]
  ds_read_b128 v[16:19], v5 offset:8192
  v_mfma_f32_16x16x32_bf16 v[60:63], a[76:79], v[24:27], v[60:63]
  v_mfma_f32_16x16x32_bf16 v[64:67], a[132:135], v[24:27], v[64:67]
  v_mfma_f32_16x16x32_bf16 v[68:71], a[188:191], v[24:27], v[68:71]
  s_waitcnt lgkmcnt(4)
  v_mfma_f32_16x16x32_bf16 v[40:43], a[24:27], v[28:31], v[40:43]
  ds_read_b128 v[20:23], v5 offset:22528
  v_mfma_f32_16x16x32_bf16 v[44:47], a[80:83], v[28:31], v[44:47]
  buffer_load_dwordx4 v2, s[8:11], s24 offen offset:1024 sc1 lds
  v_mfma_f32_16x16x32_bf16 v[48:51], a[136:139], v[28:31], v[48:51]
  v_mfma_f32_16x16x32_bf16 v[52:55], a[192:195], v[28:31], v[52:55]
  s_waitcnt lgkmcnt(4)
  v_mfma_f32_16x16x32_bf16 v[56:59], a[24:27], v[32:35], v[56:59]
  ds_read_b128 v[24:27], v5 offset:9216
  v_mfma_f32_16x16x32_bf16 v[60:63], a[80:83], v[32:35], v[60:63]
  v_mfma_f32_16x16x32_bf16 v[64:67], a[136:139], v[32:35], v[64:67]
  buffer_load_dwordx4 v2, s[8:11], s24 offen offset:2048 sc1 lds
  v_mfma_f32_16x16x32_bf16 v[68:71], a[192:195], v[32:35], v[68:71]
  s_waitcnt lgkmcnt(4)
  v_mfma_f32_16x16x32_bf16 v[40:43], a[28:31], v[8:11], v[40:43]
  ds_read_b128 v[28:31], v5 offset:23552
  v_mfma_f32_16x16x32_bf16 v[44:47], a[84:87], v[8:11], v[44:47]
  v_mfma_f32_16x16x32_bf16 v[48:51], a[140:143], v[8:11], v[48:51]
  v_mfma_f32_16x16x32_bf16 v[52:55], a[196:199], v[8:11], v[52:55]
  s_waitcnt lgkmcnt(4)
  buffer_load_dwordx4 v2, s[8:11], s24 offen offset:3072 sc1 lds
  v_mfma_f32_16x16x32_bf16 v[56:59], a[28:31], v[12:15], v[56:59]
  ds_read_b128 v[32:35], v5 offset:10240
  v_mfma_f32_16x16x32_bf16 v[60:63], a[84:87], v[12:15], v[60:63]
  v_mfma_f32_16x16x32_bf16 v[64:67], a[140:143], v[12:15], v[64:67]
  v_mfma_f32_16x16x32_bf16 v[68:71], a[196:199], v[12:15], v[68:71]
  s_waitcnt lgkmcnt(4)
  v_mfma_f32_16x16x32_bf16 v[40:43], a[32:35], v[16:19], v[40:43]
  ds_read_b128 v[8:11], v5 offset:24576
  v_mfma_f32_16x16x32_bf16 v[44:47], a[88:91], v[16:19], v[44:47]
  s_add_u32 m0, m0, 4096
  s_add_u32 s24, s24, 4096
  buffer_load_dwordx4 v2, s[8:11], s24 offen offset:0 sc1 lds
  v_mfma_f32_16x16x32_bf16 v[48:51], a[144:147], v[16:19], v[48:51]
  v_mfma_f32_16x16x32_bf16 v[52:55], a[200:203], v[16:19], v[52:55]
  s_waitcnt lgkmcnt(4)
  v_mfma_f32_16x16x32_bf16 v[56:59], a[32:35], v[20:23], v[56:59]
  ds_read_b128 v[12:15], v5 offset:11264
  v_mfma_f32_16x16x32_bf16 v[60:63], a[88:91], v[20:23], v[60:63]
  v_mfma_f32_16x16x32_bf16 v[64:67], a[144:147], v[20:23], v[64:67]
  buffer_load_dwordx4 v2, s[8:11], s24 offen offset:1024 sc1 lds
  v_mfma_f32_16x16x32_bf16 v[68:71], a[200:203], v[20:23], v[68:71]
  s_waitcnt lgkmcnt(4)
  v_mfma_f32_16x16x32_bf16 v[40:43], a[36:39], v[24:27], v[40:43]
  ds_read_b128 v[16:19], v5 offset:25600
  v_mfma_f32_16x16x32_bf16 v[44:47], a[92:95], v[24:27], v[44:47]
  v_mfma_f32_16x16x32_bf16 v[48:51], a[148:151], v[24:27], v[48:51]
  v_mfma_f32_16x16x32_bf16 v[52:55], a[204:207], v[24:27], v[52:55]
  s_waitcnt lgkmcnt(4)
  buffer_load_dwordx4 v2, s[8:11], s24 offen offset:2048 sc1 lds
  v_mfma_f32_16x16x32_bf16 v[56:59], a[36:39], v[28:31], v[56:59]
  ds_read_b128 v[20:23], v5 offset:12288
  v_mfma_f32_16x16x32_bf16 v[60:63], a[92:95], v[28:31], v[60:63]
  v_mfma_f32_16x16x32_bf16 v[64:67], a[148:151], v[28:31], v[64:67]
  v_mfma_f32_16x16x32_bf16 v[68:71], a[204:207], v[28:31], v[68:71]
  s_waitcnt lgkmcnt(4)
  v_mfma_f32_16x16x32_bf16 v[40:43], a[40:43], v[32:35], v[40:43]
  ds_read_b128 v[24:27], v5 offset:26624
  v_mfma_f32_16x16x32_bf16 v[44:47], a[96:99], v[32:35], v[44:47]
  s_add_u32 s33, s33, 28672
  s_cmp_eq_u32 s33, 114688
  s_cselect_b32 s33, 0, s33
  v_mfma_f32_16x16x32_bf16 v[48:51], a[152:155], v[32:35], v[48:51]
  s_add_u32 s32, s32, 28672
  s_cmp_eq_u32 s32, 114688
  s_cselect_b32 s32, 0, s32
  v_mfma_f32_16x16x32_bf16 v[52:55], a[208:211], v[32:35], v[52:55]
  s_waitcnt lgkmcnt(4)
  v_add_u32 v128, s32, v2
  v_mfma_f32_16x16x32_bf16 v[56:59], a[40:43], v[8:11], v[56:59]
  ds_read_b128 v[28:31], v5 offset:13312
  v_mfma_f32_16x16x32_bf16 v[60:63], a[96:99], v[8:11], v[60:63]
  v_mfma_f32_16x16x32_bf16 v[64:67], a[152:155], v[8:11], v[64:67]
  v_mfma_f32_16x16x32_bf16 v[68:71], a[208:211], v[8:11], v[68:71]
  s_waitcnt lgkmcnt(4)
  v_mfma_f32_16x16x32_bf16 v[40:43], a[44:47], v[12:15], v[40:43]
  ds_read_b128 v[32:35], v5 offset:27648
  v_mfma_f32_16x16x32_bf16 v[44:47], a[100:103], v[12:15], v[44:47]
  v_mfma_f32_16x16x32_bf16 v[48:51], a[156:159], v[12:15], v[48:51]
  v_mfma_f32_16x16x32_bf16 v[52:55], a[212:215], v[12:15], v[52:55]
  s_waitcnt lgkmcnt(4)
  v_mfma_f32_16x16x32_bf16 v[56:59], a[44:47], v[16:19], v[56:59]
  s_waitcnt vmcnt(11)
  s_barrier
  ds_read_b128 v[8:11], v128 offset:0
  v_mfma_f32_16x16x32_bf16 v[60:63], a[100:103], v[16:19], v[60:63]
  v_mfma_f32_16x16x32_bf16 v[64:67], a[156:159], v[16:19], v[64:67]
  v_mfma_f32_16x16x32_bf16 v[68:71], a[212:215], v[16:19], v[68:71]
  s_waitcnt lgkmcnt(4)
  v_mfma_f32_16x16x32_bf16 v[40:43], a[48:51], v[20:23], v[40:43]
  ds_read_b128 v[12:15], v128 offset:14336
  v_mfma_f32_16x16x32_bf16 v[44:47], a[104:107], v[20:23], v[44:47]
  v_mfma_f32_16x16x32_bf16 v[48:51], a[160:163], v[20:23], v[48:51]
  v_mfma_f32_16x16x32_bf16 v[52:55], a[216:219], v[20:23], v[52:55]
  s_waitcnt lgkmcnt(4)
  v_mfma_f32_16x16x32_bf16 v[56:59], a[48:51], v[24:27], v[56:59]
  ds_read_b128 v[16:19], v128 offset:1024
  v_mfma_f32_16x16x32_bf16 v[60:63], a[104:107], v[24:27], v[60:63]
  v_mfma_f32_16x16x32_bf16 v[64:67], a[160:163], v[24:27], v[64:67]
  v_mfma_f32_16x16x32_bf16 v[68:71], a[216:219], v[24:27], v[68:71]
  s_waitcnt lgkmcnt(4)
  v_mfma_f32_16x16x32_bf16 v[40:43], a[52:55], v[28:31], v[40:43]
  ds_read_b128 v[20:23], v128 offset:15360
  v_mfma_f32_16x16x32_bf16 v[44:47], a[108:111], v[28:31], v[44:47]
  v_mfma_f32_16x16x32_bf16 v[48:51], a[164:167], v[28:31], v[48:51]
  v_mfma_f32_16x16x32_bf16 v[52:55], a[220:223], v[28:31], v[52:55]
  s_waitcnt lgkmcnt(4)
  v_mfma_f32_16x16x32_bf16 v[56:59], a[52:55], v[32:35], v[56:59]
  ds_read_b128 v[24:27], v128 offset:2048
  v_mfma_f32_16x16x32_bf16 v[60:63], a[108:111], v[32:35], v[60:63]
  v_mfma_f32_16x16x32_bf16 v[64:67], a[164:167], v[32:35], v[64:67]
  v_mfma_f32_16x16x32_bf16 v[68:71], a[220:223], v[32:35], v[68:71]
  s_waitcnt lgkmcnt(4)
  s_mov_b32 s40, s19
  s_mov_b32 s41, s29
  s_add_u32 s19, s19, 1
  s_cmp_lt_u32 s19, s35
  s_cbranch_scc0 wg_vo_e0
  v_mfma_f32_16x16x32_bf16 v[96:99], a[0:3], v[8:11], 0
  ds_read_b128 v[28:31], v128 offset:16384
  v_mfma_f32_16x16x32_bf16 v[100:103], a[56:59], v[8:11], 0
  v_mfma_f32_16x16x32_bf16 v[104:107], a[112:115], v[8:11], 0
  v_mfma_f32_16x16x32_bf16 v[108:111], a[168:171], v[8:11], 0
  s_waitcnt lgkmcnt(4)
  s_add_u32 s43, s41, 458752
  v_mfma_f32_16x16x32_bf16 v[112:115], a[0:3], v[12:15], 0
  ds_read_b128 v[32:35], v128 offset:3072
  v_mfma_f32_16x16x32_bf16 v[116:119], a[56:59], v[12:15], 0
  s_lshl_b32 s42, s40, 5
  s_add_u32 s42, s42, 0
  v_mfma_f32_16x16x32_bf16 v[120:123], a[112:115], v[12:15], 0
  v_add_u32 v88, s42, v4
  v_mul_u32_u24 v89, 2341, v88
  v_mfma_f32_16x16x32_bf16 v[124:127], a[168:171], v[12:15], 0
  s_waitcnt lgkmcnt(4)
  v_lshrrev_b32 v89, 16, v89
  v_mfma_f32_16x16x32_bf16 v[96:99], a[4:7], v[16:19], v[96:99]
  ds_read_b128 v[8:11], v128 offset:17408
  v_mfma_f32_16x16x32_bf16 v[100:103], a[60:63], v[16:19], v[100:103]
  v_mul_u32_u24 v92, 28, v89
  v_sub_u32 v92, v88, v92
  v_mfma_f32_16x16x32_bf16 v[104:107], a[116:119], v[16:19], v[104:107]
  v_cmp_gt_u32 vcc, 16, v92
  v_mul_u32_u24 v89, 84, v89
  v_mfma_f32_16x16x32_bf16 v[108:111], a[172:175], v[16:19], v[108:111]
  s_waitcnt lgkmcnt(4)
  v_cndmask_b32 v92, v7, v6, vcc
  v_mfma_f32_16x16x32_bf16 v[112:115], a[4:7], v[20:23], v[112:115]
  ds_read_b128 v[12:15], v128 offset:4096
  v_mfma_f32_16x16x32_bf16 v[116:119], a[60:63], v[20:23], v[116:119]
  v_add3_u32 v88, v88, v89, v92
  v_lshlrev_b32 v90, 4, v88
  v_mfma_f32_16x16x32_bf16 v[120:123], a[116:119], v[20:23], v[120:123]
  v_cvt_pk_bf16_f32 v72, v40, v44
  v_cvt_pk_bf16_f32 v73, v41, v45
  v_mfma_f32_16x16x32_bf16 v[124:127], a[172:175], v[20:23], v[124:127]
  s_waitcnt lgkmcnt(4)
  v_cvt_pk_bf16_f32 v74, v42, v46
  v_mfma_f32_16x16x32_bf16 v[96:99], a[8:11], v[24:27], v[96:99]
  ds_read_b128 v[16:19], v128 offset:18432
  v_mfma_f32_16x16x32_bf16 v[100:103], a[64:67], v[24:27], v[100:103]
  v_cvt_pk_bf16_f32 v75, v43, v47
  v_mfma_f32_16x16x32_bf16 v[104:107], a[120:123], v[24:27], v[104:107]
  buffer_store_dwordx4 v[72:75], v90, s[8:11], s41 offen sc1
  v_cvt_pk_bf16_f32 v76, v48, v52
  v_mfma_f32_16x16x32_bf16 v[108:111], a[176:179], v[24:27], v[108:111]
  s_waitcnt lgkmcnt(4)
  v_cvt_pk_bf16_f32 v77, v49, v53
  v_mfma_f32_16x16x32_bf16 v[112:115], a[8:11], v[28:31], v[112:115]
  ds_read_b128 v[20:23], v128 offset:5120
  v_mfma_f32_16x16x32_bf16 v[116:119], a[64:67], v[28:31], v[116:119]
  v_cvt_pk_bf16_f32 v78, v50, v54
  v_cvt_pk_bf16_f32 v79, v51, v55
  v_mfma_f32_16x16x32_bf16 v[120:123], a[120:123], v[28:31], v[120:123]
  buffer_store_dwordx4 v[76:79], v90, s[8:11], s43 offen sc1
  s_lshl_b32 s42, s40, 5
  v_mfma_f32_16x16x32_bf16 v[124:127], a[176:179], v[28:31], v[124:127]
  s_waitcnt lgkmcnt(4)
  s_add_u32 s42, s42, 16
  v_mfma_f32_16x16x32_bf16 v[96:99], a[12:15], v[32:35], v[96:99]
  ds_read_b128 v[24:27], v128 offset:19456
  v_mfma_f32_16x16x32_bf16 v[100:103], a[68:71], v[32:35], v[100:103]
  v_add_u32 v88, s42, v4
  v_mul_u32_u24 v89, 2341, v88
  v_mfma_f32_16x16x32_bf16 v[104:107], a[124:127], v[32:35], v[104:107]
  v_lshrrev_b32 v89, 16, v89
  v_mul_u32_u24 v92, 28, v89
  v_mfma_f32_16x16x32_bf16 v[108:111], a[180:183], v[32:35], v[108:111]
  s_waitcnt lgkmcnt(4)
  v_sub_u32 v92, v88, v92
  v_mfma_f32_16x16x32_bf16 v[112:115], a[12:15], v[8:11], v[112:115]
  ds_read_b128 v[28:31], v128 offset:6144
  v_mfma_f32_16x16x32_bf16 v[116:119], a[68:71], v[8:11], v[116:119]
  v_cmp_gt_u32 vcc, 16, v92
  v_mul_u32_u24 v89, 84, v89
  v_mfma_f32_16x16x32_bf16 v[120:123], a[124:127], v[8:11], v[120:123]
  v_cndmask_b32 v92, v7, v6, vcc
  v_add3_u32 v88, v88, v89, v92
  v_mfma_f32_16x16x32_bf16 v[124:127], a[180:183], v[8:11], v[124:127]
  s_waitcnt lgkmcnt(4)
  v_lshlrev_b32 v91, 4, v88
  v_mfma_f32_16x16x32_bf16 v[96:99], a[16:19], v[12:15], v[96:99]
  ds_read_b128 v[32:35], v128 offset:20480
  v_mfma_f32_16x16x32_bf16 v[100:103], a[72:75], v[12:15], v[100:103]
  v_cvt_pk_bf16_f32 v80, v56, v60
  v_cvt_pk_bf16_f32 v81, v57, v61
  v_mfma_f32_16x16x32_bf16 v[104:107], a[128:131], v[12:15], v[104:107]
  v_cvt_pk_bf16_f32 v82, v58, v62
  v_cvt_pk_bf16_f32 v83, v59, v63
  v_mfma_f32_16x16x32_bf16 v[108:111], a[184:187], v[12:15], v[108:111]
  s_waitcnt lgkmcnt(4)
  buffer_store_dwordx4 v[80:83], v91, s[8:11], s41 offen sc1
  v_mfma_f32_16x16x32_bf16 v[112:115], a[16:19], v[16:19], v[112:115]
  ds_read_b128 v[8:11], v128 offset:7168
  v_mfma_f32_16x16x32_bf16 v[116:119], a[72:75], v[16:19], v[116:119]
  v_cvt_pk_bf16_f32 v84, v64, v68
  v_cvt_pk_bf16_f32 v85, v65, v69
  v_mfma_f32_16x16x32_bf16 v[120:123], a[128:131], v[16:19], v[120:123]
  v_cvt_pk_bf16_f32 v86, v66, v70
  v_cvt_pk_bf16_f32 v87, v67, v71
  v_mfma_f32_16x16x32_bf16 v[124:127], a[184:187], v[16:19], v[124:127]
  s_waitcnt lgkmcnt(4)
  buffer_store_dwordx4 v[84:87], v91, s[8:11], s43 offen sc1
  v_mfma_f32_16x16x32_bf16 v[96:99], a[20:23], v[20:23], v[96:99]
  ds_read_b128 v[12:15], v128 offset:21504
  v_mfma_f32_16x16x32_bf16 v[100:103], a[76:79], v[20:23], v[100:103]
  s_add_u32 s30, s19, 2
  s_lshl_b32 s24, s30, 1
  s_mul_i32 s24, s24, 14336
  v_mfma_f32_16x16x32_bf16 v[104:107], a[132:135], v[20:23], v[104:107]
  s_add_u32 s24, s24, s23
  s_cmp_lt_u32 s30, s35
  s_cselect_b32 s24, s24, 0x40000000
  v_mfma_f32_16x16x32_bf16 v[108:111], a[188:191], v[20:23], v[108:111]
  s_waitcnt lgkmcnt(4)
  s_add_u32 m0, s33, s27
  s_nop 0
  buffer_load_dwordx4 v2, s[8:11], s24 offen offset:0 sc1 lds
  v_mfma_f32_16x16x32_bf16 v[112:115], a[20:23], v[24:27], v[112:115]
  ds_read_b128 v[16:19], v128 offset:8192
  v_mfma_f32_16x16x32_bf16 v[116:119], a[76:79], v[24:27], v[116:119]
  v_mfma_f32_16x16x32_bf16 v[120:123], a[132:135], v[24:27], v[120:123]
  v_mfma_f32_16x16x32_bf16 v[124:127], a[188:191], v[24:27], v[124:127]
  s_waitcnt lgkmcnt(4)
  v_mfma_f32_16x16x32_bf16 v[96:99], a[24:27], v[28:31], v[96:99]
  ds_read_b128 v[20:23], v128 offset:22528
  v_mfma_f32_16x16x32_bf16 v[100:103], a[80:83], v[28:31], v[100:103]
  buffer_load_dwordx4 v2, s[8:11], s24 offen offset:1024 sc1 lds
  v_mfma_f32_16x16x32_bf16 v[104:107], a[136:139], v[28:31], v[104:107]
  v_mfma_f32_16x16x32_bf16 v[108:111], a[192:195], v[28:31], v[108:111]
  s_waitcnt lgkmcnt(4)
  v_mfma_f32_16x16x32_bf16 v[112:115], a[24:27], v[32:35], v[112:115]
  ds_read_b128 v[24:27], v128 offset:9216
  v_mfma_f32_16x16x32_bf16 v[116:119], a[80:83], v[32:35], v[116:119]
  v_mfma_f32_16x16x32_bf16 v[120:123], a[136:139], v[32:35], v[120:123]
  buffer_load_dwordx4 v2, s[8:11], s24 offen offset:2048 sc1 lds
  v_mfma_f32_16x16x32_bf16 v[124:127], a[192:195], v[32:35], v[124:127]
  s_waitcnt lgkmcnt(4)
  v_mfma_f32_16x16x32_bf16 v[96:99], a[28:31], v[8:11], v[96:99]
  ds_read_b128 v[28:31], v128 offset:23552
  v_mfma_f32_16x16x32_bf16 v[100:103], a[84:87], v[8:11], v[100:103]
  v_mfma_f32_16x16x32_bf16 v[104:107], a[140:143], v[8:11], v[104:107]
  v_mfma_f32_16x16x32_bf16 v[108:111], a[196:199], v[8:11], v[108:111]
  s_waitcnt lgkmcnt(4)
  buffer_load_dwordx4 v2, s[8:11], s24 offen offset:3072 sc1 lds
  v_mfma_f32_16x16x32_bf16 v[112:115], a[28:31], v[12:15], v[112:115]
  ds_read_b128 v[32:35], v128 offset:10240
  v_mfma_f32_16x16x32_bf16 v[116:119], a[84:87], v[12:15], v[116:119]
  v_mfma_f32_16x16x32_bf16 v[120:123], a[140:143], v[12:15], v[120:123]
  v_mfma_f32_16x16x32_bf16 v[124:127], a[196:199], v[12:15], v[124:127]
  s_waitcnt lgkmcnt(4)
  v_mfma_f32_16x16x32_bf16 v[96:99], a[32:35], v[16:19], v[96:99]
  ds_read_b128 v[8:11], v128 offset:24576
  v_mfma_f32_16x16x32_bf16 v[100:103], a[88:91], v[16:19], v[100:103]
  s_add_u32 m0, m0, 4096
  s_add_u32 s24, s24, 4096
  buffer_load_dwordx4 v2, s[8:11], s24 offen offset:0 sc1 lds
  v_mfma_f32_16x16x32_bf16 v[104:107], a[144:147], v[16:19], v[104:107]
  v_mfma_f32_16x16x32_bf16 v[108:111], a[200:203], v[16:19], v[108:111]
  s_waitcnt lgkmcnt(4)
  v_mfma_f32_16x16x32_bf16 v[112:115], a[32:35], v[20:23], v[112:115]
  ds_read_b128 v[12:15], v128 offset:11264
  v_mfma_f32_16x16x32_bf16 v[116:119], a[88:91], v[20:23], v[116:119]
  v_mfma_f32_16x16x32_bf16 v[120:123], a[144:147], v[20:23], v[120:123]
  buffer_load_dwordx4 v2, s[8:11], s24 offen offset:1024 sc1 lds
  v_mfma_f32_16x16x32_bf16 v[124:127], a[200:203], v[20:23], v[124:127]
  s_waitcnt lgkmcnt(4)
  v_mfma_f32_16x16x32_bf16 v[96:99], a[36:39], v[24:27], v[96:99]
  ds_read_b128 v[16:19], v128 offset:25600
  v_mfma_f32_16x16x32_bf16 v[100:103], a[92:95], v[24:27], v[100:103]
  v_mfma_f32_16x16x32_bf16 v[104:107], a[148:151], v[24:27], v[104:107]
  v_mfma_f32_16x16x32_bf16 v[108:111], a[204:207], v[24:27], v[108:111]
  s_waitcnt lgkmcnt(4)
  buffer_load_dwordx4 v2, s[8:11], s24 offen offset:2048 sc1 lds
  v_mfma_f32_16x16x32_bf16 v[112:115], a[36:39], v[28:31], v[112:115]
  ds_read_b128 v[20:23], v128 offset:12288
  v_mfma_f32_16x16x32_bf16 v[116:119], a[92:95], v[28:31], v[116:119]
  v_mfma_f32_16x16x32_bf16 v[120:123], a[148:151], v[28:31], v[120:123]
  v_mfma_f32_16x16x32_bf16 v[124:127], a[204:207], v[28:31], v[124:127]
  s_waitcnt lgkmcnt(4)
  v_mfma_f32_16x16x32_bf16 v[96:99], a[40:43], v[32:35], v[96:99]
  ds_read_b128 v[24:27], v128 offset:26624
  v_mfma_f32_16x16x32_bf16 v[100:103], a[96:99], v[32:35], v[100:103]
  s_add_u32 s33, s33, 28672
  s_cmp_eq_u32 s33, 114688
  s_cselect_b32 s33, 0, s33
  v_mfma_f32_16x16x32_bf16 v[104:107], a[152:155], v[32:35], v[104:107]
  s_add_u32 s32, s32, 28672
  s_cmp_eq_u32 s32, 114688
  s_cselect_b32 s32, 0, s32
  v_mfma_f32_16x16x32_bf16 v[108:111], a[208:211], v[32:35], v[108:111]
  s_waitcnt lgkmcnt(4)
  v_add_u32 v5, s32, v2
  v_mfma_f32_16x16x32_bf16 v[112:115], a[40:43], v[8:11], v[112:115]
  ds_read_b128 v[28:31], v128 offset:13312
  v_mfma_f32_16x16x32_bf16 v[116:119], a[96:99], v[8:11], v[116:119]
  v_mfma_f32_16x16x32_bf16 v[120:123], a[152:155], v[8:11], v[120:123]
  v_mfma_f32_16x16x32_bf16 v[124:127], a[208:211], v[8:11], v[124:127]
  s_waitcnt lgkmcnt(4)
  v_mfma_f32_16x16x32_bf16 v[96:99], a[44:47], v[12:15], v[96:99]
  ds_read_b128 v[32:35], v128 offset:27648
  v_mfma_f32_16x16x32_bf16 v[100:103], a[100:103], v[12:15], v[100:103]
  v_mfma_f32_16x16x32_bf16 v[104:107], a[156:159], v[12:15], v[104:107]
  v_mfma_f32_16x16x32_bf16 v[108:111], a[212:215], v[12:15], v[108:111]
  s_waitcnt lgkmcnt(4)
  v_mfma_f32_16x16x32_bf16 v[112:115], a[44:47], v[16:19], v[112:115]
  s_waitcnt vmcnt(11)
  s_barrier
  ds_read_b128 v[8:11], v5 offset:0
  v_mfma_f32_16x16x32_bf16 v[116:119], a[100:103], v[16:19], v[116:119]
  v_mfma_f32_16x16x32_bf16 v[120:123], a[156:159], v[16:19], v[120:123]
  v_mfma_f32_16x16x32_bf16 v[124:127], a[212:215], v[16:19], v[124:127]
  s_waitcnt lgkmcnt(4)
  v_mfma_f32_16x16x32_bf16 v[96:99], a[48:51], v[20:23], v[96:99]
  ds_read_b128 v[12:15], v5 offset:14336
  v_mfma_f32_16x16x32_bf16 v[100:103], a[104:107], v[20:23], v[100:103]
  v_mfma_f32_16x16x32_bf16 v[104:107], a[160:163], v[20:23], v[104:107]
  v_mfma_f32_16x16x32_bf16 v[108:111], a[216:219], v[20:23], v[108:111]
  s_waitcnt lgkmcnt(4)
  v_mfma_f32_16x16x32_bf16 v[112:115], a[48:51], v[24:27], v[112:115]
  ds_read_b128 v[16:19], v5 offset:1024
  v_mfma_f32_16x16x32_bf16 v[116:119], a[104:107], v[24:27], v[116:119]
  v_mfma_f32_16x16x32_bf16 v[120:123], a[160:163], v[24:27], v[120:123]
  v_mfma_f32_16x16x32_bf16 v[124:127], a[216:219], v[24:27], v[124:127]
  s_waitcnt lgkmcnt(4)
  v_mfma_f32_16x16x32_bf16 v[96:99], a[52:55], v[28:31], v[96:99]
  ds_read_b128 v[20:23], v5 offset:15360
  v_mfma_f32_16x16x32_bf16 v[100:103], a[108:111], v[28:31], v[100:103]
  v_mfma_f32_16x16x32_bf16 v[104:107], a[164:167], v[28:31], v[104:107]
  v_mfma_f32_16x16x32_bf16 v[108:111], a[220:223], v[28:31], v[108:111]
  s_waitcnt lgkmcnt(4)
  v_mfma_f32_16x16x32_bf16 v[112:115], a[52:55], v[32:35], v[112:115]
  ds_read_b128 v[24:27], v5 offset:2048
  v_mfma_f32_16x16x32_bf16 v[116:119], a[108:111], v[32:35], v[116:119]
  v_mfma_f32_16x16x32_bf16 v[120:123], a[164:167], v[32:35], v[120:123]
  v_mfma_f32_16x16x32_bf16 v[124:127], a[220:223], v[32:35], v[124:127]
  s_waitcnt lgkmcnt(4)
  s_mov_b32 s40, s19
  s_mov_b32 s41, s29
  s_add_u32 s19, s19, 1
  s_cmp_lt_u32 s19, s35
  s_cbranch_scc1 wg_vo_loop
  s_nop 3
  s_add_u32 s43, s41, 458752
  s_lshl_b32 s42, s40, 5
  s_add_u32 s42, s42, 0
  v_add_u32 v88, s42, v4
  v_mul_u32_u24 v89, 2341, v88
  v_lshrrev_b32 v89, 16, v89
  v_mul_u32_u24 v92, 28, v89
  v_sub_u32 v92, v88, v92
  v_cmp_gt_u32 vcc, 16, v92
  v_mul_u32_u24 v89, 84, v89
  s_nop 0
  v_cndmask_b32 v92, v7, v6, vcc
  v_add3_u32 v88, v88, v89, v92
  v_lshlrev_b32 v90, 4, v88
  v_cvt_pk_bf16_f32 v72, v96, v100
  v_cvt_pk_bf16_f32 v73, v97, v101
  v_cvt_pk_bf16_f32 v74, v98, v102
  v_cvt_pk_bf16_f32 v75, v99, v103
  buffer_store_dwordx4 v[72:75], v90, s[8:11], s41 offen sc1
  v_cvt_pk_bf16_f32 v76, v104, v108
  v_cvt_pk_bf16_f32 v77, v105, v109
  v_cvt_pk_bf16_f32 v78, v106, v110
  v_cvt_pk_bf16_f32 v79, v107, v111
  buffer_store_dwordx4 v[76:79], v90, s[8:11], s43 offen sc1
  s_lshl_b32 s42, s40, 5
  s_add_u32 s42, s42, 16
  v_add_u32 v88, s42, v4
  v_mul_u32_u24 v89, 2341, v88
  v_lshrrev_b32 v89, 16, v89
  v_mul_u32_u24 v92, 28, v89
  v_sub_u32 v92, v88, v92
  v_cmp_gt_u32 vcc, 16, v92
  v_mul_u32_u24 v89, 84, v89
  s_nop 0
  v_cndmask_b32 v92, v7, v6, vcc
  v_add3_u32 v88, v88, v89, v92
  v_lshlrev_b32 v91, 4, v88
  v_cvt_pk_bf16_f32 v80, v112, v116
  v_cvt_pk_bf16_f32 v81, v113, v117
  v_cvt_pk_bf16_f32 v82, v114, v118
  v_cvt_pk_bf16_f32 v83, v115, v119
  buffer_store_dwordx4 v[80:83], v91, s[8:11], s41 offen sc1
  v_cvt_pk_bf16_f32 v84, v120, v124
  v_cvt_pk_bf16_f32 v85, v121, v125
  v_cvt_pk_bf16_f32 v86, v122, v126
  v_cvt_pk_bf16_f32 v87, v123, v127
  buffer_store_dwordx4 v[84:87], v91, s[8:11], s43 offen sc1
  s_branch wg_done
wg_vo_e0:
  s_nop 7
  s_add_u32 s43, s41, 458752
  s_lshl_b32 s42, s40, 5
  s_add_u32 s42, s42, 0
  v_add_u32 v88, s42, v4
  v_mul_u32_u24 v89, 2341, v88
  v_lshrrev_b32 v89, 16, v89
  v_mul_u32_u24 v92, 28, v89
  v_sub_u32 v92, v88, v92
  v_cmp_gt_u32 vcc, 16, v92
  v_mul_u32_u24 v89, 84, v89
  s_nop 0
  v_cndmask_b32 v92, v7, v6, vcc
  v_add3_u32 v88, v88, v89, v92
  v_lshlrev_b32 v90, 4, v88
  v_cvt_pk_bf16_f32 v72, v40, v44
  v_cvt_pk_bf16_f32 v73, v41, v45
  v_cvt_pk_bf16_f32 v74, v42, v46
  v_cvt_pk_bf16_f32 v75, v43, v47
  buffer_store_dwordx4 v[72:75], v90, s[8:11], s41 offen sc1
  v_cvt_pk_bf16_f32 v76, v48, v52
  v_cvt_pk_bf16_f32 v77, v49, v53
  v_cvt_pk_bf16_f32 v78, v50, v54
  v_cvt_pk_bf16_f32 v79, v51, v55
  buffer_store_dwordx4 v[76:79], v90, s[8:11], s43 offen sc1
  s_lshl_b32 s42, s40, 5
  s_add_u32 s42, s42, 16
  v_add_u32 v88, s42, v4
  v_mul_u32_u24 v89, 2341, v88
  v_lshrrev_b32 v89, 16, v89
  v_mul_u32_u24 v92, 28, v89
  v_sub_u32 v92, v88, v92
  v_cmp_gt_u32 vcc, 16, v92
  v_mul_u32_u24 v89, 84, v89
  s_nop 0
  v_cndmask_b32 v92, v7, v6, vcc
  v_add3_u32 v88, v88, v89, v92
  v_lshlrev_b32 v91, 4, v88
  v_cvt_pk_bf16_f32 v80, v56, v60
  v_cvt_pk_bf16_f32 v81, v57, v61
  v_cvt_pk_bf16_f32 v82, v58, v62
  v_cvt_pk_bf16_f32 v83, v59, v63
  buffer_store_dwordx4 v[80:83], v91, s[8:11], s41 offen sc1
  v_cvt_pk_bf16_f32 v84, v64, v68
  v_cvt_pk_bf16_f32 v85, v65, v69
  v_cvt_pk_bf16_f32 v86, v66, v70
  v_cvt_pk_bf16_f32 v87, v67, v71
  buffer_store_dwordx4 v[84:87], v91, s[8:11], s43 offen sc1
  s_branch wg_done
wg_done:
  s_lshl_b32 s20, s18, 4
  s_and_b32 s21, s17, 15
  s_add_u32 s20, s20, s21
  s_lshl_b32 s20, s20, 7
  s_cmp_lt_u32 s17, 16
  s_cselect_b32 s21, 16384, 0
  s_add_u32 s20, s20, s21
  s_add_u32 s20, s20, 524288
  s_sub_u32 s21, s35, s34
  s_lshl_b32 s21, s21, 2
  v_mov_b32 v5, s21
  v_mov_b32 v6, 0
  s_waitcnt vmcnt(0) lgkmcnt(0)
  s_barrier
  s_cmp_lg_u32 s16, 0
  s_cbranch_scc1 wg_sg
  s_mov_b64 exec, 1
  buffer_atomic_add v5, v6, s[8:11], s20 offen
  s_mov_b64 exec, -1
wg_sg:
  s_branch wk_loop
wk_srv:
  s_and_b32 s18, s3, 15
  s_lshr_b32 s19, s3, 4
  s_and_b32 s19, s19, 1
  s_mul_i32 s20, s18, 401408
  s_mul_i32 s21, s16, 100352
  s_add_u32 s20, s20, s21
  s_add_u32 s20, s20, 39976960
  s_add_u32 s22, s20, 0
  buffer_load_dwordx4 a[0:3], v2, s[8:11], s22 offen offset:0 sc1
  buffer_load_dwordx4 a[4:7], v2, s[8:11], s22 offen offset:1024 sc1
  buffer_load_dwordx4 a[8:11], v2, s[8:11], s22 offen offset:2048 sc1
  buffer_load_dwordx4 a[12:15], v2, s[8:11], s22 offen offset:3072 sc1
  s_add_u32 s22, s20, 4096
  buffer_load_dwordx4 a[16:19], v2, s[8:11], s22 offen offset:0 sc1
  buffer_load_dwordx4 a[20:23], v2, s[8:11], s22 offen offset:1024 sc1
  buffer_load_dwordx4 a[24:27], v2, s[8:11], s22 offen offset:2048 sc1
  buffer_load_dwordx4 a[28:31], v2, s[8:11], s22 offen offset:3072 sc1
  s_add_u32 s22, s20, 8192
  buffer_load_dwordx4 a[32:35], v2, s[8:11], s22 offen offset:0 sc1
  buffer_load_dwordx4 a[36:39], v2, s[8:11], s22 offen offset:1024 sc1
  s_waitcnt vmcnt(8)
  buffer_load_dwordx4 a[40:43], v2, s[8:11], s22 offen offset:2048 sc1
  buffer_load_dwordx4 a[44:47], v2, s[8:11], s22 offen offset:3072 sc1
  s_waitcnt vmcnt(8)
  s_add_u32 s22, s20, 12288
  buffer_load_dwordx4 a[48:51], v2, s[8:11], s22 offen offset:0 sc1
  buffer_load_dwordx4 a[52:55], v2, s[8:11], s22 offen offset:1024 sc1
  s_waitcnt vmcnt(8)
  buffer_load_dwordx4 a[56:59], v2, s[8:11], s22 offen offset:2048 sc1
  buffer_load_dwordx4 a[60:63], v2, s[8:11], s22 offen offset:3072 sc1
  s_waitcnt vmcnt(8)
  s_add_u32 s22, s20, 16384
  buffer_load_dwordx4 a[64:67], v2, s[8:11], s22 offen offset:0 sc1
  buffer_load_dwordx4 a[68:71], v2, s[8:11], s22 offen offset:1024 sc1
  s_waitcnt vmcnt(8)
  buffer_load_dwordx4 a[72:75], v2, s[8:11], s22 offen offset:2048 sc1
  buffer_load_dwordx4 a[76:79], v2, s[8:11], s22 offen offset:3072 sc1
  s_waitcnt vmcnt(8)
  s_add_u32 s22, s20, 20480
  buffer_load_dwordx4 a[80:83], v2, s[8:11], s22 offen offset:0 sc1
  buffer_load_dwordx4 a[84:87], v2, s[8:11], s22 offen offset:1024 sc1
  s_waitcnt vmcnt(8)
  buffer_load_dwordx4 a[88:91], v2, s[8:11], s22 offen offset:2048 sc1
  buffer_load_dwordx4 a[92:95], v2, s[8:11], s22 offen offset:3072 sc1
  s_waitcnt vmcnt(8)
  s_add_u32 s22, s20, 24576
  buffer_load_dwordx4 a[96:99], v2, s[8:11], s22 offen offset:0 sc1
  buffer_load_dwordx4 a[100:103], v2, s[8:11], s22 offen offset:1024 sc1
  s_waitcnt vmcnt(8)
  buffer_load_dwordx4 a[104:107], v2, s[8:11], s22 offen offset:2048 sc1
  buffer_load_dwordx4 a[108:111], v2, s[8:11], s22 offen offset:3072 sc1
  s_waitcnt vmcnt(8)
  s_add_u32 s22, s20, 28672
  buffer_load_dwordx4 a[112:115], v2, s[8:11], s22 offen offset:0 sc1
  buffer_load_dwordx4 a[116:119], v2, s[8:11], s22 offen offset:1024 sc1
  s_waitcnt vmcnt(8)
  buffer_load_dwordx4 a[120:123], v2, s[8:11], s22 offen offset:2048 sc1
  buffer_load_dwordx4 a[124:127], v2, s[8:11], s22 offen offset:3072 sc1
  s_waitcnt vmcnt(8)
  s_add_u32 s22, s20, 32768
  buffer_load_dwordx4 a[128:131], v2, s[8:11], s22 offen offset:0 sc1
  buffer_load_dwordx4 a[132:135], v2, s[8:11], s22 offen offset:1024 sc1
  s_waitcnt vmcnt(8)
  buffer_load_dwordx4 a[136:139], v2, s[8:11], s22 offen offset:2048 sc1
  buffer_load_dwordx4 a[140:143], v2, s[8:11], s22 offen offset:3072 sc1
  s_waitcnt vmcnt(8)
  s_add_u32 s22, s20, 36864
  buffer_load_dwordx4 a[144:147], v2, s[8:11], s22 offen offset:0 sc1
  buffer_load_dwordx4 a[148:151], v2, s[8:11], s22 offen offset:1024 sc1
  s_waitcnt vmcnt(8)
  buffer_load_dwordx4 a[152:155], v2, s[8:11], s22 offen offset:2048 sc1
  buffer_load_dwordx4 a[156:159], v2, s[8:11], s22 offen offset:3072 sc1
  s_waitcnt vmcnt(8)
  s_add_u32 s22, s20, 40960
  buffer_load_dwordx4 a[160:163], v2, s[8:11], s22 offen offset:0 sc1
  buffer_load_dwordx4 a[164:167], v2, s[8:11], s22 offen offset:1024 sc1
  s_waitcnt vmcnt(8)
  buffer_load_dwordx4 a[168:171], v2, s[8:11], s22 offen offset:2048 sc1
  buffer_load_dwordx4 a[172:175], v2, s[8:11], s22 offen offset:3072 sc1
  s_waitcnt vmcnt(8)
  s_add_u32 s22, s20, 45056
  buffer_load_dwordx4 a[176:179], v2, s[8:11], s22 offen offset:0 sc1
  buffer_load_dwordx4 a[180:183], v2, s[8:11], s22 offen offset:1024 sc1
  s_waitcnt vmcnt(8)
  buffer_load_dwordx4 a[184:187], v2, s[8:11], s22 offen offset:2048 sc1
  buffer_load_dwordx4 a[188:191], v2, s[8:11], s22 offen offset:3072 sc1
  s_waitcnt vmcnt(8)
  s_add_u32 s22, s20, 49152
  buffer_load_dwordx4 a[192:195], v2, s[8:11], s22 offen offset:0 sc1
  buffer_load_dwordx4 a[196:199], v2, s[8:11], s22 offen offset:1024 sc1
  s_waitcnt vmcnt(8)
  buffer_load_dwordx4 a[200:203], v2, s[8:11], s22 offen offset:2048 sc1
  buffer_load_dwordx4 a[204:207], v2, s[8:11], s22 offen offset:3072 sc1
  s_waitcnt vmcnt(8)
  s_add_u32 s22, s20, 53248
  buffer_load_dwordx4 a[208:211], v2, s[8:11], s22 offen offset:0 sc1
  buffer_load_dwordx4 a[212:215], v2, s[8:11], s22 offen offset:1024 sc1
  s_waitcnt vmcnt(8)
  buffer_load_dwordx4 a[216:219], v2, s[8:11], s22 offen offset:2048 sc1
  buffer_load_dwordx4 a[220:223], v2, s[8:11], s22 offen offset:3072 sc1
  s_waitcnt vmcnt(8)
  s_add_u32 s22, s20, 57344
  buffer_load_dwordx4 a[224:227], v2, s[8:11], s22 offen offset:0 sc1
  buffer_load_dwordx4 a[228:231], v2, s[8:11], s22 offen offset:1024 sc1
  s_waitcnt vmcnt(8)
  buffer_load_dwordx4 a[232:235], v2, s[8:11], s22 offen offset:2048 sc1
  buffer_load_dwordx4 a[236:239], v2, s[8:11], s22 offen offset:3072 sc1
  s_waitcnt vmcnt(8)
  s_add_u32 s22, s20, 61440
  buffer_load_dwordx4 a[240:243], v2, s[8:11], s22 offen offset:0 sc1
  buffer_load_dwordx4 a[244:247], v2, s[8:11], s22 offen offset:1024 sc1
  s_waitcnt vmcnt(8)
  buffer_load_dwordx4 a[248:251], v2, s[8:11], s22 offen offset:2048 sc1
  buffer_load_dwordx4 a[252:255], v2, s[8:11], s22 offen offset:3072 sc1
  s_waitcnt vmcnt(8)
  s_add_u32 s22, s20, 65536
  buffer_load_dwordx4 v[120:123], v2, s[8:11], s22 offen offset:0 sc1
  buffer_load_dwordx4 v[124:127], v2, s[8:11], s22 offen offset:1024 sc1
  s_waitcnt vmcnt(8)
  buffer_load_dwordx4 v[128:131], v2, s[8:11], s22 offen offset:2048 sc1
  buffer_load_dwordx4 v[132:135], v2, s[8:11], s22 offen offset:3072 sc1
  s_waitcnt vmcnt(8)
  s_add_u32 s22, s20, 69632
  buffer_load_dwordx4 v[136:139], v2, s[8:11], s22 offen offset:0 sc1
  buffer_load_dwordx4 v[140:143], v2, s[8:11], s22 offen offset:1024 sc1
  s_waitcnt vmcnt(8)
  buffer_load_dwordx4 v[144:147], v2, s[8:11], s22 offen offset:2048 sc1
  buffer_load_dwordx4 v[148:151], v2, s[8:11], s22 offen offset:3072 sc1
  s_waitcnt vmcnt(8)
  s_add_u32 s22, s20, 73728
  buffer_load_dwordx4 v[152:155], v2, s[8:11], s22 offen offset:0 sc1
  buffer_load_dwordx4 v[156:159], v2, s[8:11], s22 offen offset:1024 sc1
  s_waitcnt vmcnt(8)
  buffer_load_dwordx4 v[160:163], v2, s[8:11], s22 offen offset:2048 sc1
  buffer_load_dwordx4 v[164:167], v2, s[8:11], s22 offen offset:3072 sc1
  s_waitcnt vmcnt(8)
  s_add_u32 s22, s20, 77824
  buffer_load_dwordx4 v[168:171], v2, s[8:11], s22 offen offset:0 sc1
  buffer_load_dwordx4 v[172:175], v2, s[8:11], s22 offen offset:1024 sc1
  s_waitcnt vmcnt(8)
  buffer_load_dwordx4 v[176:179], v2, s[8:11], s22 offen offset:2048 sc1
  buffer_load_dwordx4 v[180:183], v2, s[8:11], s22 offen offset:3072 sc1
  s_waitcnt vmcnt(8)
  s_add_u32 s22, s20, 81920
  buffer_load_dwordx4 v[184:187], v2, s[8:11], s22 offen offset:0 sc1
  buffer_load_dwordx4 v[188:191], v2, s[8:11], s22 offen offset:1024 sc1
  s_waitcnt vmcnt(8)
  buffer_load_dwordx4 v[192:195], v2, s[8:11], s22 offen offset:2048 sc1
  buffer_load_dwordx4 v[196:199], v2, s[8:11], s22 offen offset:3072 sc1
  s_waitcnt vmcnt(8)
  s_add_u32 s22, s20, 86016
  buffer_load_dwordx4 v[200:203], v2, s[8:11], s22 offen offset:0 sc1
  buffer_load_dwordx4 v[204:207], v2, s[8:11], s22 offen offset:1024 sc1
  s_waitcnt vmcnt(8)
  buffer_load_dwordx4 v[208:211], v2, s[8:11], s22 offen offset:2048 sc1
  buffer_load_dwordx4 v[212:215], v2, s[8:11], s22 offen offset:3072 sc1
  s_waitcnt vmcnt(8)
  s_add_u32 s22, s20, 90112
  buffer_load_dwordx4 v[216:219], v2, s[8:11], s22 offen offset:0 sc1
  buffer_load_dwordx4 v[220:223], v2, s[8:11], s22 offen offset:1024 sc1
  s_waitcnt vmcnt(8)
  buffer_load_dwordx4 v[224:227], v2, s[8:11], s22 offen offset:2048 sc1
  buffer_load_dwordx4 v[228:231], v2, s[8:11], s22 offen offset:3072 sc1
  s_waitcnt vmcnt(8)
  s_add_u32 s22, s20, 94208
  buffer_load_dwordx4 v[232:235], v2, s[8:11], s22 offen offset:0 sc1
  buffer_load_dwordx4 v[236:239], v2, s[8:11], s22 offen offset:1024 sc1
  s_waitcnt vmcnt(8)
  buffer_load_dwordx4 v[240:243], v2, s[8:11], s22 offen offset:2048 sc1
  buffer_load_dwordx4 v[244:247], v2, s[8:11], s22 offen offset:3072 sc1
  s_waitcnt vmcnt(8)
  s_add_u32 s22, s20, 98304
  buffer_load_dwordx4 v[248:251], v2, s[8:11], s22 offen offset:0 sc1
  buffer_load_dwordx4 v[252:255], v2, s[8:11], s22 offen offset:1024 sc1
  s_waitcnt vmcnt(8)
  v_mov_b32 v5, 0x4444
  v_mov_b32 v6, 0xeeee
  v_cmp_lt_u32 vcc, 7, v4
  s_nop 1
  v_cndmask_b32 v5, v5, v6, vcc
  s_lshl_b32 s23, s16, 11
  v_lshrrev_b32 v80, 1, v3
  v_and_b32 v81, 1, v3
  v_add_u32 v82, 0, v80
  v_lshl_add_u32 v82, v82, 4, v4
  v_mul_u32_u24 v83, 2341, v82
  v_lshrrev_b32 v83, 16, v83
  v_mul_u32_u24 v84, 28, v83
  v_sub_u32 v84, v82, v84
  v_lshrrev_b32 v85, 4, v84
  v_and_b32 v84, 15, v84
  v_lshlrev_b32 v86, 10, v85
  v_lshl_add_u32 v86, v83, 8, v86
  v_lshl_add_u32 v86, v84, 4, v86
  v_lshl_add_u32 v86, v81, 3, v86
  v_add_u32 v72, s23, v86
  v_add_u32 v82, 2, v80
  v_lshl_add_u32 v82, v82, 4, v4
  v_mul_u32_u24 v83, 2341, v82
  v_lshrrev_b32 v83, 16, v83
  v_mul_u32_u24 v84, 28, v83
  v_sub_u32 v84, v82, v84
  v_lshrrev_b32 v85, 4, v84
  v_and_b32 v84, 15, v84
  v_lshlrev_b32 v86, 10, v85
  v_lshl_add_u32 v86, v83, 8, v86
  v_lshl_add_u32 v86, v84, 4, v86
  v_lshl_add_u32 v86, v81, 3, v86
  v_add_u32 v73, s23, v86
  v_add_u32 v82, 4, v80
  v_lshl_add_u32 v82, v82, 4, v4
  v_mul_u32_u24 v83, 2341, v82
  v_lshrrev_b32 v83, 16, v83
  v_mul_u32_u24 v84, 28, v83
  v_sub_u32 v84, v82, v84
  v_lshrrev_b32 v85, 4, v84
  v_and_b32 v84, 15, v84
  v_lshlrev_b32 v86, 10, v85
  v_lshl_add_u32 v86, v83, 8, v86
  v_lshl_add_u32 v86, v84, 4, v86
  v_lshl_add_u32 v86, v81, 3, v86
  v_add_u32 v74, s23, v86
  v_mov_b32 v82, 6
  v_lshl_add_u32 v82, v82, 4, v4
  v_mul_u32_u24 v83, 2341, v82
  v_lshrrev_b32 v83, 16, v83
  v_mul_u32_u24 v84, 28, v83
  v_sub_u32 v84, v82, v84
  v_lshrrev_b32 v85, 4, v84
  v_and_b32 v84, 15, v84
  v_lshlrev_b32 v86, 10, v85
  v_lshl_add_u32 v86, v83, 8, v86
  v_lshl_add_u32 v86, v84, 4, v86
  v_lshl_add_u32 v86, v81, 3, v86
  v_add_u32 v75, s23, v86
  v_add_u32 v76, s23, v2
  s_mul_i32 s27, s18, 448
  v_mov_b32 v77, s27
  v_mov_b32 v78, 1
  s_mov_b32 s17, s19
  s_mul_i32 s24, s19, 7168
  s_add_u32 s24, s24, 65536
  s_mul_i32 s25, s18, 65
  s_add_u32 s25, s25, s19
  s_lshl_b32 s25, s25, 13
  s_add_u32 s25, s25, s23
  s_add_u32 s25, s25, 77602816
  s_lshl_b32 s26, s18, 6
  s_add_u32 s26, s26, s19
  s_lshl_b32 s26, s26, 4
  s_lshl_b32 s27, s16, 2
  s_add_u32 s26, s26, s27
  s_add_u32 s26, s26, 565248
  v_mov_b32 v88, 0
  v_mov_b32 v89, 0
  v_mov_b32 v90, 0
  v_mov_b32 v91, 0
  v_mov_b32 v92, -1
  v_mov_b32 v93, -1
  v_mov_b32 v94, -1
  v_mov_b32 v95, -1
  ds_write_b128 v76, v[88:91]
  ds_write_b128 v76, v[88:91] offset:1024
  s_mov_b32 s28, s25
  s_mov_b32 s29, 0
ws_arm:
  buffer_store_dwordx4 v[92:95], v2, s[8:11], s28 offen sc1
  buffer_store_dwordx4 v[92:95], v2, s[8:11], s28 offen offset:1024 sc1
  s_waitcnt vmcnt(8)
  s_add_u32 s28, s28, 16384
  s_add_u32 s29, s29, 1
  s_cmp_lt_u32 s29, 31
  s_cbranch_scc1 ws_arm
  s_waitcnt vmcnt(0)
  s_mov_b64 exec, 1
  buffer_store_dword v78, v2, s[8:11], s26 offen sc1
  s_mov_b64 exec, -1
ws_loop:
  v_mov_b32 v36, 0
  v_mov_b32 v37, 0
  v_mov_b32 v38, 0
  v_mov_b32 v39, 0
  v_mov_b32 v40, 0
  v_mov_b32 v41, 0
  v_mov_b32 v42, 0
  v_mov_b32 v43, 0
  v_mov_b32 v44, 0
  v_mov_b32 v45, 0
  v_mov_b32 v46, 0
  v_mov_b32 v47, 0
  v_mov_b32 v48, 0
  v_mov_b32 v49, 0
  v_mov_b32 v50, 0
  v_mov_b32 v51, 0
  v_mov_b32 v52, 0
  v_mov_b32 v53, 0
  v_mov_b32 v54, 0
  v_mov_b32 v55, 0
  v_mov_b32 v56, 0
  v_mov_b32 v57, 0
  v_mov_b32 v58, 0
  v_mov_b32 v59, 0
  v_mov_b32 v60, 0
  v_mov_b32 v61, 0
  v_mov_b32 v62, 0
  v_mov_b32 v63, 0
  s_mov_b32 s30, 0
  s_branch ws_fl
ws_pm:
  s_cmp_ge_u32 s17, 64
  s_cbranch_scc1 ws_fl
  buffer_load_dword v79, v77, s[8:11], s24 offen sc1
  s_waitcnt vmcnt(0)
  v_cmp_eq_u32 vcc, -1, v79
  s_cbranch_vccnz ws_pr
ws_fl:
  s_add_u32 s22, s24, 4096
  buffer_load_dwordx4 v[8:11], v2, s[8:11], s24 offen offset:0 sc1
  buffer_load_dwordx4 v[12:15], v2, s[8:11], s24 offen offset:1024 sc1
  buffer_load_dwordx4 v[16:19], v2, s[8:11], s24 offen offset:2048 sc1
  buffer_load_dwordx4 v[20:23], v2, s[8:11], s24 offen offset:3072 sc1
  buffer_load_dwordx4 v[24:27], v2, s[8:11], s22 offen offset:0 sc1
  buffer_load_dwordx4 v[28:31], v2, s[8:11], s22 offen offset:1024 sc1
  buffer_load_dwordx4 v[32:35], v2, s[8:11], s22 offen offset:2048 sc1
  s_waitcnt vmcnt(0)
  v_max_u32 v79, v8, v9
  v_max3_u32 v79, v79, v10, v11
  v_max3_u32 v79, v79, v12, v13
  v_max3_u32 v79, v79, v14, v15
  v_max3_u32 v79, v79, v16, v17
  v_max3_u32 v79, v79, v18, v19
  v_max3_u32 v79, v79, v20, v21
  v_max3_u32 v79, v79, v22, v23
  v_max3_u32 v79, v79, v24, v25
  v_max3_u32 v79, v79, v26, v27
  v_max3_u32 v79, v79, v28, v29
  v_max3_u32 v79, v79, v30, v31
  v_max3_u32 v79, v79, v32, v33
  v_max3_u32 v79, v79, v34, v35
  v_cmp_eq_u32 vcc, -1, v79
  s_cbranch_vccz ws_pk
ws_pr:
  s_sleep 6
  s_add_u32 s30, s30, 1
  s_cmp_lt_u32 s30, 2000000
  s_cbranch_scc1 ws_pm
  s_branch cA_abort
ws_pk:
  v_smfmac_f32_16x16x64_bf16 v[36:39], v[8:11], a[0:7], v5
  v_smfmac_f32_16x16x64_bf16 v[36:39], v[12:15], a[8:15], v5
  v_smfmac_f32_16x16x64_bf16 v[36:39], v[16:19], a[16:23], v5
  v_smfmac_f32_16x16x64_bf16 v[36:39], v[20:23], a[24:31], v5
  v_smfmac_f32_16x16x64_bf16 v[36:39], v[24:27], a[32:39], v5
  v_smfmac_f32_16x16x64_bf16 v[36:39], v[28:31], a[40:47], v5
  v_smfmac_f32_16x16x64_bf16 v[36:39], v[32:35], a[48:55], v5
  v_smfmac_f32_16x16x64_bf16 v[40:43], v[8:11], a[56:63], v5
  v_smfmac_f32_16x16x64_bf16 v[40:43], v[12:15], a[64:71], v5
  v_smfmac_f32_16x16x64_bf16 v[40:43], v[16:19], a[72:79], v5
  v_smfmac_f32_16x16x64_bf16 v[40:43], v[20:23], a[80:87], v5
  v_smfmac_f32_16x16x64_bf16 v[40:43], v[24:27], a[88:95], v5
  v_smfmac_f32_16x16x64_bf16 v[40:43], v[28:31], a[96:103], v5
  v_smfmac_f32_16x16x64_bf16 v[40:43], v[32:35], a[104:111], v5
  v_smfmac_f32_16x16x64_bf16 v[44:47], v[8:11], a[112:119], v5
  v_smfmac_f32_16x16x64_bf16 v[44:47], v[12:15], a[120:127], v5
  v_smfmac_f32_16x16x64_bf16 v[44:47], v[16:19], a[128:135], v5
  v_smfmac_f32_16x16x64_bf16 v[44:47], v[20:23], a[136:143], v5
  v_smfmac_f32_16x16x64_bf16 v[44:47], v[24:27], a[144:151], v5
  v_smfmac_f32_16x16x64_bf16 v[44:47], v[28:31], a[152:159], v5
  v_smfmac_f32_16x16x64_bf16 v[44:47], v[32:35], a[160:167], v5
  v_smfmac_f32_16x16x64_bf16 v[48:51], v[8:11], a[168:175], v5
  v_smfmac_f32_16x16x64_bf16 v[48:51], v[12:15], a[176:183], v5
  v_smfmac_f32_16x16x64_bf16 v[48:51], v[16:19], a[184:191], v5
  v_smfmac_f32_16x16x64_bf16 v[48:51], v[20:23], a[192:199], v5
  v_smfmac_f32_16x16x64_bf16 v[48:51], v[24:27], a[200:207], v5
  v_smfmac_f32_16x16x64_bf16 v[48:51], v[28:31], a[208:215], v5
  v_smfmac_f32_16x16x64_bf16 v[48:51], v[32:35], a[216:223], v5
  v_smfmac_f32_16x16x64_bf16 v[52:55], v[8:11], a[224:231], v5
  v_smfmac_f32_16x16x64_bf16 v[52:55], v[12:15], a[232:239], v5
  v_smfmac_f32_16x16x64_bf16 v[52:55], v[16:19], a[240:247], v5
  v_smfmac_f32_16x16x64_bf16 v[52:55], v[20:23], a[248:255], v5
  v_smfmac_f32_16x16x64_bf16 v[52:55], v[24:27], v[120:127], v5
  v_smfmac_f32_16x16x64_bf16 v[52:55], v[28:31], v[128:135], v5
  v_smfmac_f32_16x16x64_bf16 v[52:55], v[32:35], v[136:143], v5
  v_smfmac_f32_16x16x64_bf16 v[56:59], v[8:11], v[144:151], v5
  v_smfmac_f32_16x16x64_bf16 v[56:59], v[12:15], v[152:159], v5
  v_smfmac_f32_16x16x64_bf16 v[56:59], v[16:19], v[160:167], v5
  v_smfmac_f32_16x16x64_bf16 v[56:59], v[20:23], v[168:175], v5
  v_smfmac_f32_16x16x64_bf16 v[56:59], v[24:27], v[176:183], v5
  v_smfmac_f32_16x16x64_bf16 v[56:59], v[28:31], v[184:191], v5
  v_smfmac_f32_16x16x64_bf16 v[56:59], v[32:35], v[192:199], v5
  v_smfmac_f32_16x16x64_bf16 v[60:63], v[8:11], v[200:207], v5
  v_smfmac_f32_16x16x64_bf16 v[60:63], v[12:15], v[208:215], v5
  v_smfmac_f32_16x16x64_bf16 v[60:63], v[16:19], v[216:223], v5
  v_smfmac_f32_16x16x64_bf16 v[60:63], v[20:23], v[224:231], v5
  v_smfmac_f32_16x16x64_bf16 v[60:63], v[24:27], v[232:239], v5
  v_smfmac_f32_16x16x64_bf16 v[60:63], v[28:31], v[240:247], v5
  v_smfmac_f32_16x16x64_bf16 v[60:63], v[32:35], v[248:255], v5
  v_permlane32_swap_b32 v36, v40
  v_permlane32_swap_b32 v37, v41
  v_permlane32_swap_b32 v38, v42
  v_permlane32_swap_b32 v39, v43
  v_add_f32 v36, v36, v40
  v_add_f32 v37, v37, v41
  v_add_f32 v38, v38, v42
  v_add_f32 v39, v39, v43
  v_cvt_pk_bf16_f32 v40, v36, v37
  v_cvt_pk_bf16_f32 v41, v38, v39
  v_min_u32 v40, -2, v40
  v_min_u32 v41, -2, v41
  ds_write_b64 v72, v[40:41]
  v_permlane32_swap_b32 v44, v48
  v_permlane32_swap_b32 v45, v49
  v_permlane32_swap_b32 v46, v50
  v_permlane32_swap_b32 v47, v51
  v_add_f32 v44, v44, v48
  v_add_f32 v45, v45, v49
  v_add_f32 v46, v46, v50
  v_add_f32 v47, v47, v51
  v_cvt_pk_bf16_f32 v48, v44, v45
  v_cvt_pk_bf16_f32 v49, v46, v47
  v_min_u32 v48, -2, v48
  v_min_u32 v49, -2, v49
  ds_write_b64 v73, v[48:49]
  v_permlane32_swap_b32 v52, v56
  v_permlane32_swap_b32 v53, v57
  v_permlane32_swap_b32 v54, v58
  v_permlane32_swap_b32 v55, v59
  v_add_f32 v52, v52, v56
  v_add_f32 v53, v53, v57
  v_add_f32 v54, v54, v58
  v_add_f32 v55, v55, v59
  v_cvt_pk_bf16_f32 v56, v52, v53
  v_cvt_pk_bf16_f32 v57, v54, v55
  v_min_u32 v56, -2, v56
  v_min_u32 v57, -2, v57
  ds_write_b64 v74, v[56:57]
  v_mov_b32 v64, v60
  v_mov_b32 v65, v61
  v_mov_b32 v66, v62
  v_mov_b32 v67, v63
  v_permlane32_swap_b32 v60, v64
  v_permlane32_swap_b32 v61, v65
  v_permlane32_swap_b32 v62, v66
  v_permlane32_swap_b32 v63, v67
  v_add_f32 v60, v60, v64
  v_add_f32 v61, v61, v65
  v_add_f32 v62, v62, v66
  v_add_f32 v63, v63, v67
  v_cvt_pk_bf16_f32 v64, v60, v61
  v_cvt_pk_bf16_f32 v65, v62, v63
  v_min_u32 v64, -2, v64
  v_min_u32 v65, -2, v65
  ds_write_b64 v75, v[64:65]
  s_waitcnt lgkmcnt(0)
  ds_read_b128 v[64:67], v76
  ds_read_b128 v[68:71], v76 offset:1024
  s_waitcnt lgkmcnt(0)
  buffer_store_dwordx4 v[64:67], v2, s[8:11], s25 offen sc1
  buffer_store_dwordx4 v[68:71], v2, s[8:11], s25 offen offset:1024 sc1
  s_add_u32 s24, s24, 14336
  s_add_u32 s25, s25, 16384
  s_add_u32 s17, s17, 2
  s_cmp_lt_u32 s17, 62
  s_cbranch_scc1 ws_loop
  v_mov_b32 v250, 0
  s_branch wk_loop
wk_s4d:
  s_sub_u32 s3, s3, 640
  s_getreg_b32 s33, hwreg(HW_REG_XCC_ID)
  s_sub_u32 s33, s33, 2
  s_and_b32 s33, s33, 7
  s_min_u32 s33, s33, 6
  s_mov_b32 s35, 6
wk_s4c:
  s_lshl_b32 s34, s33, 7
  s_add_u32 s34, s34, 588416
  v_mov_b32 v4, 1
  v_mov_b32 v5, s34
  v_mov_b32 v6, 160000
  s_barrier
  s_cmp_lg_u32 s16, 0
  s_cbranch_scc1 wk_s4e1
  s_mov_b64 exec, 1
  buffer_atomic_add v4, v5, s[8:11], 0 offen sc0
  s_waitcnt vmcnt(0)
  ds_write_b32 v6, v4
  s_waitcnt lgkmcnt(0)
  s_mov_b64 exec, -1
wk_s4e1:
  s_barrier
  ds_read_b32 v4, v6
  s_waitcnt lgkmcnt(0)
  v_readfirstlane_b32 s3, v4
  s_cmp_lt_u32 s3, 16
  s_cbranch_scc1 wk_s4g
  s_mov_b32 s33, s35
  s_sub_u32 s35, s35, 1
  s_max_i32 s35, s35, 0
  s_branch wk_s4c
wk_s4g:
  s_lshl_b32 s33, s33, 4
  s_add_u32 s3, s3, s33
  s_load_dwordx8 s[40:47], s[0:1], 0
  s_load_dwordx4 s[48:51], s[0:1], 32
  s_load_dwordx2 s[52:53], s[0:1], 48
  s_load_dwordx2 s[54:55], s[0:1], 112
  v_lshrrev_b32 v1, 6, v0
  s_nop 0
  v_readfirstlane_b32 s16, v1
  v_and_b32 v1, 63, v0
  v_lshrrev_b32 v3, 4, v1
  v_and_b32 v4, 15, v1
  s_mul_i32 s17, s16, 24576
  s_waitcnt lgkmcnt(0)
  s_mov_b32 s60, s40
  s_and_b32 s61, s41, 0xffff
  s_mov_b32 s62, 1835008
  s_mov_b32 s63, 0x20000
  s_mov_b32 s64, s42
  s_and_b32 s65, s43, 0xffff
  s_mov_b32 s66, 229376
  s_mov_b32 s67, 0x20000
  s_mov_b32 s68, s44
  s_and_b32 s69, s45, 0xffff
  s_mov_b32 s70, 229376
  s_mov_b32 s71, 0x20000
  s_mov_b32 s72, s46
  s_and_b32 s73, s47, 0xffff
  s_mov_b32 s74, 229376
  s_mov_b32 s75, 0x20000
  s_mov_b32 s76, s48
  s_and_b32 s77, s49, 0xffff
  s_mov_b32 s78, 229376
  s_mov_b32 s79, 0x20000
  s_mov_b32 s80, s50
  s_and_b32 s81, s51, 0xffff
  s_mov_b32 s82, 896
  s_mov_b32 s83, 0x20000
  s_mov_b32 s84, s52
  s_and_b32 s85, s53, 0xffff
  s_mov_b32 s86, 896
  s_mov_b32 s87, 0x20000
  s_mov_b32 s88, s54
  s_and_b32 s89, s55, 0xffff
  s_mov_b32 s90, 3670016
  s_mov_b32 s91, 0x20000
  v_lshlrev_b32 v5, 5, v1
  v_sub_u32 v5, 2047, v5
  s_add_u32 s18, s17, 13056
  v_subrev_u32 v6, 0, v5
  v_max_i32 v7, 0, v6
  v_cvt_f32_u32 v7, v7
  v_cvt_pk_bf16_f32 v8, v7, v7
  v_and_b32 v7, 0xffff0000, v8
  v_lshrrev_b32 v8, 23, v7
  v_subrev_u32 v8, 134, v8
  v_max_i32 v8, 0, v8
  v_cvt_u32_f32 v7, v7
  v_lshrrev_b32 v7, v8, v7
  v_lshl_add_u32 v7, v8, 8, v7
  v_lshl_add_u32 v200, v7, 2, s18
  v_subrev_u32 v6, 1, v5
  v_max_i32 v7, 0, v6
  v_cvt_f32_u32 v7, v7
  v_cvt_pk_bf16_f32 v8, v7, v7
  v_and_b32 v7, 0xffff0000, v8
  v_lshrrev_b32 v8, 23, v7
  v_subrev_u32 v8, 134, v8
  v_max_i32 v8, 0, v8
  v_cvt_u32_f32 v7, v7
  v_lshrrev_b32 v7, v8, v7
  v_lshl_add_u32 v7, v8, 8, v7
  v_lshl_add_u32 v201, v7, 2, s18
  v_subrev_u32 v6, 2, v5
  v_max_i32 v7, 0, v6
  v_cvt_f32_u32 v7, v7
  v_cvt_pk_bf16_f32 v8, v7, v7
  v_and_b32 v7, 0xffff0000, v8
  v_lshrrev_b32 v8, 23, v7
  v_subrev_u32 v8, 134, v8
  v_max_i32 v8, 0, v8
  v_cvt_u32_f32 v7, v7
  v_lshrrev_b32 v7, v8, v7
  v_lshl_add_u32 v7, v8, 8, v7
  v_lshl_add_u32 v202, v7, 2, s18
  v_subrev_u32 v6, 3, v5
  v_max_i32 v7, 0, v6
  v_cvt_f32_u32 v7, v7
  v_cvt_pk_bf16_f32 v8, v7, v7
  v_and_b32 v7, 0xffff0000, v8
  v_lshrrev_b32 v8, 23, v7
  v_subrev_u32 v8, 134, v8
  v_max_i32 v8, 0, v8
  v_cvt_u32_f32 v7, v7
  v_lshrrev_b32 v7, v8, v7
  v_lshl_add_u32 v7, v8, 8, v7
  v_lshl_add_u32 v203, v7, 2, s18
  v_subrev_u32 v6, 4, v5
  v_max_i32 v7, 0, v6
  v_cvt_f32_u32 v7, v7
  v_cvt_pk_bf16_f32 v8, v7, v7
  v_and_b32 v7, 0xffff0000, v8
  v_lshrrev_b32 v8, 23, v7
  v_subrev_u32 v8, 134, v8
  v_max_i32 v8, 0, v8
  v_cvt_u32_f32 v7, v7
  v_lshrrev_b32 v7, v8, v7
  v_lshl_add_u32 v7, v8, 8, v7
  v_lshl_add_u32 v204, v7, 2, s18
  v_subrev_u32 v6, 5, v5
  v_max_i32 v7, 0, v6
  v_cvt_f32_u32 v7, v7
  v_cvt_pk_bf16_f32 v8, v7, v7
  v_and_b32 v7, 0xffff0000, v8
  v_lshrrev_b32 v8, 23, v7
  v_subrev_u32 v8, 134, v8
  v_max_i32 v8, 0, v8
  v_cvt_u32_f32 v7, v7
  v_lshrrev_b32 v7, v8, v7
  v_lshl_add_u32 v7, v8, 8, v7
  v_lshl_add_u32 v205, v7, 2, s18
  v_subrev_u32 v6, 6, v5
  v_max_i32 v7, 0, v6
  v_cvt_f32_u32 v7, v7
  v_cvt_pk_bf16_f32 v8, v7, v7
  v_and_b32 v7, 0xffff0000, v8
  v_lshrrev_b32 v8, 23, v7
  v_subrev_u32 v8, 134, v8
  v_max_i32 v8, 0, v8
  v_cvt_u32_f32 v7, v7
  v_lshrrev_b32 v7, v8, v7
  v_lshl_add_u32 v7, v8, 8, v7
  v_lshl_add_u32 v206, v7, 2, s18
  v_subrev_u32 v6, 7, v5
  v_max_i32 v7, 0, v6
  v_cvt_f32_u32 v7, v7
  v_cvt_pk_bf16_f32 v8, v7, v7
  v_and_b32 v7, 0xffff0000, v8
  v_lshrrev_b32 v8, 23, v7
  v_subrev_u32 v8, 134, v8
  v_max_i32 v8, 0, v8
  v_cvt_u32_f32 v7, v7
  v_lshrrev_b32 v7, v8, v7
  v_lshl_add_u32 v7, v8, 8, v7
  v_lshl_add_u32 v207, v7, 2, s18
  v_subrev_u32 v6, 8, v5
  v_max_i32 v7, 0, v6
  v_cvt_f32_u32 v7, v7
  v_cvt_pk_bf16_f32 v8, v7, v7
  v_and_b32 v7, 0xffff0000, v8
  v_lshrrev_b32 v8, 23, v7
  v_subrev_u32 v8, 134, v8
  v_max_i32 v8, 0, v8
  v_cvt_u32_f32 v7, v7
  v_lshrrev_b32 v7, v8, v7
  v_lshl_add_u32 v7, v8, 8, v7
  v_lshl_add_u32 v208, v7, 2, s18
  v_subrev_u32 v6, 9, v5
  v_max_i32 v7, 0, v6
  v_cvt_f32_u32 v7, v7
  v_cvt_pk_bf16_f32 v8, v7, v7
  v_and_b32 v7, 0xffff0000, v8
  v_lshrrev_b32 v8, 23, v7
  v_subrev_u32 v8, 134, v8
  v_max_i32 v8, 0, v8
  v_cvt_u32_f32 v7, v7
  v_lshrrev_b32 v7, v8, v7
  v_lshl_add_u32 v7, v8, 8, v7
  v_lshl_add_u32 v209, v7, 2, s18
  v_subrev_u32 v6, 10, v5
  v_max_i32 v7, 0, v6
  v_cvt_f32_u32 v7, v7
  v_cvt_pk_bf16_f32 v8, v7, v7
  v_and_b32 v7, 0xffff0000, v8
  v_lshrrev_b32 v8, 23, v7
  v_subrev_u32 v8, 134, v8
  v_max_i32 v8, 0, v8
  v_cvt_u32_f32 v7, v7
  v_lshrrev_b32 v7, v8, v7
  v_lshl_add_u32 v7, v8, 8, v7
  v_lshl_add_u32 v210, v7, 2, s18
  v_subrev_u32 v6, 11, v5
  v_max_i32 v7, 0, v6
  v_cvt_f32_u32 v7, v7
  v_cvt_pk_bf16_f32 v8, v7, v7
  v_and_b32 v7, 0xffff0000, v8
  v_lshrrev_b32 v8, 23, v7
  v_subrev_u32 v8, 134, v8
  v_max_i32 v8, 0, v8
  v_cvt_u32_f32 v7, v7
  v_lshrrev_b32 v7, v8, v7
  v_lshl_add_u32 v7, v8, 8, v7
  v_lshl_add_u32 v211, v7, 2, s18
  v_subrev_u32 v6, 12, v5
  v_max_i32 v7, 0, v6
  v_cvt_f32_u32 v7, v7
  v_cvt_pk_bf16_f32 v8, v7, v7
  v_and_b32 v7, 0xffff0000, v8
  v_lshrrev_b32 v8, 23, v7
  v_subrev_u32 v8, 134, v8
  v_max_i32 v8, 0, v8
  v_cvt_u32_f32 v7, v7
  v_lshrrev_b32 v7, v8, v7
  v_lshl_add_u32 v7, v8, 8, v7
  v_lshl_add_u32 v212, v7, 2, s18
  v_subrev_u32 v6, 13, v5
  v_max_i32 v7, 0, v6
  v_cvt_f32_u32 v7, v7
  v_cvt_pk_bf16_f32 v8, v7, v7
  v_and_b32 v7, 0xffff0000, v8
  v_lshrrev_b32 v8, 23, v7
  v_subrev_u32 v8, 134, v8
  v_max_i32 v8, 0, v8
  v_cvt_u32_f32 v7, v7
  v_lshrrev_b32 v7, v8, v7
  v_lshl_add_u32 v7, v8, 8, v7
  v_lshl_add_u32 v213, v7, 2, s18
  v_subrev_u32 v6, 14, v5
  v_max_i32 v7, 0, v6
  v_cvt_f32_u32 v7, v7
  v_cvt_pk_bf16_f32 v8, v7, v7
  v_and_b32 v7, 0xffff0000, v8
  v_lshrrev_b32 v8, 23, v7
  v_subrev_u32 v8, 134, v8
  v_max_i32 v8, 0, v8
  v_cvt_u32_f32 v7, v7
  v_lshrrev_b32 v7, v8, v7
  v_lshl_add_u32 v7, v8, 8, v7
  v_lshl_add_u32 v214, v7, 2, s18
  v_subrev_u32 v6, 15, v5
  v_max_i32 v7, 0, v6
  v_cvt_f32_u32 v7, v7
  v_cvt_pk_bf16_f32 v8, v7, v7
  v_and_b32 v7, 0xffff0000, v8
  v_lshrrev_b32 v8, 23, v7
  v_subrev_u32 v8, 134, v8
  v_max_i32 v8, 0, v8
  v_cvt_u32_f32 v7, v7
  v_lshrrev_b32 v7, v8, v7
  v_lshl_add_u32 v7, v8, 8, v7
  v_lshl_add_u32 v215, v7, 2, s18
  v_subrev_u32 v6, 16, v5
  v_max_i32 v7, 0, v6
  v_cvt_f32_u32 v7, v7
  v_cvt_pk_bf16_f32 v8, v7, v7
  v_and_b32 v7, 0xffff0000, v8
  v_lshrrev_b32 v8, 23, v7
  v_subrev_u32 v8, 134, v8
  v_max_i32 v8, 0, v8
  v_cvt_u32_f32 v7, v7
  v_lshrrev_b32 v7, v8, v7
  v_lshl_add_u32 v7, v8, 8, v7
  v_lshl_add_u32 v216, v7, 2, s18
  v_subrev_u32 v6, 17, v5
  v_max_i32 v7, 0, v6
  v_cvt_f32_u32 v7, v7
  v_cvt_pk_bf16_f32 v8, v7, v7
  v_and_b32 v7, 0xffff0000, v8
  v_lshrrev_b32 v8, 23, v7
  v_subrev_u32 v8, 134, v8
  v_max_i32 v8, 0, v8
  v_cvt_u32_f32 v7, v7
  v_lshrrev_b32 v7, v8, v7
  v_lshl_add_u32 v7, v8, 8, v7
  v_lshl_add_u32 v217, v7, 2, s18
  v_subrev_u32 v6, 18, v5
  v_max_i32 v7, 0, v6
  v_cvt_f32_u32 v7, v7
  v_cvt_pk_bf16_f32 v8, v7, v7
  v_and_b32 v7, 0xffff0000, v8
  v_lshrrev_b32 v8, 23, v7
  v_subrev_u32 v8, 134, v8
  v_max_i32 v8, 0, v8
  v_cvt_u32_f32 v7, v7
  v_lshrrev_b32 v7, v8, v7
  v_lshl_add_u32 v7, v8, 8, v7
  v_lshl_add_u32 v218, v7, 2, s18
  v_subrev_u32 v6, 19, v5
  v_max_i32 v7, 0, v6
  v_cvt_f32_u32 v7, v7
  v_cvt_pk_bf16_f32 v8, v7, v7
  v_and_b32 v7, 0xffff0000, v8
  v_lshrrev_b32 v8, 23, v7
  v_subrev_u32 v8, 134, v8
  v_max_i32 v8, 0, v8
  v_cvt_u32_f32 v7, v7
  v_lshrrev_b32 v7, v8, v7
  v_lshl_add_u32 v7, v8, 8, v7
  v_lshl_add_u32 v219, v7, 2, s18
  v_subrev_u32 v6, 20, v5
  v_max_i32 v7, 0, v6
  v_cvt_f32_u32 v7, v7
  v_cvt_pk_bf16_f32 v8, v7, v7
  v_and_b32 v7, 0xffff0000, v8
  v_lshrrev_b32 v8, 23, v7
  v_subrev_u32 v8, 134, v8
  v_max_i32 v8, 0, v8
  v_cvt_u32_f32 v7, v7
  v_lshrrev_b32 v7, v8, v7
  v_lshl_add_u32 v7, v8, 8, v7
  v_lshl_add_u32 v220, v7, 2, s18
  v_subrev_u32 v6, 21, v5
  v_max_i32 v7, 0, v6
  v_cvt_f32_u32 v7, v7
  v_cvt_pk_bf16_f32 v8, v7, v7
  v_and_b32 v7, 0xffff0000, v8
  v_lshrrev_b32 v8, 23, v7
  v_subrev_u32 v8, 134, v8
  v_max_i32 v8, 0, v8
  v_cvt_u32_f32 v7, v7
  v_lshrrev_b32 v7, v8, v7
  v_lshl_add_u32 v7, v8, 8, v7
  v_lshl_add_u32 v221, v7, 2, s18
  v_subrev_u32 v6, 22, v5
  v_max_i32 v7, 0, v6
  v_cvt_f32_u32 v7, v7
  v_cvt_pk_bf16_f32 v8, v7, v7
  v_and_b32 v7, 0xffff0000, v8
  v_lshrrev_b32 v8, 23, v7
  v_subrev_u32 v8, 134, v8
  v_max_i32 v8, 0, v8
  v_cvt_u32_f32 v7, v7
  v_lshrrev_b32 v7, v8, v7
  v_lshl_add_u32 v7, v8, 8, v7
  v_lshl_add_u32 v222, v7, 2, s18
  v_subrev_u32 v6, 23, v5
  v_max_i32 v7, 0, v6
  v_cvt_f32_u32 v7, v7
  v_cvt_pk_bf16_f32 v8, v7, v7
  v_and_b32 v7, 0xffff0000, v8
  v_lshrrev_b32 v8, 23, v7
  v_subrev_u32 v8, 134, v8
  v_max_i32 v8, 0, v8
  v_cvt_u32_f32 v7, v7
  v_lshrrev_b32 v7, v8, v7
  v_lshl_add_u32 v7, v8, 8, v7
  v_lshl_add_u32 v223, v7, 2, s18
  v_subrev_u32 v6, 24, v5
  v_max_i32 v7, 0, v6
  v_cvt_f32_u32 v7, v7
  v_cvt_pk_bf16_f32 v8, v7, v7
  v_and_b32 v7, 0xffff0000, v8
  v_lshrrev_b32 v8, 23, v7
  v_subrev_u32 v8, 134, v8
  v_max_i32 v8, 0, v8
  v_cvt_u32_f32 v7, v7
  v_lshrrev_b32 v7, v8, v7
  v_lshl_add_u32 v7, v8, 8, v7
  v_lshl_add_u32 v224, v7, 2, s18
  v_subrev_u32 v6, 25, v5
  v_max_i32 v7, 0, v6
  v_cvt_f32_u32 v7, v7
  v_cvt_pk_bf16_f32 v8, v7, v7
  v_and_b32 v7, 0xffff0000, v8
  v_lshrrev_b32 v8, 23, v7
  v_subrev_u32 v8, 134, v8
  v_max_i32 v8, 0, v8
  v_cvt_u32_f32 v7, v7
  v_lshrrev_b32 v7, v8, v7
  v_lshl_add_u32 v7, v8, 8, v7
  v_lshl_add_u32 v225, v7, 2, s18
  v_subrev_u32 v6, 26, v5
  v_max_i32 v7, 0, v6
  v_cvt_f32_u32 v7, v7
  v_cvt_pk_bf16_f32 v8, v7, v7
  v_and_b32 v7, 0xffff0000, v8
  v_lshrrev_b32 v8, 23, v7
  v_subrev_u32 v8, 134, v8
  v_max_i32 v8, 0, v8
  v_cvt_u32_f32 v7, v7
  v_lshrrev_b32 v7, v8, v7
  v_lshl_add_u32 v7, v8, 8, v7
  v_lshl_add_u32 v226, v7, 2, s18
  v_subrev_u32 v6, 27, v5
  v_max_i32 v7, 0, v6
  v_cvt_f32_u32 v7, v7
  v_cvt_pk_bf16_f32 v8, v7, v7
  v_and_b32 v7, 0xffff0000, v8
  v_lshrrev_b32 v8, 23, v7
  v_subrev_u32 v8, 134, v8
  v_max_i32 v8, 0, v8
  v_cvt_u32_f32 v7, v7
  v_lshrrev_b32 v7, v8, v7
  v_lshl_add_u32 v7, v8, 8, v7
  v_lshl_add_u32 v227, v7, 2, s18
  v_subrev_u32 v6, 28, v5
  v_max_i32 v7, 0, v6
  v_cvt_f32_u32 v7, v7
  v_cvt_pk_bf16_f32 v8, v7, v7
  v_and_b32 v7, 0xffff0000, v8
  v_lshrrev_b32 v8, 23, v7
  v_subrev_u32 v8, 134, v8
  v_max_i32 v8, 0, v8
  v_cvt_u32_f32 v7, v7
  v_lshrrev_b32 v7, v8, v7
  v_lshl_add_u32 v7, v8, 8, v7
  v_lshl_add_u32 v228, v7, 2, s18
  v_subrev_u32 v6, 29, v5
  v_max_i32 v7, 0, v6
  v_cvt_f32_u32 v7, v7
  v_cvt_pk_bf16_f32 v8, v7, v7
  v_and_b32 v7, 0xffff0000, v8
  v_lshrrev_b32 v8, 23, v7
  v_subrev_u32 v8, 134, v8
  v_max_i32 v8, 0, v8
  v_cvt_u32_f32 v7, v7
  v_lshrrev_b32 v7, v8, v7
  v_lshl_add_u32 v7, v8, 8, v7
  v_lshl_add_u32 v229, v7, 2, s18
  v_subrev_u32 v6, 30, v5
  v_max_i32 v7, 0, v6
  v_cvt_f32_u32 v7, v7
  v_cvt_pk_bf16_f32 v8, v7, v7
  v_and_b32 v7, 0xffff0000, v8
  v_lshrrev_b32 v8, 23, v7
  v_subrev_u32 v8, 134, v8
  v_max_i32 v8, 0, v8
  v_cvt_u32_f32 v7, v7
  v_lshrrev_b32 v7, v8, v7
  v_lshl_add_u32 v7, v8, 8, v7
  v_lshl_add_u32 v230, v7, 2, s18
  v_subrev_u32 v6, 31, v5
  v_max_i32 v7, 0, v6
  v_cvt_f32_u32 v7, v7
  v_cvt_pk_bf16_f32 v8, v7, v7
  v_and_b32 v7, 0xffff0000, v8
  v_lshrrev_b32 v8, 23, v7
  v_subrev_u32 v8, 134, v8
  v_max_i32 v8, 0, v8
  v_cvt_u32_f32 v7, v7
  v_lshrrev_b32 v7, v8, v7
  v_lshl_add_u32 v7, v8, 8, v7
  v_lshl_add_u32 v231, v7, 2, s18
  v_subrev_u32 v6, 32, v5
  v_max_i32 v7, 0, v6
  v_cvt_f32_u32 v7, v7
  v_cvt_pk_bf16_f32 v8, v7, v7
  v_and_b32 v7, 0xffff0000, v8
  v_lshrrev_b32 v8, 23, v7
  v_subrev_u32 v8, 134, v8
  v_max_i32 v8, 0, v8
  v_cvt_u32_f32 v7, v7
  v_lshrrev_b32 v7, v8, v7
  v_lshl_add_u32 v7, v8, 8, v7
  v_mov_b32 v8, 1280
  v_cmp_gt_i32 vcc, 0, v6
  s_nop 1
  v_cndmask_b32 v7, v7, v8, vcc
  v_lshl_add_u32 v232, v7, 2, s18
  v_mov_b32 v8, 0
  v_mov_b32 v9, 0
  v_lshlrev_b32 v5, 3, v1
  v_add_u32 v5, s17, v5
  ds_write_b64 v5, v[8:9]
  v_and_b32 v6, 15, v1
  v_lshlrev_b32 v6, 3, v6
  v_add_u32 v6, s17, v6
  ds_write_b64 v6, v[8:9] offset:8704
  ds_write_b64 v6, v[8:9] offset:12928
  v_mov_b32 v6, s17
  ds_write_b64 v6, v[8:9] offset:18176
  s_lshl_b32 s19, s3, 2
  s_add_u32 s20, s19, s16
  s_lshl_b32 s21, s3, 3
  v_mul_u32_u24 v5, 3584, v0
  s_add_u32 s22, s21, 0
  buffer_load_dwordx2 v[8:9], v5, s[60:63], s22 offen offset:0
  buffer_load_dwordx2 v[10:11], v5, s[60:63], s22 offen offset:896
  buffer_load_dwordx2 v[12:13], v5, s[60:63], s22 offen offset:1792
  buffer_load_dwordx2 v[14:15], v5, s[60:63], s22 offen offset:2688
  s_add_u32 s22, s21, 917504
  buffer_load_dwordx2 v[16:17], v5, s[60:63], s22 offen offset:0
  buffer_load_dwordx2 v[18:19], v5, s[60:63], s22 offen offset:896
  buffer_load_dwordx2 v[20:21], v5, s[60:63], s22 offen offset:1792
  buffer_load_dwordx2 v[22:23], v5, s[60:63], s22 offen offset:2688
  s_lshl_b32 s22, s20, 9
  v_lshlrev_b32 v6, 3, v1
  buffer_load_dwordx2 v[24:25], v6, s[64:67], s22 offen
  buffer_load_dwordx2 v[26:27], v6, s[68:71], s22 offen
  buffer_load_dwordx2 v[28:29], v6, s[72:75], s22 offen
  buffer_load_dwordx2 v[30:31], v6, s[76:79], s22 offen
  s_lshl_b32 s22, s20, 1
  v_mov_b32 v7, 0
  buffer_load_ushort v32, v7, s[80:83], s22 offen
  buffer_load_ushort v33, v7, s[84:87], s22 offen
  s_mov_b32 s24, 0x05040100
  s_mov_b32 s25, 0x07060302
  s_barrier
  s_waitcnt vmcnt(6)
  v_lshlrev_b32 v6, 3, v0
  v_perm_b32 v34, v10, v8, s24
  v_perm_b32 v35, v14, v12, s24
  v_add_u32 v36, 512, v6
  ds_write_b64 v36, v[34:35]
  v_perm_b32 v34, v10, v8, s25
  v_perm_b32 v35, v14, v12, s25
  v_add_u32 v36, 25088, v6
  ds_write_b64 v36, v[34:35]
  v_perm_b32 v34, v11, v9, s24
  v_perm_b32 v35, v15, v13, s24
  v_add_u32 v36, 49664, v6
  ds_write_b64 v36, v[34:35]
  v_perm_b32 v34, v11, v9, s25
  v_perm_b32 v35, v15, v13, s25
  v_add_u32 v36, 74240, v6
  ds_write_b64 v36, v[34:35]
  v_perm_b32 v34, v18, v16, s24
  v_perm_b32 v35, v22, v20, s24
  v_add_u32 v36, 2560, v6
  ds_write_b64 v36, v[34:35]
  v_perm_b32 v34, v18, v16, s25
  v_perm_b32 v35, v22, v20, s25
  v_add_u32 v36, 27136, v6
  ds_write_b64 v36, v[34:35]
  v_perm_b32 v34, v19, v17, s24
  v_perm_b32 v35, v23, v21, s24
  v_add_u32 v36, 51712, v6
  ds_write_b64 v36, v[34:35]
  v_perm_b32 v34, v19, v17, s25
  v_perm_b32 v35, v23, v21, s25
  v_add_u32 v36, 76288, v6
  ds_write_b64 v36, v[34:35]
  s_waitcnt vmcnt(0)
  s_mov_b32 s26, 1069066811
  s_mov_b32 s27, 1042479491
  v_lshlrev_b32 v32, 16, v32
  v_lshlrev_b32 v33, 16, v33
  v_mul_f32 v32, s26, v32
  v_exp_f32 v32, v32
  s_nop 0
  v_cvt_pk_bf16_f32 v34, v32, v32
  v_and_b32 v32, 0xffff0000, v34
  v_lshlrev_b32 v37, 6, v1
  v_add_u32 v37, s17, v37
  v_lshlrev_b32 v40, 16, v24
  v_lshlrev_b32 v41, 16, v26
  v_lshlrev_b32 v42, 16, v28
  v_lshlrev_b32 v43, 16, v30
  v_mul_f32 v40, s26, v40
  v_exp_f32 v40, v40
  s_nop 0
  v_cvt_pk_bf16_f32 v34, v40, v40
  v_and_b32 v40, 0xffff0000, v34
  v_mul_f32 v40, v40, v32
  v_mul_f32 v40, s26, v40
  v_sub_f32 v40, 0, v40
  v_mul_f32 v41, v41, v32
  v_mul_f32 v41, s27, v41
  v_mul_f32 v42, v42, v32
  v_mul_f32 v43, v43, v32
  v_add_f32 v42, v42, v42
  v_add_f32 v43, v43, v43
  ds_write_b128 v37, v[40:43] offset:18240
  v_and_b32 v40, 0xffff0000, v24
  v_and_b32 v41, 0xffff0000, v26
  v_and_b32 v42, 0xffff0000, v28
  v_and_b32 v43, 0xffff0000, v30
  v_mul_f32 v40, s26, v40
  v_exp_f32 v40, v40
  s_nop 0
  v_cvt_pk_bf16_f32 v34, v40, v40
  v_and_b32 v40, 0xffff0000, v34
  v_mul_f32 v40, v40, v32
  v_mul_f32 v40, s26, v40
  v_sub_f32 v40, 0, v40
  v_mul_f32 v41, v41, v32
  v_mul_f32 v41, s27, v41
  v_mul_f32 v42, v42, v32
  v_mul_f32 v43, v43, v32
  v_add_f32 v42, v42, v42
  v_add_f32 v43, v43, v43
  ds_write_b128 v37, v[40:43] offset:18256
  v_lshlrev_b32 v40, 16, v25
  v_lshlrev_b32 v41, 16, v27
  v_lshlrev_b32 v42, 16, v29
  v_lshlrev_b32 v43, 16, v31
  v_mul_f32 v40, s26, v40
  v_exp_f32 v40, v40
  s_nop 0
  v_cvt_pk_bf16_f32 v34, v40, v40
  v_and_b32 v40, 0xffff0000, v34
  v_mul_f32 v40, v40, v32
  v_mul_f32 v40, s26, v40
  v_sub_f32 v40, 0, v40
  v_mul_f32 v41, v41, v32
  v_mul_f32 v41, s27, v41
  v_mul_f32 v42, v42, v32
  v_mul_f32 v43, v43, v32
  v_add_f32 v42, v42, v42
  v_add_f32 v43, v43, v43
  ds_write_b128 v37, v[40:43] offset:18272
  v_and_b32 v40, 0xffff0000, v25
  v_and_b32 v41, 0xffff0000, v27
  v_and_b32 v42, 0xffff0000, v29
  v_and_b32 v43, 0xffff0000, v31
  v_mul_f32 v40, s26, v40
  v_exp_f32 v40, v40
  s_nop 0
  v_cvt_pk_bf16_f32 v34, v40, v40
  v_and_b32 v40, 0xffff0000, v34
  v_mul_f32 v40, v40, v32
  v_mul_f32 v40, s26, v40
  v_sub_f32 v40, 0, v40
  v_mul_f32 v41, v41, v32
  v_mul_f32 v41, s27, v41
  v_mul_f32 v42, v42, v32
  v_mul_f32 v43, v43, v32
  v_add_f32 v42, v42, v42
  v_add_f32 v43, v43, v43
  ds_write_b128 v37, v[40:43] offset:18288
  v_cvt_f32_u32 v44, v4
  v_lshlrev_b32 v45, 4, v4
  v_cvt_f32_u32 v45, v45
  v_lshlrev_b32 v46, 4, v3
  v_add_u32 v46, s17, v46
  v_mov_b32 v48, 0
  v_mov_b32 v49, 0
  v_mov_b32 v50, 0
  v_mov_b32 v51, 0
  v_mov_b32 v52, 0
  v_mov_b32 v53, 0
  v_mov_b32 v54, 0
  v_mov_b32 v55, 0
  v_mov_b32 v56, 0
  v_mov_b32 v57, 0
  v_mov_b32 v58, 0
  v_mov_b32 v59, 0
  v_mov_b32 v60, 0
  v_mov_b32 v61, 0
  v_mov_b32 v62, 0
  v_mov_b32 v63, 0
  v_mov_b32 v64, 0
  v_mov_b32 v65, 0
  v_mov_b32 v66, 0
  v_mov_b32 v67, 0
  s_mov_b32 s28, 0
  s_waitcnt lgkmcnt(0)
  ds_read_b128 v[68:71], v46 offset:18240
wk_kl:
  s_waitcnt lgkmcnt(0)
  v_mov_b32 v72, v68
  v_mov_b32 v73, v69
  v_mov_b32 v74, v70
  v_mov_b32 v75, v71
  v_add_u32 v46, 64, v46
  ds_read_b128 v[68:71], v46 offset:18240
  v_mul_f32 v80, v72, v45
  v_mul_f32 v81, v73, v45
  v_exp_f32 v80, v80
  v_fract_f32 v81, v81
  v_cos_f32 v76, v81
  v_sin_f32 v77, v81
  v_mul_f32 v76, v76, v80
  v_mul_f32 v77, v77, v80
  v_mul_f32 v80, v72, v44
  v_mul_f32 v81, v73, v44
  v_exp_f32 v80, v80
  v_fract_f32 v81, v81
  v_cos_f32 v78, v81
  v_sin_f32 v79, v81
  v_mul_f32 v78, v78, v80
  v_mul_f32 v79, v79, v80
  v_mul_f32 v82, v74, v76
  v_mul_f32 v83, v74, v77
  v_fma_f32 v82, -v75, v77, v82
  v_fma_f32 v83, -v75, v76, -v83
  v_mul_f32 v86, v76, v76
  v_mul_f32 v87, v76, v77
  v_fma_f32 v86, -v77, v77, v86
  v_add_f32 v87, v87, v87
  v_mfma_f32_16x16x4_f32 v[48:51], v82, v78, v[48:51]
  v_mul_f32 v88, v78, v78
  v_mul_f32 v89, v78, v79
  v_fma_f32 v88, -v79, v79, v88
  v_add_f32 v89, v89, v89
  v_mfma_f32_16x16x4_f32 v[48:51], v83, v79, v[48:51]
  v_mul_f32 v84, v74, v86
  v_mul_f32 v85, v74, v87
  v_fma_f32 v84, -v75, v87, v84
  v_fma_f32 v85, -v75, v86, -v85
  v_mul_f32 v76, v86, v86
  v_mul_f32 v77, v86, v87
  v_fma_f32 v76, -v87, v87, v76
  v_add_f32 v77, v77, v77
  v_mfma_f32_16x16x4_f32 v[52:55], v84, v88, v[52:55]
  v_mul_f32 v78, v88, v88
  v_mul_f32 v79, v88, v89
  v_fma_f32 v78, -v89, v89, v78
  v_add_f32 v79, v79, v79
  v_mfma_f32_16x16x4_f32 v[52:55], v85, v89, v[52:55]
  v_mul_f32 v82, v74, v76
  v_mul_f32 v83, v74, v77
  v_fma_f32 v82, -v75, v77, v82
  v_fma_f32 v83, -v75, v76, -v83
  v_mul_f32 v86, v76, v76
  v_mul_f32 v87, v76, v77
  v_fma_f32 v86, -v77, v77, v86
  v_add_f32 v87, v87, v87
  v_mfma_f32_16x16x4_f32 v[56:59], v82, v78, v[56:59]
  v_mul_f32 v88, v78, v78
  v_mul_f32 v89, v78, v79
  v_fma_f32 v88, -v79, v79, v88
  v_add_f32 v89, v89, v89
  v_mfma_f32_16x16x4_f32 v[56:59], v83, v79, v[56:59]
  v_mul_f32 v84, v74, v86
  v_mul_f32 v85, v74, v87
  v_fma_f32 v84, -v75, v87, v84
  v_fma_f32 v85, -v75, v86, -v85
  v_mul_f32 v76, v86, v86
  v_mul_f32 v77, v86, v87
  v_fma_f32 v76, -v87, v87, v76
  v_add_f32 v77, v77, v77
  v_mfma_f32_16x16x4_f32 v[60:63], v84, v88, v[60:63]
  v_mfma_f32_16x16x4_f32 v[60:63], v85, v89, v[60:63]
  v_mul_f32 v82, v74, v76
  v_fma_f32 v82, -v75, v77, v82
  s_nop 1
  v_mfma_f32_16x16x4_f32 v[64:67], v82, v88, v[64:67]
  s_add_u32 s28, s28, 1
  s_cmp_lt_u32 s28, 64
  s_cbranch_scc1 wk_kl
  s_nop 15
  s_nop 3
  v_lshlrev_b32 v46, 8, v3
  v_lshl_add_u32 v46, v4, 2, v46
  v_add_u32 v46, s17, v46
  ds_write_b32 v46, v48 offset:13056
  ds_write_b32 v46, v49 offset:13120
  ds_write_b32 v46, v50 offset:13184
  ds_write_b32 v46, v51 offset:13248
  s_waitcnt lgkmcnt(8)
  ds_write_b32 v46, v52 offset:14080
  ds_write_b32 v46, v53 offset:14144
  ds_write_b32 v46, v54 offset:14208
  ds_write_b32 v46, v55 offset:14272
  s_waitcnt lgkmcnt(8)
  ds_write_b32 v46, v56 offset:15104
  ds_write_b32 v46, v57 offset:15168
  ds_write_b32 v46, v58 offset:15232
  ds_write_b32 v46, v59 offset:15296
  s_waitcnt lgkmcnt(8)
  ds_write_b32 v46, v60 offset:16128
  ds_write_b32 v46, v61 offset:16192
  ds_write_b32 v46, v62 offset:16256
  ds_write_b32 v46, v63 offset:16320
  s_waitcnt lgkmcnt(8)
  ds_write_b32 v46, v64 offset:17152
  ds_write_b32 v46, v65 offset:17216
  ds_write_b32 v46, v66 offset:17280
  ds_write_b32 v46, v67 offset:17344
  s_waitcnt lgkmcnt(8)
  s_waitcnt lgkmcnt(0)
  ds_read_b32 v48, v200
  ds_read_b32 v49, v201
  ds_read_b32 v50, v202
  ds_read_b32 v51, v203
  ds_read_b32 v52, v204
  ds_read_b32 v53, v205
  ds_read_b32 v54, v206
  ds_read_b32 v55, v207
  s_waitcnt lgkmcnt(4)
  ds_read_b32 v56, v208
  ds_read_b32 v57, v209
  ds_read_b32 v58, v210
  ds_read_b32 v59, v211
  ds_read_b32 v60, v212
  ds_read_b32 v61, v213
  ds_read_b32 v62, v214
  ds_read_b32 v63, v215
  s_waitcnt lgkmcnt(4)
  ds_read_b32 v64, v216
  ds_read_b32 v65, v217
  ds_read_b32 v66, v218
  ds_read_b32 v67, v219
  ds_read_b32 v68, v220
  ds_read_b32 v69, v221
  ds_read_b32 v70, v222
  ds_read_b32 v71, v223
  s_waitcnt lgkmcnt(4)
  ds_read_b32 v72, v224
  ds_read_b32 v73, v225
  ds_read_b32 v74, v226
  ds_read_b32 v75, v227
  ds_read_b32 v76, v228
  ds_read_b32 v77, v229
  ds_read_b32 v78, v230
  ds_read_b32 v79, v231
  s_waitcnt lgkmcnt(4)
  ds_read_b32 v80, v232
  s_waitcnt lgkmcnt(0)
  v_lshlrev_b32 v46, 6, v1
  v_add_u32 v46, s17, v46
  v_cvt_pk_bf16_f32 v84, v48, v49
  v_cvt_pk_bf16_f32 v88, v49, v50
  v_cvt_pk_bf16_f32 v85, v50, v51
  v_cvt_pk_bf16_f32 v89, v51, v52
  v_cvt_pk_bf16_f32 v86, v52, v53
  v_cvt_pk_bf16_f32 v90, v53, v54
  v_cvt_pk_bf16_f32 v87, v54, v55
  v_cvt_pk_bf16_f32 v91, v55, v56
  ds_write_b128 v46, v[84:87] offset:4608
  ds_write_b128 v46, v[88:91] offset:8832
  s_waitcnt lgkmcnt(0)
  v_cvt_pk_bf16_f32 v84, v56, v57
  v_cvt_pk_bf16_f32 v88, v57, v58
  v_cvt_pk_bf16_f32 v85, v58, v59
  v_cvt_pk_bf16_f32 v89, v59, v60
  v_cvt_pk_bf16_f32 v86, v60, v61
  v_cvt_pk_bf16_f32 v90, v61, v62
  v_cvt_pk_bf16_f32 v87, v62, v63
  v_cvt_pk_bf16_f32 v91, v63, v64
  ds_write_b128 v46, v[84:87] offset:4624
  ds_write_b128 v46, v[88:91] offset:8848
  s_waitcnt lgkmcnt(0)
  v_cvt_pk_bf16_f32 v84, v64, v65
  v_cvt_pk_bf16_f32 v88, v65, v66
  v_cvt_pk_bf16_f32 v85, v66, v67
  v_cvt_pk_bf16_f32 v89, v67, v68
  v_cvt_pk_bf16_f32 v86, v68, v69
  v_cvt_pk_bf16_f32 v90, v69, v70
  v_cvt_pk_bf16_f32 v87, v70, v71
  v_cvt_pk_bf16_f32 v91, v71, v72
  ds_write_b128 v46, v[84:87] offset:4640
  ds_write_b128 v46, v[88:91] offset:8864
  s_waitcnt lgkmcnt(0)
  v_cvt_pk_bf16_f32 v84, v72, v73
  v_cvt_pk_bf16_f32 v88, v73, v74
  v_cvt_pk_bf16_f32 v85, v74, v75
  v_cvt_pk_bf16_f32 v89, v75, v76
  v_cvt_pk_bf16_f32 v86, v76, v77
  v_cvt_pk_bf16_f32 v90, v77, v78
  v_cvt_pk_bf16_f32 v87, v78, v79
  v_cvt_pk_bf16_f32 v91, v79, v80
  ds_write_b128 v46, v[84:87] offset:4656
  ds_write_b128 v46, v[88:91] offset:8880
  s_waitcnt lgkmcnt(0)
  s_barrier
  v_lshrrev_b32 v47, 1, v3
  v_sub_u32 v46, v4, v47
  v_add_u32 v46, 1, v46
  v_lshlrev_b32 v46, 5, v46
  v_and_b32 v48, 1, v3
  v_lshl_add_u32 v46, v48, 4, v46
  v_add_u32 v46, s17, v46
  ds_read_b128 a[0:3], v46 offset:32
  ds_read_b128 a[4:7], v46 offset:96
  ds_read_b128 a[8:11], v46 offset:160
  ds_read_b128 a[12:15], v46 offset:224
  ds_read_b128 a[16:19], v46 offset:288
  ds_read_b128 a[20:23], v46 offset:352
  ds_read_b128 a[24:27], v46 offset:416
  ds_read_b128 a[28:31], v46 offset:480
  s_waitcnt lgkmcnt(4)
  ds_read_b128 a[32:35], v46 offset:544
  ds_read_b128 a[36:39], v46 offset:608
  ds_read_b128 a[40:43], v46 offset:672
  ds_read_b128 a[44:47], v46 offset:736
  ds_read_b128 a[48:51], v46 offset:800
  ds_read_b128 a[52:55], v46 offset:864
  ds_read_b128 a[56:59], v46 offset:928
  ds_read_b128 a[60:63], v46 offset:992
  s_waitcnt lgkmcnt(4)
  ds_read_b128 a[64:67], v46 offset:1056
  ds_read_b128 a[68:71], v46 offset:1120
  ds_read_b128 a[72:75], v46 offset:1184
  ds_read_b128 a[76:79], v46 offset:1248
  ds_read_b128 a[80:83], v46 offset:1312
  ds_read_b128 a[84:87], v46 offset:1376
  ds_read_b128 a[88:91], v46 offset:1440
  ds_read_b128 a[92:95], v46 offset:1504
  s_waitcnt lgkmcnt(4)
  ds_read_b128 a[96:99], v46 offset:1568
  ds_read_b128 a[100:103], v46 offset:1632
  ds_read_b128 a[104:107], v46 offset:1696
  ds_read_b128 a[108:111], v46 offset:1760
  ds_read_b128 a[112:115], v46 offset:1824
  ds_read_b128 a[116:119], v46 offset:1888
  ds_read_b128 a[120:123], v46 offset:1952
  ds_read_b128 a[124:127], v46 offset:2016
  s_waitcnt lgkmcnt(4)
  ds_read_b128 a[128:131], v46 offset:2080
  ds_read_b128 a[132:135], v46 offset:2144
  ds_read_b128 a[136:139], v46 offset:2208
  ds_read_b128 a[140:143], v46 offset:2272
  ds_read_b128 a[144:147], v46 offset:2336
  ds_read_b128 a[148:151], v46 offset:2400
  ds_read_b128 a[152:155], v46 offset:2464
  ds_read_b128 a[156:159], v46 offset:2528
  s_waitcnt lgkmcnt(4)
  ds_read_b128 a[160:163], v46 offset:2592
  ds_read_b128 a[164:167], v46 offset:2656
  ds_read_b128 a[168:171], v46 offset:2720
  ds_read_b128 a[172:175], v46 offset:2784
  ds_read_b128 a[176:179], v46 offset:2848
  ds_read_b128 a[180:183], v46 offset:2912
  ds_read_b128 a[184:187], v46 offset:2976
  ds_read_b128 a[188:191], v46 offset:3040
  s_waitcnt lgkmcnt(4)
  ds_read_b128 a[192:195], v46 offset:3104
  ds_read_b128 a[196:199], v46 offset:3168
  ds_read_b128 a[200:203], v46 offset:3232
  ds_read_b128 a[204:207], v46 offset:3296
  ds_read_b128 a[208:211], v46 offset:3360
  ds_read_b128 a[212:215], v46 offset:3424
  ds_read_b128 a[216:219], v46 offset:3488
  ds_read_b128 a[220:223], v46 offset:3552
  s_waitcnt lgkmcnt(4)
  ds_read_b128 a[224:227], v46 offset:3616
  ds_read_b128 a[228:231], v46 offset:3680
  ds_read_b128 a[232:235], v46 offset:3744
  ds_read_b128 a[236:239], v46 offset:3808
  ds_read_b128 a[240:243], v46 offset:3872
  ds_read_b128 a[244:247], v46 offset:3936
  ds_read_b128 a[248:251], v46 offset:4000
  ds_read_b128 a[252:255], v46 offset:4064
  s_waitcnt lgkmcnt(4)
  v_lshlrev_b32 v49, 4, v47
  v_add_u32 v49, v49, v4
  v_sub_u32 v49, 2047, v49
  v_lshl_add_u32 v49, v48, 3, v49
  v_and_b32 v50, 1, v49
  v_lshrrev_b32 v49, 1, v49
  v_lshlrev_b32 v49, 2, v49
  v_mul_u32_u24 v50, 4224, v50
  v_add3_u32 v49, v49, v50, s17
  v_add_u32 v49, 4608, v49
  v_subrev_u32 v52, 896, v49
  v_subrev_u32 v53, 1856, v49
  v_subrev_u32 v54, 2816, v49
  v_subrev_u32 v55, 3776, v49
  v_subrev_u32 v56, 4736, v49
  s_waitcnt lgkmcnt(0)
  ds_read2_b32 v[92:93], v52 offset0:224 offset1:225
  ds_read2_b32 v[94:95], v52 offset0:226 offset1:227
  ds_read2_b32 v[96:97], v52 offset0:208 offset1:209
  ds_read2_b32 v[98:99], v52 offset0:210 offset1:211
  ds_read2_b32 v[100:101], v52 offset0:192 offset1:193
  ds_read2_b32 v[102:103], v52 offset0:194 offset1:195
  ds_read2_b32 v[104:105], v52 offset0:176 offset1:177
  ds_read2_b32 v[106:107], v52 offset0:178 offset1:179
  s_waitcnt lgkmcnt(6)
  v_mfma_f32_16x16x32_bf16 v[60:63], v[92:95], a[28:31], 0
  v_mfma_f32_16x16x32_bf16 v[64:67], v[92:95], a[60:63], 0
  v_mfma_f32_16x16x32_bf16 v[68:71], v[92:95], a[92:95], 0
  v_mfma_f32_16x16x32_bf16 v[72:75], v[92:95], a[124:127], 0
  v_mfma_f32_16x16x32_bf16 v[76:79], v[92:95], a[156:159], 0
  v_mfma_f32_16x16x32_bf16 v[80:83], v[92:95], a[188:191], 0
  v_mfma_f32_16x16x32_bf16 v[84:87], v[92:95], a[220:223], 0
  v_mfma_f32_16x16x32_bf16 v[88:91], v[92:95], a[252:255], 0
  ds_read2_b32 v[92:93], v52 offset0:160 offset1:161
  ds_read2_b32 v[94:95], v52 offset0:162 offset1:163
  s_waitcnt lgkmcnt(6)
  v_mfma_f32_16x16x32_bf16 v[60:63], v[96:99], a[24:27], v[60:63]
  v_mfma_f32_16x16x32_bf16 v[64:67], v[96:99], a[56:59], v[64:67]
  v_mfma_f32_16x16x32_bf16 v[68:71], v[96:99], a[88:91], v[68:71]
  v_mfma_f32_16x16x32_bf16 v[72:75], v[96:99], a[120:123], v[72:75]
  v_mfma_f32_16x16x32_bf16 v[76:79], v[96:99], a[152:155], v[76:79]
  v_mfma_f32_16x16x32_bf16 v[80:83], v[96:99], a[184:187], v[80:83]
  v_mfma_f32_16x16x32_bf16 v[84:87], v[96:99], a[216:219], v[84:87]
  v_mfma_f32_16x16x32_bf16 v[88:91], v[96:99], a[248:251], v[88:91]
  ds_read2_b32 v[96:97], v52 offset0:144 offset1:145
  ds_read2_b32 v[98:99], v52 offset0:146 offset1:147
  s_waitcnt lgkmcnt(6)
  v_mfma_f32_16x16x32_bf16 v[60:63], v[100:103], a[20:23], v[60:63]
  v_mfma_f32_16x16x32_bf16 v[64:67], v[100:103], a[52:55], v[64:67]
  v_mfma_f32_16x16x32_bf16 v[68:71], v[100:103], a[84:87], v[68:71]
  v_mfma_f32_16x16x32_bf16 v[72:75], v[100:103], a[116:119], v[72:75]
  v_mfma_f32_16x16x32_bf16 v[76:79], v[100:103], a[148:151], v[76:79]
  v_mfma_f32_16x16x32_bf16 v[80:83], v[100:103], a[180:183], v[80:83]
  v_mfma_f32_16x16x32_bf16 v[84:87], v[100:103], a[212:215], v[84:87]
  v_mfma_f32_16x16x32_bf16 v[88:91], v[100:103], a[244:247], v[88:91]
  ds_read2_b32 v[100:101], v52 offset0:128 offset1:129
  ds_read2_b32 v[102:103], v52 offset0:130 offset1:131
  s_waitcnt lgkmcnt(6)
  v_mfma_f32_16x16x32_bf16 v[60:63], v[104:107], a[16:19], v[60:63]
  v_mfma_f32_16x16x32_bf16 v[64:67], v[104:107], a[48:51], v[64:67]
  v_mfma_f32_16x16x32_bf16 v[68:71], v[104:107], a[80:83], v[68:71]
  v_mfma_f32_16x16x32_bf16 v[72:75], v[104:107], a[112:115], v[72:75]
  v_mfma_f32_16x16x32_bf16 v[76:79], v[104:107], a[144:147], v[76:79]
  v_mfma_f32_16x16x32_bf16 v[80:83], v[104:107], a[176:179], v[80:83]
  v_mfma_f32_16x16x32_bf16 v[84:87], v[104:107], a[208:211], v[84:87]
  v_mfma_f32_16x16x32_bf16 v[88:91], v[104:107], a[240:243], v[88:91]
  ds_read2_b32 v[104:105], v52 offset0:112 offset1:113
  ds_read2_b32 v[106:107], v52 offset0:114 offset1:115
  s_waitcnt lgkmcnt(6)
  v_mfma_f32_16x16x32_bf16 v[60:63], v[92:95], a[12:15], v[60:63]
  v_mfma_f32_16x16x32_bf16 v[64:67], v[92:95], a[44:47], v[64:67]
  v_mfma_f32_16x16x32_bf16 v[68:71], v[92:95], a[76:79], v[68:71]
  v_mfma_f32_16x16x32_bf16 v[72:75], v[92:95], a[108:111], v[72:75]
  v_mfma_f32_16x16x32_bf16 v[76:79], v[92:95], a[140:143], v[76:79]
  v_mfma_f32_16x16x32_bf16 v[80:83], v[92:95], a[172:175], v[80:83]
  v_mfma_f32_16x16x32_bf16 v[84:87], v[92:95], a[204:207], v[84:87]
  v_mfma_f32_16x16x32_bf16 v[88:91], v[92:95], a[236:239], v[88:91]
  ds_read2_b32 v[92:93], v52 offset0:96 offset1:97
  ds_read2_b32 v[94:95], v52 offset0:98 offset1:99
  s_waitcnt lgkmcnt(6)
  v_mfma_f32_16x16x32_bf16 v[60:63], v[96:99], a[8:11], v[60:63]
  v_mfma_f32_16x16x32_bf16 v[64:67], v[96:99], a[40:43], v[64:67]
  v_mfma_f32_16x16x32_bf16 v[68:71], v[96:99], a[72:75], v[68:71]
  v_mfma_f32_16x16x32_bf16 v[72:75], v[96:99], a[104:107], v[72:75]
  v_mfma_f32_16x16x32_bf16 v[76:79], v[96:99], a[136:139], v[76:79]
  v_mfma_f32_16x16x32_bf16 v[80:83], v[96:99], a[168:171], v[80:83]
  v_mfma_f32_16x16x32_bf16 v[84:87], v[96:99], a[200:203], v[84:87]
  v_mfma_f32_16x16x32_bf16 v[88:91], v[96:99], a[232:235], v[88:91]
  ds_read2_b32 v[96:97], v52 offset0:80 offset1:81
  ds_read2_b32 v[98:99], v52 offset0:82 offset1:83
  s_waitcnt lgkmcnt(6)
  v_mfma_f32_16x16x32_bf16 v[60:63], v[100:103], a[4:7], v[60:63]
  v_mfma_f32_16x16x32_bf16 v[64:67], v[100:103], a[36:39], v[64:67]
  v_mfma_f32_16x16x32_bf16 v[68:71], v[100:103], a[68:71], v[68:71]
  v_mfma_f32_16x16x32_bf16 v[72:75], v[100:103], a[100:103], v[72:75]
  v_mfma_f32_16x16x32_bf16 v[76:79], v[100:103], a[132:135], v[76:79]
  v_mfma_f32_16x16x32_bf16 v[80:83], v[100:103], a[164:167], v[80:83]
  v_mfma_f32_16x16x32_bf16 v[84:87], v[100:103], a[196:199], v[84:87]
  v_mfma_f32_16x16x32_bf16 v[88:91], v[100:103], a[228:231], v[88:91]
  ds_read2_b32 v[100:101], v52 offset0:64 offset1:65
  ds_read2_b32 v[102:103], v52 offset0:66 offset1:67
  s_waitcnt lgkmcnt(6)
  v_mfma_f32_16x16x32_bf16 v[60:63], v[104:107], a[0:3], v[60:63]
  v_mfma_f32_16x16x32_bf16 v[64:67], v[104:107], a[32:35], v[64:67]
  v_mfma_f32_16x16x32_bf16 v[68:71], v[104:107], a[64:67], v[68:71]
  v_mfma_f32_16x16x32_bf16 v[72:75], v[104:107], a[96:99], v[72:75]
  v_mfma_f32_16x16x32_bf16 v[76:79], v[104:107], a[128:131], v[76:79]
  v_mfma_f32_16x16x32_bf16 v[80:83], v[104:107], a[160:163], v[80:83]
  v_mfma_f32_16x16x32_bf16 v[84:87], v[104:107], a[192:195], v[84:87]
  v_mfma_f32_16x16x32_bf16 v[88:91], v[104:107], a[224:227], v[88:91]
  ds_read2_b32 v[104:105], v52 offset0:48 offset1:49
  ds_read2_b32 v[106:107], v52 offset0:50 offset1:51
  s_waitcnt lgkmcnt(6)
  v_mfma_f32_16x16x32_bf16 v[64:67], v[92:95], a[28:31], v[64:67]
  v_mfma_f32_16x16x32_bf16 v[68:71], v[92:95], a[60:63], v[68:71]
  v_mfma_f32_16x16x32_bf16 v[72:75], v[92:95], a[92:95], v[72:75]
  v_mfma_f32_16x16x32_bf16 v[76:79], v[92:95], a[124:127], v[76:79]
  v_mfma_f32_16x16x32_bf16 v[80:83], v[92:95], a[156:159], v[80:83]
  v_mfma_f32_16x16x32_bf16 v[84:87], v[92:95], a[188:191], v[84:87]
  v_mfma_f32_16x16x32_bf16 v[88:91], v[92:95], a[220:223], v[88:91]
  ds_read2_b32 v[92:93], v52 offset0:32 offset1:33
  ds_read2_b32 v[94:95], v52 offset0:34 offset1:35
  s_waitcnt lgkmcnt(6)
  v_mfma_f32_16x16x32_bf16 v[64:67], v[96:99], a[24:27], v[64:67]
  v_mfma_f32_16x16x32_bf16 v[68:71], v[96:99], a[56:59], v[68:71]
  v_mfma_f32_16x16x32_bf16 v[72:75], v[96:99], a[88:91], v[72:75]
  v_mfma_f32_16x16x32_bf16 v[76:79], v[96:99], a[120:123], v[76:79]
  v_mfma_f32_16x16x32_bf16 v[80:83], v[96:99], a[152:155], v[80:83]
  v_mfma_f32_16x16x32_bf16 v[84:87], v[96:99], a[184:187], v[84:87]
  v_mfma_f32_16x16x32_bf16 v[88:91], v[96:99], a[216:219], v[88:91]
  ds_read2_b32 v[96:97], v52 offset0:16 offset1:17
  ds_read2_b32 v[98:99], v52 offset0:18 offset1:19
  s_waitcnt lgkmcnt(6)
  v_mfma_f32_16x16x32_bf16 v[64:67], v[100:103], a[20:23], v[64:67]
  v_mfma_f32_16x16x32_bf16 v[68:71], v[100:103], a[52:55], v[68:71]
  v_mfma_f32_16x16x32_bf16 v[72:75], v[100:103], a[84:87], v[72:75]
  v_mfma_f32_16x16x32_bf16 v[76:79], v[100:103], a[116:119], v[76:79]
  v_mfma_f32_16x16x32_bf16 v[80:83], v[100:103], a[148:151], v[80:83]
  v_mfma_f32_16x16x32_bf16 v[84:87], v[100:103], a[180:183], v[84:87]
  v_mfma_f32_16x16x32_bf16 v[88:91], v[100:103], a[212:215], v[88:91]
  ds_read2_b32 v[100:101], v52 offset0:0 offset1:1
  ds_read2_b32 v[102:103], v52 offset0:2 offset1:3
  s_waitcnt lgkmcnt(6)
  v_mfma_f32_16x16x32_bf16 v[64:67], v[104:107], a[16:19], v[64:67]
  v_mfma_f32_16x16x32_bf16 v[68:71], v[104:107], a[48:51], v[68:71]
  v_mfma_f32_16x16x32_bf16 v[72:75], v[104:107], a[80:83], v[72:75]
  v_mfma_f32_16x16x32_bf16 v[76:79], v[104:107], a[112:115], v[76:79]
  v_mfma_f32_16x16x32_bf16 v[80:83], v[104:107], a[144:147], v[80:83]
  v_mfma_f32_16x16x32_bf16 v[84:87], v[104:107], a[176:179], v[84:87]
  v_mfma_f32_16x16x32_bf16 v[88:91], v[104:107], a[208:211], v[88:91]
  ds_read2_b32 v[104:105], v53 offset0:224 offset1:225
  ds_read2_b32 v[106:107], v53 offset0:226 offset1:227
  s_waitcnt lgkmcnt(6)
  v_mfma_f32_16x16x32_bf16 v[64:67], v[92:95], a[12:15], v[64:67]
  v_mfma_f32_16x16x32_bf16 v[68:71], v[92:95], a[44:47], v[68:71]
  v_mfma_f32_16x16x32_bf16 v[72:75], v[92:95], a[76:79], v[72:75]
  v_mfma_f32_16x16x32_bf16 v[76:79], v[92:95], a[108:111], v[76:79]
  v_mfma_f32_16x16x32_bf16 v[80:83], v[92:95], a[140:143], v[80:83]
  v_mfma_f32_16x16x32_bf16 v[84:87], v[92:95], a[172:175], v[84:87]
  v_mfma_f32_16x16x32_bf16 v[88:91], v[92:95], a[204:207], v[88:91]
  ds_read2_b32 v[92:93], v53 offset0:208 offset1:209
  ds_read2_b32 v[94:95], v53 offset0:210 offset1:211
  s_waitcnt lgkmcnt(6)
  v_mfma_f32_16x16x32_bf16 v[64:67], v[96:99], a[8:11], v[64:67]
  v_mfma_f32_16x16x32_bf16 v[68:71], v[96:99], a[40:43], v[68:71]
  v_mfma_f32_16x16x32_bf16 v[72:75], v[96:99], a[72:75], v[72:75]
  v_mfma_f32_16x16x32_bf16 v[76:79], v[96:99], a[104:107], v[76:79]
  v_mfma_f32_16x16x32_bf16 v[80:83], v[96:99], a[136:139], v[80:83]
  v_mfma_f32_16x16x32_bf16 v[84:87], v[96:99], a[168:171], v[84:87]
  v_mfma_f32_16x16x32_bf16 v[88:91], v[96:99], a[200:203], v[88:91]
  ds_read2_b32 v[96:97], v53 offset0:192 offset1:193
  ds_read2_b32 v[98:99], v53 offset0:194 offset1:195
  s_waitcnt lgkmcnt(6)
  v_mfma_f32_16x16x32_bf16 v[64:67], v[100:103], a[4:7], v[64:67]
  v_mfma_f32_16x16x32_bf16 v[68:71], v[100:103], a[36:39], v[68:71]
  v_mfma_f32_16x16x32_bf16 v[72:75], v[100:103], a[68:71], v[72:75]
  v_mfma_f32_16x16x32_bf16 v[76:79], v[100:103], a[100:103], v[76:79]
  v_mfma_f32_16x16x32_bf16 v[80:83], v[100:103], a[132:135], v[80:83]
  v_mfma_f32_16x16x32_bf16 v[84:87], v[100:103], a[164:167], v[84:87]
  v_mfma_f32_16x16x32_bf16 v[88:91], v[100:103], a[196:199], v[88:91]
  ds_read2_b32 v[100:101], v53 offset0:176 offset1:177
  ds_read2_b32 v[102:103], v53 offset0:178 offset1:179
  s_waitcnt lgkmcnt(6)
  v_mfma_f32_16x16x32_bf16 v[64:67], v[104:107], a[0:3], v[64:67]
  v_mfma_f32_16x16x32_bf16 v[68:71], v[104:107], a[32:35], v[68:71]
  v_mfma_f32_16x16x32_bf16 v[72:75], v[104:107], a[64:67], v[72:75]
  v_mfma_f32_16x16x32_bf16 v[76:79], v[104:107], a[96:99], v[76:79]
  v_mfma_f32_16x16x32_bf16 v[80:83], v[104:107], a[128:131], v[80:83]
  v_mfma_f32_16x16x32_bf16 v[84:87], v[104:107], a[160:163], v[84:87]
  v_mfma_f32_16x16x32_bf16 v[88:91], v[104:107], a[192:195], v[88:91]
  ds_read2_b32 v[104:105], v53 offset0:160 offset1:161
  ds_read2_b32 v[106:107], v53 offset0:162 offset1:163
  s_waitcnt lgkmcnt(6)
  v_mfma_f32_16x16x32_bf16 v[68:71], v[92:95], a[28:31], v[68:71]
  v_mfma_f32_16x16x32_bf16 v[72:75], v[92:95], a[60:63], v[72:75]
  v_mfma_f32_16x16x32_bf16 v[76:79], v[92:95], a[92:95], v[76:79]
  v_mfma_f32_16x16x32_bf16 v[80:83], v[92:95], a[124:127], v[80:83]
  v_mfma_f32_16x16x32_bf16 v[84:87], v[92:95], a[156:159], v[84:87]
  v_mfma_f32_16x16x32_bf16 v[88:91], v[92:95], a[188:191], v[88:91]
  ds_read2_b32 v[92:93], v53 offset0:144 offset1:145
  ds_read2_b32 v[94:95], v53 offset0:146 offset1:147
  s_waitcnt lgkmcnt(6)
  v_mfma_f32_16x16x32_bf16 v[68:71], v[96:99], a[24:27], v[68:71]
  v_mfma_f32_16x16x32_bf16 v[72:75], v[96:99], a[56:59], v[72:75]
  v_mfma_f32_16x16x32_bf16 v[76:79], v[96:99], a[88:91], v[76:79]
  v_mfma_f32_16x16x32_bf16 v[80:83], v[96:99], a[120:123], v[80:83]
  v_mfma_f32_16x16x32_bf16 v[84:87], v[96:99], a[152:155], v[84:87]
  v_mfma_f32_16x16x32_bf16 v[88:91], v[96:99], a[184:187], v[88:91]
  ds_read2_b32 v[96:97], v53 offset0:128 offset1:129
  ds_read2_b32 v[98:99], v53 offset0:130 offset1:131
  s_waitcnt lgkmcnt(6)
  v_mfma_f32_16x16x32_bf16 v[68:71], v[100:103], a[20:23], v[68:71]
  v_mfma_f32_16x16x32_bf16 v[72:75], v[100:103], a[52:55], v[72:75]
  v_mfma_f32_16x16x32_bf16 v[76:79], v[100:103], a[84:87], v[76:79]
  v_mfma_f32_16x16x32_bf16 v[80:83], v[100:103], a[116:119], v[80:83]
  v_mfma_f32_16x16x32_bf16 v[84:87], v[100:103], a[148:151], v[84:87]
  v_mfma_f32_16x16x32_bf16 v[88:91], v[100:103], a[180:183], v[88:91]
  ds_read2_b32 v[100:101], v53 offset0:112 offset1:113
  ds_read2_b32 v[102:103], v53 offset0:114 offset1:115
  s_waitcnt lgkmcnt(6)
  v_mfma_f32_16x16x32_bf16 v[68:71], v[104:107], a[16:19], v[68:71]
  v_mfma_f32_16x16x32_bf16 v[72:75], v[104:107], a[48:51], v[72:75]
  v_mfma_f32_16x16x32_bf16 v[76:79], v[104:107], a[80:83], v[76:79]
  v_mfma_f32_16x16x32_bf16 v[80:83], v[104:107], a[112:115], v[80:83]
  v_mfma_f32_16x16x32_bf16 v[84:87], v[104:107], a[144:147], v[84:87]
  v_mfma_f32_16x16x32_bf16 v[88:91], v[104:107], a[176:179], v[88:91]
  ds_read2_b32 v[104:105], v53 offset0:96 offset1:97
  ds_read2_b32 v[106:107], v53 offset0:98 offset1:99
  s_waitcnt lgkmcnt(6)
  v_mfma_f32_16x16x32_bf16 v[68:71], v[92:95], a[12:15], v[68:71]
  v_mfma_f32_16x16x32_bf16 v[72:75], v[92:95], a[44:47], v[72:75]
  v_mfma_f32_16x16x32_bf16 v[76:79], v[92:95], a[76:79], v[76:79]
  v_mfma_f32_16x16x32_bf16 v[80:83], v[92:95], a[108:111], v[80:83]
  v_mfma_f32_16x16x32_bf16 v[84:87], v[92:95], a[140:143], v[84:87]
  v_mfma_f32_16x16x32_bf16 v[88:91], v[92:95], a[172:175], v[88:91]
  ds_read2_b32 v[92:93], v53 offset0:80 offset1:81
  ds_read2_b32 v[94:95], v53 offset0:82 offset1:83
  s_waitcnt lgkmcnt(6)
  v_mfma_f32_16x16x32_bf16 v[68:71], v[96:99], a[8:11], v[68:71]
  v_mfma_f32_16x16x32_bf16 v[72:75], v[96:99], a[40:43], v[72:75]
  v_mfma_f32_16x16x32_bf16 v[76:79], v[96:99], a[72:75], v[76:79]
  v_mfma_f32_16x16x32_bf16 v[80:83], v[96:99], a[104:107], v[80:83]
  v_mfma_f32_16x16x32_bf16 v[84:87], v[96:99], a[136:139], v[84:87]
  v_mfma_f32_16x16x32_bf16 v[88:91], v[96:99], a[168:171], v[88:91]
  ds_read2_b32 v[96:97], v53 offset0:64 offset1:65
  ds_read2_b32 v[98:99], v53 offset0:66 offset1:67
  s_waitcnt lgkmcnt(6)
  v_mfma_f32_16x16x32_bf16 v[68:71], v[100:103], a[4:7], v[68:71]
  v_mfma_f32_16x16x32_bf16 v[72:75], v[100:103], a[36:39], v[72:75]
  v_mfma_f32_16x16x32_bf16 v[76:79], v[100:103], a[68:71], v[76:79]
  v_mfma_f32_16x16x32_bf16 v[80:83], v[100:103], a[100:103], v[80:83]
  v_mfma_f32_16x16x32_bf16 v[84:87], v[100:103], a[132:135], v[84:87]
  v_mfma_f32_16x16x32_bf16 v[88:91], v[100:103], a[164:167], v[88:91]
  ds_read2_b32 v[100:101], v53 offset0:48 offset1:49
  ds_read2_b32 v[102:103], v53 offset0:50 offset1:51
  s_waitcnt lgkmcnt(6)
  v_mfma_f32_16x16x32_bf16 v[68:71], v[104:107], a[0:3], v[68:71]
  v_mfma_f32_16x16x32_bf16 v[72:75], v[104:107], a[32:35], v[72:75]
  v_mfma_f32_16x16x32_bf16 v[76:79], v[104:107], a[64:67], v[76:79]
  v_mfma_f32_16x16x32_bf16 v[80:83], v[104:107], a[96:99], v[80:83]
  v_mfma_f32_16x16x32_bf16 v[84:87], v[104:107], a[128:131], v[84:87]
  v_mfma_f32_16x16x32_bf16 v[88:91], v[104:107], a[160:163], v[88:91]
  ds_read2_b32 v[104:105], v53 offset0:32 offset1:33
  ds_read2_b32 v[106:107], v53 offset0:34 offset1:35
  s_waitcnt lgkmcnt(6)
  v_mfma_f32_16x16x32_bf16 v[72:75], v[92:95], a[28:31], v[72:75]
  v_mfma_f32_16x16x32_bf16 v[76:79], v[92:95], a[60:63], v[76:79]
  v_mfma_f32_16x16x32_bf16 v[80:83], v[92:95], a[92:95], v[80:83]
  v_mfma_f32_16x16x32_bf16 v[84:87], v[92:95], a[124:127], v[84:87]
  v_mfma_f32_16x16x32_bf16 v[88:91], v[92:95], a[156:159], v[88:91]
  ds_read2_b32 v[92:93], v53 offset0:16 offset1:17
  ds_read2_b32 v[94:95], v53 offset0:18 offset1:19
  s_waitcnt lgkmcnt(6)
  v_mfma_f32_16x16x32_bf16 v[72:75], v[96:99], a[24:27], v[72:75]
  v_mfma_f32_16x16x32_bf16 v[76:79], v[96:99], a[56:59], v[76:79]
  v_mfma_f32_16x16x32_bf16 v[80:83], v[96:99], a[88:91], v[80:83]
  v_mfma_f32_16x16x32_bf16 v[84:87], v[96:99], a[120:123], v[84:87]
  v_mfma_f32_16x16x32_bf16 v[88:91], v[96:99], a[152:155], v[88:91]
  ds_read2_b32 v[96:97], v53 offset0:0 offset1:1
  ds_read2_b32 v[98:99], v53 offset0:2 offset1:3
  s_waitcnt lgkmcnt(6)
  v_mfma_f32_16x16x32_bf16 v[72:75], v[100:103], a[20:23], v[72:75]
  v_mfma_f32_16x16x32_bf16 v[76:79], v[100:103], a[52:55], v[76:79]
  v_mfma_f32_16x16x32_bf16 v[80:83], v[100:103], a[84:87], v[80:83]
  v_mfma_f32_16x16x32_bf16 v[84:87], v[100:103], a[116:119], v[84:87]
  v_mfma_f32_16x16x32_bf16 v[88:91], v[100:103], a[148:151], v[88:91]
  ds_read2_b32 v[100:101], v54 offset0:224 offset1:225
  ds_read2_b32 v[102:103], v54 offset0:226 offset1:227
  s_waitcnt lgkmcnt(6)
  v_mfma_f32_16x16x32_bf16 v[72:75], v[104:107], a[16:19], v[72:75]
  v_mfma_f32_16x16x32_bf16 v[76:79], v[104:107], a[48:51], v[76:79]
  v_mfma_f32_16x16x32_bf16 v[80:83], v[104:107], a[80:83], v[80:83]
  v_mfma_f32_16x16x32_bf16 v[84:87], v[104:107], a[112:115], v[84:87]
  v_mfma_f32_16x16x32_bf16 v[88:91], v[104:107], a[144:147], v[88:91]
  ds_read2_b32 v[104:105], v54 offset0:208 offset1:209
  ds_read2_b32 v[106:107], v54 offset0:210 offset1:211
  s_waitcnt lgkmcnt(6)
  v_mfma_f32_16x16x32_bf16 v[72:75], v[92:95], a[12:15], v[72:75]
  v_mfma_f32_16x16x32_bf16 v[76:79], v[92:95], a[44:47], v[76:79]
  v_mfma_f32_16x16x32_bf16 v[80:83], v[92:95], a[76:79], v[80:83]
  v_mfma_f32_16x16x32_bf16 v[84:87], v[92:95], a[108:111], v[84:87]
  v_mfma_f32_16x16x32_bf16 v[88:91], v[92:95], a[140:143], v[88:91]
  ds_read2_b32 v[92:93], v54 offset0:192 offset1:193
  ds_read2_b32 v[94:95], v54 offset0:194 offset1:195
  s_waitcnt lgkmcnt(6)
  v_mfma_f32_16x16x32_bf16 v[72:75], v[96:99], a[8:11], v[72:75]
  v_mfma_f32_16x16x32_bf16 v[76:79], v[96:99], a[40:43], v[76:79]
  v_mfma_f32_16x16x32_bf16 v[80:83], v[96:99], a[72:75], v[80:83]
  v_mfma_f32_16x16x32_bf16 v[84:87], v[96:99], a[104:107], v[84:87]
  v_mfma_f32_16x16x32_bf16 v[88:91], v[96:99], a[136:139], v[88:91]
  ds_read2_b32 v[96:97], v54 offset0:176 offset1:177
  ds_read2_b32 v[98:99], v54 offset0:178 offset1:179
  s_waitcnt lgkmcnt(6)
  v_mfma_f32_16x16x32_bf16 v[72:75], v[100:103], a[4:7], v[72:75]
  v_mfma_f32_16x16x32_bf16 v[76:79], v[100:103], a[36:39], v[76:79]
  v_mfma_f32_16x16x32_bf16 v[80:83], v[100:103], a[68:71], v[80:83]
  v_mfma_f32_16x16x32_bf16 v[84:87], v[100:103], a[100:103], v[84:87]
  v_mfma_f32_16x16x32_bf16 v[88:91], v[100:103], a[132:135], v[88:91]
  ds_read2_b32 v[100:101], v54 offset0:160 offset1:161
  ds_read2_b32 v[102:103], v54 offset0:162 offset1:163
  s_waitcnt lgkmcnt(6)
  v_mfma_f32_16x16x32_bf16 v[72:75], v[104:107], a[0:3], v[72:75]
  v_mfma_f32_16x16x32_bf16 v[76:79], v[104:107], a[32:35], v[76:79]
  v_mfma_f32_16x16x32_bf16 v[80:83], v[104:107], a[64:67], v[80:83]
  v_mfma_f32_16x16x32_bf16 v[84:87], v[104:107], a[96:99], v[84:87]
  v_mfma_f32_16x16x32_bf16 v[88:91], v[104:107], a[128:131], v[88:91]
  ds_read2_b32 v[104:105], v54 offset0:144 offset1:145
  ds_read2_b32 v[106:107], v54 offset0:146 offset1:147
  s_waitcnt lgkmcnt(6)
  v_mfma_f32_16x16x32_bf16 v[76:79], v[92:95], a[28:31], v[76:79]
  v_mfma_f32_16x16x32_bf16 v[80:83], v[92:95], a[60:63], v[80:83]
  v_mfma_f32_16x16x32_bf16 v[84:87], v[92:95], a[92:95], v[84:87]
  v_mfma_f32_16x16x32_bf16 v[88:91], v[92:95], a[124:127], v[88:91]
  ds_read2_b32 v[92:93], v54 offset0:128 offset1:129
  ds_read2_b32 v[94:95], v54 offset0:130 offset1:131
  s_waitcnt lgkmcnt(6)
  v_mfma_f32_16x16x32_bf16 v[76:79], v[96:99], a[24:27], v[76:79]
  v_mfma_f32_16x16x32_bf16 v[80:83], v[96:99], a[56:59], v[80:83]
  v_mfma_f32_16x16x32_bf16 v[84:87], v[96:99], a[88:91], v[84:87]
  v_mfma_f32_16x16x32_bf16 v[88:91], v[96:99], a[120:123], v[88:91]
  ds_read2_b32 v[96:97], v54 offset0:112 offset1:113
  ds_read2_b32 v[98:99], v54 offset0:114 offset1:115
  s_waitcnt lgkmcnt(6)
  v_mfma_f32_16x16x32_bf16 v[76:79], v[100:103], a[20:23], v[76:79]
  v_mfma_f32_16x16x32_bf16 v[80:83], v[100:103], a[52:55], v[80:83]
  v_mfma_f32_16x16x32_bf16 v[84:87], v[100:103], a[84:87], v[84:87]
  v_mfma_f32_16x16x32_bf16 v[88:91], v[100:103], a[116:119], v[88:91]
  ds_read2_b32 v[100:101], v54 offset0:96 offset1:97
  ds_read2_b32 v[102:103], v54 offset0:98 offset1:99
  s_waitcnt lgkmcnt(6)
  v_mfma_f32_16x16x32_bf16 v[76:79], v[104:107], a[16:19], v[76:79]
  v_mfma_f32_16x16x32_bf16 v[80:83], v[104:107], a[48:51], v[80:83]
  v_mfma_f32_16x16x32_bf16 v[84:87], v[104:107], a[80:83], v[84:87]
  v_mfma_f32_16x16x32_bf16 v[88:91], v[104:107], a[112:115], v[88:91]
  ds_read2_b32 v[104:105], v54 offset0:80 offset1:81
  ds_read2_b32 v[106:107], v54 offset0:82 offset1:83
  s_waitcnt lgkmcnt(6)
  v_mfma_f32_16x16x32_bf16 v[76:79], v[92:95], a[12:15], v[76:79]
  v_mfma_f32_16x16x32_bf16 v[80:83], v[92:95], a[44:47], v[80:83]
  v_mfma_f32_16x16x32_bf16 v[84:87], v[92:95], a[76:79], v[84:87]
  v_mfma_f32_16x16x32_bf16 v[88:91], v[92:95], a[108:111], v[88:91]
  ds_read2_b32 v[92:93], v54 offset0:64 offset1:65
  ds_read2_b32 v[94:95], v54 offset0:66 offset1:67
  s_waitcnt lgkmcnt(6)
  v_mfma_f32_16x16x32_bf16 v[76:79], v[96:99], a[8:11], v[76:79]
  v_mfma_f32_16x16x32_bf16 v[80:83], v[96:99], a[40:43], v[80:83]
  v_mfma_f32_16x16x32_bf16 v[84:87], v[96:99], a[72:75], v[84:87]
  v_mfma_f32_16x16x32_bf16 v[88:91], v[96:99], a[104:107], v[88:91]
  ds_read2_b32 v[96:97], v54 offset0:48 offset1:49
  ds_read2_b32 v[98:99], v54 offset0:50 offset1:51
  s_waitcnt lgkmcnt(6)
  v_mfma_f32_16x16x32_bf16 v[76:79], v[100:103], a[4:7], v[76:79]
  v_mfma_f32_16x16x32_bf16 v[80:83], v[100:103], a[36:39], v[80:83]
  v_mfma_f32_16x16x32_bf16 v[84:87], v[100:103], a[68:71], v[84:87]
  v_mfma_f32_16x16x32_bf16 v[88:91], v[100:103], a[100:103], v[88:91]
  ds_read2_b32 v[100:101], v54 offset0:32 offset1:33
  ds_read2_b32 v[102:103], v54 offset0:34 offset1:35
  s_waitcnt lgkmcnt(6)
  v_mfma_f32_16x16x32_bf16 v[76:79], v[104:107], a[0:3], v[76:79]
  v_mfma_f32_16x16x32_bf16 v[80:83], v[104:107], a[32:35], v[80:83]
  v_mfma_f32_16x16x32_bf16 v[84:87], v[104:107], a[64:67], v[84:87]
  v_mfma_f32_16x16x32_bf16 v[88:91], v[104:107], a[96:99], v[88:91]
  ds_read2_b32 v[104:105], v54 offset0:16 offset1:17
  ds_read2_b32 v[106:107], v54 offset0:18 offset1:19
  s_waitcnt lgkmcnt(6)
  v_mfma_f32_16x16x32_bf16 v[80:83], v[92:95], a[28:31], v[80:83]
  v_mfma_f32_16x16x32_bf16 v[84:87], v[92:95], a[60:63], v[84:87]
  v_mfma_f32_16x16x32_bf16 v[88:91], v[92:95], a[92:95], v[88:91]
  ds_read2_b32 v[92:93], v54 offset0:0 offset1:1
  ds_read2_b32 v[94:95], v54 offset0:2 offset1:3
  s_waitcnt lgkmcnt(6)
  v_mfma_f32_16x16x32_bf16 v[80:83], v[96:99], a[24:27], v[80:83]
  v_mfma_f32_16x16x32_bf16 v[84:87], v[96:99], a[56:59], v[84:87]
  v_mfma_f32_16x16x32_bf16 v[88:91], v[96:99], a[88:91], v[88:91]
  ds_read2_b32 v[96:97], v55 offset0:224 offset1:225
  ds_read2_b32 v[98:99], v55 offset0:226 offset1:227
  s_waitcnt lgkmcnt(6)
  v_mfma_f32_16x16x32_bf16 v[80:83], v[100:103], a[20:23], v[80:83]
  v_mfma_f32_16x16x32_bf16 v[84:87], v[100:103], a[52:55], v[84:87]
  v_mfma_f32_16x16x32_bf16 v[88:91], v[100:103], a[84:87], v[88:91]
  ds_read2_b32 v[100:101], v55 offset0:208 offset1:209
  ds_read2_b32 v[102:103], v55 offset0:210 offset1:211
  s_waitcnt lgkmcnt(6)
  v_mfma_f32_16x16x32_bf16 v[80:83], v[104:107], a[16:19], v[80:83]
  v_mfma_f32_16x16x32_bf16 v[84:87], v[104:107], a[48:51], v[84:87]
  v_mfma_f32_16x16x32_bf16 v[88:91], v[104:107], a[80:83], v[88:91]
  ds_read2_b32 v[104:105], v55 offset0:192 offset1:193
  ds_read2_b32 v[106:107], v55 offset0:194 offset1:195
  s_waitcnt lgkmcnt(6)
  v_mfma_f32_16x16x32_bf16 v[80:83], v[92:95], a[12:15], v[80:83]
  v_mfma_f32_16x16x32_bf16 v[84:87], v[92:95], a[44:47], v[84:87]
  v_mfma_f32_16x16x32_bf16 v[88:91], v[92:95], a[76:79], v[88:91]
  ds_read2_b32 v[92:93], v55 offset0:176 offset1:177
  ds_read2_b32 v[94:95], v55 offset0:178 offset1:179
  s_waitcnt lgkmcnt(6)
  v_mfma_f32_16x16x32_bf16 v[80:83], v[96:99], a[8:11], v[80:83]
  v_mfma_f32_16x16x32_bf16 v[84:87], v[96:99], a[40:43], v[84:87]
  v_mfma_f32_16x16x32_bf16 v[88:91], v[96:99], a[72:75], v[88:91]
  ds_read2_b32 v[96:97], v55 offset0:160 offset1:161
  ds_read2_b32 v[98:99], v55 offset0:162 offset1:163
  s_waitcnt lgkmcnt(6)
  v_mfma_f32_16x16x32_bf16 v[80:83], v[100:103], a[4:7], v[80:83]
  v_mfma_f32_16x16x32_bf16 v[84:87], v[100:103], a[36:39], v[84:87]
  v_mfma_f32_16x16x32_bf16 v[88:91], v[100:103], a[68:71], v[88:91]
  ds_read2_b32 v[100:101], v55 offset0:144 offset1:145
  ds_read2_b32 v[102:103], v55 offset0:146 offset1:147
  s_waitcnt lgkmcnt(6)
  v_mfma_f32_16x16x32_bf16 v[80:83], v[104:107], a[0:3], v[80:83]
  v_mfma_f32_16x16x32_bf16 v[84:87], v[104:107], a[32:35], v[84:87]
  v_mfma_f32_16x16x32_bf16 v[88:91], v[104:107], a[64:67], v[88:91]
  ds_read2_b32 v[104:105], v55 offset0:128 offset1:129
  ds_read2_b32 v[106:107], v55 offset0:130 offset1:131
  s_waitcnt lgkmcnt(6)
  v_mfma_f32_16x16x32_bf16 v[84:87], v[92:95], a[28:31], v[84:87]
  v_mfma_f32_16x16x32_bf16 v[88:91], v[92:95], a[60:63], v[88:91]
  ds_read2_b32 v[92:93], v55 offset0:112 offset1:113
  ds_read2_b32 v[94:95], v55 offset0:114 offset1:115
  s_waitcnt lgkmcnt(6)
  v_mfma_f32_16x16x32_bf16 v[84:87], v[96:99], a[24:27], v[84:87]
  v_mfma_f32_16x16x32_bf16 v[88:91], v[96:99], a[56:59], v[88:91]
  ds_read2_b32 v[96:97], v55 offset0:96 offset1:97
  ds_read2_b32 v[98:99], v55 offset0:98 offset1:99
  s_waitcnt lgkmcnt(6)
  v_mfma_f32_16x16x32_bf16 v[84:87], v[100:103], a[20:23], v[84:87]
  v_mfma_f32_16x16x32_bf16 v[88:91], v[100:103], a[52:55], v[88:91]
  ds_read2_b32 v[100:101], v55 offset0:80 offset1:81
  ds_read2_b32 v[102:103], v55 offset0:82 offset1:83
  s_waitcnt lgkmcnt(6)
  v_mfma_f32_16x16x32_bf16 v[84:87], v[104:107], a[16:19], v[84:87]
  v_mfma_f32_16x16x32_bf16 v[88:91], v[104:107], a[48:51], v[88:91]
  ds_read2_b32 v[104:105], v55 offset0:64 offset1:65
  ds_read2_b32 v[106:107], v55 offset0:66 offset1:67
  s_waitcnt lgkmcnt(6)
  v_mfma_f32_16x16x32_bf16 v[84:87], v[92:95], a[12:15], v[84:87]
  v_mfma_f32_16x16x32_bf16 v[88:91], v[92:95], a[44:47], v[88:91]
  ds_read2_b32 v[92:93], v55 offset0:48 offset1:49
  ds_read2_b32 v[94:95], v55 offset0:50 offset1:51
  s_waitcnt lgkmcnt(6)
  v_mfma_f32_16x16x32_bf16 v[84:87], v[96:99], a[8:11], v[84:87]
  v_mfma_f32_16x16x32_bf16 v[88:91], v[96:99], a[40:43], v[88:91]
  ds_read2_b32 v[96:97], v55 offset0:32 offset1:33
  ds_read2_b32 v[98:99], v55 offset0:34 offset1:35
  s_waitcnt lgkmcnt(6)
  v_mfma_f32_16x16x32_bf16 v[84:87], v[100:103], a[4:7], v[84:87]
  v_mfma_f32_16x16x32_bf16 v[88:91], v[100:103], a[36:39], v[88:91]
  ds_read2_b32 v[100:101], v55 offset0:16 offset1:17
  ds_read2_b32 v[102:103], v55 offset0:18 offset1:19
  s_waitcnt lgkmcnt(6)
  v_mfma_f32_16x16x32_bf16 v[84:87], v[104:107], a[0:3], v[84:87]
  v_mfma_f32_16x16x32_bf16 v[88:91], v[104:107], a[32:35], v[88:91]
  ds_read2_b32 v[104:105], v55 offset0:0 offset1:1
  ds_read2_b32 v[106:107], v55 offset0:2 offset1:3
  s_waitcnt lgkmcnt(6)
  v_mfma_f32_16x16x32_bf16 v[88:91], v[92:95], a[28:31], v[88:91]
  ds_read2_b32 v[92:93], v56 offset0:224 offset1:225
  ds_read2_b32 v[94:95], v56 offset0:226 offset1:227
  s_waitcnt lgkmcnt(6)
  v_mfma_f32_16x16x32_bf16 v[88:91], v[96:99], a[24:27], v[88:91]
  ds_read2_b32 v[96:97], v56 offset0:208 offset1:209
  ds_read2_b32 v[98:99], v56 offset0:210 offset1:211
  s_waitcnt lgkmcnt(6)
  v_mfma_f32_16x16x32_bf16 v[88:91], v[100:103], a[20:23], v[88:91]
  ds_read2_b32 v[100:101], v56 offset0:192 offset1:193
  ds_read2_b32 v[102:103], v56 offset0:194 offset1:195
  s_waitcnt lgkmcnt(6)
  v_mfma_f32_16x16x32_bf16 v[88:91], v[104:107], a[16:19], v[88:91]
  ds_read2_b32 v[104:105], v56 offset0:176 offset1:177
  ds_read2_b32 v[106:107], v56 offset0:178 offset1:179
  s_waitcnt lgkmcnt(6)
  v_mfma_f32_16x16x32_bf16 v[88:91], v[92:95], a[12:15], v[88:91]
  s_waitcnt lgkmcnt(4)
  v_mfma_f32_16x16x32_bf16 v[88:91], v[96:99], a[8:11], v[88:91]
  s_waitcnt lgkmcnt(2)
  v_mfma_f32_16x16x32_bf16 v[88:91], v[100:103], a[4:7], v[88:91]
  s_waitcnt lgkmcnt(0)
  v_mfma_f32_16x16x32_bf16 v[88:91], v[104:107], a[0:3], v[88:91]
  v_lshlrev_b32 v46, 5, v4
  v_lshl_add_u32 v46, v3, 3, v46
  v_add_u32 v46, s17, v46
  ds_read_b64 v[108:109], v46 offset:512
  ds_read_b64 v[110:111], v46 offset:1024
  ds_read_b64 v[112:113], v46 offset:1536
  ds_read_b64 v[114:115], v46 offset:2048
  ds_read_b64 v[116:117], v46 offset:2560
  ds_read_b64 v[118:119], v46 offset:3072
  ds_read_b64 v[120:121], v46 offset:3584
  ds_read_b64 v[122:123], v46 offset:4096
  s_waitcnt lgkmcnt(0)
  v_lshlrev_b32 v124, 16, v108
  v_and_b32 v125, 0xffff0000, v108
  v_lshlrev_b32 v126, 16, v109
  v_and_b32 v127, 0xffff0000, v109
  v_mul_f32 v124, v124, v33
  v_mul_f32 v125, v125, v33
  v_mul_f32 v126, v126, v33
  v_mul_f32 v127, v127, v33
  v_cvt_pk_bf16_f32 v128, v124, v125
  v_cvt_pk_bf16_f32 v129, v126, v127
  v_cvt_pk_bf16_f32 v130, v60, v61
  v_cvt_pk_bf16_f32 v131, v62, v63
  v_lshlrev_b32 v124, 16, v128
  v_and_b32 v125, 0xffff0000, v128
  v_lshlrev_b32 v132, 16, v130
  v_and_b32 v133, 0xffff0000, v130
  v_lshlrev_b32 v126, 16, v129
  v_and_b32 v127, 0xffff0000, v129
  v_lshlrev_b32 v134, 16, v131
  v_and_b32 v135, 0xffff0000, v131
  v_add_f32 v124, v124, v132
  v_add_f32 v125, v125, v133
  v_add_f32 v126, v126, v134
  v_add_f32 v127, v127, v135
  v_cvt_pk_bf16_f32 v108, v124, v125
  v_cvt_pk_bf16_f32 v109, v126, v127
  ds_write_b64 v46, v[108:109] offset:512
  v_lshlrev_b32 v124, 16, v110
  v_and_b32 v125, 0xffff0000, v110
  v_lshlrev_b32 v126, 16, v111
  v_and_b32 v127, 0xffff0000, v111
  v_mul_f32 v124, v124, v33
  v_mul_f32 v125, v125, v33
  v_mul_f32 v126, v126, v33
  v_mul_f32 v127, v127, v33
  v_cvt_pk_bf16_f32 v128, v124, v125
  v_cvt_pk_bf16_f32 v129, v126, v127
  v_cvt_pk_bf16_f32 v130, v64, v65
  v_cvt_pk_bf16_f32 v131, v66, v67
  v_lshlrev_b32 v124, 16, v128
  v_and_b32 v125, 0xffff0000, v128
  v_lshlrev_b32 v132, 16, v130
  v_and_b32 v133, 0xffff0000, v130
  v_lshlrev_b32 v126, 16, v129
  v_and_b32 v127, 0xffff0000, v129
  v_lshlrev_b32 v134, 16, v131
  v_and_b32 v135, 0xffff0000, v131
  v_add_f32 v124, v124, v132
  v_add_f32 v125, v125, v133
  v_add_f32 v126, v126, v134
  v_add_f32 v127, v127, v135
  v_cvt_pk_bf16_f32 v110, v124, v125
  v_cvt_pk_bf16_f32 v111, v126, v127
  ds_write_b64 v46, v[110:111] offset:1024
  v_lshlrev_b32 v124, 16, v112
  v_and_b32 v125, 0xffff0000, v112
  v_lshlrev_b32 v126, 16, v113
  v_and_b32 v127, 0xffff0000, v113
  v_mul_f32 v124, v124, v33
  v_mul_f32 v125, v125, v33
  v_mul_f32 v126, v126, v33
  v_mul_f32 v127, v127, v33
  v_cvt_pk_bf16_f32 v128, v124, v125
  v_cvt_pk_bf16_f32 v129, v126, v127
  v_cvt_pk_bf16_f32 v130, v68, v69
  v_cvt_pk_bf16_f32 v131, v70, v71
  v_lshlrev_b32 v124, 16, v128
  v_and_b32 v125, 0xffff0000, v128
  v_lshlrev_b32 v132, 16, v130
  v_and_b32 v133, 0xffff0000, v130
  v_lshlrev_b32 v126, 16, v129
  v_and_b32 v127, 0xffff0000, v129
  v_lshlrev_b32 v134, 16, v131
  v_and_b32 v135, 0xffff0000, v131
  v_add_f32 v124, v124, v132
  v_add_f32 v125, v125, v133
  v_add_f32 v126, v126, v134
  v_add_f32 v127, v127, v135
  v_cvt_pk_bf16_f32 v112, v124, v125
  v_cvt_pk_bf16_f32 v113, v126, v127
  ds_write_b64 v46, v[112:113] offset:1536
  v_lshlrev_b32 v124, 16, v114
  v_and_b32 v125, 0xffff0000, v114
  v_lshlrev_b32 v126, 16, v115
  v_and_b32 v127, 0xffff0000, v115
  v_mul_f32 v124, v124, v33
  v_mul_f32 v125, v125, v33
  v_mul_f32 v126, v126, v33
  v_mul_f32 v127, v127, v33
  v_cvt_pk_bf16_f32 v128, v124, v125
  v_cvt_pk_bf16_f32 v129, v126, v127
  v_cvt_pk_bf16_f32 v130, v72, v73
  v_cvt_pk_bf16_f32 v131, v74, v75
  v_lshlrev_b32 v124, 16, v128
  v_and_b32 v125, 0xffff0000, v128
  v_lshlrev_b32 v132, 16, v130
  v_and_b32 v133, 0xffff0000, v130
  v_lshlrev_b32 v126, 16, v129
  v_and_b32 v127, 0xffff0000, v129
  v_lshlrev_b32 v134, 16, v131
  v_and_b32 v135, 0xffff0000, v131
  v_add_f32 v124, v124, v132
  v_add_f32 v125, v125, v133
  v_add_f32 v126, v126, v134
  v_add_f32 v127, v127, v135
  v_cvt_pk_bf16_f32 v114, v124, v125
  v_cvt_pk_bf16_f32 v115, v126, v127
  ds_write_b64 v46, v[114:115] offset:2048
  v_lshlrev_b32 v124, 16, v116
  v_and_b32 v125, 0xffff0000, v116
  v_lshlrev_b32 v126, 16, v117
  v_and_b32 v127, 0xffff0000, v117
  v_mul_f32 v124, v124, v33
  v_mul_f32 v125, v125, v33
  v_mul_f32 v126, v126, v33
  v_mul_f32 v127, v127, v33
  v_cvt_pk_bf16_f32 v128, v124, v125
  v_cvt_pk_bf16_f32 v129, v126, v127
  v_cvt_pk_bf16_f32 v130, v76, v77
  v_cvt_pk_bf16_f32 v131, v78, v79
  v_lshlrev_b32 v124, 16, v128
  v_and_b32 v125, 0xffff0000, v128
  v_lshlrev_b32 v132, 16, v130
  v_and_b32 v133, 0xffff0000, v130
  v_lshlrev_b32 v126, 16, v129
  v_and_b32 v127, 0xffff0000, v129
  v_lshlrev_b32 v134, 16, v131
  v_and_b32 v135, 0xffff0000, v131
  v_add_f32 v124, v124, v132
  v_add_f32 v125, v125, v133
  v_add_f32 v126, v126, v134
  v_add_f32 v127, v127, v135
  v_cvt_pk_bf16_f32 v116, v124, v125
  v_cvt_pk_bf16_f32 v117, v126, v127
  ds_write_b64 v46, v[116:117] offset:2560
  v_lshlrev_b32 v124, 16, v118
  v_and_b32 v125, 0xffff0000, v118
  v_lshlrev_b32 v126, 16, v119
  v_and_b32 v127, 0xffff0000, v119
  v_mul_f32 v124, v124, v33
  v_mul_f32 v125, v125, v33
  v_mul_f32 v126, v126, v33
  v_mul_f32 v127, v127, v33
  v_cvt_pk_bf16_f32 v128, v124, v125
  v_cvt_pk_bf16_f32 v129, v126, v127
  v_cvt_pk_bf16_f32 v130, v80, v81
  v_cvt_pk_bf16_f32 v131, v82, v83
  v_lshlrev_b32 v124, 16, v128
  v_and_b32 v125, 0xffff0000, v128
  v_lshlrev_b32 v132, 16, v130
  v_and_b32 v133, 0xffff0000, v130
  v_lshlrev_b32 v126, 16, v129
  v_and_b32 v127, 0xffff0000, v129
  v_lshlrev_b32 v134, 16, v131
  v_and_b32 v135, 0xffff0000, v131
  v_add_f32 v124, v124, v132
  v_add_f32 v125, v125, v133
  v_add_f32 v126, v126, v134
  v_add_f32 v127, v127, v135
  v_cvt_pk_bf16_f32 v118, v124, v125
  v_cvt_pk_bf16_f32 v119, v126, v127
  ds_write_b64 v46, v[118:119] offset:3072
  v_lshlrev_b32 v124, 16, v120
  v_and_b32 v125, 0xffff0000, v120
  v_lshlrev_b32 v126, 16, v121
  v_and_b32 v127, 0xffff0000, v121
  v_mul_f32 v124, v124, v33
  v_mul_f32 v125, v125, v33
  v_mul_f32 v126, v126, v33
  v_mul_f32 v127, v127, v33
  v_cvt_pk_bf16_f32 v128, v124, v125
  v_cvt_pk_bf16_f32 v129, v126, v127
  v_cvt_pk_bf16_f32 v130, v84, v85
  v_cvt_pk_bf16_f32 v131, v86, v87
  v_lshlrev_b32 v124, 16, v128
  v_and_b32 v125, 0xffff0000, v128
  v_lshlrev_b32 v132, 16, v130
  v_and_b32 v133, 0xffff0000, v130
  v_lshlrev_b32 v126, 16, v129
  v_and_b32 v127, 0xffff0000, v129
  v_lshlrev_b32 v134, 16, v131
  v_and_b32 v135, 0xffff0000, v131
  v_add_f32 v124, v124, v132
  v_add_f32 v125, v125, v133
  v_add_f32 v126, v126, v134
  v_add_f32 v127, v127, v135
  v_cvt_pk_bf16_f32 v120, v124, v125
  v_cvt_pk_bf16_f32 v121, v126, v127
  ds_write_b64 v46, v[120:121] offset:3584
  v_lshlrev_b32 v124, 16, v122
  v_and_b32 v125, 0xffff0000, v122
  v_lshlrev_b32 v126, 16, v123
  v_and_b32 v127, 0xffff0000, v123
  v_mul_f32 v124, v124, v33
  v_mul_f32 v125, v125, v33
  v_mul_f32 v126, v126, v33
  v_mul_f32 v127, v127, v33
  v_cvt_pk_bf16_f32 v128, v124, v125
  v_cvt_pk_bf16_f32 v129, v126, v127
  v_cvt_pk_bf16_f32 v130, v88, v89
  v_cvt_pk_bf16_f32 v131, v90, v91
  v_lshlrev_b32 v124, 16, v128
  v_and_b32 v125, 0xffff0000, v128
  v_lshlrev_b32 v132, 16, v130
  v_and_b32 v133, 0xffff0000, v130
  v_lshlrev_b32 v126, 16, v129
  v_and_b32 v127, 0xffff0000, v129
  v_lshlrev_b32 v134, 16, v131
  v_and_b32 v135, 0xffff0000, v131
  v_add_f32 v124, v124, v132
  v_add_f32 v125, v125, v133
  v_add_f32 v126, v126, v134
  v_add_f32 v127, v127, v135
  v_cvt_pk_bf16_f32 v122, v124, v125
  v_cvt_pk_bf16_f32 v123, v126, v127
  ds_write_b64 v46, v[122:123] offset:4096
  s_waitcnt lgkmcnt(0)
  s_barrier
  v_lshlrev_b32 v6, 3, v0
  v_mul_u32_u24 v5, 7168, v0
  v_add_u32 v36, 512, v6
  ds_read_b64 v[8:9], v36
  v_add_u32 v36, 25088, v6
  ds_read_b64 v[10:11], v36
  v_add_u32 v36, 49664, v6
  ds_read_b64 v[12:13], v36
  v_add_u32 v36, 74240, v6
  ds_read_b64 v[14:15], v36
  s_waitcnt lgkmcnt(0)
  s_add_u32 s22, s21, 0
  s_add_u32 s23, s22, 3584
  v_perm_b32 v16, v10, v8, s24
  v_perm_b32 v17, v14, v12, s24
  buffer_store_dwordx2 v[16:17], v5, s[88:91], s22 offen offset:0
  v_perm_b32 v18, v10, v8, s25
  v_perm_b32 v19, v14, v12, s25
  buffer_store_dwordx2 v[18:19], v5, s[88:91], s22 offen offset:1792
  v_perm_b32 v20, v11, v9, s24
  v_perm_b32 v21, v15, v13, s24
  buffer_store_dwordx2 v[20:21], v5, s[88:91], s23 offen offset:0
  v_perm_b32 v22, v11, v9, s25
  v_perm_b32 v23, v15, v13, s25
  buffer_store_dwordx2 v[22:23], v5, s[88:91], s23 offen offset:1792
  v_add_u32 v36, 2560, v6
  ds_read_b64 v[8:9], v36
  v_add_u32 v36, 27136, v6
  ds_read_b64 v[10:11], v36
  v_add_u32 v36, 51712, v6
  ds_read_b64 v[12:13], v36
  v_add_u32 v36, 76288, v6
  ds_read_b64 v[14:15], v36
  s_waitcnt lgkmcnt(0)
  s_add_u32 s22, s21, 1835008
  s_add_u32 s23, s22, 3584
  v_perm_b32 v24, v10, v8, s24
  v_perm_b32 v25, v14, v12, s24
  buffer_store_dwordx2 v[24:25], v5, s[88:91], s22 offen offset:0
  v_perm_b32 v26, v10, v8, s25
  v_perm_b32 v27, v14, v12, s25
  buffer_store_dwordx2 v[26:27], v5, s[88:91], s22 offen offset:1792
  v_perm_b32 v28, v11, v9, s24
  v_perm_b32 v29, v15, v13, s24
  buffer_store_dwordx2 v[28:29], v5, s[88:91], s23 offen offset:0
  v_perm_b32 v30, v11, v9, s25
  v_perm_b32 v31, v15, v13, s25
  buffer_store_dwordx2 v[30:31], v5, s[88:91], s23 offen offset:1792
  s_branch wk_loop
wk_tok:
  s_sub_u32 s3, s3, 752
  s_cmp_ge_u32 s3, 512
  s_cbranch_scc1 wk_done
  s_lshr_b32 s17, s3, 3
  s_and_b32 s18, s3, 3
  s_bitcmp1_b32 s3, 2
  s_cbranch_scc1 wk_toko
  s_lshl_b32 s20, s18, 2
  s_add_u32 s20, s20, s16
  s_lshl_b32 s21, s17, 4
  s_add_u32 s21, s21, s20
  s_mul_i32 s21, s21, 28672
  s_add_u32 s21, s21, 46399488
  s_mul_i32 s23, s17, 28672
  s_add_u32 s23, s23, 75759616
  s_mul_i32 s24, s17, 7168
  s_add_u32 s24, s24, 65536
  s_lshr_b32 s25, s17, 3
  s_lshl_b32 s25, s25, 4
  s_add_u32 s25, s25, s20
  s_lshl_b32 s25, s25, 7
  s_add_u32 s25, s25, 540672
  v_mov_b32 v60, 0
  s_mov_b32 s30, 0
wp_wf:
  buffer_load_dword v61, v60, s[8:11], s25 offen sc1
  s_waitcnt vmcnt(0)
  v_cmp_ne_u32 vcc, 56, v61
  s_cbranch_vccz wp_wf_ok
  s_sleep 4
  s_cmp_ge_u32 s17, 50
  s_cbranch_scc1 wp_wf_bo
  s_sleep 127
wp_wf_bo:
  s_add_u32 s30, s30, 1
  s_cmp_lt_u32 s30, 2000000
  s_cbranch_scc1 wp_wf
  s_branch wp_abort
wp_wf_ok:
  s_lshl_b32 s25, s17, 1
  s_mul_i32 s25, s25, 20480
  s_add_u32 s25, s25, 86114304
  s_lshl_b32 s26, s20, 10
  s_add_u32 s26, s26, s25
  s_lshl_b32 s27, s18, 10
  s_add_u32 s27, s27, s25
  s_lshr_b32 s28, s16, 1
  s_lshl_b32 s28, s28, 3
  s_add_u32 s27, s27, s28
  s_add_u32 s27, s27, 16384
  s_and_b32 s28, s16, 1
  s_cmp_eq_u32 s28, 0
  s_cselect_b32 s50, -1, 0
  s_cselect_b32 s51, 0, -1
  v_mov_b32 v44, -1
  v_mov_b32 v45, -1
  v_mov_b32 v46, -1
  v_mov_b32 v47, -1
  s_add_u32 s28, s26, 0
  s_add_u32 s29, s27, 0
  buffer_store_dwordx4 v[44:47], v2, s[8:11], s28 offen sc1
  s_mov_b64 exec, s[50:51]
  buffer_store_dwordx2 v[44:45], v2, s[8:11], s29 offen sc1
  s_mov_b64 exec, -1
  s_add_u32 s28, s26, 20480
  s_add_u32 s29, s27, 20480
  buffer_store_dwordx4 v[44:47], v2, s[8:11], s28 offen sc1
  s_mov_b64 exec, s[50:51]
  buffer_store_dwordx2 v[44:45], v2, s[8:11], s29 offen sc1
  s_mov_b64 exec, -1
  s_add_u32 s22, s21, 0
  buffer_load_dwordx4 a[0:3], v2, s[8:11], s22 offen offset:0 sc1
  buffer_load_dwordx4 a[4:7], v2, s[8:11], s22 offen offset:1024 sc1
  buffer_load_dwordx4 a[8:11], v2, s[8:11], s22 offen offset:2048 sc1
  buffer_load_dwordx4 a[12:15], v2, s[8:11], s22 offen offset:3072 sc1
  s_add_u32 s22, s21, 4096
  buffer_load_dwordx4 a[16:19], v2, s[8:11], s22 offen offset:0 sc1
  buffer_load_dwordx4 a[20:23], v2, s[8:11], s22 offen offset:1024 sc1
  buffer_load_dwordx4 a[24:27], v2, s[8:11], s22 offen offset:2048 sc1
  buffer_load_dwordx4 a[28:31], v2, s[8:11], s22 offen offset:3072 sc1
  s_add_u32 s22, s21, 8192
  buffer_load_dwordx4 a[32:35], v2, s[8:11], s22 offen offset:0 sc1
  buffer_load_dwordx4 a[36:39], v2, s[8:11], s22 offen offset:1024 sc1
  buffer_load_dwordx4 a[40:43], v2, s[8:11], s22 offen offset:2048 sc1
  buffer_load_dwordx4 a[44:47], v2, s[8:11], s22 offen offset:3072 sc1
  s_add_u32 s22, s21, 12288
  buffer_load_dwordx4 a[48:51], v2, s[8:11], s22 offen offset:0 sc1
  buffer_load_dwordx4 a[52:55], v2, s[8:11], s22 offen offset:1024 sc1
  buffer_load_dwordx4 a[56:59], v2, s[8:11], s22 offen offset:2048 sc1
  buffer_load_dwordx4 a[60:63], v2, s[8:11], s22 offen offset:3072 sc1
  s_add_u32 s22, s21, 16384
  buffer_load_dwordx4 a[64:67], v2, s[8:11], s22 offen offset:0 sc1
  buffer_load_dwordx4 a[68:71], v2, s[8:11], s22 offen offset:1024 sc1
  buffer_load_dwordx4 a[72:75], v2, s[8:11], s22 offen offset:2048 sc1
  buffer_load_dwordx4 a[76:79], v2, s[8:11], s22 offen offset:3072 sc1
  s_add_u32 s22, s21, 20480
  buffer_load_dwordx4 a[80:83], v2, s[8:11], s22 offen offset:0 sc1
  buffer_load_dwordx4 a[84:87], v2, s[8:11], s22 offen offset:1024 sc1
  buffer_load_dwordx4 a[88:91], v2, s[8:11], s22 offen offset:2048 sc1
  buffer_load_dwordx4 a[92:95], v2, s[8:11], s22 offen offset:3072 sc1
  s_add_u32 s22, s21, 24576
  buffer_load_dwordx4 a[96:99], v2, s[8:11], s22 offen offset:0 sc1
  buffer_load_dwordx4 a[100:103], v2, s[8:11], s22 offen offset:1024 sc1
  buffer_load_dwordx4 a[104:107], v2, s[8:11], s22 offen offset:2048 sc1
  buffer_load_dwordx4 a[108:111], v2, s[8:11], s22 offen offset:3072 sc1
  s_add_u32 s22, s23, 0
  buffer_load_dwordx4 a[112:115], v2, s[8:11], s22 offen offset:0 sc1
  buffer_load_dwordx4 a[116:119], v2, s[8:11], s22 offen offset:1024 sc1
  buffer_load_dwordx4 a[120:123], v2, s[8:11], s22 offen offset:2048 sc1
  buffer_load_dwordx4 a[124:127], v2, s[8:11], s22 offen offset:3072 sc1
  s_add_u32 s22, s23, 4096
  buffer_load_dwordx4 a[128:131], v2, s[8:11], s22 offen offset:0 sc1
  buffer_load_dwordx4 a[132:135], v2, s[8:11], s22 offen offset:1024 sc1
  buffer_load_dwordx4 a[136:139], v2, s[8:11], s22 offen offset:2048 sc1
  buffer_load_dwordx4 a[140:143], v2, s[8:11], s22 offen offset:3072 sc1
  s_add_u32 s22, s23, 8192
  buffer_load_dwordx4 a[144:147], v2, s[8:11], s22 offen offset:0 sc1
  buffer_load_dwordx4 a[148:151], v2, s[8:11], s22 offen offset:1024 sc1
  buffer_load_dwordx4 a[152:155], v2, s[8:11], s22 offen offset:2048 sc1
  buffer_load_dwordx4 a[156:159], v2, s[8:11], s22 offen offset:3072 sc1
  s_add_u32 s22, s23, 12288
  buffer_load_dwordx4 a[160:163], v2, s[8:11], s22 offen offset:0 sc1
  buffer_load_dwordx4 a[164:167], v2, s[8:11], s22 offen offset:1024 sc1
  buffer_load_dwordx4 a[168:171], v2, s[8:11], s22 offen offset:2048 sc1
  buffer_load_dwordx4 a[172:175], v2, s[8:11], s22 offen offset:3072 sc1
  s_add_u32 s22, s23, 16384
  buffer_load_dwordx4 a[176:179], v2, s[8:11], s22 offen offset:0 sc1
  buffer_load_dwordx4 a[180:183], v2, s[8:11], s22 offen offset:1024 sc1
  buffer_load_dwordx4 a[184:187], v2, s[8:11], s22 offen offset:2048 sc1
  buffer_load_dwordx4 a[188:191], v2, s[8:11], s22 offen offset:3072 sc1
  s_add_u32 s22, s23, 20480
  buffer_load_dwordx4 a[192:195], v2, s[8:11], s22 offen offset:0 sc1
  buffer_load_dwordx4 a[196:199], v2, s[8:11], s22 offen offset:1024 sc1
  buffer_load_dwordx4 a[200:203], v2, s[8:11], s22 offen offset:2048 sc1
  buffer_load_dwordx4 a[204:207], v2, s[8:11], s22 offen offset:3072 sc1
  s_add_u32 s22, s23, 24576
  buffer_load_dwordx4 a[208:211], v2, s[8:11], s22 offen offset:0 sc1
  buffer_load_dwordx4 a[212:215], v2, s[8:11], s22 offen offset:1024 sc1
  buffer_load_dwordx4 a[216:219], v2, s[8:11], s22 offen offset:2048 sc1
  buffer_load_dwordx4 a[220:223], v2, s[8:11], s22 offen offset:3072 sc1
  v_lshl_add_u32 v5, v3, 2, 0
  v_cmp_le_u32 s[40:41], v5, v4
  v_lshl_add_u32 v5, v3, 2, 1
  v_cmp_le_u32 s[42:43], v5, v4
  v_lshl_add_u32 v5, v3, 2, 2
  v_cmp_le_u32 s[44:45], v5, v4
  v_lshl_add_u32 v5, v3, 2, 3
  v_cmp_le_u32 s[46:47], v5, v4
  v_cmp_gt_u32 s[48:49], 2, v3
  v_mov_b32 v6, 0xff800000
  s_waitcnt vmcnt(0)
  s_lshl_b32 s25, s17, 7
  s_add_u32 s25, s25, 557056
  v_mov_b32 v5, 1
  v_mov_b32 v7, 0
  s_waitcnt vmcnt(0)
  s_mov_b64 exec, 1
  buffer_atomic_add v5, v7, s[8:11], s25 offen
  s_mov_b64 exec, -1
  v_mfma_f32_16x16x32_bf16 v[8:11], a[112:115], a[0:3], 0
  v_mfma_f32_16x16x32_bf16 v[12:15], a[112:115], a[56:59], 0
  v_mfma_f32_16x16x32_bf16 v[16:19], a[168:171], a[56:59], 0
  v_mfma_f32_16x16x32_bf16 v[8:11], a[116:119], a[4:7], v[8:11]
  v_mfma_f32_16x16x32_bf16 v[12:15], a[116:119], a[60:63], v[12:15]
  v_mfma_f32_16x16x32_bf16 v[16:19], a[172:175], a[60:63], v[16:19]
  v_mfma_f32_16x16x32_bf16 v[8:11], a[120:123], a[8:11], v[8:11]
  v_mfma_f32_16x16x32_bf16 v[12:15], a[120:123], a[64:67], v[12:15]
  v_mfma_f32_16x16x32_bf16 v[16:19], a[176:179], a[64:67], v[16:19]
  v_mfma_f32_16x16x32_bf16 v[8:11], a[124:127], a[12:15], v[8:11]
  v_mfma_f32_16x16x32_bf16 v[12:15], a[124:127], a[68:71], v[12:15]
  v_mfma_f32_16x16x32_bf16 v[16:19], a[180:183], a[68:71], v[16:19]
  v_mfma_f32_16x16x32_bf16 v[8:11], a[128:131], a[16:19], v[8:11]
  v_mfma_f32_16x16x32_bf16 v[12:15], a[128:131], a[72:75], v[12:15]
  v_mfma_f32_16x16x32_bf16 v[16:19], a[184:187], a[72:75], v[16:19]
  v_mfma_f32_16x16x32_bf16 v[8:11], a[132:135], a[20:23], v[8:11]
  v_mfma_f32_16x16x32_bf16 v[12:15], a[132:135], a[76:79], v[12:15]
  v_mfma_f32_16x16x32_bf16 v[16:19], a[188:191], a[76:79], v[16:19]
  v_mfma_f32_16x16x32_bf16 v[8:11], a[136:139], a[24:27], v[8:11]
  v_mfma_f32_16x16x32_bf16 v[12:15], a[136:139], a[80:83], v[12:15]
  v_mfma_f32_16x16x32_bf16 v[16:19], a[192:195], a[80:83], v[16:19]
  v_mfma_f32_16x16x32_bf16 v[8:11], a[140:143], a[28:31], v[8:11]
  v_mfma_f32_16x16x32_bf16 v[12:15], a[140:143], a[84:87], v[12:15]
  v_mfma_f32_16x16x32_bf16 v[16:19], a[196:199], a[84:87], v[16:19]
  v_mfma_f32_16x16x32_bf16 v[8:11], a[144:147], a[32:35], v[8:11]
  v_mfma_f32_16x16x32_bf16 v[12:15], a[144:147], a[88:91], v[12:15]
  v_mfma_f32_16x16x32_bf16 v[16:19], a[200:203], a[88:91], v[16:19]
  v_mfma_f32_16x16x32_bf16 v[8:11], a[148:151], a[36:39], v[8:11]
  v_mfma_f32_16x16x32_bf16 v[12:15], a[148:151], a[92:95], v[12:15]
  v_mfma_f32_16x16x32_bf16 v[16:19], a[204:207], a[92:95], v[16:19]
  v_mfma_f32_16x16x32_bf16 v[8:11], a[152:155], a[40:43], v[8:11]
  v_mfma_f32_16x16x32_bf16 v[12:15], a[152:155], a[96:99], v[12:15]
  v_mfma_f32_16x16x32_bf16 v[16:19], a[208:211], a[96:99], v[16:19]
  v_mfma_f32_16x16x32_bf16 v[8:11], a[156:159], a[44:47], v[8:11]
  v_mfma_f32_16x16x32_bf16 v[12:15], a[156:159], a[100:103], v[12:15]
  v_mfma_f32_16x16x32_bf16 v[16:19], a[212:215], a[100:103], v[16:19]
  v_mfma_f32_16x16x32_bf16 v[8:11], a[160:163], a[48:51], v[8:11]
  v_mfma_f32_16x16x32_bf16 v[12:15], a[160:163], a[104:107], v[12:15]
  v_mfma_f32_16x16x32_bf16 v[16:19], a[216:219], a[104:107], v[16:19]
  v_mfma_f32_16x16x32_bf16 v[8:11], a[164:167], a[52:55], v[8:11]
  v_mfma_f32_16x16x32_bf16 v[12:15], a[164:167], a[108:111], v[12:15]
  v_mfma_f32_16x16x32_bf16 v[16:19], a[220:223], a[108:111], v[16:19]
  s_mul_i32 s22, s20, 448
  v_mov_b32 v62, s22
  s_mov_b32 s30, 0
wp_pm:
  s_cmp_ge_u32 s17, 64
  s_cbranch_scc1 wp_pf
  buffer_load_dword v61, v62, s[8:11], s24 offen sc1
  s_waitcnt vmcnt(0)
  v_cmp_eq_u32 vcc, -1, v61
  s_cbranch_vccnz wp_pr
wp_pf:
  s_add_u32 s22, s24, 4096
  buffer_load_dwordx4 v[64:67], v2, s[8:11], s24 offen offset:0 sc1
  buffer_load_dwordx4 v[68:71], v2, s[8:11], s24 offen offset:1024 sc1
  buffer_load_dwordx4 v[72:75], v2, s[8:11], s24 offen offset:2048 sc1
  buffer_load_dwordx4 v[76:79], v2, s[8:11], s24 offen offset:3072 sc1
  buffer_load_dwordx4 v[80:83], v2, s[8:11], s22 offen offset:0 sc1
  buffer_load_dwordx4 v[84:87], v2, s[8:11], s22 offen offset:1024 sc1
  buffer_load_dwordx4 v[88:91], v2, s[8:11], s22 offen offset:2048 sc1
  s_waitcnt vmcnt(0)
  v_max_u32 v61, v64, v65
  v_max3_u32 v61, v61, v66, v67
  v_max3_u32 v61, v61, v68, v69
  v_max3_u32 v61, v61, v70, v71
  v_max3_u32 v61, v61, v72, v73
  v_max3_u32 v61, v61, v74, v75
  v_max3_u32 v61, v61, v76, v77
  v_max3_u32 v61, v61, v78, v79
  v_max3_u32 v61, v61, v80, v81
  v_max3_u32 v61, v61, v82, v83
  v_max3_u32 v61, v61, v84, v85
  v_max3_u32 v61, v61, v86, v87
  v_max3_u32 v61, v61, v88, v89
  v_max3_u32 v61, v61, v90, v91
  v_cmp_eq_u32 vcc, -1, v61
  s_cbranch_vccz wp_pk
wp_pr:
  s_sleep 4
  s_cmp_ge_u32 s17, 50
  s_cbranch_scc1 wp_pm_bo
  s_sleep 127
wp_pm_bo:
  s_add_u32 s30, s30, 1
  s_cmp_lt_u32 s30, 2000000
  s_cbranch_scc1 wp_pm
  s_branch wp_abort
wp_pk:
  buffer_load_dword v250, v251, s[8:11], 0 offen sc1
  v_mfma_f32_16x16x32_bf16 v[20:23], v[64:67], a[0:3], 0
  v_mfma_f32_16x16x32_bf16 v[24:27], v[64:67], a[4:7], 0
  v_mfma_f32_16x16x32_bf16 v[28:31], v[64:67], a[56:59], 0
  v_mfma_f32_16x16x32_bf16 v[32:35], v[64:67], a[60:63], 0
  v_mfma_f32_16x16x32_bf16 v[20:23], v[68:71], a[8:11], v[20:23]
  v_mfma_f32_16x16x32_bf16 v[24:27], v[68:71], a[12:15], v[24:27]
  v_mfma_f32_16x16x32_bf16 v[28:31], v[68:71], a[64:67], v[28:31]
  v_mfma_f32_16x16x32_bf16 v[32:35], v[68:71], a[68:71], v[32:35]
  v_mfma_f32_16x16x32_bf16 v[20:23], v[72:75], a[16:19], v[20:23]
  v_mfma_f32_16x16x32_bf16 v[24:27], v[72:75], a[20:23], v[24:27]
  v_mfma_f32_16x16x32_bf16 v[28:31], v[72:75], a[72:75], v[28:31]
  v_mfma_f32_16x16x32_bf16 v[32:35], v[72:75], a[76:79], v[32:35]
  v_mfma_f32_16x16x32_bf16 v[20:23], v[76:79], a[24:27], v[20:23]
  v_mfma_f32_16x16x32_bf16 v[24:27], v[76:79], a[28:31], v[24:27]
  v_mfma_f32_16x16x32_bf16 v[28:31], v[76:79], a[80:83], v[28:31]
  v_mfma_f32_16x16x32_bf16 v[32:35], v[76:79], a[84:87], v[32:35]
  v_mfma_f32_16x16x32_bf16 v[20:23], v[80:83], a[32:35], v[20:23]
  v_mfma_f32_16x16x32_bf16 v[24:27], v[80:83], a[36:39], v[24:27]
  v_mfma_f32_16x16x32_bf16 v[28:31], v[80:83], a[88:91], v[28:31]
  v_mfma_f32_16x16x32_bf16 v[32:35], v[80:83], a[92:95], v[32:35]
  v_mfma_f32_16x16x32_bf16 v[20:23], v[84:87], a[40:43], v[20:23]
  v_mfma_f32_16x16x32_bf16 v[24:27], v[84:87], a[44:47], v[24:27]
  v_mfma_f32_16x16x32_bf16 v[28:31], v[84:87], a[96:99], v[28:31]
  v_mfma_f32_16x16x32_bf16 v[32:35], v[84:87], a[100:103], v[32:35]
  v_mfma_f32_16x16x32_bf16 v[20:23], v[88:91], a[48:51], v[20:23]
  v_mfma_f32_16x16x32_bf16 v[24:27], v[88:91], a[52:55], v[24:27]
  v_mfma_f32_16x16x32_bf16 v[28:31], v[88:91], a[104:107], v[28:31]
  v_mfma_f32_16x16x32_bf16 v[32:35], v[88:91], a[108:111], v[32:35]
  v_cndmask_b32 v8, v6, v8, s[40:41]
  v_cndmask_b32 v9, v6, v9, s[42:43]
  v_cndmask_b32 v10, v6, v10, s[44:45]
  v_cndmask_b32 v11, v6, v11, s[46:47]
  v_cndmask_b32 v20, v24, v20, s[48:49]
  v_cndmask_b32 v21, v25, v21, s[48:49]
  v_cndmask_b32 v22, v26, v22, s[48:49]
  v_cndmask_b32 v23, v27, v23, s[48:49]
  v_mov_b32 v24, v20
  v_mov_b32 v25, v21
  v_mov_b32 v26, v22
  v_mov_b32 v27, v23
  v_permlane32_swap_b32 v20, v24
  v_permlane32_swap_b32 v21, v25
  v_permlane32_swap_b32 v22, v26
  v_permlane32_swap_b32 v23, v27
  v_add_f32 v20, v20, v24
  v_add_f32 v21, v21, v25
  v_add_f32 v22, v22, v26
  v_add_f32 v23, v23, v27
  v_max3_f32 v40, v8, v9, v10
  v_max3_f32 v40, v40, v11, v20
  v_max3_f32 v40, v40, v21, v22
  v_max_f32 v40, v40, v23
  v_mov_b32 v41, v40
  s_nop 1
  v_permlane16_swap_b32 v40, v41
  v_max_f32 v40, v40, v41
  v_mov_b32 v41, v40
  s_nop 1
  v_permlane32_swap_b32 v40, v41
  v_max_f32 v40, v40, v41
  v_sub_f32 v8, v8, v40
  v_sub_f32 v9, v9, v40
  v_sub_f32 v10, v10, v40
  v_sub_f32 v11, v11, v40
  v_sub_f32 v20, v20, v40
  v_sub_f32 v21, v21, v40
  v_sub_f32 v22, v22, v40
  v_sub_f32 v23, v23, v40
  v_exp_f32 v8, v8
  v_exp_f32 v9, v9
  v_exp_f32 v10, v10
  v_exp_f32 v11, v11
  v_exp_f32 v20, v20
  v_exp_f32 v21, v21
  v_exp_f32 v22, v22
  v_exp_f32 v23, v23
  v_add_f32 v42, v20, v21
  v_add_f32 v43, v22, v23
  v_add_f32 v42, v42, v43
  v_mul_f32 v42, 0.5, v42
  v_add_f32 v42, v42, v8
  v_add_f32 v42, v42, v9
  v_add_f32 v42, v42, v10
  v_add_f32 v42, v42, v11
  v_mov_b32 v41, v42
  s_nop 1
  v_permlane16_swap_b32 v42, v41
  v_add_f32 v42, v42, v41
  v_mov_b32 v41, v42
  s_nop 1
  v_permlane32_swap_b32 v42, v41
  v_add_f32 v42, v42, v41
  v_rcp_f32 v42, v42
  s_nop 0
  v_mul_f32 v8, v8, v42
  v_mul_f32 v9, v9, v42
  v_mul_f32 v10, v10, v42
  v_mul_f32 v11, v11, v42
  v_mul_f32 v20, v20, v42
  v_mul_f32 v21, v21, v42
  v_mul_f32 v22, v22, v42
  v_mul_f32 v23, v23, v42
  v_cvt_pk_bf16_f32 v44, v8, 0
  v_cvt_pk_bf16_f32 v45, v9, 0
  v_cvt_pk_bf16_f32 v46, v10, 0
  v_cvt_pk_bf16_f32 v47, v11, 0
  v_cvt_pk_bf16_f32 v48, v20, v21
  v_cvt_pk_bf16_f32 v49, v22, v23
  v_min_u32 v44, -2, v44
  v_min_u32 v45, -2, v45
  v_min_u32 v46, -2, v46
  v_min_u32 v47, -2, v47
  v_min_u32 v48, -2, v48
  v_min_u32 v49, -2, v49
  buffer_store_dwordx4 v[44:47], v2, s[8:11], s26 offen sc1
  s_mov_b64 exec, s[50:51]
  buffer_store_dwordx2 v[48:49], v2, s[8:11], s27 offen sc1
  s_mov_b64 exec, -1
  s_add_u32 s26, s26, 20480
  s_add_u32 s27, s27, 20480
  v_cndmask_b32 v16, v6, v16, s[40:41]
  v_cndmask_b32 v17, v6, v17, s[42:43]
  v_cndmask_b32 v18, v6, v18, s[44:45]
  v_cndmask_b32 v19, v6, v19, s[46:47]
  v_cndmask_b32 v28, v32, v28, s[48:49]
  v_cndmask_b32 v29, v33, v29, s[48:49]
  v_cndmask_b32 v30, v34, v30, s[48:49]
  v_cndmask_b32 v31, v35, v31, s[48:49]
  v_mov_b32 v32, v28
  v_mov_b32 v33, v29
  v_mov_b32 v34, v30
  v_mov_b32 v35, v31
  v_permlane32_swap_b32 v28, v32
  v_permlane32_swap_b32 v29, v33
  v_permlane32_swap_b32 v30, v34
  v_permlane32_swap_b32 v31, v35
  v_add_f32 v28, v28, v32
  v_add_f32 v29, v29, v33
  v_add_f32 v30, v30, v34
  v_add_f32 v31, v31, v35
  v_max3_f32 v40, v12, v13, v14
  v_max3_f32 v40, v40, v15, v16
  v_max3_f32 v40, v40, v17, v18
  v_max3_f32 v40, v40, v19, v28
  v_max3_f32 v40, v40, v29, v30
  v_max_f32 v40, v40, v31
  v_mov_b32 v41, v40
  s_nop 1
  v_permlane16_swap_b32 v40, v41
  v_max_f32 v40, v40, v41
  v_mov_b32 v41, v40
  s_nop 1
  v_permlane32_swap_b32 v40, v41
  v_max_f32 v40, v40, v41
  v_sub_f32 v12, v12, v40
  v_sub_f32 v13, v13, v40
  v_sub_f32 v14, v14, v40
  v_sub_f32 v15, v15, v40
  v_sub_f32 v16, v16, v40
  v_sub_f32 v17, v17, v40
  v_sub_f32 v18, v18, v40
  v_sub_f32 v19, v19, v40
  v_sub_f32 v28, v28, v40
  v_sub_f32 v29, v29, v40
  v_sub_f32 v30, v30, v40
  v_sub_f32 v31, v31, v40
  v_exp_f32 v12, v12
  v_exp_f32 v13, v13
  v_exp_f32 v14, v14
  v_exp_f32 v15, v15
  v_exp_f32 v16, v16
  v_exp_f32 v17, v17
  v_exp_f32 v18, v18
  v_exp_f32 v19, v19
  v_exp_f32 v28, v28
  v_exp_f32 v29, v29
  v_exp_f32 v30, v30
  v_exp_f32 v31, v31
  v_add_f32 v42, v28, v29
  v_add_f32 v43, v30, v31
  v_add_f32 v42, v42, v43
  v_mul_f32 v42, 0.5, v42
  v_add_f32 v42, v42, v12
  v_add_f32 v42, v42, v13
  v_add_f32 v42, v42, v14
  v_add_f32 v42, v42, v15
  v_add_f32 v42, v42, v16
  v_add_f32 v42, v42, v17
  v_add_f32 v42, v42, v18
  v_add_f32 v42, v42, v19
  v_mov_b32 v41, v42
  s_nop 1
  v_permlane16_swap_b32 v42, v41
  v_add_f32 v42, v42, v41
  v_mov_b32 v41, v42
  s_nop 1
  v_permlane32_swap_b32 v42, v41
  v_add_f32 v42, v42, v41
  v_rcp_f32 v42, v42
  s_nop 0
  v_mul_f32 v12, v12, v42
  v_mul_f32 v13, v13, v42
  v_mul_f32 v14, v14, v42
  v_mul_f32 v15, v15, v42
  v_mul_f32 v16, v16, v42
  v_mul_f32 v17, v17, v42
  v_mul_f32 v18, v18, v42
  v_mul_f32 v19, v19, v42
  v_mul_f32 v28, v28, v42
  v_mul_f32 v29, v29, v42
  v_mul_f32 v30, v30, v42
  v_mul_f32 v31, v31, v42
  v_cvt_pk_bf16_f32 v52, v12, v16
  v_cvt_pk_bf16_f32 v53, v13, v17
  v_cvt_pk_bf16_f32 v54, v14, v18
  v_cvt_pk_bf16_f32 v55, v15, v19
  v_cvt_pk_bf16_f32 v56, v28, v29
  v_cvt_pk_bf16_f32 v57, v30, v31
  v_min_u32 v52, -2, v52
  v_min_u32 v53, -2, v53
  v_min_u32 v54, -2, v54
  v_min_u32 v55, -2, v55
  v_min_u32 v56, -2, v56
  v_min_u32 v57, -2, v57
  buffer_store_dwordx4 v[52:55], v2, s[8:11], s26 offen sc1
  s_mov_b64 exec, s[50:51]
  buffer_store_dwordx2 v[56:57], v2, s[8:11], s27 offen sc1
  s_mov_b64 exec, -1
  s_branch wk_loop
wk_toko:
  s_load_dwordx2 s[36:37], s[0:1], 112
  s_waitcnt lgkmcnt(0)
  s_mov_b32 s92, s36
  s_and_b32 s93, s37, 0xffff
  s_mov_b32 s94, 3670016
  s_mov_b32 s95, 0x20000
  s_lshl_b32 s20, s18, 2
  s_add_u32 s20, s20, s16
  s_mul_i32 s24, s20, 65
  s_add_u32 s24, s24, s17
  s_lshl_b32 s24, s24, 13
  s_add_u32 s24, s24, 77602816
  s_mul_i32 s21, s20, 28672
  s_mul_i32 s22, s17, 458752
  s_add_u32 s21, s21, s22
  s_add_u32 s21, s21, 2490368
  s_lshl_b32 s25, s17, 1
  s_mul_i32 s25, s25, 20480
  s_add_u32 s25, s25, 86114304
  v_mov_b32 v5, v2
  v_min_u32 v6, 11, v4
  v_mad_u32_u24 v6, v3, 12, v6
  v_lshlrev_b32 v6, 4, v6
  v_add_u32 v6, 1024, v6
  v_lshrrev_b32 v8, 1, v3
  v_lshl_add_u32 v8, v8, 4, v4
  v_lshlrev_b32 v8, 4, v8
  v_and_b32 v9, 1, v3
  v_lshl_add_u32 v7, v9, 3, v8
  s_lshr_b32 s26, s17, 3
  s_lshl_b32 s26, s26, 4
  s_add_u32 s26, s26, s20
  s_lshl_b32 s26, s26, 7
  s_add_u32 s26, s26, 524288
  v_mov_b32 v60, 0
  s_mov_b32 s30, 0
wo_wv:
  buffer_load_dword v61, v60, s[8:11], s26 offen sc1
  s_waitcnt vmcnt(0)
  v_cmp_ne_u32 vcc, 56, v61
  s_cbranch_vccz wo_wv_ok
  s_sleep 4
  s_cmp_ge_u32 s17, 50
  s_cbranch_scc1 wo_wv_bo
  s_sleep 127
wo_wv_bo:
  s_add_u32 s30, s30, 1
  s_cmp_lt_u32 s30, 2000000
  s_cbranch_scc1 wo_wv
  s_branch wo_abort
wo_wv_ok:
  s_add_u32 s22, s21, 0
  buffer_load_dwordx4 a[0:3], v5, s[8:11], s22 offen offset:0 sc1
  buffer_load_dwordx4 a[4:7], v6, s[8:11], s22 offen offset:0 sc1
  buffer_load_dwordx4 a[8:11], v5, s[8:11], s22 offen offset:1792 sc1
  buffer_load_dwordx4 a[12:15], v6, s[8:11], s22 offen offset:1792 sc1
  s_add_u32 s22, s21, 3584
  buffer_load_dwordx4 a[16:19], v5, s[8:11], s22 offen offset:0 sc1
  buffer_load_dwordx4 a[20:23], v6, s[8:11], s22 offen offset:0 sc1
  buffer_load_dwordx4 a[24:27], v5, s[8:11], s22 offen offset:1792 sc1
  buffer_load_dwordx4 a[28:31], v6, s[8:11], s22 offen offset:1792 sc1
  s_add_u32 s22, s21, 7168
  buffer_load_dwordx4 a[32:35], v5, s[8:11], s22 offen offset:0 sc1
  buffer_load_dwordx4 a[36:39], v6, s[8:11], s22 offen offset:0 sc1
  buffer_load_dwordx4 a[40:43], v5, s[8:11], s22 offen offset:1792 sc1
  buffer_load_dwordx4 a[44:47], v6, s[8:11], s22 offen offset:1792 sc1
  s_add_u32 s22, s21, 10752
  buffer_load_dwordx4 a[48:51], v5, s[8:11], s22 offen offset:0 sc1
  buffer_load_dwordx4 a[52:55], v6, s[8:11], s22 offen offset:0 sc1
  buffer_load_dwordx4 a[56:59], v5, s[8:11], s22 offen offset:1792 sc1
  buffer_load_dwordx4 a[60:63], v6, s[8:11], s22 offen offset:1792 sc1
  s_add_u32 s22, s21, 14336
  buffer_load_dwordx4 a[64:67], v5, s[8:11], s22 offen offset:0 sc1
  buffer_load_dwordx4 a[68:71], v6, s[8:11], s22 offen offset:0 sc1
  buffer_load_dwordx4 a[72:75], v5, s[8:11], s22 offen offset:1792 sc1
  buffer_load_dwordx4 a[76:79], v6, s[8:11], s22 offen offset:1792 sc1
  s_add_u32 s22, s21, 17920
  buffer_load_dwordx4 a[80:83], v5, s[8:11], s22 offen offset:0 sc1
  buffer_load_dwordx4 a[84:87], v6, s[8:11], s22 offen offset:0 sc1
  buffer_load_dwordx4 a[88:91], v5, s[8:11], s22 offen offset:1792 sc1
  buffer_load_dwordx4 a[92:95], v6, s[8:11], s22 offen offset:1792 sc1
  s_add_u32 s22, s21, 21504
  buffer_load_dwordx4 a[96:99], v5, s[8:11], s22 offen offset:0 sc1
  buffer_load_dwordx4 a[100:103], v6, s[8:11], s22 offen offset:0 sc1
  buffer_load_dwordx4 a[104:107], v5, s[8:11], s22 offen offset:1792 sc1
  buffer_load_dwordx4 a[108:111], v6, s[8:11], s22 offen offset:1792 sc1
  s_add_u32 s22, s21, 25088
  buffer_load_dwordx4 a[112:115], v5, s[8:11], s22 offen offset:0 sc1
  buffer_load_dwordx4 a[116:119], v6, s[8:11], s22 offen offset:0 sc1
  buffer_load_dwordx4 a[120:123], v5, s[8:11], s22 offen offset:1792 sc1
  buffer_load_dwordx4 a[124:127], v6, s[8:11], s22 offen offset:1792 sc1
  s_and_b32 s27, s17, 1
  s_cmp_ge_u32 s17, 62
  s_cselect_b32 s27, s17, s27
  s_lshl_b32 s26, s20, 6
  s_add_u32 s26, s26, s27
  s_lshl_b32 s26, s26, 4
  s_add_u32 s26, s26, 565248
  v_lshlrev_b32 v60, 2, v3
  s_mov_b32 s30, 0
wo_wt:
  buffer_load_dword v61, v60, s[8:11], s26 offen sc1
  s_waitcnt vmcnt(0)
  v_cmp_ne_u32 vcc, 1, v61
  s_cbranch_vccz wo_wt_ok
  s_sleep 4
  s_cmp_ge_u32 s17, 50
  s_cbranch_scc1 wo_wt_bo
  s_sleep 127
wo_wt_bo:
  s_add_u32 s30, s30, 1
  s_cmp_lt_u32 s30, 2000000
  s_cbranch_scc1 wo_wt
  s_branch wo_abort
wo_wt_ok:
  s_lshl_b32 s26, s17, 7
  s_add_u32 s26, s26, 557056
  v_mov_b32 v60, 0
  s_mov_b32 s30, 0
wo_wp:
  buffer_load_dword v61, v60, s[8:11], s26 offen sc1
  s_waitcnt vmcnt(0)
  v_cmp_ne_u32 vcc, 16, v61
  s_cbranch_vccz wo_wp_ok
  s_sleep 4
  s_cmp_ge_u32 s17, 50
  s_cbranch_scc1 wo_wp_bo
  s_sleep 127
wo_wp_bo:
  s_add_u32 s30, s30, 1
  s_cmp_lt_u32 s30, 2000000
  s_cbranch_scc1 wo_wp
  s_branch wo_abort
wo_wp_ok:
  s_lshl_b32 s28, s16, 12
  s_add_u32 s26, s25, s28
  s_add_u32 s27, s26, 20480
  s_lshl_b32 s28, s16, 10
  s_add_u32 s28, s28, s25
  s_add_u32 s28, s28, 16384
  s_add_u32 s29, s28, 20480
  s_add_u32 s23, s24, 4096
  s_mov_b32 s30, 0
wo_ps:
  buffer_load_dword v61, off, s[8:11], s24 sc1
  buffer_load_dword v62, off, s[8:11], s26 sc1
  s_waitcnt vmcnt(0)
  v_max_u32 v61, v61, v62
  v_cmp_eq_u32 vcc, -1, v61
  s_cbranch_vccz wo_pl
  s_sleep 2
  s_cmp_ge_u32 s17, 50
  s_cbranch_scc1 wo_ps_bo
  s_sleep 127
wo_ps_bo:
  s_add_u32 s30, s30, 1
  s_cmp_lt_u32 s30, 2000000
  s_cbranch_scc1 wo_ps
  s_branch wo_abort
wo_pl:
  buffer_load_dwordx4 v[64:67], v2, s[8:11], s26 offen offset:0 sc1
  buffer_load_dwordx4 v[68:71], v2, s[8:11], s26 offen offset:1024 sc1
  buffer_load_dwordx4 v[72:75], v2, s[8:11], s26 offen offset:2048 sc1
  buffer_load_dwordx4 v[76:79], v2, s[8:11], s26 offen offset:3072 sc1
  buffer_load_dwordx4 v[80:83], v2, s[8:11], s28 offen sc1
  buffer_load_dwordx4 v[84:87], v2, s[8:11], s27 offen offset:0 sc1
  buffer_load_dwordx4 v[88:91], v2, s[8:11], s27 offen offset:1024 sc1
  buffer_load_dwordx4 v[92:95], v2, s[8:11], s27 offen offset:2048 sc1
  buffer_load_dwordx4 v[96:99], v2, s[8:11], s27 offen offset:3072 sc1
  buffer_load_dwordx4 v[100:103], v2, s[8:11], s29 offen sc1
  buffer_load_dwordx2 v[28:29], v7, s[8:11], s24 offen offset:0 sc1
  buffer_load_dwordx2 v[30:31], v7, s[8:11], s24 offen offset:512 sc1
  buffer_load_dwordx2 v[32:33], v7, s[8:11], s24 offen offset:1024 sc1
  buffer_load_dwordx2 v[34:35], v7, s[8:11], s24 offen offset:1536 sc1
  buffer_load_dwordx2 v[36:37], v7, s[8:11], s24 offen offset:2048 sc1
  buffer_load_dwordx2 v[38:39], v7, s[8:11], s24 offen offset:2560 sc1
  buffer_load_dwordx2 v[40:41], v7, s[8:11], s24 offen offset:3072 sc1
  buffer_load_dwordx2 v[42:43], v7, s[8:11], s24 offen offset:3584 sc1
  buffer_load_dwordx2 v[44:45], v7, s[8:11], s23 offen offset:0 sc1
  buffer_load_dwordx2 v[46:47], v7, s[8:11], s23 offen offset:512 sc1
  buffer_load_dwordx2 v[48:49], v7, s[8:11], s23 offen offset:1024 sc1
  buffer_load_dwordx2 v[50:51], v7, s[8:11], s23 offen offset:1536 sc1
  buffer_load_dwordx2 v[52:53], v7, s[8:11], s23 offen offset:2048 sc1
  buffer_load_dwordx2 v[54:55], v7, s[8:11], s23 offen offset:2560 sc1
  buffer_load_dwordx2 v[56:57], v7, s[8:11], s23 offen offset:3072 sc1
  buffer_load_dwordx2 v[58:59], v7, s[8:11], s23 offen offset:3584 sc1
  s_waitcnt vmcnt(16)
  v_max_u32 v61, v64, v65
  v_max3_u32 v61, v61, v66, v67
  v_max3_u32 v61, v61, v68, v69
  v_max3_u32 v61, v61, v70, v71
  v_max3_u32 v61, v61, v72, v73
  v_max3_u32 v61, v61, v74, v75
  v_max3_u32 v61, v61, v76, v77
  v_max3_u32 v61, v61, v78, v79
  v_max3_u32 v61, v61, v80, v81
  v_max3_u32 v61, v61, v82, v83
  v_max3_u32 v61, v61, v84, v85
  v_max3_u32 v61, v61, v86, v87
  v_max3_u32 v61, v61, v88, v89
  v_max3_u32 v61, v61, v90, v91
  v_max3_u32 v61, v61, v92, v93
  v_max3_u32 v61, v61, v94, v95
  v_max3_u32 v61, v61, v96, v97
  v_max3_u32 v61, v61, v98, v99
  v_max3_u32 v61, v61, v100, v101
  v_max3_u32 v61, v61, v102, v103
  s_mul_i32 s22, s16, 10240
  v_add_u32 v62, s22, v2
  ds_write_b128 v62, v[64:67] offset:0
  ds_write_b128 v62, v[68:71] offset:1024
  ds_write_b128 v62, v[72:75] offset:2048
  ds_write_b128 v62, v[76:79] offset:3072
  ds_write_b128 v62, v[80:83] offset:4096
  ds_write_b128 v62, v[84:87] offset:5120
  ds_write_b128 v62, v[88:91] offset:6144
  ds_write_b128 v62, v[92:95] offset:7168
  ds_write_b128 v62, v[96:99] offset:8192
  ds_write_b128 v62, v[100:103] offset:9216
  s_waitcnt vmcnt(0)
  v_max3_u32 v61, v61, v28, v29
  v_max3_u32 v61, v61, v30, v31
  v_max3_u32 v61, v61, v32, v33
  v_max3_u32 v61, v61, v34, v35
  v_max3_u32 v61, v61, v36, v37
  v_max3_u32 v61, v61, v38, v39
  v_max3_u32 v61, v61, v40, v41
  v_max3_u32 v61, v61, v42, v43
  v_max3_u32 v61, v61, v44, v45
  v_max3_u32 v61, v61, v46, v47
  v_max3_u32 v61, v61, v48, v49
  v_max3_u32 v61, v61, v50, v51
  v_max3_u32 v61, v61, v52, v53
  v_max3_u32 v61, v61, v54, v55
  v_max3_u32 v61, v61, v56, v57
  v_max3_u32 v61, v61, v58, v59
  v_cmp_eq_u32 vcc, -1, v61
  s_cbranch_vccz wo_pk
  s_waitcnt lgkmcnt(0)
  s_sleep 1
  s_add_u32 s30, s30, 1
  s_cmp_lt_u32 s30, 2000000
  s_cbranch_scc1 wo_pl
  s_branch wo_abort
wo_pk:
  buffer_load_dword v250, v251, s[8:11], 0 offen sc1
  s_waitcnt lgkmcnt(0)
  s_barrier
  ds_read_b128 v[64:67], v2 offset:0
  ds_read_b128 v[68:71], v2 offset:5120
  ds_read_b128 v[72:75], v2 offset:1024
  ds_read_b128 v[76:79], v2 offset:6144
  ds_read_b128 v[80:83], v2 offset:2048
  ds_read_b128 v[84:87], v2 offset:7168
  ds_read_b128 v[88:91], v2 offset:3072
  ds_read_b128 v[92:95], v2 offset:8192
  s_waitcnt lgkmcnt(7)
  v_mfma_f32_16x16x32_bf16 v[12:15], a[0:3], v[64:67], 0
  ds_read_b128 v[96:99], v2 offset:4096
  v_mfma_f32_16x16x32_bf16 v[20:23], a[4:7], v[64:67], 0
  s_waitcnt lgkmcnt(7)
  v_mfma_f32_16x16x32_bf16 v[16:19], a[0:3], v[68:71], 0
  ds_read_b128 v[100:103], v2 offset:9216
  v_mfma_f32_16x16x32_bf16 v[24:27], a[4:7], v[68:71], 0
  s_waitcnt lgkmcnt(7)
  v_mfma_f32_16x16x32_bf16 v[12:15], a[8:11], v[72:75], v[12:15]
  ds_read_b128 v[64:67], v2 offset:10240
  v_mfma_f32_16x16x32_bf16 v[20:23], a[12:15], v[72:75], v[20:23]
  s_waitcnt lgkmcnt(7)
  v_mfma_f32_16x16x32_bf16 v[16:19], a[8:11], v[76:79], v[16:19]
  ds_read_b128 v[68:71], v2 offset:15360
  v_mfma_f32_16x16x32_bf16 v[24:27], a[12:15], v[76:79], v[24:27]
  s_waitcnt lgkmcnt(7)
  v_mfma_f32_16x16x32_bf16 v[12:15], a[16:19], v[80:83], v[12:15]
  ds_read_b128 v[72:75], v2 offset:11264
  v_mfma_f32_16x16x32_bf16 v[20:23], a[20:23], v[80:83], v[20:23]
  s_waitcnt lgkmcnt(7)
  v_mfma_f32_16x16x32_bf16 v[16:19], a[16:19], v[84:87], v[16:19]
  ds_read_b128 v[76:79], v2 offset:16384
  v_mfma_f32_16x16x32_bf16 v[24:27], a[20:23], v[84:87], v[24:27]
  s_waitcnt lgkmcnt(7)
  v_mfma_f32_16x16x32_bf16 v[12:15], a[24:27], v[88:91], v[12:15]
  ds_read_b128 v[80:83], v2 offset:12288
  v_mfma_f32_16x16x32_bf16 v[20:23], a[28:31], v[88:91], v[20:23]
  s_waitcnt lgkmcnt(7)
  v_mfma_f32_16x16x32_bf16 v[16:19], a[24:27], v[92:95], v[16:19]
  ds_read_b128 v[84:87], v2 offset:17408
  v_mfma_f32_16x16x32_bf16 v[24:27], a[28:31], v[92:95], v[24:27]
  s_waitcnt lgkmcnt(7)
  v_mfma_f32_16x16x32_bf16 v[12:15], v[28:31], v[96:99], v[12:15]
  ds_read_b128 v[88:91], v2 offset:13312
  v_mfma_f32_16x16x32_bf16 v[20:23], v[32:35], v[96:99], v[20:23]
  s_waitcnt lgkmcnt(7)
  v_mfma_f32_16x16x32_bf16 v[16:19], v[28:31], v[100:103], v[16:19]
  ds_read_b128 v[92:95], v2 offset:18432
  v_mfma_f32_16x16x32_bf16 v[24:27], v[32:35], v[100:103], v[24:27]
  s_waitcnt lgkmcnt(7)
  v_mfma_f32_16x16x32_bf16 v[12:15], a[32:35], v[64:67], v[12:15]
  ds_read_b128 v[96:99], v2 offset:14336
  v_mfma_f32_16x16x32_bf16 v[20:23], a[36:39], v[64:67], v[20:23]
  s_waitcnt lgkmcnt(7)
  v_mfma_f32_16x16x32_bf16 v[16:19], a[32:35], v[68:71], v[16:19]
  ds_read_b128 v[100:103], v2 offset:19456
  v_mfma_f32_16x16x32_bf16 v[24:27], a[36:39], v[68:71], v[24:27]
  s_waitcnt lgkmcnt(7)
  v_mfma_f32_16x16x32_bf16 v[12:15], a[40:43], v[72:75], v[12:15]
  ds_read_b128 v[64:67], v2 offset:20480
  v_mfma_f32_16x16x32_bf16 v[20:23], a[44:47], v[72:75], v[20:23]
  s_waitcnt lgkmcnt(7)
  v_mfma_f32_16x16x32_bf16 v[16:19], a[40:43], v[76:79], v[16:19]
  ds_read_b128 v[68:71], v2 offset:25600
  v_mfma_f32_16x16x32_bf16 v[24:27], a[44:47], v[76:79], v[24:27]
  s_waitcnt lgkmcnt(7)
  v_mfma_f32_16x16x32_bf16 v[12:15], a[48:51], v[80:83], v[12:15]
  ds_read_b128 v[72:75], v2 offset:21504
  v_mfma_f32_16x16x32_bf16 v[20:23], a[52:55], v[80:83], v[20:23]
  s_waitcnt lgkmcnt(7)
  v_mfma_f32_16x16x32_bf16 v[16:19], a[48:51], v[84:87], v[16:19]
  ds_read_b128 v[76:79], v2 offset:26624
  v_mfma_f32_16x16x32_bf16 v[24:27], a[52:55], v[84:87], v[24:27]
  s_waitcnt lgkmcnt(7)
  v_mfma_f32_16x16x32_bf16 v[12:15], a[56:59], v[88:91], v[12:15]
  ds_read_b128 v[80:83], v2 offset:22528
  v_mfma_f32_16x16x32_bf16 v[20:23], a[60:63], v[88:91], v[20:23]
  s_waitcnt lgkmcnt(7)
  v_mfma_f32_16x16x32_bf16 v[16:19], a[56:59], v[92:95], v[16:19]
  ds_read_b128 v[84:87], v2 offset:27648
  v_mfma_f32_16x16x32_bf16 v[24:27], a[60:63], v[92:95], v[24:27]
  s_waitcnt lgkmcnt(7)
  v_mfma_f32_16x16x32_bf16 v[12:15], v[36:39], v[96:99], v[12:15]
  ds_read_b128 v[88:91], v2 offset:23552
  v_mfma_f32_16x16x32_bf16 v[20:23], v[40:43], v[96:99], v[20:23]
  s_waitcnt lgkmcnt(7)
  v_mfma_f32_16x16x32_bf16 v[16:19], v[36:39], v[100:103], v[16:19]
  ds_read_b128 v[92:95], v2 offset:28672
  v_mfma_f32_16x16x32_bf16 v[24:27], v[40:43], v[100:103], v[24:27]
  s_waitcnt lgkmcnt(7)
  v_mfma_f32_16x16x32_bf16 v[12:15], a[64:67], v[64:67], v[12:15]
  ds_read_b128 v[96:99], v2 offset:24576
  v_mfma_f32_16x16x32_bf16 v[20:23], a[68:71], v[64:67], v[20:23]
  s_waitcnt lgkmcnt(7)
  v_mfma_f32_16x16x32_bf16 v[16:19], a[64:67], v[68:71], v[16:19]
  ds_read_b128 v[100:103], v2 offset:29696
  v_mfma_f32_16x16x32_bf16 v[24:27], a[68:71], v[68:71], v[24:27]
  s_waitcnt lgkmcnt(7)
  v_mfma_f32_16x16x32_bf16 v[12:15], a[72:75], v[72:75], v[12:15]
  ds_read_b128 v[64:67], v2 offset:30720
  v_mfma_f32_16x16x32_bf16 v[20:23], a[76:79], v[72:75], v[20:23]
  s_waitcnt lgkmcnt(7)
  v_mfma_f32_16x16x32_bf16 v[16:19], a[72:75], v[76:79], v[16:19]
  ds_read_b128 v[68:71], v2 offset:35840
  v_mfma_f32_16x16x32_bf16 v[24:27], a[76:79], v[76:79], v[24:27]
  s_waitcnt lgkmcnt(7)
  v_mfma_f32_16x16x32_bf16 v[12:15], a[80:83], v[80:83], v[12:15]
  ds_read_b128 v[72:75], v2 offset:31744
  v_mfma_f32_16x16x32_bf16 v[20:23], a[84:87], v[80:83], v[20:23]
  s_waitcnt lgkmcnt(7)
  v_mfma_f32_16x16x32_bf16 v[16:19], a[80:83], v[84:87], v[16:19]
  ds_read_b128 v[76:79], v2 offset:36864
  v_mfma_f32_16x16x32_bf16 v[24:27], a[84:87], v[84:87], v[24:27]
  s_waitcnt lgkmcnt(7)
  v_mfma_f32_16x16x32_bf16 v[12:15], a[88:91], v[88:91], v[12:15]
  ds_read_b128 v[80:83], v2 offset:32768
  v_mfma_f32_16x16x32_bf16 v[20:23], a[92:95], v[88:91], v[20:23]
  s_waitcnt lgkmcnt(7)
  v_mfma_f32_16x16x32_bf16 v[16:19], a[88:91], v[92:95], v[16:19]
  ds_read_b128 v[84:87], v2 offset:37888
  v_mfma_f32_16x16x32_bf16 v[24:27], a[92:95], v[92:95], v[24:27]
  s_waitcnt lgkmcnt(7)
  v_mfma_f32_16x16x32_bf16 v[12:15], v[44:47], v[96:99], v[12:15]
  ds_read_b128 v[88:91], v2 offset:33792
  v_mfma_f32_16x16x32_bf16 v[20:23], v[48:51], v[96:99], v[20:23]
  s_waitcnt lgkmcnt(7)
  v_mfma_f32_16x16x32_bf16 v[16:19], v[44:47], v[100:103], v[16:19]
  ds_read_b128 v[92:95], v2 offset:38912
  v_mfma_f32_16x16x32_bf16 v[24:27], v[48:51], v[100:103], v[24:27]
  s_waitcnt lgkmcnt(7)
  v_mfma_f32_16x16x32_bf16 v[12:15], a[96:99], v[64:67], v[12:15]
  ds_read_b128 v[96:99], v2 offset:34816
  v_mfma_f32_16x16x32_bf16 v[20:23], a[100:103], v[64:67], v[20:23]
  s_waitcnt lgkmcnt(7)
  v_mfma_f32_16x16x32_bf16 v[16:19], a[96:99], v[68:71], v[16:19]
  ds_read_b128 v[100:103], v2 offset:39936
  v_mfma_f32_16x16x32_bf16 v[24:27], a[100:103], v[68:71], v[24:27]
  s_waitcnt lgkmcnt(7)
  v_mfma_f32_16x16x32_bf16 v[12:15], a[104:107], v[72:75], v[12:15]
  v_mfma_f32_16x16x32_bf16 v[20:23], a[108:111], v[72:75], v[20:23]
  s_waitcnt lgkmcnt(6)
  v_mfma_f32_16x16x32_bf16 v[16:19], a[104:107], v[76:79], v[16:19]
  v_mfma_f32_16x16x32_bf16 v[24:27], a[108:111], v[76:79], v[24:27]
  s_waitcnt lgkmcnt(5)
  v_mfma_f32_16x16x32_bf16 v[12:15], a[112:115], v[80:83], v[12:15]
  v_mfma_f32_16x16x32_bf16 v[20:23], a[116:119], v[80:83], v[20:23]
  s_waitcnt lgkmcnt(4)
  v_mfma_f32_16x16x32_bf16 v[16:19], a[112:115], v[84:87], v[16:19]
  v_mfma_f32_16x16x32_bf16 v[24:27], a[116:119], v[84:87], v[24:27]
  s_waitcnt lgkmcnt(3)
  v_mfma_f32_16x16x32_bf16 v[12:15], a[120:123], v[88:91], v[12:15]
  v_mfma_f32_16x16x32_bf16 v[20:23], a[124:127], v[88:91], v[20:23]
  s_waitcnt lgkmcnt(2)
  v_mfma_f32_16x16x32_bf16 v[16:19], a[120:123], v[92:95], v[16:19]
  v_mfma_f32_16x16x32_bf16 v[24:27], a[124:127], v[92:95], v[24:27]
  s_waitcnt lgkmcnt(1)
  v_mfma_f32_16x16x32_bf16 v[12:15], v[52:55], v[96:99], v[12:15]
  v_mfma_f32_16x16x32_bf16 v[20:23], v[56:59], v[96:99], v[20:23]
  s_waitcnt lgkmcnt(0)
  v_mfma_f32_16x16x32_bf16 v[16:19], v[52:55], v[100:103], v[16:19]
  v_mfma_f32_16x16x32_bf16 v[24:27], v[56:59], v[100:103], v[24:27]
  v_mul_u32_u24 v9, 1792, v4
  v_lshl_add_u32 v9, v3, 3, v9
  s_lshl_b32 s22, s20, 5
  v_add_u32 v8, s22, v9
  s_mul_i32 s22, s20, 24
  s_add_u32 s22, s22, 512
  v_add_u32 v9, s22, v9
  v_mov_b32 v10, 0x40000000
  v_cmp_eq_u32 vcc, 3, v3
  s_nop 1
  v_cndmask_b32 v9, v9, v10, vcc
  s_mul_i32 s26, s17, 57344
  s_add_u32 s26, s26, 896
  s_add_u32 s27, s26, 28672
  v_cvt_pk_bf16_f32 v108, v12, v13
  v_cvt_pk_bf16_f32 v109, v14, v15
  buffer_store_dwordx2 v[108:109], v8, s[92:95], s26 offen
  v_cvt_pk_bf16_f32 v110, v20, v21
  v_cvt_pk_bf16_f32 v111, v22, v23
  buffer_store_dwordx2 v[110:111], v9, s[92:95], s26 offen
  v_cvt_pk_bf16_f32 v112, v16, v17
  v_cvt_pk_bf16_f32 v113, v18, v19
  buffer_store_dwordx2 v[112:113], v8, s[92:95], s27 offen
  v_cvt_pk_bf16_f32 v114, v24, v25
  v_cvt_pk_bf16_f32 v115, v26, v27
  buffer_store_dwordx2 v[114:115], v9, s[92:95], s27 offen
  s_branch wk_loop
wp_abort:
wo_abort:
  s_branch cA_abort
wk_done:
ch_end:
  s_endpgm

.section .rodata,"a"
.p2align 6
.amdhsa_kernel main_kernel
  .amdhsa_next_free_vgpr 512
  .amdhsa_next_free_sgpr 102
  .amdhsa_accum_offset 256
  .amdhsa_group_segment_fixed_size 0
  .amdhsa_kernarg_size 136
  .amdhsa_user_sgpr_count 2
  .amdhsa_user_sgpr_kernarg_segment_ptr 1
  .amdhsa_system_sgpr_workgroup_id_x 1
.end_amdhsa_kernel
```

```asm
; @launch kernel=main_kernel grid=(256,1,1) block=(256,1,1) lds=163840
.amdgcn_target "amdgcn-amd-amdhsa--gfx950"
.text
.globl main_kernel
.p2align 8
.type main_kernel,@function
main_kernel:
  s_cmp_ge_u32 s2, 256
  s_cbranch_scc1 ch_end
  s_load_dwordx2 s[4:5], s[0:1], 120
  s_load_dwordx2 s[6:7], s[0:1], 128
  s_load_dwordx8 s[40:47], s[0:1], 72
  s_load_dwordx4 s[48:51], s[0:1], 56
  s_mov_b32 s32, 0
  s_getreg_b32 s3, hwreg(HW_REG_XCC_ID)
  s_and_b32 s3, s3, 15
  s_cmp_lg_u32 s3, 1
  s_cbranch_scc1 ch_pf
  s_cmp_lt_u32 s2, 224
  s_cbranch_scc1 ch_npf
ch_pf:
  s_getpc_b64 s[98:99]
pf_main_kernel_1:
  s_sub_u32 s98, s98, pf_main_kernel_1-main_kernel
  s_subb_u32 s99, s99, 0
  v_lshlrev_b32 v60, 7, v0
  v_min_u32 v61, ch_end-main_kernel-4, v60
  global_load_dword v62, v61, s[98:99]
  v_add_u32 v60, 32768, v60
  v_min_u32 v61, ch_end-main_kernel-4, v60
  global_load_dword v62, v61, s[98:99]
  v_add_u32 v60, 32768, v60
  v_min_u32 v61, ch_end-main_kernel-4, v60
  global_load_dword v62, v61, s[98:99]
  v_add_u32 v60, 32768, v60
  v_min_u32 v61, ch_end-main_kernel-4, v60
  global_load_dword v62, v61, s[98:99]
  v_add_u32 v60, 32768, v60
  v_min_u32 v61, ch_end-main_kernel-4, v60
  global_load_dword v62, v61, s[98:99]
  v_add_u32 v60, 32768, v60
ch_npf:
  v_lshrrev_b32 v1, 6, v0
  s_nop 0
  v_readfirstlane_b32 s16, v1
  s_waitcnt lgkmcnt(0)
  s_mov_b32 s8, s6
  s_and_b32 s9, s7, 0xffff
  s_mov_b32 s10, 0x10000000
  s_mov_b32 s11, 0x20000
  s_mov_b32 s12, s4
  s_and_b32 s13, s5, 0xffff
  s_mov_b32 s14, 256
  s_mov_b32 s15, 0x20000
  v_mov_b32 v252, 0x40000000
  v_cmp_eq_u32 vcc, 0, v0
  s_nop 1
  v_cndmask_b32 v252, v252, v0, vcc
  s_cmp_lg_u32 s3, 1
  s_cbranch_scc1 ch_worker
  s_mov_b32 s18, 0
  v_mov_b32 v249, 1
  s_mov_b64 exec, 1
  buffer_atomic_add v249, v252, s[12:15], 0 offen sc0
  s_mov_b64 exec, -1
  v_and_b32 v1, 63, v0
  v_lshlrev_b32 v2, 4, v1
  v_lshrrev_b32 v3, 4, v1
  v_and_b32 v4, 15, v1
  s_lshr_b32 s33, s2, 3
  s_lshl_b32 s27, s33, 2
  s_add_u32 s27, s27, s16
  s_lshl_b32 s27, s27, 13
  v_lshlrev_b32 v12, 7, v1
  s_mov_b32 s64, s42
  s_and_b32 s65, s43, 0xffff
  s_mov_b32 s66, 2097152
  s_mov_b32 s67, 0x20000
  s_mov_b32 s28, s27
  buffer_load_dword v13, v12, s[64:67], s28 offen
  s_add_u32 s28, s28, 1048576
  buffer_load_dword v13, v12, s[64:67], s28 offen
  s_add_u32 s28, s28, 1048576
  s_waitcnt vmcnt(2)
  v_readfirstlane_b32 s17, v249
  v_mov_b32 v6, 160032
  s_nop 0
  v_mov_b32 v7, s17
  s_barrier
  s_cmp_lg_u32 s16, 0
  s_cbranch_scc1 uni_2
  ds_write_b32 v6, v7
  s_waitcnt lgkmcnt(0)
uni_2:
  s_barrier
  ds_read_b32 v7, v6
  s_waitcnt lgkmcnt(0)
  v_readfirstlane_b32 s17, v7
  s_branch ch_got
ch_take:
  v_mov_b32 v5, 0
  v_mov_b32 v6, 160000
  s_barrier
  s_cmp_lg_u32 s16, 0
  s_cbranch_scc1 ch_el1
  s_mov_b64 exec, 1
  buffer_atomic_add v4, v5, s[12:15], 0 offen sc0
  s_waitcnt vmcnt(0)
  ds_write_b32 v6, v4
  s_waitcnt lgkmcnt(0)
  s_mov_b64 exec, -1
ch_el1:
  s_barrier
  ds_read_b32 v4, v6
  s_waitcnt lgkmcnt(0)
  v_readfirstlane_b32 s17, v4
ch_got:
  s_and_b32 s17, s17, 0xffff
  s_cmp_lt_u32 s17, 32
  s_cbranch_scc1 ch_role
  s_cmp_eq_u32 s18, 0
  s_cbranch_scc1 ch_worker
  v_and_b32 v1, 63, v0
  v_lshlrev_b32 v2, 4, v1
  v_lshrrev_b32 v3, 4, v1
  v_and_b32 v4, 15, v1
  s_branch wp_all
ch_role:
  v_and_b32 v1, 63, v0
  v_lshlrev_b32 v2, 4, v1
  v_lshrrev_b32 v3, 4, v1
  v_and_b32 v4, 15, v1
  s_cmp_lt_u32 s17, 16
  s_cbranch_scc1 ch_self
  s_cmp_lt_u32 s17, 24
  s_cbranch_scc1 ch_tch
  s_sub_u32 s33, s17, 24
  v_mov_b32 v10, 0x40000000
  v_mov_b32 v5, 1
  v_mov_b32 v148, 0
  v_mov_b32 v149, 0
  v_mov_b32 v150, 0
  v_mov_b32 v151, 0
  v_mov_b32 v152, -1
  v_mov_b32 v153, -1
  v_mov_b32 v154, -1
  v_mov_b32 v155, -1
  v_lshlrev_b32 v8, 4, v0
  s_mov_b32 s64, s48
  s_and_b32 s65, s49, 0xffff
  s_mov_b32 s66, 1835008
  s_mov_b32 s67, 0x20000
  s_lshl_b32 s21, s33, 2
  s_add_u32 s21, s21, s16
  s_lshr_b32 s22, s21, 1
  s_mul_i32 s22, s22, 14336
  s_and_b32 s24, s21, 1
  s_mul_i32 s24, s24, 448
  s_add_u32 s22, s22, s24
  s_mul_i32 s21, s21, 7168
  v_mul_u32_u24 v7, 896, v4
  v_lshl_add_u32 v7, v3, 4, v7
  buffer_load_dwordx4 v[64:67], v7, s[64:67], s22 offen offset:0
  buffer_load_dwordx4 v[68:71], v7, s[64:67], s22 offen offset:64
  buffer_load_dwordx4 v[72:75], v7, s[64:67], s22 offen offset:128
  buffer_load_dwordx4 v[76:79], v7, s[64:67], s22 offen offset:192
  buffer_load_dwordx4 v[80:83], v7, s[64:67], s22 offen offset:256
  buffer_load_dwordx4 v[84:87], v7, s[64:67], s22 offen offset:320
  buffer_load_dwordx4 v[88:91], v7, s[64:67], s22 offen offset:384
  s_mov_b32 s68, s50
  s_and_b32 s69, s51, 0xffff
  s_mov_b32 s70, 7168
  s_mov_b32 s71, 0x20000
  v_lshrrev_b32 v6, 3, v0
  v_min_u32 v6, 27, v6
  v_and_b32 v7, 7, v0
  v_mul_u32_u24 v9, 896, v7
  v_lshl_add_u32 v9, v6, 5, v9
  buffer_load_dwordx4 v[176:179], v9, s[68:71], 0 offen
  buffer_load_dwordx4 v[180:183], v9, s[68:71], 0 offen offset:16
  s_cmp_lg_u32 s33, 0
  s_cbranch_scc1 ch_ij_1
  s_mov_b32 s23, 582144
  buffer_store_dwordx4 v[148:151], v8, s[8:11], s23 offen sc1
  s_mov_b32 s23, 586240
  buffer_store_dwordx4 v[148:151], v8, s[8:11], s23 offen sc1
  s_waitcnt vmcnt(0)
  s_barrier
  buffer_store_dword v5, v252, s[12:15], 0 offen offset:128 sc1
ch_ij_1:
  s_waitcnt vmcnt(1)
  s_add_u32 s23, s21, 655360
  buffer_store_dwordx4 v[64:67], v2, s[8:11], s23 offen offset:0 sc1
  buffer_store_dwordx4 v[68:71], v2, s[8:11], s23 offen offset:1024 sc1
  buffer_store_dwordx4 v[72:75], v2, s[8:11], s23 offen offset:2048 sc1
  buffer_store_dwordx4 v[76:79], v2, s[8:11], s23 offen offset:3072 sc1
  s_add_u32 s23, s21, 659456
  buffer_store_dwordx4 v[80:83], v2, s[8:11], s23 offen offset:0 sc1
  buffer_store_dwordx4 v[84:87], v2, s[8:11], s23 offen offset:1024 sc1
  buffer_store_dwordx4 v[88:91], v2, s[8:11], s23 offen offset:2048 sc1
  s_waitcnt vmcnt(0)
  s_barrier
  s_cmp_lg_u32 s16, 0
  s_cbranch_scc1 ch_ij_x_e
  v_mov_b32 v6, 1
  s_mov_b64 exec, 1
  buffer_atomic_add v6, v252, s[12:15], 0 offen offset:4 sc0
  s_waitcnt vmcnt(0)
  v_readfirstlane_b32 s20, v6
  s_cmp_lg_u32 s20, 7
  s_cbranch_scc1 ch_ij_x_e0
  s_mov_b64 exec, 0xff
  v_lshlrev_b32 v6, 7, v0
  s_mov_b32 s20, 586240
  buffer_store_dword v5, v6, s[8:11], s20 offen offset:8 sc1
ch_ij_x_e0:
  s_mov_b64 exec, -1
ch_ij_x_e:
  s_lshl_b32 s20, s33, 12
  v_add_u32 v8, s20, v8
  s_mov_b32 s23, 524288
ch_ijlp_3:
  buffer_store_dwordx4 v[148:151], v8, s[8:11], s23 offen sc1
  s_add_u32 s23, s23, 32768
  s_cmp_lt_u32 s23, 557056
  s_cbranch_scc1 ch_ijlp_3
  v_cmp_gt_u32 vcc, 25088, v8
  s_nop 1
  v_cndmask_b32 v9, v10, v8, vcc
  buffer_store_dwordx4 v[148:151], v9, s[8:11], s23 offen sc1
  s_mov_b32 s23, 35328
  v_cmp_gt_u32 vcc, 6144, v8
  s_nop 1
  v_cndmask_b32 v9, v10, v8, vcc
  buffer_store_dwordx4 v[148:151], v9, s[8:11], s23 offen sc1
  s_mov_b32 s23, 7168
  v_cmp_gt_u32 vcc, 28160, v8
  s_nop 1
  v_cndmask_b32 v9, v10, v8, vcc
  buffer_store_dwordx4 v[152:155], v9, s[8:11], s23 offen sc1
  s_mov_b32 s23, 72704
ch_ijlp_4:
  buffer_store_dwordx4 v[152:155], v8, s[8:11], s23 offen sc1
  s_add_u32 s23, s23, 32768
  s_cmp_lt_u32 s23, 498688
  s_cbranch_scc1 ch_ijlp_4
  v_cmp_gt_u32 vcc, 25600, v8
  s_nop 1
  v_cndmask_b32 v9, v10, v8, vcc
  buffer_store_dwordx4 v[152:155], v9, s[8:11], s23 offen sc1
  s_cmp_lg_u32 s33, 1
  s_cbranch_scc1 ch_ij_nm
  v_lshrrev_b32 v6, 3, v0
  v_and_b32 v7, 7, v0
  v_lshlrev_b32 v8, 8, v6
  v_lshl_add_u32 v8, v7, 4, v8
  v_cmp_gt_u32 vcc, 28, v6
  s_nop 1
  v_cndmask_b32 v8, v10, v8, vcc
  s_waitcnt vmcnt(4)
  v_mov_b32 v184, v176
  v_mov_b32 v188, v177
  v_mov_b32 v185, v178
  v_mov_b32 v189, v179
  v_mov_b32 v186, v180
  v_mov_b32 v190, v181
  v_mov_b32 v187, v182
  v_mov_b32 v191, v183
  s_mov_b32 s23, 0
  buffer_store_dwordx4 v[184:187], v8, s[8:11], s23 offen sc1
  buffer_store_dwordx4 v[188:191], v8, s[8:11], s23 offen offset:128 sc1
  s_mov_b32 s23, 65536
  buffer_store_dwordx4 v[184:187], v8, s[8:11], s23 offen sc1
  buffer_store_dwordx4 v[188:191], v8, s[8:11], s23 offen offset:128 sc1
ch_ij_nm:
  s_waitcnt vmcnt(0)
  s_barrier
  s_cmp_lg_u32 s16, 0
  s_cbranch_scc1 ch_ij_e
  v_mov_b32 v6, 1
  s_mov_b64 exec, 1
  buffer_atomic_add v6, v252, s[12:15], 0 offen offset:12 sc0
  s_waitcnt vmcnt(0)
  v_readfirstlane_b32 s20, v6
  s_cmp_lg_u32 s20, 7
  s_cbranch_scc1 ch_ij_e0
  buffer_store_dword v5, v252, s[12:15], 0 offen offset:132 sc1
  s_mov_b64 exec, 0xff
  v_lshlrev_b32 v6, 7, v0
  s_mov_b32 s20, 586240
  buffer_store_dword v5, v6, s[8:11], s20 offen offset:4 sc1
ch_ij_e0:
  s_mov_b64 exec, -1
ch_ij_e:
  s_branch ch_role2
ch_tch:
  s_sub_u32 s33, s17, 16
  s_lshl_b32 s27, s33, 2
  s_add_u32 s27, s27, s16
  s_lshl_b32 s27, s27, 13
  v_lshlrev_b32 v12, 7, v1
  s_mov_b32 s64, s40
  s_and_b32 s65, s41, 0xffff
  s_mov_b32 s66, 2097152
  s_mov_b32 s67, 0x20000
  s_mov_b32 s28, s27
  buffer_load_dword v13, v12, s[64:67], s28 offen
  s_add_u32 s28, s28, 262144
  buffer_load_dword v13, v12, s[64:67], s28 offen
  s_add_u32 s28, s28, 262144
  buffer_load_dword v13, v12, s[64:67], s28 offen
  s_add_u32 s28, s28, 262144
  buffer_load_dword v13, v12, s[64:67], s28 offen
  s_add_u32 s28, s28, 262144
  buffer_load_dword v13, v12, s[64:67], s28 offen
  s_add_u32 s28, s28, 262144
  buffer_load_dword v13, v12, s[64:67], s28 offen
  s_add_u32 s28, s28, 262144
  buffer_load_dword v13, v12, s[64:67], s28 offen
  s_add_u32 s28, s28, 262144
  buffer_load_dword v13, v12, s[64:67], s28 offen
  s_add_u32 s28, s28, 262144
  s_branch ch_role2
ch_self:
  v_lshrrev_b32 v5, 5, v1
  v_and_b32 v6, 31, v1
  v_xor_b32 v8, v6, v5
  v_lshlrev_b32 v8, 4, v8
  v_lshl_add_u32 v16, v5, 13, v8
  v_xor_b32 v17, 32, v16
  v_xor_b32 v18, 64, v16
  v_xor_b32 v19, 96, v16
  v_xor_b32 v20, 128, v16
  v_xor_b32 v21, 160, v16
  v_xor_b32 v22, 192, v16
  v_xor_b32 v23, 224, v16
  s_lshl_b32 s20, s16, 6
  v_xor_b32 v26, s20, v16
  v_xor_b32 v27, 32, v26
  s_mov_b32 s60, s40
  s_and_b32 s61, s41, 0xffff
  s_mov_b32 s62, 3670016
  s_mov_b32 s63, 0x20000
  s_mov_b32 s56, s42
  s_and_b32 s57, s43, 0xffff
  s_mov_b32 s58, 3670016
  s_mov_b32 s59, 0x20000
  s_lshl_b32 s26, s17, 9
  s_lshl_b32 s27, s16, 19
  s_add_u32 s27, s27, s26
  s_lshl_b32 s25, s16, 15
  s_add_u32 s25, s25, 32768
  s_barrier
  s_add_u32 m0, s25, 0
  s_nop 0
  buffer_load_dwordx4 v16, s[56:59], s27 offen lds
  s_add_u32 s27, s27, 16384
  s_add_u32 m0, s25, 1024
  s_nop 0
  buffer_load_dwordx4 v16, s[56:59], s27 offen lds
  s_add_u32 s27, s27, 16384
  s_add_u32 m0, s25, 2048
  s_nop 0
  buffer_load_dwordx4 v17, s[56:59], s27 offen lds
  s_add_u32 s27, s27, 16384
  s_add_u32 m0, s25, 3072
  s_nop 0
  buffer_load_dwordx4 v17, s[56:59], s27 offen lds
  s_add_u32 s27, s27, 16384
  s_add_u32 m0, s25, 4096
  s_nop 0
  buffer_load_dwordx4 v16, s[56:59], s27 offen lds
  s_add_u32 s27, s27, 16384
  s_add_u32 m0, s25, 5120
  s_nop 0
  buffer_load_dwordx4 v16, s[56:59], s27 offen lds
  s_add_u32 s27, s27, 16384
  s_add_u32 m0, s25, 6144
  s_nop 0
  buffer_load_dwordx4 v17, s[56:59], s27 offen lds
  s_add_u32 s27, s27, 16384
  s_add_u32 m0, s25, 7168
  s_nop 0
  buffer_load_dwordx4 v17, s[56:59], s27 offen lds
  s_add_u32 s27, s27, 16384
  s_add_u32 m0, s25, 8192
  s_nop 0
  buffer_load_dwordx4 v18, s[56:59], s27 offen lds
  s_add_u32 s27, s27, 16384
  s_add_u32 m0, s25, 9216
  s_nop 0
  buffer_load_dwordx4 v18, s[56:59], s27 offen lds
  s_add_u32 s27, s27, 16384
  s_add_u32 m0, s25, 10240
  s_nop 0
  buffer_load_dwordx4 v19, s[56:59], s27 offen lds
  s_add_u32 s27, s27, 16384
  s_add_u32 m0, s25, 11264
  s_nop 0
  buffer_load_dwordx4 v19, s[56:59], s27 offen lds
  s_add_u32 s27, s27, 16384
  s_add_u32 m0, s25, 12288
  s_nop 0
  buffer_load_dwordx4 v18, s[56:59], s27 offen lds
  s_add_u32 s27, s27, 16384
  s_add_u32 m0, s25, 13312
  s_nop 0
  buffer_load_dwordx4 v18, s[56:59], s27 offen lds
  s_add_u32 s27, s27, 16384
  s_add_u32 m0, s25, 14336
  s_nop 0
  buffer_load_dwordx4 v19, s[56:59], s27 offen lds
  s_add_u32 s27, s27, 16384
  s_add_u32 m0, s25, 15360
  s_nop 0
  buffer_load_dwordx4 v19, s[56:59], s27 offen lds
  s_add_u32 s27, s27, 16384
  s_add_u32 m0, s25, 16384
  s_nop 0
  buffer_load_dwordx4 v20, s[56:59], s27 offen lds
  s_add_u32 s27, s27, 16384
  s_add_u32 m0, s25, 17408
  s_nop 0
  buffer_load_dwordx4 v20, s[56:59], s27 offen lds
  s_add_u32 s27, s27, 16384
  s_add_u32 m0, s25, 18432
  s_nop 0
  buffer_load_dwordx4 v21, s[56:59], s27 offen lds
  s_add_u32 s27, s27, 16384
  s_add_u32 m0, s25, 19456
  s_nop 0
  buffer_load_dwordx4 v21, s[56:59], s27 offen lds
  s_add_u32 s27, s27, 16384
  s_add_u32 m0, s25, 20480
  s_nop 0
  buffer_load_dwordx4 v20, s[56:59], s27 offen lds
  s_add_u32 s27, s27, 16384
  s_add_u32 m0, s25, 21504
  s_nop 0
  buffer_load_dwordx4 v20, s[56:59], s27 offen lds
  s_add_u32 s27, s27, 16384
  s_add_u32 m0, s25, 22528
  s_nop 0
  buffer_load_dwordx4 v21, s[56:59], s27 offen lds
  s_add_u32 s27, s27, 16384
  s_add_u32 m0, s25, 23552
  s_nop 0
  buffer_load_dwordx4 v21, s[56:59], s27 offen lds
  s_add_u32 s27, s27, 16384
  s_add_u32 m0, s25, 24576
  s_nop 0
  buffer_load_dwordx4 v22, s[56:59], s27 offen lds
  s_add_u32 s27, s27, 16384
  s_add_u32 m0, s25, 25600
  s_nop 0
  buffer_load_dwordx4 v22, s[56:59], s27 offen lds
  s_add_u32 s27, s27, 16384
  s_add_u32 m0, s25, 26624
  s_nop 0
  buffer_load_dwordx4 v23, s[56:59], s27 offen lds
  s_add_u32 s27, s27, 16384
  s_add_u32 m0, s25, 27648
  s_nop 0
  buffer_load_dwordx4 v23, s[56:59], s27 offen lds
  s_add_u32 s27, s27, 16384
  s_add_u32 m0, s25, 28672
  s_nop 0
  buffer_load_dwordx4 v22, s[56:59], s27 offen lds
  s_add_u32 s27, s27, 16384
  s_add_u32 m0, s25, 29696
  s_nop 0
  buffer_load_dwordx4 v22, s[56:59], s27 offen lds
  s_add_u32 s27, s27, 16384
  s_add_u32 m0, s25, 30720
  s_nop 0
  buffer_load_dwordx4 v23, s[56:59], s27 offen lds
  s_add_u32 s27, s27, 16384
  s_add_u32 m0, s25, 31744
  s_nop 0
  buffer_load_dwordx4 v23, s[56:59], s27 offen lds
  s_add_u32 s27, s27, 16384
  v_mov_b32 v14, v26
  v_mov_b32 v15, v27
  s_lshl_b32 s28, s16, 16
  s_add_u32 s28, s28, s26
  s_lshl_b32 s29, s16, 12
  s_add_u32 m0, s29, 0
  s_add_u32 s27, s28, 0
  buffer_load_dwordx4 v14, s[60:63], s27 offen lds
  s_add_u32 m0, s29, 1024
  s_add_u32 s27, s28, 16384
  buffer_load_dwordx4 v15, s[60:63], s27 offen lds
  s_add_u32 m0, s29, 2048
  s_add_u32 s27, s28, 32768
  buffer_load_dwordx4 v14, s[60:63], s27 offen lds
  s_add_u32 m0, s29, 3072
  s_add_u32 s27, s28, 49152
  buffer_load_dwordx4 v15, s[60:63], s27 offen lds
  s_add_u32 m0, s29, 16384
  s_add_u32 s27, s28, 262144
  buffer_load_dwordx4 v14, s[60:63], s27 offen lds
  s_add_u32 m0, s29, 17408
  s_add_u32 s27, s28, 278528
  buffer_load_dwordx4 v15, s[60:63], s27 offen lds
  s_add_u32 m0, s29, 18432
  s_add_u32 s27, s28, 294912
  buffer_load_dwordx4 v14, s[60:63], s27 offen lds
  s_add_u32 m0, s29, 19456
  s_add_u32 s27, s28, 311296
  buffer_load_dwordx4 v15, s[60:63], s27 offen lds
  v_lshrrev_b32 v7, 2, v4
  v_lshlrev_b32 v11, 4, v7
  v_lshlrev_b32 v7, 3, v7
  v_and_b32 v8, 3, v4
  v_add_u32 v7, v7, v8
  v_and_b32 v8, 2, v4
  v_lshl_add_u32 v11, v8, 1, v11
  v_and_b32 v8, 1, v4
  v_add_u32 v11, v11, v8
  v_or_b32 v10, 0, v3
  v_xor_b32 v10, v10, v4
  v_lshlrev_b32 v10, 4, v10
  v_lshl_add_u32 v248, v7, 9, v10
  v_add_u32 v252, 65536, v248
  v_add_u32 v16, 131072, v248
  v_lshl_add_u32 v10, v11, 9, v10
  v_add_u32 v20, s25, v10
  v_or_b32 v10, 4, v3
  v_xor_b32 v10, v10, v4
  v_lshlrev_b32 v10, 4, v10
  v_lshl_add_u32 v249, v7, 9, v10
  v_add_u32 v253, 65536, v249
  v_add_u32 v17, 131072, v249
  v_lshl_add_u32 v10, v11, 9, v10
  v_add_u32 v21, s25, v10
  v_or_b32 v10, 8, v3
  v_xor_b32 v10, v10, v4
  v_lshlrev_b32 v10, 4, v10
  v_lshl_add_u32 v250, v7, 9, v10
  v_add_u32 v254, 65536, v250
  v_add_u32 v18, 131072, v250
  v_lshl_add_u32 v10, v11, 9, v10
  v_add_u32 v22, s25, v10
  v_or_b32 v10, 12, v3
  v_xor_b32 v10, v10, v4
  v_lshlrev_b32 v10, 4, v10
  v_lshl_add_u32 v251, v7, 9, v10
  v_add_u32 v255, 65536, v251
  v_add_u32 v19, 131072, v251
  v_lshl_add_u32 v10, v11, 9, v10
  v_add_u32 v23, s25, v10
  v_mov_b32 v12, 1035512379
  v_lshlrev_b32 v6, 7, v1
  s_getpc_b64 s[98:99]
  global_load_dword v7, v6, s[98:99]
  s_waitcnt vmcnt(9)
  ds_read_b128 v[120:123], v20 offset:0
  ds_read_b128 v[124:127], v21 offset:0
  ds_read_b128 v[128:131], v22 offset:0
  ds_read_b128 v[132:135], v23 offset:0
  ds_read_b128 v[136:139], v20 offset:256
  ds_read_b128 v[140:143], v21 offset:256
  ds_read_b128 v[144:147], v22 offset:256
  ds_read_b128 v[148:151], v23 offset:256
  s_waitcnt lgkmcnt(8)
  ds_read_b128 v[152:155], v20 offset:1024
  ds_read_b128 v[156:159], v21 offset:1024
  ds_read_b128 v[160:163], v22 offset:1024
  ds_read_b128 v[164:167], v23 offset:1024
  ds_read_b128 v[168:171], v20 offset:1280
  ds_read_b128 v[172:175], v21 offset:1280
  ds_read_b128 v[176:179], v22 offset:1280
  ds_read_b128 v[180:183], v23 offset:1280
  s_waitcnt lgkmcnt(8)
  ds_read_b128 v[184:187], v20 offset:4096
  ds_read_b128 v[188:191], v21 offset:4096
  ds_read_b128 v[192:195], v22 offset:4096
  ds_read_b128 v[196:199], v23 offset:4096
  ds_read_b128 v[200:203], v20 offset:4352
  ds_read_b128 v[204:207], v21 offset:4352
  ds_read_b128 v[208:211], v22 offset:4352
  ds_read_b128 v[212:215], v23 offset:4352
  s_waitcnt lgkmcnt(8)
  ds_read_b128 v[216:219], v20 offset:5120
  ds_read_b128 v[220:223], v21 offset:5120
  ds_read_b128 v[224:227], v22 offset:5120
  ds_read_b128 v[228:231], v23 offset:5120
  ds_read_b128 v[232:235], v20 offset:5376
  ds_read_b128 v[236:239], v21 offset:5376
  ds_read_b128 v[240:243], v22 offset:5376
  ds_read_b128 v[244:247], v23 offset:5376
  s_waitcnt lgkmcnt(8)
  s_waitcnt vmcnt(4) lgkmcnt(0)
  s_barrier
  s_add_u32 m0, s29, 32768
  s_add_u32 s27, s28, 524288
  buffer_load_dwordx4 v14, s[60:63], s27 offen lds
  s_add_u32 m0, s29, 33792
  s_add_u32 s27, s28, 540672
  buffer_load_dwordx4 v15, s[60:63], s27 offen lds
  s_add_u32 m0, s29, 34816
  s_add_u32 s27, s28, 557056
  buffer_load_dwordx4 v14, s[60:63], s27 offen lds
  s_add_u32 m0, s29, 35840
  s_add_u32 s27, s28, 573440
  buffer_load_dwordx4 v15, s[60:63], s27 offen lds
  s_add_u32 m0, s29, 49152
  s_add_u32 s27, s28, 786432
  buffer_load_dwordx4 v14, s[60:63], s27 offen lds
  s_add_u32 m0, s29, 50176
  s_add_u32 s27, s28, 802816
  buffer_load_dwordx4 v15, s[60:63], s27 offen lds
  s_add_u32 m0, s29, 51200
  s_add_u32 s27, s28, 819200
  buffer_load_dwordx4 v14, s[60:63], s27 offen lds
  s_add_u32 m0, s29, 52224
  s_add_u32 s27, s28, 835584
  buffer_load_dwordx4 v15, s[60:63], s27 offen lds
  s_add_u32 m0, s29, 65536
  s_add_u32 s27, s28, 1048576
  buffer_load_dwordx4 v14, s[60:63], s27 offen lds
  s_add_u32 m0, s29, 66560
  s_add_u32 s27, s28, 1064960
  buffer_load_dwordx4 v15, s[60:63], s27 offen lds
  s_add_u32 m0, s29, 67584
  s_add_u32 s27, s28, 1081344
  buffer_load_dwordx4 v14, s[60:63], s27 offen lds
  s_add_u32 m0, s29, 68608
  s_add_u32 s27, s28, 1097728
  buffer_load_dwordx4 v15, s[60:63], s27 offen lds
  s_add_u32 m0, s29, 81920
  s_add_u32 s27, s28, 1310720
  buffer_load_dwordx4 v14, s[60:63], s27 offen lds
  s_add_u32 m0, s29, 82944
  s_add_u32 s27, s28, 1327104
  buffer_load_dwordx4 v15, s[60:63], s27 offen lds
  s_add_u32 m0, s29, 83968
  s_add_u32 s27, s28, 1343488
  buffer_load_dwordx4 v14, s[60:63], s27 offen lds
  s_add_u32 m0, s29, 84992
  s_add_u32 s27, s28, 1359872
  buffer_load_dwordx4 v15, s[60:63], s27 offen lds
  ds_read_b128 v[24:27], v248 offset:0
  ds_read_b128 v[28:31], v248 offset:2048
  ds_read_b128 v[32:35], v249 offset:0
  ds_read_b128 v[36:39], v249 offset:2048
  ds_read_b128 v[40:43], v250 offset:0
  ds_read_b128 v[44:47], v250 offset:2048
  s_waitcnt lgkmcnt(5)
  s_getpc_b64 s[98:99]
  s_add_u32 s98, s98, 4096
  s_addc_u32 s99, s99, 0
  global_load_dword v7, v6, s[98:99]
  v_mfma_f32_16x16x32_bf16 v[56:59], v[24:27], v[120:123], 0
  ds_read_b128 v[48:51], v251 offset:0
  v_mfma_f32_16x16x32_bf16 v[64:67], v[24:27], v[152:155], 0
  v_mfma_f32_16x16x32_bf16 v[72:75], v[24:27], v[184:187], 0
  s_add_u32 m0, s29, 98304
  s_add_u32 s27, s28, 1572864
  buffer_load_dwordx4 v14, s[60:63], s27 offen lds
  v_mfma_f32_16x16x32_bf16 v[80:83], v[24:27], v[216:219], 0
  s_waitcnt lgkmcnt(5)
  v_mfma_f32_16x16x32_bf16 v[60:63], v[28:31], v[120:123], 0
  ds_read_b128 v[52:55], v251 offset:2048
  v_mfma_f32_16x16x32_bf16 v[68:71], v[28:31], v[152:155], 0
  v_mfma_f32_16x16x32_bf16 v[76:79], v[28:31], v[184:187], 0
  v_mfma_f32_16x16x32_bf16 v[84:87], v[28:31], v[216:219], 0
  s_waitcnt lgkmcnt(5)
  v_mfma_f32_16x16x32_bf16 v[56:59], v[32:35], v[124:127], v[56:59]
  ds_read_b128 v[24:27], v248 offset:256
  v_mfma_f32_16x16x32_bf16 v[64:67], v[32:35], v[156:159], v[64:67]
  v_mfma_f32_16x16x32_bf16 v[72:75], v[32:35], v[188:191], v[72:75]
  s_add_u32 m0, s29, 99328
  s_add_u32 s27, s28, 1589248
  buffer_load_dwordx4 v15, s[60:63], s27 offen lds
  v_mfma_f32_16x16x32_bf16 v[80:83], v[32:35], v[220:223], v[80:83]
  s_waitcnt lgkmcnt(5)
  v_mfma_f32_16x16x32_bf16 v[60:63], v[36:39], v[124:127], v[60:63]
  ds_read_b128 v[28:31], v248 offset:2304
  v_mfma_f32_16x16x32_bf16 v[68:71], v[36:39], v[156:159], v[68:71]
  v_mfma_f32_16x16x32_bf16 v[76:79], v[36:39], v[188:191], v[76:79]
  v_mfma_f32_16x16x32_bf16 v[84:87], v[36:39], v[220:223], v[84:87]
  s_waitcnt lgkmcnt(5)
  v_mfma_f32_16x16x32_bf16 v[56:59], v[40:43], v[128:131], v[56:59]
  ds_read_b128 v[32:35], v249 offset:256
  v_mfma_f32_16x16x32_bf16 v[64:67], v[40:43], v[160:163], v[64:67]
  v_mfma_f32_16x16x32_bf16 v[72:75], v[40:43], v[192:195], v[72:75]
  s_add_u32 m0, s29, 100352
  s_add_u32 s27, s28, 1605632
  buffer_load_dwordx4 v14, s[60:63], s27 offen lds
  v_mfma_f32_16x16x32_bf16 v[80:83], v[40:43], v[224:227], v[80:83]
  s_waitcnt lgkmcnt(5)
  v_mfma_f32_16x16x32_bf16 v[60:63], v[44:47], v[128:131], v[60:63]
  ds_read_b128 v[36:39], v249 offset:2304
  v_mfma_f32_16x16x32_bf16 v[68:71], v[44:47], v[160:163], v[68:71]
  v_mfma_f32_16x16x32_bf16 v[76:79], v[44:47], v[192:195], v[76:79]
  v_mfma_f32_16x16x32_bf16 v[84:87], v[44:47], v[224:227], v[84:87]
  s_waitcnt lgkmcnt(5)
  v_mfma_f32_16x16x32_bf16 v[56:59], v[48:51], v[132:135], v[56:59]
  ds_read_b128 v[40:43], v250 offset:256
  v_mfma_f32_16x16x32_bf16 v[64:67], v[48:51], v[164:167], v[64:67]
  v_mfma_f32_16x16x32_bf16 v[72:75], v[48:51], v[196:199], v[72:75]
  s_add_u32 m0, s29, 101376
  s_add_u32 s27, s28, 1622016
  buffer_load_dwordx4 v15, s[60:63], s27 offen lds
  v_mfma_f32_16x16x32_bf16 v[80:83], v[48:51], v[228:231], v[80:83]
  s_waitcnt lgkmcnt(5)
  v_mfma_f32_16x16x32_bf16 v[60:63], v[52:55], v[132:135], v[60:63]
  ds_read_b128 v[44:47], v250 offset:2304
  v_mfma_f32_16x16x32_bf16 v[68:71], v[52:55], v[164:167], v[68:71]
  v_mfma_f32_16x16x32_bf16 v[76:79], v[52:55], v[196:199], v[76:79]
  v_mfma_f32_16x16x32_bf16 v[84:87], v[52:55], v[228:231], v[84:87]
  s_waitcnt lgkmcnt(5)
  v_mfma_f32_16x16x32_bf16 v[56:59], v[24:27], v[136:139], v[56:59]
  ds_read_b128 v[48:51], v251 offset:256
  v_mfma_f32_16x16x32_bf16 v[64:67], v[24:27], v[168:171], v[64:67]
  v_mfma_f32_16x16x32_bf16 v[72:75], v[24:27], v[200:203], v[72:75]
  v_mfma_f32_16x16x32_bf16 v[80:83], v[24:27], v[232:235], v[80:83]
  s_waitcnt lgkmcnt(5)
  v_mfma_f32_16x16x32_bf16 v[60:63], v[28:31], v[136:139], v[60:63]
  ds_read_b128 v[52:55], v251 offset:2304
  v_mfma_f32_16x16x32_bf16 v[68:71], v[28:31], v[168:171], v[68:71]
  v_mfma_f32_16x16x32_bf16 v[76:79], v[28:31], v[200:203], v[76:79]
  v_mfma_f32_16x16x32_bf16 v[84:87], v[28:31], v[232:235], v[84:87]
  s_waitcnt lgkmcnt(5)
  v_mfma_f32_16x16x32_bf16 v[56:59], v[32:35], v[140:143], v[56:59]
  s_waitcnt vmcnt(20)
  s_barrier
  ds_read_b128 v[24:27], v248 offset:16384
  v_mfma_f32_16x16x32_bf16 v[64:67], v[32:35], v[172:175], v[64:67]
  v_mfma_f32_16x16x32_bf16 v[72:75], v[32:35], v[204:207], v[72:75]
  v_mfma_f32_16x16x32_bf16 v[80:83], v[32:35], v[236:239], v[80:83]
  s_waitcnt lgkmcnt(5)
  v_mfma_f32_16x16x32_bf16 v[60:63], v[36:39], v[140:143], v[60:63]
  ds_read_b128 v[28:31], v248 offset:18432
  v_mfma_f32_16x16x32_bf16 v[68:71], v[36:39], v[172:175], v[68:71]
  v_mfma_f32_16x16x32_bf16 v[76:79], v[36:39], v[204:207], v[76:79]
  v_mfma_f32_16x16x32_bf16 v[84:87], v[36:39], v[236:239], v[84:87]
  s_waitcnt lgkmcnt(5)
  v_mfma_f32_16x16x32_bf16 v[56:59], v[40:43], v[144:147], v[56:59]
  ds_read_b128 v[32:35], v249 offset:16384
  v_mfma_f32_16x16x32_bf16 v[64:67], v[40:43], v[176:179], v[64:67]
  v_mfma_f32_16x16x32_bf16 v[72:75], v[40:43], v[208:211], v[72:75]
  v_mfma_f32_16x16x32_bf16 v[80:83], v[40:43], v[240:243], v[80:83]
  s_waitcnt lgkmcnt(5)
  v_mfma_f32_16x16x32_bf16 v[60:63], v[44:47], v[144:147], v[60:63]
  ds_read_b128 v[36:39], v249 offset:18432
  v_mfma_f32_16x16x32_bf16 v[68:71], v[44:47], v[176:179], v[68:71]
  v_mfma_f32_16x16x32_bf16 v[76:79], v[44:47], v[208:211], v[76:79]
  v_mfma_f32_16x16x32_bf16 v[84:87], v[44:47], v[240:243], v[84:87]
  s_waitcnt lgkmcnt(5)
  v_mfma_f32_16x16x32_bf16 v[56:59], v[48:51], v[148:151], v[56:59]
  ds_read_b128 v[40:43], v250 offset:16384
  v_mfma_f32_16x16x32_bf16 v[64:67], v[48:51], v[180:183], v[64:67]
  v_mfma_f32_16x16x32_bf16 v[72:75], v[48:51], v[212:215], v[72:75]
  v_mfma_f32_16x16x32_bf16 v[80:83], v[48:51], v[244:247], v[80:83]
  s_waitcnt lgkmcnt(5)
  v_mfma_f32_16x16x32_bf16 v[60:63], v[52:55], v[148:151], v[60:63]
  ds_read_b128 v[44:47], v250 offset:18432
  v_mfma_f32_16x16x32_bf16 v[68:71], v[52:55], v[180:183], v[68:71]
  v_mfma_f32_16x16x32_bf16 v[76:79], v[52:55], v[212:215], v[76:79]
  v_mfma_f32_16x16x32_bf16 v[84:87], v[52:55], v[244:247], v[84:87]
  s_waitcnt lgkmcnt(5)
  v_mfma_f32_16x16x32_bf16 v[88:91], v[24:27], v[120:123], 0
  ds_read_b128 v[48:51], v251 offset:16384
  v_mfma_f32_16x16x32_bf16 v[96:99], v[24:27], v[152:155], 0
  v_mfma_f32_16x16x32_bf16 v[104:107], v[24:27], v[184:187], 0
  s_add_u32 m0, s29, 114688
  s_add_u32 s27, s28, 1835008
  buffer_load_dwordx4 v14, s[60:63], s27 offen lds
  v_mfma_f32_16x16x32_bf16 v[112:115], v[24:27], v[216:219], 0
  s_waitcnt lgkmcnt(5)
  v_mul_f32 v56, v12, v56
  v_mfma_f32_16x16x32_bf16 v[92:95], v[28:31], v[120:123], 0
  ds_read_b128 v[52:55], v251 offset:18432
  v_mul_f32 v57, v12, v57
  v_mfma_f32_16x16x32_bf16 v[100:103], v[28:31], v[152:155], 0
  v_mul_f32 v58, v12, v58
  v_mul_f32 v59, v12, v59
  v_mfma_f32_16x16x32_bf16 v[108:111], v[28:31], v[184:187], 0
  v_mul_f32 v60, v12, v60
  v_mfma_f32_16x16x32_bf16 v[116:119], v[28:31], v[216:219], 0
  s_waitcnt lgkmcnt(5)
  v_mul_f32 v61, v12, v61
  v_mfma_f32_16x16x32_bf16 v[88:91], v[32:35], v[124:127], v[88:91]
  ds_read_b128 v[24:27], v248 offset:16640
  v_mul_f32 v62, v12, v62
  v_mfma_f32_16x16x32_bf16 v[96:99], v[32:35], v[156:159], v[96:99]
  v_mul_f32 v63, v12, v63
  v_cvt_pk_bf16_f32 v56, v56, v57
  v_mfma_f32_16x16x32_bf16 v[104:107], v[32:35], v[188:191], v[104:107]
  s_add_u32 m0, s29, 115712
  s_add_u32 s27, s28, 1851392
  buffer_load_dwordx4 v15, s[60:63], s27 offen lds
  v_mfma_f32_16x16x32_bf16 v[112:115], v[32:35], v[220:223], v[112:115]
  s_waitcnt lgkmcnt(5)
  v_cvt_pk_bf16_f32 v57, v58, v59
  v_mfma_f32_16x16x32_bf16 v[92:95], v[36:39], v[124:127], v[92:95]
  ds_read_b128 v[28:31], v248 offset:18688
  v_cvt_pk_bf16_f32 v58, v60, v61
  v_mfma_f32_16x16x32_bf16 v[100:103], v[36:39], v[156:159], v[100:103]
  v_cvt_pk_bf16_f32 v59, v62, v63
  v_accvgpr_write_b32 a0, v56
  v_mfma_f32_16x16x32_bf16 v[108:111], v[36:39], v[188:191], v[108:111]
  v_accvgpr_write_b32 a1, v57
  v_mfma_f32_16x16x32_bf16 v[116:119], v[36:39], v[220:223], v[116:119]
  s_waitcnt lgkmcnt(5)
  v_accvgpr_write_b32 a2, v58
  v_mfma_f32_16x16x32_bf16 v[88:91], v[40:43], v[128:131], v[88:91]
  ds_read_b128 v[32:35], v249 offset:16640
  v_accvgpr_write_b32 a3, v59
  v_mfma_f32_16x16x32_bf16 v[96:99], v[40:43], v[160:163], v[96:99]
  v_mul_f32 v64, v12, v64
  v_mul_f32 v65, v12, v65
  v_mfma_f32_16x16x32_bf16 v[104:107], v[40:43], v[192:195], v[104:107]
  s_add_u32 m0, s29, 116736
  s_add_u32 s27, s28, 1867776
  buffer_load_dwordx4 v14, s[60:63], s27 offen lds
  v_mfma_f32_16x16x32_bf16 v[112:115], v[40:43], v[224:227], v[112:115]
  s_waitcnt lgkmcnt(5)
  v_mul_f32 v66, v12, v66
  v_mfma_f32_16x16x32_bf16 v[92:95], v[44:47], v[128:131], v[92:95]
  ds_read_b128 v[36:39], v249 offset:18688
  v_mul_f32 v67, v12, v67
  v_mfma_f32_16x16x32_bf16 v[100:103], v[44:47], v[160:163], v[100:103]
  v_mul_f32 v68, v12, v68
  v_mul_f32 v69, v12, v69
  v_mfma_f32_16x16x32_bf16 v[108:111], v[44:47], v[192:195], v[108:111]
  v_mul_f32 v70, v12, v70
  v_mfma_f32_16x16x32_bf16 v[116:119], v[44:47], v[224:227], v[116:119]
  s_waitcnt lgkmcnt(5)
  v_mul_f32 v71, v12, v71
  v_mfma_f32_16x16x32_bf16 v[88:91], v[48:51], v[132:135], v[88:91]
  ds_read_b128 v[40:43], v250 offset:16640
  v_cvt_pk_bf16_f32 v64, v64, v65
  v_mfma_f32_16x16x32_bf16 v[96:99], v[48:51], v[164:167], v[96:99]
  v_cvt_pk_bf16_f32 v65, v66, v67
  v_cvt_pk_bf16_f32 v66, v68, v69
  v_mfma_f32_16x16x32_bf16 v[104:107], v[48:51], v[196:199], v[104:107]
  s_add_u32 m0, s29, 117760
  s_add_u32 s27, s28, 1884160
  buffer_load_dwordx4 v15, s[60:63], s27 offen lds
  v_mfma_f32_16x16x32_bf16 v[112:115], v[48:51], v[228:231], v[112:115]
  s_waitcnt lgkmcnt(5)
  v_cvt_pk_bf16_f32 v67, v70, v71
  v_mfma_f32_16x16x32_bf16 v[92:95], v[52:55], v[132:135], v[92:95]
  ds_read_b128 v[44:47], v250 offset:18688
  v_accvgpr_write_b32 a56, v64
  v_mfma_f32_16x16x32_bf16 v[100:103], v[52:55], v[164:167], v[100:103]
  v_accvgpr_write_b32 a57, v65
  v_accvgpr_write_b32 a58, v66
  v_mfma_f32_16x16x32_bf16 v[108:111], v[52:55], v[196:199], v[108:111]
  v_accvgpr_write_b32 a59, v67
  v_mfma_f32_16x16x32_bf16 v[116:119], v[52:55], v[228:231], v[116:119]
  s_waitcnt lgkmcnt(5)
  v_mul_f32 v72, v12, v72
  v_mfma_f32_16x16x32_bf16 v[88:91], v[24:27], v[136:139], v[88:91]
  ds_read_b128 v[48:51], v251 offset:16640
  v_mul_f32 v73, v12, v73
  v_mfma_f32_16x16x32_bf16 v[96:99], v[24:27], v[168:171], v[96:99]
  v_mul_f32 v74, v12, v74
  v_mul_f32 v75, v12, v75
  v_mfma_f32_16x16x32_bf16 v[104:107], v[24:27], v[200:203], v[104:107]
  v_mul_f32 v76, v12, v76
  v_mfma_f32_16x16x32_bf16 v[112:115], v[24:27], v[232:235], v[112:115]
  s_waitcnt lgkmcnt(5)
  v_mul_f32 v77, v12, v77
  v_mfma_f32_16x16x32_bf16 v[92:95], v[28:31], v[136:139], v[92:95]
  ds_read_b128 v[52:55], v251 offset:18688
  v_mul_f32 v78, v12, v78
  v_mfma_f32_16x16x32_bf16 v[100:103], v[28:31], v[168:171], v[100:103]
  v_mul_f32 v79, v12, v79
  v_cvt_pk_bf16_f32 v72, v72, v73
  v_mfma_f32_16x16x32_bf16 v[108:111], v[28:31], v[200:203], v[108:111]
  v_cvt_pk_bf16_f32 v73, v74, v75
  v_mfma_f32_16x16x32_bf16 v[116:119], v[28:31], v[232:235], v[116:119]
  s_waitcnt lgkmcnt(5)
  v_cvt_pk_bf16_f32 v74, v76, v77
  v_mfma_f32_16x16x32_bf16 v[88:91], v[32:35], v[140:143], v[88:91]
  s_waitcnt vmcnt(20)
  s_barrier
  ds_read_b128 v[24:27], v248 offset:32768
  v_cvt_pk_bf16_f32 v75, v78, v79
  v_mfma_f32_16x16x32_bf16 v[96:99], v[32:35], v[172:175], v[96:99]
  v_accvgpr_write_b32 a112, v72
  v_accvgpr_write_b32 a113, v73
  v_mfma_f32_16x16x32_bf16 v[104:107], v[32:35], v[204:207], v[104:107]
  v_accvgpr_write_b32 a114, v74
  v_mfma_f32_16x16x32_bf16 v[112:115], v[32:35], v[236:239], v[112:115]
  s_waitcnt lgkmcnt(5)
  v_accvgpr_write_b32 a115, v75
  v_mfma_f32_16x16x32_bf16 v[92:95], v[36:39], v[140:143], v[92:95]
  ds_read_b128 v[28:31], v248 offset:34816
  v_mul_f32 v80, v12, v80
  v_mfma_f32_16x16x32_bf16 v[100:103], v[36:39], v[172:175], v[100:103]
  v_mul_f32 v81, v12, v81
  v_mul_f32 v82, v12, v82
  v_mfma_f32_16x16x32_bf16 v[108:111], v[36:39], v[204:207], v[108:111]
  v_mul_f32 v83, v12, v83
  v_mfma_f32_16x16x32_bf16 v[116:119], v[36:39], v[236:239], v[116:119]
  s_waitcnt lgkmcnt(5)
  v_mul_f32 v84, v12, v84
  v_mfma_f32_16x16x32_bf16 v[88:91], v[40:43], v[144:147], v[88:91]
  ds_read_b128 v[32:35], v249 offset:32768
  v_mul_f32 v85, v12, v85
  v_mfma_f32_16x16x32_bf16 v[96:99], v[40:43], v[176:179], v[96:99]
  v_mul_f32 v86, v12, v86
  v_mul_f32 v87, v12, v87
  v_mfma_f32_16x16x32_bf16 v[104:107], v[40:43], v[208:211], v[104:107]
  v_cvt_pk_bf16_f32 v80, v80, v81
  v_mfma_f32_16x16x32_bf16 v[112:115], v[40:43], v[240:243], v[112:115]
  s_waitcnt lgkmcnt(5)
  v_cvt_pk_bf16_f32 v81, v82, v83
  v_mfma_f32_16x16x32_bf16 v[92:95], v[44:47], v[144:147], v[92:95]
  ds_read_b128 v[36:39], v249 offset:34816
  v_cvt_pk_bf16_f32 v82, v84, v85
  v_mfma_f32_16x16x32_bf16 v[100:103], v[44:47], v[176:179], v[100:103]
  v_cvt_pk_bf16_f32 v83, v86, v87
  v_accvgpr_write_b32 a168, v80
  v_mfma_f32_16x16x32_bf16 v[108:111], v[44:47], v[208:211], v[108:111]
  v_accvgpr_write_b32 a169, v81
  v_mfma_f32_16x16x32_bf16 v[116:119], v[44:47], v[240:243], v[116:119]
  s_waitcnt lgkmcnt(5)
  v_accvgpr_write_b32 a170, v82
  v_mfma_f32_16x16x32_bf16 v[88:91], v[48:51], v[148:151], v[88:91]
  ds_read_b128 v[40:43], v250 offset:32768
  v_accvgpr_write_b32 a171, v83
  v_mfma_f32_16x16x32_bf16 v[96:99], v[48:51], v[180:183], v[96:99]
  v_mfma_f32_16x16x32_bf16 v[104:107], v[48:51], v[212:215], v[104:107]
  v_mfma_f32_16x16x32_bf16 v[112:115], v[48:51], v[244:247], v[112:115]
  s_waitcnt lgkmcnt(5)
  v_mfma_f32_16x16x32_bf16 v[92:95], v[52:55], v[148:151], v[92:95]
  ds_read_b128 v[44:47], v250 offset:34816
  v_mfma_f32_16x16x32_bf16 v[100:103], v[52:55], v[180:183], v[100:103]
  v_mfma_f32_16x16x32_bf16 v[108:111], v[52:55], v[212:215], v[108:111]
  v_mfma_f32_16x16x32_bf16 v[116:119], v[52:55], v[244:247], v[116:119]
  s_waitcnt lgkmcnt(5)
  v_mfma_f32_16x16x32_bf16 v[56:59], v[24:27], v[120:123], 0
  ds_read_b128 v[48:51], v251 offset:32768
  v_mfma_f32_16x16x32_bf16 v[64:67], v[24:27], v[152:155], 0
  v_mfma_f32_16x16x32_bf16 v[72:75], v[24:27], v[184:187], 0
  s_add_u32 m0, s29, 131072
  s_add_u32 s27, s28, 2097152
  buffer_load_dwordx4 v14, s[60:63], s27 offen lds
  v_mfma_f32_16x16x32_bf16 v[80:83], v[24:27], v[216:219], 0
  s_waitcnt lgkmcnt(5)
  v_mul_f32 v88, v12, v88
  v_mfma_f32_16x16x32_bf16 v[60:63], v[28:31], v[120:123], 0
  ds_read_b128 v[52:55], v251 offset:34816
  v_mul_f32 v89, v12, v89
  v_mfma_f32_16x16x32_bf16 v[68:71], v[28:31], v[152:155], 0
  v_mul_f32 v90, v12, v90
  v_mul_f32 v91, v12, v91
  v_mfma_f32_16x16x32_bf16 v[76:79], v[28:31], v[184:187], 0
  v_mul_f32 v92, v12, v92
  v_mfma_f32_16x16x32_bf16 v[84:87], v[28:31], v[216:219], 0
  s_waitcnt lgkmcnt(5)
  v_mul_f32 v93, v12, v93
  v_mfma_f32_16x16x32_bf16 v[56:59], v[32:35], v[124:127], v[56:59]
  ds_read_b128 v[24:27], v248 offset:33024
  v_mul_f32 v94, v12, v94
  v_mfma_f32_16x16x32_bf16 v[64:67], v[32:35], v[156:159], v[64:67]
  v_mul_f32 v95, v12, v95
  v_cvt_pk_bf16_f32 v88, v88, v89
  v_mfma_f32_16x16x32_bf16 v[72:75], v[32:35], v[188:191], v[72:75]
  s_add_u32 m0, s29, 132096
  s_add_u32 s27, s28, 2113536
  buffer_load_dwordx4 v15, s[60:63], s27 offen lds
  v_mfma_f32_16x16x32_bf16 v[80:83], v[32:35], v[220:223], v[80:83]
  s_waitcnt lgkmcnt(5)
  v_cvt_pk_bf16_f32 v89, v90, v91
  v_mfma_f32_16x16x32_bf16 v[60:63], v[36:39], v[124:127], v[60:63]
  ds_read_b128 v[28:31], v248 offset:35072
  v_cvt_pk_bf16_f32 v90, v92, v93
  v_mfma_f32_16x16x32_bf16 v[68:71], v[36:39], v[156:159], v[68:71]
  v_cvt_pk_bf16_f32 v91, v94, v95
  v_accvgpr_write_b32 a4, v88
  v_mfma_f32_16x16x32_bf16 v[76:79], v[36:39], v[188:191], v[76:79]
  v_accvgpr_write_b32 a5, v89
  v_mfma_f32_16x16x32_bf16 v[84:87], v[36:39], v[220:223], v[84:87]
  s_waitcnt lgkmcnt(5)
  v_accvgpr_write_b32 a6, v90
  v_mfma_f32_16x16x32_bf16 v[56:59], v[40:43], v[128:131], v[56:59]
  ds_read_b128 v[32:35], v249 offset:33024
  v_accvgpr_write_b32 a7, v91
  v_mfma_f32_16x16x32_bf16 v[64:67], v[40:43], v[160:163], v[64:67]
  v_mul_f32 v96, v12, v96
  v_mul_f32 v97, v12, v97
  v_mfma_f32_16x16x32_bf16 v[72:75], v[40:43], v[192:195], v[72:75]
  s_add_u32 m0, s29, 133120
  s_add_u32 s27, s28, 2129920
  buffer_load_dwordx4 v14, s[60:63], s27 offen lds
  v_mfma_f32_16x16x32_bf16 v[80:83], v[40:43], v[224:227], v[80:83]
  s_waitcnt lgkmcnt(5)
  v_mul_f32 v98, v12, v98
  v_mfma_f32_16x16x32_bf16 v[60:63], v[44:47], v[128:131], v[60:63]
  ds_read_b128 v[36:39], v249 offset:35072
  v_mul_f32 v99, v12, v99
  v_mfma_f32_16x16x32_bf16 v[68:71], v[44:47], v[160:163], v[68:71]
  v_mul_f32 v100, v12, v100
  v_mul_f32 v101, v12, v101
  v_mfma_f32_16x16x32_bf16 v[76:79], v[44:47], v[192:195], v[76:79]
  v_mul_f32 v102, v12, v102
  v_mfma_f32_16x16x32_bf16 v[84:87], v[44:47], v[224:227], v[84:87]
  s_waitcnt lgkmcnt(5)
  v_mul_f32 v103, v12, v103
  v_mfma_f32_16x16x32_bf16 v[56:59], v[48:51], v[132:135], v[56:59]
  ds_read_b128 v[40:43], v250 offset:33024
  v_cvt_pk_bf16_f32 v96, v96, v97
  v_mfma_f32_16x16x32_bf16 v[64:67], v[48:51], v[164:167], v[64:67]
  v_cvt_pk_bf16_f32 v97, v98, v99
  v_cvt_pk_bf16_f32 v98, v100, v101
  v_mfma_f32_16x16x32_bf16 v[72:75], v[48:51], v[196:199], v[72:75]
  s_add_u32 m0, s29, 134144
  s_add_u32 s27, s28, 2146304
  buffer_load_dwordx4 v15, s[60:63], s27 offen lds
  v_mfma_f32_16x16x32_bf16 v[80:83], v[48:51], v[228:231], v[80:83]
  s_waitcnt lgkmcnt(5)
  v_cvt_pk_bf16_f32 v99, v102, v103
  v_mfma_f32_16x16x32_bf16 v[60:63], v[52:55], v[132:135], v[60:63]
  ds_read_b128 v[44:47], v250 offset:35072
  v_accvgpr_write_b32 a60, v96
  v_mfma_f32_16x16x32_bf16 v[68:71], v[52:55], v[164:167], v[68:71]
  v_accvgpr_write_b32 a61, v97
  v_accvgpr_write_b32 a62, v98
  v_mfma_f32_16x16x32_bf16 v[76:79], v[52:55], v[196:199], v[76:79]
  v_accvgpr_write_b32 a63, v99
  v_mfma_f32_16x16x32_bf16 v[84:87], v[52:55], v[228:231], v[84:87]
  s_waitcnt lgkmcnt(5)
  v_mul_f32 v104, v12, v104
  v_mfma_f32_16x16x32_bf16 v[56:59], v[24:27], v[136:139], v[56:59]
  ds_read_b128 v[48:51], v251 offset:33024
  v_mul_f32 v105, v12, v105
  v_mfma_f32_16x16x32_bf16 v[64:67], v[24:27], v[168:171], v[64:67]
  v_mul_f32 v106, v12, v106
  v_mul_f32 v107, v12, v107
  v_mfma_f32_16x16x32_bf16 v[72:75], v[24:27], v[200:203], v[72:75]
  v_mul_f32 v108, v12, v108
  v_mfma_f32_16x16x32_bf16 v[80:83], v[24:27], v[232:235], v[80:83]
  s_waitcnt lgkmcnt(5)
  v_mul_f32 v109, v12, v109
  v_mfma_f32_16x16x32_bf16 v[60:63], v[28:31], v[136:139], v[60:63]
  ds_read_b128 v[52:55], v251 offset:35072
  v_mul_f32 v110, v12, v110
  v_mfma_f32_16x16x32_bf16 v[68:71], v[28:31], v[168:171], v[68:71]
  v_mul_f32 v111, v12, v111
  v_cvt_pk_bf16_f32 v104, v104, v105
  v_mfma_f32_16x16x32_bf16 v[76:79], v[28:31], v[200:203], v[76:79]
  v_cvt_pk_bf16_f32 v105, v106, v107
  v_mfma_f32_16x16x32_bf16 v[84:87], v[28:31], v[232:235], v[84:87]
  s_waitcnt lgkmcnt(5)
  v_cvt_pk_bf16_f32 v106, v108, v109
  v_mfma_f32_16x16x32_bf16 v[56:59], v[32:35], v[140:143], v[56:59]
  s_waitcnt vmcnt(20)
  s_barrier
  ds_read_b128 v[24:27], v248 offset:49152
  v_cvt_pk_bf16_f32 v107, v110, v111
  v_mfma_f32_16x16x32_bf16 v[64:67], v[32:35], v[172:175], v[64:67]
  v_accvgpr_write_b32 a116, v104
  v_accvgpr_write_b32 a117, v105
  v_mfma_f32_16x16x32_bf16 v[72:75], v[32:35], v[204:207], v[72:75]
  v_accvgpr_write_b32 a118, v106
  v_mfma_f32_16x16x32_bf16 v[80:83], v[32:35], v[236:239], v[80:83]
  s_waitcnt lgkmcnt(5)
  v_accvgpr_write_b32 a119, v107
  v_mfma_f32_16x16x32_bf16 v[60:63], v[36:39], v[140:143], v[60:63]
  ds_read_b128 v[28:31], v248 offset:51200
  v_mul_f32 v112, v12, v112
  v_mfma_f32_16x16x32_bf16 v[68:71], v[36:39], v[172:175], v[68:71]
  v_mul_f32 v113, v12, v113
  v_mul_f32 v114, v12, v114
  v_mfma_f32_16x16x32_bf16 v[76:79], v[36:39], v[204:207], v[76:79]
  v_mul_f32 v115, v12, v115
  v_mfma_f32_16x16x32_bf16 v[84:87], v[36:39], v[236:239], v[84:87]
  s_waitcnt lgkmcnt(5)
  v_mul_f32 v116, v12, v116
  v_mfma_f32_16x16x32_bf16 v[56:59], v[40:43], v[144:147], v[56:59]
  ds_read_b128 v[32:35], v249 offset:49152
  v_mul_f32 v117, v12, v117
  v_mfma_f32_16x16x32_bf16 v[64:67], v[40:43], v[176:179], v[64:67]
  v_mul_f32 v118, v12, v118
  v_mul_f32 v119, v12, v119
  v_mfma_f32_16x16x32_bf16 v[72:75], v[40:43], v[208:211], v[72:75]
  v_cvt_pk_bf16_f32 v112, v112, v113
  v_mfma_f32_16x16x32_bf16 v[80:83], v[40:43], v[240:243], v[80:83]
  s_waitcnt lgkmcnt(5)
  v_cvt_pk_bf16_f32 v113, v114, v115
  v_mfma_f32_16x16x32_bf16 v[60:63], v[44:47], v[144:147], v[60:63]
  ds_read_b128 v[36:39], v249 offset:51200
  v_cvt_pk_bf16_f32 v114, v116, v117
  v_mfma_f32_16x16x32_bf16 v[68:71], v[44:47], v[176:179], v[68:71]
  v_cvt_pk_bf16_f32 v115, v118, v119
  v_accvgpr_write_b32 a172, v112
  v_mfma_f32_16x16x32_bf16 v[76:79], v[44:47], v[208:211], v[76:79]
  v_accvgpr_write_b32 a173, v113
  v_mfma_f32_16x16x32_bf16 v[84:87], v[44:47], v[240:243], v[84:87]
  s_waitcnt lgkmcnt(5)
  v_accvgpr_write_b32 a174, v114
  v_mfma_f32_16x16x32_bf16 v[56:59], v[48:51], v[148:151], v[56:59]
  ds_read_b128 v[40:43], v250 offset:49152
  v_accvgpr_write_b32 a175, v115
  v_mfma_f32_16x16x32_bf16 v[64:67], v[48:51], v[180:183], v[64:67]
  v_mfma_f32_16x16x32_bf16 v[72:75], v[48:51], v[212:215], v[72:75]
  v_mfma_f32_16x16x32_bf16 v[80:83], v[48:51], v[244:247], v[80:83]
  s_waitcnt lgkmcnt(5)
  v_mfma_f32_16x16x32_bf16 v[60:63], v[52:55], v[148:151], v[60:63]
  ds_read_b128 v[44:47], v250 offset:51200
  v_mfma_f32_16x16x32_bf16 v[68:71], v[52:55], v[180:183], v[68:71]
  v_mfma_f32_16x16x32_bf16 v[76:79], v[52:55], v[212:215], v[76:79]
  v_mfma_f32_16x16x32_bf16 v[84:87], v[52:55], v[244:247], v[84:87]
  s_waitcnt lgkmcnt(5)
  s_getpc_b64 s[98:99]
  s_add_u32 s98, s98, 4096
  s_addc_u32 s99, s99, 0
  global_load_dword v7, v6, s[98:99]
  v_mfma_f32_16x16x32_bf16 v[88:91], v[24:27], v[120:123], 0
  ds_read_b128 v[48:51], v251 offset:49152
  v_mfma_f32_16x16x32_bf16 v[96:99], v[24:27], v[152:155], 0
  v_mfma_f32_16x16x32_bf16 v[104:107], v[24:27], v[184:187], 0
  buffer_load_dword v13, off, s[12:15], 0 offset:128 sc1
  buffer_load_dword v9, off, s[12:15], 0 sc1
  s_add_u32 m0, s29, 147456
  s_add_u32 s27, s28, 2359296
  buffer_load_dwordx4 v14, s[60:63], s27 offen lds
  v_mfma_f32_16x16x32_bf16 v[112:115], v[24:27], v[216:219], 0
  s_waitcnt lgkmcnt(5)
  v_mul_f32 v56, v12, v56
  v_mfma_f32_16x16x32_bf16 v[92:95], v[28:31], v[120:123], 0
  ds_read_b128 v[52:55], v251 offset:51200
  v_mul_f32 v57, v12, v57
  v_mfma_f32_16x16x32_bf16 v[100:103], v[28:31], v[152:155], 0
  v_mul_f32 v58, v12, v58
  v_mul_f32 v59, v12, v59
  v_mfma_f32_16x16x32_bf16 v[108:111], v[28:31], v[184:187], 0
  v_mul_f32 v60, v12, v60
  v_mfma_f32_16x16x32_bf16 v[116:119], v[28:31], v[216:219], 0
  s_waitcnt lgkmcnt(5)
  v_mul_f32 v61, v12, v61
  v_mfma_f32_16x16x32_bf16 v[88:91], v[32:35], v[124:127], v[88:91]
  ds_read_b128 v[24:27], v248 offset:49408
  v_mul_f32 v62, v12, v62
  v_mfma_f32_16x16x32_bf16 v[96:99], v[32:35], v[156:159], v[96:99]
  v_mul_f32 v63, v12, v63
  v_cvt_pk_bf16_f32 v56, v56, v57
  v_mfma_f32_16x16x32_bf16 v[104:107], v[32:35], v[188:191], v[104:107]
  s_add_u32 m0, s29, 148480
  s_add_u32 s27, s28, 2375680
  buffer_load_dwordx4 v15, s[60:63], s27 offen lds
  v_mfma_f32_16x16x32_bf16 v[112:115], v[32:35], v[220:223], v[112:115]
  s_waitcnt lgkmcnt(5)
  v_cvt_pk_bf16_f32 v57, v58, v59
  v_mfma_f32_16x16x32_bf16 v[92:95], v[36:39], v[124:127], v[92:95]
  ds_read_b128 v[28:31], v248 offset:51456
  v_cvt_pk_bf16_f32 v58, v60, v61
  v_mfma_f32_16x16x32_bf16 v[100:103], v[36:39], v[156:159], v[100:103]
  v_cvt_pk_bf16_f32 v59, v62, v63
  v_accvgpr_write_b32 a8, v56
  v_mfma_f32_16x16x32_bf16 v[108:111], v[36:39], v[188:191], v[108:111]
  v_accvgpr_write_b32 a9, v57
  v_mfma_f32_16x16x32_bf16 v[116:119], v[36:39], v[220:223], v[116:119]
  s_waitcnt lgkmcnt(5)
  v_accvgpr_write_b32 a10, v58
  v_mfma_f32_16x16x32_bf16 v[88:91], v[40:43], v[128:131], v[88:91]
  ds_read_b128 v[32:35], v249 offset:49408
  v_accvgpr_write_b32 a11, v59
  v_mfma_f32_16x16x32_bf16 v[96:99], v[40:43], v[160:163], v[96:99]
  v_mul_f32 v64, v12, v64
  v_mul_f32 v65, v12, v65
  v_mfma_f32_16x16x32_bf16 v[104:107], v[40:43], v[192:195], v[104:107]
  s_add_u32 m0, s29, 149504
  s_add_u32 s27, s28, 2392064
  buffer_load_dwordx4 v14, s[60:63], s27 offen lds
  v_mfma_f32_16x16x32_bf16 v[112:115], v[40:43], v[224:227], v[112:115]
  s_waitcnt lgkmcnt(5)
  v_mul_f32 v66, v12, v66
  v_mfma_f32_16x16x32_bf16 v[92:95], v[44:47], v[128:131], v[92:95]
  ds_read_b128 v[36:39], v249 offset:51456
  v_mul_f32 v67, v12, v67
  v_mfma_f32_16x16x32_bf16 v[100:103], v[44:47], v[160:163], v[100:103]
  v_mul_f32 v68, v12, v68
  v_mul_f32 v69, v12, v69
  v_mfma_f32_16x16x32_bf16 v[108:111], v[44:47], v[192:195], v[108:111]
  v_mul_f32 v70, v12, v70
  v_mfma_f32_16x16x32_bf16 v[116:119], v[44:47], v[224:227], v[116:119]
  s_waitcnt lgkmcnt(5)
  v_mul_f32 v71, v12, v71
  v_mfma_f32_16x16x32_bf16 v[88:91], v[48:51], v[132:135], v[88:91]
  ds_read_b128 v[40:43], v250 offset:49408
  v_cvt_pk_bf16_f32 v64, v64, v65
  v_mfma_f32_16x16x32_bf16 v[96:99], v[48:51], v[164:167], v[96:99]
  v_cvt_pk_bf16_f32 v65, v66, v67
  v_cvt_pk_bf16_f32 v66, v68, v69
  v_mfma_f32_16x16x32_bf16 v[104:107], v[48:51], v[196:199], v[104:107]
  s_add_u32 m0, s29, 150528
  s_add_u32 s27, s28, 2408448
  buffer_load_dwordx4 v15, s[60:63], s27 offen lds
  v_mfma_f32_16x16x32_bf16 v[112:115], v[48:51], v[228:231], v[112:115]
  s_waitcnt lgkmcnt(5)
  v_cvt_pk_bf16_f32 v67, v70, v71
  v_mfma_f32_16x16x32_bf16 v[92:95], v[52:55], v[132:135], v[92:95]
  ds_read_b128 v[44:47], v250 offset:51456
  v_accvgpr_write_b32 a64, v64
  v_mfma_f32_16x16x32_bf16 v[100:103], v[52:55], v[164:167], v[100:103]
  v_accvgpr_write_b32 a65, v65
  v_accvgpr_write_b32 a66, v66
  v_mfma_f32_16x16x32_bf16 v[108:111], v[52:55], v[196:199], v[108:111]
  v_accvgpr_write_b32 a67, v67
  v_mfma_f32_16x16x32_bf16 v[116:119], v[52:55], v[228:231], v[116:119]
  s_waitcnt lgkmcnt(5)
  v_mul_f32 v72, v12, v72
  v_mfma_f32_16x16x32_bf16 v[88:91], v[24:27], v[136:139], v[88:91]
  ds_read_b128 v[48:51], v251 offset:49408
  v_mul_f32 v73, v12, v73
  v_mfma_f32_16x16x32_bf16 v[96:99], v[24:27], v[168:171], v[96:99]
  v_mul_f32 v74, v12, v74
  v_mul_f32 v75, v12, v75
  v_mfma_f32_16x16x32_bf16 v[104:107], v[24:27], v[200:203], v[104:107]
  v_mul_f32 v76, v12, v76
  v_mfma_f32_16x16x32_bf16 v[112:115], v[24:27], v[232:235], v[112:115]
  s_waitcnt lgkmcnt(5)
  v_mul_f32 v77, v12, v77
  v_mfma_f32_16x16x32_bf16 v[92:95], v[28:31], v[136:139], v[92:95]
  ds_read_b128 v[52:55], v251 offset:51456
  v_mul_f32 v78, v12, v78
  v_mfma_f32_16x16x32_bf16 v[100:103], v[28:31], v[168:171], v[100:103]
  v_mul_f32 v79, v12, v79
  v_cvt_pk_bf16_f32 v72, v72, v73
  v_mfma_f32_16x16x32_bf16 v[108:111], v[28:31], v[200:203], v[108:111]
  v_cvt_pk_bf16_f32 v73, v74, v75
  v_mfma_f32_16x16x32_bf16 v[116:119], v[28:31], v[232:235], v[116:119]
  s_waitcnt lgkmcnt(5)
  v_cvt_pk_bf16_f32 v74, v76, v77
  v_mfma_f32_16x16x32_bf16 v[88:91], v[32:35], v[140:143], v[88:91]
  s_waitcnt vmcnt(20)
  s_barrier
  ds_read_b128 v[24:27], v252 offset:0
  v_cvt_pk_bf16_f32 v75, v78, v79
  v_mfma_f32_16x16x32_bf16 v[96:99], v[32:35], v[172:175], v[96:99]
  v_accvgpr_write_b32 a120, v72
  v_accvgpr_write_b32 a121, v73
  v_mfma_f32_16x16x32_bf16 v[104:107], v[32:35], v[204:207], v[104:107]
  v_accvgpr_write_b32 a122, v74
  v_mfma_f32_16x16x32_bf16 v[112:115], v[32:35], v[236:239], v[112:115]
  s_waitcnt lgkmcnt(5)
  v_accvgpr_write_b32 a123, v75
  v_mfma_f32_16x16x32_bf16 v[92:95], v[36:39], v[140:143], v[92:95]
  ds_read_b128 v[28:31], v252 offset:2048
  v_mul_f32 v80, v12, v80
  v_mfma_f32_16x16x32_bf16 v[100:103], v[36:39], v[172:175], v[100:103]
  v_mul_f32 v81, v12, v81
  v_mul_f32 v82, v12, v82
  v_mfma_f32_16x16x32_bf16 v[108:111], v[36:39], v[204:207], v[108:111]
  v_mul_f32 v83, v12, v83
  v_mfma_f32_16x16x32_bf16 v[116:119], v[36:39], v[236:239], v[116:119]
  s_waitcnt lgkmcnt(5)
  v_mul_f32 v84, v12, v84
  v_mfma_f32_16x16x32_bf16 v[88:91], v[40:43], v[144:147], v[88:91]
  ds_read_b128 v[32:35], v253 offset:0
  v_mul_f32 v85, v12, v85
  v_mfma_f32_16x16x32_bf16 v[96:99], v[40:43], v[176:179], v[96:99]
  v_mul_f32 v86, v12, v86
  v_mul_f32 v87, v12, v87
  v_mfma_f32_16x16x32_bf16 v[104:107], v[40:43], v[208:211], v[104:107]
  v_cvt_pk_bf16_f32 v80, v80, v81
  v_mfma_f32_16x16x32_bf16 v[112:115], v[40:43], v[240:243], v[112:115]
  s_waitcnt lgkmcnt(5)
  v_cvt_pk_bf16_f32 v81, v82, v83
  v_mfma_f32_16x16x32_bf16 v[92:95], v[44:47], v[144:147], v[92:95]
  ds_read_b128 v[36:39], v253 offset:2048
  v_cvt_pk_bf16_f32 v82, v84, v85
  v_mfma_f32_16x16x32_bf16 v[100:103], v[44:47], v[176:179], v[100:103]
  v_cvt_pk_bf16_f32 v83, v86, v87
  v_accvgpr_write_b32 a176, v80
  v_mfma_f32_16x16x32_bf16 v[108:111], v[44:47], v[208:211], v[108:111]
  v_accvgpr_write_b32 a177, v81
  v_mfma_f32_16x16x32_bf16 v[116:119], v[44:47], v[240:243], v[116:119]
  s_waitcnt lgkmcnt(5)
  v_accvgpr_write_b32 a178, v82
  v_mfma_f32_16x16x32_bf16 v[88:91], v[48:51], v[148:151], v[88:91]
  ds_read_b128 v[40:43], v254 offset:0
  v_accvgpr_write_b32 a179, v83
  v_mfma_f32_16x16x32_bf16 v[96:99], v[48:51], v[180:183], v[96:99]
  v_mfma_f32_16x16x32_bf16 v[104:107], v[48:51], v[212:215], v[104:107]
  v_mfma_f32_16x16x32_bf16 v[112:115], v[48:51], v[244:247], v[112:115]
  s_waitcnt lgkmcnt(5)
  v_mfma_f32_16x16x32_bf16 v[92:95], v[52:55], v[148:151], v[92:95]
  ds_read_b128 v[44:47], v254 offset:2048
  v_mfma_f32_16x16x32_bf16 v[100:103], v[52:55], v[180:183], v[100:103]
  v_mfma_f32_16x16x32_bf16 v[108:111], v[52:55], v[212:215], v[108:111]
  v_mfma_f32_16x16x32_bf16 v[116:119], v[52:55], v[244:247], v[116:119]
  s_waitcnt lgkmcnt(5)
  v_mfma_f32_16x16x32_bf16 v[56:59], v[24:27], v[120:123], 0
  ds_read_b128 v[48:51], v255 offset:0
  v_mfma_f32_16x16x32_bf16 v[64:67], v[24:27], v[152:155], 0
  v_mfma_f32_16x16x32_bf16 v[72:75], v[24:27], v[184:187], 0
  s_add_u32 m0, s29, 0
  s_add_u32 s27, s28, 2621440
  buffer_load_dwordx4 v14, s[60:63], s27 offen lds
  v_mfma_f32_16x16x32_bf16 v[80:83], v[24:27], v[216:219], 0
  s_waitcnt lgkmcnt(5)
  v_mul_f32 v88, v12, v88
  v_mfma_f32_16x16x32_bf16 v[60:63], v[28:31], v[120:123], 0
  ds_read_b128 v[52:55], v255 offset:2048
  v_mul_f32 v89, v12, v89
  v_mfma_f32_16x16x32_bf16 v[68:71], v[28:31], v[152:155], 0
  v_mul_f32 v90, v12, v90
  v_mul_f32 v91, v12, v91
  v_mfma_f32_16x16x32_bf16 v[76:79], v[28:31], v[184:187], 0
  v_mul_f32 v92, v12, v92
  v_mfma_f32_16x16x32_bf16 v[84:87], v[28:31], v[216:219], 0
  s_waitcnt lgkmcnt(5)
  v_mul_f32 v93, v12, v93
  v_mfma_f32_16x16x32_bf16 v[56:59], v[32:35], v[124:127], v[56:59]
  ds_read_b128 v[24:27], v252 offset:256
  v_mul_f32 v94, v12, v94
  v_mfma_f32_16x16x32_bf16 v[64:67], v[32:35], v[156:159], v[64:67]
  v_mul_f32 v95, v12, v95
  v_cvt_pk_bf16_f32 v88, v88, v89
  v_mfma_f32_16x16x32_bf16 v[72:75], v[32:35], v[188:191], v[72:75]
  s_add_u32 m0, s29, 1024
  s_add_u32 s27, s28, 2637824
  buffer_load_dwordx4 v15, s[60:63], s27 offen lds
  v_mfma_f32_16x16x32_bf16 v[80:83], v[32:35], v[220:223], v[80:83]
  s_waitcnt lgkmcnt(5)
  v_cvt_pk_bf16_f32 v89, v90, v91
  v_mfma_f32_16x16x32_bf16 v[60:63], v[36:39], v[124:127], v[60:63]
  ds_read_b128 v[28:31], v252 offset:2304
  v_cvt_pk_bf16_f32 v90, v92, v93
  v_mfma_f32_16x16x32_bf16 v[68:71], v[36:39], v[156:159], v[68:71]
  v_cvt_pk_bf16_f32 v91, v94, v95
  v_accvgpr_write_b32 a12, v88
  v_mfma_f32_16x16x32_bf16 v[76:79], v[36:39], v[188:191], v[76:79]
  v_accvgpr_write_b32 a13, v89
  v_mfma_f32_16x16x32_bf16 v[84:87], v[36:39], v[220:223], v[84:87]
  s_waitcnt lgkmcnt(5)
  v_accvgpr_write_b32 a14, v90
  v_mfma_f32_16x16x32_bf16 v[56:59], v[40:43], v[128:131], v[56:59]
  ds_read_b128 v[32:35], v253 offset:256
  v_accvgpr_write_b32 a15, v91
  v_mfma_f32_16x16x32_bf16 v[64:67], v[40:43], v[160:163], v[64:67]
  v_mul_f32 v96, v12, v96
  v_mul_f32 v97, v12, v97
  v_mfma_f32_16x16x32_bf16 v[72:75], v[40:43], v[192:195], v[72:75]
  s_add_u32 m0, s29, 2048
  s_add_u32 s27, s28, 2654208
  buffer_load_dwordx4 v14, s[60:63], s27 offen lds
  v_mfma_f32_16x16x32_bf16 v[80:83], v[40:43], v[224:227], v[80:83]
  s_waitcnt lgkmcnt(5)
  v_mul_f32 v98, v12, v98
  v_mfma_f32_16x16x32_bf16 v[60:63], v[44:47], v[128:131], v[60:63]
  ds_read_b128 v[36:39], v253 offset:2304
  v_mul_f32 v99, v12, v99
  v_mfma_f32_16x16x32_bf16 v[68:71], v[44:47], v[160:163], v[68:71]
  v_mul_f32 v100, v12, v100
  v_mul_f32 v101, v12, v101
  v_mfma_f32_16x16x32_bf16 v[76:79], v[44:47], v[192:195], v[76:79]
  v_mul_f32 v102, v12, v102
  v_mfma_f32_16x16x32_bf16 v[84:87], v[44:47], v[224:227], v[84:87]
  s_waitcnt lgkmcnt(5)
  v_mul_f32 v103, v12, v103
  v_mfma_f32_16x16x32_bf16 v[56:59], v[48:51], v[132:135], v[56:59]
  ds_read_b128 v[40:43], v254 offset:256
  v_cvt_pk_bf16_f32 v96, v96, v97
  v_mfma_f32_16x16x32_bf16 v[64:67], v[48:51], v[164:167], v[64:67]
  v_cvt_pk_bf16_f32 v97, v98, v99
  v_cvt_pk_bf16_f32 v98, v100, v101
  v_mfma_f32_16x16x32_bf16 v[72:75], v[48:51], v[196:199], v[72:75]
  s_add_u32 m0, s29, 3072
  s_add_u32 s27, s28, 2670592
  buffer_load_dwordx4 v15, s[60:63], s27 offen lds
  v_mfma_f32_16x16x32_bf16 v[80:83], v[48:51], v[228:231], v[80:83]
  s_waitcnt lgkmcnt(5)
  v_cvt_pk_bf16_f32 v99, v102, v103
  v_mfma_f32_16x16x32_bf16 v[60:63], v[52:55], v[132:135], v[60:63]
  ds_read_b128 v[44:47], v254 offset:2304
  v_accvgpr_write_b32 a68, v96
  v_mfma_f32_16x16x32_bf16 v[68:71], v[52:55], v[164:167], v[68:71]
  v_accvgpr_write_b32 a69, v97
  v_accvgpr_write_b32 a70, v98
  v_mfma_f32_16x16x32_bf16 v[76:79], v[52:55], v[196:199], v[76:79]
  v_accvgpr_write_b32 a71, v99
  v_mfma_f32_16x16x32_bf16 v[84:87], v[52:55], v[228:231], v[84:87]
  s_waitcnt lgkmcnt(5)
  v_mul_f32 v104, v12, v104
  v_mfma_f32_16x16x32_bf16 v[56:59], v[24:27], v[136:139], v[56:59]
  ds_read_b128 v[48:51], v255 offset:256
  v_mul_f32 v105, v12, v105
  v_mfma_f32_16x16x32_bf16 v[64:67], v[24:27], v[168:171], v[64:67]
  v_mul_f32 v106, v12, v106
  v_mul_f32 v107, v12, v107
  v_mfma_f32_16x16x32_bf16 v[72:75], v[24:27], v[200:203], v[72:75]
  v_mul_f32 v108, v12, v108
  v_mfma_f32_16x16x32_bf16 v[80:83], v[24:27], v[232:235], v[80:83]
  s_waitcnt lgkmcnt(5)
  v_mul_f32 v109, v12, v109
  v_mfma_f32_16x16x32_bf16 v[60:63], v[28:31], v[136:139], v[60:63]
  ds_read_b128 v[52:55], v255 offset:2304
  v_mul_f32 v110, v12, v110
  v_mfma_f32_16x16x32_bf16 v[68:71], v[28:31], v[168:171], v[68:71]
  v_mul_f32 v111, v12, v111
  v_cvt_pk_bf16_f32 v104, v104, v105
  v_mfma_f32_16x16x32_bf16 v[76:79], v[28:31], v[200:203], v[76:79]
  v_cvt_pk_bf16_f32 v105, v106, v107
  v_mfma_f32_16x16x32_bf16 v[84:87], v[28:31], v[232:235], v[84:87]
  s_waitcnt lgkmcnt(5)
  v_cvt_pk_bf16_f32 v106, v108, v109
  v_mfma_f32_16x16x32_bf16 v[56:59], v[32:35], v[140:143], v[56:59]
  s_waitcnt vmcnt(20)
  s_barrier
  ds_read_b128 v[24:27], v252 offset:16384
  v_cvt_pk_bf16_f32 v107, v110, v111
  v_mfma_f32_16x16x32_bf16 v[64:67], v[32:35], v[172:175], v[64:67]
  v_accvgpr_write_b32 a124, v104
  v_accvgpr_write_b32 a125, v105
  v_mfma_f32_16x16x32_bf16 v[72:75], v[32:35], v[204:207], v[72:75]
  v_accvgpr_write_b32 a126, v106
  v_mfma_f32_16x16x32_bf16 v[80:83], v[32:35], v[236:239], v[80:83]
  s_waitcnt lgkmcnt(5)
  v_accvgpr_write_b32 a127, v107
  v_mfma_f32_16x16x32_bf16 v[60:63], v[36:39], v[140:143], v[60:63]
  ds_read_b128 v[28:31], v252 offset:18432
  v_mul_f32 v112, v12, v112
  v_mfma_f32_16x16x32_bf16 v[68:71], v[36:39], v[172:175], v[68:71]
  v_mul_f32 v113, v12, v113
  v_mul_f32 v114, v12, v114
  v_mfma_f32_16x16x32_bf16 v[76:79], v[36:39], v[204:207], v[76:79]
  v_mul_f32 v115, v12, v115
  v_mfma_f32_16x16x32_bf16 v[84:87], v[36:39], v[236:239], v[84:87]
  s_waitcnt lgkmcnt(5)
  v_mul_f32 v116, v12, v116
  v_mfma_f32_16x16x32_bf16 v[56:59], v[40:43], v[144:147], v[56:59]
  ds_read_b128 v[32:35], v253 offset:16384
  v_mul_f32 v117, v12, v117
  v_mfma_f32_16x16x32_bf16 v[64:67], v[40:43], v[176:179], v[64:67]
  v_mul_f32 v118, v12, v118
  v_mul_f32 v119, v12, v119
  v_mfma_f32_16x16x32_bf16 v[72:75], v[40:43], v[208:211], v[72:75]
  v_cvt_pk_bf16_f32 v112, v112, v113
  v_mfma_f32_16x16x32_bf16 v[80:83], v[40:43], v[240:243], v[80:83]
  s_waitcnt lgkmcnt(5)
  v_cvt_pk_bf16_f32 v113, v114, v115
  v_mfma_f32_16x16x32_bf16 v[60:63], v[44:47], v[144:147], v[60:63]
  ds_read_b128 v[36:39], v253 offset:18432
  v_cvt_pk_bf16_f32 v114, v116, v117
  v_mfma_f32_16x16x32_bf16 v[68:71], v[44:47], v[176:179], v[68:71]
  v_cvt_pk_bf16_f32 v115, v118, v119
  v_accvgpr_write_b32 a180, v112
  v_mfma_f32_16x16x32_bf16 v[76:79], v[44:47], v[208:211], v[76:79]
  v_accvgpr_write_b32 a181, v113
  v_mfma_f32_16x16x32_bf16 v[84:87], v[44:47], v[240:243], v[84:87]
  s_waitcnt lgkmcnt(5)
  v_accvgpr_write_b32 a182, v114
  v_mfma_f32_16x16x32_bf16 v[56:59], v[48:51], v[148:151], v[56:59]
  ds_read_b128 v[40:43], v254 offset:16384
  v_accvgpr_write_b32 a183, v115
  v_mfma_f32_16x16x32_bf16 v[64:67], v[48:51], v[180:183], v[64:67]
  v_mfma_f32_16x16x32_bf16 v[72:75], v[48:51], v[212:215], v[72:75]
  v_mfma_f32_16x16x32_bf16 v[80:83], v[48:51], v[244:247], v[80:83]
  s_waitcnt lgkmcnt(5)
  v_mfma_f32_16x16x32_bf16 v[60:63], v[52:55], v[148:151], v[60:63]
  ds_read_b128 v[44:47], v254 offset:18432
  v_mfma_f32_16x16x32_bf16 v[68:71], v[52:55], v[180:183], v[68:71]
  v_mfma_f32_16x16x32_bf16 v[76:79], v[52:55], v[212:215], v[76:79]
  v_mfma_f32_16x16x32_bf16 v[84:87], v[52:55], v[244:247], v[84:87]
  s_waitcnt lgkmcnt(5)
  v_mfma_f32_16x16x32_bf16 v[88:91], v[24:27], v[120:123], 0
  ds_read_b128 v[48:51], v255 offset:16384
  v_mfma_f32_16x16x32_bf16 v[96:99], v[24:27], v[152:155], 0
  v_mfma_f32_16x16x32_bf16 v[104:107], v[24:27], v[184:187], 0
  s_add_u32 m0, s29, 16384
  s_add_u32 s27, s28, 2883584
  buffer_load_dwordx4 v14, s[60:63], s27 offen lds
  v_mfma_f32_16x16x32_bf16 v[112:115], v[24:27], v[216:219], 0
  s_waitcnt lgkmcnt(5)
  v_mul_f32 v56, v12, v56
  v_mfma_f32_16x16x32_bf16 v[92:95], v[28:31], v[120:123], 0
  ds_read_b128 v[52:55], v255 offset:18432
  v_mul_f32 v57, v12, v57
  v_mfma_f32_16x16x32_bf16 v[100:103], v[28:31], v[152:155], 0
  v_mul_f32 v58, v12, v58
  v_mul_f32 v59, v12, v59
  v_mfma_f32_16x16x32_bf16 v[108:111], v[28:31], v[184:187], 0
  v_mul_f32 v60, v12, v60
  v_mfma_f32_16x16x32_bf16 v[116:119], v[28:31], v[216:219], 0
  s_waitcnt lgkmcnt(5)
  v_mul_f32 v61, v12, v61
  v_mfma_f32_16x16x32_bf16 v[88:91], v[32:35], v[124:127], v[88:91]
  ds_read_b128 v[24:27], v252 offset:16640
  v_mul_f32 v62, v12, v62
  v_mfma_f32_16x16x32_bf16 v[96:99], v[32:35], v[156:159], v[96:99]
  v_mul_f32 v63, v12, v63
  v_cvt_pk_bf16_f32 v56, v56, v57
  v_mfma_f32_16x16x32_bf16 v[104:107], v[32:35], v[188:191], v[104:107]
  s_add_u32 m0, s29, 17408
  s_add_u32 s27, s28, 2899968
  buffer_load_dwordx4 v15, s[60:63], s27 offen lds
  v_mfma_f32_16x16x32_bf16 v[112:115], v[32:35], v[220:223], v[112:115]
  s_waitcnt lgkmcnt(5)
  v_cvt_pk_bf16_f32 v57, v58, v59
  v_mfma_f32_16x16x32_bf16 v[92:95], v[36:39], v[124:127], v[92:95]
  ds_read_b128 v[28:31], v252 offset:18688
  v_cvt_pk_bf16_f32 v58, v60, v61
  v_mfma_f32_16x16x32_bf16 v[100:103], v[36:39], v[156:159], v[100:103]
  v_cvt_pk_bf16_f32 v59, v62, v63
  v_accvgpr_write_b32 a16, v56
  v_mfma_f32_16x16x32_bf16 v[108:111], v[36:39], v[188:191], v[108:111]
  v_accvgpr_write_b32 a17, v57
  v_mfma_f32_16x16x32_bf16 v[116:119], v[36:39], v[220:223], v[116:119]
  s_waitcnt lgkmcnt(5)
  v_accvgpr_write_b32 a18, v58
  v_mfma_f32_16x16x32_bf16 v[88:91], v[40:43], v[128:131], v[88:91]
  ds_read_b128 v[32:35], v253 offset:16640
  v_accvgpr_write_b32 a19, v59
  v_mfma_f32_16x16x32_bf16 v[96:99], v[40:43], v[160:163], v[96:99]
  v_mul_f32 v64, v12, v64
  v_mul_f32 v65, v12, v65
  v_mfma_f32_16x16x32_bf16 v[104:107], v[40:43], v[192:195], v[104:107]
  s_add_u32 m0, s29, 18432
  s_add_u32 s27, s28, 2916352
  buffer_load_dwordx4 v14, s[60:63], s27 offen lds
  v_mfma_f32_16x16x32_bf16 v[112:115], v[40:43], v[224:227], v[112:115]
  s_waitcnt lgkmcnt(5)
  v_mul_f32 v66, v12, v66
  v_mfma_f32_16x16x32_bf16 v[92:95], v[44:47], v[128:131], v[92:95]
  ds_read_b128 v[36:39], v253 offset:18688
  v_mul_f32 v67, v12, v67
  v_mfma_f32_16x16x32_bf16 v[100:103], v[44:47], v[160:163], v[100:103]
  v_mul_f32 v68, v12, v68
  v_mul_f32 v69, v12, v69
  v_mfma_f32_16x16x32_bf16 v[108:111], v[44:47], v[192:195], v[108:111]
  v_mul_f32 v70, v12, v70
  v_mfma_f32_16x16x32_bf16 v[116:119], v[44:47], v[224:227], v[116:119]
  s_waitcnt lgkmcnt(5)
  v_mul_f32 v71, v12, v71
  v_mfma_f32_16x16x32_bf16 v[88:91], v[48:51], v[132:135], v[88:91]
  ds_read_b128 v[40:43], v254 offset:16640
  v_cvt_pk_bf16_f32 v64, v64, v65
  v_mfma_f32_16x16x32_bf16 v[96:99], v[48:51], v[164:167], v[96:99]
  v_cvt_pk_bf16_f32 v65, v66, v67
  v_cvt_pk_bf16_f32 v66, v68, v69
  v_mfma_f32_16x16x32_bf16 v[104:107], v[48:51], v[196:199], v[104:107]
  s_add_u32 m0, s29, 19456
  s_add_u32 s27, s28, 2932736
  buffer_load_dwordx4 v15, s[60:63], s27 offen lds
  v_mfma_f32_16x16x32_bf16 v[112:115], v[48:51], v[228:231], v[112:115]
  s_waitcnt lgkmcnt(5)
  v_cvt_pk_bf16_f32 v67, v70, v71
  v_mfma_f32_16x16x32_bf16 v[92:95], v[52:55], v[132:135], v[92:95]
  ds_read_b128 v[44:47], v254 offset:18688
  v_accvgpr_write_b32 a72, v64
  v_mfma_f32_16x16x32_bf16 v[100:103], v[52:55], v[164:167], v[100:103]
  v_accvgpr_write_b32 a73, v65
  v_accvgpr_write_b32 a74, v66
  v_mfma_f32_16x16x32_bf16 v[108:111], v[52:55], v[196:199], v[108:111]
  v_accvgpr_write_b32 a75, v67
  v_mfma_f32_16x16x32_bf16 v[116:119], v[52:55], v[228:231], v[116:119]
  s_waitcnt lgkmcnt(5)
  v_mul_f32 v72, v12, v72
  v_mfma_f32_16x16x32_bf16 v[88:91], v[24:27], v[136:139], v[88:91]
  ds_read_b128 v[48:51], v255 offset:16640
  v_mul_f32 v73, v12, v73
  v_mfma_f32_16x16x32_bf16 v[96:99], v[24:27], v[168:171], v[96:99]
  v_mul_f32 v74, v12, v74
  v_mul_f32 v75, v12, v75
  v_mfma_f32_16x16x32_bf16 v[104:107], v[24:27], v[200:203], v[104:107]
  v_mul_f32 v76, v12, v76
  v_mfma_f32_16x16x32_bf16 v[112:115], v[24:27], v[232:235], v[112:115]
  s_waitcnt lgkmcnt(5)
  v_mul_f32 v77, v12, v77
  v_mfma_f32_16x16x32_bf16 v[92:95], v[28:31], v[136:139], v[92:95]
  ds_read_b128 v[52:55], v255 offset:18688
  v_mul_f32 v78, v12, v78
  v_mfma_f32_16x16x32_bf16 v[100:103], v[28:31], v[168:171], v[100:103]
  v_mul_f32 v79, v12, v79
  v_cvt_pk_bf16_f32 v72, v72, v73
  v_mfma_f32_16x16x32_bf16 v[108:111], v[28:31], v[200:203], v[108:111]
  v_cvt_pk_bf16_f32 v73, v74, v75
  v_mfma_f32_16x16x32_bf16 v[116:119], v[28:31], v[232:235], v[116:119]
  s_waitcnt lgkmcnt(5)
  v_cvt_pk_bf16_f32 v74, v76, v77
  v_mfma_f32_16x16x32_bf16 v[88:91], v[32:35], v[140:143], v[88:91]
  s_waitcnt vmcnt(20)
  s_barrier
  ds_read_b128 v[24:27], v252 offset:32768
  v_cvt_pk_bf16_f32 v75, v78, v79
  v_mfma_f32_16x16x32_bf16 v[96:99], v[32:35], v[172:175], v[96:99]
  v_accvgpr_write_b32 a128, v72
  v_accvgpr_write_b32 a129, v73
  v_mfma_f32_16x16x32_bf16 v[104:107], v[32:35], v[204:207], v[104:107]
  v_accvgpr_write_b32 a130, v74
  v_mfma_f32_16x16x32_bf16 v[112:115], v[32:35], v[236:239], v[112:115]
  s_waitcnt lgkmcnt(5)
  v_accvgpr_write_b32 a131, v75
  v_mfma_f32_16x16x32_bf16 v[92:95], v[36:39], v[140:143], v[92:95]
  ds_read_b128 v[28:31], v252 offset:34816
  v_mul_f32 v80, v12, v80
  v_mfma_f32_16x16x32_bf16 v[100:103], v[36:39], v[172:175], v[100:103]
  v_mul_f32 v81, v12, v81
  v_mul_f32 v82, v12, v82
  v_mfma_f32_16x16x32_bf16 v[108:111], v[36:39], v[204:207], v[108:111]
  v_mul_f32 v83, v12, v83
  v_mfma_f32_16x16x32_bf16 v[116:119], v[36:39], v[236:239], v[116:119]
  s_waitcnt lgkmcnt(5)
  v_mul_f32 v84, v12, v84
  v_mfma_f32_16x16x32_bf16 v[88:91], v[40:43], v[144:147], v[88:91]
  ds_read_b128 v[32:35], v253 offset:32768
  v_mul_f32 v85, v12, v85
  v_mfma_f32_16x16x32_bf16 v[96:99], v[40:43], v[176:179], v[96:99]
  v_mul_f32 v86, v12, v86
  v_mul_f32 v87, v12, v87
  v_mfma_f32_16x16x32_bf16 v[104:107], v[40:43], v[208:211], v[104:107]
  v_cvt_pk_bf16_f32 v80, v80, v81
  v_mfma_f32_16x16x32_bf16 v[112:115], v[40:43], v[240:243], v[112:115]
  s_waitcnt lgkmcnt(5)
  v_cvt_pk_bf16_f32 v81, v82, v83
  v_mfma_f32_16x16x32_bf16 v[92:95], v[44:47], v[144:147], v[92:95]
  ds_read_b128 v[36:39], v253 offset:34816
  v_cvt_pk_bf16_f32 v82, v84, v85
  v_mfma_f32_16x16x32_bf16 v[100:103], v[44:47], v[176:179], v[100:103]
  v_cvt_pk_bf16_f32 v83, v86, v87
  v_accvgpr_write_b32 a184, v80
  v_mfma_f32_16x16x32_bf16 v[108:111], v[44:47], v[208:211], v[108:111]
  v_accvgpr_write_b32 a185, v81
  v_mfma_f32_16x16x32_bf16 v[116:119], v[44:47], v[240:243], v[116:119]
  s_waitcnt lgkmcnt(5)
  v_accvgpr_write_b32 a186, v82
  v_mfma_f32_16x16x32_bf16 v[88:91], v[48:51], v[148:151], v[88:91]
  ds_read_b128 v[40:43], v254 offset:32768
  v_accvgpr_write_b32 a187, v83
  v_mfma_f32_16x16x32_bf16 v[96:99], v[48:51], v[180:183], v[96:99]
  v_mfma_f32_16x16x32_bf16 v[104:107], v[48:51], v[212:215], v[104:107]
  v_mfma_f32_16x16x32_bf16 v[112:115], v[48:51], v[244:247], v[112:115]
  s_waitcnt lgkmcnt(5)
  v_mfma_f32_16x16x32_bf16 v[92:95], v[52:55], v[148:151], v[92:95]
  ds_read_b128 v[44:47], v254 offset:34816
  v_mfma_f32_16x16x32_bf16 v[100:103], v[52:55], v[180:183], v[100:103]
  v_mfma_f32_16x16x32_bf16 v[108:111], v[52:55], v[212:215], v[108:111]
  v_mfma_f32_16x16x32_bf16 v[116:119], v[52:55], v[244:247], v[116:119]
  s_waitcnt lgkmcnt(5)
  s_getpc_b64 s[98:99]
  s_add_u32 s98, s98, 4096
  s_addc_u32 s99, s99, 0
  global_load_dword v7, v6, s[98:99]
  v_mfma_f32_16x16x32_bf16 v[56:59], v[24:27], v[120:123], 0
  ds_read_b128 v[48:51], v255 offset:32768
  v_mfma_f32_16x16x32_bf16 v[64:67], v[24:27], v[152:155], 0
  v_mfma_f32_16x16x32_bf16 v[72:75], v[24:27], v[184:187], 0
  s_add_u32 m0, s29, 32768
  s_add_u32 s27, s28, 3145728
  buffer_load_dwordx4 v14, s[60:63], s27 offen lds
  v_mfma_f32_16x16x32_bf16 v[80:83], v[24:27], v[216:219], 0
  s_waitcnt lgkmcnt(5)
  v_mul_f32 v88, v12, v88
  v_mfma_f32_16x16x32_bf16 v[60:63], v[28:31], v[120:123], 0
  ds_read_b128 v[52:55], v255 offset:34816
  v_mul_f32 v89, v12, v89
  v_mfma_f32_16x16x32_bf16 v[68:71], v[28:31], v[152:155], 0
  v_mul_f32 v90, v12, v90
  v_mul_f32 v91, v12, v91
  v_mfma_f32_16x16x32_bf16 v[76:79], v[28:31], v[184:187], 0
  v_mul_f32 v92, v12, v92
  v_mfma_f32_16x16x32_bf16 v[84:87], v[28:31], v[216:219], 0
  s_waitcnt lgkmcnt(5)
  v_mul_f32 v93, v12, v93
  v_mfma_f32_16x16x32_bf16 v[56:59], v[32:35], v[124:127], v[56:59]
  ds_read_b128 v[24:27], v252 offset:33024
  v_mul_f32 v94, v12, v94
  v_mfma_f32_16x16x32_bf16 v[64:67], v[32:35], v[156:159], v[64:67]
  v_mul_f32 v95, v12, v95
  v_cvt_pk_bf16_f32 v88, v88, v89
  v_mfma_f32_16x16x32_bf16 v[72:75], v[32:35], v[188:191], v[72:75]
  s_add_u32 m0, s29, 33792
  s_add_u32 s27, s28, 3162112
  buffer_load_dwordx4 v15, s[60:63], s27 offen lds
  v_mfma_f32_16x16x32_bf16 v[80:83], v[32:35], v[220:223], v[80:83]
  s_waitcnt lgkmcnt(5)
  v_cvt_pk_bf16_f32 v89, v90, v91
  v_mfma_f32_16x16x32_bf16 v[60:63], v[36:39], v[124:127], v[60:63]
  ds_read_b128 v[28:31], v252 offset:35072
  v_cvt_pk_bf16_f32 v90, v92, v93
  v_mfma_f32_16x16x32_bf16 v[68:71], v[36:39], v[156:159], v[68:71]
  v_cvt_pk_bf16_f32 v91, v94, v95
  v_accvgpr_write_b32 a20, v88
  v_mfma_f32_16x16x32_bf16 v[76:79], v[36:39], v[188:191], v[76:79]
  v_accvgpr_write_b32 a21, v89
  v_mfma_f32_16x16x32_bf16 v[84:87], v[36:39], v[220:223], v[84:87]
  s_waitcnt lgkmcnt(5)
  v_accvgpr_write_b32 a22, v90
  v_mfma_f32_16x16x32_bf16 v[56:59], v[40:43], v[128:131], v[56:59]
  ds_read_b128 v[32:35], v253 offset:33024
  v_accvgpr_write_b32 a23, v91
  v_mfma_f32_16x16x32_bf16 v[64:67], v[40:43], v[160:163], v[64:67]
  v_mul_f32 v96, v12, v96
  v_mul_f32 v97, v12, v97
  v_mfma_f32_16x16x32_bf16 v[72:75], v[40:43], v[192:195], v[72:75]
  s_add_u32 m0, s29, 34816
  s_add_u32 s27, s28, 3178496
  buffer_load_dwordx4 v14, s[60:63], s27 offen lds
  v_mfma_f32_16x16x32_bf16 v[80:83], v[40:43], v[224:227], v[80:83]
  s_waitcnt lgkmcnt(5)
  v_mul_f32 v98, v12, v98
  v_mfma_f32_16x16x32_bf16 v[60:63], v[44:47], v[128:131], v[60:63]
  ds_read_b128 v[36:39], v253 offset:35072
  v_mul_f32 v99, v12, v99
  v_mfma_f32_16x16x32_bf16 v[68:71], v[44:47], v[160:163], v[68:71]
  v_mul_f32 v100, v12, v100
  v_mul_f32 v101, v12, v101
  v_mfma_f32_16x16x32_bf16 v[76:79], v[44:47], v[192:195], v[76:79]
  v_mul_f32 v102, v12, v102
  v_mfma_f32_16x16x32_bf16 v[84:87], v[44:47], v[224:227], v[84:87]
  s_waitcnt lgkmcnt(5)
  v_mul_f32 v103, v12, v103
  v_mfma_f32_16x16x32_bf16 v[56:59], v[48:51], v[132:135], v[56:59]
  ds_read_b128 v[40:43], v254 offset:33024
  v_cvt_pk_bf16_f32 v96, v96, v97
  v_mfma_f32_16x16x32_bf16 v[64:67], v[48:51], v[164:167], v[64:67]
  v_cvt_pk_bf16_f32 v97, v98, v99
  v_cvt_pk_bf16_f32 v98, v100, v101
  v_mfma_f32_16x16x32_bf16 v[72:75], v[48:51], v[196:199], v[72:75]
  s_add_u32 m0, s29, 35840
  s_add_u32 s27, s28, 3194880
  buffer_load_dwordx4 v15, s[60:63], s27 offen lds
  v_mfma_f32_16x16x32_bf16 v[80:83], v[48:51], v[228:231], v[80:83]
  s_waitcnt lgkmcnt(5)
  v_cvt_pk_bf16_f32 v99, v102, v103
  v_mfma_f32_16x16x32_bf16 v[60:63], v[52:55], v[132:135], v[60:63]
  ds_read_b128 v[44:47], v254 offset:35072
  v_accvgpr_write_b32 a76, v96
  v_mfma_f32_16x16x32_bf16 v[68:71], v[52:55], v[164:167], v[68:71]
  v_accvgpr_write_b32 a77, v97
  v_accvgpr_write_b32 a78, v98
  v_mfma_f32_16x16x32_bf16 v[76:79], v[52:55], v[196:199], v[76:79]
  v_accvgpr_write_b32 a79, v99
  v_mfma_f32_16x16x32_bf16 v[84:87], v[52:55], v[228:231], v[84:87]
  s_waitcnt lgkmcnt(5)
  v_mul_f32 v104, v12, v104
  v_mfma_f32_16x16x32_bf16 v[56:59], v[24:27], v[136:139], v[56:59]
  ds_read_b128 v[48:51], v255 offset:33024
  v_mul_f32 v105, v12, v105
  v_mfma_f32_16x16x32_bf16 v[64:67], v[24:27], v[168:171], v[64:67]
  v_mul_f32 v106, v12, v106
  v_mul_f32 v107, v12, v107
  v_mfma_f32_16x16x32_bf16 v[72:75], v[24:27], v[200:203], v[72:75]
  v_mul_f32 v108, v12, v108
  v_mfma_f32_16x16x32_bf16 v[80:83], v[24:27], v[232:235], v[80:83]
  s_waitcnt lgkmcnt(5)
  v_mul_f32 v109, v12, v109
  v_mfma_f32_16x16x32_bf16 v[60:63], v[28:31], v[136:139], v[60:63]
  ds_read_b128 v[52:55], v255 offset:35072
  v_mul_f32 v110, v12, v110
  v_mfma_f32_16x16x32_bf16 v[68:71], v[28:31], v[168:171], v[68:71]
  v_mul_f32 v111, v12, v111
  v_cvt_pk_bf16_f32 v104, v104, v105
  v_mfma_f32_16x16x32_bf16 v[76:79], v[28:31], v[200:203], v[76:79]
  v_cvt_pk_bf16_f32 v105, v106, v107
  v_mfma_f32_16x16x32_bf16 v[84:87], v[28:31], v[232:235], v[84:87]
  s_waitcnt lgkmcnt(5)
  v_cvt_pk_bf16_f32 v106, v108, v109
  v_mfma_f32_16x16x32_bf16 v[56:59], v[32:35], v[140:143], v[56:59]
  s_waitcnt vmcnt(20)
  s_barrier
  ds_read_b128 v[24:27], v252 offset:49152
  v_cvt_pk_bf16_f32 v107, v110, v111
  v_mfma_f32_16x16x32_bf16 v[64:67], v[32:35], v[172:175], v[64:67]
  v_accvgpr_write_b32 a132, v104
  v_accvgpr_write_b32 a133, v105
  v_mfma_f32_16x16x32_bf16 v[72:75], v[32:35], v[204:207], v[72:75]
  v_accvgpr_write_b32 a134, v106
  v_mfma_f32_16x16x32_bf16 v[80:83], v[32:35], v[236:239], v[80:83]
  s_waitcnt lgkmcnt(5)
  v_accvgpr_write_b32 a135, v107
  v_mfma_f32_16x16x32_bf16 v[60:63], v[36:39], v[140:143], v[60:63]
  ds_read_b128 v[28:31], v252 offset:51200
  v_mul_f32 v112, v12, v112
  v_mfma_f32_16x16x32_bf16 v[68:71], v[36:39], v[172:175], v[68:71]
  v_mul_f32 v113, v12, v113
  v_mul_f32 v114, v12, v114
  v_mfma_f32_16x16x32_bf16 v[76:79], v[36:39], v[204:207], v[76:79]
  v_mul_f32 v115, v12, v115
  v_mfma_f32_16x16x32_bf16 v[84:87], v[36:39], v[236:239], v[84:87]
  s_waitcnt lgkmcnt(5)
  v_mul_f32 v116, v12, v116
  v_mfma_f32_16x16x32_bf16 v[56:59], v[40:43], v[144:147], v[56:59]
  ds_read_b128 v[32:35], v253 offset:49152
  v_mul_f32 v117, v12, v117
  v_mfma_f32_16x16x32_bf16 v[64:67], v[40:43], v[176:179], v[64:67]
  v_mul_f32 v118, v12, v118
  v_mul_f32 v119, v12, v119
  v_mfma_f32_16x16x32_bf16 v[72:75], v[40:43], v[208:211], v[72:75]
  v_cvt_pk_bf16_f32 v112, v112, v113
  v_mfma_f32_16x16x32_bf16 v[80:83], v[40:43], v[240:243], v[80:83]
  s_waitcnt lgkmcnt(5)
  v_cvt_pk_bf16_f32 v113, v114, v115
  v_mfma_f32_16x16x32_bf16 v[60:63], v[44:47], v[144:147], v[60:63]
  ds_read_b128 v[36:39], v253 offset:51200
  v_cvt_pk_bf16_f32 v114, v116, v117
  v_mfma_f32_16x16x32_bf16 v[68:71], v[44:47], v[176:179], v[68:71]
  v_cvt_pk_bf16_f32 v115, v118, v119
  v_accvgpr_write_b32 a188, v112
  v_mfma_f32_16x16x32_bf16 v[76:79], v[44:47], v[208:211], v[76:79]
  v_accvgpr_write_b32 a189, v113
  v_mfma_f32_16x16x32_bf16 v[84:87], v[44:47], v[240:243], v[84:87]
  s_waitcnt lgkmcnt(5)
  v_accvgpr_write_b32 a190, v114
  v_mfma_f32_16x16x32_bf16 v[56:59], v[48:51], v[148:151], v[56:59]
  ds_read_b128 v[40:43], v254 offset:49152
  v_accvgpr_write_b32 a191, v115
  v_mfma_f32_16x16x32_bf16 v[64:67], v[48:51], v[180:183], v[64:67]
  v_mfma_f32_16x16x32_bf16 v[72:75], v[48:51], v[212:215], v[72:75]
  v_mfma_f32_16x16x32_bf16 v[80:83], v[48:51], v[244:247], v[80:83]
  s_waitcnt lgkmcnt(5)
  v_mfma_f32_16x16x32_bf16 v[60:63], v[52:55], v[148:151], v[60:63]
  ds_read_b128 v[44:47], v254 offset:51200
  v_mfma_f32_16x16x32_bf16 v[68:71], v[52:55], v[180:183], v[68:71]
  v_mfma_f32_16x16x32_bf16 v[76:79], v[52:55], v[212:215], v[76:79]
  v_mfma_f32_16x16x32_bf16 v[84:87], v[52:55], v[244:247], v[84:87]
  s_waitcnt lgkmcnt(5)
  v_mfma_f32_16x16x32_bf16 v[88:91], v[24:27], v[120:123], 0
  ds_read_b128 v[48:51], v255 offset:49152
  v_mfma_f32_16x16x32_bf16 v[96:99], v[24:27], v[152:155], 0
  v_mfma_f32_16x16x32_bf16 v[104:107], v[24:27], v[184:187], 0
  s_add_u32 m0, s29, 49152
  s_add_u32 s27, s28, 3407872
  buffer_load_dwordx4 v14, s[60:63], s27 offen lds
  v_mfma_f32_16x16x32_bf16 v[112:115], v[24:27], v[216:219], 0
  s_waitcnt lgkmcnt(5)
  v_mul_f32 v56, v12, v56
  v_mfma_f32_16x16x32_bf16 v[92:95], v[28:31], v[120:123], 0
  ds_read_b128 v[52:55], v255 offset:51200
  v_mul_f32 v57, v12, v57
  v_mfma_f32_16x16x32_bf16 v[100:103], v[28:31], v[152:155], 0
  v_mul_f32 v58, v12, v58
  v_mul_f32 v59, v12, v59
  v_mfma_f32_16x16x32_bf16 v[108:111], v[28:31], v[184:187], 0
  v_mul_f32 v60, v12, v60
  v_mfma_f32_16x16x32_bf16 v[116:119], v[28:31], v[216:219], 0
  s_waitcnt lgkmcnt(5)
  v_mul_f32 v61, v12, v61
  v_mfma_f32_16x16x32_bf16 v[88:91], v[32:35], v[124:127], v[88:91]
  ds_read_b128 v[24:27], v252 offset:49408
  v_mul_f32 v62, v12, v62
  v_mfma_f32_16x16x32_bf16 v[96:99], v[32:35], v[156:159], v[96:99]
  v_mul_f32 v63, v12, v63
  v_cvt_pk_bf16_f32 v56, v56, v57
  v_mfma_f32_16x16x32_bf16 v[104:107], v[32:35], v[188:191], v[104:107]
  s_add_u32 m0, s29, 50176
  s_add_u32 s27, s28, 3424256
  buffer_load_dwordx4 v15, s[60:63], s27 offen lds
  v_mfma_f32_16x16x32_bf16 v[112:115], v[32:35], v[220:223], v[112:115]
  s_waitcnt lgkmcnt(5)
  v_cvt_pk_bf16_f32 v57, v58, v59
  v_mfma_f32_16x16x32_bf16 v[92:95], v[36:39], v[124:127], v[92:95]
  ds_read_b128 v[28:31], v252 offset:51456
  v_cvt_pk_bf16_f32 v58, v60, v61
  v_mfma_f32_16x16x32_bf16 v[100:103], v[36:39], v[156:159], v[100:103]
  v_cvt_pk_bf16_f32 v59, v62, v63
  v_accvgpr_write_b32 a24, v56
  v_mfma_f32_16x16x32_bf16 v[108:111], v[36:39], v[188:191], v[108:111]
  v_accvgpr_write_b32 a25, v57
  v_mfma_f32_16x16x32_bf16 v[116:119], v[36:39], v[220:223], v[116:119]
  s_waitcnt lgkmcnt(5)
  v_accvgpr_write_b32 a26, v58
  v_mfma_f32_16x16x32_bf16 v[88:91], v[40:43], v[128:131], v[88:91]
  ds_read_b128 v[32:35], v253 offset:49408
  v_accvgpr_write_b32 a27, v59
  v_mfma_f32_16x16x32_bf16 v[96:99], v[40:43], v[160:163], v[96:99]
  v_mul_f32 v64, v12, v64
  v_mul_f32 v65, v12, v65
  v_mfma_f32_16x16x32_bf16 v[104:107], v[40:43], v[192:195], v[104:107]
  s_add_u32 m0, s29, 51200
  s_add_u32 s27, s28, 3440640
  buffer_load_dwordx4 v14, s[60:63], s27 offen lds
  v_mfma_f32_16x16x32_bf16 v[112:115], v[40:43], v[224:227], v[112:115]
  s_waitcnt lgkmcnt(5)
  v_mul_f32 v66, v12, v66
  v_mfma_f32_16x16x32_bf16 v[92:95], v[44:47], v[128:131], v[92:95]
  ds_read_b128 v[36:39], v253 offset:51456
  v_mul_f32 v67, v12, v67
  v_mfma_f32_16x16x32_bf16 v[100:103], v[44:47], v[160:163], v[100:103]
  v_mul_f32 v68, v12, v68
  v_mul_f32 v69, v12, v69
  v_mfma_f32_16x16x32_bf16 v[108:111], v[44:47], v[192:195], v[108:111]
  v_mul_f32 v70, v12, v70
  v_mfma_f32_16x16x32_bf16 v[116:119], v[44:47], v[224:227], v[116:119]
  s_waitcnt lgkmcnt(5)
  v_mul_f32 v71, v12, v71
  v_mfma_f32_16x16x32_bf16 v[88:91], v[48:51], v[132:135], v[88:91]
  ds_read_b128 v[40:43], v254 offset:49408
  v_cvt_pk_bf16_f32 v64, v64, v65
  v_mfma_f32_16x16x32_bf16 v[96:99], v[48:51], v[164:167], v[96:99]
  v_cvt_pk_bf16_f32 v65, v66, v67
  v_cvt_pk_bf16_f32 v66, v68, v69
  v_mfma_f32_16x16x32_bf16 v[104:107], v[48:51], v[196:199], v[104:107]
  s_add_u32 m0, s29, 52224
  s_add_u32 s27, s28, 3457024
  buffer_load_dwordx4 v15, s[60:63], s27 offen lds
  v_mfma_f32_16x16x32_bf16 v[112:115], v[48:51], v[228:231], v[112:115]
  s_waitcnt lgkmcnt(5)
  v_cvt_pk_bf16_f32 v67, v70, v71
  v_mfma_f32_16x16x32_bf16 v[92:95], v[52:55], v[132:135], v[92:95]
  ds_read_b128 v[44:47], v254 offset:51456
  v_accvgpr_write_b32 a80, v64
  v_mfma_f32_16x16x32_bf16 v[100:103], v[52:55], v[164:167], v[100:103]
  v_accvgpr_write_b32 a81, v65
  v_accvgpr_write_b32 a82, v66
  v_mfma_f32_16x16x32_bf16 v[108:111], v[52:55], v[196:199], v[108:111]
  v_accvgpr_write_b32 a83, v67
  v_mfma_f32_16x16x32_bf16 v[116:119], v[52:55], v[228:231], v[116:119]
  s_waitcnt lgkmcnt(5)
  v_mul_f32 v72, v12, v72
  v_mfma_f32_16x16x32_bf16 v[88:91], v[24:27], v[136:139], v[88:91]
  ds_read_b128 v[48:51], v255 offset:49408
  v_mul_f32 v73, v12, v73
  v_mfma_f32_16x16x32_bf16 v[96:99], v[24:27], v[168:171], v[96:99]
  v_mul_f32 v74, v12, v74
  v_mul_f32 v75, v12, v75
  v_mfma_f32_16x16x32_bf16 v[104:107], v[24:27], v[200:203], v[104:107]
  v_mul_f32 v76, v12, v76
  v_mfma_f32_16x16x32_bf16 v[112:115], v[24:27], v[232:235], v[112:115]
  s_waitcnt lgkmcnt(5)
  v_mul_f32 v77, v12, v77
  v_mfma_f32_16x16x32_bf16 v[92:95], v[28:31], v[136:139], v[92:95]
  ds_read_b128 v[52:55], v255 offset:51456
  v_mul_f32 v78, v12, v78
  v_mfma_f32_16x16x32_bf16 v[100:103], v[28:31], v[168:171], v[100:103]
  v_mul_f32 v79, v12, v79
  v_cvt_pk_bf16_f32 v72, v72, v73
  v_mfma_f32_16x16x32_bf16 v[108:111], v[28:31], v[200:203], v[108:111]
  v_cvt_pk_bf16_f32 v73, v74, v75
  v_mfma_f32_16x16x32_bf16 v[116:119], v[28:31], v[232:235], v[116:119]
  s_waitcnt lgkmcnt(5)
  v_cvt_pk_bf16_f32 v74, v76, v77
  v_mfma_f32_16x16x32_bf16 v[88:91], v[32:35], v[140:143], v[88:91]
  s_waitcnt vmcnt(20)
  s_barrier
  ds_read_b128 v[24:27], v16 offset:0
  v_cvt_pk_bf16_f32 v75, v78, v79
  v_mfma_f32_16x16x32_bf16 v[96:99], v[32:35], v[172:175], v[96:99]
  v_accvgpr_write_b32 a136, v72
  v_accvgpr_write_b32 a137, v73
  v_mfma_f32_16x16x32_bf16 v[104:107], v[32:35], v[204:207], v[104:107]
  v_accvgpr_write_b32 a138, v74
  v_mfma_f32_16x16x32_bf16 v[112:115], v[32:35], v[236:239], v[112:115]
  s_waitcnt lgkmcnt(5)
  v_accvgpr_write_b32 a139, v75
  v_mfma_f32_16x16x32_bf16 v[92:95], v[36:39], v[140:143], v[92:95]
  ds_read_b128 v[28:31], v16 offset:2048
  v_mul_f32 v80, v12, v80
  v_mfma_f32_16x16x32_bf16 v[100:103], v[36:39], v[172:175], v[100:103]
  v_mul_f32 v81, v12, v81
  v_mul_f32 v82, v12, v82
  v_mfma_f32_16x16x32_bf16 v[108:111], v[36:39], v[204:207], v[108:111]
  v_mul_f32 v83, v12, v83
  v_mfma_f32_16x16x32_bf16 v[116:119], v[36:39], v[236:239], v[116:119]
  s_waitcnt lgkmcnt(5)
  v_mul_f32 v84, v12, v84
  v_mfma_f32_16x16x32_bf16 v[88:91], v[40:43], v[144:147], v[88:91]
  ds_read_b128 v[32:35], v17 offset:0
  v_mul_f32 v85, v12, v85
  v_mfma_f32_16x16x32_bf16 v[96:99], v[40:43], v[176:179], v[96:99]
  v_mul_f32 v86, v12, v86
  v_mul_f32 v87, v12, v87
  v_mfma_f32_16x16x32_bf16 v[104:107], v[40:43], v[208:211], v[104:107]
  v_cvt_pk_bf16_f32 v80, v80, v81
  v_mfma_f32_16x16x32_bf16 v[112:115], v[40:43], v[240:243], v[112:115]
  s_waitcnt lgkmcnt(5)
  v_cvt_pk_bf16_f32 v81, v82, v83
  v_mfma_f32_16x16x32_bf16 v[92:95], v[44:47], v[144:147], v[92:95]
  ds_read_b128 v[36:39], v17 offset:2048
  v_cvt_pk_bf16_f32 v82, v84, v85
  v_mfma_f32_16x16x32_bf16 v[100:103], v[44:47], v[176:179], v[100:103]
  v_cvt_pk_bf16_f32 v83, v86, v87
  v_accvgpr_write_b32 a192, v80
  v_mfma_f32_16x16x32_bf16 v[108:111], v[44:47], v[208:211], v[108:111]
  v_accvgpr_write_b32 a193, v81
  v_mfma_f32_16x16x32_bf16 v[116:119], v[44:47], v[240:243], v[116:119]
  s_waitcnt lgkmcnt(5)
  v_accvgpr_write_b32 a194, v82
  v_mfma_f32_16x16x32_bf16 v[88:91], v[48:51], v[148:151], v[88:91]
  ds_read_b128 v[40:43], v18 offset:0
  v_accvgpr_write_b32 a195, v83
  v_mfma_f32_16x16x32_bf16 v[96:99], v[48:51], v[180:183], v[96:99]
  v_mfma_f32_16x16x32_bf16 v[104:107], v[48:51], v[212:215], v[104:107]
  v_mfma_f32_16x16x32_bf16 v[112:115], v[48:51], v[244:247], v[112:115]
  s_waitcnt lgkmcnt(5)
  v_mfma_f32_16x16x32_bf16 v[92:95], v[52:55], v[148:151], v[92:95]
  ds_read_b128 v[44:47], v18 offset:2048
  v_mfma_f32_16x16x32_bf16 v[100:103], v[52:55], v[180:183], v[100:103]
  v_mfma_f32_16x16x32_bf16 v[108:111], v[52:55], v[212:215], v[108:111]
  v_mfma_f32_16x16x32_bf16 v[116:119], v[52:55], v[244:247], v[116:119]
  s_waitcnt lgkmcnt(5)
  v_mfma_f32_16x16x32_bf16 v[56:59], v[24:27], v[120:123], 0
  ds_read_b128 v[48:51], v19 offset:0
  v_mfma_f32_16x16x32_bf16 v[64:67], v[24:27], v[152:155], 0
  v_mfma_f32_16x16x32_bf16 v[72:75], v[24:27], v[184:187], 0
  v_mfma_f32_16x16x32_bf16 v[80:83], v[24:27], v[216:219], 0
  s_waitcnt lgkmcnt(5)
  v_mul_f32 v88, v12, v88
  v_mfma_f32_16x16x32_bf16 v[60:63], v[28:31], v[120:123], 0
  ds_read_b128 v[52:55], v19 offset:2048
  v_mul_f32 v89, v12, v89
  v_mfma_f32_16x16x32_bf16 v[68:71], v[28:31], v[152:155], 0
  v_mul_f32 v90, v12, v90
  v_mul_f32 v91, v12, v91
  v_mfma_f32_16x16x32_bf16 v[76:79], v[28:31], v[184:187], 0
  v_mul_f32 v92, v12, v92
  v_mfma_f32_16x16x32_bf16 v[84:87], v[28:31], v[216:219], 0
  s_waitcnt lgkmcnt(5)
  v_mul_f32 v93, v12, v93
  v_mfma_f32_16x16x32_bf16 v[56:59], v[32:35], v[124:127], v[56:59]
  ds_read_b128 v[24:27], v16 offset:256
  v_mul_f32 v94, v12, v94
  v_mfma_f32_16x16x32_bf16 v[64:67], v[32:35], v[156:159], v[64:67]
  v_mul_f32 v95, v12, v95
  v_cvt_pk_bf16_f32 v88, v88, v89
  v_mfma_f32_16x16x32_bf16 v[72:75], v[32:35], v[188:191], v[72:75]
  v_cvt_pk_bf16_f32 v89, v90, v91
  v_mfma_f32_16x16x32_bf16 v[80:83], v[32:35], v[220:223], v[80:83]
  s_waitcnt lgkmcnt(5)
  v_cvt_pk_bf16_f32 v90, v92, v93
  v_mfma_f32_16x16x32_bf16 v[60:63], v[36:39], v[124:127], v[60:63]
  ds_read_b128 v[28:31], v16 offset:2304
  v_cvt_pk_bf16_f32 v91, v94, v95
  v_mfma_f32_16x16x32_bf16 v[68:71], v[36:39], v[156:159], v[68:71]
  v_accvgpr_write_b32 a28, v88
  v_accvgpr_write_b32 a29, v89
  v_mfma_f32_16x16x32_bf16 v[76:79], v[36:39], v[188:191], v[76:79]
  v_accvgpr_write_b32 a30, v90
  v_mfma_f32_16x16x32_bf16 v[84:87], v[36:39], v[220:223], v[84:87]
  s_waitcnt lgkmcnt(5)
  v_accvgpr_write_b32 a31, v91
  v_mfma_f32_16x16x32_bf16 v[56:59], v[40:43], v[128:131], v[56:59]
  ds_read_b128 v[32:35], v17 offset:256
  v_mul_f32 v96, v12, v96
  v_mfma_f32_16x16x32_bf16 v[64:67], v[40:43], v[160:163], v[64:67]
  v_mul_f32 v97, v12, v97
  v_mul_f32 v98, v12, v98
  v_mfma_f32_16x16x32_bf16 v[72:75], v[40:43], v[192:195], v[72:75]
  v_mul_f32 v99, v12, v99
  v_mfma_f32_16x16x32_bf16 v[80:83], v[40:43], v[224:227], v[80:83]
  s_waitcnt lgkmcnt(5)
  v_mul_f32 v100, v12, v100
  v_mfma_f32_16x16x32_bf16 v[60:63], v[44:47], v[128:131], v[60:63]
  ds_read_b128 v[36:39], v17 offset:2304
  v_mul_f32 v101, v12, v101
  v_mfma_f32_16x16x32_bf16 v[68:71], v[44:47], v[160:163], v[68:71]
  v_mul_f32 v102, v12, v102
  v_mul_f32 v103, v12, v103
  v_mfma_f32_16x16x32_bf16 v[76:79], v[44:47], v[192:195], v[76:79]
  v_cvt_pk_bf16_f32 v96, v96, v97
  v_mfma_f32_16x16x32_bf16 v[84:87], v[44:47], v[224:227], v[84:87]
  s_waitcnt lgkmcnt(5)
  v_cvt_pk_bf16_f32 v97, v98, v99
  v_mfma_f32_16x16x32_bf16 v[56:59], v[48:51], v[132:135], v[56:59]
  ds_read_b128 v[40:43], v18 offset:256
  v_cvt_pk_bf16_f32 v98, v100, v101
  v_mfma_f32_16x16x32_bf16 v[64:67], v[48:51], v[164:167], v[64:67]
  v_cvt_pk_bf16_f32 v99, v102, v103
  v_accvgpr_write_b32 a84, v96
  v_mfma_f32_16x16x32_bf16 v[72:75], v[48:51], v[196:199], v[72:75]
  v_accvgpr_write_b32 a85, v97
  v_mfma_f32_16x16x32_bf16 v[80:83], v[48:51], v[228:231], v[80:83]
  s_waitcnt lgkmcnt(5)
  v_accvgpr_write_b32 a86, v98
  v_mfma_f32_16x16x32_bf16 v[60:63], v[52:55], v[132:135], v[60:63]
  ds_read_b128 v[44:47], v18 offset:2304
  v_accvgpr_write_b32 a87, v99
  v_mfma_f32_16x16x32_bf16 v[68:71], v[52:55], v[164:167], v[68:71]
  v_mul_f32 v104, v12, v104
  v_mul_f32 v105, v12, v105
  v_mfma_f32_16x16x32_bf16 v[76:79], v[52:55], v[196:199], v[76:79]
  v_mul_f32 v106, v12, v106
  v_mfma_f32_16x16x32_bf16 v[84:87], v[52:55], v[228:231], v[84:87]
  s_waitcnt lgkmcnt(5)
  v_mul_f32 v107, v12, v107
  v_mfma_f32_16x16x32_bf16 v[56:59], v[24:27], v[136:139], v[56:59]
  ds_read_b128 v[48:51], v19 offset:256
  v_mul_f32 v108, v12, v108
  v_mfma_f32_16x16x32_bf16 v[64:67], v[24:27], v[168:171], v[64:67]
  v_mul_f32 v109, v12, v109
  v_mul_f32 v110, v12, v110
  v_mfma_f32_16x16x32_bf16 v[72:75], v[24:27], v[200:203], v[72:75]
  v_mul_f32 v111, v12, v111
  v_mfma_f32_16x16x32_bf16 v[80:83], v[24:27], v[232:235], v[80:83]
  s_waitcnt lgkmcnt(5)
  v_cvt_pk_bf16_f32 v104, v104, v105
  v_mfma_f32_16x16x32_bf16 v[60:63], v[28:31], v[136:139], v[60:63]
  ds_read_b128 v[52:55], v19 offset:2304
  v_cvt_pk_bf16_f32 v105, v106, v107
  v_mfma_f32_16x16x32_bf16 v[68:71], v[28:31], v[168:171], v[68:71]
  v_cvt_pk_bf16_f32 v106, v108, v109
  v_cvt_pk_bf16_f32 v107, v110, v111
  v_mfma_f32_16x16x32_bf16 v[76:79], v[28:31], v[200:203], v[76:79]
  v_accvgpr_write_b32 a140, v104
  v_mfma_f32_16x16x32_bf16 v[84:87], v[28:31], v[232:235], v[84:87]
  s_waitcnt lgkmcnt(5)
  v_accvgpr_write_b32 a141, v105
  v_mfma_f32_16x16x32_bf16 v[56:59], v[32:35], v[140:143], v[56:59]
  s_waitcnt vmcnt(16)
  s_barrier
  ds_read_b128 v[24:27], v16 offset:16384
  v_accvgpr_write_b32 a142, v106
  v_mfma_f32_16x16x32_bf16 v[64:67], v[32:35], v[172:175], v[64:67]
  v_accvgpr_write_b32 a143, v107
  v_mul_f32 v112, v12, v112
  v_mfma_f32_16x16x32_bf16 v[72:75], v[32:35], v[204:207], v[72:75]
  v_mul_f32 v113, v12, v113
  v_mfma_f32_16x16x32_bf16 v[80:83], v[32:35], v[236:239], v[80:83]
  s_waitcnt lgkmcnt(5)
  v_mul_f32 v114, v12, v114
  v_mfma_f32_16x16x32_bf16 v[60:63], v[36:39], v[140:143], v[60:63]
  ds_read_b128 v[28:31], v16 offset:18432
  v_mul_f32 v115, v12, v115
  v_mfma_f32_16x16x32_bf16 v[68:71], v[36:39], v[172:175], v[68:71]
  v_mul_f32 v116, v12, v116
  v_mul_f32 v117, v12, v117
  v_mfma_f32_16x16x32_bf16 v[76:79], v[36:39], v[204:207], v[76:79]
  v_mul_f32 v118, v12, v118
  v_mfma_f32_16x16x32_bf16 v[84:87], v[36:39], v[236:239], v[84:87]
  s_waitcnt lgkmcnt(5)
  v_mul_f32 v119, v12, v119
  v_mfma_f32_16x16x32_bf16 v[56:59], v[40:43], v[144:147], v[56:59]
  ds_read_b128 v[32:35], v17 offset:16384
  v_cvt_pk_bf16_f32 v112, v112, v113
  v_mfma_f32_16x16x32_bf16 v[64:67], v[40:43], v[176:179], v[64:67]
  v_cvt_pk_bf16_f32 v113, v114, v115
  v_cvt_pk_bf16_f32 v114, v116, v117
  v_mfma_f32_16x16x32_bf16 v[72:75], v[40:43], v[208:211], v[72:75]
  v_cvt_pk_bf16_f32 v115, v118, v119
  v_mfma_f32_16x16x32_bf16 v[80:83], v[40:43], v[240:243], v[80:83]
  s_waitcnt lgkmcnt(5)
  v_accvgpr_write_b32 a196, v112
  v_mfma_f32_16x16x32_bf16 v[60:63], v[44:47], v[144:147], v[60:63]
  ds_read_b128 v[36:39], v17 offset:18432
  v_accvgpr_write_b32 a197, v113
  v_mfma_f32_16x16x32_bf16 v[68:71], v[44:47], v[176:179], v[68:71]
  v_accvgpr_write_b32 a198, v114
  v_accvgpr_write_b32 a199, v115
  v_mfma_f32_16x16x32_bf16 v[76:79], v[44:47], v[208:211], v[76:79]
  v_mfma_f32_16x16x32_bf16 v[84:87], v[44:47], v[240:243], v[84:87]
  s_waitcnt lgkmcnt(5)
  v_mfma_f32_16x16x32_bf16 v[56:59], v[48:51], v[148:151], v[56:59]
  ds_read_b128 v[40:43], v18 offset:16384
  v_mfma_f32_16x16x32_bf16 v[64:67], v[48:51], v[180:183], v[64:67]
  v_mfma_f32_16x16x32_bf16 v[72:75], v[48:51], v[212:215], v[72:75]
  v_mfma_f32_16x16x32_bf16 v[80:83], v[48:51], v[244:247], v[80:83]
  s_waitcnt lgkmcnt(5)
  v_mfma_f32_16x16x32_bf16 v[60:63], v[52:55], v[148:151], v[60:63]
  ds_read_b128 v[44:47], v18 offset:18432
  v_mfma_f32_16x16x32_bf16 v[68:71], v[52:55], v[180:183], v[68:71]
  v_mfma_f32_16x16x32_bf16 v[76:79], v[52:55], v[212:215], v[76:79]
  v_mfma_f32_16x16x32_bf16 v[84:87], v[52:55], v[244:247], v[84:87]
  s_waitcnt lgkmcnt(5)
  s_getpc_b64 s[98:99]
  s_add_u32 s98, s98, 4096
  s_addc_u32 s99, s99, 0
  global_load_dword v7, v6, s[98:99]
  v_mfma_f32_16x16x32_bf16 v[88:91], v[24:27], v[120:123], 0
  ds_read_b128 v[48:51], v19 offset:16384
  v_mfma_f32_16x16x32_bf16 v[96:99], v[24:27], v[152:155], 0
  v_mfma_f32_16x16x32_bf16 v[104:107], v[24:27], v[184:187], 0
  v_mfma_f32_16x16x32_bf16 v[112:115], v[24:27], v[216:219], 0
  s_waitcnt lgkmcnt(5)
  v_mul_f32 v56, v12, v56
  v_mfma_f32_16x16x32_bf16 v[92:95], v[28:31], v[120:123], 0
  ds_read_b128 v[52:55], v19 offset:18432
  v_mul_f32 v57, v12, v57
  v_mfma_f32_16x16x32_bf16 v[100:103], v[28:31], v[152:155], 0
  v_mul_f32 v58, v12, v58
  v_mul_f32 v59, v12, v59
  v_mfma_f32_16x16x32_bf16 v[108:111], v[28:31], v[184:187], 0
  v_mul_f32 v60, v12, v60
  v_mfma_f32_16x16x32_bf16 v[116:119], v[28:31], v[216:219], 0
  s_waitcnt lgkmcnt(5)
  v_mul_f32 v61, v12, v61
  v_mfma_f32_16x16x32_bf16 v[88:91], v[32:35], v[124:127], v[88:91]
  ds_read_b128 v[24:27], v16 offset:16640
  v_mul_f32 v62, v12, v62
  v_mfma_f32_16x16x32_bf16 v[96:99], v[32:35], v[156:159], v[96:99]
  v_mul_f32 v63, v12, v63
  v_cvt_pk_bf16_f32 v56, v56, v57
  v_mfma_f32_16x16x32_bf16 v[104:107], v[32:35], v[188:191], v[104:107]
  v_cvt_pk_bf16_f32 v57, v58, v59
  v_mfma_f32_16x16x32_bf16 v[112:115], v[32:35], v[220:223], v[112:115]
  s_waitcnt lgkmcnt(5)
  v_cvt_pk_bf16_f32 v58, v60, v61
  v_mfma_f32_16x16x32_bf16 v[92:95], v[36:39], v[124:127], v[92:95]
  ds_read_b128 v[28:31], v16 offset:18688
  v_cvt_pk_bf16_f32 v59, v62, v63
  v_mfma_f32_16x16x32_bf16 v[100:103], v[36:39], v[156:159], v[100:103]
  v_accvgpr_write_b32 a32, v56
  v_accvgpr_write_b32 a33, v57
  v_mfma_f32_16x16x32_bf16 v[108:111], v[36:39], v[188:191], v[108:111]
  v_accvgpr_write_b32 a34, v58
  v_mfma_f32_16x16x32_bf16 v[116:119], v[36:39], v[220:223], v[116:119]
  s_waitcnt lgkmcnt(5)
  v_accvgpr_write_b32 a35, v59
  v_mfma_f32_16x16x32_bf16 v[88:91], v[40:43], v[128:131], v[88:91]
  ds_read_b128 v[32:35], v17 offset:16640
  v_mul_f32 v64, v12, v64
  v_mfma_f32_16x16x32_bf16 v[96:99], v[40:43], v[160:163], v[96:99]
  v_mul_f32 v65, v12, v65
  v_mul_f32 v66, v12, v66
  v_mfma_f32_16x16x32_bf16 v[104:107], v[40:43], v[192:195], v[104:107]
  v_mul_f32 v67, v12, v67
  v_mfma_f32_16x16x32_bf16 v[112:115], v[40:43], v[224:227], v[112:115]
  s_waitcnt lgkmcnt(5)
  v_mul_f32 v68, v12, v68
  v_mfma_f32_16x16x32_bf16 v[92:95], v[44:47], v[128:131], v[92:95]
  ds_read_b128 v[36:39], v17 offset:18688
  v_mul_f32 v69, v12, v69
  v_mfma_f32_16x16x32_bf16 v[100:103], v[44:47], v[160:163], v[100:103]
  v_mul_f32 v70, v12, v70
  v_mul_f32 v71, v12, v71
  v_mfma_f32_16x16x32_bf16 v[108:111], v[44:47], v[192:195], v[108:111]
  v_cvt_pk_bf16_f32 v64, v64, v65
  v_mfma_f32_16x16x32_bf16 v[116:119], v[44:47], v[224:227], v[116:119]
  s_waitcnt lgkmcnt(5)
  v_cvt_pk_bf16_f32 v65, v66, v67
  v_mfma_f32_16x16x32_bf16 v[88:91], v[48:51], v[132:135], v[88:91]
  ds_read_b128 v[40:43], v18 offset:16640
  v_cvt_pk_bf16_f32 v66, v68, v69
  v_mfma_f32_16x16x32_bf16 v[96:99], v[48:51], v[164:167], v[96:99]
  v_cvt_pk_bf16_f32 v67, v70, v71
  v_accvgpr_write_b32 a88, v64
  v_mfma_f32_16x16x32_bf16 v[104:107], v[48:51], v[196:199], v[104:107]
  v_accvgpr_write_b32 a89, v65
  v_mfma_f32_16x16x32_bf16 v[112:115], v[48:51], v[228:231], v[112:115]
  s_waitcnt lgkmcnt(5)
  v_accvgpr_write_b32 a90, v66
  v_mfma_f32_16x16x32_bf16 v[92:95], v[52:55], v[132:135], v[92:95]
  ds_read_b128 v[44:47], v18 offset:18688
  v_accvgpr_write_b32 a91, v67
  v_mfma_f32_16x16x32_bf16 v[100:103], v[52:55], v[164:167], v[100:103]
  v_mul_f32 v72, v12, v72
  v_mul_f32 v73, v12, v73
  v_mfma_f32_16x16x32_bf16 v[108:111], v[52:55], v[196:199], v[108:111]
  v_mul_f32 v74, v12, v74
  v_mfma_f32_16x16x32_bf16 v[116:119], v[52:55], v[228:231], v[116:119]
  s_waitcnt lgkmcnt(5)
  v_mul_f32 v75, v12, v75
  v_mfma_f32_16x16x32_bf16 v[88:91], v[24:27], v[136:139], v[88:91]
  ds_read_b128 v[48:51], v19 offset:16640
  v_mul_f32 v76, v12, v76
  v_mfma_f32_16x16x32_bf16 v[96:99], v[24:27], v[168:171], v[96:99]
  v_mul_f32 v77, v12, v77
  v_mul_f32 v78, v12, v78
  v_mfma_f32_16x16x32_bf16 v[104:107], v[24:27], v[200:203], v[104:107]
  v_mul_f32 v79, v12, v79
  v_mfma_f32_16x16x32_bf16 v[112:115], v[24:27], v[232:235], v[112:115]
  s_waitcnt lgkmcnt(5)
  v_cvt_pk_bf16_f32 v72, v72, v73
  v_mfma_f32_16x16x32_bf16 v[92:95], v[28:31], v[136:139], v[92:95]
  ds_read_b128 v[52:55], v19 offset:18688
  v_cvt_pk_bf16_f32 v73, v74, v75
  v_mfma_f32_16x16x32_bf16 v[100:103], v[28:31], v[168:171], v[100:103]
  v_cvt_pk_bf16_f32 v74, v76, v77
  v_cvt_pk_bf16_f32 v75, v78, v79
  v_mfma_f32_16x16x32_bf16 v[108:111], v[28:31], v[200:203], v[108:111]
  v_accvgpr_write_b32 a144, v72
  v_mfma_f32_16x16x32_bf16 v[116:119], v[28:31], v[232:235], v[116:119]
  s_waitcnt lgkmcnt(5)
  v_accvgpr_write_b32 a145, v73
  v_mfma_f32_16x16x32_bf16 v[88:91], v[32:35], v[140:143], v[88:91]
  s_waitcnt vmcnt(12)
  s_barrier
  ds_read_b128 v[24:27], v248 offset:0
  v_accvgpr_write_b32 a146, v74
  v_mfma_f32_16x16x32_bf16 v[96:99], v[32:35], v[172:175], v[96:99]
  v_accvgpr_write_b32 a147, v75
  v_mul_f32 v80, v12, v80
  v_mfma_f32_16x16x32_bf16 v[104:107], v[32:35], v[204:207], v[104:107]
  v_mul_f32 v81, v12, v81
  v_mfma_f32_16x16x32_bf16 v[112:115], v[32:35], v[236:239], v[112:115]
  s_waitcnt lgkmcnt(5)
  v_mul_f32 v82, v12, v82
  v_mfma_f32_16x16x32_bf16 v[92:95], v[36:39], v[140:143], v[92:95]
  ds_read_b128 v[28:31], v248 offset:2048
  v_mul_f32 v83, v12, v83
  v_mfma_f32_16x16x32_bf16 v[100:103], v[36:39], v[172:175], v[100:103]
  v_mul_f32 v84, v12, v84
  v_mul_f32 v85, v12, v85
  v_mfma_f32_16x16x32_bf16 v[108:111], v[36:39], v[204:207], v[108:111]
  v_mul_f32 v86, v12, v86
  v_mfma_f32_16x16x32_bf16 v[116:119], v[36:39], v[236:239], v[116:119]
  s_waitcnt lgkmcnt(5)
  v_mul_f32 v87, v12, v87
  v_mfma_f32_16x16x32_bf16 v[88:91], v[40:43], v[144:147], v[88:91]
  ds_read_b128 v[32:35], v249 offset:0
  v_cvt_pk_bf16_f32 v80, v80, v81
  v_mfma_f32_16x16x32_bf16 v[96:99], v[40:43], v[176:179], v[96:99]
  v_cvt_pk_bf16_f32 v81, v82, v83
  v_cvt_pk_bf16_f32 v82, v84, v85
  v_mfma_f32_16x16x32_bf16 v[104:107], v[40:43], v[208:211], v[104:107]
  v_cvt_pk_bf16_f32 v83, v86, v87
  v_mfma_f32_16x16x32_bf16 v[112:115], v[40:43], v[240:243], v[112:115]
  s_waitcnt lgkmcnt(5)
  v_accvgpr_write_b32 a200, v80
  v_mfma_f32_16x16x32_bf16 v[92:95], v[44:47], v[144:147], v[92:95]
  ds_read_b128 v[36:39], v249 offset:2048
  v_accvgpr_write_b32 a201, v81
  v_mfma_f32_16x16x32_bf16 v[100:103], v[44:47], v[176:179], v[100:103]
  v_accvgpr_write_b32 a202, v82
  v_accvgpr_write_b32 a203, v83
  v_mfma_f32_16x16x32_bf16 v[108:111], v[44:47], v[208:211], v[108:111]
  v_mfma_f32_16x16x32_bf16 v[116:119], v[44:47], v[240:243], v[116:119]
  s_waitcnt lgkmcnt(5)
  v_mfma_f32_16x16x32_bf16 v[88:91], v[48:51], v[148:151], v[88:91]
  ds_read_b128 v[40:43], v250 offset:0
  v_mfma_f32_16x16x32_bf16 v[96:99], v[48:51], v[180:183], v[96:99]
  v_mfma_f32_16x16x32_bf16 v[104:107], v[48:51], v[212:215], v[104:107]
  v_mfma_f32_16x16x32_bf16 v[112:115], v[48:51], v[244:247], v[112:115]
  s_waitcnt lgkmcnt(5)
  v_mfma_f32_16x16x32_bf16 v[92:95], v[52:55], v[148:151], v[92:95]
  ds_read_b128 v[44:47], v250 offset:2048
  v_mfma_f32_16x16x32_bf16 v[100:103], v[52:55], v[180:183], v[100:103]
  v_mfma_f32_16x16x32_bf16 v[108:111], v[52:55], v[212:215], v[108:111]
  v_mfma_f32_16x16x32_bf16 v[116:119], v[52:55], v[244:247], v[116:119]
  s_waitcnt lgkmcnt(5)
  v_mfma_f32_16x16x32_bf16 v[56:59], v[24:27], v[120:123], 0
  ds_read_b128 v[48:51], v251 offset:0
  v_mfma_f32_16x16x32_bf16 v[64:67], v[24:27], v[152:155], 0
  v_mfma_f32_16x16x32_bf16 v[72:75], v[24:27], v[184:187], 0
  v_mfma_f32_16x16x32_bf16 v[80:83], v[24:27], v[216:219], 0
  s_waitcnt lgkmcnt(5)
  v_mul_f32 v88, v12, v88
  v_mfma_f32_16x16x32_bf16 v[60:63], v[28:31], v[120:123], 0
  ds_read_b128 v[52:55], v251 offset:2048
  v_mul_f32 v89, v12, v89
  v_mfma_f32_16x16x32_bf16 v[68:71], v[28:31], v[152:155], 0
  v_mul_f32 v90, v12, v90
  v_mul_f32 v91, v12, v91
  v_mfma_f32_16x16x32_bf16 v[76:79], v[28:31], v[184:187], 0
  v_mul_f32 v92, v12, v92
  v_mfma_f32_16x16x32_bf16 v[84:87], v[28:31], v[216:219], 0
  s_waitcnt lgkmcnt(5)
  v_mul_f32 v93, v12, v93
  v_mfma_f32_16x16x32_bf16 v[56:59], v[32:35], v[124:127], v[56:59]
  ds_read_b128 v[24:27], v248 offset:256
  v_mul_f32 v94, v12, v94
  v_mfma_f32_16x16x32_bf16 v[64:67], v[32:35], v[156:159], v[64:67]
  v_mul_f32 v95, v12, v95
  v_cvt_pk_bf16_f32 v88, v88, v89
  v_mfma_f32_16x16x32_bf16 v[72:75], v[32:35], v[188:191], v[72:75]
  v_cvt_pk_bf16_f32 v89, v90, v91
  v_mfma_f32_16x16x32_bf16 v[80:83], v[32:35], v[220:223], v[80:83]
  s_waitcnt lgkmcnt(5)
  v_cvt_pk_bf16_f32 v90, v92, v93
  v_mfma_f32_16x16x32_bf16 v[60:63], v[36:39], v[124:127], v[60:63]
  ds_read_b128 v[28:31], v248 offset:2304
  v_cvt_pk_bf16_f32 v91, v94, v95
  v_mfma_f32_16x16x32_bf16 v[68:71], v[36:39], v[156:159], v[68:71]
  v_accvgpr_write_b32 a36, v88
  v_accvgpr_write_b32 a37, v89
  v_mfma_f32_16x16x32_bf16 v[76:79], v[36:39], v[188:191], v[76:79]
  v_accvgpr_write_b32 a38, v90
  v_mfma_f32_16x16x32_bf16 v[84:87], v[36:39], v[220:223], v[84:87]
  s_waitcnt lgkmcnt(5)
  v_accvgpr_write_b32 a39, v91
  v_mfma_f32_16x16x32_bf16 v[56:59], v[40:43], v[128:131], v[56:59]
  ds_read_b128 v[32:35], v249 offset:256
  v_mul_f32 v96, v12, v96
  v_mfma_f32_16x16x32_bf16 v[64:67], v[40:43], v[160:163], v[64:67]
  v_mul_f32 v97, v12, v97
  v_mul_f32 v98, v12, v98
  v_mfma_f32_16x16x32_bf16 v[72:75], v[40:43], v[192:195], v[72:75]
  v_mul_f32 v99, v12, v99
  v_mfma_f32_16x16x32_bf16 v[80:83], v[40:43], v[224:227], v[80:83]
  s_waitcnt lgkmcnt(5)
  v_mul_f32 v100, v12, v100
  v_mfma_f32_16x16x32_bf16 v[60:63], v[44:47], v[128:131], v[60:63]
  ds_read_b128 v[36:39], v249 offset:2304
  v_mul_f32 v101, v12, v101
  v_mfma_f32_16x16x32_bf16 v[68:71], v[44:47], v[160:163], v[68:71]
  v_mul_f32 v102, v12, v102
  v_mul_f32 v103, v12, v103
  v_mfma_f32_16x16x32_bf16 v[76:79], v[44:47], v[192:195], v[76:79]
  v_cvt_pk_bf16_f32 v96, v96, v97
  v_mfma_f32_16x16x32_bf16 v[84:87], v[44:47], v[224:227], v[84:87]
  s_waitcnt lgkmcnt(5)
  v_cvt_pk_bf16_f32 v97, v98, v99
  v_mfma_f32_16x16x32_bf16 v[56:59], v[48:51], v[132:135], v[56:59]
  ds_read_b128 v[40:43], v250 offset:256
  v_cvt_pk_bf16_f32 v98, v100, v101
  v_mfma_f32_16x16x32_bf16 v[64:67], v[48:51], v[164:167], v[64:67]
  v_cvt_pk_bf16_f32 v99, v102, v103
  v_accvgpr_write_b32 a92, v96
  v_mfma_f32_16x16x32_bf16 v[72:75], v[48:51], v[196:199], v[72:75]
  v_accvgpr_write_b32 a93, v97
  v_mfma_f32_16x16x32_bf16 v[80:83], v[48:51], v[228:231], v[80:83]
  s_waitcnt lgkmcnt(5)
  v_accvgpr_write_b32 a94, v98
  v_mfma_f32_16x16x32_bf16 v[60:63], v[52:55], v[132:135], v[60:63]
  ds_read_b128 v[44:47], v250 offset:2304
  v_accvgpr_write_b32 a95, v99
  v_mfma_f32_16x16x32_bf16 v[68:71], v[52:55], v[164:167], v[68:71]
  v_mul_f32 v104, v12, v104
  v_mul_f32 v105, v12, v105
  v_mfma_f32_16x16x32_bf16 v[76:79], v[52:55], v[196:199], v[76:79]
  v_mul_f32 v106, v12, v106
  v_mfma_f32_16x16x32_bf16 v[84:87], v[52:55], v[228:231], v[84:87]
  s_waitcnt lgkmcnt(5)
  v_mul_f32 v107, v12, v107
  v_mfma_f32_16x16x32_bf16 v[56:59], v[24:27], v[136:139], v[56:59]
  ds_read_b128 v[48:51], v251 offset:256
  v_mul_f32 v108, v12, v108
  v_mfma_f32_16x16x32_bf16 v[64:67], v[24:27], v[168:171], v[64:67]
  v_mul_f32 v109, v12, v109
  v_mul_f32 v110, v12, v110
  v_mfma_f32_16x16x32_bf16 v[72:75], v[24:27], v[200:203], v[72:75]
  v_mul_f32 v111, v12, v111
  v_mfma_f32_16x16x32_bf16 v[80:83], v[24:27], v[232:235], v[80:83]
  s_waitcnt lgkmcnt(5)
  v_cvt_pk_bf16_f32 v104, v104, v105
  v_mfma_f32_16x16x32_bf16 v[60:63], v[28:31], v[136:139], v[60:63]
  ds_read_b128 v[52:55], v251 offset:2304
  v_cvt_pk_bf16_f32 v105, v106, v107
  v_mfma_f32_16x16x32_bf16 v[68:71], v[28:31], v[168:171], v[68:71]
  v_cvt_pk_bf16_f32 v106, v108, v109
  v_cvt_pk_bf16_f32 v107, v110, v111
  v_mfma_f32_16x16x32_bf16 v[76:79], v[28:31], v[200:203], v[76:79]
  v_accvgpr_write_b32 a148, v104
  v_mfma_f32_16x16x32_bf16 v[84:87], v[28:31], v[232:235], v[84:87]
  s_waitcnt lgkmcnt(5)
  v_accvgpr_write_b32 a149, v105
  v_mfma_f32_16x16x32_bf16 v[56:59], v[32:35], v[140:143], v[56:59]
  s_waitcnt vmcnt(8)
  s_barrier
  ds_read_b128 v[24:27], v248 offset:16384
  v_accvgpr_write_b32 a150, v106
  v_mfma_f32_16x16x32_bf16 v[64:67], v[32:35], v[172:175], v[64:67]
  v_accvgpr_write_b32 a151, v107
  v_mul_f32 v112, v12, v112
  v_mfma_f32_16x16x32_bf16 v[72:75], v[32:35], v[204:207], v[72:75]
  v_mul_f32 v113, v12, v113
  v_mfma_f32_16x16x32_bf16 v[80:83], v[32:35], v[236:239], v[80:83]
  s_waitcnt lgkmcnt(5)
  v_mul_f32 v114, v12, v114
  v_mfma_f32_16x16x32_bf16 v[60:63], v[36:39], v[140:143], v[60:63]
  ds_read_b128 v[28:31], v248 offset:18432
  v_mul_f32 v115, v12, v115
  v_mfma_f32_16x16x32_bf16 v[68:71], v[36:39], v[172:175], v[68:71]
  v_mul_f32 v116, v12, v116
  v_mul_f32 v117, v12, v117
  v_mfma_f32_16x16x32_bf16 v[76:79], v[36:39], v[204:207], v[76:79]
  v_mul_f32 v118, v12, v118
  v_mfma_f32_16x16x32_bf16 v[84:87], v[36:39], v[236:239], v[84:87]
  s_waitcnt lgkmcnt(5)
  v_mul_f32 v119, v12, v119
  v_mfma_f32_16x16x32_bf16 v[56:59], v[40:43], v[144:147], v[56:59]
  ds_read_b128 v[32:35], v249 offset:16384
  v_cvt_pk_bf16_f32 v112, v112, v113
  v_mfma_f32_16x16x32_bf16 v[64:67], v[40:43], v[176:179], v[64:67]
  v_cvt_pk_bf16_f32 v113, v114, v115
  v_cvt_pk_bf16_f32 v114, v116, v117
  v_mfma_f32_16x16x32_bf16 v[72:75], v[40:43], v[208:211], v[72:75]
  v_cvt_pk_bf16_f32 v115, v118, v119
  v_mfma_f32_16x16x32_bf16 v[80:83], v[40:43], v[240:243], v[80:83]
  s_waitcnt lgkmcnt(5)
  v_accvgpr_write_b32 a204, v112
  v_mfma_f32_16x16x32_bf16 v[60:63], v[44:47], v[144:147], v[60:63]
  ds_read_b128 v[36:39], v249 offset:18432
  v_accvgpr_write_b32 a205, v113
  v_mfma_f32_16x16x32_bf16 v[68:71], v[44:47], v[176:179], v[68:71]
  v_accvgpr_write_b32 a206, v114
  v_accvgpr_write_b32 a207, v115
  v_mfma_f32_16x16x32_bf16 v[76:79], v[44:47], v[208:211], v[76:79]
  v_mfma_f32_16x16x32_bf16 v[84:87], v[44:47], v[240:243], v[84:87]
  s_waitcnt lgkmcnt(5)
  v_mfma_f32_16x16x32_bf16 v[56:59], v[48:51], v[148:151], v[56:59]
  ds_read_b128 v[40:43], v250 offset:16384
  v_mfma_f32_16x16x32_bf16 v[64:67], v[48:51], v[180:183], v[64:67]
  v_mfma_f32_16x16x32_bf16 v[72:75], v[48:51], v[212:215], v[72:75]
  v_mfma_f32_16x16x32_bf16 v[80:83], v[48:51], v[244:247], v[80:83]
  s_waitcnt lgkmcnt(5)
  v_mfma_f32_16x16x32_bf16 v[60:63], v[52:55], v[148:151], v[60:63]
  ds_read_b128 v[44:47], v250 offset:18432
  v_mfma_f32_16x16x32_bf16 v[68:71], v[52:55], v[180:183], v[68:71]
  v_mfma_f32_16x16x32_bf16 v[76:79], v[52:55], v[212:215], v[76:79]
  v_mfma_f32_16x16x32_bf16 v[84:87], v[52:55], v[244:247], v[84:87]
  s_waitcnt lgkmcnt(5)
  v_mfma_f32_16x16x32_bf16 v[88:91], v[24:27], v[120:123], 0
  ds_read_b128 v[48:51], v251 offset:16384
  v_mfma_f32_16x16x32_bf16 v[96:99], v[24:27], v[152:155], 0
  v_mfma_f32_16x16x32_bf16 v[104:107], v[24:27], v[184:187], 0
  v_mfma_f32_16x16x32_bf16 v[112:115], v[24:27], v[216:219], 0
  s_waitcnt lgkmcnt(5)
  v_mul_f32 v56, v12, v56
  v_mfma_f32_16x16x32_bf16 v[92:95], v[28:31], v[120:123], 0
  ds_read_b128 v[52:55], v251 offset:18432
  v_mul_f32 v57, v12, v57
  v_mfma_f32_16x16x32_bf16 v[100:103], v[28:31], v[152:155], 0
  v_mul_f32 v58, v12, v58
  v_mul_f32 v59, v12, v59
  v_mfma_f32_16x16x32_bf16 v[108:111], v[28:31], v[184:187], 0
  v_mul_f32 v60, v12, v60
  v_mfma_f32_16x16x32_bf16 v[116:119], v[28:31], v[216:219], 0
  s_waitcnt lgkmcnt(5)
  v_mul_f32 v61, v12, v61
  v_mfma_f32_16x16x32_bf16 v[88:91], v[32:35], v[124:127], v[88:91]
  ds_read_b128 v[24:27], v248 offset:16640
  v_mul_f32 v62, v12, v62
  v_mfma_f32_16x16x32_bf16 v[96:99], v[32:35], v[156:159], v[96:99]
  v_mul_f32 v63, v12, v63
  v_cvt_pk_bf16_f32 v56, v56, v57
  v_mfma_f32_16x16x32_bf16 v[104:107], v[32:35], v[188:191], v[104:107]
  v_cvt_pk_bf16_f32 v57, v58, v59
  v_mfma_f32_16x16x32_bf16 v[112:115], v[32:35], v[220:223], v[112:115]
  s_waitcnt lgkmcnt(5)
  v_cvt_pk_bf16_f32 v58, v60, v61
  v_mfma_f32_16x16x32_bf16 v[92:95], v[36:39], v[124:127], v[92:95]
  ds_read_b128 v[28:31], v248 offset:18688
  v_cvt_pk_bf16_f32 v59, v62, v63
  v_mfma_f32_16x16x32_bf16 v[100:103], v[36:39], v[156:159], v[100:103]
  v_accvgpr_write_b32 a40, v56
  v_accvgpr_write_b32 a41, v57
  v_mfma_f32_16x16x32_bf16 v[108:111], v[36:39], v[188:191], v[108:111]
  v_accvgpr_write_b32 a42, v58
  v_mfma_f32_16x16x32_bf16 v[116:119], v[36:39], v[220:223], v[116:119]
  s_waitcnt lgkmcnt(5)
  v_accvgpr_write_b32 a43, v59
  v_mfma_f32_16x16x32_bf16 v[88:91], v[40:43], v[128:131], v[88:91]
  ds_read_b128 v[32:35], v249 offset:16640
  v_mul_f32 v64, v12, v64
  v_mfma_f32_16x16x32_bf16 v[96:99], v[40:43], v[160:163], v[96:99]
  v_mul_f32 v65, v12, v65
  v_mul_f32 v66, v12, v66
  v_mfma_f32_16x16x32_bf16 v[104:107], v[40:43], v[192:195], v[104:107]
  v_mul_f32 v67, v12, v67
  v_mfma_f32_16x16x32_bf16 v[112:115], v[40:43], v[224:227], v[112:115]
  s_waitcnt lgkmcnt(5)
  v_mul_f32 v68, v12, v68
  v_mfma_f32_16x16x32_bf16 v[92:95], v[44:47], v[128:131], v[92:95]
  ds_read_b128 v[36:39], v249 offset:18688
  v_mul_f32 v69, v12, v69
  v_mfma_f32_16x16x32_bf16 v[100:103], v[44:47], v[160:163], v[100:103]
  v_mul_f32 v70, v12, v70
  v_mul_f32 v71, v12, v71
  v_mfma_f32_16x16x32_bf16 v[108:111], v[44:47], v[192:195], v[108:111]
  v_cvt_pk_bf16_f32 v64, v64, v65
  v_mfma_f32_16x16x32_bf16 v[116:119], v[44:47], v[224:227], v[116:119]
  s_waitcnt lgkmcnt(5)
  v_cvt_pk_bf16_f32 v65, v66, v67
  v_mfma_f32_16x16x32_bf16 v[88:91], v[48:51], v[132:135], v[88:91]
  ds_read_b128 v[40:43], v250 offset:16640
  v_cvt_pk_bf16_f32 v66, v68, v69
  v_mfma_f32_16x16x32_bf16 v[96:99], v[48:51], v[164:167], v[96:99]
  v_cvt_pk_bf16_f32 v67, v70, v71
  v_accvgpr_write_b32 a96, v64
  v_mfma_f32_16x16x32_bf16 v[104:107], v[48:51], v[196:199], v[104:107]
  v_accvgpr_write_b32 a97, v65
  v_mfma_f32_16x16x32_bf16 v[112:115], v[48:51], v[228:231], v[112:115]
  s_waitcnt lgkmcnt(5)
  v_accvgpr_write_b32 a98, v66
  v_mfma_f32_16x16x32_bf16 v[92:95], v[52:55], v[132:135], v[92:95]
  ds_read_b128 v[44:47], v250 offset:18688
  v_accvgpr_write_b32 a99, v67
  v_mfma_f32_16x16x32_bf16 v[100:103], v[52:55], v[164:167], v[100:103]
  v_mul_f32 v72, v12, v72
  v_mul_f32 v73, v12, v73
  v_mfma_f32_16x16x32_bf16 v[108:111], v[52:55], v[196:199], v[108:111]
  v_mul_f32 v74, v12, v74
  v_mfma_f32_16x16x32_bf16 v[116:119], v[52:55], v[228:231], v[116:119]
  s_waitcnt lgkmcnt(5)
  v_mul_f32 v75, v12, v75
  v_mfma_f32_16x16x32_bf16 v[88:91], v[24:27], v[136:139], v[88:91]
  ds_read_b128 v[48:51], v251 offset:16640
  v_mul_f32 v76, v12, v76
  v_mfma_f32_16x16x32_bf16 v[96:99], v[24:27], v[168:171], v[96:99]
  v_mul_f32 v77, v12, v77
  v_mul_f32 v78, v12, v78
  v_mfma_f32_16x16x32_bf16 v[104:107], v[24:27], v[200:203], v[104:107]
  v_mul_f32 v79, v12, v79
  v_mfma_f32_16x16x32_bf16 v[112:115], v[24:27], v[232:235], v[112:115]
  s_waitcnt lgkmcnt(5)
  v_cvt_pk_bf16_f32 v72, v72, v73
  v_mfma_f32_16x16x32_bf16 v[92:95], v[28:31], v[136:139], v[92:95]
  ds_read_b128 v[52:55], v251 offset:18688
  v_cvt_pk_bf16_f32 v73, v74, v75
  v_mfma_f32_16x16x32_bf16 v[100:103], v[28:31], v[168:171], v[100:103]
  v_cvt_pk_bf16_f32 v74, v76, v77
  v_cvt_pk_bf16_f32 v75, v78, v79
  v_mfma_f32_16x16x32_bf16 v[108:111], v[28:31], v[200:203], v[108:111]
  v_accvgpr_write_b32 a152, v72
  v_mfma_f32_16x16x32_bf16 v[116:119], v[28:31], v[232:235], v[116:119]
  s_waitcnt lgkmcnt(5)
  v_accvgpr_write_b32 a153, v73
  v_mfma_f32_16x16x32_bf16 v[88:91], v[32:35], v[140:143], v[88:91]
  s_waitcnt vmcnt(4)
  s_barrier
  ds_read_b128 v[24:27], v248 offset:32768
  v_accvgpr_write_b32 a154, v74
  v_mfma_f32_16x16x32_bf16 v[96:99], v[32:35], v[172:175], v[96:99]
  v_accvgpr_write_b32 a155, v75
  v_mul_f32 v80, v12, v80
  v_mfma_f32_16x16x32_bf16 v[104:107], v[32:35], v[204:207], v[104:107]
  v_mul_f32 v81, v12, v81
  v_mfma_f32_16x16x32_bf16 v[112:115], v[32:35], v[236:239], v[112:115]
  s_waitcnt lgkmcnt(5)
  v_mul_f32 v82, v12, v82
  v_mfma_f32_16x16x32_bf16 v[92:95], v[36:39], v[140:143], v[92:95]
  ds_read_b128 v[28:31], v248 offset:34816
  v_mul_f32 v83, v12, v83
  v_mfma_f32_16x16x32_bf16 v[100:103], v[36:39], v[172:175], v[100:103]
  v_mul_f32 v84, v12, v84
  v_mul_f32 v85, v12, v85
  v_mfma_f32_16x16x32_bf16 v[108:111], v[36:39], v[204:207], v[108:111]
  v_mul_f32 v86, v12, v86
  v_mfma_f32_16x16x32_bf16 v[116:119], v[36:39], v[236:239], v[116:119]
  s_waitcnt lgkmcnt(5)
  v_mul_f32 v87, v12, v87
  v_mfma_f32_16x16x32_bf16 v[88:91], v[40:43], v[144:147], v[88:91]
  ds_read_b128 v[32:35], v249 offset:32768
  v_cvt_pk_bf16_f32 v80, v80, v81
  v_mfma_f32_16x16x32_bf16 v[96:99], v[40:43], v[176:179], v[96:99]
  v_cvt_pk_bf16_f32 v81, v82, v83
  v_cvt_pk_bf16_f32 v82, v84, v85
  v_mfma_f32_16x16x32_bf16 v[104:107], v[40:43], v[208:211], v[104:107]
  v_cvt_pk_bf16_f32 v83, v86, v87
  v_mfma_f32_16x16x32_bf16 v[112:115], v[40:43], v[240:243], v[112:115]
  s_waitcnt lgkmcnt(5)
  v_accvgpr_write_b32 a208, v80
  v_mfma_f32_16x16x32_bf16 v[92:95], v[44:47], v[144:147], v[92:95]
  ds_read_b128 v[36:39], v249 offset:34816
  v_accvgpr_write_b32 a209, v81
  v_mfma_f32_16x16x32_bf16 v[100:103], v[44:47], v[176:179], v[100:103]
  v_accvgpr_write_b32 a210, v82
  v_accvgpr_write_b32 a211, v83
  v_mfma_f32_16x16x32_bf16 v[108:111], v[44:47], v[208:211], v[108:111]
  v_mfma_f32_16x16x32_bf16 v[116:119], v[44:47], v[240:243], v[116:119]
  s_waitcnt lgkmcnt(5)
  v_mfma_f32_16x16x32_bf16 v[88:91], v[48:51], v[148:151], v[88:91]
  ds_read_b128 v[40:43], v250 offset:32768
  v_mfma_f32_16x16x32_bf16 v[96:99], v[48:51], v[180:183], v[96:99]
  v_mfma_f32_16x16x32_bf16 v[104:107], v[48:51], v[212:215], v[104:107]
  v_mfma_f32_16x16x32_bf16 v[112:115], v[48:51], v[244:247], v[112:115]
  s_waitcnt lgkmcnt(5)
  v_mfma_f32_16x16x32_bf16 v[92:95], v[52:55], v[148:151], v[92:95]
  ds_read_b128 v[44:47], v250 offset:34816
  v_mfma_f32_16x16x32_bf16 v[100:103], v[52:55], v[180:183], v[100:103]
  v_mfma_f32_16x16x32_bf16 v[108:111], v[52:55], v[212:215], v[108:111]
  v_mfma_f32_16x16x32_bf16 v[116:119], v[52:55], v[244:247], v[116:119]
  s_waitcnt lgkmcnt(5)
  v_mfma_f32_16x16x32_bf16 v[56:59], v[24:27], v[120:123], 0
  ds_read_b128 v[48:51], v251 offset:32768
  v_mfma_f32_16x16x32_bf16 v[64:67], v[24:27], v[152:155], 0
  v_mfma_f32_16x16x32_bf16 v[72:75], v[24:27], v[184:187], 0
  v_mfma_f32_16x16x32_bf16 v[80:83], v[24:27], v[216:219], 0
  s_waitcnt lgkmcnt(5)
  v_mul_f32 v88, v12, v88
  v_mfma_f32_16x16x32_bf16 v[60:63], v[28:31], v[120:123], 0
  ds_read_b128 v[52:55], v251 offset:34816
  v_mul_f32 v89, v12, v89
  v_mfma_f32_16x16x32_bf16 v[68:71], v[28:31], v[152:155], 0
  v_mul_f32 v90, v12, v90
  v_mul_f32 v91, v12, v91
  v_mfma_f32_16x16x32_bf16 v[76:79], v[28:31], v[184:187], 0
  v_mul_f32 v92, v12, v92
  v_mfma_f32_16x16x32_bf16 v[84:87], v[28:31], v[216:219], 0
  s_waitcnt lgkmcnt(5)
  v_mul_f32 v93, v12, v93
  v_mfma_f32_16x16x32_bf16 v[56:59], v[32:35], v[124:127], v[56:59]
  ds_read_b128 v[24:27], v248 offset:33024
  v_mul_f32 v94, v12, v94
  v_mfma_f32_16x16x32_bf16 v[64:67], v[32:35], v[156:159], v[64:67]
  v_mul_f32 v95, v12, v95
  v_cvt_pk_bf16_f32 v88, v88, v89
  v_mfma_f32_16x16x32_bf16 v[72:75], v[32:35], v[188:191], v[72:75]
  v_mfma_f32_16x16x32_bf16 v[80:83], v[32:35], v[220:223], v[80:83]
  s_waitcnt lgkmcnt(5)
  v_cvt_pk_bf16_f32 v89, v90, v91
  v_mfma_f32_16x16x32_bf16 v[60:63], v[36:39], v[124:127], v[60:63]
  ds_read_b128 v[28:31], v248 offset:35072
  v_cvt_pk_bf16_f32 v90, v92, v93
  v_mfma_f32_16x16x32_bf16 v[68:71], v[36:39], v[156:159], v[68:71]
  v_cvt_pk_bf16_f32 v91, v94, v95
  v_accvgpr_write_b32 a44, v88
  v_mfma_f32_16x16x32_bf16 v[76:79], v[36:39], v[188:191], v[76:79]
  v_accvgpr_write_b32 a45, v89
  v_mfma_f32_16x16x32_bf16 v[84:87], v[36:39], v[220:223], v[84:87]
  s_waitcnt lgkmcnt(5)
  v_accvgpr_write_b32 a46, v90
  v_mfma_f32_16x16x32_bf16 v[56:59], v[40:43], v[128:131], v[56:59]
  ds_read_b128 v[32:35], v249 offset:33024
  v_accvgpr_write_b32 a47, v91
  v_mfma_f32_16x16x32_bf16 v[64:67], v[40:43], v[160:163], v[64:67]
  v_mul_f32 v96, v12, v96
  v_mul_f32 v97, v12, v97
  v_mfma_f32_16x16x32_bf16 v[72:75], v[40:43], v[192:195], v[72:75]
  v_mfma_f32_16x16x32_bf16 v[80:83], v[40:43], v[224:227], v[80:83]
  s_waitcnt lgkmcnt(5)
  v_mul_f32 v98, v12, v98
  v_mfma_f32_16x16x32_bf16 v[60:63], v[44:47], v[128:131], v[60:63]
  ds_read_b128 v[36:39], v249 offset:35072
  v_mul_f32 v99, v12, v99
  v_mfma_f32_16x16x32_bf16 v[68:71], v[44:47], v[160:163], v[68:71]
  v_mul_f32 v100, v12, v100
  v_mul_f32 v101, v12, v101
  v_mfma_f32_16x16x32_bf16 v[76:79], v[44:47], v[192:195], v[76:79]
  v_mul_f32 v102, v12, v102
  v_mfma_f32_16x16x32_bf16 v[84:87], v[44:47], v[224:227], v[84:87]
  s_waitcnt lgkmcnt(5)
  v_mul_f32 v103, v12, v103
  v_mfma_f32_16x16x32_bf16 v[56:59], v[48:51], v[132:135], v[56:59]
  ds_read_b128 v[40:43], v250 offset:33024
  v_cvt_pk_bf16_f32 v96, v96, v97
  v_mfma_f32_16x16x32_bf16 v[64:67], v[48:51], v[164:167], v[64:67]
  v_cvt_pk_bf16_f32 v97, v98, v99
  v_cvt_pk_bf16_f32 v98, v100, v101
  v_mfma_f32_16x16x32_bf16 v[72:75], v[48:51], v[196:199], v[72:75]
  v_mfma_f32_16x16x32_bf16 v[80:83], v[48:51], v[228:231], v[80:83]
  s_waitcnt lgkmcnt(5)
  v_cvt_pk_bf16_f32 v99, v102, v103
  v_mfma_f32_16x16x32_bf16 v[60:63], v[52:55], v[132:135], v[60:63]
  ds_read_b128 v[44:47], v250 offset:35072
  v_accvgpr_write_b32 a100, v96
  v_mfma_f32_16x16x32_bf16 v[68:71], v[52:55], v[164:167], v[68:71]
  v_accvgpr_write_b32 a101, v97
  v_accvgpr_write_b32 a102, v98
  v_mfma_f32_16x16x32_bf16 v[76:79], v[52:55], v[196:199], v[76:79]
  v_accvgpr_write_b32 a103, v99
  v_mfma_f32_16x16x32_bf16 v[84:87], v[52:55], v[228:231], v[84:87]
  s_waitcnt lgkmcnt(5)
  v_mul_f32 v104, v12, v104
  v_mfma_f32_16x16x32_bf16 v[56:59], v[24:27], v[136:139], v[56:59]
  ds_read_b128 v[48:51], v251 offset:33024
  v_mul_f32 v105, v12, v105
  v_mfma_f32_16x16x32_bf16 v[64:67], v[24:27], v[168:171], v[64:67]
  v_mul_f32 v106, v12, v106
  v_mul_f32 v107, v12, v107
  v_mfma_f32_16x16x32_bf16 v[72:75], v[24:27], v[200:203], v[72:75]
  v_mfma_f32_16x16x32_bf16 v[80:83], v[24:27], v[232:235], v[80:83]
  s_waitcnt lgkmcnt(5)
  v_mul_f32 v108, v12, v108
  v_mfma_f32_16x16x32_bf16 v[60:63], v[28:31], v[136:139], v[60:63]
  ds_read_b128 v[52:55], v251 offset:35072
  v_mul_f32 v109, v12, v109
  v_mfma_f32_16x16x32_bf16 v[68:71], v[28:31], v[168:171], v[68:71]
  v_mul_f32 v110, v12, v110
  v_mul_f32 v111, v12, v111
  v_mfma_f32_16x16x32_bf16 v[76:79], v[28:31], v[200:203], v[76:79]
  v_cvt_pk_bf16_f32 v104, v104, v105
  v_mfma_f32_16x16x32_bf16 v[84:87], v[28:31], v[232:235], v[84:87]
  s_waitcnt lgkmcnt(5)
  v_cvt_pk_bf16_f32 v105, v106, v107
  v_mfma_f32_16x16x32_bf16 v[56:59], v[32:35], v[140:143], v[56:59]
  s_waitcnt vmcnt(0)
  s_barrier
  ds_read_b128 v[24:27], v248 offset:49152
  v_cvt_pk_bf16_f32 v106, v108, v109
  v_mfma_f32_16x16x32_bf16 v[64:67], v[32:35], v[172:175], v[64:67]
  v_cvt_pk_bf16_f32 v107, v110, v111
  v_accvgpr_write_b32 a156, v104
  v_mfma_f32_16x16x32_bf16 v[72:75], v[32:35], v[204:207], v[72:75]
  v_mfma_f32_16x16x32_bf16 v[80:83], v[32:35], v[236:239], v[80:83]
  s_waitcnt lgkmcnt(5)
  v_accvgpr_write_b32 a157, v105
  v_mfma_f32_16x16x32_bf16 v[60:63], v[36:39], v[140:143], v[60:63]
  ds_read_b128 v[28:31], v248 offset:51200
  v_accvgpr_write_b32 a158, v106
  v_mfma_f32_16x16x32_bf16 v[68:71], v[36:39], v[172:175], v[68:71]
  v_accvgpr_write_b32 a159, v107
  v_mul_f32 v112, v12, v112
  v_mfma_f32_16x16x32_bf16 v[76:79], v[36:39], v[204:207], v[76:79]
  v_mul_f32 v113, v12, v113
  v_mfma_f32_16x16x32_bf16 v[84:87], v[36:39], v[236:239], v[84:87]
  s_waitcnt lgkmcnt(5)
  v_mul_f32 v114, v12, v114
  v_mfma_f32_16x16x32_bf16 v[56:59], v[40:43], v[144:147], v[56:59]
  ds_read_b128 v[32:35], v249 offset:49152
  v_mul_f32 v115, v12, v115
  v_mfma_f32_16x16x32_bf16 v[64:67], v[40:43], v[176:179], v[64:67]
  v_mul_f32 v116, v12, v116
  v_mul_f32 v117, v12, v117
  v_mfma_f32_16x16x32_bf16 v[72:75], v[40:43], v[208:211], v[72:75]
  v_readfirstlane_b32 s86, v13
  s_lshl_b32 s22, s17, 7
  s_add_u32 s22, s22, 584192
  s_mov_b32 s23, 586240
  buffer_load_dword v13, off, s[8:11], s22 sc1
  buffer_load_dwordx2 v[10:11], off, s[8:11], s23 sc1
  v_mfma_f32_16x16x32_bf16 v[80:83], v[40:43], v[240:243], v[80:83]
  s_waitcnt lgkmcnt(5)
  v_mul_f32 v118, v12, v118
  v_mfma_f32_16x16x32_bf16 v[60:63], v[44:47], v[144:147], v[60:63]
  ds_read_b128 v[36:39], v249 offset:51200
  v_mul_f32 v119, v12, v119
  v_mfma_f32_16x16x32_bf16 v[68:71], v[44:47], v[176:179], v[68:71]
  v_cvt_pk_bf16_f32 v112, v112, v113
  v_cvt_pk_bf16_f32 v113, v114, v115
  v_mfma_f32_16x16x32_bf16 v[76:79], v[44:47], v[208:211], v[76:79]
  v_cvt_pk_bf16_f32 v114, v116, v117
  v_mfma_f32_16x16x32_bf16 v[84:87], v[44:47], v[240:243], v[84:87]
  s_waitcnt lgkmcnt(5)
  v_cvt_pk_bf16_f32 v115, v118, v119
  v_mfma_f32_16x16x32_bf16 v[56:59], v[48:51], v[148:151], v[56:59]
  ds_read_b128 v[40:43], v250 offset:49152
  v_accvgpr_write_b32 a212, v112
  v_mfma_f32_16x16x32_bf16 v[64:67], v[48:51], v[180:183], v[64:67]
  v_accvgpr_write_b32 a213, v113
  v_accvgpr_write_b32 a214, v114
  v_mfma_f32_16x16x32_bf16 v[72:75], v[48:51], v[212:215], v[72:75]
  v_accvgpr_write_b32 a215, v115
  v_mfma_f32_16x16x32_bf16 v[80:83], v[48:51], v[244:247], v[80:83]
  s_waitcnt lgkmcnt(5)
  v_mfma_f32_16x16x32_bf16 v[60:63], v[52:55], v[148:151], v[60:63]
  ds_read_b128 v[44:47], v250 offset:51200
  v_mfma_f32_16x16x32_bf16 v[68:71], v[52:55], v[180:183], v[68:71]
  v_mfma_f32_16x16x32_bf16 v[76:79], v[52:55], v[212:215], v[76:79]
  v_mfma_f32_16x16x32_bf16 v[84:87], v[52:55], v[244:247], v[84:87]
  s_waitcnt lgkmcnt(5)
  v_mfma_f32_16x16x32_bf16 v[88:91], v[24:27], v[120:123], 0
  ds_read_b128 v[48:51], v251 offset:49152
  v_mfma_f32_16x16x32_bf16 v[96:99], v[24:27], v[152:155], 0
  v_mfma_f32_16x16x32_bf16 v[104:107], v[24:27], v[184:187], 0
  v_mfma_f32_16x16x32_bf16 v[112:115], v[24:27], v[216:219], 0
  s_waitcnt lgkmcnt(5)
  v_mul_f32 v56, v12, v56
  v_mfma_f32_16x16x32_bf16 v[92:95], v[28:31], v[120:123], 0
  ds_read_b128 v[52:55], v251 offset:51200
  v_mul_f32 v57, v12, v57
  v_mfma_f32_16x16x32_bf16 v[100:103], v[28:31], v[152:155], 0
  v_mul_f32 v58, v12, v58
  v_mul_f32 v59, v12, v59
  v_mfma_f32_16x16x32_bf16 v[108:111], v[28:31], v[184:187], 0
  v_mul_f32 v60, v12, v60
  v_mfma_f32_16x16x32_bf16 v[116:119], v[28:31], v[216:219], 0
  s_waitcnt lgkmcnt(5)
  v_mul_f32 v61, v12, v61
  v_mfma_f32_16x16x32_bf16 v[88:91], v[32:35], v[124:127], v[88:91]
  ds_read_b128 v[24:27], v248 offset:49408
  v_mul_f32 v62, v12, v62
  v_mfma_f32_16x16x32_bf16 v[96:99], v[32:35], v[156:159], v[96:99]
  v_mul_f32 v63, v12, v63
  v_cvt_pk_bf16_f32 v56, v56, v57
  v_mfma_f32_16x16x32_bf16 v[104:107], v[32:35], v[188:191], v[104:107]
  v_cvt_pk_bf16_f32 v57, v58, v59
  v_mfma_f32_16x16x32_bf16 v[112:115], v[32:35], v[220:223], v[112:115]
  s_waitcnt lgkmcnt(5)
  v_cvt_pk_bf16_f32 v58, v60, v61
  v_mfma_f32_16x16x32_bf16 v[92:95], v[36:39], v[124:127], v[92:95]
  ds_read_b128 v[28:31], v248 offset:51456
  v_cvt_pk_bf16_f32 v59, v62, v63
  v_mfma_f32_16x16x32_bf16 v[100:103], v[36:39], v[156:159], v[100:103]
  v_accvgpr_write_b32 a48, v56
  v_accvgpr_write_b32 a49, v57
  v_mfma_f32_16x16x32_bf16 v[108:111], v[36:39], v[188:191], v[108:111]
  v_accvgpr_write_b32 a50, v58
  v_mfma_f32_16x16x32_bf16 v[116:119], v[36:39], v[220:223], v[116:119]
  s_waitcnt lgkmcnt(5)
  v_accvgpr_write_b32 a51, v59
  v_mfma_f32_16x16x32_bf16 v[88:91], v[40:43], v[128:131], v[88:91]
  ds_read_b128 v[32:35], v249 offset:49408
  v_mul_f32 v64, v12, v64
  v_mfma_f32_16x16x32_bf16 v[96:99], v[40:43], v[160:163], v[96:99]
  v_mul_f32 v65, v12, v65
  v_mul_f32 v66, v12, v66
  v_mfma_f32_16x16x32_bf16 v[104:107], v[40:43], v[192:195], v[104:107]
  v_mul_f32 v67, v12, v67
  v_mfma_f32_16x16x32_bf16 v[112:115], v[40:43], v[224:227], v[112:115]
  s_waitcnt lgkmcnt(5)
  v_mul_f32 v68, v12, v68
  v_mfma_f32_16x16x32_bf16 v[92:95], v[44:47], v[128:131], v[92:95]
  ds_read_b128 v[36:39], v249 offset:51456
  v_mul_f32 v69, v12, v69
  v_mfma_f32_16x16x32_bf16 v[100:103], v[44:47], v[160:163], v[100:103]
  v_mul_f32 v70, v12, v70
  v_mul_f32 v71, v12, v71
  v_mfma_f32_16x16x32_bf16 v[108:111], v[44:47], v[192:195], v[108:111]
  v_cvt_pk_bf16_f32 v64, v64, v65
  v_mfma_f32_16x16x32_bf16 v[116:119], v[44:47], v[224:227], v[116:119]
  s_waitcnt lgkmcnt(5)
  v_cvt_pk_bf16_f32 v65, v66, v67
  v_mfma_f32_16x16x32_bf16 v[88:91], v[48:51], v[132:135], v[88:91]
  ds_read_b128 v[40:43], v250 offset:49408
  v_cvt_pk_bf16_f32 v66, v68, v69
  v_mfma_f32_16x16x32_bf16 v[96:99], v[48:51], v[164:167], v[96:99]
  v_cvt_pk_bf16_f32 v67, v70, v71
  v_accvgpr_write_b32 a104, v64
  v_mfma_f32_16x16x32_bf16 v[104:107], v[48:51], v[196:199], v[104:107]
  v_accvgpr_write_b32 a105, v65
  v_mfma_f32_16x16x32_bf16 v[112:115], v[48:51], v[228:231], v[112:115]
  s_waitcnt lgkmcnt(5)
  v_accvgpr_write_b32 a106, v66
  v_mfma_f32_16x16x32_bf16 v[92:95], v[52:55], v[132:135], v[92:95]
  ds_read_b128 v[44:47], v250 offset:51456
  v_accvgpr_write_b32 a107, v67
  v_mfma_f32_16x16x32_bf16 v[100:103], v[52:55], v[164:167], v[100:103]
  v_mul_f32 v72, v12, v72
  v_mul_f32 v73, v12, v73
  v_mfma_f32_16x16x32_bf16 v[108:111], v[52:55], v[196:199], v[108:111]
  v_mul_f32 v74, v12, v74
  v_mfma_f32_16x16x32_bf16 v[116:119], v[52:55], v[228:231], v[116:119]
  s_waitcnt lgkmcnt(5)
  v_mul_f32 v75, v12, v75
  v_mfma_f32_16x16x32_bf16 v[88:91], v[24:27], v[136:139], v[88:91]
  ds_read_b128 v[48:51], v251 offset:49408
  v_mul_f32 v76, v12, v76
  v_mfma_f32_16x16x32_bf16 v[96:99], v[24:27], v[168:171], v[96:99]
  v_mul_f32 v77, v12, v77
  v_mul_f32 v78, v12, v78
  v_mfma_f32_16x16x32_bf16 v[104:107], v[24:27], v[200:203], v[104:107]
  v_mul_f32 v79, v12, v79
  v_mfma_f32_16x16x32_bf16 v[112:115], v[24:27], v[232:235], v[112:115]
  s_waitcnt lgkmcnt(5)
  v_cvt_pk_bf16_f32 v72, v72, v73
  v_mfma_f32_16x16x32_bf16 v[92:95], v[28:31], v[136:139], v[92:95]
  ds_read_b128 v[52:55], v251 offset:51456
  v_cvt_pk_bf16_f32 v73, v74, v75
  v_mfma_f32_16x16x32_bf16 v[100:103], v[28:31], v[168:171], v[100:103]
  v_cvt_pk_bf16_f32 v74, v76, v77
  v_cvt_pk_bf16_f32 v75, v78, v79
  v_mfma_f32_16x16x32_bf16 v[108:111], v[28:31], v[200:203], v[108:111]
  v_accvgpr_write_b32 a160, v72
  v_mfma_f32_16x16x32_bf16 v[116:119], v[28:31], v[232:235], v[116:119]
  s_waitcnt lgkmcnt(5)
  v_accvgpr_write_b32 a161, v73
  v_mfma_f32_16x16x32_bf16 v[88:91], v[32:35], v[140:143], v[88:91]
  v_accvgpr_write_b32 a162, v74
  v_mfma_f32_16x16x32_bf16 v[96:99], v[32:35], v[172:175], v[96:99]
  v_accvgpr_write_b32 a163, v75
  v_mul_f32 v80, v12, v80
  v_mfma_f32_16x16x32_bf16 v[104:107], v[32:35], v[204:207], v[104:107]
  v_mul_f32 v81, v12, v81
  v_mfma_f32_16x16x32_bf16 v[112:115], v[32:35], v[236:239], v[112:115]
  s_waitcnt lgkmcnt(4)
  v_mul_f32 v82, v12, v82
  v_mfma_f32_16x16x32_bf16 v[92:95], v[36:39], v[140:143], v[92:95]
  v_mul_f32 v83, v12, v83
  v_mfma_f32_16x16x32_bf16 v[100:103], v[36:39], v[172:175], v[100:103]
  v_mul_f32 v84, v12, v84
  v_mul_f32 v85, v12, v85
  v_mfma_f32_16x16x32_bf16 v[108:111], v[36:39], v[204:207], v[108:111]
  v_mul_f32 v86, v12, v86
  v_mfma_f32_16x16x32_bf16 v[116:119], v[36:39], v[236:239], v[116:119]
  s_waitcnt lgkmcnt(3)
  v_mul_f32 v87, v12, v87
  v_mfma_f32_16x16x32_bf16 v[88:91], v[40:43], v[144:147], v[88:91]
  v_cvt_pk_bf16_f32 v80, v80, v81
  v_mfma_f32_16x16x32_bf16 v[96:99], v[40:43], v[176:179], v[96:99]
  v_cvt_pk_bf16_f32 v81, v82, v83
  v_cvt_pk_bf16_f32 v82, v84, v85
  v_mfma_f32_16x16x32_bf16 v[104:107], v[40:43], v[208:211], v[104:107]
  v_cvt_pk_bf16_f32 v83, v86, v87
  v_mfma_f32_16x16x32_bf16 v[112:115], v[40:43], v[240:243], v[112:115]
  s_waitcnt lgkmcnt(2)
  v_accvgpr_write_b32 a216, v80
  v_mfma_f32_16x16x32_bf16 v[92:95], v[44:47], v[144:147], v[92:95]
  v_accvgpr_write_b32 a217, v81
  v_mfma_f32_16x16x32_bf16 v[100:103], v[44:47], v[176:179], v[100:103]
  v_accvgpr_write_b32 a218, v82
  v_accvgpr_write_b32 a219, v83
  v_mfma_f32_16x16x32_bf16 v[108:111], v[44:47], v[208:211], v[108:111]
  v_mfma_f32_16x16x32_bf16 v[116:119], v[44:47], v[240:243], v[116:119]
  s_waitcnt lgkmcnt(1)
  v_mfma_f32_16x16x32_bf16 v[88:91], v[48:51], v[148:151], v[88:91]
  v_mfma_f32_16x16x32_bf16 v[96:99], v[48:51], v[180:183], v[96:99]
  v_mfma_f32_16x16x32_bf16 v[104:107], v[48:51], v[212:215], v[104:107]
  v_mfma_f32_16x16x32_bf16 v[112:115], v[48:51], v[244:247], v[112:115]
  s_waitcnt lgkmcnt(0)
  v_mfma_f32_16x16x32_bf16 v[92:95], v[52:55], v[148:151], v[92:95]
  v_mfma_f32_16x16x32_bf16 v[100:103], v[52:55], v[180:183], v[100:103]
  v_mfma_f32_16x16x32_bf16 v[108:111], v[52:55], v[212:215], v[108:111]
  v_mfma_f32_16x16x32_bf16 v[116:119], v[52:55], v[244:247], v[116:119]
  v_mul_f32 v88, v12, v88
  v_mul_f32 v89, v12, v89
  v_mul_f32 v90, v12, v90
  v_mul_f32 v91, v12, v91
  v_mul_f32 v92, v12, v92
  v_mul_f32 v93, v12, v93
  v_mul_f32 v94, v12, v94
  v_mul_f32 v95, v12, v95
  v_cvt_pk_bf16_f32 v88, v88, v89
  v_cvt_pk_bf16_f32 v89, v90, v91
  v_cvt_pk_bf16_f32 v90, v92, v93
  v_cvt_pk_bf16_f32 v91, v94, v95
  v_accvgpr_write_b32 a52, v88
  v_accvgpr_write_b32 a53, v89
  v_accvgpr_write_b32 a54, v90
  v_accvgpr_write_b32 a55, v91
  v_mul_f32 v96, v12, v96
  v_mul_f32 v97, v12, v97
  v_mul_f32 v98, v12, v98
  v_mul_f32 v99, v12, v99
  v_mul_f32 v100, v12, v100
  v_mul_f32 v101, v12, v101
  v_mul_f32 v102, v12, v102
  v_mul_f32 v103, v12, v103
  v_cvt_pk_bf16_f32 v96, v96, v97
  v_cvt_pk_bf16_f32 v97, v98, v99
  v_cvt_pk_bf16_f32 v98, v100, v101
  v_cvt_pk_bf16_f32 v99, v102, v103
  v_accvgpr_write_b32 a108, v96
  v_accvgpr_write_b32 a109, v97
  v_accvgpr_write_b32 a110, v98
  v_accvgpr_write_b32 a111, v99
  v_mul_f32 v104, v12, v104
  v_mul_f32 v105, v12, v105
  v_mul_f32 v106, v12, v106
  v_mul_f32 v107, v12, v107
  v_mul_f32 v108, v12, v108
  v_mul_f32 v109, v12, v109
  v_mul_f32 v110, v12, v110
  v_mul_f32 v111, v12, v111
  v_cvt_pk_bf16_f32 v104, v104, v105
  v_cvt_pk_bf16_f32 v105, v106, v107
  v_cvt_pk_bf16_f32 v106, v108, v109
  v_cvt_pk_bf16_f32 v107, v110, v111
  v_accvgpr_write_b32 a164, v104
  v_accvgpr_write_b32 a165, v105
  v_accvgpr_write_b32 a166, v106
  v_accvgpr_write_b32 a167, v107
  v_mul_f32 v112, v12, v112
  v_mul_f32 v113, v12, v113
  v_mul_f32 v114, v12, v114
  v_mul_f32 v115, v12, v115
  v_mul_f32 v116, v12, v116
  v_mul_f32 v117, v12, v117
  v_mul_f32 v118, v12, v118
  v_mul_f32 v119, v12, v119
  v_cvt_pk_bf16_f32 v112, v112, v113
  v_cvt_pk_bf16_f32 v113, v114, v115
  v_cvt_pk_bf16_f32 v114, v116, v117
  v_cvt_pk_bf16_f32 v115, v118, v119
  v_accvgpr_write_b32 a220, v112
  v_accvgpr_write_b32 a221, v113
  v_accvgpr_write_b32 a222, v114
  v_accvgpr_write_b32 a223, v115
  s_waitcnt vmcnt(0)
  s_barrier
  v_readfirstlane_b32 s84, v13
  v_readfirstlane_b32 s85, v10
  v_readfirstlane_b32 s22, v11
  s_and_b32 s86, s86, s22
  s_cmp_eq_u32 s86, 1
  s_cselect_b32 s84, s84, 0
  v_and_b32 v10, 0xffe0, v9
  v_cmp_eq_u32 vcc, 0, v10
  s_cbranch_vccz ch_md_ok
ch_role2:
  s_mov_b32 s30, 0
ch_md:
  buffer_load_dword v9, off, s[12:15], 0 sc1
  s_waitcnt vmcnt(0)
  v_and_b32 v10, 0xffe0, v9
  v_cmp_eq_u32 vcc, 0, v10
  s_cbranch_vccz ch_md_ok
  s_sleep 4
  s_add_u32 s30, s30, 1
  s_cmp_lt_u32 s30, 1600000
  s_cbranch_scc1 ch_md
  s_branch ch_end
ch_md_ok:
  v_readfirstlane_b32 s88, v9
  s_lshr_b32 s88, s88, 16
  v_and_b32 v1, 63, v0
  v_lshlrev_b32 v2, 4, v1
  v_lshrrev_b32 v116, 4, v1
  v_and_b32 v117, 15, v1
  v_mov_b32 v3, 0x4444
  v_mov_b32 v118, 0xeeee
  v_cmp_lt_u32 vcc, 7, v117
  s_nop 1
  v_cndmask_b32 v3, v3, v118, vcc
  s_mov_b32 s19, 0
  s_mov_b32 s18, 1
  s_mov_b32 s20, 0
  s_mov_b32 s21, 17664
  s_mov_b32 s23, 4096
  s_lshr_b32 s89, s17, 4
  s_lshl_b32 s89, s89, 2
  s_add_u32 s89, s89, s16
  s_and_b32 s17, s17, 15
  s_cmp_eq_u32 s89, 0
  s_cbranch_scc1 ch_init0
  s_cmp_eq_u32 s89, 1
  s_cbranch_scc1 ch_init1
  s_cmp_eq_u32 s89, 2
  s_cbranch_scc1 ch_init2
  s_cmp_eq_u32 s89, 3
  s_cbranch_scc1 ch_init3
  s_cmp_eq_u32 s89, 4
  s_cbranch_scc1 ch_init4
  s_cmp_eq_u32 s89, 5
  s_cbranch_scc1 ch_init5
  s_cmp_eq_u32 s89, 6
  s_cbranch_scc1 ch_init6
  s_cmp_eq_u32 s89, 7
  s_cbranch_scc1 ch_init7
  s_branch ch_end
ch_init0:
  s_mul_i32 s31, s17, 401408
  s_add_u32 s31, s31, 33554432
  s_and_b32 s28, s84, 10320
  s_lshl_b32 s22, s85, 16
  s_or_b32 s28, s28, s22
  s_cmp_eq_u32 s28, 4294912080
  s_cbranch_scc1 ch_wx0_ok
  s_mov_b32 s30, 0
ch_wr0:
  buffer_load_dword v9, off, s[12:15], 0 offset:132 sc1
  s_waitcnt vmcnt(0)
  v_cmp_ne_u32 vcc, 1, v9
  s_cbranch_vccz ch_wr0_ok
  s_sleep 8
  s_add_u32 s30, s30, 1
  s_cmp_lt_u32 s30, 400000
  s_cbranch_scc1 ch_wr0
  s_branch cA_abort
ch_wr0_ok:
  s_lshl_b32 s27, s17, 7
  s_add_u32 s27, s27, 584192
  s_mov_b32 s28, 10320
  s_mov_b32 s30, 0
ch_wb0:
  buffer_load_dword v9, off, s[8:11], s27  sc1
  s_waitcnt vmcnt(0)
  v_and_b32 v10, s28, v9
  v_cmp_ne_u32 vcc, s28, v10
  s_cbranch_vccz ch_wb0_ok
  s_sleep 3
  s_add_u32 s30, s30, 1
  s_cmp_lt_u32 s30, 400000
  s_cbranch_scc1 ch_wb0
  s_branch cA_abort
ch_wb0_ok:
  s_mov_b32 s29, 586240
  s_mov_b32 s28, 0xffff
  s_mov_b32 s30, 0
ch_wx0:
  buffer_load_dword v9, off, s[8:11], s29  sc1
  s_waitcnt vmcnt(0)
  v_and_b32 v10, s28, v9
  v_cmp_ne_u32 vcc, s28, v10
  s_cbranch_vccz ch_wx0_ok
  s_sleep 8
  s_add_u32 s30, s30, 1
  s_cmp_lt_u32 s30, 400000
  s_cbranch_scc1 ch_wx0
  s_branch cA_abort
ch_wx0_ok:
  s_add_u32 s22, s31, 229376
  buffer_load_dwordx4 a[224:227], v2, s[8:11], s22 offen offset:0 sc1
  buffer_load_dwordx4 a[228:231], v2, s[8:11], s22 offen offset:1024 sc1
  buffer_load_dwordx4 a[232:235], v2, s[8:11], s22 offen offset:2048 sc1
  buffer_load_dwordx4 a[236:239], v2, s[8:11], s22 offen offset:3072 sc1
  s_add_u32 s22, s31, 233472
  buffer_load_dwordx4 a[240:243], v2, s[8:11], s22 offen offset:0 sc1
  buffer_load_dwordx4 a[244:247], v2, s[8:11], s22 offen offset:1024 sc1
  buffer_load_dwordx4 a[248:251], v2, s[8:11], s22 offen offset:2048 sc1
  buffer_load_dwordx4 a[252:255], v2, s[8:11], s22 offen offset:3072 sc1
  s_add_u32 s22, s31, 237568
  buffer_load_dwordx4 v[120:123], v2, s[8:11], s22 offen offset:0 sc1
  buffer_load_dwordx4 v[124:127], v2, s[8:11], s22 offen offset:1024 sc1
  buffer_load_dwordx4 v[128:131], v2, s[8:11], s22 offen offset:2048 sc1
  buffer_load_dwordx4 v[132:135], v2, s[8:11], s22 offen offset:3072 sc1
  s_add_u32 s22, s31, 241664
  buffer_load_dwordx4 v[136:139], v2, s[8:11], s22 offen offset:0 sc1
  buffer_load_dwordx4 v[140:143], v2, s[8:11], s22 offen offset:1024 sc1
  buffer_load_dwordx4 v[144:147], v2, s[8:11], s22 offen offset:2048 sc1
  buffer_load_dwordx4 v[148:151], v2, s[8:11], s22 offen offset:3072 sc1
  s_add_u32 s22, s31, 245760
  buffer_load_dwordx4 v[152:155], v2, s[8:11], s22 offen offset:0 sc1
  buffer_load_dwordx4 v[156:159], v2, s[8:11], s22 offen offset:1024 sc1
  buffer_load_dwordx4 v[160:163], v2, s[8:11], s22 offen offset:2048 sc1
  buffer_load_dwordx4 v[164:167], v2, s[8:11], s22 offen offset:3072 sc1
  s_add_u32 s22, s31, 249856
  buffer_load_dwordx4 v[168:171], v2, s[8:11], s22 offen offset:0 sc1
  buffer_load_dwordx4 v[172:175], v2, s[8:11], s22 offen offset:1024 sc1
  buffer_load_dwordx4 v[176:179], v2, s[8:11], s22 offen offset:2048 sc1
  buffer_load_dwordx4 v[180:183], v2, s[8:11], s22 offen offset:3072 sc1
  s_mov_b32 s24, 655360
  s_mov_b32 s26, 669696
  v_and_b32 v64, 7, v117
  v_and_b32 v65, 1, v116
  v_lshlrev_b32 v65, 2, v65
  v_sub_u32 v64, v64, v65
  v_lshrrev_b32 v65, 3, v117
  v_lshl_add_u32 v66, v65, 2, v64
  v_cmp_gt_u32 vcc, 4, v64
  v_mov_b32 v67, 99
  s_nop 0
  v_cndmask_b32 v66, v67, v66, vcc
  v_mov_b32 v68, 0x3f80
  v_mov_b32 v69, 0x3f800000
  v_mov_b32 v4, 0
  v_cmp_eq_u32 vcc, 0, v66
  s_nop 1
  v_cndmask_b32 v4, v4, v68, vcc
  v_cmp_eq_u32 vcc, 1, v66
  s_nop 1
  v_cndmask_b32 v4, v4, v69, vcc
  v_mov_b32 v5, 0
  v_cmp_eq_u32 vcc, 2, v66
  s_nop 1
  v_cndmask_b32 v5, v5, v68, vcc
  v_cmp_eq_u32 vcc, 3, v66
  s_nop 1
  v_cndmask_b32 v5, v5, v69, vcc
  v_mov_b32 v6, 0
  v_cmp_eq_u32 vcc, 4, v66
  s_nop 1
  v_cndmask_b32 v6, v6, v68, vcc
  v_cmp_eq_u32 vcc, 5, v66
  s_nop 1
  v_cndmask_b32 v6, v6, v69, vcc
  v_mov_b32 v7, 0
  v_cmp_eq_u32 vcc, 6, v66
  s_nop 1
  v_cndmask_b32 v7, v7, v68, vcc
  v_cmp_eq_u32 vcc, 7, v66
  s_nop 1
  v_cndmask_b32 v7, v7, v69, vcc
  v_lshrrev_b32 v64, 1, v116
  v_lshrrev_b32 v65, 3, v117
  v_and_b32 v66, 1, v116
  v_and_b32 v68, 7, v117
  v_lshlrev_b32 v67, 8, v65
  v_lshl_add_u32 v67, v68, 5, v67
  v_lshl_add_u32 v67, v66, 4, v67
  v_add_u32 v69, 4096, v67
  v_add_u32 v70, 6400, v67
  v_cmp_eq_u32 vcc, v64, v65
  s_nop 1
  v_cndmask_b32 v113, v70, v69, vcc
  v_and_b32 v74, 3, v117
  v_lshlrev_b32 v74, 1, v74
  v_bfe_u32 v75, v117, 2, 1
  v_or_b32 v74, v74, v75
  v_and_b32 v75, 8, v117
  v_or_b32 v74, v74, v75
  v_lshlrev_b32 v67, 9, v64
  v_lshl_add_u32 v67, v74, 4, v67
  v_lshl_add_u32 v67, v66, 3, v67
  v_add_u32 v114, 0, v67
  v_mul_u32_u24 v67, 1088, v65
  v_lshl_add_u32 v67, v116, 5, v67
  v_and_b32 v75, 1, v117
  v_and_b32 v76, 2, v117
  v_lshl_add_u32 v75, v76, 1, v75
  v_bfe_u32 v76, v117, 2, 1
  v_lshl_add_u32 v75, v76, 1, v75
  v_lshl_add_u32 v67, v75, 2, v67
  v_add_u32 v115, 4096, v67
  v_and_b32 v69, 1, v74
  v_lshlrev_b32 v67, 7, v69
  v_lshl_add_u32 v67, v116, 4, v67
  v_lshl_add_u32 v67, v65, 8, v67
  v_bfe_u32 v69, v74, 1, 2
  v_lshl_add_u32 v67, v69, 2, v67
  s_lshl_b32 s22, s17, 9
  s_add_u32 s22, s22, 9216
  v_add_u32 v72, s22, v67
  v_bfe_u32 v69, v75, 1, 1
  v_lshlrev_b32 v67, 7, v69
  v_lshl_add_u32 v67, v116, 4, v67
  v_and_b32 v69, 4, v75
  v_add_u32 v67, v67, v69
  s_lshr_b32 s22, s17, 1
  s_lshl_b32 s22, s22, 8
  s_and_b32 s27, s17, 1
  s_lshl_b32 s27, s27, 3
  s_add_u32 s22, s22, s27
  s_add_u32 s22, s22, 7168
  v_add_u32 v67, s22, v67
  v_and_b32 v69, 9, v117
  v_mov_b32 v70, 0x40000000
  v_cmp_eq_u32 vcc, 0, v69
  s_nop 1
  v_cndmask_b32 v118, v70, v67, vcc
  v_mov_b32 v119, -1
  v_and_b32 v0, 15, v1
  s_and_b32 s22, s17, 0
  s_lshl_b32 s22, s22, 7
  s_add_u32 s22, s22, 37376
  v_lshl_add_u32 v0, v0, 2, s22
  v_xor_b32 v69, 256, v2
  v_mul_i32_i24 v70, -4096, v66
  v_add_u32 v69, v69, v70
  v_add_u32 v117, 12288, v69
  v_mov_b32 v116, v73
  v_mov_b32 v112, 0
  s_mul_i32 s35, s17, 28672
  s_add_u32 s35, s35, 4325376
  v_mov_b32 v1, v72
  v_mov_b32 v36, 0
  v_mov_b32 v37, 0
  v_mov_b32 v38, 0
  v_mov_b32 v39, 0
  v_mov_b32 v40, 0
  v_mov_b32 v41, 0
  v_mov_b32 v42, 0
  v_mov_b32 v43, 0
  v_mov_b32 v44, 0
  v_mov_b32 v45, 0
  v_mov_b32 v46, 0
  v_mov_b32 v47, 0
  v_mov_b32 v48, 0
  v_mov_b32 v49, 0
  v_mov_b32 v50, 0
  v_mov_b32 v51, 0
  v_mov_b32 v52, 0
  v_mov_b32 v53, 0
  v_mov_b32 v54, 0
  v_mov_b32 v55, 0
  v_mov_b32 v56, 0
  v_mov_b32 v57, 0
  v_mov_b32 v58, 0
  v_mov_b32 v59, 0
  v_mov_b32 v60, 0
  v_mov_b32 v61, 0
  v_mov_b32 v62, 0
  v_mov_b32 v63, 0
  v_mov_b32 v64, 0
  v_mov_b32 v65, 0
  v_mov_b32 v66, 0
  v_mov_b32 v67, 0
  v_mov_b32 v68, 0
  v_mov_b32 v69, 0
  v_mov_b32 v70, 0
  v_mov_b32 v71, 0
  v_mov_b32 v72, 0
  v_mov_b32 v73, 0
  v_mov_b32 v74, 0
  v_mov_b32 v75, 0
  v_mov_b32 v76, 0
  v_mov_b32 v77, 0
  v_mov_b32 v78, 0
  v_mov_b32 v79, 0
  s_mov_b32 s22, 0
  v_lshrrev_b32 v14, 4, v2
  v_add_u32 v14, 0, v14
  v_min_u32 v14, 308, v14
  v_lshlrev_b32 v14, 7, v14
  buffer_load_dword v15, v14, s[8:11], s22 offen sc1
  v_lshrrev_b32 v14, 4, v2
  v_add_u32 v14, 256, v14
  v_min_u32 v14, 308, v14
  v_lshlrev_b32 v14, 7, v14
  buffer_load_dword v15, v14, s[8:11], s22 offen sc1
  buffer_load_dwordx4 v[80:83], v117, s[8:11], s24 offen offset:0 sc1
  buffer_load_dwordx4 v[84:87], v117, s[8:11], s24 offen offset:1024 sc1
  buffer_load_dwordx4 v[88:91], v117, s[8:11], s26 offen offset:0 sc1
  buffer_load_dwordx4 v[92:95], v117, s[8:11], s26 offen offset:1024 sc1
  buffer_load_dwordx4 v[96:99], v2, s[8:11], s24 offen offset:0 sc1
  buffer_load_dwordx4 v[100:103], v2, s[8:11], s24 offen offset:1024 sc1
  buffer_load_dwordx4 v[104:107], v2, s[8:11], s26 offen offset:0 sc1
  buffer_load_dwordx4 v[108:111], v2, s[8:11], s26 offen offset:1024 sc1
  s_add_u32 s22, s31, 253952
  buffer_load_dwordx4 v[184:187], v2, s[8:11], s22 offen offset:0 sc1
  buffer_load_dwordx4 v[188:191], v2, s[8:11], s22 offen offset:1024 sc1
  buffer_load_dwordx4 v[192:195], v2, s[8:11], s22 offen offset:2048 sc1
  buffer_load_dwordx4 v[196:199], v2, s[8:11], s22 offen offset:3072 sc1
  s_add_u32 s22, s31, 372736
  buffer_load_dwordx4 v[200:203], v2, s[8:11], s22 offen offset:0 sc1
  buffer_load_dwordx4 v[204:207], v2, s[8:11], s22 offen offset:1024 sc1
  buffer_load_dwordx4 v[208:211], v2, s[8:11], s22 offen offset:2048 sc1
  buffer_load_dwordx4 v[212:215], v2, s[8:11], s22 offen offset:3072 sc1
  s_add_u32 s22, s31, 376832
  buffer_load_dwordx4 v[216:219], v2, s[8:11], s22 offen offset:0 sc1
  buffer_load_dwordx4 v[220:223], v2, s[8:11], s22 offen offset:1024 sc1
  buffer_load_dwordx4 v[224:227], v2, s[8:11], s22 offen offset:2048 sc1
  buffer_load_dwordx4 v[228:231], v2, s[8:11], s22 offen offset:3072 sc1
  s_add_u32 s22, s31, 380928
  buffer_load_dwordx4 v[232:235], v2, s[8:11], s22 offen offset:0 sc1
  buffer_load_dwordx4 v[236:239], v2, s[8:11], s22 offen offset:1024 sc1
  buffer_load_dwordx4 v[240:243], v2, s[8:11], s22 offen offset:2048 sc1
  buffer_load_dwordx4 v[244:247], v2, s[8:11], s22 offen offset:3072 sc1
  s_add_u32 s22, s31, 385024
  buffer_load_dwordx4 v[248:251], v2, s[8:11], s22 offen offset:0 sc1
  buffer_load_dwordx4 v[252:255], v2, s[8:11], s22 offen offset:1024 sc1
  s_waitcnt vmcnt(0) lgkmcnt(0)
  s_mov_b32 s31, 0
  s_cmp_lg_u32 s88, 0
  s_cbranch_scc1 cB_sc0_loop
  s_branch cA_sc0_loop
ch_init1:
  s_mul_i32 s31, s17, 401408
  s_add_u32 s31, s31, 33554432
  s_and_b32 s28, s84, 10320
  s_lshl_b32 s22, s85, 16
  s_or_b32 s28, s28, s22
  s_cmp_eq_u32 s28, 4294912080
  s_cbranch_scc1 ch_wx1_ok
  s_mov_b32 s30, 0
ch_wr1:
  buffer_load_dword v9, off, s[12:15], 0 offset:132 sc1
  s_waitcnt vmcnt(0)
  v_cmp_ne_u32 vcc, 1, v9
  s_cbranch_vccz ch_wr1_ok
  s_sleep 8
  s_add_u32 s30, s30, 1
  s_cmp_lt_u32 s30, 400000
  s_cbranch_scc1 ch_wr1
  s_branch cA_abort
ch_wr1_ok:
  s_lshl_b32 s27, s17, 7
  s_add_u32 s27, s27, 584192
  s_mov_b32 s28, 10320
  s_mov_b32 s30, 0
ch_wb1:
  buffer_load_dword v9, off, s[8:11], s27  sc1
  s_waitcnt vmcnt(0)
  v_and_b32 v10, s28, v9
  v_cmp_ne_u32 vcc, s28, v10
  s_cbranch_vccz ch_wb1_ok
  s_sleep 3
  s_add_u32 s30, s30, 1
  s_cmp_lt_u32 s30, 400000
  s_cbranch_scc1 ch_wb1
  s_branch cA_abort
ch_wb1_ok:
  s_mov_b32 s29, 586240
  s_mov_b32 s28, 0xffff
  s_mov_b32 s30, 0
ch_wx1:
  buffer_load_dword v9, off, s[8:11], s29  sc1
  s_waitcnt vmcnt(0)
  v_and_b32 v10, s28, v9
  v_cmp_ne_u32 vcc, s28, v10
  s_cbranch_vccz ch_wx1_ok
  s_sleep 8
  s_add_u32 s30, s30, 1
  s_cmp_lt_u32 s30, 400000
  s_cbranch_scc1 ch_wx1
  s_branch cA_abort
ch_wx1_ok:
  s_add_u32 s22, s31, 258048
  buffer_load_dwordx4 a[224:227], v2, s[8:11], s22 offen offset:0 sc1
  buffer_load_dwordx4 a[228:231], v2, s[8:11], s22 offen offset:1024 sc1
  buffer_load_dwordx4 a[232:235], v2, s[8:11], s22 offen offset:2048 sc1
  buffer_load_dwordx4 a[236:239], v2, s[8:11], s22 offen offset:3072 sc1
  s_add_u32 s22, s31, 262144
  buffer_load_dwordx4 a[240:243], v2, s[8:11], s22 offen offset:0 sc1
  buffer_load_dwordx4 a[244:247], v2, s[8:11], s22 offen offset:1024 sc1
  buffer_load_dwordx4 a[248:251], v2, s[8:11], s22 offen offset:2048 sc1
  buffer_load_dwordx4 a[252:255], v2, s[8:11], s22 offen offset:3072 sc1
  s_add_u32 s22, s31, 266240
  buffer_load_dwordx4 v[120:123], v2, s[8:11], s22 offen offset:0 sc1
  buffer_load_dwordx4 v[124:127], v2, s[8:11], s22 offen offset:1024 sc1
  buffer_load_dwordx4 v[128:131], v2, s[8:11], s22 offen offset:2048 sc1
  buffer_load_dwordx4 v[132:135], v2, s[8:11], s22 offen offset:3072 sc1
  s_add_u32 s22, s31, 270336
  buffer_load_dwordx4 v[136:139], v2, s[8:11], s22 offen offset:0 sc1
  buffer_load_dwordx4 v[140:143], v2, s[8:11], s22 offen offset:1024 sc1
  buffer_load_dwordx4 v[144:147], v2, s[8:11], s22 offen offset:2048 sc1
  buffer_load_dwordx4 v[148:151], v2, s[8:11], s22 offen offset:3072 sc1
  s_add_u32 s22, s31, 274432
  buffer_load_dwordx4 v[152:155], v2, s[8:11], s22 offen offset:0 sc1
  buffer_load_dwordx4 v[156:159], v2, s[8:11], s22 offen offset:1024 sc1
  buffer_load_dwordx4 v[160:163], v2, s[8:11], s22 offen offset:2048 sc1
  buffer_load_dwordx4 v[164:167], v2, s[8:11], s22 offen offset:3072 sc1
  s_add_u32 s22, s31, 278528
  buffer_load_dwordx4 v[168:171], v2, s[8:11], s22 offen offset:0 sc1
  buffer_load_dwordx4 v[172:175], v2, s[8:11], s22 offen offset:1024 sc1
  buffer_load_dwordx4 v[176:179], v2, s[8:11], s22 offen offset:2048 sc1
  buffer_load_dwordx4 v[180:183], v2, s[8:11], s22 offen offset:3072 sc1
  s_mov_b32 s24, 657408
  s_mov_b32 s26, 671744
  v_and_b32 v64, 7, v117
  v_and_b32 v65, 1, v116
  v_lshlrev_b32 v65, 2, v65
  v_sub_u32 v64, v64, v65
  v_lshrrev_b32 v65, 3, v117
  v_lshl_add_u32 v66, v65, 2, v64
  v_cmp_gt_u32 vcc, 4, v64
  v_mov_b32 v67, 99
  s_nop 0
  v_cndmask_b32 v66, v67, v66, vcc
  v_mov_b32 v68, 0x3f80
  v_mov_b32 v69, 0x3f800000
  v_mov_b32 v4, 0
  v_cmp_eq_u32 vcc, 0, v66
  s_nop 1
  v_cndmask_b32 v4, v4, v68, vcc
  v_cmp_eq_u32 vcc, 1, v66
  s_nop 1
  v_cndmask_b32 v4, v4, v69, vcc
  v_mov_b32 v5, 0
  v_cmp_eq_u32 vcc, 2, v66
  s_nop 1
  v_cndmask_b32 v5, v5, v68, vcc
  v_cmp_eq_u32 vcc, 3, v66
  s_nop 1
  v_cndmask_b32 v5, v5, v69, vcc
  v_mov_b32 v6, 0
  v_cmp_eq_u32 vcc, 4, v66
  s_nop 1
  v_cndmask_b32 v6, v6, v68, vcc
  v_cmp_eq_u32 vcc, 5, v66
  s_nop 1
  v_cndmask_b32 v6, v6, v69, vcc
  v_mov_b32 v7, 0
  v_cmp_eq_u32 vcc, 6, v66
  s_nop 1
  v_cndmask_b32 v7, v7, v68, vcc
  v_cmp_eq_u32 vcc, 7, v66
  s_nop 1
  v_cndmask_b32 v7, v7, v69, vcc
  v_lshrrev_b32 v64, 1, v116
  v_lshrrev_b32 v65, 3, v117
  v_and_b32 v66, 1, v116
  v_and_b32 v68, 7, v117
  v_lshlrev_b32 v67, 8, v65
  v_lshl_add_u32 v67, v68, 5, v67
  v_lshl_add_u32 v67, v66, 4, v67
  v_add_u32 v69, 4608, v67
  v_add_u32 v70, 6400, v67
  v_cmp_eq_u32 vcc, v64, v65
  s_nop 1
  v_cndmask_b32 v113, v70, v69, vcc
  v_and_b32 v74, 3, v117
  v_lshlrev_b32 v74, 1, v74
  v_bfe_u32 v75, v117, 2, 1
  v_or_b32 v74, v74, v75
  v_and_b32 v75, 8, v117
  v_or_b32 v74, v74, v75
  v_lshlrev_b32 v67, 9, v64
  v_lshl_add_u32 v67, v74, 4, v67
  v_lshl_add_u32 v67, v66, 3, v67
  v_add_u32 v114, 256, v67
  v_mul_u32_u24 v67, 1088, v65
  v_lshl_add_u32 v67, v116, 5, v67
  v_and_b32 v75, 1, v117
  v_and_b32 v76, 2, v117
  v_lshl_add_u32 v75, v76, 1, v75
  v_bfe_u32 v76, v117, 2, 1
  v_lshl_add_u32 v75, v76, 1, v75
  v_lshl_add_u32 v67, v75, 2, v67
  v_add_u32 v115, 4224, v67
  v_and_b32 v69, 1, v74
  v_lshlrev_b32 v67, 7, v69
  v_lshl_add_u32 v67, v116, 4, v67
  v_lshl_add_u32 v67, v65, 8, v67
  v_bfe_u32 v69, v74, 1, 2
  v_lshl_add_u32 v67, v69, 2, v67
  s_lshl_b32 s22, s17, 9
  s_add_u32 s22, s22, 9280
  v_add_u32 v72, s22, v67
  v_bfe_u32 v69, v75, 1, 1
  v_lshlrev_b32 v67, 7, v69
  v_lshl_add_u32 v67, v116, 4, v67
  v_and_b32 v69, 4, v75
  v_add_u32 v67, v67, v69
  s_lshr_b32 s22, s17, 1
  s_lshl_b32 s22, s22, 8
  s_and_b32 s27, s17, 1
  s_lshl_b32 s27, s27, 3
  s_add_u32 s22, s22, s27
  s_add_u32 s22, s22, 7232
  v_add_u32 v67, s22, v67
  v_and_b32 v69, 9, v117
  v_mov_b32 v70, 0x40000000
  v_cmp_eq_u32 vcc, 0, v69
  s_nop 1
  v_cndmask_b32 v118, v70, v67, vcc
  v_mov_b32 v119, -1
  s_lshl_b32 s22, s17, 2
  s_add_u32 s22, s22, 35328
  v_lshl_add_u32 v67, v1, 7, s22
  v_mov_b32 v70, 0x40000000
  v_cmp_gt_u32 vcc, 1, v1
  s_nop 1
  v_cndmask_b32 v73, v70, v67, vcc
  v_mov_b32 v112, 1
  v_and_b32 v0, 15, v1
  s_and_b32 s22, s17, 0
  s_lshl_b32 s22, s22, 7
  s_add_u32 s22, s22, 37376
  v_lshl_add_u32 v0, v0, 2, s22
  v_xor_b32 v69, 256, v2
  v_mul_i32_i24 v70, 4096, v66
  v_add_u32 v69, v69, v70
  v_add_u32 v117, 6144, v69
  v_mov_b32 v116, v73
  s_mul_i32 s35, s17, 28672
  s_add_u32 s35, s35, 4325376
  v_mov_b32 v1, v72
  v_mov_b32 v36, 0
  v_mov_b32 v37, 0
  v_mov_b32 v38, 0
  v_mov_b32 v39, 0
  v_mov_b32 v40, 0
  v_mov_b32 v41, 0
  v_mov_b32 v42, 0
  v_mov_b32 v43, 0
  v_mov_b32 v44, 0
  v_mov_b32 v45, 0
  v_mov_b32 v46, 0
  v_mov_b32 v47, 0
  v_mov_b32 v48, 0
  v_mov_b32 v49, 0
  v_mov_b32 v50, 0
  v_mov_b32 v51, 0
  v_mov_b32 v52, 0
  v_mov_b32 v53, 0
  v_mov_b32 v54, 0
  v_mov_b32 v55, 0
  v_mov_b32 v56, 0
  v_mov_b32 v57, 0
  v_mov_b32 v58, 0
  v_mov_b32 v59, 0
  v_mov_b32 v60, 0
  v_mov_b32 v61, 0
  v_mov_b32 v62, 0
  v_mov_b32 v63, 0
  v_mov_b32 v64, 0
  v_mov_b32 v65, 0
  v_mov_b32 v66, 0
  v_mov_b32 v67, 0
  v_mov_b32 v68, 0
  v_mov_b32 v69, 0
  v_mov_b32 v70, 0
  v_mov_b32 v71, 0
  v_mov_b32 v72, 0
  v_mov_b32 v73, 0
  v_mov_b32 v74, 0
  v_mov_b32 v75, 0
  v_mov_b32 v76, 0
  v_mov_b32 v77, 0
  v_mov_b32 v78, 0
  v_mov_b32 v79, 0
  s_mov_b32 s22, 0
  v_lshrrev_b32 v14, 4, v2
  v_add_u32 v14, 64, v14
  v_min_u32 v14, 308, v14
  v_lshlrev_b32 v14, 7, v14
  buffer_load_dword v15, v14, s[8:11], s22 offen sc1
  buffer_load_dwordx4 v[80:83], v117, s[8:11], s24 offen offset:0 sc1
  buffer_load_dwordx4 v[84:87], v117, s[8:11], s24 offen offset:1024 sc1
  buffer_load_dwordx4 v[88:91], v117, s[8:11], s26 offen offset:0 sc1
  buffer_load_dwordx4 v[92:95], v117, s[8:11], s26 offen offset:1024 sc1
  buffer_load_dwordx4 v[96:99], v2, s[8:11], s24 offen offset:0 sc1
  buffer_load_dwordx4 v[100:103], v2, s[8:11], s24 offen offset:1024 sc1
  buffer_load_dwordx4 v[104:107], v2, s[8:11], s26 offen offset:0 sc1
  buffer_load_dwordx4 v[108:111], v2, s[8:11], s26 offen offset:1024 sc1
  s_add_u32 s22, s31, 282624
  buffer_load_dwordx4 v[184:187], v2, s[8:11], s22 offen offset:0 sc1
  buffer_load_dwordx4 v[188:191], v2, s[8:11], s22 offen offset:1024 sc1
  buffer_load_dwordx4 v[192:195], v2, s[8:11], s22 offen offset:2048 sc1
  buffer_load_dwordx4 v[196:199], v2, s[8:11], s22 offen offset:3072 sc1
  s_add_u32 s22, s31, 344064
  buffer_load_dwordx4 v[200:203], v2, s[8:11], s22 offen offset:0 sc1
  buffer_load_dwordx4 v[204:207], v2, s[8:11], s22 offen offset:1024 sc1
  buffer_load_dwordx4 v[208:211], v2, s[8:11], s22 offen offset:2048 sc1
  buffer_load_dwordx4 v[212:215], v2, s[8:11], s22 offen offset:3072 sc1
  s_add_u32 s22, s31, 348160
  buffer_load_dwordx4 v[216:219], v2, s[8:11], s22 offen offset:0 sc1
  buffer_load_dwordx4 v[220:223], v2, s[8:11], s22 offen offset:1024 sc1
  buffer_load_dwordx4 v[224:227], v2, s[8:11], s22 offen offset:2048 sc1
  buffer_load_dwordx4 v[228:231], v2, s[8:11], s22 offen offset:3072 sc1
  s_add_u32 s22, s31, 352256
  buffer_load_dwordx4 v[232:235], v2, s[8:11], s22 offen offset:0 sc1
  buffer_load_dwordx4 v[236:239], v2, s[8:11], s22 offen offset:1024 sc1
  buffer_load_dwordx4 v[240:243], v2, s[8:11], s22 offen offset:2048 sc1
  buffer_load_dwordx4 v[244:247], v2, s[8:11], s22 offen offset:3072 sc1
  s_add_u32 s22, s31, 356352
  buffer_load_dwordx4 v[248:251], v2, s[8:11], s22 offen offset:0 sc1
  buffer_load_dwordx4 v[252:255], v2, s[8:11], s22 offen offset:1024 sc1
  s_waitcnt vmcnt(0) lgkmcnt(0)
  s_mov_b32 s31, 0
  s_cmp_lg_u32 s88, 0
  s_cbranch_scc1 cB_sc1_loop
  s_branch cA_sc1_loop
ch_init2:
  s_mul_i32 s31, s17, 401408
  s_add_u32 s31, s31, 33554432
  s_and_b32 s28, s84, 12384
  s_lshl_b32 s22, s85, 16
  s_or_b32 s28, s28, s22
  s_cmp_eq_u32 s28, 4294914144
  s_cbranch_scc1 ch_wx2_ok
  s_mov_b32 s30, 0
ch_wr2:
  buffer_load_dword v9, off, s[12:15], 0 offset:132 sc1
  s_waitcnt vmcnt(0)
  v_cmp_ne_u32 vcc, 1, v9
  s_cbranch_vccz ch_wr2_ok
  s_sleep 8
  s_add_u32 s30, s30, 1
  s_cmp_lt_u32 s30, 400000
  s_cbranch_scc1 ch_wr2
  s_branch cA_abort
ch_wr2_ok:
  s_lshl_b32 s27, s17, 7
  s_add_u32 s27, s27, 584192
  s_mov_b32 s28, 12384
  s_mov_b32 s30, 0
ch_wb2:
  buffer_load_dword v9, off, s[8:11], s27  sc1
  s_waitcnt vmcnt(0)
  v_and_b32 v10, s28, v9
  v_cmp_ne_u32 vcc, s28, v10
  s_cbranch_vccz ch_wb2_ok
  s_sleep 3
  s_add_u32 s30, s30, 1
  s_cmp_lt_u32 s30, 400000
  s_cbranch_scc1 ch_wb2
  s_branch cA_abort
ch_wb2_ok:
  s_mov_b32 s29, 586240
  s_mov_b32 s28, 0xffff
  s_mov_b32 s30, 0
ch_wx2:
  buffer_load_dword v9, off, s[8:11], s29  sc1
  s_waitcnt vmcnt(0)
  v_and_b32 v10, s28, v9
  v_cmp_ne_u32 vcc, s28, v10
  s_cbranch_vccz ch_wx2_ok
  s_sleep 8
  s_add_u32 s30, s30, 1
  s_cmp_lt_u32 s30, 400000
  s_cbranch_scc1 ch_wx2
  s_branch cA_abort
ch_wx2_ok:
  s_add_u32 s22, s31, 286720
  buffer_load_dwordx4 a[224:227], v2, s[8:11], s22 offen offset:0 sc1
  buffer_load_dwordx4 a[228:231], v2, s[8:11], s22 offen offset:1024 sc1
  buffer_load_dwordx4 a[232:235], v2, s[8:11], s22 offen offset:2048 sc1
  buffer_load_dwordx4 a[236:239], v2, s[8:11], s22 offen offset:3072 sc1
  s_add_u32 s22, s31, 290816
  buffer_load_dwordx4 a[240:243], v2, s[8:11], s22 offen offset:0 sc1
  buffer_load_dwordx4 a[244:247], v2, s[8:11], s22 offen offset:1024 sc1
  buffer_load_dwordx4 a[248:251], v2, s[8:11], s22 offen offset:2048 sc1
  buffer_load_dwordx4 a[252:255], v2, s[8:11], s22 offen offset:3072 sc1
  s_add_u32 s22, s31, 294912
  buffer_load_dwordx4 v[120:123], v2, s[8:11], s22 offen offset:0 sc1
  buffer_load_dwordx4 v[124:127], v2, s[8:11], s22 offen offset:1024 sc1
  buffer_load_dwordx4 v[128:131], v2, s[8:11], s22 offen offset:2048 sc1
  buffer_load_dwordx4 v[132:135], v2, s[8:11], s22 offen offset:3072 sc1
  s_add_u32 s22, s31, 299008
  buffer_load_dwordx4 v[136:139], v2, s[8:11], s22 offen offset:0 sc1
  buffer_load_dwordx4 v[140:143], v2, s[8:11], s22 offen offset:1024 sc1
  buffer_load_dwordx4 v[144:147], v2, s[8:11], s22 offen offset:2048 sc1
  buffer_load_dwordx4 v[148:151], v2, s[8:11], s22 offen offset:3072 sc1
  s_add_u32 s22, s31, 303104
  buffer_load_dwordx4 v[152:155], v2, s[8:11], s22 offen offset:0 sc1
  buffer_load_dwordx4 v[156:159], v2, s[8:11], s22 offen offset:1024 sc1
  buffer_load_dwordx4 v[160:163], v2, s[8:11], s22 offen offset:2048 sc1
  buffer_load_dwordx4 v[164:167], v2, s[8:11], s22 offen offset:3072 sc1
  s_add_u32 s22, s31, 307200
  buffer_load_dwordx4 v[168:171], v2, s[8:11], s22 offen offset:0 sc1
  buffer_load_dwordx4 v[172:175], v2, s[8:11], s22 offen offset:1024 sc1
  buffer_load_dwordx4 v[176:179], v2, s[8:11], s22 offen offset:2048 sc1
  buffer_load_dwordx4 v[180:183], v2, s[8:11], s22 offen offset:3072 sc1
  s_mov_b32 s24, 659456
  s_mov_b32 s26, 673792
  v_and_b32 v64, 7, v117
  v_and_b32 v65, 1, v116
  v_lshlrev_b32 v65, 2, v65
  v_sub_u32 v64, v64, v65
  v_lshrrev_b32 v65, 3, v117
  v_lshl_add_u32 v66, v65, 2, v64
  v_cmp_gt_u32 vcc, 4, v64
  v_mov_b32 v67, 99
  s_nop 0
  v_cndmask_b32 v66, v67, v66, vcc
  v_mov_b32 v68, 0x3f80
  v_mov_b32 v69, 0x3f800000
  v_mov_b32 v4, 0
  v_cmp_eq_u32 vcc, 0, v66
  s_nop 1
  v_cndmask_b32 v4, v4, v68, vcc
  v_cmp_eq_u32 vcc, 1, v66
  s_nop 1
  v_cndmask_b32 v4, v4, v69, vcc
  v_mov_b32 v5, 0
  v_cmp_eq_u32 vcc, 2, v66
  s_nop 1
  v_cndmask_b32 v5, v5, v68, vcc
  v_cmp_eq_u32 vcc, 3, v66
  s_nop 1
  v_cndmask_b32 v5, v5, v69, vcc
  v_mov_b32 v6, 0
  v_cmp_eq_u32 vcc, 4, v66
  s_nop 1
  v_cndmask_b32 v6, v6, v68, vcc
  v_cmp_eq_u32 vcc, 5, v66
  s_nop 1
  v_cndmask_b32 v6, v6, v69, vcc
  v_mov_b32 v7, 0
  v_cmp_eq_u32 vcc, 6, v66
  s_nop 1
  v_cndmask_b32 v7, v7, v68, vcc
  v_cmp_eq_u32 vcc, 7, v66
  s_nop 1
  v_cndmask_b32 v7, v7, v69, vcc
  v_lshrrev_b32 v64, 1, v116
  v_lshrrev_b32 v65, 3, v117
  v_and_b32 v66, 1, v116
  v_and_b32 v68, 7, v117
  v_lshlrev_b32 v67, 8, v65
  v_lshl_add_u32 v67, v68, 5, v67
  v_lshl_add_u32 v67, v66, 4, v67
  v_add_u32 v69, 5184, v67
  v_add_u32 v70, 6400, v67
  v_cmp_eq_u32 vcc, v64, v65
  s_nop 1
  v_cndmask_b32 v113, v70, v69, vcc
  s_lshl_b32 s22, s17, 9
  s_add_u32 s22, s22, 9216
  v_lshl_add_u32 v114, v1, 3, s22
  s_lshr_b32 s22, s17, 1
  s_lshl_b32 s22, s22, 8
  s_and_b32 s27, s17, 1
  s_lshl_b32 s27, s27, 3
  s_add_u32 s22, s22, s27
  s_add_u32 s22, s22, 7168
  v_add_u32 v115, s22, v2
  v_mov_b32 v70, 0x40000000
  v_cmp_gt_u32 vcc, 16, v1
  s_nop 1
  v_cndmask_b32 v115, v70, v115, vcc
  v_mov_b32 v118, -1
  v_mov_b32 v119, -1
  v_and_b32 v0, 15, v1
  s_and_b32 s22, s17, 0
  s_lshl_b32 s22, s22, 7
  s_add_u32 s22, s22, 37376
  v_lshl_add_u32 v0, v0, 2, s22
  v_xor_b32 v69, 256, v2
  v_mul_i32_i24 v70, -2048, v66
  v_add_u32 v69, v69, v70
  v_add_u32 v117, 8192, v69
  v_mov_b32 v116, v73
  s_mul_i32 s35, s17, 28672
  s_add_u32 s35, s35, 4325376
  v_mov_b32 v36, 0
  v_mov_b32 v37, 0
  v_mov_b32 v38, 0
  v_mov_b32 v39, 0
  v_mov_b32 v40, 0
  v_mov_b32 v41, 0
  v_mov_b32 v42, 0
  v_mov_b32 v43, 0
  v_mov_b32 v44, 0
  v_mov_b32 v45, 0
  v_mov_b32 v46, 0
  v_mov_b32 v47, 0
  v_mov_b32 v48, 0
  v_mov_b32 v49, 0
  v_mov_b32 v50, 0
  v_mov_b32 v51, 0
  v_mov_b32 v52, 0
  v_mov_b32 v53, 0
  v_mov_b32 v54, 0
  v_mov_b32 v55, 0
  v_mov_b32 v56, 0
  v_mov_b32 v57, 0
  v_mov_b32 v58, 0
  v_mov_b32 v59, 0
  v_mov_b32 v60, 0
  v_mov_b32 v61, 0
  v_mov_b32 v62, 0
  v_mov_b32 v63, 0
  v_mov_b32 v64, 0
  v_mov_b32 v65, 0
  v_mov_b32 v66, 0
  v_mov_b32 v67, 0
  v_mov_b32 v68, 0
  v_mov_b32 v69, 0
  v_mov_b32 v70, 0
  v_mov_b32 v71, 0
  v_mov_b32 v72, 0
  v_mov_b32 v73, 0
  v_mov_b32 v74, 0
  v_mov_b32 v75, 0
  v_mov_b32 v76, 0
  v_mov_b32 v77, 0
  v_mov_b32 v78, 0
  v_mov_b32 v79, 0
  s_mov_b32 s22, 0
  v_lshrrev_b32 v14, 4, v2
  v_add_u32 v14, 128, v14
  v_min_u32 v14, 308, v14
  v_lshlrev_b32 v14, 7, v14
  buffer_load_dword v15, v14, s[8:11], s22 offen sc1
  buffer_load_dwordx4 v[80:83], v117, s[8:11], s24 offen offset:0 sc1
  buffer_load_dwordx4 v[84:87], v117, s[8:11], s24 offen offset:1024 sc1
  buffer_load_dwordx4 v[88:91], v117, s[8:11], s26 offen offset:0 sc1
  buffer_load_dwordx4 v[92:95], v117, s[8:11], s26 offen offset:1024 sc1
  buffer_load_dwordx4 v[96:99], v2, s[8:11], s24 offen offset:0 sc1
  buffer_load_dwordx4 v[100:103], v2, s[8:11], s24 offen offset:1024 sc1
  buffer_load_dwordx4 v[104:107], v2, s[8:11], s26 offen offset:0 sc1
  buffer_load_dwordx4 v[108:111], v2, s[8:11], s26 offen offset:1024 sc1
  s_add_u32 s22, s31, 311296
  buffer_load_dwordx4 v[184:187], v2, s[8:11], s22 offen offset:0 sc1
  buffer_load_dwordx4 v[188:191], v2, s[8:11], s22 offen offset:1024 sc1
  buffer_load_dwordx4 v[192:195], v2, s[8:11], s22 offen offset:2048 sc1
  buffer_load_dwordx4 v[196:199], v2, s[8:11], s22 offen offset:3072 sc1
  s_add_u32 s22, s31, 385024
  buffer_load_dwordx4 v[200:203], v2, s[8:11], s22 offen offset:2048 sc1
  buffer_load_dwordx4 v[204:207], v2, s[8:11], s22 offen offset:3072 sc1
  s_add_u32 s22, s31, 389120
  buffer_load_dwordx4 v[208:211], v2, s[8:11], s22 offen offset:0 sc1
  buffer_load_dwordx4 v[212:215], v2, s[8:11], s22 offen offset:1024 sc1
  buffer_load_dwordx4 v[216:219], v2, s[8:11], s22 offen offset:2048 sc1
  buffer_load_dwordx4 v[220:223], v2, s[8:11], s22 offen offset:3072 sc1
  s_add_u32 s22, s31, 393216
  buffer_load_dwordx4 v[224:227], v2, s[8:11], s22 offen offset:0 sc1
  buffer_load_dwordx4 v[228:231], v2, s[8:11], s22 offen offset:1024 sc1
  buffer_load_dwordx4 v[232:235], v2, s[8:11], s22 offen offset:2048 sc1
  buffer_load_dwordx4 v[236:239], v2, s[8:11], s22 offen offset:3072 sc1
  s_add_u32 s22, s31, 397312
  buffer_load_dwordx4 v[240:243], v2, s[8:11], s22 offen offset:0 sc1
  buffer_load_dwordx4 v[244:247], v2, s[8:11], s22 offen offset:1024 sc1
  buffer_load_dwordx4 v[248:251], v2, s[8:11], s22 offen offset:2048 sc1
  buffer_load_dwordx4 v[252:255], v2, s[8:11], s22 offen offset:3072 sc1
  s_waitcnt vmcnt(0) lgkmcnt(0)
  s_mov_b32 s31, 0
  s_cmp_lg_u32 s88, 0
  s_cbranch_scc1 cB_sc2_loop
  s_branch cA_sc2_loop
ch_init3:
  s_mul_i32 s31, s17, 401408
  s_add_u32 s31, s31, 33554432
  s_and_b32 s28, s84, 12384
  s_lshl_b32 s22, s85, 16
  s_or_b32 s28, s28, s22
  s_cmp_eq_u32 s28, 4294914144
  s_cbranch_scc1 ch_wx3_ok
  s_mov_b32 s30, 0
ch_wr3:
  buffer_load_dword v9, off, s[12:15], 0 offset:132 sc1
  s_waitcnt vmcnt(0)
  v_cmp_ne_u32 vcc, 1, v9
  s_cbranch_vccz ch_wr3_ok
  s_sleep 8
  s_add_u32 s30, s30, 1
  s_cmp_lt_u32 s30, 400000
  s_cbranch_scc1 ch_wr3
  s_branch cA_abort
ch_wr3_ok:
  s_lshl_b32 s27, s17, 7
  s_add_u32 s27, s27, 584192
  s_mov_b32 s28, 12384
  s_mov_b32 s30, 0
ch_wb3:
  buffer_load_dword v9, off, s[8:11], s27  sc1
  s_waitcnt vmcnt(0)
  v_and_b32 v10, s28, v9
  v_cmp_ne_u32 vcc, s28, v10
  s_cbranch_vccz ch_wb3_ok
  s_sleep 3
  s_add_u32 s30, s30, 1
  s_cmp_lt_u32 s30, 400000
  s_cbranch_scc1 ch_wb3
  s_branch cA_abort
ch_wb3_ok:
  s_mov_b32 s29, 586240
  s_mov_b32 s28, 0xffff
  s_mov_b32 s30, 0
ch_wx3:
  buffer_load_dword v9, off, s[8:11], s29  sc1
  s_waitcnt vmcnt(0)
  v_and_b32 v10, s28, v9
  v_cmp_ne_u32 vcc, s28, v10
  s_cbranch_vccz ch_wx3_ok
  s_sleep 8
  s_add_u32 s30, s30, 1
  s_cmp_lt_u32 s30, 400000
  s_cbranch_scc1 ch_wx3
  s_branch cA_abort
ch_wx3_ok:
  s_add_u32 s22, s31, 315392
  buffer_load_dwordx4 a[224:227], v2, s[8:11], s22 offen offset:0 sc1
  buffer_load_dwordx4 a[228:231], v2, s[8:11], s22 offen offset:1024 sc1
  buffer_load_dwordx4 a[232:235], v2, s[8:11], s22 offen offset:2048 sc1
  buffer_load_dwordx4 a[236:239], v2, s[8:11], s22 offen offset:3072 sc1
  s_add_u32 s22, s31, 319488
  buffer_load_dwordx4 a[240:243], v2, s[8:11], s22 offen offset:0 sc1
  buffer_load_dwordx4 a[244:247], v2, s[8:11], s22 offen offset:1024 sc1
  buffer_load_dwordx4 a[248:251], v2, s[8:11], s22 offen offset:2048 sc1
  buffer_load_dwordx4 a[252:255], v2, s[8:11], s22 offen offset:3072 sc1
  s_add_u32 s22, s31, 323584
  buffer_load_dwordx4 v[120:123], v2, s[8:11], s22 offen offset:0 sc1
  buffer_load_dwordx4 v[124:127], v2, s[8:11], s22 offen offset:1024 sc1
  buffer_load_dwordx4 v[128:131], v2, s[8:11], s22 offen offset:2048 sc1
  buffer_load_dwordx4 v[132:135], v2, s[8:11], s22 offen offset:3072 sc1
  s_add_u32 s22, s31, 327680
  buffer_load_dwordx4 v[136:139], v2, s[8:11], s22 offen offset:0 sc1
  buffer_load_dwordx4 v[140:143], v2, s[8:11], s22 offen offset:1024 sc1
  buffer_load_dwordx4 v[144:147], v2, s[8:11], s22 offen offset:2048 sc1
  buffer_load_dwordx4 v[148:151], v2, s[8:11], s22 offen offset:3072 sc1
  s_add_u32 s22, s31, 331776
  buffer_load_dwordx4 v[152:155], v2, s[8:11], s22 offen offset:0 sc1
  buffer_load_dwordx4 v[156:159], v2, s[8:11], s22 offen offset:1024 sc1
  buffer_load_dwordx4 v[160:163], v2, s[8:11], s22 offen offset:2048 sc1
  buffer_load_dwordx4 v[164:167], v2, s[8:11], s22 offen offset:3072 sc1
  s_add_u32 s22, s31, 335872
  buffer_load_dwordx4 v[168:171], v2, s[8:11], s22 offen offset:0 sc1
  buffer_load_dwordx4 v[172:175], v2, s[8:11], s22 offen offset:1024 sc1
  buffer_load_dwordx4 v[176:179], v2, s[8:11], s22 offen offset:2048 sc1
  buffer_load_dwordx4 v[180:183], v2, s[8:11], s22 offen offset:3072 sc1
  s_mov_b32 s24, 661504
  s_mov_b32 s26, 675840
  v_and_b32 v64, 7, v117
  v_and_b32 v65, 1, v116
  v_lshlrev_b32 v65, 2, v65
  v_sub_u32 v64, v64, v65
  v_lshrrev_b32 v65, 3, v117
  v_lshl_add_u32 v66, v65, 2, v64
  v_cmp_gt_u32 vcc, 4, v64
  v_mov_b32 v67, 99
  s_nop 0
  v_cndmask_b32 v66, v67, v66, vcc
  v_mov_b32 v68, 0x3f80
  v_mov_b32 v69, 0x3f800000
  v_mov_b32 v4, 0
  v_cmp_eq_u32 vcc, 0, v66
  s_nop 1
  v_cndmask_b32 v4, v4, v68, vcc
  v_cmp_eq_u32 vcc, 1, v66
  s_nop 1
  v_cndmask_b32 v4, v4, v69, vcc
  v_mov_b32 v5, 0
  v_cmp_eq_u32 vcc, 2, v66
  s_nop 1
  v_cndmask_b32 v5, v5, v68, vcc
  v_cmp_eq_u32 vcc, 3, v66
  s_nop 1
  v_cndmask_b32 v5, v5, v69, vcc
  v_mov_b32 v6, 0
  v_cmp_eq_u32 vcc, 4, v66
  s_nop 1
  v_cndmask_b32 v6, v6, v68, vcc
  v_cmp_eq_u32 vcc, 5, v66
  s_nop 1
  v_cndmask_b32 v6, v6, v69, vcc
  v_mov_b32 v7, 0
  v_cmp_eq_u32 vcc, 6, v66
  s_nop 1
  v_cndmask_b32 v7, v7, v68, vcc
  v_cmp_eq_u32 vcc, 7, v66
  s_nop 1
  v_cndmask_b32 v7, v7, v69, vcc
  v_lshrrev_b32 v64, 1, v116
  v_lshrrev_b32 v65, 3, v117
  v_and_b32 v66, 1, v116
  v_and_b32 v68, 7, v117
  v_lshlrev_b32 v67, 8, v65
  v_lshl_add_u32 v67, v68, 5, v67
  v_lshl_add_u32 v67, v66, 4, v67
  v_add_u32 v69, 5696, v67
  v_add_u32 v70, 6400, v67
  v_cmp_eq_u32 vcc, v64, v65
  s_nop 1
  v_cndmask_b32 v113, v70, v69, vcc
  v_and_b32 v0, 15, v1
  s_and_b32 s22, s17, 0
  s_lshl_b32 s22, s22, 7
  s_add_u32 s22, s22, 37376
  v_lshl_add_u32 v0, v0, 2, s22
  v_xor_b32 v69, 256, v2
  v_mul_i32_i24 v70, 2048, v66
  v_add_u32 v69, v69, v70
  v_add_u32 v117, 4096, v69
  v_mov_b32 v116, v73
  s_mul_i32 s35, s17, 28672
  s_add_u32 s35, s35, 4325376
  v_mov_b32 v36, 0
  v_mov_b32 v37, 0
  v_mov_b32 v38, 0
  v_mov_b32 v39, 0
  v_mov_b32 v40, 0
  v_mov_b32 v41, 0
  v_mov_b32 v42, 0
  v_mov_b32 v43, 0
  v_mov_b32 v44, 0
  v_mov_b32 v45, 0
  v_mov_b32 v46, 0
  v_mov_b32 v47, 0
  v_mov_b32 v48, 0
  v_mov_b32 v49, 0
  v_mov_b32 v50, 0
  v_mov_b32 v51, 0
  v_mov_b32 v52, 0
  v_mov_b32 v53, 0
  v_mov_b32 v54, 0
  v_mov_b32 v55, 0
  v_mov_b32 v56, 0
  v_mov_b32 v57, 0
  v_mov_b32 v58, 0
  v_mov_b32 v59, 0
  v_mov_b32 v60, 0
  v_mov_b32 v61, 0
  v_mov_b32 v62, 0
  v_mov_b32 v63, 0
  v_mov_b32 v64, 0
  v_mov_b32 v65, 0
  v_mov_b32 v66, 0
  v_mov_b32 v67, 0
  v_mov_b32 v68, 0
  v_mov_b32 v69, 0
  v_mov_b32 v70, 0
  v_mov_b32 v71, 0
  v_mov_b32 v72, 0
  v_mov_b32 v73, 0
  v_mov_b32 v74, 0
  v_mov_b32 v75, 0
  v_mov_b32 v76, 0
  v_mov_b32 v77, 0
  v_mov_b32 v78, 0
  v_mov_b32 v79, 0
  s_mov_b32 s22, 0
  v_lshrrev_b32 v14, 4, v2
  v_add_u32 v14, 192, v14
  v_min_u32 v14, 308, v14
  v_lshlrev_b32 v14, 7, v14
  buffer_load_dword v15, v14, s[8:11], s22 offen sc1
  buffer_load_dwordx4 v[80:83], v117, s[8:11], s24 offen offset:0 sc1
  buffer_load_dwordx4 v[84:87], v117, s[8:11], s24 offen offset:1024 sc1
  buffer_load_dwordx4 v[88:91], v117, s[8:11], s26 offen offset:0 sc1
  buffer_load_dwordx4 v[92:95], v117, s[8:11], s26 offen offset:1024 sc1
  buffer_load_dwordx4 v[96:99], v2, s[8:11], s24 offen offset:0 sc1
  buffer_load_dwordx4 v[100:103], v2, s[8:11], s24 offen offset:1024 sc1
  buffer_load_dwordx4 v[104:107], v2, s[8:11], s26 offen offset:0 sc1
  buffer_load_dwordx4 v[108:111], v2, s[8:11], s26 offen offset:1024 sc1
  s_add_u32 s22, s31, 339968
  buffer_load_dwordx4 v[184:187], v2, s[8:11], s22 offen offset:0 sc1
  buffer_load_dwordx4 v[188:191], v2, s[8:11], s22 offen offset:1024 sc1
  buffer_load_dwordx4 v[192:195], v2, s[8:11], s22 offen offset:2048 sc1
  buffer_load_dwordx4 v[196:199], v2, s[8:11], s22 offen offset:3072 sc1
  s_add_u32 s22, s31, 356352
  buffer_load_dwordx4 v[200:203], v2, s[8:11], s22 offen offset:2048 sc1
  buffer_load_dwordx4 v[204:207], v2, s[8:11], s22 offen offset:3072 sc1
  s_add_u32 s22, s31, 360448
  buffer_load_dwordx4 v[208:211], v2, s[8:11], s22 offen offset:0 sc1
  buffer_load_dwordx4 v[212:215], v2, s[8:11], s22 offen offset:1024 sc1
  buffer_load_dwordx4 v[216:219], v2, s[8:11], s22 offen offset:2048 sc1
  buffer_load_dwordx4 v[220:223], v2, s[8:11], s22 offen offset:3072 sc1
  s_add_u32 s22, s31, 364544
  buffer_load_dwordx4 v[224:227], v2, s[8:11], s22 offen offset:0 sc1
  buffer_load_dwordx4 v[228:231], v2, s[8:11], s22 offen offset:1024 sc1
  buffer_load_dwordx4 v[232:235], v2, s[8:11], s22 offen offset:2048 sc1
  buffer_load_dwordx4 v[236:239], v2, s[8:11], s22 offen offset:3072 sc1
  s_add_u32 s22, s31, 368640
  buffer_load_dwordx4 v[240:243], v2, s[8:11], s22 offen offset:0 sc1
  buffer_load_dwordx4 v[244:247], v2, s[8:11], s22 offen offset:1024 sc1
  buffer_load_dwordx4 v[248:251], v2, s[8:11], s22 offen offset:2048 sc1
  buffer_load_dwordx4 v[252:255], v2, s[8:11], s22 offen offset:3072 sc1
  s_waitcnt vmcnt(0) lgkmcnt(0)
  s_mov_b32 s31, 0
  s_cmp_lg_u32 s88, 0
  s_cbranch_scc1 cB_sc3_loop
  s_branch cA_sc3_loop
ch_init4:
  v_mov_b32 v72, v116
  v_mov_b32 v73, v117
  v_lshrrev_b32 v65, 1, v72
  v_and_b32 v66, 1, v72
  v_mov_b32 v36, 0
  v_mov_b32 v37, 0
  v_mov_b32 v38, 0
  v_mov_b32 v39, 0
  v_mov_b32 v40, 0
  v_mov_b32 v41, 0
  v_mov_b32 v42, 0
  v_mov_b32 v43, 0
  v_mov_b32 v44, 0
  v_mov_b32 v45, 0
  v_mov_b32 v46, 0
  v_mov_b32 v47, 0
  v_mov_b32 v48, 0
  v_mov_b32 v49, 0
  v_mov_b32 v50, 0
  v_mov_b32 v51, 0
  v_mov_b32 v52, 0
  v_mov_b32 v53, 0
  v_mov_b32 v54, 0
  v_mov_b32 v55, 0
  v_mov_b32 v56, 0
  v_mov_b32 v57, 0
  v_mov_b32 v58, 0
  v_mov_b32 v59, 0
  v_mov_b32 v60, 0
  v_mov_b32 v61, 0
  v_mov_b32 v62, 0
  v_mov_b32 v63, 0
  v_lshlrev_b32 v75, 2, v65
  v_lshl_add_u32 v75, v66, 3, v75
  v_add_u32 v67, 0, v73
  v_mul_u32_u24 v68, 2341, v67
  v_lshrrev_b32 v68, 16, v68
  v_mul_u32_u24 v69, 28, v68
  v_sub_u32 v69, v67, v69
  v_lshrrev_b32 v70, 4, v69
  v_and_b32 v69, 15, v69
  v_lshlrev_b32 v71, 12, v70
  v_lshl_add_u32 v71, v68, 8, v71
  v_lshl_add_u32 v71, v69, 4, v71
  v_add_u32 v152, v71, v75
  v_add_u32 v67, 16, v73
  v_mul_u32_u24 v68, 2341, v67
  v_lshrrev_b32 v68, 16, v68
  v_mul_u32_u24 v69, 28, v68
  v_sub_u32 v69, v67, v69
  v_lshrrev_b32 v70, 4, v69
  v_and_b32 v69, 15, v69
  v_lshlrev_b32 v71, 12, v70
  v_lshl_add_u32 v71, v68, 8, v71
  v_lshl_add_u32 v71, v69, 4, v71
  v_add_u32 v153, v71, v75
  v_add_u32 v67, 32, v73
  v_mul_u32_u24 v68, 2341, v67
  v_lshrrev_b32 v68, 16, v68
  v_mul_u32_u24 v69, 28, v68
  v_sub_u32 v69, v67, v69
  v_lshrrev_b32 v70, 4, v69
  v_and_b32 v69, 15, v69
  v_lshlrev_b32 v71, 12, v70
  v_lshl_add_u32 v71, v68, 8, v71
  v_lshl_add_u32 v71, v69, 4, v71
  v_add_u32 v154, v71, v75
  v_add_u32 v67, 48, v73
  v_mul_u32_u24 v68, 2341, v67
  v_lshrrev_b32 v68, 16, v68
  v_mul_u32_u24 v69, 28, v68
  v_sub_u32 v69, v67, v69
  v_lshrrev_b32 v70, 4, v69
  v_and_b32 v69, 15, v69
  v_lshlrev_b32 v71, 12, v70
  v_lshl_add_u32 v71, v68, 8, v71
  v_lshl_add_u32 v71, v69, 4, v71
  v_add_u32 v155, v71, v75
  v_add_u32 v67, 64, v73
  v_mul_u32_u24 v68, 2341, v67
  v_lshrrev_b32 v68, 16, v68
  v_mul_u32_u24 v69, 28, v68
  v_sub_u32 v69, v67, v69
  v_lshrrev_b32 v70, 4, v69
  v_and_b32 v69, 15, v69
  v_lshlrev_b32 v71, 12, v70
  v_lshl_add_u32 v71, v68, 8, v71
  v_lshl_add_u32 v71, v69, 4, v71
  v_add_u32 v156, v71, v75
  v_add_u32 v67, 80, v73
  v_mul_u32_u24 v68, 2341, v67
  v_lshrrev_b32 v68, 16, v68
  v_mul_u32_u24 v69, 28, v68
  v_sub_u32 v69, v67, v69
  v_lshrrev_b32 v70, 4, v69
  v_and_b32 v69, 15, v69
  v_lshlrev_b32 v71, 12, v70
  v_lshl_add_u32 v71, v68, 8, v71
  v_lshl_add_u32 v71, v69, 4, v71
  v_add_u32 v157, v71, v75
  v_mov_b32 v74, 0x40000000
  v_mov_b32 v164, 0
  v_mov_b32 v76, 0
  v_mov_b32 v77, 0
  v_mov_b32 v78, 0
  v_mov_b32 v79, 0
  ds_write_b128 v2, v[76:79] offset:0
  ds_write_b128 v2, v[76:79] offset:1024
  ds_write_b128 v2, v[76:79] offset:2048
  ds_write_b128 v2, v[76:79] offset:3072
  s_and_b32 s22, s17, 0
  s_lshl_b32 s22, s22, 7
  s_add_u32 s22, s22, 35328
  v_lshl_add_u32 v4, v73, 2, s22
  v_and_b32 v64, 1, v73
  v_mov_b32 v5, 0x05040100
  v_mov_b32 v65, 0x03020706
  v_cmp_eq_u32 vcc, 1, v64
  s_nop 1
  v_cndmask_b32 v5, v5, v65, vcc
  s_lshl_b32 s22, s17, 2
  s_add_u32 s22, s22, 37376
  v_lshl_add_u32 v7, v1, 7, s22
  v_cmp_gt_u32 vcc, 1, v1
  s_nop 1
  v_cndmask_b32 v7, v74, v7, vcc
  v_mov_b32 v6, v2
  v_lshl_add_u32 v64, v66, 2, v64
  v_and_b32 v65, 2, v72
  v_add_u32 v64, v64, v65
  s_mul_i32 s22, s17, 16
  v_add_u32 v75, s22, v73
  v_lshrrev_b32 v68, 4, v75
  v_lshlrev_b32 v68, 8, v68
  v_bfe_u32 v69, v75, 1, 1
  v_lshl_add_u32 v68, v69, 7, v68
  v_lshl_add_u32 v68, v64, 4, v68
  v_and_b32 v69, 12, v75
  v_add_u32 v1, v68, v69
  s_mul_i32 s22, s17, 28672
  s_add_u32 s25, s22, 2490368
  s_and_b32 s27, s17, 0
  s_xor_b32 s22, s27, 0
  s_mul_i32 s80, s22, 7168
  s_lshl_b32 s22, s22, 11
  s_add_u32 s76, s22, 9216
  s_xor_b32 s22, s27, 1
  s_mul_i32 s81, s22, 7168
  s_lshl_b32 s22, s22, 11
  s_add_u32 s77, s22, 9216
  s_xor_b32 s22, s27, 2
  s_mul_i32 s82, s22, 7168
  s_lshl_b32 s22, s22, 11
  s_add_u32 s78, s22, 9216
  s_xor_b32 s22, s27, 3
  s_mul_i32 s83, s22, 7168
  s_lshl_b32 s22, s22, 11
  s_add_u32 s79, s22, 9216
  v_mov_b32 v162, -1
  s_mov_b32 s38, 0x40000000
  s_mul_i32 s31, s17, 401408
  s_add_u32 s31, s31, 39976960
  s_mov_b32 s30, 0
ch_wr4:
  buffer_load_dword v9, off, s[12:15], 0 offset:128 sc1
  s_waitcnt vmcnt(0)
  v_cmp_ne_u32 vcc, 1, v9
  s_cbranch_vccz ch_wr4_ok
  s_sleep 8
  s_add_u32 s30, s30, 1
  s_cmp_lt_u32 s30, 400000
  s_cbranch_scc1 ch_wr4
  s_branch cA_abort
ch_wr4_ok:
  s_lshr_b32 s22, s17, 2
  s_lshl_b32 s28, 0x81, s22
  s_mul_i32 s27, s17, 12
  s_add_u32 s22, s27, 256
  s_lshr_b32 s22, s22, 6
  s_lshl_b32 s22, 0x81, s22
  s_or_b32 s28, s28, s22
  s_add_u32 s22, s27, 267
  s_lshr_b32 s22, s22, 6
  s_lshl_b32 s22, 0x81, s22
  s_or_b32 s28, s28, s22
  v_lshrrev_b32 v12, 8, v2
  v_lshlrev_b32 v12, 7, v12
  s_mov_b32 s27, 582144
  s_mov_b32 s30, 0
ch_ww4:
  buffer_load_dword v9, v12, s[8:11], s27 offen sc1
  s_waitcnt vmcnt(0)
  v_and_b32 v10, s28, v9
  v_cmp_ne_u32 vcc, s28, v10
  s_cbranch_vccz ch_ww4_ok
  s_sleep 3
  s_add_u32 s30, s30, 1
  s_cmp_lt_u32 s30, 400000
  s_cbranch_scc1 ch_ww4
  s_branch cA_abort
ch_ww4_ok:
  s_add_u32 s22, s31, 0
  buffer_load_dwordx4 a[0:3], v2, s[8:11], s22 offen offset:0 sc1
  buffer_load_dwordx4 a[4:7], v2, s[8:11], s22 offen offset:1024 sc1
  buffer_load_dwordx4 a[8:11], v2, s[8:11], s22 offen offset:2048 sc1
  buffer_load_dwordx4 a[12:15], v2, s[8:11], s22 offen offset:3072 sc1
  s_add_u32 s22, s31, 4096
  buffer_load_dwordx4 a[16:19], v2, s[8:11], s22 offen offset:0 sc1
  buffer_load_dwordx4 a[20:23], v2, s[8:11], s22 offen offset:1024 sc1
  buffer_load_dwordx4 a[24:27], v2, s[8:11], s22 offen offset:2048 sc1
  buffer_load_dwordx4 a[28:31], v2, s[8:11], s22 offen offset:3072 sc1
  s_add_u32 s22, s31, 8192
  buffer_load_dwordx4 a[32:35], v2, s[8:11], s22 offen offset:0 sc1
  buffer_load_dwordx4 a[36:39], v2, s[8:11], s22 offen offset:1024 sc1
  buffer_load_dwordx4 a[40:43], v2, s[8:11], s22 offen offset:2048 sc1
  buffer_load_dwordx4 a[44:47], v2, s[8:11], s22 offen offset:3072 sc1
  s_add_u32 s22, s31, 12288
  buffer_load_dwordx4 a[48:51], v2, s[8:11], s22 offen offset:0 sc1
  buffer_load_dwordx4 a[52:55], v2, s[8:11], s22 offen offset:1024 sc1
  buffer_load_dwordx4 a[56:59], v2, s[8:11], s22 offen offset:2048 sc1
  buffer_load_dwordx4 a[60:63], v2, s[8:11], s22 offen offset:3072 sc1
  s_add_u32 s22, s31, 16384
  buffer_load_dwordx4 a[64:67], v2, s[8:11], s22 offen offset:0 sc1
  buffer_load_dwordx4 a[68:71], v2, s[8:11], s22 offen offset:1024 sc1
  buffer_load_dwordx4 a[72:75], v2, s[8:11], s22 offen offset:2048 sc1
  buffer_load_dwordx4 a[76:79], v2, s[8:11], s22 offen offset:3072 sc1
  s_add_u32 s22, s31, 20480
  buffer_load_dwordx4 a[80:83], v2, s[8:11], s22 offen offset:0 sc1
  buffer_load_dwordx4 a[84:87], v2, s[8:11], s22 offen offset:1024 sc1
  buffer_load_dwordx4 a[88:91], v2, s[8:11], s22 offen offset:2048 sc1
  buffer_load_dwordx4 a[92:95], v2, s[8:11], s22 offen offset:3072 sc1
  s_add_u32 s22, s31, 24576
  buffer_load_dwordx4 a[96:99], v2, s[8:11], s22 offen offset:0 sc1
  buffer_load_dwordx4 a[100:103], v2, s[8:11], s22 offen offset:1024 sc1
  buffer_load_dwordx4 a[104:107], v2, s[8:11], s22 offen offset:2048 sc1
  buffer_load_dwordx4 a[108:111], v2, s[8:11], s22 offen offset:3072 sc1
  s_add_u32 s22, s31, 28672
  buffer_load_dwordx4 a[112:115], v2, s[8:11], s22 offen offset:0 sc1
  buffer_load_dwordx4 a[116:119], v2, s[8:11], s22 offen offset:1024 sc1
  buffer_load_dwordx4 a[120:123], v2, s[8:11], s22 offen offset:2048 sc1
  buffer_load_dwordx4 a[124:127], v2, s[8:11], s22 offen offset:3072 sc1
  s_waitcnt vmcnt(24)
  s_add_u32 s22, s31, 32768
  buffer_load_dwordx4 a[128:131], v2, s[8:11], s22 offen offset:0 sc1
  buffer_load_dwordx4 a[132:135], v2, s[8:11], s22 offen offset:1024 sc1
  buffer_load_dwordx4 a[136:139], v2, s[8:11], s22 offen offset:2048 sc1
  buffer_load_dwordx4 a[140:143], v2, s[8:11], s22 offen offset:3072 sc1
  s_add_u32 s22, s31, 36864
  buffer_load_dwordx4 a[144:147], v2, s[8:11], s22 offen offset:0 sc1
  buffer_load_dwordx4 a[148:151], v2, s[8:11], s22 offen offset:1024 sc1
  buffer_load_dwordx4 a[152:155], v2, s[8:11], s22 offen offset:2048 sc1
  buffer_load_dwordx4 a[156:159], v2, s[8:11], s22 offen offset:3072 sc1
  s_add_u32 s22, s31, 40960
  buffer_load_dwordx4 a[160:163], v2, s[8:11], s22 offen offset:0 sc1
  buffer_load_dwordx4 a[164:167], v2, s[8:11], s22 offen offset:1024 sc1
  buffer_load_dwordx4 a[168:171], v2, s[8:11], s22 offen offset:2048 sc1
  buffer_load_dwordx4 a[172:175], v2, s[8:11], s22 offen offset:3072 sc1
  s_add_u32 s22, s31, 45056
  buffer_load_dwordx4 a[176:179], v2, s[8:11], s22 offen offset:0 sc1
  buffer_load_dwordx4 a[180:183], v2, s[8:11], s22 offen offset:1024 sc1
  buffer_load_dwordx4 a[184:187], v2, s[8:11], s22 offen offset:2048 sc1
  buffer_load_dwordx4 a[188:191], v2, s[8:11], s22 offen offset:3072 sc1
  s_add_u32 s22, s31, 49152
  buffer_load_dwordx4 a[192:195], v2, s[8:11], s22 offen offset:0 sc1
  buffer_load_dwordx4 a[196:199], v2, s[8:11], s22 offen offset:1024 sc1
  buffer_load_dwordx4 a[200:203], v2, s[8:11], s22 offen offset:2048 sc1
  buffer_load_dwordx4 a[204:207], v2, s[8:11], s22 offen offset:3072 sc1
  s_add_u32 s22, s31, 53248
  buffer_load_dwordx4 a[208:211], v2, s[8:11], s22 offen offset:0 sc1
  buffer_load_dwordx4 a[212:215], v2, s[8:11], s22 offen offset:1024 sc1
  buffer_load_dwordx4 a[216:219], v2, s[8:11], s22 offen offset:2048 sc1
  buffer_load_dwordx4 a[220:223], v2, s[8:11], s22 offen offset:3072 sc1
  s_add_u32 s22, s31, 57344
  buffer_load_dwordx4 a[224:227], v2, s[8:11], s22 offen offset:0 sc1
  buffer_load_dwordx4 a[228:231], v2, s[8:11], s22 offen offset:1024 sc1
  buffer_load_dwordx4 a[232:235], v2, s[8:11], s22 offen offset:2048 sc1
  buffer_load_dwordx4 a[236:239], v2, s[8:11], s22 offen offset:3072 sc1
  s_add_u32 s22, s31, 61440
  buffer_load_dwordx4 a[240:243], v2, s[8:11], s22 offen offset:0 sc1
  buffer_load_dwordx4 a[244:247], v2, s[8:11], s22 offen offset:1024 sc1
  buffer_load_dwordx4 a[248:251], v2, s[8:11], s22 offen offset:2048 sc1
  buffer_load_dwordx4 a[252:255], v2, s[8:11], s22 offen offset:3072 sc1
  s_waitcnt vmcnt(24)
  s_add_u32 s22, s31, 65536
  buffer_load_dwordx4 v[176:179], v2, s[8:11], s22 offen offset:0 sc1
  buffer_load_dwordx4 v[180:183], v2, s[8:11], s22 offen offset:1024 sc1
  buffer_load_dwordx4 v[184:187], v2, s[8:11], s22 offen offset:2048 sc1
  buffer_load_dwordx4 v[188:191], v2, s[8:11], s22 offen offset:3072 sc1
  s_add_u32 s22, s31, 69632
  buffer_load_dwordx4 v[192:195], v2, s[8:11], s22 offen offset:0 sc1
  buffer_load_dwordx4 v[196:199], v2, s[8:11], s22 offen offset:1024 sc1
  buffer_load_dwordx4 v[200:203], v2, s[8:11], s22 offen offset:2048 sc1
  buffer_load_dwordx4 v[204:207], v2, s[8:11], s22 offen offset:3072 sc1
  s_add_u32 s22, s31, 73728
  buffer_load_dwordx4 v[208:211], v2, s[8:11], s22 offen offset:0 sc1
  buffer_load_dwordx4 v[212:215], v2, s[8:11], s22 offen offset:1024 sc1
  buffer_load_dwordx4 v[216:219], v2, s[8:11], s22 offen offset:2048 sc1
  buffer_load_dwordx4 v[220:223], v2, s[8:11], s22 offen offset:3072 sc1
  s_add_u32 s22, s31, 77824
  buffer_load_dwordx4 v[224:227], v2, s[8:11], s22 offen offset:0 sc1
  buffer_load_dwordx4 v[228:231], v2, s[8:11], s22 offen offset:1024 sc1
  buffer_load_dwordx4 v[232:235], v2, s[8:11], s22 offen offset:2048 sc1
  buffer_load_dwordx4 v[236:239], v2, s[8:11], s22 offen offset:3072 sc1
  s_add_u32 s22, s31, 81920
  buffer_load_dwordx4 v[240:243], v2, s[8:11], s22 offen offset:0 sc1
  buffer_load_dwordx4 v[244:247], v2, s[8:11], s22 offen offset:1024 sc1
  buffer_load_dwordx4 v[248:251], v2, s[8:11], s22 offen offset:2048 sc1
  buffer_load_dwordx4 v[252:255], v2, s[8:11], s22 offen offset:3072 sc1
  s_mov_b32 m0, 16384
  s_add_u32 s22, s31, 86016
  buffer_load_dwordx4 v2, s[8:11], s22 offen offset:0 sc1 lds
  buffer_load_dwordx4 v2, s[8:11], s22 offen offset:1024 sc1 lds
  buffer_load_dwordx4 v2, s[8:11], s22 offen offset:2048 sc1 lds
  buffer_load_dwordx4 v2, s[8:11], s22 offen offset:3072 sc1 lds
  s_mov_b32 m0, 20480
  s_add_u32 s22, s31, 90112
  buffer_load_dwordx4 v2, s[8:11], s22 offen offset:0 sc1 lds
  buffer_load_dwordx4 v2, s[8:11], s22 offen offset:1024 sc1 lds
  buffer_load_dwordx4 v2, s[8:11], s22 offen offset:2048 sc1 lds
  buffer_load_dwordx4 v2, s[8:11], s22 offen offset:3072 sc1 lds
  s_mov_b32 m0, 24576
  s_add_u32 s22, s31, 94208
  buffer_load_dwordx4 v2, s[8:11], s22 offen offset:0 sc1 lds
  buffer_load_dwordx4 v2, s[8:11], s22 offen offset:1024 sc1 lds
  buffer_load_dwordx4 v2, s[8:11], s22 offen offset:2048 sc1 lds
  buffer_load_dwordx4 v2, s[8:11], s22 offen offset:3072 sc1 lds
  s_mov_b32 m0, 28672
  s_add_u32 s22, s31, 98304
  buffer_load_dwordx4 v2, s[8:11], s22 offen offset:0 sc1 lds
  buffer_load_dwordx4 v2, s[8:11], s22 offen offset:1024 sc1 lds
  s_mov_b32 s30, 0
ch_ws4:
  buffer_load_dword v9, off, s[12:15], 0 offset:132 sc1
  s_waitcnt vmcnt(0)
  v_cmp_ne_u32 vcc, 1, v9
  s_cbranch_vccz ch_ws4_ok
  s_sleep 8
  s_add_u32 s30, s30, 1
  s_cmp_lt_u32 s30, 400000
  s_cbranch_scc1 ch_ws4
  s_branch cA_abort
ch_ws4_ok:
  s_mul_i32 s33, s17, 532480
  s_add_u32 s33, s33, 78110720
  v_mov_b32 v12, -1
  v_mov_b32 v13, -1
  v_mov_b32 v14, -1
  v_mov_b32 v15, -1
  s_add_u32 s22, s33, 0
  buffer_store_dwordx4 v[12:15], v2, s[8:11], s22 offen sc1
  s_add_u32 s22, s33, 2048
  buffer_store_dwordx4 v[12:15], v2, s[8:11], s22 offen sc1
  s_add_u32 s22, s33, 4096
  buffer_store_dwordx4 v[12:15], v2, s[8:11], s22 offen sc1
  s_add_u32 s22, s33, 6144
  buffer_store_dwordx4 v[12:15], v2, s[8:11], s22 offen sc1
  s_add_u32 s22, s33, 8192
  buffer_store_dwordx4 v[12:15], v2, s[8:11], s22 offen sc1
  s_add_u32 s22, s33, 10240
  buffer_store_dwordx4 v[12:15], v2, s[8:11], s22 offen sc1
  s_add_u32 s22, s33, 12288
  buffer_store_dwordx4 v[12:15], v2, s[8:11], s22 offen sc1
  s_add_u32 s22, s33, 14336
  buffer_store_dwordx4 v[12:15], v2, s[8:11], s22 offen sc1
  v_mov_b32 v16, 1
  v_mov_b32 v17, 1
  s_lshl_b32 s22, s17, 10
  s_add_u32 s22, s22, 566240
  s_waitcnt vmcnt(0)
  s_mov_b64 exec, 3
  buffer_store_dwordx2 v[16:17], v2, s[8:11], s22 offen sc1
  s_mov_b64 exec, -1
  s_mov_b32 s28, s35
  s_waitcnt vmcnt(0) lgkmcnt(0)
  s_mov_b32 s31, 0
  s_cmp_lg_u32 s88, 0
  s_cbranch_scc1 cB_va0_loop
  s_branch cA_va0_loop
ch_init5:
  v_mov_b32 v72, v116
  v_mov_b32 v73, v117
  v_lshrrev_b32 v65, 1, v72
  v_and_b32 v66, 1, v72
  v_mov_b32 v36, 0
  v_mov_b32 v37, 0
  v_mov_b32 v38, 0
  v_mov_b32 v39, 0
  v_mov_b32 v40, 0
  v_mov_b32 v41, 0
  v_mov_b32 v42, 0
  v_mov_b32 v43, 0
  v_mov_b32 v44, 0
  v_mov_b32 v45, 0
  v_mov_b32 v46, 0
  v_mov_b32 v47, 0
  v_mov_b32 v48, 0
  v_mov_b32 v49, 0
  v_mov_b32 v50, 0
  v_mov_b32 v51, 0
  v_mov_b32 v52, 0
  v_mov_b32 v53, 0
  v_mov_b32 v54, 0
  v_mov_b32 v55, 0
  v_mov_b32 v56, 0
  v_mov_b32 v57, 0
  v_mov_b32 v58, 0
  v_mov_b32 v59, 0
  v_mov_b32 v60, 0
  v_mov_b32 v61, 0
  v_mov_b32 v62, 0
  v_mov_b32 v63, 0
  v_lshlrev_b32 v75, 2, v65
  v_lshl_add_u32 v75, v66, 3, v75
  v_add_u32 v67, 112, v73
  v_mul_u32_u24 v68, 2341, v67
  v_lshrrev_b32 v68, 16, v68
  v_mul_u32_u24 v69, 28, v68
  v_sub_u32 v69, v67, v69
  v_lshrrev_b32 v70, 4, v69
  v_and_b32 v69, 15, v69
  v_lshlrev_b32 v71, 12, v70
  v_lshl_add_u32 v71, v68, 8, v71
  v_lshl_add_u32 v71, v69, 4, v71
  v_add_u32 v152, v71, v75
  v_add_u32 v67, 128, v73
  v_mul_u32_u24 v68, 2341, v67
  v_lshrrev_b32 v68, 16, v68
  v_mul_u32_u24 v69, 28, v68
  v_sub_u32 v69, v67, v69
  v_lshrrev_b32 v70, 4, v69
  v_and_b32 v69, 15, v69
  v_lshlrev_b32 v71, 12, v70
  v_lshl_add_u32 v71, v68, 8, v71
  v_lshl_add_u32 v71, v69, 4, v71
  v_add_u32 v153, v71, v75
  v_add_u32 v67, 144, v73
  v_mul_u32_u24 v68, 2341, v67
  v_lshrrev_b32 v68, 16, v68
  v_mul_u32_u24 v69, 28, v68
  v_sub_u32 v69, v67, v69
  v_lshrrev_b32 v70, 4, v69
  v_and_b32 v69, 15, v69
  v_lshlrev_b32 v71, 12, v70
  v_lshl_add_u32 v71, v68, 8, v71
  v_lshl_add_u32 v71, v69, 4, v71
  v_add_u32 v154, v71, v75
  v_add_u32 v67, 160, v73
  v_mul_u32_u24 v68, 2341, v67
  v_lshrrev_b32 v68, 16, v68
  v_mul_u32_u24 v69, 28, v68
  v_sub_u32 v69, v67, v69
  v_lshrrev_b32 v70, 4, v69
  v_and_b32 v69, 15, v69
  v_lshlrev_b32 v71, 12, v70
  v_lshl_add_u32 v71, v68, 8, v71
  v_lshl_add_u32 v71, v69, 4, v71
  v_add_u32 v155, v71, v75
  v_add_u32 v67, 176, v73
  v_mul_u32_u24 v68, 2341, v67
  v_lshrrev_b32 v68, 16, v68
  v_mul_u32_u24 v69, 28, v68
  v_sub_u32 v69, v67, v69
  v_lshrrev_b32 v70, 4, v69
  v_and_b32 v69, 15, v69
  v_lshlrev_b32 v71, 12, v70
  v_lshl_add_u32 v71, v68, 8, v71
  v_lshl_add_u32 v71, v69, 4, v71
  v_add_u32 v156, v71, v75
  v_add_u32 v67, 192, v73
  v_mul_u32_u24 v68, 2341, v67
  v_lshrrev_b32 v68, 16, v68
  v_mul_u32_u24 v69, 28, v68
  v_sub_u32 v69, v67, v69
  v_lshrrev_b32 v70, 4, v69
  v_and_b32 v69, 15, v69
  v_lshlrev_b32 v71, 12, v70
  v_lshl_add_u32 v71, v68, 8, v71
  v_lshl_add_u32 v71, v69, 4, v71
  v_add_u32 v157, v71, v75
  v_add_u32 v67, 208, v73
  v_mul_u32_u24 v68, 2341, v67
  v_lshrrev_b32 v68, 16, v68
  v_mul_u32_u24 v69, 28, v68
  v_sub_u32 v69, v67, v69
  v_lshrrev_b32 v70, 4, v69
  v_and_b32 v69, 15, v69
  v_lshlrev_b32 v71, 12, v70
  v_lshl_add_u32 v71, v68, 8, v71
  v_lshl_add_u32 v71, v69, 4, v71
  v_add_u32 v158, v71, v75
  v_mov_b32 v74, 0x40000000
  v_mov_b32 v164, 0
  v_add_u32 v0, 30720, v2
  v_mov_b32 v76, 0
  v_mov_b32 v77, 0
  v_mov_b32 v78, 0
  v_mov_b32 v79, 0
  ds_write_b128 v2, v[76:79] offset:4096
  ds_write_b128 v2, v[76:79] offset:5120
  ds_write_b128 v2, v[76:79] offset:6144
  ds_write_b128 v2, v[76:79] offset:7168
  s_and_b32 s22, s17, 0
  s_lshl_b32 s22, s22, 7
  s_add_u32 s22, s22, 35328
  v_lshl_add_u32 v4, v73, 2, s22
  v_and_b32 v64, 1, v73
  v_mov_b32 v5, 0x05040100
  v_mov_b32 v65, 0x03020706
  v_cmp_eq_u32 vcc, 1, v64
  s_nop 1
  v_cndmask_b32 v5, v5, v65, vcc
  s_lshl_b32 s22, s17, 2
  s_add_u32 s22, s22, 39424
  v_lshl_add_u32 v7, v1, 7, s22
  v_cmp_gt_u32 vcc, 1, v1
  s_nop 1
  v_cndmask_b32 v7, v74, v7, vcc
  v_min_u32 v65, 11, v73
  v_mad_u32_u24 v65, v72, 12, v65
  v_lshlrev_b32 v6, 4, v65
  v_add_u32 v6, 1024, v6
  v_lshl_add_u32 v64, v66, 2, v64
  v_and_b32 v65, 2, v72
  v_add_u32 v64, v64, v65
  s_mul_i32 s22, s17, 12
  s_add_u32 s22, s22, 256
  v_add_u32 v75, s22, v73
  v_lshrrev_b32 v68, 4, v75
  v_lshlrev_b32 v68, 8, v68
  v_bfe_u32 v69, v75, 1, 1
  v_lshl_add_u32 v68, v69, 7, v68
  v_lshl_add_u32 v68, v64, 4, v68
  v_and_b32 v69, 12, v75
  v_add_u32 v1, v68, v69
  v_cmp_gt_u32 vcc, 12, v73
  s_nop 1
  v_cndmask_b32 v1, v74, v1, vcc
  s_mul_i32 s22, s17, 28672
  s_add_u32 s25, s22, 2490368
  s_and_b32 s27, s17, 0
  s_xor_b32 s22, s27, 0
  s_mul_i32 s80, s22, 7168
  s_lshl_b32 s22, s22, 11
  s_add_u32 s76, s22, 9216
  s_xor_b32 s22, s27, 1
  s_mul_i32 s81, s22, 7168
  s_lshl_b32 s22, s22, 11
  s_add_u32 s77, s22, 9216
  s_xor_b32 s22, s27, 2
  s_mul_i32 s82, s22, 7168
  s_lshl_b32 s22, s22, 11
  s_add_u32 s78, s22, 9216
  s_xor_b32 s22, s27, 3
  s_mul_i32 s83, s22, 7168
  s_lshl_b32 s22, s22, 11
  s_add_u32 s79, s22, 9216
  v_mov_b32 v162, -1
  s_mov_b32 s38, 0x40000000
  s_mul_i32 s31, s17, 401408
  s_add_u32 s31, s31, 40077312
  s_mov_b32 s30, 0
ch_wr5:
  buffer_load_dword v9, off, s[12:15], 0 offset:128 sc1
  s_waitcnt vmcnt(0)
  v_cmp_ne_u32 vcc, 1, v9
  s_cbranch_vccz ch_wr5_ok
  s_sleep 8
  s_add_u32 s30, s30, 1
  s_cmp_lt_u32 s30, 400000
  s_cbranch_scc1 ch_wr5
  s_branch cA_abort
ch_wr5_ok:
  s_lshr_b32 s22, s17, 2
  s_lshl_b32 s28, 0x81, s22
  s_mul_i32 s27, s17, 12
  s_add_u32 s22, s27, 256
  s_lshr_b32 s22, s22, 6
  s_lshl_b32 s22, 0x81, s22
  s_or_b32 s28, s28, s22
  s_add_u32 s22, s27, 267
  s_lshr_b32 s22, s22, 6
  s_lshl_b32 s22, 0x81, s22
  s_or_b32 s28, s28, s22
  v_lshrrev_b32 v12, 8, v2
  v_lshlrev_b32 v12, 7, v12
  s_mov_b32 s27, 582656
  s_mov_b32 s30, 0
ch_ww5:
  buffer_load_dword v9, v12, s[8:11], s27 offen sc1
  s_waitcnt vmcnt(0)
  v_and_b32 v10, s28, v9
  v_cmp_ne_u32 vcc, s28, v10
  s_cbranch_vccz ch_ww5_ok
  s_sleep 3
  s_add_u32 s30, s30, 1
  s_cmp_lt_u32 s30, 400000
  s_cbranch_scc1 ch_ww5
  s_branch cA_abort
ch_ww5_ok:
  s_add_u32 s22, s31, 0
  buffer_load_dwordx4 a[0:3], v2, s[8:11], s22 offen offset:0 sc1
  buffer_load_dwordx4 a[4:7], v2, s[8:11], s22 offen offset:1024 sc1
  buffer_load_dwordx4 a[8:11], v2, s[8:11], s22 offen offset:2048 sc1
  buffer_load_dwordx4 a[12:15], v2, s[8:11], s22 offen offset:3072 sc1
  s_add_u32 s22, s31, 4096
  buffer_load_dwordx4 a[16:19], v2, s[8:11], s22 offen offset:0 sc1
  buffer_load_dwordx4 a[20:23], v2, s[8:11], s22 offen offset:1024 sc1
  buffer_load_dwordx4 a[24:27], v2, s[8:11], s22 offen offset:2048 sc1
  buffer_load_dwordx4 a[28:31], v2, s[8:11], s22 offen offset:3072 sc1
  s_add_u32 s22, s31, 8192
  buffer_load_dwordx4 a[32:35], v2, s[8:11], s22 offen offset:0 sc1
  buffer_load_dwordx4 a[36:39], v2, s[8:11], s22 offen offset:1024 sc1
  buffer_load_dwordx4 a[40:43], v2, s[8:11], s22 offen offset:2048 sc1
  buffer_load_dwordx4 a[44:47], v2, s[8:11], s22 offen offset:3072 sc1
  s_add_u32 s22, s31, 12288
  buffer_load_dwordx4 a[48:51], v2, s[8:11], s22 offen offset:0 sc1
  buffer_load_dwordx4 a[52:55], v2, s[8:11], s22 offen offset:1024 sc1
  buffer_load_dwordx4 a[56:59], v2, s[8:11], s22 offen offset:2048 sc1
  buffer_load_dwordx4 a[60:63], v2, s[8:11], s22 offen offset:3072 sc1
  s_add_u32 s22, s31, 16384
  buffer_load_dwordx4 a[64:67], v2, s[8:11], s22 offen offset:0 sc1
  buffer_load_dwordx4 a[68:71], v2, s[8:11], s22 offen offset:1024 sc1
  buffer_load_dwordx4 a[72:75], v2, s[8:11], s22 offen offset:2048 sc1
  buffer_load_dwordx4 a[76:79], v2, s[8:11], s22 offen offset:3072 sc1
  s_add_u32 s22, s31, 20480
  buffer_load_dwordx4 a[80:83], v2, s[8:11], s22 offen offset:0 sc1
  buffer_load_dwordx4 a[84:87], v2, s[8:11], s22 offen offset:1024 sc1
  buffer_load_dwordx4 a[88:91], v2, s[8:11], s22 offen offset:2048 sc1
  buffer_load_dwordx4 a[92:95], v2, s[8:11], s22 offen offset:3072 sc1
  s_add_u32 s22, s31, 24576
  buffer_load_dwordx4 a[96:99], v2, s[8:11], s22 offen offset:0 sc1
  buffer_load_dwordx4 a[100:103], v2, s[8:11], s22 offen offset:1024 sc1
  buffer_load_dwordx4 a[104:107], v2, s[8:11], s22 offen offset:2048 sc1
  buffer_load_dwordx4 a[108:111], v2, s[8:11], s22 offen offset:3072 sc1
  s_add_u32 s22, s31, 28672
  buffer_load_dwordx4 a[112:115], v2, s[8:11], s22 offen offset:0 sc1
  buffer_load_dwordx4 a[116:119], v2, s[8:11], s22 offen offset:1024 sc1
  buffer_load_dwordx4 a[120:123], v2, s[8:11], s22 offen offset:2048 sc1
  buffer_load_dwordx4 a[124:127], v2, s[8:11], s22 offen offset:3072 sc1
  s_waitcnt vmcnt(24)
  s_add_u32 s22, s31, 32768
  buffer_load_dwordx4 a[128:131], v2, s[8:11], s22 offen offset:0 sc1
  buffer_load_dwordx4 a[132:135], v2, s[8:11], s22 offen offset:1024 sc1
  buffer_load_dwordx4 a[136:139], v2, s[8:11], s22 offen offset:2048 sc1
  buffer_load_dwordx4 a[140:143], v2, s[8:11], s22 offen offset:3072 sc1
  s_add_u32 s22, s31, 36864
  buffer_load_dwordx4 a[144:147], v2, s[8:11], s22 offen offset:0 sc1
  buffer_load_dwordx4 a[148:151], v2, s[8:11], s22 offen offset:1024 sc1
  buffer_load_dwordx4 a[152:155], v2, s[8:11], s22 offen offset:2048 sc1
  buffer_load_dwordx4 a[156:159], v2, s[8:11], s22 offen offset:3072 sc1
  s_add_u32 s22, s31, 40960
  buffer_load_dwordx4 a[160:163], v2, s[8:11], s22 offen offset:0 sc1
  buffer_load_dwordx4 a[164:167], v2, s[8:11], s22 offen offset:1024 sc1
  buffer_load_dwordx4 a[168:171], v2, s[8:11], s22 offen offset:2048 sc1
  buffer_load_dwordx4 a[172:175], v2, s[8:11], s22 offen offset:3072 sc1
  s_add_u32 s22, s31, 45056
  buffer_load_dwordx4 a[176:179], v2, s[8:11], s22 offen offset:0 sc1
  buffer_load_dwordx4 a[180:183], v2, s[8:11], s22 offen offset:1024 sc1
  buffer_load_dwordx4 a[184:187], v2, s[8:11], s22 offen offset:2048 sc1
  buffer_load_dwordx4 a[188:191], v2, s[8:11], s22 offen offset:3072 sc1
  s_add_u32 s22, s31, 49152
  buffer_load_dwordx4 a[192:195], v2, s[8:11], s22 offen offset:0 sc1
  buffer_load_dwordx4 a[196:199], v2, s[8:11], s22 offen offset:1024 sc1
  buffer_load_dwordx4 a[200:203], v2, s[8:11], s22 offen offset:2048 sc1
  buffer_load_dwordx4 a[204:207], v2, s[8:11], s22 offen offset:3072 sc1
  s_add_u32 s22, s31, 53248
  buffer_load_dwordx4 a[208:211], v2, s[8:11], s22 offen offset:0 sc1
  buffer_load_dwordx4 a[212:215], v2, s[8:11], s22 offen offset:1024 sc1
  buffer_load_dwordx4 a[216:219], v2, s[8:11], s22 offen offset:2048 sc1
  buffer_load_dwordx4 a[220:223], v2, s[8:11], s22 offen offset:3072 sc1
  s_add_u32 s22, s31, 57344
  buffer_load_dwordx4 a[224:227], v2, s[8:11], s22 offen offset:0 sc1
  buffer_load_dwordx4 a[228:231], v2, s[8:11], s22 offen offset:1024 sc1
  buffer_load_dwordx4 a[232:235], v2, s[8:11], s22 offen offset:2048 sc1
  buffer_load_dwordx4 a[236:239], v2, s[8:11], s22 offen offset:3072 sc1
  s_add_u32 s22, s31, 61440
  buffer_load_dwordx4 a[240:243], v2, s[8:11], s22 offen offset:0 sc1
  buffer_load_dwordx4 a[244:247], v2, s[8:11], s22 offen offset:1024 sc1
  buffer_load_dwordx4 a[248:251], v2, s[8:11], s22 offen offset:2048 sc1
  buffer_load_dwordx4 a[252:255], v2, s[8:11], s22 offen offset:3072 sc1
  s_waitcnt vmcnt(24)
  s_add_u32 s22, s31, 65536
  buffer_load_dwordx4 v[176:179], v2, s[8:11], s22 offen offset:0 sc1
  buffer_load_dwordx4 v[180:183], v2, s[8:11], s22 offen offset:1024 sc1
  buffer_load_dwordx4 v[184:187], v2, s[8:11], s22 offen offset:2048 sc1
  buffer_load_dwordx4 v[188:191], v2, s[8:11], s22 offen offset:3072 sc1
  s_add_u32 s22, s31, 69632
  buffer_load_dwordx4 v[192:195], v2, s[8:11], s22 offen offset:0 sc1
  buffer_load_dwordx4 v[196:199], v2, s[8:11], s22 offen offset:1024 sc1
  buffer_load_dwordx4 v[200:203], v2, s[8:11], s22 offen offset:2048 sc1
  buffer_load_dwordx4 v[204:207], v2, s[8:11], s22 offen offset:3072 sc1
  s_add_u32 s22, s31, 73728
  buffer_load_dwordx4 v[208:211], v2, s[8:11], s22 offen offset:0 sc1
  buffer_load_dwordx4 v[212:215], v2, s[8:11], s22 offen offset:1024 sc1
  buffer_load_dwordx4 v[216:219], v2, s[8:11], s22 offen offset:2048 sc1
  buffer_load_dwordx4 v[220:223], v2, s[8:11], s22 offen offset:3072 sc1
  s_add_u32 s22, s31, 77824
  buffer_load_dwordx4 v[224:227], v2, s[8:11], s22 offen offset:0 sc1
  buffer_load_dwordx4 v[228:231], v2, s[8:11], s22 offen offset:1024 sc1
  buffer_load_dwordx4 v[232:235], v2, s[8:11], s22 offen offset:2048 sc1
  buffer_load_dwordx4 v[236:239], v2, s[8:11], s22 offen offset:3072 sc1
  s_add_u32 s22, s31, 81920
  buffer_load_dwordx4 v[240:243], v2, s[8:11], s22 offen offset:0 sc1
  buffer_load_dwordx4 v[244:247], v2, s[8:11], s22 offen offset:1024 sc1
  buffer_load_dwordx4 v[248:251], v2, s[8:11], s22 offen offset:2048 sc1
  buffer_load_dwordx4 v[252:255], v2, s[8:11], s22 offen offset:3072 sc1
  s_mov_b32 m0, 30720
  s_add_u32 s22, s31, 86016
  buffer_load_dwordx4 v2, s[8:11], s22 offen offset:0 sc1 lds
  buffer_load_dwordx4 v2, s[8:11], s22 offen offset:1024 sc1 lds
  buffer_load_dwordx4 v2, s[8:11], s22 offen offset:2048 sc1 lds
  buffer_load_dwordx4 v2, s[8:11], s22 offen offset:3072 sc1 lds
  s_mov_b32 m0, 34816
  s_add_u32 s22, s31, 90112
  buffer_load_dwordx4 v2, s[8:11], s22 offen offset:0 sc1 lds
  buffer_load_dwordx4 v2, s[8:11], s22 offen offset:1024 sc1 lds
  buffer_load_dwordx4 v2, s[8:11], s22 offen offset:2048 sc1 lds
  buffer_load_dwordx4 v2, s[8:11], s22 offen offset:3072 sc1 lds
  s_mov_b32 m0, 38912
  s_add_u32 s22, s31, 94208
  buffer_load_dwordx4 v2, s[8:11], s22 offen offset:0 sc1 lds
  buffer_load_dwordx4 v2, s[8:11], s22 offen offset:1024 sc1 lds
  buffer_load_dwordx4 v2, s[8:11], s22 offen offset:2048 sc1 lds
  buffer_load_dwordx4 v2, s[8:11], s22 offen offset:3072 sc1 lds
  s_mov_b32 m0, 43008
  s_add_u32 s22, s31, 98304
  buffer_load_dwordx4 v2, s[8:11], s22 offen offset:0 sc1 lds
  buffer_load_dwordx4 v2, s[8:11], s22 offen offset:1024 sc1 lds
  s_mov_b32 s30, 0
ch_ws5:
  buffer_load_dword v9, off, s[12:15], 0 offset:132 sc1
  s_waitcnt vmcnt(0)
  v_cmp_ne_u32 vcc, 1, v9
  s_cbranch_vccz ch_ws5_ok
  s_sleep 8
  s_add_u32 s30, s30, 1
  s_cmp_lt_u32 s30, 400000
  s_cbranch_scc1 ch_ws5
  s_branch cA_abort
ch_ws5_ok:
  s_mul_i32 s33, s17, 532480
  s_add_u32 s33, s33, 78111744
  v_mov_b32 v12, -1
  v_mov_b32 v13, -1
  v_mov_b32 v14, -1
  v_mov_b32 v15, -1
  s_add_u32 s22, s33, 0
  buffer_store_dwordx4 v[12:15], v2, s[8:11], s22 offen sc1
  s_add_u32 s22, s33, 2048
  buffer_store_dwordx4 v[12:15], v2, s[8:11], s22 offen sc1
  s_add_u32 s22, s33, 4096
  buffer_store_dwordx4 v[12:15], v2, s[8:11], s22 offen sc1
  s_add_u32 s22, s33, 6144
  buffer_store_dwordx4 v[12:15], v2, s[8:11], s22 offen sc1
  s_add_u32 s22, s33, 8192
  buffer_store_dwordx4 v[12:15], v2, s[8:11], s22 offen sc1
  s_add_u32 s22, s33, 10240
  buffer_store_dwordx4 v[12:15], v2, s[8:11], s22 offen sc1
  s_add_u32 s22, s33, 12288
  buffer_store_dwordx4 v[12:15], v2, s[8:11], s22 offen sc1
  s_add_u32 s22, s33, 14336
  buffer_store_dwordx4 v[12:15], v2, s[8:11], s22 offen sc1
  v_mov_b32 v16, 1
  v_mov_b32 v17, 1
  s_lshl_b32 s22, s17, 10
  s_add_u32 s22, s22, 566248
  s_waitcnt vmcnt(0)
  s_mov_b64 exec, 3
  buffer_store_dwordx2 v[16:17], v2, s[8:11], s22 offen sc1
  s_mov_b64 exec, -1
  s_mov_b32 s28, s35
  s_waitcnt vmcnt(0) lgkmcnt(0)
  s_mov_b32 s31, 0
  s_cmp_lg_u32 s88, 0
  s_cbranch_scc1 cB_va1_loop
  s_branch cA_va1_loop
ch_init6:
  v_mov_b32 v72, v116
  v_mov_b32 v73, v117
  v_lshrrev_b32 v65, 1, v72
  v_and_b32 v66, 1, v72
  v_mov_b32 v36, 0
  v_mov_b32 v37, 0
  v_mov_b32 v38, 0
  v_mov_b32 v39, 0
  v_mov_b32 v40, 0
  v_mov_b32 v41, 0
  v_mov_b32 v42, 0
  v_mov_b32 v43, 0
  v_mov_b32 v44, 0
  v_mov_b32 v45, 0
  v_mov_b32 v46, 0
  v_mov_b32 v47, 0
  v_mov_b32 v48, 0
  v_mov_b32 v49, 0
  v_mov_b32 v50, 0
  v_mov_b32 v51, 0
  v_mov_b32 v52, 0
  v_mov_b32 v53, 0
  v_mov_b32 v54, 0
  v_mov_b32 v55, 0
  v_mov_b32 v56, 0
  v_mov_b32 v57, 0
  v_mov_b32 v58, 0
  v_mov_b32 v59, 0
  v_mov_b32 v60, 0
  v_mov_b32 v61, 0
  v_mov_b32 v62, 0
  v_mov_b32 v63, 0
  v_lshlrev_b32 v75, 2, v65
  v_lshl_add_u32 v75, v66, 3, v75
  v_add_u32 v67, 224, v73
  v_mul_u32_u24 v68, 2341, v67
  v_lshrrev_b32 v68, 16, v68
  v_mul_u32_u24 v69, 28, v68
  v_sub_u32 v69, v67, v69
  v_lshrrev_b32 v70, 4, v69
  v_and_b32 v69, 15, v69
  v_lshlrev_b32 v71, 12, v70
  v_lshl_add_u32 v71, v68, 8, v71
  v_lshl_add_u32 v71, v69, 4, v71
  v_add_u32 v104, v71, v75
  v_add_u32 v67, 240, v73
  v_mul_u32_u24 v68, 2341, v67
  v_lshrrev_b32 v68, 16, v68
  v_mul_u32_u24 v69, 28, v68
  v_sub_u32 v69, v67, v69
  v_lshrrev_b32 v70, 4, v69
  v_and_b32 v69, 15, v69
  v_lshlrev_b32 v71, 12, v70
  v_lshl_add_u32 v71, v68, 8, v71
  v_lshl_add_u32 v71, v69, 4, v71
  v_add_u32 v105, v71, v75
  v_add_u32 v67, 256, v73
  v_mul_u32_u24 v68, 2341, v67
  v_lshrrev_b32 v68, 16, v68
  v_mul_u32_u24 v69, 28, v68
  v_sub_u32 v69, v67, v69
  v_lshrrev_b32 v70, 4, v69
  v_and_b32 v69, 15, v69
  v_lshlrev_b32 v71, 12, v70
  v_lshl_add_u32 v71, v68, 8, v71
  v_lshl_add_u32 v71, v69, 4, v71
  v_add_u32 v106, v71, v75
  v_add_u32 v67, 272, v73
  v_mul_u32_u24 v68, 2341, v67
  v_lshrrev_b32 v68, 16, v68
  v_mul_u32_u24 v69, 28, v68
  v_sub_u32 v69, v67, v69
  v_lshrrev_b32 v70, 4, v69
  v_and_b32 v69, 15, v69
  v_lshlrev_b32 v71, 12, v70
  v_lshl_add_u32 v71, v68, 8, v71
  v_lshl_add_u32 v71, v69, 4, v71
  v_add_u32 v107, v71, v75
  v_add_u32 v67, 288, v73
  v_mul_u32_u24 v68, 2341, v67
  v_lshrrev_b32 v68, 16, v68
  v_mul_u32_u24 v69, 28, v68
  v_sub_u32 v69, v67, v69
  v_lshrrev_b32 v70, 4, v69
  v_and_b32 v69, 15, v69
  v_lshlrev_b32 v71, 12, v70
  v_lshl_add_u32 v71, v68, 8, v71
  v_lshl_add_u32 v71, v69, 4, v71
  v_add_u32 v108, v71, v75
  v_add_u32 v67, 304, v73
  v_mul_u32_u24 v68, 2341, v67
  v_lshrrev_b32 v68, 16, v68
  v_mul_u32_u24 v69, 28, v68
  v_sub_u32 v69, v67, v69
  v_lshrrev_b32 v70, 4, v69
  v_and_b32 v69, 15, v69
  v_lshlrev_b32 v71, 12, v70
  v_lshl_add_u32 v71, v68, 8, v71
  v_lshl_add_u32 v71, v69, 4, v71
  v_add_u32 v109, v71, v75
  v_add_u32 v67, 320, v73
  v_mul_u32_u24 v68, 2341, v67
  v_lshrrev_b32 v68, 16, v68
  v_mul_u32_u24 v69, 28, v68
  v_sub_u32 v69, v67, v69
  v_lshrrev_b32 v70, 4, v69
  v_and_b32 v69, 15, v69
  v_lshlrev_b32 v71, 12, v70
  v_lshl_add_u32 v71, v68, 8, v71
  v_lshl_add_u32 v71, v69, 4, v71
  v_add_u32 v110, v71, v75
  v_add_u32 v67, 96, v73
  v_mul_u32_u24 v68, 2341, v67
  v_lshrrev_b32 v68, 16, v68
  v_mul_u32_u24 v69, 28, v68
  v_sub_u32 v69, v67, v69
  v_lshrrev_b32 v70, 4, v69
  v_and_b32 v69, 15, v69
  v_lshlrev_b32 v71, 12, v70
  v_lshl_add_u32 v71, v68, 8, v71
  v_lshl_add_u32 v71, v69, 4, v71
  v_add_u32 v111, v71, v75
  v_mov_b32 v74, 0x40000000
  v_mov_b32 v96, 0
  v_add_u32 v0, 16384, v2
  v_and_b32 v119, 15, v1
  s_and_b32 s22, s17, 0
  s_lshl_b32 s22, s22, 7
  s_add_u32 s22, s22, 39424
  v_lshl_add_u32 v119, v119, 2, s22
  s_lshl_b32 s22, s17, 2
  s_add_u32 s22, s22, 37376
  v_lshl_add_u32 v118, v1, 7, s22
  v_cmp_gt_u32 vcc, 1, v1
  s_nop 1
  v_cndmask_b32 v118, v74, v118, vcc
  s_lshl_b32 s35, s17, 7
  s_add_u32 s35, s35, 524288
  v_mov_b32 v64, 0
  v_mov_b32 v65, 0
  v_mov_b32 v66, 0
  v_mov_b32 v67, 0
  v_min_u32 v116, 13, v1
  s_mul_i32 s22, s17, 14
  v_add_u32 v116, s22, v116
  v_lshlrev_b32 v116, 7, v116
  s_mul_i32 s31, s17, 401408
  s_add_u32 s31, s31, 40177664
  s_mov_b32 s30, 0
ch_wr6:
  buffer_load_dword v9, off, s[12:15], 0 offset:128 sc1
  s_waitcnt vmcnt(0)
  v_cmp_ne_u32 vcc, 1, v9
  s_cbranch_vccz ch_wr6_ok
  s_sleep 8
  s_add_u32 s30, s30, 1
  s_cmp_lt_u32 s30, 400000
  s_cbranch_scc1 ch_wr6
  s_branch cA_abort
ch_wr6_ok:
  s_lshr_b32 s22, s17, 2
  s_lshl_b32 s28, 0x81, s22
  s_mul_i32 s27, s17, 12
  s_add_u32 s22, s27, 256
  s_lshr_b32 s22, s22, 6
  s_lshl_b32 s22, 0x81, s22
  s_or_b32 s28, s28, s22
  s_add_u32 s22, s27, 267
  s_lshr_b32 s22, s22, 6
  s_lshl_b32 s22, 0x81, s22
  s_or_b32 s28, s28, s22
  v_lshrrev_b32 v12, 8, v2
  v_lshlrev_b32 v12, 7, v12
  s_mov_b32 s27, 583168
  s_mov_b32 s30, 0
ch_ww6:
  buffer_load_dword v9, v12, s[8:11], s27 offen sc1
  s_waitcnt vmcnt(0)
  v_and_b32 v10, s28, v9
  v_cmp_ne_u32 vcc, s28, v10
  s_cbranch_vccz ch_ww6_ok
  s_sleep 3
  s_add_u32 s30, s30, 1
  s_cmp_lt_u32 s30, 400000
  s_cbranch_scc1 ch_ww6
  s_branch cA_abort
ch_ww6_ok:
  s_add_u32 s22, s31, 0
  buffer_load_dwordx4 a[0:3], v2, s[8:11], s22 offen offset:0 sc1
  buffer_load_dwordx4 a[4:7], v2, s[8:11], s22 offen offset:1024 sc1
  buffer_load_dwordx4 a[8:11], v2, s[8:11], s22 offen offset:2048 sc1
  buffer_load_dwordx4 a[12:15], v2, s[8:11], s22 offen offset:3072 sc1
  s_add_u32 s22, s31, 4096
  buffer_load_dwordx4 a[16:19], v2, s[8:11], s22 offen offset:0 sc1
  buffer_load_dwordx4 a[20:23], v2, s[8:11], s22 offen offset:1024 sc1
  buffer_load_dwordx4 a[24:27], v2, s[8:11], s22 offen offset:2048 sc1
  buffer_load_dwordx4 a[28:31], v2, s[8:11], s22 offen offset:3072 sc1
  s_add_u32 s22, s31, 8192
  buffer_load_dwordx4 a[32:35], v2, s[8:11], s22 offen offset:0 sc1
  buffer_load_dwordx4 a[36:39], v2, s[8:11], s22 offen offset:1024 sc1
  buffer_load_dwordx4 a[40:43], v2, s[8:11], s22 offen offset:2048 sc1
  buffer_load_dwordx4 a[44:47], v2, s[8:11], s22 offen offset:3072 sc1
  s_add_u32 s22, s31, 12288
  buffer_load_dwordx4 a[48:51], v2, s[8:11], s22 offen offset:0 sc1
  buffer_load_dwordx4 a[52:55], v2, s[8:11], s22 offen offset:1024 sc1
  buffer_load_dwordx4 a[56:59], v2, s[8:11], s22 offen offset:2048 sc1
  buffer_load_dwordx4 a[60:63], v2, s[8:11], s22 offen offset:3072 sc1
  s_add_u32 s22, s31, 16384
  buffer_load_dwordx4 a[64:67], v2, s[8:11], s22 offen offset:0 sc1
  buffer_load_dwordx4 a[68:71], v2, s[8:11], s22 offen offset:1024 sc1
  buffer_load_dwordx4 a[72:75], v2, s[8:11], s22 offen offset:2048 sc1
  buffer_load_dwordx4 a[76:79], v2, s[8:11], s22 offen offset:3072 sc1
  s_add_u32 s22, s31, 20480
  buffer_load_dwordx4 a[80:83], v2, s[8:11], s22 offen offset:0 sc1
  buffer_load_dwordx4 a[84:87], v2, s[8:11], s22 offen offset:1024 sc1
  buffer_load_dwordx4 a[88:91], v2, s[8:11], s22 offen offset:2048 sc1
  buffer_load_dwordx4 a[92:95], v2, s[8:11], s22 offen offset:3072 sc1
  s_add_u32 s22, s31, 24576
  buffer_load_dwordx4 a[96:99], v2, s[8:11], s22 offen offset:0 sc1
  buffer_load_dwordx4 a[100:103], v2, s[8:11], s22 offen offset:1024 sc1
  buffer_load_dwordx4 a[104:107], v2, s[8:11], s22 offen offset:2048 sc1
  buffer_load_dwordx4 a[108:111], v2, s[8:11], s22 offen offset:3072 sc1
  s_add_u32 s22, s31, 28672
  buffer_load_dwordx4 a[112:115], v2, s[8:11], s22 offen offset:0 sc1
  buffer_load_dwordx4 a[116:119], v2, s[8:11], s22 offen offset:1024 sc1
  buffer_load_dwordx4 a[120:123], v2, s[8:11], s22 offen offset:2048 sc1
  buffer_load_dwordx4 a[124:127], v2, s[8:11], s22 offen offset:3072 sc1
  s_waitcnt vmcnt(24)
  s_add_u32 s22, s31, 32768
  buffer_load_dwordx4 a[128:131], v2, s[8:11], s22 offen offset:0 sc1
  buffer_load_dwordx4 a[132:135], v2, s[8:11], s22 offen offset:1024 sc1
  buffer_load_dwordx4 a[136:139], v2, s[8:11], s22 offen offset:2048 sc1
  buffer_load_dwordx4 a[140:143], v2, s[8:11], s22 offen offset:3072 sc1
  s_add_u32 s22, s31, 36864
  buffer_load_dwordx4 a[144:147], v2, s[8:11], s22 offen offset:0 sc1
  buffer_load_dwordx4 a[148:151], v2, s[8:11], s22 offen offset:1024 sc1
  buffer_load_dwordx4 a[152:155], v2, s[8:11], s22 offen offset:2048 sc1
  buffer_load_dwordx4 a[156:159], v2, s[8:11], s22 offen offset:3072 sc1
  s_add_u32 s22, s31, 40960
  buffer_load_dwordx4 a[160:163], v2, s[8:11], s22 offen offset:0 sc1
  buffer_load_dwordx4 a[164:167], v2, s[8:11], s22 offen offset:1024 sc1
  buffer_load_dwordx4 a[168:171], v2, s[8:11], s22 offen offset:2048 sc1
  buffer_load_dwordx4 a[172:175], v2, s[8:11], s22 offen offset:3072 sc1
  s_add_u32 s22, s31, 45056
  buffer_load_dwordx4 a[176:179], v2, s[8:11], s22 offen offset:0 sc1
  buffer_load_dwordx4 a[180:183], v2, s[8:11], s22 offen offset:1024 sc1
  buffer_load_dwordx4 a[184:187], v2, s[8:11], s22 offen offset:2048 sc1
  buffer_load_dwordx4 a[188:191], v2, s[8:11], s22 offen offset:3072 sc1
  s_add_u32 s22, s31, 49152
  buffer_load_dwordx4 a[192:195], v2, s[8:11], s22 offen offset:0 sc1
  buffer_load_dwordx4 a[196:199], v2, s[8:11], s22 offen offset:1024 sc1
  buffer_load_dwordx4 a[200:203], v2, s[8:11], s22 offen offset:2048 sc1
  buffer_load_dwordx4 a[204:207], v2, s[8:11], s22 offen offset:3072 sc1
  s_add_u32 s22, s31, 53248
  buffer_load_dwordx4 a[208:211], v2, s[8:11], s22 offen offset:0 sc1
  buffer_load_dwordx4 a[212:215], v2, s[8:11], s22 offen offset:1024 sc1
  buffer_load_dwordx4 a[216:219], v2, s[8:11], s22 offen offset:2048 sc1
  buffer_load_dwordx4 a[220:223], v2, s[8:11], s22 offen offset:3072 sc1
  s_add_u32 s22, s31, 57344
  buffer_load_dwordx4 a[224:227], v2, s[8:11], s22 offen offset:0 sc1
  buffer_load_dwordx4 a[228:231], v2, s[8:11], s22 offen offset:1024 sc1
  buffer_load_dwordx4 a[232:235], v2, s[8:11], s22 offen offset:2048 sc1
  buffer_load_dwordx4 a[236:239], v2, s[8:11], s22 offen offset:3072 sc1
  s_add_u32 s22, s31, 61440
  buffer_load_dwordx4 a[240:243], v2, s[8:11], s22 offen offset:0 sc1
  buffer_load_dwordx4 a[244:247], v2, s[8:11], s22 offen offset:1024 sc1
  buffer_load_dwordx4 a[248:251], v2, s[8:11], s22 offen offset:2048 sc1
  buffer_load_dwordx4 a[252:255], v2, s[8:11], s22 offen offset:3072 sc1
  s_waitcnt vmcnt(24)
  s_add_u32 s22, s31, 65536
  buffer_load_dwordx4 v[120:123], v2, s[8:11], s22 offen offset:0 sc1
  buffer_load_dwordx4 v[124:127], v2, s[8:11], s22 offen offset:1024 sc1
  buffer_load_dwordx4 v[128:131], v2, s[8:11], s22 offen offset:2048 sc1
  buffer_load_dwordx4 v[132:135], v2, s[8:11], s22 offen offset:3072 sc1
  s_add_u32 s22, s31, 69632
  buffer_load_dwordx4 v[136:139], v2, s[8:11], s22 offen offset:0 sc1
  buffer_load_dwordx4 v[140:143], v2, s[8:11], s22 offen offset:1024 sc1
  buffer_load_dwordx4 v[144:147], v2, s[8:11], s22 offen offset:2048 sc1
  buffer_load_dwordx4 v[148:151], v2, s[8:11], s22 offen offset:3072 sc1
  s_add_u32 s22, s31, 73728
  buffer_load_dwordx4 v[152:155], v2, s[8:11], s22 offen offset:0 sc1
  buffer_load_dwordx4 v[156:159], v2, s[8:11], s22 offen offset:1024 sc1
  buffer_load_dwordx4 v[160:163], v2, s[8:11], s22 offen offset:2048 sc1
  buffer_load_dwordx4 v[164:167], v2, s[8:11], s22 offen offset:3072 sc1
  s_add_u32 s22, s31, 77824
  buffer_load_dwordx4 v[168:171], v2, s[8:11], s22 offen offset:0 sc1
  buffer_load_dwordx4 v[172:175], v2, s[8:11], s22 offen offset:1024 sc1
  buffer_load_dwordx4 v[176:179], v2, s[8:11], s22 offen offset:2048 sc1
  buffer_load_dwordx4 v[180:183], v2, s[8:11], s22 offen offset:3072 sc1
  s_add_u32 s22, s31, 81920
  buffer_load_dwordx4 v[184:187], v2, s[8:11], s22 offen offset:0 sc1
  buffer_load_dwordx4 v[188:191], v2, s[8:11], s22 offen offset:1024 sc1
  buffer_load_dwordx4 v[192:195], v2, s[8:11], s22 offen offset:2048 sc1
  buffer_load_dwordx4 v[196:199], v2, s[8:11], s22 offen offset:3072 sc1
  s_add_u32 s22, s31, 86016
  buffer_load_dwordx4 v[200:203], v2, s[8:11], s22 offen offset:0 sc1
  buffer_load_dwordx4 v[204:207], v2, s[8:11], s22 offen offset:1024 sc1
  buffer_load_dwordx4 v[208:211], v2, s[8:11], s22 offen offset:2048 sc1
  buffer_load_dwordx4 v[212:215], v2, s[8:11], s22 offen offset:3072 sc1
  s_add_u32 s22, s31, 90112
  buffer_load_dwordx4 v[216:219], v2, s[8:11], s22 offen offset:0 sc1
  buffer_load_dwordx4 v[220:223], v2, s[8:11], s22 offen offset:1024 sc1
  buffer_load_dwordx4 v[224:227], v2, s[8:11], s22 offen offset:2048 sc1
  buffer_load_dwordx4 v[228:231], v2, s[8:11], s22 offen offset:3072 sc1
  s_add_u32 s22, s31, 94208
  buffer_load_dwordx4 v[232:235], v2, s[8:11], s22 offen offset:0 sc1
  buffer_load_dwordx4 v[236:239], v2, s[8:11], s22 offen offset:1024 sc1
  buffer_load_dwordx4 v[240:243], v2, s[8:11], s22 offen offset:2048 sc1
  buffer_load_dwordx4 v[244:247], v2, s[8:11], s22 offen offset:3072 sc1
  s_waitcnt vmcnt(24)
  s_add_u32 s22, s31, 98304
  buffer_load_dwordx4 v[248:251], v2, s[8:11], s22 offen offset:0 sc1
  buffer_load_dwordx4 v[252:255], v2, s[8:11], s22 offen offset:1024 sc1
  s_mov_b32 s30, 0
ch_ws6:
  buffer_load_dword v9, off, s[12:15], 0 offset:132 sc1
  s_waitcnt vmcnt(0)
  v_cmp_ne_u32 vcc, 1, v9
  s_cbranch_vccz ch_ws6_ok
  s_sleep 8
  s_add_u32 s30, s30, 1
  s_cmp_lt_u32 s30, 400000
  s_cbranch_scc1 ch_ws6
  s_branch cA_abort
ch_ws6_ok:
  s_lshl_b32 s27, s17, 7
  s_add_u32 s27, s27, 524288
  s_mov_b32 s30, 0
ch_vw2:
  buffer_load_dword v9, off, s[8:11], s27 sc1
  s_waitcnt vmcnt(0)
  v_cmp_ne_u32 vcc, 56, v9
  s_cbranch_vccz ch_vw2_d
  s_sleep 2
  s_add_u32 s30, s30, 1
  s_cmp_lt_u32 s30, 400000
  s_cbranch_scc1 ch_vw2
  s_branch cA_abort
ch_vw2_d:
  s_mov_b32 s28, s35
  s_waitcnt vmcnt(0) lgkmcnt(0)
  s_mov_b32 s31, 0
  s_cmp_lg_u32 s88, 0
  s_cbranch_scc1 cB_va2_loop
  s_branch cA_va2_loop
ch_init7:
  v_mov_b32 v72, v116
  v_mov_b32 v73, v117
  v_lshrrev_b32 v65, 1, v72
  v_and_b32 v66, 1, v72
  v_mov_b32 v36, 0
  v_mov_b32 v37, 0
  v_mov_b32 v38, 0
  v_mov_b32 v39, 0
  v_mov_b32 v40, 0
  v_mov_b32 v41, 0
  v_mov_b32 v42, 0
  v_mov_b32 v43, 0
  v_mov_b32 v44, 0
  v_mov_b32 v45, 0
  v_mov_b32 v46, 0
  v_mov_b32 v47, 0
  v_mov_b32 v48, 0
  v_mov_b32 v49, 0
  v_mov_b32 v50, 0
  v_mov_b32 v51, 0
  v_mov_b32 v52, 0
  v_mov_b32 v53, 0
  v_mov_b32 v54, 0
  v_mov_b32 v55, 0
  v_mov_b32 v56, 0
  v_mov_b32 v57, 0
  v_mov_b32 v58, 0
  v_mov_b32 v59, 0
  v_mov_b32 v60, 0
  v_mov_b32 v61, 0
  v_mov_b32 v62, 0
  v_mov_b32 v63, 0
  v_lshlrev_b32 v75, 2, v65
  v_lshl_add_u32 v75, v66, 3, v75
  v_add_u32 v67, 336, v73
  v_mul_u32_u24 v68, 2341, v67
  v_lshrrev_b32 v68, 16, v68
  v_mul_u32_u24 v69, 28, v68
  v_sub_u32 v69, v67, v69
  v_lshrrev_b32 v70, 4, v69
  v_and_b32 v69, 15, v69
  v_lshlrev_b32 v71, 12, v70
  v_lshl_add_u32 v71, v68, 8, v71
  v_lshl_add_u32 v71, v69, 4, v71
  v_add_u32 v104, v71, v75
  v_add_u32 v67, 352, v73
  v_mul_u32_u24 v68, 2341, v67
  v_lshrrev_b32 v68, 16, v68
  v_mul_u32_u24 v69, 28, v68
  v_sub_u32 v69, v67, v69
  v_lshrrev_b32 v70, 4, v69
  v_and_b32 v69, 15, v69
  v_lshlrev_b32 v71, 12, v70
  v_lshl_add_u32 v71, v68, 8, v71
  v_lshl_add_u32 v71, v69, 4, v71
  v_add_u32 v105, v71, v75
  v_add_u32 v67, 368, v73
  v_mul_u32_u24 v68, 2341, v67
  v_lshrrev_b32 v68, 16, v68
  v_mul_u32_u24 v69, 28, v68
  v_sub_u32 v69, v67, v69
  v_lshrrev_b32 v70, 4, v69
  v_and_b32 v69, 15, v69
  v_lshlrev_b32 v71, 12, v70
  v_lshl_add_u32 v71, v68, 8, v71
  v_lshl_add_u32 v71, v69, 4, v71
  v_add_u32 v106, v71, v75
  v_add_u32 v67, 384, v73
  v_mul_u32_u24 v68, 2341, v67
  v_lshrrev_b32 v68, 16, v68
  v_mul_u32_u24 v69, 28, v68
  v_sub_u32 v69, v67, v69
  v_lshrrev_b32 v70, 4, v69
  v_and_b32 v69, 15, v69
  v_lshlrev_b32 v71, 12, v70
  v_lshl_add_u32 v71, v68, 8, v71
  v_lshl_add_u32 v71, v69, 4, v71
  v_add_u32 v107, v71, v75
  v_add_u32 v67, 400, v73
  v_mul_u32_u24 v68, 2341, v67
  v_lshrrev_b32 v68, 16, v68
  v_mul_u32_u24 v69, 28, v68
  v_sub_u32 v69, v67, v69
  v_lshrrev_b32 v70, 4, v69
  v_and_b32 v69, 15, v69
  v_lshlrev_b32 v71, 12, v70
  v_lshl_add_u32 v71, v68, 8, v71
  v_lshl_add_u32 v71, v69, 4, v71
  v_add_u32 v108, v71, v75
  v_add_u32 v67, 416, v73
  v_mul_u32_u24 v68, 2341, v67
  v_lshrrev_b32 v68, 16, v68
  v_mul_u32_u24 v69, 28, v68
  v_sub_u32 v69, v67, v69
  v_lshrrev_b32 v70, 4, v69
  v_and_b32 v69, 15, v69
  v_lshlrev_b32 v71, 12, v70
  v_lshl_add_u32 v71, v68, 8, v71
  v_lshl_add_u32 v71, v69, 4, v71
  v_add_u32 v109, v71, v75
  v_add_u32 v67, 432, v73
  v_mul_u32_u24 v68, 2341, v67
  v_lshrrev_b32 v68, 16, v68
  v_mul_u32_u24 v69, 28, v68
  v_sub_u32 v69, v67, v69
  v_lshrrev_b32 v70, 4, v69
  v_and_b32 v69, 15, v69
  v_lshlrev_b32 v71, 12, v70
  v_lshl_add_u32 v71, v68, 8, v71
  v_lshl_add_u32 v71, v69, 4, v71
  v_add_u32 v110, v71, v75
  v_mov_b32 v74, 0x40000000
  v_mov_b32 v96, 0
  v_and_b32 v119, 15, v1
  s_and_b32 s22, s17, 0
  s_lshl_b32 s22, s22, 7
  s_add_u32 s22, s22, 39424
  v_lshl_add_u32 v119, v119, 2, s22
  s_lshl_b32 s22, s17, 2
  s_add_u32 s22, s22, 37376
  v_lshl_add_u32 v118, v1, 7, s22
  v_cmp_gt_u32 vcc, 1, v1
  s_nop 1
  v_cndmask_b32 v118, v74, v118, vcc
  s_lshl_b32 s35, s17, 7
  s_add_u32 s35, s35, 524288
  v_mov_b32 v64, 0
  v_mov_b32 v65, 0
  v_mov_b32 v66, 0
  v_mov_b32 v67, 0
  v_min_u32 v116, 13, v1
  s_mul_i32 s22, s17, 14
  v_add_u32 v116, s22, v116
  v_lshlrev_b32 v116, 7, v116
  s_mul_i32 s31, s17, 401408
  s_add_u32 s31, s31, 40278016
  s_mov_b32 s30, 0
ch_wr7:
  buffer_load_dword v9, off, s[12:15], 0 offset:128 sc1
  s_waitcnt vmcnt(0)
  v_cmp_ne_u32 vcc, 1, v9
  s_cbranch_vccz ch_wr7_ok
  s_sleep 8
  s_add_u32 s30, s30, 1
  s_cmp_lt_u32 s30, 400000
  s_cbranch_scc1 ch_wr7
  s_branch cA_abort
ch_wr7_ok:
  s_lshr_b32 s22, s17, 2
  s_lshl_b32 s28, 0x81, s22
  s_mul_i32 s27, s17, 12
  s_add_u32 s22, s27, 256
  s_lshr_b32 s22, s22, 6
  s_lshl_b32 s22, 0x81, s22
  s_or_b32 s28, s28, s22
  s_add_u32 s22, s27, 267
  s_lshr_b32 s22, s22, 6
  s_lshl_b32 s22, 0x81, s22
  s_or_b32 s28, s28, s22
  v_lshrrev_b32 v12, 8, v2
  v_lshlrev_b32 v12, 7, v12
  s_mov_b32 s27, 583680
  s_mov_b32 s30, 0
ch_ww7:
  buffer_load_dword v9, v12, s[8:11], s27 offen sc1
  s_waitcnt vmcnt(0)
  v_and_b32 v10, s28, v9
  v_cmp_ne_u32 vcc, s28, v10
  s_cbranch_vccz ch_ww7_ok
  s_sleep 3
  s_add_u32 s30, s30, 1
  s_cmp_lt_u32 s30, 400000
  s_cbranch_scc1 ch_ww7
  s_branch cA_abort
ch_ww7_ok:
  s_add_u32 s22, s31, 0
  buffer_load_dwordx4 a[0:3], v2, s[8:11], s22 offen offset:0 sc1
  buffer_load_dwordx4 a[4:7], v2, s[8:11], s22 offen offset:1024 sc1
  buffer_load_dwordx4 a[8:11], v2, s[8:11], s22 offen offset:2048 sc1
  buffer_load_dwordx4 a[12:15], v2, s[8:11], s22 offen offset:3072 sc1
  s_add_u32 s22, s31, 4096
  buffer_load_dwordx4 a[16:19], v2, s[8:11], s22 offen offset:0 sc1
  buffer_load_dwordx4 a[20:23], v2, s[8:11], s22 offen offset:1024 sc1
  buffer_load_dwordx4 a[24:27], v2, s[8:11], s22 offen offset:2048 sc1
  buffer_load_dwordx4 a[28:31], v2, s[8:11], s22 offen offset:3072 sc1
  s_add_u32 s22, s31, 8192
  buffer_load_dwordx4 a[32:35], v2, s[8:11], s22 offen offset:0 sc1
  buffer_load_dwordx4 a[36:39], v2, s[8:11], s22 offen offset:1024 sc1
  buffer_load_dwordx4 a[40:43], v2, s[8:11], s22 offen offset:2048 sc1
  buffer_load_dwordx4 a[44:47], v2, s[8:11], s22 offen offset:3072 sc1
  s_add_u32 s22, s31, 12288
  buffer_load_dwordx4 a[48:51], v2, s[8:11], s22 offen offset:0 sc1
  buffer_load_dwordx4 a[52:55], v2, s[8:11], s22 offen offset:1024 sc1
  buffer_load_dwordx4 a[56:59], v2, s[8:11], s22 offen offset:2048 sc1
  buffer_load_dwordx4 a[60:63], v2, s[8:11], s22 offen offset:3072 sc1
  s_add_u32 s22, s31, 16384
  buffer_load_dwordx4 a[64:67], v2, s[8:11], s22 offen offset:0 sc1
  buffer_load_dwordx4 a[68:71], v2, s[8:11], s22 offen offset:1024 sc1
  buffer_load_dwordx4 a[72:75], v2, s[8:11], s22 offen offset:2048 sc1
  buffer_load_dwordx4 a[76:79], v2, s[8:11], s22 offen offset:3072 sc1
  s_add_u32 s22, s31, 20480
  buffer_load_dwordx4 a[80:83], v2, s[8:11], s22 offen offset:0 sc1
  buffer_load_dwordx4 a[84:87], v2, s[8:11], s22 offen offset:1024 sc1
  buffer_load_dwordx4 a[88:91], v2, s[8:11], s22 offen offset:2048 sc1
  buffer_load_dwordx4 a[92:95], v2, s[8:11], s22 offen offset:3072 sc1
  s_add_u32 s22, s31, 24576
  buffer_load_dwordx4 a[96:99], v2, s[8:11], s22 offen offset:0 sc1
  buffer_load_dwordx4 a[100:103], v2, s[8:11], s22 offen offset:1024 sc1
  buffer_load_dwordx4 a[104:107], v2, s[8:11], s22 offen offset:2048 sc1
  buffer_load_dwordx4 a[108:111], v2, s[8:11], s22 offen offset:3072 sc1
  s_add_u32 s22, s31, 28672
  buffer_load_dwordx4 a[112:115], v2, s[8:11], s22 offen offset:0 sc1
  buffer_load_dwordx4 a[116:119], v2, s[8:11], s22 offen offset:1024 sc1
  buffer_load_dwordx4 a[120:123], v2, s[8:11], s22 offen offset:2048 sc1
  buffer_load_dwordx4 a[124:127], v2, s[8:11], s22 offen offset:3072 sc1
  s_waitcnt vmcnt(24)
  s_add_u32 s22, s31, 32768
  buffer_load_dwordx4 a[128:131], v2, s[8:11], s22 offen offset:0 sc1
  buffer_load_dwordx4 a[132:135], v2, s[8:11], s22 offen offset:1024 sc1
  buffer_load_dwordx4 a[136:139], v2, s[8:11], s22 offen offset:2048 sc1
  buffer_load_dwordx4 a[140:143], v2, s[8:11], s22 offen offset:3072 sc1
  s_add_u32 s22, s31, 36864
  buffer_load_dwordx4 a[144:147], v2, s[8:11], s22 offen offset:0 sc1
  buffer_load_dwordx4 a[148:151], v2, s[8:11], s22 offen offset:1024 sc1
  buffer_load_dwordx4 a[152:155], v2, s[8:11], s22 offen offset:2048 sc1
  buffer_load_dwordx4 a[156:159], v2, s[8:11], s22 offen offset:3072 sc1
  s_add_u32 s22, s31, 40960
  buffer_load_dwordx4 a[160:163], v2, s[8:11], s22 offen offset:0 sc1
  buffer_load_dwordx4 a[164:167], v2, s[8:11], s22 offen offset:1024 sc1
  buffer_load_dwordx4 a[168:171], v2, s[8:11], s22 offen offset:2048 sc1
  buffer_load_dwordx4 a[172:175], v2, s[8:11], s22 offen offset:3072 sc1
  s_add_u32 s22, s31, 45056
  buffer_load_dwordx4 a[176:179], v2, s[8:11], s22 offen offset:0 sc1
  buffer_load_dwordx4 a[180:183], v2, s[8:11], s22 offen offset:1024 sc1
  buffer_load_dwordx4 a[184:187], v2, s[8:11], s22 offen offset:2048 sc1
  buffer_load_dwordx4 a[188:191], v2, s[8:11], s22 offen offset:3072 sc1
  s_add_u32 s22, s31, 49152
  buffer_load_dwordx4 a[192:195], v2, s[8:11], s22 offen offset:0 sc1
  buffer_load_dwordx4 a[196:199], v2, s[8:11], s22 offen offset:1024 sc1
  buffer_load_dwordx4 a[200:203], v2, s[8:11], s22 offen offset:2048 sc1
  buffer_load_dwordx4 a[204:207], v2, s[8:11], s22 offen offset:3072 sc1
  s_add_u32 s22, s31, 53248
  buffer_load_dwordx4 a[208:211], v2, s[8:11], s22 offen offset:0 sc1
  buffer_load_dwordx4 a[212:215], v2, s[8:11], s22 offen offset:1024 sc1
  buffer_load_dwordx4 a[216:219], v2, s[8:11], s22 offen offset:2048 sc1
  buffer_load_dwordx4 a[220:223], v2, s[8:11], s22 offen offset:3072 sc1
  s_add_u32 s22, s31, 57344
  buffer_load_dwordx4 a[224:227], v2, s[8:11], s22 offen offset:0 sc1
  buffer_load_dwordx4 a[228:231], v2, s[8:11], s22 offen offset:1024 sc1
  buffer_load_dwordx4 a[232:235], v2, s[8:11], s22 offen offset:2048 sc1
  buffer_load_dwordx4 a[236:239], v2, s[8:11], s22 offen offset:3072 sc1
  s_add_u32 s22, s31, 61440
  buffer_load_dwordx4 a[240:243], v2, s[8:11], s22 offen offset:0 sc1
  buffer_load_dwordx4 a[244:247], v2, s[8:11], s22 offen offset:1024 sc1
  buffer_load_dwordx4 a[248:251], v2, s[8:11], s22 offen offset:2048 sc1
  buffer_load_dwordx4 a[252:255], v2, s[8:11], s22 offen offset:3072 sc1
  s_waitcnt vmcnt(24)
  s_add_u32 s22, s31, 65536
  buffer_load_dwordx4 v[120:123], v2, s[8:11], s22 offen offset:0 sc1
  buffer_load_dwordx4 v[124:127], v2, s[8:11], s22 offen offset:1024 sc1
  buffer_load_dwordx4 v[128:131], v2, s[8:11], s22 offen offset:2048 sc1
  buffer_load_dwordx4 v[132:135], v2, s[8:11], s22 offen offset:3072 sc1
  s_add_u32 s22, s31, 69632
  buffer_load_dwordx4 v[136:139], v2, s[8:11], s22 offen offset:0 sc1
  buffer_load_dwordx4 v[140:143], v2, s[8:11], s22 offen offset:1024 sc1
  buffer_load_dwordx4 v[144:147], v2, s[8:11], s22 offen offset:2048 sc1
  buffer_load_dwordx4 v[148:151], v2, s[8:11], s22 offen offset:3072 sc1
  s_add_u32 s22, s31, 73728
  buffer_load_dwordx4 v[152:155], v2, s[8:11], s22 offen offset:0 sc1
  buffer_load_dwordx4 v[156:159], v2, s[8:11], s22 offen offset:1024 sc1
  buffer_load_dwordx4 v[160:163], v2, s[8:11], s22 offen offset:2048 sc1
  buffer_load_dwordx4 v[164:167], v2, s[8:11], s22 offen offset:3072 sc1
  s_add_u32 s22, s31, 77824
  buffer_load_dwordx4 v[168:171], v2, s[8:11], s22 offen offset:0 sc1
  buffer_load_dwordx4 v[172:175], v2, s[8:11], s22 offen offset:1024 sc1
  buffer_load_dwordx4 v[176:179], v2, s[8:11], s22 offen offset:2048 sc1
  buffer_load_dwordx4 v[180:183], v2, s[8:11], s22 offen offset:3072 sc1
  s_add_u32 s22, s31, 81920
  buffer_load_dwordx4 v[184:187], v2, s[8:11], s22 offen offset:0 sc1
  buffer_load_dwordx4 v[188:191], v2, s[8:11], s22 offen offset:1024 sc1
  buffer_load_dwordx4 v[192:195], v2, s[8:11], s22 offen offset:2048 sc1
  buffer_load_dwordx4 v[196:199], v2, s[8:11], s22 offen offset:3072 sc1
  s_add_u32 s22, s31, 86016
  buffer_load_dwordx4 v[200:203], v2, s[8:11], s22 offen offset:0 sc1
  buffer_load_dwordx4 v[204:207], v2, s[8:11], s22 offen offset:1024 sc1
  buffer_load_dwordx4 v[208:211], v2, s[8:11], s22 offen offset:2048 sc1
  buffer_load_dwordx4 v[212:215], v2, s[8:11], s22 offen offset:3072 sc1
  s_add_u32 s22, s31, 90112
  buffer_load_dwordx4 v[216:219], v2, s[8:11], s22 offen offset:0 sc1
  buffer_load_dwordx4 v[220:223], v2, s[8:11], s22 offen offset:1024 sc1
  buffer_load_dwordx4 v[224:227], v2, s[8:11], s22 offen offset:2048 sc1
  buffer_load_dwordx4 v[228:231], v2, s[8:11], s22 offen offset:3072 sc1
  s_add_u32 s22, s31, 94208
  buffer_load_dwordx4 v[232:235], v2, s[8:11], s22 offen offset:0 sc1
  buffer_load_dwordx4 v[236:239], v2, s[8:11], s22 offen offset:1024 sc1
  buffer_load_dwordx4 v[240:243], v2, s[8:11], s22 offen offset:2048 sc1
  buffer_load_dwordx4 v[244:247], v2, s[8:11], s22 offen offset:3072 sc1
  s_waitcnt vmcnt(24)
  s_add_u32 s22, s31, 98304
  buffer_load_dwordx4 v[248:251], v2, s[8:11], s22 offen offset:0 sc1
  buffer_load_dwordx4 v[252:255], v2, s[8:11], s22 offen offset:1024 sc1
  s_mov_b32 s30, 0
ch_ws7:
  buffer_load_dword v9, off, s[12:15], 0 offset:132 sc1
  s_waitcnt vmcnt(0)
  v_cmp_ne_u32 vcc, 1, v9
  s_cbranch_vccz ch_ws7_ok
  s_sleep 8
  s_add_u32 s30, s30, 1
  s_cmp_lt_u32 s30, 400000
  s_cbranch_scc1 ch_ws7
  s_branch cA_abort
ch_ws7_ok:
  s_lshl_b32 s27, s17, 7
  s_add_u32 s27, s27, 524288
  s_mov_b32 s30, 0
ch_vw3:
  buffer_load_dword v9, off, s[8:11], s27 sc1
  s_waitcnt vmcnt(0)
  v_cmp_ne_u32 vcc, 56, v9
  s_cbranch_vccz ch_vw3_d
  s_sleep 2
  s_add_u32 s30, s30, 1
  s_cmp_lt_u32 s30, 400000
  s_cbranch_scc1 ch_vw3
  s_branch cA_abort
ch_vw3_d:
  s_mov_b32 s28, s35
  s_mov_b32 s39, 684032
  buffer_load_dword v100, v116, s[8:11], s39 offen sc1
  s_mov_b32 s39, 712704
  s_waitcnt vmcnt(1) lgkmcnt(0)
  s_mov_b32 s31, 0
  s_cmp_lg_u32 s88, 0
  s_cbranch_scc1 cB_va3_loop
  s_branch cA_va3_loop
.p2align 6
cA_sc0_loop:
  s_mov_b32 s30, 0
  s_mov_b32 s62, 0
  s_setprio 3
  s_sleep 6
cA_sc0_fp_l:
  v_cmp_gt_u32 vcc, s19, v112
  buffer_load_dword v112, v0, s[8:11], 0 offen sc1
  s_cbranch_vccz cA_sc0_fp_d
  v_cmp_gt_u32 vcc, s19, v112
  buffer_load_dword v112, v0, s[8:11], 0 offen sc1
  s_cbranch_vccz cA_sc0_fp_d
  v_cmp_gt_u32 vcc, s19, v112
  buffer_load_dword v112, v0, s[8:11], 0 offen sc1
  s_cbranch_vccz cA_sc0_fp_d
  v_cmp_gt_u32 vcc, s19, v112
  buffer_load_dword v112, v0, s[8:11], 0 offen sc1
  s_cbranch_vccz cA_sc0_fp_d
  v_cmp_gt_u32 vcc, s19, v112
  buffer_load_dword v112, v0, s[8:11], 0 offen sc1
  s_cbranch_vccz cA_sc0_fp_d
  v_cmp_gt_u32 vcc, s19, v112
  buffer_load_dword v112, v0, s[8:11], 0 offen sc1
  s_cbranch_vccz cA_sc0_fp_d
  v_cmp_gt_u32 vcc, s19, v112
  buffer_load_dword v112, v0, s[8:11], 0 offen sc1
  s_cbranch_vccz cA_sc0_fp_d
  v_cmp_gt_u32 vcc, s19, v112
  buffer_load_dword v112, v0, s[8:11], 0 offen sc1
  s_cbranch_vccz cA_sc0_fp_d
  v_cmp_gt_u32 vcc, s19, v112
  buffer_load_dword v112, v0, s[8:11], 0 offen sc1
  s_cbranch_vccz cA_sc0_fp_d
  v_cmp_gt_u32 vcc, s19, v112
  buffer_load_dword v112, v0, s[8:11], 0 offen sc1
  s_cbranch_vccz cA_sc0_fp_d
  v_cmp_gt_u32 vcc, s19, v112
  buffer_load_dword v112, v0, s[8:11], 0 offen sc1
  s_cbranch_vccz cA_sc0_fp_d
  v_cmp_gt_u32 vcc, s19, v112
  buffer_load_dword v112, v0, s[8:11], 0 offen sc1
  s_cbranch_vccz cA_sc0_fp_d
  v_cmp_gt_u32 vcc, s19, v112
  buffer_load_dword v112, v0, s[8:11], 0 offen sc1
  s_cbranch_vccz cA_sc0_fp_d
  v_cmp_gt_u32 vcc, s19, v112
  buffer_load_dword v112, v0, s[8:11], 0 offen sc1
  s_cbranch_vccz cA_sc0_fp_d
  v_cmp_gt_u32 vcc, s19, v112
  buffer_load_dword v112, v0, s[8:11], 0 offen sc1
  s_cbranch_vccz cA_sc0_fp_d
  v_cmp_gt_u32 vcc, s19, v112
  buffer_load_dword v112, v0, s[8:11], 0 offen sc1
  s_cbranch_vccz cA_sc0_fp_d
  s_waitcnt vmcnt(24)
  s_add_u32 s30, s30, 1
  s_cmp_lt_u32 s30, 400000
  s_cbranch_scc1 cA_sc0_fp_l
  s_branch cA_abort
cA_sc0_fp_d:
  buffer_load_dwordx4 v[8:11], v2, s[8:11], s20 offen offset:0 sc1
  s_barrier
  s_setprio 2
  buffer_load_dwordx4 v[12:15], v2, s[8:11], s20 offen offset:1024 sc1
  s_setprio 1
  buffer_load_dwordx4 v[16:19], v2, s[8:11], s20 offen offset:2048 sc1
  s_setprio 0
  buffer_load_dwordx4 v[20:23], v2, s[8:11], s20 offen offset:3072 sc1
cA_sc0_go:
  s_waitcnt vmcnt(3)
  v_smfmac_f32_16x16x64_bf16 v[36:39], v[8:11], a[0:7], v3
  buffer_load_dwordx4 v[32:35], v2, s[8:11], s23 offen offset:0 sc1
  v_cmp_eq_u32 vcc, -1, v8
  v_smfmac_f32_16x16x64_bf16 v[40:43], v[8:11], a[56:63], v3
  v_smfmac_f32_16x16x64_bf16 v[44:47], v[8:11], a[112:119], v3
  buffer_load_dwordx4 v[24:27], v2, s[8:11], s23 offen offset:1024 sc1
  s_cbranch_vccnz cA_sc0_r0
  v_smfmac_f32_16x16x64_bf16 v[48:51], v[8:11], a[168:175], v3
  v_smfmac_f32_16x16x64_bf16 v[52:55], v[8:11], a[224:231], v3
  s_waitcnt vmcnt(4)
  v_cmp_eq_u32 vcc, -1, v12
  v_smfmac_f32_16x16x64_bf16 v[56:59], v[8:11], v[144:151], v3
  buffer_load_dwordx4 v[28:31], v2, s[8:11], s23 offen offset:2048 sc1
  v_smfmac_f32_16x16x64_bf16 v[60:63], v[8:11], v[200:207], v3
  s_cbranch_vccnz cA_sc0_r1
cA_sc0_c1:
  v_smfmac_f32_16x16x64_bf16 v[36:39], v[12:15], a[8:15], v3
  v_smfmac_f32_16x16x64_bf16 v[40:43], v[12:15], a[64:71], v3
  v_smfmac_f32_16x16x64_bf16 v[44:47], v[12:15], a[120:127], v3
  v_smfmac_f32_16x16x64_bf16 v[48:51], v[12:15], a[176:183], v3
  v_smfmac_f32_16x16x64_bf16 v[52:55], v[12:15], a[232:239], v3
  s_waitcnt vmcnt(4)
  v_cmp_eq_u32 vcc, -1, v16
  v_smfmac_f32_16x16x64_bf16 v[56:59], v[12:15], v[152:159], v3
  buffer_load_dwordx4 v[88:91], v117, s[8:11], s26 offen offset:0 sc1
  v_smfmac_f32_16x16x64_bf16 v[60:63], v[12:15], v[208:215], v3
  s_cbranch_vccnz cA_sc0_r2
cA_sc0_c2:
  v_smfmac_f32_16x16x64_bf16 v[36:39], v[16:19], a[16:23], v3
  v_smfmac_f32_16x16x64_bf16 v[40:43], v[16:19], a[72:79], v3
  v_smfmac_f32_16x16x64_bf16 v[44:47], v[16:19], a[128:135], v3
  buffer_load_dwordx4 v[92:95], v117, s[8:11], s26 offen offset:1024 sc1
  v_smfmac_f32_16x16x64_bf16 v[48:51], v[16:19], a[184:191], v3
  v_smfmac_f32_16x16x64_bf16 v[52:55], v[16:19], a[240:247], v3
  s_waitcnt vmcnt(5)
  v_cmp_eq_u32 vcc, -1, v20
  v_smfmac_f32_16x16x64_bf16 v[56:59], v[16:19], v[160:167], v3
  v_smfmac_f32_16x16x64_bf16 v[60:63], v[16:19], v[216:223], v3
  buffer_load_dwordx4 v[96:99], v2, s[8:11], s24 offen offset:0 sc1
  s_cbranch_vccnz cA_sc0_r3
cA_sc0_c3:
  v_smfmac_f32_16x16x64_bf16 v[36:39], v[20:23], a[24:31], v3
  v_smfmac_f32_16x16x64_bf16 v[40:43], v[20:23], a[80:87], v3
  s_waitcnt vmcnt(3)
  v_max3_u32 v66, v24, v27, v28
  v_smfmac_f32_16x16x64_bf16 v[44:47], v[20:23], a[136:143], v3
  v_max3_u32 v66, v66, v31, v32
  v_smfmac_f32_16x16x64_bf16 v[48:51], v[20:23], a[192:199], v3
  buffer_load_dwordx4 v[100:103], v2, s[8:11], s24 offen offset:1024 sc1
  v_max_u32 v66, v66, v35
  v_smfmac_f32_16x16x64_bf16 v[52:55], v[20:23], a[248:255], v3
  v_cmp_eq_u32 vcc, -1, v66
  v_smfmac_f32_16x16x64_bf16 v[56:59], v[20:23], v[168:175], v3
  v_smfmac_f32_16x16x64_bf16 v[60:63], v[20:23], v[224:231], v3
  s_cbranch_vccnz cA_sc0_r4
cA_sc0_c4:
  v_smfmac_f32_16x16x64_bf16 v[60:63], v[32:35], v[232:239], v3
  buffer_load_dwordx4 v[104:107], v2, s[8:11], s26 offen offset:0 sc1
  v_smfmac_f32_16x16x64_bf16 v[60:63], v[24:27], v[240:247], v3
  v_smfmac_f32_16x16x64_bf16 v[60:63], v[28:31], v[248:255], v3
  v_smfmac_f32_16x16x64_bf16 v[52:55], v[32:35], v[120:127], v3
  v_smfmac_f32_16x16x64_bf16 v[52:55], v[24:27], v[128:135], v3
  buffer_load_dwordx4 v[108:111], v2, s[8:11], s26 offen offset:1024 sc1
  v_smfmac_f32_16x16x64_bf16 v[52:55], v[28:31], v[136:143], v3
  v_cvt_pk_bf16_f32 v63, v62, v63
  v_smfmac_f32_16x16x64_bf16 v[56:59], v[32:35], v[176:183], v3
  v_cvt_pk_bf16_f32 v62, v60, v61
  v_smfmac_f32_16x16x64_bf16 v[56:59], v[24:27], v[184:191], v3
  v_mfma_f32_16x16x32_bf16 v[12:15], v[62:65], v[4:7], 0
  v_cvt_pk_bf16_f32 v55, v54, v55
  v_smfmac_f32_16x16x64_bf16 v[56:59], v[28:31], v[192:199], v3
  v_cvt_pk_bf16_f32 v54, v52, v53
  v_smfmac_f32_16x16x64_bf16 v[36:39], v[32:35], a[32:39], v3
  s_nop 1
  v_cvt_pk_bf16_f32 v76, v12, v13
  v_smfmac_f32_16x16x64_bf16 v[36:39], v[24:27], a[40:47], v3
  v_cvt_pk_bf16_f32 v77, v14, v15
  v_smfmac_f32_16x16x64_bf16 v[36:39], v[28:31], a[48:55], v3
  v_cvt_pk_bf16_f32 v56, v56, v57
  v_smfmac_f32_16x16x64_bf16 v[40:43], v[32:35], a[88:95], v3
  v_cvt_pk_bf16_f32 v57, v58, v59
  v_smfmac_f32_16x16x64_bf16 v[40:43], v[24:27], a[96:103], v3
  v_mfma_f32_16x16x32_bf16 v[16:19], v[54:57], v[4:7], 0
  v_cvt_pk_bf16_f32 v39, v38, v39
  v_smfmac_f32_16x16x64_bf16 v[40:43], v[28:31], a[104:111], v3
  v_cvt_pk_bf16_f32 v38, v36, v37
  v_smfmac_f32_16x16x64_bf16 v[44:47], v[32:35], a[144:151], v3
  s_nop 1
  v_cvt_pk_bf16_f32 v78, v16, v17
  v_smfmac_f32_16x16x64_bf16 v[44:47], v[24:27], a[152:159], v3
  v_cvt_pk_bf16_f32 v79, v18, v19
  v_smfmac_f32_16x16x64_bf16 v[44:47], v[28:31], a[160:167], v3
  v_cvt_pk_bf16_f32 v40, v40, v41
  v_smfmac_f32_16x16x64_bf16 v[48:51], v[32:35], a[200:207], v3
  v_cvt_pk_bf16_f32 v41, v42, v43
  v_smfmac_f32_16x16x64_bf16 v[48:51], v[24:27], a[208:215], v3
  v_smfmac_f32_16x16x64_bf16 v[48:51], v[28:31], a[216:223], v3
  s_waitcnt vmcnt(4)
  v_cvt_pk_bf16_f32 v47, v46, v47
  v_smfmac_f32_16x16x64_bf16 v[68:71], v[76:79], v[80:87], v3
  v_cvt_pk_bf16_f32 v46, v44, v45
  v_mfma_f32_16x16x32_bf16 v[12:15], v[38:41], v[4:7], 0
  s_nop 1
  v_cvt_pk_bf16_f32 v48, v48, v49
  v_cvt_pk_bf16_f32 v49, v50, v51
  s_nop 1
  v_mfma_f32_16x16x32_bf16 v[16:19], v[46:49], v[4:7], 0
  v_smfmac_f32_16x16x64_bf16 v[72:75], v[76:79], v[88:95], v3
  v_cvt_pk_bf16_f32 v20, v12, v13
  v_mfma_f32_16x16x32_bf16 v[52:55], v[30:33], v[76:79], 0
  s_waitcnt vmcnt(0)
  v_cvt_pk_bf16_f32 v21, v14, v15
  v_cvt_pk_bf16_f32 v22, v16, v17
  v_cvt_pk_bf16_f32 v23, v18, v19
  s_nop 1
  v_mfma_f32_16x16x32_bf16 v[52:55], v[8:11], v[20:23], v[52:55]
  v_smfmac_f32_16x16x64_bf16 v[68:71], v[20:23], v[96:103], v3
  v_smfmac_f32_16x16x64_bf16 v[72:75], v[20:23], v[104:111], v3
  s_nop 1
  ds_write_b128 v113, v[52:55]
  s_nop 1
  v_permlane32_swap_b32 v68, v70
  v_permlane32_swap_b32 v69, v71
  v_add_f32 v56, v68, v70
  v_add_f32 v58, v69, v71
  v_permlane32_swap_b32 v72, v74
  v_permlane32_swap_b32 v73, v75
  v_add_f32 v57, v72, v74
  v_add_f32 v59, v73, v75
  ds_write_b128 v2, v[56:59] offset:0
  v_cmp_u_f32 vcc, v57, v59
  v_mov_b32 v68, 0
  v_mov_b32 v69, 0
  v_mov_b32 v70, 0
  v_mov_b32 v71, 0
  s_cbranch_vccnz cA_sc0_retry
cA_sc0_cont:
  s_add_u32 s24, s24, 28672
  s_add_u32 s26, s26, 28672
  buffer_load_dwordx4 v[80:83], v117, s[8:11], s24 offen offset:0 sc1
  buffer_load_dwordx4 v[84:87], v117, s[8:11], s24 offen offset:1024 sc1
  v_mov_b32 v72, 0
  v_mov_b32 v73, 0
  v_mfma_f32_32x32x16_bf16 v[36:51], v[68:71], v[68:71], 0
  s_waitcnt lgkmcnt(0)
  s_barrier
  ds_read_b64 v[8:9], v114 offset:0
  ds_read_b64 v[10:11], v114 offset:1024
  ds_read_b64 v[12:13], v114 offset:2048
  ds_read_b64 v[14:15], v114 offset:3072
  ds_read2_b32 v[16:17], v115 offset0:0 offset1:64
  ds_read2_b32 v[18:19], v115 offset0:128 offset1:192
  v_mfma_f32_32x32x16_bf16 v[52:67], v[68:71], v[68:71], 0
  s_waitcnt lgkmcnt(0)
  v_pk_add_f32 v[16:17], v[16:17], v[18:19]
  v_pk_add_f32 v[8:9], v[8:9], v[10:11]
  v_pk_add_f32 v[12:13], v[12:13], v[14:15]
  v_add_f32 v20, v16, v17
  v_pk_add_f32 v[8:9], v[8:9], v[12:13]
  v_max_f32 v22, v8, v9
  v_add_f32_dpp v20, v20, v20 row_ror:8 row_mask:0xf bank_mask:0xf
  s_nop 0
  v_max_f32_dpp v22, v22, v22 row_ror:8 row_mask:0xf bank_mask:0xf
  v_max_f32 v22, v22, v20
  s_nop 1
  v_max_f32_dpp v22, v22, v22 quad_perm:[1,0,3,2] row_mask:0xf bank_mask:0xf
  s_nop 1
  v_max_f32_dpp v22, v22, v22 quad_perm:[2,3,0,1] row_mask:0xf bank_mask:0xf
  s_nop 1
  v_max_f32_dpp v22, v22, v22 row_half_mirror row_mask:0xf bank_mask:0xf
  v_pk_add_f32 v[8:9], v[8:9], v[22:23] op_sel_hi:[1,0] neg_lo:[0,1] neg_hi:[0,1]
  v_sub_f32 v20, v20, v22
  v_exp_f32 v8, v8
  v_exp_f32 v9, v9
  v_exp_f32 v20, v20
  v_add_f32 v24, v8, v9
  v_fmac_f32 v24, 0.5, v20
  v_mov_b32_dpp v21, v20 quad_perm:[1,0,3,2] row_mask:0xf bank_mask:0xf
  s_nop 0
  v_add_f32_dpp v24, v24, v24 quad_perm:[1,0,3,2] row_mask:0xf bank_mask:0xf
  s_nop 1
  v_add_f32_dpp v24, v24, v24 quad_perm:[2,3,0,1] row_mask:0xf bank_mask:0xf
  s_nop 1
  v_add_f32_dpp v24, v24, v24 row_half_mirror row_mask:0xf bank_mask:0xf
  s_nop 1
  v_add_f32_dpp v24, v24, v24 row_ror:8 row_mask:0xf bank_mask:0xf
  v_rcp_f32 v24, v24
  s_nop 0
  v_pk_mul_f32 v[8:9], v[8:9], v[24:25] op_sel_hi:[1,0]
  v_cvt_pk_bf16_f32 v8, abs(v8), abs(v9)
  buffer_store_dword v8, v1, s[8:11], s20 offen
  v_pk_mul_f32 v[20:21], v[20:21], v[24:25] op_sel_hi:[1,0]
  v_cvt_pk_bf16_f32 v20, abs(v20), abs(v21)
  buffer_store_dword v20, v118, s[8:11], s20 offen
  v_mov_b32 v74, 0
  v_mov_b32 v75, 0
  s_mov_b32 s19, s18
  s_add_u32 s18, s18, 1
  s_mov_b32 s22, s20
  s_mov_b32 s20, s21
  s_mov_b32 s21, s22
  s_add_u32 s23, s20, 4096
  s_cmp_lt_u32 s19, 63
  s_cbranch_scc1 cA_sc0_loop
  s_branch cA_done
cA_sc0_r0:
  s_add_u32 s31, s31, 1
  buffer_load_dwordx4 v[8:11], v2, s[8:11], s20 offen offset:0 sc1
  s_waitcnt vmcnt(0)
  v_cmp_eq_u32 vcc, -1, v8
  v_mov_b32 v36, 0
  v_mov_b32 v37, 0
  v_mov_b32 v38, 0
  v_mov_b32 v39, 0
  v_mov_b32 v40, 0
  v_mov_b32 v41, 0
  v_mov_b32 v42, 0
  v_mov_b32 v43, 0
  v_mov_b32 v44, 0
  v_mov_b32 v45, 0
  v_mov_b32 v46, 0
  v_mov_b32 v47, 0
  v_mov_b32 v48, 0
  v_mov_b32 v49, 0
  v_mov_b32 v50, 0
  v_mov_b32 v51, 0
  s_nop 1
  s_cbranch_vccz cA_sc0_go
  s_add_u32 s30, s30, 1
  s_cmp_lt_u32 s30, 400000
  s_cbranch_scc1 cA_sc0_r0
  s_branch cA_abort
cA_sc0_r1:
  s_add_u32 s31, s31, 1
  buffer_load_dwordx4 v[12:15], v2, s[8:11], s20 offen offset:1024 sc1
  s_waitcnt vmcnt(0)
  v_cmp_eq_u32 vcc, -1, v12
  s_nop 4
  s_cbranch_vccz cA_sc0_c1
  s_add_u32 s30, s30, 1
  s_cmp_lt_u32 s30, 400000
  s_cbranch_scc1 cA_sc0_r1
  s_branch cA_abort
cA_sc0_r2:
  s_add_u32 s31, s31, 1
  buffer_load_dwordx4 v[16:19], v2, s[8:11], s20 offen offset:2048 sc1
  s_waitcnt vmcnt(0)
  v_cmp_eq_u32 vcc, -1, v16
  s_nop 4
  s_cbranch_vccz cA_sc0_c2
  s_add_u32 s30, s30, 1
  s_cmp_lt_u32 s30, 400000
  s_cbranch_scc1 cA_sc0_r2
  s_branch cA_abort
cA_sc0_r3:
  s_add_u32 s31, s31, 1
  buffer_load_dwordx4 v[20:23], v2, s[8:11], s20 offen offset:3072 sc1
  s_waitcnt vmcnt(0)
  v_cmp_eq_u32 vcc, -1, v20
  s_nop 4
  s_cbranch_vccz cA_sc0_c3
  s_add_u32 s30, s30, 1
  s_cmp_lt_u32 s30, 400000
  s_cbranch_scc1 cA_sc0_r3
  s_branch cA_abort
cA_sc0_r4:
  s_add_u32 s31, s31, 1
  buffer_load_dwordx4 v[32:35], v2, s[8:11], s23 offen offset:0 sc1
  buffer_load_dwordx4 v[24:27], v2, s[8:11], s23 offen offset:1024 sc1
  buffer_load_dwordx4 v[28:31], v2, s[8:11], s23 offen offset:2048 sc1
  s_waitcnt vmcnt(0)
  v_max3_u32 v66, v24, v27, v28
  v_max3_u32 v66, v66, v31, v32
  v_max_u32 v66, v66, v35
  v_cmp_eq_u32 vcc, -1, v66
  s_nop 4
  s_cbranch_vccz cA_sc0_c4
  s_add_u32 s30, s30, 1
  s_cmp_lt_u32 s30, 400000
  s_cbranch_scc1 cA_sc0_r4
  s_branch cA_abort
cA_sc0_retry:
  s_cmp_lg_u32 s62, 0
  s_cbranch_scc1 cA_sc0_cont
  s_waitcnt vmcnt(0) lgkmcnt(0)
cA_sc0_rv:
  buffer_load_dwordx4 v[8:11], v2, s[8:11], s20 offen offset:0 sc1
  buffer_load_dwordx4 v[12:15], v2, s[8:11], s20 offen offset:1024 sc1
  buffer_load_dwordx4 v[16:19], v2, s[8:11], s20 offen offset:2048 sc1
  buffer_load_dwordx4 v[20:23], v2, s[8:11], s20 offen offset:3072 sc1
  buffer_load_dwordx4 v[32:35], v2, s[8:11], s23 offen offset:0 sc1
  buffer_load_dwordx4 v[24:27], v2, s[8:11], s23 offen offset:1024 sc1
  buffer_load_dwordx4 v[28:31], v2, s[8:11], s23 offen offset:2048 sc1
  s_waitcnt vmcnt(0)
  v_max3_u32 v66, v8, v9, v10
  v_max3_u32 v66, v66, v11, v12
  v_max3_u32 v66, v66, v13, v14
  v_max3_u32 v66, v66, v15, v16
  v_max3_u32 v66, v66, v17, v18
  v_max3_u32 v66, v66, v19, v20
  v_max3_u32 v66, v66, v21, v22
  v_max3_u32 v66, v66, v23, v24
  v_max3_u32 v66, v66, v25, v26
  v_max3_u32 v66, v66, v27, v28
  v_max3_u32 v66, v66, v29, v30
  v_max3_u32 v66, v66, v31, v32
  v_max3_u32 v66, v66, v33, v34
  v_max_u32 v66, v66, v35
  v_cmp_eq_u32 vcc, -1, v66
  s_cbranch_vccz cA_sc0_rk
  s_add_u32 s30, s30, 1
  s_cmp_lt_u32 s30, 400000
  s_cbranch_scc1 cA_sc0_rv
  s_branch cA_abort
cA_sc0_rk:
  s_mov_b32 s62, 1
  v_mov_b32 v36, 0
  v_mov_b32 v37, 0
  v_mov_b32 v38, 0
  v_mov_b32 v39, 0
  v_mov_b32 v40, 0
  v_mov_b32 v41, 0
  v_mov_b32 v42, 0
  v_mov_b32 v43, 0
  v_mov_b32 v44, 0
  v_mov_b32 v45, 0
  v_mov_b32 v46, 0
  v_mov_b32 v47, 0
  v_mov_b32 v48, 0
  v_mov_b32 v49, 0
  v_mov_b32 v50, 0
  v_mov_b32 v51, 0
  v_mov_b32 v60, 0
  v_mov_b32 v61, 0
  v_mov_b32 v62, 0
  v_mov_b32 v63, 0
  v_mov_b32 v68, 0
  v_mov_b32 v69, 0
  v_mov_b32 v70, 0
  v_mov_b32 v71, 0
  v_mov_b32 v72, 0
  v_mov_b32 v73, 0
  v_mov_b32 v74, 0
  v_mov_b32 v75, 0
  v_mov_b32 v52, 0
  v_mov_b32 v53, 0
  v_mov_b32 v54, 0
  v_mov_b32 v55, 0
  v_mov_b32 v56, 0
  v_mov_b32 v57, 0
  v_mov_b32 v58, 0
  v_mov_b32 v59, 0
  s_add_u32 s31, s31, 0x100
  s_nop 0
  s_branch cA_sc0_go
.p2align 6
cA_sc1_loop:
  s_mov_b32 s30, 0
  s_mov_b32 s62, 0
  s_setprio 3
  s_barrier
  buffer_load_dwordx4 v[8:11], v2, s[8:11], s20 offen offset:0 sc1
  s_setprio 2
  buffer_load_dwordx4 v[12:15], v2, s[8:11], s20 offen offset:1024 sc1
  s_setprio 1
  buffer_load_dwordx4 v[16:19], v2, s[8:11], s20 offen offset:2048 sc1
  s_setprio 0
  buffer_load_dwordx4 v[20:23], v2, s[8:11], s20 offen offset:3072 sc1
cA_sc1_go:
  s_waitcnt vmcnt(3)
  v_smfmac_f32_16x16x64_bf16 v[36:39], v[8:11], a[0:7], v3
  buffer_load_dwordx4 v[28:31], v2, s[8:11], s23 offen offset:0 sc1
  v_cmp_eq_u32 vcc, -1, v8
  v_smfmac_f32_16x16x64_bf16 v[40:43], v[8:11], a[56:63], v3
  v_smfmac_f32_16x16x64_bf16 v[44:47], v[8:11], a[112:119], v3
  buffer_load_dwordx4 v[24:27], v2, s[8:11], s23 offen offset:1024 sc1
  s_cbranch_vccnz cA_sc1_r0
  v_smfmac_f32_16x16x64_bf16 v[48:51], v[8:11], a[168:175], v3
  v_smfmac_f32_16x16x64_bf16 v[52:55], v[8:11], a[224:231], v3
  s_waitcnt vmcnt(4)
  v_cmp_eq_u32 vcc, -1, v12
  v_smfmac_f32_16x16x64_bf16 v[56:59], v[8:11], v[144:151], v3
  buffer_load_dwordx4 v[32:35], v2, s[8:11], s23 offen offset:2048 sc1
  v_smfmac_f32_16x16x64_bf16 v[60:63], v[8:11], v[200:207], v3
  s_cbranch_vccnz cA_sc1_r1
cA_sc1_c1:
  v_smfmac_f32_16x16x64_bf16 v[36:39], v[12:15], a[8:15], v3
  v_smfmac_f32_16x16x64_bf16 v[40:43], v[12:15], a[64:71], v3
  v_smfmac_f32_16x16x64_bf16 v[44:47], v[12:15], a[120:127], v3
  v_smfmac_f32_16x16x64_bf16 v[48:51], v[12:15], a[176:183], v3
  v_smfmac_f32_16x16x64_bf16 v[52:55], v[12:15], a[232:239], v3
  s_waitcnt vmcnt(4)
  v_cmp_eq_u32 vcc, -1, v16
  v_smfmac_f32_16x16x64_bf16 v[56:59], v[12:15], v[152:159], v3
  buffer_load_dwordx4 v[88:91], v117, s[8:11], s26 offen offset:0 sc1
  v_smfmac_f32_16x16x64_bf16 v[60:63], v[12:15], v[208:215], v3
  s_cbranch_vccnz cA_sc1_r2
cA_sc1_c2:
  v_smfmac_f32_16x16x64_bf16 v[36:39], v[16:19], a[16:23], v3
  v_smfmac_f32_16x16x64_bf16 v[40:43], v[16:19], a[72:79], v3
  v_smfmac_f32_16x16x64_bf16 v[44:47], v[16:19], a[128:135], v3
  buffer_load_dwordx4 v[92:95], v117, s[8:11], s26 offen offset:1024 sc1
  v_smfmac_f32_16x16x64_bf16 v[48:51], v[16:19], a[184:191], v3
  v_smfmac_f32_16x16x64_bf16 v[52:55], v[16:19], a[240:247], v3
  s_waitcnt vmcnt(5)
  v_cmp_eq_u32 vcc, -1, v20
  v_smfmac_f32_16x16x64_bf16 v[56:59], v[16:19], v[160:167], v3
  v_smfmac_f32_16x16x64_bf16 v[60:63], v[16:19], v[216:223], v3
  buffer_load_dwordx4 v[96:99], v2, s[8:11], s24 offen offset:0 sc1
  s_cbranch_vccnz cA_sc1_r3
cA_sc1_c3:
  v_smfmac_f32_16x16x64_bf16 v[36:39], v[20:23], a[24:31], v3
  v_smfmac_f32_16x16x64_bf16 v[40:43], v[20:23], a[80:87], v3
  s_waitcnt vmcnt(3)
  v_max3_u32 v66, v24, v27, v28
  v_smfmac_f32_16x16x64_bf16 v[44:47], v[20:23], a[136:143], v3
  v_max3_u32 v66, v66, v31, v32
  v_smfmac_f32_16x16x64_bf16 v[48:51], v[20:23], a[192:199], v3
  buffer_load_dwordx4 v[100:103], v2, s[8:11], s24 offen offset:1024 sc1
  v_max_u32 v66, v66, v35
  v_smfmac_f32_16x16x64_bf16 v[52:55], v[20:23], a[248:255], v3
  v_cmp_eq_u32 vcc, -1, v66
  v_smfmac_f32_16x16x64_bf16 v[56:59], v[20:23], v[168:175], v3
  v_smfmac_f32_16x16x64_bf16 v[60:63], v[20:23], v[224:231], v3
  s_cbranch_vccnz cA_sc1_r4
cA_sc1_c4:
  v_smfmac_f32_16x16x64_bf16 v[60:63], v[28:31], v[232:239], v3
  buffer_load_dwordx4 v[104:107], v2, s[8:11], s26 offen offset:0 sc1
  v_smfmac_f32_16x16x64_bf16 v[60:63], v[24:27], v[240:247], v3
  v_smfmac_f32_16x16x64_bf16 v[60:63], v[32:35], v[248:255], v3
  v_smfmac_f32_16x16x64_bf16 v[52:55], v[28:31], v[120:127], v3
  v_smfmac_f32_16x16x64_bf16 v[52:55], v[24:27], v[128:135], v3
  buffer_load_dwordx4 v[108:111], v2, s[8:11], s26 offen offset:1024 sc1
  v_smfmac_f32_16x16x64_bf16 v[52:55], v[32:35], v[136:143], v3
  v_cvt_pk_bf16_f32 v63, v62, v63
  v_smfmac_f32_16x16x64_bf16 v[56:59], v[28:31], v[176:183], v3
  v_cvt_pk_bf16_f32 v62, v60, v61
  v_smfmac_f32_16x16x64_bf16 v[56:59], v[24:27], v[184:191], v3
  v_mfma_f32_16x16x32_bf16 v[8:11], v[62:65], v[4:7], 0
  v_cvt_pk_bf16_f32 v55, v54, v55
  v_smfmac_f32_16x16x64_bf16 v[56:59], v[32:35], v[192:199], v3
  v_cvt_pk_bf16_f32 v54, v52, v53
  v_smfmac_f32_16x16x64_bf16 v[36:39], v[28:31], a[32:39], v3
  s_nop 1
  v_cvt_pk_bf16_f32 v78, v8, v9
  v_smfmac_f32_16x16x64_bf16 v[36:39], v[24:27], a[40:47], v3
  v_cvt_pk_bf16_f32 v79, v10, v11
  v_smfmac_f32_16x16x64_bf16 v[36:39], v[32:35], a[48:55], v3
  v_cvt_pk_bf16_f32 v56, v56, v57
  v_smfmac_f32_16x16x64_bf16 v[40:43], v[28:31], a[88:95], v3
  v_cvt_pk_bf16_f32 v57, v58, v59
  v_smfmac_f32_16x16x64_bf16 v[40:43], v[24:27], a[96:103], v3
  v_mfma_f32_16x16x32_bf16 v[16:19], v[54:57], v[4:7], 0
  v_cvt_pk_bf16_f32 v39, v38, v39
  v_smfmac_f32_16x16x64_bf16 v[40:43], v[32:35], a[104:111], v3
  v_cvt_pk_bf16_f32 v38, v36, v37
  v_smfmac_f32_16x16x64_bf16 v[44:47], v[28:31], a[144:151], v3
  s_nop 1
  v_cvt_pk_bf16_f32 v76, v16, v17
  v_smfmac_f32_16x16x64_bf16 v[44:47], v[24:27], a[152:159], v3
  v_cvt_pk_bf16_f32 v77, v18, v19
  v_smfmac_f32_16x16x64_bf16 v[44:47], v[32:35], a[160:167], v3
  v_cvt_pk_bf16_f32 v40, v40, v41
  v_smfmac_f32_16x16x64_bf16 v[48:51], v[28:31], a[200:207], v3
  v_cvt_pk_bf16_f32 v41, v42, v43
  v_smfmac_f32_16x16x64_bf16 v[48:51], v[24:27], a[208:215], v3
  v_smfmac_f32_16x16x64_bf16 v[48:51], v[32:35], a[216:223], v3
  s_waitcnt vmcnt(4)
  v_cvt_pk_bf16_f32 v47, v46, v47
  v_smfmac_f32_16x16x64_bf16 v[68:71], v[76:79], v[80:87], v3
  v_cvt_pk_bf16_f32 v46, v44, v45
  v_mfma_f32_16x16x32_bf16 v[8:11], v[38:41], v[4:7], 0
  s_nop 1
  v_cvt_pk_bf16_f32 v48, v48, v49
  v_cvt_pk_bf16_f32 v49, v50, v51
  s_nop 1
  v_mfma_f32_16x16x32_bf16 v[16:19], v[46:49], v[4:7], 0
  v_smfmac_f32_16x16x64_bf16 v[72:75], v[76:79], v[88:95], v3
  v_cvt_pk_bf16_f32 v20, v8, v9
  v_mfma_f32_16x16x32_bf16 v[52:55], v[30:33], v[76:79], 0
  s_waitcnt vmcnt(0)
  v_cvt_pk_bf16_f32 v21, v10, v11
  v_cvt_pk_bf16_f32 v22, v16, v17
  v_cvt_pk_bf16_f32 v23, v18, v19
  s_nop 1
  v_mfma_f32_16x16x32_bf16 v[52:55], v[12:15], v[20:23], v[52:55]
  v_smfmac_f32_16x16x64_bf16 v[68:71], v[20:23], v[96:103], v3
  v_smfmac_f32_16x16x64_bf16 v[72:75], v[20:23], v[104:111], v3
  s_nop 1
  ds_write_b128 v113, v[52:55]
  s_nop 1
  v_permlane32_swap_b32 v68, v70
  v_permlane32_swap_b32 v69, v71
  v_add_f32 v56, v68, v70
  v_add_f32 v58, v69, v71
  v_permlane32_swap_b32 v72, v74
  v_permlane32_swap_b32 v73, v75
  v_add_f32 v57, v72, v74
  v_add_f32 v59, v73, v75
  ds_write_b128 v2, v[56:59] offset:1024
  v_cmp_u_f32 vcc, v57, v59
  v_mov_b32 v68, 0
  v_mov_b32 v69, 0
  v_mov_b32 v70, 0
  v_mov_b32 v71, 0
  s_cbranch_vccnz cA_sc1_retry
cA_sc1_cont:
  s_add_u32 s24, s24, 28672
  s_add_u32 s26, s26, 28672
  buffer_load_dwordx4 v[80:83], v117, s[8:11], s24 offen offset:0 sc1
  buffer_load_dwordx4 v[84:87], v117, s[8:11], s24 offen offset:1024 sc1
  v_mov_b32 v72, 0
  v_mov_b32 v73, 0
  v_mfma_f32_32x32x16_bf16 v[36:51], v[68:71], v[68:71], 0
  s_waitcnt lgkmcnt(0)
  s_barrier
  ds_read_b64 v[8:9], v114 offset:0
  ds_read_b64 v[10:11], v114 offset:1024
  ds_read_b64 v[12:13], v114 offset:2048
  ds_read_b64 v[14:15], v114 offset:3072
  ds_read2_b32 v[16:17], v115 offset0:0 offset1:64
  ds_read2_b32 v[18:19], v115 offset0:128 offset1:192
  v_mfma_f32_32x32x16_bf16 v[52:67], v[68:71], v[68:71], 0
  s_waitcnt lgkmcnt(0)
  v_pk_add_f32 v[16:17], v[16:17], v[18:19]
  v_pk_add_f32 v[8:9], v[8:9], v[10:11]
  v_pk_add_f32 v[12:13], v[12:13], v[14:15]
  v_add_f32 v20, v16, v17
  v_pk_add_f32 v[8:9], v[8:9], v[12:13]
  v_max_f32 v22, v8, v9
  v_add_f32_dpp v20, v20, v20 row_ror:8 row_mask:0xf bank_mask:0xf
  s_nop 0
  v_max_f32_dpp v22, v22, v22 row_ror:8 row_mask:0xf bank_mask:0xf
  v_max_f32 v22, v22, v20
  buffer_store_dword v112, v116, s[8:11], 0 offen
  s_nop 0
  v_max_f32_dpp v22, v22, v22 quad_perm:[1,0,3,2] row_mask:0xf bank_mask:0xf
  s_nop 1
  v_max_f32_dpp v22, v22, v22 quad_perm:[2,3,0,1] row_mask:0xf bank_mask:0xf
  s_nop 1
  v_max_f32_dpp v22, v22, v22 row_half_mirror row_mask:0xf bank_mask:0xf
  v_pk_add_f32 v[8:9], v[8:9], v[22:23] op_sel_hi:[1,0] neg_lo:[0,1] neg_hi:[0,1]
  v_sub_f32 v20, v20, v22
  v_exp_f32 v8, v8
  v_exp_f32 v9, v9
  v_exp_f32 v20, v20
  v_add_f32 v24, v8, v9
  v_fmac_f32 v24, 0.5, v20
  v_mov_b32_dpp v21, v20 quad_perm:[1,0,3,2] row_mask:0xf bank_mask:0xf
  s_nop 0
  v_add_f32_dpp v24, v24, v24 quad_perm:[1,0,3,2] row_mask:0xf bank_mask:0xf
  s_nop 1
  v_add_f32_dpp v24, v24, v24 quad_perm:[2,3,0,1] row_mask:0xf bank_mask:0xf
  s_nop 1
  v_add_f32_dpp v24, v24, v24 row_half_mirror row_mask:0xf bank_mask:0xf
  s_nop 1
  v_add_f32_dpp v24, v24, v24 row_ror:8 row_mask:0xf bank_mask:0xf
  v_rcp_f32 v24, v24
  s_nop 0
  v_pk_mul_f32 v[8:9], v[8:9], v[24:25] op_sel_hi:[1,0]
  v_cvt_pk_bf16_f32 v8, abs(v8), abs(v9)
  buffer_store_dword v8, v1, s[8:11], s20 offen
  v_pk_mul_f32 v[20:21], v[20:21], v[24:25] op_sel_hi:[1,0]
  v_cvt_pk_bf16_f32 v20, abs(v20), abs(v21)
  buffer_store_dword v20, v118, s[8:11], s20 offen
  v_mov_b32 v74, 0
  v_mov_b32 v75, 0
  s_mov_b32 s19, s18
  s_add_u32 s18, s18, 1
  s_mov_b32 s22, s20
  s_mov_b32 s20, s21
  s_mov_b32 s21, s22
  s_add_u32 s23, s20, 4096
  v_mov_b32 v112, s18
  s_cmp_lt_u32 s19, 63
  s_nop 0
  s_cbranch_scc1 cA_sc1_loop
  s_branch cA_done
cA_sc1_r0:
  s_add_u32 s31, s31, 1
  buffer_load_dwordx4 v[8:11], v2, s[8:11], s20 offen offset:0 sc1
  s_waitcnt vmcnt(0)
  v_cmp_eq_u32 vcc, -1, v8
  v_mov_b32 v36, 0
  v_mov_b32 v37, 0
  v_mov_b32 v38, 0
  v_mov_b32 v39, 0
  v_mov_b32 v40, 0
  v_mov_b32 v41, 0
  v_mov_b32 v42, 0
  v_mov_b32 v43, 0
  v_mov_b32 v44, 0
  v_mov_b32 v45, 0
  v_mov_b32 v46, 0
  v_mov_b32 v47, 0
  v_mov_b32 v48, 0
  v_mov_b32 v49, 0
  v_mov_b32 v50, 0
  v_mov_b32 v51, 0
  s_nop 1
  s_cbranch_vccz cA_sc1_go
  s_add_u32 s30, s30, 1
  s_cmp_lt_u32 s30, 400000
  s_cbranch_scc1 cA_sc1_r0
  s_branch cA_abort
cA_sc1_r1:
  s_add_u32 s31, s31, 1
  buffer_load_dwordx4 v[12:15], v2, s[8:11], s20 offen offset:1024 sc1
  s_waitcnt vmcnt(0)
  v_cmp_eq_u32 vcc, -1, v12
  s_nop 4
  s_cbranch_vccz cA_sc1_c1
  s_add_u32 s30, s30, 1
  s_cmp_lt_u32 s30, 400000
  s_cbranch_scc1 cA_sc1_r1
  s_branch cA_abort
cA_sc1_r2:
  s_add_u32 s31, s31, 1
  buffer_load_dwordx4 v[16:19], v2, s[8:11], s20 offen offset:2048 sc1
  s_waitcnt vmcnt(0)
  v_cmp_eq_u32 vcc, -1, v16
  s_nop 4
  s_cbranch_vccz cA_sc1_c2
  s_add_u32 s30, s30, 1
  s_cmp_lt_u32 s30, 400000
  s_cbranch_scc1 cA_sc1_r2
  s_branch cA_abort
cA_sc1_r3:
  s_add_u32 s31, s31, 1
  buffer_load_dwordx4 v[20:23], v2, s[8:11], s20 offen offset:3072 sc1
  s_waitcnt vmcnt(0)
  v_cmp_eq_u32 vcc, -1, v20
  s_nop 4
  s_cbranch_vccz cA_sc1_c3
  s_add_u32 s30, s30, 1
  s_cmp_lt_u32 s30, 400000
  s_cbranch_scc1 cA_sc1_r3
  s_branch cA_abort
cA_sc1_r4:
  s_add_u32 s31, s31, 1
  buffer_load_dwordx4 v[28:31], v2, s[8:11], s23 offen offset:0 sc1
  buffer_load_dwordx4 v[24:27], v2, s[8:11], s23 offen offset:1024 sc1
  buffer_load_dwordx4 v[32:35], v2, s[8:11], s23 offen offset:2048 sc1
  s_waitcnt vmcnt(0)
  v_max3_u32 v66, v24, v27, v28
  v_max3_u32 v66, v66, v31, v32
  v_max_u32 v66, v66, v35
  v_cmp_eq_u32 vcc, -1, v66
  s_nop 4
  s_cbranch_vccz cA_sc1_c4
  s_add_u32 s30, s30, 1
  s_cmp_lt_u32 s30, 400000
  s_cbranch_scc1 cA_sc1_r4
  s_branch cA_abort
cA_sc1_retry:
  s_cmp_lg_u32 s62, 0
  s_cbranch_scc1 cA_sc1_cont
  s_waitcnt vmcnt(0) lgkmcnt(0)
cA_sc1_rv:
  buffer_load_dwordx4 v[8:11], v2, s[8:11], s20 offen offset:0 sc1
  buffer_load_dwordx4 v[12:15], v2, s[8:11], s20 offen offset:1024 sc1
  buffer_load_dwordx4 v[16:19], v2, s[8:11], s20 offen offset:2048 sc1
  buffer_load_dwordx4 v[20:23], v2, s[8:11], s20 offen offset:3072 sc1
  buffer_load_dwordx4 v[28:31], v2, s[8:11], s23 offen offset:0 sc1
  buffer_load_dwordx4 v[24:27], v2, s[8:11], s23 offen offset:1024 sc1
  buffer_load_dwordx4 v[32:35], v2, s[8:11], s23 offen offset:2048 sc1
  s_waitcnt vmcnt(0)
  v_max3_u32 v66, v8, v9, v10
  v_max3_u32 v66, v66, v11, v12
  v_max3_u32 v66, v66, v13, v14
  v_max3_u32 v66, v66, v15, v16
  v_max3_u32 v66, v66, v17, v18
  v_max3_u32 v66, v66, v19, v20
  v_max3_u32 v66, v66, v21, v22
  v_max3_u32 v66, v66, v23, v24
  v_max3_u32 v66, v66, v25, v26
  v_max3_u32 v66, v66, v27, v28
  v_max3_u32 v66, v66, v29, v30
  v_max3_u32 v66, v66, v31, v32
  v_max3_u32 v66, v66, v33, v34
  v_max_u32 v66, v66, v35
  v_cmp_eq_u32 vcc, -1, v66
  s_cbranch_vccz cA_sc1_rk
  s_add_u32 s30, s30, 1
  s_cmp_lt_u32 s30, 400000
  s_cbranch_scc1 cA_sc1_rv
  s_branch cA_abort
cA_sc1_rk:
  s_mov_b32 s62, 1
  v_mov_b32 v36, 0
  v_mov_b32 v37, 0
  v_mov_b32 v38, 0
  v_mov_b32 v39, 0
  v_mov_b32 v40, 0
  v_mov_b32 v41, 0
  v_mov_b32 v42, 0
  v_mov_b32 v43, 0
  v_mov_b32 v44, 0
  v_mov_b32 v45, 0
  v_mov_b32 v46, 0
  v_mov_b32 v47, 0
  v_mov_b32 v48, 0
  v_mov_b32 v49, 0
  v_mov_b32 v50, 0
  v_mov_b32 v51, 0
  v_mov_b32 v60, 0
  v_mov_b32 v61, 0
  v_mov_b32 v62, 0
  v_mov_b32 v63, 0
  v_mov_b32 v68, 0
  v_mov_b32 v69, 0
  v_mov_b32 v70, 0
  v_mov_b32 v71, 0
  v_mov_b32 v72, 0
  v_mov_b32 v73, 0
  v_mov_b32 v74, 0
  v_mov_b32 v75, 0
  v_mov_b32 v52, 0
  v_mov_b32 v53, 0
  v_mov_b32 v54, 0
  v_mov_b32 v55, 0
  v_mov_b32 v56, 0
  v_mov_b32 v57, 0
  v_mov_b32 v58, 0
  v_mov_b32 v59, 0
  s_add_u32 s31, s31, 0x100
  s_nop 0
  s_branch cA_sc1_go
.p2align 6
cA_sc2_loop:
  s_mov_b32 s30, 0
  s_mov_b32 s62, 0
  s_setprio 3
  s_barrier
  buffer_load_dwordx4 v[8:11], v2, s[8:11], s20 offen offset:0 sc1
  s_setprio 2
  buffer_load_dwordx4 v[12:15], v2, s[8:11], s20 offen offset:1024 sc1
  s_setprio 1
  buffer_load_dwordx4 v[16:19], v2, s[8:11], s20 offen offset:2048 sc1
  s_setprio 0
  buffer_load_dwordx4 v[20:23], v2, s[8:11], s20 offen offset:3072 sc1
cA_sc2_go:
  s_waitcnt vmcnt(3)
  v_smfmac_f32_16x16x64_bf16 v[36:39], v[8:11], a[0:7], v3
  buffer_load_dwordx4 v[24:27], v2, s[8:11], s23 offen offset:0 sc1
  v_cmp_eq_u32 vcc, -1, v8
  v_smfmac_f32_16x16x64_bf16 v[40:43], v[8:11], a[56:63], v3
  v_smfmac_f32_16x16x64_bf16 v[44:47], v[8:11], a[112:119], v3
  buffer_load_dwordx4 v[32:35], v2, s[8:11], s23 offen offset:1024 sc1
  s_cbranch_vccnz cA_sc2_r0
  v_smfmac_f32_16x16x64_bf16 v[48:51], v[8:11], a[168:175], v3
  v_smfmac_f32_16x16x64_bf16 v[52:55], v[8:11], a[224:231], v3
  s_waitcnt vmcnt(4)
  v_cmp_eq_u32 vcc, -1, v12
  v_smfmac_f32_16x16x64_bf16 v[56:59], v[8:11], v[144:151], v3
  buffer_load_dwordx4 v[28:31], v2, s[8:11], s23 offen offset:2048 sc1
  v_smfmac_f32_16x16x64_bf16 v[62:65], v[8:11], v[200:207], v3
  s_cbranch_vccnz cA_sc2_r1
cA_sc2_c1:
  v_smfmac_f32_16x16x64_bf16 v[36:39], v[12:15], a[8:15], v3
  v_smfmac_f32_16x16x64_bf16 v[40:43], v[12:15], a[64:71], v3
  v_smfmac_f32_16x16x64_bf16 v[44:47], v[12:15], a[120:127], v3
  v_smfmac_f32_16x16x64_bf16 v[48:51], v[12:15], a[176:183], v3
  v_smfmac_f32_16x16x64_bf16 v[52:55], v[12:15], a[232:239], v3
  s_waitcnt vmcnt(4)
  v_cmp_eq_u32 vcc, -1, v16
  v_smfmac_f32_16x16x64_bf16 v[56:59], v[12:15], v[152:159], v3
  buffer_load_dwordx4 v[88:91], v117, s[8:11], s26 offen offset:0 sc1
  v_smfmac_f32_16x16x64_bf16 v[62:65], v[12:15], v[208:215], v3
  s_cbranch_vccnz cA_sc2_r2
cA_sc2_c2:
  v_smfmac_f32_16x16x64_bf16 v[36:39], v[16:19], a[16:23], v3
  v_smfmac_f32_16x16x64_bf16 v[40:43], v[16:19], a[72:79], v3
  v_smfmac_f32_16x16x64_bf16 v[44:47], v[16:19], a[128:135], v3
  buffer_load_dwordx4 v[92:95], v117, s[8:11], s26 offen offset:1024 sc1
  v_smfmac_f32_16x16x64_bf16 v[48:51], v[16:19], a[184:191], v3
  v_smfmac_f32_16x16x64_bf16 v[52:55], v[16:19], a[240:247], v3
  s_waitcnt vmcnt(5)
  v_cmp_eq_u32 vcc, -1, v20
  v_smfmac_f32_16x16x64_bf16 v[56:59], v[16:19], v[160:167], v3
  v_smfmac_f32_16x16x64_bf16 v[62:65], v[16:19], v[216:223], v3
  buffer_load_dwordx4 v[96:99], v2, s[8:11], s24 offen offset:0 sc1
  s_cbranch_vccnz cA_sc2_r3
cA_sc2_c3:
  v_smfmac_f32_16x16x64_bf16 v[36:39], v[20:23], a[24:31], v3
  v_smfmac_f32_16x16x64_bf16 v[40:43], v[20:23], a[80:87], v3
  s_waitcnt vmcnt(3)
  v_max3_u32 v66, v24, v27, v28
  v_smfmac_f32_16x16x64_bf16 v[44:47], v[20:23], a[136:143], v3
  v_max3_u32 v66, v66, v31, v32
  v_smfmac_f32_16x16x64_bf16 v[48:51], v[20:23], a[192:199], v3
  buffer_load_dwordx4 v[100:103], v2, s[8:11], s24 offen offset:1024 sc1
  v_max_u32 v66, v66, v35
  v_smfmac_f32_16x16x64_bf16 v[52:55], v[20:23], a[248:255], v3
  v_cmp_eq_u32 vcc, -1, v66
  v_smfmac_f32_16x16x64_bf16 v[56:59], v[20:23], v[168:175], v3
  v_smfmac_f32_16x16x64_bf16 v[62:65], v[20:23], v[224:231], v3
  s_cbranch_vccnz cA_sc2_r4
cA_sc2_c4:
  v_smfmac_f32_16x16x64_bf16 v[62:65], v[24:27], v[232:239], v3
  buffer_load_dwordx4 v[104:107], v2, s[8:11], s26 offen offset:0 sc1
  v_smfmac_f32_16x16x64_bf16 v[62:65], v[32:35], v[240:247], v3
  v_smfmac_f32_16x16x64_bf16 v[62:65], v[28:31], v[248:255], v3
  v_smfmac_f32_16x16x64_bf16 v[52:55], v[24:27], v[120:127], v3
  v_smfmac_f32_16x16x64_bf16 v[52:55], v[32:35], v[128:135], v3
  buffer_load_dwordx4 v[108:111], v2, s[8:11], s26 offen offset:1024 sc1
  v_smfmac_f32_16x16x64_bf16 v[52:55], v[28:31], v[136:143], v3
  v_cvt_pk_bf16_f32 v62, v62, v63
  v_smfmac_f32_16x16x64_bf16 v[56:59], v[24:27], v[176:183], v3
  v_cvt_pk_bf16_f32 v63, v64, v65
  v_smfmac_f32_16x16x64_bf16 v[56:59], v[32:35], v[184:191], v3
  v_mfma_f32_16x16x32_bf16 v[8:11], v[60:63], v[4:7], 0
  v_cvt_pk_bf16_f32 v55, v54, v55
  v_smfmac_f32_16x16x64_bf16 v[56:59], v[28:31], v[192:199], v3
  v_cvt_pk_bf16_f32 v54, v52, v53
  v_smfmac_f32_16x16x64_bf16 v[36:39], v[24:27], a[32:39], v3
  s_nop 1
  v_cvt_pk_bf16_f32 v76, v8, v9
  v_smfmac_f32_16x16x64_bf16 v[36:39], v[32:35], a[40:47], v3
  v_cvt_pk_bf16_f32 v77, v10, v11
  v_smfmac_f32_16x16x64_bf16 v[36:39], v[28:31], a[48:55], v3
  v_cvt_pk_bf16_f32 v56, v56, v57
  v_smfmac_f32_16x16x64_bf16 v[40:43], v[24:27], a[88:95], v3
  v_cvt_pk_bf16_f32 v57, v58, v59
  v_smfmac_f32_16x16x64_bf16 v[40:43], v[32:35], a[96:103], v3
  v_mfma_f32_16x16x32_bf16 v[12:15], v[54:57], v[4:7], 0
  v_cvt_pk_bf16_f32 v39, v38, v39
  v_smfmac_f32_16x16x64_bf16 v[40:43], v[28:31], a[104:111], v3
  v_cvt_pk_bf16_f32 v38, v36, v37
  v_smfmac_f32_16x16x64_bf16 v[44:47], v[24:27], a[144:151], v3
  s_nop 1
  v_cvt_pk_bf16_f32 v78, v12, v13
  v_smfmac_f32_16x16x64_bf16 v[44:47], v[32:35], a[152:159], v3
  v_cvt_pk_bf16_f32 v79, v14, v15
  v_smfmac_f32_16x16x64_bf16 v[44:47], v[28:31], a[160:167], v3
  v_cvt_pk_bf16_f32 v40, v40, v41
  v_smfmac_f32_16x16x64_bf16 v[48:51], v[24:27], a[200:207], v3
  v_cvt_pk_bf16_f32 v41, v42, v43
  v_smfmac_f32_16x16x64_bf16 v[48:51], v[32:35], a[208:215], v3
  v_smfmac_f32_16x16x64_bf16 v[48:51], v[28:31], a[216:223], v3
  s_waitcnt vmcnt(4)
  v_cvt_pk_bf16_f32 v47, v46, v47
  v_smfmac_f32_16x16x64_bf16 v[68:71], v[76:79], v[80:87], v3
  v_cvt_pk_bf16_f32 v46, v44, v45
  v_mfma_f32_16x16x32_bf16 v[8:11], v[38:41], v[4:7], 0
  s_nop 1
  v_cvt_pk_bf16_f32 v48, v48, v49
  v_cvt_pk_bf16_f32 v49, v50, v51
  s_nop 1
  v_mfma_f32_16x16x32_bf16 v[12:15], v[46:49], v[4:7], 0
  v_smfmac_f32_16x16x64_bf16 v[72:75], v[76:79], v[88:95], v3
  v_cvt_pk_bf16_f32 v20, v8, v9
  v_mfma_f32_16x16x32_bf16 v[52:55], v[30:33], v[76:79], 0
  s_waitcnt vmcnt(0)
  v_cvt_pk_bf16_f32 v21, v10, v11
  v_cvt_pk_bf16_f32 v22, v12, v13
  v_cvt_pk_bf16_f32 v23, v14, v15
  s_nop 1
  v_mfma_f32_16x16x32_bf16 v[52:55], v[16:19], v[20:23], v[52:55]
  v_smfmac_f32_16x16x64_bf16 v[68:71], v[20:23], v[96:103], v3
  v_smfmac_f32_16x16x64_bf16 v[72:75], v[20:23], v[104:111], v3
  s_nop 1
  ds_write_b128 v113, v[52:55]
  s_nop 1
  v_permlane32_swap_b32 v68, v70
  v_permlane32_swap_b32 v69, v71
  v_add_f32 v56, v68, v70
  v_add_f32 v58, v69, v71
  v_permlane32_swap_b32 v72, v74
  v_permlane32_swap_b32 v73, v75
  v_add_f32 v57, v72, v74
  v_add_f32 v59, v73, v75
  ds_write_b128 v2, v[56:59] offset:2048
  v_cmp_u_f32 vcc, v57, v59
  v_mov_b32 v68, 0
  v_mov_b32 v69, 0
  v_mov_b32 v70, 0
  v_mov_b32 v71, 0
  s_cbranch_vccnz cA_sc2_retry
cA_sc2_cont:
  s_add_u32 s24, s24, 28672
  s_add_u32 s26, s26, 28672
  buffer_load_dwordx4 v[80:83], v117, s[8:11], s24 offen offset:0 sc1
  buffer_load_dwordx4 v[84:87], v117, s[8:11], s24 offen offset:1024 sc1
  v_mov_b32 v72, 0
  v_mov_b32 v73, 0
  v_mfma_f32_32x32x16_bf16 v[36:51], v[68:71], v[68:71], 0
  s_waitcnt lgkmcnt(0)
  s_barrier
  v_mfma_f32_32x32x16_bf16 v[52:67], v[68:71], v[68:71], 0
  buffer_store_dwordx2 v[118:119], v114, s[8:11], s21 offen
  buffer_store_dwordx2 v[118:119], v115, s[8:11], s21 offen
  s_buffer_load_dword s70, s[8:11], s35
  s_add_u32 s22, s24, 114688
  s_buffer_load_dword s71, s[8:11], s22
  s_mul_i32 s22, s18, 7168
  s_add_u32 s22, s22, 87040
  s_buffer_load_dword s72, s[8:11], s22
  s_add_u32 s35, s35, 458752
  v_mov_b32 v74, 0
  v_mov_b32 v75, 0
  s_mov_b32 s19, s18
  s_add_u32 s18, s18, 1
  s_mov_b32 s22, s20
  s_mov_b32 s20, s21
  s_mov_b32 s21, s22
  s_add_u32 s23, s20, 4096
  s_cmp_lt_u32 s19, 63
  s_cbranch_scc1 cA_sc2_loop
  s_branch cA_done
cA_sc2_r0:
  s_add_u32 s31, s31, 1
  buffer_load_dwordx4 v[8:11], v2, s[8:11], s20 offen offset:0 sc1
  s_waitcnt vmcnt(0)
  v_cmp_eq_u32 vcc, -1, v8
  v_mov_b32 v36, 0
  v_mov_b32 v37, 0
  v_mov_b32 v38, 0
  v_mov_b32 v39, 0
  v_mov_b32 v40, 0
  v_mov_b32 v41, 0
  v_mov_b32 v42, 0
  v_mov_b32 v43, 0
  v_mov_b32 v44, 0
  v_mov_b32 v45, 0
  v_mov_b32 v46, 0
  v_mov_b32 v47, 0
  v_mov_b32 v48, 0
  v_mov_b32 v49, 0
  v_mov_b32 v50, 0
  v_mov_b32 v51, 0
  s_nop 1
  s_cbranch_vccz cA_sc2_go
  s_add_u32 s30, s30, 1
  s_cmp_lt_u32 s30, 400000
  s_cbranch_scc1 cA_sc2_r0
  s_branch cA_abort
cA_sc2_r1:
  s_add_u32 s31, s31, 1
  buffer_load_dwordx4 v[12:15], v2, s[8:11], s20 offen offset:1024 sc1
  s_waitcnt vmcnt(0)
  v_cmp_eq_u32 vcc, -1, v12
  s_nop 4
  s_cbranch_vccz cA_sc2_c1
  s_add_u32 s30, s30, 1
  s_cmp_lt_u32 s30, 400000
  s_cbranch_scc1 cA_sc2_r1
  s_branch cA_abort
cA_sc2_r2:
  s_add_u32 s31, s31, 1
  buffer_load_dwordx4 v[16:19], v2, s[8:11], s20 offen offset:2048 sc1
  s_waitcnt vmcnt(0)
  v_cmp_eq_u32 vcc, -1, v16
  s_nop 4
  s_cbranch_vccz cA_sc2_c2
  s_add_u32 s30, s30, 1
  s_cmp_lt_u32 s30, 400000
  s_cbranch_scc1 cA_sc2_r2
  s_branch cA_abort
cA_sc2_r3:
  s_add_u32 s31, s31, 1
  buffer_load_dwordx4 v[20:23], v2, s[8:11], s20 offen offset:3072 sc1
  s_waitcnt vmcnt(0)
  v_cmp_eq_u32 vcc, -1, v20
  s_nop 4
  s_cbranch_vccz cA_sc2_c3
  s_add_u32 s30, s30, 1
  s_cmp_lt_u32 s30, 400000
  s_cbranch_scc1 cA_sc2_r3
  s_branch cA_abort
cA_sc2_r4:
  s_add_u32 s31, s31, 1
  buffer_load_dwordx4 v[24:27], v2, s[8:11], s23 offen offset:0 sc1
  buffer_load_dwordx4 v[32:35], v2, s[8:11], s23 offen offset:1024 sc1
  buffer_load_dwordx4 v[28:31], v2, s[8:11], s23 offen offset:2048 sc1
  s_waitcnt vmcnt(0)
  v_max3_u32 v66, v24, v27, v28
  v_max3_u32 v66, v66, v31, v32
  v_max_u32 v66, v66, v35
  v_cmp_eq_u32 vcc, -1, v66
  s_nop 4
  s_cbranch_vccz cA_sc2_c4
  s_add_u32 s30, s30, 1
  s_cmp_lt_u32 s30, 400000
  s_cbranch_scc1 cA_sc2_r4
  s_branch cA_abort
cA_sc2_retry:
  s_cmp_lg_u32 s62, 0
  s_cbranch_scc1 cA_sc2_cont
  s_waitcnt vmcnt(0) lgkmcnt(0)
cA_sc2_rv:
  buffer_load_dwordx4 v[8:11], v2, s[8:11], s20 offen offset:0 sc1
  buffer_load_dwordx4 v[12:15], v2, s[8:11], s20 offen offset:1024 sc1
  buffer_load_dwordx4 v[16:19], v2, s[8:11], s20 offen offset:2048 sc1
  buffer_load_dwordx4 v[20:23], v2, s[8:11], s20 offen offset:3072 sc1
  buffer_load_dwordx4 v[24:27], v2, s[8:11], s23 offen offset:0 sc1
  buffer_load_dwordx4 v[32:35], v2, s[8:11], s23 offen offset:1024 sc1
  buffer_load_dwordx4 v[28:31], v2, s[8:11], s23 offen offset:2048 sc1
  s_waitcnt vmcnt(0)
  v_max3_u32 v66, v8, v9, v10
  v_max3_u32 v66, v66, v11, v12
  v_max3_u32 v66, v66, v13, v14
  v_max3_u32 v66, v66, v15, v16
  v_max3_u32 v66, v66, v17, v18
  v_max3_u32 v66, v66, v19, v20
  v_max3_u32 v66, v66, v21, v22
  v_max3_u32 v66, v66, v23, v24
  v_max3_u32 v66, v66, v25, v26
  v_max3_u32 v66, v66, v27, v28
  v_max3_u32 v66, v66, v29, v30
  v_max3_u32 v66, v66, v31, v32
  v_max3_u32 v66, v66, v33, v34
  v_max_u32 v66, v66, v35
  v_cmp_eq_u32 vcc, -1, v66
  s_cbranch_vccz cA_sc2_rk
  s_add_u32 s30, s30, 1
  s_cmp_lt_u32 s30, 400000
  s_cbranch_scc1 cA_sc2_rv
  s_branch cA_abort
cA_sc2_rk:
  s_mov_b32 s62, 1
  v_mov_b32 v36, 0
  v_mov_b32 v37, 0
  v_mov_b32 v38, 0
  v_mov_b32 v39, 0
  v_mov_b32 v40, 0
  v_mov_b32 v41, 0
  v_mov_b32 v42, 0
  v_mov_b32 v43, 0
  v_mov_b32 v44, 0
  v_mov_b32 v45, 0
  v_mov_b32 v46, 0
  v_mov_b32 v47, 0
  v_mov_b32 v48, 0
  v_mov_b32 v49, 0
  v_mov_b32 v50, 0
  v_mov_b32 v51, 0
  v_mov_b32 v62, 0
  v_mov_b32 v63, 0
  v_mov_b32 v64, 0
  v_mov_b32 v65, 0
  v_mov_b32 v68, 0
  v_mov_b32 v69, 0
  v_mov_b32 v70, 0
  v_mov_b32 v71, 0
  v_mov_b32 v72, 0
  v_mov_b32 v73, 0
  v_mov_b32 v74, 0
  v_mov_b32 v75, 0
  v_mov_b32 v52, 0
  v_mov_b32 v53, 0
  v_mov_b32 v54, 0
  v_mov_b32 v55, 0
  v_mov_b32 v56, 0
  v_mov_b32 v57, 0
  v_mov_b32 v58, 0
  v_mov_b32 v59, 0
  s_add_u32 s31, s31, 0x100
  s_nop 0
  s_branch cA_sc2_go
.p2align 6
cA_sc3_loop:
  s_mov_b32 s30, 0
  s_mov_b32 s62, 0
  s_setprio 3
  s_barrier
  buffer_load_dwordx4 v[8:11], v2, s[8:11], s20 offen offset:0 sc1
  s_setprio 2
  buffer_load_dwordx4 v[12:15], v2, s[8:11], s20 offen offset:1024 sc1
  s_setprio 1
  buffer_load_dwordx4 v[16:19], v2, s[8:11], s20 offen offset:2048 sc1
  s_setprio 0
  buffer_load_dwordx4 v[20:23], v2, s[8:11], s20 offen offset:3072 sc1
cA_sc3_go:
  s_waitcnt vmcnt(3)
  v_smfmac_f32_16x16x64_bf16 v[36:39], v[8:11], a[0:7], v3
  buffer_load_dwordx4 v[24:27], v2, s[8:11], s23 offen offset:0 sc1
  v_cmp_eq_u32 vcc, -1, v8
  v_smfmac_f32_16x16x64_bf16 v[40:43], v[8:11], a[56:63], v3
  v_smfmac_f32_16x16x64_bf16 v[44:47], v[8:11], a[112:119], v3
  buffer_load_dwordx4 v[28:31], v2, s[8:11], s23 offen offset:1024 sc1
  s_cbranch_vccnz cA_sc3_r0
  v_smfmac_f32_16x16x64_bf16 v[48:51], v[8:11], a[168:175], v3
  v_smfmac_f32_16x16x64_bf16 v[52:55], v[8:11], a[224:231], v3
  s_waitcnt vmcnt(4)
  v_cmp_eq_u32 vcc, -1, v12
  v_smfmac_f32_16x16x64_bf16 v[56:59], v[8:11], v[144:151], v3
  buffer_load_dwordx4 v[32:35], v2, s[8:11], s23 offen offset:2048 sc1
  v_smfmac_f32_16x16x64_bf16 v[62:65], v[8:11], v[200:207], v3
  s_cbranch_vccnz cA_sc3_r1
cA_sc3_c1:
  v_smfmac_f32_16x16x64_bf16 v[36:39], v[12:15], a[8:15], v3
  v_smfmac_f32_16x16x64_bf16 v[40:43], v[12:15], a[64:71], v3
  v_smfmac_f32_16x16x64_bf16 v[44:47], v[12:15], a[120:127], v3
  v_smfmac_f32_16x16x64_bf16 v[48:51], v[12:15], a[176:183], v3
  v_smfmac_f32_16x16x64_bf16 v[52:55], v[12:15], a[232:239], v3
  s_waitcnt vmcnt(4)
  v_cmp_eq_u32 vcc, -1, v16
  v_smfmac_f32_16x16x64_bf16 v[56:59], v[12:15], v[152:159], v3
  buffer_load_dwordx4 v[88:91], v117, s[8:11], s26 offen offset:0 sc1
  v_smfmac_f32_16x16x64_bf16 v[62:65], v[12:15], v[208:215], v3
  s_cbranch_vccnz cA_sc3_r2
cA_sc3_c2:
  v_smfmac_f32_16x16x64_bf16 v[36:39], v[16:19], a[16:23], v3
  v_smfmac_f32_16x16x64_bf16 v[40:43], v[16:19], a[72:79], v3
  v_smfmac_f32_16x16x64_bf16 v[44:47], v[16:19], a[128:135], v3
  buffer_load_dwordx4 v[92:95], v117, s[8:11], s26 offen offset:1024 sc1
  v_smfmac_f32_16x16x64_bf16 v[48:51], v[16:19], a[184:191], v3
  v_smfmac_f32_16x16x64_bf16 v[52:55], v[16:19], a[240:247], v3
  s_waitcnt vmcnt(5)
  v_cmp_eq_u32 vcc, -1, v20
  v_smfmac_f32_16x16x64_bf16 v[56:59], v[16:19], v[160:167], v3
  v_smfmac_f32_16x16x64_bf16 v[62:65], v[16:19], v[216:223], v3
  buffer_load_dwordx4 v[96:99], v2, s[8:11], s24 offen offset:0 sc1
  s_cbranch_vccnz cA_sc3_r3
cA_sc3_c3:
  v_smfmac_f32_16x16x64_bf16 v[36:39], v[20:23], a[24:31], v3
  v_smfmac_f32_16x16x64_bf16 v[40:43], v[20:23], a[80:87], v3
  s_waitcnt vmcnt(3)
  v_max3_u32 v66, v24, v27, v28
  v_smfmac_f32_16x16x64_bf16 v[44:47], v[20:23], a[136:143], v3
  v_max3_u32 v66, v66, v31, v32
  v_smfmac_f32_16x16x64_bf16 v[48:51], v[20:23], a[192:199], v3
  buffer_load_dwordx4 v[100:103], v2, s[8:11], s24 offen offset:1024 sc1
  v_max_u32 v66, v66, v35
  v_smfmac_f32_16x16x64_bf16 v[52:55], v[20:23], a[248:255], v3
  v_cmp_eq_u32 vcc, -1, v66
  v_smfmac_f32_16x16x64_bf16 v[56:59], v[20:23], v[168:175], v3
  v_smfmac_f32_16x16x64_bf16 v[62:65], v[20:23], v[224:231], v3
  s_cbranch_vccnz cA_sc3_r4
cA_sc3_c4:
  v_smfmac_f32_16x16x64_bf16 v[62:65], v[24:27], v[232:239], v3
  buffer_load_dwordx4 v[104:107], v2, s[8:11], s26 offen offset:0 sc1
  v_smfmac_f32_16x16x64_bf16 v[62:65], v[28:31], v[240:247], v3
  v_smfmac_f32_16x16x64_bf16 v[62:65], v[32:35], v[248:255], v3
  v_smfmac_f32_16x16x64_bf16 v[52:55], v[24:27], v[120:127], v3
  v_smfmac_f32_16x16x64_bf16 v[52:55], v[28:31], v[128:135], v3
  buffer_load_dwordx4 v[108:111], v2, s[8:11], s26 offen offset:1024 sc1
  v_smfmac_f32_16x16x64_bf16 v[52:55], v[32:35], v[136:143], v3
  v_cvt_pk_bf16_f32 v62, v62, v63
  v_smfmac_f32_16x16x64_bf16 v[56:59], v[24:27], v[176:183], v3
  v_cvt_pk_bf16_f32 v63, v64, v65
  v_smfmac_f32_16x16x64_bf16 v[56:59], v[28:31], v[184:191], v3
  v_mfma_f32_16x16x32_bf16 v[8:11], v[60:63], v[4:7], 0
  v_cvt_pk_bf16_f32 v55, v54, v55
  v_smfmac_f32_16x16x64_bf16 v[56:59], v[32:35], v[192:199], v3
  v_cvt_pk_bf16_f32 v54, v52, v53
  v_smfmac_f32_16x16x64_bf16 v[36:39], v[24:27], a[32:39], v3
  s_nop 1
  v_cvt_pk_bf16_f32 v78, v8, v9
  v_smfmac_f32_16x16x64_bf16 v[36:39], v[28:31], a[40:47], v3
  v_cvt_pk_bf16_f32 v79, v10, v11
  v_smfmac_f32_16x16x64_bf16 v[36:39], v[32:35], a[48:55], v3
  v_cvt_pk_bf16_f32 v56, v56, v57
  v_smfmac_f32_16x16x64_bf16 v[40:43], v[24:27], a[88:95], v3
  v_cvt_pk_bf16_f32 v57, v58, v59
  v_smfmac_f32_16x16x64_bf16 v[40:43], v[28:31], a[96:103], v3
  v_mfma_f32_16x16x32_bf16 v[12:15], v[54:57], v[4:7], 0
  v_cvt_pk_bf16_f32 v39, v38, v39
  v_smfmac_f32_16x16x64_bf16 v[40:43], v[32:35], a[104:111], v3
  v_cvt_pk_bf16_f32 v38, v36, v37
  v_smfmac_f32_16x16x64_bf16 v[44:47], v[24:27], a[144:151], v3
  s_nop 1
  v_cvt_pk_bf16_f32 v76, v12, v13
  v_smfmac_f32_16x16x64_bf16 v[44:47], v[28:31], a[152:159], v3
  v_cvt_pk_bf16_f32 v77, v14, v15
  v_smfmac_f32_16x16x64_bf16 v[44:47], v[32:35], a[160:167], v3
  v_cvt_pk_bf16_f32 v40, v40, v41
  v_smfmac_f32_16x16x64_bf16 v[48:51], v[24:27], a[200:207], v3
  v_cvt_pk_bf16_f32 v41, v42, v43
  v_smfmac_f32_16x16x64_bf16 v[48:51], v[28:31], a[208:215], v3
  v_smfmac_f32_16x16x64_bf16 v[48:51], v[32:35], a[216:223], v3
  s_waitcnt vmcnt(4)
  v_cvt_pk_bf16_f32 v47, v46, v47
  v_smfmac_f32_16x16x64_bf16 v[68:71], v[76:79], v[80:87], v3
  v_cvt_pk_bf16_f32 v46, v44, v45
  v_mfma_f32_16x16x32_bf16 v[8:11], v[38:41], v[4:7], 0
  s_nop 1
  v_cvt_pk_bf16_f32 v48, v48, v49
  v_cvt_pk_bf16_f32 v49, v50, v51
  s_nop 1
  v_mfma_f32_16x16x32_bf16 v[12:15], v[46:49], v[4:7], 0
  v_smfmac_f32_16x16x64_bf16 v[72:75], v[76:79], v[88:95], v3
  v_cvt_pk_bf16_f32 v16, v8, v9
  v_mfma_f32_16x16x32_bf16 v[52:55], v[30:33], v[76:79], 0
  s_waitcnt vmcnt(0)
  v_cvt_pk_bf16_f32 v17, v10, v11
  v_cvt_pk_bf16_f32 v18, v12, v13
  v_cvt_pk_bf16_f32 v19, v14, v15
  s_nop 1
  v_mfma_f32_16x16x32_bf16 v[52:55], v[20:23], v[16:19], v[52:55]
  v_smfmac_f32_16x16x64_bf16 v[68:71], v[16:19], v[96:103], v3
  v_smfmac_f32_16x16x64_bf16 v[72:75], v[16:19], v[104:111], v3
  s_nop 1
  ds_write_b128 v113, v[52:55]
  s_nop 1
  v_permlane32_swap_b32 v68, v70
  v_permlane32_swap_b32 v69, v71
  v_add_f32 v56, v68, v70
  v_add_f32 v58, v69, v71
  v_permlane32_swap_b32 v72, v74
  v_permlane32_swap_b32 v73, v75
  v_add_f32 v57, v72, v74
  v_add_f32 v59, v73, v75
  ds_write_b128 v2, v[56:59] offset:3072
  v_cmp_u_f32 vcc, v57, v59
  v_mov_b32 v68, 0
  v_mov_b32 v69, 0
  v_mov_b32 v70, 0
  v_mov_b32 v71, 0
  s_cbranch_vccnz cA_sc3_retry
cA_sc3_cont:
  s_add_u32 s24, s24, 28672
  s_add_u32 s26, s26, 28672
  buffer_load_dwordx4 v[80:83], v117, s[8:11], s24 offen offset:0 sc1
  buffer_load_dwordx4 v[84:87], v117, s[8:11], s24 offen offset:1024 sc1
  v_mov_b32 v72, 0
  v_mov_b32 v73, 0
  v_mfma_f32_16x16x32_bf16 v[62:65], v[68:71], v[68:71], 0
  s_waitcnt lgkmcnt(0)
  s_barrier
  v_mov_b32 v52, 0
  v_mov_b32 v53, 0
  v_mov_b32 v54, 0
  v_mov_b32 v55, 0
  v_mov_b32 v56, 0
  v_mov_b32 v57, 0
  v_mov_b32 v58, 0
  v_mov_b32 v59, 0
  v_mfma_f32_32x32x16_bf16 v[36:51], v[68:71], v[68:71], 0
  v_mov_b32 v74, 0
  v_mov_b32 v75, 0
  s_mov_b32 s19, s18
  s_add_u32 s18, s18, 1
  s_mov_b32 s22, s20
  s_mov_b32 s20, s21
  s_mov_b32 s21, s22
  s_add_u32 s23, s20, 4096
  s_cmp_lt_u32 s19, 63
  s_nop 2
  s_cbranch_scc1 cA_sc3_loop
  s_branch cA_done
cA_sc3_r0:
  s_add_u32 s31, s31, 1
  buffer_load_dwordx4 v[8:11], v2, s[8:11], s20 offen offset:0 sc1
  s_waitcnt vmcnt(0)
  v_cmp_eq_u32 vcc, -1, v8
  v_mov_b32 v36, 0
  v_mov_b32 v37, 0
  v_mov_b32 v38, 0
  v_mov_b32 v39, 0
  v_mov_b32 v40, 0
  v_mov_b32 v41, 0
  v_mov_b32 v42, 0
  v_mov_b32 v43, 0
  v_mov_b32 v44, 0
  v_mov_b32 v45, 0
  v_mov_b32 v46, 0
  v_mov_b32 v47, 0
  v_mov_b32 v48, 0
  v_mov_b32 v49, 0
  v_mov_b32 v50, 0
  v_mov_b32 v51, 0
  s_nop 1
  s_cbranch_vccz cA_sc3_go
  s_add_u32 s30, s30, 1
  s_cmp_lt_u32 s30, 400000
  s_cbranch_scc1 cA_sc3_r0
  s_branch cA_abort
cA_sc3_r1:
  s_add_u32 s31, s31, 1
  buffer_load_dwordx4 v[12:15], v2, s[8:11], s20 offen offset:1024 sc1
  s_waitcnt vmcnt(0)
  v_cmp_eq_u32 vcc, -1, v12
  s_nop 4
  s_cbranch_vccz cA_sc3_c1
  s_add_u32 s30, s30, 1
  s_cmp_lt_u32 s30, 400000
  s_cbranch_scc1 cA_sc3_r1
  s_branch cA_abort
cA_sc3_r2:
  s_add_u32 s31, s31, 1
  buffer_load_dwordx4 v[16:19], v2, s[8:11], s20 offen offset:2048 sc1
  s_waitcnt vmcnt(0)
  v_cmp_eq_u32 vcc, -1, v16
  s_nop 4
  s_cbranch_vccz cA_sc3_c2
  s_add_u32 s30, s30, 1
  s_cmp_lt_u32 s30, 400000
  s_cbranch_scc1 cA_sc3_r2
  s_branch cA_abort
cA_sc3_r3:
  s_add_u32 s31, s31, 1
  buffer_load_dwordx4 v[20:23], v2, s[8:11], s20 offen offset:3072 sc1
  s_waitcnt vmcnt(0)
  v_cmp_eq_u32 vcc, -1, v20
  s_nop 4
  s_cbranch_vccz cA_sc3_c3
  s_add_u32 s30, s30, 1
  s_cmp_lt_u32 s30, 400000
  s_cbranch_scc1 cA_sc3_r3
  s_branch cA_abort
cA_sc3_r4:
  s_add_u32 s31, s31, 1
  buffer_load_dwordx4 v[24:27], v2, s[8:11], s23 offen offset:0 sc1
  buffer_load_dwordx4 v[28:31], v2, s[8:11], s23 offen offset:1024 sc1
  buffer_load_dwordx4 v[32:35], v2, s[8:11], s23 offen offset:2048 sc1
  s_waitcnt vmcnt(0)
  v_max3_u32 v66, v24, v27, v28
  v_max3_u32 v66, v66, v31, v32
  v_max_u32 v66, v66, v35
  v_cmp_eq_u32 vcc, -1, v66
  s_nop 4
  s_cbranch_vccz cA_sc3_c4
  s_add_u32 s30, s30, 1
  s_cmp_lt_u32 s30, 400000
  s_cbranch_scc1 cA_sc3_r4
  s_branch cA_abort
cA_sc3_retry:
  s_cmp_lg_u32 s62, 0
  s_cbranch_scc1 cA_sc3_cont
  s_waitcnt vmcnt(0) lgkmcnt(0)
cA_sc3_rv:
  buffer_load_dwordx4 v[8:11], v2, s[8:11], s20 offen offset:0 sc1
  buffer_load_dwordx4 v[12:15], v2, s[8:11], s20 offen offset:1024 sc1
  buffer_load_dwordx4 v[16:19], v2, s[8:11], s20 offen offset:2048 sc1
  buffer_load_dwordx4 v[20:23], v2, s[8:11], s20 offen offset:3072 sc1
  buffer_load_dwordx4 v[24:27], v2, s[8:11], s23 offen offset:0 sc1
  buffer_load_dwordx4 v[28:31], v2, s[8:11], s23 offen offset:1024 sc1
  buffer_load_dwordx4 v[32:35], v2, s[8:11], s23 offen offset:2048 sc1
  s_waitcnt vmcnt(0)
  v_max3_u32 v66, v8, v9, v10
  v_max3_u32 v66, v66, v11, v12
  v_max3_u32 v66, v66, v13, v14
  v_max3_u32 v66, v66, v15, v16
  v_max3_u32 v66, v66, v17, v18
  v_max3_u32 v66, v66, v19, v20
  v_max3_u32 v66, v66, v21, v22
  v_max3_u32 v66, v66, v23, v24
  v_max3_u32 v66, v66, v25, v26
  v_max3_u32 v66, v66, v27, v28
  v_max3_u32 v66, v66, v29, v30
  v_max3_u32 v66, v66, v31, v32
  v_max3_u32 v66, v66, v33, v34
  v_max_u32 v66, v66, v35
  v_cmp_eq_u32 vcc, -1, v66
  s_cbranch_vccz cA_sc3_rk
  s_add_u32 s30, s30, 1
  s_cmp_lt_u32 s30, 400000
  s_cbranch_scc1 cA_sc3_rv
  s_branch cA_abort
cA_sc3_rk:
  s_mov_b32 s62, 1
  v_mov_b32 v36, 0
  v_mov_b32 v37, 0
  v_mov_b32 v38, 0
  v_mov_b32 v39, 0
  v_mov_b32 v40, 0
  v_mov_b32 v41, 0
  v_mov_b32 v42, 0
  v_mov_b32 v43, 0
  v_mov_b32 v44, 0
  v_mov_b32 v45, 0
  v_mov_b32 v46, 0
  v_mov_b32 v47, 0
  v_mov_b32 v48, 0
  v_mov_b32 v49, 0
  v_mov_b32 v50, 0
  v_mov_b32 v51, 0
  v_mov_b32 v62, 0
  v_mov_b32 v63, 0
  v_mov_b32 v64, 0
  v_mov_b32 v65, 0
  v_mov_b32 v68, 0
  v_mov_b32 v69, 0
  v_mov_b32 v70, 0
  v_mov_b32 v71, 0
  v_mov_b32 v72, 0
  v_mov_b32 v73, 0
  v_mov_b32 v74, 0
  v_mov_b32 v75, 0
  v_mov_b32 v52, 0
  v_mov_b32 v53, 0
  v_mov_b32 v54, 0
  v_mov_b32 v55, 0
  v_mov_b32 v56, 0
  v_mov_b32 v57, 0
  v_mov_b32 v58, 0
  v_mov_b32 v59, 0
  s_add_u32 s31, s31, 0x100
  s_nop 0
  s_branch cA_sc3_go
.p2align 6
cA_va0_loop:
  s_mov_b32 s30, 0
  s_barrier
  buffer_load_dwordx4 v[24:27], v2, s[8:11], s23 offen offset:0 sc1
  buffer_load_dwordx4 v[28:31], v2, s[8:11], s23 offen offset:1024 sc1
  s_barrier
  s_cmp_lt_u32 s19, 60
  s_cbranch_scc1 cA_va0_m1
  buffer_store_dword v160, v1, s[8:11], s38 offen sc1
  s_cmp_lg_u32 s19, 63
  s_cbranch_scc1 cA_va0_m2
  v_min_u32 v64, -2, v64
  v_min_u32 v65, -2, v65
  v_min_u32 v66, -2, v66
  v_min_u32 v67, -2, v67
  v_min_u32 v68, -2, v68
  v_min_u32 v69, -2, v69
  v_min_u32 v70, -2, v70
  v_min_u32 v71, -2, v71
  v_min_u32 v72, -2, v72
  v_min_u32 v73, -2, v73
  v_min_u32 v74, -2, v74
  v_min_u32 v75, -2, v75
  v_min_u32 v76, -2, v76
  v_min_u32 v77, -2, v77
  v_min_u32 v78, -2, v78
  v_min_u32 v79, -2, v79
  buffer_store_dwordx4 v[64:67], v2, s[8:11], s33 offen offset:0 sc1
  buffer_store_dwordx4 v[68:71], v2, s[8:11], s33 offen offset:2048 sc1
  s_add_u32 s33, s33, 4096
  buffer_store_dwordx4 v[72:75], v2, s[8:11], s33 offen offset:0 sc1
  buffer_store_dwordx4 v[76:79], v2, s[8:11], s33 offen offset:2048 sc1
  s_add_u32 s33, s33, 4096
  s_waitcnt vmcnt(5)
  s_branch cA_va0_m3
cA_va0_m1:
  buffer_store_dword v160, v1, s[8:11], s38 offen nt
cA_va0_m2:
  s_add_u32 s22, s25, 0
  buffer_load_dwordx4 v[80:83], v6, s[8:11], s22 offen offset:0 sc1
  buffer_load_dwordx4 v[84:87], v6, s[8:11], s22 offen offset:1792 sc1
  s_add_u32 s22, s25, 3584
  buffer_load_dwordx4 v[88:91], v6, s[8:11], s22 offen offset:0 sc1
  buffer_load_dwordx4 v[92:95], v6, s[8:11], s22 offen offset:1792 sc1
  s_add_u32 s22, s25, 7168
  buffer_load_dwordx4 v[96:99], v6, s[8:11], s22 offen offset:0 sc1
  s_mul_i32 s38, s18, 7168
  s_add_u32 s38, s38, 65536
  s_waitcnt vmcnt(6)
cA_va0_m3:
  ds_write_b128 v2, v[24:27] offset:12288
  ds_write_b128 v2, v[28:31] offset:13312
  v_smfmac_f32_16x16x64_bf16 v[36:39], v[24:27], a[32:39], v3
  buffer_load_dwordx4 v[100:103], v6, s[8:11], s22 offen offset:1792 sc1
  v_smfmac_f32_16x16x64_bf16 v[40:43], v[24:27], a[88:95], v3
  s_add_u32 s22, s25, 10752
  buffer_load_dwordx4 v[104:107], v6, s[8:11], s22 offen offset:0 sc1
  v_smfmac_f32_16x16x64_bf16 v[44:47], v[24:27], a[144:151], v3
  buffer_load_dwordx4 v[108:111], v6, s[8:11], s22 offen offset:1792 sc1
  v_smfmac_f32_16x16x64_bf16 v[48:51], v[24:27], a[200:207], v3
  s_add_u32 s22, s25, 14336
  buffer_load_dwordx4 v[112:115], v6, s[8:11], s22 offen offset:0 sc1
  v_smfmac_f32_16x16x64_bf16 v[52:55], v[24:27], v[176:183], v3
  s_waitcnt lgkmcnt(0)
  s_barrier
  ds_read_b128 v[8:11], v2 offset:8192
  ds_read_b128 v[12:15], v2 offset:9216
  ds_read_b128 v[16:19], v2 offset:10240
  ds_read_b128 v[20:23], v2 offset:11264
  ds_read_b128 v[32:35], v2 offset:14336
  buffer_load_dwordx4 v[116:119], v6, s[8:11], s22 offen offset:1792 sc1
  v_smfmac_f32_16x16x64_bf16 v[56:59], v[24:27], v[232:239], v3
  s_add_u32 s22, s25, 17920
  buffer_load_dwordx4 v[120:123], v6, s[8:11], s22 offen offset:0 sc1
  v_smfmac_f32_16x16x64_bf16 v[36:39], v[28:31], a[40:47], v3
  buffer_load_dwordx4 v[124:127], v6, s[8:11], s22 offen offset:1792 sc1
  v_smfmac_f32_16x16x64_bf16 v[40:43], v[28:31], a[96:103], v3
  s_add_u32 s22, s25, 21504
  buffer_load_dwordx4 v[128:131], v6, s[8:11], s22 offen offset:0 sc1
  v_smfmac_f32_16x16x64_bf16 v[44:47], v[28:31], a[152:159], v3
  buffer_load_dwordx4 v[132:135], v6, s[8:11], s22 offen offset:1792 sc1
  v_smfmac_f32_16x16x64_bf16 v[48:51], v[28:31], a[208:215], v3
  s_add_u32 s22, s25, 25088
  buffer_load_dwordx4 v[136:139], v6, s[8:11], s22 offen offset:0 sc1
  v_smfmac_f32_16x16x64_bf16 v[52:55], v[28:31], v[184:191], v3
  buffer_load_dwordx4 v[140:143], v6, s[8:11], s22 offen offset:1792 sc1
  v_smfmac_f32_16x16x64_bf16 v[56:59], v[28:31], v[240:247], v3
  s_waitcnt lgkmcnt(4)
  v_smfmac_f32_16x16x64_bf16 v[36:39], v[8:11], a[0:7], v3
  s_waitcnt lgkmcnt(3)
  v_smfmac_f32_16x16x64_bf16 v[36:39], v[12:15], a[8:15], v3
  s_waitcnt lgkmcnt(2)
  v_smfmac_f32_16x16x64_bf16 v[36:39], v[16:19], a[16:23], v3
  s_waitcnt lgkmcnt(1)
  v_smfmac_f32_16x16x64_bf16 v[36:39], v[20:23], a[24:31], v3
  s_waitcnt lgkmcnt(0)
  v_smfmac_f32_16x16x64_bf16 v[36:39], v[32:35], a[48:55], v3
  v_smfmac_f32_16x16x64_bf16 v[40:43], v[8:11], a[56:63], v3
  v_smfmac_f32_16x16x64_bf16 v[40:43], v[12:15], a[64:71], v3
  v_smfmac_f32_16x16x64_bf16 v[40:43], v[16:19], a[72:79], v3
  v_permlane32_swap_b32 v36, v38
  v_smfmac_f32_16x16x64_bf16 v[40:43], v[20:23], a[80:87], v3
  v_permlane32_swap_b32 v37, v39
  v_smfmac_f32_16x16x64_bf16 v[40:43], v[32:35], a[104:111], v3
  v_add_f32 v36, v36, v38
  v_smfmac_f32_16x16x64_bf16 v[44:47], v[8:11], a[112:119], v3
  v_add_f32 v37, v37, v39
  v_smfmac_f32_16x16x64_bf16 v[44:47], v[12:15], a[120:127], v3
  v_cmp_u_f32 vcc, v36, v37
  v_smfmac_f32_16x16x64_bf16 v[44:47], v[16:19], a[128:135], v3
  v_cvt_pk_bf16_f32 v38, v36, v37
  v_smfmac_f32_16x16x64_bf16 v[44:47], v[20:23], a[136:143], v3
  ds_write_b32 v152, v38
  s_cbranch_vccnz cA_va0_slow
  v_permlane32_swap_b32 v40, v42
  v_smfmac_f32_16x16x64_bf16 v[44:47], v[32:35], a[160:167], v3
  v_permlane32_swap_b32 v41, v43
  v_smfmac_f32_16x16x64_bf16 v[48:51], v[8:11], a[168:175], v3
  buffer_store_dword v162, v1, s[8:11], s21 offen
  v_add_f32 v40, v40, v42
  v_smfmac_f32_16x16x64_bf16 v[48:51], v[12:15], a[176:183], v3
  v_add_f32 v41, v41, v43
  v_smfmac_f32_16x16x64_bf16 v[48:51], v[16:19], a[184:191], v3
  buffer_load_dword v164, v4, s[8:11], 0 offen sc1
  v_cvt_pk_bf16_f32 v42, v40, v41
  v_smfmac_f32_16x16x64_bf16 v[48:51], v[20:23], a[192:199], v3
  ds_write_b32 v153, v42
  v_permlane32_swap_b32 v44, v46
  v_smfmac_f32_16x16x64_bf16 v[48:51], v[32:35], a[216:223], v3
  v_permlane32_swap_b32 v45, v47
  v_smfmac_f32_16x16x64_bf16 v[52:55], v[8:11], a[224:231], v3
  buffer_load_dword v164, v4, s[8:11], 0 offen sc1
  v_add_f32 v44, v44, v46
  v_smfmac_f32_16x16x64_bf16 v[52:55], v[12:15], a[232:239], v3
  v_add_f32 v45, v45, v47
  v_smfmac_f32_16x16x64_bf16 v[52:55], v[16:19], a[240:247], v3
  v_cvt_pk_bf16_f32 v46, v44, v45
  v_smfmac_f32_16x16x64_bf16 v[52:55], v[20:23], a[248:255], v3
  ds_write_b32 v154, v46
  buffer_load_dword v164, v4, s[8:11], 0 offen sc1
  v_permlane32_swap_b32 v48, v50
  v_smfmac_f32_16x16x64_bf16 v[52:55], v[32:35], v[192:199], v3
  v_permlane32_swap_b32 v49, v51
  v_smfmac_f32_16x16x64_bf16 v[56:59], v[8:11], v[200:207], v3
  v_add_f32 v48, v48, v50
  v_smfmac_f32_16x16x64_bf16 v[56:59], v[12:15], v[208:215], v3
  buffer_load_dword v164, v4, s[8:11], 0 offen sc1
  v_add_f32 v49, v49, v51
  v_smfmac_f32_16x16x64_bf16 v[56:59], v[16:19], v[216:223], v3
  v_cvt_pk_bf16_f32 v50, v48, v49
  v_smfmac_f32_16x16x64_bf16 v[56:59], v[20:23], v[224:231], v3
  ds_write_b32 v155, v50
  v_permlane32_swap_b32 v52, v54
  v_smfmac_f32_16x16x64_bf16 v[56:59], v[32:35], v[248:255], v3
  buffer_load_dword v164, v4, s[8:11], 0 offen sc1
  v_permlane32_swap_b32 v53, v55
  v_add_f32 v52, v52, v54
  v_add_f32 v53, v53, v55
  v_cvt_pk_bf16_f32 v54, v52, v53
  ds_write_b32 v156, v54
  s_nop 1
  v_permlane32_swap_b32 v56, v58
  v_permlane32_swap_b32 v57, v59
  v_add_f32 v56, v56, v58
  v_add_f32 v57, v57, v59
  v_cvt_pk_bf16_f32 v58, v56, v57
  ds_write_b32 v157, v58
cA_va0_t2d:
  s_add_u32 s22, s20, 9216
  s_add_u32 s34, s20, 13312
  s_add_u32 s36, s20, 7168
  s_mov_b32 s37, 0
  v_mov_b32 v48, 0
  v_mov_b32 v49, 0
  v_mov_b32 v50, 0
  v_mov_b32 v51, 0
  v_mov_b32 v163, s18
  s_cmp_eq_u32 s19, 63
  s_waitcnt lgkmcnt(0)
  s_cbranch_scc1 cA_va0_last
  s_setprio 3
cA_va0_fw_l:
  v_cmp_gt_u32 vcc, s18, v164
  buffer_load_dword v164, v4, s[8:11], 0 offen sc1
  s_cbranch_vccz cA_va0_fw_d
  v_cmp_gt_u32 vcc, s18, v164
  buffer_load_dword v164, v4, s[8:11], 0 offen sc1
  s_cbranch_vccz cA_va0_fw_d
  v_cmp_gt_u32 vcc, s18, v164
  buffer_load_dword v164, v4, s[8:11], 0 offen sc1
  s_cbranch_vccz cA_va0_fw_d
  v_cmp_gt_u32 vcc, s18, v164
  buffer_load_dword v164, v4, s[8:11], 0 offen sc1
  s_cbranch_vccz cA_va0_fw_d
  v_cmp_gt_u32 vcc, s18, v164
  buffer_load_dword v164, v4, s[8:11], 0 offen sc1
  s_cbranch_vccz cA_va0_fw_d
  v_cmp_gt_u32 vcc, s18, v164
  buffer_load_dword v164, v4, s[8:11], 0 offen sc1
  s_cbranch_vccz cA_va0_fw_d
  v_cmp_gt_u32 vcc, s18, v164
  buffer_load_dword v164, v4, s[8:11], 0 offen sc1
  s_cbranch_vccz cA_va0_fw_d
  v_cmp_gt_u32 vcc, s18, v164
  buffer_load_dword v164, v4, s[8:11], 0 offen sc1
  s_cbranch_vccz cA_va0_fw_d
  v_cmp_gt_u32 vcc, s18, v164
  buffer_load_dword v164, v4, s[8:11], 0 offen sc1
  s_cbranch_vccz cA_va0_fw_d
  v_cmp_gt_u32 vcc, s18, v164
  buffer_load_dword v164, v4, s[8:11], 0 offen sc1
  s_cbranch_vccz cA_va0_fw_d
  v_cmp_gt_u32 vcc, s18, v164
  buffer_load_dword v164, v4, s[8:11], 0 offen sc1
  s_cbranch_vccz cA_va0_fw_d
  v_cmp_gt_u32 vcc, s18, v164
  buffer_load_dword v164, v4, s[8:11], 0 offen sc1
  s_cbranch_vccz cA_va0_fw_d
  v_cmp_gt_u32 vcc, s18, v164
  buffer_load_dword v164, v4, s[8:11], 0 offen sc1
  s_cbranch_vccz cA_va0_fw_d
  v_cmp_gt_u32 vcc, s18, v164
  buffer_load_dword v164, v4, s[8:11], 0 offen sc1
  s_cbranch_vccz cA_va0_fw_d
  v_cmp_gt_u32 vcc, s18, v164
  buffer_load_dword v164, v4, s[8:11], 0 offen sc1
  s_cbranch_vccz cA_va0_fw_d
  v_cmp_gt_u32 vcc, s18, v164
  buffer_load_dword v164, v4, s[8:11], 0 offen sc1
  s_cbranch_vccz cA_va0_fw_d
  s_waitcnt vmcnt(24)
  s_add_u32 s30, s30, 1
  s_cmp_lt_u32 s30, 400000
  s_cbranch_scc1 cA_va0_fw_l
  s_branch cA_abort
cA_va0_fw_d:
  buffer_load_dwordx4 v[8:11], v2, s[8:11], s22 offen offset:0 sc1
  buffer_load_dwordx4 v[12:15], v2, s[8:11], s22 offen offset:1024 sc1
  buffer_load_dwordx4 v[16:19], v2, s[8:11], s22 offen offset:2048 sc1
  buffer_load_dwordx4 v[20:23], v2, s[8:11], s22 offen offset:3072 sc1
  buffer_load_dwordx4 v[24:27], v2, s[8:11], s34 offen offset:0 sc1
  buffer_load_dwordx4 v[28:31], v2, s[8:11], s34 offen offset:1024 sc1
  buffer_load_dwordx4 v[32:35], v2, s[8:11], s34 offen offset:2048 sc1
  buffer_load_dwordx4 v[36:39], v2, s[8:11], s34 offen offset:3072 sc1
  buffer_load_dwordx4 v[40:43], v2, s[8:11], s36 offen offset:0 sc1
  buffer_load_dwordx4 v[44:47], v2, s[8:11], s36 offen offset:1024 sc1
  s_barrier
  ds_read_b128 v[64:67], v2 offset:0
  ds_read_b128 v[68:71], v2 offset:1024
  ds_read_b128 v[72:75], v2 offset:2048
  ds_read_b128 v[76:79], v2 offset:3072
cA_va0_lp:
  s_waitcnt vmcnt(9)
  v_smfmac_f32_16x16x64_bf16 v[48:51], v[8:11], v[80:87], v3
  s_waitcnt vmcnt(8)
  v_smfmac_f32_16x16x64_bf16 v[48:51], v[12:15], v[88:95], v3
  s_waitcnt vmcnt(7)
  v_smfmac_f32_16x16x64_bf16 v[48:51], v[16:19], v[96:103], v3
  s_waitcnt vmcnt(6)
  v_smfmac_f32_16x16x64_bf16 v[48:51], v[20:23], v[104:111], v3
  s_waitcnt vmcnt(5)
  v_smfmac_f32_16x16x64_bf16 v[48:51], v[24:27], v[112:119], v3
  s_waitcnt vmcnt(4)
  v_smfmac_f32_16x16x64_bf16 v[48:51], v[28:31], v[120:127], v3
  s_waitcnt vmcnt(3)
  v_smfmac_f32_16x16x64_bf16 v[48:51], v[32:35], v[128:135], v3
  s_waitcnt vmcnt(2)
  v_smfmac_f32_16x16x64_bf16 v[48:51], v[36:39], v[136:143], v3
  s_waitcnt vmcnt(1) lgkmcnt(0)
  v_smfmac_f32_16x16x64_bf16 v[48:51], v[40:43], v[64:71], v3
  s_waitcnt vmcnt(0)
  v_smfmac_f32_16x16x64_bf16 v[48:51], v[44:47], v[72:79], v3
  s_nop 7
  v_permlane32_swap_b32 v48, v50
  v_permlane32_swap_b32 v49, v51
  v_pk_add_f32 v[48:49], v[48:49], v[50:51]
  v_cvt_pk_bf16_f32 v160, v48, v49
  v_cmp_u_f32 vcc, v48, v49
  s_nop 0
  v_mov_b32_dpp v161, v160 quad_perm:[1,0,3,2] row_mask:0xf bank_mask:0xf
  v_perm_b32 v160, v161, v160, v5
  v_cndmask_b32 v161, v160, v162, vcc
  buffer_store_dword v161, v1, s[8:11], s21 offen
  s_cbranch_vccnz cA_va0_rp
cA_va0_cont:
  s_setprio 0
  s_cmp_lg_u32 s19, 62
  s_cbranch_scc1 cA_va0_nl
  s_sleep 4
  buffer_store_dword v160, v1, s[8:11], s38 offen sc1
  s_mov_b32 s38, 0x40000000
  s_mov_b32 s25, 0x40000000
cA_va0_nl:
  s_add_u32 s25, s25, 458752
  v_mov_b32 v36, 0
  v_mov_b32 v37, 0
  v_mov_b32 v38, 0
  v_mov_b32 v39, 0
  v_mov_b32 v40, 0
  v_mov_b32 v41, 0
  v_mov_b32 v42, 0
  v_mov_b32 v43, 0
  v_mov_b32 v44, 0
  v_mov_b32 v45, 0
  v_mov_b32 v46, 0
  v_mov_b32 v47, 0
  v_mov_b32 v48, 0
  v_mov_b32 v49, 0
  v_mov_b32 v50, 0
  v_mov_b32 v51, 0
  v_mov_b32 v52, 0
  v_mov_b32 v53, 0
  v_mov_b32 v54, 0
  v_mov_b32 v55, 0
  v_mov_b32 v56, 0
  v_mov_b32 v57, 0
  v_mov_b32 v58, 0
  v_mov_b32 v59, 0
  v_mov_b32 v60, 0
  v_mov_b32 v61, 0
  v_mov_b32 v62, 0
  v_mov_b32 v63, 0
  s_mov_b32 s19, s18
  s_add_u32 s18, s18, 1
  s_mov_b32 s22, s20
  s_mov_b32 s20, s21
  s_mov_b32 s21, s22
  s_add_u32 s23, s20, 4096
  s_branch cA_va0_loop
cA_va0_slow:
  s_waitcnt lgkmcnt(0)
cA_va0_sl1:
  s_add_u32 s31, s31, 0x1000000
  buffer_load_dwordx4 v[8:11], v2, s[8:11], s20 offen offset:0 sc1
  buffer_load_dwordx4 v[12:15], v2, s[8:11], s20 offen offset:1024 sc1
  buffer_load_dwordx4 v[16:19], v2, s[8:11], s20 offen offset:2048 sc1
  buffer_load_dwordx4 v[20:23], v2, s[8:11], s20 offen offset:3072 sc1
  buffer_load_dwordx4 v[24:27], v2, s[8:11], s23 offen offset:0 sc1
  buffer_load_dwordx4 v[28:31], v2, s[8:11], s23 offen offset:1024 sc1
  buffer_load_dwordx4 v[32:35], v2, s[8:11], s23 offen offset:2048 sc1
  s_waitcnt vmcnt(0)
  v_max3_u32 v36, v8, v9, v10
  v_max3_u32 v36, v36, v11, v12
  v_max3_u32 v36, v36, v13, v14
  v_max3_u32 v36, v36, v15, v16
  v_max3_u32 v36, v36, v17, v18
  v_max3_u32 v36, v36, v19, v20
  v_max3_u32 v36, v36, v21, v22
  v_max3_u32 v36, v36, v23, v24
  v_max3_u32 v36, v36, v25, v26
  v_max3_u32 v36, v36, v27, v28
  v_max3_u32 v36, v36, v29, v30
  v_max3_u32 v36, v36, v31, v32
  v_max3_u32 v36, v36, v33, v34
  v_max_u32 v36, v36, v35
  v_cmp_eq_u32 vcc, -1, v36
  s_cbranch_vccz cA_va0_sl2
  s_add_u32 s30, s30, 1
  s_cmp_lt_u32 s30, 400000
  s_cbranch_scc1 cA_va0_sl1
  s_branch cA_abort
cA_va0_sl2:
  v_mov_b32 v36, 0
  v_mov_b32 v37, 0
  v_mov_b32 v38, 0
  v_mov_b32 v39, 0
  v_mov_b32 v40, 0
  v_mov_b32 v41, 0
  v_mov_b32 v42, 0
  v_mov_b32 v43, 0
  v_mov_b32 v44, 0
  v_mov_b32 v45, 0
  v_mov_b32 v46, 0
  v_mov_b32 v47, 0
  v_mov_b32 v48, 0
  v_mov_b32 v49, 0
  v_mov_b32 v50, 0
  v_mov_b32 v51, 0
  v_mov_b32 v52, 0
  v_mov_b32 v53, 0
  v_mov_b32 v54, 0
  v_mov_b32 v55, 0
  v_mov_b32 v56, 0
  v_mov_b32 v57, 0
  v_mov_b32 v58, 0
  v_mov_b32 v59, 0
  v_mov_b32 v60, 0
  v_mov_b32 v61, 0
  v_mov_b32 v62, 0
  v_mov_b32 v63, 0
  buffer_store_dword v162, v1, s[8:11], s21 offen
  v_smfmac_f32_16x16x64_bf16 v[36:39], v[8:11], a[0:7], v3
  v_smfmac_f32_16x16x64_bf16 v[40:43], v[8:11], a[56:63], v3
  v_smfmac_f32_16x16x64_bf16 v[44:47], v[8:11], a[112:119], v3
  v_smfmac_f32_16x16x64_bf16 v[48:51], v[8:11], a[168:175], v3
  v_smfmac_f32_16x16x64_bf16 v[52:55], v[8:11], a[224:231], v3
  v_smfmac_f32_16x16x64_bf16 v[56:59], v[8:11], v[200:207], v3
  v_smfmac_f32_16x16x64_bf16 v[36:39], v[12:15], a[8:15], v3
  v_smfmac_f32_16x16x64_bf16 v[40:43], v[12:15], a[64:71], v3
  v_smfmac_f32_16x16x64_bf16 v[44:47], v[12:15], a[120:127], v3
  v_smfmac_f32_16x16x64_bf16 v[48:51], v[12:15], a[176:183], v3
  v_smfmac_f32_16x16x64_bf16 v[52:55], v[12:15], a[232:239], v3
  v_smfmac_f32_16x16x64_bf16 v[56:59], v[12:15], v[208:215], v3
  v_smfmac_f32_16x16x64_bf16 v[36:39], v[16:19], a[16:23], v3
  v_smfmac_f32_16x16x64_bf16 v[40:43], v[16:19], a[72:79], v3
  v_smfmac_f32_16x16x64_bf16 v[44:47], v[16:19], a[128:135], v3
  v_smfmac_f32_16x16x64_bf16 v[48:51], v[16:19], a[184:191], v3
  v_smfmac_f32_16x16x64_bf16 v[52:55], v[16:19], a[240:247], v3
  v_smfmac_f32_16x16x64_bf16 v[56:59], v[16:19], v[216:223], v3
  v_smfmac_f32_16x16x64_bf16 v[36:39], v[20:23], a[24:31], v3
  v_smfmac_f32_16x16x64_bf16 v[40:43], v[20:23], a[80:87], v3
  v_smfmac_f32_16x16x64_bf16 v[44:47], v[20:23], a[136:143], v3
  v_smfmac_f32_16x16x64_bf16 v[48:51], v[20:23], a[192:199], v3
  v_smfmac_f32_16x16x64_bf16 v[52:55], v[20:23], a[248:255], v3
  v_smfmac_f32_16x16x64_bf16 v[56:59], v[20:23], v[224:231], v3
  v_smfmac_f32_16x16x64_bf16 v[36:39], v[24:27], a[32:39], v3
  v_smfmac_f32_16x16x64_bf16 v[40:43], v[24:27], a[88:95], v3
  v_smfmac_f32_16x16x64_bf16 v[44:47], v[24:27], a[144:151], v3
  v_smfmac_f32_16x16x64_bf16 v[48:51], v[24:27], a[200:207], v3
  v_smfmac_f32_16x16x64_bf16 v[52:55], v[24:27], v[176:183], v3
  v_smfmac_f32_16x16x64_bf16 v[56:59], v[24:27], v[232:239], v3
  v_smfmac_f32_16x16x64_bf16 v[36:39], v[28:31], a[40:47], v3
  v_smfmac_f32_16x16x64_bf16 v[40:43], v[28:31], a[96:103], v3
  v_smfmac_f32_16x16x64_bf16 v[44:47], v[28:31], a[152:159], v3
  v_smfmac_f32_16x16x64_bf16 v[48:51], v[28:31], a[208:215], v3
  v_smfmac_f32_16x16x64_bf16 v[52:55], v[28:31], v[184:191], v3
  v_smfmac_f32_16x16x64_bf16 v[56:59], v[28:31], v[240:247], v3
  v_smfmac_f32_16x16x64_bf16 v[36:39], v[32:35], a[48:55], v3
  v_smfmac_f32_16x16x64_bf16 v[40:43], v[32:35], a[104:111], v3
  v_smfmac_f32_16x16x64_bf16 v[44:47], v[32:35], a[160:167], v3
  v_smfmac_f32_16x16x64_bf16 v[48:51], v[32:35], a[216:223], v3
  v_smfmac_f32_16x16x64_bf16 v[52:55], v[32:35], v[192:199], v3
  v_smfmac_f32_16x16x64_bf16 v[56:59], v[32:35], v[248:255], v3
  v_permlane32_swap_b32 v36, v38
  v_permlane32_swap_b32 v37, v39
  v_add_f32 v36, v36, v38
  v_add_f32 v37, v37, v39
  v_cvt_pk_bf16_f32 v38, v36, v37
  ds_write_b32 v152, v38
  v_permlane32_swap_b32 v40, v42
  v_permlane32_swap_b32 v41, v43
  v_add_f32 v40, v40, v42
  v_add_f32 v41, v41, v43
  v_cvt_pk_bf16_f32 v42, v40, v41
  ds_write_b32 v153, v42
  v_permlane32_swap_b32 v44, v46
  v_permlane32_swap_b32 v45, v47
  v_add_f32 v44, v44, v46
  v_add_f32 v45, v45, v47
  v_cvt_pk_bf16_f32 v46, v44, v45
  ds_write_b32 v154, v46
  v_permlane32_swap_b32 v48, v50
  v_permlane32_swap_b32 v49, v51
  v_add_f32 v48, v48, v50
  v_add_f32 v49, v49, v51
  v_cvt_pk_bf16_f32 v50, v48, v49
  ds_write_b32 v155, v50
  v_permlane32_swap_b32 v52, v54
  v_permlane32_swap_b32 v53, v55
  v_add_f32 v52, v52, v54
  v_add_f32 v53, v53, v55
  v_cvt_pk_bf16_f32 v54, v52, v53
  ds_write_b32 v156, v54
  v_permlane32_swap_b32 v56, v58
  v_permlane32_swap_b32 v57, v59
  v_add_f32 v56, v56, v58
  v_add_f32 v57, v57, v59
  v_cvt_pk_bf16_f32 v58, v56, v57
  ds_write_b32 v157, v58
  buffer_load_dword v164, v4, s[8:11], 0 offen sc1
  buffer_load_dword v164, v4, s[8:11], 0 offen sc1
  buffer_load_dword v164, v4, s[8:11], 0 offen sc1
  buffer_load_dword v164, v4, s[8:11], 0 offen sc1
  buffer_load_dword v164, v4, s[8:11], 0 offen sc1
  s_branch cA_va0_t2d
cA_va0_last:
  s_barrier
  ds_read_b128 v[64:67], v2 offset:0
  ds_read_b128 v[68:71], v2 offset:1024
  ds_read_b128 v[72:75], v2 offset:2048
  ds_read_b128 v[76:79], v2 offset:3072
  s_waitcnt lgkmcnt(0)
  v_min_u32 v64, -2, v64
  v_min_u32 v65, -2, v65
  v_min_u32 v66, -2, v66
  v_min_u32 v67, -2, v67
  v_min_u32 v68, -2, v68
  v_min_u32 v69, -2, v69
  v_min_u32 v70, -2, v70
  v_min_u32 v71, -2, v71
  v_min_u32 v72, -2, v72
  v_min_u32 v73, -2, v73
  v_min_u32 v74, -2, v74
  v_min_u32 v75, -2, v75
  v_min_u32 v76, -2, v76
  v_min_u32 v77, -2, v77
  v_min_u32 v78, -2, v78
  v_min_u32 v79, -2, v79
  buffer_store_dwordx4 v[64:67], v2, s[8:11], s33 offen offset:0 sc1
  buffer_store_dwordx4 v[68:71], v2, s[8:11], s33 offen offset:2048 sc1
  s_add_u32 s33, s33, 4096
  buffer_store_dwordx4 v[72:75], v2, s[8:11], s33 offen offset:0 sc1
  buffer_store_dwordx4 v[76:79], v2, s[8:11], s33 offen offset:2048 sc1
  s_add_u32 s33, s33, 4096
  s_waitcnt vmcnt(0)
  buffer_wbl2 sc1
  s_branch cA_done
cA_va0_rp:
  s_cmp_eq_u32 s37, 0
  s_cbranch_scc1 cA_va0_rv
  v_min_u32 v160, -2, v160
  buffer_store_dword v160, v1, s[8:11], s21 offen
  s_branch cA_va0_cont
cA_va0_rv:
  s_add_u32 s31, s31, 0x10000
  buffer_load_dwordx4 v[8:11], v2, s[8:11], s22 offen offset:0 sc1
  buffer_load_dwordx4 v[12:15], v2, s[8:11], s22 offen offset:1024 sc1
  buffer_load_dwordx4 v[16:19], v2, s[8:11], s22 offen offset:2048 sc1
  buffer_load_dwordx4 v[20:23], v2, s[8:11], s22 offen offset:3072 sc1
  buffer_load_dwordx4 v[24:27], v2, s[8:11], s34 offen offset:0 sc1
  buffer_load_dwordx4 v[28:31], v2, s[8:11], s34 offen offset:1024 sc1
  buffer_load_dwordx4 v[32:35], v2, s[8:11], s34 offen offset:2048 sc1
  buffer_load_dwordx4 v[36:39], v2, s[8:11], s34 offen offset:3072 sc1
  buffer_load_dwordx4 v[40:43], v2, s[8:11], s36 offen offset:0 sc1
  buffer_load_dwordx4 v[44:47], v2, s[8:11], s36 offen offset:1024 sc1
  s_waitcnt vmcnt(0)
  v_max3_u32 v52, v8, v9, v10
  v_max3_u32 v52, v52, v11, v12
  v_max3_u32 v52, v52, v13, v14
  v_max3_u32 v52, v52, v15, v16
  v_max3_u32 v52, v52, v17, v18
  v_max3_u32 v52, v52, v19, v20
  v_max3_u32 v52, v52, v21, v22
  v_max3_u32 v52, v52, v23, v24
  v_max3_u32 v52, v52, v25, v26
  v_max3_u32 v52, v52, v27, v28
  v_max3_u32 v52, v52, v29, v30
  v_max3_u32 v52, v52, v31, v32
  v_max3_u32 v52, v52, v33, v34
  v_max3_u32 v52, v52, v35, v36
  v_max3_u32 v52, v52, v37, v38
  v_max3_u32 v52, v52, v39, v40
  v_max3_u32 v52, v52, v41, v42
  v_max3_u32 v52, v52, v43, v44
  v_max3_u32 v52, v52, v45, v46
  v_max_u32 v52, v52, v47
  v_cmp_eq_u32 vcc, -1, v52
  s_mov_b32 s37, 1
  v_mov_b32 v48, 0
  v_mov_b32 v49, 0
  v_mov_b32 v50, 0
  v_mov_b32 v51, 0
  s_nop 1
  s_cbranch_vccz cA_va0_lp
  s_add_u32 s30, s30, 1
  s_cmp_lt_u32 s30, 400000
  s_cbranch_scc1 cA_va0_rv
  s_branch cA_abort
.p2align 6
cA_va1_loop:
  s_mov_b32 s30, 0
  s_barrier
  buffer_load_dwordx4 v[28:31], v2, s[8:11], s23 offen offset:1024 sc1
  buffer_load_dwordx4 v[32:35], v2, s[8:11], s23 offen offset:2048 sc1
  s_barrier
  s_cmp_lt_u32 s19, 60
  s_cbranch_scc1 cA_va1_m1
  buffer_store_dword v160, v1, s[8:11], s38 offen sc1
  s_cmp_lg_u32 s19, 63
  s_cbranch_scc1 cA_va1_m2
  v_min_u32 v64, -2, v64
  v_min_u32 v65, -2, v65
  v_min_u32 v66, -2, v66
  v_min_u32 v67, -2, v67
  v_min_u32 v68, -2, v68
  v_min_u32 v69, -2, v69
  v_min_u32 v70, -2, v70
  v_min_u32 v71, -2, v71
  v_min_u32 v72, -2, v72
  v_min_u32 v73, -2, v73
  v_min_u32 v74, -2, v74
  v_min_u32 v75, -2, v75
  v_min_u32 v76, -2, v76
  v_min_u32 v77, -2, v77
  v_min_u32 v78, -2, v78
  v_min_u32 v79, -2, v79
  buffer_store_dwordx4 v[64:67], v2, s[8:11], s33 offen offset:0 sc1
  buffer_store_dwordx4 v[68:71], v2, s[8:11], s33 offen offset:2048 sc1
  s_add_u32 s33, s33, 4096
  buffer_store_dwordx4 v[72:75], v2, s[8:11], s33 offen offset:0 sc1
  buffer_store_dwordx4 v[76:79], v2, s[8:11], s33 offen offset:2048 sc1
  s_add_u32 s33, s33, 4096
  s_waitcnt vmcnt(5)
  s_branch cA_va1_m3
cA_va1_m1:
  buffer_store_dword v160, v1, s[8:11], s38 offen nt
cA_va1_m2:
  s_add_u32 s22, s25, 0
  buffer_load_dwordx4 v[80:83], v6, s[8:11], s22 offen offset:0 sc1
  buffer_load_dwordx4 v[84:87], v6, s[8:11], s22 offen offset:1792 sc1
  s_add_u32 s22, s25, 3584
  buffer_load_dwordx4 v[88:91], v6, s[8:11], s22 offen offset:0 sc1
  buffer_load_dwordx4 v[92:95], v6, s[8:11], s22 offen offset:1792 sc1
  s_add_u32 s22, s25, 7168
  buffer_load_dwordx4 v[96:99], v6, s[8:11], s22 offen offset:0 sc1
  s_mul_i32 s38, s18, 7168
  s_add_u32 s38, s38, 65536
  s_waitcnt vmcnt(6)
cA_va1_m3:
  ds_write_b128 v2, v[32:35] offset:14336
  v_smfmac_f32_16x16x64_bf16 v[36:39], v[28:31], a[40:47], v3
  buffer_load_dwordx4 v[100:103], v6, s[8:11], s22 offen offset:1792 sc1
  v_smfmac_f32_16x16x64_bf16 v[40:43], v[28:31], a[96:103], v3
  s_add_u32 s22, s25, 10752
  buffer_load_dwordx4 v[104:107], v6, s[8:11], s22 offen offset:0 sc1
  v_smfmac_f32_16x16x64_bf16 v[44:47], v[28:31], a[152:159], v3
  buffer_load_dwordx4 v[108:111], v6, s[8:11], s22 offen offset:1792 sc1
  v_smfmac_f32_16x16x64_bf16 v[48:51], v[28:31], a[208:215], v3
  s_add_u32 s22, s25, 14336
  buffer_load_dwordx4 v[112:115], v6, s[8:11], s22 offen offset:0 sc1
  v_smfmac_f32_16x16x64_bf16 v[52:55], v[28:31], v[184:191], v3
  s_waitcnt lgkmcnt(0)
  s_barrier
  ds_read_b128 v[8:11], v2 offset:8192
  ds_read_b128 v[12:15], v2 offset:9216
  ds_read_b128 v[16:19], v2 offset:10240
  ds_read_b128 v[20:23], v2 offset:11264
  ds_read_b128 v[24:27], v2 offset:12288
  buffer_load_dwordx4 v[116:119], v6, s[8:11], s22 offen offset:1792 sc1
  v_smfmac_f32_16x16x64_bf16 v[56:59], v[28:31], v[240:247], v3
  s_add_u32 s22, s25, 17920
  buffer_load_dwordx4 v[120:123], v6, s[8:11], s22 offen offset:0 sc1
  v_smfmac_f32_16x16x64_bf16 v[36:39], v[32:35], a[48:55], v3
  buffer_load_dwordx4 v[124:127], v6, s[8:11], s22 offen offset:1792 sc1
  v_smfmac_f32_16x16x64_bf16 v[40:43], v[32:35], a[104:111], v3
  s_add_u32 s22, s25, 21504
  buffer_load_dwordx4 v[128:131], v6, s[8:11], s22 offen offset:0 sc1
  v_smfmac_f32_16x16x64_bf16 v[44:47], v[32:35], a[160:167], v3
  buffer_load_dwordx4 v[132:135], v6, s[8:11], s22 offen offset:1792 sc1
  v_smfmac_f32_16x16x64_bf16 v[48:51], v[32:35], a[216:223], v3
  s_add_u32 s22, s25, 25088
  buffer_load_dwordx4 v[136:139], v6, s[8:11], s22 offen offset:0 sc1
  v_smfmac_f32_16x16x64_bf16 v[52:55], v[32:35], v[192:199], v3
  ds_read_b128 v[64:67], v0 offset:0
  ds_read_b128 v[68:71], v0 offset:1024
  buffer_load_dwordx4 v[140:143], v6, s[8:11], s22 offen offset:1792 sc1
  v_smfmac_f32_16x16x64_bf16 v[56:59], v[32:35], v[248:255], v3
  s_waitcnt lgkmcnt(6)
  ds_read_b128 v[72:75], v0 offset:2048
  ds_read_b128 v[76:79], v0 offset:3072
  v_smfmac_f32_16x16x64_bf16 v[36:39], v[8:11], a[0:7], v3
  s_waitcnt lgkmcnt(7)
  v_smfmac_f32_16x16x64_bf16 v[36:39], v[12:15], a[8:15], v3
  s_waitcnt lgkmcnt(6)
  v_smfmac_f32_16x16x64_bf16 v[36:39], v[16:19], a[16:23], v3
  s_waitcnt lgkmcnt(2)
  v_smfmac_f32_16x16x64_bf16 v[60:63], v[8:11], v[64:71], v3
  s_waitcnt lgkmcnt(5)
  ds_read_b128 v[144:147], v0 offset:4096
  ds_read_b128 v[148:151], v0 offset:5120
  v_smfmac_f32_16x16x64_bf16 v[36:39], v[20:23], a[24:31], v3
  s_waitcnt lgkmcnt(6)
  v_smfmac_f32_16x16x64_bf16 v[36:39], v[24:27], a[32:39], v3
  v_smfmac_f32_16x16x64_bf16 v[40:43], v[8:11], a[56:63], v3
  s_waitcnt lgkmcnt(2)
  v_smfmac_f32_16x16x64_bf16 v[60:63], v[12:15], v[72:79], v3
  ds_read_b128 v[64:67], v0 offset:6144
  ds_read_b128 v[68:71], v0 offset:7168
  v_smfmac_f32_16x16x64_bf16 v[40:43], v[12:15], a[64:71], v3
  v_permlane32_swap_b32 v36, v38
  v_smfmac_f32_16x16x64_bf16 v[40:43], v[16:19], a[72:79], v3
  v_permlane32_swap_b32 v37, v39
  v_smfmac_f32_16x16x64_bf16 v[40:43], v[20:23], a[80:87], v3
  s_waitcnt lgkmcnt(2)
  v_add_f32 v36, v36, v38
  v_smfmac_f32_16x16x64_bf16 v[60:63], v[16:19], v[144:151], v3
  ds_read_b128 v[72:75], v0 offset:8192
  ds_read_b128 v[76:79], v0 offset:9216
  v_add_f32 v37, v37, v39
  v_smfmac_f32_16x16x64_bf16 v[40:43], v[24:27], a[88:95], v3
  v_cmp_u_f32 vcc, v36, v37
  v_smfmac_f32_16x16x64_bf16 v[44:47], v[8:11], a[112:119], v3
  v_cvt_pk_bf16_f32 v38, v36, v37
  v_smfmac_f32_16x16x64_bf16 v[44:47], v[12:15], a[120:127], v3
  ds_write_b32 v152, v38
  s_waitcnt lgkmcnt(3)
  s_cbranch_vccnz cA_va1_slow
  v_permlane32_swap_b32 v40, v42
  v_smfmac_f32_16x16x64_bf16 v[60:63], v[20:23], v[64:71], v3
  ds_read_b128 v[144:147], v0 offset:10240
  ds_read_b128 v[148:151], v0 offset:11264
  v_permlane32_swap_b32 v41, v43
  v_smfmac_f32_16x16x64_bf16 v[44:47], v[16:19], a[128:135], v3
  buffer_store_dword v162, v1, s[8:11], s21 offen
  v_add_f32 v40, v40, v42
  v_smfmac_f32_16x16x64_bf16 v[44:47], v[20:23], a[136:143], v3
  v_add_f32 v41, v41, v43
  v_smfmac_f32_16x16x64_bf16 v[44:47], v[24:27], a[144:151], v3
  s_waitcnt lgkmcnt(3)
  v_cvt_pk_bf16_f32 v42, v40, v41
  v_smfmac_f32_16x16x64_bf16 v[60:63], v[24:27], v[72:79], v3
  ds_write_b32 v153, v42
  ds_read_b128 v[64:67], v0 offset:12288
  ds_read_b128 v[68:71], v0 offset:13312
  v_smfmac_f32_16x16x64_bf16 v[48:51], v[8:11], a[168:175], v3
  s_nop 0
  v_permlane32_swap_b32 v44, v46
  v_smfmac_f32_16x16x64_bf16 v[48:51], v[12:15], a[176:183], v3
  v_permlane32_swap_b32 v45, v47
  v_smfmac_f32_16x16x64_bf16 v[48:51], v[16:19], a[184:191], v3
  s_waitcnt lgkmcnt(3)
  v_add_f32 v44, v44, v46
  v_smfmac_f32_16x16x64_bf16 v[60:63], v[28:31], v[144:151], v3
  v_add_f32 v45, v45, v47
  v_smfmac_f32_16x16x64_bf16 v[48:51], v[20:23], a[192:199], v3
  v_cvt_pk_bf16_f32 v46, v44, v45
  v_smfmac_f32_16x16x64_bf16 v[48:51], v[24:27], a[200:207], v3
  ds_write_b32 v154, v46
  v_smfmac_f32_16x16x64_bf16 v[52:55], v[8:11], a[224:231], v3
  s_waitcnt lgkmcnt(1)
  v_smfmac_f32_16x16x64_bf16 v[60:63], v[32:35], v[64:71], v3
  v_smfmac_f32_16x16x64_bf16 v[52:55], v[12:15], a[232:239], v3
  v_permlane32_swap_b32 v48, v50
  v_smfmac_f32_16x16x64_bf16 v[52:55], v[16:19], a[240:247], v3
  v_permlane32_swap_b32 v49, v51
  v_smfmac_f32_16x16x64_bf16 v[52:55], v[20:23], a[248:255], v3
  v_add_f32 v48, v48, v50
  v_smfmac_f32_16x16x64_bf16 v[52:55], v[24:27], v[176:183], v3
  v_add_f32 v49, v49, v51
  v_smfmac_f32_16x16x64_bf16 v[56:59], v[8:11], v[200:207], v3
  v_cvt_pk_bf16_f32 v50, v48, v49
  v_smfmac_f32_16x16x64_bf16 v[56:59], v[12:15], v[208:215], v3
  ds_write_b32 v155, v50
  v_permlane32_swap_b32 v60, v62
  v_smfmac_f32_16x16x64_bf16 v[56:59], v[16:19], v[216:223], v3
  v_permlane32_swap_b32 v61, v63
  v_smfmac_f32_16x16x64_bf16 v[56:59], v[20:23], v[224:231], v3
  v_add_f32 v60, v60, v62
  v_smfmac_f32_16x16x64_bf16 v[56:59], v[24:27], v[232:239], v3
  v_add_f32 v61, v61, v63
  v_cvt_pk_bf16_f32 v62, v60, v61
  ds_write_b32 v158, v62
  v_permlane32_swap_b32 v52, v54
  v_permlane32_swap_b32 v53, v55
  v_add_f32 v52, v52, v54
  v_add_f32 v53, v53, v55
  v_cvt_pk_bf16_f32 v54, v52, v53
  ds_write_b32 v156, v54
  v_permlane32_swap_b32 v56, v58
  v_permlane32_swap_b32 v57, v59
  v_add_f32 v56, v56, v58
  v_add_f32 v57, v57, v59
  v_cvt_pk_bf16_f32 v58, v56, v57
  ds_write_b32 v157, v58
cA_va1_t2d:
  s_add_u32 s22, s20, 9216
  s_add_u32 s34, s20, 13312
  s_add_u32 s36, s20, 7168
  s_mov_b32 s37, 0
  v_mov_b32 v48, 0
  v_mov_b32 v49, 0
  v_mov_b32 v50, 0
  v_mov_b32 v51, 0
  v_mov_b32 v163, s18
  s_cmp_eq_u32 s19, 63
  s_waitcnt lgkmcnt(0)
  s_cbranch_scc1 cA_va1_last
  s_barrier
  buffer_load_dwordx4 v[8:11], v2, s[8:11], s22 offen offset:0 sc1
  buffer_load_dwordx4 v[12:15], v2, s[8:11], s22 offen offset:1024 sc1
  buffer_load_dwordx4 v[16:19], v2, s[8:11], s22 offen offset:2048 sc1
  buffer_load_dwordx4 v[20:23], v2, s[8:11], s22 offen offset:3072 sc1
  buffer_load_dwordx4 v[24:27], v2, s[8:11], s34 offen offset:0 sc1
  buffer_load_dwordx4 v[28:31], v2, s[8:11], s34 offen offset:1024 sc1
  buffer_load_dwordx4 v[32:35], v2, s[8:11], s34 offen offset:2048 sc1
  buffer_load_dwordx4 v[36:39], v2, s[8:11], s34 offen offset:3072 sc1
  buffer_load_dwordx4 v[40:43], v2, s[8:11], s36 offen offset:0 sc1
  buffer_load_dwordx4 v[44:47], v2, s[8:11], s36 offen offset:1024 sc1
  ds_read_b128 v[64:67], v2 offset:4096
  ds_read_b128 v[68:71], v2 offset:5120
  ds_read_b128 v[72:75], v2 offset:6144
  ds_read_b128 v[76:79], v2 offset:7168
cA_va1_lp:
  s_waitcnt vmcnt(9)
  v_smfmac_f32_16x16x64_bf16 v[48:51], v[8:11], v[80:87], v3
  s_waitcnt vmcnt(8)
  v_smfmac_f32_16x16x64_bf16 v[48:51], v[12:15], v[88:95], v3
  s_waitcnt vmcnt(7)
  v_smfmac_f32_16x16x64_bf16 v[48:51], v[16:19], v[96:103], v3
  v_max3_u32 v55, v8, v12, v16
  s_waitcnt vmcnt(6)
  v_smfmac_f32_16x16x64_bf16 v[48:51], v[20:23], v[104:111], v3
  v_max_u32 v55, v55, v20
  v_cmp_eq_u32 vcc, -1, v55
  s_waitcnt vmcnt(5)
  v_smfmac_f32_16x16x64_bf16 v[48:51], v[24:27], v[112:119], v3
  s_waitcnt vmcnt(4)
  v_smfmac_f32_16x16x64_bf16 v[48:51], v[28:31], v[120:127], v3
  s_cbranch_vccnz cA_va1_rv
  buffer_store_dword v163, v7, s[8:11], 0 offen
  s_waitcnt vmcnt(4)
  v_smfmac_f32_16x16x64_bf16 v[48:51], v[32:35], v[128:135], v3
  s_waitcnt vmcnt(3)
  v_smfmac_f32_16x16x64_bf16 v[48:51], v[36:39], v[136:143], v3
  s_waitcnt vmcnt(2) lgkmcnt(0)
  v_smfmac_f32_16x16x64_bf16 v[48:51], v[40:43], v[64:71], v3
  s_waitcnt vmcnt(1)
  v_smfmac_f32_16x16x64_bf16 v[48:51], v[44:47], v[72:79], v3
  s_nop 7
  v_permlane32_swap_b32 v48, v50
  v_permlane32_swap_b32 v49, v51
  v_pk_add_f32 v[48:49], v[48:49], v[50:51]
  v_cvt_pk_bf16_f32 v160, v48, v49
  v_cmp_u_f32 vcc, v48, v49
  s_nop 0
  v_mov_b32_dpp v161, v160 quad_perm:[1,0,3,2] row_mask:0xf bank_mask:0xf
  v_perm_b32 v160, v161, v160, v5
  v_cndmask_b32 v161, v160, v162, vcc
  buffer_store_dword v161, v1, s[8:11], s21 offen
  s_cbranch_vccnz cA_va1_rp
cA_va1_cont:
  s_cmp_lg_u32 s19, 62
  s_cbranch_scc1 cA_va1_nl
  buffer_store_dword v160, v1, s[8:11], s38 offen sc1
  s_mov_b32 s38, 0x40000000
  s_mov_b32 s25, 0x40000000
cA_va1_nl:
  s_add_u32 s25, s25, 458752
  v_mov_b32 v36, 0
  v_mov_b32 v37, 0
  v_mov_b32 v38, 0
  v_mov_b32 v39, 0
  v_mov_b32 v40, 0
  v_mov_b32 v41, 0
  v_mov_b32 v42, 0
  v_mov_b32 v43, 0
  v_mov_b32 v44, 0
  v_mov_b32 v45, 0
  v_mov_b32 v46, 0
  v_mov_b32 v47, 0
  v_mov_b32 v48, 0
  v_mov_b32 v49, 0
  v_mov_b32 v50, 0
  v_mov_b32 v51, 0
  v_mov_b32 v52, 0
  v_mov_b32 v53, 0
  v_mov_b32 v54, 0
  v_mov_b32 v55, 0
  v_mov_b32 v56, 0
  v_mov_b32 v57, 0
  v_mov_b32 v58, 0
  v_mov_b32 v59, 0
  v_mov_b32 v60, 0
  v_mov_b32 v61, 0
  v_mov_b32 v62, 0
  v_mov_b32 v63, 0
  s_mov_b32 s19, s18
  s_add_u32 s18, s18, 1
  s_mov_b32 s22, s20
  s_mov_b32 s20, s21
  s_mov_b32 s21, s22
  s_add_u32 s23, s20, 4096
  s_branch cA_va1_loop
cA_va1_slow:
  s_waitcnt lgkmcnt(0)
cA_va1_sl1:
  s_add_u32 s31, s31, 0x1000000
  buffer_load_dwordx4 v[8:11], v2, s[8:11], s20 offen offset:0 sc1
  buffer_load_dwordx4 v[12:15], v2, s[8:11], s20 offen offset:1024 sc1
  buffer_load_dwordx4 v[16:19], v2, s[8:11], s20 offen offset:2048 sc1
  buffer_load_dwordx4 v[20:23], v2, s[8:11], s20 offen offset:3072 sc1
  buffer_load_dwordx4 v[24:27], v2, s[8:11], s23 offen offset:0 sc1
  buffer_load_dwordx4 v[28:31], v2, s[8:11], s23 offen offset:1024 sc1
  buffer_load_dwordx4 v[32:35], v2, s[8:11], s23 offen offset:2048 sc1
  s_waitcnt vmcnt(0)
  v_max3_u32 v36, v8, v9, v10
  v_max3_u32 v36, v36, v11, v12
  v_max3_u32 v36, v36, v13, v14
  v_max3_u32 v36, v36, v15, v16
  v_max3_u32 v36, v36, v17, v18
  v_max3_u32 v36, v36, v19, v20
  v_max3_u32 v36, v36, v21, v22
  v_max3_u32 v36, v36, v23, v24
  v_max3_u32 v36, v36, v25, v26
  v_max3_u32 v36, v36, v27, v28
  v_max3_u32 v36, v36, v29, v30
  v_max3_u32 v36, v36, v31, v32
  v_max3_u32 v36, v36, v33, v34
  v_max_u32 v36, v36, v35
  v_cmp_eq_u32 vcc, -1, v36
  s_cbranch_vccz cA_va1_sl2
  s_add_u32 s30, s30, 1
  s_cmp_lt_u32 s30, 400000
  s_cbranch_scc1 cA_va1_sl1
  s_branch cA_abort
cA_va1_sl2:
  v_mov_b32 v36, 0
  v_mov_b32 v37, 0
  v_mov_b32 v38, 0
  v_mov_b32 v39, 0
  v_mov_b32 v40, 0
  v_mov_b32 v41, 0
  v_mov_b32 v42, 0
  v_mov_b32 v43, 0
  v_mov_b32 v44, 0
  v_mov_b32 v45, 0
  v_mov_b32 v46, 0
  v_mov_b32 v47, 0
  v_mov_b32 v48, 0
  v_mov_b32 v49, 0
  v_mov_b32 v50, 0
  v_mov_b32 v51, 0
  v_mov_b32 v52, 0
  v_mov_b32 v53, 0
  v_mov_b32 v54, 0
  v_mov_b32 v55, 0
  v_mov_b32 v56, 0
  v_mov_b32 v57, 0
  v_mov_b32 v58, 0
  v_mov_b32 v59, 0
  v_mov_b32 v60, 0
  v_mov_b32 v61, 0
  v_mov_b32 v62, 0
  v_mov_b32 v63, 0
  buffer_store_dword v162, v1, s[8:11], s21 offen
  ds_read_b128 v[64:67], v0 offset:0
  ds_read_b128 v[68:71], v0 offset:1024
  v_smfmac_f32_16x16x64_bf16 v[36:39], v[8:11], a[0:7], v3
  v_smfmac_f32_16x16x64_bf16 v[40:43], v[8:11], a[56:63], v3
  v_smfmac_f32_16x16x64_bf16 v[44:47], v[8:11], a[112:119], v3
  v_smfmac_f32_16x16x64_bf16 v[48:51], v[8:11], a[168:175], v3
  v_smfmac_f32_16x16x64_bf16 v[52:55], v[8:11], a[224:231], v3
  v_smfmac_f32_16x16x64_bf16 v[56:59], v[8:11], v[200:207], v3
  s_waitcnt lgkmcnt(0)
  v_smfmac_f32_16x16x64_bf16 v[60:63], v[8:11], v[64:71], v3
  ds_read_b128 v[72:75], v0 offset:2048
  ds_read_b128 v[76:79], v0 offset:3072
  v_smfmac_f32_16x16x64_bf16 v[36:39], v[12:15], a[8:15], v3
  v_smfmac_f32_16x16x64_bf16 v[40:43], v[12:15], a[64:71], v3
  v_smfmac_f32_16x16x64_bf16 v[44:47], v[12:15], a[120:127], v3
  v_smfmac_f32_16x16x64_bf16 v[48:51], v[12:15], a[176:183], v3
  v_smfmac_f32_16x16x64_bf16 v[52:55], v[12:15], a[232:239], v3
  v_smfmac_f32_16x16x64_bf16 v[56:59], v[12:15], v[208:215], v3
  s_waitcnt lgkmcnt(0)
  v_smfmac_f32_16x16x64_bf16 v[60:63], v[12:15], v[72:79], v3
  ds_read_b128 v[144:147], v0 offset:4096
  ds_read_b128 v[148:151], v0 offset:5120
  v_smfmac_f32_16x16x64_bf16 v[36:39], v[16:19], a[16:23], v3
  v_smfmac_f32_16x16x64_bf16 v[40:43], v[16:19], a[72:79], v3
  v_smfmac_f32_16x16x64_bf16 v[44:47], v[16:19], a[128:135], v3
  v_smfmac_f32_16x16x64_bf16 v[48:51], v[16:19], a[184:191], v3
  v_smfmac_f32_16x16x64_bf16 v[52:55], v[16:19], a[240:247], v3
  v_smfmac_f32_16x16x64_bf16 v[56:59], v[16:19], v[216:223], v3
  s_waitcnt lgkmcnt(0)
  v_smfmac_f32_16x16x64_bf16 v[60:63], v[16:19], v[144:151], v3
  ds_read_b128 v[64:67], v0 offset:6144
  ds_read_b128 v[68:71], v0 offset:7168
  v_smfmac_f32_16x16x64_bf16 v[36:39], v[20:23], a[24:31], v3
  v_smfmac_f32_16x16x64_bf16 v[40:43], v[20:23], a[80:87], v3
  v_smfmac_f32_16x16x64_bf16 v[44:47], v[20:23], a[136:143], v3
  v_smfmac_f32_16x16x64_bf16 v[48:51], v[20:23], a[192:199], v3
  v_smfmac_f32_16x16x64_bf16 v[52:55], v[20:23], a[248:255], v3
  v_smfmac_f32_16x16x64_bf16 v[56:59], v[20:23], v[224:231], v3
  s_waitcnt lgkmcnt(0)
  v_smfmac_f32_16x16x64_bf16 v[60:63], v[20:23], v[64:71], v3
  ds_read_b128 v[72:75], v0 offset:8192
  ds_read_b128 v[76:79], v0 offset:9216
  v_smfmac_f32_16x16x64_bf16 v[36:39], v[24:27], a[32:39], v3
  v_smfmac_f32_16x16x64_bf16 v[40:43], v[24:27], a[88:95], v3
  v_smfmac_f32_16x16x64_bf16 v[44:47], v[24:27], a[144:151], v3
  v_smfmac_f32_16x16x64_bf16 v[48:51], v[24:27], a[200:207], v3
  v_smfmac_f32_16x16x64_bf16 v[52:55], v[24:27], v[176:183], v3
  v_smfmac_f32_16x16x64_bf16 v[56:59], v[24:27], v[232:239], v3
  s_waitcnt lgkmcnt(0)
  v_smfmac_f32_16x16x64_bf16 v[60:63], v[24:27], v[72:79], v3
  ds_read_b128 v[144:147], v0 offset:10240
  ds_read_b128 v[148:151], v0 offset:11264
  v_smfmac_f32_16x16x64_bf16 v[36:39], v[28:31], a[40:47], v3
  v_smfmac_f32_16x16x64_bf16 v[40:43], v[28:31], a[96:103], v3
  v_smfmac_f32_16x16x64_bf16 v[44:47], v[28:31], a[152:159], v3
  v_smfmac_f32_16x16x64_bf16 v[48:51], v[28:31], a[208:215], v3
  v_smfmac_f32_16x16x64_bf16 v[52:55], v[28:31], v[184:191], v3
  v_smfmac_f32_16x16x64_bf16 v[56:59], v[28:31], v[240:247], v3
  s_waitcnt lgkmcnt(0)
  v_smfmac_f32_16x16x64_bf16 v[60:63], v[28:31], v[144:151], v3
  ds_read_b128 v[64:67], v0 offset:12288
  ds_read_b128 v[68:71], v0 offset:13312
  v_smfmac_f32_16x16x64_bf16 v[36:39], v[32:35], a[48:55], v3
  v_smfmac_f32_16x16x64_bf16 v[40:43], v[32:35], a[104:111], v3
  v_smfmac_f32_16x16x64_bf16 v[44:47], v[32:35], a[160:167], v3
  v_smfmac_f32_16x16x64_bf16 v[48:51], v[32:35], a[216:223], v3
  v_smfmac_f32_16x16x64_bf16 v[52:55], v[32:35], v[192:199], v3
  v_smfmac_f32_16x16x64_bf16 v[56:59], v[32:35], v[248:255], v3
  s_waitcnt lgkmcnt(0)
  v_smfmac_f32_16x16x64_bf16 v[60:63], v[32:35], v[64:71], v3
  v_permlane32_swap_b32 v36, v38
  v_permlane32_swap_b32 v37, v39
  v_add_f32 v36, v36, v38
  v_add_f32 v37, v37, v39
  v_cvt_pk_bf16_f32 v38, v36, v37
  ds_write_b32 v152, v38
  v_permlane32_swap_b32 v40, v42
  v_permlane32_swap_b32 v41, v43
  v_add_f32 v40, v40, v42
  v_add_f32 v41, v41, v43
  v_cvt_pk_bf16_f32 v42, v40, v41
  ds_write_b32 v153, v42
  v_permlane32_swap_b32 v44, v46
  v_permlane32_swap_b32 v45, v47
  v_add_f32 v44, v44, v46
  v_add_f32 v45, v45, v47
  v_cvt_pk_bf16_f32 v46, v44, v45
  ds_write_b32 v154, v46
  v_permlane32_swap_b32 v48, v50
  v_permlane32_swap_b32 v49, v51
  v_add_f32 v48, v48, v50
  v_add_f32 v49, v49, v51
  v_cvt_pk_bf16_f32 v50, v48, v49
  ds_write_b32 v155, v50
  v_permlane32_swap_b32 v52, v54
  v_permlane32_swap_b32 v53, v55
  v_add_f32 v52, v52, v54
  v_add_f32 v53, v53, v55
  v_cvt_pk_bf16_f32 v54, v52, v53
  ds_write_b32 v156, v54
  v_permlane32_swap_b32 v56, v58
  v_permlane32_swap_b32 v57, v59
  v_add_f32 v56, v56, v58
  v_add_f32 v57, v57, v59
  v_cvt_pk_bf16_f32 v58, v56, v57
  ds_write_b32 v157, v58
  v_permlane32_swap_b32 v60, v62
  v_permlane32_swap_b32 v61, v63
  v_add_f32 v60, v60, v62
  v_add_f32 v61, v61, v63
  v_cvt_pk_bf16_f32 v62, v60, v61
  ds_write_b32 v158, v62
  s_branch cA_va1_t2d
cA_va1_last:
  s_barrier
  ds_read_b128 v[64:67], v2 offset:4096
  ds_read_b128 v[68:71], v2 offset:5120
  ds_read_b128 v[72:75], v2 offset:6144
  ds_read_b128 v[76:79], v2 offset:7168
  s_waitcnt lgkmcnt(0)
  v_min_u32 v64, -2, v64
  v_min_u32 v65, -2, v65
  v_min_u32 v66, -2, v66
  v_min_u32 v67, -2, v67
  v_min_u32 v68, -2, v68
  v_min_u32 v69, -2, v69
  v_min_u32 v70, -2, v70
  v_min_u32 v71, -2, v71
  v_min_u32 v72, -2, v72
  v_min_u32 v73, -2, v73
  v_min_u32 v74, -2, v74
  v_min_u32 v75, -2, v75
  v_min_u32 v76, -2, v76
  v_min_u32 v77, -2, v77
  v_min_u32 v78, -2, v78
  v_min_u32 v79, -2, v79
  buffer_store_dwordx4 v[64:67], v2, s[8:11], s33 offen offset:0 sc1
  buffer_store_dwordx4 v[68:71], v2, s[8:11], s33 offen offset:2048 sc1
  s_add_u32 s33, s33, 4096
  buffer_store_dwordx4 v[72:75], v2, s[8:11], s33 offen offset:0 sc1
  buffer_store_dwordx4 v[76:79], v2, s[8:11], s33 offen offset:2048 sc1
  s_add_u32 s33, s33, 4096
  s_waitcnt vmcnt(0)
  buffer_wbl2 sc1
  s_branch cA_done
cA_va1_rp:
  s_cmp_eq_u32 s37, 0
  s_cbranch_scc1 cA_va1_rv
  v_min_u32 v160, -2, v160
  buffer_store_dword v160, v1, s[8:11], s21 offen
  s_branch cA_va1_cont
cA_va1_rv:
  s_add_u32 s31, s31, 0x10000
  buffer_load_dwordx4 v[8:11], v2, s[8:11], s22 offen offset:0 sc1
  buffer_load_dwordx4 v[12:15], v2, s[8:11], s22 offen offset:1024 sc1
  buffer_load_dwordx4 v[16:19], v2, s[8:11], s22 offen offset:2048 sc1
  buffer_load_dwordx4 v[20:23], v2, s[8:11], s22 offen offset:3072 sc1
  buffer_load_dwordx4 v[24:27], v2, s[8:11], s34 offen offset:0 sc1
  buffer_load_dwordx4 v[28:31], v2, s[8:11], s34 offen offset:1024 sc1
  buffer_load_dwordx4 v[32:35], v2, s[8:11], s34 offen offset:2048 sc1
  buffer_load_dwordx4 v[36:39], v2, s[8:11], s34 offen offset:3072 sc1
  buffer_load_dwordx4 v[40:43], v2, s[8:11], s36 offen offset:0 sc1
  buffer_load_dwordx4 v[44:47], v2, s[8:11], s36 offen offset:1024 sc1
  s_waitcnt vmcnt(0)
  v_max3_u32 v52, v8, v9, v10
  v_max3_u32 v52, v52, v11, v12
  v_max3_u32 v52, v52, v13, v14
  v_max3_u32 v52, v52, v15, v16
  v_max3_u32 v52, v52, v17, v18
  v_max3_u32 v52, v52, v19, v20
  v_max3_u32 v52, v52, v21, v22
  v_max3_u32 v52, v52, v23, v24
  v_max3_u32 v52, v52, v25, v26
  v_max3_u32 v52, v52, v27, v28
  v_max3_u32 v52, v52, v29, v30
  v_max3_u32 v52, v52, v31, v32
  v_max3_u32 v52, v52, v33, v34
  v_max3_u32 v52, v52, v35, v36
  v_max3_u32 v52, v52, v37, v38
  v_max3_u32 v52, v52, v39, v40
  v_max3_u32 v52, v52, v41, v42
  v_max3_u32 v52, v52, v43, v44
  v_max3_u32 v52, v52, v45, v46
  v_max_u32 v52, v52, v47
  v_cmp_eq_u32 vcc, -1, v52
  s_mov_b32 s37, 1
  v_mov_b32 v48, 0
  v_mov_b32 v49, 0
  v_mov_b32 v50, 0
  v_mov_b32 v51, 0
  s_nop 1
  s_cbranch_vccz cA_va1_lp
  s_add_u32 s30, s30, 1
  s_cmp_lt_u32 s30, 400000
  s_cbranch_scc1 cA_va1_rv
  s_branch cA_abort
.p2align 6
cA_va2_loop:
  s_mov_b32 s30, 0
cA_va2_fp_l:
  v_cmp_gt_u32 vcc, s19, v96
  buffer_load_dword v96, v119, s[8:11], 0 offen sc1
  s_cbranch_vccz cA_va2_fp_d
  v_cmp_gt_u32 vcc, s19, v96
  buffer_load_dword v96, v119, s[8:11], 0 offen sc1
  s_cbranch_vccz cA_va2_fp_d
  v_cmp_gt_u32 vcc, s19, v96
  buffer_load_dword v96, v119, s[8:11], 0 offen sc1
  s_cbranch_vccz cA_va2_fp_d
  v_cmp_gt_u32 vcc, s19, v96
  buffer_load_dword v96, v119, s[8:11], 0 offen sc1
  s_cbranch_vccz cA_va2_fp_d
  v_cmp_gt_u32 vcc, s19, v96
  buffer_load_dword v96, v119, s[8:11], 0 offen sc1
  s_cbranch_vccz cA_va2_fp_d
  v_cmp_gt_u32 vcc, s19, v96
  buffer_load_dword v96, v119, s[8:11], 0 offen sc1
  s_cbranch_vccz cA_va2_fp_d
  v_cmp_gt_u32 vcc, s19, v96
  buffer_load_dword v96, v119, s[8:11], 0 offen sc1
  s_cbranch_vccz cA_va2_fp_d
  v_cmp_gt_u32 vcc, s19, v96
  buffer_load_dword v96, v119, s[8:11], 0 offen sc1
  s_cbranch_vccz cA_va2_fp_d
  v_cmp_gt_u32 vcc, s19, v96
  buffer_load_dword v96, v119, s[8:11], 0 offen sc1
  s_cbranch_vccz cA_va2_fp_d
  v_cmp_gt_u32 vcc, s19, v96
  buffer_load_dword v96, v119, s[8:11], 0 offen sc1
  s_cbranch_vccz cA_va2_fp_d
  v_cmp_gt_u32 vcc, s19, v96
  buffer_load_dword v96, v119, s[8:11], 0 offen sc1
  s_cbranch_vccz cA_va2_fp_d
  v_cmp_gt_u32 vcc, s19, v96
  buffer_load_dword v96, v119, s[8:11], 0 offen sc1
  s_cbranch_vccz cA_va2_fp_d
  v_cmp_gt_u32 vcc, s19, v96
  buffer_load_dword v96, v119, s[8:11], 0 offen sc1
  s_cbranch_vccz cA_va2_fp_d
  v_cmp_gt_u32 vcc, s19, v96
  buffer_load_dword v96, v119, s[8:11], 0 offen sc1
  s_cbranch_vccz cA_va2_fp_d
  v_cmp_gt_u32 vcc, s19, v96
  buffer_load_dword v96, v119, s[8:11], 0 offen sc1
  s_cbranch_vccz cA_va2_fp_d
  v_cmp_gt_u32 vcc, s19, v96
  buffer_load_dword v96, v119, s[8:11], 0 offen sc1
  s_cbranch_vccz cA_va2_fp_d
  s_waitcnt vmcnt(24)
  s_add_u32 s30, s30, 1
  s_cmp_lt_u32 s30, 400000
  s_cbranch_scc1 cA_va2_fp_l
  s_branch cA_abort
cA_va2_fp_d:
  buffer_load_dwordx4 v[8:11], v2, s[8:11], s20 offen offset:0 sc1
  buffer_load_dwordx4 v[12:15], v2, s[8:11], s20 offen offset:1024 sc1
  s_barrier
  s_barrier
  s_waitcnt vmcnt(0)
  ds_write_b128 v2, v[8:11] offset:8192
  ds_write_b128 v2, v[12:15] offset:9216
  v_smfmac_f32_16x16x64_bf16 v[36:39], v[8:11], a[0:7], v3
  v_smfmac_f32_16x16x64_bf16 v[40:43], v[8:11], a[56:63], v3
  v_smfmac_f32_16x16x64_bf16 v[44:47], v[8:11], a[112:119], v3
  v_smfmac_f32_16x16x64_bf16 v[48:51], v[8:11], a[168:175], v3
  v_smfmac_f32_16x16x64_bf16 v[52:55], v[8:11], a[224:231], v3
  s_waitcnt lgkmcnt(0)
  s_barrier
  ds_read_b128 v[16:19], v2 offset:10240
  ds_read_b128 v[20:23], v2 offset:11264
  ds_read_b128 v[24:27], v2 offset:12288
  ds_read_b128 v[28:31], v2 offset:13312
  ds_read_b128 v[32:35], v2 offset:14336
  v_smfmac_f32_16x16x64_bf16 v[56:59], v[8:11], v[144:151], v3
  v_smfmac_f32_16x16x64_bf16 v[60:63], v[8:11], v[200:207], v3
  v_smfmac_f32_16x16x64_bf16 v[36:39], v[12:15], a[8:15], v3
  v_smfmac_f32_16x16x64_bf16 v[40:43], v[12:15], a[64:71], v3
  v_smfmac_f32_16x16x64_bf16 v[44:47], v[12:15], a[120:127], v3
  v_smfmac_f32_16x16x64_bf16 v[48:51], v[12:15], a[176:183], v3
  v_smfmac_f32_16x16x64_bf16 v[52:55], v[12:15], a[232:239], v3
  v_smfmac_f32_16x16x64_bf16 v[56:59], v[12:15], v[152:159], v3
  ds_read_b128 v[68:71], v0 offset:0
  ds_read_b128 v[72:75], v0 offset:1024
  v_smfmac_f32_16x16x64_bf16 v[60:63], v[12:15], v[208:215], v3
  s_waitcnt lgkmcnt(6)
  ds_read_b128 v[76:79], v0 offset:2048
  ds_read_b128 v[80:83], v0 offset:3072
  v_smfmac_f32_16x16x64_bf16 v[36:39], v[16:19], a[16:23], v3
  s_waitcnt lgkmcnt(7)
  v_smfmac_f32_16x16x64_bf16 v[36:39], v[20:23], a[24:31], v3
  s_waitcnt lgkmcnt(6)
  v_smfmac_f32_16x16x64_bf16 v[36:39], v[24:27], a[32:39], v3
  s_waitcnt lgkmcnt(2)
  v_smfmac_f32_16x16x64_bf16 v[64:67], v[8:11], v[68:75], v3
  s_waitcnt lgkmcnt(5)
  ds_read_b128 v[84:87], v0 offset:4096
  ds_read_b128 v[88:91], v0 offset:5120
  v_smfmac_f32_16x16x64_bf16 v[36:39], v[28:31], a[40:47], v3
  s_waitcnt lgkmcnt(6)
  v_smfmac_f32_16x16x64_bf16 v[36:39], v[32:35], a[48:55], v3
  v_smfmac_f32_16x16x64_bf16 v[40:43], v[16:19], a[72:79], v3
  s_waitcnt lgkmcnt(2)
  v_smfmac_f32_16x16x64_bf16 v[64:67], v[12:15], v[76:83], v3
  ds_read_b128 v[68:71], v0 offset:6144
  ds_read_b128 v[72:75], v0 offset:7168
  v_smfmac_f32_16x16x64_bf16 v[40:43], v[20:23], a[80:87], v3
  v_permlane32_swap_b32 v36, v38
  v_smfmac_f32_16x16x64_bf16 v[40:43], v[24:27], a[88:95], v3
  v_permlane32_swap_b32 v37, v39
  v_smfmac_f32_16x16x64_bf16 v[40:43], v[28:31], a[96:103], v3
  s_waitcnt lgkmcnt(2)
  v_add_f32 v36, v36, v38
  v_smfmac_f32_16x16x64_bf16 v[64:67], v[16:19], v[84:91], v3
  ds_read_b128 v[76:79], v0 offset:8192
  ds_read_b128 v[80:83], v0 offset:9216
  v_add_f32 v37, v37, v39
  v_smfmac_f32_16x16x64_bf16 v[40:43], v[32:35], a[104:111], v3
  v_cmp_u_f32 vcc, v36, v37
  v_smfmac_f32_16x16x64_bf16 v[44:47], v[16:19], a[128:135], v3
  v_cvt_pk_bf16_f32 v38, v36, v37
  v_smfmac_f32_16x16x64_bf16 v[44:47], v[20:23], a[136:143], v3
  ds_write_b32 v104, v38
  s_waitcnt lgkmcnt(3)
  s_cbranch_vccnz cA_va2_slow
  v_permlane32_swap_b32 v40, v42
  v_smfmac_f32_16x16x64_bf16 v[64:67], v[20:23], v[68:75], v3
  ds_read_b128 v[84:87], v0 offset:10240
  ds_read_b128 v[88:91], v0 offset:11264
  v_permlane32_swap_b32 v41, v43
  v_smfmac_f32_16x16x64_bf16 v[44:47], v[24:27], a[144:151], v3
  v_add_f32 v40, v40, v42
  v_smfmac_f32_16x16x64_bf16 v[44:47], v[28:31], a[152:159], v3
  v_add_f32 v41, v41, v43
  v_smfmac_f32_16x16x64_bf16 v[44:47], v[32:35], a[160:167], v3
  s_waitcnt lgkmcnt(3)
  v_cvt_pk_bf16_f32 v42, v40, v41
  v_smfmac_f32_16x16x64_bf16 v[64:67], v[24:27], v[76:83], v3
  ds_write_b32 v105, v42
  ds_read_b128 v[68:71], v0 offset:12288
  ds_read_b128 v[72:75], v0 offset:13312
  v_smfmac_f32_16x16x64_bf16 v[48:51], v[16:19], a[184:191], v3
  s_nop 0
  v_permlane32_swap_b32 v44, v46
  v_smfmac_f32_16x16x64_bf16 v[48:51], v[20:23], a[192:199], v3
  v_permlane32_swap_b32 v45, v47
  v_smfmac_f32_16x16x64_bf16 v[48:51], v[24:27], a[200:207], v3
  s_waitcnt lgkmcnt(3)
  v_add_f32 v44, v44, v46
  v_smfmac_f32_16x16x64_bf16 v[64:67], v[28:31], v[84:91], v3
  v_add_f32 v45, v45, v47
  v_smfmac_f32_16x16x64_bf16 v[48:51], v[28:31], a[208:215], v3
  v_cvt_pk_bf16_f32 v46, v44, v45
  v_smfmac_f32_16x16x64_bf16 v[48:51], v[32:35], a[216:223], v3
  ds_write_b32 v106, v46
  v_smfmac_f32_16x16x64_bf16 v[52:55], v[16:19], a[240:247], v3
  s_waitcnt lgkmcnt(1)
  v_smfmac_f32_16x16x64_bf16 v[64:67], v[32:35], v[68:75], v3
  v_smfmac_f32_16x16x64_bf16 v[52:55], v[20:23], a[248:255], v3
  v_permlane32_swap_b32 v48, v50
  v_smfmac_f32_16x16x64_bf16 v[52:55], v[24:27], v[120:127], v3
  v_permlane32_swap_b32 v49, v51
  v_smfmac_f32_16x16x64_bf16 v[52:55], v[28:31], v[128:135], v3
  v_add_f32 v48, v48, v50
  v_smfmac_f32_16x16x64_bf16 v[52:55], v[32:35], v[136:143], v3
  v_add_f32 v49, v49, v51
  v_smfmac_f32_16x16x64_bf16 v[56:59], v[16:19], v[160:167], v3
  v_cvt_pk_bf16_f32 v50, v48, v49
  v_smfmac_f32_16x16x64_bf16 v[56:59], v[20:23], v[168:175], v3
  ds_write_b32 v107, v50
  v_permlane32_swap_b32 v64, v66
  v_smfmac_f32_16x16x64_bf16 v[56:59], v[24:27], v[176:183], v3
  v_permlane32_swap_b32 v65, v67
  v_smfmac_f32_16x16x64_bf16 v[56:59], v[28:31], v[184:191], v3
  v_add_f32 v64, v64, v66
  v_smfmac_f32_16x16x64_bf16 v[56:59], v[32:35], v[192:199], v3
  v_add_f32 v65, v65, v67
  v_smfmac_f32_16x16x64_bf16 v[60:63], v[16:19], v[216:223], v3
  v_cvt_pk_bf16_f32 v66, v64, v65
  v_smfmac_f32_16x16x64_bf16 v[60:63], v[20:23], v[224:231], v3
  ds_write_b32 v111, v66
  v_permlane32_swap_b32 v52, v54
  v_smfmac_f32_16x16x64_bf16 v[60:63], v[24:27], v[232:239], v3
  v_permlane32_swap_b32 v53, v55
  v_smfmac_f32_16x16x64_bf16 v[60:63], v[28:31], v[240:247], v3
  v_add_f32 v52, v52, v54
  v_smfmac_f32_16x16x64_bf16 v[60:63], v[32:35], v[248:255], v3
  v_add_f32 v53, v53, v55
  v_cvt_pk_bf16_f32 v54, v52, v53
  ds_write_b32 v108, v54
  v_permlane32_swap_b32 v56, v58
  v_permlane32_swap_b32 v57, v59
  v_add_f32 v56, v56, v58
  v_add_f32 v57, v57, v59
  v_cvt_pk_bf16_f32 v58, v56, v57
  ds_write_b32 v109, v58
  v_permlane32_swap_b32 v60, v62
  v_permlane32_swap_b32 v61, v63
  v_add_f32 v60, v60, v62
  v_add_f32 v61, v61, v63
  v_cvt_pk_bf16_f32 v62, v60, v61
  ds_write_b32 v110, v62
cA_va2_t2d:
  v_mov_b32 v117, s18
  s_waitcnt lgkmcnt(0)
  s_barrier
  s_cmp_eq_u32 s19, 63
  s_cbranch_scc1 cA_done
  s_sleep 1
  v_mov_b32 v36, 0
  v_mov_b32 v37, 0
  v_mov_b32 v38, 0
  v_mov_b32 v39, 0
  v_mov_b32 v40, 0
  v_mov_b32 v41, 0
  v_mov_b32 v42, 0
  v_mov_b32 v43, 0
  v_mov_b32 v44, 0
  v_mov_b32 v45, 0
  v_mov_b32 v46, 0
  v_mov_b32 v47, 0
  v_mov_b32 v48, 0
  v_mov_b32 v49, 0
  v_mov_b32 v50, 0
  v_mov_b32 v51, 0
  v_mov_b32 v52, 0
  v_mov_b32 v53, 0
  v_mov_b32 v54, 0
  v_mov_b32 v55, 0
  v_mov_b32 v56, 0
  v_mov_b32 v57, 0
  v_mov_b32 v58, 0
  v_mov_b32 v59, 0
  v_mov_b32 v60, 0
  v_mov_b32 v61, 0
  v_mov_b32 v62, 0
  v_mov_b32 v63, 0
  v_mov_b32 v64, 0
  v_mov_b32 v65, 0
  v_mov_b32 v66, 0
  v_mov_b32 v67, 0
  s_sleep 5
  s_mov_b32 s19, s18
  s_add_u32 s18, s18, 1
  s_mov_b32 s22, s20
  s_mov_b32 s20, s21
  s_mov_b32 s21, s22
  s_add_u32 s23, s20, 4096
  s_branch cA_va2_loop
cA_va2_slow:
  s_waitcnt lgkmcnt(0)
cA_va2_sl1:
  s_add_u32 s31, s31, 0x1000000
  buffer_load_dwordx4 v[8:11], v2, s[8:11], s20 offen offset:0 sc1
  buffer_load_dwordx4 v[12:15], v2, s[8:11], s20 offen offset:1024 sc1
  buffer_load_dwordx4 v[16:19], v2, s[8:11], s20 offen offset:2048 sc1
  buffer_load_dwordx4 v[20:23], v2, s[8:11], s20 offen offset:3072 sc1
  buffer_load_dwordx4 v[24:27], v2, s[8:11], s23 offen offset:0 sc1
  buffer_load_dwordx4 v[28:31], v2, s[8:11], s23 offen offset:1024 sc1
  buffer_load_dwordx4 v[32:35], v2, s[8:11], s23 offen offset:2048 sc1
  s_waitcnt vmcnt(0)
  v_max3_u32 v36, v8, v9, v10
  v_max3_u32 v36, v36, v11, v12
  v_max3_u32 v36, v36, v13, v14
  v_max3_u32 v36, v36, v15, v16
  v_max3_u32 v36, v36, v17, v18
  v_max3_u32 v36, v36, v19, v20
  v_max3_u32 v36, v36, v21, v22
  v_max3_u32 v36, v36, v23, v24
  v_max3_u32 v36, v36, v25, v26
  v_max3_u32 v36, v36, v27, v28
  v_max3_u32 v36, v36, v29, v30
  v_max3_u32 v36, v36, v31, v32
  v_max3_u32 v36, v36, v33, v34
  v_max_u32 v36, v36, v35
  v_cmp_eq_u32 vcc, -1, v36
  s_cbranch_vccz cA_va2_sl2
  s_add_u32 s30, s30, 1
  s_cmp_lt_u32 s30, 400000
  s_cbranch_scc1 cA_va2_sl1
  s_branch cA_abort
cA_va2_sl2:
  v_mov_b32 v36, 0
  v_mov_b32 v37, 0
  v_mov_b32 v38, 0
  v_mov_b32 v39, 0
  v_mov_b32 v40, 0
  v_mov_b32 v41, 0
  v_mov_b32 v42, 0
  v_mov_b32 v43, 0
  v_mov_b32 v44, 0
  v_mov_b32 v45, 0
  v_mov_b32 v46, 0
  v_mov_b32 v47, 0
  v_mov_b32 v48, 0
  v_mov_b32 v49, 0
  v_mov_b32 v50, 0
  v_mov_b32 v51, 0
  v_mov_b32 v52, 0
  v_mov_b32 v53, 0
  v_mov_b32 v54, 0
  v_mov_b32 v55, 0
  v_mov_b32 v56, 0
  v_mov_b32 v57, 0
  v_mov_b32 v58, 0
  v_mov_b32 v59, 0
  v_mov_b32 v60, 0
  v_mov_b32 v61, 0
  v_mov_b32 v62, 0
  v_mov_b32 v63, 0
  v_mov_b32 v64, 0
  v_mov_b32 v65, 0
  v_mov_b32 v66, 0
  v_mov_b32 v67, 0
  ds_read_b128 v[68:71], v0 offset:0
  ds_read_b128 v[72:75], v0 offset:1024
  v_smfmac_f32_16x16x64_bf16 v[36:39], v[8:11], a[0:7], v3
  v_smfmac_f32_16x16x64_bf16 v[40:43], v[8:11], a[56:63], v3
  v_smfmac_f32_16x16x64_bf16 v[44:47], v[8:11], a[112:119], v3
  v_smfmac_f32_16x16x64_bf16 v[48:51], v[8:11], a[168:175], v3
  v_smfmac_f32_16x16x64_bf16 v[52:55], v[8:11], a[224:231], v3
  v_smfmac_f32_16x16x64_bf16 v[56:59], v[8:11], v[144:151], v3
  v_smfmac_f32_16x16x64_bf16 v[60:63], v[8:11], v[200:207], v3
  s_waitcnt lgkmcnt(0)
  v_smfmac_f32_16x16x64_bf16 v[64:67], v[8:11], v[68:75], v3
  ds_read_b128 v[76:79], v0 offset:2048
  ds_read_b128 v[80:83], v0 offset:3072
  v_smfmac_f32_16x16x64_bf16 v[36:39], v[12:15], a[8:15], v3
  v_smfmac_f32_16x16x64_bf16 v[40:43], v[12:15], a[64:71], v3
  v_smfmac_f32_16x16x64_bf16 v[44:47], v[12:15], a[120:127], v3
  v_smfmac_f32_16x16x64_bf16 v[48:51], v[12:15], a[176:183], v3
  v_smfmac_f32_16x16x64_bf16 v[52:55], v[12:15], a[232:239], v3
  v_smfmac_f32_16x16x64_bf16 v[56:59], v[12:15], v[152:159], v3
  v_smfmac_f32_16x16x64_bf16 v[60:63], v[12:15], v[208:215], v3
  s_waitcnt lgkmcnt(0)
  v_smfmac_f32_16x16x64_bf16 v[64:67], v[12:15], v[76:83], v3
  ds_read_b128 v[84:87], v0 offset:4096
  ds_read_b128 v[88:91], v0 offset:5120
  v_smfmac_f32_16x16x64_bf16 v[36:39], v[16:19], a[16:23], v3
  v_smfmac_f32_16x16x64_bf16 v[40:43], v[16:19], a[72:79], v3
  v_smfmac_f32_16x16x64_bf16 v[44:47], v[16:19], a[128:135], v3
  v_smfmac_f32_16x16x64_bf16 v[48:51], v[16:19], a[184:191], v3
  v_smfmac_f32_16x16x64_bf16 v[52:55], v[16:19], a[240:247], v3
  v_smfmac_f32_16x16x64_bf16 v[56:59], v[16:19], v[160:167], v3
  v_smfmac_f32_16x16x64_bf16 v[60:63], v[16:19], v[216:223], v3
  s_waitcnt lgkmcnt(0)
  v_smfmac_f32_16x16x64_bf16 v[64:67], v[16:19], v[84:91], v3
  ds_read_b128 v[68:71], v0 offset:6144
  ds_read_b128 v[72:75], v0 offset:7168
  v_smfmac_f32_16x16x64_bf16 v[36:39], v[20:23], a[24:31], v3
  v_smfmac_f32_16x16x64_bf16 v[40:43], v[20:23], a[80:87], v3
  v_smfmac_f32_16x16x64_bf16 v[44:47], v[20:23], a[136:143], v3
  v_smfmac_f32_16x16x64_bf16 v[48:51], v[20:23], a[192:199], v3
  v_smfmac_f32_16x16x64_bf16 v[52:55], v[20:23], a[248:255], v3
  v_smfmac_f32_16x16x64_bf16 v[56:59], v[20:23], v[168:175], v3
  v_smfmac_f32_16x16x64_bf16 v[60:63], v[20:23], v[224:231], v3
  s_waitcnt lgkmcnt(0)
  v_smfmac_f32_16x16x64_bf16 v[64:67], v[20:23], v[68:75], v3
  ds_read_b128 v[76:79], v0 offset:8192
  ds_read_b128 v[80:83], v0 offset:9216
  v_smfmac_f32_16x16x64_bf16 v[36:39], v[24:27], a[32:39], v3
  v_smfmac_f32_16x16x64_bf16 v[40:43], v[24:27], a[88:95], v3
  v_smfmac_f32_16x16x64_bf16 v[44:47], v[24:27], a[144:151], v3
  v_smfmac_f32_16x16x64_bf16 v[48:51], v[24:27], a[200:207], v3
  v_smfmac_f32_16x16x64_bf16 v[52:55], v[24:27], v[120:127], v3
  v_smfmac_f32_16x16x64_bf16 v[56:59], v[24:27], v[176:183], v3
  v_smfmac_f32_16x16x64_bf16 v[60:63], v[24:27], v[232:239], v3
  s_waitcnt lgkmcnt(0)
  v_smfmac_f32_16x16x64_bf16 v[64:67], v[24:27], v[76:83], v3
  ds_read_b128 v[84:87], v0 offset:10240
  ds_read_b128 v[88:91], v0 offset:11264
  v_smfmac_f32_16x16x64_bf16 v[36:39], v[28:31], a[40:47], v3
  v_smfmac_f32_16x16x64_bf16 v[40:43], v[28:31], a[96:103], v3
  v_smfmac_f32_16x16x64_bf16 v[44:47], v[28:31], a[152:159], v3
  v_smfmac_f32_16x16x64_bf16 v[48:51], v[28:31], a[208:215], v3
  v_smfmac_f32_16x16x64_bf16 v[52:55], v[28:31], v[128:135], v3
  v_smfmac_f32_16x16x64_bf16 v[56:59], v[28:31], v[184:191], v3
  v_smfmac_f32_16x16x64_bf16 v[60:63], v[28:31], v[240:247], v3
  s_waitcnt lgkmcnt(0)
  v_smfmac_f32_16x16x64_bf16 v[64:67], v[28:31], v[84:91], v3
  ds_read_b128 v[68:71], v0 offset:12288
  ds_read_b128 v[72:75], v0 offset:13312
  v_smfmac_f32_16x16x64_bf16 v[36:39], v[32:35], a[48:55], v3
  v_smfmac_f32_16x16x64_bf16 v[40:43], v[32:35], a[104:111], v3
  v_smfmac_f32_16x16x64_bf16 v[44:47], v[32:35], a[160:167], v3
  v_smfmac_f32_16x16x64_bf16 v[48:51], v[32:35], a[216:223], v3
  v_smfmac_f32_16x16x64_bf16 v[52:55], v[32:35], v[136:143], v3
  v_smfmac_f32_16x16x64_bf16 v[56:59], v[32:35], v[192:199], v3
  v_smfmac_f32_16x16x64_bf16 v[60:63], v[32:35], v[248:255], v3
  s_waitcnt lgkmcnt(0)
  v_smfmac_f32_16x16x64_bf16 v[64:67], v[32:35], v[68:75], v3
  v_permlane32_swap_b32 v36, v38
  v_permlane32_swap_b32 v37, v39
  v_add_f32 v36, v36, v38
  v_add_f32 v37, v37, v39
  v_cvt_pk_bf16_f32 v38, v36, v37
  ds_write_b32 v104, v38
  v_permlane32_swap_b32 v40, v42
  v_permlane32_swap_b32 v41, v43
  v_add_f32 v40, v40, v42
  v_add_f32 v41, v41, v43
  v_cvt_pk_bf16_f32 v42, v40, v41
  ds_write_b32 v105, v42
  v_permlane32_swap_b32 v44, v46
  v_permlane32_swap_b32 v45, v47
  v_add_f32 v44, v44, v46
  v_add_f32 v45, v45, v47
  v_cvt_pk_bf16_f32 v46, v44, v45
  ds_write_b32 v106, v46
  v_permlane32_swap_b32 v48, v50
  v_permlane32_swap_b32 v49, v51
  v_add_f32 v48, v48, v50
  v_add_f32 v49, v49, v51
  v_cvt_pk_bf16_f32 v50, v48, v49
  ds_write_b32 v107, v50
  v_permlane32_swap_b32 v52, v54
  v_permlane32_swap_b32 v53, v55
  v_add_f32 v52, v52, v54
  v_add_f32 v53, v53, v55
  v_cvt_pk_bf16_f32 v54, v52, v53
  ds_write_b32 v108, v54
  v_permlane32_swap_b32 v56, v58
  v_permlane32_swap_b32 v57, v59
  v_add_f32 v56, v56, v58
  v_add_f32 v57, v57, v59
  v_cvt_pk_bf16_f32 v58, v56, v57
  ds_write_b32 v109, v58
  v_permlane32_swap_b32 v60, v62
  v_permlane32_swap_b32 v61, v63
  v_add_f32 v60, v60, v62
  v_add_f32 v61, v61, v63
  v_cvt_pk_bf16_f32 v62, v60, v61
  ds_write_b32 v110, v62
  v_permlane32_swap_b32 v64, v66
  v_permlane32_swap_b32 v65, v67
  v_add_f32 v64, v64, v66
  v_add_f32 v65, v65, v67
  v_cvt_pk_bf16_f32 v66, v64, v65
  ds_write_b32 v111, v66
  s_branch cA_va2_t2d
.p2align 6
cA_va3_loop:
  s_mov_b32 s30, 0
  s_barrier
  buffer_load_dwordx4 v[16:19], v2, s[8:11], s20 offen offset:2048 sc1
  buffer_load_dwordx4 v[20:23], v2, s[8:11], s20 offen offset:3072 sc1
  s_barrier
  buffer_load_dword v100, v116, s[8:11], s39 offen sc1
  s_add_u32 s27, s19, 2
  s_min_u32 s27, s27, 63
  s_lshr_b32 s27, s27, 3
  s_lshl_b32 s27, s27, 11
  s_add_u32 s27, s27, s35
  s_cmp_eq_u32 s27, s28
  s_cselect_b32 s29, 35328, s27
  buffer_load_dword v101, off, s[8:11], s29 sc1
  s_add_u32 s39, s39, 28672
  s_waitcnt vmcnt(2)
  ds_write_b128 v2, v[16:19] offset:10240
  ds_write_b128 v2, v[20:23] offset:11264
  v_smfmac_f32_16x16x64_bf16 v[36:39], v[16:19], a[16:23], v3
  v_smfmac_f32_16x16x64_bf16 v[40:43], v[16:19], a[72:79], v3
  v_smfmac_f32_16x16x64_bf16 v[44:47], v[16:19], a[128:135], v3
  v_smfmac_f32_16x16x64_bf16 v[48:51], v[16:19], a[184:191], v3
  v_smfmac_f32_16x16x64_bf16 v[52:55], v[16:19], a[240:247], v3
  s_waitcnt lgkmcnt(0)
  s_barrier
  ds_read_b128 v[8:11], v2 offset:8192
  ds_read_b128 v[12:15], v2 offset:9216
  ds_read_b128 v[24:27], v2 offset:12288
  ds_read_b128 v[28:31], v2 offset:13312
  ds_read_b128 v[32:35], v2 offset:14336
  v_smfmac_f32_16x16x64_bf16 v[56:59], v[16:19], v[160:167], v3
  v_smfmac_f32_16x16x64_bf16 v[60:63], v[16:19], v[216:223], v3
  v_smfmac_f32_16x16x64_bf16 v[36:39], v[20:23], a[24:31], v3
  v_smfmac_f32_16x16x64_bf16 v[40:43], v[20:23], a[80:87], v3
  v_smfmac_f32_16x16x64_bf16 v[44:47], v[20:23], a[136:143], v3
  v_smfmac_f32_16x16x64_bf16 v[48:51], v[20:23], a[192:199], v3
  v_smfmac_f32_16x16x64_bf16 v[52:55], v[20:23], a[248:255], v3
  v_smfmac_f32_16x16x64_bf16 v[56:59], v[20:23], v[168:175], v3
  v_smfmac_f32_16x16x64_bf16 v[60:63], v[20:23], v[224:231], v3
  s_waitcnt lgkmcnt(4)
  v_smfmac_f32_16x16x64_bf16 v[36:39], v[8:11], a[0:7], v3
  s_waitcnt lgkmcnt(3)
  v_smfmac_f32_16x16x64_bf16 v[36:39], v[12:15], a[8:15], v3
  s_waitcnt lgkmcnt(2)
  v_smfmac_f32_16x16x64_bf16 v[36:39], v[24:27], a[32:39], v3
  s_waitcnt lgkmcnt(1)
  v_smfmac_f32_16x16x64_bf16 v[36:39], v[28:31], a[40:47], v3
  s_waitcnt lgkmcnt(0)
  v_smfmac_f32_16x16x64_bf16 v[36:39], v[32:35], a[48:55], v3
  v_smfmac_f32_16x16x64_bf16 v[40:43], v[8:11], a[56:63], v3
  v_smfmac_f32_16x16x64_bf16 v[40:43], v[12:15], a[64:71], v3
  v_smfmac_f32_16x16x64_bf16 v[40:43], v[24:27], a[88:95], v3
  v_permlane32_swap_b32 v36, v38
  v_smfmac_f32_16x16x64_bf16 v[40:43], v[28:31], a[96:103], v3
  v_permlane32_swap_b32 v37, v39
  v_smfmac_f32_16x16x64_bf16 v[40:43], v[32:35], a[104:111], v3
  v_add_f32 v36, v36, v38
  v_smfmac_f32_16x16x64_bf16 v[44:47], v[8:11], a[112:119], v3
  v_add_f32 v37, v37, v39
  v_smfmac_f32_16x16x64_bf16 v[44:47], v[12:15], a[120:127], v3
  v_cmp_u_f32 vcc, v36, v37
  v_smfmac_f32_16x16x64_bf16 v[44:47], v[24:27], a[144:151], v3
  v_cvt_pk_bf16_f32 v38, v36, v37
  v_smfmac_f32_16x16x64_bf16 v[44:47], v[28:31], a[152:159], v3
  ds_write_b32 v104, v38
  s_cbranch_vccnz cA_va3_slow
  v_permlane32_swap_b32 v40, v42
  v_smfmac_f32_16x16x64_bf16 v[44:47], v[32:35], a[160:167], v3
  v_permlane32_swap_b32 v41, v43
  v_smfmac_f32_16x16x64_bf16 v[48:51], v[8:11], a[168:175], v3
  v_add_f32 v40, v40, v42
  v_smfmac_f32_16x16x64_bf16 v[48:51], v[12:15], a[176:183], v3
  v_add_f32 v41, v41, v43
  v_smfmac_f32_16x16x64_bf16 v[48:51], v[24:27], a[200:207], v3
  v_cvt_pk_bf16_f32 v42, v40, v41
  v_smfmac_f32_16x16x64_bf16 v[48:51], v[28:31], a[208:215], v3
  ds_write_b32 v105, v42
  v_permlane32_swap_b32 v44, v46
  v_smfmac_f32_16x16x64_bf16 v[48:51], v[32:35], a[216:223], v3
  v_permlane32_swap_b32 v45, v47
  v_smfmac_f32_16x16x64_bf16 v[52:55], v[8:11], a[224:231], v3
  v_add_f32 v44, v44, v46
  v_smfmac_f32_16x16x64_bf16 v[52:55], v[12:15], a[232:239], v3
  v_add_f32 v45, v45, v47
  v_smfmac_f32_16x16x64_bf16 v[52:55], v[24:27], v[120:127], v3
  v_cvt_pk_bf16_f32 v46, v44, v45
  v_smfmac_f32_16x16x64_bf16 v[52:55], v[28:31], v[128:135], v3
  ds_write_b32 v106, v46
  v_permlane32_swap_b32 v48, v50
  v_smfmac_f32_16x16x64_bf16 v[52:55], v[32:35], v[136:143], v3
  v_permlane32_swap_b32 v49, v51
  v_smfmac_f32_16x16x64_bf16 v[56:59], v[8:11], v[144:151], v3
  v_add_f32 v48, v48, v50
  v_smfmac_f32_16x16x64_bf16 v[56:59], v[12:15], v[152:159], v3
  v_add_f32 v49, v49, v51
  v_smfmac_f32_16x16x64_bf16 v[56:59], v[24:27], v[176:183], v3
  v_cvt_pk_bf16_f32 v50, v48, v49
  v_smfmac_f32_16x16x64_bf16 v[56:59], v[28:31], v[184:191], v3
  ds_write_b32 v107, v50
  v_permlane32_swap_b32 v52, v54
  v_smfmac_f32_16x16x64_bf16 v[56:59], v[32:35], v[192:199], v3
  v_permlane32_swap_b32 v53, v55
  v_smfmac_f32_16x16x64_bf16 v[60:63], v[8:11], v[200:207], v3
  v_add_f32 v52, v52, v54
  v_smfmac_f32_16x16x64_bf16 v[60:63], v[12:15], v[208:215], v3
  v_add_f32 v53, v53, v55
  v_smfmac_f32_16x16x64_bf16 v[60:63], v[24:27], v[232:239], v3
  v_cvt_pk_bf16_f32 v54, v52, v53
  v_smfmac_f32_16x16x64_bf16 v[60:63], v[28:31], v[240:247], v3
  ds_write_b32 v108, v54
  v_permlane32_swap_b32 v56, v58
  v_smfmac_f32_16x16x64_bf16 v[60:63], v[32:35], v[248:255], v3
  v_permlane32_swap_b32 v57, v59
  v_add_f32 v56, v56, v58
  v_add_f32 v57, v57, v59
  v_cvt_pk_bf16_f32 v58, v56, v57
  ds_write_b32 v109, v58
  s_nop 2
  v_permlane32_swap_b32 v60, v62
  v_permlane32_swap_b32 v61, v63
  v_add_f32 v60, v60, v62
  v_add_f32 v61, v61, v63
  v_cvt_pk_bf16_f32 v62, v60, v61
  ds_write_b32 v110, v62
cA_va3_t2d:
  v_mov_b32 v117, s18
  s_cmp_eq_u32 s27, s28
  s_cbranch_scc1 cA_va3_vok
cA_va3_vow:
  s_waitcnt vmcnt(0)
  v_cmp_ne_u32 vcc, 56, v101
  s_cbranch_vccnz cA_va3_vor
  s_mov_b32 s28, s27
cA_va3_vok:
  s_waitcnt lgkmcnt(0)
  s_setprio 3
  s_barrier
  v_mov_b32 v36, 0
  v_mov_b32 v37, 0
  buffer_store_dword v117, v118, s[8:11], 0 offen
  s_setprio 0
  s_cmp_eq_u32 s19, 63
  s_cbranch_scc1 cA_done
  v_mov_b32 v38, 0
  v_mov_b32 v39, 0
  v_mov_b32 v40, 0
  v_mov_b32 v41, 0
  v_mov_b32 v42, 0
  v_mov_b32 v43, 0
  v_mov_b32 v44, 0
  v_mov_b32 v45, 0
  v_mov_b32 v46, 0
  v_mov_b32 v47, 0
  v_mov_b32 v48, 0
  v_mov_b32 v49, 0
  v_mov_b32 v50, 0
  v_mov_b32 v51, 0
  v_mov_b32 v52, 0
  v_mov_b32 v53, 0
  v_mov_b32 v54, 0
  v_mov_b32 v55, 0
  v_mov_b32 v56, 0
  v_mov_b32 v57, 0
  v_mov_b32 v58, 0
  v_mov_b32 v59, 0
  v_mov_b32 v60, 0
  v_mov_b32 v61, 0
  v_mov_b32 v62, 0
  v_mov_b32 v63, 0
  s_mov_b32 s19, s18
  s_add_u32 s18, s18, 1
  s_mov_b32 s22, s20
  s_mov_b32 s20, s21
  s_mov_b32 s21, s22
  s_add_u32 s23, s20, 4096
  s_branch cA_va3_loop
cA_va3_slow:
  s_waitcnt lgkmcnt(0)
cA_va3_sl1:
  s_add_u32 s31, s31, 0x1000000
  buffer_load_dwordx4 v[8:11], v2, s[8:11], s20 offen offset:0 sc1
  buffer_load_dwordx4 v[12:15], v2, s[8:11], s20 offen offset:1024 sc1
  buffer_load_dwordx4 v[16:19], v2, s[8:11], s20 offen offset:2048 sc1
  buffer_load_dwordx4 v[20:23], v2, s[8:11], s20 offen offset:3072 sc1
  buffer_load_dwordx4 v[24:27], v2, s[8:11], s23 offen offset:0 sc1
  buffer_load_dwordx4 v[28:31], v2, s[8:11], s23 offen offset:1024 sc1
  buffer_load_dwordx4 v[32:35], v2, s[8:11], s23 offen offset:2048 sc1
  s_waitcnt vmcnt(0)
  v_max3_u32 v36, v8, v9, v10
  v_max3_u32 v36, v36, v11, v12
  v_max3_u32 v36, v36, v13, v14
  v_max3_u32 v36, v36, v15, v16
  v_max3_u32 v36, v36, v17, v18
  v_max3_u32 v36, v36, v19, v20
  v_max3_u32 v36, v36, v21, v22
  v_max3_u32 v36, v36, v23, v24
  v_max3_u32 v36, v36, v25, v26
  v_max3_u32 v36, v36, v27, v28
  v_max3_u32 v36, v36, v29, v30
  v_max3_u32 v36, v36, v31, v32
  v_max3_u32 v36, v36, v33, v34
  v_max_u32 v36, v36, v35
  v_cmp_eq_u32 vcc, -1, v36
  s_cbranch_vccz cA_va3_sl2
  s_add_u32 s30, s30, 1
  s_cmp_lt_u32 s30, 400000
  s_cbranch_scc1 cA_va3_sl1
  s_branch cA_abort
cA_va3_sl2:
  v_mov_b32 v36, 0
  v_mov_b32 v37, 0
  v_mov_b32 v38, 0
  v_mov_b32 v39, 0
  v_mov_b32 v40, 0
  v_mov_b32 v41, 0
  v_mov_b32 v42, 0
  v_mov_b32 v43, 0
  v_mov_b32 v44, 0
  v_mov_b32 v45, 0
  v_mov_b32 v46, 0
  v_mov_b32 v47, 0
  v_mov_b32 v48, 0
  v_mov_b32 v49, 0
  v_mov_b32 v50, 0
  v_mov_b32 v51, 0
  v_mov_b32 v52, 0
  v_mov_b32 v53, 0
  v_mov_b32 v54, 0
  v_mov_b32 v55, 0
  v_mov_b32 v56, 0
  v_mov_b32 v57, 0
  v_mov_b32 v58, 0
  v_mov_b32 v59, 0
  v_mov_b32 v60, 0
  v_mov_b32 v61, 0
  v_mov_b32 v62, 0
  v_mov_b32 v63, 0
  v_smfmac_f32_16x16x64_bf16 v[36:39], v[8:11], a[0:7], v3
  v_smfmac_f32_16x16x64_bf16 v[40:43], v[8:11], a[56:63], v3
  v_smfmac_f32_16x16x64_bf16 v[44:47], v[8:11], a[112:119], v3
  v_smfmac_f32_16x16x64_bf16 v[48:51], v[8:11], a[168:175], v3
  v_smfmac_f32_16x16x64_bf16 v[52:55], v[8:11], a[224:231], v3
  v_smfmac_f32_16x16x64_bf16 v[56:59], v[8:11], v[144:151], v3
  v_smfmac_f32_16x16x64_bf16 v[60:63], v[8:11], v[200:207], v3
  v_smfmac_f32_16x16x64_bf16 v[36:39], v[12:15], a[8:15], v3
  v_smfmac_f32_16x16x64_bf16 v[40:43], v[12:15], a[64:71], v3
  v_smfmac_f32_16x16x64_bf16 v[44:47], v[12:15], a[120:127], v3
  v_smfmac_f32_16x16x64_bf16 v[48:51], v[12:15], a[176:183], v3
  v_smfmac_f32_16x16x64_bf16 v[52:55], v[12:15], a[232:239], v3
  v_smfmac_f32_16x16x64_bf16 v[56:59], v[12:15], v[152:159], v3
  v_smfmac_f32_16x16x64_bf16 v[60:63], v[12:15], v[208:215], v3
  v_smfmac_f32_16x16x64_bf16 v[36:39], v[16:19], a[16:23], v3
  v_smfmac_f32_16x16x64_bf16 v[40:43], v[16:19], a[72:79], v3
  v_smfmac_f32_16x16x64_bf16 v[44:47], v[16:19], a[128:135], v3
  v_smfmac_f32_16x16x64_bf16 v[48:51], v[16:19], a[184:191], v3
  v_smfmac_f32_16x16x64_bf16 v[52:55], v[16:19], a[240:247], v3
  v_smfmac_f32_16x16x64_bf16 v[56:59], v[16:19], v[160:167], v3
  v_smfmac_f32_16x16x64_bf16 v[60:63], v[16:19], v[216:223], v3
  v_smfmac_f32_16x16x64_bf16 v[36:39], v[20:23], a[24:31], v3
  v_smfmac_f32_16x16x64_bf16 v[40:43], v[20:23], a[80:87], v3
  v_smfmac_f32_16x16x64_bf16 v[44:47], v[20:23], a[136:143], v3
  v_smfmac_f32_16x16x64_bf16 v[48:51], v[20:23], a[192:199], v3
  v_smfmac_f32_16x16x64_bf16 v[52:55], v[20:23], a[248:255], v3
  v_smfmac_f32_16x16x64_bf16 v[56:59], v[20:23], v[168:175], v3
  v_smfmac_f32_16x16x64_bf16 v[60:63], v[20:23], v[224:231], v3
  v_smfmac_f32_16x16x64_bf16 v[36:39], v[24:27], a[32:39], v3
  v_smfmac_f32_16x16x64_bf16 v[40:43], v[24:27], a[88:95], v3
  v_smfmac_f32_16x16x64_bf16 v[44:47], v[24:27], a[144:151], v3
  v_smfmac_f32_16x16x64_bf16 v[48:51], v[24:27], a[200:207], v3
  v_smfmac_f32_16x16x64_bf16 v[52:55], v[24:27], v[120:127], v3
  v_smfmac_f32_16x16x64_bf16 v[56:59], v[24:27], v[176:183], v3
  v_smfmac_f32_16x16x64_bf16 v[60:63], v[24:27], v[232:239], v3
  v_smfmac_f32_16x16x64_bf16 v[36:39], v[28:31], a[40:47], v3
  v_smfmac_f32_16x16x64_bf16 v[40:43], v[28:31], a[96:103], v3
  v_smfmac_f32_16x16x64_bf16 v[44:47], v[28:31], a[152:159], v3
  v_smfmac_f32_16x16x64_bf16 v[48:51], v[28:31], a[208:215], v3
  v_smfmac_f32_16x16x64_bf16 v[52:55], v[28:31], v[128:135], v3
  v_smfmac_f32_16x16x64_bf16 v[56:59], v[28:31], v[184:191], v3
  v_smfmac_f32_16x16x64_bf16 v[60:63], v[28:31], v[240:247], v3
  v_smfmac_f32_16x16x64_bf16 v[36:39], v[32:35], a[48:55], v3
  v_smfmac_f32_16x16x64_bf16 v[40:43], v[32:35], a[104:111], v3
  v_smfmac_f32_16x16x64_bf16 v[44:47], v[32:35], a[160:167], v3
  v_smfmac_f32_16x16x64_bf16 v[48:51], v[32:35], a[216:223], v3
  v_smfmac_f32_16x16x64_bf16 v[52:55], v[32:35], v[136:143], v3
  v_smfmac_f32_16x16x64_bf16 v[56:59], v[32:35], v[192:199], v3
  v_smfmac_f32_16x16x64_bf16 v[60:63], v[32:35], v[248:255], v3
  v_permlane32_swap_b32 v36, v38
  v_permlane32_swap_b32 v37, v39
  v_add_f32 v36, v36, v38
  v_add_f32 v37, v37, v39
  v_cvt_pk_bf16_f32 v38, v36, v37
  ds_write_b32 v104, v38
  v_permlane32_swap_b32 v40, v42
  v_permlane32_swap_b32 v41, v43
  v_add_f32 v40, v40, v42
  v_add_f32 v41, v41, v43
  v_cvt_pk_bf16_f32 v42, v40, v41
  ds_write_b32 v105, v42
  v_permlane32_swap_b32 v44, v46
  v_permlane32_swap_b32 v45, v47
  v_add_f32 v44, v44, v46
  v_add_f32 v45, v45, v47
  v_cvt_pk_bf16_f32 v46, v44, v45
  ds_write_b32 v106, v46
  v_permlane32_swap_b32 v48, v50
  v_permlane32_swap_b32 v49, v51
  v_add_f32 v48, v48, v50
  v_add_f32 v49, v49, v51
  v_cvt_pk_bf16_f32 v50, v48, v49
  ds_write_b32 v107, v50
  v_permlane32_swap_b32 v52, v54
  v_permlane32_swap_b32 v53, v55
  v_add_f32 v52, v52, v54
  v_add_f32 v53, v53, v55
  v_cvt_pk_bf16_f32 v54, v52, v53
  ds_write_b32 v108, v54
  v_permlane32_swap_b32 v56, v58
  v_permlane32_swap_b32 v57, v59
  v_add_f32 v56, v56, v58
  v_add_f32 v57, v57, v59
  v_cvt_pk_bf16_f32 v58, v56, v57
  ds_write_b32 v109, v58
  v_permlane32_swap_b32 v60, v62
  v_permlane32_swap_b32 v61, v63
  v_add_f32 v60, v60, v62
  v_add_f32 v61, v61, v63
  v_cvt_pk_bf16_f32 v62, v60, v61
  ds_write_b32 v110, v62
  s_branch cA_va3_t2d
cA_va3_vor:
  s_sleep 2
  buffer_load_dword v101, off, s[8:11], s27 sc1
  s_add_u32 s30, s30, 1
  s_cmp_lt_u32 s30, 400000
  s_cbranch_scc1 cA_va3_vow
  s_branch cA_abort
cA_abort:
  v_mov_b32 v4, 0xdead
  v_mov_b32 v5, 16
  buffer_store_dword v4, v5, s[12:15], 0 offen
  s_branch ch_end
cA_done:
  s_branch ch_end
.p2align 6
cB_sc0_loop:
  s_mov_b32 s30, 0
  s_mov_b32 s62, 0
  s_setprio 3
  s_sleep 6
cB_sc0_fp_l:
  v_cmp_gt_u32 vcc, s19, v112
  buffer_load_dword v112, v0, s[8:11], 0 offen sc1
  s_cbranch_vccz cB_sc0_fp_d
  v_cmp_gt_u32 vcc, s19, v112
  buffer_load_dword v112, v0, s[8:11], 0 offen sc1
  s_cbranch_vccz cB_sc0_fp_d
  v_cmp_gt_u32 vcc, s19, v112
  buffer_load_dword v112, v0, s[8:11], 0 offen sc1
  s_cbranch_vccz cB_sc0_fp_d
  v_cmp_gt_u32 vcc, s19, v112
  buffer_load_dword v112, v0, s[8:11], 0 offen sc1
  s_cbranch_vccz cB_sc0_fp_d
  v_cmp_gt_u32 vcc, s19, v112
  buffer_load_dword v112, v0, s[8:11], 0 offen sc1
  s_cbranch_vccz cB_sc0_fp_d
  v_cmp_gt_u32 vcc, s19, v112
  buffer_load_dword v112, v0, s[8:11], 0 offen sc1
  s_cbranch_vccz cB_sc0_fp_d
  v_cmp_gt_u32 vcc, s19, v112
  buffer_load_dword v112, v0, s[8:11], 0 offen sc1
  s_cbranch_vccz cB_sc0_fp_d
  v_cmp_gt_u32 vcc, s19, v112
  buffer_load_dword v112, v0, s[8:11], 0 offen sc1
  s_cbranch_vccz cB_sc0_fp_d
  v_cmp_gt_u32 vcc, s19, v112
  buffer_load_dword v112, v0, s[8:11], 0 offen sc1
  s_cbranch_vccz cB_sc0_fp_d
  v_cmp_gt_u32 vcc, s19, v112
  buffer_load_dword v112, v0, s[8:11], 0 offen sc1
  s_cbranch_vccz cB_sc0_fp_d
  v_cmp_gt_u32 vcc, s19, v112
  buffer_load_dword v112, v0, s[8:11], 0 offen sc1
  s_cbranch_vccz cB_sc0_fp_d
  v_cmp_gt_u32 vcc, s19, v112
  buffer_load_dword v112, v0, s[8:11], 0 offen sc1
  s_cbranch_vccz cB_sc0_fp_d
  v_cmp_gt_u32 vcc, s19, v112
  buffer_load_dword v112, v0, s[8:11], 0 offen sc1
  s_cbranch_vccz cB_sc0_fp_d
  v_cmp_gt_u32 vcc, s19, v112
  buffer_load_dword v112, v0, s[8:11], 0 offen sc1
  s_cbranch_vccz cB_sc0_fp_d
  v_cmp_gt_u32 vcc, s19, v112
  buffer_load_dword v112, v0, s[8:11], 0 offen sc1
  s_cbranch_vccz cB_sc0_fp_d
  v_cmp_gt_u32 vcc, s19, v112
  buffer_load_dword v112, v0, s[8:11], 0 offen sc1
  s_cbranch_vccz cB_sc0_fp_d
  s_waitcnt vmcnt(24)
  s_add_u32 s30, s30, 1
  s_cmp_lt_u32 s30, 400000
  s_cbranch_scc1 cB_sc0_fp_l
  s_branch cB_abort
cB_sc0_fp_d:
  buffer_load_dwordx4 v[8:11], v2, s[8:11], s20 offen offset:0 sc1
  s_barrier
  s_setprio 2
  buffer_load_dwordx4 v[12:15], v2, s[8:11], s20 offen offset:1024 sc1
  s_setprio 1
  buffer_load_dwordx4 v[16:19], v2, s[8:11], s20 offen offset:2048 sc1
  s_setprio 0
  buffer_load_dwordx4 v[20:23], v2, s[8:11], s20 offen offset:3072 sc1
cB_sc0_go:
  s_waitcnt vmcnt(3)
  v_smfmac_f32_16x16x64_bf16 v[36:39], v[8:11], a[0:7], v3
  buffer_load_dwordx4 v[32:35], v2, s[8:11], s23 offen offset:0 sc1
  v_cmp_eq_u32 vcc, -1, v8
  v_smfmac_f32_16x16x64_bf16 v[40:43], v[8:11], a[56:63], v3
  v_smfmac_f32_16x16x64_bf16 v[44:47], v[8:11], a[112:119], v3
  buffer_load_dwordx4 v[24:27], v2, s[8:11], s23 offen offset:1024 sc1
  s_cbranch_vccnz cB_sc0_r0
  v_smfmac_f32_16x16x64_bf16 v[48:51], v[8:11], a[168:175], v3
  v_smfmac_f32_16x16x64_bf16 v[52:55], v[8:11], a[224:231], v3
  s_waitcnt vmcnt(4)
  v_cmp_eq_u32 vcc, -1, v12
  v_smfmac_f32_16x16x64_bf16 v[56:59], v[8:11], v[144:151], v3
  buffer_load_dwordx4 v[28:31], v2, s[8:11], s23 offen offset:2048 sc1
  v_smfmac_f32_16x16x64_bf16 v[60:63], v[8:11], v[200:207], v3
  s_cbranch_vccnz cB_sc0_r1
cB_sc0_c1:
  v_smfmac_f32_16x16x64_bf16 v[36:39], v[12:15], a[8:15], v3
  v_smfmac_f32_16x16x64_bf16 v[40:43], v[12:15], a[64:71], v3
  v_smfmac_f32_16x16x64_bf16 v[44:47], v[12:15], a[120:127], v3
  v_smfmac_f32_16x16x64_bf16 v[48:51], v[12:15], a[176:183], v3
  v_smfmac_f32_16x16x64_bf16 v[52:55], v[12:15], a[232:239], v3
  s_waitcnt vmcnt(4)
  v_cmp_eq_u32 vcc, -1, v16
  v_smfmac_f32_16x16x64_bf16 v[56:59], v[12:15], v[152:159], v3
  buffer_load_dwordx4 v[88:91], v117, s[8:11], s26 offen offset:0 sc1
  v_smfmac_f32_16x16x64_bf16 v[60:63], v[12:15], v[208:215], v3
  s_cbranch_vccnz cB_sc0_r2
cB_sc0_c2:
  v_smfmac_f32_16x16x64_bf16 v[36:39], v[16:19], a[16:23], v3
  v_smfmac_f32_16x16x64_bf16 v[40:43], v[16:19], a[72:79], v3
  v_smfmac_f32_16x16x64_bf16 v[44:47], v[16:19], a[128:135], v3
  buffer_load_dwordx4 v[92:95], v117, s[8:11], s26 offen offset:1024 sc1
  v_smfmac_f32_16x16x64_bf16 v[48:51], v[16:19], a[184:191], v3
  v_smfmac_f32_16x16x64_bf16 v[52:55], v[16:19], a[240:247], v3
  s_waitcnt vmcnt(5)
  v_cmp_eq_u32 vcc, -1, v20
  v_smfmac_f32_16x16x64_bf16 v[56:59], v[16:19], v[160:167], v3
  v_smfmac_f32_16x16x64_bf16 v[60:63], v[16:19], v[216:223], v3
  buffer_load_dwordx4 v[96:99], v2, s[8:11], s24 offen offset:0 sc1
  s_cbranch_vccnz cB_sc0_r3
cB_sc0_c3:
  v_smfmac_f32_16x16x64_bf16 v[36:39], v[20:23], a[24:31], v3
  v_smfmac_f32_16x16x64_bf16 v[40:43], v[20:23], a[80:87], v3
  s_waitcnt vmcnt(3)
  v_max3_u32 v66, v24, v27, v28
  v_smfmac_f32_16x16x64_bf16 v[44:47], v[20:23], a[136:143], v3
  v_max3_u32 v66, v66, v31, v32
  v_smfmac_f32_16x16x64_bf16 v[48:51], v[20:23], a[192:199], v3
  buffer_load_dwordx4 v[100:103], v2, s[8:11], s24 offen offset:1024 sc1
  v_max_u32 v66, v66, v35
  v_smfmac_f32_16x16x64_bf16 v[52:55], v[20:23], a[248:255], v3
  v_cmp_eq_u32 vcc, -1, v66
  v_smfmac_f32_16x16x64_bf16 v[56:59], v[20:23], v[168:175], v3
  v_smfmac_f32_16x16x64_bf16 v[60:63], v[20:23], v[224:231], v3
  s_cbranch_vccnz cB_sc0_r4
cB_sc0_c4:
  v_smfmac_f32_16x16x64_bf16 v[60:63], v[32:35], v[232:239], v3
  buffer_load_dwordx4 v[104:107], v2, s[8:11], s26 offen offset:0 sc1
  v_smfmac_f32_16x16x64_bf16 v[60:63], v[24:27], v[240:247], v3
  v_smfmac_f32_16x16x64_bf16 v[60:63], v[28:31], v[248:255], v3
  v_smfmac_f32_16x16x64_bf16 v[52:55], v[32:35], v[120:127], v3
  v_smfmac_f32_16x16x64_bf16 v[52:55], v[24:27], v[128:135], v3
  buffer_load_dwordx4 v[108:111], v2, s[8:11], s26 offen offset:1024 sc1
  v_smfmac_f32_16x16x64_bf16 v[52:55], v[28:31], v[136:143], v3
  v_cvt_pk_bf16_f32 v63, v62, v63
  v_smfmac_f32_16x16x64_bf16 v[56:59], v[32:35], v[176:183], v3
  v_cvt_pk_bf16_f32 v62, v60, v61
  v_smfmac_f32_16x16x64_bf16 v[56:59], v[24:27], v[184:191], v3
  v_mfma_f32_16x16x32_bf16 v[12:15], v[62:65], v[4:7], 0
  v_cvt_pk_bf16_f32 v55, v54, v55
  v_smfmac_f32_16x16x64_bf16 v[56:59], v[28:31], v[192:199], v3
  v_cvt_pk_bf16_f32 v54, v52, v53
  v_smfmac_f32_16x16x64_bf16 v[36:39], v[32:35], a[32:39], v3
  s_nop 1
  v_cvt_pk_bf16_f32 v76, v12, v13
  v_smfmac_f32_16x16x64_bf16 v[36:39], v[24:27], a[40:47], v3
  v_cvt_pk_bf16_f32 v77, v14, v15
  v_smfmac_f32_16x16x64_bf16 v[36:39], v[28:31], a[48:55], v3
  v_cvt_pk_bf16_f32 v56, v56, v57
  v_smfmac_f32_16x16x64_bf16 v[40:43], v[32:35], a[88:95], v3
  v_cvt_pk_bf16_f32 v57, v58, v59
  v_smfmac_f32_16x16x64_bf16 v[40:43], v[24:27], a[96:103], v3
  v_mfma_f32_16x16x32_bf16 v[16:19], v[54:57], v[4:7], 0
  v_cvt_pk_bf16_f32 v39, v38, v39
  v_smfmac_f32_16x16x64_bf16 v[40:43], v[28:31], a[104:111], v3
  v_cvt_pk_bf16_f32 v38, v36, v37
  v_smfmac_f32_16x16x64_bf16 v[44:47], v[32:35], a[144:151], v3
  s_nop 1
  v_cvt_pk_bf16_f32 v78, v16, v17
  v_smfmac_f32_16x16x64_bf16 v[44:47], v[24:27], a[152:159], v3
  v_cvt_pk_bf16_f32 v79, v18, v19
  v_smfmac_f32_16x16x64_bf16 v[44:47], v[28:31], a[160:167], v3
  v_cvt_pk_bf16_f32 v40, v40, v41
  v_smfmac_f32_16x16x64_bf16 v[48:51], v[32:35], a[200:207], v3
  v_cvt_pk_bf16_f32 v41, v42, v43
  v_smfmac_f32_16x16x64_bf16 v[48:51], v[24:27], a[208:215], v3
  v_smfmac_f32_16x16x64_bf16 v[48:51], v[28:31], a[216:223], v3
  s_waitcnt vmcnt(4)
  v_cvt_pk_bf16_f32 v47, v46, v47
  v_smfmac_f32_16x16x64_bf16 v[68:71], v[76:79], v[80:87], v3
  v_cvt_pk_bf16_f32 v46, v44, v45
  v_mfma_f32_16x16x32_bf16 v[12:15], v[38:41], v[4:7], 0
  s_nop 1
  v_cvt_pk_bf16_f32 v48, v48, v49
  v_cvt_pk_bf16_f32 v49, v50, v51
  s_nop 1
  v_mfma_f32_16x16x32_bf16 v[16:19], v[46:49], v[4:7], 0
  v_smfmac_f32_16x16x64_bf16 v[72:75], v[76:79], v[88:95], v3
  v_cvt_pk_bf16_f32 v20, v12, v13
  v_mfma_f32_16x16x32_bf16 v[52:55], v[30:33], v[76:79], 0
  s_waitcnt vmcnt(0)
  v_cvt_pk_bf16_f32 v21, v14, v15
  v_cvt_pk_bf16_f32 v22, v16, v17
  v_cvt_pk_bf16_f32 v23, v18, v19
  s_nop 1
  v_mfma_f32_16x16x32_bf16 v[52:55], v[8:11], v[20:23], v[52:55]
  v_smfmac_f32_16x16x64_bf16 v[68:71], v[20:23], v[96:103], v3
  v_smfmac_f32_16x16x64_bf16 v[72:75], v[20:23], v[104:111], v3
  s_nop 1
  ds_write_b128 v113, v[52:55]
  s_nop 1
  v_permlane32_swap_b32 v68, v70
  v_permlane32_swap_b32 v69, v71
  v_add_f32 v56, v68, v70
  v_add_f32 v58, v69, v71
  v_permlane32_swap_b32 v72, v74
  v_permlane32_swap_b32 v73, v75
  v_add_f32 v57, v72, v74
  v_add_f32 v59, v73, v75
  ds_write_b128 v2, v[56:59] offset:0
  v_cmp_u_f32 vcc, v57, v59
  v_mov_b32 v68, 0
  v_mov_b32 v69, 0
  v_mov_b32 v70, 0
  v_mov_b32 v71, 0
  s_cbranch_vccnz cB_sc0_retry
cB_sc0_cont:
  s_add_u32 s24, s24, 28672
  s_add_u32 s26, s26, 28672
  buffer_load_dwordx4 v[80:83], v117, s[8:11], s24 offen offset:0 sc1
  buffer_load_dwordx4 v[84:87], v117, s[8:11], s24 offen offset:1024 sc1
  v_mov_b32 v72, 0
  v_mov_b32 v73, 0
  v_mfma_f32_32x32x16_bf16 v[36:51], v[68:71], v[68:71], 0
  s_waitcnt lgkmcnt(0)
  s_barrier
  ds_read_b64 v[8:9], v114 offset:0
  ds_read_b64 v[10:11], v114 offset:1024
  ds_read_b64 v[12:13], v114 offset:2048
  ds_read_b64 v[14:15], v114 offset:3072
  ds_read2_b32 v[16:17], v115 offset0:0 offset1:64
  ds_read2_b32 v[18:19], v115 offset0:128 offset1:192
  v_mfma_f32_32x32x16_bf16 v[52:67], v[68:71], v[68:71], 0
  s_waitcnt lgkmcnt(0)
  v_pk_add_f32 v[16:17], v[16:17], v[18:19]
  v_pk_add_f32 v[8:9], v[8:9], v[10:11]
  v_pk_add_f32 v[12:13], v[12:13], v[14:15]
  v_add_f32 v20, v16, v17
  v_pk_add_f32 v[8:9], v[8:9], v[12:13]
  v_max_f32 v22, v8, v9
  v_add_f32_dpp v20, v20, v20 row_ror:8 row_mask:0xf bank_mask:0xf
  s_nop 0
  v_max_f32_dpp v22, v22, v22 row_ror:8 row_mask:0xf bank_mask:0xf
  v_max_f32 v22, v22, v20
  s_nop 1
  v_max_f32_dpp v22, v22, v22 quad_perm:[1,0,3,2] row_mask:0xf bank_mask:0xf
  s_nop 1
  v_max_f32_dpp v22, v22, v22 quad_perm:[2,3,0,1] row_mask:0xf bank_mask:0xf
  s_nop 1
  v_max_f32_dpp v22, v22, v22 row_half_mirror row_mask:0xf bank_mask:0xf
  v_pk_add_f32 v[8:9], v[8:9], v[22:23] op_sel_hi:[1,0] neg_lo:[0,1] neg_hi:[0,1]
  v_sub_f32 v20, v20, v22
  v_exp_f32 v8, v8
  v_exp_f32 v9, v9
  v_exp_f32 v20, v20
  v_add_f32 v24, v8, v9
  v_fmac_f32 v24, 0.5, v20
  v_mov_b32_dpp v21, v20 quad_perm:[1,0,3,2] row_mask:0xf bank_mask:0xf
  s_nop 0
  v_add_f32_dpp v24, v24, v24 quad_perm:[1,0,3,2] row_mask:0xf bank_mask:0xf
  s_nop 1
  v_add_f32_dpp v24, v24, v24 quad_perm:[2,3,0,1] row_mask:0xf bank_mask:0xf
  s_nop 1
  v_add_f32_dpp v24, v24, v24 row_half_mirror row_mask:0xf bank_mask:0xf
  s_nop 1
  v_add_f32_dpp v24, v24, v24 row_ror:8 row_mask:0xf bank_mask:0xf
  v_rcp_f32 v24, v24
  s_nop 0
  v_pk_mul_f32 v[8:9], v[8:9], v[24:25] op_sel_hi:[1,0]
  v_cvt_pk_bf16_f32 v8, abs(v8), abs(v9)
  buffer_store_dword v8, v1, s[8:11], s20 offen sc1
  v_pk_mul_f32 v[20:21], v[20:21], v[24:25] op_sel_hi:[1,0]
  v_cvt_pk_bf16_f32 v20, abs(v20), abs(v21)
  buffer_store_dword v20, v118, s[8:11], s20 offen sc1
  v_mov_b32 v74, 0
  v_mov_b32 v75, 0
  s_mov_b32 s19, s18
  s_add_u32 s18, s18, 1
  s_mov_b32 s22, s20
  s_mov_b32 s20, s21
  s_mov_b32 s21, s22
  s_add_u32 s23, s20, 4096
  s_cmp_lt_u32 s19, 63
  s_cbranch_scc1 cB_sc0_loop
  s_branch cB_done
cB_sc0_r0:
  s_add_u32 s31, s31, 1
  buffer_load_dwordx4 v[8:11], v2, s[8:11], s20 offen offset:0 sc1
  s_waitcnt vmcnt(0)
  v_cmp_eq_u32 vcc, -1, v8
  v_mov_b32 v36, 0
  v_mov_b32 v37, 0
  v_mov_b32 v38, 0
  v_mov_b32 v39, 0
  v_mov_b32 v40, 0
  v_mov_b32 v41, 0
  v_mov_b32 v42, 0
  v_mov_b32 v43, 0
  v_mov_b32 v44, 0
  v_mov_b32 v45, 0
  v_mov_b32 v46, 0
  v_mov_b32 v47, 0
  v_mov_b32 v48, 0
  v_mov_b32 v49, 0
  v_mov_b32 v50, 0
  v_mov_b32 v51, 0
  s_nop 1
  s_cbranch_vccz cB_sc0_go
  s_add_u32 s30, s30, 1
  s_cmp_lt_u32 s30, 400000
  s_cbranch_scc1 cB_sc0_r0
  s_branch cB_abort
cB_sc0_r1:
  s_add_u32 s31, s31, 1
  buffer_load_dwordx4 v[12:15], v2, s[8:11], s20 offen offset:1024 sc1
  s_waitcnt vmcnt(0)
  v_cmp_eq_u32 vcc, -1, v12
  s_nop 4
  s_cbranch_vccz cB_sc0_c1
  s_add_u32 s30, s30, 1
  s_cmp_lt_u32 s30, 400000
  s_cbranch_scc1 cB_sc0_r1
  s_branch cB_abort
cB_sc0_r2:
  s_add_u32 s31, s31, 1
  buffer_load_dwordx4 v[16:19], v2, s[8:11], s20 offen offset:2048 sc1
  s_waitcnt vmcnt(0)
  v_cmp_eq_u32 vcc, -1, v16
  s_nop 4
  s_cbranch_vccz cB_sc0_c2
  s_add_u32 s30, s30, 1
  s_cmp_lt_u32 s30, 400000
  s_cbranch_scc1 cB_sc0_r2
  s_branch cB_abort
cB_sc0_r3:
  s_add_u32 s31, s31, 1
  buffer_load_dwordx4 v[20:23], v2, s[8:11], s20 offen offset:3072 sc1
  s_waitcnt vmcnt(0)
  v_cmp_eq_u32 vcc, -1, v20
  s_nop 4
  s_cbranch_vccz cB_sc0_c3
  s_add_u32 s30, s30, 1
  s_cmp_lt_u32 s30, 400000
  s_cbranch_scc1 cB_sc0_r3
  s_branch cB_abort
cB_sc0_r4:
  s_add_u32 s31, s31, 1
  buffer_load_dwordx4 v[32:35], v2, s[8:11], s23 offen offset:0 sc1
  buffer_load_dwordx4 v[24:27], v2, s[8:11], s23 offen offset:1024 sc1
  buffer_load_dwordx4 v[28:31], v2, s[8:11], s23 offen offset:2048 sc1
  s_waitcnt vmcnt(0)
  v_max3_u32 v66, v24, v27, v28
  v_max3_u32 v66, v66, v31, v32
  v_max_u32 v66, v66, v35
  v_cmp_eq_u32 vcc, -1, v66
  s_nop 4
  s_cbranch_vccz cB_sc0_c4
  s_add_u32 s30, s30, 1
  s_cmp_lt_u32 s30, 400000
  s_cbranch_scc1 cB_sc0_r4
  s_branch cB_abort
cB_sc0_retry:
  s_cmp_lg_u32 s62, 0
  s_cbranch_scc1 cB_sc0_cont
  s_waitcnt vmcnt(0) lgkmcnt(0)
cB_sc0_rv:
  buffer_load_dwordx4 v[8:11], v2, s[8:11], s20 offen offset:0 sc1
  buffer_load_dwordx4 v[12:15], v2, s[8:11], s20 offen offset:1024 sc1
  buffer_load_dwordx4 v[16:19], v2, s[8:11], s20 offen offset:2048 sc1
  buffer_load_dwordx4 v[20:23], v2, s[8:11], s20 offen offset:3072 sc1
  buffer_load_dwordx4 v[32:35], v2, s[8:11], s23 offen offset:0 sc1
  buffer_load_dwordx4 v[24:27], v2, s[8:11], s23 offen offset:1024 sc1
  buffer_load_dwordx4 v[28:31], v2, s[8:11], s23 offen offset:2048 sc1
  s_waitcnt vmcnt(0)
  v_max3_u32 v66, v8, v9, v10
  v_max3_u32 v66, v66, v11, v12
  v_max3_u32 v66, v66, v13, v14
  v_max3_u32 v66, v66, v15, v16
  v_max3_u32 v66, v66, v17, v18
  v_max3_u32 v66, v66, v19, v20
  v_max3_u32 v66, v66, v21, v22
  v_max3_u32 v66, v66, v23, v24
  v_max3_u32 v66, v66, v25, v26
  v_max3_u32 v66, v66, v27, v28
  v_max3_u32 v66, v66, v29, v30
  v_max3_u32 v66, v66, v31, v32
  v_max3_u32 v66, v66, v33, v34
  v_max_u32 v66, v66, v35
  v_cmp_eq_u32 vcc, -1, v66
  s_cbranch_vccz cB_sc0_rk
  s_add_u32 s30, s30, 1
  s_cmp_lt_u32 s30, 400000
  s_cbranch_scc1 cB_sc0_rv
  s_branch cB_abort
cB_sc0_rk:
  s_mov_b32 s62, 1
  v_mov_b32 v36, 0
  v_mov_b32 v37, 0
  v_mov_b32 v38, 0
  v_mov_b32 v39, 0
  v_mov_b32 v40, 0
  v_mov_b32 v41, 0
  v_mov_b32 v42, 0
  v_mov_b32 v43, 0
  v_mov_b32 v44, 0
  v_mov_b32 v45, 0
  v_mov_b32 v46, 0
  v_mov_b32 v47, 0
  v_mov_b32 v48, 0
  v_mov_b32 v49, 0
  v_mov_b32 v50, 0
  v_mov_b32 v51, 0
  v_mov_b32 v60, 0
  v_mov_b32 v61, 0
  v_mov_b32 v62, 0
  v_mov_b32 v63, 0
  v_mov_b32 v68, 0
  v_mov_b32 v69, 0
  v_mov_b32 v70, 0
  v_mov_b32 v71, 0
  v_mov_b32 v72, 0
  v_mov_b32 v73, 0
  v_mov_b32 v74, 0
  v_mov_b32 v75, 0
  v_mov_b32 v52, 0
  v_mov_b32 v53, 0
  v_mov_b32 v54, 0
  v_mov_b32 v55, 0
  v_mov_b32 v56, 0
  v_mov_b32 v57, 0
  v_mov_b32 v58, 0
  v_mov_b32 v59, 0
  s_add_u32 s31, s31, 0x100
  s_nop 0
  s_branch cB_sc0_go
.p2align 6
cB_sc1_loop:
  s_mov_b32 s30, 0
  s_mov_b32 s62, 0
  s_setprio 3
  s_barrier
  buffer_load_dwordx4 v[8:11], v2, s[8:11], s20 offen offset:0 sc1
  s_setprio 2
  buffer_load_dwordx4 v[12:15], v2, s[8:11], s20 offen offset:1024 sc1
  s_setprio 1
  buffer_load_dwordx4 v[16:19], v2, s[8:11], s20 offen offset:2048 sc1
  s_setprio 0
  buffer_load_dwordx4 v[20:23], v2, s[8:11], s20 offen offset:3072 sc1
cB_sc1_go:
  s_waitcnt vmcnt(3)
  v_smfmac_f32_16x16x64_bf16 v[36:39], v[8:11], a[0:7], v3
  buffer_load_dwordx4 v[28:31], v2, s[8:11], s23 offen offset:0 sc1
  v_cmp_eq_u32 vcc, -1, v8
  v_smfmac_f32_16x16x64_bf16 v[40:43], v[8:11], a[56:63], v3
  v_smfmac_f32_16x16x64_bf16 v[44:47], v[8:11], a[112:119], v3
  buffer_load_dwordx4 v[24:27], v2, s[8:11], s23 offen offset:1024 sc1
  s_cbranch_vccnz cB_sc1_r0
  v_smfmac_f32_16x16x64_bf16 v[48:51], v[8:11], a[168:175], v3
  v_smfmac_f32_16x16x64_bf16 v[52:55], v[8:11], a[224:231], v3
  s_waitcnt vmcnt(4)
  v_cmp_eq_u32 vcc, -1, v12
  v_smfmac_f32_16x16x64_bf16 v[56:59], v[8:11], v[144:151], v3
  buffer_load_dwordx4 v[32:35], v2, s[8:11], s23 offen offset:2048 sc1
  v_smfmac_f32_16x16x64_bf16 v[60:63], v[8:11], v[200:207], v3
  s_cbranch_vccnz cB_sc1_r1
cB_sc1_c1:
  v_smfmac_f32_16x16x64_bf16 v[36:39], v[12:15], a[8:15], v3
  v_smfmac_f32_16x16x64_bf16 v[40:43], v[12:15], a[64:71], v3
  v_smfmac_f32_16x16x64_bf16 v[44:47], v[12:15], a[120:127], v3
  v_smfmac_f32_16x16x64_bf16 v[48:51], v[12:15], a[176:183], v3
  v_smfmac_f32_16x16x64_bf16 v[52:55], v[12:15], a[232:239], v3
  s_waitcnt vmcnt(4)
  v_cmp_eq_u32 vcc, -1, v16
  v_smfmac_f32_16x16x64_bf16 v[56:59], v[12:15], v[152:159], v3
  buffer_load_dwordx4 v[88:91], v117, s[8:11], s26 offen offset:0 sc1
  v_smfmac_f32_16x16x64_bf16 v[60:63], v[12:15], v[208:215], v3
  s_cbranch_vccnz cB_sc1_r2
cB_sc1_c2:
  v_smfmac_f32_16x16x64_bf16 v[36:39], v[16:19], a[16:23], v3
  v_smfmac_f32_16x16x64_bf16 v[40:43], v[16:19], a[72:79], v3
  v_smfmac_f32_16x16x64_bf16 v[44:47], v[16:19], a[128:135], v3
  buffer_load_dwordx4 v[92:95], v117, s[8:11], s26 offen offset:1024 sc1
  v_smfmac_f32_16x16x64_bf16 v[48:51], v[16:19], a[184:191], v3
  v_smfmac_f32_16x16x64_bf16 v[52:55], v[16:19], a[240:247], v3
  s_waitcnt vmcnt(5)
  v_cmp_eq_u32 vcc, -1, v20
  v_smfmac_f32_16x16x64_bf16 v[56:59], v[16:19], v[160:167], v3
  v_smfmac_f32_16x16x64_bf16 v[60:63], v[16:19], v[216:223], v3
  buffer_load_dwordx4 v[96:99], v2, s[8:11], s24 offen offset:0 sc1
  s_cbranch_vccnz cB_sc1_r3
cB_sc1_c3:
  v_smfmac_f32_16x16x64_bf16 v[36:39], v[20:23], a[24:31], v3
  v_smfmac_f32_16x16x64_bf16 v[40:43], v[20:23], a[80:87], v3
  s_waitcnt vmcnt(3)
  v_max3_u32 v66, v24, v27, v28
  v_smfmac_f32_16x16x64_bf16 v[44:47], v[20:23], a[136:143], v3
  v_max3_u32 v66, v66, v31, v32
  v_smfmac_f32_16x16x64_bf16 v[48:51], v[20:23], a[192:199], v3
  buffer_load_dwordx4 v[100:103], v2, s[8:11], s24 offen offset:1024 sc1
  v_max_u32 v66, v66, v35
  v_smfmac_f32_16x16x64_bf16 v[52:55], v[20:23], a[248:255], v3
  v_cmp_eq_u32 vcc, -1, v66
  v_smfmac_f32_16x16x64_bf16 v[56:59], v[20:23], v[168:175], v3
  v_smfmac_f32_16x16x64_bf16 v[60:63], v[20:23], v[224:231], v3
  s_cbranch_vccnz cB_sc1_r4
cB_sc1_c4:
  v_smfmac_f32_16x16x64_bf16 v[60:63], v[28:31], v[232:239], v3
  buffer_load_dwordx4 v[104:107], v2, s[8:11], s26 offen offset:0 sc1
  v_smfmac_f32_16x16x64_bf16 v[60:63], v[24:27], v[240:247], v3
  v_smfmac_f32_16x16x64_bf16 v[60:63], v[32:35], v[248:255], v3
  v_smfmac_f32_16x16x64_bf16 v[52:55], v[28:31], v[120:127], v3
  v_smfmac_f32_16x16x64_bf16 v[52:55], v[24:27], v[128:135], v3
  buffer_load_dwordx4 v[108:111], v2, s[8:11], s26 offen offset:1024 sc1
  v_smfmac_f32_16x16x64_bf16 v[52:55], v[32:35], v[136:143], v3
  v_cvt_pk_bf16_f32 v63, v62, v63
  v_smfmac_f32_16x16x64_bf16 v[56:59], v[28:31], v[176:183], v3
  v_cvt_pk_bf16_f32 v62, v60, v61
  v_smfmac_f32_16x16x64_bf16 v[56:59], v[24:27], v[184:191], v3
  v_mfma_f32_16x16x32_bf16 v[8:11], v[62:65], v[4:7], 0
  v_cvt_pk_bf16_f32 v55, v54, v55
  v_smfmac_f32_16x16x64_bf16 v[56:59], v[32:35], v[192:199], v3
  v_cvt_pk_bf16_f32 v54, v52, v53
  v_smfmac_f32_16x16x64_bf16 v[36:39], v[28:31], a[32:39], v3
  s_nop 1
  v_cvt_pk_bf16_f32 v78, v8, v9
  v_smfmac_f32_16x16x64_bf16 v[36:39], v[24:27], a[40:47], v3
  v_cvt_pk_bf16_f32 v79, v10, v11
  v_smfmac_f32_16x16x64_bf16 v[36:39], v[32:35], a[48:55], v3
  v_cvt_pk_bf16_f32 v56, v56, v57
  v_smfmac_f32_16x16x64_bf16 v[40:43], v[28:31], a[88:95], v3
  v_cvt_pk_bf16_f32 v57, v58, v59
  v_smfmac_f32_16x16x64_bf16 v[40:43], v[24:27], a[96:103], v3
  v_mfma_f32_16x16x32_bf16 v[16:19], v[54:57], v[4:7], 0
  v_cvt_pk_bf16_f32 v39, v38, v39
  v_smfmac_f32_16x16x64_bf16 v[40:43], v[32:35], a[104:111], v3
  v_cvt_pk_bf16_f32 v38, v36, v37
  v_smfmac_f32_16x16x64_bf16 v[44:47], v[28:31], a[144:151], v3
  s_nop 1
  v_cvt_pk_bf16_f32 v76, v16, v17
  v_smfmac_f32_16x16x64_bf16 v[44:47], v[24:27], a[152:159], v3
  v_cvt_pk_bf16_f32 v77, v18, v19
  v_smfmac_f32_16x16x64_bf16 v[44:47], v[32:35], a[160:167], v3
  v_cvt_pk_bf16_f32 v40, v40, v41
  v_smfmac_f32_16x16x64_bf16 v[48:51], v[28:31], a[200:207], v3
  v_cvt_pk_bf16_f32 v41, v42, v43
  v_smfmac_f32_16x16x64_bf16 v[48:51], v[24:27], a[208:215], v3
  v_smfmac_f32_16x16x64_bf16 v[48:51], v[32:35], a[216:223], v3
  s_waitcnt vmcnt(4)
  v_cvt_pk_bf16_f32 v47, v46, v47
  v_smfmac_f32_16x16x64_bf16 v[68:71], v[76:79], v[80:87], v3
  v_cvt_pk_bf16_f32 v46, v44, v45
  v_mfma_f32_16x16x32_bf16 v[8:11], v[38:41], v[4:7], 0
  s_nop 1
  v_cvt_pk_bf16_f32 v48, v48, v49
  v_cvt_pk_bf16_f32 v49, v50, v51
  s_nop 1
  v_mfma_f32_16x16x32_bf16 v[16:19], v[46:49], v[4:7], 0
  v_smfmac_f32_16x16x64_bf16 v[72:75], v[76:79], v[88:95], v3
  v_cvt_pk_bf16_f32 v20, v8, v9
  v_mfma_f32_16x16x32_bf16 v[52:55], v[30:33], v[76:79], 0
  s_waitcnt vmcnt(0)
  v_cvt_pk_bf16_f32 v21, v10, v11
  v_cvt_pk_bf16_f32 v22, v16, v17
  v_cvt_pk_bf16_f32 v23, v18, v19
  s_nop 1
  v_mfma_f32_16x16x32_bf16 v[52:55], v[12:15], v[20:23], v[52:55]
  v_smfmac_f32_16x16x64_bf16 v[68:71], v[20:23], v[96:103], v3
  v_smfmac_f32_16x16x64_bf16 v[72:75], v[20:23], v[104:111], v3
  s_nop 1
  ds_write_b128 v113, v[52:55]
  s_nop 1
  v_permlane32_swap_b32 v68, v70
  v_permlane32_swap_b32 v69, v71
  v_add_f32 v56, v68, v70
  v_add_f32 v58, v69, v71
  v_permlane32_swap_b32 v72, v74
  v_permlane32_swap_b32 v73, v75
  v_add_f32 v57, v72, v74
  v_add_f32 v59, v73, v75
  ds_write_b128 v2, v[56:59] offset:1024
  v_cmp_u_f32 vcc, v57, v59
  v_mov_b32 v68, 0
  v_mov_b32 v69, 0
  v_mov_b32 v70, 0
  v_mov_b32 v71, 0
  s_cbranch_vccnz cB_sc1_retry
cB_sc1_cont:
  s_add_u32 s24, s24, 28672
  s_add_u32 s26, s26, 28672
  buffer_load_dwordx4 v[80:83], v117, s[8:11], s24 offen offset:0 sc1
  buffer_load_dwordx4 v[84:87], v117, s[8:11], s24 offen offset:1024 sc1
  v_mov_b32 v72, 0
  v_mov_b32 v73, 0
  v_mfma_f32_32x32x16_bf16 v[36:51], v[68:71], v[68:71], 0
  s_waitcnt lgkmcnt(0)
  s_barrier
  ds_read_b64 v[8:9], v114 offset:0
  ds_read_b64 v[10:11], v114 offset:1024
  ds_read_b64 v[12:13], v114 offset:2048
  ds_read_b64 v[14:15], v114 offset:3072
  ds_read2_b32 v[16:17], v115 offset0:0 offset1:64
  ds_read2_b32 v[18:19], v115 offset0:128 offset1:192
  v_mfma_f32_32x32x16_bf16 v[52:67], v[68:71], v[68:71], 0
  s_waitcnt lgkmcnt(0)
  v_pk_add_f32 v[16:17], v[16:17], v[18:19]
  v_pk_add_f32 v[8:9], v[8:9], v[10:11]
  v_pk_add_f32 v[12:13], v[12:13], v[14:15]
  v_add_f32 v20, v16, v17
  v_pk_add_f32 v[8:9], v[8:9], v[12:13]
  v_max_f32 v22, v8, v9
  v_add_f32_dpp v20, v20, v20 row_ror:8 row_mask:0xf bank_mask:0xf
  s_nop 0
  v_max_f32_dpp v22, v22, v22 row_ror:8 row_mask:0xf bank_mask:0xf
  v_max_f32 v22, v22, v20
  buffer_store_dword v112, v116, s[8:11], 0 offen sc1
  s_nop 0
  v_max_f32_dpp v22, v22, v22 quad_perm:[1,0,3,2] row_mask:0xf bank_mask:0xf
  s_nop 1
  v_max_f32_dpp v22, v22, v22 quad_perm:[2,3,0,1] row_mask:0xf bank_mask:0xf
  s_nop 1
  v_max_f32_dpp v22, v22, v22 row_half_mirror row_mask:0xf bank_mask:0xf
  v_pk_add_f32 v[8:9], v[8:9], v[22:23] op_sel_hi:[1,0] neg_lo:[0,1] neg_hi:[0,1]
  v_sub_f32 v20, v20, v22
  v_exp_f32 v8, v8
  v_exp_f32 v9, v9
  v_exp_f32 v20, v20
  v_add_f32 v24, v8, v9
  v_fmac_f32 v24, 0.5, v20
  v_mov_b32_dpp v21, v20 quad_perm:[1,0,3,2] row_mask:0xf bank_mask:0xf
  s_nop 0
  v_add_f32_dpp v24, v24, v24 quad_perm:[1,0,3,2] row_mask:0xf bank_mask:0xf
  s_nop 1
  v_add_f32_dpp v24, v24, v24 quad_perm:[2,3,0,1] row_mask:0xf bank_mask:0xf
  s_nop 1
  v_add_f32_dpp v24, v24, v24 row_half_mirror row_mask:0xf bank_mask:0xf
  s_nop 1
  v_add_f32_dpp v24, v24, v24 row_ror:8 row_mask:0xf bank_mask:0xf
  v_rcp_f32 v24, v24
  s_nop 0
  v_pk_mul_f32 v[8:9], v[8:9], v[24:25] op_sel_hi:[1,0]
  v_cvt_pk_bf16_f32 v8, abs(v8), abs(v9)
  buffer_store_dword v8, v1, s[8:11], s20 offen sc1
  v_pk_mul_f32 v[20:21], v[20:21], v[24:25] op_sel_hi:[1,0]
  v_cvt_pk_bf16_f32 v20, abs(v20), abs(v21)
  buffer_store_dword v20, v118, s[8:11], s20 offen sc1
  v_mov_b32 v74, 0
  v_mov_b32 v75, 0
  s_mov_b32 s19, s18
  s_add_u32 s18, s18, 1
  s_mov_b32 s22, s20
  s_mov_b32 s20, s21
  s_mov_b32 s21, s22
  s_add_u32 s23, s20, 4096
  v_mov_b32 v112, s18
  s_cmp_lt_u32 s19, 63
  s_nop 0
  s_cbranch_scc1 cB_sc1_loop
  s_branch cB_done
cB_sc1_r0:
  s_add_u32 s31, s31, 1
  buffer_load_dwordx4 v[8:11], v2, s[8:11], s20 offen offset:0 sc1
  s_waitcnt vmcnt(0)
  v_cmp_eq_u32 vcc, -1, v8
  v_mov_b32 v36, 0
  v_mov_b32 v37, 0
  v_mov_b32 v38, 0
  v_mov_b32 v39, 0
  v_mov_b32 v40, 0
  v_mov_b32 v41, 0
  v_mov_b32 v42, 0
  v_mov_b32 v43, 0
  v_mov_b32 v44, 0
  v_mov_b32 v45, 0
  v_mov_b32 v46, 0
  v_mov_b32 v47, 0
  v_mov_b32 v48, 0
  v_mov_b32 v49, 0
  v_mov_b32 v50, 0
  v_mov_b32 v51, 0
  s_nop 1
  s_cbranch_vccz cB_sc1_go
  s_add_u32 s30, s30, 1
  s_cmp_lt_u32 s30, 400000
  s_cbranch_scc1 cB_sc1_r0
  s_branch cB_abort
cB_sc1_r1:
  s_add_u32 s31, s31, 1
  buffer_load_dwordx4 v[12:15], v2, s[8:11], s20 offen offset:1024 sc1
  s_waitcnt vmcnt(0)
  v_cmp_eq_u32 vcc, -1, v12
  s_nop 4
  s_cbranch_vccz cB_sc1_c1
  s_add_u32 s30, s30, 1
  s_cmp_lt_u32 s30, 400000
  s_cbranch_scc1 cB_sc1_r1
  s_branch cB_abort
cB_sc1_r2:
  s_add_u32 s31, s31, 1
  buffer_load_dwordx4 v[16:19], v2, s[8:11], s20 offen offset:2048 sc1
  s_waitcnt vmcnt(0)
  v_cmp_eq_u32 vcc, -1, v16
  s_nop 4
  s_cbranch_vccz cB_sc1_c2
  s_add_u32 s30, s30, 1
  s_cmp_lt_u32 s30, 400000
  s_cbranch_scc1 cB_sc1_r2
  s_branch cB_abort
cB_sc1_r3:
  s_add_u32 s31, s31, 1
  buffer_load_dwordx4 v[20:23], v2, s[8:11], s20 offen offset:3072 sc1
  s_waitcnt vmcnt(0)
  v_cmp_eq_u32 vcc, -1, v20
  s_nop 4
  s_cbranch_vccz cB_sc1_c3
  s_add_u32 s30, s30, 1
  s_cmp_lt_u32 s30, 400000
  s_cbranch_scc1 cB_sc1_r3
  s_branch cB_abort
cB_sc1_r4:
  s_add_u32 s31, s31, 1
  buffer_load_dwordx4 v[28:31], v2, s[8:11], s23 offen offset:0 sc1
  buffer_load_dwordx4 v[24:27], v2, s[8:11], s23 offen offset:1024 sc1
  buffer_load_dwordx4 v[32:35], v2, s[8:11], s23 offen offset:2048 sc1
  s_waitcnt vmcnt(0)
  v_max3_u32 v66, v24, v27, v28
  v_max3_u32 v66, v66, v31, v32
  v_max_u32 v66, v66, v35
  v_cmp_eq_u32 vcc, -1, v66
  s_nop 4
  s_cbranch_vccz cB_sc1_c4
  s_add_u32 s30, s30, 1
  s_cmp_lt_u32 s30, 400000
  s_cbranch_scc1 cB_sc1_r4
  s_branch cB_abort
cB_sc1_retry:
  s_cmp_lg_u32 s62, 0
  s_cbranch_scc1 cB_sc1_cont
  s_waitcnt vmcnt(0) lgkmcnt(0)
cB_sc1_rv:
  buffer_load_dwordx4 v[8:11], v2, s[8:11], s20 offen offset:0 sc1
  buffer_load_dwordx4 v[12:15], v2, s[8:11], s20 offen offset:1024 sc1
  buffer_load_dwordx4 v[16:19], v2, s[8:11], s20 offen offset:2048 sc1
  buffer_load_dwordx4 v[20:23], v2, s[8:11], s20 offen offset:3072 sc1
  buffer_load_dwordx4 v[28:31], v2, s[8:11], s23 offen offset:0 sc1
  buffer_load_dwordx4 v[24:27], v2, s[8:11], s23 offen offset:1024 sc1
  buffer_load_dwordx4 v[32:35], v2, s[8:11], s23 offen offset:2048 sc1
  s_waitcnt vmcnt(0)
  v_max3_u32 v66, v8, v9, v10
  v_max3_u32 v66, v66, v11, v12
  v_max3_u32 v66, v66, v13, v14
  v_max3_u32 v66, v66, v15, v16
  v_max3_u32 v66, v66, v17, v18
  v_max3_u32 v66, v66, v19, v20
  v_max3_u32 v66, v66, v21, v22
  v_max3_u32 v66, v66, v23, v24
  v_max3_u32 v66, v66, v25, v26
  v_max3_u32 v66, v66, v27, v28
  v_max3_u32 v66, v66, v29, v30
  v_max3_u32 v66, v66, v31, v32
  v_max3_u32 v66, v66, v33, v34
  v_max_u32 v66, v66, v35
  v_cmp_eq_u32 vcc, -1, v66
  s_cbranch_vccz cB_sc1_rk
  s_add_u32 s30, s30, 1
  s_cmp_lt_u32 s30, 400000
  s_cbranch_scc1 cB_sc1_rv
  s_branch cB_abort
cB_sc1_rk:
  s_mov_b32 s62, 1
  v_mov_b32 v36, 0
  v_mov_b32 v37, 0
  v_mov_b32 v38, 0
  v_mov_b32 v39, 0
  v_mov_b32 v40, 0
  v_mov_b32 v41, 0
  v_mov_b32 v42, 0
  v_mov_b32 v43, 0
  v_mov_b32 v44, 0
  v_mov_b32 v45, 0
  v_mov_b32 v46, 0
  v_mov_b32 v47, 0
  v_mov_b32 v48, 0
  v_mov_b32 v49, 0
  v_mov_b32 v50, 0
  v_mov_b32 v51, 0
  v_mov_b32 v60, 0
  v_mov_b32 v61, 0
  v_mov_b32 v62, 0
  v_mov_b32 v63, 0
  v_mov_b32 v68, 0
  v_mov_b32 v69, 0
  v_mov_b32 v70, 0
  v_mov_b32 v71, 0
  v_mov_b32 v72, 0
  v_mov_b32 v73, 0
  v_mov_b32 v74, 0
  v_mov_b32 v75, 0
  v_mov_b32 v52, 0
  v_mov_b32 v53, 0
  v_mov_b32 v54, 0
  v_mov_b32 v55, 0
  v_mov_b32 v56, 0
  v_mov_b32 v57, 0
  v_mov_b32 v58, 0
  v_mov_b32 v59, 0
  s_add_u32 s31, s31, 0x100
  s_nop 0
  s_branch cB_sc1_go
.p2align 6
cB_sc2_loop:
  s_mov_b32 s30, 0
  s_mov_b32 s62, 0
  s_setprio 3
  s_barrier
  buffer_load_dwordx4 v[8:11], v2, s[8:11], s20 offen offset:0 sc1
  s_setprio 2
  buffer_load_dwordx4 v[12:15], v2, s[8:11], s20 offen offset:1024 sc1
  s_setprio 1
  buffer_load_dwordx4 v[16:19], v2, s[8:11], s20 offen offset:2048 sc1
  s_setprio 0
  buffer_load_dwordx4 v[20:23], v2, s[8:11], s20 offen offset:3072 sc1
cB_sc2_go:
  s_waitcnt vmcnt(3)
  v_smfmac_f32_16x16x64_bf16 v[36:39], v[8:11], a[0:7], v3
  buffer_load_dwordx4 v[24:27], v2, s[8:11], s23 offen offset:0 sc1
  v_cmp_eq_u32 vcc, -1, v8
  v_smfmac_f32_16x16x64_bf16 v[40:43], v[8:11], a[56:63], v3
  v_smfmac_f32_16x16x64_bf16 v[44:47], v[8:11], a[112:119], v3
  buffer_load_dwordx4 v[32:35], v2, s[8:11], s23 offen offset:1024 sc1
  s_cbranch_vccnz cB_sc2_r0
  v_smfmac_f32_16x16x64_bf16 v[48:51], v[8:11], a[168:175], v3
  v_smfmac_f32_16x16x64_bf16 v[52:55], v[8:11], a[224:231], v3
  s_waitcnt vmcnt(4)
  v_cmp_eq_u32 vcc, -1, v12
  v_smfmac_f32_16x16x64_bf16 v[56:59], v[8:11], v[144:151], v3
  buffer_load_dwordx4 v[28:31], v2, s[8:11], s23 offen offset:2048 sc1
  v_smfmac_f32_16x16x64_bf16 v[62:65], v[8:11], v[200:207], v3
  s_cbranch_vccnz cB_sc2_r1
cB_sc2_c1:
  v_smfmac_f32_16x16x64_bf16 v[36:39], v[12:15], a[8:15], v3
  v_smfmac_f32_16x16x64_bf16 v[40:43], v[12:15], a[64:71], v3
  v_smfmac_f32_16x16x64_bf16 v[44:47], v[12:15], a[120:127], v3
  v_smfmac_f32_16x16x64_bf16 v[48:51], v[12:15], a[176:183], v3
  v_smfmac_f32_16x16x64_bf16 v[52:55], v[12:15], a[232:239], v3
  s_waitcnt vmcnt(4)
  v_cmp_eq_u32 vcc, -1, v16
  v_smfmac_f32_16x16x64_bf16 v[56:59], v[12:15], v[152:159], v3
  buffer_load_dwordx4 v[88:91], v117, s[8:11], s26 offen offset:0 sc1
  v_smfmac_f32_16x16x64_bf16 v[62:65], v[12:15], v[208:215], v3
  s_cbranch_vccnz cB_sc2_r2
cB_sc2_c2:
  v_smfmac_f32_16x16x64_bf16 v[36:39], v[16:19], a[16:23], v3
  v_smfmac_f32_16x16x64_bf16 v[40:43], v[16:19], a[72:79], v3
  v_smfmac_f32_16x16x64_bf16 v[44:47], v[16:19], a[128:135], v3
  buffer_load_dwordx4 v[92:95], v117, s[8:11], s26 offen offset:1024 sc1
  v_smfmac_f32_16x16x64_bf16 v[48:51], v[16:19], a[184:191], v3
  v_smfmac_f32_16x16x64_bf16 v[52:55], v[16:19], a[240:247], v3
  s_waitcnt vmcnt(5)
  v_cmp_eq_u32 vcc, -1, v20
  v_smfmac_f32_16x16x64_bf16 v[56:59], v[16:19], v[160:167], v3
  v_smfmac_f32_16x16x64_bf16 v[62:65], v[16:19], v[216:223], v3
  buffer_load_dwordx4 v[96:99], v2, s[8:11], s24 offen offset:0 sc1
  s_cbranch_vccnz cB_sc2_r3
cB_sc2_c3:
  v_smfmac_f32_16x16x64_bf16 v[36:39], v[20:23], a[24:31], v3
  v_smfmac_f32_16x16x64_bf16 v[40:43], v[20:23], a[80:87], v3
  s_waitcnt vmcnt(3)
  v_max3_u32 v66, v24, v27, v28
  v_smfmac_f32_16x16x64_bf16 v[44:47], v[20:23], a[136:143], v3
  v_max3_u32 v66, v66, v31, v32
  v_smfmac_f32_16x16x64_bf16 v[48:51], v[20:23], a[192:199], v3
  buffer_load_dwordx4 v[100:103], v2, s[8:11], s24 offen offset:1024 sc1
  v_max_u32 v66, v66, v35
  v_smfmac_f32_16x16x64_bf16 v[52:55], v[20:23], a[248:255], v3
  v_cmp_eq_u32 vcc, -1, v66
  v_smfmac_f32_16x16x64_bf16 v[56:59], v[20:23], v[168:175], v3
  v_smfmac_f32_16x16x64_bf16 v[62:65], v[20:23], v[224:231], v3
  s_cbranch_vccnz cB_sc2_r4
cB_sc2_c4:
  v_smfmac_f32_16x16x64_bf16 v[62:65], v[24:27], v[232:239], v3
  buffer_load_dwordx4 v[104:107], v2, s[8:11], s26 offen offset:0 sc1
  v_smfmac_f32_16x16x64_bf16 v[62:65], v[32:35], v[240:247], v3
  v_smfmac_f32_16x16x64_bf16 v[62:65], v[28:31], v[248:255], v3
  v_smfmac_f32_16x16x64_bf16 v[52:55], v[24:27], v[120:127], v3
  v_smfmac_f32_16x16x64_bf16 v[52:55], v[32:35], v[128:135], v3
  buffer_load_dwordx4 v[108:111], v2, s[8:11], s26 offen offset:1024 sc1
  v_smfmac_f32_16x16x64_bf16 v[52:55], v[28:31], v[136:143], v3
  v_cvt_pk_bf16_f32 v62, v62, v63
  v_smfmac_f32_16x16x64_bf16 v[56:59], v[24:27], v[176:183], v3
  v_cvt_pk_bf16_f32 v63, v64, v65
  v_smfmac_f32_16x16x64_bf16 v[56:59], v[32:35], v[184:191], v3
  v_mfma_f32_16x16x32_bf16 v[8:11], v[60:63], v[4:7], 0
  v_cvt_pk_bf16_f32 v55, v54, v55
  v_smfmac_f32_16x16x64_bf16 v[56:59], v[28:31], v[192:199], v3
  v_cvt_pk_bf16_f32 v54, v52, v53
  v_smfmac_f32_16x16x64_bf16 v[36:39], v[24:27], a[32:39], v3
  s_nop 1
  v_cvt_pk_bf16_f32 v76, v8, v9
  v_smfmac_f32_16x16x64_bf16 v[36:39], v[32:35], a[40:47], v3
  v_cvt_pk_bf16_f32 v77, v10, v11
  v_smfmac_f32_16x16x64_bf16 v[36:39], v[28:31], a[48:55], v3
  v_cvt_pk_bf16_f32 v56, v56, v57
  v_smfmac_f32_16x16x64_bf16 v[40:43], v[24:27], a[88:95], v3
  v_cvt_pk_bf16_f32 v57, v58, v59
  v_smfmac_f32_16x16x64_bf16 v[40:43], v[32:35], a[96:103], v3
  v_mfma_f32_16x16x32_bf16 v[12:15], v[54:57], v[4:7], 0
  v_cvt_pk_bf16_f32 v39, v38, v39
  v_smfmac_f32_16x16x64_bf16 v[40:43], v[28:31], a[104:111], v3
  v_cvt_pk_bf16_f32 v38, v36, v37
  v_smfmac_f32_16x16x64_bf16 v[44:47], v[24:27], a[144:151], v3
  s_nop 1
  v_cvt_pk_bf16_f32 v78, v12, v13
  v_smfmac_f32_16x16x64_bf16 v[44:47], v[32:35], a[152:159], v3
  v_cvt_pk_bf16_f32 v79, v14, v15
  v_smfmac_f32_16x16x64_bf16 v[44:47], v[28:31], a[160:167], v3
  v_cvt_pk_bf16_f32 v40, v40, v41
  v_smfmac_f32_16x16x64_bf16 v[48:51], v[24:27], a[200:207], v3
  v_cvt_pk_bf16_f32 v41, v42, v43
  v_smfmac_f32_16x16x64_bf16 v[48:51], v[32:35], a[208:215], v3
  v_smfmac_f32_16x16x64_bf16 v[48:51], v[28:31], a[216:223], v3
  s_waitcnt vmcnt(4)
  v_cvt_pk_bf16_f32 v47, v46, v47
  v_smfmac_f32_16x16x64_bf16 v[68:71], v[76:79], v[80:87], v3
  v_cvt_pk_bf16_f32 v46, v44, v45
  v_mfma_f32_16x16x32_bf16 v[8:11], v[38:41], v[4:7], 0
  s_nop 1
  v_cvt_pk_bf16_f32 v48, v48, v49
  v_cvt_pk_bf16_f32 v49, v50, v51
  s_nop 1
  v_mfma_f32_16x16x32_bf16 v[12:15], v[46:49], v[4:7], 0
  v_smfmac_f32_16x16x64_bf16 v[72:75], v[76:79], v[88:95], v3
  v_cvt_pk_bf16_f32 v20, v8, v9
  v_mfma_f32_16x16x32_bf16 v[52:55], v[30:33], v[76:79], 0
  s_waitcnt vmcnt(0)
  v_cvt_pk_bf16_f32 v21, v10, v11
  v_cvt_pk_bf16_f32 v22, v12, v13
  v_cvt_pk_bf16_f32 v23, v14, v15
  s_nop 1
  v_mfma_f32_16x16x32_bf16 v[52:55], v[16:19], v[20:23], v[52:55]
  v_smfmac_f32_16x16x64_bf16 v[68:71], v[20:23], v[96:103], v3
  v_smfmac_f32_16x16x64_bf16 v[72:75], v[20:23], v[104:111], v3
  s_nop 1
  ds_write_b128 v113, v[52:55]
  s_nop 1
  v_permlane32_swap_b32 v68, v70
  v_permlane32_swap_b32 v69, v71
  v_add_f32 v56, v68, v70
  v_add_f32 v58, v69, v71
  v_permlane32_swap_b32 v72, v74
  v_permlane32_swap_b32 v73, v75
  v_add_f32 v57, v72, v74
  v_add_f32 v59, v73, v75
  ds_write_b128 v2, v[56:59] offset:2048
  v_cmp_u_f32 vcc, v57, v59
  v_mov_b32 v68, 0
  v_mov_b32 v69, 0
  v_mov_b32 v70, 0
  v_mov_b32 v71, 0
  s_cbranch_vccnz cB_sc2_retry
cB_sc2_cont:
  s_add_u32 s24, s24, 28672
  s_add_u32 s26, s26, 28672
  buffer_load_dwordx4 v[80:83], v117, s[8:11], s24 offen offset:0 sc1
  buffer_load_dwordx4 v[84:87], v117, s[8:11], s24 offen offset:1024 sc1
  v_mov_b32 v72, 0
  v_mov_b32 v73, 0
  v_mfma_f32_32x32x16_bf16 v[36:51], v[68:71], v[68:71], 0
  s_waitcnt lgkmcnt(0)
  s_barrier
  v_mfma_f32_32x32x16_bf16 v[52:67], v[68:71], v[68:71], 0
  buffer_store_dwordx2 v[118:119], v114, s[8:11], s21 offen sc1
  buffer_store_dwordx2 v[118:119], v115, s[8:11], s21 offen sc1
  s_buffer_load_dword s70, s[8:11], s35
  s_add_u32 s22, s24, 114688
  s_buffer_load_dword s71, s[8:11], s22
  s_mul_i32 s22, s18, 7168
  s_add_u32 s22, s22, 87040
  s_buffer_load_dword s72, s[8:11], s22
  s_add_u32 s35, s35, 458752
  v_mov_b32 v74, 0
  v_mov_b32 v75, 0
  s_mov_b32 s19, s18
  s_add_u32 s18, s18, 1
  s_mov_b32 s22, s20
  s_mov_b32 s20, s21
  s_mov_b32 s21, s22
  s_add_u32 s23, s20, 4096
  s_cmp_lt_u32 s19, 63
  s_cbranch_scc1 cB_sc2_loop
  s_branch cB_done
cB_sc2_r0:
  s_add_u32 s31, s31, 1
  buffer_load_dwordx4 v[8:11], v2, s[8:11], s20 offen offset:0 sc1
  s_waitcnt vmcnt(0)
  v_cmp_eq_u32 vcc, -1, v8
  v_mov_b32 v36, 0
  v_mov_b32 v37, 0
  v_mov_b32 v38, 0
  v_mov_b32 v39, 0
  v_mov_b32 v40, 0
  v_mov_b32 v41, 0
  v_mov_b32 v42, 0
  v_mov_b32 v43, 0
  v_mov_b32 v44, 0
  v_mov_b32 v45, 0
  v_mov_b32 v46, 0
  v_mov_b32 v47, 0
  v_mov_b32 v48, 0
  v_mov_b32 v49, 0
  v_mov_b32 v50, 0
  v_mov_b32 v51, 0
  s_nop 1
  s_cbranch_vccz cB_sc2_go
  s_add_u32 s30, s30, 1
  s_cmp_lt_u32 s30, 400000
  s_cbranch_scc1 cB_sc2_r0
  s_branch cB_abort
cB_sc2_r1:
  s_add_u32 s31, s31, 1
  buffer_load_dwordx4 v[12:15], v2, s[8:11], s20 offen offset:1024 sc1
  s_waitcnt vmcnt(0)
  v_cmp_eq_u32 vcc, -1, v12
  s_nop 4
  s_cbranch_vccz cB_sc2_c1
  s_add_u32 s30, s30, 1
  s_cmp_lt_u32 s30, 400000
  s_cbranch_scc1 cB_sc2_r1
  s_branch cB_abort
cB_sc2_r2:
  s_add_u32 s31, s31, 1
  buffer_load_dwordx4 v[16:19], v2, s[8:11], s20 offen offset:2048 sc1
  s_waitcnt vmcnt(0)
  v_cmp_eq_u32 vcc, -1, v16
  s_nop 4
  s_cbranch_vccz cB_sc2_c2
  s_add_u32 s30, s30, 1
  s_cmp_lt_u32 s30, 400000
  s_cbranch_scc1 cB_sc2_r2
  s_branch cB_abort
cB_sc2_r3:
  s_add_u32 s31, s31, 1
  buffer_load_dwordx4 v[20:23], v2, s[8:11], s20 offen offset:3072 sc1
  s_waitcnt vmcnt(0)
  v_cmp_eq_u32 vcc, -1, v20
  s_nop 4
  s_cbranch_vccz cB_sc2_c3
  s_add_u32 s30, s30, 1
  s_cmp_lt_u32 s30, 400000
  s_cbranch_scc1 cB_sc2_r3
  s_branch cB_abort
cB_sc2_r4:
  s_add_u32 s31, s31, 1
  buffer_load_dwordx4 v[24:27], v2, s[8:11], s23 offen offset:0 sc1
  buffer_load_dwordx4 v[32:35], v2, s[8:11], s23 offen offset:1024 sc1
  buffer_load_dwordx4 v[28:31], v2, s[8:11], s23 offen offset:2048 sc1
  s_waitcnt vmcnt(0)
  v_max3_u32 v66, v24, v27, v28
  v_max3_u32 v66, v66, v31, v32
  v_max_u32 v66, v66, v35
  v_cmp_eq_u32 vcc, -1, v66
  s_nop 4
  s_cbranch_vccz cB_sc2_c4
  s_add_u32 s30, s30, 1
  s_cmp_lt_u32 s30, 400000
  s_cbranch_scc1 cB_sc2_r4
  s_branch cB_abort
cB_sc2_retry:
  s_cmp_lg_u32 s62, 0
  s_cbranch_scc1 cB_sc2_cont
  s_waitcnt vmcnt(0) lgkmcnt(0)
cB_sc2_rv:
  buffer_load_dwordx4 v[8:11], v2, s[8:11], s20 offen offset:0 sc1
  buffer_load_dwordx4 v[12:15], v2, s[8:11], s20 offen offset:1024 sc1
  buffer_load_dwordx4 v[16:19], v2, s[8:11], s20 offen offset:2048 sc1
  buffer_load_dwordx4 v[20:23], v2, s[8:11], s20 offen offset:3072 sc1
  buffer_load_dwordx4 v[24:27], v2, s[8:11], s23 offen offset:0 sc1
  buffer_load_dwordx4 v[32:35], v2, s[8:11], s23 offen offset:1024 sc1
  buffer_load_dwordx4 v[28:31], v2, s[8:11], s23 offen offset:2048 sc1
  s_waitcnt vmcnt(0)
  v_max3_u32 v66, v8, v9, v10
  v_max3_u32 v66, v66, v11, v12
  v_max3_u32 v66, v66, v13, v14
  v_max3_u32 v66, v66, v15, v16
  v_max3_u32 v66, v66, v17, v18
  v_max3_u32 v66, v66, v19, v20
  v_max3_u32 v66, v66, v21, v22
  v_max3_u32 v66, v66, v23, v24
  v_max3_u32 v66, v66, v25, v26
  v_max3_u32 v66, v66, v27, v28
  v_max3_u32 v66, v66, v29, v30
  v_max3_u32 v66, v66, v31, v32
  v_max3_u32 v66, v66, v33, v34
  v_max_u32 v66, v66, v35
  v_cmp_eq_u32 vcc, -1, v66
  s_cbranch_vccz cB_sc2_rk
  s_add_u32 s30, s30, 1
  s_cmp_lt_u32 s30, 400000
  s_cbranch_scc1 cB_sc2_rv
  s_branch cB_abort
cB_sc2_rk:
  s_mov_b32 s62, 1
  v_mov_b32 v36, 0
  v_mov_b32 v37, 0
  v_mov_b32 v38, 0
  v_mov_b32 v39, 0
  v_mov_b32 v40, 0
  v_mov_b32 v41, 0
  v_mov_b32 v42, 0
  v_mov_b32 v43, 0
  v_mov_b32 v44, 0
  v_mov_b32 v45, 0
  v_mov_b32 v46, 0
  v_mov_b32 v47, 0
  v_mov_b32 v48, 0
  v_mov_b32 v49, 0
  v_mov_b32 v50, 0
  v_mov_b32 v51, 0
  v_mov_b32 v62, 0
  v_mov_b32 v63, 0
  v_mov_b32 v64, 0
  v_mov_b32 v65, 0
  v_mov_b32 v68, 0
  v_mov_b32 v69, 0
  v_mov_b32 v70, 0
  v_mov_b32 v71, 0
  v_mov_b32 v72, 0
  v_mov_b32 v73, 0
  v_mov_b32 v74, 0
  v_mov_b32 v75, 0
  v_mov_b32 v52, 0
  v_mov_b32 v53, 0
  v_mov_b32 v54, 0
  v_mov_b32 v55, 0
  v_mov_b32 v56, 0
  v_mov_b32 v57, 0
  v_mov_b32 v58, 0
  v_mov_b32 v59, 0
  s_add_u32 s31, s31, 0x100
  s_nop 0
  s_branch cB_sc2_go
.p2align 6
cB_sc3_loop:
  s_mov_b32 s30, 0
  s_mov_b32 s62, 0
  s_setprio 3
  s_barrier
  buffer_load_dwordx4 v[8:11], v2, s[8:11], s20 offen offset:0 sc1
  s_setprio 2
  buffer_load_dwordx4 v[12:15], v2, s[8:11], s20 offen offset:1024 sc1
  s_setprio 1
  buffer_load_dwordx4 v[16:19], v2, s[8:11], s20 offen offset:2048 sc1
  s_setprio 0
  buffer_load_dwordx4 v[20:23], v2, s[8:11], s20 offen offset:3072 sc1
cB_sc3_go:
  s_waitcnt vmcnt(3)
  v_smfmac_f32_16x16x64_bf16 v[36:39], v[8:11], a[0:7], v3
  buffer_load_dwordx4 v[24:27], v2, s[8:11], s23 offen offset:0 sc1
  v_cmp_eq_u32 vcc, -1, v8
  v_smfmac_f32_16x16x64_bf16 v[40:43], v[8:11], a[56:63], v3
  v_smfmac_f32_16x16x64_bf16 v[44:47], v[8:11], a[112:119], v3
  buffer_load_dwordx4 v[28:31], v2, s[8:11], s23 offen offset:1024 sc1
  s_cbranch_vccnz cB_sc3_r0
  v_smfmac_f32_16x16x64_bf16 v[48:51], v[8:11], a[168:175], v3
  v_smfmac_f32_16x16x64_bf16 v[52:55], v[8:11], a[224:231], v3
  s_waitcnt vmcnt(4)
  v_cmp_eq_u32 vcc, -1, v12
  v_smfmac_f32_16x16x64_bf16 v[56:59], v[8:11], v[144:151], v3
  buffer_load_dwordx4 v[32:35], v2, s[8:11], s23 offen offset:2048 sc1
  v_smfmac_f32_16x16x64_bf16 v[62:65], v[8:11], v[200:207], v3
  s_cbranch_vccnz cB_sc3_r1
cB_sc3_c1:
  v_smfmac_f32_16x16x64_bf16 v[36:39], v[12:15], a[8:15], v3
  v_smfmac_f32_16x16x64_bf16 v[40:43], v[12:15], a[64:71], v3
  v_smfmac_f32_16x16x64_bf16 v[44:47], v[12:15], a[120:127], v3
  v_smfmac_f32_16x16x64_bf16 v[48:51], v[12:15], a[176:183], v3
  v_smfmac_f32_16x16x64_bf16 v[52:55], v[12:15], a[232:239], v3
  s_waitcnt vmcnt(4)
  v_cmp_eq_u32 vcc, -1, v16
  v_smfmac_f32_16x16x64_bf16 v[56:59], v[12:15], v[152:159], v3
  buffer_load_dwordx4 v[88:91], v117, s[8:11], s26 offen offset:0 sc1
  v_smfmac_f32_16x16x64_bf16 v[62:65], v[12:15], v[208:215], v3
  s_cbranch_vccnz cB_sc3_r2
cB_sc3_c2:
  v_smfmac_f32_16x16x64_bf16 v[36:39], v[16:19], a[16:23], v3
  v_smfmac_f32_16x16x64_bf16 v[40:43], v[16:19], a[72:79], v3
  v_smfmac_f32_16x16x64_bf16 v[44:47], v[16:19], a[128:135], v3
  buffer_load_dwordx4 v[92:95], v117, s[8:11], s26 offen offset:1024 sc1
  v_smfmac_f32_16x16x64_bf16 v[48:51], v[16:19], a[184:191], v3
  v_smfmac_f32_16x16x64_bf16 v[52:55], v[16:19], a[240:247], v3
  s_waitcnt vmcnt(5)
  v_cmp_eq_u32 vcc, -1, v20
  v_smfmac_f32_16x16x64_bf16 v[56:59], v[16:19], v[160:167], v3
  v_smfmac_f32_16x16x64_bf16 v[62:65], v[16:19], v[216:223], v3
  buffer_load_dwordx4 v[96:99], v2, s[8:11], s24 offen offset:0 sc1
  s_cbranch_vccnz cB_sc3_r3
cB_sc3_c3:
  v_smfmac_f32_16x16x64_bf16 v[36:39], v[20:23], a[24:31], v3
  v_smfmac_f32_16x16x64_bf16 v[40:43], v[20:23], a[80:87], v3
  s_waitcnt vmcnt(3)
  v_max3_u32 v66, v24, v27, v28
  v_smfmac_f32_16x16x64_bf16 v[44:47], v[20:23], a[136:143], v3
  v_max3_u32 v66, v66, v31, v32
  v_smfmac_f32_16x16x64_bf16 v[48:51], v[20:23], a[192:199], v3
  buffer_load_dwordx4 v[100:103], v2, s[8:11], s24 offen offset:1024 sc1
  v_max_u32 v66, v66, v35
  v_smfmac_f32_16x16x64_bf16 v[52:55], v[20:23], a[248:255], v3
  v_cmp_eq_u32 vcc, -1, v66
  v_smfmac_f32_16x16x64_bf16 v[56:59], v[20:23], v[168:175], v3
  v_smfmac_f32_16x16x64_bf16 v[62:65], v[20:23], v[224:231], v3
  s_cbranch_vccnz cB_sc3_r4
cB_sc3_c4:
  v_smfmac_f32_16x16x64_bf16 v[62:65], v[24:27], v[232:239], v3
  buffer_load_dwordx4 v[104:107], v2, s[8:11], s26 offen offset:0 sc1
  v_smfmac_f32_16x16x64_bf16 v[62:65], v[28:31], v[240:247], v3
  v_smfmac_f32_16x16x64_bf16 v[62:65], v[32:35], v[248:255], v3
  v_smfmac_f32_16x16x64_bf16 v[52:55], v[24:27], v[120:127], v3
  v_smfmac_f32_16x16x64_bf16 v[52:55], v[28:31], v[128:135], v3
  buffer_load_dwordx4 v[108:111], v2, s[8:11], s26 offen offset:1024 sc1
  v_smfmac_f32_16x16x64_bf16 v[52:55], v[32:35], v[136:143], v3
  v_cvt_pk_bf16_f32 v62, v62, v63
  v_smfmac_f32_16x16x64_bf16 v[56:59], v[24:27], v[176:183], v3
  v_cvt_pk_bf16_f32 v63, v64, v65
  v_smfmac_f32_16x16x64_bf16 v[56:59], v[28:31], v[184:191], v3
  v_mfma_f32_16x16x32_bf16 v[8:11], v[60:63], v[4:7], 0
  v_cvt_pk_bf16_f32 v55, v54, v55
  v_smfmac_f32_16x16x64_bf16 v[56:59], v[32:35], v[192:199], v3
  v_cvt_pk_bf16_f32 v54, v52, v53
  v_smfmac_f32_16x16x64_bf16 v[36:39], v[24:27], a[32:39], v3
  s_nop 1
  v_cvt_pk_bf16_f32 v78, v8, v9
  v_smfmac_f32_16x16x64_bf16 v[36:39], v[28:31], a[40:47], v3
  v_cvt_pk_bf16_f32 v79, v10, v11
  v_smfmac_f32_16x16x64_bf16 v[36:39], v[32:35], a[48:55], v3
  v_cvt_pk_bf16_f32 v56, v56, v57
  v_smfmac_f32_16x16x64_bf16 v[40:43], v[24:27], a[88:95], v3
  v_cvt_pk_bf16_f32 v57, v58, v59
  v_smfmac_f32_16x16x64_bf16 v[40:43], v[28:31], a[96:103], v3
  v_mfma_f32_16x16x32_bf16 v[12:15], v[54:57], v[4:7], 0
  v_cvt_pk_bf16_f32 v39, v38, v39
  v_smfmac_f32_16x16x64_bf16 v[40:43], v[32:35], a[104:111], v3
  v_cvt_pk_bf16_f32 v38, v36, v37
  v_smfmac_f32_16x16x64_bf16 v[44:47], v[24:27], a[144:151], v3
  s_nop 1
  v_cvt_pk_bf16_f32 v76, v12, v13
  v_smfmac_f32_16x16x64_bf16 v[44:47], v[28:31], a[152:159], v3
  v_cvt_pk_bf16_f32 v77, v14, v15
  v_smfmac_f32_16x16x64_bf16 v[44:47], v[32:35], a[160:167], v3
  v_cvt_pk_bf16_f32 v40, v40, v41
  v_smfmac_f32_16x16x64_bf16 v[48:51], v[24:27], a[200:207], v3
  v_cvt_pk_bf16_f32 v41, v42, v43
  v_smfmac_f32_16x16x64_bf16 v[48:51], v[28:31], a[208:215], v3
  v_smfmac_f32_16x16x64_bf16 v[48:51], v[32:35], a[216:223], v3
  s_waitcnt vmcnt(4)
  v_cvt_pk_bf16_f32 v47, v46, v47
  v_smfmac_f32_16x16x64_bf16 v[68:71], v[76:79], v[80:87], v3
  v_cvt_pk_bf16_f32 v46, v44, v45
  v_mfma_f32_16x16x32_bf16 v[8:11], v[38:41], v[4:7], 0
  s_nop 1
  v_cvt_pk_bf16_f32 v48, v48, v49
  v_cvt_pk_bf16_f32 v49, v50, v51
  s_nop 1
  v_mfma_f32_16x16x32_bf16 v[12:15], v[46:49], v[4:7], 0
  v_smfmac_f32_16x16x64_bf16 v[72:75], v[76:79], v[88:95], v3
  v_cvt_pk_bf16_f32 v16, v8, v9
  v_mfma_f32_16x16x32_bf16 v[52:55], v[30:33], v[76:79], 0
  s_waitcnt vmcnt(0)
  v_cvt_pk_bf16_f32 v17, v10, v11
  v_cvt_pk_bf16_f32 v18, v12, v13
  v_cvt_pk_bf16_f32 v19, v14, v15
  s_nop 1
  v_mfma_f32_16x16x32_bf16 v[52:55], v[20:23], v[16:19], v[52:55]
  v_smfmac_f32_16x16x64_bf16 v[68:71], v[16:19], v[96:103], v3
  v_smfmac_f32_16x16x64_bf16 v[72:75], v[16:19], v[104:111], v3
  s_nop 1
  ds_write_b128 v113, v[52:55]
  s_nop 1
  v_permlane32_swap_b32 v68, v70
  v_permlane32_swap_b32 v69, v71
  v_add_f32 v56, v68, v70
  v_add_f32 v58, v69, v71
  v_permlane32_swap_b32 v72, v74
  v_permlane32_swap_b32 v73, v75
  v_add_f32 v57, v72, v74
  v_add_f32 v59, v73, v75
  ds_write_b128 v2, v[56:59] offset:3072
  v_cmp_u_f32 vcc, v57, v59
  v_mov_b32 v68, 0
  v_mov_b32 v69, 0
  v_mov_b32 v70, 0
  v_mov_b32 v71, 0
  s_cbranch_vccnz cB_sc3_retry
cB_sc3_cont:
  s_add_u32 s24, s24, 28672
  s_add_u32 s26, s26, 28672
  buffer_load_dwordx4 v[80:83], v117, s[8:11], s24 offen offset:0 sc1
  buffer_load_dwordx4 v[84:87], v117, s[8:11], s24 offen offset:1024 sc1
  v_mov_b32 v72, 0
  v_mov_b32 v73, 0
  v_mfma_f32_16x16x32_bf16 v[62:65], v[68:71], v[68:71], 0
  s_waitcnt lgkmcnt(0)
  s_barrier
  v_mov_b32 v52, 0
  v_mov_b32 v53, 0
  v_mov_b32 v54, 0
  v_mov_b32 v55, 0
  v_mov_b32 v56, 0
  v_mov_b32 v57, 0
  v_mov_b32 v58, 0
  v_mov_b32 v59, 0
  v_mfma_f32_32x32x16_bf16 v[36:51], v[68:71], v[68:71], 0
  v_mov_b32 v74, 0
  v_mov_b32 v75, 0
  s_mov_b32 s19, s18
  s_add_u32 s18, s18, 1
  s_mov_b32 s22, s20
  s_mov_b32 s20, s21
  s_mov_b32 s21, s22
  s_add_u32 s23, s20, 4096
  s_cmp_lt_u32 s19, 63
  s_nop 2
  s_cbranch_scc1 cB_sc3_loop
  s_branch cB_done
cB_sc3_r0:
  s_add_u32 s31, s31, 1
  buffer_load_dwordx4 v[8:11], v2, s[8:11], s20 offen offset:0 sc1
  s_waitcnt vmcnt(0)
  v_cmp_eq_u32 vcc, -1, v8
  v_mov_b32 v36, 0
  v_mov_b32 v37, 0
  v_mov_b32 v38, 0
  v_mov_b32 v39, 0
  v_mov_b32 v40, 0
  v_mov_b32 v41, 0
  v_mov_b32 v42, 0
  v_mov_b32 v43, 0
  v_mov_b32 v44, 0
  v_mov_b32 v45, 0
  v_mov_b32 v46, 0
  v_mov_b32 v47, 0
  v_mov_b32 v48, 0
  v_mov_b32 v49, 0
  v_mov_b32 v50, 0
  v_mov_b32 v51, 0
  s_nop 1
  s_cbranch_vccz cB_sc3_go
  s_add_u32 s30, s30, 1
  s_cmp_lt_u32 s30, 400000
  s_cbranch_scc1 cB_sc3_r0
  s_branch cB_abort
cB_sc3_r1:
  s_add_u32 s31, s31, 1
  buffer_load_dwordx4 v[12:15], v2, s[8:11], s20 offen offset:1024 sc1
  s_waitcnt vmcnt(0)
  v_cmp_eq_u32 vcc, -1, v12
  s_nop 4
  s_cbranch_vccz cB_sc3_c1
  s_add_u32 s30, s30, 1
  s_cmp_lt_u32 s30, 400000
  s_cbranch_scc1 cB_sc3_r1
  s_branch cB_abort
cB_sc3_r2:
  s_add_u32 s31, s31, 1
  buffer_load_dwordx4 v[16:19], v2, s[8:11], s20 offen offset:2048 sc1
  s_waitcnt vmcnt(0)
  v_cmp_eq_u32 vcc, -1, v16
  s_nop 4
  s_cbranch_vccz cB_sc3_c2
  s_add_u32 s30, s30, 1
  s_cmp_lt_u32 s30, 400000
  s_cbranch_scc1 cB_sc3_r2
  s_branch cB_abort
cB_sc3_r3:
  s_add_u32 s31, s31, 1
  buffer_load_dwordx4 v[20:23], v2, s[8:11], s20 offen offset:3072 sc1
  s_waitcnt vmcnt(0)
  v_cmp_eq_u32 vcc, -1, v20
  s_nop 4
  s_cbranch_vccz cB_sc3_c3
  s_add_u32 s30, s30, 1
  s_cmp_lt_u32 s30, 400000
  s_cbranch_scc1 cB_sc3_r3
  s_branch cB_abort
cB_sc3_r4:
  s_add_u32 s31, s31, 1
  buffer_load_dwordx4 v[24:27], v2, s[8:11], s23 offen offset:0 sc1
  buffer_load_dwordx4 v[28:31], v2, s[8:11], s23 offen offset:1024 sc1
  buffer_load_dwordx4 v[32:35], v2, s[8:11], s23 offen offset:2048 sc1
  s_waitcnt vmcnt(0)
  v_max3_u32 v66, v24, v27, v28
  v_max3_u32 v66, v66, v31, v32
  v_max_u32 v66, v66, v35
  v_cmp_eq_u32 vcc, -1, v66
  s_nop 4
  s_cbranch_vccz cB_sc3_c4
  s_add_u32 s30, s30, 1
  s_cmp_lt_u32 s30, 400000
  s_cbranch_scc1 cB_sc3_r4
  s_branch cB_abort
cB_sc3_retry:
  s_cmp_lg_u32 s62, 0
  s_cbranch_scc1 cB_sc3_cont
  s_waitcnt vmcnt(0) lgkmcnt(0)
cB_sc3_rv:
  buffer_load_dwordx4 v[8:11], v2, s[8:11], s20 offen offset:0 sc1
  buffer_load_dwordx4 v[12:15], v2, s[8:11], s20 offen offset:1024 sc1
  buffer_load_dwordx4 v[16:19], v2, s[8:11], s20 offen offset:2048 sc1
  buffer_load_dwordx4 v[20:23], v2, s[8:11], s20 offen offset:3072 sc1
  buffer_load_dwordx4 v[24:27], v2, s[8:11], s23 offen offset:0 sc1
  buffer_load_dwordx4 v[28:31], v2, s[8:11], s23 offen offset:1024 sc1
  buffer_load_dwordx4 v[32:35], v2, s[8:11], s23 offen offset:2048 sc1
  s_waitcnt vmcnt(0)
  v_max3_u32 v66, v8, v9, v10
  v_max3_u32 v66, v66, v11, v12
  v_max3_u32 v66, v66, v13, v14
  v_max3_u32 v66, v66, v15, v16
  v_max3_u32 v66, v66, v17, v18
  v_max3_u32 v66, v66, v19, v20
  v_max3_u32 v66, v66, v21, v22
  v_max3_u32 v66, v66, v23, v24
  v_max3_u32 v66, v66, v25, v26
  v_max3_u32 v66, v66, v27, v28
  v_max3_u32 v66, v66, v29, v30
  v_max3_u32 v66, v66, v31, v32
  v_max3_u32 v66, v66, v33, v34
  v_max_u32 v66, v66, v35
  v_cmp_eq_u32 vcc, -1, v66
  s_cbranch_vccz cB_sc3_rk
  s_add_u32 s30, s30, 1
  s_cmp_lt_u32 s30, 400000
  s_cbranch_scc1 cB_sc3_rv
  s_branch cB_abort
cB_sc3_rk:
  s_mov_b32 s62, 1
  v_mov_b32 v36, 0
  v_mov_b32 v37, 0
  v_mov_b32 v38, 0
  v_mov_b32 v39, 0
  v_mov_b32 v40, 0
  v_mov_b32 v41, 0
  v_mov_b32 v42, 0
  v_mov_b32 v43, 0
  v_mov_b32 v44, 0
  v_mov_b32 v45, 0
  v_mov_b32 v46, 0
  v_mov_b32 v47, 0
  v_mov_b32 v48, 0
  v_mov_b32 v49, 0
  v_mov_b32 v50, 0
  v_mov_b32 v51, 0
  v_mov_b32 v62, 0
  v_mov_b32 v63, 0
  v_mov_b32 v64, 0
  v_mov_b32 v65, 0
  v_mov_b32 v68, 0
  v_mov_b32 v69, 0
  v_mov_b32 v70, 0
  v_mov_b32 v71, 0
  v_mov_b32 v72, 0
  v_mov_b32 v73, 0
  v_mov_b32 v74, 0
  v_mov_b32 v75, 0
  v_mov_b32 v52, 0
  v_mov_b32 v53, 0
  v_mov_b32 v54, 0
  v_mov_b32 v55, 0
  v_mov_b32 v56, 0
  v_mov_b32 v57, 0
  v_mov_b32 v58, 0
  v_mov_b32 v59, 0
  s_add_u32 s31, s31, 0x100
  s_nop 0
  s_branch cB_sc3_go
.p2align 6
cB_va0_loop:
  s_mov_b32 s30, 0
  s_barrier
  buffer_load_dwordx4 v[24:27], v2, s[8:11], s23 offen offset:0 sc1
  buffer_load_dwordx4 v[28:31], v2, s[8:11], s23 offen offset:1024 sc1
  s_barrier
  s_cmp_lt_u32 s19, 60
  s_cbranch_scc1 cB_va0_m1
  buffer_store_dword v160, v1, s[8:11], s38 offen sc1
  s_cmp_lg_u32 s19, 63
  s_cbranch_scc1 cB_va0_m2
  v_min_u32 v64, -2, v64
  v_min_u32 v65, -2, v65
  v_min_u32 v66, -2, v66
  v_min_u32 v67, -2, v67
  v_min_u32 v68, -2, v68
  v_min_u32 v69, -2, v69
  v_min_u32 v70, -2, v70
  v_min_u32 v71, -2, v71
  v_min_u32 v72, -2, v72
  v_min_u32 v73, -2, v73
  v_min_u32 v74, -2, v74
  v_min_u32 v75, -2, v75
  v_min_u32 v76, -2, v76
  v_min_u32 v77, -2, v77
  v_min_u32 v78, -2, v78
  v_min_u32 v79, -2, v79
  buffer_store_dwordx4 v[64:67], v2, s[8:11], s33 offen offset:0 sc1
  buffer_store_dwordx4 v[68:71], v2, s[8:11], s33 offen offset:2048 sc1
  s_add_u32 s33, s33, 4096
  buffer_store_dwordx4 v[72:75], v2, s[8:11], s33 offen offset:0 sc1
  buffer_store_dwordx4 v[76:79], v2, s[8:11], s33 offen offset:2048 sc1
  s_add_u32 s33, s33, 4096
  s_waitcnt vmcnt(5)
  s_branch cB_va0_m3
cB_va0_m1:
  buffer_store_dword v160, v1, s[8:11], s38 offen sc1
cB_va0_m2:
  s_add_u32 s22, s25, 0
  buffer_load_dwordx4 v[80:83], v6, s[8:11], s22 offen offset:0 sc1
  buffer_load_dwordx4 v[84:87], v6, s[8:11], s22 offen offset:1792 sc1
  s_add_u32 s22, s25, 3584
  buffer_load_dwordx4 v[88:91], v6, s[8:11], s22 offen offset:0 sc1
  buffer_load_dwordx4 v[92:95], v6, s[8:11], s22 offen offset:1792 sc1
  s_add_u32 s22, s25, 7168
  buffer_load_dwordx4 v[96:99], v6, s[8:11], s22 offen offset:0 sc1
  s_mul_i32 s38, s18, 7168
  s_add_u32 s38, s38, 65536
  s_waitcnt vmcnt(6)
cB_va0_m3:
  ds_write_b128 v2, v[24:27] offset:12288
  ds_write_b128 v2, v[28:31] offset:13312
  v_smfmac_f32_16x16x64_bf16 v[36:39], v[24:27], a[32:39], v3
  buffer_load_dwordx4 v[100:103], v6, s[8:11], s22 offen offset:1792 sc1
  v_smfmac_f32_16x16x64_bf16 v[40:43], v[24:27], a[88:95], v3
  s_add_u32 s22, s25, 10752
  buffer_load_dwordx4 v[104:107], v6, s[8:11], s22 offen offset:0 sc1
  v_smfmac_f32_16x16x64_bf16 v[44:47], v[24:27], a[144:151], v3
  buffer_load_dwordx4 v[108:111], v6, s[8:11], s22 offen offset:1792 sc1
  v_smfmac_f32_16x16x64_bf16 v[48:51], v[24:27], a[200:207], v3
  s_add_u32 s22, s25, 14336
  buffer_load_dwordx4 v[112:115], v6, s[8:11], s22 offen offset:0 sc1
  v_smfmac_f32_16x16x64_bf16 v[52:55], v[24:27], v[176:183], v3
  s_waitcnt lgkmcnt(0)
  s_barrier
  ds_read_b128 v[8:11], v2 offset:8192
  ds_read_b128 v[12:15], v2 offset:9216
  ds_read_b128 v[16:19], v2 offset:10240
  ds_read_b128 v[20:23], v2 offset:11264
  ds_read_b128 v[32:35], v2 offset:14336
  buffer_load_dwordx4 v[116:119], v6, s[8:11], s22 offen offset:1792 sc1
  v_smfmac_f32_16x16x64_bf16 v[56:59], v[24:27], v[232:239], v3
  s_add_u32 s22, s25, 17920
  buffer_load_dwordx4 v[120:123], v6, s[8:11], s22 offen offset:0 sc1
  v_smfmac_f32_16x16x64_bf16 v[36:39], v[28:31], a[40:47], v3
  buffer_load_dwordx4 v[124:127], v6, s[8:11], s22 offen offset:1792 sc1
  v_smfmac_f32_16x16x64_bf16 v[40:43], v[28:31], a[96:103], v3
  s_add_u32 s22, s25, 21504
  buffer_load_dwordx4 v[128:131], v6, s[8:11], s22 offen offset:0 sc1
  v_smfmac_f32_16x16x64_bf16 v[44:47], v[28:31], a[152:159], v3
  buffer_load_dwordx4 v[132:135], v6, s[8:11], s22 offen offset:1792 sc1
  v_smfmac_f32_16x16x64_bf16 v[48:51], v[28:31], a[208:215], v3
  s_add_u32 s22, s25, 25088
  buffer_load_dwordx4 v[136:139], v6, s[8:11], s22 offen offset:0 sc1
  v_smfmac_f32_16x16x64_bf16 v[52:55], v[28:31], v[184:191], v3
  buffer_load_dwordx4 v[140:143], v6, s[8:11], s22 offen offset:1792 sc1
  v_smfmac_f32_16x16x64_bf16 v[56:59], v[28:31], v[240:247], v3
  s_waitcnt lgkmcnt(4)
  v_smfmac_f32_16x16x64_bf16 v[36:39], v[8:11], a[0:7], v3
  s_waitcnt lgkmcnt(3)
  v_smfmac_f32_16x16x64_bf16 v[36:39], v[12:15], a[8:15], v3
  s_waitcnt lgkmcnt(2)
  v_smfmac_f32_16x16x64_bf16 v[36:39], v[16:19], a[16:23], v3
  s_waitcnt lgkmcnt(1)
  v_smfmac_f32_16x16x64_bf16 v[36:39], v[20:23], a[24:31], v3
  s_waitcnt lgkmcnt(0)
  v_smfmac_f32_16x16x64_bf16 v[36:39], v[32:35], a[48:55], v3
  v_smfmac_f32_16x16x64_bf16 v[40:43], v[8:11], a[56:63], v3
  v_smfmac_f32_16x16x64_bf16 v[40:43], v[12:15], a[64:71], v3
  v_smfmac_f32_16x16x64_bf16 v[40:43], v[16:19], a[72:79], v3
  v_permlane32_swap_b32 v36, v38
  v_smfmac_f32_16x16x64_bf16 v[40:43], v[20:23], a[80:87], v3
  v_permlane32_swap_b32 v37, v39
  v_smfmac_f32_16x16x64_bf16 v[40:43], v[32:35], a[104:111], v3
  v_add_f32 v36, v36, v38
  v_smfmac_f32_16x16x64_bf16 v[44:47], v[8:11], a[112:119], v3
  v_add_f32 v37, v37, v39
  v_smfmac_f32_16x16x64_bf16 v[44:47], v[12:15], a[120:127], v3
  v_cmp_u_f32 vcc, v36, v37
  v_smfmac_f32_16x16x64_bf16 v[44:47], v[16:19], a[128:135], v3
  v_cvt_pk_bf16_f32 v38, v36, v37
  v_smfmac_f32_16x16x64_bf16 v[44:47], v[20:23], a[136:143], v3
  ds_write_b32 v152, v38
  s_cbranch_vccnz cB_va0_slow
  v_permlane32_swap_b32 v40, v42
  v_smfmac_f32_16x16x64_bf16 v[44:47], v[32:35], a[160:167], v3
  v_permlane32_swap_b32 v41, v43
  v_smfmac_f32_16x16x64_bf16 v[48:51], v[8:11], a[168:175], v3
  buffer_store_dword v162, v1, s[8:11], s21 offen sc1
  v_add_f32 v40, v40, v42
  v_smfmac_f32_16x16x64_bf16 v[48:51], v[12:15], a[176:183], v3
  v_add_f32 v41, v41, v43
  v_smfmac_f32_16x16x64_bf16 v[48:51], v[16:19], a[184:191], v3
  buffer_load_dword v164, v4, s[8:11], 0 offen sc1
  v_cvt_pk_bf16_f32 v42, v40, v41
  v_smfmac_f32_16x16x64_bf16 v[48:51], v[20:23], a[192:199], v3
  ds_write_b32 v153, v42
  v_permlane32_swap_b32 v44, v46
  v_smfmac_f32_16x16x64_bf16 v[48:51], v[32:35], a[216:223], v3
  v_permlane32_swap_b32 v45, v47
  v_smfmac_f32_16x16x64_bf16 v[52:55], v[8:11], a[224:231], v3
  buffer_load_dword v164, v4, s[8:11], 0 offen sc1
  v_add_f32 v44, v44, v46
  v_smfmac_f32_16x16x64_bf16 v[52:55], v[12:15], a[232:239], v3
  v_add_f32 v45, v45, v47
  v_smfmac_f32_16x16x64_bf16 v[52:55], v[16:19], a[240:247], v3
  v_cvt_pk_bf16_f32 v46, v44, v45
  v_smfmac_f32_16x16x64_bf16 v[52:55], v[20:23], a[248:255], v3
  ds_write_b32 v154, v46
  buffer_load_dword v164, v4, s[8:11], 0 offen sc1
  v_permlane32_swap_b32 v48, v50
  v_smfmac_f32_16x16x64_bf16 v[52:55], v[32:35], v[192:199], v3
  v_permlane32_swap_b32 v49, v51
  v_smfmac_f32_16x16x64_bf16 v[56:59], v[8:11], v[200:207], v3
  v_add_f32 v48, v48, v50
  v_smfmac_f32_16x16x64_bf16 v[56:59], v[12:15], v[208:215], v3
  buffer_load_dword v164, v4, s[8:11], 0 offen sc1
  v_add_f32 v49, v49, v51
  v_smfmac_f32_16x16x64_bf16 v[56:59], v[16:19], v[216:223], v3
  v_cvt_pk_bf16_f32 v50, v48, v49
  v_smfmac_f32_16x16x64_bf16 v[56:59], v[20:23], v[224:231], v3
  ds_write_b32 v155, v50
  v_permlane32_swap_b32 v52, v54
  v_smfmac_f32_16x16x64_bf16 v[56:59], v[32:35], v[248:255], v3
  buffer_load_dword v164, v4, s[8:11], 0 offen sc1
  v_permlane32_swap_b32 v53, v55
  v_add_f32 v52, v52, v54
  v_add_f32 v53, v53, v55
  v_cvt_pk_bf16_f32 v54, v52, v53
  ds_write_b32 v156, v54
  s_nop 1
  v_permlane32_swap_b32 v56, v58
  v_permlane32_swap_b32 v57, v59
  v_add_f32 v56, v56, v58
  v_add_f32 v57, v57, v59
  v_cvt_pk_bf16_f32 v58, v56, v57
  ds_write_b32 v157, v58
cB_va0_t2d:
  s_add_u32 s22, s20, 9216
  s_add_u32 s34, s20, 13312
  s_add_u32 s36, s20, 7168
  s_mov_b32 s37, 0
  v_mov_b32 v48, 0
  v_mov_b32 v49, 0
  v_mov_b32 v50, 0
  v_mov_b32 v51, 0
  v_mov_b32 v163, s18
  s_cmp_eq_u32 s19, 63
  s_waitcnt lgkmcnt(0)
  s_cbranch_scc1 cB_va0_last
  s_setprio 3
cB_va0_fw_l:
  v_cmp_gt_u32 vcc, s18, v164
  buffer_load_dword v164, v4, s[8:11], 0 offen sc1
  s_cbranch_vccz cB_va0_fw_d
  v_cmp_gt_u32 vcc, s18, v164
  buffer_load_dword v164, v4, s[8:11], 0 offen sc1
  s_cbranch_vccz cB_va0_fw_d
  v_cmp_gt_u32 vcc, s18, v164
  buffer_load_dword v164, v4, s[8:11], 0 offen sc1
  s_cbranch_vccz cB_va0_fw_d
  v_cmp_gt_u32 vcc, s18, v164
  buffer_load_dword v164, v4, s[8:11], 0 offen sc1
  s_cbranch_vccz cB_va0_fw_d
  v_cmp_gt_u32 vcc, s18, v164
  buffer_load_dword v164, v4, s[8:11], 0 offen sc1
  s_cbranch_vccz cB_va0_fw_d
  v_cmp_gt_u32 vcc, s18, v164
  buffer_load_dword v164, v4, s[8:11], 0 offen sc1
  s_cbranch_vccz cB_va0_fw_d
  v_cmp_gt_u32 vcc, s18, v164
  buffer_load_dword v164, v4, s[8:11], 0 offen sc1
  s_cbranch_vccz cB_va0_fw_d
  v_cmp_gt_u32 vcc, s18, v164
  buffer_load_dword v164, v4, s[8:11], 0 offen sc1
  s_cbranch_vccz cB_va0_fw_d
  v_cmp_gt_u32 vcc, s18, v164
  buffer_load_dword v164, v4, s[8:11], 0 offen sc1
  s_cbranch_vccz cB_va0_fw_d
  v_cmp_gt_u32 vcc, s18, v164
  buffer_load_dword v164, v4, s[8:11], 0 offen sc1
  s_cbranch_vccz cB_va0_fw_d
  v_cmp_gt_u32 vcc, s18, v164
  buffer_load_dword v164, v4, s[8:11], 0 offen sc1
  s_cbranch_vccz cB_va0_fw_d
  v_cmp_gt_u32 vcc, s18, v164
  buffer_load_dword v164, v4, s[8:11], 0 offen sc1
  s_cbranch_vccz cB_va0_fw_d
  v_cmp_gt_u32 vcc, s18, v164
  buffer_load_dword v164, v4, s[8:11], 0 offen sc1
  s_cbranch_vccz cB_va0_fw_d
  v_cmp_gt_u32 vcc, s18, v164
  buffer_load_dword v164, v4, s[8:11], 0 offen sc1
  s_cbranch_vccz cB_va0_fw_d
  v_cmp_gt_u32 vcc, s18, v164
  buffer_load_dword v164, v4, s[8:11], 0 offen sc1
  s_cbranch_vccz cB_va0_fw_d
  v_cmp_gt_u32 vcc, s18, v164
  buffer_load_dword v164, v4, s[8:11], 0 offen sc1
  s_cbranch_vccz cB_va0_fw_d
  s_waitcnt vmcnt(24)
  s_add_u32 s30, s30, 1
  s_cmp_lt_u32 s30, 400000
  s_cbranch_scc1 cB_va0_fw_l
  s_branch cB_abort
cB_va0_fw_d:
  buffer_load_dwordx4 v[8:11], v2, s[8:11], s22 offen offset:0 sc1
  buffer_load_dwordx4 v[12:15], v2, s[8:11], s22 offen offset:1024 sc1
  buffer_load_dwordx4 v[16:19], v2, s[8:11], s22 offen offset:2048 sc1
  buffer_load_dwordx4 v[20:23], v2, s[8:11], s22 offen offset:3072 sc1
  buffer_load_dwordx4 v[24:27], v2, s[8:11], s34 offen offset:0 sc1
  buffer_load_dwordx4 v[28:31], v2, s[8:11], s34 offen offset:1024 sc1
  buffer_load_dwordx4 v[32:35], v2, s[8:11], s34 offen offset:2048 sc1
  buffer_load_dwordx4 v[36:39], v2, s[8:11], s34 offen offset:3072 sc1
  buffer_load_dwordx4 v[40:43], v2, s[8:11], s36 offen offset:0 sc1
  buffer_load_dwordx4 v[44:47], v2, s[8:11], s36 offen offset:1024 sc1
  s_barrier
  ds_read_b128 v[64:67], v2 offset:0
  ds_read_b128 v[68:71], v2 offset:1024
  ds_read_b128 v[72:75], v2 offset:2048
  ds_read_b128 v[76:79], v2 offset:3072
cB_va0_lp:
  s_waitcnt vmcnt(9)
  v_smfmac_f32_16x16x64_bf16 v[48:51], v[8:11], v[80:87], v3
  s_waitcnt vmcnt(8)
  v_smfmac_f32_16x16x64_bf16 v[48:51], v[12:15], v[88:95], v3
  s_waitcnt vmcnt(7)
  v_smfmac_f32_16x16x64_bf16 v[48:51], v[16:19], v[96:103], v3
  s_waitcnt vmcnt(6)
  v_smfmac_f32_16x16x64_bf16 v[48:51], v[20:23], v[104:111], v3
  s_waitcnt vmcnt(5)
  v_smfmac_f32_16x16x64_bf16 v[48:51], v[24:27], v[112:119], v3
  s_waitcnt vmcnt(4)
  v_smfmac_f32_16x16x64_bf16 v[48:51], v[28:31], v[120:127], v3
  s_waitcnt vmcnt(3)
  v_smfmac_f32_16x16x64_bf16 v[48:51], v[32:35], v[128:135], v3
  s_waitcnt vmcnt(2)
  v_smfmac_f32_16x16x64_bf16 v[48:51], v[36:39], v[136:143], v3
  s_waitcnt vmcnt(1) lgkmcnt(0)
  v_smfmac_f32_16x16x64_bf16 v[48:51], v[40:43], v[64:71], v3
  s_waitcnt vmcnt(0)
  v_smfmac_f32_16x16x64_bf16 v[48:51], v[44:47], v[72:79], v3
  s_nop 7
  v_permlane32_swap_b32 v48, v50
  v_permlane32_swap_b32 v49, v51
  v_pk_add_f32 v[48:49], v[48:49], v[50:51]
  v_cvt_pk_bf16_f32 v160, v48, v49
  v_cmp_u_f32 vcc, v48, v49
  s_nop 0
  v_mov_b32_dpp v161, v160 quad_perm:[1,0,3,2] row_mask:0xf bank_mask:0xf
  v_perm_b32 v160, v161, v160, v5
  v_cndmask_b32 v161, v160, v162, vcc
  buffer_store_dword v161, v1, s[8:11], s21 offen sc1
  s_cbranch_vccnz cB_va0_rp
cB_va0_cont:
  s_setprio 0
  s_cmp_lg_u32 s19, 62
  s_cbranch_scc1 cB_va0_nl
  s_sleep 4
  buffer_store_dword v160, v1, s[8:11], s38 offen sc1
  s_mov_b32 s38, 0x40000000
  s_mov_b32 s25, 0x40000000
cB_va0_nl:
  s_add_u32 s25, s25, 458752
  v_mov_b32 v36, 0
  v_mov_b32 v37, 0
  v_mov_b32 v38, 0
  v_mov_b32 v39, 0
  v_mov_b32 v40, 0
  v_mov_b32 v41, 0
  v_mov_b32 v42, 0
  v_mov_b32 v43, 0
  v_mov_b32 v44, 0
  v_mov_b32 v45, 0
  v_mov_b32 v46, 0
  v_mov_b32 v47, 0
  v_mov_b32 v48, 0
  v_mov_b32 v49, 0
  v_mov_b32 v50, 0
  v_mov_b32 v51, 0
  v_mov_b32 v52, 0
  v_mov_b32 v53, 0
  v_mov_b32 v54, 0
  v_mov_b32 v55, 0
  v_mov_b32 v56, 0
  v_mov_b32 v57, 0
  v_mov_b32 v58, 0
  v_mov_b32 v59, 0
  v_mov_b32 v60, 0
  v_mov_b32 v61, 0
  v_mov_b32 v62, 0
  v_mov_b32 v63, 0
  s_mov_b32 s19, s18
  s_add_u32 s18, s18, 1
  s_mov_b32 s22, s20
  s_mov_b32 s20, s21
  s_mov_b32 s21, s22
  s_add_u32 s23, s20, 4096
  s_branch cB_va0_loop
cB_va0_slow:
  s_waitcnt lgkmcnt(0)
cB_va0_sl1:
  s_add_u32 s31, s31, 0x1000000
  buffer_load_dwordx4 v[8:11], v2, s[8:11], s20 offen offset:0 sc1
  buffer_load_dwordx4 v[12:15], v2, s[8:11], s20 offen offset:1024 sc1
  buffer_load_dwordx4 v[16:19], v2, s[8:11], s20 offen offset:2048 sc1
  buffer_load_dwordx4 v[20:23], v2, s[8:11], s20 offen offset:3072 sc1
  buffer_load_dwordx4 v[24:27], v2, s[8:11], s23 offen offset:0 sc1
  buffer_load_dwordx4 v[28:31], v2, s[8:11], s23 offen offset:1024 sc1
  buffer_load_dwordx4 v[32:35], v2, s[8:11], s23 offen offset:2048 sc1
  s_waitcnt vmcnt(0)
  v_max3_u32 v36, v8, v9, v10
  v_max3_u32 v36, v36, v11, v12
  v_max3_u32 v36, v36, v13, v14
  v_max3_u32 v36, v36, v15, v16
  v_max3_u32 v36, v36, v17, v18
  v_max3_u32 v36, v36, v19, v20
  v_max3_u32 v36, v36, v21, v22
  v_max3_u32 v36, v36, v23, v24
  v_max3_u32 v36, v36, v25, v26
  v_max3_u32 v36, v36, v27, v28
  v_max3_u32 v36, v36, v29, v30
  v_max3_u32 v36, v36, v31, v32
  v_max3_u32 v36, v36, v33, v34
  v_max_u32 v36, v36, v35
  v_cmp_eq_u32 vcc, -1, v36
  s_cbranch_vccz cB_va0_sl2
  s_add_u32 s30, s30, 1
  s_cmp_lt_u32 s30, 400000
  s_cbranch_scc1 cB_va0_sl1
  s_branch cB_abort
cB_va0_sl2:
  v_mov_b32 v36, 0
  v_mov_b32 v37, 0
  v_mov_b32 v38, 0
  v_mov_b32 v39, 0
  v_mov_b32 v40, 0
  v_mov_b32 v41, 0
  v_mov_b32 v42, 0
  v_mov_b32 v43, 0
  v_mov_b32 v44, 0
  v_mov_b32 v45, 0
  v_mov_b32 v46, 0
  v_mov_b32 v47, 0
  v_mov_b32 v48, 0
  v_mov_b32 v49, 0
  v_mov_b32 v50, 0
  v_mov_b32 v51, 0
  v_mov_b32 v52, 0
  v_mov_b32 v53, 0
  v_mov_b32 v54, 0
  v_mov_b32 v55, 0
  v_mov_b32 v56, 0
  v_mov_b32 v57, 0
  v_mov_b32 v58, 0
  v_mov_b32 v59, 0
  v_mov_b32 v60, 0
  v_mov_b32 v61, 0
  v_mov_b32 v62, 0
  v_mov_b32 v63, 0
  buffer_store_dword v162, v1, s[8:11], s21 offen sc1
  v_smfmac_f32_16x16x64_bf16 v[36:39], v[8:11], a[0:7], v3
  v_smfmac_f32_16x16x64_bf16 v[40:43], v[8:11], a[56:63], v3
  v_smfmac_f32_16x16x64_bf16 v[44:47], v[8:11], a[112:119], v3
  v_smfmac_f32_16x16x64_bf16 v[48:51], v[8:11], a[168:175], v3
  v_smfmac_f32_16x16x64_bf16 v[52:55], v[8:11], a[224:231], v3
  v_smfmac_f32_16x16x64_bf16 v[56:59], v[8:11], v[200:207], v3
  v_smfmac_f32_16x16x64_bf16 v[36:39], v[12:15], a[8:15], v3
  v_smfmac_f32_16x16x64_bf16 v[40:43], v[12:15], a[64:71], v3
  v_smfmac_f32_16x16x64_bf16 v[44:47], v[12:15], a[120:127], v3
  v_smfmac_f32_16x16x64_bf16 v[48:51], v[12:15], a[176:183], v3
  v_smfmac_f32_16x16x64_bf16 v[52:55], v[12:15], a[232:239], v3
  v_smfmac_f32_16x16x64_bf16 v[56:59], v[12:15], v[208:215], v3
  v_smfmac_f32_16x16x64_bf16 v[36:39], v[16:19], a[16:23], v3
  v_smfmac_f32_16x16x64_bf16 v[40:43], v[16:19], a[72:79], v3
  v_smfmac_f32_16x16x64_bf16 v[44:47], v[16:19], a[128:135], v3
  v_smfmac_f32_16x16x64_bf16 v[48:51], v[16:19], a[184:191], v3
  v_smfmac_f32_16x16x64_bf16 v[52:55], v[16:19], a[240:247], v3
  v_smfmac_f32_16x16x64_bf16 v[56:59], v[16:19], v[216:223], v3
  v_smfmac_f32_16x16x64_bf16 v[36:39], v[20:23], a[24:31], v3
  v_smfmac_f32_16x16x64_bf16 v[40:43], v[20:23], a[80:87], v3
  v_smfmac_f32_16x16x64_bf16 v[44:47], v[20:23], a[136:143], v3
  v_smfmac_f32_16x16x64_bf16 v[48:51], v[20:23], a[192:199], v3
  v_smfmac_f32_16x16x64_bf16 v[52:55], v[20:23], a[248:255], v3
  v_smfmac_f32_16x16x64_bf16 v[56:59], v[20:23], v[224:231], v3
  v_smfmac_f32_16x16x64_bf16 v[36:39], v[24:27], a[32:39], v3
  v_smfmac_f32_16x16x64_bf16 v[40:43], v[24:27], a[88:95], v3
  v_smfmac_f32_16x16x64_bf16 v[44:47], v[24:27], a[144:151], v3
  v_smfmac_f32_16x16x64_bf16 v[48:51], v[24:27], a[200:207], v3
  v_smfmac_f32_16x16x64_bf16 v[52:55], v[24:27], v[176:183], v3
  v_smfmac_f32_16x16x64_bf16 v[56:59], v[24:27], v[232:239], v3
  v_smfmac_f32_16x16x64_bf16 v[36:39], v[28:31], a[40:47], v3
  v_smfmac_f32_16x16x64_bf16 v[40:43], v[28:31], a[96:103], v3
  v_smfmac_f32_16x16x64_bf16 v[44:47], v[28:31], a[152:159], v3
  v_smfmac_f32_16x16x64_bf16 v[48:51], v[28:31], a[208:215], v3
  v_smfmac_f32_16x16x64_bf16 v[52:55], v[28:31], v[184:191], v3
  v_smfmac_f32_16x16x64_bf16 v[56:59], v[28:31], v[240:247], v3
  v_smfmac_f32_16x16x64_bf16 v[36:39], v[32:35], a[48:55], v3
  v_smfmac_f32_16x16x64_bf16 v[40:43], v[32:35], a[104:111], v3
  v_smfmac_f32_16x16x64_bf16 v[44:47], v[32:35], a[160:167], v3
  v_smfmac_f32_16x16x64_bf16 v[48:51], v[32:35], a[216:223], v3
  v_smfmac_f32_16x16x64_bf16 v[52:55], v[32:35], v[192:199], v3
  v_smfmac_f32_16x16x64_bf16 v[56:59], v[32:35], v[248:255], v3
  v_permlane32_swap_b32 v36, v38
  v_permlane32_swap_b32 v37, v39
  v_add_f32 v36, v36, v38
  v_add_f32 v37, v37, v39
  v_cvt_pk_bf16_f32 v38, v36, v37
  ds_write_b32 v152, v38
  v_permlane32_swap_b32 v40, v42
  v_permlane32_swap_b32 v41, v43
  v_add_f32 v40, v40, v42
  v_add_f32 v41, v41, v43
  v_cvt_pk_bf16_f32 v42, v40, v41
  ds_write_b32 v153, v42
  v_permlane32_swap_b32 v44, v46
  v_permlane32_swap_b32 v45, v47
  v_add_f32 v44, v44, v46
  v_add_f32 v45, v45, v47
  v_cvt_pk_bf16_f32 v46, v44, v45
  ds_write_b32 v154, v46
  v_permlane32_swap_b32 v48, v50
  v_permlane32_swap_b32 v49, v51
  v_add_f32 v48, v48, v50
  v_add_f32 v49, v49, v51
  v_cvt_pk_bf16_f32 v50, v48, v49
  ds_write_b32 v155, v50
  v_permlane32_swap_b32 v52, v54
  v_permlane32_swap_b32 v53, v55
  v_add_f32 v52, v52, v54
  v_add_f32 v53, v53, v55
  v_cvt_pk_bf16_f32 v54, v52, v53
  ds_write_b32 v156, v54
  v_permlane32_swap_b32 v56, v58
  v_permlane32_swap_b32 v57, v59
  v_add_f32 v56, v56, v58
  v_add_f32 v57, v57, v59
  v_cvt_pk_bf16_f32 v58, v56, v57
  ds_write_b32 v157, v58
  buffer_load_dword v164, v4, s[8:11], 0 offen sc1
  buffer_load_dword v164, v4, s[8:11], 0 offen sc1
  buffer_load_dword v164, v4, s[8:11], 0 offen sc1
  buffer_load_dword v164, v4, s[8:11], 0 offen sc1
  buffer_load_dword v164, v4, s[8:11], 0 offen sc1
  s_branch cB_va0_t2d
cB_va0_last:
  s_barrier
  ds_read_b128 v[64:67], v2 offset:0
  ds_read_b128 v[68:71], v2 offset:1024
  ds_read_b128 v[72:75], v2 offset:2048
  ds_read_b128 v[76:79], v2 offset:3072
  s_waitcnt lgkmcnt(0)
  v_min_u32 v64, -2, v64
  v_min_u32 v65, -2, v65
  v_min_u32 v66, -2, v66
  v_min_u32 v67, -2, v67
  v_min_u32 v68, -2, v68
  v_min_u32 v69, -2, v69
  v_min_u32 v70, -2, v70
  v_min_u32 v71, -2, v71
  v_min_u32 v72, -2, v72
  v_min_u32 v73, -2, v73
  v_min_u32 v74, -2, v74
  v_min_u32 v75, -2, v75
  v_min_u32 v76, -2, v76
  v_min_u32 v77, -2, v77
  v_min_u32 v78, -2, v78
  v_min_u32 v79, -2, v79
  buffer_store_dwordx4 v[64:67], v2, s[8:11], s33 offen offset:0 sc1
  buffer_store_dwordx4 v[68:71], v2, s[8:11], s33 offen offset:2048 sc1
  s_add_u32 s33, s33, 4096
  buffer_store_dwordx4 v[72:75], v2, s[8:11], s33 offen offset:0 sc1
  buffer_store_dwordx4 v[76:79], v2, s[8:11], s33 offen offset:2048 sc1
  s_add_u32 s33, s33, 4096
  s_waitcnt vmcnt(0)
  buffer_wbl2 sc1
  s_branch cB_done
cB_va0_rp:
  s_cmp_eq_u32 s37, 0
  s_cbranch_scc1 cB_va0_rv
  v_min_u32 v160, -2, v160
  buffer_store_dword v160, v1, s[8:11], s21 offen sc1
  s_branch cB_va0_cont
cB_va0_rv:
  s_add_u32 s31, s31, 0x10000
  buffer_load_dwordx4 v[8:11], v2, s[8:11], s22 offen offset:0 sc1
  buffer_load_dwordx4 v[12:15], v2, s[8:11], s22 offen offset:1024 sc1
  buffer_load_dwordx4 v[16:19], v2, s[8:11], s22 offen offset:2048 sc1
  buffer_load_dwordx4 v[20:23], v2, s[8:11], s22 offen offset:3072 sc1
  buffer_load_dwordx4 v[24:27], v2, s[8:11], s34 offen offset:0 sc1
  buffer_load_dwordx4 v[28:31], v2, s[8:11], s34 offen offset:1024 sc1
  buffer_load_dwordx4 v[32:35], v2, s[8:11], s34 offen offset:2048 sc1
  buffer_load_dwordx4 v[36:39], v2, s[8:11], s34 offen offset:3072 sc1
  buffer_load_dwordx4 v[40:43], v2, s[8:11], s36 offen offset:0 sc1
  buffer_load_dwordx4 v[44:47], v2, s[8:11], s36 offen offset:1024 sc1
  s_waitcnt vmcnt(0)
  v_max3_u32 v52, v8, v9, v10
  v_max3_u32 v52, v52, v11, v12
  v_max3_u32 v52, v52, v13, v14
  v_max3_u32 v52, v52, v15, v16
  v_max3_u32 v52, v52, v17, v18
  v_max3_u32 v52, v52, v19, v20
  v_max3_u32 v52, v52, v21, v22
  v_max3_u32 v52, v52, v23, v24
  v_max3_u32 v52, v52, v25, v26
  v_max3_u32 v52, v52, v27, v28
  v_max3_u32 v52, v52, v29, v30
  v_max3_u32 v52, v52, v31, v32
  v_max3_u32 v52, v52, v33, v34
  v_max3_u32 v52, v52, v35, v36
  v_max3_u32 v52, v52, v37, v38
  v_max3_u32 v52, v52, v39, v40
  v_max3_u32 v52, v52, v41, v42
  v_max3_u32 v52, v52, v43, v44
  v_max3_u32 v52, v52, v45, v46
  v_max_u32 v52, v52, v47
  v_cmp_eq_u32 vcc, -1, v52
  s_mov_b32 s37, 1
  v_mov_b32 v48, 0
  v_mov_b32 v49, 0
  v_mov_b32 v50, 0
  v_mov_b32 v51, 0
  s_nop 1
  s_cbranch_vccz cB_va0_lp
  s_add_u32 s30, s30, 1
  s_cmp_lt_u32 s30, 400000
  s_cbranch_scc1 cB_va0_rv
  s_branch cB_abort
.p2align 6
cB_va1_loop:
  s_mov_b32 s30, 0
  s_barrier
  buffer_load_dwordx4 v[28:31], v2, s[8:11], s23 offen offset:1024 sc1
  buffer_load_dwordx4 v[32:35], v2, s[8:11], s23 offen offset:2048 sc1
  s_barrier
  s_cmp_lt_u32 s19, 60
  s_cbranch_scc1 cB_va1_m1
  buffer_store_dword v160, v1, s[8:11], s38 offen sc1
  s_cmp_lg_u32 s19, 63
  s_cbranch_scc1 cB_va1_m2
  v_min_u32 v64, -2, v64
  v_min_u32 v65, -2, v65
  v_min_u32 v66, -2, v66
  v_min_u32 v67, -2, v67
  v_min_u32 v68, -2, v68
  v_min_u32 v69, -2, v69
  v_min_u32 v70, -2, v70
  v_min_u32 v71, -2, v71
  v_min_u32 v72, -2, v72
  v_min_u32 v73, -2, v73
  v_min_u32 v74, -2, v74
  v_min_u32 v75, -2, v75
  v_min_u32 v76, -2, v76
  v_min_u32 v77, -2, v77
  v_min_u32 v78, -2, v78
  v_min_u32 v79, -2, v79
  buffer_store_dwordx4 v[64:67], v2, s[8:11], s33 offen offset:0 sc1
  buffer_store_dwordx4 v[68:71], v2, s[8:11], s33 offen offset:2048 sc1
  s_add_u32 s33, s33, 4096
  buffer_store_dwordx4 v[72:75], v2, s[8:11], s33 offen offset:0 sc1
  buffer_store_dwordx4 v[76:79], v2, s[8:11], s33 offen offset:2048 sc1
  s_add_u32 s33, s33, 4096
  s_waitcnt vmcnt(5)
  s_branch cB_va1_m3
cB_va1_m1:
  buffer_store_dword v160, v1, s[8:11], s38 offen sc1
cB_va1_m2:
  s_add_u32 s22, s25, 0
  buffer_load_dwordx4 v[80:83], v6, s[8:11], s22 offen offset:0 sc1
  buffer_load_dwordx4 v[84:87], v6, s[8:11], s22 offen offset:1792 sc1
  s_add_u32 s22, s25, 3584
  buffer_load_dwordx4 v[88:91], v6, s[8:11], s22 offen offset:0 sc1
  buffer_load_dwordx4 v[92:95], v6, s[8:11], s22 offen offset:1792 sc1
  s_add_u32 s22, s25, 7168
  buffer_load_dwordx4 v[96:99], v6, s[8:11], s22 offen offset:0 sc1
  s_mul_i32 s38, s18, 7168
  s_add_u32 s38, s38, 65536
  s_waitcnt vmcnt(6)
cB_va1_m3:
  ds_write_b128 v2, v[32:35] offset:14336
  v_smfmac_f32_16x16x64_bf16 v[36:39], v[28:31], a[40:47], v3
  buffer_load_dwordx4 v[100:103], v6, s[8:11], s22 offen offset:1792 sc1
  v_smfmac_f32_16x16x64_bf16 v[40:43], v[28:31], a[96:103], v3
  s_add_u32 s22, s25, 10752
  buffer_load_dwordx4 v[104:107], v6, s[8:11], s22 offen offset:0 sc1
  v_smfmac_f32_16x16x64_bf16 v[44:47], v[28:31], a[152:159], v3
  buffer_load_dwordx4 v[108:111], v6, s[8:11], s22 offen offset:1792 sc1
  v_smfmac_f32_16x16x64_bf16 v[48:51], v[28:31], a[208:215], v3
  s_add_u32 s22, s25, 14336
  buffer_load_dwordx4 v[112:115], v6, s[8:11], s22 offen offset:0 sc1
  v_smfmac_f32_16x16x64_bf16 v[52:55], v[28:31], v[184:191], v3
  s_waitcnt lgkmcnt(0)
  s_barrier
  ds_read_b128 v[8:11], v2 offset:8192
  ds_read_b128 v[12:15], v2 offset:9216
  ds_read_b128 v[16:19], v2 offset:10240
  ds_read_b128 v[20:23], v2 offset:11264
  ds_read_b128 v[24:27], v2 offset:12288
  buffer_load_dwordx4 v[116:119], v6, s[8:11], s22 offen offset:1792 sc1
  v_smfmac_f32_16x16x64_bf16 v[56:59], v[28:31], v[240:247], v3
  s_add_u32 s22, s25, 17920
  buffer_load_dwordx4 v[120:123], v6, s[8:11], s22 offen offset:0 sc1
  v_smfmac_f32_16x16x64_bf16 v[36:39], v[32:35], a[48:55], v3
  buffer_load_dwordx4 v[124:127], v6, s[8:11], s22 offen offset:1792 sc1
  v_smfmac_f32_16x16x64_bf16 v[40:43], v[32:35], a[104:111], v3
  s_add_u32 s22, s25, 21504
  buffer_load_dwordx4 v[128:131], v6, s[8:11], s22 offen offset:0 sc1
  v_smfmac_f32_16x16x64_bf16 v[44:47], v[32:35], a[160:167], v3
  buffer_load_dwordx4 v[132:135], v6, s[8:11], s22 offen offset:1792 sc1
  v_smfmac_f32_16x16x64_bf16 v[48:51], v[32:35], a[216:223], v3
  s_add_u32 s22, s25, 25088
  buffer_load_dwordx4 v[136:139], v6, s[8:11], s22 offen offset:0 sc1
  v_smfmac_f32_16x16x64_bf16 v[52:55], v[32:35], v[192:199], v3
  ds_read_b128 v[64:67], v0 offset:0
  ds_read_b128 v[68:71], v0 offset:1024
  buffer_load_dwordx4 v[140:143], v6, s[8:11], s22 offen offset:1792 sc1
  v_smfmac_f32_16x16x64_bf16 v[56:59], v[32:35], v[248:255], v3
  s_waitcnt lgkmcnt(6)
  ds_read_b128 v[72:75], v0 offset:2048
  ds_read_b128 v[76:79], v0 offset:3072
  v_smfmac_f32_16x16x64_bf16 v[36:39], v[8:11], a[0:7], v3
  s_waitcnt lgkmcnt(7)
  v_smfmac_f32_16x16x64_bf16 v[36:39], v[12:15], a[8:15], v3
  s_waitcnt lgkmcnt(6)
  v_smfmac_f32_16x16x64_bf16 v[36:39], v[16:19], a[16:23], v3
  s_waitcnt lgkmcnt(2)
  v_smfmac_f32_16x16x64_bf16 v[60:63], v[8:11], v[64:71], v3
  s_waitcnt lgkmcnt(5)
  ds_read_b128 v[144:147], v0 offset:4096
  ds_read_b128 v[148:151], v0 offset:5120
  v_smfmac_f32_16x16x64_bf16 v[36:39], v[20:23], a[24:31], v3
  s_waitcnt lgkmcnt(6)
  v_smfmac_f32_16x16x64_bf16 v[36:39], v[24:27], a[32:39], v3
  v_smfmac_f32_16x16x64_bf16 v[40:43], v[8:11], a[56:63], v3
  s_waitcnt lgkmcnt(2)
  v_smfmac_f32_16x16x64_bf16 v[60:63], v[12:15], v[72:79], v3
  ds_read_b128 v[64:67], v0 offset:6144
  ds_read_b128 v[68:71], v0 offset:7168
  v_smfmac_f32_16x16x64_bf16 v[40:43], v[12:15], a[64:71], v3
  v_permlane32_swap_b32 v36, v38
  v_smfmac_f32_16x16x64_bf16 v[40:43], v[16:19], a[72:79], v3
  v_permlane32_swap_b32 v37, v39
  v_smfmac_f32_16x16x64_bf16 v[40:43], v[20:23], a[80:87], v3
  s_waitcnt lgkmcnt(2)
  v_add_f32 v36, v36, v38
  v_smfmac_f32_16x16x64_bf16 v[60:63], v[16:19], v[144:151], v3
  ds_read_b128 v[72:75], v0 offset:8192
  ds_read_b128 v[76:79], v0 offset:9216
  v_add_f32 v37, v37, v39
  v_smfmac_f32_16x16x64_bf16 v[40:43], v[24:27], a[88:95], v3
  v_cmp_u_f32 vcc, v36, v37
  v_smfmac_f32_16x16x64_bf16 v[44:47], v[8:11], a[112:119], v3
  v_cvt_pk_bf16_f32 v38, v36, v37
  v_smfmac_f32_16x16x64_bf16 v[44:47], v[12:15], a[120:127], v3
  ds_write_b32 v152, v38
  s_waitcnt lgkmcnt(3)
  s_cbranch_vccnz cB_va1_slow
  v_permlane32_swap_b32 v40, v42
  v_smfmac_f32_16x16x64_bf16 v[60:63], v[20:23], v[64:71], v3
  ds_read_b128 v[144:147], v0 offset:10240
  ds_read_b128 v[148:151], v0 offset:11264
  v_permlane32_swap_b32 v41, v43
  v_smfmac_f32_16x16x64_bf16 v[44:47], v[16:19], a[128:135], v3
  buffer_store_dword v162, v1, s[8:11], s21 offen sc1
  v_add_f32 v40, v40, v42
  v_smfmac_f32_16x16x64_bf16 v[44:47], v[20:23], a[136:143], v3
  v_add_f32 v41, v41, v43
  v_smfmac_f32_16x16x64_bf16 v[44:47], v[24:27], a[144:151], v3
  s_waitcnt lgkmcnt(3)
  v_cvt_pk_bf16_f32 v42, v40, v41
  v_smfmac_f32_16x16x64_bf16 v[60:63], v[24:27], v[72:79], v3
  ds_write_b32 v153, v42
  ds_read_b128 v[64:67], v0 offset:12288
  ds_read_b128 v[68:71], v0 offset:13312
  v_smfmac_f32_16x16x64_bf16 v[48:51], v[8:11], a[168:175], v3
  s_nop 0
  v_permlane32_swap_b32 v44, v46
  v_smfmac_f32_16x16x64_bf16 v[48:51], v[12:15], a[176:183], v3
  v_permlane32_swap_b32 v45, v47
  v_smfmac_f32_16x16x64_bf16 v[48:51], v[16:19], a[184:191], v3
  s_waitcnt lgkmcnt(3)
  v_add_f32 v44, v44, v46
  v_smfmac_f32_16x16x64_bf16 v[60:63], v[28:31], v[144:151], v3
  v_add_f32 v45, v45, v47
  v_smfmac_f32_16x16x64_bf16 v[48:51], v[20:23], a[192:199], v3
  v_cvt_pk_bf16_f32 v46, v44, v45
  v_smfmac_f32_16x16x64_bf16 v[48:51], v[24:27], a[200:207], v3
  ds_write_b32 v154, v46
  v_smfmac_f32_16x16x64_bf16 v[52:55], v[8:11], a[224:231], v3
  s_waitcnt lgkmcnt(1)
  v_smfmac_f32_16x16x64_bf16 v[60:63], v[32:35], v[64:71], v3
  v_smfmac_f32_16x16x64_bf16 v[52:55], v[12:15], a[232:239], v3
  v_permlane32_swap_b32 v48, v50
  v_smfmac_f32_16x16x64_bf16 v[52:55], v[16:19], a[240:247], v3
  v_permlane32_swap_b32 v49, v51
  v_smfmac_f32_16x16x64_bf16 v[52:55], v[20:23], a[248:255], v3
  v_add_f32 v48, v48, v50
  v_smfmac_f32_16x16x64_bf16 v[52:55], v[24:27], v[176:183], v3
  v_add_f32 v49, v49, v51
  v_smfmac_f32_16x16x64_bf16 v[56:59], v[8:11], v[200:207], v3
  v_cvt_pk_bf16_f32 v50, v48, v49
  v_smfmac_f32_16x16x64_bf16 v[56:59], v[12:15], v[208:215], v3
  ds_write_b32 v155, v50
  v_permlane32_swap_b32 v60, v62
  v_smfmac_f32_16x16x64_bf16 v[56:59], v[16:19], v[216:223], v3
  v_permlane32_swap_b32 v61, v63
  v_smfmac_f32_16x16x64_bf16 v[56:59], v[20:23], v[224:231], v3
  v_add_f32 v60, v60, v62
  v_smfmac_f32_16x16x64_bf16 v[56:59], v[24:27], v[232:239], v3
  v_add_f32 v61, v61, v63
  v_cvt_pk_bf16_f32 v62, v60, v61
  ds_write_b32 v158, v62
  v_permlane32_swap_b32 v52, v54
  v_permlane32_swap_b32 v53, v55
  v_add_f32 v52, v52, v54
  v_add_f32 v53, v53, v55
  v_cvt_pk_bf16_f32 v54, v52, v53
  ds_write_b32 v156, v54
  v_permlane32_swap_b32 v56, v58
  v_permlane32_swap_b32 v57, v59
  v_add_f32 v56, v56, v58
  v_add_f32 v57, v57, v59
  v_cvt_pk_bf16_f32 v58, v56, v57
  ds_write_b32 v157, v58
cB_va1_t2d:
  s_add_u32 s22, s20, 9216
  s_add_u32 s34, s20, 13312
  s_add_u32 s36, s20, 7168
  s_mov_b32 s37, 0
  v_mov_b32 v48, 0
  v_mov_b32 v49, 0
  v_mov_b32 v50, 0
  v_mov_b32 v51, 0
  v_mov_b32 v163, s18
  s_cmp_eq_u32 s19, 63
  s_waitcnt lgkmcnt(0)
  s_cbranch_scc1 cB_va1_last
  s_barrier
  buffer_load_dwordx4 v[8:11], v2, s[8:11], s22 offen offset:0 sc1
  buffer_load_dwordx4 v[12:15], v2, s[8:11], s22 offen offset:1024 sc1
  buffer_load_dwordx4 v[16:19], v2, s[8:11], s22 offen offset:2048 sc1
  buffer_load_dwordx4 v[20:23], v2, s[8:11], s22 offen offset:3072 sc1
  buffer_load_dwordx4 v[24:27], v2, s[8:11], s34 offen offset:0 sc1
  buffer_load_dwordx4 v[28:31], v2, s[8:11], s34 offen offset:1024 sc1
  buffer_load_dwordx4 v[32:35], v2, s[8:11], s34 offen offset:2048 sc1
  buffer_load_dwordx4 v[36:39], v2, s[8:11], s34 offen offset:3072 sc1
  buffer_load_dwordx4 v[40:43], v2, s[8:11], s36 offen offset:0 sc1
  buffer_load_dwordx4 v[44:47], v2, s[8:11], s36 offen offset:1024 sc1
  ds_read_b128 v[64:67], v2 offset:4096
  ds_read_b128 v[68:71], v2 offset:5120
  ds_read_b128 v[72:75], v2 offset:6144
  ds_read_b128 v[76:79], v2 offset:7168
cB_va1_lp:
  s_waitcnt vmcnt(9)
  v_smfmac_f32_16x16x64_bf16 v[48:51], v[8:11], v[80:87], v3
  s_waitcnt vmcnt(8)
  v_smfmac_f32_16x16x64_bf16 v[48:51], v[12:15], v[88:95], v3
  s_waitcnt vmcnt(7)
  v_smfmac_f32_16x16x64_bf16 v[48:51], v[16:19], v[96:103], v3
  v_max3_u32 v55, v8, v12, v16
  s_waitcnt vmcnt(6)
  v_smfmac_f32_16x16x64_bf16 v[48:51], v[20:23], v[104:111], v3
  v_max_u32 v55, v55, v20
  v_cmp_eq_u32 vcc, -1, v55
  s_waitcnt vmcnt(5)
  v_smfmac_f32_16x16x64_bf16 v[48:51], v[24:27], v[112:119], v3
  s_waitcnt vmcnt(4)
  v_smfmac_f32_16x16x64_bf16 v[48:51], v[28:31], v[120:127], v3
  s_cbranch_vccnz cB_va1_rv
  buffer_store_dword v163, v7, s[8:11], 0 offen sc1
  s_waitcnt vmcnt(4)
  v_smfmac_f32_16x16x64_bf16 v[48:51], v[32:35], v[128:135], v3
  s_waitcnt vmcnt(3)
  v_smfmac_f32_16x16x64_bf16 v[48:51], v[36:39], v[136:143], v3
  s_waitcnt vmcnt(2) lgkmcnt(0)
  v_smfmac_f32_16x16x64_bf16 v[48:51], v[40:43], v[64:71], v3
  s_waitcnt vmcnt(1)
  v_smfmac_f32_16x16x64_bf16 v[48:51], v[44:47], v[72:79], v3
  s_nop 7
  v_permlane32_swap_b32 v48, v50
  v_permlane32_swap_b32 v49, v51
  v_pk_add_f32 v[48:49], v[48:49], v[50:51]
  v_cvt_pk_bf16_f32 v160, v48, v49
  v_cmp_u_f32 vcc, v48, v49
  s_nop 0
  v_mov_b32_dpp v161, v160 quad_perm:[1,0,3,2] row_mask:0xf bank_mask:0xf
  v_perm_b32 v160, v161, v160, v5
  v_cndmask_b32 v161, v160, v162, vcc
  buffer_store_dword v161, v1, s[8:11], s21 offen sc1
  s_cbranch_vccnz cB_va1_rp
cB_va1_cont:
  s_cmp_lg_u32 s19, 62
  s_cbranch_scc1 cB_va1_nl
  buffer_store_dword v160, v1, s[8:11], s38 offen sc1
  s_mov_b32 s38, 0x40000000
  s_mov_b32 s25, 0x40000000
cB_va1_nl:
  s_add_u32 s25, s25, 458752
  v_mov_b32 v36, 0
  v_mov_b32 v37, 0
  v_mov_b32 v38, 0
  v_mov_b32 v39, 0
  v_mov_b32 v40, 0
  v_mov_b32 v41, 0
  v_mov_b32 v42, 0
  v_mov_b32 v43, 0
  v_mov_b32 v44, 0
  v_mov_b32 v45, 0
  v_mov_b32 v46, 0
  v_mov_b32 v47, 0
  v_mov_b32 v48, 0
  v_mov_b32 v49, 0
  v_mov_b32 v50, 0
  v_mov_b32 v51, 0
  v_mov_b32 v52, 0
  v_mov_b32 v53, 0
  v_mov_b32 v54, 0
  v_mov_b32 v55, 0
  v_mov_b32 v56, 0
  v_mov_b32 v57, 0
  v_mov_b32 v58, 0
  v_mov_b32 v59, 0
  v_mov_b32 v60, 0
  v_mov_b32 v61, 0
  v_mov_b32 v62, 0
  v_mov_b32 v63, 0
  s_mov_b32 s19, s18
  s_add_u32 s18, s18, 1
  s_mov_b32 s22, s20
  s_mov_b32 s20, s21
  s_mov_b32 s21, s22
  s_add_u32 s23, s20, 4096
  s_branch cB_va1_loop
cB_va1_slow:
  s_waitcnt lgkmcnt(0)
cB_va1_sl1:
  s_add_u32 s31, s31, 0x1000000
  buffer_load_dwordx4 v[8:11], v2, s[8:11], s20 offen offset:0 sc1
  buffer_load_dwordx4 v[12:15], v2, s[8:11], s20 offen offset:1024 sc1
  buffer_load_dwordx4 v[16:19], v2, s[8:11], s20 offen offset:2048 sc1
  buffer_load_dwordx4 v[20:23], v2, s[8:11], s20 offen offset:3072 sc1
  buffer_load_dwordx4 v[24:27], v2, s[8:11], s23 offen offset:0 sc1
  buffer_load_dwordx4 v[28:31], v2, s[8:11], s23 offen offset:1024 sc1
  buffer_load_dwordx4 v[32:35], v2, s[8:11], s23 offen offset:2048 sc1
  s_waitcnt vmcnt(0)
  v_max3_u32 v36, v8, v9, v10
  v_max3_u32 v36, v36, v11, v12
  v_max3_u32 v36, v36, v13, v14
  v_max3_u32 v36, v36, v15, v16
  v_max3_u32 v36, v36, v17, v18
  v_max3_u32 v36, v36, v19, v20
  v_max3_u32 v36, v36, v21, v22
  v_max3_u32 v36, v36, v23, v24
  v_max3_u32 v36, v36, v25, v26
  v_max3_u32 v36, v36, v27, v28
  v_max3_u32 v36, v36, v29, v30
  v_max3_u32 v36, v36, v31, v32
  v_max3_u32 v36, v36, v33, v34
  v_max_u32 v36, v36, v35
  v_cmp_eq_u32 vcc, -1, v36
  s_cbranch_vccz cB_va1_sl2
  s_add_u32 s30, s30, 1
  s_cmp_lt_u32 s30, 400000
  s_cbranch_scc1 cB_va1_sl1
  s_branch cB_abort
cB_va1_sl2:
  v_mov_b32 v36, 0
  v_mov_b32 v37, 0
  v_mov_b32 v38, 0
  v_mov_b32 v39, 0
  v_mov_b32 v40, 0
  v_mov_b32 v41, 0
  v_mov_b32 v42, 0
  v_mov_b32 v43, 0
  v_mov_b32 v44, 0
  v_mov_b32 v45, 0
  v_mov_b32 v46, 0
  v_mov_b32 v47, 0
  v_mov_b32 v48, 0
  v_mov_b32 v49, 0
  v_mov_b32 v50, 0
  v_mov_b32 v51, 0
  v_mov_b32 v52, 0
  v_mov_b32 v53, 0
  v_mov_b32 v54, 0
  v_mov_b32 v55, 0
  v_mov_b32 v56, 0
  v_mov_b32 v57, 0
  v_mov_b32 v58, 0
  v_mov_b32 v59, 0
  v_mov_b32 v60, 0
  v_mov_b32 v61, 0
  v_mov_b32 v62, 0
  v_mov_b32 v63, 0
  buffer_store_dword v162, v1, s[8:11], s21 offen sc1
  ds_read_b128 v[64:67], v0 offset:0
  ds_read_b128 v[68:71], v0 offset:1024
  v_smfmac_f32_16x16x64_bf16 v[36:39], v[8:11], a[0:7], v3
  v_smfmac_f32_16x16x64_bf16 v[40:43], v[8:11], a[56:63], v3
  v_smfmac_f32_16x16x64_bf16 v[44:47], v[8:11], a[112:119], v3
  v_smfmac_f32_16x16x64_bf16 v[48:51], v[8:11], a[168:175], v3
  v_smfmac_f32_16x16x64_bf16 v[52:55], v[8:11], a[224:231], v3
  v_smfmac_f32_16x16x64_bf16 v[56:59], v[8:11], v[200:207], v3
  s_waitcnt lgkmcnt(0)
  v_smfmac_f32_16x16x64_bf16 v[60:63], v[8:11], v[64:71], v3
  ds_read_b128 v[72:75], v0 offset:2048
  ds_read_b128 v[76:79], v0 offset:3072
  v_smfmac_f32_16x16x64_bf16 v[36:39], v[12:15], a[8:15], v3
  v_smfmac_f32_16x16x64_bf16 v[40:43], v[12:15], a[64:71], v3
  v_smfmac_f32_16x16x64_bf16 v[44:47], v[12:15], a[120:127], v3
  v_smfmac_f32_16x16x64_bf16 v[48:51], v[12:15], a[176:183], v3
  v_smfmac_f32_16x16x64_bf16 v[52:55], v[12:15], a[232:239], v3
  v_smfmac_f32_16x16x64_bf16 v[56:59], v[12:15], v[208:215], v3
  s_waitcnt lgkmcnt(0)
  v_smfmac_f32_16x16x64_bf16 v[60:63], v[12:15], v[72:79], v3
  ds_read_b128 v[144:147], v0 offset:4096
  ds_read_b128 v[148:151], v0 offset:5120
  v_smfmac_f32_16x16x64_bf16 v[36:39], v[16:19], a[16:23], v3
  v_smfmac_f32_16x16x64_bf16 v[40:43], v[16:19], a[72:79], v3
  v_smfmac_f32_16x16x64_bf16 v[44:47], v[16:19], a[128:135], v3
  v_smfmac_f32_16x16x64_bf16 v[48:51], v[16:19], a[184:191], v3
  v_smfmac_f32_16x16x64_bf16 v[52:55], v[16:19], a[240:247], v3
  v_smfmac_f32_16x16x64_bf16 v[56:59], v[16:19], v[216:223], v3
  s_waitcnt lgkmcnt(0)
  v_smfmac_f32_16x16x64_bf16 v[60:63], v[16:19], v[144:151], v3
  ds_read_b128 v[64:67], v0 offset:6144
  ds_read_b128 v[68:71], v0 offset:7168
  v_smfmac_f32_16x16x64_bf16 v[36:39], v[20:23], a[24:31], v3
  v_smfmac_f32_16x16x64_bf16 v[40:43], v[20:23], a[80:87], v3
  v_smfmac_f32_16x16x64_bf16 v[44:47], v[20:23], a[136:143], v3
  v_smfmac_f32_16x16x64_bf16 v[48:51], v[20:23], a[192:199], v3
  v_smfmac_f32_16x16x64_bf16 v[52:55], v[20:23], a[248:255], v3
  v_smfmac_f32_16x16x64_bf16 v[56:59], v[20:23], v[224:231], v3
  s_waitcnt lgkmcnt(0)
  v_smfmac_f32_16x16x64_bf16 v[60:63], v[20:23], v[64:71], v3
  ds_read_b128 v[72:75], v0 offset:8192
  ds_read_b128 v[76:79], v0 offset:9216
  v_smfmac_f32_16x16x64_bf16 v[36:39], v[24:27], a[32:39], v3
  v_smfmac_f32_16x16x64_bf16 v[40:43], v[24:27], a[88:95], v3
  v_smfmac_f32_16x16x64_bf16 v[44:47], v[24:27], a[144:151], v3
  v_smfmac_f32_16x16x64_bf16 v[48:51], v[24:27], a[200:207], v3
  v_smfmac_f32_16x16x64_bf16 v[52:55], v[24:27], v[176:183], v3
  v_smfmac_f32_16x16x64_bf16 v[56:59], v[24:27], v[232:239], v3
  s_waitcnt lgkmcnt(0)
  v_smfmac_f32_16x16x64_bf16 v[60:63], v[24:27], v[72:79], v3
  ds_read_b128 v[144:147], v0 offset:10240
  ds_read_b128 v[148:151], v0 offset:11264
  v_smfmac_f32_16x16x64_bf16 v[36:39], v[28:31], a[40:47], v3
  v_smfmac_f32_16x16x64_bf16 v[40:43], v[28:31], a[96:103], v3
  v_smfmac_f32_16x16x64_bf16 v[44:47], v[28:31], a[152:159], v3
  v_smfmac_f32_16x16x64_bf16 v[48:51], v[28:31], a[208:215], v3
  v_smfmac_f32_16x16x64_bf16 v[52:55], v[28:31], v[184:191], v3
  v_smfmac_f32_16x16x64_bf16 v[56:59], v[28:31], v[240:247], v3
  s_waitcnt lgkmcnt(0)
  v_smfmac_f32_16x16x64_bf16 v[60:63], v[28:31], v[144:151], v3
  ds_read_b128 v[64:67], v0 offset:12288
  ds_read_b128 v[68:71], v0 offset:13312
  v_smfmac_f32_16x16x64_bf16 v[36:39], v[32:35], a[48:55], v3
  v_smfmac_f32_16x16x64_bf16 v[40:43], v[32:35], a[104:111], v3
  v_smfmac_f32_16x16x64_bf16 v[44:47], v[32:35], a[160:167], v3
  v_smfmac_f32_16x16x64_bf16 v[48:51], v[32:35], a[216:223], v3
  v_smfmac_f32_16x16x64_bf16 v[52:55], v[32:35], v[192:199], v3
  v_smfmac_f32_16x16x64_bf16 v[56:59], v[32:35], v[248:255], v3
  s_waitcnt lgkmcnt(0)
  v_smfmac_f32_16x16x64_bf16 v[60:63], v[32:35], v[64:71], v3
  v_permlane32_swap_b32 v36, v38
  v_permlane32_swap_b32 v37, v39
  v_add_f32 v36, v36, v38
  v_add_f32 v37, v37, v39
  v_cvt_pk_bf16_f32 v38, v36, v37
  ds_write_b32 v152, v38
  v_permlane32_swap_b32 v40, v42
  v_permlane32_swap_b32 v41, v43
  v_add_f32 v40, v40, v42
  v_add_f32 v41, v41, v43
  v_cvt_pk_bf16_f32 v42, v40, v41
  ds_write_b32 v153, v42
  v_permlane32_swap_b32 v44, v46
  v_permlane32_swap_b32 v45, v47
  v_add_f32 v44, v44, v46
  v_add_f32 v45, v45, v47
  v_cvt_pk_bf16_f32 v46, v44, v45
  ds_write_b32 v154, v46
  v_permlane32_swap_b32 v48, v50
  v_permlane32_swap_b32 v49, v51
  v_add_f32 v48, v48, v50
  v_add_f32 v49, v49, v51
  v_cvt_pk_bf16_f32 v50, v48, v49
  ds_write_b32 v155, v50
  v_permlane32_swap_b32 v52, v54
  v_permlane32_swap_b32 v53, v55
  v_add_f32 v52, v52, v54
  v_add_f32 v53, v53, v55
  v_cvt_pk_bf16_f32 v54, v52, v53
  ds_write_b32 v156, v54
  v_permlane32_swap_b32 v56, v58
  v_permlane32_swap_b32 v57, v59
  v_add_f32 v56, v56, v58
  v_add_f32 v57, v57, v59
  v_cvt_pk_bf16_f32 v58, v56, v57
  ds_write_b32 v157, v58
  v_permlane32_swap_b32 v60, v62
  v_permlane32_swap_b32 v61, v63
  v_add_f32 v60, v60, v62
  v_add_f32 v61, v61, v63
  v_cvt_pk_bf16_f32 v62, v60, v61
  ds_write_b32 v158, v62
  s_branch cB_va1_t2d
cB_va1_last:
  s_barrier
  ds_read_b128 v[64:67], v2 offset:4096
  ds_read_b128 v[68:71], v2 offset:5120
  ds_read_b128 v[72:75], v2 offset:6144
  ds_read_b128 v[76:79], v2 offset:7168
  s_waitcnt lgkmcnt(0)
  v_min_u32 v64, -2, v64
  v_min_u32 v65, -2, v65
  v_min_u32 v66, -2, v66
  v_min_u32 v67, -2, v67
  v_min_u32 v68, -2, v68
  v_min_u32 v69, -2, v69
  v_min_u32 v70, -2, v70
  v_min_u32 v71, -2, v71
  v_min_u32 v72, -2, v72
  v_min_u32 v73, -2, v73
  v_min_u32 v74, -2, v74
  v_min_u32 v75, -2, v75
  v_min_u32 v76, -2, v76
  v_min_u32 v77, -2, v77
  v_min_u32 v78, -2, v78
  v_min_u32 v79, -2, v79
  buffer_store_dwordx4 v[64:67], v2, s[8:11], s33 offen offset:0 sc1
  buffer_store_dwordx4 v[68:71], v2, s[8:11], s33 offen offset:2048 sc1
  s_add_u32 s33, s33, 4096
  buffer_store_dwordx4 v[72:75], v2, s[8:11], s33 offen offset:0 sc1
  buffer_store_dwordx4 v[76:79], v2, s[8:11], s33 offen offset:2048 sc1
  s_add_u32 s33, s33, 4096
  s_waitcnt vmcnt(0)
  buffer_wbl2 sc1
  s_branch cB_done
cB_va1_rp:
  s_cmp_eq_u32 s37, 0
  s_cbranch_scc1 cB_va1_rv
  v_min_u32 v160, -2, v160
  buffer_store_dword v160, v1, s[8:11], s21 offen sc1
  s_branch cB_va1_cont
cB_va1_rv:
  s_add_u32 s31, s31, 0x10000
  buffer_load_dwordx4 v[8:11], v2, s[8:11], s22 offen offset:0 sc1
  buffer_load_dwordx4 v[12:15], v2, s[8:11], s22 offen offset:1024 sc1
  buffer_load_dwordx4 v[16:19], v2, s[8:11], s22 offen offset:2048 sc1
  buffer_load_dwordx4 v[20:23], v2, s[8:11], s22 offen offset:3072 sc1
  buffer_load_dwordx4 v[24:27], v2, s[8:11], s34 offen offset:0 sc1
  buffer_load_dwordx4 v[28:31], v2, s[8:11], s34 offen offset:1024 sc1
  buffer_load_dwordx4 v[32:35], v2, s[8:11], s34 offen offset:2048 sc1
  buffer_load_dwordx4 v[36:39], v2, s[8:11], s34 offen offset:3072 sc1
  buffer_load_dwordx4 v[40:43], v2, s[8:11], s36 offen offset:0 sc1
  buffer_load_dwordx4 v[44:47], v2, s[8:11], s36 offen offset:1024 sc1
  s_waitcnt vmcnt(0)
  v_max3_u32 v52, v8, v9, v10
  v_max3_u32 v52, v52, v11, v12
  v_max3_u32 v52, v52, v13, v14
  v_max3_u32 v52, v52, v15, v16
  v_max3_u32 v52, v52, v17, v18
  v_max3_u32 v52, v52, v19, v20
  v_max3_u32 v52, v52, v21, v22
  v_max3_u32 v52, v52, v23, v24
  v_max3_u32 v52, v52, v25, v26
  v_max3_u32 v52, v52, v27, v28
  v_max3_u32 v52, v52, v29, v30
  v_max3_u32 v52, v52, v31, v32
  v_max3_u32 v52, v52, v33, v34
  v_max3_u32 v52, v52, v35, v36
  v_max3_u32 v52, v52, v37, v38
  v_max3_u32 v52, v52, v39, v40
  v_max3_u32 v52, v52, v41, v42
  v_max3_u32 v52, v52, v43, v44
  v_max3_u32 v52, v52, v45, v46
  v_max_u32 v52, v52, v47
  v_cmp_eq_u32 vcc, -1, v52
  s_mov_b32 s37, 1
  v_mov_b32 v48, 0
  v_mov_b32 v49, 0
  v_mov_b32 v50, 0
  v_mov_b32 v51, 0
  s_nop 1
  s_cbranch_vccz cB_va1_lp
  s_add_u32 s30, s30, 1
  s_cmp_lt_u32 s30, 400000
  s_cbranch_scc1 cB_va1_rv
  s_branch cB_abort
.p2align 6
cB_va2_loop:
  s_mov_b32 s30, 0
cB_va2_fp_l:
  v_cmp_gt_u32 vcc, s19, v96
  buffer_load_dword v96, v119, s[8:11], 0 offen sc1
  s_cbranch_vccz cB_va2_fp_d
  v_cmp_gt_u32 vcc, s19, v96
  buffer_load_dword v96, v119, s[8:11], 0 offen sc1
  s_cbranch_vccz cB_va2_fp_d
  v_cmp_gt_u32 vcc, s19, v96
  buffer_load_dword v96, v119, s[8:11], 0 offen sc1
  s_cbranch_vccz cB_va2_fp_d
  v_cmp_gt_u32 vcc, s19, v96
  buffer_load_dword v96, v119, s[8:11], 0 offen sc1
  s_cbranch_vccz cB_va2_fp_d
  v_cmp_gt_u32 vcc, s19, v96
  buffer_load_dword v96, v119, s[8:11], 0 offen sc1
  s_cbranch_vccz cB_va2_fp_d
  v_cmp_gt_u32 vcc, s19, v96
  buffer_load_dword v96, v119, s[8:11], 0 offen sc1
  s_cbranch_vccz cB_va2_fp_d
  v_cmp_gt_u32 vcc, s19, v96
  buffer_load_dword v96, v119, s[8:11], 0 offen sc1
  s_cbranch_vccz cB_va2_fp_d
  v_cmp_gt_u32 vcc, s19, v96
  buffer_load_dword v96, v119, s[8:11], 0 offen sc1
  s_cbranch_vccz cB_va2_fp_d
  v_cmp_gt_u32 vcc, s19, v96
  buffer_load_dword v96, v119, s[8:11], 0 offen sc1
  s_cbranch_vccz cB_va2_fp_d
  v_cmp_gt_u32 vcc, s19, v96
  buffer_load_dword v96, v119, s[8:11], 0 offen sc1
  s_cbranch_vccz cB_va2_fp_d
  v_cmp_gt_u32 vcc, s19, v96
  buffer_load_dword v96, v119, s[8:11], 0 offen sc1
  s_cbranch_vccz cB_va2_fp_d
  v_cmp_gt_u32 vcc, s19, v96
  buffer_load_dword v96, v119, s[8:11], 0 offen sc1
  s_cbranch_vccz cB_va2_fp_d
  v_cmp_gt_u32 vcc, s19, v96
  buffer_load_dword v96, v119, s[8:11], 0 offen sc1
  s_cbranch_vccz cB_va2_fp_d
  v_cmp_gt_u32 vcc, s19, v96
  buffer_load_dword v96, v119, s[8:11], 0 offen sc1
  s_cbranch_vccz cB_va2_fp_d
  v_cmp_gt_u32 vcc, s19, v96
  buffer_load_dword v96, v119, s[8:11], 0 offen sc1
  s_cbranch_vccz cB_va2_fp_d
  v_cmp_gt_u32 vcc, s19, v96
  buffer_load_dword v96, v119, s[8:11], 0 offen sc1
  s_cbranch_vccz cB_va2_fp_d
  s_waitcnt vmcnt(24)
  s_add_u32 s30, s30, 1
  s_cmp_lt_u32 s30, 400000
  s_cbranch_scc1 cB_va2_fp_l
  s_branch cB_abort
cB_va2_fp_d:
  buffer_load_dwordx4 v[8:11], v2, s[8:11], s20 offen offset:0 sc1
  buffer_load_dwordx4 v[12:15], v2, s[8:11], s20 offen offset:1024 sc1
  s_barrier
  s_barrier
  s_waitcnt vmcnt(0)
  ds_write_b128 v2, v[8:11] offset:8192
  ds_write_b128 v2, v[12:15] offset:9216
  v_smfmac_f32_16x16x64_bf16 v[36:39], v[8:11], a[0:7], v3
  v_smfmac_f32_16x16x64_bf16 v[40:43], v[8:11], a[56:63], v3
  v_smfmac_f32_16x16x64_bf16 v[44:47], v[8:11], a[112:119], v3
  v_smfmac_f32_16x16x64_bf16 v[48:51], v[8:11], a[168:175], v3
  v_smfmac_f32_16x16x64_bf16 v[52:55], v[8:11], a[224:231], v3
  s_waitcnt lgkmcnt(0)
  s_barrier
  ds_read_b128 v[16:19], v2 offset:10240
  ds_read_b128 v[20:23], v2 offset:11264
  ds_read_b128 v[24:27], v2 offset:12288
  ds_read_b128 v[28:31], v2 offset:13312
  ds_read_b128 v[32:35], v2 offset:14336
  v_smfmac_f32_16x16x64_bf16 v[56:59], v[8:11], v[144:151], v3
  v_smfmac_f32_16x16x64_bf16 v[60:63], v[8:11], v[200:207], v3
  v_smfmac_f32_16x16x64_bf16 v[36:39], v[12:15], a[8:15], v3
  v_smfmac_f32_16x16x64_bf16 v[40:43], v[12:15], a[64:71], v3
  v_smfmac_f32_16x16x64_bf16 v[44:47], v[12:15], a[120:127], v3
  v_smfmac_f32_16x16x64_bf16 v[48:51], v[12:15], a[176:183], v3
  v_smfmac_f32_16x16x64_bf16 v[52:55], v[12:15], a[232:239], v3
  v_smfmac_f32_16x16x64_bf16 v[56:59], v[12:15], v[152:159], v3
  ds_read_b128 v[68:71], v0 offset:0
  ds_read_b128 v[72:75], v0 offset:1024
  v_smfmac_f32_16x16x64_bf16 v[60:63], v[12:15], v[208:215], v3
  s_waitcnt lgkmcnt(6)
  ds_read_b128 v[76:79], v0 offset:2048
  ds_read_b128 v[80:83], v0 offset:3072
  v_smfmac_f32_16x16x64_bf16 v[36:39], v[16:19], a[16:23], v3
  s_waitcnt lgkmcnt(7)
  v_smfmac_f32_16x16x64_bf16 v[36:39], v[20:23], a[24:31], v3
  s_waitcnt lgkmcnt(6)
  v_smfmac_f32_16x16x64_bf16 v[36:39], v[24:27], a[32:39], v3
  s_waitcnt lgkmcnt(2)
  v_smfmac_f32_16x16x64_bf16 v[64:67], v[8:11], v[68:75], v3
  s_waitcnt lgkmcnt(5)
  ds_read_b128 v[84:87], v0 offset:4096
  ds_read_b128 v[88:91], v0 offset:5120
  v_smfmac_f32_16x16x64_bf16 v[36:39], v[28:31], a[40:47], v3
  s_waitcnt lgkmcnt(6)
  v_smfmac_f32_16x16x64_bf16 v[36:39], v[32:35], a[48:55], v3
  v_smfmac_f32_16x16x64_bf16 v[40:43], v[16:19], a[72:79], v3
  s_waitcnt lgkmcnt(2)
  v_smfmac_f32_16x16x64_bf16 v[64:67], v[12:15], v[76:83], v3
  ds_read_b128 v[68:71], v0 offset:6144
  ds_read_b128 v[72:75], v0 offset:7168
  v_smfmac_f32_16x16x64_bf16 v[40:43], v[20:23], a[80:87], v3
  v_permlane32_swap_b32 v36, v38
  v_smfmac_f32_16x16x64_bf16 v[40:43], v[24:27], a[88:95], v3
  v_permlane32_swap_b32 v37, v39
  v_smfmac_f32_16x16x64_bf16 v[40:43], v[28:31], a[96:103], v3
  s_waitcnt lgkmcnt(2)
  v_add_f32 v36, v36, v38
  v_smfmac_f32_16x16x64_bf16 v[64:67], v[16:19], v[84:91], v3
  ds_read_b128 v[76:79], v0 offset:8192
  ds_read_b128 v[80:83], v0 offset:9216
  v_add_f32 v37, v37, v39
  v_smfmac_f32_16x16x64_bf16 v[40:43], v[32:35], a[104:111], v3
  v_cmp_u_f32 vcc, v36, v37
  v_smfmac_f32_16x16x64_bf16 v[44:47], v[16:19], a[128:135], v3
  v_cvt_pk_bf16_f32 v38, v36, v37
  v_smfmac_f32_16x16x64_bf16 v[44:47], v[20:23], a[136:143], v3
  ds_write_b32 v104, v38
  s_waitcnt lgkmcnt(3)
  s_cbranch_vccnz cB_va2_slow
  v_permlane32_swap_b32 v40, v42
  v_smfmac_f32_16x16x64_bf16 v[64:67], v[20:23], v[68:75], v3
  ds_read_b128 v[84:87], v0 offset:10240
  ds_read_b128 v[88:91], v0 offset:11264
  v_permlane32_swap_b32 v41, v43
  v_smfmac_f32_16x16x64_bf16 v[44:47], v[24:27], a[144:151], v3
  v_add_f32 v40, v40, v42
  v_smfmac_f32_16x16x64_bf16 v[44:47], v[28:31], a[152:159], v3
  v_add_f32 v41, v41, v43
  v_smfmac_f32_16x16x64_bf16 v[44:47], v[32:35], a[160:167], v3
  s_waitcnt lgkmcnt(3)
  v_cvt_pk_bf16_f32 v42, v40, v41
  v_smfmac_f32_16x16x64_bf16 v[64:67], v[24:27], v[76:83], v3
  ds_write_b32 v105, v42
  ds_read_b128 v[68:71], v0 offset:12288
  ds_read_b128 v[72:75], v0 offset:13312
  v_smfmac_f32_16x16x64_bf16 v[48:51], v[16:19], a[184:191], v3
  s_nop 0
  v_permlane32_swap_b32 v44, v46
  v_smfmac_f32_16x16x64_bf16 v[48:51], v[20:23], a[192:199], v3
  v_permlane32_swap_b32 v45, v47
  v_smfmac_f32_16x16x64_bf16 v[48:51], v[24:27], a[200:207], v3
  s_waitcnt lgkmcnt(3)
  v_add_f32 v44, v44, v46
  v_smfmac_f32_16x16x64_bf16 v[64:67], v[28:31], v[84:91], v3
  v_add_f32 v45, v45, v47
  v_smfmac_f32_16x16x64_bf16 v[48:51], v[28:31], a[208:215], v3
  v_cvt_pk_bf16_f32 v46, v44, v45
  v_smfmac_f32_16x16x64_bf16 v[48:51], v[32:35], a[216:223], v3
  ds_write_b32 v106, v46
  v_smfmac_f32_16x16x64_bf16 v[52:55], v[16:19], a[240:247], v3
  s_waitcnt lgkmcnt(1)
  v_smfmac_f32_16x16x64_bf16 v[64:67], v[32:35], v[68:75], v3
  v_smfmac_f32_16x16x64_bf16 v[52:55], v[20:23], a[248:255], v3
  v_permlane32_swap_b32 v48, v50
  v_smfmac_f32_16x16x64_bf16 v[52:55], v[24:27], v[120:127], v3
  v_permlane32_swap_b32 v49, v51
  v_smfmac_f32_16x16x64_bf16 v[52:55], v[28:31], v[128:135], v3
  v_add_f32 v48, v48, v50
  v_smfmac_f32_16x16x64_bf16 v[52:55], v[32:35], v[136:143], v3
  v_add_f32 v49, v49, v51
  v_smfmac_f32_16x16x64_bf16 v[56:59], v[16:19], v[160:167], v3
  v_cvt_pk_bf16_f32 v50, v48, v49
  v_smfmac_f32_16x16x64_bf16 v[56:59], v[20:23], v[168:175], v3
  ds_write_b32 v107, v50
  v_permlane32_swap_b32 v64, v66
  v_smfmac_f32_16x16x64_bf16 v[56:59], v[24:27], v[176:183], v3
  v_permlane32_swap_b32 v65, v67
  v_smfmac_f32_16x16x64_bf16 v[56:59], v[28:31], v[184:191], v3
  v_add_f32 v64, v64, v66
  v_smfmac_f32_16x16x64_bf16 v[56:59], v[32:35], v[192:199], v3
  v_add_f32 v65, v65, v67
  v_smfmac_f32_16x16x64_bf16 v[60:63], v[16:19], v[216:223], v3
  v_cvt_pk_bf16_f32 v66, v64, v65
  v_smfmac_f32_16x16x64_bf16 v[60:63], v[20:23], v[224:231], v3
  ds_write_b32 v111, v66
  v_permlane32_swap_b32 v52, v54
  v_smfmac_f32_16x16x64_bf16 v[60:63], v[24:27], v[232:239], v3
  v_permlane32_swap_b32 v53, v55
  v_smfmac_f32_16x16x64_bf16 v[60:63], v[28:31], v[240:247], v3
  v_add_f32 v52, v52, v54
  v_smfmac_f32_16x16x64_bf16 v[60:63], v[32:35], v[248:255], v3
  v_add_f32 v53, v53, v55
  v_cvt_pk_bf16_f32 v54, v52, v53
  ds_write_b32 v108, v54
  v_permlane32_swap_b32 v56, v58
  v_permlane32_swap_b32 v57, v59
  v_add_f32 v56, v56, v58
  v_add_f32 v57, v57, v59
  v_cvt_pk_bf16_f32 v58, v56, v57
  ds_write_b32 v109, v58
  v_permlane32_swap_b32 v60, v62
  v_permlane32_swap_b32 v61, v63
  v_add_f32 v60, v60, v62
  v_add_f32 v61, v61, v63
  v_cvt_pk_bf16_f32 v62, v60, v61
  ds_write_b32 v110, v62
cB_va2_t2d:
  v_mov_b32 v117, s18
  s_waitcnt lgkmcnt(0)
  s_barrier
  s_cmp_eq_u32 s19, 63
  s_cbranch_scc1 cB_done
  s_sleep 1
  v_mov_b32 v36, 0
  v_mov_b32 v37, 0
  v_mov_b32 v38, 0
  v_mov_b32 v39, 0
  v_mov_b32 v40, 0
  v_mov_b32 v41, 0
  v_mov_b32 v42, 0
  v_mov_b32 v43, 0
  v_mov_b32 v44, 0
  v_mov_b32 v45, 0
  v_mov_b32 v46, 0
  v_mov_b32 v47, 0
  v_mov_b32 v48, 0
  v_mov_b32 v49, 0
  v_mov_b32 v50, 0
  v_mov_b32 v51, 0
  v_mov_b32 v52, 0
  v_mov_b32 v53, 0
  v_mov_b32 v54, 0
  v_mov_b32 v55, 0
  v_mov_b32 v56, 0
  v_mov_b32 v57, 0
  v_mov_b32 v58, 0
  v_mov_b32 v59, 0
  v_mov_b32 v60, 0
  v_mov_b32 v61, 0
  v_mov_b32 v62, 0
  v_mov_b32 v63, 0
  v_mov_b32 v64, 0
  v_mov_b32 v65, 0
  v_mov_b32 v66, 0
  v_mov_b32 v67, 0
  s_sleep 5
  s_mov_b32 s19, s18
  s_add_u32 s18, s18, 1
  s_mov_b32 s22, s20
  s_mov_b32 s20, s21
  s_mov_b32 s21, s22
  s_add_u32 s23, s20, 4096
  s_branch cB_va2_loop
cB_va2_slow:
  s_waitcnt lgkmcnt(0)
cB_va2_sl1:
  s_add_u32 s31, s31, 0x1000000
  buffer_load_dwordx4 v[8:11], v2, s[8:11], s20 offen offset:0 sc1
  buffer_load_dwordx4 v[12:15], v2, s[8:11], s20 offen offset:1024 sc1
  buffer_load_dwordx4 v[16:19], v2, s[8:11], s20 offen offset:2048 sc1
  buffer_load_dwordx4 v[20:23], v2, s[8:11], s20 offen offset:3072 sc1
  buffer_load_dwordx4 v[24:27], v2, s[8:11], s23 offen offset:0 sc1
  buffer_load_dwordx4 v[28:31], v2, s[8:11], s23 offen offset:1024 sc1
  buffer_load_dwordx4 v[32:35], v2, s[8:11], s23 offen offset:2048 sc1
  s_waitcnt vmcnt(0)
  v_max3_u32 v36, v8, v9, v10
  v_max3_u32 v36, v36, v11, v12
  v_max3_u32 v36, v36, v13, v14
  v_max3_u32 v36, v36, v15, v16
  v_max3_u32 v36, v36, v17, v18
  v_max3_u32 v36, v36, v19, v20
  v_max3_u32 v36, v36, v21, v22
  v_max3_u32 v36, v36, v23, v24
  v_max3_u32 v36, v36, v25, v26
  v_max3_u32 v36, v36, v27, v28
  v_max3_u32 v36, v36, v29, v30
  v_max3_u32 v36, v36, v31, v32
  v_max3_u32 v36, v36, v33, v34
  v_max_u32 v36, v36, v35
  v_cmp_eq_u32 vcc, -1, v36
  s_cbranch_vccz cB_va2_sl2
  s_add_u32 s30, s30, 1
  s_cmp_lt_u32 s30, 400000
  s_cbranch_scc1 cB_va2_sl1
  s_branch cB_abort
cB_va2_sl2:
  v_mov_b32 v36, 0
  v_mov_b32 v37, 0
  v_mov_b32 v38, 0
  v_mov_b32 v39, 0
  v_mov_b32 v40, 0
  v_mov_b32 v41, 0
  v_mov_b32 v42, 0
  v_mov_b32 v43, 0
  v_mov_b32 v44, 0
  v_mov_b32 v45, 0
  v_mov_b32 v46, 0
  v_mov_b32 v47, 0
  v_mov_b32 v48, 0
  v_mov_b32 v49, 0
  v_mov_b32 v50, 0
  v_mov_b32 v51, 0
  v_mov_b32 v52, 0
  v_mov_b32 v53, 0
  v_mov_b32 v54, 0
  v_mov_b32 v55, 0
  v_mov_b32 v56, 0
  v_mov_b32 v57, 0
  v_mov_b32 v58, 0
  v_mov_b32 v59, 0
  v_mov_b32 v60, 0
  v_mov_b32 v61, 0
  v_mov_b32 v62, 0
  v_mov_b32 v63, 0
  v_mov_b32 v64, 0
  v_mov_b32 v65, 0
  v_mov_b32 v66, 0
  v_mov_b32 v67, 0
  ds_read_b128 v[68:71], v0 offset:0
  ds_read_b128 v[72:75], v0 offset:1024
  v_smfmac_f32_16x16x64_bf16 v[36:39], v[8:11], a[0:7], v3
  v_smfmac_f32_16x16x64_bf16 v[40:43], v[8:11], a[56:63], v3
  v_smfmac_f32_16x16x64_bf16 v[44:47], v[8:11], a[112:119], v3
  v_smfmac_f32_16x16x64_bf16 v[48:51], v[8:11], a[168:175], v3
  v_smfmac_f32_16x16x64_bf16 v[52:55], v[8:11], a[224:231], v3
  v_smfmac_f32_16x16x64_bf16 v[56:59], v[8:11], v[144:151], v3
  v_smfmac_f32_16x16x64_bf16 v[60:63], v[8:11], v[200:207], v3
  s_waitcnt lgkmcnt(0)
  v_smfmac_f32_16x16x64_bf16 v[64:67], v[8:11], v[68:75], v3
  ds_read_b128 v[76:79], v0 offset:2048
  ds_read_b128 v[80:83], v0 offset:3072
  v_smfmac_f32_16x16x64_bf16 v[36:39], v[12:15], a[8:15], v3
  v_smfmac_f32_16x16x64_bf16 v[40:43], v[12:15], a[64:71], v3
  v_smfmac_f32_16x16x64_bf16 v[44:47], v[12:15], a[120:127], v3
  v_smfmac_f32_16x16x64_bf16 v[48:51], v[12:15], a[176:183], v3
  v_smfmac_f32_16x16x64_bf16 v[52:55], v[12:15], a[232:239], v3
  v_smfmac_f32_16x16x64_bf16 v[56:59], v[12:15], v[152:159], v3
  v_smfmac_f32_16x16x64_bf16 v[60:63], v[12:15], v[208:215], v3
  s_waitcnt lgkmcnt(0)
  v_smfmac_f32_16x16x64_bf16 v[64:67], v[12:15], v[76:83], v3
  ds_read_b128 v[84:87], v0 offset:4096
  ds_read_b128 v[88:91], v0 offset:5120
  v_smfmac_f32_16x16x64_bf16 v[36:39], v[16:19], a[16:23], v3
  v_smfmac_f32_16x16x64_bf16 v[40:43], v[16:19], a[72:79], v3
  v_smfmac_f32_16x16x64_bf16 v[44:47], v[16:19], a[128:135], v3
  v_smfmac_f32_16x16x64_bf16 v[48:51], v[16:19], a[184:191], v3
  v_smfmac_f32_16x16x64_bf16 v[52:55], v[16:19], a[240:247], v3
  v_smfmac_f32_16x16x64_bf16 v[56:59], v[16:19], v[160:167], v3
  v_smfmac_f32_16x16x64_bf16 v[60:63], v[16:19], v[216:223], v3
  s_waitcnt lgkmcnt(0)
  v_smfmac_f32_16x16x64_bf16 v[64:67], v[16:19], v[84:91], v3
  ds_read_b128 v[68:71], v0 offset:6144
  ds_read_b128 v[72:75], v0 offset:7168
  v_smfmac_f32_16x16x64_bf16 v[36:39], v[20:23], a[24:31], v3
  v_smfmac_f32_16x16x64_bf16 v[40:43], v[20:23], a[80:87], v3
  v_smfmac_f32_16x16x64_bf16 v[44:47], v[20:23], a[136:143], v3
  v_smfmac_f32_16x16x64_bf16 v[48:51], v[20:23], a[192:199], v3
  v_smfmac_f32_16x16x64_bf16 v[52:55], v[20:23], a[248:255], v3
  v_smfmac_f32_16x16x64_bf16 v[56:59], v[20:23], v[168:175], v3
  v_smfmac_f32_16x16x64_bf16 v[60:63], v[20:23], v[224:231], v3
  s_waitcnt lgkmcnt(0)
  v_smfmac_f32_16x16x64_bf16 v[64:67], v[20:23], v[68:75], v3
  ds_read_b128 v[76:79], v0 offset:8192
  ds_read_b128 v[80:83], v0 offset:9216
  v_smfmac_f32_16x16x64_bf16 v[36:39], v[24:27], a[32:39], v3
  v_smfmac_f32_16x16x64_bf16 v[40:43], v[24:27], a[88:95], v3
  v_smfmac_f32_16x16x64_bf16 v[44:47], v[24:27], a[144:151], v3
  v_smfmac_f32_16x16x64_bf16 v[48:51], v[24:27], a[200:207], v3
  v_smfmac_f32_16x16x64_bf16 v[52:55], v[24:27], v[120:127], v3
  v_smfmac_f32_16x16x64_bf16 v[56:59], v[24:27], v[176:183], v3
  v_smfmac_f32_16x16x64_bf16 v[60:63], v[24:27], v[232:239], v3
  s_waitcnt lgkmcnt(0)
  v_smfmac_f32_16x16x64_bf16 v[64:67], v[24:27], v[76:83], v3
  ds_read_b128 v[84:87], v0 offset:10240
  ds_read_b128 v[88:91], v0 offset:11264
  v_smfmac_f32_16x16x64_bf16 v[36:39], v[28:31], a[40:47], v3
  v_smfmac_f32_16x16x64_bf16 v[40:43], v[28:31], a[96:103], v3
  v_smfmac_f32_16x16x64_bf16 v[44:47], v[28:31], a[152:159], v3
  v_smfmac_f32_16x16x64_bf16 v[48:51], v[28:31], a[208:215], v3
  v_smfmac_f32_16x16x64_bf16 v[52:55], v[28:31], v[128:135], v3
  v_smfmac_f32_16x16x64_bf16 v[56:59], v[28:31], v[184:191], v3
  v_smfmac_f32_16x16x64_bf16 v[60:63], v[28:31], v[240:247], v3
  s_waitcnt lgkmcnt(0)
  v_smfmac_f32_16x16x64_bf16 v[64:67], v[28:31], v[84:91], v3
  ds_read_b128 v[68:71], v0 offset:12288
  ds_read_b128 v[72:75], v0 offset:13312
  v_smfmac_f32_16x16x64_bf16 v[36:39], v[32:35], a[48:55], v3
  v_smfmac_f32_16x16x64_bf16 v[40:43], v[32:35], a[104:111], v3
  v_smfmac_f32_16x16x64_bf16 v[44:47], v[32:35], a[160:167], v3
  v_smfmac_f32_16x16x64_bf16 v[48:51], v[32:35], a[216:223], v3
  v_smfmac_f32_16x16x64_bf16 v[52:55], v[32:35], v[136:143], v3
  v_smfmac_f32_16x16x64_bf16 v[56:59], v[32:35], v[192:199], v3
  v_smfmac_f32_16x16x64_bf16 v[60:63], v[32:35], v[248:255], v3
  s_waitcnt lgkmcnt(0)
  v_smfmac_f32_16x16x64_bf16 v[64:67], v[32:35], v[68:75], v3
  v_permlane32_swap_b32 v36, v38
  v_permlane32_swap_b32 v37, v39
  v_add_f32 v36, v36, v38
  v_add_f32 v37, v37, v39
  v_cvt_pk_bf16_f32 v38, v36, v37
  ds_write_b32 v104, v38
  v_permlane32_swap_b32 v40, v42
  v_permlane32_swap_b32 v41, v43
  v_add_f32 v40, v40, v42
  v_add_f32 v41, v41, v43
  v_cvt_pk_bf16_f32 v42, v40, v41
  ds_write_b32 v105, v42
  v_permlane32_swap_b32 v44, v46
  v_permlane32_swap_b32 v45, v47
  v_add_f32 v44, v44, v46
  v_add_f32 v45, v45, v47
  v_cvt_pk_bf16_f32 v46, v44, v45
  ds_write_b32 v106, v46
  v_permlane32_swap_b32 v48, v50
  v_permlane32_swap_b32 v49, v51
  v_add_f32 v48, v48, v50
  v_add_f32 v49, v49, v51
  v_cvt_pk_bf16_f32 v50, v48, v49
  ds_write_b32 v107, v50
  v_permlane32_swap_b32 v52, v54
  v_permlane32_swap_b32 v53, v55
  v_add_f32 v52, v52, v54
  v_add_f32 v53, v53, v55
  v_cvt_pk_bf16_f32 v54, v52, v53
  ds_write_b32 v108, v54
  v_permlane32_swap_b32 v56, v58
  v_permlane32_swap_b32 v57, v59
  v_add_f32 v56, v56, v58
  v_add_f32 v57, v57, v59
  v_cvt_pk_bf16_f32 v58, v56, v57
  ds_write_b32 v109, v58
  v_permlane32_swap_b32 v60, v62
  v_permlane32_swap_b32 v61, v63
  v_add_f32 v60, v60, v62
  v_add_f32 v61, v61, v63
  v_cvt_pk_bf16_f32 v62, v60, v61
  ds_write_b32 v110, v62
  v_permlane32_swap_b32 v64, v66
  v_permlane32_swap_b32 v65, v67
  v_add_f32 v64, v64, v66
  v_add_f32 v65, v65, v67
  v_cvt_pk_bf16_f32 v66, v64, v65
  ds_write_b32 v111, v66
  s_branch cB_va2_t2d
.p2align 6
cB_va3_loop:
  s_mov_b32 s30, 0
  s_barrier
  buffer_load_dwordx4 v[16:19], v2, s[8:11], s20 offen offset:2048 sc1
  buffer_load_dwordx4 v[20:23], v2, s[8:11], s20 offen offset:3072 sc1
  s_barrier
  buffer_load_dword v100, v116, s[8:11], s39 offen sc1
  s_add_u32 s27, s19, 2
  s_min_u32 s27, s27, 63
  s_lshr_b32 s27, s27, 3
  s_lshl_b32 s27, s27, 11
  s_add_u32 s27, s27, s35
  s_cmp_eq_u32 s27, s28
  s_cselect_b32 s29, 35328, s27
  buffer_load_dword v101, off, s[8:11], s29 sc1
  s_add_u32 s39, s39, 28672
  s_waitcnt vmcnt(2)
  ds_write_b128 v2, v[16:19] offset:10240
  ds_write_b128 v2, v[20:23] offset:11264
  v_smfmac_f32_16x16x64_bf16 v[36:39], v[16:19], a[16:23], v3
  v_smfmac_f32_16x16x64_bf16 v[40:43], v[16:19], a[72:79], v3
  v_smfmac_f32_16x16x64_bf16 v[44:47], v[16:19], a[128:135], v3
  v_smfmac_f32_16x16x64_bf16 v[48:51], v[16:19], a[184:191], v3
  v_smfmac_f32_16x16x64_bf16 v[52:55], v[16:19], a[240:247], v3
  s_waitcnt lgkmcnt(0)
  s_barrier
  ds_read_b128 v[8:11], v2 offset:8192
  ds_read_b128 v[12:15], v2 offset:9216
  ds_read_b128 v[24:27], v2 offset:12288
  ds_read_b128 v[28:31], v2 offset:13312
  ds_read_b128 v[32:35], v2 offset:14336
  v_smfmac_f32_16x16x64_bf16 v[56:59], v[16:19], v[160:167], v3
  v_smfmac_f32_16x16x64_bf16 v[60:63], v[16:19], v[216:223], v3
  v_smfmac_f32_16x16x64_bf16 v[36:39], v[20:23], a[24:31], v3
  v_smfmac_f32_16x16x64_bf16 v[40:43], v[20:23], a[80:87], v3
  v_smfmac_f32_16x16x64_bf16 v[44:47], v[20:23], a[136:143], v3
  v_smfmac_f32_16x16x64_bf16 v[48:51], v[20:23], a[192:199], v3
  v_smfmac_f32_16x16x64_bf16 v[52:55], v[20:23], a[248:255], v3
  v_smfmac_f32_16x16x64_bf16 v[56:59], v[20:23], v[168:175], v3
  v_smfmac_f32_16x16x64_bf16 v[60:63], v[20:23], v[224:231], v3
  s_waitcnt lgkmcnt(4)
  v_smfmac_f32_16x16x64_bf16 v[36:39], v[8:11], a[0:7], v3
  s_waitcnt lgkmcnt(3)
  v_smfmac_f32_16x16x64_bf16 v[36:39], v[12:15], a[8:15], v3
  s_waitcnt lgkmcnt(2)
  v_smfmac_f32_16x16x64_bf16 v[36:39], v[24:27], a[32:39], v3
  s_waitcnt lgkmcnt(1)
  v_smfmac_f32_16x16x64_bf16 v[36:39], v[28:31], a[40:47], v3
  s_waitcnt lgkmcnt(0)
  v_smfmac_f32_16x16x64_bf16 v[36:39], v[32:35], a[48:55], v3
  v_smfmac_f32_16x16x64_bf16 v[40:43], v[8:11], a[56:63], v3
  v_smfmac_f32_16x16x64_bf16 v[40:43], v[12:15], a[64:71], v3
  v_smfmac_f32_16x16x64_bf16 v[40:43], v[24:27], a[88:95], v3
  v_permlane32_swap_b32 v36, v38
  v_smfmac_f32_16x16x64_bf16 v[40:43], v[28:31], a[96:103], v3
  v_permlane32_swap_b32 v37, v39
  v_smfmac_f32_16x16x64_bf16 v[40:43], v[32:35], a[104:111], v3
  v_add_f32 v36, v36, v38
  v_smfmac_f32_16x16x64_bf16 v[44:47], v[8:11], a[112:119], v3
  v_add_f32 v37, v37, v39
  v_smfmac_f32_16x16x64_bf16 v[44:47], v[12:15], a[120:127], v3
  v_cmp_u_f32 vcc, v36, v37
  v_smfmac_f32_16x16x64_bf16 v[44:47], v[24:27], a[144:151], v3
  v_cvt_pk_bf16_f32 v38, v36, v37
  v_smfmac_f32_16x16x64_bf16 v[44:47], v[28:31], a[152:159], v3
  ds_write_b32 v104, v38
  s_cbranch_vccnz cB_va3_slow
  v_permlane32_swap_b32 v40, v42
  v_smfmac_f32_16x16x64_bf16 v[44:47], v[32:35], a[160:167], v3
  v_permlane32_swap_b32 v41, v43
  v_smfmac_f32_16x16x64_bf16 v[48:51], v[8:11], a[168:175], v3
  v_add_f32 v40, v40, v42
  v_smfmac_f32_16x16x64_bf16 v[48:51], v[12:15], a[176:183], v3
  v_add_f32 v41, v41, v43
  v_smfmac_f32_16x16x64_bf16 v[48:51], v[24:27], a[200:207], v3
  v_cvt_pk_bf16_f32 v42, v40, v41
  v_smfmac_f32_16x16x64_bf16 v[48:51], v[28:31], a[208:215], v3
  ds_write_b32 v105, v42
  v_permlane32_swap_b32 v44, v46
  v_smfmac_f32_16x16x64_bf16 v[48:51], v[32:35], a[216:223], v3
  v_permlane32_swap_b32 v45, v47
  v_smfmac_f32_16x16x64_bf16 v[52:55], v[8:11], a[224:231], v3
  v_add_f32 v44, v44, v46
  v_smfmac_f32_16x16x64_bf16 v[52:55], v[12:15], a[232:239], v3
  v_add_f32 v45, v45, v47
  v_smfmac_f32_16x16x64_bf16 v[52:55], v[24:27], v[120:127], v3
  v_cvt_pk_bf16_f32 v46, v44, v45
  v_smfmac_f32_16x16x64_bf16 v[52:55], v[28:31], v[128:135], v3
  ds_write_b32 v106, v46
  v_permlane32_swap_b32 v48, v50
  v_smfmac_f32_16x16x64_bf16 v[52:55], v[32:35], v[136:143], v3
  v_permlane32_swap_b32 v49, v51
  v_smfmac_f32_16x16x64_bf16 v[56:59], v[8:11], v[144:151], v3
  v_add_f32 v48, v48, v50
  v_smfmac_f32_16x16x64_bf16 v[56:59], v[12:15], v[152:159], v3
  v_add_f32 v49, v49, v51
  v_smfmac_f32_16x16x64_bf16 v[56:59], v[24:27], v[176:183], v3
  v_cvt_pk_bf16_f32 v50, v48, v49
  v_smfmac_f32_16x16x64_bf16 v[56:59], v[28:31], v[184:191], v3
  ds_write_b32 v107, v50
  v_permlane32_swap_b32 v52, v54
  v_smfmac_f32_16x16x64_bf16 v[56:59], v[32:35], v[192:199], v3
  v_permlane32_swap_b32 v53, v55
  v_smfmac_f32_16x16x64_bf16 v[60:63], v[8:11], v[200:207], v3
  v_add_f32 v52, v52, v54
  v_smfmac_f32_16x16x64_bf16 v[60:63], v[12:15], v[208:215], v3
  v_add_f32 v53, v53, v55
  v_smfmac_f32_16x16x64_bf16 v[60:63], v[24:27], v[232:239], v3
  v_cvt_pk_bf16_f32 v54, v52, v53
  v_smfmac_f32_16x16x64_bf16 v[60:63], v[28:31], v[240:247], v3
  ds_write_b32 v108, v54
  v_permlane32_swap_b32 v56, v58
  v_smfmac_f32_16x16x64_bf16 v[60:63], v[32:35], v[248:255], v3
  v_permlane32_swap_b32 v57, v59
  v_add_f32 v56, v56, v58
  v_add_f32 v57, v57, v59
  v_cvt_pk_bf16_f32 v58, v56, v57
  ds_write_b32 v109, v58
  s_nop 2
  v_permlane32_swap_b32 v60, v62
  v_permlane32_swap_b32 v61, v63
  v_add_f32 v60, v60, v62
  v_add_f32 v61, v61, v63
  v_cvt_pk_bf16_f32 v62, v60, v61
  ds_write_b32 v110, v62
cB_va3_t2d:
  v_mov_b32 v117, s18
  s_cmp_eq_u32 s27, s28
  s_cbranch_scc1 cB_va3_vok
cB_va3_vow:
  s_waitcnt vmcnt(0)
  v_cmp_ne_u32 vcc, 56, v101
  s_cbranch_vccnz cB_va3_vor
  s_mov_b32 s28, s27
cB_va3_vok:
  s_waitcnt lgkmcnt(0)
  s_setprio 3
  s_barrier
  v_mov_b32 v36, 0
  v_mov_b32 v37, 0
  buffer_store_dword v117, v118, s[8:11], 0 offen sc1
  s_setprio 0
  s_cmp_eq_u32 s19, 63
  s_cbranch_scc1 cB_done
  v_mov_b32 v38, 0
  v_mov_b32 v39, 0
  v_mov_b32 v40, 0
  v_mov_b32 v41, 0
  v_mov_b32 v42, 0
  v_mov_b32 v43, 0
  v_mov_b32 v44, 0
  v_mov_b32 v45, 0
  v_mov_b32 v46, 0
  v_mov_b32 v47, 0
  v_mov_b32 v48, 0
  v_mov_b32 v49, 0
  v_mov_b32 v50, 0
  v_mov_b32 v51, 0
  v_mov_b32 v52, 0
  v_mov_b32 v53, 0
  v_mov_b32 v54, 0
  v_mov_b32 v55, 0
  v_mov_b32 v56, 0
  v_mov_b32 v57, 0
  v_mov_b32 v58, 0
  v_mov_b32 v59, 0
  v_mov_b32 v60, 0
  v_mov_b32 v61, 0
  v_mov_b32 v62, 0
  v_mov_b32 v63, 0
  s_mov_b32 s19, s18
  s_add_u32 s18, s18, 1
  s_mov_b32 s22, s20
  s_mov_b32 s20, s21
  s_mov_b32 s21, s22
  s_add_u32 s23, s20, 4096
  s_branch cB_va3_loop
cB_va3_slow:
  s_waitcnt lgkmcnt(0)
cB_va3_sl1:
  s_add_u32 s31, s31, 0x1000000
  buffer_load_dwordx4 v[8:11], v2, s[8:11], s20 offen offset:0 sc1
  buffer_load_dwordx4 v[12:15], v2, s[8:11], s20 offen offset:1024 sc1
  buffer_load_dwordx4 v[16:19], v2, s[8:11], s20 offen offset:2048 sc1
  buffer_load_dwordx4 v[20:23], v2, s[8:11], s20 offen offset:3072 sc1
  buffer_load_dwordx4 v[24:27], v2, s[8:11], s23 offen offset:0 sc1
  buffer_load_dwordx4 v[28:31], v2, s[8:11], s23 offen offset:1024 sc1
  buffer_load_dwordx4 v[32:35], v2, s[8:11], s23 offen offset:2048 sc1
  s_waitcnt vmcnt(0)
  v_max3_u32 v36, v8, v9, v10
  v_max3_u32 v36, v36, v11, v12
  v_max3_u32 v36, v36, v13, v14
  v_max3_u32 v36, v36, v15, v16
  v_max3_u32 v36, v36, v17, v18
  v_max3_u32 v36, v36, v19, v20
  v_max3_u32 v36, v36, v21, v22
  v_max3_u32 v36, v36, v23, v24
  v_max3_u32 v36, v36, v25, v26
  v_max3_u32 v36, v36, v27, v28
  v_max3_u32 v36, v36, v29, v30
  v_max3_u32 v36, v36, v31, v32
  v_max3_u32 v36, v36, v33, v34
  v_max_u32 v36, v36, v35
  v_cmp_eq_u32 vcc, -1, v36
  s_cbranch_vccz cB_va3_sl2
  s_add_u32 s30, s30, 1
  s_cmp_lt_u32 s30, 400000
  s_cbranch_scc1 cB_va3_sl1
  s_branch cB_abort
cB_va3_sl2:
  v_mov_b32 v36, 0
  v_mov_b32 v37, 0
  v_mov_b32 v38, 0
  v_mov_b32 v39, 0
  v_mov_b32 v40, 0
  v_mov_b32 v41, 0
  v_mov_b32 v42, 0
  v_mov_b32 v43, 0
  v_mov_b32 v44, 0
  v_mov_b32 v45, 0
  v_mov_b32 v46, 0
  v_mov_b32 v47, 0
  v_mov_b32 v48, 0
  v_mov_b32 v49, 0
  v_mov_b32 v50, 0
  v_mov_b32 v51, 0
  v_mov_b32 v52, 0
  v_mov_b32 v53, 0
  v_mov_b32 v54, 0
  v_mov_b32 v55, 0
  v_mov_b32 v56, 0
  v_mov_b32 v57, 0
  v_mov_b32 v58, 0
  v_mov_b32 v59, 0
  v_mov_b32 v60, 0
  v_mov_b32 v61, 0
  v_mov_b32 v62, 0
  v_mov_b32 v63, 0
  v_smfmac_f32_16x16x64_bf16 v[36:39], v[8:11], a[0:7], v3
  v_smfmac_f32_16x16x64_bf16 v[40:43], v[8:11], a[56:63], v3
  v_smfmac_f32_16x16x64_bf16 v[44:47], v[8:11], a[112:119], v3
  v_smfmac_f32_16x16x64_bf16 v[48:51], v[8:11], a[168:175], v3
  v_smfmac_f32_16x16x64_bf16 v[52:55], v[8:11], a[224:231], v3
  v_smfmac_f32_16x16x64_bf16 v[56:59], v[8:11], v[144:151], v3
  v_smfmac_f32_16x16x64_bf16 v[60:63], v[8:11], v[200:207], v3
  v_smfmac_f32_16x16x64_bf16 v[36:39], v[12:15], a[8:15], v3
  v_smfmac_f32_16x16x64_bf16 v[40:43], v[12:15], a[64:71], v3
  v_smfmac_f32_16x16x64_bf16 v[44:47], v[12:15], a[120:127], v3
  v_smfmac_f32_16x16x64_bf16 v[48:51], v[12:15], a[176:183], v3
  v_smfmac_f32_16x16x64_bf16 v[52:55], v[12:15], a[232:239], v3
  v_smfmac_f32_16x16x64_bf16 v[56:59], v[12:15], v[152:159], v3
  v_smfmac_f32_16x16x64_bf16 v[60:63], v[12:15], v[208:215], v3
  v_smfmac_f32_16x16x64_bf16 v[36:39], v[16:19], a[16:23], v3
  v_smfmac_f32_16x16x64_bf16 v[40:43], v[16:19], a[72:79], v3
  v_smfmac_f32_16x16x64_bf16 v[44:47], v[16:19], a[128:135], v3
  v_smfmac_f32_16x16x64_bf16 v[48:51], v[16:19], a[184:191], v3
  v_smfmac_f32_16x16x64_bf16 v[52:55], v[16:19], a[240:247], v3
  v_smfmac_f32_16x16x64_bf16 v[56:59], v[16:19], v[160:167], v3
  v_smfmac_f32_16x16x64_bf16 v[60:63], v[16:19], v[216:223], v3
  v_smfmac_f32_16x16x64_bf16 v[36:39], v[20:23], a[24:31], v3
  v_smfmac_f32_16x16x64_bf16 v[40:43], v[20:23], a[80:87], v3
  v_smfmac_f32_16x16x64_bf16 v[44:47], v[20:23], a[136:143], v3
  v_smfmac_f32_16x16x64_bf16 v[48:51], v[20:23], a[192:199], v3
  v_smfmac_f32_16x16x64_bf16 v[52:55], v[20:23], a[248:255], v3
  v_smfmac_f32_16x16x64_bf16 v[56:59], v[20:23], v[168:175], v3
  v_smfmac_f32_16x16x64_bf16 v[60:63], v[20:23], v[224:231], v3
  v_smfmac_f32_16x16x64_bf16 v[36:39], v[24:27], a[32:39], v3
  v_smfmac_f32_16x16x64_bf16 v[40:43], v[24:27], a[88:95], v3
  v_smfmac_f32_16x16x64_bf16 v[44:47], v[24:27], a[144:151], v3
  v_smfmac_f32_16x16x64_bf16 v[48:51], v[24:27], a[200:207], v3
  v_smfmac_f32_16x16x64_bf16 v[52:55], v[24:27], v[120:127], v3
  v_smfmac_f32_16x16x64_bf16 v[56:59], v[24:27], v[176:183], v3
  v_smfmac_f32_16x16x64_bf16 v[60:63], v[24:27], v[232:239], v3
  v_smfmac_f32_16x16x64_bf16 v[36:39], v[28:31], a[40:47], v3
  v_smfmac_f32_16x16x64_bf16 v[40:43], v[28:31], a[96:103], v3
  v_smfmac_f32_16x16x64_bf16 v[44:47], v[28:31], a[152:159], v3
  v_smfmac_f32_16x16x64_bf16 v[48:51], v[28:31], a[208:215], v3
  v_smfmac_f32_16x16x64_bf16 v[52:55], v[28:31], v[128:135], v3
  v_smfmac_f32_16x16x64_bf16 v[56:59], v[28:31], v[184:191], v3
  v_smfmac_f32_16x16x64_bf16 v[60:63], v[28:31], v[240:247], v3
  v_smfmac_f32_16x16x64_bf16 v[36:39], v[32:35], a[48:55], v3
  v_smfmac_f32_16x16x64_bf16 v[40:43], v[32:35], a[104:111], v3
  v_smfmac_f32_16x16x64_bf16 v[44:47], v[32:35], a[160:167], v3
  v_smfmac_f32_16x16x64_bf16 v[48:51], v[32:35], a[216:223], v3
  v_smfmac_f32_16x16x64_bf16 v[52:55], v[32:35], v[136:143], v3
  v_smfmac_f32_16x16x64_bf16 v[56:59], v[32:35], v[192:199], v3
  v_smfmac_f32_16x16x64_bf16 v[60:63], v[32:35], v[248:255], v3
  v_permlane32_swap_b32 v36, v38
  v_permlane32_swap_b32 v37, v39
  v_add_f32 v36, v36, v38
  v_add_f32 v37, v37, v39
  v_cvt_pk_bf16_f32 v38, v36, v37
  ds_write_b32 v104, v38
  v_permlane32_swap_b32 v40, v42
  v_permlane32_swap_b32 v41, v43
  v_add_f32 v40, v40, v42
  v_add_f32 v41, v41, v43
  v_cvt_pk_bf16_f32 v42, v40, v41
  ds_write_b32 v105, v42
  v_permlane32_swap_b32 v44, v46
  v_permlane32_swap_b32 v45, v47
  v_add_f32 v44, v44, v46
  v_add_f32 v45, v45, v47
  v_cvt_pk_bf16_f32 v46, v44, v45
  ds_write_b32 v106, v46
  v_permlane32_swap_b32 v48, v50
  v_permlane32_swap_b32 v49, v51
  v_add_f32 v48, v48, v50
  v_add_f32 v49, v49, v51
  v_cvt_pk_bf16_f32 v50, v48, v49
  ds_write_b32 v107, v50
  v_permlane32_swap_b32 v52, v54
  v_permlane32_swap_b32 v53, v55
  v_add_f32 v52, v52, v54
  v_add_f32 v53, v53, v55
  v_cvt_pk_bf16_f32 v54, v52, v53
  ds_write_b32 v108, v54
  v_permlane32_swap_b32 v56, v58
  v_permlane32_swap_b32 v57, v59
  v_add_f32 v56, v56, v58
  v_add_f32 v57, v57, v59
  v_cvt_pk_bf16_f32 v58, v56, v57
  ds_write_b32 v109, v58
  v_permlane32_swap_b32 v60, v62
  v_permlane32_swap_b32 v61, v63
  v_add_f32 v60, v60, v62
  v_add_f32 v61, v61, v63
  v_cvt_pk_bf16_f32 v62, v60, v61
  ds_write_b32 v110, v62
  s_branch cB_va3_t2d
cB_va3_vor:
  s_sleep 2
  buffer_load_dword v101, off, s[8:11], s27 sc1
  s_add_u32 s30, s30, 1
  s_cmp_lt_u32 s30, 400000
  s_cbranch_scc1 cB_va3_vow
  s_branch cB_abort
cB_abort:
  v_mov_b32 v4, 0xdead
  v_mov_b32 v5, 16
  buffer_store_dword v4, v5, s[12:15], 0 offen
  s_branch ch_end
cB_done:
  s_branch ch_end
ch_worker:
  s_sub_u32 s35, s3, 2
  s_and_b32 s35, s35, 7
  s_lshr_b32 s36, s2, 3
  s_lshl_b32 s33, s35, 5
  s_add_u32 s33, s33, s36
  s_mov_b32 s97, 0
  s_mov_b32 s96, 0
  s_mov_b32 s37, 0
  s_mov_b32 s38, 0
  s_mov_b32 s39, 0xffff0000
  s_mov_b32 s101, -1
  v_and_b32 v1, 63, v0
  v_lshlrev_b32 v2, 4, v1
  v_lshrrev_b32 v3, 4, v1
  v_and_b32 v4, 15, v1
  s_cmp_ge_u32 s33, 224
  s_cbranch_scc1 wp_all
  s_mov_b32 s68, s44
  s_and_b32 s69, s45, 0xffff
  s_mov_b32 s70, 3670016
  s_mov_b32 s71, 0x20000
  s_and_b32 s20, s33, 0xe0
  s_mul_i32 s20, s20, 9363
  s_lshr_b32 s20, s20, 16
  s_lshl_b32 s20, s20, 10
  s_and_b32 s21, s33, 31
  s_mul_i32 s21, s21, 192
  s_add_u32 s20, s20, s21
  v_min_u32 v7, 191, v0
  v_add_u32 v7, s20, v7
  v_lshrrev_b32 v8, 11, v7
  v_min_u32 v8, 15, v8
  v_bfe_u32 v9, v7, 2, 9
  v_lshlrev_b32 v9, 13, v9
  v_lshl_add_u32 v9, v8, 9, v9
  v_and_b32 v7, 3, v7
  v_lshl_add_u32 v9, v7, 7, v9
  buffer_load_dword v253, v9, s[68:71], 0 offen
  s_mov_b32 s68, s40
  s_and_b32 s69, s41, 0xffff
  s_mov_b32 s70, 3670016
  s_mov_b32 s71, 0x20000
  s_and_b32 s20, s33, 0xe0
  s_mul_i32 s20, s20, 9363
  s_lshr_b32 s20, s20, 16
  s_lshl_b32 s20, s20, 10
  s_and_b32 s21, s33, 31
  s_mul_i32 s21, s21, 192
  s_add_u32 s20, s20, s21
  v_min_u32 v7, 191, v0
  v_add_u32 v7, s20, v7
  v_lshrrev_b32 v8, 11, v7
  v_min_u32 v8, 15, v8
  v_bfe_u32 v9, v7, 2, 9
  v_lshlrev_b32 v9, 13, v9
  v_lshl_add_u32 v9, v8, 9, v9
  v_and_b32 v7, 3, v7
  v_lshl_add_u32 v9, v7, 7, v9
  buffer_load_dword v253, v9, s[68:71], 0 offen
  v_lshrrev_b32 v5, 5, v1
  v_and_b32 v6, 31, v1
  v_xor_b32 v8, v6, v5
  v_lshlrev_b32 v8, 4, v8
  v_lshl_add_u32 v16, v5, 13, v8
  v_xor_b32 v17, 32, v16
  v_xor_b32 v18, 64, v16
  v_xor_b32 v19, 96, v16
  v_xor_b32 v20, 128, v16
  v_xor_b32 v21, 160, v16
  v_xor_b32 v22, 192, v16
  v_xor_b32 v23, 224, v16
  s_lshl_b32 s20, s16, 6
  v_xor_b32 v26, s20, v16
  v_xor_b32 v27, 32, v26
wp_B:
  s_mul_i32 s17, s33, 4682
  s_lshr_b32 s17, s17, 16
  s_mul_i32 s23, s17, 14
  s_sub_u32 s19, s33, s23
  s_cmp_lt_u32 s19, 7
  s_cselect_b32 s18, 0, 7
  s_cselect_b32 s28, 0, 8
  s_sub_u32 s18, s19, s18
  s_add_u32 s28, s28, s16
  s_lshl_b32 s25, s16, 15
  s_add_u32 s25, s25, 32768
  s_lshl_b32 s26, s17, 9
  s_lshl_b32 s20, s33, 2
  s_add_u32 s20, s20, s16
  s_mul_i32 s21, s20, 9363
  s_lshr_b32 s21, s21, 16
  s_mul_i32 s22, s21, 7
  s_sub_u32 s22, s20, s22
  s_mul_i32 s21, s21, 14336
  s_lshl_b32 s20, s22, 7
  s_add_u32 s20, s20, s21
  s_lshl_b32 s22, s22, 11
  s_add_u32 s52, s21, s22
  s_mov_b32 s68, s48
  s_and_b32 s69, s49, 0xffff
  s_mov_b32 s70, 1835008
  s_mov_b32 s71, 0x20000
  v_mul_u32_u24 v7, 896, v4
  v_lshl_add_u32 v7, v3, 5, v7
  buffer_load_dwordx4 v[128:131], v7, s[68:71], s20 offen
  buffer_load_dwordx4 v[132:135], v7, s[68:71], s20 offen offset:16
  s_mov_b32 s60, s44
  s_and_b32 s61, s45, 0xffff
  s_mov_b32 s62, 3670016
  s_mov_b32 s63, 0x20000
  s_mov_b32 s56, s46
  s_and_b32 s57, s47, 0xffff
  s_mov_b32 s58, 3670016
  s_mov_b32 s59, 0x20000
  s_mul_i32 s27, s17, 229376
  s_lshl_b32 s30, s18, 7
  s_add_u32 s27, s27, s30
  s_mul_i32 s30, s16, 57344
  s_add_u32 s27, s27, s30
  v_lshrrev_b32 v7, 3, v1
  v_and_b32 v8, 7, v1
  v_and_b32 v9, 2, v7
  v_xor_b32 v8, v8, v9
  v_mul_u32_u24 v7, 896, v7
  v_lshl_add_u32 v24, v8, 4, v7
  v_xor_b32 v25, 64, v24
  s_lshl_b32 s30, s16, 13
  s_add_u32 m0, s30, 0
  s_nop 0
  buffer_load_dwordx4 v24, s[56:59], s27 offen  lds
  s_add_u32 s27, s27, 7168
  s_add_u32 m0, s30, 1024
  s_nop 0
  buffer_load_dwordx4 v25, s[56:59], s27 offen  lds
  s_add_u32 s27, s27, 7168
  s_add_u32 m0, s30, 2048
  s_nop 0
  buffer_load_dwordx4 v24, s[56:59], s27 offen  lds
  s_add_u32 s27, s27, 7168
  s_add_u32 m0, s30, 3072
  s_nop 0
  buffer_load_dwordx4 v25, s[56:59], s27 offen  lds
  s_add_u32 s27, s27, 7168
  s_add_u32 m0, s30, 4096
  s_nop 0
  buffer_load_dwordx4 v24, s[56:59], s27 offen  lds
  s_add_u32 s27, s27, 7168
  s_add_u32 m0, s30, 5120
  s_nop 0
  buffer_load_dwordx4 v25, s[56:59], s27 offen  lds
  s_add_u32 s27, s27, 7168
  s_add_u32 m0, s30, 6144
  s_nop 0
  buffer_load_dwordx4 v24, s[56:59], s27 offen  lds
  s_add_u32 s27, s27, 7168
  s_add_u32 m0, s30, 7168
  s_nop 0
  buffer_load_dwordx4 v25, s[56:59], s27 offen  lds
  s_add_u32 s27, s27, 7168
  s_add_u32 s27, s28, 0
  s_min_u32 s27, s27, 13
  s_lshl_b32 s27, s27, 18
  s_add_u32 s27, s27, s26
  s_mov_b32 s55, s27
  v_lshrrev_b32 v7, 2, v4
  v_lshlrev_b32 v11, 4, v7
  v_lshlrev_b32 v7, 3, v7
  v_and_b32 v8, 3, v4
  v_add_u32 v7, v7, v8
  v_and_b32 v8, 2, v4
  v_lshl_add_u32 v11, v8, 1, v11
  v_and_b32 v8, 1, v4
  v_add_u32 v11, v11, v8
  v_or_b32 v10, 0, v3
  v_xor_b32 v10, v10, v4
  v_lshlrev_b32 v10, 4, v10
  v_lshl_add_u32 v44, v11, 9, v10
  v_lshl_add_u32 v10, v7, 9, v10
  v_add_u32 v32, s25, v10
  v_or_b32 v10, 4, v3
  v_xor_b32 v10, v10, v4
  v_lshlrev_b32 v10, 4, v10
  v_lshl_add_u32 v45, v11, 9, v10
  v_lshl_add_u32 v10, v7, 9, v10
  v_add_u32 v33, s25, v10
  v_or_b32 v10, 8, v3
  v_xor_b32 v10, v10, v4
  v_lshlrev_b32 v10, 4, v10
  v_lshl_add_u32 v46, v11, 9, v10
  v_lshl_add_u32 v10, v7, 9, v10
  v_add_u32 v34, s25, v10
  v_or_b32 v10, 12, v3
  v_xor_b32 v10, v10, v4
  v_lshlrev_b32 v10, 4, v10
  v_lshl_add_u32 v47, v11, 9, v10
  v_lshl_add_u32 v10, v7, 9, v10
  v_add_u32 v35, s25, v10
  s_mul_i32 s30, s17, 401408
  s_mul_i32 s31, s18, 57344
  s_add_u32 s30, s30, s31
  s_add_u32 s30, s30, 33554432
  v_add_u32 v28, s30, v2
  s_add_u32 s30, s30, 14336
  v_add_u32 v29, s30, v2
  s_add_u32 s30, s30, 14336
  v_add_u32 v30, s30, v2
  s_add_u32 s30, s30, 14336
  v_add_u32 v31, s30, v2
  s_add_u32 s30, s30, 14336
  v_mov_b32 v48, 1035512379
  v_lshrrev_b32 v7, 2, v4
  v_lshl_add_u32 v7, v3, 3, v7
  v_lshlrev_b32 v7, 7, v7
  v_and_b32 v8, 3, v4
  v_lshl_add_u32 v7, v8, 3, v7
  v_lshrrev_b32 v8, 3, v4
  v_and_b32 v9, 1, v3
  v_lshl_add_u32 v8, v9, 1, v8
  v_lshl_add_u32 v40, v8, 5, v7
  s_mul_i32 s31, s17, 28
  s_mov_b32 s29, 401408
  s_lshl_b32 s30, s18, 6
  s_add_u32 s30, s30, 0
  v_add_u32 v8, s30, v4
  v_subrev_u32 v9, 256, v8
  v_mul_u32_u24 v11, 171, v9
  v_lshrrev_b32 v11, 11, v11
  v_mul_u32_u24 v38, 12, v11
  v_sub_u32 v38, v9, v38
  v_add_u32 v38, 16, v38
  v_lshrrev_b32 v10, 4, v8
  v_cmp_gt_i32 vcc, 0, v9
  s_nop 1
  v_cndmask_b32 v10, v11, v10, vcc
  v_cndmask_b32 v39, v38, v4, vcc
  v_add_u32 v39, s31, v39
  v_lshrrev_b32 v38, 4, v39
  v_and_b32 v39, 15, v39
  v_mul_lo_u32 v10, v10, s29
  v_mul_u32_u24 v38, 14336, v38
  v_add_u32 v10, v10, v38
  v_lshl_add_u32 v10, v3, 8, v10
  v_lshl_add_u32 v10, v39, 4, v10
  v_add_u32 v12, 39976960, v10
  v_xor_b32 v41, 32, v40
  s_lshl_b32 s30, s18, 6
  s_add_u32 s30, s30, 16
  v_add_u32 v8, s30, v4
  v_subrev_u32 v9, 256, v8
  v_mul_u32_u24 v11, 171, v9
  v_lshrrev_b32 v11, 11, v11
  v_mul_u32_u24 v38, 12, v11
  v_sub_u32 v38, v9, v38
  v_add_u32 v38, 16, v38
  v_lshrrev_b32 v10, 4, v8
  v_cmp_gt_i32 vcc, 0, v9
  s_nop 1
  v_cndmask_b32 v10, v11, v10, vcc
  v_cndmask_b32 v39, v38, v4, vcc
  v_add_u32 v39, s31, v39
  v_lshrrev_b32 v38, 4, v39
  v_and_b32 v39, 15, v39
  v_mul_lo_u32 v10, v10, s29
  v_mul_u32_u24 v38, 14336, v38
  v_add_u32 v10, v10, v38
  v_lshl_add_u32 v10, v3, 8, v10
  v_lshl_add_u32 v10, v39, 4, v10
  v_add_u32 v13, 39976960, v10
  v_xor_b32 v42, 64, v40
  s_lshl_b32 s30, s18, 6
  s_add_u32 s30, s30, 32
  v_add_u32 v8, s30, v4
  v_subrev_u32 v9, 256, v8
  v_mul_u32_u24 v11, 171, v9
  v_lshrrev_b32 v11, 11, v11
  v_mul_u32_u24 v38, 12, v11
  v_sub_u32 v38, v9, v38
  v_add_u32 v38, 16, v38
  v_lshrrev_b32 v10, 4, v8
  v_cmp_gt_i32 vcc, 0, v9
  s_nop 1
  v_cndmask_b32 v10, v11, v10, vcc
  v_cndmask_b32 v39, v38, v4, vcc
  v_add_u32 v39, s31, v39
  v_lshrrev_b32 v38, 4, v39
  v_and_b32 v39, 15, v39
  v_mul_lo_u32 v10, v10, s29
  v_mul_u32_u24 v38, 14336, v38
  v_add_u32 v10, v10, v38
  v_lshl_add_u32 v10, v3, 8, v10
  v_lshl_add_u32 v10, v39, 4, v10
  v_add_u32 v14, 39976960, v10
  v_xor_b32 v43, 96, v40
  s_lshl_b32 s30, s18, 6
  s_add_u32 s30, s30, 48
  v_add_u32 v8, s30, v4
  v_subrev_u32 v9, 256, v8
  v_mul_u32_u24 v11, 171, v9
  v_lshrrev_b32 v11, 11, v11
  v_mul_u32_u24 v38, 12, v11
  v_sub_u32 v38, v9, v38
  v_add_u32 v38, 16, v38
  v_lshrrev_b32 v10, 4, v8
  v_cmp_gt_i32 vcc, 0, v9
  s_nop 1
  v_cndmask_b32 v10, v11, v10, vcc
  v_cndmask_b32 v39, v38, v4, vcc
  v_add_u32 v39, s31, v39
  v_lshrrev_b32 v38, 4, v39
  v_and_b32 v39, 15, v39
  v_mul_lo_u32 v10, v10, s29
  v_mul_u32_u24 v38, 14336, v38
  v_add_u32 v10, v10, v38
  v_lshl_add_u32 v10, v3, 8, v10
  v_lshl_add_u32 v10, v39, 4, v10
  v_add_u32 v15, 39976960, v10
  s_mov_b32 s27, s55
  s_add_u32 m0, s25, 0
  s_nop 0
  buffer_load_dwordx4 v16, s[60:63], s27 offen  lds
  s_add_u32 s27, s27, 16384
  s_add_u32 m0, s25, 1024
  s_nop 0
  buffer_load_dwordx4 v17, s[60:63], s27 offen  lds
  s_add_u32 s27, s27, 16384
  s_add_u32 m0, s25, 2048
  s_nop 0
  buffer_load_dwordx4 v16, s[60:63], s27 offen  lds
  s_add_u32 s27, s27, 16384
  s_add_u32 m0, s25, 3072
  s_nop 0
  buffer_load_dwordx4 v17, s[60:63], s27 offen  lds
  s_add_u32 s27, s27, 16384
  s_add_u32 m0, s25, 4096
  s_nop 0
  buffer_load_dwordx4 v18, s[60:63], s27 offen  lds
  s_add_u32 s27, s27, 16384
  s_add_u32 m0, s25, 5120
  s_nop 0
  buffer_load_dwordx4 v19, s[60:63], s27 offen  lds
  s_add_u32 s27, s27, 16384
  s_add_u32 m0, s25, 6144
  s_nop 0
  buffer_load_dwordx4 v18, s[60:63], s27 offen  lds
  s_add_u32 s27, s27, 16384
  s_add_u32 m0, s25, 7168
  s_nop 0
  buffer_load_dwordx4 v19, s[60:63], s27 offen  lds
  s_add_u32 s27, s27, 16384
  s_add_u32 m0, s25, 8192
  s_nop 0
  buffer_load_dwordx4 v20, s[60:63], s27 offen  lds
  s_add_u32 s27, s27, 16384
  s_add_u32 m0, s25, 9216
  s_nop 0
  buffer_load_dwordx4 v21, s[60:63], s27 offen  lds
  s_add_u32 s27, s27, 16384
  s_add_u32 m0, s25, 10240
  s_nop 0
  buffer_load_dwordx4 v20, s[60:63], s27 offen  lds
  s_add_u32 s27, s27, 16384
  s_add_u32 m0, s25, 11264
  s_nop 0
  buffer_load_dwordx4 v21, s[60:63], s27 offen  lds
  s_add_u32 s27, s27, 16384
  s_add_u32 m0, s25, 12288
  s_nop 0
  buffer_load_dwordx4 v22, s[60:63], s27 offen  lds
  s_add_u32 s27, s27, 16384
  s_add_u32 m0, s25, 13312
  s_nop 0
  buffer_load_dwordx4 v23, s[60:63], s27 offen  lds
  s_add_u32 s27, s27, 16384
  s_add_u32 m0, s25, 14336
  s_nop 0
  buffer_load_dwordx4 v22, s[60:63], s27 offen  lds
  s_add_u32 s27, s27, 16384
  s_add_u32 m0, s25, 15360
  s_nop 0
  buffer_load_dwordx4 v23, s[60:63], s27 offen  lds
  s_add_u32 s27, s27, 16384
  s_add_u32 s27, s28, 4
  s_min_u32 s27, s27, 13
  s_lshl_b32 s27, s27, 18
  s_add_u32 s27, s27, s26
  s_add_u32 m0, s25, 16384
  s_nop 0
  buffer_load_dwordx4 v16, s[60:63], s27 offen  lds
  s_add_u32 s27, s27, 16384
  s_add_u32 m0, s25, 17408
  s_nop 0
  buffer_load_dwordx4 v17, s[60:63], s27 offen  lds
  s_add_u32 s27, s27, 16384
  s_add_u32 m0, s25, 18432
  s_nop 0
  buffer_load_dwordx4 v16, s[60:63], s27 offen  lds
  s_add_u32 s27, s27, 16384
  s_add_u32 m0, s25, 19456
  s_nop 0
  buffer_load_dwordx4 v17, s[60:63], s27 offen  lds
  s_add_u32 s27, s27, 16384
  s_add_u32 m0, s25, 20480
  s_nop 0
  buffer_load_dwordx4 v18, s[60:63], s27 offen  lds
  s_add_u32 s27, s27, 16384
  s_add_u32 m0, s25, 21504
  s_nop 0
  buffer_load_dwordx4 v19, s[60:63], s27 offen  lds
  s_add_u32 s27, s27, 16384
  s_add_u32 m0, s25, 22528
  s_nop 0
  buffer_load_dwordx4 v18, s[60:63], s27 offen  lds
  s_add_u32 s27, s27, 16384
  s_add_u32 m0, s25, 23552
  s_nop 0
  buffer_load_dwordx4 v19, s[60:63], s27 offen  lds
  s_add_u32 s27, s27, 16384
  s_add_u32 m0, s25, 24576
  s_nop 0
  buffer_load_dwordx4 v20, s[60:63], s27 offen  lds
  s_add_u32 s27, s27, 16384
  s_add_u32 m0, s25, 25600
  s_nop 0
  buffer_load_dwordx4 v21, s[60:63], s27 offen  lds
  s_add_u32 s27, s27, 16384
  s_add_u32 m0, s25, 26624
  s_nop 0
  buffer_load_dwordx4 v20, s[60:63], s27 offen  lds
  s_add_u32 s27, s27, 16384
  s_add_u32 m0, s25, 27648
  s_nop 0
  buffer_load_dwordx4 v21, s[60:63], s27 offen  lds
  s_add_u32 s27, s27, 16384
  s_add_u32 m0, s25, 28672
  s_nop 0
  buffer_load_dwordx4 v22, s[60:63], s27 offen  lds
  s_add_u32 s27, s27, 16384
  s_add_u32 m0, s25, 29696
  s_nop 0
  buffer_load_dwordx4 v23, s[60:63], s27 offen  lds
  s_add_u32 s27, s27, 16384
  s_add_u32 m0, s25, 30720
  s_nop 0
  buffer_load_dwordx4 v22, s[60:63], s27 offen  lds
  s_add_u32 s27, s27, 16384
  s_add_u32 m0, s25, 31744
  s_nop 0
  buffer_load_dwordx4 v23, s[60:63], s27 offen  lds
  s_add_u32 s27, s27, 16384
  s_cmp_lt_u32 s18, 4
  s_cselect_b32 s34, 1, s97
  s_mov_b32 s68, s42
  s_and_b32 s69, s43, 0xffff
  s_mov_b32 s70, 3670016
  s_mov_b32 s71, 0x20000
  s_lshl_b32 s27, s18, 19
  s_add_u32 s27, s27, s26
  s_cmp_lg_u32 s34, 0
  s_cselect_b32 s27, 0x40000000, s27
  v_lshrrev_b32 v7, 2, v0
  v_and_b32 v8, 3, v0
  v_lshlrev_b32 v8, 7, v8
  v_lshl_add_u32 v9, v7, 13, v8
  buffer_load_dword v253, v9, s[68:71], s27 offen
  s_lshl_b32 s29, s28, 10
  s_add_u32 s31, s29, 4096
  s_cmp_lt_u32 s28, 10
  s_cselect_b32 s31, s31, 0x40000000
  s_waitcnt vmcnt(1)
  s_barrier
  ds_read_b64_tr_b16 a[0:1], v40 offset:0
  ds_read_b64_tr_b16 a[2:3], v40 offset:512
  ds_read_b64_tr_b16 a[32:33], v41 offset:0
  ds_read_b64_tr_b16 a[34:35], v41 offset:512
  ds_read_b64_tr_b16 a[64:65], v42 offset:0
  ds_read_b64_tr_b16 a[66:67], v42 offset:512
  ds_read_b64_tr_b16 a[96:97], v43 offset:0
  ds_read_b64_tr_b16 a[98:99], v43 offset:512
  ds_read_b128 a[128:131], v32 offset:0
  ds_read_b128 a[160:163], v32 offset:2048
  ds_read_b128 a[192:195], v32 offset:16384
  ds_read_b128 a[224:227], v32 offset:18432
  v_lshlrev_b32 v144, 9, v3
  v_lshl_add_u32 v144, v4, 4, v144
  s_add_u32 s53, s52, 75759616
  s_add_u32 s52, s52, 655360
  v_mov_b32 v136, v128
  v_mov_b32 v140, v129
  v_mov_b32 v137, v130
  v_mov_b32 v141, v131
  v_mov_b32 v138, v132
  v_mov_b32 v142, v133
  v_mov_b32 v139, v134
  v_mov_b32 v143, v135
  buffer_store_dwordx4 v[128:131], v144, s[8:11], s52 offen sc1
  buffer_store_dwordx4 v[132:135], v144, s[8:11], s52 offen offset:256 sc1
  buffer_store_dwordx4 v[136:139], v2, s[8:11], s53 offen sc1
  buffer_store_dwordx4 v[140:143], v2, s[8:11], s53 offen offset:1024 sc1
  s_waitcnt lgkmcnt(0)
  v_mfma_f32_16x16x32_bf16 v[64:67], a[128:131], a[0:3], 0
  ds_read_b64_tr_b16 a[4:5], v40 offset:4096
  ds_read_b64_tr_b16 a[6:7], v40 offset:4608
  v_mfma_f32_16x16x32_bf16 v[68:71], a[160:163], a[0:3], 0
  ds_read_b64_tr_b16 a[36:37], v41 offset:4096
  ds_read_b64_tr_b16 a[38:39], v41 offset:4608
  v_mfma_f32_16x16x32_bf16 v[72:75], a[128:131], a[32:35], 0
  ds_read_b64_tr_b16 a[68:69], v42 offset:4096
  ds_read_b64_tr_b16 a[70:71], v42 offset:4608
  v_mfma_f32_16x16x32_bf16 v[76:79], a[160:163], a[32:35], 0
  ds_read_b64_tr_b16 a[100:101], v43 offset:4096
  ds_read_b64_tr_b16 a[102:103], v43 offset:4608
  v_mfma_f32_16x16x32_bf16 v[80:83], a[128:131], a[64:67], 0
  ds_read_b128 a[132:135], v33 offset:0
  ds_read_b128 a[164:167], v33 offset:2048
  v_mfma_f32_16x16x32_bf16 v[84:87], a[160:163], a[64:67], 0
  ds_read_b128 a[196:199], v33 offset:16384
  ds_read_b128 a[228:231], v33 offset:18432
  v_mfma_f32_16x16x32_bf16 v[88:91], a[128:131], a[96:99], 0
  v_mfma_f32_16x16x32_bf16 v[92:95], a[160:163], a[96:99], 0
  v_mfma_f32_16x16x32_bf16 v[96:99], a[192:195], a[0:3], 0
  v_mfma_f32_16x16x32_bf16 v[100:103], a[224:227], a[0:3], 0
  v_mfma_f32_16x16x32_bf16 v[104:107], a[192:195], a[32:35], 0
  v_mfma_f32_16x16x32_bf16 v[108:111], a[224:227], a[32:35], 0
  v_mfma_f32_16x16x32_bf16 v[112:115], a[192:195], a[64:67], 0
  v_mfma_f32_16x16x32_bf16 v[116:119], a[224:227], a[64:67], 0
  v_mfma_f32_16x16x32_bf16 v[120:123], a[192:195], a[96:99], 0
  v_mfma_f32_16x16x32_bf16 v[124:127], a[224:227], a[96:99], 0
  s_waitcnt lgkmcnt(0)
  v_mfma_f32_16x16x32_bf16 v[64:67], a[132:135], a[4:7], v[64:67]
  ds_read_b64_tr_b16 a[8:9], v40 offset:8192
  ds_read_b64_tr_b16 a[10:11], v40 offset:8704
  v_mfma_f32_16x16x32_bf16 v[68:71], a[164:167], a[4:7], v[68:71]
  ds_read_b64_tr_b16 a[40:41], v41 offset:8192
  ds_read_b64_tr_b16 a[42:43], v41 offset:8704
  v_mfma_f32_16x16x32_bf16 v[72:75], a[132:135], a[36:39], v[72:75]
  ds_read_b64_tr_b16 a[72:73], v42 offset:8192
  ds_read_b64_tr_b16 a[74:75], v42 offset:8704
  v_mfma_f32_16x16x32_bf16 v[76:79], a[164:167], a[36:39], v[76:79]
  ds_read_b64_tr_b16 a[104:105], v43 offset:8192
  ds_read_b64_tr_b16 a[106:107], v43 offset:8704
  v_mfma_f32_16x16x32_bf16 v[80:83], a[132:135], a[68:71], v[80:83]
  ds_read_b128 a[136:139], v34 offset:0
  ds_read_b128 a[168:171], v34 offset:2048
  v_mfma_f32_16x16x32_bf16 v[84:87], a[164:167], a[68:71], v[84:87]
  ds_read_b128 a[200:203], v34 offset:16384
  ds_read_b128 a[232:235], v34 offset:18432
  v_mfma_f32_16x16x32_bf16 v[88:91], a[132:135], a[100:103], v[88:91]
  v_mfma_f32_16x16x32_bf16 v[92:95], a[164:167], a[100:103], v[92:95]
  v_mfma_f32_16x16x32_bf16 v[96:99], a[196:199], a[4:7], v[96:99]
  v_mfma_f32_16x16x32_bf16 v[100:103], a[228:231], a[4:7], v[100:103]
  v_mfma_f32_16x16x32_bf16 v[104:107], a[196:199], a[36:39], v[104:107]
  v_mfma_f32_16x16x32_bf16 v[108:111], a[228:231], a[36:39], v[108:111]
  v_mfma_f32_16x16x32_bf16 v[112:115], a[196:199], a[68:71], v[112:115]
  v_mfma_f32_16x16x32_bf16 v[116:119], a[228:231], a[68:71], v[116:119]
  v_mfma_f32_16x16x32_bf16 v[120:123], a[196:199], a[100:103], v[120:123]
  v_mfma_f32_16x16x32_bf16 v[124:127], a[228:231], a[100:103], v[124:127]
  s_waitcnt lgkmcnt(0)
  v_mfma_f32_16x16x32_bf16 v[64:67], a[136:139], a[8:11], v[64:67]
  ds_read_b64_tr_b16 a[12:13], v40 offset:12288
  ds_read_b64_tr_b16 a[14:15], v40 offset:12800
  v_mfma_f32_16x16x32_bf16 v[68:71], a[168:171], a[8:11], v[68:71]
  ds_read_b64_tr_b16 a[44:45], v41 offset:12288
  ds_read_b64_tr_b16 a[46:47], v41 offset:12800
  v_mfma_f32_16x16x32_bf16 v[72:75], a[136:139], a[40:43], v[72:75]
  ds_read_b64_tr_b16 a[76:77], v42 offset:12288
  ds_read_b64_tr_b16 a[78:79], v42 offset:12800
  v_mfma_f32_16x16x32_bf16 v[76:79], a[168:171], a[40:43], v[76:79]
  ds_read_b64_tr_b16 a[108:109], v43 offset:12288
  ds_read_b64_tr_b16 a[110:111], v43 offset:12800
  v_mfma_f32_16x16x32_bf16 v[80:83], a[136:139], a[72:75], v[80:83]
  ds_read_b128 a[140:143], v35 offset:0
  ds_read_b128 a[172:175], v35 offset:2048
  v_mfma_f32_16x16x32_bf16 v[84:87], a[168:171], a[72:75], v[84:87]
  ds_read_b128 a[204:207], v35 offset:16384
  ds_read_b128 a[236:239], v35 offset:18432
  v_mfma_f32_16x16x32_bf16 v[88:91], a[136:139], a[104:107], v[88:91]
  v_mfma_f32_16x16x32_bf16 v[92:95], a[168:171], a[104:107], v[92:95]
  v_mfma_f32_16x16x32_bf16 v[96:99], a[200:203], a[8:11], v[96:99]
  v_mfma_f32_16x16x32_bf16 v[100:103], a[232:235], a[8:11], v[100:103]
  v_mfma_f32_16x16x32_bf16 v[104:107], a[200:203], a[40:43], v[104:107]
  v_mfma_f32_16x16x32_bf16 v[108:111], a[232:235], a[40:43], v[108:111]
  v_mfma_f32_16x16x32_bf16 v[112:115], a[200:203], a[72:75], v[112:115]
  v_mfma_f32_16x16x32_bf16 v[116:119], a[232:235], a[72:75], v[116:119]
  v_mfma_f32_16x16x32_bf16 v[120:123], a[200:203], a[104:107], v[120:123]
  v_mfma_f32_16x16x32_bf16 v[124:127], a[232:235], a[104:107], v[124:127]
  s_waitcnt lgkmcnt(0)
  v_mfma_f32_16x16x32_bf16 v[64:67], a[140:143], a[12:15], v[64:67]
  ds_read_b64_tr_b16 a[16:17], v40 offset:16384
  ds_read_b64_tr_b16 a[18:19], v40 offset:16896
  v_mfma_f32_16x16x32_bf16 v[68:71], a[172:175], a[12:15], v[68:71]
  ds_read_b64_tr_b16 a[48:49], v41 offset:16384
  ds_read_b64_tr_b16 a[50:51], v41 offset:16896
  v_mfma_f32_16x16x32_bf16 v[72:75], a[140:143], a[44:47], v[72:75]
  ds_read_b64_tr_b16 a[80:81], v42 offset:16384
  ds_read_b64_tr_b16 a[82:83], v42 offset:16896
  v_mfma_f32_16x16x32_bf16 v[76:79], a[172:175], a[44:47], v[76:79]
  ds_read_b64_tr_b16 a[112:113], v43 offset:16384
  ds_read_b64_tr_b16 a[114:115], v43 offset:16896
  v_mfma_f32_16x16x32_bf16 v[80:83], a[140:143], a[76:79], v[80:83]
  ds_read_b128 a[144:147], v32 offset:256
  ds_read_b128 a[176:179], v32 offset:2304
  v_mfma_f32_16x16x32_bf16 v[84:87], a[172:175], a[76:79], v[84:87]
  ds_read_b128 a[208:211], v32 offset:16640
  ds_read_b128 a[240:243], v32 offset:18688
  v_mfma_f32_16x16x32_bf16 v[88:91], a[140:143], a[108:111], v[88:91]
  v_mfma_f32_16x16x32_bf16 v[92:95], a[172:175], a[108:111], v[92:95]
  v_mfma_f32_16x16x32_bf16 v[96:99], a[204:207], a[12:15], v[96:99]
  v_mfma_f32_16x16x32_bf16 v[100:103], a[236:239], a[12:15], v[100:103]
  v_mfma_f32_16x16x32_bf16 v[104:107], a[204:207], a[44:47], v[104:107]
  v_mfma_f32_16x16x32_bf16 v[108:111], a[236:239], a[44:47], v[108:111]
  v_mfma_f32_16x16x32_bf16 v[112:115], a[204:207], a[76:79], v[112:115]
  v_mfma_f32_16x16x32_bf16 v[116:119], a[236:239], a[76:79], v[116:119]
  v_mfma_f32_16x16x32_bf16 v[120:123], a[204:207], a[108:111], v[120:123]
  v_mfma_f32_16x16x32_bf16 v[124:127], a[236:239], a[108:111], v[124:127]
  s_waitcnt lgkmcnt(0)
  v_mfma_f32_16x16x32_bf16 v[64:67], a[144:147], a[16:19], v[64:67]
  ds_read_b64_tr_b16 a[20:21], v40 offset:20480
  ds_read_b64_tr_b16 a[22:23], v40 offset:20992
  v_mfma_f32_16x16x32_bf16 v[68:71], a[176:179], a[16:19], v[68:71]
  ds_read_b64_tr_b16 a[52:53], v41 offset:20480
  ds_read_b64_tr_b16 a[54:55], v41 offset:20992
  v_mfma_f32_16x16x32_bf16 v[72:75], a[144:147], a[48:51], v[72:75]
  ds_read_b64_tr_b16 a[84:85], v42 offset:20480
  ds_read_b64_tr_b16 a[86:87], v42 offset:20992
  v_mfma_f32_16x16x32_bf16 v[76:79], a[176:179], a[48:51], v[76:79]
  ds_read_b64_tr_b16 a[116:117], v43 offset:20480
  ds_read_b64_tr_b16 a[118:119], v43 offset:20992
  v_mfma_f32_16x16x32_bf16 v[80:83], a[144:147], a[80:83], v[80:83]
  ds_read_b128 a[148:151], v33 offset:256
  ds_read_b128 a[180:183], v33 offset:2304
  v_mfma_f32_16x16x32_bf16 v[84:87], a[176:179], a[80:83], v[84:87]
  ds_read_b128 a[212:215], v33 offset:16640
  ds_read_b128 a[244:247], v33 offset:18688
  v_mfma_f32_16x16x32_bf16 v[88:91], a[144:147], a[112:115], v[88:91]
  v_mfma_f32_16x16x32_bf16 v[92:95], a[176:179], a[112:115], v[92:95]
  v_mfma_f32_16x16x32_bf16 v[96:99], a[208:211], a[16:19], v[96:99]
  v_mfma_f32_16x16x32_bf16 v[100:103], a[240:243], a[16:19], v[100:103]
  v_mfma_f32_16x16x32_bf16 v[104:107], a[208:211], a[48:51], v[104:107]
  v_mfma_f32_16x16x32_bf16 v[108:111], a[240:243], a[48:51], v[108:111]
  v_mfma_f32_16x16x32_bf16 v[112:115], a[208:211], a[80:83], v[112:115]
  v_mfma_f32_16x16x32_bf16 v[116:119], a[240:243], a[80:83], v[116:119]
  v_mfma_f32_16x16x32_bf16 v[120:123], a[208:211], a[112:115], v[120:123]
  v_mfma_f32_16x16x32_bf16 v[124:127], a[240:243], a[112:115], v[124:127]
  s_waitcnt lgkmcnt(0)
  v_mfma_f32_16x16x32_bf16 v[64:67], a[148:151], a[20:23], v[64:67]
  ds_read_b64_tr_b16 a[24:25], v40 offset:24576
  ds_read_b64_tr_b16 a[26:27], v40 offset:25088
  v_mfma_f32_16x16x32_bf16 v[68:71], a[180:183], a[20:23], v[68:71]
  ds_read_b64_tr_b16 a[56:57], v41 offset:24576
  ds_read_b64_tr_b16 a[58:59], v41 offset:25088
  v_mfma_f32_16x16x32_bf16 v[72:75], a[148:151], a[52:55], v[72:75]
  ds_read_b64_tr_b16 a[88:89], v42 offset:24576
  ds_read_b64_tr_b16 a[90:91], v42 offset:25088
  v_mfma_f32_16x16x32_bf16 v[76:79], a[180:183], a[52:55], v[76:79]
  ds_read_b64_tr_b16 a[120:121], v43 offset:24576
  ds_read_b64_tr_b16 a[122:123], v43 offset:25088
  v_mfma_f32_16x16x32_bf16 v[80:83], a[148:151], a[84:87], v[80:83]
  ds_read_b128 a[152:155], v34 offset:256
  ds_read_b128 a[184:187], v34 offset:2304
  v_mfma_f32_16x16x32_bf16 v[84:87], a[180:183], a[84:87], v[84:87]
  ds_read_b128 a[216:219], v34 offset:16640
  ds_read_b128 a[248:251], v34 offset:18688
  v_mfma_f32_16x16x32_bf16 v[88:91], a[148:151], a[116:119], v[88:91]
  v_mfma_f32_16x16x32_bf16 v[92:95], a[180:183], a[116:119], v[92:95]
  v_mfma_f32_16x16x32_bf16 v[96:99], a[212:215], a[20:23], v[96:99]
  v_mfma_f32_16x16x32_bf16 v[100:103], a[244:247], a[20:23], v[100:103]
  v_mfma_f32_16x16x32_bf16 v[104:107], a[212:215], a[52:55], v[104:107]
  v_mfma_f32_16x16x32_bf16 v[108:111], a[244:247], a[52:55], v[108:111]
  v_mfma_f32_16x16x32_bf16 v[112:115], a[212:215], a[84:87], v[112:115]
  v_mfma_f32_16x16x32_bf16 v[116:119], a[244:247], a[84:87], v[116:119]
  v_mfma_f32_16x16x32_bf16 v[120:123], a[212:215], a[116:119], v[120:123]
  v_mfma_f32_16x16x32_bf16 v[124:127], a[244:247], a[116:119], v[124:127]
  s_waitcnt lgkmcnt(0)
  v_mfma_f32_16x16x32_bf16 v[64:67], a[152:155], a[24:27], v[64:67]
  ds_read_b64_tr_b16 a[28:29], v40 offset:28672
  ds_read_b64_tr_b16 a[30:31], v40 offset:29184
  v_mfma_f32_16x16x32_bf16 v[68:71], a[184:187], a[24:27], v[68:71]
  ds_read_b64_tr_b16 a[60:61], v41 offset:28672
  ds_read_b64_tr_b16 a[62:63], v41 offset:29184
  v_mfma_f32_16x16x32_bf16 v[72:75], a[152:155], a[56:59], v[72:75]
  ds_read_b64_tr_b16 a[92:93], v42 offset:28672
  ds_read_b64_tr_b16 a[94:95], v42 offset:29184
  v_mfma_f32_16x16x32_bf16 v[76:79], a[184:187], a[56:59], v[76:79]
  ds_read_b64_tr_b16 a[124:125], v43 offset:28672
  ds_read_b64_tr_b16 a[126:127], v43 offset:29184
  v_mfma_f32_16x16x32_bf16 v[80:83], a[152:155], a[88:91], v[80:83]
  ds_read_b128 a[156:159], v35 offset:256
  ds_read_b128 a[188:191], v35 offset:2304
  v_mfma_f32_16x16x32_bf16 v[84:87], a[184:187], a[88:91], v[84:87]
  ds_read_b128 a[220:223], v35 offset:16640
  ds_read_b128 a[252:255], v35 offset:18688
  v_mfma_f32_16x16x32_bf16 v[88:91], a[152:155], a[120:123], v[88:91]
  v_mfma_f32_16x16x32_bf16 v[92:95], a[184:187], a[120:123], v[92:95]
  v_mfma_f32_16x16x32_bf16 v[96:99], a[216:219], a[24:27], v[96:99]
  v_mfma_f32_16x16x32_bf16 v[100:103], a[248:251], a[24:27], v[100:103]
  v_mfma_f32_16x16x32_bf16 v[104:107], a[216:219], a[56:59], v[104:107]
  v_mfma_f32_16x16x32_bf16 v[108:111], a[248:251], a[56:59], v[108:111]
  v_mfma_f32_16x16x32_bf16 v[112:115], a[216:219], a[88:91], v[112:115]
  v_mfma_f32_16x16x32_bf16 v[116:119], a[248:251], a[88:91], v[116:119]
  v_mfma_f32_16x16x32_bf16 v[120:123], a[216:219], a[120:123], v[120:123]
  v_mfma_f32_16x16x32_bf16 v[124:127], a[248:251], a[120:123], v[124:127]
  s_waitcnt lgkmcnt(0)
  s_barrier
  buffer_load_dwordx2 v[254:255], v252, s[12:15], 0 offen offset:128 sc1
  buffer_load_dword v253, v252, s[12:15], 0 offen sc1
  v_mfma_f32_16x16x32_bf16 v[64:67], a[156:159], a[28:31], v[64:67]
  v_mfma_f32_16x16x32_bf16 v[68:71], a[188:191], a[28:31], v[68:71]
  v_mfma_f32_16x16x32_bf16 v[72:75], a[156:159], a[60:63], v[72:75]
  v_mfma_f32_16x16x32_bf16 v[76:79], a[188:191], a[60:63], v[76:79]
  v_mfma_f32_16x16x32_bf16 v[80:83], a[156:159], a[92:95], v[80:83]
  v_cvt_pk_bf16_f32 v64, v64, v65
  v_cvt_pk_bf16_f32 v65, v66, v67
  v_mfma_f32_16x16x32_bf16 v[84:87], a[188:191], a[92:95], v[84:87]
  v_cvt_pk_bf16_f32 v66, v68, v69
  v_cvt_pk_bf16_f32 v67, v70, v71
  v_mfma_f32_16x16x32_bf16 v[88:91], a[156:159], a[124:127], v[88:91]
  buffer_store_dwordx4 v[64:67], v12, s[8:11], s29 offen sc1
  v_cvt_pk_bf16_f32 v72, v72, v73
  v_mfma_f32_16x16x32_bf16 v[92:95], a[188:191], a[124:127], v[92:95]
  v_cvt_pk_bf16_f32 v73, v74, v75
  v_cvt_pk_bf16_f32 v74, v76, v77
  v_mfma_f32_16x16x32_bf16 v[96:99], a[220:223], a[28:31], v[96:99]
  v_cvt_pk_bf16_f32 v75, v78, v79
  buffer_store_dwordx4 v[72:75], v13, s[8:11], s29 offen sc1
  v_mfma_f32_16x16x32_bf16 v[100:103], a[252:255], a[28:31], v[100:103]
  v_cvt_pk_bf16_f32 v80, v80, v81
  v_cvt_pk_bf16_f32 v81, v82, v83
  v_mfma_f32_16x16x32_bf16 v[104:107], a[220:223], a[60:63], v[104:107]
  v_cvt_pk_bf16_f32 v82, v84, v85
  v_cvt_pk_bf16_f32 v83, v86, v87
  v_mfma_f32_16x16x32_bf16 v[108:111], a[252:255], a[60:63], v[108:111]
  buffer_store_dwordx4 v[80:83], v14, s[8:11], s29 offen sc1
  v_cvt_pk_bf16_f32 v88, v88, v89
  v_mfma_f32_16x16x32_bf16 v[112:115], a[220:223], a[92:95], v[112:115]
  v_cvt_pk_bf16_f32 v89, v90, v91
  v_cvt_pk_bf16_f32 v90, v92, v93
  v_mfma_f32_16x16x32_bf16 v[116:119], a[252:255], a[92:95], v[116:119]
  v_cvt_pk_bf16_f32 v91, v94, v95
  buffer_store_dwordx4 v[88:91], v15, s[8:11], s29 offen sc1
  v_mfma_f32_16x16x32_bf16 v[120:123], a[220:223], a[124:127], v[120:123]
  v_cvt_pk_bf16_f32 v96, v96, v97
  v_cvt_pk_bf16_f32 v97, v98, v99
  v_mfma_f32_16x16x32_bf16 v[124:127], a[252:255], a[124:127], v[124:127]
  v_cvt_pk_bf16_f32 v98, v100, v101
  v_cvt_pk_bf16_f32 v99, v102, v103
  buffer_store_dwordx4 v[96:99], v12, s[8:11], s31 offen sc1
  v_cvt_pk_bf16_f32 v104, v104, v105
  v_cvt_pk_bf16_f32 v105, v106, v107
  v_cvt_pk_bf16_f32 v106, v108, v109
  v_cvt_pk_bf16_f32 v107, v110, v111
  buffer_store_dwordx4 v[104:107], v13, s[8:11], s31 offen sc1
  v_cvt_pk_bf16_f32 v112, v112, v113
  v_cvt_pk_bf16_f32 v113, v114, v115
  v_cvt_pk_bf16_f32 v114, v116, v117
  v_cvt_pk_bf16_f32 v115, v118, v119
  buffer_store_dwordx4 v[112:115], v14, s[8:11], s31 offen sc1
  v_cvt_pk_bf16_f32 v120, v120, v121
  v_cvt_pk_bf16_f32 v121, v122, v123
  v_cvt_pk_bf16_f32 v122, v124, v125
  v_cvt_pk_bf16_f32 v123, v126, v127
  buffer_store_dwordx4 v[120:123], v15, s[8:11], s31 offen sc1
  s_cmp_lg_u32 s34, 0
  s_cbranch_scc1 wp_B2
  s_mov_b32 s60, s40
  s_and_b32 s61, s41, 0xffff
  s_mov_b32 s62, 3670016
  s_mov_b32 s63, 0x20000
  s_mov_b32 s56, s42
  s_and_b32 s57, s43, 0xffff
  s_mov_b32 s58, 3670016
  s_mov_b32 s59, 0x20000
  s_lshl_b32 s27, s18, 2
  s_add_u32 s27, s27, s16
  s_lshl_b32 s27, s27, 17
  s_add_u32 s27, s27, s26
  s_lshl_b32 s30, s16, 13
  s_add_u32 m0, s30, 0
  s_nop 0
  buffer_load_dwordx4 v26, s[56:59], s27 offen  lds
  s_add_u32 s27, s27, 16384
  s_add_u32 m0, s30, 1024
  s_nop 0
  buffer_load_dwordx4 v26, s[56:59], s27 offen  lds
  s_add_u32 s27, s27, 16384
  s_add_u32 m0, s30, 2048
  s_nop 0
  buffer_load_dwordx4 v27, s[56:59], s27 offen  lds
  s_add_u32 s27, s27, 16384
  s_add_u32 m0, s30, 3072
  s_nop 0
  buffer_load_dwordx4 v27, s[56:59], s27 offen  lds
  s_add_u32 s27, s27, 16384
  s_add_u32 m0, s30, 4096
  s_nop 0
  buffer_load_dwordx4 v26, s[56:59], s27 offen  lds
  s_add_u32 s27, s27, 16384
  s_add_u32 m0, s30, 5120
  s_nop 0
  buffer_load_dwordx4 v26, s[56:59], s27 offen  lds
  s_add_u32 s27, s27, 16384
  s_add_u32 m0, s30, 6144
  s_nop 0
  buffer_load_dwordx4 v27, s[56:59], s27 offen  lds
  s_add_u32 s27, s27, 16384
  s_add_u32 m0, s30, 7168
  s_nop 0
  buffer_load_dwordx4 v27, s[56:59], s27 offen  lds
  s_add_u32 s27, s27, 16384
  s_add_u32 s27, s28, 0
  s_min_u32 s27, s27, 13
  s_lshl_b32 s27, s27, 18
  s_add_u32 s27, s27, s26
  s_add_u32 m0, s25, 0
  s_nop 0
  buffer_load_dwordx4 v16, s[60:63], s27 offen  lds
  s_add_u32 s27, s27, 16384
  s_add_u32 m0, s25, 1024
  s_nop 0
  buffer_load_dwordx4 v17, s[60:63], s27 offen  lds
  s_add_u32 s27, s27, 16384
  s_add_u32 m0, s25, 2048
  s_nop 0
  buffer_load_dwordx4 v16, s[60:63], s27 offen  lds
  s_add_u32 s27, s27, 16384
  s_add_u32 m0, s25, 3072
  s_nop 0
  buffer_load_dwordx4 v17, s[60:63], s27 offen  lds
  s_add_u32 s27, s27, 16384
  s_waitcnt vmcnt(12)
  s_barrier
  s_cmp_lg_u32 s16, 0
  s_cbranch_scc1 wp_f1_f
  v_readfirstlane_b32 s20, v254
  s_cmp_eq_u32 s20, 1
  s_cbranch_scc1 wp_f1_w_ok
  s_mov_b32 s30, 0
wp_f1_w:
  buffer_load_dword v254, off, s[12:15], 0 offset:128 sc1
  s_waitcnt vmcnt(0)
  v_cmp_ne_u32 vcc, 1, v254
  s_cbranch_vccz wp_f1_w_ok
  s_sleep 8
  s_add_u32 s30, s30, 1
  s_cmp_lt_u32 s30, 16
  s_cbranch_scc1 wp_f1_w
  s_branch wp_f1_f
wp_f1_w_ok:
  s_lshl_b32 s20, s17, 7
  s_add_u32 s20, s20, 582144
  s_lshl_b32 s21, 1, s19
  v_mov_b32 v248, s21
  s_mov_b64 exec, 1
  buffer_atomic_or v248, v252, s[8:11], s20 offen sc0
  s_mov_b64 exec, -1
  s_mov_b32 s37, s21
wp_f1_f:
  s_add_u32 m0, s25, 4096
  s_nop 0
  buffer_load_dwordx4 v18, s[60:63], s27 offen  lds
  s_add_u32 s27, s27, 16384
  s_add_u32 m0, s25, 5120
  s_nop 0
  buffer_load_dwordx4 v19, s[60:63], s27 offen  lds
  s_add_u32 s27, s27, 16384
  s_add_u32 m0, s25, 6144
  s_nop 0
  buffer_load_dwordx4 v18, s[60:63], s27 offen  lds
  s_add_u32 s27, s27, 16384
  s_add_u32 m0, s25, 7168
  s_nop 0
  buffer_load_dwordx4 v19, s[60:63], s27 offen  lds
  s_add_u32 s27, s27, 16384
  s_add_u32 m0, s25, 8192
  s_nop 0
  buffer_load_dwordx4 v20, s[60:63], s27 offen  lds
  s_add_u32 s27, s27, 16384
  s_add_u32 m0, s25, 9216
  s_nop 0
  buffer_load_dwordx4 v21, s[60:63], s27 offen  lds
  s_add_u32 s27, s27, 16384
  s_add_u32 m0, s25, 10240
  s_nop 0
  buffer_load_dwordx4 v20, s[60:63], s27 offen  lds
  s_add_u32 s27, s27, 16384
  s_add_u32 m0, s25, 11264
  s_nop 0
  buffer_load_dwordx4 v21, s[60:63], s27 offen  lds
  s_add_u32 s27, s27, 16384
  s_add_u32 m0, s25, 12288
  s_nop 0
  buffer_load_dwordx4 v22, s[60:63], s27 offen  lds
  s_add_u32 s27, s27, 16384
  s_add_u32 m0, s25, 13312
  s_nop 0
  buffer_load_dwordx4 v23, s[60:63], s27 offen  lds
  s_add_u32 s27, s27, 16384
  s_add_u32 m0, s25, 14336
  s_nop 0
  buffer_load_dwordx4 v22, s[60:63], s27 offen  lds
  s_add_u32 s27, s27, 16384
  s_add_u32 m0, s25, 15360
  s_nop 0
  buffer_load_dwordx4 v23, s[60:63], s27 offen  lds
  s_add_u32 s27, s27, 16384
  s_add_u32 s27, s28, 4
  s_min_u32 s27, s27, 13
  s_lshl_b32 s27, s27, 18
  s_add_u32 s27, s27, s26
  s_waitcnt vmcnt(12)
  v_readfirstlane_b32 s20, v248
  s_and_b32 s20, s20, 16383
  s_xor_b32 s20, s20, s37
  s_cmp_lg_u32 s20, 16383
  s_cselect_b32 s20, 0, s37
  s_mov_b32 s37, 0
  s_cmp_eq_u32 s20, 0
  s_cbranch_scc1 wp_g1
  s_lshl_b32 s21, 1, s17
  v_mov_b32 v248, s21
  s_mov_b32 s20, 586240
  v_lshlrev_b32 v247, 7, v0
  s_mov_b64 exec, 0xff
  buffer_atomic_or v248, v247, s[8:11], s20 offen
  s_mov_b64 exec, -1
wp_g1:
  s_add_u32 m0, s25, 16384
  s_nop 0
  buffer_load_dwordx4 v16, s[60:63], s27 offen  lds
  s_add_u32 s27, s27, 16384
  s_add_u32 m0, s25, 17408
  s_nop 0
  buffer_load_dwordx4 v17, s[60:63], s27 offen  lds
  s_add_u32 s27, s27, 16384
  s_add_u32 m0, s25, 18432
  s_nop 0
  buffer_load_dwordx4 v16, s[60:63], s27 offen  lds
  s_add_u32 s27, s27, 16384
  s_add_u32 m0, s25, 19456
  s_nop 0
  buffer_load_dwordx4 v17, s[60:63], s27 offen  lds
  s_add_u32 s27, s27, 16384
  s_add_u32 m0, s25, 20480
  s_nop 0
  buffer_load_dwordx4 v18, s[60:63], s27 offen  lds
  s_add_u32 s27, s27, 16384
  s_add_u32 m0, s25, 21504
  s_nop 0
  buffer_load_dwordx4 v19, s[60:63], s27 offen  lds
  s_add_u32 s27, s27, 16384
  s_add_u32 m0, s25, 22528
  s_nop 0
  buffer_load_dwordx4 v18, s[60:63], s27 offen  lds
  s_add_u32 s27, s27, 16384
  s_add_u32 m0, s25, 23552
  s_nop 0
  buffer_load_dwordx4 v19, s[60:63], s27 offen  lds
  s_add_u32 s27, s27, 16384
  s_add_u32 m0, s25, 24576
  s_nop 0
  buffer_load_dwordx4 v20, s[60:63], s27 offen  lds
  s_add_u32 s27, s27, 16384
  s_add_u32 m0, s25, 25600
  s_nop 0
  buffer_load_dwordx4 v21, s[60:63], s27 offen  lds
  s_add_u32 s27, s27, 16384
  s_add_u32 m0, s25, 26624
  s_nop 0
  buffer_load_dwordx4 v20, s[60:63], s27 offen  lds
  s_add_u32 s27, s27, 16384
  s_add_u32 m0, s25, 27648
  s_nop 0
  buffer_load_dwordx4 v21, s[60:63], s27 offen  lds
  s_add_u32 s27, s27, 16384
  s_add_u32 m0, s25, 28672
  s_nop 0
  buffer_load_dwordx4 v22, s[60:63], s27 offen  lds
  s_add_u32 s27, s27, 16384
  s_add_u32 m0, s25, 29696
  s_nop 0
  buffer_load_dwordx4 v23, s[60:63], s27 offen  lds
  s_add_u32 s27, s27, 16384
  s_add_u32 m0, s25, 30720
  s_nop 0
  buffer_load_dwordx4 v22, s[60:63], s27 offen  lds
  s_add_u32 s27, s27, 16384
  s_add_u32 m0, s25, 31744
  s_nop 0
  buffer_load_dwordx4 v23, s[60:63], s27 offen  lds
  s_add_u32 s27, s27, 16384
  s_branch wp_A
wp_B2:
  v_lshlrev_b32 v6, 7, v1
  s_getpc_b64 s[98:99]
ct_5:
  s_add_u32 s98, s98, wp_fin-ct_5
  s_addc_u32 s99, s99, 0
  global_load_dword v7, v6, s[98:99]
  s_getpc_b64 s[98:99]
ct_6:
  s_add_u32 s98, s98, wg_vo-ct_6
  s_addc_u32 s99, s99, 0
  global_load_dword v7, v6, s[98:99]
  s_waitcnt vmcnt(2)
  s_barrier
  s_cmp_lg_u32 s16, 0
  s_cbranch_scc1 wp_f2_f
  v_readfirstlane_b32 s20, v254
  s_cmp_eq_u32 s20, 1
  s_cbranch_scc1 wp_f2_w_ok
  s_mov_b32 s30, 0
wp_f2_w:
  buffer_load_dword v254, off, s[12:15], 0 offset:128 sc1
  s_waitcnt vmcnt(0)
  v_cmp_ne_u32 vcc, 1, v254
  s_cbranch_vccz wp_f2_w_ok
  s_sleep 8
  s_add_u32 s30, s30, 1
  s_cmp_lt_u32 s30, 16
  s_cbranch_scc1 wp_f2_w
  s_branch wp_f2_f
wp_f2_w_ok:
  s_lshl_b32 s20, s17, 7
  s_add_u32 s20, s20, 582144
  s_lshl_b32 s21, 1, s19
  v_mov_b32 v248, s21
  s_mov_b64 exec, 1
  buffer_atomic_or v248, v252, s[8:11], s20 offen sc0
  s_mov_b64 exec, -1
  s_mov_b32 s37, s21
wp_f2_f:
  s_cmp_eq_u32 s97, 0
  s_cselect_b32 s39, -1, s39
  s_branch wp_fin
wp_A0:
  s_mov_b32 s60, s40
  s_and_b32 s61, s41, 0xffff
  s_mov_b32 s62, 3670016
  s_mov_b32 s63, 0x20000
  s_mov_b32 s56, s42
  s_and_b32 s57, s43, 0xffff
  s_mov_b32 s58, 3670016
  s_mov_b32 s59, 0x20000
  s_lshl_b32 s27, s18, 2
  s_add_u32 s27, s27, s16
  s_lshl_b32 s27, s27, 17
  s_add_u32 s27, s27, s26
  s_lshl_b32 s30, s16, 13
  s_add_u32 m0, s30, 0
  s_nop 0
  buffer_load_dwordx4 v26, s[56:59], s27 offen  lds
  s_add_u32 s27, s27, 16384
  s_add_u32 m0, s30, 1024
  s_nop 0
  buffer_load_dwordx4 v26, s[56:59], s27 offen  lds
  s_add_u32 s27, s27, 16384
  s_add_u32 m0, s30, 2048
  s_nop 0
  buffer_load_dwordx4 v27, s[56:59], s27 offen  lds
  s_add_u32 s27, s27, 16384
  s_add_u32 m0, s30, 3072
  s_nop 0
  buffer_load_dwordx4 v27, s[56:59], s27 offen  lds
  s_add_u32 s27, s27, 16384
  s_add_u32 m0, s30, 4096
  s_nop 0
  buffer_load_dwordx4 v26, s[56:59], s27 offen  lds
  s_add_u32 s27, s27, 16384
  s_add_u32 m0, s30, 5120
  s_nop 0
  buffer_load_dwordx4 v26, s[56:59], s27 offen  lds
  s_add_u32 s27, s27, 16384
  s_add_u32 m0, s30, 6144
  s_nop 0
  buffer_load_dwordx4 v27, s[56:59], s27 offen  lds
  s_add_u32 s27, s27, 16384
  s_add_u32 m0, s30, 7168
  s_nop 0
  buffer_load_dwordx4 v27, s[56:59], s27 offen  lds
  s_add_u32 s27, s27, 16384
  s_add_u32 s27, s28, 0
  s_min_u32 s27, s27, 13
  s_lshl_b32 s27, s27, 18
  s_add_u32 s27, s27, s26
  s_add_u32 m0, s25, 0
  s_nop 0
  buffer_load_dwordx4 v16, s[60:63], s27 offen  lds
  s_add_u32 s27, s27, 16384
  s_add_u32 m0, s25, 1024
  s_nop 0
  buffer_load_dwordx4 v17, s[60:63], s27 offen  lds
  s_add_u32 s27, s27, 16384
  s_add_u32 m0, s25, 2048
  s_nop 0
  buffer_load_dwordx4 v16, s[60:63], s27 offen  lds
  s_add_u32 s27, s27, 16384
  s_add_u32 m0, s25, 3072
  s_nop 0
  buffer_load_dwordx4 v17, s[60:63], s27 offen  lds
  s_add_u32 s27, s27, 16384
  s_add_u32 m0, s25, 4096
  s_nop 0
  buffer_load_dwordx4 v18, s[60:63], s27 offen  lds
  s_add_u32 s27, s27, 16384
  s_add_u32 m0, s25, 5120
  s_nop 0
  buffer_load_dwordx4 v19, s[60:63], s27 offen  lds
  s_add_u32 s27, s27, 16384
  s_add_u32 m0, s25, 6144
  s_nop 0
  buffer_load_dwordx4 v18, s[60:63], s27 offen  lds
  s_add_u32 s27, s27, 16384
  s_add_u32 m0, s25, 7168
  s_nop 0
  buffer_load_dwordx4 v19, s[60:63], s27 offen  lds
  s_add_u32 s27, s27, 16384
  s_add_u32 m0, s25, 8192
  s_nop 0
  buffer_load_dwordx4 v20, s[60:63], s27 offen  lds
  s_add_u32 s27, s27, 16384
  s_add_u32 m0, s25, 9216
  s_nop 0
  buffer_load_dwordx4 v21, s[60:63], s27 offen  lds
  s_add_u32 s27, s27, 16384
  s_add_u32 m0, s25, 10240
  s_nop 0
  buffer_load_dwordx4 v20, s[60:63], s27 offen  lds
  s_add_u32 s27, s27, 16384
  s_add_u32 m0, s25, 11264
  s_nop 0
  buffer_load_dwordx4 v21, s[60:63], s27 offen  lds
  s_add_u32 s27, s27, 16384
  s_add_u32 m0, s25, 12288
  s_nop 0
  buffer_load_dwordx4 v22, s[60:63], s27 offen  lds
  s_add_u32 s27, s27, 16384
  s_add_u32 m0, s25, 13312
  s_nop 0
  buffer_load_dwordx4 v23, s[60:63], s27 offen  lds
  s_add_u32 s27, s27, 16384
  s_add_u32 m0, s25, 14336
  s_nop 0
  buffer_load_dwordx4 v22, s[60:63], s27 offen  lds
  s_add_u32 s27, s27, 16384
  s_add_u32 m0, s25, 15360
  s_nop 0
  buffer_load_dwordx4 v23, s[60:63], s27 offen  lds
  s_add_u32 s27, s27, 16384
  s_add_u32 s27, s28, 4
  s_min_u32 s27, s27, 13
  s_lshl_b32 s27, s27, 18
  s_add_u32 s27, s27, s26
  s_add_u32 m0, s25, 16384
  s_nop 0
  buffer_load_dwordx4 v16, s[60:63], s27 offen  lds
  s_add_u32 s27, s27, 16384
  s_add_u32 m0, s25, 17408
  s_nop 0
  buffer_load_dwordx4 v17, s[60:63], s27 offen  lds
  s_add_u32 s27, s27, 16384
  s_add_u32 m0, s25, 18432
  s_nop 0
  buffer_load_dwordx4 v16, s[60:63], s27 offen  lds
  s_add_u32 s27, s27, 16384
  s_add_u32 m0, s25, 19456
  s_nop 0
  buffer_load_dwordx4 v17, s[60:63], s27 offen  lds
  s_add_u32 s27, s27, 16384
  s_add_u32 m0, s25, 20480
  s_nop 0
  buffer_load_dwordx4 v18, s[60:63], s27 offen  lds
  s_add_u32 s27, s27, 16384
  s_add_u32 m0, s25, 21504
  s_nop 0
  buffer_load_dwordx4 v19, s[60:63], s27 offen  lds
  s_add_u32 s27, s27, 16384
  s_add_u32 m0, s25, 22528
  s_nop 0
  buffer_load_dwordx4 v18, s[60:63], s27 offen  lds
  s_add_u32 s27, s27, 16384
  s_add_u32 m0, s25, 23552
  s_nop 0
  buffer_load_dwordx4 v19, s[60:63], s27 offen  lds
  s_add_u32 s27, s27, 16384
  s_add_u32 m0, s25, 24576
  s_nop 0
  buffer_load_dwordx4 v20, s[60:63], s27 offen  lds
  s_add_u32 s27, s27, 16384
  s_add_u32 m0, s25, 25600
  s_nop 0
  buffer_load_dwordx4 v21, s[60:63], s27 offen  lds
  s_add_u32 s27, s27, 16384
  s_add_u32 m0, s25, 26624
  s_nop 0
  buffer_load_dwordx4 v20, s[60:63], s27 offen  lds
  s_add_u32 s27, s27, 16384
  s_add_u32 m0, s25, 27648
  s_nop 0
  buffer_load_dwordx4 v21, s[60:63], s27 offen  lds
  s_add_u32 s27, s27, 16384
  s_add_u32 m0, s25, 28672
  s_nop 0
  buffer_load_dwordx4 v22, s[60:63], s27 offen  lds
  s_add_u32 s27, s27, 16384
  s_add_u32 m0, s25, 29696
  s_nop 0
  buffer_load_dwordx4 v23, s[60:63], s27 offen  lds
  s_add_u32 s27, s27, 16384
  s_add_u32 m0, s25, 30720
  s_nop 0
  buffer_load_dwordx4 v22, s[60:63], s27 offen  lds
  s_add_u32 s27, s27, 16384
  s_add_u32 m0, s25, 31744
  s_nop 0
  buffer_load_dwordx4 v23, s[60:63], s27 offen  lds
  s_add_u32 s27, s27, 16384
  v_lshrrev_b32 v7, 2, v4
  v_lshlrev_b32 v11, 4, v7
  v_lshlrev_b32 v7, 3, v7
  v_and_b32 v8, 3, v4
  v_add_u32 v7, v7, v8
  v_and_b32 v8, 2, v4
  v_lshl_add_u32 v11, v8, 1, v11
  v_and_b32 v8, 1, v4
  v_add_u32 v11, v11, v8
  v_or_b32 v10, 0, v3
  v_xor_b32 v10, v10, v4
  v_lshlrev_b32 v10, 4, v10
  v_lshl_add_u32 v44, v11, 9, v10
  v_lshl_add_u32 v10, v7, 9, v10
  v_add_u32 v32, s25, v10
  v_or_b32 v10, 4, v3
  v_xor_b32 v10, v10, v4
  v_lshlrev_b32 v10, 4, v10
  v_lshl_add_u32 v45, v11, 9, v10
  v_lshl_add_u32 v10, v7, 9, v10
  v_add_u32 v33, s25, v10
  v_or_b32 v10, 8, v3
  v_xor_b32 v10, v10, v4
  v_lshlrev_b32 v10, 4, v10
  v_lshl_add_u32 v46, v11, 9, v10
  v_lshl_add_u32 v10, v7, 9, v10
  v_add_u32 v34, s25, v10
  v_or_b32 v10, 12, v3
  v_xor_b32 v10, v10, v4
  v_lshlrev_b32 v10, 4, v10
  v_lshl_add_u32 v47, v11, 9, v10
  v_lshl_add_u32 v10, v7, 9, v10
  v_add_u32 v35, s25, v10
  s_mul_i32 s30, s17, 401408
  s_mul_i32 s31, s18, 57344
  s_add_u32 s30, s30, s31
  s_add_u32 s30, s30, 33554432
  v_add_u32 v28, s30, v2
  s_add_u32 s30, s30, 14336
  v_add_u32 v29, s30, v2
  s_add_u32 s30, s30, 14336
  v_add_u32 v30, s30, v2
  s_add_u32 s30, s30, 14336
  v_add_u32 v31, s30, v2
  s_add_u32 s30, s30, 14336
  v_mov_b32 v48, 1035512379
wp_A:
  s_lshl_b32 s29, s28, 10
  s_add_u32 s31, s29, 4096
  s_cmp_lt_u32 s28, 10
  s_cselect_b32 s31, s31, 0x40000000
  s_waitcnt vmcnt(0)
  s_barrier
  ds_read_b128 a[0:3], v44 offset:0
  ds_read_b128 a[32:35], v44 offset:1024
  ds_read_b128 a[64:67], v44 offset:4096
  ds_read_b128 a[96:99], v44 offset:5120
  ds_read_b128 a[128:131], v32 offset:0
  ds_read_b128 a[160:163], v32 offset:2048
  ds_read_b128 a[192:195], v32 offset:16384
  ds_read_b128 a[224:227], v32 offset:18432
  s_waitcnt lgkmcnt(0)
  v_mfma_f32_16x16x32_bf16 v[64:67], a[128:131], a[0:3], 0
  ds_read_b128 a[4:7], v45 offset:0
  ds_read_b128 a[36:39], v45 offset:1024
  v_mfma_f32_16x16x32_bf16 v[68:71], a[160:163], a[0:3], 0
  ds_read_b128 a[68:71], v45 offset:4096
  ds_read_b128 a[100:103], v45 offset:5120
  v_mfma_f32_16x16x32_bf16 v[72:75], a[128:131], a[32:35], 0
  ds_read_b128 a[132:135], v33 offset:0
  ds_read_b128 a[164:167], v33 offset:2048
  v_mfma_f32_16x16x32_bf16 v[76:79], a[160:163], a[32:35], 0
  ds_read_b128 a[196:199], v33 offset:16384
  ds_read_b128 a[228:231], v33 offset:18432
  v_mfma_f32_16x16x32_bf16 v[80:83], a[128:131], a[64:67], 0
  v_mfma_f32_16x16x32_bf16 v[84:87], a[160:163], a[64:67], 0
  v_mfma_f32_16x16x32_bf16 v[88:91], a[128:131], a[96:99], 0
  v_mfma_f32_16x16x32_bf16 v[92:95], a[160:163], a[96:99], 0
  v_mfma_f32_16x16x32_bf16 v[96:99], a[192:195], a[0:3], 0
  v_mfma_f32_16x16x32_bf16 v[100:103], a[224:227], a[0:3], 0
  v_mfma_f32_16x16x32_bf16 v[104:107], a[192:195], a[32:35], 0
  v_mfma_f32_16x16x32_bf16 v[108:111], a[224:227], a[32:35], 0
  v_mfma_f32_16x16x32_bf16 v[112:115], a[192:195], a[64:67], 0
  v_mfma_f32_16x16x32_bf16 v[116:119], a[224:227], a[64:67], 0
  v_mfma_f32_16x16x32_bf16 v[120:123], a[192:195], a[96:99], 0
  v_mfma_f32_16x16x32_bf16 v[124:127], a[224:227], a[96:99], 0
  s_waitcnt lgkmcnt(0)
  v_mfma_f32_16x16x32_bf16 v[64:67], a[132:135], a[4:7], v[64:67]
  ds_read_b128 a[8:11], v46 offset:0
  ds_read_b128 a[40:43], v46 offset:1024
  v_mfma_f32_16x16x32_bf16 v[68:71], a[164:167], a[4:7], v[68:71]
  ds_read_b128 a[72:75], v46 offset:4096
  ds_read_b128 a[104:107], v46 offset:5120
  v_mfma_f32_16x16x32_bf16 v[72:75], a[132:135], a[36:39], v[72:75]
  ds_read_b128 a[136:139], v34 offset:0
  ds_read_b128 a[168:171], v34 offset:2048
  v_mfma_f32_16x16x32_bf16 v[76:79], a[164:167], a[36:39], v[76:79]
  ds_read_b128 a[200:203], v34 offset:16384
  ds_read_b128 a[232:235], v34 offset:18432
  v_mfma_f32_16x16x32_bf16 v[80:83], a[132:135], a[68:71], v[80:83]
  v_mfma_f32_16x16x32_bf16 v[84:87], a[164:167], a[68:71], v[84:87]
  v_mfma_f32_16x16x32_bf16 v[88:91], a[132:135], a[100:103], v[88:91]
  v_mfma_f32_16x16x32_bf16 v[92:95], a[164:167], a[100:103], v[92:95]
  v_mfma_f32_16x16x32_bf16 v[96:99], a[196:199], a[4:7], v[96:99]
  v_mfma_f32_16x16x32_bf16 v[100:103], a[228:231], a[4:7], v[100:103]
  v_mfma_f32_16x16x32_bf16 v[104:107], a[196:199], a[36:39], v[104:107]
  v_mfma_f32_16x16x32_bf16 v[108:111], a[228:231], a[36:39], v[108:111]
  v_mfma_f32_16x16x32_bf16 v[112:115], a[196:199], a[68:71], v[112:115]
  v_mfma_f32_16x16x32_bf16 v[116:119], a[228:231], a[68:71], v[116:119]
  v_mfma_f32_16x16x32_bf16 v[120:123], a[196:199], a[100:103], v[120:123]
  v_mfma_f32_16x16x32_bf16 v[124:127], a[228:231], a[100:103], v[124:127]
  s_waitcnt lgkmcnt(0)
  v_mfma_f32_16x16x32_bf16 v[64:67], a[136:139], a[8:11], v[64:67]
  ds_read_b128 a[12:15], v47 offset:0
  ds_read_b128 a[44:47], v47 offset:1024
  v_mfma_f32_16x16x32_bf16 v[68:71], a[168:171], a[8:11], v[68:71]
  ds_read_b128 a[76:79], v47 offset:4096
  ds_read_b128 a[108:111], v47 offset:5120
  v_mfma_f32_16x16x32_bf16 v[72:75], a[136:139], a[40:43], v[72:75]
  ds_read_b128 a[140:143], v35 offset:0
  ds_read_b128 a[172:175], v35 offset:2048
  v_mfma_f32_16x16x32_bf16 v[76:79], a[168:171], a[40:43], v[76:79]
  ds_read_b128 a[204:207], v35 offset:16384
  ds_read_b128 a[236:239], v35 offset:18432
  v_mfma_f32_16x16x32_bf16 v[80:83], a[136:139], a[72:75], v[80:83]
  v_mfma_f32_16x16x32_bf16 v[84:87], a[168:171], a[72:75], v[84:87]
  v_mfma_f32_16x16x32_bf16 v[88:91], a[136:139], a[104:107], v[88:91]
  v_mfma_f32_16x16x32_bf16 v[92:95], a[168:171], a[104:107], v[92:95]
  v_mfma_f32_16x16x32_bf16 v[96:99], a[200:203], a[8:11], v[96:99]
  v_mfma_f32_16x16x32_bf16 v[100:103], a[232:235], a[8:11], v[100:103]
  v_mfma_f32_16x16x32_bf16 v[104:107], a[200:203], a[40:43], v[104:107]
  v_mfma_f32_16x16x32_bf16 v[108:111], a[232:235], a[40:43], v[108:111]
  v_mfma_f32_16x16x32_bf16 v[112:115], a[200:203], a[72:75], v[112:115]
  v_mfma_f32_16x16x32_bf16 v[116:119], a[232:235], a[72:75], v[116:119]
  v_mfma_f32_16x16x32_bf16 v[120:123], a[200:203], a[104:107], v[120:123]
  v_mfma_f32_16x16x32_bf16 v[124:127], a[232:235], a[104:107], v[124:127]
  s_waitcnt lgkmcnt(0)
  v_mfma_f32_16x16x32_bf16 v[64:67], a[140:143], a[12:15], v[64:67]
  ds_read_b128 a[16:19], v44 offset:256
  ds_read_b128 a[48:51], v44 offset:1280
  v_mfma_f32_16x16x32_bf16 v[68:71], a[172:175], a[12:15], v[68:71]
  ds_read_b128 a[80:83], v44 offset:4352
  ds_read_b128 a[112:115], v44 offset:5376
  v_mfma_f32_16x16x32_bf16 v[72:75], a[140:143], a[44:47], v[72:75]
  ds_read_b128 a[144:147], v32 offset:256
  ds_read_b128 a[176:179], v32 offset:2304
  v_mfma_f32_16x16x32_bf16 v[76:79], a[172:175], a[44:47], v[76:79]
  ds_read_b128 a[208:211], v32 offset:16640
  ds_read_b128 a[240:243], v32 offset:18688
  v_mfma_f32_16x16x32_bf16 v[80:83], a[140:143], a[76:79], v[80:83]
  v_mfma_f32_16x16x32_bf16 v[84:87], a[172:175], a[76:79], v[84:87]
  v_mfma_f32_16x16x32_bf16 v[88:91], a[140:143], a[108:111], v[88:91]
  v_mfma_f32_16x16x32_bf16 v[92:95], a[172:175], a[108:111], v[92:95]
  v_mfma_f32_16x16x32_bf16 v[96:99], a[204:207], a[12:15], v[96:99]
  v_mfma_f32_16x16x32_bf16 v[100:103], a[236:239], a[12:15], v[100:103]
  v_mfma_f32_16x16x32_bf16 v[104:107], a[204:207], a[44:47], v[104:107]
  v_mfma_f32_16x16x32_bf16 v[108:111], a[236:239], a[44:47], v[108:111]
  v_mfma_f32_16x16x32_bf16 v[112:115], a[204:207], a[76:79], v[112:115]
  v_mfma_f32_16x16x32_bf16 v[116:119], a[236:239], a[76:79], v[116:119]
  v_mfma_f32_16x16x32_bf16 v[120:123], a[204:207], a[108:111], v[120:123]
  v_mfma_f32_16x16x32_bf16 v[124:127], a[236:239], a[108:111], v[124:127]
  s_waitcnt lgkmcnt(0)
  v_mfma_f32_16x16x32_bf16 v[64:67], a[144:147], a[16:19], v[64:67]
  ds_read_b128 a[20:23], v45 offset:256
  ds_read_b128 a[52:55], v45 offset:1280
  v_mfma_f32_16x16x32_bf16 v[68:71], a[176:179], a[16:19], v[68:71]
  ds_read_b128 a[84:87], v45 offset:4352
  ds_read_b128 a[116:119], v45 offset:5376
  v_mfma_f32_16x16x32_bf16 v[72:75], a[144:147], a[48:51], v[72:75]
  ds_read_b128 a[148:151], v33 offset:256
  ds_read_b128 a[180:183], v33 offset:2304
  v_mfma_f32_16x16x32_bf16 v[76:79], a[176:179], a[48:51], v[76:79]
  ds_read_b128 a[212:215], v33 offset:16640
  ds_read_b128 a[244:247], v33 offset:18688
  v_mfma_f32_16x16x32_bf16 v[80:83], a[144:147], a[80:83], v[80:83]
  v_mfma_f32_16x16x32_bf16 v[84:87], a[176:179], a[80:83], v[84:87]
  v_mfma_f32_16x16x32_bf16 v[88:91], a[144:147], a[112:115], v[88:91]
  v_mfma_f32_16x16x32_bf16 v[92:95], a[176:179], a[112:115], v[92:95]
  v_mfma_f32_16x16x32_bf16 v[96:99], a[208:211], a[16:19], v[96:99]
  v_mfma_f32_16x16x32_bf16 v[100:103], a[240:243], a[16:19], v[100:103]
  v_mfma_f32_16x16x32_bf16 v[104:107], a[208:211], a[48:51], v[104:107]
  v_mfma_f32_16x16x32_bf16 v[108:111], a[240:243], a[48:51], v[108:111]
  v_mfma_f32_16x16x32_bf16 v[112:115], a[208:211], a[80:83], v[112:115]
  v_mfma_f32_16x16x32_bf16 v[116:119], a[240:243], a[80:83], v[116:119]
  v_mfma_f32_16x16x32_bf16 v[120:123], a[208:211], a[112:115], v[120:123]
  v_mfma_f32_16x16x32_bf16 v[124:127], a[240:243], a[112:115], v[124:127]
  s_waitcnt lgkmcnt(0)
  v_mfma_f32_16x16x32_bf16 v[64:67], a[148:151], a[20:23], v[64:67]
  ds_read_b128 a[24:27], v46 offset:256
  ds_read_b128 a[56:59], v46 offset:1280
  v_mfma_f32_16x16x32_bf16 v[68:71], a[180:183], a[20:23], v[68:71]
  ds_read_b128 a[88:91], v46 offset:4352
  ds_read_b128 a[120:123], v46 offset:5376
  v_mfma_f32_16x16x32_bf16 v[72:75], a[148:151], a[52:55], v[72:75]
  ds_read_b128 a[152:155], v34 offset:256
  ds_read_b128 a[184:187], v34 offset:2304
  v_mfma_f32_16x16x32_bf16 v[76:79], a[180:183], a[52:55], v[76:79]
  ds_read_b128 a[216:219], v34 offset:16640
  ds_read_b128 a[248:251], v34 offset:18688
  v_mfma_f32_16x16x32_bf16 v[80:83], a[148:151], a[84:87], v[80:83]
  v_mfma_f32_16x16x32_bf16 v[84:87], a[180:183], a[84:87], v[84:87]
  v_mfma_f32_16x16x32_bf16 v[88:91], a[148:151], a[116:119], v[88:91]
  v_mfma_f32_16x16x32_bf16 v[92:95], a[180:183], a[116:119], v[92:95]
  v_mfma_f32_16x16x32_bf16 v[96:99], a[212:215], a[20:23], v[96:99]
  v_mfma_f32_16x16x32_bf16 v[100:103], a[244:247], a[20:23], v[100:103]
  v_mfma_f32_16x16x32_bf16 v[104:107], a[212:215], a[52:55], v[104:107]
  v_mfma_f32_16x16x32_bf16 v[108:111], a[244:247], a[52:55], v[108:111]
  v_mfma_f32_16x16x32_bf16 v[112:115], a[212:215], a[84:87], v[112:115]
  v_mfma_f32_16x16x32_bf16 v[116:119], a[244:247], a[84:87], v[116:119]
  v_mfma_f32_16x16x32_bf16 v[120:123], a[212:215], a[116:119], v[120:123]
  v_mfma_f32_16x16x32_bf16 v[124:127], a[244:247], a[116:119], v[124:127]
  s_waitcnt lgkmcnt(0)
  v_mfma_f32_16x16x32_bf16 v[64:67], a[152:155], a[24:27], v[64:67]
  ds_read_b128 a[28:31], v47 offset:256
  ds_read_b128 a[60:63], v47 offset:1280
  v_mfma_f32_16x16x32_bf16 v[68:71], a[184:187], a[24:27], v[68:71]
  ds_read_b128 a[92:95], v47 offset:4352
  ds_read_b128 a[124:127], v47 offset:5376
  v_mfma_f32_16x16x32_bf16 v[72:75], a[152:155], a[56:59], v[72:75]
  ds_read_b128 a[156:159], v35 offset:256
  ds_read_b128 a[188:191], v35 offset:2304
  v_mfma_f32_16x16x32_bf16 v[76:79], a[184:187], a[56:59], v[76:79]
  ds_read_b128 a[220:223], v35 offset:16640
  ds_read_b128 a[252:255], v35 offset:18688
  v_mfma_f32_16x16x32_bf16 v[80:83], a[152:155], a[88:91], v[80:83]
  v_mfma_f32_16x16x32_bf16 v[84:87], a[184:187], a[88:91], v[84:87]
  v_mfma_f32_16x16x32_bf16 v[88:91], a[152:155], a[120:123], v[88:91]
  v_mfma_f32_16x16x32_bf16 v[92:95], a[184:187], a[120:123], v[92:95]
  v_mfma_f32_16x16x32_bf16 v[96:99], a[216:219], a[24:27], v[96:99]
  v_mfma_f32_16x16x32_bf16 v[100:103], a[248:251], a[24:27], v[100:103]
  v_mfma_f32_16x16x32_bf16 v[104:107], a[216:219], a[56:59], v[104:107]
  v_mfma_f32_16x16x32_bf16 v[108:111], a[248:251], a[56:59], v[108:111]
  v_mfma_f32_16x16x32_bf16 v[112:115], a[216:219], a[88:91], v[112:115]
  v_mfma_f32_16x16x32_bf16 v[116:119], a[248:251], a[88:91], v[116:119]
  v_mfma_f32_16x16x32_bf16 v[120:123], a[216:219], a[120:123], v[120:123]
  v_mfma_f32_16x16x32_bf16 v[124:127], a[248:251], a[120:123], v[124:127]
  s_waitcnt lgkmcnt(0)
  s_barrier
  buffer_load_dwordx2 v[254:255], v252, s[12:15], 0 offen offset:128 sc1
  buffer_load_dword v253, v252, s[12:15], 0 offen sc1
  v_mfma_f32_16x16x32_bf16 v[64:67], a[156:159], a[28:31], v[64:67]
  v_mfma_f32_16x16x32_bf16 v[68:71], a[188:191], a[28:31], v[68:71]
  v_mfma_f32_16x16x32_bf16 v[72:75], a[156:159], a[60:63], v[72:75]
  v_mfma_f32_16x16x32_bf16 v[76:79], a[188:191], a[60:63], v[76:79]
  v_mfma_f32_16x16x32_bf16 v[80:83], a[156:159], a[92:95], v[80:83]
  v_pk_mul_f32 v[64:65], v[64:65], v[48:49] op_sel_hi:[1,0]
  v_pk_mul_f32 v[66:67], v[66:67], v[48:49] op_sel_hi:[1,0]
  v_mfma_f32_16x16x32_bf16 v[84:87], a[188:191], a[92:95], v[84:87]
  v_pk_mul_f32 v[68:69], v[68:69], v[48:49] op_sel_hi:[1,0]
  v_pk_mul_f32 v[70:71], v[70:71], v[48:49] op_sel_hi:[1,0]
  v_mfma_f32_16x16x32_bf16 v[88:91], a[156:159], a[124:127], v[88:91]
  v_cvt_pk_bf16_f32 v64, v64, v65
  v_cvt_pk_bf16_f32 v65, v66, v67
  v_mfma_f32_16x16x32_bf16 v[92:95], a[188:191], a[124:127], v[92:95]
  v_cvt_pk_bf16_f32 v66, v68, v69
  v_cvt_pk_bf16_f32 v67, v70, v71
  v_mfma_f32_16x16x32_bf16 v[96:99], a[220:223], a[28:31], v[96:99]
  buffer_store_dwordx4 v[64:67], v28, s[8:11], s29 offen sc1
  v_pk_mul_f32 v[72:73], v[72:73], v[48:49] op_sel_hi:[1,0]
  v_mfma_f32_16x16x32_bf16 v[100:103], a[252:255], a[28:31], v[100:103]
  v_pk_mul_f32 v[74:75], v[74:75], v[48:49] op_sel_hi:[1,0]
  v_pk_mul_f32 v[76:77], v[76:77], v[48:49] op_sel_hi:[1,0]
  v_mfma_f32_16x16x32_bf16 v[104:107], a[220:223], a[60:63], v[104:107]
  v_pk_mul_f32 v[78:79], v[78:79], v[48:49] op_sel_hi:[1,0]
  v_cvt_pk_bf16_f32 v72, v72, v73
  v_mfma_f32_16x16x32_bf16 v[108:111], a[252:255], a[60:63], v[108:111]
  v_cvt_pk_bf16_f32 v73, v74, v75
  v_cvt_pk_bf16_f32 v74, v76, v77
  v_mfma_f32_16x16x32_bf16 v[112:115], a[220:223], a[92:95], v[112:115]
  v_cvt_pk_bf16_f32 v75, v78, v79
  buffer_store_dwordx4 v[72:75], v29, s[8:11], s29 offen sc1
  v_mfma_f32_16x16x32_bf16 v[116:119], a[252:255], a[92:95], v[116:119]
  v_pk_mul_f32 v[80:81], v[80:81], v[48:49] op_sel_hi:[1,0]
  v_pk_mul_f32 v[82:83], v[82:83], v[48:49] op_sel_hi:[1,0]
  v_mfma_f32_16x16x32_bf16 v[120:123], a[220:223], a[124:127], v[120:123]
  v_pk_mul_f32 v[84:85], v[84:85], v[48:49] op_sel_hi:[1,0]
  v_pk_mul_f32 v[86:87], v[86:87], v[48:49] op_sel_hi:[1,0]
  v_mfma_f32_16x16x32_bf16 v[124:127], a[252:255], a[124:127], v[124:127]
  v_cvt_pk_bf16_f32 v80, v80, v81
  v_cvt_pk_bf16_f32 v81, v82, v83
  v_cvt_pk_bf16_f32 v82, v84, v85
  v_cvt_pk_bf16_f32 v83, v86, v87
  buffer_store_dwordx4 v[80:83], v30, s[8:11], s29 offen sc1
  v_pk_mul_f32 v[88:89], v[88:89], v[48:49] op_sel_hi:[1,0]
  v_pk_mul_f32 v[90:91], v[90:91], v[48:49] op_sel_hi:[1,0]
  v_pk_mul_f32 v[92:93], v[92:93], v[48:49] op_sel_hi:[1,0]
  v_pk_mul_f32 v[94:95], v[94:95], v[48:49] op_sel_hi:[1,0]
  v_cvt_pk_bf16_f32 v88, v88, v89
  v_cvt_pk_bf16_f32 v89, v90, v91
  v_cvt_pk_bf16_f32 v90, v92, v93
  v_cvt_pk_bf16_f32 v91, v94, v95
  buffer_store_dwordx4 v[88:91], v31, s[8:11], s29 offen sc1
  v_pk_mul_f32 v[96:97], v[96:97], v[48:49] op_sel_hi:[1,0]
  v_pk_mul_f32 v[98:99], v[98:99], v[48:49] op_sel_hi:[1,0]
  v_pk_mul_f32 v[100:101], v[100:101], v[48:49] op_sel_hi:[1,0]
  v_pk_mul_f32 v[102:103], v[102:103], v[48:49] op_sel_hi:[1,0]
  v_cvt_pk_bf16_f32 v96, v96, v97
  v_cvt_pk_bf16_f32 v97, v98, v99
  v_cvt_pk_bf16_f32 v98, v100, v101
  v_cvt_pk_bf16_f32 v99, v102, v103
  buffer_store_dwordx4 v[96:99], v28, s[8:11], s31 offen sc1
  v_pk_mul_f32 v[104:105], v[104:105], v[48:49] op_sel_hi:[1,0]
  v_pk_mul_f32 v[106:107], v[106:107], v[48:49] op_sel_hi:[1,0]
  v_pk_mul_f32 v[108:109], v[108:109], v[48:49] op_sel_hi:[1,0]
  v_pk_mul_f32 v[110:111], v[110:111], v[48:49] op_sel_hi:[1,0]
  v_cvt_pk_bf16_f32 v104, v104, v105
  v_cvt_pk_bf16_f32 v105, v106, v107
  v_cvt_pk_bf16_f32 v106, v108, v109
  v_cvt_pk_bf16_f32 v107, v110, v111
  buffer_store_dwordx4 v[104:107], v29, s[8:11], s31 offen sc1
  v_pk_mul_f32 v[112:113], v[112:113], v[48:49] op_sel_hi:[1,0]
  v_pk_mul_f32 v[114:115], v[114:115], v[48:49] op_sel_hi:[1,0]
  v_pk_mul_f32 v[116:117], v[116:117], v[48:49] op_sel_hi:[1,0]
  v_pk_mul_f32 v[118:119], v[118:119], v[48:49] op_sel_hi:[1,0]
  v_cvt_pk_bf16_f32 v112, v112, v113
  v_cvt_pk_bf16_f32 v113, v114, v115
  v_cvt_pk_bf16_f32 v114, v116, v117
  v_cvt_pk_bf16_f32 v115, v118, v119
  buffer_store_dwordx4 v[112:115], v30, s[8:11], s31 offen sc1
  v_pk_mul_f32 v[120:121], v[120:121], v[48:49] op_sel_hi:[1,0]
  v_pk_mul_f32 v[122:123], v[122:123], v[48:49] op_sel_hi:[1,0]
  v_pk_mul_f32 v[124:125], v[124:125], v[48:49] op_sel_hi:[1,0]
  v_pk_mul_f32 v[126:127], v[126:127], v[48:49] op_sel_hi:[1,0]
  v_cvt_pk_bf16_f32 v120, v120, v121
  v_cvt_pk_bf16_f32 v121, v122, v123
  v_cvt_pk_bf16_f32 v122, v124, v125
  v_cvt_pk_bf16_f32 v123, v126, v127
  buffer_store_dwordx4 v[120:123], v31, s[8:11], s31 offen sc1
  s_waitcnt vmcnt(0)
  s_barrier
  s_cmp_lg_u32 s16, 0
  s_cbranch_scc1 wp_f3_f
  v_readfirstlane_b32 s20, v254
  s_cmp_eq_u32 s20, 1
  s_cbranch_scc1 wp_f3_w_ok
  s_mov_b32 s30, 0
wp_f3_w:
  buffer_load_dword v254, off, s[12:15], 0 offset:128 sc1
  s_waitcnt vmcnt(0)
  v_cmp_ne_u32 vcc, 1, v254
  s_cbranch_vccz wp_f3_w_ok
  s_sleep 8
  s_add_u32 s30, s30, 1
  s_cmp_lt_u32 s30, 16
  s_cbranch_scc1 wp_f3_w
  s_branch wp_f3_f
wp_f3_w_ok:
  s_lshl_b32 s20, s17, 7
  s_add_u32 s20, s20, 584192
  s_lshl_b32 s21, 1, s19
  v_mov_b32 v248, s21
  s_mov_b64 exec, 1
  buffer_atomic_or v248, v252, s[8:11], s20 offen sc0
  s_mov_b64 exec, -1
  s_mov_b32 s38, s21
wp_f3_f:
  s_cmp_eq_u32 s97, 3
  s_cbranch_scc1 wk_adone
wp_fin:
  s_cmp_lg_u32 s97, 0
  s_cbranch_scc1 wp_all
  v_readfirstlane_b32 s20, v254
  v_readfirstlane_b32 s21, v253
  s_and_b32 s21, s21, 0xffe0
  s_cselect_b32 s96, s20, 0
  s_cmp_eq_u32 s96, 0
  s_cbranch_scc1 wp_all
  v_mov_b32 v250, 1
  s_mov_b32 s20, 588288
  s_mov_b64 exec, 1
  buffer_atomic_add v250, v252, s[8:11], s20 offen sc0
  s_mov_b64 exec, -1
wp_all:
  v_mov_b32 v252, 0x40000000
  v_cmp_eq_u32 vcc, 0, v0
  s_nop 1
  v_cndmask_b32 v252, v252, v0, vcc
  s_mov_b32 s34, 0
  s_cmp_lg_u32 s16, 0
  s_cbranch_scc1 wp_w2
  s_getreg_b32 s24, hwreg(HW_REG_XCC_ID)
  s_sub_u32 s24, s24, 1
  s_and_b32 s24, s24, 7
  s_lshl_b32 s24, s24, 7
  s_add_u32 s24, s24, 586240
  s_cmp_lg_u32 s96, 0
  s_cbranch_scc1 wp_v0
  s_waitcnt vmcnt(0)
wp_v0:
  s_cmp_eq_u32 s97, 0
  s_cbranch_scc1 wp_v1
  s_waitcnt vmcnt(0)
wp_v1:
  s_waitcnt vmcnt(1)
  v_readfirstlane_b32 s20, v248
  s_and_b32 s20, s20, 14448
  s_xor_b32 s20, s20, s38
  s_cmp_lg_u32 s20, 14448
  s_cselect_b32 s20, 0, s38
  s_mov_b32 s38, 0
  s_cmp_eq_u32 s20, 0
  s_cbranch_scc1 wp_g3
  s_lshl_b32 s21, 65536, s17
  v_mov_b32 v248, s21
  s_mov_b32 s20, 586240
  v_lshlrev_b32 v247, 7, v0
  s_mov_b64 exec, 0xff
  buffer_atomic_or v248, v247, s[8:11], s20 offen
  s_mov_b64 exec, -1
wp_g3:
  v_readfirstlane_b32 s20, v248
  s_and_b32 s20, s20, 16383
  s_xor_b32 s20, s20, s37
  s_cmp_lg_u32 s20, 16383
  s_cselect_b32 s20, 0, s37
  s_mov_b32 s37, 0
  s_cmp_eq_u32 s20, 0
  s_cbranch_scc1 wp_g2
  s_lshl_b32 s21, 1, s17
  v_mov_b32 v248, s21
  s_mov_b32 s20, 586240
  v_lshlrev_b32 v247, 7, v0
  s_mov_b64 exec, 0xff
  buffer_atomic_or v248, v247, s[8:11], s20 offen
  s_mov_b64 exec, -1
wp_g2:
  s_cmp_lg_u32 s96, 0
  s_cbranch_scc1 wp_v_ok
  s_mov_b32 s30, 0
wp_v:
  buffer_load_dwordx2 v[64:65], off, s[12:15], 0 sc1
  buffer_load_dword v66, off, s[12:15], 0 offset:128 sc1
  s_waitcnt vmcnt(0)
  v_and_b32 v68, 0xffe0, v64
  v_min_u32 v68, v68, v66
  v_cmp_ne_u32 vcc, 1, v68
  s_cbranch_vccz wp_v_ok
  s_sleep 16
  s_add_u32 s30, s30, 1
  s_cmp_lt_u32 s30, 30
  s_cbranch_scc1 wp_v
  s_branch wp_w1
wp_v_ok:
  v_mov_b32 v64, 32
  s_cmp_eq_u32 s97, 2
  s_cselect_b32 s31, 1, 60
  s_cmp_eq_u32 s39, -1
  s_cselect_b32 s20, 4, 0
  s_add_u32 s24, s24, s20
  s_mov_b32 s30, 0
wp_w:
  buffer_load_dword v66, off, s[8:11], s24 sc1
  buffer_load_dword v67, off, s[8:11], s24 offset:4 sc1
  s_waitcnt vmcnt(0)
  v_or_b32 v66, s39, v66
  v_add_u32 v66, v66, v67
  v_cmp_ne_u32 vcc, 0, v66
  s_cbranch_vccz wp_w_ok
  s_sleep 8
  s_add_u32 s30, s30, 1
  s_cmp_lt_u32 s30, s31
  s_cbranch_scc1 wp_w
  s_branch wp_w1
wp_w_ok:
  s_branch wp_w2
wp_w1:
  v_readfirstlane_b32 s20, v64
  v_readfirstlane_b32 s21, v65
  s_and_b32 s20, s20, 0xffff
  s_cmp_lt_u32 s20, 32
  s_cselect_b32 s34, 2, 1
  s_add_u32 s32, s32, 1
  s_cmp_lt_u32 s32, 4000
  s_cselect_b32 s34, s34, 3
wp_w2:
  v_mov_b32 v6, 160032
  v_mov_b32 v7, s34
  s_barrier
  s_cmp_lg_u32 s16, 0
  s_cbranch_scc1 uni_7
  ds_write_b32 v6, v7
  s_waitcnt lgkmcnt(0)
uni_7:
  s_barrier
  ds_read_b32 v7, v6
  s_waitcnt lgkmcnt(0)
  v_readfirstlane_b32 s34, v7
  s_cmp_lg_u32 s34, 0
  s_cbranch_scc1 wp_bad
  s_cmp_lg_u32 s39, -1
  s_cbranch_scc1 wp_done
  s_mov_b32 s101, 0
  s_lshl_b32 s20, s101, 4
  s_lshr_b32 s21, s2, 3
  s_add_u32 s21, s21, s16
  s_and_b32 s21, s21, 3
  s_lshl_b32 s21, s21, 2
  s_add_u32 s20, s20, s21
  s_mul_i32 s21, s20, 14336
  s_add_u32 s21, s21, 655360
  s_add_u32 s22, s21, 0
  buffer_load_dwordx4 a[0:3], v2, s[8:11], s22 offen offset:0 sc1
  buffer_load_dwordx4 a[4:7], v2, s[8:11], s22 offen offset:1024 sc1
  buffer_load_dwordx4 a[8:11], v2, s[8:11], s22 offen offset:2048 sc1
  buffer_load_dwordx4 a[12:15], v2, s[8:11], s22 offen offset:3072 sc1
  s_add_u32 s22, s21, 4096
  buffer_load_dwordx4 a[16:19], v2, s[8:11], s22 offen offset:0 sc1
  buffer_load_dwordx4 a[20:23], v2, s[8:11], s22 offen offset:1024 sc1
  buffer_load_dwordx4 a[24:27], v2, s[8:11], s22 offen offset:2048 sc1
  buffer_load_dwordx4 a[28:31], v2, s[8:11], s22 offen offset:3072 sc1
  s_add_u32 s22, s21, 8192
  buffer_load_dwordx4 a[32:35], v2, s[8:11], s22 offen offset:0 sc1
  buffer_load_dwordx4 a[36:39], v2, s[8:11], s22 offen offset:1024 sc1
  buffer_load_dwordx4 a[40:43], v2, s[8:11], s22 offen offset:2048 sc1
  buffer_load_dwordx4 a[44:47], v2, s[8:11], s22 offen offset:3072 sc1
  s_add_u32 s22, s21, 12288
  buffer_load_dwordx4 a[48:51], v2, s[8:11], s22 offen offset:0 sc1
  buffer_load_dwordx4 a[52:55], v2, s[8:11], s22 offen offset:1024 sc1
  buffer_load_dwordx4 a[56:59], v2, s[8:11], s22 offen offset:2048 sc1
  buffer_load_dwordx4 a[60:63], v2, s[8:11], s22 offen offset:3072 sc1
  s_add_u32 s22, s21, 16384
  buffer_load_dwordx4 a[64:67], v2, s[8:11], s22 offen offset:0 sc1
  buffer_load_dwordx4 a[68:71], v2, s[8:11], s22 offen offset:1024 sc1
  buffer_load_dwordx4 a[72:75], v2, s[8:11], s22 offen offset:2048 sc1
  buffer_load_dwordx4 a[76:79], v2, s[8:11], s22 offen offset:3072 sc1
  s_add_u32 s22, s21, 20480
  buffer_load_dwordx4 a[80:83], v2, s[8:11], s22 offen offset:0 sc1
  buffer_load_dwordx4 a[84:87], v2, s[8:11], s22 offen offset:1024 sc1
  buffer_load_dwordx4 a[88:91], v2, s[8:11], s22 offen offset:2048 sc1
  buffer_load_dwordx4 a[92:95], v2, s[8:11], s22 offen offset:3072 sc1
  s_add_u32 s22, s21, 24576
  buffer_load_dwordx4 a[96:99], v2, s[8:11], s22 offen offset:0 sc1
  buffer_load_dwordx4 a[100:103], v2, s[8:11], s22 offen offset:1024 sc1
  buffer_load_dwordx4 a[104:107], v2, s[8:11], s22 offen offset:2048 sc1
  buffer_load_dwordx4 a[108:111], v2, s[8:11], s22 offen offset:3072 sc1
  s_add_u32 s22, s21, 28672
  buffer_load_dwordx4 a[112:115], v2, s[8:11], s22 offen offset:0 sc1
  buffer_load_dwordx4 a[116:119], v2, s[8:11], s22 offen offset:1024 sc1
  buffer_load_dwordx4 a[120:123], v2, s[8:11], s22 offen offset:2048 sc1
  buffer_load_dwordx4 a[124:127], v2, s[8:11], s22 offen offset:3072 sc1
  s_add_u32 s22, s21, 32768
  buffer_load_dwordx4 a[128:131], v2, s[8:11], s22 offen offset:0 sc1
  buffer_load_dwordx4 a[132:135], v2, s[8:11], s22 offen offset:1024 sc1
  buffer_load_dwordx4 a[136:139], v2, s[8:11], s22 offen offset:2048 sc1
  buffer_load_dwordx4 a[140:143], v2, s[8:11], s22 offen offset:3072 sc1
  s_add_u32 s22, s21, 36864
  buffer_load_dwordx4 a[144:147], v2, s[8:11], s22 offen offset:0 sc1
  buffer_load_dwordx4 a[148:151], v2, s[8:11], s22 offen offset:1024 sc1
  buffer_load_dwordx4 a[152:155], v2, s[8:11], s22 offen offset:2048 sc1
  buffer_load_dwordx4 a[156:159], v2, s[8:11], s22 offen offset:3072 sc1
  s_add_u32 s22, s21, 40960
  s_waitcnt vmcnt(40)
  buffer_load_dwordx4 a[160:163], v2, s[8:11], s22 offen offset:0 sc1
  buffer_load_dwordx4 a[164:167], v2, s[8:11], s22 offen offset:1024 sc1
  buffer_load_dwordx4 a[168:171], v2, s[8:11], s22 offen offset:2048 sc1
  buffer_load_dwordx4 a[172:175], v2, s[8:11], s22 offen offset:3072 sc1
  s_add_u32 s22, s21, 45056
  buffer_load_dwordx4 a[176:179], v2, s[8:11], s22 offen offset:0 sc1
  buffer_load_dwordx4 a[180:183], v2, s[8:11], s22 offen offset:1024 sc1
  buffer_load_dwordx4 a[184:187], v2, s[8:11], s22 offen offset:2048 sc1
  buffer_load_dwordx4 a[188:191], v2, s[8:11], s22 offen offset:3072 sc1
  s_add_u32 s22, s21, 49152
  buffer_load_dwordx4 a[192:195], v2, s[8:11], s22 offen offset:0 sc1
  buffer_load_dwordx4 a[196:199], v2, s[8:11], s22 offen offset:1024 sc1
  buffer_load_dwordx4 a[200:203], v2, s[8:11], s22 offen offset:2048 sc1
  buffer_load_dwordx4 a[204:207], v2, s[8:11], s22 offen offset:3072 sc1
  s_add_u32 s22, s21, 53248
  buffer_load_dwordx4 a[208:211], v2, s[8:11], s22 offen offset:0 sc1
  buffer_load_dwordx4 a[212:215], v2, s[8:11], s22 offen offset:1024 sc1
  buffer_load_dwordx4 a[216:219], v2, s[8:11], s22 offen offset:2048 sc1
  buffer_load_dwordx4 a[220:223], v2, s[8:11], s22 offen offset:3072 sc1
  s_mov_b32 s39, 0xffff0000
  s_branch wp_all
wp_bad:
  s_and_b32 s39, s39, 0xffff0000
  s_mov_b32 s97, 1
  s_cmp_eq_u32 s34, 1
  s_cbranch_scc1 wp_rep
  s_cmp_eq_u32 s34, 3
  s_cbranch_scc1 cA_abort
  s_load_dwordx8 s[40:47], s[0:1], 72
  s_load_dwordx4 s[48:51], s[0:1], 56
  s_waitcnt lgkmcnt(0)
  v_mov_b32 v4, 0x10001
  s_mov_b32 s18, 1
  s_branch ch_take
wp_rep:
  s_mov_b32 s101, -1
  s_load_dwordx8 s[40:47], s[0:1], 72
  s_load_dwordx4 s[48:51], s[0:1], 56
  s_waitcnt vmcnt(0) lgkmcnt(0)
  v_mov_b32 v4, 1
  v_mov_b32 v5, 20
  v_mov_b32 v6, 160000
  s_barrier
  s_cmp_lg_u32 s16, 0
  s_cbranch_scc1 wp_el1
  s_mov_b64 exec, 1
  buffer_atomic_add v4, v5, s[12:15], 0 offen sc0
  s_waitcnt vmcnt(0)
  ds_write_b32 v6, v4
  s_waitcnt lgkmcnt(0)
  s_mov_b64 exec, -1
wp_el1:
  s_barrier
  ds_read_b32 v4, v6
  s_waitcnt lgkmcnt(0)
  v_readfirstlane_b32 s33, v4
  v_and_b32 v1, 63, v0
  v_lshlrev_b32 v2, 4, v1
  v_lshrrev_b32 v3, 4, v1
  v_and_b32 v4, 15, v1
  v_lshrrev_b32 v5, 5, v1
  v_and_b32 v6, 31, v1
  v_xor_b32 v8, v6, v5
  v_lshlrev_b32 v8, 4, v8
  v_lshl_add_u32 v16, v5, 13, v8
  v_xor_b32 v17, 32, v16
  v_xor_b32 v18, 64, v16
  v_xor_b32 v19, 96, v16
  v_xor_b32 v20, 128, v16
  v_xor_b32 v21, 160, v16
  v_xor_b32 v22, 192, v16
  v_xor_b32 v23, 224, v16
  s_lshl_b32 s20, s16, 6
  v_xor_b32 v26, s20, v16
  v_xor_b32 v27, 32, v26
  s_and_b32 s33, s33, 511
  s_and_b32 s20, s33, 255
  s_cmp_ge_u32 s20, 224
  s_cselect_b32 s97, 1, 2
  s_cbranch_scc1 wp_all
  s_mul_i32 s17, s20, 4682
  s_lshr_b32 s17, s17, 16
  s_mul_i32 s23, s17, 14
  s_sub_u32 s19, s20, s23
  s_cmp_lt_u32 s19, 7
  s_cselect_b32 s18, 0, 7
  s_cselect_b32 s28, 0, 8
  s_sub_u32 s18, s19, s18
  s_add_u32 s28, s28, s16
  s_lshl_b32 s25, s16, 15
  s_add_u32 s25, s25, 32768
  s_lshl_b32 s26, s17, 9
  s_lshl_b32 s20, s17, 7
  s_lshr_b32 s21, s33, 8
  s_lshl_b32 s21, s21, 11
  s_add_u32 s20, s20, s21
  s_add_u32 s20, s20, 582144
  buffer_load_dword v5, off, s[8:11], s20 sc1
  s_waitcnt vmcnt(0)
  v_readfirstlane_b32 s34, v5
  v_mov_b32 v6, 160032
  s_nop 0
  v_mov_b32 v7, s34
  s_barrier
  s_cmp_lg_u32 s16, 0
  s_cbranch_scc1 uni_8
  ds_write_b32 v6, v7
  s_waitcnt lgkmcnt(0)
uni_8:
  s_barrier
  ds_read_b32 v7, v6
  s_waitcnt lgkmcnt(0)
  v_readfirstlane_b32 s34, v7
  s_cmp_lt_u32 s33, 256
  s_cselect_b32 s20, 0, 1935
  s_or_b32 s34, s34, s20
  s_bitcmp1_b32 s34, s19
  s_cbranch_scc1 wp_rep
  s_barrier
  s_cmp_lt_u32 s33, 256
  s_cbranch_scc1 wp_B
  s_branch wp_A0
wp_done:
  s_mov_b32 s97, s39
  s_cmp_lg_u32 s96, 0
  s_cbranch_scc1 wk_next
  s_cmp_lg_u32 s16, 0
  s_cbranch_scc1 ask_9
  v_mov_b32 v250, 1
  v_mov_b32 v251, 588288
  s_mov_b64 exec, 1
  buffer_atomic_add v250, v251, s[8:11], 0 offen sc0
  s_mov_b64 exec, -1
ask_9:
  s_branch wk_next
wk_loop:
  s_waitcnt vmcnt(0) lgkmcnt(0)
  s_getreg_b32 s22, hwreg(HW_REG_XCC_ID)
  s_and_b32 s22, s22, 15
  s_cmp_lg_u32 s22, 0
  s_cbranch_scc1 wk_ask
  s_cmp_eq_u32 s96, 7
  s_cbranch_scc0 wk_srv
wk_ask:
  v_readfirstlane_b32 s22, v250
  s_cmp_ge_u32 s22, 1264
  s_cbranch_scc1 wk_next
  s_cmp_lg_u32 s16, 0
  s_cbranch_scc1 ask_10
  v_mov_b32 v250, 1
  v_mov_b32 v251, 588288
  s_mov_b64 exec, 1
  buffer_atomic_add v250, v251, s[8:11], 0 offen sc0
  s_mov_b64 exec, -1
ask_10:
wk_next:
  v_mov_b32 v6, 160000
  s_waitcnt vmcnt(0)
  s_barrier
  s_cmp_lg_u32 s16, 0
  s_cbranch_scc1 wk_n1
  s_mov_b64 exec, 1
  ds_write_b32 v6, v250
  s_mov_b64 exec, -1
  s_waitcnt lgkmcnt(0)
wk_n1:
  s_barrier
  ds_read_b32 v4, v6
  s_waitcnt lgkmcnt(0)
  v_readfirstlane_b32 s3, v4
  s_cmp_ge_u32 s3, 1264
  s_cbranch_scc1 wk_done
  v_mov_b32 v250, 0
  v_mov_b32 v251, 588288
  v_and_b32 v1, 63, v0
  v_lshlrev_b32 v2, 4, v1
  v_lshrrev_b32 v3, 4, v1
  v_and_b32 v4, 15, v1
  s_cmp_lt_u32 s3, 112
  s_cbranch_scc1 wk_n2
  s_cmp_eq_u32 s97, 0
  s_cbranch_scc1 wk_n2
  v_mov_b32 v250, s3
  s_mov_b32 s96, 1
  s_mov_b32 s97, 1
  s_mov_b32 s39, 0
  s_mov_b32 s37, 0
  s_mov_b32 s38, 0
  s_mov_b32 s32, 0
  s_branch wp_all
wk_n2:
  s_sub_u32 s20, s3, 288
  s_cmp_ge_u32 s20, 352
  s_cbranch_scc1 wk_nr
  s_cmp_ge_u32 s20, 320
  s_cbranch_scc1 wk_srv
  s_add_u32 s3, s3, 32
wk_nr:
  s_cmp_ge_u32 s3, 752
  s_cbranch_scc1 wk_tok
  s_cmp_ge_u32 s3, 640
  s_cbranch_scc1 wk_s4d
  s_cmp_ge_u32 s3, 448
  s_cbranch_scc1 wk_full
  s_cmp_ge_u32 s3, 320
  s_cbranch_scc1 wk_adef
  s_cmp_ge_u32 s3, 288
  s_cbranch_scc1 wk_srv
  s_and_b32 s17, s3, 15
  s_add_u32 s17, s17, 16
  s_cmp_ge_u32 s3, 224
  s_cbranch_scc1 wk_half
  s_cmp_ge_u32 s3, 112
  s_cselect_b32 s18, 1, 0
  s_cselect_b32 s20, 112, 0
  s_sub_u32 s34, s3, s20
  s_lshr_b32 s34, s34, 4
  s_lshl_b32 s34, s34, 1
  s_add_u32 s35, s34, 2
  s_branch wk_gemm
wk_adef:
  s_mov_b32 s101, -1
  s_load_dwordx8 s[40:47], s[0:1], 72
  s_sub_u32 s20, s3, 320
  s_getreg_b32 s33, hwreg(HW_REG_XCC_ID)
  s_sub_u32 s33, s33, 2
  s_and_b32 s33, s33, 7
  s_min_u32 s33, s33, 7
  s_mov_b32 s35, 7
wk_adc:
  s_lshl_b32 s34, s33, 7
  s_add_u32 s34, s34, 589312
  v_mov_b32 v4, 1
  v_mov_b32 v5, s34
  v_mov_b32 v6, 160000
  s_barrier
  s_cmp_lg_u32 s16, 0
  s_cbranch_scc1 wk_ade1
  s_mov_b64 exec, 1
  buffer_atomic_add v4, v5, s[8:11], 0 offen sc0
  s_waitcnt vmcnt(0)
  ds_write_b32 v6, v4
  s_waitcnt lgkmcnt(0)
  s_mov_b64 exec, -1
wk_ade1:
  s_barrier
  ds_read_b32 v4, v6
  s_waitcnt lgkmcnt(0)
  v_readfirstlane_b32 s20, v4
  s_cmp_lt_u32 s20, 16
  s_cbranch_scc1 wk_adg
  s_mov_b32 s33, s35
  s_sub_u32 s35, s35, 1
  s_max_i32 s35, s35, 0
  s_branch wk_adc
wk_adg:
  s_lshl_b32 s33, s33, 4
  s_add_u32 s20, s20, s33
  v_and_b32 v1, 63, v0
  v_lshlrev_b32 v2, 4, v1
  v_lshrrev_b32 v3, 4, v1
  v_and_b32 v4, 15, v1
  s_lshr_b32 s33, s20, 2
  s_mul_i32 s33, s33, 7
  s_and_b32 s20, s20, 3
  s_add_u32 s33, s33, s20
  s_mov_b32 s97, 3
  v_mov_b32 v252, 0x40000000
  v_cmp_eq_u32 vcc, 0, v0
  s_nop 1
  v_cndmask_b32 v252, v252, v0, vcc
  v_lshrrev_b32 v5, 5, v1
  v_and_b32 v6, 31, v1
  v_xor_b32 v8, v6, v5
  v_lshlrev_b32 v8, 4, v8
  v_lshl_add_u32 v16, v5, 13, v8
  v_xor_b32 v17, 32, v16
  v_xor_b32 v18, 64, v16
  v_xor_b32 v19, 96, v16
  v_xor_b32 v20, 128, v16
  v_xor_b32 v21, 160, v16
  v_xor_b32 v22, 192, v16
  v_xor_b32 v23, 224, v16
  s_lshl_b32 s20, s16, 6
  v_xor_b32 v26, s20, v16
  v_xor_b32 v27, 32, v26
  s_mul_i32 s17, s33, 4682
  s_lshr_b32 s17, s17, 16
  s_mul_i32 s23, s17, 14
  s_sub_u32 s19, s33, s23
  s_cmp_lt_u32 s19, 7
  s_cselect_b32 s18, 0, 7
  s_cselect_b32 s28, 0, 8
  s_sub_u32 s18, s19, s18
  s_add_u32 s28, s28, s16
  s_lshl_b32 s25, s16, 15
  s_add_u32 s25, s25, 32768
  s_lshl_b32 s26, s17, 9
  s_waitcnt lgkmcnt(0)
  s_barrier
  s_branch wp_A0
wk_adone:
  s_mov_b32 s97, 0
  s_branch wk_loop
wk_half:
  s_sub_u32 s20, s3, 224
  s_lshr_b32 s18, s20, 5
  s_add_u32 s18, s18, 2
  s_bitcmp1_b32 s20, 4
  s_cselect_b32 s34, 7, 0
  s_add_u32 s35, s34, 7
  s_branch wk_gemm
wk_full:
  s_sub_u32 s20, s3, 384
  s_and_b32 s17, s20, 15
  s_lshr_b32 s18, s20, 4
  s_mov_b32 s34, 0
  s_mov_b32 s35, 14
  s_cmp_lt_u32 s18, 8
  s_cselect_b32 s21, 16, 0
  s_add_u32 s17, s17, s21
  s_and_b32 s18, s18, 7
  s_cmp_ge_u32 s17, 16
  s_cbranch_scc1 wk_gemm
  s_load_dwordx8 s[40:47], s[0:1], 0
  s_load_dwordx2 s[48:49], s[0:1], 32
  s_sub_u32 s21, s3, 512
  v_min_u32 v12, 111, v0
  v_lshlrev_b32 v12, 7, v12
  v_min_u32 v13, 13, v0
  v_lshlrev_b32 v13, 7, v13
  s_mul_i32 s22, s21, 14336
  s_mul_i32 s21, s21, 1792
  s_waitcnt lgkmcnt(0)
  s_cmp_ge_u32 s16, 2
  s_cbranch_scc1 wk_up
  s_mov_b32 s60, s40
  s_and_b32 s61, s41, 0xffff
  s_mov_b32 s62, 1835008
  s_mov_b32 s63, 0x20000
  buffer_load_dword v14, v12, s[60:63], s22 offen
  s_mov_b32 s60, s42
  s_and_b32 s61, s43, 0xffff
  s_mov_b32 s62, 229376
  s_mov_b32 s63, 0x20000
  buffer_load_dword v14, v13, s[60:63], s21 offen
  s_mov_b32 s60, s44
  s_and_b32 s61, s45, 0xffff
  s_mov_b32 s62, 229376
  s_mov_b32 s63, 0x20000
  buffer_load_dword v14, v13, s[60:63], s21 offen
  s_mov_b32 s60, s46
  s_and_b32 s61, s47, 0xffff
  s_mov_b32 s62, 229376
  s_mov_b32 s63, 0x20000
  buffer_load_dword v14, v13, s[60:63], s21 offen
  s_mov_b32 s60, s48
  s_and_b32 s61, s49, 0xffff
  s_mov_b32 s62, 229376
  s_mov_b32 s63, 0x20000
  buffer_load_dword v14, v13, s[60:63], s21 offen
wk_up:
  s_lshl_b32 s27, s17, 7
  s_add_u32 s27, s27, 584192
  s_mov_b32 s28, 16383
  s_mov_b32 s30, 0
wk_aw:
  buffer_load_dword v9, off, s[8:11], s27  sc1
  s_waitcnt vmcnt(0)
  v_and_b32 v10, s28, v9
  v_cmp_ne_u32 vcc, s28, v10
  s_cbranch_vccz wk_aw_ok
  s_sleep 3
  s_add_u32 s30, s30, 1
  s_cmp_lt_u32 s30, 400000
  s_cbranch_scc1 wk_aw
  s_branch cA_abort
wk_aw_ok:
wk_gemm:
  s_lshl_b32 s20, s18, 4
  s_lshr_b32 s21, s2, 3
  s_add_u32 s21, s21, s16
  s_and_b32 s21, s21, 3
  s_lshl_b32 s21, s21, 2
  s_add_u32 s20, s20, s21
  s_mul_i32 s21, s20, 14336
  s_add_u32 s21, s21, 655360
  s_mul_i32 s23, s17, 401408
  s_and_b32 s22, s16, 1
  s_mul_i32 s22, s22, 7168
  s_add_u32 s23, s23, s22
  s_add_u32 s23, s23, 33554432
  s_lshr_b32 s22, s16, 1
  s_mul_i32 s22, s22, 14336
  s_add_u32 s23, s23, s22
  s_mul_i32 s27, s16, 7168
  s_lshr_b32 s28, s20, 1
  s_cmp_lt_u32 s17, 16
  s_cbranch_scc0 wg_vo
  s_add_u32 s23, s23, s22
  s_lshl_b32 s29, s28, 4
  s_add_u32 s29, s29, s17
  s_mul_i32 s29, s29, 28672
  s_add_u32 s29, s29, 46399488
  s_mov_b32 s31, 0
  s_lshr_b32 s24, s34, 1
  s_lshl_b32 s24, s24, 2
  s_and_b32 s25, s34, 1
  s_add_u32 s24, s24, s25
  s_mul_i32 s24, s24, 14336
  s_add_u32 s24, s24, s23
  s_add_u32 m0, s31, s27
  s_nop 0
  buffer_load_dwordx4 v2, s[8:11], s24 offen offset:0 sc1 lds
  buffer_load_dwordx4 v2, s[8:11], s24 offen offset:1024 sc1 lds
  buffer_load_dwordx4 v2, s[8:11], s24 offen offset:2048 sc1 lds
  buffer_load_dwordx4 v2, s[8:11], s24 offen offset:3072 sc1 lds
  s_add_u32 m0, m0, 4096
  s_add_u32 s24, s24, 4096
  buffer_load_dwordx4 v2, s[8:11], s24 offen offset:0 sc1 lds
  buffer_load_dwordx4 v2, s[8:11], s24 offen offset:1024 sc1 lds
  buffer_load_dwordx4 v2, s[8:11], s24 offen offset:2048 sc1 lds
  s_sub_u32 s36, s35, 1
  s_add_u32 s30, s34, 1
  s_min_u32 s30, s30, s36
  s_mov_b32 s31, 28672
  s_lshr_b32 s24, s30, 1
  s_lshl_b32 s24, s24, 2
  s_and_b32 s25, s30, 1
  s_add_u32 s24, s24, s25
  s_mul_i32 s24, s24, 14336
  s_add_u32 s24, s24, s23
  s_add_u32 m0, s31, s27
  s_nop 0
  buffer_load_dwordx4 v2, s[8:11], s24 offen offset:0 sc1 lds
  buffer_load_dwordx4 v2, s[8:11], s24 offen offset:1024 sc1 lds
  buffer_load_dwordx4 v2, s[8:11], s24 offen offset:2048 sc1 lds
  buffer_load_dwordx4 v2, s[8:11], s24 offen offset:3072 sc1 lds
  s_add_u32 m0, m0, 4096
  s_add_u32 s24, s24, 4096
  buffer_load_dwordx4 v2, s[8:11], s24 offen offset:0 sc1 lds
  buffer_load_dwordx4 v2, s[8:11], s24 offen offset:1024 sc1 lds
  buffer_load_dwordx4 v2, s[8:11], s24 offen offset:2048 sc1 lds
  s_mov_b32 s19, s34
  s_mov_b32 s32, 0
  s_mov_b32 s33, 57344
  s_cmp_eq_u32 s18, s101
  s_cbranch_scc1 wg_f_hx
  s_add_u32 s22, s21, 0
  buffer_load_dwordx4 a[0:3], v2, s[8:11], s22 offen offset:0 sc1
  buffer_load_dwordx4 a[4:7], v2, s[8:11], s22 offen offset:1024 sc1
  buffer_load_dwordx4 a[8:11], v2, s[8:11], s22 offen offset:2048 sc1
  buffer_load_dwordx4 a[12:15], v2, s[8:11], s22 offen offset:3072 sc1
  s_add_u32 s22, s21, 4096
  buffer_load_dwordx4 a[16:19], v2, s[8:11], s22 offen offset:0 sc1
  buffer_load_dwordx4 a[20:23], v2, s[8:11], s22 offen offset:1024 sc1
  buffer_load_dwordx4 a[24:27], v2, s[8:11], s22 offen offset:2048 sc1
  buffer_load_dwordx4 a[28:31], v2, s[8:11], s22 offen offset:3072 sc1
  s_add_u32 s22, s21, 8192
  buffer_load_dwordx4 a[32:35], v2, s[8:11], s22 offen offset:0 sc1
  buffer_load_dwordx4 a[36:39], v2, s[8:11], s22 offen offset:1024 sc1
  buffer_load_dwordx4 a[40:43], v2, s[8:11], s22 offen offset:2048 sc1
  buffer_load_dwordx4 a[44:47], v2, s[8:11], s22 offen offset:3072 sc1
  s_add_u32 s22, s21, 12288
  buffer_load_dwordx4 a[48:51], v2, s[8:11], s22 offen offset:0 sc1
  buffer_load_dwordx4 a[52:55], v2, s[8:11], s22 offen offset:1024 sc1
  buffer_load_dwordx4 a[56:59], v2, s[8:11], s22 offen offset:2048 sc1
  buffer_load_dwordx4 a[60:63], v2, s[8:11], s22 offen offset:3072 sc1
  s_add_u32 s22, s21, 16384
  buffer_load_dwordx4 a[64:67], v2, s[8:11], s22 offen offset:0 sc1
  buffer_load_dwordx4 a[68:71], v2, s[8:11], s22 offen offset:1024 sc1
  buffer_load_dwordx4 a[72:75], v2, s[8:11], s22 offen offset:2048 sc1
  buffer_load_dwordx4 a[76:79], v2, s[8:11], s22 offen offset:3072 sc1
  s_add_u32 s22, s21, 20480
  buffer_load_dwordx4 a[80:83], v2, s[8:11], s22 offen offset:0 sc1
  buffer_load_dwordx4 a[84:87], v2, s[8:11], s22 offen offset:1024 sc1
  buffer_load_dwordx4 a[88:91], v2, s[8:11], s22 offen offset:2048 sc1
  buffer_load_dwordx4 a[92:95], v2, s[8:11], s22 offen offset:3072 sc1
  s_add_u32 s22, s21, 24576
  buffer_load_dwordx4 a[96:99], v2, s[8:11], s22 offen offset:0 sc1
  buffer_load_dwordx4 a[100:103], v2, s[8:11], s22 offen offset:1024 sc1
  buffer_load_dwordx4 a[104:107], v2, s[8:11], s22 offen offset:2048 sc1
  buffer_load_dwordx4 a[108:111], v2, s[8:11], s22 offen offset:3072 sc1
  s_add_u32 s22, s21, 28672
  buffer_load_dwordx4 a[112:115], v2, s[8:11], s22 offen offset:0 sc1
  buffer_load_dwordx4 a[116:119], v2, s[8:11], s22 offen offset:1024 sc1
  buffer_load_dwordx4 a[120:123], v2, s[8:11], s22 offen offset:2048 sc1
  buffer_load_dwordx4 a[124:127], v2, s[8:11], s22 offen offset:3072 sc1
  s_add_u32 s22, s21, 32768
  buffer_load_dwordx4 a[128:131], v2, s[8:11], s22 offen offset:0 sc1
  buffer_load_dwordx4 a[132:135], v2, s[8:11], s22 offen offset:1024 sc1
  buffer_load_dwordx4 a[136:139], v2, s[8:11], s22 offen offset:2048 sc1
  buffer_load_dwordx4 a[140:143], v2, s[8:11], s22 offen offset:3072 sc1
  s_add_u32 s22, s21, 36864
  buffer_load_dwordx4 a[144:147], v2, s[8:11], s22 offen offset:0 sc1
  buffer_load_dwordx4 a[148:151], v2, s[8:11], s22 offen offset:1024 sc1
  buffer_load_dwordx4 a[152:155], v2, s[8:11], s22 offen offset:2048 sc1
  buffer_load_dwordx4 a[156:159], v2, s[8:11], s22 offen offset:3072 sc1
  s_add_u32 s22, s21, 40960
  s_waitcnt vmcnt(40)
  buffer_load_dwordx4 a[160:163], v2, s[8:11], s22 offen offset:0 sc1
  buffer_load_dwordx4 a[164:167], v2, s[8:11], s22 offen offset:1024 sc1
  buffer_load_dwordx4 a[168:171], v2, s[8:11], s22 offen offset:2048 sc1
  buffer_load_dwordx4 a[172:175], v2, s[8:11], s22 offen offset:3072 sc1
  s_add_u32 s22, s21, 45056
  buffer_load_dwordx4 a[176:179], v2, s[8:11], s22 offen offset:0 sc1
  buffer_load_dwordx4 a[180:183], v2, s[8:11], s22 offen offset:1024 sc1
  buffer_load_dwordx4 a[184:187], v2, s[8:11], s22 offen offset:2048 sc1
  buffer_load_dwordx4 a[188:191], v2, s[8:11], s22 offen offset:3072 sc1
  s_add_u32 s22, s21, 49152
  buffer_load_dwordx4 a[192:195], v2, s[8:11], s22 offen offset:0 sc1
  buffer_load_dwordx4 a[196:199], v2, s[8:11], s22 offen offset:1024 sc1
  buffer_load_dwordx4 a[200:203], v2, s[8:11], s22 offen offset:2048 sc1
  buffer_load_dwordx4 a[204:207], v2, s[8:11], s22 offen offset:3072 sc1
  s_add_u32 s22, s21, 53248
  buffer_load_dwordx4 a[208:211], v2, s[8:11], s22 offen offset:0 sc1
  buffer_load_dwordx4 a[212:215], v2, s[8:11], s22 offen offset:1024 sc1
  buffer_load_dwordx4 a[216:219], v2, s[8:11], s22 offen offset:2048 sc1
  buffer_load_dwordx4 a[220:223], v2, s[8:11], s22 offen offset:3072 sc1
wg_f_hx:
  s_mov_b32 s101, -1
  s_waitcnt vmcnt(0)
  s_barrier
  s_mov_b32 s40, 0
  s_mov_b32 s41, 0x40000000
  v_mov_b32 v5, v2
  ds_read_b128 v[8:11], v5 offset:0
  ds_read_b128 v[12:15], v5 offset:14336
  ds_read_b128 v[16:19], v5 offset:1024
  ds_read_b128 v[20:23], v5 offset:15360
  ds_read_b128 v[24:27], v5 offset:2048
  s_waitcnt lgkmcnt(4)
.p2align 6
wg_f_loop:
  v_mfma_f32_16x16x32_bf16 v[40:43], v[8:11], a[0:3], 0
  ds_read_b128 v[28:31], v5 offset:16384
  v_mfma_f32_16x16x32_bf16 v[44:47], v[8:11], a[56:59], 0
  v_mfma_f32_16x16x32_bf16 v[48:51], v[8:11], a[112:115], 0
  v_mfma_f32_16x16x32_bf16 v[52:55], v[8:11], a[168:171], 0
  s_waitcnt lgkmcnt(4)
  s_lshl_b32 s42, s40, 10
  v_mfma_f32_16x16x32_bf16 v[56:59], v[12:15], a[0:3], 0
  ds_read_b128 v[32:35], v5 offset:3072
  v_mfma_f32_16x16x32_bf16 v[60:63], v[12:15], a[56:59], 0
  s_add_u32 s42, s42, s41
  v_cvt_pk_bf16_f32 v72, v96, v97
  v_mfma_f32_16x16x32_bf16 v[64:67], v[12:15], a[112:115], 0
  v_cvt_pk_bf16_f32 v73, v98, v99
  v_cvt_pk_bf16_f32 v74, v112, v113
  v_mfma_f32_16x16x32_bf16 v[68:71], v[12:15], a[168:171], 0
  s_waitcnt lgkmcnt(4)
  v_cvt_pk_bf16_f32 v75, v114, v115
  v_mfma_f32_16x16x32_bf16 v[40:43], v[16:19], a[4:7], v[40:43]
  ds_read_b128 v[8:11], v5 offset:17408
  v_mfma_f32_16x16x32_bf16 v[44:47], v[16:19], a[60:63], v[44:47]
  s_add_u32 s43, s42, 0
  v_mfma_f32_16x16x32_bf16 v[48:51], v[16:19], a[116:119], v[48:51]
  buffer_store_dwordx4 v[72:75], v2, s[8:11], s43 offen sc1
  v_cvt_pk_bf16_f32 v76, v100, v101
  v_mfma_f32_16x16x32_bf16 v[52:55], v[16:19], a[172:175], v[52:55]
  s_waitcnt lgkmcnt(4)
  v_cvt_pk_bf16_f32 v77, v102, v103
  v_mfma_f32_16x16x32_bf16 v[56:59], v[20:23], a[4:7], v[56:59]
  ds_read_b128 v[12:15], v5 offset:4096
  v_mfma_f32_16x16x32_bf16 v[60:63], v[20:23], a[60:63], v[60:63]
  v_cvt_pk_bf16_f32 v78, v116, v117
  v_cvt_pk_bf16_f32 v79, v118, v119
  v_mfma_f32_16x16x32_bf16 v[64:67], v[20:23], a[116:119], v[64:67]
  s_add_u32 s43, s42, 14336
  v_mfma_f32_16x16x32_bf16 v[68:71], v[20:23], a[172:175], v[68:71]
  s_waitcnt lgkmcnt(4)
  buffer_store_dwordx4 v[76:79], v2, s[8:11], s43 offen sc1
  v_mfma_f32_16x16x32_bf16 v[40:43], v[24:27], a[8:11], v[40:43]
  ds_read_b128 v[16:19], v5 offset:18432
  v_mfma_f32_16x16x32_bf16 v[44:47], v[24:27], a[64:67], v[44:47]
  v_cvt_pk_bf16_f32 v80, v104, v105
  v_cvt_pk_bf16_f32 v81, v106, v107
  v_mfma_f32_16x16x32_bf16 v[48:51], v[24:27], a[120:123], v[48:51]
  v_cvt_pk_bf16_f32 v82, v120, v121
  v_cvt_pk_bf16_f32 v83, v122, v123
  v_mfma_f32_16x16x32_bf16 v[52:55], v[24:27], a[176:179], v[52:55]
  s_waitcnt lgkmcnt(4)
  s_add_u32 s43, s42, 458752
  v_mfma_f32_16x16x32_bf16 v[56:59], v[28:31], a[8:11], v[56:59]
  ds_read_b128 v[20:23], v5 offset:5120
  v_mfma_f32_16x16x32_bf16 v[60:63], v[28:31], a[64:67], v[60:63]
  buffer_store_dwordx4 v[80:83], v2, s[8:11], s43 offen sc1
  v_cvt_pk_bf16_f32 v84, v108, v109
  v_mfma_f32_16x16x32_bf16 v[64:67], v[28:31], a[120:123], v[64:67]
  v_cvt_pk_bf16_f32 v85, v110, v111
  v_cvt_pk_bf16_f32 v86, v124, v125
  v_mfma_f32_16x16x32_bf16 v[68:71], v[28:31], a[176:179], v[68:71]
  s_waitcnt lgkmcnt(4)
  v_cvt_pk_bf16_f32 v87, v126, v127
  v_mfma_f32_16x16x32_bf16 v[40:43], v[32:35], a[12:15], v[40:43]
  ds_read_b128 v[24:27], v5 offset:19456
  v_mfma_f32_16x16x32_bf16 v[44:47], v[32:35], a[68:71], v[44:47]
  s_add_u32 s43, s42, 473088
  v_mfma_f32_16x16x32_bf16 v[48:51], v[32:35], a[124:127], v[48:51]
  buffer_store_dwordx4 v[84:87], v2, s[8:11], s43 offen sc1
  v_mfma_f32_16x16x32_bf16 v[52:55], v[32:35], a[180:183], v[52:55]
  s_waitcnt lgkmcnt(4)
  s_add_u32 s30, s19, 2
  s_lshr_b32 s24, s30, 1
  s_lshl_b32 s24, s24, 2
  s_and_b32 s25, s30, 1
  s_add_u32 s24, s24, s25
  s_mul_i32 s24, s24, 14336
  v_mfma_f32_16x16x32_bf16 v[56:59], v[8:11], a[12:15], v[56:59]
  ds_read_b128 v[28:31], v5 offset:6144
  v_mfma_f32_16x16x32_bf16 v[60:63], v[8:11], a[68:71], v[60:63]
  s_add_u32 s24, s24, s23
  s_cmp_lt_u32 s30, s35
  s_cselect_b32 s24, s24, 0x40000000
  v_mfma_f32_16x16x32_bf16 v[64:67], v[8:11], a[124:127], v[64:67]
  s_add_u32 m0, s33, s27
  s_nop 0
  buffer_load_dwordx4 v2, s[8:11], s24 offen offset:0 sc1 lds
  v_mfma_f32_16x16x32_bf16 v[68:71], v[8:11], a[180:183], v[68:71]
  s_waitcnt lgkmcnt(4)
  v_mfma_f32_16x16x32_bf16 v[40:43], v[12:15], a[16:19], v[40:43]
  ds_read_b128 v[32:35], v5 offset:20480
  v_mfma_f32_16x16x32_bf16 v[44:47], v[12:15], a[72:75], v[44:47]
  v_mfma_f32_16x16x32_bf16 v[48:51], v[12:15], a[128:131], v[48:51]
  v_mfma_f32_16x16x32_bf16 v[52:55], v[12:15], a[184:187], v[52:55]
  s_waitcnt lgkmcnt(4)
  buffer_load_dwordx4 v2, s[8:11], s24 offen offset:1024 sc1 lds
  v_mfma_f32_16x16x32_bf16 v[56:59], v[16:19], a[16:19], v[56:59]
  ds_read_b128 v[8:11], v5 offset:7168
  v_mfma_f32_16x16x32_bf16 v[60:63], v[16:19], a[72:75], v[60:63]
  v_mfma_f32_16x16x32_bf16 v[64:67], v[16:19], a[128:131], v[64:67]
  v_mfma_f32_16x16x32_bf16 v[68:71], v[16:19], a[184:187], v[68:71]
  s_waitcnt lgkmcnt(4)
  v_mfma_f32_16x16x32_bf16 v[40:43], v[20:23], a[20:23], v[40:43]
  ds_read_b128 v[12:15], v5 offset:21504
  v_mfma_f32_16x16x32_bf16 v[44:47], v[20:23], a[76:79], v[44:47]
  buffer_load_dwordx4 v2, s[8:11], s24 offen offset:2048 sc1 lds
  v_mfma_f32_16x16x32_bf16 v[48:51], v[20:23], a[132:135], v[48:51]
  v_mfma_f32_16x16x32_bf16 v[52:55], v[20:23], a[188:191], v[52:55]
  s_waitcnt lgkmcnt(4)
  v_mfma_f32_16x16x32_bf16 v[56:59], v[24:27], a[20:23], v[56:59]
  ds_read_b128 v[16:19], v5 offset:8192
  v_mfma_f32_16x16x32_bf16 v[60:63], v[24:27], a[76:79], v[60:63]
  v_mfma_f32_16x16x32_bf16 v[64:67], v[24:27], a[132:135], v[64:67]
  buffer_load_dwordx4 v2, s[8:11], s24 offen offset:3072 sc1 lds
  v_mfma_f32_16x16x32_bf16 v[68:71], v[24:27], a[188:191], v[68:71]
  s_waitcnt lgkmcnt(4)
  v_mfma_f32_16x16x32_bf16 v[40:43], v[28:31], a[24:27], v[40:43]
  ds_read_b128 v[20:23], v5 offset:22528
  v_mfma_f32_16x16x32_bf16 v[44:47], v[28:31], a[80:83], v[44:47]
  v_mfma_f32_16x16x32_bf16 v[48:51], v[28:31], a[136:139], v[48:51]
  v_mfma_f32_16x16x32_bf16 v[52:55], v[28:31], a[192:195], v[52:55]
  s_waitcnt lgkmcnt(4)
  s_add_u32 m0, m0, 4096
  s_add_u32 s24, s24, 4096
  buffer_load_dwordx4 v2, s[8:11], s24 offen offset:0 sc1 lds
  v_mfma_f32_16x16x32_bf16 v[56:59], v[32:35], a[24:27], v[56:59]
  ds_read_b128 v[24:27], v5 offset:9216
  v_mfma_f32_16x16x32_bf16 v[60:63], v[32:35], a[80:83], v[60:63]
  v_mfma_f32_16x16x32_bf16 v[64:67], v[32:35], a[136:139], v[64:67]
  v_mfma_f32_16x16x32_bf16 v[68:71], v[32:35], a[192:195], v[68:71]
  s_waitcnt lgkmcnt(4)
  v_mfma_f32_16x16x32_bf16 v[40:43], v[8:11], a[28:31], v[40:43]
  ds_read_b128 v[28:31], v5 offset:23552
  v_mfma_f32_16x16x32_bf16 v[44:47], v[8:11], a[84:87], v[44:47]
  buffer_load_dwordx4 v2, s[8:11], s24 offen offset:1024 sc1 lds
  v_mfma_f32_16x16x32_bf16 v[48:51], v[8:11], a[140:143], v[48:51]
  v_mfma_f32_16x16x32_bf16 v[52:55], v[8:11], a[196:199], v[52:55]
  s_waitcnt lgkmcnt(4)
  v_mfma_f32_16x16x32_bf16 v[56:59], v[12:15], a[28:31], v[56:59]
  ds_read_b128 v[32:35], v5 offset:10240
  v_mfma_f32_16x16x32_bf16 v[60:63], v[12:15], a[84:87], v[60:63]
  v_mfma_f32_16x16x32_bf16 v[64:67], v[12:15], a[140:143], v[64:67]
  buffer_load_dwordx4 v2, s[8:11], s24 offen offset:2048 sc1 lds
  v_mfma_f32_16x16x32_bf16 v[68:71], v[12:15], a[196:199], v[68:71]
  s_waitcnt lgkmcnt(4)
  v_mfma_f32_16x16x32_bf16 v[40:43], v[16:19], a[32:35], v[40:43]
  ds_read_b128 v[8:11], v5 offset:24576
  v_mfma_f32_16x16x32_bf16 v[44:47], v[16:19], a[88:91], v[44:47]
  v_mfma_f32_16x16x32_bf16 v[48:51], v[16:19], a[144:147], v[48:51]
  v_mfma_f32_16x16x32_bf16 v[52:55], v[16:19], a[200:203], v[52:55]
  s_waitcnt lgkmcnt(4)
  s_add_u32 s33, s33, 28672
  s_cmp_eq_u32 s33, 114688
  s_cselect_b32 s33, 0, s33
  v_mfma_f32_16x16x32_bf16 v[56:59], v[20:23], a[32:35], v[56:59]
  ds_read_b128 v[12:15], v5 offset:11264
  v_mfma_f32_16x16x32_bf16 v[60:63], v[20:23], a[88:91], v[60:63]
  s_add_u32 s32, s32, 28672
  s_cmp_eq_u32 s32, 114688
  s_cselect_b32 s32, 0, s32
  v_mfma_f32_16x16x32_bf16 v[64:67], v[20:23], a[144:147], v[64:67]
  v_add_u32 v128, s32, v2
  v_mfma_f32_16x16x32_bf16 v[68:71], v[20:23], a[200:203], v[68:71]
  s_waitcnt lgkmcnt(4)
  v_mfma_f32_16x16x32_bf16 v[40:43], v[24:27], a[36:39], v[40:43]
  ds_read_b128 v[16:19], v5 offset:25600
  v_mfma_f32_16x16x32_bf16 v[44:47], v[24:27], a[92:95], v[44:47]
  v_mfma_f32_16x16x32_bf16 v[48:51], v[24:27], a[148:151], v[48:51]
  v_mfma_f32_16x16x32_bf16 v[52:55], v[24:27], a[204:207], v[52:55]
  s_waitcnt lgkmcnt(4)
  v_mfma_f32_16x16x32_bf16 v[56:59], v[28:31], a[36:39], v[56:59]
  ds_read_b128 v[20:23], v5 offset:12288
  v_mfma_f32_16x16x32_bf16 v[60:63], v[28:31], a[92:95], v[60:63]
  v_mfma_f32_16x16x32_bf16 v[64:67], v[28:31], a[148:151], v[64:67]
  v_mfma_f32_16x16x32_bf16 v[68:71], v[28:31], a[204:207], v[68:71]
  s_waitcnt lgkmcnt(4)
  v_mfma_f32_16x16x32_bf16 v[40:43], v[32:35], a[40:43], v[40:43]
  ds_read_b128 v[24:27], v5 offset:26624
  v_mfma_f32_16x16x32_bf16 v[44:47], v[32:35], a[96:99], v[44:47]
  v_mfma_f32_16x16x32_bf16 v[48:51], v[32:35], a[152:155], v[48:51]
  v_mfma_f32_16x16x32_bf16 v[52:55], v[32:35], a[208:211], v[52:55]
  s_waitcnt lgkmcnt(4)
  v_mfma_f32_16x16x32_bf16 v[56:59], v[8:11], a[40:43], v[56:59]
  ds_read_b128 v[28:31], v5 offset:13312
  v_mfma_f32_16x16x32_bf16 v[60:63], v[8:11], a[96:99], v[60:63]
  v_mfma_f32_16x16x32_bf16 v[64:67], v[8:11], a[152:155], v[64:67]
  v_mfma_f32_16x16x32_bf16 v[68:71], v[8:11], a[208:211], v[68:71]
  s_waitcnt lgkmcnt(4)
  v_mfma_f32_16x16x32_bf16 v[40:43], v[12:15], a[44:47], v[40:43]
  ds_read_b128 v[32:35], v5 offset:27648
  v_mfma_f32_16x16x32_bf16 v[44:47], v[12:15], a[100:103], v[44:47]
  v_mfma_f32_16x16x32_bf16 v[48:51], v[12:15], a[156:159], v[48:51]
  v_mfma_f32_16x16x32_bf16 v[52:55], v[12:15], a[212:215], v[52:55]
  s_waitcnt lgkmcnt(4)
  v_mfma_f32_16x16x32_bf16 v[56:59], v[16:19], a[44:47], v[56:59]
  s_waitcnt vmcnt(11)
  s_barrier
  ds_read_b128 v[8:11], v128 offset:0
  v_mfma_f32_16x16x32_bf16 v[60:63], v[16:19], a[100:103], v[60:63]
  v_mfma_f32_16x16x32_bf16 v[64:67], v[16:19], a[156:159], v[64:67]
  v_mfma_f32_16x16x32_bf16 v[68:71], v[16:19], a[212:215], v[68:71]
  s_waitcnt lgkmcnt(4)
  v_mfma_f32_16x16x32_bf16 v[40:43], v[20:23], a[48:51], v[40:43]
  ds_read_b128 v[12:15], v128 offset:14336
  v_mfma_f32_16x16x32_bf16 v[44:47], v[20:23], a[104:107], v[44:47]
  v_mfma_f32_16x16x32_bf16 v[48:51], v[20:23], a[160:163], v[48:51]
  v_mfma_f32_16x16x32_bf16 v[52:55], v[20:23], a[216:219], v[52:55]
  s_waitcnt lgkmcnt(4)
  v_mfma_f32_16x16x32_bf16 v[56:59], v[24:27], a[48:51], v[56:59]
  ds_read_b128 v[16:19], v128 offset:1024
  v_mfma_f32_16x16x32_bf16 v[60:63], v[24:27], a[104:107], v[60:63]
  v_mfma_f32_16x16x32_bf16 v[64:67], v[24:27], a[160:163], v[64:67]
  v_mfma_f32_16x16x32_bf16 v[68:71], v[24:27], a[216:219], v[68:71]
  s_waitcnt lgkmcnt(4)
  v_mfma_f32_16x16x32_bf16 v[40:43], v[28:31], a[52:55], v[40:43]
  ds_read_b128 v[20:23], v128 offset:15360
  v_mfma_f32_16x16x32_bf16 v[44:47], v[28:31], a[108:111], v[44:47]
  v_mfma_f32_16x16x32_bf16 v[48:51], v[28:31], a[164:167], v[48:51]
  v_mfma_f32_16x16x32_bf16 v[52:55], v[28:31], a[220:223], v[52:55]
  s_waitcnt lgkmcnt(4)
  v_mfma_f32_16x16x32_bf16 v[56:59], v[32:35], a[52:55], v[56:59]
  ds_read_b128 v[24:27], v128 offset:2048
  v_mfma_f32_16x16x32_bf16 v[60:63], v[32:35], a[108:111], v[60:63]
  v_mfma_f32_16x16x32_bf16 v[64:67], v[32:35], a[164:167], v[64:67]
  v_mfma_f32_16x16x32_bf16 v[68:71], v[32:35], a[220:223], v[68:71]
  s_waitcnt lgkmcnt(4)
  s_mov_b32 s40, s19
  s_mov_b32 s41, s29
  s_add_u32 s19, s19, 1
  s_cmp_lt_u32 s19, s35
  s_cbranch_scc0 wg_f_e0
  v_mfma_f32_16x16x32_bf16 v[96:99], v[8:11], a[0:3], 0
  ds_read_b128 v[28:31], v128 offset:16384
  v_mfma_f32_16x16x32_bf16 v[100:103], v[8:11], a[56:59], 0
  v_mfma_f32_16x16x32_bf16 v[104:107], v[8:11], a[112:115], 0
  v_mfma_f32_16x16x32_bf16 v[108:111], v[8:11], a[168:171], 0
  s_waitcnt lgkmcnt(4)
  s_lshl_b32 s42, s40, 10
  v_mfma_f32_16x16x32_bf16 v[112:115], v[12:15], a[0:3], 0
  ds_read_b128 v[32:35], v128 offset:3072
  v_mfma_f32_16x16x32_bf16 v[116:119], v[12:15], a[56:59], 0
  s_add_u32 s42, s42, s41
  v_cvt_pk_bf16_f32 v72, v40, v41
  v_mfma_f32_16x16x32_bf16 v[120:123], v[12:15], a[112:115], 0
  v_cvt_pk_bf16_f32 v73, v42, v43
  v_cvt_pk_bf16_f32 v74, v56, v57
  v_mfma_f32_16x16x32_bf16 v[124:127], v[12:15], a[168:171], 0
  s_waitcnt lgkmcnt(4)
  v_cvt_pk_bf16_f32 v75, v58, v59
  v_mfma_f32_16x16x32_bf16 v[96:99], v[16:19], a[4:7], v[96:99]
  ds_read_b128 v[8:11], v128 offset:17408
  v_mfma_f32_16x16x32_bf16 v[100:103], v[16:19], a[60:63], v[100:103]
  s_add_u32 s43, s42, 0
  v_mfma_f32_16x16x32_bf16 v[104:107], v[16:19], a[116:119], v[104:107]
  buffer_store_dwordx4 v[72:75], v2, s[8:11], s43 offen sc1
  v_cvt_pk_bf16_f32 v76, v44, v45
  v_mfma_f32_16x16x32_bf16 v[108:111], v[16:19], a[172:175], v[108:111]
  s_waitcnt lgkmcnt(4)
  v_cvt_pk_bf16_f32 v77, v46, v47
  v_mfma_f32_16x16x32_bf16 v[112:115], v[20:23], a[4:7], v[112:115]
  ds_read_b128 v[12:15], v128 offset:4096
  v_mfma_f32_16x16x32_bf16 v[116:119], v[20:23], a[60:63], v[116:119]
  v_cvt_pk_bf16_f32 v78, v60, v61
  v_cvt_pk_bf16_f32 v79, v62, v63
  v_mfma_f32_16x16x32_bf16 v[120:123], v[20:23], a[116:119], v[120:123]
  s_add_u32 s43, s42, 14336
  v_mfma_f32_16x16x32_bf16 v[124:127], v[20:23], a[172:175], v[124:127]
  s_waitcnt lgkmcnt(4)
  buffer_store_dwordx4 v[76:79], v2, s[8:11], s43 offen sc1
  v_mfma_f32_16x16x32_bf16 v[96:99], v[24:27], a[8:11], v[96:99]
  ds_read_b128 v[16:19], v128 offset:18432
  v_mfma_f32_16x16x32_bf16 v[100:103], v[24:27], a[64:67], v[100:103]
  v_cvt_pk_bf16_f32 v80, v48, v49
  v_cvt_pk_bf16_f32 v81, v50, v51
  v_mfma_f32_16x16x32_bf16 v[104:107], v[24:27], a[120:123], v[104:107]
  v_cvt_pk_bf16_f32 v82, v64, v65
  v_cvt_pk_bf16_f32 v83, v66, v67
  v_mfma_f32_16x16x32_bf16 v[108:111], v[24:27], a[176:179], v[108:111]
  s_waitcnt lgkmcnt(4)
  s_add_u32 s43, s42, 458752
  v_mfma_f32_16x16x32_bf16 v[112:115], v[28:31], a[8:11], v[112:115]
  ds_read_b128 v[20:23], v128 offset:5120
  v_mfma_f32_16x16x32_bf16 v[116:119], v[28:31], a[64:67], v[116:119]
  buffer_store_dwordx4 v[80:83], v2, s[8:11], s43 offen sc1
  v_cvt_pk_bf16_f32 v84, v52, v53
  v_mfma_f32_16x16x32_bf16 v[120:123], v[28:31], a[120:123], v[120:123]
  v_cvt_pk_bf16_f32 v85, v54, v55
  v_cvt_pk_bf16_f32 v86, v68, v69
  v_mfma_f32_16x16x32_bf16 v[124:127], v[28:31], a[176:179], v[124:127]
  s_waitcnt lgkmcnt(4)
  v_cvt_pk_bf16_f32 v87, v70, v71
  v_mfma_f32_16x16x32_bf16 v[96:99], v[32:35], a[12:15], v[96:99]
  ds_read_b128 v[24:27], v128 offset:19456
  v_mfma_f32_16x16x32_bf16 v[100:103], v[32:35], a[68:71], v[100:103]
  s_add_u32 s43, s42, 473088
  v_mfma_f32_16x16x32_bf16 v[104:107], v[32:35], a[124:127], v[104:107]
  buffer_store_dwordx4 v[84:87], v2, s[8:11], s43 offen sc1
  v_mfma_f32_16x16x32_bf16 v[108:111], v[32:35], a[180:183], v[108:111]
  s_waitcnt lgkmcnt(4)
  s_add_u32 s30, s19, 2
  s_lshr_b32 s24, s30, 1
  s_lshl_b32 s24, s24, 2
  s_and_b32 s25, s30, 1
  s_add_u32 s24, s24, s25
  s_mul_i32 s24, s24, 14336
  v_mfma_f32_16x16x32_bf16 v[112:115], v[8:11], a[12:15], v[112:115]
  ds_read_b128 v[28:31], v128 offset:6144
  v_mfma_f32_16x16x32_bf16 v[116:119], v[8:11], a[68:71], v[116:119]
  s_add_u32 s24, s24, s23
  s_cmp_lt_u32 s30, s35
  s_cselect_b32 s24, s24, 0x40000000
  v_mfma_f32_16x16x32_bf16 v[120:123], v[8:11], a[124:127], v[120:123]
  s_add_u32 m0, s33, s27
  s_nop 0
  buffer_load_dwordx4 v2, s[8:11], s24 offen offset:0 sc1 lds
  v_mfma_f32_16x16x32_bf16 v[124:127], v[8:11], a[180:183], v[124:127]
  s_waitcnt lgkmcnt(4)
  v_mfma_f32_16x16x32_bf16 v[96:99], v[12:15], a[16:19], v[96:99]
  ds_read_b128 v[32:35], v128 offset:20480
  v_mfma_f32_16x16x32_bf16 v[100:103], v[12:15], a[72:75], v[100:103]
  v_mfma_f32_16x16x32_bf16 v[104:107], v[12:15], a[128:131], v[104:107]
  v_mfma_f32_16x16x32_bf16 v[108:111], v[12:15], a[184:187], v[108:111]
  s_waitcnt lgkmcnt(4)
  buffer_load_dwordx4 v2, s[8:11], s24 offen offset:1024 sc1 lds
  v_mfma_f32_16x16x32_bf16 v[112:115], v[16:19], a[16:19], v[112:115]
  ds_read_b128 v[8:11], v128 offset:7168
  v_mfma_f32_16x16x32_bf16 v[116:119], v[16:19], a[72:75], v[116:119]
  v_mfma_f32_16x16x32_bf16 v[120:123], v[16:19], a[128:131], v[120:123]
  v_mfma_f32_16x16x32_bf16 v[124:127], v[16:19], a[184:187], v[124:127]
  s_waitcnt lgkmcnt(4)
  v_mfma_f32_16x16x32_bf16 v[96:99], v[20:23], a[20:23], v[96:99]
  ds_read_b128 v[12:15], v128 offset:21504
  v_mfma_f32_16x16x32_bf16 v[100:103], v[20:23], a[76:79], v[100:103]
  buffer_load_dwordx4 v2, s[8:11], s24 offen offset:2048 sc1 lds
  v_mfma_f32_16x16x32_bf16 v[104:107], v[20:23], a[132:135], v[104:107]
  v_mfma_f32_16x16x32_bf16 v[108:111], v[20:23], a[188:191], v[108:111]
  s_waitcnt lgkmcnt(4)
  v_mfma_f32_16x16x32_bf16 v[112:115], v[24:27], a[20:23], v[112:115]
  ds_read_b128 v[16:19], v128 offset:8192
  v_mfma_f32_16x16x32_bf16 v[116:119], v[24:27], a[76:79], v[116:119]
  v_mfma_f32_16x16x32_bf16 v[120:123], v[24:27], a[132:135], v[120:123]
  buffer_load_dwordx4 v2, s[8:11], s24 offen offset:3072 sc1 lds
  v_mfma_f32_16x16x32_bf16 v[124:127], v[24:27], a[188:191], v[124:127]
  s_waitcnt lgkmcnt(4)
  v_mfma_f32_16x16x32_bf16 v[96:99], v[28:31], a[24:27], v[96:99]
  ds_read_b128 v[20:23], v128 offset:22528
  v_mfma_f32_16x16x32_bf16 v[100:103], v[28:31], a[80:83], v[100:103]
  v_mfma_f32_16x16x32_bf16 v[104:107], v[28:31], a[136:139], v[104:107]
  v_mfma_f32_16x16x32_bf16 v[108:111], v[28:31], a[192:195], v[108:111]
  s_waitcnt lgkmcnt(4)
  s_add_u32 m0, m0, 4096
  s_add_u32 s24, s24, 4096
  buffer_load_dwordx4 v2, s[8:11], s24 offen offset:0 sc1 lds
  v_mfma_f32_16x16x32_bf16 v[112:115], v[32:35], a[24:27], v[112:115]
  ds_read_b128 v[24:27], v128 offset:9216
  v_mfma_f32_16x16x32_bf16 v[116:119], v[32:35], a[80:83], v[116:119]
  v_mfma_f32_16x16x32_bf16 v[120:123], v[32:35], a[136:139], v[120:123]
  v_mfma_f32_16x16x32_bf16 v[124:127], v[32:35], a[192:195], v[124:127]
  s_waitcnt lgkmcnt(4)
  v_mfma_f32_16x16x32_bf16 v[96:99], v[8:11], a[28:31], v[96:99]
  ds_read_b128 v[28:31], v128 offset:23552
  v_mfma_f32_16x16x32_bf16 v[100:103], v[8:11], a[84:87], v[100:103]
  buffer_load_dwordx4 v2, s[8:11], s24 offen offset:1024 sc1 lds
  v_mfma_f32_16x16x32_bf16 v[104:107], v[8:11], a[140:143], v[104:107]
  v_mfma_f32_16x16x32_bf16 v[108:111], v[8:11], a[196:199], v[108:111]
  s_waitcnt lgkmcnt(4)
  v_mfma_f32_16x16x32_bf16 v[112:115], v[12:15], a[28:31], v[112:115]
  ds_read_b128 v[32:35], v128 offset:10240
  v_mfma_f32_16x16x32_bf16 v[116:119], v[12:15], a[84:87], v[116:119]
  v_mfma_f32_16x16x32_bf16 v[120:123], v[12:15], a[140:143], v[120:123]
  buffer_load_dwordx4 v2, s[8:11], s24 offen offset:2048 sc1 lds
  v_mfma_f32_16x16x32_bf16 v[124:127], v[12:15], a[196:199], v[124:127]
  s_waitcnt lgkmcnt(4)
  v_mfma_f32_16x16x32_bf16 v[96:99], v[16:19], a[32:35], v[96:99]
  ds_read_b128 v[8:11], v128 offset:24576
  v_mfma_f32_16x16x32_bf16 v[100:103], v[16:19], a[88:91], v[100:103]
  v_mfma_f32_16x16x32_bf16 v[104:107], v[16:19], a[144:147], v[104:107]
  v_mfma_f32_16x16x32_bf16 v[108:111], v[16:19], a[200:203], v[108:111]
  s_waitcnt lgkmcnt(4)
  s_add_u32 s33, s33, 28672
  s_cmp_eq_u32 s33, 114688
  s_cselect_b32 s33, 0, s33
  v_mfma_f32_16x16x32_bf16 v[112:115], v[20:23], a[32:35], v[112:115]
  ds_read_b128 v[12:15], v128 offset:11264
  v_mfma_f32_16x16x32_bf16 v[116:119], v[20:23], a[88:91], v[116:119]
  s_add_u32 s32, s32, 28672
  s_cmp_eq_u32 s32, 114688
  s_cselect_b32 s32, 0, s32
  v_mfma_f32_16x16x32_bf16 v[120:123], v[20:23], a[144:147], v[120:123]
  v_add_u32 v5, s32, v2
  v_mfma_f32_16x16x32_bf16 v[124:127], v[20:23], a[200:203], v[124:127]
  s_waitcnt lgkmcnt(4)
  v_mfma_f32_16x16x32_bf16 v[96:99], v[24:27], a[36:39], v[96:99]
  ds_read_b128 v[16:19], v128 offset:25600
  v_mfma_f32_16x16x32_bf16 v[100:103], v[24:27], a[92:95], v[100:103]
  v_mfma_f32_16x16x32_bf16 v[104:107], v[24:27], a[148:151], v[104:107]
  v_mfma_f32_16x16x32_bf16 v[108:111], v[24:27], a[204:207], v[108:111]
  s_waitcnt lgkmcnt(4)
  v_mfma_f32_16x16x32_bf16 v[112:115], v[28:31], a[36:39], v[112:115]
  ds_read_b128 v[20:23], v128 offset:12288
  v_mfma_f32_16x16x32_bf16 v[116:119], v[28:31], a[92:95], v[116:119]
  v_mfma_f32_16x16x32_bf16 v[120:123], v[28:31], a[148:151], v[120:123]
  v_mfma_f32_16x16x32_bf16 v[124:127], v[28:31], a[204:207], v[124:127]
  s_waitcnt lgkmcnt(4)
  v_mfma_f32_16x16x32_bf16 v[96:99], v[32:35], a[40:43], v[96:99]
  ds_read_b128 v[24:27], v128 offset:26624
  v_mfma_f32_16x16x32_bf16 v[100:103], v[32:35], a[96:99], v[100:103]
  v_mfma_f32_16x16x32_bf16 v[104:107], v[32:35], a[152:155], v[104:107]
  v_mfma_f32_16x16x32_bf16 v[108:111], v[32:35], a[208:211], v[108:111]
  s_waitcnt lgkmcnt(4)
  v_mfma_f32_16x16x32_bf16 v[112:115], v[8:11], a[40:43], v[112:115]
  ds_read_b128 v[28:31], v128 offset:13312
  v_mfma_f32_16x16x32_bf16 v[116:119], v[8:11], a[96:99], v[116:119]
  v_mfma_f32_16x16x32_bf16 v[120:123], v[8:11], a[152:155], v[120:123]
  v_mfma_f32_16x16x32_bf16 v[124:127], v[8:11], a[208:211], v[124:127]
  s_waitcnt lgkmcnt(4)
  v_mfma_f32_16x16x32_bf16 v[96:99], v[12:15], a[44:47], v[96:99]
  ds_read_b128 v[32:35], v128 offset:27648
  v_mfma_f32_16x16x32_bf16 v[100:103], v[12:15], a[100:103], v[100:103]
  v_mfma_f32_16x16x32_bf16 v[104:107], v[12:15], a[156:159], v[104:107]
  v_mfma_f32_16x16x32_bf16 v[108:111], v[12:15], a[212:215], v[108:111]
  s_waitcnt lgkmcnt(4)
  v_mfma_f32_16x16x32_bf16 v[112:115], v[16:19], a[44:47], v[112:115]
  s_waitcnt vmcnt(11)
  s_barrier
  ds_read_b128 v[8:11], v5 offset:0
  v_mfma_f32_16x16x32_bf16 v[116:119], v[16:19], a[100:103], v[116:119]
  v_mfma_f32_16x16x32_bf16 v[120:123], v[16:19], a[156:159], v[120:123]
  v_mfma_f32_16x16x32_bf16 v[124:127], v[16:19], a[212:215], v[124:127]
  s_waitcnt lgkmcnt(4)
  v_mfma_f32_16x16x32_bf16 v[96:99], v[20:23], a[48:51], v[96:99]
  ds_read_b128 v[12:15], v5 offset:14336
  v_mfma_f32_16x16x32_bf16 v[100:103], v[20:23], a[104:107], v[100:103]
  v_mfma_f32_16x16x32_bf16 v[104:107], v[20:23], a[160:163], v[104:107]
  v_mfma_f32_16x16x32_bf16 v[108:111], v[20:23], a[216:219], v[108:111]
  s_waitcnt lgkmcnt(4)
  v_mfma_f32_16x16x32_bf16 v[112:115], v[24:27], a[48:51], v[112:115]
  ds_read_b128 v[16:19], v5 offset:1024
  v_mfma_f32_16x16x32_bf16 v[116:119], v[24:27], a[104:107], v[116:119]
  v_mfma_f32_16x16x32_bf16 v[120:123], v[24:27], a[160:163], v[120:123]
  v_mfma_f32_16x16x32_bf16 v[124:127], v[24:27], a[216:219], v[124:127]
  s_waitcnt lgkmcnt(4)
  v_mfma_f32_16x16x32_bf16 v[96:99], v[28:31], a[52:55], v[96:99]
  ds_read_b128 v[20:23], v5 offset:15360
  v_mfma_f32_16x16x32_bf16 v[100:103], v[28:31], a[108:111], v[100:103]
  v_mfma_f32_16x16x32_bf16 v[104:107], v[28:31], a[164:167], v[104:107]
  v_mfma_f32_16x16x32_bf16 v[108:111], v[28:31], a[220:223], v[108:111]
  s_waitcnt lgkmcnt(4)
  v_mfma_f32_16x16x32_bf16 v[112:115], v[32:35], a[52:55], v[112:115]
  ds_read_b128 v[24:27], v5 offset:2048
  v_mfma_f32_16x16x32_bf16 v[116:119], v[32:35], a[108:111], v[116:119]
  v_mfma_f32_16x16x32_bf16 v[120:123], v[32:35], a[164:167], v[120:123]
  v_mfma_f32_16x16x32_bf16 v[124:127], v[32:35], a[220:223], v[124:127]
  s_waitcnt lgkmcnt(4)
  s_mov_b32 s40, s19
  s_mov_b32 s41, s29
  s_add_u32 s19, s19, 1
  s_cmp_lt_u32 s19, s35
  s_cbranch_scc1 wg_f_loop
  s_nop 3
  s_lshl_b32 s42, s40, 10
  s_add_u32 s42, s42, s41
  v_cvt_pk_bf16_f32 v72, v96, v97
  v_cvt_pk_bf16_f32 v73, v98, v99
  v_cvt_pk_bf16_f32 v74, v112, v113
  v_cvt_pk_bf16_f32 v75, v114, v115
  s_add_u32 s43, s42, 0
  buffer_store_dwordx4 v[72:75], v2, s[8:11], s43 offen sc1
  v_cvt_pk_bf16_f32 v76, v100, v101
  v_cvt_pk_bf16_f32 v77, v102, v103
  v_cvt_pk_bf16_f32 v78, v116, v117
  v_cvt_pk_bf16_f32 v79, v118, v119
  s_add_u32 s43, s42, 14336
  buffer_store_dwordx4 v[76:79], v2, s[8:11], s43 offen sc1
  v_cvt_pk_bf16_f32 v80, v104, v105
  v_cvt_pk_bf16_f32 v81, v106, v107
  v_cvt_pk_bf16_f32 v82, v120, v121
  v_cvt_pk_bf16_f32 v83, v122, v123
  s_add_u32 s43, s42, 458752
  buffer_store_dwordx4 v[80:83], v2, s[8:11], s43 offen sc1
  v_cvt_pk_bf16_f32 v84, v108, v109
  v_cvt_pk_bf16_f32 v85, v110, v111
  v_cvt_pk_bf16_f32 v86, v124, v125
  v_cvt_pk_bf16_f32 v87, v126, v127
  s_add_u32 s43, s42, 473088
  buffer_store_dwordx4 v[84:87], v2, s[8:11], s43 offen sc1
  s_branch wg_done
wg_f_e0:
  s_nop 7
  s_lshl_b32 s42, s40, 10
  s_add_u32 s42, s42, s41
  v_cvt_pk_bf16_f32 v72, v40, v41
  v_cvt_pk_bf16_f32 v73, v42, v43
  v_cvt_pk_bf16_f32 v74, v56, v57
  v_cvt_pk_bf16_f32 v75, v58, v59
  s_add_u32 s43, s42, 0
  buffer_store_dwordx4 v[72:75], v2, s[8:11], s43 offen sc1
  v_cvt_pk_bf16_f32 v76, v44, v45
  v_cvt_pk_bf16_f32 v77, v46, v47
  v_cvt_pk_bf16_f32 v78, v60, v61
  v_cvt_pk_bf16_f32 v79, v62, v63
  s_add_u32 s43, s42, 14336
  buffer_store_dwordx4 v[76:79], v2, s[8:11], s43 offen sc1
  v_cvt_pk_bf16_f32 v80, v48, v49
  v_cvt_pk_bf16_f32 v81, v50, v51
  v_cvt_pk_bf16_f32 v82, v64, v65
  v_cvt_pk_bf16_f32 v83, v66, v67
  s_add_u32 s43, s42, 458752
  buffer_store_dwordx4 v[80:83], v2, s[8:11], s43 offen sc1
  v_cvt_pk_bf16_f32 v84, v52, v53
  v_cvt_pk_bf16_f32 v85, v54, v55
  v_cvt_pk_bf16_f32 v86, v68, v69
  v_cvt_pk_bf16_f32 v87, v70, v71
  s_add_u32 s43, s42, 473088
  buffer_store_dwordx4 v[84:87], v2, s[8:11], s43 offen sc1
  s_branch wg_done
wg_vo:
  s_sub_u32 s29, s17, 16
  s_mul_i32 s29, s29, 28672
  s_mul_i32 s24, s28, 458752
  s_add_u32 s29, s29, s24
  s_add_u32 s29, s29, 2490368
  v_lshlrev_b32 v6, 4, v3
  v_mul_u32_u24 v7, 12, v3
  v_add_u32 v7, 48, v7
  s_mov_b32 s31, 0
  s_lshl_b32 s24, s34, 1
  s_mul_i32 s24, s24, 14336
  s_add_u32 s24, s24, s23
  s_add_u32 m0, s31, s27
  s_nop 0
  buffer_load_dwordx4 v2, s[8:11], s24 offen offset:0 sc1 lds
  buffer_load_dwordx4 v2, s[8:11], s24 offen offset:1024 sc1 lds
  buffer_load_dwordx4 v2, s[8:11], s24 offen offset:2048 sc1 lds
  buffer_load_dwordx4 v2, s[8:11], s24 offen offset:3072 sc1 lds
  s_add_u32 m0, m0, 4096
  s_add_u32 s24, s24, 4096
  buffer_load_dwordx4 v2, s[8:11], s24 offen offset:0 sc1 lds
  buffer_load_dwordx4 v2, s[8:11], s24 offen offset:1024 sc1 lds
  buffer_load_dwordx4 v2, s[8:11], s24 offen offset:2048 sc1 lds
  s_sub_u32 s36, s35, 1
  s_add_u32 s30, s34, 1
  s_min_u32 s30, s30, s36
  s_mov_b32 s31, 28672
  s_lshl_b32 s24, s30, 1
  s_mul_i32 s24, s24, 14336
  s_add_u32 s24, s24, s23
  s_add_u32 m0, s31, s27
  s_nop 0
  buffer_load_dwordx4 v2, s[8:11], s24 offen offset:0 sc1 lds
  buffer_load_dwordx4 v2, s[8:11], s24 offen offset:1024 sc1 lds
  buffer_load_dwordx4 v2, s[8:11], s24 offen offset:2048 sc1 lds
  buffer_load_dwordx4 v2, s[8:11], s24 offen offset:3072 sc1 lds
  s_add_u32 m0, m0, 4096
  s_add_u32 s24, s24, 4096
  buffer_load_dwordx4 v2, s[8:11], s24 offen offset:0 sc1 lds
  buffer_load_dwordx4 v2, s[8:11], s24 offen offset:1024 sc1 lds
  buffer_load_dwordx4 v2, s[8:11], s24 offen offset:2048 sc1 lds
  s_mov_b32 s19, s34
  s_mov_b32 s32, 0
  s_mov_b32 s33, 57344
  s_cmp_eq_u32 s18, s101
  s_cbranch_scc1 wg_vo_hx
  s_add_u32 s22, s21, 0
  buffer_load_dwordx4 a[0:3], v2, s[8:11], s22 offen offset:0 sc1
  buffer_load_dwordx4 a[4:7], v2, s[8:11], s22 offen offset:1024 sc1
  buffer_load_dwordx4 a[8:11], v2, s[8:11], s22 offen offset:2048 sc1
  buffer_load_dwordx4 a[12:15], v2, s[8:11], s22 offen offset:3072 sc1
  s_add_u32 s22, s21, 4096
  buffer_load_dwordx4 a[16:19], v2, s[8:11], s22 offen offset:0 sc1
  buffer_load_dwordx4 a[20:23], v2, s[8:11], s22 offen offset:1024 sc1
  buffer_load_dwordx4 a[24:27], v2, s[8:11], s22 offen offset:2048 sc1
  buffer_load_dwordx4 a[28:31], v2, s[8:11], s22 offen offset:3072 sc1
  s_add_u32 s22, s21, 8192
  buffer_load_dwordx4 a[32:35], v2, s[8:11], s22 offen offset:0 sc1
  buffer_load_dwordx4 a[36:39], v2, s[8:11], s22 offen offset:1024 sc1
  buffer_load_dwordx4 a[40:43], v2, s[8:11], s22 offen offset:2048 sc1
  buffer_load_dwordx4 a[44:47], v2, s[8:11], s22 offen offset:3072 sc1
  s_add_u32 s22, s21, 12288
  buffer_load_dwordx4 a[48:51], v2, s[8:11], s22 offen offset:0 sc1
  buffer_load_dwordx4 a[52:55], v2, s[8:11], s22 offen offset:1024 sc1
  buffer_load_dwordx4 a[56:59], v2, s[8:11], s22 offen offset:2048 sc1
  buffer_load_dwordx4 a[60:63], v2, s[8:11], s22 offen offset:3072 sc1
  s_add_u32 s22, s21, 16384
  buffer_load_dwordx4 a[64:67], v2, s[8:11], s22 offen offset:0 sc1
  buffer_load_dwordx4 a[68:71], v2, s[8:11], s22 offen offset:1024 sc1
  buffer_load_dwordx4 a[72:75], v2, s[8:11], s22 offen offset:2048 sc1
  buffer_load_dwordx4 a[76:79], v2, s[8:11], s22 offen offset:3072 sc1
  s_add_u32 s22, s21, 20480
  buffer_load_dwordx4 a[80:83], v2, s[8:11], s22 offen offset:0 sc1
  buffer_load_dwordx4 a[84:87], v2, s[8:11], s22 offen offset:1024 sc1
  buffer_load_dwordx4 a[88:91], v2, s[8:11], s22 offen offset:2048 sc1
  buffer_load_dwordx4 a[92:95], v2, s[8:11], s22 offen offset:3072 sc1
  s_add_u32 s22, s21, 24576
  buffer_load_dwordx4 a[96:99], v2, s[8:11], s22 offen offset:0 sc1
  buffer_load_dwordx4 a[100:103], v2, s[8:11], s22 offen offset:1024 sc1
  buffer_load_dwordx4 a[104:107], v2, s[8:11], s22 offen offset:2048 sc1
  buffer_load_dwordx4 a[108:111], v2, s[8:11], s22 offen offset:3072 sc1
  s_add_u32 s22, s21, 28672
  buffer_load_dwordx4 a[112:115], v2, s[8:11], s22 offen offset:0 sc1
  buffer_load_dwordx4 a[116:119], v2, s[8:11], s22 offen offset:1024 sc1
  buffer_load_dwordx4 a[120:123], v2, s[8:11], s22 offen offset:2048 sc1
  buffer_load_dwordx4 a[124:127], v2, s[8:11], s22 offen offset:3072 sc1
  s_add_u32 s22, s21, 32768
  buffer_load_dwordx4 a[128:131], v2, s[8:11], s22 offen offset:0 sc1
  buffer_load_dwordx4 a[132:135], v2, s[8:11], s22 offen offset:1024 sc1
  buffer_load_dwordx4 a[136:139], v2, s[8:11], s22 offen offset:2048 sc1
  buffer_load_dwordx4 a[140:143], v2, s[8:11], s22 offen offset:3072 sc1
  s_add_u32 s22, s21, 36864
  buffer_load_dwordx4 a[144:147], v2, s[8:11], s22 offen offset:0 sc1
  buffer_load_dwordx4 a[148:151], v2, s[8:11], s22 offen offset:1024 sc1
  buffer_load_dwordx4 a[152:155], v2, s[8:11], s22 offen offset:2048 sc1
  buffer_load_dwordx4 a[156:159], v2, s[8:11], s22 offen offset:3072 sc1
  s_add_u32 s22, s21, 40960
  s_waitcnt vmcnt(40)
  buffer_load_dwordx4 a[160:163], v2, s[8:11], s22 offen offset:0 sc1
  buffer_load_dwordx4 a[164:167], v2, s[8:11], s22 offen offset:1024 sc1
  buffer_load_dwordx4 a[168:171], v2, s[8:11], s22 offen offset:2048 sc1
  buffer_load_dwordx4 a[172:175], v2, s[8:11], s22 offen offset:3072 sc1
  s_add_u32 s22, s21, 45056
  buffer_load_dwordx4 a[176:179], v2, s[8:11], s22 offen offset:0 sc1
  buffer_load_dwordx4 a[180:183], v2, s[8:11], s22 offen offset:1024 sc1
  buffer_load_dwordx4 a[184:187], v2, s[8:11], s22 offen offset:2048 sc1
  buffer_load_dwordx4 a[188:191], v2, s[8:11], s22 offen offset:3072 sc1
  s_add_u32 s22, s21, 49152
  buffer_load_dwordx4 a[192:195], v2, s[8:11], s22 offen offset:0 sc1
  buffer_load_dwordx4 a[196:199], v2, s[8:11], s22 offen offset:1024 sc1
  buffer_load_dwordx4 a[200:203], v2, s[8:11], s22 offen offset:2048 sc1
  buffer_load_dwordx4 a[204:207], v2, s[8:11], s22 offen offset:3072 sc1
  s_add_u32 s22, s21, 53248
  buffer_load_dwordx4 a[208:211], v2, s[8:11], s22 offen offset:0 sc1
  buffer_load_dwordx4 a[212:215], v2, s[8:11], s22 offen offset:1024 sc1
  buffer_load_dwordx4 a[216:219], v2, s[8:11], s22 offen offset:2048 sc1
  buffer_load_dwordx4 a[220:223], v2, s[8:11], s22 offen offset:3072 sc1
wg_vo_hx:
  s_mov_b32 s101, -1
  s_waitcnt vmcnt(0)
  s_barrier
  s_mov_b32 s40, 0
  s_mov_b32 s41, 0x40000000
  v_mov_b32 v5, v2
  ds_read_b128 v[8:11], v5 offset:0
  ds_read_b128 v[12:15], v5 offset:14336
  ds_read_b128 v[16:19], v5 offset:1024
  ds_read_b128 v[20:23], v5 offset:15360
  ds_read_b128 v[24:27], v5 offset:2048
  s_waitcnt lgkmcnt(4)
.p2align 6
wg_vo_loop:
  v_mfma_f32_16x16x32_bf16 v[40:43], a[0:3], v[8:11], 0
  ds_read_b128 v[28:31], v5 offset:16384
  v_mfma_f32_16x16x32_bf16 v[44:47], a[56:59], v[8:11], 0
  v_mfma_f32_16x16x32_bf16 v[48:51], a[112:115], v[8:11], 0
  v_mfma_f32_16x16x32_bf16 v[52:55], a[168:171], v[8:11], 0
  s_waitcnt lgkmcnt(4)
  s_add_u32 s43, s41, 458752
  v_mfma_f32_16x16x32_bf16 v[56:59], a[0:3], v[12:15], 0
  ds_read_b128 v[32:35], v5 offset:3072
  v_mfma_f32_16x16x32_bf16 v[60:63], a[56:59], v[12:15], 0
  s_lshl_b32 s42, s40, 5
  s_add_u32 s42, s42, 0
  v_mfma_f32_16x16x32_bf16 v[64:67], a[112:115], v[12:15], 0
  v_add_u32 v88, s42, v4
  v_mul_u32_u24 v89, 2341, v88
  v_mfma_f32_16x16x32_bf16 v[68:71], a[168:171], v[12:15], 0
  s_waitcnt lgkmcnt(4)
  v_lshrrev_b32 v89, 16, v89
  v_mfma_f32_16x16x32_bf16 v[40:43], a[4:7], v[16:19], v[40:43]
  ds_read_b128 v[8:11], v5 offset:17408
  v_mfma_f32_16x16x32_bf16 v[44:47], a[60:63], v[16:19], v[44:47]
  v_mul_u32_u24 v92, 28, v89
  v_sub_u32 v92, v88, v92
  v_mfma_f32_16x16x32_bf16 v[48:51], a[116:119], v[16:19], v[48:51]
  v_cmp_gt_u32 vcc, 16, v92
  v_mul_u32_u24 v89, 84, v89
  v_mfma_f32_16x16x32_bf16 v[52:55], a[172:175], v[16:19], v[52:55]
  s_waitcnt lgkmcnt(4)
  v_cndmask_b32 v92, v7, v6, vcc
  v_mfma_f32_16x16x32_bf16 v[56:59], a[4:7], v[20:23], v[56:59]
  ds_read_b128 v[12:15], v5 offset:4096
  v_mfma_f32_16x16x32_bf16 v[60:63], a[60:63], v[20:23], v[60:63]
  v_add3_u32 v88, v88, v89, v92
  v_lshlrev_b32 v90, 4, v88
  v_mfma_f32_16x16x32_bf16 v[64:67], a[116:119], v[20:23], v[64:67]
  v_cvt_pk_bf16_f32 v72, v96, v100
  v_cvt_pk_bf16_f32 v73, v97, v101
  v_mfma_f32_16x16x32_bf16 v[68:71], a[172:175], v[20:23], v[68:71]
  s_waitcnt lgkmcnt(4)
  v_cvt_pk_bf16_f32 v74, v98, v102
  v_mfma_f32_16x16x32_bf16 v[40:43], a[8:11], v[24:27], v[40:43]
  ds_read_b128 v[16:19], v5 offset:18432
  v_mfma_f32_16x16x32_bf16 v[44:47], a[64:67], v[24:27], v[44:47]
  v_cvt_pk_bf16_f32 v75, v99, v103
  v_mfma_f32_16x16x32_bf16 v[48:51], a[120:123], v[24:27], v[48:51]
  buffer_store_dwordx4 v[72:75], v90, s[8:11], s41 offen sc1
  v_cvt_pk_bf16_f32 v76, v104, v108
  v_mfma_f32_16x16x32_bf16 v[52:55], a[176:179], v[24:27], v[52:55]
  s_waitcnt lgkmcnt(4)
  v_cvt_pk_bf16_f32 v77, v105, v109
  v_mfma_f32_16x16x32_bf16 v[56:59], a[8:11], v[28:31], v[56:59]
  ds_read_b128 v[20:23], v5 offset:5120
  v_mfma_f32_16x16x32_bf16 v[60:63], a[64:67], v[28:31], v[60:63]
  v_cvt_pk_bf16_f32 v78, v106, v110
  v_cvt_pk_bf16_f32 v79, v107, v111
  v_mfma_f32_16x16x32_bf16 v[64:67], a[120:123], v[28:31], v[64:67]
  buffer_store_dwordx4 v[76:79], v90, s[8:11], s43 offen sc1
  s_lshl_b32 s42, s40, 5
  v_mfma_f32_16x16x32_bf16 v[68:71], a[176:179], v[28:31], v[68:71]
  s_waitcnt lgkmcnt(4)
  s_add_u32 s42, s42, 16
  v_mfma_f32_16x16x32_bf16 v[40:43], a[12:15], v[32:35], v[40:43]
  ds_read_b128 v[24:27], v5 offset:19456
  v_mfma_f32_16x16x32_bf16 v[44:47], a[68:71], v[32:35], v[44:47]
  v_add_u32 v88, s42, v4
  v_mul_u32_u24 v89, 2341, v88
  v_mfma_f32_16x16x32_bf16 v[48:51], a[124:127], v[32:35], v[48:51]
  v_lshrrev_b32 v89, 16, v89
  v_mul_u32_u24 v92, 28, v89
  v_mfma_f32_16x16x32_bf16 v[52:55], a[180:183], v[32:35], v[52:55]
  s_waitcnt lgkmcnt(4)
  v_sub_u32 v92, v88, v92
  v_mfma_f32_16x16x32_bf16 v[56:59], a[12:15], v[8:11], v[56:59]
  ds_read_b128 v[28:31], v5 offset:6144
  v_mfma_f32_16x16x32_bf16 v[60:63], a[68:71], v[8:11], v[60:63]
  v_cmp_gt_u32 vcc, 16, v92
  v_mul_u32_u24 v89, 84, v89
  v_mfma_f32_16x16x32_bf16 v[64:67], a[124:127], v[8:11], v[64:67]
  v_cndmask_b32 v92, v7, v6, vcc
  v_add3_u32 v88, v88, v89, v92
  v_mfma_f32_16x16x32_bf16 v[68:71], a[180:183], v[8:11], v[68:71]
  s_waitcnt lgkmcnt(4)
  v_lshlrev_b32 v91, 4, v88
  v_mfma_f32_16x16x32_bf16 v[40:43], a[16:19], v[12:15], v[40:43]
  ds_read_b128 v[32:35], v5 offset:20480
  v_mfma_f32_16x16x32_bf16 v[44:47], a[72:75], v[12:15], v[44:47]
  v_cvt_pk_bf16_f32 v80, v112, v116
  v_cvt_pk_bf16_f32 v81, v113, v117
  v_mfma_f32_16x16x32_bf16 v[48:51], a[128:131], v[12:15], v[48:51]
  v_cvt_pk_bf16_f32 v82, v114, v118
  v_cvt_pk_bf16_f32 v83, v115, v119
  v_mfma_f32_16x16x32_bf16 v[52:55], a[184:187], v[12:15], v[52:55]
  s_waitcnt lgkmcnt(4)
  buffer_store_dwordx4 v[80:83], v91, s[8:11], s41 offen sc1
  v_mfma_f32_16x16x32_bf16 v[56:59], a[16:19], v[16:19], v[56:59]
  ds_read_b128 v[8:11], v5 offset:7168
  v_mfma_f32_16x16x32_bf16 v[60:63], a[72:75], v[16:19], v[60:63]
  v_cvt_pk_bf16_f32 v84, v120, v124
  v_cvt_pk_bf16_f32 v85, v121, v125
  v_mfma_f32_16x16x32_bf16 v[64:67], a[128:131], v[16:19], v[64:67]
  v_cvt_pk_bf16_f32 v86, v122, v126
  v_cvt_pk_bf16_f32 v87, v123, v127
  v_mfma_f32_16x16x32_bf16 v[68:71], a[184:187], v[16:19], v[68:71]
  s_waitcnt lgkmcnt(4)
  buffer_store_dwordx4 v[84:87], v91, s[8:11], s43 offen sc1
  v_mfma_f32_16x16x32_bf16 v[40:43], a[20:23], v[20:23], v[40:43]
  ds_read_b128 v[12:15], v5 offset:21504
  v_mfma_f32_16x16x32_bf16 v[44:47], a[76:79], v[20:23], v[44:47]
  s_add_u32 s30, s19, 2
  s_lshl_b32 s24, s30, 1
  s_mul_i32 s24, s24, 14336
  v_mfma_f32_16x16x32_bf16 v[48:51], a[132:135], v[20:23], v[48:51]
  s_add_u32 s24, s24, s23
  s_cmp_lt_u32 s30, s35
  s_cselect_b32 s24, s24, 0x40000000
  v_mfma_f32_16x16x32_bf16 v[52:55], a[188:191], v[20:23], v[52:55]
  s_waitcnt lgkmcnt(4)
  s_add_u32 m0, s33, s27
  s_nop 0
  buffer_load_dwordx4 v2, s[8:11], s24 offen offset:0 sc1 lds
  v_mfma_f32_16x16x32_bf16 v[56:59], a[20:23], v[24:27], v[56:59]
  ds_read_b128 v[16:19], v5 offset:8192
  v_mfma_f32_16x16x32_bf16 v[60:63], a[76:79], v[24:27], v[60:63]
  v_mfma_f32_16x16x32_bf16 v[64:67], a[132:135], v[24:27], v[64:67]
  v_mfma_f32_16x16x32_bf16 v[68:71], a[188:191], v[24:27], v[68:71]
  s_waitcnt lgkmcnt(4)
  v_mfma_f32_16x16x32_bf16 v[40:43], a[24:27], v[28:31], v[40:43]
  ds_read_b128 v[20:23], v5 offset:22528
  v_mfma_f32_16x16x32_bf16 v[44:47], a[80:83], v[28:31], v[44:47]
  buffer_load_dwordx4 v2, s[8:11], s24 offen offset:1024 sc1 lds
  v_mfma_f32_16x16x32_bf16 v[48:51], a[136:139], v[28:31], v[48:51]
  v_mfma_f32_16x16x32_bf16 v[52:55], a[192:195], v[28:31], v[52:55]
  s_waitcnt lgkmcnt(4)
  v_mfma_f32_16x16x32_bf16 v[56:59], a[24:27], v[32:35], v[56:59]
  ds_read_b128 v[24:27], v5 offset:9216
  v_mfma_f32_16x16x32_bf16 v[60:63], a[80:83], v[32:35], v[60:63]
  v_mfma_f32_16x16x32_bf16 v[64:67], a[136:139], v[32:35], v[64:67]
  buffer_load_dwordx4 v2, s[8:11], s24 offen offset:2048 sc1 lds
  v_mfma_f32_16x16x32_bf16 v[68:71], a[192:195], v[32:35], v[68:71]
  s_waitcnt lgkmcnt(4)
  v_mfma_f32_16x16x32_bf16 v[40:43], a[28:31], v[8:11], v[40:43]
  ds_read_b128 v[28:31], v5 offset:23552
  v_mfma_f32_16x16x32_bf16 v[44:47], a[84:87], v[8:11], v[44:47]
  v_mfma_f32_16x16x32_bf16 v[48:51], a[140:143], v[8:11], v[48:51]
  v_mfma_f32_16x16x32_bf16 v[52:55], a[196:199], v[8:11], v[52:55]
  s_waitcnt lgkmcnt(4)
  buffer_load_dwordx4 v2, s[8:11], s24 offen offset:3072 sc1 lds
  v_mfma_f32_16x16x32_bf16 v[56:59], a[28:31], v[12:15], v[56:59]
  ds_read_b128 v[32:35], v5 offset:10240
  v_mfma_f32_16x16x32_bf16 v[60:63], a[84:87], v[12:15], v[60:63]
  v_mfma_f32_16x16x32_bf16 v[64:67], a[140:143], v[12:15], v[64:67]
  v_mfma_f32_16x16x32_bf16 v[68:71], a[196:199], v[12:15], v[68:71]
  s_waitcnt lgkmcnt(4)
  v_mfma_f32_16x16x32_bf16 v[40:43], a[32:35], v[16:19], v[40:43]
  ds_read_b128 v[8:11], v5 offset:24576
  v_mfma_f32_16x16x32_bf16 v[44:47], a[88:91], v[16:19], v[44:47]
  s_add_u32 m0, m0, 4096
  s_add_u32 s24, s24, 4096
  buffer_load_dwordx4 v2, s[8:11], s24 offen offset:0 sc1 lds
  v_mfma_f32_16x16x32_bf16 v[48:51], a[144:147], v[16:19], v[48:51]
  v_mfma_f32_16x16x32_bf16 v[52:55], a[200:203], v[16:19], v[52:55]
  s_waitcnt lgkmcnt(4)
  v_mfma_f32_16x16x32_bf16 v[56:59], a[32:35], v[20:23], v[56:59]
  ds_read_b128 v[12:15], v5 offset:11264
  v_mfma_f32_16x16x32_bf16 v[60:63], a[88:91], v[20:23], v[60:63]
  v_mfma_f32_16x16x32_bf16 v[64:67], a[144:147], v[20:23], v[64:67]
  buffer_load_dwordx4 v2, s[8:11], s24 offen offset:1024 sc1 lds
  v_mfma_f32_16x16x32_bf16 v[68:71], a[200:203], v[20:23], v[68:71]
  s_waitcnt lgkmcnt(4)
  v_mfma_f32_16x16x32_bf16 v[40:43], a[36:39], v[24:27], v[40:43]
  ds_read_b128 v[16:19], v5 offset:25600
  v_mfma_f32_16x16x32_bf16 v[44:47], a[92:95], v[24:27], v[44:47]
  v_mfma_f32_16x16x32_bf16 v[48:51], a[148:151], v[24:27], v[48:51]
  v_mfma_f32_16x16x32_bf16 v[52:55], a[204:207], v[24:27], v[52:55]
  s_waitcnt lgkmcnt(4)
  buffer_load_dwordx4 v2, s[8:11], s24 offen offset:2048 sc1 lds
  v_mfma_f32_16x16x32_bf16 v[56:59], a[36:39], v[28:31], v[56:59]
  ds_read_b128 v[20:23], v5 offset:12288
  v_mfma_f32_16x16x32_bf16 v[60:63], a[92:95], v[28:31], v[60:63]
  v_mfma_f32_16x16x32_bf16 v[64:67], a[148:151], v[28:31], v[64:67]
  v_mfma_f32_16x16x32_bf16 v[68:71], a[204:207], v[28:31], v[68:71]
  s_waitcnt lgkmcnt(4)
  v_mfma_f32_16x16x32_bf16 v[40:43], a[40:43], v[32:35], v[40:43]
  ds_read_b128 v[24:27], v5 offset:26624
  v_mfma_f32_16x16x32_bf16 v[44:47], a[96:99], v[32:35], v[44:47]
  s_add_u32 s33, s33, 28672
  s_cmp_eq_u32 s33, 114688
  s_cselect_b32 s33, 0, s33
  v_mfma_f32_16x16x32_bf16 v[48:51], a[152:155], v[32:35], v[48:51]
  s_add_u32 s32, s32, 28672
  s_cmp_eq_u32 s32, 114688
  s_cselect_b32 s32, 0, s32
  v_mfma_f32_16x16x32_bf16 v[52:55], a[208:211], v[32:35], v[52:55]
  s_waitcnt lgkmcnt(4)
  v_add_u32 v128, s32, v2
  v_mfma_f32_16x16x32_bf16 v[56:59], a[40:43], v[8:11], v[56:59]
  ds_read_b128 v[28:31], v5 offset:13312
  v_mfma_f32_16x16x32_bf16 v[60:63], a[96:99], v[8:11], v[60:63]
  v_mfma_f32_16x16x32_bf16 v[64:67], a[152:155], v[8:11], v[64:67]
  v_mfma_f32_16x16x32_bf16 v[68:71], a[208:211], v[8:11], v[68:71]
  s_waitcnt lgkmcnt(4)
  v_mfma_f32_16x16x32_bf16 v[40:43], a[44:47], v[12:15], v[40:43]
  ds_read_b128 v[32:35], v5 offset:27648
  v_mfma_f32_16x16x32_bf16 v[44:47], a[100:103], v[12:15], v[44:47]
  v_mfma_f32_16x16x32_bf16 v[48:51], a[156:159], v[12:15], v[48:51]
  v_mfma_f32_16x16x32_bf16 v[52:55], a[212:215], v[12:15], v[52:55]
  s_waitcnt lgkmcnt(4)
  v_mfma_f32_16x16x32_bf16 v[56:59], a[44:47], v[16:19], v[56:59]
  s_waitcnt vmcnt(11)
  s_barrier
  ds_read_b128 v[8:11], v128 offset:0
  v_mfma_f32_16x16x32_bf16 v[60:63], a[100:103], v[16:19], v[60:63]
  v_mfma_f32_16x16x32_bf16 v[64:67], a[156:159], v[16:19], v[64:67]
  v_mfma_f32_16x16x32_bf16 v[68:71], a[212:215], v[16:19], v[68:71]
  s_waitcnt lgkmcnt(4)
  v_mfma_f32_16x16x32_bf16 v[40:43], a[48:51], v[20:23], v[40:43]
  ds_read_b128 v[12:15], v128 offset:14336
  v_mfma_f32_16x16x32_bf16 v[44:47], a[104:107], v[20:23], v[44:47]
  v_mfma_f32_16x16x32_bf16 v[48:51], a[160:163], v[20:23], v[48:51]
  v_mfma_f32_16x16x32_bf16 v[52:55], a[216:219], v[20:23], v[52:55]
  s_waitcnt lgkmcnt(4)
  v_mfma_f32_16x16x32_bf16 v[56:59], a[48:51], v[24:27], v[56:59]
  ds_read_b128 v[16:19], v128 offset:1024
  v_mfma_f32_16x16x32_bf16 v[60:63], a[104:107], v[24:27], v[60:63]
  v_mfma_f32_16x16x32_bf16 v[64:67], a[160:163], v[24:27], v[64:67]
  v_mfma_f32_16x16x32_bf16 v[68:71], a[216:219], v[24:27], v[68:71]
  s_waitcnt lgkmcnt(4)
  v_mfma_f32_16x16x32_bf16 v[40:43], a[52:55], v[28:31], v[40:43]
  ds_read_b128 v[20:23], v128 offset:15360
  v_mfma_f32_16x16x32_bf16 v[44:47], a[108:111], v[28:31], v[44:47]
  v_mfma_f32_16x16x32_bf16 v[48:51], a[164:167], v[28:31], v[48:51]
  v_mfma_f32_16x16x32_bf16 v[52:55], a[220:223], v[28:31], v[52:55]
  s_waitcnt lgkmcnt(4)
  v_mfma_f32_16x16x32_bf16 v[56:59], a[52:55], v[32:35], v[56:59]
  ds_read_b128 v[24:27], v128 offset:2048
  v_mfma_f32_16x16x32_bf16 v[60:63], a[108:111], v[32:35], v[60:63]
  v_mfma_f32_16x16x32_bf16 v[64:67], a[164:167], v[32:35], v[64:67]
  v_mfma_f32_16x16x32_bf16 v[68:71], a[220:223], v[32:35], v[68:71]
  s_waitcnt lgkmcnt(4)
  s_mov_b32 s40, s19
  s_mov_b32 s41, s29
  s_add_u32 s19, s19, 1
  s_cmp_lt_u32 s19, s35
  s_cbranch_scc0 wg_vo_e0
  v_mfma_f32_16x16x32_bf16 v[96:99], a[0:3], v[8:11], 0
  ds_read_b128 v[28:31], v128 offset:16384
  v_mfma_f32_16x16x32_bf16 v[100:103], a[56:59], v[8:11], 0
  v_mfma_f32_16x16x32_bf16 v[104:107], a[112:115], v[8:11], 0
  v_mfma_f32_16x16x32_bf16 v[108:111], a[168:171], v[8:11], 0
  s_waitcnt lgkmcnt(4)
  s_add_u32 s43, s41, 458752
  v_mfma_f32_16x16x32_bf16 v[112:115], a[0:3], v[12:15], 0
  ds_read_b128 v[32:35], v128 offset:3072
  v_mfma_f32_16x16x32_bf16 v[116:119], a[56:59], v[12:15], 0
  s_lshl_b32 s42, s40, 5
  s_add_u32 s42, s42, 0
  v_mfma_f32_16x16x32_bf16 v[120:123], a[112:115], v[12:15], 0
  v_add_u32 v88, s42, v4
  v_mul_u32_u24 v89, 2341, v88
  v_mfma_f32_16x16x32_bf16 v[124:127], a[168:171], v[12:15], 0
  s_waitcnt lgkmcnt(4)
  v_lshrrev_b32 v89, 16, v89
  v_mfma_f32_16x16x32_bf16 v[96:99], a[4:7], v[16:19], v[96:99]
  ds_read_b128 v[8:11], v128 offset:17408
  v_mfma_f32_16x16x32_bf16 v[100:103], a[60:63], v[16:19], v[100:103]
  v_mul_u32_u24 v92, 28, v89
  v_sub_u32 v92, v88, v92
  v_mfma_f32_16x16x32_bf16 v[104:107], a[116:119], v[16:19], v[104:107]
  v_cmp_gt_u32 vcc, 16, v92
  v_mul_u32_u24 v89, 84, v89
  v_mfma_f32_16x16x32_bf16 v[108:111], a[172:175], v[16:19], v[108:111]
  s_waitcnt lgkmcnt(4)
  v_cndmask_b32 v92, v7, v6, vcc
  v_mfma_f32_16x16x32_bf16 v[112:115], a[4:7], v[20:23], v[112:115]
  ds_read_b128 v[12:15], v128 offset:4096
  v_mfma_f32_16x16x32_bf16 v[116:119], a[60:63], v[20:23], v[116:119]
  v_add3_u32 v88, v88, v89, v92
  v_lshlrev_b32 v90, 4, v88
  v_mfma_f32_16x16x32_bf16 v[120:123], a[116:119], v[20:23], v[120:123]
  v_cvt_pk_bf16_f32 v72, v40, v44
  v_cvt_pk_bf16_f32 v73, v41, v45
  v_mfma_f32_16x16x32_bf16 v[124:127], a[172:175], v[20:23], v[124:127]
  s_waitcnt lgkmcnt(4)
  v_cvt_pk_bf16_f32 v74, v42, v46
  v_mfma_f32_16x16x32_bf16 v[96:99], a[8:11], v[24:27], v[96:99]
  ds_read_b128 v[16:19], v128 offset:18432
  v_mfma_f32_16x16x32_bf16 v[100:103], a[64:67], v[24:27], v[100:103]
  v_cvt_pk_bf16_f32 v75, v43, v47
  v_mfma_f32_16x16x32_bf16 v[104:107], a[120:123], v[24:27], v[104:107]
  buffer_store_dwordx4 v[72:75], v90, s[8:11], s41 offen sc1
  v_cvt_pk_bf16_f32 v76, v48, v52
  v_mfma_f32_16x16x32_bf16 v[108:111], a[176:179], v[24:27], v[108:111]
  s_waitcnt lgkmcnt(4)
  v_cvt_pk_bf16_f32 v77, v49, v53
  v_mfma_f32_16x16x32_bf16 v[112:115], a[8:11], v[28:31], v[112:115]
  ds_read_b128 v[20:23], v128 offset:5120
  v_mfma_f32_16x16x32_bf16 v[116:119], a[64:67], v[28:31], v[116:119]
  v_cvt_pk_bf16_f32 v78, v50, v54
  v_cvt_pk_bf16_f32 v79, v51, v55
  v_mfma_f32_16x16x32_bf16 v[120:123], a[120:123], v[28:31], v[120:123]
  buffer_store_dwordx4 v[76:79], v90, s[8:11], s43 offen sc1
  s_lshl_b32 s42, s40, 5
  v_mfma_f32_16x16x32_bf16 v[124:127], a[176:179], v[28:31], v[124:127]
  s_waitcnt lgkmcnt(4)
  s_add_u32 s42, s42, 16
  v_mfma_f32_16x16x32_bf16 v[96:99], a[12:15], v[32:35], v[96:99]
  ds_read_b128 v[24:27], v128 offset:19456
  v_mfma_f32_16x16x32_bf16 v[100:103], a[68:71], v[32:35], v[100:103]
  v_add_u32 v88, s42, v4
  v_mul_u32_u24 v89, 2341, v88
  v_mfma_f32_16x16x32_bf16 v[104:107], a[124:127], v[32:35], v[104:107]
  v_lshrrev_b32 v89, 16, v89
  v_mul_u32_u24 v92, 28, v89
  v_mfma_f32_16x16x32_bf16 v[108:111], a[180:183], v[32:35], v[108:111]
  s_waitcnt lgkmcnt(4)
  v_sub_u32 v92, v88, v92
  v_mfma_f32_16x16x32_bf16 v[112:115], a[12:15], v[8:11], v[112:115]
  ds_read_b128 v[28:31], v128 offset:6144
  v_mfma_f32_16x16x32_bf16 v[116:119], a[68:71], v[8:11], v[116:119]
  v_cmp_gt_u32 vcc, 16, v92
  v_mul_u32_u24 v89, 84, v89
  v_mfma_f32_16x16x32_bf16 v[120:123], a[124:127], v[8:11], v[120:123]
  v_cndmask_b32 v92, v7, v6, vcc
  v_add3_u32 v88, v88, v89, v92
  v_mfma_f32_16x16x32_bf16 v[124:127], a[180:183], v[8:11], v[124:127]
  s_waitcnt lgkmcnt(4)
  v_lshlrev_b32 v91, 4, v88
  v_mfma_f32_16x16x32_bf16 v[96:99], a[16:19], v[12:15], v[96:99]
  ds_read_b128 v[32:35], v128 offset:20480
  v_mfma_f32_16x16x32_bf16 v[100:103], a[72:75], v[12:15], v[100:103]
  v_cvt_pk_bf16_f32 v80, v56, v60
  v_cvt_pk_bf16_f32 v81, v57, v61
  v_mfma_f32_16x16x32_bf16 v[104:107], a[128:131], v[12:15], v[104:107]
  v_cvt_pk_bf16_f32 v82, v58, v62
  v_cvt_pk_bf16_f32 v83, v59, v63
  v_mfma_f32_16x16x32_bf16 v[108:111], a[184:187], v[12:15], v[108:111]
  s_waitcnt lgkmcnt(4)
  buffer_store_dwordx4 v[80:83], v91, s[8:11], s41 offen sc1
  v_mfma_f32_16x16x32_bf16 v[112:115], a[16:19], v[16:19], v[112:115]
  ds_read_b128 v[8:11], v128 offset:7168
  v_mfma_f32_16x16x32_bf16 v[116:119], a[72:75], v[16:19], v[116:119]
  v_cvt_pk_bf16_f32 v84, v64, v68
  v_cvt_pk_bf16_f32 v85, v65, v69
  v_mfma_f32_16x16x32_bf16 v[120:123], a[128:131], v[16:19], v[120:123]
  v_cvt_pk_bf16_f32 v86, v66, v70
  v_cvt_pk_bf16_f32 v87, v67, v71
  v_mfma_f32_16x16x32_bf16 v[124:127], a[184:187], v[16:19], v[124:127]
  s_waitcnt lgkmcnt(4)
  buffer_store_dwordx4 v[84:87], v91, s[8:11], s43 offen sc1
  v_mfma_f32_16x16x32_bf16 v[96:99], a[20:23], v[20:23], v[96:99]
  ds_read_b128 v[12:15], v128 offset:21504
  v_mfma_f32_16x16x32_bf16 v[100:103], a[76:79], v[20:23], v[100:103]
  s_add_u32 s30, s19, 2
  s_lshl_b32 s24, s30, 1
  s_mul_i32 s24, s24, 14336
  v_mfma_f32_16x16x32_bf16 v[104:107], a[132:135], v[20:23], v[104:107]
  s_add_u32 s24, s24, s23
  s_cmp_lt_u32 s30, s35
  s_cselect_b32 s24, s24, 0x40000000
  v_mfma_f32_16x16x32_bf16 v[108:111], a[188:191], v[20:23], v[108:111]
  s_waitcnt lgkmcnt(4)
  s_add_u32 m0, s33, s27
  s_nop 0
  buffer_load_dwordx4 v2, s[8:11], s24 offen offset:0 sc1 lds
  v_mfma_f32_16x16x32_bf16 v[112:115], a[20:23], v[24:27], v[112:115]
  ds_read_b128 v[16:19], v128 offset:8192
  v_mfma_f32_16x16x32_bf16 v[116:119], a[76:79], v[24:27], v[116:119]
  v_mfma_f32_16x16x32_bf16 v[120:123], a[132:135], v[24:27], v[120:123]
  v_mfma_f32_16x16x32_bf16 v[124:127], a[188:191], v[24:27], v[124:127]
  s_waitcnt lgkmcnt(4)
  v_mfma_f32_16x16x32_bf16 v[96:99], a[24:27], v[28:31], v[96:99]
  ds_read_b128 v[20:23], v128 offset:22528
  v_mfma_f32_16x16x32_bf16 v[100:103], a[80:83], v[28:31], v[100:103]
  buffer_load_dwordx4 v2, s[8:11], s24 offen offset:1024 sc1 lds
  v_mfma_f32_16x16x32_bf16 v[104:107], a[136:139], v[28:31], v[104:107]
  v_mfma_f32_16x16x32_bf16 v[108:111], a[192:195], v[28:31], v[108:111]
  s_waitcnt lgkmcnt(4)
  v_mfma_f32_16x16x32_bf16 v[112:115], a[24:27], v[32:35], v[112:115]
  ds_read_b128 v[24:27], v128 offset:9216
  v_mfma_f32_16x16x32_bf16 v[116:119], a[80:83], v[32:35], v[116:119]
  v_mfma_f32_16x16x32_bf16 v[120:123], a[136:139], v[32:35], v[120:123]
  buffer_load_dwordx4 v2, s[8:11], s24 offen offset:2048 sc1 lds
  v_mfma_f32_16x16x32_bf16 v[124:127], a[192:195], v[32:35], v[124:127]
  s_waitcnt lgkmcnt(4)
  v_mfma_f32_16x16x32_bf16 v[96:99], a[28:31], v[8:11], v[96:99]
  ds_read_b128 v[28:31], v128 offset:23552
  v_mfma_f32_16x16x32_bf16 v[100:103], a[84:87], v[8:11], v[100:103]
  v_mfma_f32_16x16x32_bf16 v[104:107], a[140:143], v[8:11], v[104:107]
  v_mfma_f32_16x16x32_bf16 v[108:111], a[196:199], v[8:11], v[108:111]
  s_waitcnt lgkmcnt(4)
  buffer_load_dwordx4 v2, s[8:11], s24 offen offset:3072 sc1 lds
  v_mfma_f32_16x16x32_bf16 v[112:115], a[28:31], v[12:15], v[112:115]
  ds_read_b128 v[32:35], v128 offset:10240
  v_mfma_f32_16x16x32_bf16 v[116:119], a[84:87], v[12:15], v[116:119]
  v_mfma_f32_16x16x32_bf16 v[120:123], a[140:143], v[12:15], v[120:123]
  v_mfma_f32_16x16x32_bf16 v[124:127], a[196:199], v[12:15], v[124:127]
  s_waitcnt lgkmcnt(4)
  v_mfma_f32_16x16x32_bf16 v[96:99], a[32:35], v[16:19], v[96:99]
  ds_read_b128 v[8:11], v128 offset:24576
  v_mfma_f32_16x16x32_bf16 v[100:103], a[88:91], v[16:19], v[100:103]
  s_add_u32 m0, m0, 4096
  s_add_u32 s24, s24, 4096
  buffer_load_dwordx4 v2, s[8:11], s24 offen offset:0 sc1 lds
  v_mfma_f32_16x16x32_bf16 v[104:107], a[144:147], v[16:19], v[104:107]
  v_mfma_f32_16x16x32_bf16 v[108:111], a[200:203], v[16:19], v[108:111]
  s_waitcnt lgkmcnt(4)
  v_mfma_f32_16x16x32_bf16 v[112:115], a[32:35], v[20:23], v[112:115]
  ds_read_b128 v[12:15], v128 offset:11264
  v_mfma_f32_16x16x32_bf16 v[116:119], a[88:91], v[20:23], v[116:119]
  v_mfma_f32_16x16x32_bf16 v[120:123], a[144:147], v[20:23], v[120:123]
  buffer_load_dwordx4 v2, s[8:11], s24 offen offset:1024 sc1 lds
  v_mfma_f32_16x16x32_bf16 v[124:127], a[200:203], v[20:23], v[124:127]
  s_waitcnt lgkmcnt(4)
  v_mfma_f32_16x16x32_bf16 v[96:99], a[36:39], v[24:27], v[96:99]
  ds_read_b128 v[16:19], v128 offset:25600
  v_mfma_f32_16x16x32_bf16 v[100:103], a[92:95], v[24:27], v[100:103]
  v_mfma_f32_16x16x32_bf16 v[104:107], a[148:151], v[24:27], v[104:107]
  v_mfma_f32_16x16x32_bf16 v[108:111], a[204:207], v[24:27], v[108:111]
  s_waitcnt lgkmcnt(4)
  buffer_load_dwordx4 v2, s[8:11], s24 offen offset:2048 sc1 lds
  v_mfma_f32_16x16x32_bf16 v[112:115], a[36:39], v[28:31], v[112:115]
  ds_read_b128 v[20:23], v128 offset:12288
  v_mfma_f32_16x16x32_bf16 v[116:119], a[92:95], v[28:31], v[116:119]
  v_mfma_f32_16x16x32_bf16 v[120:123], a[148:151], v[28:31], v[120:123]
  v_mfma_f32_16x16x32_bf16 v[124:127], a[204:207], v[28:31], v[124:127]
  s_waitcnt lgkmcnt(4)
  v_mfma_f32_16x16x32_bf16 v[96:99], a[40:43], v[32:35], v[96:99]
  ds_read_b128 v[24:27], v128 offset:26624
  v_mfma_f32_16x16x32_bf16 v[100:103], a[96:99], v[32:35], v[100:103]
  s_add_u32 s33, s33, 28672
  s_cmp_eq_u32 s33, 114688
  s_cselect_b32 s33, 0, s33
  v_mfma_f32_16x16x32_bf16 v[104:107], a[152:155], v[32:35], v[104:107]
  s_add_u32 s32, s32, 28672
  s_cmp_eq_u32 s32, 114688
  s_cselect_b32 s32, 0, s32
  v_mfma_f32_16x16x32_bf16 v[108:111], a[208:211], v[32:35], v[108:111]
  s_waitcnt lgkmcnt(4)
  v_add_u32 v5, s32, v2
  v_mfma_f32_16x16x32_bf16 v[112:115], a[40:43], v[8:11], v[112:115]
  ds_read_b128 v[28:31], v128 offset:13312
  v_mfma_f32_16x16x32_bf16 v[116:119], a[96:99], v[8:11], v[116:119]
  v_mfma_f32_16x16x32_bf16 v[120:123], a[152:155], v[8:11], v[120:123]
  v_mfma_f32_16x16x32_bf16 v[124:127], a[208:211], v[8:11], v[124:127]
  s_waitcnt lgkmcnt(4)
  v_mfma_f32_16x16x32_bf16 v[96:99], a[44:47], v[12:15], v[96:99]
  ds_read_b128 v[32:35], v128 offset:27648
  v_mfma_f32_16x16x32_bf16 v[100:103], a[100:103], v[12:15], v[100:103]
  v_mfma_f32_16x16x32_bf16 v[104:107], a[156:159], v[12:15], v[104:107]
  v_mfma_f32_16x16x32_bf16 v[108:111], a[212:215], v[12:15], v[108:111]
  s_waitcnt lgkmcnt(4)
  v_mfma_f32_16x16x32_bf16 v[112:115], a[44:47], v[16:19], v[112:115]
  s_waitcnt vmcnt(11)
  s_barrier
  ds_read_b128 v[8:11], v5 offset:0
  v_mfma_f32_16x16x32_bf16 v[116:119], a[100:103], v[16:19], v[116:119]
  v_mfma_f32_16x16x32_bf16 v[120:123], a[156:159], v[16:19], v[120:123]
  v_mfma_f32_16x16x32_bf16 v[124:127], a[212:215], v[16:19], v[124:127]
  s_waitcnt lgkmcnt(4)
  v_mfma_f32_16x16x32_bf16 v[96:99], a[48:51], v[20:23], v[96:99]
  ds_read_b128 v[12:15], v5 offset:14336
  v_mfma_f32_16x16x32_bf16 v[100:103], a[104:107], v[20:23], v[100:103]
  v_mfma_f32_16x16x32_bf16 v[104:107], a[160:163], v[20:23], v[104:107]
  v_mfma_f32_16x16x32_bf16 v[108:111], a[216:219], v[20:23], v[108:111]
  s_waitcnt lgkmcnt(4)
  v_mfma_f32_16x16x32_bf16 v[112:115], a[48:51], v[24:27], v[112:115]
  ds_read_b128 v[16:19], v5 offset:1024
  v_mfma_f32_16x16x32_bf16 v[116:119], a[104:107], v[24:27], v[116:119]
  v_mfma_f32_16x16x32_bf16 v[120:123], a[160:163], v[24:27], v[120:123]
  v_mfma_f32_16x16x32_bf16 v[124:127], a[216:219], v[24:27], v[124:127]
  s_waitcnt lgkmcnt(4)
  v_mfma_f32_16x16x32_bf16 v[96:99], a[52:55], v[28:31], v[96:99]
  ds_read_b128 v[20:23], v5 offset:15360
  v_mfma_f32_16x16x32_bf16 v[100:103], a[108:111], v[28:31], v[100:103]
  v_mfma_f32_16x16x32_bf16 v[104:107], a[164:167], v[28:31], v[104:107]
  v_mfma_f32_16x16x32_bf16 v[108:111], a[220:223], v[28:31], v[108:111]
  s_waitcnt lgkmcnt(4)
  v_mfma_f32_16x16x32_bf16 v[112:115], a[52:55], v[32:35], v[112:115]
  ds_read_b128 v[24:27], v5 offset:2048
  v_mfma_f32_16x16x32_bf16 v[116:119], a[108:111], v[32:35], v[116:119]
  v_mfma_f32_16x16x32_bf16 v[120:123], a[164:167], v[32:35], v[120:123]
  v_mfma_f32_16x16x32_bf16 v[124:127], a[220:223], v[32:35], v[124:127]
  s_waitcnt lgkmcnt(4)
  s_mov_b32 s40, s19
  s_mov_b32 s41, s29
  s_add_u32 s19, s19, 1
  s_cmp_lt_u32 s19, s35
  s_cbranch_scc1 wg_vo_loop
  s_nop 3
  s_add_u32 s43, s41, 458752
  s_lshl_b32 s42, s40, 5
  s_add_u32 s42, s42, 0
  v_add_u32 v88, s42, v4
  v_mul_u32_u24 v89, 2341, v88
  v_lshrrev_b32 v89, 16, v89
  v_mul_u32_u24 v92, 28, v89
  v_sub_u32 v92, v88, v92
  v_cmp_gt_u32 vcc, 16, v92
  v_mul_u32_u24 v89, 84, v89
  s_nop 0
  v_cndmask_b32 v92, v7, v6, vcc
  v_add3_u32 v88, v88, v89, v92
  v_lshlrev_b32 v90, 4, v88
  v_cvt_pk_bf16_f32 v72, v96, v100
  v_cvt_pk_bf16_f32 v73, v97, v101
  v_cvt_pk_bf16_f32 v74, v98, v102
  v_cvt_pk_bf16_f32 v75, v99, v103
  buffer_store_dwordx4 v[72:75], v90, s[8:11], s41 offen sc1
  v_cvt_pk_bf16_f32 v76, v104, v108
  v_cvt_pk_bf16_f32 v77, v105, v109
  v_cvt_pk_bf16_f32 v78, v106, v110
  v_cvt_pk_bf16_f32 v79, v107, v111
  buffer_store_dwordx4 v[76:79], v90, s[8:11], s43 offen sc1
  s_lshl_b32 s42, s40, 5
  s_add_u32 s42, s42, 16
  v_add_u32 v88, s42, v4
  v_mul_u32_u24 v89, 2341, v88
  v_lshrrev_b32 v89, 16, v89
  v_mul_u32_u24 v92, 28, v89
  v_sub_u32 v92, v88, v92
  v_cmp_gt_u32 vcc, 16, v92
  v_mul_u32_u24 v89, 84, v89
  s_nop 0
  v_cndmask_b32 v92, v7, v6, vcc
  v_add3_u32 v88, v88, v89, v92
  v_lshlrev_b32 v91, 4, v88
  v_cvt_pk_bf16_f32 v80, v112, v116
  v_cvt_pk_bf16_f32 v81, v113, v117
  v_cvt_pk_bf16_f32 v82, v114, v118
  v_cvt_pk_bf16_f32 v83, v115, v119
  buffer_store_dwordx4 v[80:83], v91, s[8:11], s41 offen sc1
  v_cvt_pk_bf16_f32 v84, v120, v124
  v_cvt_pk_bf16_f32 v85, v121, v125
  v_cvt_pk_bf16_f32 v86, v122, v126
  v_cvt_pk_bf16_f32 v87, v123, v127
  buffer_store_dwordx4 v[84:87], v91, s[8:11], s43 offen sc1
  s_branch wg_done
wg_vo_e0:
  s_nop 7
  s_add_u32 s43, s41, 458752
  s_lshl_b32 s42, s40, 5
  s_add_u32 s42, s42, 0
  v_add_u32 v88, s42, v4
  v_mul_u32_u24 v89, 2341, v88
  v_lshrrev_b32 v89, 16, v89
  v_mul_u32_u24 v92, 28, v89
  v_sub_u32 v92, v88, v92
  v_cmp_gt_u32 vcc, 16, v92
  v_mul_u32_u24 v89, 84, v89
  s_nop 0
  v_cndmask_b32 v92, v7, v6, vcc
  v_add3_u32 v88, v88, v89, v92
  v_lshlrev_b32 v90, 4, v88
  v_cvt_pk_bf16_f32 v72, v40, v44
  v_cvt_pk_bf16_f32 v73, v41, v45
  v_cvt_pk_bf16_f32 v74, v42, v46
  v_cvt_pk_bf16_f32 v75, v43, v47
  buffer_store_dwordx4 v[72:75], v90, s[8:11], s41 offen sc1
  v_cvt_pk_bf16_f32 v76, v48, v52
  v_cvt_pk_bf16_f32 v77, v49, v53
  v_cvt_pk_bf16_f32 v78, v50, v54
  v_cvt_pk_bf16_f32 v79, v51, v55
  buffer_store_dwordx4 v[76:79], v90, s[8:11], s43 offen sc1
  s_lshl_b32 s42, s40, 5
  s_add_u32 s42, s42, 16
  v_add_u32 v88, s42, v4
  v_mul_u32_u24 v89, 2341, v88
  v_lshrrev_b32 v89, 16, v89
  v_mul_u32_u24 v92, 28, v89
  v_sub_u32 v92, v88, v92
  v_cmp_gt_u32 vcc, 16, v92
  v_mul_u32_u24 v89, 84, v89
  s_nop 0
  v_cndmask_b32 v92, v7, v6, vcc
  v_add3_u32 v88, v88, v89, v92
  v_lshlrev_b32 v91, 4, v88
  v_cvt_pk_bf16_f32 v80, v56, v60
  v_cvt_pk_bf16_f32 v81, v57, v61
  v_cvt_pk_bf16_f32 v82, v58, v62
  v_cvt_pk_bf16_f32 v83, v59, v63
  buffer_store_dwordx4 v[80:83], v91, s[8:11], s41 offen sc1
  v_cvt_pk_bf16_f32 v84, v64, v68
  v_cvt_pk_bf16_f32 v85, v65, v69
  v_cvt_pk_bf16_f32 v86, v66, v70
  v_cvt_pk_bf16_f32 v87, v67, v71
  buffer_store_dwordx4 v[84:87], v91, s[8:11], s43 offen sc1
  s_branch wg_done
wg_done:
  s_lshl_b32 s20, s18, 4
  s_and_b32 s21, s17, 15
  s_add_u32 s20, s20, s21
  s_lshl_b32 s20, s20, 7
  s_cmp_lt_u32 s17, 16
  s_cselect_b32 s21, 16384, 0
  s_add_u32 s20, s20, s21
  s_add_u32 s20, s20, 524288
  s_sub_u32 s21, s35, s34
  s_lshl_b32 s21, s21, 2
  v_mov_b32 v5, s21
  v_mov_b32 v6, 0
  s_waitcnt vmcnt(0) lgkmcnt(0)
  s_barrier
  s_cmp_lg_u32 s16, 0
  s_cbranch_scc1 wg_sg
  s_mov_b64 exec, 1
  buffer_atomic_add v5, v6, s[8:11], s20 offen
  s_mov_b64 exec, -1
wg_sg:
  s_branch wk_loop
wk_srv:
  s_mov_b32 s96, 7
  v_mov_b32 v4, 1
  v_mov_b32 v5, 588352
  v_mov_b32 v6, 160000
  s_barrier
  s_cmp_lg_u32 s16, 0
  s_cbranch_scc1 wk_sve1
  s_mov_b64 exec, 1
  buffer_atomic_add v4, v5, s[8:11], 0 offen sc0
  s_waitcnt vmcnt(0)
  ds_write_b32 v6, v4
  s_waitcnt lgkmcnt(0)
  s_mov_b64 exec, -1
wk_sve1:
  s_barrier
  ds_read_b32 v4, v6
  s_waitcnt lgkmcnt(0)
  v_readfirstlane_b32 s3, v4
  v_and_b32 v1, 63, v0
  v_lshlrev_b32 v2, 4, v1
  v_lshrrev_b32 v3, 4, v1
  v_and_b32 v4, 15, v1
  v_mov_b32 v250, 0
  s_cmp_ge_u32 s3, 32
  s_cbranch_scc1 wk_ask
  s_and_b32 s18, s3, 15
  s_lshr_b32 s19, s3, 4
  s_and_b32 s19, s19, 1
  s_mul_i32 s20, s18, 401408
  s_mul_i32 s21, s16, 100352
  s_add_u32 s20, s20, s21
  s_add_u32 s20, s20, 39976960
  s_add_u32 s22, s20, 0
  buffer_load_dwordx4 a[0:3], v2, s[8:11], s22 offen offset:0 sc1
  buffer_load_dwordx4 a[4:7], v2, s[8:11], s22 offen offset:1024 sc1
  buffer_load_dwordx4 a[8:11], v2, s[8:11], s22 offen offset:2048 sc1
  buffer_load_dwordx4 a[12:15], v2, s[8:11], s22 offen offset:3072 sc1
  s_add_u32 s22, s20, 4096
  buffer_load_dwordx4 a[16:19], v2, s[8:11], s22 offen offset:0 sc1
  buffer_load_dwordx4 a[20:23], v2, s[8:11], s22 offen offset:1024 sc1
  buffer_load_dwordx4 a[24:27], v2, s[8:11], s22 offen offset:2048 sc1
  buffer_load_dwordx4 a[28:31], v2, s[8:11], s22 offen offset:3072 sc1
  s_add_u32 s22, s20, 8192
  buffer_load_dwordx4 a[32:35], v2, s[8:11], s22 offen offset:0 sc1
  buffer_load_dwordx4 a[36:39], v2, s[8:11], s22 offen offset:1024 sc1
  s_waitcnt vmcnt(8)
  buffer_load_dwordx4 a[40:43], v2, s[8:11], s22 offen offset:2048 sc1
  buffer_load_dwordx4 a[44:47], v2, s[8:11], s22 offen offset:3072 sc1
  s_waitcnt vmcnt(8)
  s_add_u32 s22, s20, 12288
  buffer_load_dwordx4 a[48:51], v2, s[8:11], s22 offen offset:0 sc1
  buffer_load_dwordx4 a[52:55], v2, s[8:11], s22 offen offset:1024 sc1
  s_waitcnt vmcnt(8)
  buffer_load_dwordx4 a[56:59], v2, s[8:11], s22 offen offset:2048 sc1
  buffer_load_dwordx4 a[60:63], v2, s[8:11], s22 offen offset:3072 sc1
  s_waitcnt vmcnt(8)
  s_add_u32 s22, s20, 16384
  buffer_load_dwordx4 a[64:67], v2, s[8:11], s22 offen offset:0 sc1
  buffer_load_dwordx4 a[68:71], v2, s[8:11], s22 offen offset:1024 sc1
  s_waitcnt vmcnt(8)
  buffer_load_dwordx4 a[72:75], v2, s[8:11], s22 offen offset:2048 sc1
  buffer_load_dwordx4 a[76:79], v2, s[8:11], s22 offen offset:3072 sc1
  s_waitcnt vmcnt(8)
  s_add_u32 s22, s20, 20480
  buffer_load_dwordx4 a[80:83], v2, s[8:11], s22 offen offset:0 sc1
  buffer_load_dwordx4 a[84:87], v2, s[8:11], s22 offen offset:1024 sc1
  s_waitcnt vmcnt(8)
  buffer_load_dwordx4 a[88:91], v2, s[8:11], s22 offen offset:2048 sc1
  buffer_load_dwordx4 a[92:95], v2, s[8:11], s22 offen offset:3072 sc1
  s_waitcnt vmcnt(8)
  s_add_u32 s22, s20, 24576
  buffer_load_dwordx4 a[96:99], v2, s[8:11], s22 offen offset:0 sc1
  buffer_load_dwordx4 a[100:103], v2, s[8:11], s22 offen offset:1024 sc1
  s_waitcnt vmcnt(8)
  buffer_load_dwordx4 a[104:107], v2, s[8:11], s22 offen offset:2048 sc1
  buffer_load_dwordx4 a[108:111], v2, s[8:11], s22 offen offset:3072 sc1
  s_waitcnt vmcnt(8)
  s_add_u32 s22, s20, 28672
  buffer_load_dwordx4 a[112:115], v2, s[8:11], s22 offen offset:0 sc1
  buffer_load_dwordx4 a[116:119], v2, s[8:11], s22 offen offset:1024 sc1
  s_waitcnt vmcnt(8)
  buffer_load_dwordx4 a[120:123], v2, s[8:11], s22 offen offset:2048 sc1
  buffer_load_dwordx4 a[124:127], v2, s[8:11], s22 offen offset:3072 sc1
  s_waitcnt vmcnt(8)
  s_add_u32 s22, s20, 32768
  buffer_load_dwordx4 a[128:131], v2, s[8:11], s22 offen offset:0 sc1
  buffer_load_dwordx4 a[132:135], v2, s[8:11], s22 offen offset:1024 sc1
  s_waitcnt vmcnt(8)
  buffer_load_dwordx4 a[136:139], v2, s[8:11], s22 offen offset:2048 sc1
  buffer_load_dwordx4 a[140:143], v2, s[8:11], s22 offen offset:3072 sc1
  s_waitcnt vmcnt(8)
  s_add_u32 s22, s20, 36864
  buffer_load_dwordx4 a[144:147], v2, s[8:11], s22 offen offset:0 sc1
  buffer_load_dwordx4 a[148:151], v2, s[8:11], s22 offen offset:1024 sc1
  s_waitcnt vmcnt(8)
  buffer_load_dwordx4 a[152:155], v2, s[8:11], s22 offen offset:2048 sc1
  buffer_load_dwordx4 a[156:159], v2, s[8:11], s22 offen offset:3072 sc1
  s_waitcnt vmcnt(8)
  s_add_u32 s22, s20, 40960
  buffer_load_dwordx4 a[160:163], v2, s[8:11], s22 offen offset:0 sc1
  buffer_load_dwordx4 a[164:167], v2, s[8:11], s22 offen offset:1024 sc1
  s_waitcnt vmcnt(8)
  buffer_load_dwordx4 a[168:171], v2, s[8:11], s22 offen offset:2048 sc1
  buffer_load_dwordx4 a[172:175], v2, s[8:11], s22 offen offset:3072 sc1
  s_waitcnt vmcnt(8)
  s_add_u32 s22, s20, 45056
  buffer_load_dwordx4 a[176:179], v2, s[8:11], s22 offen offset:0 sc1
  buffer_load_dwordx4 a[180:183], v2, s[8:11], s22 offen offset:1024 sc1
  s_waitcnt vmcnt(8)
  buffer_load_dwordx4 a[184:187], v2, s[8:11], s22 offen offset:2048 sc1
  buffer_load_dwordx4 a[188:191], v2, s[8:11], s22 offen offset:3072 sc1
  s_waitcnt vmcnt(8)
  s_add_u32 s22, s20, 49152
  buffer_load_dwordx4 a[192:195], v2, s[8:11], s22 offen offset:0 sc1
  buffer_load_dwordx4 a[196:199], v2, s[8:11], s22 offen offset:1024 sc1
  s_waitcnt vmcnt(8)
  buffer_load_dwordx4 a[200:203], v2, s[8:11], s22 offen offset:2048 sc1
  buffer_load_dwordx4 a[204:207], v2, s[8:11], s22 offen offset:3072 sc1
  s_waitcnt vmcnt(8)
  s_add_u32 s22, s20, 53248
  buffer_load_dwordx4 a[208:211], v2, s[8:11], s22 offen offset:0 sc1
  buffer_load_dwordx4 a[212:215], v2, s[8:11], s22 offen offset:1024 sc1
  s_waitcnt vmcnt(8)
  buffer_load_dwordx4 a[216:219], v2, s[8:11], s22 offen offset:2048 sc1
  buffer_load_dwordx4 a[220:223], v2, s[8:11], s22 offen offset:3072 sc1
  s_waitcnt vmcnt(8)
  s_add_u32 s22, s20, 57344
  buffer_load_dwordx4 a[224:227], v2, s[8:11], s22 offen offset:0 sc1
  buffer_load_dwordx4 a[228:231], v2, s[8:11], s22 offen offset:1024 sc1
  s_waitcnt vmcnt(8)
  buffer_load_dwordx4 a[232:235], v2, s[8:11], s22 offen offset:2048 sc1
  buffer_load_dwordx4 a[236:239], v2, s[8:11], s22 offen offset:3072 sc1
  s_waitcnt vmcnt(8)
  s_add_u32 s22, s20, 61440
  buffer_load_dwordx4 a[240:243], v2, s[8:11], s22 offen offset:0 sc1
  buffer_load_dwordx4 a[244:247], v2, s[8:11], s22 offen offset:1024 sc1
  s_waitcnt vmcnt(8)
  buffer_load_dwordx4 a[248:251], v2, s[8:11], s22 offen offset:2048 sc1
  buffer_load_dwordx4 a[252:255], v2, s[8:11], s22 offen offset:3072 sc1
  s_waitcnt vmcnt(8)
  s_add_u32 s22, s20, 65536
  buffer_load_dwordx4 v[120:123], v2, s[8:11], s22 offen offset:0 sc1
  buffer_load_dwordx4 v[124:127], v2, s[8:11], s22 offen offset:1024 sc1
  s_waitcnt vmcnt(8)
  buffer_load_dwordx4 v[128:131], v2, s[8:11], s22 offen offset:2048 sc1
  buffer_load_dwordx4 v[132:135], v2, s[8:11], s22 offen offset:3072 sc1
  s_waitcnt vmcnt(8)
  s_add_u32 s22, s20, 69632
  buffer_load_dwordx4 v[136:139], v2, s[8:11], s22 offen offset:0 sc1
  buffer_load_dwordx4 v[140:143], v2, s[8:11], s22 offen offset:1024 sc1
  s_waitcnt vmcnt(8)
  buffer_load_dwordx4 v[144:147], v2, s[8:11], s22 offen offset:2048 sc1
  buffer_load_dwordx4 v[148:151], v2, s[8:11], s22 offen offset:3072 sc1
  s_waitcnt vmcnt(8)
  s_add_u32 s22, s20, 73728
  buffer_load_dwordx4 v[152:155], v2, s[8:11], s22 offen offset:0 sc1
  buffer_load_dwordx4 v[156:159], v2, s[8:11], s22 offen offset:1024 sc1
  s_waitcnt vmcnt(8)
  buffer_load_dwordx4 v[160:163], v2, s[8:11], s22 offen offset:2048 sc1
  buffer_load_dwordx4 v[164:167], v2, s[8:11], s22 offen offset:3072 sc1
  s_waitcnt vmcnt(8)
  s_add_u32 s22, s20, 77824
  buffer_load_dwordx4 v[168:171], v2, s[8:11], s22 offen offset:0 sc1
  buffer_load_dwordx4 v[172:175], v2, s[8:11], s22 offen offset:1024 sc1
  s_waitcnt vmcnt(8)
  buffer_load_dwordx4 v[176:179], v2, s[8:11], s22 offen offset:2048 sc1
  buffer_load_dwordx4 v[180:183], v2, s[8:11], s22 offen offset:3072 sc1
  s_waitcnt vmcnt(8)
  s_add_u32 s22, s20, 81920
  buffer_load_dwordx4 v[184:187], v2, s[8:11], s22 offen offset:0 sc1
  buffer_load_dwordx4 v[188:191], v2, s[8:11], s22 offen offset:1024 sc1
  s_waitcnt vmcnt(8)
  buffer_load_dwordx4 v[192:195], v2, s[8:11], s22 offen offset:2048 sc1
  buffer_load_dwordx4 v[196:199], v2, s[8:11], s22 offen offset:3072 sc1
  s_waitcnt vmcnt(8)
  s_add_u32 s22, s20, 86016
  buffer_load_dwordx4 v[200:203], v2, s[8:11], s22 offen offset:0 sc1
  buffer_load_dwordx4 v[204:207], v2, s[8:11], s22 offen offset:1024 sc1
  s_waitcnt vmcnt(8)
  buffer_load_dwordx4 v[208:211], v2, s[8:11], s22 offen offset:2048 sc1
  buffer_load_dwordx4 v[212:215], v2, s[8:11], s22 offen offset:3072 sc1
  s_waitcnt vmcnt(8)
  s_add_u32 s22, s20, 90112
  buffer_load_dwordx4 v[216:219], v2, s[8:11], s22 offen offset:0 sc1
  buffer_load_dwordx4 v[220:223], v2, s[8:11], s22 offen offset:1024 sc1
  s_waitcnt vmcnt(8)
  buffer_load_dwordx4 v[224:227], v2, s[8:11], s22 offen offset:2048 sc1
  buffer_load_dwordx4 v[228:231], v2, s[8:11], s22 offen offset:3072 sc1
  s_waitcnt vmcnt(8)
  s_add_u32 s22, s20, 94208
  buffer_load_dwordx4 v[232:235], v2, s[8:11], s22 offen offset:0 sc1
  buffer_load_dwordx4 v[236:239], v2, s[8:11], s22 offen offset:1024 sc1
  s_waitcnt vmcnt(8)
  buffer_load_dwordx4 v[240:243], v2, s[8:11], s22 offen offset:2048 sc1
  buffer_load_dwordx4 v[244:247], v2, s[8:11], s22 offen offset:3072 sc1
  s_waitcnt vmcnt(8)
  s_add_u32 s22, s20, 98304
  buffer_load_dwordx4 v[248:251], v2, s[8:11], s22 offen offset:0 sc1
  buffer_load_dwordx4 v[252:255], v2, s[8:11], s22 offen offset:1024 sc1
  s_waitcnt vmcnt(8)
  v_mov_b32 v5, 0x4444
  v_mov_b32 v6, 0xeeee
  v_cmp_lt_u32 vcc, 7, v4
  s_nop 1
  v_cndmask_b32 v5, v5, v6, vcc
  s_lshl_b32 s23, s16, 11
  v_lshrrev_b32 v80, 1, v3
  v_and_b32 v81, 1, v3
  v_add_u32 v82, 0, v80
  v_lshl_add_u32 v82, v82, 4, v4
  v_mul_u32_u24 v83, 2341, v82
  v_lshrrev_b32 v83, 16, v83
  v_mul_u32_u24 v84, 28, v83
  v_sub_u32 v84, v82, v84
  v_lshrrev_b32 v85, 4, v84
  v_and_b32 v84, 15, v84
  v_lshlrev_b32 v86, 10, v85
  v_lshl_add_u32 v86, v83, 8, v86
  v_lshl_add_u32 v86, v84, 4, v86
  v_lshl_add_u32 v86, v81, 3, v86
  v_add_u32 v72, s23, v86
  v_add_u32 v82, 2, v80
  v_lshl_add_u32 v82, v82, 4, v4
  v_mul_u32_u24 v83, 2341, v82
  v_lshrrev_b32 v83, 16, v83
  v_mul_u32_u24 v84, 28, v83
  v_sub_u32 v84, v82, v84
  v_lshrrev_b32 v85, 4, v84
  v_and_b32 v84, 15, v84
  v_lshlrev_b32 v86, 10, v85
  v_lshl_add_u32 v86, v83, 8, v86
  v_lshl_add_u32 v86, v84, 4, v86
  v_lshl_add_u32 v86, v81, 3, v86
  v_add_u32 v73, s23, v86
  v_add_u32 v82, 4, v80
  v_lshl_add_u32 v82, v82, 4, v4
  v_mul_u32_u24 v83, 2341, v82
  v_lshrrev_b32 v83, 16, v83
  v_mul_u32_u24 v84, 28, v83
  v_sub_u32 v84, v82, v84
  v_lshrrev_b32 v85, 4, v84
  v_and_b32 v84, 15, v84
  v_lshlrev_b32 v86, 10, v85
  v_lshl_add_u32 v86, v83, 8, v86
  v_lshl_add_u32 v86, v84, 4, v86
  v_lshl_add_u32 v86, v81, 3, v86
  v_add_u32 v74, s23, v86
  v_mov_b32 v82, 6
  v_lshl_add_u32 v82, v82, 4, v4
  v_mul_u32_u24 v83, 2341, v82
  v_lshrrev_b32 v83, 16, v83
  v_mul_u32_u24 v84, 28, v83
  v_sub_u32 v84, v82, v84
  v_lshrrev_b32 v85, 4, v84
  v_and_b32 v84, 15, v84
  v_lshlrev_b32 v86, 10, v85
  v_lshl_add_u32 v86, v83, 8, v86
  v_lshl_add_u32 v86, v84, 4, v86
  v_lshl_add_u32 v86, v81, 3, v86
  v_add_u32 v75, s23, v86
  v_add_u32 v76, s23, v2
  s_mul_i32 s27, s18, 448
  v_mov_b32 v77, s27
  v_mov_b32 v78, 1
  s_mov_b32 s17, s19
  s_mul_i32 s24, s19, 7168
  s_add_u32 s24, s24, 65536
  s_mul_i32 s25, s18, 65
  s_add_u32 s25, s25, s19
  s_lshl_b32 s25, s25, 13
  s_add_u32 s25, s25, s23
  s_add_u32 s25, s25, 77602816
  s_lshl_b32 s26, s18, 6
  s_add_u32 s26, s26, s19
  s_lshl_b32 s26, s26, 4
  s_lshl_b32 s27, s16, 2
  s_add_u32 s26, s26, s27
  s_add_u32 s26, s26, 565248
  v_mov_b32 v88, 0
  v_mov_b32 v89, 0
  v_mov_b32 v90, 0
  v_mov_b32 v91, 0
  v_mov_b32 v92, -1
  v_mov_b32 v93, -1
  v_mov_b32 v94, -1
  v_mov_b32 v95, -1
  ds_write_b128 v76, v[88:91]
  ds_write_b128 v76, v[88:91] offset:1024
  s_mov_b32 s28, s25
  s_mov_b32 s29, 0
ws_arm:
  buffer_store_dwordx4 v[92:95], v2, s[8:11], s28 offen sc1
  buffer_store_dwordx4 v[92:95], v2, s[8:11], s28 offen offset:1024 sc1
  s_waitcnt vmcnt(8)
  s_add_u32 s28, s28, 16384
  s_add_u32 s29, s29, 1
  s_cmp_lt_u32 s29, 31
  s_cbranch_scc1 ws_arm
  s_waitcnt vmcnt(0)
  s_mov_b64 exec, 1
  buffer_store_dword v78, v2, s[8:11], s26 offen sc1
  s_mov_b64 exec, -1
ws_loop:
  v_mov_b32 v36, 0
  v_mov_b32 v37, 0
  v_mov_b32 v38, 0
  v_mov_b32 v39, 0
  v_mov_b32 v40, 0
  v_mov_b32 v41, 0
  v_mov_b32 v42, 0
  v_mov_b32 v43, 0
  v_mov_b32 v44, 0
  v_mov_b32 v45, 0
  v_mov_b32 v46, 0
  v_mov_b32 v47, 0
  v_mov_b32 v48, 0
  v_mov_b32 v49, 0
  v_mov_b32 v50, 0
  v_mov_b32 v51, 0
  v_mov_b32 v52, 0
  v_mov_b32 v53, 0
  v_mov_b32 v54, 0
  v_mov_b32 v55, 0
  v_mov_b32 v56, 0
  v_mov_b32 v57, 0
  v_mov_b32 v58, 0
  v_mov_b32 v59, 0
  v_mov_b32 v60, 0
  v_mov_b32 v61, 0
  v_mov_b32 v62, 0
  v_mov_b32 v63, 0
  s_mov_b32 s30, 0
  s_branch ws_fl
ws_pm:
  s_cmp_ge_u32 s17, 64
  s_cbranch_scc1 ws_fl
  buffer_load_dword v79, v77, s[8:11], s24 offen sc1
  s_waitcnt vmcnt(0)
  v_cmp_eq_u32 vcc, -1, v79
  s_cbranch_vccnz ws_pr
ws_fl:
  s_add_u32 s22, s24, 4096
  buffer_load_dwordx4 v[8:11], v2, s[8:11], s24 offen offset:0 sc1
  buffer_load_dwordx4 v[12:15], v2, s[8:11], s24 offen offset:1024 sc1
  buffer_load_dwordx4 v[16:19], v2, s[8:11], s24 offen offset:2048 sc1
  buffer_load_dwordx4 v[20:23], v2, s[8:11], s24 offen offset:3072 sc1
  buffer_load_dwordx4 v[24:27], v2, s[8:11], s22 offen offset:0 sc1
  buffer_load_dwordx4 v[28:31], v2, s[8:11], s22 offen offset:1024 sc1
  buffer_load_dwordx4 v[32:35], v2, s[8:11], s22 offen offset:2048 sc1
  s_waitcnt vmcnt(0)
  v_max_u32 v79, v8, v9
  v_max3_u32 v79, v79, v10, v11
  v_max3_u32 v79, v79, v12, v13
  v_max3_u32 v79, v79, v14, v15
  v_max3_u32 v79, v79, v16, v17
  v_max3_u32 v79, v79, v18, v19
  v_max3_u32 v79, v79, v20, v21
  v_max3_u32 v79, v79, v22, v23
  v_max3_u32 v79, v79, v24, v25
  v_max3_u32 v79, v79, v26, v27
  v_max3_u32 v79, v79, v28, v29
  v_max3_u32 v79, v79, v30, v31
  v_max3_u32 v79, v79, v32, v33
  v_max3_u32 v79, v79, v34, v35
  v_cmp_eq_u32 vcc, -1, v79
  s_cbranch_vccz ws_pk
ws_pr:
  s_sleep 20
  s_add_u32 s30, s30, 1
  s_cmp_lt_u32 s30, 2000000
  s_cbranch_scc1 ws_pm
  s_branch cA_abort
ws_pk:
  v_smfmac_f32_16x16x64_bf16 v[36:39], v[8:11], a[0:7], v5
  v_smfmac_f32_16x16x64_bf16 v[36:39], v[12:15], a[8:15], v5
  v_smfmac_f32_16x16x64_bf16 v[36:39], v[16:19], a[16:23], v5
  v_smfmac_f32_16x16x64_bf16 v[36:39], v[20:23], a[24:31], v5
  v_smfmac_f32_16x16x64_bf16 v[36:39], v[24:27], a[32:39], v5
  v_smfmac_f32_16x16x64_bf16 v[36:39], v[28:31], a[40:47], v5
  v_smfmac_f32_16x16x64_bf16 v[36:39], v[32:35], a[48:55], v5
  v_smfmac_f32_16x16x64_bf16 v[40:43], v[8:11], a[56:63], v5
  v_smfmac_f32_16x16x64_bf16 v[40:43], v[12:15], a[64:71], v5
  v_smfmac_f32_16x16x64_bf16 v[40:43], v[16:19], a[72:79], v5
  v_smfmac_f32_16x16x64_bf16 v[40:43], v[20:23], a[80:87], v5
  v_smfmac_f32_16x16x64_bf16 v[40:43], v[24:27], a[88:95], v5
  v_smfmac_f32_16x16x64_bf16 v[40:43], v[28:31], a[96:103], v5
  v_smfmac_f32_16x16x64_bf16 v[40:43], v[32:35], a[104:111], v5
  v_smfmac_f32_16x16x64_bf16 v[44:47], v[8:11], a[112:119], v5
  v_smfmac_f32_16x16x64_bf16 v[44:47], v[12:15], a[120:127], v5
  v_smfmac_f32_16x16x64_bf16 v[44:47], v[16:19], a[128:135], v5
  v_smfmac_f32_16x16x64_bf16 v[44:47], v[20:23], a[136:143], v5
  v_smfmac_f32_16x16x64_bf16 v[44:47], v[24:27], a[144:151], v5
  v_smfmac_f32_16x16x64_bf16 v[44:47], v[28:31], a[152:159], v5
  v_smfmac_f32_16x16x64_bf16 v[44:47], v[32:35], a[160:167], v5
  v_smfmac_f32_16x16x64_bf16 v[48:51], v[8:11], a[168:175], v5
  v_smfmac_f32_16x16x64_bf16 v[48:51], v[12:15], a[176:183], v5
  v_smfmac_f32_16x16x64_bf16 v[48:51], v[16:19], a[184:191], v5
  v_smfmac_f32_16x16x64_bf16 v[48:51], v[20:23], a[192:199], v5
  v_smfmac_f32_16x16x64_bf16 v[48:51], v[24:27], a[200:207], v5
  v_smfmac_f32_16x16x64_bf16 v[48:51], v[28:31], a[208:215], v5
  v_smfmac_f32_16x16x64_bf16 v[48:51], v[32:35], a[216:223], v5
  v_smfmac_f32_16x16x64_bf16 v[52:55], v[8:11], a[224:231], v5
  v_smfmac_f32_16x16x64_bf16 v[52:55], v[12:15], a[232:239], v5
  v_smfmac_f32_16x16x64_bf16 v[52:55], v[16:19], a[240:247], v5
  v_smfmac_f32_16x16x64_bf16 v[52:55], v[20:23], a[248:255], v5
  v_smfmac_f32_16x16x64_bf16 v[52:55], v[24:27], v[120:127], v5
  v_smfmac_f32_16x16x64_bf16 v[52:55], v[28:31], v[128:135], v5
  v_smfmac_f32_16x16x64_bf16 v[52:55], v[32:35], v[136:143], v5
  v_smfmac_f32_16x16x64_bf16 v[56:59], v[8:11], v[144:151], v5
  v_smfmac_f32_16x16x64_bf16 v[56:59], v[12:15], v[152:159], v5
  v_smfmac_f32_16x16x64_bf16 v[56:59], v[16:19], v[160:167], v5
  v_smfmac_f32_16x16x64_bf16 v[56:59], v[20:23], v[168:175], v5
  v_smfmac_f32_16x16x64_bf16 v[56:59], v[24:27], v[176:183], v5
  v_smfmac_f32_16x16x64_bf16 v[56:59], v[28:31], v[184:191], v5
  v_smfmac_f32_16x16x64_bf16 v[56:59], v[32:35], v[192:199], v5
  v_smfmac_f32_16x16x64_bf16 v[60:63], v[8:11], v[200:207], v5
  v_smfmac_f32_16x16x64_bf16 v[60:63], v[12:15], v[208:215], v5
  v_smfmac_f32_16x16x64_bf16 v[60:63], v[16:19], v[216:223], v5
  v_smfmac_f32_16x16x64_bf16 v[60:63], v[20:23], v[224:231], v5
  v_smfmac_f32_16x16x64_bf16 v[60:63], v[24:27], v[232:239], v5
  v_smfmac_f32_16x16x64_bf16 v[60:63], v[28:31], v[240:247], v5
  v_smfmac_f32_16x16x64_bf16 v[60:63], v[32:35], v[248:255], v5
  v_permlane32_swap_b32 v36, v40
  v_permlane32_swap_b32 v37, v41
  v_permlane32_swap_b32 v38, v42
  v_permlane32_swap_b32 v39, v43
  v_add_f32 v36, v36, v40
  v_add_f32 v37, v37, v41
  v_add_f32 v38, v38, v42
  v_add_f32 v39, v39, v43
  v_cvt_pk_bf16_f32 v40, v36, v37
  v_cvt_pk_bf16_f32 v41, v38, v39
  v_min_u32 v40, -2, v40
  v_min_u32 v41, -2, v41
  ds_write_b64 v72, v[40:41]
  v_permlane32_swap_b32 v44, v48
  v_permlane32_swap_b32 v45, v49
  v_permlane32_swap_b32 v46, v50
  v_permlane32_swap_b32 v47, v51
  v_add_f32 v44, v44, v48
  v_add_f32 v45, v45, v49
  v_add_f32 v46, v46, v50
  v_add_f32 v47, v47, v51
  v_cvt_pk_bf16_f32 v48, v44, v45
  v_cvt_pk_bf16_f32 v49, v46, v47
  v_min_u32 v48, -2, v48
  v_min_u32 v49, -2, v49
  ds_write_b64 v73, v[48:49]
  v_permlane32_swap_b32 v52, v56
  v_permlane32_swap_b32 v53, v57
  v_permlane32_swap_b32 v54, v58
  v_permlane32_swap_b32 v55, v59
  v_add_f32 v52, v52, v56
  v_add_f32 v53, v53, v57
  v_add_f32 v54, v54, v58
  v_add_f32 v55, v55, v59
  v_cvt_pk_bf16_f32 v56, v52, v53
  v_cvt_pk_bf16_f32 v57, v54, v55
  v_min_u32 v56, -2, v56
  v_min_u32 v57, -2, v57
  ds_write_b64 v74, v[56:57]
  v_mov_b32 v64, v60
  v_mov_b32 v65, v61
  v_mov_b32 v66, v62
  v_mov_b32 v67, v63
  v_permlane32_swap_b32 v60, v64
  v_permlane32_swap_b32 v61, v65
  v_permlane32_swap_b32 v62, v66
  v_permlane32_swap_b32 v63, v67
  v_add_f32 v60, v60, v64
  v_add_f32 v61, v61, v65
  v_add_f32 v62, v62, v66
  v_add_f32 v63, v63, v67
  v_cvt_pk_bf16_f32 v64, v60, v61
  v_cvt_pk_bf16_f32 v65, v62, v63
  v_min_u32 v64, -2, v64
  v_min_u32 v65, -2, v65
  ds_write_b64 v75, v[64:65]
  s_waitcnt lgkmcnt(0)
  ds_read_b128 v[64:67], v76
  ds_read_b128 v[68:71], v76 offset:1024
  s_waitcnt lgkmcnt(0)
  buffer_store_dwordx4 v[64:67], v2, s[8:11], s25 offen sc1
  buffer_store_dwordx4 v[68:71], v2, s[8:11], s25 offen offset:1024 sc1
  s_add_u32 s24, s24, 14336
  s_add_u32 s25, s25, 16384
  s_add_u32 s17, s17, 2
  s_cmp_lt_u32 s17, 62
  s_cbranch_scc1 ws_loop
  v_mov_b32 v250, 0
  s_branch wk_loop
wk_s4d:
  s_sub_u32 s3, s3, 640
  s_getreg_b32 s33, hwreg(HW_REG_XCC_ID)
  s_sub_u32 s33, s33, 2
  s_and_b32 s33, s33, 7
  s_min_u32 s33, s33, 6
  s_mov_b32 s35, 6
wk_s4c:
  s_lshl_b32 s34, s33, 7
  s_add_u32 s34, s34, 588416
  v_mov_b32 v4, 1
  v_mov_b32 v5, s34
  v_mov_b32 v6, 160000
  s_barrier
  s_cmp_lg_u32 s16, 0
  s_cbranch_scc1 wk_s4e1
  s_mov_b64 exec, 1
  buffer_atomic_add v4, v5, s[8:11], 0 offen sc0
  s_waitcnt vmcnt(0)
  ds_write_b32 v6, v4
  s_waitcnt lgkmcnt(0)
  s_mov_b64 exec, -1
wk_s4e1:
  s_barrier
  ds_read_b32 v4, v6
  s_waitcnt lgkmcnt(0)
  v_readfirstlane_b32 s3, v4
  s_cmp_lt_u32 s3, 16
  s_cbranch_scc1 wk_s4g
  s_mov_b32 s33, s35
  s_sub_u32 s35, s35, 1
  s_max_i32 s35, s35, 0
  s_branch wk_s4c
wk_s4g:
  s_lshl_b32 s33, s33, 4
  s_add_u32 s3, s3, s33
  s_load_dwordx8 s[40:47], s[0:1], 0
  s_load_dwordx4 s[48:51], s[0:1], 32
  s_load_dwordx2 s[52:53], s[0:1], 48
  s_load_dwordx2 s[54:55], s[0:1], 112
  v_lshrrev_b32 v1, 6, v0
  s_nop 0
  v_readfirstlane_b32 s16, v1
  v_and_b32 v1, 63, v0
  v_lshrrev_b32 v3, 4, v1
  v_and_b32 v4, 15, v1
  s_mul_i32 s17, s16, 24576
  s_waitcnt lgkmcnt(0)
  s_mov_b32 s60, s40
  s_and_b32 s61, s41, 0xffff
  s_mov_b32 s62, 1835008
  s_mov_b32 s63, 0x20000
  s_mov_b32 s64, s42
  s_and_b32 s65, s43, 0xffff
  s_mov_b32 s66, 229376
  s_mov_b32 s67, 0x20000
  s_mov_b32 s68, s44
  s_and_b32 s69, s45, 0xffff
  s_mov_b32 s70, 229376
  s_mov_b32 s71, 0x20000
  s_mov_b32 s72, s46
  s_and_b32 s73, s47, 0xffff
  s_mov_b32 s74, 229376
  s_mov_b32 s75, 0x20000
  s_mov_b32 s76, s48
  s_and_b32 s77, s49, 0xffff
  s_mov_b32 s78, 229376
  s_mov_b32 s79, 0x20000
  s_mov_b32 s80, s50
  s_and_b32 s81, s51, 0xffff
  s_mov_b32 s82, 896
  s_mov_b32 s83, 0x20000
  s_mov_b32 s84, s52
  s_and_b32 s85, s53, 0xffff
  s_mov_b32 s86, 896
  s_mov_b32 s87, 0x20000
  s_mov_b32 s88, s54
  s_and_b32 s89, s55, 0xffff
  s_mov_b32 s90, 3670016
  s_mov_b32 s91, 0x20000
  v_lshlrev_b32 v5, 5, v1
  v_sub_u32 v5, 2047, v5
  s_add_u32 s18, s17, 13056
  v_subrev_u32 v6, 0, v5
  v_max_i32 v7, 0, v6
  v_cvt_f32_u32 v7, v7
  v_cvt_pk_bf16_f32 v8, v7, v7
  v_and_b32 v7, 0xffff0000, v8
  v_lshrrev_b32 v8, 23, v7
  v_subrev_u32 v8, 134, v8
  v_max_i32 v8, 0, v8
  v_cvt_u32_f32 v7, v7
  v_lshrrev_b32 v7, v8, v7
  v_lshl_add_u32 v7, v8, 8, v7
  v_lshl_add_u32 v200, v7, 2, s18
  v_subrev_u32 v6, 1, v5
  v_max_i32 v7, 0, v6
  v_cvt_f32_u32 v7, v7
  v_cvt_pk_bf16_f32 v8, v7, v7
  v_and_b32 v7, 0xffff0000, v8
  v_lshrrev_b32 v8, 23, v7
  v_subrev_u32 v8, 134, v8
  v_max_i32 v8, 0, v8
  v_cvt_u32_f32 v7, v7
  v_lshrrev_b32 v7, v8, v7
  v_lshl_add_u32 v7, v8, 8, v7
  v_lshl_add_u32 v201, v7, 2, s18
  v_subrev_u32 v6, 2, v5
  v_max_i32 v7, 0, v6
  v_cvt_f32_u32 v7, v7
  v_cvt_pk_bf16_f32 v8, v7, v7
  v_and_b32 v7, 0xffff0000, v8
  v_lshrrev_b32 v8, 23, v7
  v_subrev_u32 v8, 134, v8
  v_max_i32 v8, 0, v8
  v_cvt_u32_f32 v7, v7
  v_lshrrev_b32 v7, v8, v7
  v_lshl_add_u32 v7, v8, 8, v7
  v_lshl_add_u32 v202, v7, 2, s18
  v_subrev_u32 v6, 3, v5
  v_max_i32 v7, 0, v6
  v_cvt_f32_u32 v7, v7
  v_cvt_pk_bf16_f32 v8, v7, v7
  v_and_b32 v7, 0xffff0000, v8
  v_lshrrev_b32 v8, 23, v7
  v_subrev_u32 v8, 134, v8
  v_max_i32 v8, 0, v8
  v_cvt_u32_f32 v7, v7
  v_lshrrev_b32 v7, v8, v7
  v_lshl_add_u32 v7, v8, 8, v7
  v_lshl_add_u32 v203, v7, 2, s18
  v_subrev_u32 v6, 4, v5
  v_max_i32 v7, 0, v6
  v_cvt_f32_u32 v7, v7
  v_cvt_pk_bf16_f32 v8, v7, v7
  v_and_b32 v7, 0xffff0000, v8
  v_lshrrev_b32 v8, 23, v7
  v_subrev_u32 v8, 134, v8
  v_max_i32 v8, 0, v8
  v_cvt_u32_f32 v7, v7
  v_lshrrev_b32 v7, v8, v7
  v_lshl_add_u32 v7, v8, 8, v7
  v_lshl_add_u32 v204, v7, 2, s18
  v_subrev_u32 v6, 5, v5
  v_max_i32 v7, 0, v6
  v_cvt_f32_u32 v7, v7
  v_cvt_pk_bf16_f32 v8, v7, v7
  v_and_b32 v7, 0xffff0000, v8
  v_lshrrev_b32 v8, 23, v7
  v_subrev_u32 v8, 134, v8
  v_max_i32 v8, 0, v8
  v_cvt_u32_f32 v7, v7
  v_lshrrev_b32 v7, v8, v7
  v_lshl_add_u32 v7, v8, 8, v7
  v_lshl_add_u32 v205, v7, 2, s18
  v_subrev_u32 v6, 6, v5
  v_max_i32 v7, 0, v6
  v_cvt_f32_u32 v7, v7
  v_cvt_pk_bf16_f32 v8, v7, v7
  v_and_b32 v7, 0xffff0000, v8
  v_lshrrev_b32 v8, 23, v7
  v_subrev_u32 v8, 134, v8
  v_max_i32 v8, 0, v8
  v_cvt_u32_f32 v7, v7
  v_lshrrev_b32 v7, v8, v7
  v_lshl_add_u32 v7, v8, 8, v7
  v_lshl_add_u32 v206, v7, 2, s18
  v_subrev_u32 v6, 7, v5
  v_max_i32 v7, 0, v6
  v_cvt_f32_u32 v7, v7
  v_cvt_pk_bf16_f32 v8, v7, v7
  v_and_b32 v7, 0xffff0000, v8
  v_lshrrev_b32 v8, 23, v7
  v_subrev_u32 v8, 134, v8
  v_max_i32 v8, 0, v8
  v_cvt_u32_f32 v7, v7
  v_lshrrev_b32 v7, v8, v7
  v_lshl_add_u32 v7, v8, 8, v7
  v_lshl_add_u32 v207, v7, 2, s18
  v_subrev_u32 v6, 8, v5
  v_max_i32 v7, 0, v6
  v_cvt_f32_u32 v7, v7
  v_cvt_pk_bf16_f32 v8, v7, v7
  v_and_b32 v7, 0xffff0000, v8
  v_lshrrev_b32 v8, 23, v7
  v_subrev_u32 v8, 134, v8
  v_max_i32 v8, 0, v8
  v_cvt_u32_f32 v7, v7
  v_lshrrev_b32 v7, v8, v7
  v_lshl_add_u32 v7, v8, 8, v7
  v_lshl_add_u32 v208, v7, 2, s18
  v_subrev_u32 v6, 9, v5
  v_max_i32 v7, 0, v6
  v_cvt_f32_u32 v7, v7
  v_cvt_pk_bf16_f32 v8, v7, v7
  v_and_b32 v7, 0xffff0000, v8
  v_lshrrev_b32 v8, 23, v7
  v_subrev_u32 v8, 134, v8
  v_max_i32 v8, 0, v8
  v_cvt_u32_f32 v7, v7
  v_lshrrev_b32 v7, v8, v7
  v_lshl_add_u32 v7, v8, 8, v7
  v_lshl_add_u32 v209, v7, 2, s18
  v_subrev_u32 v6, 10, v5
  v_max_i32 v7, 0, v6
  v_cvt_f32_u32 v7, v7
  v_cvt_pk_bf16_f32 v8, v7, v7
  v_and_b32 v7, 0xffff0000, v8
  v_lshrrev_b32 v8, 23, v7
  v_subrev_u32 v8, 134, v8
  v_max_i32 v8, 0, v8
  v_cvt_u32_f32 v7, v7
  v_lshrrev_b32 v7, v8, v7
  v_lshl_add_u32 v7, v8, 8, v7
  v_lshl_add_u32 v210, v7, 2, s18
  v_subrev_u32 v6, 11, v5
  v_max_i32 v7, 0, v6
  v_cvt_f32_u32 v7, v7
  v_cvt_pk_bf16_f32 v8, v7, v7
  v_and_b32 v7, 0xffff0000, v8
  v_lshrrev_b32 v8, 23, v7
  v_subrev_u32 v8, 134, v8
  v_max_i32 v8, 0, v8
  v_cvt_u32_f32 v7, v7
  v_lshrrev_b32 v7, v8, v7
  v_lshl_add_u32 v7, v8, 8, v7
  v_lshl_add_u32 v211, v7, 2, s18
  v_subrev_u32 v6, 12, v5
  v_max_i32 v7, 0, v6
  v_cvt_f32_u32 v7, v7
  v_cvt_pk_bf16_f32 v8, v7, v7
  v_and_b32 v7, 0xffff0000, v8
  v_lshrrev_b32 v8, 23, v7
  v_subrev_u32 v8, 134, v8
  v_max_i32 v8, 0, v8
  v_cvt_u32_f32 v7, v7
  v_lshrrev_b32 v7, v8, v7
  v_lshl_add_u32 v7, v8, 8, v7
  v_lshl_add_u32 v212, v7, 2, s18
  v_subrev_u32 v6, 13, v5
  v_max_i32 v7, 0, v6
  v_cvt_f32_u32 v7, v7
  v_cvt_pk_bf16_f32 v8, v7, v7
  v_and_b32 v7, 0xffff0000, v8
  v_lshrrev_b32 v8, 23, v7
  v_subrev_u32 v8, 134, v8
  v_max_i32 v8, 0, v8
  v_cvt_u32_f32 v7, v7
  v_lshrrev_b32 v7, v8, v7
  v_lshl_add_u32 v7, v8, 8, v7
  v_lshl_add_u32 v213, v7, 2, s18
  v_subrev_u32 v6, 14, v5
  v_max_i32 v7, 0, v6
  v_cvt_f32_u32 v7, v7
  v_cvt_pk_bf16_f32 v8, v7, v7
  v_and_b32 v7, 0xffff0000, v8
  v_lshrrev_b32 v8, 23, v7
  v_subrev_u32 v8, 134, v8
  v_max_i32 v8, 0, v8
  v_cvt_u32_f32 v7, v7
  v_lshrrev_b32 v7, v8, v7
  v_lshl_add_u32 v7, v8, 8, v7
  v_lshl_add_u32 v214, v7, 2, s18
  v_subrev_u32 v6, 15, v5
  v_max_i32 v7, 0, v6
  v_cvt_f32_u32 v7, v7
  v_cvt_pk_bf16_f32 v8, v7, v7
  v_and_b32 v7, 0xffff0000, v8
  v_lshrrev_b32 v8, 23, v7
  v_subrev_u32 v8, 134, v8
  v_max_i32 v8, 0, v8
  v_cvt_u32_f32 v7, v7
  v_lshrrev_b32 v7, v8, v7
  v_lshl_add_u32 v7, v8, 8, v7
  v_lshl_add_u32 v215, v7, 2, s18
  v_subrev_u32 v6, 16, v5
  v_max_i32 v7, 0, v6
  v_cvt_f32_u32 v7, v7
  v_cvt_pk_bf16_f32 v8, v7, v7
  v_and_b32 v7, 0xffff0000, v8
  v_lshrrev_b32 v8, 23, v7
  v_subrev_u32 v8, 134, v8
  v_max_i32 v8, 0, v8
  v_cvt_u32_f32 v7, v7
  v_lshrrev_b32 v7, v8, v7
  v_lshl_add_u32 v7, v8, 8, v7
  v_lshl_add_u32 v216, v7, 2, s18
  v_subrev_u32 v6, 17, v5
  v_max_i32 v7, 0, v6
  v_cvt_f32_u32 v7, v7
  v_cvt_pk_bf16_f32 v8, v7, v7
  v_and_b32 v7, 0xffff0000, v8
  v_lshrrev_b32 v8, 23, v7
  v_subrev_u32 v8, 134, v8
  v_max_i32 v8, 0, v8
  v_cvt_u32_f32 v7, v7
  v_lshrrev_b32 v7, v8, v7
  v_lshl_add_u32 v7, v8, 8, v7
  v_lshl_add_u32 v217, v7, 2, s18
  v_subrev_u32 v6, 18, v5
  v_max_i32 v7, 0, v6
  v_cvt_f32_u32 v7, v7
  v_cvt_pk_bf16_f32 v8, v7, v7
  v_and_b32 v7, 0xffff0000, v8
  v_lshrrev_b32 v8, 23, v7
  v_subrev_u32 v8, 134, v8
  v_max_i32 v8, 0, v8
  v_cvt_u32_f32 v7, v7
  v_lshrrev_b32 v7, v8, v7
  v_lshl_add_u32 v7, v8, 8, v7
  v_lshl_add_u32 v218, v7, 2, s18
  v_subrev_u32 v6, 19, v5
  v_max_i32 v7, 0, v6
  v_cvt_f32_u32 v7, v7
  v_cvt_pk_bf16_f32 v8, v7, v7
  v_and_b32 v7, 0xffff0000, v8
  v_lshrrev_b32 v8, 23, v7
  v_subrev_u32 v8, 134, v8
  v_max_i32 v8, 0, v8
  v_cvt_u32_f32 v7, v7
  v_lshrrev_b32 v7, v8, v7
  v_lshl_add_u32 v7, v8, 8, v7
  v_lshl_add_u32 v219, v7, 2, s18
  v_subrev_u32 v6, 20, v5
  v_max_i32 v7, 0, v6
  v_cvt_f32_u32 v7, v7
  v_cvt_pk_bf16_f32 v8, v7, v7
  v_and_b32 v7, 0xffff0000, v8
  v_lshrrev_b32 v8, 23, v7
  v_subrev_u32 v8, 134, v8
  v_max_i32 v8, 0, v8
  v_cvt_u32_f32 v7, v7
  v_lshrrev_b32 v7, v8, v7
  v_lshl_add_u32 v7, v8, 8, v7
  v_lshl_add_u32 v220, v7, 2, s18
  v_subrev_u32 v6, 21, v5
  v_max_i32 v7, 0, v6
  v_cvt_f32_u32 v7, v7
  v_cvt_pk_bf16_f32 v8, v7, v7
  v_and_b32 v7, 0xffff0000, v8
  v_lshrrev_b32 v8, 23, v7
  v_subrev_u32 v8, 134, v8
  v_max_i32 v8, 0, v8
  v_cvt_u32_f32 v7, v7
  v_lshrrev_b32 v7, v8, v7
  v_lshl_add_u32 v7, v8, 8, v7
  v_lshl_add_u32 v221, v7, 2, s18
  v_subrev_u32 v6, 22, v5
  v_max_i32 v7, 0, v6
  v_cvt_f32_u32 v7, v7
  v_cvt_pk_bf16_f32 v8, v7, v7
  v_and_b32 v7, 0xffff0000, v8
  v_lshrrev_b32 v8, 23, v7
  v_subrev_u32 v8, 134, v8
  v_max_i32 v8, 0, v8
  v_cvt_u32_f32 v7, v7
  v_lshrrev_b32 v7, v8, v7
  v_lshl_add_u32 v7, v8, 8, v7
  v_lshl_add_u32 v222, v7, 2, s18
  v_subrev_u32 v6, 23, v5
  v_max_i32 v7, 0, v6
  v_cvt_f32_u32 v7, v7
  v_cvt_pk_bf16_f32 v8, v7, v7
  v_and_b32 v7, 0xffff0000, v8
  v_lshrrev_b32 v8, 23, v7
  v_subrev_u32 v8, 134, v8
  v_max_i32 v8, 0, v8
  v_cvt_u32_f32 v7, v7
  v_lshrrev_b32 v7, v8, v7
  v_lshl_add_u32 v7, v8, 8, v7
  v_lshl_add_u32 v223, v7, 2, s18
  v_subrev_u32 v6, 24, v5
  v_max_i32 v7, 0, v6
  v_cvt_f32_u32 v7, v7
  v_cvt_pk_bf16_f32 v8, v7, v7
  v_and_b32 v7, 0xffff0000, v8
  v_lshrrev_b32 v8, 23, v7
  v_subrev_u32 v8, 134, v8
  v_max_i32 v8, 0, v8
  v_cvt_u32_f32 v7, v7
  v_lshrrev_b32 v7, v8, v7
  v_lshl_add_u32 v7, v8, 8, v7
  v_lshl_add_u32 v224, v7, 2, s18
  v_subrev_u32 v6, 25, v5
  v_max_i32 v7, 0, v6
  v_cvt_f32_u32 v7, v7
  v_cvt_pk_bf16_f32 v8, v7, v7
  v_and_b32 v7, 0xffff0000, v8
  v_lshrrev_b32 v8, 23, v7
  v_subrev_u32 v8, 134, v8
  v_max_i32 v8, 0, v8
  v_cvt_u32_f32 v7, v7
  v_lshrrev_b32 v7, v8, v7
  v_lshl_add_u32 v7, v8, 8, v7
  v_lshl_add_u32 v225, v7, 2, s18
  v_subrev_u32 v6, 26, v5
  v_max_i32 v7, 0, v6
  v_cvt_f32_u32 v7, v7
  v_cvt_pk_bf16_f32 v8, v7, v7
  v_and_b32 v7, 0xffff0000, v8
  v_lshrrev_b32 v8, 23, v7
  v_subrev_u32 v8, 134, v8
  v_max_i32 v8, 0, v8
  v_cvt_u32_f32 v7, v7
  v_lshrrev_b32 v7, v8, v7
  v_lshl_add_u32 v7, v8, 8, v7
  v_lshl_add_u32 v226, v7, 2, s18
  v_subrev_u32 v6, 27, v5
  v_max_i32 v7, 0, v6
  v_cvt_f32_u32 v7, v7
  v_cvt_pk_bf16_f32 v8, v7, v7
  v_and_b32 v7, 0xffff0000, v8
  v_lshrrev_b32 v8, 23, v7
  v_subrev_u32 v8, 134, v8
  v_max_i32 v8, 0, v8
  v_cvt_u32_f32 v7, v7
  v_lshrrev_b32 v7, v8, v7
  v_lshl_add_u32 v7, v8, 8, v7
  v_lshl_add_u32 v227, v7, 2, s18
  v_subrev_u32 v6, 28, v5
  v_max_i32 v7, 0, v6
  v_cvt_f32_u32 v7, v7
  v_cvt_pk_bf16_f32 v8, v7, v7
  v_and_b32 v7, 0xffff0000, v8
  v_lshrrev_b32 v8, 23, v7
  v_subrev_u32 v8, 134, v8
  v_max_i32 v8, 0, v8
  v_cvt_u32_f32 v7, v7
  v_lshrrev_b32 v7, v8, v7
  v_lshl_add_u32 v7, v8, 8, v7
  v_lshl_add_u32 v228, v7, 2, s18
  v_subrev_u32 v6, 29, v5
  v_max_i32 v7, 0, v6
  v_cvt_f32_u32 v7, v7
  v_cvt_pk_bf16_f32 v8, v7, v7
  v_and_b32 v7, 0xffff0000, v8
  v_lshrrev_b32 v8, 23, v7
  v_subrev_u32 v8, 134, v8
  v_max_i32 v8, 0, v8
  v_cvt_u32_f32 v7, v7
  v_lshrrev_b32 v7, v8, v7
  v_lshl_add_u32 v7, v8, 8, v7
  v_lshl_add_u32 v229, v7, 2, s18
  v_subrev_u32 v6, 30, v5
  v_max_i32 v7, 0, v6
  v_cvt_f32_u32 v7, v7
  v_cvt_pk_bf16_f32 v8, v7, v7
  v_and_b32 v7, 0xffff0000, v8
  v_lshrrev_b32 v8, 23, v7
  v_subrev_u32 v8, 134, v8
  v_max_i32 v8, 0, v8
  v_cvt_u32_f32 v7, v7
  v_lshrrev_b32 v7, v8, v7
  v_lshl_add_u32 v7, v8, 8, v7
  v_lshl_add_u32 v230, v7, 2, s18
  v_subrev_u32 v6, 31, v5
  v_max_i32 v7, 0, v6
  v_cvt_f32_u32 v7, v7
  v_cvt_pk_bf16_f32 v8, v7, v7
  v_and_b32 v7, 0xffff0000, v8
  v_lshrrev_b32 v8, 23, v7
  v_subrev_u32 v8, 134, v8
  v_max_i32 v8, 0, v8
  v_cvt_u32_f32 v7, v7
  v_lshrrev_b32 v7, v8, v7
  v_lshl_add_u32 v7, v8, 8, v7
  v_lshl_add_u32 v231, v7, 2, s18
  v_subrev_u32 v6, 32, v5
  v_max_i32 v7, 0, v6
  v_cvt_f32_u32 v7, v7
  v_cvt_pk_bf16_f32 v8, v7, v7
  v_and_b32 v7, 0xffff0000, v8
  v_lshrrev_b32 v8, 23, v7
  v_subrev_u32 v8, 134, v8
  v_max_i32 v8, 0, v8
  v_cvt_u32_f32 v7, v7
  v_lshrrev_b32 v7, v8, v7
  v_lshl_add_u32 v7, v8, 8, v7
  v_mov_b32 v8, 1280
  v_cmp_gt_i32 vcc, 0, v6
  s_nop 1
  v_cndmask_b32 v7, v7, v8, vcc
  v_lshl_add_u32 v232, v7, 2, s18
  v_mov_b32 v8, 0
  v_mov_b32 v9, 0
  v_lshlrev_b32 v5, 3, v1
  v_add_u32 v5, s17, v5
  ds_write_b64 v5, v[8:9]
  v_and_b32 v6, 15, v1
  v_lshlrev_b32 v6, 3, v6
  v_add_u32 v6, s17, v6
  ds_write_b64 v6, v[8:9] offset:8704
  ds_write_b64 v6, v[8:9] offset:12928
  v_mov_b32 v6, s17
  ds_write_b64 v6, v[8:9] offset:18176
  s_lshl_b32 s19, s3, 2
  s_add_u32 s20, s19, s16
  s_lshl_b32 s21, s3, 3
  v_mul_u32_u24 v5, 3584, v0
  s_add_u32 s22, s21, 0
  buffer_load_dwordx2 v[8:9], v5, s[60:63], s22 offen offset:0
  buffer_load_dwordx2 v[10:11], v5, s[60:63], s22 offen offset:896
  buffer_load_dwordx2 v[12:13], v5, s[60:63], s22 offen offset:1792
  buffer_load_dwordx2 v[14:15], v5, s[60:63], s22 offen offset:2688
  s_add_u32 s22, s21, 917504
  buffer_load_dwordx2 v[16:17], v5, s[60:63], s22 offen offset:0
  buffer_load_dwordx2 v[18:19], v5, s[60:63], s22 offen offset:896
  buffer_load_dwordx2 v[20:21], v5, s[60:63], s22 offen offset:1792
  buffer_load_dwordx2 v[22:23], v5, s[60:63], s22 offen offset:2688
  s_lshl_b32 s22, s20, 9
  v_lshlrev_b32 v6, 3, v1
  buffer_load_dwordx2 v[24:25], v6, s[64:67], s22 offen
  buffer_load_dwordx2 v[26:27], v6, s[68:71], s22 offen
  buffer_load_dwordx2 v[28:29], v6, s[72:75], s22 offen
  buffer_load_dwordx2 v[30:31], v6, s[76:79], s22 offen
  s_lshl_b32 s22, s20, 1
  v_mov_b32 v7, 0
  buffer_load_ushort v32, v7, s[80:83], s22 offen
  buffer_load_ushort v33, v7, s[84:87], s22 offen
  s_mov_b32 s24, 0x05040100
  s_mov_b32 s25, 0x07060302
  s_barrier
  s_waitcnt vmcnt(6)
  v_lshlrev_b32 v6, 3, v0
  v_perm_b32 v34, v10, v8, s24
  v_perm_b32 v35, v14, v12, s24
  v_add_u32 v36, 512, v6
  ds_write_b64 v36, v[34:35]
  v_perm_b32 v34, v10, v8, s25
  v_perm_b32 v35, v14, v12, s25
  v_add_u32 v36, 25088, v6
  ds_write_b64 v36, v[34:35]
  v_perm_b32 v34, v11, v9, s24
  v_perm_b32 v35, v15, v13, s24
  v_add_u32 v36, 49664, v6
  ds_write_b64 v36, v[34:35]
  v_perm_b32 v34, v11, v9, s25
  v_perm_b32 v35, v15, v13, s25
  v_add_u32 v36, 74240, v6
  ds_write_b64 v36, v[34:35]
  v_perm_b32 v34, v18, v16, s24
  v_perm_b32 v35, v22, v20, s24
  v_add_u32 v36, 2560, v6
  ds_write_b64 v36, v[34:35]
  v_perm_b32 v34, v18, v16, s25
  v_perm_b32 v35, v22, v20, s25
  v_add_u32 v36, 27136, v6
  ds_write_b64 v36, v[34:35]
  v_perm_b32 v34, v19, v17, s24
  v_perm_b32 v35, v23, v21, s24
  v_add_u32 v36, 51712, v6
  ds_write_b64 v36, v[34:35]
  v_perm_b32 v34, v19, v17, s25
  v_perm_b32 v35, v23, v21, s25
  v_add_u32 v36, 76288, v6
  ds_write_b64 v36, v[34:35]
  s_waitcnt vmcnt(0)
  s_mov_b32 s26, 1069066811
  s_mov_b32 s27, 1042479491
  v_lshlrev_b32 v32, 16, v32
  v_lshlrev_b32 v33, 16, v33
  v_mul_f32 v32, s26, v32
  v_exp_f32 v32, v32
  s_nop 0
  v_cvt_pk_bf16_f32 v34, v32, v32
  v_and_b32 v32, 0xffff0000, v34
  v_lshlrev_b32 v37, 6, v1
  v_add_u32 v37, s17, v37
  v_lshlrev_b32 v40, 16, v24
  v_lshlrev_b32 v41, 16, v26
  v_lshlrev_b32 v42, 16, v28
  v_lshlrev_b32 v43, 16, v30
  v_mul_f32 v40, s26, v40
  v_exp_f32 v40, v40
  s_nop 0
  v_cvt_pk_bf16_f32 v34, v40, v40
  v_and_b32 v40, 0xffff0000, v34
  v_mul_f32 v40, v40, v32
  v_mul_f32 v40, s26, v40
  v_sub_f32 v40, 0, v40
  v_mul_f32 v41, v41, v32
  v_mul_f32 v41, s27, v41
  v_mul_f32 v42, v42, v32
  v_mul_f32 v43, v43, v32
  v_add_f32 v42, v42, v42
  v_add_f32 v43, v43, v43
  ds_write_b128 v37, v[40:43] offset:18240
  v_and_b32 v40, 0xffff0000, v24
  v_and_b32 v41, 0xffff0000, v26
  v_and_b32 v42, 0xffff0000, v28
  v_and_b32 v43, 0xffff0000, v30
  v_mul_f32 v40, s26, v40
  v_exp_f32 v40, v40
  s_nop 0
  v_cvt_pk_bf16_f32 v34, v40, v40
  v_and_b32 v40, 0xffff0000, v34
  v_mul_f32 v40, v40, v32
  v_mul_f32 v40, s26, v40
  v_sub_f32 v40, 0, v40
  v_mul_f32 v41, v41, v32
  v_mul_f32 v41, s27, v41
  v_mul_f32 v42, v42, v32
  v_mul_f32 v43, v43, v32
  v_add_f32 v42, v42, v42
  v_add_f32 v43, v43, v43
  ds_write_b128 v37, v[40:43] offset:18256
  v_lshlrev_b32 v40, 16, v25
  v_lshlrev_b32 v41, 16, v27
  v_lshlrev_b32 v42, 16, v29
  v_lshlrev_b32 v43, 16, v31
  v_mul_f32 v40, s26, v40
  v_exp_f32 v40, v40
  s_nop 0
  v_cvt_pk_bf16_f32 v34, v40, v40
  v_and_b32 v40, 0xffff0000, v34
  v_mul_f32 v40, v40, v32
  v_mul_f32 v40, s26, v40
  v_sub_f32 v40, 0, v40
  v_mul_f32 v41, v41, v32
  v_mul_f32 v41, s27, v41
  v_mul_f32 v42, v42, v32
  v_mul_f32 v43, v43, v32
  v_add_f32 v42, v42, v42
  v_add_f32 v43, v43, v43
  ds_write_b128 v37, v[40:43] offset:18272
  v_and_b32 v40, 0xffff0000, v25
  v_and_b32 v41, 0xffff0000, v27
  v_and_b32 v42, 0xffff0000, v29
  v_and_b32 v43, 0xffff0000, v31
  v_mul_f32 v40, s26, v40
  v_exp_f32 v40, v40
  s_nop 0
  v_cvt_pk_bf16_f32 v34, v40, v40
  v_and_b32 v40, 0xffff0000, v34
  v_mul_f32 v40, v40, v32
  v_mul_f32 v40, s26, v40
  v_sub_f32 v40, 0, v40
  v_mul_f32 v41, v41, v32
  v_mul_f32 v41, s27, v41
  v_mul_f32 v42, v42, v32
  v_mul_f32 v43, v43, v32
  v_add_f32 v42, v42, v42
  v_add_f32 v43, v43, v43
  ds_write_b128 v37, v[40:43] offset:18288
  v_cvt_f32_u32 v44, v4
  v_lshlrev_b32 v45, 4, v4
  v_cvt_f32_u32 v45, v45
  v_lshlrev_b32 v46, 4, v3
  v_add_u32 v46, s17, v46
  v_mov_b32 v48, 0
  v_mov_b32 v49, 0
  v_mov_b32 v50, 0
  v_mov_b32 v51, 0
  v_mov_b32 v52, 0
  v_mov_b32 v53, 0
  v_mov_b32 v54, 0
  v_mov_b32 v55, 0
  v_mov_b32 v56, 0
  v_mov_b32 v57, 0
  v_mov_b32 v58, 0
  v_mov_b32 v59, 0
  v_mov_b32 v60, 0
  v_mov_b32 v61, 0
  v_mov_b32 v62, 0
  v_mov_b32 v63, 0
  v_mov_b32 v64, 0
  v_mov_b32 v65, 0
  v_mov_b32 v66, 0
  v_mov_b32 v67, 0
  s_mov_b32 s28, 0
  s_waitcnt lgkmcnt(0)
  ds_read_b128 v[68:71], v46 offset:18240
wk_kl:
  s_waitcnt lgkmcnt(0)
  v_mov_b32 v72, v68
  v_mov_b32 v73, v69
  v_mov_b32 v74, v70
  v_mov_b32 v75, v71
  v_add_u32 v46, 64, v46
  ds_read_b128 v[68:71], v46 offset:18240
  v_mul_f32 v80, v72, v45
  v_mul_f32 v81, v73, v45
  v_exp_f32 v80, v80
  v_fract_f32 v81, v81
  v_cos_f32 v76, v81
  v_sin_f32 v77, v81
  v_mul_f32 v76, v76, v80
  v_mul_f32 v77, v77, v80
  v_mul_f32 v80, v72, v44
  v_mul_f32 v81, v73, v44
  v_exp_f32 v80, v80
  v_fract_f32 v81, v81
  v_cos_f32 v78, v81
  v_sin_f32 v79, v81
  v_mul_f32 v78, v78, v80
  v_mul_f32 v79, v79, v80
  v_mul_f32 v82, v74, v76
  v_mul_f32 v83, v74, v77
  v_fma_f32 v82, -v75, v77, v82
  v_fma_f32 v83, -v75, v76, -v83
  v_mul_f32 v86, v76, v76
  v_mul_f32 v87, v76, v77
  v_fma_f32 v86, -v77, v77, v86
  v_add_f32 v87, v87, v87
  v_mfma_f32_16x16x4_f32 v[48:51], v82, v78, v[48:51]
  v_mul_f32 v88, v78, v78
  v_mul_f32 v89, v78, v79
  v_fma_f32 v88, -v79, v79, v88
  v_add_f32 v89, v89, v89
  v_mfma_f32_16x16x4_f32 v[48:51], v83, v79, v[48:51]
  v_mul_f32 v84, v74, v86
  v_mul_f32 v85, v74, v87
  v_fma_f32 v84, -v75, v87, v84
  v_fma_f32 v85, -v75, v86, -v85
  v_mul_f32 v76, v86, v86
  v_mul_f32 v77, v86, v87
  v_fma_f32 v76, -v87, v87, v76
  v_add_f32 v77, v77, v77
  v_mfma_f32_16x16x4_f32 v[52:55], v84, v88, v[52:55]
  v_mul_f32 v78, v88, v88
  v_mul_f32 v79, v88, v89
  v_fma_f32 v78, -v89, v89, v78
  v_add_f32 v79, v79, v79
  v_mfma_f32_16x16x4_f32 v[52:55], v85, v89, v[52:55]
  v_mul_f32 v82, v74, v76
  v_mul_f32 v83, v74, v77
  v_fma_f32 v82, -v75, v77, v82
  v_fma_f32 v83, -v75, v76, -v83
  v_mul_f32 v86, v76, v76
  v_mul_f32 v87, v76, v77
  v_fma_f32 v86, -v77, v77, v86
  v_add_f32 v87, v87, v87
  v_mfma_f32_16x16x4_f32 v[56:59], v82, v78, v[56:59]
  v_mul_f32 v88, v78, v78
  v_mul_f32 v89, v78, v79
  v_fma_f32 v88, -v79, v79, v88
  v_add_f32 v89, v89, v89
  v_mfma_f32_16x16x4_f32 v[56:59], v83, v79, v[56:59]
  v_mul_f32 v84, v74, v86
  v_mul_f32 v85, v74, v87
  v_fma_f32 v84, -v75, v87, v84
  v_fma_f32 v85, -v75, v86, -v85
  v_mul_f32 v76, v86, v86
  v_mul_f32 v77, v86, v87
  v_fma_f32 v76, -v87, v87, v76
  v_add_f32 v77, v77, v77
  v_mfma_f32_16x16x4_f32 v[60:63], v84, v88, v[60:63]
  v_mfma_f32_16x16x4_f32 v[60:63], v85, v89, v[60:63]
  v_mul_f32 v82, v74, v76
  v_fma_f32 v82, -v75, v77, v82
  s_nop 1
  v_mfma_f32_16x16x4_f32 v[64:67], v82, v88, v[64:67]
  s_add_u32 s28, s28, 1
  s_cmp_lt_u32 s28, 64
  s_cbranch_scc1 wk_kl
  s_nop 15
  s_nop 3
  v_lshlrev_b32 v46, 8, v3
  v_lshl_add_u32 v46, v4, 2, v46
  v_add_u32 v46, s17, v46
  ds_write_b32 v46, v48 offset:13056
  ds_write_b32 v46, v49 offset:13120
  ds_write_b32 v46, v50 offset:13184
  ds_write_b32 v46, v51 offset:13248
  s_waitcnt lgkmcnt(8)
  ds_write_b32 v46, v52 offset:14080
  ds_write_b32 v46, v53 offset:14144
  ds_write_b32 v46, v54 offset:14208
  ds_write_b32 v46, v55 offset:14272
  s_waitcnt lgkmcnt(8)
  ds_write_b32 v46, v56 offset:15104
  ds_write_b32 v46, v57 offset:15168
  ds_write_b32 v46, v58 offset:15232
  ds_write_b32 v46, v59 offset:15296
  s_waitcnt lgkmcnt(8)
  ds_write_b32 v46, v60 offset:16128
  ds_write_b32 v46, v61 offset:16192
  ds_write_b32 v46, v62 offset:16256
  ds_write_b32 v46, v63 offset:16320
  s_waitcnt lgkmcnt(8)
  ds_write_b32 v46, v64 offset:17152
  ds_write_b32 v46, v65 offset:17216
  ds_write_b32 v46, v66 offset:17280
  ds_write_b32 v46, v67 offset:17344
  s_waitcnt lgkmcnt(8)
  s_waitcnt lgkmcnt(0)
  ds_read_b32 v48, v200
  ds_read_b32 v49, v201
  ds_read_b32 v50, v202
  ds_read_b32 v51, v203
  ds_read_b32 v52, v204
  ds_read_b32 v53, v205
  ds_read_b32 v54, v206
  ds_read_b32 v55, v207
  s_waitcnt lgkmcnt(4)
  ds_read_b32 v56, v208
  ds_read_b32 v57, v209
  ds_read_b32 v58, v210
  ds_read_b32 v59, v211
  ds_read_b32 v60, v212
  ds_read_b32 v61, v213
  ds_read_b32 v62, v214
  ds_read_b32 v63, v215
  s_waitcnt lgkmcnt(4)
  ds_read_b32 v64, v216
  ds_read_b32 v65, v217
  ds_read_b32 v66, v218
  ds_read_b32 v67, v219
  ds_read_b32 v68, v220
  ds_read_b32 v69, v221
  ds_read_b32 v70, v222
  ds_read_b32 v71, v223
  s_waitcnt lgkmcnt(4)
  ds_read_b32 v72, v224
  ds_read_b32 v73, v225
  ds_read_b32 v74, v226
  ds_read_b32 v75, v227
  ds_read_b32 v76, v228
  ds_read_b32 v77, v229
  ds_read_b32 v78, v230
  ds_read_b32 v79, v231
  s_waitcnt lgkmcnt(4)
  ds_read_b32 v80, v232
  s_waitcnt lgkmcnt(0)
  v_lshlrev_b32 v46, 6, v1
  v_add_u32 v46, s17, v46
  v_cvt_pk_bf16_f32 v84, v48, v49
  v_cvt_pk_bf16_f32 v88, v49, v50
  v_cvt_pk_bf16_f32 v85, v50, v51
  v_cvt_pk_bf16_f32 v89, v51, v52
  v_cvt_pk_bf16_f32 v86, v52, v53
  v_cvt_pk_bf16_f32 v90, v53, v54
  v_cvt_pk_bf16_f32 v87, v54, v55
  v_cvt_pk_bf16_f32 v91, v55, v56
  ds_write_b128 v46, v[84:87] offset:4608
  ds_write_b128 v46, v[88:91] offset:8832
  s_waitcnt lgkmcnt(0)
  v_cvt_pk_bf16_f32 v84, v56, v57
  v_cvt_pk_bf16_f32 v88, v57, v58
  v_cvt_pk_bf16_f32 v85, v58, v59
  v_cvt_pk_bf16_f32 v89, v59, v60
  v_cvt_pk_bf16_f32 v86, v60, v61
  v_cvt_pk_bf16_f32 v90, v61, v62
  v_cvt_pk_bf16_f32 v87, v62, v63
  v_cvt_pk_bf16_f32 v91, v63, v64
  ds_write_b128 v46, v[84:87] offset:4624
  ds_write_b128 v46, v[88:91] offset:8848
  s_waitcnt lgkmcnt(0)
  v_cvt_pk_bf16_f32 v84, v64, v65
  v_cvt_pk_bf16_f32 v88, v65, v66
  v_cvt_pk_bf16_f32 v85, v66, v67
  v_cvt_pk_bf16_f32 v89, v67, v68
  v_cvt_pk_bf16_f32 v86, v68, v69
  v_cvt_pk_bf16_f32 v90, v69, v70
  v_cvt_pk_bf16_f32 v87, v70, v71
  v_cvt_pk_bf16_f32 v91, v71, v72
  ds_write_b128 v46, v[84:87] offset:4640
  ds_write_b128 v46, v[88:91] offset:8864
  s_waitcnt lgkmcnt(0)
  v_cvt_pk_bf16_f32 v84, v72, v73
  v_cvt_pk_bf16_f32 v88, v73, v74
  v_cvt_pk_bf16_f32 v85, v74, v75
  v_cvt_pk_bf16_f32 v89, v75, v76
  v_cvt_pk_bf16_f32 v86, v76, v77
  v_cvt_pk_bf16_f32 v90, v77, v78
  v_cvt_pk_bf16_f32 v87, v78, v79
  v_cvt_pk_bf16_f32 v91, v79, v80
  ds_write_b128 v46, v[84:87] offset:4656
  ds_write_b128 v46, v[88:91] offset:8880
  s_waitcnt lgkmcnt(0)
  s_barrier
  v_lshrrev_b32 v47, 1, v3
  v_sub_u32 v46, v4, v47
  v_add_u32 v46, 1, v46
  v_lshlrev_b32 v46, 5, v46
  v_and_b32 v48, 1, v3
  v_lshl_add_u32 v46, v48, 4, v46
  v_add_u32 v46, s17, v46
  ds_read_b128 a[0:3], v46 offset:32
  ds_read_b128 a[4:7], v46 offset:96
  ds_read_b128 a[8:11], v46 offset:160
  ds_read_b128 a[12:15], v46 offset:224
  ds_read_b128 a[16:19], v46 offset:288
  ds_read_b128 a[20:23], v46 offset:352
  ds_read_b128 a[24:27], v46 offset:416
  ds_read_b128 a[28:31], v46 offset:480
  s_waitcnt lgkmcnt(4)
  ds_read_b128 a[32:35], v46 offset:544
  ds_read_b128 a[36:39], v46 offset:608
  ds_read_b128 a[40:43], v46 offset:672
  ds_read_b128 a[44:47], v46 offset:736
  ds_read_b128 a[48:51], v46 offset:800
  ds_read_b128 a[52:55], v46 offset:864
  ds_read_b128 a[56:59], v46 offset:928
  ds_read_b128 a[60:63], v46 offset:992
  s_waitcnt lgkmcnt(4)
  ds_read_b128 a[64:67], v46 offset:1056
  ds_read_b128 a[68:71], v46 offset:1120
  ds_read_b128 a[72:75], v46 offset:1184
  ds_read_b128 a[76:79], v46 offset:1248
  ds_read_b128 a[80:83], v46 offset:1312
  ds_read_b128 a[84:87], v46 offset:1376
  ds_read_b128 a[88:91], v46 offset:1440
  ds_read_b128 a[92:95], v46 offset:1504
  s_waitcnt lgkmcnt(4)
  ds_read_b128 a[96:99], v46 offset:1568
  ds_read_b128 a[100:103], v46 offset:1632
  ds_read_b128 a[104:107], v46 offset:1696
  ds_read_b128 a[108:111], v46 offset:1760
  ds_read_b128 a[112:115], v46 offset:1824
  ds_read_b128 a[116:119], v46 offset:1888
  ds_read_b128 a[120:123], v46 offset:1952
  ds_read_b128 a[124:127], v46 offset:2016
  s_waitcnt lgkmcnt(4)
  ds_read_b128 a[128:131], v46 offset:2080
  ds_read_b128 a[132:135], v46 offset:2144
  ds_read_b128 a[136:139], v46 offset:2208
  ds_read_b128 a[140:143], v46 offset:2272
  ds_read_b128 a[144:147], v46 offset:2336
  ds_read_b128 a[148:151], v46 offset:2400
  ds_read_b128 a[152:155], v46 offset:2464
  ds_read_b128 a[156:159], v46 offset:2528
  s_waitcnt lgkmcnt(4)
  ds_read_b128 a[160:163], v46 offset:2592
  ds_read_b128 a[164:167], v46 offset:2656
  ds_read_b128 a[168:171], v46 offset:2720
  ds_read_b128 a[172:175], v46 offset:2784
  ds_read_b128 a[176:179], v46 offset:2848
  ds_read_b128 a[180:183], v46 offset:2912
  ds_read_b128 a[184:187], v46 offset:2976
  ds_read_b128 a[188:191], v46 offset:3040
  s_waitcnt lgkmcnt(4)
  ds_read_b128 a[192:195], v46 offset:3104
  ds_read_b128 a[196:199], v46 offset:3168
  ds_read_b128 a[200:203], v46 offset:3232
  ds_read_b128 a[204:207], v46 offset:3296
  ds_read_b128 a[208:211], v46 offset:3360
  ds_read_b128 a[212:215], v46 offset:3424
  ds_read_b128 a[216:219], v46 offset:3488
  ds_read_b128 a[220:223], v46 offset:3552
  s_waitcnt lgkmcnt(4)
  ds_read_b128 a[224:227], v46 offset:3616
  ds_read_b128 a[228:231], v46 offset:3680
  ds_read_b128 a[232:235], v46 offset:3744
  ds_read_b128 a[236:239], v46 offset:3808
  ds_read_b128 a[240:243], v46 offset:3872
  ds_read_b128 a[244:247], v46 offset:3936
  ds_read_b128 a[248:251], v46 offset:4000
  ds_read_b128 a[252:255], v46 offset:4064
  s_waitcnt lgkmcnt(4)
  v_lshlrev_b32 v49, 4, v47
  v_add_u32 v49, v49, v4
  v_sub_u32 v49, 2047, v49
  v_lshl_add_u32 v49, v48, 3, v49
  v_and_b32 v50, 1, v49
  v_lshrrev_b32 v49, 1, v49
  v_lshlrev_b32 v49, 2, v49
  v_mul_u32_u24 v50, 4224, v50
  v_add3_u32 v49, v49, v50, s17
  v_add_u32 v49, 4608, v49
  v_subrev_u32 v52, 896, v49
  v_subrev_u32 v53, 1856, v49
  v_subrev_u32 v54, 2816, v49
  v_subrev_u32 v55, 3776, v49
  v_subrev_u32 v56, 4736, v49
  s_waitcnt lgkmcnt(0)
  ds_read2_b32 v[92:93], v52 offset0:224 offset1:225
  ds_read2_b32 v[94:95], v52 offset0:226 offset1:227
  ds_read2_b32 v[96:97], v52 offset0:208 offset1:209
  ds_read2_b32 v[98:99], v52 offset0:210 offset1:211
  ds_read2_b32 v[100:101], v52 offset0:192 offset1:193
  ds_read2_b32 v[102:103], v52 offset0:194 offset1:195
  ds_read2_b32 v[104:105], v52 offset0:176 offset1:177
  ds_read2_b32 v[106:107], v52 offset0:178 offset1:179
  s_waitcnt lgkmcnt(6)
  v_mfma_f32_16x16x32_bf16 v[60:63], v[92:95], a[28:31], 0
  v_mfma_f32_16x16x32_bf16 v[64:67], v[92:95], a[60:63], 0
  v_mfma_f32_16x16x32_bf16 v[68:71], v[92:95], a[92:95], 0
  v_mfma_f32_16x16x32_bf16 v[72:75], v[92:95], a[124:127], 0
  v_mfma_f32_16x16x32_bf16 v[76:79], v[92:95], a[156:159], 0
  v_mfma_f32_16x16x32_bf16 v[80:83], v[92:95], a[188:191], 0
  v_mfma_f32_16x16x32_bf16 v[84:87], v[92:95], a[220:223], 0
  v_mfma_f32_16x16x32_bf16 v[88:91], v[92:95], a[252:255], 0
  ds_read2_b32 v[92:93], v52 offset0:160 offset1:161
  ds_read2_b32 v[94:95], v52 offset0:162 offset1:163
  s_waitcnt lgkmcnt(6)
  v_mfma_f32_16x16x32_bf16 v[60:63], v[96:99], a[24:27], v[60:63]
  v_mfma_f32_16x16x32_bf16 v[64:67], v[96:99], a[56:59], v[64:67]
  v_mfma_f32_16x16x32_bf16 v[68:71], v[96:99], a[88:91], v[68:71]
  v_mfma_f32_16x16x32_bf16 v[72:75], v[96:99], a[120:123], v[72:75]
  v_mfma_f32_16x16x32_bf16 v[76:79], v[96:99], a[152:155], v[76:79]
  v_mfma_f32_16x16x32_bf16 v[80:83], v[96:99], a[184:187], v[80:83]
  v_mfma_f32_16x16x32_bf16 v[84:87], v[96:99], a[216:219], v[84:87]
  v_mfma_f32_16x16x32_bf16 v[88:91], v[96:99], a[248:251], v[88:91]
  ds_read2_b32 v[96:97], v52 offset0:144 offset1:145
  ds_read2_b32 v[98:99], v52 offset0:146 offset1:147
  s_waitcnt lgkmcnt(6)
  v_mfma_f32_16x16x32_bf16 v[60:63], v[100:103], a[20:23], v[60:63]
  v_mfma_f32_16x16x32_bf16 v[64:67], v[100:103], a[52:55], v[64:67]
  v_mfma_f32_16x16x32_bf16 v[68:71], v[100:103], a[84:87], v[68:71]
  v_mfma_f32_16x16x32_bf16 v[72:75], v[100:103], a[116:119], v[72:75]
  v_mfma_f32_16x16x32_bf16 v[76:79], v[100:103], a[148:151], v[76:79]
  v_mfma_f32_16x16x32_bf16 v[80:83], v[100:103], a[180:183], v[80:83]
  v_mfma_f32_16x16x32_bf16 v[84:87], v[100:103], a[212:215], v[84:87]
  v_mfma_f32_16x16x32_bf16 v[88:91], v[100:103], a[244:247], v[88:91]
  ds_read2_b32 v[100:101], v52 offset0:128 offset1:129
  ds_read2_b32 v[102:103], v52 offset0:130 offset1:131
  s_waitcnt lgkmcnt(6)
  v_mfma_f32_16x16x32_bf16 v[60:63], v[104:107], a[16:19], v[60:63]
  v_mfma_f32_16x16x32_bf16 v[64:67], v[104:107], a[48:51], v[64:67]
  v_mfma_f32_16x16x32_bf16 v[68:71], v[104:107], a[80:83], v[68:71]
  v_mfma_f32_16x16x32_bf16 v[72:75], v[104:107], a[112:115], v[72:75]
  v_mfma_f32_16x16x32_bf16 v[76:79], v[104:107], a[144:147], v[76:79]
  v_mfma_f32_16x16x32_bf16 v[80:83], v[104:107], a[176:179], v[80:83]
  v_mfma_f32_16x16x32_bf16 v[84:87], v[104:107], a[208:211], v[84:87]
  v_mfma_f32_16x16x32_bf16 v[88:91], v[104:107], a[240:243], v[88:91]
  ds_read2_b32 v[104:105], v52 offset0:112 offset1:113
  ds_read2_b32 v[106:107], v52 offset0:114 offset1:115
  s_waitcnt lgkmcnt(6)
  v_mfma_f32_16x16x32_bf16 v[60:63], v[92:95], a[12:15], v[60:63]
  v_mfma_f32_16x16x32_bf16 v[64:67], v[92:95], a[44:47], v[64:67]
  v_mfma_f32_16x16x32_bf16 v[68:71], v[92:95], a[76:79], v[68:71]
  v_mfma_f32_16x16x32_bf16 v[72:75], v[92:95], a[108:111], v[72:75]
  v_mfma_f32_16x16x32_bf16 v[76:79], v[92:95], a[140:143], v[76:79]
  v_mfma_f32_16x16x32_bf16 v[80:83], v[92:95], a[172:175], v[80:83]
  v_mfma_f32_16x16x32_bf16 v[84:87], v[92:95], a[204:207], v[84:87]
  v_mfma_f32_16x16x32_bf16 v[88:91], v[92:95], a[236:239], v[88:91]
  ds_read2_b32 v[92:93], v52 offset0:96 offset1:97
  ds_read2_b32 v[94:95], v52 offset0:98 offset1:99
  s_waitcnt lgkmcnt(6)
  v_mfma_f32_16x16x32_bf16 v[60:63], v[96:99], a[8:11], v[60:63]
  v_mfma_f32_16x16x32_bf16 v[64:67], v[96:99], a[40:43], v[64:67]
  v_mfma_f32_16x16x32_bf16 v[68:71], v[96:99], a[72:75], v[68:71]
  v_mfma_f32_16x16x32_bf16 v[72:75], v[96:99], a[104:107], v[72:75]
  v_mfma_f32_16x16x32_bf16 v[76:79], v[96:99], a[136:139], v[76:79]
  v_mfma_f32_16x16x32_bf16 v[80:83], v[96:99], a[168:171], v[80:83]
  v_mfma_f32_16x16x32_bf16 v[84:87], v[96:99], a[200:203], v[84:87]
  v_mfma_f32_16x16x32_bf16 v[88:91], v[96:99], a[232:235], v[88:91]
  ds_read2_b32 v[96:97], v52 offset0:80 offset1:81
  ds_read2_b32 v[98:99], v52 offset0:82 offset1:83
  s_waitcnt lgkmcnt(6)
  v_mfma_f32_16x16x32_bf16 v[60:63], v[100:103], a[4:7], v[60:63]
  v_mfma_f32_16x16x32_bf16 v[64:67], v[100:103], a[36:39], v[64:67]
  v_mfma_f32_16x16x32_bf16 v[68:71], v[100:103], a[68:71], v[68:71]
  v_mfma_f32_16x16x32_bf16 v[72:75], v[100:103], a[100:103], v[72:75]
  v_mfma_f32_16x16x32_bf16 v[76:79], v[100:103], a[132:135], v[76:79]
  v_mfma_f32_16x16x32_bf16 v[80:83], v[100:103], a[164:167], v[80:83]
  v_mfma_f32_16x16x32_bf16 v[84:87], v[100:103], a[196:199], v[84:87]
  v_mfma_f32_16x16x32_bf16 v[88:91], v[100:103], a[228:231], v[88:91]
  ds_read2_b32 v[100:101], v52 offset0:64 offset1:65
  ds_read2_b32 v[102:103], v52 offset0:66 offset1:67
  s_waitcnt lgkmcnt(6)
  v_mfma_f32_16x16x32_bf16 v[60:63], v[104:107], a[0:3], v[60:63]
  v_mfma_f32_16x16x32_bf16 v[64:67], v[104:107], a[32:35], v[64:67]
  v_mfma_f32_16x16x32_bf16 v[68:71], v[104:107], a[64:67], v[68:71]
  v_mfma_f32_16x16x32_bf16 v[72:75], v[104:107], a[96:99], v[72:75]
  v_mfma_f32_16x16x32_bf16 v[76:79], v[104:107], a[128:131], v[76:79]
  v_mfma_f32_16x16x32_bf16 v[80:83], v[104:107], a[160:163], v[80:83]
  v_mfma_f32_16x16x32_bf16 v[84:87], v[104:107], a[192:195], v[84:87]
  v_mfma_f32_16x16x32_bf16 v[88:91], v[104:107], a[224:227], v[88:91]
  ds_read2_b32 v[104:105], v52 offset0:48 offset1:49
  ds_read2_b32 v[106:107], v52 offset0:50 offset1:51
  s_waitcnt lgkmcnt(6)
  v_mfma_f32_16x16x32_bf16 v[64:67], v[92:95], a[28:31], v[64:67]
  v_mfma_f32_16x16x32_bf16 v[68:71], v[92:95], a[60:63], v[68:71]
  v_mfma_f32_16x16x32_bf16 v[72:75], v[92:95], a[92:95], v[72:75]
  v_mfma_f32_16x16x32_bf16 v[76:79], v[92:95], a[124:127], v[76:79]
  v_mfma_f32_16x16x32_bf16 v[80:83], v[92:95], a[156:159], v[80:83]
  v_mfma_f32_16x16x32_bf16 v[84:87], v[92:95], a[188:191], v[84:87]
  v_mfma_f32_16x16x32_bf16 v[88:91], v[92:95], a[220:223], v[88:91]
  ds_read2_b32 v[92:93], v52 offset0:32 offset1:33
  ds_read2_b32 v[94:95], v52 offset0:34 offset1:35
  s_waitcnt lgkmcnt(6)
  v_mfma_f32_16x16x32_bf16 v[64:67], v[96:99], a[24:27], v[64:67]
  v_mfma_f32_16x16x32_bf16 v[68:71], v[96:99], a[56:59], v[68:71]
  v_mfma_f32_16x16x32_bf16 v[72:75], v[96:99], a[88:91], v[72:75]
  v_mfma_f32_16x16x32_bf16 v[76:79], v[96:99], a[120:123], v[76:79]
  v_mfma_f32_16x16x32_bf16 v[80:83], v[96:99], a[152:155], v[80:83]
  v_mfma_f32_16x16x32_bf16 v[84:87], v[96:99], a[184:187], v[84:87]
  v_mfma_f32_16x16x32_bf16 v[88:91], v[96:99], a[216:219], v[88:91]
  ds_read2_b32 v[96:97], v52 offset0:16 offset1:17
  ds_read2_b32 v[98:99], v52 offset0:18 offset1:19
  s_waitcnt lgkmcnt(6)
  v_mfma_f32_16x16x32_bf16 v[64:67], v[100:103], a[20:23], v[64:67]
  v_mfma_f32_16x16x32_bf16 v[68:71], v[100:103], a[52:55], v[68:71]
  v_mfma_f32_16x16x32_bf16 v[72:75], v[100:103], a[84:87], v[72:75]
  v_mfma_f32_16x16x32_bf16 v[76:79], v[100:103], a[116:119], v[76:79]
  v_mfma_f32_16x16x32_bf16 v[80:83], v[100:103], a[148:151], v[80:83]
  v_mfma_f32_16x16x32_bf16 v[84:87], v[100:103], a[180:183], v[84:87]
  v_mfma_f32_16x16x32_bf16 v[88:91], v[100:103], a[212:215], v[88:91]
  ds_read2_b32 v[100:101], v52 offset0:0 offset1:1
  ds_read2_b32 v[102:103], v52 offset0:2 offset1:3
  s_waitcnt lgkmcnt(6)
  v_mfma_f32_16x16x32_bf16 v[64:67], v[104:107], a[16:19], v[64:67]
  v_mfma_f32_16x16x32_bf16 v[68:71], v[104:107], a[48:51], v[68:71]
  v_mfma_f32_16x16x32_bf16 v[72:75], v[104:107], a[80:83], v[72:75]
  v_mfma_f32_16x16x32_bf16 v[76:79], v[104:107], a[112:115], v[76:79]
  v_mfma_f32_16x16x32_bf16 v[80:83], v[104:107], a[144:147], v[80:83]
  v_mfma_f32_16x16x32_bf16 v[84:87], v[104:107], a[176:179], v[84:87]
  v_mfma_f32_16x16x32_bf16 v[88:91], v[104:107], a[208:211], v[88:91]
  ds_read2_b32 v[104:105], v53 offset0:224 offset1:225
  ds_read2_b32 v[106:107], v53 offset0:226 offset1:227
  s_waitcnt lgkmcnt(6)
  v_mfma_f32_16x16x32_bf16 v[64:67], v[92:95], a[12:15], v[64:67]
  v_mfma_f32_16x16x32_bf16 v[68:71], v[92:95], a[44:47], v[68:71]
  v_mfma_f32_16x16x32_bf16 v[72:75], v[92:95], a[76:79], v[72:75]
  v_mfma_f32_16x16x32_bf16 v[76:79], v[92:95], a[108:111], v[76:79]
  v_mfma_f32_16x16x32_bf16 v[80:83], v[92:95], a[140:143], v[80:83]
  v_mfma_f32_16x16x32_bf16 v[84:87], v[92:95], a[172:175], v[84:87]
  v_mfma_f32_16x16x32_bf16 v[88:91], v[92:95], a[204:207], v[88:91]
  ds_read2_b32 v[92:93], v53 offset0:208 offset1:209
  ds_read2_b32 v[94:95], v53 offset0:210 offset1:211
  s_waitcnt lgkmcnt(6)
  v_mfma_f32_16x16x32_bf16 v[64:67], v[96:99], a[8:11], v[64:67]
  v_mfma_f32_16x16x32_bf16 v[68:71], v[96:99], a[40:43], v[68:71]
  v_mfma_f32_16x16x32_bf16 v[72:75], v[96:99], a[72:75], v[72:75]
  v_mfma_f32_16x16x32_bf16 v[76:79], v[96:99], a[104:107], v[76:79]
  v_mfma_f32_16x16x32_bf16 v[80:83], v[96:99], a[136:139], v[80:83]
  v_mfma_f32_16x16x32_bf16 v[84:87], v[96:99], a[168:171], v[84:87]
  v_mfma_f32_16x16x32_bf16 v[88:91], v[96:99], a[200:203], v[88:91]
  ds_read2_b32 v[96:97], v53 offset0:192 offset1:193
  ds_read2_b32 v[98:99], v53 offset0:194 offset1:195
  s_waitcnt lgkmcnt(6)
  v_mfma_f32_16x16x32_bf16 v[64:67], v[100:103], a[4:7], v[64:67]
  v_mfma_f32_16x16x32_bf16 v[68:71], v[100:103], a[36:39], v[68:71]
  v_mfma_f32_16x16x32_bf16 v[72:75], v[100:103], a[68:71], v[72:75]
  v_mfma_f32_16x16x32_bf16 v[76:79], v[100:103], a[100:103], v[76:79]
  v_mfma_f32_16x16x32_bf16 v[80:83], v[100:103], a[132:135], v[80:83]
  v_mfma_f32_16x16x32_bf16 v[84:87], v[100:103], a[164:167], v[84:87]
  v_mfma_f32_16x16x32_bf16 v[88:91], v[100:103], a[196:199], v[88:91]
  ds_read2_b32 v[100:101], v53 offset0:176 offset1:177
  ds_read2_b32 v[102:103], v53 offset0:178 offset1:179
  s_waitcnt lgkmcnt(6)
  v_mfma_f32_16x16x32_bf16 v[64:67], v[104:107], a[0:3], v[64:67]
  v_mfma_f32_16x16x32_bf16 v[68:71], v[104:107], a[32:35], v[68:71]
  v_mfma_f32_16x16x32_bf16 v[72:75], v[104:107], a[64:67], v[72:75]
  v_mfma_f32_16x16x32_bf16 v[76:79], v[104:107], a[96:99], v[76:79]
  v_mfma_f32_16x16x32_bf16 v[80:83], v[104:107], a[128:131], v[80:83]
  v_mfma_f32_16x16x32_bf16 v[84:87], v[104:107], a[160:163], v[84:87]
  v_mfma_f32_16x16x32_bf16 v[88:91], v[104:107], a[192:195], v[88:91]
  ds_read2_b32 v[104:105], v53 offset0:160 offset1:161
  ds_read2_b32 v[106:107], v53 offset0:162 offset1:163
  s_waitcnt lgkmcnt(6)
  v_mfma_f32_16x16x32_bf16 v[68:71], v[92:95], a[28:31], v[68:71]
  v_mfma_f32_16x16x32_bf16 v[72:75], v[92:95], a[60:63], v[72:75]
  v_mfma_f32_16x16x32_bf16 v[76:79], v[92:95], a[92:95], v[76:79]
  v_mfma_f32_16x16x32_bf16 v[80:83], v[92:95], a[124:127], v[80:83]
  v_mfma_f32_16x16x32_bf16 v[84:87], v[92:95], a[156:159], v[84:87]
  v_mfma_f32_16x16x32_bf16 v[88:91], v[92:95], a[188:191], v[88:91]
  ds_read2_b32 v[92:93], v53 offset0:144 offset1:145
  ds_read2_b32 v[94:95], v53 offset0:146 offset1:147
  s_waitcnt lgkmcnt(6)
  v_mfma_f32_16x16x32_bf16 v[68:71], v[96:99], a[24:27], v[68:71]
  v_mfma_f32_16x16x32_bf16 v[72:75], v[96:99], a[56:59], v[72:75]
  v_mfma_f32_16x16x32_bf16 v[76:79], v[96:99], a[88:91], v[76:79]
  v_mfma_f32_16x16x32_bf16 v[80:83], v[96:99], a[120:123], v[80:83]
  v_mfma_f32_16x16x32_bf16 v[84:87], v[96:99], a[152:155], v[84:87]
  v_mfma_f32_16x16x32_bf16 v[88:91], v[96:99], a[184:187], v[88:91]
  ds_read2_b32 v[96:97], v53 offset0:128 offset1:129
  ds_read2_b32 v[98:99], v53 offset0:130 offset1:131
  s_waitcnt lgkmcnt(6)
  v_mfma_f32_16x16x32_bf16 v[68:71], v[100:103], a[20:23], v[68:71]
  v_mfma_f32_16x16x32_bf16 v[72:75], v[100:103], a[52:55], v[72:75]
  v_mfma_f32_16x16x32_bf16 v[76:79], v[100:103], a[84:87], v[76:79]
  v_mfma_f32_16x16x32_bf16 v[80:83], v[100:103], a[116:119], v[80:83]
  v_mfma_f32_16x16x32_bf16 v[84:87], v[100:103], a[148:151], v[84:87]
  v_mfma_f32_16x16x32_bf16 v[88:91], v[100:103], a[180:183], v[88:91]
  ds_read2_b32 v[100:101], v53 offset0:112 offset1:113
  ds_read2_b32 v[102:103], v53 offset0:114 offset1:115
  s_waitcnt lgkmcnt(6)
  v_mfma_f32_16x16x32_bf16 v[68:71], v[104:107], a[16:19], v[68:71]
  v_mfma_f32_16x16x32_bf16 v[72:75], v[104:107], a[48:51], v[72:75]
  v_mfma_f32_16x16x32_bf16 v[76:79], v[104:107], a[80:83], v[76:79]
  v_mfma_f32_16x16x32_bf16 v[80:83], v[104:107], a[112:115], v[80:83]
  v_mfma_f32_16x16x32_bf16 v[84:87], v[104:107], a[144:147], v[84:87]
  v_mfma_f32_16x16x32_bf16 v[88:91], v[104:107], a[176:179], v[88:91]
  ds_read2_b32 v[104:105], v53 offset0:96 offset1:97
  ds_read2_b32 v[106:107], v53 offset0:98 offset1:99
  s_waitcnt lgkmcnt(6)
  v_mfma_f32_16x16x32_bf16 v[68:71], v[92:95], a[12:15], v[68:71]
  v_mfma_f32_16x16x32_bf16 v[72:75], v[92:95], a[44:47], v[72:75]
  v_mfma_f32_16x16x32_bf16 v[76:79], v[92:95], a[76:79], v[76:79]
  v_mfma_f32_16x16x32_bf16 v[80:83], v[92:95], a[108:111], v[80:83]
  v_mfma_f32_16x16x32_bf16 v[84:87], v[92:95], a[140:143], v[84:87]
  v_mfma_f32_16x16x32_bf16 v[88:91], v[92:95], a[172:175], v[88:91]
  ds_read2_b32 v[92:93], v53 offset0:80 offset1:81
  ds_read2_b32 v[94:95], v53 offset0:82 offset1:83
  s_waitcnt lgkmcnt(6)
  v_mfma_f32_16x16x32_bf16 v[68:71], v[96:99], a[8:11], v[68:71]
  v_mfma_f32_16x16x32_bf16 v[72:75], v[96:99], a[40:43], v[72:75]
  v_mfma_f32_16x16x32_bf16 v[76:79], v[96:99], a[72:75], v[76:79]
  v_mfma_f32_16x16x32_bf16 v[80:83], v[96:99], a[104:107], v[80:83]
  v_mfma_f32_16x16x32_bf16 v[84:87], v[96:99], a[136:139], v[84:87]
  v_mfma_f32_16x16x32_bf16 v[88:91], v[96:99], a[168:171], v[88:91]
  ds_read2_b32 v[96:97], v53 offset0:64 offset1:65
  ds_read2_b32 v[98:99], v53 offset0:66 offset1:67
  s_waitcnt lgkmcnt(6)
  v_mfma_f32_16x16x32_bf16 v[68:71], v[100:103], a[4:7], v[68:71]
  v_mfma_f32_16x16x32_bf16 v[72:75], v[100:103], a[36:39], v[72:75]
  v_mfma_f32_16x16x32_bf16 v[76:79], v[100:103], a[68:71], v[76:79]
  v_mfma_f32_16x16x32_bf16 v[80:83], v[100:103], a[100:103], v[80:83]
  v_mfma_f32_16x16x32_bf16 v[84:87], v[100:103], a[132:135], v[84:87]
  v_mfma_f32_16x16x32_bf16 v[88:91], v[100:103], a[164:167], v[88:91]
  ds_read2_b32 v[100:101], v53 offset0:48 offset1:49
  ds_read2_b32 v[102:103], v53 offset0:50 offset1:51
  s_waitcnt lgkmcnt(6)
  v_mfma_f32_16x16x32_bf16 v[68:71], v[104:107], a[0:3], v[68:71]
  v_mfma_f32_16x16x32_bf16 v[72:75], v[104:107], a[32:35], v[72:75]
  v_mfma_f32_16x16x32_bf16 v[76:79], v[104:107], a[64:67], v[76:79]
  v_mfma_f32_16x16x32_bf16 v[80:83], v[104:107], a[96:99], v[80:83]
  v_mfma_f32_16x16x32_bf16 v[84:87], v[104:107], a[128:131], v[84:87]
  v_mfma_f32_16x16x32_bf16 v[88:91], v[104:107], a[160:163], v[88:91]
  ds_read2_b32 v[104:105], v53 offset0:32 offset1:33
  ds_read2_b32 v[106:107], v53 offset0:34 offset1:35
  s_waitcnt lgkmcnt(6)
  v_mfma_f32_16x16x32_bf16 v[72:75], v[92:95], a[28:31], v[72:75]
  v_mfma_f32_16x16x32_bf16 v[76:79], v[92:95], a[60:63], v[76:79]
  v_mfma_f32_16x16x32_bf16 v[80:83], v[92:95], a[92:95], v[80:83]
  v_mfma_f32_16x16x32_bf16 v[84:87], v[92:95], a[124:127], v[84:87]
  v_mfma_f32_16x16x32_bf16 v[88:91], v[92:95], a[156:159], v[88:91]
  ds_read2_b32 v[92:93], v53 offset0:16 offset1:17
  ds_read2_b32 v[94:95], v53 offset0:18 offset1:19
  s_waitcnt lgkmcnt(6)
  v_mfma_f32_16x16x32_bf16 v[72:75], v[96:99], a[24:27], v[72:75]
  v_mfma_f32_16x16x32_bf16 v[76:79], v[96:99], a[56:59], v[76:79]
  v_mfma_f32_16x16x32_bf16 v[80:83], v[96:99], a[88:91], v[80:83]
  v_mfma_f32_16x16x32_bf16 v[84:87], v[96:99], a[120:123], v[84:87]
  v_mfma_f32_16x16x32_bf16 v[88:91], v[96:99], a[152:155], v[88:91]
  ds_read2_b32 v[96:97], v53 offset0:0 offset1:1
  ds_read2_b32 v[98:99], v53 offset0:2 offset1:3
  s_waitcnt lgkmcnt(6)
  v_mfma_f32_16x16x32_bf16 v[72:75], v[100:103], a[20:23], v[72:75]
  v_mfma_f32_16x16x32_bf16 v[76:79], v[100:103], a[52:55], v[76:79]
  v_mfma_f32_16x16x32_bf16 v[80:83], v[100:103], a[84:87], v[80:83]
  v_mfma_f32_16x16x32_bf16 v[84:87], v[100:103], a[116:119], v[84:87]
  v_mfma_f32_16x16x32_bf16 v[88:91], v[100:103], a[148:151], v[88:91]
  ds_read2_b32 v[100:101], v54 offset0:224 offset1:225
  ds_read2_b32 v[102:103], v54 offset0:226 offset1:227
  s_waitcnt lgkmcnt(6)
  v_mfma_f32_16x16x32_bf16 v[72:75], v[104:107], a[16:19], v[72:75]
  v_mfma_f32_16x16x32_bf16 v[76:79], v[104:107], a[48:51], v[76:79]
  v_mfma_f32_16x16x32_bf16 v[80:83], v[104:107], a[80:83], v[80:83]
  v_mfma_f32_16x16x32_bf16 v[84:87], v[104:107], a[112:115], v[84:87]
  v_mfma_f32_16x16x32_bf16 v[88:91], v[104:107], a[144:147], v[88:91]
  ds_read2_b32 v[104:105], v54 offset0:208 offset1:209
  ds_read2_b32 v[106:107], v54 offset0:210 offset1:211
  s_waitcnt lgkmcnt(6)
  v_mfma_f32_16x16x32_bf16 v[72:75], v[92:95], a[12:15], v[72:75]
  v_mfma_f32_16x16x32_bf16 v[76:79], v[92:95], a[44:47], v[76:79]
  v_mfma_f32_16x16x32_bf16 v[80:83], v[92:95], a[76:79], v[80:83]
  v_mfma_f32_16x16x32_bf16 v[84:87], v[92:95], a[108:111], v[84:87]
  v_mfma_f32_16x16x32_bf16 v[88:91], v[92:95], a[140:143], v[88:91]
  ds_read2_b32 v[92:93], v54 offset0:192 offset1:193
  ds_read2_b32 v[94:95], v54 offset0:194 offset1:195
  s_waitcnt lgkmcnt(6)
  v_mfma_f32_16x16x32_bf16 v[72:75], v[96:99], a[8:11], v[72:75]
  v_mfma_f32_16x16x32_bf16 v[76:79], v[96:99], a[40:43], v[76:79]
  v_mfma_f32_16x16x32_bf16 v[80:83], v[96:99], a[72:75], v[80:83]
  v_mfma_f32_16x16x32_bf16 v[84:87], v[96:99], a[104:107], v[84:87]
  v_mfma_f32_16x16x32_bf16 v[88:91], v[96:99], a[136:139], v[88:91]
  ds_read2_b32 v[96:97], v54 offset0:176 offset1:177
  ds_read2_b32 v[98:99], v54 offset0:178 offset1:179
  s_waitcnt lgkmcnt(6)
  v_mfma_f32_16x16x32_bf16 v[72:75], v[100:103], a[4:7], v[72:75]
  v_mfma_f32_16x16x32_bf16 v[76:79], v[100:103], a[36:39], v[76:79]
  v_mfma_f32_16x16x32_bf16 v[80:83], v[100:103], a[68:71], v[80:83]
  v_mfma_f32_16x16x32_bf16 v[84:87], v[100:103], a[100:103], v[84:87]
  v_mfma_f32_16x16x32_bf16 v[88:91], v[100:103], a[132:135], v[88:91]
  ds_read2_b32 v[100:101], v54 offset0:160 offset1:161
  ds_read2_b32 v[102:103], v54 offset0:162 offset1:163
  s_waitcnt lgkmcnt(6)
  v_mfma_f32_16x16x32_bf16 v[72:75], v[104:107], a[0:3], v[72:75]
  v_mfma_f32_16x16x32_bf16 v[76:79], v[104:107], a[32:35], v[76:79]
  v_mfma_f32_16x16x32_bf16 v[80:83], v[104:107], a[64:67], v[80:83]
  v_mfma_f32_16x16x32_bf16 v[84:87], v[104:107], a[96:99], v[84:87]
  v_mfma_f32_16x16x32_bf16 v[88:91], v[104:107], a[128:131], v[88:91]
  ds_read2_b32 v[104:105], v54 offset0:144 offset1:145
  ds_read2_b32 v[106:107], v54 offset0:146 offset1:147
  s_waitcnt lgkmcnt(6)
  v_mfma_f32_16x16x32_bf16 v[76:79], v[92:95], a[28:31], v[76:79]
  v_mfma_f32_16x16x32_bf16 v[80:83], v[92:95], a[60:63], v[80:83]
  v_mfma_f32_16x16x32_bf16 v[84:87], v[92:95], a[92:95], v[84:87]
  v_mfma_f32_16x16x32_bf16 v[88:91], v[92:95], a[124:127], v[88:91]
  ds_read2_b32 v[92:93], v54 offset0:128 offset1:129
  ds_read2_b32 v[94:95], v54 offset0:130 offset1:131
  s_waitcnt lgkmcnt(6)
  v_mfma_f32_16x16x32_bf16 v[76:79], v[96:99], a[24:27], v[76:79]
  v_mfma_f32_16x16x32_bf16 v[80:83], v[96:99], a[56:59], v[80:83]
  v_mfma_f32_16x16x32_bf16 v[84:87], v[96:99], a[88:91], v[84:87]
  v_mfma_f32_16x16x32_bf16 v[88:91], v[96:99], a[120:123], v[88:91]
  ds_read2_b32 v[96:97], v54 offset0:112 offset1:113
  ds_read2_b32 v[98:99], v54 offset0:114 offset1:115
  s_waitcnt lgkmcnt(6)
  v_mfma_f32_16x16x32_bf16 v[76:79], v[100:103], a[20:23], v[76:79]
  v_mfma_f32_16x16x32_bf16 v[80:83], v[100:103], a[52:55], v[80:83]
  v_mfma_f32_16x16x32_bf16 v[84:87], v[100:103], a[84:87], v[84:87]
  v_mfma_f32_16x16x32_bf16 v[88:91], v[100:103], a[116:119], v[88:91]
  ds_read2_b32 v[100:101], v54 offset0:96 offset1:97
  ds_read2_b32 v[102:103], v54 offset0:98 offset1:99
  s_waitcnt lgkmcnt(6)
  v_mfma_f32_16x16x32_bf16 v[76:79], v[104:107], a[16:19], v[76:79]
  v_mfma_f32_16x16x32_bf16 v[80:83], v[104:107], a[48:51], v[80:83]
  v_mfma_f32_16x16x32_bf16 v[84:87], v[104:107], a[80:83], v[84:87]
  v_mfma_f32_16x16x32_bf16 v[88:91], v[104:107], a[112:115], v[88:91]
  ds_read2_b32 v[104:105], v54 offset0:80 offset1:81
  ds_read2_b32 v[106:107], v54 offset0:82 offset1:83
  s_waitcnt lgkmcnt(6)
  v_mfma_f32_16x16x32_bf16 v[76:79], v[92:95], a[12:15], v[76:79]
  v_mfma_f32_16x16x32_bf16 v[80:83], v[92:95], a[44:47], v[80:83]
  v_mfma_f32_16x16x32_bf16 v[84:87], v[92:95], a[76:79], v[84:87]
  v_mfma_f32_16x16x32_bf16 v[88:91], v[92:95], a[108:111], v[88:91]
  ds_read2_b32 v[92:93], v54 offset0:64 offset1:65
  ds_read2_b32 v[94:95], v54 offset0:66 offset1:67
  s_waitcnt lgkmcnt(6)
  v_mfma_f32_16x16x32_bf16 v[76:79], v[96:99], a[8:11], v[76:79]
  v_mfma_f32_16x16x32_bf16 v[80:83], v[96:99], a[40:43], v[80:83]
  v_mfma_f32_16x16x32_bf16 v[84:87], v[96:99], a[72:75], v[84:87]
  v_mfma_f32_16x16x32_bf16 v[88:91], v[96:99], a[104:107], v[88:91]
  ds_read2_b32 v[96:97], v54 offset0:48 offset1:49
  ds_read2_b32 v[98:99], v54 offset0:50 offset1:51
  s_waitcnt lgkmcnt(6)
  v_mfma_f32_16x16x32_bf16 v[76:79], v[100:103], a[4:7], v[76:79]
  v_mfma_f32_16x16x32_bf16 v[80:83], v[100:103], a[36:39], v[80:83]
  v_mfma_f32_16x16x32_bf16 v[84:87], v[100:103], a[68:71], v[84:87]
  v_mfma_f32_16x16x32_bf16 v[88:91], v[100:103], a[100:103], v[88:91]
  ds_read2_b32 v[100:101], v54 offset0:32 offset1:33
  ds_read2_b32 v[102:103], v54 offset0:34 offset1:35
  s_waitcnt lgkmcnt(6)
  v_mfma_f32_16x16x32_bf16 v[76:79], v[104:107], a[0:3], v[76:79]
  v_mfma_f32_16x16x32_bf16 v[80:83], v[104:107], a[32:35], v[80:83]
  v_mfma_f32_16x16x32_bf16 v[84:87], v[104:107], a[64:67], v[84:87]
  v_mfma_f32_16x16x32_bf16 v[88:91], v[104:107], a[96:99], v[88:91]
  ds_read2_b32 v[104:105], v54 offset0:16 offset1:17
  ds_read2_b32 v[106:107], v54 offset0:18 offset1:19
  s_waitcnt lgkmcnt(6)
  v_mfma_f32_16x16x32_bf16 v[80:83], v[92:95], a[28:31], v[80:83]
  v_mfma_f32_16x16x32_bf16 v[84:87], v[92:95], a[60:63], v[84:87]
  v_mfma_f32_16x16x32_bf16 v[88:91], v[92:95], a[92:95], v[88:91]
  ds_read2_b32 v[92:93], v54 offset0:0 offset1:1
  ds_read2_b32 v[94:95], v54 offset0:2 offset1:3
  s_waitcnt lgkmcnt(6)
  v_mfma_f32_16x16x32_bf16 v[80:83], v[96:99], a[24:27], v[80:83]
  v_mfma_f32_16x16x32_bf16 v[84:87], v[96:99], a[56:59], v[84:87]
  v_mfma_f32_16x16x32_bf16 v[88:91], v[96:99], a[88:91], v[88:91]
  ds_read2_b32 v[96:97], v55 offset0:224 offset1:225
  ds_read2_b32 v[98:99], v55 offset0:226 offset1:227
  s_waitcnt lgkmcnt(6)
  v_mfma_f32_16x16x32_bf16 v[80:83], v[100:103], a[20:23], v[80:83]
  v_mfma_f32_16x16x32_bf16 v[84:87], v[100:103], a[52:55], v[84:87]
  v_mfma_f32_16x16x32_bf16 v[88:91], v[100:103], a[84:87], v[88:91]
  ds_read2_b32 v[100:101], v55 offset0:208 offset1:209
  ds_read2_b32 v[102:103], v55 offset0:210 offset1:211
  s_waitcnt lgkmcnt(6)
  v_mfma_f32_16x16x32_bf16 v[80:83], v[104:107], a[16:19], v[80:83]
  v_mfma_f32_16x16x32_bf16 v[84:87], v[104:107], a[48:51], v[84:87]
  v_mfma_f32_16x16x32_bf16 v[88:91], v[104:107], a[80:83], v[88:91]
  ds_read2_b32 v[104:105], v55 offset0:192 offset1:193
  ds_read2_b32 v[106:107], v55 offset0:194 offset1:195
  s_waitcnt lgkmcnt(6)
  v_mfma_f32_16x16x32_bf16 v[80:83], v[92:95], a[12:15], v[80:83]
  v_mfma_f32_16x16x32_bf16 v[84:87], v[92:95], a[44:47], v[84:87]
  v_mfma_f32_16x16x32_bf16 v[88:91], v[92:95], a[76:79], v[88:91]
  ds_read2_b32 v[92:93], v55 offset0:176 offset1:177
  ds_read2_b32 v[94:95], v55 offset0:178 offset1:179
  s_waitcnt lgkmcnt(6)
  v_mfma_f32_16x16x32_bf16 v[80:83], v[96:99], a[8:11], v[80:83]
  v_mfma_f32_16x16x32_bf16 v[84:87], v[96:99], a[40:43], v[84:87]
  v_mfma_f32_16x16x32_bf16 v[88:91], v[96:99], a[72:75], v[88:91]
  ds_read2_b32 v[96:97], v55 offset0:160 offset1:161
  ds_read2_b32 v[98:99], v55 offset0:162 offset1:163
  s_waitcnt lgkmcnt(6)
  v_mfma_f32_16x16x32_bf16 v[80:83], v[100:103], a[4:7], v[80:83]
  v_mfma_f32_16x16x32_bf16 v[84:87], v[100:103], a[36:39], v[84:87]
  v_mfma_f32_16x16x32_bf16 v[88:91], v[100:103], a[68:71], v[88:91]
  ds_read2_b32 v[100:101], v55 offset0:144 offset1:145
  ds_read2_b32 v[102:103], v55 offset0:146 offset1:147
  s_waitcnt lgkmcnt(6)
  v_mfma_f32_16x16x32_bf16 v[80:83], v[104:107], a[0:3], v[80:83]
  v_mfma_f32_16x16x32_bf16 v[84:87], v[104:107], a[32:35], v[84:87]
  v_mfma_f32_16x16x32_bf16 v[88:91], v[104:107], a[64:67], v[88:91]
  ds_read2_b32 v[104:105], v55 offset0:128 offset1:129
  ds_read2_b32 v[106:107], v55 offset0:130 offset1:131
  s_waitcnt lgkmcnt(6)
  v_mfma_f32_16x16x32_bf16 v[84:87], v[92:95], a[28:31], v[84:87]
  v_mfma_f32_16x16x32_bf16 v[88:91], v[92:95], a[60:63], v[88:91]
  ds_read2_b32 v[92:93], v55 offset0:112 offset1:113
  ds_read2_b32 v[94:95], v55 offset0:114 offset1:115
  s_waitcnt lgkmcnt(6)
  v_mfma_f32_16x16x32_bf16 v[84:87], v[96:99], a[24:27], v[84:87]
  v_mfma_f32_16x16x32_bf16 v[88:91], v[96:99], a[56:59], v[88:91]
  ds_read2_b32 v[96:97], v55 offset0:96 offset1:97
  ds_read2_b32 v[98:99], v55 offset0:98 offset1:99
  s_waitcnt lgkmcnt(6)
  v_mfma_f32_16x16x32_bf16 v[84:87], v[100:103], a[20:23], v[84:87]
  v_mfma_f32_16x16x32_bf16 v[88:91], v[100:103], a[52:55], v[88:91]
  ds_read2_b32 v[100:101], v55 offset0:80 offset1:81
  ds_read2_b32 v[102:103], v55 offset0:82 offset1:83
  s_waitcnt lgkmcnt(6)
  v_mfma_f32_16x16x32_bf16 v[84:87], v[104:107], a[16:19], v[84:87]
  v_mfma_f32_16x16x32_bf16 v[88:91], v[104:107], a[48:51], v[88:91]
  ds_read2_b32 v[104:105], v55 offset0:64 offset1:65
  ds_read2_b32 v[106:107], v55 offset0:66 offset1:67
  s_waitcnt lgkmcnt(6)
  v_mfma_f32_16x16x32_bf16 v[84:87], v[92:95], a[12:15], v[84:87]
  v_mfma_f32_16x16x32_bf16 v[88:91], v[92:95], a[44:47], v[88:91]
  ds_read2_b32 v[92:93], v55 offset0:48 offset1:49
  ds_read2_b32 v[94:95], v55 offset0:50 offset1:51
  s_waitcnt lgkmcnt(6)
  v_mfma_f32_16x16x32_bf16 v[84:87], v[96:99], a[8:11], v[84:87]
  v_mfma_f32_16x16x32_bf16 v[88:91], v[96:99], a[40:43], v[88:91]
  ds_read2_b32 v[96:97], v55 offset0:32 offset1:33
  ds_read2_b32 v[98:99], v55 offset0:34 offset1:35
  s_waitcnt lgkmcnt(6)
  v_mfma_f32_16x16x32_bf16 v[84:87], v[100:103], a[4:7], v[84:87]
  v_mfma_f32_16x16x32_bf16 v[88:91], v[100:103], a[36:39], v[88:91]
  ds_read2_b32 v[100:101], v55 offset0:16 offset1:17
  ds_read2_b32 v[102:103], v55 offset0:18 offset1:19
  s_waitcnt lgkmcnt(6)
  v_mfma_f32_16x16x32_bf16 v[84:87], v[104:107], a[0:3], v[84:87]
  v_mfma_f32_16x16x32_bf16 v[88:91], v[104:107], a[32:35], v[88:91]
  ds_read2_b32 v[104:105], v55 offset0:0 offset1:1
  ds_read2_b32 v[106:107], v55 offset0:2 offset1:3
  s_waitcnt lgkmcnt(6)
  v_mfma_f32_16x16x32_bf16 v[88:91], v[92:95], a[28:31], v[88:91]
  ds_read2_b32 v[92:93], v56 offset0:224 offset1:225
  ds_read2_b32 v[94:95], v56 offset0:226 offset1:227
  s_waitcnt lgkmcnt(6)
  v_mfma_f32_16x16x32_bf16 v[88:91], v[96:99], a[24:27], v[88:91]
  ds_read2_b32 v[96:97], v56 offset0:208 offset1:209
  ds_read2_b32 v[98:99], v56 offset0:210 offset1:211
  s_waitcnt lgkmcnt(6)
  v_mfma_f32_16x16x32_bf16 v[88:91], v[100:103], a[20:23], v[88:91]
  ds_read2_b32 v[100:101], v56 offset0:192 offset1:193
  ds_read2_b32 v[102:103], v56 offset0:194 offset1:195
  s_waitcnt lgkmcnt(6)
  v_mfma_f32_16x16x32_bf16 v[88:91], v[104:107], a[16:19], v[88:91]
  ds_read2_b32 v[104:105], v56 offset0:176 offset1:177
  ds_read2_b32 v[106:107], v56 offset0:178 offset1:179
  s_waitcnt lgkmcnt(6)
  v_mfma_f32_16x16x32_bf16 v[88:91], v[92:95], a[12:15], v[88:91]
  s_waitcnt lgkmcnt(4)
  v_mfma_f32_16x16x32_bf16 v[88:91], v[96:99], a[8:11], v[88:91]
  s_waitcnt lgkmcnt(2)
  v_mfma_f32_16x16x32_bf16 v[88:91], v[100:103], a[4:7], v[88:91]
  s_waitcnt lgkmcnt(0)
  v_mfma_f32_16x16x32_bf16 v[88:91], v[104:107], a[0:3], v[88:91]
  v_lshlrev_b32 v46, 5, v4
  v_lshl_add_u32 v46, v3, 3, v46
  v_add_u32 v46, s17, v46
  ds_read_b64 v[108:109], v46 offset:512
  ds_read_b64 v[110:111], v46 offset:1024
  ds_read_b64 v[112:113], v46 offset:1536
  ds_read_b64 v[114:115], v46 offset:2048
  ds_read_b64 v[116:117], v46 offset:2560
  ds_read_b64 v[118:119], v46 offset:3072
  ds_read_b64 v[120:121], v46 offset:3584
  ds_read_b64 v[122:123], v46 offset:4096
  s_waitcnt lgkmcnt(0)
  v_lshlrev_b32 v124, 16, v108
  v_and_b32 v125, 0xffff0000, v108
  v_lshlrev_b32 v126, 16, v109
  v_and_b32 v127, 0xffff0000, v109
  v_mul_f32 v124, v124, v33
  v_mul_f32 v125, v125, v33
  v_mul_f32 v126, v126, v33
  v_mul_f32 v127, v127, v33
  v_cvt_pk_bf16_f32 v128, v124, v125
  v_cvt_pk_bf16_f32 v129, v126, v127
  v_cvt_pk_bf16_f32 v130, v60, v61
  v_cvt_pk_bf16_f32 v131, v62, v63
  v_lshlrev_b32 v124, 16, v128
  v_and_b32 v125, 0xffff0000, v128
  v_lshlrev_b32 v132, 16, v130
  v_and_b32 v133, 0xffff0000, v130
  v_lshlrev_b32 v126, 16, v129
  v_and_b32 v127, 0xffff0000, v129
  v_lshlrev_b32 v134, 16, v131
  v_and_b32 v135, 0xffff0000, v131
  v_add_f32 v124, v124, v132
  v_add_f32 v125, v125, v133
  v_add_f32 v126, v126, v134
  v_add_f32 v127, v127, v135
  v_cvt_pk_bf16_f32 v108, v124, v125
  v_cvt_pk_bf16_f32 v109, v126, v127
  ds_write_b64 v46, v[108:109] offset:512
  v_lshlrev_b32 v124, 16, v110
  v_and_b32 v125, 0xffff0000, v110
  v_lshlrev_b32 v126, 16, v111
  v_and_b32 v127, 0xffff0000, v111
  v_mul_f32 v124, v124, v33
  v_mul_f32 v125, v125, v33
  v_mul_f32 v126, v126, v33
  v_mul_f32 v127, v127, v33
  v_cvt_pk_bf16_f32 v128, v124, v125
  v_cvt_pk_bf16_f32 v129, v126, v127
  v_cvt_pk_bf16_f32 v130, v64, v65
  v_cvt_pk_bf16_f32 v131, v66, v67
  v_lshlrev_b32 v124, 16, v128
  v_and_b32 v125, 0xffff0000, v128
  v_lshlrev_b32 v132, 16, v130
  v_and_b32 v133, 0xffff0000, v130
  v_lshlrev_b32 v126, 16, v129
  v_and_b32 v127, 0xffff0000, v129
  v_lshlrev_b32 v134, 16, v131
  v_and_b32 v135, 0xffff0000, v131
  v_add_f32 v124, v124, v132
  v_add_f32 v125, v125, v133
  v_add_f32 v126, v126, v134
  v_add_f32 v127, v127, v135
  v_cvt_pk_bf16_f32 v110, v124, v125
  v_cvt_pk_bf16_f32 v111, v126, v127
  ds_write_b64 v46, v[110:111] offset:1024
  v_lshlrev_b32 v124, 16, v112
  v_and_b32 v125, 0xffff0000, v112
  v_lshlrev_b32 v126, 16, v113
  v_and_b32 v127, 0xffff0000, v113
  v_mul_f32 v124, v124, v33
  v_mul_f32 v125, v125, v33
  v_mul_f32 v126, v126, v33
  v_mul_f32 v127, v127, v33
  v_cvt_pk_bf16_f32 v128, v124, v125
  v_cvt_pk_bf16_f32 v129, v126, v127
  v_cvt_pk_bf16_f32 v130, v68, v69
  v_cvt_pk_bf16_f32 v131, v70, v71
  v_lshlrev_b32 v124, 16, v128
  v_and_b32 v125, 0xffff0000, v128
  v_lshlrev_b32 v132, 16, v130
  v_and_b32 v133, 0xffff0000, v130
  v_lshlrev_b32 v126, 16, v129
  v_and_b32 v127, 0xffff0000, v129
  v_lshlrev_b32 v134, 16, v131
  v_and_b32 v135, 0xffff0000, v131
  v_add_f32 v124, v124, v132
  v_add_f32 v125, v125, v133
  v_add_f32 v126, v126, v134
  v_add_f32 v127, v127, v135
  v_cvt_pk_bf16_f32 v112, v124, v125
  v_cvt_pk_bf16_f32 v113, v126, v127
  ds_write_b64 v46, v[112:113] offset:1536
  v_lshlrev_b32 v124, 16, v114
  v_and_b32 v125, 0xffff0000, v114
  v_lshlrev_b32 v126, 16, v115
  v_and_b32 v127, 0xffff0000, v115
  v_mul_f32 v124, v124, v33
  v_mul_f32 v125, v125, v33
  v_mul_f32 v126, v126, v33
  v_mul_f32 v127, v127, v33
  v_cvt_pk_bf16_f32 v128, v124, v125
  v_cvt_pk_bf16_f32 v129, v126, v127
  v_cvt_pk_bf16_f32 v130, v72, v73
  v_cvt_pk_bf16_f32 v131, v74, v75
  v_lshlrev_b32 v124, 16, v128
  v_and_b32 v125, 0xffff0000, v128
  v_lshlrev_b32 v132, 16, v130
  v_and_b32 v133, 0xffff0000, v130
  v_lshlrev_b32 v126, 16, v129
  v_and_b32 v127, 0xffff0000, v129
  v_lshlrev_b32 v134, 16, v131
  v_and_b32 v135, 0xffff0000, v131
  v_add_f32 v124, v124, v132
  v_add_f32 v125, v125, v133
  v_add_f32 v126, v126, v134
  v_add_f32 v127, v127, v135
  v_cvt_pk_bf16_f32 v114, v124, v125
  v_cvt_pk_bf16_f32 v115, v126, v127
  ds_write_b64 v46, v[114:115] offset:2048
  v_lshlrev_b32 v124, 16, v116
  v_and_b32 v125, 0xffff0000, v116
  v_lshlrev_b32 v126, 16, v117
  v_and_b32 v127, 0xffff0000, v117
  v_mul_f32 v124, v124, v33
  v_mul_f32 v125, v125, v33
  v_mul_f32 v126, v126, v33
  v_mul_f32 v127, v127, v33
  v_cvt_pk_bf16_f32 v128, v124, v125
  v_cvt_pk_bf16_f32 v129, v126, v127
  v_cvt_pk_bf16_f32 v130, v76, v77
  v_cvt_pk_bf16_f32 v131, v78, v79
  v_lshlrev_b32 v124, 16, v128
  v_and_b32 v125, 0xffff0000, v128
  v_lshlrev_b32 v132, 16, v130
  v_and_b32 v133, 0xffff0000, v130
  v_lshlrev_b32 v126, 16, v129
  v_and_b32 v127, 0xffff0000, v129
  v_lshlrev_b32 v134, 16, v131
  v_and_b32 v135, 0xffff0000, v131
  v_add_f32 v124, v124, v132
  v_add_f32 v125, v125, v133
  v_add_f32 v126, v126, v134
  v_add_f32 v127, v127, v135
  v_cvt_pk_bf16_f32 v116, v124, v125
  v_cvt_pk_bf16_f32 v117, v126, v127
  ds_write_b64 v46, v[116:117] offset:2560
  v_lshlrev_b32 v124, 16, v118
  v_and_b32 v125, 0xffff0000, v118
  v_lshlrev_b32 v126, 16, v119
  v_and_b32 v127, 0xffff0000, v119
  v_mul_f32 v124, v124, v33
  v_mul_f32 v125, v125, v33
  v_mul_f32 v126, v126, v33
  v_mul_f32 v127, v127, v33
  v_cvt_pk_bf16_f32 v128, v124, v125
  v_cvt_pk_bf16_f32 v129, v126, v127
  v_cvt_pk_bf16_f32 v130, v80, v81
  v_cvt_pk_bf16_f32 v131, v82, v83
  v_lshlrev_b32 v124, 16, v128
  v_and_b32 v125, 0xffff0000, v128
  v_lshlrev_b32 v132, 16, v130
  v_and_b32 v133, 0xffff0000, v130
  v_lshlrev_b32 v126, 16, v129
  v_and_b32 v127, 0xffff0000, v129
  v_lshlrev_b32 v134, 16, v131
  v_and_b32 v135, 0xffff0000, v131
  v_add_f32 v124, v124, v132
  v_add_f32 v125, v125, v133
  v_add_f32 v126, v126, v134
  v_add_f32 v127, v127, v135
  v_cvt_pk_bf16_f32 v118, v124, v125
  v_cvt_pk_bf16_f32 v119, v126, v127
  ds_write_b64 v46, v[118:119] offset:3072
  v_lshlrev_b32 v124, 16, v120
  v_and_b32 v125, 0xffff0000, v120
  v_lshlrev_b32 v126, 16, v121
  v_and_b32 v127, 0xffff0000, v121
  v_mul_f32 v124, v124, v33
  v_mul_f32 v125, v125, v33
  v_mul_f32 v126, v126, v33
  v_mul_f32 v127, v127, v33
  v_cvt_pk_bf16_f32 v128, v124, v125
  v_cvt_pk_bf16_f32 v129, v126, v127
  v_cvt_pk_bf16_f32 v130, v84, v85
  v_cvt_pk_bf16_f32 v131, v86, v87
  v_lshlrev_b32 v124, 16, v128
  v_and_b32 v125, 0xffff0000, v128
  v_lshlrev_b32 v132, 16, v130
  v_and_b32 v133, 0xffff0000, v130
  v_lshlrev_b32 v126, 16, v129
  v_and_b32 v127, 0xffff0000, v129
  v_lshlrev_b32 v134, 16, v131
  v_and_b32 v135, 0xffff0000, v131
  v_add_f32 v124, v124, v132
  v_add_f32 v125, v125, v133
  v_add_f32 v126, v126, v134
  v_add_f32 v127, v127, v135
  v_cvt_pk_bf16_f32 v120, v124, v125
  v_cvt_pk_bf16_f32 v121, v126, v127
  ds_write_b64 v46, v[120:121] offset:3584
  v_lshlrev_b32 v124, 16, v122
  v_and_b32 v125, 0xffff0000, v122
  v_lshlrev_b32 v126, 16, v123
  v_and_b32 v127, 0xffff0000, v123
  v_mul_f32 v124, v124, v33
  v_mul_f32 v125, v125, v33
  v_mul_f32 v126, v126, v33
  v_mul_f32 v127, v127, v33
  v_cvt_pk_bf16_f32 v128, v124, v125
  v_cvt_pk_bf16_f32 v129, v126, v127
  v_cvt_pk_bf16_f32 v130, v88, v89
  v_cvt_pk_bf16_f32 v131, v90, v91
  v_lshlrev_b32 v124, 16, v128
  v_and_b32 v125, 0xffff0000, v128
  v_lshlrev_b32 v132, 16, v130
  v_and_b32 v133, 0xffff0000, v130
  v_lshlrev_b32 v126, 16, v129
  v_and_b32 v127, 0xffff0000, v129
  v_lshlrev_b32 v134, 16, v131
  v_and_b32 v135, 0xffff0000, v131
  v_add_f32 v124, v124, v132
  v_add_f32 v125, v125, v133
  v_add_f32 v126, v126, v134
  v_add_f32 v127, v127, v135
  v_cvt_pk_bf16_f32 v122, v124, v125
  v_cvt_pk_bf16_f32 v123, v126, v127
  ds_write_b64 v46, v[122:123] offset:4096
  s_waitcnt lgkmcnt(0)
  s_barrier
  v_lshlrev_b32 v6, 3, v0
  v_mul_u32_u24 v5, 7168, v0
  v_add_u32 v36, 512, v6
  ds_read_b64 v[8:9], v36
  v_add_u32 v36, 25088, v6
  ds_read_b64 v[10:11], v36
  v_add_u32 v36, 49664, v6
  ds_read_b64 v[12:13], v36
  v_add_u32 v36, 74240, v6
  ds_read_b64 v[14:15], v36
  s_waitcnt lgkmcnt(0)
  s_add_u32 s22, s21, 0
  s_add_u32 s23, s22, 3584
  v_perm_b32 v16, v10, v8, s24
  v_perm_b32 v17, v14, v12, s24
  buffer_store_dwordx2 v[16:17], v5, s[88:91], s22 offen offset:0
  v_perm_b32 v18, v10, v8, s25
  v_perm_b32 v19, v14, v12, s25
  buffer_store_dwordx2 v[18:19], v5, s[88:91], s22 offen offset:1792
  v_perm_b32 v20, v11, v9, s24
  v_perm_b32 v21, v15, v13, s24
  buffer_store_dwordx2 v[20:21], v5, s[88:91], s23 offen offset:0
  v_perm_b32 v22, v11, v9, s25
  v_perm_b32 v23, v15, v13, s25
  buffer_store_dwordx2 v[22:23], v5, s[88:91], s23 offen offset:1792
  v_add_u32 v36, 2560, v6
  ds_read_b64 v[8:9], v36
  v_add_u32 v36, 27136, v6
  ds_read_b64 v[10:11], v36
  v_add_u32 v36, 51712, v6
  ds_read_b64 v[12:13], v36
  v_add_u32 v36, 76288, v6
  ds_read_b64 v[14:15], v36
  s_waitcnt lgkmcnt(0)
  s_add_u32 s22, s21, 1835008
  s_add_u32 s23, s22, 3584
  v_perm_b32 v24, v10, v8, s24
  v_perm_b32 v25, v14, v12, s24
  buffer_store_dwordx2 v[24:25], v5, s[88:91], s22 offen offset:0
  v_perm_b32 v26, v10, v8, s25
  v_perm_b32 v27, v14, v12, s25
  buffer_store_dwordx2 v[26:27], v5, s[88:91], s22 offen offset:1792
  v_perm_b32 v28, v11, v9, s24
  v_perm_b32 v29, v15, v13, s24
  buffer_store_dwordx2 v[28:29], v5, s[88:91], s23 offen offset:0
  v_perm_b32 v30, v11, v9, s25
  v_perm_b32 v31, v15, v13, s25
  buffer_store_dwordx2 v[30:31], v5, s[88:91], s23 offen offset:1792
  s_branch wk_loop
wk_tok:
  s_sub_u32 s3, s3, 752
  s_cmp_ge_u32 s3, 512
  s_cbranch_scc1 wk_done
  s_and_b32 s18, s3, 3
  s_lshr_b32 s17, s3, 2
  s_cmp_lt_u32 s17, 8
  s_cbranch_scc1 wk_tokp
  s_sub_u32 s20, s17, 8
  s_sub_u32 s17, s17, 64
  s_cmp_ge_u32 s20, 112
  s_cbranch_scc1 wk_toko
  s_lshr_b32 s17, s20, 1
  s_bitcmp0_b32 s20, 0
  s_cbranch_scc1 wk_toko
  s_add_u32 s17, s17, 8
wk_tokp:
  s_lshl_b32 s20, s18, 2
  s_add_u32 s20, s20, s16
  s_lshl_b32 s21, s17, 4
  s_add_u32 s21, s21, s20
  s_mul_i32 s21, s21, 28672
  s_add_u32 s21, s21, 46399488
  s_mul_i32 s23, s17, 28672
  s_add_u32 s23, s23, 75759616
  s_mul_i32 s24, s17, 7168
  s_add_u32 s24, s24, 65536
  s_lshr_b32 s25, s17, 3
  s_lshl_b32 s25, s25, 4
  s_add_u32 s25, s25, s20
  s_lshl_b32 s25, s25, 7
  s_add_u32 s25, s25, 540672
  v_mov_b32 v60, 0
  s_mov_b32 s30, 0
wp_wf:
  buffer_load_dword v61, v60, s[8:11], s25 offen sc1
  s_waitcnt vmcnt(0)
  v_cmp_ne_u32 vcc, 56, v61
  s_cbranch_vccz wp_wf_ok
  s_sleep 4
  s_cmp_ge_u32 s17, 50
  s_cbranch_scc1 wp_wf_bo
  s_sleep 64
wp_wf_bo:
  s_add_u32 s30, s30, 1
  s_cmp_lt_u32 s30, 2000000
  s_cbranch_scc1 wp_wf
  s_branch wp_abort
wp_wf_ok:
  s_lshl_b32 s25, s17, 1
  s_mul_i32 s25, s25, 20480
  s_add_u32 s25, s25, 86114304
  s_lshl_b32 s26, s20, 10
  s_add_u32 s26, s26, s25
  s_lshl_b32 s27, s18, 10
  s_add_u32 s27, s27, s25
  s_lshr_b32 s28, s16, 1
  s_lshl_b32 s28, s28, 3
  s_add_u32 s27, s27, s28
  s_add_u32 s27, s27, 16384
  s_and_b32 s28, s16, 1
  s_cmp_eq_u32 s28, 0
  s_cselect_b32 s50, -1, 0
  s_cselect_b32 s51, 0, -1
  v_mov_b32 v44, -1
  v_mov_b32 v45, -1
  v_mov_b32 v46, -1
  v_mov_b32 v47, -1
  s_add_u32 s28, s26, 0
  s_add_u32 s29, s27, 0
  buffer_store_dwordx4 v[44:47], v2, s[8:11], s28 offen sc1
  s_mov_b64 exec, s[50:51]
  buffer_store_dwordx2 v[44:45], v2, s[8:11], s29 offen sc1
  s_mov_b64 exec, -1
  s_add_u32 s28, s26, 20480
  s_add_u32 s29, s27, 20480
  buffer_store_dwordx4 v[44:47], v2, s[8:11], s28 offen sc1
  s_mov_b64 exec, s[50:51]
  buffer_store_dwordx2 v[44:45], v2, s[8:11], s29 offen sc1
  s_mov_b64 exec, -1
  s_add_u32 s22, s21, 0
  buffer_load_dwordx4 a[0:3], v2, s[8:11], s22 offen offset:0 sc1
  buffer_load_dwordx4 a[4:7], v2, s[8:11], s22 offen offset:1024 sc1
  buffer_load_dwordx4 a[8:11], v2, s[8:11], s22 offen offset:2048 sc1
  buffer_load_dwordx4 a[12:15], v2, s[8:11], s22 offen offset:3072 sc1
  s_add_u32 s22, s21, 4096
  buffer_load_dwordx4 a[16:19], v2, s[8:11], s22 offen offset:0 sc1
  buffer_load_dwordx4 a[20:23], v2, s[8:11], s22 offen offset:1024 sc1
  buffer_load_dwordx4 a[24:27], v2, s[8:11], s22 offen offset:2048 sc1
  buffer_load_dwordx4 a[28:31], v2, s[8:11], s22 offen offset:3072 sc1
  s_add_u32 s22, s21, 8192
  buffer_load_dwordx4 a[32:35], v2, s[8:11], s22 offen offset:0 sc1
  buffer_load_dwordx4 a[36:39], v2, s[8:11], s22 offen offset:1024 sc1
  buffer_load_dwordx4 a[40:43], v2, s[8:11], s22 offen offset:2048 sc1
  buffer_load_dwordx4 a[44:47], v2, s[8:11], s22 offen offset:3072 sc1
  s_add_u32 s22, s21, 12288
  buffer_load_dwordx4 a[48:51], v2, s[8:11], s22 offen offset:0 sc1
  buffer_load_dwordx4 a[52:55], v2, s[8:11], s22 offen offset:1024 sc1
  buffer_load_dwordx4 a[56:59], v2, s[8:11], s22 offen offset:2048 sc1
  buffer_load_dwordx4 a[60:63], v2, s[8:11], s22 offen offset:3072 sc1
  s_add_u32 s22, s21, 16384
  buffer_load_dwordx4 a[64:67], v2, s[8:11], s22 offen offset:0 sc1
  buffer_load_dwordx4 a[68:71], v2, s[8:11], s22 offen offset:1024 sc1
  buffer_load_dwordx4 a[72:75], v2, s[8:11], s22 offen offset:2048 sc1
  buffer_load_dwordx4 a[76:79], v2, s[8:11], s22 offen offset:3072 sc1
  s_add_u32 s22, s21, 20480
  buffer_load_dwordx4 a[80:83], v2, s[8:11], s22 offen offset:0 sc1
  buffer_load_dwordx4 a[84:87], v2, s[8:11], s22 offen offset:1024 sc1
  buffer_load_dwordx4 a[88:91], v2, s[8:11], s22 offen offset:2048 sc1
  buffer_load_dwordx4 a[92:95], v2, s[8:11], s22 offen offset:3072 sc1
  s_add_u32 s22, s21, 24576
  buffer_load_dwordx4 a[96:99], v2, s[8:11], s22 offen offset:0 sc1
  buffer_load_dwordx4 a[100:103], v2, s[8:11], s22 offen offset:1024 sc1
  buffer_load_dwordx4 a[104:107], v2, s[8:11], s22 offen offset:2048 sc1
  buffer_load_dwordx4 a[108:111], v2, s[8:11], s22 offen offset:3072 sc1
  s_add_u32 s22, s23, 0
  buffer_load_dwordx4 a[112:115], v2, s[8:11], s22 offen offset:0 sc1
  buffer_load_dwordx4 a[116:119], v2, s[8:11], s22 offen offset:1024 sc1
  buffer_load_dwordx4 a[120:123], v2, s[8:11], s22 offen offset:2048 sc1
  buffer_load_dwordx4 a[124:127], v2, s[8:11], s22 offen offset:3072 sc1
  s_add_u32 s22, s23, 4096
  buffer_load_dwordx4 a[128:131], v2, s[8:11], s22 offen offset:0 sc1
  buffer_load_dwordx4 a[132:135], v2, s[8:11], s22 offen offset:1024 sc1
  buffer_load_dwordx4 a[136:139], v2, s[8:11], s22 offen offset:2048 sc1
  buffer_load_dwordx4 a[140:143], v2, s[8:11], s22 offen offset:3072 sc1
  s_add_u32 s22, s23, 8192
  buffer_load_dwordx4 a[144:147], v2, s[8:11], s22 offen offset:0 sc1
  buffer_load_dwordx4 a[148:151], v2, s[8:11], s22 offen offset:1024 sc1
  buffer_load_dwordx4 a[152:155], v2, s[8:11], s22 offen offset:2048 sc1
  buffer_load_dwordx4 a[156:159], v2, s[8:11], s22 offen offset:3072 sc1
  s_add_u32 s22, s23, 12288
  buffer_load_dwordx4 a[160:163], v2, s[8:11], s22 offen offset:0 sc1
  buffer_load_dwordx4 a[164:167], v2, s[8:11], s22 offen offset:1024 sc1
  buffer_load_dwordx4 a[168:171], v2, s[8:11], s22 offen offset:2048 sc1
  buffer_load_dwordx4 a[172:175], v2, s[8:11], s22 offen offset:3072 sc1
  s_add_u32 s22, s23, 16384
  buffer_load_dwordx4 a[176:179], v2, s[8:11], s22 offen offset:0 sc1
  buffer_load_dwordx4 a[180:183], v2, s[8:11], s22 offen offset:1024 sc1
  buffer_load_dwordx4 a[184:187], v2, s[8:11], s22 offen offset:2048 sc1
  buffer_load_dwordx4 a[188:191], v2, s[8:11], s22 offen offset:3072 sc1
  s_add_u32 s22, s23, 20480
  buffer_load_dwordx4 a[192:195], v2, s[8:11], s22 offen offset:0 sc1
  buffer_load_dwordx4 a[196:199], v2, s[8:11], s22 offen offset:1024 sc1
  buffer_load_dwordx4 a[200:203], v2, s[8:11], s22 offen offset:2048 sc1
  buffer_load_dwordx4 a[204:207], v2, s[8:11], s22 offen offset:3072 sc1
  s_add_u32 s22, s23, 24576
  buffer_load_dwordx4 a[208:211], v2, s[8:11], s22 offen offset:0 sc1
  buffer_load_dwordx4 a[212:215], v2, s[8:11], s22 offen offset:1024 sc1
  buffer_load_dwordx4 a[216:219], v2, s[8:11], s22 offen offset:2048 sc1
  buffer_load_dwordx4 a[220:223], v2, s[8:11], s22 offen offset:3072 sc1
  v_lshl_add_u32 v5, v3, 2, 0
  v_cmp_le_u32 s[40:41], v5, v4
  v_lshl_add_u32 v5, v3, 2, 1
  v_cmp_le_u32 s[42:43], v5, v4
  v_lshl_add_u32 v5, v3, 2, 2
  v_cmp_le_u32 s[44:45], v5, v4
  v_lshl_add_u32 v5, v3, 2, 3
  v_cmp_le_u32 s[46:47], v5, v4
  v_cmp_gt_u32 s[48:49], 2, v3
  v_mov_b32 v6, 0xff800000
  s_waitcnt vmcnt(0)
  s_lshl_b32 s25, s17, 7
  s_add_u32 s25, s25, 557056
  v_mov_b32 v5, 1
  v_mov_b32 v7, 0
  s_waitcnt vmcnt(0)
  s_mov_b64 exec, 1
  buffer_atomic_add v5, v7, s[8:11], s25 offen
  s_mov_b64 exec, -1
  v_mfma_f32_16x16x32_bf16 v[8:11], a[112:115], a[0:3], 0
  v_mfma_f32_16x16x32_bf16 v[12:15], a[112:115], a[56:59], 0
  v_mfma_f32_16x16x32_bf16 v[16:19], a[168:171], a[56:59], 0
  v_mfma_f32_16x16x32_bf16 v[8:11], a[116:119], a[4:7], v[8:11]
  v_mfma_f32_16x16x32_bf16 v[12:15], a[116:119], a[60:63], v[12:15]
  v_mfma_f32_16x16x32_bf16 v[16:19], a[172:175], a[60:63], v[16:19]
  v_mfma_f32_16x16x32_bf16 v[8:11], a[120:123], a[8:11], v[8:11]
  v_mfma_f32_16x16x32_bf16 v[12:15], a[120:123], a[64:67], v[12:15]
  v_mfma_f32_16x16x32_bf16 v[16:19], a[176:179], a[64:67], v[16:19]
  v_mfma_f32_16x16x32_bf16 v[8:11], a[124:127], a[12:15], v[8:11]
  v_mfma_f32_16x16x32_bf16 v[12:15], a[124:127], a[68:71], v[12:15]
  v_mfma_f32_16x16x32_bf16 v[16:19], a[180:183], a[68:71], v[16:19]
  v_mfma_f32_16x16x32_bf16 v[8:11], a[128:131], a[16:19], v[8:11]
  v_mfma_f32_16x16x32_bf16 v[12:15], a[128:131], a[72:75], v[12:15]
  v_mfma_f32_16x16x32_bf16 v[16:19], a[184:187], a[72:75], v[16:19]
  v_mfma_f32_16x16x32_bf16 v[8:11], a[132:135], a[20:23], v[8:11]
  v_mfma_f32_16x16x32_bf16 v[12:15], a[132:135], a[76:79], v[12:15]
  v_mfma_f32_16x16x32_bf16 v[16:19], a[188:191], a[76:79], v[16:19]
  v_mfma_f32_16x16x32_bf16 v[8:11], a[136:139], a[24:27], v[8:11]
  v_mfma_f32_16x16x32_bf16 v[12:15], a[136:139], a[80:83], v[12:15]
  v_mfma_f32_16x16x32_bf16 v[16:19], a[192:195], a[80:83], v[16:19]
  v_mfma_f32_16x16x32_bf16 v[8:11], a[140:143], a[28:31], v[8:11]
  v_mfma_f32_16x16x32_bf16 v[12:15], a[140:143], a[84:87], v[12:15]
  v_mfma_f32_16x16x32_bf16 v[16:19], a[196:199], a[84:87], v[16:19]
  v_mfma_f32_16x16x32_bf16 v[8:11], a[144:147], a[32:35], v[8:11]
  v_mfma_f32_16x16x32_bf16 v[12:15], a[144:147], a[88:91], v[12:15]
  v_mfma_f32_16x16x32_bf16 v[16:19], a[200:203], a[88:91], v[16:19]
  v_mfma_f32_16x16x32_bf16 v[8:11], a[148:151], a[36:39], v[8:11]
  v_mfma_f32_16x16x32_bf16 v[12:15], a[148:151], a[92:95], v[12:15]
  v_mfma_f32_16x16x32_bf16 v[16:19], a[204:207], a[92:95], v[16:19]
  v_mfma_f32_16x16x32_bf16 v[8:11], a[152:155], a[40:43], v[8:11]
  v_mfma_f32_16x16x32_bf16 v[12:15], a[152:155], a[96:99], v[12:15]
  v_mfma_f32_16x16x32_bf16 v[16:19], a[208:211], a[96:99], v[16:19]
  v_mfma_f32_16x16x32_bf16 v[8:11], a[156:159], a[44:47], v[8:11]
  v_mfma_f32_16x16x32_bf16 v[12:15], a[156:159], a[100:103], v[12:15]
  v_mfma_f32_16x16x32_bf16 v[16:19], a[212:215], a[100:103], v[16:19]
  v_mfma_f32_16x16x32_bf16 v[8:11], a[160:163], a[48:51], v[8:11]
  v_mfma_f32_16x16x32_bf16 v[12:15], a[160:163], a[104:107], v[12:15]
  v_mfma_f32_16x16x32_bf16 v[16:19], a[216:219], a[104:107], v[16:19]
  v_mfma_f32_16x16x32_bf16 v[8:11], a[164:167], a[52:55], v[8:11]
  v_mfma_f32_16x16x32_bf16 v[12:15], a[164:167], a[108:111], v[12:15]
  v_mfma_f32_16x16x32_bf16 v[16:19], a[220:223], a[108:111], v[16:19]
  s_mul_i32 s22, s20, 448
  v_mov_b32 v62, s22
  s_mov_b32 s30, 0
wp_pm:
  s_cmp_ge_u32 s17, 64
  s_cbranch_scc1 wp_pf
  buffer_load_dword v61, v62, s[8:11], s24 offen sc1
  s_waitcnt vmcnt(0)
  v_cmp_eq_u32 vcc, -1, v61
  s_cbranch_vccnz wp_pr
wp_pf:
  s_add_u32 s22, s24, 4096
  buffer_load_dwordx4 v[64:67], v2, s[8:11], s24 offen offset:0 sc1
  buffer_load_dwordx4 v[68:71], v2, s[8:11], s24 offen offset:1024 sc1
  buffer_load_dwordx4 v[72:75], v2, s[8:11], s24 offen offset:2048 sc1
  buffer_load_dwordx4 v[76:79], v2, s[8:11], s24 offen offset:3072 sc1
  buffer_load_dwordx4 v[80:83], v2, s[8:11], s22 offen offset:0 sc1
  buffer_load_dwordx4 v[84:87], v2, s[8:11], s22 offen offset:1024 sc1
  buffer_load_dwordx4 v[88:91], v2, s[8:11], s22 offen offset:2048 sc1
  s_waitcnt vmcnt(0)
  v_max_u32 v61, v64, v65
  v_max3_u32 v61, v61, v66, v67
  v_max3_u32 v61, v61, v68, v69
  v_max3_u32 v61, v61, v70, v71
  v_max3_u32 v61, v61, v72, v73
  v_max3_u32 v61, v61, v74, v75
  v_max3_u32 v61, v61, v76, v77
  v_max3_u32 v61, v61, v78, v79
  v_max3_u32 v61, v61, v80, v81
  v_max3_u32 v61, v61, v82, v83
  v_max3_u32 v61, v61, v84, v85
  v_max3_u32 v61, v61, v86, v87
  v_max3_u32 v61, v61, v88, v89
  v_max3_u32 v61, v61, v90, v91
  v_cmp_eq_u32 vcc, -1, v61
  s_cbranch_vccz wp_pk
wp_pr:
  s_sleep 4
  s_cmp_ge_u32 s17, 50
  s_cbranch_scc1 wp_pm_bo
  s_sleep 64
wp_pm_bo:
  s_add_u32 s30, s30, 1
  s_cmp_lt_u32 s30, 2000000
  s_cbranch_scc1 wp_pm
  s_branch wp_abort
wp_pk:
  buffer_load_dword v250, v251, s[8:11], 0 offen sc1
  v_mfma_f32_16x16x32_bf16 v[20:23], v[64:67], a[0:3], 0
  v_mfma_f32_16x16x32_bf16 v[24:27], v[64:67], a[4:7], 0
  v_mfma_f32_16x16x32_bf16 v[28:31], v[64:67], a[56:59], 0
  v_mfma_f32_16x16x32_bf16 v[32:35], v[64:67], a[60:63], 0
  v_mfma_f32_16x16x32_bf16 v[20:23], v[68:71], a[8:11], v[20:23]
  v_mfma_f32_16x16x32_bf16 v[24:27], v[68:71], a[12:15], v[24:27]
  v_mfma_f32_16x16x32_bf16 v[28:31], v[68:71], a[64:67], v[28:31]
  v_mfma_f32_16x16x32_bf16 v[32:35], v[68:71], a[68:71], v[32:35]
  v_mfma_f32_16x16x32_bf16 v[20:23], v[72:75], a[16:19], v[20:23]
  v_mfma_f32_16x16x32_bf16 v[24:27], v[72:75], a[20:23], v[24:27]
  v_mfma_f32_16x16x32_bf16 v[28:31], v[72:75], a[72:75], v[28:31]
  v_mfma_f32_16x16x32_bf16 v[32:35], v[72:75], a[76:79], v[32:35]
  v_mfma_f32_16x16x32_bf16 v[20:23], v[76:79], a[24:27], v[20:23]
  v_mfma_f32_16x16x32_bf16 v[24:27], v[76:79], a[28:31], v[24:27]
  v_mfma_f32_16x16x32_bf16 v[28:31], v[76:79], a[80:83], v[28:31]
  v_mfma_f32_16x16x32_bf16 v[32:35], v[76:79], a[84:87], v[32:35]
  v_mfma_f32_16x16x32_bf16 v[20:23], v[80:83], a[32:35], v[20:23]
  v_mfma_f32_16x16x32_bf16 v[24:27], v[80:83], a[36:39], v[24:27]
  v_mfma_f32_16x16x32_bf16 v[28:31], v[80:83], a[88:91], v[28:31]
  v_mfma_f32_16x16x32_bf16 v[32:35], v[80:83], a[92:95], v[32:35]
  v_mfma_f32_16x16x32_bf16 v[20:23], v[84:87], a[40:43], v[20:23]
  v_mfma_f32_16x16x32_bf16 v[24:27], v[84:87], a[44:47], v[24:27]
  v_mfma_f32_16x16x32_bf16 v[28:31], v[84:87], a[96:99], v[28:31]
  v_mfma_f32_16x16x32_bf16 v[32:35], v[84:87], a[100:103], v[32:35]
  v_mfma_f32_16x16x32_bf16 v[20:23], v[88:91], a[48:51], v[20:23]
  v_mfma_f32_16x16x32_bf16 v[24:27], v[88:91], a[52:55], v[24:27]
  v_mfma_f32_16x16x32_bf16 v[28:31], v[88:91], a[104:107], v[28:31]
  v_mfma_f32_16x16x32_bf16 v[32:35], v[88:91], a[108:111], v[32:35]
  v_cndmask_b32 v8, v6, v8, s[40:41]
  v_cndmask_b32 v9, v6, v9, s[42:43]
  v_cndmask_b32 v10, v6, v10, s[44:45]
  v_cndmask_b32 v11, v6, v11, s[46:47]
  v_cndmask_b32 v20, v24, v20, s[48:49]
  v_cndmask_b32 v21, v25, v21, s[48:49]
  v_cndmask_b32 v22, v26, v22, s[48:49]
  v_cndmask_b32 v23, v27, v23, s[48:49]
  v_mov_b32 v24, v20
  v_mov_b32 v25, v21
  v_mov_b32 v26, v22
  v_mov_b32 v27, v23
  v_permlane32_swap_b32 v20, v24
  v_permlane32_swap_b32 v21, v25
  v_permlane32_swap_b32 v22, v26
  v_permlane32_swap_b32 v23, v27
  v_add_f32 v20, v20, v24
  v_add_f32 v21, v21, v25
  v_add_f32 v22, v22, v26
  v_add_f32 v23, v23, v27
  v_max3_f32 v40, v8, v9, v10
  v_max3_f32 v40, v40, v11, v20
  v_max3_f32 v40, v40, v21, v22
  v_max_f32 v40, v40, v23
  v_mov_b32 v41, v40
  s_nop 1
  v_permlane16_swap_b32 v40, v41
  v_max_f32 v40, v40, v41
  v_mov_b32 v41, v40
  s_nop 1
  v_permlane32_swap_b32 v40, v41
  v_max_f32 v40, v40, v41
  v_sub_f32 v8, v8, v40
  v_sub_f32 v9, v9, v40
  v_sub_f32 v10, v10, v40
  v_sub_f32 v11, v11, v40
  v_sub_f32 v20, v20, v40
  v_sub_f32 v21, v21, v40
  v_sub_f32 v22, v22, v40
  v_sub_f32 v23, v23, v40
  v_exp_f32 v8, v8
  v_exp_f32 v9, v9
  v_exp_f32 v10, v10
  v_exp_f32 v11, v11
  v_exp_f32 v20, v20
  v_exp_f32 v21, v21
  v_exp_f32 v22, v22
  v_exp_f32 v23, v23
  v_add_f32 v42, v20, v21
  v_add_f32 v43, v22, v23
  v_add_f32 v42, v42, v43
  v_mul_f32 v42, 0.5, v42
  v_add_f32 v42, v42, v8
  v_add_f32 v42, v42, v9
  v_add_f32 v42, v42, v10
  v_add_f32 v42, v42, v11
  v_mov_b32 v41, v42
  s_nop 1
  v_permlane16_swap_b32 v42, v41
  v_add_f32 v42, v42, v41
  v_mov_b32 v41, v42
  s_nop 1
  v_permlane32_swap_b32 v42, v41
  v_add_f32 v42, v42, v41
  v_rcp_f32 v42, v42
  s_nop 0
  v_mul_f32 v8, v8, v42
  v_mul_f32 v9, v9, v42
  v_mul_f32 v10, v10, v42
  v_mul_f32 v11, v11, v42
  v_mul_f32 v20, v20, v42
  v_mul_f32 v21, v21, v42
  v_mul_f32 v22, v22, v42
  v_mul_f32 v23, v23, v42
  v_cvt_pk_bf16_f32 v44, v8, 0
  v_cvt_pk_bf16_f32 v45, v9, 0
  v_cvt_pk_bf16_f32 v46, v10, 0
  v_cvt_pk_bf16_f32 v47, v11, 0
  v_cvt_pk_bf16_f32 v48, v20, v21
  v_cvt_pk_bf16_f32 v49, v22, v23
  v_min_u32 v44, -2, v44
  v_min_u32 v45, -2, v45
  v_min_u32 v46, -2, v46
  v_min_u32 v47, -2, v47
  v_min_u32 v48, -2, v48
  v_min_u32 v49, -2, v49
  buffer_store_dwordx4 v[44:47], v2, s[8:11], s26 offen sc1
  s_mov_b64 exec, s[50:51]
  buffer_store_dwordx2 v[48:49], v2, s[8:11], s27 offen sc1
  s_mov_b64 exec, -1
  s_add_u32 s26, s26, 20480
  s_add_u32 s27, s27, 20480
  v_cndmask_b32 v16, v6, v16, s[40:41]
  v_cndmask_b32 v17, v6, v17, s[42:43]
  v_cndmask_b32 v18, v6, v18, s[44:45]
  v_cndmask_b32 v19, v6, v19, s[46:47]
  v_cndmask_b32 v28, v32, v28, s[48:49]
  v_cndmask_b32 v29, v33, v29, s[48:49]
  v_cndmask_b32 v30, v34, v30, s[48:49]
  v_cndmask_b32 v31, v35, v31, s[48:49]
  v_mov_b32 v32, v28
  v_mov_b32 v33, v29
  v_mov_b32 v34, v30
  v_mov_b32 v35, v31
  v_permlane32_swap_b32 v28, v32
  v_permlane32_swap_b32 v29, v33
  v_permlane32_swap_b32 v30, v34
  v_permlane32_swap_b32 v31, v35
  v_add_f32 v28, v28, v32
  v_add_f32 v29, v29, v33
  v_add_f32 v30, v30, v34
  v_add_f32 v31, v31, v35
  v_max3_f32 v40, v12, v13, v14
  v_max3_f32 v40, v40, v15, v16
  v_max3_f32 v40, v40, v17, v18
  v_max3_f32 v40, v40, v19, v28
  v_max3_f32 v40, v40, v29, v30
  v_max_f32 v40, v40, v31
  v_mov_b32 v41, v40
  s_nop 1
  v_permlane16_swap_b32 v40, v41
  v_max_f32 v40, v40, v41
  v_mov_b32 v41, v40
  s_nop 1
  v_permlane32_swap_b32 v40, v41
  v_max_f32 v40, v40, v41
  v_sub_f32 v12, v12, v40
  v_sub_f32 v13, v13, v40
  v_sub_f32 v14, v14, v40
  v_sub_f32 v15, v15, v40
  v_sub_f32 v16, v16, v40
  v_sub_f32 v17, v17, v40
  v_sub_f32 v18, v18, v40
  v_sub_f32 v19, v19, v40
  v_sub_f32 v28, v28, v40
  v_sub_f32 v29, v29, v40
  v_sub_f32 v30, v30, v40
  v_sub_f32 v31, v31, v40
  v_exp_f32 v12, v12
  v_exp_f32 v13, v13
  v_exp_f32 v14, v14
  v_exp_f32 v15, v15
  v_exp_f32 v16, v16
  v_exp_f32 v17, v17
  v_exp_f32 v18, v18
  v_exp_f32 v19, v19
  v_exp_f32 v28, v28
  v_exp_f32 v29, v29
  v_exp_f32 v30, v30
  v_exp_f32 v31, v31
  v_add_f32 v42, v28, v29
  v_add_f32 v43, v30, v31
  v_add_f32 v42, v42, v43
  v_mul_f32 v42, 0.5, v42
  v_add_f32 v42, v42, v12
  v_add_f32 v42, v42, v13
  v_add_f32 v42, v42, v14
  v_add_f32 v42, v42, v15
  v_add_f32 v42, v42, v16
  v_add_f32 v42, v42, v17
  v_add_f32 v42, v42, v18
  v_add_f32 v42, v42, v19
  v_mov_b32 v41, v42
  s_nop 1
  v_permlane16_swap_b32 v42, v41
  v_add_f32 v42, v42, v41
  v_mov_b32 v41, v42
  s_nop 1
  v_permlane32_swap_b32 v42, v41
  v_add_f32 v42, v42, v41
  v_rcp_f32 v42, v42
  s_nop 0
  v_mul_f32 v12, v12, v42
  v_mul_f32 v13, v13, v42
  v_mul_f32 v14, v14, v42
  v_mul_f32 v15, v15, v42
  v_mul_f32 v16, v16, v42
  v_mul_f32 v17, v17, v42
  v_mul_f32 v18, v18, v42
  v_mul_f32 v19, v19, v42
  v_mul_f32 v28, v28, v42
  v_mul_f32 v29, v29, v42
  v_mul_f32 v30, v30, v42
  v_mul_f32 v31, v31, v42
  v_cvt_pk_bf16_f32 v52, v12, v16
  v_cvt_pk_bf16_f32 v53, v13, v17
  v_cvt_pk_bf16_f32 v54, v14, v18
  v_cvt_pk_bf16_f32 v55, v15, v19
  v_cvt_pk_bf16_f32 v56, v28, v29
  v_cvt_pk_bf16_f32 v57, v30, v31
  v_min_u32 v52, -2, v52
  v_min_u32 v53, -2, v53
  v_min_u32 v54, -2, v54
  v_min_u32 v55, -2, v55
  v_min_u32 v56, -2, v56
  v_min_u32 v57, -2, v57
  buffer_store_dwordx4 v[52:55], v2, s[8:11], s26 offen sc1
  s_mov_b64 exec, s[50:51]
  buffer_store_dwordx2 v[56:57], v2, s[8:11], s27 offen sc1
  s_mov_b64 exec, -1
  s_branch wk_loop
wk_toko:
  s_load_dwordx2 s[36:37], s[0:1], 112
  s_waitcnt lgkmcnt(0)
  s_mov_b32 s92, s36
  s_and_b32 s93, s37, 0xffff
  s_mov_b32 s94, 3670016
  s_mov_b32 s95, 0x20000
  s_lshl_b32 s20, s18, 2
  s_add_u32 s20, s20, s16
  s_mul_i32 s24, s20, 65
  s_add_u32 s24, s24, s17
  s_lshl_b32 s24, s24, 13
  s_add_u32 s24, s24, 77602816
  s_mul_i32 s21, s20, 28672
  s_mul_i32 s22, s17, 458752
  s_add_u32 s21, s21, s22
  s_add_u32 s21, s21, 2490368
  s_lshl_b32 s25, s17, 1
  s_mul_i32 s25, s25, 20480
  s_add_u32 s25, s25, 86114304
  v_mov_b32 v5, v2
  v_min_u32 v6, 11, v4
  v_mad_u32_u24 v6, v3, 12, v6
  v_lshlrev_b32 v6, 4, v6
  v_add_u32 v6, 1024, v6
  v_lshrrev_b32 v8, 1, v3
  v_lshl_add_u32 v8, v8, 4, v4
  v_lshlrev_b32 v8, 4, v8
  v_and_b32 v9, 1, v3
  v_lshl_add_u32 v7, v9, 3, v8
  s_lshr_b32 s26, s17, 3
  s_lshl_b32 s26, s26, 4
  s_add_u32 s26, s26, s20
  s_lshl_b32 s26, s26, 7
  s_add_u32 s26, s26, 524288
  v_mov_b32 v60, 0
  s_mov_b32 s30, 0
wo_wv:
  buffer_load_dword v61, v60, s[8:11], s26 offen sc1
  s_waitcnt vmcnt(0)
  v_cmp_ne_u32 vcc, 56, v61
  s_cbranch_vccz wo_wv_ok
  s_sleep 4
  s_cmp_ge_u32 s17, 50
  s_cbranch_scc1 wo_wv_bo
  s_sleep 64
wo_wv_bo:
  s_add_u32 s30, s30, 1
  s_cmp_lt_u32 s30, 2000000
  s_cbranch_scc1 wo_wv
  s_branch wo_abort
wo_wv_ok:
  s_add_u32 s22, s21, 0
  buffer_load_dwordx4 a[0:3], v5, s[8:11], s22 offen offset:0 sc1
  buffer_load_dwordx4 a[4:7], v6, s[8:11], s22 offen offset:0 sc1
  buffer_load_dwordx4 a[8:11], v5, s[8:11], s22 offen offset:1792 sc1
  buffer_load_dwordx4 a[12:15], v6, s[8:11], s22 offen offset:1792 sc1
  s_add_u32 s22, s21, 3584
  buffer_load_dwordx4 a[16:19], v5, s[8:11], s22 offen offset:0 sc1
  buffer_load_dwordx4 a[20:23], v6, s[8:11], s22 offen offset:0 sc1
  buffer_load_dwordx4 a[24:27], v5, s[8:11], s22 offen offset:1792 sc1
  buffer_load_dwordx4 a[28:31], v6, s[8:11], s22 offen offset:1792 sc1
  s_add_u32 s22, s21, 7168
  buffer_load_dwordx4 a[32:35], v5, s[8:11], s22 offen offset:0 sc1
  buffer_load_dwordx4 a[36:39], v6, s[8:11], s22 offen offset:0 sc1
  buffer_load_dwordx4 a[40:43], v5, s[8:11], s22 offen offset:1792 sc1
  buffer_load_dwordx4 a[44:47], v6, s[8:11], s22 offen offset:1792 sc1
  s_add_u32 s22, s21, 10752
  buffer_load_dwordx4 a[48:51], v5, s[8:11], s22 offen offset:0 sc1
  buffer_load_dwordx4 a[52:55], v6, s[8:11], s22 offen offset:0 sc1
  buffer_load_dwordx4 a[56:59], v5, s[8:11], s22 offen offset:1792 sc1
  buffer_load_dwordx4 a[60:63], v6, s[8:11], s22 offen offset:1792 sc1
  s_add_u32 s22, s21, 14336
  buffer_load_dwordx4 a[64:67], v5, s[8:11], s22 offen offset:0 sc1
  buffer_load_dwordx4 a[68:71], v6, s[8:11], s22 offen offset:0 sc1
  buffer_load_dwordx4 a[72:75], v5, s[8:11], s22 offen offset:1792 sc1
  buffer_load_dwordx4 a[76:79], v6, s[8:11], s22 offen offset:1792 sc1
  s_add_u32 s22, s21, 17920
  buffer_load_dwordx4 a[80:83], v5, s[8:11], s22 offen offset:0 sc1
  buffer_load_dwordx4 a[84:87], v6, s[8:11], s22 offen offset:0 sc1
  buffer_load_dwordx4 a[88:91], v5, s[8:11], s22 offen offset:1792 sc1
  buffer_load_dwordx4 a[92:95], v6, s[8:11], s22 offen offset:1792 sc1
  s_add_u32 s22, s21, 21504
  buffer_load_dwordx4 a[96:99], v5, s[8:11], s22 offen offset:0 sc1
  buffer_load_dwordx4 a[100:103], v6, s[8:11], s22 offen offset:0 sc1
  buffer_load_dwordx4 a[104:107], v5, s[8:11], s22 offen offset:1792 sc1
  buffer_load_dwordx4 a[108:111], v6, s[8:11], s22 offen offset:1792 sc1
  s_add_u32 s22, s21, 25088
  buffer_load_dwordx4 a[112:115], v5, s[8:11], s22 offen offset:0 sc1
  buffer_load_dwordx4 a[116:119], v6, s[8:11], s22 offen offset:0 sc1
  buffer_load_dwordx4 a[120:123], v5, s[8:11], s22 offen offset:1792 sc1
  buffer_load_dwordx4 a[124:127], v6, s[8:11], s22 offen offset:1792 sc1
  s_and_b32 s27, s17, 1
  s_cmp_ge_u32 s17, 62
  s_cselect_b32 s27, s17, s27
  s_lshl_b32 s26, s20, 6
  s_add_u32 s26, s26, s27
  s_lshl_b32 s26, s26, 4
  s_add_u32 s26, s26, 565248
  v_lshlrev_b32 v60, 2, v3
  s_mov_b32 s30, 0
wo_wt:
  buffer_load_dword v61, v60, s[8:11], s26 offen sc1
  s_waitcnt vmcnt(0)
  v_cmp_ne_u32 vcc, 1, v61
  s_cbranch_vccz wo_wt_ok
  s_sleep 4
  s_cmp_ge_u32 s17, 50
  s_cbranch_scc1 wo_wt_bo
  s_sleep 64
wo_wt_bo:
  s_add_u32 s30, s30, 1
  s_cmp_lt_u32 s30, 2000000
  s_cbranch_scc1 wo_wt
  s_branch wo_abort
wo_wt_ok:
  s_lshl_b32 s26, s17, 7
  s_add_u32 s26, s26, 557056
  v_mov_b32 v60, 0
  s_mov_b32 s30, 0
wo_wp:
  buffer_load_dword v61, v60, s[8:11], s26 offen sc1
  s_waitcnt vmcnt(0)
  v_cmp_ne_u32 vcc, 16, v61
  s_cbranch_vccz wo_wp_ok
  s_sleep 4
  s_cmp_ge_u32 s17, 50
  s_cbranch_scc1 wo_wp_bo
  s_sleep 64
wo_wp_bo:
  s_add_u32 s30, s30, 1
  s_cmp_lt_u32 s30, 2000000
  s_cbranch_scc1 wo_wp
  s_branch wo_abort
wo_wp_ok:
  s_lshl_b32 s28, s16, 12
  s_add_u32 s26, s25, s28
  s_add_u32 s27, s26, 20480
  s_lshl_b32 s28, s16, 10
  s_add_u32 s28, s28, s25
  s_add_u32 s28, s28, 16384
  s_add_u32 s29, s28, 20480
  s_add_u32 s23, s24, 4096
  s_mov_b32 s30, 0
wo_ps:
  buffer_load_dword v61, off, s[8:11], s24 sc1
  buffer_load_dword v62, off, s[8:11], s26 sc1
  s_waitcnt vmcnt(0)
  v_max_u32 v61, v61, v62
  v_cmp_eq_u32 vcc, -1, v61
  s_cbranch_vccz wo_pl
  s_sleep 2
  s_cmp_ge_u32 s17, 50
  s_cbranch_scc1 wo_ps_bo
  s_sleep 64
wo_ps_bo:
  s_add_u32 s30, s30, 1
  s_cmp_lt_u32 s30, 2000000
  s_cbranch_scc1 wo_ps
  s_branch wo_abort
wo_pl:
  buffer_load_dwordx4 v[64:67], v2, s[8:11], s26 offen offset:0 sc1
  buffer_load_dwordx4 v[68:71], v2, s[8:11], s26 offen offset:1024 sc1
  buffer_load_dwordx4 v[72:75], v2, s[8:11], s26 offen offset:2048 sc1
  buffer_load_dwordx4 v[76:79], v2, s[8:11], s26 offen offset:3072 sc1
  buffer_load_dwordx4 v[80:83], v2, s[8:11], s28 offen sc1
  buffer_load_dwordx4 v[84:87], v2, s[8:11], s27 offen offset:0 sc1
  buffer_load_dwordx4 v[88:91], v2, s[8:11], s27 offen offset:1024 sc1
  buffer_load_dwordx4 v[92:95], v2, s[8:11], s27 offen offset:2048 sc1
  buffer_load_dwordx4 v[96:99], v2, s[8:11], s27 offen offset:3072 sc1
  buffer_load_dwordx4 v[100:103], v2, s[8:11], s29 offen sc1
  buffer_load_dwordx2 v[28:29], v7, s[8:11], s24 offen offset:0 sc1
  buffer_load_dwordx2 v[30:31], v7, s[8:11], s24 offen offset:512 sc1
  buffer_load_dwordx2 v[32:33], v7, s[8:11], s24 offen offset:1024 sc1
  buffer_load_dwordx2 v[34:35], v7, s[8:11], s24 offen offset:1536 sc1
  buffer_load_dwordx2 v[36:37], v7, s[8:11], s24 offen offset:2048 sc1
  buffer_load_dwordx2 v[38:39], v7, s[8:11], s24 offen offset:2560 sc1
  buffer_load_dwordx2 v[40:41], v7, s[8:11], s24 offen offset:3072 sc1
  buffer_load_dwordx2 v[42:43], v7, s[8:11], s24 offen offset:3584 sc1
  buffer_load_dwordx2 v[44:45], v7, s[8:11], s23 offen offset:0 sc1
  buffer_load_dwordx2 v[46:47], v7, s[8:11], s23 offen offset:512 sc1
  buffer_load_dwordx2 v[48:49], v7, s[8:11], s23 offen offset:1024 sc1
  buffer_load_dwordx2 v[50:51], v7, s[8:11], s23 offen offset:1536 sc1
  buffer_load_dwordx2 v[52:53], v7, s[8:11], s23 offen offset:2048 sc1
  buffer_load_dwordx2 v[54:55], v7, s[8:11], s23 offen offset:2560 sc1
  buffer_load_dwordx2 v[56:57], v7, s[8:11], s23 offen offset:3072 sc1
  buffer_load_dwordx2 v[58:59], v7, s[8:11], s23 offen offset:3584 sc1
  s_waitcnt vmcnt(16)
  v_max_u32 v61, v64, v65
  v_max3_u32 v61, v61, v66, v67
  v_max3_u32 v61, v61, v68, v69
  v_max3_u32 v61, v61, v70, v71
  v_max3_u32 v61, v61, v72, v73
  v_max3_u32 v61, v61, v74, v75
  v_max3_u32 v61, v61, v76, v77
  v_max3_u32 v61, v61, v78, v79
  v_max3_u32 v61, v61, v80, v81
  v_max3_u32 v61, v61, v82, v83
  v_max3_u32 v61, v61, v84, v85
  v_max3_u32 v61, v61, v86, v87
  v_max3_u32 v61, v61, v88, v89
  v_max3_u32 v61, v61, v90, v91
  v_max3_u32 v61, v61, v92, v93
  v_max3_u32 v61, v61, v94, v95
  v_max3_u32 v61, v61, v96, v97
  v_max3_u32 v61, v61, v98, v99
  v_max3_u32 v61, v61, v100, v101
  v_max3_u32 v61, v61, v102, v103
  s_mul_i32 s22, s16, 10240
  v_add_u32 v62, s22, v2
  ds_write_b128 v62, v[64:67] offset:0
  ds_write_b128 v62, v[68:71] offset:1024
  ds_write_b128 v62, v[72:75] offset:2048
  ds_write_b128 v62, v[76:79] offset:3072
  ds_write_b128 v62, v[80:83] offset:4096
  ds_write_b128 v62, v[84:87] offset:5120
  ds_write_b128 v62, v[88:91] offset:6144
  ds_write_b128 v62, v[92:95] offset:7168
  ds_write_b128 v62, v[96:99] offset:8192
  ds_write_b128 v62, v[100:103] offset:9216
  s_waitcnt vmcnt(0)
  v_max3_u32 v61, v61, v28, v29
  v_max3_u32 v61, v61, v30, v31
  v_max3_u32 v61, v61, v32, v33
  v_max3_u32 v61, v61, v34, v35
  v_max3_u32 v61, v61, v36, v37
  v_max3_u32 v61, v61, v38, v39
  v_max3_u32 v61, v61, v40, v41
  v_max3_u32 v61, v61, v42, v43
  v_max3_u32 v61, v61, v44, v45
  v_max3_u32 v61, v61, v46, v47
  v_max3_u32 v61, v61, v48, v49
  v_max3_u32 v61, v61, v50, v51
  v_max3_u32 v61, v61, v52, v53
  v_max3_u32 v61, v61, v54, v55
  v_max3_u32 v61, v61, v56, v57
  v_max3_u32 v61, v61, v58, v59
  v_cmp_eq_u32 vcc, -1, v61
  s_cbranch_vccz wo_pk
  s_waitcnt lgkmcnt(0)
  s_sleep 1
  s_add_u32 s30, s30, 1
  s_cmp_lt_u32 s30, 2000000
  s_cbranch_scc1 wo_pl
  s_branch wo_abort
wo_pk:
  buffer_load_dword v250, v251, s[8:11], 0 offen sc1
  s_waitcnt lgkmcnt(0)
  s_barrier
  ds_read_b128 v[64:67], v2 offset:0
  ds_read_b128 v[68:71], v2 offset:5120
  ds_read_b128 v[72:75], v2 offset:1024
  ds_read_b128 v[76:79], v2 offset:6144
  ds_read_b128 v[80:83], v2 offset:2048
  ds_read_b128 v[84:87], v2 offset:7168
  ds_read_b128 v[88:91], v2 offset:3072
  ds_read_b128 v[92:95], v2 offset:8192
  s_waitcnt lgkmcnt(7)
  v_mfma_f32_16x16x32_bf16 v[12:15], a[0:3], v[64:67], 0
  ds_read_b128 v[96:99], v2 offset:4096
  v_mfma_f32_16x16x32_bf16 v[20:23], a[4:7], v[64:67], 0
  s_waitcnt lgkmcnt(7)
  v_mfma_f32_16x16x32_bf16 v[16:19], a[0:3], v[68:71], 0
  ds_read_b128 v[100:103], v2 offset:9216
  v_mfma_f32_16x16x32_bf16 v[24:27], a[4:7], v[68:71], 0
  s_waitcnt lgkmcnt(7)
  v_mfma_f32_16x16x32_bf16 v[12:15], a[8:11], v[72:75], v[12:15]
  ds_read_b128 v[64:67], v2 offset:10240
  v_mfma_f32_16x16x32_bf16 v[20:23], a[12:15], v[72:75], v[20:23]
  s_waitcnt lgkmcnt(7)
  v_mfma_f32_16x16x32_bf16 v[16:19], a[8:11], v[76:79], v[16:19]
  ds_read_b128 v[68:71], v2 offset:15360
  v_mfma_f32_16x16x32_bf16 v[24:27], a[12:15], v[76:79], v[24:27]
  s_waitcnt lgkmcnt(7)
  v_mfma_f32_16x16x32_bf16 v[12:15], a[16:19], v[80:83], v[12:15]
  ds_read_b128 v[72:75], v2 offset:11264
  v_mfma_f32_16x16x32_bf16 v[20:23], a[20:23], v[80:83], v[20:23]
  s_waitcnt lgkmcnt(7)
  v_mfma_f32_16x16x32_bf16 v[16:19], a[16:19], v[84:87], v[16:19]
  ds_read_b128 v[76:79], v2 offset:16384
  v_mfma_f32_16x16x32_bf16 v[24:27], a[20:23], v[84:87], v[24:27]
  s_waitcnt lgkmcnt(7)
  v_mfma_f32_16x16x32_bf16 v[12:15], a[24:27], v[88:91], v[12:15]
  ds_read_b128 v[80:83], v2 offset:12288
  v_mfma_f32_16x16x32_bf16 v[20:23], a[28:31], v[88:91], v[20:23]
  s_waitcnt lgkmcnt(7)
  v_mfma_f32_16x16x32_bf16 v[16:19], a[24:27], v[92:95], v[16:19]
  ds_read_b128 v[84:87], v2 offset:17408
  v_mfma_f32_16x16x32_bf16 v[24:27], a[28:31], v[92:95], v[24:27]
  s_waitcnt lgkmcnt(7)
  v_mfma_f32_16x16x32_bf16 v[12:15], v[28:31], v[96:99], v[12:15]
  ds_read_b128 v[88:91], v2 offset:13312
  v_mfma_f32_16x16x32_bf16 v[20:23], v[32:35], v[96:99], v[20:23]
  s_waitcnt lgkmcnt(7)
  v_mfma_f32_16x16x32_bf16 v[16:19], v[28:31], v[100:103], v[16:19]
  ds_read_b128 v[92:95], v2 offset:18432
  v_mfma_f32_16x16x32_bf16 v[24:27], v[32:35], v[100:103], v[24:27]
  s_waitcnt lgkmcnt(7)
  v_mfma_f32_16x16x32_bf16 v[12:15], a[32:35], v[64:67], v[12:15]
  ds_read_b128 v[96:99], v2 offset:14336
  v_mfma_f32_16x16x32_bf16 v[20:23], a[36:39], v[64:67], v[20:23]
  s_waitcnt lgkmcnt(7)
  v_mfma_f32_16x16x32_bf16 v[16:19], a[32:35], v[68:71], v[16:19]
  ds_read_b128 v[100:103], v2 offset:19456
  v_mfma_f32_16x16x32_bf16 v[24:27], a[36:39], v[68:71], v[24:27]
  s_waitcnt lgkmcnt(7)
  v_mfma_f32_16x16x32_bf16 v[12:15], a[40:43], v[72:75], v[12:15]
  ds_read_b128 v[64:67], v2 offset:20480
  v_mfma_f32_16x16x32_bf16 v[20:23], a[44:47], v[72:75], v[20:23]
  s_waitcnt lgkmcnt(7)
  v_mfma_f32_16x16x32_bf16 v[16:19], a[40:43], v[76:79], v[16:19]
  ds_read_b128 v[68:71], v2 offset:25600
  v_mfma_f32_16x16x32_bf16 v[24:27], a[44:47], v[76:79], v[24:27]
  s_waitcnt lgkmcnt(7)
  v_mfma_f32_16x16x32_bf16 v[12:15], a[48:51], v[80:83], v[12:15]
  ds_read_b128 v[72:75], v2 offset:21504
  v_mfma_f32_16x16x32_bf16 v[20:23], a[52:55], v[80:83], v[20:23]
  s_waitcnt lgkmcnt(7)
  v_mfma_f32_16x16x32_bf16 v[16:19], a[48:51], v[84:87], v[16:19]
  ds_read_b128 v[76:79], v2 offset:26624
  v_mfma_f32_16x16x32_bf16 v[24:27], a[52:55], v[84:87], v[24:27]
  s_waitcnt lgkmcnt(7)
  v_mfma_f32_16x16x32_bf16 v[12:15], a[56:59], v[88:91], v[12:15]
  ds_read_b128 v[80:83], v2 offset:22528
  v_mfma_f32_16x16x32_bf16 v[20:23], a[60:63], v[88:91], v[20:23]
  s_waitcnt lgkmcnt(7)
  v_mfma_f32_16x16x32_bf16 v[16:19], a[56:59], v[92:95], v[16:19]
  ds_read_b128 v[84:87], v2 offset:27648
  v_mfma_f32_16x16x32_bf16 v[24:27], a[60:63], v[92:95], v[24:27]
  s_waitcnt lgkmcnt(7)
  v_mfma_f32_16x16x32_bf16 v[12:15], v[36:39], v[96:99], v[12:15]
  ds_read_b128 v[88:91], v2 offset:23552
  v_mfma_f32_16x16x32_bf16 v[20:23], v[40:43], v[96:99], v[20:23]
  s_waitcnt lgkmcnt(7)
  v_mfma_f32_16x16x32_bf16 v[16:19], v[36:39], v[100:103], v[16:19]
  ds_read_b128 v[92:95], v2 offset:28672
  v_mfma_f32_16x16x32_bf16 v[24:27], v[40:43], v[100:103], v[24:27]
  s_waitcnt lgkmcnt(7)
  v_mfma_f32_16x16x32_bf16 v[12:15], a[64:67], v[64:67], v[12:15]
  ds_read_b128 v[96:99], v2 offset:24576
  v_mfma_f32_16x16x32_bf16 v[20:23], a[68:71], v[64:67], v[20:23]
  s_waitcnt lgkmcnt(7)
  v_mfma_f32_16x16x32_bf16 v[16:19], a[64:67], v[68:71], v[16:19]
  ds_read_b128 v[100:103], v2 offset:29696
  v_mfma_f32_16x16x32_bf16 v[24:27], a[68:71], v[68:71], v[24:27]
  s_waitcnt lgkmcnt(7)
  v_mfma_f32_16x16x32_bf16 v[12:15], a[72:75], v[72:75], v[12:15]
  ds_read_b128 v[64:67], v2 offset:30720
  v_mfma_f32_16x16x32_bf16 v[20:23], a[76:79], v[72:75], v[20:23]
  s_waitcnt lgkmcnt(7)
  v_mfma_f32_16x16x32_bf16 v[16:19], a[72:75], v[76:79], v[16:19]
  ds_read_b128 v[68:71], v2 offset:35840
  v_mfma_f32_16x16x32_bf16 v[24:27], a[76:79], v[76:79], v[24:27]
  s_waitcnt lgkmcnt(7)
  v_mfma_f32_16x16x32_bf16 v[12:15], a[80:83], v[80:83], v[12:15]
  ds_read_b128 v[72:75], v2 offset:31744
  v_mfma_f32_16x16x32_bf16 v[20:23], a[84:87], v[80:83], v[20:23]
  s_waitcnt lgkmcnt(7)
  v_mfma_f32_16x16x32_bf16 v[16:19], a[80:83], v[84:87], v[16:19]
  ds_read_b128 v[76:79], v2 offset:36864
  v_mfma_f32_16x16x32_bf16 v[24:27], a[84:87], v[84:87], v[24:27]
  s_waitcnt lgkmcnt(7)
  v_mfma_f32_16x16x32_bf16 v[12:15], a[88:91], v[88:91], v[12:15]
  ds_read_b128 v[80:83], v2 offset:32768
  v_mfma_f32_16x16x32_bf16 v[20:23], a[92:95], v[88:91], v[20:23]
  s_waitcnt lgkmcnt(7)
  v_mfma_f32_16x16x32_bf16 v[16:19], a[88:91], v[92:95], v[16:19]
  ds_read_b128 v[84:87], v2 offset:37888
  v_mfma_f32_16x16x32_bf16 v[24:27], a[92:95], v[92:95], v[24:27]
  s_waitcnt lgkmcnt(7)
  v_mfma_f32_16x16x32_bf16 v[12:15], v[44:47], v[96:99], v[12:15]
  ds_read_b128 v[88:91], v2 offset:33792
  v_mfma_f32_16x16x32_bf16 v[20:23], v[48:51], v[96:99], v[20:23]
  s_waitcnt lgkmcnt(7)
  v_mfma_f32_16x16x32_bf16 v[16:19], v[44:47], v[100:103], v[16:19]
  ds_read_b128 v[92:95], v2 offset:38912
  v_mfma_f32_16x16x32_bf16 v[24:27], v[48:51], v[100:103], v[24:27]
  s_waitcnt lgkmcnt(7)
  v_mfma_f32_16x16x32_bf16 v[12:15], a[96:99], v[64:67], v[12:15]
  ds_read_b128 v[96:99], v2 offset:34816
  v_mfma_f32_16x16x32_bf16 v[20:23], a[100:103], v[64:67], v[20:23]
  s_waitcnt lgkmcnt(7)
  v_mfma_f32_16x16x32_bf16 v[16:19], a[96:99], v[68:71], v[16:19]
  ds_read_b128 v[100:103], v2 offset:39936
  v_mfma_f32_16x16x32_bf16 v[24:27], a[100:103], v[68:71], v[24:27]
  s_waitcnt lgkmcnt(7)
  v_mfma_f32_16x16x32_bf16 v[12:15], a[104:107], v[72:75], v[12:15]
  v_mfma_f32_16x16x32_bf16 v[20:23], a[108:111], v[72:75], v[20:23]
  s_waitcnt lgkmcnt(6)
  v_mfma_f32_16x16x32_bf16 v[16:19], a[104:107], v[76:79], v[16:19]
  v_mfma_f32_16x16x32_bf16 v[24:27], a[108:111], v[76:79], v[24:27]
  s_waitcnt lgkmcnt(5)
  v_mfma_f32_16x16x32_bf16 v[12:15], a[112:115], v[80:83], v[12:15]
  v_mfma_f32_16x16x32_bf16 v[20:23], a[116:119], v[80:83], v[20:23]
  s_waitcnt lgkmcnt(4)
  v_mfma_f32_16x16x32_bf16 v[16:19], a[112:115], v[84:87], v[16:19]
  v_mfma_f32_16x16x32_bf16 v[24:27], a[116:119], v[84:87], v[24:27]
  s_waitcnt lgkmcnt(3)
  v_mfma_f32_16x16x32_bf16 v[12:15], a[120:123], v[88:91], v[12:15]
  v_mfma_f32_16x16x32_bf16 v[20:23], a[124:127], v[88:91], v[20:23]
  s_waitcnt lgkmcnt(2)
  v_mfma_f32_16x16x32_bf16 v[16:19], a[120:123], v[92:95], v[16:19]
  v_mfma_f32_16x16x32_bf16 v[24:27], a[124:127], v[92:95], v[24:27]
  s_waitcnt lgkmcnt(1)
  v_mfma_f32_16x16x32_bf16 v[12:15], v[52:55], v[96:99], v[12:15]
  v_mfma_f32_16x16x32_bf16 v[20:23], v[56:59], v[96:99], v[20:23]
  s_waitcnt lgkmcnt(0)
  v_mfma_f32_16x16x32_bf16 v[16:19], v[52:55], v[100:103], v[16:19]
  v_mfma_f32_16x16x32_bf16 v[24:27], v[56:59], v[100:103], v[24:27]
  v_mul_u32_u24 v9, 1792, v4
  v_lshl_add_u32 v9, v3, 3, v9
  s_lshl_b32 s22, s20, 5
  v_add_u32 v8, s22, v9
  s_mul_i32 s22, s20, 24
  s_add_u32 s22, s22, 512
  v_add_u32 v9, s22, v9
  v_mov_b32 v10, 0x40000000
  v_cmp_eq_u32 vcc, 3, v3
  s_nop 1
  v_cndmask_b32 v9, v9, v10, vcc
  s_mul_i32 s26, s17, 57344
  s_add_u32 s26, s26, 896
  s_add_u32 s27, s26, 28672
  v_cvt_pk_bf16_f32 v108, v12, v13
  v_cvt_pk_bf16_f32 v109, v14, v15
  buffer_store_dwordx2 v[108:109], v8, s[92:95], s26 offen
  v_cvt_pk_bf16_f32 v110, v20, v21
  v_cvt_pk_bf16_f32 v111, v22, v23
  buffer_store_dwordx2 v[110:111], v9, s[92:95], s26 offen
  v_cvt_pk_bf16_f32 v112, v16, v17
  v_cvt_pk_bf16_f32 v113, v18, v19
  buffer_store_dwordx2 v[112:113], v8, s[92:95], s27 offen
  v_cvt_pk_bf16_f32 v114, v24, v25
  v_cvt_pk_bf16_f32 v115, v26, v27
  buffer_store_dwordx2 v[114:115], v9, s[92:95], s27 offen
  s_branch wk_loop
wp_abort:
wo_abort:
  s_branch cA_abort
wk_done:
ch_end:
  s_endpgm

.section .rodata,"a"
.p2align 6
.amdhsa_kernel main_kernel
  .amdhsa_next_free_vgpr 512
  .amdhsa_next_free_sgpr 102
  .amdhsa_accum_offset 256
  .amdhsa_group_segment_fixed_size 0
  .amdhsa_kernarg_size 136
  .amdhsa_user_sgpr_count 2
  .amdhsa_user_sgpr_kernarg_segment_ptr 1
  .amdhsa_system_sgpr_workgroup_id_x 1
.end_amdhsa_kernel
```

```asm
; @launch kernel=main_kernel grid=(256,1,1) block=(256,1,1) lds=163840
.amdgcn_target "amdgcn-amd-amdhsa--gfx950"
.text
.globl main_kernel
.p2align 8
.type main_kernel,@function
main_kernel:
  s_cmp_ge_u32 s2, 256
  s_cbranch_scc1 ch_end
  s_load_dwordx2 s[4:5], s[0:1], 120
  s_load_dwordx2 s[6:7], s[0:1], 128
  s_load_dwordx8 s[40:47], s[0:1], 72
  s_load_dwordx4 s[48:51], s[0:1], 56
  s_mov_b32 s32, 0
  s_getreg_b32 s3, hwreg(HW_REG_XCC_ID)
  s_and_b32 s3, s3, 15
  s_cmp_lg_u32 s3, 1
  s_cbranch_scc1 ch_pf
  s_cmp_lt_u32 s2, 224
  s_cbranch_scc1 ch_npf
ch_pf:
  s_getpc_b64 s[98:99]
pf_main_kernel_1:
  s_sub_u32 s98, s98, pf_main_kernel_1-main_kernel
  s_subb_u32 s99, s99, 0
  v_lshlrev_b32 v60, 7, v0
  v_min_u32 v61, ch_end-main_kernel-4, v60
  global_load_dword v62, v61, s[98:99]
  v_add_u32 v60, 32768, v60
  v_min_u32 v61, ch_end-main_kernel-4, v60
  global_load_dword v62, v61, s[98:99]
  v_add_u32 v60, 32768, v60
  v_min_u32 v61, ch_end-main_kernel-4, v60
  global_load_dword v62, v61, s[98:99]
  v_add_u32 v60, 32768, v60
  v_min_u32 v61, ch_end-main_kernel-4, v60
  global_load_dword v62, v61, s[98:99]
  v_add_u32 v60, 32768, v60
  v_min_u32 v61, ch_end-main_kernel-4, v60
  global_load_dword v62, v61, s[98:99]
  v_add_u32 v60, 32768, v60
ch_npf:
  v_lshrrev_b32 v1, 6, v0
  s_nop 0
  v_readfirstlane_b32 s16, v1
  s_waitcnt lgkmcnt(0)
  s_mov_b32 s8, s6
  s_and_b32 s9, s7, 0xffff
  s_mov_b32 s10, 0x10000000
  s_mov_b32 s11, 0x20000
  s_mov_b32 s12, s4
  s_and_b32 s13, s5, 0xffff
  s_mov_b32 s14, 256
  s_mov_b32 s15, 0x20000
  v_mov_b32 v252, 0x40000000
  v_cmp_eq_u32 vcc, 0, v0
  s_nop 1
  v_cndmask_b32 v252, v252, v0, vcc
  s_cmp_lg_u32 s3, 1
  s_cbranch_scc1 ch_worker
  s_mov_b32 s18, 0
  v_mov_b32 v249, 1
  s_mov_b64 exec, 1
  buffer_atomic_add v249, v252, s[12:15], 0 offen sc0
  s_mov_b64 exec, -1
  v_and_b32 v1, 63, v0
  v_lshlrev_b32 v2, 4, v1
  v_lshrrev_b32 v3, 4, v1
  v_and_b32 v4, 15, v1
  s_lshr_b32 s33, s2, 3
  s_lshl_b32 s27, s33, 2
  s_add_u32 s27, s27, s16
  s_lshl_b32 s27, s27, 13
  v_lshlrev_b32 v12, 7, v1
  s_mov_b32 s64, s42
  s_and_b32 s65, s43, 0xffff
  s_mov_b32 s66, 2097152
  s_mov_b32 s67, 0x20000
  s_mov_b32 s28, s27
  buffer_load_dword v13, v12, s[64:67], s28 offen
  s_add_u32 s28, s28, 1048576
  buffer_load_dword v13, v12, s[64:67], s28 offen
  s_add_u32 s28, s28, 1048576
  s_waitcnt vmcnt(2)
  v_readfirstlane_b32 s17, v249
  v_mov_b32 v6, 160032
  s_nop 0
  v_mov_b32 v7, s17
  s_barrier
  s_cmp_lg_u32 s16, 0
  s_cbranch_scc1 uni_2
  ds_write_b32 v6, v7
  s_waitcnt lgkmcnt(0)
uni_2:
  s_barrier
  ds_read_b32 v7, v6
  s_waitcnt lgkmcnt(0)
  v_readfirstlane_b32 s17, v7
  s_branch ch_got
ch_take:
  v_mov_b32 v5, 0
  v_mov_b32 v6, 160000
  s_barrier
  s_cmp_lg_u32 s16, 0
  s_cbranch_scc1 ch_el1
  s_mov_b64 exec, 1
  buffer_atomic_add v4, v5, s[12:15], 0 offen sc0
  s_waitcnt vmcnt(0)
  ds_write_b32 v6, v4
  s_waitcnt lgkmcnt(0)
  s_mov_b64 exec, -1
ch_el1:
  s_barrier
  ds_read_b32 v4, v6
  s_waitcnt lgkmcnt(0)
  v_readfirstlane_b32 s17, v4
ch_got:
  s_and_b32 s17, s17, 0xffff
  s_cmp_lt_u32 s17, 32
  s_cbranch_scc1 ch_role
  s_cmp_eq_u32 s18, 0
  s_cbranch_scc1 ch_worker
  v_and_b32 v1, 63, v0
  v_lshlrev_b32 v2, 4, v1
  v_lshrrev_b32 v3, 4, v1
  v_and_b32 v4, 15, v1
  s_branch wp_all
ch_role:
  v_and_b32 v1, 63, v0
  v_lshlrev_b32 v2, 4, v1
  v_lshrrev_b32 v3, 4, v1
  v_and_b32 v4, 15, v1
  s_cmp_lt_u32 s17, 16
  s_cbranch_scc1 ch_self
  s_cmp_lt_u32 s17, 24
  s_cbranch_scc1 ch_tch
  s_sub_u32 s33, s17, 24
  v_mov_b32 v10, 0x40000000
  v_mov_b32 v5, 1
  v_mov_b32 v148, 0
  v_mov_b32 v149, 0
  v_mov_b32 v150, 0
  v_mov_b32 v151, 0
  v_mov_b32 v152, -1
  v_mov_b32 v153, -1
  v_mov_b32 v154, -1
  v_mov_b32 v155, -1
  v_lshlrev_b32 v8, 4, v0
  s_mov_b32 s64, s48
  s_and_b32 s65, s49, 0xffff
  s_mov_b32 s66, 1835008
  s_mov_b32 s67, 0x20000
  s_lshl_b32 s21, s33, 2
  s_add_u32 s21, s21, s16
  s_lshr_b32 s22, s21, 1
  s_mul_i32 s22, s22, 14336
  s_and_b32 s24, s21, 1
  s_mul_i32 s24, s24, 448
  s_add_u32 s22, s22, s24
  s_mul_i32 s21, s21, 7168
  v_mul_u32_u24 v7, 896, v4
  v_lshl_add_u32 v7, v3, 4, v7
  buffer_load_dwordx4 v[64:67], v7, s[64:67], s22 offen offset:0
  buffer_load_dwordx4 v[68:71], v7, s[64:67], s22 offen offset:64
  buffer_load_dwordx4 v[72:75], v7, s[64:67], s22 offen offset:128
  buffer_load_dwordx4 v[76:79], v7, s[64:67], s22 offen offset:192
  buffer_load_dwordx4 v[80:83], v7, s[64:67], s22 offen offset:256
  buffer_load_dwordx4 v[84:87], v7, s[64:67], s22 offen offset:320
  buffer_load_dwordx4 v[88:91], v7, s[64:67], s22 offen offset:384
  s_mov_b32 s68, s50
  s_and_b32 s69, s51, 0xffff
  s_mov_b32 s70, 7168
  s_mov_b32 s71, 0x20000
  v_lshrrev_b32 v6, 3, v0
  v_min_u32 v6, 27, v6
  v_and_b32 v7, 7, v0
  v_mul_u32_u24 v9, 896, v7
  v_lshl_add_u32 v9, v6, 5, v9
  buffer_load_dwordx4 v[176:179], v9, s[68:71], 0 offen
  buffer_load_dwordx4 v[180:183], v9, s[68:71], 0 offen offset:16
  s_cmp_lg_u32 s33, 0
  s_cbranch_scc1 ch_ij_1
  s_mov_b32 s23, 582144
  buffer_store_dwordx4 v[148:151], v8, s[8:11], s23 offen sc1
  s_mov_b32 s23, 586240
  buffer_store_dwordx4 v[148:151], v8, s[8:11], s23 offen sc1
  s_waitcnt vmcnt(0)
  s_barrier
  buffer_store_dword v5, v252, s[12:15], 0 offen offset:128 sc1
ch_ij_1:
  s_waitcnt vmcnt(1)
  s_add_u32 s23, s21, 655360
  buffer_store_dwordx4 v[64:67], v2, s[8:11], s23 offen offset:0 sc1
  buffer_store_dwordx4 v[68:71], v2, s[8:11], s23 offen offset:1024 sc1
  buffer_store_dwordx4 v[72:75], v2, s[8:11], s23 offen offset:2048 sc1
  buffer_store_dwordx4 v[76:79], v2, s[8:11], s23 offen offset:3072 sc1
  s_add_u32 s23, s21, 659456
  buffer_store_dwordx4 v[80:83], v2, s[8:11], s23 offen offset:0 sc1
  buffer_store_dwordx4 v[84:87], v2, s[8:11], s23 offen offset:1024 sc1
  buffer_store_dwordx4 v[88:91], v2, s[8:11], s23 offen offset:2048 sc1
  s_waitcnt vmcnt(0)
  s_barrier
  s_cmp_lg_u32 s16, 0
  s_cbranch_scc1 ch_ij_x_e
  v_mov_b32 v6, 1
  s_mov_b64 exec, 1
  buffer_atomic_add v6, v252, s[12:15], 0 offen offset:4 sc0
  s_waitcnt vmcnt(0)
  v_readfirstlane_b32 s20, v6
  s_cmp_lg_u32 s20, 7
  s_cbranch_scc1 ch_ij_x_e0
  s_mov_b64 exec, 0xff
  v_lshlrev_b32 v6, 7, v0
  s_mov_b32 s20, 586240
  buffer_store_dword v5, v6, s[8:11], s20 offen offset:8 sc1
ch_ij_x_e0:
  s_mov_b64 exec, -1
ch_ij_x_e:
  s_lshl_b32 s20, s33, 12
  v_add_u32 v8, s20, v8
  s_mov_b32 s23, 524288
ch_ijlp_3:
  buffer_store_dwordx4 v[148:151], v8, s[8:11], s23 offen sc1
  s_add_u32 s23, s23, 32768
  s_cmp_lt_u32 s23, 557056
  s_cbranch_scc1 ch_ijlp_3
  v_cmp_gt_u32 vcc, 25088, v8
  s_nop 1
  v_cndmask_b32 v9, v10, v8, vcc
  buffer_store_dwordx4 v[148:151], v9, s[8:11], s23 offen sc1
  s_mov_b32 s23, 35328
  v_cmp_gt_u32 vcc, 6144, v8
  s_nop 1
  v_cndmask_b32 v9, v10, v8, vcc
  buffer_store_dwordx4 v[148:151], v9, s[8:11], s23 offen sc1
  s_mov_b32 s23, 7168
  v_cmp_gt_u32 vcc, 28160, v8
  s_nop 1
  v_cndmask_b32 v9, v10, v8, vcc
  buffer_store_dwordx4 v[152:155], v9, s[8:11], s23 offen sc1
  s_mov_b32 s23, 72704
ch_ijlp_4:
  buffer_store_dwordx4 v[152:155], v8, s[8:11], s23 offen sc1
  s_add_u32 s23, s23, 32768
  s_cmp_lt_u32 s23, 498688
  s_cbranch_scc1 ch_ijlp_4
  v_cmp_gt_u32 vcc, 25600, v8
  s_nop 1
  v_cndmask_b32 v9, v10, v8, vcc
  buffer_store_dwordx4 v[152:155], v9, s[8:11], s23 offen sc1
  s_cmp_lg_u32 s33, 1
  s_cbranch_scc1 ch_ij_nm
  v_lshrrev_b32 v6, 3, v0
  v_and_b32 v7, 7, v0
  v_lshlrev_b32 v8, 8, v6
  v_lshl_add_u32 v8, v7, 4, v8
  v_cmp_gt_u32 vcc, 28, v6
  s_nop 1
  v_cndmask_b32 v8, v10, v8, vcc
  s_waitcnt vmcnt(4)
  v_min_u32 v184, -2, v176
  v_min_u32 v188, -2, v177
  v_min_u32 v185, -2, v178
  v_min_u32 v189, -2, v179
  v_min_u32 v186, -2, v180
  v_min_u32 v190, -2, v181
  v_min_u32 v187, -2, v182
  v_min_u32 v191, -2, v183
  s_mov_b32 s23, 0
  buffer_store_dwordx4 v[184:187], v8, s[8:11], s23 offen sc1
  buffer_store_dwordx4 v[188:191], v8, s[8:11], s23 offen offset:128 sc1
  s_mov_b32 s23, 65536
  buffer_store_dwordx4 v[184:187], v8, s[8:11], s23 offen sc1
  buffer_store_dwordx4 v[188:191], v8, s[8:11], s23 offen offset:128 sc1
ch_ij_nm:
  s_waitcnt vmcnt(0)
  s_barrier
  s_cmp_lg_u32 s16, 0
  s_cbranch_scc1 ch_ij_e
  v_mov_b32 v6, 1
  s_mov_b64 exec, 1
  buffer_atomic_add v6, v252, s[12:15], 0 offen offset:12 sc0
  s_waitcnt vmcnt(0)
  v_readfirstlane_b32 s20, v6
  s_cmp_lg_u32 s20, 7
  s_cbranch_scc1 ch_ij_e0
  buffer_store_dword v5, v252, s[12:15], 0 offen offset:132 sc1
  s_mov_b64 exec, 0xff
  v_lshlrev_b32 v6, 7, v0
  s_mov_b32 s20, 586240
  buffer_store_dword v5, v6, s[8:11], s20 offen offset:4 sc1
ch_ij_e0:
  s_mov_b64 exec, -1
ch_ij_e:
  s_branch ch_role2
ch_tch:
  s_sub_u32 s33, s17, 16
  s_lshl_b32 s27, s33, 2
  s_add_u32 s27, s27, s16
  s_lshl_b32 s27, s27, 13
  v_lshlrev_b32 v12, 7, v1
  s_mov_b32 s64, s40
  s_and_b32 s65, s41, 0xffff
  s_mov_b32 s66, 2097152
  s_mov_b32 s67, 0x20000
  s_mov_b32 s28, s27
  buffer_load_dword v13, v12, s[64:67], s28 offen
  s_add_u32 s28, s28, 262144
  buffer_load_dword v13, v12, s[64:67], s28 offen
  s_add_u32 s28, s28, 262144
  buffer_load_dword v13, v12, s[64:67], s28 offen
  s_add_u32 s28, s28, 262144
  buffer_load_dword v13, v12, s[64:67], s28 offen
  s_add_u32 s28, s28, 262144
  buffer_load_dword v13, v12, s[64:67], s28 offen
  s_add_u32 s28, s28, 262144
  buffer_load_dword v13, v12, s[64:67], s28 offen
  s_add_u32 s28, s28, 262144
  buffer_load_dword v13, v12, s[64:67], s28 offen
  s_add_u32 s28, s28, 262144
  buffer_load_dword v13, v12, s[64:67], s28 offen
  s_add_u32 s28, s28, 262144
  s_branch ch_role2
ch_self:
  v_lshrrev_b32 v5, 5, v1
  v_and_b32 v6, 31, v1
  v_xor_b32 v8, v6, v5
  v_lshlrev_b32 v8, 4, v8
  v_lshl_add_u32 v16, v5, 13, v8
  v_xor_b32 v17, 32, v16
  v_xor_b32 v18, 64, v16
  v_xor_b32 v19, 96, v16
  v_xor_b32 v20, 128, v16
  v_xor_b32 v21, 160, v16
  v_xor_b32 v22, 192, v16
  v_xor_b32 v23, 224, v16
  s_lshl_b32 s20, s16, 6
  v_xor_b32 v26, s20, v16
  v_xor_b32 v27, 32, v26
  s_mov_b32 s60, s40
  s_and_b32 s61, s41, 0xffff
  s_mov_b32 s62, 3670016
  s_mov_b32 s63, 0x20000
  s_mov_b32 s56, s42
  s_and_b32 s57, s43, 0xffff
  s_mov_b32 s58, 3670016
  s_mov_b32 s59, 0x20000
  s_lshl_b32 s26, s17, 9
  s_lshl_b32 s27, s16, 19
  s_add_u32 s27, s27, s26
  s_lshl_b32 s25, s16, 15
  s_add_u32 s25, s25, 32768
  s_barrier
  s_add_u32 m0, s25, 0
  s_nop 0
  buffer_load_dwordx4 v16, s[56:59], s27 offen lds
  s_add_u32 s27, s27, 16384
  s_add_u32 m0, s25, 1024
  s_nop 0
  buffer_load_dwordx4 v16, s[56:59], s27 offen lds
  s_add_u32 s27, s27, 16384
  s_add_u32 m0, s25, 2048
  s_nop 0
  buffer_load_dwordx4 v17, s[56:59], s27 offen lds
  s_add_u32 s27, s27, 16384
  s_add_u32 m0, s25, 3072
  s_nop 0
  buffer_load_dwordx4 v17, s[56:59], s27 offen lds
  s_add_u32 s27, s27, 16384
  s_add_u32 m0, s25, 4096
  s_nop 0
  buffer_load_dwordx4 v16, s[56:59], s27 offen lds
  s_add_u32 s27, s27, 16384
  s_add_u32 m0, s25, 5120
  s_nop 0
  buffer_load_dwordx4 v16, s[56:59], s27 offen lds
  s_add_u32 s27, s27, 16384
  s_add_u32 m0, s25, 6144
  s_nop 0
  buffer_load_dwordx4 v17, s[56:59], s27 offen lds
  s_add_u32 s27, s27, 16384
  s_add_u32 m0, s25, 7168
  s_nop 0
  buffer_load_dwordx4 v17, s[56:59], s27 offen lds
  s_add_u32 s27, s27, 16384
  s_add_u32 m0, s25, 8192
  s_nop 0
  buffer_load_dwordx4 v18, s[56:59], s27 offen lds
  s_add_u32 s27, s27, 16384
  s_add_u32 m0, s25, 9216
  s_nop 0
  buffer_load_dwordx4 v18, s[56:59], s27 offen lds
  s_add_u32 s27, s27, 16384
  s_add_u32 m0, s25, 10240
  s_nop 0
  buffer_load_dwordx4 v19, s[56:59], s27 offen lds
  s_add_u32 s27, s27, 16384
  s_add_u32 m0, s25, 11264
  s_nop 0
  buffer_load_dwordx4 v19, s[56:59], s27 offen lds
  s_add_u32 s27, s27, 16384
  s_add_u32 m0, s25, 12288
  s_nop 0
  buffer_load_dwordx4 v18, s[56:59], s27 offen lds
  s_add_u32 s27, s27, 16384
  s_add_u32 m0, s25, 13312
  s_nop 0
  buffer_load_dwordx4 v18, s[56:59], s27 offen lds
  s_add_u32 s27, s27, 16384
  s_add_u32 m0, s25, 14336
  s_nop 0
  buffer_load_dwordx4 v19, s[56:59], s27 offen lds
  s_add_u32 s27, s27, 16384
  s_add_u32 m0, s25, 15360
  s_nop 0
  buffer_load_dwordx4 v19, s[56:59], s27 offen lds
  s_add_u32 s27, s27, 16384
  s_add_u32 m0, s25, 16384
  s_nop 0
  buffer_load_dwordx4 v20, s[56:59], s27 offen lds
  s_add_u32 s27, s27, 16384
  s_add_u32 m0, s25, 17408
  s_nop 0
  buffer_load_dwordx4 v20, s[56:59], s27 offen lds
  s_add_u32 s27, s27, 16384
  s_add_u32 m0, s25, 18432
  s_nop 0
  buffer_load_dwordx4 v21, s[56:59], s27 offen lds
  s_add_u32 s27, s27, 16384
  s_add_u32 m0, s25, 19456
  s_nop 0
  buffer_load_dwordx4 v21, s[56:59], s27 offen lds
  s_add_u32 s27, s27, 16384
  s_add_u32 m0, s25, 20480
  s_nop 0
  buffer_load_dwordx4 v20, s[56:59], s27 offen lds
  s_add_u32 s27, s27, 16384
  s_add_u32 m0, s25, 21504
  s_nop 0
  buffer_load_dwordx4 v20, s[56:59], s27 offen lds
  s_add_u32 s27, s27, 16384
  s_add_u32 m0, s25, 22528
  s_nop 0
  buffer_load_dwordx4 v21, s[56:59], s27 offen lds
  s_add_u32 s27, s27, 16384
  s_add_u32 m0, s25, 23552
  s_nop 0
  buffer_load_dwordx4 v21, s[56:59], s27 offen lds
  s_add_u32 s27, s27, 16384
  s_add_u32 m0, s25, 24576
  s_nop 0
  buffer_load_dwordx4 v22, s[56:59], s27 offen lds
  s_add_u32 s27, s27, 16384
  s_add_u32 m0, s25, 25600
  s_nop 0
  buffer_load_dwordx4 v22, s[56:59], s27 offen lds
  s_add_u32 s27, s27, 16384
  s_add_u32 m0, s25, 26624
  s_nop 0
  buffer_load_dwordx4 v23, s[56:59], s27 offen lds
  s_add_u32 s27, s27, 16384
  s_add_u32 m0, s25, 27648
  s_nop 0
  buffer_load_dwordx4 v23, s[56:59], s27 offen lds
  s_add_u32 s27, s27, 16384
  s_add_u32 m0, s25, 28672
  s_nop 0
  buffer_load_dwordx4 v22, s[56:59], s27 offen lds
  s_add_u32 s27, s27, 16384
  s_add_u32 m0, s25, 29696
  s_nop 0
  buffer_load_dwordx4 v22, s[56:59], s27 offen lds
  s_add_u32 s27, s27, 16384
  s_add_u32 m0, s25, 30720
  s_nop 0
  buffer_load_dwordx4 v23, s[56:59], s27 offen lds
  s_add_u32 s27, s27, 16384
  s_add_u32 m0, s25, 31744
  s_nop 0
  buffer_load_dwordx4 v23, s[56:59], s27 offen lds
  s_add_u32 s27, s27, 16384
  v_mov_b32 v14, v26
  v_mov_b32 v15, v27
  s_lshl_b32 s28, s16, 16
  s_add_u32 s28, s28, s26
  s_lshl_b32 s29, s16, 12
  s_add_u32 m0, s29, 0
  s_add_u32 s27, s28, 0
  buffer_load_dwordx4 v14, s[60:63], s27 offen lds
  s_add_u32 m0, s29, 1024
  s_add_u32 s27, s28, 16384
  buffer_load_dwordx4 v15, s[60:63], s27 offen lds
  s_add_u32 m0, s29, 2048
  s_add_u32 s27, s28, 32768
  buffer_load_dwordx4 v14, s[60:63], s27 offen lds
  s_add_u32 m0, s29, 3072
  s_add_u32 s27, s28, 49152
  buffer_load_dwordx4 v15, s[60:63], s27 offen lds
  s_add_u32 m0, s29, 16384
  s_add_u32 s27, s28, 262144
  buffer_load_dwordx4 v14, s[60:63], s27 offen lds
  s_add_u32 m0, s29, 17408
  s_add_u32 s27, s28, 278528
  buffer_load_dwordx4 v15, s[60:63], s27 offen lds
  s_add_u32 m0, s29, 18432
  s_add_u32 s27, s28, 294912
  buffer_load_dwordx4 v14, s[60:63], s27 offen lds
  s_add_u32 m0, s29, 19456
  s_add_u32 s27, s28, 311296
  buffer_load_dwordx4 v15, s[60:63], s27 offen lds
  v_lshrrev_b32 v7, 2, v4
  v_lshlrev_b32 v11, 4, v7
  v_lshlrev_b32 v7, 3, v7
  v_and_b32 v8, 3, v4
  v_add_u32 v7, v7, v8
  v_and_b32 v8, 2, v4
  v_lshl_add_u32 v11, v8, 1, v11
  v_and_b32 v8, 1, v4
  v_add_u32 v11, v11, v8
  v_or_b32 v10, 0, v3
  v_xor_b32 v10, v10, v4
  v_lshlrev_b32 v10, 4, v10
  v_lshl_add_u32 v248, v7, 9, v10
  v_add_u32 v252, 65536, v248
  v_add_u32 v16, 131072, v248
  v_lshl_add_u32 v10, v11, 9, v10
  v_add_u32 v20, s25, v10
  v_or_b32 v10, 4, v3
  v_xor_b32 v10, v10, v4
  v_lshlrev_b32 v10, 4, v10
  v_lshl_add_u32 v249, v7, 9, v10
  v_add_u32 v253, 65536, v249
  v_add_u32 v17, 131072, v249
  v_lshl_add_u32 v10, v11, 9, v10
  v_add_u32 v21, s25, v10
  v_or_b32 v10, 8, v3
  v_xor_b32 v10, v10, v4
  v_lshlrev_b32 v10, 4, v10
  v_lshl_add_u32 v250, v7, 9, v10
  v_add_u32 v254, 65536, v250
  v_add_u32 v18, 131072, v250
  v_lshl_add_u32 v10, v11, 9, v10
  v_add_u32 v22, s25, v10
  v_or_b32 v10, 12, v3
  v_xor_b32 v10, v10, v4
  v_lshlrev_b32 v10, 4, v10
  v_lshl_add_u32 v251, v7, 9, v10
  v_add_u32 v255, 65536, v251
  v_add_u32 v19, 131072, v251
  v_lshl_add_u32 v10, v11, 9, v10
  v_add_u32 v23, s25, v10
  v_mov_b32 v12, 1035512379
  v_lshlrev_b32 v6, 7, v1
  s_getpc_b64 s[98:99]
  global_load_dword v7, v6, s[98:99]
  s_waitcnt vmcnt(9)
  ds_read_b128 v[120:123], v20 offset:0
  ds_read_b128 v[124:127], v21 offset:0
  ds_read_b128 v[128:131], v22 offset:0
  ds_read_b128 v[132:135], v23 offset:0
  ds_read_b128 v[136:139], v20 offset:256
  ds_read_b128 v[140:143], v21 offset:256
  ds_read_b128 v[144:147], v22 offset:256
  ds_read_b128 v[148:151], v23 offset:256
  s_waitcnt lgkmcnt(8)
  ds_read_b128 v[152:155], v20 offset:1024
  ds_read_b128 v[156:159], v21 offset:1024
  ds_read_b128 v[160:163], v22 offset:1024
  ds_read_b128 v[164:167], v23 offset:1024
  ds_read_b128 v[168:171], v20 offset:1280
  ds_read_b128 v[172:175], v21 offset:1280
  ds_read_b128 v[176:179], v22 offset:1280
  ds_read_b128 v[180:183], v23 offset:1280
  s_waitcnt lgkmcnt(8)
  ds_read_b128 v[184:187], v20 offset:4096
  ds_read_b128 v[188:191], v21 offset:4096
  ds_read_b128 v[192:195], v22 offset:4096
  ds_read_b128 v[196:199], v23 offset:4096
  ds_read_b128 v[200:203], v20 offset:4352
  ds_read_b128 v[204:207], v21 offset:4352
  ds_read_b128 v[208:211], v22 offset:4352
  ds_read_b128 v[212:215], v23 offset:4352
  s_waitcnt lgkmcnt(8)
  ds_read_b128 v[216:219], v20 offset:5120
  ds_read_b128 v[220:223], v21 offset:5120
  ds_read_b128 v[224:227], v22 offset:5120
  ds_read_b128 v[228:231], v23 offset:5120
  ds_read_b128 v[232:235], v20 offset:5376
  ds_read_b128 v[236:239], v21 offset:5376
  ds_read_b128 v[240:243], v22 offset:5376
  ds_read_b128 v[244:247], v23 offset:5376
  s_waitcnt lgkmcnt(8)
  s_waitcnt vmcnt(4) lgkmcnt(0)
  s_barrier
  s_add_u32 m0, s29, 32768
  s_add_u32 s27, s28, 524288
  buffer_load_dwordx4 v14, s[60:63], s27 offen lds
  s_add_u32 m0, s29, 33792
  s_add_u32 s27, s28, 540672
  buffer_load_dwordx4 v15, s[60:63], s27 offen lds
  s_add_u32 m0, s29, 34816
  s_add_u32 s27, s28, 557056
  buffer_load_dwordx4 v14, s[60:63], s27 offen lds
  s_add_u32 m0, s29, 35840
  s_add_u32 s27, s28, 573440
  buffer_load_dwordx4 v15, s[60:63], s27 offen lds
  s_add_u32 m0, s29, 49152
  s_add_u32 s27, s28, 786432
  buffer_load_dwordx4 v14, s[60:63], s27 offen lds
  s_add_u32 m0, s29, 50176
  s_add_u32 s27, s28, 802816
  buffer_load_dwordx4 v15, s[60:63], s27 offen lds
  s_add_u32 m0, s29, 51200
  s_add_u32 s27, s28, 819200
  buffer_load_dwordx4 v14, s[60:63], s27 offen lds
  s_add_u32 m0, s29, 52224
  s_add_u32 s27, s28, 835584
  buffer_load_dwordx4 v15, s[60:63], s27 offen lds
  s_add_u32 m0, s29, 65536
  s_add_u32 s27, s28, 1048576
  buffer_load_dwordx4 v14, s[60:63], s27 offen lds
  s_add_u32 m0, s29, 66560
  s_add_u32 s27, s28, 1064960
  buffer_load_dwordx4 v15, s[60:63], s27 offen lds
  s_add_u32 m0, s29, 67584
  s_add_u32 s27, s28, 1081344
  buffer_load_dwordx4 v14, s[60:63], s27 offen lds
  s_add_u32 m0, s29, 68608
  s_add_u32 s27, s28, 1097728
  buffer_load_dwordx4 v15, s[60:63], s27 offen lds
  s_add_u32 m0, s29, 81920
  s_add_u32 s27, s28, 1310720
  buffer_load_dwordx4 v14, s[60:63], s27 offen lds
  s_add_u32 m0, s29, 82944
  s_add_u32 s27, s28, 1327104
  buffer_load_dwordx4 v15, s[60:63], s27 offen lds
  s_add_u32 m0, s29, 83968
  s_add_u32 s27, s28, 1343488
  buffer_load_dwordx4 v14, s[60:63], s27 offen lds
  s_add_u32 m0, s29, 84992
  s_add_u32 s27, s28, 1359872
  buffer_load_dwordx4 v15, s[60:63], s27 offen lds
  ds_read_b128 v[24:27], v248 offset:0
  ds_read_b128 v[28:31], v248 offset:2048
  ds_read_b128 v[32:35], v249 offset:0
  ds_read_b128 v[36:39], v249 offset:2048
  ds_read_b128 v[40:43], v250 offset:0
  ds_read_b128 v[44:47], v250 offset:2048
  s_waitcnt lgkmcnt(5)
  s_getpc_b64 s[98:99]
  s_add_u32 s98, s98, 4096
  s_addc_u32 s99, s99, 0
  global_load_dword v7, v6, s[98:99]
  v_mfma_f32_16x16x32_bf16 v[56:59], v[24:27], v[120:123], 0
  ds_read_b128 v[48:51], v251 offset:0
  v_mfma_f32_16x16x32_bf16 v[64:67], v[24:27], v[152:155], 0
  v_mfma_f32_16x16x32_bf16 v[72:75], v[24:27], v[184:187], 0
  s_add_u32 m0, s29, 98304
  s_add_u32 s27, s28, 1572864
  buffer_load_dwordx4 v14, s[60:63], s27 offen lds
  v_mfma_f32_16x16x32_bf16 v[80:83], v[24:27], v[216:219], 0
  s_waitcnt lgkmcnt(5)
  v_mfma_f32_16x16x32_bf16 v[60:63], v[28:31], v[120:123], 0
  ds_read_b128 v[52:55], v251 offset:2048
  v_mfma_f32_16x16x32_bf16 v[68:71], v[28:31], v[152:155], 0
  v_mfma_f32_16x16x32_bf16 v[76:79], v[28:31], v[184:187], 0
  v_mfma_f32_16x16x32_bf16 v[84:87], v[28:31], v[216:219], 0
  s_waitcnt lgkmcnt(5)
  v_mfma_f32_16x16x32_bf16 v[56:59], v[32:35], v[124:127], v[56:59]
  ds_read_b128 v[24:27], v248 offset:256
  v_mfma_f32_16x16x32_bf16 v[64:67], v[32:35], v[156:159], v[64:67]
  v_mfma_f32_16x16x32_bf16 v[72:75], v[32:35], v[188:191], v[72:75]
  s_add_u32 m0, s29, 99328
  s_add_u32 s27, s28, 1589248
  buffer_load_dwordx4 v15, s[60:63], s27 offen lds
  v_mfma_f32_16x16x32_bf16 v[80:83], v[32:35], v[220:223], v[80:83]
  s_waitcnt lgkmcnt(5)
  v_mfma_f32_16x16x32_bf16 v[60:63], v[36:39], v[124:127], v[60:63]
  ds_read_b128 v[28:31], v248 offset:2304
  v_mfma_f32_16x16x32_bf16 v[68:71], v[36:39], v[156:159], v[68:71]
  v_mfma_f32_16x16x32_bf16 v[76:79], v[36:39], v[188:191], v[76:79]
  v_mfma_f32_16x16x32_bf16 v[84:87], v[36:39], v[220:223], v[84:87]
  s_waitcnt lgkmcnt(5)
  v_mfma_f32_16x16x32_bf16 v[56:59], v[40:43], v[128:131], v[56:59]
  ds_read_b128 v[32:35], v249 offset:256
  v_mfma_f32_16x16x32_bf16 v[64:67], v[40:43], v[160:163], v[64:67]
  v_mfma_f32_16x16x32_bf16 v[72:75], v[40:43], v[192:195], v[72:75]
  s_add_u32 m0, s29, 100352
  s_add_u32 s27, s28, 1605632
  buffer_load_dwordx4 v14, s[60:63], s27 offen lds
  v_mfma_f32_16x16x32_bf16 v[80:83], v[40:43], v[224:227], v[80:83]
  s_waitcnt lgkmcnt(5)
  v_mfma_f32_16x16x32_bf16 v[60:63], v[44:47], v[128:131], v[60:63]
  ds_read_b128 v[36:39], v249 offset:2304
  v_mfma_f32_16x16x32_bf16 v[68:71], v[44:47], v[160:163], v[68:71]
  v_mfma_f32_16x16x32_bf16 v[76:79], v[44:47], v[192:195], v[76:79]
  v_mfma_f32_16x16x32_bf16 v[84:87], v[44:47], v[224:227], v[84:87]
  s_waitcnt lgkmcnt(5)
  v_mfma_f32_16x16x32_bf16 v[56:59], v[48:51], v[132:135], v[56:59]
  ds_read_b128 v[40:43], v250 offset:256
  v_mfma_f32_16x16x32_bf16 v[64:67], v[48:51], v[164:167], v[64:67]
  v_mfma_f32_16x16x32_bf16 v[72:75], v[48:51], v[196:199], v[72:75]
  s_add_u32 m0, s29, 101376
  s_add_u32 s27, s28, 1622016
  buffer_load_dwordx4 v15, s[60:63], s27 offen lds
  v_mfma_f32_16x16x32_bf16 v[80:83], v[48:51], v[228:231], v[80:83]
  s_waitcnt lgkmcnt(5)
  v_mfma_f32_16x16x32_bf16 v[60:63], v[52:55], v[132:135], v[60:63]
  ds_read_b128 v[44:47], v250 offset:2304
  v_mfma_f32_16x16x32_bf16 v[68:71], v[52:55], v[164:167], v[68:71]
  v_mfma_f32_16x16x32_bf16 v[76:79], v[52:55], v[196:199], v[76:79]
  v_mfma_f32_16x16x32_bf16 v[84:87], v[52:55], v[228:231], v[84:87]
  s_waitcnt lgkmcnt(5)
  v_mfma_f32_16x16x32_bf16 v[56:59], v[24:27], v[136:139], v[56:59]
  ds_read_b128 v[48:51], v251 offset:256
  v_mfma_f32_16x16x32_bf16 v[64:67], v[24:27], v[168:171], v[64:67]
  v_mfma_f32_16x16x32_bf16 v[72:75], v[24:27], v[200:203], v[72:75]
  v_mfma_f32_16x16x32_bf16 v[80:83], v[24:27], v[232:235], v[80:83]
  s_waitcnt lgkmcnt(5)
  v_mfma_f32_16x16x32_bf16 v[60:63], v[28:31], v[136:139], v[60:63]
  ds_read_b128 v[52:55], v251 offset:2304
  v_mfma_f32_16x16x32_bf16 v[68:71], v[28:31], v[168:171], v[68:71]
  v_mfma_f32_16x16x32_bf16 v[76:79], v[28:31], v[200:203], v[76:79]
  v_mfma_f32_16x16x32_bf16 v[84:87], v[28:31], v[232:235], v[84:87]
  s_waitcnt lgkmcnt(5)
  v_mfma_f32_16x16x32_bf16 v[56:59], v[32:35], v[140:143], v[56:59]
  s_waitcnt vmcnt(20)
  s_barrier
  ds_read_b128 v[24:27], v248 offset:16384
  v_mfma_f32_16x16x32_bf16 v[64:67], v[32:35], v[172:175], v[64:67]
  v_mfma_f32_16x16x32_bf16 v[72:75], v[32:35], v[204:207], v[72:75]
  v_mfma_f32_16x16x32_bf16 v[80:83], v[32:35], v[236:239], v[80:83]
  s_waitcnt lgkmcnt(5)
  v_mfma_f32_16x16x32_bf16 v[60:63], v[36:39], v[140:143], v[60:63]
  ds_read_b128 v[28:31], v248 offset:18432
  v_mfma_f32_16x16x32_bf16 v[68:71], v[36:39], v[172:175], v[68:71]
  v_mfma_f32_16x16x32_bf16 v[76:79], v[36:39], v[204:207], v[76:79]
  v_mfma_f32_16x16x32_bf16 v[84:87], v[36:39], v[236:239], v[84:87]
  s_waitcnt lgkmcnt(5)
  v_mfma_f32_16x16x32_bf16 v[56:59], v[40:43], v[144:147], v[56:59]
  ds_read_b128 v[32:35], v249 offset:16384
  v_mfma_f32_16x16x32_bf16 v[64:67], v[40:43], v[176:179], v[64:67]
  v_mfma_f32_16x16x32_bf16 v[72:75], v[40:43], v[208:211], v[72:75]
  v_mfma_f32_16x16x32_bf16 v[80:83], v[40:43], v[240:243], v[80:83]
  s_waitcnt lgkmcnt(5)
  v_mfma_f32_16x16x32_bf16 v[60:63], v[44:47], v[144:147], v[60:63]
  ds_read_b128 v[36:39], v249 offset:18432
  v_mfma_f32_16x16x32_bf16 v[68:71], v[44:47], v[176:179], v[68:71]
  v_mfma_f32_16x16x32_bf16 v[76:79], v[44:47], v[208:211], v[76:79]
  v_mfma_f32_16x16x32_bf16 v[84:87], v[44:47], v[240:243], v[84:87]
  s_waitcnt lgkmcnt(5)
  v_mfma_f32_16x16x32_bf16 v[56:59], v[48:51], v[148:151], v[56:59]
  ds_read_b128 v[40:43], v250 offset:16384
  v_mfma_f32_16x16x32_bf16 v[64:67], v[48:51], v[180:183], v[64:67]
  v_mfma_f32_16x16x32_bf16 v[72:75], v[48:51], v[212:215], v[72:75]
  v_mfma_f32_16x16x32_bf16 v[80:83], v[48:51], v[244:247], v[80:83]
  s_waitcnt lgkmcnt(5)
  v_mfma_f32_16x16x32_bf16 v[60:63], v[52:55], v[148:151], v[60:63]
  ds_read_b128 v[44:47], v250 offset:18432
  v_mfma_f32_16x16x32_bf16 v[68:71], v[52:55], v[180:183], v[68:71]
  v_mfma_f32_16x16x32_bf16 v[76:79], v[52:55], v[212:215], v[76:79]
  v_mfma_f32_16x16x32_bf16 v[84:87], v[52:55], v[244:247], v[84:87]
  s_waitcnt lgkmcnt(5)
  v_mfma_f32_16x16x32_bf16 v[88:91], v[24:27], v[120:123], 0
  ds_read_b128 v[48:51], v251 offset:16384
  v_mfma_f32_16x16x32_bf16 v[96:99], v[24:27], v[152:155], 0
  v_mfma_f32_16x16x32_bf16 v[104:107], v[24:27], v[184:187], 0
  s_add_u32 m0, s29, 114688
  s_add_u32 s27, s28, 1835008
  buffer_load_dwordx4 v14, s[60:63], s27 offen lds
  v_mfma_f32_16x16x32_bf16 v[112:115], v[24:27], v[216:219], 0
  s_waitcnt lgkmcnt(5)
  v_mul_f32 v56, v12, v56
  v_mfma_f32_16x16x32_bf16 v[92:95], v[28:31], v[120:123], 0
  ds_read_b128 v[52:55], v251 offset:18432
  v_mul_f32 v57, v12, v57
  v_mfma_f32_16x16x32_bf16 v[100:103], v[28:31], v[152:155], 0
  v_mul_f32 v58, v12, v58
  v_mul_f32 v59, v12, v59
  v_mfma_f32_16x16x32_bf16 v[108:111], v[28:31], v[184:187], 0
  v_mul_f32 v60, v12, v60
  v_mfma_f32_16x16x32_bf16 v[116:119], v[28:31], v[216:219], 0
  s_waitcnt lgkmcnt(5)
  v_mul_f32 v61, v12, v61
  v_mfma_f32_16x16x32_bf16 v[88:91], v[32:35], v[124:127], v[88:91]
  ds_read_b128 v[24:27], v248 offset:16640
  v_mul_f32 v62, v12, v62
  v_mfma_f32_16x16x32_bf16 v[96:99], v[32:35], v[156:159], v[96:99]
  v_mul_f32 v63, v12, v63
  v_cvt_pk_bf16_f32 v56, v56, v57
  v_mfma_f32_16x16x32_bf16 v[104:107], v[32:35], v[188:191], v[104:107]
  s_add_u32 m0, s29, 115712
  s_add_u32 s27, s28, 1851392
  buffer_load_dwordx4 v15, s[60:63], s27 offen lds
  v_mfma_f32_16x16x32_bf16 v[112:115], v[32:35], v[220:223], v[112:115]
  s_waitcnt lgkmcnt(5)
  v_cvt_pk_bf16_f32 v57, v58, v59
  v_mfma_f32_16x16x32_bf16 v[92:95], v[36:39], v[124:127], v[92:95]
  ds_read_b128 v[28:31], v248 offset:18688
  v_cvt_pk_bf16_f32 v58, v60, v61
  v_mfma_f32_16x16x32_bf16 v[100:103], v[36:39], v[156:159], v[100:103]
  v_cvt_pk_bf16_f32 v59, v62, v63
  v_accvgpr_write_b32 a0, v56
  v_mfma_f32_16x16x32_bf16 v[108:111], v[36:39], v[188:191], v[108:111]
  v_accvgpr_write_b32 a1, v57
  v_mfma_f32_16x16x32_bf16 v[116:119], v[36:39], v[220:223], v[116:119]
  s_waitcnt lgkmcnt(5)
  v_accvgpr_write_b32 a2, v58
  v_mfma_f32_16x16x32_bf16 v[88:91], v[40:43], v[128:131], v[88:91]
  ds_read_b128 v[32:35], v249 offset:16640
  v_accvgpr_write_b32 a3, v59
  v_mfma_f32_16x16x32_bf16 v[96:99], v[40:43], v[160:163], v[96:99]
  v_mul_f32 v64, v12, v64
  v_mul_f32 v65, v12, v65
  v_mfma_f32_16x16x32_bf16 v[104:107], v[40:43], v[192:195], v[104:107]
  s_add_u32 m0, s29, 116736
  s_add_u32 s27, s28, 1867776
  buffer_load_dwordx4 v14, s[60:63], s27 offen lds
  v_mfma_f32_16x16x32_bf16 v[112:115], v[40:43], v[224:227], v[112:115]
  s_waitcnt lgkmcnt(5)
  v_mul_f32 v66, v12, v66
  v_mfma_f32_16x16x32_bf16 v[92:95], v[44:47], v[128:131], v[92:95]
  ds_read_b128 v[36:39], v249 offset:18688
  v_mul_f32 v67, v12, v67
  v_mfma_f32_16x16x32_bf16 v[100:103], v[44:47], v[160:163], v[100:103]
  v_mul_f32 v68, v12, v68
  v_mul_f32 v69, v12, v69
  v_mfma_f32_16x16x32_bf16 v[108:111], v[44:47], v[192:195], v[108:111]
  v_mul_f32 v70, v12, v70
  v_mfma_f32_16x16x32_bf16 v[116:119], v[44:47], v[224:227], v[116:119]
  s_waitcnt lgkmcnt(5)
  v_mul_f32 v71, v12, v71
  v_mfma_f32_16x16x32_bf16 v[88:91], v[48:51], v[132:135], v[88:91]
  ds_read_b128 v[40:43], v250 offset:16640
  v_cvt_pk_bf16_f32 v64, v64, v65
  v_mfma_f32_16x16x32_bf16 v[96:99], v[48:51], v[164:167], v[96:99]
  v_cvt_pk_bf16_f32 v65, v66, v67
  v_cvt_pk_bf16_f32 v66, v68, v69
  v_mfma_f32_16x16x32_bf16 v[104:107], v[48:51], v[196:199], v[104:107]
  s_add_u32 m0, s29, 117760
  s_add_u32 s27, s28, 1884160
  buffer_load_dwordx4 v15, s[60:63], s27 offen lds
  v_mfma_f32_16x16x32_bf16 v[112:115], v[48:51], v[228:231], v[112:115]
  s_waitcnt lgkmcnt(5)
  v_cvt_pk_bf16_f32 v67, v70, v71
  v_mfma_f32_16x16x32_bf16 v[92:95], v[52:55], v[132:135], v[92:95]
  ds_read_b128 v[44:47], v250 offset:18688
  v_accvgpr_write_b32 a56, v64
  v_mfma_f32_16x16x32_bf16 v[100:103], v[52:55], v[164:167], v[100:103]
  v_accvgpr_write_b32 a57, v65
  v_accvgpr_write_b32 a58, v66
  v_mfma_f32_16x16x32_bf16 v[108:111], v[52:55], v[196:199], v[108:111]
  v_accvgpr_write_b32 a59, v67
  v_mfma_f32_16x16x32_bf16 v[116:119], v[52:55], v[228:231], v[116:119]
  s_waitcnt lgkmcnt(5)
  v_mul_f32 v72, v12, v72
  v_mfma_f32_16x16x32_bf16 v[88:91], v[24:27], v[136:139], v[88:91]
  ds_read_b128 v[48:51], v251 offset:16640
  v_mul_f32 v73, v12, v73
  v_mfma_f32_16x16x32_bf16 v[96:99], v[24:27], v[168:171], v[96:99]
  v_mul_f32 v74, v12, v74
  v_mul_f32 v75, v12, v75
  v_mfma_f32_16x16x32_bf16 v[104:107], v[24:27], v[200:203], v[104:107]
  v_mul_f32 v76, v12, v76
  v_mfma_f32_16x16x32_bf16 v[112:115], v[24:27], v[232:235], v[112:115]
  s_waitcnt lgkmcnt(5)
  v_mul_f32 v77, v12, v77
  v_mfma_f32_16x16x32_bf16 v[92:95], v[28:31], v[136:139], v[92:95]
  ds_read_b128 v[52:55], v251 offset:18688
  v_mul_f32 v78, v12, v78
  v_mfma_f32_16x16x32_bf16 v[100:103], v[28:31], v[168:171], v[100:103]
  v_mul_f32 v79, v12, v79
  v_cvt_pk_bf16_f32 v72, v72, v73
  v_mfma_f32_16x16x32_bf16 v[108:111], v[28:31], v[200:203], v[108:111]
  v_cvt_pk_bf16_f32 v73, v74, v75
  v_mfma_f32_16x16x32_bf16 v[116:119], v[28:31], v[232:235], v[116:119]
  s_waitcnt lgkmcnt(5)
  v_cvt_pk_bf16_f32 v74, v76, v77
  v_mfma_f32_16x16x32_bf16 v[88:91], v[32:35], v[140:143], v[88:91]
  s_waitcnt vmcnt(20)
  s_barrier
  ds_read_b128 v[24:27], v248 offset:32768
  v_cvt_pk_bf16_f32 v75, v78, v79
  v_mfma_f32_16x16x32_bf16 v[96:99], v[32:35], v[172:175], v[96:99]
  v_accvgpr_write_b32 a112, v72
  v_accvgpr_write_b32 a113, v73
  v_mfma_f32_16x16x32_bf16 v[104:107], v[32:35], v[204:207], v[104:107]
  v_accvgpr_write_b32 a114, v74
  v_mfma_f32_16x16x32_bf16 v[112:115], v[32:35], v[236:239], v[112:115]
  s_waitcnt lgkmcnt(5)
  v_accvgpr_write_b32 a115, v75
  v_mfma_f32_16x16x32_bf16 v[92:95], v[36:39], v[140:143], v[92:95]
  ds_read_b128 v[28:31], v248 offset:34816
  v_mul_f32 v80, v12, v80
  v_mfma_f32_16x16x32_bf16 v[100:103], v[36:39], v[172:175], v[100:103]
  v_mul_f32 v81, v12, v81
  v_mul_f32 v82, v12, v82
  v_mfma_f32_16x16x32_bf16 v[108:111], v[36:39], v[204:207], v[108:111]
  v_mul_f32 v83, v12, v83
  v_mfma_f32_16x16x32_bf16 v[116:119], v[36:39], v[236:239], v[116:119]
  s_waitcnt lgkmcnt(5)
  v_mul_f32 v84, v12, v84
  v_mfma_f32_16x16x32_bf16 v[88:91], v[40:43], v[144:147], v[88:91]
  ds_read_b128 v[32:35], v249 offset:32768
  v_mul_f32 v85, v12, v85
  v_mfma_f32_16x16x32_bf16 v[96:99], v[40:43], v[176:179], v[96:99]
  v_mul_f32 v86, v12, v86
  v_mul_f32 v87, v12, v87
  v_mfma_f32_16x16x32_bf16 v[104:107], v[40:43], v[208:211], v[104:107]
  v_cvt_pk_bf16_f32 v80, v80, v81
  v_mfma_f32_16x16x32_bf16 v[112:115], v[40:43], v[240:243], v[112:115]
  s_waitcnt lgkmcnt(5)
  v_cvt_pk_bf16_f32 v81, v82, v83
  v_mfma_f32_16x16x32_bf16 v[92:95], v[44:47], v[144:147], v[92:95]
  ds_read_b128 v[36:39], v249 offset:34816
  v_cvt_pk_bf16_f32 v82, v84, v85
  v_mfma_f32_16x16x32_bf16 v[100:103], v[44:47], v[176:179], v[100:103]
  v_cvt_pk_bf16_f32 v83, v86, v87
  v_accvgpr_write_b32 a168, v80
  v_mfma_f32_16x16x32_bf16 v[108:111], v[44:47], v[208:211], v[108:111]
  v_accvgpr_write_b32 a169, v81
  v_mfma_f32_16x16x32_bf16 v[116:119], v[44:47], v[240:243], v[116:119]
  s_waitcnt lgkmcnt(5)
  v_accvgpr_write_b32 a170, v82
  v_mfma_f32_16x16x32_bf16 v[88:91], v[48:51], v[148:151], v[88:91]
  ds_read_b128 v[40:43], v250 offset:32768
  v_accvgpr_write_b32 a171, v83
  v_mfma_f32_16x16x32_bf16 v[96:99], v[48:51], v[180:183], v[96:99]
  v_mfma_f32_16x16x32_bf16 v[104:107], v[48:51], v[212:215], v[104:107]
  v_mfma_f32_16x16x32_bf16 v[112:115], v[48:51], v[244:247], v[112:115]
  s_waitcnt lgkmcnt(5)
  v_mfma_f32_16x16x32_bf16 v[92:95], v[52:55], v[148:151], v[92:95]
  ds_read_b128 v[44:47], v250 offset:34816
  v_mfma_f32_16x16x32_bf16 v[100:103], v[52:55], v[180:183], v[100:103]
  v_mfma_f32_16x16x32_bf16 v[108:111], v[52:55], v[212:215], v[108:111]
  v_mfma_f32_16x16x32_bf16 v[116:119], v[52:55], v[244:247], v[116:119]
  s_waitcnt lgkmcnt(5)
  v_mfma_f32_16x16x32_bf16 v[56:59], v[24:27], v[120:123], 0
  ds_read_b128 v[48:51], v251 offset:32768
  v_mfma_f32_16x16x32_bf16 v[64:67], v[24:27], v[152:155], 0
  v_mfma_f32_16x16x32_bf16 v[72:75], v[24:27], v[184:187], 0
  s_add_u32 m0, s29, 131072
  s_add_u32 s27, s28, 2097152
  buffer_load_dwordx4 v14, s[60:63], s27 offen lds
  v_mfma_f32_16x16x32_bf16 v[80:83], v[24:27], v[216:219], 0
  s_waitcnt lgkmcnt(5)
  v_mul_f32 v88, v12, v88
  v_mfma_f32_16x16x32_bf16 v[60:63], v[28:31], v[120:123], 0
  ds_read_b128 v[52:55], v251 offset:34816
  v_mul_f32 v89, v12, v89
  v_mfma_f32_16x16x32_bf16 v[68:71], v[28:31], v[152:155], 0
  v_mul_f32 v90, v12, v90
  v_mul_f32 v91, v12, v91
  v_mfma_f32_16x16x32_bf16 v[76:79], v[28:31], v[184:187], 0
  v_mul_f32 v92, v12, v92
  v_mfma_f32_16x16x32_bf16 v[84:87], v[28:31], v[216:219], 0
  s_waitcnt lgkmcnt(5)
  v_mul_f32 v93, v12, v93
  v_mfma_f32_16x16x32_bf16 v[56:59], v[32:35], v[124:127], v[56:59]
  ds_read_b128 v[24:27], v248 offset:33024
  v_mul_f32 v94, v12, v94
  v_mfma_f32_16x16x32_bf16 v[64:67], v[32:35], v[156:159], v[64:67]
  v_mul_f32 v95, v12, v95
  v_cvt_pk_bf16_f32 v88, v88, v89
  v_mfma_f32_16x16x32_bf16 v[72:75], v[32:35], v[188:191], v[72:75]
  s_add_u32 m0, s29, 132096
  s_add_u32 s27, s28, 2113536
  buffer_load_dwordx4 v15, s[60:63], s27 offen lds
  v_mfma_f32_16x16x32_bf16 v[80:83], v[32:35], v[220:223], v[80:83]
  s_waitcnt lgkmcnt(5)
  v_cvt_pk_bf16_f32 v89, v90, v91
  v_mfma_f32_16x16x32_bf16 v[60:63], v[36:39], v[124:127], v[60:63]
  ds_read_b128 v[28:31], v248 offset:35072
  v_cvt_pk_bf16_f32 v90, v92, v93
  v_mfma_f32_16x16x32_bf16 v[68:71], v[36:39], v[156:159], v[68:71]
  v_cvt_pk_bf16_f32 v91, v94, v95
  v_accvgpr_write_b32 a4, v88
  v_mfma_f32_16x16x32_bf16 v[76:79], v[36:39], v[188:191], v[76:79]
  v_accvgpr_write_b32 a5, v89
  v_mfma_f32_16x16x32_bf16 v[84:87], v[36:39], v[220:223], v[84:87]
  s_waitcnt lgkmcnt(5)
  v_accvgpr_write_b32 a6, v90
  v_mfma_f32_16x16x32_bf16 v[56:59], v[40:43], v[128:131], v[56:59]
  ds_read_b128 v[32:35], v249 offset:33024
  v_accvgpr_write_b32 a7, v91
  v_mfma_f32_16x16x32_bf16 v[64:67], v[40:43], v[160:163], v[64:67]
  v_mul_f32 v96, v12, v96
  v_mul_f32 v97, v12, v97
  v_mfma_f32_16x16x32_bf16 v[72:75], v[40:43], v[192:195], v[72:75]
  s_add_u32 m0, s29, 133120
  s_add_u32 s27, s28, 2129920
  buffer_load_dwordx4 v14, s[60:63], s27 offen lds
  v_mfma_f32_16x16x32_bf16 v[80:83], v[40:43], v[224:227], v[80:83]
  s_waitcnt lgkmcnt(5)
  v_mul_f32 v98, v12, v98
  v_mfma_f32_16x16x32_bf16 v[60:63], v[44:47], v[128:131], v[60:63]
  ds_read_b128 v[36:39], v249 offset:35072
  v_mul_f32 v99, v12, v99
  v_mfma_f32_16x16x32_bf16 v[68:71], v[44:47], v[160:163], v[68:71]
  v_mul_f32 v100, v12, v100
  v_mul_f32 v101, v12, v101
  v_mfma_f32_16x16x32_bf16 v[76:79], v[44:47], v[192:195], v[76:79]
  v_mul_f32 v102, v12, v102
  v_mfma_f32_16x16x32_bf16 v[84:87], v[44:47], v[224:227], v[84:87]
  s_waitcnt lgkmcnt(5)
  v_mul_f32 v103, v12, v103
  v_mfma_f32_16x16x32_bf16 v[56:59], v[48:51], v[132:135], v[56:59]
  ds_read_b128 v[40:43], v250 offset:33024
  v_cvt_pk_bf16_f32 v96, v96, v97
  v_mfma_f32_16x16x32_bf16 v[64:67], v[48:51], v[164:167], v[64:67]
  v_cvt_pk_bf16_f32 v97, v98, v99
  v_cvt_pk_bf16_f32 v98, v100, v101
  v_mfma_f32_16x16x32_bf16 v[72:75], v[48:51], v[196:199], v[72:75]
  s_add_u32 m0, s29, 134144
  s_add_u32 s27, s28, 2146304
  buffer_load_dwordx4 v15, s[60:63], s27 offen lds
  v_mfma_f32_16x16x32_bf16 v[80:83], v[48:51], v[228:231], v[80:83]
  s_waitcnt lgkmcnt(5)
  v_cvt_pk_bf16_f32 v99, v102, v103
  v_mfma_f32_16x16x32_bf16 v[60:63], v[52:55], v[132:135], v[60:63]
  ds_read_b128 v[44:47], v250 offset:35072
  v_accvgpr_write_b32 a60, v96
  v_mfma_f32_16x16x32_bf16 v[68:71], v[52:55], v[164:167], v[68:71]
  v_accvgpr_write_b32 a61, v97
  v_accvgpr_write_b32 a62, v98
  v_mfma_f32_16x16x32_bf16 v[76:79], v[52:55], v[196:199], v[76:79]
  v_accvgpr_write_b32 a63, v99
  v_mfma_f32_16x16x32_bf16 v[84:87], v[52:55], v[228:231], v[84:87]
  s_waitcnt lgkmcnt(5)
  v_mul_f32 v104, v12, v104
  v_mfma_f32_16x16x32_bf16 v[56:59], v[24:27], v[136:139], v[56:59]
  ds_read_b128 v[48:51], v251 offset:33024
  v_mul_f32 v105, v12, v105
  v_mfma_f32_16x16x32_bf16 v[64:67], v[24:27], v[168:171], v[64:67]
  v_mul_f32 v106, v12, v106
  v_mul_f32 v107, v12, v107
  v_mfma_f32_16x16x32_bf16 v[72:75], v[24:27], v[200:203], v[72:75]
  v_mul_f32 v108, v12, v108
  v_mfma_f32_16x16x32_bf16 v[80:83], v[24:27], v[232:235], v[80:83]
  s_waitcnt lgkmcnt(5)
  v_mul_f32 v109, v12, v109
  v_mfma_f32_16x16x32_bf16 v[60:63], v[28:31], v[136:139], v[60:63]
  ds_read_b128 v[52:55], v251 offset:35072
  v_mul_f32 v110, v12, v110
  v_mfma_f32_16x16x32_bf16 v[68:71], v[28:31], v[168:171], v[68:71]
  v_mul_f32 v111, v12, v111
  v_cvt_pk_bf16_f32 v104, v104, v105
  v_mfma_f32_16x16x32_bf16 v[76:79], v[28:31], v[200:203], v[76:79]
  v_cvt_pk_bf16_f32 v105, v106, v107
  v_mfma_f32_16x16x32_bf16 v[84:87], v[28:31], v[232:235], v[84:87]
  s_waitcnt lgkmcnt(5)
  v_cvt_pk_bf16_f32 v106, v108, v109
  v_mfma_f32_16x16x32_bf16 v[56:59], v[32:35], v[140:143], v[56:59]
  s_waitcnt vmcnt(20)
  s_barrier
  ds_read_b128 v[24:27], v248 offset:49152
  v_cvt_pk_bf16_f32 v107, v110, v111
  v_mfma_f32_16x16x32_bf16 v[64:67], v[32:35], v[172:175], v[64:67]
  v_accvgpr_write_b32 a116, v104
  v_accvgpr_write_b32 a117, v105
  v_mfma_f32_16x16x32_bf16 v[72:75], v[32:35], v[204:207], v[72:75]
  v_accvgpr_write_b32 a118, v106
  v_mfma_f32_16x16x32_bf16 v[80:83], v[32:35], v[236:239], v[80:83]
  s_waitcnt lgkmcnt(5)
  v_accvgpr_write_b32 a119, v107
  v_mfma_f32_16x16x32_bf16 v[60:63], v[36:39], v[140:143], v[60:63]
  ds_read_b128 v[28:31], v248 offset:51200
  v_mul_f32 v112, v12, v112
  v_mfma_f32_16x16x32_bf16 v[68:71], v[36:39], v[172:175], v[68:71]
  v_mul_f32 v113, v12, v113
  v_mul_f32 v114, v12, v114
  v_mfma_f32_16x16x32_bf16 v[76:79], v[36:39], v[204:207], v[76:79]
  v_mul_f32 v115, v12, v115
  v_mfma_f32_16x16x32_bf16 v[84:87], v[36:39], v[236:239], v[84:87]
  s_waitcnt lgkmcnt(5)
  v_mul_f32 v116, v12, v116
  v_mfma_f32_16x16x32_bf16 v[56:59], v[40:43], v[144:147], v[56:59]
  ds_read_b128 v[32:35], v249 offset:49152
  v_mul_f32 v117, v12, v117
  v_mfma_f32_16x16x32_bf16 v[64:67], v[40:43], v[176:179], v[64:67]
  v_mul_f32 v118, v12, v118
  v_mul_f32 v119, v12, v119
  v_mfma_f32_16x16x32_bf16 v[72:75], v[40:43], v[208:211], v[72:75]
  v_cvt_pk_bf16_f32 v112, v112, v113
  v_mfma_f32_16x16x32_bf16 v[80:83], v[40:43], v[240:243], v[80:83]
  s_waitcnt lgkmcnt(5)
  v_cvt_pk_bf16_f32 v113, v114, v115
  v_mfma_f32_16x16x32_bf16 v[60:63], v[44:47], v[144:147], v[60:63]
  ds_read_b128 v[36:39], v249 offset:51200
  v_cvt_pk_bf16_f32 v114, v116, v117
  v_mfma_f32_16x16x32_bf16 v[68:71], v[44:47], v[176:179], v[68:71]
  v_cvt_pk_bf16_f32 v115, v118, v119
  v_accvgpr_write_b32 a172, v112
  v_mfma_f32_16x16x32_bf16 v[76:79], v[44:47], v[208:211], v[76:79]
  v_accvgpr_write_b32 a173, v113
  v_mfma_f32_16x16x32_bf16 v[84:87], v[44:47], v[240:243], v[84:87]
  s_waitcnt lgkmcnt(5)
  v_accvgpr_write_b32 a174, v114
  v_mfma_f32_16x16x32_bf16 v[56:59], v[48:51], v[148:151], v[56:59]
  ds_read_b128 v[40:43], v250 offset:49152
  v_accvgpr_write_b32 a175, v115
  v_mfma_f32_16x16x32_bf16 v[64:67], v[48:51], v[180:183], v[64:67]
  v_mfma_f32_16x16x32_bf16 v[72:75], v[48:51], v[212:215], v[72:75]
  v_mfma_f32_16x16x32_bf16 v[80:83], v[48:51], v[244:247], v[80:83]
  s_waitcnt lgkmcnt(5)
  v_mfma_f32_16x16x32_bf16 v[60:63], v[52:55], v[148:151], v[60:63]
  ds_read_b128 v[44:47], v250 offset:51200
  v_mfma_f32_16x16x32_bf16 v[68:71], v[52:55], v[180:183], v[68:71]
  v_mfma_f32_16x16x32_bf16 v[76:79], v[52:55], v[212:215], v[76:79]
  v_mfma_f32_16x16x32_bf16 v[84:87], v[52:55], v[244:247], v[84:87]
  s_waitcnt lgkmcnt(5)
  s_getpc_b64 s[98:99]
  s_add_u32 s98, s98, 4096
  s_addc_u32 s99, s99, 0
  global_load_dword v7, v6, s[98:99]
  v_mfma_f32_16x16x32_bf16 v[88:91], v[24:27], v[120:123], 0
  ds_read_b128 v[48:51], v251 offset:49152
  v_mfma_f32_16x16x32_bf16 v[96:99], v[24:27], v[152:155], 0
  v_mfma_f32_16x16x32_bf16 v[104:107], v[24:27], v[184:187], 0
  buffer_load_dword v13, off, s[12:15], 0 offset:128 sc1
  buffer_load_dword v9, off, s[12:15], 0 sc1
  s_add_u32 m0, s29, 147456
  s_add_u32 s27, s28, 2359296
  buffer_load_dwordx4 v14, s[60:63], s27 offen lds
  v_mfma_f32_16x16x32_bf16 v[112:115], v[24:27], v[216:219], 0
  s_waitcnt lgkmcnt(5)
  v_mul_f32 v56, v12, v56
  v_mfma_f32_16x16x32_bf16 v[92:95], v[28:31], v[120:123], 0
  ds_read_b128 v[52:55], v251 offset:51200
  v_mul_f32 v57, v12, v57
  v_mfma_f32_16x16x32_bf16 v[100:103], v[28:31], v[152:155], 0
  v_mul_f32 v58, v12, v58
  v_mul_f32 v59, v12, v59
  v_mfma_f32_16x16x32_bf16 v[108:111], v[28:31], v[184:187], 0
  v_mul_f32 v60, v12, v60
  v_mfma_f32_16x16x32_bf16 v[116:119], v[28:31], v[216:219], 0
  s_waitcnt lgkmcnt(5)
  v_mul_f32 v61, v12, v61
  v_mfma_f32_16x16x32_bf16 v[88:91], v[32:35], v[124:127], v[88:91]
  ds_read_b128 v[24:27], v248 offset:49408
  v_mul_f32 v62, v12, v62
  v_mfma_f32_16x16x32_bf16 v[96:99], v[32:35], v[156:159], v[96:99]
  v_mul_f32 v63, v12, v63
  v_cvt_pk_bf16_f32 v56, v56, v57
  v_mfma_f32_16x16x32_bf16 v[104:107], v[32:35], v[188:191], v[104:107]
  s_add_u32 m0, s29, 148480
  s_add_u32 s27, s28, 2375680
  buffer_load_dwordx4 v15, s[60:63], s27 offen lds
  v_mfma_f32_16x16x32_bf16 v[112:115], v[32:35], v[220:223], v[112:115]
  s_waitcnt lgkmcnt(5)
  v_cvt_pk_bf16_f32 v57, v58, v59
  v_mfma_f32_16x16x32_bf16 v[92:95], v[36:39], v[124:127], v[92:95]
  ds_read_b128 v[28:31], v248 offset:51456
  v_cvt_pk_bf16_f32 v58, v60, v61
  v_mfma_f32_16x16x32_bf16 v[100:103], v[36:39], v[156:159], v[100:103]
  v_cvt_pk_bf16_f32 v59, v62, v63
  v_accvgpr_write_b32 a8, v56
  v_mfma_f32_16x16x32_bf16 v[108:111], v[36:39], v[188:191], v[108:111]
  v_accvgpr_write_b32 a9, v57
  v_mfma_f32_16x16x32_bf16 v[116:119], v[36:39], v[220:223], v[116:119]
  s_waitcnt lgkmcnt(5)
  v_accvgpr_write_b32 a10, v58
  v_mfma_f32_16x16x32_bf16 v[88:91], v[40:43], v[128:131], v[88:91]
  ds_read_b128 v[32:35], v249 offset:49408
  v_accvgpr_write_b32 a11, v59
  v_mfma_f32_16x16x32_bf16 v[96:99], v[40:43], v[160:163], v[96:99]
  v_mul_f32 v64, v12, v64
  v_mul_f32 v65, v12, v65
  v_mfma_f32_16x16x32_bf16 v[104:107], v[40:43], v[192:195], v[104:107]
  s_add_u32 m0, s29, 149504
  s_add_u32 s27, s28, 2392064
  buffer_load_dwordx4 v14, s[60:63], s27 offen lds
  v_mfma_f32_16x16x32_bf16 v[112:115], v[40:43], v[224:227], v[112:115]
  s_waitcnt lgkmcnt(5)
  v_mul_f32 v66, v12, v66
  v_mfma_f32_16x16x32_bf16 v[92:95], v[44:47], v[128:131], v[92:95]
  ds_read_b128 v[36:39], v249 offset:51456
  v_mul_f32 v67, v12, v67
  v_mfma_f32_16x16x32_bf16 v[100:103], v[44:47], v[160:163], v[100:103]
  v_mul_f32 v68, v12, v68
  v_mul_f32 v69, v12, v69
  v_mfma_f32_16x16x32_bf16 v[108:111], v[44:47], v[192:195], v[108:111]
  v_mul_f32 v70, v12, v70
  v_mfma_f32_16x16x32_bf16 v[116:119], v[44:47], v[224:227], v[116:119]
  s_waitcnt lgkmcnt(5)
  v_mul_f32 v71, v12, v71
  v_mfma_f32_16x16x32_bf16 v[88:91], v[48:51], v[132:135], v[88:91]
  ds_read_b128 v[40:43], v250 offset:49408
  v_cvt_pk_bf16_f32 v64, v64, v65
  v_mfma_f32_16x16x32_bf16 v[96:99], v[48:51], v[164:167], v[96:99]
  v_cvt_pk_bf16_f32 v65, v66, v67
  v_cvt_pk_bf16_f32 v66, v68, v69
  v_mfma_f32_16x16x32_bf16 v[104:107], v[48:51], v[196:199], v[104:107]
  s_add_u32 m0, s29, 150528
  s_add_u32 s27, s28, 2408448
  buffer_load_dwordx4 v15, s[60:63], s27 offen lds
  v_mfma_f32_16x16x32_bf16 v[112:115], v[48:51], v[228:231], v[112:115]
  s_waitcnt lgkmcnt(5)
  v_cvt_pk_bf16_f32 v67, v70, v71
  v_mfma_f32_16x16x32_bf16 v[92:95], v[52:55], v[132:135], v[92:95]
  ds_read_b128 v[44:47], v250 offset:51456
  v_accvgpr_write_b32 a64, v64
  v_mfma_f32_16x16x32_bf16 v[100:103], v[52:55], v[164:167], v[100:103]
  v_accvgpr_write_b32 a65, v65
  v_accvgpr_write_b32 a66, v66
  v_mfma_f32_16x16x32_bf16 v[108:111], v[52:55], v[196:199], v[108:111]
  v_accvgpr_write_b32 a67, v67
  v_mfma_f32_16x16x32_bf16 v[116:119], v[52:55], v[228:231], v[116:119]
  s_waitcnt lgkmcnt(5)
  v_mul_f32 v72, v12, v72
  v_mfma_f32_16x16x32_bf16 v[88:91], v[24:27], v[136:139], v[88:91]
  ds_read_b128 v[48:51], v251 offset:49408
  v_mul_f32 v73, v12, v73
  v_mfma_f32_16x16x32_bf16 v[96:99], v[24:27], v[168:171], v[96:99]
  v_mul_f32 v74, v12, v74
  v_mul_f32 v75, v12, v75
  v_mfma_f32_16x16x32_bf16 v[104:107], v[24:27], v[200:203], v[104:107]
  v_mul_f32 v76, v12, v76
  v_mfma_f32_16x16x32_bf16 v[112:115], v[24:27], v[232:235], v[112:115]
  s_waitcnt lgkmcnt(5)
  v_mul_f32 v77, v12, v77
  v_mfma_f32_16x16x32_bf16 v[92:95], v[28:31], v[136:139], v[92:95]
  ds_read_b128 v[52:55], v251 offset:51456
  v_mul_f32 v78, v12, v78
  v_mfma_f32_16x16x32_bf16 v[100:103], v[28:31], v[168:171], v[100:103]
  v_mul_f32 v79, v12, v79
  v_cvt_pk_bf16_f32 v72, v72, v73
  v_mfma_f32_16x16x32_bf16 v[108:111], v[28:31], v[200:203], v[108:111]
  v_cvt_pk_bf16_f32 v73, v74, v75
  v_mfma_f32_16x16x32_bf16 v[116:119], v[28:31], v[232:235], v[116:119]
  s_waitcnt lgkmcnt(5)
  v_cvt_pk_bf16_f32 v74, v76, v77
  v_mfma_f32_16x16x32_bf16 v[88:91], v[32:35], v[140:143], v[88:91]
  s_waitcnt vmcnt(20)
  s_barrier
  ds_read_b128 v[24:27], v252 offset:0
  v_cvt_pk_bf16_f32 v75, v78, v79
  v_mfma_f32_16x16x32_bf16 v[96:99], v[32:35], v[172:175], v[96:99]
  v_accvgpr_write_b32 a120, v72
  v_accvgpr_write_b32 a121, v73
  v_mfma_f32_16x16x32_bf16 v[104:107], v[32:35], v[204:207], v[104:107]
  v_accvgpr_write_b32 a122, v74
  v_mfma_f32_16x16x32_bf16 v[112:115], v[32:35], v[236:239], v[112:115]
  s_waitcnt lgkmcnt(5)
  v_accvgpr_write_b32 a123, v75
  v_mfma_f32_16x16x32_bf16 v[92:95], v[36:39], v[140:143], v[92:95]
  ds_read_b128 v[28:31], v252 offset:2048
  v_mul_f32 v80, v12, v80
  v_mfma_f32_16x16x32_bf16 v[100:103], v[36:39], v[172:175], v[100:103]
  v_mul_f32 v81, v12, v81
  v_mul_f32 v82, v12, v82
  v_mfma_f32_16x16x32_bf16 v[108:111], v[36:39], v[204:207], v[108:111]
  v_mul_f32 v83, v12, v83
  v_mfma_f32_16x16x32_bf16 v[116:119], v[36:39], v[236:239], v[116:119]
  s_waitcnt lgkmcnt(5)
  v_mul_f32 v84, v12, v84
  v_mfma_f32_16x16x32_bf16 v[88:91], v[40:43], v[144:147], v[88:91]
  ds_read_b128 v[32:35], v253 offset:0
  v_mul_f32 v85, v12, v85
  v_mfma_f32_16x16x32_bf16 v[96:99], v[40:43], v[176:179], v[96:99]
  v_mul_f32 v86, v12, v86
  v_mul_f32 v87, v12, v87
  v_mfma_f32_16x16x32_bf16 v[104:107], v[40:43], v[208:211], v[104:107]
  v_cvt_pk_bf16_f32 v80, v80, v81
  v_mfma_f32_16x16x32_bf16 v[112:115], v[40:43], v[240:243], v[112:115]
  s_waitcnt lgkmcnt(5)
  v_cvt_pk_bf16_f32 v81, v82, v83
  v_mfma_f32_16x16x32_bf16 v[92:95], v[44:47], v[144:147], v[92:95]
  ds_read_b128 v[36:39], v253 offset:2048
  v_cvt_pk_bf16_f32 v82, v84, v85
  v_mfma_f32_16x16x32_bf16 v[100:103], v[44:47], v[176:179], v[100:103]
  v_cvt_pk_bf16_f32 v83, v86, v87
  v_accvgpr_write_b32 a176, v80
  v_mfma_f32_16x16x32_bf16 v[108:111], v[44:47], v[208:211], v[108:111]
  v_accvgpr_write_b32 a177, v81
  v_mfma_f32_16x16x32_bf16 v[116:119], v[44:47], v[240:243], v[116:119]
  s_waitcnt lgkmcnt(5)
  v_accvgpr_write_b32 a178, v82
  v_mfma_f32_16x16x32_bf16 v[88:91], v[48:51], v[148:151], v[88:91]
  ds_read_b128 v[40:43], v254 offset:0
  v_accvgpr_write_b32 a179, v83
  v_mfma_f32_16x16x32_bf16 v[96:99], v[48:51], v[180:183], v[96:99]
  v_mfma_f32_16x16x32_bf16 v[104:107], v[48:51], v[212:215], v[104:107]
  v_mfma_f32_16x16x32_bf16 v[112:115], v[48:51], v[244:247], v[112:115]
  s_waitcnt lgkmcnt(5)
  v_mfma_f32_16x16x32_bf16 v[92:95], v[52:55], v[148:151], v[92:95]
  ds_read_b128 v[44:47], v254 offset:2048
  v_mfma_f32_16x16x32_bf16 v[100:103], v[52:55], v[180:183], v[100:103]
  v_mfma_f32_16x16x32_bf16 v[108:111], v[52:55], v[212:215], v[108:111]
  v_mfma_f32_16x16x32_bf16 v[116:119], v[52:55], v[244:247], v[116:119]
  s_waitcnt lgkmcnt(5)
  v_mfma_f32_16x16x32_bf16 v[56:59], v[24:27], v[120:123], 0
  ds_read_b128 v[48:51], v255 offset:0
  v_mfma_f32_16x16x32_bf16 v[64:67], v[24:27], v[152:155], 0
  v_mfma_f32_16x16x32_bf16 v[72:75], v[24:27], v[184:187], 0
  s_add_u32 m0, s29, 0
  s_add_u32 s27, s28, 2621440
  buffer_load_dwordx4 v14, s[60:63], s27 offen lds
  v_mfma_f32_16x16x32_bf16 v[80:83], v[24:27], v[216:219], 0
  s_waitcnt lgkmcnt(5)
  v_mul_f32 v88, v12, v88
  v_mfma_f32_16x16x32_bf16 v[60:63], v[28:31], v[120:123], 0
  ds_read_b128 v[52:55], v255 offset:2048
  v_mul_f32 v89, v12, v89
  v_mfma_f32_16x16x32_bf16 v[68:71], v[28:31], v[152:155], 0
  v_mul_f32 v90, v12, v90
  v_mul_f32 v91, v12, v91
  v_mfma_f32_16x16x32_bf16 v[76:79], v[28:31], v[184:187], 0
  v_mul_f32 v92, v12, v92
  v_mfma_f32_16x16x32_bf16 v[84:87], v[28:31], v[216:219], 0
  s_waitcnt lgkmcnt(5)
  v_mul_f32 v93, v12, v93
  v_mfma_f32_16x16x32_bf16 v[56:59], v[32:35], v[124:127], v[56:59]
  ds_read_b128 v[24:27], v252 offset:256
  v_mul_f32 v94, v12, v94
  v_mfma_f32_16x16x32_bf16 v[64:67], v[32:35], v[156:159], v[64:67]
  v_mul_f32 v95, v12, v95
  v_cvt_pk_bf16_f32 v88, v88, v89
  v_mfma_f32_16x16x32_bf16 v[72:75], v[32:35], v[188:191], v[72:75]
  s_add_u32 m0, s29, 1024
  s_add_u32 s27, s28, 2637824
  buffer_load_dwordx4 v15, s[60:63], s27 offen lds
  v_mfma_f32_16x16x32_bf16 v[80:83], v[32:35], v[220:223], v[80:83]
  s_waitcnt lgkmcnt(5)
  v_cvt_pk_bf16_f32 v89, v90, v91
  v_mfma_f32_16x16x32_bf16 v[60:63], v[36:39], v[124:127], v[60:63]
  ds_read_b128 v[28:31], v252 offset:2304
  v_cvt_pk_bf16_f32 v90, v92, v93
  v_mfma_f32_16x16x32_bf16 v[68:71], v[36:39], v[156:159], v[68:71]
  v_cvt_pk_bf16_f32 v91, v94, v95
  v_accvgpr_write_b32 a12, v88
  v_mfma_f32_16x16x32_bf16 v[76:79], v[36:39], v[188:191], v[76:79]
  v_accvgpr_write_b32 a13, v89
  v_mfma_f32_16x16x32_bf16 v[84:87], v[36:39], v[220:223], v[84:87]
  s_waitcnt lgkmcnt(5)
  v_accvgpr_write_b32 a14, v90
  v_mfma_f32_16x16x32_bf16 v[56:59], v[40:43], v[128:131], v[56:59]
  ds_read_b128 v[32:35], v253 offset:256
  v_accvgpr_write_b32 a15, v91
  v_mfma_f32_16x16x32_bf16 v[64:67], v[40:43], v[160:163], v[64:67]
  v_mul_f32 v96, v12, v96
  v_mul_f32 v97, v12, v97
  v_mfma_f32_16x16x32_bf16 v[72:75], v[40:43], v[192:195], v[72:75]
  s_add_u32 m0, s29, 2048
  s_add_u32 s27, s28, 2654208
  buffer_load_dwordx4 v14, s[60:63], s27 offen lds
  v_mfma_f32_16x16x32_bf16 v[80:83], v[40:43], v[224:227], v[80:83]
  s_waitcnt lgkmcnt(5)
  v_mul_f32 v98, v12, v98
  v_mfma_f32_16x16x32_bf16 v[60:63], v[44:47], v[128:131], v[60:63]
  ds_read_b128 v[36:39], v253 offset:2304
  v_mul_f32 v99, v12, v99
  v_mfma_f32_16x16x32_bf16 v[68:71], v[44:47], v[160:163], v[68:71]
  v_mul_f32 v100, v12, v100
  v_mul_f32 v101, v12, v101
  v_mfma_f32_16x16x32_bf16 v[76:79], v[44:47], v[192:195], v[76:79]
  v_mul_f32 v102, v12, v102
  v_mfma_f32_16x16x32_bf16 v[84:87], v[44:47], v[224:227], v[84:87]
  s_waitcnt lgkmcnt(5)
  v_mul_f32 v103, v12, v103
  v_mfma_f32_16x16x32_bf16 v[56:59], v[48:51], v[132:135], v[56:59]
  ds_read_b128 v[40:43], v254 offset:256
  v_cvt_pk_bf16_f32 v96, v96, v97
  v_mfma_f32_16x16x32_bf16 v[64:67], v[48:51], v[164:167], v[64:67]
  v_cvt_pk_bf16_f32 v97, v98, v99
  v_cvt_pk_bf16_f32 v98, v100, v101
  v_mfma_f32_16x16x32_bf16 v[72:75], v[48:51], v[196:199], v[72:75]
  s_add_u32 m0, s29, 3072
  s_add_u32 s27, s28, 2670592
  buffer_load_dwordx4 v15, s[60:63], s27 offen lds
  v_mfma_f32_16x16x32_bf16 v[80:83], v[48:51], v[228:231], v[80:83]
  s_waitcnt lgkmcnt(5)
  v_cvt_pk_bf16_f32 v99, v102, v103
  v_mfma_f32_16x16x32_bf16 v[60:63], v[52:55], v[132:135], v[60:63]
  ds_read_b128 v[44:47], v254 offset:2304
  v_accvgpr_write_b32 a68, v96
  v_mfma_f32_16x16x32_bf16 v[68:71], v[52:55], v[164:167], v[68:71]
  v_accvgpr_write_b32 a69, v97
  v_accvgpr_write_b32 a70, v98
  v_mfma_f32_16x16x32_bf16 v[76:79], v[52:55], v[196:199], v[76:79]
  v_accvgpr_write_b32 a71, v99
  v_mfma_f32_16x16x32_bf16 v[84:87], v[52:55], v[228:231], v[84:87]
  s_waitcnt lgkmcnt(5)
  v_mul_f32 v104, v12, v104
  v_mfma_f32_16x16x32_bf16 v[56:59], v[24:27], v[136:139], v[56:59]
  ds_read_b128 v[48:51], v255 offset:256
  v_mul_f32 v105, v12, v105
  v_mfma_f32_16x16x32_bf16 v[64:67], v[24:27], v[168:171], v[64:67]
  v_mul_f32 v106, v12, v106
  v_mul_f32 v107, v12, v107
  v_mfma_f32_16x16x32_bf16 v[72:75], v[24:27], v[200:203], v[72:75]
  v_mul_f32 v108, v12, v108
  v_mfma_f32_16x16x32_bf16 v[80:83], v[24:27], v[232:235], v[80:83]
  s_waitcnt lgkmcnt(5)
  v_mul_f32 v109, v12, v109
  v_mfma_f32_16x16x32_bf16 v[60:63], v[28:31], v[136:139], v[60:63]
  ds_read_b128 v[52:55], v255 offset:2304
  v_mul_f32 v110, v12, v110
  v_mfma_f32_16x16x32_bf16 v[68:71], v[28:31], v[168:171], v[68:71]
  v_mul_f32 v111, v12, v111
  v_cvt_pk_bf16_f32 v104, v104, v105
  v_mfma_f32_16x16x32_bf16 v[76:79], v[28:31], v[200:203], v[76:79]
  v_cvt_pk_bf16_f32 v105, v106, v107
  v_mfma_f32_16x16x32_bf16 v[84:87], v[28:31], v[232:235], v[84:87]
  s_waitcnt lgkmcnt(5)
  v_cvt_pk_bf16_f32 v106, v108, v109
  v_mfma_f32_16x16x32_bf16 v[56:59], v[32:35], v[140:143], v[56:59]
  s_waitcnt vmcnt(20)
  s_barrier
  ds_read_b128 v[24:27], v252 offset:16384
  v_cvt_pk_bf16_f32 v107, v110, v111
  v_mfma_f32_16x16x32_bf16 v[64:67], v[32:35], v[172:175], v[64:67]
  v_accvgpr_write_b32 a124, v104
  v_accvgpr_write_b32 a125, v105
  v_mfma_f32_16x16x32_bf16 v[72:75], v[32:35], v[204:207], v[72:75]
  v_accvgpr_write_b32 a126, v106
  v_mfma_f32_16x16x32_bf16 v[80:83], v[32:35], v[236:239], v[80:83]
  s_waitcnt lgkmcnt(5)
  v_accvgpr_write_b32 a127, v107
  v_mfma_f32_16x16x32_bf16 v[60:63], v[36:39], v[140:143], v[60:63]
  ds_read_b128 v[28:31], v252 offset:18432
  v_mul_f32 v112, v12, v112
  v_mfma_f32_16x16x32_bf16 v[68:71], v[36:39], v[172:175], v[68:71]
  v_mul_f32 v113, v12, v113
  v_mul_f32 v114, v12, v114
  v_mfma_f32_16x16x32_bf16 v[76:79], v[36:39], v[204:207], v[76:79]
  v_mul_f32 v115, v12, v115
  v_mfma_f32_16x16x32_bf16 v[84:87], v[36:39], v[236:239], v[84:87]
  s_waitcnt lgkmcnt(5)
  v_mul_f32 v116, v12, v116
  v_mfma_f32_16x16x32_bf16 v[56:59], v[40:43], v[144:147], v[56:59]
  ds_read_b128 v[32:35], v253 offset:16384
  v_mul_f32 v117, v12, v117
  v_mfma_f32_16x16x32_bf16 v[64:67], v[40:43], v[176:179], v[64:67]
  v_mul_f32 v118, v12, v118
  v_mul_f32 v119, v12, v119
  v_mfma_f32_16x16x32_bf16 v[72:75], v[40:43], v[208:211], v[72:75]
  v_cvt_pk_bf16_f32 v112, v112, v113
  v_mfma_f32_16x16x32_bf16 v[80:83], v[40:43], v[240:243], v[80:83]
  s_waitcnt lgkmcnt(5)
  v_cvt_pk_bf16_f32 v113, v114, v115
  v_mfma_f32_16x16x32_bf16 v[60:63], v[44:47], v[144:147], v[60:63]
  ds_read_b128 v[36:39], v253 offset:18432
  v_cvt_pk_bf16_f32 v114, v116, v117
  v_mfma_f32_16x16x32_bf16 v[68:71], v[44:47], v[176:179], v[68:71]
  v_cvt_pk_bf16_f32 v115, v118, v119
  v_accvgpr_write_b32 a180, v112
  v_mfma_f32_16x16x32_bf16 v[76:79], v[44:47], v[208:211], v[76:79]
  v_accvgpr_write_b32 a181, v113
  v_mfma_f32_16x16x32_bf16 v[84:87], v[44:47], v[240:243], v[84:87]
  s_waitcnt lgkmcnt(5)
  v_accvgpr_write_b32 a182, v114
  v_mfma_f32_16x16x32_bf16 v[56:59], v[48:51], v[148:151], v[56:59]
  ds_read_b128 v[40:43], v254 offset:16384
  v_accvgpr_write_b32 a183, v115
  v_mfma_f32_16x16x32_bf16 v[64:67], v[48:51], v[180:183], v[64:67]
  v_mfma_f32_16x16x32_bf16 v[72:75], v[48:51], v[212:215], v[72:75]
  v_mfma_f32_16x16x32_bf16 v[80:83], v[48:51], v[244:247], v[80:83]
  s_waitcnt lgkmcnt(5)
  v_mfma_f32_16x16x32_bf16 v[60:63], v[52:55], v[148:151], v[60:63]
  ds_read_b128 v[44:47], v254 offset:18432
  v_mfma_f32_16x16x32_bf16 v[68:71], v[52:55], v[180:183], v[68:71]
  v_mfma_f32_16x16x32_bf16 v[76:79], v[52:55], v[212:215], v[76:79]
  v_mfma_f32_16x16x32_bf16 v[84:87], v[52:55], v[244:247], v[84:87]
  s_waitcnt lgkmcnt(5)
  v_mfma_f32_16x16x32_bf16 v[88:91], v[24:27], v[120:123], 0
  ds_read_b128 v[48:51], v255 offset:16384
  v_mfma_f32_16x16x32_bf16 v[96:99], v[24:27], v[152:155], 0
  v_mfma_f32_16x16x32_bf16 v[104:107], v[24:27], v[184:187], 0
  s_add_u32 m0, s29, 16384
  s_add_u32 s27, s28, 2883584
  buffer_load_dwordx4 v14, s[60:63], s27 offen lds
  v_mfma_f32_16x16x32_bf16 v[112:115], v[24:27], v[216:219], 0
  s_waitcnt lgkmcnt(5)
  v_mul_f32 v56, v12, v56
  v_mfma_f32_16x16x32_bf16 v[92:95], v[28:31], v[120:123], 0
  ds_read_b128 v[52:55], v255 offset:18432
  v_mul_f32 v57, v12, v57
  v_mfma_f32_16x16x32_bf16 v[100:103], v[28:31], v[152:155], 0
  v_mul_f32 v58, v12, v58
  v_mul_f32 v59, v12, v59
  v_mfma_f32_16x16x32_bf16 v[108:111], v[28:31], v[184:187], 0
  v_mul_f32 v60, v12, v60
  v_mfma_f32_16x16x32_bf16 v[116:119], v[28:31], v[216:219], 0
  s_waitcnt lgkmcnt(5)
  v_mul_f32 v61, v12, v61
  v_mfma_f32_16x16x32_bf16 v[88:91], v[32:35], v[124:127], v[88:91]
  ds_read_b128 v[24:27], v252 offset:16640
  v_mul_f32 v62, v12, v62
  v_mfma_f32_16x16x32_bf16 v[96:99], v[32:35], v[156:159], v[96:99]
  v_mul_f32 v63, v12, v63
  v_cvt_pk_bf16_f32 v56, v56, v57
  v_mfma_f32_16x16x32_bf16 v[104:107], v[32:35], v[188:191], v[104:107]
  s_add_u32 m0, s29, 17408
  s_add_u32 s27, s28, 2899968
  buffer_load_dwordx4 v15, s[60:63], s27 offen lds
  v_mfma_f32_16x16x32_bf16 v[112:115], v[32:35], v[220:223], v[112:115]
  s_waitcnt lgkmcnt(5)
  v_cvt_pk_bf16_f32 v57, v58, v59
  v_mfma_f32_16x16x32_bf16 v[92:95], v[36:39], v[124:127], v[92:95]
  ds_read_b128 v[28:31], v252 offset:18688
  v_cvt_pk_bf16_f32 v58, v60, v61
  v_mfma_f32_16x16x32_bf16 v[100:103], v[36:39], v[156:159], v[100:103]
  v_cvt_pk_bf16_f32 v59, v62, v63
  v_accvgpr_write_b32 a16, v56
  v_mfma_f32_16x16x32_bf16 v[108:111], v[36:39], v[188:191], v[108:111]
  v_accvgpr_write_b32 a17, v57
  v_mfma_f32_16x16x32_bf16 v[116:119], v[36:39], v[220:223], v[116:119]
  s_waitcnt lgkmcnt(5)
  v_accvgpr_write_b32 a18, v58
  v_mfma_f32_16x16x32_bf16 v[88:91], v[40:43], v[128:131], v[88:91]
  ds_read_b128 v[32:35], v253 offset:16640
  v_accvgpr_write_b32 a19, v59
  v_mfma_f32_16x16x32_bf16 v[96:99], v[40:43], v[160:163], v[96:99]
  v_mul_f32 v64, v12, v64
  v_mul_f32 v65, v12, v65
  v_mfma_f32_16x16x32_bf16 v[104:107], v[40:43], v[192:195], v[104:107]
  s_add_u32 m0, s29, 18432
  s_add_u32 s27, s28, 2916352
  buffer_load_dwordx4 v14, s[60:63], s27 offen lds
  v_mfma_f32_16x16x32_bf16 v[112:115], v[40:43], v[224:227], v[112:115]
  s_waitcnt lgkmcnt(5)
  v_mul_f32 v66, v12, v66
  v_mfma_f32_16x16x32_bf16 v[92:95], v[44:47], v[128:131], v[92:95]
  ds_read_b128 v[36:39], v253 offset:18688
  v_mul_f32 v67, v12, v67
  v_mfma_f32_16x16x32_bf16 v[100:103], v[44:47], v[160:163], v[100:103]
  v_mul_f32 v68, v12, v68
  v_mul_f32 v69, v12, v69
  v_mfma_f32_16x16x32_bf16 v[108:111], v[44:47], v[192:195], v[108:111]
  v_mul_f32 v70, v12, v70
  v_mfma_f32_16x16x32_bf16 v[116:119], v[44:47], v[224:227], v[116:119]
  s_waitcnt lgkmcnt(5)
  v_mul_f32 v71, v12, v71
  v_mfma_f32_16x16x32_bf16 v[88:91], v[48:51], v[132:135], v[88:91]
  ds_read_b128 v[40:43], v254 offset:16640
  v_cvt_pk_bf16_f32 v64, v64, v65
  v_mfma_f32_16x16x32_bf16 v[96:99], v[48:51], v[164:167], v[96:99]
  v_cvt_pk_bf16_f32 v65, v66, v67
  v_cvt_pk_bf16_f32 v66, v68, v69
  v_mfma_f32_16x16x32_bf16 v[104:107], v[48:51], v[196:199], v[104:107]
  s_add_u32 m0, s29, 19456
  s_add_u32 s27, s28, 2932736
  buffer_load_dwordx4 v15, s[60:63], s27 offen lds
  v_mfma_f32_16x16x32_bf16 v[112:115], v[48:51], v[228:231], v[112:115]
  s_waitcnt lgkmcnt(5)
  v_cvt_pk_bf16_f32 v67, v70, v71
  v_mfma_f32_16x16x32_bf16 v[92:95], v[52:55], v[132:135], v[92:95]
  ds_read_b128 v[44:47], v254 offset:18688
  v_accvgpr_write_b32 a72, v64
  v_mfma_f32_16x16x32_bf16 v[100:103], v[52:55], v[164:167], v[100:103]
  v_accvgpr_write_b32 a73, v65
  v_accvgpr_write_b32 a74, v66
  v_mfma_f32_16x16x32_bf16 v[108:111], v[52:55], v[196:199], v[108:111]
  v_accvgpr_write_b32 a75, v67
  v_mfma_f32_16x16x32_bf16 v[116:119], v[52:55], v[228:231], v[116:119]
  s_waitcnt lgkmcnt(5)
  v_mul_f32 v72, v12, v72
  v_mfma_f32_16x16x32_bf16 v[88:91], v[24:27], v[136:139], v[88:91]
  ds_read_b128 v[48:51], v255 offset:16640
  v_mul_f32 v73, v12, v73
  v_mfma_f32_16x16x32_bf16 v[96:99], v[24:27], v[168:171], v[96:99]
  v_mul_f32 v74, v12, v74
  v_mul_f32 v75, v12, v75
  v_mfma_f32_16x16x32_bf16 v[104:107], v[24:27], v[200:203], v[104:107]
  v_mul_f32 v76, v12, v76
  v_mfma_f32_16x16x32_bf16 v[112:115], v[24:27], v[232:235], v[112:115]
  s_waitcnt lgkmcnt(5)
  v_mul_f32 v77, v12, v77
  v_mfma_f32_16x16x32_bf16 v[92:95], v[28:31], v[136:139], v[92:95]
  ds_read_b128 v[52:55], v255 offset:18688
  v_mul_f32 v78, v12, v78
  v_mfma_f32_16x16x32_bf16 v[100:103], v[28:31], v[168:171], v[100:103]
  v_mul_f32 v79, v12, v79
  v_cvt_pk_bf16_f32 v72, v72, v73
  v_mfma_f32_16x16x32_bf16 v[108:111], v[28:31], v[200:203], v[108:111]
  v_cvt_pk_bf16_f32 v73, v74, v75
  v_mfma_f32_16x16x32_bf16 v[116:119], v[28:31], v[232:235], v[116:119]
  s_waitcnt lgkmcnt(5)
  v_cvt_pk_bf16_f32 v74, v76, v77
  v_mfma_f32_16x16x32_bf16 v[88:91], v[32:35], v[140:143], v[88:91]
  s_waitcnt vmcnt(20)
  s_barrier
  ds_read_b128 v[24:27], v252 offset:32768
  v_cvt_pk_bf16_f32 v75, v78, v79
  v_mfma_f32_16x16x32_bf16 v[96:99], v[32:35], v[172:175], v[96:99]
  v_accvgpr_write_b32 a128, v72
  v_accvgpr_write_b32 a129, v73
  v_mfma_f32_16x16x32_bf16 v[104:107], v[32:35], v[204:207], v[104:107]
  v_accvgpr_write_b32 a130, v74
  v_mfma_f32_16x16x32_bf16 v[112:115], v[32:35], v[236:239], v[112:115]
  s_waitcnt lgkmcnt(5)
  v_accvgpr_write_b32 a131, v75
  v_mfma_f32_16x16x32_bf16 v[92:95], v[36:39], v[140:143], v[92:95]
  ds_read_b128 v[28:31], v252 offset:34816
  v_mul_f32 v80, v12, v80
  v_mfma_f32_16x16x32_bf16 v[100:103], v[36:39], v[172:175], v[100:103]
  v_mul_f32 v81, v12, v81
  v_mul_f32 v82, v12, v82
  v_mfma_f32_16x16x32_bf16 v[108:111], v[36:39], v[204:207], v[108:111]
  v_mul_f32 v83, v12, v83
  v_mfma_f32_16x16x32_bf16 v[116:119], v[36:39], v[236:239], v[116:119]
  s_waitcnt lgkmcnt(5)
  v_mul_f32 v84, v12, v84
  v_mfma_f32_16x16x32_bf16 v[88:91], v[40:43], v[144:147], v[88:91]
  ds_read_b128 v[32:35], v253 offset:32768
  v_mul_f32 v85, v12, v85
  v_mfma_f32_16x16x32_bf16 v[96:99], v[40:43], v[176:179], v[96:99]
  v_mul_f32 v86, v12, v86
  v_mul_f32 v87, v12, v87
  v_mfma_f32_16x16x32_bf16 v[104:107], v[40:43], v[208:211], v[104:107]
  v_cvt_pk_bf16_f32 v80, v80, v81
  v_mfma_f32_16x16x32_bf16 v[112:115], v[40:43], v[240:243], v[112:115]
  s_waitcnt lgkmcnt(5)
  v_cvt_pk_bf16_f32 v81, v82, v83
  v_mfma_f32_16x16x32_bf16 v[92:95], v[44:47], v[144:147], v[92:95]
  ds_read_b128 v[36:39], v253 offset:34816
  v_cvt_pk_bf16_f32 v82, v84, v85
  v_mfma_f32_16x16x32_bf16 v[100:103], v[44:47], v[176:179], v[100:103]
  v_cvt_pk_bf16_f32 v83, v86, v87
  v_accvgpr_write_b32 a184, v80
  v_mfma_f32_16x16x32_bf16 v[108:111], v[44:47], v[208:211], v[108:111]
  v_accvgpr_write_b32 a185, v81
  v_mfma_f32_16x16x32_bf16 v[116:119], v[44:47], v[240:243], v[116:119]
  s_waitcnt lgkmcnt(5)
  v_accvgpr_write_b32 a186, v82
  v_mfma_f32_16x16x32_bf16 v[88:91], v[48:51], v[148:151], v[88:91]
  ds_read_b128 v[40:43], v254 offset:32768
  v_accvgpr_write_b32 a187, v83
  v_mfma_f32_16x16x32_bf16 v[96:99], v[48:51], v[180:183], v[96:99]
  v_mfma_f32_16x16x32_bf16 v[104:107], v[48:51], v[212:215], v[104:107]
  v_mfma_f32_16x16x32_bf16 v[112:115], v[48:51], v[244:247], v[112:115]
  s_waitcnt lgkmcnt(5)
  v_mfma_f32_16x16x32_bf16 v[92:95], v[52:55], v[148:151], v[92:95]
  ds_read_b128 v[44:47], v254 offset:34816
  v_mfma_f32_16x16x32_bf16 v[100:103], v[52:55], v[180:183], v[100:103]
  v_mfma_f32_16x16x32_bf16 v[108:111], v[52:55], v[212:215], v[108:111]
  v_mfma_f32_16x16x32_bf16 v[116:119], v[52:55], v[244:247], v[116:119]
  s_waitcnt lgkmcnt(5)
  s_getpc_b64 s[98:99]
  s_add_u32 s98, s98, 4096
  s_addc_u32 s99, s99, 0
  global_load_dword v7, v6, s[98:99]
  v_mfma_f32_16x16x32_bf16 v[56:59], v[24:27], v[120:123], 0
  ds_read_b128 v[48:51], v255 offset:32768
  v_mfma_f32_16x16x32_bf16 v[64:67], v[24:27], v[152:155], 0
  v_mfma_f32_16x16x32_bf16 v[72:75], v[24:27], v[184:187], 0
  s_add_u32 m0, s29, 32768
  s_add_u32 s27, s28, 3145728
  buffer_load_dwordx4 v14, s[60:63], s27 offen lds
  v_mfma_f32_16x16x32_bf16 v[80:83], v[24:27], v[216:219], 0
  s_waitcnt lgkmcnt(5)
  v_mul_f32 v88, v12, v88
  v_mfma_f32_16x16x32_bf16 v[60:63], v[28:31], v[120:123], 0
  ds_read_b128 v[52:55], v255 offset:34816
  v_mul_f32 v89, v12, v89
  v_mfma_f32_16x16x32_bf16 v[68:71], v[28:31], v[152:155], 0
  v_mul_f32 v90, v12, v90
  v_mul_f32 v91, v12, v91
  v_mfma_f32_16x16x32_bf16 v[76:79], v[28:31], v[184:187], 0
  v_mul_f32 v92, v12, v92
  v_mfma_f32_16x16x32_bf16 v[84:87], v[28:31], v[216:219], 0
  s_waitcnt lgkmcnt(5)
  v_mul_f32 v93, v12, v93
  v_mfma_f32_16x16x32_bf16 v[56:59], v[32:35], v[124:127], v[56:59]
  ds_read_b128 v[24:27], v252 offset:33024
  v_mul_f32 v94, v12, v94
  v_mfma_f32_16x16x32_bf16 v[64:67], v[32:35], v[156:159], v[64:67]
  v_mul_f32 v95, v12, v95
  v_cvt_pk_bf16_f32 v88, v88, v89
  v_mfma_f32_16x16x32_bf16 v[72:75], v[32:35], v[188:191], v[72:75]
  s_add_u32 m0, s29, 33792
  s_add_u32 s27, s28, 3162112
  buffer_load_dwordx4 v15, s[60:63], s27 offen lds
  v_mfma_f32_16x16x32_bf16 v[80:83], v[32:35], v[220:223], v[80:83]
  s_waitcnt lgkmcnt(5)
  v_cvt_pk_bf16_f32 v89, v90, v91
  v_mfma_f32_16x16x32_bf16 v[60:63], v[36:39], v[124:127], v[60:63]
  ds_read_b128 v[28:31], v252 offset:35072
  v_cvt_pk_bf16_f32 v90, v92, v93
  v_mfma_f32_16x16x32_bf16 v[68:71], v[36:39], v[156:159], v[68:71]
  v_cvt_pk_bf16_f32 v91, v94, v95
  v_accvgpr_write_b32 a20, v88
  v_mfma_f32_16x16x32_bf16 v[76:79], v[36:39], v[188:191], v[76:79]
  v_accvgpr_write_b32 a21, v89
  v_mfma_f32_16x16x32_bf16 v[84:87], v[36:39], v[220:223], v[84:87]
  s_waitcnt lgkmcnt(5)
  v_accvgpr_write_b32 a22, v90
  v_mfma_f32_16x16x32_bf16 v[56:59], v[40:43], v[128:131], v[56:59]
  ds_read_b128 v[32:35], v253 offset:33024
  v_accvgpr_write_b32 a23, v91
  v_mfma_f32_16x16x32_bf16 v[64:67], v[40:43], v[160:163], v[64:67]
  v_mul_f32 v96, v12, v96
  v_mul_f32 v97, v12, v97
  v_mfma_f32_16x16x32_bf16 v[72:75], v[40:43], v[192:195], v[72:75]
  s_add_u32 m0, s29, 34816
  s_add_u32 s27, s28, 3178496
  buffer_load_dwordx4 v14, s[60:63], s27 offen lds
  v_mfma_f32_16x16x32_bf16 v[80:83], v[40:43], v[224:227], v[80:83]
  s_waitcnt lgkmcnt(5)
  v_mul_f32 v98, v12, v98
  v_mfma_f32_16x16x32_bf16 v[60:63], v[44:47], v[128:131], v[60:63]
  ds_read_b128 v[36:39], v253 offset:35072
  v_mul_f32 v99, v12, v99
  v_mfma_f32_16x16x32_bf16 v[68:71], v[44:47], v[160:163], v[68:71]
  v_mul_f32 v100, v12, v100
  v_mul_f32 v101, v12, v101
  v_mfma_f32_16x16x32_bf16 v[76:79], v[44:47], v[192:195], v[76:79]
  v_mul_f32 v102, v12, v102
  v_mfma_f32_16x16x32_bf16 v[84:87], v[44:47], v[224:227], v[84:87]
  s_waitcnt lgkmcnt(5)
  v_mul_f32 v103, v12, v103
  v_mfma_f32_16x16x32_bf16 v[56:59], v[48:51], v[132:135], v[56:59]
  ds_read_b128 v[40:43], v254 offset:33024
  v_cvt_pk_bf16_f32 v96, v96, v97
  v_mfma_f32_16x16x32_bf16 v[64:67], v[48:51], v[164:167], v[64:67]
  v_cvt_pk_bf16_f32 v97, v98, v99
  v_cvt_pk_bf16_f32 v98, v100, v101
  v_mfma_f32_16x16x32_bf16 v[72:75], v[48:51], v[196:199], v[72:75]
  s_add_u32 m0, s29, 35840
  s_add_u32 s27, s28, 3194880
  buffer_load_dwordx4 v15, s[60:63], s27 offen lds
  v_mfma_f32_16x16x32_bf16 v[80:83], v[48:51], v[228:231], v[80:83]
  s_waitcnt lgkmcnt(5)
  v_cvt_pk_bf16_f32 v99, v102, v103
  v_mfma_f32_16x16x32_bf16 v[60:63], v[52:55], v[132:135], v[60:63]
  ds_read_b128 v[44:47], v254 offset:35072
  v_accvgpr_write_b32 a76, v96
  v_mfma_f32_16x16x32_bf16 v[68:71], v[52:55], v[164:167], v[68:71]
  v_accvgpr_write_b32 a77, v97
  v_accvgpr_write_b32 a78, v98
  v_mfma_f32_16x16x32_bf16 v[76:79], v[52:55], v[196:199], v[76:79]
  v_accvgpr_write_b32 a79, v99
  v_mfma_f32_16x16x32_bf16 v[84:87], v[52:55], v[228:231], v[84:87]
  s_waitcnt lgkmcnt(5)
  v_mul_f32 v104, v12, v104
  v_mfma_f32_16x16x32_bf16 v[56:59], v[24:27], v[136:139], v[56:59]
  ds_read_b128 v[48:51], v255 offset:33024
  v_mul_f32 v105, v12, v105
  v_mfma_f32_16x16x32_bf16 v[64:67], v[24:27], v[168:171], v[64:67]
  v_mul_f32 v106, v12, v106
  v_mul_f32 v107, v12, v107
  v_mfma_f32_16x16x32_bf16 v[72:75], v[24:27], v[200:203], v[72:75]
  v_mul_f32 v108, v12, v108
  v_mfma_f32_16x16x32_bf16 v[80:83], v[24:27], v[232:235], v[80:83]
  s_waitcnt lgkmcnt(5)
  v_mul_f32 v109, v12, v109
  v_mfma_f32_16x16x32_bf16 v[60:63], v[28:31], v[136:139], v[60:63]
  ds_read_b128 v[52:55], v255 offset:35072
  v_mul_f32 v110, v12, v110
  v_mfma_f32_16x16x32_bf16 v[68:71], v[28:31], v[168:171], v[68:71]
  v_mul_f32 v111, v12, v111
  v_cvt_pk_bf16_f32 v104, v104, v105
  v_mfma_f32_16x16x32_bf16 v[76:79], v[28:31], v[200:203], v[76:79]
  v_cvt_pk_bf16_f32 v105, v106, v107
  v_mfma_f32_16x16x32_bf16 v[84:87], v[28:31], v[232:235], v[84:87]
  s_waitcnt lgkmcnt(5)
  v_cvt_pk_bf16_f32 v106, v108, v109
  v_mfma_f32_16x16x32_bf16 v[56:59], v[32:35], v[140:143], v[56:59]
  s_waitcnt vmcnt(20)
  s_barrier
  ds_read_b128 v[24:27], v252 offset:49152
  v_cvt_pk_bf16_f32 v107, v110, v111
  v_mfma_f32_16x16x32_bf16 v[64:67], v[32:35], v[172:175], v[64:67]
  v_accvgpr_write_b32 a132, v104
  v_accvgpr_write_b32 a133, v105
  v_mfma_f32_16x16x32_bf16 v[72:75], v[32:35], v[204:207], v[72:75]
  v_accvgpr_write_b32 a134, v106
  v_mfma_f32_16x16x32_bf16 v[80:83], v[32:35], v[236:239], v[80:83]
  s_waitcnt lgkmcnt(5)
  v_accvgpr_write_b32 a135, v107
  v_mfma_f32_16x16x32_bf16 v[60:63], v[36:39], v[140:143], v[60:63]
  ds_read_b128 v[28:31], v252 offset:51200
  v_mul_f32 v112, v12, v112
  v_mfma_f32_16x16x32_bf16 v[68:71], v[36:39], v[172:175], v[68:71]
  v_mul_f32 v113, v12, v113
  v_mul_f32 v114, v12, v114
  v_mfma_f32_16x16x32_bf16 v[76:79], v[36:39], v[204:207], v[76:79]
  v_mul_f32 v115, v12, v115
  v_mfma_f32_16x16x32_bf16 v[84:87], v[36:39], v[236:239], v[84:87]
  s_waitcnt lgkmcnt(5)
  v_mul_f32 v116, v12, v116
  v_mfma_f32_16x16x32_bf16 v[56:59], v[40:43], v[144:147], v[56:59]
  ds_read_b128 v[32:35], v253 offset:49152
  v_mul_f32 v117, v12, v117
  v_mfma_f32_16x16x32_bf16 v[64:67], v[40:43], v[176:179], v[64:67]
  v_mul_f32 v118, v12, v118
  v_mul_f32 v119, v12, v119
  v_mfma_f32_16x16x32_bf16 v[72:75], v[40:43], v[208:211], v[72:75]
  v_cvt_pk_bf16_f32 v112, v112, v113
  v_mfma_f32_16x16x32_bf16 v[80:83], v[40:43], v[240:243], v[80:83]
  s_waitcnt lgkmcnt(5)
  v_cvt_pk_bf16_f32 v113, v114, v115
  v_mfma_f32_16x16x32_bf16 v[60:63], v[44:47], v[144:147], v[60:63]
  ds_read_b128 v[36:39], v253 offset:51200
  v_cvt_pk_bf16_f32 v114, v116, v117
  v_mfma_f32_16x16x32_bf16 v[68:71], v[44:47], v[176:179], v[68:71]
  v_cvt_pk_bf16_f32 v115, v118, v119
  v_accvgpr_write_b32 a188, v112
  v_mfma_f32_16x16x32_bf16 v[76:79], v[44:47], v[208:211], v[76:79]
  v_accvgpr_write_b32 a189, v113
  v_mfma_f32_16x16x32_bf16 v[84:87], v[44:47], v[240:243], v[84:87]
  s_waitcnt lgkmcnt(5)
  v_accvgpr_write_b32 a190, v114
  v_mfma_f32_16x16x32_bf16 v[56:59], v[48:51], v[148:151], v[56:59]
  ds_read_b128 v[40:43], v254 offset:49152
  v_accvgpr_write_b32 a191, v115
  v_mfma_f32_16x16x32_bf16 v[64:67], v[48:51], v[180:183], v[64:67]
  v_mfma_f32_16x16x32_bf16 v[72:75], v[48:51], v[212:215], v[72:75]
  v_mfma_f32_16x16x32_bf16 v[80:83], v[48:51], v[244:247], v[80:83]
  s_waitcnt lgkmcnt(5)
  v_mfma_f32_16x16x32_bf16 v[60:63], v[52:55], v[148:151], v[60:63]
  ds_read_b128 v[44:47], v254 offset:51200
  v_mfma_f32_16x16x32_bf16 v[68:71], v[52:55], v[180:183], v[68:71]
  v_mfma_f32_16x16x32_bf16 v[76:79], v[52:55], v[212:215], v[76:79]
  v_mfma_f32_16x16x32_bf16 v[84:87], v[52:55], v[244:247], v[84:87]
  s_waitcnt lgkmcnt(5)
  v_mfma_f32_16x16x32_bf16 v[88:91], v[24:27], v[120:123], 0
  ds_read_b128 v[48:51], v255 offset:49152
  v_mfma_f32_16x16x32_bf16 v[96:99], v[24:27], v[152:155], 0
  v_mfma_f32_16x16x32_bf16 v[104:107], v[24:27], v[184:187], 0
  s_add_u32 m0, s29, 49152
  s_add_u32 s27, s28, 3407872
  buffer_load_dwordx4 v14, s[60:63], s27 offen lds
  v_mfma_f32_16x16x32_bf16 v[112:115], v[24:27], v[216:219], 0
  s_waitcnt lgkmcnt(5)
  v_mul_f32 v56, v12, v56
  v_mfma_f32_16x16x32_bf16 v[92:95], v[28:31], v[120:123], 0
  ds_read_b128 v[52:55], v255 offset:51200
  v_mul_f32 v57, v12, v57
  v_mfma_f32_16x16x32_bf16 v[100:103], v[28:31], v[152:155], 0
  v_mul_f32 v58, v12, v58
  v_mul_f32 v59, v12, v59
  v_mfma_f32_16x16x32_bf16 v[108:111], v[28:31], v[184:187], 0
  v_mul_f32 v60, v12, v60
  v_mfma_f32_16x16x32_bf16 v[116:119], v[28:31], v[216:219], 0
  s_waitcnt lgkmcnt(5)
  v_mul_f32 v61, v12, v61
  v_mfma_f32_16x16x32_bf16 v[88:91], v[32:35], v[124:127], v[88:91]
  ds_read_b128 v[24:27], v252 offset:49408
  v_mul_f32 v62, v12, v62
  v_mfma_f32_16x16x32_bf16 v[96:99], v[32:35], v[156:159], v[96:99]
  v_mul_f32 v63, v12, v63
  v_cvt_pk_bf16_f32 v56, v56, v57
  v_mfma_f32_16x16x32_bf16 v[104:107], v[32:35], v[188:191], v[104:107]
  s_add_u32 m0, s29, 50176
  s_add_u32 s27, s28, 3424256
  buffer_load_dwordx4 v15, s[60:63], s27 offen lds
  v_mfma_f32_16x16x32_bf16 v[112:115], v[32:35], v[220:223], v[112:115]
  s_waitcnt lgkmcnt(5)
  v_cvt_pk_bf16_f32 v57, v58, v59
  v_mfma_f32_16x16x32_bf16 v[92:95], v[36:39], v[124:127], v[92:95]
  ds_read_b128 v[28:31], v252 offset:51456
  v_cvt_pk_bf16_f32 v58, v60, v61
  v_mfma_f32_16x16x32_bf16 v[100:103], v[36:39], v[156:159], v[100:103]
  v_cvt_pk_bf16_f32 v59, v62, v63
  v_accvgpr_write_b32 a24, v56
  v_mfma_f32_16x16x32_bf16 v[108:111], v[36:39], v[188:191], v[108:111]
  v_accvgpr_write_b32 a25, v57
  v_mfma_f32_16x16x32_bf16 v[116:119], v[36:39], v[220:223], v[116:119]
  s_waitcnt lgkmcnt(5)
  v_accvgpr_write_b32 a26, v58
  v_mfma_f32_16x16x32_bf16 v[88:91], v[40:43], v[128:131], v[88:91]
  ds_read_b128 v[32:35], v253 offset:49408
  v_accvgpr_write_b32 a27, v59
  v_mfma_f32_16x16x32_bf16 v[96:99], v[40:43], v[160:163], v[96:99]
  v_mul_f32 v64, v12, v64
  v_mul_f32 v65, v12, v65
  v_mfma_f32_16x16x32_bf16 v[104:107], v[40:43], v[192:195], v[104:107]
  s_add_u32 m0, s29, 51200
  s_add_u32 s27, s28, 3440640
  buffer_load_dwordx4 v14, s[60:63], s27 offen lds
  v_mfma_f32_16x16x32_bf16 v[112:115], v[40:43], v[224:227], v[112:115]
  s_waitcnt lgkmcnt(5)
  v_mul_f32 v66, v12, v66
  v_mfma_f32_16x16x32_bf16 v[92:95], v[44:47], v[128:131], v[92:95]
  ds_read_b128 v[36:39], v253 offset:51456
  v_mul_f32 v67, v12, v67
  v_mfma_f32_16x16x32_bf16 v[100:103], v[44:47], v[160:163], v[100:103]
  v_mul_f32 v68, v12, v68
  v_mul_f32 v69, v12, v69
  v_mfma_f32_16x16x32_bf16 v[108:111], v[44:47], v[192:195], v[108:111]
  v_mul_f32 v70, v12, v70
  v_mfma_f32_16x16x32_bf16 v[116:119], v[44:47], v[224:227], v[116:119]
  s_waitcnt lgkmcnt(5)
  v_mul_f32 v71, v12, v71
  v_mfma_f32_16x16x32_bf16 v[88:91], v[48:51], v[132:135], v[88:91]
  ds_read_b128 v[40:43], v254 offset:49408
  v_cvt_pk_bf16_f32 v64, v64, v65
  v_mfma_f32_16x16x32_bf16 v[96:99], v[48:51], v[164:167], v[96:99]
  v_cvt_pk_bf16_f32 v65, v66, v67
  v_cvt_pk_bf16_f32 v66, v68, v69
  v_mfma_f32_16x16x32_bf16 v[104:107], v[48:51], v[196:199], v[104:107]
  s_add_u32 m0, s29, 52224
  s_add_u32 s27, s28, 3457024
  buffer_load_dwordx4 v15, s[60:63], s27 offen lds
  v_mfma_f32_16x16x32_bf16 v[112:115], v[48:51], v[228:231], v[112:115]
  s_waitcnt lgkmcnt(5)
  v_cvt_pk_bf16_f32 v67, v70, v71
  v_mfma_f32_16x16x32_bf16 v[92:95], v[52:55], v[132:135], v[92:95]
  ds_read_b128 v[44:47], v254 offset:51456
  v_accvgpr_write_b32 a80, v64
  v_mfma_f32_16x16x32_bf16 v[100:103], v[52:55], v[164:167], v[100:103]
  v_accvgpr_write_b32 a81, v65
  v_accvgpr_write_b32 a82, v66
  v_mfma_f32_16x16x32_bf16 v[108:111], v[52:55], v[196:199], v[108:111]
  v_accvgpr_write_b32 a83, v67
  v_mfma_f32_16x16x32_bf16 v[116:119], v[52:55], v[228:231], v[116:119]
  s_waitcnt lgkmcnt(5)
  v_mul_f32 v72, v12, v72
  v_mfma_f32_16x16x32_bf16 v[88:91], v[24:27], v[136:139], v[88:91]
  ds_read_b128 v[48:51], v255 offset:49408
  v_mul_f32 v73, v12, v73
  v_mfma_f32_16x16x32_bf16 v[96:99], v[24:27], v[168:171], v[96:99]
  v_mul_f32 v74, v12, v74
  v_mul_f32 v75, v12, v75
  v_mfma_f32_16x16x32_bf16 v[104:107], v[24:27], v[200:203], v[104:107]
  v_mul_f32 v76, v12, v76
  v_mfma_f32_16x16x32_bf16 v[112:115], v[24:27], v[232:235], v[112:115]
  s_waitcnt lgkmcnt(5)
  v_mul_f32 v77, v12, v77
  v_mfma_f32_16x16x32_bf16 v[92:95], v[28:31], v[136:139], v[92:95]
  ds_read_b128 v[52:55], v255 offset:51456
  v_mul_f32 v78, v12, v78
  v_mfma_f32_16x16x32_bf16 v[100:103], v[28:31], v[168:171], v[100:103]
  v_mul_f32 v79, v12, v79
  v_cvt_pk_bf16_f32 v72, v72, v73
  v_mfma_f32_16x16x32_bf16 v[108:111], v[28:31], v[200:203], v[108:111]
  v_cvt_pk_bf16_f32 v73, v74, v75
  v_mfma_f32_16x16x32_bf16 v[116:119], v[28:31], v[232:235], v[116:119]
  s_waitcnt lgkmcnt(5)
  v_cvt_pk_bf16_f32 v74, v76, v77
  v_mfma_f32_16x16x32_bf16 v[88:91], v[32:35], v[140:143], v[88:91]
  s_waitcnt vmcnt(20)
  s_barrier
  ds_read_b128 v[24:27], v16 offset:0
  v_cvt_pk_bf16_f32 v75, v78, v79
  v_mfma_f32_16x16x32_bf16 v[96:99], v[32:35], v[172:175], v[96:99]
  v_accvgpr_write_b32 a136, v72
  v_accvgpr_write_b32 a137, v73
  v_mfma_f32_16x16x32_bf16 v[104:107], v[32:35], v[204:207], v[104:107]
  v_accvgpr_write_b32 a138, v74
  v_mfma_f32_16x16x32_bf16 v[112:115], v[32:35], v[236:239], v[112:115]
  s_waitcnt lgkmcnt(5)
  v_accvgpr_write_b32 a139, v75
  v_mfma_f32_16x16x32_bf16 v[92:95], v[36:39], v[140:143], v[92:95]
  ds_read_b128 v[28:31], v16 offset:2048
  v_mul_f32 v80, v12, v80
  v_mfma_f32_16x16x32_bf16 v[100:103], v[36:39], v[172:175], v[100:103]
  v_mul_f32 v81, v12, v81
  v_mul_f32 v82, v12, v82
  v_mfma_f32_16x16x32_bf16 v[108:111], v[36:39], v[204:207], v[108:111]
  v_mul_f32 v83, v12, v83
  v_mfma_f32_16x16x32_bf16 v[116:119], v[36:39], v[236:239], v[116:119]
  s_waitcnt lgkmcnt(5)
  v_mul_f32 v84, v12, v84
  v_mfma_f32_16x16x32_bf16 v[88:91], v[40:43], v[144:147], v[88:91]
  ds_read_b128 v[32:35], v17 offset:0
  v_mul_f32 v85, v12, v85
  v_mfma_f32_16x16x32_bf16 v[96:99], v[40:43], v[176:179], v[96:99]
  v_mul_f32 v86, v12, v86
  v_mul_f32 v87, v12, v87
  v_mfma_f32_16x16x32_bf16 v[104:107], v[40:43], v[208:211], v[104:107]
  v_cvt_pk_bf16_f32 v80, v80, v81
  v_mfma_f32_16x16x32_bf16 v[112:115], v[40:43], v[240:243], v[112:115]
  s_waitcnt lgkmcnt(5)
  v_cvt_pk_bf16_f32 v81, v82, v83
  v_mfma_f32_16x16x32_bf16 v[92:95], v[44:47], v[144:147], v[92:95]
  ds_read_b128 v[36:39], v17 offset:2048
  v_cvt_pk_bf16_f32 v82, v84, v85
  v_mfma_f32_16x16x32_bf16 v[100:103], v[44:47], v[176:179], v[100:103]
  v_cvt_pk_bf16_f32 v83, v86, v87
  v_accvgpr_write_b32 a192, v80
  v_mfma_f32_16x16x32_bf16 v[108:111], v[44:47], v[208:211], v[108:111]
  v_accvgpr_write_b32 a193, v81
  v_mfma_f32_16x16x32_bf16 v[116:119], v[44:47], v[240:243], v[116:119]
  s_waitcnt lgkmcnt(5)
  v_accvgpr_write_b32 a194, v82
  v_mfma_f32_16x16x32_bf16 v[88:91], v[48:51], v[148:151], v[88:91]
  ds_read_b128 v[40:43], v18 offset:0
  v_accvgpr_write_b32 a195, v83
  v_mfma_f32_16x16x32_bf16 v[96:99], v[48:51], v[180:183], v[96:99]
  v_mfma_f32_16x16x32_bf16 v[104:107], v[48:51], v[212:215], v[104:107]
  v_mfma_f32_16x16x32_bf16 v[112:115], v[48:51], v[244:247], v[112:115]
  s_waitcnt lgkmcnt(5)
  v_mfma_f32_16x16x32_bf16 v[92:95], v[52:55], v[148:151], v[92:95]
  ds_read_b128 v[44:47], v18 offset:2048
  v_mfma_f32_16x16x32_bf16 v[100:103], v[52:55], v[180:183], v[100:103]
  v_mfma_f32_16x16x32_bf16 v[108:111], v[52:55], v[212:215], v[108:111]
  v_mfma_f32_16x16x32_bf16 v[116:119], v[52:55], v[244:247], v[116:119]
  s_waitcnt lgkmcnt(5)
  v_mfma_f32_16x16x32_bf16 v[56:59], v[24:27], v[120:123], 0
  ds_read_b128 v[48:51], v19 offset:0
  v_mfma_f32_16x16x32_bf16 v[64:67], v[24:27], v[152:155], 0
  v_mfma_f32_16x16x32_bf16 v[72:75], v[24:27], v[184:187], 0
  v_mfma_f32_16x16x32_bf16 v[80:83], v[24:27], v[216:219], 0
  s_waitcnt lgkmcnt(5)
  v_mul_f32 v88, v12, v88
  v_mfma_f32_16x16x32_bf16 v[60:63], v[28:31], v[120:123], 0
  ds_read_b128 v[52:55], v19 offset:2048
  v_mul_f32 v89, v12, v89
  v_mfma_f32_16x16x32_bf16 v[68:71], v[28:31], v[152:155], 0
  v_mul_f32 v90, v12, v90
  v_mul_f32 v91, v12, v91
  v_mfma_f32_16x16x32_bf16 v[76:79], v[28:31], v[184:187], 0
  v_mul_f32 v92, v12, v92
  v_mfma_f32_16x16x32_bf16 v[84:87], v[28:31], v[216:219], 0
  s_waitcnt lgkmcnt(5)
  v_mul_f32 v93, v12, v93
  v_mfma_f32_16x16x32_bf16 v[56:59], v[32:35], v[124:127], v[56:59]
  ds_read_b128 v[24:27], v16 offset:256
  v_mul_f32 v94, v12, v94
  v_mfma_f32_16x16x32_bf16 v[64:67], v[32:35], v[156:159], v[64:67]
  v_mul_f32 v95, v12, v95
  v_cvt_pk_bf16_f32 v88, v88, v89
  v_mfma_f32_16x16x32_bf16 v[72:75], v[32:35], v[188:191], v[72:75]
  v_cvt_pk_bf16_f32 v89, v90, v91
  v_mfma_f32_16x16x32_bf16 v[80:83], v[32:35], v[220:223], v[80:83]
  s_waitcnt lgkmcnt(5)
  v_cvt_pk_bf16_f32 v90, v92, v93
  v_mfma_f32_16x16x32_bf16 v[60:63], v[36:39], v[124:127], v[60:63]
  ds_read_b128 v[28:31], v16 offset:2304
  v_cvt_pk_bf16_f32 v91, v94, v95
  v_mfma_f32_16x16x32_bf16 v[68:71], v[36:39], v[156:159], v[68:71]
  v_accvgpr_write_b32 a28, v88
  v_accvgpr_write_b32 a29, v89
  v_mfma_f32_16x16x32_bf16 v[76:79], v[36:39], v[188:191], v[76:79]
  v_accvgpr_write_b32 a30, v90
  v_mfma_f32_16x16x32_bf16 v[84:87], v[36:39], v[220:223], v[84:87]
  s_waitcnt lgkmcnt(5)
  v_accvgpr_write_b32 a31, v91
  v_mfma_f32_16x16x32_bf16 v[56:59], v[40:43], v[128:131], v[56:59]
  ds_read_b128 v[32:35], v17 offset:256
  v_mul_f32 v96, v12, v96
  v_mfma_f32_16x16x32_bf16 v[64:67], v[40:43], v[160:163], v[64:67]
  v_mul_f32 v97, v12, v97
  v_mul_f32 v98, v12, v98
  v_mfma_f32_16x16x32_bf16 v[72:75], v[40:43], v[192:195], v[72:75]
  v_mul_f32 v99, v12, v99
  v_mfma_f32_16x16x32_bf16 v[80:83], v[40:43], v[224:227], v[80:83]
  s_waitcnt lgkmcnt(5)
  v_mul_f32 v100, v12, v100
  v_mfma_f32_16x16x32_bf16 v[60:63], v[44:47], v[128:131], v[60:63]
  ds_read_b128 v[36:39], v17 offset:2304
  v_mul_f32 v101, v12, v101
  v_mfma_f32_16x16x32_bf16 v[68:71], v[44:47], v[160:163], v[68:71]
  v_mul_f32 v102, v12, v102
  v_mul_f32 v103, v12, v103
  v_mfma_f32_16x16x32_bf16 v[76:79], v[44:47], v[192:195], v[76:79]
  v_cvt_pk_bf16_f32 v96, v96, v97
  v_mfma_f32_16x16x32_bf16 v[84:87], v[44:47], v[224:227], v[84:87]
  s_waitcnt lgkmcnt(5)
  v_cvt_pk_bf16_f32 v97, v98, v99
  v_mfma_f32_16x16x32_bf16 v[56:59], v[48:51], v[132:135], v[56:59]
  ds_read_b128 v[40:43], v18 offset:256
  v_cvt_pk_bf16_f32 v98, v100, v101
  v_mfma_f32_16x16x32_bf16 v[64:67], v[48:51], v[164:167], v[64:67]
  v_cvt_pk_bf16_f32 v99, v102, v103
  v_accvgpr_write_b32 a84, v96
  v_mfma_f32_16x16x32_bf16 v[72:75], v[48:51], v[196:199], v[72:75]
  v_accvgpr_write_b32 a85, v97
  v_mfma_f32_16x16x32_bf16 v[80:83], v[48:51], v[228:231], v[80:83]
  s_waitcnt lgkmcnt(5)
  v_accvgpr_write_b32 a86, v98
  v_mfma_f32_16x16x32_bf16 v[60:63], v[52:55], v[132:135], v[60:63]
  ds_read_b128 v[44:47], v18 offset:2304
  v_accvgpr_write_b32 a87, v99
  v_mfma_f32_16x16x32_bf16 v[68:71], v[52:55], v[164:167], v[68:71]
  v_mul_f32 v104, v12, v104
  v_mul_f32 v105, v12, v105
  v_mfma_f32_16x16x32_bf16 v[76:79], v[52:55], v[196:199], v[76:79]
  v_mul_f32 v106, v12, v106
  v_mfma_f32_16x16x32_bf16 v[84:87], v[52:55], v[228:231], v[84:87]
  s_waitcnt lgkmcnt(5)
  v_mul_f32 v107, v12, v107
  v_mfma_f32_16x16x32_bf16 v[56:59], v[24:27], v[136:139], v[56:59]
  ds_read_b128 v[48:51], v19 offset:256
  v_mul_f32 v108, v12, v108
  v_mfma_f32_16x16x32_bf16 v[64:67], v[24:27], v[168:171], v[64:67]
  v_mul_f32 v109, v12, v109
  v_mul_f32 v110, v12, v110
  v_mfma_f32_16x16x32_bf16 v[72:75], v[24:27], v[200:203], v[72:75]
  v_mul_f32 v111, v12, v111
  v_mfma_f32_16x16x32_bf16 v[80:83], v[24:27], v[232:235], v[80:83]
  s_waitcnt lgkmcnt(5)
  v_cvt_pk_bf16_f32 v104, v104, v105
  v_mfma_f32_16x16x32_bf16 v[60:63], v[28:31], v[136:139], v[60:63]
  ds_read_b128 v[52:55], v19 offset:2304
  v_cvt_pk_bf16_f32 v105, v106, v107
  v_mfma_f32_16x16x32_bf16 v[68:71], v[28:31], v[168:171], v[68:71]
  v_cvt_pk_bf16_f32 v106, v108, v109
  v_cvt_pk_bf16_f32 v107, v110, v111
  v_mfma_f32_16x16x32_bf16 v[76:79], v[28:31], v[200:203], v[76:79]
  v_accvgpr_write_b32 a140, v104
  v_mfma_f32_16x16x32_bf16 v[84:87], v[28:31], v[232:235], v[84:87]
  s_waitcnt lgkmcnt(5)
  v_accvgpr_write_b32 a141, v105
  v_mfma_f32_16x16x32_bf16 v[56:59], v[32:35], v[140:143], v[56:59]
  s_waitcnt vmcnt(16)
  s_barrier
  ds_read_b128 v[24:27], v16 offset:16384
  v_accvgpr_write_b32 a142, v106
  v_mfma_f32_16x16x32_bf16 v[64:67], v[32:35], v[172:175], v[64:67]
  v_accvgpr_write_b32 a143, v107
  v_mul_f32 v112, v12, v112
  v_mfma_f32_16x16x32_bf16 v[72:75], v[32:35], v[204:207], v[72:75]
  v_mul_f32 v113, v12, v113
  v_mfma_f32_16x16x32_bf16 v[80:83], v[32:35], v[236:239], v[80:83]
  s_waitcnt lgkmcnt(5)
  v_mul_f32 v114, v12, v114
  v_mfma_f32_16x16x32_bf16 v[60:63], v[36:39], v[140:143], v[60:63]
  ds_read_b128 v[28:31], v16 offset:18432
  v_mul_f32 v115, v12, v115
  v_mfma_f32_16x16x32_bf16 v[68:71], v[36:39], v[172:175], v[68:71]
  v_mul_f32 v116, v12, v116
  v_mul_f32 v117, v12, v117
  v_mfma_f32_16x16x32_bf16 v[76:79], v[36:39], v[204:207], v[76:79]
  v_mul_f32 v118, v12, v118
  v_mfma_f32_16x16x32_bf16 v[84:87], v[36:39], v[236:239], v[84:87]
  s_waitcnt lgkmcnt(5)
  v_mul_f32 v119, v12, v119
  v_mfma_f32_16x16x32_bf16 v[56:59], v[40:43], v[144:147], v[56:59]
  ds_read_b128 v[32:35], v17 offset:16384
  v_cvt_pk_bf16_f32 v112, v112, v113
  v_mfma_f32_16x16x32_bf16 v[64:67], v[40:43], v[176:179], v[64:67]
  v_cvt_pk_bf16_f32 v113, v114, v115
  v_cvt_pk_bf16_f32 v114, v116, v117
  v_mfma_f32_16x16x32_bf16 v[72:75], v[40:43], v[208:211], v[72:75]
  v_cvt_pk_bf16_f32 v115, v118, v119
  v_mfma_f32_16x16x32_bf16 v[80:83], v[40:43], v[240:243], v[80:83]
  s_waitcnt lgkmcnt(5)
  v_accvgpr_write_b32 a196, v112
  v_mfma_f32_16x16x32_bf16 v[60:63], v[44:47], v[144:147], v[60:63]
  ds_read_b128 v[36:39], v17 offset:18432
  v_accvgpr_write_b32 a197, v113
  v_mfma_f32_16x16x32_bf16 v[68:71], v[44:47], v[176:179], v[68:71]
  v_accvgpr_write_b32 a198, v114
  v_accvgpr_write_b32 a199, v115
  v_mfma_f32_16x16x32_bf16 v[76:79], v[44:47], v[208:211], v[76:79]
  v_mfma_f32_16x16x32_bf16 v[84:87], v[44:47], v[240:243], v[84:87]
  s_waitcnt lgkmcnt(5)
  v_mfma_f32_16x16x32_bf16 v[56:59], v[48:51], v[148:151], v[56:59]
  ds_read_b128 v[40:43], v18 offset:16384
  v_mfma_f32_16x16x32_bf16 v[64:67], v[48:51], v[180:183], v[64:67]
  v_mfma_f32_16x16x32_bf16 v[72:75], v[48:51], v[212:215], v[72:75]
  v_mfma_f32_16x16x32_bf16 v[80:83], v[48:51], v[244:247], v[80:83]
  s_waitcnt lgkmcnt(5)
  v_mfma_f32_16x16x32_bf16 v[60:63], v[52:55], v[148:151], v[60:63]
  ds_read_b128 v[44:47], v18 offset:18432
  v_mfma_f32_16x16x32_bf16 v[68:71], v[52:55], v[180:183], v[68:71]
  v_mfma_f32_16x16x32_bf16 v[76:79], v[52:55], v[212:215], v[76:79]
  v_mfma_f32_16x16x32_bf16 v[84:87], v[52:55], v[244:247], v[84:87]
  s_waitcnt lgkmcnt(5)
  s_getpc_b64 s[98:99]
  s_add_u32 s98, s98, 4096
  s_addc_u32 s99, s99, 0
  global_load_dword v7, v6, s[98:99]
  v_mfma_f32_16x16x32_bf16 v[88:91], v[24:27], v[120:123], 0
  ds_read_b128 v[48:51], v19 offset:16384
  v_mfma_f32_16x16x32_bf16 v[96:99], v[24:27], v[152:155], 0
  v_mfma_f32_16x16x32_bf16 v[104:107], v[24:27], v[184:187], 0
  v_mfma_f32_16x16x32_bf16 v[112:115], v[24:27], v[216:219], 0
  s_waitcnt lgkmcnt(5)
  v_mul_f32 v56, v12, v56
  v_mfma_f32_16x16x32_bf16 v[92:95], v[28:31], v[120:123], 0
  ds_read_b128 v[52:55], v19 offset:18432
  v_mul_f32 v57, v12, v57
  v_mfma_f32_16x16x32_bf16 v[100:103], v[28:31], v[152:155], 0
  v_mul_f32 v58, v12, v58
  v_mul_f32 v59, v12, v59
  v_mfma_f32_16x16x32_bf16 v[108:111], v[28:31], v[184:187], 0
  v_mul_f32 v60, v12, v60
  v_mfma_f32_16x16x32_bf16 v[116:119], v[28:31], v[216:219], 0
  s_waitcnt lgkmcnt(5)
  v_mul_f32 v61, v12, v61
  v_mfma_f32_16x16x32_bf16 v[88:91], v[32:35], v[124:127], v[88:91]
  ds_read_b128 v[24:27], v16 offset:16640
  v_mul_f32 v62, v12, v62
  v_mfma_f32_16x16x32_bf16 v[96:99], v[32:35], v[156:159], v[96:99]
  v_mul_f32 v63, v12, v63
  v_cvt_pk_bf16_f32 v56, v56, v57
  v_mfma_f32_16x16x32_bf16 v[104:107], v[32:35], v[188:191], v[104:107]
  v_cvt_pk_bf16_f32 v57, v58, v59
  v_mfma_f32_16x16x32_bf16 v[112:115], v[32:35], v[220:223], v[112:115]
  s_waitcnt lgkmcnt(5)
  v_cvt_pk_bf16_f32 v58, v60, v61
  v_mfma_f32_16x16x32_bf16 v[92:95], v[36:39], v[124:127], v[92:95]
  ds_read_b128 v[28:31], v16 offset:18688
  v_cvt_pk_bf16_f32 v59, v62, v63
  v_mfma_f32_16x16x32_bf16 v[100:103], v[36:39], v[156:159], v[100:103]
  v_accvgpr_write_b32 a32, v56
  v_accvgpr_write_b32 a33, v57
  v_mfma_f32_16x16x32_bf16 v[108:111], v[36:39], v[188:191], v[108:111]
  v_accvgpr_write_b32 a34, v58
  v_mfma_f32_16x16x32_bf16 v[116:119], v[36:39], v[220:223], v[116:119]
  s_waitcnt lgkmcnt(5)
  v_accvgpr_write_b32 a35, v59
  v_mfma_f32_16x16x32_bf16 v[88:91], v[40:43], v[128:131], v[88:91]
  ds_read_b128 v[32:35], v17 offset:16640
  v_mul_f32 v64, v12, v64
  v_mfma_f32_16x16x32_bf16 v[96:99], v[40:43], v[160:163], v[96:99]
  v_mul_f32 v65, v12, v65
  v_mul_f32 v66, v12, v66
  v_mfma_f32_16x16x32_bf16 v[104:107], v[40:43], v[192:195], v[104:107]
  v_mul_f32 v67, v12, v67
  v_mfma_f32_16x16x32_bf16 v[112:115], v[40:43], v[224:227], v[112:115]
  s_waitcnt lgkmcnt(5)
  v_mul_f32 v68, v12, v68
  v_mfma_f32_16x16x32_bf16 v[92:95], v[44:47], v[128:131], v[92:95]
  ds_read_b128 v[36:39], v17 offset:18688
  v_mul_f32 v69, v12, v69
  v_mfma_f32_16x16x32_bf16 v[100:103], v[44:47], v[160:163], v[100:103]
  v_mul_f32 v70, v12, v70
  v_mul_f32 v71, v12, v71
  v_mfma_f32_16x16x32_bf16 v[108:111], v[44:47], v[192:195], v[108:111]
  v_cvt_pk_bf16_f32 v64, v64, v65
  v_mfma_f32_16x16x32_bf16 v[116:119], v[44:47], v[224:227], v[116:119]
  s_waitcnt lgkmcnt(5)
  v_cvt_pk_bf16_f32 v65, v66, v67
  v_mfma_f32_16x16x32_bf16 v[88:91], v[48:51], v[132:135], v[88:91]
  ds_read_b128 v[40:43], v18 offset:16640
  v_cvt_pk_bf16_f32 v66, v68, v69
  v_mfma_f32_16x16x32_bf16 v[96:99], v[48:51], v[164:167], v[96:99]
  v_cvt_pk_bf16_f32 v67, v70, v71
  v_accvgpr_write_b32 a88, v64
  v_mfma_f32_16x16x32_bf16 v[104:107], v[48:51], v[196:199], v[104:107]
  v_accvgpr_write_b32 a89, v65
  v_mfma_f32_16x16x32_bf16 v[112:115], v[48:51], v[228:231], v[112:115]
  s_waitcnt lgkmcnt(5)
  v_accvgpr_write_b32 a90, v66
  v_mfma_f32_16x16x32_bf16 v[92:95], v[52:55], v[132:135], v[92:95]
  ds_read_b128 v[44:47], v18 offset:18688
  v_accvgpr_write_b32 a91, v67
  v_mfma_f32_16x16x32_bf16 v[100:103], v[52:55], v[164:167], v[100:103]
  v_mul_f32 v72, v12, v72
  v_mul_f32 v73, v12, v73
  v_mfma_f32_16x16x32_bf16 v[108:111], v[52:55], v[196:199], v[108:111]
  v_mul_f32 v74, v12, v74
  v_mfma_f32_16x16x32_bf16 v[116:119], v[52:55], v[228:231], v[116:119]
  s_waitcnt lgkmcnt(5)
  v_mul_f32 v75, v12, v75
  v_mfma_f32_16x16x32_bf16 v[88:91], v[24:27], v[136:139], v[88:91]
  ds_read_b128 v[48:51], v19 offset:16640
  v_mul_f32 v76, v12, v76
  v_mfma_f32_16x16x32_bf16 v[96:99], v[24:27], v[168:171], v[96:99]
  v_mul_f32 v77, v12, v77
  v_mul_f32 v78, v12, v78
  v_mfma_f32_16x16x32_bf16 v[104:107], v[24:27], v[200:203], v[104:107]
  v_mul_f32 v79, v12, v79
  v_mfma_f32_16x16x32_bf16 v[112:115], v[24:27], v[232:235], v[112:115]
  s_waitcnt lgkmcnt(5)
  v_cvt_pk_bf16_f32 v72, v72, v73
  v_mfma_f32_16x16x32_bf16 v[92:95], v[28:31], v[136:139], v[92:95]
  ds_read_b128 v[52:55], v19 offset:18688
  v_cvt_pk_bf16_f32 v73, v74, v75
  v_mfma_f32_16x16x32_bf16 v[100:103], v[28:31], v[168:171], v[100:103]
  v_cvt_pk_bf16_f32 v74, v76, v77
  v_cvt_pk_bf16_f32 v75, v78, v79
  v_mfma_f32_16x16x32_bf16 v[108:111], v[28:31], v[200:203], v[108:111]
  v_accvgpr_write_b32 a144, v72
  v_mfma_f32_16x16x32_bf16 v[116:119], v[28:31], v[232:235], v[116:119]
  s_waitcnt lgkmcnt(5)
  v_accvgpr_write_b32 a145, v73
  v_mfma_f32_16x16x32_bf16 v[88:91], v[32:35], v[140:143], v[88:91]
  s_waitcnt vmcnt(12)
  s_barrier
  ds_read_b128 v[24:27], v248 offset:0
  v_accvgpr_write_b32 a146, v74
  v_mfma_f32_16x16x32_bf16 v[96:99], v[32:35], v[172:175], v[96:99]
  v_accvgpr_write_b32 a147, v75
  v_mul_f32 v80, v12, v80
  v_mfma_f32_16x16x32_bf16 v[104:107], v[32:35], v[204:207], v[104:107]
  v_mul_f32 v81, v12, v81
  v_mfma_f32_16x16x32_bf16 v[112:115], v[32:35], v[236:239], v[112:115]
  s_waitcnt lgkmcnt(5)
  v_mul_f32 v82, v12, v82
  v_mfma_f32_16x16x32_bf16 v[92:95], v[36:39], v[140:143], v[92:95]
  ds_read_b128 v[28:31], v248 offset:2048
  v_mul_f32 v83, v12, v83
  v_mfma_f32_16x16x32_bf16 v[100:103], v[36:39], v[172:175], v[100:103]
  v_mul_f32 v84, v12, v84
  v_mul_f32 v85, v12, v85
  v_mfma_f32_16x16x32_bf16 v[108:111], v[36:39], v[204:207], v[108:111]
  v_mul_f32 v86, v12, v86
  v_mfma_f32_16x16x32_bf16 v[116:119], v[36:39], v[236:239], v[116:119]
  s_waitcnt lgkmcnt(5)
  v_mul_f32 v87, v12, v87
  v_mfma_f32_16x16x32_bf16 v[88:91], v[40:43], v[144:147], v[88:91]
  ds_read_b128 v[32:35], v249 offset:0
  v_cvt_pk_bf16_f32 v80, v80, v81
  v_mfma_f32_16x16x32_bf16 v[96:99], v[40:43], v[176:179], v[96:99]
  v_cvt_pk_bf16_f32 v81, v82, v83
  v_cvt_pk_bf16_f32 v82, v84, v85
  v_mfma_f32_16x16x32_bf16 v[104:107], v[40:43], v[208:211], v[104:107]
  v_cvt_pk_bf16_f32 v83, v86, v87
  v_mfma_f32_16x16x32_bf16 v[112:115], v[40:43], v[240:243], v[112:115]
  s_waitcnt lgkmcnt(5)
  v_accvgpr_write_b32 a200, v80
  v_mfma_f32_16x16x32_bf16 v[92:95], v[44:47], v[144:147], v[92:95]
  ds_read_b128 v[36:39], v249 offset:2048
  v_accvgpr_write_b32 a201, v81
  v_mfma_f32_16x16x32_bf16 v[100:103], v[44:47], v[176:179], v[100:103]
  v_accvgpr_write_b32 a202, v82
  v_accvgpr_write_b32 a203, v83
  v_mfma_f32_16x16x32_bf16 v[108:111], v[44:47], v[208:211], v[108:111]
  v_mfma_f32_16x16x32_bf16 v[116:119], v[44:47], v[240:243], v[116:119]
  s_waitcnt lgkmcnt(5)
  v_mfma_f32_16x16x32_bf16 v[88:91], v[48:51], v[148:151], v[88:91]
  ds_read_b128 v[40:43], v250 offset:0
  v_mfma_f32_16x16x32_bf16 v[96:99], v[48:51], v[180:183], v[96:99]
  v_mfma_f32_16x16x32_bf16 v[104:107], v[48:51], v[212:215], v[104:107]
  v_mfma_f32_16x16x32_bf16 v[112:115], v[48:51], v[244:247], v[112:115]
  s_waitcnt lgkmcnt(5)
  v_mfma_f32_16x16x32_bf16 v[92:95], v[52:55], v[148:151], v[92:95]
  ds_read_b128 v[44:47], v250 offset:2048
  v_mfma_f32_16x16x32_bf16 v[100:103], v[52:55], v[180:183], v[100:103]
  v_mfma_f32_16x16x32_bf16 v[108:111], v[52:55], v[212:215], v[108:111]
  v_mfma_f32_16x16x32_bf16 v[116:119], v[52:55], v[244:247], v[116:119]
  s_waitcnt lgkmcnt(5)
  v_mfma_f32_16x16x32_bf16 v[56:59], v[24:27], v[120:123], 0
  ds_read_b128 v[48:51], v251 offset:0
  v_mfma_f32_16x16x32_bf16 v[64:67], v[24:27], v[152:155], 0
  v_mfma_f32_16x16x32_bf16 v[72:75], v[24:27], v[184:187], 0
  v_mfma_f32_16x16x32_bf16 v[80:83], v[24:27], v[216:219], 0
  s_waitcnt lgkmcnt(5)
  v_mul_f32 v88, v12, v88
  v_mfma_f32_16x16x32_bf16 v[60:63], v[28:31], v[120:123], 0
  ds_read_b128 v[52:55], v251 offset:2048
  v_mul_f32 v89, v12, v89
  v_mfma_f32_16x16x32_bf16 v[68:71], v[28:31], v[152:155], 0
  v_mul_f32 v90, v12, v90
  v_mul_f32 v91, v12, v91
  v_mfma_f32_16x16x32_bf16 v[76:79], v[28:31], v[184:187], 0
  v_mul_f32 v92, v12, v92
  v_mfma_f32_16x16x32_bf16 v[84:87], v[28:31], v[216:219], 0
  s_waitcnt lgkmcnt(5)
  v_mul_f32 v93, v12, v93
  v_mfma_f32_16x16x32_bf16 v[56:59], v[32:35], v[124:127], v[56:59]
  ds_read_b128 v[24:27], v248 offset:256
  v_mul_f32 v94, v12, v94
  v_mfma_f32_16x16x32_bf16 v[64:67], v[32:35], v[156:159], v[64:67]
  v_mul_f32 v95, v12, v95
  v_cvt_pk_bf16_f32 v88, v88, v89
  v_mfma_f32_16x16x32_bf16 v[72:75], v[32:35], v[188:191], v[72:75]
  v_cvt_pk_bf16_f32 v89, v90, v91
  v_mfma_f32_16x16x32_bf16 v[80:83], v[32:35], v[220:223], v[80:83]
  s_waitcnt lgkmcnt(5)
  v_cvt_pk_bf16_f32 v90, v92, v93
  v_mfma_f32_16x16x32_bf16 v[60:63], v[36:39], v[124:127], v[60:63]
  ds_read_b128 v[28:31], v248 offset:2304
  v_cvt_pk_bf16_f32 v91, v94, v95
  v_mfma_f32_16x16x32_bf16 v[68:71], v[36:39], v[156:159], v[68:71]
  v_accvgpr_write_b32 a36, v88
  v_accvgpr_write_b32 a37, v89
  v_mfma_f32_16x16x32_bf16 v[76:79], v[36:39], v[188:191], v[76:79]
  v_accvgpr_write_b32 a38, v90
  v_mfma_f32_16x16x32_bf16 v[84:87], v[36:39], v[220:223], v[84:87]
  s_waitcnt lgkmcnt(5)
  v_accvgpr_write_b32 a39, v91
  v_mfma_f32_16x16x32_bf16 v[56:59], v[40:43], v[128:131], v[56:59]
  ds_read_b128 v[32:35], v249 offset:256
  v_mul_f32 v96, v12, v96
  v_mfma_f32_16x16x32_bf16 v[64:67], v[40:43], v[160:163], v[64:67]
  v_mul_f32 v97, v12, v97
  v_mul_f32 v98, v12, v98
  v_mfma_f32_16x16x32_bf16 v[72:75], v[40:43], v[192:195], v[72:75]
  v_mul_f32 v99, v12, v99
  v_mfma_f32_16x16x32_bf16 v[80:83], v[40:43], v[224:227], v[80:83]
  s_waitcnt lgkmcnt(5)
  v_mul_f32 v100, v12, v100
  v_mfma_f32_16x16x32_bf16 v[60:63], v[44:47], v[128:131], v[60:63]
  ds_read_b128 v[36:39], v249 offset:2304
  v_mul_f32 v101, v12, v101
  v_mfma_f32_16x16x32_bf16 v[68:71], v[44:47], v[160:163], v[68:71]
  v_mul_f32 v102, v12, v102
  v_mul_f32 v103, v12, v103
  v_mfma_f32_16x16x32_bf16 v[76:79], v[44:47], v[192:195], v[76:79]
  v_cvt_pk_bf16_f32 v96, v96, v97
  v_mfma_f32_16x16x32_bf16 v[84:87], v[44:47], v[224:227], v[84:87]
  s_waitcnt lgkmcnt(5)
  v_cvt_pk_bf16_f32 v97, v98, v99
  v_mfma_f32_16x16x32_bf16 v[56:59], v[48:51], v[132:135], v[56:59]
  ds_read_b128 v[40:43], v250 offset:256
  v_cvt_pk_bf16_f32 v98, v100, v101
  v_mfma_f32_16x16x32_bf16 v[64:67], v[48:51], v[164:167], v[64:67]
  v_cvt_pk_bf16_f32 v99, v102, v103
  v_accvgpr_write_b32 a92, v96
  v_mfma_f32_16x16x32_bf16 v[72:75], v[48:51], v[196:199], v[72:75]
  v_accvgpr_write_b32 a93, v97
  v_mfma_f32_16x16x32_bf16 v[80:83], v[48:51], v[228:231], v[80:83]
  s_waitcnt lgkmcnt(5)
  v_accvgpr_write_b32 a94, v98
  v_mfma_f32_16x16x32_bf16 v[60:63], v[52:55], v[132:135], v[60:63]
  ds_read_b128 v[44:47], v250 offset:2304
  v_accvgpr_write_b32 a95, v99
  v_mfma_f32_16x16x32_bf16 v[68:71], v[52:55], v[164:167], v[68:71]
  v_mul_f32 v104, v12, v104
  v_mul_f32 v105, v12, v105
  v_mfma_f32_16x16x32_bf16 v[76:79], v[52:55], v[196:199], v[76:79]
  v_mul_f32 v106, v12, v106
  v_mfma_f32_16x16x32_bf16 v[84:87], v[52:55], v[228:231], v[84:87]
  s_waitcnt lgkmcnt(5)
  v_mul_f32 v107, v12, v107
  v_mfma_f32_16x16x32_bf16 v[56:59], v[24:27], v[136:139], v[56:59]
  ds_read_b128 v[48:51], v251 offset:256
  v_mul_f32 v108, v12, v108
  v_mfma_f32_16x16x32_bf16 v[64:67], v[24:27], v[168:171], v[64:67]
  v_mul_f32 v109, v12, v109
  v_mul_f32 v110, v12, v110
  v_mfma_f32_16x16x32_bf16 v[72:75], v[24:27], v[200:203], v[72:75]
  v_mul_f32 v111, v12, v111
  v_mfma_f32_16x16x32_bf16 v[80:83], v[24:27], v[232:235], v[80:83]
  s_waitcnt lgkmcnt(5)
  v_cvt_pk_bf16_f32 v104, v104, v105
  v_mfma_f32_16x16x32_bf16 v[60:63], v[28:31], v[136:139], v[60:63]
  ds_read_b128 v[52:55], v251 offset:2304
  v_cvt_pk_bf16_f32 v105, v106, v107
  v_mfma_f32_16x16x32_bf16 v[68:71], v[28:31], v[168:171], v[68:71]
  v_cvt_pk_bf16_f32 v106, v108, v109
  v_cvt_pk_bf16_f32 v107, v110, v111
  v_mfma_f32_16x16x32_bf16 v[76:79], v[28:31], v[200:203], v[76:79]
  v_accvgpr_write_b32 a148, v104
  v_mfma_f32_16x16x32_bf16 v[84:87], v[28:31], v[232:235], v[84:87]
  s_waitcnt lgkmcnt(5)
  v_accvgpr_write_b32 a149, v105
  v_mfma_f32_16x16x32_bf16 v[56:59], v[32:35], v[140:143], v[56:59]
  s_waitcnt vmcnt(8)
  s_barrier
  ds_read_b128 v[24:27], v248 offset:16384
  v_accvgpr_write_b32 a150, v106
  v_mfma_f32_16x16x32_bf16 v[64:67], v[32:35], v[172:175], v[64:67]
  v_accvgpr_write_b32 a151, v107
  v_mul_f32 v112, v12, v112
  v_mfma_f32_16x16x32_bf16 v[72:75], v[32:35], v[204:207], v[72:75]
  v_mul_f32 v113, v12, v113
  v_mfma_f32_16x16x32_bf16 v[80:83], v[32:35], v[236:239], v[80:83]
  s_waitcnt lgkmcnt(5)
  v_mul_f32 v114, v12, v114
  v_mfma_f32_16x16x32_bf16 v[60:63], v[36:39], v[140:143], v[60:63]
  ds_read_b128 v[28:31], v248 offset:18432
  v_mul_f32 v115, v12, v115
  v_mfma_f32_16x16x32_bf16 v[68:71], v[36:39], v[172:175], v[68:71]
  v_mul_f32 v116, v12, v116
  v_mul_f32 v117, v12, v117
  v_mfma_f32_16x16x32_bf16 v[76:79], v[36:39], v[204:207], v[76:79]
  v_mul_f32 v118, v12, v118
  v_mfma_f32_16x16x32_bf16 v[84:87], v[36:39], v[236:239], v[84:87]
  s_waitcnt lgkmcnt(5)
  v_mul_f32 v119, v12, v119
  v_mfma_f32_16x16x32_bf16 v[56:59], v[40:43], v[144:147], v[56:59]
  ds_read_b128 v[32:35], v249 offset:16384
  v_cvt_pk_bf16_f32 v112, v112, v113
  v_mfma_f32_16x16x32_bf16 v[64:67], v[40:43], v[176:179], v[64:67]
  v_cvt_pk_bf16_f32 v113, v114, v115
  v_cvt_pk_bf16_f32 v114, v116, v117
  v_mfma_f32_16x16x32_bf16 v[72:75], v[40:43], v[208:211], v[72:75]
  v_cvt_pk_bf16_f32 v115, v118, v119
  v_mfma_f32_16x16x32_bf16 v[80:83], v[40:43], v[240:243], v[80:83]
  s_waitcnt lgkmcnt(5)
  v_accvgpr_write_b32 a204, v112
  v_mfma_f32_16x16x32_bf16 v[60:63], v[44:47], v[144:147], v[60:63]
  ds_read_b128 v[36:39], v249 offset:18432
  v_accvgpr_write_b32 a205, v113
  v_mfma_f32_16x16x32_bf16 v[68:71], v[44:47], v[176:179], v[68:71]
  v_accvgpr_write_b32 a206, v114
  v_accvgpr_write_b32 a207, v115
  v_mfma_f32_16x16x32_bf16 v[76:79], v[44:47], v[208:211], v[76:79]
  v_mfma_f32_16x16x32_bf16 v[84:87], v[44:47], v[240:243], v[84:87]
  s_waitcnt lgkmcnt(5)
  v_mfma_f32_16x16x32_bf16 v[56:59], v[48:51], v[148:151], v[56:59]
  ds_read_b128 v[40:43], v250 offset:16384
  v_mfma_f32_16x16x32_bf16 v[64:67], v[48:51], v[180:183], v[64:67]
  v_mfma_f32_16x16x32_bf16 v[72:75], v[48:51], v[212:215], v[72:75]
  v_mfma_f32_16x16x32_bf16 v[80:83], v[48:51], v[244:247], v[80:83]
  s_waitcnt lgkmcnt(5)
  v_mfma_f32_16x16x32_bf16 v[60:63], v[52:55], v[148:151], v[60:63]
  ds_read_b128 v[44:47], v250 offset:18432
  v_mfma_f32_16x16x32_bf16 v[68:71], v[52:55], v[180:183], v[68:71]
  v_mfma_f32_16x16x32_bf16 v[76:79], v[52:55], v[212:215], v[76:79]
  v_mfma_f32_16x16x32_bf16 v[84:87], v[52:55], v[244:247], v[84:87]
  s_waitcnt lgkmcnt(5)
  v_mfma_f32_16x16x32_bf16 v[88:91], v[24:27], v[120:123], 0
  ds_read_b128 v[48:51], v251 offset:16384
  v_mfma_f32_16x16x32_bf16 v[96:99], v[24:27], v[152:155], 0
  v_mfma_f32_16x16x32_bf16 v[104:107], v[24:27], v[184:187], 0
  v_mfma_f32_16x16x32_bf16 v[112:115], v[24:27], v[216:219], 0
  s_waitcnt lgkmcnt(5)
  v_mul_f32 v56, v12, v56
  v_mfma_f32_16x16x32_bf16 v[92:95], v[28:31], v[120:123], 0
  ds_read_b128 v[52:55], v251 offset:18432
  v_mul_f32 v57, v12, v57
  v_mfma_f32_16x16x32_bf16 v[100:103], v[28:31], v[152:155], 0
  v_mul_f32 v58, v12, v58
  v_mul_f32 v59, v12, v59
  v_mfma_f32_16x16x32_bf16 v[108:111], v[28:31], v[184:187], 0
  v_mul_f32 v60, v12, v60
  v_mfma_f32_16x16x32_bf16 v[116:119], v[28:31], v[216:219], 0
  s_waitcnt lgkmcnt(5)
  v_mul_f32 v61, v12, v61
  v_mfma_f32_16x16x32_bf16 v[88:91], v[32:35], v[124:127], v[88:91]
  ds_read_b128 v[24:27], v248 offset:16640
  v_mul_f32 v62, v12, v62
  v_mfma_f32_16x16x32_bf16 v[96:99], v[32:35], v[156:159], v[96:99]
  v_mul_f32 v63, v12, v63
  v_cvt_pk_bf16_f32 v56, v56, v57
  v_mfma_f32_16x16x32_bf16 v[104:107], v[32:35], v[188:191], v[104:107]
  v_cvt_pk_bf16_f32 v57, v58, v59
  v_mfma_f32_16x16x32_bf16 v[112:115], v[32:35], v[220:223], v[112:115]
  s_waitcnt lgkmcnt(5)
  v_cvt_pk_bf16_f32 v58, v60, v61
  v_mfma_f32_16x16x32_bf16 v[92:95], v[36:39], v[124:127], v[92:95]
  ds_read_b128 v[28:31], v248 offset:18688
  v_cvt_pk_bf16_f32 v59, v62, v63
  v_mfma_f32_16x16x32_bf16 v[100:103], v[36:39], v[156:159], v[100:103]
  v_accvgpr_write_b32 a40, v56
  v_accvgpr_write_b32 a41, v57
  v_mfma_f32_16x16x32_bf16 v[108:111], v[36:39], v[188:191], v[108:111]
  v_accvgpr_write_b32 a42, v58
  v_mfma_f32_16x16x32_bf16 v[116:119], v[36:39], v[220:223], v[116:119]
  s_waitcnt lgkmcnt(5)
  v_accvgpr_write_b32 a43, v59
  v_mfma_f32_16x16x32_bf16 v[88:91], v[40:43], v[128:131], v[88:91]
  ds_read_b128 v[32:35], v249 offset:16640
  v_mul_f32 v64, v12, v64
  v_mfma_f32_16x16x32_bf16 v[96:99], v[40:43], v[160:163], v[96:99]
  v_mul_f32 v65, v12, v65
  v_mul_f32 v66, v12, v66
  v_mfma_f32_16x16x32_bf16 v[104:107], v[40:43], v[192:195], v[104:107]
  v_mul_f32 v67, v12, v67
  v_mfma_f32_16x16x32_bf16 v[112:115], v[40:43], v[224:227], v[112:115]
  s_waitcnt lgkmcnt(5)
  v_mul_f32 v68, v12, v68
  v_mfma_f32_16x16x32_bf16 v[92:95], v[44:47], v[128:131], v[92:95]
  ds_read_b128 v[36:39], v249 offset:18688
  v_mul_f32 v69, v12, v69
  v_mfma_f32_16x16x32_bf16 v[100:103], v[44:47], v[160:163], v[100:103]
  v_mul_f32 v70, v12, v70
  v_mul_f32 v71, v12, v71
  v_mfma_f32_16x16x32_bf16 v[108:111], v[44:47], v[192:195], v[108:111]
  v_cvt_pk_bf16_f32 v64, v64, v65
  v_mfma_f32_16x16x32_bf16 v[116:119], v[44:47], v[224:227], v[116:119]
  s_waitcnt lgkmcnt(5)
  v_cvt_pk_bf16_f32 v65, v66, v67
  v_mfma_f32_16x16x32_bf16 v[88:91], v[48:51], v[132:135], v[88:91]
  ds_read_b128 v[40:43], v250 offset:16640
  v_cvt_pk_bf16_f32 v66, v68, v69
  v_mfma_f32_16x16x32_bf16 v[96:99], v[48:51], v[164:167], v[96:99]
  v_cvt_pk_bf16_f32 v67, v70, v71
  v_accvgpr_write_b32 a96, v64
  v_mfma_f32_16x16x32_bf16 v[104:107], v[48:51], v[196:199], v[104:107]
  v_accvgpr_write_b32 a97, v65
  v_mfma_f32_16x16x32_bf16 v[112:115], v[48:51], v[228:231], v[112:115]
  s_waitcnt lgkmcnt(5)
  v_accvgpr_write_b32 a98, v66
  v_mfma_f32_16x16x32_bf16 v[92:95], v[52:55], v[132:135], v[92:95]
  ds_read_b128 v[44:47], v250 offset:18688
  v_accvgpr_write_b32 a99, v67
  v_mfma_f32_16x16x32_bf16 v[100:103], v[52:55], v[164:167], v[100:103]
  v_mul_f32 v72, v12, v72
  v_mul_f32 v73, v12, v73
  v_mfma_f32_16x16x32_bf16 v[108:111], v[52:55], v[196:199], v[108:111]
  v_mul_f32 v74, v12, v74
  v_mfma_f32_16x16x32_bf16 v[116:119], v[52:55], v[228:231], v[116:119]
  s_waitcnt lgkmcnt(5)
  v_mul_f32 v75, v12, v75
  v_mfma_f32_16x16x32_bf16 v[88:91], v[24:27], v[136:139], v[88:91]
  ds_read_b128 v[48:51], v251 offset:16640
  v_mul_f32 v76, v12, v76
  v_mfma_f32_16x16x32_bf16 v[96:99], v[24:27], v[168:171], v[96:99]
  v_mul_f32 v77, v12, v77
  v_mul_f32 v78, v12, v78
  v_mfma_f32_16x16x32_bf16 v[104:107], v[24:27], v[200:203], v[104:107]
  v_mul_f32 v79, v12, v79
  v_mfma_f32_16x16x32_bf16 v[112:115], v[24:27], v[232:235], v[112:115]
  s_waitcnt lgkmcnt(5)
  v_cvt_pk_bf16_f32 v72, v72, v73
  v_mfma_f32_16x16x32_bf16 v[92:95], v[28:31], v[136:139], v[92:95]
  ds_read_b128 v[52:55], v251 offset:18688
  v_cvt_pk_bf16_f32 v73, v74, v75
  v_mfma_f32_16x16x32_bf16 v[100:103], v[28:31], v[168:171], v[100:103]
  v_cvt_pk_bf16_f32 v74, v76, v77
  v_cvt_pk_bf16_f32 v75, v78, v79
  v_mfma_f32_16x16x32_bf16 v[108:111], v[28:31], v[200:203], v[108:111]
  v_accvgpr_write_b32 a152, v72
  v_mfma_f32_16x16x32_bf16 v[116:119], v[28:31], v[232:235], v[116:119]
  s_waitcnt lgkmcnt(5)
  v_accvgpr_write_b32 a153, v73
  v_mfma_f32_16x16x32_bf16 v[88:91], v[32:35], v[140:143], v[88:91]
  s_waitcnt vmcnt(4)
  s_barrier
  ds_read_b128 v[24:27], v248 offset:32768
  v_accvgpr_write_b32 a154, v74
  v_mfma_f32_16x16x32_bf16 v[96:99], v[32:35], v[172:175], v[96:99]
  v_accvgpr_write_b32 a155, v75
  v_mul_f32 v80, v12, v80
  v_mfma_f32_16x16x32_bf16 v[104:107], v[32:35], v[204:207], v[104:107]
  v_mul_f32 v81, v12, v81
  v_mfma_f32_16x16x32_bf16 v[112:115], v[32:35], v[236:239], v[112:115]
  s_waitcnt lgkmcnt(5)
  v_mul_f32 v82, v12, v82
  v_mfma_f32_16x16x32_bf16 v[92:95], v[36:39], v[140:143], v[92:95]
  ds_read_b128 v[28:31], v248 offset:34816
  v_mul_f32 v83, v12, v83
  v_mfma_f32_16x16x32_bf16 v[100:103], v[36:39], v[172:175], v[100:103]
  v_mul_f32 v84, v12, v84
  v_mul_f32 v85, v12, v85
  v_mfma_f32_16x16x32_bf16 v[108:111], v[36:39], v[204:207], v[108:111]
  v_mul_f32 v86, v12, v86
  v_mfma_f32_16x16x32_bf16 v[116:119], v[36:39], v[236:239], v[116:119]
  s_waitcnt lgkmcnt(5)
  v_mul_f32 v87, v12, v87
  v_mfma_f32_16x16x32_bf16 v[88:91], v[40:43], v[144:147], v[88:91]
  ds_read_b128 v[32:35], v249 offset:32768
  v_cvt_pk_bf16_f32 v80, v80, v81
  v_mfma_f32_16x16x32_bf16 v[96:99], v[40:43], v[176:179], v[96:99]
  v_cvt_pk_bf16_f32 v81, v82, v83
  v_cvt_pk_bf16_f32 v82, v84, v85
  v_mfma_f32_16x16x32_bf16 v[104:107], v[40:43], v[208:211], v[104:107]
  v_cvt_pk_bf16_f32 v83, v86, v87
  v_mfma_f32_16x16x32_bf16 v[112:115], v[40:43], v[240:243], v[112:115]
  s_waitcnt lgkmcnt(5)
  v_accvgpr_write_b32 a208, v80
  v_mfma_f32_16x16x32_bf16 v[92:95], v[44:47], v[144:147], v[92:95]
  ds_read_b128 v[36:39], v249 offset:34816
  v_accvgpr_write_b32 a209, v81
  v_mfma_f32_16x16x32_bf16 v[100:103], v[44:47], v[176:179], v[100:103]
  v_accvgpr_write_b32 a210, v82
  v_accvgpr_write_b32 a211, v83
  v_mfma_f32_16x16x32_bf16 v[108:111], v[44:47], v[208:211], v[108:111]
  v_mfma_f32_16x16x32_bf16 v[116:119], v[44:47], v[240:243], v[116:119]
  s_waitcnt lgkmcnt(5)
  v_mfma_f32_16x16x32_bf16 v[88:91], v[48:51], v[148:151], v[88:91]
  ds_read_b128 v[40:43], v250 offset:32768
  v_mfma_f32_16x16x32_bf16 v[96:99], v[48:51], v[180:183], v[96:99]
  v_mfma_f32_16x16x32_bf16 v[104:107], v[48:51], v[212:215], v[104:107]
  v_mfma_f32_16x16x32_bf16 v[112:115], v[48:51], v[244:247], v[112:115]
  s_waitcnt lgkmcnt(5)
  v_mfma_f32_16x16x32_bf16 v[92:95], v[52:55], v[148:151], v[92:95]
  ds_read_b128 v[44:47], v250 offset:34816
  v_mfma_f32_16x16x32_bf16 v[100:103], v[52:55], v[180:183], v[100:103]
  v_mfma_f32_16x16x32_bf16 v[108:111], v[52:55], v[212:215], v[108:111]
  v_mfma_f32_16x16x32_bf16 v[116:119], v[52:55], v[244:247], v[116:119]
  s_waitcnt lgkmcnt(5)
  v_mfma_f32_16x16x32_bf16 v[56:59], v[24:27], v[120:123], 0
  ds_read_b128 v[48:51], v251 offset:32768
  v_mfma_f32_16x16x32_bf16 v[64:67], v[24:27], v[152:155], 0
  v_mfma_f32_16x16x32_bf16 v[72:75], v[24:27], v[184:187], 0
  v_mfma_f32_16x16x32_bf16 v[80:83], v[24:27], v[216:219], 0
  s_waitcnt lgkmcnt(5)
  v_mul_f32 v88, v12, v88
  v_mfma_f32_16x16x32_bf16 v[60:63], v[28:31], v[120:123], 0
  ds_read_b128 v[52:55], v251 offset:34816
  v_mul_f32 v89, v12, v89
  v_mfma_f32_16x16x32_bf16 v[68:71], v[28:31], v[152:155], 0
  v_mul_f32 v90, v12, v90
  v_mul_f32 v91, v12, v91
  v_mfma_f32_16x16x32_bf16 v[76:79], v[28:31], v[184:187], 0
  v_mul_f32 v92, v12, v92
  v_mfma_f32_16x16x32_bf16 v[84:87], v[28:31], v[216:219], 0
  s_waitcnt lgkmcnt(5)
  v_mul_f32 v93, v12, v93
  v_mfma_f32_16x16x32_bf16 v[56:59], v[32:35], v[124:127], v[56:59]
  ds_read_b128 v[24:27], v248 offset:33024
  v_mul_f32 v94, v12, v94
  v_mfma_f32_16x16x32_bf16 v[64:67], v[32:35], v[156:159], v[64:67]
  v_mul_f32 v95, v12, v95
  v_cvt_pk_bf16_f32 v88, v88, v89
  v_mfma_f32_16x16x32_bf16 v[72:75], v[32:35], v[188:191], v[72:75]
  v_mfma_f32_16x16x32_bf16 v[80:83], v[32:35], v[220:223], v[80:83]
  s_waitcnt lgkmcnt(5)
  v_cvt_pk_bf16_f32 v89, v90, v91
  v_mfma_f32_16x16x32_bf16 v[60:63], v[36:39], v[124:127], v[60:63]
  ds_read_b128 v[28:31], v248 offset:35072
  v_cvt_pk_bf16_f32 v90, v92, v93
  v_mfma_f32_16x16x32_bf16 v[68:71], v[36:39], v[156:159], v[68:71]
  v_cvt_pk_bf16_f32 v91, v94, v95
  v_accvgpr_write_b32 a44, v88
  v_mfma_f32_16x16x32_bf16 v[76:79], v[36:39], v[188:191], v[76:79]
  v_accvgpr_write_b32 a45, v89
  v_mfma_f32_16x16x32_bf16 v[84:87], v[36:39], v[220:223], v[84:87]
  s_waitcnt lgkmcnt(5)
  v_accvgpr_write_b32 a46, v90
  v_mfma_f32_16x16x32_bf16 v[56:59], v[40:43], v[128:131], v[56:59]
  ds_read_b128 v[32:35], v249 offset:33024
  v_accvgpr_write_b32 a47, v91
  v_mfma_f32_16x16x32_bf16 v[64:67], v[40:43], v[160:163], v[64:67]
  v_mul_f32 v96, v12, v96
  v_mul_f32 v97, v12, v97
  v_mfma_f32_16x16x32_bf16 v[72:75], v[40:43], v[192:195], v[72:75]
  v_mfma_f32_16x16x32_bf16 v[80:83], v[40:43], v[224:227], v[80:83]
  s_waitcnt lgkmcnt(5)
  v_mul_f32 v98, v12, v98
  v_mfma_f32_16x16x32_bf16 v[60:63], v[44:47], v[128:131], v[60:63]
  ds_read_b128 v[36:39], v249 offset:35072
  v_mul_f32 v99, v12, v99
  v_mfma_f32_16x16x32_bf16 v[68:71], v[44:47], v[160:163], v[68:71]
  v_mul_f32 v100, v12, v100
  v_mul_f32 v101, v12, v101
  v_mfma_f32_16x16x32_bf16 v[76:79], v[44:47], v[192:195], v[76:79]
  v_mul_f32 v102, v12, v102
  v_mfma_f32_16x16x32_bf16 v[84:87], v[44:47], v[224:227], v[84:87]
  s_waitcnt lgkmcnt(5)
  v_mul_f32 v103, v12, v103
  v_mfma_f32_16x16x32_bf16 v[56:59], v[48:51], v[132:135], v[56:59]
  ds_read_b128 v[40:43], v250 offset:33024
  v_cvt_pk_bf16_f32 v96, v96, v97
  v_mfma_f32_16x16x32_bf16 v[64:67], v[48:51], v[164:167], v[64:67]
  v_cvt_pk_bf16_f32 v97, v98, v99
  v_cvt_pk_bf16_f32 v98, v100, v101
  v_mfma_f32_16x16x32_bf16 v[72:75], v[48:51], v[196:199], v[72:75]
  v_mfma_f32_16x16x32_bf16 v[80:83], v[48:51], v[228:231], v[80:83]
  s_waitcnt lgkmcnt(5)
  v_cvt_pk_bf16_f32 v99, v102, v103
  v_mfma_f32_16x16x32_bf16 v[60:63], v[52:55], v[132:135], v[60:63]
  ds_read_b128 v[44:47], v250 offset:35072
  v_accvgpr_write_b32 a100, v96
  v_mfma_f32_16x16x32_bf16 v[68:71], v[52:55], v[164:167], v[68:71]
  v_accvgpr_write_b32 a101, v97
  v_accvgpr_write_b32 a102, v98
  v_mfma_f32_16x16x32_bf16 v[76:79], v[52:55], v[196:199], v[76:79]
  v_accvgpr_write_b32 a103, v99
  v_mfma_f32_16x16x32_bf16 v[84:87], v[52:55], v[228:231], v[84:87]
  s_waitcnt lgkmcnt(5)
  v_mul_f32 v104, v12, v104
  v_mfma_f32_16x16x32_bf16 v[56:59], v[24:27], v[136:139], v[56:59]
  ds_read_b128 v[48:51], v251 offset:33024
  v_mul_f32 v105, v12, v105
  v_mfma_f32_16x16x32_bf16 v[64:67], v[24:27], v[168:171], v[64:67]
  v_mul_f32 v106, v12, v106
  v_mul_f32 v107, v12, v107
  v_mfma_f32_16x16x32_bf16 v[72:75], v[24:27], v[200:203], v[72:75]
  v_mfma_f32_16x16x32_bf16 v[80:83], v[24:27], v[232:235], v[80:83]
  s_waitcnt lgkmcnt(5)
  v_mul_f32 v108, v12, v108
  v_mfma_f32_16x16x32_bf16 v[60:63], v[28:31], v[136:139], v[60:63]
  ds_read_b128 v[52:55], v251 offset:35072
  v_mul_f32 v109, v12, v109
  v_mfma_f32_16x16x32_bf16 v[68:71], v[28:31], v[168:171], v[68:71]
  v_mul_f32 v110, v12, v110
  v_mul_f32 v111, v12, v111
  v_mfma_f32_16x16x32_bf16 v[76:79], v[28:31], v[200:203], v[76:79]
  v_cvt_pk_bf16_f32 v104, v104, v105
  v_mfma_f32_16x16x32_bf16 v[84:87], v[28:31], v[232:235], v[84:87]
  s_waitcnt lgkmcnt(5)
  v_cvt_pk_bf16_f32 v105, v106, v107
  v_mfma_f32_16x16x32_bf16 v[56:59], v[32:35], v[140:143], v[56:59]
  s_waitcnt vmcnt(0)
  s_barrier
  ds_read_b128 v[24:27], v248 offset:49152
  v_cvt_pk_bf16_f32 v106, v108, v109
  v_mfma_f32_16x16x32_bf16 v[64:67], v[32:35], v[172:175], v[64:67]
  v_cvt_pk_bf16_f32 v107, v110, v111
  v_accvgpr_write_b32 a156, v104
  v_mfma_f32_16x16x32_bf16 v[72:75], v[32:35], v[204:207], v[72:75]
  v_mfma_f32_16x16x32_bf16 v[80:83], v[32:35], v[236:239], v[80:83]
  s_waitcnt lgkmcnt(5)
  v_accvgpr_write_b32 a157, v105
  v_mfma_f32_16x16x32_bf16 v[60:63], v[36:39], v[140:143], v[60:63]
  ds_read_b128 v[28:31], v248 offset:51200
  v_accvgpr_write_b32 a158, v106
  v_mfma_f32_16x16x32_bf16 v[68:71], v[36:39], v[172:175], v[68:71]
  v_accvgpr_write_b32 a159, v107
  v_mul_f32 v112, v12, v112
  v_mfma_f32_16x16x32_bf16 v[76:79], v[36:39], v[204:207], v[76:79]
  v_mul_f32 v113, v12, v113
  v_mfma_f32_16x16x32_bf16 v[84:87], v[36:39], v[236:239], v[84:87]
  s_waitcnt lgkmcnt(5)
  v_mul_f32 v114, v12, v114
  v_mfma_f32_16x16x32_bf16 v[56:59], v[40:43], v[144:147], v[56:59]
  ds_read_b128 v[32:35], v249 offset:49152
  v_mul_f32 v115, v12, v115
  v_mfma_f32_16x16x32_bf16 v[64:67], v[40:43], v[176:179], v[64:67]
  v_mul_f32 v116, v12, v116
  v_mul_f32 v117, v12, v117
  v_mfma_f32_16x16x32_bf16 v[72:75], v[40:43], v[208:211], v[72:75]
  v_readfirstlane_b32 s86, v13
  s_lshl_b32 s22, s17, 7
  s_add_u32 s22, s22, 584192
  s_mov_b32 s23, 586240
  buffer_load_dword v13, off, s[8:11], s22 sc1
  buffer_load_dwordx2 v[10:11], off, s[8:11], s23 sc1
  v_mfma_f32_16x16x32_bf16 v[80:83], v[40:43], v[240:243], v[80:83]
  s_waitcnt lgkmcnt(5)
  v_mul_f32 v118, v12, v118
  v_mfma_f32_16x16x32_bf16 v[60:63], v[44:47], v[144:147], v[60:63]
  ds_read_b128 v[36:39], v249 offset:51200
  v_mul_f32 v119, v12, v119
  v_mfma_f32_16x16x32_bf16 v[68:71], v[44:47], v[176:179], v[68:71]
  v_cvt_pk_bf16_f32 v112, v112, v113
  v_cvt_pk_bf16_f32 v113, v114, v115
  v_mfma_f32_16x16x32_bf16 v[76:79], v[44:47], v[208:211], v[76:79]
  v_cvt_pk_bf16_f32 v114, v116, v117
  v_mfma_f32_16x16x32_bf16 v[84:87], v[44:47], v[240:243], v[84:87]
  s_waitcnt lgkmcnt(5)
  v_cvt_pk_bf16_f32 v115, v118, v119
  v_mfma_f32_16x16x32_bf16 v[56:59], v[48:51], v[148:151], v[56:59]
  ds_read_b128 v[40:43], v250 offset:49152
  v_accvgpr_write_b32 a212, v112
  v_mfma_f32_16x16x32_bf16 v[64:67], v[48:51], v[180:183], v[64:67]
  v_accvgpr_write_b32 a213, v113
  v_accvgpr_write_b32 a214, v114
  v_mfma_f32_16x16x32_bf16 v[72:75], v[48:51], v[212:215], v[72:75]
  v_accvgpr_write_b32 a215, v115
  v_mfma_f32_16x16x32_bf16 v[80:83], v[48:51], v[244:247], v[80:83]
  s_waitcnt lgkmcnt(5)
  v_mfma_f32_16x16x32_bf16 v[60:63], v[52:55], v[148:151], v[60:63]
  ds_read_b128 v[44:47], v250 offset:51200
  v_mfma_f32_16x16x32_bf16 v[68:71], v[52:55], v[180:183], v[68:71]
  v_mfma_f32_16x16x32_bf16 v[76:79], v[52:55], v[212:215], v[76:79]
  v_mfma_f32_16x16x32_bf16 v[84:87], v[52:55], v[244:247], v[84:87]
  s_waitcnt lgkmcnt(5)
  v_mfma_f32_16x16x32_bf16 v[88:91], v[24:27], v[120:123], 0
  ds_read_b128 v[48:51], v251 offset:49152
  v_mfma_f32_16x16x32_bf16 v[96:99], v[24:27], v[152:155], 0
  v_mfma_f32_16x16x32_bf16 v[104:107], v[24:27], v[184:187], 0
  v_mfma_f32_16x16x32_bf16 v[112:115], v[24:27], v[216:219], 0
  s_waitcnt lgkmcnt(5)
  v_mul_f32 v56, v12, v56
  v_mfma_f32_16x16x32_bf16 v[92:95], v[28:31], v[120:123], 0
  ds_read_b128 v[52:55], v251 offset:51200
  v_mul_f32 v57, v12, v57
  v_mfma_f32_16x16x32_bf16 v[100:103], v[28:31], v[152:155], 0
  v_mul_f32 v58, v12, v58
  v_mul_f32 v59, v12, v59
  v_mfma_f32_16x16x32_bf16 v[108:111], v[28:31], v[184:187], 0
  v_mul_f32 v60, v12, v60
  v_mfma_f32_16x16x32_bf16 v[116:119], v[28:31], v[216:219], 0
  s_waitcnt lgkmcnt(5)
  v_mul_f32 v61, v12, v61
  v_mfma_f32_16x16x32_bf16 v[88:91], v[32:35], v[124:127], v[88:91]
  ds_read_b128 v[24:27], v248 offset:49408
  v_mul_f32 v62, v12, v62
  v_mfma_f32_16x16x32_bf16 v[96:99], v[32:35], v[156:159], v[96:99]
  v_mul_f32 v63, v12, v63
  v_cvt_pk_bf16_f32 v56, v56, v57
  v_mfma_f32_16x16x32_bf16 v[104:107], v[32:35], v[188:191], v[104:107]
  v_cvt_pk_bf16_f32 v57, v58, v59
  v_mfma_f32_16x16x32_bf16 v[112:115], v[32:35], v[220:223], v[112:115]
  s_waitcnt lgkmcnt(5)
  v_cvt_pk_bf16_f32 v58, v60, v61
  v_mfma_f32_16x16x32_bf16 v[92:95], v[36:39], v[124:127], v[92:95]
  ds_read_b128 v[28:31], v248 offset:51456
  v_cvt_pk_bf16_f32 v59, v62, v63
  v_mfma_f32_16x16x32_bf16 v[100:103], v[36:39], v[156:159], v[100:103]
  v_accvgpr_write_b32 a48, v56
  v_accvgpr_write_b32 a49, v57
  v_mfma_f32_16x16x32_bf16 v[108:111], v[36:39], v[188:191], v[108:111]
  v_accvgpr_write_b32 a50, v58
  v_mfma_f32_16x16x32_bf16 v[116:119], v[36:39], v[220:223], v[116:119]
  s_waitcnt lgkmcnt(5)
  v_accvgpr_write_b32 a51, v59
  v_mfma_f32_16x16x32_bf16 v[88:91], v[40:43], v[128:131], v[88:91]
  ds_read_b128 v[32:35], v249 offset:49408
  v_mul_f32 v64, v12, v64
  v_mfma_f32_16x16x32_bf16 v[96:99], v[40:43], v[160:163], v[96:99]
  v_mul_f32 v65, v12, v65
  v_mul_f32 v66, v12, v66
  v_mfma_f32_16x16x32_bf16 v[104:107], v[40:43], v[192:195], v[104:107]
  v_mul_f32 v67, v12, v67
  v_mfma_f32_16x16x32_bf16 v[112:115], v[40:43], v[224:227], v[112:115]
  s_waitcnt lgkmcnt(5)
  v_mul_f32 v68, v12, v68
  v_mfma_f32_16x16x32_bf16 v[92:95], v[44:47], v[128:131], v[92:95]
  ds_read_b128 v[36:39], v249 offset:51456
  v_mul_f32 v69, v12, v69
  v_mfma_f32_16x16x32_bf16 v[100:103], v[44:47], v[160:163], v[100:103]
  v_mul_f32 v70, v12, v70
  v_mul_f32 v71, v12, v71
  v_mfma_f32_16x16x32_bf16 v[108:111], v[44:47], v[192:195], v[108:111]
  v_cvt_pk_bf16_f32 v64, v64, v65
  v_mfma_f32_16x16x32_bf16 v[116:119], v[44:47], v[224:227], v[116:119]
  s_waitcnt lgkmcnt(5)
  v_cvt_pk_bf16_f32 v65, v66, v67
  v_mfma_f32_16x16x32_bf16 v[88:91], v[48:51], v[132:135], v[88:91]
  ds_read_b128 v[40:43], v250 offset:49408
  v_cvt_pk_bf16_f32 v66, v68, v69
  v_mfma_f32_16x16x32_bf16 v[96:99], v[48:51], v[164:167], v[96:99]
  v_cvt_pk_bf16_f32 v67, v70, v71
  v_accvgpr_write_b32 a104, v64
  v_mfma_f32_16x16x32_bf16 v[104:107], v[48:51], v[196:199], v[104:107]
  v_accvgpr_write_b32 a105, v65
  v_mfma_f32_16x16x32_bf16 v[112:115], v[48:51], v[228:231], v[112:115]
  s_waitcnt lgkmcnt(5)
  v_accvgpr_write_b32 a106, v66
  v_mfma_f32_16x16x32_bf16 v[92:95], v[52:55], v[132:135], v[92:95]
  ds_read_b128 v[44:47], v250 offset:51456
  v_accvgpr_write_b32 a107, v67
  v_mfma_f32_16x16x32_bf16 v[100:103], v[52:55], v[164:167], v[100:103]
  v_mul_f32 v72, v12, v72
  v_mul_f32 v73, v12, v73
  v_mfma_f32_16x16x32_bf16 v[108:111], v[52:55], v[196:199], v[108:111]
  v_mul_f32 v74, v12, v74
  v_mfma_f32_16x16x32_bf16 v[116:119], v[52:55], v[228:231], v[116:119]
  s_waitcnt lgkmcnt(5)
  v_mul_f32 v75, v12, v75
  v_mfma_f32_16x16x32_bf16 v[88:91], v[24:27], v[136:139], v[88:91]
  ds_read_b128 v[48:51], v251 offset:49408
  v_mul_f32 v76, v12, v76
  v_mfma_f32_16x16x32_bf16 v[96:99], v[24:27], v[168:171], v[96:99]
  v_mul_f32 v77, v12, v77
  v_mul_f32 v78, v12, v78
  v_mfma_f32_16x16x32_bf16 v[104:107], v[24:27], v[200:203], v[104:107]
  v_mul_f32 v79, v12, v79
  v_mfma_f32_16x16x32_bf16 v[112:115], v[24:27], v[232:235], v[112:115]
  s_waitcnt lgkmcnt(5)
  v_cvt_pk_bf16_f32 v72, v72, v73
  v_mfma_f32_16x16x32_bf16 v[92:95], v[28:31], v[136:139], v[92:95]
  ds_read_b128 v[52:55], v251 offset:51456
  v_cvt_pk_bf16_f32 v73, v74, v75
  v_mfma_f32_16x16x32_bf16 v[100:103], v[28:31], v[168:171], v[100:103]
  v_cvt_pk_bf16_f32 v74, v76, v77
  v_cvt_pk_bf16_f32 v75, v78, v79
  v_mfma_f32_16x16x32_bf16 v[108:111], v[28:31], v[200:203], v[108:111]
  v_accvgpr_write_b32 a160, v72
  v_mfma_f32_16x16x32_bf16 v[116:119], v[28:31], v[232:235], v[116:119]
  s_waitcnt lgkmcnt(5)
  v_accvgpr_write_b32 a161, v73
  v_mfma_f32_16x16x32_bf16 v[88:91], v[32:35], v[140:143], v[88:91]
  v_accvgpr_write_b32 a162, v74
  v_mfma_f32_16x16x32_bf16 v[96:99], v[32:35], v[172:175], v[96:99]
  v_accvgpr_write_b32 a163, v75
  v_mul_f32 v80, v12, v80
  v_mfma_f32_16x16x32_bf16 v[104:107], v[32:35], v[204:207], v[104:107]
  v_mul_f32 v81, v12, v81
  v_mfma_f32_16x16x32_bf16 v[112:115], v[32:35], v[236:239], v[112:115]
  s_waitcnt lgkmcnt(4)
  v_mul_f32 v82, v12, v82
  v_mfma_f32_16x16x32_bf16 v[92:95], v[36:39], v[140:143], v[92:95]
  v_mul_f32 v83, v12, v83
  v_mfma_f32_16x16x32_bf16 v[100:103], v[36:39], v[172:175], v[100:103]
  v_mul_f32 v84, v12, v84
  v_mul_f32 v85, v12, v85
  v_mfma_f32_16x16x32_bf16 v[108:111], v[36:39], v[204:207], v[108:111]
  v_mul_f32 v86, v12, v86
  v_mfma_f32_16x16x32_bf16 v[116:119], v[36:39], v[236:239], v[116:119]
  s_waitcnt lgkmcnt(3)
  v_mul_f32 v87, v12, v87
  v_mfma_f32_16x16x32_bf16 v[88:91], v[40:43], v[144:147], v[88:91]
  v_cvt_pk_bf16_f32 v80, v80, v81
  v_mfma_f32_16x16x32_bf16 v[96:99], v[40:43], v[176:179], v[96:99]
  v_cvt_pk_bf16_f32 v81, v82, v83
  v_cvt_pk_bf16_f32 v82, v84, v85
  v_mfma_f32_16x16x32_bf16 v[104:107], v[40:43], v[208:211], v[104:107]
  v_cvt_pk_bf16_f32 v83, v86, v87
  v_mfma_f32_16x16x32_bf16 v[112:115], v[40:43], v[240:243], v[112:115]
  s_waitcnt lgkmcnt(2)
  v_accvgpr_write_b32 a216, v80
  v_mfma_f32_16x16x32_bf16 v[92:95], v[44:47], v[144:147], v[92:95]
  v_accvgpr_write_b32 a217, v81
  v_mfma_f32_16x16x32_bf16 v[100:103], v[44:47], v[176:179], v[100:103]
  v_accvgpr_write_b32 a218, v82
  v_accvgpr_write_b32 a219, v83
  v_mfma_f32_16x16x32_bf16 v[108:111], v[44:47], v[208:211], v[108:111]
  v_mfma_f32_16x16x32_bf16 v[116:119], v[44:47], v[240:243], v[116:119]
  s_waitcnt lgkmcnt(1)
  v_mfma_f32_16x16x32_bf16 v[88:91], v[48:51], v[148:151], v[88:91]
  v_mfma_f32_16x16x32_bf16 v[96:99], v[48:51], v[180:183], v[96:99]
  v_mfma_f32_16x16x32_bf16 v[104:107], v[48:51], v[212:215], v[104:107]
  v_mfma_f32_16x16x32_bf16 v[112:115], v[48:51], v[244:247], v[112:115]
  s_waitcnt lgkmcnt(0)
  v_mfma_f32_16x16x32_bf16 v[92:95], v[52:55], v[148:151], v[92:95]
  v_mfma_f32_16x16x32_bf16 v[100:103], v[52:55], v[180:183], v[100:103]
  v_mfma_f32_16x16x32_bf16 v[108:111], v[52:55], v[212:215], v[108:111]
  v_mfma_f32_16x16x32_bf16 v[116:119], v[52:55], v[244:247], v[116:119]
  v_mul_f32 v88, v12, v88
  v_mul_f32 v89, v12, v89
  v_mul_f32 v90, v12, v90
  v_mul_f32 v91, v12, v91
  v_mul_f32 v92, v12, v92
  v_mul_f32 v93, v12, v93
  v_mul_f32 v94, v12, v94
  v_mul_f32 v95, v12, v95
  v_cvt_pk_bf16_f32 v88, v88, v89
  v_cvt_pk_bf16_f32 v89, v90, v91
  v_cvt_pk_bf16_f32 v90, v92, v93
  v_cvt_pk_bf16_f32 v91, v94, v95
  v_accvgpr_write_b32 a52, v88
  v_accvgpr_write_b32 a53, v89
  v_accvgpr_write_b32 a54, v90
  v_accvgpr_write_b32 a55, v91
  v_mul_f32 v96, v12, v96
  v_mul_f32 v97, v12, v97
  v_mul_f32 v98, v12, v98
  v_mul_f32 v99, v12, v99
  v_mul_f32 v100, v12, v100
  v_mul_f32 v101, v12, v101
  v_mul_f32 v102, v12, v102
  v_mul_f32 v103, v12, v103
  v_cvt_pk_bf16_f32 v96, v96, v97
  v_cvt_pk_bf16_f32 v97, v98, v99
  v_cvt_pk_bf16_f32 v98, v100, v101
  v_cvt_pk_bf16_f32 v99, v102, v103
  v_accvgpr_write_b32 a108, v96
  v_accvgpr_write_b32 a109, v97
  v_accvgpr_write_b32 a110, v98
  v_accvgpr_write_b32 a111, v99
  v_mul_f32 v104, v12, v104
  v_mul_f32 v105, v12, v105
  v_mul_f32 v106, v12, v106
  v_mul_f32 v107, v12, v107
  v_mul_f32 v108, v12, v108
  v_mul_f32 v109, v12, v109
  v_mul_f32 v110, v12, v110
  v_mul_f32 v111, v12, v111
  v_cvt_pk_bf16_f32 v104, v104, v105
  v_cvt_pk_bf16_f32 v105, v106, v107
  v_cvt_pk_bf16_f32 v106, v108, v109
  v_cvt_pk_bf16_f32 v107, v110, v111
  v_accvgpr_write_b32 a164, v104
  v_accvgpr_write_b32 a165, v105
  v_accvgpr_write_b32 a166, v106
  v_accvgpr_write_b32 a167, v107
  v_mul_f32 v112, v12, v112
  v_mul_f32 v113, v12, v113
  v_mul_f32 v114, v12, v114
  v_mul_f32 v115, v12, v115
  v_mul_f32 v116, v12, v116
  v_mul_f32 v117, v12, v117
  v_mul_f32 v118, v12, v118
  v_mul_f32 v119, v12, v119
  v_cvt_pk_bf16_f32 v112, v112, v113
  v_cvt_pk_bf16_f32 v113, v114, v115
  v_cvt_pk_bf16_f32 v114, v116, v117
  v_cvt_pk_bf16_f32 v115, v118, v119
  v_accvgpr_write_b32 a220, v112
  v_accvgpr_write_b32 a221, v113
  v_accvgpr_write_b32 a222, v114
  v_accvgpr_write_b32 a223, v115
  s_waitcnt vmcnt(0)
  s_barrier
  v_readfirstlane_b32 s84, v13
  v_readfirstlane_b32 s85, v10
  v_readfirstlane_b32 s22, v11
  s_and_b32 s86, s86, s22
  s_cmp_eq_u32 s86, 1
  s_cselect_b32 s84, s84, 0
  v_and_b32 v10, 0xffe0, v9
  v_cmp_eq_u32 vcc, 0, v10
  s_cbranch_vccz ch_md_ok
ch_role2:
  s_mov_b32 s30, 0
ch_md:
  buffer_load_dword v9, off, s[12:15], 0 sc1
  s_waitcnt vmcnt(0)
  v_and_b32 v10, 0xffe0, v9
  v_cmp_eq_u32 vcc, 0, v10
  s_cbranch_vccz ch_md_ok
  s_sleep 4
  s_add_u32 s30, s30, 1
  s_cmp_lt_u32 s30, 1600000
  s_cbranch_scc1 ch_md
  s_branch ch_end
ch_md_ok:
  v_readfirstlane_b32 s88, v9
  s_lshr_b32 s88, s88, 16
  v_and_b32 v1, 63, v0
  v_lshlrev_b32 v2, 4, v1
  v_lshrrev_b32 v116, 4, v1
  v_and_b32 v117, 15, v1
  v_mov_b32 v3, 0x4444
  v_mov_b32 v118, 0xeeee
  v_cmp_lt_u32 vcc, 7, v117
  s_nop 1
  v_cndmask_b32 v3, v3, v118, vcc
  s_mov_b32 s19, 0
  s_mov_b32 s18, 1
  s_mov_b32 s20, 0
  s_mov_b32 s21, 17664
  s_mov_b32 s23, 4096
  s_lshr_b32 s89, s17, 4
  s_lshl_b32 s89, s89, 2
  s_add_u32 s89, s89, s16
  s_and_b32 s17, s17, 15
  s_cmp_eq_u32 s89, 0
  s_cbranch_scc1 ch_init0
  s_cmp_eq_u32 s89, 1
  s_cbranch_scc1 ch_init1
  s_cmp_eq_u32 s89, 2
  s_cbranch_scc1 ch_init2
  s_cmp_eq_u32 s89, 3
  s_cbranch_scc1 ch_init3
  s_cmp_eq_u32 s89, 4
  s_cbranch_scc1 ch_init4
  s_cmp_eq_u32 s89, 5
  s_cbranch_scc1 ch_init5
  s_cmp_eq_u32 s89, 6
  s_cbranch_scc1 ch_init6
  s_cmp_eq_u32 s89, 7
  s_cbranch_scc1 ch_init7
  s_branch ch_end
ch_init0:
  s_mul_i32 s31, s17, 401408
  s_add_u32 s31, s31, 33554432
  s_and_b32 s28, s84, 10320
  s_lshl_b32 s22, s85, 16
  s_or_b32 s28, s28, s22
  s_cmp_eq_u32 s28, 4294912080
  s_cbranch_scc1 ch_wx0_ok
  s_mov_b32 s30, 0
ch_wr0:
  buffer_load_dword v9, off, s[12:15], 0 offset:132 sc1
  s_waitcnt vmcnt(0)
  v_cmp_ne_u32 vcc, 1, v9
  s_cbranch_vccz ch_wr0_ok
  s_sleep 8
  s_add_u32 s30, s30, 1
  s_cmp_lt_u32 s30, 400000
  s_cbranch_scc1 ch_wr0
  s_branch cA_abort
ch_wr0_ok:
  s_lshl_b32 s27, s17, 7
  s_add_u32 s27, s27, 584192
  s_mov_b32 s28, 10320
  s_mov_b32 s30, 0
ch_wb0:
  buffer_load_dword v9, off, s[8:11], s27  sc1
  s_waitcnt vmcnt(0)
  v_and_b32 v10, s28, v9
  v_cmp_ne_u32 vcc, s28, v10
  s_cbranch_vccz ch_wb0_ok
  s_sleep 3
  s_add_u32 s30, s30, 1
  s_cmp_lt_u32 s30, 400000
  s_cbranch_scc1 ch_wb0
  s_branch cA_abort
ch_wb0_ok:
  s_mov_b32 s29, 586240
  s_mov_b32 s28, 0xffff
  s_mov_b32 s30, 0
ch_wx0:
  buffer_load_dword v9, off, s[8:11], s29  sc1
  s_waitcnt vmcnt(0)
  v_and_b32 v10, s28, v9
  v_cmp_ne_u32 vcc, s28, v10
  s_cbranch_vccz ch_wx0_ok
  s_sleep 8
  s_add_u32 s30, s30, 1
  s_cmp_lt_u32 s30, 400000
  s_cbranch_scc1 ch_wx0
  s_branch cA_abort
ch_wx0_ok:
  s_add_u32 s22, s31, 229376
  buffer_load_dwordx4 a[224:227], v2, s[8:11], s22 offen offset:0 sc1
  buffer_load_dwordx4 a[228:231], v2, s[8:11], s22 offen offset:1024 sc1
  buffer_load_dwordx4 a[232:235], v2, s[8:11], s22 offen offset:2048 sc1
  buffer_load_dwordx4 a[236:239], v2, s[8:11], s22 offen offset:3072 sc1
  s_add_u32 s22, s31, 233472
  buffer_load_dwordx4 a[240:243], v2, s[8:11], s22 offen offset:0 sc1
  buffer_load_dwordx4 a[244:247], v2, s[8:11], s22 offen offset:1024 sc1
  buffer_load_dwordx4 a[248:251], v2, s[8:11], s22 offen offset:2048 sc1
  buffer_load_dwordx4 a[252:255], v2, s[8:11], s22 offen offset:3072 sc1
  s_add_u32 s22, s31, 237568
  buffer_load_dwordx4 v[120:123], v2, s[8:11], s22 offen offset:0 sc1
  buffer_load_dwordx4 v[124:127], v2, s[8:11], s22 offen offset:1024 sc1
  buffer_load_dwordx4 v[128:131], v2, s[8:11], s22 offen offset:2048 sc1
  buffer_load_dwordx4 v[132:135], v2, s[8:11], s22 offen offset:3072 sc1
  s_add_u32 s22, s31, 241664
  buffer_load_dwordx4 v[136:139], v2, s[8:11], s22 offen offset:0 sc1
  buffer_load_dwordx4 v[140:143], v2, s[8:11], s22 offen offset:1024 sc1
  buffer_load_dwordx4 v[144:147], v2, s[8:11], s22 offen offset:2048 sc1
  buffer_load_dwordx4 v[148:151], v2, s[8:11], s22 offen offset:3072 sc1
  s_add_u32 s22, s31, 245760
  buffer_load_dwordx4 v[152:155], v2, s[8:11], s22 offen offset:0 sc1
  buffer_load_dwordx4 v[156:159], v2, s[8:11], s22 offen offset:1024 sc1
  buffer_load_dwordx4 v[160:163], v2, s[8:11], s22 offen offset:2048 sc1
  buffer_load_dwordx4 v[164:167], v2, s[8:11], s22 offen offset:3072 sc1
  s_add_u32 s22, s31, 249856
  buffer_load_dwordx4 v[168:171], v2, s[8:11], s22 offen offset:0 sc1
  buffer_load_dwordx4 v[172:175], v2, s[8:11], s22 offen offset:1024 sc1
  buffer_load_dwordx4 v[176:179], v2, s[8:11], s22 offen offset:2048 sc1
  buffer_load_dwordx4 v[180:183], v2, s[8:11], s22 offen offset:3072 sc1
  s_mov_b32 s24, 655360
  s_mov_b32 s26, 669696
  v_and_b32 v64, 7, v117
  v_and_b32 v65, 1, v116
  v_lshlrev_b32 v65, 2, v65
  v_sub_u32 v64, v64, v65
  v_lshrrev_b32 v65, 3, v117
  v_lshl_add_u32 v66, v65, 2, v64
  v_cmp_gt_u32 vcc, 4, v64
  v_mov_b32 v67, 99
  s_nop 0
  v_cndmask_b32 v66, v67, v66, vcc
  v_mov_b32 v68, 0x3f80
  v_mov_b32 v69, 0x3f800000
  v_mov_b32 v4, 0
  v_cmp_eq_u32 vcc, 0, v66
  s_nop 1
  v_cndmask_b32 v4, v4, v68, vcc
  v_cmp_eq_u32 vcc, 1, v66
  s_nop 1
  v_cndmask_b32 v4, v4, v69, vcc
  v_mov_b32 v5, 0
  v_cmp_eq_u32 vcc, 2, v66
  s_nop 1
  v_cndmask_b32 v5, v5, v68, vcc
  v_cmp_eq_u32 vcc, 3, v66
  s_nop 1
  v_cndmask_b32 v5, v5, v69, vcc
  v_mov_b32 v6, 0
  v_cmp_eq_u32 vcc, 4, v66
  s_nop 1
  v_cndmask_b32 v6, v6, v68, vcc
  v_cmp_eq_u32 vcc, 5, v66
  s_nop 1
  v_cndmask_b32 v6, v6, v69, vcc
  v_mov_b32 v7, 0
  v_cmp_eq_u32 vcc, 6, v66
  s_nop 1
  v_cndmask_b32 v7, v7, v68, vcc
  v_cmp_eq_u32 vcc, 7, v66
  s_nop 1
  v_cndmask_b32 v7, v7, v69, vcc
  v_lshrrev_b32 v64, 1, v116
  v_lshrrev_b32 v65, 3, v117
  v_and_b32 v66, 1, v116
  v_and_b32 v68, 7, v117
  v_lshlrev_b32 v67, 8, v65
  v_lshl_add_u32 v67, v68, 5, v67
  v_lshl_add_u32 v67, v66, 4, v67
  v_add_u32 v69, 4096, v67
  v_add_u32 v70, 6400, v67
  v_cmp_eq_u32 vcc, v64, v65
  s_nop 1
  v_cndmask_b32 v113, v70, v69, vcc
  v_and_b32 v74, 3, v117
  v_lshlrev_b32 v74, 1, v74
  v_bfe_u32 v75, v117, 2, 1
  v_or_b32 v74, v74, v75
  v_and_b32 v75, 8, v117
  v_or_b32 v74, v74, v75
  v_lshlrev_b32 v67, 9, v64
  v_lshl_add_u32 v67, v74, 4, v67
  v_lshl_add_u32 v67, v66, 3, v67
  v_add_u32 v114, 0, v67
  v_mul_u32_u24 v67, 1088, v65
  v_lshl_add_u32 v67, v116, 5, v67
  v_and_b32 v75, 1, v117
  v_and_b32 v76, 2, v117
  v_lshl_add_u32 v75, v76, 1, v75
  v_bfe_u32 v76, v117, 2, 1
  v_lshl_add_u32 v75, v76, 1, v75
  v_lshl_add_u32 v67, v75, 2, v67
  v_add_u32 v115, 4096, v67
  v_and_b32 v69, 1, v74
  v_lshlrev_b32 v67, 7, v69
  v_lshl_add_u32 v67, v116, 4, v67
  v_lshl_add_u32 v67, v65, 8, v67
  v_bfe_u32 v69, v74, 1, 2
  v_lshl_add_u32 v67, v69, 2, v67
  s_lshl_b32 s22, s17, 9
  s_add_u32 s22, s22, 9216
  v_add_u32 v72, s22, v67
  v_bfe_u32 v69, v75, 1, 1
  v_lshlrev_b32 v67, 7, v69
  v_lshl_add_u32 v67, v116, 4, v67
  v_and_b32 v69, 4, v75
  v_add_u32 v67, v67, v69
  s_lshr_b32 s22, s17, 1
  s_lshl_b32 s22, s22, 8
  s_and_b32 s27, s17, 1
  s_lshl_b32 s27, s27, 3
  s_add_u32 s22, s22, s27
  s_add_u32 s22, s22, 7168
  v_add_u32 v67, s22, v67
  v_and_b32 v69, 9, v117
  v_mov_b32 v70, 0x40000000
  v_cmp_eq_u32 vcc, 0, v69
  s_nop 1
  v_cndmask_b32 v118, v70, v67, vcc
  v_mov_b32 v119, -1
  v_and_b32 v0, 15, v1
  s_and_b32 s22, s17, 0
  s_lshl_b32 s22, s22, 7
  s_add_u32 s22, s22, 37376
  v_lshl_add_u32 v0, v0, 2, s22
  v_xor_b32 v69, 256, v2
  v_mul_i32_i24 v70, -4096, v66
  v_add_u32 v69, v69, v70
  v_add_u32 v117, 12288, v69
  v_mov_b32 v116, v73
  v_mov_b32 v112, 0
  s_mul_i32 s35, s17, 28672
  s_add_u32 s35, s35, 4325376
  v_mov_b32 v1, v72
  v_mov_b32 v36, 0
  v_mov_b32 v37, 0
  v_mov_b32 v38, 0
  v_mov_b32 v39, 0
  v_mov_b32 v40, 0
  v_mov_b32 v41, 0
  v_mov_b32 v42, 0
  v_mov_b32 v43, 0
  v_mov_b32 v44, 0
  v_mov_b32 v45, 0
  v_mov_b32 v46, 0
  v_mov_b32 v47, 0
  v_mov_b32 v48, 0
  v_mov_b32 v49, 0
  v_mov_b32 v50, 0
  v_mov_b32 v51, 0
  v_mov_b32 v52, 0
  v_mov_b32 v53, 0
  v_mov_b32 v54, 0
  v_mov_b32 v55, 0
  v_mov_b32 v56, 0
  v_mov_b32 v57, 0
  v_mov_b32 v58, 0
  v_mov_b32 v59, 0
  v_mov_b32 v60, 0
  v_mov_b32 v61, 0
  v_mov_b32 v62, 0
  v_mov_b32 v63, 0
  v_mov_b32 v64, 0
  v_mov_b32 v65, 0
  v_mov_b32 v66, 0
  v_mov_b32 v67, 0
  v_mov_b32 v68, 0
  v_mov_b32 v69, 0
  v_mov_b32 v70, 0
  v_mov_b32 v71, 0
  v_mov_b32 v72, 0
  v_mov_b32 v73, 0
  v_mov_b32 v74, 0
  v_mov_b32 v75, 0
  v_mov_b32 v76, 0
  v_mov_b32 v77, 0
  v_mov_b32 v78, 0
  v_mov_b32 v79, 0
  s_mov_b32 s22, 0
  v_lshrrev_b32 v14, 4, v2
  v_add_u32 v14, 0, v14
  v_min_u32 v14, 308, v14
  v_lshlrev_b32 v14, 7, v14
  buffer_load_dword v15, v14, s[8:11], s22 offen sc1
  v_lshrrev_b32 v14, 4, v2
  v_add_u32 v14, 256, v14
  v_min_u32 v14, 308, v14
  v_lshlrev_b32 v14, 7, v14
  buffer_load_dword v15, v14, s[8:11], s22 offen sc1
  buffer_load_dwordx4 v[80:83], v117, s[8:11], s24 offen offset:0 sc1
  buffer_load_dwordx4 v[84:87], v117, s[8:11], s24 offen offset:1024 sc1
  buffer_load_dwordx4 v[88:91], v117, s[8:11], s26 offen offset:0 sc1
  buffer_load_dwordx4 v[92:95], v117, s[8:11], s26 offen offset:1024 sc1
  buffer_load_dwordx4 v[96:99], v2, s[8:11], s24 offen offset:0 sc1
  buffer_load_dwordx4 v[100:103], v2, s[8:11], s24 offen offset:1024 sc1
  buffer_load_dwordx4 v[104:107], v2, s[8:11], s26 offen offset:0 sc1
  buffer_load_dwordx4 v[108:111], v2, s[8:11], s26 offen offset:1024 sc1
  s_add_u32 s22, s31, 253952
  buffer_load_dwordx4 v[184:187], v2, s[8:11], s22 offen offset:0 sc1
  buffer_load_dwordx4 v[188:191], v2, s[8:11], s22 offen offset:1024 sc1
  buffer_load_dwordx4 v[192:195], v2, s[8:11], s22 offen offset:2048 sc1
  buffer_load_dwordx4 v[196:199], v2, s[8:11], s22 offen offset:3072 sc1
  s_add_u32 s22, s31, 372736
  buffer_load_dwordx4 v[200:203], v2, s[8:11], s22 offen offset:0 sc1
  buffer_load_dwordx4 v[204:207], v2, s[8:11], s22 offen offset:1024 sc1
  buffer_load_dwordx4 v[208:211], v2, s[8:11], s22 offen offset:2048 sc1
  buffer_load_dwordx4 v[212:215], v2, s[8:11], s22 offen offset:3072 sc1
  s_add_u32 s22, s31, 376832
  buffer_load_dwordx4 v[216:219], v2, s[8:11], s22 offen offset:0 sc1
  buffer_load_dwordx4 v[220:223], v2, s[8:11], s22 offen offset:1024 sc1
  buffer_load_dwordx4 v[224:227], v2, s[8:11], s22 offen offset:2048 sc1
  buffer_load_dwordx4 v[228:231], v2, s[8:11], s22 offen offset:3072 sc1
  s_add_u32 s22, s31, 380928
  buffer_load_dwordx4 v[232:235], v2, s[8:11], s22 offen offset:0 sc1
  buffer_load_dwordx4 v[236:239], v2, s[8:11], s22 offen offset:1024 sc1
  buffer_load_dwordx4 v[240:243], v2, s[8:11], s22 offen offset:2048 sc1
  buffer_load_dwordx4 v[244:247], v2, s[8:11], s22 offen offset:3072 sc1
  s_add_u32 s22, s31, 385024
  buffer_load_dwordx4 v[248:251], v2, s[8:11], s22 offen offset:0 sc1
  buffer_load_dwordx4 v[252:255], v2, s[8:11], s22 offen offset:1024 sc1
  s_waitcnt vmcnt(0) lgkmcnt(0)
  s_mov_b32 s31, 0
  s_cmp_lg_u32 s88, 0
  s_cbranch_scc1 cB_sc0_loop
  s_branch cA_sc0_loop
ch_init1:
  s_mul_i32 s31, s17, 401408
  s_add_u32 s31, s31, 33554432
  s_and_b32 s28, s84, 10320
  s_lshl_b32 s22, s85, 16
  s_or_b32 s28, s28, s22
  s_cmp_eq_u32 s28, 4294912080
  s_cbranch_scc1 ch_wx1_ok
  s_mov_b32 s30, 0
ch_wr1:
  buffer_load_dword v9, off, s[12:15], 0 offset:132 sc1
  s_waitcnt vmcnt(0)
  v_cmp_ne_u32 vcc, 1, v9
  s_cbranch_vccz ch_wr1_ok
  s_sleep 8
  s_add_u32 s30, s30, 1
  s_cmp_lt_u32 s30, 400000
  s_cbranch_scc1 ch_wr1
  s_branch cA_abort
ch_wr1_ok:
  s_lshl_b32 s27, s17, 7
  s_add_u32 s27, s27, 584192
  s_mov_b32 s28, 10320
  s_mov_b32 s30, 0
ch_wb1:
  buffer_load_dword v9, off, s[8:11], s27  sc1
  s_waitcnt vmcnt(0)
  v_and_b32 v10, s28, v9
  v_cmp_ne_u32 vcc, s28, v10
  s_cbranch_vccz ch_wb1_ok
  s_sleep 3
  s_add_u32 s30, s30, 1
  s_cmp_lt_u32 s30, 400000
  s_cbranch_scc1 ch_wb1
  s_branch cA_abort
ch_wb1_ok:
  s_mov_b32 s29, 586240
  s_mov_b32 s28, 0xffff
  s_mov_b32 s30, 0
ch_wx1:
  buffer_load_dword v9, off, s[8:11], s29  sc1
  s_waitcnt vmcnt(0)
  v_and_b32 v10, s28, v9
  v_cmp_ne_u32 vcc, s28, v10
  s_cbranch_vccz ch_wx1_ok
  s_sleep 8
  s_add_u32 s30, s30, 1
  s_cmp_lt_u32 s30, 400000
  s_cbranch_scc1 ch_wx1
  s_branch cA_abort
ch_wx1_ok:
  s_add_u32 s22, s31, 258048
  buffer_load_dwordx4 a[224:227], v2, s[8:11], s22 offen offset:0 sc1
  buffer_load_dwordx4 a[228:231], v2, s[8:11], s22 offen offset:1024 sc1
  buffer_load_dwordx4 a[232:235], v2, s[8:11], s22 offen offset:2048 sc1
  buffer_load_dwordx4 a[236:239], v2, s[8:11], s22 offen offset:3072 sc1
  s_add_u32 s22, s31, 262144
  buffer_load_dwordx4 a[240:243], v2, s[8:11], s22 offen offset:0 sc1
  buffer_load_dwordx4 a[244:247], v2, s[8:11], s22 offen offset:1024 sc1
  buffer_load_dwordx4 a[248:251], v2, s[8:11], s22 offen offset:2048 sc1
  buffer_load_dwordx4 a[252:255], v2, s[8:11], s22 offen offset:3072 sc1
  s_add_u32 s22, s31, 266240
  buffer_load_dwordx4 v[120:123], v2, s[8:11], s22 offen offset:0 sc1
  buffer_load_dwordx4 v[124:127], v2, s[8:11], s22 offen offset:1024 sc1
  buffer_load_dwordx4 v[128:131], v2, s[8:11], s22 offen offset:2048 sc1
  buffer_load_dwordx4 v[132:135], v2, s[8:11], s22 offen offset:3072 sc1
  s_add_u32 s22, s31, 270336
  buffer_load_dwordx4 v[136:139], v2, s[8:11], s22 offen offset:0 sc1
  buffer_load_dwordx4 v[140:143], v2, s[8:11], s22 offen offset:1024 sc1
  buffer_load_dwordx4 v[144:147], v2, s[8:11], s22 offen offset:2048 sc1
  buffer_load_dwordx4 v[148:151], v2, s[8:11], s22 offen offset:3072 sc1
  s_add_u32 s22, s31, 274432
  buffer_load_dwordx4 v[152:155], v2, s[8:11], s22 offen offset:0 sc1
  buffer_load_dwordx4 v[156:159], v2, s[8:11], s22 offen offset:1024 sc1
  buffer_load_dwordx4 v[160:163], v2, s[8:11], s22 offen offset:2048 sc1
  buffer_load_dwordx4 v[164:167], v2, s[8:11], s22 offen offset:3072 sc1
  s_add_u32 s22, s31, 278528
  buffer_load_dwordx4 v[168:171], v2, s[8:11], s22 offen offset:0 sc1
  buffer_load_dwordx4 v[172:175], v2, s[8:11], s22 offen offset:1024 sc1
  buffer_load_dwordx4 v[176:179], v2, s[8:11], s22 offen offset:2048 sc1
  buffer_load_dwordx4 v[180:183], v2, s[8:11], s22 offen offset:3072 sc1
  s_mov_b32 s24, 657408
  s_mov_b32 s26, 671744
  v_and_b32 v64, 7, v117
  v_and_b32 v65, 1, v116
  v_lshlrev_b32 v65, 2, v65
  v_sub_u32 v64, v64, v65
  v_lshrrev_b32 v65, 3, v117
  v_lshl_add_u32 v66, v65, 2, v64
  v_cmp_gt_u32 vcc, 4, v64
  v_mov_b32 v67, 99
  s_nop 0
  v_cndmask_b32 v66, v67, v66, vcc
  v_mov_b32 v68, 0x3f80
  v_mov_b32 v69, 0x3f800000
  v_mov_b32 v4, 0
  v_cmp_eq_u32 vcc, 0, v66
  s_nop 1
  v_cndmask_b32 v4, v4, v68, vcc
  v_cmp_eq_u32 vcc, 1, v66
  s_nop 1
  v_cndmask_b32 v4, v4, v69, vcc
  v_mov_b32 v5, 0
  v_cmp_eq_u32 vcc, 2, v66
  s_nop 1
  v_cndmask_b32 v5, v5, v68, vcc
  v_cmp_eq_u32 vcc, 3, v66
  s_nop 1
  v_cndmask_b32 v5, v5, v69, vcc
  v_mov_b32 v6, 0
  v_cmp_eq_u32 vcc, 4, v66
  s_nop 1
  v_cndmask_b32 v6, v6, v68, vcc
  v_cmp_eq_u32 vcc, 5, v66
  s_nop 1
  v_cndmask_b32 v6, v6, v69, vcc
  v_mov_b32 v7, 0
  v_cmp_eq_u32 vcc, 6, v66
  s_nop 1
  v_cndmask_b32 v7, v7, v68, vcc
  v_cmp_eq_u32 vcc, 7, v66
  s_nop 1
  v_cndmask_b32 v7, v7, v69, vcc
  v_lshrrev_b32 v64, 1, v116
  v_lshrrev_b32 v65, 3, v117
  v_and_b32 v66, 1, v116
  v_and_b32 v68, 7, v117
  v_lshlrev_b32 v67, 8, v65
  v_lshl_add_u32 v67, v68, 5, v67
  v_lshl_add_u32 v67, v66, 4, v67
  v_add_u32 v69, 4608, v67
  v_add_u32 v70, 6400, v67
  v_cmp_eq_u32 vcc, v64, v65
  s_nop 1
  v_cndmask_b32 v113, v70, v69, vcc
  v_and_b32 v74, 3, v117
  v_lshlrev_b32 v74, 1, v74
  v_bfe_u32 v75, v117, 2, 1
  v_or_b32 v74, v74, v75
  v_and_b32 v75, 8, v117
  v_or_b32 v74, v74, v75
  v_lshlrev_b32 v67, 9, v64
  v_lshl_add_u32 v67, v74, 4, v67
  v_lshl_add_u32 v67, v66, 3, v67
  v_add_u32 v114, 256, v67
  v_mul_u32_u24 v67, 1088, v65
  v_lshl_add_u32 v67, v116, 5, v67
  v_and_b32 v75, 1, v117
  v_and_b32 v76, 2, v117
  v_lshl_add_u32 v75, v76, 1, v75
  v_bfe_u32 v76, v117, 2, 1
  v_lshl_add_u32 v75, v76, 1, v75
  v_lshl_add_u32 v67, v75, 2, v67
  v_add_u32 v115, 4224, v67
  v_and_b32 v69, 1, v74
  v_lshlrev_b32 v67, 7, v69
  v_lshl_add_u32 v67, v116, 4, v67
  v_lshl_add_u32 v67, v65, 8, v67
  v_bfe_u32 v69, v74, 1, 2
  v_lshl_add_u32 v67, v69, 2, v67
  s_lshl_b32 s22, s17, 9
  s_add_u32 s22, s22, 9280
  v_add_u32 v72, s22, v67
  v_bfe_u32 v69, v75, 1, 1
  v_lshlrev_b32 v67, 7, v69
  v_lshl_add_u32 v67, v116, 4, v67
  v_and_b32 v69, 4, v75
  v_add_u32 v67, v67, v69
  s_lshr_b32 s22, s17, 1
  s_lshl_b32 s22, s22, 8
  s_and_b32 s27, s17, 1
  s_lshl_b32 s27, s27, 3
  s_add_u32 s22, s22, s27
  s_add_u32 s22, s22, 7232
  v_add_u32 v67, s22, v67
  v_and_b32 v69, 9, v117
  v_mov_b32 v70, 0x40000000
  v_cmp_eq_u32 vcc, 0, v69
  s_nop 1
  v_cndmask_b32 v118, v70, v67, vcc
  v_mov_b32 v119, -1
  s_lshl_b32 s22, s17, 2
  s_add_u32 s22, s22, 35328
  v_lshl_add_u32 v67, v1, 7, s22
  v_mov_b32 v70, 0x40000000
  v_cmp_gt_u32 vcc, 1, v1
  s_nop 1
  v_cndmask_b32 v73, v70, v67, vcc
  v_mov_b32 v112, 1
  v_and_b32 v0, 15, v1
  s_and_b32 s22, s17, 0
  s_lshl_b32 s22, s22, 7
  s_add_u32 s22, s22, 37376
  v_lshl_add_u32 v0, v0, 2, s22
  v_xor_b32 v69, 256, v2
  v_mul_i32_i24 v70, 4096, v66
  v_add_u32 v69, v69, v70
  v_add_u32 v117, 6144, v69
  v_mov_b32 v116, v73
  s_mul_i32 s35, s17, 28672
  s_add_u32 s35, s35, 4325376
  v_mov_b32 v1, v72
  v_mov_b32 v36, 0
  v_mov_b32 v37, 0
  v_mov_b32 v38, 0
  v_mov_b32 v39, 0
  v_mov_b32 v40, 0
  v_mov_b32 v41, 0
  v_mov_b32 v42, 0
  v_mov_b32 v43, 0
  v_mov_b32 v44, 0
  v_mov_b32 v45, 0
  v_mov_b32 v46, 0
  v_mov_b32 v47, 0
  v_mov_b32 v48, 0
  v_mov_b32 v49, 0
  v_mov_b32 v50, 0
  v_mov_b32 v51, 0
  v_mov_b32 v52, 0
  v_mov_b32 v53, 0
  v_mov_b32 v54, 0
  v_mov_b32 v55, 0
  v_mov_b32 v56, 0
  v_mov_b32 v57, 0
  v_mov_b32 v58, 0
  v_mov_b32 v59, 0
  v_mov_b32 v60, 0
  v_mov_b32 v61, 0
  v_mov_b32 v62, 0
  v_mov_b32 v63, 0
  v_mov_b32 v64, 0
  v_mov_b32 v65, 0
  v_mov_b32 v66, 0
  v_mov_b32 v67, 0
  v_mov_b32 v68, 0
  v_mov_b32 v69, 0
  v_mov_b32 v70, 0
  v_mov_b32 v71, 0
  v_mov_b32 v72, 0
  v_mov_b32 v73, 0
  v_mov_b32 v74, 0
  v_mov_b32 v75, 0
  v_mov_b32 v76, 0
  v_mov_b32 v77, 0
  v_mov_b32 v78, 0
  v_mov_b32 v79, 0
  s_mov_b32 s22, 0
  v_lshrrev_b32 v14, 4, v2
  v_add_u32 v14, 64, v14
  v_min_u32 v14, 308, v14
  v_lshlrev_b32 v14, 7, v14
  buffer_load_dword v15, v14, s[8:11], s22 offen sc1
  buffer_load_dwordx4 v[80:83], v117, s[8:11], s24 offen offset:0 sc1
  buffer_load_dwordx4 v[84:87], v117, s[8:11], s24 offen offset:1024 sc1
  buffer_load_dwordx4 v[88:91], v117, s[8:11], s26 offen offset:0 sc1
  buffer_load_dwordx4 v[92:95], v117, s[8:11], s26 offen offset:1024 sc1
  buffer_load_dwordx4 v[96:99], v2, s[8:11], s24 offen offset:0 sc1
  buffer_load_dwordx4 v[100:103], v2, s[8:11], s24 offen offset:1024 sc1
  buffer_load_dwordx4 v[104:107], v2, s[8:11], s26 offen offset:0 sc1
  buffer_load_dwordx4 v[108:111], v2, s[8:11], s26 offen offset:1024 sc1
  s_add_u32 s22, s31, 282624
  buffer_load_dwordx4 v[184:187], v2, s[8:11], s22 offen offset:0 sc1
  buffer_load_dwordx4 v[188:191], v2, s[8:11], s22 offen offset:1024 sc1
  buffer_load_dwordx4 v[192:195], v2, s[8:11], s22 offen offset:2048 sc1
  buffer_load_dwordx4 v[196:199], v2, s[8:11], s22 offen offset:3072 sc1
  s_add_u32 s22, s31, 344064
  buffer_load_dwordx4 v[200:203], v2, s[8:11], s22 offen offset:0 sc1
  buffer_load_dwordx4 v[204:207], v2, s[8:11], s22 offen offset:1024 sc1
  buffer_load_dwordx4 v[208:211], v2, s[8:11], s22 offen offset:2048 sc1
  buffer_load_dwordx4 v[212:215], v2, s[8:11], s22 offen offset:3072 sc1
  s_add_u32 s22, s31, 348160
  buffer_load_dwordx4 v[216:219], v2, s[8:11], s22 offen offset:0 sc1
  buffer_load_dwordx4 v[220:223], v2, s[8:11], s22 offen offset:1024 sc1
  buffer_load_dwordx4 v[224:227], v2, s[8:11], s22 offen offset:2048 sc1
  buffer_load_dwordx4 v[228:231], v2, s[8:11], s22 offen offset:3072 sc1
  s_add_u32 s22, s31, 352256
  buffer_load_dwordx4 v[232:235], v2, s[8:11], s22 offen offset:0 sc1
  buffer_load_dwordx4 v[236:239], v2, s[8:11], s22 offen offset:1024 sc1
  buffer_load_dwordx4 v[240:243], v2, s[8:11], s22 offen offset:2048 sc1
  buffer_load_dwordx4 v[244:247], v2, s[8:11], s22 offen offset:3072 sc1
  s_add_u32 s22, s31, 356352
  buffer_load_dwordx4 v[248:251], v2, s[8:11], s22 offen offset:0 sc1
  buffer_load_dwordx4 v[252:255], v2, s[8:11], s22 offen offset:1024 sc1
  s_waitcnt vmcnt(0) lgkmcnt(0)
  s_mov_b32 s31, 0
  s_cmp_lg_u32 s88, 0
  s_cbranch_scc1 cB_sc1_loop
  s_branch cA_sc1_loop
ch_init2:
  s_mul_i32 s31, s17, 401408
  s_add_u32 s31, s31, 33554432
  s_and_b32 s28, s84, 12384
  s_lshl_b32 s22, s85, 16
  s_or_b32 s28, s28, s22
  s_cmp_eq_u32 s28, 4294914144
  s_cbranch_scc1 ch_wx2_ok
  s_mov_b32 s30, 0
ch_wr2:
  buffer_load_dword v9, off, s[12:15], 0 offset:132 sc1
  s_waitcnt vmcnt(0)
  v_cmp_ne_u32 vcc, 1, v9
  s_cbranch_vccz ch_wr2_ok
  s_sleep 8
  s_add_u32 s30, s30, 1
  s_cmp_lt_u32 s30, 400000
  s_cbranch_scc1 ch_wr2
  s_branch cA_abort
ch_wr2_ok:
  s_lshl_b32 s27, s17, 7
  s_add_u32 s27, s27, 584192
  s_mov_b32 s28, 12384
  s_mov_b32 s30, 0
ch_wb2:
  buffer_load_dword v9, off, s[8:11], s27  sc1
  s_waitcnt vmcnt(0)
  v_and_b32 v10, s28, v9
  v_cmp_ne_u32 vcc, s28, v10
  s_cbranch_vccz ch_wb2_ok
  s_sleep 3
  s_add_u32 s30, s30, 1
  s_cmp_lt_u32 s30, 400000
  s_cbranch_scc1 ch_wb2
  s_branch cA_abort
ch_wb2_ok:
  s_mov_b32 s29, 586240
  s_mov_b32 s28, 0xffff
  s_mov_b32 s30, 0
ch_wx2:
  buffer_load_dword v9, off, s[8:11], s29  sc1
  s_waitcnt vmcnt(0)
  v_and_b32 v10, s28, v9
  v_cmp_ne_u32 vcc, s28, v10
  s_cbranch_vccz ch_wx2_ok
  s_sleep 8
  s_add_u32 s30, s30, 1
  s_cmp_lt_u32 s30, 400000
  s_cbranch_scc1 ch_wx2
  s_branch cA_abort
ch_wx2_ok:
  s_add_u32 s22, s31, 286720
  buffer_load_dwordx4 a[224:227], v2, s[8:11], s22 offen offset:0 sc1
  buffer_load_dwordx4 a[228:231], v2, s[8:11], s22 offen offset:1024 sc1
  buffer_load_dwordx4 a[232:235], v2, s[8:11], s22 offen offset:2048 sc1
  buffer_load_dwordx4 a[236:239], v2, s[8:11], s22 offen offset:3072 sc1
  s_add_u32 s22, s31, 290816
  buffer_load_dwordx4 a[240:243], v2, s[8:11], s22 offen offset:0 sc1
  buffer_load_dwordx4 a[244:247], v2, s[8:11], s22 offen offset:1024 sc1
  buffer_load_dwordx4 a[248:251], v2, s[8:11], s22 offen offset:2048 sc1
  buffer_load_dwordx4 a[252:255], v2, s[8:11], s22 offen offset:3072 sc1
  s_add_u32 s22, s31, 294912
  buffer_load_dwordx4 v[120:123], v2, s[8:11], s22 offen offset:0 sc1
  buffer_load_dwordx4 v[124:127], v2, s[8:11], s22 offen offset:1024 sc1
  buffer_load_dwordx4 v[128:131], v2, s[8:11], s22 offen offset:2048 sc1
  buffer_load_dwordx4 v[132:135], v2, s[8:11], s22 offen offset:3072 sc1
  s_add_u32 s22, s31, 299008
  buffer_load_dwordx4 v[136:139], v2, s[8:11], s22 offen offset:0 sc1
  buffer_load_dwordx4 v[140:143], v2, s[8:11], s22 offen offset:1024 sc1
  buffer_load_dwordx4 v[144:147], v2, s[8:11], s22 offen offset:2048 sc1
  buffer_load_dwordx4 v[148:151], v2, s[8:11], s22 offen offset:3072 sc1
  s_add_u32 s22, s31, 303104
  buffer_load_dwordx4 v[152:155], v2, s[8:11], s22 offen offset:0 sc1
  buffer_load_dwordx4 v[156:159], v2, s[8:11], s22 offen offset:1024 sc1
  buffer_load_dwordx4 v[160:163], v2, s[8:11], s22 offen offset:2048 sc1
  buffer_load_dwordx4 v[164:167], v2, s[8:11], s22 offen offset:3072 sc1
  s_add_u32 s22, s31, 307200
  buffer_load_dwordx4 v[168:171], v2, s[8:11], s22 offen offset:0 sc1
  buffer_load_dwordx4 v[172:175], v2, s[8:11], s22 offen offset:1024 sc1
  buffer_load_dwordx4 v[176:179], v2, s[8:11], s22 offen offset:2048 sc1
  buffer_load_dwordx4 v[180:183], v2, s[8:11], s22 offen offset:3072 sc1
  s_mov_b32 s24, 659456
  s_mov_b32 s26, 673792
  v_and_b32 v64, 7, v117
  v_and_b32 v65, 1, v116
  v_lshlrev_b32 v65, 2, v65
  v_sub_u32 v64, v64, v65
  v_lshrrev_b32 v65, 3, v117
  v_lshl_add_u32 v66, v65, 2, v64
  v_cmp_gt_u32 vcc, 4, v64
  v_mov_b32 v67, 99
  s_nop 0
  v_cndmask_b32 v66, v67, v66, vcc
  v_mov_b32 v68, 0x3f80
  v_mov_b32 v69, 0x3f800000
  v_mov_b32 v4, 0
  v_cmp_eq_u32 vcc, 0, v66
  s_nop 1
  v_cndmask_b32 v4, v4, v68, vcc
  v_cmp_eq_u32 vcc, 1, v66
  s_nop 1
  v_cndmask_b32 v4, v4, v69, vcc
  v_mov_b32 v5, 0
  v_cmp_eq_u32 vcc, 2, v66
  s_nop 1
  v_cndmask_b32 v5, v5, v68, vcc
  v_cmp_eq_u32 vcc, 3, v66
  s_nop 1
  v_cndmask_b32 v5, v5, v69, vcc
  v_mov_b32 v6, 0
  v_cmp_eq_u32 vcc, 4, v66
  s_nop 1
  v_cndmask_b32 v6, v6, v68, vcc
  v_cmp_eq_u32 vcc, 5, v66
  s_nop 1
  v_cndmask_b32 v6, v6, v69, vcc
  v_mov_b32 v7, 0
  v_cmp_eq_u32 vcc, 6, v66
  s_nop 1
  v_cndmask_b32 v7, v7, v68, vcc
  v_cmp_eq_u32 vcc, 7, v66
  s_nop 1
  v_cndmask_b32 v7, v7, v69, vcc
  v_lshrrev_b32 v64, 1, v116
  v_lshrrev_b32 v65, 3, v117
  v_and_b32 v66, 1, v116
  v_and_b32 v68, 7, v117
  v_lshlrev_b32 v67, 8, v65
  v_lshl_add_u32 v67, v68, 5, v67
  v_lshl_add_u32 v67, v66, 4, v67
  v_add_u32 v69, 5184, v67
  v_add_u32 v70, 6400, v67
  v_cmp_eq_u32 vcc, v64, v65
  s_nop 1
  v_cndmask_b32 v113, v70, v69, vcc
  s_lshl_b32 s22, s17, 9
  s_add_u32 s22, s22, 9216
  v_lshl_add_u32 v114, v1, 3, s22
  s_lshr_b32 s22, s17, 1
  s_lshl_b32 s22, s22, 8
  s_and_b32 s27, s17, 1
  s_lshl_b32 s27, s27, 3
  s_add_u32 s22, s22, s27
  s_add_u32 s22, s22, 7168
  v_add_u32 v115, s22, v2
  v_mov_b32 v70, 0x40000000
  v_cmp_gt_u32 vcc, 16, v1
  s_nop 1
  v_cndmask_b32 v115, v70, v115, vcc
  v_mov_b32 v118, -1
  v_mov_b32 v119, -1
  v_and_b32 v0, 15, v1
  s_and_b32 s22, s17, 0
  s_lshl_b32 s22, s22, 7
  s_add_u32 s22, s22, 37376
  v_lshl_add_u32 v0, v0, 2, s22
  v_xor_b32 v69, 256, v2
  v_mul_i32_i24 v70, -2048, v66
  v_add_u32 v69, v69, v70
  v_add_u32 v117, 8192, v69
  v_mov_b32 v116, v73
  s_mul_i32 s35, s17, 28672
  s_add_u32 s35, s35, 4325376
  v_mov_b32 v36, 0
  v_mov_b32 v37, 0
  v_mov_b32 v38, 0
  v_mov_b32 v39, 0
  v_mov_b32 v40, 0
  v_mov_b32 v41, 0
  v_mov_b32 v42, 0
  v_mov_b32 v43, 0
  v_mov_b32 v44, 0
  v_mov_b32 v45, 0
  v_mov_b32 v46, 0
  v_mov_b32 v47, 0
  v_mov_b32 v48, 0
  v_mov_b32 v49, 0
  v_mov_b32 v50, 0
  v_mov_b32 v51, 0
  v_mov_b32 v52, 0
  v_mov_b32 v53, 0
  v_mov_b32 v54, 0
  v_mov_b32 v55, 0
  v_mov_b32 v56, 0
  v_mov_b32 v57, 0
  v_mov_b32 v58, 0
  v_mov_b32 v59, 0
  v_mov_b32 v60, 0
  v_mov_b32 v61, 0
  v_mov_b32 v62, 0
  v_mov_b32 v63, 0
  v_mov_b32 v64, 0
  v_mov_b32 v65, 0
  v_mov_b32 v66, 0
  v_mov_b32 v67, 0
  v_mov_b32 v68, 0
  v_mov_b32 v69, 0
  v_mov_b32 v70, 0
  v_mov_b32 v71, 0
  v_mov_b32 v72, 0
  v_mov_b32 v73, 0
  v_mov_b32 v74, 0
  v_mov_b32 v75, 0
  v_mov_b32 v76, 0
  v_mov_b32 v77, 0
  v_mov_b32 v78, 0
  v_mov_b32 v79, 0
  s_mov_b32 s22, 0
  v_lshrrev_b32 v14, 4, v2
  v_add_u32 v14, 128, v14
  v_min_u32 v14, 308, v14
  v_lshlrev_b32 v14, 7, v14
  buffer_load_dword v15, v14, s[8:11], s22 offen sc1
  buffer_load_dwordx4 v[80:83], v117, s[8:11], s24 offen offset:0 sc1
  buffer_load_dwordx4 v[84:87], v117, s[8:11], s24 offen offset:1024 sc1
  buffer_load_dwordx4 v[88:91], v117, s[8:11], s26 offen offset:0 sc1
  buffer_load_dwordx4 v[92:95], v117, s[8:11], s26 offen offset:1024 sc1
  buffer_load_dwordx4 v[96:99], v2, s[8:11], s24 offen offset:0 sc1
  buffer_load_dwordx4 v[100:103], v2, s[8:11], s24 offen offset:1024 sc1
  buffer_load_dwordx4 v[104:107], v2, s[8:11], s26 offen offset:0 sc1
  buffer_load_dwordx4 v[108:111], v2, s[8:11], s26 offen offset:1024 sc1
  s_add_u32 s22, s31, 311296
  buffer_load_dwordx4 v[184:187], v2, s[8:11], s22 offen offset:0 sc1
  buffer_load_dwordx4 v[188:191], v2, s[8:11], s22 offen offset:1024 sc1
  buffer_load_dwordx4 v[192:195], v2, s[8:11], s22 offen offset:2048 sc1
  buffer_load_dwordx4 v[196:199], v2, s[8:11], s22 offen offset:3072 sc1
  s_add_u32 s22, s31, 385024
  buffer_load_dwordx4 v[200:203], v2, s[8:11], s22 offen offset:2048 sc1
  buffer_load_dwordx4 v[204:207], v2, s[8:11], s22 offen offset:3072 sc1
  s_add_u32 s22, s31, 389120
  buffer_load_dwordx4 v[208:211], v2, s[8:11], s22 offen offset:0 sc1
  buffer_load_dwordx4 v[212:215], v2, s[8:11], s22 offen offset:1024 sc1
  buffer_load_dwordx4 v[216:219], v2, s[8:11], s22 offen offset:2048 sc1
  buffer_load_dwordx4 v[220:223], v2, s[8:11], s22 offen offset:3072 sc1
  s_add_u32 s22, s31, 393216
  buffer_load_dwordx4 v[224:227], v2, s[8:11], s22 offen offset:0 sc1
  buffer_load_dwordx4 v[228:231], v2, s[8:11], s22 offen offset:1024 sc1
  buffer_load_dwordx4 v[232:235], v2, s[8:11], s22 offen offset:2048 sc1
  buffer_load_dwordx4 v[236:239], v2, s[8:11], s22 offen offset:3072 sc1
  s_add_u32 s22, s31, 397312
  buffer_load_dwordx4 v[240:243], v2, s[8:11], s22 offen offset:0 sc1
  buffer_load_dwordx4 v[244:247], v2, s[8:11], s22 offen offset:1024 sc1
  buffer_load_dwordx4 v[248:251], v2, s[8:11], s22 offen offset:2048 sc1
  buffer_load_dwordx4 v[252:255], v2, s[8:11], s22 offen offset:3072 sc1
  s_waitcnt vmcnt(0) lgkmcnt(0)
  s_mov_b32 s31, 0
  s_cmp_lg_u32 s88, 0
  s_cbranch_scc1 cB_sc2_loop
  s_branch cA_sc2_loop
ch_init3:
  s_mul_i32 s31, s17, 401408
  s_add_u32 s31, s31, 33554432
  s_and_b32 s28, s84, 12384
  s_lshl_b32 s22, s85, 16
  s_or_b32 s28, s28, s22
  s_cmp_eq_u32 s28, 4294914144
  s_cbranch_scc1 ch_wx3_ok
  s_mov_b32 s30, 0
ch_wr3:
  buffer_load_dword v9, off, s[12:15], 0 offset:132 sc1
  s_waitcnt vmcnt(0)
  v_cmp_ne_u32 vcc, 1, v9
  s_cbranch_vccz ch_wr3_ok
  s_sleep 8
  s_add_u32 s30, s30, 1
  s_cmp_lt_u32 s30, 400000
  s_cbranch_scc1 ch_wr3
  s_branch cA_abort
ch_wr3_ok:
  s_lshl_b32 s27, s17, 7
  s_add_u32 s27, s27, 584192
  s_mov_b32 s28, 12384
  s_mov_b32 s30, 0
ch_wb3:
  buffer_load_dword v9, off, s[8:11], s27  sc1
  s_waitcnt vmcnt(0)
  v_and_b32 v10, s28, v9
  v_cmp_ne_u32 vcc, s28, v10
  s_cbranch_vccz ch_wb3_ok
  s_sleep 3
  s_add_u32 s30, s30, 1
  s_cmp_lt_u32 s30, 400000
  s_cbranch_scc1 ch_wb3
  s_branch cA_abort
ch_wb3_ok:
  s_mov_b32 s29, 586240
  s_mov_b32 s28, 0xffff
  s_mov_b32 s30, 0
ch_wx3:
  buffer_load_dword v9, off, s[8:11], s29  sc1
  s_waitcnt vmcnt(0)
  v_and_b32 v10, s28, v9
  v_cmp_ne_u32 vcc, s28, v10
  s_cbranch_vccz ch_wx3_ok
  s_sleep 8
  s_add_u32 s30, s30, 1
  s_cmp_lt_u32 s30, 400000
  s_cbranch_scc1 ch_wx3
  s_branch cA_abort
ch_wx3_ok:
  s_add_u32 s22, s31, 315392
  buffer_load_dwordx4 a[224:227], v2, s[8:11], s22 offen offset:0 sc1
  buffer_load_dwordx4 a[228:231], v2, s[8:11], s22 offen offset:1024 sc1
  buffer_load_dwordx4 a[232:235], v2, s[8:11], s22 offen offset:2048 sc1
  buffer_load_dwordx4 a[236:239], v2, s[8:11], s22 offen offset:3072 sc1
  s_add_u32 s22, s31, 319488
  buffer_load_dwordx4 a[240:243], v2, s[8:11], s22 offen offset:0 sc1
  buffer_load_dwordx4 a[244:247], v2, s[8:11], s22 offen offset:1024 sc1
  buffer_load_dwordx4 a[248:251], v2, s[8:11], s22 offen offset:2048 sc1
  buffer_load_dwordx4 a[252:255], v2, s[8:11], s22 offen offset:3072 sc1
  s_add_u32 s22, s31, 323584
  buffer_load_dwordx4 v[120:123], v2, s[8:11], s22 offen offset:0 sc1
  buffer_load_dwordx4 v[124:127], v2, s[8:11], s22 offen offset:1024 sc1
  buffer_load_dwordx4 v[128:131], v2, s[8:11], s22 offen offset:2048 sc1
  buffer_load_dwordx4 v[132:135], v2, s[8:11], s22 offen offset:3072 sc1
  s_add_u32 s22, s31, 327680
  buffer_load_dwordx4 v[136:139], v2, s[8:11], s22 offen offset:0 sc1
  buffer_load_dwordx4 v[140:143], v2, s[8:11], s22 offen offset:1024 sc1
  buffer_load_dwordx4 v[144:147], v2, s[8:11], s22 offen offset:2048 sc1
  buffer_load_dwordx4 v[148:151], v2, s[8:11], s22 offen offset:3072 sc1
  s_add_u32 s22, s31, 331776
  buffer_load_dwordx4 v[152:155], v2, s[8:11], s22 offen offset:0 sc1
  buffer_load_dwordx4 v[156:159], v2, s[8:11], s22 offen offset:1024 sc1
  buffer_load_dwordx4 v[160:163], v2, s[8:11], s22 offen offset:2048 sc1
  buffer_load_dwordx4 v[164:167], v2, s[8:11], s22 offen offset:3072 sc1
  s_add_u32 s22, s31, 335872
  buffer_load_dwordx4 v[168:171], v2, s[8:11], s22 offen offset:0 sc1
  buffer_load_dwordx4 v[172:175], v2, s[8:11], s22 offen offset:1024 sc1
  buffer_load_dwordx4 v[176:179], v2, s[8:11], s22 offen offset:2048 sc1
  buffer_load_dwordx4 v[180:183], v2, s[8:11], s22 offen offset:3072 sc1
  s_mov_b32 s24, 661504
  s_mov_b32 s26, 675840
  v_and_b32 v64, 7, v117
  v_and_b32 v65, 1, v116
  v_lshlrev_b32 v65, 2, v65
  v_sub_u32 v64, v64, v65
  v_lshrrev_b32 v65, 3, v117
  v_lshl_add_u32 v66, v65, 2, v64
  v_cmp_gt_u32 vcc, 4, v64
  v_mov_b32 v67, 99
  s_nop 0
  v_cndmask_b32 v66, v67, v66, vcc
  v_mov_b32 v68, 0x3f80
  v_mov_b32 v69, 0x3f800000
  v_mov_b32 v4, 0
  v_cmp_eq_u32 vcc, 0, v66
  s_nop 1
  v_cndmask_b32 v4, v4, v68, vcc
  v_cmp_eq_u32 vcc, 1, v66
  s_nop 1
  v_cndmask_b32 v4, v4, v69, vcc
  v_mov_b32 v5, 0
  v_cmp_eq_u32 vcc, 2, v66
  s_nop 1
  v_cndmask_b32 v5, v5, v68, vcc
  v_cmp_eq_u32 vcc, 3, v66
  s_nop 1
  v_cndmask_b32 v5, v5, v69, vcc
  v_mov_b32 v6, 0
  v_cmp_eq_u32 vcc, 4, v66
  s_nop 1
  v_cndmask_b32 v6, v6, v68, vcc
  v_cmp_eq_u32 vcc, 5, v66
  s_nop 1
  v_cndmask_b32 v6, v6, v69, vcc
  v_mov_b32 v7, 0
  v_cmp_eq_u32 vcc, 6, v66
  s_nop 1
  v_cndmask_b32 v7, v7, v68, vcc
  v_cmp_eq_u32 vcc, 7, v66
  s_nop 1
  v_cndmask_b32 v7, v7, v69, vcc
  v_lshrrev_b32 v64, 1, v116
  v_lshrrev_b32 v65, 3, v117
  v_and_b32 v66, 1, v116
  v_and_b32 v68, 7, v117
  v_lshlrev_b32 v67, 8, v65
  v_lshl_add_u32 v67, v68, 5, v67
  v_lshl_add_u32 v67, v66, 4, v67
  v_add_u32 v69, 5696, v67
  v_add_u32 v70, 6400, v67
  v_cmp_eq_u32 vcc, v64, v65
  s_nop 1
  v_cndmask_b32 v113, v70, v69, vcc
  v_and_b32 v0, 15, v1
  s_and_b32 s22, s17, 0
  s_lshl_b32 s22, s22, 7
  s_add_u32 s22, s22, 37376
  v_lshl_add_u32 v0, v0, 2, s22
  v_xor_b32 v69, 256, v2
  v_mul_i32_i24 v70, 2048, v66
  v_add_u32 v69, v69, v70
  v_add_u32 v117, 4096, v69
  v_mov_b32 v116, v73
  s_mul_i32 s35, s17, 28672
  s_add_u32 s35, s35, 4325376
  v_mov_b32 v36, 0
  v_mov_b32 v37, 0
  v_mov_b32 v38, 0
  v_mov_b32 v39, 0
  v_mov_b32 v40, 0
  v_mov_b32 v41, 0
  v_mov_b32 v42, 0
  v_mov_b32 v43, 0
  v_mov_b32 v44, 0
  v_mov_b32 v45, 0
  v_mov_b32 v46, 0
  v_mov_b32 v47, 0
  v_mov_b32 v48, 0
  v_mov_b32 v49, 0
  v_mov_b32 v50, 0
  v_mov_b32 v51, 0
  v_mov_b32 v52, 0
  v_mov_b32 v53, 0
  v_mov_b32 v54, 0
  v_mov_b32 v55, 0
  v_mov_b32 v56, 0
  v_mov_b32 v57, 0
  v_mov_b32 v58, 0
  v_mov_b32 v59, 0
  v_mov_b32 v60, 0
  v_mov_b32 v61, 0
  v_mov_b32 v62, 0
  v_mov_b32 v63, 0
  v_mov_b32 v64, 0
  v_mov_b32 v65, 0
  v_mov_b32 v66, 0
  v_mov_b32 v67, 0
  v_mov_b32 v68, 0
  v_mov_b32 v69, 0
  v_mov_b32 v70, 0
  v_mov_b32 v71, 0
  v_mov_b32 v72, 0
  v_mov_b32 v73, 0
  v_mov_b32 v74, 0
  v_mov_b32 v75, 0
  v_mov_b32 v76, 0
  v_mov_b32 v77, 0
  v_mov_b32 v78, 0
  v_mov_b32 v79, 0
  s_mov_b32 s22, 0
  v_lshrrev_b32 v14, 4, v2
  v_add_u32 v14, 192, v14
  v_min_u32 v14, 308, v14
  v_lshlrev_b32 v14, 7, v14
  buffer_load_dword v15, v14, s[8:11], s22 offen sc1
  buffer_load_dwordx4 v[80:83], v117, s[8:11], s24 offen offset:0 sc1
  buffer_load_dwordx4 v[84:87], v117, s[8:11], s24 offen offset:1024 sc1
  buffer_load_dwordx4 v[88:91], v117, s[8:11], s26 offen offset:0 sc1
  buffer_load_dwordx4 v[92:95], v117, s[8:11], s26 offen offset:1024 sc1
  buffer_load_dwordx4 v[96:99], v2, s[8:11], s24 offen offset:0 sc1
  buffer_load_dwordx4 v[100:103], v2, s[8:11], s24 offen offset:1024 sc1
  buffer_load_dwordx4 v[104:107], v2, s[8:11], s26 offen offset:0 sc1
  buffer_load_dwordx4 v[108:111], v2, s[8:11], s26 offen offset:1024 sc1
  s_add_u32 s22, s31, 339968
  buffer_load_dwordx4 v[184:187], v2, s[8:11], s22 offen offset:0 sc1
  buffer_load_dwordx4 v[188:191], v2, s[8:11], s22 offen offset:1024 sc1
  buffer_load_dwordx4 v[192:195], v2, s[8:11], s22 offen offset:2048 sc1
  buffer_load_dwordx4 v[196:199], v2, s[8:11], s22 offen offset:3072 sc1
  s_add_u32 s22, s31, 356352
  buffer_load_dwordx4 v[200:203], v2, s[8:11], s22 offen offset:2048 sc1
  buffer_load_dwordx4 v[204:207], v2, s[8:11], s22 offen offset:3072 sc1
  s_add_u32 s22, s31, 360448
  buffer_load_dwordx4 v[208:211], v2, s[8:11], s22 offen offset:0 sc1
  buffer_load_dwordx4 v[212:215], v2, s[8:11], s22 offen offset:1024 sc1
  buffer_load_dwordx4 v[216:219], v2, s[8:11], s22 offen offset:2048 sc1
  buffer_load_dwordx4 v[220:223], v2, s[8:11], s22 offen offset:3072 sc1
  s_add_u32 s22, s31, 364544
  buffer_load_dwordx4 v[224:227], v2, s[8:11], s22 offen offset:0 sc1
  buffer_load_dwordx4 v[228:231], v2, s[8:11], s22 offen offset:1024 sc1
  buffer_load_dwordx4 v[232:235], v2, s[8:11], s22 offen offset:2048 sc1
  buffer_load_dwordx4 v[236:239], v2, s[8:11], s22 offen offset:3072 sc1
  s_add_u32 s22, s31, 368640
  buffer_load_dwordx4 v[240:243], v2, s[8:11], s22 offen offset:0 sc1
  buffer_load_dwordx4 v[244:247], v2, s[8:11], s22 offen offset:1024 sc1
  buffer_load_dwordx4 v[248:251], v2, s[8:11], s22 offen offset:2048 sc1
  buffer_load_dwordx4 v[252:255], v2, s[8:11], s22 offen offset:3072 sc1
  s_waitcnt vmcnt(0) lgkmcnt(0)
  s_mov_b32 s31, 0
  s_cmp_lg_u32 s88, 0
  s_cbranch_scc1 cB_sc3_loop
  s_branch cA_sc3_loop
ch_init4:
  v_mov_b32 v72, v116
  v_mov_b32 v73, v117
  v_lshrrev_b32 v65, 1, v72
  v_and_b32 v66, 1, v72
  v_mov_b32 v36, 0
  v_mov_b32 v37, 0
  v_mov_b32 v38, 0
  v_mov_b32 v39, 0
  v_mov_b32 v40, 0
  v_mov_b32 v41, 0
  v_mov_b32 v42, 0
  v_mov_b32 v43, 0
  v_mov_b32 v44, 0
  v_mov_b32 v45, 0
  v_mov_b32 v46, 0
  v_mov_b32 v47, 0
  v_mov_b32 v48, 0
  v_mov_b32 v49, 0
  v_mov_b32 v50, 0
  v_mov_b32 v51, 0
  v_mov_b32 v52, 0
  v_mov_b32 v53, 0
  v_mov_b32 v54, 0
  v_mov_b32 v55, 0
  v_mov_b32 v56, 0
  v_mov_b32 v57, 0
  v_mov_b32 v58, 0
  v_mov_b32 v59, 0
  v_mov_b32 v60, 0
  v_mov_b32 v61, 0
  v_mov_b32 v62, 0
  v_mov_b32 v63, 0
  v_lshlrev_b32 v75, 2, v65
  v_lshl_add_u32 v75, v66, 3, v75
  v_add_u32 v67, 0, v73
  v_mul_u32_u24 v68, 2341, v67
  v_lshrrev_b32 v68, 16, v68
  v_mul_u32_u24 v69, 28, v68
  v_sub_u32 v69, v67, v69
  v_lshrrev_b32 v70, 4, v69
  v_and_b32 v69, 15, v69
  v_lshlrev_b32 v71, 12, v70
  v_lshl_add_u32 v71, v68, 8, v71
  v_lshl_add_u32 v71, v69, 4, v71
  v_add_u32 v152, v71, v75
  v_add_u32 v67, 16, v73
  v_mul_u32_u24 v68, 2341, v67
  v_lshrrev_b32 v68, 16, v68
  v_mul_u32_u24 v69, 28, v68
  v_sub_u32 v69, v67, v69
  v_lshrrev_b32 v70, 4, v69
  v_and_b32 v69, 15, v69
  v_lshlrev_b32 v71, 12, v70
  v_lshl_add_u32 v71, v68, 8, v71
  v_lshl_add_u32 v71, v69, 4, v71
  v_add_u32 v153, v71, v75
  v_add_u32 v67, 32, v73
  v_mul_u32_u24 v68, 2341, v67
  v_lshrrev_b32 v68, 16, v68
  v_mul_u32_u24 v69, 28, v68
  v_sub_u32 v69, v67, v69
  v_lshrrev_b32 v70, 4, v69
  v_and_b32 v69, 15, v69
  v_lshlrev_b32 v71, 12, v70
  v_lshl_add_u32 v71, v68, 8, v71
  v_lshl_add_u32 v71, v69, 4, v71
  v_add_u32 v154, v71, v75
  v_add_u32 v67, 48, v73
  v_mul_u32_u24 v68, 2341, v67
  v_lshrrev_b32 v68, 16, v68
  v_mul_u32_u24 v69, 28, v68
  v_sub_u32 v69, v67, v69
  v_lshrrev_b32 v70, 4, v69
  v_and_b32 v69, 15, v69
  v_lshlrev_b32 v71, 12, v70
  v_lshl_add_u32 v71, v68, 8, v71
  v_lshl_add_u32 v71, v69, 4, v71
  v_add_u32 v155, v71, v75
  v_add_u32 v67, 64, v73
  v_mul_u32_u24 v68, 2341, v67
  v_lshrrev_b32 v68, 16, v68
  v_mul_u32_u24 v69, 28, v68
  v_sub_u32 v69, v67, v69
  v_lshrrev_b32 v70, 4, v69
  v_and_b32 v69, 15, v69
  v_lshlrev_b32 v71, 12, v70
  v_lshl_add_u32 v71, v68, 8, v71
  v_lshl_add_u32 v71, v69, 4, v71
  v_add_u32 v156, v71, v75
  v_add_u32 v67, 80, v73
  v_mul_u32_u24 v68, 2341, v67
  v_lshrrev_b32 v68, 16, v68
  v_mul_u32_u24 v69, 28, v68
  v_sub_u32 v69, v67, v69
  v_lshrrev_b32 v70, 4, v69
  v_and_b32 v69, 15, v69
  v_lshlrev_b32 v71, 12, v70
  v_lshl_add_u32 v71, v68, 8, v71
  v_lshl_add_u32 v71, v69, 4, v71
  v_add_u32 v157, v71, v75
  v_mov_b32 v74, 0x40000000
  v_mov_b32 v164, 0
  v_mov_b32 v76, 0
  v_mov_b32 v77, 0
  v_mov_b32 v78, 0
  v_mov_b32 v79, 0
  ds_write_b128 v2, v[76:79] offset:0
  ds_write_b128 v2, v[76:79] offset:1024
  ds_write_b128 v2, v[76:79] offset:2048
  ds_write_b128 v2, v[76:79] offset:3072
  s_and_b32 s22, s17, 0
  s_lshl_b32 s22, s22, 7
  s_add_u32 s22, s22, 35328
  v_lshl_add_u32 v4, v73, 2, s22
  v_and_b32 v64, 1, v73
  v_mov_b32 v5, 0x05040100
  v_mov_b32 v65, 0x03020706
  v_cmp_eq_u32 vcc, 1, v64
  s_nop 1
  v_cndmask_b32 v5, v5, v65, vcc
  s_lshl_b32 s22, s17, 2
  s_add_u32 s22, s22, 37376
  v_lshl_add_u32 v7, v1, 7, s22
  v_cmp_gt_u32 vcc, 1, v1
  s_nop 1
  v_cndmask_b32 v7, v74, v7, vcc
  v_mov_b32 v6, v2
  v_lshl_add_u32 v64, v66, 2, v64
  v_and_b32 v65, 2, v72
  v_add_u32 v64, v64, v65
  s_mul_i32 s22, s17, 16
  v_add_u32 v75, s22, v73
  v_lshrrev_b32 v68, 4, v75
  v_lshlrev_b32 v68, 8, v68
  v_bfe_u32 v69, v75, 1, 1
  v_lshl_add_u32 v68, v69, 7, v68
  v_lshl_add_u32 v68, v64, 4, v68
  v_and_b32 v69, 12, v75
  v_add_u32 v1, v68, v69
  s_mul_i32 s22, s17, 28672
  s_add_u32 s25, s22, 2490368
  s_and_b32 s27, s17, 0
  s_xor_b32 s22, s27, 0
  s_mul_i32 s80, s22, 7168
  s_lshl_b32 s22, s22, 11
  s_add_u32 s76, s22, 9216
  s_xor_b32 s22, s27, 1
  s_mul_i32 s81, s22, 7168
  s_lshl_b32 s22, s22, 11
  s_add_u32 s77, s22, 9216
  s_xor_b32 s22, s27, 2
  s_mul_i32 s82, s22, 7168
  s_lshl_b32 s22, s22, 11
  s_add_u32 s78, s22, 9216
  s_xor_b32 s22, s27, 3
  s_mul_i32 s83, s22, 7168
  s_lshl_b32 s22, s22, 11
  s_add_u32 s79, s22, 9216
  v_mov_b32 v162, -1
  s_mov_b32 s38, 0x40000000
  s_mul_i32 s31, s17, 401408
  s_add_u32 s31, s31, 39976960
  s_mov_b32 s30, 0
ch_wr4:
  buffer_load_dword v9, off, s[12:15], 0 offset:128 sc1
  s_waitcnt vmcnt(0)
  v_cmp_ne_u32 vcc, 1, v9
  s_cbranch_vccz ch_wr4_ok
  s_sleep 8
  s_add_u32 s30, s30, 1
  s_cmp_lt_u32 s30, 400000
  s_cbranch_scc1 ch_wr4
  s_branch cA_abort
ch_wr4_ok:
  s_lshr_b32 s22, s17, 2
  s_lshl_b32 s28, 0x81, s22
  s_mul_i32 s27, s17, 12
  s_add_u32 s22, s27, 256
  s_lshr_b32 s22, s22, 6
  s_lshl_b32 s22, 0x81, s22
  s_or_b32 s28, s28, s22
  s_add_u32 s22, s27, 267
  s_lshr_b32 s22, s22, 6
  s_lshl_b32 s22, 0x81, s22
  s_or_b32 s28, s28, s22
  v_lshrrev_b32 v12, 8, v2
  v_lshlrev_b32 v12, 7, v12
  s_mov_b32 s27, 582144
  s_mov_b32 s30, 0
ch_ww4:
  buffer_load_dword v9, v12, s[8:11], s27 offen sc1
  s_waitcnt vmcnt(0)
  v_and_b32 v10, s28, v9
  v_cmp_ne_u32 vcc, s28, v10
  s_cbranch_vccz ch_ww4_ok
  s_sleep 3
  s_add_u32 s30, s30, 1
  s_cmp_lt_u32 s30, 400000
  s_cbranch_scc1 ch_ww4
  s_branch cA_abort
ch_ww4_ok:
  s_add_u32 s22, s31, 0
  buffer_load_dwordx4 a[0:3], v2, s[8:11], s22 offen offset:0 sc1
  buffer_load_dwordx4 a[4:7], v2, s[8:11], s22 offen offset:1024 sc1
  buffer_load_dwordx4 a[8:11], v2, s[8:11], s22 offen offset:2048 sc1
  buffer_load_dwordx4 a[12:15], v2, s[8:11], s22 offen offset:3072 sc1
  s_add_u32 s22, s31, 4096
  buffer_load_dwordx4 a[16:19], v2, s[8:11], s22 offen offset:0 sc1
  buffer_load_dwordx4 a[20:23], v2, s[8:11], s22 offen offset:1024 sc1
  buffer_load_dwordx4 a[24:27], v2, s[8:11], s22 offen offset:2048 sc1
  buffer_load_dwordx4 a[28:31], v2, s[8:11], s22 offen offset:3072 sc1
  s_add_u32 s22, s31, 8192
  buffer_load_dwordx4 a[32:35], v2, s[8:11], s22 offen offset:0 sc1
  buffer_load_dwordx4 a[36:39], v2, s[8:11], s22 offen offset:1024 sc1
  buffer_load_dwordx4 a[40:43], v2, s[8:11], s22 offen offset:2048 sc1
  buffer_load_dwordx4 a[44:47], v2, s[8:11], s22 offen offset:3072 sc1
  s_add_u32 s22, s31, 12288
  buffer_load_dwordx4 a[48:51], v2, s[8:11], s22 offen offset:0 sc1
  buffer_load_dwordx4 a[52:55], v2, s[8:11], s22 offen offset:1024 sc1
  buffer_load_dwordx4 a[56:59], v2, s[8:11], s22 offen offset:2048 sc1
  buffer_load_dwordx4 a[60:63], v2, s[8:11], s22 offen offset:3072 sc1
  s_add_u32 s22, s31, 16384
  buffer_load_dwordx4 a[64:67], v2, s[8:11], s22 offen offset:0 sc1
  buffer_load_dwordx4 a[68:71], v2, s[8:11], s22 offen offset:1024 sc1
  buffer_load_dwordx4 a[72:75], v2, s[8:11], s22 offen offset:2048 sc1
  buffer_load_dwordx4 a[76:79], v2, s[8:11], s22 offen offset:3072 sc1
  s_add_u32 s22, s31, 20480
  buffer_load_dwordx4 a[80:83], v2, s[8:11], s22 offen offset:0 sc1
  buffer_load_dwordx4 a[84:87], v2, s[8:11], s22 offen offset:1024 sc1
  buffer_load_dwordx4 a[88:91], v2, s[8:11], s22 offen offset:2048 sc1
  buffer_load_dwordx4 a[92:95], v2, s[8:11], s22 offen offset:3072 sc1
  s_add_u32 s22, s31, 24576
  buffer_load_dwordx4 a[96:99], v2, s[8:11], s22 offen offset:0 sc1
  buffer_load_dwordx4 a[100:103], v2, s[8:11], s22 offen offset:1024 sc1
  buffer_load_dwordx4 a[104:107], v2, s[8:11], s22 offen offset:2048 sc1
  buffer_load_dwordx4 a[108:111], v2, s[8:11], s22 offen offset:3072 sc1
  s_add_u32 s22, s31, 28672
  buffer_load_dwordx4 a[112:115], v2, s[8:11], s22 offen offset:0 sc1
  buffer_load_dwordx4 a[116:119], v2, s[8:11], s22 offen offset:1024 sc1
  buffer_load_dwordx4 a[120:123], v2, s[8:11], s22 offen offset:2048 sc1
  buffer_load_dwordx4 a[124:127], v2, s[8:11], s22 offen offset:3072 sc1
  s_waitcnt vmcnt(24)
  s_add_u32 s22, s31, 32768
  buffer_load_dwordx4 a[128:131], v2, s[8:11], s22 offen offset:0 sc1
  buffer_load_dwordx4 a[132:135], v2, s[8:11], s22 offen offset:1024 sc1
  buffer_load_dwordx4 a[136:139], v2, s[8:11], s22 offen offset:2048 sc1
  buffer_load_dwordx4 a[140:143], v2, s[8:11], s22 offen offset:3072 sc1
  s_add_u32 s22, s31, 36864
  buffer_load_dwordx4 a[144:147], v2, s[8:11], s22 offen offset:0 sc1
  buffer_load_dwordx4 a[148:151], v2, s[8:11], s22 offen offset:1024 sc1
  buffer_load_dwordx4 a[152:155], v2, s[8:11], s22 offen offset:2048 sc1
  buffer_load_dwordx4 a[156:159], v2, s[8:11], s22 offen offset:3072 sc1
  s_add_u32 s22, s31, 40960
  buffer_load_dwordx4 a[160:163], v2, s[8:11], s22 offen offset:0 sc1
  buffer_load_dwordx4 a[164:167], v2, s[8:11], s22 offen offset:1024 sc1
  buffer_load_dwordx4 a[168:171], v2, s[8:11], s22 offen offset:2048 sc1
  buffer_load_dwordx4 a[172:175], v2, s[8:11], s22 offen offset:3072 sc1
  s_add_u32 s22, s31, 45056
  buffer_load_dwordx4 a[176:179], v2, s[8:11], s22 offen offset:0 sc1
  buffer_load_dwordx4 a[180:183], v2, s[8:11], s22 offen offset:1024 sc1
  buffer_load_dwordx4 a[184:187], v2, s[8:11], s22 offen offset:2048 sc1
  buffer_load_dwordx4 a[188:191], v2, s[8:11], s22 offen offset:3072 sc1
  s_add_u32 s22, s31, 49152
  buffer_load_dwordx4 a[192:195], v2, s[8:11], s22 offen offset:0 sc1
  buffer_load_dwordx4 a[196:199], v2, s[8:11], s22 offen offset:1024 sc1
  buffer_load_dwordx4 a[200:203], v2, s[8:11], s22 offen offset:2048 sc1
  buffer_load_dwordx4 a[204:207], v2, s[8:11], s22 offen offset:3072 sc1
  s_add_u32 s22, s31, 53248
  buffer_load_dwordx4 a[208:211], v2, s[8:11], s22 offen offset:0 sc1
  buffer_load_dwordx4 a[212:215], v2, s[8:11], s22 offen offset:1024 sc1
  buffer_load_dwordx4 a[216:219], v2, s[8:11], s22 offen offset:2048 sc1
  buffer_load_dwordx4 a[220:223], v2, s[8:11], s22 offen offset:3072 sc1
  s_add_u32 s22, s31, 57344
  buffer_load_dwordx4 a[224:227], v2, s[8:11], s22 offen offset:0 sc1
  buffer_load_dwordx4 a[228:231], v2, s[8:11], s22 offen offset:1024 sc1
  buffer_load_dwordx4 a[232:235], v2, s[8:11], s22 offen offset:2048 sc1
  buffer_load_dwordx4 a[236:239], v2, s[8:11], s22 offen offset:3072 sc1
  s_add_u32 s22, s31, 61440
  buffer_load_dwordx4 a[240:243], v2, s[8:11], s22 offen offset:0 sc1
  buffer_load_dwordx4 a[244:247], v2, s[8:11], s22 offen offset:1024 sc1
  buffer_load_dwordx4 a[248:251], v2, s[8:11], s22 offen offset:2048 sc1
  buffer_load_dwordx4 a[252:255], v2, s[8:11], s22 offen offset:3072 sc1
  s_waitcnt vmcnt(24)
  s_add_u32 s22, s31, 65536
  buffer_load_dwordx4 v[176:179], v2, s[8:11], s22 offen offset:0 sc1
  buffer_load_dwordx4 v[180:183], v2, s[8:11], s22 offen offset:1024 sc1
  buffer_load_dwordx4 v[184:187], v2, s[8:11], s22 offen offset:2048 sc1
  buffer_load_dwordx4 v[188:191], v2, s[8:11], s22 offen offset:3072 sc1
  s_add_u32 s22, s31, 69632
  buffer_load_dwordx4 v[192:195], v2, s[8:11], s22 offen offset:0 sc1
  buffer_load_dwordx4 v[196:199], v2, s[8:11], s22 offen offset:1024 sc1
  buffer_load_dwordx4 v[200:203], v2, s[8:11], s22 offen offset:2048 sc1
  buffer_load_dwordx4 v[204:207], v2, s[8:11], s22 offen offset:3072 sc1
  s_add_u32 s22, s31, 73728
  buffer_load_dwordx4 v[208:211], v2, s[8:11], s22 offen offset:0 sc1
  buffer_load_dwordx4 v[212:215], v2, s[8:11], s22 offen offset:1024 sc1
  buffer_load_dwordx4 v[216:219], v2, s[8:11], s22 offen offset:2048 sc1
  buffer_load_dwordx4 v[220:223], v2, s[8:11], s22 offen offset:3072 sc1
  s_add_u32 s22, s31, 77824
  buffer_load_dwordx4 v[224:227], v2, s[8:11], s22 offen offset:0 sc1
  buffer_load_dwordx4 v[228:231], v2, s[8:11], s22 offen offset:1024 sc1
  buffer_load_dwordx4 v[232:235], v2, s[8:11], s22 offen offset:2048 sc1
  buffer_load_dwordx4 v[236:239], v2, s[8:11], s22 offen offset:3072 sc1
  s_add_u32 s22, s31, 81920
  buffer_load_dwordx4 v[240:243], v2, s[8:11], s22 offen offset:0 sc1
  buffer_load_dwordx4 v[244:247], v2, s[8:11], s22 offen offset:1024 sc1
  buffer_load_dwordx4 v[248:251], v2, s[8:11], s22 offen offset:2048 sc1
  buffer_load_dwordx4 v[252:255], v2, s[8:11], s22 offen offset:3072 sc1
  s_mov_b32 m0, 16384
  s_add_u32 s22, s31, 86016
  buffer_load_dwordx4 v2, s[8:11], s22 offen offset:0 sc1 lds
  buffer_load_dwordx4 v2, s[8:11], s22 offen offset:1024 sc1 lds
  buffer_load_dwordx4 v2, s[8:11], s22 offen offset:2048 sc1 lds
  buffer_load_dwordx4 v2, s[8:11], s22 offen offset:3072 sc1 lds
  s_mov_b32 m0, 20480
  s_add_u32 s22, s31, 90112
  buffer_load_dwordx4 v2, s[8:11], s22 offen offset:0 sc1 lds
  buffer_load_dwordx4 v2, s[8:11], s22 offen offset:1024 sc1 lds
  buffer_load_dwordx4 v2, s[8:11], s22 offen offset:2048 sc1 lds
  buffer_load_dwordx4 v2, s[8:11], s22 offen offset:3072 sc1 lds
  s_mov_b32 m0, 24576
  s_add_u32 s22, s31, 94208
  buffer_load_dwordx4 v2, s[8:11], s22 offen offset:0 sc1 lds
  buffer_load_dwordx4 v2, s[8:11], s22 offen offset:1024 sc1 lds
  buffer_load_dwordx4 v2, s[8:11], s22 offen offset:2048 sc1 lds
  buffer_load_dwordx4 v2, s[8:11], s22 offen offset:3072 sc1 lds
  s_mov_b32 m0, 28672
  s_add_u32 s22, s31, 98304
  buffer_load_dwordx4 v2, s[8:11], s22 offen offset:0 sc1 lds
  buffer_load_dwordx4 v2, s[8:11], s22 offen offset:1024 sc1 lds
  s_mov_b32 s30, 0
ch_ws4:
  buffer_load_dword v9, off, s[12:15], 0 offset:132 sc1
  s_waitcnt vmcnt(0)
  v_cmp_ne_u32 vcc, 1, v9
  s_cbranch_vccz ch_ws4_ok
  s_sleep 8
  s_add_u32 s30, s30, 1
  s_cmp_lt_u32 s30, 400000
  s_cbranch_scc1 ch_ws4
  s_branch cA_abort
ch_ws4_ok:
  s_mul_i32 s33, s17, 532480
  s_add_u32 s33, s33, 78110720
  v_mov_b32 v12, -1
  v_mov_b32 v13, -1
  v_mov_b32 v14, -1
  v_mov_b32 v15, -1
  s_add_u32 s22, s33, 0
  buffer_store_dwordx4 v[12:15], v2, s[8:11], s22 offen sc1
  s_add_u32 s22, s33, 2048
  buffer_store_dwordx4 v[12:15], v2, s[8:11], s22 offen sc1
  s_add_u32 s22, s33, 4096
  buffer_store_dwordx4 v[12:15], v2, s[8:11], s22 offen sc1
  s_add_u32 s22, s33, 6144
  buffer_store_dwordx4 v[12:15], v2, s[8:11], s22 offen sc1
  s_add_u32 s22, s33, 8192
  buffer_store_dwordx4 v[12:15], v2, s[8:11], s22 offen sc1
  s_add_u32 s22, s33, 10240
  buffer_store_dwordx4 v[12:15], v2, s[8:11], s22 offen sc1
  s_add_u32 s22, s33, 12288
  buffer_store_dwordx4 v[12:15], v2, s[8:11], s22 offen sc1
  s_add_u32 s22, s33, 14336
  buffer_store_dwordx4 v[12:15], v2, s[8:11], s22 offen sc1
  v_mov_b32 v16, 1
  v_mov_b32 v17, 1
  s_lshl_b32 s22, s17, 10
  s_add_u32 s22, s22, 566240
  s_waitcnt vmcnt(0)
  s_mov_b64 exec, 3
  buffer_store_dwordx2 v[16:17], v2, s[8:11], s22 offen sc1
  s_mov_b64 exec, -1
  s_mov_b32 s28, s35
  s_waitcnt vmcnt(0) lgkmcnt(0)
  s_mov_b32 s31, 0
  s_cmp_lg_u32 s88, 0
  s_cbranch_scc1 cB_va0_loop
  s_branch cA_va0_loop
ch_init5:
  v_mov_b32 v72, v116
  v_mov_b32 v73, v117
  v_lshrrev_b32 v65, 1, v72
  v_and_b32 v66, 1, v72
  v_mov_b32 v36, 0
  v_mov_b32 v37, 0
  v_mov_b32 v38, 0
  v_mov_b32 v39, 0
  v_mov_b32 v40, 0
  v_mov_b32 v41, 0
  v_mov_b32 v42, 0
  v_mov_b32 v43, 0
  v_mov_b32 v44, 0
  v_mov_b32 v45, 0
  v_mov_b32 v46, 0
  v_mov_b32 v47, 0
  v_mov_b32 v48, 0
  v_mov_b32 v49, 0
  v_mov_b32 v50, 0
  v_mov_b32 v51, 0
  v_mov_b32 v52, 0
  v_mov_b32 v53, 0
  v_mov_b32 v54, 0
  v_mov_b32 v55, 0
  v_mov_b32 v56, 0
  v_mov_b32 v57, 0
  v_mov_b32 v58, 0
  v_mov_b32 v59, 0
  v_mov_b32 v60, 0
  v_mov_b32 v61, 0
  v_mov_b32 v62, 0
  v_mov_b32 v63, 0
  v_lshlrev_b32 v75, 2, v65
  v_lshl_add_u32 v75, v66, 3, v75
  v_add_u32 v67, 112, v73
  v_mul_u32_u24 v68, 2341, v67
  v_lshrrev_b32 v68, 16, v68
  v_mul_u32_u24 v69, 28, v68
  v_sub_u32 v69, v67, v69
  v_lshrrev_b32 v70, 4, v69
  v_and_b32 v69, 15, v69
  v_lshlrev_b32 v71, 12, v70
  v_lshl_add_u32 v71, v68, 8, v71
  v_lshl_add_u32 v71, v69, 4, v71
  v_add_u32 v152, v71, v75
  v_add_u32 v67, 128, v73
  v_mul_u32_u24 v68, 2341, v67
  v_lshrrev_b32 v68, 16, v68
  v_mul_u32_u24 v69, 28, v68
  v_sub_u32 v69, v67, v69
  v_lshrrev_b32 v70, 4, v69
  v_and_b32 v69, 15, v69
  v_lshlrev_b32 v71, 12, v70
  v_lshl_add_u32 v71, v68, 8, v71
  v_lshl_add_u32 v71, v69, 4, v71
  v_add_u32 v153, v71, v75
  v_add_u32 v67, 144, v73
  v_mul_u32_u24 v68, 2341, v67
  v_lshrrev_b32 v68, 16, v68
  v_mul_u32_u24 v69, 28, v68
  v_sub_u32 v69, v67, v69
  v_lshrrev_b32 v70, 4, v69
  v_and_b32 v69, 15, v69
  v_lshlrev_b32 v71, 12, v70
  v_lshl_add_u32 v71, v68, 8, v71
  v_lshl_add_u32 v71, v69, 4, v71
  v_add_u32 v154, v71, v75
  v_add_u32 v67, 160, v73
  v_mul_u32_u24 v68, 2341, v67
  v_lshrrev_b32 v68, 16, v68
  v_mul_u32_u24 v69, 28, v68
  v_sub_u32 v69, v67, v69
  v_lshrrev_b32 v70, 4, v69
  v_and_b32 v69, 15, v69
  v_lshlrev_b32 v71, 12, v70
  v_lshl_add_u32 v71, v68, 8, v71
  v_lshl_add_u32 v71, v69, 4, v71
  v_add_u32 v155, v71, v75
  v_add_u32 v67, 176, v73
  v_mul_u32_u24 v68, 2341, v67
  v_lshrrev_b32 v68, 16, v68
  v_mul_u32_u24 v69, 28, v68
  v_sub_u32 v69, v67, v69
  v_lshrrev_b32 v70, 4, v69
  v_and_b32 v69, 15, v69
  v_lshlrev_b32 v71, 12, v70
  v_lshl_add_u32 v71, v68, 8, v71
  v_lshl_add_u32 v71, v69, 4, v71
  v_add_u32 v156, v71, v75
  v_add_u32 v67, 192, v73
  v_mul_u32_u24 v68, 2341, v67
  v_lshrrev_b32 v68, 16, v68
  v_mul_u32_u24 v69, 28, v68
  v_sub_u32 v69, v67, v69
  v_lshrrev_b32 v70, 4, v69
  v_and_b32 v69, 15, v69
  v_lshlrev_b32 v71, 12, v70
  v_lshl_add_u32 v71, v68, 8, v71
  v_lshl_add_u32 v71, v69, 4, v71
  v_add_u32 v157, v71, v75
  v_add_u32 v67, 208, v73
  v_mul_u32_u24 v68, 2341, v67
  v_lshrrev_b32 v68, 16, v68
  v_mul_u32_u24 v69, 28, v68
  v_sub_u32 v69, v67, v69
  v_lshrrev_b32 v70, 4, v69
  v_and_b32 v69, 15, v69
  v_lshlrev_b32 v71, 12, v70
  v_lshl_add_u32 v71, v68, 8, v71
  v_lshl_add_u32 v71, v69, 4, v71
  v_add_u32 v158, v71, v75
  v_mov_b32 v74, 0x40000000
  v_mov_b32 v164, 0
  v_add_u32 v0, 30720, v2
  v_mov_b32 v76, 0
  v_mov_b32 v77, 0
  v_mov_b32 v78, 0
  v_mov_b32 v79, 0
  ds_write_b128 v2, v[76:79] offset:4096
  ds_write_b128 v2, v[76:79] offset:5120
  ds_write_b128 v2, v[76:79] offset:6144
  ds_write_b128 v2, v[76:79] offset:7168
  s_and_b32 s22, s17, 0
  s_lshl_b32 s22, s22, 7
  s_add_u32 s22, s22, 35328
  v_lshl_add_u32 v4, v73, 2, s22
  v_and_b32 v64, 1, v73
  v_mov_b32 v5, 0x05040100
  v_mov_b32 v65, 0x03020706
  v_cmp_eq_u32 vcc, 1, v64
  s_nop 1
  v_cndmask_b32 v5, v5, v65, vcc
  s_lshl_b32 s22, s17, 2
  s_add_u32 s22, s22, 39424
  v_lshl_add_u32 v7, v1, 7, s22
  v_cmp_gt_u32 vcc, 1, v1
  s_nop 1
  v_cndmask_b32 v7, v74, v7, vcc
  v_min_u32 v65, 11, v73
  v_mad_u32_u24 v65, v72, 12, v65
  v_lshlrev_b32 v6, 4, v65
  v_add_u32 v6, 1024, v6
  v_lshl_add_u32 v64, v66, 2, v64
  v_and_b32 v65, 2, v72
  v_add_u32 v64, v64, v65
  s_mul_i32 s22, s17, 12
  s_add_u32 s22, s22, 256
  v_add_u32 v75, s22, v73
  v_lshrrev_b32 v68, 4, v75
  v_lshlrev_b32 v68, 8, v68
  v_bfe_u32 v69, v75, 1, 1
  v_lshl_add_u32 v68, v69, 7, v68
  v_lshl_add_u32 v68, v64, 4, v68
  v_and_b32 v69, 12, v75
  v_add_u32 v1, v68, v69
  v_cmp_gt_u32 vcc, 12, v73
  s_nop 1
  v_cndmask_b32 v1, v74, v1, vcc
  s_mul_i32 s22, s17, 28672
  s_add_u32 s25, s22, 2490368
  s_and_b32 s27, s17, 0
  s_xor_b32 s22, s27, 0
  s_mul_i32 s80, s22, 7168
  s_lshl_b32 s22, s22, 11
  s_add_u32 s76, s22, 9216
  s_xor_b32 s22, s27, 1
  s_mul_i32 s81, s22, 7168
  s_lshl_b32 s22, s22, 11
  s_add_u32 s77, s22, 9216
  s_xor_b32 s22, s27, 2
  s_mul_i32 s82, s22, 7168
  s_lshl_b32 s22, s22, 11
  s_add_u32 s78, s22, 9216
  s_xor_b32 s22, s27, 3
  s_mul_i32 s83, s22, 7168
  s_lshl_b32 s22, s22, 11
  s_add_u32 s79, s22, 9216
  v_mov_b32 v162, -1
  s_mov_b32 s38, 0x40000000
  s_mul_i32 s31, s17, 401408
  s_add_u32 s31, s31, 40077312
  s_mov_b32 s30, 0
ch_wr5:
  buffer_load_dword v9, off, s[12:15], 0 offset:128 sc1
  s_waitcnt vmcnt(0)
  v_cmp_ne_u32 vcc, 1, v9
  s_cbranch_vccz ch_wr5_ok
  s_sleep 8
  s_add_u32 s30, s30, 1
  s_cmp_lt_u32 s30, 400000
  s_cbranch_scc1 ch_wr5
  s_branch cA_abort
ch_wr5_ok:
  s_lshr_b32 s22, s17, 2
  s_lshl_b32 s28, 0x81, s22
  s_mul_i32 s27, s17, 12
  s_add_u32 s22, s27, 256
  s_lshr_b32 s22, s22, 6
  s_lshl_b32 s22, 0x81, s22
  s_or_b32 s28, s28, s22
  s_add_u32 s22, s27, 267
  s_lshr_b32 s22, s22, 6
  s_lshl_b32 s22, 0x81, s22
  s_or_b32 s28, s28, s22
  v_lshrrev_b32 v12, 8, v2
  v_lshlrev_b32 v12, 7, v12
  s_mov_b32 s27, 582656
  s_mov_b32 s30, 0
ch_ww5:
  buffer_load_dword v9, v12, s[8:11], s27 offen sc1
  s_waitcnt vmcnt(0)
  v_and_b32 v10, s28, v9
  v_cmp_ne_u32 vcc, s28, v10
  s_cbranch_vccz ch_ww5_ok
  s_sleep 3
  s_add_u32 s30, s30, 1
  s_cmp_lt_u32 s30, 400000
  s_cbranch_scc1 ch_ww5
  s_branch cA_abort
ch_ww5_ok:
  s_add_u32 s22, s31, 0
  buffer_load_dwordx4 a[0:3], v2, s[8:11], s22 offen offset:0 sc1
  buffer_load_dwordx4 a[4:7], v2, s[8:11], s22 offen offset:1024 sc1
  buffer_load_dwordx4 a[8:11], v2, s[8:11], s22 offen offset:2048 sc1
  buffer_load_dwordx4 a[12:15], v2, s[8:11], s22 offen offset:3072 sc1
  s_add_u32 s22, s31, 4096
  buffer_load_dwordx4 a[16:19], v2, s[8:11], s22 offen offset:0 sc1
  buffer_load_dwordx4 a[20:23], v2, s[8:11], s22 offen offset:1024 sc1
  buffer_load_dwordx4 a[24:27], v2, s[8:11], s22 offen offset:2048 sc1
  buffer_load_dwordx4 a[28:31], v2, s[8:11], s22 offen offset:3072 sc1
  s_add_u32 s22, s31, 8192
  buffer_load_dwordx4 a[32:35], v2, s[8:11], s22 offen offset:0 sc1
  buffer_load_dwordx4 a[36:39], v2, s[8:11], s22 offen offset:1024 sc1
  buffer_load_dwordx4 a[40:43], v2, s[8:11], s22 offen offset:2048 sc1
  buffer_load_dwordx4 a[44:47], v2, s[8:11], s22 offen offset:3072 sc1
  s_add_u32 s22, s31, 12288
  buffer_load_dwordx4 a[48:51], v2, s[8:11], s22 offen offset:0 sc1
  buffer_load_dwordx4 a[52:55], v2, s[8:11], s22 offen offset:1024 sc1
  buffer_load_dwordx4 a[56:59], v2, s[8:11], s22 offen offset:2048 sc1
  buffer_load_dwordx4 a[60:63], v2, s[8:11], s22 offen offset:3072 sc1
  s_add_u32 s22, s31, 16384
  buffer_load_dwordx4 a[64:67], v2, s[8:11], s22 offen offset:0 sc1
  buffer_load_dwordx4 a[68:71], v2, s[8:11], s22 offen offset:1024 sc1
  buffer_load_dwordx4 a[72:75], v2, s[8:11], s22 offen offset:2048 sc1
  buffer_load_dwordx4 a[76:79], v2, s[8:11], s22 offen offset:3072 sc1
  s_add_u32 s22, s31, 20480
  buffer_load_dwordx4 a[80:83], v2, s[8:11], s22 offen offset:0 sc1
  buffer_load_dwordx4 a[84:87], v2, s[8:11], s22 offen offset:1024 sc1
  buffer_load_dwordx4 a[88:91], v2, s[8:11], s22 offen offset:2048 sc1
  buffer_load_dwordx4 a[92:95], v2, s[8:11], s22 offen offset:3072 sc1
  s_add_u32 s22, s31, 24576
  buffer_load_dwordx4 a[96:99], v2, s[8:11], s22 offen offset:0 sc1
  buffer_load_dwordx4 a[100:103], v2, s[8:11], s22 offen offset:1024 sc1
  buffer_load_dwordx4 a[104:107], v2, s[8:11], s22 offen offset:2048 sc1
  buffer_load_dwordx4 a[108:111], v2, s[8:11], s22 offen offset:3072 sc1
  s_add_u32 s22, s31, 28672
  buffer_load_dwordx4 a[112:115], v2, s[8:11], s22 offen offset:0 sc1
  buffer_load_dwordx4 a[116:119], v2, s[8:11], s22 offen offset:1024 sc1
  buffer_load_dwordx4 a[120:123], v2, s[8:11], s22 offen offset:2048 sc1
  buffer_load_dwordx4 a[124:127], v2, s[8:11], s22 offen offset:3072 sc1
  s_waitcnt vmcnt(24)
  s_add_u32 s22, s31, 32768
  buffer_load_dwordx4 a[128:131], v2, s[8:11], s22 offen offset:0 sc1
  buffer_load_dwordx4 a[132:135], v2, s[8:11], s22 offen offset:1024 sc1
  buffer_load_dwordx4 a[136:139], v2, s[8:11], s22 offen offset:2048 sc1
  buffer_load_dwordx4 a[140:143], v2, s[8:11], s22 offen offset:3072 sc1
  s_add_u32 s22, s31, 36864
  buffer_load_dwordx4 a[144:147], v2, s[8:11], s22 offen offset:0 sc1
  buffer_load_dwordx4 a[148:151], v2, s[8:11], s22 offen offset:1024 sc1
  buffer_load_dwordx4 a[152:155], v2, s[8:11], s22 offen offset:2048 sc1
  buffer_load_dwordx4 a[156:159], v2, s[8:11], s22 offen offset:3072 sc1
  s_add_u32 s22, s31, 40960
  buffer_load_dwordx4 a[160:163], v2, s[8:11], s22 offen offset:0 sc1
  buffer_load_dwordx4 a[164:167], v2, s[8:11], s22 offen offset:1024 sc1
  buffer_load_dwordx4 a[168:171], v2, s[8:11], s22 offen offset:2048 sc1
  buffer_load_dwordx4 a[172:175], v2, s[8:11], s22 offen offset:3072 sc1
  s_add_u32 s22, s31, 45056
  buffer_load_dwordx4 a[176:179], v2, s[8:11], s22 offen offset:0 sc1
  buffer_load_dwordx4 a[180:183], v2, s[8:11], s22 offen offset:1024 sc1
  buffer_load_dwordx4 a[184:187], v2, s[8:11], s22 offen offset:2048 sc1
  buffer_load_dwordx4 a[188:191], v2, s[8:11], s22 offen offset:3072 sc1
  s_add_u32 s22, s31, 49152
  buffer_load_dwordx4 a[192:195], v2, s[8:11], s22 offen offset:0 sc1
  buffer_load_dwordx4 a[196:199], v2, s[8:11], s22 offen offset:1024 sc1
  buffer_load_dwordx4 a[200:203], v2, s[8:11], s22 offen offset:2048 sc1
  buffer_load_dwordx4 a[204:207], v2, s[8:11], s22 offen offset:3072 sc1
  s_add_u32 s22, s31, 53248
  buffer_load_dwordx4 a[208:211], v2, s[8:11], s22 offen offset:0 sc1
  buffer_load_dwordx4 a[212:215], v2, s[8:11], s22 offen offset:1024 sc1
  buffer_load_dwordx4 a[216:219], v2, s[8:11], s22 offen offset:2048 sc1
  buffer_load_dwordx4 a[220:223], v2, s[8:11], s22 offen offset:3072 sc1
  s_add_u32 s22, s31, 57344
  buffer_load_dwordx4 a[224:227], v2, s[8:11], s22 offen offset:0 sc1
  buffer_load_dwordx4 a[228:231], v2, s[8:11], s22 offen offset:1024 sc1
  buffer_load_dwordx4 a[232:235], v2, s[8:11], s22 offen offset:2048 sc1
  buffer_load_dwordx4 a[236:239], v2, s[8:11], s22 offen offset:3072 sc1
  s_add_u32 s22, s31, 61440
  buffer_load_dwordx4 a[240:243], v2, s[8:11], s22 offen offset:0 sc1
  buffer_load_dwordx4 a[244:247], v2, s[8:11], s22 offen offset:1024 sc1
  buffer_load_dwordx4 a[248:251], v2, s[8:11], s22 offen offset:2048 sc1
  buffer_load_dwordx4 a[252:255], v2, s[8:11], s22 offen offset:3072 sc1
  s_waitcnt vmcnt(24)
  s_add_u32 s22, s31, 65536
  buffer_load_dwordx4 v[176:179], v2, s[8:11], s22 offen offset:0 sc1
  buffer_load_dwordx4 v[180:183], v2, s[8:11], s22 offen offset:1024 sc1
  buffer_load_dwordx4 v[184:187], v2, s[8:11], s22 offen offset:2048 sc1
  buffer_load_dwordx4 v[188:191], v2, s[8:11], s22 offen offset:3072 sc1
  s_add_u32 s22, s31, 69632
  buffer_load_dwordx4 v[192:195], v2, s[8:11], s22 offen offset:0 sc1
  buffer_load_dwordx4 v[196:199], v2, s[8:11], s22 offen offset:1024 sc1
  buffer_load_dwordx4 v[200:203], v2, s[8:11], s22 offen offset:2048 sc1
  buffer_load_dwordx4 v[204:207], v2, s[8:11], s22 offen offset:3072 sc1
  s_add_u32 s22, s31, 73728
  buffer_load_dwordx4 v[208:211], v2, s[8:11], s22 offen offset:0 sc1
  buffer_load_dwordx4 v[212:215], v2, s[8:11], s22 offen offset:1024 sc1
  buffer_load_dwordx4 v[216:219], v2, s[8:11], s22 offen offset:2048 sc1
  buffer_load_dwordx4 v[220:223], v2, s[8:11], s22 offen offset:3072 sc1
  s_add_u32 s22, s31, 77824
  buffer_load_dwordx4 v[224:227], v2, s[8:11], s22 offen offset:0 sc1
  buffer_load_dwordx4 v[228:231], v2, s[8:11], s22 offen offset:1024 sc1
  buffer_load_dwordx4 v[232:235], v2, s[8:11], s22 offen offset:2048 sc1
  buffer_load_dwordx4 v[236:239], v2, s[8:11], s22 offen offset:3072 sc1
  s_add_u32 s22, s31, 81920
  buffer_load_dwordx4 v[240:243], v2, s[8:11], s22 offen offset:0 sc1
  buffer_load_dwordx4 v[244:247], v2, s[8:11], s22 offen offset:1024 sc1
  buffer_load_dwordx4 v[248:251], v2, s[8:11], s22 offen offset:2048 sc1
  buffer_load_dwordx4 v[252:255], v2, s[8:11], s22 offen offset:3072 sc1
  s_mov_b32 m0, 30720
  s_add_u32 s22, s31, 86016
  buffer_load_dwordx4 v2, s[8:11], s22 offen offset:0 sc1 lds
  buffer_load_dwordx4 v2, s[8:11], s22 offen offset:1024 sc1 lds
  buffer_load_dwordx4 v2, s[8:11], s22 offen offset:2048 sc1 lds
  buffer_load_dwordx4 v2, s[8:11], s22 offen offset:3072 sc1 lds
  s_mov_b32 m0, 34816
  s_add_u32 s22, s31, 90112
  buffer_load_dwordx4 v2, s[8:11], s22 offen offset:0 sc1 lds
  buffer_load_dwordx4 v2, s[8:11], s22 offen offset:1024 sc1 lds
  buffer_load_dwordx4 v2, s[8:11], s22 offen offset:2048 sc1 lds
  buffer_load_dwordx4 v2, s[8:11], s22 offen offset:3072 sc1 lds
  s_mov_b32 m0, 38912
  s_add_u32 s22, s31, 94208
  buffer_load_dwordx4 v2, s[8:11], s22 offen offset:0 sc1 lds
  buffer_load_dwordx4 v2, s[8:11], s22 offen offset:1024 sc1 lds
  buffer_load_dwordx4 v2, s[8:11], s22 offen offset:2048 sc1 lds
  buffer_load_dwordx4 v2, s[8:11], s22 offen offset:3072 sc1 lds
  s_mov_b32 m0, 43008
  s_add_u32 s22, s31, 98304
  buffer_load_dwordx4 v2, s[8:11], s22 offen offset:0 sc1 lds
  buffer_load_dwordx4 v2, s[8:11], s22 offen offset:1024 sc1 lds
  s_mov_b32 s30, 0
ch_ws5:
  buffer_load_dword v9, off, s[12:15], 0 offset:132 sc1
  s_waitcnt vmcnt(0)
  v_cmp_ne_u32 vcc, 1, v9
  s_cbranch_vccz ch_ws5_ok
  s_sleep 8
  s_add_u32 s30, s30, 1
  s_cmp_lt_u32 s30, 400000
  s_cbranch_scc1 ch_ws5
  s_branch cA_abort
ch_ws5_ok:
  s_mul_i32 s33, s17, 532480
  s_add_u32 s33, s33, 78111744
  v_mov_b32 v12, -1
  v_mov_b32 v13, -1
  v_mov_b32 v14, -1
  v_mov_b32 v15, -1
  s_add_u32 s22, s33, 0
  buffer_store_dwordx4 v[12:15], v2, s[8:11], s22 offen sc1
  s_add_u32 s22, s33, 2048
  buffer_store_dwordx4 v[12:15], v2, s[8:11], s22 offen sc1
  s_add_u32 s22, s33, 4096
  buffer_store_dwordx4 v[12:15], v2, s[8:11], s22 offen sc1
  s_add_u32 s22, s33, 6144
  buffer_store_dwordx4 v[12:15], v2, s[8:11], s22 offen sc1
  s_add_u32 s22, s33, 8192
  buffer_store_dwordx4 v[12:15], v2, s[8:11], s22 offen sc1
  s_add_u32 s22, s33, 10240
  buffer_store_dwordx4 v[12:15], v2, s[8:11], s22 offen sc1
  s_add_u32 s22, s33, 12288
  buffer_store_dwordx4 v[12:15], v2, s[8:11], s22 offen sc1
  s_add_u32 s22, s33, 14336
  buffer_store_dwordx4 v[12:15], v2, s[8:11], s22 offen sc1
  v_mov_b32 v16, 1
  v_mov_b32 v17, 1
  s_lshl_b32 s22, s17, 10
  s_add_u32 s22, s22, 566248
  s_waitcnt vmcnt(0)
  s_mov_b64 exec, 3
  buffer_store_dwordx2 v[16:17], v2, s[8:11], s22 offen sc1
  s_mov_b64 exec, -1
  s_mov_b32 s28, s35
  s_waitcnt vmcnt(0) lgkmcnt(0)
  s_mov_b32 s31, 0
  s_cmp_lg_u32 s88, 0
  s_cbranch_scc1 cB_va1_loop
  s_branch cA_va1_loop
ch_init6:
  v_mov_b32 v72, v116
  v_mov_b32 v73, v117
  v_lshrrev_b32 v65, 1, v72
  v_and_b32 v66, 1, v72
  v_mov_b32 v36, 0
  v_mov_b32 v37, 0
  v_mov_b32 v38, 0
  v_mov_b32 v39, 0
  v_mov_b32 v40, 0
  v_mov_b32 v41, 0
  v_mov_b32 v42, 0
  v_mov_b32 v43, 0
  v_mov_b32 v44, 0
  v_mov_b32 v45, 0
  v_mov_b32 v46, 0
  v_mov_b32 v47, 0
  v_mov_b32 v48, 0
  v_mov_b32 v49, 0
  v_mov_b32 v50, 0
  v_mov_b32 v51, 0
  v_mov_b32 v52, 0
  v_mov_b32 v53, 0
  v_mov_b32 v54, 0
  v_mov_b32 v55, 0
  v_mov_b32 v56, 0
  v_mov_b32 v57, 0
  v_mov_b32 v58, 0
  v_mov_b32 v59, 0
  v_mov_b32 v60, 0
  v_mov_b32 v61, 0
  v_mov_b32 v62, 0
  v_mov_b32 v63, 0
  v_lshlrev_b32 v75, 2, v65
  v_lshl_add_u32 v75, v66, 3, v75
  v_add_u32 v67, 224, v73
  v_mul_u32_u24 v68, 2341, v67
  v_lshrrev_b32 v68, 16, v68
  v_mul_u32_u24 v69, 28, v68
  v_sub_u32 v69, v67, v69
  v_lshrrev_b32 v70, 4, v69
  v_and_b32 v69, 15, v69
  v_lshlrev_b32 v71, 12, v70
  v_lshl_add_u32 v71, v68, 8, v71
  v_lshl_add_u32 v71, v69, 4, v71
  v_add_u32 v104, v71, v75
  v_add_u32 v67, 240, v73
  v_mul_u32_u24 v68, 2341, v67
  v_lshrrev_b32 v68, 16, v68
  v_mul_u32_u24 v69, 28, v68
  v_sub_u32 v69, v67, v69
  v_lshrrev_b32 v70, 4, v69
  v_and_b32 v69, 15, v69
  v_lshlrev_b32 v71, 12, v70
  v_lshl_add_u32 v71, v68, 8, v71
  v_lshl_add_u32 v71, v69, 4, v71
  v_add_u32 v105, v71, v75
  v_add_u32 v67, 256, v73
  v_mul_u32_u24 v68, 2341, v67
  v_lshrrev_b32 v68, 16, v68
  v_mul_u32_u24 v69, 28, v68
  v_sub_u32 v69, v67, v69
  v_lshrrev_b32 v70, 4, v69
  v_and_b32 v69, 15, v69
  v_lshlrev_b32 v71, 12, v70
  v_lshl_add_u32 v71, v68, 8, v71
  v_lshl_add_u32 v71, v69, 4, v71
  v_add_u32 v106, v71, v75
  v_add_u32 v67, 272, v73
  v_mul_u32_u24 v68, 2341, v67
  v_lshrrev_b32 v68, 16, v68
  v_mul_u32_u24 v69, 28, v68
  v_sub_u32 v69, v67, v69
  v_lshrrev_b32 v70, 4, v69
  v_and_b32 v69, 15, v69
  v_lshlrev_b32 v71, 12, v70
  v_lshl_add_u32 v71, v68, 8, v71
  v_lshl_add_u32 v71, v69, 4, v71
  v_add_u32 v107, v71, v75
  v_add_u32 v67, 288, v73
  v_mul_u32_u24 v68, 2341, v67
  v_lshrrev_b32 v68, 16, v68
  v_mul_u32_u24 v69, 28, v68
  v_sub_u32 v69, v67, v69
  v_lshrrev_b32 v70, 4, v69
  v_and_b32 v69, 15, v69
  v_lshlrev_b32 v71, 12, v70
  v_lshl_add_u32 v71, v68, 8, v71
  v_lshl_add_u32 v71, v69, 4, v71
  v_add_u32 v108, v71, v75
  v_add_u32 v67, 304, v73
  v_mul_u32_u24 v68, 2341, v67
  v_lshrrev_b32 v68, 16, v68
  v_mul_u32_u24 v69, 28, v68
  v_sub_u32 v69, v67, v69
  v_lshrrev_b32 v70, 4, v69
  v_and_b32 v69, 15, v69
  v_lshlrev_b32 v71, 12, v70
  v_lshl_add_u32 v71, v68, 8, v71
  v_lshl_add_u32 v71, v69, 4, v71
  v_add_u32 v109, v71, v75
  v_add_u32 v67, 320, v73
  v_mul_u32_u24 v68, 2341, v67
  v_lshrrev_b32 v68, 16, v68
  v_mul_u32_u24 v69, 28, v68
  v_sub_u32 v69, v67, v69
  v_lshrrev_b32 v70, 4, v69
  v_and_b32 v69, 15, v69
  v_lshlrev_b32 v71, 12, v70
  v_lshl_add_u32 v71, v68, 8, v71
  v_lshl_add_u32 v71, v69, 4, v71
  v_add_u32 v110, v71, v75
  v_add_u32 v67, 96, v73
  v_mul_u32_u24 v68, 2341, v67
  v_lshrrev_b32 v68, 16, v68
  v_mul_u32_u24 v69, 28, v68
  v_sub_u32 v69, v67, v69
  v_lshrrev_b32 v70, 4, v69
  v_and_b32 v69, 15, v69
  v_lshlrev_b32 v71, 12, v70
  v_lshl_add_u32 v71, v68, 8, v71
  v_lshl_add_u32 v71, v69, 4, v71
  v_add_u32 v111, v71, v75
  v_mov_b32 v74, 0x40000000
  v_mov_b32 v96, 0
  v_add_u32 v0, 16384, v2
  v_and_b32 v119, 15, v1
  s_and_b32 s22, s17, 0
  s_lshl_b32 s22, s22, 7
  s_add_u32 s22, s22, 39424
  v_lshl_add_u32 v119, v119, 2, s22
  s_lshl_b32 s22, s17, 2
  s_add_u32 s22, s22, 37376
  v_lshl_add_u32 v118, v1, 7, s22
  v_cmp_gt_u32 vcc, 1, v1
  s_nop 1
  v_cndmask_b32 v118, v74, v118, vcc
  s_lshl_b32 s35, s17, 7
  s_add_u32 s35, s35, 524288
  v_mov_b32 v64, 0
  v_mov_b32 v65, 0
  v_mov_b32 v66, 0
  v_mov_b32 v67, 0
  v_min_u32 v116, 13, v1
  s_mul_i32 s22, s17, 14
  v_add_u32 v116, s22, v116
  v_lshlrev_b32 v116, 7, v116
  s_mul_i32 s31, s17, 401408
  s_add_u32 s31, s31, 40177664
  s_mov_b32 s30, 0
ch_wr6:
  buffer_load_dword v9, off, s[12:15], 0 offset:128 sc1
  s_waitcnt vmcnt(0)
  v_cmp_ne_u32 vcc, 1, v9
  s_cbranch_vccz ch_wr6_ok
  s_sleep 8
  s_add_u32 s30, s30, 1
  s_cmp_lt_u32 s30, 400000
  s_cbranch_scc1 ch_wr6
  s_branch cA_abort
ch_wr6_ok:
  s_lshr_b32 s22, s17, 2
  s_lshl_b32 s28, 0x81, s22
  s_mul_i32 s27, s17, 12
  s_add_u32 s22, s27, 256
  s_lshr_b32 s22, s22, 6
  s_lshl_b32 s22, 0x81, s22
  s_or_b32 s28, s28, s22
  s_add_u32 s22, s27, 267
  s_lshr_b32 s22, s22, 6
  s_lshl_b32 s22, 0x81, s22
  s_or_b32 s28, s28, s22
  v_lshrrev_b32 v12, 8, v2
  v_lshlrev_b32 v12, 7, v12
  s_mov_b32 s27, 583168
  s_mov_b32 s30, 0
ch_ww6:
  buffer_load_dword v9, v12, s[8:11], s27 offen sc1
  s_waitcnt vmcnt(0)
  v_and_b32 v10, s28, v9
  v_cmp_ne_u32 vcc, s28, v10
  s_cbranch_vccz ch_ww6_ok
  s_sleep 3
  s_add_u32 s30, s30, 1
  s_cmp_lt_u32 s30, 400000
  s_cbranch_scc1 ch_ww6
  s_branch cA_abort
ch_ww6_ok:
  s_add_u32 s22, s31, 0
  buffer_load_dwordx4 a[0:3], v2, s[8:11], s22 offen offset:0 sc1
  buffer_load_dwordx4 a[4:7], v2, s[8:11], s22 offen offset:1024 sc1
  buffer_load_dwordx4 a[8:11], v2, s[8:11], s22 offen offset:2048 sc1
  buffer_load_dwordx4 a[12:15], v2, s[8:11], s22 offen offset:3072 sc1
  s_add_u32 s22, s31, 4096
  buffer_load_dwordx4 a[16:19], v2, s[8:11], s22 offen offset:0 sc1
  buffer_load_dwordx4 a[20:23], v2, s[8:11], s22 offen offset:1024 sc1
  buffer_load_dwordx4 a[24:27], v2, s[8:11], s22 offen offset:2048 sc1
  buffer_load_dwordx4 a[28:31], v2, s[8:11], s22 offen offset:3072 sc1
  s_add_u32 s22, s31, 8192
  buffer_load_dwordx4 a[32:35], v2, s[8:11], s22 offen offset:0 sc1
  buffer_load_dwordx4 a[36:39], v2, s[8:11], s22 offen offset:1024 sc1
  buffer_load_dwordx4 a[40:43], v2, s[8:11], s22 offen offset:2048 sc1
  buffer_load_dwordx4 a[44:47], v2, s[8:11], s22 offen offset:3072 sc1
  s_add_u32 s22, s31, 12288
  buffer_load_dwordx4 a[48:51], v2, s[8:11], s22 offen offset:0 sc1
  buffer_load_dwordx4 a[52:55], v2, s[8:11], s22 offen offset:1024 sc1
  buffer_load_dwordx4 a[56:59], v2, s[8:11], s22 offen offset:2048 sc1
  buffer_load_dwordx4 a[60:63], v2, s[8:11], s22 offen offset:3072 sc1
  s_add_u32 s22, s31, 16384
  buffer_load_dwordx4 a[64:67], v2, s[8:11], s22 offen offset:0 sc1
  buffer_load_dwordx4 a[68:71], v2, s[8:11], s22 offen offset:1024 sc1
  buffer_load_dwordx4 a[72:75], v2, s[8:11], s22 offen offset:2048 sc1
  buffer_load_dwordx4 a[76:79], v2, s[8:11], s22 offen offset:3072 sc1
  s_add_u32 s22, s31, 20480
  buffer_load_dwordx4 a[80:83], v2, s[8:11], s22 offen offset:0 sc1
  buffer_load_dwordx4 a[84:87], v2, s[8:11], s22 offen offset:1024 sc1
  buffer_load_dwordx4 a[88:91], v2, s[8:11], s22 offen offset:2048 sc1
  buffer_load_dwordx4 a[92:95], v2, s[8:11], s22 offen offset:3072 sc1
  s_add_u32 s22, s31, 24576
  buffer_load_dwordx4 a[96:99], v2, s[8:11], s22 offen offset:0 sc1
  buffer_load_dwordx4 a[100:103], v2, s[8:11], s22 offen offset:1024 sc1
  buffer_load_dwordx4 a[104:107], v2, s[8:11], s22 offen offset:2048 sc1
  buffer_load_dwordx4 a[108:111], v2, s[8:11], s22 offen offset:3072 sc1
  s_add_u32 s22, s31, 28672
  buffer_load_dwordx4 a[112:115], v2, s[8:11], s22 offen offset:0 sc1
  buffer_load_dwordx4 a[116:119], v2, s[8:11], s22 offen offset:1024 sc1
  buffer_load_dwordx4 a[120:123], v2, s[8:11], s22 offen offset:2048 sc1
  buffer_load_dwordx4 a[124:127], v2, s[8:11], s22 offen offset:3072 sc1
  s_waitcnt vmcnt(24)
  s_add_u32 s22, s31, 32768
  buffer_load_dwordx4 a[128:131], v2, s[8:11], s22 offen offset:0 sc1
  buffer_load_dwordx4 a[132:135], v2, s[8:11], s22 offen offset:1024 sc1
  buffer_load_dwordx4 a[136:139], v2, s[8:11], s22 offen offset:2048 sc1
  buffer_load_dwordx4 a[140:143], v2, s[8:11], s22 offen offset:3072 sc1
  s_add_u32 s22, s31, 36864
  buffer_load_dwordx4 a[144:147], v2, s[8:11], s22 offen offset:0 sc1
  buffer_load_dwordx4 a[148:151], v2, s[8:11], s22 offen offset:1024 sc1
  buffer_load_dwordx4 a[152:155], v2, s[8:11], s22 offen offset:2048 sc1
  buffer_load_dwordx4 a[156:159], v2, s[8:11], s22 offen offset:3072 sc1
  s_add_u32 s22, s31, 40960
  buffer_load_dwordx4 a[160:163], v2, s[8:11], s22 offen offset:0 sc1
  buffer_load_dwordx4 a[164:167], v2, s[8:11], s22 offen offset:1024 sc1
  buffer_load_dwordx4 a[168:171], v2, s[8:11], s22 offen offset:2048 sc1
  buffer_load_dwordx4 a[172:175], v2, s[8:11], s22 offen offset:3072 sc1
  s_add_u32 s22, s31, 45056
  buffer_load_dwordx4 a[176:179], v2, s[8:11], s22 offen offset:0 sc1
  buffer_load_dwordx4 a[180:183], v2, s[8:11], s22 offen offset:1024 sc1
  buffer_load_dwordx4 a[184:187], v2, s[8:11], s22 offen offset:2048 sc1
  buffer_load_dwordx4 a[188:191], v2, s[8:11], s22 offen offset:3072 sc1
  s_add_u32 s22, s31, 49152
  buffer_load_dwordx4 a[192:195], v2, s[8:11], s22 offen offset:0 sc1
  buffer_load_dwordx4 a[196:199], v2, s[8:11], s22 offen offset:1024 sc1
  buffer_load_dwordx4 a[200:203], v2, s[8:11], s22 offen offset:2048 sc1
  buffer_load_dwordx4 a[204:207], v2, s[8:11], s22 offen offset:3072 sc1
  s_add_u32 s22, s31, 53248
  buffer_load_dwordx4 a[208:211], v2, s[8:11], s22 offen offset:0 sc1
  buffer_load_dwordx4 a[212:215], v2, s[8:11], s22 offen offset:1024 sc1
  buffer_load_dwordx4 a[216:219], v2, s[8:11], s22 offen offset:2048 sc1
  buffer_load_dwordx4 a[220:223], v2, s[8:11], s22 offen offset:3072 sc1
  s_add_u32 s22, s31, 57344
  buffer_load_dwordx4 a[224:227], v2, s[8:11], s22 offen offset:0 sc1
  buffer_load_dwordx4 a[228:231], v2, s[8:11], s22 offen offset:1024 sc1
  buffer_load_dwordx4 a[232:235], v2, s[8:11], s22 offen offset:2048 sc1
  buffer_load_dwordx4 a[236:239], v2, s[8:11], s22 offen offset:3072 sc1
  s_add_u32 s22, s31, 61440
  buffer_load_dwordx4 a[240:243], v2, s[8:11], s22 offen offset:0 sc1
  buffer_load_dwordx4 a[244:247], v2, s[8:11], s22 offen offset:1024 sc1
  buffer_load_dwordx4 a[248:251], v2, s[8:11], s22 offen offset:2048 sc1
  buffer_load_dwordx4 a[252:255], v2, s[8:11], s22 offen offset:3072 sc1
  s_waitcnt vmcnt(24)
  s_add_u32 s22, s31, 65536
  buffer_load_dwordx4 v[120:123], v2, s[8:11], s22 offen offset:0 sc1
  buffer_load_dwordx4 v[124:127], v2, s[8:11], s22 offen offset:1024 sc1
  buffer_load_dwordx4 v[128:131], v2, s[8:11], s22 offen offset:2048 sc1
  buffer_load_dwordx4 v[132:135], v2, s[8:11], s22 offen offset:3072 sc1
  s_add_u32 s22, s31, 69632
  buffer_load_dwordx4 v[136:139], v2, s[8:11], s22 offen offset:0 sc1
  buffer_load_dwordx4 v[140:143], v2, s[8:11], s22 offen offset:1024 sc1
  buffer_load_dwordx4 v[144:147], v2, s[8:11], s22 offen offset:2048 sc1
  buffer_load_dwordx4 v[148:151], v2, s[8:11], s22 offen offset:3072 sc1
  s_add_u32 s22, s31, 73728
  buffer_load_dwordx4 v[152:155], v2, s[8:11], s22 offen offset:0 sc1
  buffer_load_dwordx4 v[156:159], v2, s[8:11], s22 offen offset:1024 sc1
  buffer_load_dwordx4 v[160:163], v2, s[8:11], s22 offen offset:2048 sc1
  buffer_load_dwordx4 v[164:167], v2, s[8:11], s22 offen offset:3072 sc1
  s_add_u32 s22, s31, 77824
  buffer_load_dwordx4 v[168:171], v2, s[8:11], s22 offen offset:0 sc1
  buffer_load_dwordx4 v[172:175], v2, s[8:11], s22 offen offset:1024 sc1
  buffer_load_dwordx4 v[176:179], v2, s[8:11], s22 offen offset:2048 sc1
  buffer_load_dwordx4 v[180:183], v2, s[8:11], s22 offen offset:3072 sc1
  s_add_u32 s22, s31, 81920
  buffer_load_dwordx4 v[184:187], v2, s[8:11], s22 offen offset:0 sc1
  buffer_load_dwordx4 v[188:191], v2, s[8:11], s22 offen offset:1024 sc1
  buffer_load_dwordx4 v[192:195], v2, s[8:11], s22 offen offset:2048 sc1
  buffer_load_dwordx4 v[196:199], v2, s[8:11], s22 offen offset:3072 sc1
  s_add_u32 s22, s31, 86016
  buffer_load_dwordx4 v[200:203], v2, s[8:11], s22 offen offset:0 sc1
  buffer_load_dwordx4 v[204:207], v2, s[8:11], s22 offen offset:1024 sc1
  buffer_load_dwordx4 v[208:211], v2, s[8:11], s22 offen offset:2048 sc1
  buffer_load_dwordx4 v[212:215], v2, s[8:11], s22 offen offset:3072 sc1
  s_add_u32 s22, s31, 90112
  buffer_load_dwordx4 v[216:219], v2, s[8:11], s22 offen offset:0 sc1
  buffer_load_dwordx4 v[220:223], v2, s[8:11], s22 offen offset:1024 sc1
  buffer_load_dwordx4 v[224:227], v2, s[8:11], s22 offen offset:2048 sc1
  buffer_load_dwordx4 v[228:231], v2, s[8:11], s22 offen offset:3072 sc1
  s_add_u32 s22, s31, 94208
  buffer_load_dwordx4 v[232:235], v2, s[8:11], s22 offen offset:0 sc1
  buffer_load_dwordx4 v[236:239], v2, s[8:11], s22 offen offset:1024 sc1
  buffer_load_dwordx4 v[240:243], v2, s[8:11], s22 offen offset:2048 sc1
  buffer_load_dwordx4 v[244:247], v2, s[8:11], s22 offen offset:3072 sc1
  s_waitcnt vmcnt(24)
  s_add_u32 s22, s31, 98304
  buffer_load_dwordx4 v[248:251], v2, s[8:11], s22 offen offset:0 sc1
  buffer_load_dwordx4 v[252:255], v2, s[8:11], s22 offen offset:1024 sc1
  s_mov_b32 s30, 0
ch_ws6:
  buffer_load_dword v9, off, s[12:15], 0 offset:132 sc1
  s_waitcnt vmcnt(0)
  v_cmp_ne_u32 vcc, 1, v9
  s_cbranch_vccz ch_ws6_ok
  s_sleep 8
  s_add_u32 s30, s30, 1
  s_cmp_lt_u32 s30, 400000
  s_cbranch_scc1 ch_ws6
  s_branch cA_abort
ch_ws6_ok:
  s_lshl_b32 s27, s17, 7
  s_add_u32 s27, s27, 524288
  s_mov_b32 s30, 0
ch_vw2:
  buffer_load_dword v9, off, s[8:11], s27 sc1
  s_waitcnt vmcnt(0)
  v_cmp_ne_u32 vcc, 56, v9
  s_cbranch_vccz ch_vw2_d
  s_sleep 2
  s_add_u32 s30, s30, 1
  s_cmp_lt_u32 s30, 400000
  s_cbranch_scc1 ch_vw2
  s_branch cA_abort
ch_vw2_d:
  s_mov_b32 s28, s35
  s_waitcnt vmcnt(0) lgkmcnt(0)
  s_mov_b32 s31, 0
  s_cmp_lg_u32 s88, 0
  s_cbranch_scc1 cB_va2_loop
  s_branch cA_va2_loop
ch_init7:
  v_mov_b32 v72, v116
  v_mov_b32 v73, v117
  v_lshrrev_b32 v65, 1, v72
  v_and_b32 v66, 1, v72
  v_mov_b32 v36, 0
  v_mov_b32 v37, 0
  v_mov_b32 v38, 0
  v_mov_b32 v39, 0
  v_mov_b32 v40, 0
  v_mov_b32 v41, 0
  v_mov_b32 v42, 0
  v_mov_b32 v43, 0
  v_mov_b32 v44, 0
  v_mov_b32 v45, 0
  v_mov_b32 v46, 0
  v_mov_b32 v47, 0
  v_mov_b32 v48, 0
  v_mov_b32 v49, 0
  v_mov_b32 v50, 0
  v_mov_b32 v51, 0
  v_mov_b32 v52, 0
  v_mov_b32 v53, 0
  v_mov_b32 v54, 0
  v_mov_b32 v55, 0
  v_mov_b32 v56, 0
  v_mov_b32 v57, 0
  v_mov_b32 v58, 0
  v_mov_b32 v59, 0
  v_mov_b32 v60, 0
  v_mov_b32 v61, 0
  v_mov_b32 v62, 0
  v_mov_b32 v63, 0
  v_lshlrev_b32 v75, 2, v65
  v_lshl_add_u32 v75, v66, 3, v75
  v_add_u32 v67, 336, v73
  v_mul_u32_u24 v68, 2341, v67
  v_lshrrev_b32 v68, 16, v68
  v_mul_u32_u24 v69, 28, v68
  v_sub_u32 v69, v67, v69
  v_lshrrev_b32 v70, 4, v69
  v_and_b32 v69, 15, v69
  v_lshlrev_b32 v71, 12, v70
  v_lshl_add_u32 v71, v68, 8, v71
  v_lshl_add_u32 v71, v69, 4, v71
  v_add_u32 v104, v71, v75
  v_add_u32 v67, 352, v73
  v_mul_u32_u24 v68, 2341, v67
  v_lshrrev_b32 v68, 16, v68
  v_mul_u32_u24 v69, 28, v68
  v_sub_u32 v69, v67, v69
  v_lshrrev_b32 v70, 4, v69
  v_and_b32 v69, 15, v69
  v_lshlrev_b32 v71, 12, v70
  v_lshl_add_u32 v71, v68, 8, v71
  v_lshl_add_u32 v71, v69, 4, v71
  v_add_u32 v105, v71, v75
  v_add_u32 v67, 368, v73
  v_mul_u32_u24 v68, 2341, v67
  v_lshrrev_b32 v68, 16, v68
  v_mul_u32_u24 v69, 28, v68
  v_sub_u32 v69, v67, v69
  v_lshrrev_b32 v70, 4, v69
  v_and_b32 v69, 15, v69
  v_lshlrev_b32 v71, 12, v70
  v_lshl_add_u32 v71, v68, 8, v71
  v_lshl_add_u32 v71, v69, 4, v71
  v_add_u32 v106, v71, v75
  v_add_u32 v67, 384, v73
  v_mul_u32_u24 v68, 2341, v67
  v_lshrrev_b32 v68, 16, v68
  v_mul_u32_u24 v69, 28, v68
  v_sub_u32 v69, v67, v69
  v_lshrrev_b32 v70, 4, v69
  v_and_b32 v69, 15, v69
  v_lshlrev_b32 v71, 12, v70
  v_lshl_add_u32 v71, v68, 8, v71
  v_lshl_add_u32 v71, v69, 4, v71
  v_add_u32 v107, v71, v75
  v_add_u32 v67, 400, v73
  v_mul_u32_u24 v68, 2341, v67
  v_lshrrev_b32 v68, 16, v68
  v_mul_u32_u24 v69, 28, v68
  v_sub_u32 v69, v67, v69
  v_lshrrev_b32 v70, 4, v69
  v_and_b32 v69, 15, v69
  v_lshlrev_b32 v71, 12, v70
  v_lshl_add_u32 v71, v68, 8, v71
  v_lshl_add_u32 v71, v69, 4, v71
  v_add_u32 v108, v71, v75
  v_add_u32 v67, 416, v73
  v_mul_u32_u24 v68, 2341, v67
  v_lshrrev_b32 v68, 16, v68
  v_mul_u32_u24 v69, 28, v68
  v_sub_u32 v69, v67, v69
  v_lshrrev_b32 v70, 4, v69
  v_and_b32 v69, 15, v69
  v_lshlrev_b32 v71, 12, v70
  v_lshl_add_u32 v71, v68, 8, v71
  v_lshl_add_u32 v71, v69, 4, v71
  v_add_u32 v109, v71, v75
  v_add_u32 v67, 432, v73
  v_mul_u32_u24 v68, 2341, v67
  v_lshrrev_b32 v68, 16, v68
  v_mul_u32_u24 v69, 28, v68
  v_sub_u32 v69, v67, v69
  v_lshrrev_b32 v70, 4, v69
  v_and_b32 v69, 15, v69
  v_lshlrev_b32 v71, 12, v70
  v_lshl_add_u32 v71, v68, 8, v71
  v_lshl_add_u32 v71, v69, 4, v71
  v_add_u32 v110, v71, v75
  v_mov_b32 v74, 0x40000000
  v_mov_b32 v96, 0
  v_and_b32 v119, 15, v1
  s_and_b32 s22, s17, 0
  s_lshl_b32 s22, s22, 7
  s_add_u32 s22, s22, 39424
  v_lshl_add_u32 v119, v119, 2, s22
  s_lshl_b32 s22, s17, 2
  s_add_u32 s22, s22, 37376
  v_lshl_add_u32 v118, v1, 7, s22
  v_cmp_gt_u32 vcc, 1, v1
  s_nop 1
  v_cndmask_b32 v118, v74, v118, vcc
  s_lshl_b32 s35, s17, 7
  s_add_u32 s35, s35, 524288
  v_mov_b32 v64, 0
  v_mov_b32 v65, 0
  v_mov_b32 v66, 0
  v_mov_b32 v67, 0
  v_min_u32 v116, 13, v1
  s_mul_i32 s22, s17, 14
  v_add_u32 v116, s22, v116
  v_lshlrev_b32 v116, 7, v116
  s_mul_i32 s31, s17, 401408
  s_add_u32 s31, s31, 40278016
  s_mov_b32 s30, 0
ch_wr7:
  buffer_load_dword v9, off, s[12:15], 0 offset:128 sc1
  s_waitcnt vmcnt(0)
  v_cmp_ne_u32 vcc, 1, v9
  s_cbranch_vccz ch_wr7_ok
  s_sleep 8
  s_add_u32 s30, s30, 1
  s_cmp_lt_u32 s30, 400000
  s_cbranch_scc1 ch_wr7
  s_branch cA_abort
ch_wr7_ok:
  s_lshr_b32 s22, s17, 2
  s_lshl_b32 s28, 0x81, s22
  s_mul_i32 s27, s17, 12
  s_add_u32 s22, s27, 256
  s_lshr_b32 s22, s22, 6
  s_lshl_b32 s22, 0x81, s22
  s_or_b32 s28, s28, s22
  s_add_u32 s22, s27, 267
  s_lshr_b32 s22, s22, 6
  s_lshl_b32 s22, 0x81, s22
  s_or_b32 s28, s28, s22
  v_lshrrev_b32 v12, 8, v2
  v_lshlrev_b32 v12, 7, v12
  s_mov_b32 s27, 583680
  s_mov_b32 s30, 0
ch_ww7:
  buffer_load_dword v9, v12, s[8:11], s27 offen sc1
  s_waitcnt vmcnt(0)
  v_and_b32 v10, s28, v9
  v_cmp_ne_u32 vcc, s28, v10
  s_cbranch_vccz ch_ww7_ok
  s_sleep 3
  s_add_u32 s30, s30, 1
  s_cmp_lt_u32 s30, 400000
  s_cbranch_scc1 ch_ww7
  s_branch cA_abort
ch_ww7_ok:
  s_add_u32 s22, s31, 0
  buffer_load_dwordx4 a[0:3], v2, s[8:11], s22 offen offset:0 sc1
  buffer_load_dwordx4 a[4:7], v2, s[8:11], s22 offen offset:1024 sc1
  buffer_load_dwordx4 a[8:11], v2, s[8:11], s22 offen offset:2048 sc1
  buffer_load_dwordx4 a[12:15], v2, s[8:11], s22 offen offset:3072 sc1
  s_add_u32 s22, s31, 4096
  buffer_load_dwordx4 a[16:19], v2, s[8:11], s22 offen offset:0 sc1
  buffer_load_dwordx4 a[20:23], v2, s[8:11], s22 offen offset:1024 sc1
  buffer_load_dwordx4 a[24:27], v2, s[8:11], s22 offen offset:2048 sc1
  buffer_load_dwordx4 a[28:31], v2, s[8:11], s22 offen offset:3072 sc1
  s_add_u32 s22, s31, 8192
  buffer_load_dwordx4 a[32:35], v2, s[8:11], s22 offen offset:0 sc1
  buffer_load_dwordx4 a[36:39], v2, s[8:11], s22 offen offset:1024 sc1
  buffer_load_dwordx4 a[40:43], v2, s[8:11], s22 offen offset:2048 sc1
  buffer_load_dwordx4 a[44:47], v2, s[8:11], s22 offen offset:3072 sc1
  s_add_u32 s22, s31, 12288
  buffer_load_dwordx4 a[48:51], v2, s[8:11], s22 offen offset:0 sc1
  buffer_load_dwordx4 a[52:55], v2, s[8:11], s22 offen offset:1024 sc1
  buffer_load_dwordx4 a[56:59], v2, s[8:11], s22 offen offset:2048 sc1
  buffer_load_dwordx4 a[60:63], v2, s[8:11], s22 offen offset:3072 sc1
  s_add_u32 s22, s31, 16384
  buffer_load_dwordx4 a[64:67], v2, s[8:11], s22 offen offset:0 sc1
  buffer_load_dwordx4 a[68:71], v2, s[8:11], s22 offen offset:1024 sc1
  buffer_load_dwordx4 a[72:75], v2, s[8:11], s22 offen offset:2048 sc1
  buffer_load_dwordx4 a[76:79], v2, s[8:11], s22 offen offset:3072 sc1
  s_add_u32 s22, s31, 20480
  buffer_load_dwordx4 a[80:83], v2, s[8:11], s22 offen offset:0 sc1
  buffer_load_dwordx4 a[84:87], v2, s[8:11], s22 offen offset:1024 sc1
  buffer_load_dwordx4 a[88:91], v2, s[8:11], s22 offen offset:2048 sc1
  buffer_load_dwordx4 a[92:95], v2, s[8:11], s22 offen offset:3072 sc1
  s_add_u32 s22, s31, 24576
  buffer_load_dwordx4 a[96:99], v2, s[8:11], s22 offen offset:0 sc1
  buffer_load_dwordx4 a[100:103], v2, s[8:11], s22 offen offset:1024 sc1
  buffer_load_dwordx4 a[104:107], v2, s[8:11], s22 offen offset:2048 sc1
  buffer_load_dwordx4 a[108:111], v2, s[8:11], s22 offen offset:3072 sc1
  s_add_u32 s22, s31, 28672
  buffer_load_dwordx4 a[112:115], v2, s[8:11], s22 offen offset:0 sc1
  buffer_load_dwordx4 a[116:119], v2, s[8:11], s22 offen offset:1024 sc1
  buffer_load_dwordx4 a[120:123], v2, s[8:11], s22 offen offset:2048 sc1
  buffer_load_dwordx4 a[124:127], v2, s[8:11], s22 offen offset:3072 sc1
  s_waitcnt vmcnt(24)
  s_add_u32 s22, s31, 32768
  buffer_load_dwordx4 a[128:131], v2, s[8:11], s22 offen offset:0 sc1
  buffer_load_dwordx4 a[132:135], v2, s[8:11], s22 offen offset:1024 sc1
  buffer_load_dwordx4 a[136:139], v2, s[8:11], s22 offen offset:2048 sc1
  buffer_load_dwordx4 a[140:143], v2, s[8:11], s22 offen offset:3072 sc1
  s_add_u32 s22, s31, 36864
  buffer_load_dwordx4 a[144:147], v2, s[8:11], s22 offen offset:0 sc1
  buffer_load_dwordx4 a[148:151], v2, s[8:11], s22 offen offset:1024 sc1
  buffer_load_dwordx4 a[152:155], v2, s[8:11], s22 offen offset:2048 sc1
  buffer_load_dwordx4 a[156:159], v2, s[8:11], s22 offen offset:3072 sc1
  s_add_u32 s22, s31, 40960
  buffer_load_dwordx4 a[160:163], v2, s[8:11], s22 offen offset:0 sc1
  buffer_load_dwordx4 a[164:167], v2, s[8:11], s22 offen offset:1024 sc1
  buffer_load_dwordx4 a[168:171], v2, s[8:11], s22 offen offset:2048 sc1
  buffer_load_dwordx4 a[172:175], v2, s[8:11], s22 offen offset:3072 sc1
  s_add_u32 s22, s31, 45056
  buffer_load_dwordx4 a[176:179], v2, s[8:11], s22 offen offset:0 sc1
  buffer_load_dwordx4 a[180:183], v2, s[8:11], s22 offen offset:1024 sc1
  buffer_load_dwordx4 a[184:187], v2, s[8:11], s22 offen offset:2048 sc1
  buffer_load_dwordx4 a[188:191], v2, s[8:11], s22 offen offset:3072 sc1
  s_add_u32 s22, s31, 49152
  buffer_load_dwordx4 a[192:195], v2, s[8:11], s22 offen offset:0 sc1
  buffer_load_dwordx4 a[196:199], v2, s[8:11], s22 offen offset:1024 sc1
  buffer_load_dwordx4 a[200:203], v2, s[8:11], s22 offen offset:2048 sc1
  buffer_load_dwordx4 a[204:207], v2, s[8:11], s22 offen offset:3072 sc1
  s_add_u32 s22, s31, 53248
  buffer_load_dwordx4 a[208:211], v2, s[8:11], s22 offen offset:0 sc1
  buffer_load_dwordx4 a[212:215], v2, s[8:11], s22 offen offset:1024 sc1
  buffer_load_dwordx4 a[216:219], v2, s[8:11], s22 offen offset:2048 sc1
  buffer_load_dwordx4 a[220:223], v2, s[8:11], s22 offen offset:3072 sc1
  s_add_u32 s22, s31, 57344
  buffer_load_dwordx4 a[224:227], v2, s[8:11], s22 offen offset:0 sc1
  buffer_load_dwordx4 a[228:231], v2, s[8:11], s22 offen offset:1024 sc1
  buffer_load_dwordx4 a[232:235], v2, s[8:11], s22 offen offset:2048 sc1
  buffer_load_dwordx4 a[236:239], v2, s[8:11], s22 offen offset:3072 sc1
  s_add_u32 s22, s31, 61440
  buffer_load_dwordx4 a[240:243], v2, s[8:11], s22 offen offset:0 sc1
  buffer_load_dwordx4 a[244:247], v2, s[8:11], s22 offen offset:1024 sc1
  buffer_load_dwordx4 a[248:251], v2, s[8:11], s22 offen offset:2048 sc1
  buffer_load_dwordx4 a[252:255], v2, s[8:11], s22 offen offset:3072 sc1
  s_waitcnt vmcnt(24)
  s_add_u32 s22, s31, 65536
  buffer_load_dwordx4 v[120:123], v2, s[8:11], s22 offen offset:0 sc1
  buffer_load_dwordx4 v[124:127], v2, s[8:11], s22 offen offset:1024 sc1
  buffer_load_dwordx4 v[128:131], v2, s[8:11], s22 offen offset:2048 sc1
  buffer_load_dwordx4 v[132:135], v2, s[8:11], s22 offen offset:3072 sc1
  s_add_u32 s22, s31, 69632
  buffer_load_dwordx4 v[136:139], v2, s[8:11], s22 offen offset:0 sc1
  buffer_load_dwordx4 v[140:143], v2, s[8:11], s22 offen offset:1024 sc1
  buffer_load_dwordx4 v[144:147], v2, s[8:11], s22 offen offset:2048 sc1
  buffer_load_dwordx4 v[148:151], v2, s[8:11], s22 offen offset:3072 sc1
  s_add_u32 s22, s31, 73728
  buffer_load_dwordx4 v[152:155], v2, s[8:11], s22 offen offset:0 sc1
  buffer_load_dwordx4 v[156:159], v2, s[8:11], s22 offen offset:1024 sc1
  buffer_load_dwordx4 v[160:163], v2, s[8:11], s22 offen offset:2048 sc1
  buffer_load_dwordx4 v[164:167], v2, s[8:11], s22 offen offset:3072 sc1
  s_add_u32 s22, s31, 77824
  buffer_load_dwordx4 v[168:171], v2, s[8:11], s22 offen offset:0 sc1
  buffer_load_dwordx4 v[172:175], v2, s[8:11], s22 offen offset:1024 sc1
  buffer_load_dwordx4 v[176:179], v2, s[8:11], s22 offen offset:2048 sc1
  buffer_load_dwordx4 v[180:183], v2, s[8:11], s22 offen offset:3072 sc1
  s_add_u32 s22, s31, 81920
  buffer_load_dwordx4 v[184:187], v2, s[8:11], s22 offen offset:0 sc1
  buffer_load_dwordx4 v[188:191], v2, s[8:11], s22 offen offset:1024 sc1
  buffer_load_dwordx4 v[192:195], v2, s[8:11], s22 offen offset:2048 sc1
  buffer_load_dwordx4 v[196:199], v2, s[8:11], s22 offen offset:3072 sc1
  s_add_u32 s22, s31, 86016
  buffer_load_dwordx4 v[200:203], v2, s[8:11], s22 offen offset:0 sc1
  buffer_load_dwordx4 v[204:207], v2, s[8:11], s22 offen offset:1024 sc1
  buffer_load_dwordx4 v[208:211], v2, s[8:11], s22 offen offset:2048 sc1
  buffer_load_dwordx4 v[212:215], v2, s[8:11], s22 offen offset:3072 sc1
  s_add_u32 s22, s31, 90112
  buffer_load_dwordx4 v[216:219], v2, s[8:11], s22 offen offset:0 sc1
  buffer_load_dwordx4 v[220:223], v2, s[8:11], s22 offen offset:1024 sc1
  buffer_load_dwordx4 v[224:227], v2, s[8:11], s22 offen offset:2048 sc1
  buffer_load_dwordx4 v[228:231], v2, s[8:11], s22 offen offset:3072 sc1
  s_add_u32 s22, s31, 94208
  buffer_load_dwordx4 v[232:235], v2, s[8:11], s22 offen offset:0 sc1
  buffer_load_dwordx4 v[236:239], v2, s[8:11], s22 offen offset:1024 sc1
  buffer_load_dwordx4 v[240:243], v2, s[8:11], s22 offen offset:2048 sc1
  buffer_load_dwordx4 v[244:247], v2, s[8:11], s22 offen offset:3072 sc1
  s_waitcnt vmcnt(24)
  s_add_u32 s22, s31, 98304
  buffer_load_dwordx4 v[248:251], v2, s[8:11], s22 offen offset:0 sc1
  buffer_load_dwordx4 v[252:255], v2, s[8:11], s22 offen offset:1024 sc1
  s_mov_b32 s30, 0
ch_ws7:
  buffer_load_dword v9, off, s[12:15], 0 offset:132 sc1
  s_waitcnt vmcnt(0)
  v_cmp_ne_u32 vcc, 1, v9
  s_cbranch_vccz ch_ws7_ok
  s_sleep 8
  s_add_u32 s30, s30, 1
  s_cmp_lt_u32 s30, 400000
  s_cbranch_scc1 ch_ws7
  s_branch cA_abort
ch_ws7_ok:
  s_lshl_b32 s27, s17, 7
  s_add_u32 s27, s27, 524288
  s_mov_b32 s30, 0
ch_vw3:
  buffer_load_dword v9, off, s[8:11], s27 sc1
  s_waitcnt vmcnt(0)
  v_cmp_ne_u32 vcc, 56, v9
  s_cbranch_vccz ch_vw3_d
  s_sleep 2
  s_add_u32 s30, s30, 1
  s_cmp_lt_u32 s30, 400000
  s_cbranch_scc1 ch_vw3
  s_branch cA_abort
ch_vw3_d:
  s_mov_b32 s28, s35
  s_mov_b32 s39, 684032
  buffer_load_dword v100, v116, s[8:11], s39 offen sc1
  s_mov_b32 s39, 712704
  s_waitcnt vmcnt(1) lgkmcnt(0)
  s_mov_b32 s31, 0
  s_cmp_lg_u32 s88, 0
  s_cbranch_scc1 cB_va3_loop
  s_branch cA_va3_loop
.p2align 6
cA_sc0_loop:
  s_mov_b32 s30, 0
  s_mov_b32 s62, 0
  s_setprio 3
  s_sleep 6
cA_sc0_fp_l:
  v_cmp_gt_u32 vcc, s19, v112
  buffer_load_dword v112, v0, s[8:11], 0 offen sc1
  s_cbranch_vccz cA_sc0_fp_d
  v_cmp_gt_u32 vcc, s19, v112
  buffer_load_dword v112, v0, s[8:11], 0 offen sc1
  s_cbranch_vccz cA_sc0_fp_d
  v_cmp_gt_u32 vcc, s19, v112
  buffer_load_dword v112, v0, s[8:11], 0 offen sc1
  s_cbranch_vccz cA_sc0_fp_d
  v_cmp_gt_u32 vcc, s19, v112
  buffer_load_dword v112, v0, s[8:11], 0 offen sc1
  s_cbranch_vccz cA_sc0_fp_d
  v_cmp_gt_u32 vcc, s19, v112
  buffer_load_dword v112, v0, s[8:11], 0 offen sc1
  s_cbranch_vccz cA_sc0_fp_d
  v_cmp_gt_u32 vcc, s19, v112
  buffer_load_dword v112, v0, s[8:11], 0 offen sc1
  s_cbranch_vccz cA_sc0_fp_d
  v_cmp_gt_u32 vcc, s19, v112
  buffer_load_dword v112, v0, s[8:11], 0 offen sc1
  s_cbranch_vccz cA_sc0_fp_d
  v_cmp_gt_u32 vcc, s19, v112
  buffer_load_dword v112, v0, s[8:11], 0 offen sc1
  s_cbranch_vccz cA_sc0_fp_d
  v_cmp_gt_u32 vcc, s19, v112
  buffer_load_dword v112, v0, s[8:11], 0 offen sc1
  s_cbranch_vccz cA_sc0_fp_d
  v_cmp_gt_u32 vcc, s19, v112
  buffer_load_dword v112, v0, s[8:11], 0 offen sc1
  s_cbranch_vccz cA_sc0_fp_d
  v_cmp_gt_u32 vcc, s19, v112
  buffer_load_dword v112, v0, s[8:11], 0 offen sc1
  s_cbranch_vccz cA_sc0_fp_d
  v_cmp_gt_u32 vcc, s19, v112
  buffer_load_dword v112, v0, s[8:11], 0 offen sc1
  s_cbranch_vccz cA_sc0_fp_d
  v_cmp_gt_u32 vcc, s19, v112
  buffer_load_dword v112, v0, s[8:11], 0 offen sc1
  s_cbranch_vccz cA_sc0_fp_d
  v_cmp_gt_u32 vcc, s19, v112
  buffer_load_dword v112, v0, s[8:11], 0 offen sc1
  s_cbranch_vccz cA_sc0_fp_d
  v_cmp_gt_u32 vcc, s19, v112
  buffer_load_dword v112, v0, s[8:11], 0 offen sc1
  s_cbranch_vccz cA_sc0_fp_d
  v_cmp_gt_u32 vcc, s19, v112
  buffer_load_dword v112, v0, s[8:11], 0 offen sc1
  s_cbranch_vccz cA_sc0_fp_d
  s_waitcnt vmcnt(24)
  s_add_u32 s30, s30, 1
  s_cmp_lt_u32 s30, 400000
  s_cbranch_scc1 cA_sc0_fp_l
  s_branch cA_abort
cA_sc0_fp_d:
  buffer_load_dwordx4 v[8:11], v2, s[8:11], s20 offen offset:0 sc1
  s_barrier
  s_setprio 2
  buffer_load_dwordx4 v[12:15], v2, s[8:11], s20 offen offset:1024 sc1
  s_setprio 1
  buffer_load_dwordx4 v[16:19], v2, s[8:11], s20 offen offset:2048 sc1
  s_setprio 0
  buffer_load_dwordx4 v[20:23], v2, s[8:11], s20 offen offset:3072 sc1
cA_sc0_go:
  s_waitcnt vmcnt(3)
  v_smfmac_f32_16x16x64_bf16 v[36:39], v[8:11], a[0:7], v3
  buffer_load_dwordx4 v[32:35], v2, s[8:11], s23 offen offset:0 sc1
  v_cmp_eq_u32 vcc, -1, v8
  v_smfmac_f32_16x16x64_bf16 v[40:43], v[8:11], a[56:63], v3
  v_smfmac_f32_16x16x64_bf16 v[44:47], v[8:11], a[112:119], v3
  buffer_load_dwordx4 v[24:27], v2, s[8:11], s23 offen offset:1024 sc1
  s_cbranch_vccnz cA_sc0_r0
  v_smfmac_f32_16x16x64_bf16 v[48:51], v[8:11], a[168:175], v3
  v_smfmac_f32_16x16x64_bf16 v[52:55], v[8:11], a[224:231], v3
  s_waitcnt vmcnt(4)
  v_cmp_eq_u32 vcc, -1, v12
  v_smfmac_f32_16x16x64_bf16 v[56:59], v[8:11], v[144:151], v3
  buffer_load_dwordx4 v[28:31], v2, s[8:11], s23 offen offset:2048 sc1
  v_smfmac_f32_16x16x64_bf16 v[60:63], v[8:11], v[200:207], v3
  s_cbranch_vccnz cA_sc0_r1
cA_sc0_c1:
  v_smfmac_f32_16x16x64_bf16 v[36:39], v[12:15], a[8:15], v3
  v_smfmac_f32_16x16x64_bf16 v[40:43], v[12:15], a[64:71], v3
  v_smfmac_f32_16x16x64_bf16 v[44:47], v[12:15], a[120:127], v3
  v_smfmac_f32_16x16x64_bf16 v[48:51], v[12:15], a[176:183], v3
  v_smfmac_f32_16x16x64_bf16 v[52:55], v[12:15], a[232:239], v3
  s_waitcnt vmcnt(4)
  v_cmp_eq_u32 vcc, -1, v16
  v_smfmac_f32_16x16x64_bf16 v[56:59], v[12:15], v[152:159], v3
  buffer_load_dwordx4 v[88:91], v117, s[8:11], s26 offen offset:0 sc1
  v_smfmac_f32_16x16x64_bf16 v[60:63], v[12:15], v[208:215], v3
  s_cbranch_vccnz cA_sc0_r2
cA_sc0_c2:
  v_smfmac_f32_16x16x64_bf16 v[36:39], v[16:19], a[16:23], v3
  v_smfmac_f32_16x16x64_bf16 v[40:43], v[16:19], a[72:79], v3
  v_smfmac_f32_16x16x64_bf16 v[44:47], v[16:19], a[128:135], v3
  buffer_load_dwordx4 v[92:95], v117, s[8:11], s26 offen offset:1024 sc1
  v_smfmac_f32_16x16x64_bf16 v[48:51], v[16:19], a[184:191], v3
  v_smfmac_f32_16x16x64_bf16 v[52:55], v[16:19], a[240:247], v3
  s_waitcnt vmcnt(5)
  v_cmp_eq_u32 vcc, -1, v20
  v_smfmac_f32_16x16x64_bf16 v[56:59], v[16:19], v[160:167], v3
  v_smfmac_f32_16x16x64_bf16 v[60:63], v[16:19], v[216:223], v3
  buffer_load_dwordx4 v[96:99], v2, s[8:11], s24 offen offset:0 sc1
  s_cbranch_vccnz cA_sc0_r3
cA_sc0_c3:
  v_smfmac_f32_16x16x64_bf16 v[36:39], v[20:23], a[24:31], v3
  v_smfmac_f32_16x16x64_bf16 v[40:43], v[20:23], a[80:87], v3
  s_waitcnt vmcnt(3)
  v_max3_u32 v66, v24, v27, v28
  v_smfmac_f32_16x16x64_bf16 v[44:47], v[20:23], a[136:143], v3
  v_max3_u32 v66, v66, v31, v32
  v_smfmac_f32_16x16x64_bf16 v[48:51], v[20:23], a[192:199], v3
  buffer_load_dwordx4 v[100:103], v2, s[8:11], s24 offen offset:1024 sc1
  v_max_u32 v66, v66, v35
  v_smfmac_f32_16x16x64_bf16 v[52:55], v[20:23], a[248:255], v3
  v_cmp_eq_u32 vcc, -1, v66
  v_smfmac_f32_16x16x64_bf16 v[56:59], v[20:23], v[168:175], v3
  v_smfmac_f32_16x16x64_bf16 v[60:63], v[20:23], v[224:231], v3
  s_cbranch_vccnz cA_sc0_r4
cA_sc0_c4:
  v_smfmac_f32_16x16x64_bf16 v[60:63], v[32:35], v[232:239], v3
  buffer_load_dwordx4 v[104:107], v2, s[8:11], s26 offen offset:0 sc1
  v_smfmac_f32_16x16x64_bf16 v[60:63], v[24:27], v[240:247], v3
  v_smfmac_f32_16x16x64_bf16 v[60:63], v[28:31], v[248:255], v3
  v_smfmac_f32_16x16x64_bf16 v[52:55], v[32:35], v[120:127], v3
  v_smfmac_f32_16x16x64_bf16 v[52:55], v[24:27], v[128:135], v3
  buffer_load_dwordx4 v[108:111], v2, s[8:11], s26 offen offset:1024 sc1
  v_smfmac_f32_16x16x64_bf16 v[52:55], v[28:31], v[136:143], v3
  v_cvt_pk_bf16_f32 v63, v62, v63
  v_smfmac_f32_16x16x64_bf16 v[56:59], v[32:35], v[176:183], v3
  v_cvt_pk_bf16_f32 v62, v60, v61
  v_smfmac_f32_16x16x64_bf16 v[56:59], v[24:27], v[184:191], v3
  v_mfma_f32_16x16x32_bf16 v[12:15], v[62:65], v[4:7], 0
  v_cvt_pk_bf16_f32 v55, v54, v55
  v_smfmac_f32_16x16x64_bf16 v[56:59], v[28:31], v[192:199], v3
  v_cvt_pk_bf16_f32 v54, v52, v53
  v_smfmac_f32_16x16x64_bf16 v[36:39], v[32:35], a[32:39], v3
  s_nop 1
  v_cvt_pk_bf16_f32 v76, v12, v13
  v_smfmac_f32_16x16x64_bf16 v[36:39], v[24:27], a[40:47], v3
  v_cvt_pk_bf16_f32 v77, v14, v15
  v_smfmac_f32_16x16x64_bf16 v[36:39], v[28:31], a[48:55], v3
  v_cvt_pk_bf16_f32 v56, v56, v57
  v_smfmac_f32_16x16x64_bf16 v[40:43], v[32:35], a[88:95], v3
  v_cvt_pk_bf16_f32 v57, v58, v59
  v_smfmac_f32_16x16x64_bf16 v[40:43], v[24:27], a[96:103], v3
  v_mfma_f32_16x16x32_bf16 v[16:19], v[54:57], v[4:7], 0
  v_cvt_pk_bf16_f32 v39, v38, v39
  v_smfmac_f32_16x16x64_bf16 v[40:43], v[28:31], a[104:111], v3
  v_cvt_pk_bf16_f32 v38, v36, v37
  v_smfmac_f32_16x16x64_bf16 v[44:47], v[32:35], a[144:151], v3
  s_nop 1
  v_cvt_pk_bf16_f32 v78, v16, v17
  v_smfmac_f32_16x16x64_bf16 v[44:47], v[24:27], a[152:159], v3
  v_cvt_pk_bf16_f32 v79, v18, v19
  v_smfmac_f32_16x16x64_bf16 v[44:47], v[28:31], a[160:167], v3
  v_cvt_pk_bf16_f32 v40, v40, v41
  v_smfmac_f32_16x16x64_bf16 v[48:51], v[32:35], a[200:207], v3
  v_cvt_pk_bf16_f32 v41, v42, v43
  v_smfmac_f32_16x16x64_bf16 v[48:51], v[24:27], a[208:215], v3
  v_smfmac_f32_16x16x64_bf16 v[48:51], v[28:31], a[216:223], v3
  s_waitcnt vmcnt(4)
  v_cvt_pk_bf16_f32 v47, v46, v47
  v_smfmac_f32_16x16x64_bf16 v[68:71], v[76:79], v[80:87], v3
  v_cvt_pk_bf16_f32 v46, v44, v45
  v_mfma_f32_16x16x32_bf16 v[12:15], v[38:41], v[4:7], 0
  s_nop 1
  v_cvt_pk_bf16_f32 v48, v48, v49
  v_cvt_pk_bf16_f32 v49, v50, v51
  s_nop 1
  v_mfma_f32_16x16x32_bf16 v[16:19], v[46:49], v[4:7], 0
  v_smfmac_f32_16x16x64_bf16 v[72:75], v[76:79], v[88:95], v3
  v_cvt_pk_bf16_f32 v20, v12, v13
  v_mfma_f32_16x16x32_bf16 v[52:55], v[30:33], v[76:79], 0
  s_waitcnt vmcnt(0)
  v_cvt_pk_bf16_f32 v21, v14, v15
  v_cvt_pk_bf16_f32 v22, v16, v17
  v_cvt_pk_bf16_f32 v23, v18, v19
  s_nop 1
  v_mfma_f32_16x16x32_bf16 v[52:55], v[8:11], v[20:23], v[52:55]
  v_smfmac_f32_16x16x64_bf16 v[68:71], v[20:23], v[96:103], v3
  v_smfmac_f32_16x16x64_bf16 v[72:75], v[20:23], v[104:111], v3
  s_nop 1
  ds_write_b128 v113, v[52:55]
  s_nop 1
  v_permlane32_swap_b32 v68, v70
  v_permlane32_swap_b32 v69, v71
  v_add_f32 v56, v68, v70
  v_add_f32 v58, v69, v71
  v_permlane32_swap_b32 v72, v74
  v_permlane32_swap_b32 v73, v75
  v_add_f32 v57, v72, v74
  v_add_f32 v59, v73, v75
  ds_write_b128 v2, v[56:59] offset:0
  v_cmp_u_f32 vcc, v57, v59
  v_mov_b32 v68, 0
  v_mov_b32 v69, 0
  v_mov_b32 v70, 0
  v_mov_b32 v71, 0
  s_cbranch_vccnz cA_sc0_retry
cA_sc0_cont:
  s_add_u32 s24, s24, 28672
  s_add_u32 s26, s26, 28672
  buffer_load_dwordx4 v[80:83], v117, s[8:11], s24 offen offset:0 sc1
  buffer_load_dwordx4 v[84:87], v117, s[8:11], s24 offen offset:1024 sc1
  v_mov_b32 v72, 0
  v_mov_b32 v73, 0
  v_mfma_f32_32x32x16_bf16 v[36:51], v[68:71], v[68:71], 0
  s_waitcnt lgkmcnt(0)
  s_barrier
  ds_read_b64 v[8:9], v114 offset:0
  ds_read_b64 v[10:11], v114 offset:1024
  ds_read_b64 v[12:13], v114 offset:2048
  ds_read_b64 v[14:15], v114 offset:3072
  ds_read2_b32 v[16:17], v115 offset0:0 offset1:64
  ds_read2_b32 v[18:19], v115 offset0:128 offset1:192
  v_mfma_f32_32x32x16_bf16 v[52:67], v[68:71], v[68:71], 0
  s_waitcnt lgkmcnt(0)
  v_pk_add_f32 v[16:17], v[16:17], v[18:19]
  v_pk_add_f32 v[8:9], v[8:9], v[10:11]
  v_pk_add_f32 v[12:13], v[12:13], v[14:15]
  v_add_f32 v20, v16, v17
  v_pk_add_f32 v[8:9], v[8:9], v[12:13]
  v_max_f32 v22, v8, v9
  v_add_f32_dpp v20, v20, v20 row_ror:8 row_mask:0xf bank_mask:0xf
  s_nop 0
  v_max_f32_dpp v22, v22, v22 row_ror:8 row_mask:0xf bank_mask:0xf
  v_max_f32 v22, v22, v20
  s_nop 1
  v_max_f32_dpp v22, v22, v22 quad_perm:[1,0,3,2] row_mask:0xf bank_mask:0xf
  s_nop 1
  v_max_f32_dpp v22, v22, v22 quad_perm:[2,3,0,1] row_mask:0xf bank_mask:0xf
  s_nop 1
  v_max_f32_dpp v22, v22, v22 row_half_mirror row_mask:0xf bank_mask:0xf
  v_pk_add_f32 v[8:9], v[8:9], v[22:23] op_sel_hi:[1,0] neg_lo:[0,1] neg_hi:[0,1]
  v_sub_f32 v20, v20, v22
  v_exp_f32 v8, v8
  v_exp_f32 v9, v9
  v_exp_f32 v20, v20
  v_add_f32 v24, v8, v9
  v_fmac_f32 v24, 0.5, v20
  v_mov_b32_dpp v21, v20 quad_perm:[1,0,3,2] row_mask:0xf bank_mask:0xf
  s_nop 0
  v_add_f32_dpp v24, v24, v24 quad_perm:[1,0,3,2] row_mask:0xf bank_mask:0xf
  s_nop 1
  v_add_f32_dpp v24, v24, v24 quad_perm:[2,3,0,1] row_mask:0xf bank_mask:0xf
  s_nop 1
  v_add_f32_dpp v24, v24, v24 row_half_mirror row_mask:0xf bank_mask:0xf
  s_nop 1
  v_add_f32_dpp v24, v24, v24 row_ror:8 row_mask:0xf bank_mask:0xf
  v_rcp_f32 v24, v24
  s_nop 0
  v_pk_mul_f32 v[8:9], v[8:9], v[24:25] op_sel_hi:[1,0]
  v_cvt_pk_bf16_f32 v8, abs(v8), abs(v9)
  buffer_store_dword v8, v1, s[8:11], s20 offen
  v_pk_mul_f32 v[20:21], v[20:21], v[24:25] op_sel_hi:[1,0]
  v_cvt_pk_bf16_f32 v20, abs(v20), abs(v21)
  buffer_store_dword v20, v118, s[8:11], s20 offen
  v_mov_b32 v74, 0
  v_mov_b32 v75, 0
  s_mov_b32 s19, s18
  s_add_u32 s18, s18, 1
  s_mov_b32 s22, s20
  s_mov_b32 s20, s21
  s_mov_b32 s21, s22
  s_add_u32 s23, s20, 4096
  s_cmp_lt_u32 s19, 63
  s_cbranch_scc1 cA_sc0_loop
  s_branch cA_done
cA_sc0_r0:
  s_add_u32 s31, s31, 1
  buffer_load_dwordx4 v[8:11], v2, s[8:11], s20 offen offset:0 sc1
  s_waitcnt vmcnt(0)
  v_cmp_eq_u32 vcc, -1, v8
  v_mov_b32 v36, 0
  v_mov_b32 v37, 0
  v_mov_b32 v38, 0
  v_mov_b32 v39, 0
  v_mov_b32 v40, 0
  v_mov_b32 v41, 0
  v_mov_b32 v42, 0
  v_mov_b32 v43, 0
  v_mov_b32 v44, 0
  v_mov_b32 v45, 0
  v_mov_b32 v46, 0
  v_mov_b32 v47, 0
  v_mov_b32 v48, 0
  v_mov_b32 v49, 0
  v_mov_b32 v50, 0
  v_mov_b32 v51, 0
  s_nop 1
  s_cbranch_vccz cA_sc0_go
  s_add_u32 s30, s30, 1
  s_cmp_lt_u32 s30, 400000
  s_cbranch_scc1 cA_sc0_r0
  s_branch cA_abort
cA_sc0_r1:
  s_add_u32 s31, s31, 1
  buffer_load_dwordx4 v[12:15], v2, s[8:11], s20 offen offset:1024 sc1
  s_waitcnt vmcnt(0)
  v_cmp_eq_u32 vcc, -1, v12
  s_nop 4
  s_cbranch_vccz cA_sc0_c1
  s_add_u32 s30, s30, 1
  s_cmp_lt_u32 s30, 400000
  s_cbranch_scc1 cA_sc0_r1
  s_branch cA_abort
cA_sc0_r2:
  s_add_u32 s31, s31, 1
  buffer_load_dwordx4 v[16:19], v2, s[8:11], s20 offen offset:2048 sc1
  s_waitcnt vmcnt(0)
  v_cmp_eq_u32 vcc, -1, v16
  s_nop 4
  s_cbranch_vccz cA_sc0_c2
  s_add_u32 s30, s30, 1
  s_cmp_lt_u32 s30, 400000
  s_cbranch_scc1 cA_sc0_r2
  s_branch cA_abort
cA_sc0_r3:
  s_add_u32 s31, s31, 1
  buffer_load_dwordx4 v[20:23], v2, s[8:11], s20 offen offset:3072 sc1
  s_waitcnt vmcnt(0)
  v_cmp_eq_u32 vcc, -1, v20
  s_nop 4
  s_cbranch_vccz cA_sc0_c3
  s_add_u32 s30, s30, 1
  s_cmp_lt_u32 s30, 400000
  s_cbranch_scc1 cA_sc0_r3
  s_branch cA_abort
cA_sc0_r4:
  s_add_u32 s31, s31, 1
  buffer_load_dwordx4 v[32:35], v2, s[8:11], s23 offen offset:0 sc1
  buffer_load_dwordx4 v[24:27], v2, s[8:11], s23 offen offset:1024 sc1
  buffer_load_dwordx4 v[28:31], v2, s[8:11], s23 offen offset:2048 sc1
  s_waitcnt vmcnt(0)
  v_max3_u32 v66, v24, v27, v28
  v_max3_u32 v66, v66, v31, v32
  v_max_u32 v66, v66, v35
  v_cmp_eq_u32 vcc, -1, v66
  s_nop 4
  s_cbranch_vccz cA_sc0_c4
  s_add_u32 s30, s30, 1
  s_cmp_lt_u32 s30, 400000
  s_cbranch_scc1 cA_sc0_r4
  s_branch cA_abort
cA_sc0_retry:
  s_cmp_lg_u32 s62, 0
  s_cbranch_scc1 cA_sc0_cont
  s_waitcnt vmcnt(0) lgkmcnt(0)
cA_sc0_rv:
  buffer_load_dwordx4 v[8:11], v2, s[8:11], s20 offen offset:0 sc1
  buffer_load_dwordx4 v[12:15], v2, s[8:11], s20 offen offset:1024 sc1
  buffer_load_dwordx4 v[16:19], v2, s[8:11], s20 offen offset:2048 sc1
  buffer_load_dwordx4 v[20:23], v2, s[8:11], s20 offen offset:3072 sc1
  buffer_load_dwordx4 v[32:35], v2, s[8:11], s23 offen offset:0 sc1
  buffer_load_dwordx4 v[24:27], v2, s[8:11], s23 offen offset:1024 sc1
  buffer_load_dwordx4 v[28:31], v2, s[8:11], s23 offen offset:2048 sc1
  s_waitcnt vmcnt(0)
  v_max3_u32 v66, v8, v9, v10
  v_max3_u32 v66, v66, v11, v12
  v_max3_u32 v66, v66, v13, v14
  v_max3_u32 v66, v66, v15, v16
  v_max3_u32 v66, v66, v17, v18
  v_max3_u32 v66, v66, v19, v20
  v_max3_u32 v66, v66, v21, v22
  v_max3_u32 v66, v66, v23, v24
  v_max3_u32 v66, v66, v25, v26
  v_max3_u32 v66, v66, v27, v28
  v_max3_u32 v66, v66, v29, v30
  v_max3_u32 v66, v66, v31, v32
  v_max3_u32 v66, v66, v33, v34
  v_max_u32 v66, v66, v35
  v_cmp_eq_u32 vcc, -1, v66
  s_cbranch_vccz cA_sc0_rk
  s_add_u32 s30, s30, 1
  s_cmp_lt_u32 s30, 400000
  s_cbranch_scc1 cA_sc0_rv
  s_branch cA_abort
cA_sc0_rk:
  s_mov_b32 s62, 1
  v_mov_b32 v36, 0
  v_mov_b32 v37, 0
  v_mov_b32 v38, 0
  v_mov_b32 v39, 0
  v_mov_b32 v40, 0
  v_mov_b32 v41, 0
  v_mov_b32 v42, 0
  v_mov_b32 v43, 0
  v_mov_b32 v44, 0
  v_mov_b32 v45, 0
  v_mov_b32 v46, 0
  v_mov_b32 v47, 0
  v_mov_b32 v48, 0
  v_mov_b32 v49, 0
  v_mov_b32 v50, 0
  v_mov_b32 v51, 0
  v_mov_b32 v60, 0
  v_mov_b32 v61, 0
  v_mov_b32 v62, 0
  v_mov_b32 v63, 0
  v_mov_b32 v68, 0
  v_mov_b32 v69, 0
  v_mov_b32 v70, 0
  v_mov_b32 v71, 0
  v_mov_b32 v72, 0
  v_mov_b32 v73, 0
  v_mov_b32 v74, 0
  v_mov_b32 v75, 0
  v_mov_b32 v52, 0
  v_mov_b32 v53, 0
  v_mov_b32 v54, 0
  v_mov_b32 v55, 0
  v_mov_b32 v56, 0
  v_mov_b32 v57, 0
  v_mov_b32 v58, 0
  v_mov_b32 v59, 0
  s_add_u32 s31, s31, 0x100
  s_nop 0
  s_branch cA_sc0_go
.p2align 6
cA_sc1_loop:
  s_mov_b32 s30, 0
  s_mov_b32 s62, 0
  s_setprio 3
  s_barrier
  buffer_load_dwordx4 v[8:11], v2, s[8:11], s20 offen offset:0 sc1
  s_setprio 2
  buffer_load_dwordx4 v[12:15], v2, s[8:11], s20 offen offset:1024 sc1
  s_setprio 1
  buffer_load_dwordx4 v[16:19], v2, s[8:11], s20 offen offset:2048 sc1
  s_setprio 0
  buffer_load_dwordx4 v[20:23], v2, s[8:11], s20 offen offset:3072 sc1
cA_sc1_go:
  s_waitcnt vmcnt(3)
  v_smfmac_f32_16x16x64_bf16 v[36:39], v[8:11], a[0:7], v3
  buffer_load_dwordx4 v[28:31], v2, s[8:11], s23 offen offset:0 sc1
  v_cmp_eq_u32 vcc, -1, v8
  v_smfmac_f32_16x16x64_bf16 v[40:43], v[8:11], a[56:63], v3
  v_smfmac_f32_16x16x64_bf16 v[44:47], v[8:11], a[112:119], v3
  buffer_load_dwordx4 v[24:27], v2, s[8:11], s23 offen offset:1024 sc1
  s_cbranch_vccnz cA_sc1_r0
  v_smfmac_f32_16x16x64_bf16 v[48:51], v[8:11], a[168:175], v3
  v_smfmac_f32_16x16x64_bf16 v[52:55], v[8:11], a[224:231], v3
  s_waitcnt vmcnt(4)
  v_cmp_eq_u32 vcc, -1, v12
  v_smfmac_f32_16x16x64_bf16 v[56:59], v[8:11], v[144:151], v3
  buffer_load_dwordx4 v[32:35], v2, s[8:11], s23 offen offset:2048 sc1
  v_smfmac_f32_16x16x64_bf16 v[60:63], v[8:11], v[200:207], v3
  s_cbranch_vccnz cA_sc1_r1
cA_sc1_c1:
  v_smfmac_f32_16x16x64_bf16 v[36:39], v[12:15], a[8:15], v3
  v_smfmac_f32_16x16x64_bf16 v[40:43], v[12:15], a[64:71], v3
  v_smfmac_f32_16x16x64_bf16 v[44:47], v[12:15], a[120:127], v3
  v_smfmac_f32_16x16x64_bf16 v[48:51], v[12:15], a[176:183], v3
  v_smfmac_f32_16x16x64_bf16 v[52:55], v[12:15], a[232:239], v3
  s_waitcnt vmcnt(4)
  v_cmp_eq_u32 vcc, -1, v16
  v_smfmac_f32_16x16x64_bf16 v[56:59], v[12:15], v[152:159], v3
  buffer_load_dwordx4 v[88:91], v117, s[8:11], s26 offen offset:0 sc1
  v_smfmac_f32_16x16x64_bf16 v[60:63], v[12:15], v[208:215], v3
  s_cbranch_vccnz cA_sc1_r2
cA_sc1_c2:
  v_smfmac_f32_16x16x64_bf16 v[36:39], v[16:19], a[16:23], v3
  v_smfmac_f32_16x16x64_bf16 v[40:43], v[16:19], a[72:79], v3
  v_smfmac_f32_16x16x64_bf16 v[44:47], v[16:19], a[128:135], v3
  buffer_load_dwordx4 v[92:95], v117, s[8:11], s26 offen offset:1024 sc1
  v_smfmac_f32_16x16x64_bf16 v[48:51], v[16:19], a[184:191], v3
  v_smfmac_f32_16x16x64_bf16 v[52:55], v[16:19], a[240:247], v3
  s_waitcnt vmcnt(5)
  v_cmp_eq_u32 vcc, -1, v20
  v_smfmac_f32_16x16x64_bf16 v[56:59], v[16:19], v[160:167], v3
  v_smfmac_f32_16x16x64_bf16 v[60:63], v[16:19], v[216:223], v3
  buffer_load_dwordx4 v[96:99], v2, s[8:11], s24 offen offset:0 sc1
  s_cbranch_vccnz cA_sc1_r3
cA_sc1_c3:
  v_smfmac_f32_16x16x64_bf16 v[36:39], v[20:23], a[24:31], v3
  v_smfmac_f32_16x16x64_bf16 v[40:43], v[20:23], a[80:87], v3
  s_waitcnt vmcnt(3)
  v_max3_u32 v66, v24, v27, v28
  v_smfmac_f32_16x16x64_bf16 v[44:47], v[20:23], a[136:143], v3
  v_max3_u32 v66, v66, v31, v32
  v_smfmac_f32_16x16x64_bf16 v[48:51], v[20:23], a[192:199], v3
  buffer_load_dwordx4 v[100:103], v2, s[8:11], s24 offen offset:1024 sc1
  v_max_u32 v66, v66, v35
  v_smfmac_f32_16x16x64_bf16 v[52:55], v[20:23], a[248:255], v3
  v_cmp_eq_u32 vcc, -1, v66
  v_smfmac_f32_16x16x64_bf16 v[56:59], v[20:23], v[168:175], v3
  v_smfmac_f32_16x16x64_bf16 v[60:63], v[20:23], v[224:231], v3
  s_cbranch_vccnz cA_sc1_r4
cA_sc1_c4:
  v_smfmac_f32_16x16x64_bf16 v[60:63], v[28:31], v[232:239], v3
  buffer_load_dwordx4 v[104:107], v2, s[8:11], s26 offen offset:0 sc1
  v_smfmac_f32_16x16x64_bf16 v[60:63], v[24:27], v[240:247], v3
  v_smfmac_f32_16x16x64_bf16 v[60:63], v[32:35], v[248:255], v3
  v_smfmac_f32_16x16x64_bf16 v[52:55], v[28:31], v[120:127], v3
  v_smfmac_f32_16x16x64_bf16 v[52:55], v[24:27], v[128:135], v3
  buffer_load_dwordx4 v[108:111], v2, s[8:11], s26 offen offset:1024 sc1
  v_smfmac_f32_16x16x64_bf16 v[52:55], v[32:35], v[136:143], v3
  v_cvt_pk_bf16_f32 v63, v62, v63
  v_smfmac_f32_16x16x64_bf16 v[56:59], v[28:31], v[176:183], v3
  v_cvt_pk_bf16_f32 v62, v60, v61
  v_smfmac_f32_16x16x64_bf16 v[56:59], v[24:27], v[184:191], v3
  v_mfma_f32_16x16x32_bf16 v[8:11], v[62:65], v[4:7], 0
  v_cvt_pk_bf16_f32 v55, v54, v55
  v_smfmac_f32_16x16x64_bf16 v[56:59], v[32:35], v[192:199], v3
  v_cvt_pk_bf16_f32 v54, v52, v53
  v_smfmac_f32_16x16x64_bf16 v[36:39], v[28:31], a[32:39], v3
  s_nop 1
  v_cvt_pk_bf16_f32 v78, v8, v9
  v_smfmac_f32_16x16x64_bf16 v[36:39], v[24:27], a[40:47], v3
  v_cvt_pk_bf16_f32 v79, v10, v11
  v_smfmac_f32_16x16x64_bf16 v[36:39], v[32:35], a[48:55], v3
  v_cvt_pk_bf16_f32 v56, v56, v57
  v_smfmac_f32_16x16x64_bf16 v[40:43], v[28:31], a[88:95], v3
  v_cvt_pk_bf16_f32 v57, v58, v59
  v_smfmac_f32_16x16x64_bf16 v[40:43], v[24:27], a[96:103], v3
  v_mfma_f32_16x16x32_bf16 v[16:19], v[54:57], v[4:7], 0
  v_cvt_pk_bf16_f32 v39, v38, v39
  v_smfmac_f32_16x16x64_bf16 v[40:43], v[32:35], a[104:111], v3
  v_cvt_pk_bf16_f32 v38, v36, v37
  v_smfmac_f32_16x16x64_bf16 v[44:47], v[28:31], a[144:151], v3
  s_nop 1
  v_cvt_pk_bf16_f32 v76, v16, v17
  v_smfmac_f32_16x16x64_bf16 v[44:47], v[24:27], a[152:159], v3
  v_cvt_pk_bf16_f32 v77, v18, v19
  v_smfmac_f32_16x16x64_bf16 v[44:47], v[32:35], a[160:167], v3
  v_cvt_pk_bf16_f32 v40, v40, v41
  v_smfmac_f32_16x16x64_bf16 v[48:51], v[28:31], a[200:207], v3
  v_cvt_pk_bf16_f32 v41, v42, v43
  v_smfmac_f32_16x16x64_bf16 v[48:51], v[24:27], a[208:215], v3
  v_smfmac_f32_16x16x64_bf16 v[48:51], v[32:35], a[216:223], v3
  s_waitcnt vmcnt(4)
  v_cvt_pk_bf16_f32 v47, v46, v47
  v_smfmac_f32_16x16x64_bf16 v[68:71], v[76:79], v[80:87], v3
  v_cvt_pk_bf16_f32 v46, v44, v45
  v_mfma_f32_16x16x32_bf16 v[8:11], v[38:41], v[4:7], 0
  s_nop 1
  v_cvt_pk_bf16_f32 v48, v48, v49
  v_cvt_pk_bf16_f32 v49, v50, v51
  s_nop 1
  v_mfma_f32_16x16x32_bf16 v[16:19], v[46:49], v[4:7], 0
  v_smfmac_f32_16x16x64_bf16 v[72:75], v[76:79], v[88:95], v3
  v_cvt_pk_bf16_f32 v20, v8, v9
  v_mfma_f32_16x16x32_bf16 v[52:55], v[30:33], v[76:79], 0
  s_waitcnt vmcnt(0)
  v_cvt_pk_bf16_f32 v21, v10, v11
  v_cvt_pk_bf16_f32 v22, v16, v17
  v_cvt_pk_bf16_f32 v23, v18, v19
  s_nop 1
  v_mfma_f32_16x16x32_bf16 v[52:55], v[12:15], v[20:23], v[52:55]
  v_smfmac_f32_16x16x64_bf16 v[68:71], v[20:23], v[96:103], v3
  v_smfmac_f32_16x16x64_bf16 v[72:75], v[20:23], v[104:111], v3
  s_nop 1
  ds_write_b128 v113, v[52:55]
  s_nop 1
  v_permlane32_swap_b32 v68, v70
  v_permlane32_swap_b32 v69, v71
  v_add_f32 v56, v68, v70
  v_add_f32 v58, v69, v71
  v_permlane32_swap_b32 v72, v74
  v_permlane32_swap_b32 v73, v75
  v_add_f32 v57, v72, v74
  v_add_f32 v59, v73, v75
  ds_write_b128 v2, v[56:59] offset:1024
  v_cmp_u_f32 vcc, v57, v59
  v_mov_b32 v68, 0
  v_mov_b32 v69, 0
  v_mov_b32 v70, 0
  v_mov_b32 v71, 0
  s_cbranch_vccnz cA_sc1_retry
cA_sc1_cont:
  s_add_u32 s24, s24, 28672
  s_add_u32 s26, s26, 28672
  buffer_load_dwordx4 v[80:83], v117, s[8:11], s24 offen offset:0 sc1
  buffer_load_dwordx4 v[84:87], v117, s[8:11], s24 offen offset:1024 sc1
  v_mov_b32 v72, 0
  v_mov_b32 v73, 0
  v_mfma_f32_32x32x16_bf16 v[36:51], v[68:71], v[68:71], 0
  s_waitcnt lgkmcnt(0)
  s_barrier
  ds_read_b64 v[8:9], v114 offset:0
  ds_read_b64 v[10:11], v114 offset:1024
  ds_read_b64 v[12:13], v114 offset:2048
  ds_read_b64 v[14:15], v114 offset:3072
  ds_read2_b32 v[16:17], v115 offset0:0 offset1:64
  ds_read2_b32 v[18:19], v115 offset0:128 offset1:192
  v_mfma_f32_32x32x16_bf16 v[52:67], v[68:71], v[68:71], 0
  s_waitcnt lgkmcnt(0)
  v_pk_add_f32 v[16:17], v[16:17], v[18:19]
  v_pk_add_f32 v[8:9], v[8:9], v[10:11]
  v_pk_add_f32 v[12:13], v[12:13], v[14:15]
  v_add_f32 v20, v16, v17
  v_pk_add_f32 v[8:9], v[8:9], v[12:13]
  v_max_f32 v22, v8, v9
  v_add_f32_dpp v20, v20, v20 row_ror:8 row_mask:0xf bank_mask:0xf
  s_nop 0
  v_max_f32_dpp v22, v22, v22 row_ror:8 row_mask:0xf bank_mask:0xf
  v_max_f32 v22, v22, v20
  buffer_store_dword v112, v116, s[8:11], 0 offen
  s_nop 0
  v_max_f32_dpp v22, v22, v22 quad_perm:[1,0,3,2] row_mask:0xf bank_mask:0xf
  s_nop 1
  v_max_f32_dpp v22, v22, v22 quad_perm:[2,3,0,1] row_mask:0xf bank_mask:0xf
  s_nop 1
  v_max_f32_dpp v22, v22, v22 row_half_mirror row_mask:0xf bank_mask:0xf
  v_pk_add_f32 v[8:9], v[8:9], v[22:23] op_sel_hi:[1,0] neg_lo:[0,1] neg_hi:[0,1]
  v_sub_f32 v20, v20, v22
  v_exp_f32 v8, v8
  v_exp_f32 v9, v9
  v_exp_f32 v20, v20
  v_add_f32 v24, v8, v9
  v_fmac_f32 v24, 0.5, v20
  v_mov_b32_dpp v21, v20 quad_perm:[1,0,3,2] row_mask:0xf bank_mask:0xf
  s_nop 0
  v_add_f32_dpp v24, v24, v24 quad_perm:[1,0,3,2] row_mask:0xf bank_mask:0xf
  s_nop 1
  v_add_f32_dpp v24, v24, v24 quad_perm:[2,3,0,1] row_mask:0xf bank_mask:0xf
  s_nop 1
  v_add_f32_dpp v24, v24, v24 row_half_mirror row_mask:0xf bank_mask:0xf
  s_nop 1
  v_add_f32_dpp v24, v24, v24 row_ror:8 row_mask:0xf bank_mask:0xf
  v_rcp_f32 v24, v24
  s_nop 0
  v_pk_mul_f32 v[8:9], v[8:9], v[24:25] op_sel_hi:[1,0]
  v_cvt_pk_bf16_f32 v8, abs(v8), abs(v9)
  buffer_store_dword v8, v1, s[8:11], s20 offen
  v_pk_mul_f32 v[20:21], v[20:21], v[24:25] op_sel_hi:[1,0]
  v_cvt_pk_bf16_f32 v20, abs(v20), abs(v21)
  buffer_store_dword v20, v118, s[8:11], s20 offen
  v_mov_b32 v74, 0
  v_mov_b32 v75, 0
  s_mov_b32 s19, s18
  s_add_u32 s18, s18, 1
  s_mov_b32 s22, s20
  s_mov_b32 s20, s21
  s_mov_b32 s21, s22
  s_add_u32 s23, s20, 4096
  v_mov_b32 v112, s18
  s_cmp_lt_u32 s19, 63
  s_nop 0
  s_cbranch_scc1 cA_sc1_loop
  s_branch cA_done
cA_sc1_r0:
  s_add_u32 s31, s31, 1
  buffer_load_dwordx4 v[8:11], v2, s[8:11], s20 offen offset:0 sc1
  s_waitcnt vmcnt(0)
  v_cmp_eq_u32 vcc, -1, v8
  v_mov_b32 v36, 0
  v_mov_b32 v37, 0
  v_mov_b32 v38, 0
  v_mov_b32 v39, 0
  v_mov_b32 v40, 0
  v_mov_b32 v41, 0
  v_mov_b32 v42, 0
  v_mov_b32 v43, 0
  v_mov_b32 v44, 0
  v_mov_b32 v45, 0
  v_mov_b32 v46, 0
  v_mov_b32 v47, 0
  v_mov_b32 v48, 0
  v_mov_b32 v49, 0
  v_mov_b32 v50, 0
  v_mov_b32 v51, 0
  s_nop 1
  s_cbranch_vccz cA_sc1_go
  s_add_u32 s30, s30, 1
  s_cmp_lt_u32 s30, 400000
  s_cbranch_scc1 cA_sc1_r0
  s_branch cA_abort
cA_sc1_r1:
  s_add_u32 s31, s31, 1
  buffer_load_dwordx4 v[12:15], v2, s[8:11], s20 offen offset:1024 sc1
  s_waitcnt vmcnt(0)
  v_cmp_eq_u32 vcc, -1, v12
  s_nop 4
  s_cbranch_vccz cA_sc1_c1
  s_add_u32 s30, s30, 1
  s_cmp_lt_u32 s30, 400000
  s_cbranch_scc1 cA_sc1_r1
  s_branch cA_abort
cA_sc1_r2:
  s_add_u32 s31, s31, 1
  buffer_load_dwordx4 v[16:19], v2, s[8:11], s20 offen offset:2048 sc1
  s_waitcnt vmcnt(0)
  v_cmp_eq_u32 vcc, -1, v16
  s_nop 4
  s_cbranch_vccz cA_sc1_c2
  s_add_u32 s30, s30, 1
  s_cmp_lt_u32 s30, 400000
  s_cbranch_scc1 cA_sc1_r2
  s_branch cA_abort
cA_sc1_r3:
  s_add_u32 s31, s31, 1
  buffer_load_dwordx4 v[20:23], v2, s[8:11], s20 offen offset:3072 sc1
  s_waitcnt vmcnt(0)
  v_cmp_eq_u32 vcc, -1, v20
  s_nop 4
  s_cbranch_vccz cA_sc1_c3
  s_add_u32 s30, s30, 1
  s_cmp_lt_u32 s30, 400000
  s_cbranch_scc1 cA_sc1_r3
  s_branch cA_abort
cA_sc1_r4:
  s_add_u32 s31, s31, 1
  buffer_load_dwordx4 v[28:31], v2, s[8:11], s23 offen offset:0 sc1
  buffer_load_dwordx4 v[24:27], v2, s[8:11], s23 offen offset:1024 sc1
  buffer_load_dwordx4 v[32:35], v2, s[8:11], s23 offen offset:2048 sc1
  s_waitcnt vmcnt(0)
  v_max3_u32 v66, v24, v27, v28
  v_max3_u32 v66, v66, v31, v32
  v_max_u32 v66, v66, v35
  v_cmp_eq_u32 vcc, -1, v66
  s_nop 4
  s_cbranch_vccz cA_sc1_c4
  s_add_u32 s30, s30, 1
  s_cmp_lt_u32 s30, 400000
  s_cbranch_scc1 cA_sc1_r4
  s_branch cA_abort
cA_sc1_retry:
  s_cmp_lg_u32 s62, 0
  s_cbranch_scc1 cA_sc1_cont
  s_waitcnt vmcnt(0) lgkmcnt(0)
cA_sc1_rv:
  buffer_load_dwordx4 v[8:11], v2, s[8:11], s20 offen offset:0 sc1
  buffer_load_dwordx4 v[12:15], v2, s[8:11], s20 offen offset:1024 sc1
  buffer_load_dwordx4 v[16:19], v2, s[8:11], s20 offen offset:2048 sc1
  buffer_load_dwordx4 v[20:23], v2, s[8:11], s20 offen offset:3072 sc1
  buffer_load_dwordx4 v[28:31], v2, s[8:11], s23 offen offset:0 sc1
  buffer_load_dwordx4 v[24:27], v2, s[8:11], s23 offen offset:1024 sc1
  buffer_load_dwordx4 v[32:35], v2, s[8:11], s23 offen offset:2048 sc1
  s_waitcnt vmcnt(0)
  v_max3_u32 v66, v8, v9, v10
  v_max3_u32 v66, v66, v11, v12
  v_max3_u32 v66, v66, v13, v14
  v_max3_u32 v66, v66, v15, v16
  v_max3_u32 v66, v66, v17, v18
  v_max3_u32 v66, v66, v19, v20
  v_max3_u32 v66, v66, v21, v22
  v_max3_u32 v66, v66, v23, v24
  v_max3_u32 v66, v66, v25, v26
  v_max3_u32 v66, v66, v27, v28
  v_max3_u32 v66, v66, v29, v30
  v_max3_u32 v66, v66, v31, v32
  v_max3_u32 v66, v66, v33, v34
  v_max_u32 v66, v66, v35
  v_cmp_eq_u32 vcc, -1, v66
  s_cbranch_vccz cA_sc1_rk
  s_add_u32 s30, s30, 1
  s_cmp_lt_u32 s30, 400000
  s_cbranch_scc1 cA_sc1_rv
  s_branch cA_abort
cA_sc1_rk:
  s_mov_b32 s62, 1
  v_mov_b32 v36, 0
  v_mov_b32 v37, 0
  v_mov_b32 v38, 0
  v_mov_b32 v39, 0
  v_mov_b32 v40, 0
  v_mov_b32 v41, 0
  v_mov_b32 v42, 0
  v_mov_b32 v43, 0
  v_mov_b32 v44, 0
  v_mov_b32 v45, 0
  v_mov_b32 v46, 0
  v_mov_b32 v47, 0
  v_mov_b32 v48, 0
  v_mov_b32 v49, 0
  v_mov_b32 v50, 0
  v_mov_b32 v51, 0
  v_mov_b32 v60, 0
  v_mov_b32 v61, 0
  v_mov_b32 v62, 0
  v_mov_b32 v63, 0
  v_mov_b32 v68, 0
  v_mov_b32 v69, 0
  v_mov_b32 v70, 0
  v_mov_b32 v71, 0
  v_mov_b32 v72, 0
  v_mov_b32 v73, 0
  v_mov_b32 v74, 0
  v_mov_b32 v75, 0
  v_mov_b32 v52, 0
  v_mov_b32 v53, 0
  v_mov_b32 v54, 0
  v_mov_b32 v55, 0
  v_mov_b32 v56, 0
  v_mov_b32 v57, 0
  v_mov_b32 v58, 0
  v_mov_b32 v59, 0
  s_add_u32 s31, s31, 0x100
  s_nop 0
  s_branch cA_sc1_go
.p2align 6
cA_sc2_loop:
  s_mov_b32 s30, 0
  s_mov_b32 s62, 0
  s_setprio 3
  s_barrier
  buffer_load_dwordx4 v[8:11], v2, s[8:11], s20 offen offset:0 sc1
  s_setprio 2
  buffer_load_dwordx4 v[12:15], v2, s[8:11], s20 offen offset:1024 sc1
  s_setprio 1
  buffer_load_dwordx4 v[16:19], v2, s[8:11], s20 offen offset:2048 sc1
  s_setprio 0
  buffer_load_dwordx4 v[20:23], v2, s[8:11], s20 offen offset:3072 sc1
cA_sc2_go:
  s_waitcnt vmcnt(3)
  v_smfmac_f32_16x16x64_bf16 v[36:39], v[8:11], a[0:7], v3
  buffer_load_dwordx4 v[24:27], v2, s[8:11], s23 offen offset:0 sc1
  v_cmp_eq_u32 vcc, -1, v8
  v_smfmac_f32_16x16x64_bf16 v[40:43], v[8:11], a[56:63], v3
  v_smfmac_f32_16x16x64_bf16 v[44:47], v[8:11], a[112:119], v3
  buffer_load_dwordx4 v[32:35], v2, s[8:11], s23 offen offset:1024 sc1
  s_cbranch_vccnz cA_sc2_r0
  v_smfmac_f32_16x16x64_bf16 v[48:51], v[8:11], a[168:175], v3
  v_smfmac_f32_16x16x64_bf16 v[52:55], v[8:11], a[224:231], v3
  s_waitcnt vmcnt(4)
  v_cmp_eq_u32 vcc, -1, v12
  v_smfmac_f32_16x16x64_bf16 v[56:59], v[8:11], v[144:151], v3
  buffer_load_dwordx4 v[28:31], v2, s[8:11], s23 offen offset:2048 sc1
  v_smfmac_f32_16x16x64_bf16 v[62:65], v[8:11], v[200:207], v3
  s_cbranch_vccnz cA_sc2_r1
cA_sc2_c1:
  v_smfmac_f32_16x16x64_bf16 v[36:39], v[12:15], a[8:15], v3
  v_smfmac_f32_16x16x64_bf16 v[40:43], v[12:15], a[64:71], v3
  v_smfmac_f32_16x16x64_bf16 v[44:47], v[12:15], a[120:127], v3
  v_smfmac_f32_16x16x64_bf16 v[48:51], v[12:15], a[176:183], v3
  v_smfmac_f32_16x16x64_bf16 v[52:55], v[12:15], a[232:239], v3
  s_waitcnt vmcnt(4)
  v_cmp_eq_u32 vcc, -1, v16
  v_smfmac_f32_16x16x64_bf16 v[56:59], v[12:15], v[152:159], v3
  buffer_load_dwordx4 v[88:91], v117, s[8:11], s26 offen offset:0 sc1
  v_smfmac_f32_16x16x64_bf16 v[62:65], v[12:15], v[208:215], v3
  s_cbranch_vccnz cA_sc2_r2
cA_sc2_c2:
  v_smfmac_f32_16x16x64_bf16 v[36:39], v[16:19], a[16:23], v3
  v_smfmac_f32_16x16x64_bf16 v[40:43], v[16:19], a[72:79], v3
  v_smfmac_f32_16x16x64_bf16 v[44:47], v[16:19], a[128:135], v3
  buffer_load_dwordx4 v[92:95], v117, s[8:11], s26 offen offset:1024 sc1
  v_smfmac_f32_16x16x64_bf16 v[48:51], v[16:19], a[184:191], v3
  v_smfmac_f32_16x16x64_bf16 v[52:55], v[16:19], a[240:247], v3
  s_waitcnt vmcnt(5)
  v_cmp_eq_u32 vcc, -1, v20
  v_smfmac_f32_16x16x64_bf16 v[56:59], v[16:19], v[160:167], v3
  v_smfmac_f32_16x16x64_bf16 v[62:65], v[16:19], v[216:223], v3
  buffer_load_dwordx4 v[96:99], v2, s[8:11], s24 offen offset:0 sc1
  s_cbranch_vccnz cA_sc2_r3
cA_sc2_c3:
  v_smfmac_f32_16x16x64_bf16 v[36:39], v[20:23], a[24:31], v3
  v_smfmac_f32_16x16x64_bf16 v[40:43], v[20:23], a[80:87], v3
  s_waitcnt vmcnt(3)
  v_max3_u32 v66, v24, v27, v28
  v_smfmac_f32_16x16x64_bf16 v[44:47], v[20:23], a[136:143], v3
  v_max3_u32 v66, v66, v31, v32
  v_smfmac_f32_16x16x64_bf16 v[48:51], v[20:23], a[192:199], v3
  buffer_load_dwordx4 v[100:103], v2, s[8:11], s24 offen offset:1024 sc1
  v_max_u32 v66, v66, v35
  v_smfmac_f32_16x16x64_bf16 v[52:55], v[20:23], a[248:255], v3
  v_cmp_eq_u32 vcc, -1, v66
  v_smfmac_f32_16x16x64_bf16 v[56:59], v[20:23], v[168:175], v3
  v_smfmac_f32_16x16x64_bf16 v[62:65], v[20:23], v[224:231], v3
  s_cbranch_vccnz cA_sc2_r4
cA_sc2_c4:
  v_smfmac_f32_16x16x64_bf16 v[62:65], v[24:27], v[232:239], v3
  buffer_load_dwordx4 v[104:107], v2, s[8:11], s26 offen offset:0 sc1
  v_smfmac_f32_16x16x64_bf16 v[62:65], v[32:35], v[240:247], v3
  v_smfmac_f32_16x16x64_bf16 v[62:65], v[28:31], v[248:255], v3
  v_smfmac_f32_16x16x64_bf16 v[52:55], v[24:27], v[120:127], v3
  v_smfmac_f32_16x16x64_bf16 v[52:55], v[32:35], v[128:135], v3
  buffer_load_dwordx4 v[108:111], v2, s[8:11], s26 offen offset:1024 sc1
  v_smfmac_f32_16x16x64_bf16 v[52:55], v[28:31], v[136:143], v3
  v_cvt_pk_bf16_f32 v62, v62, v63
  v_smfmac_f32_16x16x64_bf16 v[56:59], v[24:27], v[176:183], v3
  v_cvt_pk_bf16_f32 v63, v64, v65
  v_smfmac_f32_16x16x64_bf16 v[56:59], v[32:35], v[184:191], v3
  v_mfma_f32_16x16x32_bf16 v[8:11], v[60:63], v[4:7], 0
  v_cvt_pk_bf16_f32 v55, v54, v55
  v_smfmac_f32_16x16x64_bf16 v[56:59], v[28:31], v[192:199], v3
  v_cvt_pk_bf16_f32 v54, v52, v53
  v_smfmac_f32_16x16x64_bf16 v[36:39], v[24:27], a[32:39], v3
  s_nop 1
  v_cvt_pk_bf16_f32 v76, v8, v9
  v_smfmac_f32_16x16x64_bf16 v[36:39], v[32:35], a[40:47], v3
  v_cvt_pk_bf16_f32 v77, v10, v11
  v_smfmac_f32_16x16x64_bf16 v[36:39], v[28:31], a[48:55], v3
  v_cvt_pk_bf16_f32 v56, v56, v57
  v_smfmac_f32_16x16x64_bf16 v[40:43], v[24:27], a[88:95], v3
  v_cvt_pk_bf16_f32 v57, v58, v59
  v_smfmac_f32_16x16x64_bf16 v[40:43], v[32:35], a[96:103], v3
  v_mfma_f32_16x16x32_bf16 v[12:15], v[54:57], v[4:7], 0
  v_cvt_pk_bf16_f32 v39, v38, v39
  v_smfmac_f32_16x16x64_bf16 v[40:43], v[28:31], a[104:111], v3
  v_cvt_pk_bf16_f32 v38, v36, v37
  v_smfmac_f32_16x16x64_bf16 v[44:47], v[24:27], a[144:151], v3
  s_nop 1
  v_cvt_pk_bf16_f32 v78, v12, v13
  v_smfmac_f32_16x16x64_bf16 v[44:47], v[32:35], a[152:159], v3
  v_cvt_pk_bf16_f32 v79, v14, v15
  v_smfmac_f32_16x16x64_bf16 v[44:47], v[28:31], a[160:167], v3
  v_cvt_pk_bf16_f32 v40, v40, v41
  v_smfmac_f32_16x16x64_bf16 v[48:51], v[24:27], a[200:207], v3
  v_cvt_pk_bf16_f32 v41, v42, v43
  v_smfmac_f32_16x16x64_bf16 v[48:51], v[32:35], a[208:215], v3
  v_smfmac_f32_16x16x64_bf16 v[48:51], v[28:31], a[216:223], v3
  s_waitcnt vmcnt(4)
  v_cvt_pk_bf16_f32 v47, v46, v47
  v_smfmac_f32_16x16x64_bf16 v[68:71], v[76:79], v[80:87], v3
  v_cvt_pk_bf16_f32 v46, v44, v45
  v_mfma_f32_16x16x32_bf16 v[8:11], v[38:41], v[4:7], 0
  s_nop 1
  v_cvt_pk_bf16_f32 v48, v48, v49
  v_cvt_pk_bf16_f32 v49, v50, v51
  s_nop 1
  v_mfma_f32_16x16x32_bf16 v[12:15], v[46:49], v[4:7], 0
  v_smfmac_f32_16x16x64_bf16 v[72:75], v[76:79], v[88:95], v3
  v_cvt_pk_bf16_f32 v20, v8, v9
  v_mfma_f32_16x16x32_bf16 v[52:55], v[30:33], v[76:79], 0
  s_waitcnt vmcnt(0)
  v_cvt_pk_bf16_f32 v21, v10, v11
  v_cvt_pk_bf16_f32 v22, v12, v13
  v_cvt_pk_bf16_f32 v23, v14, v15
  s_nop 1
  v_mfma_f32_16x16x32_bf16 v[52:55], v[16:19], v[20:23], v[52:55]
  v_smfmac_f32_16x16x64_bf16 v[68:71], v[20:23], v[96:103], v3
  v_smfmac_f32_16x16x64_bf16 v[72:75], v[20:23], v[104:111], v3
  s_nop 1
  ds_write_b128 v113, v[52:55]
  s_nop 1
  v_permlane32_swap_b32 v68, v70
  v_permlane32_swap_b32 v69, v71
  v_add_f32 v56, v68, v70
  v_add_f32 v58, v69, v71
  v_permlane32_swap_b32 v72, v74
  v_permlane32_swap_b32 v73, v75
  v_add_f32 v57, v72, v74
  v_add_f32 v59, v73, v75
  ds_write_b128 v2, v[56:59] offset:2048
  v_cmp_u_f32 vcc, v57, v59
  v_mov_b32 v68, 0
  v_mov_b32 v69, 0
  v_mov_b32 v70, 0
  v_mov_b32 v71, 0
  s_cbranch_vccnz cA_sc2_retry
cA_sc2_cont:
  s_add_u32 s24, s24, 28672
  s_add_u32 s26, s26, 28672
  buffer_load_dwordx4 v[80:83], v117, s[8:11], s24 offen offset:0 sc1
  buffer_load_dwordx4 v[84:87], v117, s[8:11], s24 offen offset:1024 sc1
  v_mov_b32 v72, 0
  v_mov_b32 v73, 0
  v_mfma_f32_32x32x16_bf16 v[36:51], v[68:71], v[68:71], 0
  s_waitcnt lgkmcnt(0)
  s_barrier
  v_mfma_f32_32x32x16_bf16 v[52:67], v[68:71], v[68:71], 0
  buffer_store_dwordx2 v[118:119], v114, s[8:11], s21 offen
  buffer_store_dwordx2 v[118:119], v115, s[8:11], s21 offen
  s_buffer_load_dword s70, s[8:11], s35
  s_add_u32 s22, s24, 114688
  s_buffer_load_dword s71, s[8:11], s22
  s_mul_i32 s22, s18, 7168
  s_add_u32 s22, s22, 87040
  s_buffer_load_dword s72, s[8:11], s22
  s_add_u32 s35, s35, 458752
  v_mov_b32 v74, 0
  v_mov_b32 v75, 0
  s_mov_b32 s19, s18
  s_add_u32 s18, s18, 1
  s_mov_b32 s22, s20
  s_mov_b32 s20, s21
  s_mov_b32 s21, s22
  s_add_u32 s23, s20, 4096
  s_cmp_lt_u32 s19, 63
  s_cbranch_scc1 cA_sc2_loop
  s_branch cA_done
cA_sc2_r0:
  s_add_u32 s31, s31, 1
  buffer_load_dwordx4 v[8:11], v2, s[8:11], s20 offen offset:0 sc1
  s_waitcnt vmcnt(0)
  v_cmp_eq_u32 vcc, -1, v8
  v_mov_b32 v36, 0
  v_mov_b32 v37, 0
  v_mov_b32 v38, 0
  v_mov_b32 v39, 0
  v_mov_b32 v40, 0
  v_mov_b32 v41, 0
  v_mov_b32 v42, 0
  v_mov_b32 v43, 0
  v_mov_b32 v44, 0
  v_mov_b32 v45, 0
  v_mov_b32 v46, 0
  v_mov_b32 v47, 0
  v_mov_b32 v48, 0
  v_mov_b32 v49, 0
  v_mov_b32 v50, 0
  v_mov_b32 v51, 0
  s_nop 1
  s_cbranch_vccz cA_sc2_go
  s_add_u32 s30, s30, 1
  s_cmp_lt_u32 s30, 400000
  s_cbranch_scc1 cA_sc2_r0
  s_branch cA_abort
cA_sc2_r1:
  s_add_u32 s31, s31, 1
  buffer_load_dwordx4 v[12:15], v2, s[8:11], s20 offen offset:1024 sc1
  s_waitcnt vmcnt(0)
  v_cmp_eq_u32 vcc, -1, v12
  s_nop 4
  s_cbranch_vccz cA_sc2_c1
  s_add_u32 s30, s30, 1
  s_cmp_lt_u32 s30, 400000
  s_cbranch_scc1 cA_sc2_r1
  s_branch cA_abort
cA_sc2_r2:
  s_add_u32 s31, s31, 1
  buffer_load_dwordx4 v[16:19], v2, s[8:11], s20 offen offset:2048 sc1
  s_waitcnt vmcnt(0)
  v_cmp_eq_u32 vcc, -1, v16
  s_nop 4
  s_cbranch_vccz cA_sc2_c2
  s_add_u32 s30, s30, 1
  s_cmp_lt_u32 s30, 400000
  s_cbranch_scc1 cA_sc2_r2
  s_branch cA_abort
cA_sc2_r3:
  s_add_u32 s31, s31, 1
  buffer_load_dwordx4 v[20:23], v2, s[8:11], s20 offen offset:3072 sc1
  s_waitcnt vmcnt(0)
  v_cmp_eq_u32 vcc, -1, v20
  s_nop 4
  s_cbranch_vccz cA_sc2_c3
  s_add_u32 s30, s30, 1
  s_cmp_lt_u32 s30, 400000
  s_cbranch_scc1 cA_sc2_r3
  s_branch cA_abort
cA_sc2_r4:
  s_add_u32 s31, s31, 1
  buffer_load_dwordx4 v[24:27], v2, s[8:11], s23 offen offset:0 sc1
  buffer_load_dwordx4 v[32:35], v2, s[8:11], s23 offen offset:1024 sc1
  buffer_load_dwordx4 v[28:31], v2, s[8:11], s23 offen offset:2048 sc1
  s_waitcnt vmcnt(0)
  v_max3_u32 v66, v24, v27, v28
  v_max3_u32 v66, v66, v31, v32
  v_max_u32 v66, v66, v35
  v_cmp_eq_u32 vcc, -1, v66
  s_nop 4
  s_cbranch_vccz cA_sc2_c4
  s_add_u32 s30, s30, 1
  s_cmp_lt_u32 s30, 400000
  s_cbranch_scc1 cA_sc2_r4
  s_branch cA_abort
cA_sc2_retry:
  s_cmp_lg_u32 s62, 0
  s_cbranch_scc1 cA_sc2_cont
  s_waitcnt vmcnt(0) lgkmcnt(0)
cA_sc2_rv:
  buffer_load_dwordx4 v[8:11], v2, s[8:11], s20 offen offset:0 sc1
  buffer_load_dwordx4 v[12:15], v2, s[8:11], s20 offen offset:1024 sc1
  buffer_load_dwordx4 v[16:19], v2, s[8:11], s20 offen offset:2048 sc1
  buffer_load_dwordx4 v[20:23], v2, s[8:11], s20 offen offset:3072 sc1
  buffer_load_dwordx4 v[24:27], v2, s[8:11], s23 offen offset:0 sc1
  buffer_load_dwordx4 v[32:35], v2, s[8:11], s23 offen offset:1024 sc1
  buffer_load_dwordx4 v[28:31], v2, s[8:11], s23 offen offset:2048 sc1
  s_waitcnt vmcnt(0)
  v_max3_u32 v66, v8, v9, v10
  v_max3_u32 v66, v66, v11, v12
  v_max3_u32 v66, v66, v13, v14
  v_max3_u32 v66, v66, v15, v16
  v_max3_u32 v66, v66, v17, v18
  v_max3_u32 v66, v66, v19, v20
  v_max3_u32 v66, v66, v21, v22
  v_max3_u32 v66, v66, v23, v24
  v_max3_u32 v66, v66, v25, v26
  v_max3_u32 v66, v66, v27, v28
  v_max3_u32 v66, v66, v29, v30
  v_max3_u32 v66, v66, v31, v32
  v_max3_u32 v66, v66, v33, v34
  v_max_u32 v66, v66, v35
  v_cmp_eq_u32 vcc, -1, v66
  s_cbranch_vccz cA_sc2_rk
  s_add_u32 s30, s30, 1
  s_cmp_lt_u32 s30, 400000
  s_cbranch_scc1 cA_sc2_rv
  s_branch cA_abort
cA_sc2_rk:
  s_mov_b32 s62, 1
  v_mov_b32 v36, 0
  v_mov_b32 v37, 0
  v_mov_b32 v38, 0
  v_mov_b32 v39, 0
  v_mov_b32 v40, 0
  v_mov_b32 v41, 0
  v_mov_b32 v42, 0
  v_mov_b32 v43, 0
  v_mov_b32 v44, 0
  v_mov_b32 v45, 0
  v_mov_b32 v46, 0
  v_mov_b32 v47, 0
  v_mov_b32 v48, 0
  v_mov_b32 v49, 0
  v_mov_b32 v50, 0
  v_mov_b32 v51, 0
  v_mov_b32 v62, 0
  v_mov_b32 v63, 0
  v_mov_b32 v64, 0
  v_mov_b32 v65, 0
  v_mov_b32 v68, 0
  v_mov_b32 v69, 0
  v_mov_b32 v70, 0
  v_mov_b32 v71, 0
  v_mov_b32 v72, 0
  v_mov_b32 v73, 0
  v_mov_b32 v74, 0
  v_mov_b32 v75, 0
  v_mov_b32 v52, 0
  v_mov_b32 v53, 0
  v_mov_b32 v54, 0
  v_mov_b32 v55, 0
  v_mov_b32 v56, 0
  v_mov_b32 v57, 0
  v_mov_b32 v58, 0
  v_mov_b32 v59, 0
  s_add_u32 s31, s31, 0x100
  s_nop 0
  s_branch cA_sc2_go
.p2align 6
cA_sc3_loop:
  s_mov_b32 s30, 0
  s_mov_b32 s62, 0
  s_setprio 3
  s_barrier
  buffer_load_dwordx4 v[8:11], v2, s[8:11], s20 offen offset:0 sc1
  s_setprio 2
  buffer_load_dwordx4 v[12:15], v2, s[8:11], s20 offen offset:1024 sc1
  s_setprio 1
  buffer_load_dwordx4 v[16:19], v2, s[8:11], s20 offen offset:2048 sc1
  s_setprio 0
  buffer_load_dwordx4 v[20:23], v2, s[8:11], s20 offen offset:3072 sc1
cA_sc3_go:
  s_waitcnt vmcnt(3)
  v_smfmac_f32_16x16x64_bf16 v[36:39], v[8:11], a[0:7], v3
  buffer_load_dwordx4 v[24:27], v2, s[8:11], s23 offen offset:0 sc1
  v_cmp_eq_u32 vcc, -1, v8
  v_smfmac_f32_16x16x64_bf16 v[40:43], v[8:11], a[56:63], v3
  v_smfmac_f32_16x16x64_bf16 v[44:47], v[8:11], a[112:119], v3
  buffer_load_dwordx4 v[28:31], v2, s[8:11], s23 offen offset:1024 sc1
  s_cbranch_vccnz cA_sc3_r0
  v_smfmac_f32_16x16x64_bf16 v[48:51], v[8:11], a[168:175], v3
  v_smfmac_f32_16x16x64_bf16 v[52:55], v[8:11], a[224:231], v3
  s_waitcnt vmcnt(4)
  v_cmp_eq_u32 vcc, -1, v12
  v_smfmac_f32_16x16x64_bf16 v[56:59], v[8:11], v[144:151], v3
  buffer_load_dwordx4 v[32:35], v2, s[8:11], s23 offen offset:2048 sc1
  v_smfmac_f32_16x16x64_bf16 v[62:65], v[8:11], v[200:207], v3
  s_cbranch_vccnz cA_sc3_r1
cA_sc3_c1:
  v_smfmac_f32_16x16x64_bf16 v[36:39], v[12:15], a[8:15], v3
  v_smfmac_f32_16x16x64_bf16 v[40:43], v[12:15], a[64:71], v3
  v_smfmac_f32_16x16x64_bf16 v[44:47], v[12:15], a[120:127], v3
  v_smfmac_f32_16x16x64_bf16 v[48:51], v[12:15], a[176:183], v3
  v_smfmac_f32_16x16x64_bf16 v[52:55], v[12:15], a[232:239], v3
  s_waitcnt vmcnt(4)
  v_cmp_eq_u32 vcc, -1, v16
  v_smfmac_f32_16x16x64_bf16 v[56:59], v[12:15], v[152:159], v3
  buffer_load_dwordx4 v[88:91], v117, s[8:11], s26 offen offset:0 sc1
  v_smfmac_f32_16x16x64_bf16 v[62:65], v[12:15], v[208:215], v3
  s_cbranch_vccnz cA_sc3_r2
cA_sc3_c2:
  v_smfmac_f32_16x16x64_bf16 v[36:39], v[16:19], a[16:23], v3
  v_smfmac_f32_16x16x64_bf16 v[40:43], v[16:19], a[72:79], v3
  v_smfmac_f32_16x16x64_bf16 v[44:47], v[16:19], a[128:135], v3
  buffer_load_dwordx4 v[92:95], v117, s[8:11], s26 offen offset:1024 sc1
  v_smfmac_f32_16x16x64_bf16 v[48:51], v[16:19], a[184:191], v3
  v_smfmac_f32_16x16x64_bf16 v[52:55], v[16:19], a[240:247], v3
  s_waitcnt vmcnt(5)
  v_cmp_eq_u32 vcc, -1, v20
  v_smfmac_f32_16x16x64_bf16 v[56:59], v[16:19], v[160:167], v3
  v_smfmac_f32_16x16x64_bf16 v[62:65], v[16:19], v[216:223], v3
  buffer_load_dwordx4 v[96:99], v2, s[8:11], s24 offen offset:0 sc1
  s_cbranch_vccnz cA_sc3_r3
cA_sc3_c3:
  v_smfmac_f32_16x16x64_bf16 v[36:39], v[20:23], a[24:31], v3
  v_smfmac_f32_16x16x64_bf16 v[40:43], v[20:23], a[80:87], v3
  s_waitcnt vmcnt(3)
  v_max3_u32 v66, v24, v27, v28
  v_smfmac_f32_16x16x64_bf16 v[44:47], v[20:23], a[136:143], v3
  v_max3_u32 v66, v66, v31, v32
  v_smfmac_f32_16x16x64_bf16 v[48:51], v[20:23], a[192:199], v3
  buffer_load_dwordx4 v[100:103], v2, s[8:11], s24 offen offset:1024 sc1
  v_max_u32 v66, v66, v35
  v_smfmac_f32_16x16x64_bf16 v[52:55], v[20:23], a[248:255], v3
  v_cmp_eq_u32 vcc, -1, v66
  v_smfmac_f32_16x16x64_bf16 v[56:59], v[20:23], v[168:175], v3
  v_smfmac_f32_16x16x64_bf16 v[62:65], v[20:23], v[224:231], v3
  s_cbranch_vccnz cA_sc3_r4
cA_sc3_c4:
  v_smfmac_f32_16x16x64_bf16 v[62:65], v[24:27], v[232:239], v3
  buffer_load_dwordx4 v[104:107], v2, s[8:11], s26 offen offset:0 sc1
  v_smfmac_f32_16x16x64_bf16 v[62:65], v[28:31], v[240:247], v3
  v_smfmac_f32_16x16x64_bf16 v[62:65], v[32:35], v[248:255], v3
  v_smfmac_f32_16x16x64_bf16 v[52:55], v[24:27], v[120:127], v3
  v_smfmac_f32_16x16x64_bf16 v[52:55], v[28:31], v[128:135], v3
  buffer_load_dwordx4 v[108:111], v2, s[8:11], s26 offen offset:1024 sc1
  v_smfmac_f32_16x16x64_bf16 v[52:55], v[32:35], v[136:143], v3
  v_cvt_pk_bf16_f32 v62, v62, v63
  v_smfmac_f32_16x16x64_bf16 v[56:59], v[24:27], v[176:183], v3
  v_cvt_pk_bf16_f32 v63, v64, v65
  v_smfmac_f32_16x16x64_bf16 v[56:59], v[28:31], v[184:191], v3
  v_mfma_f32_16x16x32_bf16 v[8:11], v[60:63], v[4:7], 0
  v_cvt_pk_bf16_f32 v55, v54, v55
  v_smfmac_f32_16x16x64_bf16 v[56:59], v[32:35], v[192:199], v3
  v_cvt_pk_bf16_f32 v54, v52, v53
  v_smfmac_f32_16x16x64_bf16 v[36:39], v[24:27], a[32:39], v3
  s_nop 1
  v_cvt_pk_bf16_f32 v78, v8, v9
  v_smfmac_f32_16x16x64_bf16 v[36:39], v[28:31], a[40:47], v3
  v_cvt_pk_bf16_f32 v79, v10, v11
  v_smfmac_f32_16x16x64_bf16 v[36:39], v[32:35], a[48:55], v3
  v_cvt_pk_bf16_f32 v56, v56, v57
  v_smfmac_f32_16x16x64_bf16 v[40:43], v[24:27], a[88:95], v3
  v_cvt_pk_bf16_f32 v57, v58, v59
  v_smfmac_f32_16x16x64_bf16 v[40:43], v[28:31], a[96:103], v3
  v_mfma_f32_16x16x32_bf16 v[12:15], v[54:57], v[4:7], 0
  v_cvt_pk_bf16_f32 v39, v38, v39
  v_smfmac_f32_16x16x64_bf16 v[40:43], v[32:35], a[104:111], v3
  v_cvt_pk_bf16_f32 v38, v36, v37
  v_smfmac_f32_16x16x64_bf16 v[44:47], v[24:27], a[144:151], v3
  s_nop 1
  v_cvt_pk_bf16_f32 v76, v12, v13
  v_smfmac_f32_16x16x64_bf16 v[44:47], v[28:31], a[152:159], v3
  v_cvt_pk_bf16_f32 v77, v14, v15
  v_smfmac_f32_16x16x64_bf16 v[44:47], v[32:35], a[160:167], v3
  v_cvt_pk_bf16_f32 v40, v40, v41
  v_smfmac_f32_16x16x64_bf16 v[48:51], v[24:27], a[200:207], v3
  v_cvt_pk_bf16_f32 v41, v42, v43
  v_smfmac_f32_16x16x64_bf16 v[48:51], v[28:31], a[208:215], v3
  v_smfmac_f32_16x16x64_bf16 v[48:51], v[32:35], a[216:223], v3
  s_waitcnt vmcnt(4)
  v_cvt_pk_bf16_f32 v47, v46, v47
  v_smfmac_f32_16x16x64_bf16 v[68:71], v[76:79], v[80:87], v3
  v_cvt_pk_bf16_f32 v46, v44, v45
  v_mfma_f32_16x16x32_bf16 v[8:11], v[38:41], v[4:7], 0
  s_nop 1
  v_cvt_pk_bf16_f32 v48, v48, v49
  v_cvt_pk_bf16_f32 v49, v50, v51
  s_nop 1
  v_mfma_f32_16x16x32_bf16 v[12:15], v[46:49], v[4:7], 0
  v_smfmac_f32_16x16x64_bf16 v[72:75], v[76:79], v[88:95], v3
  v_cvt_pk_bf16_f32 v16, v8, v9
  v_mfma_f32_16x16x32_bf16 v[52:55], v[30:33], v[76:79], 0
  s_waitcnt vmcnt(0)
  v_cvt_pk_bf16_f32 v17, v10, v11
  v_cvt_pk_bf16_f32 v18, v12, v13
  v_cvt_pk_bf16_f32 v19, v14, v15
  s_nop 1
  v_mfma_f32_16x16x32_bf16 v[52:55], v[20:23], v[16:19], v[52:55]
  v_smfmac_f32_16x16x64_bf16 v[68:71], v[16:19], v[96:103], v3
  v_smfmac_f32_16x16x64_bf16 v[72:75], v[16:19], v[104:111], v3
  s_nop 1
  ds_write_b128 v113, v[52:55]
  s_nop 1
  v_permlane32_swap_b32 v68, v70
  v_permlane32_swap_b32 v69, v71
  v_add_f32 v56, v68, v70
  v_add_f32 v58, v69, v71
  v_permlane32_swap_b32 v72, v74
  v_permlane32_swap_b32 v73, v75
  v_add_f32 v57, v72, v74
  v_add_f32 v59, v73, v75
  ds_write_b128 v2, v[56:59] offset:3072
  v_cmp_u_f32 vcc, v57, v59
  v_mov_b32 v68, 0
  v_mov_b32 v69, 0
  v_mov_b32 v70, 0
  v_mov_b32 v71, 0
  s_cbranch_vccnz cA_sc3_retry
cA_sc3_cont:
  s_add_u32 s24, s24, 28672
  s_add_u32 s26, s26, 28672
  buffer_load_dwordx4 v[80:83], v117, s[8:11], s24 offen offset:0 sc1
  buffer_load_dwordx4 v[84:87], v117, s[8:11], s24 offen offset:1024 sc1
  v_mov_b32 v72, 0
  v_mov_b32 v73, 0
  v_mfma_f32_16x16x32_bf16 v[62:65], v[68:71], v[68:71], 0
  s_waitcnt lgkmcnt(0)
  s_barrier
  v_mov_b32 v52, 0
  v_mov_b32 v53, 0
  v_mov_b32 v54, 0
  v_mov_b32 v55, 0
  v_mov_b32 v56, 0
  v_mov_b32 v57, 0
  v_mov_b32 v58, 0
  v_mov_b32 v59, 0
  v_mfma_f32_32x32x16_bf16 v[36:51], v[68:71], v[68:71], 0
  v_mov_b32 v74, 0
  v_mov_b32 v75, 0
  s_mov_b32 s19, s18
  s_add_u32 s18, s18, 1
  s_mov_b32 s22, s20
  s_mov_b32 s20, s21
  s_mov_b32 s21, s22
  s_add_u32 s23, s20, 4096
  s_cmp_lt_u32 s19, 63
  s_nop 2
  s_cbranch_scc1 cA_sc3_loop
  s_branch cA_done
cA_sc3_r0:
  s_add_u32 s31, s31, 1
  buffer_load_dwordx4 v[8:11], v2, s[8:11], s20 offen offset:0 sc1
  s_waitcnt vmcnt(0)
  v_cmp_eq_u32 vcc, -1, v8
  v_mov_b32 v36, 0
  v_mov_b32 v37, 0
  v_mov_b32 v38, 0
  v_mov_b32 v39, 0
  v_mov_b32 v40, 0
  v_mov_b32 v41, 0
  v_mov_b32 v42, 0
  v_mov_b32 v43, 0
  v_mov_b32 v44, 0
  v_mov_b32 v45, 0
  v_mov_b32 v46, 0
  v_mov_b32 v47, 0
  v_mov_b32 v48, 0
  v_mov_b32 v49, 0
  v_mov_b32 v50, 0
  v_mov_b32 v51, 0
  s_nop 1
  s_cbranch_vccz cA_sc3_go
  s_add_u32 s30, s30, 1
  s_cmp_lt_u32 s30, 400000
  s_cbranch_scc1 cA_sc3_r0
  s_branch cA_abort
cA_sc3_r1:
  s_add_u32 s31, s31, 1
  buffer_load_dwordx4 v[12:15], v2, s[8:11], s20 offen offset:1024 sc1
  s_waitcnt vmcnt(0)
  v_cmp_eq_u32 vcc, -1, v12
  s_nop 4
  s_cbranch_vccz cA_sc3_c1
  s_add_u32 s30, s30, 1
  s_cmp_lt_u32 s30, 400000
  s_cbranch_scc1 cA_sc3_r1
  s_branch cA_abort
cA_sc3_r2:
  s_add_u32 s31, s31, 1
  buffer_load_dwordx4 v[16:19], v2, s[8:11], s20 offen offset:2048 sc1
  s_waitcnt vmcnt(0)
  v_cmp_eq_u32 vcc, -1, v16
  s_nop 4
  s_cbranch_vccz cA_sc3_c2
  s_add_u32 s30, s30, 1
  s_cmp_lt_u32 s30, 400000
  s_cbranch_scc1 cA_sc3_r2
  s_branch cA_abort
cA_sc3_r3:
  s_add_u32 s31, s31, 1
  buffer_load_dwordx4 v[20:23], v2, s[8:11], s20 offen offset:3072 sc1
  s_waitcnt vmcnt(0)
  v_cmp_eq_u32 vcc, -1, v20
  s_nop 4
  s_cbranch_vccz cA_sc3_c3
  s_add_u32 s30, s30, 1
  s_cmp_lt_u32 s30, 400000
  s_cbranch_scc1 cA_sc3_r3
  s_branch cA_abort
cA_sc3_r4:
  s_add_u32 s31, s31, 1
  buffer_load_dwordx4 v[24:27], v2, s[8:11], s23 offen offset:0 sc1
  buffer_load_dwordx4 v[28:31], v2, s[8:11], s23 offen offset:1024 sc1
  buffer_load_dwordx4 v[32:35], v2, s[8:11], s23 offen offset:2048 sc1
  s_waitcnt vmcnt(0)
  v_max3_u32 v66, v24, v27, v28
  v_max3_u32 v66, v66, v31, v32
  v_max_u32 v66, v66, v35
  v_cmp_eq_u32 vcc, -1, v66
  s_nop 4
  s_cbranch_vccz cA_sc3_c4
  s_add_u32 s30, s30, 1
  s_cmp_lt_u32 s30, 400000
  s_cbranch_scc1 cA_sc3_r4
  s_branch cA_abort
cA_sc3_retry:
  s_cmp_lg_u32 s62, 0
  s_cbranch_scc1 cA_sc3_cont
  s_waitcnt vmcnt(0) lgkmcnt(0)
cA_sc3_rv:
  buffer_load_dwordx4 v[8:11], v2, s[8:11], s20 offen offset:0 sc1
  buffer_load_dwordx4 v[12:15], v2, s[8:11], s20 offen offset:1024 sc1
  buffer_load_dwordx4 v[16:19], v2, s[8:11], s20 offen offset:2048 sc1
  buffer_load_dwordx4 v[20:23], v2, s[8:11], s20 offen offset:3072 sc1
  buffer_load_dwordx4 v[24:27], v2, s[8:11], s23 offen offset:0 sc1
  buffer_load_dwordx4 v[28:31], v2, s[8:11], s23 offen offset:1024 sc1
  buffer_load_dwordx4 v[32:35], v2, s[8:11], s23 offen offset:2048 sc1
  s_waitcnt vmcnt(0)
  v_max3_u32 v66, v8, v9, v10
  v_max3_u32 v66, v66, v11, v12
  v_max3_u32 v66, v66, v13, v14
  v_max3_u32 v66, v66, v15, v16
  v_max3_u32 v66, v66, v17, v18
  v_max3_u32 v66, v66, v19, v20
  v_max3_u32 v66, v66, v21, v22
  v_max3_u32 v66, v66, v23, v24
  v_max3_u32 v66, v66, v25, v26
  v_max3_u32 v66, v66, v27, v28
  v_max3_u32 v66, v66, v29, v30
  v_max3_u32 v66, v66, v31, v32
  v_max3_u32 v66, v66, v33, v34
  v_max_u32 v66, v66, v35
  v_cmp_eq_u32 vcc, -1, v66
  s_cbranch_vccz cA_sc3_rk
  s_add_u32 s30, s30, 1
  s_cmp_lt_u32 s30, 400000
  s_cbranch_scc1 cA_sc3_rv
  s_branch cA_abort
cA_sc3_rk:
  s_mov_b32 s62, 1
  v_mov_b32 v36, 0
  v_mov_b32 v37, 0
  v_mov_b32 v38, 0
  v_mov_b32 v39, 0
  v_mov_b32 v40, 0
  v_mov_b32 v41, 0
  v_mov_b32 v42, 0
  v_mov_b32 v43, 0
  v_mov_b32 v44, 0
  v_mov_b32 v45, 0
  v_mov_b32 v46, 0
  v_mov_b32 v47, 0
  v_mov_b32 v48, 0
  v_mov_b32 v49, 0
  v_mov_b32 v50, 0
  v_mov_b32 v51, 0
  v_mov_b32 v62, 0
  v_mov_b32 v63, 0
  v_mov_b32 v64, 0
  v_mov_b32 v65, 0
  v_mov_b32 v68, 0
  v_mov_b32 v69, 0
  v_mov_b32 v70, 0
  v_mov_b32 v71, 0
  v_mov_b32 v72, 0
  v_mov_b32 v73, 0
  v_mov_b32 v74, 0
  v_mov_b32 v75, 0
  v_mov_b32 v52, 0
  v_mov_b32 v53, 0
  v_mov_b32 v54, 0
  v_mov_b32 v55, 0
  v_mov_b32 v56, 0
  v_mov_b32 v57, 0
  v_mov_b32 v58, 0
  v_mov_b32 v59, 0
  s_add_u32 s31, s31, 0x100
  s_nop 0
  s_branch cA_sc3_go
.p2align 6
cA_va0_loop:
  s_mov_b32 s30, 0
  s_barrier
  buffer_load_dwordx4 v[24:27], v2, s[8:11], s23 offen offset:0 sc1
  buffer_load_dwordx4 v[28:31], v2, s[8:11], s23 offen offset:1024 sc1
  s_barrier
  s_cmp_lt_u32 s19, 60
  s_cbranch_scc1 cA_va0_m1
  buffer_store_dword v160, v1, s[8:11], s38 offen sc1
  s_cmp_lg_u32 s19, 63
  s_cbranch_scc1 cA_va0_m2
  v_min_u32 v64, -2, v64
  v_min_u32 v65, -2, v65
  v_min_u32 v66, -2, v66
  v_min_u32 v67, -2, v67
  v_min_u32 v68, -2, v68
  v_min_u32 v69, -2, v69
  v_min_u32 v70, -2, v70
  v_min_u32 v71, -2, v71
  v_min_u32 v72, -2, v72
  v_min_u32 v73, -2, v73
  v_min_u32 v74, -2, v74
  v_min_u32 v75, -2, v75
  v_min_u32 v76, -2, v76
  v_min_u32 v77, -2, v77
  v_min_u32 v78, -2, v78
  v_min_u32 v79, -2, v79
  buffer_store_dwordx4 v[64:67], v2, s[8:11], s33 offen offset:0 sc1
  buffer_store_dwordx4 v[68:71], v2, s[8:11], s33 offen offset:2048 sc1
  s_add_u32 s33, s33, 4096
  buffer_store_dwordx4 v[72:75], v2, s[8:11], s33 offen offset:0 sc1
  buffer_store_dwordx4 v[76:79], v2, s[8:11], s33 offen offset:2048 sc1
  s_add_u32 s33, s33, 4096
  s_waitcnt vmcnt(5)
  s_branch cA_va0_m3
cA_va0_m1:
  buffer_store_dword v160, v1, s[8:11], s38 offen nt
cA_va0_m2:
  s_add_u32 s22, s25, 0
  buffer_load_dwordx4 v[80:83], v6, s[8:11], s22 offen offset:0 sc1
  buffer_load_dwordx4 v[84:87], v6, s[8:11], s22 offen offset:1792 sc1
  s_add_u32 s22, s25, 3584
  buffer_load_dwordx4 v[88:91], v6, s[8:11], s22 offen offset:0 sc1
  buffer_load_dwordx4 v[92:95], v6, s[8:11], s22 offen offset:1792 sc1
  s_add_u32 s22, s25, 7168
  buffer_load_dwordx4 v[96:99], v6, s[8:11], s22 offen offset:0 sc1
  s_mul_i32 s38, s18, 7168
  s_add_u32 s38, s38, 65536
  s_waitcnt vmcnt(6)
cA_va0_m3:
  ds_write_b128 v2, v[24:27] offset:12288
  ds_write_b128 v2, v[28:31] offset:13312
  v_smfmac_f32_16x16x64_bf16 v[36:39], v[24:27], a[32:39], v3
  buffer_load_dwordx4 v[100:103], v6, s[8:11], s22 offen offset:1792 sc1
  v_smfmac_f32_16x16x64_bf16 v[40:43], v[24:27], a[88:95], v3
  s_add_u32 s22, s25, 10752
  buffer_load_dwordx4 v[104:107], v6, s[8:11], s22 offen offset:0 sc1
  v_smfmac_f32_16x16x64_bf16 v[44:47], v[24:27], a[144:151], v3
  buffer_load_dwordx4 v[108:111], v6, s[8:11], s22 offen offset:1792 sc1
  v_smfmac_f32_16x16x64_bf16 v[48:51], v[24:27], a[200:207], v3
  s_add_u32 s22, s25, 14336
  buffer_load_dwordx4 v[112:115], v6, s[8:11], s22 offen offset:0 sc1
  v_smfmac_f32_16x16x64_bf16 v[52:55], v[24:27], v[176:183], v3
  s_waitcnt lgkmcnt(0)
  s_barrier
  ds_read_b128 v[8:11], v2 offset:8192
  ds_read_b128 v[12:15], v2 offset:9216
  ds_read_b128 v[16:19], v2 offset:10240
  ds_read_b128 v[20:23], v2 offset:11264
  ds_read_b128 v[32:35], v2 offset:14336
  buffer_load_dwordx4 v[116:119], v6, s[8:11], s22 offen offset:1792 sc1
  v_smfmac_f32_16x16x64_bf16 v[56:59], v[24:27], v[232:239], v3
  s_add_u32 s22, s25, 17920
  buffer_load_dwordx4 v[120:123], v6, s[8:11], s22 offen offset:0 sc1
  v_smfmac_f32_16x16x64_bf16 v[36:39], v[28:31], a[40:47], v3
  buffer_load_dwordx4 v[124:127], v6, s[8:11], s22 offen offset:1792 sc1
  v_smfmac_f32_16x16x64_bf16 v[40:43], v[28:31], a[96:103], v3
  s_add_u32 s22, s25, 21504
  buffer_load_dwordx4 v[128:131], v6, s[8:11], s22 offen offset:0 sc1
  v_smfmac_f32_16x16x64_bf16 v[44:47], v[28:31], a[152:159], v3
  buffer_load_dwordx4 v[132:135], v6, s[8:11], s22 offen offset:1792 sc1
  v_smfmac_f32_16x16x64_bf16 v[48:51], v[28:31], a[208:215], v3
  s_add_u32 s22, s25, 25088
  buffer_load_dwordx4 v[136:139], v6, s[8:11], s22 offen offset:0 sc1
  v_smfmac_f32_16x16x64_bf16 v[52:55], v[28:31], v[184:191], v3
  buffer_load_dwordx4 v[140:143], v6, s[8:11], s22 offen offset:1792 sc1
  v_smfmac_f32_16x16x64_bf16 v[56:59], v[28:31], v[240:247], v3
  s_waitcnt lgkmcnt(4)
  v_smfmac_f32_16x16x64_bf16 v[36:39], v[8:11], a[0:7], v3
  s_waitcnt lgkmcnt(3)
  v_smfmac_f32_16x16x64_bf16 v[36:39], v[12:15], a[8:15], v3
  s_waitcnt lgkmcnt(2)
  v_smfmac_f32_16x16x64_bf16 v[36:39], v[16:19], a[16:23], v3
  s_waitcnt lgkmcnt(1)
  v_smfmac_f32_16x16x64_bf16 v[36:39], v[20:23], a[24:31], v3
  s_waitcnt lgkmcnt(0)
  v_smfmac_f32_16x16x64_bf16 v[36:39], v[32:35], a[48:55], v3
  v_smfmac_f32_16x16x64_bf16 v[40:43], v[8:11], a[56:63], v3
  v_smfmac_f32_16x16x64_bf16 v[40:43], v[12:15], a[64:71], v3
  v_smfmac_f32_16x16x64_bf16 v[40:43], v[16:19], a[72:79], v3
  v_permlane32_swap_b32 v36, v38
  v_smfmac_f32_16x16x64_bf16 v[40:43], v[20:23], a[80:87], v3
  v_permlane32_swap_b32 v37, v39
  v_smfmac_f32_16x16x64_bf16 v[40:43], v[32:35], a[104:111], v3
  v_add_f32 v36, v36, v38
  v_smfmac_f32_16x16x64_bf16 v[44:47], v[8:11], a[112:119], v3
  v_add_f32 v37, v37, v39
  v_smfmac_f32_16x16x64_bf16 v[44:47], v[12:15], a[120:127], v3
  v_cmp_u_f32 vcc, v36, v37
  v_smfmac_f32_16x16x64_bf16 v[44:47], v[16:19], a[128:135], v3
  v_cvt_pk_bf16_f32 v38, v36, v37
  v_smfmac_f32_16x16x64_bf16 v[44:47], v[20:23], a[136:143], v3
  ds_write_b32 v152, v38
  s_cbranch_vccnz cA_va0_slow
  v_permlane32_swap_b32 v40, v42
  v_smfmac_f32_16x16x64_bf16 v[44:47], v[32:35], a[160:167], v3
  v_permlane32_swap_b32 v41, v43
  v_smfmac_f32_16x16x64_bf16 v[48:51], v[8:11], a[168:175], v3
  buffer_store_dword v162, v1, s[8:11], s21 offen
  v_add_f32 v40, v40, v42
  v_smfmac_f32_16x16x64_bf16 v[48:51], v[12:15], a[176:183], v3
  v_add_f32 v41, v41, v43
  v_smfmac_f32_16x16x64_bf16 v[48:51], v[16:19], a[184:191], v3
  buffer_load_dword v164, v4, s[8:11], 0 offen sc1
  v_cvt_pk_bf16_f32 v42, v40, v41
  v_smfmac_f32_16x16x64_bf16 v[48:51], v[20:23], a[192:199], v3
  ds_write_b32 v153, v42
  v_permlane32_swap_b32 v44, v46
  v_smfmac_f32_16x16x64_bf16 v[48:51], v[32:35], a[216:223], v3
  v_permlane32_swap_b32 v45, v47
  v_smfmac_f32_16x16x64_bf16 v[52:55], v[8:11], a[224:231], v3
  buffer_load_dword v164, v4, s[8:11], 0 offen sc1
  v_add_f32 v44, v44, v46
  v_smfmac_f32_16x16x64_bf16 v[52:55], v[12:15], a[232:239], v3
  v_add_f32 v45, v45, v47
  v_smfmac_f32_16x16x64_bf16 v[52:55], v[16:19], a[240:247], v3
  v_cvt_pk_bf16_f32 v46, v44, v45
  v_smfmac_f32_16x16x64_bf16 v[52:55], v[20:23], a[248:255], v3
  ds_write_b32 v154, v46
  buffer_load_dword v164, v4, s[8:11], 0 offen sc1
  v_permlane32_swap_b32 v48, v50
  v_smfmac_f32_16x16x64_bf16 v[52:55], v[32:35], v[192:199], v3
  v_permlane32_swap_b32 v49, v51
  v_smfmac_f32_16x16x64_bf16 v[56:59], v[8:11], v[200:207], v3
  v_add_f32 v48, v48, v50
  v_smfmac_f32_16x16x64_bf16 v[56:59], v[12:15], v[208:215], v3
  buffer_load_dword v164, v4, s[8:11], 0 offen sc1
  v_add_f32 v49, v49, v51
  v_smfmac_f32_16x16x64_bf16 v[56:59], v[16:19], v[216:223], v3
  v_cvt_pk_bf16_f32 v50, v48, v49
  v_smfmac_f32_16x16x64_bf16 v[56:59], v[20:23], v[224:231], v3
  ds_write_b32 v155, v50
  v_permlane32_swap_b32 v52, v54
  v_smfmac_f32_16x16x64_bf16 v[56:59], v[32:35], v[248:255], v3
  buffer_load_dword v164, v4, s[8:11], 0 offen sc1
  v_permlane32_swap_b32 v53, v55
  v_add_f32 v52, v52, v54
  v_add_f32 v53, v53, v55
  v_cvt_pk_bf16_f32 v54, v52, v53
  ds_write_b32 v156, v54
  s_nop 1
  v_permlane32_swap_b32 v56, v58
  v_permlane32_swap_b32 v57, v59
  v_add_f32 v56, v56, v58
  v_add_f32 v57, v57, v59
  v_cvt_pk_bf16_f32 v58, v56, v57
  ds_write_b32 v157, v58
cA_va0_t2d:
  s_add_u32 s22, s20, 9216
  s_add_u32 s34, s20, 13312
  s_add_u32 s36, s20, 7168
  s_mov_b32 s37, 0
  v_mov_b32 v48, 0
  v_mov_b32 v49, 0
  v_mov_b32 v50, 0
  v_mov_b32 v51, 0
  v_mov_b32 v163, s18
  s_cmp_eq_u32 s19, 63
  s_waitcnt lgkmcnt(0)
  s_cbranch_scc1 cA_va0_last
  s_setprio 3
cA_va0_fw_l:
  v_cmp_gt_u32 vcc, s18, v164
  buffer_load_dword v164, v4, s[8:11], 0 offen sc1
  s_cbranch_vccz cA_va0_fw_d
  v_cmp_gt_u32 vcc, s18, v164
  buffer_load_dword v164, v4, s[8:11], 0 offen sc1
  s_cbranch_vccz cA_va0_fw_d
  v_cmp_gt_u32 vcc, s18, v164
  buffer_load_dword v164, v4, s[8:11], 0 offen sc1
  s_cbranch_vccz cA_va0_fw_d
  v_cmp_gt_u32 vcc, s18, v164
  buffer_load_dword v164, v4, s[8:11], 0 offen sc1
  s_cbranch_vccz cA_va0_fw_d
  v_cmp_gt_u32 vcc, s18, v164
  buffer_load_dword v164, v4, s[8:11], 0 offen sc1
  s_cbranch_vccz cA_va0_fw_d
  v_cmp_gt_u32 vcc, s18, v164
  buffer_load_dword v164, v4, s[8:11], 0 offen sc1
  s_cbranch_vccz cA_va0_fw_d
  v_cmp_gt_u32 vcc, s18, v164
  buffer_load_dword v164, v4, s[8:11], 0 offen sc1
  s_cbranch_vccz cA_va0_fw_d
  v_cmp_gt_u32 vcc, s18, v164
  buffer_load_dword v164, v4, s[8:11], 0 offen sc1
  s_cbranch_vccz cA_va0_fw_d
  v_cmp_gt_u32 vcc, s18, v164
  buffer_load_dword v164, v4, s[8:11], 0 offen sc1
  s_cbranch_vccz cA_va0_fw_d
  v_cmp_gt_u32 vcc, s18, v164
  buffer_load_dword v164, v4, s[8:11], 0 offen sc1
  s_cbranch_vccz cA_va0_fw_d
  v_cmp_gt_u32 vcc, s18, v164
  buffer_load_dword v164, v4, s[8:11], 0 offen sc1
  s_cbranch_vccz cA_va0_fw_d
  v_cmp_gt_u32 vcc, s18, v164
  buffer_load_dword v164, v4, s[8:11], 0 offen sc1
  s_cbranch_vccz cA_va0_fw_d
  v_cmp_gt_u32 vcc, s18, v164
  buffer_load_dword v164, v4, s[8:11], 0 offen sc1
  s_cbranch_vccz cA_va0_fw_d
  v_cmp_gt_u32 vcc, s18, v164
  buffer_load_dword v164, v4, s[8:11], 0 offen sc1
  s_cbranch_vccz cA_va0_fw_d
  v_cmp_gt_u32 vcc, s18, v164
  buffer_load_dword v164, v4, s[8:11], 0 offen sc1
  s_cbranch_vccz cA_va0_fw_d
  v_cmp_gt_u32 vcc, s18, v164
  buffer_load_dword v164, v4, s[8:11], 0 offen sc1
  s_cbranch_vccz cA_va0_fw_d
  s_waitcnt vmcnt(24)
  s_add_u32 s30, s30, 1
  s_cmp_lt_u32 s30, 400000
  s_cbranch_scc1 cA_va0_fw_l
  s_branch cA_abort
cA_va0_fw_d:
  buffer_load_dwordx4 v[8:11], v2, s[8:11], s22 offen offset:0 sc1
  buffer_load_dwordx4 v[12:15], v2, s[8:11], s22 offen offset:1024 sc1
  buffer_load_dwordx4 v[16:19], v2, s[8:11], s22 offen offset:2048 sc1
  buffer_load_dwordx4 v[20:23], v2, s[8:11], s22 offen offset:3072 sc1
  buffer_load_dwordx4 v[24:27], v2, s[8:11], s34 offen offset:0 sc1
  buffer_load_dwordx4 v[28:31], v2, s[8:11], s34 offen offset:1024 sc1
  buffer_load_dwordx4 v[32:35], v2, s[8:11], s34 offen offset:2048 sc1
  buffer_load_dwordx4 v[36:39], v2, s[8:11], s34 offen offset:3072 sc1
  buffer_load_dwordx4 v[40:43], v2, s[8:11], s36 offen offset:0 sc1
  buffer_load_dwordx4 v[44:47], v2, s[8:11], s36 offen offset:1024 sc1
  s_barrier
  ds_read_b128 v[64:67], v2 offset:0
  ds_read_b128 v[68:71], v2 offset:1024
  ds_read_b128 v[72:75], v2 offset:2048
  ds_read_b128 v[76:79], v2 offset:3072
cA_va0_lp:
  s_waitcnt vmcnt(9)
  v_smfmac_f32_16x16x64_bf16 v[48:51], v[8:11], v[80:87], v3
  s_waitcnt vmcnt(8)
  v_smfmac_f32_16x16x64_bf16 v[48:51], v[12:15], v[88:95], v3
  s_waitcnt vmcnt(7)
  v_smfmac_f32_16x16x64_bf16 v[48:51], v[16:19], v[96:103], v3
  s_waitcnt vmcnt(6)
  v_smfmac_f32_16x16x64_bf16 v[48:51], v[20:23], v[104:111], v3
  s_waitcnt vmcnt(5)
  v_smfmac_f32_16x16x64_bf16 v[48:51], v[24:27], v[112:119], v3
  s_waitcnt vmcnt(4)
  v_smfmac_f32_16x16x64_bf16 v[48:51], v[28:31], v[120:127], v3
  s_waitcnt vmcnt(3)
  v_smfmac_f32_16x16x64_bf16 v[48:51], v[32:35], v[128:135], v3
  s_waitcnt vmcnt(2)
  v_smfmac_f32_16x16x64_bf16 v[48:51], v[36:39], v[136:143], v3
  s_waitcnt vmcnt(1) lgkmcnt(0)
  v_smfmac_f32_16x16x64_bf16 v[48:51], v[40:43], v[64:71], v3
  s_waitcnt vmcnt(0)
  v_smfmac_f32_16x16x64_bf16 v[48:51], v[44:47], v[72:79], v3
  s_nop 7
  v_permlane32_swap_b32 v48, v50
  v_permlane32_swap_b32 v49, v51
  v_pk_add_f32 v[48:49], v[48:49], v[50:51]
  v_cvt_pk_bf16_f32 v160, v48, v49
  v_cmp_u_f32 vcc, v48, v49
  s_nop 0
  v_mov_b32_dpp v161, v160 quad_perm:[1,0,3,2] row_mask:0xf bank_mask:0xf
  v_perm_b32 v160, v161, v160, v5
  v_cndmask_b32 v161, v160, v162, vcc
  buffer_store_dword v161, v1, s[8:11], s21 offen
  s_cbranch_vccnz cA_va0_rp
cA_va0_cont:
  s_setprio 0
  s_cmp_lg_u32 s19, 62
  s_cbranch_scc1 cA_va0_nl
  s_sleep 4
  buffer_store_dword v160, v1, s[8:11], s38 offen sc1
  s_mov_b32 s38, 0x40000000
  s_mov_b32 s25, 0x40000000
cA_va0_nl:
  s_add_u32 s25, s25, 458752
  v_mov_b32 v36, 0
  v_mov_b32 v37, 0
  v_mov_b32 v38, 0
  v_mov_b32 v39, 0
  v_mov_b32 v40, 0
  v_mov_b32 v41, 0
  v_mov_b32 v42, 0
  v_mov_b32 v43, 0
  v_mov_b32 v44, 0
  v_mov_b32 v45, 0
  v_mov_b32 v46, 0
  v_mov_b32 v47, 0
  v_mov_b32 v48, 0
  v_mov_b32 v49, 0
  v_mov_b32 v50, 0
  v_mov_b32 v51, 0
  v_mov_b32 v52, 0
  v_mov_b32 v53, 0
  v_mov_b32 v54, 0
  v_mov_b32 v55, 0
  v_mov_b32 v56, 0
  v_mov_b32 v57, 0
  v_mov_b32 v58, 0
  v_mov_b32 v59, 0
  v_mov_b32 v60, 0
  v_mov_b32 v61, 0
  v_mov_b32 v62, 0
  v_mov_b32 v63, 0
  s_mov_b32 s19, s18
  s_add_u32 s18, s18, 1
  s_mov_b32 s22, s20
  s_mov_b32 s20, s21
  s_mov_b32 s21, s22
  s_add_u32 s23, s20, 4096
  s_branch cA_va0_loop
cA_va0_slow:
  s_waitcnt lgkmcnt(0)
cA_va0_sl1:
  s_add_u32 s31, s31, 0x1000000
  buffer_load_dwordx4 v[8:11], v2, s[8:11], s20 offen offset:0 sc1
  buffer_load_dwordx4 v[12:15], v2, s[8:11], s20 offen offset:1024 sc1
  buffer_load_dwordx4 v[16:19], v2, s[8:11], s20 offen offset:2048 sc1
  buffer_load_dwordx4 v[20:23], v2, s[8:11], s20 offen offset:3072 sc1
  buffer_load_dwordx4 v[24:27], v2, s[8:11], s23 offen offset:0 sc1
  buffer_load_dwordx4 v[28:31], v2, s[8:11], s23 offen offset:1024 sc1
  buffer_load_dwordx4 v[32:35], v2, s[8:11], s23 offen offset:2048 sc1
  s_waitcnt vmcnt(0)
  v_max3_u32 v36, v8, v9, v10
  v_max3_u32 v36, v36, v11, v12
  v_max3_u32 v36, v36, v13, v14
  v_max3_u32 v36, v36, v15, v16
  v_max3_u32 v36, v36, v17, v18
  v_max3_u32 v36, v36, v19, v20
  v_max3_u32 v36, v36, v21, v22
  v_max3_u32 v36, v36, v23, v24
  v_max3_u32 v36, v36, v25, v26
  v_max3_u32 v36, v36, v27, v28
  v_max3_u32 v36, v36, v29, v30
  v_max3_u32 v36, v36, v31, v32
  v_max3_u32 v36, v36, v33, v34
  v_max_u32 v36, v36, v35
  v_cmp_eq_u32 vcc, -1, v36
  s_cbranch_vccz cA_va0_sl2
  s_add_u32 s30, s30, 1
  s_cmp_lt_u32 s30, 400000
  s_cbranch_scc1 cA_va0_sl1
  s_branch cA_abort
cA_va0_sl2:
  v_mov_b32 v36, 0
  v_mov_b32 v37, 0
  v_mov_b32 v38, 0
  v_mov_b32 v39, 0
  v_mov_b32 v40, 0
  v_mov_b32 v41, 0
  v_mov_b32 v42, 0
  v_mov_b32 v43, 0
  v_mov_b32 v44, 0
  v_mov_b32 v45, 0
  v_mov_b32 v46, 0
  v_mov_b32 v47, 0
  v_mov_b32 v48, 0
  v_mov_b32 v49, 0
  v_mov_b32 v50, 0
  v_mov_b32 v51, 0
  v_mov_b32 v52, 0
  v_mov_b32 v53, 0
  v_mov_b32 v54, 0
  v_mov_b32 v55, 0
  v_mov_b32 v56, 0
  v_mov_b32 v57, 0
  v_mov_b32 v58, 0
  v_mov_b32 v59, 0
  v_mov_b32 v60, 0
  v_mov_b32 v61, 0
  v_mov_b32 v62, 0
  v_mov_b32 v63, 0
  buffer_store_dword v162, v1, s[8:11], s21 offen
  v_smfmac_f32_16x16x64_bf16 v[36:39], v[8:11], a[0:7], v3
  v_smfmac_f32_16x16x64_bf16 v[40:43], v[8:11], a[56:63], v3
  v_smfmac_f32_16x16x64_bf16 v[44:47], v[8:11], a[112:119], v3
  v_smfmac_f32_16x16x64_bf16 v[48:51], v[8:11], a[168:175], v3
  v_smfmac_f32_16x16x64_bf16 v[52:55], v[8:11], a[224:231], v3
  v_smfmac_f32_16x16x64_bf16 v[56:59], v[8:11], v[200:207], v3
  v_smfmac_f32_16x16x64_bf16 v[36:39], v[12:15], a[8:15], v3
  v_smfmac_f32_16x16x64_bf16 v[40:43], v[12:15], a[64:71], v3
  v_smfmac_f32_16x16x64_bf16 v[44:47], v[12:15], a[120:127], v3
  v_smfmac_f32_16x16x64_bf16 v[48:51], v[12:15], a[176:183], v3
  v_smfmac_f32_16x16x64_bf16 v[52:55], v[12:15], a[232:239], v3
  v_smfmac_f32_16x16x64_bf16 v[56:59], v[12:15], v[208:215], v3
  v_smfmac_f32_16x16x64_bf16 v[36:39], v[16:19], a[16:23], v3
  v_smfmac_f32_16x16x64_bf16 v[40:43], v[16:19], a[72:79], v3
  v_smfmac_f32_16x16x64_bf16 v[44:47], v[16:19], a[128:135], v3
  v_smfmac_f32_16x16x64_bf16 v[48:51], v[16:19], a[184:191], v3
  v_smfmac_f32_16x16x64_bf16 v[52:55], v[16:19], a[240:247], v3
  v_smfmac_f32_16x16x64_bf16 v[56:59], v[16:19], v[216:223], v3
  v_smfmac_f32_16x16x64_bf16 v[36:39], v[20:23], a[24:31], v3
  v_smfmac_f32_16x16x64_bf16 v[40:43], v[20:23], a[80:87], v3
  v_smfmac_f32_16x16x64_bf16 v[44:47], v[20:23], a[136:143], v3
  v_smfmac_f32_16x16x64_bf16 v[48:51], v[20:23], a[192:199], v3
  v_smfmac_f32_16x16x64_bf16 v[52:55], v[20:23], a[248:255], v3
  v_smfmac_f32_16x16x64_bf16 v[56:59], v[20:23], v[224:231], v3
  v_smfmac_f32_16x16x64_bf16 v[36:39], v[24:27], a[32:39], v3
  v_smfmac_f32_16x16x64_bf16 v[40:43], v[24:27], a[88:95], v3
  v_smfmac_f32_16x16x64_bf16 v[44:47], v[24:27], a[144:151], v3
  v_smfmac_f32_16x16x64_bf16 v[48:51], v[24:27], a[200:207], v3
  v_smfmac_f32_16x16x64_bf16 v[52:55], v[24:27], v[176:183], v3
  v_smfmac_f32_16x16x64_bf16 v[56:59], v[24:27], v[232:239], v3
  v_smfmac_f32_16x16x64_bf16 v[36:39], v[28:31], a[40:47], v3
  v_smfmac_f32_16x16x64_bf16 v[40:43], v[28:31], a[96:103], v3
  v_smfmac_f32_16x16x64_bf16 v[44:47], v[28:31], a[152:159], v3
  v_smfmac_f32_16x16x64_bf16 v[48:51], v[28:31], a[208:215], v3
  v_smfmac_f32_16x16x64_bf16 v[52:55], v[28:31], v[184:191], v3
  v_smfmac_f32_16x16x64_bf16 v[56:59], v[28:31], v[240:247], v3
  v_smfmac_f32_16x16x64_bf16 v[36:39], v[32:35], a[48:55], v3
  v_smfmac_f32_16x16x64_bf16 v[40:43], v[32:35], a[104:111], v3
  v_smfmac_f32_16x16x64_bf16 v[44:47], v[32:35], a[160:167], v3
  v_smfmac_f32_16x16x64_bf16 v[48:51], v[32:35], a[216:223], v3
  v_smfmac_f32_16x16x64_bf16 v[52:55], v[32:35], v[192:199], v3
  v_smfmac_f32_16x16x64_bf16 v[56:59], v[32:35], v[248:255], v3
  v_permlane32_swap_b32 v36, v38
  v_permlane32_swap_b32 v37, v39
  v_add_f32 v36, v36, v38
  v_add_f32 v37, v37, v39
  v_cvt_pk_bf16_f32 v38, v36, v37
  ds_write_b32 v152, v38
  v_permlane32_swap_b32 v40, v42
  v_permlane32_swap_b32 v41, v43
  v_add_f32 v40, v40, v42
  v_add_f32 v41, v41, v43
  v_cvt_pk_bf16_f32 v42, v40, v41
  ds_write_b32 v153, v42
  v_permlane32_swap_b32 v44, v46
  v_permlane32_swap_b32 v45, v47
  v_add_f32 v44, v44, v46
  v_add_f32 v45, v45, v47
  v_cvt_pk_bf16_f32 v46, v44, v45
  ds_write_b32 v154, v46
  v_permlane32_swap_b32 v48, v50
  v_permlane32_swap_b32 v49, v51
  v_add_f32 v48, v48, v50
  v_add_f32 v49, v49, v51
  v_cvt_pk_bf16_f32 v50, v48, v49
  ds_write_b32 v155, v50
  v_permlane32_swap_b32 v52, v54
  v_permlane32_swap_b32 v53, v55
  v_add_f32 v52, v52, v54
  v_add_f32 v53, v53, v55
  v_cvt_pk_bf16_f32 v54, v52, v53
  ds_write_b32 v156, v54
  v_permlane32_swap_b32 v56, v58
  v_permlane32_swap_b32 v57, v59
  v_add_f32 v56, v56, v58
  v_add_f32 v57, v57, v59
  v_cvt_pk_bf16_f32 v58, v56, v57
  ds_write_b32 v157, v58
  buffer_load_dword v164, v4, s[8:11], 0 offen sc1
  buffer_load_dword v164, v4, s[8:11], 0 offen sc1
  buffer_load_dword v164, v4, s[8:11], 0 offen sc1
  buffer_load_dword v164, v4, s[8:11], 0 offen sc1
  buffer_load_dword v164, v4, s[8:11], 0 offen sc1
  s_branch cA_va0_t2d
cA_va0_last:
  s_barrier
  ds_read_b128 v[64:67], v2 offset:0
  ds_read_b128 v[68:71], v2 offset:1024
  ds_read_b128 v[72:75], v2 offset:2048
  ds_read_b128 v[76:79], v2 offset:3072
  s_waitcnt lgkmcnt(0)
  v_min_u32 v64, -2, v64
  v_min_u32 v65, -2, v65
  v_min_u32 v66, -2, v66
  v_min_u32 v67, -2, v67
  v_min_u32 v68, -2, v68
  v_min_u32 v69, -2, v69
  v_min_u32 v70, -2, v70
  v_min_u32 v71, -2, v71
  v_min_u32 v72, -2, v72
  v_min_u32 v73, -2, v73
  v_min_u32 v74, -2, v74
  v_min_u32 v75, -2, v75
  v_min_u32 v76, -2, v76
  v_min_u32 v77, -2, v77
  v_min_u32 v78, -2, v78
  v_min_u32 v79, -2, v79
  buffer_store_dwordx4 v[64:67], v2, s[8:11], s33 offen offset:0 sc1
  buffer_store_dwordx4 v[68:71], v2, s[8:11], s33 offen offset:2048 sc1
  s_add_u32 s33, s33, 4096
  buffer_store_dwordx4 v[72:75], v2, s[8:11], s33 offen offset:0 sc1
  buffer_store_dwordx4 v[76:79], v2, s[8:11], s33 offen offset:2048 sc1
  s_add_u32 s33, s33, 4096
  s_waitcnt vmcnt(0)
  buffer_wbl2 sc1
  s_branch cA_done
cA_va0_rp:
  s_cmp_eq_u32 s37, 0
  s_cbranch_scc1 cA_va0_rv
  v_min_u32 v160, -2, v160
  buffer_store_dword v160, v1, s[8:11], s21 offen
  s_branch cA_va0_cont
cA_va0_rv:
  s_add_u32 s31, s31, 0x10000
  buffer_load_dwordx4 v[8:11], v2, s[8:11], s22 offen offset:0 sc1
  buffer_load_dwordx4 v[12:15], v2, s[8:11], s22 offen offset:1024 sc1
  buffer_load_dwordx4 v[16:19], v2, s[8:11], s22 offen offset:2048 sc1
  buffer_load_dwordx4 v[20:23], v2, s[8:11], s22 offen offset:3072 sc1
  buffer_load_dwordx4 v[24:27], v2, s[8:11], s34 offen offset:0 sc1
  buffer_load_dwordx4 v[28:31], v2, s[8:11], s34 offen offset:1024 sc1
  buffer_load_dwordx4 v[32:35], v2, s[8:11], s34 offen offset:2048 sc1
  buffer_load_dwordx4 v[36:39], v2, s[8:11], s34 offen offset:3072 sc1
  buffer_load_dwordx4 v[40:43], v2, s[8:11], s36 offen offset:0 sc1
  buffer_load_dwordx4 v[44:47], v2, s[8:11], s36 offen offset:1024 sc1
  s_waitcnt vmcnt(0)
  v_max3_u32 v52, v8, v9, v10
  v_max3_u32 v52, v52, v11, v12
  v_max3_u32 v52, v52, v13, v14
  v_max3_u32 v52, v52, v15, v16
  v_max3_u32 v52, v52, v17, v18
  v_max3_u32 v52, v52, v19, v20
  v_max3_u32 v52, v52, v21, v22
  v_max3_u32 v52, v52, v23, v24
  v_max3_u32 v52, v52, v25, v26
  v_max3_u32 v52, v52, v27, v28
  v_max3_u32 v52, v52, v29, v30
  v_max3_u32 v52, v52, v31, v32
  v_max3_u32 v52, v52, v33, v34
  v_max3_u32 v52, v52, v35, v36
  v_max3_u32 v52, v52, v37, v38
  v_max3_u32 v52, v52, v39, v40
  v_max3_u32 v52, v52, v41, v42
  v_max3_u32 v52, v52, v43, v44
  v_max3_u32 v52, v52, v45, v46
  v_max_u32 v52, v52, v47
  v_cmp_eq_u32 vcc, -1, v52
  s_mov_b32 s37, 1
  v_mov_b32 v48, 0
  v_mov_b32 v49, 0
  v_mov_b32 v50, 0
  v_mov_b32 v51, 0
  s_nop 1
  s_cbranch_vccz cA_va0_lp
  s_add_u32 s30, s30, 1
  s_cmp_lt_u32 s30, 400000
  s_cbranch_scc1 cA_va0_rv
  s_branch cA_abort
.p2align 6
cA_va1_loop:
  s_mov_b32 s30, 0
  s_barrier
  buffer_load_dwordx4 v[28:31], v2, s[8:11], s23 offen offset:1024 sc1
  buffer_load_dwordx4 v[32:35], v2, s[8:11], s23 offen offset:2048 sc1
  s_barrier
  s_cmp_lt_u32 s19, 60
  s_cbranch_scc1 cA_va1_m1
  buffer_store_dword v160, v1, s[8:11], s38 offen sc1
  s_cmp_lg_u32 s19, 63
  s_cbranch_scc1 cA_va1_m2
  v_min_u32 v64, -2, v64
  v_min_u32 v65, -2, v65
  v_min_u32 v66, -2, v66
  v_min_u32 v67, -2, v67
  v_min_u32 v68, -2, v68
  v_min_u32 v69, -2, v69
  v_min_u32 v70, -2, v70
  v_min_u32 v71, -2, v71
  v_min_u32 v72, -2, v72
  v_min_u32 v73, -2, v73
  v_min_u32 v74, -2, v74
  v_min_u32 v75, -2, v75
  v_min_u32 v76, -2, v76
  v_min_u32 v77, -2, v77
  v_min_u32 v78, -2, v78
  v_min_u32 v79, -2, v79
  buffer_store_dwordx4 v[64:67], v2, s[8:11], s33 offen offset:0 sc1
  buffer_store_dwordx4 v[68:71], v2, s[8:11], s33 offen offset:2048 sc1
  s_add_u32 s33, s33, 4096
  buffer_store_dwordx4 v[72:75], v2, s[8:11], s33 offen offset:0 sc1
  buffer_store_dwordx4 v[76:79], v2, s[8:11], s33 offen offset:2048 sc1
  s_add_u32 s33, s33, 4096
  s_waitcnt vmcnt(5)
  s_branch cA_va1_m3
cA_va1_m1:
  buffer_store_dword v160, v1, s[8:11], s38 offen nt
cA_va1_m2:
  s_add_u32 s22, s25, 0
  buffer_load_dwordx4 v[80:83], v6, s[8:11], s22 offen offset:0 sc1
  buffer_load_dwordx4 v[84:87], v6, s[8:11], s22 offen offset:1792 sc1
  s_add_u32 s22, s25, 3584
  buffer_load_dwordx4 v[88:91], v6, s[8:11], s22 offen offset:0 sc1
  buffer_load_dwordx4 v[92:95], v6, s[8:11], s22 offen offset:1792 sc1
  s_add_u32 s22, s25, 7168
  buffer_load_dwordx4 v[96:99], v6, s[8:11], s22 offen offset:0 sc1
  s_mul_i32 s38, s18, 7168
  s_add_u32 s38, s38, 65536
  s_waitcnt vmcnt(6)
cA_va1_m3:
  ds_write_b128 v2, v[32:35] offset:14336
  v_smfmac_f32_16x16x64_bf16 v[36:39], v[28:31], a[40:47], v3
  buffer_load_dwordx4 v[100:103], v6, s[8:11], s22 offen offset:1792 sc1
  v_smfmac_f32_16x16x64_bf16 v[40:43], v[28:31], a[96:103], v3
  s_add_u32 s22, s25, 10752
  buffer_load_dwordx4 v[104:107], v6, s[8:11], s22 offen offset:0 sc1
  v_smfmac_f32_16x16x64_bf16 v[44:47], v[28:31], a[152:159], v3
  buffer_load_dwordx4 v[108:111], v6, s[8:11], s22 offen offset:1792 sc1
  v_smfmac_f32_16x16x64_bf16 v[48:51], v[28:31], a[208:215], v3
  s_add_u32 s22, s25, 14336
  buffer_load_dwordx4 v[112:115], v6, s[8:11], s22 offen offset:0 sc1
  v_smfmac_f32_16x16x64_bf16 v[52:55], v[28:31], v[184:191], v3
  s_waitcnt lgkmcnt(0)
  s_barrier
  ds_read_b128 v[8:11], v2 offset:8192
  ds_read_b128 v[12:15], v2 offset:9216
  ds_read_b128 v[16:19], v2 offset:10240
  ds_read_b128 v[20:23], v2 offset:11264
  ds_read_b128 v[24:27], v2 offset:12288
  buffer_load_dwordx4 v[116:119], v6, s[8:11], s22 offen offset:1792 sc1
  v_smfmac_f32_16x16x64_bf16 v[56:59], v[28:31], v[240:247], v3
  s_add_u32 s22, s25, 17920
  buffer_load_dwordx4 v[120:123], v6, s[8:11], s22 offen offset:0 sc1
  v_smfmac_f32_16x16x64_bf16 v[36:39], v[32:35], a[48:55], v3
  buffer_load_dwordx4 v[124:127], v6, s[8:11], s22 offen offset:1792 sc1
  v_smfmac_f32_16x16x64_bf16 v[40:43], v[32:35], a[104:111], v3
  s_add_u32 s22, s25, 21504
  buffer_load_dwordx4 v[128:131], v6, s[8:11], s22 offen offset:0 sc1
  v_smfmac_f32_16x16x64_bf16 v[44:47], v[32:35], a[160:167], v3
  buffer_load_dwordx4 v[132:135], v6, s[8:11], s22 offen offset:1792 sc1
  v_smfmac_f32_16x16x64_bf16 v[48:51], v[32:35], a[216:223], v3
  s_add_u32 s22, s25, 25088
  buffer_load_dwordx4 v[136:139], v6, s[8:11], s22 offen offset:0 sc1
  v_smfmac_f32_16x16x64_bf16 v[52:55], v[32:35], v[192:199], v3
  ds_read_b128 v[64:67], v0 offset:0
  ds_read_b128 v[68:71], v0 offset:1024
  buffer_load_dwordx4 v[140:143], v6, s[8:11], s22 offen offset:1792 sc1
  v_smfmac_f32_16x16x64_bf16 v[56:59], v[32:35], v[248:255], v3
  s_waitcnt lgkmcnt(6)
  ds_read_b128 v[72:75], v0 offset:2048
  ds_read_b128 v[76:79], v0 offset:3072
  v_smfmac_f32_16x16x64_bf16 v[36:39], v[8:11], a[0:7], v3
  s_waitcnt lgkmcnt(7)
  v_smfmac_f32_16x16x64_bf16 v[36:39], v[12:15], a[8:15], v3
  s_waitcnt lgkmcnt(6)
  v_smfmac_f32_16x16x64_bf16 v[36:39], v[16:19], a[16:23], v3
  s_waitcnt lgkmcnt(2)
  v_smfmac_f32_16x16x64_bf16 v[60:63], v[8:11], v[64:71], v3
  s_waitcnt lgkmcnt(5)
  ds_read_b128 v[144:147], v0 offset:4096
  ds_read_b128 v[148:151], v0 offset:5120
  v_smfmac_f32_16x16x64_bf16 v[36:39], v[20:23], a[24:31], v3
  s_waitcnt lgkmcnt(6)
  v_smfmac_f32_16x16x64_bf16 v[36:39], v[24:27], a[32:39], v3
  v_smfmac_f32_16x16x64_bf16 v[40:43], v[8:11], a[56:63], v3
  s_waitcnt lgkmcnt(2)
  v_smfmac_f32_16x16x64_bf16 v[60:63], v[12:15], v[72:79], v3
  ds_read_b128 v[64:67], v0 offset:6144
  ds_read_b128 v[68:71], v0 offset:7168
  v_smfmac_f32_16x16x64_bf16 v[40:43], v[12:15], a[64:71], v3
  v_permlane32_swap_b32 v36, v38
  v_smfmac_f32_16x16x64_bf16 v[40:43], v[16:19], a[72:79], v3
  v_permlane32_swap_b32 v37, v39
  v_smfmac_f32_16x16x64_bf16 v[40:43], v[20:23], a[80:87], v3
  s_waitcnt lgkmcnt(2)
  v_add_f32 v36, v36, v38
  v_smfmac_f32_16x16x64_bf16 v[60:63], v[16:19], v[144:151], v3
  ds_read_b128 v[72:75], v0 offset:8192
  ds_read_b128 v[76:79], v0 offset:9216
  v_add_f32 v37, v37, v39
  v_smfmac_f32_16x16x64_bf16 v[40:43], v[24:27], a[88:95], v3
  v_cmp_u_f32 vcc, v36, v37
  v_smfmac_f32_16x16x64_bf16 v[44:47], v[8:11], a[112:119], v3
  v_cvt_pk_bf16_f32 v38, v36, v37
  v_smfmac_f32_16x16x64_bf16 v[44:47], v[12:15], a[120:127], v3
  ds_write_b32 v152, v38
  s_waitcnt lgkmcnt(3)
  s_cbranch_vccnz cA_va1_slow
  v_permlane32_swap_b32 v40, v42
  v_smfmac_f32_16x16x64_bf16 v[60:63], v[20:23], v[64:71], v3
  ds_read_b128 v[144:147], v0 offset:10240
  ds_read_b128 v[148:151], v0 offset:11264
  v_permlane32_swap_b32 v41, v43
  v_smfmac_f32_16x16x64_bf16 v[44:47], v[16:19], a[128:135], v3
  buffer_store_dword v162, v1, s[8:11], s21 offen
  v_add_f32 v40, v40, v42
  v_smfmac_f32_16x16x64_bf16 v[44:47], v[20:23], a[136:143], v3
  v_add_f32 v41, v41, v43
  v_smfmac_f32_16x16x64_bf16 v[44:47], v[24:27], a[144:151], v3
  s_waitcnt lgkmcnt(3)
  v_cvt_pk_bf16_f32 v42, v40, v41
  v_smfmac_f32_16x16x64_bf16 v[60:63], v[24:27], v[72:79], v3
  ds_write_b32 v153, v42
  ds_read_b128 v[64:67], v0 offset:12288
  ds_read_b128 v[68:71], v0 offset:13312
  v_smfmac_f32_16x16x64_bf16 v[48:51], v[8:11], a[168:175], v3
  s_nop 0
  v_permlane32_swap_b32 v44, v46
  v_smfmac_f32_16x16x64_bf16 v[48:51], v[12:15], a[176:183], v3
  v_permlane32_swap_b32 v45, v47
  v_smfmac_f32_16x16x64_bf16 v[48:51], v[16:19], a[184:191], v3
  s_waitcnt lgkmcnt(3)
  v_add_f32 v44, v44, v46
  v_smfmac_f32_16x16x64_bf16 v[60:63], v[28:31], v[144:151], v3
  v_add_f32 v45, v45, v47
  v_smfmac_f32_16x16x64_bf16 v[48:51], v[20:23], a[192:199], v3
  v_cvt_pk_bf16_f32 v46, v44, v45
  v_smfmac_f32_16x16x64_bf16 v[48:51], v[24:27], a[200:207], v3
  ds_write_b32 v154, v46
  v_smfmac_f32_16x16x64_bf16 v[52:55], v[8:11], a[224:231], v3
  s_waitcnt lgkmcnt(1)
  v_smfmac_f32_16x16x64_bf16 v[60:63], v[32:35], v[64:71], v3
  v_smfmac_f32_16x16x64_bf16 v[52:55], v[12:15], a[232:239], v3
  v_permlane32_swap_b32 v48, v50
  v_smfmac_f32_16x16x64_bf16 v[52:55], v[16:19], a[240:247], v3
  v_permlane32_swap_b32 v49, v51
  v_smfmac_f32_16x16x64_bf16 v[52:55], v[20:23], a[248:255], v3
  v_add_f32 v48, v48, v50
  v_smfmac_f32_16x16x64_bf16 v[52:55], v[24:27], v[176:183], v3
  v_add_f32 v49, v49, v51
  v_smfmac_f32_16x16x64_bf16 v[56:59], v[8:11], v[200:207], v3
  v_cvt_pk_bf16_f32 v50, v48, v49
  v_smfmac_f32_16x16x64_bf16 v[56:59], v[12:15], v[208:215], v3
  ds_write_b32 v155, v50
  v_permlane32_swap_b32 v60, v62
  v_smfmac_f32_16x16x64_bf16 v[56:59], v[16:19], v[216:223], v3
  v_permlane32_swap_b32 v61, v63
  v_smfmac_f32_16x16x64_bf16 v[56:59], v[20:23], v[224:231], v3
  v_add_f32 v60, v60, v62
  v_smfmac_f32_16x16x64_bf16 v[56:59], v[24:27], v[232:239], v3
  v_add_f32 v61, v61, v63
  v_cvt_pk_bf16_f32 v62, v60, v61
  ds_write_b32 v158, v62
  v_permlane32_swap_b32 v52, v54
  v_permlane32_swap_b32 v53, v55
  v_add_f32 v52, v52, v54
  v_add_f32 v53, v53, v55
  v_cvt_pk_bf16_f32 v54, v52, v53
  ds_write_b32 v156, v54
  v_permlane32_swap_b32 v56, v58
  v_permlane32_swap_b32 v57, v59
  v_add_f32 v56, v56, v58
  v_add_f32 v57, v57, v59
  v_cvt_pk_bf16_f32 v58, v56, v57
  ds_write_b32 v157, v58
cA_va1_t2d:
  s_add_u32 s22, s20, 9216
  s_add_u32 s34, s20, 13312
  s_add_u32 s36, s20, 7168
  s_mov_b32 s37, 0
  v_mov_b32 v48, 0
  v_mov_b32 v49, 0
  v_mov_b32 v50, 0
  v_mov_b32 v51, 0
  v_mov_b32 v163, s18
  s_cmp_eq_u32 s19, 63
  s_waitcnt lgkmcnt(0)
  s_cbranch_scc1 cA_va1_last
  s_barrier
  buffer_load_dwordx4 v[8:11], v2, s[8:11], s22 offen offset:0 sc1
  buffer_load_dwordx4 v[12:15], v2, s[8:11], s22 offen offset:1024 sc1
  buffer_load_dwordx4 v[16:19], v2, s[8:11], s22 offen offset:2048 sc1
  buffer_load_dwordx4 v[20:23], v2, s[8:11], s22 offen offset:3072 sc1
  buffer_load_dwordx4 v[24:27], v2, s[8:11], s34 offen offset:0 sc1
  buffer_load_dwordx4 v[28:31], v2, s[8:11], s34 offen offset:1024 sc1
  buffer_load_dwordx4 v[32:35], v2, s[8:11], s34 offen offset:2048 sc1
  buffer_load_dwordx4 v[36:39], v2, s[8:11], s34 offen offset:3072 sc1
  buffer_load_dwordx4 v[40:43], v2, s[8:11], s36 offen offset:0 sc1
  buffer_load_dwordx4 v[44:47], v2, s[8:11], s36 offen offset:1024 sc1
  ds_read_b128 v[64:67], v2 offset:4096
  ds_read_b128 v[68:71], v2 offset:5120
  ds_read_b128 v[72:75], v2 offset:6144
  ds_read_b128 v[76:79], v2 offset:7168
cA_va1_lp:
  s_waitcnt vmcnt(9)
  v_smfmac_f32_16x16x64_bf16 v[48:51], v[8:11], v[80:87], v3
  s_waitcnt vmcnt(8)
  v_smfmac_f32_16x16x64_bf16 v[48:51], v[12:15], v[88:95], v3
  s_waitcnt vmcnt(7)
  v_smfmac_f32_16x16x64_bf16 v[48:51], v[16:19], v[96:103], v3
  v_max3_u32 v55, v8, v12, v16
  s_waitcnt vmcnt(6)
  v_smfmac_f32_16x16x64_bf16 v[48:51], v[20:23], v[104:111], v3
  v_max_u32 v55, v55, v20
  v_cmp_eq_u32 vcc, -1, v55
  s_waitcnt vmcnt(5)
  v_smfmac_f32_16x16x64_bf16 v[48:51], v[24:27], v[112:119], v3
  s_waitcnt vmcnt(4)
  v_smfmac_f32_16x16x64_bf16 v[48:51], v[28:31], v[120:127], v3
  s_cbranch_vccnz cA_va1_rv
  buffer_store_dword v163, v7, s[8:11], 0 offen
  s_waitcnt vmcnt(4)
  v_smfmac_f32_16x16x64_bf16 v[48:51], v[32:35], v[128:135], v3
  s_waitcnt vmcnt(3)
  v_smfmac_f32_16x16x64_bf16 v[48:51], v[36:39], v[136:143], v3
  s_waitcnt vmcnt(2) lgkmcnt(0)
  v_smfmac_f32_16x16x64_bf16 v[48:51], v[40:43], v[64:71], v3
  s_waitcnt vmcnt(1)
  v_smfmac_f32_16x16x64_bf16 v[48:51], v[44:47], v[72:79], v3
  s_nop 7
  v_permlane32_swap_b32 v48, v50
  v_permlane32_swap_b32 v49, v51
  v_pk_add_f32 v[48:49], v[48:49], v[50:51]
  v_cvt_pk_bf16_f32 v160, v48, v49
  v_cmp_u_f32 vcc, v48, v49
  s_nop 0
  v_mov_b32_dpp v161, v160 quad_perm:[1,0,3,2] row_mask:0xf bank_mask:0xf
  v_perm_b32 v160, v161, v160, v5
  v_cndmask_b32 v161, v160, v162, vcc
  buffer_store_dword v161, v1, s[8:11], s21 offen
  s_cbranch_vccnz cA_va1_rp
cA_va1_cont:
  s_cmp_lg_u32 s19, 62
  s_cbranch_scc1 cA_va1_nl
  buffer_store_dword v160, v1, s[8:11], s38 offen sc1
  s_mov_b32 s38, 0x40000000
  s_mov_b32 s25, 0x40000000
cA_va1_nl:
  s_add_u32 s25, s25, 458752
  v_mov_b32 v36, 0
  v_mov_b32 v37, 0
  v_mov_b32 v38, 0
  v_mov_b32 v39, 0
  v_mov_b32 v40, 0
  v_mov_b32 v41, 0
  v_mov_b32 v42, 0
  v_mov_b32 v43, 0
  v_mov_b32 v44, 0
  v_mov_b32 v45, 0
  v_mov_b32 v46, 0
  v_mov_b32 v47, 0
  v_mov_b32 v48, 0
  v_mov_b32 v49, 0
  v_mov_b32 v50, 0
  v_mov_b32 v51, 0
  v_mov_b32 v52, 0
  v_mov_b32 v53, 0
  v_mov_b32 v54, 0
  v_mov_b32 v55, 0
  v_mov_b32 v56, 0
  v_mov_b32 v57, 0
  v_mov_b32 v58, 0
  v_mov_b32 v59, 0
  v_mov_b32 v60, 0
  v_mov_b32 v61, 0
  v_mov_b32 v62, 0
  v_mov_b32 v63, 0
  s_mov_b32 s19, s18
  s_add_u32 s18, s18, 1
  s_mov_b32 s22, s20
  s_mov_b32 s20, s21
  s_mov_b32 s21, s22
  s_add_u32 s23, s20, 4096
  s_branch cA_va1_loop
cA_va1_slow:
  s_waitcnt lgkmcnt(0)
cA_va1_sl1:
  s_add_u32 s31, s31, 0x1000000
  buffer_load_dwordx4 v[8:11], v2, s[8:11], s20 offen offset:0 sc1
  buffer_load_dwordx4 v[12:15], v2, s[8:11], s20 offen offset:1024 sc1
  buffer_load_dwordx4 v[16:19], v2, s[8:11], s20 offen offset:2048 sc1
  buffer_load_dwordx4 v[20:23], v2, s[8:11], s20 offen offset:3072 sc1
  buffer_load_dwordx4 v[24:27], v2, s[8:11], s23 offen offset:0 sc1
  buffer_load_dwordx4 v[28:31], v2, s[8:11], s23 offen offset:1024 sc1
  buffer_load_dwordx4 v[32:35], v2, s[8:11], s23 offen offset:2048 sc1
  s_waitcnt vmcnt(0)
  v_max3_u32 v36, v8, v9, v10
  v_max3_u32 v36, v36, v11, v12
  v_max3_u32 v36, v36, v13, v14
  v_max3_u32 v36, v36, v15, v16
  v_max3_u32 v36, v36, v17, v18
  v_max3_u32 v36, v36, v19, v20
  v_max3_u32 v36, v36, v21, v22
  v_max3_u32 v36, v36, v23, v24
  v_max3_u32 v36, v36, v25, v26
  v_max3_u32 v36, v36, v27, v28
  v_max3_u32 v36, v36, v29, v30
  v_max3_u32 v36, v36, v31, v32
  v_max3_u32 v36, v36, v33, v34
  v_max_u32 v36, v36, v35
  v_cmp_eq_u32 vcc, -1, v36
  s_cbranch_vccz cA_va1_sl2
  s_add_u32 s30, s30, 1
  s_cmp_lt_u32 s30, 400000
  s_cbranch_scc1 cA_va1_sl1
  s_branch cA_abort
cA_va1_sl2:
  v_mov_b32 v36, 0
  v_mov_b32 v37, 0
  v_mov_b32 v38, 0
  v_mov_b32 v39, 0
  v_mov_b32 v40, 0
  v_mov_b32 v41, 0
  v_mov_b32 v42, 0
  v_mov_b32 v43, 0
  v_mov_b32 v44, 0
  v_mov_b32 v45, 0
  v_mov_b32 v46, 0
  v_mov_b32 v47, 0
  v_mov_b32 v48, 0
  v_mov_b32 v49, 0
  v_mov_b32 v50, 0
  v_mov_b32 v51, 0
  v_mov_b32 v52, 0
  v_mov_b32 v53, 0
  v_mov_b32 v54, 0
  v_mov_b32 v55, 0
  v_mov_b32 v56, 0
  v_mov_b32 v57, 0
  v_mov_b32 v58, 0
  v_mov_b32 v59, 0
  v_mov_b32 v60, 0
  v_mov_b32 v61, 0
  v_mov_b32 v62, 0
  v_mov_b32 v63, 0
  buffer_store_dword v162, v1, s[8:11], s21 offen
  ds_read_b128 v[64:67], v0 offset:0
  ds_read_b128 v[68:71], v0 offset:1024
  v_smfmac_f32_16x16x64_bf16 v[36:39], v[8:11], a[0:7], v3
  v_smfmac_f32_16x16x64_bf16 v[40:43], v[8:11], a[56:63], v3
  v_smfmac_f32_16x16x64_bf16 v[44:47], v[8:11], a[112:119], v3
  v_smfmac_f32_16x16x64_bf16 v[48:51], v[8:11], a[168:175], v3
  v_smfmac_f32_16x16x64_bf16 v[52:55], v[8:11], a[224:231], v3
  v_smfmac_f32_16x16x64_bf16 v[56:59], v[8:11], v[200:207], v3
  s_waitcnt lgkmcnt(0)
  v_smfmac_f32_16x16x64_bf16 v[60:63], v[8:11], v[64:71], v3
  ds_read_b128 v[72:75], v0 offset:2048
  ds_read_b128 v[76:79], v0 offset:3072
  v_smfmac_f32_16x16x64_bf16 v[36:39], v[12:15], a[8:15], v3
  v_smfmac_f32_16x16x64_bf16 v[40:43], v[12:15], a[64:71], v3
  v_smfmac_f32_16x16x64_bf16 v[44:47], v[12:15], a[120:127], v3
  v_smfmac_f32_16x16x64_bf16 v[48:51], v[12:15], a[176:183], v3
  v_smfmac_f32_16x16x64_bf16 v[52:55], v[12:15], a[232:239], v3
  v_smfmac_f32_16x16x64_bf16 v[56:59], v[12:15], v[208:215], v3
  s_waitcnt lgkmcnt(0)
  v_smfmac_f32_16x16x64_bf16 v[60:63], v[12:15], v[72:79], v3
  ds_read_b128 v[144:147], v0 offset:4096
  ds_read_b128 v[148:151], v0 offset:5120
  v_smfmac_f32_16x16x64_bf16 v[36:39], v[16:19], a[16:23], v3
  v_smfmac_f32_16x16x64_bf16 v[40:43], v[16:19], a[72:79], v3
  v_smfmac_f32_16x16x64_bf16 v[44:47], v[16:19], a[128:135], v3
  v_smfmac_f32_16x16x64_bf16 v[48:51], v[16:19], a[184:191], v3
  v_smfmac_f32_16x16x64_bf16 v[52:55], v[16:19], a[240:247], v3
  v_smfmac_f32_16x16x64_bf16 v[56:59], v[16:19], v[216:223], v3
  s_waitcnt lgkmcnt(0)
  v_smfmac_f32_16x16x64_bf16 v[60:63], v[16:19], v[144:151], v3
  ds_read_b128 v[64:67], v0 offset:6144
  ds_read_b128 v[68:71], v0 offset:7168
  v_smfmac_f32_16x16x64_bf16 v[36:39], v[20:23], a[24:31], v3
  v_smfmac_f32_16x16x64_bf16 v[40:43], v[20:23], a[80:87], v3
  v_smfmac_f32_16x16x64_bf16 v[44:47], v[20:23], a[136:143], v3
  v_smfmac_f32_16x16x64_bf16 v[48:51], v[20:23], a[192:199], v3
  v_smfmac_f32_16x16x64_bf16 v[52:55], v[20:23], a[248:255], v3
  v_smfmac_f32_16x16x64_bf16 v[56:59], v[20:23], v[224:231], v3
  s_waitcnt lgkmcnt(0)
  v_smfmac_f32_16x16x64_bf16 v[60:63], v[20:23], v[64:71], v3
  ds_read_b128 v[72:75], v0 offset:8192
  ds_read_b128 v[76:79], v0 offset:9216
  v_smfmac_f32_16x16x64_bf16 v[36:39], v[24:27], a[32:39], v3
  v_smfmac_f32_16x16x64_bf16 v[40:43], v[24:27], a[88:95], v3
  v_smfmac_f32_16x16x64_bf16 v[44:47], v[24:27], a[144:151], v3
  v_smfmac_f32_16x16x64_bf16 v[48:51], v[24:27], a[200:207], v3
  v_smfmac_f32_16x16x64_bf16 v[52:55], v[24:27], v[176:183], v3
  v_smfmac_f32_16x16x64_bf16 v[56:59], v[24:27], v[232:239], v3
  s_waitcnt lgkmcnt(0)
  v_smfmac_f32_16x16x64_bf16 v[60:63], v[24:27], v[72:79], v3
  ds_read_b128 v[144:147], v0 offset:10240
  ds_read_b128 v[148:151], v0 offset:11264
  v_smfmac_f32_16x16x64_bf16 v[36:39], v[28:31], a[40:47], v3
  v_smfmac_f32_16x16x64_bf16 v[40:43], v[28:31], a[96:103], v3
  v_smfmac_f32_16x16x64_bf16 v[44:47], v[28:31], a[152:159], v3
  v_smfmac_f32_16x16x64_bf16 v[48:51], v[28:31], a[208:215], v3
  v_smfmac_f32_16x16x64_bf16 v[52:55], v[28:31], v[184:191], v3
  v_smfmac_f32_16x16x64_bf16 v[56:59], v[28:31], v[240:247], v3
  s_waitcnt lgkmcnt(0)
  v_smfmac_f32_16x16x64_bf16 v[60:63], v[28:31], v[144:151], v3
  ds_read_b128 v[64:67], v0 offset:12288
  ds_read_b128 v[68:71], v0 offset:13312
  v_smfmac_f32_16x16x64_bf16 v[36:39], v[32:35], a[48:55], v3
  v_smfmac_f32_16x16x64_bf16 v[40:43], v[32:35], a[104:111], v3
  v_smfmac_f32_16x16x64_bf16 v[44:47], v[32:35], a[160:167], v3
  v_smfmac_f32_16x16x64_bf16 v[48:51], v[32:35], a[216:223], v3
  v_smfmac_f32_16x16x64_bf16 v[52:55], v[32:35], v[192:199], v3
  v_smfmac_f32_16x16x64_bf16 v[56:59], v[32:35], v[248:255], v3
  s_waitcnt lgkmcnt(0)
  v_smfmac_f32_16x16x64_bf16 v[60:63], v[32:35], v[64:71], v3
  v_permlane32_swap_b32 v36, v38
  v_permlane32_swap_b32 v37, v39
  v_add_f32 v36, v36, v38
  v_add_f32 v37, v37, v39
  v_cvt_pk_bf16_f32 v38, v36, v37
  ds_write_b32 v152, v38
  v_permlane32_swap_b32 v40, v42
  v_permlane32_swap_b32 v41, v43
  v_add_f32 v40, v40, v42
  v_add_f32 v41, v41, v43
  v_cvt_pk_bf16_f32 v42, v40, v41
  ds_write_b32 v153, v42
  v_permlane32_swap_b32 v44, v46
  v_permlane32_swap_b32 v45, v47
  v_add_f32 v44, v44, v46
  v_add_f32 v45, v45, v47
  v_cvt_pk_bf16_f32 v46, v44, v45
  ds_write_b32 v154, v46
  v_permlane32_swap_b32 v48, v50
  v_permlane32_swap_b32 v49, v51
  v_add_f32 v48, v48, v50
  v_add_f32 v49, v49, v51
  v_cvt_pk_bf16_f32 v50, v48, v49
  ds_write_b32 v155, v50
  v_permlane32_swap_b32 v52, v54
  v_permlane32_swap_b32 v53, v55
  v_add_f32 v52, v52, v54
  v_add_f32 v53, v53, v55
  v_cvt_pk_bf16_f32 v54, v52, v53
  ds_write_b32 v156, v54
  v_permlane32_swap_b32 v56, v58
  v_permlane32_swap_b32 v57, v59
  v_add_f32 v56, v56, v58
  v_add_f32 v57, v57, v59
  v_cvt_pk_bf16_f32 v58, v56, v57
  ds_write_b32 v157, v58
  v_permlane32_swap_b32 v60, v62
  v_permlane32_swap_b32 v61, v63
  v_add_f32 v60, v60, v62
  v_add_f32 v61, v61, v63
  v_cvt_pk_bf16_f32 v62, v60, v61
  ds_write_b32 v158, v62
  s_branch cA_va1_t2d
cA_va1_last:
  s_barrier
  ds_read_b128 v[64:67], v2 offset:4096
  ds_read_b128 v[68:71], v2 offset:5120
  ds_read_b128 v[72:75], v2 offset:6144
  ds_read_b128 v[76:79], v2 offset:7168
  s_waitcnt lgkmcnt(0)
  v_min_u32 v64, -2, v64
  v_min_u32 v65, -2, v65
  v_min_u32 v66, -2, v66
  v_min_u32 v67, -2, v67
  v_min_u32 v68, -2, v68
  v_min_u32 v69, -2, v69
  v_min_u32 v70, -2, v70
  v_min_u32 v71, -2, v71
  v_min_u32 v72, -2, v72
  v_min_u32 v73, -2, v73
  v_min_u32 v74, -2, v74
  v_min_u32 v75, -2, v75
  v_min_u32 v76, -2, v76
  v_min_u32 v77, -2, v77
  v_min_u32 v78, -2, v78
  v_min_u32 v79, -2, v79
  buffer_store_dwordx4 v[64:67], v2, s[8:11], s33 offen offset:0 sc1
  buffer_store_dwordx4 v[68:71], v2, s[8:11], s33 offen offset:2048 sc1
  s_add_u32 s33, s33, 4096
  buffer_store_dwordx4 v[72:75], v2, s[8:11], s33 offen offset:0 sc1
  buffer_store_dwordx4 v[76:79], v2, s[8:11], s33 offen offset:2048 sc1
  s_add_u32 s33, s33, 4096
  s_waitcnt vmcnt(0)
  buffer_wbl2 sc1
  s_branch cA_done
cA_va1_rp:
  s_cmp_eq_u32 s37, 0
  s_cbranch_scc1 cA_va1_rv
  v_min_u32 v160, -2, v160
  buffer_store_dword v160, v1, s[8:11], s21 offen
  s_branch cA_va1_cont
cA_va1_rv:
  s_add_u32 s31, s31, 0x10000
  buffer_load_dwordx4 v[8:11], v2, s[8:11], s22 offen offset:0 sc1
  buffer_load_dwordx4 v[12:15], v2, s[8:11], s22 offen offset:1024 sc1
  buffer_load_dwordx4 v[16:19], v2, s[8:11], s22 offen offset:2048 sc1
  buffer_load_dwordx4 v[20:23], v2, s[8:11], s22 offen offset:3072 sc1
  buffer_load_dwordx4 v[24:27], v2, s[8:11], s34 offen offset:0 sc1
  buffer_load_dwordx4 v[28:31], v2, s[8:11], s34 offen offset:1024 sc1
  buffer_load_dwordx4 v[32:35], v2, s[8:11], s34 offen offset:2048 sc1
  buffer_load_dwordx4 v[36:39], v2, s[8:11], s34 offen offset:3072 sc1
  buffer_load_dwordx4 v[40:43], v2, s[8:11], s36 offen offset:0 sc1
  buffer_load_dwordx4 v[44:47], v2, s[8:11], s36 offen offset:1024 sc1
  s_waitcnt vmcnt(0)
  v_max3_u32 v52, v8, v9, v10
  v_max3_u32 v52, v52, v11, v12
  v_max3_u32 v52, v52, v13, v14
  v_max3_u32 v52, v52, v15, v16
  v_max3_u32 v52, v52, v17, v18
  v_max3_u32 v52, v52, v19, v20
  v_max3_u32 v52, v52, v21, v22
  v_max3_u32 v52, v52, v23, v24
  v_max3_u32 v52, v52, v25, v26
  v_max3_u32 v52, v52, v27, v28
  v_max3_u32 v52, v52, v29, v30
  v_max3_u32 v52, v52, v31, v32
  v_max3_u32 v52, v52, v33, v34
  v_max3_u32 v52, v52, v35, v36
  v_max3_u32 v52, v52, v37, v38
  v_max3_u32 v52, v52, v39, v40
  v_max3_u32 v52, v52, v41, v42
  v_max3_u32 v52, v52, v43, v44
  v_max3_u32 v52, v52, v45, v46
  v_max_u32 v52, v52, v47
  v_cmp_eq_u32 vcc, -1, v52
  s_mov_b32 s37, 1
  v_mov_b32 v48, 0
  v_mov_b32 v49, 0
  v_mov_b32 v50, 0
  v_mov_b32 v51, 0
  s_nop 1
  s_cbranch_vccz cA_va1_lp
  s_add_u32 s30, s30, 1
  s_cmp_lt_u32 s30, 400000
  s_cbranch_scc1 cA_va1_rv
  s_branch cA_abort
.p2align 6
cA_va2_loop:
  s_mov_b32 s30, 0
cA_va2_fp_l:
  v_cmp_gt_u32 vcc, s19, v96
  buffer_load_dword v96, v119, s[8:11], 0 offen sc1
  s_cbranch_vccz cA_va2_fp_d
  v_cmp_gt_u32 vcc, s19, v96
  buffer_load_dword v96, v119, s[8:11], 0 offen sc1
  s_cbranch_vccz cA_va2_fp_d
  v_cmp_gt_u32 vcc, s19, v96
  buffer_load_dword v96, v119, s[8:11], 0 offen sc1
  s_cbranch_vccz cA_va2_fp_d
  v_cmp_gt_u32 vcc, s19, v96
  buffer_load_dword v96, v119, s[8:11], 0 offen sc1
  s_cbranch_vccz cA_va2_fp_d
  v_cmp_gt_u32 vcc, s19, v96
  buffer_load_dword v96, v119, s[8:11], 0 offen sc1
  s_cbranch_vccz cA_va2_fp_d
  v_cmp_gt_u32 vcc, s19, v96
  buffer_load_dword v96, v119, s[8:11], 0 offen sc1
  s_cbranch_vccz cA_va2_fp_d
  v_cmp_gt_u32 vcc, s19, v96
  buffer_load_dword v96, v119, s[8:11], 0 offen sc1
  s_cbranch_vccz cA_va2_fp_d
  v_cmp_gt_u32 vcc, s19, v96
  buffer_load_dword v96, v119, s[8:11], 0 offen sc1
  s_cbranch_vccz cA_va2_fp_d
  v_cmp_gt_u32 vcc, s19, v96
  buffer_load_dword v96, v119, s[8:11], 0 offen sc1
  s_cbranch_vccz cA_va2_fp_d
  v_cmp_gt_u32 vcc, s19, v96
  buffer_load_dword v96, v119, s[8:11], 0 offen sc1
  s_cbranch_vccz cA_va2_fp_d
  v_cmp_gt_u32 vcc, s19, v96
  buffer_load_dword v96, v119, s[8:11], 0 offen sc1
  s_cbranch_vccz cA_va2_fp_d
  v_cmp_gt_u32 vcc, s19, v96
  buffer_load_dword v96, v119, s[8:11], 0 offen sc1
  s_cbranch_vccz cA_va2_fp_d
  v_cmp_gt_u32 vcc, s19, v96
  buffer_load_dword v96, v119, s[8:11], 0 offen sc1
  s_cbranch_vccz cA_va2_fp_d
  v_cmp_gt_u32 vcc, s19, v96
  buffer_load_dword v96, v119, s[8:11], 0 offen sc1
  s_cbranch_vccz cA_va2_fp_d
  v_cmp_gt_u32 vcc, s19, v96
  buffer_load_dword v96, v119, s[8:11], 0 offen sc1
  s_cbranch_vccz cA_va2_fp_d
  v_cmp_gt_u32 vcc, s19, v96
  buffer_load_dword v96, v119, s[8:11], 0 offen sc1
  s_cbranch_vccz cA_va2_fp_d
  s_waitcnt vmcnt(24)
  s_add_u32 s30, s30, 1
  s_cmp_lt_u32 s30, 400000
  s_cbranch_scc1 cA_va2_fp_l
  s_branch cA_abort
cA_va2_fp_d:
  buffer_load_dwordx4 v[8:11], v2, s[8:11], s20 offen offset:0 sc1
  buffer_load_dwordx4 v[12:15], v2, s[8:11], s20 offen offset:1024 sc1
  s_barrier
  s_barrier
  s_waitcnt vmcnt(0)
  ds_write_b128 v2, v[8:11] offset:8192
  ds_write_b128 v2, v[12:15] offset:9216
  v_smfmac_f32_16x16x64_bf16 v[36:39], v[8:11], a[0:7], v3
  v_smfmac_f32_16x16x64_bf16 v[40:43], v[8:11], a[56:63], v3
  v_smfmac_f32_16x16x64_bf16 v[44:47], v[8:11], a[112:119], v3
  v_smfmac_f32_16x16x64_bf16 v[48:51], v[8:11], a[168:175], v3
  v_smfmac_f32_16x16x64_bf16 v[52:55], v[8:11], a[224:231], v3
  s_waitcnt lgkmcnt(0)
  s_barrier
  ds_read_b128 v[16:19], v2 offset:10240
  ds_read_b128 v[20:23], v2 offset:11264
  ds_read_b128 v[24:27], v2 offset:12288
  ds_read_b128 v[28:31], v2 offset:13312
  ds_read_b128 v[32:35], v2 offset:14336
  v_smfmac_f32_16x16x64_bf16 v[56:59], v[8:11], v[144:151], v3
  v_smfmac_f32_16x16x64_bf16 v[60:63], v[8:11], v[200:207], v3
  v_smfmac_f32_16x16x64_bf16 v[36:39], v[12:15], a[8:15], v3
  v_smfmac_f32_16x16x64_bf16 v[40:43], v[12:15], a[64:71], v3
  v_smfmac_f32_16x16x64_bf16 v[44:47], v[12:15], a[120:127], v3
  v_smfmac_f32_16x16x64_bf16 v[48:51], v[12:15], a[176:183], v3
  v_smfmac_f32_16x16x64_bf16 v[52:55], v[12:15], a[232:239], v3
  v_smfmac_f32_16x16x64_bf16 v[56:59], v[12:15], v[152:159], v3
  ds_read_b128 v[68:71], v0 offset:0
  ds_read_b128 v[72:75], v0 offset:1024
  v_smfmac_f32_16x16x64_bf16 v[60:63], v[12:15], v[208:215], v3
  s_waitcnt lgkmcnt(6)
  ds_read_b128 v[76:79], v0 offset:2048
  ds_read_b128 v[80:83], v0 offset:3072
  v_smfmac_f32_16x16x64_bf16 v[36:39], v[16:19], a[16:23], v3
  s_waitcnt lgkmcnt(7)
  v_smfmac_f32_16x16x64_bf16 v[36:39], v[20:23], a[24:31], v3
  s_waitcnt lgkmcnt(6)
  v_smfmac_f32_16x16x64_bf16 v[36:39], v[24:27], a[32:39], v3
  s_waitcnt lgkmcnt(2)
  v_smfmac_f32_16x16x64_bf16 v[64:67], v[8:11], v[68:75], v3
  s_waitcnt lgkmcnt(5)
  ds_read_b128 v[84:87], v0 offset:4096
  ds_read_b128 v[88:91], v0 offset:5120
  v_smfmac_f32_16x16x64_bf16 v[36:39], v[28:31], a[40:47], v3
  s_waitcnt lgkmcnt(6)
  v_smfmac_f32_16x16x64_bf16 v[36:39], v[32:35], a[48:55], v3
  v_smfmac_f32_16x16x64_bf16 v[40:43], v[16:19], a[72:79], v3
  s_waitcnt lgkmcnt(2)
  v_smfmac_f32_16x16x64_bf16 v[64:67], v[12:15], v[76:83], v3
  ds_read_b128 v[68:71], v0 offset:6144
  ds_read_b128 v[72:75], v0 offset:7168
  v_smfmac_f32_16x16x64_bf16 v[40:43], v[20:23], a[80:87], v3
  v_permlane32_swap_b32 v36, v38
  v_smfmac_f32_16x16x64_bf16 v[40:43], v[24:27], a[88:95], v3
  v_permlane32_swap_b32 v37, v39
  v_smfmac_f32_16x16x64_bf16 v[40:43], v[28:31], a[96:103], v3
  s_waitcnt lgkmcnt(2)
  v_add_f32 v36, v36, v38
  v_smfmac_f32_16x16x64_bf16 v[64:67], v[16:19], v[84:91], v3
  ds_read_b128 v[76:79], v0 offset:8192
  ds_read_b128 v[80:83], v0 offset:9216
  v_add_f32 v37, v37, v39
  v_smfmac_f32_16x16x64_bf16 v[40:43], v[32:35], a[104:111], v3
  v_cmp_u_f32 vcc, v36, v37
  v_smfmac_f32_16x16x64_bf16 v[44:47], v[16:19], a[128:135], v3
  v_cvt_pk_bf16_f32 v38, v36, v37
  v_smfmac_f32_16x16x64_bf16 v[44:47], v[20:23], a[136:143], v3
  ds_write_b32 v104, v38
  s_waitcnt lgkmcnt(3)
  s_cbranch_vccnz cA_va2_slow
  v_permlane32_swap_b32 v40, v42
  v_smfmac_f32_16x16x64_bf16 v[64:67], v[20:23], v[68:75], v3
  ds_read_b128 v[84:87], v0 offset:10240
  ds_read_b128 v[88:91], v0 offset:11264
  v_permlane32_swap_b32 v41, v43
  v_smfmac_f32_16x16x64_bf16 v[44:47], v[24:27], a[144:151], v3
  v_add_f32 v40, v40, v42
  v_smfmac_f32_16x16x64_bf16 v[44:47], v[28:31], a[152:159], v3
  v_add_f32 v41, v41, v43
  v_smfmac_f32_16x16x64_bf16 v[44:47], v[32:35], a[160:167], v3
  s_waitcnt lgkmcnt(3)
  v_cvt_pk_bf16_f32 v42, v40, v41
  v_smfmac_f32_16x16x64_bf16 v[64:67], v[24:27], v[76:83], v3
  ds_write_b32 v105, v42
  ds_read_b128 v[68:71], v0 offset:12288
  ds_read_b128 v[72:75], v0 offset:13312
  v_smfmac_f32_16x16x64_bf16 v[48:51], v[16:19], a[184:191], v3
  s_nop 0
  v_permlane32_swap_b32 v44, v46
  v_smfmac_f32_16x16x64_bf16 v[48:51], v[20:23], a[192:199], v3
  v_permlane32_swap_b32 v45, v47
  v_smfmac_f32_16x16x64_bf16 v[48:51], v[24:27], a[200:207], v3
  s_waitcnt lgkmcnt(3)
  v_add_f32 v44, v44, v46
  v_smfmac_f32_16x16x64_bf16 v[64:67], v[28:31], v[84:91], v3
  v_add_f32 v45, v45, v47
  v_smfmac_f32_16x16x64_bf16 v[48:51], v[28:31], a[208:215], v3
  v_cvt_pk_bf16_f32 v46, v44, v45
  v_smfmac_f32_16x16x64_bf16 v[48:51], v[32:35], a[216:223], v3
  ds_write_b32 v106, v46
  v_smfmac_f32_16x16x64_bf16 v[52:55], v[16:19], a[240:247], v3
  s_waitcnt lgkmcnt(1)
  v_smfmac_f32_16x16x64_bf16 v[64:67], v[32:35], v[68:75], v3
  v_smfmac_f32_16x16x64_bf16 v[52:55], v[20:23], a[248:255], v3
  v_permlane32_swap_b32 v48, v50
  v_smfmac_f32_16x16x64_bf16 v[52:55], v[24:27], v[120:127], v3
  v_permlane32_swap_b32 v49, v51
  v_smfmac_f32_16x16x64_bf16 v[52:55], v[28:31], v[128:135], v3
  v_add_f32 v48, v48, v50
  v_smfmac_f32_16x16x64_bf16 v[52:55], v[32:35], v[136:143], v3
  v_add_f32 v49, v49, v51
  v_smfmac_f32_16x16x64_bf16 v[56:59], v[16:19], v[160:167], v3
  v_cvt_pk_bf16_f32 v50, v48, v49
  v_smfmac_f32_16x16x64_bf16 v[56:59], v[20:23], v[168:175], v3
  ds_write_b32 v107, v50
  v_permlane32_swap_b32 v64, v66
  v_smfmac_f32_16x16x64_bf16 v[56:59], v[24:27], v[176:183], v3
  v_permlane32_swap_b32 v65, v67
  v_smfmac_f32_16x16x64_bf16 v[56:59], v[28:31], v[184:191], v3
  v_add_f32 v64, v64, v66
  v_smfmac_f32_16x16x64_bf16 v[56:59], v[32:35], v[192:199], v3
  v_add_f32 v65, v65, v67
  v_smfmac_f32_16x16x64_bf16 v[60:63], v[16:19], v[216:223], v3
  v_cvt_pk_bf16_f32 v66, v64, v65
  v_smfmac_f32_16x16x64_bf16 v[60:63], v[20:23], v[224:231], v3
  ds_write_b32 v111, v66
  v_permlane32_swap_b32 v52, v54
  v_smfmac_f32_16x16x64_bf16 v[60:63], v[24:27], v[232:239], v3
  v_permlane32_swap_b32 v53, v55
  v_smfmac_f32_16x16x64_bf16 v[60:63], v[28:31], v[240:247], v3
  v_add_f32 v52, v52, v54
  v_smfmac_f32_16x16x64_bf16 v[60:63], v[32:35], v[248:255], v3
  v_add_f32 v53, v53, v55
  v_cvt_pk_bf16_f32 v54, v52, v53
  ds_write_b32 v108, v54
  v_permlane32_swap_b32 v56, v58
  v_permlane32_swap_b32 v57, v59
  v_add_f32 v56, v56, v58
  v_add_f32 v57, v57, v59
  v_cvt_pk_bf16_f32 v58, v56, v57
  ds_write_b32 v109, v58
  v_permlane32_swap_b32 v60, v62
  v_permlane32_swap_b32 v61, v63
  v_add_f32 v60, v60, v62
  v_add_f32 v61, v61, v63
  v_cvt_pk_bf16_f32 v62, v60, v61
  ds_write_b32 v110, v62
cA_va2_t2d:
  v_mov_b32 v117, s18
  s_waitcnt lgkmcnt(0)
  s_barrier
  s_cmp_eq_u32 s19, 63
  s_cbranch_scc1 cA_done
  s_sleep 1
  v_mov_b32 v36, 0
  v_mov_b32 v37, 0
  v_mov_b32 v38, 0
  v_mov_b32 v39, 0
  v_mov_b32 v40, 0
  v_mov_b32 v41, 0
  v_mov_b32 v42, 0
  v_mov_b32 v43, 0
  v_mov_b32 v44, 0
  v_mov_b32 v45, 0
  v_mov_b32 v46, 0
  v_mov_b32 v47, 0
  v_mov_b32 v48, 0
  v_mov_b32 v49, 0
  v_mov_b32 v50, 0
  v_mov_b32 v51, 0
  v_mov_b32 v52, 0
  v_mov_b32 v53, 0
  v_mov_b32 v54, 0
  v_mov_b32 v55, 0
  v_mov_b32 v56, 0
  v_mov_b32 v57, 0
  v_mov_b32 v58, 0
  v_mov_b32 v59, 0
  v_mov_b32 v60, 0
  v_mov_b32 v61, 0
  v_mov_b32 v62, 0
  v_mov_b32 v63, 0
  v_mov_b32 v64, 0
  v_mov_b32 v65, 0
  v_mov_b32 v66, 0
  v_mov_b32 v67, 0
  s_sleep 5
  s_mov_b32 s19, s18
  s_add_u32 s18, s18, 1
  s_mov_b32 s22, s20
  s_mov_b32 s20, s21
  s_mov_b32 s21, s22
  s_add_u32 s23, s20, 4096
  s_branch cA_va2_loop
cA_va2_slow:
  s_waitcnt lgkmcnt(0)
cA_va2_sl1:
  s_add_u32 s31, s31, 0x1000000
  buffer_load_dwordx4 v[8:11], v2, s[8:11], s20 offen offset:0 sc1
  buffer_load_dwordx4 v[12:15], v2, s[8:11], s20 offen offset:1024 sc1
  buffer_load_dwordx4 v[16:19], v2, s[8:11], s20 offen offset:2048 sc1
  buffer_load_dwordx4 v[20:23], v2, s[8:11], s20 offen offset:3072 sc1
  buffer_load_dwordx4 v[24:27], v2, s[8:11], s23 offen offset:0 sc1
  buffer_load_dwordx4 v[28:31], v2, s[8:11], s23 offen offset:1024 sc1
  buffer_load_dwordx4 v[32:35], v2, s[8:11], s23 offen offset:2048 sc1
  s_waitcnt vmcnt(0)
  v_max3_u32 v36, v8, v9, v10
  v_max3_u32 v36, v36, v11, v12
  v_max3_u32 v36, v36, v13, v14
  v_max3_u32 v36, v36, v15, v16
  v_max3_u32 v36, v36, v17, v18
  v_max3_u32 v36, v36, v19, v20
  v_max3_u32 v36, v36, v21, v22
  v_max3_u32 v36, v36, v23, v24
  v_max3_u32 v36, v36, v25, v26
  v_max3_u32 v36, v36, v27, v28
  v_max3_u32 v36, v36, v29, v30
  v_max3_u32 v36, v36, v31, v32
  v_max3_u32 v36, v36, v33, v34
  v_max_u32 v36, v36, v35
  v_cmp_eq_u32 vcc, -1, v36
  s_cbranch_vccz cA_va2_sl2
  s_add_u32 s30, s30, 1
  s_cmp_lt_u32 s30, 400000
  s_cbranch_scc1 cA_va2_sl1
  s_branch cA_abort
cA_va2_sl2:
  v_mov_b32 v36, 0
  v_mov_b32 v37, 0
  v_mov_b32 v38, 0
  v_mov_b32 v39, 0
  v_mov_b32 v40, 0
  v_mov_b32 v41, 0
  v_mov_b32 v42, 0
  v_mov_b32 v43, 0
  v_mov_b32 v44, 0
  v_mov_b32 v45, 0
  v_mov_b32 v46, 0
  v_mov_b32 v47, 0
  v_mov_b32 v48, 0
  v_mov_b32 v49, 0
  v_mov_b32 v50, 0
  v_mov_b32 v51, 0
  v_mov_b32 v52, 0
  v_mov_b32 v53, 0
  v_mov_b32 v54, 0
  v_mov_b32 v55, 0
  v_mov_b32 v56, 0
  v_mov_b32 v57, 0
  v_mov_b32 v58, 0
  v_mov_b32 v59, 0
  v_mov_b32 v60, 0
  v_mov_b32 v61, 0
  v_mov_b32 v62, 0
  v_mov_b32 v63, 0
  v_mov_b32 v64, 0
  v_mov_b32 v65, 0
  v_mov_b32 v66, 0
  v_mov_b32 v67, 0
  ds_read_b128 v[68:71], v0 offset:0
  ds_read_b128 v[72:75], v0 offset:1024
  v_smfmac_f32_16x16x64_bf16 v[36:39], v[8:11], a[0:7], v3
  v_smfmac_f32_16x16x64_bf16 v[40:43], v[8:11], a[56:63], v3
  v_smfmac_f32_16x16x64_bf16 v[44:47], v[8:11], a[112:119], v3
  v_smfmac_f32_16x16x64_bf16 v[48:51], v[8:11], a[168:175], v3
  v_smfmac_f32_16x16x64_bf16 v[52:55], v[8:11], a[224:231], v3
  v_smfmac_f32_16x16x64_bf16 v[56:59], v[8:11], v[144:151], v3
  v_smfmac_f32_16x16x64_bf16 v[60:63], v[8:11], v[200:207], v3
  s_waitcnt lgkmcnt(0)
  v_smfmac_f32_16x16x64_bf16 v[64:67], v[8:11], v[68:75], v3
  ds_read_b128 v[76:79], v0 offset:2048
  ds_read_b128 v[80:83], v0 offset:3072
  v_smfmac_f32_16x16x64_bf16 v[36:39], v[12:15], a[8:15], v3
  v_smfmac_f32_16x16x64_bf16 v[40:43], v[12:15], a[64:71], v3
  v_smfmac_f32_16x16x64_bf16 v[44:47], v[12:15], a[120:127], v3
  v_smfmac_f32_16x16x64_bf16 v[48:51], v[12:15], a[176:183], v3
  v_smfmac_f32_16x16x64_bf16 v[52:55], v[12:15], a[232:239], v3
  v_smfmac_f32_16x16x64_bf16 v[56:59], v[12:15], v[152:159], v3
  v_smfmac_f32_16x16x64_bf16 v[60:63], v[12:15], v[208:215], v3
  s_waitcnt lgkmcnt(0)
  v_smfmac_f32_16x16x64_bf16 v[64:67], v[12:15], v[76:83], v3
  ds_read_b128 v[84:87], v0 offset:4096
  ds_read_b128 v[88:91], v0 offset:5120
  v_smfmac_f32_16x16x64_bf16 v[36:39], v[16:19], a[16:23], v3
  v_smfmac_f32_16x16x64_bf16 v[40:43], v[16:19], a[72:79], v3
  v_smfmac_f32_16x16x64_bf16 v[44:47], v[16:19], a[128:135], v3
  v_smfmac_f32_16x16x64_bf16 v[48:51], v[16:19], a[184:191], v3
  v_smfmac_f32_16x16x64_bf16 v[52:55], v[16:19], a[240:247], v3
  v_smfmac_f32_16x16x64_bf16 v[56:59], v[16:19], v[160:167], v3
  v_smfmac_f32_16x16x64_bf16 v[60:63], v[16:19], v[216:223], v3
  s_waitcnt lgkmcnt(0)
  v_smfmac_f32_16x16x64_bf16 v[64:67], v[16:19], v[84:91], v3
  ds_read_b128 v[68:71], v0 offset:6144
  ds_read_b128 v[72:75], v0 offset:7168
  v_smfmac_f32_16x16x64_bf16 v[36:39], v[20:23], a[24:31], v3
  v_smfmac_f32_16x16x64_bf16 v[40:43], v[20:23], a[80:87], v3
  v_smfmac_f32_16x16x64_bf16 v[44:47], v[20:23], a[136:143], v3
  v_smfmac_f32_16x16x64_bf16 v[48:51], v[20:23], a[192:199], v3
  v_smfmac_f32_16x16x64_bf16 v[52:55], v[20:23], a[248:255], v3
  v_smfmac_f32_16x16x64_bf16 v[56:59], v[20:23], v[168:175], v3
  v_smfmac_f32_16x16x64_bf16 v[60:63], v[20:23], v[224:231], v3
  s_waitcnt lgkmcnt(0)
  v_smfmac_f32_16x16x64_bf16 v[64:67], v[20:23], v[68:75], v3
  ds_read_b128 v[76:79], v0 offset:8192
  ds_read_b128 v[80:83], v0 offset:9216
  v_smfmac_f32_16x16x64_bf16 v[36:39], v[24:27], a[32:39], v3
  v_smfmac_f32_16x16x64_bf16 v[40:43], v[24:27], a[88:95], v3
  v_smfmac_f32_16x16x64_bf16 v[44:47], v[24:27], a[144:151], v3
  v_smfmac_f32_16x16x64_bf16 v[48:51], v[24:27], a[200:207], v3
  v_smfmac_f32_16x16x64_bf16 v[52:55], v[24:27], v[120:127], v3
  v_smfmac_f32_16x16x64_bf16 v[56:59], v[24:27], v[176:183], v3
  v_smfmac_f32_16x16x64_bf16 v[60:63], v[24:27], v[232:239], v3
  s_waitcnt lgkmcnt(0)
  v_smfmac_f32_16x16x64_bf16 v[64:67], v[24:27], v[76:83], v3
  ds_read_b128 v[84:87], v0 offset:10240
  ds_read_b128 v[88:91], v0 offset:11264
  v_smfmac_f32_16x16x64_bf16 v[36:39], v[28:31], a[40:47], v3
  v_smfmac_f32_16x16x64_bf16 v[40:43], v[28:31], a[96:103], v3
  v_smfmac_f32_16x16x64_bf16 v[44:47], v[28:31], a[152:159], v3
  v_smfmac_f32_16x16x64_bf16 v[48:51], v[28:31], a[208:215], v3
  v_smfmac_f32_16x16x64_bf16 v[52:55], v[28:31], v[128:135], v3
  v_smfmac_f32_16x16x64_bf16 v[56:59], v[28:31], v[184:191], v3
  v_smfmac_f32_16x16x64_bf16 v[60:63], v[28:31], v[240:247], v3
  s_waitcnt lgkmcnt(0)
  v_smfmac_f32_16x16x64_bf16 v[64:67], v[28:31], v[84:91], v3
  ds_read_b128 v[68:71], v0 offset:12288
  ds_read_b128 v[72:75], v0 offset:13312
  v_smfmac_f32_16x16x64_bf16 v[36:39], v[32:35], a[48:55], v3
  v_smfmac_f32_16x16x64_bf16 v[40:43], v[32:35], a[104:111], v3
  v_smfmac_f32_16x16x64_bf16 v[44:47], v[32:35], a[160:167], v3
  v_smfmac_f32_16x16x64_bf16 v[48:51], v[32:35], a[216:223], v3
  v_smfmac_f32_16x16x64_bf16 v[52:55], v[32:35], v[136:143], v3
  v_smfmac_f32_16x16x64_bf16 v[56:59], v[32:35], v[192:199], v3
  v_smfmac_f32_16x16x64_bf16 v[60:63], v[32:35], v[248:255], v3
  s_waitcnt lgkmcnt(0)
  v_smfmac_f32_16x16x64_bf16 v[64:67], v[32:35], v[68:75], v3
  v_permlane32_swap_b32 v36, v38
  v_permlane32_swap_b32 v37, v39
  v_add_f32 v36, v36, v38
  v_add_f32 v37, v37, v39
  v_cvt_pk_bf16_f32 v38, v36, v37
  ds_write_b32 v104, v38
  v_permlane32_swap_b32 v40, v42
  v_permlane32_swap_b32 v41, v43
  v_add_f32 v40, v40, v42
  v_add_f32 v41, v41, v43
  v_cvt_pk_bf16_f32 v42, v40, v41
  ds_write_b32 v105, v42
  v_permlane32_swap_b32 v44, v46
  v_permlane32_swap_b32 v45, v47
  v_add_f32 v44, v44, v46
  v_add_f32 v45, v45, v47
  v_cvt_pk_bf16_f32 v46, v44, v45
  ds_write_b32 v106, v46
  v_permlane32_swap_b32 v48, v50
  v_permlane32_swap_b32 v49, v51
  v_add_f32 v48, v48, v50
  v_add_f32 v49, v49, v51
  v_cvt_pk_bf16_f32 v50, v48, v49
  ds_write_b32 v107, v50
  v_permlane32_swap_b32 v52, v54
  v_permlane32_swap_b32 v53, v55
  v_add_f32 v52, v52, v54
  v_add_f32 v53, v53, v55
  v_cvt_pk_bf16_f32 v54, v52, v53
  ds_write_b32 v108, v54
  v_permlane32_swap_b32 v56, v58
  v_permlane32_swap_b32 v57, v59
  v_add_f32 v56, v56, v58
  v_add_f32 v57, v57, v59
  v_cvt_pk_bf16_f32 v58, v56, v57
  ds_write_b32 v109, v58
  v_permlane32_swap_b32 v60, v62
  v_permlane32_swap_b32 v61, v63
  v_add_f32 v60, v60, v62
  v_add_f32 v61, v61, v63
  v_cvt_pk_bf16_f32 v62, v60, v61
  ds_write_b32 v110, v62
  v_permlane32_swap_b32 v64, v66
  v_permlane32_swap_b32 v65, v67
  v_add_f32 v64, v64, v66
  v_add_f32 v65, v65, v67
  v_cvt_pk_bf16_f32 v66, v64, v65
  ds_write_b32 v111, v66
  s_branch cA_va2_t2d
.p2align 6
cA_va3_loop:
  s_mov_b32 s30, 0
  s_barrier
  buffer_load_dwordx4 v[16:19], v2, s[8:11], s20 offen offset:2048 sc1
  buffer_load_dwordx4 v[20:23], v2, s[8:11], s20 offen offset:3072 sc1
  s_barrier
  buffer_load_dword v100, v116, s[8:11], s39 offen sc1
  s_add_u32 s27, s19, 2
  s_min_u32 s27, s27, 63
  s_lshr_b32 s27, s27, 3
  s_lshl_b32 s27, s27, 11
  s_add_u32 s27, s27, s35
  s_cmp_eq_u32 s27, s28
  s_cselect_b32 s29, 35328, s27
  buffer_load_dword v101, off, s[8:11], s29 sc1
  s_add_u32 s39, s39, 28672
  s_waitcnt vmcnt(2)
  ds_write_b128 v2, v[16:19] offset:10240
  ds_write_b128 v2, v[20:23] offset:11264
  v_smfmac_f32_16x16x64_bf16 v[36:39], v[16:19], a[16:23], v3
  v_smfmac_f32_16x16x64_bf16 v[40:43], v[16:19], a[72:79], v3
  v_smfmac_f32_16x16x64_bf16 v[44:47], v[16:19], a[128:135], v3
  v_smfmac_f32_16x16x64_bf16 v[48:51], v[16:19], a[184:191], v3
  v_smfmac_f32_16x16x64_bf16 v[52:55], v[16:19], a[240:247], v3
  s_waitcnt lgkmcnt(0)
  s_barrier
  ds_read_b128 v[8:11], v2 offset:8192
  ds_read_b128 v[12:15], v2 offset:9216
  ds_read_b128 v[24:27], v2 offset:12288
  ds_read_b128 v[28:31], v2 offset:13312
  ds_read_b128 v[32:35], v2 offset:14336
  v_smfmac_f32_16x16x64_bf16 v[56:59], v[16:19], v[160:167], v3
  v_smfmac_f32_16x16x64_bf16 v[60:63], v[16:19], v[216:223], v3
  v_smfmac_f32_16x16x64_bf16 v[36:39], v[20:23], a[24:31], v3
  v_smfmac_f32_16x16x64_bf16 v[40:43], v[20:23], a[80:87], v3
  v_smfmac_f32_16x16x64_bf16 v[44:47], v[20:23], a[136:143], v3
  v_smfmac_f32_16x16x64_bf16 v[48:51], v[20:23], a[192:199], v3
  v_smfmac_f32_16x16x64_bf16 v[52:55], v[20:23], a[248:255], v3
  v_smfmac_f32_16x16x64_bf16 v[56:59], v[20:23], v[168:175], v3
  v_smfmac_f32_16x16x64_bf16 v[60:63], v[20:23], v[224:231], v3
  s_waitcnt lgkmcnt(4)
  v_smfmac_f32_16x16x64_bf16 v[36:39], v[8:11], a[0:7], v3
  s_waitcnt lgkmcnt(3)
  v_smfmac_f32_16x16x64_bf16 v[36:39], v[12:15], a[8:15], v3
  s_waitcnt lgkmcnt(2)
  v_smfmac_f32_16x16x64_bf16 v[36:39], v[24:27], a[32:39], v3
  s_waitcnt lgkmcnt(1)
  v_smfmac_f32_16x16x64_bf16 v[36:39], v[28:31], a[40:47], v3
  s_waitcnt lgkmcnt(0)
  v_smfmac_f32_16x16x64_bf16 v[36:39], v[32:35], a[48:55], v3
  v_smfmac_f32_16x16x64_bf16 v[40:43], v[8:11], a[56:63], v3
  v_smfmac_f32_16x16x64_bf16 v[40:43], v[12:15], a[64:71], v3
  v_smfmac_f32_16x16x64_bf16 v[40:43], v[24:27], a[88:95], v3
  v_permlane32_swap_b32 v36, v38
  v_smfmac_f32_16x16x64_bf16 v[40:43], v[28:31], a[96:103], v3
  v_permlane32_swap_b32 v37, v39
  v_smfmac_f32_16x16x64_bf16 v[40:43], v[32:35], a[104:111], v3
  v_add_f32 v36, v36, v38
  v_smfmac_f32_16x16x64_bf16 v[44:47], v[8:11], a[112:119], v3
  v_add_f32 v37, v37, v39
  v_smfmac_f32_16x16x64_bf16 v[44:47], v[12:15], a[120:127], v3
  v_cmp_u_f32 vcc, v36, v37
  v_smfmac_f32_16x16x64_bf16 v[44:47], v[24:27], a[144:151], v3
  v_cvt_pk_bf16_f32 v38, v36, v37
  v_smfmac_f32_16x16x64_bf16 v[44:47], v[28:31], a[152:159], v3
  ds_write_b32 v104, v38
  s_cbranch_vccnz cA_va3_slow
  v_permlane32_swap_b32 v40, v42
  v_smfmac_f32_16x16x64_bf16 v[44:47], v[32:35], a[160:167], v3
  v_permlane32_swap_b32 v41, v43
  v_smfmac_f32_16x16x64_bf16 v[48:51], v[8:11], a[168:175], v3
  v_add_f32 v40, v40, v42
  v_smfmac_f32_16x16x64_bf16 v[48:51], v[12:15], a[176:183], v3
  v_add_f32 v41, v41, v43
  v_smfmac_f32_16x16x64_bf16 v[48:51], v[24:27], a[200:207], v3
  v_cvt_pk_bf16_f32 v42, v40, v41
  v_smfmac_f32_16x16x64_bf16 v[48:51], v[28:31], a[208:215], v3
  ds_write_b32 v105, v42
  v_permlane32_swap_b32 v44, v46
  v_smfmac_f32_16x16x64_bf16 v[48:51], v[32:35], a[216:223], v3
  v_permlane32_swap_b32 v45, v47
  v_smfmac_f32_16x16x64_bf16 v[52:55], v[8:11], a[224:231], v3
  v_add_f32 v44, v44, v46
  v_smfmac_f32_16x16x64_bf16 v[52:55], v[12:15], a[232:239], v3
  v_add_f32 v45, v45, v47
  v_smfmac_f32_16x16x64_bf16 v[52:55], v[24:27], v[120:127], v3
  v_cvt_pk_bf16_f32 v46, v44, v45
  v_smfmac_f32_16x16x64_bf16 v[52:55], v[28:31], v[128:135], v3
  ds_write_b32 v106, v46
  v_permlane32_swap_b32 v48, v50
  v_smfmac_f32_16x16x64_bf16 v[52:55], v[32:35], v[136:143], v3
  v_permlane32_swap_b32 v49, v51
  v_smfmac_f32_16x16x64_bf16 v[56:59], v[8:11], v[144:151], v3
  v_add_f32 v48, v48, v50
  v_smfmac_f32_16x16x64_bf16 v[56:59], v[12:15], v[152:159], v3
  v_add_f32 v49, v49, v51
  v_smfmac_f32_16x16x64_bf16 v[56:59], v[24:27], v[176:183], v3
  v_cvt_pk_bf16_f32 v50, v48, v49
  v_smfmac_f32_16x16x64_bf16 v[56:59], v[28:31], v[184:191], v3
  ds_write_b32 v107, v50
  v_permlane32_swap_b32 v52, v54
  v_smfmac_f32_16x16x64_bf16 v[56:59], v[32:35], v[192:199], v3
  v_permlane32_swap_b32 v53, v55
  v_smfmac_f32_16x16x64_bf16 v[60:63], v[8:11], v[200:207], v3
  v_add_f32 v52, v52, v54
  v_smfmac_f32_16x16x64_bf16 v[60:63], v[12:15], v[208:215], v3
  v_add_f32 v53, v53, v55
  v_smfmac_f32_16x16x64_bf16 v[60:63], v[24:27], v[232:239], v3
  v_cvt_pk_bf16_f32 v54, v52, v53
  v_smfmac_f32_16x16x64_bf16 v[60:63], v[28:31], v[240:247], v3
  ds_write_b32 v108, v54
  v_permlane32_swap_b32 v56, v58
  v_smfmac_f32_16x16x64_bf16 v[60:63], v[32:35], v[248:255], v3
  v_permlane32_swap_b32 v57, v59
  v_add_f32 v56, v56, v58
  v_add_f32 v57, v57, v59
  v_cvt_pk_bf16_f32 v58, v56, v57
  ds_write_b32 v109, v58
  s_nop 2
  v_permlane32_swap_b32 v60, v62
  v_permlane32_swap_b32 v61, v63
  v_add_f32 v60, v60, v62
  v_add_f32 v61, v61, v63
  v_cvt_pk_bf16_f32 v62, v60, v61
  ds_write_b32 v110, v62
cA_va3_t2d:
  v_mov_b32 v117, s18
  s_cmp_eq_u32 s27, s28
  s_cbranch_scc1 cA_va3_vok
cA_va3_vow:
  s_waitcnt vmcnt(0)
  v_cmp_ne_u32 vcc, 56, v101
  s_cbranch_vccnz cA_va3_vor
  s_mov_b32 s28, s27
cA_va3_vok:
  s_waitcnt lgkmcnt(0)
  s_setprio 3
  s_barrier
  v_mov_b32 v36, 0
  v_mov_b32 v37, 0
  buffer_store_dword v117, v118, s[8:11], 0 offen
  s_setprio 0
  s_cmp_eq_u32 s19, 63
  s_cbranch_scc1 cA_done
  v_mov_b32 v38, 0
  v_mov_b32 v39, 0
  v_mov_b32 v40, 0
  v_mov_b32 v41, 0
  v_mov_b32 v42, 0
  v_mov_b32 v43, 0
  v_mov_b32 v44, 0
  v_mov_b32 v45, 0
  v_mov_b32 v46, 0
  v_mov_b32 v47, 0
  v_mov_b32 v48, 0
  v_mov_b32 v49, 0
  v_mov_b32 v50, 0
  v_mov_b32 v51, 0
  v_mov_b32 v52, 0
  v_mov_b32 v53, 0
  v_mov_b32 v54, 0
  v_mov_b32 v55, 0
  v_mov_b32 v56, 0
  v_mov_b32 v57, 0
  v_mov_b32 v58, 0
  v_mov_b32 v59, 0
  v_mov_b32 v60, 0
  v_mov_b32 v61, 0
  v_mov_b32 v62, 0
  v_mov_b32 v63, 0
  s_mov_b32 s19, s18
  s_add_u32 s18, s18, 1
  s_mov_b32 s22, s20
  s_mov_b32 s20, s21
  s_mov_b32 s21, s22
  s_add_u32 s23, s20, 4096
  s_branch cA_va3_loop
cA_va3_slow:
  s_waitcnt lgkmcnt(0)
cA_va3_sl1:
  s_add_u32 s31, s31, 0x1000000
  buffer_load_dwordx4 v[8:11], v2, s[8:11], s20 offen offset:0 sc1
  buffer_load_dwordx4 v[12:15], v2, s[8:11], s20 offen offset:1024 sc1
  buffer_load_dwordx4 v[16:19], v2, s[8:11], s20 offen offset:2048 sc1
  buffer_load_dwordx4 v[20:23], v2, s[8:11], s20 offen offset:3072 sc1
  buffer_load_dwordx4 v[24:27], v2, s[8:11], s23 offen offset:0 sc1
  buffer_load_dwordx4 v[28:31], v2, s[8:11], s23 offen offset:1024 sc1
  buffer_load_dwordx4 v[32:35], v2, s[8:11], s23 offen offset:2048 sc1
  s_waitcnt vmcnt(0)
  v_max3_u32 v36, v8, v9, v10
  v_max3_u32 v36, v36, v11, v12
  v_max3_u32 v36, v36, v13, v14
  v_max3_u32 v36, v36, v15, v16
  v_max3_u32 v36, v36, v17, v18
  v_max3_u32 v36, v36, v19, v20
  v_max3_u32 v36, v36, v21, v22
  v_max3_u32 v36, v36, v23, v24
  v_max3_u32 v36, v36, v25, v26
  v_max3_u32 v36, v36, v27, v28
  v_max3_u32 v36, v36, v29, v30
  v_max3_u32 v36, v36, v31, v32
  v_max3_u32 v36, v36, v33, v34
  v_max_u32 v36, v36, v35
  v_cmp_eq_u32 vcc, -1, v36
  s_cbranch_vccz cA_va3_sl2
  s_add_u32 s30, s30, 1
  s_cmp_lt_u32 s30, 400000
  s_cbranch_scc1 cA_va3_sl1
  s_branch cA_abort
cA_va3_sl2:
  v_mov_b32 v36, 0
  v_mov_b32 v37, 0
  v_mov_b32 v38, 0
  v_mov_b32 v39, 0
  v_mov_b32 v40, 0
  v_mov_b32 v41, 0
  v_mov_b32 v42, 0
  v_mov_b32 v43, 0
  v_mov_b32 v44, 0
  v_mov_b32 v45, 0
  v_mov_b32 v46, 0
  v_mov_b32 v47, 0
  v_mov_b32 v48, 0
  v_mov_b32 v49, 0
  v_mov_b32 v50, 0
  v_mov_b32 v51, 0
  v_mov_b32 v52, 0
  v_mov_b32 v53, 0
  v_mov_b32 v54, 0
  v_mov_b32 v55, 0
  v_mov_b32 v56, 0
  v_mov_b32 v57, 0
  v_mov_b32 v58, 0
  v_mov_b32 v59, 0
  v_mov_b32 v60, 0
  v_mov_b32 v61, 0
  v_mov_b32 v62, 0
  v_mov_b32 v63, 0
  v_smfmac_f32_16x16x64_bf16 v[36:39], v[8:11], a[0:7], v3
  v_smfmac_f32_16x16x64_bf16 v[40:43], v[8:11], a[56:63], v3
  v_smfmac_f32_16x16x64_bf16 v[44:47], v[8:11], a[112:119], v3
  v_smfmac_f32_16x16x64_bf16 v[48:51], v[8:11], a[168:175], v3
  v_smfmac_f32_16x16x64_bf16 v[52:55], v[8:11], a[224:231], v3
  v_smfmac_f32_16x16x64_bf16 v[56:59], v[8:11], v[144:151], v3
  v_smfmac_f32_16x16x64_bf16 v[60:63], v[8:11], v[200:207], v3
  v_smfmac_f32_16x16x64_bf16 v[36:39], v[12:15], a[8:15], v3
  v_smfmac_f32_16x16x64_bf16 v[40:43], v[12:15], a[64:71], v3
  v_smfmac_f32_16x16x64_bf16 v[44:47], v[12:15], a[120:127], v3
  v_smfmac_f32_16x16x64_bf16 v[48:51], v[12:15], a[176:183], v3
  v_smfmac_f32_16x16x64_bf16 v[52:55], v[12:15], a[232:239], v3
  v_smfmac_f32_16x16x64_bf16 v[56:59], v[12:15], v[152:159], v3
  v_smfmac_f32_16x16x64_bf16 v[60:63], v[12:15], v[208:215], v3
  v_smfmac_f32_16x16x64_bf16 v[36:39], v[16:19], a[16:23], v3
  v_smfmac_f32_16x16x64_bf16 v[40:43], v[16:19], a[72:79], v3
  v_smfmac_f32_16x16x64_bf16 v[44:47], v[16:19], a[128:135], v3
  v_smfmac_f32_16x16x64_bf16 v[48:51], v[16:19], a[184:191], v3
  v_smfmac_f32_16x16x64_bf16 v[52:55], v[16:19], a[240:247], v3
  v_smfmac_f32_16x16x64_bf16 v[56:59], v[16:19], v[160:167], v3
  v_smfmac_f32_16x16x64_bf16 v[60:63], v[16:19], v[216:223], v3
  v_smfmac_f32_16x16x64_bf16 v[36:39], v[20:23], a[24:31], v3
  v_smfmac_f32_16x16x64_bf16 v[40:43], v[20:23], a[80:87], v3
  v_smfmac_f32_16x16x64_bf16 v[44:47], v[20:23], a[136:143], v3
  v_smfmac_f32_16x16x64_bf16 v[48:51], v[20:23], a[192:199], v3
  v_smfmac_f32_16x16x64_bf16 v[52:55], v[20:23], a[248:255], v3
  v_smfmac_f32_16x16x64_bf16 v[56:59], v[20:23], v[168:175], v3
  v_smfmac_f32_16x16x64_bf16 v[60:63], v[20:23], v[224:231], v3
  v_smfmac_f32_16x16x64_bf16 v[36:39], v[24:27], a[32:39], v3
  v_smfmac_f32_16x16x64_bf16 v[40:43], v[24:27], a[88:95], v3
  v_smfmac_f32_16x16x64_bf16 v[44:47], v[24:27], a[144:151], v3
  v_smfmac_f32_16x16x64_bf16 v[48:51], v[24:27], a[200:207], v3
  v_smfmac_f32_16x16x64_bf16 v[52:55], v[24:27], v[120:127], v3
  v_smfmac_f32_16x16x64_bf16 v[56:59], v[24:27], v[176:183], v3
  v_smfmac_f32_16x16x64_bf16 v[60:63], v[24:27], v[232:239], v3
  v_smfmac_f32_16x16x64_bf16 v[36:39], v[28:31], a[40:47], v3
  v_smfmac_f32_16x16x64_bf16 v[40:43], v[28:31], a[96:103], v3
  v_smfmac_f32_16x16x64_bf16 v[44:47], v[28:31], a[152:159], v3
  v_smfmac_f32_16x16x64_bf16 v[48:51], v[28:31], a[208:215], v3
  v_smfmac_f32_16x16x64_bf16 v[52:55], v[28:31], v[128:135], v3
  v_smfmac_f32_16x16x64_bf16 v[56:59], v[28:31], v[184:191], v3
  v_smfmac_f32_16x16x64_bf16 v[60:63], v[28:31], v[240:247], v3
  v_smfmac_f32_16x16x64_bf16 v[36:39], v[32:35], a[48:55], v3
  v_smfmac_f32_16x16x64_bf16 v[40:43], v[32:35], a[104:111], v3
  v_smfmac_f32_16x16x64_bf16 v[44:47], v[32:35], a[160:167], v3
  v_smfmac_f32_16x16x64_bf16 v[48:51], v[32:35], a[216:223], v3
  v_smfmac_f32_16x16x64_bf16 v[52:55], v[32:35], v[136:143], v3
  v_smfmac_f32_16x16x64_bf16 v[56:59], v[32:35], v[192:199], v3
  v_smfmac_f32_16x16x64_bf16 v[60:63], v[32:35], v[248:255], v3
  v_permlane32_swap_b32 v36, v38
  v_permlane32_swap_b32 v37, v39
  v_add_f32 v36, v36, v38
  v_add_f32 v37, v37, v39
  v_cvt_pk_bf16_f32 v38, v36, v37
  ds_write_b32 v104, v38
  v_permlane32_swap_b32 v40, v42
  v_permlane32_swap_b32 v41, v43
  v_add_f32 v40, v40, v42
  v_add_f32 v41, v41, v43
  v_cvt_pk_bf16_f32 v42, v40, v41
  ds_write_b32 v105, v42
  v_permlane32_swap_b32 v44, v46
  v_permlane32_swap_b32 v45, v47
  v_add_f32 v44, v44, v46
  v_add_f32 v45, v45, v47
  v_cvt_pk_bf16_f32 v46, v44, v45
  ds_write_b32 v106, v46
  v_permlane32_swap_b32 v48, v50
  v_permlane32_swap_b32 v49, v51
  v_add_f32 v48, v48, v50
  v_add_f32 v49, v49, v51
  v_cvt_pk_bf16_f32 v50, v48, v49
  ds_write_b32 v107, v50
  v_permlane32_swap_b32 v52, v54
  v_permlane32_swap_b32 v53, v55
  v_add_f32 v52, v52, v54
  v_add_f32 v53, v53, v55
  v_cvt_pk_bf16_f32 v54, v52, v53
  ds_write_b32 v108, v54
  v_permlane32_swap_b32 v56, v58
  v_permlane32_swap_b32 v57, v59
  v_add_f32 v56, v56, v58
  v_add_f32 v57, v57, v59
  v_cvt_pk_bf16_f32 v58, v56, v57
  ds_write_b32 v109, v58
  v_permlane32_swap_b32 v60, v62
  v_permlane32_swap_b32 v61, v63
  v_add_f32 v60, v60, v62
  v_add_f32 v61, v61, v63
  v_cvt_pk_bf16_f32 v62, v60, v61
  ds_write_b32 v110, v62
  s_branch cA_va3_t2d
cA_va3_vor:
  s_sleep 2
  buffer_load_dword v101, off, s[8:11], s27 sc1
  s_add_u32 s30, s30, 1
  s_cmp_lt_u32 s30, 400000
  s_cbranch_scc1 cA_va3_vow
  s_branch cA_abort
cA_abort:
  v_mov_b32 v4, 0xdead
  v_mov_b32 v5, 16
  buffer_store_dword v4, v5, s[12:15], 0 offen
  s_branch ch_end
cA_done:
  s_branch ch_end
.p2align 6
cB_sc0_loop:
  s_mov_b32 s30, 0
  s_mov_b32 s62, 0
  s_setprio 3
  s_sleep 6
cB_sc0_fp_l:
  v_cmp_gt_u32 vcc, s19, v112
  buffer_load_dword v112, v0, s[8:11], 0 offen sc1
  s_cbranch_vccz cB_sc0_fp_d
  v_cmp_gt_u32 vcc, s19, v112
  buffer_load_dword v112, v0, s[8:11], 0 offen sc1
  s_cbranch_vccz cB_sc0_fp_d
  v_cmp_gt_u32 vcc, s19, v112
  buffer_load_dword v112, v0, s[8:11], 0 offen sc1
  s_cbranch_vccz cB_sc0_fp_d
  v_cmp_gt_u32 vcc, s19, v112
  buffer_load_dword v112, v0, s[8:11], 0 offen sc1
  s_cbranch_vccz cB_sc0_fp_d
  v_cmp_gt_u32 vcc, s19, v112
  buffer_load_dword v112, v0, s[8:11], 0 offen sc1
  s_cbranch_vccz cB_sc0_fp_d
  v_cmp_gt_u32 vcc, s19, v112
  buffer_load_dword v112, v0, s[8:11], 0 offen sc1
  s_cbranch_vccz cB_sc0_fp_d
  v_cmp_gt_u32 vcc, s19, v112
  buffer_load_dword v112, v0, s[8:11], 0 offen sc1
  s_cbranch_vccz cB_sc0_fp_d
  v_cmp_gt_u32 vcc, s19, v112
  buffer_load_dword v112, v0, s[8:11], 0 offen sc1
  s_cbranch_vccz cB_sc0_fp_d
  v_cmp_gt_u32 vcc, s19, v112
  buffer_load_dword v112, v0, s[8:11], 0 offen sc1
  s_cbranch_vccz cB_sc0_fp_d
  v_cmp_gt_u32 vcc, s19, v112
  buffer_load_dword v112, v0, s[8:11], 0 offen sc1
  s_cbranch_vccz cB_sc0_fp_d
  v_cmp_gt_u32 vcc, s19, v112
  buffer_load_dword v112, v0, s[8:11], 0 offen sc1
  s_cbranch_vccz cB_sc0_fp_d
  v_cmp_gt_u32 vcc, s19, v112
  buffer_load_dword v112, v0, s[8:11], 0 offen sc1
  s_cbranch_vccz cB_sc0_fp_d
  v_cmp_gt_u32 vcc, s19, v112
  buffer_load_dword v112, v0, s[8:11], 0 offen sc1
  s_cbranch_vccz cB_sc0_fp_d
  v_cmp_gt_u32 vcc, s19, v112
  buffer_load_dword v112, v0, s[8:11], 0 offen sc1
  s_cbranch_vccz cB_sc0_fp_d
  v_cmp_gt_u32 vcc, s19, v112
  buffer_load_dword v112, v0, s[8:11], 0 offen sc1
  s_cbranch_vccz cB_sc0_fp_d
  v_cmp_gt_u32 vcc, s19, v112
  buffer_load_dword v112, v0, s[8:11], 0 offen sc1
  s_cbranch_vccz cB_sc0_fp_d
  s_waitcnt vmcnt(24)
  s_add_u32 s30, s30, 1
  s_cmp_lt_u32 s30, 400000
  s_cbranch_scc1 cB_sc0_fp_l
  s_branch cB_abort
cB_sc0_fp_d:
  buffer_load_dwordx4 v[8:11], v2, s[8:11], s20 offen offset:0 sc1
  s_barrier
  s_setprio 2
  buffer_load_dwordx4 v[12:15], v2, s[8:11], s20 offen offset:1024 sc1
  s_setprio 1
  buffer_load_dwordx4 v[16:19], v2, s[8:11], s20 offen offset:2048 sc1
  s_setprio 0
  buffer_load_dwordx4 v[20:23], v2, s[8:11], s20 offen offset:3072 sc1
cB_sc0_go:
  s_waitcnt vmcnt(3)
  v_smfmac_f32_16x16x64_bf16 v[36:39], v[8:11], a[0:7], v3
  buffer_load_dwordx4 v[32:35], v2, s[8:11], s23 offen offset:0 sc1
  v_cmp_eq_u32 vcc, -1, v8
  v_smfmac_f32_16x16x64_bf16 v[40:43], v[8:11], a[56:63], v3
  v_smfmac_f32_16x16x64_bf16 v[44:47], v[8:11], a[112:119], v3
  buffer_load_dwordx4 v[24:27], v2, s[8:11], s23 offen offset:1024 sc1
  s_cbranch_vccnz cB_sc0_r0
  v_smfmac_f32_16x16x64_bf16 v[48:51], v[8:11], a[168:175], v3
  v_smfmac_f32_16x16x64_bf16 v[52:55], v[8:11], a[224:231], v3
  s_waitcnt vmcnt(4)
  v_cmp_eq_u32 vcc, -1, v12
  v_smfmac_f32_16x16x64_bf16 v[56:59], v[8:11], v[144:151], v3
  buffer_load_dwordx4 v[28:31], v2, s[8:11], s23 offen offset:2048 sc1
  v_smfmac_f32_16x16x64_bf16 v[60:63], v[8:11], v[200:207], v3
  s_cbranch_vccnz cB_sc0_r1
cB_sc0_c1:
  v_smfmac_f32_16x16x64_bf16 v[36:39], v[12:15], a[8:15], v3
  v_smfmac_f32_16x16x64_bf16 v[40:43], v[12:15], a[64:71], v3
  v_smfmac_f32_16x16x64_bf16 v[44:47], v[12:15], a[120:127], v3
  v_smfmac_f32_16x16x64_bf16 v[48:51], v[12:15], a[176:183], v3
  v_smfmac_f32_16x16x64_bf16 v[52:55], v[12:15], a[232:239], v3
  s_waitcnt vmcnt(4)
  v_cmp_eq_u32 vcc, -1, v16
  v_smfmac_f32_16x16x64_bf16 v[56:59], v[12:15], v[152:159], v3
  buffer_load_dwordx4 v[88:91], v117, s[8:11], s26 offen offset:0 sc1
  v_smfmac_f32_16x16x64_bf16 v[60:63], v[12:15], v[208:215], v3
  s_cbranch_vccnz cB_sc0_r2
cB_sc0_c2:
  v_smfmac_f32_16x16x64_bf16 v[36:39], v[16:19], a[16:23], v3
  v_smfmac_f32_16x16x64_bf16 v[40:43], v[16:19], a[72:79], v3
  v_smfmac_f32_16x16x64_bf16 v[44:47], v[16:19], a[128:135], v3
  buffer_load_dwordx4 v[92:95], v117, s[8:11], s26 offen offset:1024 sc1
  v_smfmac_f32_16x16x64_bf16 v[48:51], v[16:19], a[184:191], v3
  v_smfmac_f32_16x16x64_bf16 v[52:55], v[16:19], a[240:247], v3
  s_waitcnt vmcnt(5)
  v_cmp_eq_u32 vcc, -1, v20
  v_smfmac_f32_16x16x64_bf16 v[56:59], v[16:19], v[160:167], v3
  v_smfmac_f32_16x16x64_bf16 v[60:63], v[16:19], v[216:223], v3
  buffer_load_dwordx4 v[96:99], v2, s[8:11], s24 offen offset:0 sc1
  s_cbranch_vccnz cB_sc0_r3
cB_sc0_c3:
  v_smfmac_f32_16x16x64_bf16 v[36:39], v[20:23], a[24:31], v3
  v_smfmac_f32_16x16x64_bf16 v[40:43], v[20:23], a[80:87], v3
  s_waitcnt vmcnt(3)
  v_max3_u32 v66, v24, v27, v28
  v_smfmac_f32_16x16x64_bf16 v[44:47], v[20:23], a[136:143], v3
  v_max3_u32 v66, v66, v31, v32
  v_smfmac_f32_16x16x64_bf16 v[48:51], v[20:23], a[192:199], v3
  buffer_load_dwordx4 v[100:103], v2, s[8:11], s24 offen offset:1024 sc1
  v_max_u32 v66, v66, v35
  v_smfmac_f32_16x16x64_bf16 v[52:55], v[20:23], a[248:255], v3
  v_cmp_eq_u32 vcc, -1, v66
  v_smfmac_f32_16x16x64_bf16 v[56:59], v[20:23], v[168:175], v3
  v_smfmac_f32_16x16x64_bf16 v[60:63], v[20:23], v[224:231], v3
  s_cbranch_vccnz cB_sc0_r4
cB_sc0_c4:
  v_smfmac_f32_16x16x64_bf16 v[60:63], v[32:35], v[232:239], v3
  buffer_load_dwordx4 v[104:107], v2, s[8:11], s26 offen offset:0 sc1
  v_smfmac_f32_16x16x64_bf16 v[60:63], v[24:27], v[240:247], v3
  v_smfmac_f32_16x16x64_bf16 v[60:63], v[28:31], v[248:255], v3
  v_smfmac_f32_16x16x64_bf16 v[52:55], v[32:35], v[120:127], v3
  v_smfmac_f32_16x16x64_bf16 v[52:55], v[24:27], v[128:135], v3
  buffer_load_dwordx4 v[108:111], v2, s[8:11], s26 offen offset:1024 sc1
  v_smfmac_f32_16x16x64_bf16 v[52:55], v[28:31], v[136:143], v3
  v_cvt_pk_bf16_f32 v63, v62, v63
  v_smfmac_f32_16x16x64_bf16 v[56:59], v[32:35], v[176:183], v3
  v_cvt_pk_bf16_f32 v62, v60, v61
  v_smfmac_f32_16x16x64_bf16 v[56:59], v[24:27], v[184:191], v3
  v_mfma_f32_16x16x32_bf16 v[12:15], v[62:65], v[4:7], 0
  v_cvt_pk_bf16_f32 v55, v54, v55
  v_smfmac_f32_16x16x64_bf16 v[56:59], v[28:31], v[192:199], v3
  v_cvt_pk_bf16_f32 v54, v52, v53
  v_smfmac_f32_16x16x64_bf16 v[36:39], v[32:35], a[32:39], v3
  s_nop 1
  v_cvt_pk_bf16_f32 v76, v12, v13
  v_smfmac_f32_16x16x64_bf16 v[36:39], v[24:27], a[40:47], v3
  v_cvt_pk_bf16_f32 v77, v14, v15
  v_smfmac_f32_16x16x64_bf16 v[36:39], v[28:31], a[48:55], v3
  v_cvt_pk_bf16_f32 v56, v56, v57
  v_smfmac_f32_16x16x64_bf16 v[40:43], v[32:35], a[88:95], v3
  v_cvt_pk_bf16_f32 v57, v58, v59
  v_smfmac_f32_16x16x64_bf16 v[40:43], v[24:27], a[96:103], v3
  v_mfma_f32_16x16x32_bf16 v[16:19], v[54:57], v[4:7], 0
  v_cvt_pk_bf16_f32 v39, v38, v39
  v_smfmac_f32_16x16x64_bf16 v[40:43], v[28:31], a[104:111], v3
  v_cvt_pk_bf16_f32 v38, v36, v37
  v_smfmac_f32_16x16x64_bf16 v[44:47], v[32:35], a[144:151], v3
  s_nop 1
  v_cvt_pk_bf16_f32 v78, v16, v17
  v_smfmac_f32_16x16x64_bf16 v[44:47], v[24:27], a[152:159], v3
  v_cvt_pk_bf16_f32 v79, v18, v19
  v_smfmac_f32_16x16x64_bf16 v[44:47], v[28:31], a[160:167], v3
  v_cvt_pk_bf16_f32 v40, v40, v41
  v_smfmac_f32_16x16x64_bf16 v[48:51], v[32:35], a[200:207], v3
  v_cvt_pk_bf16_f32 v41, v42, v43
  v_smfmac_f32_16x16x64_bf16 v[48:51], v[24:27], a[208:215], v3
  v_smfmac_f32_16x16x64_bf16 v[48:51], v[28:31], a[216:223], v3
  s_waitcnt vmcnt(4)
  v_cvt_pk_bf16_f32 v47, v46, v47
  v_smfmac_f32_16x16x64_bf16 v[68:71], v[76:79], v[80:87], v3
  v_cvt_pk_bf16_f32 v46, v44, v45
  v_mfma_f32_16x16x32_bf16 v[12:15], v[38:41], v[4:7], 0
  s_nop 1
  v_cvt_pk_bf16_f32 v48, v48, v49
  v_cvt_pk_bf16_f32 v49, v50, v51
  s_nop 1
  v_mfma_f32_16x16x32_bf16 v[16:19], v[46:49], v[4:7], 0
  v_smfmac_f32_16x16x64_bf16 v[72:75], v[76:79], v[88:95], v3
  v_cvt_pk_bf16_f32 v20, v12, v13
  v_mfma_f32_16x16x32_bf16 v[52:55], v[30:33], v[76:79], 0
  s_waitcnt vmcnt(0)
  v_cvt_pk_bf16_f32 v21, v14, v15
  v_cvt_pk_bf16_f32 v22, v16, v17
  v_cvt_pk_bf16_f32 v23, v18, v19
  s_nop 1
  v_mfma_f32_16x16x32_bf16 v[52:55], v[8:11], v[20:23], v[52:55]
  v_smfmac_f32_16x16x64_bf16 v[68:71], v[20:23], v[96:103], v3
  v_smfmac_f32_16x16x64_bf16 v[72:75], v[20:23], v[104:111], v3
  s_nop 1
  ds_write_b128 v113, v[52:55]
  s_nop 1
  v_permlane32_swap_b32 v68, v70
  v_permlane32_swap_b32 v69, v71
  v_add_f32 v56, v68, v70
  v_add_f32 v58, v69, v71
  v_permlane32_swap_b32 v72, v74
  v_permlane32_swap_b32 v73, v75
  v_add_f32 v57, v72, v74
  v_add_f32 v59, v73, v75
  ds_write_b128 v2, v[56:59] offset:0
  v_cmp_u_f32 vcc, v57, v59
  v_mov_b32 v68, 0
  v_mov_b32 v69, 0
  v_mov_b32 v70, 0
  v_mov_b32 v71, 0
  s_cbranch_vccnz cB_sc0_retry
cB_sc0_cont:
  s_add_u32 s24, s24, 28672
  s_add_u32 s26, s26, 28672
  buffer_load_dwordx4 v[80:83], v117, s[8:11], s24 offen offset:0 sc1
  buffer_load_dwordx4 v[84:87], v117, s[8:11], s24 offen offset:1024 sc1
  v_mov_b32 v72, 0
  v_mov_b32 v73, 0
  v_mfma_f32_32x32x16_bf16 v[36:51], v[68:71], v[68:71], 0
  s_waitcnt lgkmcnt(0)
  s_barrier
  ds_read_b64 v[8:9], v114 offset:0
  ds_read_b64 v[10:11], v114 offset:1024
  ds_read_b64 v[12:13], v114 offset:2048
  ds_read_b64 v[14:15], v114 offset:3072
  ds_read2_b32 v[16:17], v115 offset0:0 offset1:64
  ds_read2_b32 v[18:19], v115 offset0:128 offset1:192
  v_mfma_f32_32x32x16_bf16 v[52:67], v[68:71], v[68:71], 0
  s_waitcnt lgkmcnt(0)
  v_pk_add_f32 v[16:17], v[16:17], v[18:19]
  v_pk_add_f32 v[8:9], v[8:9], v[10:11]
  v_pk_add_f32 v[12:13], v[12:13], v[14:15]
  v_add_f32 v20, v16, v17
  v_pk_add_f32 v[8:9], v[8:9], v[12:13]
  v_max_f32 v22, v8, v9
  v_add_f32_dpp v20, v20, v20 row_ror:8 row_mask:0xf bank_mask:0xf
  s_nop 0
  v_max_f32_dpp v22, v22, v22 row_ror:8 row_mask:0xf bank_mask:0xf
  v_max_f32 v22, v22, v20
  s_nop 1
  v_max_f32_dpp v22, v22, v22 quad_perm:[1,0,3,2] row_mask:0xf bank_mask:0xf
  s_nop 1
  v_max_f32_dpp v22, v22, v22 quad_perm:[2,3,0,1] row_mask:0xf bank_mask:0xf
  s_nop 1
  v_max_f32_dpp v22, v22, v22 row_half_mirror row_mask:0xf bank_mask:0xf
  v_pk_add_f32 v[8:9], v[8:9], v[22:23] op_sel_hi:[1,0] neg_lo:[0,1] neg_hi:[0,1]
  v_sub_f32 v20, v20, v22
  v_exp_f32 v8, v8
  v_exp_f32 v9, v9
  v_exp_f32 v20, v20
  v_add_f32 v24, v8, v9
  v_fmac_f32 v24, 0.5, v20
  v_mov_b32_dpp v21, v20 quad_perm:[1,0,3,2] row_mask:0xf bank_mask:0xf
  s_nop 0
  v_add_f32_dpp v24, v24, v24 quad_perm:[1,0,3,2] row_mask:0xf bank_mask:0xf
  s_nop 1
  v_add_f32_dpp v24, v24, v24 quad_perm:[2,3,0,1] row_mask:0xf bank_mask:0xf
  s_nop 1
  v_add_f32_dpp v24, v24, v24 row_half_mirror row_mask:0xf bank_mask:0xf
  s_nop 1
  v_add_f32_dpp v24, v24, v24 row_ror:8 row_mask:0xf bank_mask:0xf
  v_rcp_f32 v24, v24
  s_nop 0
  v_pk_mul_f32 v[8:9], v[8:9], v[24:25] op_sel_hi:[1,0]
  v_cvt_pk_bf16_f32 v8, abs(v8), abs(v9)
  buffer_store_dword v8, v1, s[8:11], s20 offen sc1
  v_pk_mul_f32 v[20:21], v[20:21], v[24:25] op_sel_hi:[1,0]
  v_cvt_pk_bf16_f32 v20, abs(v20), abs(v21)
  buffer_store_dword v20, v118, s[8:11], s20 offen sc1
  v_mov_b32 v74, 0
  v_mov_b32 v75, 0
  s_mov_b32 s19, s18
  s_add_u32 s18, s18, 1
  s_mov_b32 s22, s20
  s_mov_b32 s20, s21
  s_mov_b32 s21, s22
  s_add_u32 s23, s20, 4096
  s_cmp_lt_u32 s19, 63
  s_cbranch_scc1 cB_sc0_loop
  s_branch cB_done
cB_sc0_r0:
  s_add_u32 s31, s31, 1
  buffer_load_dwordx4 v[8:11], v2, s[8:11], s20 offen offset:0 sc1
  s_waitcnt vmcnt(0)
  v_cmp_eq_u32 vcc, -1, v8
  v_mov_b32 v36, 0
  v_mov_b32 v37, 0
  v_mov_b32 v38, 0
  v_mov_b32 v39, 0
  v_mov_b32 v40, 0
  v_mov_b32 v41, 0
  v_mov_b32 v42, 0
  v_mov_b32 v43, 0
  v_mov_b32 v44, 0
  v_mov_b32 v45, 0
  v_mov_b32 v46, 0
  v_mov_b32 v47, 0
  v_mov_b32 v48, 0
  v_mov_b32 v49, 0
  v_mov_b32 v50, 0
  v_mov_b32 v51, 0
  s_nop 1
  s_cbranch_vccz cB_sc0_go
  s_add_u32 s30, s30, 1
  s_cmp_lt_u32 s30, 400000
  s_cbranch_scc1 cB_sc0_r0
  s_branch cB_abort
cB_sc0_r1:
  s_add_u32 s31, s31, 1
  buffer_load_dwordx4 v[12:15], v2, s[8:11], s20 offen offset:1024 sc1
  s_waitcnt vmcnt(0)
  v_cmp_eq_u32 vcc, -1, v12
  s_nop 4
  s_cbranch_vccz cB_sc0_c1
  s_add_u32 s30, s30, 1
  s_cmp_lt_u32 s30, 400000
  s_cbranch_scc1 cB_sc0_r1
  s_branch cB_abort
cB_sc0_r2:
  s_add_u32 s31, s31, 1
  buffer_load_dwordx4 v[16:19], v2, s[8:11], s20 offen offset:2048 sc1
  s_waitcnt vmcnt(0)
  v_cmp_eq_u32 vcc, -1, v16
  s_nop 4
  s_cbranch_vccz cB_sc0_c2
  s_add_u32 s30, s30, 1
  s_cmp_lt_u32 s30, 400000
  s_cbranch_scc1 cB_sc0_r2
  s_branch cB_abort
cB_sc0_r3:
  s_add_u32 s31, s31, 1
  buffer_load_dwordx4 v[20:23], v2, s[8:11], s20 offen offset:3072 sc1
  s_waitcnt vmcnt(0)
  v_cmp_eq_u32 vcc, -1, v20
  s_nop 4
  s_cbranch_vccz cB_sc0_c3
  s_add_u32 s30, s30, 1
  s_cmp_lt_u32 s30, 400000
  s_cbranch_scc1 cB_sc0_r3
  s_branch cB_abort
cB_sc0_r4:
  s_add_u32 s31, s31, 1
  buffer_load_dwordx4 v[32:35], v2, s[8:11], s23 offen offset:0 sc1
  buffer_load_dwordx4 v[24:27], v2, s[8:11], s23 offen offset:1024 sc1
  buffer_load_dwordx4 v[28:31], v2, s[8:11], s23 offen offset:2048 sc1
  s_waitcnt vmcnt(0)
  v_max3_u32 v66, v24, v27, v28
  v_max3_u32 v66, v66, v31, v32
  v_max_u32 v66, v66, v35
  v_cmp_eq_u32 vcc, -1, v66
  s_nop 4
  s_cbranch_vccz cB_sc0_c4
  s_add_u32 s30, s30, 1
  s_cmp_lt_u32 s30, 400000
  s_cbranch_scc1 cB_sc0_r4
  s_branch cB_abort
cB_sc0_retry:
  s_cmp_lg_u32 s62, 0
  s_cbranch_scc1 cB_sc0_cont
  s_waitcnt vmcnt(0) lgkmcnt(0)
cB_sc0_rv:
  buffer_load_dwordx4 v[8:11], v2, s[8:11], s20 offen offset:0 sc1
  buffer_load_dwordx4 v[12:15], v2, s[8:11], s20 offen offset:1024 sc1
  buffer_load_dwordx4 v[16:19], v2, s[8:11], s20 offen offset:2048 sc1
  buffer_load_dwordx4 v[20:23], v2, s[8:11], s20 offen offset:3072 sc1
  buffer_load_dwordx4 v[32:35], v2, s[8:11], s23 offen offset:0 sc1
  buffer_load_dwordx4 v[24:27], v2, s[8:11], s23 offen offset:1024 sc1
  buffer_load_dwordx4 v[28:31], v2, s[8:11], s23 offen offset:2048 sc1
  s_waitcnt vmcnt(0)
  v_max3_u32 v66, v8, v9, v10
  v_max3_u32 v66, v66, v11, v12
  v_max3_u32 v66, v66, v13, v14
  v_max3_u32 v66, v66, v15, v16
  v_max3_u32 v66, v66, v17, v18
  v_max3_u32 v66, v66, v19, v20
  v_max3_u32 v66, v66, v21, v22
  v_max3_u32 v66, v66, v23, v24
  v_max3_u32 v66, v66, v25, v26
  v_max3_u32 v66, v66, v27, v28
  v_max3_u32 v66, v66, v29, v30
  v_max3_u32 v66, v66, v31, v32
  v_max3_u32 v66, v66, v33, v34
  v_max_u32 v66, v66, v35
  v_cmp_eq_u32 vcc, -1, v66
  s_cbranch_vccz cB_sc0_rk
  s_add_u32 s30, s30, 1
  s_cmp_lt_u32 s30, 400000
  s_cbranch_scc1 cB_sc0_rv
  s_branch cB_abort
cB_sc0_rk:
  s_mov_b32 s62, 1
  v_mov_b32 v36, 0
  v_mov_b32 v37, 0
  v_mov_b32 v38, 0
  v_mov_b32 v39, 0
  v_mov_b32 v40, 0
  v_mov_b32 v41, 0
  v_mov_b32 v42, 0
  v_mov_b32 v43, 0
  v_mov_b32 v44, 0
  v_mov_b32 v45, 0
  v_mov_b32 v46, 0
  v_mov_b32 v47, 0
  v_mov_b32 v48, 0
  v_mov_b32 v49, 0
  v_mov_b32 v50, 0
  v_mov_b32 v51, 0
  v_mov_b32 v60, 0
  v_mov_b32 v61, 0
  v_mov_b32 v62, 0
  v_mov_b32 v63, 0
  v_mov_b32 v68, 0
  v_mov_b32 v69, 0
  v_mov_b32 v70, 0
  v_mov_b32 v71, 0
  v_mov_b32 v72, 0
  v_mov_b32 v73, 0
  v_mov_b32 v74, 0
  v_mov_b32 v75, 0
  v_mov_b32 v52, 0
  v_mov_b32 v53, 0
  v_mov_b32 v54, 0
  v_mov_b32 v55, 0
  v_mov_b32 v56, 0
  v_mov_b32 v57, 0
  v_mov_b32 v58, 0
  v_mov_b32 v59, 0
  s_add_u32 s31, s31, 0x100
  s_nop 0
  s_branch cB_sc0_go
.p2align 6
cB_sc1_loop:
  s_mov_b32 s30, 0
  s_mov_b32 s62, 0
  s_setprio 3
  s_barrier
  buffer_load_dwordx4 v[8:11], v2, s[8:11], s20 offen offset:0 sc1
  s_setprio 2
  buffer_load_dwordx4 v[12:15], v2, s[8:11], s20 offen offset:1024 sc1
  s_setprio 1
  buffer_load_dwordx4 v[16:19], v2, s[8:11], s20 offen offset:2048 sc1
  s_setprio 0
  buffer_load_dwordx4 v[20:23], v2, s[8:11], s20 offen offset:3072 sc1
cB_sc1_go:
  s_waitcnt vmcnt(3)
  v_smfmac_f32_16x16x64_bf16 v[36:39], v[8:11], a[0:7], v3
  buffer_load_dwordx4 v[28:31], v2, s[8:11], s23 offen offset:0 sc1
  v_cmp_eq_u32 vcc, -1, v8
  v_smfmac_f32_16x16x64_bf16 v[40:43], v[8:11], a[56:63], v3
  v_smfmac_f32_16x16x64_bf16 v[44:47], v[8:11], a[112:119], v3
  buffer_load_dwordx4 v[24:27], v2, s[8:11], s23 offen offset:1024 sc1
  s_cbranch_vccnz cB_sc1_r0
  v_smfmac_f32_16x16x64_bf16 v[48:51], v[8:11], a[168:175], v3
  v_smfmac_f32_16x16x64_bf16 v[52:55], v[8:11], a[224:231], v3
  s_waitcnt vmcnt(4)
  v_cmp_eq_u32 vcc, -1, v12
  v_smfmac_f32_16x16x64_bf16 v[56:59], v[8:11], v[144:151], v3
  buffer_load_dwordx4 v[32:35], v2, s[8:11], s23 offen offset:2048 sc1
  v_smfmac_f32_16x16x64_bf16 v[60:63], v[8:11], v[200:207], v3
  s_cbranch_vccnz cB_sc1_r1
cB_sc1_c1:
  v_smfmac_f32_16x16x64_bf16 v[36:39], v[12:15], a[8:15], v3
  v_smfmac_f32_16x16x64_bf16 v[40:43], v[12:15], a[64:71], v3
  v_smfmac_f32_16x16x64_bf16 v[44:47], v[12:15], a[120:127], v3
  v_smfmac_f32_16x16x64_bf16 v[48:51], v[12:15], a[176:183], v3
  v_smfmac_f32_16x16x64_bf16 v[52:55], v[12:15], a[232:239], v3
  s_waitcnt vmcnt(4)
  v_cmp_eq_u32 vcc, -1, v16
  v_smfmac_f32_16x16x64_bf16 v[56:59], v[12:15], v[152:159], v3
  buffer_load_dwordx4 v[88:91], v117, s[8:11], s26 offen offset:0 sc1
  v_smfmac_f32_16x16x64_bf16 v[60:63], v[12:15], v[208:215], v3
  s_cbranch_vccnz cB_sc1_r2
cB_sc1_c2:
  v_smfmac_f32_16x16x64_bf16 v[36:39], v[16:19], a[16:23], v3
  v_smfmac_f32_16x16x64_bf16 v[40:43], v[16:19], a[72:79], v3
  v_smfmac_f32_16x16x64_bf16 v[44:47], v[16:19], a[128:135], v3
  buffer_load_dwordx4 v[92:95], v117, s[8:11], s26 offen offset:1024 sc1
  v_smfmac_f32_16x16x64_bf16 v[48:51], v[16:19], a[184:191], v3
  v_smfmac_f32_16x16x64_bf16 v[52:55], v[16:19], a[240:247], v3
  s_waitcnt vmcnt(5)
  v_cmp_eq_u32 vcc, -1, v20
  v_smfmac_f32_16x16x64_bf16 v[56:59], v[16:19], v[160:167], v3
  v_smfmac_f32_16x16x64_bf16 v[60:63], v[16:19], v[216:223], v3
  buffer_load_dwordx4 v[96:99], v2, s[8:11], s24 offen offset:0 sc1
  s_cbranch_vccnz cB_sc1_r3
cB_sc1_c3:
  v_smfmac_f32_16x16x64_bf16 v[36:39], v[20:23], a[24:31], v3
  v_smfmac_f32_16x16x64_bf16 v[40:43], v[20:23], a[80:87], v3
  s_waitcnt vmcnt(3)
  v_max3_u32 v66, v24, v27, v28
  v_smfmac_f32_16x16x64_bf16 v[44:47], v[20:23], a[136:143], v3
  v_max3_u32 v66, v66, v31, v32
  v_smfmac_f32_16x16x64_bf16 v[48:51], v[20:23], a[192:199], v3
  buffer_load_dwordx4 v[100:103], v2, s[8:11], s24 offen offset:1024 sc1
  v_max_u32 v66, v66, v35
  v_smfmac_f32_16x16x64_bf16 v[52:55], v[20:23], a[248:255], v3
  v_cmp_eq_u32 vcc, -1, v66
  v_smfmac_f32_16x16x64_bf16 v[56:59], v[20:23], v[168:175], v3
  v_smfmac_f32_16x16x64_bf16 v[60:63], v[20:23], v[224:231], v3
  s_cbranch_vccnz cB_sc1_r4
cB_sc1_c4:
  v_smfmac_f32_16x16x64_bf16 v[60:63], v[28:31], v[232:239], v3
  buffer_load_dwordx4 v[104:107], v2, s[8:11], s26 offen offset:0 sc1
  v_smfmac_f32_16x16x64_bf16 v[60:63], v[24:27], v[240:247], v3
  v_smfmac_f32_16x16x64_bf16 v[60:63], v[32:35], v[248:255], v3
  v_smfmac_f32_16x16x64_bf16 v[52:55], v[28:31], v[120:127], v3
  v_smfmac_f32_16x16x64_bf16 v[52:55], v[24:27], v[128:135], v3
  buffer_load_dwordx4 v[108:111], v2, s[8:11], s26 offen offset:1024 sc1
  v_smfmac_f32_16x16x64_bf16 v[52:55], v[32:35], v[136:143], v3
  v_cvt_pk_bf16_f32 v63, v62, v63
  v_smfmac_f32_16x16x64_bf16 v[56:59], v[28:31], v[176:183], v3
  v_cvt_pk_bf16_f32 v62, v60, v61
  v_smfmac_f32_16x16x64_bf16 v[56:59], v[24:27], v[184:191], v3
  v_mfma_f32_16x16x32_bf16 v[8:11], v[62:65], v[4:7], 0
  v_cvt_pk_bf16_f32 v55, v54, v55
  v_smfmac_f32_16x16x64_bf16 v[56:59], v[32:35], v[192:199], v3
  v_cvt_pk_bf16_f32 v54, v52, v53
  v_smfmac_f32_16x16x64_bf16 v[36:39], v[28:31], a[32:39], v3
  s_nop 1
  v_cvt_pk_bf16_f32 v78, v8, v9
  v_smfmac_f32_16x16x64_bf16 v[36:39], v[24:27], a[40:47], v3
  v_cvt_pk_bf16_f32 v79, v10, v11
  v_smfmac_f32_16x16x64_bf16 v[36:39], v[32:35], a[48:55], v3
  v_cvt_pk_bf16_f32 v56, v56, v57
  v_smfmac_f32_16x16x64_bf16 v[40:43], v[28:31], a[88:95], v3
  v_cvt_pk_bf16_f32 v57, v58, v59
  v_smfmac_f32_16x16x64_bf16 v[40:43], v[24:27], a[96:103], v3
  v_mfma_f32_16x16x32_bf16 v[16:19], v[54:57], v[4:7], 0
  v_cvt_pk_bf16_f32 v39, v38, v39
  v_smfmac_f32_16x16x64_bf16 v[40:43], v[32:35], a[104:111], v3
  v_cvt_pk_bf16_f32 v38, v36, v37
  v_smfmac_f32_16x16x64_bf16 v[44:47], v[28:31], a[144:151], v3
  s_nop 1
  v_cvt_pk_bf16_f32 v76, v16, v17
  v_smfmac_f32_16x16x64_bf16 v[44:47], v[24:27], a[152:159], v3
  v_cvt_pk_bf16_f32 v77, v18, v19
  v_smfmac_f32_16x16x64_bf16 v[44:47], v[32:35], a[160:167], v3
  v_cvt_pk_bf16_f32 v40, v40, v41
  v_smfmac_f32_16x16x64_bf16 v[48:51], v[28:31], a[200:207], v3
  v_cvt_pk_bf16_f32 v41, v42, v43
  v_smfmac_f32_16x16x64_bf16 v[48:51], v[24:27], a[208:215], v3
  v_smfmac_f32_16x16x64_bf16 v[48:51], v[32:35], a[216:223], v3
  s_waitcnt vmcnt(4)
  v_cvt_pk_bf16_f32 v47, v46, v47
  v_smfmac_f32_16x16x64_bf16 v[68:71], v[76:79], v[80:87], v3
  v_cvt_pk_bf16_f32 v46, v44, v45
  v_mfma_f32_16x16x32_bf16 v[8:11], v[38:41], v[4:7], 0
  s_nop 1
  v_cvt_pk_bf16_f32 v48, v48, v49
  v_cvt_pk_bf16_f32 v49, v50, v51
  s_nop 1
  v_mfma_f32_16x16x32_bf16 v[16:19], v[46:49], v[4:7], 0
  v_smfmac_f32_16x16x64_bf16 v[72:75], v[76:79], v[88:95], v3
  v_cvt_pk_bf16_f32 v20, v8, v9
  v_mfma_f32_16x16x32_bf16 v[52:55], v[30:33], v[76:79], 0
  s_waitcnt vmcnt(0)
  v_cvt_pk_bf16_f32 v21, v10, v11
  v_cvt_pk_bf16_f32 v22, v16, v17
  v_cvt_pk_bf16_f32 v23, v18, v19
  s_nop 1
  v_mfma_f32_16x16x32_bf16 v[52:55], v[12:15], v[20:23], v[52:55]
  v_smfmac_f32_16x16x64_bf16 v[68:71], v[20:23], v[96:103], v3
  v_smfmac_f32_16x16x64_bf16 v[72:75], v[20:23], v[104:111], v3
  s_nop 1
  ds_write_b128 v113, v[52:55]
  s_nop 1
  v_permlane32_swap_b32 v68, v70
  v_permlane32_swap_b32 v69, v71
  v_add_f32 v56, v68, v70
  v_add_f32 v58, v69, v71
  v_permlane32_swap_b32 v72, v74
  v_permlane32_swap_b32 v73, v75
  v_add_f32 v57, v72, v74
  v_add_f32 v59, v73, v75
  ds_write_b128 v2, v[56:59] offset:1024
  v_cmp_u_f32 vcc, v57, v59
  v_mov_b32 v68, 0
  v_mov_b32 v69, 0
  v_mov_b32 v70, 0
  v_mov_b32 v71, 0
  s_cbranch_vccnz cB_sc1_retry
cB_sc1_cont:
  s_add_u32 s24, s24, 28672
  s_add_u32 s26, s26, 28672
  buffer_load_dwordx4 v[80:83], v117, s[8:11], s24 offen offset:0 sc1
  buffer_load_dwordx4 v[84:87], v117, s[8:11], s24 offen offset:1024 sc1
  v_mov_b32 v72, 0
  v_mov_b32 v73, 0
  v_mfma_f32_32x32x16_bf16 v[36:51], v[68:71], v[68:71], 0
  s_waitcnt lgkmcnt(0)
  s_barrier
  ds_read_b64 v[8:9], v114 offset:0
  ds_read_b64 v[10:11], v114 offset:1024
  ds_read_b64 v[12:13], v114 offset:2048
  ds_read_b64 v[14:15], v114 offset:3072
  ds_read2_b32 v[16:17], v115 offset0:0 offset1:64
  ds_read2_b32 v[18:19], v115 offset0:128 offset1:192
  v_mfma_f32_32x32x16_bf16 v[52:67], v[68:71], v[68:71], 0
  s_waitcnt lgkmcnt(0)
  v_pk_add_f32 v[16:17], v[16:17], v[18:19]
  v_pk_add_f32 v[8:9], v[8:9], v[10:11]
  v_pk_add_f32 v[12:13], v[12:13], v[14:15]
  v_add_f32 v20, v16, v17
  v_pk_add_f32 v[8:9], v[8:9], v[12:13]
  v_max_f32 v22, v8, v9
  v_add_f32_dpp v20, v20, v20 row_ror:8 row_mask:0xf bank_mask:0xf
  s_nop 0
  v_max_f32_dpp v22, v22, v22 row_ror:8 row_mask:0xf bank_mask:0xf
  v_max_f32 v22, v22, v20
  buffer_store_dword v112, v116, s[8:11], 0 offen sc1
  s_nop 0
  v_max_f32_dpp v22, v22, v22 quad_perm:[1,0,3,2] row_mask:0xf bank_mask:0xf
  s_nop 1
  v_max_f32_dpp v22, v22, v22 quad_perm:[2,3,0,1] row_mask:0xf bank_mask:0xf
  s_nop 1
  v_max_f32_dpp v22, v22, v22 row_half_mirror row_mask:0xf bank_mask:0xf
  v_pk_add_f32 v[8:9], v[8:9], v[22:23] op_sel_hi:[1,0] neg_lo:[0,1] neg_hi:[0,1]
  v_sub_f32 v20, v20, v22
  v_exp_f32 v8, v8
  v_exp_f32 v9, v9
  v_exp_f32 v20, v20
  v_add_f32 v24, v8, v9
  v_fmac_f32 v24, 0.5, v20
  v_mov_b32_dpp v21, v20 quad_perm:[1,0,3,2] row_mask:0xf bank_mask:0xf
  s_nop 0
  v_add_f32_dpp v24, v24, v24 quad_perm:[1,0,3,2] row_mask:0xf bank_mask:0xf
  s_nop 1
  v_add_f32_dpp v24, v24, v24 quad_perm:[2,3,0,1] row_mask:0xf bank_mask:0xf
  s_nop 1
  v_add_f32_dpp v24, v24, v24 row_half_mirror row_mask:0xf bank_mask:0xf
  s_nop 1
  v_add_f32_dpp v24, v24, v24 row_ror:8 row_mask:0xf bank_mask:0xf
  v_rcp_f32 v24, v24
  s_nop 0
  v_pk_mul_f32 v[8:9], v[8:9], v[24:25] op_sel_hi:[1,0]
  v_cvt_pk_bf16_f32 v8, abs(v8), abs(v9)
  buffer_store_dword v8, v1, s[8:11], s20 offen sc1
  v_pk_mul_f32 v[20:21], v[20:21], v[24:25] op_sel_hi:[1,0]
  v_cvt_pk_bf16_f32 v20, abs(v20), abs(v21)
  buffer_store_dword v20, v118, s[8:11], s20 offen sc1
  v_mov_b32 v74, 0
  v_mov_b32 v75, 0
  s_mov_b32 s19, s18
  s_add_u32 s18, s18, 1
  s_mov_b32 s22, s20
  s_mov_b32 s20, s21
  s_mov_b32 s21, s22
  s_add_u32 s23, s20, 4096
  v_mov_b32 v112, s18
  s_cmp_lt_u32 s19, 63
  s_nop 0
  s_cbranch_scc1 cB_sc1_loop
  s_branch cB_done
cB_sc1_r0:
  s_add_u32 s31, s31, 1
  buffer_load_dwordx4 v[8:11], v2, s[8:11], s20 offen offset:0 sc1
  s_waitcnt vmcnt(0)
  v_cmp_eq_u32 vcc, -1, v8
  v_mov_b32 v36, 0
  v_mov_b32 v37, 0
  v_mov_b32 v38, 0
  v_mov_b32 v39, 0
  v_mov_b32 v40, 0
  v_mov_b32 v41, 0
  v_mov_b32 v42, 0
  v_mov_b32 v43, 0
  v_mov_b32 v44, 0
  v_mov_b32 v45, 0
  v_mov_b32 v46, 0
  v_mov_b32 v47, 0
  v_mov_b32 v48, 0
  v_mov_b32 v49, 0
  v_mov_b32 v50, 0
  v_mov_b32 v51, 0
  s_nop 1
  s_cbranch_vccz cB_sc1_go
  s_add_u32 s30, s30, 1
  s_cmp_lt_u32 s30, 400000
  s_cbranch_scc1 cB_sc1_r0
  s_branch cB_abort
cB_sc1_r1:
  s_add_u32 s31, s31, 1
  buffer_load_dwordx4 v[12:15], v2, s[8:11], s20 offen offset:1024 sc1
  s_waitcnt vmcnt(0)
  v_cmp_eq_u32 vcc, -1, v12
  s_nop 4
  s_cbranch_vccz cB_sc1_c1
  s_add_u32 s30, s30, 1
  s_cmp_lt_u32 s30, 400000
  s_cbranch_scc1 cB_sc1_r1
  s_branch cB_abort
cB_sc1_r2:
  s_add_u32 s31, s31, 1
  buffer_load_dwordx4 v[16:19], v2, s[8:11], s20 offen offset:2048 sc1
  s_waitcnt vmcnt(0)
  v_cmp_eq_u32 vcc, -1, v16
  s_nop 4
  s_cbranch_vccz cB_sc1_c2
  s_add_u32 s30, s30, 1
  s_cmp_lt_u32 s30, 400000
  s_cbranch_scc1 cB_sc1_r2
  s_branch cB_abort
cB_sc1_r3:
  s_add_u32 s31, s31, 1
  buffer_load_dwordx4 v[20:23], v2, s[8:11], s20 offen offset:3072 sc1
  s_waitcnt vmcnt(0)
  v_cmp_eq_u32 vcc, -1, v20
  s_nop 4
  s_cbranch_vccz cB_sc1_c3
  s_add_u32 s30, s30, 1
  s_cmp_lt_u32 s30, 400000
  s_cbranch_scc1 cB_sc1_r3
  s_branch cB_abort
cB_sc1_r4:
  s_add_u32 s31, s31, 1
  buffer_load_dwordx4 v[28:31], v2, s[8:11], s23 offen offset:0 sc1
  buffer_load_dwordx4 v[24:27], v2, s[8:11], s23 offen offset:1024 sc1
  buffer_load_dwordx4 v[32:35], v2, s[8:11], s23 offen offset:2048 sc1
  s_waitcnt vmcnt(0)
  v_max3_u32 v66, v24, v27, v28
  v_max3_u32 v66, v66, v31, v32
  v_max_u32 v66, v66, v35
  v_cmp_eq_u32 vcc, -1, v66
  s_nop 4
  s_cbranch_vccz cB_sc1_c4
  s_add_u32 s30, s30, 1
  s_cmp_lt_u32 s30, 400000
  s_cbranch_scc1 cB_sc1_r4
  s_branch cB_abort
cB_sc1_retry:
  s_cmp_lg_u32 s62, 0
  s_cbranch_scc1 cB_sc1_cont
  s_waitcnt vmcnt(0) lgkmcnt(0)
cB_sc1_rv:
  buffer_load_dwordx4 v[8:11], v2, s[8:11], s20 offen offset:0 sc1
  buffer_load_dwordx4 v[12:15], v2, s[8:11], s20 offen offset:1024 sc1
  buffer_load_dwordx4 v[16:19], v2, s[8:11], s20 offen offset:2048 sc1
  buffer_load_dwordx4 v[20:23], v2, s[8:11], s20 offen offset:3072 sc1
  buffer_load_dwordx4 v[28:31], v2, s[8:11], s23 offen offset:0 sc1
  buffer_load_dwordx4 v[24:27], v2, s[8:11], s23 offen offset:1024 sc1
  buffer_load_dwordx4 v[32:35], v2, s[8:11], s23 offen offset:2048 sc1
  s_waitcnt vmcnt(0)
  v_max3_u32 v66, v8, v9, v10
  v_max3_u32 v66, v66, v11, v12
  v_max3_u32 v66, v66, v13, v14
  v_max3_u32 v66, v66, v15, v16
  v_max3_u32 v66, v66, v17, v18
  v_max3_u32 v66, v66, v19, v20
  v_max3_u32 v66, v66, v21, v22
  v_max3_u32 v66, v66, v23, v24
  v_max3_u32 v66, v66, v25, v26
  v_max3_u32 v66, v66, v27, v28
  v_max3_u32 v66, v66, v29, v30
  v_max3_u32 v66, v66, v31, v32
  v_max3_u32 v66, v66, v33, v34
  v_max_u32 v66, v66, v35
  v_cmp_eq_u32 vcc, -1, v66
  s_cbranch_vccz cB_sc1_rk
  s_add_u32 s30, s30, 1
  s_cmp_lt_u32 s30, 400000
  s_cbranch_scc1 cB_sc1_rv
  s_branch cB_abort
cB_sc1_rk:
  s_mov_b32 s62, 1
  v_mov_b32 v36, 0
  v_mov_b32 v37, 0
  v_mov_b32 v38, 0
  v_mov_b32 v39, 0
  v_mov_b32 v40, 0
  v_mov_b32 v41, 0
  v_mov_b32 v42, 0
  v_mov_b32 v43, 0
  v_mov_b32 v44, 0
  v_mov_b32 v45, 0
  v_mov_b32 v46, 0
  v_mov_b32 v47, 0
  v_mov_b32 v48, 0
  v_mov_b32 v49, 0
  v_mov_b32 v50, 0
  v_mov_b32 v51, 0
  v_mov_b32 v60, 0
  v_mov_b32 v61, 0
  v_mov_b32 v62, 0
  v_mov_b32 v63, 0
  v_mov_b32 v68, 0
  v_mov_b32 v69, 0
  v_mov_b32 v70, 0
  v_mov_b32 v71, 0
  v_mov_b32 v72, 0
  v_mov_b32 v73, 0
  v_mov_b32 v74, 0
  v_mov_b32 v75, 0
  v_mov_b32 v52, 0
  v_mov_b32 v53, 0
  v_mov_b32 v54, 0
  v_mov_b32 v55, 0
  v_mov_b32 v56, 0
  v_mov_b32 v57, 0
  v_mov_b32 v58, 0
  v_mov_b32 v59, 0
  s_add_u32 s31, s31, 0x100
  s_nop 0
  s_branch cB_sc1_go
.p2align 6
cB_sc2_loop:
  s_mov_b32 s30, 0
  s_mov_b32 s62, 0
  s_setprio 3
  s_barrier
  buffer_load_dwordx4 v[8:11], v2, s[8:11], s20 offen offset:0 sc1
  s_setprio 2
  buffer_load_dwordx4 v[12:15], v2, s[8:11], s20 offen offset:1024 sc1
  s_setprio 1
  buffer_load_dwordx4 v[16:19], v2, s[8:11], s20 offen offset:2048 sc1
  s_setprio 0
  buffer_load_dwordx4 v[20:23], v2, s[8:11], s20 offen offset:3072 sc1
cB_sc2_go:
  s_waitcnt vmcnt(3)
  v_smfmac_f32_16x16x64_bf16 v[36:39], v[8:11], a[0:7], v3
  buffer_load_dwordx4 v[24:27], v2, s[8:11], s23 offen offset:0 sc1
  v_cmp_eq_u32 vcc, -1, v8
  v_smfmac_f32_16x16x64_bf16 v[40:43], v[8:11], a[56:63], v3
  v_smfmac_f32_16x16x64_bf16 v[44:47], v[8:11], a[112:119], v3
  buffer_load_dwordx4 v[32:35], v2, s[8:11], s23 offen offset:1024 sc1
  s_cbranch_vccnz cB_sc2_r0
  v_smfmac_f32_16x16x64_bf16 v[48:51], v[8:11], a[168:175], v3
  v_smfmac_f32_16x16x64_bf16 v[52:55], v[8:11], a[224:231], v3
  s_waitcnt vmcnt(4)
  v_cmp_eq_u32 vcc, -1, v12
  v_smfmac_f32_16x16x64_bf16 v[56:59], v[8:11], v[144:151], v3
  buffer_load_dwordx4 v[28:31], v2, s[8:11], s23 offen offset:2048 sc1
  v_smfmac_f32_16x16x64_bf16 v[62:65], v[8:11], v[200:207], v3
  s_cbranch_vccnz cB_sc2_r1
cB_sc2_c1:
  v_smfmac_f32_16x16x64_bf16 v[36:39], v[12:15], a[8:15], v3
  v_smfmac_f32_16x16x64_bf16 v[40:43], v[12:15], a[64:71], v3
  v_smfmac_f32_16x16x64_bf16 v[44:47], v[12:15], a[120:127], v3
  v_smfmac_f32_16x16x64_bf16 v[48:51], v[12:15], a[176:183], v3
  v_smfmac_f32_16x16x64_bf16 v[52:55], v[12:15], a[232:239], v3
  s_waitcnt vmcnt(4)
  v_cmp_eq_u32 vcc, -1, v16
  v_smfmac_f32_16x16x64_bf16 v[56:59], v[12:15], v[152:159], v3
  buffer_load_dwordx4 v[88:91], v117, s[8:11], s26 offen offset:0 sc1
  v_smfmac_f32_16x16x64_bf16 v[62:65], v[12:15], v[208:215], v3
  s_cbranch_vccnz cB_sc2_r2
cB_sc2_c2:
  v_smfmac_f32_16x16x64_bf16 v[36:39], v[16:19], a[16:23], v3
  v_smfmac_f32_16x16x64_bf16 v[40:43], v[16:19], a[72:79], v3
  v_smfmac_f32_16x16x64_bf16 v[44:47], v[16:19], a[128:135], v3
  buffer_load_dwordx4 v[92:95], v117, s[8:11], s26 offen offset:1024 sc1
  v_smfmac_f32_16x16x64_bf16 v[48:51], v[16:19], a[184:191], v3
  v_smfmac_f32_16x16x64_bf16 v[52:55], v[16:19], a[240:247], v3
  s_waitcnt vmcnt(5)
  v_cmp_eq_u32 vcc, -1, v20
  v_smfmac_f32_16x16x64_bf16 v[56:59], v[16:19], v[160:167], v3
  v_smfmac_f32_16x16x64_bf16 v[62:65], v[16:19], v[216:223], v3
  buffer_load_dwordx4 v[96:99], v2, s[8:11], s24 offen offset:0 sc1
  s_cbranch_vccnz cB_sc2_r3
cB_sc2_c3:
  v_smfmac_f32_16x16x64_bf16 v[36:39], v[20:23], a[24:31], v3
  v_smfmac_f32_16x16x64_bf16 v[40:43], v[20:23], a[80:87], v3
  s_waitcnt vmcnt(3)
  v_max3_u32 v66, v24, v27, v28
  v_smfmac_f32_16x16x64_bf16 v[44:47], v[20:23], a[136:143], v3
  v_max3_u32 v66, v66, v31, v32
  v_smfmac_f32_16x16x64_bf16 v[48:51], v[20:23], a[192:199], v3
  buffer_load_dwordx4 v[100:103], v2, s[8:11], s24 offen offset:1024 sc1
  v_max_u32 v66, v66, v35
  v_smfmac_f32_16x16x64_bf16 v[52:55], v[20:23], a[248:255], v3
  v_cmp_eq_u32 vcc, -1, v66
  v_smfmac_f32_16x16x64_bf16 v[56:59], v[20:23], v[168:175], v3
  v_smfmac_f32_16x16x64_bf16 v[62:65], v[20:23], v[224:231], v3
  s_cbranch_vccnz cB_sc2_r4
cB_sc2_c4:
  v_smfmac_f32_16x16x64_bf16 v[62:65], v[24:27], v[232:239], v3
  buffer_load_dwordx4 v[104:107], v2, s[8:11], s26 offen offset:0 sc1
  v_smfmac_f32_16x16x64_bf16 v[62:65], v[32:35], v[240:247], v3
  v_smfmac_f32_16x16x64_bf16 v[62:65], v[28:31], v[248:255], v3
  v_smfmac_f32_16x16x64_bf16 v[52:55], v[24:27], v[120:127], v3
  v_smfmac_f32_16x16x64_bf16 v[52:55], v[32:35], v[128:135], v3
  buffer_load_dwordx4 v[108:111], v2, s[8:11], s26 offen offset:1024 sc1
  v_smfmac_f32_16x16x64_bf16 v[52:55], v[28:31], v[136:143], v3
  v_cvt_pk_bf16_f32 v62, v62, v63
  v_smfmac_f32_16x16x64_bf16 v[56:59], v[24:27], v[176:183], v3
  v_cvt_pk_bf16_f32 v63, v64, v65
  v_smfmac_f32_16x16x64_bf16 v[56:59], v[32:35], v[184:191], v3
  v_mfma_f32_16x16x32_bf16 v[8:11], v[60:63], v[4:7], 0
  v_cvt_pk_bf16_f32 v55, v54, v55
  v_smfmac_f32_16x16x64_bf16 v[56:59], v[28:31], v[192:199], v3
  v_cvt_pk_bf16_f32 v54, v52, v53
  v_smfmac_f32_16x16x64_bf16 v[36:39], v[24:27], a[32:39], v3
  s_nop 1
  v_cvt_pk_bf16_f32 v76, v8, v9
  v_smfmac_f32_16x16x64_bf16 v[36:39], v[32:35], a[40:47], v3
  v_cvt_pk_bf16_f32 v77, v10, v11
  v_smfmac_f32_16x16x64_bf16 v[36:39], v[28:31], a[48:55], v3
  v_cvt_pk_bf16_f32 v56, v56, v57
  v_smfmac_f32_16x16x64_bf16 v[40:43], v[24:27], a[88:95], v3
  v_cvt_pk_bf16_f32 v57, v58, v59
  v_smfmac_f32_16x16x64_bf16 v[40:43], v[32:35], a[96:103], v3
  v_mfma_f32_16x16x32_bf16 v[12:15], v[54:57], v[4:7], 0
  v_cvt_pk_bf16_f32 v39, v38, v39
  v_smfmac_f32_16x16x64_bf16 v[40:43], v[28:31], a[104:111], v3
  v_cvt_pk_bf16_f32 v38, v36, v37
  v_smfmac_f32_16x16x64_bf16 v[44:47], v[24:27], a[144:151], v3
  s_nop 1
  v_cvt_pk_bf16_f32 v78, v12, v13
  v_smfmac_f32_16x16x64_bf16 v[44:47], v[32:35], a[152:159], v3
  v_cvt_pk_bf16_f32 v79, v14, v15
  v_smfmac_f32_16x16x64_bf16 v[44:47], v[28:31], a[160:167], v3
  v_cvt_pk_bf16_f32 v40, v40, v41
  v_smfmac_f32_16x16x64_bf16 v[48:51], v[24:27], a[200:207], v3
  v_cvt_pk_bf16_f32 v41, v42, v43
  v_smfmac_f32_16x16x64_bf16 v[48:51], v[32:35], a[208:215], v3
  v_smfmac_f32_16x16x64_bf16 v[48:51], v[28:31], a[216:223], v3
  s_waitcnt vmcnt(4)
  v_cvt_pk_bf16_f32 v47, v46, v47
  v_smfmac_f32_16x16x64_bf16 v[68:71], v[76:79], v[80:87], v3
  v_cvt_pk_bf16_f32 v46, v44, v45
  v_mfma_f32_16x16x32_bf16 v[8:11], v[38:41], v[4:7], 0
  s_nop 1
  v_cvt_pk_bf16_f32 v48, v48, v49
  v_cvt_pk_bf16_f32 v49, v50, v51
  s_nop 1
  v_mfma_f32_16x16x32_bf16 v[12:15], v[46:49], v[4:7], 0
  v_smfmac_f32_16x16x64_bf16 v[72:75], v[76:79], v[88:95], v3
  v_cvt_pk_bf16_f32 v20, v8, v9
  v_mfma_f32_16x16x32_bf16 v[52:55], v[30:33], v[76:79], 0
  s_waitcnt vmcnt(0)
  v_cvt_pk_bf16_f32 v21, v10, v11
  v_cvt_pk_bf16_f32 v22, v12, v13
  v_cvt_pk_bf16_f32 v23, v14, v15
  s_nop 1
  v_mfma_f32_16x16x32_bf16 v[52:55], v[16:19], v[20:23], v[52:55]
  v_smfmac_f32_16x16x64_bf16 v[68:71], v[20:23], v[96:103], v3
  v_smfmac_f32_16x16x64_bf16 v[72:75], v[20:23], v[104:111], v3
  s_nop 1
  ds_write_b128 v113, v[52:55]
  s_nop 1
  v_permlane32_swap_b32 v68, v70
  v_permlane32_swap_b32 v69, v71
  v_add_f32 v56, v68, v70
  v_add_f32 v58, v69, v71
  v_permlane32_swap_b32 v72, v74
  v_permlane32_swap_b32 v73, v75
  v_add_f32 v57, v72, v74
  v_add_f32 v59, v73, v75
  ds_write_b128 v2, v[56:59] offset:2048
  v_cmp_u_f32 vcc, v57, v59
  v_mov_b32 v68, 0
  v_mov_b32 v69, 0
  v_mov_b32 v70, 0
  v_mov_b32 v71, 0
  s_cbranch_vccnz cB_sc2_retry
cB_sc2_cont:
  s_add_u32 s24, s24, 28672
  s_add_u32 s26, s26, 28672
  buffer_load_dwordx4 v[80:83], v117, s[8:11], s24 offen offset:0 sc1
  buffer_load_dwordx4 v[84:87], v117, s[8:11], s24 offen offset:1024 sc1
  v_mov_b32 v72, 0
  v_mov_b32 v73, 0
  v_mfma_f32_32x32x16_bf16 v[36:51], v[68:71], v[68:71], 0
  s_waitcnt lgkmcnt(0)
  s_barrier
  v_mfma_f32_32x32x16_bf16 v[52:67], v[68:71], v[68:71], 0
  buffer_store_dwordx2 v[118:119], v114, s[8:11], s21 offen sc1
  buffer_store_dwordx2 v[118:119], v115, s[8:11], s21 offen sc1
  s_buffer_load_dword s70, s[8:11], s35
  s_add_u32 s22, s24, 114688
  s_buffer_load_dword s71, s[8:11], s22
  s_mul_i32 s22, s18, 7168
  s_add_u32 s22, s22, 87040
  s_buffer_load_dword s72, s[8:11], s22
  s_add_u32 s35, s35, 458752
  v_mov_b32 v74, 0
  v_mov_b32 v75, 0
  s_mov_b32 s19, s18
  s_add_u32 s18, s18, 1
  s_mov_b32 s22, s20
  s_mov_b32 s20, s21
  s_mov_b32 s21, s22
  s_add_u32 s23, s20, 4096
  s_cmp_lt_u32 s19, 63
  s_cbranch_scc1 cB_sc2_loop
  s_branch cB_done
cB_sc2_r0:
  s_add_u32 s31, s31, 1
  buffer_load_dwordx4 v[8:11], v2, s[8:11], s20 offen offset:0 sc1
  s_waitcnt vmcnt(0)
  v_cmp_eq_u32 vcc, -1, v8
  v_mov_b32 v36, 0
  v_mov_b32 v37, 0
  v_mov_b32 v38, 0
  v_mov_b32 v39, 0
  v_mov_b32 v40, 0
  v_mov_b32 v41, 0
  v_mov_b32 v42, 0
  v_mov_b32 v43, 0
  v_mov_b32 v44, 0
  v_mov_b32 v45, 0
  v_mov_b32 v46, 0
  v_mov_b32 v47, 0
  v_mov_b32 v48, 0
  v_mov_b32 v49, 0
  v_mov_b32 v50, 0
  v_mov_b32 v51, 0
  s_nop 1
  s_cbranch_vccz cB_sc2_go
  s_add_u32 s30, s30, 1
  s_cmp_lt_u32 s30, 400000
  s_cbranch_scc1 cB_sc2_r0
  s_branch cB_abort
cB_sc2_r1:
  s_add_u32 s31, s31, 1
  buffer_load_dwordx4 v[12:15], v2, s[8:11], s20 offen offset:1024 sc1
  s_waitcnt vmcnt(0)
  v_cmp_eq_u32 vcc, -1, v12
  s_nop 4
  s_cbranch_vccz cB_sc2_c1
  s_add_u32 s30, s30, 1
  s_cmp_lt_u32 s30, 400000
  s_cbranch_scc1 cB_sc2_r1
  s_branch cB_abort
cB_sc2_r2:
  s_add_u32 s31, s31, 1
  buffer_load_dwordx4 v[16:19], v2, s[8:11], s20 offen offset:2048 sc1
  s_waitcnt vmcnt(0)
  v_cmp_eq_u32 vcc, -1, v16
  s_nop 4
  s_cbranch_vccz cB_sc2_c2
  s_add_u32 s30, s30, 1
  s_cmp_lt_u32 s30, 400000
  s_cbranch_scc1 cB_sc2_r2
  s_branch cB_abort
cB_sc2_r3:
  s_add_u32 s31, s31, 1
  buffer_load_dwordx4 v[20:23], v2, s[8:11], s20 offen offset:3072 sc1
  s_waitcnt vmcnt(0)
  v_cmp_eq_u32 vcc, -1, v20
  s_nop 4
  s_cbranch_vccz cB_sc2_c3
  s_add_u32 s30, s30, 1
  s_cmp_lt_u32 s30, 400000
  s_cbranch_scc1 cB_sc2_r3
  s_branch cB_abort
cB_sc2_r4:
  s_add_u32 s31, s31, 1
  buffer_load_dwordx4 v[24:27], v2, s[8:11], s23 offen offset:0 sc1
  buffer_load_dwordx4 v[32:35], v2, s[8:11], s23 offen offset:1024 sc1
  buffer_load_dwordx4 v[28:31], v2, s[8:11], s23 offen offset:2048 sc1
  s_waitcnt vmcnt(0)
  v_max3_u32 v66, v24, v27, v28
  v_max3_u32 v66, v66, v31, v32
  v_max_u32 v66, v66, v35
  v_cmp_eq_u32 vcc, -1, v66
  s_nop 4
  s_cbranch_vccz cB_sc2_c4
  s_add_u32 s30, s30, 1
  s_cmp_lt_u32 s30, 400000
  s_cbranch_scc1 cB_sc2_r4
  s_branch cB_abort
cB_sc2_retry:
  s_cmp_lg_u32 s62, 0
  s_cbranch_scc1 cB_sc2_cont
  s_waitcnt vmcnt(0) lgkmcnt(0)
cB_sc2_rv:
  buffer_load_dwordx4 v[8:11], v2, s[8:11], s20 offen offset:0 sc1
  buffer_load_dwordx4 v[12:15], v2, s[8:11], s20 offen offset:1024 sc1
  buffer_load_dwordx4 v[16:19], v2, s[8:11], s20 offen offset:2048 sc1
  buffer_load_dwordx4 v[20:23], v2, s[8:11], s20 offen offset:3072 sc1
  buffer_load_dwordx4 v[24:27], v2, s[8:11], s23 offen offset:0 sc1
  buffer_load_dwordx4 v[32:35], v2, s[8:11], s23 offen offset:1024 sc1
  buffer_load_dwordx4 v[28:31], v2, s[8:11], s23 offen offset:2048 sc1
  s_waitcnt vmcnt(0)
  v_max3_u32 v66, v8, v9, v10
  v_max3_u32 v66, v66, v11, v12
  v_max3_u32 v66, v66, v13, v14
  v_max3_u32 v66, v66, v15, v16
  v_max3_u32 v66, v66, v17, v18
  v_max3_u32 v66, v66, v19, v20
  v_max3_u32 v66, v66, v21, v22
  v_max3_u32 v66, v66, v23, v24
  v_max3_u32 v66, v66, v25, v26
  v_max3_u32 v66, v66, v27, v28
  v_max3_u32 v66, v66, v29, v30
  v_max3_u32 v66, v66, v31, v32
  v_max3_u32 v66, v66, v33, v34
  v_max_u32 v66, v66, v35
  v_cmp_eq_u32 vcc, -1, v66
  s_cbranch_vccz cB_sc2_rk
  s_add_u32 s30, s30, 1
  s_cmp_lt_u32 s30, 400000
  s_cbranch_scc1 cB_sc2_rv
  s_branch cB_abort
cB_sc2_rk:
  s_mov_b32 s62, 1
  v_mov_b32 v36, 0
  v_mov_b32 v37, 0
  v_mov_b32 v38, 0
  v_mov_b32 v39, 0
  v_mov_b32 v40, 0
  v_mov_b32 v41, 0
  v_mov_b32 v42, 0
  v_mov_b32 v43, 0
  v_mov_b32 v44, 0
  v_mov_b32 v45, 0
  v_mov_b32 v46, 0
  v_mov_b32 v47, 0
  v_mov_b32 v48, 0
  v_mov_b32 v49, 0
  v_mov_b32 v50, 0
  v_mov_b32 v51, 0
  v_mov_b32 v62, 0
  v_mov_b32 v63, 0
  v_mov_b32 v64, 0
  v_mov_b32 v65, 0
  v_mov_b32 v68, 0
  v_mov_b32 v69, 0
  v_mov_b32 v70, 0
  v_mov_b32 v71, 0
  v_mov_b32 v72, 0
  v_mov_b32 v73, 0
  v_mov_b32 v74, 0
  v_mov_b32 v75, 0
  v_mov_b32 v52, 0
  v_mov_b32 v53, 0
  v_mov_b32 v54, 0
  v_mov_b32 v55, 0
  v_mov_b32 v56, 0
  v_mov_b32 v57, 0
  v_mov_b32 v58, 0
  v_mov_b32 v59, 0
  s_add_u32 s31, s31, 0x100
  s_nop 0
  s_branch cB_sc2_go
.p2align 6
cB_sc3_loop:
  s_mov_b32 s30, 0
  s_mov_b32 s62, 0
  s_setprio 3
  s_barrier
  buffer_load_dwordx4 v[8:11], v2, s[8:11], s20 offen offset:0 sc1
  s_setprio 2
  buffer_load_dwordx4 v[12:15], v2, s[8:11], s20 offen offset:1024 sc1
  s_setprio 1
  buffer_load_dwordx4 v[16:19], v2, s[8:11], s20 offen offset:2048 sc1
  s_setprio 0
  buffer_load_dwordx4 v[20:23], v2, s[8:11], s20 offen offset:3072 sc1
cB_sc3_go:
  s_waitcnt vmcnt(3)
  v_smfmac_f32_16x16x64_bf16 v[36:39], v[8:11], a[0:7], v3
  buffer_load_dwordx4 v[24:27], v2, s[8:11], s23 offen offset:0 sc1
  v_cmp_eq_u32 vcc, -1, v8
  v_smfmac_f32_16x16x64_bf16 v[40:43], v[8:11], a[56:63], v3
  v_smfmac_f32_16x16x64_bf16 v[44:47], v[8:11], a[112:119], v3
  buffer_load_dwordx4 v[28:31], v2, s[8:11], s23 offen offset:1024 sc1
  s_cbranch_vccnz cB_sc3_r0
  v_smfmac_f32_16x16x64_bf16 v[48:51], v[8:11], a[168:175], v3
  v_smfmac_f32_16x16x64_bf16 v[52:55], v[8:11], a[224:231], v3
  s_waitcnt vmcnt(4)
  v_cmp_eq_u32 vcc, -1, v12
  v_smfmac_f32_16x16x64_bf16 v[56:59], v[8:11], v[144:151], v3
  buffer_load_dwordx4 v[32:35], v2, s[8:11], s23 offen offset:2048 sc1
  v_smfmac_f32_16x16x64_bf16 v[62:65], v[8:11], v[200:207], v3
  s_cbranch_vccnz cB_sc3_r1
cB_sc3_c1:
  v_smfmac_f32_16x16x64_bf16 v[36:39], v[12:15], a[8:15], v3
  v_smfmac_f32_16x16x64_bf16 v[40:43], v[12:15], a[64:71], v3
  v_smfmac_f32_16x16x64_bf16 v[44:47], v[12:15], a[120:127], v3
  v_smfmac_f32_16x16x64_bf16 v[48:51], v[12:15], a[176:183], v3
  v_smfmac_f32_16x16x64_bf16 v[52:55], v[12:15], a[232:239], v3
  s_waitcnt vmcnt(4)
  v_cmp_eq_u32 vcc, -1, v16
  v_smfmac_f32_16x16x64_bf16 v[56:59], v[12:15], v[152:159], v3
  buffer_load_dwordx4 v[88:91], v117, s[8:11], s26 offen offset:0 sc1
  v_smfmac_f32_16x16x64_bf16 v[62:65], v[12:15], v[208:215], v3
  s_cbranch_vccnz cB_sc3_r2
cB_sc3_c2:
  v_smfmac_f32_16x16x64_bf16 v[36:39], v[16:19], a[16:23], v3
  v_smfmac_f32_16x16x64_bf16 v[40:43], v[16:19], a[72:79], v3
  v_smfmac_f32_16x16x64_bf16 v[44:47], v[16:19], a[128:135], v3
  buffer_load_dwordx4 v[92:95], v117, s[8:11], s26 offen offset:1024 sc1
  v_smfmac_f32_16x16x64_bf16 v[48:51], v[16:19], a[184:191], v3
  v_smfmac_f32_16x16x64_bf16 v[52:55], v[16:19], a[240:247], v3
  s_waitcnt vmcnt(5)
  v_cmp_eq_u32 vcc, -1, v20
  v_smfmac_f32_16x16x64_bf16 v[56:59], v[16:19], v[160:167], v3
  v_smfmac_f32_16x16x64_bf16 v[62:65], v[16:19], v[216:223], v3
  buffer_load_dwordx4 v[96:99], v2, s[8:11], s24 offen offset:0 sc1
  s_cbranch_vccnz cB_sc3_r3
cB_sc3_c3:
  v_smfmac_f32_16x16x64_bf16 v[36:39], v[20:23], a[24:31], v3
  v_smfmac_f32_16x16x64_bf16 v[40:43], v[20:23], a[80:87], v3
  s_waitcnt vmcnt(3)
  v_max3_u32 v66, v24, v27, v28
  v_smfmac_f32_16x16x64_bf16 v[44:47], v[20:23], a[136:143], v3
  v_max3_u32 v66, v66, v31, v32
  v_smfmac_f32_16x16x64_bf16 v[48:51], v[20:23], a[192:199], v3
  buffer_load_dwordx4 v[100:103], v2, s[8:11], s24 offen offset:1024 sc1
  v_max_u32 v66, v66, v35
  v_smfmac_f32_16x16x64_bf16 v[52:55], v[20:23], a[248:255], v3
  v_cmp_eq_u32 vcc, -1, v66
  v_smfmac_f32_16x16x64_bf16 v[56:59], v[20:23], v[168:175], v3
  v_smfmac_f32_16x16x64_bf16 v[62:65], v[20:23], v[224:231], v3
  s_cbranch_vccnz cB_sc3_r4
cB_sc3_c4:
  v_smfmac_f32_16x16x64_bf16 v[62:65], v[24:27], v[232:239], v3
  buffer_load_dwordx4 v[104:107], v2, s[8:11], s26 offen offset:0 sc1
  v_smfmac_f32_16x16x64_bf16 v[62:65], v[28:31], v[240:247], v3
  v_smfmac_f32_16x16x64_bf16 v[62:65], v[32:35], v[248:255], v3
  v_smfmac_f32_16x16x64_bf16 v[52:55], v[24:27], v[120:127], v3
  v_smfmac_f32_16x16x64_bf16 v[52:55], v[28:31], v[128:135], v3
  buffer_load_dwordx4 v[108:111], v2, s[8:11], s26 offen offset:1024 sc1
  v_smfmac_f32_16x16x64_bf16 v[52:55], v[32:35], v[136:143], v3
  v_cvt_pk_bf16_f32 v62, v62, v63
  v_smfmac_f32_16x16x64_bf16 v[56:59], v[24:27], v[176:183], v3
  v_cvt_pk_bf16_f32 v63, v64, v65
  v_smfmac_f32_16x16x64_bf16 v[56:59], v[28:31], v[184:191], v3
  v_mfma_f32_16x16x32_bf16 v[8:11], v[60:63], v[4:7], 0
  v_cvt_pk_bf16_f32 v55, v54, v55
  v_smfmac_f32_16x16x64_bf16 v[56:59], v[32:35], v[192:199], v3
  v_cvt_pk_bf16_f32 v54, v52, v53
  v_smfmac_f32_16x16x64_bf16 v[36:39], v[24:27], a[32:39], v3
  s_nop 1
  v_cvt_pk_bf16_f32 v78, v8, v9
  v_smfmac_f32_16x16x64_bf16 v[36:39], v[28:31], a[40:47], v3
  v_cvt_pk_bf16_f32 v79, v10, v11
  v_smfmac_f32_16x16x64_bf16 v[36:39], v[32:35], a[48:55], v3
  v_cvt_pk_bf16_f32 v56, v56, v57
  v_smfmac_f32_16x16x64_bf16 v[40:43], v[24:27], a[88:95], v3
  v_cvt_pk_bf16_f32 v57, v58, v59
  v_smfmac_f32_16x16x64_bf16 v[40:43], v[28:31], a[96:103], v3
  v_mfma_f32_16x16x32_bf16 v[12:15], v[54:57], v[4:7], 0
  v_cvt_pk_bf16_f32 v39, v38, v39
  v_smfmac_f32_16x16x64_bf16 v[40:43], v[32:35], a[104:111], v3
  v_cvt_pk_bf16_f32 v38, v36, v37
  v_smfmac_f32_16x16x64_bf16 v[44:47], v[24:27], a[144:151], v3
  s_nop 1
  v_cvt_pk_bf16_f32 v76, v12, v13
  v_smfmac_f32_16x16x64_bf16 v[44:47], v[28:31], a[152:159], v3
  v_cvt_pk_bf16_f32 v77, v14, v15
  v_smfmac_f32_16x16x64_bf16 v[44:47], v[32:35], a[160:167], v3
  v_cvt_pk_bf16_f32 v40, v40, v41
  v_smfmac_f32_16x16x64_bf16 v[48:51], v[24:27], a[200:207], v3
  v_cvt_pk_bf16_f32 v41, v42, v43
  v_smfmac_f32_16x16x64_bf16 v[48:51], v[28:31], a[208:215], v3
  v_smfmac_f32_16x16x64_bf16 v[48:51], v[32:35], a[216:223], v3
  s_waitcnt vmcnt(4)
  v_cvt_pk_bf16_f32 v47, v46, v47
  v_smfmac_f32_16x16x64_bf16 v[68:71], v[76:79], v[80:87], v3
  v_cvt_pk_bf16_f32 v46, v44, v45
  v_mfma_f32_16x16x32_bf16 v[8:11], v[38:41], v[4:7], 0
  s_nop 1
  v_cvt_pk_bf16_f32 v48, v48, v49
  v_cvt_pk_bf16_f32 v49, v50, v51
  s_nop 1
  v_mfma_f32_16x16x32_bf16 v[12:15], v[46:49], v[4:7], 0
  v_smfmac_f32_16x16x64_bf16 v[72:75], v[76:79], v[88:95], v3
  v_cvt_pk_bf16_f32 v16, v8, v9
  v_mfma_f32_16x16x32_bf16 v[52:55], v[30:33], v[76:79], 0
  s_waitcnt vmcnt(0)
  v_cvt_pk_bf16_f32 v17, v10, v11
  v_cvt_pk_bf16_f32 v18, v12, v13
  v_cvt_pk_bf16_f32 v19, v14, v15
  s_nop 1
  v_mfma_f32_16x16x32_bf16 v[52:55], v[20:23], v[16:19], v[52:55]
  v_smfmac_f32_16x16x64_bf16 v[68:71], v[16:19], v[96:103], v3
  v_smfmac_f32_16x16x64_bf16 v[72:75], v[16:19], v[104:111], v3
  s_nop 1
  ds_write_b128 v113, v[52:55]
  s_nop 1
  v_permlane32_swap_b32 v68, v70
  v_permlane32_swap_b32 v69, v71
  v_add_f32 v56, v68, v70
  v_add_f32 v58, v69, v71
  v_permlane32_swap_b32 v72, v74
  v_permlane32_swap_b32 v73, v75
  v_add_f32 v57, v72, v74
  v_add_f32 v59, v73, v75
  ds_write_b128 v2, v[56:59] offset:3072
  v_cmp_u_f32 vcc, v57, v59
  v_mov_b32 v68, 0
  v_mov_b32 v69, 0
  v_mov_b32 v70, 0
  v_mov_b32 v71, 0
  s_cbranch_vccnz cB_sc3_retry
cB_sc3_cont:
  s_add_u32 s24, s24, 28672
  s_add_u32 s26, s26, 28672
  buffer_load_dwordx4 v[80:83], v117, s[8:11], s24 offen offset:0 sc1
  buffer_load_dwordx4 v[84:87], v117, s[8:11], s24 offen offset:1024 sc1
  v_mov_b32 v72, 0
  v_mov_b32 v73, 0
  v_mfma_f32_16x16x32_bf16 v[62:65], v[68:71], v[68:71], 0
  s_waitcnt lgkmcnt(0)
  s_barrier
  v_mov_b32 v52, 0
  v_mov_b32 v53, 0
  v_mov_b32 v54, 0
  v_mov_b32 v55, 0
  v_mov_b32 v56, 0
  v_mov_b32 v57, 0
  v_mov_b32 v58, 0
  v_mov_b32 v59, 0
  v_mfma_f32_32x32x16_bf16 v[36:51], v[68:71], v[68:71], 0
  v_mov_b32 v74, 0
  v_mov_b32 v75, 0
  s_mov_b32 s19, s18
  s_add_u32 s18, s18, 1
  s_mov_b32 s22, s20
  s_mov_b32 s20, s21
  s_mov_b32 s21, s22
  s_add_u32 s23, s20, 4096
  s_cmp_lt_u32 s19, 63
  s_nop 2
  s_cbranch_scc1 cB_sc3_loop
  s_branch cB_done
cB_sc3_r0:
  s_add_u32 s31, s31, 1
  buffer_load_dwordx4 v[8:11], v2, s[8:11], s20 offen offset:0 sc1
  s_waitcnt vmcnt(0)
  v_cmp_eq_u32 vcc, -1, v8
  v_mov_b32 v36, 0
  v_mov_b32 v37, 0
  v_mov_b32 v38, 0
  v_mov_b32 v39, 0
  v_mov_b32 v40, 0
  v_mov_b32 v41, 0
  v_mov_b32 v42, 0
  v_mov_b32 v43, 0
  v_mov_b32 v44, 0
  v_mov_b32 v45, 0
  v_mov_b32 v46, 0
  v_mov_b32 v47, 0
  v_mov_b32 v48, 0
  v_mov_b32 v49, 0
  v_mov_b32 v50, 0
  v_mov_b32 v51, 0
  s_nop 1
  s_cbranch_vccz cB_sc3_go
  s_add_u32 s30, s30, 1
  s_cmp_lt_u32 s30, 400000
  s_cbranch_scc1 cB_sc3_r0
  s_branch cB_abort
cB_sc3_r1:
  s_add_u32 s31, s31, 1
  buffer_load_dwordx4 v[12:15], v2, s[8:11], s20 offen offset:1024 sc1
  s_waitcnt vmcnt(0)
  v_cmp_eq_u32 vcc, -1, v12
  s_nop 4
  s_cbranch_vccz cB_sc3_c1
  s_add_u32 s30, s30, 1
  s_cmp_lt_u32 s30, 400000
  s_cbranch_scc1 cB_sc3_r1
  s_branch cB_abort
cB_sc3_r2:
  s_add_u32 s31, s31, 1
  buffer_load_dwordx4 v[16:19], v2, s[8:11], s20 offen offset:2048 sc1
  s_waitcnt vmcnt(0)
  v_cmp_eq_u32 vcc, -1, v16
  s_nop 4
  s_cbranch_vccz cB_sc3_c2
  s_add_u32 s30, s30, 1
  s_cmp_lt_u32 s30, 400000
  s_cbranch_scc1 cB_sc3_r2
  s_branch cB_abort
cB_sc3_r3:
  s_add_u32 s31, s31, 1
  buffer_load_dwordx4 v[20:23], v2, s[8:11], s20 offen offset:3072 sc1
  s_waitcnt vmcnt(0)
  v_cmp_eq_u32 vcc, -1, v20
  s_nop 4
  s_cbranch_vccz cB_sc3_c3
  s_add_u32 s30, s30, 1
  s_cmp_lt_u32 s30, 400000
  s_cbranch_scc1 cB_sc3_r3
  s_branch cB_abort
cB_sc3_r4:
  s_add_u32 s31, s31, 1
  buffer_load_dwordx4 v[24:27], v2, s[8:11], s23 offen offset:0 sc1
  buffer_load_dwordx4 v[28:31], v2, s[8:11], s23 offen offset:1024 sc1
  buffer_load_dwordx4 v[32:35], v2, s[8:11], s23 offen offset:2048 sc1
  s_waitcnt vmcnt(0)
  v_max3_u32 v66, v24, v27, v28
  v_max3_u32 v66, v66, v31, v32
  v_max_u32 v66, v66, v35
  v_cmp_eq_u32 vcc, -1, v66
  s_nop 4
  s_cbranch_vccz cB_sc3_c4
  s_add_u32 s30, s30, 1
  s_cmp_lt_u32 s30, 400000
  s_cbranch_scc1 cB_sc3_r4
  s_branch cB_abort
cB_sc3_retry:
  s_cmp_lg_u32 s62, 0
  s_cbranch_scc1 cB_sc3_cont
  s_waitcnt vmcnt(0) lgkmcnt(0)
cB_sc3_rv:
  buffer_load_dwordx4 v[8:11], v2, s[8:11], s20 offen offset:0 sc1
  buffer_load_dwordx4 v[12:15], v2, s[8:11], s20 offen offset:1024 sc1
  buffer_load_dwordx4 v[16:19], v2, s[8:11], s20 offen offset:2048 sc1
  buffer_load_dwordx4 v[20:23], v2, s[8:11], s20 offen offset:3072 sc1
  buffer_load_dwordx4 v[24:27], v2, s[8:11], s23 offen offset:0 sc1
  buffer_load_dwordx4 v[28:31], v2, s[8:11], s23 offen offset:1024 sc1
  buffer_load_dwordx4 v[32:35], v2, s[8:11], s23 offen offset:2048 sc1
  s_waitcnt vmcnt(0)
  v_max3_u32 v66, v8, v9, v10
  v_max3_u32 v66, v66, v11, v12
  v_max3_u32 v66, v66, v13, v14
  v_max3_u32 v66, v66, v15, v16
  v_max3_u32 v66, v66, v17, v18
  v_max3_u32 v66, v66, v19, v20
  v_max3_u32 v66, v66, v21, v22
  v_max3_u32 v66, v66, v23, v24
  v_max3_u32 v66, v66, v25, v26
  v_max3_u32 v66, v66, v27, v28
  v_max3_u32 v66, v66, v29, v30
  v_max3_u32 v66, v66, v31, v32
  v_max3_u32 v66, v66, v33, v34
  v_max_u32 v66, v66, v35
  v_cmp_eq_u32 vcc, -1, v66
  s_cbranch_vccz cB_sc3_rk
  s_add_u32 s30, s30, 1
  s_cmp_lt_u32 s30, 400000
  s_cbranch_scc1 cB_sc3_rv
  s_branch cB_abort
cB_sc3_rk:
  s_mov_b32 s62, 1
  v_mov_b32 v36, 0
  v_mov_b32 v37, 0
  v_mov_b32 v38, 0
  v_mov_b32 v39, 0
  v_mov_b32 v40, 0
  v_mov_b32 v41, 0
  v_mov_b32 v42, 0
  v_mov_b32 v43, 0
  v_mov_b32 v44, 0
  v_mov_b32 v45, 0
  v_mov_b32 v46, 0
  v_mov_b32 v47, 0
  v_mov_b32 v48, 0
  v_mov_b32 v49, 0
  v_mov_b32 v50, 0
  v_mov_b32 v51, 0
  v_mov_b32 v62, 0
  v_mov_b32 v63, 0
  v_mov_b32 v64, 0
  v_mov_b32 v65, 0
  v_mov_b32 v68, 0
  v_mov_b32 v69, 0
  v_mov_b32 v70, 0
  v_mov_b32 v71, 0
  v_mov_b32 v72, 0
  v_mov_b32 v73, 0
  v_mov_b32 v74, 0
  v_mov_b32 v75, 0
  v_mov_b32 v52, 0
  v_mov_b32 v53, 0
  v_mov_b32 v54, 0
  v_mov_b32 v55, 0
  v_mov_b32 v56, 0
  v_mov_b32 v57, 0
  v_mov_b32 v58, 0
  v_mov_b32 v59, 0
  s_add_u32 s31, s31, 0x100
  s_nop 0
  s_branch cB_sc3_go
.p2align 6
cB_va0_loop:
  s_mov_b32 s30, 0
  s_barrier
  buffer_load_dwordx4 v[24:27], v2, s[8:11], s23 offen offset:0 sc1
  buffer_load_dwordx4 v[28:31], v2, s[8:11], s23 offen offset:1024 sc1
  s_barrier
  s_cmp_lt_u32 s19, 60
  s_cbranch_scc1 cB_va0_m1
  buffer_store_dword v160, v1, s[8:11], s38 offen sc1
  s_cmp_lg_u32 s19, 63
  s_cbranch_scc1 cB_va0_m2
  v_min_u32 v64, -2, v64
  v_min_u32 v65, -2, v65
  v_min_u32 v66, -2, v66
  v_min_u32 v67, -2, v67
  v_min_u32 v68, -2, v68
  v_min_u32 v69, -2, v69
  v_min_u32 v70, -2, v70
  v_min_u32 v71, -2, v71
  v_min_u32 v72, -2, v72
  v_min_u32 v73, -2, v73
  v_min_u32 v74, -2, v74
  v_min_u32 v75, -2, v75
  v_min_u32 v76, -2, v76
  v_min_u32 v77, -2, v77
  v_min_u32 v78, -2, v78
  v_min_u32 v79, -2, v79
  buffer_store_dwordx4 v[64:67], v2, s[8:11], s33 offen offset:0 sc1
  buffer_store_dwordx4 v[68:71], v2, s[8:11], s33 offen offset:2048 sc1
  s_add_u32 s33, s33, 4096
  buffer_store_dwordx4 v[72:75], v2, s[8:11], s33 offen offset:0 sc1
  buffer_store_dwordx4 v[76:79], v2, s[8:11], s33 offen offset:2048 sc1
  s_add_u32 s33, s33, 4096
  s_waitcnt vmcnt(5)
  s_branch cB_va0_m3
cB_va0_m1:
  buffer_store_dword v160, v1, s[8:11], s38 offen sc1
cB_va0_m2:
  s_add_u32 s22, s25, 0
  buffer_load_dwordx4 v[80:83], v6, s[8:11], s22 offen offset:0 sc1
  buffer_load_dwordx4 v[84:87], v6, s[8:11], s22 offen offset:1792 sc1
  s_add_u32 s22, s25, 3584
  buffer_load_dwordx4 v[88:91], v6, s[8:11], s22 offen offset:0 sc1
  buffer_load_dwordx4 v[92:95], v6, s[8:11], s22 offen offset:1792 sc1
  s_add_u32 s22, s25, 7168
  buffer_load_dwordx4 v[96:99], v6, s[8:11], s22 offen offset:0 sc1
  s_mul_i32 s38, s18, 7168
  s_add_u32 s38, s38, 65536
  s_waitcnt vmcnt(6)
cB_va0_m3:
  ds_write_b128 v2, v[24:27] offset:12288
  ds_write_b128 v2, v[28:31] offset:13312
  v_smfmac_f32_16x16x64_bf16 v[36:39], v[24:27], a[32:39], v3
  buffer_load_dwordx4 v[100:103], v6, s[8:11], s22 offen offset:1792 sc1
  v_smfmac_f32_16x16x64_bf16 v[40:43], v[24:27], a[88:95], v3
  s_add_u32 s22, s25, 10752
  buffer_load_dwordx4 v[104:107], v6, s[8:11], s22 offen offset:0 sc1
  v_smfmac_f32_16x16x64_bf16 v[44:47], v[24:27], a[144:151], v3
  buffer_load_dwordx4 v[108:111], v6, s[8:11], s22 offen offset:1792 sc1
  v_smfmac_f32_16x16x64_bf16 v[48:51], v[24:27], a[200:207], v3
  s_add_u32 s22, s25, 14336
  buffer_load_dwordx4 v[112:115], v6, s[8:11], s22 offen offset:0 sc1
  v_smfmac_f32_16x16x64_bf16 v[52:55], v[24:27], v[176:183], v3
  s_waitcnt lgkmcnt(0)
  s_barrier
  ds_read_b128 v[8:11], v2 offset:8192
  ds_read_b128 v[12:15], v2 offset:9216
  ds_read_b128 v[16:19], v2 offset:10240
  ds_read_b128 v[20:23], v2 offset:11264
  ds_read_b128 v[32:35], v2 offset:14336
  buffer_load_dwordx4 v[116:119], v6, s[8:11], s22 offen offset:1792 sc1
  v_smfmac_f32_16x16x64_bf16 v[56:59], v[24:27], v[232:239], v3
  s_add_u32 s22, s25, 17920
  buffer_load_dwordx4 v[120:123], v6, s[8:11], s22 offen offset:0 sc1
  v_smfmac_f32_16x16x64_bf16 v[36:39], v[28:31], a[40:47], v3
  buffer_load_dwordx4 v[124:127], v6, s[8:11], s22 offen offset:1792 sc1
  v_smfmac_f32_16x16x64_bf16 v[40:43], v[28:31], a[96:103], v3
  s_add_u32 s22, s25, 21504
  buffer_load_dwordx4 v[128:131], v6, s[8:11], s22 offen offset:0 sc1
  v_smfmac_f32_16x16x64_bf16 v[44:47], v[28:31], a[152:159], v3
  buffer_load_dwordx4 v[132:135], v6, s[8:11], s22 offen offset:1792 sc1
  v_smfmac_f32_16x16x64_bf16 v[48:51], v[28:31], a[208:215], v3
  s_add_u32 s22, s25, 25088
  buffer_load_dwordx4 v[136:139], v6, s[8:11], s22 offen offset:0 sc1
  v_smfmac_f32_16x16x64_bf16 v[52:55], v[28:31], v[184:191], v3
  buffer_load_dwordx4 v[140:143], v6, s[8:11], s22 offen offset:1792 sc1
  v_smfmac_f32_16x16x64_bf16 v[56:59], v[28:31], v[240:247], v3
  s_waitcnt lgkmcnt(4)
  v_smfmac_f32_16x16x64_bf16 v[36:39], v[8:11], a[0:7], v3
  s_waitcnt lgkmcnt(3)
  v_smfmac_f32_16x16x64_bf16 v[36:39], v[12:15], a[8:15], v3
  s_waitcnt lgkmcnt(2)
  v_smfmac_f32_16x16x64_bf16 v[36:39], v[16:19], a[16:23], v3
  s_waitcnt lgkmcnt(1)
  v_smfmac_f32_16x16x64_bf16 v[36:39], v[20:23], a[24:31], v3
  s_waitcnt lgkmcnt(0)
  v_smfmac_f32_16x16x64_bf16 v[36:39], v[32:35], a[48:55], v3
  v_smfmac_f32_16x16x64_bf16 v[40:43], v[8:11], a[56:63], v3
  v_smfmac_f32_16x16x64_bf16 v[40:43], v[12:15], a[64:71], v3
  v_smfmac_f32_16x16x64_bf16 v[40:43], v[16:19], a[72:79], v3
  v_permlane32_swap_b32 v36, v38
  v_smfmac_f32_16x16x64_bf16 v[40:43], v[20:23], a[80:87], v3
  v_permlane32_swap_b32 v37, v39
  v_smfmac_f32_16x16x64_bf16 v[40:43], v[32:35], a[104:111], v3
  v_add_f32 v36, v36, v38
  v_smfmac_f32_16x16x64_bf16 v[44:47], v[8:11], a[112:119], v3
  v_add_f32 v37, v37, v39
  v_smfmac_f32_16x16x64_bf16 v[44:47], v[12:15], a[120:127], v3
  v_cmp_u_f32 vcc, v36, v37
  v_smfmac_f32_16x16x64_bf16 v[44:47], v[16:19], a[128:135], v3
  v_cvt_pk_bf16_f32 v38, v36, v37
  v_smfmac_f32_16x16x64_bf16 v[44:47], v[20:23], a[136:143], v3
  ds_write_b32 v152, v38
  s_cbranch_vccnz cB_va0_slow
  v_permlane32_swap_b32 v40, v42
  v_smfmac_f32_16x16x64_bf16 v[44:47], v[32:35], a[160:167], v3
  v_permlane32_swap_b32 v41, v43
  v_smfmac_f32_16x16x64_bf16 v[48:51], v[8:11], a[168:175], v3
  buffer_store_dword v162, v1, s[8:11], s21 offen sc1
  v_add_f32 v40, v40, v42
  v_smfmac_f32_16x16x64_bf16 v[48:51], v[12:15], a[176:183], v3
  v_add_f32 v41, v41, v43
  v_smfmac_f32_16x16x64_bf16 v[48:51], v[16:19], a[184:191], v3
  buffer_load_dword v164, v4, s[8:11], 0 offen sc1
  v_cvt_pk_bf16_f32 v42, v40, v41
  v_smfmac_f32_16x16x64_bf16 v[48:51], v[20:23], a[192:199], v3
  ds_write_b32 v153, v42
  v_permlane32_swap_b32 v44, v46
  v_smfmac_f32_16x16x64_bf16 v[48:51], v[32:35], a[216:223], v3
  v_permlane32_swap_b32 v45, v47
  v_smfmac_f32_16x16x64_bf16 v[52:55], v[8:11], a[224:231], v3
  buffer_load_dword v164, v4, s[8:11], 0 offen sc1
  v_add_f32 v44, v44, v46
  v_smfmac_f32_16x16x64_bf16 v[52:55], v[12:15], a[232:239], v3
  v_add_f32 v45, v45, v47
  v_smfmac_f32_16x16x64_bf16 v[52:55], v[16:19], a[240:247], v3
  v_cvt_pk_bf16_f32 v46, v44, v45
  v_smfmac_f32_16x16x64_bf16 v[52:55], v[20:23], a[248:255], v3
  ds_write_b32 v154, v46
  buffer_load_dword v164, v4, s[8:11], 0 offen sc1
  v_permlane32_swap_b32 v48, v50
  v_smfmac_f32_16x16x64_bf16 v[52:55], v[32:35], v[192:199], v3
  v_permlane32_swap_b32 v49, v51
  v_smfmac_f32_16x16x64_bf16 v[56:59], v[8:11], v[200:207], v3
  v_add_f32 v48, v48, v50
  v_smfmac_f32_16x16x64_bf16 v[56:59], v[12:15], v[208:215], v3
  buffer_load_dword v164, v4, s[8:11], 0 offen sc1
  v_add_f32 v49, v49, v51
  v_smfmac_f32_16x16x64_bf16 v[56:59], v[16:19], v[216:223], v3
  v_cvt_pk_bf16_f32 v50, v48, v49
  v_smfmac_f32_16x16x64_bf16 v[56:59], v[20:23], v[224:231], v3
  ds_write_b32 v155, v50
  v_permlane32_swap_b32 v52, v54
  v_smfmac_f32_16x16x64_bf16 v[56:59], v[32:35], v[248:255], v3
  buffer_load_dword v164, v4, s[8:11], 0 offen sc1
  v_permlane32_swap_b32 v53, v55
  v_add_f32 v52, v52, v54
  v_add_f32 v53, v53, v55
  v_cvt_pk_bf16_f32 v54, v52, v53
  ds_write_b32 v156, v54
  s_nop 1
  v_permlane32_swap_b32 v56, v58
  v_permlane32_swap_b32 v57, v59
  v_add_f32 v56, v56, v58
  v_add_f32 v57, v57, v59
  v_cvt_pk_bf16_f32 v58, v56, v57
  ds_write_b32 v157, v58
cB_va0_t2d:
  s_add_u32 s22, s20, 9216
  s_add_u32 s34, s20, 13312
  s_add_u32 s36, s20, 7168
  s_mov_b32 s37, 0
  v_mov_b32 v48, 0
  v_mov_b32 v49, 0
  v_mov_b32 v50, 0
  v_mov_b32 v51, 0
  v_mov_b32 v163, s18
  s_cmp_eq_u32 s19, 63
  s_waitcnt lgkmcnt(0)
  s_cbranch_scc1 cB_va0_last
  s_setprio 3
cB_va0_fw_l:
  v_cmp_gt_u32 vcc, s18, v164
  buffer_load_dword v164, v4, s[8:11], 0 offen sc1
  s_cbranch_vccz cB_va0_fw_d
  v_cmp_gt_u32 vcc, s18, v164
  buffer_load_dword v164, v4, s[8:11], 0 offen sc1
  s_cbranch_vccz cB_va0_fw_d
  v_cmp_gt_u32 vcc, s18, v164
  buffer_load_dword v164, v4, s[8:11], 0 offen sc1
  s_cbranch_vccz cB_va0_fw_d
  v_cmp_gt_u32 vcc, s18, v164
  buffer_load_dword v164, v4, s[8:11], 0 offen sc1
  s_cbranch_vccz cB_va0_fw_d
  v_cmp_gt_u32 vcc, s18, v164
  buffer_load_dword v164, v4, s[8:11], 0 offen sc1
  s_cbranch_vccz cB_va0_fw_d
  v_cmp_gt_u32 vcc, s18, v164
  buffer_load_dword v164, v4, s[8:11], 0 offen sc1
  s_cbranch_vccz cB_va0_fw_d
  v_cmp_gt_u32 vcc, s18, v164
  buffer_load_dword v164, v4, s[8:11], 0 offen sc1
  s_cbranch_vccz cB_va0_fw_d
  v_cmp_gt_u32 vcc, s18, v164
  buffer_load_dword v164, v4, s[8:11], 0 offen sc1
  s_cbranch_vccz cB_va0_fw_d
  v_cmp_gt_u32 vcc, s18, v164
  buffer_load_dword v164, v4, s[8:11], 0 offen sc1
  s_cbranch_vccz cB_va0_fw_d
  v_cmp_gt_u32 vcc, s18, v164
  buffer_load_dword v164, v4, s[8:11], 0 offen sc1
  s_cbranch_vccz cB_va0_fw_d
  v_cmp_gt_u32 vcc, s18, v164
  buffer_load_dword v164, v4, s[8:11], 0 offen sc1
  s_cbranch_vccz cB_va0_fw_d
  v_cmp_gt_u32 vcc, s18, v164
  buffer_load_dword v164, v4, s[8:11], 0 offen sc1
  s_cbranch_vccz cB_va0_fw_d
  v_cmp_gt_u32 vcc, s18, v164
  buffer_load_dword v164, v4, s[8:11], 0 offen sc1
  s_cbranch_vccz cB_va0_fw_d
  v_cmp_gt_u32 vcc, s18, v164
  buffer_load_dword v164, v4, s[8:11], 0 offen sc1
  s_cbranch_vccz cB_va0_fw_d
  v_cmp_gt_u32 vcc, s18, v164
  buffer_load_dword v164, v4, s[8:11], 0 offen sc1
  s_cbranch_vccz cB_va0_fw_d
  v_cmp_gt_u32 vcc, s18, v164
  buffer_load_dword v164, v4, s[8:11], 0 offen sc1
  s_cbranch_vccz cB_va0_fw_d
  s_waitcnt vmcnt(24)
  s_add_u32 s30, s30, 1
  s_cmp_lt_u32 s30, 400000
  s_cbranch_scc1 cB_va0_fw_l
  s_branch cB_abort
cB_va0_fw_d:
  buffer_load_dwordx4 v[8:11], v2, s[8:11], s22 offen offset:0 sc1
  buffer_load_dwordx4 v[12:15], v2, s[8:11], s22 offen offset:1024 sc1
  buffer_load_dwordx4 v[16:19], v2, s[8:11], s22 offen offset:2048 sc1
  buffer_load_dwordx4 v[20:23], v2, s[8:11], s22 offen offset:3072 sc1
  buffer_load_dwordx4 v[24:27], v2, s[8:11], s34 offen offset:0 sc1
  buffer_load_dwordx4 v[28:31], v2, s[8:11], s34 offen offset:1024 sc1
  buffer_load_dwordx4 v[32:35], v2, s[8:11], s34 offen offset:2048 sc1
  buffer_load_dwordx4 v[36:39], v2, s[8:11], s34 offen offset:3072 sc1
  buffer_load_dwordx4 v[40:43], v2, s[8:11], s36 offen offset:0 sc1
  buffer_load_dwordx4 v[44:47], v2, s[8:11], s36 offen offset:1024 sc1
  s_barrier
  ds_read_b128 v[64:67], v2 offset:0
  ds_read_b128 v[68:71], v2 offset:1024
  ds_read_b128 v[72:75], v2 offset:2048
  ds_read_b128 v[76:79], v2 offset:3072
cB_va0_lp:
  s_waitcnt vmcnt(9)
  v_smfmac_f32_16x16x64_bf16 v[48:51], v[8:11], v[80:87], v3
  s_waitcnt vmcnt(8)
  v_smfmac_f32_16x16x64_bf16 v[48:51], v[12:15], v[88:95], v3
  s_waitcnt vmcnt(7)
  v_smfmac_f32_16x16x64_bf16 v[48:51], v[16:19], v[96:103], v3
  s_waitcnt vmcnt(6)
  v_smfmac_f32_16x16x64_bf16 v[48:51], v[20:23], v[104:111], v3
  s_waitcnt vmcnt(5)
  v_smfmac_f32_16x16x64_bf16 v[48:51], v[24:27], v[112:119], v3
  s_waitcnt vmcnt(4)
  v_smfmac_f32_16x16x64_bf16 v[48:51], v[28:31], v[120:127], v3
  s_waitcnt vmcnt(3)
  v_smfmac_f32_16x16x64_bf16 v[48:51], v[32:35], v[128:135], v3
  s_waitcnt vmcnt(2)
  v_smfmac_f32_16x16x64_bf16 v[48:51], v[36:39], v[136:143], v3
  s_waitcnt vmcnt(1) lgkmcnt(0)
  v_smfmac_f32_16x16x64_bf16 v[48:51], v[40:43], v[64:71], v3
  s_waitcnt vmcnt(0)
  v_smfmac_f32_16x16x64_bf16 v[48:51], v[44:47], v[72:79], v3
  s_nop 7
  v_permlane32_swap_b32 v48, v50
  v_permlane32_swap_b32 v49, v51
  v_pk_add_f32 v[48:49], v[48:49], v[50:51]
  v_cvt_pk_bf16_f32 v160, v48, v49
  v_cmp_u_f32 vcc, v48, v49
  s_nop 0
  v_mov_b32_dpp v161, v160 quad_perm:[1,0,3,2] row_mask:0xf bank_mask:0xf
  v_perm_b32 v160, v161, v160, v5
  v_cndmask_b32 v161, v160, v162, vcc
  buffer_store_dword v161, v1, s[8:11], s21 offen sc1
  s_cbranch_vccnz cB_va0_rp
cB_va0_cont:
  s_setprio 0
  s_cmp_lg_u32 s19, 62
  s_cbranch_scc1 cB_va0_nl
  s_sleep 4
  buffer_store_dword v160, v1, s[8:11], s38 offen sc1
  s_mov_b32 s38, 0x40000000
  s_mov_b32 s25, 0x40000000
cB_va0_nl:
  s_add_u32 s25, s25, 458752
  v_mov_b32 v36, 0
  v_mov_b32 v37, 0
  v_mov_b32 v38, 0
  v_mov_b32 v39, 0
  v_mov_b32 v40, 0
  v_mov_b32 v41, 0
  v_mov_b32 v42, 0
  v_mov_b32 v43, 0
  v_mov_b32 v44, 0
  v_mov_b32 v45, 0
  v_mov_b32 v46, 0
  v_mov_b32 v47, 0
  v_mov_b32 v48, 0
  v_mov_b32 v49, 0
  v_mov_b32 v50, 0
  v_mov_b32 v51, 0
  v_mov_b32 v52, 0
  v_mov_b32 v53, 0
  v_mov_b32 v54, 0
  v_mov_b32 v55, 0
  v_mov_b32 v56, 0
  v_mov_b32 v57, 0
  v_mov_b32 v58, 0
  v_mov_b32 v59, 0
  v_mov_b32 v60, 0
  v_mov_b32 v61, 0
  v_mov_b32 v62, 0
  v_mov_b32 v63, 0
  s_mov_b32 s19, s18
  s_add_u32 s18, s18, 1
  s_mov_b32 s22, s20
  s_mov_b32 s20, s21
  s_mov_b32 s21, s22
  s_add_u32 s23, s20, 4096
  s_branch cB_va0_loop
cB_va0_slow:
  s_waitcnt lgkmcnt(0)
cB_va0_sl1:
  s_add_u32 s31, s31, 0x1000000
  buffer_load_dwordx4 v[8:11], v2, s[8:11], s20 offen offset:0 sc1
  buffer_load_dwordx4 v[12:15], v2, s[8:11], s20 offen offset:1024 sc1
  buffer_load_dwordx4 v[16:19], v2, s[8:11], s20 offen offset:2048 sc1
  buffer_load_dwordx4 v[20:23], v2, s[8:11], s20 offen offset:3072 sc1
  buffer_load_dwordx4 v[24:27], v2, s[8:11], s23 offen offset:0 sc1
  buffer_load_dwordx4 v[28:31], v2, s[8:11], s23 offen offset:1024 sc1
  buffer_load_dwordx4 v[32:35], v2, s[8:11], s23 offen offset:2048 sc1
  s_waitcnt vmcnt(0)
  v_max3_u32 v36, v8, v9, v10
  v_max3_u32 v36, v36, v11, v12
  v_max3_u32 v36, v36, v13, v14
  v_max3_u32 v36, v36, v15, v16
  v_max3_u32 v36, v36, v17, v18
  v_max3_u32 v36, v36, v19, v20
  v_max3_u32 v36, v36, v21, v22
  v_max3_u32 v36, v36, v23, v24
  v_max3_u32 v36, v36, v25, v26
  v_max3_u32 v36, v36, v27, v28
  v_max3_u32 v36, v36, v29, v30
  v_max3_u32 v36, v36, v31, v32
  v_max3_u32 v36, v36, v33, v34
  v_max_u32 v36, v36, v35
  v_cmp_eq_u32 vcc, -1, v36
  s_cbranch_vccz cB_va0_sl2
  s_add_u32 s30, s30, 1
  s_cmp_lt_u32 s30, 400000
  s_cbranch_scc1 cB_va0_sl1
  s_branch cB_abort
cB_va0_sl2:
  v_mov_b32 v36, 0
  v_mov_b32 v37, 0
  v_mov_b32 v38, 0
  v_mov_b32 v39, 0
  v_mov_b32 v40, 0
  v_mov_b32 v41, 0
  v_mov_b32 v42, 0
  v_mov_b32 v43, 0
  v_mov_b32 v44, 0
  v_mov_b32 v45, 0
  v_mov_b32 v46, 0
  v_mov_b32 v47, 0
  v_mov_b32 v48, 0
  v_mov_b32 v49, 0
  v_mov_b32 v50, 0
  v_mov_b32 v51, 0
  v_mov_b32 v52, 0
  v_mov_b32 v53, 0
  v_mov_b32 v54, 0
  v_mov_b32 v55, 0
  v_mov_b32 v56, 0
  v_mov_b32 v57, 0
  v_mov_b32 v58, 0
  v_mov_b32 v59, 0
  v_mov_b32 v60, 0
  v_mov_b32 v61, 0
  v_mov_b32 v62, 0
  v_mov_b32 v63, 0
  buffer_store_dword v162, v1, s[8:11], s21 offen sc1
  v_smfmac_f32_16x16x64_bf16 v[36:39], v[8:11], a[0:7], v3
  v_smfmac_f32_16x16x64_bf16 v[40:43], v[8:11], a[56:63], v3
  v_smfmac_f32_16x16x64_bf16 v[44:47], v[8:11], a[112:119], v3
  v_smfmac_f32_16x16x64_bf16 v[48:51], v[8:11], a[168:175], v3
  v_smfmac_f32_16x16x64_bf16 v[52:55], v[8:11], a[224:231], v3
  v_smfmac_f32_16x16x64_bf16 v[56:59], v[8:11], v[200:207], v3
  v_smfmac_f32_16x16x64_bf16 v[36:39], v[12:15], a[8:15], v3
  v_smfmac_f32_16x16x64_bf16 v[40:43], v[12:15], a[64:71], v3
  v_smfmac_f32_16x16x64_bf16 v[44:47], v[12:15], a[120:127], v3
  v_smfmac_f32_16x16x64_bf16 v[48:51], v[12:15], a[176:183], v3
  v_smfmac_f32_16x16x64_bf16 v[52:55], v[12:15], a[232:239], v3
  v_smfmac_f32_16x16x64_bf16 v[56:59], v[12:15], v[208:215], v3
  v_smfmac_f32_16x16x64_bf16 v[36:39], v[16:19], a[16:23], v3
  v_smfmac_f32_16x16x64_bf16 v[40:43], v[16:19], a[72:79], v3
  v_smfmac_f32_16x16x64_bf16 v[44:47], v[16:19], a[128:135], v3
  v_smfmac_f32_16x16x64_bf16 v[48:51], v[16:19], a[184:191], v3
  v_smfmac_f32_16x16x64_bf16 v[52:55], v[16:19], a[240:247], v3
  v_smfmac_f32_16x16x64_bf16 v[56:59], v[16:19], v[216:223], v3
  v_smfmac_f32_16x16x64_bf16 v[36:39], v[20:23], a[24:31], v3
  v_smfmac_f32_16x16x64_bf16 v[40:43], v[20:23], a[80:87], v3
  v_smfmac_f32_16x16x64_bf16 v[44:47], v[20:23], a[136:143], v3
  v_smfmac_f32_16x16x64_bf16 v[48:51], v[20:23], a[192:199], v3
  v_smfmac_f32_16x16x64_bf16 v[52:55], v[20:23], a[248:255], v3
  v_smfmac_f32_16x16x64_bf16 v[56:59], v[20:23], v[224:231], v3
  v_smfmac_f32_16x16x64_bf16 v[36:39], v[24:27], a[32:39], v3
  v_smfmac_f32_16x16x64_bf16 v[40:43], v[24:27], a[88:95], v3
  v_smfmac_f32_16x16x64_bf16 v[44:47], v[24:27], a[144:151], v3
  v_smfmac_f32_16x16x64_bf16 v[48:51], v[24:27], a[200:207], v3
  v_smfmac_f32_16x16x64_bf16 v[52:55], v[24:27], v[176:183], v3
  v_smfmac_f32_16x16x64_bf16 v[56:59], v[24:27], v[232:239], v3
  v_smfmac_f32_16x16x64_bf16 v[36:39], v[28:31], a[40:47], v3
  v_smfmac_f32_16x16x64_bf16 v[40:43], v[28:31], a[96:103], v3
  v_smfmac_f32_16x16x64_bf16 v[44:47], v[28:31], a[152:159], v3
  v_smfmac_f32_16x16x64_bf16 v[48:51], v[28:31], a[208:215], v3
  v_smfmac_f32_16x16x64_bf16 v[52:55], v[28:31], v[184:191], v3
  v_smfmac_f32_16x16x64_bf16 v[56:59], v[28:31], v[240:247], v3
  v_smfmac_f32_16x16x64_bf16 v[36:39], v[32:35], a[48:55], v3
  v_smfmac_f32_16x16x64_bf16 v[40:43], v[32:35], a[104:111], v3
  v_smfmac_f32_16x16x64_bf16 v[44:47], v[32:35], a[160:167], v3
  v_smfmac_f32_16x16x64_bf16 v[48:51], v[32:35], a[216:223], v3
  v_smfmac_f32_16x16x64_bf16 v[52:55], v[32:35], v[192:199], v3
  v_smfmac_f32_16x16x64_bf16 v[56:59], v[32:35], v[248:255], v3
  v_permlane32_swap_b32 v36, v38
  v_permlane32_swap_b32 v37, v39
  v_add_f32 v36, v36, v38
  v_add_f32 v37, v37, v39
  v_cvt_pk_bf16_f32 v38, v36, v37
  ds_write_b32 v152, v38
  v_permlane32_swap_b32 v40, v42
  v_permlane32_swap_b32 v41, v43
  v_add_f32 v40, v40, v42
  v_add_f32 v41, v41, v43
  v_cvt_pk_bf16_f32 v42, v40, v41
  ds_write_b32 v153, v42
  v_permlane32_swap_b32 v44, v46
  v_permlane32_swap_b32 v45, v47
  v_add_f32 v44, v44, v46
  v_add_f32 v45, v45, v47
  v_cvt_pk_bf16_f32 v46, v44, v45
  ds_write_b32 v154, v46
  v_permlane32_swap_b32 v48, v50
  v_permlane32_swap_b32 v49, v51
  v_add_f32 v48, v48, v50
  v_add_f32 v49, v49, v51
  v_cvt_pk_bf16_f32 v50, v48, v49
  ds_write_b32 v155, v50
  v_permlane32_swap_b32 v52, v54
  v_permlane32_swap_b32 v53, v55
  v_add_f32 v52, v52, v54
  v_add_f32 v53, v53, v55
  v_cvt_pk_bf16_f32 v54, v52, v53
  ds_write_b32 v156, v54
  v_permlane32_swap_b32 v56, v58
  v_permlane32_swap_b32 v57, v59
  v_add_f32 v56, v56, v58
  v_add_f32 v57, v57, v59
  v_cvt_pk_bf16_f32 v58, v56, v57
  ds_write_b32 v157, v58
  buffer_load_dword v164, v4, s[8:11], 0 offen sc1
  buffer_load_dword v164, v4, s[8:11], 0 offen sc1
  buffer_load_dword v164, v4, s[8:11], 0 offen sc1
  buffer_load_dword v164, v4, s[8:11], 0 offen sc1
  buffer_load_dword v164, v4, s[8:11], 0 offen sc1
  s_branch cB_va0_t2d
cB_va0_last:
  s_barrier
  ds_read_b128 v[64:67], v2 offset:0
  ds_read_b128 v[68:71], v2 offset:1024
  ds_read_b128 v[72:75], v2 offset:2048
  ds_read_b128 v[76:79], v2 offset:3072
  s_waitcnt lgkmcnt(0)
  v_min_u32 v64, -2, v64
  v_min_u32 v65, -2, v65
  v_min_u32 v66, -2, v66
  v_min_u32 v67, -2, v67
  v_min_u32 v68, -2, v68
  v_min_u32 v69, -2, v69
  v_min_u32 v70, -2, v70
  v_min_u32 v71, -2, v71
  v_min_u32 v72, -2, v72
  v_min_u32 v73, -2, v73
  v_min_u32 v74, -2, v74
  v_min_u32 v75, -2, v75
  v_min_u32 v76, -2, v76
  v_min_u32 v77, -2, v77
  v_min_u32 v78, -2, v78
  v_min_u32 v79, -2, v79
  buffer_store_dwordx4 v[64:67], v2, s[8:11], s33 offen offset:0 sc1
  buffer_store_dwordx4 v[68:71], v2, s[8:11], s33 offen offset:2048 sc1
  s_add_u32 s33, s33, 4096
  buffer_store_dwordx4 v[72:75], v2, s[8:11], s33 offen offset:0 sc1
  buffer_store_dwordx4 v[76:79], v2, s[8:11], s33 offen offset:2048 sc1
  s_add_u32 s33, s33, 4096
  s_waitcnt vmcnt(0)
  buffer_wbl2 sc1
  s_branch cB_done
cB_va0_rp:
  s_cmp_eq_u32 s37, 0
  s_cbranch_scc1 cB_va0_rv
  v_min_u32 v160, -2, v160
  buffer_store_dword v160, v1, s[8:11], s21 offen sc1
  s_branch cB_va0_cont
cB_va0_rv:
  s_add_u32 s31, s31, 0x10000
  buffer_load_dwordx4 v[8:11], v2, s[8:11], s22 offen offset:0 sc1
  buffer_load_dwordx4 v[12:15], v2, s[8:11], s22 offen offset:1024 sc1
  buffer_load_dwordx4 v[16:19], v2, s[8:11], s22 offen offset:2048 sc1
  buffer_load_dwordx4 v[20:23], v2, s[8:11], s22 offen offset:3072 sc1
  buffer_load_dwordx4 v[24:27], v2, s[8:11], s34 offen offset:0 sc1
  buffer_load_dwordx4 v[28:31], v2, s[8:11], s34 offen offset:1024 sc1
  buffer_load_dwordx4 v[32:35], v2, s[8:11], s34 offen offset:2048 sc1
  buffer_load_dwordx4 v[36:39], v2, s[8:11], s34 offen offset:3072 sc1
  buffer_load_dwordx4 v[40:43], v2, s[8:11], s36 offen offset:0 sc1
  buffer_load_dwordx4 v[44:47], v2, s[8:11], s36 offen offset:1024 sc1
  s_waitcnt vmcnt(0)
  v_max3_u32 v52, v8, v9, v10
  v_max3_u32 v52, v52, v11, v12
  v_max3_u32 v52, v52, v13, v14
  v_max3_u32 v52, v52, v15, v16
  v_max3_u32 v52, v52, v17, v18
  v_max3_u32 v52, v52, v19, v20
  v_max3_u32 v52, v52, v21, v22
  v_max3_u32 v52, v52, v23, v24
  v_max3_u32 v52, v52, v25, v26
  v_max3_u32 v52, v52, v27, v28
  v_max3_u32 v52, v52, v29, v30
  v_max3_u32 v52, v52, v31, v32
  v_max3_u32 v52, v52, v33, v34
  v_max3_u32 v52, v52, v35, v36
  v_max3_u32 v52, v52, v37, v38
  v_max3_u32 v52, v52, v39, v40
  v_max3_u32 v52, v52, v41, v42
  v_max3_u32 v52, v52, v43, v44
  v_max3_u32 v52, v52, v45, v46
  v_max_u32 v52, v52, v47
  v_cmp_eq_u32 vcc, -1, v52
  s_mov_b32 s37, 1
  v_mov_b32 v48, 0
  v_mov_b32 v49, 0
  v_mov_b32 v50, 0
  v_mov_b32 v51, 0
  s_nop 1
  s_cbranch_vccz cB_va0_lp
  s_add_u32 s30, s30, 1
  s_cmp_lt_u32 s30, 400000
  s_cbranch_scc1 cB_va0_rv
  s_branch cB_abort
.p2align 6
cB_va1_loop:
  s_mov_b32 s30, 0
  s_barrier
  buffer_load_dwordx4 v[28:31], v2, s[8:11], s23 offen offset:1024 sc1
  buffer_load_dwordx4 v[32:35], v2, s[8:11], s23 offen offset:2048 sc1
  s_barrier
  s_cmp_lt_u32 s19, 60
  s_cbranch_scc1 cB_va1_m1
  buffer_store_dword v160, v1, s[8:11], s38 offen sc1
  s_cmp_lg_u32 s19, 63
  s_cbranch_scc1 cB_va1_m2
  v_min_u32 v64, -2, v64
  v_min_u32 v65, -2, v65
  v_min_u32 v66, -2, v66
  v_min_u32 v67, -2, v67
  v_min_u32 v68, -2, v68
  v_min_u32 v69, -2, v69
  v_min_u32 v70, -2, v70
  v_min_u32 v71, -2, v71
  v_min_u32 v72, -2, v72
  v_min_u32 v73, -2, v73
  v_min_u32 v74, -2, v74
  v_min_u32 v75, -2, v75
  v_min_u32 v76, -2, v76
  v_min_u32 v77, -2, v77
  v_min_u32 v78, -2, v78
  v_min_u32 v79, -2, v79
  buffer_store_dwordx4 v[64:67], v2, s[8:11], s33 offen offset:0 sc1
  buffer_store_dwordx4 v[68:71], v2, s[8:11], s33 offen offset:2048 sc1
  s_add_u32 s33, s33, 4096
  buffer_store_dwordx4 v[72:75], v2, s[8:11], s33 offen offset:0 sc1
  buffer_store_dwordx4 v[76:79], v2, s[8:11], s33 offen offset:2048 sc1
  s_add_u32 s33, s33, 4096
  s_waitcnt vmcnt(5)
  s_branch cB_va1_m3
cB_va1_m1:
  buffer_store_dword v160, v1, s[8:11], s38 offen sc1
cB_va1_m2:
  s_add_u32 s22, s25, 0
  buffer_load_dwordx4 v[80:83], v6, s[8:11], s22 offen offset:0 sc1
  buffer_load_dwordx4 v[84:87], v6, s[8:11], s22 offen offset:1792 sc1
  s_add_u32 s22, s25, 3584
  buffer_load_dwordx4 v[88:91], v6, s[8:11], s22 offen offset:0 sc1
  buffer_load_dwordx4 v[92:95], v6, s[8:11], s22 offen offset:1792 sc1
  s_add_u32 s22, s25, 7168
  buffer_load_dwordx4 v[96:99], v6, s[8:11], s22 offen offset:0 sc1
  s_mul_i32 s38, s18, 7168
  s_add_u32 s38, s38, 65536
  s_waitcnt vmcnt(6)
cB_va1_m3:
  ds_write_b128 v2, v[32:35] offset:14336
  v_smfmac_f32_16x16x64_bf16 v[36:39], v[28:31], a[40:47], v3
  buffer_load_dwordx4 v[100:103], v6, s[8:11], s22 offen offset:1792 sc1
  v_smfmac_f32_16x16x64_bf16 v[40:43], v[28:31], a[96:103], v3
  s_add_u32 s22, s25, 10752
  buffer_load_dwordx4 v[104:107], v6, s[8:11], s22 offen offset:0 sc1
  v_smfmac_f32_16x16x64_bf16 v[44:47], v[28:31], a[152:159], v3
  buffer_load_dwordx4 v[108:111], v6, s[8:11], s22 offen offset:1792 sc1
  v_smfmac_f32_16x16x64_bf16 v[48:51], v[28:31], a[208:215], v3
  s_add_u32 s22, s25, 14336
  buffer_load_dwordx4 v[112:115], v6, s[8:11], s22 offen offset:0 sc1
  v_smfmac_f32_16x16x64_bf16 v[52:55], v[28:31], v[184:191], v3
  s_waitcnt lgkmcnt(0)
  s_barrier
  ds_read_b128 v[8:11], v2 offset:8192
  ds_read_b128 v[12:15], v2 offset:9216
  ds_read_b128 v[16:19], v2 offset:10240
  ds_read_b128 v[20:23], v2 offset:11264
  ds_read_b128 v[24:27], v2 offset:12288
  buffer_load_dwordx4 v[116:119], v6, s[8:11], s22 offen offset:1792 sc1
  v_smfmac_f32_16x16x64_bf16 v[56:59], v[28:31], v[240:247], v3
  s_add_u32 s22, s25, 17920
  buffer_load_dwordx4 v[120:123], v6, s[8:11], s22 offen offset:0 sc1
  v_smfmac_f32_16x16x64_bf16 v[36:39], v[32:35], a[48:55], v3
  buffer_load_dwordx4 v[124:127], v6, s[8:11], s22 offen offset:1792 sc1
  v_smfmac_f32_16x16x64_bf16 v[40:43], v[32:35], a[104:111], v3
  s_add_u32 s22, s25, 21504
  buffer_load_dwordx4 v[128:131], v6, s[8:11], s22 offen offset:0 sc1
  v_smfmac_f32_16x16x64_bf16 v[44:47], v[32:35], a[160:167], v3
  buffer_load_dwordx4 v[132:135], v6, s[8:11], s22 offen offset:1792 sc1
  v_smfmac_f32_16x16x64_bf16 v[48:51], v[32:35], a[216:223], v3
  s_add_u32 s22, s25, 25088
  buffer_load_dwordx4 v[136:139], v6, s[8:11], s22 offen offset:0 sc1
  v_smfmac_f32_16x16x64_bf16 v[52:55], v[32:35], v[192:199], v3
  ds_read_b128 v[64:67], v0 offset:0
  ds_read_b128 v[68:71], v0 offset:1024
  buffer_load_dwordx4 v[140:143], v6, s[8:11], s22 offen offset:1792 sc1
  v_smfmac_f32_16x16x64_bf16 v[56:59], v[32:35], v[248:255], v3
  s_waitcnt lgkmcnt(6)
  ds_read_b128 v[72:75], v0 offset:2048
  ds_read_b128 v[76:79], v0 offset:3072
  v_smfmac_f32_16x16x64_bf16 v[36:39], v[8:11], a[0:7], v3
  s_waitcnt lgkmcnt(7)
  v_smfmac_f32_16x16x64_bf16 v[36:39], v[12:15], a[8:15], v3
  s_waitcnt lgkmcnt(6)
  v_smfmac_f32_16x16x64_bf16 v[36:39], v[16:19], a[16:23], v3
  s_waitcnt lgkmcnt(2)
  v_smfmac_f32_16x16x64_bf16 v[60:63], v[8:11], v[64:71], v3
  s_waitcnt lgkmcnt(5)
  ds_read_b128 v[144:147], v0 offset:4096
  ds_read_b128 v[148:151], v0 offset:5120
  v_smfmac_f32_16x16x64_bf16 v[36:39], v[20:23], a[24:31], v3
  s_waitcnt lgkmcnt(6)
  v_smfmac_f32_16x16x64_bf16 v[36:39], v[24:27], a[32:39], v3
  v_smfmac_f32_16x16x64_bf16 v[40:43], v[8:11], a[56:63], v3
  s_waitcnt lgkmcnt(2)
  v_smfmac_f32_16x16x64_bf16 v[60:63], v[12:15], v[72:79], v3
  ds_read_b128 v[64:67], v0 offset:6144
  ds_read_b128 v[68:71], v0 offset:7168
  v_smfmac_f32_16x16x64_bf16 v[40:43], v[12:15], a[64:71], v3
  v_permlane32_swap_b32 v36, v38
  v_smfmac_f32_16x16x64_bf16 v[40:43], v[16:19], a[72:79], v3
  v_permlane32_swap_b32 v37, v39
  v_smfmac_f32_16x16x64_bf16 v[40:43], v[20:23], a[80:87], v3
  s_waitcnt lgkmcnt(2)
  v_add_f32 v36, v36, v38
  v_smfmac_f32_16x16x64_bf16 v[60:63], v[16:19], v[144:151], v3
  ds_read_b128 v[72:75], v0 offset:8192
  ds_read_b128 v[76:79], v0 offset:9216
  v_add_f32 v37, v37, v39
  v_smfmac_f32_16x16x64_bf16 v[40:43], v[24:27], a[88:95], v3
  v_cmp_u_f32 vcc, v36, v37
  v_smfmac_f32_16x16x64_bf16 v[44:47], v[8:11], a[112:119], v3
  v_cvt_pk_bf16_f32 v38, v36, v37
  v_smfmac_f32_16x16x64_bf16 v[44:47], v[12:15], a[120:127], v3
  ds_write_b32 v152, v38
  s_waitcnt lgkmcnt(3)
  s_cbranch_vccnz cB_va1_slow
  v_permlane32_swap_b32 v40, v42
  v_smfmac_f32_16x16x64_bf16 v[60:63], v[20:23], v[64:71], v3
  ds_read_b128 v[144:147], v0 offset:10240
  ds_read_b128 v[148:151], v0 offset:11264
  v_permlane32_swap_b32 v41, v43
  v_smfmac_f32_16x16x64_bf16 v[44:47], v[16:19], a[128:135], v3
  buffer_store_dword v162, v1, s[8:11], s21 offen sc1
  v_add_f32 v40, v40, v42
  v_smfmac_f32_16x16x64_bf16 v[44:47], v[20:23], a[136:143], v3
  v_add_f32 v41, v41, v43
  v_smfmac_f32_16x16x64_bf16 v[44:47], v[24:27], a[144:151], v3
  s_waitcnt lgkmcnt(3)
  v_cvt_pk_bf16_f32 v42, v40, v41
  v_smfmac_f32_16x16x64_bf16 v[60:63], v[24:27], v[72:79], v3
  ds_write_b32 v153, v42
  ds_read_b128 v[64:67], v0 offset:12288
  ds_read_b128 v[68:71], v0 offset:13312
  v_smfmac_f32_16x16x64_bf16 v[48:51], v[8:11], a[168:175], v3
  s_nop 0
  v_permlane32_swap_b32 v44, v46
  v_smfmac_f32_16x16x64_bf16 v[48:51], v[12:15], a[176:183], v3
  v_permlane32_swap_b32 v45, v47
  v_smfmac_f32_16x16x64_bf16 v[48:51], v[16:19], a[184:191], v3
  s_waitcnt lgkmcnt(3)
  v_add_f32 v44, v44, v46
  v_smfmac_f32_16x16x64_bf16 v[60:63], v[28:31], v[144:151], v3
  v_add_f32 v45, v45, v47
  v_smfmac_f32_16x16x64_bf16 v[48:51], v[20:23], a[192:199], v3
  v_cvt_pk_bf16_f32 v46, v44, v45
  v_smfmac_f32_16x16x64_bf16 v[48:51], v[24:27], a[200:207], v3
  ds_write_b32 v154, v46
  v_smfmac_f32_16x16x64_bf16 v[52:55], v[8:11], a[224:231], v3
  s_waitcnt lgkmcnt(1)
  v_smfmac_f32_16x16x64_bf16 v[60:63], v[32:35], v[64:71], v3
  v_smfmac_f32_16x16x64_bf16 v[52:55], v[12:15], a[232:239], v3
  v_permlane32_swap_b32 v48, v50
  v_smfmac_f32_16x16x64_bf16 v[52:55], v[16:19], a[240:247], v3
  v_permlane32_swap_b32 v49, v51
  v_smfmac_f32_16x16x64_bf16 v[52:55], v[20:23], a[248:255], v3
  v_add_f32 v48, v48, v50
  v_smfmac_f32_16x16x64_bf16 v[52:55], v[24:27], v[176:183], v3
  v_add_f32 v49, v49, v51
  v_smfmac_f32_16x16x64_bf16 v[56:59], v[8:11], v[200:207], v3
  v_cvt_pk_bf16_f32 v50, v48, v49
  v_smfmac_f32_16x16x64_bf16 v[56:59], v[12:15], v[208:215], v3
  ds_write_b32 v155, v50
  v_permlane32_swap_b32 v60, v62
  v_smfmac_f32_16x16x64_bf16 v[56:59], v[16:19], v[216:223], v3
  v_permlane32_swap_b32 v61, v63
  v_smfmac_f32_16x16x64_bf16 v[56:59], v[20:23], v[224:231], v3
  v_add_f32 v60, v60, v62
  v_smfmac_f32_16x16x64_bf16 v[56:59], v[24:27], v[232:239], v3
  v_add_f32 v61, v61, v63
  v_cvt_pk_bf16_f32 v62, v60, v61
  ds_write_b32 v158, v62
  v_permlane32_swap_b32 v52, v54
  v_permlane32_swap_b32 v53, v55
  v_add_f32 v52, v52, v54
  v_add_f32 v53, v53, v55
  v_cvt_pk_bf16_f32 v54, v52, v53
  ds_write_b32 v156, v54
  v_permlane32_swap_b32 v56, v58
  v_permlane32_swap_b32 v57, v59
  v_add_f32 v56, v56, v58
  v_add_f32 v57, v57, v59
  v_cvt_pk_bf16_f32 v58, v56, v57
  ds_write_b32 v157, v58
cB_va1_t2d:
  s_add_u32 s22, s20, 9216
  s_add_u32 s34, s20, 13312
  s_add_u32 s36, s20, 7168
  s_mov_b32 s37, 0
  v_mov_b32 v48, 0
  v_mov_b32 v49, 0
  v_mov_b32 v50, 0
  v_mov_b32 v51, 0
  v_mov_b32 v163, s18
  s_cmp_eq_u32 s19, 63
  s_waitcnt lgkmcnt(0)
  s_cbranch_scc1 cB_va1_last
  s_barrier
  buffer_load_dwordx4 v[8:11], v2, s[8:11], s22 offen offset:0 sc1
  buffer_load_dwordx4 v[12:15], v2, s[8:11], s22 offen offset:1024 sc1
  buffer_load_dwordx4 v[16:19], v2, s[8:11], s22 offen offset:2048 sc1
  buffer_load_dwordx4 v[20:23], v2, s[8:11], s22 offen offset:3072 sc1
  buffer_load_dwordx4 v[24:27], v2, s[8:11], s34 offen offset:0 sc1
  buffer_load_dwordx4 v[28:31], v2, s[8:11], s34 offen offset:1024 sc1
  buffer_load_dwordx4 v[32:35], v2, s[8:11], s34 offen offset:2048 sc1
  buffer_load_dwordx4 v[36:39], v2, s[8:11], s34 offen offset:3072 sc1
  buffer_load_dwordx4 v[40:43], v2, s[8:11], s36 offen offset:0 sc1
  buffer_load_dwordx4 v[44:47], v2, s[8:11], s36 offen offset:1024 sc1
  ds_read_b128 v[64:67], v2 offset:4096
  ds_read_b128 v[68:71], v2 offset:5120
  ds_read_b128 v[72:75], v2 offset:6144
  ds_read_b128 v[76:79], v2 offset:7168
cB_va1_lp:
  s_waitcnt vmcnt(9)
  v_smfmac_f32_16x16x64_bf16 v[48:51], v[8:11], v[80:87], v3
  s_waitcnt vmcnt(8)
  v_smfmac_f32_16x16x64_bf16 v[48:51], v[12:15], v[88:95], v3
  s_waitcnt vmcnt(7)
  v_smfmac_f32_16x16x64_bf16 v[48:51], v[16:19], v[96:103], v3
  v_max3_u32 v55, v8, v12, v16
  s_waitcnt vmcnt(6)
  v_smfmac_f32_16x16x64_bf16 v[48:51], v[20:23], v[104:111], v3
  v_max_u32 v55, v55, v20
  v_cmp_eq_u32 vcc, -1, v55
  s_waitcnt vmcnt(5)
  v_smfmac_f32_16x16x64_bf16 v[48:51], v[24:27], v[112:119], v3
  s_waitcnt vmcnt(4)
  v_smfmac_f32_16x16x64_bf16 v[48:51], v[28:31], v[120:127], v3
  s_cbranch_vccnz cB_va1_rv
  buffer_store_dword v163, v7, s[8:11], 0 offen sc1
  s_waitcnt vmcnt(4)
  v_smfmac_f32_16x16x64_bf16 v[48:51], v[32:35], v[128:135], v3
  s_waitcnt vmcnt(3)
  v_smfmac_f32_16x16x64_bf16 v[48:51], v[36:39], v[136:143], v3
  s_waitcnt vmcnt(2) lgkmcnt(0)
  v_smfmac_f32_16x16x64_bf16 v[48:51], v[40:43], v[64:71], v3
  s_waitcnt vmcnt(1)
  v_smfmac_f32_16x16x64_bf16 v[48:51], v[44:47], v[72:79], v3
  s_nop 7
  v_permlane32_swap_b32 v48, v50
  v_permlane32_swap_b32 v49, v51
  v_pk_add_f32 v[48:49], v[48:49], v[50:51]
  v_cvt_pk_bf16_f32 v160, v48, v49
  v_cmp_u_f32 vcc, v48, v49
  s_nop 0
  v_mov_b32_dpp v161, v160 quad_perm:[1,0,3,2] row_mask:0xf bank_mask:0xf
  v_perm_b32 v160, v161, v160, v5
  v_cndmask_b32 v161, v160, v162, vcc
  buffer_store_dword v161, v1, s[8:11], s21 offen sc1
  s_cbranch_vccnz cB_va1_rp
cB_va1_cont:
  s_cmp_lg_u32 s19, 62
  s_cbranch_scc1 cB_va1_nl
  buffer_store_dword v160, v1, s[8:11], s38 offen sc1
  s_mov_b32 s38, 0x40000000
  s_mov_b32 s25, 0x40000000
cB_va1_nl:
  s_add_u32 s25, s25, 458752
  v_mov_b32 v36, 0
  v_mov_b32 v37, 0
  v_mov_b32 v38, 0
  v_mov_b32 v39, 0
  v_mov_b32 v40, 0
  v_mov_b32 v41, 0
  v_mov_b32 v42, 0
  v_mov_b32 v43, 0
  v_mov_b32 v44, 0
  v_mov_b32 v45, 0
  v_mov_b32 v46, 0
  v_mov_b32 v47, 0
  v_mov_b32 v48, 0
  v_mov_b32 v49, 0
  v_mov_b32 v50, 0
  v_mov_b32 v51, 0
  v_mov_b32 v52, 0
  v_mov_b32 v53, 0
  v_mov_b32 v54, 0
  v_mov_b32 v55, 0
  v_mov_b32 v56, 0
  v_mov_b32 v57, 0
  v_mov_b32 v58, 0
  v_mov_b32 v59, 0
  v_mov_b32 v60, 0
  v_mov_b32 v61, 0
  v_mov_b32 v62, 0
  v_mov_b32 v63, 0
  s_mov_b32 s19, s18
  s_add_u32 s18, s18, 1
  s_mov_b32 s22, s20
  s_mov_b32 s20, s21
  s_mov_b32 s21, s22
  s_add_u32 s23, s20, 4096
  s_branch cB_va1_loop
cB_va1_slow:
  s_waitcnt lgkmcnt(0)
cB_va1_sl1:
  s_add_u32 s31, s31, 0x1000000
  buffer_load_dwordx4 v[8:11], v2, s[8:11], s20 offen offset:0 sc1
  buffer_load_dwordx4 v[12:15], v2, s[8:11], s20 offen offset:1024 sc1
  buffer_load_dwordx4 v[16:19], v2, s[8:11], s20 offen offset:2048 sc1
  buffer_load_dwordx4 v[20:23], v2, s[8:11], s20 offen offset:3072 sc1
  buffer_load_dwordx4 v[24:27], v2, s[8:11], s23 offen offset:0 sc1
  buffer_load_dwordx4 v[28:31], v2, s[8:11], s23 offen offset:1024 sc1
  buffer_load_dwordx4 v[32:35], v2, s[8:11], s23 offen offset:2048 sc1
  s_waitcnt vmcnt(0)
  v_max3_u32 v36, v8, v9, v10
  v_max3_u32 v36, v36, v11, v12
  v_max3_u32 v36, v36, v13, v14
  v_max3_u32 v36, v36, v15, v16
  v_max3_u32 v36, v36, v17, v18
  v_max3_u32 v36, v36, v19, v20
  v_max3_u32 v36, v36, v21, v22
  v_max3_u32 v36, v36, v23, v24
  v_max3_u32 v36, v36, v25, v26
  v_max3_u32 v36, v36, v27, v28
  v_max3_u32 v36, v36, v29, v30
  v_max3_u32 v36, v36, v31, v32
  v_max3_u32 v36, v36, v33, v34
  v_max_u32 v36, v36, v35
  v_cmp_eq_u32 vcc, -1, v36
  s_cbranch_vccz cB_va1_sl2
  s_add_u32 s30, s30, 1
  s_cmp_lt_u32 s30, 400000
  s_cbranch_scc1 cB_va1_sl1
  s_branch cB_abort
cB_va1_sl2:
  v_mov_b32 v36, 0
  v_mov_b32 v37, 0
  v_mov_b32 v38, 0
  v_mov_b32 v39, 0
  v_mov_b32 v40, 0
  v_mov_b32 v41, 0
  v_mov_b32 v42, 0
  v_mov_b32 v43, 0
  v_mov_b32 v44, 0
  v_mov_b32 v45, 0
  v_mov_b32 v46, 0
  v_mov_b32 v47, 0
  v_mov_b32 v48, 0
  v_mov_b32 v49, 0
  v_mov_b32 v50, 0
  v_mov_b32 v51, 0
  v_mov_b32 v52, 0
  v_mov_b32 v53, 0
  v_mov_b32 v54, 0
  v_mov_b32 v55, 0
  v_mov_b32 v56, 0
  v_mov_b32 v57, 0
  v_mov_b32 v58, 0
  v_mov_b32 v59, 0
  v_mov_b32 v60, 0
  v_mov_b32 v61, 0
  v_mov_b32 v62, 0
  v_mov_b32 v63, 0
  buffer_store_dword v162, v1, s[8:11], s21 offen sc1
  ds_read_b128 v[64:67], v0 offset:0
  ds_read_b128 v[68:71], v0 offset:1024
  v_smfmac_f32_16x16x64_bf16 v[36:39], v[8:11], a[0:7], v3
  v_smfmac_f32_16x16x64_bf16 v[40:43], v[8:11], a[56:63], v3
  v_smfmac_f32_16x16x64_bf16 v[44:47], v[8:11], a[112:119], v3
  v_smfmac_f32_16x16x64_bf16 v[48:51], v[8:11], a[168:175], v3
  v_smfmac_f32_16x16x64_bf16 v[52:55], v[8:11], a[224:231], v3
  v_smfmac_f32_16x16x64_bf16 v[56:59], v[8:11], v[200:207], v3
  s_waitcnt lgkmcnt(0)
  v_smfmac_f32_16x16x64_bf16 v[60:63], v[8:11], v[64:71], v3
  ds_read_b128 v[72:75], v0 offset:2048
  ds_read_b128 v[76:79], v0 offset:3072
  v_smfmac_f32_16x16x64_bf16 v[36:39], v[12:15], a[8:15], v3
  v_smfmac_f32_16x16x64_bf16 v[40:43], v[12:15], a[64:71], v3
  v_smfmac_f32_16x16x64_bf16 v[44:47], v[12:15], a[120:127], v3
  v_smfmac_f32_16x16x64_bf16 v[48:51], v[12:15], a[176:183], v3
  v_smfmac_f32_16x16x64_bf16 v[52:55], v[12:15], a[232:239], v3
  v_smfmac_f32_16x16x64_bf16 v[56:59], v[12:15], v[208:215], v3
  s_waitcnt lgkmcnt(0)
  v_smfmac_f32_16x16x64_bf16 v[60:63], v[12:15], v[72:79], v3
  ds_read_b128 v[144:147], v0 offset:4096
  ds_read_b128 v[148:151], v0 offset:5120
  v_smfmac_f32_16x16x64_bf16 v[36:39], v[16:19], a[16:23], v3
  v_smfmac_f32_16x16x64_bf16 v[40:43], v[16:19], a[72:79], v3
  v_smfmac_f32_16x16x64_bf16 v[44:47], v[16:19], a[128:135], v3
  v_smfmac_f32_16x16x64_bf16 v[48:51], v[16:19], a[184:191], v3
  v_smfmac_f32_16x16x64_bf16 v[52:55], v[16:19], a[240:247], v3
  v_smfmac_f32_16x16x64_bf16 v[56:59], v[16:19], v[216:223], v3
  s_waitcnt lgkmcnt(0)
  v_smfmac_f32_16x16x64_bf16 v[60:63], v[16:19], v[144:151], v3
  ds_read_b128 v[64:67], v0 offset:6144
  ds_read_b128 v[68:71], v0 offset:7168
  v_smfmac_f32_16x16x64_bf16 v[36:39], v[20:23], a[24:31], v3
  v_smfmac_f32_16x16x64_bf16 v[40:43], v[20:23], a[80:87], v3
  v_smfmac_f32_16x16x64_bf16 v[44:47], v[20:23], a[136:143], v3
  v_smfmac_f32_16x16x64_bf16 v[48:51], v[20:23], a[192:199], v3
  v_smfmac_f32_16x16x64_bf16 v[52:55], v[20:23], a[248:255], v3
  v_smfmac_f32_16x16x64_bf16 v[56:59], v[20:23], v[224:231], v3
  s_waitcnt lgkmcnt(0)
  v_smfmac_f32_16x16x64_bf16 v[60:63], v[20:23], v[64:71], v3
  ds_read_b128 v[72:75], v0 offset:8192
  ds_read_b128 v[76:79], v0 offset:9216
  v_smfmac_f32_16x16x64_bf16 v[36:39], v[24:27], a[32:39], v3
  v_smfmac_f32_16x16x64_bf16 v[40:43], v[24:27], a[88:95], v3
  v_smfmac_f32_16x16x64_bf16 v[44:47], v[24:27], a[144:151], v3
  v_smfmac_f32_16x16x64_bf16 v[48:51], v[24:27], a[200:207], v3
  v_smfmac_f32_16x16x64_bf16 v[52:55], v[24:27], v[176:183], v3
  v_smfmac_f32_16x16x64_bf16 v[56:59], v[24:27], v[232:239], v3
  s_waitcnt lgkmcnt(0)
  v_smfmac_f32_16x16x64_bf16 v[60:63], v[24:27], v[72:79], v3
  ds_read_b128 v[144:147], v0 offset:10240
  ds_read_b128 v[148:151], v0 offset:11264
  v_smfmac_f32_16x16x64_bf16 v[36:39], v[28:31], a[40:47], v3
  v_smfmac_f32_16x16x64_bf16 v[40:43], v[28:31], a[96:103], v3
  v_smfmac_f32_16x16x64_bf16 v[44:47], v[28:31], a[152:159], v3
  v_smfmac_f32_16x16x64_bf16 v[48:51], v[28:31], a[208:215], v3
  v_smfmac_f32_16x16x64_bf16 v[52:55], v[28:31], v[184:191], v3
  v_smfmac_f32_16x16x64_bf16 v[56:59], v[28:31], v[240:247], v3
  s_waitcnt lgkmcnt(0)
  v_smfmac_f32_16x16x64_bf16 v[60:63], v[28:31], v[144:151], v3
  ds_read_b128 v[64:67], v0 offset:12288
  ds_read_b128 v[68:71], v0 offset:13312
  v_smfmac_f32_16x16x64_bf16 v[36:39], v[32:35], a[48:55], v3
  v_smfmac_f32_16x16x64_bf16 v[40:43], v[32:35], a[104:111], v3
  v_smfmac_f32_16x16x64_bf16 v[44:47], v[32:35], a[160:167], v3
  v_smfmac_f32_16x16x64_bf16 v[48:51], v[32:35], a[216:223], v3
  v_smfmac_f32_16x16x64_bf16 v[52:55], v[32:35], v[192:199], v3
  v_smfmac_f32_16x16x64_bf16 v[56:59], v[32:35], v[248:255], v3
  s_waitcnt lgkmcnt(0)
  v_smfmac_f32_16x16x64_bf16 v[60:63], v[32:35], v[64:71], v3
  v_permlane32_swap_b32 v36, v38
  v_permlane32_swap_b32 v37, v39
  v_add_f32 v36, v36, v38
  v_add_f32 v37, v37, v39
  v_cvt_pk_bf16_f32 v38, v36, v37
  ds_write_b32 v152, v38
  v_permlane32_swap_b32 v40, v42
  v_permlane32_swap_b32 v41, v43
  v_add_f32 v40, v40, v42
  v_add_f32 v41, v41, v43
  v_cvt_pk_bf16_f32 v42, v40, v41
  ds_write_b32 v153, v42
  v_permlane32_swap_b32 v44, v46
  v_permlane32_swap_b32 v45, v47
  v_add_f32 v44, v44, v46
  v_add_f32 v45, v45, v47
  v_cvt_pk_bf16_f32 v46, v44, v45
  ds_write_b32 v154, v46
  v_permlane32_swap_b32 v48, v50
  v_permlane32_swap_b32 v49, v51
  v_add_f32 v48, v48, v50
  v_add_f32 v49, v49, v51
  v_cvt_pk_bf16_f32 v50, v48, v49
  ds_write_b32 v155, v50
  v_permlane32_swap_b32 v52, v54
  v_permlane32_swap_b32 v53, v55
  v_add_f32 v52, v52, v54
  v_add_f32 v53, v53, v55
  v_cvt_pk_bf16_f32 v54, v52, v53
  ds_write_b32 v156, v54
  v_permlane32_swap_b32 v56, v58
  v_permlane32_swap_b32 v57, v59
  v_add_f32 v56, v56, v58
  v_add_f32 v57, v57, v59
  v_cvt_pk_bf16_f32 v58, v56, v57
  ds_write_b32 v157, v58
  v_permlane32_swap_b32 v60, v62
  v_permlane32_swap_b32 v61, v63
  v_add_f32 v60, v60, v62
  v_add_f32 v61, v61, v63
  v_cvt_pk_bf16_f32 v62, v60, v61
  ds_write_b32 v158, v62
  s_branch cB_va1_t2d
cB_va1_last:
  s_barrier
  ds_read_b128 v[64:67], v2 offset:4096
  ds_read_b128 v[68:71], v2 offset:5120
  ds_read_b128 v[72:75], v2 offset:6144
  ds_read_b128 v[76:79], v2 offset:7168
  s_waitcnt lgkmcnt(0)
  v_min_u32 v64, -2, v64
  v_min_u32 v65, -2, v65
  v_min_u32 v66, -2, v66
  v_min_u32 v67, -2, v67
  v_min_u32 v68, -2, v68
  v_min_u32 v69, -2, v69
  v_min_u32 v70, -2, v70
  v_min_u32 v71, -2, v71
  v_min_u32 v72, -2, v72
  v_min_u32 v73, -2, v73
  v_min_u32 v74, -2, v74
  v_min_u32 v75, -2, v75
  v_min_u32 v76, -2, v76
  v_min_u32 v77, -2, v77
  v_min_u32 v78, -2, v78
  v_min_u32 v79, -2, v79
  buffer_store_dwordx4 v[64:67], v2, s[8:11], s33 offen offset:0 sc1
  buffer_store_dwordx4 v[68:71], v2, s[8:11], s33 offen offset:2048 sc1
  s_add_u32 s33, s33, 4096
  buffer_store_dwordx4 v[72:75], v2, s[8:11], s33 offen offset:0 sc1
  buffer_store_dwordx4 v[76:79], v2, s[8:11], s33 offen offset:2048 sc1
  s_add_u32 s33, s33, 4096
  s_waitcnt vmcnt(0)
  buffer_wbl2 sc1
  s_branch cB_done
cB_va1_rp:
  s_cmp_eq_u32 s37, 0
  s_cbranch_scc1 cB_va1_rv
  v_min_u32 v160, -2, v160
  buffer_store_dword v160, v1, s[8:11], s21 offen sc1
  s_branch cB_va1_cont
cB_va1_rv:
  s_add_u32 s31, s31, 0x10000
  buffer_load_dwordx4 v[8:11], v2, s[8:11], s22 offen offset:0 sc1
  buffer_load_dwordx4 v[12:15], v2, s[8:11], s22 offen offset:1024 sc1
  buffer_load_dwordx4 v[16:19], v2, s[8:11], s22 offen offset:2048 sc1
  buffer_load_dwordx4 v[20:23], v2, s[8:11], s22 offen offset:3072 sc1
  buffer_load_dwordx4 v[24:27], v2, s[8:11], s34 offen offset:0 sc1
  buffer_load_dwordx4 v[28:31], v2, s[8:11], s34 offen offset:1024 sc1
  buffer_load_dwordx4 v[32:35], v2, s[8:11], s34 offen offset:2048 sc1
  buffer_load_dwordx4 v[36:39], v2, s[8:11], s34 offen offset:3072 sc1
  buffer_load_dwordx4 v[40:43], v2, s[8:11], s36 offen offset:0 sc1
  buffer_load_dwordx4 v[44:47], v2, s[8:11], s36 offen offset:1024 sc1
  s_waitcnt vmcnt(0)
  v_max3_u32 v52, v8, v9, v10
  v_max3_u32 v52, v52, v11, v12
  v_max3_u32 v52, v52, v13, v14
  v_max3_u32 v52, v52, v15, v16
  v_max3_u32 v52, v52, v17, v18
  v_max3_u32 v52, v52, v19, v20
  v_max3_u32 v52, v52, v21, v22
  v_max3_u32 v52, v52, v23, v24
  v_max3_u32 v52, v52, v25, v26
  v_max3_u32 v52, v52, v27, v28
  v_max3_u32 v52, v52, v29, v30
  v_max3_u32 v52, v52, v31, v32
  v_max3_u32 v52, v52, v33, v34
  v_max3_u32 v52, v52, v35, v36
  v_max3_u32 v52, v52, v37, v38
  v_max3_u32 v52, v52, v39, v40
  v_max3_u32 v52, v52, v41, v42
  v_max3_u32 v52, v52, v43, v44
  v_max3_u32 v52, v52, v45, v46
  v_max_u32 v52, v52, v47
  v_cmp_eq_u32 vcc, -1, v52
  s_mov_b32 s37, 1
  v_mov_b32 v48, 0
  v_mov_b32 v49, 0
  v_mov_b32 v50, 0
  v_mov_b32 v51, 0
  s_nop 1
  s_cbranch_vccz cB_va1_lp
  s_add_u32 s30, s30, 1
  s_cmp_lt_u32 s30, 400000
  s_cbranch_scc1 cB_va1_rv
  s_branch cB_abort
.p2align 6
cB_va2_loop:
  s_mov_b32 s30, 0
cB_va2_fp_l:
  v_cmp_gt_u32 vcc, s19, v96
  buffer_load_dword v96, v119, s[8:11], 0 offen sc1
  s_cbranch_vccz cB_va2_fp_d
  v_cmp_gt_u32 vcc, s19, v96
  buffer_load_dword v96, v119, s[8:11], 0 offen sc1
  s_cbranch_vccz cB_va2_fp_d
  v_cmp_gt_u32 vcc, s19, v96
  buffer_load_dword v96, v119, s[8:11], 0 offen sc1
  s_cbranch_vccz cB_va2_fp_d
  v_cmp_gt_u32 vcc, s19, v96
  buffer_load_dword v96, v119, s[8:11], 0 offen sc1
  s_cbranch_vccz cB_va2_fp_d
  v_cmp_gt_u32 vcc, s19, v96
  buffer_load_dword v96, v119, s[8:11], 0 offen sc1
  s_cbranch_vccz cB_va2_fp_d
  v_cmp_gt_u32 vcc, s19, v96
  buffer_load_dword v96, v119, s[8:11], 0 offen sc1
  s_cbranch_vccz cB_va2_fp_d
  v_cmp_gt_u32 vcc, s19, v96
  buffer_load_dword v96, v119, s[8:11], 0 offen sc1
  s_cbranch_vccz cB_va2_fp_d
  v_cmp_gt_u32 vcc, s19, v96
  buffer_load_dword v96, v119, s[8:11], 0 offen sc1
  s_cbranch_vccz cB_va2_fp_d
  v_cmp_gt_u32 vcc, s19, v96
  buffer_load_dword v96, v119, s[8:11], 0 offen sc1
  s_cbranch_vccz cB_va2_fp_d
  v_cmp_gt_u32 vcc, s19, v96
  buffer_load_dword v96, v119, s[8:11], 0 offen sc1
  s_cbranch_vccz cB_va2_fp_d
  v_cmp_gt_u32 vcc, s19, v96
  buffer_load_dword v96, v119, s[8:11], 0 offen sc1
  s_cbranch_vccz cB_va2_fp_d
  v_cmp_gt_u32 vcc, s19, v96
  buffer_load_dword v96, v119, s[8:11], 0 offen sc1
  s_cbranch_vccz cB_va2_fp_d
  v_cmp_gt_u32 vcc, s19, v96
  buffer_load_dword v96, v119, s[8:11], 0 offen sc1
  s_cbranch_vccz cB_va2_fp_d
  v_cmp_gt_u32 vcc, s19, v96
  buffer_load_dword v96, v119, s[8:11], 0 offen sc1
  s_cbranch_vccz cB_va2_fp_d
  v_cmp_gt_u32 vcc, s19, v96
  buffer_load_dword v96, v119, s[8:11], 0 offen sc1
  s_cbranch_vccz cB_va2_fp_d
  v_cmp_gt_u32 vcc, s19, v96
  buffer_load_dword v96, v119, s[8:11], 0 offen sc1
  s_cbranch_vccz cB_va2_fp_d
  s_waitcnt vmcnt(24)
  s_add_u32 s30, s30, 1
  s_cmp_lt_u32 s30, 400000
  s_cbranch_scc1 cB_va2_fp_l
  s_branch cB_abort
cB_va2_fp_d:
  buffer_load_dwordx4 v[8:11], v2, s[8:11], s20 offen offset:0 sc1
  buffer_load_dwordx4 v[12:15], v2, s[8:11], s20 offen offset:1024 sc1
  s_barrier
  s_barrier
  s_waitcnt vmcnt(0)
  ds_write_b128 v2, v[8:11] offset:8192
  ds_write_b128 v2, v[12:15] offset:9216
  v_smfmac_f32_16x16x64_bf16 v[36:39], v[8:11], a[0:7], v3
  v_smfmac_f32_16x16x64_bf16 v[40:43], v[8:11], a[56:63], v3
  v_smfmac_f32_16x16x64_bf16 v[44:47], v[8:11], a[112:119], v3
  v_smfmac_f32_16x16x64_bf16 v[48:51], v[8:11], a[168:175], v3
  v_smfmac_f32_16x16x64_bf16 v[52:55], v[8:11], a[224:231], v3
  s_waitcnt lgkmcnt(0)
  s_barrier
  ds_read_b128 v[16:19], v2 offset:10240
  ds_read_b128 v[20:23], v2 offset:11264
  ds_read_b128 v[24:27], v2 offset:12288
  ds_read_b128 v[28:31], v2 offset:13312
  ds_read_b128 v[32:35], v2 offset:14336
  v_smfmac_f32_16x16x64_bf16 v[56:59], v[8:11], v[144:151], v3
  v_smfmac_f32_16x16x64_bf16 v[60:63], v[8:11], v[200:207], v3
  v_smfmac_f32_16x16x64_bf16 v[36:39], v[12:15], a[8:15], v3
  v_smfmac_f32_16x16x64_bf16 v[40:43], v[12:15], a[64:71], v3
  v_smfmac_f32_16x16x64_bf16 v[44:47], v[12:15], a[120:127], v3
  v_smfmac_f32_16x16x64_bf16 v[48:51], v[12:15], a[176:183], v3
  v_smfmac_f32_16x16x64_bf16 v[52:55], v[12:15], a[232:239], v3
  v_smfmac_f32_16x16x64_bf16 v[56:59], v[12:15], v[152:159], v3
  ds_read_b128 v[68:71], v0 offset:0
  ds_read_b128 v[72:75], v0 offset:1024
  v_smfmac_f32_16x16x64_bf16 v[60:63], v[12:15], v[208:215], v3
  s_waitcnt lgkmcnt(6)
  ds_read_b128 v[76:79], v0 offset:2048
  ds_read_b128 v[80:83], v0 offset:3072
  v_smfmac_f32_16x16x64_bf16 v[36:39], v[16:19], a[16:23], v3
  s_waitcnt lgkmcnt(7)
  v_smfmac_f32_16x16x64_bf16 v[36:39], v[20:23], a[24:31], v3
  s_waitcnt lgkmcnt(6)
  v_smfmac_f32_16x16x64_bf16 v[36:39], v[24:27], a[32:39], v3
  s_waitcnt lgkmcnt(2)
  v_smfmac_f32_16x16x64_bf16 v[64:67], v[8:11], v[68:75], v3
  s_waitcnt lgkmcnt(5)
  ds_read_b128 v[84:87], v0 offset:4096
  ds_read_b128 v[88:91], v0 offset:5120
  v_smfmac_f32_16x16x64_bf16 v[36:39], v[28:31], a[40:47], v3
  s_waitcnt lgkmcnt(6)
  v_smfmac_f32_16x16x64_bf16 v[36:39], v[32:35], a[48:55], v3
  v_smfmac_f32_16x16x64_bf16 v[40:43], v[16:19], a[72:79], v3
  s_waitcnt lgkmcnt(2)
  v_smfmac_f32_16x16x64_bf16 v[64:67], v[12:15], v[76:83], v3
  ds_read_b128 v[68:71], v0 offset:6144
  ds_read_b128 v[72:75], v0 offset:7168
  v_smfmac_f32_16x16x64_bf16 v[40:43], v[20:23], a[80:87], v3
  v_permlane32_swap_b32 v36, v38
  v_smfmac_f32_16x16x64_bf16 v[40:43], v[24:27], a[88:95], v3
  v_permlane32_swap_b32 v37, v39
  v_smfmac_f32_16x16x64_bf16 v[40:43], v[28:31], a[96:103], v3
  s_waitcnt lgkmcnt(2)
  v_add_f32 v36, v36, v38
  v_smfmac_f32_16x16x64_bf16 v[64:67], v[16:19], v[84:91], v3
  ds_read_b128 v[76:79], v0 offset:8192
  ds_read_b128 v[80:83], v0 offset:9216
  v_add_f32 v37, v37, v39
  v_smfmac_f32_16x16x64_bf16 v[40:43], v[32:35], a[104:111], v3
  v_cmp_u_f32 vcc, v36, v37
  v_smfmac_f32_16x16x64_bf16 v[44:47], v[16:19], a[128:135], v3
  v_cvt_pk_bf16_f32 v38, v36, v37
  v_smfmac_f32_16x16x64_bf16 v[44:47], v[20:23], a[136:143], v3
  ds_write_b32 v104, v38
  s_waitcnt lgkmcnt(3)
  s_cbranch_vccnz cB_va2_slow
  v_permlane32_swap_b32 v40, v42
  v_smfmac_f32_16x16x64_bf16 v[64:67], v[20:23], v[68:75], v3
  ds_read_b128 v[84:87], v0 offset:10240
  ds_read_b128 v[88:91], v0 offset:11264
  v_permlane32_swap_b32 v41, v43
  v_smfmac_f32_16x16x64_bf16 v[44:47], v[24:27], a[144:151], v3
  v_add_f32 v40, v40, v42
  v_smfmac_f32_16x16x64_bf16 v[44:47], v[28:31], a[152:159], v3
  v_add_f32 v41, v41, v43
  v_smfmac_f32_16x16x64_bf16 v[44:47], v[32:35], a[160:167], v3
  s_waitcnt lgkmcnt(3)
  v_cvt_pk_bf16_f32 v42, v40, v41
  v_smfmac_f32_16x16x64_bf16 v[64:67], v[24:27], v[76:83], v3
  ds_write_b32 v105, v42
  ds_read_b128 v[68:71], v0 offset:12288
  ds_read_b128 v[72:75], v0 offset:13312
  v_smfmac_f32_16x16x64_bf16 v[48:51], v[16:19], a[184:191], v3
  s_nop 0
  v_permlane32_swap_b32 v44, v46
  v_smfmac_f32_16x16x64_bf16 v[48:51], v[20:23], a[192:199], v3
  v_permlane32_swap_b32 v45, v47
  v_smfmac_f32_16x16x64_bf16 v[48:51], v[24:27], a[200:207], v3
  s_waitcnt lgkmcnt(3)
  v_add_f32 v44, v44, v46
  v_smfmac_f32_16x16x64_bf16 v[64:67], v[28:31], v[84:91], v3
  v_add_f32 v45, v45, v47
  v_smfmac_f32_16x16x64_bf16 v[48:51], v[28:31], a[208:215], v3
  v_cvt_pk_bf16_f32 v46, v44, v45
  v_smfmac_f32_16x16x64_bf16 v[48:51], v[32:35], a[216:223], v3
  ds_write_b32 v106, v46
  v_smfmac_f32_16x16x64_bf16 v[52:55], v[16:19], a[240:247], v3
  s_waitcnt lgkmcnt(1)
  v_smfmac_f32_16x16x64_bf16 v[64:67], v[32:35], v[68:75], v3
  v_smfmac_f32_16x16x64_bf16 v[52:55], v[20:23], a[248:255], v3
  v_permlane32_swap_b32 v48, v50
  v_smfmac_f32_16x16x64_bf16 v[52:55], v[24:27], v[120:127], v3
  v_permlane32_swap_b32 v49, v51
  v_smfmac_f32_16x16x64_bf16 v[52:55], v[28:31], v[128:135], v3
  v_add_f32 v48, v48, v50
  v_smfmac_f32_16x16x64_bf16 v[52:55], v[32:35], v[136:143], v3
  v_add_f32 v49, v49, v51
  v_smfmac_f32_16x16x64_bf16 v[56:59], v[16:19], v[160:167], v3
  v_cvt_pk_bf16_f32 v50, v48, v49
  v_smfmac_f32_16x16x64_bf16 v[56:59], v[20:23], v[168:175], v3
  ds_write_b32 v107, v50
  v_permlane32_swap_b32 v64, v66
  v_smfmac_f32_16x16x64_bf16 v[56:59], v[24:27], v[176:183], v3
  v_permlane32_swap_b32 v65, v67
  v_smfmac_f32_16x16x64_bf16 v[56:59], v[28:31], v[184:191], v3
  v_add_f32 v64, v64, v66
  v_smfmac_f32_16x16x64_bf16 v[56:59], v[32:35], v[192:199], v3
  v_add_f32 v65, v65, v67
  v_smfmac_f32_16x16x64_bf16 v[60:63], v[16:19], v[216:223], v3
  v_cvt_pk_bf16_f32 v66, v64, v65
  v_smfmac_f32_16x16x64_bf16 v[60:63], v[20:23], v[224:231], v3
  ds_write_b32 v111, v66
  v_permlane32_swap_b32 v52, v54
  v_smfmac_f32_16x16x64_bf16 v[60:63], v[24:27], v[232:239], v3
  v_permlane32_swap_b32 v53, v55
  v_smfmac_f32_16x16x64_bf16 v[60:63], v[28:31], v[240:247], v3
  v_add_f32 v52, v52, v54
  v_smfmac_f32_16x16x64_bf16 v[60:63], v[32:35], v[248:255], v3
  v_add_f32 v53, v53, v55
  v_cvt_pk_bf16_f32 v54, v52, v53
  ds_write_b32 v108, v54
  v_permlane32_swap_b32 v56, v58
  v_permlane32_swap_b32 v57, v59
  v_add_f32 v56, v56, v58
  v_add_f32 v57, v57, v59
  v_cvt_pk_bf16_f32 v58, v56, v57
  ds_write_b32 v109, v58
  v_permlane32_swap_b32 v60, v62
  v_permlane32_swap_b32 v61, v63
  v_add_f32 v60, v60, v62
  v_add_f32 v61, v61, v63
  v_cvt_pk_bf16_f32 v62, v60, v61
  ds_write_b32 v110, v62
cB_va2_t2d:
  v_mov_b32 v117, s18
  s_waitcnt lgkmcnt(0)
  s_barrier
  s_cmp_eq_u32 s19, 63
  s_cbranch_scc1 cB_done
  s_sleep 1
  v_mov_b32 v36, 0
  v_mov_b32 v37, 0
  v_mov_b32 v38, 0
  v_mov_b32 v39, 0
  v_mov_b32 v40, 0
  v_mov_b32 v41, 0
  v_mov_b32 v42, 0
  v_mov_b32 v43, 0
  v_mov_b32 v44, 0
  v_mov_b32 v45, 0
  v_mov_b32 v46, 0
  v_mov_b32 v47, 0
  v_mov_b32 v48, 0
  v_mov_b32 v49, 0
  v_mov_b32 v50, 0
  v_mov_b32 v51, 0
  v_mov_b32 v52, 0
  v_mov_b32 v53, 0
  v_mov_b32 v54, 0
  v_mov_b32 v55, 0
  v_mov_b32 v56, 0
  v_mov_b32 v57, 0
  v_mov_b32 v58, 0
  v_mov_b32 v59, 0
  v_mov_b32 v60, 0
  v_mov_b32 v61, 0
  v_mov_b32 v62, 0
  v_mov_b32 v63, 0
  v_mov_b32 v64, 0
  v_mov_b32 v65, 0
  v_mov_b32 v66, 0
  v_mov_b32 v67, 0
  s_sleep 5
  s_mov_b32 s19, s18
  s_add_u32 s18, s18, 1
  s_mov_b32 s22, s20
  s_mov_b32 s20, s21
  s_mov_b32 s21, s22
  s_add_u32 s23, s20, 4096
  s_branch cB_va2_loop
cB_va2_slow:
  s_waitcnt lgkmcnt(0)
cB_va2_sl1:
  s_add_u32 s31, s31, 0x1000000
  buffer_load_dwordx4 v[8:11], v2, s[8:11], s20 offen offset:0 sc1
  buffer_load_dwordx4 v[12:15], v2, s[8:11], s20 offen offset:1024 sc1
  buffer_load_dwordx4 v[16:19], v2, s[8:11], s20 offen offset:2048 sc1
  buffer_load_dwordx4 v[20:23], v2, s[8:11], s20 offen offset:3072 sc1
  buffer_load_dwordx4 v[24:27], v2, s[8:11], s23 offen offset:0 sc1
  buffer_load_dwordx4 v[28:31], v2, s[8:11], s23 offen offset:1024 sc1
  buffer_load_dwordx4 v[32:35], v2, s[8:11], s23 offen offset:2048 sc1
  s_waitcnt vmcnt(0)
  v_max3_u32 v36, v8, v9, v10
  v_max3_u32 v36, v36, v11, v12
  v_max3_u32 v36, v36, v13, v14
  v_max3_u32 v36, v36, v15, v16
  v_max3_u32 v36, v36, v17, v18
  v_max3_u32 v36, v36, v19, v20
  v_max3_u32 v36, v36, v21, v22
  v_max3_u32 v36, v36, v23, v24
  v_max3_u32 v36, v36, v25, v26
  v_max3_u32 v36, v36, v27, v28
  v_max3_u32 v36, v36, v29, v30
  v_max3_u32 v36, v36, v31, v32
  v_max3_u32 v36, v36, v33, v34
  v_max_u32 v36, v36, v35
  v_cmp_eq_u32 vcc, -1, v36
  s_cbranch_vccz cB_va2_sl2
  s_add_u32 s30, s30, 1
  s_cmp_lt_u32 s30, 400000
  s_cbranch_scc1 cB_va2_sl1
  s_branch cB_abort
cB_va2_sl2:
  v_mov_b32 v36, 0
  v_mov_b32 v37, 0
  v_mov_b32 v38, 0
  v_mov_b32 v39, 0
  v_mov_b32 v40, 0
  v_mov_b32 v41, 0
  v_mov_b32 v42, 0
  v_mov_b32 v43, 0
  v_mov_b32 v44, 0
  v_mov_b32 v45, 0
  v_mov_b32 v46, 0
  v_mov_b32 v47, 0
  v_mov_b32 v48, 0
  v_mov_b32 v49, 0
  v_mov_b32 v50, 0
  v_mov_b32 v51, 0
  v_mov_b32 v52, 0
  v_mov_b32 v53, 0
  v_mov_b32 v54, 0
  v_mov_b32 v55, 0
  v_mov_b32 v56, 0
  v_mov_b32 v57, 0
  v_mov_b32 v58, 0
  v_mov_b32 v59, 0
  v_mov_b32 v60, 0
  v_mov_b32 v61, 0
  v_mov_b32 v62, 0
  v_mov_b32 v63, 0
  v_mov_b32 v64, 0
  v_mov_b32 v65, 0
  v_mov_b32 v66, 0
  v_mov_b32 v67, 0
  ds_read_b128 v[68:71], v0 offset:0
  ds_read_b128 v[72:75], v0 offset:1024
  v_smfmac_f32_16x16x64_bf16 v[36:39], v[8:11], a[0:7], v3
  v_smfmac_f32_16x16x64_bf16 v[40:43], v[8:11], a[56:63], v3
  v_smfmac_f32_16x16x64_bf16 v[44:47], v[8:11], a[112:119], v3
  v_smfmac_f32_16x16x64_bf16 v[48:51], v[8:11], a[168:175], v3
  v_smfmac_f32_16x16x64_bf16 v[52:55], v[8:11], a[224:231], v3
  v_smfmac_f32_16x16x64_bf16 v[56:59], v[8:11], v[144:151], v3
  v_smfmac_f32_16x16x64_bf16 v[60:63], v[8:11], v[200:207], v3
  s_waitcnt lgkmcnt(0)
  v_smfmac_f32_16x16x64_bf16 v[64:67], v[8:11], v[68:75], v3
  ds_read_b128 v[76:79], v0 offset:2048
  ds_read_b128 v[80:83], v0 offset:3072
  v_smfmac_f32_16x16x64_bf16 v[36:39], v[12:15], a[8:15], v3
  v_smfmac_f32_16x16x64_bf16 v[40:43], v[12:15], a[64:71], v3
  v_smfmac_f32_16x16x64_bf16 v[44:47], v[12:15], a[120:127], v3
  v_smfmac_f32_16x16x64_bf16 v[48:51], v[12:15], a[176:183], v3
  v_smfmac_f32_16x16x64_bf16 v[52:55], v[12:15], a[232:239], v3
  v_smfmac_f32_16x16x64_bf16 v[56:59], v[12:15], v[152:159], v3
  v_smfmac_f32_16x16x64_bf16 v[60:63], v[12:15], v[208:215], v3
  s_waitcnt lgkmcnt(0)
  v_smfmac_f32_16x16x64_bf16 v[64:67], v[12:15], v[76:83], v3
  ds_read_b128 v[84:87], v0 offset:4096
  ds_read_b128 v[88:91], v0 offset:5120
  v_smfmac_f32_16x16x64_bf16 v[36:39], v[16:19], a[16:23], v3
  v_smfmac_f32_16x16x64_bf16 v[40:43], v[16:19], a[72:79], v3
  v_smfmac_f32_16x16x64_bf16 v[44:47], v[16:19], a[128:135], v3
  v_smfmac_f32_16x16x64_bf16 v[48:51], v[16:19], a[184:191], v3
  v_smfmac_f32_16x16x64_bf16 v[52:55], v[16:19], a[240:247], v3
  v_smfmac_f32_16x16x64_bf16 v[56:59], v[16:19], v[160:167], v3
  v_smfmac_f32_16x16x64_bf16 v[60:63], v[16:19], v[216:223], v3
  s_waitcnt lgkmcnt(0)
  v_smfmac_f32_16x16x64_bf16 v[64:67], v[16:19], v[84:91], v3
  ds_read_b128 v[68:71], v0 offset:6144
  ds_read_b128 v[72:75], v0 offset:7168
  v_smfmac_f32_16x16x64_bf16 v[36:39], v[20:23], a[24:31], v3
  v_smfmac_f32_16x16x64_bf16 v[40:43], v[20:23], a[80:87], v3
  v_smfmac_f32_16x16x64_bf16 v[44:47], v[20:23], a[136:143], v3
  v_smfmac_f32_16x16x64_bf16 v[48:51], v[20:23], a[192:199], v3
  v_smfmac_f32_16x16x64_bf16 v[52:55], v[20:23], a[248:255], v3
  v_smfmac_f32_16x16x64_bf16 v[56:59], v[20:23], v[168:175], v3
  v_smfmac_f32_16x16x64_bf16 v[60:63], v[20:23], v[224:231], v3
  s_waitcnt lgkmcnt(0)
  v_smfmac_f32_16x16x64_bf16 v[64:67], v[20:23], v[68:75], v3
  ds_read_b128 v[76:79], v0 offset:8192
  ds_read_b128 v[80:83], v0 offset:9216
  v_smfmac_f32_16x16x64_bf16 v[36:39], v[24:27], a[32:39], v3
  v_smfmac_f32_16x16x64_bf16 v[40:43], v[24:27], a[88:95], v3
  v_smfmac_f32_16x16x64_bf16 v[44:47], v[24:27], a[144:151], v3
  v_smfmac_f32_16x16x64_bf16 v[48:51], v[24:27], a[200:207], v3
  v_smfmac_f32_16x16x64_bf16 v[52:55], v[24:27], v[120:127], v3
  v_smfmac_f32_16x16x64_bf16 v[56:59], v[24:27], v[176:183], v3
  v_smfmac_f32_16x16x64_bf16 v[60:63], v[24:27], v[232:239], v3
  s_waitcnt lgkmcnt(0)
  v_smfmac_f32_16x16x64_bf16 v[64:67], v[24:27], v[76:83], v3
  ds_read_b128 v[84:87], v0 offset:10240
  ds_read_b128 v[88:91], v0 offset:11264
  v_smfmac_f32_16x16x64_bf16 v[36:39], v[28:31], a[40:47], v3
  v_smfmac_f32_16x16x64_bf16 v[40:43], v[28:31], a[96:103], v3
  v_smfmac_f32_16x16x64_bf16 v[44:47], v[28:31], a[152:159], v3
  v_smfmac_f32_16x16x64_bf16 v[48:51], v[28:31], a[208:215], v3
  v_smfmac_f32_16x16x64_bf16 v[52:55], v[28:31], v[128:135], v3
  v_smfmac_f32_16x16x64_bf16 v[56:59], v[28:31], v[184:191], v3
  v_smfmac_f32_16x16x64_bf16 v[60:63], v[28:31], v[240:247], v3
  s_waitcnt lgkmcnt(0)
  v_smfmac_f32_16x16x64_bf16 v[64:67], v[28:31], v[84:91], v3
  ds_read_b128 v[68:71], v0 offset:12288
  ds_read_b128 v[72:75], v0 offset:13312
  v_smfmac_f32_16x16x64_bf16 v[36:39], v[32:35], a[48:55], v3
  v_smfmac_f32_16x16x64_bf16 v[40:43], v[32:35], a[104:111], v3
  v_smfmac_f32_16x16x64_bf16 v[44:47], v[32:35], a[160:167], v3
  v_smfmac_f32_16x16x64_bf16 v[48:51], v[32:35], a[216:223], v3
  v_smfmac_f32_16x16x64_bf16 v[52:55], v[32:35], v[136:143], v3
  v_smfmac_f32_16x16x64_bf16 v[56:59], v[32:35], v[192:199], v3
  v_smfmac_f32_16x16x64_bf16 v[60:63], v[32:35], v[248:255], v3
  s_waitcnt lgkmcnt(0)
  v_smfmac_f32_16x16x64_bf16 v[64:67], v[32:35], v[68:75], v3
  v_permlane32_swap_b32 v36, v38
  v_permlane32_swap_b32 v37, v39
  v_add_f32 v36, v36, v38
  v_add_f32 v37, v37, v39
  v_cvt_pk_bf16_f32 v38, v36, v37
  ds_write_b32 v104, v38
  v_permlane32_swap_b32 v40, v42
  v_permlane32_swap_b32 v41, v43
  v_add_f32 v40, v40, v42
  v_add_f32 v41, v41, v43
  v_cvt_pk_bf16_f32 v42, v40, v41
  ds_write_b32 v105, v42
  v_permlane32_swap_b32 v44, v46
  v_permlane32_swap_b32 v45, v47
  v_add_f32 v44, v44, v46
  v_add_f32 v45, v45, v47
  v_cvt_pk_bf16_f32 v46, v44, v45
  ds_write_b32 v106, v46
  v_permlane32_swap_b32 v48, v50
  v_permlane32_swap_b32 v49, v51
  v_add_f32 v48, v48, v50
  v_add_f32 v49, v49, v51
  v_cvt_pk_bf16_f32 v50, v48, v49
  ds_write_b32 v107, v50
  v_permlane32_swap_b32 v52, v54
  v_permlane32_swap_b32 v53, v55
  v_add_f32 v52, v52, v54
  v_add_f32 v53, v53, v55
  v_cvt_pk_bf16_f32 v54, v52, v53
  ds_write_b32 v108, v54
  v_permlane32_swap_b32 v56, v58
  v_permlane32_swap_b32 v57, v59
  v_add_f32 v56, v56, v58
  v_add_f32 v57, v57, v59
  v_cvt_pk_bf16_f32 v58, v56, v57
  ds_write_b32 v109, v58
  v_permlane32_swap_b32 v60, v62
  v_permlane32_swap_b32 v61, v63
  v_add_f32 v60, v60, v62
  v_add_f32 v61, v61, v63
  v_cvt_pk_bf16_f32 v62, v60, v61
  ds_write_b32 v110, v62
  v_permlane32_swap_b32 v64, v66
  v_permlane32_swap_b32 v65, v67
  v_add_f32 v64, v64, v66
  v_add_f32 v65, v65, v67
  v_cvt_pk_bf16_f32 v66, v64, v65
  ds_write_b32 v111, v66
  s_branch cB_va2_t2d
.p2align 6
cB_va3_loop:
  s_mov_b32 s30, 0
  s_barrier
  buffer_load_dwordx4 v[16:19], v2, s[8:11], s20 offen offset:2048 sc1
  buffer_load_dwordx4 v[20:23], v2, s[8:11], s20 offen offset:3072 sc1
  s_barrier
  buffer_load_dword v100, v116, s[8:11], s39 offen sc1
  s_add_u32 s27, s19, 2
  s_min_u32 s27, s27, 63
  s_lshr_b32 s27, s27, 3
  s_lshl_b32 s27, s27, 11
  s_add_u32 s27, s27, s35
  s_cmp_eq_u32 s27, s28
  s_cselect_b32 s29, 35328, s27
  buffer_load_dword v101, off, s[8:11], s29 sc1
  s_add_u32 s39, s39, 28672
  s_waitcnt vmcnt(2)
  ds_write_b128 v2, v[16:19] offset:10240
  ds_write_b128 v2, v[20:23] offset:11264
  v_smfmac_f32_16x16x64_bf16 v[36:39], v[16:19], a[16:23], v3
  v_smfmac_f32_16x16x64_bf16 v[40:43], v[16:19], a[72:79], v3
  v_smfmac_f32_16x16x64_bf16 v[44:47], v[16:19], a[128:135], v3
  v_smfmac_f32_16x16x64_bf16 v[48:51], v[16:19], a[184:191], v3
  v_smfmac_f32_16x16x64_bf16 v[52:55], v[16:19], a[240:247], v3
  s_waitcnt lgkmcnt(0)
  s_barrier
  ds_read_b128 v[8:11], v2 offset:8192
  ds_read_b128 v[12:15], v2 offset:9216
  ds_read_b128 v[24:27], v2 offset:12288
  ds_read_b128 v[28:31], v2 offset:13312
  ds_read_b128 v[32:35], v2 offset:14336
  v_smfmac_f32_16x16x64_bf16 v[56:59], v[16:19], v[160:167], v3
  v_smfmac_f32_16x16x64_bf16 v[60:63], v[16:19], v[216:223], v3
  v_smfmac_f32_16x16x64_bf16 v[36:39], v[20:23], a[24:31], v3
  v_smfmac_f32_16x16x64_bf16 v[40:43], v[20:23], a[80:87], v3
  v_smfmac_f32_16x16x64_bf16 v[44:47], v[20:23], a[136:143], v3
  v_smfmac_f32_16x16x64_bf16 v[48:51], v[20:23], a[192:199], v3
  v_smfmac_f32_16x16x64_bf16 v[52:55], v[20:23], a[248:255], v3
  v_smfmac_f32_16x16x64_bf16 v[56:59], v[20:23], v[168:175], v3
  v_smfmac_f32_16x16x64_bf16 v[60:63], v[20:23], v[224:231], v3
  s_waitcnt lgkmcnt(4)
  v_smfmac_f32_16x16x64_bf16 v[36:39], v[8:11], a[0:7], v3
  s_waitcnt lgkmcnt(3)
  v_smfmac_f32_16x16x64_bf16 v[36:39], v[12:15], a[8:15], v3
  s_waitcnt lgkmcnt(2)
  v_smfmac_f32_16x16x64_bf16 v[36:39], v[24:27], a[32:39], v3
  s_waitcnt lgkmcnt(1)
  v_smfmac_f32_16x16x64_bf16 v[36:39], v[28:31], a[40:47], v3
  s_waitcnt lgkmcnt(0)
  v_smfmac_f32_16x16x64_bf16 v[36:39], v[32:35], a[48:55], v3
  v_smfmac_f32_16x16x64_bf16 v[40:43], v[8:11], a[56:63], v3
  v_smfmac_f32_16x16x64_bf16 v[40:43], v[12:15], a[64:71], v3
  v_smfmac_f32_16x16x64_bf16 v[40:43], v[24:27], a[88:95], v3
  v_permlane32_swap_b32 v36, v38
  v_smfmac_f32_16x16x64_bf16 v[40:43], v[28:31], a[96:103], v3
  v_permlane32_swap_b32 v37, v39
  v_smfmac_f32_16x16x64_bf16 v[40:43], v[32:35], a[104:111], v3
  v_add_f32 v36, v36, v38
  v_smfmac_f32_16x16x64_bf16 v[44:47], v[8:11], a[112:119], v3
  v_add_f32 v37, v37, v39
  v_smfmac_f32_16x16x64_bf16 v[44:47], v[12:15], a[120:127], v3
  v_cmp_u_f32 vcc, v36, v37
  v_smfmac_f32_16x16x64_bf16 v[44:47], v[24:27], a[144:151], v3
  v_cvt_pk_bf16_f32 v38, v36, v37
  v_smfmac_f32_16x16x64_bf16 v[44:47], v[28:31], a[152:159], v3
  ds_write_b32 v104, v38
  s_cbranch_vccnz cB_va3_slow
  v_permlane32_swap_b32 v40, v42
  v_smfmac_f32_16x16x64_bf16 v[44:47], v[32:35], a[160:167], v3
  v_permlane32_swap_b32 v41, v43
  v_smfmac_f32_16x16x64_bf16 v[48:51], v[8:11], a[168:175], v3
  v_add_f32 v40, v40, v42
  v_smfmac_f32_16x16x64_bf16 v[48:51], v[12:15], a[176:183], v3
  v_add_f32 v41, v41, v43
  v_smfmac_f32_16x16x64_bf16 v[48:51], v[24:27], a[200:207], v3
  v_cvt_pk_bf16_f32 v42, v40, v41
  v_smfmac_f32_16x16x64_bf16 v[48:51], v[28:31], a[208:215], v3
  ds_write_b32 v105, v42
  v_permlane32_swap_b32 v44, v46
  v_smfmac_f32_16x16x64_bf16 v[48:51], v[32:35], a[216:223], v3
  v_permlane32_swap_b32 v45, v47
  v_smfmac_f32_16x16x64_bf16 v[52:55], v[8:11], a[224:231], v3
  v_add_f32 v44, v44, v46
  v_smfmac_f32_16x16x64_bf16 v[52:55], v[12:15], a[232:239], v3
  v_add_f32 v45, v45, v47
  v_smfmac_f32_16x16x64_bf16 v[52:55], v[24:27], v[120:127], v3
  v_cvt_pk_bf16_f32 v46, v44, v45
  v_smfmac_f32_16x16x64_bf16 v[52:55], v[28:31], v[128:135], v3
  ds_write_b32 v106, v46
  v_permlane32_swap_b32 v48, v50
  v_smfmac_f32_16x16x64_bf16 v[52:55], v[32:35], v[136:143], v3
  v_permlane32_swap_b32 v49, v51
  v_smfmac_f32_16x16x64_bf16 v[56:59], v[8:11], v[144:151], v3
  v_add_f32 v48, v48, v50
  v_smfmac_f32_16x16x64_bf16 v[56:59], v[12:15], v[152:159], v3
  v_add_f32 v49, v49, v51
  v_smfmac_f32_16x16x64_bf16 v[56:59], v[24:27], v[176:183], v3
  v_cvt_pk_bf16_f32 v50, v48, v49
  v_smfmac_f32_16x16x64_bf16 v[56:59], v[28:31], v[184:191], v3
  ds_write_b32 v107, v50
  v_permlane32_swap_b32 v52, v54
  v_smfmac_f32_16x16x64_bf16 v[56:59], v[32:35], v[192:199], v3
  v_permlane32_swap_b32 v53, v55
  v_smfmac_f32_16x16x64_bf16 v[60:63], v[8:11], v[200:207], v3
  v_add_f32 v52, v52, v54
  v_smfmac_f32_16x16x64_bf16 v[60:63], v[12:15], v[208:215], v3
  v_add_f32 v53, v53, v55
  v_smfmac_f32_16x16x64_bf16 v[60:63], v[24:27], v[232:239], v3
  v_cvt_pk_bf16_f32 v54, v52, v53
  v_smfmac_f32_16x16x64_bf16 v[60:63], v[28:31], v[240:247], v3
  ds_write_b32 v108, v54
  v_permlane32_swap_b32 v56, v58
  v_smfmac_f32_16x16x64_bf16 v[60:63], v[32:35], v[248:255], v3
  v_permlane32_swap_b32 v57, v59
  v_add_f32 v56, v56, v58
  v_add_f32 v57, v57, v59
  v_cvt_pk_bf16_f32 v58, v56, v57
  ds_write_b32 v109, v58
  s_nop 2
  v_permlane32_swap_b32 v60, v62
  v_permlane32_swap_b32 v61, v63
  v_add_f32 v60, v60, v62
  v_add_f32 v61, v61, v63
  v_cvt_pk_bf16_f32 v62, v60, v61
  ds_write_b32 v110, v62
cB_va3_t2d:
  v_mov_b32 v117, s18
  s_cmp_eq_u32 s27, s28
  s_cbranch_scc1 cB_va3_vok
cB_va3_vow:
  s_waitcnt vmcnt(0)
  v_cmp_ne_u32 vcc, 56, v101
  s_cbranch_vccnz cB_va3_vor
  s_mov_b32 s28, s27
cB_va3_vok:
  s_waitcnt lgkmcnt(0)
  s_setprio 3
  s_barrier
  v_mov_b32 v36, 0
  v_mov_b32 v37, 0
  buffer_store_dword v117, v118, s[8:11], 0 offen sc1
  s_setprio 0
  s_cmp_eq_u32 s19, 63
  s_cbranch_scc1 cB_done
  v_mov_b32 v38, 0
  v_mov_b32 v39, 0
  v_mov_b32 v40, 0
  v_mov_b32 v41, 0
  v_mov_b32 v42, 0
  v_mov_b32 v43, 0
  v_mov_b32 v44, 0
  v_mov_b32 v45, 0
  v_mov_b32 v46, 0
  v_mov_b32 v47, 0
  v_mov_b32 v48, 0
  v_mov_b32 v49, 0
  v_mov_b32 v50, 0
  v_mov_b32 v51, 0
  v_mov_b32 v52, 0
  v_mov_b32 v53, 0
  v_mov_b32 v54, 0
  v_mov_b32 v55, 0
  v_mov_b32 v56, 0
  v_mov_b32 v57, 0
  v_mov_b32 v58, 0
  v_mov_b32 v59, 0
  v_mov_b32 v60, 0
  v_mov_b32 v61, 0
  v_mov_b32 v62, 0
  v_mov_b32 v63, 0
  s_mov_b32 s19, s18
  s_add_u32 s18, s18, 1
  s_mov_b32 s22, s20
  s_mov_b32 s20, s21
  s_mov_b32 s21, s22
  s_add_u32 s23, s20, 4096
  s_branch cB_va3_loop
cB_va3_slow:
  s_waitcnt lgkmcnt(0)
cB_va3_sl1:
  s_add_u32 s31, s31, 0x1000000
  buffer_load_dwordx4 v[8:11], v2, s[8:11], s20 offen offset:0 sc1
  buffer_load_dwordx4 v[12:15], v2, s[8:11], s20 offen offset:1024 sc1
  buffer_load_dwordx4 v[16:19], v2, s[8:11], s20 offen offset:2048 sc1
  buffer_load_dwordx4 v[20:23], v2, s[8:11], s20 offen offset:3072 sc1
  buffer_load_dwordx4 v[24:27], v2, s[8:11], s23 offen offset:0 sc1
  buffer_load_dwordx4 v[28:31], v2, s[8:11], s23 offen offset:1024 sc1
  buffer_load_dwordx4 v[32:35], v2, s[8:11], s23 offen offset:2048 sc1
  s_waitcnt vmcnt(0)
  v_max3_u32 v36, v8, v9, v10
  v_max3_u32 v36, v36, v11, v12
  v_max3_u32 v36, v36, v13, v14
  v_max3_u32 v36, v36, v15, v16
  v_max3_u32 v36, v36, v17, v18
  v_max3_u32 v36, v36, v19, v20
  v_max3_u32 v36, v36, v21, v22
  v_max3_u32 v36, v36, v23, v24
  v_max3_u32 v36, v36, v25, v26
  v_max3_u32 v36, v36, v27, v28
  v_max3_u32 v36, v36, v29, v30
  v_max3_u32 v36, v36, v31, v32
  v_max3_u32 v36, v36, v33, v34
  v_max_u32 v36, v36, v35
  v_cmp_eq_u32 vcc, -1, v36
  s_cbranch_vccz cB_va3_sl2
  s_add_u32 s30, s30, 1
  s_cmp_lt_u32 s30, 400000
  s_cbranch_scc1 cB_va3_sl1
  s_branch cB_abort
cB_va3_sl2:
  v_mov_b32 v36, 0
  v_mov_b32 v37, 0
  v_mov_b32 v38, 0
  v_mov_b32 v39, 0
  v_mov_b32 v40, 0
  v_mov_b32 v41, 0
  v_mov_b32 v42, 0
  v_mov_b32 v43, 0
  v_mov_b32 v44, 0
  v_mov_b32 v45, 0
  v_mov_b32 v46, 0
  v_mov_b32 v47, 0
  v_mov_b32 v48, 0
  v_mov_b32 v49, 0
  v_mov_b32 v50, 0
  v_mov_b32 v51, 0
  v_mov_b32 v52, 0
  v_mov_b32 v53, 0
  v_mov_b32 v54, 0
  v_mov_b32 v55, 0
  v_mov_b32 v56, 0
  v_mov_b32 v57, 0
  v_mov_b32 v58, 0
  v_mov_b32 v59, 0
  v_mov_b32 v60, 0
  v_mov_b32 v61, 0
  v_mov_b32 v62, 0
  v_mov_b32 v63, 0
  v_smfmac_f32_16x16x64_bf16 v[36:39], v[8:11], a[0:7], v3
  v_smfmac_f32_16x16x64_bf16 v[40:43], v[8:11], a[56:63], v3
  v_smfmac_f32_16x16x64_bf16 v[44:47], v[8:11], a[112:119], v3
  v_smfmac_f32_16x16x64_bf16 v[48:51], v[8:11], a[168:175], v3
  v_smfmac_f32_16x16x64_bf16 v[52:55], v[8:11], a[224:231], v3
  v_smfmac_f32_16x16x64_bf16 v[56:59], v[8:11], v[144:151], v3
  v_smfmac_f32_16x16x64_bf16 v[60:63], v[8:11], v[200:207], v3
  v_smfmac_f32_16x16x64_bf16 v[36:39], v[12:15], a[8:15], v3
  v_smfmac_f32_16x16x64_bf16 v[40:43], v[12:15], a[64:71], v3
  v_smfmac_f32_16x16x64_bf16 v[44:47], v[12:15], a[120:127], v3
  v_smfmac_f32_16x16x64_bf16 v[48:51], v[12:15], a[176:183], v3
  v_smfmac_f32_16x16x64_bf16 v[52:55], v[12:15], a[232:239], v3
  v_smfmac_f32_16x16x64_bf16 v[56:59], v[12:15], v[152:159], v3
  v_smfmac_f32_16x16x64_bf16 v[60:63], v[12:15], v[208:215], v3
  v_smfmac_f32_16x16x64_bf16 v[36:39], v[16:19], a[16:23], v3
  v_smfmac_f32_16x16x64_bf16 v[40:43], v[16:19], a[72:79], v3
  v_smfmac_f32_16x16x64_bf16 v[44:47], v[16:19], a[128:135], v3
  v_smfmac_f32_16x16x64_bf16 v[48:51], v[16:19], a[184:191], v3
  v_smfmac_f32_16x16x64_bf16 v[52:55], v[16:19], a[240:247], v3
  v_smfmac_f32_16x16x64_bf16 v[56:59], v[16:19], v[160:167], v3
  v_smfmac_f32_16x16x64_bf16 v[60:63], v[16:19], v[216:223], v3
  v_smfmac_f32_16x16x64_bf16 v[36:39], v[20:23], a[24:31], v3
  v_smfmac_f32_16x16x64_bf16 v[40:43], v[20:23], a[80:87], v3
  v_smfmac_f32_16x16x64_bf16 v[44:47], v[20:23], a[136:143], v3
  v_smfmac_f32_16x16x64_bf16 v[48:51], v[20:23], a[192:199], v3
  v_smfmac_f32_16x16x64_bf16 v[52:55], v[20:23], a[248:255], v3
  v_smfmac_f32_16x16x64_bf16 v[56:59], v[20:23], v[168:175], v3
  v_smfmac_f32_16x16x64_bf16 v[60:63], v[20:23], v[224:231], v3
  v_smfmac_f32_16x16x64_bf16 v[36:39], v[24:27], a[32:39], v3
  v_smfmac_f32_16x16x64_bf16 v[40:43], v[24:27], a[88:95], v3
  v_smfmac_f32_16x16x64_bf16 v[44:47], v[24:27], a[144:151], v3
  v_smfmac_f32_16x16x64_bf16 v[48:51], v[24:27], a[200:207], v3
  v_smfmac_f32_16x16x64_bf16 v[52:55], v[24:27], v[120:127], v3
  v_smfmac_f32_16x16x64_bf16 v[56:59], v[24:27], v[176:183], v3
  v_smfmac_f32_16x16x64_bf16 v[60:63], v[24:27], v[232:239], v3
  v_smfmac_f32_16x16x64_bf16 v[36:39], v[28:31], a[40:47], v3
  v_smfmac_f32_16x16x64_bf16 v[40:43], v[28:31], a[96:103], v3
  v_smfmac_f32_16x16x64_bf16 v[44:47], v[28:31], a[152:159], v3
  v_smfmac_f32_16x16x64_bf16 v[48:51], v[28:31], a[208:215], v3
  v_smfmac_f32_16x16x64_bf16 v[52:55], v[28:31], v[128:135], v3
  v_smfmac_f32_16x16x64_bf16 v[56:59], v[28:31], v[184:191], v3
  v_smfmac_f32_16x16x64_bf16 v[60:63], v[28:31], v[240:247], v3
  v_smfmac_f32_16x16x64_bf16 v[36:39], v[32:35], a[48:55], v3
  v_smfmac_f32_16x16x64_bf16 v[40:43], v[32:35], a[104:111], v3
  v_smfmac_f32_16x16x64_bf16 v[44:47], v[32:35], a[160:167], v3
  v_smfmac_f32_16x16x64_bf16 v[48:51], v[32:35], a[216:223], v3
  v_smfmac_f32_16x16x64_bf16 v[52:55], v[32:35], v[136:143], v3
  v_smfmac_f32_16x16x64_bf16 v[56:59], v[32:35], v[192:199], v3
  v_smfmac_f32_16x16x64_bf16 v[60:63], v[32:35], v[248:255], v3
  v_permlane32_swap_b32 v36, v38
  v_permlane32_swap_b32 v37, v39
  v_add_f32 v36, v36, v38
  v_add_f32 v37, v37, v39
  v_cvt_pk_bf16_f32 v38, v36, v37
  ds_write_b32 v104, v38
  v_permlane32_swap_b32 v40, v42
  v_permlane32_swap_b32 v41, v43
  v_add_f32 v40, v40, v42
  v_add_f32 v41, v41, v43
  v_cvt_pk_bf16_f32 v42, v40, v41
  ds_write_b32 v105, v42
  v_permlane32_swap_b32 v44, v46
  v_permlane32_swap_b32 v45, v47
  v_add_f32 v44, v44, v46
  v_add_f32 v45, v45, v47
  v_cvt_pk_bf16_f32 v46, v44, v45
  ds_write_b32 v106, v46
  v_permlane32_swap_b32 v48, v50
  v_permlane32_swap_b32 v49, v51
  v_add_f32 v48, v48, v50
  v_add_f32 v49, v49, v51
  v_cvt_pk_bf16_f32 v50, v48, v49
  ds_write_b32 v107, v50
  v_permlane32_swap_b32 v52, v54
  v_permlane32_swap_b32 v53, v55
  v_add_f32 v52, v52, v54
  v_add_f32 v53, v53, v55
  v_cvt_pk_bf16_f32 v54, v52, v53
  ds_write_b32 v108, v54
  v_permlane32_swap_b32 v56, v58
  v_permlane32_swap_b32 v57, v59
  v_add_f32 v56, v56, v58
  v_add_f32 v57, v57, v59
  v_cvt_pk_bf16_f32 v58, v56, v57
  ds_write_b32 v109, v58
  v_permlane32_swap_b32 v60, v62
  v_permlane32_swap_b32 v61, v63
  v_add_f32 v60, v60, v62
  v_add_f32 v61, v61, v63
  v_cvt_pk_bf16_f32 v62, v60, v61
  ds_write_b32 v110, v62
  s_branch cB_va3_t2d
cB_va3_vor:
  s_sleep 2
  buffer_load_dword v101, off, s[8:11], s27 sc1
  s_add_u32 s30, s30, 1
  s_cmp_lt_u32 s30, 400000
  s_cbranch_scc1 cB_va3_vow
  s_branch cB_abort
cB_abort:
  v_mov_b32 v4, 0xdead
  v_mov_b32 v5, 16
  buffer_store_dword v4, v5, s[12:15], 0 offen
  s_branch ch_end
cB_done:
  s_branch ch_end
ch_worker:
  s_sub_u32 s35, s3, 2
  s_and_b32 s35, s35, 7
  s_lshr_b32 s36, s2, 3
  s_lshl_b32 s33, s35, 5
  s_add_u32 s33, s33, s36
  s_mov_b32 s97, 0
  s_mov_b32 s96, 0
  s_mov_b32 s37, 0
  s_mov_b32 s38, 0
  s_mov_b32 s39, 0xffff0000
  s_mov_b32 s101, -1
  v_and_b32 v1, 63, v0
  v_lshlrev_b32 v2, 4, v1
  v_lshrrev_b32 v3, 4, v1
  v_and_b32 v4, 15, v1
  s_cmp_ge_u32 s33, 224
  s_cbranch_scc1 wp_all
  s_mov_b32 s68, s44
  s_and_b32 s69, s45, 0xffff
  s_mov_b32 s70, 3670016
  s_mov_b32 s71, 0x20000
  s_and_b32 s20, s33, 0xe0
  s_mul_i32 s20, s20, 9363
  s_lshr_b32 s20, s20, 16
  s_lshl_b32 s20, s20, 10
  s_and_b32 s21, s33, 31
  s_mul_i32 s21, s21, 192
  s_add_u32 s20, s20, s21
  v_min_u32 v7, 191, v0
  v_add_u32 v7, s20, v7
  v_lshrrev_b32 v8, 11, v7
  v_min_u32 v8, 15, v8
  v_bfe_u32 v9, v7, 2, 9
  v_lshlrev_b32 v9, 13, v9
  v_lshl_add_u32 v9, v8, 9, v9
  v_and_b32 v7, 3, v7
  v_lshl_add_u32 v9, v7, 7, v9
  buffer_load_dword v253, v9, s[68:71], 0 offen
  s_mov_b32 s68, s40
  s_and_b32 s69, s41, 0xffff
  s_mov_b32 s70, 3670016
  s_mov_b32 s71, 0x20000
  s_and_b32 s20, s33, 0xe0
  s_mul_i32 s20, s20, 9363
  s_lshr_b32 s20, s20, 16
  s_lshl_b32 s20, s20, 10
  s_and_b32 s21, s33, 31
  s_mul_i32 s21, s21, 192
  s_add_u32 s20, s20, s21
  v_min_u32 v7, 191, v0
  v_add_u32 v7, s20, v7
  v_lshrrev_b32 v8, 11, v7
  v_min_u32 v8, 15, v8
  v_bfe_u32 v9, v7, 2, 9
  v_lshlrev_b32 v9, 13, v9
  v_lshl_add_u32 v9, v8, 9, v9
  v_and_b32 v7, 3, v7
  v_lshl_add_u32 v9, v7, 7, v9
  buffer_load_dword v253, v9, s[68:71], 0 offen
  v_lshrrev_b32 v5, 5, v1
  v_and_b32 v6, 31, v1
  v_xor_b32 v8, v6, v5
  v_lshlrev_b32 v8, 4, v8
  v_lshl_add_u32 v16, v5, 13, v8
  v_xor_b32 v17, 32, v16
  v_xor_b32 v18, 64, v16
  v_xor_b32 v19, 96, v16
  v_xor_b32 v20, 128, v16
  v_xor_b32 v21, 160, v16
  v_xor_b32 v22, 192, v16
  v_xor_b32 v23, 224, v16
  s_lshl_b32 s20, s16, 6
  v_xor_b32 v26, s20, v16
  v_xor_b32 v27, 32, v26
wp_B:
  s_mul_i32 s17, s33, 4682
  s_lshr_b32 s17, s17, 16
  s_mul_i32 s23, s17, 14
  s_sub_u32 s19, s33, s23
  s_cmp_lt_u32 s19, 7
  s_cselect_b32 s18, 0, 7
  s_cselect_b32 s28, 0, 8
  s_sub_u32 s18, s19, s18
  s_add_u32 s28, s28, s16
  s_lshl_b32 s25, s16, 15
  s_add_u32 s25, s25, 32768
  s_lshl_b32 s26, s17, 9
  s_lshl_b32 s20, s33, 2
  s_add_u32 s20, s20, s16
  s_mul_i32 s21, s20, 9363
  s_lshr_b32 s21, s21, 16
  s_mul_i32 s22, s21, 7
  s_sub_u32 s22, s20, s22
  s_mul_i32 s21, s21, 14336
  s_lshl_b32 s20, s22, 7
  s_add_u32 s20, s20, s21
  s_lshl_b32 s22, s22, 11
  s_add_u32 s52, s21, s22
  s_mov_b32 s68, s48
  s_and_b32 s69, s49, 0xffff
  s_mov_b32 s70, 1835008
  s_mov_b32 s71, 0x20000
  v_mul_u32_u24 v7, 896, v4
  v_lshl_add_u32 v7, v3, 5, v7
  buffer_load_dwordx4 v[128:131], v7, s[68:71], s20 offen
  buffer_load_dwordx4 v[132:135], v7, s[68:71], s20 offen offset:16
  s_mov_b32 s60, s44
  s_and_b32 s61, s45, 0xffff
  s_mov_b32 s62, 3670016
  s_mov_b32 s63, 0x20000
  s_mov_b32 s56, s46
  s_and_b32 s57, s47, 0xffff
  s_mov_b32 s58, 3670016
  s_mov_b32 s59, 0x20000
  s_mul_i32 s27, s17, 229376
  s_lshl_b32 s30, s18, 7
  s_add_u32 s27, s27, s30
  s_mul_i32 s30, s16, 57344
  s_add_u32 s27, s27, s30
  v_lshrrev_b32 v7, 3, v1
  v_and_b32 v8, 7, v1
  v_and_b32 v9, 2, v7
  v_xor_b32 v8, v8, v9
  v_mul_u32_u24 v7, 896, v7
  v_lshl_add_u32 v24, v8, 4, v7
  v_xor_b32 v25, 64, v24
  s_lshl_b32 s30, s16, 13
  s_add_u32 m0, s30, 0
  s_nop 0
  buffer_load_dwordx4 v24, s[56:59], s27 offen  lds
  s_add_u32 s27, s27, 7168
  s_add_u32 m0, s30, 1024
  s_nop 0
  buffer_load_dwordx4 v25, s[56:59], s27 offen  lds
  s_add_u32 s27, s27, 7168
  s_add_u32 m0, s30, 2048
  s_nop 0
  buffer_load_dwordx4 v24, s[56:59], s27 offen  lds
  s_add_u32 s27, s27, 7168
  s_add_u32 m0, s30, 3072
  s_nop 0
  buffer_load_dwordx4 v25, s[56:59], s27 offen  lds
  s_add_u32 s27, s27, 7168
  s_add_u32 m0, s30, 4096
  s_nop 0
  buffer_load_dwordx4 v24, s[56:59], s27 offen  lds
  s_add_u32 s27, s27, 7168
  s_add_u32 m0, s30, 5120
  s_nop 0
  buffer_load_dwordx4 v25, s[56:59], s27 offen  lds
  s_add_u32 s27, s27, 7168
  s_add_u32 m0, s30, 6144
  s_nop 0
  buffer_load_dwordx4 v24, s[56:59], s27 offen  lds
  s_add_u32 s27, s27, 7168
  s_add_u32 m0, s30, 7168
  s_nop 0
  buffer_load_dwordx4 v25, s[56:59], s27 offen  lds
  s_add_u32 s27, s27, 7168
  s_add_u32 s27, s28, 0
  s_min_u32 s27, s27, 13
  s_lshl_b32 s27, s27, 18
  s_add_u32 s27, s27, s26
  s_mov_b32 s55, s27
  v_lshrrev_b32 v7, 2, v4
  v_lshlrev_b32 v11, 4, v7
  v_lshlrev_b32 v7, 3, v7
  v_and_b32 v8, 3, v4
  v_add_u32 v7, v7, v8
  v_and_b32 v8, 2, v4
  v_lshl_add_u32 v11, v8, 1, v11
  v_and_b32 v8, 1, v4
  v_add_u32 v11, v11, v8
  v_or_b32 v10, 0, v3
  v_xor_b32 v10, v10, v4
  v_lshlrev_b32 v10, 4, v10
  v_lshl_add_u32 v44, v11, 9, v10
  v_lshl_add_u32 v10, v7, 9, v10
  v_add_u32 v32, s25, v10
  v_or_b32 v10, 4, v3
  v_xor_b32 v10, v10, v4
  v_lshlrev_b32 v10, 4, v10
  v_lshl_add_u32 v45, v11, 9, v10
  v_lshl_add_u32 v10, v7, 9, v10
  v_add_u32 v33, s25, v10
  v_or_b32 v10, 8, v3
  v_xor_b32 v10, v10, v4
  v_lshlrev_b32 v10, 4, v10
  v_lshl_add_u32 v46, v11, 9, v10
  v_lshl_add_u32 v10, v7, 9, v10
  v_add_u32 v34, s25, v10
  v_or_b32 v10, 12, v3
  v_xor_b32 v10, v10, v4
  v_lshlrev_b32 v10, 4, v10
  v_lshl_add_u32 v47, v11, 9, v10
  v_lshl_add_u32 v10, v7, 9, v10
  v_add_u32 v35, s25, v10
  s_mul_i32 s30, s17, 401408
  s_mul_i32 s31, s18, 57344
  s_add_u32 s30, s30, s31
  s_add_u32 s30, s30, 33554432
  v_add_u32 v28, s30, v2
  s_add_u32 s30, s30, 14336
  v_add_u32 v29, s30, v2
  s_add_u32 s30, s30, 14336
  v_add_u32 v30, s30, v2
  s_add_u32 s30, s30, 14336
  v_add_u32 v31, s30, v2
  s_add_u32 s30, s30, 14336
  v_mov_b32 v48, 1035512379
  v_lshrrev_b32 v7, 2, v4
  v_lshl_add_u32 v7, v3, 3, v7
  v_lshlrev_b32 v7, 7, v7
  v_and_b32 v8, 3, v4
  v_lshl_add_u32 v7, v8, 3, v7
  v_lshrrev_b32 v8, 3, v4
  v_and_b32 v9, 1, v3
  v_lshl_add_u32 v8, v9, 1, v8
  v_lshl_add_u32 v40, v8, 5, v7
  s_mul_i32 s31, s17, 28
  s_mov_b32 s29, 401408
  s_lshl_b32 s30, s18, 6
  s_add_u32 s30, s30, 0
  v_add_u32 v8, s30, v4
  v_subrev_u32 v9, 256, v8
  v_mul_u32_u24 v11, 171, v9
  v_lshrrev_b32 v11, 11, v11
  v_mul_u32_u24 v38, 12, v11
  v_sub_u32 v38, v9, v38
  v_add_u32 v38, 16, v38
  v_lshrrev_b32 v10, 4, v8
  v_cmp_gt_i32 vcc, 0, v9
  s_nop 1
  v_cndmask_b32 v10, v11, v10, vcc
  v_cndmask_b32 v39, v38, v4, vcc
  v_add_u32 v39, s31, v39
  v_lshrrev_b32 v38, 4, v39
  v_and_b32 v39, 15, v39
  v_mul_lo_u32 v10, v10, s29
  v_mul_u32_u24 v38, 14336, v38
  v_add_u32 v10, v10, v38
  v_lshl_add_u32 v10, v3, 8, v10
  v_lshl_add_u32 v10, v39, 4, v10
  v_add_u32 v12, 39976960, v10
  v_xor_b32 v41, 32, v40
  s_lshl_b32 s30, s18, 6
  s_add_u32 s30, s30, 16
  v_add_u32 v8, s30, v4
  v_subrev_u32 v9, 256, v8
  v_mul_u32_u24 v11, 171, v9
  v_lshrrev_b32 v11, 11, v11
  v_mul_u32_u24 v38, 12, v11
  v_sub_u32 v38, v9, v38
  v_add_u32 v38, 16, v38
  v_lshrrev_b32 v10, 4, v8
  v_cmp_gt_i32 vcc, 0, v9
  s_nop 1
  v_cndmask_b32 v10, v11, v10, vcc
  v_cndmask_b32 v39, v38, v4, vcc
  v_add_u32 v39, s31, v39
  v_lshrrev_b32 v38, 4, v39
  v_and_b32 v39, 15, v39
  v_mul_lo_u32 v10, v10, s29
  v_mul_u32_u24 v38, 14336, v38
  v_add_u32 v10, v10, v38
  v_lshl_add_u32 v10, v3, 8, v10
  v_lshl_add_u32 v10, v39, 4, v10
  v_add_u32 v13, 39976960, v10
  v_xor_b32 v42, 64, v40
  s_lshl_b32 s30, s18, 6
  s_add_u32 s30, s30, 32
  v_add_u32 v8, s30, v4
  v_subrev_u32 v9, 256, v8
  v_mul_u32_u24 v11, 171, v9
  v_lshrrev_b32 v11, 11, v11
  v_mul_u32_u24 v38, 12, v11
  v_sub_u32 v38, v9, v38
  v_add_u32 v38, 16, v38
  v_lshrrev_b32 v10, 4, v8
  v_cmp_gt_i32 vcc, 0, v9
  s_nop 1
  v_cndmask_b32 v10, v11, v10, vcc
  v_cndmask_b32 v39, v38, v4, vcc
  v_add_u32 v39, s31, v39
  v_lshrrev_b32 v38, 4, v39
  v_and_b32 v39, 15, v39
  v_mul_lo_u32 v10, v10, s29
  v_mul_u32_u24 v38, 14336, v38
  v_add_u32 v10, v10, v38
  v_lshl_add_u32 v10, v3, 8, v10
  v_lshl_add_u32 v10, v39, 4, v10
  v_add_u32 v14, 39976960, v10
  v_xor_b32 v43, 96, v40
  s_lshl_b32 s30, s18, 6
  s_add_u32 s30, s30, 48
  v_add_u32 v8, s30, v4
  v_subrev_u32 v9, 256, v8
  v_mul_u32_u24 v11, 171, v9
  v_lshrrev_b32 v11, 11, v11
  v_mul_u32_u24 v38, 12, v11
  v_sub_u32 v38, v9, v38
  v_add_u32 v38, 16, v38
  v_lshrrev_b32 v10, 4, v8
  v_cmp_gt_i32 vcc, 0, v9
  s_nop 1
  v_cndmask_b32 v10, v11, v10, vcc
  v_cndmask_b32 v39, v38, v4, vcc
  v_add_u32 v39, s31, v39
  v_lshrrev_b32 v38, 4, v39
  v_and_b32 v39, 15, v39
  v_mul_lo_u32 v10, v10, s29
  v_mul_u32_u24 v38, 14336, v38
  v_add_u32 v10, v10, v38
  v_lshl_add_u32 v10, v3, 8, v10
  v_lshl_add_u32 v10, v39, 4, v10
  v_add_u32 v15, 39976960, v10
  s_mov_b32 s27, s55
  s_add_u32 m0, s25, 0
  s_nop 0
  buffer_load_dwordx4 v16, s[60:63], s27 offen  lds
  s_add_u32 s27, s27, 16384
  s_add_u32 m0, s25, 1024
  s_nop 0
  buffer_load_dwordx4 v17, s[60:63], s27 offen  lds
  s_add_u32 s27, s27, 16384
  s_add_u32 m0, s25, 2048
  s_nop 0
  buffer_load_dwordx4 v16, s[60:63], s27 offen  lds
  s_add_u32 s27, s27, 16384
  s_add_u32 m0, s25, 3072
  s_nop 0
  buffer_load_dwordx4 v17, s[60:63], s27 offen  lds
  s_add_u32 s27, s27, 16384
  s_add_u32 m0, s25, 4096
  s_nop 0
  buffer_load_dwordx4 v18, s[60:63], s27 offen  lds
  s_add_u32 s27, s27, 16384
  s_add_u32 m0, s25, 5120
  s_nop 0
  buffer_load_dwordx4 v19, s[60:63], s27 offen  lds
  s_add_u32 s27, s27, 16384
  s_add_u32 m0, s25, 6144
  s_nop 0
  buffer_load_dwordx4 v18, s[60:63], s27 offen  lds
  s_add_u32 s27, s27, 16384
  s_add_u32 m0, s25, 7168
  s_nop 0
  buffer_load_dwordx4 v19, s[60:63], s27 offen  lds
  s_add_u32 s27, s27, 16384
  s_add_u32 m0, s25, 8192
  s_nop 0
  buffer_load_dwordx4 v20, s[60:63], s27 offen  lds
  s_add_u32 s27, s27, 16384
  s_add_u32 m0, s25, 9216
  s_nop 0
  buffer_load_dwordx4 v21, s[60:63], s27 offen  lds
  s_add_u32 s27, s27, 16384
  s_add_u32 m0, s25, 10240
  s_nop 0
  buffer_load_dwordx4 v20, s[60:63], s27 offen  lds
  s_add_u32 s27, s27, 16384
  s_add_u32 m0, s25, 11264
  s_nop 0
  buffer_load_dwordx4 v21, s[60:63], s27 offen  lds
  s_add_u32 s27, s27, 16384
  s_add_u32 m0, s25, 12288
  s_nop 0
  buffer_load_dwordx4 v22, s[60:63], s27 offen  lds
  s_add_u32 s27, s27, 16384
  s_add_u32 m0, s25, 13312
  s_nop 0
  buffer_load_dwordx4 v23, s[60:63], s27 offen  lds
  s_add_u32 s27, s27, 16384
  s_add_u32 m0, s25, 14336
  s_nop 0
  buffer_load_dwordx4 v22, s[60:63], s27 offen  lds
  s_add_u32 s27, s27, 16384
  s_add_u32 m0, s25, 15360
  s_nop 0
  buffer_load_dwordx4 v23, s[60:63], s27 offen  lds
  s_add_u32 s27, s27, 16384
  s_add_u32 s27, s28, 4
  s_min_u32 s27, s27, 13
  s_lshl_b32 s27, s27, 18
  s_add_u32 s27, s27, s26
  s_add_u32 m0, s25, 16384
  s_nop 0
  buffer_load_dwordx4 v16, s[60:63], s27 offen  lds
  s_add_u32 s27, s27, 16384
  s_add_u32 m0, s25, 17408
  s_nop 0
  buffer_load_dwordx4 v17, s[60:63], s27 offen  lds
  s_add_u32 s27, s27, 16384
  s_add_u32 m0, s25, 18432
  s_nop 0
  buffer_load_dwordx4 v16, s[60:63], s27 offen  lds
  s_add_u32 s27, s27, 16384
  s_add_u32 m0, s25, 19456
  s_nop 0
  buffer_load_dwordx4 v17, s[60:63], s27 offen  lds
  s_add_u32 s27, s27, 16384
  s_add_u32 m0, s25, 20480
  s_nop 0
  buffer_load_dwordx4 v18, s[60:63], s27 offen  lds
  s_add_u32 s27, s27, 16384
  s_add_u32 m0, s25, 21504
  s_nop 0
  buffer_load_dwordx4 v19, s[60:63], s27 offen  lds
  s_add_u32 s27, s27, 16384
  s_add_u32 m0, s25, 22528
  s_nop 0
  buffer_load_dwordx4 v18, s[60:63], s27 offen  lds
  s_add_u32 s27, s27, 16384
  s_add_u32 m0, s25, 23552
  s_nop 0
  buffer_load_dwordx4 v19, s[60:63], s27 offen  lds
  s_add_u32 s27, s27, 16384
  s_add_u32 m0, s25, 24576
  s_nop 0
  buffer_load_dwordx4 v20, s[60:63], s27 offen  lds
  s_add_u32 s27, s27, 16384
  s_add_u32 m0, s25, 25600
  s_nop 0
  buffer_load_dwordx4 v21, s[60:63], s27 offen  lds
  s_add_u32 s27, s27, 16384
  s_add_u32 m0, s25, 26624
  s_nop 0
  buffer_load_dwordx4 v20, s[60:63], s27 offen  lds
  s_add_u32 s27, s27, 16384
  s_add_u32 m0, s25, 27648
  s_nop 0
  buffer_load_dwordx4 v21, s[60:63], s27 offen  lds
  s_add_u32 s27, s27, 16384
  s_add_u32 m0, s25, 28672
  s_nop 0
  buffer_load_dwordx4 v22, s[60:63], s27 offen  lds
  s_add_u32 s27, s27, 16384
  s_add_u32 m0, s25, 29696
  s_nop 0
  buffer_load_dwordx4 v23, s[60:63], s27 offen  lds
  s_add_u32 s27, s27, 16384
  s_add_u32 m0, s25, 30720
  s_nop 0
  buffer_load_dwordx4 v22, s[60:63], s27 offen  lds
  s_add_u32 s27, s27, 16384
  s_add_u32 m0, s25, 31744
  s_nop 0
  buffer_load_dwordx4 v23, s[60:63], s27 offen  lds
  s_add_u32 s27, s27, 16384
  s_cmp_lt_u32 s18, 4
  s_cselect_b32 s34, 1, s97
  s_mov_b32 s68, s42
  s_and_b32 s69, s43, 0xffff
  s_mov_b32 s70, 3670016
  s_mov_b32 s71, 0x20000
  s_lshl_b32 s27, s18, 19
  s_add_u32 s27, s27, s26
  s_cmp_lg_u32 s34, 0
  s_cselect_b32 s27, 0x40000000, s27
  v_lshrrev_b32 v7, 2, v0
  v_and_b32 v8, 3, v0
  v_lshlrev_b32 v8, 7, v8
  v_lshl_add_u32 v9, v7, 13, v8
  buffer_load_dword v253, v9, s[68:71], s27 offen
  s_lshl_b32 s29, s28, 10
  s_add_u32 s31, s29, 4096
  s_cmp_lt_u32 s28, 10
  s_cselect_b32 s31, s31, 0x40000000
  s_waitcnt vmcnt(1)
  s_barrier
  ds_read_b64_tr_b16 a[0:1], v40 offset:0
  ds_read_b64_tr_b16 a[2:3], v40 offset:512
  ds_read_b64_tr_b16 a[32:33], v41 offset:0
  ds_read_b64_tr_b16 a[34:35], v41 offset:512
  ds_read_b64_tr_b16 a[64:65], v42 offset:0
  ds_read_b64_tr_b16 a[66:67], v42 offset:512
  ds_read_b64_tr_b16 a[96:97], v43 offset:0
  ds_read_b64_tr_b16 a[98:99], v43 offset:512
  ds_read_b128 a[128:131], v32 offset:0
  ds_read_b128 a[160:163], v32 offset:2048
  ds_read_b128 a[192:195], v32 offset:16384
  ds_read_b128 a[224:227], v32 offset:18432
  v_lshlrev_b32 v144, 9, v3
  v_lshl_add_u32 v144, v4, 4, v144
  s_add_u32 s53, s52, 75759616
  s_add_u32 s52, s52, 655360
  v_mov_b32 v136, v128
  v_mov_b32 v140, v129
  v_mov_b32 v137, v130
  v_mov_b32 v141, v131
  v_mov_b32 v138, v132
  v_mov_b32 v142, v133
  v_mov_b32 v139, v134
  v_mov_b32 v143, v135
  buffer_store_dwordx4 v[128:131], v144, s[8:11], s52 offen sc1
  buffer_store_dwordx4 v[132:135], v144, s[8:11], s52 offen offset:256 sc1
  buffer_store_dwordx4 v[136:139], v2, s[8:11], s53 offen sc1
  buffer_store_dwordx4 v[140:143], v2, s[8:11], s53 offen offset:1024 sc1
  s_waitcnt lgkmcnt(0)
  v_mfma_f32_16x16x32_bf16 v[64:67], a[128:131], a[0:3], 0
  ds_read_b64_tr_b16 a[4:5], v40 offset:4096
  ds_read_b64_tr_b16 a[6:7], v40 offset:4608
  v_mfma_f32_16x16x32_bf16 v[68:71], a[160:163], a[0:3], 0
  ds_read_b64_tr_b16 a[36:37], v41 offset:4096
  ds_read_b64_tr_b16 a[38:39], v41 offset:4608
  v_mfma_f32_16x16x32_bf16 v[72:75], a[128:131], a[32:35], 0
  ds_read_b64_tr_b16 a[68:69], v42 offset:4096
  ds_read_b64_tr_b16 a[70:71], v42 offset:4608
  v_mfma_f32_16x16x32_bf16 v[76:79], a[160:163], a[32:35], 0
  ds_read_b64_tr_b16 a[100:101], v43 offset:4096
  ds_read_b64_tr_b16 a[102:103], v43 offset:4608
  v_mfma_f32_16x16x32_bf16 v[80:83], a[128:131], a[64:67], 0
  ds_read_b128 a[132:135], v33 offset:0
  ds_read_b128 a[164:167], v33 offset:2048
  v_mfma_f32_16x16x32_bf16 v[84:87], a[160:163], a[64:67], 0
  ds_read_b128 a[196:199], v33 offset:16384
  ds_read_b128 a[228:231], v33 offset:18432
  v_mfma_f32_16x16x32_bf16 v[88:91], a[128:131], a[96:99], 0
  v_mfma_f32_16x16x32_bf16 v[92:95], a[160:163], a[96:99], 0
  v_mfma_f32_16x16x32_bf16 v[96:99], a[192:195], a[0:3], 0
  v_mfma_f32_16x16x32_bf16 v[100:103], a[224:227], a[0:3], 0
  v_mfma_f32_16x16x32_bf16 v[104:107], a[192:195], a[32:35], 0
  v_mfma_f32_16x16x32_bf16 v[108:111], a[224:227], a[32:35], 0
  v_mfma_f32_16x16x32_bf16 v[112:115], a[192:195], a[64:67], 0
  v_mfma_f32_16x16x32_bf16 v[116:119], a[224:227], a[64:67], 0
  v_mfma_f32_16x16x32_bf16 v[120:123], a[192:195], a[96:99], 0
  v_mfma_f32_16x16x32_bf16 v[124:127], a[224:227], a[96:99], 0
  s_waitcnt lgkmcnt(0)
  v_mfma_f32_16x16x32_bf16 v[64:67], a[132:135], a[4:7], v[64:67]
  ds_read_b64_tr_b16 a[8:9], v40 offset:8192
  ds_read_b64_tr_b16 a[10:11], v40 offset:8704
  v_mfma_f32_16x16x32_bf16 v[68:71], a[164:167], a[4:7], v[68:71]
  ds_read_b64_tr_b16 a[40:41], v41 offset:8192
  ds_read_b64_tr_b16 a[42:43], v41 offset:8704
  v_mfma_f32_16x16x32_bf16 v[72:75], a[132:135], a[36:39], v[72:75]
  ds_read_b64_tr_b16 a[72:73], v42 offset:8192
  ds_read_b64_tr_b16 a[74:75], v42 offset:8704
  v_mfma_f32_16x16x32_bf16 v[76:79], a[164:167], a[36:39], v[76:79]
  ds_read_b64_tr_b16 a[104:105], v43 offset:8192
  ds_read_b64_tr_b16 a[106:107], v43 offset:8704
  v_mfma_f32_16x16x32_bf16 v[80:83], a[132:135], a[68:71], v[80:83]
  ds_read_b128 a[136:139], v34 offset:0
  ds_read_b128 a[168:171], v34 offset:2048
  v_mfma_f32_16x16x32_bf16 v[84:87], a[164:167], a[68:71], v[84:87]
  ds_read_b128 a[200:203], v34 offset:16384
  ds_read_b128 a[232:235], v34 offset:18432
  v_mfma_f32_16x16x32_bf16 v[88:91], a[132:135], a[100:103], v[88:91]
  v_mfma_f32_16x16x32_bf16 v[92:95], a[164:167], a[100:103], v[92:95]
  v_mfma_f32_16x16x32_bf16 v[96:99], a[196:199], a[4:7], v[96:99]
  v_mfma_f32_16x16x32_bf16 v[100:103], a[228:231], a[4:7], v[100:103]
  v_mfma_f32_16x16x32_bf16 v[104:107], a[196:199], a[36:39], v[104:107]
  v_mfma_f32_16x16x32_bf16 v[108:111], a[228:231], a[36:39], v[108:111]
  v_mfma_f32_16x16x32_bf16 v[112:115], a[196:199], a[68:71], v[112:115]
  v_mfma_f32_16x16x32_bf16 v[116:119], a[228:231], a[68:71], v[116:119]
  v_mfma_f32_16x16x32_bf16 v[120:123], a[196:199], a[100:103], v[120:123]
  v_mfma_f32_16x16x32_bf16 v[124:127], a[228:231], a[100:103], v[124:127]
  s_waitcnt lgkmcnt(0)
  v_mfma_f32_16x16x32_bf16 v[64:67], a[136:139], a[8:11], v[64:67]
  ds_read_b64_tr_b16 a[12:13], v40 offset:12288
  ds_read_b64_tr_b16 a[14:15], v40 offset:12800
  v_mfma_f32_16x16x32_bf16 v[68:71], a[168:171], a[8:11], v[68:71]
  ds_read_b64_tr_b16 a[44:45], v41 offset:12288
  ds_read_b64_tr_b16 a[46:47], v41 offset:12800
  v_mfma_f32_16x16x32_bf16 v[72:75], a[136:139], a[40:43], v[72:75]
  ds_read_b64_tr_b16 a[76:77], v42 offset:12288
  ds_read_b64_tr_b16 a[78:79], v42 offset:12800
  v_mfma_f32_16x16x32_bf16 v[76:79], a[168:171], a[40:43], v[76:79]
  ds_read_b64_tr_b16 a[108:109], v43 offset:12288
  ds_read_b64_tr_b16 a[110:111], v43 offset:12800
  v_mfma_f32_16x16x32_bf16 v[80:83], a[136:139], a[72:75], v[80:83]
  ds_read_b128 a[140:143], v35 offset:0
  ds_read_b128 a[172:175], v35 offset:2048
  v_mfma_f32_16x16x32_bf16 v[84:87], a[168:171], a[72:75], v[84:87]
  ds_read_b128 a[204:207], v35 offset:16384
  ds_read_b128 a[236:239], v35 offset:18432
  v_mfma_f32_16x16x32_bf16 v[88:91], a[136:139], a[104:107], v[88:91]
  v_mfma_f32_16x16x32_bf16 v[92:95], a[168:171], a[104:107], v[92:95]
  v_mfma_f32_16x16x32_bf16 v[96:99], a[200:203], a[8:11], v[96:99]
  v_mfma_f32_16x16x32_bf16 v[100:103], a[232:235], a[8:11], v[100:103]
  v_mfma_f32_16x16x32_bf16 v[104:107], a[200:203], a[40:43], v[104:107]
  v_mfma_f32_16x16x32_bf16 v[108:111], a[232:235], a[40:43], v[108:111]
  v_mfma_f32_16x16x32_bf16 v[112:115], a[200:203], a[72:75], v[112:115]
  v_mfma_f32_16x16x32_bf16 v[116:119], a[232:235], a[72:75], v[116:119]
  v_mfma_f32_16x16x32_bf16 v[120:123], a[200:203], a[104:107], v[120:123]
  v_mfma_f32_16x16x32_bf16 v[124:127], a[232:235], a[104:107], v[124:127]
  s_waitcnt lgkmcnt(0)
  v_mfma_f32_16x16x32_bf16 v[64:67], a[140:143], a[12:15], v[64:67]
  ds_read_b64_tr_b16 a[16:17], v40 offset:16384
  ds_read_b64_tr_b16 a[18:19], v40 offset:16896
  v_mfma_f32_16x16x32_bf16 v[68:71], a[172:175], a[12:15], v[68:71]
  ds_read_b64_tr_b16 a[48:49], v41 offset:16384
  ds_read_b64_tr_b16 a[50:51], v41 offset:16896
  v_mfma_f32_16x16x32_bf16 v[72:75], a[140:143], a[44:47], v[72:75]
  ds_read_b64_tr_b16 a[80:81], v42 offset:16384
  ds_read_b64_tr_b16 a[82:83], v42 offset:16896
  v_mfma_f32_16x16x32_bf16 v[76:79], a[172:175], a[44:47], v[76:79]
  ds_read_b64_tr_b16 a[112:113], v43 offset:16384
  ds_read_b64_tr_b16 a[114:115], v43 offset:16896
  v_mfma_f32_16x16x32_bf16 v[80:83], a[140:143], a[76:79], v[80:83]
  ds_read_b128 a[144:147], v32 offset:256
  ds_read_b128 a[176:179], v32 offset:2304
  v_mfma_f32_16x16x32_bf16 v[84:87], a[172:175], a[76:79], v[84:87]
  ds_read_b128 a[208:211], v32 offset:16640
  ds_read_b128 a[240:243], v32 offset:18688
  v_mfma_f32_16x16x32_bf16 v[88:91], a[140:143], a[108:111], v[88:91]
  v_mfma_f32_16x16x32_bf16 v[92:95], a[172:175], a[108:111], v[92:95]
  v_mfma_f32_16x16x32_bf16 v[96:99], a[204:207], a[12:15], v[96:99]
  v_mfma_f32_16x16x32_bf16 v[100:103], a[236:239], a[12:15], v[100:103]
  v_mfma_f32_16x16x32_bf16 v[104:107], a[204:207], a[44:47], v[104:107]
  v_mfma_f32_16x16x32_bf16 v[108:111], a[236:239], a[44:47], v[108:111]
  v_mfma_f32_16x16x32_bf16 v[112:115], a[204:207], a[76:79], v[112:115]
  v_mfma_f32_16x16x32_bf16 v[116:119], a[236:239], a[76:79], v[116:119]
  v_mfma_f32_16x16x32_bf16 v[120:123], a[204:207], a[108:111], v[120:123]
  v_mfma_f32_16x16x32_bf16 v[124:127], a[236:239], a[108:111], v[124:127]
  s_waitcnt lgkmcnt(0)
  v_mfma_f32_16x16x32_bf16 v[64:67], a[144:147], a[16:19], v[64:67]
  ds_read_b64_tr_b16 a[20:21], v40 offset:20480
  ds_read_b64_tr_b16 a[22:23], v40 offset:20992
  v_mfma_f32_16x16x32_bf16 v[68:71], a[176:179], a[16:19], v[68:71]
  ds_read_b64_tr_b16 a[52:53], v41 offset:20480
  ds_read_b64_tr_b16 a[54:55], v41 offset:20992
  v_mfma_f32_16x16x32_bf16 v[72:75], a[144:147], a[48:51], v[72:75]
  ds_read_b64_tr_b16 a[84:85], v42 offset:20480
  ds_read_b64_tr_b16 a[86:87], v42 offset:20992
  v_mfma_f32_16x16x32_bf16 v[76:79], a[176:179], a[48:51], v[76:79]
  ds_read_b64_tr_b16 a[116:117], v43 offset:20480
  ds_read_b64_tr_b16 a[118:119], v43 offset:20992
  v_mfma_f32_16x16x32_bf16 v[80:83], a[144:147], a[80:83], v[80:83]
  ds_read_b128 a[148:151], v33 offset:256
  ds_read_b128 a[180:183], v33 offset:2304
  v_mfma_f32_16x16x32_bf16 v[84:87], a[176:179], a[80:83], v[84:87]
  ds_read_b128 a[212:215], v33 offset:16640
  ds_read_b128 a[244:247], v33 offset:18688
  v_mfma_f32_16x16x32_bf16 v[88:91], a[144:147], a[112:115], v[88:91]
  v_mfma_f32_16x16x32_bf16 v[92:95], a[176:179], a[112:115], v[92:95]
  v_mfma_f32_16x16x32_bf16 v[96:99], a[208:211], a[16:19], v[96:99]
  v_mfma_f32_16x16x32_bf16 v[100:103], a[240:243], a[16:19], v[100:103]
  v_mfma_f32_16x16x32_bf16 v[104:107], a[208:211], a[48:51], v[104:107]
  v_mfma_f32_16x16x32_bf16 v[108:111], a[240:243], a[48:51], v[108:111]
  v_mfma_f32_16x16x32_bf16 v[112:115], a[208:211], a[80:83], v[112:115]
  v_mfma_f32_16x16x32_bf16 v[116:119], a[240:243], a[80:83], v[116:119]
  v_mfma_f32_16x16x32_bf16 v[120:123], a[208:211], a[112:115], v[120:123]
  v_mfma_f32_16x16x32_bf16 v[124:127], a[240:243], a[112:115], v[124:127]
  s_waitcnt lgkmcnt(0)
  v_mfma_f32_16x16x32_bf16 v[64:67], a[148:151], a[20:23], v[64:67]
  ds_read_b64_tr_b16 a[24:25], v40 offset:24576
  ds_read_b64_tr_b16 a[26:27], v40 offset:25088
  v_mfma_f32_16x16x32_bf16 v[68:71], a[180:183], a[20:23], v[68:71]
  ds_read_b64_tr_b16 a[56:57], v41 offset:24576
  ds_read_b64_tr_b16 a[58:59], v41 offset:25088
  v_mfma_f32_16x16x32_bf16 v[72:75], a[148:151], a[52:55], v[72:75]
  ds_read_b64_tr_b16 a[88:89], v42 offset:24576
  ds_read_b64_tr_b16 a[90:91], v42 offset:25088
  v_mfma_f32_16x16x32_bf16 v[76:79], a[180:183], a[52:55], v[76:79]
  ds_read_b64_tr_b16 a[120:121], v43 offset:24576
  ds_read_b64_tr_b16 a[122:123], v43 offset:25088
  v_mfma_f32_16x16x32_bf16 v[80:83], a[148:151], a[84:87], v[80:83]
  ds_read_b128 a[152:155], v34 offset:256
  ds_read_b128 a[184:187], v34 offset:2304
  v_mfma_f32_16x16x32_bf16 v[84:87], a[180:183], a[84:87], v[84:87]
  ds_read_b128 a[216:219], v34 offset:16640
  ds_read_b128 a[248:251], v34 offset:18688
  v_mfma_f32_16x16x32_bf16 v[88:91], a[148:151], a[116:119], v[88:91]
  v_mfma_f32_16x16x32_bf16 v[92:95], a[180:183], a[116:119], v[92:95]
  v_mfma_f32_16x16x32_bf16 v[96:99], a[212:215], a[20:23], v[96:99]
  v_mfma_f32_16x16x32_bf16 v[100:103], a[244:247], a[20:23], v[100:103]
  v_mfma_f32_16x16x32_bf16 v[104:107], a[212:215], a[52:55], v[104:107]
  v_mfma_f32_16x16x32_bf16 v[108:111], a[244:247], a[52:55], v[108:111]
  v_mfma_f32_16x16x32_bf16 v[112:115], a[212:215], a[84:87], v[112:115]
  v_mfma_f32_16x16x32_bf16 v[116:119], a[244:247], a[84:87], v[116:119]
  v_mfma_f32_16x16x32_bf16 v[120:123], a[212:215], a[116:119], v[120:123]
  v_mfma_f32_16x16x32_bf16 v[124:127], a[244:247], a[116:119], v[124:127]
  s_waitcnt lgkmcnt(0)
  v_mfma_f32_16x16x32_bf16 v[64:67], a[152:155], a[24:27], v[64:67]
  ds_read_b64_tr_b16 a[28:29], v40 offset:28672
  ds_read_b64_tr_b16 a[30:31], v40 offset:29184
  v_mfma_f32_16x16x32_bf16 v[68:71], a[184:187], a[24:27], v[68:71]
  ds_read_b64_tr_b16 a[60:61], v41 offset:28672
  ds_read_b64_tr_b16 a[62:63], v41 offset:29184
  v_mfma_f32_16x16x32_bf16 v[72:75], a[152:155], a[56:59], v[72:75]
  ds_read_b64_tr_b16 a[92:93], v42 offset:28672
  ds_read_b64_tr_b16 a[94:95], v42 offset:29184
  v_mfma_f32_16x16x32_bf16 v[76:79], a[184:187], a[56:59], v[76:79]
  ds_read_b64_tr_b16 a[124:125], v43 offset:28672
  ds_read_b64_tr_b16 a[126:127], v43 offset:29184
  v_mfma_f32_16x16x32_bf16 v[80:83], a[152:155], a[88:91], v[80:83]
  ds_read_b128 a[156:159], v35 offset:256
  ds_read_b128 a[188:191], v35 offset:2304
  v_mfma_f32_16x16x32_bf16 v[84:87], a[184:187], a[88:91], v[84:87]
  ds_read_b128 a[220:223], v35 offset:16640
  ds_read_b128 a[252:255], v35 offset:18688
  v_mfma_f32_16x16x32_bf16 v[88:91], a[152:155], a[120:123], v[88:91]
  v_mfma_f32_16x16x32_bf16 v[92:95], a[184:187], a[120:123], v[92:95]
  v_mfma_f32_16x16x32_bf16 v[96:99], a[216:219], a[24:27], v[96:99]
  v_mfma_f32_16x16x32_bf16 v[100:103], a[248:251], a[24:27], v[100:103]
  v_mfma_f32_16x16x32_bf16 v[104:107], a[216:219], a[56:59], v[104:107]
  v_mfma_f32_16x16x32_bf16 v[108:111], a[248:251], a[56:59], v[108:111]
  v_mfma_f32_16x16x32_bf16 v[112:115], a[216:219], a[88:91], v[112:115]
  v_mfma_f32_16x16x32_bf16 v[116:119], a[248:251], a[88:91], v[116:119]
  v_mfma_f32_16x16x32_bf16 v[120:123], a[216:219], a[120:123], v[120:123]
  v_mfma_f32_16x16x32_bf16 v[124:127], a[248:251], a[120:123], v[124:127]
  s_waitcnt lgkmcnt(0)
  s_barrier
  buffer_load_dwordx2 v[254:255], v252, s[12:15], 0 offen offset:128 sc1
  buffer_load_dword v253, v252, s[12:15], 0 offen sc1
  v_mfma_f32_16x16x32_bf16 v[64:67], a[156:159], a[28:31], v[64:67]
  v_mfma_f32_16x16x32_bf16 v[68:71], a[188:191], a[28:31], v[68:71]
  v_mfma_f32_16x16x32_bf16 v[72:75], a[156:159], a[60:63], v[72:75]
  v_mfma_f32_16x16x32_bf16 v[76:79], a[188:191], a[60:63], v[76:79]
  v_mfma_f32_16x16x32_bf16 v[80:83], a[156:159], a[92:95], v[80:83]
  v_cvt_pk_bf16_f32 v64, v64, v65
  v_cvt_pk_bf16_f32 v65, v66, v67
  v_mfma_f32_16x16x32_bf16 v[84:87], a[188:191], a[92:95], v[84:87]
  v_cvt_pk_bf16_f32 v66, v68, v69
  v_cvt_pk_bf16_f32 v67, v70, v71
  v_mfma_f32_16x16x32_bf16 v[88:91], a[156:159], a[124:127], v[88:91]
  buffer_store_dwordx4 v[64:67], v12, s[8:11], s29 offen sc1
  v_cvt_pk_bf16_f32 v72, v72, v73
  v_mfma_f32_16x16x32_bf16 v[92:95], a[188:191], a[124:127], v[92:95]
  v_cvt_pk_bf16_f32 v73, v74, v75
  v_cvt_pk_bf16_f32 v74, v76, v77
  v_mfma_f32_16x16x32_bf16 v[96:99], a[220:223], a[28:31], v[96:99]
  v_cvt_pk_bf16_f32 v75, v78, v79
  buffer_store_dwordx4 v[72:75], v13, s[8:11], s29 offen sc1
  v_mfma_f32_16x16x32_bf16 v[100:103], a[252:255], a[28:31], v[100:103]
  v_cvt_pk_bf16_f32 v80, v80, v81
  v_cvt_pk_bf16_f32 v81, v82, v83
  v_mfma_f32_16x16x32_bf16 v[104:107], a[220:223], a[60:63], v[104:107]
  v_cvt_pk_bf16_f32 v82, v84, v85
  v_cvt_pk_bf16_f32 v83, v86, v87
  v_mfma_f32_16x16x32_bf16 v[108:111], a[252:255], a[60:63], v[108:111]
  buffer_store_dwordx4 v[80:83], v14, s[8:11], s29 offen sc1
  v_cvt_pk_bf16_f32 v88, v88, v89
  v_mfma_f32_16x16x32_bf16 v[112:115], a[220:223], a[92:95], v[112:115]
  v_cvt_pk_bf16_f32 v89, v90, v91
  v_cvt_pk_bf16_f32 v90, v92, v93
  v_mfma_f32_16x16x32_bf16 v[116:119], a[252:255], a[92:95], v[116:119]
  v_cvt_pk_bf16_f32 v91, v94, v95
  buffer_store_dwordx4 v[88:91], v15, s[8:11], s29 offen sc1
  v_mfma_f32_16x16x32_bf16 v[120:123], a[220:223], a[124:127], v[120:123]
  v_cvt_pk_bf16_f32 v96, v96, v97
  v_cvt_pk_bf16_f32 v97, v98, v99
  v_mfma_f32_16x16x32_bf16 v[124:127], a[252:255], a[124:127], v[124:127]
  v_cvt_pk_bf16_f32 v98, v100, v101
  v_cvt_pk_bf16_f32 v99, v102, v103
  buffer_store_dwordx4 v[96:99], v12, s[8:11], s31 offen sc1
  v_cvt_pk_bf16_f32 v104, v104, v105
  v_cvt_pk_bf16_f32 v105, v106, v107
  v_cvt_pk_bf16_f32 v106, v108, v109
  v_cvt_pk_bf16_f32 v107, v110, v111
  buffer_store_dwordx4 v[104:107], v13, s[8:11], s31 offen sc1
  v_cvt_pk_bf16_f32 v112, v112, v113
  v_cvt_pk_bf16_f32 v113, v114, v115
  v_cvt_pk_bf16_f32 v114, v116, v117
  v_cvt_pk_bf16_f32 v115, v118, v119
  buffer_store_dwordx4 v[112:115], v14, s[8:11], s31 offen sc1
  v_cvt_pk_bf16_f32 v120, v120, v121
  v_cvt_pk_bf16_f32 v121, v122, v123
  v_cvt_pk_bf16_f32 v122, v124, v125
  v_cvt_pk_bf16_f32 v123, v126, v127
  buffer_store_dwordx4 v[120:123], v15, s[8:11], s31 offen sc1
  s_cmp_lg_u32 s34, 0
  s_cbranch_scc1 wp_B2
  s_mov_b32 s60, s40
  s_and_b32 s61, s41, 0xffff
  s_mov_b32 s62, 3670016
  s_mov_b32 s63, 0x20000
  s_mov_b32 s56, s42
  s_and_b32 s57, s43, 0xffff
  s_mov_b32 s58, 3670016
  s_mov_b32 s59, 0x20000
  s_lshl_b32 s27, s18, 2
  s_add_u32 s27, s27, s16
  s_lshl_b32 s27, s27, 17
  s_add_u32 s27, s27, s26
  s_lshl_b32 s30, s16, 13
  s_add_u32 m0, s30, 0
  s_nop 0
  buffer_load_dwordx4 v26, s[56:59], s27 offen  lds
  s_add_u32 s27, s27, 16384
  s_add_u32 m0, s30, 1024
  s_nop 0
  buffer_load_dwordx4 v26, s[56:59], s27 offen  lds
  s_add_u32 s27, s27, 16384
  s_add_u32 m0, s30, 2048
  s_nop 0
  buffer_load_dwordx4 v27, s[56:59], s27 offen  lds
  s_add_u32 s27, s27, 16384
  s_add_u32 m0, s30, 3072
  s_nop 0
  buffer_load_dwordx4 v27, s[56:59], s27 offen  lds
  s_add_u32 s27, s27, 16384
  s_add_u32 m0, s30, 4096
  s_nop 0
  buffer_load_dwordx4 v26, s[56:59], s27 offen  lds
  s_add_u32 s27, s27, 16384
  s_add_u32 m0, s30, 5120
  s_nop 0
  buffer_load_dwordx4 v26, s[56:59], s27 offen  lds
  s_add_u32 s27, s27, 16384
  s_add_u32 m0, s30, 6144
  s_nop 0
  buffer_load_dwordx4 v27, s[56:59], s27 offen  lds
  s_add_u32 s27, s27, 16384
  s_add_u32 m0, s30, 7168
  s_nop 0
  buffer_load_dwordx4 v27, s[56:59], s27 offen  lds
  s_add_u32 s27, s27, 16384
  s_add_u32 s27, s28, 0
  s_min_u32 s27, s27, 13
  s_lshl_b32 s27, s27, 18
  s_add_u32 s27, s27, s26
  s_add_u32 m0, s25, 0
  s_nop 0
  buffer_load_dwordx4 v16, s[60:63], s27 offen  lds
  s_add_u32 s27, s27, 16384
  s_add_u32 m0, s25, 1024
  s_nop 0
  buffer_load_dwordx4 v17, s[60:63], s27 offen  lds
  s_add_u32 s27, s27, 16384
  s_add_u32 m0, s25, 2048
  s_nop 0
  buffer_load_dwordx4 v16, s[60:63], s27 offen  lds
  s_add_u32 s27, s27, 16384
  s_add_u32 m0, s25, 3072
  s_nop 0
  buffer_load_dwordx4 v17, s[60:63], s27 offen  lds
  s_add_u32 s27, s27, 16384
  s_waitcnt vmcnt(12)
  s_barrier
  s_cmp_lg_u32 s16, 0
  s_cbranch_scc1 wp_f1_f
  v_readfirstlane_b32 s20, v254
  s_cmp_eq_u32 s20, 1
  s_cbranch_scc1 wp_f1_w_ok
  s_mov_b32 s30, 0
wp_f1_w:
  buffer_load_dword v254, off, s[12:15], 0 offset:128 sc1
  s_waitcnt vmcnt(0)
  v_cmp_ne_u32 vcc, 1, v254
  s_cbranch_vccz wp_f1_w_ok
  s_sleep 8
  s_add_u32 s30, s30, 1
  s_cmp_lt_u32 s30, 16
  s_cbranch_scc1 wp_f1_w
  s_branch wp_f1_f
wp_f1_w_ok:
  s_lshl_b32 s20, s17, 7
  s_add_u32 s20, s20, 582144
  s_lshl_b32 s21, 1, s19
  v_mov_b32 v248, s21
  s_mov_b64 exec, 1
  buffer_atomic_or v248, v252, s[8:11], s20 offen sc0
  s_mov_b64 exec, -1
  s_mov_b32 s37, s21
wp_f1_f:
  s_add_u32 m0, s25, 4096
  s_nop 0
  buffer_load_dwordx4 v18, s[60:63], s27 offen  lds
  s_add_u32 s27, s27, 16384
  s_add_u32 m0, s25, 5120
  s_nop 0
  buffer_load_dwordx4 v19, s[60:63], s27 offen  lds
  s_add_u32 s27, s27, 16384
  s_add_u32 m0, s25, 6144
  s_nop 0
  buffer_load_dwordx4 v18, s[60:63], s27 offen  lds
  s_add_u32 s27, s27, 16384
  s_add_u32 m0, s25, 7168
  s_nop 0
  buffer_load_dwordx4 v19, s[60:63], s27 offen  lds
  s_add_u32 s27, s27, 16384
  s_add_u32 m0, s25, 8192
  s_nop 0
  buffer_load_dwordx4 v20, s[60:63], s27 offen  lds
  s_add_u32 s27, s27, 16384
  s_add_u32 m0, s25, 9216
  s_nop 0
  buffer_load_dwordx4 v21, s[60:63], s27 offen  lds
  s_add_u32 s27, s27, 16384
  s_add_u32 m0, s25, 10240
  s_nop 0
  buffer_load_dwordx4 v20, s[60:63], s27 offen  lds
  s_add_u32 s27, s27, 16384
  s_add_u32 m0, s25, 11264
  s_nop 0
  buffer_load_dwordx4 v21, s[60:63], s27 offen  lds
  s_add_u32 s27, s27, 16384
  s_add_u32 m0, s25, 12288
  s_nop 0
  buffer_load_dwordx4 v22, s[60:63], s27 offen  lds
  s_add_u32 s27, s27, 16384
  s_add_u32 m0, s25, 13312
  s_nop 0
  buffer_load_dwordx4 v23, s[60:63], s27 offen  lds
  s_add_u32 s27, s27, 16384
  s_add_u32 m0, s25, 14336
  s_nop 0
  buffer_load_dwordx4 v22, s[60:63], s27 offen  lds
  s_add_u32 s27, s27, 16384
  s_add_u32 m0, s25, 15360
  s_nop 0
  buffer_load_dwordx4 v23, s[60:63], s27 offen  lds
  s_add_u32 s27, s27, 16384
  s_add_u32 s27, s28, 4
  s_min_u32 s27, s27, 13
  s_lshl_b32 s27, s27, 18
  s_add_u32 s27, s27, s26
  s_waitcnt vmcnt(12)
  v_readfirstlane_b32 s20, v248
  s_and_b32 s20, s20, 16383
  s_xor_b32 s20, s20, s37
  s_cmp_lg_u32 s20, 16383
  s_cselect_b32 s20, 0, s37
  s_mov_b32 s37, 0
  s_cmp_eq_u32 s20, 0
  s_cbranch_scc1 wp_g1
  s_lshl_b32 s21, 1, s17
  v_mov_b32 v248, s21
  s_mov_b32 s20, 586240
  v_lshlrev_b32 v247, 7, v0
  s_mov_b64 exec, 0xff
  buffer_atomic_or v248, v247, s[8:11], s20 offen
  s_mov_b64 exec, -1
wp_g1:
  s_add_u32 m0, s25, 16384
  s_nop 0
  buffer_load_dwordx4 v16, s[60:63], s27 offen  lds
  s_add_u32 s27, s27, 16384
  s_add_u32 m0, s25, 17408
  s_nop 0
  buffer_load_dwordx4 v17, s[60:63], s27 offen  lds
  s_add_u32 s27, s27, 16384
  s_add_u32 m0, s25, 18432
  s_nop 0
  buffer_load_dwordx4 v16, s[60:63], s27 offen  lds
  s_add_u32 s27, s27, 16384
  s_add_u32 m0, s25, 19456
  s_nop 0
  buffer_load_dwordx4 v17, s[60:63], s27 offen  lds
  s_add_u32 s27, s27, 16384
  s_add_u32 m0, s25, 20480
  s_nop 0
  buffer_load_dwordx4 v18, s[60:63], s27 offen  lds
  s_add_u32 s27, s27, 16384
  s_add_u32 m0, s25, 21504
  s_nop 0
  buffer_load_dwordx4 v19, s[60:63], s27 offen  lds
  s_add_u32 s27, s27, 16384
  s_add_u32 m0, s25, 22528
  s_nop 0
  buffer_load_dwordx4 v18, s[60:63], s27 offen  lds
  s_add_u32 s27, s27, 16384
  s_add_u32 m0, s25, 23552
  s_nop 0
  buffer_load_dwordx4 v19, s[60:63], s27 offen  lds
  s_add_u32 s27, s27, 16384
  s_add_u32 m0, s25, 24576
  s_nop 0
  buffer_load_dwordx4 v20, s[60:63], s27 offen  lds
  s_add_u32 s27, s27, 16384
  s_add_u32 m0, s25, 25600
  s_nop 0
  buffer_load_dwordx4 v21, s[60:63], s27 offen  lds
  s_add_u32 s27, s27, 16384
  s_add_u32 m0, s25, 26624
  s_nop 0
  buffer_load_dwordx4 v20, s[60:63], s27 offen  lds
  s_add_u32 s27, s27, 16384
  s_add_u32 m0, s25, 27648
  s_nop 0
  buffer_load_dwordx4 v21, s[60:63], s27 offen  lds
  s_add_u32 s27, s27, 16384
  s_add_u32 m0, s25, 28672
  s_nop 0
  buffer_load_dwordx4 v22, s[60:63], s27 offen  lds
  s_add_u32 s27, s27, 16384
  s_add_u32 m0, s25, 29696
  s_nop 0
  buffer_load_dwordx4 v23, s[60:63], s27 offen  lds
  s_add_u32 s27, s27, 16384
  s_add_u32 m0, s25, 30720
  s_nop 0
  buffer_load_dwordx4 v22, s[60:63], s27 offen  lds
  s_add_u32 s27, s27, 16384
  s_add_u32 m0, s25, 31744
  s_nop 0
  buffer_load_dwordx4 v23, s[60:63], s27 offen  lds
  s_add_u32 s27, s27, 16384
  s_branch wp_A
wp_B2:
  v_lshlrev_b32 v6, 7, v1
  s_getpc_b64 s[98:99]
ct_5:
  s_add_u32 s98, s98, wp_fin-ct_5
  s_addc_u32 s99, s99, 0
  global_load_dword v7, v6, s[98:99]
  s_getpc_b64 s[98:99]
ct_6:
  s_add_u32 s98, s98, wg_vo-ct_6
  s_addc_u32 s99, s99, 0
  global_load_dword v7, v6, s[98:99]
  s_waitcnt vmcnt(2)
  s_barrier
  s_cmp_lg_u32 s16, 0
  s_cbranch_scc1 wp_f2_f
  v_readfirstlane_b32 s20, v254
  s_cmp_eq_u32 s20, 1
  s_cbranch_scc1 wp_f2_w_ok
  s_mov_b32 s30, 0
wp_f2_w:
  buffer_load_dword v254, off, s[12:15], 0 offset:128 sc1
  s_waitcnt vmcnt(0)
  v_cmp_ne_u32 vcc, 1, v254
  s_cbranch_vccz wp_f2_w_ok
  s_sleep 8
  s_add_u32 s30, s30, 1
  s_cmp_lt_u32 s30, 16
  s_cbranch_scc1 wp_f2_w
  s_branch wp_f2_f
wp_f2_w_ok:
  s_lshl_b32 s20, s17, 7
  s_add_u32 s20, s20, 582144
  s_lshl_b32 s21, 1, s19
  v_mov_b32 v248, s21
  s_mov_b64 exec, 1
  buffer_atomic_or v248, v252, s[8:11], s20 offen sc0
  s_mov_b64 exec, -1
  s_mov_b32 s37, s21
wp_f2_f:
  s_cmp_eq_u32 s97, 0
  s_cselect_b32 s39, -1, s39
  s_branch wp_fin
wp_A0:
  s_mov_b32 s60, s40
  s_and_b32 s61, s41, 0xffff
  s_mov_b32 s62, 3670016
  s_mov_b32 s63, 0x20000
  s_mov_b32 s56, s42
  s_and_b32 s57, s43, 0xffff
  s_mov_b32 s58, 3670016
  s_mov_b32 s59, 0x20000
  s_lshl_b32 s27, s18, 2
  s_add_u32 s27, s27, s16
  s_lshl_b32 s27, s27, 17
  s_add_u32 s27, s27, s26
  s_lshl_b32 s30, s16, 13
  s_add_u32 m0, s30, 0
  s_nop 0
  buffer_load_dwordx4 v26, s[56:59], s27 offen  lds
  s_add_u32 s27, s27, 16384
  s_add_u32 m0, s30, 1024
  s_nop 0
  buffer_load_dwordx4 v26, s[56:59], s27 offen  lds
  s_add_u32 s27, s27, 16384
  s_add_u32 m0, s30, 2048
  s_nop 0
  buffer_load_dwordx4 v27, s[56:59], s27 offen  lds
  s_add_u32 s27, s27, 16384
  s_add_u32 m0, s30, 3072
  s_nop 0
  buffer_load_dwordx4 v27, s[56:59], s27 offen  lds
  s_add_u32 s27, s27, 16384
  s_add_u32 m0, s30, 4096
  s_nop 0
  buffer_load_dwordx4 v26, s[56:59], s27 offen  lds
  s_add_u32 s27, s27, 16384
  s_add_u32 m0, s30, 5120
  s_nop 0
  buffer_load_dwordx4 v26, s[56:59], s27 offen  lds
  s_add_u32 s27, s27, 16384
  s_add_u32 m0, s30, 6144
  s_nop 0
  buffer_load_dwordx4 v27, s[56:59], s27 offen  lds
  s_add_u32 s27, s27, 16384
  s_add_u32 m0, s30, 7168
  s_nop 0
  buffer_load_dwordx4 v27, s[56:59], s27 offen  lds
  s_add_u32 s27, s27, 16384
  s_add_u32 s27, s28, 0
  s_min_u32 s27, s27, 13
  s_lshl_b32 s27, s27, 18
  s_add_u32 s27, s27, s26
  s_add_u32 m0, s25, 0
  s_nop 0
  buffer_load_dwordx4 v16, s[60:63], s27 offen  lds
  s_add_u32 s27, s27, 16384
  s_add_u32 m0, s25, 1024
  s_nop 0
  buffer_load_dwordx4 v17, s[60:63], s27 offen  lds
  s_add_u32 s27, s27, 16384
  s_add_u32 m0, s25, 2048
  s_nop 0
  buffer_load_dwordx4 v16, s[60:63], s27 offen  lds
  s_add_u32 s27, s27, 16384
  s_add_u32 m0, s25, 3072
  s_nop 0
  buffer_load_dwordx4 v17, s[60:63], s27 offen  lds
  s_add_u32 s27, s27, 16384
  s_add_u32 m0, s25, 4096
  s_nop 0
  buffer_load_dwordx4 v18, s[60:63], s27 offen  lds
  s_add_u32 s27, s27, 16384
  s_add_u32 m0, s25, 5120
  s_nop 0
  buffer_load_dwordx4 v19, s[60:63], s27 offen  lds
  s_add_u32 s27, s27, 16384
  s_add_u32 m0, s25, 6144
  s_nop 0
  buffer_load_dwordx4 v18, s[60:63], s27 offen  lds
  s_add_u32 s27, s27, 16384
  s_add_u32 m0, s25, 7168
  s_nop 0
  buffer_load_dwordx4 v19, s[60:63], s27 offen  lds
  s_add_u32 s27, s27, 16384
  s_add_u32 m0, s25, 8192
  s_nop 0
  buffer_load_dwordx4 v20, s[60:63], s27 offen  lds
  s_add_u32 s27, s27, 16384
  s_add_u32 m0, s25, 9216
  s_nop 0
  buffer_load_dwordx4 v21, s[60:63], s27 offen  lds
  s_add_u32 s27, s27, 16384
  s_add_u32 m0, s25, 10240
  s_nop 0
  buffer_load_dwordx4 v20, s[60:63], s27 offen  lds
  s_add_u32 s27, s27, 16384
  s_add_u32 m0, s25, 11264
  s_nop 0
  buffer_load_dwordx4 v21, s[60:63], s27 offen  lds
  s_add_u32 s27, s27, 16384
  s_add_u32 m0, s25, 12288
  s_nop 0
  buffer_load_dwordx4 v22, s[60:63], s27 offen  lds
  s_add_u32 s27, s27, 16384
  s_add_u32 m0, s25, 13312
  s_nop 0
  buffer_load_dwordx4 v23, s[60:63], s27 offen  lds
  s_add_u32 s27, s27, 16384
  s_add_u32 m0, s25, 14336
  s_nop 0
  buffer_load_dwordx4 v22, s[60:63], s27 offen  lds
  s_add_u32 s27, s27, 16384
  s_add_u32 m0, s25, 15360
  s_nop 0
  buffer_load_dwordx4 v23, s[60:63], s27 offen  lds
  s_add_u32 s27, s27, 16384
  s_add_u32 s27, s28, 4
  s_min_u32 s27, s27, 13
  s_lshl_b32 s27, s27, 18
  s_add_u32 s27, s27, s26
  s_add_u32 m0, s25, 16384
  s_nop 0
  buffer_load_dwordx4 v16, s[60:63], s27 offen  lds
  s_add_u32 s27, s27, 16384
  s_add_u32 m0, s25, 17408
  s_nop 0
  buffer_load_dwordx4 v17, s[60:63], s27 offen  lds
  s_add_u32 s27, s27, 16384
  s_add_u32 m0, s25, 18432
  s_nop 0
  buffer_load_dwordx4 v16, s[60:63], s27 offen  lds
  s_add_u32 s27, s27, 16384
  s_add_u32 m0, s25, 19456
  s_nop 0
  buffer_load_dwordx4 v17, s[60:63], s27 offen  lds
  s_add_u32 s27, s27, 16384
  s_add_u32 m0, s25, 20480
  s_nop 0
  buffer_load_dwordx4 v18, s[60:63], s27 offen  lds
  s_add_u32 s27, s27, 16384
  s_add_u32 m0, s25, 21504
  s_nop 0
  buffer_load_dwordx4 v19, s[60:63], s27 offen  lds
  s_add_u32 s27, s27, 16384
  s_add_u32 m0, s25, 22528
  s_nop 0
  buffer_load_dwordx4 v18, s[60:63], s27 offen  lds
  s_add_u32 s27, s27, 16384
  s_add_u32 m0, s25, 23552
  s_nop 0
  buffer_load_dwordx4 v19, s[60:63], s27 offen  lds
  s_add_u32 s27, s27, 16384
  s_add_u32 m0, s25, 24576
  s_nop 0
  buffer_load_dwordx4 v20, s[60:63], s27 offen  lds
  s_add_u32 s27, s27, 16384
  s_add_u32 m0, s25, 25600
  s_nop 0
  buffer_load_dwordx4 v21, s[60:63], s27 offen  lds
  s_add_u32 s27, s27, 16384
  s_add_u32 m0, s25, 26624
  s_nop 0
  buffer_load_dwordx4 v20, s[60:63], s27 offen  lds
  s_add_u32 s27, s27, 16384
  s_add_u32 m0, s25, 27648
  s_nop 0
  buffer_load_dwordx4 v21, s[60:63], s27 offen  lds
  s_add_u32 s27, s27, 16384
  s_add_u32 m0, s25, 28672
  s_nop 0
  buffer_load_dwordx4 v22, s[60:63], s27 offen  lds
  s_add_u32 s27, s27, 16384
  s_add_u32 m0, s25, 29696
  s_nop 0
  buffer_load_dwordx4 v23, s[60:63], s27 offen  lds
  s_add_u32 s27, s27, 16384
  s_add_u32 m0, s25, 30720
  s_nop 0
  buffer_load_dwordx4 v22, s[60:63], s27 offen  lds
  s_add_u32 s27, s27, 16384
  s_add_u32 m0, s25, 31744
  s_nop 0
  buffer_load_dwordx4 v23, s[60:63], s27 offen  lds
  s_add_u32 s27, s27, 16384
  v_lshrrev_b32 v7, 2, v4
  v_lshlrev_b32 v11, 4, v7
  v_lshlrev_b32 v7, 3, v7
  v_and_b32 v8, 3, v4
  v_add_u32 v7, v7, v8
  v_and_b32 v8, 2, v4
  v_lshl_add_u32 v11, v8, 1, v11
  v_and_b32 v8, 1, v4
  v_add_u32 v11, v11, v8
  v_or_b32 v10, 0, v3
  v_xor_b32 v10, v10, v4
  v_lshlrev_b32 v10, 4, v10
  v_lshl_add_u32 v44, v11, 9, v10
  v_lshl_add_u32 v10, v7, 9, v10
  v_add_u32 v32, s25, v10
  v_or_b32 v10, 4, v3
  v_xor_b32 v10, v10, v4
  v_lshlrev_b32 v10, 4, v10
  v_lshl_add_u32 v45, v11, 9, v10
  v_lshl_add_u32 v10, v7, 9, v10
  v_add_u32 v33, s25, v10
  v_or_b32 v10, 8, v3
  v_xor_b32 v10, v10, v4
  v_lshlrev_b32 v10, 4, v10
  v_lshl_add_u32 v46, v11, 9, v10
  v_lshl_add_u32 v10, v7, 9, v10
  v_add_u32 v34, s25, v10
  v_or_b32 v10, 12, v3
  v_xor_b32 v10, v10, v4
  v_lshlrev_b32 v10, 4, v10
  v_lshl_add_u32 v47, v11, 9, v10
  v_lshl_add_u32 v10, v7, 9, v10
  v_add_u32 v35, s25, v10
  s_mul_i32 s30, s17, 401408
  s_mul_i32 s31, s18, 57344
  s_add_u32 s30, s30, s31
  s_add_u32 s30, s30, 33554432
  v_add_u32 v28, s30, v2
  s_add_u32 s30, s30, 14336
  v_add_u32 v29, s30, v2
  s_add_u32 s30, s30, 14336
  v_add_u32 v30, s30, v2
  s_add_u32 s30, s30, 14336
  v_add_u32 v31, s30, v2
  s_add_u32 s30, s30, 14336
  v_mov_b32 v48, 1035512379
wp_A:
  s_lshl_b32 s29, s28, 10
  s_add_u32 s31, s29, 4096
  s_cmp_lt_u32 s28, 10
  s_cselect_b32 s31, s31, 0x40000000
  s_waitcnt vmcnt(0)
  s_barrier
  ds_read_b128 a[0:3], v44 offset:0
  ds_read_b128 a[32:35], v44 offset:1024
  ds_read_b128 a[64:67], v44 offset:4096
  ds_read_b128 a[96:99], v44 offset:5120
  ds_read_b128 a[128:131], v32 offset:0
  ds_read_b128 a[160:163], v32 offset:2048
  ds_read_b128 a[192:195], v32 offset:16384
  ds_read_b128 a[224:227], v32 offset:18432
  s_waitcnt lgkmcnt(0)
  v_mfma_f32_16x16x32_bf16 v[64:67], a[128:131], a[0:3], 0
  ds_read_b128 a[4:7], v45 offset:0
  ds_read_b128 a[36:39], v45 offset:1024
  v_mfma_f32_16x16x32_bf16 v[68:71], a[160:163], a[0:3], 0
  ds_read_b128 a[68:71], v45 offset:4096
  ds_read_b128 a[100:103], v45 offset:5120
  v_mfma_f32_16x16x32_bf16 v[72:75], a[128:131], a[32:35], 0
  ds_read_b128 a[132:135], v33 offset:0
  ds_read_b128 a[164:167], v33 offset:2048
  v_mfma_f32_16x16x32_bf16 v[76:79], a[160:163], a[32:35], 0
  ds_read_b128 a[196:199], v33 offset:16384
  ds_read_b128 a[228:231], v33 offset:18432
  v_mfma_f32_16x16x32_bf16 v[80:83], a[128:131], a[64:67], 0
  v_mfma_f32_16x16x32_bf16 v[84:87], a[160:163], a[64:67], 0
  v_mfma_f32_16x16x32_bf16 v[88:91], a[128:131], a[96:99], 0
  v_mfma_f32_16x16x32_bf16 v[92:95], a[160:163], a[96:99], 0
  v_mfma_f32_16x16x32_bf16 v[96:99], a[192:195], a[0:3], 0
  v_mfma_f32_16x16x32_bf16 v[100:103], a[224:227], a[0:3], 0
  v_mfma_f32_16x16x32_bf16 v[104:107], a[192:195], a[32:35], 0
  v_mfma_f32_16x16x32_bf16 v[108:111], a[224:227], a[32:35], 0
  v_mfma_f32_16x16x32_bf16 v[112:115], a[192:195], a[64:67], 0
  v_mfma_f32_16x16x32_bf16 v[116:119], a[224:227], a[64:67], 0
  v_mfma_f32_16x16x32_bf16 v[120:123], a[192:195], a[96:99], 0
  v_mfma_f32_16x16x32_bf16 v[124:127], a[224:227], a[96:99], 0
  s_waitcnt lgkmcnt(0)
  v_mfma_f32_16x16x32_bf16 v[64:67], a[132:135], a[4:7], v[64:67]
  ds_read_b128 a[8:11], v46 offset:0
  ds_read_b128 a[40:43], v46 offset:1024
  v_mfma_f32_16x16x32_bf16 v[68:71], a[164:167], a[4:7], v[68:71]
  ds_read_b128 a[72:75], v46 offset:4096
  ds_read_b128 a[104:107], v46 offset:5120
  v_mfma_f32_16x16x32_bf16 v[72:75], a[132:135], a[36:39], v[72:75]
  ds_read_b128 a[136:139], v34 offset:0
  ds_read_b128 a[168:171], v34 offset:2048
  v_mfma_f32_16x16x32_bf16 v[76:79], a[164:167], a[36:39], v[76:79]
  ds_read_b128 a[200:203], v34 offset:16384
  ds_read_b128 a[232:235], v34 offset:18432
  v_mfma_f32_16x16x32_bf16 v[80:83], a[132:135], a[68:71], v[80:83]
  v_mfma_f32_16x16x32_bf16 v[84:87], a[164:167], a[68:71], v[84:87]
  v_mfma_f32_16x16x32_bf16 v[88:91], a[132:135], a[100:103], v[88:91]
  v_mfma_f32_16x16x32_bf16 v[92:95], a[164:167], a[100:103], v[92:95]
  v_mfma_f32_16x16x32_bf16 v[96:99], a[196:199], a[4:7], v[96:99]
  v_mfma_f32_16x16x32_bf16 v[100:103], a[228:231], a[4:7], v[100:103]
  v_mfma_f32_16x16x32_bf16 v[104:107], a[196:199], a[36:39], v[104:107]
  v_mfma_f32_16x16x32_bf16 v[108:111], a[228:231], a[36:39], v[108:111]
  v_mfma_f32_16x16x32_bf16 v[112:115], a[196:199], a[68:71], v[112:115]
  v_mfma_f32_16x16x32_bf16 v[116:119], a[228:231], a[68:71], v[116:119]
  v_mfma_f32_16x16x32_bf16 v[120:123], a[196:199], a[100:103], v[120:123]
  v_mfma_f32_16x16x32_bf16 v[124:127], a[228:231], a[100:103], v[124:127]
  s_waitcnt lgkmcnt(0)
  v_mfma_f32_16x16x32_bf16 v[64:67], a[136:139], a[8:11], v[64:67]
  ds_read_b128 a[12:15], v47 offset:0
  ds_read_b128 a[44:47], v47 offset:1024
  v_mfma_f32_16x16x32_bf16 v[68:71], a[168:171], a[8:11], v[68:71]
  ds_read_b128 a[76:79], v47 offset:4096
  ds_read_b128 a[108:111], v47 offset:5120
  v_mfma_f32_16x16x32_bf16 v[72:75], a[136:139], a[40:43], v[72:75]
  ds_read_b128 a[140:143], v35 offset:0
  ds_read_b128 a[172:175], v35 offset:2048
  v_mfma_f32_16x16x32_bf16 v[76:79], a[168:171], a[40:43], v[76:79]
  ds_read_b128 a[204:207], v35 offset:16384
  ds_read_b128 a[236:239], v35 offset:18432
  v_mfma_f32_16x16x32_bf16 v[80:83], a[136:139], a[72:75], v[80:83]
  v_mfma_f32_16x16x32_bf16 v[84:87], a[168:171], a[72:75], v[84:87]
  v_mfma_f32_16x16x32_bf16 v[88:91], a[136:139], a[104:107], v[88:91]
  v_mfma_f32_16x16x32_bf16 v[92:95], a[168:171], a[104:107], v[92:95]
  v_mfma_f32_16x16x32_bf16 v[96:99], a[200:203], a[8:11], v[96:99]
  v_mfma_f32_16x16x32_bf16 v[100:103], a[232:235], a[8:11], v[100:103]
  v_mfma_f32_16x16x32_bf16 v[104:107], a[200:203], a[40:43], v[104:107]
  v_mfma_f32_16x16x32_bf16 v[108:111], a[232:235], a[40:43], v[108:111]
  v_mfma_f32_16x16x32_bf16 v[112:115], a[200:203], a[72:75], v[112:115]
  v_mfma_f32_16x16x32_bf16 v[116:119], a[232:235], a[72:75], v[116:119]
  v_mfma_f32_16x16x32_bf16 v[120:123], a[200:203], a[104:107], v[120:123]
  v_mfma_f32_16x16x32_bf16 v[124:127], a[232:235], a[104:107], v[124:127]
  s_waitcnt lgkmcnt(0)
  v_mfma_f32_16x16x32_bf16 v[64:67], a[140:143], a[12:15], v[64:67]
  ds_read_b128 a[16:19], v44 offset:256
  ds_read_b128 a[48:51], v44 offset:1280
  v_mfma_f32_16x16x32_bf16 v[68:71], a[172:175], a[12:15], v[68:71]
  ds_read_b128 a[80:83], v44 offset:4352
  ds_read_b128 a[112:115], v44 offset:5376
  v_mfma_f32_16x16x32_bf16 v[72:75], a[140:143], a[44:47], v[72:75]
  ds_read_b128 a[144:147], v32 offset:256
  ds_read_b128 a[176:179], v32 offset:2304
  v_mfma_f32_16x16x32_bf16 v[76:79], a[172:175], a[44:47], v[76:79]
  ds_read_b128 a[208:211], v32 offset:16640
  ds_read_b128 a[240:243], v32 offset:18688
  v_mfma_f32_16x16x32_bf16 v[80:83], a[140:143], a[76:79], v[80:83]
  v_mfma_f32_16x16x32_bf16 v[84:87], a[172:175], a[76:79], v[84:87]
  v_mfma_f32_16x16x32_bf16 v[88:91], a[140:143], a[108:111], v[88:91]
  v_mfma_f32_16x16x32_bf16 v[92:95], a[172:175], a[108:111], v[92:95]
  v_mfma_f32_16x16x32_bf16 v[96:99], a[204:207], a[12:15], v[96:99]
  v_mfma_f32_16x16x32_bf16 v[100:103], a[236:239], a[12:15], v[100:103]
  v_mfma_f32_16x16x32_bf16 v[104:107], a[204:207], a[44:47], v[104:107]
  v_mfma_f32_16x16x32_bf16 v[108:111], a[236:239], a[44:47], v[108:111]
  v_mfma_f32_16x16x32_bf16 v[112:115], a[204:207], a[76:79], v[112:115]
  v_mfma_f32_16x16x32_bf16 v[116:119], a[236:239], a[76:79], v[116:119]
  v_mfma_f32_16x16x32_bf16 v[120:123], a[204:207], a[108:111], v[120:123]
  v_mfma_f32_16x16x32_bf16 v[124:127], a[236:239], a[108:111], v[124:127]
  s_waitcnt lgkmcnt(0)
  v_mfma_f32_16x16x32_bf16 v[64:67], a[144:147], a[16:19], v[64:67]
  ds_read_b128 a[20:23], v45 offset:256
  ds_read_b128 a[52:55], v45 offset:1280
  v_mfma_f32_16x16x32_bf16 v[68:71], a[176:179], a[16:19], v[68:71]
  ds_read_b128 a[84:87], v45 offset:4352
  ds_read_b128 a[116:119], v45 offset:5376
  v_mfma_f32_16x16x32_bf16 v[72:75], a[144:147], a[48:51], v[72:75]
  ds_read_b128 a[148:151], v33 offset:256
  ds_read_b128 a[180:183], v33 offset:2304
  v_mfma_f32_16x16x32_bf16 v[76:79], a[176:179], a[48:51], v[76:79]
  ds_read_b128 a[212:215], v33 offset:16640
  ds_read_b128 a[244:247], v33 offset:18688
  v_mfma_f32_16x16x32_bf16 v[80:83], a[144:147], a[80:83], v[80:83]
  v_mfma_f32_16x16x32_bf16 v[84:87], a[176:179], a[80:83], v[84:87]
  v_mfma_f32_16x16x32_bf16 v[88:91], a[144:147], a[112:115], v[88:91]
  v_mfma_f32_16x16x32_bf16 v[92:95], a[176:179], a[112:115], v[92:95]
  v_mfma_f32_16x16x32_bf16 v[96:99], a[208:211], a[16:19], v[96:99]
  v_mfma_f32_16x16x32_bf16 v[100:103], a[240:243], a[16:19], v[100:103]
  v_mfma_f32_16x16x32_bf16 v[104:107], a[208:211], a[48:51], v[104:107]
  v_mfma_f32_16x16x32_bf16 v[108:111], a[240:243], a[48:51], v[108:111]
  v_mfma_f32_16x16x32_bf16 v[112:115], a[208:211], a[80:83], v[112:115]
  v_mfma_f32_16x16x32_bf16 v[116:119], a[240:243], a[80:83], v[116:119]
  v_mfma_f32_16x16x32_bf16 v[120:123], a[208:211], a[112:115], v[120:123]
  v_mfma_f32_16x16x32_bf16 v[124:127], a[240:243], a[112:115], v[124:127]
  s_waitcnt lgkmcnt(0)
  v_mfma_f32_16x16x32_bf16 v[64:67], a[148:151], a[20:23], v[64:67]
  ds_read_b128 a[24:27], v46 offset:256
  ds_read_b128 a[56:59], v46 offset:1280
  v_mfma_f32_16x16x32_bf16 v[68:71], a[180:183], a[20:23], v[68:71]
  ds_read_b128 a[88:91], v46 offset:4352
  ds_read_b128 a[120:123], v46 offset:5376
  v_mfma_f32_16x16x32_bf16 v[72:75], a[148:151], a[52:55], v[72:75]
  ds_read_b128 a[152:155], v34 offset:256
  ds_read_b128 a[184:187], v34 offset:2304
  v_mfma_f32_16x16x32_bf16 v[76:79], a[180:183], a[52:55], v[76:79]
  ds_read_b128 a[216:219], v34 offset:16640
  ds_read_b128 a[248:251], v34 offset:18688
  v_mfma_f32_16x16x32_bf16 v[80:83], a[148:151], a[84:87], v[80:83]
  v_mfma_f32_16x16x32_bf16 v[84:87], a[180:183], a[84:87], v[84:87]
  v_mfma_f32_16x16x32_bf16 v[88:91], a[148:151], a[116:119], v[88:91]
  v_mfma_f32_16x16x32_bf16 v[92:95], a[180:183], a[116:119], v[92:95]
  v_mfma_f32_16x16x32_bf16 v[96:99], a[212:215], a[20:23], v[96:99]
  v_mfma_f32_16x16x32_bf16 v[100:103], a[244:247], a[20:23], v[100:103]
  v_mfma_f32_16x16x32_bf16 v[104:107], a[212:215], a[52:55], v[104:107]
  v_mfma_f32_16x16x32_bf16 v[108:111], a[244:247], a[52:55], v[108:111]
  v_mfma_f32_16x16x32_bf16 v[112:115], a[212:215], a[84:87], v[112:115]
  v_mfma_f32_16x16x32_bf16 v[116:119], a[244:247], a[84:87], v[116:119]
  v_mfma_f32_16x16x32_bf16 v[120:123], a[212:215], a[116:119], v[120:123]
  v_mfma_f32_16x16x32_bf16 v[124:127], a[244:247], a[116:119], v[124:127]
  s_waitcnt lgkmcnt(0)
  v_mfma_f32_16x16x32_bf16 v[64:67], a[152:155], a[24:27], v[64:67]
  ds_read_b128 a[28:31], v47 offset:256
  ds_read_b128 a[60:63], v47 offset:1280
  v_mfma_f32_16x16x32_bf16 v[68:71], a[184:187], a[24:27], v[68:71]
  ds_read_b128 a[92:95], v47 offset:4352
  ds_read_b128 a[124:127], v47 offset:5376
  v_mfma_f32_16x16x32_bf16 v[72:75], a[152:155], a[56:59], v[72:75]
  ds_read_b128 a[156:159], v35 offset:256
  ds_read_b128 a[188:191], v35 offset:2304
  v_mfma_f32_16x16x32_bf16 v[76:79], a[184:187], a[56:59], v[76:79]
  ds_read_b128 a[220:223], v35 offset:16640
  ds_read_b128 a[252:255], v35 offset:18688
  v_mfma_f32_16x16x32_bf16 v[80:83], a[152:155], a[88:91], v[80:83]
  v_mfma_f32_16x16x32_bf16 v[84:87], a[184:187], a[88:91], v[84:87]
  v_mfma_f32_16x16x32_bf16 v[88:91], a[152:155], a[120:123], v[88:91]
  v_mfma_f32_16x16x32_bf16 v[92:95], a[184:187], a[120:123], v[92:95]
  v_mfma_f32_16x16x32_bf16 v[96:99], a[216:219], a[24:27], v[96:99]
  v_mfma_f32_16x16x32_bf16 v[100:103], a[248:251], a[24:27], v[100:103]
  v_mfma_f32_16x16x32_bf16 v[104:107], a[216:219], a[56:59], v[104:107]
  v_mfma_f32_16x16x32_bf16 v[108:111], a[248:251], a[56:59], v[108:111]
  v_mfma_f32_16x16x32_bf16 v[112:115], a[216:219], a[88:91], v[112:115]
  v_mfma_f32_16x16x32_bf16 v[116:119], a[248:251], a[88:91], v[116:119]
  v_mfma_f32_16x16x32_bf16 v[120:123], a[216:219], a[120:123], v[120:123]
  v_mfma_f32_16x16x32_bf16 v[124:127], a[248:251], a[120:123], v[124:127]
  s_waitcnt lgkmcnt(0)
  s_barrier
  buffer_load_dwordx2 v[254:255], v252, s[12:15], 0 offen offset:128 sc1
  buffer_load_dword v253, v252, s[12:15], 0 offen sc1
  v_mfma_f32_16x16x32_bf16 v[64:67], a[156:159], a[28:31], v[64:67]
  v_mfma_f32_16x16x32_bf16 v[68:71], a[188:191], a[28:31], v[68:71]
  v_mfma_f32_16x16x32_bf16 v[72:75], a[156:159], a[60:63], v[72:75]
  v_mfma_f32_16x16x32_bf16 v[76:79], a[188:191], a[60:63], v[76:79]
  v_mfma_f32_16x16x32_bf16 v[80:83], a[156:159], a[92:95], v[80:83]
  v_pk_mul_f32 v[64:65], v[64:65], v[48:49] op_sel_hi:[1,0]
  v_pk_mul_f32 v[66:67], v[66:67], v[48:49] op_sel_hi:[1,0]
  v_mfma_f32_16x16x32_bf16 v[84:87], a[188:191], a[92:95], v[84:87]
  v_pk_mul_f32 v[68:69], v[68:69], v[48:49] op_sel_hi:[1,0]
  v_pk_mul_f32 v[70:71], v[70:71], v[48:49] op_sel_hi:[1,0]
  v_mfma_f32_16x16x32_bf16 v[88:91], a[156:159], a[124:127], v[88:91]
  v_cvt_pk_bf16_f32 v64, v64, v65
  v_cvt_pk_bf16_f32 v65, v66, v67
  v_mfma_f32_16x16x32_bf16 v[92:95], a[188:191], a[124:127], v[92:95]
  v_cvt_pk_bf16_f32 v66, v68, v69
  v_cvt_pk_bf16_f32 v67, v70, v71
  v_mfma_f32_16x16x32_bf16 v[96:99], a[220:223], a[28:31], v[96:99]
  buffer_store_dwordx4 v[64:67], v28, s[8:11], s29 offen sc1
  v_pk_mul_f32 v[72:73], v[72:73], v[48:49] op_sel_hi:[1,0]
  v_mfma_f32_16x16x32_bf16 v[100:103], a[252:255], a[28:31], v[100:103]
  v_pk_mul_f32 v[74:75], v[74:75], v[48:49] op_sel_hi:[1,0]
  v_pk_mul_f32 v[76:77], v[76:77], v[48:49] op_sel_hi:[1,0]
  v_mfma_f32_16x16x32_bf16 v[104:107], a[220:223], a[60:63], v[104:107]
  v_pk_mul_f32 v[78:79], v[78:79], v[48:49] op_sel_hi:[1,0]
  v_cvt_pk_bf16_f32 v72, v72, v73
  v_mfma_f32_16x16x32_bf16 v[108:111], a[252:255], a[60:63], v[108:111]
  v_cvt_pk_bf16_f32 v73, v74, v75
  v_cvt_pk_bf16_f32 v74, v76, v77
  v_mfma_f32_16x16x32_bf16 v[112:115], a[220:223], a[92:95], v[112:115]
  v_cvt_pk_bf16_f32 v75, v78, v79
  buffer_store_dwordx4 v[72:75], v29, s[8:11], s29 offen sc1
  v_mfma_f32_16x16x32_bf16 v[116:119], a[252:255], a[92:95], v[116:119]
  v_pk_mul_f32 v[80:81], v[80:81], v[48:49] op_sel_hi:[1,0]
  v_pk_mul_f32 v[82:83], v[82:83], v[48:49] op_sel_hi:[1,0]
  v_mfma_f32_16x16x32_bf16 v[120:123], a[220:223], a[124:127], v[120:123]
  v_pk_mul_f32 v[84:85], v[84:85], v[48:49] op_sel_hi:[1,0]
  v_pk_mul_f32 v[86:87], v[86:87], v[48:49] op_sel_hi:[1,0]
  v_mfma_f32_16x16x32_bf16 v[124:127], a[252:255], a[124:127], v[124:127]
  v_cvt_pk_bf16_f32 v80, v80, v81
  v_cvt_pk_bf16_f32 v81, v82, v83
  v_cvt_pk_bf16_f32 v82, v84, v85
  v_cvt_pk_bf16_f32 v83, v86, v87
  buffer_store_dwordx4 v[80:83], v30, s[8:11], s29 offen sc1
  v_pk_mul_f32 v[88:89], v[88:89], v[48:49] op_sel_hi:[1,0]
  v_pk_mul_f32 v[90:91], v[90:91], v[48:49] op_sel_hi:[1,0]
  v_pk_mul_f32 v[92:93], v[92:93], v[48:49] op_sel_hi:[1,0]
  v_pk_mul_f32 v[94:95], v[94:95], v[48:49] op_sel_hi:[1,0]
  v_cvt_pk_bf16_f32 v88, v88, v89
  v_cvt_pk_bf16_f32 v89, v90, v91
  v_cvt_pk_bf16_f32 v90, v92, v93
  v_cvt_pk_bf16_f32 v91, v94, v95
  buffer_store_dwordx4 v[88:91], v31, s[8:11], s29 offen sc1
  v_pk_mul_f32 v[96:97], v[96:97], v[48:49] op_sel_hi:[1,0]
  v_pk_mul_f32 v[98:99], v[98:99], v[48:49] op_sel_hi:[1,0]
  v_pk_mul_f32 v[100:101], v[100:101], v[48:49] op_sel_hi:[1,0]
  v_pk_mul_f32 v[102:103], v[102:103], v[48:49] op_sel_hi:[1,0]
  v_cvt_pk_bf16_f32 v96, v96, v97
  v_cvt_pk_bf16_f32 v97, v98, v99
  v_cvt_pk_bf16_f32 v98, v100, v101
  v_cvt_pk_bf16_f32 v99, v102, v103
  buffer_store_dwordx4 v[96:99], v28, s[8:11], s31 offen sc1
  v_pk_mul_f32 v[104:105], v[104:105], v[48:49] op_sel_hi:[1,0]
  v_pk_mul_f32 v[106:107], v[106:107], v[48:49] op_sel_hi:[1,0]
  v_pk_mul_f32 v[108:109], v[108:109], v[48:49] op_sel_hi:[1,0]
  v_pk_mul_f32 v[110:111], v[110:111], v[48:49] op_sel_hi:[1,0]
  v_cvt_pk_bf16_f32 v104, v104, v105
  v_cvt_pk_bf16_f32 v105, v106, v107
  v_cvt_pk_bf16_f32 v106, v108, v109
  v_cvt_pk_bf16_f32 v107, v110, v111
  buffer_store_dwordx4 v[104:107], v29, s[8:11], s31 offen sc1
  v_pk_mul_f32 v[112:113], v[112:113], v[48:49] op_sel_hi:[1,0]
  v_pk_mul_f32 v[114:115], v[114:115], v[48:49] op_sel_hi:[1,0]
  v_pk_mul_f32 v[116:117], v[116:117], v[48:49] op_sel_hi:[1,0]
  v_pk_mul_f32 v[118:119], v[118:119], v[48:49] op_sel_hi:[1,0]
  v_cvt_pk_bf16_f32 v112, v112, v113
  v_cvt_pk_bf16_f32 v113, v114, v115
  v_cvt_pk_bf16_f32 v114, v116, v117
  v_cvt_pk_bf16_f32 v115, v118, v119
  buffer_store_dwordx4 v[112:115], v30, s[8:11], s31 offen sc1
  v_pk_mul_f32 v[120:121], v[120:121], v[48:49] op_sel_hi:[1,0]
  v_pk_mul_f32 v[122:123], v[122:123], v[48:49] op_sel_hi:[1,0]
  v_pk_mul_f32 v[124:125], v[124:125], v[48:49] op_sel_hi:[1,0]
  v_pk_mul_f32 v[126:127], v[126:127], v[48:49] op_sel_hi:[1,0]
  v_cvt_pk_bf16_f32 v120, v120, v121
  v_cvt_pk_bf16_f32 v121, v122, v123
  v_cvt_pk_bf16_f32 v122, v124, v125
  v_cvt_pk_bf16_f32 v123, v126, v127
  buffer_store_dwordx4 v[120:123], v31, s[8:11], s31 offen sc1
  s_waitcnt vmcnt(0)
  s_barrier
  s_cmp_lg_u32 s16, 0
  s_cbranch_scc1 wp_f3_f
  v_readfirstlane_b32 s20, v254
  s_cmp_eq_u32 s20, 1
  s_cbranch_scc1 wp_f3_w_ok
  s_mov_b32 s30, 0
wp_f3_w:
  buffer_load_dword v254, off, s[12:15], 0 offset:128 sc1
  s_waitcnt vmcnt(0)
  v_cmp_ne_u32 vcc, 1, v254
  s_cbranch_vccz wp_f3_w_ok
  s_sleep 8
  s_add_u32 s30, s30, 1
  s_cmp_lt_u32 s30, 16
  s_cbranch_scc1 wp_f3_w
  s_branch wp_f3_f
wp_f3_w_ok:
  s_lshl_b32 s20, s17, 7
  s_add_u32 s20, s20, 584192
  s_lshl_b32 s21, 1, s19
  v_mov_b32 v248, s21
  s_mov_b64 exec, 1
  buffer_atomic_or v248, v252, s[8:11], s20 offen sc0
  s_mov_b64 exec, -1
  s_mov_b32 s38, s21
wp_f3_f:
  s_cmp_eq_u32 s97, 3
  s_cbranch_scc1 wk_adone
wp_fin:
  s_cmp_lg_u32 s97, 0
  s_cbranch_scc1 wp_all
  v_readfirstlane_b32 s20, v254
  v_readfirstlane_b32 s21, v253
  s_and_b32 s21, s21, 0xffe0
  s_cselect_b32 s96, s20, 0
  s_cmp_eq_u32 s96, 0
  s_cbranch_scc1 wp_all
  v_mov_b32 v250, 1
  s_mov_b32 s20, 588288
  s_mov_b64 exec, 1
  buffer_atomic_add v250, v252, s[8:11], s20 offen sc0
  s_mov_b64 exec, -1
wp_all:
  v_mov_b32 v252, 0x40000000
  v_cmp_eq_u32 vcc, 0, v0
  s_nop 1
  v_cndmask_b32 v252, v252, v0, vcc
  s_mov_b32 s34, 0
  s_cmp_lg_u32 s16, 0
  s_cbranch_scc1 wp_w2
  s_getreg_b32 s24, hwreg(HW_REG_XCC_ID)
  s_sub_u32 s24, s24, 1
  s_and_b32 s24, s24, 7
  s_lshl_b32 s24, s24, 7
  s_add_u32 s24, s24, 586240
  s_cmp_lg_u32 s96, 0
  s_cbranch_scc1 wp_v0
  s_waitcnt vmcnt(0)
wp_v0:
  s_cmp_eq_u32 s97, 0
  s_cbranch_scc1 wp_v1
  s_waitcnt vmcnt(0)
wp_v1:
  s_waitcnt vmcnt(1)
  v_readfirstlane_b32 s20, v248
  s_and_b32 s20, s20, 14448
  s_xor_b32 s20, s20, s38
  s_cmp_lg_u32 s20, 14448
  s_cselect_b32 s20, 0, s38
  s_mov_b32 s38, 0
  s_cmp_eq_u32 s20, 0
  s_cbranch_scc1 wp_g3
  s_lshl_b32 s21, 65536, s17
  v_mov_b32 v248, s21
  s_mov_b32 s20, 586240
  v_lshlrev_b32 v247, 7, v0
  s_mov_b64 exec, 0xff
  buffer_atomic_or v248, v247, s[8:11], s20 offen
  s_mov_b64 exec, -1
wp_g3:
  v_readfirstlane_b32 s20, v248
  s_and_b32 s20, s20, 16383
  s_xor_b32 s20, s20, s37
  s_cmp_lg_u32 s20, 16383
  s_cselect_b32 s20, 0, s37
  s_mov_b32 s37, 0
  s_cmp_eq_u32 s20, 0
  s_cbranch_scc1 wp_g2
  s_lshl_b32 s21, 1, s17
  v_mov_b32 v248, s21
  s_mov_b32 s20, 586240
  v_lshlrev_b32 v247, 7, v0
  s_mov_b64 exec, 0xff
  buffer_atomic_or v248, v247, s[8:11], s20 offen
  s_mov_b64 exec, -1
wp_g2:
  s_cmp_lg_u32 s96, 0
  s_cbranch_scc1 wp_v_ok
  s_mov_b32 s30, 0
wp_v:
  buffer_load_dwordx2 v[64:65], off, s[12:15], 0 sc1
  buffer_load_dword v66, off, s[12:15], 0 offset:128 sc1
  s_waitcnt vmcnt(0)
  v_and_b32 v68, 0xffe0, v64
  v_min_u32 v68, v68, v66
  v_cmp_ne_u32 vcc, 1, v68
  s_cbranch_vccz wp_v_ok
  s_sleep 16
  s_add_u32 s30, s30, 1
  s_cmp_lt_u32 s30, 30
  s_cbranch_scc1 wp_v
  s_branch wp_w1
wp_v_ok:
  v_mov_b32 v64, 32
  s_cmp_eq_u32 s97, 2
  s_cselect_b32 s31, 1, 60
  s_cmp_eq_u32 s39, -1
  s_cselect_b32 s20, 4, 0
  s_add_u32 s24, s24, s20
  s_mov_b32 s30, 0
wp_w:
  buffer_load_dword v66, off, s[8:11], s24 sc1
  buffer_load_dword v67, off, s[8:11], s24 offset:4 sc1
  s_waitcnt vmcnt(0)
  v_or_b32 v66, s39, v66
  v_add_u32 v66, v66, v67
  v_cmp_ne_u32 vcc, 0, v66
  s_cbranch_vccz wp_w_ok
  s_sleep 8
  s_add_u32 s30, s30, 1
  s_cmp_lt_u32 s30, s31
  s_cbranch_scc1 wp_w
  s_branch wp_w1
wp_w_ok:
  s_branch wp_w2
wp_w1:
  v_readfirstlane_b32 s20, v64
  v_readfirstlane_b32 s21, v65
  s_and_b32 s20, s20, 0xffff
  s_cmp_lt_u32 s20, 32
  s_cselect_b32 s34, 2, 1
  s_add_u32 s32, s32, 1
  s_cmp_lt_u32 s32, 4000
  s_cselect_b32 s34, s34, 3
wp_w2:
  v_mov_b32 v6, 160032
  v_mov_b32 v7, s34
  s_barrier
  s_cmp_lg_u32 s16, 0
  s_cbranch_scc1 uni_7
  ds_write_b32 v6, v7
  s_waitcnt lgkmcnt(0)
uni_7:
  s_barrier
  ds_read_b32 v7, v6
  s_waitcnt lgkmcnt(0)
  v_readfirstlane_b32 s34, v7
  s_cmp_lg_u32 s34, 0
  s_cbranch_scc1 wp_bad
  s_cmp_lg_u32 s39, -1
  s_cbranch_scc1 wp_done
  s_mov_b32 s101, 0
  s_lshl_b32 s20, s101, 4
  s_lshr_b32 s21, s2, 3
  s_add_u32 s21, s21, s16
  s_and_b32 s21, s21, 3
  s_lshl_b32 s21, s21, 2
  s_add_u32 s20, s20, s21
  s_mul_i32 s21, s20, 14336
  s_add_u32 s21, s21, 655360
  s_add_u32 s22, s21, 0
  buffer_load_dwordx4 a[0:3], v2, s[8:11], s22 offen offset:0 sc1
  buffer_load_dwordx4 a[4:7], v2, s[8:11], s22 offen offset:1024 sc1
  buffer_load_dwordx4 a[8:11], v2, s[8:11], s22 offen offset:2048 sc1
  buffer_load_dwordx4 a[12:15], v2, s[8:11], s22 offen offset:3072 sc1
  s_add_u32 s22, s21, 4096
  buffer_load_dwordx4 a[16:19], v2, s[8:11], s22 offen offset:0 sc1
  buffer_load_dwordx4 a[20:23], v2, s[8:11], s22 offen offset:1024 sc1
  buffer_load_dwordx4 a[24:27], v2, s[8:11], s22 offen offset:2048 sc1
  buffer_load_dwordx4 a[28:31], v2, s[8:11], s22 offen offset:3072 sc1
  s_add_u32 s22, s21, 8192
  buffer_load_dwordx4 a[32:35], v2, s[8:11], s22 offen offset:0 sc1
  buffer_load_dwordx4 a[36:39], v2, s[8:11], s22 offen offset:1024 sc1
  buffer_load_dwordx4 a[40:43], v2, s[8:11], s22 offen offset:2048 sc1
  buffer_load_dwordx4 a[44:47], v2, s[8:11], s22 offen offset:3072 sc1
  s_add_u32 s22, s21, 12288
  buffer_load_dwordx4 a[48:51], v2, s[8:11], s22 offen offset:0 sc1
  buffer_load_dwordx4 a[52:55], v2, s[8:11], s22 offen offset:1024 sc1
  buffer_load_dwordx4 a[56:59], v2, s[8:11], s22 offen offset:2048 sc1
  buffer_load_dwordx4 a[60:63], v2, s[8:11], s22 offen offset:3072 sc1
  s_add_u32 s22, s21, 16384
  buffer_load_dwordx4 a[64:67], v2, s[8:11], s22 offen offset:0 sc1
  buffer_load_dwordx4 a[68:71], v2, s[8:11], s22 offen offset:1024 sc1
  buffer_load_dwordx4 a[72:75], v2, s[8:11], s22 offen offset:2048 sc1
  buffer_load_dwordx4 a[76:79], v2, s[8:11], s22 offen offset:3072 sc1
  s_add_u32 s22, s21, 20480
  buffer_load_dwordx4 a[80:83], v2, s[8:11], s22 offen offset:0 sc1
  buffer_load_dwordx4 a[84:87], v2, s[8:11], s22 offen offset:1024 sc1
  buffer_load_dwordx4 a[88:91], v2, s[8:11], s22 offen offset:2048 sc1
  buffer_load_dwordx4 a[92:95], v2, s[8:11], s22 offen offset:3072 sc1
  s_add_u32 s22, s21, 24576
  buffer_load_dwordx4 a[96:99], v2, s[8:11], s22 offen offset:0 sc1
  buffer_load_dwordx4 a[100:103], v2, s[8:11], s22 offen offset:1024 sc1
  buffer_load_dwordx4 a[104:107], v2, s[8:11], s22 offen offset:2048 sc1
  buffer_load_dwordx4 a[108:111], v2, s[8:11], s22 offen offset:3072 sc1
  s_add_u32 s22, s21, 28672
  buffer_load_dwordx4 a[112:115], v2, s[8:11], s22 offen offset:0 sc1
  buffer_load_dwordx4 a[116:119], v2, s[8:11], s22 offen offset:1024 sc1
  buffer_load_dwordx4 a[120:123], v2, s[8:11], s22 offen offset:2048 sc1
  buffer_load_dwordx4 a[124:127], v2, s[8:11], s22 offen offset:3072 sc1
  s_add_u32 s22, s21, 32768
  buffer_load_dwordx4 a[128:131], v2, s[8:11], s22 offen offset:0 sc1
  buffer_load_dwordx4 a[132:135], v2, s[8:11], s22 offen offset:1024 sc1
  buffer_load_dwordx4 a[136:139], v2, s[8:11], s22 offen offset:2048 sc1
  buffer_load_dwordx4 a[140:143], v2, s[8:11], s22 offen offset:3072 sc1
  s_add_u32 s22, s21, 36864
  buffer_load_dwordx4 a[144:147], v2, s[8:11], s22 offen offset:0 sc1
  buffer_load_dwordx4 a[148:151], v2, s[8:11], s22 offen offset:1024 sc1
  buffer_load_dwordx4 a[152:155], v2, s[8:11], s22 offen offset:2048 sc1
  buffer_load_dwordx4 a[156:159], v2, s[8:11], s22 offen offset:3072 sc1
  s_add_u32 s22, s21, 40960
  s_waitcnt vmcnt(40)
  buffer_load_dwordx4 a[160:163], v2, s[8:11], s22 offen offset:0 sc1
  buffer_load_dwordx4 a[164:167], v2, s[8:11], s22 offen offset:1024 sc1
  buffer_load_dwordx4 a[168:171], v2, s[8:11], s22 offen offset:2048 sc1
  buffer_load_dwordx4 a[172:175], v2, s[8:11], s22 offen offset:3072 sc1
  s_add_u32 s22, s21, 45056
  buffer_load_dwordx4 a[176:179], v2, s[8:11], s22 offen offset:0 sc1
  buffer_load_dwordx4 a[180:183], v2, s[8:11], s22 offen offset:1024 sc1
  buffer_load_dwordx4 a[184:187], v2, s[8:11], s22 offen offset:2048 sc1
  buffer_load_dwordx4 a[188:191], v2, s[8:11], s22 offen offset:3072 sc1
  s_add_u32 s22, s21, 49152
  buffer_load_dwordx4 a[192:195], v2, s[8:11], s22 offen offset:0 sc1
  buffer_load_dwordx4 a[196:199], v2, s[8:11], s22 offen offset:1024 sc1
  buffer_load_dwordx4 a[200:203], v2, s[8:11], s22 offen offset:2048 sc1
  buffer_load_dwordx4 a[204:207], v2, s[8:11], s22 offen offset:3072 sc1
  s_add_u32 s22, s21, 53248
  buffer_load_dwordx4 a[208:211], v2, s[8:11], s22 offen offset:0 sc1
  buffer_load_dwordx4 a[212:215], v2, s[8:11], s22 offen offset:1024 sc1
  buffer_load_dwordx4 a[216:219], v2, s[8:11], s22 offen offset:2048 sc1
  buffer_load_dwordx4 a[220:223], v2, s[8:11], s22 offen offset:3072 sc1
  s_mov_b32 s39, 0xffff0000
  s_branch wp_all
wp_bad:
  s_and_b32 s39, s39, 0xffff0000
  s_mov_b32 s97, 1
  s_cmp_eq_u32 s34, 1
  s_cbranch_scc1 wp_rep
  s_cmp_eq_u32 s34, 3
  s_cbranch_scc1 cA_abort
  s_load_dwordx8 s[40:47], s[0:1], 72
  s_load_dwordx4 s[48:51], s[0:1], 56
  s_waitcnt lgkmcnt(0)
  v_mov_b32 v4, 0x10001
  s_mov_b32 s18, 1
  s_branch ch_take
wp_rep:
  s_mov_b32 s101, -1
  s_load_dwordx8 s[40:47], s[0:1], 72
  s_load_dwordx4 s[48:51], s[0:1], 56
  s_waitcnt vmcnt(0) lgkmcnt(0)
  v_mov_b32 v4, 1
  v_mov_b32 v5, 20
  v_mov_b32 v6, 160000
  s_barrier
  s_cmp_lg_u32 s16, 0
  s_cbranch_scc1 wp_el1
  s_mov_b64 exec, 1
  buffer_atomic_add v4, v5, s[12:15], 0 offen sc0
  s_waitcnt vmcnt(0)
  ds_write_b32 v6, v4
  s_waitcnt lgkmcnt(0)
  s_mov_b64 exec, -1
wp_el1:
  s_barrier
  ds_read_b32 v4, v6
  s_waitcnt lgkmcnt(0)
  v_readfirstlane_b32 s33, v4
  v_and_b32 v1, 63, v0
  v_lshlrev_b32 v2, 4, v1
  v_lshrrev_b32 v3, 4, v1
  v_and_b32 v4, 15, v1
  v_lshrrev_b32 v5, 5, v1
  v_and_b32 v6, 31, v1
  v_xor_b32 v8, v6, v5
  v_lshlrev_b32 v8, 4, v8
  v_lshl_add_u32 v16, v5, 13, v8
  v_xor_b32 v17, 32, v16
  v_xor_b32 v18, 64, v16
  v_xor_b32 v19, 96, v16
  v_xor_b32 v20, 128, v16
  v_xor_b32 v21, 160, v16
  v_xor_b32 v22, 192, v16
  v_xor_b32 v23, 224, v16
  s_lshl_b32 s20, s16, 6
  v_xor_b32 v26, s20, v16
  v_xor_b32 v27, 32, v26
  s_and_b32 s33, s33, 511
  s_and_b32 s20, s33, 255
  s_cmp_ge_u32 s20, 224
  s_cselect_b32 s97, 1, 2
  s_cbranch_scc1 wp_all
  s_mul_i32 s17, s20, 4682
  s_lshr_b32 s17, s17, 16
  s_mul_i32 s23, s17, 14
  s_sub_u32 s19, s20, s23
  s_cmp_lt_u32 s19, 7
  s_cselect_b32 s18, 0, 7
  s_cselect_b32 s28, 0, 8
  s_sub_u32 s18, s19, s18
  s_add_u32 s28, s28, s16
  s_lshl_b32 s25, s16, 15
  s_add_u32 s25, s25, 32768
  s_lshl_b32 s26, s17, 9
  s_lshl_b32 s20, s17, 7
  s_lshr_b32 s21, s33, 8
  s_lshl_b32 s21, s21, 11
  s_add_u32 s20, s20, s21
  s_add_u32 s20, s20, 582144
  buffer_load_dword v5, off, s[8:11], s20 sc1
  s_waitcnt vmcnt(0)
  v_readfirstlane_b32 s34, v5
  v_mov_b32 v6, 160032
  s_nop 0
  v_mov_b32 v7, s34
  s_barrier
  s_cmp_lg_u32 s16, 0
  s_cbranch_scc1 uni_8
  ds_write_b32 v6, v7
  s_waitcnt lgkmcnt(0)
uni_8:
  s_barrier
  ds_read_b32 v7, v6
  s_waitcnt lgkmcnt(0)
  v_readfirstlane_b32 s34, v7
  s_cmp_lt_u32 s33, 256
  s_cselect_b32 s20, 0, 1935
  s_or_b32 s34, s34, s20
  s_bitcmp1_b32 s34, s19
  s_cbranch_scc1 wp_rep
  s_barrier
  s_cmp_lt_u32 s33, 256
  s_cbranch_scc1 wp_B
  s_branch wp_A0
wp_done:
  s_mov_b32 s97, s39
  s_cmp_lg_u32 s96, 0
  s_cbranch_scc1 wk_next
  s_cmp_lg_u32 s16, 0
  s_cbranch_scc1 ask_9
  v_mov_b32 v250, 1
  v_mov_b32 v251, 588288
  s_mov_b64 exec, 1
  buffer_atomic_add v250, v251, s[8:11], 0 offen sc0
  s_mov_b64 exec, -1
ask_9:
  s_branch wk_next
wk_loop:
  s_waitcnt vmcnt(0) lgkmcnt(0)
  s_getreg_b32 s22, hwreg(HW_REG_XCC_ID)
  s_and_b32 s22, s22, 15
  s_bitcmp0_b32 1, s22
  s_cbranch_scc1 wk_ni
  s_cmp_ge_u32 s96, 6
  s_cbranch_scc1 wk_ni
  s_mov_b32 s96, 6
  v_mov_b32 v4, 1
  v_mov_b32 v5, 587520
  v_mov_b32 v6, 160000
  s_barrier
  s_cmp_lg_u32 s16, 0
  s_cbranch_scc1 wk_ide1
  s_mov_b64 exec, 1
  buffer_atomic_add v4, v5, s[8:11], 0 offen sc0
  s_waitcnt vmcnt(0)
  ds_write_b32 v6, v4
  s_waitcnt lgkmcnt(0)
  s_mov_b64 exec, -1
wk_ide1:
  s_barrier
  ds_read_b32 v4, v6
  s_waitcnt lgkmcnt(0)
  v_readfirstlane_b32 s3, v4
  s_cmp_lt_u32 s3, 32
  s_cbranch_scc1 wk_done
wk_ni:
  s_getreg_b32 s22, hwreg(HW_REG_XCC_ID)
  s_and_b32 s22, s22, 15
  s_cmp_lg_u32 s22, 15
  s_cbranch_scc1 wk_ask
  s_cmp_eq_u32 s96, 7
  s_cbranch_scc0 wk_srv
wk_ask:
  v_readfirstlane_b32 s22, v250
  s_cmp_ge_u32 s22, 1264
  s_cbranch_scc1 wk_next
  s_cmp_lg_u32 s16, 0
  s_cbranch_scc1 ask_10
  v_mov_b32 v250, 1
  v_mov_b32 v251, 588288
  s_mov_b64 exec, 1
  buffer_atomic_add v250, v251, s[8:11], 0 offen sc0
  s_mov_b64 exec, -1
ask_10:
wk_next:
  v_mov_b32 v6, 160000
  s_waitcnt vmcnt(0)
  s_barrier
  s_cmp_lg_u32 s16, 0
  s_cbranch_scc1 wk_n1
  s_mov_b64 exec, 1
  ds_write_b32 v6, v250
  s_mov_b64 exec, -1
  s_waitcnt lgkmcnt(0)
wk_n1:
  s_barrier
  ds_read_b32 v4, v6
  s_waitcnt lgkmcnt(0)
  v_readfirstlane_b32 s3, v4
  s_cmp_ge_u32 s3, 1264
  s_cbranch_scc1 wk_done
  v_mov_b32 v250, 0
  v_mov_b32 v251, 587264
  s_cmp_lg_u32 s3, 1263
  s_cbranch_scc1 wk_nl
  v_mov_b32 v5, 1264
  s_mov_b64 exec, 1
  buffer_store_dword v5, v251, s[8:11], 0 offen sc1
  s_mov_b64 exec, -1
wk_nl:
  v_and_b32 v1, 63, v0
  v_lshlrev_b32 v2, 4, v1
  v_lshrrev_b32 v3, 4, v1
  v_and_b32 v4, 15, v1
  s_cmp_lt_u32 s3, 112
  s_cbranch_scc1 wk_n2
  s_cmp_eq_u32 s97, 0
  s_cbranch_scc1 wk_n2
  v_mov_b32 v250, s3
  s_mov_b32 s96, 1
  s_mov_b32 s97, 1
  s_mov_b32 s39, 0
  s_mov_b32 s37, 0
  s_mov_b32 s38, 0
  s_mov_b32 s32, 0
  s_branch wp_all
wk_n2:
  s_sub_u32 s20, s3, 288
  s_cmp_ge_u32 s20, 352
  s_cbranch_scc1 wk_nr
  s_cmp_ge_u32 s20, 320
  s_cbranch_scc1 wk_srv
  s_add_u32 s3, s3, 32
wk_nr:
  s_cmp_ge_u32 s3, 752
  s_cbranch_scc1 wk_tok
  s_cmp_ge_u32 s3, 640
  s_cbranch_scc1 wk_s4d
  s_cmp_ge_u32 s3, 448
  s_cbranch_scc1 wk_full
  s_cmp_ge_u32 s3, 320
  s_cbranch_scc1 wk_adef
  s_cmp_ge_u32 s3, 288
  s_cbranch_scc1 wk_srv
  s_and_b32 s17, s3, 15
  s_add_u32 s17, s17, 16
  s_cmp_ge_u32 s3, 224
  s_cbranch_scc1 wk_half
  s_cmp_ge_u32 s3, 112
  s_cselect_b32 s18, 1, 0
  s_cselect_b32 s20, 112, 0
  s_sub_u32 s34, s3, s20
  s_lshr_b32 s34, s34, 4
  s_lshl_b32 s34, s34, 1
  s_add_u32 s35, s34, 2
  s_branch wk_gemm
wk_adef:
  s_mov_b32 s101, -1
  s_load_dwordx8 s[40:47], s[0:1], 72
  s_sub_u32 s20, s3, 320
  s_getreg_b32 s33, hwreg(HW_REG_XCC_ID)
  s_sub_u32 s33, s33, 2
  s_and_b32 s33, s33, 7
  s_min_u32 s33, s33, 7
  s_mov_b32 s35, 7
wk_adc:
  s_lshl_b32 s34, s33, 7
  s_add_u32 s34, s34, 589312
  v_mov_b32 v4, 1
  v_mov_b32 v5, s34
  v_mov_b32 v6, 160000
  s_barrier
  s_cmp_lg_u32 s16, 0
  s_cbranch_scc1 wk_ade1
  s_mov_b64 exec, 1
  buffer_atomic_add v4, v5, s[8:11], 0 offen sc0
  s_waitcnt vmcnt(0)
  ds_write_b32 v6, v4
  s_waitcnt lgkmcnt(0)
  s_mov_b64 exec, -1
wk_ade1:
  s_barrier
  ds_read_b32 v4, v6
  s_waitcnt lgkmcnt(0)
  v_readfirstlane_b32 s20, v4
  s_cmp_lt_u32 s20, 16
  s_cbranch_scc1 wk_adg
  s_mov_b32 s33, s35
  s_sub_u32 s35, s35, 1
  s_max_i32 s35, s35, 0
  s_branch wk_adc
wk_adg:
  s_lshl_b32 s33, s33, 4
  s_add_u32 s20, s20, s33
  v_and_b32 v1, 63, v0
  v_lshlrev_b32 v2, 4, v1
  v_lshrrev_b32 v3, 4, v1
  v_and_b32 v4, 15, v1
  s_lshr_b32 s33, s20, 2
  s_mul_i32 s33, s33, 7
  s_and_b32 s20, s20, 3
  s_add_u32 s33, s33, s20
  s_mov_b32 s97, 3
  v_mov_b32 v252, 0x40000000
  v_cmp_eq_u32 vcc, 0, v0
  s_nop 1
  v_cndmask_b32 v252, v252, v0, vcc
  v_lshrrev_b32 v5, 5, v1
  v_and_b32 v6, 31, v1
  v_xor_b32 v8, v6, v5
  v_lshlrev_b32 v8, 4, v8
  v_lshl_add_u32 v16, v5, 13, v8
  v_xor_b32 v17, 32, v16
  v_xor_b32 v18, 64, v16
  v_xor_b32 v19, 96, v16
  v_xor_b32 v20, 128, v16
  v_xor_b32 v21, 160, v16
  v_xor_b32 v22, 192, v16
  v_xor_b32 v23, 224, v16
  s_lshl_b32 s20, s16, 6
  v_xor_b32 v26, s20, v16
  v_xor_b32 v27, 32, v26
  s_mul_i32 s17, s33, 4682
  s_lshr_b32 s17, s17, 16
  s_mul_i32 s23, s17, 14
  s_sub_u32 s19, s33, s23
  s_cmp_lt_u32 s19, 7
  s_cselect_b32 s18, 0, 7
  s_cselect_b32 s28, 0, 8
  s_sub_u32 s18, s19, s18
  s_add_u32 s28, s28, s16
  s_lshl_b32 s25, s16, 15
  s_add_u32 s25, s25, 32768
  s_lshl_b32 s26, s17, 9
  s_waitcnt lgkmcnt(0)
  s_barrier
  s_branch wp_A0
wk_adone:
  s_mov_b32 s97, 0
  s_branch wk_loop
wk_half:
  s_sub_u32 s20, s3, 224
  s_lshr_b32 s18, s20, 5
  s_add_u32 s18, s18, 2
  s_bitcmp1_b32 s20, 4
  s_cselect_b32 s34, 7, 0
  s_add_u32 s35, s34, 7
  s_branch wk_gemm
wk_full:
  s_sub_u32 s20, s3, 384
  s_and_b32 s17, s20, 15
  s_lshr_b32 s18, s20, 4
  s_mov_b32 s34, 0
  s_mov_b32 s35, 14
  s_cmp_lt_u32 s18, 8
  s_cselect_b32 s21, 16, 0
  s_add_u32 s17, s17, s21
  s_and_b32 s18, s18, 7
  s_cmp_ge_u32 s17, 16
  s_cbranch_scc1 wk_gemm
  s_load_dwordx8 s[40:47], s[0:1], 0
  s_load_dwordx2 s[48:49], s[0:1], 32
  s_sub_u32 s21, s3, 512
  v_min_u32 v12, 111, v0
  v_lshlrev_b32 v12, 7, v12
  v_min_u32 v13, 13, v0
  v_lshlrev_b32 v13, 7, v13
  s_mul_i32 s22, s21, 14336
  s_mul_i32 s21, s21, 1792
  s_waitcnt lgkmcnt(0)
  s_cmp_ge_u32 s16, 2
  s_cbranch_scc1 wk_up
  s_mov_b32 s60, s40
  s_and_b32 s61, s41, 0xffff
  s_mov_b32 s62, 1835008
  s_mov_b32 s63, 0x20000
  buffer_load_dword v14, v12, s[60:63], s22 offen
  s_mov_b32 s60, s42
  s_and_b32 s61, s43, 0xffff
  s_mov_b32 s62, 229376
  s_mov_b32 s63, 0x20000
  buffer_load_dword v14, v13, s[60:63], s21 offen
  s_mov_b32 s60, s44
  s_and_b32 s61, s45, 0xffff
  s_mov_b32 s62, 229376
  s_mov_b32 s63, 0x20000
  buffer_load_dword v14, v13, s[60:63], s21 offen
  s_mov_b32 s60, s46
  s_and_b32 s61, s47, 0xffff
  s_mov_b32 s62, 229376
  s_mov_b32 s63, 0x20000
  buffer_load_dword v14, v13, s[60:63], s21 offen
  s_mov_b32 s60, s48
  s_and_b32 s61, s49, 0xffff
  s_mov_b32 s62, 229376
  s_mov_b32 s63, 0x20000
  buffer_load_dword v14, v13, s[60:63], s21 offen
wk_up:
  s_lshl_b32 s27, s17, 7
  s_add_u32 s27, s27, 584192
  s_mov_b32 s28, 16383
  s_mov_b32 s30, 0
wk_aw:
  buffer_load_dword v9, off, s[8:11], s27  sc1
  s_waitcnt vmcnt(0)
  v_and_b32 v10, s28, v9
  v_cmp_ne_u32 vcc, s28, v10
  s_cbranch_vccz wk_aw_ok
  s_sleep 3
  s_add_u32 s30, s30, 1
  s_cmp_lt_u32 s30, 400000
  s_cbranch_scc1 wk_aw
  s_branch cA_abort
wk_aw_ok:
wk_gemm:
  s_lshl_b32 s20, s18, 4
  s_lshr_b32 s21, s2, 3
  s_add_u32 s21, s21, s16
  s_and_b32 s21, s21, 3
  s_lshl_b32 s21, s21, 2
  s_add_u32 s20, s20, s21
  s_mul_i32 s21, s20, 14336
  s_add_u32 s21, s21, 655360
  s_mul_i32 s23, s17, 401408
  s_and_b32 s22, s16, 1
  s_mul_i32 s22, s22, 7168
  s_add_u32 s23, s23, s22
  s_add_u32 s23, s23, 33554432
  s_lshr_b32 s22, s16, 1
  s_mul_i32 s22, s22, 14336
  s_add_u32 s23, s23, s22
  s_mul_i32 s27, s16, 7168
  s_lshr_b32 s28, s20, 1
  s_cmp_lt_u32 s17, 16
  s_cbranch_scc0 wg_vo
  s_add_u32 s23, s23, s22
  s_lshl_b32 s29, s28, 4
  s_add_u32 s29, s29, s17
  s_mul_i32 s29, s29, 28672
  s_add_u32 s29, s29, 46399488
  s_mov_b32 s31, 0
  s_lshr_b32 s24, s34, 1
  s_lshl_b32 s24, s24, 2
  s_and_b32 s25, s34, 1
  s_add_u32 s24, s24, s25
  s_mul_i32 s24, s24, 14336
  s_add_u32 s24, s24, s23
  s_add_u32 m0, s31, s27
  s_nop 0
  buffer_load_dwordx4 v2, s[8:11], s24 offen offset:0 sc1 lds
  buffer_load_dwordx4 v2, s[8:11], s24 offen offset:1024 sc1 lds
  buffer_load_dwordx4 v2, s[8:11], s24 offen offset:2048 sc1 lds
  buffer_load_dwordx4 v2, s[8:11], s24 offen offset:3072 sc1 lds
  s_add_u32 m0, m0, 4096
  s_add_u32 s24, s24, 4096
  buffer_load_dwordx4 v2, s[8:11], s24 offen offset:0 sc1 lds
  buffer_load_dwordx4 v2, s[8:11], s24 offen offset:1024 sc1 lds
  buffer_load_dwordx4 v2, s[8:11], s24 offen offset:2048 sc1 lds
  s_sub_u32 s36, s35, 1
  s_add_u32 s30, s34, 1
  s_min_u32 s30, s30, s36
  s_mov_b32 s31, 28672
  s_lshr_b32 s24, s30, 1
  s_lshl_b32 s24, s24, 2
  s_and_b32 s25, s30, 1
  s_add_u32 s24, s24, s25
  s_mul_i32 s24, s24, 14336
  s_add_u32 s24, s24, s23
  s_add_u32 m0, s31, s27
  s_nop 0
  buffer_load_dwordx4 v2, s[8:11], s24 offen offset:0 sc1 lds
  buffer_load_dwordx4 v2, s[8:11], s24 offen offset:1024 sc1 lds
  buffer_load_dwordx4 v2, s[8:11], s24 offen offset:2048 sc1 lds
  buffer_load_dwordx4 v2, s[8:11], s24 offen offset:3072 sc1 lds
  s_add_u32 m0, m0, 4096
  s_add_u32 s24, s24, 4096
  buffer_load_dwordx4 v2, s[8:11], s24 offen offset:0 sc1 lds
  buffer_load_dwordx4 v2, s[8:11], s24 offen offset:1024 sc1 lds
  buffer_load_dwordx4 v2, s[8:11], s24 offen offset:2048 sc1 lds
  s_mov_b32 s19, s34
  s_mov_b32 s32, 0
  s_mov_b32 s33, 57344
  s_cmp_eq_u32 s18, s101
  s_cbranch_scc1 wg_f_hx
  s_add_u32 s22, s21, 0
  buffer_load_dwordx4 a[0:3], v2, s[8:11], s22 offen offset:0 sc1
  buffer_load_dwordx4 a[4:7], v2, s[8:11], s22 offen offset:1024 sc1
  buffer_load_dwordx4 a[8:11], v2, s[8:11], s22 offen offset:2048 sc1
  buffer_load_dwordx4 a[12:15], v2, s[8:11], s22 offen offset:3072 sc1
  s_add_u32 s22, s21, 4096
  buffer_load_dwordx4 a[16:19], v2, s[8:11], s22 offen offset:0 sc1
  buffer_load_dwordx4 a[20:23], v2, s[8:11], s22 offen offset:1024 sc1
  buffer_load_dwordx4 a[24:27], v2, s[8:11], s22 offen offset:2048 sc1
  buffer_load_dwordx4 a[28:31], v2, s[8:11], s22 offen offset:3072 sc1
  s_add_u32 s22, s21, 8192
  buffer_load_dwordx4 a[32:35], v2, s[8:11], s22 offen offset:0 sc1
  buffer_load_dwordx4 a[36:39], v2, s[8:11], s22 offen offset:1024 sc1
  buffer_load_dwordx4 a[40:43], v2, s[8:11], s22 offen offset:2048 sc1
  buffer_load_dwordx4 a[44:47], v2, s[8:11], s22 offen offset:3072 sc1
  s_add_u32 s22, s21, 12288
  buffer_load_dwordx4 a[48:51], v2, s[8:11], s22 offen offset:0 sc1
  buffer_load_dwordx4 a[52:55], v2, s[8:11], s22 offen offset:1024 sc1
  buffer_load_dwordx4 a[56:59], v2, s[8:11], s22 offen offset:2048 sc1
  buffer_load_dwordx4 a[60:63], v2, s[8:11], s22 offen offset:3072 sc1
  s_add_u32 s22, s21, 16384
  buffer_load_dwordx4 a[64:67], v2, s[8:11], s22 offen offset:0 sc1
  buffer_load_dwordx4 a[68:71], v2, s[8:11], s22 offen offset:1024 sc1
  buffer_load_dwordx4 a[72:75], v2, s[8:11], s22 offen offset:2048 sc1
  buffer_load_dwordx4 a[76:79], v2, s[8:11], s22 offen offset:3072 sc1
  s_add_u32 s22, s21, 20480
  buffer_load_dwordx4 a[80:83], v2, s[8:11], s22 offen offset:0 sc1
  buffer_load_dwordx4 a[84:87], v2, s[8:11], s22 offen offset:1024 sc1
  buffer_load_dwordx4 a[88:91], v2, s[8:11], s22 offen offset:2048 sc1
  buffer_load_dwordx4 a[92:95], v2, s[8:11], s22 offen offset:3072 sc1
  s_add_u32 s22, s21, 24576
  buffer_load_dwordx4 a[96:99], v2, s[8:11], s22 offen offset:0 sc1
  buffer_load_dwordx4 a[100:103], v2, s[8:11], s22 offen offset:1024 sc1
  buffer_load_dwordx4 a[104:107], v2, s[8:11], s22 offen offset:2048 sc1
  buffer_load_dwordx4 a[108:111], v2, s[8:11], s22 offen offset:3072 sc1
  s_add_u32 s22, s21, 28672
  buffer_load_dwordx4 a[112:115], v2, s[8:11], s22 offen offset:0 sc1
  buffer_load_dwordx4 a[116:119], v2, s[8:11], s22 offen offset:1024 sc1
  buffer_load_dwordx4 a[120:123], v2, s[8:11], s22 offen offset:2048 sc1
  buffer_load_dwordx4 a[124:127], v2, s[8:11], s22 offen offset:3072 sc1
  s_add_u32 s22, s21, 32768
  buffer_load_dwordx4 a[128:131], v2, s[8:11], s22 offen offset:0 sc1
  buffer_load_dwordx4 a[132:135], v2, s[8:11], s22 offen offset:1024 sc1
  buffer_load_dwordx4 a[136:139], v2, s[8:11], s22 offen offset:2048 sc1
  buffer_load_dwordx4 a[140:143], v2, s[8:11], s22 offen offset:3072 sc1
  s_add_u32 s22, s21, 36864
  buffer_load_dwordx4 a[144:147], v2, s[8:11], s22 offen offset:0 sc1
  buffer_load_dwordx4 a[148:151], v2, s[8:11], s22 offen offset:1024 sc1
  buffer_load_dwordx4 a[152:155], v2, s[8:11], s22 offen offset:2048 sc1
  buffer_load_dwordx4 a[156:159], v2, s[8:11], s22 offen offset:3072 sc1
  s_add_u32 s22, s21, 40960
  s_waitcnt vmcnt(40)
  buffer_load_dwordx4 a[160:163], v2, s[8:11], s22 offen offset:0 sc1
  buffer_load_dwordx4 a[164:167], v2, s[8:11], s22 offen offset:1024 sc1
  buffer_load_dwordx4 a[168:171], v2, s[8:11], s22 offen offset:2048 sc1
  buffer_load_dwordx4 a[172:175], v2, s[8:11], s22 offen offset:3072 sc1
  s_add_u32 s22, s21, 45056
  buffer_load_dwordx4 a[176:179], v2, s[8:11], s22 offen offset:0 sc1
  buffer_load_dwordx4 a[180:183], v2, s[8:11], s22 offen offset:1024 sc1
  buffer_load_dwordx4 a[184:187], v2, s[8:11], s22 offen offset:2048 sc1
  buffer_load_dwordx4 a[188:191], v2, s[8:11], s22 offen offset:3072 sc1
  s_add_u32 s22, s21, 49152
  buffer_load_dwordx4 a[192:195], v2, s[8:11], s22 offen offset:0 sc1
  buffer_load_dwordx4 a[196:199], v2, s[8:11], s22 offen offset:1024 sc1
  buffer_load_dwordx4 a[200:203], v2, s[8:11], s22 offen offset:2048 sc1
  buffer_load_dwordx4 a[204:207], v2, s[8:11], s22 offen offset:3072 sc1
  s_add_u32 s22, s21, 53248
  buffer_load_dwordx4 a[208:211], v2, s[8:11], s22 offen offset:0 sc1
  buffer_load_dwordx4 a[212:215], v2, s[8:11], s22 offen offset:1024 sc1
  buffer_load_dwordx4 a[216:219], v2, s[8:11], s22 offen offset:2048 sc1
  buffer_load_dwordx4 a[220:223], v2, s[8:11], s22 offen offset:3072 sc1
wg_f_hx:
  s_mov_b32 s101, -1
  s_waitcnt vmcnt(0)
  s_barrier
  s_mov_b32 s40, 0
  s_mov_b32 s41, 0x40000000
  v_mov_b32 v5, v2
  ds_read_b128 v[8:11], v5 offset:0
  ds_read_b128 v[12:15], v5 offset:14336
  ds_read_b128 v[16:19], v5 offset:1024
  ds_read_b128 v[20:23], v5 offset:15360
  ds_read_b128 v[24:27], v5 offset:2048
  s_waitcnt lgkmcnt(4)
.p2align 6
wg_f_loop:
  v_mfma_f32_16x16x32_bf16 v[40:43], v[8:11], a[0:3], 0
  ds_read_b128 v[28:31], v5 offset:16384
  v_mfma_f32_16x16x32_bf16 v[44:47], v[8:11], a[56:59], 0
  v_mfma_f32_16x16x32_bf16 v[48:51], v[8:11], a[112:115], 0
  v_mfma_f32_16x16x32_bf16 v[52:55], v[8:11], a[168:171], 0
  s_waitcnt lgkmcnt(4)
  s_lshl_b32 s42, s40, 10
  v_mfma_f32_16x16x32_bf16 v[56:59], v[12:15], a[0:3], 0
  ds_read_b128 v[32:35], v5 offset:3072
  v_mfma_f32_16x16x32_bf16 v[60:63], v[12:15], a[56:59], 0
  s_add_u32 s42, s42, s41
  v_cvt_pk_bf16_f32 v72, v96, v97
  v_mfma_f32_16x16x32_bf16 v[64:67], v[12:15], a[112:115], 0
  v_cvt_pk_bf16_f32 v73, v98, v99
  v_cvt_pk_bf16_f32 v74, v112, v113
  v_mfma_f32_16x16x32_bf16 v[68:71], v[12:15], a[168:171], 0
  s_waitcnt lgkmcnt(4)
  v_cvt_pk_bf16_f32 v75, v114, v115
  v_mfma_f32_16x16x32_bf16 v[40:43], v[16:19], a[4:7], v[40:43]
  ds_read_b128 v[8:11], v5 offset:17408
  v_mfma_f32_16x16x32_bf16 v[44:47], v[16:19], a[60:63], v[44:47]
  s_add_u32 s43, s42, 0
  v_mfma_f32_16x16x32_bf16 v[48:51], v[16:19], a[116:119], v[48:51]
  buffer_store_dwordx4 v[72:75], v2, s[8:11], s43 offen sc1
  v_cvt_pk_bf16_f32 v76, v100, v101
  v_mfma_f32_16x16x32_bf16 v[52:55], v[16:19], a[172:175], v[52:55]
  s_waitcnt lgkmcnt(4)
  v_cvt_pk_bf16_f32 v77, v102, v103
  v_mfma_f32_16x16x32_bf16 v[56:59], v[20:23], a[4:7], v[56:59]
  ds_read_b128 v[12:15], v5 offset:4096
  v_mfma_f32_16x16x32_bf16 v[60:63], v[20:23], a[60:63], v[60:63]
  v_cvt_pk_bf16_f32 v78, v116, v117
  v_cvt_pk_bf16_f32 v79, v118, v119
  v_mfma_f32_16x16x32_bf16 v[64:67], v[20:23], a[116:119], v[64:67]
  s_add_u32 s43, s42, 14336
  v_mfma_f32_16x16x32_bf16 v[68:71], v[20:23], a[172:175], v[68:71]
  s_waitcnt lgkmcnt(4)
  buffer_store_dwordx4 v[76:79], v2, s[8:11], s43 offen sc1
  v_mfma_f32_16x16x32_bf16 v[40:43], v[24:27], a[8:11], v[40:43]
  ds_read_b128 v[16:19], v5 offset:18432
  v_mfma_f32_16x16x32_bf16 v[44:47], v[24:27], a[64:67], v[44:47]
  v_cvt_pk_bf16_f32 v80, v104, v105
  v_cvt_pk_bf16_f32 v81, v106, v107
  v_mfma_f32_16x16x32_bf16 v[48:51], v[24:27], a[120:123], v[48:51]
  v_cvt_pk_bf16_f32 v82, v120, v121
  v_cvt_pk_bf16_f32 v83, v122, v123
  v_mfma_f32_16x16x32_bf16 v[52:55], v[24:27], a[176:179], v[52:55]
  s_waitcnt lgkmcnt(4)
  s_add_u32 s43, s42, 458752
  v_mfma_f32_16x16x32_bf16 v[56:59], v[28:31], a[8:11], v[56:59]
  ds_read_b128 v[20:23], v5 offset:5120
  v_mfma_f32_16x16x32_bf16 v[60:63], v[28:31], a[64:67], v[60:63]
  buffer_store_dwordx4 v[80:83], v2, s[8:11], s43 offen sc1
  v_cvt_pk_bf16_f32 v84, v108, v109
  v_mfma_f32_16x16x32_bf16 v[64:67], v[28:31], a[120:123], v[64:67]
  v_cvt_pk_bf16_f32 v85, v110, v111
  v_cvt_pk_bf16_f32 v86, v124, v125
  v_mfma_f32_16x16x32_bf16 v[68:71], v[28:31], a[176:179], v[68:71]
  s_waitcnt lgkmcnt(4)
  v_cvt_pk_bf16_f32 v87, v126, v127
  v_mfma_f32_16x16x32_bf16 v[40:43], v[32:35], a[12:15], v[40:43]
  ds_read_b128 v[24:27], v5 offset:19456
  v_mfma_f32_16x16x32_bf16 v[44:47], v[32:35], a[68:71], v[44:47]
  s_add_u32 s43, s42, 473088
  v_mfma_f32_16x16x32_bf16 v[48:51], v[32:35], a[124:127], v[48:51]
  buffer_store_dwordx4 v[84:87], v2, s[8:11], s43 offen sc1
  v_mfma_f32_16x16x32_bf16 v[52:55], v[32:35], a[180:183], v[52:55]
  s_waitcnt lgkmcnt(4)
  s_add_u32 s30, s19, 2
  s_lshr_b32 s24, s30, 1
  s_lshl_b32 s24, s24, 2
  s_and_b32 s25, s30, 1
  s_add_u32 s24, s24, s25
  s_mul_i32 s24, s24, 14336
  v_mfma_f32_16x16x32_bf16 v[56:59], v[8:11], a[12:15], v[56:59]
  ds_read_b128 v[28:31], v5 offset:6144
  v_mfma_f32_16x16x32_bf16 v[60:63], v[8:11], a[68:71], v[60:63]
  s_add_u32 s24, s24, s23
  s_cmp_lt_u32 s30, s35
  s_cselect_b32 s24, s24, 0x40000000
  v_mfma_f32_16x16x32_bf16 v[64:67], v[8:11], a[124:127], v[64:67]
  s_add_u32 m0, s33, s27
  s_nop 0
  buffer_load_dwordx4 v2, s[8:11], s24 offen offset:0 sc1 lds
  v_mfma_f32_16x16x32_bf16 v[68:71], v[8:11], a[180:183], v[68:71]
  s_waitcnt lgkmcnt(4)
  v_mfma_f32_16x16x32_bf16 v[40:43], v[12:15], a[16:19], v[40:43]
  ds_read_b128 v[32:35], v5 offset:20480
  v_mfma_f32_16x16x32_bf16 v[44:47], v[12:15], a[72:75], v[44:47]
  v_mfma_f32_16x16x32_bf16 v[48:51], v[12:15], a[128:131], v[48:51]
  v_mfma_f32_16x16x32_bf16 v[52:55], v[12:15], a[184:187], v[52:55]
  s_waitcnt lgkmcnt(4)
  buffer_load_dwordx4 v2, s[8:11], s24 offen offset:1024 sc1 lds
  v_mfma_f32_16x16x32_bf16 v[56:59], v[16:19], a[16:19], v[56:59]
  ds_read_b128 v[8:11], v5 offset:7168
  v_mfma_f32_16x16x32_bf16 v[60:63], v[16:19], a[72:75], v[60:63]
  v_mfma_f32_16x16x32_bf16 v[64:67], v[16:19], a[128:131], v[64:67]
  v_mfma_f32_16x16x32_bf16 v[68:71], v[16:19], a[184:187], v[68:71]
  s_waitcnt lgkmcnt(4)
  v_mfma_f32_16x16x32_bf16 v[40:43], v[20:23], a[20:23], v[40:43]
  ds_read_b128 v[12:15], v5 offset:21504
  v_mfma_f32_16x16x32_bf16 v[44:47], v[20:23], a[76:79], v[44:47]
  buffer_load_dwordx4 v2, s[8:11], s24 offen offset:2048 sc1 lds
  v_mfma_f32_16x16x32_bf16 v[48:51], v[20:23], a[132:135], v[48:51]
  v_mfma_f32_16x16x32_bf16 v[52:55], v[20:23], a[188:191], v[52:55]
  s_waitcnt lgkmcnt(4)
  v_mfma_f32_16x16x32_bf16 v[56:59], v[24:27], a[20:23], v[56:59]
  ds_read_b128 v[16:19], v5 offset:8192
  v_mfma_f32_16x16x32_bf16 v[60:63], v[24:27], a[76:79], v[60:63]
  v_mfma_f32_16x16x32_bf16 v[64:67], v[24:27], a[132:135], v[64:67]
  buffer_load_dwordx4 v2, s[8:11], s24 offen offset:3072 sc1 lds
  v_mfma_f32_16x16x32_bf16 v[68:71], v[24:27], a[188:191], v[68:71]
  s_waitcnt lgkmcnt(4)
  v_mfma_f32_16x16x32_bf16 v[40:43], v[28:31], a[24:27], v[40:43]
  ds_read_b128 v[20:23], v5 offset:22528
  v_mfma_f32_16x16x32_bf16 v[44:47], v[28:31], a[80:83], v[44:47]
  v_mfma_f32_16x16x32_bf16 v[48:51], v[28:31], a[136:139], v[48:51]
  v_mfma_f32_16x16x32_bf16 v[52:55], v[28:31], a[192:195], v[52:55]
  s_waitcnt lgkmcnt(4)
  s_add_u32 m0, m0, 4096
  s_add_u32 s24, s24, 4096
  buffer_load_dwordx4 v2, s[8:11], s24 offen offset:0 sc1 lds
  v_mfma_f32_16x16x32_bf16 v[56:59], v[32:35], a[24:27], v[56:59]
  ds_read_b128 v[24:27], v5 offset:9216
  v_mfma_f32_16x16x32_bf16 v[60:63], v[32:35], a[80:83], v[60:63]
  v_mfma_f32_16x16x32_bf16 v[64:67], v[32:35], a[136:139], v[64:67]
  v_mfma_f32_16x16x32_bf16 v[68:71], v[32:35], a[192:195], v[68:71]
  s_waitcnt lgkmcnt(4)
  v_mfma_f32_16x16x32_bf16 v[40:43], v[8:11], a[28:31], v[40:43]
  ds_read_b128 v[28:31], v5 offset:23552
  v_mfma_f32_16x16x32_bf16 v[44:47], v[8:11], a[84:87], v[44:47]
  buffer_load_dwordx4 v2, s[8:11], s24 offen offset:1024 sc1 lds
  v_mfma_f32_16x16x32_bf16 v[48:51], v[8:11], a[140:143], v[48:51]
  v_mfma_f32_16x16x32_bf16 v[52:55], v[8:11], a[196:199], v[52:55]
  s_waitcnt lgkmcnt(4)
  v_mfma_f32_16x16x32_bf16 v[56:59], v[12:15], a[28:31], v[56:59]
  ds_read_b128 v[32:35], v5 offset:10240
  v_mfma_f32_16x16x32_bf16 v[60:63], v[12:15], a[84:87], v[60:63]
  v_mfma_f32_16x16x32_bf16 v[64:67], v[12:15], a[140:143], v[64:67]
  buffer_load_dwordx4 v2, s[8:11], s24 offen offset:2048 sc1 lds
  v_mfma_f32_16x16x32_bf16 v[68:71], v[12:15], a[196:199], v[68:71]
  s_waitcnt lgkmcnt(4)
  v_mfma_f32_16x16x32_bf16 v[40:43], v[16:19], a[32:35], v[40:43]
  ds_read_b128 v[8:11], v5 offset:24576
  v_mfma_f32_16x16x32_bf16 v[44:47], v[16:19], a[88:91], v[44:47]
  v_mfma_f32_16x16x32_bf16 v[48:51], v[16:19], a[144:147], v[48:51]
  v_mfma_f32_16x16x32_bf16 v[52:55], v[16:19], a[200:203], v[52:55]
  s_waitcnt lgkmcnt(4)
  s_add_u32 s33, s33, 28672
  s_cmp_eq_u32 s33, 114688
  s_cselect_b32 s33, 0, s33
  v_mfma_f32_16x16x32_bf16 v[56:59], v[20:23], a[32:35], v[56:59]
  ds_read_b128 v[12:15], v5 offset:11264
  v_mfma_f32_16x16x32_bf16 v[60:63], v[20:23], a[88:91], v[60:63]
  s_add_u32 s32, s32, 28672
  s_cmp_eq_u32 s32, 114688
  s_cselect_b32 s32, 0, s32
  v_mfma_f32_16x16x32_bf16 v[64:67], v[20:23], a[144:147], v[64:67]
  v_add_u32 v128, s32, v2
  v_mfma_f32_16x16x32_bf16 v[68:71], v[20:23], a[200:203], v[68:71]
  s_waitcnt lgkmcnt(4)
  v_mfma_f32_16x16x32_bf16 v[40:43], v[24:27], a[36:39], v[40:43]
  ds_read_b128 v[16:19], v5 offset:25600
  v_mfma_f32_16x16x32_bf16 v[44:47], v[24:27], a[92:95], v[44:47]
  v_mfma_f32_16x16x32_bf16 v[48:51], v[24:27], a[148:151], v[48:51]
  v_mfma_f32_16x16x32_bf16 v[52:55], v[24:27], a[204:207], v[52:55]
  s_waitcnt lgkmcnt(4)
  v_mfma_f32_16x16x32_bf16 v[56:59], v[28:31], a[36:39], v[56:59]
  ds_read_b128 v[20:23], v5 offset:12288
  v_mfma_f32_16x16x32_bf16 v[60:63], v[28:31], a[92:95], v[60:63]
  v_mfma_f32_16x16x32_bf16 v[64:67], v[28:31], a[148:151], v[64:67]
  v_mfma_f32_16x16x32_bf16 v[68:71], v[28:31], a[204:207], v[68:71]
  s_waitcnt lgkmcnt(4)
  v_mfma_f32_16x16x32_bf16 v[40:43], v[32:35], a[40:43], v[40:43]
  ds_read_b128 v[24:27], v5 offset:26624
  v_mfma_f32_16x16x32_bf16 v[44:47], v[32:35], a[96:99], v[44:47]
  v_mfma_f32_16x16x32_bf16 v[48:51], v[32:35], a[152:155], v[48:51]
  v_mfma_f32_16x16x32_bf16 v[52:55], v[32:35], a[208:211], v[52:55]
  s_waitcnt lgkmcnt(4)
  v_mfma_f32_16x16x32_bf16 v[56:59], v[8:11], a[40:43], v[56:59]
  ds_read_b128 v[28:31], v5 offset:13312
  v_mfma_f32_16x16x32_bf16 v[60:63], v[8:11], a[96:99], v[60:63]
  v_mfma_f32_16x16x32_bf16 v[64:67], v[8:11], a[152:155], v[64:67]
  v_mfma_f32_16x16x32_bf16 v[68:71], v[8:11], a[208:211], v[68:71]
  s_waitcnt lgkmcnt(4)
  v_mfma_f32_16x16x32_bf16 v[40:43], v[12:15], a[44:47], v[40:43]
  ds_read_b128 v[32:35], v5 offset:27648
  v_mfma_f32_16x16x32_bf16 v[44:47], v[12:15], a[100:103], v[44:47]
  v_mfma_f32_16x16x32_bf16 v[48:51], v[12:15], a[156:159], v[48:51]
  v_mfma_f32_16x16x32_bf16 v[52:55], v[12:15], a[212:215], v[52:55]
  s_waitcnt lgkmcnt(4)
  v_mfma_f32_16x16x32_bf16 v[56:59], v[16:19], a[44:47], v[56:59]
  s_waitcnt vmcnt(11)
  s_barrier
  ds_read_b128 v[8:11], v128 offset:0
  v_mfma_f32_16x16x32_bf16 v[60:63], v[16:19], a[100:103], v[60:63]
  v_mfma_f32_16x16x32_bf16 v[64:67], v[16:19], a[156:159], v[64:67]
  v_mfma_f32_16x16x32_bf16 v[68:71], v[16:19], a[212:215], v[68:71]
  s_waitcnt lgkmcnt(4)
  v_mfma_f32_16x16x32_bf16 v[40:43], v[20:23], a[48:51], v[40:43]
  ds_read_b128 v[12:15], v128 offset:14336
  v_mfma_f32_16x16x32_bf16 v[44:47], v[20:23], a[104:107], v[44:47]
  v_mfma_f32_16x16x32_bf16 v[48:51], v[20:23], a[160:163], v[48:51]
  v_mfma_f32_16x16x32_bf16 v[52:55], v[20:23], a[216:219], v[52:55]
  s_waitcnt lgkmcnt(4)
  v_mfma_f32_16x16x32_bf16 v[56:59], v[24:27], a[48:51], v[56:59]
  ds_read_b128 v[16:19], v128 offset:1024
  v_mfma_f32_16x16x32_bf16 v[60:63], v[24:27], a[104:107], v[60:63]
  v_mfma_f32_16x16x32_bf16 v[64:67], v[24:27], a[160:163], v[64:67]
  v_mfma_f32_16x16x32_bf16 v[68:71], v[24:27], a[216:219], v[68:71]
  s_waitcnt lgkmcnt(4)
  v_mfma_f32_16x16x32_bf16 v[40:43], v[28:31], a[52:55], v[40:43]
  ds_read_b128 v[20:23], v128 offset:15360
  v_mfma_f32_16x16x32_bf16 v[44:47], v[28:31], a[108:111], v[44:47]
  v_mfma_f32_16x16x32_bf16 v[48:51], v[28:31], a[164:167], v[48:51]
  v_mfma_f32_16x16x32_bf16 v[52:55], v[28:31], a[220:223], v[52:55]
  s_waitcnt lgkmcnt(4)
  v_mfma_f32_16x16x32_bf16 v[56:59], v[32:35], a[52:55], v[56:59]
  ds_read_b128 v[24:27], v128 offset:2048
  v_mfma_f32_16x16x32_bf16 v[60:63], v[32:35], a[108:111], v[60:63]
  v_mfma_f32_16x16x32_bf16 v[64:67], v[32:35], a[164:167], v[64:67]
  v_mfma_f32_16x16x32_bf16 v[68:71], v[32:35], a[220:223], v[68:71]
  s_waitcnt lgkmcnt(4)
  s_mov_b32 s40, s19
  s_mov_b32 s41, s29
  s_add_u32 s19, s19, 1
  s_cmp_lt_u32 s19, s35
  s_cbranch_scc0 wg_f_e0
  v_mfma_f32_16x16x32_bf16 v[96:99], v[8:11], a[0:3], 0
  ds_read_b128 v[28:31], v128 offset:16384
  v_mfma_f32_16x16x32_bf16 v[100:103], v[8:11], a[56:59], 0
  v_mfma_f32_16x16x32_bf16 v[104:107], v[8:11], a[112:115], 0
  v_mfma_f32_16x16x32_bf16 v[108:111], v[8:11], a[168:171], 0
  s_waitcnt lgkmcnt(4)
  s_lshl_b32 s42, s40, 10
  v_mfma_f32_16x16x32_bf16 v[112:115], v[12:15], a[0:3], 0
  ds_read_b128 v[32:35], v128 offset:3072
  v_mfma_f32_16x16x32_bf16 v[116:119], v[12:15], a[56:59], 0
  s_add_u32 s42, s42, s41
  v_cvt_pk_bf16_f32 v72, v40, v41
  v_mfma_f32_16x16x32_bf16 v[120:123], v[12:15], a[112:115], 0
  v_cvt_pk_bf16_f32 v73, v42, v43
  v_cvt_pk_bf16_f32 v74, v56, v57
  v_mfma_f32_16x16x32_bf16 v[124:127], v[12:15], a[168:171], 0
  s_waitcnt lgkmcnt(4)
  v_cvt_pk_bf16_f32 v75, v58, v59
  v_mfma_f32_16x16x32_bf16 v[96:99], v[16:19], a[4:7], v[96:99]
  ds_read_b128 v[8:11], v128 offset:17408
  v_mfma_f32_16x16x32_bf16 v[100:103], v[16:19], a[60:63], v[100:103]
  s_add_u32 s43, s42, 0
  v_mfma_f32_16x16x32_bf16 v[104:107], v[16:19], a[116:119], v[104:107]
  buffer_store_dwordx4 v[72:75], v2, s[8:11], s43 offen sc1
  v_cvt_pk_bf16_f32 v76, v44, v45
  v_mfma_f32_16x16x32_bf16 v[108:111], v[16:19], a[172:175], v[108:111]
  s_waitcnt lgkmcnt(4)
  v_cvt_pk_bf16_f32 v77, v46, v47
  v_mfma_f32_16x16x32_bf16 v[112:115], v[20:23], a[4:7], v[112:115]
  ds_read_b128 v[12:15], v128 offset:4096
  v_mfma_f32_16x16x32_bf16 v[116:119], v[20:23], a[60:63], v[116:119]
  v_cvt_pk_bf16_f32 v78, v60, v61
  v_cvt_pk_bf16_f32 v79, v62, v63
  v_mfma_f32_16x16x32_bf16 v[120:123], v[20:23], a[116:119], v[120:123]
  s_add_u32 s43, s42, 14336
  v_mfma_f32_16x16x32_bf16 v[124:127], v[20:23], a[172:175], v[124:127]
  s_waitcnt lgkmcnt(4)
  buffer_store_dwordx4 v[76:79], v2, s[8:11], s43 offen sc1
  v_mfma_f32_16x16x32_bf16 v[96:99], v[24:27], a[8:11], v[96:99]
  ds_read_b128 v[16:19], v128 offset:18432
  v_mfma_f32_16x16x32_bf16 v[100:103], v[24:27], a[64:67], v[100:103]
  v_cvt_pk_bf16_f32 v80, v48, v49
  v_cvt_pk_bf16_f32 v81, v50, v51
  v_mfma_f32_16x16x32_bf16 v[104:107], v[24:27], a[120:123], v[104:107]
  v_cvt_pk_bf16_f32 v82, v64, v65
  v_cvt_pk_bf16_f32 v83, v66, v67
  v_mfma_f32_16x16x32_bf16 v[108:111], v[24:27], a[176:179], v[108:111]
  s_waitcnt lgkmcnt(4)
  s_add_u32 s43, s42, 458752
  v_mfma_f32_16x16x32_bf16 v[112:115], v[28:31], a[8:11], v[112:115]
  ds_read_b128 v[20:23], v128 offset:5120
  v_mfma_f32_16x16x32_bf16 v[116:119], v[28:31], a[64:67], v[116:119]
  buffer_store_dwordx4 v[80:83], v2, s[8:11], s43 offen sc1
  v_cvt_pk_bf16_f32 v84, v52, v53
  v_mfma_f32_16x16x32_bf16 v[120:123], v[28:31], a[120:123], v[120:123]
  v_cvt_pk_bf16_f32 v85, v54, v55
  v_cvt_pk_bf16_f32 v86, v68, v69
  v_mfma_f32_16x16x32_bf16 v[124:127], v[28:31], a[176:179], v[124:127]
  s_waitcnt lgkmcnt(4)
  v_cvt_pk_bf16_f32 v87, v70, v71
  v_mfma_f32_16x16x32_bf16 v[96:99], v[32:35], a[12:15], v[96:99]
  ds_read_b128 v[24:27], v128 offset:19456
  v_mfma_f32_16x16x32_bf16 v[100:103], v[32:35], a[68:71], v[100:103]
  s_add_u32 s43, s42, 473088
  v_mfma_f32_16x16x32_bf16 v[104:107], v[32:35], a[124:127], v[104:107]
  buffer_store_dwordx4 v[84:87], v2, s[8:11], s43 offen sc1
  v_mfma_f32_16x16x32_bf16 v[108:111], v[32:35], a[180:183], v[108:111]
  s_waitcnt lgkmcnt(4)
  s_add_u32 s30, s19, 2
  s_lshr_b32 s24, s30, 1
  s_lshl_b32 s24, s24, 2
  s_and_b32 s25, s30, 1
  s_add_u32 s24, s24, s25
  s_mul_i32 s24, s24, 14336
  v_mfma_f32_16x16x32_bf16 v[112:115], v[8:11], a[12:15], v[112:115]
  ds_read_b128 v[28:31], v128 offset:6144
  v_mfma_f32_16x16x32_bf16 v[116:119], v[8:11], a[68:71], v[116:119]
  s_add_u32 s24, s24, s23
  s_cmp_lt_u32 s30, s35
  s_cselect_b32 s24, s24, 0x40000000
  v_mfma_f32_16x16x32_bf16 v[120:123], v[8:11], a[124:127], v[120:123]
  s_add_u32 m0, s33, s27
  s_nop 0
  buffer_load_dwordx4 v2, s[8:11], s24 offen offset:0 sc1 lds
  v_mfma_f32_16x16x32_bf16 v[124:127], v[8:11], a[180:183], v[124:127]
  s_waitcnt lgkmcnt(4)
  v_mfma_f32_16x16x32_bf16 v[96:99], v[12:15], a[16:19], v[96:99]
  ds_read_b128 v[32:35], v128 offset:20480
  v_mfma_f32_16x16x32_bf16 v[100:103], v[12:15], a[72:75], v[100:103]
  v_mfma_f32_16x16x32_bf16 v[104:107], v[12:15], a[128:131], v[104:107]
  v_mfma_f32_16x16x32_bf16 v[108:111], v[12:15], a[184:187], v[108:111]
  s_waitcnt lgkmcnt(4)
  buffer_load_dwordx4 v2, s[8:11], s24 offen offset:1024 sc1 lds
  v_mfma_f32_16x16x32_bf16 v[112:115], v[16:19], a[16:19], v[112:115]
  ds_read_b128 v[8:11], v128 offset:7168
  v_mfma_f32_16x16x32_bf16 v[116:119], v[16:19], a[72:75], v[116:119]
  v_mfma_f32_16x16x32_bf16 v[120:123], v[16:19], a[128:131], v[120:123]
  v_mfma_f32_16x16x32_bf16 v[124:127], v[16:19], a[184:187], v[124:127]
  s_waitcnt lgkmcnt(4)
  v_mfma_f32_16x16x32_bf16 v[96:99], v[20:23], a[20:23], v[96:99]
  ds_read_b128 v[12:15], v128 offset:21504
  v_mfma_f32_16x16x32_bf16 v[100:103], v[20:23], a[76:79], v[100:103]
  buffer_load_dwordx4 v2, s[8:11], s24 offen offset:2048 sc1 lds
  v_mfma_f32_16x16x32_bf16 v[104:107], v[20:23], a[132:135], v[104:107]
  v_mfma_f32_16x16x32_bf16 v[108:111], v[20:23], a[188:191], v[108:111]
  s_waitcnt lgkmcnt(4)
  v_mfma_f32_16x16x32_bf16 v[112:115], v[24:27], a[20:23], v[112:115]
  ds_read_b128 v[16:19], v128 offset:8192
  v_mfma_f32_16x16x32_bf16 v[116:119], v[24:27], a[76:79], v[116:119]
  v_mfma_f32_16x16x32_bf16 v[120:123], v[24:27], a[132:135], v[120:123]
  buffer_load_dwordx4 v2, s[8:11], s24 offen offset:3072 sc1 lds
  v_mfma_f32_16x16x32_bf16 v[124:127], v[24:27], a[188:191], v[124:127]
  s_waitcnt lgkmcnt(4)
  v_mfma_f32_16x16x32_bf16 v[96:99], v[28:31], a[24:27], v[96:99]
  ds_read_b128 v[20:23], v128 offset:22528
  v_mfma_f32_16x16x32_bf16 v[100:103], v[28:31], a[80:83], v[100:103]
  v_mfma_f32_16x16x32_bf16 v[104:107], v[28:31], a[136:139], v[104:107]
  v_mfma_f32_16x16x32_bf16 v[108:111], v[28:31], a[192:195], v[108:111]
  s_waitcnt lgkmcnt(4)
  s_add_u32 m0, m0, 4096
  s_add_u32 s24, s24, 4096
  buffer_load_dwordx4 v2, s[8:11], s24 offen offset:0 sc1 lds
  v_mfma_f32_16x16x32_bf16 v[112:115], v[32:35], a[24:27], v[112:115]
  ds_read_b128 v[24:27], v128 offset:9216
  v_mfma_f32_16x16x32_bf16 v[116:119], v[32:35], a[80:83], v[116:119]
  v_mfma_f32_16x16x32_bf16 v[120:123], v[32:35], a[136:139], v[120:123]
  v_mfma_f32_16x16x32_bf16 v[124:127], v[32:35], a[192:195], v[124:127]
  s_waitcnt lgkmcnt(4)
  v_mfma_f32_16x16x32_bf16 v[96:99], v[8:11], a[28:31], v[96:99]
  ds_read_b128 v[28:31], v128 offset:23552
  v_mfma_f32_16x16x32_bf16 v[100:103], v[8:11], a[84:87], v[100:103]
  buffer_load_dwordx4 v2, s[8:11], s24 offen offset:1024 sc1 lds
  v_mfma_f32_16x16x32_bf16 v[104:107], v[8:11], a[140:143], v[104:107]
  v_mfma_f32_16x16x32_bf16 v[108:111], v[8:11], a[196:199], v[108:111]
  s_waitcnt lgkmcnt(4)
  v_mfma_f32_16x16x32_bf16 v[112:115], v[12:15], a[28:31], v[112:115]
  ds_read_b128 v[32:35], v128 offset:10240
  v_mfma_f32_16x16x32_bf16 v[116:119], v[12:15], a[84:87], v[116:119]
  v_mfma_f32_16x16x32_bf16 v[120:123], v[12:15], a[140:143], v[120:123]
  buffer_load_dwordx4 v2, s[8:11], s24 offen offset:2048 sc1 lds
  v_mfma_f32_16x16x32_bf16 v[124:127], v[12:15], a[196:199], v[124:127]
  s_waitcnt lgkmcnt(4)
  v_mfma_f32_16x16x32_bf16 v[96:99], v[16:19], a[32:35], v[96:99]
  ds_read_b128 v[8:11], v128 offset:24576
  v_mfma_f32_16x16x32_bf16 v[100:103], v[16:19], a[88:91], v[100:103]
  v_mfma_f32_16x16x32_bf16 v[104:107], v[16:19], a[144:147], v[104:107]
  v_mfma_f32_16x16x32_bf16 v[108:111], v[16:19], a[200:203], v[108:111]
  s_waitcnt lgkmcnt(4)
  s_add_u32 s33, s33, 28672
  s_cmp_eq_u32 s33, 114688
  s_cselect_b32 s33, 0, s33
  v_mfma_f32_16x16x32_bf16 v[112:115], v[20:23], a[32:35], v[112:115]
  ds_read_b128 v[12:15], v128 offset:11264
  v_mfma_f32_16x16x32_bf16 v[116:119], v[20:23], a[88:91], v[116:119]
  s_add_u32 s32, s32, 28672
  s_cmp_eq_u32 s32, 114688
  s_cselect_b32 s32, 0, s32
  v_mfma_f32_16x16x32_bf16 v[120:123], v[20:23], a[144:147], v[120:123]
  v_add_u32 v5, s32, v2
  v_mfma_f32_16x16x32_bf16 v[124:127], v[20:23], a[200:203], v[124:127]
  s_waitcnt lgkmcnt(4)
  v_mfma_f32_16x16x32_bf16 v[96:99], v[24:27], a[36:39], v[96:99]
  ds_read_b128 v[16:19], v128 offset:25600
  v_mfma_f32_16x16x32_bf16 v[100:103], v[24:27], a[92:95], v[100:103]
  v_mfma_f32_16x16x32_bf16 v[104:107], v[24:27], a[148:151], v[104:107]
  v_mfma_f32_16x16x32_bf16 v[108:111], v[24:27], a[204:207], v[108:111]
  s_waitcnt lgkmcnt(4)
  v_mfma_f32_16x16x32_bf16 v[112:115], v[28:31], a[36:39], v[112:115]
  ds_read_b128 v[20:23], v128 offset:12288
  v_mfma_f32_16x16x32_bf16 v[116:119], v[28:31], a[92:95], v[116:119]
  v_mfma_f32_16x16x32_bf16 v[120:123], v[28:31], a[148:151], v[120:123]
  v_mfma_f32_16x16x32_bf16 v[124:127], v[28:31], a[204:207], v[124:127]
  s_waitcnt lgkmcnt(4)
  v_mfma_f32_16x16x32_bf16 v[96:99], v[32:35], a[40:43], v[96:99]
  ds_read_b128 v[24:27], v128 offset:26624
  v_mfma_f32_16x16x32_bf16 v[100:103], v[32:35], a[96:99], v[100:103]
  v_mfma_f32_16x16x32_bf16 v[104:107], v[32:35], a[152:155], v[104:107]
  v_mfma_f32_16x16x32_bf16 v[108:111], v[32:35], a[208:211], v[108:111]
  s_waitcnt lgkmcnt(4)
  v_mfma_f32_16x16x32_bf16 v[112:115], v[8:11], a[40:43], v[112:115]
  ds_read_b128 v[28:31], v128 offset:13312
  v_mfma_f32_16x16x32_bf16 v[116:119], v[8:11], a[96:99], v[116:119]
  v_mfma_f32_16x16x32_bf16 v[120:123], v[8:11], a[152:155], v[120:123]
  v_mfma_f32_16x16x32_bf16 v[124:127], v[8:11], a[208:211], v[124:127]
  s_waitcnt lgkmcnt(4)
  v_mfma_f32_16x16x32_bf16 v[96:99], v[12:15], a[44:47], v[96:99]
  ds_read_b128 v[32:35], v128 offset:27648
  v_mfma_f32_16x16x32_bf16 v[100:103], v[12:15], a[100:103], v[100:103]
  v_mfma_f32_16x16x32_bf16 v[104:107], v[12:15], a[156:159], v[104:107]
  v_mfma_f32_16x16x32_bf16 v[108:111], v[12:15], a[212:215], v[108:111]
  s_waitcnt lgkmcnt(4)
  v_mfma_f32_16x16x32_bf16 v[112:115], v[16:19], a[44:47], v[112:115]
  s_waitcnt vmcnt(11)
  s_barrier
  ds_read_b128 v[8:11], v5 offset:0
  v_mfma_f32_16x16x32_bf16 v[116:119], v[16:19], a[100:103], v[116:119]
  v_mfma_f32_16x16x32_bf16 v[120:123], v[16:19], a[156:159], v[120:123]
  v_mfma_f32_16x16x32_bf16 v[124:127], v[16:19], a[212:215], v[124:127]
  s_waitcnt lgkmcnt(4)
  v_mfma_f32_16x16x32_bf16 v[96:99], v[20:23], a[48:51], v[96:99]
  ds_read_b128 v[12:15], v5 offset:14336
  v_mfma_f32_16x16x32_bf16 v[100:103], v[20:23], a[104:107], v[100:103]
  v_mfma_f32_16x16x32_bf16 v[104:107], v[20:23], a[160:163], v[104:107]
  v_mfma_f32_16x16x32_bf16 v[108:111], v[20:23], a[216:219], v[108:111]
  s_waitcnt lgkmcnt(4)
  v_mfma_f32_16x16x32_bf16 v[112:115], v[24:27], a[48:51], v[112:115]
  ds_read_b128 v[16:19], v5 offset:1024
  v_mfma_f32_16x16x32_bf16 v[116:119], v[24:27], a[104:107], v[116:119]
  v_mfma_f32_16x16x32_bf16 v[120:123], v[24:27], a[160:163], v[120:123]
  v_mfma_f32_16x16x32_bf16 v[124:127], v[24:27], a[216:219], v[124:127]
  s_waitcnt lgkmcnt(4)
  v_mfma_f32_16x16x32_bf16 v[96:99], v[28:31], a[52:55], v[96:99]
  ds_read_b128 v[20:23], v5 offset:15360
  v_mfma_f32_16x16x32_bf16 v[100:103], v[28:31], a[108:111], v[100:103]
  v_mfma_f32_16x16x32_bf16 v[104:107], v[28:31], a[164:167], v[104:107]
  v_mfma_f32_16x16x32_bf16 v[108:111], v[28:31], a[220:223], v[108:111]
  s_waitcnt lgkmcnt(4)
  v_mfma_f32_16x16x32_bf16 v[112:115], v[32:35], a[52:55], v[112:115]
  ds_read_b128 v[24:27], v5 offset:2048
  v_mfma_f32_16x16x32_bf16 v[116:119], v[32:35], a[108:111], v[116:119]
  v_mfma_f32_16x16x32_bf16 v[120:123], v[32:35], a[164:167], v[120:123]
  v_mfma_f32_16x16x32_bf16 v[124:127], v[32:35], a[220:223], v[124:127]
  s_waitcnt lgkmcnt(4)
  s_mov_b32 s40, s19
  s_mov_b32 s41, s29
  s_add_u32 s19, s19, 1
  s_cmp_lt_u32 s19, s35
  s_cbranch_scc1 wg_f_loop
  s_nop 3
  s_lshl_b32 s42, s40, 10
  s_add_u32 s42, s42, s41
  v_cvt_pk_bf16_f32 v72, v96, v97
  v_cvt_pk_bf16_f32 v73, v98, v99
  v_cvt_pk_bf16_f32 v74, v112, v113
  v_cvt_pk_bf16_f32 v75, v114, v115
  s_add_u32 s43, s42, 0
  buffer_store_dwordx4 v[72:75], v2, s[8:11], s43 offen sc1
  v_cvt_pk_bf16_f32 v76, v100, v101
  v_cvt_pk_bf16_f32 v77, v102, v103
  v_cvt_pk_bf16_f32 v78, v116, v117
  v_cvt_pk_bf16_f32 v79, v118, v119
  s_add_u32 s43, s42, 14336
  buffer_store_dwordx4 v[76:79], v2, s[8:11], s43 offen sc1
  v_cvt_pk_bf16_f32 v80, v104, v105
  v_cvt_pk_bf16_f32 v81, v106, v107
  v_cvt_pk_bf16_f32 v82, v120, v121
  v_cvt_pk_bf16_f32 v83, v122, v123
  s_add_u32 s43, s42, 458752
  buffer_store_dwordx4 v[80:83], v2, s[8:11], s43 offen sc1
  v_cvt_pk_bf16_f32 v84, v108, v109
  v_cvt_pk_bf16_f32 v85, v110, v111
  v_cvt_pk_bf16_f32 v86, v124, v125
  v_cvt_pk_bf16_f32 v87, v126, v127
  s_add_u32 s43, s42, 473088
  buffer_store_dwordx4 v[84:87], v2, s[8:11], s43 offen sc1
  s_branch wg_done
wg_f_e0:
  s_nop 7
  s_lshl_b32 s42, s40, 10
  s_add_u32 s42, s42, s41
  v_cvt_pk_bf16_f32 v72, v40, v41
  v_cvt_pk_bf16_f32 v73, v42, v43
  v_cvt_pk_bf16_f32 v74, v56, v57
  v_cvt_pk_bf16_f32 v75, v58, v59
  s_add_u32 s43, s42, 0
  buffer_store_dwordx4 v[72:75], v2, s[8:11], s43 offen sc1
  v_cvt_pk_bf16_f32 v76, v44, v45
  v_cvt_pk_bf16_f32 v77, v46, v47
  v_cvt_pk_bf16_f32 v78, v60, v61
  v_cvt_pk_bf16_f32 v79, v62, v63
  s_add_u32 s43, s42, 14336
  buffer_store_dwordx4 v[76:79], v2, s[8:11], s43 offen sc1
  v_cvt_pk_bf16_f32 v80, v48, v49
  v_cvt_pk_bf16_f32 v81, v50, v51
  v_cvt_pk_bf16_f32 v82, v64, v65
  v_cvt_pk_bf16_f32 v83, v66, v67
  s_add_u32 s43, s42, 458752
  buffer_store_dwordx4 v[80:83], v2, s[8:11], s43 offen sc1
  v_cvt_pk_bf16_f32 v84, v52, v53
  v_cvt_pk_bf16_f32 v85, v54, v55
  v_cvt_pk_bf16_f32 v86, v68, v69
  v_cvt_pk_bf16_f32 v87, v70, v71
  s_add_u32 s43, s42, 473088
  buffer_store_dwordx4 v[84:87], v2, s[8:11], s43 offen sc1
  s_branch wg_done
wg_vo:
  s_sub_u32 s29, s17, 16
  s_mul_i32 s29, s29, 28672
  s_mul_i32 s24, s28, 458752
  s_add_u32 s29, s29, s24
  s_add_u32 s29, s29, 2490368
  v_lshlrev_b32 v6, 4, v3
  v_mul_u32_u24 v7, 12, v3
  v_add_u32 v7, 48, v7
  s_mov_b32 s31, 0
  s_lshl_b32 s24, s34, 1
  s_mul_i32 s24, s24, 14336
  s_add_u32 s24, s24, s23
  s_add_u32 m0, s31, s27
  s_nop 0
  buffer_load_dwordx4 v2, s[8:11], s24 offen offset:0 sc1 lds
  buffer_load_dwordx4 v2, s[8:11], s24 offen offset:1024 sc1 lds
  buffer_load_dwordx4 v2, s[8:11], s24 offen offset:2048 sc1 lds
  buffer_load_dwordx4 v2, s[8:11], s24 offen offset:3072 sc1 lds
  s_add_u32 m0, m0, 4096
  s_add_u32 s24, s24, 4096
  buffer_load_dwordx4 v2, s[8:11], s24 offen offset:0 sc1 lds
  buffer_load_dwordx4 v2, s[8:11], s24 offen offset:1024 sc1 lds
  buffer_load_dwordx4 v2, s[8:11], s24 offen offset:2048 sc1 lds
  s_sub_u32 s36, s35, 1
  s_add_u32 s30, s34, 1
  s_min_u32 s30, s30, s36
  s_mov_b32 s31, 28672
  s_lshl_b32 s24, s30, 1
  s_mul_i32 s24, s24, 14336
  s_add_u32 s24, s24, s23
  s_add_u32 m0, s31, s27
  s_nop 0
  buffer_load_dwordx4 v2, s[8:11], s24 offen offset:0 sc1 lds
  buffer_load_dwordx4 v2, s[8:11], s24 offen offset:1024 sc1 lds
  buffer_load_dwordx4 v2, s[8:11], s24 offen offset:2048 sc1 lds
  buffer_load_dwordx4 v2, s[8:11], s24 offen offset:3072 sc1 lds
  s_add_u32 m0, m0, 4096
  s_add_u32 s24, s24, 4096
  buffer_load_dwordx4 v2, s[8:11], s24 offen offset:0 sc1 lds
  buffer_load_dwordx4 v2, s[8:11], s24 offen offset:1024 sc1 lds
  buffer_load_dwordx4 v2, s[8:11], s24 offen offset:2048 sc1 lds
  s_mov_b32 s19, s34
  s_mov_b32 s32, 0
  s_mov_b32 s33, 57344
  s_cmp_eq_u32 s18, s101
  s_cbranch_scc1 wg_vo_hx
  s_add_u32 s22, s21, 0
  buffer_load_dwordx4 a[0:3], v2, s[8:11], s22 offen offset:0 sc1
  buffer_load_dwordx4 a[4:7], v2, s[8:11], s22 offen offset:1024 sc1
  buffer_load_dwordx4 a[8:11], v2, s[8:11], s22 offen offset:2048 sc1
  buffer_load_dwordx4 a[12:15], v2, s[8:11], s22 offen offset:3072 sc1
  s_add_u32 s22, s21, 4096
  buffer_load_dwordx4 a[16:19], v2, s[8:11], s22 offen offset:0 sc1
  buffer_load_dwordx4 a[20:23], v2, s[8:11], s22 offen offset:1024 sc1
  buffer_load_dwordx4 a[24:27], v2, s[8:11], s22 offen offset:2048 sc1
  buffer_load_dwordx4 a[28:31], v2, s[8:11], s22 offen offset:3072 sc1
  s_add_u32 s22, s21, 8192
  buffer_load_dwordx4 a[32:35], v2, s[8:11], s22 offen offset:0 sc1
  buffer_load_dwordx4 a[36:39], v2, s[8:11], s22 offen offset:1024 sc1
  buffer_load_dwordx4 a[40:43], v2, s[8:11], s22 offen offset:2048 sc1
  buffer_load_dwordx4 a[44:47], v2, s[8:11], s22 offen offset:3072 sc1
  s_add_u32 s22, s21, 12288
  buffer_load_dwordx4 a[48:51], v2, s[8:11], s22 offen offset:0 sc1
  buffer_load_dwordx4 a[52:55], v2, s[8:11], s22 offen offset:1024 sc1
  buffer_load_dwordx4 a[56:59], v2, s[8:11], s22 offen offset:2048 sc1
  buffer_load_dwordx4 a[60:63], v2, s[8:11], s22 offen offset:3072 sc1
  s_add_u32 s22, s21, 16384
  buffer_load_dwordx4 a[64:67], v2, s[8:11], s22 offen offset:0 sc1
  buffer_load_dwordx4 a[68:71], v2, s[8:11], s22 offen offset:1024 sc1
  buffer_load_dwordx4 a[72:75], v2, s[8:11], s22 offen offset:2048 sc1
  buffer_load_dwordx4 a[76:79], v2, s[8:11], s22 offen offset:3072 sc1
  s_add_u32 s22, s21, 20480
  buffer_load_dwordx4 a[80:83], v2, s[8:11], s22 offen offset:0 sc1
  buffer_load_dwordx4 a[84:87], v2, s[8:11], s22 offen offset:1024 sc1
  buffer_load_dwordx4 a[88:91], v2, s[8:11], s22 offen offset:2048 sc1
  buffer_load_dwordx4 a[92:95], v2, s[8:11], s22 offen offset:3072 sc1
  s_add_u32 s22, s21, 24576
  buffer_load_dwordx4 a[96:99], v2, s[8:11], s22 offen offset:0 sc1
  buffer_load_dwordx4 a[100:103], v2, s[8:11], s22 offen offset:1024 sc1
  buffer_load_dwordx4 a[104:107], v2, s[8:11], s22 offen offset:2048 sc1
  buffer_load_dwordx4 a[108:111], v2, s[8:11], s22 offen offset:3072 sc1
  s_add_u32 s22, s21, 28672
  buffer_load_dwordx4 a[112:115], v2, s[8:11], s22 offen offset:0 sc1
  buffer_load_dwordx4 a[116:119], v2, s[8:11], s22 offen offset:1024 sc1
  buffer_load_dwordx4 a[120:123], v2, s[8:11], s22 offen offset:2048 sc1
  buffer_load_dwordx4 a[124:127], v2, s[8:11], s22 offen offset:3072 sc1
  s_add_u32 s22, s21, 32768
  buffer_load_dwordx4 a[128:131], v2, s[8:11], s22 offen offset:0 sc1
  buffer_load_dwordx4 a[132:135], v2, s[8:11], s22 offen offset:1024 sc1
  buffer_load_dwordx4 a[136:139], v2, s[8:11], s22 offen offset:2048 sc1
  buffer_load_dwordx4 a[140:143], v2, s[8:11], s22 offen offset:3072 sc1
  s_add_u32 s22, s21, 36864
  buffer_load_dwordx4 a[144:147], v2, s[8:11], s22 offen offset:0 sc1
  buffer_load_dwordx4 a[148:151], v2, s[8:11], s22 offen offset:1024 sc1
  buffer_load_dwordx4 a[152:155], v2, s[8:11], s22 offen offset:2048 sc1
  buffer_load_dwordx4 a[156:159], v2, s[8:11], s22 offen offset:3072 sc1
  s_add_u32 s22, s21, 40960
  s_waitcnt vmcnt(40)
  buffer_load_dwordx4 a[160:163], v2, s[8:11], s22 offen offset:0 sc1
  buffer_load_dwordx4 a[164:167], v2, s[8:11], s22 offen offset:1024 sc1
  buffer_load_dwordx4 a[168:171], v2, s[8:11], s22 offen offset:2048 sc1
  buffer_load_dwordx4 a[172:175], v2, s[8:11], s22 offen offset:3072 sc1
  s_add_u32 s22, s21, 45056
  buffer_load_dwordx4 a[176:179], v2, s[8:11], s22 offen offset:0 sc1
  buffer_load_dwordx4 a[180:183], v2, s[8:11], s22 offen offset:1024 sc1
  buffer_load_dwordx4 a[184:187], v2, s[8:11], s22 offen offset:2048 sc1
  buffer_load_dwordx4 a[188:191], v2, s[8:11], s22 offen offset:3072 sc1
  s_add_u32 s22, s21, 49152
  buffer_load_dwordx4 a[192:195], v2, s[8:11], s22 offen offset:0 sc1
  buffer_load_dwordx4 a[196:199], v2, s[8:11], s22 offen offset:1024 sc1
  buffer_load_dwordx4 a[200:203], v2, s[8:11], s22 offen offset:2048 sc1
  buffer_load_dwordx4 a[204:207], v2, s[8:11], s22 offen offset:3072 sc1
  s_add_u32 s22, s21, 53248
  buffer_load_dwordx4 a[208:211], v2, s[8:11], s22 offen offset:0 sc1
  buffer_load_dwordx4 a[212:215], v2, s[8:11], s22 offen offset:1024 sc1
  buffer_load_dwordx4 a[216:219], v2, s[8:11], s22 offen offset:2048 sc1
  buffer_load_dwordx4 a[220:223], v2, s[8:11], s22 offen offset:3072 sc1
wg_vo_hx:
  s_mov_b32 s101, -1
  s_waitcnt vmcnt(0)
  s_barrier
  s_mov_b32 s40, 0
  s_mov_b32 s41, 0x40000000
  v_mov_b32 v5, v2
  ds_read_b128 v[8:11], v5 offset:0
  ds_read_b128 v[12:15], v5 offset:14336
  ds_read_b128 v[16:19], v5 offset:1024
  ds_read_b128 v[20:23], v5 offset:15360
  ds_read_b128 v[24:27], v5 offset:2048
  s_waitcnt lgkmcnt(4)
.p2align 6
wg_vo_loop:
  v_mfma_f32_16x16x32_bf16 v[40:43], a[0:3], v[8:11], 0
  ds_read_b128 v[28:31], v5 offset:16384
  v_mfma_f32_16x16x32_bf16 v[44:47], a[56:59], v[8:11], 0
  v_mfma_f32_16x16x32_bf16 v[48:51], a[112:115], v[8:11], 0
  v_mfma_f32_16x16x32_bf16 v[52:55], a[168:171], v[8:11], 0
  s_waitcnt lgkmcnt(4)
  s_add_u32 s43, s41, 458752
  v_mfma_f32_16x16x32_bf16 v[56:59], a[0:3], v[12:15], 0
  ds_read_b128 v[32:35], v5 offset:3072
  v_mfma_f32_16x16x32_bf16 v[60:63], a[56:59], v[12:15], 0
  s_lshl_b32 s42, s40, 5
  s_add_u32 s42, s42, 0
  v_mfma_f32_16x16x32_bf16 v[64:67], a[112:115], v[12:15], 0
  v_add_u32 v88, s42, v4
  v_mul_u32_u24 v89, 2341, v88
  v_mfma_f32_16x16x32_bf16 v[68:71], a[168:171], v[12:15], 0
  s_waitcnt lgkmcnt(4)
  v_lshrrev_b32 v89, 16, v89
  v_mfma_f32_16x16x32_bf16 v[40:43], a[4:7], v[16:19], v[40:43]
  ds_read_b128 v[8:11], v5 offset:17408
  v_mfma_f32_16x16x32_bf16 v[44:47], a[60:63], v[16:19], v[44:47]
  v_mul_u32_u24 v92, 28, v89
  v_sub_u32 v92, v88, v92
  v_mfma_f32_16x16x32_bf16 v[48:51], a[116:119], v[16:19], v[48:51]
  v_cmp_gt_u32 vcc, 16, v92
  v_mul_u32_u24 v89, 84, v89
  v_mfma_f32_16x16x32_bf16 v[52:55], a[172:175], v[16:19], v[52:55]
  s_waitcnt lgkmcnt(4)
  v_cndmask_b32 v92, v7, v6, vcc
  v_mfma_f32_16x16x32_bf16 v[56:59], a[4:7], v[20:23], v[56:59]
  ds_read_b128 v[12:15], v5 offset:4096
  v_mfma_f32_16x16x32_bf16 v[60:63], a[60:63], v[20:23], v[60:63]
  v_add3_u32 v88, v88, v89, v92
  v_lshlrev_b32 v90, 4, v88
  v_mfma_f32_16x16x32_bf16 v[64:67], a[116:119], v[20:23], v[64:67]
  v_cvt_pk_bf16_f32 v72, v96, v100
  v_cvt_pk_bf16_f32 v73, v97, v101
  v_mfma_f32_16x16x32_bf16 v[68:71], a[172:175], v[20:23], v[68:71]
  s_waitcnt lgkmcnt(4)
  v_cvt_pk_bf16_f32 v74, v98, v102
  v_mfma_f32_16x16x32_bf16 v[40:43], a[8:11], v[24:27], v[40:43]
  ds_read_b128 v[16:19], v5 offset:18432
  v_mfma_f32_16x16x32_bf16 v[44:47], a[64:67], v[24:27], v[44:47]
  v_cvt_pk_bf16_f32 v75, v99, v103
  v_mfma_f32_16x16x32_bf16 v[48:51], a[120:123], v[24:27], v[48:51]
  buffer_store_dwordx4 v[72:75], v90, s[8:11], s41 offen sc1
  v_cvt_pk_bf16_f32 v76, v104, v108
  v_mfma_f32_16x16x32_bf16 v[52:55], a[176:179], v[24:27], v[52:55]
  s_waitcnt lgkmcnt(4)
  v_cvt_pk_bf16_f32 v77, v105, v109
  v_mfma_f32_16x16x32_bf16 v[56:59], a[8:11], v[28:31], v[56:59]
  ds_read_b128 v[20:23], v5 offset:5120
  v_mfma_f32_16x16x32_bf16 v[60:63], a[64:67], v[28:31], v[60:63]
  v_cvt_pk_bf16_f32 v78, v106, v110
  v_cvt_pk_bf16_f32 v79, v107, v111
  v_mfma_f32_16x16x32_bf16 v[64:67], a[120:123], v[28:31], v[64:67]
  buffer_store_dwordx4 v[76:79], v90, s[8:11], s43 offen sc1
  s_lshl_b32 s42, s40, 5
  v_mfma_f32_16x16x32_bf16 v[68:71], a[176:179], v[28:31], v[68:71]
  s_waitcnt lgkmcnt(4)
  s_add_u32 s42, s42, 16
  v_mfma_f32_16x16x32_bf16 v[40:43], a[12:15], v[32:35], v[40:43]
  ds_read_b128 v[24:27], v5 offset:19456
  v_mfma_f32_16x16x32_bf16 v[44:47], a[68:71], v[32:35], v[44:47]
  v_add_u32 v88, s42, v4
  v_mul_u32_u24 v89, 2341, v88
  v_mfma_f32_16x16x32_bf16 v[48:51], a[124:127], v[32:35], v[48:51]
  v_lshrrev_b32 v89, 16, v89
  v_mul_u32_u24 v92, 28, v89
  v_mfma_f32_16x16x32_bf16 v[52:55], a[180:183], v[32:35], v[52:55]
  s_waitcnt lgkmcnt(4)
  v_sub_u32 v92, v88, v92
  v_mfma_f32_16x16x32_bf16 v[56:59], a[12:15], v[8:11], v[56:59]
  ds_read_b128 v[28:31], v5 offset:6144
  v_mfma_f32_16x16x32_bf16 v[60:63], a[68:71], v[8:11], v[60:63]
  v_cmp_gt_u32 vcc, 16, v92
  v_mul_u32_u24 v89, 84, v89
  v_mfma_f32_16x16x32_bf16 v[64:67], a[124:127], v[8:11], v[64:67]
  v_cndmask_b32 v92, v7, v6, vcc
  v_add3_u32 v88, v88, v89, v92
  v_mfma_f32_16x16x32_bf16 v[68:71], a[180:183], v[8:11], v[68:71]
  s_waitcnt lgkmcnt(4)
  v_lshlrev_b32 v91, 4, v88
  v_mfma_f32_16x16x32_bf16 v[40:43], a[16:19], v[12:15], v[40:43]
  ds_read_b128 v[32:35], v5 offset:20480
  v_mfma_f32_16x16x32_bf16 v[44:47], a[72:75], v[12:15], v[44:47]
  v_cvt_pk_bf16_f32 v80, v112, v116
  v_cvt_pk_bf16_f32 v81, v113, v117
  v_mfma_f32_16x16x32_bf16 v[48:51], a[128:131], v[12:15], v[48:51]
  v_cvt_pk_bf16_f32 v82, v114, v118
  v_cvt_pk_bf16_f32 v83, v115, v119
  v_mfma_f32_16x16x32_bf16 v[52:55], a[184:187], v[12:15], v[52:55]
  s_waitcnt lgkmcnt(4)
  buffer_store_dwordx4 v[80:83], v91, s[8:11], s41 offen sc1
  v_mfma_f32_16x16x32_bf16 v[56:59], a[16:19], v[16:19], v[56:59]
  ds_read_b128 v[8:11], v5 offset:7168
  v_mfma_f32_16x16x32_bf16 v[60:63], a[72:75], v[16:19], v[60:63]
  v_cvt_pk_bf16_f32 v84, v120, v124
  v_cvt_pk_bf16_f32 v85, v121, v125
  v_mfma_f32_16x16x32_bf16 v[64:67], a[128:131], v[16:19], v[64:67]
  v_cvt_pk_bf16_f32 v86, v122, v126
  v_cvt_pk_bf16_f32 v87, v123, v127
  v_mfma_f32_16x16x32_bf16 v[68:71], a[184:187], v[16:19], v[68:71]
  s_waitcnt lgkmcnt(4)
  buffer_store_dwordx4 v[84:87], v91, s[8:11], s43 offen sc1
  v_mfma_f32_16x16x32_bf16 v[40:43], a[20:23], v[20:23], v[40:43]
  ds_read_b128 v[12:15], v5 offset:21504
  v_mfma_f32_16x16x32_bf16 v[44:47], a[76:79], v[20:23], v[44:47]
  s_add_u32 s30, s19, 2
  s_lshl_b32 s24, s30, 1
  s_mul_i32 s24, s24, 14336
  v_mfma_f32_16x16x32_bf16 v[48:51], a[132:135], v[20:23], v[48:51]
  s_add_u32 s24, s24, s23
  s_cmp_lt_u32 s30, s35
  s_cselect_b32 s24, s24, 0x40000000
  v_mfma_f32_16x16x32_bf16 v[52:55], a[188:191], v[20:23], v[52:55]
  s_waitcnt lgkmcnt(4)
  s_add_u32 m0, s33, s27
  s_nop 0
  buffer_load_dwordx4 v2, s[8:11], s24 offen offset:0 sc1 lds
  v_mfma_f32_16x16x32_bf16 v[56:59], a[20:23], v[24:27], v[56:59]
  ds_read_b128 v[16:19], v5 offset:8192
  v_mfma_f32_16x16x32_bf16 v[60:63], a[76:79], v[24:27], v[60:63]
  v_mfma_f32_16x16x32_bf16 v[64:67], a[132:135], v[24:27], v[64:67]
  v_mfma_f32_16x16x32_bf16 v[68:71], a[188:191], v[24:27], v[68:71]
  s_waitcnt lgkmcnt(4)
  v_mfma_f32_16x16x32_bf16 v[40:43], a[24:27], v[28:31], v[40:43]
  ds_read_b128 v[20:23], v5 offset:22528
  v_mfma_f32_16x16x32_bf16 v[44:47], a[80:83], v[28:31], v[44:47]
  buffer_load_dwordx4 v2, s[8:11], s24 offen offset:1024 sc1 lds
  v_mfma_f32_16x16x32_bf16 v[48:51], a[136:139], v[28:31], v[48:51]
  v_mfma_f32_16x16x32_bf16 v[52:55], a[192:195], v[28:31], v[52:55]
  s_waitcnt lgkmcnt(4)
  v_mfma_f32_16x16x32_bf16 v[56:59], a[24:27], v[32:35], v[56:59]
  ds_read_b128 v[24:27], v5 offset:9216
  v_mfma_f32_16x16x32_bf16 v[60:63], a[80:83], v[32:35], v[60:63]
  v_mfma_f32_16x16x32_bf16 v[64:67], a[136:139], v[32:35], v[64:67]
  buffer_load_dwordx4 v2, s[8:11], s24 offen offset:2048 sc1 lds
  v_mfma_f32_16x16x32_bf16 v[68:71], a[192:195], v[32:35], v[68:71]
  s_waitcnt lgkmcnt(4)
  v_mfma_f32_16x16x32_bf16 v[40:43], a[28:31], v[8:11], v[40:43]
  ds_read_b128 v[28:31], v5 offset:23552
  v_mfma_f32_16x16x32_bf16 v[44:47], a[84:87], v[8:11], v[44:47]
  v_mfma_f32_16x16x32_bf16 v[48:51], a[140:143], v[8:11], v[48:51]
  v_mfma_f32_16x16x32_bf16 v[52:55], a[196:199], v[8:11], v[52:55]
  s_waitcnt lgkmcnt(4)
  buffer_load_dwordx4 v2, s[8:11], s24 offen offset:3072 sc1 lds
  v_mfma_f32_16x16x32_bf16 v[56:59], a[28:31], v[12:15], v[56:59]
  ds_read_b128 v[32:35], v5 offset:10240
  v_mfma_f32_16x16x32_bf16 v[60:63], a[84:87], v[12:15], v[60:63]
  v_mfma_f32_16x16x32_bf16 v[64:67], a[140:143], v[12:15], v[64:67]
  v_mfma_f32_16x16x32_bf16 v[68:71], a[196:199], v[12:15], v[68:71]
  s_waitcnt lgkmcnt(4)
  v_mfma_f32_16x16x32_bf16 v[40:43], a[32:35], v[16:19], v[40:43]
  ds_read_b128 v[8:11], v5 offset:24576
  v_mfma_f32_16x16x32_bf16 v[44:47], a[88:91], v[16:19], v[44:47]
  s_add_u32 m0, m0, 4096
  s_add_u32 s24, s24, 4096
  buffer_load_dwordx4 v2, s[8:11], s24 offen offset:0 sc1 lds
  v_mfma_f32_16x16x32_bf16 v[48:51], a[144:147], v[16:19], v[48:51]
  v_mfma_f32_16x16x32_bf16 v[52:55], a[200:203], v[16:19], v[52:55]
  s_waitcnt lgkmcnt(4)
  v_mfma_f32_16x16x32_bf16 v[56:59], a[32:35], v[20:23], v[56:59]
  ds_read_b128 v[12:15], v5 offset:11264
  v_mfma_f32_16x16x32_bf16 v[60:63], a[88:91], v[20:23], v[60:63]
  v_mfma_f32_16x16x32_bf16 v[64:67], a[144:147], v[20:23], v[64:67]
  buffer_load_dwordx4 v2, s[8:11], s24 offen offset:1024 sc1 lds
  v_mfma_f32_16x16x32_bf16 v[68:71], a[200:203], v[20:23], v[68:71]
  s_waitcnt lgkmcnt(4)
  v_mfma_f32_16x16x32_bf16 v[40:43], a[36:39], v[24:27], v[40:43]
  ds_read_b128 v[16:19], v5 offset:25600
  v_mfma_f32_16x16x32_bf16 v[44:47], a[92:95], v[24:27], v[44:47]
  v_mfma_f32_16x16x32_bf16 v[48:51], a[148:151], v[24:27], v[48:51]
  v_mfma_f32_16x16x32_bf16 v[52:55], a[204:207], v[24:27], v[52:55]
  s_waitcnt lgkmcnt(4)
  buffer_load_dwordx4 v2, s[8:11], s24 offen offset:2048 sc1 lds
  v_mfma_f32_16x16x32_bf16 v[56:59], a[36:39], v[28:31], v[56:59]
  ds_read_b128 v[20:23], v5 offset:12288
  v_mfma_f32_16x16x32_bf16 v[60:63], a[92:95], v[28:31], v[60:63]
  v_mfma_f32_16x16x32_bf16 v[64:67], a[148:151], v[28:31], v[64:67]
  v_mfma_f32_16x16x32_bf16 v[68:71], a[204:207], v[28:31], v[68:71]
  s_waitcnt lgkmcnt(4)
  v_mfma_f32_16x16x32_bf16 v[40:43], a[40:43], v[32:35], v[40:43]
  ds_read_b128 v[24:27], v5 offset:26624
  v_mfma_f32_16x16x32_bf16 v[44:47], a[96:99], v[32:35], v[44:47]
  s_add_u32 s33, s33, 28672
  s_cmp_eq_u32 s33, 114688
  s_cselect_b32 s33, 0, s33
  v_mfma_f32_16x16x32_bf16 v[48:51], a[152:155], v[32:35], v[48:51]
  s_add_u32 s32, s32, 28672
  s_cmp_eq_u32 s32, 114688
  s_cselect_b32 s32, 0, s32
  v_mfma_f32_16x16x32_bf16 v[52:55], a[208:211], v[32:35], v[52:55]
  s_waitcnt lgkmcnt(4)
  v_add_u32 v128, s32, v2
  v_mfma_f32_16x16x32_bf16 v[56:59], a[40:43], v[8:11], v[56:59]
  ds_read_b128 v[28:31], v5 offset:13312
  v_mfma_f32_16x16x32_bf16 v[60:63], a[96:99], v[8:11], v[60:63]
  v_mfma_f32_16x16x32_bf16 v[64:67], a[152:155], v[8:11], v[64:67]
  v_mfma_f32_16x16x32_bf16 v[68:71], a[208:211], v[8:11], v[68:71]
  s_waitcnt lgkmcnt(4)
  v_mfma_f32_16x16x32_bf16 v[40:43], a[44:47], v[12:15], v[40:43]
  ds_read_b128 v[32:35], v5 offset:27648
  v_mfma_f32_16x16x32_bf16 v[44:47], a[100:103], v[12:15], v[44:47]
  v_mfma_f32_16x16x32_bf16 v[48:51], a[156:159], v[12:15], v[48:51]
  v_mfma_f32_16x16x32_bf16 v[52:55], a[212:215], v[12:15], v[52:55]
  s_waitcnt lgkmcnt(4)
  v_mfma_f32_16x16x32_bf16 v[56:59], a[44:47], v[16:19], v[56:59]
  s_waitcnt vmcnt(11)
  s_barrier
  ds_read_b128 v[8:11], v128 offset:0
  v_mfma_f32_16x16x32_bf16 v[60:63], a[100:103], v[16:19], v[60:63]
  v_mfma_f32_16x16x32_bf16 v[64:67], a[156:159], v[16:19], v[64:67]
  v_mfma_f32_16x16x32_bf16 v[68:71], a[212:215], v[16:19], v[68:71]
  s_waitcnt lgkmcnt(4)
  v_mfma_f32_16x16x32_bf16 v[40:43], a[48:51], v[20:23], v[40:43]
  ds_read_b128 v[12:15], v128 offset:14336
  v_mfma_f32_16x16x32_bf16 v[44:47], a[104:107], v[20:23], v[44:47]
  v_mfma_f32_16x16x32_bf16 v[48:51], a[160:163], v[20:23], v[48:51]
  v_mfma_f32_16x16x32_bf16 v[52:55], a[216:219], v[20:23], v[52:55]
  s_waitcnt lgkmcnt(4)
  v_mfma_f32_16x16x32_bf16 v[56:59], a[48:51], v[24:27], v[56:59]
  ds_read_b128 v[16:19], v128 offset:1024
  v_mfma_f32_16x16x32_bf16 v[60:63], a[104:107], v[24:27], v[60:63]
  v_mfma_f32_16x16x32_bf16 v[64:67], a[160:163], v[24:27], v[64:67]
  v_mfma_f32_16x16x32_bf16 v[68:71], a[216:219], v[24:27], v[68:71]
  s_waitcnt lgkmcnt(4)
  v_mfma_f32_16x16x32_bf16 v[40:43], a[52:55], v[28:31], v[40:43]
  ds_read_b128 v[20:23], v128 offset:15360
  v_mfma_f32_16x16x32_bf16 v[44:47], a[108:111], v[28:31], v[44:47]
  v_mfma_f32_16x16x32_bf16 v[48:51], a[164:167], v[28:31], v[48:51]
  v_mfma_f32_16x16x32_bf16 v[52:55], a[220:223], v[28:31], v[52:55]
  s_waitcnt lgkmcnt(4)
  v_mfma_f32_16x16x32_bf16 v[56:59], a[52:55], v[32:35], v[56:59]
  ds_read_b128 v[24:27], v128 offset:2048
  v_mfma_f32_16x16x32_bf16 v[60:63], a[108:111], v[32:35], v[60:63]
  v_mfma_f32_16x16x32_bf16 v[64:67], a[164:167], v[32:35], v[64:67]
  v_mfma_f32_16x16x32_bf16 v[68:71], a[220:223], v[32:35], v[68:71]
  s_waitcnt lgkmcnt(4)
  s_mov_b32 s40, s19
  s_mov_b32 s41, s29
  s_add_u32 s19, s19, 1
  s_cmp_lt_u32 s19, s35
  s_cbranch_scc0 wg_vo_e0
  v_mfma_f32_16x16x32_bf16 v[96:99], a[0:3], v[8:11], 0
  ds_read_b128 v[28:31], v128 offset:16384
  v_mfma_f32_16x16x32_bf16 v[100:103], a[56:59], v[8:11], 0
  v_mfma_f32_16x16x32_bf16 v[104:107], a[112:115], v[8:11], 0
  v_mfma_f32_16x16x32_bf16 v[108:111], a[168:171], v[8:11], 0
  s_waitcnt lgkmcnt(4)
  s_add_u32 s43, s41, 458752
  v_mfma_f32_16x16x32_bf16 v[112:115], a[0:3], v[12:15], 0
  ds_read_b128 v[32:35], v128 offset:3072
  v_mfma_f32_16x16x32_bf16 v[116:119], a[56:59], v[12:15], 0
  s_lshl_b32 s42, s40, 5
  s_add_u32 s42, s42, 0
  v_mfma_f32_16x16x32_bf16 v[120:123], a[112:115], v[12:15], 0
  v_add_u32 v88, s42, v4
  v_mul_u32_u24 v89, 2341, v88
  v_mfma_f32_16x16x32_bf16 v[124:127], a[168:171], v[12:15], 0
  s_waitcnt lgkmcnt(4)
  v_lshrrev_b32 v89, 16, v89
  v_mfma_f32_16x16x32_bf16 v[96:99], a[4:7], v[16:19], v[96:99]
  ds_read_b128 v[8:11], v128 offset:17408
  v_mfma_f32_16x16x32_bf16 v[100:103], a[60:63], v[16:19], v[100:103]
  v_mul_u32_u24 v92, 28, v89
  v_sub_u32 v92, v88, v92
  v_mfma_f32_16x16x32_bf16 v[104:107], a[116:119], v[16:19], v[104:107]
  v_cmp_gt_u32 vcc, 16, v92
  v_mul_u32_u24 v89, 84, v89
  v_mfma_f32_16x16x32_bf16 v[108:111], a[172:175], v[16:19], v[108:111]
  s_waitcnt lgkmcnt(4)
  v_cndmask_b32 v92, v7, v6, vcc
  v_mfma_f32_16x16x32_bf16 v[112:115], a[4:7], v[20:23], v[112:115]
  ds_read_b128 v[12:15], v128 offset:4096
  v_mfma_f32_16x16x32_bf16 v[116:119], a[60:63], v[20:23], v[116:119]
  v_add3_u32 v88, v88, v89, v92
  v_lshlrev_b32 v90, 4, v88
  v_mfma_f32_16x16x32_bf16 v[120:123], a[116:119], v[20:23], v[120:123]
  v_cvt_pk_bf16_f32 v72, v40, v44
  v_cvt_pk_bf16_f32 v73, v41, v45
  v_mfma_f32_16x16x32_bf16 v[124:127], a[172:175], v[20:23], v[124:127]
  s_waitcnt lgkmcnt(4)
  v_cvt_pk_bf16_f32 v74, v42, v46
  v_mfma_f32_16x16x32_bf16 v[96:99], a[8:11], v[24:27], v[96:99]
  ds_read_b128 v[16:19], v128 offset:18432
  v_mfma_f32_16x16x32_bf16 v[100:103], a[64:67], v[24:27], v[100:103]
  v_cvt_pk_bf16_f32 v75, v43, v47
  v_mfma_f32_16x16x32_bf16 v[104:107], a[120:123], v[24:27], v[104:107]
  buffer_store_dwordx4 v[72:75], v90, s[8:11], s41 offen sc1
  v_cvt_pk_bf16_f32 v76, v48, v52
  v_mfma_f32_16x16x32_bf16 v[108:111], a[176:179], v[24:27], v[108:111]
  s_waitcnt lgkmcnt(4)
  v_cvt_pk_bf16_f32 v77, v49, v53
  v_mfma_f32_16x16x32_bf16 v[112:115], a[8:11], v[28:31], v[112:115]
  ds_read_b128 v[20:23], v128 offset:5120
  v_mfma_f32_16x16x32_bf16 v[116:119], a[64:67], v[28:31], v[116:119]
  v_cvt_pk_bf16_f32 v78, v50, v54
  v_cvt_pk_bf16_f32 v79, v51, v55
  v_mfma_f32_16x16x32_bf16 v[120:123], a[120:123], v[28:31], v[120:123]
  buffer_store_dwordx4 v[76:79], v90, s[8:11], s43 offen sc1
  s_lshl_b32 s42, s40, 5
  v_mfma_f32_16x16x32_bf16 v[124:127], a[176:179], v[28:31], v[124:127]
  s_waitcnt lgkmcnt(4)
  s_add_u32 s42, s42, 16
  v_mfma_f32_16x16x32_bf16 v[96:99], a[12:15], v[32:35], v[96:99]
  ds_read_b128 v[24:27], v128 offset:19456
  v_mfma_f32_16x16x32_bf16 v[100:103], a[68:71], v[32:35], v[100:103]
  v_add_u32 v88, s42, v4
  v_mul_u32_u24 v89, 2341, v88
  v_mfma_f32_16x16x32_bf16 v[104:107], a[124:127], v[32:35], v[104:107]
  v_lshrrev_b32 v89, 16, v89
  v_mul_u32_u24 v92, 28, v89
  v_mfma_f32_16x16x32_bf16 v[108:111], a[180:183], v[32:35], v[108:111]
  s_waitcnt lgkmcnt(4)
  v_sub_u32 v92, v88, v92
  v_mfma_f32_16x16x32_bf16 v[112:115], a[12:15], v[8:11], v[112:115]
  ds_read_b128 v[28:31], v128 offset:6144
  v_mfma_f32_16x16x32_bf16 v[116:119], a[68:71], v[8:11], v[116:119]
  v_cmp_gt_u32 vcc, 16, v92
  v_mul_u32_u24 v89, 84, v89
  v_mfma_f32_16x16x32_bf16 v[120:123], a[124:127], v[8:11], v[120:123]
  v_cndmask_b32 v92, v7, v6, vcc
  v_add3_u32 v88, v88, v89, v92
  v_mfma_f32_16x16x32_bf16 v[124:127], a[180:183], v[8:11], v[124:127]
  s_waitcnt lgkmcnt(4)
  v_lshlrev_b32 v91, 4, v88
  v_mfma_f32_16x16x32_bf16 v[96:99], a[16:19], v[12:15], v[96:99]
  ds_read_b128 v[32:35], v128 offset:20480
  v_mfma_f32_16x16x32_bf16 v[100:103], a[72:75], v[12:15], v[100:103]
  v_cvt_pk_bf16_f32 v80, v56, v60
  v_cvt_pk_bf16_f32 v81, v57, v61
  v_mfma_f32_16x16x32_bf16 v[104:107], a[128:131], v[12:15], v[104:107]
  v_cvt_pk_bf16_f32 v82, v58, v62
  v_cvt_pk_bf16_f32 v83, v59, v63
  v_mfma_f32_16x16x32_bf16 v[108:111], a[184:187], v[12:15], v[108:111]
  s_waitcnt lgkmcnt(4)
  buffer_store_dwordx4 v[80:83], v91, s[8:11], s41 offen sc1
  v_mfma_f32_16x16x32_bf16 v[112:115], a[16:19], v[16:19], v[112:115]
  ds_read_b128 v[8:11], v128 offset:7168
  v_mfma_f32_16x16x32_bf16 v[116:119], a[72:75], v[16:19], v[116:119]
  v_cvt_pk_bf16_f32 v84, v64, v68
  v_cvt_pk_bf16_f32 v85, v65, v69
  v_mfma_f32_16x16x32_bf16 v[120:123], a[128:131], v[16:19], v[120:123]
  v_cvt_pk_bf16_f32 v86, v66, v70
  v_cvt_pk_bf16_f32 v87, v67, v71
  v_mfma_f32_16x16x32_bf16 v[124:127], a[184:187], v[16:19], v[124:127]
  s_waitcnt lgkmcnt(4)
  buffer_store_dwordx4 v[84:87], v91, s[8:11], s43 offen sc1
  v_mfma_f32_16x16x32_bf16 v[96:99], a[20:23], v[20:23], v[96:99]
  ds_read_b128 v[12:15], v128 offset:21504
  v_mfma_f32_16x16x32_bf16 v[100:103], a[76:79], v[20:23], v[100:103]
  s_add_u32 s30, s19, 2
  s_lshl_b32 s24, s30, 1
  s_mul_i32 s24, s24, 14336
  v_mfma_f32_16x16x32_bf16 v[104:107], a[132:135], v[20:23], v[104:107]
  s_add_u32 s24, s24, s23
  s_cmp_lt_u32 s30, s35
  s_cselect_b32 s24, s24, 0x40000000
  v_mfma_f32_16x16x32_bf16 v[108:111], a[188:191], v[20:23], v[108:111]
  s_waitcnt lgkmcnt(4)
  s_add_u32 m0, s33, s27
  s_nop 0
  buffer_load_dwordx4 v2, s[8:11], s24 offen offset:0 sc1 lds
  v_mfma_f32_16x16x32_bf16 v[112:115], a[20:23], v[24:27], v[112:115]
  ds_read_b128 v[16:19], v128 offset:8192
  v_mfma_f32_16x16x32_bf16 v[116:119], a[76:79], v[24:27], v[116:119]
  v_mfma_f32_16x16x32_bf16 v[120:123], a[132:135], v[24:27], v[120:123]
  v_mfma_f32_16x16x32_bf16 v[124:127], a[188:191], v[24:27], v[124:127]
  s_waitcnt lgkmcnt(4)
  v_mfma_f32_16x16x32_bf16 v[96:99], a[24:27], v[28:31], v[96:99]
  ds_read_b128 v[20:23], v128 offset:22528
  v_mfma_f32_16x16x32_bf16 v[100:103], a[80:83], v[28:31], v[100:103]
  buffer_load_dwordx4 v2, s[8:11], s24 offen offset:1024 sc1 lds
  v_mfma_f32_16x16x32_bf16 v[104:107], a[136:139], v[28:31], v[104:107]
  v_mfma_f32_16x16x32_bf16 v[108:111], a[192:195], v[28:31], v[108:111]
  s_waitcnt lgkmcnt(4)
  v_mfma_f32_16x16x32_bf16 v[112:115], a[24:27], v[32:35], v[112:115]
  ds_read_b128 v[24:27], v128 offset:9216
  v_mfma_f32_16x16x32_bf16 v[116:119], a[80:83], v[32:35], v[116:119]
  v_mfma_f32_16x16x32_bf16 v[120:123], a[136:139], v[32:35], v[120:123]
  buffer_load_dwordx4 v2, s[8:11], s24 offen offset:2048 sc1 lds
  v_mfma_f32_16x16x32_bf16 v[124:127], a[192:195], v[32:35], v[124:127]
  s_waitcnt lgkmcnt(4)
  v_mfma_f32_16x16x32_bf16 v[96:99], a[28:31], v[8:11], v[96:99]
  ds_read_b128 v[28:31], v128 offset:23552
  v_mfma_f32_16x16x32_bf16 v[100:103], a[84:87], v[8:11], v[100:103]
  v_mfma_f32_16x16x32_bf16 v[104:107], a[140:143], v[8:11], v[104:107]
  v_mfma_f32_16x16x32_bf16 v[108:111], a[196:199], v[8:11], v[108:111]
  s_waitcnt lgkmcnt(4)
  buffer_load_dwordx4 v2, s[8:11], s24 offen offset:3072 sc1 lds
  v_mfma_f32_16x16x32_bf16 v[112:115], a[28:31], v[12:15], v[112:115]
  ds_read_b128 v[32:35], v128 offset:10240
  v_mfma_f32_16x16x32_bf16 v[116:119], a[84:87], v[12:15], v[116:119]
  v_mfma_f32_16x16x32_bf16 v[120:123], a[140:143], v[12:15], v[120:123]
  v_mfma_f32_16x16x32_bf16 v[124:127], a[196:199], v[12:15], v[124:127]
  s_waitcnt lgkmcnt(4)
  v_mfma_f32_16x16x32_bf16 v[96:99], a[32:35], v[16:19], v[96:99]
  ds_read_b128 v[8:11], v128 offset:24576
  v_mfma_f32_16x16x32_bf16 v[100:103], a[88:91], v[16:19], v[100:103]
  s_add_u32 m0, m0, 4096
  s_add_u32 s24, s24, 4096
  buffer_load_dwordx4 v2, s[8:11], s24 offen offset:0 sc1 lds
  v_mfma_f32_16x16x32_bf16 v[104:107], a[144:147], v[16:19], v[104:107]
  v_mfma_f32_16x16x32_bf16 v[108:111], a[200:203], v[16:19], v[108:111]
  s_waitcnt lgkmcnt(4)
  v_mfma_f32_16x16x32_bf16 v[112:115], a[32:35], v[20:23], v[112:115]
  ds_read_b128 v[12:15], v128 offset:11264
  v_mfma_f32_16x16x32_bf16 v[116:119], a[88:91], v[20:23], v[116:119]
  v_mfma_f32_16x16x32_bf16 v[120:123], a[144:147], v[20:23], v[120:123]
  buffer_load_dwordx4 v2, s[8:11], s24 offen offset:1024 sc1 lds
  v_mfma_f32_16x16x32_bf16 v[124:127], a[200:203], v[20:23], v[124:127]
  s_waitcnt lgkmcnt(4)
  v_mfma_f32_16x16x32_bf16 v[96:99], a[36:39], v[24:27], v[96:99]
  ds_read_b128 v[16:19], v128 offset:25600
  v_mfma_f32_16x16x32_bf16 v[100:103], a[92:95], v[24:27], v[100:103]
  v_mfma_f32_16x16x32_bf16 v[104:107], a[148:151], v[24:27], v[104:107]
  v_mfma_f32_16x16x32_bf16 v[108:111], a[204:207], v[24:27], v[108:111]
  s_waitcnt lgkmcnt(4)
  buffer_load_dwordx4 v2, s[8:11], s24 offen offset:2048 sc1 lds
  v_mfma_f32_16x16x32_bf16 v[112:115], a[36:39], v[28:31], v[112:115]
  ds_read_b128 v[20:23], v128 offset:12288
  v_mfma_f32_16x16x32_bf16 v[116:119], a[92:95], v[28:31], v[116:119]
  v_mfma_f32_16x16x32_bf16 v[120:123], a[148:151], v[28:31], v[120:123]
  v_mfma_f32_16x16x32_bf16 v[124:127], a[204:207], v[28:31], v[124:127]
  s_waitcnt lgkmcnt(4)
  v_mfma_f32_16x16x32_bf16 v[96:99], a[40:43], v[32:35], v[96:99]
  ds_read_b128 v[24:27], v128 offset:26624
  v_mfma_f32_16x16x32_bf16 v[100:103], a[96:99], v[32:35], v[100:103]
  s_add_u32 s33, s33, 28672
  s_cmp_eq_u32 s33, 114688
  s_cselect_b32 s33, 0, s33
  v_mfma_f32_16x16x32_bf16 v[104:107], a[152:155], v[32:35], v[104:107]
  s_add_u32 s32, s32, 28672
  s_cmp_eq_u32 s32, 114688
  s_cselect_b32 s32, 0, s32
  v_mfma_f32_16x16x32_bf16 v[108:111], a[208:211], v[32:35], v[108:111]
  s_waitcnt lgkmcnt(4)
  v_add_u32 v5, s32, v2
  v_mfma_f32_16x16x32_bf16 v[112:115], a[40:43], v[8:11], v[112:115]
  ds_read_b128 v[28:31], v128 offset:13312
  v_mfma_f32_16x16x32_bf16 v[116:119], a[96:99], v[8:11], v[116:119]
  v_mfma_f32_16x16x32_bf16 v[120:123], a[152:155], v[8:11], v[120:123]
  v_mfma_f32_16x16x32_bf16 v[124:127], a[208:211], v[8:11], v[124:127]
  s_waitcnt lgkmcnt(4)
  v_mfma_f32_16x16x32_bf16 v[96:99], a[44:47], v[12:15], v[96:99]
  ds_read_b128 v[32:35], v128 offset:27648
  v_mfma_f32_16x16x32_bf16 v[100:103], a[100:103], v[12:15], v[100:103]
  v_mfma_f32_16x16x32_bf16 v[104:107], a[156:159], v[12:15], v[104:107]
  v_mfma_f32_16x16x32_bf16 v[108:111], a[212:215], v[12:15], v[108:111]
  s_waitcnt lgkmcnt(4)
  v_mfma_f32_16x16x32_bf16 v[112:115], a[44:47], v[16:19], v[112:115]
  s_waitcnt vmcnt(11)
  s_barrier
  ds_read_b128 v[8:11], v5 offset:0
  v_mfma_f32_16x16x32_bf16 v[116:119], a[100:103], v[16:19], v[116:119]
  v_mfma_f32_16x16x32_bf16 v[120:123], a[156:159], v[16:19], v[120:123]
  v_mfma_f32_16x16x32_bf16 v[124:127], a[212:215], v[16:19], v[124:127]
  s_waitcnt lgkmcnt(4)
  v_mfma_f32_16x16x32_bf16 v[96:99], a[48:51], v[20:23], v[96:99]
  ds_read_b128 v[12:15], v5 offset:14336
  v_mfma_f32_16x16x32_bf16 v[100:103], a[104:107], v[20:23], v[100:103]
  v_mfma_f32_16x16x32_bf16 v[104:107], a[160:163], v[20:23], v[104:107]
  v_mfma_f32_16x16x32_bf16 v[108:111], a[216:219], v[20:23], v[108:111]
  s_waitcnt lgkmcnt(4)
  v_mfma_f32_16x16x32_bf16 v[112:115], a[48:51], v[24:27], v[112:115]
  ds_read_b128 v[16:19], v5 offset:1024
  v_mfma_f32_16x16x32_bf16 v[116:119], a[104:107], v[24:27], v[116:119]
  v_mfma_f32_16x16x32_bf16 v[120:123], a[160:163], v[24:27], v[120:123]
  v_mfma_f32_16x16x32_bf16 v[124:127], a[216:219], v[24:27], v[124:127]
  s_waitcnt lgkmcnt(4)
  v_mfma_f32_16x16x32_bf16 v[96:99], a[52:55], v[28:31], v[96:99]
  ds_read_b128 v[20:23], v5 offset:15360
  v_mfma_f32_16x16x32_bf16 v[100:103], a[108:111], v[28:31], v[100:103]
  v_mfma_f32_16x16x32_bf16 v[104:107], a[164:167], v[28:31], v[104:107]
  v_mfma_f32_16x16x32_bf16 v[108:111], a[220:223], v[28:31], v[108:111]
  s_waitcnt lgkmcnt(4)
  v_mfma_f32_16x16x32_bf16 v[112:115], a[52:55], v[32:35], v[112:115]
  ds_read_b128 v[24:27], v5 offset:2048
  v_mfma_f32_16x16x32_bf16 v[116:119], a[108:111], v[32:35], v[116:119]
  v_mfma_f32_16x16x32_bf16 v[120:123], a[164:167], v[32:35], v[120:123]
  v_mfma_f32_16x16x32_bf16 v[124:127], a[220:223], v[32:35], v[124:127]
  s_waitcnt lgkmcnt(4)
  s_mov_b32 s40, s19
  s_mov_b32 s41, s29
  s_add_u32 s19, s19, 1
  s_cmp_lt_u32 s19, s35
  s_cbranch_scc1 wg_vo_loop
  s_nop 3
  s_add_u32 s43, s41, 458752
  s_lshl_b32 s42, s40, 5
  s_add_u32 s42, s42, 0
  v_add_u32 v88, s42, v4
  v_mul_u32_u24 v89, 2341, v88
  v_lshrrev_b32 v89, 16, v89
  v_mul_u32_u24 v92, 28, v89
  v_sub_u32 v92, v88, v92
  v_cmp_gt_u32 vcc, 16, v92
  v_mul_u32_u24 v89, 84, v89
  s_nop 0
  v_cndmask_b32 v92, v7, v6, vcc
  v_add3_u32 v88, v88, v89, v92
  v_lshlrev_b32 v90, 4, v88
  v_cvt_pk_bf16_f32 v72, v96, v100
  v_cvt_pk_bf16_f32 v73, v97, v101
  v_cvt_pk_bf16_f32 v74, v98, v102
  v_cvt_pk_bf16_f32 v75, v99, v103
  buffer_store_dwordx4 v[72:75], v90, s[8:11], s41 offen sc1
  v_cvt_pk_bf16_f32 v76, v104, v108
  v_cvt_pk_bf16_f32 v77, v105, v109
  v_cvt_pk_bf16_f32 v78, v106, v110
  v_cvt_pk_bf16_f32 v79, v107, v111
  buffer_store_dwordx4 v[76:79], v90, s[8:11], s43 offen sc1
  s_lshl_b32 s42, s40, 5
  s_add_u32 s42, s42, 16
  v_add_u32 v88, s42, v4
  v_mul_u32_u24 v89, 2341, v88
  v_lshrrev_b32 v89, 16, v89
  v_mul_u32_u24 v92, 28, v89
  v_sub_u32 v92, v88, v92
  v_cmp_gt_u32 vcc, 16, v92
  v_mul_u32_u24 v89, 84, v89
  s_nop 0
  v_cndmask_b32 v92, v7, v6, vcc
  v_add3_u32 v88, v88, v89, v92
  v_lshlrev_b32 v91, 4, v88
  v_cvt_pk_bf16_f32 v80, v112, v116
  v_cvt_pk_bf16_f32 v81, v113, v117
  v_cvt_pk_bf16_f32 v82, v114, v118
  v_cvt_pk_bf16_f32 v83, v115, v119
  buffer_store_dwordx4 v[80:83], v91, s[8:11], s41 offen sc1
  v_cvt_pk_bf16_f32 v84, v120, v124
  v_cvt_pk_bf16_f32 v85, v121, v125
  v_cvt_pk_bf16_f32 v86, v122, v126
  v_cvt_pk_bf16_f32 v87, v123, v127
  buffer_store_dwordx4 v[84:87], v91, s[8:11], s43 offen sc1
  s_branch wg_done
wg_vo_e0:
  s_nop 7
  s_add_u32 s43, s41, 458752
  s_lshl_b32 s42, s40, 5
  s_add_u32 s42, s42, 0
  v_add_u32 v88, s42, v4
  v_mul_u32_u24 v89, 2341, v88
  v_lshrrev_b32 v89, 16, v89
  v_mul_u32_u24 v92, 28, v89
  v_sub_u32 v92, v88, v92
  v_cmp_gt_u32 vcc, 16, v92
  v_mul_u32_u24 v89, 84, v89
  s_nop 0
  v_cndmask_b32 v92, v7, v6, vcc
  v_add3_u32 v88, v88, v89, v92
  v_lshlrev_b32 v90, 4, v88
  v_cvt_pk_bf16_f32 v72, v40, v44
  v_cvt_pk_bf16_f32 v73, v41, v45
  v_cvt_pk_bf16_f32 v74, v42, v46
  v_cvt_pk_bf16_f32 v75, v43, v47
  buffer_store_dwordx4 v[72:75], v90, s[8:11], s41 offen sc1
  v_cvt_pk_bf16_f32 v76, v48, v52
  v_cvt_pk_bf16_f32 v77, v49, v53
  v_cvt_pk_bf16_f32 v78, v50, v54
  v_cvt_pk_bf16_f32 v79, v51, v55
  buffer_store_dwordx4 v[76:79], v90, s[8:11], s43 offen sc1
  s_lshl_b32 s42, s40, 5
  s_add_u32 s42, s42, 16
  v_add_u32 v88, s42, v4
  v_mul_u32_u24 v89, 2341, v88
  v_lshrrev_b32 v89, 16, v89
  v_mul_u32_u24 v92, 28, v89
  v_sub_u32 v92, v88, v92
  v_cmp_gt_u32 vcc, 16, v92
  v_mul_u32_u24 v89, 84, v89
  s_nop 0
  v_cndmask_b32 v92, v7, v6, vcc
  v_add3_u32 v88, v88, v89, v92
  v_lshlrev_b32 v91, 4, v88
  v_cvt_pk_bf16_f32 v80, v56, v60
  v_cvt_pk_bf16_f32 v81, v57, v61
  v_cvt_pk_bf16_f32 v82, v58, v62
  v_cvt_pk_bf16_f32 v83, v59, v63
  buffer_store_dwordx4 v[80:83], v91, s[8:11], s41 offen sc1
  v_cvt_pk_bf16_f32 v84, v64, v68
  v_cvt_pk_bf16_f32 v85, v65, v69
  v_cvt_pk_bf16_f32 v86, v66, v70
  v_cvt_pk_bf16_f32 v87, v67, v71
  buffer_store_dwordx4 v[84:87], v91, s[8:11], s43 offen sc1
  s_branch wg_done
wg_done:
  s_lshl_b32 s20, s18, 4
  s_and_b32 s21, s17, 15
  s_add_u32 s20, s20, s21
  s_lshl_b32 s20, s20, 7
  s_cmp_lt_u32 s17, 16
  s_cselect_b32 s21, 16384, 0
  s_add_u32 s20, s20, s21
  s_add_u32 s20, s20, 524288
  s_sub_u32 s21, s35, s34
  s_lshl_b32 s21, s21, 2
  v_mov_b32 v5, s21
  v_mov_b32 v6, 0
  s_waitcnt vmcnt(0) lgkmcnt(0)
  s_barrier
  s_cmp_lg_u32 s16, 0
  s_cbranch_scc1 wg_sg
  s_mov_b64 exec, 1
  buffer_atomic_add v5, v6, s[8:11], s20 offen
  s_mov_b64 exec, -1
wg_sg:
  s_branch wk_loop
wk_srv:
  s_mov_b32 s96, 7
  v_mov_b32 v4, 1
  v_mov_b32 v5, 587392
  v_mov_b32 v6, 160000
  s_barrier
  s_cmp_lg_u32 s16, 0
  s_cbranch_scc1 wk_sve1
  s_mov_b64 exec, 1
  buffer_atomic_add v4, v5, s[8:11], 0 offen sc0
  s_waitcnt vmcnt(0)
  ds_write_b32 v6, v4
  s_waitcnt lgkmcnt(0)
  s_mov_b64 exec, -1
wk_sve1:
  s_barrier
  ds_read_b32 v4, v6
  s_waitcnt lgkmcnt(0)
  v_readfirstlane_b32 s3, v4
  v_and_b32 v1, 63, v0
  v_lshlrev_b32 v2, 4, v1
  v_lshrrev_b32 v3, 4, v1
  v_and_b32 v4, 15, v1
  v_mov_b32 v250, 0
  s_cmp_ge_u32 s3, 32
  s_cbranch_scc1 wk_ask
  s_and_b32 s18, s3, 15
  s_lshr_b32 s19, s3, 4
  s_and_b32 s19, s19, 1
  s_mul_i32 s20, s18, 401408
  s_mul_i32 s21, s16, 100352
  s_add_u32 s20, s20, s21
  s_add_u32 s20, s20, 39976960
  s_add_u32 s22, s20, 0
  buffer_load_dwordx4 a[0:3], v2, s[8:11], s22 offen offset:0 sc1
  buffer_load_dwordx4 a[4:7], v2, s[8:11], s22 offen offset:1024 sc1
  buffer_load_dwordx4 a[8:11], v2, s[8:11], s22 offen offset:2048 sc1
  buffer_load_dwordx4 a[12:15], v2, s[8:11], s22 offen offset:3072 sc1
  s_add_u32 s22, s20, 4096
  buffer_load_dwordx4 a[16:19], v2, s[8:11], s22 offen offset:0 sc1
  buffer_load_dwordx4 a[20:23], v2, s[8:11], s22 offen offset:1024 sc1
  buffer_load_dwordx4 a[24:27], v2, s[8:11], s22 offen offset:2048 sc1
  buffer_load_dwordx4 a[28:31], v2, s[8:11], s22 offen offset:3072 sc1
  s_add_u32 s22, s20, 8192
  buffer_load_dwordx4 a[32:35], v2, s[8:11], s22 offen offset:0 sc1
  buffer_load_dwordx4 a[36:39], v2, s[8:11], s22 offen offset:1024 sc1
  s_waitcnt vmcnt(8)
  buffer_load_dwordx4 a[40:43], v2, s[8:11], s22 offen offset:2048 sc1
  buffer_load_dwordx4 a[44:47], v2, s[8:11], s22 offen offset:3072 sc1
  s_waitcnt vmcnt(8)
  s_add_u32 s22, s20, 12288
  buffer_load_dwordx4 a[48:51], v2, s[8:11], s22 offen offset:0 sc1
  buffer_load_dwordx4 a[52:55], v2, s[8:11], s22 offen offset:1024 sc1
  s_waitcnt vmcnt(8)
  buffer_load_dwordx4 a[56:59], v2, s[8:11], s22 offen offset:2048 sc1
  buffer_load_dwordx4 a[60:63], v2, s[8:11], s22 offen offset:3072 sc1
  s_waitcnt vmcnt(8)
  s_add_u32 s22, s20, 16384
  buffer_load_dwordx4 a[64:67], v2, s[8:11], s22 offen offset:0 sc1
  buffer_load_dwordx4 a[68:71], v2, s[8:11], s22 offen offset:1024 sc1
  s_waitcnt vmcnt(8)
  buffer_load_dwordx4 a[72:75], v2, s[8:11], s22 offen offset:2048 sc1
  buffer_load_dwordx4 a[76:79], v2, s[8:11], s22 offen offset:3072 sc1
  s_waitcnt vmcnt(8)
  s_add_u32 s22, s20, 20480
  buffer_load_dwordx4 a[80:83], v2, s[8:11], s22 offen offset:0 sc1
  buffer_load_dwordx4 a[84:87], v2, s[8:11], s22 offen offset:1024 sc1
  s_waitcnt vmcnt(8)
  buffer_load_dwordx4 a[88:91], v2, s[8:11], s22 offen offset:2048 sc1
  buffer_load_dwordx4 a[92:95], v2, s[8:11], s22 offen offset:3072 sc1
  s_waitcnt vmcnt(8)
  s_add_u32 s22, s20, 24576
  buffer_load_dwordx4 a[96:99], v2, s[8:11], s22 offen offset:0 sc1
  buffer_load_dwordx4 a[100:103], v2, s[8:11], s22 offen offset:1024 sc1
  s_waitcnt vmcnt(8)
  buffer_load_dwordx4 a[104:107], v2, s[8:11], s22 offen offset:2048 sc1
  buffer_load_dwordx4 a[108:111], v2, s[8:11], s22 offen offset:3072 sc1
  s_waitcnt vmcnt(8)
  s_add_u32 s22, s20, 28672
  buffer_load_dwordx4 a[112:115], v2, s[8:11], s22 offen offset:0 sc1
  buffer_load_dwordx4 a[116:119], v2, s[8:11], s22 offen offset:1024 sc1
  s_waitcnt vmcnt(8)
  buffer_load_dwordx4 a[120:123], v2, s[8:11], s22 offen offset:2048 sc1
  buffer_load_dwordx4 a[124:127], v2, s[8:11], s22 offen offset:3072 sc1
  s_waitcnt vmcnt(8)
  s_add_u32 s22, s20, 32768
  buffer_load_dwordx4 a[128:131], v2, s[8:11], s22 offen offset:0 sc1
  buffer_load_dwordx4 a[132:135], v2, s[8:11], s22 offen offset:1024 sc1
  s_waitcnt vmcnt(8)
  buffer_load_dwordx4 a[136:139], v2, s[8:11], s22 offen offset:2048 sc1
  buffer_load_dwordx4 a[140:143], v2, s[8:11], s22 offen offset:3072 sc1
  s_waitcnt vmcnt(8)
  s_add_u32 s22, s20, 36864
  buffer_load_dwordx4 a[144:147], v2, s[8:11], s22 offen offset:0 sc1
  buffer_load_dwordx4 a[148:151], v2, s[8:11], s22 offen offset:1024 sc1
  s_waitcnt vmcnt(8)
  buffer_load_dwordx4 a[152:155], v2, s[8:11], s22 offen offset:2048 sc1
  buffer_load_dwordx4 a[156:159], v2, s[8:11], s22 offen offset:3072 sc1
  s_waitcnt vmcnt(8)
  s_add_u32 s22, s20, 40960
  buffer_load_dwordx4 a[160:163], v2, s[8:11], s22 offen offset:0 sc1
  buffer_load_dwordx4 a[164:167], v2, s[8:11], s22 offen offset:1024 sc1
  s_waitcnt vmcnt(8)
  buffer_load_dwordx4 a[168:171], v2, s[8:11], s22 offen offset:2048 sc1
  buffer_load_dwordx4 a[172:175], v2, s[8:11], s22 offen offset:3072 sc1
  s_waitcnt vmcnt(8)
  s_add_u32 s22, s20, 45056
  buffer_load_dwordx4 a[176:179], v2, s[8:11], s22 offen offset:0 sc1
  buffer_load_dwordx4 a[180:183], v2, s[8:11], s22 offen offset:1024 sc1
  s_waitcnt vmcnt(8)
  buffer_load_dwordx4 a[184:187], v2, s[8:11], s22 offen offset:2048 sc1
  buffer_load_dwordx4 a[188:191], v2, s[8:11], s22 offen offset:3072 sc1
  s_waitcnt vmcnt(8)
  s_add_u32 s22, s20, 49152
  buffer_load_dwordx4 a[192:195], v2, s[8:11], s22 offen offset:0 sc1
  buffer_load_dwordx4 a[196:199], v2, s[8:11], s22 offen offset:1024 sc1
  s_waitcnt vmcnt(8)
  buffer_load_dwordx4 a[200:203], v2, s[8:11], s22 offen offset:2048 sc1
  buffer_load_dwordx4 a[204:207], v2, s[8:11], s22 offen offset:3072 sc1
  s_waitcnt vmcnt(8)
  s_add_u32 s22, s20, 53248
  buffer_load_dwordx4 a[208:211], v2, s[8:11], s22 offen offset:0 sc1
  buffer_load_dwordx4 a[212:215], v2, s[8:11], s22 offen offset:1024 sc1
  s_waitcnt vmcnt(8)
  buffer_load_dwordx4 a[216:219], v2, s[8:11], s22 offen offset:2048 sc1
  buffer_load_dwordx4 a[220:223], v2, s[8:11], s22 offen offset:3072 sc1
  s_waitcnt vmcnt(8)
  s_add_u32 s22, s20, 57344
  buffer_load_dwordx4 a[224:227], v2, s[8:11], s22 offen offset:0 sc1
  buffer_load_dwordx4 a[228:231], v2, s[8:11], s22 offen offset:1024 sc1
  s_waitcnt vmcnt(8)
  buffer_load_dwordx4 a[232:235], v2, s[8:11], s22 offen offset:2048 sc1
  buffer_load_dwordx4 a[236:239], v2, s[8:11], s22 offen offset:3072 sc1
  s_waitcnt vmcnt(8)
  s_add_u32 s22, s20, 61440
  buffer_load_dwordx4 a[240:243], v2, s[8:11], s22 offen offset:0 sc1
  buffer_load_dwordx4 a[244:247], v2, s[8:11], s22 offen offset:1024 sc1
  s_waitcnt vmcnt(8)
  buffer_load_dwordx4 a[248:251], v2, s[8:11], s22 offen offset:2048 sc1
  buffer_load_dwordx4 a[252:255], v2, s[8:11], s22 offen offset:3072 sc1
  s_waitcnt vmcnt(8)
  s_add_u32 s22, s20, 65536
  buffer_load_dwordx4 v[120:123], v2, s[8:11], s22 offen offset:0 sc1
  buffer_load_dwordx4 v[124:127], v2, s[8:11], s22 offen offset:1024 sc1
  s_waitcnt vmcnt(8)
  buffer_load_dwordx4 v[128:131], v2, s[8:11], s22 offen offset:2048 sc1
  buffer_load_dwordx4 v[132:135], v2, s[8:11], s22 offen offset:3072 sc1
  s_waitcnt vmcnt(8)
  s_add_u32 s22, s20, 69632
  buffer_load_dwordx4 v[136:139], v2, s[8:11], s22 offen offset:0 sc1
  buffer_load_dwordx4 v[140:143], v2, s[8:11], s22 offen offset:1024 sc1
  s_waitcnt vmcnt(8)
  buffer_load_dwordx4 v[144:147], v2, s[8:11], s22 offen offset:2048 sc1
  buffer_load_dwordx4 v[148:151], v2, s[8:11], s22 offen offset:3072 sc1
  s_waitcnt vmcnt(8)
  s_add_u32 s22, s20, 73728
  buffer_load_dwordx4 v[152:155], v2, s[8:11], s22 offen offset:0 sc1
  buffer_load_dwordx4 v[156:159], v2, s[8:11], s22 offen offset:1024 sc1
  s_waitcnt vmcnt(8)
  buffer_load_dwordx4 v[160:163], v2, s[8:11], s22 offen offset:2048 sc1
  buffer_load_dwordx4 v[164:167], v2, s[8:11], s22 offen offset:3072 sc1
  s_waitcnt vmcnt(8)
  s_add_u32 s22, s20, 77824
  buffer_load_dwordx4 v[168:171], v2, s[8:11], s22 offen offset:0 sc1
  buffer_load_dwordx4 v[172:175], v2, s[8:11], s22 offen offset:1024 sc1
  s_waitcnt vmcnt(8)
  buffer_load_dwordx4 v[176:179], v2, s[8:11], s22 offen offset:2048 sc1
  buffer_load_dwordx4 v[180:183], v2, s[8:11], s22 offen offset:3072 sc1
  s_waitcnt vmcnt(8)
  s_add_u32 s22, s20, 81920
  buffer_load_dwordx4 v[184:187], v2, s[8:11], s22 offen offset:0 sc1
  buffer_load_dwordx4 v[188:191], v2, s[8:11], s22 offen offset:1024 sc1
  s_waitcnt vmcnt(8)
  buffer_load_dwordx4 v[192:195], v2, s[8:11], s22 offen offset:2048 sc1
  buffer_load_dwordx4 v[196:199], v2, s[8:11], s22 offen offset:3072 sc1
  s_waitcnt vmcnt(8)
  s_add_u32 s22, s20, 86016
  buffer_load_dwordx4 v[200:203], v2, s[8:11], s22 offen offset:0 sc1
  buffer_load_dwordx4 v[204:207], v2, s[8:11], s22 offen offset:1024 sc1
  s_waitcnt vmcnt(8)
  buffer_load_dwordx4 v[208:211], v2, s[8:11], s22 offen offset:2048 sc1
  buffer_load_dwordx4 v[212:215], v2, s[8:11], s22 offen offset:3072 sc1
  s_waitcnt vmcnt(8)
  s_add_u32 s22, s20, 90112
  buffer_load_dwordx4 v[216:219], v2, s[8:11], s22 offen offset:0 sc1
  buffer_load_dwordx4 v[220:223], v2, s[8:11], s22 offen offset:1024 sc1
  s_waitcnt vmcnt(8)
  buffer_load_dwordx4 v[224:227], v2, s[8:11], s22 offen offset:2048 sc1
  buffer_load_dwordx4 v[228:231], v2, s[8:11], s22 offen offset:3072 sc1
  s_waitcnt vmcnt(8)
  s_add_u32 s22, s20, 94208
  buffer_load_dwordx4 v[232:235], v2, s[8:11], s22 offen offset:0 sc1
  buffer_load_dwordx4 v[236:239], v2, s[8:11], s22 offen offset:1024 sc1
  s_waitcnt vmcnt(8)
  buffer_load_dwordx4 v[240:243], v2, s[8:11], s22 offen offset:2048 sc1
  buffer_load_dwordx4 v[244:247], v2, s[8:11], s22 offen offset:3072 sc1
  s_waitcnt vmcnt(8)
  s_add_u32 s22, s20, 98304
  buffer_load_dwordx4 v[248:251], v2, s[8:11], s22 offen offset:0 sc1
  buffer_load_dwordx4 v[252:255], v2, s[8:11], s22 offen offset:1024 sc1
  s_waitcnt vmcnt(8)
  v_mov_b32 v5, 0x4444
  v_mov_b32 v6, 0xeeee
  v_cmp_lt_u32 vcc, 7, v4
  s_nop 1
  v_cndmask_b32 v5, v5, v6, vcc
  s_lshl_b32 s23, s16, 11
  v_lshrrev_b32 v80, 1, v3
  v_and_b32 v81, 1, v3
  v_add_u32 v82, 0, v80
  v_lshl_add_u32 v82, v82, 4, v4
  v_mul_u32_u24 v83, 2341, v82
  v_lshrrev_b32 v83, 16, v83
  v_mul_u32_u24 v84, 28, v83
  v_sub_u32 v84, v82, v84
  v_lshrrev_b32 v85, 4, v84
  v_and_b32 v84, 15, v84
  v_lshlrev_b32 v86, 10, v85
  v_lshl_add_u32 v86, v83, 8, v86
  v_lshl_add_u32 v86, v84, 4, v86
  v_lshl_add_u32 v86, v81, 3, v86
  v_add_u32 v72, s23, v86
  v_add_u32 v82, 2, v80
  v_lshl_add_u32 v82, v82, 4, v4
  v_mul_u32_u24 v83, 2341, v82
  v_lshrrev_b32 v83, 16, v83
  v_mul_u32_u24 v84, 28, v83
  v_sub_u32 v84, v82, v84
  v_lshrrev_b32 v85, 4, v84
  v_and_b32 v84, 15, v84
  v_lshlrev_b32 v86, 10, v85
  v_lshl_add_u32 v86, v83, 8, v86
  v_lshl_add_u32 v86, v84, 4, v86
  v_lshl_add_u32 v86, v81, 3, v86
  v_add_u32 v73, s23, v86
  v_add_u32 v82, 4, v80
  v_lshl_add_u32 v82, v82, 4, v4
  v_mul_u32_u24 v83, 2341, v82
  v_lshrrev_b32 v83, 16, v83
  v_mul_u32_u24 v84, 28, v83
  v_sub_u32 v84, v82, v84
  v_lshrrev_b32 v85, 4, v84
  v_and_b32 v84, 15, v84
  v_lshlrev_b32 v86, 10, v85
  v_lshl_add_u32 v86, v83, 8, v86
  v_lshl_add_u32 v86, v84, 4, v86
  v_lshl_add_u32 v86, v81, 3, v86
  v_add_u32 v74, s23, v86
  v_mov_b32 v82, 6
  v_lshl_add_u32 v82, v82, 4, v4
  v_mul_u32_u24 v83, 2341, v82
  v_lshrrev_b32 v83, 16, v83
  v_mul_u32_u24 v84, 28, v83
  v_sub_u32 v84, v82, v84
  v_lshrrev_b32 v85, 4, v84
  v_and_b32 v84, 15, v84
  v_lshlrev_b32 v86, 10, v85
  v_lshl_add_u32 v86, v83, 8, v86
  v_lshl_add_u32 v86, v84, 4, v86
  v_lshl_add_u32 v86, v81, 3, v86
  v_add_u32 v75, s23, v86
  v_add_u32 v76, s23, v2
  s_mul_i32 s27, s18, 448
  v_mov_b32 v77, s27
  v_mov_b32 v78, 1
  s_mov_b32 s17, s19
  s_mul_i32 s24, s19, 7168
  s_add_u32 s24, s24, 65536
  s_mul_i32 s25, s18, 65
  s_add_u32 s25, s25, s19
  s_lshl_b32 s25, s25, 13
  s_add_u32 s25, s25, s23
  s_add_u32 s25, s25, 77602816
  s_lshl_b32 s26, s18, 6
  s_add_u32 s26, s26, s19
  s_lshl_b32 s26, s26, 4
  s_lshl_b32 s27, s16, 2
  s_add_u32 s26, s26, s27
  s_add_u32 s26, s26, 565248
  v_mov_b32 v88, 0
  v_mov_b32 v89, 0
  v_mov_b32 v90, 0
  v_mov_b32 v91, 0
  v_mov_b32 v92, -1
  v_mov_b32 v93, -1
  v_mov_b32 v94, -1
  v_mov_b32 v95, -1
  ds_write_b128 v76, v[88:91]
  ds_write_b128 v76, v[88:91] offset:1024
  s_mov_b32 s28, s25
  s_mov_b32 s29, 0
ws_arm:
  buffer_store_dwordx4 v[92:95], v2, s[8:11], s28 offen sc1
  buffer_store_dwordx4 v[92:95], v2, s[8:11], s28 offen offset:1024 sc1
  s_waitcnt vmcnt(8)
  s_add_u32 s28, s28, 16384
  s_add_u32 s29, s29, 1
  s_cmp_lt_u32 s29, 31
  s_cbranch_scc1 ws_arm
  s_waitcnt vmcnt(0)
  s_mov_b64 exec, 1
  buffer_store_dword v78, v2, s[8:11], s26 offen sc1
  s_mov_b64 exec, -1
ws_loop:
  v_mov_b32 v36, 0
  v_mov_b32 v37, 0
  v_mov_b32 v38, 0
  v_mov_b32 v39, 0
  v_mov_b32 v40, 0
  v_mov_b32 v41, 0
  v_mov_b32 v42, 0
  v_mov_b32 v43, 0
  v_mov_b32 v44, 0
  v_mov_b32 v45, 0
  v_mov_b32 v46, 0
  v_mov_b32 v47, 0
  v_mov_b32 v48, 0
  v_mov_b32 v49, 0
  v_mov_b32 v50, 0
  v_mov_b32 v51, 0
  v_mov_b32 v52, 0
  v_mov_b32 v53, 0
  v_mov_b32 v54, 0
  v_mov_b32 v55, 0
  v_mov_b32 v56, 0
  v_mov_b32 v57, 0
  v_mov_b32 v58, 0
  v_mov_b32 v59, 0
  v_mov_b32 v60, 0
  v_mov_b32 v61, 0
  v_mov_b32 v62, 0
  v_mov_b32 v63, 0
  s_mov_b32 s30, 0
  s_branch ws_fl
ws_pm:
  s_cmp_ge_u32 s17, 64
  s_cbranch_scc1 ws_fl
  buffer_load_dword v79, v77, s[8:11], s24 offen sc1
  s_waitcnt vmcnt(0)
  v_cmp_eq_u32 vcc, -1, v79
  s_cbranch_vccnz ws_pr
ws_fl:
  s_add_u32 s22, s24, 4096
  buffer_load_dwordx4 v[8:11], v2, s[8:11], s24 offen offset:0 sc1
  buffer_load_dwordx4 v[12:15], v2, s[8:11], s24 offen offset:1024 sc1
  buffer_load_dwordx4 v[16:19], v2, s[8:11], s24 offen offset:2048 sc1
  buffer_load_dwordx4 v[20:23], v2, s[8:11], s24 offen offset:3072 sc1
  buffer_load_dwordx4 v[24:27], v2, s[8:11], s22 offen offset:0 sc1
  buffer_load_dwordx4 v[28:31], v2, s[8:11], s22 offen offset:1024 sc1
  buffer_load_dwordx4 v[32:35], v2, s[8:11], s22 offen offset:2048 sc1
  s_waitcnt vmcnt(0)
  v_max_u32 v79, v8, v9
  v_max3_u32 v79, v79, v10, v11
  v_max3_u32 v79, v79, v12, v13
  v_max3_u32 v79, v79, v14, v15
  v_max3_u32 v79, v79, v16, v17
  v_max3_u32 v79, v79, v18, v19
  v_max3_u32 v79, v79, v20, v21
  v_max3_u32 v79, v79, v22, v23
  v_max3_u32 v79, v79, v24, v25
  v_max3_u32 v79, v79, v26, v27
  v_max3_u32 v79, v79, v28, v29
  v_max3_u32 v79, v79, v30, v31
  v_max3_u32 v79, v79, v32, v33
  v_max3_u32 v79, v79, v34, v35
  v_cmp_eq_u32 vcc, -1, v79
  s_cbranch_vccz ws_pk
ws_pr:
  s_sleep 20
  s_add_u32 s30, s30, 1
  s_cmp_lt_u32 s30, 2000000
  s_cbranch_scc1 ws_pm
  s_branch cA_abort
ws_pk:
  v_smfmac_f32_16x16x64_bf16 v[36:39], v[8:11], a[0:7], v5
  v_smfmac_f32_16x16x64_bf16 v[36:39], v[12:15], a[8:15], v5
  v_smfmac_f32_16x16x64_bf16 v[36:39], v[16:19], a[16:23], v5
  v_smfmac_f32_16x16x64_bf16 v[36:39], v[20:23], a[24:31], v5
  v_smfmac_f32_16x16x64_bf16 v[36:39], v[24:27], a[32:39], v5
  v_smfmac_f32_16x16x64_bf16 v[36:39], v[28:31], a[40:47], v5
  v_smfmac_f32_16x16x64_bf16 v[36:39], v[32:35], a[48:55], v5
  v_smfmac_f32_16x16x64_bf16 v[40:43], v[8:11], a[56:63], v5
  v_smfmac_f32_16x16x64_bf16 v[40:43], v[12:15], a[64:71], v5
  v_smfmac_f32_16x16x64_bf16 v[40:43], v[16:19], a[72:79], v5
  v_smfmac_f32_16x16x64_bf16 v[40:43], v[20:23], a[80:87], v5
  v_smfmac_f32_16x16x64_bf16 v[40:43], v[24:27], a[88:95], v5
  v_smfmac_f32_16x16x64_bf16 v[40:43], v[28:31], a[96:103], v5
  v_smfmac_f32_16x16x64_bf16 v[40:43], v[32:35], a[104:111], v5
  v_smfmac_f32_16x16x64_bf16 v[44:47], v[8:11], a[112:119], v5
  v_smfmac_f32_16x16x64_bf16 v[44:47], v[12:15], a[120:127], v5
  v_smfmac_f32_16x16x64_bf16 v[44:47], v[16:19], a[128:135], v5
  v_smfmac_f32_16x16x64_bf16 v[44:47], v[20:23], a[136:143], v5
  v_smfmac_f32_16x16x64_bf16 v[44:47], v[24:27], a[144:151], v5
  v_smfmac_f32_16x16x64_bf16 v[44:47], v[28:31], a[152:159], v5
  v_smfmac_f32_16x16x64_bf16 v[44:47], v[32:35], a[160:167], v5
  v_smfmac_f32_16x16x64_bf16 v[48:51], v[8:11], a[168:175], v5
  v_smfmac_f32_16x16x64_bf16 v[48:51], v[12:15], a[176:183], v5
  v_smfmac_f32_16x16x64_bf16 v[48:51], v[16:19], a[184:191], v5
  v_smfmac_f32_16x16x64_bf16 v[48:51], v[20:23], a[192:199], v5
  v_smfmac_f32_16x16x64_bf16 v[48:51], v[24:27], a[200:207], v5
  v_smfmac_f32_16x16x64_bf16 v[48:51], v[28:31], a[208:215], v5
  v_smfmac_f32_16x16x64_bf16 v[48:51], v[32:35], a[216:223], v5
  v_smfmac_f32_16x16x64_bf16 v[52:55], v[8:11], a[224:231], v5
  v_smfmac_f32_16x16x64_bf16 v[52:55], v[12:15], a[232:239], v5
  v_smfmac_f32_16x16x64_bf16 v[52:55], v[16:19], a[240:247], v5
  v_smfmac_f32_16x16x64_bf16 v[52:55], v[20:23], a[248:255], v5
  v_smfmac_f32_16x16x64_bf16 v[52:55], v[24:27], v[120:127], v5
  v_smfmac_f32_16x16x64_bf16 v[52:55], v[28:31], v[128:135], v5
  v_smfmac_f32_16x16x64_bf16 v[52:55], v[32:35], v[136:143], v5
  v_smfmac_f32_16x16x64_bf16 v[56:59], v[8:11], v[144:151], v5
  v_smfmac_f32_16x16x64_bf16 v[56:59], v[12:15], v[152:159], v5
  v_smfmac_f32_16x16x64_bf16 v[56:59], v[16:19], v[160:167], v5
  v_smfmac_f32_16x16x64_bf16 v[56:59], v[20:23], v[168:175], v5
  v_smfmac_f32_16x16x64_bf16 v[56:59], v[24:27], v[176:183], v5
  v_smfmac_f32_16x16x64_bf16 v[56:59], v[28:31], v[184:191], v5
  v_smfmac_f32_16x16x64_bf16 v[56:59], v[32:35], v[192:199], v5
  v_smfmac_f32_16x16x64_bf16 v[60:63], v[8:11], v[200:207], v5
  v_smfmac_f32_16x16x64_bf16 v[60:63], v[12:15], v[208:215], v5
  v_smfmac_f32_16x16x64_bf16 v[60:63], v[16:19], v[216:223], v5
  v_smfmac_f32_16x16x64_bf16 v[60:63], v[20:23], v[224:231], v5
  v_smfmac_f32_16x16x64_bf16 v[60:63], v[24:27], v[232:239], v5
  v_smfmac_f32_16x16x64_bf16 v[60:63], v[28:31], v[240:247], v5
  v_smfmac_f32_16x16x64_bf16 v[60:63], v[32:35], v[248:255], v5
  v_permlane32_swap_b32 v36, v40
  v_permlane32_swap_b32 v37, v41
  v_permlane32_swap_b32 v38, v42
  v_permlane32_swap_b32 v39, v43
  v_add_f32 v36, v36, v40
  v_add_f32 v37, v37, v41
  v_add_f32 v38, v38, v42
  v_add_f32 v39, v39, v43
  v_cvt_pk_bf16_f32 v40, v36, v37
  v_cvt_pk_bf16_f32 v41, v38, v39
  v_min_u32 v40, -2, v40
  v_min_u32 v41, -2, v41
  ds_write_b64 v72, v[40:41]
  v_permlane32_swap_b32 v44, v48
  v_permlane32_swap_b32 v45, v49
  v_permlane32_swap_b32 v46, v50
  v_permlane32_swap_b32 v47, v51
  v_add_f32 v44, v44, v48
  v_add_f32 v45, v45, v49
  v_add_f32 v46, v46, v50
  v_add_f32 v47, v47, v51
  v_cvt_pk_bf16_f32 v48, v44, v45
  v_cvt_pk_bf16_f32 v49, v46, v47
  v_min_u32 v48, -2, v48
  v_min_u32 v49, -2, v49
  ds_write_b64 v73, v[48:49]
  v_permlane32_swap_b32 v52, v56
  v_permlane32_swap_b32 v53, v57
  v_permlane32_swap_b32 v54, v58
  v_permlane32_swap_b32 v55, v59
  v_add_f32 v52, v52, v56
  v_add_f32 v53, v53, v57
  v_add_f32 v54, v54, v58
  v_add_f32 v55, v55, v59
  v_cvt_pk_bf16_f32 v56, v52, v53
  v_cvt_pk_bf16_f32 v57, v54, v55
  v_min_u32 v56, -2, v56
  v_min_u32 v57, -2, v57
  ds_write_b64 v74, v[56:57]
  v_mov_b32 v64, v60
  v_mov_b32 v65, v61
  v_mov_b32 v66, v62
  v_mov_b32 v67, v63
  v_permlane32_swap_b32 v60, v64
  v_permlane32_swap_b32 v61, v65
  v_permlane32_swap_b32 v62, v66
  v_permlane32_swap_b32 v63, v67
  v_add_f32 v60, v60, v64
  v_add_f32 v61, v61, v65
  v_add_f32 v62, v62, v66
  v_add_f32 v63, v63, v67
  v_cvt_pk_bf16_f32 v64, v60, v61
  v_cvt_pk_bf16_f32 v65, v62, v63
  v_min_u32 v64, -2, v64
  v_min_u32 v65, -2, v65
  ds_write_b64 v75, v[64:65]
  s_waitcnt lgkmcnt(0)
  ds_read_b128 v[64:67], v76
  ds_read_b128 v[68:71], v76 offset:1024
  s_waitcnt lgkmcnt(0)
  buffer_store_dwordx4 v[64:67], v2, s[8:11], s25 offen sc1
  buffer_store_dwordx4 v[68:71], v2, s[8:11], s25 offen offset:1024 sc1
  s_add_u32 s24, s24, 14336
  s_add_u32 s25, s25, 16384
  s_add_u32 s17, s17, 2
  s_cmp_lt_u32 s17, 62
  s_cbranch_scc1 ws_loop
  v_mov_b32 v250, 0
  s_branch wk_loop
wk_s4d:
  s_sub_u32 s3, s3, 640
  s_getreg_b32 s33, hwreg(HW_REG_XCC_ID)
  s_sub_u32 s33, s33, 2
  s_and_b32 s33, s33, 7
  s_min_u32 s33, s33, 6
  s_mov_b32 s35, 6
wk_s4c:
  s_lshl_b32 s34, s33, 7
  s_add_u32 s34, s34, 588416
  v_mov_b32 v4, 1
  v_mov_b32 v5, s34
  v_mov_b32 v6, 160000
  s_barrier
  s_cmp_lg_u32 s16, 0
  s_cbranch_scc1 wk_s4e1
  s_mov_b64 exec, 1
  buffer_atomic_add v4, v5, s[8:11], 0 offen sc0
  s_waitcnt vmcnt(0)
  ds_write_b32 v6, v4
  s_waitcnt lgkmcnt(0)
  s_mov_b64 exec, -1
wk_s4e1:
  s_barrier
  ds_read_b32 v4, v6
  s_waitcnt lgkmcnt(0)
  v_readfirstlane_b32 s3, v4
  s_cmp_lt_u32 s3, 16
  s_cbranch_scc1 wk_s4g
  s_mov_b32 s33, s35
  s_sub_u32 s35, s35, 1
  s_max_i32 s35, s35, 0
  s_branch wk_s4c
wk_s4g:
  s_lshl_b32 s33, s33, 4
  s_add_u32 s3, s3, s33
  s_load_dwordx8 s[40:47], s[0:1], 0
  s_load_dwordx4 s[48:51], s[0:1], 32
  s_load_dwordx2 s[52:53], s[0:1], 48
  s_load_dwordx2 s[54:55], s[0:1], 112
  v_lshrrev_b32 v1, 6, v0
  s_nop 0
  v_readfirstlane_b32 s16, v1
  v_and_b32 v1, 63, v0
  v_lshrrev_b32 v3, 4, v1
  v_and_b32 v4, 15, v1
  s_mul_i32 s17, s16, 24576
  s_waitcnt lgkmcnt(0)
  s_mov_b32 s60, s40
  s_and_b32 s61, s41, 0xffff
  s_mov_b32 s62, 1835008
  s_mov_b32 s63, 0x20000
  s_mov_b32 s64, s42
  s_and_b32 s65, s43, 0xffff
  s_mov_b32 s66, 229376
  s_mov_b32 s67, 0x20000
  s_mov_b32 s68, s44
  s_and_b32 s69, s45, 0xffff
  s_mov_b32 s70, 229376
  s_mov_b32 s71, 0x20000
  s_mov_b32 s72, s46
  s_and_b32 s73, s47, 0xffff
  s_mov_b32 s74, 229376
  s_mov_b32 s75, 0x20000
  s_mov_b32 s76, s48
  s_and_b32 s77, s49, 0xffff
  s_mov_b32 s78, 229376
  s_mov_b32 s79, 0x20000
  s_mov_b32 s80, s50
  s_and_b32 s81, s51, 0xffff
  s_mov_b32 s82, 896
  s_mov_b32 s83, 0x20000
  s_mov_b32 s84, s52
  s_and_b32 s85, s53, 0xffff
  s_mov_b32 s86, 896
  s_mov_b32 s87, 0x20000
  s_mov_b32 s88, s54
  s_and_b32 s89, s55, 0xffff
  s_mov_b32 s90, 3670016
  s_mov_b32 s91, 0x20000
  v_lshlrev_b32 v5, 5, v1
  v_sub_u32 v5, 2047, v5
  s_add_u32 s18, s17, 13056
  v_subrev_u32 v6, 0, v5
  v_max_i32 v7, 0, v6
  v_cvt_f32_u32 v7, v7
  v_cvt_pk_bf16_f32 v8, v7, v7
  v_and_b32 v7, 0xffff0000, v8
  v_lshrrev_b32 v8, 23, v7
  v_subrev_u32 v8, 134, v8
  v_max_i32 v8, 0, v8
  v_cvt_u32_f32 v7, v7
  v_lshrrev_b32 v7, v8, v7
  v_lshl_add_u32 v7, v8, 8, v7
  v_lshl_add_u32 v200, v7, 2, s18
  v_subrev_u32 v6, 1, v5
  v_max_i32 v7, 0, v6
  v_cvt_f32_u32 v7, v7
  v_cvt_pk_bf16_f32 v8, v7, v7
  v_and_b32 v7, 0xffff0000, v8
  v_lshrrev_b32 v8, 23, v7
  v_subrev_u32 v8, 134, v8
  v_max_i32 v8, 0, v8
  v_cvt_u32_f32 v7, v7
  v_lshrrev_b32 v7, v8, v7
  v_lshl_add_u32 v7, v8, 8, v7
  v_lshl_add_u32 v201, v7, 2, s18
  v_subrev_u32 v6, 2, v5
  v_max_i32 v7, 0, v6
  v_cvt_f32_u32 v7, v7
  v_cvt_pk_bf16_f32 v8, v7, v7
  v_and_b32 v7, 0xffff0000, v8
  v_lshrrev_b32 v8, 23, v7
  v_subrev_u32 v8, 134, v8
  v_max_i32 v8, 0, v8
  v_cvt_u32_f32 v7, v7
  v_lshrrev_b32 v7, v8, v7
  v_lshl_add_u32 v7, v8, 8, v7
  v_lshl_add_u32 v202, v7, 2, s18
  v_subrev_u32 v6, 3, v5
  v_max_i32 v7, 0, v6
  v_cvt_f32_u32 v7, v7
  v_cvt_pk_bf16_f32 v8, v7, v7
  v_and_b32 v7, 0xffff0000, v8
  v_lshrrev_b32 v8, 23, v7
  v_subrev_u32 v8, 134, v8
  v_max_i32 v8, 0, v8
  v_cvt_u32_f32 v7, v7
  v_lshrrev_b32 v7, v8, v7
  v_lshl_add_u32 v7, v8, 8, v7
  v_lshl_add_u32 v203, v7, 2, s18
  v_subrev_u32 v6, 4, v5
  v_max_i32 v7, 0, v6
  v_cvt_f32_u32 v7, v7
  v_cvt_pk_bf16_f32 v8, v7, v7
  v_and_b32 v7, 0xffff0000, v8
  v_lshrrev_b32 v8, 23, v7
  v_subrev_u32 v8, 134, v8
  v_max_i32 v8, 0, v8
  v_cvt_u32_f32 v7, v7
  v_lshrrev_b32 v7, v8, v7
  v_lshl_add_u32 v7, v8, 8, v7
  v_lshl_add_u32 v204, v7, 2, s18
  v_subrev_u32 v6, 5, v5
  v_max_i32 v7, 0, v6
  v_cvt_f32_u32 v7, v7
  v_cvt_pk_bf16_f32 v8, v7, v7
  v_and_b32 v7, 0xffff0000, v8
  v_lshrrev_b32 v8, 23, v7
  v_subrev_u32 v8, 134, v8
  v_max_i32 v8, 0, v8
  v_cvt_u32_f32 v7, v7
  v_lshrrev_b32 v7, v8, v7
  v_lshl_add_u32 v7, v8, 8, v7
  v_lshl_add_u32 v205, v7, 2, s18
  v_subrev_u32 v6, 6, v5
  v_max_i32 v7, 0, v6
  v_cvt_f32_u32 v7, v7
  v_cvt_pk_bf16_f32 v8, v7, v7
  v_and_b32 v7, 0xffff0000, v8
  v_lshrrev_b32 v8, 23, v7
  v_subrev_u32 v8, 134, v8
  v_max_i32 v8, 0, v8
  v_cvt_u32_f32 v7, v7
  v_lshrrev_b32 v7, v8, v7
  v_lshl_add_u32 v7, v8, 8, v7
  v_lshl_add_u32 v206, v7, 2, s18
  v_subrev_u32 v6, 7, v5
  v_max_i32 v7, 0, v6
  v_cvt_f32_u32 v7, v7
  v_cvt_pk_bf16_f32 v8, v7, v7
  v_and_b32 v7, 0xffff0000, v8
  v_lshrrev_b32 v8, 23, v7
  v_subrev_u32 v8, 134, v8
  v_max_i32 v8, 0, v8
  v_cvt_u32_f32 v7, v7
  v_lshrrev_b32 v7, v8, v7
  v_lshl_add_u32 v7, v8, 8, v7
  v_lshl_add_u32 v207, v7, 2, s18
  v_subrev_u32 v6, 8, v5
  v_max_i32 v7, 0, v6
  v_cvt_f32_u32 v7, v7
  v_cvt_pk_bf16_f32 v8, v7, v7
  v_and_b32 v7, 0xffff0000, v8
  v_lshrrev_b32 v8, 23, v7
  v_subrev_u32 v8, 134, v8
  v_max_i32 v8, 0, v8
  v_cvt_u32_f32 v7, v7
  v_lshrrev_b32 v7, v8, v7
  v_lshl_add_u32 v7, v8, 8, v7
  v_lshl_add_u32 v208, v7, 2, s18
  v_subrev_u32 v6, 9, v5
  v_max_i32 v7, 0, v6
  v_cvt_f32_u32 v7, v7
  v_cvt_pk_bf16_f32 v8, v7, v7
  v_and_b32 v7, 0xffff0000, v8
  v_lshrrev_b32 v8, 23, v7
  v_subrev_u32 v8, 134, v8
  v_max_i32 v8, 0, v8
  v_cvt_u32_f32 v7, v7
  v_lshrrev_b32 v7, v8, v7
  v_lshl_add_u32 v7, v8, 8, v7
  v_lshl_add_u32 v209, v7, 2, s18
  v_subrev_u32 v6, 10, v5
  v_max_i32 v7, 0, v6
  v_cvt_f32_u32 v7, v7
  v_cvt_pk_bf16_f32 v8, v7, v7
  v_and_b32 v7, 0xffff0000, v8
  v_lshrrev_b32 v8, 23, v7
  v_subrev_u32 v8, 134, v8
  v_max_i32 v8, 0, v8
  v_cvt_u32_f32 v7, v7
  v_lshrrev_b32 v7, v8, v7
  v_lshl_add_u32 v7, v8, 8, v7
  v_lshl_add_u32 v210, v7, 2, s18
  v_subrev_u32 v6, 11, v5
  v_max_i32 v7, 0, v6
  v_cvt_f32_u32 v7, v7
  v_cvt_pk_bf16_f32 v8, v7, v7
  v_and_b32 v7, 0xffff0000, v8
  v_lshrrev_b32 v8, 23, v7
  v_subrev_u32 v8, 134, v8
  v_max_i32 v8, 0, v8
  v_cvt_u32_f32 v7, v7
  v_lshrrev_b32 v7, v8, v7
  v_lshl_add_u32 v7, v8, 8, v7
  v_lshl_add_u32 v211, v7, 2, s18
  v_subrev_u32 v6, 12, v5
  v_max_i32 v7, 0, v6
  v_cvt_f32_u32 v7, v7
  v_cvt_pk_bf16_f32 v8, v7, v7
  v_and_b32 v7, 0xffff0000, v8
  v_lshrrev_b32 v8, 23, v7
  v_subrev_u32 v8, 134, v8
  v_max_i32 v8, 0, v8
  v_cvt_u32_f32 v7, v7
  v_lshrrev_b32 v7, v8, v7
  v_lshl_add_u32 v7, v8, 8, v7
  v_lshl_add_u32 v212, v7, 2, s18
  v_subrev_u32 v6, 13, v5
  v_max_i32 v7, 0, v6
  v_cvt_f32_u32 v7, v7
  v_cvt_pk_bf16_f32 v8, v7, v7
  v_and_b32 v7, 0xffff0000, v8
  v_lshrrev_b32 v8, 23, v7
  v_subrev_u32 v8, 134, v8
  v_max_i32 v8, 0, v8
  v_cvt_u32_f32 v7, v7
  v_lshrrev_b32 v7, v8, v7
  v_lshl_add_u32 v7, v8, 8, v7
  v_lshl_add_u32 v213, v7, 2, s18
  v_subrev_u32 v6, 14, v5
  v_max_i32 v7, 0, v6
  v_cvt_f32_u32 v7, v7
  v_cvt_pk_bf16_f32 v8, v7, v7
  v_and_b32 v7, 0xffff0000, v8
  v_lshrrev_b32 v8, 23, v7
  v_subrev_u32 v8, 134, v8
  v_max_i32 v8, 0, v8
  v_cvt_u32_f32 v7, v7
  v_lshrrev_b32 v7, v8, v7
  v_lshl_add_u32 v7, v8, 8, v7
  v_lshl_add_u32 v214, v7, 2, s18
  v_subrev_u32 v6, 15, v5
  v_max_i32 v7, 0, v6
  v_cvt_f32_u32 v7, v7
  v_cvt_pk_bf16_f32 v8, v7, v7
  v_and_b32 v7, 0xffff0000, v8
  v_lshrrev_b32 v8, 23, v7
  v_subrev_u32 v8, 134, v8
  v_max_i32 v8, 0, v8
  v_cvt_u32_f32 v7, v7
  v_lshrrev_b32 v7, v8, v7
  v_lshl_add_u32 v7, v8, 8, v7
  v_lshl_add_u32 v215, v7, 2, s18
  v_subrev_u32 v6, 16, v5
  v_max_i32 v7, 0, v6
  v_cvt_f32_u32 v7, v7
  v_cvt_pk_bf16_f32 v8, v7, v7
  v_and_b32 v7, 0xffff0000, v8
  v_lshrrev_b32 v8, 23, v7
  v_subrev_u32 v8, 134, v8
  v_max_i32 v8, 0, v8
  v_cvt_u32_f32 v7, v7
  v_lshrrev_b32 v7, v8, v7
  v_lshl_add_u32 v7, v8, 8, v7
  v_lshl_add_u32 v216, v7, 2, s18
  v_subrev_u32 v6, 17, v5
  v_max_i32 v7, 0, v6
  v_cvt_f32_u32 v7, v7
  v_cvt_pk_bf16_f32 v8, v7, v7
  v_and_b32 v7, 0xffff0000, v8
  v_lshrrev_b32 v8, 23, v7
  v_subrev_u32 v8, 134, v8
  v_max_i32 v8, 0, v8
  v_cvt_u32_f32 v7, v7
  v_lshrrev_b32 v7, v8, v7
  v_lshl_add_u32 v7, v8, 8, v7
  v_lshl_add_u32 v217, v7, 2, s18
  v_subrev_u32 v6, 18, v5
  v_max_i32 v7, 0, v6
  v_cvt_f32_u32 v7, v7
  v_cvt_pk_bf16_f32 v8, v7, v7
  v_and_b32 v7, 0xffff0000, v8
  v_lshrrev_b32 v8, 23, v7
  v_subrev_u32 v8, 134, v8
  v_max_i32 v8, 0, v8
  v_cvt_u32_f32 v7, v7
  v_lshrrev_b32 v7, v8, v7
  v_lshl_add_u32 v7, v8, 8, v7
  v_lshl_add_u32 v218, v7, 2, s18
  v_subrev_u32 v6, 19, v5
  v_max_i32 v7, 0, v6
  v_cvt_f32_u32 v7, v7
  v_cvt_pk_bf16_f32 v8, v7, v7
  v_and_b32 v7, 0xffff0000, v8
  v_lshrrev_b32 v8, 23, v7
  v_subrev_u32 v8, 134, v8
  v_max_i32 v8, 0, v8
  v_cvt_u32_f32 v7, v7
  v_lshrrev_b32 v7, v8, v7
  v_lshl_add_u32 v7, v8, 8, v7
  v_lshl_add_u32 v219, v7, 2, s18
  v_subrev_u32 v6, 20, v5
  v_max_i32 v7, 0, v6
  v_cvt_f32_u32 v7, v7
  v_cvt_pk_bf16_f32 v8, v7, v7
  v_and_b32 v7, 0xffff0000, v8
  v_lshrrev_b32 v8, 23, v7
  v_subrev_u32 v8, 134, v8
  v_max_i32 v8, 0, v8
  v_cvt_u32_f32 v7, v7
  v_lshrrev_b32 v7, v8, v7
  v_lshl_add_u32 v7, v8, 8, v7
  v_lshl_add_u32 v220, v7, 2, s18
  v_subrev_u32 v6, 21, v5
  v_max_i32 v7, 0, v6
  v_cvt_f32_u32 v7, v7
  v_cvt_pk_bf16_f32 v8, v7, v7
  v_and_b32 v7, 0xffff0000, v8
  v_lshrrev_b32 v8, 23, v7
  v_subrev_u32 v8, 134, v8
  v_max_i32 v8, 0, v8
  v_cvt_u32_f32 v7, v7
  v_lshrrev_b32 v7, v8, v7
  v_lshl_add_u32 v7, v8, 8, v7
  v_lshl_add_u32 v221, v7, 2, s18
  v_subrev_u32 v6, 22, v5
  v_max_i32 v7, 0, v6
  v_cvt_f32_u32 v7, v7
  v_cvt_pk_bf16_f32 v8, v7, v7
  v_and_b32 v7, 0xffff0000, v8
  v_lshrrev_b32 v8, 23, v7
  v_subrev_u32 v8, 134, v8
  v_max_i32 v8, 0, v8
  v_cvt_u32_f32 v7, v7
  v_lshrrev_b32 v7, v8, v7
  v_lshl_add_u32 v7, v8, 8, v7
  v_lshl_add_u32 v222, v7, 2, s18
  v_subrev_u32 v6, 23, v5
  v_max_i32 v7, 0, v6
  v_cvt_f32_u32 v7, v7
  v_cvt_pk_bf16_f32 v8, v7, v7
  v_and_b32 v7, 0xffff0000, v8
  v_lshrrev_b32 v8, 23, v7
  v_subrev_u32 v8, 134, v8
  v_max_i32 v8, 0, v8
  v_cvt_u32_f32 v7, v7
  v_lshrrev_b32 v7, v8, v7
  v_lshl_add_u32 v7, v8, 8, v7
  v_lshl_add_u32 v223, v7, 2, s18
  v_subrev_u32 v6, 24, v5
  v_max_i32 v7, 0, v6
  v_cvt_f32_u32 v7, v7
  v_cvt_pk_bf16_f32 v8, v7, v7
  v_and_b32 v7, 0xffff0000, v8
  v_lshrrev_b32 v8, 23, v7
  v_subrev_u32 v8, 134, v8
  v_max_i32 v8, 0, v8
  v_cvt_u32_f32 v7, v7
  v_lshrrev_b32 v7, v8, v7
  v_lshl_add_u32 v7, v8, 8, v7
  v_lshl_add_u32 v224, v7, 2, s18
  v_subrev_u32 v6, 25, v5
  v_max_i32 v7, 0, v6
  v_cvt_f32_u32 v7, v7
  v_cvt_pk_bf16_f32 v8, v7, v7
  v_and_b32 v7, 0xffff0000, v8
  v_lshrrev_b32 v8, 23, v7
  v_subrev_u32 v8, 134, v8
  v_max_i32 v8, 0, v8
  v_cvt_u32_f32 v7, v7
  v_lshrrev_b32 v7, v8, v7
  v_lshl_add_u32 v7, v8, 8, v7
  v_lshl_add_u32 v225, v7, 2, s18
  v_subrev_u32 v6, 26, v5
  v_max_i32 v7, 0, v6
  v_cvt_f32_u32 v7, v7
  v_cvt_pk_bf16_f32 v8, v7, v7
  v_and_b32 v7, 0xffff0000, v8
  v_lshrrev_b32 v8, 23, v7
  v_subrev_u32 v8, 134, v8
  v_max_i32 v8, 0, v8
  v_cvt_u32_f32 v7, v7
  v_lshrrev_b32 v7, v8, v7
  v_lshl_add_u32 v7, v8, 8, v7
  v_lshl_add_u32 v226, v7, 2, s18
  v_subrev_u32 v6, 27, v5
  v_max_i32 v7, 0, v6
  v_cvt_f32_u32 v7, v7
  v_cvt_pk_bf16_f32 v8, v7, v7
  v_and_b32 v7, 0xffff0000, v8
  v_lshrrev_b32 v8, 23, v7
  v_subrev_u32 v8, 134, v8
  v_max_i32 v8, 0, v8
  v_cvt_u32_f32 v7, v7
  v_lshrrev_b32 v7, v8, v7
  v_lshl_add_u32 v7, v8, 8, v7
  v_lshl_add_u32 v227, v7, 2, s18
  v_subrev_u32 v6, 28, v5
  v_max_i32 v7, 0, v6
  v_cvt_f32_u32 v7, v7
  v_cvt_pk_bf16_f32 v8, v7, v7
  v_and_b32 v7, 0xffff0000, v8
  v_lshrrev_b32 v8, 23, v7
  v_subrev_u32 v8, 134, v8
  v_max_i32 v8, 0, v8
  v_cvt_u32_f32 v7, v7
  v_lshrrev_b32 v7, v8, v7
  v_lshl_add_u32 v7, v8, 8, v7
  v_lshl_add_u32 v228, v7, 2, s18
  v_subrev_u32 v6, 29, v5
  v_max_i32 v7, 0, v6
  v_cvt_f32_u32 v7, v7
  v_cvt_pk_bf16_f32 v8, v7, v7
  v_and_b32 v7, 0xffff0000, v8
  v_lshrrev_b32 v8, 23, v7
  v_subrev_u32 v8, 134, v8
  v_max_i32 v8, 0, v8
  v_cvt_u32_f32 v7, v7
  v_lshrrev_b32 v7, v8, v7
  v_lshl_add_u32 v7, v8, 8, v7
  v_lshl_add_u32 v229, v7, 2, s18
  v_subrev_u32 v6, 30, v5
  v_max_i32 v7, 0, v6
  v_cvt_f32_u32 v7, v7
  v_cvt_pk_bf16_f32 v8, v7, v7
  v_and_b32 v7, 0xffff0000, v8
  v_lshrrev_b32 v8, 23, v7
  v_subrev_u32 v8, 134, v8
  v_max_i32 v8, 0, v8
  v_cvt_u32_f32 v7, v7
  v_lshrrev_b32 v7, v8, v7
  v_lshl_add_u32 v7, v8, 8, v7
  v_lshl_add_u32 v230, v7, 2, s18
  v_subrev_u32 v6, 31, v5
  v_max_i32 v7, 0, v6
  v_cvt_f32_u32 v7, v7
  v_cvt_pk_bf16_f32 v8, v7, v7
  v_and_b32 v7, 0xffff0000, v8
  v_lshrrev_b32 v8, 23, v7
  v_subrev_u32 v8, 134, v8
  v_max_i32 v8, 0, v8
  v_cvt_u32_f32 v7, v7
  v_lshrrev_b32 v7, v8, v7
  v_lshl_add_u32 v7, v8, 8, v7
  v_lshl_add_u32 v231, v7, 2, s18
  v_subrev_u32 v6, 32, v5
  v_max_i32 v7, 0, v6
  v_cvt_f32_u32 v7, v7
  v_cvt_pk_bf16_f32 v8, v7, v7
  v_and_b32 v7, 0xffff0000, v8
  v_lshrrev_b32 v8, 23, v7
  v_subrev_u32 v8, 134, v8
  v_max_i32 v8, 0, v8
  v_cvt_u32_f32 v7, v7
  v_lshrrev_b32 v7, v8, v7
  v_lshl_add_u32 v7, v8, 8, v7
  v_mov_b32 v8, 1280
  v_cmp_gt_i32 vcc, 0, v6
  s_nop 1
  v_cndmask_b32 v7, v7, v8, vcc
  v_lshl_add_u32 v232, v7, 2, s18
  v_mov_b32 v8, 0
  v_mov_b32 v9, 0
  v_lshlrev_b32 v5, 3, v1
  v_add_u32 v5, s17, v5
  ds_write_b64 v5, v[8:9]
  v_and_b32 v6, 15, v1
  v_lshlrev_b32 v6, 3, v6
  v_add_u32 v6, s17, v6
  ds_write_b64 v6, v[8:9] offset:8704
  ds_write_b64 v6, v[8:9] offset:12928
  v_mov_b32 v6, s17
  ds_write_b64 v6, v[8:9] offset:18176
  s_lshl_b32 s19, s3, 2
  s_add_u32 s20, s19, s16
  s_lshl_b32 s21, s3, 3
  v_mul_u32_u24 v5, 3584, v0
  s_add_u32 s22, s21, 0
  buffer_load_dwordx2 v[8:9], v5, s[60:63], s22 offen offset:0
  buffer_load_dwordx2 v[10:11], v5, s[60:63], s22 offen offset:896
  buffer_load_dwordx2 v[12:13], v5, s[60:63], s22 offen offset:1792
  buffer_load_dwordx2 v[14:15], v5, s[60:63], s22 offen offset:2688
  s_add_u32 s22, s21, 917504
  buffer_load_dwordx2 v[16:17], v5, s[60:63], s22 offen offset:0
  buffer_load_dwordx2 v[18:19], v5, s[60:63], s22 offen offset:896
  buffer_load_dwordx2 v[20:21], v5, s[60:63], s22 offen offset:1792
  buffer_load_dwordx2 v[22:23], v5, s[60:63], s22 offen offset:2688
  s_lshl_b32 s22, s20, 9
  v_lshlrev_b32 v6, 3, v1
  buffer_load_dwordx2 v[24:25], v6, s[64:67], s22 offen
  buffer_load_dwordx2 v[26:27], v6, s[68:71], s22 offen
  buffer_load_dwordx2 v[28:29], v6, s[72:75], s22 offen
  buffer_load_dwordx2 v[30:31], v6, s[76:79], s22 offen
  s_lshl_b32 s22, s20, 1
  v_mov_b32 v7, 0
  buffer_load_ushort v32, v7, s[80:83], s22 offen
  buffer_load_ushort v33, v7, s[84:87], s22 offen
  s_mov_b32 s24, 0x05040100
  s_mov_b32 s25, 0x07060302
  s_barrier
  s_waitcnt vmcnt(6)
  v_lshlrev_b32 v6, 3, v0
  v_perm_b32 v34, v10, v8, s24
  v_perm_b32 v35, v14, v12, s24
  v_add_u32 v36, 512, v6
  ds_write_b64 v36, v[34:35]
  v_perm_b32 v34, v10, v8, s25
  v_perm_b32 v35, v14, v12, s25
  v_add_u32 v36, 25088, v6
  ds_write_b64 v36, v[34:35]
  v_perm_b32 v34, v11, v9, s24
  v_perm_b32 v35, v15, v13, s24
  v_add_u32 v36, 49664, v6
  ds_write_b64 v36, v[34:35]
  v_perm_b32 v34, v11, v9, s25
  v_perm_b32 v35, v15, v13, s25
  v_add_u32 v36, 74240, v6
  ds_write_b64 v36, v[34:35]
  v_perm_b32 v34, v18, v16, s24
  v_perm_b32 v35, v22, v20, s24
  v_add_u32 v36, 2560, v6
  ds_write_b64 v36, v[34:35]
  v_perm_b32 v34, v18, v16, s25
  v_perm_b32 v35, v22, v20, s25
  v_add_u32 v36, 27136, v6
  ds_write_b64 v36, v[34:35]
  v_perm_b32 v34, v19, v17, s24
  v_perm_b32 v35, v23, v21, s24
  v_add_u32 v36, 51712, v6
  ds_write_b64 v36, v[34:35]
  v_perm_b32 v34, v19, v17, s25
  v_perm_b32 v35, v23, v21, s25
  v_add_u32 v36, 76288, v6
  ds_write_b64 v36, v[34:35]
  s_waitcnt vmcnt(0)
  s_mov_b32 s26, 1069066811
  s_mov_b32 s27, 1042479491
  v_lshlrev_b32 v32, 16, v32
  v_lshlrev_b32 v33, 16, v33
  v_mul_f32 v32, s26, v32
  v_exp_f32 v32, v32
  s_nop 0
  v_cvt_pk_bf16_f32 v34, v32, v32
  v_and_b32 v32, 0xffff0000, v34
  v_lshlrev_b32 v37, 6, v1
  v_add_u32 v37, s17, v37
  v_lshlrev_b32 v40, 16, v24
  v_lshlrev_b32 v41, 16, v26
  v_lshlrev_b32 v42, 16, v28
  v_lshlrev_b32 v43, 16, v30
  v_mul_f32 v40, s26, v40
  v_exp_f32 v40, v40
  s_nop 0
  v_cvt_pk_bf16_f32 v34, v40, v40
  v_and_b32 v40, 0xffff0000, v34
  v_mul_f32 v40, v40, v32
  v_mul_f32 v40, s26, v40
  v_sub_f32 v40, 0, v40
  v_mul_f32 v41, v41, v32
  v_mul_f32 v41, s27, v41
  v_mul_f32 v42, v42, v32
  v_mul_f32 v43, v43, v32
  v_add_f32 v42, v42, v42
  v_add_f32 v43, v43, v43
  ds_write_b128 v37, v[40:43] offset:18240
  v_and_b32 v40, 0xffff0000, v24
  v_and_b32 v41, 0xffff0000, v26
  v_and_b32 v42, 0xffff0000, v28
  v_and_b32 v43, 0xffff0000, v30
  v_mul_f32 v40, s26, v40
  v_exp_f32 v40, v40
  s_nop 0
  v_cvt_pk_bf16_f32 v34, v40, v40
  v_and_b32 v40, 0xffff0000, v34
  v_mul_f32 v40, v40, v32
  v_mul_f32 v40, s26, v40
  v_sub_f32 v40, 0, v40
  v_mul_f32 v41, v41, v32
  v_mul_f32 v41, s27, v41
  v_mul_f32 v42, v42, v32
  v_mul_f32 v43, v43, v32
  v_add_f32 v42, v42, v42
  v_add_f32 v43, v43, v43
  ds_write_b128 v37, v[40:43] offset:18256
  v_lshlrev_b32 v40, 16, v25
  v_lshlrev_b32 v41, 16, v27
  v_lshlrev_b32 v42, 16, v29
  v_lshlrev_b32 v43, 16, v31
  v_mul_f32 v40, s26, v40
  v_exp_f32 v40, v40
  s_nop 0
  v_cvt_pk_bf16_f32 v34, v40, v40
  v_and_b32 v40, 0xffff0000, v34
  v_mul_f32 v40, v40, v32
  v_mul_f32 v40, s26, v40
  v_sub_f32 v40, 0, v40
  v_mul_f32 v41, v41, v32
  v_mul_f32 v41, s27, v41
  v_mul_f32 v42, v42, v32
  v_mul_f32 v43, v43, v32
  v_add_f32 v42, v42, v42
  v_add_f32 v43, v43, v43
  ds_write_b128 v37, v[40:43] offset:18272
  v_and_b32 v40, 0xffff0000, v25
  v_and_b32 v41, 0xffff0000, v27
  v_and_b32 v42, 0xffff0000, v29
  v_and_b32 v43, 0xffff0000, v31
  v_mul_f32 v40, s26, v40
  v_exp_f32 v40, v40
  s_nop 0
  v_cvt_pk_bf16_f32 v34, v40, v40
  v_and_b32 v40, 0xffff0000, v34
  v_mul_f32 v40, v40, v32
  v_mul_f32 v40, s26, v40
  v_sub_f32 v40, 0, v40
  v_mul_f32 v41, v41, v32
  v_mul_f32 v41, s27, v41
  v_mul_f32 v42, v42, v32
  v_mul_f32 v43, v43, v32
  v_add_f32 v42, v42, v42
  v_add_f32 v43, v43, v43
  ds_write_b128 v37, v[40:43] offset:18288
  v_cvt_f32_u32 v44, v4
  v_lshlrev_b32 v45, 4, v4
  v_cvt_f32_u32 v45, v45
  v_lshlrev_b32 v46, 4, v3
  v_add_u32 v46, s17, v46
  v_mov_b32 v48, 0
  v_mov_b32 v49, 0
  v_mov_b32 v50, 0
  v_mov_b32 v51, 0
  v_mov_b32 v52, 0
  v_mov_b32 v53, 0
  v_mov_b32 v54, 0
  v_mov_b32 v55, 0
  v_mov_b32 v56, 0
  v_mov_b32 v57, 0
  v_mov_b32 v58, 0
  v_mov_b32 v59, 0
  v_mov_b32 v60, 0
  v_mov_b32 v61, 0
  v_mov_b32 v62, 0
  v_mov_b32 v63, 0
  v_mov_b32 v64, 0
  v_mov_b32 v65, 0
  v_mov_b32 v66, 0
  v_mov_b32 v67, 0
  s_mov_b32 s28, 0
  s_waitcnt lgkmcnt(0)
  ds_read_b128 v[68:71], v46 offset:18240
wk_kl:
  s_waitcnt lgkmcnt(0)
  v_mov_b32 v72, v68
  v_mov_b32 v73, v69
  v_mov_b32 v74, v70
  v_mov_b32 v75, v71
  v_add_u32 v46, 64, v46
  ds_read_b128 v[68:71], v46 offset:18240
  v_mul_f32 v80, v72, v45
  v_mul_f32 v81, v73, v45
  v_exp_f32 v80, v80
  v_fract_f32 v81, v81
  v_cos_f32 v76, v81
  v_sin_f32 v77, v81
  v_mul_f32 v76, v76, v80
  v_mul_f32 v77, v77, v80
  v_mul_f32 v80, v72, v44
  v_mul_f32 v81, v73, v44
  v_exp_f32 v80, v80
  v_fract_f32 v81, v81
  v_cos_f32 v78, v81
  v_sin_f32 v79, v81
  v_mul_f32 v78, v78, v80
  v_mul_f32 v79, v79, v80
  v_mul_f32 v82, v74, v76
  v_mul_f32 v83, v74, v77
  v_fma_f32 v82, -v75, v77, v82
  v_fma_f32 v83, -v75, v76, -v83
  v_mul_f32 v86, v76, v76
  v_mul_f32 v87, v76, v77
  v_fma_f32 v86, -v77, v77, v86
  v_add_f32 v87, v87, v87
  v_mfma_f32_16x16x4_f32 v[48:51], v82, v78, v[48:51]
  v_mul_f32 v88, v78, v78
  v_mul_f32 v89, v78, v79
  v_fma_f32 v88, -v79, v79, v88
  v_add_f32 v89, v89, v89
  v_mfma_f32_16x16x4_f32 v[48:51], v83, v79, v[48:51]
  v_mul_f32 v84, v74, v86
  v_mul_f32 v85, v74, v87
  v_fma_f32 v84, -v75, v87, v84
  v_fma_f32 v85, -v75, v86, -v85
  v_mul_f32 v76, v86, v86
  v_mul_f32 v77, v86, v87
  v_fma_f32 v76, -v87, v87, v76
  v_add_f32 v77, v77, v77
  v_mfma_f32_16x16x4_f32 v[52:55], v84, v88, v[52:55]
  v_mul_f32 v78, v88, v88
  v_mul_f32 v79, v88, v89
  v_fma_f32 v78, -v89, v89, v78
  v_add_f32 v79, v79, v79
  v_mfma_f32_16x16x4_f32 v[52:55], v85, v89, v[52:55]
  v_mul_f32 v82, v74, v76
  v_mul_f32 v83, v74, v77
  v_fma_f32 v82, -v75, v77, v82
  v_fma_f32 v83, -v75, v76, -v83
  v_mul_f32 v86, v76, v76
  v_mul_f32 v87, v76, v77
  v_fma_f32 v86, -v77, v77, v86
  v_add_f32 v87, v87, v87
  v_mfma_f32_16x16x4_f32 v[56:59], v82, v78, v[56:59]
  v_mul_f32 v88, v78, v78
  v_mul_f32 v89, v78, v79
  v_fma_f32 v88, -v79, v79, v88
  v_add_f32 v89, v89, v89
  v_mfma_f32_16x16x4_f32 v[56:59], v83, v79, v[56:59]
  v_mul_f32 v84, v74, v86
  v_mul_f32 v85, v74, v87
  v_fma_f32 v84, -v75, v87, v84
  v_fma_f32 v85, -v75, v86, -v85
  v_mul_f32 v76, v86, v86
  v_mul_f32 v77, v86, v87
  v_fma_f32 v76, -v87, v87, v76
  v_add_f32 v77, v77, v77
  v_mfma_f32_16x16x4_f32 v[60:63], v84, v88, v[60:63]
  v_mfma_f32_16x16x4_f32 v[60:63], v85, v89, v[60:63]
  v_mul_f32 v82, v74, v76
  v_fma_f32 v82, -v75, v77, v82
  s_nop 1
  v_mfma_f32_16x16x4_f32 v[64:67], v82, v88, v[64:67]
  s_add_u32 s28, s28, 1
  s_cmp_lt_u32 s28, 64
  s_cbranch_scc1 wk_kl
  s_nop 15
  s_nop 3
  v_lshlrev_b32 v46, 8, v3
  v_lshl_add_u32 v46, v4, 2, v46
  v_add_u32 v46, s17, v46
  ds_write_b32 v46, v48 offset:13056
  ds_write_b32 v46, v49 offset:13120
  ds_write_b32 v46, v50 offset:13184
  ds_write_b32 v46, v51 offset:13248
  s_waitcnt lgkmcnt(8)
  ds_write_b32 v46, v52 offset:14080
  ds_write_b32 v46, v53 offset:14144
  ds_write_b32 v46, v54 offset:14208
  ds_write_b32 v46, v55 offset:14272
  s_waitcnt lgkmcnt(8)
  ds_write_b32 v46, v56 offset:15104
  ds_write_b32 v46, v57 offset:15168
  ds_write_b32 v46, v58 offset:15232
  ds_write_b32 v46, v59 offset:15296
  s_waitcnt lgkmcnt(8)
  ds_write_b32 v46, v60 offset:16128
  ds_write_b32 v46, v61 offset:16192
  ds_write_b32 v46, v62 offset:16256
  ds_write_b32 v46, v63 offset:16320
  s_waitcnt lgkmcnt(8)
  ds_write_b32 v46, v64 offset:17152
  ds_write_b32 v46, v65 offset:17216
  ds_write_b32 v46, v66 offset:17280
  ds_write_b32 v46, v67 offset:17344
  s_waitcnt lgkmcnt(8)
  s_waitcnt lgkmcnt(0)
  ds_read_b32 v48, v200
  ds_read_b32 v49, v201
  ds_read_b32 v50, v202
  ds_read_b32 v51, v203
  ds_read_b32 v52, v204
  ds_read_b32 v53, v205
  ds_read_b32 v54, v206
  ds_read_b32 v55, v207
  s_waitcnt lgkmcnt(4)
  ds_read_b32 v56, v208
  ds_read_b32 v57, v209
  ds_read_b32 v58, v210
  ds_read_b32 v59, v211
  ds_read_b32 v60, v212
  ds_read_b32 v61, v213
  ds_read_b32 v62, v214
  ds_read_b32 v63, v215
  s_waitcnt lgkmcnt(4)
  ds_read_b32 v64, v216
  ds_read_b32 v65, v217
  ds_read_b32 v66, v218
  ds_read_b32 v67, v219
  ds_read_b32 v68, v220
  ds_read_b32 v69, v221
  ds_read_b32 v70, v222
  ds_read_b32 v71, v223
  s_waitcnt lgkmcnt(4)
  ds_read_b32 v72, v224
  ds_read_b32 v73, v225
  ds_read_b32 v74, v226
  ds_read_b32 v75, v227
  ds_read_b32 v76, v228
  ds_read_b32 v77, v229
  ds_read_b32 v78, v230
  ds_read_b32 v79, v231
  s_waitcnt lgkmcnt(4)
  ds_read_b32 v80, v232
  s_waitcnt lgkmcnt(0)
  v_lshlrev_b32 v46, 6, v1
  v_add_u32 v46, s17, v46
  v_cvt_pk_bf16_f32 v84, v48, v49
  v_cvt_pk_bf16_f32 v88, v49, v50
  v_cvt_pk_bf16_f32 v85, v50, v51
  v_cvt_pk_bf16_f32 v89, v51, v52
  v_cvt_pk_bf16_f32 v86, v52, v53
  v_cvt_pk_bf16_f32 v90, v53, v54
  v_cvt_pk_bf16_f32 v87, v54, v55
  v_cvt_pk_bf16_f32 v91, v55, v56
  ds_write_b128 v46, v[84:87] offset:4608
  ds_write_b128 v46, v[88:91] offset:8832
  s_waitcnt lgkmcnt(0)
  v_cvt_pk_bf16_f32 v84, v56, v57
  v_cvt_pk_bf16_f32 v88, v57, v58
  v_cvt_pk_bf16_f32 v85, v58, v59
  v_cvt_pk_bf16_f32 v89, v59, v60
  v_cvt_pk_bf16_f32 v86, v60, v61
  v_cvt_pk_bf16_f32 v90, v61, v62
  v_cvt_pk_bf16_f32 v87, v62, v63
  v_cvt_pk_bf16_f32 v91, v63, v64
  ds_write_b128 v46, v[84:87] offset:4624
  ds_write_b128 v46, v[88:91] offset:8848
  s_waitcnt lgkmcnt(0)
  v_cvt_pk_bf16_f32 v84, v64, v65
  v_cvt_pk_bf16_f32 v88, v65, v66
  v_cvt_pk_bf16_f32 v85, v66, v67
  v_cvt_pk_bf16_f32 v89, v67, v68
  v_cvt_pk_bf16_f32 v86, v68, v69
  v_cvt_pk_bf16_f32 v90, v69, v70
  v_cvt_pk_bf16_f32 v87, v70, v71
  v_cvt_pk_bf16_f32 v91, v71, v72
  ds_write_b128 v46, v[84:87] offset:4640
  ds_write_b128 v46, v[88:91] offset:8864
  s_waitcnt lgkmcnt(0)
  v_cvt_pk_bf16_f32 v84, v72, v73
  v_cvt_pk_bf16_f32 v88, v73, v74
  v_cvt_pk_bf16_f32 v85, v74, v75
  v_cvt_pk_bf16_f32 v89, v75, v76
  v_cvt_pk_bf16_f32 v86, v76, v77
  v_cvt_pk_bf16_f32 v90, v77, v78
  v_cvt_pk_bf16_f32 v87, v78, v79
  v_cvt_pk_bf16_f32 v91, v79, v80
  ds_write_b128 v46, v[84:87] offset:4656
  ds_write_b128 v46, v[88:91] offset:8880
  s_waitcnt lgkmcnt(0)
  s_barrier
  v_lshrrev_b32 v47, 1, v3
  v_sub_u32 v46, v4, v47
  v_add_u32 v46, 1, v46
  v_lshlrev_b32 v46, 5, v46
  v_and_b32 v48, 1, v3
  v_lshl_add_u32 v46, v48, 4, v46
  v_add_u32 v46, s17, v46
  ds_read_b128 a[0:3], v46 offset:32
  ds_read_b128 a[4:7], v46 offset:96
  ds_read_b128 a[8:11], v46 offset:160
  ds_read_b128 a[12:15], v46 offset:224
  ds_read_b128 a[16:19], v46 offset:288
  ds_read_b128 a[20:23], v46 offset:352
  ds_read_b128 a[24:27], v46 offset:416
  ds_read_b128 a[28:31], v46 offset:480
  s_waitcnt lgkmcnt(4)
  ds_read_b128 a[32:35], v46 offset:544
  ds_read_b128 a[36:39], v46 offset:608
  ds_read_b128 a[40:43], v46 offset:672
  ds_read_b128 a[44:47], v46 offset:736
  ds_read_b128 a[48:51], v46 offset:800
  ds_read_b128 a[52:55], v46 offset:864
  ds_read_b128 a[56:59], v46 offset:928
  ds_read_b128 a[60:63], v46 offset:992
  s_waitcnt lgkmcnt(4)
  ds_read_b128 a[64:67], v46 offset:1056
  ds_read_b128 a[68:71], v46 offset:1120
  ds_read_b128 a[72:75], v46 offset:1184
  ds_read_b128 a[76:79], v46 offset:1248
  ds_read_b128 a[80:83], v46 offset:1312
  ds_read_b128 a[84:87], v46 offset:1376
  ds_read_b128 a[88:91], v46 offset:1440
  ds_read_b128 a[92:95], v46 offset:1504
  s_waitcnt lgkmcnt(4)
  ds_read_b128 a[96:99], v46 offset:1568
  ds_read_b128 a[100:103], v46 offset:1632
  ds_read_b128 a[104:107], v46 offset:1696
  ds_read_b128 a[108:111], v46 offset:1760
  ds_read_b128 a[112:115], v46 offset:1824
  ds_read_b128 a[116:119], v46 offset:1888
  ds_read_b128 a[120:123], v46 offset:1952
  ds_read_b128 a[124:127], v46 offset:2016
  s_waitcnt lgkmcnt(4)
  ds_read_b128 a[128:131], v46 offset:2080
  ds_read_b128 a[132:135], v46 offset:2144
  ds_read_b128 a[136:139], v46 offset:2208
  ds_read_b128 a[140:143], v46 offset:2272
  ds_read_b128 a[144:147], v46 offset:2336
  ds_read_b128 a[148:151], v46 offset:2400
  ds_read_b128 a[152:155], v46 offset:2464
  ds_read_b128 a[156:159], v46 offset:2528
  s_waitcnt lgkmcnt(4)
  ds_read_b128 a[160:163], v46 offset:2592
  ds_read_b128 a[164:167], v46 offset:2656
  ds_read_b128 a[168:171], v46 offset:2720
  ds_read_b128 a[172:175], v46 offset:2784
  ds_read_b128 a[176:179], v46 offset:2848
  ds_read_b128 a[180:183], v46 offset:2912
  ds_read_b128 a[184:187], v46 offset:2976
  ds_read_b128 a[188:191], v46 offset:3040
  s_waitcnt lgkmcnt(4)
  ds_read_b128 a[192:195], v46 offset:3104
  ds_read_b128 a[196:199], v46 offset:3168
  ds_read_b128 a[200:203], v46 offset:3232
  ds_read_b128 a[204:207], v46 offset:3296
  ds_read_b128 a[208:211], v46 offset:3360
  ds_read_b128 a[212:215], v46 offset:3424
  ds_read_b128 a[216:219], v46 offset:3488
  ds_read_b128 a[220:223], v46 offset:3552
  s_waitcnt lgkmcnt(4)
  ds_read_b128 a[224:227], v46 offset:3616
  ds_read_b128 a[228:231], v46 offset:3680
  ds_read_b128 a[232:235], v46 offset:3744
  ds_read_b128 a[236:239], v46 offset:3808
  ds_read_b128 a[240:243], v46 offset:3872
  ds_read_b128 a[244:247], v46 offset:3936
  ds_read_b128 a[248:251], v46 offset:4000
  ds_read_b128 a[252:255], v46 offset:4064
  s_waitcnt lgkmcnt(4)
  v_lshlrev_b32 v49, 4, v47
  v_add_u32 v49, v49, v4
  v_sub_u32 v49, 2047, v49
  v_lshl_add_u32 v49, v48, 3, v49
  v_and_b32 v50, 1, v49
  v_lshrrev_b32 v49, 1, v49
  v_lshlrev_b32 v49, 2, v49
  v_mul_u32_u24 v50, 4224, v50
  v_add3_u32 v49, v49, v50, s17
  v_add_u32 v49, 4608, v49
  v_subrev_u32 v52, 896, v49
  v_subrev_u32 v53, 1856, v49
  v_subrev_u32 v54, 2816, v49
  v_subrev_u32 v55, 3776, v49
  v_subrev_u32 v56, 4736, v49
  s_waitcnt lgkmcnt(0)
  ds_read2_b32 v[92:93], v52 offset0:224 offset1:225
  ds_read2_b32 v[94:95], v52 offset0:226 offset1:227
  ds_read2_b32 v[96:97], v52 offset0:208 offset1:209
  ds_read2_b32 v[98:99], v52 offset0:210 offset1:211
  ds_read2_b32 v[100:101], v52 offset0:192 offset1:193
  ds_read2_b32 v[102:103], v52 offset0:194 offset1:195
  ds_read2_b32 v[104:105], v52 offset0:176 offset1:177
  ds_read2_b32 v[106:107], v52 offset0:178 offset1:179
  s_waitcnt lgkmcnt(6)
  v_mfma_f32_16x16x32_bf16 v[60:63], v[92:95], a[28:31], 0
  v_mfma_f32_16x16x32_bf16 v[64:67], v[92:95], a[60:63], 0
  v_mfma_f32_16x16x32_bf16 v[68:71], v[92:95], a[92:95], 0
  v_mfma_f32_16x16x32_bf16 v[72:75], v[92:95], a[124:127], 0
  v_mfma_f32_16x16x32_bf16 v[76:79], v[92:95], a[156:159], 0
  v_mfma_f32_16x16x32_bf16 v[80:83], v[92:95], a[188:191], 0
  v_mfma_f32_16x16x32_bf16 v[84:87], v[92:95], a[220:223], 0
  v_mfma_f32_16x16x32_bf16 v[88:91], v[92:95], a[252:255], 0
  ds_read2_b32 v[92:93], v52 offset0:160 offset1:161
  ds_read2_b32 v[94:95], v52 offset0:162 offset1:163
  s_waitcnt lgkmcnt(6)
  v_mfma_f32_16x16x32_bf16 v[60:63], v[96:99], a[24:27], v[60:63]
  v_mfma_f32_16x16x32_bf16 v[64:67], v[96:99], a[56:59], v[64:67]
  v_mfma_f32_16x16x32_bf16 v[68:71], v[96:99], a[88:91], v[68:71]
  v_mfma_f32_16x16x32_bf16 v[72:75], v[96:99], a[120:123], v[72:75]
  v_mfma_f32_16x16x32_bf16 v[76:79], v[96:99], a[152:155], v[76:79]
  v_mfma_f32_16x16x32_bf16 v[80:83], v[96:99], a[184:187], v[80:83]
  v_mfma_f32_16x16x32_bf16 v[84:87], v[96:99], a[216:219], v[84:87]
  v_mfma_f32_16x16x32_bf16 v[88:91], v[96:99], a[248:251], v[88:91]
  ds_read2_b32 v[96:97], v52 offset0:144 offset1:145
  ds_read2_b32 v[98:99], v52 offset0:146 offset1:147
  s_waitcnt lgkmcnt(6)
  v_mfma_f32_16x16x32_bf16 v[60:63], v[100:103], a[20:23], v[60:63]
  v_mfma_f32_16x16x32_bf16 v[64:67], v[100:103], a[52:55], v[64:67]
  v_mfma_f32_16x16x32_bf16 v[68:71], v[100:103], a[84:87], v[68:71]
  v_mfma_f32_16x16x32_bf16 v[72:75], v[100:103], a[116:119], v[72:75]
  v_mfma_f32_16x16x32_bf16 v[76:79], v[100:103], a[148:151], v[76:79]
  v_mfma_f32_16x16x32_bf16 v[80:83], v[100:103], a[180:183], v[80:83]
  v_mfma_f32_16x16x32_bf16 v[84:87], v[100:103], a[212:215], v[84:87]
  v_mfma_f32_16x16x32_bf16 v[88:91], v[100:103], a[244:247], v[88:91]
  ds_read2_b32 v[100:101], v52 offset0:128 offset1:129
  ds_read2_b32 v[102:103], v52 offset0:130 offset1:131
  s_waitcnt lgkmcnt(6)
  v_mfma_f32_16x16x32_bf16 v[60:63], v[104:107], a[16:19], v[60:63]
  v_mfma_f32_16x16x32_bf16 v[64:67], v[104:107], a[48:51], v[64:67]
  v_mfma_f32_16x16x32_bf16 v[68:71], v[104:107], a[80:83], v[68:71]
  v_mfma_f32_16x16x32_bf16 v[72:75], v[104:107], a[112:115], v[72:75]
  v_mfma_f32_16x16x32_bf16 v[76:79], v[104:107], a[144:147], v[76:79]
  v_mfma_f32_16x16x32_bf16 v[80:83], v[104:107], a[176:179], v[80:83]
  v_mfma_f32_16x16x32_bf16 v[84:87], v[104:107], a[208:211], v[84:87]
  v_mfma_f32_16x16x32_bf16 v[88:91], v[104:107], a[240:243], v[88:91]
  ds_read2_b32 v[104:105], v52 offset0:112 offset1:113
  ds_read2_b32 v[106:107], v52 offset0:114 offset1:115
  s_waitcnt lgkmcnt(6)
  v_mfma_f32_16x16x32_bf16 v[60:63], v[92:95], a[12:15], v[60:63]
  v_mfma_f32_16x16x32_bf16 v[64:67], v[92:95], a[44:47], v[64:67]
  v_mfma_f32_16x16x32_bf16 v[68:71], v[92:95], a[76:79], v[68:71]
  v_mfma_f32_16x16x32_bf16 v[72:75], v[92:95], a[108:111], v[72:75]
  v_mfma_f32_16x16x32_bf16 v[76:79], v[92:95], a[140:143], v[76:79]
  v_mfma_f32_16x16x32_bf16 v[80:83], v[92:95], a[172:175], v[80:83]
  v_mfma_f32_16x16x32_bf16 v[84:87], v[92:95], a[204:207], v[84:87]
  v_mfma_f32_16x16x32_bf16 v[88:91], v[92:95], a[236:239], v[88:91]
  ds_read2_b32 v[92:93], v52 offset0:96 offset1:97
  ds_read2_b32 v[94:95], v52 offset0:98 offset1:99
  s_waitcnt lgkmcnt(6)
  v_mfma_f32_16x16x32_bf16 v[60:63], v[96:99], a[8:11], v[60:63]
  v_mfma_f32_16x16x32_bf16 v[64:67], v[96:99], a[40:43], v[64:67]
  v_mfma_f32_16x16x32_bf16 v[68:71], v[96:99], a[72:75], v[68:71]
  v_mfma_f32_16x16x32_bf16 v[72:75], v[96:99], a[104:107], v[72:75]
  v_mfma_f32_16x16x32_bf16 v[76:79], v[96:99], a[136:139], v[76:79]
  v_mfma_f32_16x16x32_bf16 v[80:83], v[96:99], a[168:171], v[80:83]
  v_mfma_f32_16x16x32_bf16 v[84:87], v[96:99], a[200:203], v[84:87]
  v_mfma_f32_16x16x32_bf16 v[88:91], v[96:99], a[232:235], v[88:91]
  ds_read2_b32 v[96:97], v52 offset0:80 offset1:81
  ds_read2_b32 v[98:99], v52 offset0:82 offset1:83
  s_waitcnt lgkmcnt(6)
  v_mfma_f32_16x16x32_bf16 v[60:63], v[100:103], a[4:7], v[60:63]
  v_mfma_f32_16x16x32_bf16 v[64:67], v[100:103], a[36:39], v[64:67]
  v_mfma_f32_16x16x32_bf16 v[68:71], v[100:103], a[68:71], v[68:71]
  v_mfma_f32_16x16x32_bf16 v[72:75], v[100:103], a[100:103], v[72:75]
  v_mfma_f32_16x16x32_bf16 v[76:79], v[100:103], a[132:135], v[76:79]
  v_mfma_f32_16x16x32_bf16 v[80:83], v[100:103], a[164:167], v[80:83]
  v_mfma_f32_16x16x32_bf16 v[84:87], v[100:103], a[196:199], v[84:87]
  v_mfma_f32_16x16x32_bf16 v[88:91], v[100:103], a[228:231], v[88:91]
  ds_read2_b32 v[100:101], v52 offset0:64 offset1:65
  ds_read2_b32 v[102:103], v52 offset0:66 offset1:67
  s_waitcnt lgkmcnt(6)
  v_mfma_f32_16x16x32_bf16 v[60:63], v[104:107], a[0:3], v[60:63]
  v_mfma_f32_16x16x32_bf16 v[64:67], v[104:107], a[32:35], v[64:67]
  v_mfma_f32_16x16x32_bf16 v[68:71], v[104:107], a[64:67], v[68:71]
  v_mfma_f32_16x16x32_bf16 v[72:75], v[104:107], a[96:99], v[72:75]
  v_mfma_f32_16x16x32_bf16 v[76:79], v[104:107], a[128:131], v[76:79]
  v_mfma_f32_16x16x32_bf16 v[80:83], v[104:107], a[160:163], v[80:83]
  v_mfma_f32_16x16x32_bf16 v[84:87], v[104:107], a[192:195], v[84:87]
  v_mfma_f32_16x16x32_bf16 v[88:91], v[104:107], a[224:227], v[88:91]
  ds_read2_b32 v[104:105], v52 offset0:48 offset1:49
  ds_read2_b32 v[106:107], v52 offset0:50 offset1:51
  s_waitcnt lgkmcnt(6)
  v_mfma_f32_16x16x32_bf16 v[64:67], v[92:95], a[28:31], v[64:67]
  v_mfma_f32_16x16x32_bf16 v[68:71], v[92:95], a[60:63], v[68:71]
  v_mfma_f32_16x16x32_bf16 v[72:75], v[92:95], a[92:95], v[72:75]
  v_mfma_f32_16x16x32_bf16 v[76:79], v[92:95], a[124:127], v[76:79]
  v_mfma_f32_16x16x32_bf16 v[80:83], v[92:95], a[156:159], v[80:83]
  v_mfma_f32_16x16x32_bf16 v[84:87], v[92:95], a[188:191], v[84:87]
  v_mfma_f32_16x16x32_bf16 v[88:91], v[92:95], a[220:223], v[88:91]
  ds_read2_b32 v[92:93], v52 offset0:32 offset1:33
  ds_read2_b32 v[94:95], v52 offset0:34 offset1:35
  s_waitcnt lgkmcnt(6)
  v_mfma_f32_16x16x32_bf16 v[64:67], v[96:99], a[24:27], v[64:67]
  v_mfma_f32_16x16x32_bf16 v[68:71], v[96:99], a[56:59], v[68:71]
  v_mfma_f32_16x16x32_bf16 v[72:75], v[96:99], a[88:91], v[72:75]
  v_mfma_f32_16x16x32_bf16 v[76:79], v[96:99], a[120:123], v[76:79]
  v_mfma_f32_16x16x32_bf16 v[80:83], v[96:99], a[152:155], v[80:83]
  v_mfma_f32_16x16x32_bf16 v[84:87], v[96:99], a[184:187], v[84:87]
  v_mfma_f32_16x16x32_bf16 v[88:91], v[96:99], a[216:219], v[88:91]
  ds_read2_b32 v[96:97], v52 offset0:16 offset1:17
  ds_read2_b32 v[98:99], v52 offset0:18 offset1:19
  s_waitcnt lgkmcnt(6)
  v_mfma_f32_16x16x32_bf16 v[64:67], v[100:103], a[20:23], v[64:67]
  v_mfma_f32_16x16x32_bf16 v[68:71], v[100:103], a[52:55], v[68:71]
  v_mfma_f32_16x16x32_bf16 v[72:75], v[100:103], a[84:87], v[72:75]
  v_mfma_f32_16x16x32_bf16 v[76:79], v[100:103], a[116:119], v[76:79]
  v_mfma_f32_16x16x32_bf16 v[80:83], v[100:103], a[148:151], v[80:83]
  v_mfma_f32_16x16x32_bf16 v[84:87], v[100:103], a[180:183], v[84:87]
  v_mfma_f32_16x16x32_bf16 v[88:91], v[100:103], a[212:215], v[88:91]
  ds_read2_b32 v[100:101], v52 offset0:0 offset1:1
  ds_read2_b32 v[102:103], v52 offset0:2 offset1:3
  s_waitcnt lgkmcnt(6)
  v_mfma_f32_16x16x32_bf16 v[64:67], v[104:107], a[16:19], v[64:67]
  v_mfma_f32_16x16x32_bf16 v[68:71], v[104:107], a[48:51], v[68:71]
  v_mfma_f32_16x16x32_bf16 v[72:75], v[104:107], a[80:83], v[72:75]
  v_mfma_f32_16x16x32_bf16 v[76:79], v[104:107], a[112:115], v[76:79]
  v_mfma_f32_16x16x32_bf16 v[80:83], v[104:107], a[144:147], v[80:83]
  v_mfma_f32_16x16x32_bf16 v[84:87], v[104:107], a[176:179], v[84:87]
  v_mfma_f32_16x16x32_bf16 v[88:91], v[104:107], a[208:211], v[88:91]
  ds_read2_b32 v[104:105], v53 offset0:224 offset1:225
  ds_read2_b32 v[106:107], v53 offset0:226 offset1:227
  s_waitcnt lgkmcnt(6)
  v_mfma_f32_16x16x32_bf16 v[64:67], v[92:95], a[12:15], v[64:67]
  v_mfma_f32_16x16x32_bf16 v[68:71], v[92:95], a[44:47], v[68:71]
  v_mfma_f32_16x16x32_bf16 v[72:75], v[92:95], a[76:79], v[72:75]
  v_mfma_f32_16x16x32_bf16 v[76:79], v[92:95], a[108:111], v[76:79]
  v_mfma_f32_16x16x32_bf16 v[80:83], v[92:95], a[140:143], v[80:83]
  v_mfma_f32_16x16x32_bf16 v[84:87], v[92:95], a[172:175], v[84:87]
  v_mfma_f32_16x16x32_bf16 v[88:91], v[92:95], a[204:207], v[88:91]
  ds_read2_b32 v[92:93], v53 offset0:208 offset1:209
  ds_read2_b32 v[94:95], v53 offset0:210 offset1:211
  s_waitcnt lgkmcnt(6)
  v_mfma_f32_16x16x32_bf16 v[64:67], v[96:99], a[8:11], v[64:67]
  v_mfma_f32_16x16x32_bf16 v[68:71], v[96:99], a[40:43], v[68:71]
  v_mfma_f32_16x16x32_bf16 v[72:75], v[96:99], a[72:75], v[72:75]
  v_mfma_f32_16x16x32_bf16 v[76:79], v[96:99], a[104:107], v[76:79]
  v_mfma_f32_16x16x32_bf16 v[80:83], v[96:99], a[136:139], v[80:83]
  v_mfma_f32_16x16x32_bf16 v[84:87], v[96:99], a[168:171], v[84:87]
  v_mfma_f32_16x16x32_bf16 v[88:91], v[96:99], a[200:203], v[88:91]
  ds_read2_b32 v[96:97], v53 offset0:192 offset1:193
  ds_read2_b32 v[98:99], v53 offset0:194 offset1:195
  s_waitcnt lgkmcnt(6)
  v_mfma_f32_16x16x32_bf16 v[64:67], v[100:103], a[4:7], v[64:67]
  v_mfma_f32_16x16x32_bf16 v[68:71], v[100:103], a[36:39], v[68:71]
  v_mfma_f32_16x16x32_bf16 v[72:75], v[100:103], a[68:71], v[72:75]
  v_mfma_f32_16x16x32_bf16 v[76:79], v[100:103], a[100:103], v[76:79]
  v_mfma_f32_16x16x32_bf16 v[80:83], v[100:103], a[132:135], v[80:83]
  v_mfma_f32_16x16x32_bf16 v[84:87], v[100:103], a[164:167], v[84:87]
  v_mfma_f32_16x16x32_bf16 v[88:91], v[100:103], a[196:199], v[88:91]
  ds_read2_b32 v[100:101], v53 offset0:176 offset1:177
  ds_read2_b32 v[102:103], v53 offset0:178 offset1:179
  s_waitcnt lgkmcnt(6)
  v_mfma_f32_16x16x32_bf16 v[64:67], v[104:107], a[0:3], v[64:67]
  v_mfma_f32_16x16x32_bf16 v[68:71], v[104:107], a[32:35], v[68:71]
  v_mfma_f32_16x16x32_bf16 v[72:75], v[104:107], a[64:67], v[72:75]
  v_mfma_f32_16x16x32_bf16 v[76:79], v[104:107], a[96:99], v[76:79]
  v_mfma_f32_16x16x32_bf16 v[80:83], v[104:107], a[128:131], v[80:83]
  v_mfma_f32_16x16x32_bf16 v[84:87], v[104:107], a[160:163], v[84:87]
  v_mfma_f32_16x16x32_bf16 v[88:91], v[104:107], a[192:195], v[88:91]
  ds_read2_b32 v[104:105], v53 offset0:160 offset1:161
  ds_read2_b32 v[106:107], v53 offset0:162 offset1:163
  s_waitcnt lgkmcnt(6)
  v_mfma_f32_16x16x32_bf16 v[68:71], v[92:95], a[28:31], v[68:71]
  v_mfma_f32_16x16x32_bf16 v[72:75], v[92:95], a[60:63], v[72:75]
  v_mfma_f32_16x16x32_bf16 v[76:79], v[92:95], a[92:95], v[76:79]
  v_mfma_f32_16x16x32_bf16 v[80:83], v[92:95], a[124:127], v[80:83]
  v_mfma_f32_16x16x32_bf16 v[84:87], v[92:95], a[156:159], v[84:87]
  v_mfma_f32_16x16x32_bf16 v[88:91], v[92:95], a[188:191], v[88:91]
  ds_read2_b32 v[92:93], v53 offset0:144 offset1:145
  ds_read2_b32 v[94:95], v53 offset0:146 offset1:147
  s_waitcnt lgkmcnt(6)
  v_mfma_f32_16x16x32_bf16 v[68:71], v[96:99], a[24:27], v[68:71]
  v_mfma_f32_16x16x32_bf16 v[72:75], v[96:99], a[56:59], v[72:75]
  v_mfma_f32_16x16x32_bf16 v[76:79], v[96:99], a[88:91], v[76:79]
  v_mfma_f32_16x16x32_bf16 v[80:83], v[96:99], a[120:123], v[80:83]
  v_mfma_f32_16x16x32_bf16 v[84:87], v[96:99], a[152:155], v[84:87]
  v_mfma_f32_16x16x32_bf16 v[88:91], v[96:99], a[184:187], v[88:91]
  ds_read2_b32 v[96:97], v53 offset0:128 offset1:129
  ds_read2_b32 v[98:99], v53 offset0:130 offset1:131
  s_waitcnt lgkmcnt(6)
  v_mfma_f32_16x16x32_bf16 v[68:71], v[100:103], a[20:23], v[68:71]
  v_mfma_f32_16x16x32_bf16 v[72:75], v[100:103], a[52:55], v[72:75]
  v_mfma_f32_16x16x32_bf16 v[76:79], v[100:103], a[84:87], v[76:79]
  v_mfma_f32_16x16x32_bf16 v[80:83], v[100:103], a[116:119], v[80:83]
  v_mfma_f32_16x16x32_bf16 v[84:87], v[100:103], a[148:151], v[84:87]
  v_mfma_f32_16x16x32_bf16 v[88:91], v[100:103], a[180:183], v[88:91]
  ds_read2_b32 v[100:101], v53 offset0:112 offset1:113
  ds_read2_b32 v[102:103], v53 offset0:114 offset1:115
  s_waitcnt lgkmcnt(6)
  v_mfma_f32_16x16x32_bf16 v[68:71], v[104:107], a[16:19], v[68:71]
  v_mfma_f32_16x16x32_bf16 v[72:75], v[104:107], a[48:51], v[72:75]
  v_mfma_f32_16x16x32_bf16 v[76:79], v[104:107], a[80:83], v[76:79]
  v_mfma_f32_16x16x32_bf16 v[80:83], v[104:107], a[112:115], v[80:83]
  v_mfma_f32_16x16x32_bf16 v[84:87], v[104:107], a[144:147], v[84:87]
  v_mfma_f32_16x16x32_bf16 v[88:91], v[104:107], a[176:179], v[88:91]
  ds_read2_b32 v[104:105], v53 offset0:96 offset1:97
  ds_read2_b32 v[106:107], v53 offset0:98 offset1:99
  s_waitcnt lgkmcnt(6)
  v_mfma_f32_16x16x32_bf16 v[68:71], v[92:95], a[12:15], v[68:71]
  v_mfma_f32_16x16x32_bf16 v[72:75], v[92:95], a[44:47], v[72:75]
  v_mfma_f32_16x16x32_bf16 v[76:79], v[92:95], a[76:79], v[76:79]
  v_mfma_f32_16x16x32_bf16 v[80:83], v[92:95], a[108:111], v[80:83]
  v_mfma_f32_16x16x32_bf16 v[84:87], v[92:95], a[140:143], v[84:87]
  v_mfma_f32_16x16x32_bf16 v[88:91], v[92:95], a[172:175], v[88:91]
  ds_read2_b32 v[92:93], v53 offset0:80 offset1:81
  ds_read2_b32 v[94:95], v53 offset0:82 offset1:83
  s_waitcnt lgkmcnt(6)
  v_mfma_f32_16x16x32_bf16 v[68:71], v[96:99], a[8:11], v[68:71]
  v_mfma_f32_16x16x32_bf16 v[72:75], v[96:99], a[40:43], v[72:75]
  v_mfma_f32_16x16x32_bf16 v[76:79], v[96:99], a[72:75], v[76:79]
  v_mfma_f32_16x16x32_bf16 v[80:83], v[96:99], a[104:107], v[80:83]
  v_mfma_f32_16x16x32_bf16 v[84:87], v[96:99], a[136:139], v[84:87]
  v_mfma_f32_16x16x32_bf16 v[88:91], v[96:99], a[168:171], v[88:91]
  ds_read2_b32 v[96:97], v53 offset0:64 offset1:65
  ds_read2_b32 v[98:99], v53 offset0:66 offset1:67
  s_waitcnt lgkmcnt(6)
  v_mfma_f32_16x16x32_bf16 v[68:71], v[100:103], a[4:7], v[68:71]
  v_mfma_f32_16x16x32_bf16 v[72:75], v[100:103], a[36:39], v[72:75]
  v_mfma_f32_16x16x32_bf16 v[76:79], v[100:103], a[68:71], v[76:79]
  v_mfma_f32_16x16x32_bf16 v[80:83], v[100:103], a[100:103], v[80:83]
  v_mfma_f32_16x16x32_bf16 v[84:87], v[100:103], a[132:135], v[84:87]
  v_mfma_f32_16x16x32_bf16 v[88:91], v[100:103], a[164:167], v[88:91]
  ds_read2_b32 v[100:101], v53 offset0:48 offset1:49
  ds_read2_b32 v[102:103], v53 offset0:50 offset1:51
  s_waitcnt lgkmcnt(6)
  v_mfma_f32_16x16x32_bf16 v[68:71], v[104:107], a[0:3], v[68:71]
  v_mfma_f32_16x16x32_bf16 v[72:75], v[104:107], a[32:35], v[72:75]
  v_mfma_f32_16x16x32_bf16 v[76:79], v[104:107], a[64:67], v[76:79]
  v_mfma_f32_16x16x32_bf16 v[80:83], v[104:107], a[96:99], v[80:83]
  v_mfma_f32_16x16x32_bf16 v[84:87], v[104:107], a[128:131], v[84:87]
  v_mfma_f32_16x16x32_bf16 v[88:91], v[104:107], a[160:163], v[88:91]
  ds_read2_b32 v[104:105], v53 offset0:32 offset1:33
  ds_read2_b32 v[106:107], v53 offset0:34 offset1:35
  s_waitcnt lgkmcnt(6)
  v_mfma_f32_16x16x32_bf16 v[72:75], v[92:95], a[28:31], v[72:75]
  v_mfma_f32_16x16x32_bf16 v[76:79], v[92:95], a[60:63], v[76:79]
  v_mfma_f32_16x16x32_bf16 v[80:83], v[92:95], a[92:95], v[80:83]
  v_mfma_f32_16x16x32_bf16 v[84:87], v[92:95], a[124:127], v[84:87]
  v_mfma_f32_16x16x32_bf16 v[88:91], v[92:95], a[156:159], v[88:91]
  ds_read2_b32 v[92:93], v53 offset0:16 offset1:17
  ds_read2_b32 v[94:95], v53 offset0:18 offset1:19
  s_waitcnt lgkmcnt(6)
  v_mfma_f32_16x16x32_bf16 v[72:75], v[96:99], a[24:27], v[72:75]
  v_mfma_f32_16x16x32_bf16 v[76:79], v[96:99], a[56:59], v[76:79]
  v_mfma_f32_16x16x32_bf16 v[80:83], v[96:99], a[88:91], v[80:83]
  v_mfma_f32_16x16x32_bf16 v[84:87], v[96:99], a[120:123], v[84:87]
  v_mfma_f32_16x16x32_bf16 v[88:91], v[96:99], a[152:155], v[88:91]
  ds_read2_b32 v[96:97], v53 offset0:0 offset1:1
  ds_read2_b32 v[98:99], v53 offset0:2 offset1:3
  s_waitcnt lgkmcnt(6)
  v_mfma_f32_16x16x32_bf16 v[72:75], v[100:103], a[20:23], v[72:75]
  v_mfma_f32_16x16x32_bf16 v[76:79], v[100:103], a[52:55], v[76:79]
  v_mfma_f32_16x16x32_bf16 v[80:83], v[100:103], a[84:87], v[80:83]
  v_mfma_f32_16x16x32_bf16 v[84:87], v[100:103], a[116:119], v[84:87]
  v_mfma_f32_16x16x32_bf16 v[88:91], v[100:103], a[148:151], v[88:91]
  ds_read2_b32 v[100:101], v54 offset0:224 offset1:225
  ds_read2_b32 v[102:103], v54 offset0:226 offset1:227
  s_waitcnt lgkmcnt(6)
  v_mfma_f32_16x16x32_bf16 v[72:75], v[104:107], a[16:19], v[72:75]
  v_mfma_f32_16x16x32_bf16 v[76:79], v[104:107], a[48:51], v[76:79]
  v_mfma_f32_16x16x32_bf16 v[80:83], v[104:107], a[80:83], v[80:83]
  v_mfma_f32_16x16x32_bf16 v[84:87], v[104:107], a[112:115], v[84:87]
  v_mfma_f32_16x16x32_bf16 v[88:91], v[104:107], a[144:147], v[88:91]
  ds_read2_b32 v[104:105], v54 offset0:208 offset1:209
  ds_read2_b32 v[106:107], v54 offset0:210 offset1:211
  s_waitcnt lgkmcnt(6)
  v_mfma_f32_16x16x32_bf16 v[72:75], v[92:95], a[12:15], v[72:75]
  v_mfma_f32_16x16x32_bf16 v[76:79], v[92:95], a[44:47], v[76:79]
  v_mfma_f32_16x16x32_bf16 v[80:83], v[92:95], a[76:79], v[80:83]
  v_mfma_f32_16x16x32_bf16 v[84:87], v[92:95], a[108:111], v[84:87]
  v_mfma_f32_16x16x32_bf16 v[88:91], v[92:95], a[140:143], v[88:91]
  ds_read2_b32 v[92:93], v54 offset0:192 offset1:193
  ds_read2_b32 v[94:95], v54 offset0:194 offset1:195
  s_waitcnt lgkmcnt(6)
  v_mfma_f32_16x16x32_bf16 v[72:75], v[96:99], a[8:11], v[72:75]
  v_mfma_f32_16x16x32_bf16 v[76:79], v[96:99], a[40:43], v[76:79]
  v_mfma_f32_16x16x32_bf16 v[80:83], v[96:99], a[72:75], v[80:83]
  v_mfma_f32_16x16x32_bf16 v[84:87], v[96:99], a[104:107], v[84:87]
  v_mfma_f32_16x16x32_bf16 v[88:91], v[96:99], a[136:139], v[88:91]
  ds_read2_b32 v[96:97], v54 offset0:176 offset1:177
  ds_read2_b32 v[98:99], v54 offset0:178 offset1:179
  s_waitcnt lgkmcnt(6)
  v_mfma_f32_16x16x32_bf16 v[72:75], v[100:103], a[4:7], v[72:75]
  v_mfma_f32_16x16x32_bf16 v[76:79], v[100:103], a[36:39], v[76:79]
  v_mfma_f32_16x16x32_bf16 v[80:83], v[100:103], a[68:71], v[80:83]
  v_mfma_f32_16x16x32_bf16 v[84:87], v[100:103], a[100:103], v[84:87]
  v_mfma_f32_16x16x32_bf16 v[88:91], v[100:103], a[132:135], v[88:91]
  ds_read2_b32 v[100:101], v54 offset0:160 offset1:161
  ds_read2_b32 v[102:103], v54 offset0:162 offset1:163
  s_waitcnt lgkmcnt(6)
  v_mfma_f32_16x16x32_bf16 v[72:75], v[104:107], a[0:3], v[72:75]
  v_mfma_f32_16x16x32_bf16 v[76:79], v[104:107], a[32:35], v[76:79]
  v_mfma_f32_16x16x32_bf16 v[80:83], v[104:107], a[64:67], v[80:83]
  v_mfma_f32_16x16x32_bf16 v[84:87], v[104:107], a[96:99], v[84:87]
  v_mfma_f32_16x16x32_bf16 v[88:91], v[104:107], a[128:131], v[88:91]
  ds_read2_b32 v[104:105], v54 offset0:144 offset1:145
  ds_read2_b32 v[106:107], v54 offset0:146 offset1:147
  s_waitcnt lgkmcnt(6)
  v_mfma_f32_16x16x32_bf16 v[76:79], v[92:95], a[28:31], v[76:79]
  v_mfma_f32_16x16x32_bf16 v[80:83], v[92:95], a[60:63], v[80:83]
  v_mfma_f32_16x16x32_bf16 v[84:87], v[92:95], a[92:95], v[84:87]
  v_mfma_f32_16x16x32_bf16 v[88:91], v[92:95], a[124:127], v[88:91]
  ds_read2_b32 v[92:93], v54 offset0:128 offset1:129
  ds_read2_b32 v[94:95], v54 offset0:130 offset1:131
  s_waitcnt lgkmcnt(6)
  v_mfma_f32_16x16x32_bf16 v[76:79], v[96:99], a[24:27], v[76:79]
  v_mfma_f32_16x16x32_bf16 v[80:83], v[96:99], a[56:59], v[80:83]
  v_mfma_f32_16x16x32_bf16 v[84:87], v[96:99], a[88:91], v[84:87]
  v_mfma_f32_16x16x32_bf16 v[88:91], v[96:99], a[120:123], v[88:91]
  ds_read2_b32 v[96:97], v54 offset0:112 offset1:113
  ds_read2_b32 v[98:99], v54 offset0:114 offset1:115
  s_waitcnt lgkmcnt(6)
  v_mfma_f32_16x16x32_bf16 v[76:79], v[100:103], a[20:23], v[76:79]
  v_mfma_f32_16x16x32_bf16 v[80:83], v[100:103], a[52:55], v[80:83]
  v_mfma_f32_16x16x32_bf16 v[84:87], v[100:103], a[84:87], v[84:87]
  v_mfma_f32_16x16x32_bf16 v[88:91], v[100:103], a[116:119], v[88:91]
  ds_read2_b32 v[100:101], v54 offset0:96 offset1:97
  ds_read2_b32 v[102:103], v54 offset0:98 offset1:99
  s_waitcnt lgkmcnt(6)
  v_mfma_f32_16x16x32_bf16 v[76:79], v[104:107], a[16:19], v[76:79]
  v_mfma_f32_16x16x32_bf16 v[80:83], v[104:107], a[48:51], v[80:83]
  v_mfma_f32_16x16x32_bf16 v[84:87], v[104:107], a[80:83], v[84:87]
  v_mfma_f32_16x16x32_bf16 v[88:91], v[104:107], a[112:115], v[88:91]
  ds_read2_b32 v[104:105], v54 offset0:80 offset1:81
  ds_read2_b32 v[106:107], v54 offset0:82 offset1:83
  s_waitcnt lgkmcnt(6)
  v_mfma_f32_16x16x32_bf16 v[76:79], v[92:95], a[12:15], v[76:79]
  v_mfma_f32_16x16x32_bf16 v[80:83], v[92:95], a[44:47], v[80:83]
  v_mfma_f32_16x16x32_bf16 v[84:87], v[92:95], a[76:79], v[84:87]
  v_mfma_f32_16x16x32_bf16 v[88:91], v[92:95], a[108:111], v[88:91]
  ds_read2_b32 v[92:93], v54 offset0:64 offset1:65
  ds_read2_b32 v[94:95], v54 offset0:66 offset1:67
  s_waitcnt lgkmcnt(6)
  v_mfma_f32_16x16x32_bf16 v[76:79], v[96:99], a[8:11], v[76:79]
  v_mfma_f32_16x16x32_bf16 v[80:83], v[96:99], a[40:43], v[80:83]
  v_mfma_f32_16x16x32_bf16 v[84:87], v[96:99], a[72:75], v[84:87]
  v_mfma_f32_16x16x32_bf16 v[88:91], v[96:99], a[104:107], v[88:91]
  ds_read2_b32 v[96:97], v54 offset0:48 offset1:49
  ds_read2_b32 v[98:99], v54 offset0:50 offset1:51
  s_waitcnt lgkmcnt(6)
  v_mfma_f32_16x16x32_bf16 v[76:79], v[100:103], a[4:7], v[76:79]
  v_mfma_f32_16x16x32_bf16 v[80:83], v[100:103], a[36:39], v[80:83]
  v_mfma_f32_16x16x32_bf16 v[84:87], v[100:103], a[68:71], v[84:87]
  v_mfma_f32_16x16x32_bf16 v[88:91], v[100:103], a[100:103], v[88:91]
  ds_read2_b32 v[100:101], v54 offset0:32 offset1:33
  ds_read2_b32 v[102:103], v54 offset0:34 offset1:35
  s_waitcnt lgkmcnt(6)
  v_mfma_f32_16x16x32_bf16 v[76:79], v[104:107], a[0:3], v[76:79]
  v_mfma_f32_16x16x32_bf16 v[80:83], v[104:107], a[32:35], v[80:83]
  v_mfma_f32_16x16x32_bf16 v[84:87], v[104:107], a[64:67], v[84:87]
  v_mfma_f32_16x16x32_bf16 v[88:91], v[104:107], a[96:99], v[88:91]
  ds_read2_b32 v[104:105], v54 offset0:16 offset1:17
  ds_read2_b32 v[106:107], v54 offset0:18 offset1:19
  s_waitcnt lgkmcnt(6)
  v_mfma_f32_16x16x32_bf16 v[80:83], v[92:95], a[28:31], v[80:83]
  v_mfma_f32_16x16x32_bf16 v[84:87], v[92:95], a[60:63], v[84:87]
  v_mfma_f32_16x16x32_bf16 v[88:91], v[92:95], a[92:95], v[88:91]
  ds_read2_b32 v[92:93], v54 offset0:0 offset1:1
  ds_read2_b32 v[94:95], v54 offset0:2 offset1:3
  s_waitcnt lgkmcnt(6)
  v_mfma_f32_16x16x32_bf16 v[80:83], v[96:99], a[24:27], v[80:83]
  v_mfma_f32_16x16x32_bf16 v[84:87], v[96:99], a[56:59], v[84:87]
  v_mfma_f32_16x16x32_bf16 v[88:91], v[96:99], a[88:91], v[88:91]
  ds_read2_b32 v[96:97], v55 offset0:224 offset1:225
  ds_read2_b32 v[98:99], v55 offset0:226 offset1:227
  s_waitcnt lgkmcnt(6)
  v_mfma_f32_16x16x32_bf16 v[80:83], v[100:103], a[20:23], v[80:83]
  v_mfma_f32_16x16x32_bf16 v[84:87], v[100:103], a[52:55], v[84:87]
  v_mfma_f32_16x16x32_bf16 v[88:91], v[100:103], a[84:87], v[88:91]
  ds_read2_b32 v[100:101], v55 offset0:208 offset1:209
  ds_read2_b32 v[102:103], v55 offset0:210 offset1:211
  s_waitcnt lgkmcnt(6)
  v_mfma_f32_16x16x32_bf16 v[80:83], v[104:107], a[16:19], v[80:83]
  v_mfma_f32_16x16x32_bf16 v[84:87], v[104:107], a[48:51], v[84:87]
  v_mfma_f32_16x16x32_bf16 v[88:91], v[104:107], a[80:83], v[88:91]
  ds_read2_b32 v[104:105], v55 offset0:192 offset1:193
  ds_read2_b32 v[106:107], v55 offset0:194 offset1:195
  s_waitcnt lgkmcnt(6)
  v_mfma_f32_16x16x32_bf16 v[80:83], v[92:95], a[12:15], v[80:83]
  v_mfma_f32_16x16x32_bf16 v[84:87], v[92:95], a[44:47], v[84:87]
  v_mfma_f32_16x16x32_bf16 v[88:91], v[92:95], a[76:79], v[88:91]
  ds_read2_b32 v[92:93], v55 offset0:176 offset1:177
  ds_read2_b32 v[94:95], v55 offset0:178 offset1:179
  s_waitcnt lgkmcnt(6)
  v_mfma_f32_16x16x32_bf16 v[80:83], v[96:99], a[8:11], v[80:83]
  v_mfma_f32_16x16x32_bf16 v[84:87], v[96:99], a[40:43], v[84:87]
  v_mfma_f32_16x16x32_bf16 v[88:91], v[96:99], a[72:75], v[88:91]
  ds_read2_b32 v[96:97], v55 offset0:160 offset1:161
  ds_read2_b32 v[98:99], v55 offset0:162 offset1:163
  s_waitcnt lgkmcnt(6)
  v_mfma_f32_16x16x32_bf16 v[80:83], v[100:103], a[4:7], v[80:83]
  v_mfma_f32_16x16x32_bf16 v[84:87], v[100:103], a[36:39], v[84:87]
  v_mfma_f32_16x16x32_bf16 v[88:91], v[100:103], a[68:71], v[88:91]
  ds_read2_b32 v[100:101], v55 offset0:144 offset1:145
  ds_read2_b32 v[102:103], v55 offset0:146 offset1:147
  s_waitcnt lgkmcnt(6)
  v_mfma_f32_16x16x32_bf16 v[80:83], v[104:107], a[0:3], v[80:83]
  v_mfma_f32_16x16x32_bf16 v[84:87], v[104:107], a[32:35], v[84:87]
  v_mfma_f32_16x16x32_bf16 v[88:91], v[104:107], a[64:67], v[88:91]
  ds_read2_b32 v[104:105], v55 offset0:128 offset1:129
  ds_read2_b32 v[106:107], v55 offset0:130 offset1:131
  s_waitcnt lgkmcnt(6)
  v_mfma_f32_16x16x32_bf16 v[84:87], v[92:95], a[28:31], v[84:87]
  v_mfma_f32_16x16x32_bf16 v[88:91], v[92:95], a[60:63], v[88:91]
  ds_read2_b32 v[92:93], v55 offset0:112 offset1:113
  ds_read2_b32 v[94:95], v55 offset0:114 offset1:115
  s_waitcnt lgkmcnt(6)
  v_mfma_f32_16x16x32_bf16 v[84:87], v[96:99], a[24:27], v[84:87]
  v_mfma_f32_16x16x32_bf16 v[88:91], v[96:99], a[56:59], v[88:91]
  ds_read2_b32 v[96:97], v55 offset0:96 offset1:97
  ds_read2_b32 v[98:99], v55 offset0:98 offset1:99
  s_waitcnt lgkmcnt(6)
  v_mfma_f32_16x16x32_bf16 v[84:87], v[100:103], a[20:23], v[84:87]
  v_mfma_f32_16x16x32_bf16 v[88:91], v[100:103], a[52:55], v[88:91]
  ds_read2_b32 v[100:101], v55 offset0:80 offset1:81
  ds_read2_b32 v[102:103], v55 offset0:82 offset1:83
  s_waitcnt lgkmcnt(6)
  v_mfma_f32_16x16x32_bf16 v[84:87], v[104:107], a[16:19], v[84:87]
  v_mfma_f32_16x16x32_bf16 v[88:91], v[104:107], a[48:51], v[88:91]
  ds_read2_b32 v[104:105], v55 offset0:64 offset1:65
  ds_read2_b32 v[106:107], v55 offset0:66 offset1:67
  s_waitcnt lgkmcnt(6)
  v_mfma_f32_16x16x32_bf16 v[84:87], v[92:95], a[12:15], v[84:87]
  v_mfma_f32_16x16x32_bf16 v[88:91], v[92:95], a[44:47], v[88:91]
  ds_read2_b32 v[92:93], v55 offset0:48 offset1:49
  ds_read2_b32 v[94:95], v55 offset0:50 offset1:51
  s_waitcnt lgkmcnt(6)
  v_mfma_f32_16x16x32_bf16 v[84:87], v[96:99], a[8:11], v[84:87]
  v_mfma_f32_16x16x32_bf16 v[88:91], v[96:99], a[40:43], v[88:91]
  ds_read2_b32 v[96:97], v55 offset0:32 offset1:33
  ds_read2_b32 v[98:99], v55 offset0:34 offset1:35
  s_waitcnt lgkmcnt(6)
  v_mfma_f32_16x16x32_bf16 v[84:87], v[100:103], a[4:7], v[84:87]
  v_mfma_f32_16x16x32_bf16 v[88:91], v[100:103], a[36:39], v[88:91]
  ds_read2_b32 v[100:101], v55 offset0:16 offset1:17
  ds_read2_b32 v[102:103], v55 offset0:18 offset1:19
  s_waitcnt lgkmcnt(6)
  v_mfma_f32_16x16x32_bf16 v[84:87], v[104:107], a[0:3], v[84:87]
  v_mfma_f32_16x16x32_bf16 v[88:91], v[104:107], a[32:35], v[88:91]
  ds_read2_b32 v[104:105], v55 offset0:0 offset1:1
  ds_read2_b32 v[106:107], v55 offset0:2 offset1:3
  s_waitcnt lgkmcnt(6)
  v_mfma_f32_16x16x32_bf16 v[88:91], v[92:95], a[28:31], v[88:91]
  ds_read2_b32 v[92:93], v56 offset0:224 offset1:225
  ds_read2_b32 v[94:95], v56 offset0:226 offset1:227
  s_waitcnt lgkmcnt(6)
  v_mfma_f32_16x16x32_bf16 v[88:91], v[96:99], a[24:27], v[88:91]
  ds_read2_b32 v[96:97], v56 offset0:208 offset1:209
  ds_read2_b32 v[98:99], v56 offset0:210 offset1:211
  s_waitcnt lgkmcnt(6)
  v_mfma_f32_16x16x32_bf16 v[88:91], v[100:103], a[20:23], v[88:91]
  ds_read2_b32 v[100:101], v56 offset0:192 offset1:193
  ds_read2_b32 v[102:103], v56 offset0:194 offset1:195
  s_waitcnt lgkmcnt(6)
  v_mfma_f32_16x16x32_bf16 v[88:91], v[104:107], a[16:19], v[88:91]
  ds_read2_b32 v[104:105], v56 offset0:176 offset1:177
  ds_read2_b32 v[106:107], v56 offset0:178 offset1:179
  s_waitcnt lgkmcnt(6)
  v_mfma_f32_16x16x32_bf16 v[88:91], v[92:95], a[12:15], v[88:91]
  s_waitcnt lgkmcnt(4)
  v_mfma_f32_16x16x32_bf16 v[88:91], v[96:99], a[8:11], v[88:91]
  s_waitcnt lgkmcnt(2)
  v_mfma_f32_16x16x32_bf16 v[88:91], v[100:103], a[4:7], v[88:91]
  s_waitcnt lgkmcnt(0)
  v_mfma_f32_16x16x32_bf16 v[88:91], v[104:107], a[0:3], v[88:91]
  v_lshlrev_b32 v46, 5, v4
  v_lshl_add_u32 v46, v3, 3, v46
  v_add_u32 v46, s17, v46
  ds_read_b64 v[108:109], v46 offset:512
  ds_read_b64 v[110:111], v46 offset:1024
  ds_read_b64 v[112:113], v46 offset:1536
  ds_read_b64 v[114:115], v46 offset:2048
  ds_read_b64 v[116:117], v46 offset:2560
  ds_read_b64 v[118:119], v46 offset:3072
  ds_read_b64 v[120:121], v46 offset:3584
  ds_read_b64 v[122:123], v46 offset:4096
  s_waitcnt lgkmcnt(0)
  v_lshlrev_b32 v124, 16, v108
  v_and_b32 v125, 0xffff0000, v108
  v_lshlrev_b32 v126, 16, v109
  v_and_b32 v127, 0xffff0000, v109
  v_mul_f32 v124, v124, v33
  v_mul_f32 v125, v125, v33
  v_mul_f32 v126, v126, v33
  v_mul_f32 v127, v127, v33
  v_cvt_pk_bf16_f32 v128, v124, v125
  v_cvt_pk_bf16_f32 v129, v126, v127
  v_cvt_pk_bf16_f32 v130, v60, v61
  v_cvt_pk_bf16_f32 v131, v62, v63
  v_lshlrev_b32 v124, 16, v128
  v_and_b32 v125, 0xffff0000, v128
  v_lshlrev_b32 v132, 16, v130
  v_and_b32 v133, 0xffff0000, v130
  v_lshlrev_b32 v126, 16, v129
  v_and_b32 v127, 0xffff0000, v129
  v_lshlrev_b32 v134, 16, v131
  v_and_b32 v135, 0xffff0000, v131
  v_add_f32 v124, v124, v132
  v_add_f32 v125, v125, v133
  v_add_f32 v126, v126, v134
  v_add_f32 v127, v127, v135
  v_cvt_pk_bf16_f32 v108, v124, v125
  v_cvt_pk_bf16_f32 v109, v126, v127
  ds_write_b64 v46, v[108:109] offset:512
  v_lshlrev_b32 v124, 16, v110
  v_and_b32 v125, 0xffff0000, v110
  v_lshlrev_b32 v126, 16, v111
  v_and_b32 v127, 0xffff0000, v111
  v_mul_f32 v124, v124, v33
  v_mul_f32 v125, v125, v33
  v_mul_f32 v126, v126, v33
  v_mul_f32 v127, v127, v33
  v_cvt_pk_bf16_f32 v128, v124, v125
  v_cvt_pk_bf16_f32 v129, v126, v127
  v_cvt_pk_bf16_f32 v130, v64, v65
  v_cvt_pk_bf16_f32 v131, v66, v67
  v_lshlrev_b32 v124, 16, v128
  v_and_b32 v125, 0xffff0000, v128
  v_lshlrev_b32 v132, 16, v130
  v_and_b32 v133, 0xffff0000, v130
  v_lshlrev_b32 v126, 16, v129
  v_and_b32 v127, 0xffff0000, v129
  v_lshlrev_b32 v134, 16, v131
  v_and_b32 v135, 0xffff0000, v131
  v_add_f32 v124, v124, v132
  v_add_f32 v125, v125, v133
  v_add_f32 v126, v126, v134
  v_add_f32 v127, v127, v135
  v_cvt_pk_bf16_f32 v110, v124, v125
  v_cvt_pk_bf16_f32 v111, v126, v127
  ds_write_b64 v46, v[110:111] offset:1024
  v_lshlrev_b32 v124, 16, v112
  v_and_b32 v125, 0xffff0000, v112
  v_lshlrev_b32 v126, 16, v113
  v_and_b32 v127, 0xffff0000, v113
  v_mul_f32 v124, v124, v33
  v_mul_f32 v125, v125, v33
  v_mul_f32 v126, v126, v33
  v_mul_f32 v127, v127, v33
  v_cvt_pk_bf16_f32 v128, v124, v125
  v_cvt_pk_bf16_f32 v129, v126, v127
  v_cvt_pk_bf16_f32 v130, v68, v69
  v_cvt_pk_bf16_f32 v131, v70, v71
  v_lshlrev_b32 v124, 16, v128
  v_and_b32 v125, 0xffff0000, v128
  v_lshlrev_b32 v132, 16, v130
  v_and_b32 v133, 0xffff0000, v130
  v_lshlrev_b32 v126, 16, v129
  v_and_b32 v127, 0xffff0000, v129
  v_lshlrev_b32 v134, 16, v131
  v_and_b32 v135, 0xffff0000, v131
  v_add_f32 v124, v124, v132
  v_add_f32 v125, v125, v133
  v_add_f32 v126, v126, v134
  v_add_f32 v127, v127, v135
  v_cvt_pk_bf16_f32 v112, v124, v125
  v_cvt_pk_bf16_f32 v113, v126, v127
  ds_write_b64 v46, v[112:113] offset:1536
  v_lshlrev_b32 v124, 16, v114
  v_and_b32 v125, 0xffff0000, v114
  v_lshlrev_b32 v126, 16, v115
  v_and_b32 v127, 0xffff0000, v115
  v_mul_f32 v124, v124, v33
  v_mul_f32 v125, v125, v33
  v_mul_f32 v126, v126, v33
  v_mul_f32 v127, v127, v33
  v_cvt_pk_bf16_f32 v128, v124, v125
  v_cvt_pk_bf16_f32 v129, v126, v127
  v_cvt_pk_bf16_f32 v130, v72, v73
  v_cvt_pk_bf16_f32 v131, v74, v75
  v_lshlrev_b32 v124, 16, v128
  v_and_b32 v125, 0xffff0000, v128
  v_lshlrev_b32 v132, 16, v130
  v_and_b32 v133, 0xffff0000, v130
  v_lshlrev_b32 v126, 16, v129
  v_and_b32 v127, 0xffff0000, v129
  v_lshlrev_b32 v134, 16, v131
  v_and_b32 v135, 0xffff0000, v131
  v_add_f32 v124, v124, v132
  v_add_f32 v125, v125, v133
  v_add_f32 v126, v126, v134
  v_add_f32 v127, v127, v135
  v_cvt_pk_bf16_f32 v114, v124, v125
  v_cvt_pk_bf16_f32 v115, v126, v127
  ds_write_b64 v46, v[114:115] offset:2048
  v_lshlrev_b32 v124, 16, v116
  v_and_b32 v125, 0xffff0000, v116
  v_lshlrev_b32 v126, 16, v117
  v_and_b32 v127, 0xffff0000, v117
  v_mul_f32 v124, v124, v33
  v_mul_f32 v125, v125, v33
  v_mul_f32 v126, v126, v33
  v_mul_f32 v127, v127, v33
  v_cvt_pk_bf16_f32 v128, v124, v125
  v_cvt_pk_bf16_f32 v129, v126, v127
  v_cvt_pk_bf16_f32 v130, v76, v77
  v_cvt_pk_bf16_f32 v131, v78, v79
  v_lshlrev_b32 v124, 16, v128
  v_and_b32 v125, 0xffff0000, v128
  v_lshlrev_b32 v132, 16, v130
  v_and_b32 v133, 0xffff0000, v130
  v_lshlrev_b32 v126, 16, v129
  v_and_b32 v127, 0xffff0000, v129
  v_lshlrev_b32 v134, 16, v131
  v_and_b32 v135, 0xffff0000, v131
  v_add_f32 v124, v124, v132
  v_add_f32 v125, v125, v133
  v_add_f32 v126, v126, v134
  v_add_f32 v127, v127, v135
  v_cvt_pk_bf16_f32 v116, v124, v125
  v_cvt_pk_bf16_f32 v117, v126, v127
  ds_write_b64 v46, v[116:117] offset:2560
  v_lshlrev_b32 v124, 16, v118
  v_and_b32 v125, 0xffff0000, v118
  v_lshlrev_b32 v126, 16, v119
  v_and_b32 v127, 0xffff0000, v119
  v_mul_f32 v124, v124, v33
  v_mul_f32 v125, v125, v33
  v_mul_f32 v126, v126, v33
  v_mul_f32 v127, v127, v33
  v_cvt_pk_bf16_f32 v128, v124, v125
  v_cvt_pk_bf16_f32 v129, v126, v127
  v_cvt_pk_bf16_f32 v130, v80, v81
  v_cvt_pk_bf16_f32 v131, v82, v83
  v_lshlrev_b32 v124, 16, v128
  v_and_b32 v125, 0xffff0000, v128
  v_lshlrev_b32 v132, 16, v130
  v_and_b32 v133, 0xffff0000, v130
  v_lshlrev_b32 v126, 16, v129
  v_and_b32 v127, 0xffff0000, v129
  v_lshlrev_b32 v134, 16, v131
  v_and_b32 v135, 0xffff0000, v131
  v_add_f32 v124, v124, v132
  v_add_f32 v125, v125, v133
  v_add_f32 v126, v126, v134
  v_add_f32 v127, v127, v135
  v_cvt_pk_bf16_f32 v118, v124, v125
  v_cvt_pk_bf16_f32 v119, v126, v127
  ds_write_b64 v46, v[118:119] offset:3072
  v_lshlrev_b32 v124, 16, v120
  v_and_b32 v125, 0xffff0000, v120
  v_lshlrev_b32 v126, 16, v121
  v_and_b32 v127, 0xffff0000, v121
  v_mul_f32 v124, v124, v33
  v_mul_f32 v125, v125, v33
  v_mul_f32 v126, v126, v33
  v_mul_f32 v127, v127, v33
  v_cvt_pk_bf16_f32 v128, v124, v125
  v_cvt_pk_bf16_f32 v129, v126, v127
  v_cvt_pk_bf16_f32 v130, v84, v85
  v_cvt_pk_bf16_f32 v131, v86, v87
  v_lshlrev_b32 v124, 16, v128
  v_and_b32 v125, 0xffff0000, v128
  v_lshlrev_b32 v132, 16, v130
  v_and_b32 v133, 0xffff0000, v130
  v_lshlrev_b32 v126, 16, v129
  v_and_b32 v127, 0xffff0000, v129
  v_lshlrev_b32 v134, 16, v131
  v_and_b32 v135, 0xffff0000, v131
  v_add_f32 v124, v124, v132
  v_add_f32 v125, v125, v133
  v_add_f32 v126, v126, v134
  v_add_f32 v127, v127, v135
  v_cvt_pk_bf16_f32 v120, v124, v125
  v_cvt_pk_bf16_f32 v121, v126, v127
  ds_write_b64 v46, v[120:121] offset:3584
  v_lshlrev_b32 v124, 16, v122
  v_and_b32 v125, 0xffff0000, v122
  v_lshlrev_b32 v126, 16, v123
  v_and_b32 v127, 0xffff0000, v123
  v_mul_f32 v124, v124, v33
  v_mul_f32 v125, v125, v33
  v_mul_f32 v126, v126, v33
  v_mul_f32 v127, v127, v33
  v_cvt_pk_bf16_f32 v128, v124, v125
  v_cvt_pk_bf16_f32 v129, v126, v127
  v_cvt_pk_bf16_f32 v130, v88, v89
  v_cvt_pk_bf16_f32 v131, v90, v91
  v_lshlrev_b32 v124, 16, v128
  v_and_b32 v125, 0xffff0000, v128
  v_lshlrev_b32 v132, 16, v130
  v_and_b32 v133, 0xffff0000, v130
  v_lshlrev_b32 v126, 16, v129
  v_and_b32 v127, 0xffff0000, v129
  v_lshlrev_b32 v134, 16, v131
  v_and_b32 v135, 0xffff0000, v131
  v_add_f32 v124, v124, v132
  v_add_f32 v125, v125, v133
  v_add_f32 v126, v126, v134
  v_add_f32 v127, v127, v135
  v_cvt_pk_bf16_f32 v122, v124, v125
  v_cvt_pk_bf16_f32 v123, v126, v127
  ds_write_b64 v46, v[122:123] offset:4096
  s_waitcnt lgkmcnt(0)
  s_barrier
  v_lshlrev_b32 v6, 3, v0
  v_mul_u32_u24 v5, 7168, v0
  v_add_u32 v36, 512, v6
  ds_read_b64 v[8:9], v36
  v_add_u32 v36, 25088, v6
  ds_read_b64 v[10:11], v36
  v_add_u32 v36, 49664, v6
  ds_read_b64 v[12:13], v36
  v_add_u32 v36, 74240, v6
  ds_read_b64 v[14:15], v36
  s_waitcnt lgkmcnt(0)
  s_add_u32 s22, s21, 0
  s_add_u32 s23, s22, 3584
  v_perm_b32 v16, v10, v8, s24
  v_perm_b32 v17, v14, v12, s24
  buffer_store_dwordx2 v[16:17], v5, s[88:91], s22 offen offset:0
  v_perm_b32 v18, v10, v8, s25
  v_perm_b32 v19, v14, v12, s25
  buffer_store_dwordx2 v[18:19], v5, s[88:91], s22 offen offset:1792
  v_perm_b32 v20, v11, v9, s24
  v_perm_b32 v21, v15, v13, s24
  buffer_store_dwordx2 v[20:21], v5, s[88:91], s23 offen offset:0
  v_perm_b32 v22, v11, v9, s25
  v_perm_b32 v23, v15, v13, s25
  buffer_store_dwordx2 v[22:23], v5, s[88:91], s23 offen offset:1792
  v_add_u32 v36, 2560, v6
  ds_read_b64 v[8:9], v36
  v_add_u32 v36, 27136, v6
  ds_read_b64 v[10:11], v36
  v_add_u32 v36, 51712, v6
  ds_read_b64 v[12:13], v36
  v_add_u32 v36, 76288, v6
  ds_read_b64 v[14:15], v36
  s_waitcnt lgkmcnt(0)
  s_add_u32 s22, s21, 1835008
  s_add_u32 s23, s22, 3584
  v_perm_b32 v24, v10, v8, s24
  v_perm_b32 v25, v14, v12, s24
  buffer_store_dwordx2 v[24:25], v5, s[88:91], s22 offen offset:0
  v_perm_b32 v26, v10, v8, s25
  v_perm_b32 v27, v14, v12, s25
  buffer_store_dwordx2 v[26:27], v5, s[88:91], s22 offen offset:1792
  v_perm_b32 v28, v11, v9, s24
  v_perm_b32 v29, v15, v13, s24
  buffer_store_dwordx2 v[28:29], v5, s[88:91], s23 offen offset:0
  v_perm_b32 v30, v11, v9, s25
  v_perm_b32 v31, v15, v13, s25
  buffer_store_dwordx2 v[30:31], v5, s[88:91], s23 offen offset:1792
  s_branch wk_loop
wk_tok:
  s_sub_u32 s3, s3, 752
  s_cmp_ge_u32 s3, 512
  s_cbranch_scc1 wk_done
  s_and_b32 s18, s3, 3
  s_lshr_b32 s17, s3, 2
  s_cmp_lt_u32 s17, 8
  s_cbranch_scc1 wk_tokp
  s_sub_u32 s20, s17, 8
  s_sub_u32 s17, s17, 64
  s_cmp_ge_u32 s20, 112
  s_cbranch_scc1 wk_toko
  s_lshr_b32 s17, s20, 1
  s_bitcmp0_b32 s20, 0
  s_cbranch_scc1 wk_toko
  s_add_u32 s17, s17, 8
wk_tokp:
  s_lshl_b32 s20, s18, 2
  s_add_u32 s20, s20, s16
  s_lshl_b32 s21, s17, 4
  s_add_u32 s21, s21, s20
  s_mul_i32 s21, s21, 28672
  s_add_u32 s21, s21, 46399488
  s_mul_i32 s23, s17, 28672
  s_add_u32 s23, s23, 75759616
  s_mul_i32 s24, s17, 7168
  s_add_u32 s24, s24, 65536
  s_lshr_b32 s25, s17, 3
  s_lshl_b32 s25, s25, 4
  s_add_u32 s25, s25, s20
  s_lshl_b32 s25, s25, 7
  s_add_u32 s25, s25, 540672
  v_mov_b32 v60, 0
  s_mov_b32 s30, 0
wp_wf:
  buffer_load_dword v61, v60, s[8:11], s25 offen sc1
  s_waitcnt vmcnt(0)
  v_cmp_ne_u32 vcc, 56, v61
  s_cbranch_vccz wp_wf_ok
  s_sleep 4
  s_cmp_ge_u32 s17, 50
  s_cbranch_scc1 wp_wf_bo
  s_sleep 64
wp_wf_bo:
  s_add_u32 s30, s30, 1
  s_cmp_lt_u32 s30, 2000000
  s_cbranch_scc1 wp_wf
  s_branch wp_abort
wp_wf_ok:
  s_lshl_b32 s25, s17, 1
  s_mul_i32 s25, s25, 20480
  s_add_u32 s25, s25, 86114304
  s_lshl_b32 s26, s20, 10
  s_add_u32 s26, s26, s25
  s_lshl_b32 s27, s18, 10
  s_add_u32 s27, s27, s25
  s_lshr_b32 s28, s16, 1
  s_lshl_b32 s28, s28, 3
  s_add_u32 s27, s27, s28
  s_add_u32 s27, s27, 16384
  s_and_b32 s28, s16, 1
  s_cmp_eq_u32 s28, 0
  s_cselect_b32 s50, -1, 0
  s_cselect_b32 s51, 0, -1
  v_mov_b32 v44, -1
  v_mov_b32 v45, -1
  v_mov_b32 v46, -1
  v_mov_b32 v47, -1
  s_add_u32 s28, s26, 0
  s_add_u32 s29, s27, 0
  buffer_store_dwordx4 v[44:47], v2, s[8:11], s28 offen sc1
  s_mov_b64 exec, s[50:51]
  buffer_store_dwordx2 v[44:45], v2, s[8:11], s29 offen sc1
  s_mov_b64 exec, -1
  s_add_u32 s28, s26, 20480
  s_add_u32 s29, s27, 20480
  buffer_store_dwordx4 v[44:47], v2, s[8:11], s28 offen sc1
  s_mov_b64 exec, s[50:51]
  buffer_store_dwordx2 v[44:45], v2, s[8:11], s29 offen sc1
  s_mov_b64 exec, -1
  s_add_u32 s22, s21, 0
  buffer_load_dwordx4 a[0:3], v2, s[8:11], s22 offen offset:0 sc1
  buffer_load_dwordx4 a[4:7], v2, s[8:11], s22 offen offset:1024 sc1
  buffer_load_dwordx4 a[8:11], v2, s[8:11], s22 offen offset:2048 sc1
  buffer_load_dwordx4 a[12:15], v2, s[8:11], s22 offen offset:3072 sc1
  s_add_u32 s22, s21, 4096
  buffer_load_dwordx4 a[16:19], v2, s[8:11], s22 offen offset:0 sc1
  buffer_load_dwordx4 a[20:23], v2, s[8:11], s22 offen offset:1024 sc1
  buffer_load_dwordx4 a[24:27], v2, s[8:11], s22 offen offset:2048 sc1
  buffer_load_dwordx4 a[28:31], v2, s[8:11], s22 offen offset:3072 sc1
  s_add_u32 s22, s21, 8192
  buffer_load_dwordx4 a[32:35], v2, s[8:11], s22 offen offset:0 sc1
  buffer_load_dwordx4 a[36:39], v2, s[8:11], s22 offen offset:1024 sc1
  buffer_load_dwordx4 a[40:43], v2, s[8:11], s22 offen offset:2048 sc1
  buffer_load_dwordx4 a[44:47], v2, s[8:11], s22 offen offset:3072 sc1
  s_add_u32 s22, s21, 12288
  buffer_load_dwordx4 a[48:51], v2, s[8:11], s22 offen offset:0 sc1
  buffer_load_dwordx4 a[52:55], v2, s[8:11], s22 offen offset:1024 sc1
  buffer_load_dwordx4 a[56:59], v2, s[8:11], s22 offen offset:2048 sc1
  buffer_load_dwordx4 a[60:63], v2, s[8:11], s22 offen offset:3072 sc1
  s_add_u32 s22, s21, 16384
  buffer_load_dwordx4 a[64:67], v2, s[8:11], s22 offen offset:0 sc1
  buffer_load_dwordx4 a[68:71], v2, s[8:11], s22 offen offset:1024 sc1
  buffer_load_dwordx4 a[72:75], v2, s[8:11], s22 offen offset:2048 sc1
  buffer_load_dwordx4 a[76:79], v2, s[8:11], s22 offen offset:3072 sc1
  s_add_u32 s22, s21, 20480
  buffer_load_dwordx4 a[80:83], v2, s[8:11], s22 offen offset:0 sc1
  buffer_load_dwordx4 a[84:87], v2, s[8:11], s22 offen offset:1024 sc1
  buffer_load_dwordx4 a[88:91], v2, s[8:11], s22 offen offset:2048 sc1
  buffer_load_dwordx4 a[92:95], v2, s[8:11], s22 offen offset:3072 sc1
  s_add_u32 s22, s21, 24576
  buffer_load_dwordx4 a[96:99], v2, s[8:11], s22 offen offset:0 sc1
  buffer_load_dwordx4 a[100:103], v2, s[8:11], s22 offen offset:1024 sc1
  buffer_load_dwordx4 a[104:107], v2, s[8:11], s22 offen offset:2048 sc1
  buffer_load_dwordx4 a[108:111], v2, s[8:11], s22 offen offset:3072 sc1
  s_add_u32 s22, s23, 0
  buffer_load_dwordx4 a[112:115], v2, s[8:11], s22 offen offset:0 sc1
  buffer_load_dwordx4 a[116:119], v2, s[8:11], s22 offen offset:1024 sc1
  buffer_load_dwordx4 a[120:123], v2, s[8:11], s22 offen offset:2048 sc1
  buffer_load_dwordx4 a[124:127], v2, s[8:11], s22 offen offset:3072 sc1
  s_add_u32 s22, s23, 4096
  buffer_load_dwordx4 a[128:131], v2, s[8:11], s22 offen offset:0 sc1
  buffer_load_dwordx4 a[132:135], v2, s[8:11], s22 offen offset:1024 sc1
  buffer_load_dwordx4 a[136:139], v2, s[8:11], s22 offen offset:2048 sc1
  buffer_load_dwordx4 a[140:143], v2, s[8:11], s22 offen offset:3072 sc1
  s_add_u32 s22, s23, 8192
  buffer_load_dwordx4 a[144:147], v2, s[8:11], s22 offen offset:0 sc1
  buffer_load_dwordx4 a[148:151], v2, s[8:11], s22 offen offset:1024 sc1
  buffer_load_dwordx4 a[152:155], v2, s[8:11], s22 offen offset:2048 sc1
  buffer_load_dwordx4 a[156:159], v2, s[8:11], s22 offen offset:3072 sc1
  s_add_u32 s22, s23, 12288
  buffer_load_dwordx4 a[160:163], v2, s[8:11], s22 offen offset:0 sc1
  buffer_load_dwordx4 a[164:167], v2, s[8:11], s22 offen offset:1024 sc1
  buffer_load_dwordx4 a[168:171], v2, s[8:11], s22 offen offset:2048 sc1
  buffer_load_dwordx4 a[172:175], v2, s[8:11], s22 offen offset:3072 sc1
  s_add_u32 s22, s23, 16384
  buffer_load_dwordx4 a[176:179], v2, s[8:11], s22 offen offset:0 sc1
  buffer_load_dwordx4 a[180:183], v2, s[8:11], s22 offen offset:1024 sc1
  buffer_load_dwordx4 a[184:187], v2, s[8:11], s22 offen offset:2048 sc1
  buffer_load_dwordx4 a[188:191], v2, s[8:11], s22 offen offset:3072 sc1
  s_add_u32 s22, s23, 20480
  buffer_load_dwordx4 a[192:195], v2, s[8:11], s22 offen offset:0 sc1
  buffer_load_dwordx4 a[196:199], v2, s[8:11], s22 offen offset:1024 sc1
  buffer_load_dwordx4 a[200:203], v2, s[8:11], s22 offen offset:2048 sc1
  buffer_load_dwordx4 a[204:207], v2, s[8:11], s22 offen offset:3072 sc1
  s_add_u32 s22, s23, 24576
  buffer_load_dwordx4 a[208:211], v2, s[8:11], s22 offen offset:0 sc1
  buffer_load_dwordx4 a[212:215], v2, s[8:11], s22 offen offset:1024 sc1
  buffer_load_dwordx4 a[216:219], v2, s[8:11], s22 offen offset:2048 sc1
  buffer_load_dwordx4 a[220:223], v2, s[8:11], s22 offen offset:3072 sc1
  v_lshl_add_u32 v5, v3, 2, 0
  v_cmp_le_u32 s[40:41], v5, v4
  v_lshl_add_u32 v5, v3, 2, 1
  v_cmp_le_u32 s[42:43], v5, v4
  v_lshl_add_u32 v5, v3, 2, 2
  v_cmp_le_u32 s[44:45], v5, v4
  v_lshl_add_u32 v5, v3, 2, 3
  v_cmp_le_u32 s[46:47], v5, v4
  v_cmp_gt_u32 s[48:49], 2, v3
  v_mov_b32 v6, 0xff800000
  s_waitcnt vmcnt(0)
  s_lshl_b32 s25, s17, 7
  s_add_u32 s25, s25, 557056
  v_mov_b32 v5, 1
  v_mov_b32 v7, 0
  s_waitcnt vmcnt(0)
  s_mov_b64 exec, 1
  buffer_atomic_add v5, v7, s[8:11], s25 offen
  s_mov_b64 exec, -1
  v_mfma_f32_16x16x32_bf16 v[8:11], a[112:115], a[0:3], 0
  v_mfma_f32_16x16x32_bf16 v[12:15], a[112:115], a[56:59], 0
  v_mfma_f32_16x16x32_bf16 v[16:19], a[168:171], a[56:59], 0
  v_mfma_f32_16x16x32_bf16 v[8:11], a[116:119], a[4:7], v[8:11]
  v_mfma_f32_16x16x32_bf16 v[12:15], a[116:119], a[60:63], v[12:15]
  v_mfma_f32_16x16x32_bf16 v[16:19], a[172:175], a[60:63], v[16:19]
  v_mfma_f32_16x16x32_bf16 v[8:11], a[120:123], a[8:11], v[8:11]
  v_mfma_f32_16x16x32_bf16 v[12:15], a[120:123], a[64:67], v[12:15]
  v_mfma_f32_16x16x32_bf16 v[16:19], a[176:179], a[64:67], v[16:19]
  v_mfma_f32_16x16x32_bf16 v[8:11], a[124:127], a[12:15], v[8:11]
  v_mfma_f32_16x16x32_bf16 v[12:15], a[124:127], a[68:71], v[12:15]
  v_mfma_f32_16x16x32_bf16 v[16:19], a[180:183], a[68:71], v[16:19]
  v_mfma_f32_16x16x32_bf16 v[8:11], a[128:131], a[16:19], v[8:11]
  v_mfma_f32_16x16x32_bf16 v[12:15], a[128:131], a[72:75], v[12:15]
  v_mfma_f32_16x16x32_bf16 v[16:19], a[184:187], a[72:75], v[16:19]
  v_mfma_f32_16x16x32_bf16 v[8:11], a[132:135], a[20:23], v[8:11]
  v_mfma_f32_16x16x32_bf16 v[12:15], a[132:135], a[76:79], v[12:15]
  v_mfma_f32_16x16x32_bf16 v[16:19], a[188:191], a[76:79], v[16:19]
  v_mfma_f32_16x16x32_bf16 v[8:11], a[136:139], a[24:27], v[8:11]
  v_mfma_f32_16x16x32_bf16 v[12:15], a[136:139], a[80:83], v[12:15]
  v_mfma_f32_16x16x32_bf16 v[16:19], a[192:195], a[80:83], v[16:19]
  v_mfma_f32_16x16x32_bf16 v[8:11], a[140:143], a[28:31], v[8:11]
  v_mfma_f32_16x16x32_bf16 v[12:15], a[140:143], a[84:87], v[12:15]
  v_mfma_f32_16x16x32_bf16 v[16:19], a[196:199], a[84:87], v[16:19]
  v_mfma_f32_16x16x32_bf16 v[8:11], a[144:147], a[32:35], v[8:11]
  v_mfma_f32_16x16x32_bf16 v[12:15], a[144:147], a[88:91], v[12:15]
  v_mfma_f32_16x16x32_bf16 v[16:19], a[200:203], a[88:91], v[16:19]
  v_mfma_f32_16x16x32_bf16 v[8:11], a[148:151], a[36:39], v[8:11]
  v_mfma_f32_16x16x32_bf16 v[12:15], a[148:151], a[92:95], v[12:15]
  v_mfma_f32_16x16x32_bf16 v[16:19], a[204:207], a[92:95], v[16:19]
  v_mfma_f32_16x16x32_bf16 v[8:11], a[152:155], a[40:43], v[8:11]
  v_mfma_f32_16x16x32_bf16 v[12:15], a[152:155], a[96:99], v[12:15]
  v_mfma_f32_16x16x32_bf16 v[16:19], a[208:211], a[96:99], v[16:19]
  v_mfma_f32_16x16x32_bf16 v[8:11], a[156:159], a[44:47], v[8:11]
  v_mfma_f32_16x16x32_bf16 v[12:15], a[156:159], a[100:103], v[12:15]
  v_mfma_f32_16x16x32_bf16 v[16:19], a[212:215], a[100:103], v[16:19]
  v_mfma_f32_16x16x32_bf16 v[8:11], a[160:163], a[48:51], v[8:11]
  v_mfma_f32_16x16x32_bf16 v[12:15], a[160:163], a[104:107], v[12:15]
  v_mfma_f32_16x16x32_bf16 v[16:19], a[216:219], a[104:107], v[16:19]
  v_mfma_f32_16x16x32_bf16 v[8:11], a[164:167], a[52:55], v[8:11]
  v_mfma_f32_16x16x32_bf16 v[12:15], a[164:167], a[108:111], v[12:15]
  v_mfma_f32_16x16x32_bf16 v[16:19], a[220:223], a[108:111], v[16:19]
  s_mul_i32 s22, s20, 448
  s_add_u32 s22, s22, s24
  s_mov_b32 s31, 0
  v_mov_b32 v62, s22
  s_mov_b32 s30, 0
wp_pm:
  s_cmp_ge_u32 s17, 64
  s_cbranch_scc1 wp_pf
  buffer_load_dword v61, v62, s[8:11], 0 offen sc1
  s_waitcnt vmcnt(0)
  v_subrev_u32 v61, s31, v61
  v_cmp_eq_u32 vcc, -1, v61
  s_cbranch_vccnz wp_pr
wp_pf:
  s_add_u32 s22, s24, 4096
  buffer_load_dwordx4 v[64:67], v2, s[8:11], s24 offen offset:0 sc1
  buffer_load_dwordx4 v[68:71], v2, s[8:11], s24 offen offset:1024 sc1
  buffer_load_dwordx4 v[72:75], v2, s[8:11], s24 offen offset:2048 sc1
  buffer_load_dwordx4 v[76:79], v2, s[8:11], s24 offen offset:3072 sc1
  buffer_load_dwordx4 v[80:83], v2, s[8:11], s22 offen offset:0 sc1
  buffer_load_dwordx4 v[84:87], v2, s[8:11], s22 offen offset:1024 sc1
  buffer_load_dwordx4 v[88:91], v2, s[8:11], s22 offen offset:2048 sc1
  s_waitcnt vmcnt(0)
  v_max_u32 v61, v64, v65
  v_max3_u32 v61, v61, v66, v67
  v_max3_u32 v61, v61, v68, v69
  v_max3_u32 v61, v61, v70, v71
  v_max3_u32 v61, v61, v72, v73
  v_max3_u32 v61, v61, v74, v75
  v_max3_u32 v61, v61, v76, v77
  v_max3_u32 v61, v61, v78, v79
  v_max3_u32 v61, v61, v80, v81
  v_max3_u32 v61, v61, v82, v83
  v_max3_u32 v61, v61, v84, v85
  v_max3_u32 v61, v61, v86, v87
  v_max3_u32 v61, v61, v88, v89
  v_max3_u32 v61, v61, v90, v91
  v_cmp_eq_u32 vcc, -1, v61
  s_cbranch_vccz wp_pk
  s_add_u32 s30, s30, 1
  s_cmp_eq_u32 s31, 0
  s_cbranch_scc1 wp_pr
  s_cmp_lt_u32 s30, 2000000
  s_cbranch_scc1 wp_pf
wp_pr:
  s_sleep 4
  s_cmp_ge_u32 s17, 50
  s_cbranch_scc1 wp_pm_bo
  s_sleep 64
wp_pm_bo:
  s_add_u32 s30, s30, 1
  s_cmp_lt_u32 s30, 2000000
  s_cbranch_scc1 wp_pm
  s_branch wp_abort
wp_pk:
  buffer_load_dword v250, v251, s[8:11], 0 offen sc1
  v_mfma_f32_16x16x32_bf16 v[20:23], v[64:67], a[0:3], 0
  v_mfma_f32_16x16x32_bf16 v[24:27], v[64:67], a[4:7], 0
  v_mfma_f32_16x16x32_bf16 v[28:31], v[64:67], a[56:59], 0
  v_mfma_f32_16x16x32_bf16 v[32:35], v[64:67], a[60:63], 0
  v_mfma_f32_16x16x32_bf16 v[20:23], v[68:71], a[8:11], v[20:23]
  v_mfma_f32_16x16x32_bf16 v[24:27], v[68:71], a[12:15], v[24:27]
  v_mfma_f32_16x16x32_bf16 v[28:31], v[68:71], a[64:67], v[28:31]
  v_mfma_f32_16x16x32_bf16 v[32:35], v[68:71], a[68:71], v[32:35]
  v_mfma_f32_16x16x32_bf16 v[20:23], v[72:75], a[16:19], v[20:23]
  v_mfma_f32_16x16x32_bf16 v[24:27], v[72:75], a[20:23], v[24:27]
  v_mfma_f32_16x16x32_bf16 v[28:31], v[72:75], a[72:75], v[28:31]
  v_mfma_f32_16x16x32_bf16 v[32:35], v[72:75], a[76:79], v[32:35]
  v_mfma_f32_16x16x32_bf16 v[20:23], v[76:79], a[24:27], v[20:23]
  v_mfma_f32_16x16x32_bf16 v[24:27], v[76:79], a[28:31], v[24:27]
  v_mfma_f32_16x16x32_bf16 v[28:31], v[76:79], a[80:83], v[28:31]
  v_mfma_f32_16x16x32_bf16 v[32:35], v[76:79], a[84:87], v[32:35]
  v_mfma_f32_16x16x32_bf16 v[20:23], v[80:83], a[32:35], v[20:23]
  v_mfma_f32_16x16x32_bf16 v[24:27], v[80:83], a[36:39], v[24:27]
  v_mfma_f32_16x16x32_bf16 v[28:31], v[80:83], a[88:91], v[28:31]
  v_mfma_f32_16x16x32_bf16 v[32:35], v[80:83], a[92:95], v[32:35]
  v_mfma_f32_16x16x32_bf16 v[20:23], v[84:87], a[40:43], v[20:23]
  v_mfma_f32_16x16x32_bf16 v[24:27], v[84:87], a[44:47], v[24:27]
  v_mfma_f32_16x16x32_bf16 v[28:31], v[84:87], a[96:99], v[28:31]
  v_mfma_f32_16x16x32_bf16 v[32:35], v[84:87], a[100:103], v[32:35]
  v_mfma_f32_16x16x32_bf16 v[20:23], v[88:91], a[48:51], v[20:23]
  v_mfma_f32_16x16x32_bf16 v[24:27], v[88:91], a[52:55], v[24:27]
  v_mfma_f32_16x16x32_bf16 v[28:31], v[88:91], a[104:107], v[28:31]
  v_mfma_f32_16x16x32_bf16 v[32:35], v[88:91], a[108:111], v[32:35]
  v_cndmask_b32 v8, v6, v8, s[40:41]
  v_cndmask_b32 v9, v6, v9, s[42:43]
  v_cndmask_b32 v10, v6, v10, s[44:45]
  v_cndmask_b32 v11, v6, v11, s[46:47]
  v_cndmask_b32 v20, v24, v20, s[48:49]
  v_cndmask_b32 v21, v25, v21, s[48:49]
  v_cndmask_b32 v22, v26, v22, s[48:49]
  v_cndmask_b32 v23, v27, v23, s[48:49]
  v_mov_b32 v24, v20
  v_mov_b32 v25, v21
  v_mov_b32 v26, v22
  v_mov_b32 v27, v23
  v_permlane32_swap_b32 v20, v24
  v_permlane32_swap_b32 v21, v25
  v_permlane32_swap_b32 v22, v26
  v_permlane32_swap_b32 v23, v27
  v_add_f32 v20, v20, v24
  v_add_f32 v21, v21, v25
  v_add_f32 v22, v22, v26
  v_add_f32 v23, v23, v27
  v_max3_f32 v40, v8, v9, v10
  v_max3_f32 v40, v40, v11, v20
  v_max3_f32 v40, v40, v21, v22
  v_max_f32 v40, v40, v23
  v_mov_b32 v41, v40
  s_nop 1
  v_permlane16_swap_b32 v40, v41
  v_max_f32 v40, v40, v41
  v_mov_b32 v41, v40
  s_nop 1
  v_permlane32_swap_b32 v40, v41
  v_max_f32 v40, v40, v41
  v_sub_f32 v8, v8, v40
  v_sub_f32 v9, v9, v40
  v_sub_f32 v10, v10, v40
  v_sub_f32 v11, v11, v40
  v_sub_f32 v20, v20, v40
  v_sub_f32 v21, v21, v40
  v_sub_f32 v22, v22, v40
  v_sub_f32 v23, v23, v40
  v_exp_f32 v8, v8
  v_exp_f32 v9, v9
  v_exp_f32 v10, v10
  v_exp_f32 v11, v11
  v_exp_f32 v20, v20
  v_exp_f32 v21, v21
  v_exp_f32 v22, v22
  v_exp_f32 v23, v23
  v_add_f32 v42, v20, v21
  v_add_f32 v43, v22, v23
  v_add_f32 v42, v42, v43
  v_mul_f32 v42, 0.5, v42
  v_add_f32 v42, v42, v8
  v_add_f32 v42, v42, v9
  v_add_f32 v42, v42, v10
  v_add_f32 v42, v42, v11
  v_mov_b32 v41, v42
  s_nop 1
  v_permlane16_swap_b32 v42, v41
  v_add_f32 v42, v42, v41
  v_mov_b32 v41, v42
  s_nop 1
  v_permlane32_swap_b32 v42, v41
  v_add_f32 v42, v42, v41
  v_rcp_f32 v42, v42
  s_nop 0
  v_mul_f32 v8, v8, v42
  v_mul_f32 v9, v9, v42
  v_mul_f32 v10, v10, v42
  v_mul_f32 v11, v11, v42
  v_mul_f32 v20, v20, v42
  v_mul_f32 v21, v21, v42
  v_mul_f32 v22, v22, v42
  v_mul_f32 v23, v23, v42
  v_cvt_pk_bf16_f32 v44, v8, 0
  v_cvt_pk_bf16_f32 v45, v9, 0
  v_cvt_pk_bf16_f32 v46, v10, 0
  v_cvt_pk_bf16_f32 v47, v11, 0
  v_cvt_pk_bf16_f32 v48, v20, v21
  v_cvt_pk_bf16_f32 v49, v22, v23
  v_min_u32 v44, -2, v44
  v_min_u32 v45, -2, v45
  v_min_u32 v46, -2, v46
  v_min_u32 v47, -2, v47
  v_min_u32 v48, -2, v48
  v_min_u32 v49, -2, v49
  buffer_store_dwordx4 v[44:47], v2, s[8:11], s26 offen sc1
  s_mov_b64 exec, s[50:51]
  buffer_store_dwordx2 v[48:49], v2, s[8:11], s27 offen sc1
  s_mov_b64 exec, -1
  s_add_u32 s26, s26, 20480
  s_add_u32 s27, s27, 20480
  v_cndmask_b32 v16, v6, v16, s[40:41]
  v_cndmask_b32 v17, v6, v17, s[42:43]
  v_cndmask_b32 v18, v6, v18, s[44:45]
  v_cndmask_b32 v19, v6, v19, s[46:47]
  v_cndmask_b32 v28, v32, v28, s[48:49]
  v_cndmask_b32 v29, v33, v29, s[48:49]
  v_cndmask_b32 v30, v34, v30, s[48:49]
  v_cndmask_b32 v31, v35, v31, s[48:49]
  v_mov_b32 v32, v28
  v_mov_b32 v33, v29
  v_mov_b32 v34, v30
  v_mov_b32 v35, v31
  v_permlane32_swap_b32 v28, v32
  v_permlane32_swap_b32 v29, v33
  v_permlane32_swap_b32 v30, v34
  v_permlane32_swap_b32 v31, v35
  v_add_f32 v28, v28, v32
  v_add_f32 v29, v29, v33
  v_add_f32 v30, v30, v34
  v_add_f32 v31, v31, v35
  v_max3_f32 v40, v12, v13, v14
  v_max3_f32 v40, v40, v15, v16
  v_max3_f32 v40, v40, v17, v18
  v_max3_f32 v40, v40, v19, v28
  v_max3_f32 v40, v40, v29, v30
  v_max_f32 v40, v40, v31
  v_mov_b32 v41, v40
  s_nop 1
  v_permlane16_swap_b32 v40, v41
  v_max_f32 v40, v40, v41
  v_mov_b32 v41, v40
  s_nop 1
  v_permlane32_swap_b32 v40, v41
  v_max_f32 v40, v40, v41
  v_sub_f32 v12, v12, v40
  v_sub_f32 v13, v13, v40
  v_sub_f32 v14, v14, v40
  v_sub_f32 v15, v15, v40
  v_sub_f32 v16, v16, v40
  v_sub_f32 v17, v17, v40
  v_sub_f32 v18, v18, v40
  v_sub_f32 v19, v19, v40
  v_sub_f32 v28, v28, v40
  v_sub_f32 v29, v29, v40
  v_sub_f32 v30, v30, v40
  v_sub_f32 v31, v31, v40
  v_exp_f32 v12, v12
  v_exp_f32 v13, v13
  v_exp_f32 v14, v14
  v_exp_f32 v15, v15
  v_exp_f32 v16, v16
  v_exp_f32 v17, v17
  v_exp_f32 v18, v18
  v_exp_f32 v19, v19
  v_exp_f32 v28, v28
  v_exp_f32 v29, v29
  v_exp_f32 v30, v30
  v_exp_f32 v31, v31
  v_add_f32 v42, v28, v29
  v_add_f32 v43, v30, v31
  v_add_f32 v42, v42, v43
  v_mul_f32 v42, 0.5, v42
  v_add_f32 v42, v42, v12
  v_add_f32 v42, v42, v13
  v_add_f32 v42, v42, v14
  v_add_f32 v42, v42, v15
  v_add_f32 v42, v42, v16
  v_add_f32 v42, v42, v17
  v_add_f32 v42, v42, v18
  v_add_f32 v42, v42, v19
  v_mov_b32 v41, v42
  s_nop 1
  v_permlane16_swap_b32 v42, v41
  v_add_f32 v42, v42, v41
  v_mov_b32 v41, v42
  s_nop 1
  v_permlane32_swap_b32 v42, v41
  v_add_f32 v42, v42, v41
  v_rcp_f32 v42, v42
  s_nop 0
  v_mul_f32 v12, v12, v42
  v_mul_f32 v13, v13, v42
  v_mul_f32 v14, v14, v42
  v_mul_f32 v15, v15, v42
  v_mul_f32 v16, v16, v42
  v_mul_f32 v17, v17, v42
  v_mul_f32 v18, v18, v42
  v_mul_f32 v19, v19, v42
  v_mul_f32 v28, v28, v42
  v_mul_f32 v29, v29, v42
  v_mul_f32 v30, v30, v42
  v_mul_f32 v31, v31, v42
  v_cvt_pk_bf16_f32 v52, v12, v16
  v_cvt_pk_bf16_f32 v53, v13, v17
  v_cvt_pk_bf16_f32 v54, v14, v18
  v_cvt_pk_bf16_f32 v55, v15, v19
  v_cvt_pk_bf16_f32 v56, v28, v29
  v_cvt_pk_bf16_f32 v57, v30, v31
  v_min_u32 v52, -2, v52
  v_min_u32 v53, -2, v53
  v_min_u32 v54, -2, v54
  v_min_u32 v55, -2, v55
  v_min_u32 v56, -2, v56
  v_min_u32 v57, -2, v57
  buffer_store_dwordx4 v[52:55], v2, s[8:11], s26 offen sc1
  s_mov_b64 exec, s[50:51]
  buffer_store_dwordx2 v[56:57], v2, s[8:11], s27 offen sc1
  s_mov_b64 exec, -1
  s_branch wk_loop
wk_toko:
  s_load_dwordx2 s[36:37], s[0:1], 112
  s_waitcnt lgkmcnt(0)
  s_mov_b32 s92, s36
  s_and_b32 s93, s37, 0xffff
  s_mov_b32 s94, 3670016
  s_mov_b32 s95, 0x20000
  s_lshl_b32 s20, s18, 2
  s_add_u32 s20, s20, s16
  s_mul_i32 s24, s20, 65
  s_add_u32 s24, s24, s17
  s_lshl_b32 s24, s24, 13
  s_add_u32 s24, s24, 77602816
  s_mul_i32 s21, s20, 28672
  s_mul_i32 s22, s17, 458752
  s_add_u32 s21, s21, s22
  s_add_u32 s21, s21, 2490368
  s_lshl_b32 s25, s17, 1
  s_mul_i32 s25, s25, 20480
  s_add_u32 s25, s25, 86114304
  v_mov_b32 v5, v2
  v_min_u32 v6, 11, v4
  v_mad_u32_u24 v6, v3, 12, v6
  v_lshlrev_b32 v6, 4, v6
  v_add_u32 v6, 1024, v6
  v_lshrrev_b32 v8, 1, v3
  v_lshl_add_u32 v8, v8, 4, v4
  v_lshlrev_b32 v8, 4, v8
  v_and_b32 v9, 1, v3
  v_lshl_add_u32 v7, v9, 3, v8
  s_lshr_b32 s26, s17, 3
  s_lshl_b32 s26, s26, 4
  s_add_u32 s26, s26, s20
  s_lshl_b32 s26, s26, 7
  s_add_u32 s26, s26, 524288
  v_mov_b32 v60, 0
  s_mov_b32 s30, 0
wo_wv:
  buffer_load_dword v61, v60, s[8:11], s26 offen sc1
  s_waitcnt vmcnt(0)
  v_cmp_ne_u32 vcc, 56, v61
  s_cbranch_vccz wo_wv_ok
  s_sleep 4
  s_cmp_ge_u32 s17, 50
  s_cbranch_scc1 wo_wv_bo
  s_sleep 64
wo_wv_bo:
  s_add_u32 s30, s30, 1
  s_cmp_lt_u32 s30, 2000000
  s_cbranch_scc1 wo_wv
  s_branch wo_abort
wo_wv_ok:
  s_add_u32 s22, s21, 0
  buffer_load_dwordx4 a[0:3], v5, s[8:11], s22 offen offset:0 sc1
  buffer_load_dwordx4 a[4:7], v6, s[8:11], s22 offen offset:0 sc1
  buffer_load_dwordx4 a[8:11], v5, s[8:11], s22 offen offset:1792 sc1
  buffer_load_dwordx4 a[12:15], v6, s[8:11], s22 offen offset:1792 sc1
  s_add_u32 s22, s21, 3584
  buffer_load_dwordx4 a[16:19], v5, s[8:11], s22 offen offset:0 sc1
  buffer_load_dwordx4 a[20:23], v6, s[8:11], s22 offen offset:0 sc1
  buffer_load_dwordx4 a[24:27], v5, s[8:11], s22 offen offset:1792 sc1
  buffer_load_dwordx4 a[28:31], v6, s[8:11], s22 offen offset:1792 sc1
  s_add_u32 s22, s21, 7168
  buffer_load_dwordx4 a[32:35], v5, s[8:11], s22 offen offset:0 sc1
  buffer_load_dwordx4 a[36:39], v6, s[8:11], s22 offen offset:0 sc1
  buffer_load_dwordx4 a[40:43], v5, s[8:11], s22 offen offset:1792 sc1
  buffer_load_dwordx4 a[44:47], v6, s[8:11], s22 offen offset:1792 sc1
  s_add_u32 s22, s21, 10752
  buffer_load_dwordx4 a[48:51], v5, s[8:11], s22 offen offset:0 sc1
  buffer_load_dwordx4 a[52:55], v6, s[8:11], s22 offen offset:0 sc1
  buffer_load_dwordx4 a[56:59], v5, s[8:11], s22 offen offset:1792 sc1
  buffer_load_dwordx4 a[60:63], v6, s[8:11], s22 offen offset:1792 sc1
  s_add_u32 s22, s21, 14336
  buffer_load_dwordx4 a[64:67], v5, s[8:11], s22 offen offset:0 sc1
  buffer_load_dwordx4 a[68:71], v6, s[8:11], s22 offen offset:0 sc1
  buffer_load_dwordx4 a[72:75], v5, s[8:11], s22 offen offset:1792 sc1
  buffer_load_dwordx4 a[76:79], v6, s[8:11], s22 offen offset:1792 sc1
  s_add_u32 s22, s21, 17920
  buffer_load_dwordx4 a[80:83], v5, s[8:11], s22 offen offset:0 sc1
  buffer_load_dwordx4 a[84:87], v6, s[8:11], s22 offen offset:0 sc1
  buffer_load_dwordx4 a[88:91], v5, s[8:11], s22 offen offset:1792 sc1
  buffer_load_dwordx4 a[92:95], v6, s[8:11], s22 offen offset:1792 sc1
  s_add_u32 s22, s21, 21504
  buffer_load_dwordx4 a[96:99], v5, s[8:11], s22 offen offset:0 sc1
  buffer_load_dwordx4 a[100:103], v6, s[8:11], s22 offen offset:0 sc1
  buffer_load_dwordx4 a[104:107], v5, s[8:11], s22 offen offset:1792 sc1
  buffer_load_dwordx4 a[108:111], v6, s[8:11], s22 offen offset:1792 sc1
  s_add_u32 s22, s21, 25088
  buffer_load_dwordx4 a[112:115], v5, s[8:11], s22 offen offset:0 sc1
  buffer_load_dwordx4 a[116:119], v6, s[8:11], s22 offen offset:0 sc1
  buffer_load_dwordx4 a[120:123], v5, s[8:11], s22 offen offset:1792 sc1
  buffer_load_dwordx4 a[124:127], v6, s[8:11], s22 offen offset:1792 sc1
  s_and_b32 s27, s17, 1
  s_cmp_ge_u32 s17, 62
  s_cselect_b32 s27, s17, s27
  s_lshl_b32 s26, s20, 6
  s_add_u32 s26, s26, s27
  s_lshl_b32 s26, s26, 4
  s_add_u32 s26, s26, 565248
  v_lshlrev_b32 v60, 2, v3
  s_mov_b32 s30, 0
wo_wt:
  buffer_load_dword v61, v60, s[8:11], s26 offen sc1
  s_waitcnt vmcnt(0)
  v_cmp_ne_u32 vcc, 1, v61
  s_cbranch_vccz wo_wt_ok
  s_sleep 4
  s_cmp_ge_u32 s17, 50
  s_cbranch_scc1 wo_wt_bo
  s_sleep 64
wo_wt_bo:
  s_add_u32 s30, s30, 1
  s_cmp_lt_u32 s30, 2000000
  s_cbranch_scc1 wo_wt
  s_branch wo_abort
wo_wt_ok:
  v_mul_u32_u24 v9, 1792, v4
  v_lshl_add_u32 v9, v3, 3, v9
  s_lshl_b32 s22, s20, 5
  v_add_u32 v8, s22, v9
  s_mul_i32 s22, s20, 24
  s_add_u32 s22, s22, 512
  v_add_u32 v9, s22, v9
  v_mov_b32 v10, 0x40000000
  v_cmp_eq_u32 vcc, 3, v3
  s_nop 1
  v_cndmask_b32 v9, v9, v10, vcc
  s_mul_i32 s44, s17, 57344
  s_add_u32 s44, s44, 896
  s_add_u32 s45, s44, 28672
  s_lshl_b32 s26, s17, 7
  s_add_u32 s26, s26, 557056
  v_mov_b32 v60, 0
  s_mov_b32 s30, 0
wo_wp:
  buffer_load_dword v61, v60, s[8:11], s26 offen sc1
  s_waitcnt vmcnt(0)
  v_cmp_ne_u32 vcc, 16, v61
  s_cbranch_vccz wo_wp_ok
  s_sleep 4
  s_cmp_ge_u32 s17, 50
  s_cbranch_scc1 wo_wp_bo
  s_sleep 64
wo_wp_bo:
  s_add_u32 s30, s30, 1
  s_cmp_lt_u32 s30, 2000000
  s_cbranch_scc1 wo_wp
  s_branch wo_abort
wo_wp_ok:
  s_lshl_b32 s31, s16, 2
  s_add_u32 s31, s31, s26
  s_lshl_b32 s28, s16, 12
  s_add_u32 s26, s25, s28
  s_add_u32 s27, s26, 20480
  s_lshl_b32 s28, s16, 10
  s_add_u32 s28, s28, s25
  s_add_u32 s28, s28, 16384
  s_add_u32 s29, s28, 20480
  s_add_u32 s23, s24, 4096
  s_mov_b32 s30, 0
wo_ps:
  buffer_load_dword v61, off, s[8:11], s24 sc1
  buffer_load_dword v62, off, s[8:11], s26 sc1
  s_waitcnt vmcnt(0)
  v_max_u32 v61, v61, v62
  v_cmp_eq_u32 vcc, -1, v61
  s_cbranch_vccz wo_pl
  s_sleep 2
  s_cmp_ge_u32 s17, 50
  s_cbranch_scc1 wo_ps_bo
  s_sleep 64
wo_ps_bo:
  s_add_u32 s30, s30, 1
  s_cmp_lt_u32 s30, 2000000
  s_cbranch_scc1 wo_ps
  s_branch wo_abort
wo_pl:
  buffer_load_dword v250, v251, s[8:11], 0 offen sc1
  buffer_load_dwordx4 v[64:67], v2, s[8:11], s26 offen offset:0 sc1
  buffer_load_dwordx4 v[68:71], v2, s[8:11], s26 offen offset:1024 sc1
  buffer_load_dwordx4 v[72:75], v2, s[8:11], s26 offen offset:2048 sc1
  buffer_load_dwordx4 v[76:79], v2, s[8:11], s26 offen offset:3072 sc1
  buffer_load_dwordx4 v[80:83], v2, s[8:11], s28 offen sc1
  buffer_load_dwordx4 v[84:87], v2, s[8:11], s27 offen offset:0 sc1
  buffer_load_dwordx4 v[88:91], v2, s[8:11], s27 offen offset:1024 sc1
  buffer_load_dwordx4 v[92:95], v2, s[8:11], s27 offen offset:2048 sc1
  buffer_load_dwordx4 v[96:99], v2, s[8:11], s27 offen offset:3072 sc1
  buffer_load_dwordx4 v[100:103], v2, s[8:11], s29 offen sc1
  buffer_load_dwordx2 v[28:29], v7, s[8:11], s24 offen offset:0 sc1
  buffer_load_dwordx2 v[30:31], v7, s[8:11], s24 offen offset:512 sc1
  buffer_load_dwordx2 v[32:33], v7, s[8:11], s24 offen offset:1024 sc1
  buffer_load_dwordx2 v[34:35], v7, s[8:11], s24 offen offset:1536 sc1
  buffer_load_dwordx2 v[36:37], v7, s[8:11], s24 offen offset:2048 sc1
  buffer_load_dwordx2 v[38:39], v7, s[8:11], s24 offen offset:2560 sc1
  buffer_load_dwordx2 v[40:41], v7, s[8:11], s24 offen offset:3072 sc1
  buffer_load_dwordx2 v[42:43], v7, s[8:11], s24 offen offset:3584 sc1
  buffer_load_dwordx2 v[44:45], v7, s[8:11], s23 offen offset:0 sc1
  buffer_load_dwordx2 v[46:47], v7, s[8:11], s23 offen offset:512 sc1
  buffer_load_dwordx2 v[48:49], v7, s[8:11], s23 offen offset:1024 sc1
  buffer_load_dwordx2 v[50:51], v7, s[8:11], s23 offen offset:1536 sc1
  buffer_load_dwordx2 v[52:53], v7, s[8:11], s23 offen offset:2048 sc1
  buffer_load_dwordx2 v[54:55], v7, s[8:11], s23 offen offset:2560 sc1
  buffer_load_dwordx2 v[56:57], v7, s[8:11], s23 offen offset:3072 sc1
  buffer_load_dwordx2 v[58:59], v7, s[8:11], s23 offen offset:3584 sc1
  s_waitcnt vmcnt(16)
  v_max_u32 v61, v64, v65
  v_max3_u32 v61, v61, v66, v67
  v_max3_u32 v61, v61, v68, v69
  v_max3_u32 v61, v61, v70, v71
  v_max3_u32 v61, v61, v72, v73
  v_max3_u32 v61, v61, v74, v75
  v_max3_u32 v61, v61, v76, v77
  v_max3_u32 v61, v61, v78, v79
  v_max3_u32 v61, v61, v80, v81
  v_max3_u32 v61, v61, v82, v83
  v_max3_u32 v61, v61, v84, v85
  v_max3_u32 v61, v61, v86, v87
  v_max3_u32 v61, v61, v88, v89
  v_max3_u32 v61, v61, v90, v91
  v_max3_u32 v61, v61, v92, v93
  v_max3_u32 v61, v61, v94, v95
  v_max3_u32 v61, v61, v96, v97
  v_max3_u32 v61, v61, v98, v99
  v_max3_u32 v61, v61, v100, v101
  v_max3_u32 v61, v61, v102, v103
  s_mul_i32 s22, s16, 10240
  v_add_u32 v62, s22, v2
  ds_write_b128 v62, v[64:67] offset:0
  ds_write_b128 v62, v[68:71] offset:1024
  ds_write_b128 v62, v[72:75] offset:2048
  ds_write_b128 v62, v[76:79] offset:3072
  ds_write_b128 v62, v[80:83] offset:4096
  ds_write_b128 v62, v[84:87] offset:5120
  ds_write_b128 v62, v[88:91] offset:6144
  ds_write_b128 v62, v[92:95] offset:7168
  ds_write_b128 v62, v[96:99] offset:8192
  ds_write_b128 v62, v[100:103] offset:9216
  s_waitcnt vmcnt(0)
  v_max3_u32 v61, v61, v28, v29
  v_max3_u32 v61, v61, v30, v31
  v_max3_u32 v61, v61, v32, v33
  v_max3_u32 v61, v61, v34, v35
  v_max3_u32 v61, v61, v36, v37
  v_max3_u32 v61, v61, v38, v39
  v_max3_u32 v61, v61, v40, v41
  v_max3_u32 v61, v61, v42, v43
  v_max3_u32 v61, v61, v44, v45
  v_max3_u32 v61, v61, v46, v47
  v_max3_u32 v61, v61, v48, v49
  v_max3_u32 v61, v61, v50, v51
  v_max3_u32 v61, v61, v52, v53
  v_max3_u32 v61, v61, v54, v55
  v_max3_u32 v61, v61, v56, v57
  v_max3_u32 v61, v61, v58, v59
  v_cmp_eq_u32 vcc, -1, v61
  s_cbranch_vccz wo_pk
  s_waitcnt lgkmcnt(0)
  s_sleep 1
  s_add_u32 s30, s30, 1
  s_cmp_lt_u32 s30, 2000000
  s_cbranch_scc1 wo_pl
  s_branch wo_abort
wo_pk:
  s_lshl_b32 s22, s16, 2
  s_add_u32 s22, s22, 49152
  v_mov_b32 v63, s22
  ds_write_b32 v63, v250
  s_waitcnt lgkmcnt(0)
  s_barrier
  v_mov_b32 v63, 49152
  ds_read_b32 v250, v63
  ds_read_b128 v[64:67], v2 offset:0
  ds_read_b128 v[68:71], v2 offset:5120
  ds_read_b128 v[72:75], v2 offset:1024
  ds_read_b128 v[76:79], v2 offset:6144
  ds_read_b128 v[80:83], v2 offset:2048
  ds_read_b128 v[84:87], v2 offset:7168
  ds_read_b128 v[88:91], v2 offset:3072
  ds_read_b128 v[92:95], v2 offset:8192
  s_waitcnt lgkmcnt(7)
  v_mfma_f32_16x16x32_bf16 v[12:15], a[0:3], v[64:67], 0
  ds_read_b128 v[96:99], v2 offset:4096
  v_mfma_f32_16x16x32_bf16 v[20:23], a[4:7], v[64:67], 0
  s_waitcnt lgkmcnt(7)
  v_mfma_f32_16x16x32_bf16 v[16:19], a[0:3], v[68:71], 0
  ds_read_b128 v[100:103], v2 offset:9216
  v_mfma_f32_16x16x32_bf16 v[24:27], a[4:7], v[68:71], 0
  s_waitcnt lgkmcnt(7)
  v_mfma_f32_16x16x32_bf16 v[12:15], a[8:11], v[72:75], v[12:15]
  ds_read_b128 v[64:67], v2 offset:10240
  v_mfma_f32_16x16x32_bf16 v[20:23], a[12:15], v[72:75], v[20:23]
  s_waitcnt lgkmcnt(7)
  v_mfma_f32_16x16x32_bf16 v[16:19], a[8:11], v[76:79], v[16:19]
  ds_read_b128 v[68:71], v2 offset:15360
  v_mfma_f32_16x16x32_bf16 v[24:27], a[12:15], v[76:79], v[24:27]
  s_waitcnt lgkmcnt(7)
  v_mfma_f32_16x16x32_bf16 v[12:15], a[16:19], v[80:83], v[12:15]
  ds_read_b128 v[72:75], v2 offset:11264
  v_mfma_f32_16x16x32_bf16 v[20:23], a[20:23], v[80:83], v[20:23]
  s_waitcnt lgkmcnt(7)
  v_mfma_f32_16x16x32_bf16 v[16:19], a[16:19], v[84:87], v[16:19]
  ds_read_b128 v[76:79], v2 offset:16384
  v_mfma_f32_16x16x32_bf16 v[24:27], a[20:23], v[84:87], v[24:27]
  s_waitcnt lgkmcnt(7)
  v_mfma_f32_16x16x32_bf16 v[12:15], a[24:27], v[88:91], v[12:15]
  ds_read_b128 v[80:83], v2 offset:12288
  v_mfma_f32_16x16x32_bf16 v[20:23], a[28:31], v[88:91], v[20:23]
  s_waitcnt lgkmcnt(7)
  v_mfma_f32_16x16x32_bf16 v[16:19], a[24:27], v[92:95], v[16:19]
  ds_read_b128 v[84:87], v2 offset:17408
  v_mfma_f32_16x16x32_bf16 v[24:27], a[28:31], v[92:95], v[24:27]
  s_waitcnt lgkmcnt(7)
  v_mfma_f32_16x16x32_bf16 v[12:15], v[28:31], v[96:99], v[12:15]
  ds_read_b128 v[88:91], v2 offset:13312
  v_mfma_f32_16x16x32_bf16 v[20:23], v[32:35], v[96:99], v[20:23]
  s_waitcnt lgkmcnt(7)
  v_mfma_f32_16x16x32_bf16 v[16:19], v[28:31], v[100:103], v[16:19]
  ds_read_b128 v[92:95], v2 offset:18432
  v_mfma_f32_16x16x32_bf16 v[24:27], v[32:35], v[100:103], v[24:27]
  s_waitcnt lgkmcnt(7)
  v_mfma_f32_16x16x32_bf16 v[12:15], a[32:35], v[64:67], v[12:15]
  ds_read_b128 v[96:99], v2 offset:14336
  v_mfma_f32_16x16x32_bf16 v[20:23], a[36:39], v[64:67], v[20:23]
  s_waitcnt lgkmcnt(7)
  v_mfma_f32_16x16x32_bf16 v[16:19], a[32:35], v[68:71], v[16:19]
  ds_read_b128 v[100:103], v2 offset:19456
  v_mfma_f32_16x16x32_bf16 v[24:27], a[36:39], v[68:71], v[24:27]
  s_waitcnt lgkmcnt(7)
  v_mfma_f32_16x16x32_bf16 v[12:15], a[40:43], v[72:75], v[12:15]
  ds_read_b128 v[64:67], v2 offset:20480
  v_mfma_f32_16x16x32_bf16 v[20:23], a[44:47], v[72:75], v[20:23]
  s_waitcnt lgkmcnt(7)
  v_mfma_f32_16x16x32_bf16 v[16:19], a[40:43], v[76:79], v[16:19]
  ds_read_b128 v[68:71], v2 offset:25600
  v_mfma_f32_16x16x32_bf16 v[24:27], a[44:47], v[76:79], v[24:27]
  s_waitcnt lgkmcnt(7)
  v_mfma_f32_16x16x32_bf16 v[12:15], a[48:51], v[80:83], v[12:15]
  ds_read_b128 v[72:75], v2 offset:21504
  v_mfma_f32_16x16x32_bf16 v[20:23], a[52:55], v[80:83], v[20:23]
  s_waitcnt lgkmcnt(7)
  v_mfma_f32_16x16x32_bf16 v[16:19], a[48:51], v[84:87], v[16:19]
  ds_read_b128 v[76:79], v2 offset:26624
  v_mfma_f32_16x16x32_bf16 v[24:27], a[52:55], v[84:87], v[24:27]
  s_waitcnt lgkmcnt(7)
  v_mfma_f32_16x16x32_bf16 v[12:15], a[56:59], v[88:91], v[12:15]
  ds_read_b128 v[80:83], v2 offset:22528
  v_mfma_f32_16x16x32_bf16 v[20:23], a[60:63], v[88:91], v[20:23]
  s_waitcnt lgkmcnt(7)
  v_mfma_f32_16x16x32_bf16 v[16:19], a[56:59], v[92:95], v[16:19]
  ds_read_b128 v[84:87], v2 offset:27648
  v_mfma_f32_16x16x32_bf16 v[24:27], a[60:63], v[92:95], v[24:27]
  s_waitcnt lgkmcnt(7)
  v_mfma_f32_16x16x32_bf16 v[12:15], v[36:39], v[96:99], v[12:15]
  ds_read_b128 v[88:91], v2 offset:23552
  v_mfma_f32_16x16x32_bf16 v[20:23], v[40:43], v[96:99], v[20:23]
  s_waitcnt lgkmcnt(7)
  v_mfma_f32_16x16x32_bf16 v[16:19], v[36:39], v[100:103], v[16:19]
  ds_read_b128 v[92:95], v2 offset:28672
  v_mfma_f32_16x16x32_bf16 v[24:27], v[40:43], v[100:103], v[24:27]
  s_waitcnt lgkmcnt(7)
  v_mfma_f32_16x16x32_bf16 v[12:15], a[64:67], v[64:67], v[12:15]
  ds_read_b128 v[96:99], v2 offset:24576
  v_mfma_f32_16x16x32_bf16 v[20:23], a[68:71], v[64:67], v[20:23]
  s_waitcnt lgkmcnt(7)
  v_mfma_f32_16x16x32_bf16 v[16:19], a[64:67], v[68:71], v[16:19]
  ds_read_b128 v[100:103], v2 offset:29696
  v_mfma_f32_16x16x32_bf16 v[24:27], a[68:71], v[68:71], v[24:27]
  s_waitcnt lgkmcnt(7)
  v_mfma_f32_16x16x32_bf16 v[12:15], a[72:75], v[72:75], v[12:15]
  ds_read_b128 v[64:67], v2 offset:30720
  v_mfma_f32_16x16x32_bf16 v[20:23], a[76:79], v[72:75], v[20:23]
  s_waitcnt lgkmcnt(7)
  v_mfma_f32_16x16x32_bf16 v[16:19], a[72:75], v[76:79], v[16:19]
  ds_read_b128 v[68:71], v2 offset:35840
  v_mfma_f32_16x16x32_bf16 v[24:27], a[76:79], v[76:79], v[24:27]
  s_waitcnt lgkmcnt(7)
  v_mfma_f32_16x16x32_bf16 v[12:15], a[80:83], v[80:83], v[12:15]
  ds_read_b128 v[72:75], v2 offset:31744
  v_mfma_f32_16x16x32_bf16 v[20:23], a[84:87], v[80:83], v[20:23]
  s_waitcnt lgkmcnt(7)
  v_mfma_f32_16x16x32_bf16 v[16:19], a[80:83], v[84:87], v[16:19]
  ds_read_b128 v[76:79], v2 offset:36864
  v_mfma_f32_16x16x32_bf16 v[24:27], a[84:87], v[84:87], v[24:27]
  s_waitcnt lgkmcnt(7)
  v_mfma_f32_16x16x32_bf16 v[12:15], a[88:91], v[88:91], v[12:15]
  ds_read_b128 v[80:83], v2 offset:32768
  v_mfma_f32_16x16x32_bf16 v[20:23], a[92:95], v[88:91], v[20:23]
  s_waitcnt lgkmcnt(7)
  v_mfma_f32_16x16x32_bf16 v[16:19], a[88:91], v[92:95], v[16:19]
  ds_read_b128 v[84:87], v2 offset:37888
  v_mfma_f32_16x16x32_bf16 v[24:27], a[92:95], v[92:95], v[24:27]
  s_waitcnt lgkmcnt(7)
  v_mfma_f32_16x16x32_bf16 v[12:15], v[44:47], v[96:99], v[12:15]
  ds_read_b128 v[88:91], v2 offset:33792
  v_mfma_f32_16x16x32_bf16 v[20:23], v[48:51], v[96:99], v[20:23]
  s_waitcnt lgkmcnt(7)
  v_mfma_f32_16x16x32_bf16 v[16:19], v[44:47], v[100:103], v[16:19]
  ds_read_b128 v[92:95], v2 offset:38912
  v_mfma_f32_16x16x32_bf16 v[24:27], v[48:51], v[100:103], v[24:27]
  s_waitcnt lgkmcnt(7)
  v_mfma_f32_16x16x32_bf16 v[12:15], a[96:99], v[64:67], v[12:15]
  ds_read_b128 v[96:99], v2 offset:34816
  v_mfma_f32_16x16x32_bf16 v[20:23], a[100:103], v[64:67], v[20:23]
  s_waitcnt lgkmcnt(7)
  v_mfma_f32_16x16x32_bf16 v[16:19], a[96:99], v[68:71], v[16:19]
  ds_read_b128 v[100:103], v2 offset:39936
  v_mfma_f32_16x16x32_bf16 v[24:27], a[100:103], v[68:71], v[24:27]
  s_waitcnt lgkmcnt(7)
  v_mfma_f32_16x16x32_bf16 v[12:15], a[104:107], v[72:75], v[12:15]
  v_mfma_f32_16x16x32_bf16 v[20:23], a[108:111], v[72:75], v[20:23]
  s_waitcnt lgkmcnt(6)
  v_mfma_f32_16x16x32_bf16 v[16:19], a[104:107], v[76:79], v[16:19]
  v_mfma_f32_16x16x32_bf16 v[24:27], a[108:111], v[76:79], v[24:27]
  s_waitcnt lgkmcnt(5)
  v_mfma_f32_16x16x32_bf16 v[12:15], a[112:115], v[80:83], v[12:15]
  v_mfma_f32_16x16x32_bf16 v[20:23], a[116:119], v[80:83], v[20:23]
  s_waitcnt lgkmcnt(4)
  v_mfma_f32_16x16x32_bf16 v[16:19], a[112:115], v[84:87], v[16:19]
  v_mfma_f32_16x16x32_bf16 v[24:27], a[116:119], v[84:87], v[24:27]
  s_waitcnt lgkmcnt(3)
  v_mfma_f32_16x16x32_bf16 v[12:15], a[120:123], v[88:91], v[12:15]
  v_mfma_f32_16x16x32_bf16 v[20:23], a[124:127], v[88:91], v[20:23]
  s_waitcnt lgkmcnt(2)
  v_mfma_f32_16x16x32_bf16 v[16:19], a[120:123], v[92:95], v[16:19]
  v_mfma_f32_16x16x32_bf16 v[24:27], a[124:127], v[92:95], v[24:27]
  s_waitcnt lgkmcnt(1)
  v_mfma_f32_16x16x32_bf16 v[12:15], v[52:55], v[96:99], v[12:15]
  v_mfma_f32_16x16x32_bf16 v[20:23], v[56:59], v[96:99], v[20:23]
  s_waitcnt lgkmcnt(0)
  v_mfma_f32_16x16x32_bf16 v[16:19], v[52:55], v[100:103], v[16:19]
  v_mfma_f32_16x16x32_bf16 v[24:27], v[56:59], v[100:103], v[24:27]
  v_cvt_pk_bf16_f32 v108, v12, v13
  v_cvt_pk_bf16_f32 v109, v14, v15
  buffer_store_dwordx2 v[108:109], v8, s[92:95], s44 offen
  v_cvt_pk_bf16_f32 v110, v20, v21
  v_cvt_pk_bf16_f32 v111, v22, v23
  buffer_store_dwordx2 v[110:111], v9, s[92:95], s44 offen
  v_cvt_pk_bf16_f32 v112, v16, v17
  v_cvt_pk_bf16_f32 v113, v18, v19
  buffer_store_dwordx2 v[112:113], v8, s[92:95], s45 offen
  v_cvt_pk_bf16_f32 v114, v24, v25
  v_cvt_pk_bf16_f32 v115, v26, v27
  buffer_store_dwordx2 v[114:115], v9, s[92:95], s45 offen
  v_readfirstlane_b32 s22, v250
  s_cmp_ge_u32 s22, 1264
  s_cbranch_scc1 wk_done
  s_branch wk_loop
wp_abort:
wo_abort:
  s_branch cA_abort
wk_done:
ch_end:
  s_endpgm

.section .rodata,"a"
.p2align 6
.amdhsa_kernel main_kernel
  .amdhsa_next_free_vgpr 512
  .amdhsa_next_free_sgpr 102
  .amdhsa_accum_offset 256
  .amdhsa_group_segment_fixed_size 0
  .amdhsa_kernarg_size 136
  .amdhsa_user_sgpr_count 2
  .amdhsa_user_sgpr_kernarg_segment_ptr 1
  .amdhsa_system_sgpr_workgroup_id_x 1
.end_amdhsa_kernel
```

```asm
; @launch kernel=main_kernel grid=(256,1,1) block=(256,1,1) lds=163840
.amdgcn_target "amdgcn-amd-amdhsa--gfx950"
.text
.globl main_kernel
.p2align 8
.type main_kernel,@function
main_kernel:
  s_cmp_ge_u32 s2, 256
  s_cbranch_scc1 ch_end
  s_load_dwordx2 s[4:5], s[0:1], 120
  s_load_dwordx2 s[6:7], s[0:1], 128
  s_load_dwordx8 s[40:47], s[0:1], 72
  s_load_dwordx4 s[48:51], s[0:1], 56
  s_mov_b32 s32, 0
  s_getreg_b32 s3, hwreg(HW_REG_XCC_ID)
  s_and_b32 s3, s3, 15
  s_cmp_lg_u32 s3, 3
  s_cbranch_scc1 ch_pf
  s_cmp_lt_u32 s2, 224
  s_cbranch_scc1 ch_npf
ch_pf:
  s_getpc_b64 s[98:99]
pf_main_kernel_1:
  s_sub_u32 s98, s98, pf_main_kernel_1-main_kernel
  s_subb_u32 s99, s99, 0
  v_lshlrev_b32 v60, 7, v0
  v_min_u32 v61, ch_end-main_kernel-4, v60
  global_load_dword v62, v61, s[98:99]
  v_add_u32 v60, 32768, v60
  v_min_u32 v61, ch_end-main_kernel-4, v60
  global_load_dword v62, v61, s[98:99]
  v_add_u32 v60, 32768, v60
  v_min_u32 v61, ch_end-main_kernel-4, v60
  global_load_dword v62, v61, s[98:99]
  v_add_u32 v60, 32768, v60
  v_min_u32 v61, ch_end-main_kernel-4, v60
  global_load_dword v62, v61, s[98:99]
  v_add_u32 v60, 32768, v60
  v_min_u32 v61, ch_end-main_kernel-4, v60
  global_load_dword v62, v61, s[98:99]
  v_add_u32 v60, 32768, v60
ch_npf:
  v_lshrrev_b32 v1, 6, v0
  s_nop 0
  v_readfirstlane_b32 s16, v1
  s_waitcnt lgkmcnt(0)
  s_mov_b32 s8, s6
  s_and_b32 s9, s7, 0xffff
  s_mov_b32 s10, 0x10000000
  s_mov_b32 s11, 0x20000
  s_mov_b32 s12, s4
  s_and_b32 s13, s5, 0xffff
  s_mov_b32 s14, 256
  s_mov_b32 s15, 0x20000
  v_mov_b32 v252, 0x40000000
  v_cmp_eq_u32 vcc, 0, v0
  s_nop 1
  v_cndmask_b32 v252, v252, v0, vcc
  s_cmp_lg_u32 s3, 3
  s_cbranch_scc1 ch_worker
  s_mov_b32 s18, 0
  v_mov_b32 v249, 1
  s_mov_b64 exec, 1
  buffer_atomic_add v249, v252, s[12:15], 0 offen sc0
  s_mov_b64 exec, -1
  v_and_b32 v1, 63, v0
  v_lshlrev_b32 v2, 4, v1
  v_lshrrev_b32 v3, 4, v1
  v_and_b32 v4, 15, v1
  s_lshr_b32 s33, s2, 3
  s_lshl_b32 s27, s33, 2
  s_add_u32 s27, s27, s16
  s_lshl_b32 s27, s27, 13
  v_lshlrev_b32 v12, 7, v1
  s_mov_b32 s64, s42
  s_and_b32 s65, s43, 0xffff
  s_mov_b32 s66, 2097152
  s_mov_b32 s67, 0x20000
  s_mov_b32 s28, s27
  buffer_load_dword v13, v12, s[64:67], s28 offen
  s_add_u32 s28, s28, 1048576
  buffer_load_dword v13, v12, s[64:67], s28 offen
  s_add_u32 s28, s28, 1048576
  s_waitcnt vmcnt(2)
  v_readfirstlane_b32 s17, v249
  v_mov_b32 v6, 160032
  s_nop 0
  v_mov_b32 v7, s17
  s_barrier
  s_cmp_lg_u32 s16, 0
  s_cbranch_scc1 uni_2
  ds_write_b32 v6, v7
  s_waitcnt lgkmcnt(0)
uni_2:
  s_barrier
  ds_read_b32 v7, v6
  s_waitcnt lgkmcnt(0)
  v_readfirstlane_b32 s17, v7
  s_branch ch_got
ch_take:
  v_mov_b32 v5, 0
  v_mov_b32 v6, 160000
  s_barrier
  s_cmp_lg_u32 s16, 0
  s_cbranch_scc1 ch_el1
  s_mov_b64 exec, 1
  buffer_atomic_add v4, v5, s[12:15], 0 offen sc0
  s_waitcnt vmcnt(0)
  ds_write_b32 v6, v4
  s_waitcnt lgkmcnt(0)
  s_mov_b64 exec, -1
ch_el1:
  s_barrier
  ds_read_b32 v4, v6
  s_waitcnt lgkmcnt(0)
  v_readfirstlane_b32 s17, v4
ch_got:
  s_and_b32 s17, s17, 0xffff
  s_cmp_lt_u32 s17, 32
  s_cbranch_scc1 ch_role
  s_cmp_eq_u32 s18, 0
  s_cbranch_scc1 ch_worker
  v_and_b32 v1, 63, v0
  v_lshlrev_b32 v2, 4, v1
  v_lshrrev_b32 v3, 4, v1
  v_and_b32 v4, 15, v1
  s_branch wp_all
ch_role:
  v_and_b32 v1, 63, v0
  v_lshlrev_b32 v2, 4, v1
  v_lshrrev_b32 v3, 4, v1
  v_and_b32 v4, 15, v1
  s_cmp_lt_u32 s17, 16
  s_cbranch_scc1 ch_self
  s_cmp_lt_u32 s17, 24
  s_cbranch_scc1 ch_tch
  s_sub_u32 s33, s17, 24
  v_mov_b32 v10, 0x40000000
  v_mov_b32 v5, 1
  v_mov_b32 v148, 0
  v_mov_b32 v149, 0
  v_mov_b32 v150, 0
  v_mov_b32 v151, 0
  v_mov_b32 v152, -1
  v_mov_b32 v153, -1
  v_mov_b32 v154, -1
  v_mov_b32 v155, -1
  v_lshlrev_b32 v8, 4, v0
  s_mov_b32 s64, s48
  s_and_b32 s65, s49, 0xffff
  s_mov_b32 s66, 1835008
  s_mov_b32 s67, 0x20000
  s_lshl_b32 s21, s33, 2
  s_add_u32 s21, s21, s16
  s_lshr_b32 s22, s21, 1
  s_mul_i32 s22, s22, 14336
  s_and_b32 s24, s21, 1
  s_mul_i32 s24, s24, 448
  s_add_u32 s22, s22, s24
  s_mul_i32 s21, s21, 7168
  v_mul_u32_u24 v7, 896, v4
  v_lshl_add_u32 v7, v3, 4, v7
  buffer_load_dwordx4 v[64:67], v7, s[64:67], s22 offen offset:0
  buffer_load_dwordx4 v[68:71], v7, s[64:67], s22 offen offset:64
  buffer_load_dwordx4 v[72:75], v7, s[64:67], s22 offen offset:128
  buffer_load_dwordx4 v[76:79], v7, s[64:67], s22 offen offset:192
  buffer_load_dwordx4 v[80:83], v7, s[64:67], s22 offen offset:256
  buffer_load_dwordx4 v[84:87], v7, s[64:67], s22 offen offset:320
  buffer_load_dwordx4 v[88:91], v7, s[64:67], s22 offen offset:384
  s_mov_b32 s68, s50
  s_and_b32 s69, s51, 0xffff
  s_mov_b32 s70, 7168
  s_mov_b32 s71, 0x20000
  v_lshrrev_b32 v6, 3, v0
  v_min_u32 v6, 27, v6
  v_and_b32 v7, 7, v0
  v_mul_u32_u24 v9, 896, v7
  v_lshl_add_u32 v9, v6, 5, v9
  buffer_load_dwordx4 v[176:179], v9, s[68:71], 0 offen
  buffer_load_dwordx4 v[180:183], v9, s[68:71], 0 offen offset:16
  s_cmp_lg_u32 s33, 0
  s_cbranch_scc1 ch_ij_1
  s_mov_b32 s23, 582144
  buffer_store_dwordx4 v[148:151], v8, s[8:11], s23 offen sc1
  s_mov_b32 s23, 586240
  buffer_store_dwordx4 v[148:151], v8, s[8:11], s23 offen sc1
  s_waitcnt vmcnt(0)
  s_barrier
  buffer_store_dword v5, v252, s[12:15], 0 offen offset:128 sc1
ch_ij_1:
  s_waitcnt vmcnt(1)
  s_add_u32 s23, s21, 655360
  buffer_store_dwordx4 v[64:67], v2, s[8:11], s23 offen offset:0 sc1
  buffer_store_dwordx4 v[68:71], v2, s[8:11], s23 offen offset:1024 sc1
  buffer_store_dwordx4 v[72:75], v2, s[8:11], s23 offen offset:2048 sc1
  buffer_store_dwordx4 v[76:79], v2, s[8:11], s23 offen offset:3072 sc1
  s_add_u32 s23, s21, 659456
  buffer_store_dwordx4 v[80:83], v2, s[8:11], s23 offen offset:0 sc1
  buffer_store_dwordx4 v[84:87], v2, s[8:11], s23 offen offset:1024 sc1
  buffer_store_dwordx4 v[88:91], v2, s[8:11], s23 offen offset:2048 sc1
  s_waitcnt vmcnt(0)
  s_barrier
  s_cmp_lg_u32 s16, 0
  s_cbranch_scc1 ch_ij_x_e
  v_mov_b32 v6, 1
  s_mov_b64 exec, 1
  buffer_atomic_add v6, v252, s[12:15], 0 offen offset:4 sc0
  s_waitcnt vmcnt(0)
  v_readfirstlane_b32 s20, v6
  s_cmp_lg_u32 s20, 7
  s_cbranch_scc1 ch_ij_x_e0
  s_mov_b64 exec, 0xff
  v_lshlrev_b32 v6, 7, v0
  s_mov_b32 s20, 586240
  buffer_store_dword v5, v6, s[8:11], s20 offen offset:8 sc1
ch_ij_x_e0:
  s_mov_b64 exec, -1
ch_ij_x_e:
  s_lshl_b32 s20, s33, 12
  v_add_u32 v8, s20, v8
  s_mov_b32 s23, 524288
ch_ijlp_3:
  buffer_store_dwordx4 v[148:151], v8, s[8:11], s23 offen sc1
  s_add_u32 s23, s23, 32768
  s_cmp_lt_u32 s23, 557056
  s_cbranch_scc1 ch_ijlp_3
  v_cmp_gt_u32 vcc, 25088, v8
  s_nop 1
  v_cndmask_b32 v9, v10, v8, vcc
  buffer_store_dwordx4 v[148:151], v9, s[8:11], s23 offen sc1
  s_mov_b32 s23, 35328
  v_cmp_gt_u32 vcc, 6144, v8
  s_nop 1
  v_cndmask_b32 v9, v10, v8, vcc
  buffer_store_dwordx4 v[148:151], v9, s[8:11], s23 offen sc1
  s_mov_b32 s23, 7168
  v_cmp_gt_u32 vcc, 28160, v8
  s_nop 1
  v_cndmask_b32 v9, v10, v8, vcc
  buffer_store_dwordx4 v[152:155], v9, s[8:11], s23 offen sc1
  s_mov_b32 s23, 72704
ch_ijlp_4:
  buffer_store_dwordx4 v[152:155], v8, s[8:11], s23 offen sc1
  s_add_u32 s23, s23, 32768
  s_cmp_lt_u32 s23, 498688
  s_cbranch_scc1 ch_ijlp_4
  v_cmp_gt_u32 vcc, 25600, v8
  s_nop 1
  v_cndmask_b32 v9, v10, v8, vcc
  buffer_store_dwordx4 v[152:155], v9, s[8:11], s23 offen sc1
  s_cmp_lg_u32 s33, 1
  s_cbranch_scc1 ch_ij_nm
  v_lshrrev_b32 v6, 3, v0
  v_and_b32 v7, 7, v0
  v_lshlrev_b32 v8, 8, v6
  v_lshl_add_u32 v8, v7, 4, v8
  v_cmp_gt_u32 vcc, 28, v6
  s_nop 1
  v_cndmask_b32 v8, v10, v8, vcc
  s_waitcnt vmcnt(4)
  v_min_u32 v184, -2, v176
  v_min_u32 v188, -2, v177
  v_min_u32 v185, -2, v178
  v_min_u32 v189, -2, v179
  v_min_u32 v186, -2, v180
  v_min_u32 v190, -2, v181
  v_min_u32 v187, -2, v182
  v_min_u32 v191, -2, v183
  s_mov_b32 s23, 0
  buffer_store_dwordx4 v[184:187], v8, s[8:11], s23 offen sc1
  buffer_store_dwordx4 v[188:191], v8, s[8:11], s23 offen offset:128 sc1
  s_mov_b32 s23, 65536
  buffer_store_dwordx4 v[184:187], v8, s[8:11], s23 offen sc1
  buffer_store_dwordx4 v[188:191], v8, s[8:11], s23 offen offset:128 sc1
ch_ij_nm:
  s_waitcnt vmcnt(0)
  s_barrier
  s_cmp_lg_u32 s16, 0
  s_cbranch_scc1 ch_ij_e
  v_mov_b32 v6, 1
  s_mov_b64 exec, 1
  buffer_atomic_add v6, v252, s[12:15], 0 offen offset:12 sc0
  s_waitcnt vmcnt(0)
  v_readfirstlane_b32 s20, v6
  s_cmp_lg_u32 s20, 7
  s_cbranch_scc1 ch_ij_e0
  buffer_store_dword v5, v252, s[12:15], 0 offen offset:132 sc1
  s_mov_b64 exec, 0xff
  v_lshlrev_b32 v6, 7, v0
  s_mov_b32 s20, 586240
  buffer_store_dword v5, v6, s[8:11], s20 offen offset:4 sc1
ch_ij_e0:
  s_mov_b64 exec, -1
ch_ij_e:
  s_branch ch_role2
ch_tch:
  s_sub_u32 s33, s17, 16
  s_lshl_b32 s27, s33, 2
  s_add_u32 s27, s27, s16
  s_lshl_b32 s27, s27, 13
  v_lshlrev_b32 v12, 7, v1
  s_mov_b32 s64, s40
  s_and_b32 s65, s41, 0xffff
  s_mov_b32 s66, 2097152
  s_mov_b32 s67, 0x20000
  s_mov_b32 s28, s27
  buffer_load_dword v13, v12, s[64:67], s28 offen
  s_add_u32 s28, s28, 262144
  buffer_load_dword v13, v12, s[64:67], s28 offen
  s_add_u32 s28, s28, 262144
  buffer_load_dword v13, v12, s[64:67], s28 offen
  s_add_u32 s28, s28, 262144
  buffer_load_dword v13, v12, s[64:67], s28 offen
  s_add_u32 s28, s28, 262144
  buffer_load_dword v13, v12, s[64:67], s28 offen
  s_add_u32 s28, s28, 262144
  buffer_load_dword v13, v12, s[64:67], s28 offen
  s_add_u32 s28, s28, 262144
  buffer_load_dword v13, v12, s[64:67], s28 offen
  s_add_u32 s28, s28, 262144
  buffer_load_dword v13, v12, s[64:67], s28 offen
  s_add_u32 s28, s28, 262144
  s_branch ch_role2
ch_self:
  v_lshrrev_b32 v5, 5, v1
  v_and_b32 v6, 31, v1
  v_xor_b32 v8, v6, v5
  v_lshlrev_b32 v8, 4, v8
  v_lshl_add_u32 v16, v5, 13, v8
  v_xor_b32 v17, 32, v16
  v_xor_b32 v18, 64, v16
  v_xor_b32 v19, 96, v16
  v_xor_b32 v20, 128, v16
  v_xor_b32 v21, 160, v16
  v_xor_b32 v22, 192, v16
  v_xor_b32 v23, 224, v16
  s_lshl_b32 s20, s16, 6
  v_xor_b32 v26, s20, v16
  v_xor_b32 v27, 32, v26
  s_mov_b32 s60, s40
  s_and_b32 s61, s41, 0xffff
  s_mov_b32 s62, 3670016
  s_mov_b32 s63, 0x20000
  s_mov_b32 s56, s42
  s_and_b32 s57, s43, 0xffff
  s_mov_b32 s58, 3670016
  s_mov_b32 s59, 0x20000
  s_lshl_b32 s26, s17, 9
  s_lshl_b32 s27, s16, 19
  s_add_u32 s27, s27, s26
  s_lshl_b32 s25, s16, 15
  s_add_u32 s25, s25, 32768
  s_barrier
  s_add_u32 m0, s25, 0
  s_nop 0
  buffer_load_dwordx4 v16, s[56:59], s27 offen lds
  s_add_u32 s27, s27, 16384
  s_add_u32 m0, s25, 1024
  s_nop 0
  buffer_load_dwordx4 v16, s[56:59], s27 offen lds
  s_add_u32 s27, s27, 16384
  s_add_u32 m0, s25, 2048
  s_nop 0
  buffer_load_dwordx4 v17, s[56:59], s27 offen lds
  s_add_u32 s27, s27, 16384
  s_add_u32 m0, s25, 3072
  s_nop 0
  buffer_load_dwordx4 v17, s[56:59], s27 offen lds
  s_add_u32 s27, s27, 16384
  s_add_u32 m0, s25, 4096
  s_nop 0
  buffer_load_dwordx4 v16, s[56:59], s27 offen lds
  s_add_u32 s27, s27, 16384
  s_add_u32 m0, s25, 5120
  s_nop 0
  buffer_load_dwordx4 v16, s[56:59], s27 offen lds
  s_add_u32 s27, s27, 16384
  s_add_u32 m0, s25, 6144
  s_nop 0
  buffer_load_dwordx4 v17, s[56:59], s27 offen lds
  s_add_u32 s27, s27, 16384
  s_add_u32 m0, s25, 7168
  s_nop 0
  buffer_load_dwordx4 v17, s[56:59], s27 offen lds
  s_add_u32 s27, s27, 16384
  s_add_u32 m0, s25, 8192
  s_nop 0
  buffer_load_dwordx4 v18, s[56:59], s27 offen lds
  s_add_u32 s27, s27, 16384
  s_add_u32 m0, s25, 9216
  s_nop 0
  buffer_load_dwordx4 v18, s[56:59], s27 offen lds
  s_add_u32 s27, s27, 16384
  s_add_u32 m0, s25, 10240
  s_nop 0
  buffer_load_dwordx4 v19, s[56:59], s27 offen lds
  s_add_u32 s27, s27, 16384
  s_add_u32 m0, s25, 11264
  s_nop 0
  buffer_load_dwordx4 v19, s[56:59], s27 offen lds
  s_add_u32 s27, s27, 16384
  s_add_u32 m0, s25, 12288
  s_nop 0
  buffer_load_dwordx4 v18, s[56:59], s27 offen lds
  s_add_u32 s27, s27, 16384
  s_add_u32 m0, s25, 13312
  s_nop 0
  buffer_load_dwordx4 v18, s[56:59], s27 offen lds
  s_add_u32 s27, s27, 16384
  s_add_u32 m0, s25, 14336
  s_nop 0
  buffer_load_dwordx4 v19, s[56:59], s27 offen lds
  s_add_u32 s27, s27, 16384
  s_add_u32 m0, s25, 15360
  s_nop 0
  buffer_load_dwordx4 v19, s[56:59], s27 offen lds
  s_add_u32 s27, s27, 16384
  s_add_u32 m0, s25, 16384
  s_nop 0
  buffer_load_dwordx4 v20, s[56:59], s27 offen lds
  s_add_u32 s27, s27, 16384
  s_add_u32 m0, s25, 17408
  s_nop 0
  buffer_load_dwordx4 v20, s[56:59], s27 offen lds
  s_add_u32 s27, s27, 16384
  s_add_u32 m0, s25, 18432
  s_nop 0
  buffer_load_dwordx4 v21, s[56:59], s27 offen lds
  s_add_u32 s27, s27, 16384
  s_add_u32 m0, s25, 19456
  s_nop 0
  buffer_load_dwordx4 v21, s[56:59], s27 offen lds
  s_add_u32 s27, s27, 16384
  s_add_u32 m0, s25, 20480
  s_nop 0
  buffer_load_dwordx4 v20, s[56:59], s27 offen lds
  s_add_u32 s27, s27, 16384
  s_add_u32 m0, s25, 21504
  s_nop 0
  buffer_load_dwordx4 v20, s[56:59], s27 offen lds
  s_add_u32 s27, s27, 16384
  s_add_u32 m0, s25, 22528
  s_nop 0
  buffer_load_dwordx4 v21, s[56:59], s27 offen lds
  s_add_u32 s27, s27, 16384
  s_add_u32 m0, s25, 23552
  s_nop 0
  buffer_load_dwordx4 v21, s[56:59], s27 offen lds
  s_add_u32 s27, s27, 16384
  s_add_u32 m0, s25, 24576
  s_nop 0
  buffer_load_dwordx4 v22, s[56:59], s27 offen lds
  s_add_u32 s27, s27, 16384
  s_add_u32 m0, s25, 25600
  s_nop 0
  buffer_load_dwordx4 v22, s[56:59], s27 offen lds
  s_add_u32 s27, s27, 16384
  s_add_u32 m0, s25, 26624
  s_nop 0
  buffer_load_dwordx4 v23, s[56:59], s27 offen lds
  s_add_u32 s27, s27, 16384
  s_add_u32 m0, s25, 27648
  s_nop 0
  buffer_load_dwordx4 v23, s[56:59], s27 offen lds
  s_add_u32 s27, s27, 16384
  s_add_u32 m0, s25, 28672
  s_nop 0
  buffer_load_dwordx4 v22, s[56:59], s27 offen lds
  s_add_u32 s27, s27, 16384
  s_add_u32 m0, s25, 29696
  s_nop 0
  buffer_load_dwordx4 v22, s[56:59], s27 offen lds
  s_add_u32 s27, s27, 16384
  s_add_u32 m0, s25, 30720
  s_nop 0
  buffer_load_dwordx4 v23, s[56:59], s27 offen lds
  s_add_u32 s27, s27, 16384
  s_add_u32 m0, s25, 31744
  s_nop 0
  buffer_load_dwordx4 v23, s[56:59], s27 offen lds
  s_add_u32 s27, s27, 16384
  v_mov_b32 v14, v26
  v_mov_b32 v15, v27
  s_lshl_b32 s28, s16, 16
  s_add_u32 s28, s28, s26
  s_lshl_b32 s29, s16, 12
  s_add_u32 m0, s29, 0
  s_add_u32 s27, s28, 0
  buffer_load_dwordx4 v14, s[60:63], s27 offen lds
  s_add_u32 m0, s29, 1024
  s_add_u32 s27, s28, 16384
  buffer_load_dwordx4 v15, s[60:63], s27 offen lds
  s_add_u32 m0, s29, 2048
  s_add_u32 s27, s28, 32768
  buffer_load_dwordx4 v14, s[60:63], s27 offen lds
  s_add_u32 m0, s29, 3072
  s_add_u32 s27, s28, 49152
  buffer_load_dwordx4 v15, s[60:63], s27 offen lds
  s_add_u32 m0, s29, 16384
  s_add_u32 s27, s28, 262144
  buffer_load_dwordx4 v14, s[60:63], s27 offen lds
  s_add_u32 m0, s29, 17408
  s_add_u32 s27, s28, 278528
  buffer_load_dwordx4 v15, s[60:63], s27 offen lds
  s_add_u32 m0, s29, 18432
  s_add_u32 s27, s28, 294912
  buffer_load_dwordx4 v14, s[60:63], s27 offen lds
  s_add_u32 m0, s29, 19456
  s_add_u32 s27, s28, 311296
  buffer_load_dwordx4 v15, s[60:63], s27 offen lds
  v_lshrrev_b32 v7, 2, v4
  v_lshlrev_b32 v11, 4, v7
  v_lshlrev_b32 v7, 3, v7
  v_and_b32 v8, 3, v4
  v_add_u32 v7, v7, v8
  v_and_b32 v8, 2, v4
  v_lshl_add_u32 v11, v8, 1, v11
  v_and_b32 v8, 1, v4
  v_add_u32 v11, v11, v8
  v_or_b32 v10, 0, v3
  v_xor_b32 v10, v10, v4
  v_lshlrev_b32 v10, 4, v10
  v_lshl_add_u32 v248, v7, 9, v10
  v_add_u32 v252, 65536, v248
  v_add_u32 v16, 131072, v248
  v_lshl_add_u32 v10, v11, 9, v10
  v_add_u32 v20, s25, v10
  v_or_b32 v10, 4, v3
  v_xor_b32 v10, v10, v4
  v_lshlrev_b32 v10, 4, v10
  v_lshl_add_u32 v249, v7, 9, v10
  v_add_u32 v253, 65536, v249
  v_add_u32 v17, 131072, v249
  v_lshl_add_u32 v10, v11, 9, v10
  v_add_u32 v21, s25, v10
  v_or_b32 v10, 8, v3
  v_xor_b32 v10, v10, v4
  v_lshlrev_b32 v10, 4, v10
  v_lshl_add_u32 v250, v7, 9, v10
  v_add_u32 v254, 65536, v250
  v_add_u32 v18, 131072, v250
  v_lshl_add_u32 v10, v11, 9, v10
  v_add_u32 v22, s25, v10
  v_or_b32 v10, 12, v3
  v_xor_b32 v10, v10, v4
  v_lshlrev_b32 v10, 4, v10
  v_lshl_add_u32 v251, v7, 9, v10
  v_add_u32 v255, 65536, v251
  v_add_u32 v19, 131072, v251
  v_lshl_add_u32 v10, v11, 9, v10
  v_add_u32 v23, s25, v10
  v_mov_b32 v12, 1035512379
  v_lshlrev_b32 v6, 7, v1
  s_getpc_b64 s[98:99]
  global_load_dword v7, v6, s[98:99]
  s_waitcnt vmcnt(9)
  ds_read_b128 v[120:123], v20 offset:0
  ds_read_b128 v[124:127], v21 offset:0
  ds_read_b128 v[128:131], v22 offset:0
  ds_read_b128 v[132:135], v23 offset:0
  ds_read_b128 v[136:139], v20 offset:256
  ds_read_b128 v[140:143], v21 offset:256
  ds_read_b128 v[144:147], v22 offset:256
  ds_read_b128 v[148:151], v23 offset:256
  s_waitcnt lgkmcnt(8)
  ds_read_b128 v[152:155], v20 offset:1024
  ds_read_b128 v[156:159], v21 offset:1024
  ds_read_b128 v[160:163], v22 offset:1024
  ds_read_b128 v[164:167], v23 offset:1024
  ds_read_b128 v[168:171], v20 offset:1280
  ds_read_b128 v[172:175], v21 offset:1280
  ds_read_b128 v[176:179], v22 offset:1280
  ds_read_b128 v[180:183], v23 offset:1280
  s_waitcnt lgkmcnt(8)
  ds_read_b128 v[184:187], v20 offset:4096
  ds_read_b128 v[188:191], v21 offset:4096
  ds_read_b128 v[192:195], v22 offset:4096
  ds_read_b128 v[196:199], v23 offset:4096
  ds_read_b128 v[200:203], v20 offset:4352
  ds_read_b128 v[204:207], v21 offset:4352
  ds_read_b128 v[208:211], v22 offset:4352
  ds_read_b128 v[212:215], v23 offset:4352
  s_waitcnt lgkmcnt(8)
  ds_read_b128 v[216:219], v20 offset:5120
  ds_read_b128 v[220:223], v21 offset:5120
  ds_read_b128 v[224:227], v22 offset:5120
  ds_read_b128 v[228:231], v23 offset:5120
  ds_read_b128 v[232:235], v20 offset:5376
  ds_read_b128 v[236:239], v21 offset:5376
  ds_read_b128 v[240:243], v22 offset:5376
  ds_read_b128 v[244:247], v23 offset:5376
  s_waitcnt lgkmcnt(8)
  s_waitcnt vmcnt(4) lgkmcnt(0)
  s_barrier
  s_add_u32 m0, s29, 32768
  s_add_u32 s27, s28, 524288
  buffer_load_dwordx4 v14, s[60:63], s27 offen lds
  s_add_u32 m0, s29, 33792
  s_add_u32 s27, s28, 540672
  buffer_load_dwordx4 v15, s[60:63], s27 offen lds
  s_add_u32 m0, s29, 34816
  s_add_u32 s27, s28, 557056
  buffer_load_dwordx4 v14, s[60:63], s27 offen lds
  s_add_u32 m0, s29, 35840
  s_add_u32 s27, s28, 573440
  buffer_load_dwordx4 v15, s[60:63], s27 offen lds
  s_add_u32 m0, s29, 49152
  s_add_u32 s27, s28, 786432
  buffer_load_dwordx4 v14, s[60:63], s27 offen lds
  s_add_u32 m0, s29, 50176
  s_add_u32 s27, s28, 802816
  buffer_load_dwordx4 v15, s[60:63], s27 offen lds
  s_add_u32 m0, s29, 51200
  s_add_u32 s27, s28, 819200
  buffer_load_dwordx4 v14, s[60:63], s27 offen lds
  s_add_u32 m0, s29, 52224
  s_add_u32 s27, s28, 835584
  buffer_load_dwordx4 v15, s[60:63], s27 offen lds
  s_add_u32 m0, s29, 65536
  s_add_u32 s27, s28, 1048576
  buffer_load_dwordx4 v14, s[60:63], s27 offen lds
  s_add_u32 m0, s29, 66560
  s_add_u32 s27, s28, 1064960
  buffer_load_dwordx4 v15, s[60:63], s27 offen lds
  s_add_u32 m0, s29, 67584
  s_add_u32 s27, s28, 1081344
  buffer_load_dwordx4 v14, s[60:63], s27 offen lds
  s_add_u32 m0, s29, 68608
  s_add_u32 s27, s28, 1097728
  buffer_load_dwordx4 v15, s[60:63], s27 offen lds
  s_add_u32 m0, s29, 81920
  s_add_u32 s27, s28, 1310720
  buffer_load_dwordx4 v14, s[60:63], s27 offen lds
  s_add_u32 m0, s29, 82944
  s_add_u32 s27, s28, 1327104
  buffer_load_dwordx4 v15, s[60:63], s27 offen lds
  s_add_u32 m0, s29, 83968
  s_add_u32 s27, s28, 1343488
  buffer_load_dwordx4 v14, s[60:63], s27 offen lds
  s_add_u32 m0, s29, 84992
  s_add_u32 s27, s28, 1359872
  buffer_load_dwordx4 v15, s[60:63], s27 offen lds
  ds_read_b128 v[24:27], v248 offset:0
  ds_read_b128 v[28:31], v248 offset:2048
  ds_read_b128 v[32:35], v249 offset:0
  ds_read_b128 v[36:39], v249 offset:2048
  ds_read_b128 v[40:43], v250 offset:0
  ds_read_b128 v[44:47], v250 offset:2048
  s_waitcnt lgkmcnt(5)
  s_getpc_b64 s[98:99]
  s_add_u32 s98, s98, 4096
  s_addc_u32 s99, s99, 0
  global_load_dword v7, v6, s[98:99]
  v_mfma_f32_16x16x32_bf16 v[56:59], v[24:27], v[120:123], 0
  ds_read_b128 v[48:51], v251 offset:0
  v_mfma_f32_16x16x32_bf16 v[64:67], v[24:27], v[152:155], 0
  v_mfma_f32_16x16x32_bf16 v[72:75], v[24:27], v[184:187], 0
  s_add_u32 m0, s29, 98304
  s_add_u32 s27, s28, 1572864
  buffer_load_dwordx4 v14, s[60:63], s27 offen lds
  v_mfma_f32_16x16x32_bf16 v[80:83], v[24:27], v[216:219], 0
  s_waitcnt lgkmcnt(5)
  v_mfma_f32_16x16x32_bf16 v[60:63], v[28:31], v[120:123], 0
  ds_read_b128 v[52:55], v251 offset:2048
  v_mfma_f32_16x16x32_bf16 v[68:71], v[28:31], v[152:155], 0
  v_mfma_f32_16x16x32_bf16 v[76:79], v[28:31], v[184:187], 0
  v_mfma_f32_16x16x32_bf16 v[84:87], v[28:31], v[216:219], 0
  s_waitcnt lgkmcnt(5)
  v_mfma_f32_16x16x32_bf16 v[56:59], v[32:35], v[124:127], v[56:59]
  ds_read_b128 v[24:27], v248 offset:256
  v_mfma_f32_16x16x32_bf16 v[64:67], v[32:35], v[156:159], v[64:67]
  v_mfma_f32_16x16x32_bf16 v[72:75], v[32:35], v[188:191], v[72:75]
  s_add_u32 m0, s29, 99328
  s_add_u32 s27, s28, 1589248
  buffer_load_dwordx4 v15, s[60:63], s27 offen lds
  v_mfma_f32_16x16x32_bf16 v[80:83], v[32:35], v[220:223], v[80:83]
  s_waitcnt lgkmcnt(5)
  v_mfma_f32_16x16x32_bf16 v[60:63], v[36:39], v[124:127], v[60:63]
  ds_read_b128 v[28:31], v248 offset:2304
  v_mfma_f32_16x16x32_bf16 v[68:71], v[36:39], v[156:159], v[68:71]
  v_mfma_f32_16x16x32_bf16 v[76:79], v[36:39], v[188:191], v[76:79]
  v_mfma_f32_16x16x32_bf16 v[84:87], v[36:39], v[220:223], v[84:87]
  s_waitcnt lgkmcnt(5)
  v_mfma_f32_16x16x32_bf16 v[56:59], v[40:43], v[128:131], v[56:59]
  ds_read_b128 v[32:35], v249 offset:256
  v_mfma_f32_16x16x32_bf16 v[64:67], v[40:43], v[160:163], v[64:67]
  v_mfma_f32_16x16x32_bf16 v[72:75], v[40:43], v[192:195], v[72:75]
  s_add_u32 m0, s29, 100352
  s_add_u32 s27, s28, 1605632
  buffer_load_dwordx4 v14, s[60:63], s27 offen lds
  v_mfma_f32_16x16x32_bf16 v[80:83], v[40:43], v[224:227], v[80:83]
  s_waitcnt lgkmcnt(5)
  v_mfma_f32_16x16x32_bf16 v[60:63], v[44:47], v[128:131], v[60:63]
  ds_read_b128 v[36:39], v249 offset:2304
  v_mfma_f32_16x16x32_bf16 v[68:71], v[44:47], v[160:163], v[68:71]
  v_mfma_f32_16x16x32_bf16 v[76:79], v[44:47], v[192:195], v[76:79]
  v_mfma_f32_16x16x32_bf16 v[84:87], v[44:47], v[224:227], v[84:87]
  s_waitcnt lgkmcnt(5)
  v_mfma_f32_16x16x32_bf16 v[56:59], v[48:51], v[132:135], v[56:59]
  ds_read_b128 v[40:43], v250 offset:256
  v_mfma_f32_16x16x32_bf16 v[64:67], v[48:51], v[164:167], v[64:67]
  v_mfma_f32_16x16x32_bf16 v[72:75], v[48:51], v[196:199], v[72:75]
  s_add_u32 m0, s29, 101376
  s_add_u32 s27, s28, 1622016
  buffer_load_dwordx4 v15, s[60:63], s27 offen lds
  v_mfma_f32_16x16x32_bf16 v[80:83], v[48:51], v[228:231], v[80:83]
  s_waitcnt lgkmcnt(5)
  v_mfma_f32_16x16x32_bf16 v[60:63], v[52:55], v[132:135], v[60:63]
  ds_read_b128 v[44:47], v250 offset:2304
  v_mfma_f32_16x16x32_bf16 v[68:71], v[52:55], v[164:167], v[68:71]
  v_mfma_f32_16x16x32_bf16 v[76:79], v[52:55], v[196:199], v[76:79]
  v_mfma_f32_16x16x32_bf16 v[84:87], v[52:55], v[228:231], v[84:87]
  s_waitcnt lgkmcnt(5)
  v_mfma_f32_16x16x32_bf16 v[56:59], v[24:27], v[136:139], v[56:59]
  ds_read_b128 v[48:51], v251 offset:256
  v_mfma_f32_16x16x32_bf16 v[64:67], v[24:27], v[168:171], v[64:67]
  v_mfma_f32_16x16x32_bf16 v[72:75], v[24:27], v[200:203], v[72:75]
  v_mfma_f32_16x16x32_bf16 v[80:83], v[24:27], v[232:235], v[80:83]
  s_waitcnt lgkmcnt(5)
  v_mfma_f32_16x16x32_bf16 v[60:63], v[28:31], v[136:139], v[60:63]
  ds_read_b128 v[52:55], v251 offset:2304
  v_mfma_f32_16x16x32_bf16 v[68:71], v[28:31], v[168:171], v[68:71]
  v_mfma_f32_16x16x32_bf16 v[76:79], v[28:31], v[200:203], v[76:79]
  v_mfma_f32_16x16x32_bf16 v[84:87], v[28:31], v[232:235], v[84:87]
  s_waitcnt lgkmcnt(5)
  v_mfma_f32_16x16x32_bf16 v[56:59], v[32:35], v[140:143], v[56:59]
  s_waitcnt vmcnt(20)
  s_barrier
  ds_read_b128 v[24:27], v248 offset:16384
  v_mfma_f32_16x16x32_bf16 v[64:67], v[32:35], v[172:175], v[64:67]
  v_mfma_f32_16x16x32_bf16 v[72:75], v[32:35], v[204:207], v[72:75]
  v_mfma_f32_16x16x32_bf16 v[80:83], v[32:35], v[236:239], v[80:83]
  s_waitcnt lgkmcnt(5)
  v_mfma_f32_16x16x32_bf16 v[60:63], v[36:39], v[140:143], v[60:63]
  ds_read_b128 v[28:31], v248 offset:18432
  v_mfma_f32_16x16x32_bf16 v[68:71], v[36:39], v[172:175], v[68:71]
  v_mfma_f32_16x16x32_bf16 v[76:79], v[36:39], v[204:207], v[76:79]
  v_mfma_f32_16x16x32_bf16 v[84:87], v[36:39], v[236:239], v[84:87]
  s_waitcnt lgkmcnt(5)
  v_mfma_f32_16x16x32_bf16 v[56:59], v[40:43], v[144:147], v[56:59]
  ds_read_b128 v[32:35], v249 offset:16384
  v_mfma_f32_16x16x32_bf16 v[64:67], v[40:43], v[176:179], v[64:67]
  v_mfma_f32_16x16x32_bf16 v[72:75], v[40:43], v[208:211], v[72:75]
  v_mfma_f32_16x16x32_bf16 v[80:83], v[40:43], v[240:243], v[80:83]
  s_waitcnt lgkmcnt(5)
  v_mfma_f32_16x16x32_bf16 v[60:63], v[44:47], v[144:147], v[60:63]
  ds_read_b128 v[36:39], v249 offset:18432
  v_mfma_f32_16x16x32_bf16 v[68:71], v[44:47], v[176:179], v[68:71]
  v_mfma_f32_16x16x32_bf16 v[76:79], v[44:47], v[208:211], v[76:79]
  v_mfma_f32_16x16x32_bf16 v[84:87], v[44:47], v[240:243], v[84:87]
  s_waitcnt lgkmcnt(5)
  v_mfma_f32_16x16x32_bf16 v[56:59], v[48:51], v[148:151], v[56:59]
  ds_read_b128 v[40:43], v250 offset:16384
  v_mfma_f32_16x16x32_bf16 v[64:67], v[48:51], v[180:183], v[64:67]
  v_mfma_f32_16x16x32_bf16 v[72:75], v[48:51], v[212:215], v[72:75]
  v_mfma_f32_16x16x32_bf16 v[80:83], v[48:51], v[244:247], v[80:83]
  s_waitcnt lgkmcnt(5)
  v_mfma_f32_16x16x32_bf16 v[60:63], v[52:55], v[148:151], v[60:63]
  ds_read_b128 v[44:47], v250 offset:18432
  v_mfma_f32_16x16x32_bf16 v[68:71], v[52:55], v[180:183], v[68:71]
  v_mfma_f32_16x16x32_bf16 v[76:79], v[52:55], v[212:215], v[76:79]
  v_mfma_f32_16x16x32_bf16 v[84:87], v[52:55], v[244:247], v[84:87]
  s_waitcnt lgkmcnt(5)
  v_mfma_f32_16x16x32_bf16 v[88:91], v[24:27], v[120:123], 0
  ds_read_b128 v[48:51], v251 offset:16384
  v_mfma_f32_16x16x32_bf16 v[96:99], v[24:27], v[152:155], 0
  v_mfma_f32_16x16x32_bf16 v[104:107], v[24:27], v[184:187], 0
  s_add_u32 m0, s29, 114688
  s_add_u32 s27, s28, 1835008
  buffer_load_dwordx4 v14, s[60:63], s27 offen lds
  v_mfma_f32_16x16x32_bf16 v[112:115], v[24:27], v[216:219], 0
  s_waitcnt lgkmcnt(5)
  v_mul_f32 v56, v12, v56
  v_mfma_f32_16x16x32_bf16 v[92:95], v[28:31], v[120:123], 0
  ds_read_b128 v[52:55], v251 offset:18432
  v_mul_f32 v57, v12, v57
  v_mfma_f32_16x16x32_bf16 v[100:103], v[28:31], v[152:155], 0
  v_mul_f32 v58, v12, v58
  v_mul_f32 v59, v12, v59
  v_mfma_f32_16x16x32_bf16 v[108:111], v[28:31], v[184:187], 0
  v_mul_f32 v60, v12, v60
  v_mfma_f32_16x16x32_bf16 v[116:119], v[28:31], v[216:219], 0
  s_waitcnt lgkmcnt(5)
  v_mul_f32 v61, v12, v61
  v_mfma_f32_16x16x32_bf16 v[88:91], v[32:35], v[124:127], v[88:91]
  ds_read_b128 v[24:27], v248 offset:16640
  v_mul_f32 v62, v12, v62
  v_mfma_f32_16x16x32_bf16 v[96:99], v[32:35], v[156:159], v[96:99]
  v_mul_f32 v63, v12, v63
  v_cvt_pk_bf16_f32 v56, v56, v57
  v_mfma_f32_16x16x32_bf16 v[104:107], v[32:35], v[188:191], v[104:107]
  s_add_u32 m0, s29, 115712
  s_add_u32 s27, s28, 1851392
  buffer_load_dwordx4 v15, s[60:63], s27 offen lds
  v_mfma_f32_16x16x32_bf16 v[112:115], v[32:35], v[220:223], v[112:115]
  s_waitcnt lgkmcnt(5)
  v_cvt_pk_bf16_f32 v57, v58, v59
  v_mfma_f32_16x16x32_bf16 v[92:95], v[36:39], v[124:127], v[92:95]
  ds_read_b128 v[28:31], v248 offset:18688
  v_cvt_pk_bf16_f32 v58, v60, v61
  v_mfma_f32_16x16x32_bf16 v[100:103], v[36:39], v[156:159], v[100:103]
  v_cvt_pk_bf16_f32 v59, v62, v63
  v_accvgpr_write_b32 a0, v56
  v_mfma_f32_16x16x32_bf16 v[108:111], v[36:39], v[188:191], v[108:111]
  v_accvgpr_write_b32 a1, v57
  v_mfma_f32_16x16x32_bf16 v[116:119], v[36:39], v[220:223], v[116:119]
  s_waitcnt lgkmcnt(5)
  v_accvgpr_write_b32 a2, v58
  v_mfma_f32_16x16x32_bf16 v[88:91], v[40:43], v[128:131], v[88:91]
  ds_read_b128 v[32:35], v249 offset:16640
  v_accvgpr_write_b32 a3, v59
  v_mfma_f32_16x16x32_bf16 v[96:99], v[40:43], v[160:163], v[96:99]
  v_mul_f32 v64, v12, v64
  v_mul_f32 v65, v12, v65
  v_mfma_f32_16x16x32_bf16 v[104:107], v[40:43], v[192:195], v[104:107]
  s_add_u32 m0, s29, 116736
  s_add_u32 s27, s28, 1867776
  buffer_load_dwordx4 v14, s[60:63], s27 offen lds
  v_mfma_f32_16x16x32_bf16 v[112:115], v[40:43], v[224:227], v[112:115]
  s_waitcnt lgkmcnt(5)
  v_mul_f32 v66, v12, v66
  v_mfma_f32_16x16x32_bf16 v[92:95], v[44:47], v[128:131], v[92:95]
  ds_read_b128 v[36:39], v249 offset:18688
  v_mul_f32 v67, v12, v67
  v_mfma_f32_16x16x32_bf16 v[100:103], v[44:47], v[160:163], v[100:103]
  v_mul_f32 v68, v12, v68
  v_mul_f32 v69, v12, v69
  v_mfma_f32_16x16x32_bf16 v[108:111], v[44:47], v[192:195], v[108:111]
  v_mul_f32 v70, v12, v70
  v_mfma_f32_16x16x32_bf16 v[116:119], v[44:47], v[224:227], v[116:119]
  s_waitcnt lgkmcnt(5)
  v_mul_f32 v71, v12, v71
  v_mfma_f32_16x16x32_bf16 v[88:91], v[48:51], v[132:135], v[88:91]
  ds_read_b128 v[40:43], v250 offset:16640
  v_cvt_pk_bf16_f32 v64, v64, v65
  v_mfma_f32_16x16x32_bf16 v[96:99], v[48:51], v[164:167], v[96:99]
  v_cvt_pk_bf16_f32 v65, v66, v67
  v_cvt_pk_bf16_f32 v66, v68, v69
  v_mfma_f32_16x16x32_bf16 v[104:107], v[48:51], v[196:199], v[104:107]
  s_add_u32 m0, s29, 117760
  s_add_u32 s27, s28, 1884160
  buffer_load_dwordx4 v15, s[60:63], s27 offen lds
  v_mfma_f32_16x16x32_bf16 v[112:115], v[48:51], v[228:231], v[112:115]
  s_waitcnt lgkmcnt(5)
  v_cvt_pk_bf16_f32 v67, v70, v71
  v_mfma_f32_16x16x32_bf16 v[92:95], v[52:55], v[132:135], v[92:95]
  ds_read_b128 v[44:47], v250 offset:18688
  v_accvgpr_write_b32 a56, v64
  v_mfma_f32_16x16x32_bf16 v[100:103], v[52:55], v[164:167], v[100:103]
  v_accvgpr_write_b32 a57, v65
  v_accvgpr_write_b32 a58, v66
  v_mfma_f32_16x16x32_bf16 v[108:111], v[52:55], v[196:199], v[108:111]
  v_accvgpr_write_b32 a59, v67
  v_mfma_f32_16x16x32_bf16 v[116:119], v[52:55], v[228:231], v[116:119]
  s_waitcnt lgkmcnt(5)
  v_mul_f32 v72, v12, v72
  v_mfma_f32_16x16x32_bf16 v[88:91], v[24:27], v[136:139], v[88:91]
  ds_read_b128 v[48:51], v251 offset:16640
  v_mul_f32 v73, v12, v73
  v_mfma_f32_16x16x32_bf16 v[96:99], v[24:27], v[168:171], v[96:99]
  v_mul_f32 v74, v12, v74
  v_mul_f32 v75, v12, v75
  v_mfma_f32_16x16x32_bf16 v[104:107], v[24:27], v[200:203], v[104:107]
  v_mul_f32 v76, v12, v76
  v_mfma_f32_16x16x32_bf16 v[112:115], v[24:27], v[232:235], v[112:115]
  s_waitcnt lgkmcnt(5)
  v_mul_f32 v77, v12, v77
  v_mfma_f32_16x16x32_bf16 v[92:95], v[28:31], v[136:139], v[92:95]
  ds_read_b128 v[52:55], v251 offset:18688
  v_mul_f32 v78, v12, v78
  v_mfma_f32_16x16x32_bf16 v[100:103], v[28:31], v[168:171], v[100:103]
  v_mul_f32 v79, v12, v79
  v_cvt_pk_bf16_f32 v72, v72, v73
  v_mfma_f32_16x16x32_bf16 v[108:111], v[28:31], v[200:203], v[108:111]
  v_cvt_pk_bf16_f32 v73, v74, v75
  v_mfma_f32_16x16x32_bf16 v[116:119], v[28:31], v[232:235], v[116:119]
  s_waitcnt lgkmcnt(5)
  v_cvt_pk_bf16_f32 v74, v76, v77
  v_mfma_f32_16x16x32_bf16 v[88:91], v[32:35], v[140:143], v[88:91]
  s_waitcnt vmcnt(20)
  s_barrier
  ds_read_b128 v[24:27], v248 offset:32768
  v_cvt_pk_bf16_f32 v75, v78, v79
  v_mfma_f32_16x16x32_bf16 v[96:99], v[32:35], v[172:175], v[96:99]
  v_accvgpr_write_b32 a112, v72
  v_accvgpr_write_b32 a113, v73
  v_mfma_f32_16x16x32_bf16 v[104:107], v[32:35], v[204:207], v[104:107]
  v_accvgpr_write_b32 a114, v74
  v_mfma_f32_16x16x32_bf16 v[112:115], v[32:35], v[236:239], v[112:115]
  s_waitcnt lgkmcnt(5)
  v_accvgpr_write_b32 a115, v75
  v_mfma_f32_16x16x32_bf16 v[92:95], v[36:39], v[140:143], v[92:95]
  ds_read_b128 v[28:31], v248 offset:34816
  v_mul_f32 v80, v12, v80
  v_mfma_f32_16x16x32_bf16 v[100:103], v[36:39], v[172:175], v[100:103]
  v_mul_f32 v81, v12, v81
  v_mul_f32 v82, v12, v82
  v_mfma_f32_16x16x32_bf16 v[108:111], v[36:39], v[204:207], v[108:111]
  v_mul_f32 v83, v12, v83
  v_mfma_f32_16x16x32_bf16 v[116:119], v[36:39], v[236:239], v[116:119]
  s_waitcnt lgkmcnt(5)
  v_mul_f32 v84, v12, v84
  v_mfma_f32_16x16x32_bf16 v[88:91], v[40:43], v[144:147], v[88:91]
  ds_read_b128 v[32:35], v249 offset:32768
  v_mul_f32 v85, v12, v85
  v_mfma_f32_16x16x32_bf16 v[96:99], v[40:43], v[176:179], v[96:99]
  v_mul_f32 v86, v12, v86
  v_mul_f32 v87, v12, v87
  v_mfma_f32_16x16x32_bf16 v[104:107], v[40:43], v[208:211], v[104:107]
  v_cvt_pk_bf16_f32 v80, v80, v81
  v_mfma_f32_16x16x32_bf16 v[112:115], v[40:43], v[240:243], v[112:115]
  s_waitcnt lgkmcnt(5)
  v_cvt_pk_bf16_f32 v81, v82, v83
  v_mfma_f32_16x16x32_bf16 v[92:95], v[44:47], v[144:147], v[92:95]
  ds_read_b128 v[36:39], v249 offset:34816
  v_cvt_pk_bf16_f32 v82, v84, v85
  v_mfma_f32_16x16x32_bf16 v[100:103], v[44:47], v[176:179], v[100:103]
  v_cvt_pk_bf16_f32 v83, v86, v87
  v_accvgpr_write_b32 a168, v80
  v_mfma_f32_16x16x32_bf16 v[108:111], v[44:47], v[208:211], v[108:111]
  v_accvgpr_write_b32 a169, v81
  v_mfma_f32_16x16x32_bf16 v[116:119], v[44:47], v[240:243], v[116:119]
  s_waitcnt lgkmcnt(5)
  v_accvgpr_write_b32 a170, v82
  v_mfma_f32_16x16x32_bf16 v[88:91], v[48:51], v[148:151], v[88:91]
  ds_read_b128 v[40:43], v250 offset:32768
  v_accvgpr_write_b32 a171, v83
  v_mfma_f32_16x16x32_bf16 v[96:99], v[48:51], v[180:183], v[96:99]
  v_mfma_f32_16x16x32_bf16 v[104:107], v[48:51], v[212:215], v[104:107]
  v_mfma_f32_16x16x32_bf16 v[112:115], v[48:51], v[244:247], v[112:115]
  s_waitcnt lgkmcnt(5)
  v_mfma_f32_16x16x32_bf16 v[92:95], v[52:55], v[148:151], v[92:95]
  ds_read_b128 v[44:47], v250 offset:34816
  v_mfma_f32_16x16x32_bf16 v[100:103], v[52:55], v[180:183], v[100:103]
  v_mfma_f32_16x16x32_bf16 v[108:111], v[52:55], v[212:215], v[108:111]
  v_mfma_f32_16x16x32_bf16 v[116:119], v[52:55], v[244:247], v[116:119]
  s_waitcnt lgkmcnt(5)
  v_mfma_f32_16x16x32_bf16 v[56:59], v[24:27], v[120:123], 0
  ds_read_b128 v[48:51], v251 offset:32768
  v_mfma_f32_16x16x32_bf16 v[64:67], v[24:27], v[152:155], 0
  v_mfma_f32_16x16x32_bf16 v[72:75], v[24:27], v[184:187], 0
  s_add_u32 m0, s29, 131072
  s_add_u32 s27, s28, 2097152
  buffer_load_dwordx4 v14, s[60:63], s27 offen lds
  v_mfma_f32_16x16x32_bf16 v[80:83], v[24:27], v[216:219], 0
  s_waitcnt lgkmcnt(5)
  v_mul_f32 v88, v12, v88
  v_mfma_f32_16x16x32_bf16 v[60:63], v[28:31], v[120:123], 0
  ds_read_b128 v[52:55], v251 offset:34816
  v_mul_f32 v89, v12, v89
  v_mfma_f32_16x16x32_bf16 v[68:71], v[28:31], v[152:155], 0
  v_mul_f32 v90, v12, v90
  v_mul_f32 v91, v12, v91
  v_mfma_f32_16x16x32_bf16 v[76:79], v[28:31], v[184:187], 0
  v_mul_f32 v92, v12, v92
  v_mfma_f32_16x16x32_bf16 v[84:87], v[28:31], v[216:219], 0
  s_waitcnt lgkmcnt(5)
  v_mul_f32 v93, v12, v93
  v_mfma_f32_16x16x32_bf16 v[56:59], v[32:35], v[124:127], v[56:59]
  ds_read_b128 v[24:27], v248 offset:33024
  v_mul_f32 v94, v12, v94
  v_mfma_f32_16x16x32_bf16 v[64:67], v[32:35], v[156:159], v[64:67]
  v_mul_f32 v95, v12, v95
  v_cvt_pk_bf16_f32 v88, v88, v89
  v_mfma_f32_16x16x32_bf16 v[72:75], v[32:35], v[188:191], v[72:75]
  s_add_u32 m0, s29, 132096
  s_add_u32 s27, s28, 2113536
  buffer_load_dwordx4 v15, s[60:63], s27 offen lds
  v_mfma_f32_16x16x32_bf16 v[80:83], v[32:35], v[220:223], v[80:83]
  s_waitcnt lgkmcnt(5)
  v_cvt_pk_bf16_f32 v89, v90, v91
  v_mfma_f32_16x16x32_bf16 v[60:63], v[36:39], v[124:127], v[60:63]
  ds_read_b128 v[28:31], v248 offset:35072
  v_cvt_pk_bf16_f32 v90, v92, v93
  v_mfma_f32_16x16x32_bf16 v[68:71], v[36:39], v[156:159], v[68:71]
  v_cvt_pk_bf16_f32 v91, v94, v95
  v_accvgpr_write_b32 a4, v88
  v_mfma_f32_16x16x32_bf16 v[76:79], v[36:39], v[188:191], v[76:79]
  v_accvgpr_write_b32 a5, v89
  v_mfma_f32_16x16x32_bf16 v[84:87], v[36:39], v[220:223], v[84:87]
  s_waitcnt lgkmcnt(5)
  v_accvgpr_write_b32 a6, v90
  v_mfma_f32_16x16x32_bf16 v[56:59], v[40:43], v[128:131], v[56:59]
  ds_read_b128 v[32:35], v249 offset:33024
  v_accvgpr_write_b32 a7, v91
  v_mfma_f32_16x16x32_bf16 v[64:67], v[40:43], v[160:163], v[64:67]
  v_mul_f32 v96, v12, v96
  v_mul_f32 v97, v12, v97
  v_mfma_f32_16x16x32_bf16 v[72:75], v[40:43], v[192:195], v[72:75]
  s_add_u32 m0, s29, 133120
  s_add_u32 s27, s28, 2129920
  buffer_load_dwordx4 v14, s[60:63], s27 offen lds
  v_mfma_f32_16x16x32_bf16 v[80:83], v[40:43], v[224:227], v[80:83]
  s_waitcnt lgkmcnt(5)
  v_mul_f32 v98, v12, v98
  v_mfma_f32_16x16x32_bf16 v[60:63], v[44:47], v[128:131], v[60:63]
  ds_read_b128 v[36:39], v249 offset:35072
  v_mul_f32 v99, v12, v99
  v_mfma_f32_16x16x32_bf16 v[68:71], v[44:47], v[160:163], v[68:71]
  v_mul_f32 v100, v12, v100
  v_mul_f32 v101, v12, v101
  v_mfma_f32_16x16x32_bf16 v[76:79], v[44:47], v[192:195], v[76:79]
  v_mul_f32 v102, v12, v102
  v_mfma_f32_16x16x32_bf16 v[84:87], v[44:47], v[224:227], v[84:87]
  s_waitcnt lgkmcnt(5)
  v_mul_f32 v103, v12, v103
  v_mfma_f32_16x16x32_bf16 v[56:59], v[48:51], v[132:135], v[56:59]
  ds_read_b128 v[40:43], v250 offset:33024
  v_cvt_pk_bf16_f32 v96, v96, v97
  v_mfma_f32_16x16x32_bf16 v[64:67], v[48:51], v[164:167], v[64:67]
  v_cvt_pk_bf16_f32 v97, v98, v99
  v_cvt_pk_bf16_f32 v98, v100, v101
  v_mfma_f32_16x16x32_bf16 v[72:75], v[48:51], v[196:199], v[72:75]
  s_add_u32 m0, s29, 134144
  s_add_u32 s27, s28, 2146304
  buffer_load_dwordx4 v15, s[60:63], s27 offen lds
  v_mfma_f32_16x16x32_bf16 v[80:83], v[48:51], v[228:231], v[80:83]
  s_waitcnt lgkmcnt(5)
  v_cvt_pk_bf16_f32 v99, v102, v103
  v_mfma_f32_16x16x32_bf16 v[60:63], v[52:55], v[132:135], v[60:63]
  ds_read_b128 v[44:47], v250 offset:35072
  v_accvgpr_write_b32 a60, v96
  v_mfma_f32_16x16x32_bf16 v[68:71], v[52:55], v[164:167], v[68:71]
  v_accvgpr_write_b32 a61, v97
  v_accvgpr_write_b32 a62, v98
  v_mfma_f32_16x16x32_bf16 v[76:79], v[52:55], v[196:199], v[76:79]
  v_accvgpr_write_b32 a63, v99
  v_mfma_f32_16x16x32_bf16 v[84:87], v[52:55], v[228:231], v[84:87]
  s_waitcnt lgkmcnt(5)
  v_mul_f32 v104, v12, v104
  v_mfma_f32_16x16x32_bf16 v[56:59], v[24:27], v[136:139], v[56:59]
  ds_read_b128 v[48:51], v251 offset:33024
  v_mul_f32 v105, v12, v105
  v_mfma_f32_16x16x32_bf16 v[64:67], v[24:27], v[168:171], v[64:67]
  v_mul_f32 v106, v12, v106
  v_mul_f32 v107, v12, v107
  v_mfma_f32_16x16x32_bf16 v[72:75], v[24:27], v[200:203], v[72:75]
  v_mul_f32 v108, v12, v108
  v_mfma_f32_16x16x32_bf16 v[80:83], v[24:27], v[232:235], v[80:83]
  s_waitcnt lgkmcnt(5)
  v_mul_f32 v109, v12, v109
  v_mfma_f32_16x16x32_bf16 v[60:63], v[28:31], v[136:139], v[60:63]
  ds_read_b128 v[52:55], v251 offset:35072
  v_mul_f32 v110, v12, v110
  v_mfma_f32_16x16x32_bf16 v[68:71], v[28:31], v[168:171], v[68:71]
  v_mul_f32 v111, v12, v111
  v_cvt_pk_bf16_f32 v104, v104, v105
  v_mfma_f32_16x16x32_bf16 v[76:79], v[28:31], v[200:203], v[76:79]
  v_cvt_pk_bf16_f32 v105, v106, v107
  v_mfma_f32_16x16x32_bf16 v[84:87], v[28:31], v[232:235], v[84:87]
  s_waitcnt lgkmcnt(5)
  v_cvt_pk_bf16_f32 v106, v108, v109
  v_mfma_f32_16x16x32_bf16 v[56:59], v[32:35], v[140:143], v[56:59]
  s_waitcnt vmcnt(20)
  s_barrier
  ds_read_b128 v[24:27], v248 offset:49152
  v_cvt_pk_bf16_f32 v107, v110, v111
  v_mfma_f32_16x16x32_bf16 v[64:67], v[32:35], v[172:175], v[64:67]
  v_accvgpr_write_b32 a116, v104
  v_accvgpr_write_b32 a117, v105
  v_mfma_f32_16x16x32_bf16 v[72:75], v[32:35], v[204:207], v[72:75]
  v_accvgpr_write_b32 a118, v106
  v_mfma_f32_16x16x32_bf16 v[80:83], v[32:35], v[236:239], v[80:83]
  s_waitcnt lgkmcnt(5)
  v_accvgpr_write_b32 a119, v107
  v_mfma_f32_16x16x32_bf16 v[60:63], v[36:39], v[140:143], v[60:63]
  ds_read_b128 v[28:31], v248 offset:51200
  v_mul_f32 v112, v12, v112
  v_mfma_f32_16x16x32_bf16 v[68:71], v[36:39], v[172:175], v[68:71]
  v_mul_f32 v113, v12, v113
  v_mul_f32 v114, v12, v114
  v_mfma_f32_16x16x32_bf16 v[76:79], v[36:39], v[204:207], v[76:79]
  v_mul_f32 v115, v12, v115
  v_mfma_f32_16x16x32_bf16 v[84:87], v[36:39], v[236:239], v[84:87]
  s_waitcnt lgkmcnt(5)
  v_mul_f32 v116, v12, v116
  v_mfma_f32_16x16x32_bf16 v[56:59], v[40:43], v[144:147], v[56:59]
  ds_read_b128 v[32:35], v249 offset:49152
  v_mul_f32 v117, v12, v117
  v_mfma_f32_16x16x32_bf16 v[64:67], v[40:43], v[176:179], v[64:67]
  v_mul_f32 v118, v12, v118
  v_mul_f32 v119, v12, v119
  v_mfma_f32_16x16x32_bf16 v[72:75], v[40:43], v[208:211], v[72:75]
  v_cvt_pk_bf16_f32 v112, v112, v113
  v_mfma_f32_16x16x32_bf16 v[80:83], v[40:43], v[240:243], v[80:83]
  s_waitcnt lgkmcnt(5)
  v_cvt_pk_bf16_f32 v113, v114, v115
  v_mfma_f32_16x16x32_bf16 v[60:63], v[44:47], v[144:147], v[60:63]
  ds_read_b128 v[36:39], v249 offset:51200
  v_cvt_pk_bf16_f32 v114, v116, v117
  v_mfma_f32_16x16x32_bf16 v[68:71], v[44:47], v[176:179], v[68:71]
  v_cvt_pk_bf16_f32 v115, v118, v119
  v_accvgpr_write_b32 a172, v112
  v_mfma_f32_16x16x32_bf16 v[76:79], v[44:47], v[208:211], v[76:79]
  v_accvgpr_write_b32 a173, v113
  v_mfma_f32_16x16x32_bf16 v[84:87], v[44:47], v[240:243], v[84:87]
  s_waitcnt lgkmcnt(5)
  v_accvgpr_write_b32 a174, v114
  v_mfma_f32_16x16x32_bf16 v[56:59], v[48:51], v[148:151], v[56:59]
  ds_read_b128 v[40:43], v250 offset:49152
  v_accvgpr_write_b32 a175, v115
  v_mfma_f32_16x16x32_bf16 v[64:67], v[48:51], v[180:183], v[64:67]
  v_mfma_f32_16x16x32_bf16 v[72:75], v[48:51], v[212:215], v[72:75]
  v_mfma_f32_16x16x32_bf16 v[80:83], v[48:51], v[244:247], v[80:83]
  s_waitcnt lgkmcnt(5)
  v_mfma_f32_16x16x32_bf16 v[60:63], v[52:55], v[148:151], v[60:63]
  ds_read_b128 v[44:47], v250 offset:51200
  v_mfma_f32_16x16x32_bf16 v[68:71], v[52:55], v[180:183], v[68:71]
  v_mfma_f32_16x16x32_bf16 v[76:79], v[52:55], v[212:215], v[76:79]
  v_mfma_f32_16x16x32_bf16 v[84:87], v[52:55], v[244:247], v[84:87]
  s_waitcnt lgkmcnt(5)
  s_getpc_b64 s[98:99]
  s_add_u32 s98, s98, 4096
  s_addc_u32 s99, s99, 0
  global_load_dword v7, v6, s[98:99]
  v_mfma_f32_16x16x32_bf16 v[88:91], v[24:27], v[120:123], 0
  ds_read_b128 v[48:51], v251 offset:49152
  v_mfma_f32_16x16x32_bf16 v[96:99], v[24:27], v[152:155], 0
  v_mfma_f32_16x16x32_bf16 v[104:107], v[24:27], v[184:187], 0
  buffer_load_dword v13, off, s[12:15], 0 offset:128 sc1
  buffer_load_dword v9, off, s[12:15], 0 sc1
  s_add_u32 m0, s29, 147456
  s_add_u32 s27, s28, 2359296
  buffer_load_dwordx4 v14, s[60:63], s27 offen lds
  v_mfma_f32_16x16x32_bf16 v[112:115], v[24:27], v[216:219], 0
  s_waitcnt lgkmcnt(5)
  v_mul_f32 v56, v12, v56
  v_mfma_f32_16x16x32_bf16 v[92:95], v[28:31], v[120:123], 0
  ds_read_b128 v[52:55], v251 offset:51200
  v_mul_f32 v57, v12, v57
  v_mfma_f32_16x16x32_bf16 v[100:103], v[28:31], v[152:155], 0
  v_mul_f32 v58, v12, v58
  v_mul_f32 v59, v12, v59
  v_mfma_f32_16x16x32_bf16 v[108:111], v[28:31], v[184:187], 0
  v_mul_f32 v60, v12, v60
  v_mfma_f32_16x16x32_bf16 v[116:119], v[28:31], v[216:219], 0
  s_waitcnt lgkmcnt(5)
  v_mul_f32 v61, v12, v61
  v_mfma_f32_16x16x32_bf16 v[88:91], v[32:35], v[124:127], v[88:91]
  ds_read_b128 v[24:27], v248 offset:49408
  v_mul_f32 v62, v12, v62
  v_mfma_f32_16x16x32_bf16 v[96:99], v[32:35], v[156:159], v[96:99]
  v_mul_f32 v63, v12, v63
  v_cvt_pk_bf16_f32 v56, v56, v57
  v_mfma_f32_16x16x32_bf16 v[104:107], v[32:35], v[188:191], v[104:107]
  s_add_u32 m0, s29, 148480
  s_add_u32 s27, s28, 2375680
  buffer_load_dwordx4 v15, s[60:63], s27 offen lds
  v_mfma_f32_16x16x32_bf16 v[112:115], v[32:35], v[220:223], v[112:115]
  s_waitcnt lgkmcnt(5)
  v_cvt_pk_bf16_f32 v57, v58, v59
  v_mfma_f32_16x16x32_bf16 v[92:95], v[36:39], v[124:127], v[92:95]
  ds_read_b128 v[28:31], v248 offset:51456
  v_cvt_pk_bf16_f32 v58, v60, v61
  v_mfma_f32_16x16x32_bf16 v[100:103], v[36:39], v[156:159], v[100:103]
  v_cvt_pk_bf16_f32 v59, v62, v63
  v_accvgpr_write_b32 a8, v56
  v_mfma_f32_16x16x32_bf16 v[108:111], v[36:39], v[188:191], v[108:111]
  v_accvgpr_write_b32 a9, v57
  v_mfma_f32_16x16x32_bf16 v[116:119], v[36:39], v[220:223], v[116:119]
  s_waitcnt lgkmcnt(5)
  v_accvgpr_write_b32 a10, v58
  v_mfma_f32_16x16x32_bf16 v[88:91], v[40:43], v[128:131], v[88:91]
  ds_read_b128 v[32:35], v249 offset:49408
  v_accvgpr_write_b32 a11, v59
  v_mfma_f32_16x16x32_bf16 v[96:99], v[40:43], v[160:163], v[96:99]
  v_mul_f32 v64, v12, v64
  v_mul_f32 v65, v12, v65
  v_mfma_f32_16x16x32_bf16 v[104:107], v[40:43], v[192:195], v[104:107]
  s_add_u32 m0, s29, 149504
  s_add_u32 s27, s28, 2392064
  buffer_load_dwordx4 v14, s[60:63], s27 offen lds
  v_mfma_f32_16x16x32_bf16 v[112:115], v[40:43], v[224:227], v[112:115]
  s_waitcnt lgkmcnt(5)
  v_mul_f32 v66, v12, v66
  v_mfma_f32_16x16x32_bf16 v[92:95], v[44:47], v[128:131], v[92:95]
  ds_read_b128 v[36:39], v249 offset:51456
  v_mul_f32 v67, v12, v67
  v_mfma_f32_16x16x32_bf16 v[100:103], v[44:47], v[160:163], v[100:103]
  v_mul_f32 v68, v12, v68
  v_mul_f32 v69, v12, v69
  v_mfma_f32_16x16x32_bf16 v[108:111], v[44:47], v[192:195], v[108:111]
  v_mul_f32 v70, v12, v70
  v_mfma_f32_16x16x32_bf16 v[116:119], v[44:47], v[224:227], v[116:119]
  s_waitcnt lgkmcnt(5)
  v_mul_f32 v71, v12, v71
  v_mfma_f32_16x16x32_bf16 v[88:91], v[48:51], v[132:135], v[88:91]
  ds_read_b128 v[40:43], v250 offset:49408
  v_cvt_pk_bf16_f32 v64, v64, v65
  v_mfma_f32_16x16x32_bf16 v[96:99], v[48:51], v[164:167], v[96:99]
  v_cvt_pk_bf16_f32 v65, v66, v67
  v_cvt_pk_bf16_f32 v66, v68, v69
  v_mfma_f32_16x16x32_bf16 v[104:107], v[48:51], v[196:199], v[104:107]
  s_add_u32 m0, s29, 150528
  s_add_u32 s27, s28, 2408448
  buffer_load_dwordx4 v15, s[60:63], s27 offen lds
  v_mfma_f32_16x16x32_bf16 v[112:115], v[48:51], v[228:231], v[112:115]
  s_waitcnt lgkmcnt(5)
  v_cvt_pk_bf16_f32 v67, v70, v71
  v_mfma_f32_16x16x32_bf16 v[92:95], v[52:55], v[132:135], v[92:95]
  ds_read_b128 v[44:47], v250 offset:51456
  v_accvgpr_write_b32 a64, v64
  v_mfma_f32_16x16x32_bf16 v[100:103], v[52:55], v[164:167], v[100:103]
  v_accvgpr_write_b32 a65, v65
  v_accvgpr_write_b32 a66, v66
  v_mfma_f32_16x16x32_bf16 v[108:111], v[52:55], v[196:199], v[108:111]
  v_accvgpr_write_b32 a67, v67
  v_mfma_f32_16x16x32_bf16 v[116:119], v[52:55], v[228:231], v[116:119]
  s_waitcnt lgkmcnt(5)
  v_mul_f32 v72, v12, v72
  v_mfma_f32_16x16x32_bf16 v[88:91], v[24:27], v[136:139], v[88:91]
  ds_read_b128 v[48:51], v251 offset:49408
  v_mul_f32 v73, v12, v73
  v_mfma_f32_16x16x32_bf16 v[96:99], v[24:27], v[168:171], v[96:99]
  v_mul_f32 v74, v12, v74
  v_mul_f32 v75, v12, v75
  v_mfma_f32_16x16x32_bf16 v[104:107], v[24:27], v[200:203], v[104:107]
  v_mul_f32 v76, v12, v76
  v_mfma_f32_16x16x32_bf16 v[112:115], v[24:27], v[232:235], v[112:115]
  s_waitcnt lgkmcnt(5)
  v_mul_f32 v77, v12, v77
  v_mfma_f32_16x16x32_bf16 v[92:95], v[28:31], v[136:139], v[92:95]
  ds_read_b128 v[52:55], v251 offset:51456
  v_mul_f32 v78, v12, v78
  v_mfma_f32_16x16x32_bf16 v[100:103], v[28:31], v[168:171], v[100:103]
  v_mul_f32 v79, v12, v79
  v_cvt_pk_bf16_f32 v72, v72, v73
  v_mfma_f32_16x16x32_bf16 v[108:111], v[28:31], v[200:203], v[108:111]
  v_cvt_pk_bf16_f32 v73, v74, v75
  v_mfma_f32_16x16x32_bf16 v[116:119], v[28:31], v[232:235], v[116:119]
  s_waitcnt lgkmcnt(5)
  v_cvt_pk_bf16_f32 v74, v76, v77
  v_mfma_f32_16x16x32_bf16 v[88:91], v[32:35], v[140:143], v[88:91]
  s_waitcnt vmcnt(20)
  s_barrier
  ds_read_b128 v[24:27], v252 offset:0
  v_cvt_pk_bf16_f32 v75, v78, v79
  v_mfma_f32_16x16x32_bf16 v[96:99], v[32:35], v[172:175], v[96:99]
  v_accvgpr_write_b32 a120, v72
  v_accvgpr_write_b32 a121, v73
  v_mfma_f32_16x16x32_bf16 v[104:107], v[32:35], v[204:207], v[104:107]
  v_accvgpr_write_b32 a122, v74
  v_mfma_f32_16x16x32_bf16 v[112:115], v[32:35], v[236:239], v[112:115]
  s_waitcnt lgkmcnt(5)
  v_accvgpr_write_b32 a123, v75
  v_mfma_f32_16x16x32_bf16 v[92:95], v[36:39], v[140:143], v[92:95]
  ds_read_b128 v[28:31], v252 offset:2048
  v_mul_f32 v80, v12, v80
  v_mfma_f32_16x16x32_bf16 v[100:103], v[36:39], v[172:175], v[100:103]
  v_mul_f32 v81, v12, v81
  v_mul_f32 v82, v12, v82
  v_mfma_f32_16x16x32_bf16 v[108:111], v[36:39], v[204:207], v[108:111]
  v_mul_f32 v83, v12, v83
  v_mfma_f32_16x16x32_bf16 v[116:119], v[36:39], v[236:239], v[116:119]
  s_waitcnt lgkmcnt(5)
  v_mul_f32 v84, v12, v84
  v_mfma_f32_16x16x32_bf16 v[88:91], v[40:43], v[144:147], v[88:91]
  ds_read_b128 v[32:35], v253 offset:0
  v_mul_f32 v85, v12, v85
  v_mfma_f32_16x16x32_bf16 v[96:99], v[40:43], v[176:179], v[96:99]
  v_mul_f32 v86, v12, v86
  v_mul_f32 v87, v12, v87
  v_mfma_f32_16x16x32_bf16 v[104:107], v[40:43], v[208:211], v[104:107]
  v_cvt_pk_bf16_f32 v80, v80, v81
  v_mfma_f32_16x16x32_bf16 v[112:115], v[40:43], v[240:243], v[112:115]
  s_waitcnt lgkmcnt(5)
  v_cvt_pk_bf16_f32 v81, v82, v83
  v_mfma_f32_16x16x32_bf16 v[92:95], v[44:47], v[144:147], v[92:95]
  ds_read_b128 v[36:39], v253 offset:2048
  v_cvt_pk_bf16_f32 v82, v84, v85
  v_mfma_f32_16x16x32_bf16 v[100:103], v[44:47], v[176:179], v[100:103]
  v_cvt_pk_bf16_f32 v83, v86, v87
  v_accvgpr_write_b32 a176, v80
  v_mfma_f32_16x16x32_bf16 v[108:111], v[44:47], v[208:211], v[108:111]
  v_accvgpr_write_b32 a177, v81
  v_mfma_f32_16x16x32_bf16 v[116:119], v[44:47], v[240:243], v[116:119]
  s_waitcnt lgkmcnt(5)
  v_accvgpr_write_b32 a178, v82
  v_mfma_f32_16x16x32_bf16 v[88:91], v[48:51], v[148:151], v[88:91]
  ds_read_b128 v[40:43], v254 offset:0
  v_accvgpr_write_b32 a179, v83
  v_mfma_f32_16x16x32_bf16 v[96:99], v[48:51], v[180:183], v[96:99]
  v_mfma_f32_16x16x32_bf16 v[104:107], v[48:51], v[212:215], v[104:107]
  v_mfma_f32_16x16x32_bf16 v[112:115], v[48:51], v[244:247], v[112:115]
  s_waitcnt lgkmcnt(5)
  v_mfma_f32_16x16x32_bf16 v[92:95], v[52:55], v[148:151], v[92:95]
  ds_read_b128 v[44:47], v254 offset:2048
  v_mfma_f32_16x16x32_bf16 v[100:103], v[52:55], v[180:183], v[100:103]
  v_mfma_f32_16x16x32_bf16 v[108:111], v[52:55], v[212:215], v[108:111]
  v_mfma_f32_16x16x32_bf16 v[116:119], v[52:55], v[244:247], v[116:119]
  s_waitcnt lgkmcnt(5)
  v_mfma_f32_16x16x32_bf16 v[56:59], v[24:27], v[120:123], 0
  ds_read_b128 v[48:51], v255 offset:0
  v_mfma_f32_16x16x32_bf16 v[64:67], v[24:27], v[152:155], 0
  v_mfma_f32_16x16x32_bf16 v[72:75], v[24:27], v[184:187], 0
  s_add_u32 m0, s29, 0
  s_add_u32 s27, s28, 2621440
  buffer_load_dwordx4 v14, s[60:63], s27 offen lds
  v_mfma_f32_16x16x32_bf16 v[80:83], v[24:27], v[216:219], 0
  s_waitcnt lgkmcnt(5)
  v_mul_f32 v88, v12, v88
  v_mfma_f32_16x16x32_bf16 v[60:63], v[28:31], v[120:123], 0
  ds_read_b128 v[52:55], v255 offset:2048
  v_mul_f32 v89, v12, v89
  v_mfma_f32_16x16x32_bf16 v[68:71], v[28:31], v[152:155], 0
  v_mul_f32 v90, v12, v90
  v_mul_f32 v91, v12, v91
  v_mfma_f32_16x16x32_bf16 v[76:79], v[28:31], v[184:187], 0
  v_mul_f32 v92, v12, v92
  v_mfma_f32_16x16x32_bf16 v[84:87], v[28:31], v[216:219], 0
  s_waitcnt lgkmcnt(5)
  v_mul_f32 v93, v12, v93
  v_mfma_f32_16x16x32_bf16 v[56:59], v[32:35], v[124:127], v[56:59]
  ds_read_b128 v[24:27], v252 offset:256
  v_mul_f32 v94, v12, v94
  v_mfma_f32_16x16x32_bf16 v[64:67], v[32:35], v[156:159], v[64:67]
  v_mul_f32 v95, v12, v95
  v_cvt_pk_bf16_f32 v88, v88, v89
  v_mfma_f32_16x16x32_bf16 v[72:75], v[32:35], v[188:191], v[72:75]
  s_add_u32 m0, s29, 1024
  s_add_u32 s27, s28, 2637824
  buffer_load_dwordx4 v15, s[60:63], s27 offen lds
  v_mfma_f32_16x16x32_bf16 v[80:83], v[32:35], v[220:223], v[80:83]
  s_waitcnt lgkmcnt(5)
  v_cvt_pk_bf16_f32 v89, v90, v91
  v_mfma_f32_16x16x32_bf16 v[60:63], v[36:39], v[124:127], v[60:63]
  ds_read_b128 v[28:31], v252 offset:2304
  v_cvt_pk_bf16_f32 v90, v92, v93
  v_mfma_f32_16x16x32_bf16 v[68:71], v[36:39], v[156:159], v[68:71]
  v_cvt_pk_bf16_f32 v91, v94, v95
  v_accvgpr_write_b32 a12, v88
  v_mfma_f32_16x16x32_bf16 v[76:79], v[36:39], v[188:191], v[76:79]
  v_accvgpr_write_b32 a13, v89
  v_mfma_f32_16x16x32_bf16 v[84:87], v[36:39], v[220:223], v[84:87]
  s_waitcnt lgkmcnt(5)
  v_accvgpr_write_b32 a14, v90
  v_mfma_f32_16x16x32_bf16 v[56:59], v[40:43], v[128:131], v[56:59]
  ds_read_b128 v[32:35], v253 offset:256
  v_accvgpr_write_b32 a15, v91
  v_mfma_f32_16x16x32_bf16 v[64:67], v[40:43], v[160:163], v[64:67]
  v_mul_f32 v96, v12, v96
  v_mul_f32 v97, v12, v97
  v_mfma_f32_16x16x32_bf16 v[72:75], v[40:43], v[192:195], v[72:75]
  s_add_u32 m0, s29, 2048
  s_add_u32 s27, s28, 2654208
  buffer_load_dwordx4 v14, s[60:63], s27 offen lds
  v_mfma_f32_16x16x32_bf16 v[80:83], v[40:43], v[224:227], v[80:83]
  s_waitcnt lgkmcnt(5)
  v_mul_f32 v98, v12, v98
  v_mfma_f32_16x16x32_bf16 v[60:63], v[44:47], v[128:131], v[60:63]
  ds_read_b128 v[36:39], v253 offset:2304
  v_mul_f32 v99, v12, v99
  v_mfma_f32_16x16x32_bf16 v[68:71], v[44:47], v[160:163], v[68:71]
  v_mul_f32 v100, v12, v100
  v_mul_f32 v101, v12, v101
  v_mfma_f32_16x16x32_bf16 v[76:79], v[44:47], v[192:195], v[76:79]
  v_mul_f32 v102, v12, v102
  v_mfma_f32_16x16x32_bf16 v[84:87], v[44:47], v[224:227], v[84:87]
  s_waitcnt lgkmcnt(5)
  v_mul_f32 v103, v12, v103
  v_mfma_f32_16x16x32_bf16 v[56:59], v[48:51], v[132:135], v[56:59]
  ds_read_b128 v[40:43], v254 offset:256
  v_cvt_pk_bf16_f32 v96, v96, v97
  v_mfma_f32_16x16x32_bf16 v[64:67], v[48:51], v[164:167], v[64:67]
  v_cvt_pk_bf16_f32 v97, v98, v99
  v_cvt_pk_bf16_f32 v98, v100, v101
  v_mfma_f32_16x16x32_bf16 v[72:75], v[48:51], v[196:199], v[72:75]
  s_add_u32 m0, s29, 3072
  s_add_u32 s27, s28, 2670592
  buffer_load_dwordx4 v15, s[60:63], s27 offen lds
  v_mfma_f32_16x16x32_bf16 v[80:83], v[48:51], v[228:231], v[80:83]
  s_waitcnt lgkmcnt(5)
  v_cvt_pk_bf16_f32 v99, v102, v103
  v_mfma_f32_16x16x32_bf16 v[60:63], v[52:55], v[132:135], v[60:63]
  ds_read_b128 v[44:47], v254 offset:2304
  v_accvgpr_write_b32 a68, v96
  v_mfma_f32_16x16x32_bf16 v[68:71], v[52:55], v[164:167], v[68:71]
  v_accvgpr_write_b32 a69, v97
  v_accvgpr_write_b32 a70, v98
  v_mfma_f32_16x16x32_bf16 v[76:79], v[52:55], v[196:199], v[76:79]
  v_accvgpr_write_b32 a71, v99
  v_mfma_f32_16x16x32_bf16 v[84:87], v[52:55], v[228:231], v[84:87]
  s_waitcnt lgkmcnt(5)
  v_mul_f32 v104, v12, v104
  v_mfma_f32_16x16x32_bf16 v[56:59], v[24:27], v[136:139], v[56:59]
  ds_read_b128 v[48:51], v255 offset:256
  v_mul_f32 v105, v12, v105
  v_mfma_f32_16x16x32_bf16 v[64:67], v[24:27], v[168:171], v[64:67]
  v_mul_f32 v106, v12, v106
  v_mul_f32 v107, v12, v107
  v_mfma_f32_16x16x32_bf16 v[72:75], v[24:27], v[200:203], v[72:75]
  v_mul_f32 v108, v12, v108
  v_mfma_f32_16x16x32_bf16 v[80:83], v[24:27], v[232:235], v[80:83]
  s_waitcnt lgkmcnt(5)
  v_mul_f32 v109, v12, v109
  v_mfma_f32_16x16x32_bf16 v[60:63], v[28:31], v[136:139], v[60:63]
  ds_read_b128 v[52:55], v255 offset:2304
  v_mul_f32 v110, v12, v110
  v_mfma_f32_16x16x32_bf16 v[68:71], v[28:31], v[168:171], v[68:71]
  v_mul_f32 v111, v12, v111
  v_cvt_pk_bf16_f32 v104, v104, v105
  v_mfma_f32_16x16x32_bf16 v[76:79], v[28:31], v[200:203], v[76:79]
  v_cvt_pk_bf16_f32 v105, v106, v107
  v_mfma_f32_16x16x32_bf16 v[84:87], v[28:31], v[232:235], v[84:87]
  s_waitcnt lgkmcnt(5)
  v_cvt_pk_bf16_f32 v106, v108, v109
  v_mfma_f32_16x16x32_bf16 v[56:59], v[32:35], v[140:143], v[56:59]
  s_waitcnt vmcnt(20)
  s_barrier
  ds_read_b128 v[24:27], v252 offset:16384
  v_cvt_pk_bf16_f32 v107, v110, v111
  v_mfma_f32_16x16x32_bf16 v[64:67], v[32:35], v[172:175], v[64:67]
  v_accvgpr_write_b32 a124, v104
  v_accvgpr_write_b32 a125, v105
  v_mfma_f32_16x16x32_bf16 v[72:75], v[32:35], v[204:207], v[72:75]
  v_accvgpr_write_b32 a126, v106
  v_mfma_f32_16x16x32_bf16 v[80:83], v[32:35], v[236:239], v[80:83]
  s_waitcnt lgkmcnt(5)
  v_accvgpr_write_b32 a127, v107
  v_mfma_f32_16x16x32_bf16 v[60:63], v[36:39], v[140:143], v[60:63]
  ds_read_b128 v[28:31], v252 offset:18432
  v_mul_f32 v112, v12, v112
  v_mfma_f32_16x16x32_bf16 v[68:71], v[36:39], v[172:175], v[68:71]
  v_mul_f32 v113, v12, v113
  v_mul_f32 v114, v12, v114
  v_mfma_f32_16x16x32_bf16 v[76:79], v[36:39], v[204:207], v[76:79]
  v_mul_f32 v115, v12, v115
  v_mfma_f32_16x16x32_bf16 v[84:87], v[36:39], v[236:239], v[84:87]
  s_waitcnt lgkmcnt(5)
  v_mul_f32 v116, v12, v116
  v_mfma_f32_16x16x32_bf16 v[56:59], v[40:43], v[144:147], v[56:59]
  ds_read_b128 v[32:35], v253 offset:16384
  v_mul_f32 v117, v12, v117
  v_mfma_f32_16x16x32_bf16 v[64:67], v[40:43], v[176:179], v[64:67]
  v_mul_f32 v118, v12, v118
  v_mul_f32 v119, v12, v119
  v_mfma_f32_16x16x32_bf16 v[72:75], v[40:43], v[208:211], v[72:75]
  v_cvt_pk_bf16_f32 v112, v112, v113
  v_mfma_f32_16x16x32_bf16 v[80:83], v[40:43], v[240:243], v[80:83]
  s_waitcnt lgkmcnt(5)
  v_cvt_pk_bf16_f32 v113, v114, v115
  v_mfma_f32_16x16x32_bf16 v[60:63], v[44:47], v[144:147], v[60:63]
  ds_read_b128 v[36:39], v253 offset:18432
  v_cvt_pk_bf16_f32 v114, v116, v117
  v_mfma_f32_16x16x32_bf16 v[68:71], v[44:47], v[176:179], v[68:71]
  v_cvt_pk_bf16_f32 v115, v118, v119
  v_accvgpr_write_b32 a180, v112
  v_mfma_f32_16x16x32_bf16 v[76:79], v[44:47], v[208:211], v[76:79]
  v_accvgpr_write_b32 a181, v113
  v_mfma_f32_16x16x32_bf16 v[84:87], v[44:47], v[240:243], v[84:87]
  s_waitcnt lgkmcnt(5)
  v_accvgpr_write_b32 a182, v114
  v_mfma_f32_16x16x32_bf16 v[56:59], v[48:51], v[148:151], v[56:59]
  ds_read_b128 v[40:43], v254 offset:16384
  v_accvgpr_write_b32 a183, v115
  v_mfma_f32_16x16x32_bf16 v[64:67], v[48:51], v[180:183], v[64:67]
  v_mfma_f32_16x16x32_bf16 v[72:75], v[48:51], v[212:215], v[72:75]
  v_mfma_f32_16x16x32_bf16 v[80:83], v[48:51], v[244:247], v[80:83]
  s_waitcnt lgkmcnt(5)
  v_mfma_f32_16x16x32_bf16 v[60:63], v[52:55], v[148:151], v[60:63]
  ds_read_b128 v[44:47], v254 offset:18432
  v_mfma_f32_16x16x32_bf16 v[68:71], v[52:55], v[180:183], v[68:71]
  v_mfma_f32_16x16x32_bf16 v[76:79], v[52:55], v[212:215], v[76:79]
  v_mfma_f32_16x16x32_bf16 v[84:87], v[52:55], v[244:247], v[84:87]
  s_waitcnt lgkmcnt(5)
  v_mfma_f32_16x16x32_bf16 v[88:91], v[24:27], v[120:123], 0
  ds_read_b128 v[48:51], v255 offset:16384
  v_mfma_f32_16x16x32_bf16 v[96:99], v[24:27], v[152:155], 0
  v_mfma_f32_16x16x32_bf16 v[104:107], v[24:27], v[184:187], 0
  s_add_u32 m0, s29, 16384
  s_add_u32 s27, s28, 2883584
  buffer_load_dwordx4 v14, s[60:63], s27 offen lds
  v_mfma_f32_16x16x32_bf16 v[112:115], v[24:27], v[216:219], 0
  s_waitcnt lgkmcnt(5)
  v_mul_f32 v56, v12, v56
  v_mfma_f32_16x16x32_bf16 v[92:95], v[28:31], v[120:123], 0
  ds_read_b128 v[52:55], v255 offset:18432
  v_mul_f32 v57, v12, v57
  v_mfma_f32_16x16x32_bf16 v[100:103], v[28:31], v[152:155], 0
  v_mul_f32 v58, v12, v58
  v_mul_f32 v59, v12, v59
  v_mfma_f32_16x16x32_bf16 v[108:111], v[28:31], v[184:187], 0
  v_mul_f32 v60, v12, v60
  v_mfma_f32_16x16x32_bf16 v[116:119], v[28:31], v[216:219], 0
  s_waitcnt lgkmcnt(5)
  v_mul_f32 v61, v12, v61
  v_mfma_f32_16x16x32_bf16 v[88:91], v[32:35], v[124:127], v[88:91]
  ds_read_b128 v[24:27], v252 offset:16640
  v_mul_f32 v62, v12, v62
  v_mfma_f32_16x16x32_bf16 v[96:99], v[32:35], v[156:159], v[96:99]
  v_mul_f32 v63, v12, v63
  v_cvt_pk_bf16_f32 v56, v56, v57
  v_mfma_f32_16x16x32_bf16 v[104:107], v[32:35], v[188:191], v[104:107]
  s_add_u32 m0, s29, 17408
  s_add_u32 s27, s28, 2899968
  buffer_load_dwordx4 v15, s[60:63], s27 offen lds
  v_mfma_f32_16x16x32_bf16 v[112:115], v[32:35], v[220:223], v[112:115]
  s_waitcnt lgkmcnt(5)
  v_cvt_pk_bf16_f32 v57, v58, v59
  v_mfma_f32_16x16x32_bf16 v[92:95], v[36:39], v[124:127], v[92:95]
  ds_read_b128 v[28:31], v252 offset:18688
  v_cvt_pk_bf16_f32 v58, v60, v61
  v_mfma_f32_16x16x32_bf16 v[100:103], v[36:39], v[156:159], v[100:103]
  v_cvt_pk_bf16_f32 v59, v62, v63
  v_accvgpr_write_b32 a16, v56
  v_mfma_f32_16x16x32_bf16 v[108:111], v[36:39], v[188:191], v[108:111]
  v_accvgpr_write_b32 a17, v57
  v_mfma_f32_16x16x32_bf16 v[116:119], v[36:39], v[220:223], v[116:119]
  s_waitcnt lgkmcnt(5)
  v_accvgpr_write_b32 a18, v58
  v_mfma_f32_16x16x32_bf16 v[88:91], v[40:43], v[128:131], v[88:91]
  ds_read_b128 v[32:35], v253 offset:16640
  v_accvgpr_write_b32 a19, v59
  v_mfma_f32_16x16x32_bf16 v[96:99], v[40:43], v[160:163], v[96:99]
  v_mul_f32 v64, v12, v64
  v_mul_f32 v65, v12, v65
  v_mfma_f32_16x16x32_bf16 v[104:107], v[40:43], v[192:195], v[104:107]
  s_add_u32 m0, s29, 18432
  s_add_u32 s27, s28, 2916352
  buffer_load_dwordx4 v14, s[60:63], s27 offen lds
  v_mfma_f32_16x16x32_bf16 v[112:115], v[40:43], v[224:227], v[112:115]
  s_waitcnt lgkmcnt(5)
  v_mul_f32 v66, v12, v66
  v_mfma_f32_16x16x32_bf16 v[92:95], v[44:47], v[128:131], v[92:95]
  ds_read_b128 v[36:39], v253 offset:18688
  v_mul_f32 v67, v12, v67
  v_mfma_f32_16x16x32_bf16 v[100:103], v[44:47], v[160:163], v[100:103]
  v_mul_f32 v68, v12, v68
  v_mul_f32 v69, v12, v69
  v_mfma_f32_16x16x32_bf16 v[108:111], v[44:47], v[192:195], v[108:111]
  v_mul_f32 v70, v12, v70
  v_mfma_f32_16x16x32_bf16 v[116:119], v[44:47], v[224:227], v[116:119]
  s_waitcnt lgkmcnt(5)
  v_mul_f32 v71, v12, v71
  v_mfma_f32_16x16x32_bf16 v[88:91], v[48:51], v[132:135], v[88:91]
  ds_read_b128 v[40:43], v254 offset:16640
  v_cvt_pk_bf16_f32 v64, v64, v65
  v_mfma_f32_16x16x32_bf16 v[96:99], v[48:51], v[164:167], v[96:99]
  v_cvt_pk_bf16_f32 v65, v66, v67
  v_cvt_pk_bf16_f32 v66, v68, v69
  v_mfma_f32_16x16x32_bf16 v[104:107], v[48:51], v[196:199], v[104:107]
  s_add_u32 m0, s29, 19456
  s_add_u32 s27, s28, 2932736
  buffer_load_dwordx4 v15, s[60:63], s27 offen lds
  v_mfma_f32_16x16x32_bf16 v[112:115], v[48:51], v[228:231], v[112:115]
  s_waitcnt lgkmcnt(5)
  v_cvt_pk_bf16_f32 v67, v70, v71
  v_mfma_f32_16x16x32_bf16 v[92:95], v[52:55], v[132:135], v[92:95]
  ds_read_b128 v[44:47], v254 offset:18688
  v_accvgpr_write_b32 a72, v64
  v_mfma_f32_16x16x32_bf16 v[100:103], v[52:55], v[164:167], v[100:103]
  v_accvgpr_write_b32 a73, v65
  v_accvgpr_write_b32 a74, v66
  v_mfma_f32_16x16x32_bf16 v[108:111], v[52:55], v[196:199], v[108:111]
  v_accvgpr_write_b32 a75, v67
  v_mfma_f32_16x16x32_bf16 v[116:119], v[52:55], v[228:231], v[116:119]
  s_waitcnt lgkmcnt(5)
  v_mul_f32 v72, v12, v72
  v_mfma_f32_16x16x32_bf16 v[88:91], v[24:27], v[136:139], v[88:91]
  ds_read_b128 v[48:51], v255 offset:16640
  v_mul_f32 v73, v12, v73
  v_mfma_f32_16x16x32_bf16 v[96:99], v[24:27], v[168:171], v[96:99]
  v_mul_f32 v74, v12, v74
  v_mul_f32 v75, v12, v75
  v_mfma_f32_16x16x32_bf16 v[104:107], v[24:27], v[200:203], v[104:107]
  v_mul_f32 v76, v12, v76
  v_mfma_f32_16x16x32_bf16 v[112:115], v[24:27], v[232:235], v[112:115]
  s_waitcnt lgkmcnt(5)
  v_mul_f32 v77, v12, v77
  v_mfma_f32_16x16x32_bf16 v[92:95], v[28:31], v[136:139], v[92:95]
  ds_read_b128 v[52:55], v255 offset:18688
  v_mul_f32 v78, v12, v78
  v_mfma_f32_16x16x32_bf16 v[100:103], v[28:31], v[168:171], v[100:103]
  v_mul_f32 v79, v12, v79
  v_cvt_pk_bf16_f32 v72, v72, v73
  v_mfma_f32_16x16x32_bf16 v[108:111], v[28:31], v[200:203], v[108:111]
  v_cvt_pk_bf16_f32 v73, v74, v75
  v_mfma_f32_16x16x32_bf16 v[116:119], v[28:31], v[232:235], v[116:119]
  s_waitcnt lgkmcnt(5)
  v_cvt_pk_bf16_f32 v74, v76, v77
  v_mfma_f32_16x16x32_bf16 v[88:91], v[32:35], v[140:143], v[88:91]
  s_waitcnt vmcnt(20)
  s_barrier
  ds_read_b128 v[24:27], v252 offset:32768
  v_cvt_pk_bf16_f32 v75, v78, v79
  v_mfma_f32_16x16x32_bf16 v[96:99], v[32:35], v[172:175], v[96:99]
  v_accvgpr_write_b32 a128, v72
  v_accvgpr_write_b32 a129, v73
  v_mfma_f32_16x16x32_bf16 v[104:107], v[32:35], v[204:207], v[104:107]
  v_accvgpr_write_b32 a130, v74
  v_mfma_f32_16x16x32_bf16 v[112:115], v[32:35], v[236:239], v[112:115]
  s_waitcnt lgkmcnt(5)
  v_accvgpr_write_b32 a131, v75
  v_mfma_f32_16x16x32_bf16 v[92:95], v[36:39], v[140:143], v[92:95]
  ds_read_b128 v[28:31], v252 offset:34816
  v_mul_f32 v80, v12, v80
  v_mfma_f32_16x16x32_bf16 v[100:103], v[36:39], v[172:175], v[100:103]
  v_mul_f32 v81, v12, v81
  v_mul_f32 v82, v12, v82
  v_mfma_f32_16x16x32_bf16 v[108:111], v[36:39], v[204:207], v[108:111]
  v_mul_f32 v83, v12, v83
  v_mfma_f32_16x16x32_bf16 v[116:119], v[36:39], v[236:239], v[116:119]
  s_waitcnt lgkmcnt(5)
  v_mul_f32 v84, v12, v84
  v_mfma_f32_16x16x32_bf16 v[88:91], v[40:43], v[144:147], v[88:91]
  ds_read_b128 v[32:35], v253 offset:32768
  v_mul_f32 v85, v12, v85
  v_mfma_f32_16x16x32_bf16 v[96:99], v[40:43], v[176:179], v[96:99]
  v_mul_f32 v86, v12, v86
  v_mul_f32 v87, v12, v87
  v_mfma_f32_16x16x32_bf16 v[104:107], v[40:43], v[208:211], v[104:107]
  v_cvt_pk_bf16_f32 v80, v80, v81
  v_mfma_f32_16x16x32_bf16 v[112:115], v[40:43], v[240:243], v[112:115]
  s_waitcnt lgkmcnt(5)
  v_cvt_pk_bf16_f32 v81, v82, v83
  v_mfma_f32_16x16x32_bf16 v[92:95], v[44:47], v[144:147], v[92:95]
  ds_read_b128 v[36:39], v253 offset:34816
  v_cvt_pk_bf16_f32 v82, v84, v85
  v_mfma_f32_16x16x32_bf16 v[100:103], v[44:47], v[176:179], v[100:103]
  v_cvt_pk_bf16_f32 v83, v86, v87
  v_accvgpr_write_b32 a184, v80
  v_mfma_f32_16x16x32_bf16 v[108:111], v[44:47], v[208:211], v[108:111]
  v_accvgpr_write_b32 a185, v81
  v_mfma_f32_16x16x32_bf16 v[116:119], v[44:47], v[240:243], v[116:119]
  s_waitcnt lgkmcnt(5)
  v_accvgpr_write_b32 a186, v82
  v_mfma_f32_16x16x32_bf16 v[88:91], v[48:51], v[148:151], v[88:91]
  ds_read_b128 v[40:43], v254 offset:32768
  v_accvgpr_write_b32 a187, v83
  v_mfma_f32_16x16x32_bf16 v[96:99], v[48:51], v[180:183], v[96:99]
  v_mfma_f32_16x16x32_bf16 v[104:107], v[48:51], v[212:215], v[104:107]
  v_mfma_f32_16x16x32_bf16 v[112:115], v[48:51], v[244:247], v[112:115]
  s_waitcnt lgkmcnt(5)
  v_mfma_f32_16x16x32_bf16 v[92:95], v[52:55], v[148:151], v[92:95]
  ds_read_b128 v[44:47], v254 offset:34816
  v_mfma_f32_16x16x32_bf16 v[100:103], v[52:55], v[180:183], v[100:103]
  v_mfma_f32_16x16x32_bf16 v[108:111], v[52:55], v[212:215], v[108:111]
  v_mfma_f32_16x16x32_bf16 v[116:119], v[52:55], v[244:247], v[116:119]
  s_waitcnt lgkmcnt(5)
  s_getpc_b64 s[98:99]
  s_add_u32 s98, s98, 4096
  s_addc_u32 s99, s99, 0
  global_load_dword v7, v6, s[98:99]
  v_mfma_f32_16x16x32_bf16 v[56:59], v[24:27], v[120:123], 0
  ds_read_b128 v[48:51], v255 offset:32768
  v_mfma_f32_16x16x32_bf16 v[64:67], v[24:27], v[152:155], 0
  v_mfma_f32_16x16x32_bf16 v[72:75], v[24:27], v[184:187], 0
  s_add_u32 m0, s29, 32768
  s_add_u32 s27, s28, 3145728
  buffer_load_dwordx4 v14, s[60:63], s27 offen lds
  v_mfma_f32_16x16x32_bf16 v[80:83], v[24:27], v[216:219], 0
  s_waitcnt lgkmcnt(5)
  v_mul_f32 v88, v12, v88
  v_mfma_f32_16x16x32_bf16 v[60:63], v[28:31], v[120:123], 0
  ds_read_b128 v[52:55], v255 offset:34816
  v_mul_f32 v89, v12, v89
  v_mfma_f32_16x16x32_bf16 v[68:71], v[28:31], v[152:155], 0
  v_mul_f32 v90, v12, v90
  v_mul_f32 v91, v12, v91
  v_mfma_f32_16x16x32_bf16 v[76:79], v[28:31], v[184:187], 0
  v_mul_f32 v92, v12, v92
  v_mfma_f32_16x16x32_bf16 v[84:87], v[28:31], v[216:219], 0
  s_waitcnt lgkmcnt(5)
  v_mul_f32 v93, v12, v93
  v_mfma_f32_16x16x32_bf16 v[56:59], v[32:35], v[124:127], v[56:59]
  ds_read_b128 v[24:27], v252 offset:33024
  v_mul_f32 v94, v12, v94
  v_mfma_f32_16x16x32_bf16 v[64:67], v[32:35], v[156:159], v[64:67]
  v_mul_f32 v95, v12, v95
  v_cvt_pk_bf16_f32 v88, v88, v89
  v_mfma_f32_16x16x32_bf16 v[72:75], v[32:35], v[188:191], v[72:75]
  s_add_u32 m0, s29, 33792
  s_add_u32 s27, s28, 3162112
  buffer_load_dwordx4 v15, s[60:63], s27 offen lds
  v_mfma_f32_16x16x32_bf16 v[80:83], v[32:35], v[220:223], v[80:83]
  s_waitcnt lgkmcnt(5)
  v_cvt_pk_bf16_f32 v89, v90, v91
  v_mfma_f32_16x16x32_bf16 v[60:63], v[36:39], v[124:127], v[60:63]
  ds_read_b128 v[28:31], v252 offset:35072
  v_cvt_pk_bf16_f32 v90, v92, v93
  v_mfma_f32_16x16x32_bf16 v[68:71], v[36:39], v[156:159], v[68:71]
  v_cvt_pk_bf16_f32 v91, v94, v95
  v_accvgpr_write_b32 a20, v88
  v_mfma_f32_16x16x32_bf16 v[76:79], v[36:39], v[188:191], v[76:79]
  v_accvgpr_write_b32 a21, v89
  v_mfma_f32_16x16x32_bf16 v[84:87], v[36:39], v[220:223], v[84:87]
  s_waitcnt lgkmcnt(5)
  v_accvgpr_write_b32 a22, v90
  v_mfma_f32_16x16x32_bf16 v[56:59], v[40:43], v[128:131], v[56:59]
  ds_read_b128 v[32:35], v253 offset:33024
  v_accvgpr_write_b32 a23, v91
  v_mfma_f32_16x16x32_bf16 v[64:67], v[40:43], v[160:163], v[64:67]
  v_mul_f32 v96, v12, v96
  v_mul_f32 v97, v12, v97
  v_mfma_f32_16x16x32_bf16 v[72:75], v[40:43], v[192:195], v[72:75]
  s_add_u32 m0, s29, 34816
  s_add_u32 s27, s28, 3178496
  buffer_load_dwordx4 v14, s[60:63], s27 offen lds
  v_mfma_f32_16x16x32_bf16 v[80:83], v[40:43], v[224:227], v[80:83]
  s_waitcnt lgkmcnt(5)
  v_mul_f32 v98, v12, v98
  v_mfma_f32_16x16x32_bf16 v[60:63], v[44:47], v[128:131], v[60:63]
  ds_read_b128 v[36:39], v253 offset:35072
  v_mul_f32 v99, v12, v99
  v_mfma_f32_16x16x32_bf16 v[68:71], v[44:47], v[160:163], v[68:71]
  v_mul_f32 v100, v12, v100
  v_mul_f32 v101, v12, v101
  v_mfma_f32_16x16x32_bf16 v[76:79], v[44:47], v[192:195], v[76:79]
  v_mul_f32 v102, v12, v102
  v_mfma_f32_16x16x32_bf16 v[84:87], v[44:47], v[224:227], v[84:87]
  s_waitcnt lgkmcnt(5)
  v_mul_f32 v103, v12, v103
  v_mfma_f32_16x16x32_bf16 v[56:59], v[48:51], v[132:135], v[56:59]
  ds_read_b128 v[40:43], v254 offset:33024
  v_cvt_pk_bf16_f32 v96, v96, v97
  v_mfma_f32_16x16x32_bf16 v[64:67], v[48:51], v[164:167], v[64:67]
  v_cvt_pk_bf16_f32 v97, v98, v99
  v_cvt_pk_bf16_f32 v98, v100, v101
  v_mfma_f32_16x16x32_bf16 v[72:75], v[48:51], v[196:199], v[72:75]
  s_add_u32 m0, s29, 35840
  s_add_u32 s27, s28, 3194880
  buffer_load_dwordx4 v15, s[60:63], s27 offen lds
  v_mfma_f32_16x16x32_bf16 v[80:83], v[48:51], v[228:231], v[80:83]
  s_waitcnt lgkmcnt(5)
  v_cvt_pk_bf16_f32 v99, v102, v103
  v_mfma_f32_16x16x32_bf16 v[60:63], v[52:55], v[132:135], v[60:63]
  ds_read_b128 v[44:47], v254 offset:35072
  v_accvgpr_write_b32 a76, v96
  v_mfma_f32_16x16x32_bf16 v[68:71], v[52:55], v[164:167], v[68:71]
  v_accvgpr_write_b32 a77, v97
  v_accvgpr_write_b32 a78, v98
  v_mfma_f32_16x16x32_bf16 v[76:79], v[52:55], v[196:199], v[76:79]
  v_accvgpr_write_b32 a79, v99
  v_mfma_f32_16x16x32_bf16 v[84:87], v[52:55], v[228:231], v[84:87]
  s_waitcnt lgkmcnt(5)
  v_mul_f32 v104, v12, v104
  v_mfma_f32_16x16x32_bf16 v[56:59], v[24:27], v[136:139], v[56:59]
  ds_read_b128 v[48:51], v255 offset:33024
  v_mul_f32 v105, v12, v105
  v_mfma_f32_16x16x32_bf16 v[64:67], v[24:27], v[168:171], v[64:67]
  v_mul_f32 v106, v12, v106
  v_mul_f32 v107, v12, v107
  v_mfma_f32_16x16x32_bf16 v[72:75], v[24:27], v[200:203], v[72:75]
  v_mul_f32 v108, v12, v108
  v_mfma_f32_16x16x32_bf16 v[80:83], v[24:27], v[232:235], v[80:83]
  s_waitcnt lgkmcnt(5)
  v_mul_f32 v109, v12, v109
  v_mfma_f32_16x16x32_bf16 v[60:63], v[28:31], v[136:139], v[60:63]
  ds_read_b128 v[52:55], v255 offset:35072
  v_mul_f32 v110, v12, v110
  v_mfma_f32_16x16x32_bf16 v[68:71], v[28:31], v[168:171], v[68:71]
  v_mul_f32 v111, v12, v111
  v_cvt_pk_bf16_f32 v104, v104, v105
  v_mfma_f32_16x16x32_bf16 v[76:79], v[28:31], v[200:203], v[76:79]
  v_cvt_pk_bf16_f32 v105, v106, v107
  v_mfma_f32_16x16x32_bf16 v[84:87], v[28:31], v[232:235], v[84:87]
  s_waitcnt lgkmcnt(5)
  v_cvt_pk_bf16_f32 v106, v108, v109
  v_mfma_f32_16x16x32_bf16 v[56:59], v[32:35], v[140:143], v[56:59]
  s_waitcnt vmcnt(20)
  s_barrier
  ds_read_b128 v[24:27], v252 offset:49152
  v_cvt_pk_bf16_f32 v107, v110, v111
  v_mfma_f32_16x16x32_bf16 v[64:67], v[32:35], v[172:175], v[64:67]
  v_accvgpr_write_b32 a132, v104
  v_accvgpr_write_b32 a133, v105
  v_mfma_f32_16x16x32_bf16 v[72:75], v[32:35], v[204:207], v[72:75]
  v_accvgpr_write_b32 a134, v106
  v_mfma_f32_16x16x32_bf16 v[80:83], v[32:35], v[236:239], v[80:83]
  s_waitcnt lgkmcnt(5)
  v_accvgpr_write_b32 a135, v107
  v_mfma_f32_16x16x32_bf16 v[60:63], v[36:39], v[140:143], v[60:63]
  ds_read_b128 v[28:31], v252 offset:51200
  v_mul_f32 v112, v12, v112
  v_mfma_f32_16x16x32_bf16 v[68:71], v[36:39], v[172:175], v[68:71]
  v_mul_f32 v113, v12, v113
  v_mul_f32 v114, v12, v114
  v_mfma_f32_16x16x32_bf16 v[76:79], v[36:39], v[204:207], v[76:79]
  v_mul_f32 v115, v12, v115
  v_mfma_f32_16x16x32_bf16 v[84:87], v[36:39], v[236:239], v[84:87]
  s_waitcnt lgkmcnt(5)
  v_mul_f32 v116, v12, v116
  v_mfma_f32_16x16x32_bf16 v[56:59], v[40:43], v[144:147], v[56:59]
  ds_read_b128 v[32:35], v253 offset:49152
  v_mul_f32 v117, v12, v117
  v_mfma_f32_16x16x32_bf16 v[64:67], v[40:43], v[176:179], v[64:67]
  v_mul_f32 v118, v12, v118
  v_mul_f32 v119, v12, v119
  v_mfma_f32_16x16x32_bf16 v[72:75], v[40:43], v[208:211], v[72:75]
  v_cvt_pk_bf16_f32 v112, v112, v113
  v_mfma_f32_16x16x32_bf16 v[80:83], v[40:43], v[240:243], v[80:83]
  s_waitcnt lgkmcnt(5)
  v_cvt_pk_bf16_f32 v113, v114, v115
  v_mfma_f32_16x16x32_bf16 v[60:63], v[44:47], v[144:147], v[60:63]
  ds_read_b128 v[36:39], v253 offset:51200
  v_cvt_pk_bf16_f32 v114, v116, v117
  v_mfma_f32_16x16x32_bf16 v[68:71], v[44:47], v[176:179], v[68:71]
  v_cvt_pk_bf16_f32 v115, v118, v119
  v_accvgpr_write_b32 a188, v112
  v_mfma_f32_16x16x32_bf16 v[76:79], v[44:47], v[208:211], v[76:79]
  v_accvgpr_write_b32 a189, v113
  v_mfma_f32_16x16x32_bf16 v[84:87], v[44:47], v[240:243], v[84:87]
  s_waitcnt lgkmcnt(5)
  v_accvgpr_write_b32 a190, v114
  v_mfma_f32_16x16x32_bf16 v[56:59], v[48:51], v[148:151], v[56:59]
  ds_read_b128 v[40:43], v254 offset:49152
  v_accvgpr_write_b32 a191, v115
  v_mfma_f32_16x16x32_bf16 v[64:67], v[48:51], v[180:183], v[64:67]
  v_mfma_f32_16x16x32_bf16 v[72:75], v[48:51], v[212:215], v[72:75]
  v_mfma_f32_16x16x32_bf16 v[80:83], v[48:51], v[244:247], v[80:83]
  s_waitcnt lgkmcnt(5)
  v_mfma_f32_16x16x32_bf16 v[60:63], v[52:55], v[148:151], v[60:63]
  ds_read_b128 v[44:47], v254 offset:51200
  v_mfma_f32_16x16x32_bf16 v[68:71], v[52:55], v[180:183], v[68:71]
  v_mfma_f32_16x16x32_bf16 v[76:79], v[52:55], v[212:215], v[76:79]
  v_mfma_f32_16x16x32_bf16 v[84:87], v[52:55], v[244:247], v[84:87]
  s_waitcnt lgkmcnt(5)
  v_mfma_f32_16x16x32_bf16 v[88:91], v[24:27], v[120:123], 0
  ds_read_b128 v[48:51], v255 offset:49152
  v_mfma_f32_16x16x32_bf16 v[96:99], v[24:27], v[152:155], 0
  v_mfma_f32_16x16x32_bf16 v[104:107], v[24:27], v[184:187], 0
  s_add_u32 m0, s29, 49152
  s_add_u32 s27, s28, 3407872
  buffer_load_dwordx4 v14, s[60:63], s27 offen lds
  v_mfma_f32_16x16x32_bf16 v[112:115], v[24:27], v[216:219], 0
  s_waitcnt lgkmcnt(5)
  v_mul_f32 v56, v12, v56
  v_mfma_f32_16x16x32_bf16 v[92:95], v[28:31], v[120:123], 0
  ds_read_b128 v[52:55], v255 offset:51200
  v_mul_f32 v57, v12, v57
  v_mfma_f32_16x16x32_bf16 v[100:103], v[28:31], v[152:155], 0
  v_mul_f32 v58, v12, v58
  v_mul_f32 v59, v12, v59
  v_mfma_f32_16x16x32_bf16 v[108:111], v[28:31], v[184:187], 0
  v_mul_f32 v60, v12, v60
  v_mfma_f32_16x16x32_bf16 v[116:119], v[28:31], v[216:219], 0
  s_waitcnt lgkmcnt(5)
  v_mul_f32 v61, v12, v61
  v_mfma_f32_16x16x32_bf16 v[88:91], v[32:35], v[124:127], v[88:91]
  ds_read_b128 v[24:27], v252 offset:49408
  v_mul_f32 v62, v12, v62
  v_mfma_f32_16x16x32_bf16 v[96:99], v[32:35], v[156:159], v[96:99]
  v_mul_f32 v63, v12, v63
  v_cvt_pk_bf16_f32 v56, v56, v57
  v_mfma_f32_16x16x32_bf16 v[104:107], v[32:35], v[188:191], v[104:107]
  s_add_u32 m0, s29, 50176
  s_add_u32 s27, s28, 3424256
  buffer_load_dwordx4 v15, s[60:63], s27 offen lds
  v_mfma_f32_16x16x32_bf16 v[112:115], v[32:35], v[220:223], v[112:115]
  s_waitcnt lgkmcnt(5)
  v_cvt_pk_bf16_f32 v57, v58, v59
  v_mfma_f32_16x16x32_bf16 v[92:95], v[36:39], v[124:127], v[92:95]
  ds_read_b128 v[28:31], v252 offset:51456
  v_cvt_pk_bf16_f32 v58, v60, v61
  v_mfma_f32_16x16x32_bf16 v[100:103], v[36:39], v[156:159], v[100:103]
  v_cvt_pk_bf16_f32 v59, v62, v63
  v_accvgpr_write_b32 a24, v56
  v_mfma_f32_16x16x32_bf16 v[108:111], v[36:39], v[188:191], v[108:111]
  v_accvgpr_write_b32 a25, v57
  v_mfma_f32_16x16x32_bf16 v[116:119], v[36:39], v[220:223], v[116:119]
  s_waitcnt lgkmcnt(5)
  v_accvgpr_write_b32 a26, v58
  v_mfma_f32_16x16x32_bf16 v[88:91], v[40:43], v[128:131], v[88:91]
  ds_read_b128 v[32:35], v253 offset:49408
  v_accvgpr_write_b32 a27, v59
  v_mfma_f32_16x16x32_bf16 v[96:99], v[40:43], v[160:163], v[96:99]
  v_mul_f32 v64, v12, v64
  v_mul_f32 v65, v12, v65
  v_mfma_f32_16x16x32_bf16 v[104:107], v[40:43], v[192:195], v[104:107]
  s_add_u32 m0, s29, 51200
  s_add_u32 s27, s28, 3440640
  buffer_load_dwordx4 v14, s[60:63], s27 offen lds
  v_mfma_f32_16x16x32_bf16 v[112:115], v[40:43], v[224:227], v[112:115]
  s_waitcnt lgkmcnt(5)
  v_mul_f32 v66, v12, v66
  v_mfma_f32_16x16x32_bf16 v[92:95], v[44:47], v[128:131], v[92:95]
  ds_read_b128 v[36:39], v253 offset:51456
  v_mul_f32 v67, v12, v67
  v_mfma_f32_16x16x32_bf16 v[100:103], v[44:47], v[160:163], v[100:103]
  v_mul_f32 v68, v12, v68
  v_mul_f32 v69, v12, v69
  v_mfma_f32_16x16x32_bf16 v[108:111], v[44:47], v[192:195], v[108:111]
  v_mul_f32 v70, v12, v70
  v_mfma_f32_16x16x32_bf16 v[116:119], v[44:47], v[224:227], v[116:119]
  s_waitcnt lgkmcnt(5)
  v_mul_f32 v71, v12, v71
  v_mfma_f32_16x16x32_bf16 v[88:91], v[48:51], v[132:135], v[88:91]
  ds_read_b128 v[40:43], v254 offset:49408
  v_cvt_pk_bf16_f32 v64, v64, v65
  v_mfma_f32_16x16x32_bf16 v[96:99], v[48:51], v[164:167], v[96:99]
  v_cvt_pk_bf16_f32 v65, v66, v67
  v_cvt_pk_bf16_f32 v66, v68, v69
  v_mfma_f32_16x16x32_bf16 v[104:107], v[48:51], v[196:199], v[104:107]
  s_add_u32 m0, s29, 52224
  s_add_u32 s27, s28, 3457024
  buffer_load_dwordx4 v15, s[60:63], s27 offen lds
  v_mfma_f32_16x16x32_bf16 v[112:115], v[48:51], v[228:231], v[112:115]
  s_waitcnt lgkmcnt(5)
  v_cvt_pk_bf16_f32 v67, v70, v71
  v_mfma_f32_16x16x32_bf16 v[92:95], v[52:55], v[132:135], v[92:95]
  ds_read_b128 v[44:47], v254 offset:51456
  v_accvgpr_write_b32 a80, v64
  v_mfma_f32_16x16x32_bf16 v[100:103], v[52:55], v[164:167], v[100:103]
  v_accvgpr_write_b32 a81, v65
  v_accvgpr_write_b32 a82, v66
  v_mfma_f32_16x16x32_bf16 v[108:111], v[52:55], v[196:199], v[108:111]
  v_accvgpr_write_b32 a83, v67
  v_mfma_f32_16x16x32_bf16 v[116:119], v[52:55], v[228:231], v[116:119]
  s_waitcnt lgkmcnt(5)
  v_mul_f32 v72, v12, v72
  v_mfma_f32_16x16x32_bf16 v[88:91], v[24:27], v[136:139], v[88:91]
  ds_read_b128 v[48:51], v255 offset:49408
  v_mul_f32 v73, v12, v73
  v_mfma_f32_16x16x32_bf16 v[96:99], v[24:27], v[168:171], v[96:99]
  v_mul_f32 v74, v12, v74
  v_mul_f32 v75, v12, v75
  v_mfma_f32_16x16x32_bf16 v[104:107], v[24:27], v[200:203], v[104:107]
  v_mul_f32 v76, v12, v76
  v_mfma_f32_16x16x32_bf16 v[112:115], v[24:27], v[232:235], v[112:115]
  s_waitcnt lgkmcnt(5)
  v_mul_f32 v77, v12, v77
  v_mfma_f32_16x16x32_bf16 v[92:95], v[28:31], v[136:139], v[92:95]
  ds_read_b128 v[52:55], v255 offset:51456
  v_mul_f32 v78, v12, v78
  v_mfma_f32_16x16x32_bf16 v[100:103], v[28:31], v[168:171], v[100:103]
  v_mul_f32 v79, v12, v79
  v_cvt_pk_bf16_f32 v72, v72, v73
  v_mfma_f32_16x16x32_bf16 v[108:111], v[28:31], v[200:203], v[108:111]
  v_cvt_pk_bf16_f32 v73, v74, v75
  v_mfma_f32_16x16x32_bf16 v[116:119], v[28:31], v[232:235], v[116:119]
  s_waitcnt lgkmcnt(5)
  v_cvt_pk_bf16_f32 v74, v76, v77
  v_mfma_f32_16x16x32_bf16 v[88:91], v[32:35], v[140:143], v[88:91]
  s_waitcnt vmcnt(20)
  s_barrier
  ds_read_b128 v[24:27], v16 offset:0
  v_cvt_pk_bf16_f32 v75, v78, v79
  v_mfma_f32_16x16x32_bf16 v[96:99], v[32:35], v[172:175], v[96:99]
  v_accvgpr_write_b32 a136, v72
  v_accvgpr_write_b32 a137, v73
  v_mfma_f32_16x16x32_bf16 v[104:107], v[32:35], v[204:207], v[104:107]
  v_accvgpr_write_b32 a138, v74
  v_mfma_f32_16x16x32_bf16 v[112:115], v[32:35], v[236:239], v[112:115]
  s_waitcnt lgkmcnt(5)
  v_accvgpr_write_b32 a139, v75
  v_mfma_f32_16x16x32_bf16 v[92:95], v[36:39], v[140:143], v[92:95]
  ds_read_b128 v[28:31], v16 offset:2048
  v_mul_f32 v80, v12, v80
  v_mfma_f32_16x16x32_bf16 v[100:103], v[36:39], v[172:175], v[100:103]
  v_mul_f32 v81, v12, v81
  v_mul_f32 v82, v12, v82
  v_mfma_f32_16x16x32_bf16 v[108:111], v[36:39], v[204:207], v[108:111]
  v_mul_f32 v83, v12, v83
  v_mfma_f32_16x16x32_bf16 v[116:119], v[36:39], v[236:239], v[116:119]
  s_waitcnt lgkmcnt(5)
  v_mul_f32 v84, v12, v84
  v_mfma_f32_16x16x32_bf16 v[88:91], v[40:43], v[144:147], v[88:91]
  ds_read_b128 v[32:35], v17 offset:0
  v_mul_f32 v85, v12, v85
  v_mfma_f32_16x16x32_bf16 v[96:99], v[40:43], v[176:179], v[96:99]
  v_mul_f32 v86, v12, v86
  v_mul_f32 v87, v12, v87
  v_mfma_f32_16x16x32_bf16 v[104:107], v[40:43], v[208:211], v[104:107]
  v_cvt_pk_bf16_f32 v80, v80, v81
  v_mfma_f32_16x16x32_bf16 v[112:115], v[40:43], v[240:243], v[112:115]
  s_waitcnt lgkmcnt(5)
  v_cvt_pk_bf16_f32 v81, v82, v83
  v_mfma_f32_16x16x32_bf16 v[92:95], v[44:47], v[144:147], v[92:95]
  ds_read_b128 v[36:39], v17 offset:2048
  v_cvt_pk_bf16_f32 v82, v84, v85
  v_mfma_f32_16x16x32_bf16 v[100:103], v[44:47], v[176:179], v[100:103]
  v_cvt_pk_bf16_f32 v83, v86, v87
  v_accvgpr_write_b32 a192, v80
  v_mfma_f32_16x16x32_bf16 v[108:111], v[44:47], v[208:211], v[108:111]
  v_accvgpr_write_b32 a193, v81
  v_mfma_f32_16x16x32_bf16 v[116:119], v[44:47], v[240:243], v[116:119]
  s_waitcnt lgkmcnt(5)
  v_accvgpr_write_b32 a194, v82
  v_mfma_f32_16x16x32_bf16 v[88:91], v[48:51], v[148:151], v[88:91]
  ds_read_b128 v[40:43], v18 offset:0
  v_accvgpr_write_b32 a195, v83
  v_mfma_f32_16x16x32_bf16 v[96:99], v[48:51], v[180:183], v[96:99]
  v_mfma_f32_16x16x32_bf16 v[104:107], v[48:51], v[212:215], v[104:107]
  v_mfma_f32_16x16x32_bf16 v[112:115], v[48:51], v[244:247], v[112:115]
  s_waitcnt lgkmcnt(5)
  v_mfma_f32_16x16x32_bf16 v[92:95], v[52:55], v[148:151], v[92:95]
  ds_read_b128 v[44:47], v18 offset:2048
  v_mfma_f32_16x16x32_bf16 v[100:103], v[52:55], v[180:183], v[100:103]
  v_mfma_f32_16x16x32_bf16 v[108:111], v[52:55], v[212:215], v[108:111]
  v_mfma_f32_16x16x32_bf16 v[116:119], v[52:55], v[244:247], v[116:119]
  s_waitcnt lgkmcnt(5)
  v_mfma_f32_16x16x32_bf16 v[56:59], v[24:27], v[120:123], 0
  ds_read_b128 v[48:51], v19 offset:0
  v_mfma_f32_16x16x32_bf16 v[64:67], v[24:27], v[152:155], 0
  v_mfma_f32_16x16x32_bf16 v[72:75], v[24:27], v[184:187], 0
  v_mfma_f32_16x16x32_bf16 v[80:83], v[24:27], v[216:219], 0
  s_waitcnt lgkmcnt(5)
  v_mul_f32 v88, v12, v88
  v_mfma_f32_16x16x32_bf16 v[60:63], v[28:31], v[120:123], 0
  ds_read_b128 v[52:55], v19 offset:2048
  v_mul_f32 v89, v12, v89
  v_mfma_f32_16x16x32_bf16 v[68:71], v[28:31], v[152:155], 0
  v_mul_f32 v90, v12, v90
  v_mul_f32 v91, v12, v91
  v_mfma_f32_16x16x32_bf16 v[76:79], v[28:31], v[184:187], 0
  v_mul_f32 v92, v12, v92
  v_mfma_f32_16x16x32_bf16 v[84:87], v[28:31], v[216:219], 0
  s_waitcnt lgkmcnt(5)
  v_mul_f32 v93, v12, v93
  v_mfma_f32_16x16x32_bf16 v[56:59], v[32:35], v[124:127], v[56:59]
  ds_read_b128 v[24:27], v16 offset:256
  v_mul_f32 v94, v12, v94
  v_mfma_f32_16x16x32_bf16 v[64:67], v[32:35], v[156:159], v[64:67]
  v_mul_f32 v95, v12, v95
  v_cvt_pk_bf16_f32 v88, v88, v89
  v_mfma_f32_16x16x32_bf16 v[72:75], v[32:35], v[188:191], v[72:75]
  v_cvt_pk_bf16_f32 v89, v90, v91
  v_mfma_f32_16x16x32_bf16 v[80:83], v[32:35], v[220:223], v[80:83]
  s_waitcnt lgkmcnt(5)
  v_cvt_pk_bf16_f32 v90, v92, v93
  v_mfma_f32_16x16x32_bf16 v[60:63], v[36:39], v[124:127], v[60:63]
  ds_read_b128 v[28:31], v16 offset:2304
  v_cvt_pk_bf16_f32 v91, v94, v95
  v_mfma_f32_16x16x32_bf16 v[68:71], v[36:39], v[156:159], v[68:71]
  v_accvgpr_write_b32 a28, v88
  v_accvgpr_write_b32 a29, v89
  v_mfma_f32_16x16x32_bf16 v[76:79], v[36:39], v[188:191], v[76:79]
  v_accvgpr_write_b32 a30, v90
  v_mfma_f32_16x16x32_bf16 v[84:87], v[36:39], v[220:223], v[84:87]
  s_waitcnt lgkmcnt(5)
  v_accvgpr_write_b32 a31, v91
  v_mfma_f32_16x16x32_bf16 v[56:59], v[40:43], v[128:131], v[56:59]
  ds_read_b128 v[32:35], v17 offset:256
  v_mul_f32 v96, v12, v96
  v_mfma_f32_16x16x32_bf16 v[64:67], v[40:43], v[160:163], v[64:67]
  v_mul_f32 v97, v12, v97
  v_mul_f32 v98, v12, v98
  v_mfma_f32_16x16x32_bf16 v[72:75], v[40:43], v[192:195], v[72:75]
  v_mul_f32 v99, v12, v99
  v_mfma_f32_16x16x32_bf16 v[80:83], v[40:43], v[224:227], v[80:83]
  s_waitcnt lgkmcnt(5)
  v_mul_f32 v100, v12, v100
  v_mfma_f32_16x16x32_bf16 v[60:63], v[44:47], v[128:131], v[60:63]
  ds_read_b128 v[36:39], v17 offset:2304
  v_mul_f32 v101, v12, v101
  v_mfma_f32_16x16x32_bf16 v[68:71], v[44:47], v[160:163], v[68:71]
  v_mul_f32 v102, v12, v102
  v_mul_f32 v103, v12, v103
  v_mfma_f32_16x16x32_bf16 v[76:79], v[44:47], v[192:195], v[76:79]
  v_cvt_pk_bf16_f32 v96, v96, v97
  v_mfma_f32_16x16x32_bf16 v[84:87], v[44:47], v[224:227], v[84:87]
  s_waitcnt lgkmcnt(5)
  v_cvt_pk_bf16_f32 v97, v98, v99
  v_mfma_f32_16x16x32_bf16 v[56:59], v[48:51], v[132:135], v[56:59]
  ds_read_b128 v[40:43], v18 offset:256
  v_cvt_pk_bf16_f32 v98, v100, v101
  v_mfma_f32_16x16x32_bf16 v[64:67], v[48:51], v[164:167], v[64:67]
  v_cvt_pk_bf16_f32 v99, v102, v103
  v_accvgpr_write_b32 a84, v96
  v_mfma_f32_16x16x32_bf16 v[72:75], v[48:51], v[196:199], v[72:75]
  v_accvgpr_write_b32 a85, v97
  v_mfma_f32_16x16x32_bf16 v[80:83], v[48:51], v[228:231], v[80:83]
  s_waitcnt lgkmcnt(5)
  v_accvgpr_write_b32 a86, v98
  v_mfma_f32_16x16x32_bf16 v[60:63], v[52:55], v[132:135], v[60:63]
  ds_read_b128 v[44:47], v18 offset:2304
  v_accvgpr_write_b32 a87, v99
  v_mfma_f32_16x16x32_bf16 v[68:71], v[52:55], v[164:167], v[68:71]
  v_mul_f32 v104, v12, v104
  v_mul_f32 v105, v12, v105
  v_mfma_f32_16x16x32_bf16 v[76:79], v[52:55], v[196:199], v[76:79]
  v_mul_f32 v106, v12, v106
  v_mfma_f32_16x16x32_bf16 v[84:87], v[52:55], v[228:231], v[84:87]
  s_waitcnt lgkmcnt(5)
  v_mul_f32 v107, v12, v107
  v_mfma_f32_16x16x32_bf16 v[56:59], v[24:27], v[136:139], v[56:59]
  ds_read_b128 v[48:51], v19 offset:256
  v_mul_f32 v108, v12, v108
  v_mfma_f32_16x16x32_bf16 v[64:67], v[24:27], v[168:171], v[64:67]
  v_mul_f32 v109, v12, v109
  v_mul_f32 v110, v12, v110
  v_mfma_f32_16x16x32_bf16 v[72:75], v[24:27], v[200:203], v[72:75]
  v_mul_f32 v111, v12, v111
  v_mfma_f32_16x16x32_bf16 v[80:83], v[24:27], v[232:235], v[80:83]
  s_waitcnt lgkmcnt(5)
  v_cvt_pk_bf16_f32 v104, v104, v105
  v_mfma_f32_16x16x32_bf16 v[60:63], v[28:31], v[136:139], v[60:63]
  ds_read_b128 v[52:55], v19 offset:2304
  v_cvt_pk_bf16_f32 v105, v106, v107
  v_mfma_f32_16x16x32_bf16 v[68:71], v[28:31], v[168:171], v[68:71]
  v_cvt_pk_bf16_f32 v106, v108, v109
  v_cvt_pk_bf16_f32 v107, v110, v111
  v_mfma_f32_16x16x32_bf16 v[76:79], v[28:31], v[200:203], v[76:79]
  v_accvgpr_write_b32 a140, v104
  v_mfma_f32_16x16x32_bf16 v[84:87], v[28:31], v[232:235], v[84:87]
  s_waitcnt lgkmcnt(5)
  v_accvgpr_write_b32 a141, v105
  v_mfma_f32_16x16x32_bf16 v[56:59], v[32:35], v[140:143], v[56:59]
  s_waitcnt vmcnt(16)
  s_barrier
  ds_read_b128 v[24:27], v16 offset:16384
  v_accvgpr_write_b32 a142, v106
  v_mfma_f32_16x16x32_bf16 v[64:67], v[32:35], v[172:175], v[64:67]
  v_accvgpr_write_b32 a143, v107
  v_mul_f32 v112, v12, v112
  v_mfma_f32_16x16x32_bf16 v[72:75], v[32:35], v[204:207], v[72:75]
  v_mul_f32 v113, v12, v113
  v_mfma_f32_16x16x32_bf16 v[80:83], v[32:35], v[236:239], v[80:83]
  s_waitcnt lgkmcnt(5)
  v_mul_f32 v114, v12, v114
  v_mfma_f32_16x16x32_bf16 v[60:63], v[36:39], v[140:143], v[60:63]
  ds_read_b128 v[28:31], v16 offset:18432
  v_mul_f32 v115, v12, v115
  v_mfma_f32_16x16x32_bf16 v[68:71], v[36:39], v[172:175], v[68:71]
  v_mul_f32 v116, v12, v116
  v_mul_f32 v117, v12, v117
  v_mfma_f32_16x16x32_bf16 v[76:79], v[36:39], v[204:207], v[76:79]
  v_mul_f32 v118, v12, v118
  v_mfma_f32_16x16x32_bf16 v[84:87], v[36:39], v[236:239], v[84:87]
  s_waitcnt lgkmcnt(5)
  v_mul_f32 v119, v12, v119
  v_mfma_f32_16x16x32_bf16 v[56:59], v[40:43], v[144:147], v[56:59]
  ds_read_b128 v[32:35], v17 offset:16384
  v_cvt_pk_bf16_f32 v112, v112, v113
  v_mfma_f32_16x16x32_bf16 v[64:67], v[40:43], v[176:179], v[64:67]
  v_cvt_pk_bf16_f32 v113, v114, v115
  v_cvt_pk_bf16_f32 v114, v116, v117
  v_mfma_f32_16x16x32_bf16 v[72:75], v[40:43], v[208:211], v[72:75]
  v_cvt_pk_bf16_f32 v115, v118, v119
  v_mfma_f32_16x16x32_bf16 v[80:83], v[40:43], v[240:243], v[80:83]
  s_waitcnt lgkmcnt(5)
  v_accvgpr_write_b32 a196, v112
  v_mfma_f32_16x16x32_bf16 v[60:63], v[44:47], v[144:147], v[60:63]
  ds_read_b128 v[36:39], v17 offset:18432
  v_accvgpr_write_b32 a197, v113
  v_mfma_f32_16x16x32_bf16 v[68:71], v[44:47], v[176:179], v[68:71]
  v_accvgpr_write_b32 a198, v114
  v_accvgpr_write_b32 a199, v115
  v_mfma_f32_16x16x32_bf16 v[76:79], v[44:47], v[208:211], v[76:79]
  v_mfma_f32_16x16x32_bf16 v[84:87], v[44:47], v[240:243], v[84:87]
  s_waitcnt lgkmcnt(5)
  v_mfma_f32_16x16x32_bf16 v[56:59], v[48:51], v[148:151], v[56:59]
  ds_read_b128 v[40:43], v18 offset:16384
  v_mfma_f32_16x16x32_bf16 v[64:67], v[48:51], v[180:183], v[64:67]
  v_mfma_f32_16x16x32_bf16 v[72:75], v[48:51], v[212:215], v[72:75]
  v_mfma_f32_16x16x32_bf16 v[80:83], v[48:51], v[244:247], v[80:83]
  s_waitcnt lgkmcnt(5)
  v_mfma_f32_16x16x32_bf16 v[60:63], v[52:55], v[148:151], v[60:63]
  ds_read_b128 v[44:47], v18 offset:18432
  v_mfma_f32_16x16x32_bf16 v[68:71], v[52:55], v[180:183], v[68:71]
  v_mfma_f32_16x16x32_bf16 v[76:79], v[52:55], v[212:215], v[76:79]
  v_mfma_f32_16x16x32_bf16 v[84:87], v[52:55], v[244:247], v[84:87]
  s_waitcnt lgkmcnt(5)
  s_getpc_b64 s[98:99]
  s_add_u32 s98, s98, 4096
  s_addc_u32 s99, s99, 0
  global_load_dword v7, v6, s[98:99]
  v_mfma_f32_16x16x32_bf16 v[88:91], v[24:27], v[120:123], 0
  ds_read_b128 v[48:51], v19 offset:16384
  v_mfma_f32_16x16x32_bf16 v[96:99], v[24:27], v[152:155], 0
  v_mfma_f32_16x16x32_bf16 v[104:107], v[24:27], v[184:187], 0
  v_mfma_f32_16x16x32_bf16 v[112:115], v[24:27], v[216:219], 0
  s_waitcnt lgkmcnt(5)
  v_mul_f32 v56, v12, v56
  v_mfma_f32_16x16x32_bf16 v[92:95], v[28:31], v[120:123], 0
  ds_read_b128 v[52:55], v19 offset:18432
  v_mul_f32 v57, v12, v57
  v_mfma_f32_16x16x32_bf16 v[100:103], v[28:31], v[152:155], 0
  v_mul_f32 v58, v12, v58
  v_mul_f32 v59, v12, v59
  v_mfma_f32_16x16x32_bf16 v[108:111], v[28:31], v[184:187], 0
  v_mul_f32 v60, v12, v60
  v_mfma_f32_16x16x32_bf16 v[116:119], v[28:31], v[216:219], 0
  s_waitcnt lgkmcnt(5)
  v_mul_f32 v61, v12, v61
  v_mfma_f32_16x16x32_bf16 v[88:91], v[32:35], v[124:127], v[88:91]
  ds_read_b128 v[24:27], v16 offset:16640
  v_mul_f32 v62, v12, v62
  v_mfma_f32_16x16x32_bf16 v[96:99], v[32:35], v[156:159], v[96:99]
  v_mul_f32 v63, v12, v63
  v_cvt_pk_bf16_f32 v56, v56, v57
  v_mfma_f32_16x16x32_bf16 v[104:107], v[32:35], v[188:191], v[104:107]
  v_cvt_pk_bf16_f32 v57, v58, v59
  v_mfma_f32_16x16x32_bf16 v[112:115], v[32:35], v[220:223], v[112:115]
  s_waitcnt lgkmcnt(5)
  v_cvt_pk_bf16_f32 v58, v60, v61
  v_mfma_f32_16x16x32_bf16 v[92:95], v[36:39], v[124:127], v[92:95]
  ds_read_b128 v[28:31], v16 offset:18688
  v_cvt_pk_bf16_f32 v59, v62, v63
  v_mfma_f32_16x16x32_bf16 v[100:103], v[36:39], v[156:159], v[100:103]
  v_accvgpr_write_b32 a32, v56
  v_accvgpr_write_b32 a33, v57
  v_mfma_f32_16x16x32_bf16 v[108:111], v[36:39], v[188:191], v[108:111]
  v_accvgpr_write_b32 a34, v58
  v_mfma_f32_16x16x32_bf16 v[116:119], v[36:39], v[220:223], v[116:119]
  s_waitcnt lgkmcnt(5)
  v_accvgpr_write_b32 a35, v59
  v_mfma_f32_16x16x32_bf16 v[88:91], v[40:43], v[128:131], v[88:91]
  ds_read_b128 v[32:35], v17 offset:16640
  v_mul_f32 v64, v12, v64
  v_mfma_f32_16x16x32_bf16 v[96:99], v[40:43], v[160:163], v[96:99]
  v_mul_f32 v65, v12, v65
  v_mul_f32 v66, v12, v66
  v_mfma_f32_16x16x32_bf16 v[104:107], v[40:43], v[192:195], v[104:107]
  v_mul_f32 v67, v12, v67
  v_mfma_f32_16x16x32_bf16 v[112:115], v[40:43], v[224:227], v[112:115]
  s_waitcnt lgkmcnt(5)
  v_mul_f32 v68, v12, v68
  v_mfma_f32_16x16x32_bf16 v[92:95], v[44:47], v[128:131], v[92:95]
  ds_read_b128 v[36:39], v17 offset:18688
  v_mul_f32 v69, v12, v69
  v_mfma_f32_16x16x32_bf16 v[100:103], v[44:47], v[160:163], v[100:103]
  v_mul_f32 v70, v12, v70
  v_mul_f32 v71, v12, v71
  v_mfma_f32_16x16x32_bf16 v[108:111], v[44:47], v[192:195], v[108:111]
  v_cvt_pk_bf16_f32 v64, v64, v65
  v_mfma_f32_16x16x32_bf16 v[116:119], v[44:47], v[224:227], v[116:119]
  s_waitcnt lgkmcnt(5)
  v_cvt_pk_bf16_f32 v65, v66, v67
  v_mfma_f32_16x16x32_bf16 v[88:91], v[48:51], v[132:135], v[88:91]
  ds_read_b128 v[40:43], v18 offset:16640
  v_cvt_pk_bf16_f32 v66, v68, v69
  v_mfma_f32_16x16x32_bf16 v[96:99], v[48:51], v[164:167], v[96:99]
  v_cvt_pk_bf16_f32 v67, v70, v71
  v_accvgpr_write_b32 a88, v64
  v_mfma_f32_16x16x32_bf16 v[104:107], v[48:51], v[196:199], v[104:107]
  v_accvgpr_write_b32 a89, v65
  v_mfma_f32_16x16x32_bf16 v[112:115], v[48:51], v[228:231], v[112:115]
  s_waitcnt lgkmcnt(5)
  v_accvgpr_write_b32 a90, v66
  v_mfma_f32_16x16x32_bf16 v[92:95], v[52:55], v[132:135], v[92:95]
  ds_read_b128 v[44:47], v18 offset:18688
  v_accvgpr_write_b32 a91, v67
  v_mfma_f32_16x16x32_bf16 v[100:103], v[52:55], v[164:167], v[100:103]
  v_mul_f32 v72, v12, v72
  v_mul_f32 v73, v12, v73
  v_mfma_f32_16x16x32_bf16 v[108:111], v[52:55], v[196:199], v[108:111]
  v_mul_f32 v74, v12, v74
  v_mfma_f32_16x16x32_bf16 v[116:119], v[52:55], v[228:231], v[116:119]
  s_waitcnt lgkmcnt(5)
  v_mul_f32 v75, v12, v75
  v_mfma_f32_16x16x32_bf16 v[88:91], v[24:27], v[136:139], v[88:91]
  ds_read_b128 v[48:51], v19 offset:16640
  v_mul_f32 v76, v12, v76
  v_mfma_f32_16x16x32_bf16 v[96:99], v[24:27], v[168:171], v[96:99]
  v_mul_f32 v77, v12, v77
  v_mul_f32 v78, v12, v78
  v_mfma_f32_16x16x32_bf16 v[104:107], v[24:27], v[200:203], v[104:107]
  v_mul_f32 v79, v12, v79
  v_mfma_f32_16x16x32_bf16 v[112:115], v[24:27], v[232:235], v[112:115]
  s_waitcnt lgkmcnt(5)
  v_cvt_pk_bf16_f32 v72, v72, v73
  v_mfma_f32_16x16x32_bf16 v[92:95], v[28:31], v[136:139], v[92:95]
  ds_read_b128 v[52:55], v19 offset:18688
  v_cvt_pk_bf16_f32 v73, v74, v75
  v_mfma_f32_16x16x32_bf16 v[100:103], v[28:31], v[168:171], v[100:103]
  v_cvt_pk_bf16_f32 v74, v76, v77
  v_cvt_pk_bf16_f32 v75, v78, v79
  v_mfma_f32_16x16x32_bf16 v[108:111], v[28:31], v[200:203], v[108:111]
  v_accvgpr_write_b32 a144, v72
  v_mfma_f32_16x16x32_bf16 v[116:119], v[28:31], v[232:235], v[116:119]
  s_waitcnt lgkmcnt(5)
  v_accvgpr_write_b32 a145, v73
  v_mfma_f32_16x16x32_bf16 v[88:91], v[32:35], v[140:143], v[88:91]
  s_waitcnt vmcnt(12)
  s_barrier
  ds_read_b128 v[24:27], v248 offset:0
  v_accvgpr_write_b32 a146, v74
  v_mfma_f32_16x16x32_bf16 v[96:99], v[32:35], v[172:175], v[96:99]
  v_accvgpr_write_b32 a147, v75
  v_mul_f32 v80, v12, v80
  v_mfma_f32_16x16x32_bf16 v[104:107], v[32:35], v[204:207], v[104:107]
  v_mul_f32 v81, v12, v81
  v_mfma_f32_16x16x32_bf16 v[112:115], v[32:35], v[236:239], v[112:115]
  s_waitcnt lgkmcnt(5)
  v_mul_f32 v82, v12, v82
  v_mfma_f32_16x16x32_bf16 v[92:95], v[36:39], v[140:143], v[92:95]
  ds_read_b128 v[28:31], v248 offset:2048
  v_mul_f32 v83, v12, v83
  v_mfma_f32_16x16x32_bf16 v[100:103], v[36:39], v[172:175], v[100:103]
  v_mul_f32 v84, v12, v84
  v_mul_f32 v85, v12, v85
  v_mfma_f32_16x16x32_bf16 v[108:111], v[36:39], v[204:207], v[108:111]
  v_mul_f32 v86, v12, v86
  v_mfma_f32_16x16x32_bf16 v[116:119], v[36:39], v[236:239], v[116:119]
  s_waitcnt lgkmcnt(5)
  v_mul_f32 v87, v12, v87
  v_mfma_f32_16x16x32_bf16 v[88:91], v[40:43], v[144:147], v[88:91]
  ds_read_b128 v[32:35], v249 offset:0
  v_cvt_pk_bf16_f32 v80, v80, v81
  v_mfma_f32_16x16x32_bf16 v[96:99], v[40:43], v[176:179], v[96:99]
  v_cvt_pk_bf16_f32 v81, v82, v83
  v_cvt_pk_bf16_f32 v82, v84, v85
  v_mfma_f32_16x16x32_bf16 v[104:107], v[40:43], v[208:211], v[104:107]
  v_cvt_pk_bf16_f32 v83, v86, v87
  v_mfma_f32_16x16x32_bf16 v[112:115], v[40:43], v[240:243], v[112:115]
  s_waitcnt lgkmcnt(5)
  v_accvgpr_write_b32 a200, v80
  v_mfma_f32_16x16x32_bf16 v[92:95], v[44:47], v[144:147], v[92:95]
  ds_read_b128 v[36:39], v249 offset:2048
  v_accvgpr_write_b32 a201, v81
  v_mfma_f32_16x16x32_bf16 v[100:103], v[44:47], v[176:179], v[100:103]
  v_accvgpr_write_b32 a202, v82
  v_accvgpr_write_b32 a203, v83
  v_mfma_f32_16x16x32_bf16 v[108:111], v[44:47], v[208:211], v[108:111]
  v_mfma_f32_16x16x32_bf16 v[116:119], v[44:47], v[240:243], v[116:119]
  s_waitcnt lgkmcnt(5)
  v_mfma_f32_16x16x32_bf16 v[88:91], v[48:51], v[148:151], v[88:91]
  ds_read_b128 v[40:43], v250 offset:0
  v_mfma_f32_16x16x32_bf16 v[96:99], v[48:51], v[180:183], v[96:99]
  v_mfma_f32_16x16x32_bf16 v[104:107], v[48:51], v[212:215], v[104:107]
  v_mfma_f32_16x16x32_bf16 v[112:115], v[48:51], v[244:247], v[112:115]
  s_waitcnt lgkmcnt(5)
  v_mfma_f32_16x16x32_bf16 v[92:95], v[52:55], v[148:151], v[92:95]
  ds_read_b128 v[44:47], v250 offset:2048
  v_mfma_f32_16x16x32_bf16 v[100:103], v[52:55], v[180:183], v[100:103]
  v_mfma_f32_16x16x32_bf16 v[108:111], v[52:55], v[212:215], v[108:111]
  v_mfma_f32_16x16x32_bf16 v[116:119], v[52:55], v[244:247], v[116:119]
  s_waitcnt lgkmcnt(5)
  v_mfma_f32_16x16x32_bf16 v[56:59], v[24:27], v[120:123], 0
  ds_read_b128 v[48:51], v251 offset:0
  v_mfma_f32_16x16x32_bf16 v[64:67], v[24:27], v[152:155], 0
  v_mfma_f32_16x16x32_bf16 v[72:75], v[24:27], v[184:187], 0
  v_mfma_f32_16x16x32_bf16 v[80:83], v[24:27], v[216:219], 0
  s_waitcnt lgkmcnt(5)
  v_mul_f32 v88, v12, v88
  v_mfma_f32_16x16x32_bf16 v[60:63], v[28:31], v[120:123], 0
  ds_read_b128 v[52:55], v251 offset:2048
  v_mul_f32 v89, v12, v89
  v_mfma_f32_16x16x32_bf16 v[68:71], v[28:31], v[152:155], 0
  v_mul_f32 v90, v12, v90
  v_mul_f32 v91, v12, v91
  v_mfma_f32_16x16x32_bf16 v[76:79], v[28:31], v[184:187], 0
  v_mul_f32 v92, v12, v92
  v_mfma_f32_16x16x32_bf16 v[84:87], v[28:31], v[216:219], 0
  s_waitcnt lgkmcnt(5)
  v_mul_f32 v93, v12, v93
  v_mfma_f32_16x16x32_bf16 v[56:59], v[32:35], v[124:127], v[56:59]
  ds_read_b128 v[24:27], v248 offset:256
  v_mul_f32 v94, v12, v94
  v_mfma_f32_16x16x32_bf16 v[64:67], v[32:35], v[156:159], v[64:67]
  v_mul_f32 v95, v12, v95
  v_cvt_pk_bf16_f32 v88, v88, v89
  v_mfma_f32_16x16x32_bf16 v[72:75], v[32:35], v[188:191], v[72:75]
  v_cvt_pk_bf16_f32 v89, v90, v91
  v_mfma_f32_16x16x32_bf16 v[80:83], v[32:35], v[220:223], v[80:83]
  s_waitcnt lgkmcnt(5)
  v_cvt_pk_bf16_f32 v90, v92, v93
  v_mfma_f32_16x16x32_bf16 v[60:63], v[36:39], v[124:127], v[60:63]
  ds_read_b128 v[28:31], v248 offset:2304
  v_cvt_pk_bf16_f32 v91, v94, v95
  v_mfma_f32_16x16x32_bf16 v[68:71], v[36:39], v[156:159], v[68:71]
  v_accvgpr_write_b32 a36, v88
  v_accvgpr_write_b32 a37, v89
  v_mfma_f32_16x16x32_bf16 v[76:79], v[36:39], v[188:191], v[76:79]
  v_accvgpr_write_b32 a38, v90
  v_mfma_f32_16x16x32_bf16 v[84:87], v[36:39], v[220:223], v[84:87]
  s_waitcnt lgkmcnt(5)
  v_accvgpr_write_b32 a39, v91
  v_mfma_f32_16x16x32_bf16 v[56:59], v[40:43], v[128:131], v[56:59]
  ds_read_b128 v[32:35], v249 offset:256
  v_mul_f32 v96, v12, v96
  v_mfma_f32_16x16x32_bf16 v[64:67], v[40:43], v[160:163], v[64:67]
  v_mul_f32 v97, v12, v97
  v_mul_f32 v98, v12, v98
  v_mfma_f32_16x16x32_bf16 v[72:75], v[40:43], v[192:195], v[72:75]
  v_mul_f32 v99, v12, v99
  v_mfma_f32_16x16x32_bf16 v[80:83], v[40:43], v[224:227], v[80:83]
  s_waitcnt lgkmcnt(5)
  v_mul_f32 v100, v12, v100
  v_mfma_f32_16x16x32_bf16 v[60:63], v[44:47], v[128:131], v[60:63]
  ds_read_b128 v[36:39], v249 offset:2304
  v_mul_f32 v101, v12, v101
  v_mfma_f32_16x16x32_bf16 v[68:71], v[44:47], v[160:163], v[68:71]
  v_mul_f32 v102, v12, v102
  v_mul_f32 v103, v12, v103
  v_mfma_f32_16x16x32_bf16 v[76:79], v[44:47], v[192:195], v[76:79]
  v_cvt_pk_bf16_f32 v96, v96, v97
  v_mfma_f32_16x16x32_bf16 v[84:87], v[44:47], v[224:227], v[84:87]
  s_waitcnt lgkmcnt(5)
  v_cvt_pk_bf16_f32 v97, v98, v99
  v_mfma_f32_16x16x32_bf16 v[56:59], v[48:51], v[132:135], v[56:59]
  ds_read_b128 v[40:43], v250 offset:256
  v_cvt_pk_bf16_f32 v98, v100, v101
  v_mfma_f32_16x16x32_bf16 v[64:67], v[48:51], v[164:167], v[64:67]
  v_cvt_pk_bf16_f32 v99, v102, v103
  v_accvgpr_write_b32 a92, v96
  v_mfma_f32_16x16x32_bf16 v[72:75], v[48:51], v[196:199], v[72:75]
  v_accvgpr_write_b32 a93, v97
  v_mfma_f32_16x16x32_bf16 v[80:83], v[48:51], v[228:231], v[80:83]
  s_waitcnt lgkmcnt(5)
  v_accvgpr_write_b32 a94, v98
  v_mfma_f32_16x16x32_bf16 v[60:63], v[52:55], v[132:135], v[60:63]
  ds_read_b128 v[44:47], v250 offset:2304
  v_accvgpr_write_b32 a95, v99
  v_mfma_f32_16x16x32_bf16 v[68:71], v[52:55], v[164:167], v[68:71]
  v_mul_f32 v104, v12, v104
  v_mul_f32 v105, v12, v105
  v_mfma_f32_16x16x32_bf16 v[76:79], v[52:55], v[196:199], v[76:79]
  v_mul_f32 v106, v12, v106
  v_mfma_f32_16x16x32_bf16 v[84:87], v[52:55], v[228:231], v[84:87]
  s_waitcnt lgkmcnt(5)
  v_mul_f32 v107, v12, v107
  v_mfma_f32_16x16x32_bf16 v[56:59], v[24:27], v[136:139], v[56:59]
  ds_read_b128 v[48:51], v251 offset:256
  v_mul_f32 v108, v12, v108
  v_mfma_f32_16x16x32_bf16 v[64:67], v[24:27], v[168:171], v[64:67]
  v_mul_f32 v109, v12, v109
  v_mul_f32 v110, v12, v110
  v_mfma_f32_16x16x32_bf16 v[72:75], v[24:27], v[200:203], v[72:75]
  v_mul_f32 v111, v12, v111
  v_mfma_f32_16x16x32_bf16 v[80:83], v[24:27], v[232:235], v[80:83]
  s_waitcnt lgkmcnt(5)
  v_cvt_pk_bf16_f32 v104, v104, v105
  v_mfma_f32_16x16x32_bf16 v[60:63], v[28:31], v[136:139], v[60:63]
  ds_read_b128 v[52:55], v251 offset:2304
  v_cvt_pk_bf16_f32 v105, v106, v107
  v_mfma_f32_16x16x32_bf16 v[68:71], v[28:31], v[168:171], v[68:71]
  v_cvt_pk_bf16_f32 v106, v108, v109
  v_cvt_pk_bf16_f32 v107, v110, v111
  v_mfma_f32_16x16x32_bf16 v[76:79], v[28:31], v[200:203], v[76:79]
  v_accvgpr_write_b32 a148, v104
  v_mfma_f32_16x16x32_bf16 v[84:87], v[28:31], v[232:235], v[84:87]
  s_waitcnt lgkmcnt(5)
  v_accvgpr_write_b32 a149, v105
  v_mfma_f32_16x16x32_bf16 v[56:59], v[32:35], v[140:143], v[56:59]
  s_waitcnt vmcnt(8)
  s_barrier
  ds_read_b128 v[24:27], v248 offset:16384
  v_accvgpr_write_b32 a150, v106
  v_mfma_f32_16x16x32_bf16 v[64:67], v[32:35], v[172:175], v[64:67]
  v_accvgpr_write_b32 a151, v107
  v_mul_f32 v112, v12, v112
  v_mfma_f32_16x16x32_bf16 v[72:75], v[32:35], v[204:207], v[72:75]
  v_mul_f32 v113, v12, v113
  v_mfma_f32_16x16x32_bf16 v[80:83], v[32:35], v[236:239], v[80:83]
  s_waitcnt lgkmcnt(5)
  v_mul_f32 v114, v12, v114
  v_mfma_f32_16x16x32_bf16 v[60:63], v[36:39], v[140:143], v[60:63]
  ds_read_b128 v[28:31], v248 offset:18432
  v_mul_f32 v115, v12, v115
  v_mfma_f32_16x16x32_bf16 v[68:71], v[36:39], v[172:175], v[68:71]
  v_mul_f32 v116, v12, v116
  v_mul_f32 v117, v12, v117
  v_mfma_f32_16x16x32_bf16 v[76:79], v[36:39], v[204:207], v[76:79]
  v_mul_f32 v118, v12, v118
  v_mfma_f32_16x16x32_bf16 v[84:87], v[36:39], v[236:239], v[84:87]
  s_waitcnt lgkmcnt(5)
  v_mul_f32 v119, v12, v119
  v_mfma_f32_16x16x32_bf16 v[56:59], v[40:43], v[144:147], v[56:59]
  ds_read_b128 v[32:35], v249 offset:16384
  v_cvt_pk_bf16_f32 v112, v112, v113
  v_mfma_f32_16x16x32_bf16 v[64:67], v[40:43], v[176:179], v[64:67]
  v_cvt_pk_bf16_f32 v113, v114, v115
  v_cvt_pk_bf16_f32 v114, v116, v117
  v_mfma_f32_16x16x32_bf16 v[72:75], v[40:43], v[208:211], v[72:75]
  v_cvt_pk_bf16_f32 v115, v118, v119
  v_mfma_f32_16x16x32_bf16 v[80:83], v[40:43], v[240:243], v[80:83]
  s_waitcnt lgkmcnt(5)
  v_accvgpr_write_b32 a204, v112
  v_mfma_f32_16x16x32_bf16 v[60:63], v[44:47], v[144:147], v[60:63]
  ds_read_b128 v[36:39], v249 offset:18432
  v_accvgpr_write_b32 a205, v113
  v_mfma_f32_16x16x32_bf16 v[68:71], v[44:47], v[176:179], v[68:71]
  v_accvgpr_write_b32 a206, v114
  v_accvgpr_write_b32 a207, v115
  v_mfma_f32_16x16x32_bf16 v[76:79], v[44:47], v[208:211], v[76:79]
  v_mfma_f32_16x16x32_bf16 v[84:87], v[44:47], v[240:243], v[84:87]
  s_waitcnt lgkmcnt(5)
  v_mfma_f32_16x16x32_bf16 v[56:59], v[48:51], v[148:151], v[56:59]
  ds_read_b128 v[40:43], v250 offset:16384
  v_mfma_f32_16x16x32_bf16 v[64:67], v[48:51], v[180:183], v[64:67]
  v_mfma_f32_16x16x32_bf16 v[72:75], v[48:51], v[212:215], v[72:75]
  v_mfma_f32_16x16x32_bf16 v[80:83], v[48:51], v[244:247], v[80:83]
  s_waitcnt lgkmcnt(5)
  v_mfma_f32_16x16x32_bf16 v[60:63], v[52:55], v[148:151], v[60:63]
  ds_read_b128 v[44:47], v250 offset:18432
  v_mfma_f32_16x16x32_bf16 v[68:71], v[52:55], v[180:183], v[68:71]
  v_mfma_f32_16x16x32_bf16 v[76:79], v[52:55], v[212:215], v[76:79]
  v_mfma_f32_16x16x32_bf16 v[84:87], v[52:55], v[244:247], v[84:87]
  s_waitcnt lgkmcnt(5)
  v_mfma_f32_16x16x32_bf16 v[88:91], v[24:27], v[120:123], 0
  ds_read_b128 v[48:51], v251 offset:16384
  v_mfma_f32_16x16x32_bf16 v[96:99], v[24:27], v[152:155], 0
  v_mfma_f32_16x16x32_bf16 v[104:107], v[24:27], v[184:187], 0
  v_mfma_f32_16x16x32_bf16 v[112:115], v[24:27], v[216:219], 0
  s_waitcnt lgkmcnt(5)
  v_mul_f32 v56, v12, v56
  v_mfma_f32_16x16x32_bf16 v[92:95], v[28:31], v[120:123], 0
  ds_read_b128 v[52:55], v251 offset:18432
  v_mul_f32 v57, v12, v57
  v_mfma_f32_16x16x32_bf16 v[100:103], v[28:31], v[152:155], 0
  v_mul_f32 v58, v12, v58
  v_mul_f32 v59, v12, v59
  v_mfma_f32_16x16x32_bf16 v[108:111], v[28:31], v[184:187], 0
  v_mul_f32 v60, v12, v60
  v_mfma_f32_16x16x32_bf16 v[116:119], v[28:31], v[216:219], 0
  s_waitcnt lgkmcnt(5)
  v_mul_f32 v61, v12, v61
  v_mfma_f32_16x16x32_bf16 v[88:91], v[32:35], v[124:127], v[88:91]
  ds_read_b128 v[24:27], v248 offset:16640
  v_mul_f32 v62, v12, v62
  v_mfma_f32_16x16x32_bf16 v[96:99], v[32:35], v[156:159], v[96:99]
  v_mul_f32 v63, v12, v63
  v_cvt_pk_bf16_f32 v56, v56, v57
  v_mfma_f32_16x16x32_bf16 v[104:107], v[32:35], v[188:191], v[104:107]
  v_cvt_pk_bf16_f32 v57, v58, v59
  v_mfma_f32_16x16x32_bf16 v[112:115], v[32:35], v[220:223], v[112:115]
  s_waitcnt lgkmcnt(5)
  v_cvt_pk_bf16_f32 v58, v60, v61
  v_mfma_f32_16x16x32_bf16 v[92:95], v[36:39], v[124:127], v[92:95]
  ds_read_b128 v[28:31], v248 offset:18688
  v_cvt_pk_bf16_f32 v59, v62, v63
  v_mfma_f32_16x16x32_bf16 v[100:103], v[36:39], v[156:159], v[100:103]
  v_accvgpr_write_b32 a40, v56
  v_accvgpr_write_b32 a41, v57
  v_mfma_f32_16x16x32_bf16 v[108:111], v[36:39], v[188:191], v[108:111]
  v_accvgpr_write_b32 a42, v58
  v_mfma_f32_16x16x32_bf16 v[116:119], v[36:39], v[220:223], v[116:119]
  s_waitcnt lgkmcnt(5)
  v_accvgpr_write_b32 a43, v59
  v_mfma_f32_16x16x32_bf16 v[88:91], v[40:43], v[128:131], v[88:91]
  ds_read_b128 v[32:35], v249 offset:16640
  v_mul_f32 v64, v12, v64
  v_mfma_f32_16x16x32_bf16 v[96:99], v[40:43], v[160:163], v[96:99]
  v_mul_f32 v65, v12, v65
  v_mul_f32 v66, v12, v66
  v_mfma_f32_16x16x32_bf16 v[104:107], v[40:43], v[192:195], v[104:107]
  v_mul_f32 v67, v12, v67
  v_mfma_f32_16x16x32_bf16 v[112:115], v[40:43], v[224:227], v[112:115]
  s_waitcnt lgkmcnt(5)
  v_mul_f32 v68, v12, v68
  v_mfma_f32_16x16x32_bf16 v[92:95], v[44:47], v[128:131], v[92:95]
  ds_read_b128 v[36:39], v249 offset:18688
  v_mul_f32 v69, v12, v69
  v_mfma_f32_16x16x32_bf16 v[100:103], v[44:47], v[160:163], v[100:103]
  v_mul_f32 v70, v12, v70
  v_mul_f32 v71, v12, v71
  v_mfma_f32_16x16x32_bf16 v[108:111], v[44:47], v[192:195], v[108:111]
  v_cvt_pk_bf16_f32 v64, v64, v65
  v_mfma_f32_16x16x32_bf16 v[116:119], v[44:47], v[224:227], v[116:119]
  s_waitcnt lgkmcnt(5)
  v_cvt_pk_bf16_f32 v65, v66, v67
  v_mfma_f32_16x16x32_bf16 v[88:91], v[48:51], v[132:135], v[88:91]
  ds_read_b128 v[40:43], v250 offset:16640
  v_cvt_pk_bf16_f32 v66, v68, v69
  v_mfma_f32_16x16x32_bf16 v[96:99], v[48:51], v[164:167], v[96:99]
  v_cvt_pk_bf16_f32 v67, v70, v71
  v_accvgpr_write_b32 a96, v64
  v_mfma_f32_16x16x32_bf16 v[104:107], v[48:51], v[196:199], v[104:107]
  v_accvgpr_write_b32 a97, v65
  v_mfma_f32_16x16x32_bf16 v[112:115], v[48:51], v[228:231], v[112:115]
  s_waitcnt lgkmcnt(5)
  v_accvgpr_write_b32 a98, v66
  v_mfma_f32_16x16x32_bf16 v[92:95], v[52:55], v[132:135], v[92:95]
  ds_read_b128 v[44:47], v250 offset:18688
  v_accvgpr_write_b32 a99, v67
  v_mfma_f32_16x16x32_bf16 v[100:103], v[52:55], v[164:167], v[100:103]
  v_mul_f32 v72, v12, v72
  v_mul_f32 v73, v12, v73
  v_mfma_f32_16x16x32_bf16 v[108:111], v[52:55], v[196:199], v[108:111]
  v_mul_f32 v74, v12, v74
  v_mfma_f32_16x16x32_bf16 v[116:119], v[52:55], v[228:231], v[116:119]
  s_waitcnt lgkmcnt(5)
  v_mul_f32 v75, v12, v75
  v_mfma_f32_16x16x32_bf16 v[88:91], v[24:27], v[136:139], v[88:91]
  ds_read_b128 v[48:51], v251 offset:16640
  v_mul_f32 v76, v12, v76
  v_mfma_f32_16x16x32_bf16 v[96:99], v[24:27], v[168:171], v[96:99]
  v_mul_f32 v77, v12, v77
  v_mul_f32 v78, v12, v78
  v_mfma_f32_16x16x32_bf16 v[104:107], v[24:27], v[200:203], v[104:107]
  v_mul_f32 v79, v12, v79
  v_mfma_f32_16x16x32_bf16 v[112:115], v[24:27], v[232:235], v[112:115]
  s_waitcnt lgkmcnt(5)
  v_cvt_pk_bf16_f32 v72, v72, v73
  v_mfma_f32_16x16x32_bf16 v[92:95], v[28:31], v[136:139], v[92:95]
  ds_read_b128 v[52:55], v251 offset:18688
  v_cvt_pk_bf16_f32 v73, v74, v75
  v_mfma_f32_16x16x32_bf16 v[100:103], v[28:31], v[168:171], v[100:103]
  v_cvt_pk_bf16_f32 v74, v76, v77
  v_cvt_pk_bf16_f32 v75, v78, v79
  v_mfma_f32_16x16x32_bf16 v[108:111], v[28:31], v[200:203], v[108:111]
  v_accvgpr_write_b32 a152, v72
  v_mfma_f32_16x16x32_bf16 v[116:119], v[28:31], v[232:235], v[116:119]
  s_waitcnt lgkmcnt(5)
  v_accvgpr_write_b32 a153, v73
  v_mfma_f32_16x16x32_bf16 v[88:91], v[32:35], v[140:143], v[88:91]
  s_waitcnt vmcnt(4)
  s_barrier
  ds_read_b128 v[24:27], v248 offset:32768
  v_accvgpr_write_b32 a154, v74
  v_mfma_f32_16x16x32_bf16 v[96:99], v[32:35], v[172:175], v[96:99]
  v_accvgpr_write_b32 a155, v75
  v_mul_f32 v80, v12, v80
  v_mfma_f32_16x16x32_bf16 v[104:107], v[32:35], v[204:207], v[104:107]
  v_mul_f32 v81, v12, v81
  v_mfma_f32_16x16x32_bf16 v[112:115], v[32:35], v[236:239], v[112:115]
  s_waitcnt lgkmcnt(5)
  v_mul_f32 v82, v12, v82
  v_mfma_f32_16x16x32_bf16 v[92:95], v[36:39], v[140:143], v[92:95]
  ds_read_b128 v[28:31], v248 offset:34816
  v_mul_f32 v83, v12, v83
  v_mfma_f32_16x16x32_bf16 v[100:103], v[36:39], v[172:175], v[100:103]
  v_mul_f32 v84, v12, v84
  v_mul_f32 v85, v12, v85
  v_mfma_f32_16x16x32_bf16 v[108:111], v[36:39], v[204:207], v[108:111]
  v_mul_f32 v86, v12, v86
  v_mfma_f32_16x16x32_bf16 v[116:119], v[36:39], v[236:239], v[116:119]
  s_waitcnt lgkmcnt(5)
  v_mul_f32 v87, v12, v87
  v_mfma_f32_16x16x32_bf16 v[88:91], v[40:43], v[144:147], v[88:91]
  ds_read_b128 v[32:35], v249 offset:32768
  v_cvt_pk_bf16_f32 v80, v80, v81
  v_mfma_f32_16x16x32_bf16 v[96:99], v[40:43], v[176:179], v[96:99]
  v_cvt_pk_bf16_f32 v81, v82, v83
  v_cvt_pk_bf16_f32 v82, v84, v85
  v_mfma_f32_16x16x32_bf16 v[104:107], v[40:43], v[208:211], v[104:107]
  v_cvt_pk_bf16_f32 v83, v86, v87
  v_mfma_f32_16x16x32_bf16 v[112:115], v[40:43], v[240:243], v[112:115]
  s_waitcnt lgkmcnt(5)
  v_accvgpr_write_b32 a208, v80
  v_mfma_f32_16x16x32_bf16 v[92:95], v[44:47], v[144:147], v[92:95]
  ds_read_b128 v[36:39], v249 offset:34816
  v_accvgpr_write_b32 a209, v81
  v_mfma_f32_16x16x32_bf16 v[100:103], v[44:47], v[176:179], v[100:103]
  v_accvgpr_write_b32 a210, v82
  v_accvgpr_write_b32 a211, v83
  v_mfma_f32_16x16x32_bf16 v[108:111], v[44:47], v[208:211], v[108:111]
  v_mfma_f32_16x16x32_bf16 v[116:119], v[44:47], v[240:243], v[116:119]
  s_waitcnt lgkmcnt(5)
  v_mfma_f32_16x16x32_bf16 v[88:91], v[48:51], v[148:151], v[88:91]
  ds_read_b128 v[40:43], v250 offset:32768
  v_mfma_f32_16x16x32_bf16 v[96:99], v[48:51], v[180:183], v[96:99]
  v_mfma_f32_16x16x32_bf16 v[104:107], v[48:51], v[212:215], v[104:107]
  v_mfma_f32_16x16x32_bf16 v[112:115], v[48:51], v[244:247], v[112:115]
  s_waitcnt lgkmcnt(5)
  v_mfma_f32_16x16x32_bf16 v[92:95], v[52:55], v[148:151], v[92:95]
  ds_read_b128 v[44:47], v250 offset:34816
  v_mfma_f32_16x16x32_bf16 v[100:103], v[52:55], v[180:183], v[100:103]
  v_mfma_f32_16x16x32_bf16 v[108:111], v[52:55], v[212:215], v[108:111]
  v_mfma_f32_16x16x32_bf16 v[116:119], v[52:55], v[244:247], v[116:119]
  s_waitcnt lgkmcnt(5)
  v_mfma_f32_16x16x32_bf16 v[56:59], v[24:27], v[120:123], 0
  ds_read_b128 v[48:51], v251 offset:32768
  v_mfma_f32_16x16x32_bf16 v[64:67], v[24:27], v[152:155], 0
  v_mfma_f32_16x16x32_bf16 v[72:75], v[24:27], v[184:187], 0
  v_mfma_f32_16x16x32_bf16 v[80:83], v[24:27], v[216:219], 0
  s_waitcnt lgkmcnt(5)
  v_mul_f32 v88, v12, v88
  v_mfma_f32_16x16x32_bf16 v[60:63], v[28:31], v[120:123], 0
  ds_read_b128 v[52:55], v251 offset:34816
  v_mul_f32 v89, v12, v89
  v_mfma_f32_16x16x32_bf16 v[68:71], v[28:31], v[152:155], 0
  v_mul_f32 v90, v12, v90
  v_mul_f32 v91, v12, v91
  v_mfma_f32_16x16x32_bf16 v[76:79], v[28:31], v[184:187], 0
  v_mul_f32 v92, v12, v92
  v_mfma_f32_16x16x32_bf16 v[84:87], v[28:31], v[216:219], 0
  s_waitcnt lgkmcnt(5)
  v_mul_f32 v93, v12, v93
  v_mfma_f32_16x16x32_bf16 v[56:59], v[32:35], v[124:127], v[56:59]
  ds_read_b128 v[24:27], v248 offset:33024
  v_mul_f32 v94, v12, v94
  v_mfma_f32_16x16x32_bf16 v[64:67], v[32:35], v[156:159], v[64:67]
  v_mul_f32 v95, v12, v95
  v_cvt_pk_bf16_f32 v88, v88, v89
  v_mfma_f32_16x16x32_bf16 v[72:75], v[32:35], v[188:191], v[72:75]
  v_mfma_f32_16x16x32_bf16 v[80:83], v[32:35], v[220:223], v[80:83]
  s_waitcnt lgkmcnt(5)
  v_cvt_pk_bf16_f32 v89, v90, v91
  v_mfma_f32_16x16x32_bf16 v[60:63], v[36:39], v[124:127], v[60:63]
  ds_read_b128 v[28:31], v248 offset:35072
  v_cvt_pk_bf16_f32 v90, v92, v93
  v_mfma_f32_16x16x32_bf16 v[68:71], v[36:39], v[156:159], v[68:71]
  v_cvt_pk_bf16_f32 v91, v94, v95
  v_accvgpr_write_b32 a44, v88
  v_mfma_f32_16x16x32_bf16 v[76:79], v[36:39], v[188:191], v[76:79]
  v_accvgpr_write_b32 a45, v89
  v_mfma_f32_16x16x32_bf16 v[84:87], v[36:39], v[220:223], v[84:87]
  s_waitcnt lgkmcnt(5)
  v_accvgpr_write_b32 a46, v90
  v_mfma_f32_16x16x32_bf16 v[56:59], v[40:43], v[128:131], v[56:59]
  ds_read_b128 v[32:35], v249 offset:33024
  v_accvgpr_write_b32 a47, v91
  v_mfma_f32_16x16x32_bf16 v[64:67], v[40:43], v[160:163], v[64:67]
  v_mul_f32 v96, v12, v96
  v_mul_f32 v97, v12, v97
  v_mfma_f32_16x16x32_bf16 v[72:75], v[40:43], v[192:195], v[72:75]
  v_mfma_f32_16x16x32_bf16 v[80:83], v[40:43], v[224:227], v[80:83]
  s_waitcnt lgkmcnt(5)
  v_mul_f32 v98, v12, v98
  v_mfma_f32_16x16x32_bf16 v[60:63], v[44:47], v[128:131], v[60:63]
  ds_read_b128 v[36:39], v249 offset:35072
  v_mul_f32 v99, v12, v99
  v_mfma_f32_16x16x32_bf16 v[68:71], v[44:47], v[160:163], v[68:71]
  v_mul_f32 v100, v12, v100
  v_mul_f32 v101, v12, v101
  v_mfma_f32_16x16x32_bf16 v[76:79], v[44:47], v[192:195], v[76:79]
  v_mul_f32 v102, v12, v102
  v_mfma_f32_16x16x32_bf16 v[84:87], v[44:47], v[224:227], v[84:87]
  s_waitcnt lgkmcnt(5)
  v_mul_f32 v103, v12, v103
  v_mfma_f32_16x16x32_bf16 v[56:59], v[48:51], v[132:135], v[56:59]
  ds_read_b128 v[40:43], v250 offset:33024
  v_cvt_pk_bf16_f32 v96, v96, v97
  v_mfma_f32_16x16x32_bf16 v[64:67], v[48:51], v[164:167], v[64:67]
  v_cvt_pk_bf16_f32 v97, v98, v99
  v_cvt_pk_bf16_f32 v98, v100, v101
  v_mfma_f32_16x16x32_bf16 v[72:75], v[48:51], v[196:199], v[72:75]
  v_mfma_f32_16x16x32_bf16 v[80:83], v[48:51], v[228:231], v[80:83]
  s_waitcnt lgkmcnt(5)
  v_cvt_pk_bf16_f32 v99, v102, v103
  v_mfma_f32_16x16x32_bf16 v[60:63], v[52:55], v[132:135], v[60:63]
  ds_read_b128 v[44:47], v250 offset:35072
  v_accvgpr_write_b32 a100, v96
  v_mfma_f32_16x16x32_bf16 v[68:71], v[52:55], v[164:167], v[68:71]
  v_accvgpr_write_b32 a101, v97
  v_accvgpr_write_b32 a102, v98
  v_mfma_f32_16x16x32_bf16 v[76:79], v[52:55], v[196:199], v[76:79]
  v_accvgpr_write_b32 a103, v99
  v_mfma_f32_16x16x32_bf16 v[84:87], v[52:55], v[228:231], v[84:87]
  s_waitcnt lgkmcnt(5)
  v_mul_f32 v104, v12, v104
  v_mfma_f32_16x16x32_bf16 v[56:59], v[24:27], v[136:139], v[56:59]
  ds_read_b128 v[48:51], v251 offset:33024
  v_mul_f32 v105, v12, v105
  v_mfma_f32_16x16x32_bf16 v[64:67], v[24:27], v[168:171], v[64:67]
  v_mul_f32 v106, v12, v106
  v_mul_f32 v107, v12, v107
  v_mfma_f32_16x16x32_bf16 v[72:75], v[24:27], v[200:203], v[72:75]
  v_mfma_f32_16x16x32_bf16 v[80:83], v[24:27], v[232:235], v[80:83]
  s_waitcnt lgkmcnt(5)
  v_mul_f32 v108, v12, v108
  v_mfma_f32_16x16x32_bf16 v[60:63], v[28:31], v[136:139], v[60:63]
  ds_read_b128 v[52:55], v251 offset:35072
  v_mul_f32 v109, v12, v109
  v_mfma_f32_16x16x32_bf16 v[68:71], v[28:31], v[168:171], v[68:71]
  v_mul_f32 v110, v12, v110
  v_mul_f32 v111, v12, v111
  v_mfma_f32_16x16x32_bf16 v[76:79], v[28:31], v[200:203], v[76:79]
  v_cvt_pk_bf16_f32 v104, v104, v105
  v_mfma_f32_16x16x32_bf16 v[84:87], v[28:31], v[232:235], v[84:87]
  s_waitcnt lgkmcnt(5)
  v_cvt_pk_bf16_f32 v105, v106, v107
  v_mfma_f32_16x16x32_bf16 v[56:59], v[32:35], v[140:143], v[56:59]
  s_waitcnt vmcnt(0)
  s_barrier
  ds_read_b128 v[24:27], v248 offset:49152
  v_cvt_pk_bf16_f32 v106, v108, v109
  v_mfma_f32_16x16x32_bf16 v[64:67], v[32:35], v[172:175], v[64:67]
  v_cvt_pk_bf16_f32 v107, v110, v111
  v_accvgpr_write_b32 a156, v104
  v_mfma_f32_16x16x32_bf16 v[72:75], v[32:35], v[204:207], v[72:75]
  v_mfma_f32_16x16x32_bf16 v[80:83], v[32:35], v[236:239], v[80:83]
  s_waitcnt lgkmcnt(5)
  v_accvgpr_write_b32 a157, v105
  v_mfma_f32_16x16x32_bf16 v[60:63], v[36:39], v[140:143], v[60:63]
  ds_read_b128 v[28:31], v248 offset:51200
  v_accvgpr_write_b32 a158, v106
  v_mfma_f32_16x16x32_bf16 v[68:71], v[36:39], v[172:175], v[68:71]
  v_accvgpr_write_b32 a159, v107
  v_mul_f32 v112, v12, v112
  v_mfma_f32_16x16x32_bf16 v[76:79], v[36:39], v[204:207], v[76:79]
  v_mul_f32 v113, v12, v113
  v_mfma_f32_16x16x32_bf16 v[84:87], v[36:39], v[236:239], v[84:87]
  s_waitcnt lgkmcnt(5)
  v_mul_f32 v114, v12, v114
  v_mfma_f32_16x16x32_bf16 v[56:59], v[40:43], v[144:147], v[56:59]
  ds_read_b128 v[32:35], v249 offset:49152
  v_mul_f32 v115, v12, v115
  v_mfma_f32_16x16x32_bf16 v[64:67], v[40:43], v[176:179], v[64:67]
  v_mul_f32 v116, v12, v116
  v_mul_f32 v117, v12, v117
  v_mfma_f32_16x16x32_bf16 v[72:75], v[40:43], v[208:211], v[72:75]
  v_readfirstlane_b32 s86, v13
  s_lshl_b32 s22, s17, 7
  s_add_u32 s22, s22, 584192
  s_mov_b32 s23, 586240
  buffer_load_dword v13, off, s[8:11], s22 sc1
  buffer_load_dwordx2 v[10:11], off, s[8:11], s23 sc1
  v_mfma_f32_16x16x32_bf16 v[80:83], v[40:43], v[240:243], v[80:83]
  s_waitcnt lgkmcnt(5)
  v_mul_f32 v118, v12, v118
  v_mfma_f32_16x16x32_bf16 v[60:63], v[44:47], v[144:147], v[60:63]
  ds_read_b128 v[36:39], v249 offset:51200
  v_mul_f32 v119, v12, v119
  v_mfma_f32_16x16x32_bf16 v[68:71], v[44:47], v[176:179], v[68:71]
  v_cvt_pk_bf16_f32 v112, v112, v113
  v_cvt_pk_bf16_f32 v113, v114, v115
  v_mfma_f32_16x16x32_bf16 v[76:79], v[44:47], v[208:211], v[76:79]
  v_cvt_pk_bf16_f32 v114, v116, v117
  v_mfma_f32_16x16x32_bf16 v[84:87], v[44:47], v[240:243], v[84:87]
  s_waitcnt lgkmcnt(5)
  v_cvt_pk_bf16_f32 v115, v118, v119
  v_mfma_f32_16x16x32_bf16 v[56:59], v[48:51], v[148:151], v[56:59]
  ds_read_b128 v[40:43], v250 offset:49152
  v_accvgpr_write_b32 a212, v112
  v_mfma_f32_16x16x32_bf16 v[64:67], v[48:51], v[180:183], v[64:67]
  v_accvgpr_write_b32 a213, v113
  v_accvgpr_write_b32 a214, v114
  v_mfma_f32_16x16x32_bf16 v[72:75], v[48:51], v[212:215], v[72:75]
  v_accvgpr_write_b32 a215, v115
  v_mfma_f32_16x16x32_bf16 v[80:83], v[48:51], v[244:247], v[80:83]
  s_waitcnt lgkmcnt(5)
  v_mfma_f32_16x16x32_bf16 v[60:63], v[52:55], v[148:151], v[60:63]
  ds_read_b128 v[44:47], v250 offset:51200
  v_mfma_f32_16x16x32_bf16 v[68:71], v[52:55], v[180:183], v[68:71]
  v_mfma_f32_16x16x32_bf16 v[76:79], v[52:55], v[212:215], v[76:79]
  v_mfma_f32_16x16x32_bf16 v[84:87], v[52:55], v[244:247], v[84:87]
  s_waitcnt lgkmcnt(5)
  v_mfma_f32_16x16x32_bf16 v[88:91], v[24:27], v[120:123], 0
  ds_read_b128 v[48:51], v251 offset:49152
  v_mfma_f32_16x16x32_bf16 v[96:99], v[24:27], v[152:155], 0
  v_mfma_f32_16x16x32_bf16 v[104:107], v[24:27], v[184:187], 0
  v_mfma_f32_16x16x32_bf16 v[112:115], v[24:27], v[216:219], 0
  s_waitcnt lgkmcnt(5)
  v_mul_f32 v56, v12, v56
  v_mfma_f32_16x16x32_bf16 v[92:95], v[28:31], v[120:123], 0
  ds_read_b128 v[52:55], v251 offset:51200
  v_mul_f32 v57, v12, v57
  v_mfma_f32_16x16x32_bf16 v[100:103], v[28:31], v[152:155], 0
  v_mul_f32 v58, v12, v58
  v_mul_f32 v59, v12, v59
  v_mfma_f32_16x16x32_bf16 v[108:111], v[28:31], v[184:187], 0
  v_mul_f32 v60, v12, v60
  v_mfma_f32_16x16x32_bf16 v[116:119], v[28:31], v[216:219], 0
  s_waitcnt lgkmcnt(5)
  v_mul_f32 v61, v12, v61
  v_mfma_f32_16x16x32_bf16 v[88:91], v[32:35], v[124:127], v[88:91]
  ds_read_b128 v[24:27], v248 offset:49408
  v_mul_f32 v62, v12, v62
  v_mfma_f32_16x16x32_bf16 v[96:99], v[32:35], v[156:159], v[96:99]
  v_mul_f32 v63, v12, v63
  v_cvt_pk_bf16_f32 v56, v56, v57
  v_mfma_f32_16x16x32_bf16 v[104:107], v[32:35], v[188:191], v[104:107]
  v_cvt_pk_bf16_f32 v57, v58, v59
  v_mfma_f32_16x16x32_bf16 v[112:115], v[32:35], v[220:223], v[112:115]
  s_waitcnt lgkmcnt(5)
  v_cvt_pk_bf16_f32 v58, v60, v61
  v_mfma_f32_16x16x32_bf16 v[92:95], v[36:39], v[124:127], v[92:95]
  ds_read_b128 v[28:31], v248 offset:51456
  v_cvt_pk_bf16_f32 v59, v62, v63
  v_mfma_f32_16x16x32_bf16 v[100:103], v[36:39], v[156:159], v[100:103]
  v_accvgpr_write_b32 a48, v56
  v_accvgpr_write_b32 a49, v57
  v_mfma_f32_16x16x32_bf16 v[108:111], v[36:39], v[188:191], v[108:111]
  v_accvgpr_write_b32 a50, v58
  v_mfma_f32_16x16x32_bf16 v[116:119], v[36:39], v[220:223], v[116:119]
  s_waitcnt lgkmcnt(5)
  v_accvgpr_write_b32 a51, v59
  v_mfma_f32_16x16x32_bf16 v[88:91], v[40:43], v[128:131], v[88:91]
  ds_read_b128 v[32:35], v249 offset:49408
  v_mul_f32 v64, v12, v64
  v_mfma_f32_16x16x32_bf16 v[96:99], v[40:43], v[160:163], v[96:99]
  v_mul_f32 v65, v12, v65
  v_mul_f32 v66, v12, v66
  v_mfma_f32_16x16x32_bf16 v[104:107], v[40:43], v[192:195], v[104:107]
  v_mul_f32 v67, v12, v67
  v_mfma_f32_16x16x32_bf16 v[112:115], v[40:43], v[224:227], v[112:115]
  s_waitcnt lgkmcnt(5)
  v_mul_f32 v68, v12, v68
  v_mfma_f32_16x16x32_bf16 v[92:95], v[44:47], v[128:131], v[92:95]
  ds_read_b128 v[36:39], v249 offset:51456
  v_mul_f32 v69, v12, v69
  v_mfma_f32_16x16x32_bf16 v[100:103], v[44:47], v[160:163], v[100:103]
  v_mul_f32 v70, v12, v70
  v_mul_f32 v71, v12, v71
  v_mfma_f32_16x16x32_bf16 v[108:111], v[44:47], v[192:195], v[108:111]
  v_cvt_pk_bf16_f32 v64, v64, v65
  v_mfma_f32_16x16x32_bf16 v[116:119], v[44:47], v[224:227], v[116:119]
  s_waitcnt lgkmcnt(5)
  v_cvt_pk_bf16_f32 v65, v66, v67
  v_mfma_f32_16x16x32_bf16 v[88:91], v[48:51], v[132:135], v[88:91]
  ds_read_b128 v[40:43], v250 offset:49408
  v_cvt_pk_bf16_f32 v66, v68, v69
  v_mfma_f32_16x16x32_bf16 v[96:99], v[48:51], v[164:167], v[96:99]
  v_cvt_pk_bf16_f32 v67, v70, v71
  v_accvgpr_write_b32 a104, v64
  v_mfma_f32_16x16x32_bf16 v[104:107], v[48:51], v[196:199], v[104:107]
  v_accvgpr_write_b32 a105, v65
  v_mfma_f32_16x16x32_bf16 v[112:115], v[48:51], v[228:231], v[112:115]
  s_waitcnt lgkmcnt(5)
  v_accvgpr_write_b32 a106, v66
  v_mfma_f32_16x16x32_bf16 v[92:95], v[52:55], v[132:135], v[92:95]
  ds_read_b128 v[44:47], v250 offset:51456
  v_accvgpr_write_b32 a107, v67
  v_mfma_f32_16x16x32_bf16 v[100:103], v[52:55], v[164:167], v[100:103]
  v_mul_f32 v72, v12, v72
  v_mul_f32 v73, v12, v73
  v_mfma_f32_16x16x32_bf16 v[108:111], v[52:55], v[196:199], v[108:111]
  v_mul_f32 v74, v12, v74
  v_mfma_f32_16x16x32_bf16 v[116:119], v[52:55], v[228:231], v[116:119]
  s_waitcnt lgkmcnt(5)
  v_mul_f32 v75, v12, v75
  v_mfma_f32_16x16x32_bf16 v[88:91], v[24:27], v[136:139], v[88:91]
  ds_read_b128 v[48:51], v251 offset:49408
  v_mul_f32 v76, v12, v76
  v_mfma_f32_16x16x32_bf16 v[96:99], v[24:27], v[168:171], v[96:99]
  v_mul_f32 v77, v12, v77
  v_mul_f32 v78, v12, v78
  v_mfma_f32_16x16x32_bf16 v[104:107], v[24:27], v[200:203], v[104:107]
  v_mul_f32 v79, v12, v79
  v_mfma_f32_16x16x32_bf16 v[112:115], v[24:27], v[232:235], v[112:115]
  s_waitcnt lgkmcnt(5)
  v_cvt_pk_bf16_f32 v72, v72, v73
  v_mfma_f32_16x16x32_bf16 v[92:95], v[28:31], v[136:139], v[92:95]
  ds_read_b128 v[52:55], v251 offset:51456
  v_cvt_pk_bf16_f32 v73, v74, v75
  v_mfma_f32_16x16x32_bf16 v[100:103], v[28:31], v[168:171], v[100:103]
  v_cvt_pk_bf16_f32 v74, v76, v77
  v_cvt_pk_bf16_f32 v75, v78, v79
  v_mfma_f32_16x16x32_bf16 v[108:111], v[28:31], v[200:203], v[108:111]
  v_accvgpr_write_b32 a160, v72
  v_mfma_f32_16x16x32_bf16 v[116:119], v[28:31], v[232:235], v[116:119]
  s_waitcnt lgkmcnt(5)
  v_accvgpr_write_b32 a161, v73
  v_mfma_f32_16x16x32_bf16 v[88:91], v[32:35], v[140:143], v[88:91]
  v_accvgpr_write_b32 a162, v74
  v_mfma_f32_16x16x32_bf16 v[96:99], v[32:35], v[172:175], v[96:99]
  v_accvgpr_write_b32 a163, v75
  v_mul_f32 v80, v12, v80
  v_mfma_f32_16x16x32_bf16 v[104:107], v[32:35], v[204:207], v[104:107]
  v_mul_f32 v81, v12, v81
  v_mfma_f32_16x16x32_bf16 v[112:115], v[32:35], v[236:239], v[112:115]
  s_waitcnt lgkmcnt(4)
  v_mul_f32 v82, v12, v82
  v_mfma_f32_16x16x32_bf16 v[92:95], v[36:39], v[140:143], v[92:95]
  v_mul_f32 v83, v12, v83
  v_mfma_f32_16x16x32_bf16 v[100:103], v[36:39], v[172:175], v[100:103]
  v_mul_f32 v84, v12, v84
  v_mul_f32 v85, v12, v85
  v_mfma_f32_16x16x32_bf16 v[108:111], v[36:39], v[204:207], v[108:111]
  v_mul_f32 v86, v12, v86
  v_mfma_f32_16x16x32_bf16 v[116:119], v[36:39], v[236:239], v[116:119]
  s_waitcnt lgkmcnt(3)
  v_mul_f32 v87, v12, v87
  v_mfma_f32_16x16x32_bf16 v[88:91], v[40:43], v[144:147], v[88:91]
  v_cvt_pk_bf16_f32 v80, v80, v81
  v_mfma_f32_16x16x32_bf16 v[96:99], v[40:43], v[176:179], v[96:99]
  v_cvt_pk_bf16_f32 v81, v82, v83
  v_cvt_pk_bf16_f32 v82, v84, v85
  v_mfma_f32_16x16x32_bf16 v[104:107], v[40:43], v[208:211], v[104:107]
  v_cvt_pk_bf16_f32 v83, v86, v87
  v_mfma_f32_16x16x32_bf16 v[112:115], v[40:43], v[240:243], v[112:115]
  s_waitcnt lgkmcnt(2)
  v_accvgpr_write_b32 a216, v80
  v_mfma_f32_16x16x32_bf16 v[92:95], v[44:47], v[144:147], v[92:95]
  v_accvgpr_write_b32 a217, v81
  v_mfma_f32_16x16x32_bf16 v[100:103], v[44:47], v[176:179], v[100:103]
  v_accvgpr_write_b32 a218, v82
  v_accvgpr_write_b32 a219, v83
  v_mfma_f32_16x16x32_bf16 v[108:111], v[44:47], v[208:211], v[108:111]
  v_mfma_f32_16x16x32_bf16 v[116:119], v[44:47], v[240:243], v[116:119]
  s_waitcnt lgkmcnt(1)
  v_mfma_f32_16x16x32_bf16 v[88:91], v[48:51], v[148:151], v[88:91]
  v_mfma_f32_16x16x32_bf16 v[96:99], v[48:51], v[180:183], v[96:99]
  v_mfma_f32_16x16x32_bf16 v[104:107], v[48:51], v[212:215], v[104:107]
  v_mfma_f32_16x16x32_bf16 v[112:115], v[48:51], v[244:247], v[112:115]
  s_waitcnt lgkmcnt(0)
  v_mfma_f32_16x16x32_bf16 v[92:95], v[52:55], v[148:151], v[92:95]
  v_mfma_f32_16x16x32_bf16 v[100:103], v[52:55], v[180:183], v[100:103]
  v_mfma_f32_16x16x32_bf16 v[108:111], v[52:55], v[212:215], v[108:111]
  v_mfma_f32_16x16x32_bf16 v[116:119], v[52:55], v[244:247], v[116:119]
  v_mul_f32 v88, v12, v88
  v_mul_f32 v89, v12, v89
  v_mul_f32 v90, v12, v90
  v_mul_f32 v91, v12, v91
  v_mul_f32 v92, v12, v92
  v_mul_f32 v93, v12, v93
  v_mul_f32 v94, v12, v94
  v_mul_f32 v95, v12, v95
  v_cvt_pk_bf16_f32 v88, v88, v89
  v_cvt_pk_bf16_f32 v89, v90, v91
  v_cvt_pk_bf16_f32 v90, v92, v93
  v_cvt_pk_bf16_f32 v91, v94, v95
  v_accvgpr_write_b32 a52, v88
  v_accvgpr_write_b32 a53, v89
  v_accvgpr_write_b32 a54, v90
  v_accvgpr_write_b32 a55, v91
  v_mul_f32 v96, v12, v96
  v_mul_f32 v97, v12, v97
  v_mul_f32 v98, v12, v98
  v_mul_f32 v99, v12, v99
  v_mul_f32 v100, v12, v100
  v_mul_f32 v101, v12, v101
  v_mul_f32 v102, v12, v102
  v_mul_f32 v103, v12, v103
  v_cvt_pk_bf16_f32 v96, v96, v97
  v_cvt_pk_bf16_f32 v97, v98, v99
  v_cvt_pk_bf16_f32 v98, v100, v101
  v_cvt_pk_bf16_f32 v99, v102, v103
  v_accvgpr_write_b32 a108, v96
  v_accvgpr_write_b32 a109, v97
  v_accvgpr_write_b32 a110, v98
  v_accvgpr_write_b32 a111, v99
  v_mul_f32 v104, v12, v104
  v_mul_f32 v105, v12, v105
  v_mul_f32 v106, v12, v106
  v_mul_f32 v107, v12, v107
  v_mul_f32 v108, v12, v108
  v_mul_f32 v109, v12, v109
  v_mul_f32 v110, v12, v110
  v_mul_f32 v111, v12, v111
  v_cvt_pk_bf16_f32 v104, v104, v105
  v_cvt_pk_bf16_f32 v105, v106, v107
  v_cvt_pk_bf16_f32 v106, v108, v109
  v_cvt_pk_bf16_f32 v107, v110, v111
  v_accvgpr_write_b32 a164, v104
  v_accvgpr_write_b32 a165, v105
  v_accvgpr_write_b32 a166, v106
  v_accvgpr_write_b32 a167, v107
  v_mul_f32 v112, v12, v112
  v_mul_f32 v113, v12, v113
  v_mul_f32 v114, v12, v114
  v_mul_f32 v115, v12, v115
  v_mul_f32 v116, v12, v116
  v_mul_f32 v117, v12, v117
  v_mul_f32 v118, v12, v118
  v_mul_f32 v119, v12, v119
  v_cvt_pk_bf16_f32 v112, v112, v113
  v_cvt_pk_bf16_f32 v113, v114, v115
  v_cvt_pk_bf16_f32 v114, v116, v117
  v_cvt_pk_bf16_f32 v115, v118, v119
  v_accvgpr_write_b32 a220, v112
  v_accvgpr_write_b32 a221, v113
  v_accvgpr_write_b32 a222, v114
  v_accvgpr_write_b32 a223, v115
  s_waitcnt vmcnt(0)
  s_barrier
  v_readfirstlane_b32 s84, v13
  v_readfirstlane_b32 s85, v10
  v_readfirstlane_b32 s22, v11
  s_and_b32 s86, s86, s22
  s_cmp_eq_u32 s86, 1
  s_cselect_b32 s84, s84, 0
  v_and_b32 v10, 0xffe0, v9
  v_cmp_eq_u32 vcc, 0, v10
  s_cbranch_vccz ch_md_ok
ch_role2:
  s_mov_b32 s30, 0
ch_md:
  buffer_load_dword v9, off, s[12:15], 0 sc1
  s_waitcnt vmcnt(0)
  v_and_b32 v10, 0xffe0, v9
  v_cmp_eq_u32 vcc, 0, v10
  s_cbranch_vccz ch_md_ok
  s_sleep 4
  s_add_u32 s30, s30, 1
  s_cmp_lt_u32 s30, 1600000
  s_cbranch_scc1 ch_md
  s_branch ch_end
ch_md_ok:
  v_readfirstlane_b32 s88, v9
  s_lshr_b32 s88, s88, 16
  v_and_b32 v1, 63, v0
  v_lshlrev_b32 v2, 4, v1
  v_lshrrev_b32 v116, 4, v1
  v_and_b32 v117, 15, v1
  v_mov_b32 v3, 0x4444
  v_mov_b32 v118, 0xeeee
  v_cmp_lt_u32 vcc, 7, v117
  s_nop 1
  v_cndmask_b32 v3, v3, v118, vcc
  s_mov_b32 s19, 0
  s_mov_b32 s18, 1
  s_mov_b32 s20, 0
  s_mov_b32 s21, 17664
  s_mov_b32 s23, 4096
  s_lshr_b32 s89, s17, 4
  s_lshl_b32 s89, s89, 2
  s_add_u32 s89, s89, s16
  s_and_b32 s17, s17, 15
  s_cmp_eq_u32 s89, 0
  s_cbranch_scc1 ch_init0
  s_cmp_eq_u32 s89, 1
  s_cbranch_scc1 ch_init1
  s_cmp_eq_u32 s89, 2
  s_cbranch_scc1 ch_init2
  s_cmp_eq_u32 s89, 3
  s_cbranch_scc1 ch_init3
  s_cmp_eq_u32 s89, 4
  s_cbranch_scc1 ch_init4
  s_cmp_eq_u32 s89, 5
  s_cbranch_scc1 ch_init5
  s_cmp_eq_u32 s89, 6
  s_cbranch_scc1 ch_init6
  s_cmp_eq_u32 s89, 7
  s_cbranch_scc1 ch_init7
  s_branch ch_end
ch_init0:
  s_mul_i32 s31, s17, 401408
  s_add_u32 s31, s31, 33554432
  s_and_b32 s28, s84, 10320
  s_lshl_b32 s22, s85, 16
  s_or_b32 s28, s28, s22
  s_cmp_eq_u32 s28, 4294912080
  s_cbranch_scc1 ch_wx0_ok
  s_mov_b32 s30, 0
ch_wr0:
  buffer_load_dword v9, off, s[12:15], 0 offset:132 sc1
  s_waitcnt vmcnt(0)
  v_cmp_ne_u32 vcc, 1, v9
  s_cbranch_vccz ch_wr0_ok
  s_sleep 8
  s_add_u32 s30, s30, 1
  s_cmp_lt_u32 s30, 400000
  s_cbranch_scc1 ch_wr0
  s_branch cA_abort
ch_wr0_ok:
  s_lshl_b32 s27, s17, 7
  s_add_u32 s27, s27, 584192
  s_mov_b32 s28, 10320
  s_mov_b32 s30, 0
ch_wb0:
  buffer_load_dword v9, off, s[8:11], s27  sc1
  s_waitcnt vmcnt(0)
  v_and_b32 v10, s28, v9
  v_cmp_ne_u32 vcc, s28, v10
  s_cbranch_vccz ch_wb0_ok
  s_sleep 3
  s_add_u32 s30, s30, 1
  s_cmp_lt_u32 s30, 400000
  s_cbranch_scc1 ch_wb0
  s_branch cA_abort
ch_wb0_ok:
  s_mov_b32 s29, 586240
  s_mov_b32 s28, 0xffff
  s_mov_b32 s30, 0
ch_wx0:
  buffer_load_dword v9, off, s[8:11], s29  sc1
  s_waitcnt vmcnt(0)
  v_and_b32 v10, s28, v9
  v_cmp_ne_u32 vcc, s28, v10
  s_cbranch_vccz ch_wx0_ok
  s_sleep 8
  s_add_u32 s30, s30, 1
  s_cmp_lt_u32 s30, 400000
  s_cbranch_scc1 ch_wx0
  s_branch cA_abort
ch_wx0_ok:
  s_add_u32 s22, s31, 229376
  buffer_load_dwordx4 a[224:227], v2, s[8:11], s22 offen offset:0 sc1
  buffer_load_dwordx4 a[228:231], v2, s[8:11], s22 offen offset:1024 sc1
  buffer_load_dwordx4 a[232:235], v2, s[8:11], s22 offen offset:2048 sc1
  buffer_load_dwordx4 a[236:239], v2, s[8:11], s22 offen offset:3072 sc1
  s_add_u32 s22, s31, 233472
  buffer_load_dwordx4 a[240:243], v2, s[8:11], s22 offen offset:0 sc1
  buffer_load_dwordx4 a[244:247], v2, s[8:11], s22 offen offset:1024 sc1
  buffer_load_dwordx4 a[248:251], v2, s[8:11], s22 offen offset:2048 sc1
  buffer_load_dwordx4 a[252:255], v2, s[8:11], s22 offen offset:3072 sc1
  s_add_u32 s22, s31, 237568
  buffer_load_dwordx4 v[120:123], v2, s[8:11], s22 offen offset:0 sc1
  buffer_load_dwordx4 v[124:127], v2, s[8:11], s22 offen offset:1024 sc1
  buffer_load_dwordx4 v[128:131], v2, s[8:11], s22 offen offset:2048 sc1
  buffer_load_dwordx4 v[132:135], v2, s[8:11], s22 offen offset:3072 sc1
  s_add_u32 s22, s31, 241664
  buffer_load_dwordx4 v[136:139], v2, s[8:11], s22 offen offset:0 sc1
  buffer_load_dwordx4 v[140:143], v2, s[8:11], s22 offen offset:1024 sc1
  buffer_load_dwordx4 v[144:147], v2, s[8:11], s22 offen offset:2048 sc1
  buffer_load_dwordx4 v[148:151], v2, s[8:11], s22 offen offset:3072 sc1
  s_add_u32 s22, s31, 245760
  buffer_load_dwordx4 v[152:155], v2, s[8:11], s22 offen offset:0 sc1
  buffer_load_dwordx4 v[156:159], v2, s[8:11], s22 offen offset:1024 sc1
  buffer_load_dwordx4 v[160:163], v2, s[8:11], s22 offen offset:2048 sc1
  buffer_load_dwordx4 v[164:167], v2, s[8:11], s22 offen offset:3072 sc1
  s_add_u32 s22, s31, 249856
  buffer_load_dwordx4 v[168:171], v2, s[8:11], s22 offen offset:0 sc1
  buffer_load_dwordx4 v[172:175], v2, s[8:11], s22 offen offset:1024 sc1
  buffer_load_dwordx4 v[176:179], v2, s[8:11], s22 offen offset:2048 sc1
  buffer_load_dwordx4 v[180:183], v2, s[8:11], s22 offen offset:3072 sc1
  s_mov_b32 s24, 655360
  s_mov_b32 s26, 669696
  v_and_b32 v64, 7, v117
  v_and_b32 v65, 1, v116
  v_lshlrev_b32 v65, 2, v65
  v_sub_u32 v64, v64, v65
  v_lshrrev_b32 v65, 3, v117
  v_lshl_add_u32 v66, v65, 2, v64
  v_cmp_gt_u32 vcc, 4, v64
  v_mov_b32 v67, 99
  s_nop 0
  v_cndmask_b32 v66, v67, v66, vcc
  v_mov_b32 v68, 0x3f80
  v_mov_b32 v69, 0x3f800000
  v_mov_b32 v4, 0
  v_cmp_eq_u32 vcc, 0, v66
  s_nop 1
  v_cndmask_b32 v4, v4, v68, vcc
  v_cmp_eq_u32 vcc, 1, v66
  s_nop 1
  v_cndmask_b32 v4, v4, v69, vcc
  v_mov_b32 v5, 0
  v_cmp_eq_u32 vcc, 2, v66
  s_nop 1
  v_cndmask_b32 v5, v5, v68, vcc
  v_cmp_eq_u32 vcc, 3, v66
  s_nop 1
  v_cndmask_b32 v5, v5, v69, vcc
  v_mov_b32 v6, 0
  v_cmp_eq_u32 vcc, 4, v66
  s_nop 1
  v_cndmask_b32 v6, v6, v68, vcc
  v_cmp_eq_u32 vcc, 5, v66
  s_nop 1
  v_cndmask_b32 v6, v6, v69, vcc
  v_mov_b32 v7, 0
  v_cmp_eq_u32 vcc, 6, v66
  s_nop 1
  v_cndmask_b32 v7, v7, v68, vcc
  v_cmp_eq_u32 vcc, 7, v66
  s_nop 1
  v_cndmask_b32 v7, v7, v69, vcc
  v_lshrrev_b32 v64, 1, v116
  v_lshrrev_b32 v65, 3, v117
  v_and_b32 v66, 1, v116
  v_and_b32 v68, 7, v117
  v_lshlrev_b32 v67, 8, v65
  v_lshl_add_u32 v67, v68, 5, v67
  v_lshl_add_u32 v67, v66, 4, v67
  v_add_u32 v69, 4096, v67
  v_add_u32 v70, 6400, v67
  v_cmp_eq_u32 vcc, v64, v65
  s_nop 1
  v_cndmask_b32 v113, v70, v69, vcc
  v_and_b32 v74, 3, v117
  v_lshlrev_b32 v74, 1, v74
  v_bfe_u32 v75, v117, 2, 1
  v_or_b32 v74, v74, v75
  v_and_b32 v75, 8, v117
  v_or_b32 v74, v74, v75
  v_lshlrev_b32 v67, 9, v64
  v_lshl_add_u32 v67, v74, 4, v67
  v_lshl_add_u32 v67, v66, 3, v67
  v_add_u32 v114, 0, v67
  v_mul_u32_u24 v67, 1088, v65
  v_lshl_add_u32 v67, v116, 5, v67
  v_and_b32 v75, 1, v117
  v_and_b32 v76, 2, v117
  v_lshl_add_u32 v75, v76, 1, v75
  v_bfe_u32 v76, v117, 2, 1
  v_lshl_add_u32 v75, v76, 1, v75
  v_lshl_add_u32 v67, v75, 2, v67
  v_add_u32 v115, 4096, v67
  v_and_b32 v69, 1, v74
  v_lshlrev_b32 v67, 7, v69
  v_lshl_add_u32 v67, v116, 4, v67
  v_lshl_add_u32 v67, v65, 8, v67
  v_bfe_u32 v69, v74, 1, 2
  v_lshl_add_u32 v67, v69, 2, v67
  s_lshl_b32 s22, s17, 9
  s_add_u32 s22, s22, 9216
  v_add_u32 v72, s22, v67
  v_bfe_u32 v69, v75, 1, 1
  v_lshlrev_b32 v67, 7, v69
  v_lshl_add_u32 v67, v116, 4, v67
  v_and_b32 v69, 4, v75
  v_add_u32 v67, v67, v69
  s_lshr_b32 s22, s17, 1
  s_lshl_b32 s22, s22, 8
  s_and_b32 s27, s17, 1
  s_lshl_b32 s27, s27, 3
  s_add_u32 s22, s22, s27
  s_add_u32 s22, s22, 7168
  v_add_u32 v67, s22, v67
  v_and_b32 v69, 9, v117
  v_mov_b32 v70, 0x40000000
  v_cmp_eq_u32 vcc, 0, v69
  s_nop 1
  v_cndmask_b32 v118, v70, v67, vcc
  v_mov_b32 v119, -1
  v_and_b32 v0, 15, v1
  s_and_b32 s22, s17, 0
  s_lshl_b32 s22, s22, 7
  s_add_u32 s22, s22, 37376
  v_lshl_add_u32 v0, v0, 2, s22
  v_xor_b32 v69, 256, v2
  v_mul_i32_i24 v70, -4096, v66
  v_add_u32 v69, v69, v70
  v_add_u32 v117, 12288, v69
  v_mov_b32 v116, v73
  v_mov_b32 v112, 0
  s_mul_i32 s35, s17, 28672
  s_add_u32 s35, s35, 4325376
  v_mov_b32 v1, v72
  v_mov_b32 v36, 0
  v_mov_b32 v37, 0
  v_mov_b32 v38, 0
  v_mov_b32 v39, 0
  v_mov_b32 v40, 0
  v_mov_b32 v41, 0
  v_mov_b32 v42, 0
  v_mov_b32 v43, 0
  v_mov_b32 v44, 0
  v_mov_b32 v45, 0
  v_mov_b32 v46, 0
  v_mov_b32 v47, 0
  v_mov_b32 v48, 0
  v_mov_b32 v49, 0
  v_mov_b32 v50, 0
  v_mov_b32 v51, 0
  v_mov_b32 v52, 0
  v_mov_b32 v53, 0
  v_mov_b32 v54, 0
  v_mov_b32 v55, 0
  v_mov_b32 v56, 0
  v_mov_b32 v57, 0
  v_mov_b32 v58, 0
  v_mov_b32 v59, 0
  v_mov_b32 v60, 0
  v_mov_b32 v61, 0
  v_mov_b32 v62, 0
  v_mov_b32 v63, 0
  v_mov_b32 v64, 0
  v_mov_b32 v65, 0
  v_mov_b32 v66, 0
  v_mov_b32 v67, 0
  v_mov_b32 v68, 0
  v_mov_b32 v69, 0
  v_mov_b32 v70, 0
  v_mov_b32 v71, 0
  v_mov_b32 v72, 0
  v_mov_b32 v73, 0
  v_mov_b32 v74, 0
  v_mov_b32 v75, 0
  v_mov_b32 v76, 0
  v_mov_b32 v77, 0
  v_mov_b32 v78, 0
  v_mov_b32 v79, 0
  s_mov_b32 s22, 0
  v_lshrrev_b32 v14, 4, v2
  v_add_u32 v14, 0, v14
  v_min_u32 v14, 308, v14
  v_lshlrev_b32 v14, 7, v14
  buffer_load_dword v15, v14, s[8:11], s22 offen sc1
  v_lshrrev_b32 v14, 4, v2
  v_add_u32 v14, 256, v14
  v_min_u32 v14, 308, v14
  v_lshlrev_b32 v14, 7, v14
  buffer_load_dword v15, v14, s[8:11], s22 offen sc1
  buffer_load_dwordx4 v[80:83], v117, s[8:11], s24 offen offset:0 sc1
  buffer_load_dwordx4 v[84:87], v117, s[8:11], s24 offen offset:1024 sc1
  buffer_load_dwordx4 v[88:91], v117, s[8:11], s26 offen offset:0 sc1
  buffer_load_dwordx4 v[92:95], v117, s[8:11], s26 offen offset:1024 sc1
  buffer_load_dwordx4 v[96:99], v2, s[8:11], s24 offen offset:0 sc1
  buffer_load_dwordx4 v[100:103], v2, s[8:11], s24 offen offset:1024 sc1
  buffer_load_dwordx4 v[104:107], v2, s[8:11], s26 offen offset:0 sc1
  buffer_load_dwordx4 v[108:111], v2, s[8:11], s26 offen offset:1024 sc1
  s_add_u32 s22, s31, 253952
  buffer_load_dwordx4 v[184:187], v2, s[8:11], s22 offen offset:0 sc1
  buffer_load_dwordx4 v[188:191], v2, s[8:11], s22 offen offset:1024 sc1
  buffer_load_dwordx4 v[192:195], v2, s[8:11], s22 offen offset:2048 sc1
  buffer_load_dwordx4 v[196:199], v2, s[8:11], s22 offen offset:3072 sc1
  s_add_u32 s22, s31, 372736
  buffer_load_dwordx4 v[200:203], v2, s[8:11], s22 offen offset:0 sc1
  buffer_load_dwordx4 v[204:207], v2, s[8:11], s22 offen offset:1024 sc1
  buffer_load_dwordx4 v[208:211], v2, s[8:11], s22 offen offset:2048 sc1
  buffer_load_dwordx4 v[212:215], v2, s[8:11], s22 offen offset:3072 sc1
  s_add_u32 s22, s31, 376832
  buffer_load_dwordx4 v[216:219], v2, s[8:11], s22 offen offset:0 sc1
  buffer_load_dwordx4 v[220:223], v2, s[8:11], s22 offen offset:1024 sc1
  buffer_load_dwordx4 v[224:227], v2, s[8:11], s22 offen offset:2048 sc1
  buffer_load_dwordx4 v[228:231], v2, s[8:11], s22 offen offset:3072 sc1
  s_add_u32 s22, s31, 380928
  buffer_load_dwordx4 v[232:235], v2, s[8:11], s22 offen offset:0 sc1
  buffer_load_dwordx4 v[236:239], v2, s[8:11], s22 offen offset:1024 sc1
  buffer_load_dwordx4 v[240:243], v2, s[8:11], s22 offen offset:2048 sc1
  buffer_load_dwordx4 v[244:247], v2, s[8:11], s22 offen offset:3072 sc1
  s_add_u32 s22, s31, 385024
  buffer_load_dwordx4 v[248:251], v2, s[8:11], s22 offen offset:0 sc1
  buffer_load_dwordx4 v[252:255], v2, s[8:11], s22 offen offset:1024 sc1
  s_waitcnt vmcnt(0) lgkmcnt(0)
  s_mov_b32 s31, 0
  s_cmp_lg_u32 s88, 0
  s_cbranch_scc1 cB_sc0_loop
  s_branch cA_sc0_loop
ch_init1:
  s_mul_i32 s31, s17, 401408
  s_add_u32 s31, s31, 33554432
  s_and_b32 s28, s84, 10320
  s_lshl_b32 s22, s85, 16
  s_or_b32 s28, s28, s22
  s_cmp_eq_u32 s28, 4294912080
  s_cbranch_scc1 ch_wx1_ok
  s_mov_b32 s30, 0
ch_wr1:
  buffer_load_dword v9, off, s[12:15], 0 offset:132 sc1
  s_waitcnt vmcnt(0)
  v_cmp_ne_u32 vcc, 1, v9
  s_cbranch_vccz ch_wr1_ok
  s_sleep 8
  s_add_u32 s30, s30, 1
  s_cmp_lt_u32 s30, 400000
  s_cbranch_scc1 ch_wr1
  s_branch cA_abort
ch_wr1_ok:
  s_lshl_b32 s27, s17, 7
  s_add_u32 s27, s27, 584192
  s_mov_b32 s28, 10320
  s_mov_b32 s30, 0
ch_wb1:
  buffer_load_dword v9, off, s[8:11], s27  sc1
  s_waitcnt vmcnt(0)
  v_and_b32 v10, s28, v9
  v_cmp_ne_u32 vcc, s28, v10
  s_cbranch_vccz ch_wb1_ok
  s_sleep 3
  s_add_u32 s30, s30, 1
  s_cmp_lt_u32 s30, 400000
  s_cbranch_scc1 ch_wb1
  s_branch cA_abort
ch_wb1_ok:
  s_mov_b32 s29, 586240
  s_mov_b32 s28, 0xffff
  s_mov_b32 s30, 0
ch_wx1:
  buffer_load_dword v9, off, s[8:11], s29  sc1
  s_waitcnt vmcnt(0)
  v_and_b32 v10, s28, v9
  v_cmp_ne_u32 vcc, s28, v10
  s_cbranch_vccz ch_wx1_ok
  s_sleep 8
  s_add_u32 s30, s30, 1
  s_cmp_lt_u32 s30, 400000
  s_cbranch_scc1 ch_wx1
  s_branch cA_abort
ch_wx1_ok:
  s_add_u32 s22, s31, 258048
  buffer_load_dwordx4 a[224:227], v2, s[8:11], s22 offen offset:0 sc1
  buffer_load_dwordx4 a[228:231], v2, s[8:11], s22 offen offset:1024 sc1
  buffer_load_dwordx4 a[232:235], v2, s[8:11], s22 offen offset:2048 sc1
  buffer_load_dwordx4 a[236:239], v2, s[8:11], s22 offen offset:3072 sc1
  s_add_u32 s22, s31, 262144
  buffer_load_dwordx4 a[240:243], v2, s[8:11], s22 offen offset:0 sc1
  buffer_load_dwordx4 a[244:247], v2, s[8:11], s22 offen offset:1024 sc1
  buffer_load_dwordx4 a[248:251], v2, s[8:11], s22 offen offset:2048 sc1
  buffer_load_dwordx4 a[252:255], v2, s[8:11], s22 offen offset:3072 sc1
  s_add_u32 s22, s31, 266240
  buffer_load_dwordx4 v[120:123], v2, s[8:11], s22 offen offset:0 sc1
  buffer_load_dwordx4 v[124:127], v2, s[8:11], s22 offen offset:1024 sc1
  buffer_load_dwordx4 v[128:131], v2, s[8:11], s22 offen offset:2048 sc1
  buffer_load_dwordx4 v[132:135], v2, s[8:11], s22 offen offset:3072 sc1
  s_add_u32 s22, s31, 270336
  buffer_load_dwordx4 v[136:139], v2, s[8:11], s22 offen offset:0 sc1
  buffer_load_dwordx4 v[140:143], v2, s[8:11], s22 offen offset:1024 sc1
  buffer_load_dwordx4 v[144:147], v2, s[8:11], s22 offen offset:2048 sc1
  buffer_load_dwordx4 v[148:151], v2, s[8:11], s22 offen offset:3072 sc1
  s_add_u32 s22, s31, 274432
  buffer_load_dwordx4 v[152:155], v2, s[8:11], s22 offen offset:0 sc1
  buffer_load_dwordx4 v[156:159], v2, s[8:11], s22 offen offset:1024 sc1
  buffer_load_dwordx4 v[160:163], v2, s[8:11], s22 offen offset:2048 sc1
  buffer_load_dwordx4 v[164:167], v2, s[8:11], s22 offen offset:3072 sc1
  s_add_u32 s22, s31, 278528
  buffer_load_dwordx4 v[168:171], v2, s[8:11], s22 offen offset:0 sc1
  buffer_load_dwordx4 v[172:175], v2, s[8:11], s22 offen offset:1024 sc1
  buffer_load_dwordx4 v[176:179], v2, s[8:11], s22 offen offset:2048 sc1
  buffer_load_dwordx4 v[180:183], v2, s[8:11], s22 offen offset:3072 sc1
  s_mov_b32 s24, 657408
  s_mov_b32 s26, 671744
  v_and_b32 v64, 7, v117
  v_and_b32 v65, 1, v116
  v_lshlrev_b32 v65, 2, v65
  v_sub_u32 v64, v64, v65
  v_lshrrev_b32 v65, 3, v117
  v_lshl_add_u32 v66, v65, 2, v64
  v_cmp_gt_u32 vcc, 4, v64
  v_mov_b32 v67, 99
  s_nop 0
  v_cndmask_b32 v66, v67, v66, vcc
  v_mov_b32 v68, 0x3f80
  v_mov_b32 v69, 0x3f800000
  v_mov_b32 v4, 0
  v_cmp_eq_u32 vcc, 0, v66
  s_nop 1
  v_cndmask_b32 v4, v4, v68, vcc
  v_cmp_eq_u32 vcc, 1, v66
  s_nop 1
  v_cndmask_b32 v4, v4, v69, vcc
  v_mov_b32 v5, 0
  v_cmp_eq_u32 vcc, 2, v66
  s_nop 1
  v_cndmask_b32 v5, v5, v68, vcc
  v_cmp_eq_u32 vcc, 3, v66
  s_nop 1
  v_cndmask_b32 v5, v5, v69, vcc
  v_mov_b32 v6, 0
  v_cmp_eq_u32 vcc, 4, v66
  s_nop 1
  v_cndmask_b32 v6, v6, v68, vcc
  v_cmp_eq_u32 vcc, 5, v66
  s_nop 1
  v_cndmask_b32 v6, v6, v69, vcc
  v_mov_b32 v7, 0
  v_cmp_eq_u32 vcc, 6, v66
  s_nop 1
  v_cndmask_b32 v7, v7, v68, vcc
  v_cmp_eq_u32 vcc, 7, v66
  s_nop 1
  v_cndmask_b32 v7, v7, v69, vcc
  v_lshrrev_b32 v64, 1, v116
  v_lshrrev_b32 v65, 3, v117
  v_and_b32 v66, 1, v116
  v_and_b32 v68, 7, v117
  v_lshlrev_b32 v67, 8, v65
  v_lshl_add_u32 v67, v68, 5, v67
  v_lshl_add_u32 v67, v66, 4, v67
  v_add_u32 v69, 4608, v67
  v_add_u32 v70, 6400, v67
  v_cmp_eq_u32 vcc, v64, v65
  s_nop 1
  v_cndmask_b32 v113, v70, v69, vcc
  v_and_b32 v74, 3, v117
  v_lshlrev_b32 v74, 1, v74
  v_bfe_u32 v75, v117, 2, 1
  v_or_b32 v74, v74, v75
  v_and_b32 v75, 8, v117
  v_or_b32 v74, v74, v75
  v_lshlrev_b32 v67, 9, v64
  v_lshl_add_u32 v67, v74, 4, v67
  v_lshl_add_u32 v67, v66, 3, v67
  v_add_u32 v114, 256, v67
  v_mul_u32_u24 v67, 1088, v65
  v_lshl_add_u32 v67, v116, 5, v67
  v_and_b32 v75, 1, v117
  v_and_b32 v76, 2, v117
  v_lshl_add_u32 v75, v76, 1, v75
  v_bfe_u32 v76, v117, 2, 1
  v_lshl_add_u32 v75, v76, 1, v75
  v_lshl_add_u32 v67, v75, 2, v67
  v_add_u32 v115, 4224, v67
  v_and_b32 v69, 1, v74
  v_lshlrev_b32 v67, 7, v69
  v_lshl_add_u32 v67, v116, 4, v67
  v_lshl_add_u32 v67, v65, 8, v67
  v_bfe_u32 v69, v74, 1, 2
  v_lshl_add_u32 v67, v69, 2, v67
  s_lshl_b32 s22, s17, 9
  s_add_u32 s22, s22, 9280
  v_add_u32 v72, s22, v67
  v_bfe_u32 v69, v75, 1, 1
  v_lshlrev_b32 v67, 7, v69
  v_lshl_add_u32 v67, v116, 4, v67
  v_and_b32 v69, 4, v75
  v_add_u32 v67, v67, v69
  s_lshr_b32 s22, s17, 1
  s_lshl_b32 s22, s22, 8
  s_and_b32 s27, s17, 1
  s_lshl_b32 s27, s27, 3
  s_add_u32 s22, s22, s27
  s_add_u32 s22, s22, 7232
  v_add_u32 v67, s22, v67
  v_and_b32 v69, 9, v117
  v_mov_b32 v70, 0x40000000
  v_cmp_eq_u32 vcc, 0, v69
  s_nop 1
  v_cndmask_b32 v118, v70, v67, vcc
  v_mov_b32 v119, -1
  s_lshl_b32 s22, s17, 2
  s_add_u32 s22, s22, 35328
  v_lshl_add_u32 v67, v1, 7, s22
  v_mov_b32 v70, 0x40000000
  v_cmp_gt_u32 vcc, 1, v1
  s_nop 1
  v_cndmask_b32 v73, v70, v67, vcc
  v_mov_b32 v112, 1
  v_and_b32 v0, 15, v1
  s_and_b32 s22, s17, 0
  s_lshl_b32 s22, s22, 7
  s_add_u32 s22, s22, 37376
  v_lshl_add_u32 v0, v0, 2, s22
  v_xor_b32 v69, 256, v2
  v_mul_i32_i24 v70, 4096, v66
  v_add_u32 v69, v69, v70
  v_add_u32 v117, 6144, v69
  v_mov_b32 v116, v73
  s_mul_i32 s35, s17, 28672
  s_add_u32 s35, s35, 4325376
  v_mov_b32 v1, v72
  v_mov_b32 v36, 0
  v_mov_b32 v37, 0
  v_mov_b32 v38, 0
  v_mov_b32 v39, 0
  v_mov_b32 v40, 0
  v_mov_b32 v41, 0
  v_mov_b32 v42, 0
  v_mov_b32 v43, 0
  v_mov_b32 v44, 0
  v_mov_b32 v45, 0
  v_mov_b32 v46, 0
  v_mov_b32 v47, 0
  v_mov_b32 v48, 0
  v_mov_b32 v49, 0
  v_mov_b32 v50, 0
  v_mov_b32 v51, 0
  v_mov_b32 v52, 0
  v_mov_b32 v53, 0
  v_mov_b32 v54, 0
  v_mov_b32 v55, 0
  v_mov_b32 v56, 0
  v_mov_b32 v57, 0
  v_mov_b32 v58, 0
  v_mov_b32 v59, 0
  v_mov_b32 v60, 0
  v_mov_b32 v61, 0
  v_mov_b32 v62, 0
  v_mov_b32 v63, 0
  v_mov_b32 v64, 0
  v_mov_b32 v65, 0
  v_mov_b32 v66, 0
  v_mov_b32 v67, 0
  v_mov_b32 v68, 0
  v_mov_b32 v69, 0
  v_mov_b32 v70, 0
  v_mov_b32 v71, 0
  v_mov_b32 v72, 0
  v_mov_b32 v73, 0
  v_mov_b32 v74, 0
  v_mov_b32 v75, 0
  v_mov_b32 v76, 0
  v_mov_b32 v77, 0
  v_mov_b32 v78, 0
  v_mov_b32 v79, 0
  s_mov_b32 s22, 0
  v_lshrrev_b32 v14, 4, v2
  v_add_u32 v14, 64, v14
  v_min_u32 v14, 308, v14
  v_lshlrev_b32 v14, 7, v14
  buffer_load_dword v15, v14, s[8:11], s22 offen sc1
  buffer_load_dwordx4 v[80:83], v117, s[8:11], s24 offen offset:0 sc1
  buffer_load_dwordx4 v[84:87], v117, s[8:11], s24 offen offset:1024 sc1
  buffer_load_dwordx4 v[88:91], v117, s[8:11], s26 offen offset:0 sc1
  buffer_load_dwordx4 v[92:95], v117, s[8:11], s26 offen offset:1024 sc1
  buffer_load_dwordx4 v[96:99], v2, s[8:11], s24 offen offset:0 sc1
  buffer_load_dwordx4 v[100:103], v2, s[8:11], s24 offen offset:1024 sc1
  buffer_load_dwordx4 v[104:107], v2, s[8:11], s26 offen offset:0 sc1
  buffer_load_dwordx4 v[108:111], v2, s[8:11], s26 offen offset:1024 sc1
  s_add_u32 s22, s31, 282624
  buffer_load_dwordx4 v[184:187], v2, s[8:11], s22 offen offset:0 sc1
  buffer_load_dwordx4 v[188:191], v2, s[8:11], s22 offen offset:1024 sc1
  buffer_load_dwordx4 v[192:195], v2, s[8:11], s22 offen offset:2048 sc1
  buffer_load_dwordx4 v[196:199], v2, s[8:11], s22 offen offset:3072 sc1
  s_add_u32 s22, s31, 344064
  buffer_load_dwordx4 v[200:203], v2, s[8:11], s22 offen offset:0 sc1
  buffer_load_dwordx4 v[204:207], v2, s[8:11], s22 offen offset:1024 sc1
  buffer_load_dwordx4 v[208:211], v2, s[8:11], s22 offen offset:2048 sc1
  buffer_load_dwordx4 v[212:215], v2, s[8:11], s22 offen offset:3072 sc1
  s_add_u32 s22, s31, 348160
  buffer_load_dwordx4 v[216:219], v2, s[8:11], s22 offen offset:0 sc1
  buffer_load_dwordx4 v[220:223], v2, s[8:11], s22 offen offset:1024 sc1
  buffer_load_dwordx4 v[224:227], v2, s[8:11], s22 offen offset:2048 sc1
  buffer_load_dwordx4 v[228:231], v2, s[8:11], s22 offen offset:3072 sc1
  s_add_u32 s22, s31, 352256
  buffer_load_dwordx4 v[232:235], v2, s[8:11], s22 offen offset:0 sc1
  buffer_load_dwordx4 v[236:239], v2, s[8:11], s22 offen offset:1024 sc1
  buffer_load_dwordx4 v[240:243], v2, s[8:11], s22 offen offset:2048 sc1
  buffer_load_dwordx4 v[244:247], v2, s[8:11], s22 offen offset:3072 sc1
  s_add_u32 s22, s31, 356352
  buffer_load_dwordx4 v[248:251], v2, s[8:11], s22 offen offset:0 sc1
  buffer_load_dwordx4 v[252:255], v2, s[8:11], s22 offen offset:1024 sc1
  s_waitcnt vmcnt(0) lgkmcnt(0)
  s_mov_b32 s31, 0
  s_cmp_lg_u32 s88, 0
  s_cbranch_scc1 cB_sc1_loop
  s_branch cA_sc1_loop
ch_init2:
  s_mul_i32 s31, s17, 401408
  s_add_u32 s31, s31, 33554432
  s_and_b32 s28, s84, 12384
  s_lshl_b32 s22, s85, 16
  s_or_b32 s28, s28, s22
  s_cmp_eq_u32 s28, 4294914144
  s_cbranch_scc1 ch_wx2_ok
  s_mov_b32 s30, 0
ch_wr2:
  buffer_load_dword v9, off, s[12:15], 0 offset:132 sc1
  s_waitcnt vmcnt(0)
  v_cmp_ne_u32 vcc, 1, v9
  s_cbranch_vccz ch_wr2_ok
  s_sleep 8
  s_add_u32 s30, s30, 1
  s_cmp_lt_u32 s30, 400000
  s_cbranch_scc1 ch_wr2
  s_branch cA_abort
ch_wr2_ok:
  s_lshl_b32 s27, s17, 7
  s_add_u32 s27, s27, 584192
  s_mov_b32 s28, 12384
  s_mov_b32 s30, 0
ch_wb2:
  buffer_load_dword v9, off, s[8:11], s27  sc1
  s_waitcnt vmcnt(0)
  v_and_b32 v10, s28, v9
  v_cmp_ne_u32 vcc, s28, v10
  s_cbranch_vccz ch_wb2_ok
  s_sleep 3
  s_add_u32 s30, s30, 1
  s_cmp_lt_u32 s30, 400000
  s_cbranch_scc1 ch_wb2
  s_branch cA_abort
ch_wb2_ok:
  s_mov_b32 s29, 586240
  s_mov_b32 s28, 0xffff
  s_mov_b32 s30, 0
ch_wx2:
  buffer_load_dword v9, off, s[8:11], s29  sc1
  s_waitcnt vmcnt(0)
  v_and_b32 v10, s28, v9
  v_cmp_ne_u32 vcc, s28, v10
  s_cbranch_vccz ch_wx2_ok
  s_sleep 8
  s_add_u32 s30, s30, 1
  s_cmp_lt_u32 s30, 400000
  s_cbranch_scc1 ch_wx2
  s_branch cA_abort
ch_wx2_ok:
  s_add_u32 s22, s31, 286720
  buffer_load_dwordx4 a[224:227], v2, s[8:11], s22 offen offset:0 sc1
  buffer_load_dwordx4 a[228:231], v2, s[8:11], s22 offen offset:1024 sc1
  buffer_load_dwordx4 a[232:235], v2, s[8:11], s22 offen offset:2048 sc1
  buffer_load_dwordx4 a[236:239], v2, s[8:11], s22 offen offset:3072 sc1
  s_add_u32 s22, s31, 290816
  buffer_load_dwordx4 a[240:243], v2, s[8:11], s22 offen offset:0 sc1
  buffer_load_dwordx4 a[244:247], v2, s[8:11], s22 offen offset:1024 sc1
  buffer_load_dwordx4 a[248:251], v2, s[8:11], s22 offen offset:2048 sc1
  buffer_load_dwordx4 a[252:255], v2, s[8:11], s22 offen offset:3072 sc1
  s_add_u32 s22, s31, 294912
  buffer_load_dwordx4 v[120:123], v2, s[8:11], s22 offen offset:0 sc1
  buffer_load_dwordx4 v[124:127], v2, s[8:11], s22 offen offset:1024 sc1
  buffer_load_dwordx4 v[128:131], v2, s[8:11], s22 offen offset:2048 sc1
  buffer_load_dwordx4 v[132:135], v2, s[8:11], s22 offen offset:3072 sc1
  s_add_u32 s22, s31, 299008
  buffer_load_dwordx4 v[136:139], v2, s[8:11], s22 offen offset:0 sc1
  buffer_load_dwordx4 v[140:143], v2, s[8:11], s22 offen offset:1024 sc1
  buffer_load_dwordx4 v[144:147], v2, s[8:11], s22 offen offset:2048 sc1
  buffer_load_dwordx4 v[148:151], v2, s[8:11], s22 offen offset:3072 sc1
  s_add_u32 s22, s31, 303104
  buffer_load_dwordx4 v[152:155], v2, s[8:11], s22 offen offset:0 sc1
  buffer_load_dwordx4 v[156:159], v2, s[8:11], s22 offen offset:1024 sc1
  buffer_load_dwordx4 v[160:163], v2, s[8:11], s22 offen offset:2048 sc1
  buffer_load_dwordx4 v[164:167], v2, s[8:11], s22 offen offset:3072 sc1
  s_add_u32 s22, s31, 307200
  buffer_load_dwordx4 v[168:171], v2, s[8:11], s22 offen offset:0 sc1
  buffer_load_dwordx4 v[172:175], v2, s[8:11], s22 offen offset:1024 sc1
  buffer_load_dwordx4 v[176:179], v2, s[8:11], s22 offen offset:2048 sc1
  buffer_load_dwordx4 v[180:183], v2, s[8:11], s22 offen offset:3072 sc1
  s_mov_b32 s24, 659456
  s_mov_b32 s26, 673792
  v_and_b32 v64, 7, v117
  v_and_b32 v65, 1, v116
  v_lshlrev_b32 v65, 2, v65
  v_sub_u32 v64, v64, v65
  v_lshrrev_b32 v65, 3, v117
  v_lshl_add_u32 v66, v65, 2, v64
  v_cmp_gt_u32 vcc, 4, v64
  v_mov_b32 v67, 99
  s_nop 0
  v_cndmask_b32 v66, v67, v66, vcc
  v_mov_b32 v68, 0x3f80
  v_mov_b32 v69, 0x3f800000
  v_mov_b32 v4, 0
  v_cmp_eq_u32 vcc, 0, v66
  s_nop 1
  v_cndmask_b32 v4, v4, v68, vcc
  v_cmp_eq_u32 vcc, 1, v66
  s_nop 1
  v_cndmask_b32 v4, v4, v69, vcc
  v_mov_b32 v5, 0
  v_cmp_eq_u32 vcc, 2, v66
  s_nop 1
  v_cndmask_b32 v5, v5, v68, vcc
  v_cmp_eq_u32 vcc, 3, v66
  s_nop 1
  v_cndmask_b32 v5, v5, v69, vcc
  v_mov_b32 v6, 0
  v_cmp_eq_u32 vcc, 4, v66
  s_nop 1
  v_cndmask_b32 v6, v6, v68, vcc
  v_cmp_eq_u32 vcc, 5, v66
  s_nop 1
  v_cndmask_b32 v6, v6, v69, vcc
  v_mov_b32 v7, 0
  v_cmp_eq_u32 vcc, 6, v66
  s_nop 1
  v_cndmask_b32 v7, v7, v68, vcc
  v_cmp_eq_u32 vcc, 7, v66
  s_nop 1
  v_cndmask_b32 v7, v7, v69, vcc
  v_lshrrev_b32 v64, 1, v116
  v_lshrrev_b32 v65, 3, v117
  v_and_b32 v66, 1, v116
  v_and_b32 v68, 7, v117
  v_lshlrev_b32 v67, 8, v65
  v_lshl_add_u32 v67, v68, 5, v67
  v_lshl_add_u32 v67, v66, 4, v67
  v_add_u32 v69, 5184, v67
  v_add_u32 v70, 6400, v67
  v_cmp_eq_u32 vcc, v64, v65
  s_nop 1
  v_cndmask_b32 v113, v70, v69, vcc
  s_lshl_b32 s22, s17, 9
  s_add_u32 s22, s22, 9216
  v_lshl_add_u32 v114, v1, 3, s22
  s_lshr_b32 s22, s17, 1
  s_lshl_b32 s22, s22, 8
  s_and_b32 s27, s17, 1
  s_lshl_b32 s27, s27, 3
  s_add_u32 s22, s22, s27
  s_add_u32 s22, s22, 7168
  v_add_u32 v115, s22, v2
  v_mov_b32 v70, 0x40000000
  v_cmp_gt_u32 vcc, 16, v1
  s_nop 1
  v_cndmask_b32 v115, v70, v115, vcc
  v_mov_b32 v118, -1
  v_mov_b32 v119, -1
  v_and_b32 v0, 15, v1
  s_and_b32 s22, s17, 0
  s_lshl_b32 s22, s22, 7
  s_add_u32 s22, s22, 37376
  v_lshl_add_u32 v0, v0, 2, s22
  v_xor_b32 v69, 256, v2
  v_mul_i32_i24 v70, -2048, v66
  v_add_u32 v69, v69, v70
  v_add_u32 v117, 8192, v69
  v_mov_b32 v116, v73
  s_mul_i32 s35, s17, 28672
  s_add_u32 s35, s35, 4325376
  v_mov_b32 v36, 0
  v_mov_b32 v37, 0
  v_mov_b32 v38, 0
  v_mov_b32 v39, 0
  v_mov_b32 v40, 0
  v_mov_b32 v41, 0
  v_mov_b32 v42, 0
  v_mov_b32 v43, 0
  v_mov_b32 v44, 0
  v_mov_b32 v45, 0
  v_mov_b32 v46, 0
  v_mov_b32 v47, 0
  v_mov_b32 v48, 0
  v_mov_b32 v49, 0
  v_mov_b32 v50, 0
  v_mov_b32 v51, 0
  v_mov_b32 v52, 0
  v_mov_b32 v53, 0
  v_mov_b32 v54, 0
  v_mov_b32 v55, 0
  v_mov_b32 v56, 0
  v_mov_b32 v57, 0
  v_mov_b32 v58, 0
  v_mov_b32 v59, 0
  v_mov_b32 v60, 0
  v_mov_b32 v61, 0
  v_mov_b32 v62, 0
  v_mov_b32 v63, 0
  v_mov_b32 v64, 0
  v_mov_b32 v65, 0
  v_mov_b32 v66, 0
  v_mov_b32 v67, 0
  v_mov_b32 v68, 0
  v_mov_b32 v69, 0
  v_mov_b32 v70, 0
  v_mov_b32 v71, 0
  v_mov_b32 v72, 0
  v_mov_b32 v73, 0
  v_mov_b32 v74, 0
  v_mov_b32 v75, 0
  v_mov_b32 v76, 0
  v_mov_b32 v77, 0
  v_mov_b32 v78, 0
  v_mov_b32 v79, 0
  s_mov_b32 s22, 0
  v_lshrrev_b32 v14, 4, v2
  v_add_u32 v14, 128, v14
  v_min_u32 v14, 308, v14
  v_lshlrev_b32 v14, 7, v14
  buffer_load_dword v15, v14, s[8:11], s22 offen sc1
  buffer_load_dwordx4 v[80:83], v117, s[8:11], s24 offen offset:0 sc1
  buffer_load_dwordx4 v[84:87], v117, s[8:11], s24 offen offset:1024 sc1
  buffer_load_dwordx4 v[88:91], v117, s[8:11], s26 offen offset:0 sc1
  buffer_load_dwordx4 v[92:95], v117, s[8:11], s26 offen offset:1024 sc1
  buffer_load_dwordx4 v[96:99], v2, s[8:11], s24 offen offset:0 sc1
  buffer_load_dwordx4 v[100:103], v2, s[8:11], s24 offen offset:1024 sc1
  buffer_load_dwordx4 v[104:107], v2, s[8:11], s26 offen offset:0 sc1
  buffer_load_dwordx4 v[108:111], v2, s[8:11], s26 offen offset:1024 sc1
  s_add_u32 s22, s31, 311296
  buffer_load_dwordx4 v[184:187], v2, s[8:11], s22 offen offset:0 sc1
  buffer_load_dwordx4 v[188:191], v2, s[8:11], s22 offen offset:1024 sc1
  buffer_load_dwordx4 v[192:195], v2, s[8:11], s22 offen offset:2048 sc1
  buffer_load_dwordx4 v[196:199], v2, s[8:11], s22 offen offset:3072 sc1
  s_add_u32 s22, s31, 385024
  buffer_load_dwordx4 v[200:203], v2, s[8:11], s22 offen offset:2048 sc1
  buffer_load_dwordx4 v[204:207], v2, s[8:11], s22 offen offset:3072 sc1
  s_add_u32 s22, s31, 389120
  buffer_load_dwordx4 v[208:211], v2, s[8:11], s22 offen offset:0 sc1
  buffer_load_dwordx4 v[212:215], v2, s[8:11], s22 offen offset:1024 sc1
  buffer_load_dwordx4 v[216:219], v2, s[8:11], s22 offen offset:2048 sc1
  buffer_load_dwordx4 v[220:223], v2, s[8:11], s22 offen offset:3072 sc1
  s_add_u32 s22, s31, 393216
  buffer_load_dwordx4 v[224:227], v2, s[8:11], s22 offen offset:0 sc1
  buffer_load_dwordx4 v[228:231], v2, s[8:11], s22 offen offset:1024 sc1
  buffer_load_dwordx4 v[232:235], v2, s[8:11], s22 offen offset:2048 sc1
  buffer_load_dwordx4 v[236:239], v2, s[8:11], s22 offen offset:3072 sc1
  s_add_u32 s22, s31, 397312
  buffer_load_dwordx4 v[240:243], v2, s[8:11], s22 offen offset:0 sc1
  buffer_load_dwordx4 v[244:247], v2, s[8:11], s22 offen offset:1024 sc1
  buffer_load_dwordx4 v[248:251], v2, s[8:11], s22 offen offset:2048 sc1
  buffer_load_dwordx4 v[252:255], v2, s[8:11], s22 offen offset:3072 sc1
  s_waitcnt vmcnt(0) lgkmcnt(0)
  s_mov_b32 s31, 0
  s_cmp_lg_u32 s88, 0
  s_cbranch_scc1 cB_sc2_loop
  s_branch cA_sc2_loop
ch_init3:
  s_mul_i32 s31, s17, 401408
  s_add_u32 s31, s31, 33554432
  s_and_b32 s28, s84, 12384
  s_lshl_b32 s22, s85, 16
  s_or_b32 s28, s28, s22
  s_cmp_eq_u32 s28, 4294914144
  s_cbranch_scc1 ch_wx3_ok
  s_mov_b32 s30, 0
ch_wr3:
  buffer_load_dword v9, off, s[12:15], 0 offset:132 sc1
  s_waitcnt vmcnt(0)
  v_cmp_ne_u32 vcc, 1, v9
  s_cbranch_vccz ch_wr3_ok
  s_sleep 8
  s_add_u32 s30, s30, 1
  s_cmp_lt_u32 s30, 400000
  s_cbranch_scc1 ch_wr3
  s_branch cA_abort
ch_wr3_ok:
  s_lshl_b32 s27, s17, 7
  s_add_u32 s27, s27, 584192
  s_mov_b32 s28, 12384
  s_mov_b32 s30, 0
ch_wb3:
  buffer_load_dword v9, off, s[8:11], s27  sc1
  s_waitcnt vmcnt(0)
  v_and_b32 v10, s28, v9
  v_cmp_ne_u32 vcc, s28, v10
  s_cbranch_vccz ch_wb3_ok
  s_sleep 3
  s_add_u32 s30, s30, 1
  s_cmp_lt_u32 s30, 400000
  s_cbranch_scc1 ch_wb3
  s_branch cA_abort
ch_wb3_ok:
  s_mov_b32 s29, 586240
  s_mov_b32 s28, 0xffff
  s_mov_b32 s30, 0
ch_wx3:
  buffer_load_dword v9, off, s[8:11], s29  sc1
  s_waitcnt vmcnt(0)
  v_and_b32 v10, s28, v9
  v_cmp_ne_u32 vcc, s28, v10
  s_cbranch_vccz ch_wx3_ok
  s_sleep 8
  s_add_u32 s30, s30, 1
  s_cmp_lt_u32 s30, 400000
  s_cbranch_scc1 ch_wx3
  s_branch cA_abort
ch_wx3_ok:
  s_add_u32 s22, s31, 315392
  buffer_load_dwordx4 a[224:227], v2, s[8:11], s22 offen offset:0 sc1
  buffer_load_dwordx4 a[228:231], v2, s[8:11], s22 offen offset:1024 sc1
  buffer_load_dwordx4 a[232:235], v2, s[8:11], s22 offen offset:2048 sc1
  buffer_load_dwordx4 a[236:239], v2, s[8:11], s22 offen offset:3072 sc1
  s_add_u32 s22, s31, 319488
  buffer_load_dwordx4 a[240:243], v2, s[8:11], s22 offen offset:0 sc1
  buffer_load_dwordx4 a[244:247], v2, s[8:11], s22 offen offset:1024 sc1
  buffer_load_dwordx4 a[248:251], v2, s[8:11], s22 offen offset:2048 sc1
  buffer_load_dwordx4 a[252:255], v2, s[8:11], s22 offen offset:3072 sc1
  s_add_u32 s22, s31, 323584
  buffer_load_dwordx4 v[120:123], v2, s[8:11], s22 offen offset:0 sc1
  buffer_load_dwordx4 v[124:127], v2, s[8:11], s22 offen offset:1024 sc1
  buffer_load_dwordx4 v[128:131], v2, s[8:11], s22 offen offset:2048 sc1
  buffer_load_dwordx4 v[132:135], v2, s[8:11], s22 offen offset:3072 sc1
  s_add_u32 s22, s31, 327680
  buffer_load_dwordx4 v[136:139], v2, s[8:11], s22 offen offset:0 sc1
  buffer_load_dwordx4 v[140:143], v2, s[8:11], s22 offen offset:1024 sc1
  buffer_load_dwordx4 v[144:147], v2, s[8:11], s22 offen offset:2048 sc1
  buffer_load_dwordx4 v[148:151], v2, s[8:11], s22 offen offset:3072 sc1
  s_add_u32 s22, s31, 331776
  buffer_load_dwordx4 v[152:155], v2, s[8:11], s22 offen offset:0 sc1
  buffer_load_dwordx4 v[156:159], v2, s[8:11], s22 offen offset:1024 sc1
  buffer_load_dwordx4 v[160:163], v2, s[8:11], s22 offen offset:2048 sc1
  buffer_load_dwordx4 v[164:167], v2, s[8:11], s22 offen offset:3072 sc1
  s_add_u32 s22, s31, 335872
  buffer_load_dwordx4 v[168:171], v2, s[8:11], s22 offen offset:0 sc1
  buffer_load_dwordx4 v[172:175], v2, s[8:11], s22 offen offset:1024 sc1
  buffer_load_dwordx4 v[176:179], v2, s[8:11], s22 offen offset:2048 sc1
  buffer_load_dwordx4 v[180:183], v2, s[8:11], s22 offen offset:3072 sc1
  s_mov_b32 s24, 661504
  s_mov_b32 s26, 675840
  v_and_b32 v64, 7, v117
  v_and_b32 v65, 1, v116
  v_lshlrev_b32 v65, 2, v65
  v_sub_u32 v64, v64, v65
  v_lshrrev_b32 v65, 3, v117
  v_lshl_add_u32 v66, v65, 2, v64
  v_cmp_gt_u32 vcc, 4, v64
  v_mov_b32 v67, 99
  s_nop 0
  v_cndmask_b32 v66, v67, v66, vcc
  v_mov_b32 v68, 0x3f80
  v_mov_b32 v69, 0x3f800000
  v_mov_b32 v4, 0
  v_cmp_eq_u32 vcc, 0, v66
  s_nop 1
  v_cndmask_b32 v4, v4, v68, vcc
  v_cmp_eq_u32 vcc, 1, v66
  s_nop 1
  v_cndmask_b32 v4, v4, v69, vcc
  v_mov_b32 v5, 0
  v_cmp_eq_u32 vcc, 2, v66
  s_nop 1
  v_cndmask_b32 v5, v5, v68, vcc
  v_cmp_eq_u32 vcc, 3, v66
  s_nop 1
  v_cndmask_b32 v5, v5, v69, vcc
  v_mov_b32 v6, 0
  v_cmp_eq_u32 vcc, 4, v66
  s_nop 1
  v_cndmask_b32 v6, v6, v68, vcc
  v_cmp_eq_u32 vcc, 5, v66
  s_nop 1
  v_cndmask_b32 v6, v6, v69, vcc
  v_mov_b32 v7, 0
  v_cmp_eq_u32 vcc, 6, v66
  s_nop 1
  v_cndmask_b32 v7, v7, v68, vcc
  v_cmp_eq_u32 vcc, 7, v66
  s_nop 1
  v_cndmask_b32 v7, v7, v69, vcc
  v_lshrrev_b32 v64, 1, v116
  v_lshrrev_b32 v65, 3, v117
  v_and_b32 v66, 1, v116
  v_and_b32 v68, 7, v117
  v_lshlrev_b32 v67, 8, v65
  v_lshl_add_u32 v67, v68, 5, v67
  v_lshl_add_u32 v67, v66, 4, v67
  v_add_u32 v69, 5696, v67
  v_add_u32 v70, 6400, v67
  v_cmp_eq_u32 vcc, v64, v65
  s_nop 1
  v_cndmask_b32 v113, v70, v69, vcc
  v_and_b32 v0, 15, v1
  s_and_b32 s22, s17, 0
  s_lshl_b32 s22, s22, 7
  s_add_u32 s22, s22, 37376
  v_lshl_add_u32 v0, v0, 2, s22
  v_xor_b32 v69, 256, v2
  v_mul_i32_i24 v70, 2048, v66
  v_add_u32 v69, v69, v70
  v_add_u32 v117, 4096, v69
  v_mov_b32 v116, v73
  s_mul_i32 s35, s17, 28672
  s_add_u32 s35, s35, 4325376
  v_mov_b32 v36, 0
  v_mov_b32 v37, 0
  v_mov_b32 v38, 0
  v_mov_b32 v39, 0
  v_mov_b32 v40, 0
  v_mov_b32 v41, 0
  v_mov_b32 v42, 0
  v_mov_b32 v43, 0
  v_mov_b32 v44, 0
  v_mov_b32 v45, 0
  v_mov_b32 v46, 0
  v_mov_b32 v47, 0
  v_mov_b32 v48, 0
  v_mov_b32 v49, 0
  v_mov_b32 v50, 0
  v_mov_b32 v51, 0
  v_mov_b32 v52, 0
  v_mov_b32 v53, 0
  v_mov_b32 v54, 0
  v_mov_b32 v55, 0
  v_mov_b32 v56, 0
  v_mov_b32 v57, 0
  v_mov_b32 v58, 0
  v_mov_b32 v59, 0
  v_mov_b32 v60, 0
  v_mov_b32 v61, 0
  v_mov_b32 v62, 0
  v_mov_b32 v63, 0
  v_mov_b32 v64, 0
  v_mov_b32 v65, 0
  v_mov_b32 v66, 0
  v_mov_b32 v67, 0
  v_mov_b32 v68, 0
  v_mov_b32 v69, 0
  v_mov_b32 v70, 0
  v_mov_b32 v71, 0
  v_mov_b32 v72, 0
  v_mov_b32 v73, 0
  v_mov_b32 v74, 0
  v_mov_b32 v75, 0
  v_mov_b32 v76, 0
  v_mov_b32 v77, 0
  v_mov_b32 v78, 0
  v_mov_b32 v79, 0
  s_mov_b32 s22, 0
  v_lshrrev_b32 v14, 4, v2
  v_add_u32 v14, 192, v14
  v_min_u32 v14, 308, v14
  v_lshlrev_b32 v14, 7, v14
  buffer_load_dword v15, v14, s[8:11], s22 offen sc1
  buffer_load_dwordx4 v[80:83], v117, s[8:11], s24 offen offset:0 sc1
  buffer_load_dwordx4 v[84:87], v117, s[8:11], s24 offen offset:1024 sc1
  buffer_load_dwordx4 v[88:91], v117, s[8:11], s26 offen offset:0 sc1
  buffer_load_dwordx4 v[92:95], v117, s[8:11], s26 offen offset:1024 sc1
  buffer_load_dwordx4 v[96:99], v2, s[8:11], s24 offen offset:0 sc1
  buffer_load_dwordx4 v[100:103], v2, s[8:11], s24 offen offset:1024 sc1
  buffer_load_dwordx4 v[104:107], v2, s[8:11], s26 offen offset:0 sc1
  buffer_load_dwordx4 v[108:111], v2, s[8:11], s26 offen offset:1024 sc1
  s_add_u32 s22, s31, 339968
  buffer_load_dwordx4 v[184:187], v2, s[8:11], s22 offen offset:0 sc1
  buffer_load_dwordx4 v[188:191], v2, s[8:11], s22 offen offset:1024 sc1
  buffer_load_dwordx4 v[192:195], v2, s[8:11], s22 offen offset:2048 sc1
  buffer_load_dwordx4 v[196:199], v2, s[8:11], s22 offen offset:3072 sc1
  s_add_u32 s22, s31, 356352
  buffer_load_dwordx4 v[200:203], v2, s[8:11], s22 offen offset:2048 sc1
  buffer_load_dwordx4 v[204:207], v2, s[8:11], s22 offen offset:3072 sc1
  s_add_u32 s22, s31, 360448
  buffer_load_dwordx4 v[208:211], v2, s[8:11], s22 offen offset:0 sc1
  buffer_load_dwordx4 v[212:215], v2, s[8:11], s22 offen offset:1024 sc1
  buffer_load_dwordx4 v[216:219], v2, s[8:11], s22 offen offset:2048 sc1
  buffer_load_dwordx4 v[220:223], v2, s[8:11], s22 offen offset:3072 sc1
  s_add_u32 s22, s31, 364544
  buffer_load_dwordx4 v[224:227], v2, s[8:11], s22 offen offset:0 sc1
  buffer_load_dwordx4 v[228:231], v2, s[8:11], s22 offen offset:1024 sc1
  buffer_load_dwordx4 v[232:235], v2, s[8:11], s22 offen offset:2048 sc1
  buffer_load_dwordx4 v[236:239], v2, s[8:11], s22 offen offset:3072 sc1
  s_add_u32 s22, s31, 368640
  buffer_load_dwordx4 v[240:243], v2, s[8:11], s22 offen offset:0 sc1
  buffer_load_dwordx4 v[244:247], v2, s[8:11], s22 offen offset:1024 sc1
  buffer_load_dwordx4 v[248:251], v2, s[8:11], s22 offen offset:2048 sc1
  buffer_load_dwordx4 v[252:255], v2, s[8:11], s22 offen offset:3072 sc1
  s_waitcnt vmcnt(0) lgkmcnt(0)
  s_mov_b32 s31, 0
  s_cmp_lg_u32 s88, 0
  s_cbranch_scc1 cB_sc3_loop
  s_branch cA_sc3_loop
ch_init4:
  v_mov_b32 v72, v116
  v_mov_b32 v73, v117
  v_lshrrev_b32 v65, 1, v72
  v_and_b32 v66, 1, v72
  v_mov_b32 v36, 0
  v_mov_b32 v37, 0
  v_mov_b32 v38, 0
  v_mov_b32 v39, 0
  v_mov_b32 v40, 0
  v_mov_b32 v41, 0
  v_mov_b32 v42, 0
  v_mov_b32 v43, 0
  v_mov_b32 v44, 0
  v_mov_b32 v45, 0
  v_mov_b32 v46, 0
  v_mov_b32 v47, 0
  v_mov_b32 v48, 0
  v_mov_b32 v49, 0
  v_mov_b32 v50, 0
  v_mov_b32 v51, 0
  v_mov_b32 v52, 0
  v_mov_b32 v53, 0
  v_mov_b32 v54, 0
  v_mov_b32 v55, 0
  v_mov_b32 v56, 0
  v_mov_b32 v57, 0
  v_mov_b32 v58, 0
  v_mov_b32 v59, 0
  v_mov_b32 v60, 0
  v_mov_b32 v61, 0
  v_mov_b32 v62, 0
  v_mov_b32 v63, 0
  v_lshlrev_b32 v75, 2, v65
  v_lshl_add_u32 v75, v66, 3, v75
  v_add_u32 v67, 0, v73
  v_mul_u32_u24 v68, 2341, v67
  v_lshrrev_b32 v68, 16, v68
  v_mul_u32_u24 v69, 28, v68
  v_sub_u32 v69, v67, v69
  v_lshrrev_b32 v70, 4, v69
  v_and_b32 v69, 15, v69
  v_lshlrev_b32 v71, 12, v70
  v_lshl_add_u32 v71, v68, 8, v71
  v_lshl_add_u32 v71, v69, 4, v71
  v_add_u32 v152, v71, v75
  v_add_u32 v67, 16, v73
  v_mul_u32_u24 v68, 2341, v67
  v_lshrrev_b32 v68, 16, v68
  v_mul_u32_u24 v69, 28, v68
  v_sub_u32 v69, v67, v69
  v_lshrrev_b32 v70, 4, v69
  v_and_b32 v69, 15, v69
  v_lshlrev_b32 v71, 12, v70
  v_lshl_add_u32 v71, v68, 8, v71
  v_lshl_add_u32 v71, v69, 4, v71
  v_add_u32 v153, v71, v75
  v_add_u32 v67, 32, v73
  v_mul_u32_u24 v68, 2341, v67
  v_lshrrev_b32 v68, 16, v68
  v_mul_u32_u24 v69, 28, v68
  v_sub_u32 v69, v67, v69
  v_lshrrev_b32 v70, 4, v69
  v_and_b32 v69, 15, v69
  v_lshlrev_b32 v71, 12, v70
  v_lshl_add_u32 v71, v68, 8, v71
  v_lshl_add_u32 v71, v69, 4, v71
  v_add_u32 v154, v71, v75
  v_add_u32 v67, 48, v73
  v_mul_u32_u24 v68, 2341, v67
  v_lshrrev_b32 v68, 16, v68
  v_mul_u32_u24 v69, 28, v68
  v_sub_u32 v69, v67, v69
  v_lshrrev_b32 v70, 4, v69
  v_and_b32 v69, 15, v69
  v_lshlrev_b32 v71, 12, v70
  v_lshl_add_u32 v71, v68, 8, v71
  v_lshl_add_u32 v71, v69, 4, v71
  v_add_u32 v155, v71, v75
  v_add_u32 v67, 64, v73
  v_mul_u32_u24 v68, 2341, v67
  v_lshrrev_b32 v68, 16, v68
  v_mul_u32_u24 v69, 28, v68
  v_sub_u32 v69, v67, v69
  v_lshrrev_b32 v70, 4, v69
  v_and_b32 v69, 15, v69
  v_lshlrev_b32 v71, 12, v70
  v_lshl_add_u32 v71, v68, 8, v71
  v_lshl_add_u32 v71, v69, 4, v71
  v_add_u32 v156, v71, v75
  v_add_u32 v67, 80, v73
  v_mul_u32_u24 v68, 2341, v67
  v_lshrrev_b32 v68, 16, v68
  v_mul_u32_u24 v69, 28, v68
  v_sub_u32 v69, v67, v69
  v_lshrrev_b32 v70, 4, v69
  v_and_b32 v69, 15, v69
  v_lshlrev_b32 v71, 12, v70
  v_lshl_add_u32 v71, v68, 8, v71
  v_lshl_add_u32 v71, v69, 4, v71
  v_add_u32 v157, v71, v75
  v_mov_b32 v74, 0x40000000
  v_mov_b32 v164, 0
  v_mov_b32 v76, 0
  v_mov_b32 v77, 0
  v_mov_b32 v78, 0
  v_mov_b32 v79, 0
  ds_write_b128 v2, v[76:79] offset:0
  ds_write_b128 v2, v[76:79] offset:1024
  ds_write_b128 v2, v[76:79] offset:2048
  ds_write_b128 v2, v[76:79] offset:3072
  s_and_b32 s22, s17, 0
  s_lshl_b32 s22, s22, 7
  s_add_u32 s22, s22, 35328
  v_lshl_add_u32 v4, v73, 2, s22
  v_and_b32 v64, 1, v73
  v_mov_b32 v5, 0x05040100
  v_mov_b32 v65, 0x03020706
  v_cmp_eq_u32 vcc, 1, v64
  s_nop 1
  v_cndmask_b32 v5, v5, v65, vcc
  s_lshl_b32 s22, s17, 2
  s_add_u32 s22, s22, 37376
  v_lshl_add_u32 v7, v1, 7, s22
  v_cmp_gt_u32 vcc, 1, v1
  s_nop 1
  v_cndmask_b32 v7, v74, v7, vcc
  v_mov_b32 v6, v2
  v_lshl_add_u32 v64, v66, 2, v64
  v_and_b32 v65, 2, v72
  v_add_u32 v64, v64, v65
  s_mul_i32 s22, s17, 16
  v_add_u32 v75, s22, v73
  v_lshrrev_b32 v68, 4, v75
  v_lshlrev_b32 v68, 8, v68
  v_bfe_u32 v69, v75, 1, 1
  v_lshl_add_u32 v68, v69, 7, v68
  v_lshl_add_u32 v68, v64, 4, v68
  v_and_b32 v69, 12, v75
  v_add_u32 v1, v68, v69
  s_mul_i32 s22, s17, 28672
  s_add_u32 s25, s22, 2490368
  s_and_b32 s27, s17, 0
  s_xor_b32 s22, s27, 0
  s_mul_i32 s80, s22, 7168
  s_lshl_b32 s22, s22, 11
  s_add_u32 s76, s22, 9216
  s_xor_b32 s22, s27, 1
  s_mul_i32 s81, s22, 7168
  s_lshl_b32 s22, s22, 11
  s_add_u32 s77, s22, 9216
  s_xor_b32 s22, s27, 2
  s_mul_i32 s82, s22, 7168
  s_lshl_b32 s22, s22, 11
  s_add_u32 s78, s22, 9216
  s_xor_b32 s22, s27, 3
  s_mul_i32 s83, s22, 7168
  s_lshl_b32 s22, s22, 11
  s_add_u32 s79, s22, 9216
  v_mov_b32 v162, -1
  s_mov_b32 s38, 0x40000000
  s_mul_i32 s31, s17, 401408
  s_add_u32 s31, s31, 39976960
  s_mov_b32 s30, 0
ch_wr4:
  buffer_load_dword v9, off, s[12:15], 0 offset:128 sc1
  s_waitcnt vmcnt(0)
  v_cmp_ne_u32 vcc, 1, v9
  s_cbranch_vccz ch_wr4_ok
  s_sleep 8
  s_add_u32 s30, s30, 1
  s_cmp_lt_u32 s30, 400000
  s_cbranch_scc1 ch_wr4
  s_branch cA_abort
ch_wr4_ok:
  s_lshr_b32 s22, s17, 2
  s_lshl_b32 s28, 0x81, s22
  s_mul_i32 s27, s17, 12
  s_add_u32 s22, s27, 256
  s_lshr_b32 s22, s22, 6
  s_lshl_b32 s22, 0x81, s22
  s_or_b32 s28, s28, s22
  s_add_u32 s22, s27, 267
  s_lshr_b32 s22, s22, 6
  s_lshl_b32 s22, 0x81, s22
  s_or_b32 s28, s28, s22
  v_lshrrev_b32 v12, 8, v2
  v_lshlrev_b32 v12, 7, v12
  s_mov_b32 s27, 582144
  s_mov_b32 s30, 0
ch_ww4:
  buffer_load_dword v9, v12, s[8:11], s27 offen sc1
  s_waitcnt vmcnt(0)
  v_and_b32 v10, s28, v9
  v_cmp_ne_u32 vcc, s28, v10
  s_cbranch_vccz ch_ww4_ok
  s_sleep 3
  s_add_u32 s30, s30, 1
  s_cmp_lt_u32 s30, 400000
  s_cbranch_scc1 ch_ww4
  s_branch cA_abort
ch_ww4_ok:
  s_add_u32 s22, s31, 0
  buffer_load_dwordx4 a[0:3], v2, s[8:11], s22 offen offset:0 sc1
  buffer_load_dwordx4 a[4:7], v2, s[8:11], s22 offen offset:1024 sc1
  buffer_load_dwordx4 a[8:11], v2, s[8:11], s22 offen offset:2048 sc1
  buffer_load_dwordx4 a[12:15], v2, s[8:11], s22 offen offset:3072 sc1
  s_add_u32 s22, s31, 4096
  buffer_load_dwordx4 a[16:19], v2, s[8:11], s22 offen offset:0 sc1
  buffer_load_dwordx4 a[20:23], v2, s[8:11], s22 offen offset:1024 sc1
  buffer_load_dwordx4 a[24:27], v2, s[8:11], s22 offen offset:2048 sc1
  buffer_load_dwordx4 a[28:31], v2, s[8:11], s22 offen offset:3072 sc1
  s_add_u32 s22, s31, 8192
  buffer_load_dwordx4 a[32:35], v2, s[8:11], s22 offen offset:0 sc1
  buffer_load_dwordx4 a[36:39], v2, s[8:11], s22 offen offset:1024 sc1
  buffer_load_dwordx4 a[40:43], v2, s[8:11], s22 offen offset:2048 sc1
  buffer_load_dwordx4 a[44:47], v2, s[8:11], s22 offen offset:3072 sc1
  s_add_u32 s22, s31, 12288
  buffer_load_dwordx4 a[48:51], v2, s[8:11], s22 offen offset:0 sc1
  buffer_load_dwordx4 a[52:55], v2, s[8:11], s22 offen offset:1024 sc1
  buffer_load_dwordx4 a[56:59], v2, s[8:11], s22 offen offset:2048 sc1
  buffer_load_dwordx4 a[60:63], v2, s[8:11], s22 offen offset:3072 sc1
  s_add_u32 s22, s31, 16384
  buffer_load_dwordx4 a[64:67], v2, s[8:11], s22 offen offset:0 sc1
  buffer_load_dwordx4 a[68:71], v2, s[8:11], s22 offen offset:1024 sc1
  buffer_load_dwordx4 a[72:75], v2, s[8:11], s22 offen offset:2048 sc1
  buffer_load_dwordx4 a[76:79], v2, s[8:11], s22 offen offset:3072 sc1
  s_add_u32 s22, s31, 20480
  buffer_load_dwordx4 a[80:83], v2, s[8:11], s22 offen offset:0 sc1
  buffer_load_dwordx4 a[84:87], v2, s[8:11], s22 offen offset:1024 sc1
  buffer_load_dwordx4 a[88:91], v2, s[8:11], s22 offen offset:2048 sc1
  buffer_load_dwordx4 a[92:95], v2, s[8:11], s22 offen offset:3072 sc1
  s_add_u32 s22, s31, 24576
  buffer_load_dwordx4 a[96:99], v2, s[8:11], s22 offen offset:0 sc1
  buffer_load_dwordx4 a[100:103], v2, s[8:11], s22 offen offset:1024 sc1
  buffer_load_dwordx4 a[104:107], v2, s[8:11], s22 offen offset:2048 sc1
  buffer_load_dwordx4 a[108:111], v2, s[8:11], s22 offen offset:3072 sc1
  s_add_u32 s22, s31, 28672
  buffer_load_dwordx4 a[112:115], v2, s[8:11], s22 offen offset:0 sc1
  buffer_load_dwordx4 a[116:119], v2, s[8:11], s22 offen offset:1024 sc1
  buffer_load_dwordx4 a[120:123], v2, s[8:11], s22 offen offset:2048 sc1
  buffer_load_dwordx4 a[124:127], v2, s[8:11], s22 offen offset:3072 sc1
  s_waitcnt vmcnt(24)
  s_add_u32 s22, s31, 32768
  buffer_load_dwordx4 a[128:131], v2, s[8:11], s22 offen offset:0 sc1
  buffer_load_dwordx4 a[132:135], v2, s[8:11], s22 offen offset:1024 sc1
  buffer_load_dwordx4 a[136:139], v2, s[8:11], s22 offen offset:2048 sc1
  buffer_load_dwordx4 a[140:143], v2, s[8:11], s22 offen offset:3072 sc1
  s_add_u32 s22, s31, 36864
  buffer_load_dwordx4 a[144:147], v2, s[8:11], s22 offen offset:0 sc1
  buffer_load_dwordx4 a[148:151], v2, s[8:11], s22 offen offset:1024 sc1
  buffer_load_dwordx4 a[152:155], v2, s[8:11], s22 offen offset:2048 sc1
  buffer_load_dwordx4 a[156:159], v2, s[8:11], s22 offen offset:3072 sc1
  s_add_u32 s22, s31, 40960
  buffer_load_dwordx4 a[160:163], v2, s[8:11], s22 offen offset:0 sc1
  buffer_load_dwordx4 a[164:167], v2, s[8:11], s22 offen offset:1024 sc1
  buffer_load_dwordx4 a[168:171], v2, s[8:11], s22 offen offset:2048 sc1
  buffer_load_dwordx4 a[172:175], v2, s[8:11], s22 offen offset:3072 sc1
  s_add_u32 s22, s31, 45056
  buffer_load_dwordx4 a[176:179], v2, s[8:11], s22 offen offset:0 sc1
  buffer_load_dwordx4 a[180:183], v2, s[8:11], s22 offen offset:1024 sc1
  buffer_load_dwordx4 a[184:187], v2, s[8:11], s22 offen offset:2048 sc1
  buffer_load_dwordx4 a[188:191], v2, s[8:11], s22 offen offset:3072 sc1
  s_add_u32 s22, s31, 49152
  buffer_load_dwordx4 a[192:195], v2, s[8:11], s22 offen offset:0 sc1
  buffer_load_dwordx4 a[196:199], v2, s[8:11], s22 offen offset:1024 sc1
  buffer_load_dwordx4 a[200:203], v2, s[8:11], s22 offen offset:2048 sc1
  buffer_load_dwordx4 a[204:207], v2, s[8:11], s22 offen offset:3072 sc1
  s_add_u32 s22, s31, 53248
  buffer_load_dwordx4 a[208:211], v2, s[8:11], s22 offen offset:0 sc1
  buffer_load_dwordx4 a[212:215], v2, s[8:11], s22 offen offset:1024 sc1
  buffer_load_dwordx4 a[216:219], v2, s[8:11], s22 offen offset:2048 sc1
  buffer_load_dwordx4 a[220:223], v2, s[8:11], s22 offen offset:3072 sc1
  s_add_u32 s22, s31, 57344
  buffer_load_dwordx4 a[224:227], v2, s[8:11], s22 offen offset:0 sc1
  buffer_load_dwordx4 a[228:231], v2, s[8:11], s22 offen offset:1024 sc1
  buffer_load_dwordx4 a[232:235], v2, s[8:11], s22 offen offset:2048 sc1
  buffer_load_dwordx4 a[236:239], v2, s[8:11], s22 offen offset:3072 sc1
  s_add_u32 s22, s31, 61440
  buffer_load_dwordx4 a[240:243], v2, s[8:11], s22 offen offset:0 sc1
  buffer_load_dwordx4 a[244:247], v2, s[8:11], s22 offen offset:1024 sc1
  buffer_load_dwordx4 a[248:251], v2, s[8:11], s22 offen offset:2048 sc1
  buffer_load_dwordx4 a[252:255], v2, s[8:11], s22 offen offset:3072 sc1
  s_waitcnt vmcnt(24)
  s_add_u32 s22, s31, 65536
  buffer_load_dwordx4 v[176:179], v2, s[8:11], s22 offen offset:0 sc1
  buffer_load_dwordx4 v[180:183], v2, s[8:11], s22 offen offset:1024 sc1
  buffer_load_dwordx4 v[184:187], v2, s[8:11], s22 offen offset:2048 sc1
  buffer_load_dwordx4 v[188:191], v2, s[8:11], s22 offen offset:3072 sc1
  s_add_u32 s22, s31, 69632
  buffer_load_dwordx4 v[192:195], v2, s[8:11], s22 offen offset:0 sc1
  buffer_load_dwordx4 v[196:199], v2, s[8:11], s22 offen offset:1024 sc1
  buffer_load_dwordx4 v[200:203], v2, s[8:11], s22 offen offset:2048 sc1
  buffer_load_dwordx4 v[204:207], v2, s[8:11], s22 offen offset:3072 sc1
  s_add_u32 s22, s31, 73728
  buffer_load_dwordx4 v[208:211], v2, s[8:11], s22 offen offset:0 sc1
  buffer_load_dwordx4 v[212:215], v2, s[8:11], s22 offen offset:1024 sc1
  buffer_load_dwordx4 v[216:219], v2, s[8:11], s22 offen offset:2048 sc1
  buffer_load_dwordx4 v[220:223], v2, s[8:11], s22 offen offset:3072 sc1
  s_add_u32 s22, s31, 77824
  buffer_load_dwordx4 v[224:227], v2, s[8:11], s22 offen offset:0 sc1
  buffer_load_dwordx4 v[228:231], v2, s[8:11], s22 offen offset:1024 sc1
  buffer_load_dwordx4 v[232:235], v2, s[8:11], s22 offen offset:2048 sc1
  buffer_load_dwordx4 v[236:239], v2, s[8:11], s22 offen offset:3072 sc1
  s_add_u32 s22, s31, 81920
  buffer_load_dwordx4 v[240:243], v2, s[8:11], s22 offen offset:0 sc1
  buffer_load_dwordx4 v[244:247], v2, s[8:11], s22 offen offset:1024 sc1
  buffer_load_dwordx4 v[248:251], v2, s[8:11], s22 offen offset:2048 sc1
  buffer_load_dwordx4 v[252:255], v2, s[8:11], s22 offen offset:3072 sc1
  s_mov_b32 m0, 16384
  s_add_u32 s22, s31, 86016
  buffer_load_dwordx4 v2, s[8:11], s22 offen offset:0 sc1 lds
  buffer_load_dwordx4 v2, s[8:11], s22 offen offset:1024 sc1 lds
  buffer_load_dwordx4 v2, s[8:11], s22 offen offset:2048 sc1 lds
  buffer_load_dwordx4 v2, s[8:11], s22 offen offset:3072 sc1 lds
  s_mov_b32 m0, 20480
  s_add_u32 s22, s31, 90112
  buffer_load_dwordx4 v2, s[8:11], s22 offen offset:0 sc1 lds
  buffer_load_dwordx4 v2, s[8:11], s22 offen offset:1024 sc1 lds
  buffer_load_dwordx4 v2, s[8:11], s22 offen offset:2048 sc1 lds
  buffer_load_dwordx4 v2, s[8:11], s22 offen offset:3072 sc1 lds
  s_mov_b32 m0, 24576
  s_add_u32 s22, s31, 94208
  buffer_load_dwordx4 v2, s[8:11], s22 offen offset:0 sc1 lds
  buffer_load_dwordx4 v2, s[8:11], s22 offen offset:1024 sc1 lds
  buffer_load_dwordx4 v2, s[8:11], s22 offen offset:2048 sc1 lds
  buffer_load_dwordx4 v2, s[8:11], s22 offen offset:3072 sc1 lds
  s_mov_b32 m0, 28672
  s_add_u32 s22, s31, 98304
  buffer_load_dwordx4 v2, s[8:11], s22 offen offset:0 sc1 lds
  buffer_load_dwordx4 v2, s[8:11], s22 offen offset:1024 sc1 lds
  s_mov_b32 s30, 0
ch_ws4:
  buffer_load_dword v9, off, s[12:15], 0 offset:132 sc1
  s_waitcnt vmcnt(0)
  v_cmp_ne_u32 vcc, 1, v9
  s_cbranch_vccz ch_ws4_ok
  s_sleep 8
  s_add_u32 s30, s30, 1
  s_cmp_lt_u32 s30, 400000
  s_cbranch_scc1 ch_ws4
  s_branch cA_abort
ch_ws4_ok:
  s_mul_i32 s33, s17, 532480
  s_add_u32 s33, s33, 78110720
  v_mov_b32 v12, -1
  v_mov_b32 v13, -1
  v_mov_b32 v14, -1
  v_mov_b32 v15, -1
  s_add_u32 s22, s33, 0
  buffer_store_dwordx4 v[12:15], v2, s[8:11], s22 offen sc1
  s_add_u32 s22, s33, 2048
  buffer_store_dwordx4 v[12:15], v2, s[8:11], s22 offen sc1
  s_add_u32 s22, s33, 4096
  buffer_store_dwordx4 v[12:15], v2, s[8:11], s22 offen sc1
  s_add_u32 s22, s33, 6144
  buffer_store_dwordx4 v[12:15], v2, s[8:11], s22 offen sc1
  s_add_u32 s22, s33, 8192
  buffer_store_dwordx4 v[12:15], v2, s[8:11], s22 offen sc1
  s_add_u32 s22, s33, 10240
  buffer_store_dwordx4 v[12:15], v2, s[8:11], s22 offen sc1
  s_add_u32 s22, s33, 12288
  buffer_store_dwordx4 v[12:15], v2, s[8:11], s22 offen sc1
  s_add_u32 s22, s33, 14336
  buffer_store_dwordx4 v[12:15], v2, s[8:11], s22 offen sc1
  v_mov_b32 v16, 1
  v_mov_b32 v17, 1
  s_lshl_b32 s22, s17, 10
  s_add_u32 s22, s22, 566240
  s_waitcnt vmcnt(0)
  s_mov_b64 exec, 3
  buffer_store_dwordx2 v[16:17], v2, s[8:11], s22 offen sc1
  s_mov_b64 exec, -1
  s_mov_b32 s28, s35
  s_waitcnt vmcnt(0) lgkmcnt(0)
  s_mov_b32 s31, 0
  s_cmp_lg_u32 s88, 0
  s_cbranch_scc1 cB_va0_loop
  s_branch cA_va0_loop
ch_init5:
  v_mov_b32 v72, v116
  v_mov_b32 v73, v117
  v_lshrrev_b32 v65, 1, v72
  v_and_b32 v66, 1, v72
  v_mov_b32 v36, 0
  v_mov_b32 v37, 0
  v_mov_b32 v38, 0
  v_mov_b32 v39, 0
  v_mov_b32 v40, 0
  v_mov_b32 v41, 0
  v_mov_b32 v42, 0
  v_mov_b32 v43, 0
  v_mov_b32 v44, 0
  v_mov_b32 v45, 0
  v_mov_b32 v46, 0
  v_mov_b32 v47, 0
  v_mov_b32 v48, 0
  v_mov_b32 v49, 0
  v_mov_b32 v50, 0
  v_mov_b32 v51, 0
  v_mov_b32 v52, 0
  v_mov_b32 v53, 0
  v_mov_b32 v54, 0
  v_mov_b32 v55, 0
  v_mov_b32 v56, 0
  v_mov_b32 v57, 0
  v_mov_b32 v58, 0
  v_mov_b32 v59, 0
  v_mov_b32 v60, 0
  v_mov_b32 v61, 0
  v_mov_b32 v62, 0
  v_mov_b32 v63, 0
  v_lshlrev_b32 v75, 2, v65
  v_lshl_add_u32 v75, v66, 3, v75
  v_add_u32 v67, 112, v73
  v_mul_u32_u24 v68, 2341, v67
  v_lshrrev_b32 v68, 16, v68
  v_mul_u32_u24 v69, 28, v68
  v_sub_u32 v69, v67, v69
  v_lshrrev_b32 v70, 4, v69
  v_and_b32 v69, 15, v69
  v_lshlrev_b32 v71, 12, v70
  v_lshl_add_u32 v71, v68, 8, v71
  v_lshl_add_u32 v71, v69, 4, v71
  v_add_u32 v152, v71, v75
  v_add_u32 v67, 128, v73
  v_mul_u32_u24 v68, 2341, v67
  v_lshrrev_b32 v68, 16, v68
  v_mul_u32_u24 v69, 28, v68
  v_sub_u32 v69, v67, v69
  v_lshrrev_b32 v70, 4, v69
  v_and_b32 v69, 15, v69
  v_lshlrev_b32 v71, 12, v70
  v_lshl_add_u32 v71, v68, 8, v71
  v_lshl_add_u32 v71, v69, 4, v71
  v_add_u32 v153, v71, v75
  v_add_u32 v67, 144, v73
  v_mul_u32_u24 v68, 2341, v67
  v_lshrrev_b32 v68, 16, v68
  v_mul_u32_u24 v69, 28, v68
  v_sub_u32 v69, v67, v69
  v_lshrrev_b32 v70, 4, v69
  v_and_b32 v69, 15, v69
  v_lshlrev_b32 v71, 12, v70
  v_lshl_add_u32 v71, v68, 8, v71
  v_lshl_add_u32 v71, v69, 4, v71
  v_add_u32 v154, v71, v75
  v_add_u32 v67, 160, v73
  v_mul_u32_u24 v68, 2341, v67
  v_lshrrev_b32 v68, 16, v68
  v_mul_u32_u24 v69, 28, v68
  v_sub_u32 v69, v67, v69
  v_lshrrev_b32 v70, 4, v69
  v_and_b32 v69, 15, v69
  v_lshlrev_b32 v71, 12, v70
  v_lshl_add_u32 v71, v68, 8, v71
  v_lshl_add_u32 v71, v69, 4, v71
  v_add_u32 v155, v71, v75
  v_add_u32 v67, 176, v73
  v_mul_u32_u24 v68, 2341, v67
  v_lshrrev_b32 v68, 16, v68
  v_mul_u32_u24 v69, 28, v68
  v_sub_u32 v69, v67, v69
  v_lshrrev_b32 v70, 4, v69
  v_and_b32 v69, 15, v69
  v_lshlrev_b32 v71, 12, v70
  v_lshl_add_u32 v71, v68, 8, v71
  v_lshl_add_u32 v71, v69, 4, v71
  v_add_u32 v156, v71, v75
  v_add_u32 v67, 192, v73
  v_mul_u32_u24 v68, 2341, v67
  v_lshrrev_b32 v68, 16, v68
  v_mul_u32_u24 v69, 28, v68
  v_sub_u32 v69, v67, v69
  v_lshrrev_b32 v70, 4, v69
  v_and_b32 v69, 15, v69
  v_lshlrev_b32 v71, 12, v70
  v_lshl_add_u32 v71, v68, 8, v71
  v_lshl_add_u32 v71, v69, 4, v71
  v_add_u32 v157, v71, v75
  v_add_u32 v67, 208, v73
  v_mul_u32_u24 v68, 2341, v67
  v_lshrrev_b32 v68, 16, v68
  v_mul_u32_u24 v69, 28, v68
  v_sub_u32 v69, v67, v69
  v_lshrrev_b32 v70, 4, v69
  v_and_b32 v69, 15, v69
  v_lshlrev_b32 v71, 12, v70
  v_lshl_add_u32 v71, v68, 8, v71
  v_lshl_add_u32 v71, v69, 4, v71
  v_add_u32 v158, v71, v75
  v_mov_b32 v74, 0x40000000
  v_mov_b32 v164, 0
  v_add_u32 v0, 30720, v2
  v_mov_b32 v76, 0
  v_mov_b32 v77, 0
  v_mov_b32 v78, 0
  v_mov_b32 v79, 0
  ds_write_b128 v2, v[76:79] offset:4096
  ds_write_b128 v2, v[76:79] offset:5120
  ds_write_b128 v2, v[76:79] offset:6144
  ds_write_b128 v2, v[76:79] offset:7168
  s_and_b32 s22, s17, 0
  s_lshl_b32 s22, s22, 7
  s_add_u32 s22, s22, 35328
  v_lshl_add_u32 v4, v73, 2, s22
  v_and_b32 v64, 1, v73
  v_mov_b32 v5, 0x05040100
  v_mov_b32 v65, 0x03020706
  v_cmp_eq_u32 vcc, 1, v64
  s_nop 1
  v_cndmask_b32 v5, v5, v65, vcc
  s_lshl_b32 s22, s17, 2
  s_add_u32 s22, s22, 39424
  v_lshl_add_u32 v7, v1, 7, s22
  v_cmp_gt_u32 vcc, 1, v1
  s_nop 1
  v_cndmask_b32 v7, v74, v7, vcc
  v_min_u32 v65, 11, v73
  v_mad_u32_u24 v65, v72, 12, v65
  v_lshlrev_b32 v6, 4, v65
  v_add_u32 v6, 1024, v6
  v_lshl_add_u32 v64, v66, 2, v64
  v_and_b32 v65, 2, v72
  v_add_u32 v64, v64, v65
  s_mul_i32 s22, s17, 12
  s_add_u32 s22, s22, 256
  v_add_u32 v75, s22, v73
  v_lshrrev_b32 v68, 4, v75
  v_lshlrev_b32 v68, 8, v68
  v_bfe_u32 v69, v75, 1, 1
  v_lshl_add_u32 v68, v69, 7, v68
  v_lshl_add_u32 v68, v64, 4, v68
  v_and_b32 v69, 12, v75
  v_add_u32 v1, v68, v69
  v_cmp_gt_u32 vcc, 12, v73
  s_nop 1
  v_cndmask_b32 v1, v74, v1, vcc
  s_mul_i32 s22, s17, 28672
  s_add_u32 s25, s22, 2490368
  s_and_b32 s27, s17, 0
  s_xor_b32 s22, s27, 0
  s_mul_i32 s80, s22, 7168
  s_lshl_b32 s22, s22, 11
  s_add_u32 s76, s22, 9216
  s_xor_b32 s22, s27, 1
  s_mul_i32 s81, s22, 7168
  s_lshl_b32 s22, s22, 11
  s_add_u32 s77, s22, 9216
  s_xor_b32 s22, s27, 2
  s_mul_i32 s82, s22, 7168
  s_lshl_b32 s22, s22, 11
  s_add_u32 s78, s22, 9216
  s_xor_b32 s22, s27, 3
  s_mul_i32 s83, s22, 7168
  s_lshl_b32 s22, s22, 11
  s_add_u32 s79, s22, 9216
  v_mov_b32 v162, -1
  s_mov_b32 s38, 0x40000000
  s_mul_i32 s31, s17, 401408
  s_add_u32 s31, s31, 40077312
  s_mov_b32 s30, 0
ch_wr5:
  buffer_load_dword v9, off, s[12:15], 0 offset:128 sc1
  s_waitcnt vmcnt(0)
  v_cmp_ne_u32 vcc, 1, v9
  s_cbranch_vccz ch_wr5_ok
  s_sleep 8
  s_add_u32 s30, s30, 1
  s_cmp_lt_u32 s30, 400000
  s_cbranch_scc1 ch_wr5
  s_branch cA_abort
ch_wr5_ok:
  s_lshr_b32 s22, s17, 2
  s_lshl_b32 s28, 0x81, s22
  s_mul_i32 s27, s17, 12
  s_add_u32 s22, s27, 256
  s_lshr_b32 s22, s22, 6
  s_lshl_b32 s22, 0x81, s22
  s_or_b32 s28, s28, s22
  s_add_u32 s22, s27, 267
  s_lshr_b32 s22, s22, 6
  s_lshl_b32 s22, 0x81, s22
  s_or_b32 s28, s28, s22
  v_lshrrev_b32 v12, 8, v2
  v_lshlrev_b32 v12, 7, v12
  s_mov_b32 s27, 582656
  s_mov_b32 s30, 0
ch_ww5:
  buffer_load_dword v9, v12, s[8:11], s27 offen sc1
  s_waitcnt vmcnt(0)
  v_and_b32 v10, s28, v9
  v_cmp_ne_u32 vcc, s28, v10
  s_cbranch_vccz ch_ww5_ok
  s_sleep 3
  s_add_u32 s30, s30, 1
  s_cmp_lt_u32 s30, 400000
  s_cbranch_scc1 ch_ww5
  s_branch cA_abort
ch_ww5_ok:
  s_add_u32 s22, s31, 0
  buffer_load_dwordx4 a[0:3], v2, s[8:11], s22 offen offset:0 sc1
  buffer_load_dwordx4 a[4:7], v2, s[8:11], s22 offen offset:1024 sc1
  buffer_load_dwordx4 a[8:11], v2, s[8:11], s22 offen offset:2048 sc1
  buffer_load_dwordx4 a[12:15], v2, s[8:11], s22 offen offset:3072 sc1
  s_add_u32 s22, s31, 4096
  buffer_load_dwordx4 a[16:19], v2, s[8:11], s22 offen offset:0 sc1
  buffer_load_dwordx4 a[20:23], v2, s[8:11], s22 offen offset:1024 sc1
  buffer_load_dwordx4 a[24:27], v2, s[8:11], s22 offen offset:2048 sc1
  buffer_load_dwordx4 a[28:31], v2, s[8:11], s22 offen offset:3072 sc1
  s_add_u32 s22, s31, 8192
  buffer_load_dwordx4 a[32:35], v2, s[8:11], s22 offen offset:0 sc1
  buffer_load_dwordx4 a[36:39], v2, s[8:11], s22 offen offset:1024 sc1
  buffer_load_dwordx4 a[40:43], v2, s[8:11], s22 offen offset:2048 sc1
  buffer_load_dwordx4 a[44:47], v2, s[8:11], s22 offen offset:3072 sc1
  s_add_u32 s22, s31, 12288
  buffer_load_dwordx4 a[48:51], v2, s[8:11], s22 offen offset:0 sc1
  buffer_load_dwordx4 a[52:55], v2, s[8:11], s22 offen offset:1024 sc1
  buffer_load_dwordx4 a[56:59], v2, s[8:11], s22 offen offset:2048 sc1
  buffer_load_dwordx4 a[60:63], v2, s[8:11], s22 offen offset:3072 sc1
  s_add_u32 s22, s31, 16384
  buffer_load_dwordx4 a[64:67], v2, s[8:11], s22 offen offset:0 sc1
  buffer_load_dwordx4 a[68:71], v2, s[8:11], s22 offen offset:1024 sc1
  buffer_load_dwordx4 a[72:75], v2, s[8:11], s22 offen offset:2048 sc1
  buffer_load_dwordx4 a[76:79], v2, s[8:11], s22 offen offset:3072 sc1
  s_add_u32 s22, s31, 20480
  buffer_load_dwordx4 a[80:83], v2, s[8:11], s22 offen offset:0 sc1
  buffer_load_dwordx4 a[84:87], v2, s[8:11], s22 offen offset:1024 sc1
  buffer_load_dwordx4 a[88:91], v2, s[8:11], s22 offen offset:2048 sc1
  buffer_load_dwordx4 a[92:95], v2, s[8:11], s22 offen offset:3072 sc1
  s_add_u32 s22, s31, 24576
  buffer_load_dwordx4 a[96:99], v2, s[8:11], s22 offen offset:0 sc1
  buffer_load_dwordx4 a[100:103], v2, s[8:11], s22 offen offset:1024 sc1
  buffer_load_dwordx4 a[104:107], v2, s[8:11], s22 offen offset:2048 sc1
  buffer_load_dwordx4 a[108:111], v2, s[8:11], s22 offen offset:3072 sc1
  s_add_u32 s22, s31, 28672
  buffer_load_dwordx4 a[112:115], v2, s[8:11], s22 offen offset:0 sc1
  buffer_load_dwordx4 a[116:119], v2, s[8:11], s22 offen offset:1024 sc1
  buffer_load_dwordx4 a[120:123], v2, s[8:11], s22 offen offset:2048 sc1
  buffer_load_dwordx4 a[124:127], v2, s[8:11], s22 offen offset:3072 sc1
  s_waitcnt vmcnt(24)
  s_add_u32 s22, s31, 32768
  buffer_load_dwordx4 a[128:131], v2, s[8:11], s22 offen offset:0 sc1
  buffer_load_dwordx4 a[132:135], v2, s[8:11], s22 offen offset:1024 sc1
  buffer_load_dwordx4 a[136:139], v2, s[8:11], s22 offen offset:2048 sc1
  buffer_load_dwordx4 a[140:143], v2, s[8:11], s22 offen offset:3072 sc1
  s_add_u32 s22, s31, 36864
  buffer_load_dwordx4 a[144:147], v2, s[8:11], s22 offen offset:0 sc1
  buffer_load_dwordx4 a[148:151], v2, s[8:11], s22 offen offset:1024 sc1
  buffer_load_dwordx4 a[152:155], v2, s[8:11], s22 offen offset:2048 sc1
  buffer_load_dwordx4 a[156:159], v2, s[8:11], s22 offen offset:3072 sc1
  s_add_u32 s22, s31, 40960
  buffer_load_dwordx4 a[160:163], v2, s[8:11], s22 offen offset:0 sc1
  buffer_load_dwordx4 a[164:167], v2, s[8:11], s22 offen offset:1024 sc1
  buffer_load_dwordx4 a[168:171], v2, s[8:11], s22 offen offset:2048 sc1
  buffer_load_dwordx4 a[172:175], v2, s[8:11], s22 offen offset:3072 sc1
  s_add_u32 s22, s31, 45056
  buffer_load_dwordx4 a[176:179], v2, s[8:11], s22 offen offset:0 sc1
  buffer_load_dwordx4 a[180:183], v2, s[8:11], s22 offen offset:1024 sc1
  buffer_load_dwordx4 a[184:187], v2, s[8:11], s22 offen offset:2048 sc1
  buffer_load_dwordx4 a[188:191], v2, s[8:11], s22 offen offset:3072 sc1
  s_add_u32 s22, s31, 49152
  buffer_load_dwordx4 a[192:195], v2, s[8:11], s22 offen offset:0 sc1
  buffer_load_dwordx4 a[196:199], v2, s[8:11], s22 offen offset:1024 sc1
  buffer_load_dwordx4 a[200:203], v2, s[8:11], s22 offen offset:2048 sc1
  buffer_load_dwordx4 a[204:207], v2, s[8:11], s22 offen offset:3072 sc1
  s_add_u32 s22, s31, 53248
  buffer_load_dwordx4 a[208:211], v2, s[8:11], s22 offen offset:0 sc1
  buffer_load_dwordx4 a[212:215], v2, s[8:11], s22 offen offset:1024 sc1
  buffer_load_dwordx4 a[216:219], v2, s[8:11], s22 offen offset:2048 sc1
  buffer_load_dwordx4 a[220:223], v2, s[8:11], s22 offen offset:3072 sc1
  s_add_u32 s22, s31, 57344
  buffer_load_dwordx4 a[224:227], v2, s[8:11], s22 offen offset:0 sc1
  buffer_load_dwordx4 a[228:231], v2, s[8:11], s22 offen offset:1024 sc1
  buffer_load_dwordx4 a[232:235], v2, s[8:11], s22 offen offset:2048 sc1
  buffer_load_dwordx4 a[236:239], v2, s[8:11], s22 offen offset:3072 sc1
  s_add_u32 s22, s31, 61440
  buffer_load_dwordx4 a[240:243], v2, s[8:11], s22 offen offset:0 sc1
  buffer_load_dwordx4 a[244:247], v2, s[8:11], s22 offen offset:1024 sc1
  buffer_load_dwordx4 a[248:251], v2, s[8:11], s22 offen offset:2048 sc1
  buffer_load_dwordx4 a[252:255], v2, s[8:11], s22 offen offset:3072 sc1
  s_waitcnt vmcnt(24)
  s_add_u32 s22, s31, 65536
  buffer_load_dwordx4 v[176:179], v2, s[8:11], s22 offen offset:0 sc1
  buffer_load_dwordx4 v[180:183], v2, s[8:11], s22 offen offset:1024 sc1
  buffer_load_dwordx4 v[184:187], v2, s[8:11], s22 offen offset:2048 sc1
  buffer_load_dwordx4 v[188:191], v2, s[8:11], s22 offen offset:3072 sc1
  s_add_u32 s22, s31, 69632
  buffer_load_dwordx4 v[192:195], v2, s[8:11], s22 offen offset:0 sc1
  buffer_load_dwordx4 v[196:199], v2, s[8:11], s22 offen offset:1024 sc1
  buffer_load_dwordx4 v[200:203], v2, s[8:11], s22 offen offset:2048 sc1
  buffer_load_dwordx4 v[204:207], v2, s[8:11], s22 offen offset:3072 sc1
  s_add_u32 s22, s31, 73728
  buffer_load_dwordx4 v[208:211], v2, s[8:11], s22 offen offset:0 sc1
  buffer_load_dwordx4 v[212:215], v2, s[8:11], s22 offen offset:1024 sc1
  buffer_load_dwordx4 v[216:219], v2, s[8:11], s22 offen offset:2048 sc1
  buffer_load_dwordx4 v[220:223], v2, s[8:11], s22 offen offset:3072 sc1
  s_add_u32 s22, s31, 77824
  buffer_load_dwordx4 v[224:227], v2, s[8:11], s22 offen offset:0 sc1
  buffer_load_dwordx4 v[228:231], v2, s[8:11], s22 offen offset:1024 sc1
  buffer_load_dwordx4 v[232:235], v2, s[8:11], s22 offen offset:2048 sc1
  buffer_load_dwordx4 v[236:239], v2, s[8:11], s22 offen offset:3072 sc1
  s_add_u32 s22, s31, 81920
  buffer_load_dwordx4 v[240:243], v2, s[8:11], s22 offen offset:0 sc1
  buffer_load_dwordx4 v[244:247], v2, s[8:11], s22 offen offset:1024 sc1
  buffer_load_dwordx4 v[248:251], v2, s[8:11], s22 offen offset:2048 sc1
  buffer_load_dwordx4 v[252:255], v2, s[8:11], s22 offen offset:3072 sc1
  s_mov_b32 m0, 30720
  s_add_u32 s22, s31, 86016
  buffer_load_dwordx4 v2, s[8:11], s22 offen offset:0 sc1 lds
  buffer_load_dwordx4 v2, s[8:11], s22 offen offset:1024 sc1 lds
  buffer_load_dwordx4 v2, s[8:11], s22 offen offset:2048 sc1 lds
  buffer_load_dwordx4 v2, s[8:11], s22 offen offset:3072 sc1 lds
  s_mov_b32 m0, 34816
  s_add_u32 s22, s31, 90112
  buffer_load_dwordx4 v2, s[8:11], s22 offen offset:0 sc1 lds
  buffer_load_dwordx4 v2, s[8:11], s22 offen offset:1024 sc1 lds
  buffer_load_dwordx4 v2, s[8:11], s22 offen offset:2048 sc1 lds
  buffer_load_dwordx4 v2, s[8:11], s22 offen offset:3072 sc1 lds
  s_mov_b32 m0, 38912
  s_add_u32 s22, s31, 94208
  buffer_load_dwordx4 v2, s[8:11], s22 offen offset:0 sc1 lds
  buffer_load_dwordx4 v2, s[8:11], s22 offen offset:1024 sc1 lds
  buffer_load_dwordx4 v2, s[8:11], s22 offen offset:2048 sc1 lds
  buffer_load_dwordx4 v2, s[8:11], s22 offen offset:3072 sc1 lds
  s_mov_b32 m0, 43008
  s_add_u32 s22, s31, 98304
  buffer_load_dwordx4 v2, s[8:11], s22 offen offset:0 sc1 lds
  buffer_load_dwordx4 v2, s[8:11], s22 offen offset:1024 sc1 lds
  s_mov_b32 s30, 0
ch_ws5:
  buffer_load_dword v9, off, s[12:15], 0 offset:132 sc1
  s_waitcnt vmcnt(0)
  v_cmp_ne_u32 vcc, 1, v9
  s_cbranch_vccz ch_ws5_ok
  s_sleep 8
  s_add_u32 s30, s30, 1
  s_cmp_lt_u32 s30, 400000
  s_cbranch_scc1 ch_ws5
  s_branch cA_abort
ch_ws5_ok:
  s_mul_i32 s33, s17, 532480
  s_add_u32 s33, s33, 78111744
  v_mov_b32 v12, -1
  v_mov_b32 v13, -1
  v_mov_b32 v14, -1
  v_mov_b32 v15, -1
  s_add_u32 s22, s33, 0
  buffer_store_dwordx4 v[12:15], v2, s[8:11], s22 offen sc1
  s_add_u32 s22, s33, 2048
  buffer_store_dwordx4 v[12:15], v2, s[8:11], s22 offen sc1
  s_add_u32 s22, s33, 4096
  buffer_store_dwordx4 v[12:15], v2, s[8:11], s22 offen sc1
  s_add_u32 s22, s33, 6144
  buffer_store_dwordx4 v[12:15], v2, s[8:11], s22 offen sc1
  s_add_u32 s22, s33, 8192
  buffer_store_dwordx4 v[12:15], v2, s[8:11], s22 offen sc1
  s_add_u32 s22, s33, 10240
  buffer_store_dwordx4 v[12:15], v2, s[8:11], s22 offen sc1
  s_add_u32 s22, s33, 12288
  buffer_store_dwordx4 v[12:15], v2, s[8:11], s22 offen sc1
  s_add_u32 s22, s33, 14336
  buffer_store_dwordx4 v[12:15], v2, s[8:11], s22 offen sc1
  v_mov_b32 v16, 1
  v_mov_b32 v17, 1
  s_lshl_b32 s22, s17, 10
  s_add_u32 s22, s22, 566248
  s_waitcnt vmcnt(0)
  s_mov_b64 exec, 3
  buffer_store_dwordx2 v[16:17], v2, s[8:11], s22 offen sc1
  s_mov_b64 exec, -1
  s_mov_b32 s28, s35
  s_waitcnt vmcnt(0) lgkmcnt(0)
  s_mov_b32 s31, 0
  s_cmp_lg_u32 s88, 0
  s_cbranch_scc1 cB_va1_loop
  s_branch cA_va1_loop
ch_init6:
  v_mov_b32 v72, v116
  v_mov_b32 v73, v117
  v_lshrrev_b32 v65, 1, v72
  v_and_b32 v66, 1, v72
  v_mov_b32 v36, 0
  v_mov_b32 v37, 0
  v_mov_b32 v38, 0
  v_mov_b32 v39, 0
  v_mov_b32 v40, 0
  v_mov_b32 v41, 0
  v_mov_b32 v42, 0
  v_mov_b32 v43, 0
  v_mov_b32 v44, 0
  v_mov_b32 v45, 0
  v_mov_b32 v46, 0
  v_mov_b32 v47, 0
  v_mov_b32 v48, 0
  v_mov_b32 v49, 0
  v_mov_b32 v50, 0
  v_mov_b32 v51, 0
  v_mov_b32 v52, 0
  v_mov_b32 v53, 0
  v_mov_b32 v54, 0
  v_mov_b32 v55, 0
  v_mov_b32 v56, 0
  v_mov_b32 v57, 0
  v_mov_b32 v58, 0
  v_mov_b32 v59, 0
  v_mov_b32 v60, 0
  v_mov_b32 v61, 0
  v_mov_b32 v62, 0
  v_mov_b32 v63, 0
  v_lshlrev_b32 v75, 2, v65
  v_lshl_add_u32 v75, v66, 3, v75
  v_add_u32 v67, 224, v73
  v_mul_u32_u24 v68, 2341, v67
  v_lshrrev_b32 v68, 16, v68
  v_mul_u32_u24 v69, 28, v68
  v_sub_u32 v69, v67, v69
  v_lshrrev_b32 v70, 4, v69
  v_and_b32 v69, 15, v69
  v_lshlrev_b32 v71, 12, v70
  v_lshl_add_u32 v71, v68, 8, v71
  v_lshl_add_u32 v71, v69, 4, v71
  v_add_u32 v104, v71, v75
  v_add_u32 v67, 240, v73
  v_mul_u32_u24 v68, 2341, v67
  v_lshrrev_b32 v68, 16, v68
  v_mul_u32_u24 v69, 28, v68
  v_sub_u32 v69, v67, v69
  v_lshrrev_b32 v70, 4, v69
  v_and_b32 v69, 15, v69
  v_lshlrev_b32 v71, 12, v70
  v_lshl_add_u32 v71, v68, 8, v71
  v_lshl_add_u32 v71, v69, 4, v71
  v_add_u32 v105, v71, v75
  v_add_u32 v67, 256, v73
  v_mul_u32_u24 v68, 2341, v67
  v_lshrrev_b32 v68, 16, v68
  v_mul_u32_u24 v69, 28, v68
  v_sub_u32 v69, v67, v69
  v_lshrrev_b32 v70, 4, v69
  v_and_b32 v69, 15, v69
  v_lshlrev_b32 v71, 12, v70
  v_lshl_add_u32 v71, v68, 8, v71
  v_lshl_add_u32 v71, v69, 4, v71
  v_add_u32 v106, v71, v75
  v_add_u32 v67, 272, v73
  v_mul_u32_u24 v68, 2341, v67
  v_lshrrev_b32 v68, 16, v68
  v_mul_u32_u24 v69, 28, v68
  v_sub_u32 v69, v67, v69
  v_lshrrev_b32 v70, 4, v69
  v_and_b32 v69, 15, v69
  v_lshlrev_b32 v71, 12, v70
  v_lshl_add_u32 v71, v68, 8, v71
  v_lshl_add_u32 v71, v69, 4, v71
  v_add_u32 v107, v71, v75
  v_add_u32 v67, 288, v73
  v_mul_u32_u24 v68, 2341, v67
  v_lshrrev_b32 v68, 16, v68
  v_mul_u32_u24 v69, 28, v68
  v_sub_u32 v69, v67, v69
  v_lshrrev_b32 v70, 4, v69
  v_and_b32 v69, 15, v69
  v_lshlrev_b32 v71, 12, v70
  v_lshl_add_u32 v71, v68, 8, v71
  v_lshl_add_u32 v71, v69, 4, v71
  v_add_u32 v108, v71, v75
  v_add_u32 v67, 304, v73
  v_mul_u32_u24 v68, 2341, v67
  v_lshrrev_b32 v68, 16, v68
  v_mul_u32_u24 v69, 28, v68
  v_sub_u32 v69, v67, v69
  v_lshrrev_b32 v70, 4, v69
  v_and_b32 v69, 15, v69
  v_lshlrev_b32 v71, 12, v70
  v_lshl_add_u32 v71, v68, 8, v71
  v_lshl_add_u32 v71, v69, 4, v71
  v_add_u32 v109, v71, v75
  v_add_u32 v67, 320, v73
  v_mul_u32_u24 v68, 2341, v67
  v_lshrrev_b32 v68, 16, v68
  v_mul_u32_u24 v69, 28, v68
  v_sub_u32 v69, v67, v69
  v_lshrrev_b32 v70, 4, v69
  v_and_b32 v69, 15, v69
  v_lshlrev_b32 v71, 12, v70
  v_lshl_add_u32 v71, v68, 8, v71
  v_lshl_add_u32 v71, v69, 4, v71
  v_add_u32 v110, v71, v75
  v_add_u32 v67, 96, v73
  v_mul_u32_u24 v68, 2341, v67
  v_lshrrev_b32 v68, 16, v68
  v_mul_u32_u24 v69, 28, v68
  v_sub_u32 v69, v67, v69
  v_lshrrev_b32 v70, 4, v69
  v_and_b32 v69, 15, v69
  v_lshlrev_b32 v71, 12, v70
  v_lshl_add_u32 v71, v68, 8, v71
  v_lshl_add_u32 v71, v69, 4, v71
  v_add_u32 v111, v71, v75
  v_mov_b32 v74, 0x40000000
  v_mov_b32 v96, 0
  v_add_u32 v0, 16384, v2
  v_and_b32 v119, 15, v1
  s_and_b32 s22, s17, 0
  s_lshl_b32 s22, s22, 7
  s_add_u32 s22, s22, 39424
  v_lshl_add_u32 v119, v119, 2, s22
  s_lshl_b32 s22, s17, 2
  s_add_u32 s22, s22, 37376
  v_lshl_add_u32 v118, v1, 7, s22
  v_cmp_gt_u32 vcc, 1, v1
  s_nop 1
  v_cndmask_b32 v118, v74, v118, vcc
  s_lshl_b32 s35, s17, 7
  s_add_u32 s35, s35, 524288
  v_mov_b32 v64, 0
  v_mov_b32 v65, 0
  v_mov_b32 v66, 0
  v_mov_b32 v67, 0
  v_min_u32 v116, 13, v1
  s_mul_i32 s22, s17, 14
  v_add_u32 v116, s22, v116
  v_lshlrev_b32 v116, 7, v116
  s_mul_i32 s31, s17, 401408
  s_add_u32 s31, s31, 40177664
  s_mov_b32 s30, 0
ch_wr6:
  buffer_load_dword v9, off, s[12:15], 0 offset:128 sc1
  s_waitcnt vmcnt(0)
  v_cmp_ne_u32 vcc, 1, v9
  s_cbranch_vccz ch_wr6_ok
  s_sleep 8
  s_add_u32 s30, s30, 1
  s_cmp_lt_u32 s30, 400000
  s_cbranch_scc1 ch_wr6
  s_branch cA_abort
ch_wr6_ok:
  s_lshr_b32 s22, s17, 2
  s_lshl_b32 s28, 0x81, s22
  s_mul_i32 s27, s17, 12
  s_add_u32 s22, s27, 256
  s_lshr_b32 s22, s22, 6
  s_lshl_b32 s22, 0x81, s22
  s_or_b32 s28, s28, s22
  s_add_u32 s22, s27, 267
  s_lshr_b32 s22, s22, 6
  s_lshl_b32 s22, 0x81, s22
  s_or_b32 s28, s28, s22
  v_lshrrev_b32 v12, 8, v2
  v_lshlrev_b32 v12, 7, v12
  s_mov_b32 s27, 583168
  s_mov_b32 s30, 0
ch_ww6:
  buffer_load_dword v9, v12, s[8:11], s27 offen sc1
  s_waitcnt vmcnt(0)
  v_and_b32 v10, s28, v9
  v_cmp_ne_u32 vcc, s28, v10
  s_cbranch_vccz ch_ww6_ok
  s_sleep 3
  s_add_u32 s30, s30, 1
  s_cmp_lt_u32 s30, 400000
  s_cbranch_scc1 ch_ww6
  s_branch cA_abort
ch_ww6_ok:
  s_add_u32 s22, s31, 0
  buffer_load_dwordx4 a[0:3], v2, s[8:11], s22 offen offset:0 sc1
  buffer_load_dwordx4 a[4:7], v2, s[8:11], s22 offen offset:1024 sc1
  buffer_load_dwordx4 a[8:11], v2, s[8:11], s22 offen offset:2048 sc1
  buffer_load_dwordx4 a[12:15], v2, s[8:11], s22 offen offset:3072 sc1
  s_add_u32 s22, s31, 4096
  buffer_load_dwordx4 a[16:19], v2, s[8:11], s22 offen offset:0 sc1
  buffer_load_dwordx4 a[20:23], v2, s[8:11], s22 offen offset:1024 sc1
  buffer_load_dwordx4 a[24:27], v2, s[8:11], s22 offen offset:2048 sc1
  buffer_load_dwordx4 a[28:31], v2, s[8:11], s22 offen offset:3072 sc1
  s_add_u32 s22, s31, 8192
  buffer_load_dwordx4 a[32:35], v2, s[8:11], s22 offen offset:0 sc1
  buffer_load_dwordx4 a[36:39], v2, s[8:11], s22 offen offset:1024 sc1
  buffer_load_dwordx4 a[40:43], v2, s[8:11], s22 offen offset:2048 sc1
  buffer_load_dwordx4 a[44:47], v2, s[8:11], s22 offen offset:3072 sc1
  s_add_u32 s22, s31, 12288
  buffer_load_dwordx4 a[48:51], v2, s[8:11], s22 offen offset:0 sc1
  buffer_load_dwordx4 a[52:55], v2, s[8:11], s22 offen offset:1024 sc1
  buffer_load_dwordx4 a[56:59], v2, s[8:11], s22 offen offset:2048 sc1
  buffer_load_dwordx4 a[60:63], v2, s[8:11], s22 offen offset:3072 sc1
  s_add_u32 s22, s31, 16384
  buffer_load_dwordx4 a[64:67], v2, s[8:11], s22 offen offset:0 sc1
  buffer_load_dwordx4 a[68:71], v2, s[8:11], s22 offen offset:1024 sc1
  buffer_load_dwordx4 a[72:75], v2, s[8:11], s22 offen offset:2048 sc1
  buffer_load_dwordx4 a[76:79], v2, s[8:11], s22 offen offset:3072 sc1
  s_add_u32 s22, s31, 20480
  buffer_load_dwordx4 a[80:83], v2, s[8:11], s22 offen offset:0 sc1
  buffer_load_dwordx4 a[84:87], v2, s[8:11], s22 offen offset:1024 sc1
  buffer_load_dwordx4 a[88:91], v2, s[8:11], s22 offen offset:2048 sc1
  buffer_load_dwordx4 a[92:95], v2, s[8:11], s22 offen offset:3072 sc1
  s_add_u32 s22, s31, 24576
  buffer_load_dwordx4 a[96:99], v2, s[8:11], s22 offen offset:0 sc1
  buffer_load_dwordx4 a[100:103], v2, s[8:11], s22 offen offset:1024 sc1
  buffer_load_dwordx4 a[104:107], v2, s[8:11], s22 offen offset:2048 sc1
  buffer_load_dwordx4 a[108:111], v2, s[8:11], s22 offen offset:3072 sc1
  s_add_u32 s22, s31, 28672
  buffer_load_dwordx4 a[112:115], v2, s[8:11], s22 offen offset:0 sc1
  buffer_load_dwordx4 a[116:119], v2, s[8:11], s22 offen offset:1024 sc1
  buffer_load_dwordx4 a[120:123], v2, s[8:11], s22 offen offset:2048 sc1
  buffer_load_dwordx4 a[124:127], v2, s[8:11], s22 offen offset:3072 sc1
  s_waitcnt vmcnt(24)
  s_add_u32 s22, s31, 32768
  buffer_load_dwordx4 a[128:131], v2, s[8:11], s22 offen offset:0 sc1
  buffer_load_dwordx4 a[132:135], v2, s[8:11], s22 offen offset:1024 sc1
  buffer_load_dwordx4 a[136:139], v2, s[8:11], s22 offen offset:2048 sc1
  buffer_load_dwordx4 a[140:143], v2, s[8:11], s22 offen offset:3072 sc1
  s_add_u32 s22, s31, 36864
  buffer_load_dwordx4 a[144:147], v2, s[8:11], s22 offen offset:0 sc1
  buffer_load_dwordx4 a[148:151], v2, s[8:11], s22 offen offset:1024 sc1
  buffer_load_dwordx4 a[152:155], v2, s[8:11], s22 offen offset:2048 sc1
  buffer_load_dwordx4 a[156:159], v2, s[8:11], s22 offen offset:3072 sc1
  s_add_u32 s22, s31, 40960
  buffer_load_dwordx4 a[160:163], v2, s[8:11], s22 offen offset:0 sc1
  buffer_load_dwordx4 a[164:167], v2, s[8:11], s22 offen offset:1024 sc1
  buffer_load_dwordx4 a[168:171], v2, s[8:11], s22 offen offset:2048 sc1
  buffer_load_dwordx4 a[172:175], v2, s[8:11], s22 offen offset:3072 sc1
  s_add_u32 s22, s31, 45056
  buffer_load_dwordx4 a[176:179], v2, s[8:11], s22 offen offset:0 sc1
  buffer_load_dwordx4 a[180:183], v2, s[8:11], s22 offen offset:1024 sc1
  buffer_load_dwordx4 a[184:187], v2, s[8:11], s22 offen offset:2048 sc1
  buffer_load_dwordx4 a[188:191], v2, s[8:11], s22 offen offset:3072 sc1
  s_add_u32 s22, s31, 49152
  buffer_load_dwordx4 a[192:195], v2, s[8:11], s22 offen offset:0 sc1
  buffer_load_dwordx4 a[196:199], v2, s[8:11], s22 offen offset:1024 sc1
  buffer_load_dwordx4 a[200:203], v2, s[8:11], s22 offen offset:2048 sc1
  buffer_load_dwordx4 a[204:207], v2, s[8:11], s22 offen offset:3072 sc1
  s_add_u32 s22, s31, 53248
  buffer_load_dwordx4 a[208:211], v2, s[8:11], s22 offen offset:0 sc1
  buffer_load_dwordx4 a[212:215], v2, s[8:11], s22 offen offset:1024 sc1
  buffer_load_dwordx4 a[216:219], v2, s[8:11], s22 offen offset:2048 sc1
  buffer_load_dwordx4 a[220:223], v2, s[8:11], s22 offen offset:3072 sc1
  s_add_u32 s22, s31, 57344
  buffer_load_dwordx4 a[224:227], v2, s[8:11], s22 offen offset:0 sc1
  buffer_load_dwordx4 a[228:231], v2, s[8:11], s22 offen offset:1024 sc1
  buffer_load_dwordx4 a[232:235], v2, s[8:11], s22 offen offset:2048 sc1
  buffer_load_dwordx4 a[236:239], v2, s[8:11], s22 offen offset:3072 sc1
  s_add_u32 s22, s31, 61440
  buffer_load_dwordx4 a[240:243], v2, s[8:11], s22 offen offset:0 sc1
  buffer_load_dwordx4 a[244:247], v2, s[8:11], s22 offen offset:1024 sc1
  buffer_load_dwordx4 a[248:251], v2, s[8:11], s22 offen offset:2048 sc1
  buffer_load_dwordx4 a[252:255], v2, s[8:11], s22 offen offset:3072 sc1
  s_waitcnt vmcnt(24)
  s_add_u32 s22, s31, 65536
  buffer_load_dwordx4 v[120:123], v2, s[8:11], s22 offen offset:0 sc1
  buffer_load_dwordx4 v[124:127], v2, s[8:11], s22 offen offset:1024 sc1
  buffer_load_dwordx4 v[128:131], v2, s[8:11], s22 offen offset:2048 sc1
  buffer_load_dwordx4 v[132:135], v2, s[8:11], s22 offen offset:3072 sc1
  s_add_u32 s22, s31, 69632
  buffer_load_dwordx4 v[136:139], v2, s[8:11], s22 offen offset:0 sc1
  buffer_load_dwordx4 v[140:143], v2, s[8:11], s22 offen offset:1024 sc1
  buffer_load_dwordx4 v[144:147], v2, s[8:11], s22 offen offset:2048 sc1
  buffer_load_dwordx4 v[148:151], v2, s[8:11], s22 offen offset:3072 sc1
  s_add_u32 s22, s31, 73728
  buffer_load_dwordx4 v[152:155], v2, s[8:11], s22 offen offset:0 sc1
  buffer_load_dwordx4 v[156:159], v2, s[8:11], s22 offen offset:1024 sc1
  buffer_load_dwordx4 v[160:163], v2, s[8:11], s22 offen offset:2048 sc1
  buffer_load_dwordx4 v[164:167], v2, s[8:11], s22 offen offset:3072 sc1
  s_add_u32 s22, s31, 77824
  buffer_load_dwordx4 v[168:171], v2, s[8:11], s22 offen offset:0 sc1
  buffer_load_dwordx4 v[172:175], v2, s[8:11], s22 offen offset:1024 sc1
  buffer_load_dwordx4 v[176:179], v2, s[8:11], s22 offen offset:2048 sc1
  buffer_load_dwordx4 v[180:183], v2, s[8:11], s22 offen offset:3072 sc1
  s_add_u32 s22, s31, 81920
  buffer_load_dwordx4 v[184:187], v2, s[8:11], s22 offen offset:0 sc1
  buffer_load_dwordx4 v[188:191], v2, s[8:11], s22 offen offset:1024 sc1
  buffer_load_dwordx4 v[192:195], v2, s[8:11], s22 offen offset:2048 sc1
  buffer_load_dwordx4 v[196:199], v2, s[8:11], s22 offen offset:3072 sc1
  s_add_u32 s22, s31, 86016
  buffer_load_dwordx4 v[200:203], v2, s[8:11], s22 offen offset:0 sc1
  buffer_load_dwordx4 v[204:207], v2, s[8:11], s22 offen offset:1024 sc1
  buffer_load_dwordx4 v[208:211], v2, s[8:11], s22 offen offset:2048 sc1
  buffer_load_dwordx4 v[212:215], v2, s[8:11], s22 offen offset:3072 sc1
  s_add_u32 s22, s31, 90112
  buffer_load_dwordx4 v[216:219], v2, s[8:11], s22 offen offset:0 sc1
  buffer_load_dwordx4 v[220:223], v2, s[8:11], s22 offen offset:1024 sc1
  buffer_load_dwordx4 v[224:227], v2, s[8:11], s22 offen offset:2048 sc1
  buffer_load_dwordx4 v[228:231], v2, s[8:11], s22 offen offset:3072 sc1
  s_add_u32 s22, s31, 94208
  buffer_load_dwordx4 v[232:235], v2, s[8:11], s22 offen offset:0 sc1
  buffer_load_dwordx4 v[236:239], v2, s[8:11], s22 offen offset:1024 sc1
  buffer_load_dwordx4 v[240:243], v2, s[8:11], s22 offen offset:2048 sc1
  buffer_load_dwordx4 v[244:247], v2, s[8:11], s22 offen offset:3072 sc1
  s_waitcnt vmcnt(24)
  s_add_u32 s22, s31, 98304
  buffer_load_dwordx4 v[248:251], v2, s[8:11], s22 offen offset:0 sc1
  buffer_load_dwordx4 v[252:255], v2, s[8:11], s22 offen offset:1024 sc1
  s_mov_b32 s30, 0
ch_ws6:
  buffer_load_dword v9, off, s[12:15], 0 offset:132 sc1
  s_waitcnt vmcnt(0)
  v_cmp_ne_u32 vcc, 1, v9
  s_cbranch_vccz ch_ws6_ok
  s_sleep 8
  s_add_u32 s30, s30, 1
  s_cmp_lt_u32 s30, 400000
  s_cbranch_scc1 ch_ws6
  s_branch cA_abort
ch_ws6_ok:
  s_lshl_b32 s27, s17, 7
  s_add_u32 s27, s27, 524288
  s_mov_b32 s30, 0
ch_vw2:
  buffer_load_dword v9, off, s[8:11], s27 sc1
  s_waitcnt vmcnt(0)
  v_cmp_ne_u32 vcc, 56, v9
  s_cbranch_vccz ch_vw2_d
  s_sleep 2
  s_add_u32 s30, s30, 1
  s_cmp_lt_u32 s30, 400000
  s_cbranch_scc1 ch_vw2
  s_branch cA_abort
ch_vw2_d:
  s_mov_b32 s28, s35
  s_waitcnt vmcnt(0) lgkmcnt(0)
  s_mov_b32 s31, 0
  s_cmp_lg_u32 s88, 0
  s_cbranch_scc1 cB_va2_loop
  s_branch cA_va2_loop
ch_init7:
  v_mov_b32 v72, v116
  v_mov_b32 v73, v117
  v_lshrrev_b32 v65, 1, v72
  v_and_b32 v66, 1, v72
  v_mov_b32 v36, 0
  v_mov_b32 v37, 0
  v_mov_b32 v38, 0
  v_mov_b32 v39, 0
  v_mov_b32 v40, 0
  v_mov_b32 v41, 0
  v_mov_b32 v42, 0
  v_mov_b32 v43, 0
  v_mov_b32 v44, 0
  v_mov_b32 v45, 0
  v_mov_b32 v46, 0
  v_mov_b32 v47, 0
  v_mov_b32 v48, 0
  v_mov_b32 v49, 0
  v_mov_b32 v50, 0
  v_mov_b32 v51, 0
  v_mov_b32 v52, 0
  v_mov_b32 v53, 0
  v_mov_b32 v54, 0
  v_mov_b32 v55, 0
  v_mov_b32 v56, 0
  v_mov_b32 v57, 0
  v_mov_b32 v58, 0
  v_mov_b32 v59, 0
  v_mov_b32 v60, 0
  v_mov_b32 v61, 0
  v_mov_b32 v62, 0
  v_mov_b32 v63, 0
  v_lshlrev_b32 v75, 2, v65
  v_lshl_add_u32 v75, v66, 3, v75
  v_add_u32 v67, 336, v73
  v_mul_u32_u24 v68, 2341, v67
  v_lshrrev_b32 v68, 16, v68
  v_mul_u32_u24 v69, 28, v68
  v_sub_u32 v69, v67, v69
  v_lshrrev_b32 v70, 4, v69
  v_and_b32 v69, 15, v69
  v_lshlrev_b32 v71, 12, v70
  v_lshl_add_u32 v71, v68, 8, v71
  v_lshl_add_u32 v71, v69, 4, v71
  v_add_u32 v104, v71, v75
  v_add_u32 v67, 352, v73
  v_mul_u32_u24 v68, 2341, v67
  v_lshrrev_b32 v68, 16, v68
  v_mul_u32_u24 v69, 28, v68
  v_sub_u32 v69, v67, v69
  v_lshrrev_b32 v70, 4, v69
  v_and_b32 v69, 15, v69
  v_lshlrev_b32 v71, 12, v70
  v_lshl_add_u32 v71, v68, 8, v71
  v_lshl_add_u32 v71, v69, 4, v71
  v_add_u32 v105, v71, v75
  v_add_u32 v67, 368, v73
  v_mul_u32_u24 v68, 2341, v67
  v_lshrrev_b32 v68, 16, v68
  v_mul_u32_u24 v69, 28, v68
  v_sub_u32 v69, v67, v69
  v_lshrrev_b32 v70, 4, v69
  v_and_b32 v69, 15, v69
  v_lshlrev_b32 v71, 12, v70
  v_lshl_add_u32 v71, v68, 8, v71
  v_lshl_add_u32 v71, v69, 4, v71
  v_add_u32 v106, v71, v75
  v_add_u32 v67, 384, v73
  v_mul_u32_u24 v68, 2341, v67
  v_lshrrev_b32 v68, 16, v68
  v_mul_u32_u24 v69, 28, v68
  v_sub_u32 v69, v67, v69
  v_lshrrev_b32 v70, 4, v69
  v_and_b32 v69, 15, v69
  v_lshlrev_b32 v71, 12, v70
  v_lshl_add_u32 v71, v68, 8, v71
  v_lshl_add_u32 v71, v69, 4, v71
  v_add_u32 v107, v71, v75
  v_add_u32 v67, 400, v73
  v_mul_u32_u24 v68, 2341, v67
  v_lshrrev_b32 v68, 16, v68
  v_mul_u32_u24 v69, 28, v68
  v_sub_u32 v69, v67, v69
  v_lshrrev_b32 v70, 4, v69
  v_and_b32 v69, 15, v69
  v_lshlrev_b32 v71, 12, v70
  v_lshl_add_u32 v71, v68, 8, v71
  v_lshl_add_u32 v71, v69, 4, v71
  v_add_u32 v108, v71, v75
  v_add_u32 v67, 416, v73
  v_mul_u32_u24 v68, 2341, v67
  v_lshrrev_b32 v68, 16, v68
  v_mul_u32_u24 v69, 28, v68
  v_sub_u32 v69, v67, v69
  v_lshrrev_b32 v70, 4, v69
  v_and_b32 v69, 15, v69
  v_lshlrev_b32 v71, 12, v70
  v_lshl_add_u32 v71, v68, 8, v71
  v_lshl_add_u32 v71, v69, 4, v71
  v_add_u32 v109, v71, v75
  v_add_u32 v67, 432, v73
  v_mul_u32_u24 v68, 2341, v67
  v_lshrrev_b32 v68, 16, v68
  v_mul_u32_u24 v69, 28, v68
  v_sub_u32 v69, v67, v69
  v_lshrrev_b32 v70, 4, v69
  v_and_b32 v69, 15, v69
  v_lshlrev_b32 v71, 12, v70
  v_lshl_add_u32 v71, v68, 8, v71
  v_lshl_add_u32 v71, v69, 4, v71
  v_add_u32 v110, v71, v75
  v_mov_b32 v74, 0x40000000
  v_mov_b32 v96, 0
  v_and_b32 v119, 15, v1
  s_and_b32 s22, s17, 0
  s_lshl_b32 s22, s22, 7
  s_add_u32 s22, s22, 39424
  v_lshl_add_u32 v119, v119, 2, s22
  s_lshl_b32 s22, s17, 2
  s_add_u32 s22, s22, 37376
  v_lshl_add_u32 v118, v1, 7, s22
  v_cmp_gt_u32 vcc, 1, v1
  s_nop 1
  v_cndmask_b32 v118, v74, v118, vcc
  s_lshl_b32 s35, s17, 7
  s_add_u32 s35, s35, 524288
  v_mov_b32 v64, 0
  v_mov_b32 v65, 0
  v_mov_b32 v66, 0
  v_mov_b32 v67, 0
  v_min_u32 v116, 13, v1
  s_mul_i32 s22, s17, 14
  v_add_u32 v116, s22, v116
  v_lshlrev_b32 v116, 7, v116
  s_mul_i32 s31, s17, 401408
  s_add_u32 s31, s31, 40278016
  s_mov_b32 s30, 0
ch_wr7:
  buffer_load_dword v9, off, s[12:15], 0 offset:128 sc1
  s_waitcnt vmcnt(0)
  v_cmp_ne_u32 vcc, 1, v9
  s_cbranch_vccz ch_wr7_ok
  s_sleep 8
  s_add_u32 s30, s30, 1
  s_cmp_lt_u32 s30, 400000
  s_cbranch_scc1 ch_wr7
  s_branch cA_abort
ch_wr7_ok:
  s_lshr_b32 s22, s17, 2
  s_lshl_b32 s28, 0x81, s22
  s_mul_i32 s27, s17, 12
  s_add_u32 s22, s27, 256
  s_lshr_b32 s22, s22, 6
  s_lshl_b32 s22, 0x81, s22
  s_or_b32 s28, s28, s22
  s_add_u32 s22, s27, 267
  s_lshr_b32 s22, s22, 6
  s_lshl_b32 s22, 0x81, s22
  s_or_b32 s28, s28, s22
  v_lshrrev_b32 v12, 8, v2
  v_lshlrev_b32 v12, 7, v12
  s_mov_b32 s27, 583680
  s_mov_b32 s30, 0
ch_ww7:
  buffer_load_dword v9, v12, s[8:11], s27 offen sc1
  s_waitcnt vmcnt(0)
  v_and_b32 v10, s28, v9
  v_cmp_ne_u32 vcc, s28, v10
  s_cbranch_vccz ch_ww7_ok
  s_sleep 3
  s_add_u32 s30, s30, 1
  s_cmp_lt_u32 s30, 400000
  s_cbranch_scc1 ch_ww7
  s_branch cA_abort
ch_ww7_ok:
  s_add_u32 s22, s31, 0
  buffer_load_dwordx4 a[0:3], v2, s[8:11], s22 offen offset:0 sc1
  buffer_load_dwordx4 a[4:7], v2, s[8:11], s22 offen offset:1024 sc1
  buffer_load_dwordx4 a[8:11], v2, s[8:11], s22 offen offset:2048 sc1
  buffer_load_dwordx4 a[12:15], v2, s[8:11], s22 offen offset:3072 sc1
  s_add_u32 s22, s31, 4096
  buffer_load_dwordx4 a[16:19], v2, s[8:11], s22 offen offset:0 sc1
  buffer_load_dwordx4 a[20:23], v2, s[8:11], s22 offen offset:1024 sc1
  buffer_load_dwordx4 a[24:27], v2, s[8:11], s22 offen offset:2048 sc1
  buffer_load_dwordx4 a[28:31], v2, s[8:11], s22 offen offset:3072 sc1
  s_add_u32 s22, s31, 8192
  buffer_load_dwordx4 a[32:35], v2, s[8:11], s22 offen offset:0 sc1
  buffer_load_dwordx4 a[36:39], v2, s[8:11], s22 offen offset:1024 sc1
  buffer_load_dwordx4 a[40:43], v2, s[8:11], s22 offen offset:2048 sc1
  buffer_load_dwordx4 a[44:47], v2, s[8:11], s22 offen offset:3072 sc1
  s_add_u32 s22, s31, 12288
  buffer_load_dwordx4 a[48:51], v2, s[8:11], s22 offen offset:0 sc1
  buffer_load_dwordx4 a[52:55], v2, s[8:11], s22 offen offset:1024 sc1
  buffer_load_dwordx4 a[56:59], v2, s[8:11], s22 offen offset:2048 sc1
  buffer_load_dwordx4 a[60:63], v2, s[8:11], s22 offen offset:3072 sc1
  s_add_u32 s22, s31, 16384
  buffer_load_dwordx4 a[64:67], v2, s[8:11], s22 offen offset:0 sc1
  buffer_load_dwordx4 a[68:71], v2, s[8:11], s22 offen offset:1024 sc1
  buffer_load_dwordx4 a[72:75], v2, s[8:11], s22 offen offset:2048 sc1
  buffer_load_dwordx4 a[76:79], v2, s[8:11], s22 offen offset:3072 sc1
  s_add_u32 s22, s31, 20480
  buffer_load_dwordx4 a[80:83], v2, s[8:11], s22 offen offset:0 sc1
  buffer_load_dwordx4 a[84:87], v2, s[8:11], s22 offen offset:1024 sc1
  buffer_load_dwordx4 a[88:91], v2, s[8:11], s22 offen offset:2048 sc1
  buffer_load_dwordx4 a[92:95], v2, s[8:11], s22 offen offset:3072 sc1
  s_add_u32 s22, s31, 24576
  buffer_load_dwordx4 a[96:99], v2, s[8:11], s22 offen offset:0 sc1
  buffer_load_dwordx4 a[100:103], v2, s[8:11], s22 offen offset:1024 sc1
  buffer_load_dwordx4 a[104:107], v2, s[8:11], s22 offen offset:2048 sc1
  buffer_load_dwordx4 a[108:111], v2, s[8:11], s22 offen offset:3072 sc1
  s_add_u32 s22, s31, 28672
  buffer_load_dwordx4 a[112:115], v2, s[8:11], s22 offen offset:0 sc1
  buffer_load_dwordx4 a[116:119], v2, s[8:11], s22 offen offset:1024 sc1
  buffer_load_dwordx4 a[120:123], v2, s[8:11], s22 offen offset:2048 sc1
  buffer_load_dwordx4 a[124:127], v2, s[8:11], s22 offen offset:3072 sc1
  s_waitcnt vmcnt(24)
  s_add_u32 s22, s31, 32768
  buffer_load_dwordx4 a[128:131], v2, s[8:11], s22 offen offset:0 sc1
  buffer_load_dwordx4 a[132:135], v2, s[8:11], s22 offen offset:1024 sc1
  buffer_load_dwordx4 a[136:139], v2, s[8:11], s22 offen offset:2048 sc1
  buffer_load_dwordx4 a[140:143], v2, s[8:11], s22 offen offset:3072 sc1
  s_add_u32 s22, s31, 36864
  buffer_load_dwordx4 a[144:147], v2, s[8:11], s22 offen offset:0 sc1
  buffer_load_dwordx4 a[148:151], v2, s[8:11], s22 offen offset:1024 sc1
  buffer_load_dwordx4 a[152:155], v2, s[8:11], s22 offen offset:2048 sc1
  buffer_load_dwordx4 a[156:159], v2, s[8:11], s22 offen offset:3072 sc1
  s_add_u32 s22, s31, 40960
  buffer_load_dwordx4 a[160:163], v2, s[8:11], s22 offen offset:0 sc1
  buffer_load_dwordx4 a[164:167], v2, s[8:11], s22 offen offset:1024 sc1
  buffer_load_dwordx4 a[168:171], v2, s[8:11], s22 offen offset:2048 sc1
  buffer_load_dwordx4 a[172:175], v2, s[8:11], s22 offen offset:3072 sc1
  s_add_u32 s22, s31, 45056
  buffer_load_dwordx4 a[176:179], v2, s[8:11], s22 offen offset:0 sc1
  buffer_load_dwordx4 a[180:183], v2, s[8:11], s22 offen offset:1024 sc1
  buffer_load_dwordx4 a[184:187], v2, s[8:11], s22 offen offset:2048 sc1
  buffer_load_dwordx4 a[188:191], v2, s[8:11], s22 offen offset:3072 sc1
  s_add_u32 s22, s31, 49152
  buffer_load_dwordx4 a[192:195], v2, s[8:11], s22 offen offset:0 sc1
  buffer_load_dwordx4 a[196:199], v2, s[8:11], s22 offen offset:1024 sc1
  buffer_load_dwordx4 a[200:203], v2, s[8:11], s22 offen offset:2048 sc1
  buffer_load_dwordx4 a[204:207], v2, s[8:11], s22 offen offset:3072 sc1
  s_add_u32 s22, s31, 53248
  buffer_load_dwordx4 a[208:211], v2, s[8:11], s22 offen offset:0 sc1
  buffer_load_dwordx4 a[212:215], v2, s[8:11], s22 offen offset:1024 sc1
  buffer_load_dwordx4 a[216:219], v2, s[8:11], s22 offen offset:2048 sc1
  buffer_load_dwordx4 a[220:223], v2, s[8:11], s22 offen offset:3072 sc1
  s_add_u32 s22, s31, 57344
  buffer_load_dwordx4 a[224:227], v2, s[8:11], s22 offen offset:0 sc1
  buffer_load_dwordx4 a[228:231], v2, s[8:11], s22 offen offset:1024 sc1
  buffer_load_dwordx4 a[232:235], v2, s[8:11], s22 offen offset:2048 sc1
  buffer_load_dwordx4 a[236:239], v2, s[8:11], s22 offen offset:3072 sc1
  s_add_u32 s22, s31, 61440
  buffer_load_dwordx4 a[240:243], v2, s[8:11], s22 offen offset:0 sc1
  buffer_load_dwordx4 a[244:247], v2, s[8:11], s22 offen offset:1024 sc1
  buffer_load_dwordx4 a[248:251], v2, s[8:11], s22 offen offset:2048 sc1
  buffer_load_dwordx4 a[252:255], v2, s[8:11], s22 offen offset:3072 sc1
  s_waitcnt vmcnt(24)
  s_add_u32 s22, s31, 65536
  buffer_load_dwordx4 v[120:123], v2, s[8:11], s22 offen offset:0 sc1
  buffer_load_dwordx4 v[124:127], v2, s[8:11], s22 offen offset:1024 sc1
  buffer_load_dwordx4 v[128:131], v2, s[8:11], s22 offen offset:2048 sc1
  buffer_load_dwordx4 v[132:135], v2, s[8:11], s22 offen offset:3072 sc1
  s_add_u32 s22, s31, 69632
  buffer_load_dwordx4 v[136:139], v2, s[8:11], s22 offen offset:0 sc1
  buffer_load_dwordx4 v[140:143], v2, s[8:11], s22 offen offset:1024 sc1
  buffer_load_dwordx4 v[144:147], v2, s[8:11], s22 offen offset:2048 sc1
  buffer_load_dwordx4 v[148:151], v2, s[8:11], s22 offen offset:3072 sc1
  s_add_u32 s22, s31, 73728
  buffer_load_dwordx4 v[152:155], v2, s[8:11], s22 offen offset:0 sc1
  buffer_load_dwordx4 v[156:159], v2, s[8:11], s22 offen offset:1024 sc1
  buffer_load_dwordx4 v[160:163], v2, s[8:11], s22 offen offset:2048 sc1
  buffer_load_dwordx4 v[164:167], v2, s[8:11], s22 offen offset:3072 sc1
  s_add_u32 s22, s31, 77824
  buffer_load_dwordx4 v[168:171], v2, s[8:11], s22 offen offset:0 sc1
  buffer_load_dwordx4 v[172:175], v2, s[8:11], s22 offen offset:1024 sc1
  buffer_load_dwordx4 v[176:179], v2, s[8:11], s22 offen offset:2048 sc1
  buffer_load_dwordx4 v[180:183], v2, s[8:11], s22 offen offset:3072 sc1
  s_add_u32 s22, s31, 81920
  buffer_load_dwordx4 v[184:187], v2, s[8:11], s22 offen offset:0 sc1
  buffer_load_dwordx4 v[188:191], v2, s[8:11], s22 offen offset:1024 sc1
  buffer_load_dwordx4 v[192:195], v2, s[8:11], s22 offen offset:2048 sc1
  buffer_load_dwordx4 v[196:199], v2, s[8:11], s22 offen offset:3072 sc1
  s_add_u32 s22, s31, 86016
  buffer_load_dwordx4 v[200:203], v2, s[8:11], s22 offen offset:0 sc1
  buffer_load_dwordx4 v[204:207], v2, s[8:11], s22 offen offset:1024 sc1
  buffer_load_dwordx4 v[208:211], v2, s[8:11], s22 offen offset:2048 sc1
  buffer_load_dwordx4 v[212:215], v2, s[8:11], s22 offen offset:3072 sc1
  s_add_u32 s22, s31, 90112
  buffer_load_dwordx4 v[216:219], v2, s[8:11], s22 offen offset:0 sc1
  buffer_load_dwordx4 v[220:223], v2, s[8:11], s22 offen offset:1024 sc1
  buffer_load_dwordx4 v[224:227], v2, s[8:11], s22 offen offset:2048 sc1
  buffer_load_dwordx4 v[228:231], v2, s[8:11], s22 offen offset:3072 sc1
  s_add_u32 s22, s31, 94208
  buffer_load_dwordx4 v[232:235], v2, s[8:11], s22 offen offset:0 sc1
  buffer_load_dwordx4 v[236:239], v2, s[8:11], s22 offen offset:1024 sc1
  buffer_load_dwordx4 v[240:243], v2, s[8:11], s22 offen offset:2048 sc1
  buffer_load_dwordx4 v[244:247], v2, s[8:11], s22 offen offset:3072 sc1
  s_waitcnt vmcnt(24)
  s_add_u32 s22, s31, 98304
  buffer_load_dwordx4 v[248:251], v2, s[8:11], s22 offen offset:0 sc1
  buffer_load_dwordx4 v[252:255], v2, s[8:11], s22 offen offset:1024 sc1
  s_mov_b32 s30, 0
ch_ws7:
  buffer_load_dword v9, off, s[12:15], 0 offset:132 sc1
  s_waitcnt vmcnt(0)
  v_cmp_ne_u32 vcc, 1, v9
  s_cbranch_vccz ch_ws7_ok
  s_sleep 8
  s_add_u32 s30, s30, 1
  s_cmp_lt_u32 s30, 400000
  s_cbranch_scc1 ch_ws7
  s_branch cA_abort
ch_ws7_ok:
  s_lshl_b32 s27, s17, 7
  s_add_u32 s27, s27, 524288
  s_mov_b32 s30, 0
ch_vw3:
  buffer_load_dword v9, off, s[8:11], s27 sc1
  s_waitcnt vmcnt(0)
  v_cmp_ne_u32 vcc, 56, v9
  s_cbranch_vccz ch_vw3_d
  s_sleep 2
  s_add_u32 s30, s30, 1
  s_cmp_lt_u32 s30, 400000
  s_cbranch_scc1 ch_vw3
  s_branch cA_abort
ch_vw3_d:
  s_mov_b32 s28, s35
  s_mov_b32 s39, 684032
  buffer_load_dword v100, v116, s[8:11], s39 offen sc1
  s_mov_b32 s39, 712704
  s_waitcnt vmcnt(1) lgkmcnt(0)
  s_mov_b32 s31, 0
  s_cmp_lg_u32 s88, 0
  s_cbranch_scc1 cB_va3_loop
  s_branch cA_va3_loop
.p2align 6
cA_sc0_loop:
  s_mov_b32 s30, 0
  s_mov_b32 s62, 0
  s_setprio 3
  s_sleep 6
cA_sc0_fp_l:
  v_cmp_gt_u32 vcc, s19, v112
  buffer_load_dword v112, v0, s[8:11], 0 offen sc1
  s_cbranch_vccz cA_sc0_fp_d
  v_cmp_gt_u32 vcc, s19, v112
  buffer_load_dword v112, v0, s[8:11], 0 offen sc1
  s_cbranch_vccz cA_sc0_fp_d
  v_cmp_gt_u32 vcc, s19, v112
  buffer_load_dword v112, v0, s[8:11], 0 offen sc1
  s_cbranch_vccz cA_sc0_fp_d
  v_cmp_gt_u32 vcc, s19, v112
  buffer_load_dword v112, v0, s[8:11], 0 offen sc1
  s_cbranch_vccz cA_sc0_fp_d
  v_cmp_gt_u32 vcc, s19, v112
  buffer_load_dword v112, v0, s[8:11], 0 offen sc1
  s_cbranch_vccz cA_sc0_fp_d
  v_cmp_gt_u32 vcc, s19, v112
  buffer_load_dword v112, v0, s[8:11], 0 offen sc1
  s_cbranch_vccz cA_sc0_fp_d
  v_cmp_gt_u32 vcc, s19, v112
  buffer_load_dword v112, v0, s[8:11], 0 offen sc1
  s_cbranch_vccz cA_sc0_fp_d
  v_cmp_gt_u32 vcc, s19, v112
  buffer_load_dword v112, v0, s[8:11], 0 offen sc1
  s_cbranch_vccz cA_sc0_fp_d
  v_cmp_gt_u32 vcc, s19, v112
  buffer_load_dword v112, v0, s[8:11], 0 offen sc1
  s_cbranch_vccz cA_sc0_fp_d
  v_cmp_gt_u32 vcc, s19, v112
  buffer_load_dword v112, v0, s[8:11], 0 offen sc1
  s_cbranch_vccz cA_sc0_fp_d
  v_cmp_gt_u32 vcc, s19, v112
  buffer_load_dword v112, v0, s[8:11], 0 offen sc1
  s_cbranch_vccz cA_sc0_fp_d
  v_cmp_gt_u32 vcc, s19, v112
  buffer_load_dword v112, v0, s[8:11], 0 offen sc1
  s_cbranch_vccz cA_sc0_fp_d
  v_cmp_gt_u32 vcc, s19, v112
  buffer_load_dword v112, v0, s[8:11], 0 offen sc1
  s_cbranch_vccz cA_sc0_fp_d
  v_cmp_gt_u32 vcc, s19, v112
  buffer_load_dword v112, v0, s[8:11], 0 offen sc1
  s_cbranch_vccz cA_sc0_fp_d
  v_cmp_gt_u32 vcc, s19, v112
  buffer_load_dword v112, v0, s[8:11], 0 offen sc1
  s_cbranch_vccz cA_sc0_fp_d
  v_cmp_gt_u32 vcc, s19, v112
  buffer_load_dword v112, v0, s[8:11], 0 offen sc1
  s_cbranch_vccz cA_sc0_fp_d
  s_waitcnt vmcnt(24)
  s_add_u32 s30, s30, 1
  s_cmp_lt_u32 s30, 400000
  s_cbranch_scc1 cA_sc0_fp_l
  s_branch cA_abort
cA_sc0_fp_d:
  buffer_load_dwordx4 v[8:11], v2, s[8:11], s20 offen offset:0 sc1
  s_barrier
  s_setprio 2
  buffer_load_dwordx4 v[12:15], v2, s[8:11], s20 offen offset:1024 sc1
  s_setprio 1
  buffer_load_dwordx4 v[16:19], v2, s[8:11], s20 offen offset:2048 sc1
  s_setprio 0
  buffer_load_dwordx4 v[20:23], v2, s[8:11], s20 offen offset:3072 sc1
cA_sc0_go:
  s_waitcnt vmcnt(3)
  v_smfmac_f32_16x16x64_bf16 v[36:39], v[8:11], a[0:7], v3
  buffer_load_dwordx4 v[32:35], v2, s[8:11], s23 offen offset:0 sc1
  v_cmp_eq_u32 vcc, -1, v8
  v_smfmac_f32_16x16x64_bf16 v[40:43], v[8:11], a[56:63], v3
  v_smfmac_f32_16x16x64_bf16 v[44:47], v[8:11], a[112:119], v3
  buffer_load_dwordx4 v[24:27], v2, s[8:11], s23 offen offset:1024 sc1
  s_cbranch_vccnz cA_sc0_r0
  v_smfmac_f32_16x16x64_bf16 v[48:51], v[8:11], a[168:175], v3
  v_smfmac_f32_16x16x64_bf16 v[52:55], v[8:11], a[224:231], v3
  s_waitcnt vmcnt(4)
  v_cmp_eq_u32 vcc, -1, v12
  v_smfmac_f32_16x16x64_bf16 v[56:59], v[8:11], v[144:151], v3
  buffer_load_dwordx4 v[28:31], v2, s[8:11], s23 offen offset:2048 sc1
  v_smfmac_f32_16x16x64_bf16 v[60:63], v[8:11], v[200:207], v3
  s_cbranch_vccnz cA_sc0_r1
cA_sc0_c1:
  v_smfmac_f32_16x16x64_bf16 v[36:39], v[12:15], a[8:15], v3
  v_smfmac_f32_16x16x64_bf16 v[40:43], v[12:15], a[64:71], v3
  v_smfmac_f32_16x16x64_bf16 v[44:47], v[12:15], a[120:127], v3
  v_smfmac_f32_16x16x64_bf16 v[48:51], v[12:15], a[176:183], v3
  v_smfmac_f32_16x16x64_bf16 v[52:55], v[12:15], a[232:239], v3
  s_waitcnt vmcnt(4)
  v_cmp_eq_u32 vcc, -1, v16
  v_smfmac_f32_16x16x64_bf16 v[56:59], v[12:15], v[152:159], v3
  buffer_load_dwordx4 v[88:91], v117, s[8:11], s26 offen offset:0 sc1
  v_smfmac_f32_16x16x64_bf16 v[60:63], v[12:15], v[208:215], v3
  s_cbranch_vccnz cA_sc0_r2
cA_sc0_c2:
  v_smfmac_f32_16x16x64_bf16 v[36:39], v[16:19], a[16:23], v3
  v_smfmac_f32_16x16x64_bf16 v[40:43], v[16:19], a[72:79], v3
  v_smfmac_f32_16x16x64_bf16 v[44:47], v[16:19], a[128:135], v3
  buffer_load_dwordx4 v[92:95], v117, s[8:11], s26 offen offset:1024 sc1
  v_smfmac_f32_16x16x64_bf16 v[48:51], v[16:19], a[184:191], v3
  v_smfmac_f32_16x16x64_bf16 v[52:55], v[16:19], a[240:247], v3
  s_waitcnt vmcnt(5)
  v_cmp_eq_u32 vcc, -1, v20
  v_smfmac_f32_16x16x64_bf16 v[56:59], v[16:19], v[160:167], v3
  v_smfmac_f32_16x16x64_bf16 v[60:63], v[16:19], v[216:223], v3
  buffer_load_dwordx4 v[96:99], v2, s[8:11], s24 offen offset:0 sc1
  s_cbranch_vccnz cA_sc0_r3
cA_sc0_c3:
  v_smfmac_f32_16x16x64_bf16 v[36:39], v[20:23], a[24:31], v3
  v_smfmac_f32_16x16x64_bf16 v[40:43], v[20:23], a[80:87], v3
  s_waitcnt vmcnt(3)
  v_max3_u32 v66, v24, v27, v28
  v_smfmac_f32_16x16x64_bf16 v[44:47], v[20:23], a[136:143], v3
  v_max3_u32 v66, v66, v31, v32
  v_smfmac_f32_16x16x64_bf16 v[48:51], v[20:23], a[192:199], v3
  buffer_load_dwordx4 v[100:103], v2, s[8:11], s24 offen offset:1024 sc1
  v_max_u32 v66, v66, v35
  v_smfmac_f32_16x16x64_bf16 v[52:55], v[20:23], a[248:255], v3
  v_cmp_eq_u32 vcc, -1, v66
  v_smfmac_f32_16x16x64_bf16 v[56:59], v[20:23], v[168:175], v3
  v_smfmac_f32_16x16x64_bf16 v[60:63], v[20:23], v[224:231], v3
  s_cbranch_vccnz cA_sc0_r4
cA_sc0_c4:
  v_smfmac_f32_16x16x64_bf16 v[60:63], v[32:35], v[232:239], v3
  buffer_load_dwordx4 v[104:107], v2, s[8:11], s26 offen offset:0 sc1
  v_smfmac_f32_16x16x64_bf16 v[60:63], v[24:27], v[240:247], v3
  v_smfmac_f32_16x16x64_bf16 v[60:63], v[28:31], v[248:255], v3
  v_smfmac_f32_16x16x64_bf16 v[52:55], v[32:35], v[120:127], v3
  v_smfmac_f32_16x16x64_bf16 v[52:55], v[24:27], v[128:135], v3
  buffer_load_dwordx4 v[108:111], v2, s[8:11], s26 offen offset:1024 sc1
  v_smfmac_f32_16x16x64_bf16 v[52:55], v[28:31], v[136:143], v3
  v_cvt_pk_bf16_f32 v63, v62, v63
  v_smfmac_f32_16x16x64_bf16 v[56:59], v[32:35], v[176:183], v3
  v_cvt_pk_bf16_f32 v62, v60, v61
  v_smfmac_f32_16x16x64_bf16 v[56:59], v[24:27], v[184:191], v3
  v_mfma_f32_16x16x32_bf16 v[12:15], v[62:65], v[4:7], 0
  v_cvt_pk_bf16_f32 v55, v54, v55
  v_smfmac_f32_16x16x64_bf16 v[56:59], v[28:31], v[192:199], v3
  v_cvt_pk_bf16_f32 v54, v52, v53
  v_smfmac_f32_16x16x64_bf16 v[36:39], v[32:35], a[32:39], v3
  s_nop 1
  v_cvt_pk_bf16_f32 v76, v12, v13
  v_smfmac_f32_16x16x64_bf16 v[36:39], v[24:27], a[40:47], v3
  v_cvt_pk_bf16_f32 v77, v14, v15
  v_smfmac_f32_16x16x64_bf16 v[36:39], v[28:31], a[48:55], v3
  v_cvt_pk_bf16_f32 v56, v56, v57
  v_smfmac_f32_16x16x64_bf16 v[40:43], v[32:35], a[88:95], v3
  v_cvt_pk_bf16_f32 v57, v58, v59
  v_smfmac_f32_16x16x64_bf16 v[40:43], v[24:27], a[96:103], v3
  v_mfma_f32_16x16x32_bf16 v[16:19], v[54:57], v[4:7], 0
  v_cvt_pk_bf16_f32 v39, v38, v39
  v_smfmac_f32_16x16x64_bf16 v[40:43], v[28:31], a[104:111], v3
  v_cvt_pk_bf16_f32 v38, v36, v37
  v_smfmac_f32_16x16x64_bf16 v[44:47], v[32:35], a[144:151], v3
  s_nop 1
  v_cvt_pk_bf16_f32 v78, v16, v17
  v_smfmac_f32_16x16x64_bf16 v[44:47], v[24:27], a[152:159], v3
  v_cvt_pk_bf16_f32 v79, v18, v19
  v_smfmac_f32_16x16x64_bf16 v[44:47], v[28:31], a[160:167], v3
  v_cvt_pk_bf16_f32 v40, v40, v41
  v_smfmac_f32_16x16x64_bf16 v[48:51], v[32:35], a[200:207], v3
  v_cvt_pk_bf16_f32 v41, v42, v43
  v_smfmac_f32_16x16x64_bf16 v[48:51], v[24:27], a[208:215], v3
  v_smfmac_f32_16x16x64_bf16 v[48:51], v[28:31], a[216:223], v3
  s_waitcnt vmcnt(4)
  v_cvt_pk_bf16_f32 v47, v46, v47
  v_smfmac_f32_16x16x64_bf16 v[68:71], v[76:79], v[80:87], v3
  v_cvt_pk_bf16_f32 v46, v44, v45
  v_mfma_f32_16x16x32_bf16 v[12:15], v[38:41], v[4:7], 0
  s_nop 1
  v_cvt_pk_bf16_f32 v48, v48, v49
  v_cvt_pk_bf16_f32 v49, v50, v51
  s_nop 1
  v_mfma_f32_16x16x32_bf16 v[16:19], v[46:49], v[4:7], 0
  v_smfmac_f32_16x16x64_bf16 v[72:75], v[76:79], v[88:95], v3
  v_cvt_pk_bf16_f32 v20, v12, v13
  v_mfma_f32_16x16x32_bf16 v[52:55], v[30:33], v[76:79], 0
  s_waitcnt vmcnt(0)
  v_cvt_pk_bf16_f32 v21, v14, v15
  v_cvt_pk_bf16_f32 v22, v16, v17
  v_cvt_pk_bf16_f32 v23, v18, v19
  s_nop 1
  v_mfma_f32_16x16x32_bf16 v[52:55], v[8:11], v[20:23], v[52:55]
  v_smfmac_f32_16x16x64_bf16 v[68:71], v[20:23], v[96:103], v3
  v_smfmac_f32_16x16x64_bf16 v[72:75], v[20:23], v[104:111], v3
  s_nop 1
  ds_write_b128 v113, v[52:55]
  s_nop 1
  v_permlane32_swap_b32 v68, v70
  v_permlane32_swap_b32 v69, v71
  v_add_f32 v56, v68, v70
  v_add_f32 v58, v69, v71
  v_permlane32_swap_b32 v72, v74
  v_permlane32_swap_b32 v73, v75
  v_add_f32 v57, v72, v74
  v_add_f32 v59, v73, v75
  ds_write_b128 v2, v[56:59] offset:0
  v_cmp_u_f32 vcc, v57, v59
  v_mov_b32 v68, 0
  v_mov_b32 v69, 0
  v_mov_b32 v70, 0
  v_mov_b32 v71, 0
  s_cbranch_vccnz cA_sc0_retry
cA_sc0_cont:
  s_add_u32 s24, s24, 28672
  s_add_u32 s26, s26, 28672
  buffer_load_dwordx4 v[80:83], v117, s[8:11], s24 offen offset:0 sc1
  buffer_load_dwordx4 v[84:87], v117, s[8:11], s24 offen offset:1024 sc1
  v_mov_b32 v72, 0
  v_mov_b32 v73, 0
  v_mfma_f32_32x32x16_bf16 v[36:51], v[68:71], v[68:71], 0
  s_waitcnt lgkmcnt(0)
  s_barrier
  ds_read_b64 v[8:9], v114 offset:0
  ds_read_b64 v[10:11], v114 offset:1024
  ds_read_b64 v[12:13], v114 offset:2048
  ds_read_b64 v[14:15], v114 offset:3072
  ds_read2_b32 v[16:17], v115 offset0:0 offset1:64
  ds_read2_b32 v[18:19], v115 offset0:128 offset1:192
  v_mfma_f32_32x32x16_bf16 v[52:67], v[68:71], v[68:71], 0
  s_waitcnt lgkmcnt(0)
  v_pk_add_f32 v[16:17], v[16:17], v[18:19]
  v_pk_add_f32 v[8:9], v[8:9], v[10:11]
  v_pk_add_f32 v[12:13], v[12:13], v[14:15]
  v_add_f32 v20, v16, v17
  v_pk_add_f32 v[8:9], v[8:9], v[12:13]
  v_max_f32 v22, v8, v9
  v_add_f32_dpp v20, v20, v20 row_ror:8 row_mask:0xf bank_mask:0xf
  s_nop 0
  v_max_f32_dpp v22, v22, v22 row_ror:8 row_mask:0xf bank_mask:0xf
  v_max_f32 v22, v22, v20
  s_nop 1
  v_max_f32_dpp v22, v22, v22 quad_perm:[1,0,3,2] row_mask:0xf bank_mask:0xf
  s_nop 1
  v_max_f32_dpp v22, v22, v22 quad_perm:[2,3,0,1] row_mask:0xf bank_mask:0xf
  s_nop 1
  v_max_f32_dpp v22, v22, v22 row_half_mirror row_mask:0xf bank_mask:0xf
  v_pk_add_f32 v[8:9], v[8:9], v[22:23] op_sel_hi:[1,0] neg_lo:[0,1] neg_hi:[0,1]
  v_sub_f32 v20, v20, v22
  v_exp_f32 v8, v8
  v_exp_f32 v9, v9
  v_exp_f32 v20, v20
  v_add_f32 v24, v8, v9
  v_fmac_f32 v24, 0.5, v20
  v_mov_b32_dpp v21, v20 quad_perm:[1,0,3,2] row_mask:0xf bank_mask:0xf
  s_nop 0
  v_add_f32_dpp v24, v24, v24 quad_perm:[1,0,3,2] row_mask:0xf bank_mask:0xf
  s_nop 1
  v_add_f32_dpp v24, v24, v24 quad_perm:[2,3,0,1] row_mask:0xf bank_mask:0xf
  s_nop 1
  v_add_f32_dpp v24, v24, v24 row_half_mirror row_mask:0xf bank_mask:0xf
  s_nop 1
  v_add_f32_dpp v24, v24, v24 row_ror:8 row_mask:0xf bank_mask:0xf
  v_rcp_f32 v24, v24
  s_nop 0
  v_pk_mul_f32 v[8:9], v[8:9], v[24:25] op_sel_hi:[1,0]
  v_cvt_pk_bf16_f32 v8, abs(v8), abs(v9)
  buffer_store_dword v8, v1, s[8:11], s20 offen
  v_pk_mul_f32 v[20:21], v[20:21], v[24:25] op_sel_hi:[1,0]
  v_cvt_pk_bf16_f32 v20, abs(v20), abs(v21)
  buffer_store_dword v20, v118, s[8:11], s20 offen
  v_mov_b32 v74, 0
  v_mov_b32 v75, 0
  s_mov_b32 s19, s18
  s_add_u32 s18, s18, 1
  s_mov_b32 s22, s20
  s_mov_b32 s20, s21
  s_mov_b32 s21, s22
  s_add_u32 s23, s20, 4096
  s_cmp_lt_u32 s19, 63
  s_cbranch_scc1 cA_sc0_loop
  s_branch cA_done
cA_sc0_r0:
  s_add_u32 s31, s31, 1
  buffer_load_dwordx4 v[8:11], v2, s[8:11], s20 offen offset:0 sc1
  s_waitcnt vmcnt(0)
  v_cmp_eq_u32 vcc, -1, v8
  v_mov_b32 v36, 0
  v_mov_b32 v37, 0
  v_mov_b32 v38, 0
  v_mov_b32 v39, 0
  v_mov_b32 v40, 0
  v_mov_b32 v41, 0
  v_mov_b32 v42, 0
  v_mov_b32 v43, 0
  v_mov_b32 v44, 0
  v_mov_b32 v45, 0
  v_mov_b32 v46, 0
  v_mov_b32 v47, 0
  v_mov_b32 v48, 0
  v_mov_b32 v49, 0
  v_mov_b32 v50, 0
  v_mov_b32 v51, 0
  s_nop 1
  s_cbranch_vccz cA_sc0_go
  s_add_u32 s30, s30, 1
  s_cmp_lt_u32 s30, 400000
  s_cbranch_scc1 cA_sc0_r0
  s_branch cA_abort
cA_sc0_r1:
  s_add_u32 s31, s31, 1
  buffer_load_dwordx4 v[12:15], v2, s[8:11], s20 offen offset:1024 sc1
  s_waitcnt vmcnt(0)
  v_cmp_eq_u32 vcc, -1, v12
  s_nop 4
  s_cbranch_vccz cA_sc0_c1
  s_add_u32 s30, s30, 1
  s_cmp_lt_u32 s30, 400000
  s_cbranch_scc1 cA_sc0_r1
  s_branch cA_abort
cA_sc0_r2:
  s_add_u32 s31, s31, 1
  buffer_load_dwordx4 v[16:19], v2, s[8:11], s20 offen offset:2048 sc1
  s_waitcnt vmcnt(0)
  v_cmp_eq_u32 vcc, -1, v16
  s_nop 4
  s_cbranch_vccz cA_sc0_c2
  s_add_u32 s30, s30, 1
  s_cmp_lt_u32 s30, 400000
  s_cbranch_scc1 cA_sc0_r2
  s_branch cA_abort
cA_sc0_r3:
  s_add_u32 s31, s31, 1
  buffer_load_dwordx4 v[20:23], v2, s[8:11], s20 offen offset:3072 sc1
  s_waitcnt vmcnt(0)
  v_cmp_eq_u32 vcc, -1, v20
  s_nop 4
  s_cbranch_vccz cA_sc0_c3
  s_add_u32 s30, s30, 1
  s_cmp_lt_u32 s30, 400000
  s_cbranch_scc1 cA_sc0_r3
  s_branch cA_abort
cA_sc0_r4:
  s_add_u32 s31, s31, 1
  buffer_load_dwordx4 v[32:35], v2, s[8:11], s23 offen offset:0 sc1
  buffer_load_dwordx4 v[24:27], v2, s[8:11], s23 offen offset:1024 sc1
  buffer_load_dwordx4 v[28:31], v2, s[8:11], s23 offen offset:2048 sc1
  s_waitcnt vmcnt(0)
  v_max3_u32 v66, v24, v27, v28
  v_max3_u32 v66, v66, v31, v32
  v_max_u32 v66, v66, v35
  v_cmp_eq_u32 vcc, -1, v66
  s_nop 4
  s_cbranch_vccz cA_sc0_c4
  s_add_u32 s30, s30, 1
  s_cmp_lt_u32 s30, 400000
  s_cbranch_scc1 cA_sc0_r4
  s_branch cA_abort
cA_sc0_retry:
  s_cmp_lg_u32 s62, 0
  s_cbranch_scc1 cA_sc0_cont
  s_waitcnt vmcnt(0) lgkmcnt(0)
cA_sc0_rv:
  buffer_load_dwordx4 v[8:11], v2, s[8:11], s20 offen offset:0 sc1
  buffer_load_dwordx4 v[12:15], v2, s[8:11], s20 offen offset:1024 sc1
  buffer_load_dwordx4 v[16:19], v2, s[8:11], s20 offen offset:2048 sc1
  buffer_load_dwordx4 v[20:23], v2, s[8:11], s20 offen offset:3072 sc1
  buffer_load_dwordx4 v[32:35], v2, s[8:11], s23 offen offset:0 sc1
  buffer_load_dwordx4 v[24:27], v2, s[8:11], s23 offen offset:1024 sc1
  buffer_load_dwordx4 v[28:31], v2, s[8:11], s23 offen offset:2048 sc1
  s_waitcnt vmcnt(0)
  v_max3_u32 v66, v8, v9, v10
  v_max3_u32 v66, v66, v11, v12
  v_max3_u32 v66, v66, v13, v14
  v_max3_u32 v66, v66, v15, v16
  v_max3_u32 v66, v66, v17, v18
  v_max3_u32 v66, v66, v19, v20
  v_max3_u32 v66, v66, v21, v22
  v_max3_u32 v66, v66, v23, v24
  v_max3_u32 v66, v66, v25, v26
  v_max3_u32 v66, v66, v27, v28
  v_max3_u32 v66, v66, v29, v30
  v_max3_u32 v66, v66, v31, v32
  v_max3_u32 v66, v66, v33, v34
  v_max_u32 v66, v66, v35
  v_cmp_eq_u32 vcc, -1, v66
  s_cbranch_vccz cA_sc0_rk
  s_add_u32 s30, s30, 1
  s_cmp_lt_u32 s30, 400000
  s_cbranch_scc1 cA_sc0_rv
  s_branch cA_abort
cA_sc0_rk:
  s_mov_b32 s62, 1
  v_mov_b32 v36, 0
  v_mov_b32 v37, 0
  v_mov_b32 v38, 0
  v_mov_b32 v39, 0
  v_mov_b32 v40, 0
  v_mov_b32 v41, 0
  v_mov_b32 v42, 0
  v_mov_b32 v43, 0
  v_mov_b32 v44, 0
  v_mov_b32 v45, 0
  v_mov_b32 v46, 0
  v_mov_b32 v47, 0
  v_mov_b32 v48, 0
  v_mov_b32 v49, 0
  v_mov_b32 v50, 0
  v_mov_b32 v51, 0
  v_mov_b32 v60, 0
  v_mov_b32 v61, 0
  v_mov_b32 v62, 0
  v_mov_b32 v63, 0
  v_mov_b32 v68, 0
  v_mov_b32 v69, 0
  v_mov_b32 v70, 0
  v_mov_b32 v71, 0
  v_mov_b32 v72, 0
  v_mov_b32 v73, 0
  v_mov_b32 v74, 0
  v_mov_b32 v75, 0
  v_mov_b32 v52, 0
  v_mov_b32 v53, 0
  v_mov_b32 v54, 0
  v_mov_b32 v55, 0
  v_mov_b32 v56, 0
  v_mov_b32 v57, 0
  v_mov_b32 v58, 0
  v_mov_b32 v59, 0
  s_add_u32 s31, s31, 0x100
  s_nop 0
  s_branch cA_sc0_go
.p2align 6
cA_sc1_loop:
  s_mov_b32 s30, 0
  s_mov_b32 s62, 0
  s_setprio 3
  s_barrier
  buffer_load_dwordx4 v[8:11], v2, s[8:11], s20 offen offset:0 sc1
  s_setprio 2
  buffer_load_dwordx4 v[12:15], v2, s[8:11], s20 offen offset:1024 sc1
  s_setprio 1
  buffer_load_dwordx4 v[16:19], v2, s[8:11], s20 offen offset:2048 sc1
  s_setprio 0
  buffer_load_dwordx4 v[20:23], v2, s[8:11], s20 offen offset:3072 sc1
cA_sc1_go:
  s_waitcnt vmcnt(3)
  v_smfmac_f32_16x16x64_bf16 v[36:39], v[8:11], a[0:7], v3
  buffer_load_dwordx4 v[28:31], v2, s[8:11], s23 offen offset:0 sc1
  v_cmp_eq_u32 vcc, -1, v8
  v_smfmac_f32_16x16x64_bf16 v[40:43], v[8:11], a[56:63], v3
  v_smfmac_f32_16x16x64_bf16 v[44:47], v[8:11], a[112:119], v3
  buffer_load_dwordx4 v[24:27], v2, s[8:11], s23 offen offset:1024 sc1
  s_cbranch_vccnz cA_sc1_r0
  v_smfmac_f32_16x16x64_bf16 v[48:51], v[8:11], a[168:175], v3
  v_smfmac_f32_16x16x64_bf16 v[52:55], v[8:11], a[224:231], v3
  s_waitcnt vmcnt(4)
  v_cmp_eq_u32 vcc, -1, v12
  v_smfmac_f32_16x16x64_bf16 v[56:59], v[8:11], v[144:151], v3
  buffer_load_dwordx4 v[32:35], v2, s[8:11], s23 offen offset:2048 sc1
  v_smfmac_f32_16x16x64_bf16 v[60:63], v[8:11], v[200:207], v3
  s_cbranch_vccnz cA_sc1_r1
cA_sc1_c1:
  v_smfmac_f32_16x16x64_bf16 v[36:39], v[12:15], a[8:15], v3
  v_smfmac_f32_16x16x64_bf16 v[40:43], v[12:15], a[64:71], v3
  v_smfmac_f32_16x16x64_bf16 v[44:47], v[12:15], a[120:127], v3
  v_smfmac_f32_16x16x64_bf16 v[48:51], v[12:15], a[176:183], v3
  v_smfmac_f32_16x16x64_bf16 v[52:55], v[12:15], a[232:239], v3
  s_waitcnt vmcnt(4)
  v_cmp_eq_u32 vcc, -1, v16
  v_smfmac_f32_16x16x64_bf16 v[56:59], v[12:15], v[152:159], v3
  buffer_load_dwordx4 v[88:91], v117, s[8:11], s26 offen offset:0 sc1
  v_smfmac_f32_16x16x64_bf16 v[60:63], v[12:15], v[208:215], v3
  s_cbranch_vccnz cA_sc1_r2
cA_sc1_c2:
  v_smfmac_f32_16x16x64_bf16 v[36:39], v[16:19], a[16:23], v3
  v_smfmac_f32_16x16x64_bf16 v[40:43], v[16:19], a[72:79], v3
  v_smfmac_f32_16x16x64_bf16 v[44:47], v[16:19], a[128:135], v3
  buffer_load_dwordx4 v[92:95], v117, s[8:11], s26 offen offset:1024 sc1
  v_smfmac_f32_16x16x64_bf16 v[48:51], v[16:19], a[184:191], v3
  v_smfmac_f32_16x16x64_bf16 v[52:55], v[16:19], a[240:247], v3
  s_waitcnt vmcnt(5)
  v_cmp_eq_u32 vcc, -1, v20
  v_smfmac_f32_16x16x64_bf16 v[56:59], v[16:19], v[160:167], v3
  v_smfmac_f32_16x16x64_bf16 v[60:63], v[16:19], v[216:223], v3
  buffer_load_dwordx4 v[96:99], v2, s[8:11], s24 offen offset:0 sc1
  s_cbranch_vccnz cA_sc1_r3
cA_sc1_c3:
  v_smfmac_f32_16x16x64_bf16 v[36:39], v[20:23], a[24:31], v3
  v_smfmac_f32_16x16x64_bf16 v[40:43], v[20:23], a[80:87], v3
  s_waitcnt vmcnt(3)
  v_max3_u32 v66, v24, v27, v28
  v_smfmac_f32_16x16x64_bf16 v[44:47], v[20:23], a[136:143], v3
  v_max3_u32 v66, v66, v31, v32
  v_smfmac_f32_16x16x64_bf16 v[48:51], v[20:23], a[192:199], v3
  buffer_load_dwordx4 v[100:103], v2, s[8:11], s24 offen offset:1024 sc1
  v_max_u32 v66, v66, v35
  v_smfmac_f32_16x16x64_bf16 v[52:55], v[20:23], a[248:255], v3
  v_cmp_eq_u32 vcc, -1, v66
  v_smfmac_f32_16x16x64_bf16 v[56:59], v[20:23], v[168:175], v3
  v_smfmac_f32_16x16x64_bf16 v[60:63], v[20:23], v[224:231], v3
  s_cbranch_vccnz cA_sc1_r4
cA_sc1_c4:
  v_smfmac_f32_16x16x64_bf16 v[60:63], v[28:31], v[232:239], v3
  buffer_load_dwordx4 v[104:107], v2, s[8:11], s26 offen offset:0 sc1
  v_smfmac_f32_16x16x64_bf16 v[60:63], v[24:27], v[240:247], v3
  v_smfmac_f32_16x16x64_bf16 v[60:63], v[32:35], v[248:255], v3
  v_smfmac_f32_16x16x64_bf16 v[52:55], v[28:31], v[120:127], v3
  v_smfmac_f32_16x16x64_bf16 v[52:55], v[24:27], v[128:135], v3
  buffer_load_dwordx4 v[108:111], v2, s[8:11], s26 offen offset:1024 sc1
  v_smfmac_f32_16x16x64_bf16 v[52:55], v[32:35], v[136:143], v3
  v_cvt_pk_bf16_f32 v63, v62, v63
  v_smfmac_f32_16x16x64_bf16 v[56:59], v[28:31], v[176:183], v3
  v_cvt_pk_bf16_f32 v62, v60, v61
  v_smfmac_f32_16x16x64_bf16 v[56:59], v[24:27], v[184:191], v3
  v_mfma_f32_16x16x32_bf16 v[8:11], v[62:65], v[4:7], 0
  v_cvt_pk_bf16_f32 v55, v54, v55
  v_smfmac_f32_16x16x64_bf16 v[56:59], v[32:35], v[192:199], v3
  v_cvt_pk_bf16_f32 v54, v52, v53
  v_smfmac_f32_16x16x64_bf16 v[36:39], v[28:31], a[32:39], v3
  s_nop 1
  v_cvt_pk_bf16_f32 v78, v8, v9
  v_smfmac_f32_16x16x64_bf16 v[36:39], v[24:27], a[40:47], v3
  v_cvt_pk_bf16_f32 v79, v10, v11
  v_smfmac_f32_16x16x64_bf16 v[36:39], v[32:35], a[48:55], v3
  v_cvt_pk_bf16_f32 v56, v56, v57
  v_smfmac_f32_16x16x64_bf16 v[40:43], v[28:31], a[88:95], v3
  v_cvt_pk_bf16_f32 v57, v58, v59
  v_smfmac_f32_16x16x64_bf16 v[40:43], v[24:27], a[96:103], v3
  v_mfma_f32_16x16x32_bf16 v[16:19], v[54:57], v[4:7], 0
  v_cvt_pk_bf16_f32 v39, v38, v39
  v_smfmac_f32_16x16x64_bf16 v[40:43], v[32:35], a[104:111], v3
  v_cvt_pk_bf16_f32 v38, v36, v37
  v_smfmac_f32_16x16x64_bf16 v[44:47], v[28:31], a[144:151], v3
  s_nop 1
  v_cvt_pk_bf16_f32 v76, v16, v17
  v_smfmac_f32_16x16x64_bf16 v[44:47], v[24:27], a[152:159], v3
  v_cvt_pk_bf16_f32 v77, v18, v19
  v_smfmac_f32_16x16x64_bf16 v[44:47], v[32:35], a[160:167], v3
  v_cvt_pk_bf16_f32 v40, v40, v41
  v_smfmac_f32_16x16x64_bf16 v[48:51], v[28:31], a[200:207], v3
  v_cvt_pk_bf16_f32 v41, v42, v43
  v_smfmac_f32_16x16x64_bf16 v[48:51], v[24:27], a[208:215], v3
  v_smfmac_f32_16x16x64_bf16 v[48:51], v[32:35], a[216:223], v3
  s_waitcnt vmcnt(4)
  v_cvt_pk_bf16_f32 v47, v46, v47
  v_smfmac_f32_16x16x64_bf16 v[68:71], v[76:79], v[80:87], v3
  v_cvt_pk_bf16_f32 v46, v44, v45
  v_mfma_f32_16x16x32_bf16 v[8:11], v[38:41], v[4:7], 0
  s_nop 1
  v_cvt_pk_bf16_f32 v48, v48, v49
  v_cvt_pk_bf16_f32 v49, v50, v51
  s_nop 1
  v_mfma_f32_16x16x32_bf16 v[16:19], v[46:49], v[4:7], 0
  v_smfmac_f32_16x16x64_bf16 v[72:75], v[76:79], v[88:95], v3
  v_cvt_pk_bf16_f32 v20, v8, v9
  v_mfma_f32_16x16x32_bf16 v[52:55], v[30:33], v[76:79], 0
  s_waitcnt vmcnt(0)
  v_cvt_pk_bf16_f32 v21, v10, v11
  v_cvt_pk_bf16_f32 v22, v16, v17
  v_cvt_pk_bf16_f32 v23, v18, v19
  s_nop 1
  v_mfma_f32_16x16x32_bf16 v[52:55], v[12:15], v[20:23], v[52:55]
  v_smfmac_f32_16x16x64_bf16 v[68:71], v[20:23], v[96:103], v3
  v_smfmac_f32_16x16x64_bf16 v[72:75], v[20:23], v[104:111], v3
  s_nop 1
  ds_write_b128 v113, v[52:55]
  s_nop 1
  v_permlane32_swap_b32 v68, v70
  v_permlane32_swap_b32 v69, v71
  v_add_f32 v56, v68, v70
  v_add_f32 v58, v69, v71
  v_permlane32_swap_b32 v72, v74
  v_permlane32_swap_b32 v73, v75
  v_add_f32 v57, v72, v74
  v_add_f32 v59, v73, v75
  ds_write_b128 v2, v[56:59] offset:1024
  v_cmp_u_f32 vcc, v57, v59
  v_mov_b32 v68, 0
  v_mov_b32 v69, 0
  v_mov_b32 v70, 0
  v_mov_b32 v71, 0
  s_cbranch_vccnz cA_sc1_retry
cA_sc1_cont:
  s_add_u32 s24, s24, 28672
  s_add_u32 s26, s26, 28672
  buffer_load_dwordx4 v[80:83], v117, s[8:11], s24 offen offset:0 sc1
  buffer_load_dwordx4 v[84:87], v117, s[8:11], s24 offen offset:1024 sc1
  v_mov_b32 v72, 0
  v_mov_b32 v73, 0
  v_mfma_f32_32x32x16_bf16 v[36:51], v[68:71], v[68:71], 0
  s_waitcnt lgkmcnt(0)
  s_barrier
  ds_read_b64 v[8:9], v114 offset:0
  ds_read_b64 v[10:11], v114 offset:1024
  ds_read_b64 v[12:13], v114 offset:2048
  ds_read_b64 v[14:15], v114 offset:3072
  ds_read2_b32 v[16:17], v115 offset0:0 offset1:64
  ds_read2_b32 v[18:19], v115 offset0:128 offset1:192
  v_mfma_f32_32x32x16_bf16 v[52:67], v[68:71], v[68:71], 0
  s_waitcnt lgkmcnt(0)
  v_pk_add_f32 v[16:17], v[16:17], v[18:19]
  v_pk_add_f32 v[8:9], v[8:9], v[10:11]
  v_pk_add_f32 v[12:13], v[12:13], v[14:15]
  v_add_f32 v20, v16, v17
  v_pk_add_f32 v[8:9], v[8:9], v[12:13]
  v_max_f32 v22, v8, v9
  v_add_f32_dpp v20, v20, v20 row_ror:8 row_mask:0xf bank_mask:0xf
  s_nop 0
  v_max_f32_dpp v22, v22, v22 row_ror:8 row_mask:0xf bank_mask:0xf
  v_max_f32 v22, v22, v20
  buffer_store_dword v112, v116, s[8:11], 0 offen
  s_nop 0
  v_max_f32_dpp v22, v22, v22 quad_perm:[1,0,3,2] row_mask:0xf bank_mask:0xf
  s_nop 1
  v_max_f32_dpp v22, v22, v22 quad_perm:[2,3,0,1] row_mask:0xf bank_mask:0xf
  s_nop 1
  v_max_f32_dpp v22, v22, v22 row_half_mirror row_mask:0xf bank_mask:0xf
  v_pk_add_f32 v[8:9], v[8:9], v[22:23] op_sel_hi:[1,0] neg_lo:[0,1] neg_hi:[0,1]
  v_sub_f32 v20, v20, v22
  v_exp_f32 v8, v8
  v_exp_f32 v9, v9
  v_exp_f32 v20, v20
  v_add_f32 v24, v8, v9
  v_fmac_f32 v24, 0.5, v20
  v_mov_b32_dpp v21, v20 quad_perm:[1,0,3,2] row_mask:0xf bank_mask:0xf
  s_nop 0
  v_add_f32_dpp v24, v24, v24 quad_perm:[1,0,3,2] row_mask:0xf bank_mask:0xf
  s_nop 1
  v_add_f32_dpp v24, v24, v24 quad_perm:[2,3,0,1] row_mask:0xf bank_mask:0xf
  s_nop 1
  v_add_f32_dpp v24, v24, v24 row_half_mirror row_mask:0xf bank_mask:0xf
  s_nop 1
  v_add_f32_dpp v24, v24, v24 row_ror:8 row_mask:0xf bank_mask:0xf
  v_rcp_f32 v24, v24
  s_nop 0
  v_pk_mul_f32 v[8:9], v[8:9], v[24:25] op_sel_hi:[1,0]
  v_cvt_pk_bf16_f32 v8, abs(v8), abs(v9)
  buffer_store_dword v8, v1, s[8:11], s20 offen
  v_pk_mul_f32 v[20:21], v[20:21], v[24:25] op_sel_hi:[1,0]
  v_cvt_pk_bf16_f32 v20, abs(v20), abs(v21)
  buffer_store_dword v20, v118, s[8:11], s20 offen
  v_mov_b32 v74, 0
  v_mov_b32 v75, 0
  s_mov_b32 s19, s18
  s_add_u32 s18, s18, 1
  s_mov_b32 s22, s20
  s_mov_b32 s20, s21
  s_mov_b32 s21, s22
  s_add_u32 s23, s20, 4096
  v_mov_b32 v112, s18
  s_cmp_lt_u32 s19, 63
  s_nop 0
  s_cbranch_scc1 cA_sc1_loop
  s_branch cA_done
cA_sc1_r0:
  s_add_u32 s31, s31, 1
  buffer_load_dwordx4 v[8:11], v2, s[8:11], s20 offen offset:0 sc1
  s_waitcnt vmcnt(0)
  v_cmp_eq_u32 vcc, -1, v8
  v_mov_b32 v36, 0
  v_mov_b32 v37, 0
  v_mov_b32 v38, 0
  v_mov_b32 v39, 0
  v_mov_b32 v40, 0
  v_mov_b32 v41, 0
  v_mov_b32 v42, 0
  v_mov_b32 v43, 0
  v_mov_b32 v44, 0
  v_mov_b32 v45, 0
  v_mov_b32 v46, 0
  v_mov_b32 v47, 0
  v_mov_b32 v48, 0
  v_mov_b32 v49, 0
  v_mov_b32 v50, 0
  v_mov_b32 v51, 0
  s_nop 1
  s_cbranch_vccz cA_sc1_go
  s_add_u32 s30, s30, 1
  s_cmp_lt_u32 s30, 400000
  s_cbranch_scc1 cA_sc1_r0
  s_branch cA_abort
cA_sc1_r1:
  s_add_u32 s31, s31, 1
  buffer_load_dwordx4 v[12:15], v2, s[8:11], s20 offen offset:1024 sc1
  s_waitcnt vmcnt(0)
  v_cmp_eq_u32 vcc, -1, v12
  s_nop 4
  s_cbranch_vccz cA_sc1_c1
  s_add_u32 s30, s30, 1
  s_cmp_lt_u32 s30, 400000
  s_cbranch_scc1 cA_sc1_r1
  s_branch cA_abort
cA_sc1_r2:
  s_add_u32 s31, s31, 1
  buffer_load_dwordx4 v[16:19], v2, s[8:11], s20 offen offset:2048 sc1
  s_waitcnt vmcnt(0)
  v_cmp_eq_u32 vcc, -1, v16
  s_nop 4
  s_cbranch_vccz cA_sc1_c2
  s_add_u32 s30, s30, 1
  s_cmp_lt_u32 s30, 400000
  s_cbranch_scc1 cA_sc1_r2
  s_branch cA_abort
cA_sc1_r3:
  s_add_u32 s31, s31, 1
  buffer_load_dwordx4 v[20:23], v2, s[8:11], s20 offen offset:3072 sc1
  s_waitcnt vmcnt(0)
  v_cmp_eq_u32 vcc, -1, v20
  s_nop 4
  s_cbranch_vccz cA_sc1_c3
  s_add_u32 s30, s30, 1
  s_cmp_lt_u32 s30, 400000
  s_cbranch_scc1 cA_sc1_r3
  s_branch cA_abort
cA_sc1_r4:
  s_add_u32 s31, s31, 1
  buffer_load_dwordx4 v[28:31], v2, s[8:11], s23 offen offset:0 sc1
  buffer_load_dwordx4 v[24:27], v2, s[8:11], s23 offen offset:1024 sc1
  buffer_load_dwordx4 v[32:35], v2, s[8:11], s23 offen offset:2048 sc1
  s_waitcnt vmcnt(0)
  v_max3_u32 v66, v24, v27, v28
  v_max3_u32 v66, v66, v31, v32
  v_max_u32 v66, v66, v35
  v_cmp_eq_u32 vcc, -1, v66
  s_nop 4
  s_cbranch_vccz cA_sc1_c4
  s_add_u32 s30, s30, 1
  s_cmp_lt_u32 s30, 400000
  s_cbranch_scc1 cA_sc1_r4
  s_branch cA_abort
cA_sc1_retry:
  s_cmp_lg_u32 s62, 0
  s_cbranch_scc1 cA_sc1_cont
  s_waitcnt vmcnt(0) lgkmcnt(0)
cA_sc1_rv:
  buffer_load_dwordx4 v[8:11], v2, s[8:11], s20 offen offset:0 sc1
  buffer_load_dwordx4 v[12:15], v2, s[8:11], s20 offen offset:1024 sc1
  buffer_load_dwordx4 v[16:19], v2, s[8:11], s20 offen offset:2048 sc1
  buffer_load_dwordx4 v[20:23], v2, s[8:11], s20 offen offset:3072 sc1
  buffer_load_dwordx4 v[28:31], v2, s[8:11], s23 offen offset:0 sc1
  buffer_load_dwordx4 v[24:27], v2, s[8:11], s23 offen offset:1024 sc1
  buffer_load_dwordx4 v[32:35], v2, s[8:11], s23 offen offset:2048 sc1
  s_waitcnt vmcnt(0)
  v_max3_u32 v66, v8, v9, v10
  v_max3_u32 v66, v66, v11, v12
  v_max3_u32 v66, v66, v13, v14
  v_max3_u32 v66, v66, v15, v16
  v_max3_u32 v66, v66, v17, v18
  v_max3_u32 v66, v66, v19, v20
  v_max3_u32 v66, v66, v21, v22
  v_max3_u32 v66, v66, v23, v24
  v_max3_u32 v66, v66, v25, v26
  v_max3_u32 v66, v66, v27, v28
  v_max3_u32 v66, v66, v29, v30
  v_max3_u32 v66, v66, v31, v32
  v_max3_u32 v66, v66, v33, v34
  v_max_u32 v66, v66, v35
  v_cmp_eq_u32 vcc, -1, v66
  s_cbranch_vccz cA_sc1_rk
  s_add_u32 s30, s30, 1
  s_cmp_lt_u32 s30, 400000
  s_cbranch_scc1 cA_sc1_rv
  s_branch cA_abort
cA_sc1_rk:
  s_mov_b32 s62, 1
  v_mov_b32 v36, 0
  v_mov_b32 v37, 0
  v_mov_b32 v38, 0
  v_mov_b32 v39, 0
  v_mov_b32 v40, 0
  v_mov_b32 v41, 0
  v_mov_b32 v42, 0
  v_mov_b32 v43, 0
  v_mov_b32 v44, 0
  v_mov_b32 v45, 0
  v_mov_b32 v46, 0
  v_mov_b32 v47, 0
  v_mov_b32 v48, 0
  v_mov_b32 v49, 0
  v_mov_b32 v50, 0
  v_mov_b32 v51, 0
  v_mov_b32 v60, 0
  v_mov_b32 v61, 0
  v_mov_b32 v62, 0
  v_mov_b32 v63, 0
  v_mov_b32 v68, 0
  v_mov_b32 v69, 0
  v_mov_b32 v70, 0
  v_mov_b32 v71, 0
  v_mov_b32 v72, 0
  v_mov_b32 v73, 0
  v_mov_b32 v74, 0
  v_mov_b32 v75, 0
  v_mov_b32 v52, 0
  v_mov_b32 v53, 0
  v_mov_b32 v54, 0
  v_mov_b32 v55, 0
  v_mov_b32 v56, 0
  v_mov_b32 v57, 0
  v_mov_b32 v58, 0
  v_mov_b32 v59, 0
  s_add_u32 s31, s31, 0x100
  s_nop 0
  s_branch cA_sc1_go
.p2align 6
cA_sc2_loop:
  s_mov_b32 s30, 0
  s_mov_b32 s62, 0
  s_setprio 3
  s_barrier
  buffer_load_dwordx4 v[8:11], v2, s[8:11], s20 offen offset:0 sc1
  s_setprio 2
  buffer_load_dwordx4 v[12:15], v2, s[8:11], s20 offen offset:1024 sc1
  s_setprio 1
  buffer_load_dwordx4 v[16:19], v2, s[8:11], s20 offen offset:2048 sc1
  s_setprio 0
  buffer_load_dwordx4 v[20:23], v2, s[8:11], s20 offen offset:3072 sc1
cA_sc2_go:
  s_waitcnt vmcnt(3)
  v_smfmac_f32_16x16x64_bf16 v[36:39], v[8:11], a[0:7], v3
  buffer_load_dwordx4 v[24:27], v2, s[8:11], s23 offen offset:0 sc1
  v_cmp_eq_u32 vcc, -1, v8
  v_smfmac_f32_16x16x64_bf16 v[40:43], v[8:11], a[56:63], v3
  v_smfmac_f32_16x16x64_bf16 v[44:47], v[8:11], a[112:119], v3
  buffer_load_dwordx4 v[32:35], v2, s[8:11], s23 offen offset:1024 sc1
  s_cbranch_vccnz cA_sc2_r0
  v_smfmac_f32_16x16x64_bf16 v[48:51], v[8:11], a[168:175], v3
  v_smfmac_f32_16x16x64_bf16 v[52:55], v[8:11], a[224:231], v3
  s_waitcnt vmcnt(4)
  v_cmp_eq_u32 vcc, -1, v12
  v_smfmac_f32_16x16x64_bf16 v[56:59], v[8:11], v[144:151], v3
  buffer_load_dwordx4 v[28:31], v2, s[8:11], s23 offen offset:2048 sc1
  v_smfmac_f32_16x16x64_bf16 v[62:65], v[8:11], v[200:207], v3
  s_cbranch_vccnz cA_sc2_r1
cA_sc2_c1:
  v_smfmac_f32_16x16x64_bf16 v[36:39], v[12:15], a[8:15], v3
  v_smfmac_f32_16x16x64_bf16 v[40:43], v[12:15], a[64:71], v3
  v_smfmac_f32_16x16x64_bf16 v[44:47], v[12:15], a[120:127], v3
  v_smfmac_f32_16x16x64_bf16 v[48:51], v[12:15], a[176:183], v3
  v_smfmac_f32_16x16x64_bf16 v[52:55], v[12:15], a[232:239], v3
  s_waitcnt vmcnt(4)
  v_cmp_eq_u32 vcc, -1, v16
  v_smfmac_f32_16x16x64_bf16 v[56:59], v[12:15], v[152:159], v3
  buffer_load_dwordx4 v[88:91], v117, s[8:11], s26 offen offset:0 sc1
  v_smfmac_f32_16x16x64_bf16 v[62:65], v[12:15], v[208:215], v3
  s_cbranch_vccnz cA_sc2_r2
cA_sc2_c2:
  v_smfmac_f32_16x16x64_bf16 v[36:39], v[16:19], a[16:23], v3
  v_smfmac_f32_16x16x64_bf16 v[40:43], v[16:19], a[72:79], v3
  v_smfmac_f32_16x16x64_bf16 v[44:47], v[16:19], a[128:135], v3
  buffer_load_dwordx4 v[92:95], v117, s[8:11], s26 offen offset:1024 sc1
  v_smfmac_f32_16x16x64_bf16 v[48:51], v[16:19], a[184:191], v3
  v_smfmac_f32_16x16x64_bf16 v[52:55], v[16:19], a[240:247], v3
  s_waitcnt vmcnt(5)
  v_cmp_eq_u32 vcc, -1, v20
  v_smfmac_f32_16x16x64_bf16 v[56:59], v[16:19], v[160:167], v3
  v_smfmac_f32_16x16x64_bf16 v[62:65], v[16:19], v[216:223], v3
  buffer_load_dwordx4 v[96:99], v2, s[8:11], s24 offen offset:0 sc1
  s_cbranch_vccnz cA_sc2_r3
cA_sc2_c3:
  v_smfmac_f32_16x16x64_bf16 v[36:39], v[20:23], a[24:31], v3
  v_smfmac_f32_16x16x64_bf16 v[40:43], v[20:23], a[80:87], v3
  s_waitcnt vmcnt(3)
  v_max3_u32 v66, v24, v27, v28
  v_smfmac_f32_16x16x64_bf16 v[44:47], v[20:23], a[136:143], v3
  v_max3_u32 v66, v66, v31, v32
  v_smfmac_f32_16x16x64_bf16 v[48:51], v[20:23], a[192:199], v3
  buffer_load_dwordx4 v[100:103], v2, s[8:11], s24 offen offset:1024 sc1
  v_max_u32 v66, v66, v35
  v_smfmac_f32_16x16x64_bf16 v[52:55], v[20:23], a[248:255], v3
  v_cmp_eq_u32 vcc, -1, v66
  v_smfmac_f32_16x16x64_bf16 v[56:59], v[20:23], v[168:175], v3
  v_smfmac_f32_16x16x64_bf16 v[62:65], v[20:23], v[224:231], v3
  s_cbranch_vccnz cA_sc2_r4
cA_sc2_c4:
  v_smfmac_f32_16x16x64_bf16 v[62:65], v[24:27], v[232:239], v3
  buffer_load_dwordx4 v[104:107], v2, s[8:11], s26 offen offset:0 sc1
  v_smfmac_f32_16x16x64_bf16 v[62:65], v[32:35], v[240:247], v3
  v_smfmac_f32_16x16x64_bf16 v[62:65], v[28:31], v[248:255], v3
  v_smfmac_f32_16x16x64_bf16 v[52:55], v[24:27], v[120:127], v3
  v_smfmac_f32_16x16x64_bf16 v[52:55], v[32:35], v[128:135], v3
  buffer_load_dwordx4 v[108:111], v2, s[8:11], s26 offen offset:1024 sc1
  v_smfmac_f32_16x16x64_bf16 v[52:55], v[28:31], v[136:143], v3
  v_cvt_pk_bf16_f32 v62, v62, v63
  v_smfmac_f32_16x16x64_bf16 v[56:59], v[24:27], v[176:183], v3
  v_cvt_pk_bf16_f32 v63, v64, v65
  v_smfmac_f32_16x16x64_bf16 v[56:59], v[32:35], v[184:191], v3
  v_mfma_f32_16x16x32_bf16 v[8:11], v[60:63], v[4:7], 0
  v_cvt_pk_bf16_f32 v55, v54, v55
  v_smfmac_f32_16x16x64_bf16 v[56:59], v[28:31], v[192:199], v3
  v_cvt_pk_bf16_f32 v54, v52, v53
  v_smfmac_f32_16x16x64_bf16 v[36:39], v[24:27], a[32:39], v3
  s_nop 1
  v_cvt_pk_bf16_f32 v76, v8, v9
  v_smfmac_f32_16x16x64_bf16 v[36:39], v[32:35], a[40:47], v3
  v_cvt_pk_bf16_f32 v77, v10, v11
  v_smfmac_f32_16x16x64_bf16 v[36:39], v[28:31], a[48:55], v3
  v_cvt_pk_bf16_f32 v56, v56, v57
  v_smfmac_f32_16x16x64_bf16 v[40:43], v[24:27], a[88:95], v3
  v_cvt_pk_bf16_f32 v57, v58, v59
  v_smfmac_f32_16x16x64_bf16 v[40:43], v[32:35], a[96:103], v3
  v_mfma_f32_16x16x32_bf16 v[12:15], v[54:57], v[4:7], 0
  v_cvt_pk_bf16_f32 v39, v38, v39
  v_smfmac_f32_16x16x64_bf16 v[40:43], v[28:31], a[104:111], v3
  v_cvt_pk_bf16_f32 v38, v36, v37
  v_smfmac_f32_16x16x64_bf16 v[44:47], v[24:27], a[144:151], v3
  s_nop 1
  v_cvt_pk_bf16_f32 v78, v12, v13
  v_smfmac_f32_16x16x64_bf16 v[44:47], v[32:35], a[152:159], v3
  v_cvt_pk_bf16_f32 v79, v14, v15
  v_smfmac_f32_16x16x64_bf16 v[44:47], v[28:31], a[160:167], v3
  v_cvt_pk_bf16_f32 v40, v40, v41
  v_smfmac_f32_16x16x64_bf16 v[48:51], v[24:27], a[200:207], v3
  v_cvt_pk_bf16_f32 v41, v42, v43
  v_smfmac_f32_16x16x64_bf16 v[48:51], v[32:35], a[208:215], v3
  v_smfmac_f32_16x16x64_bf16 v[48:51], v[28:31], a[216:223], v3
  s_waitcnt vmcnt(4)
  v_cvt_pk_bf16_f32 v47, v46, v47
  v_smfmac_f32_16x16x64_bf16 v[68:71], v[76:79], v[80:87], v3
  v_cvt_pk_bf16_f32 v46, v44, v45
  v_mfma_f32_16x16x32_bf16 v[8:11], v[38:41], v[4:7], 0
  s_nop 1
  v_cvt_pk_bf16_f32 v48, v48, v49
  v_cvt_pk_bf16_f32 v49, v50, v51
  s_nop 1
  v_mfma_f32_16x16x32_bf16 v[12:15], v[46:49], v[4:7], 0
  v_smfmac_f32_16x16x64_bf16 v[72:75], v[76:79], v[88:95], v3
  v_cvt_pk_bf16_f32 v20, v8, v9
  v_mfma_f32_16x16x32_bf16 v[52:55], v[30:33], v[76:79], 0
  s_waitcnt vmcnt(0)
  v_cvt_pk_bf16_f32 v21, v10, v11
  v_cvt_pk_bf16_f32 v22, v12, v13
  v_cvt_pk_bf16_f32 v23, v14, v15
  s_nop 1
  v_mfma_f32_16x16x32_bf16 v[52:55], v[16:19], v[20:23], v[52:55]
  v_smfmac_f32_16x16x64_bf16 v[68:71], v[20:23], v[96:103], v3
  v_smfmac_f32_16x16x64_bf16 v[72:75], v[20:23], v[104:111], v3
  s_nop 1
  ds_write_b128 v113, v[52:55]
  s_nop 1
  v_permlane32_swap_b32 v68, v70
  v_permlane32_swap_b32 v69, v71
  v_add_f32 v56, v68, v70
  v_add_f32 v58, v69, v71
  v_permlane32_swap_b32 v72, v74
  v_permlane32_swap_b32 v73, v75
  v_add_f32 v57, v72, v74
  v_add_f32 v59, v73, v75
  ds_write_b128 v2, v[56:59] offset:2048
  v_cmp_u_f32 vcc, v57, v59
  v_mov_b32 v68, 0
  v_mov_b32 v69, 0
  v_mov_b32 v70, 0
  v_mov_b32 v71, 0
  s_cbranch_vccnz cA_sc2_retry
cA_sc2_cont:
  s_add_u32 s24, s24, 28672
  s_add_u32 s26, s26, 28672
  buffer_load_dwordx4 v[80:83], v117, s[8:11], s24 offen offset:0 sc1
  buffer_load_dwordx4 v[84:87], v117, s[8:11], s24 offen offset:1024 sc1
  v_mov_b32 v72, 0
  v_mov_b32 v73, 0
  v_mfma_f32_32x32x16_bf16 v[36:51], v[68:71], v[68:71], 0
  s_waitcnt lgkmcnt(0)
  s_barrier
  v_mfma_f32_32x32x16_bf16 v[52:67], v[68:71], v[68:71], 0
  buffer_store_dwordx2 v[118:119], v114, s[8:11], s21 offen
  buffer_store_dwordx2 v[118:119], v115, s[8:11], s21 offen
  s_buffer_load_dword s70, s[8:11], s35
  s_add_u32 s22, s24, 114688
  s_buffer_load_dword s71, s[8:11], s22
  s_mul_i32 s22, s18, 7168
  s_add_u32 s22, s22, 87040
  s_buffer_load_dword s72, s[8:11], s22
  s_add_u32 s35, s35, 458752
  v_mov_b32 v74, 0
  v_mov_b32 v75, 0
  s_mov_b32 s19, s18
  s_add_u32 s18, s18, 1
  s_mov_b32 s22, s20
  s_mov_b32 s20, s21
  s_mov_b32 s21, s22
  s_add_u32 s23, s20, 4096
  s_cmp_lt_u32 s19, 63
  s_cbranch_scc1 cA_sc2_loop
  s_branch cA_done
cA_sc2_r0:
  s_add_u32 s31, s31, 1
  buffer_load_dwordx4 v[8:11], v2, s[8:11], s20 offen offset:0 sc1
  s_waitcnt vmcnt(0)
  v_cmp_eq_u32 vcc, -1, v8
  v_mov_b32 v36, 0
  v_mov_b32 v37, 0
  v_mov_b32 v38, 0
  v_mov_b32 v39, 0
  v_mov_b32 v40, 0
  v_mov_b32 v41, 0
  v_mov_b32 v42, 0
  v_mov_b32 v43, 0
  v_mov_b32 v44, 0
  v_mov_b32 v45, 0
  v_mov_b32 v46, 0
  v_mov_b32 v47, 0
  v_mov_b32 v48, 0
  v_mov_b32 v49, 0
  v_mov_b32 v50, 0
  v_mov_b32 v51, 0
  s_nop 1
  s_cbranch_vccz cA_sc2_go
  s_add_u32 s30, s30, 1
  s_cmp_lt_u32 s30, 400000
  s_cbranch_scc1 cA_sc2_r0
  s_branch cA_abort
cA_sc2_r1:
  s_add_u32 s31, s31, 1
  buffer_load_dwordx4 v[12:15], v2, s[8:11], s20 offen offset:1024 sc1
  s_waitcnt vmcnt(0)
  v_cmp_eq_u32 vcc, -1, v12
  s_nop 4
  s_cbranch_vccz cA_sc2_c1
  s_add_u32 s30, s30, 1
  s_cmp_lt_u32 s30, 400000
  s_cbranch_scc1 cA_sc2_r1
  s_branch cA_abort
cA_sc2_r2:
  s_add_u32 s31, s31, 1
  buffer_load_dwordx4 v[16:19], v2, s[8:11], s20 offen offset:2048 sc1
  s_waitcnt vmcnt(0)
  v_cmp_eq_u32 vcc, -1, v16
  s_nop 4
  s_cbranch_vccz cA_sc2_c2
  s_add_u32 s30, s30, 1
  s_cmp_lt_u32 s30, 400000
  s_cbranch_scc1 cA_sc2_r2
  s_branch cA_abort
cA_sc2_r3:
  s_add_u32 s31, s31, 1
  buffer_load_dwordx4 v[20:23], v2, s[8:11], s20 offen offset:3072 sc1
  s_waitcnt vmcnt(0)
  v_cmp_eq_u32 vcc, -1, v20
  s_nop 4
  s_cbranch_vccz cA_sc2_c3
  s_add_u32 s30, s30, 1
  s_cmp_lt_u32 s30, 400000
  s_cbranch_scc1 cA_sc2_r3
  s_branch cA_abort
cA_sc2_r4:
  s_add_u32 s31, s31, 1
  buffer_load_dwordx4 v[24:27], v2, s[8:11], s23 offen offset:0 sc1
  buffer_load_dwordx4 v[32:35], v2, s[8:11], s23 offen offset:1024 sc1
  buffer_load_dwordx4 v[28:31], v2, s[8:11], s23 offen offset:2048 sc1
  s_waitcnt vmcnt(0)
  v_max3_u32 v66, v24, v27, v28
  v_max3_u32 v66, v66, v31, v32
  v_max_u32 v66, v66, v35
  v_cmp_eq_u32 vcc, -1, v66
  s_nop 4
  s_cbranch_vccz cA_sc2_c4
  s_add_u32 s30, s30, 1
  s_cmp_lt_u32 s30, 400000
  s_cbranch_scc1 cA_sc2_r4
  s_branch cA_abort
cA_sc2_retry:
  s_cmp_lg_u32 s62, 0
  s_cbranch_scc1 cA_sc2_cont
  s_waitcnt vmcnt(0) lgkmcnt(0)
cA_sc2_rv:
  buffer_load_dwordx4 v[8:11], v2, s[8:11], s20 offen offset:0 sc1
  buffer_load_dwordx4 v[12:15], v2, s[8:11], s20 offen offset:1024 sc1
  buffer_load_dwordx4 v[16:19], v2, s[8:11], s20 offen offset:2048 sc1
  buffer_load_dwordx4 v[20:23], v2, s[8:11], s20 offen offset:3072 sc1
  buffer_load_dwordx4 v[24:27], v2, s[8:11], s23 offen offset:0 sc1
  buffer_load_dwordx4 v[32:35], v2, s[8:11], s23 offen offset:1024 sc1
  buffer_load_dwordx4 v[28:31], v2, s[8:11], s23 offen offset:2048 sc1
  s_waitcnt vmcnt(0)
  v_max3_u32 v66, v8, v9, v10
  v_max3_u32 v66, v66, v11, v12
  v_max3_u32 v66, v66, v13, v14
  v_max3_u32 v66, v66, v15, v16
  v_max3_u32 v66, v66, v17, v18
  v_max3_u32 v66, v66, v19, v20
  v_max3_u32 v66, v66, v21, v22
  v_max3_u32 v66, v66, v23, v24
  v_max3_u32 v66, v66, v25, v26
  v_max3_u32 v66, v66, v27, v28
  v_max3_u32 v66, v66, v29, v30
  v_max3_u32 v66, v66, v31, v32
  v_max3_u32 v66, v66, v33, v34
  v_max_u32 v66, v66, v35
  v_cmp_eq_u32 vcc, -1, v66
  s_cbranch_vccz cA_sc2_rk
  s_add_u32 s30, s30, 1
  s_cmp_lt_u32 s30, 400000
  s_cbranch_scc1 cA_sc2_rv
  s_branch cA_abort
cA_sc2_rk:
  s_mov_b32 s62, 1
  v_mov_b32 v36, 0
  v_mov_b32 v37, 0
  v_mov_b32 v38, 0
  v_mov_b32 v39, 0
  v_mov_b32 v40, 0
  v_mov_b32 v41, 0
  v_mov_b32 v42, 0
  v_mov_b32 v43, 0
  v_mov_b32 v44, 0
  v_mov_b32 v45, 0
  v_mov_b32 v46, 0
  v_mov_b32 v47, 0
  v_mov_b32 v48, 0
  v_mov_b32 v49, 0
  v_mov_b32 v50, 0
  v_mov_b32 v51, 0
  v_mov_b32 v62, 0
  v_mov_b32 v63, 0
  v_mov_b32 v64, 0
  v_mov_b32 v65, 0
  v_mov_b32 v68, 0
  v_mov_b32 v69, 0
  v_mov_b32 v70, 0
  v_mov_b32 v71, 0
  v_mov_b32 v72, 0
  v_mov_b32 v73, 0
  v_mov_b32 v74, 0
  v_mov_b32 v75, 0
  v_mov_b32 v52, 0
  v_mov_b32 v53, 0
  v_mov_b32 v54, 0
  v_mov_b32 v55, 0
  v_mov_b32 v56, 0
  v_mov_b32 v57, 0
  v_mov_b32 v58, 0
  v_mov_b32 v59, 0
  s_add_u32 s31, s31, 0x100
  s_nop 0
  s_branch cA_sc2_go
.p2align 6
cA_sc3_loop:
  s_mov_b32 s30, 0
  s_mov_b32 s62, 0
  s_setprio 3
  s_barrier
  buffer_load_dwordx4 v[8:11], v2, s[8:11], s20 offen offset:0 sc1
  s_setprio 2
  buffer_load_dwordx4 v[12:15], v2, s[8:11], s20 offen offset:1024 sc1
  s_setprio 1
  buffer_load_dwordx4 v[16:19], v2, s[8:11], s20 offen offset:2048 sc1
  s_setprio 0
  buffer_load_dwordx4 v[20:23], v2, s[8:11], s20 offen offset:3072 sc1
cA_sc3_go:
  s_waitcnt vmcnt(3)
  v_smfmac_f32_16x16x64_bf16 v[36:39], v[8:11], a[0:7], v3
  buffer_load_dwordx4 v[24:27], v2, s[8:11], s23 offen offset:0 sc1
  v_cmp_eq_u32 vcc, -1, v8
  v_smfmac_f32_16x16x64_bf16 v[40:43], v[8:11], a[56:63], v3
  v_smfmac_f32_16x16x64_bf16 v[44:47], v[8:11], a[112:119], v3
  buffer_load_dwordx4 v[28:31], v2, s[8:11], s23 offen offset:1024 sc1
  s_cbranch_vccnz cA_sc3_r0
  v_smfmac_f32_16x16x64_bf16 v[48:51], v[8:11], a[168:175], v3
  v_smfmac_f32_16x16x64_bf16 v[52:55], v[8:11], a[224:231], v3
  s_waitcnt vmcnt(4)
  v_cmp_eq_u32 vcc, -1, v12
  v_smfmac_f32_16x16x64_bf16 v[56:59], v[8:11], v[144:151], v3
  buffer_load_dwordx4 v[32:35], v2, s[8:11], s23 offen offset:2048 sc1
  v_smfmac_f32_16x16x64_bf16 v[62:65], v[8:11], v[200:207], v3
  s_cbranch_vccnz cA_sc3_r1
cA_sc3_c1:
  v_smfmac_f32_16x16x64_bf16 v[36:39], v[12:15], a[8:15], v3
  v_smfmac_f32_16x16x64_bf16 v[40:43], v[12:15], a[64:71], v3
  v_smfmac_f32_16x16x64_bf16 v[44:47], v[12:15], a[120:127], v3
  v_smfmac_f32_16x16x64_bf16 v[48:51], v[12:15], a[176:183], v3
  v_smfmac_f32_16x16x64_bf16 v[52:55], v[12:15], a[232:239], v3
  s_waitcnt vmcnt(4)
  v_cmp_eq_u32 vcc, -1, v16
  v_smfmac_f32_16x16x64_bf16 v[56:59], v[12:15], v[152:159], v3
  buffer_load_dwordx4 v[88:91], v117, s[8:11], s26 offen offset:0 sc1
  v_smfmac_f32_16x16x64_bf16 v[62:65], v[12:15], v[208:215], v3
  s_cbranch_vccnz cA_sc3_r2
cA_sc3_c2:
  v_smfmac_f32_16x16x64_bf16 v[36:39], v[16:19], a[16:23], v3
  v_smfmac_f32_16x16x64_bf16 v[40:43], v[16:19], a[72:79], v3
  v_smfmac_f32_16x16x64_bf16 v[44:47], v[16:19], a[128:135], v3
  buffer_load_dwordx4 v[92:95], v117, s[8:11], s26 offen offset:1024 sc1
  v_smfmac_f32_16x16x64_bf16 v[48:51], v[16:19], a[184:191], v3
  v_smfmac_f32_16x16x64_bf16 v[52:55], v[16:19], a[240:247], v3
  s_waitcnt vmcnt(5)
  v_cmp_eq_u32 vcc, -1, v20
  v_smfmac_f32_16x16x64_bf16 v[56:59], v[16:19], v[160:167], v3
  v_smfmac_f32_16x16x64_bf16 v[62:65], v[16:19], v[216:223], v3
  buffer_load_dwordx4 v[96:99], v2, s[8:11], s24 offen offset:0 sc1
  s_cbranch_vccnz cA_sc3_r3
cA_sc3_c3:
  v_smfmac_f32_16x16x64_bf16 v[36:39], v[20:23], a[24:31], v3
  v_smfmac_f32_16x16x64_bf16 v[40:43], v[20:23], a[80:87], v3
  s_waitcnt vmcnt(3)
  v_max3_u32 v66, v24, v27, v28
  v_smfmac_f32_16x16x64_bf16 v[44:47], v[20:23], a[136:143], v3
  v_max3_u32 v66, v66, v31, v32
  v_smfmac_f32_16x16x64_bf16 v[48:51], v[20:23], a[192:199], v3
  buffer_load_dwordx4 v[100:103], v2, s[8:11], s24 offen offset:1024 sc1
  v_max_u32 v66, v66, v35
  v_smfmac_f32_16x16x64_bf16 v[52:55], v[20:23], a[248:255], v3
  v_cmp_eq_u32 vcc, -1, v66
  v_smfmac_f32_16x16x64_bf16 v[56:59], v[20:23], v[168:175], v3
  v_smfmac_f32_16x16x64_bf16 v[62:65], v[20:23], v[224:231], v3
  s_cbranch_vccnz cA_sc3_r4
cA_sc3_c4:
  v_smfmac_f32_16x16x64_bf16 v[62:65], v[24:27], v[232:239], v3
  buffer_load_dwordx4 v[104:107], v2, s[8:11], s26 offen offset:0 sc1
  v_smfmac_f32_16x16x64_bf16 v[62:65], v[28:31], v[240:247], v3
  v_smfmac_f32_16x16x64_bf16 v[62:65], v[32:35], v[248:255], v3
  v_smfmac_f32_16x16x64_bf16 v[52:55], v[24:27], v[120:127], v3
  v_smfmac_f32_16x16x64_bf16 v[52:55], v[28:31], v[128:135], v3
  buffer_load_dwordx4 v[108:111], v2, s[8:11], s26 offen offset:1024 sc1
  v_smfmac_f32_16x16x64_bf16 v[52:55], v[32:35], v[136:143], v3
  v_cvt_pk_bf16_f32 v62, v62, v63
  v_smfmac_f32_16x16x64_bf16 v[56:59], v[24:27], v[176:183], v3
  v_cvt_pk_bf16_f32 v63, v64, v65
  v_smfmac_f32_16x16x64_bf16 v[56:59], v[28:31], v[184:191], v3
  v_mfma_f32_16x16x32_bf16 v[8:11], v[60:63], v[4:7], 0
  v_cvt_pk_bf16_f32 v55, v54, v55
  v_smfmac_f32_16x16x64_bf16 v[56:59], v[32:35], v[192:199], v3
  v_cvt_pk_bf16_f32 v54, v52, v53
  v_smfmac_f32_16x16x64_bf16 v[36:39], v[24:27], a[32:39], v3
  s_nop 1
  v_cvt_pk_bf16_f32 v78, v8, v9
  v_smfmac_f32_16x16x64_bf16 v[36:39], v[28:31], a[40:47], v3
  v_cvt_pk_bf16_f32 v79, v10, v11
  v_smfmac_f32_16x16x64_bf16 v[36:39], v[32:35], a[48:55], v3
  v_cvt_pk_bf16_f32 v56, v56, v57
  v_smfmac_f32_16x16x64_bf16 v[40:43], v[24:27], a[88:95], v3
  v_cvt_pk_bf16_f32 v57, v58, v59
  v_smfmac_f32_16x16x64_bf16 v[40:43], v[28:31], a[96:103], v3
  v_mfma_f32_16x16x32_bf16 v[12:15], v[54:57], v[4:7], 0
  v_cvt_pk_bf16_f32 v39, v38, v39
  v_smfmac_f32_16x16x64_bf16 v[40:43], v[32:35], a[104:111], v3
  v_cvt_pk_bf16_f32 v38, v36, v37
  v_smfmac_f32_16x16x64_bf16 v[44:47], v[24:27], a[144:151], v3
  s_nop 1
  v_cvt_pk_bf16_f32 v76, v12, v13
  v_smfmac_f32_16x16x64_bf16 v[44:47], v[28:31], a[152:159], v3
  v_cvt_pk_bf16_f32 v77, v14, v15
  v_smfmac_f32_16x16x64_bf16 v[44:47], v[32:35], a[160:167], v3
  v_cvt_pk_bf16_f32 v40, v40, v41
  v_smfmac_f32_16x16x64_bf16 v[48:51], v[24:27], a[200:207], v3
  v_cvt_pk_bf16_f32 v41, v42, v43
  v_smfmac_f32_16x16x64_bf16 v[48:51], v[28:31], a[208:215], v3
  v_smfmac_f32_16x16x64_bf16 v[48:51], v[32:35], a[216:223], v3
  s_waitcnt vmcnt(4)
  v_cvt_pk_bf16_f32 v47, v46, v47
  v_smfmac_f32_16x16x64_bf16 v[68:71], v[76:79], v[80:87], v3
  v_cvt_pk_bf16_f32 v46, v44, v45
  v_mfma_f32_16x16x32_bf16 v[8:11], v[38:41], v[4:7], 0
  s_nop 1
  v_cvt_pk_bf16_f32 v48, v48, v49
  v_cvt_pk_bf16_f32 v49, v50, v51
  s_nop 1
  v_mfma_f32_16x16x32_bf16 v[12:15], v[46:49], v[4:7], 0
  v_smfmac_f32_16x16x64_bf16 v[72:75], v[76:79], v[88:95], v3
  v_cvt_pk_bf16_f32 v16, v8, v9
  v_mfma_f32_16x16x32_bf16 v[52:55], v[30:33], v[76:79], 0
  s_waitcnt vmcnt(0)
  v_cvt_pk_bf16_f32 v17, v10, v11
  v_cvt_pk_bf16_f32 v18, v12, v13
  v_cvt_pk_bf16_f32 v19, v14, v15
  s_nop 1
  v_mfma_f32_16x16x32_bf16 v[52:55], v[20:23], v[16:19], v[52:55]
  v_smfmac_f32_16x16x64_bf16 v[68:71], v[16:19], v[96:103], v3
  v_smfmac_f32_16x16x64_bf16 v[72:75], v[16:19], v[104:111], v3
  s_nop 1
  ds_write_b128 v113, v[52:55]
  s_nop 1
  v_permlane32_swap_b32 v68, v70
  v_permlane32_swap_b32 v69, v71
  v_add_f32 v56, v68, v70
  v_add_f32 v58, v69, v71
  v_permlane32_swap_b32 v72, v74
  v_permlane32_swap_b32 v73, v75
  v_add_f32 v57, v72, v74
  v_add_f32 v59, v73, v75
  ds_write_b128 v2, v[56:59] offset:3072
  v_cmp_u_f32 vcc, v57, v59
  v_mov_b32 v68, 0
  v_mov_b32 v69, 0
  v_mov_b32 v70, 0
  v_mov_b32 v71, 0
  s_cbranch_vccnz cA_sc3_retry
cA_sc3_cont:
  s_add_u32 s24, s24, 28672
  s_add_u32 s26, s26, 28672
  buffer_load_dwordx4 v[80:83], v117, s[8:11], s24 offen offset:0 sc1
  buffer_load_dwordx4 v[84:87], v117, s[8:11], s24 offen offset:1024 sc1
  v_mov_b32 v72, 0
  v_mov_b32 v73, 0
  v_mfma_f32_16x16x32_bf16 v[62:65], v[68:71], v[68:71], 0
  s_waitcnt lgkmcnt(0)
  s_barrier
  v_mov_b32 v52, 0
  v_mov_b32 v53, 0
  v_mov_b32 v54, 0
  v_mov_b32 v55, 0
  v_mov_b32 v56, 0
  v_mov_b32 v57, 0
  v_mov_b32 v58, 0
  v_mov_b32 v59, 0
  v_mfma_f32_32x32x16_bf16 v[36:51], v[68:71], v[68:71], 0
  v_mov_b32 v74, 0
  v_mov_b32 v75, 0
  s_mov_b32 s19, s18
  s_add_u32 s18, s18, 1
  s_mov_b32 s22, s20
  s_mov_b32 s20, s21
  s_mov_b32 s21, s22
  s_add_u32 s23, s20, 4096
  s_cmp_lt_u32 s19, 63
  s_nop 2
  s_cbranch_scc1 cA_sc3_loop
  s_branch cA_done
cA_sc3_r0:
  s_add_u32 s31, s31, 1
  buffer_load_dwordx4 v[8:11], v2, s[8:11], s20 offen offset:0 sc1
  s_waitcnt vmcnt(0)
  v_cmp_eq_u32 vcc, -1, v8
  v_mov_b32 v36, 0
  v_mov_b32 v37, 0
  v_mov_b32 v38, 0
  v_mov_b32 v39, 0
  v_mov_b32 v40, 0
  v_mov_b32 v41, 0
  v_mov_b32 v42, 0
  v_mov_b32 v43, 0
  v_mov_b32 v44, 0
  v_mov_b32 v45, 0
  v_mov_b32 v46, 0
  v_mov_b32 v47, 0
  v_mov_b32 v48, 0
  v_mov_b32 v49, 0
  v_mov_b32 v50, 0
  v_mov_b32 v51, 0
  s_nop 1
  s_cbranch_vccz cA_sc3_go
  s_add_u32 s30, s30, 1
  s_cmp_lt_u32 s30, 400000
  s_cbranch_scc1 cA_sc3_r0
  s_branch cA_abort
cA_sc3_r1:
  s_add_u32 s31, s31, 1
  buffer_load_dwordx4 v[12:15], v2, s[8:11], s20 offen offset:1024 sc1
  s_waitcnt vmcnt(0)
  v_cmp_eq_u32 vcc, -1, v12
  s_nop 4
  s_cbranch_vccz cA_sc3_c1
  s_add_u32 s30, s30, 1
  s_cmp_lt_u32 s30, 400000
  s_cbranch_scc1 cA_sc3_r1
  s_branch cA_abort
cA_sc3_r2:
  s_add_u32 s31, s31, 1
  buffer_load_dwordx4 v[16:19], v2, s[8:11], s20 offen offset:2048 sc1
  s_waitcnt vmcnt(0)
  v_cmp_eq_u32 vcc, -1, v16
  s_nop 4
  s_cbranch_vccz cA_sc3_c2
  s_add_u32 s30, s30, 1
  s_cmp_lt_u32 s30, 400000
  s_cbranch_scc1 cA_sc3_r2
  s_branch cA_abort
cA_sc3_r3:
  s_add_u32 s31, s31, 1
  buffer_load_dwordx4 v[20:23], v2, s[8:11], s20 offen offset:3072 sc1
  s_waitcnt vmcnt(0)
  v_cmp_eq_u32 vcc, -1, v20
  s_nop 4
  s_cbranch_vccz cA_sc3_c3
  s_add_u32 s30, s30, 1
  s_cmp_lt_u32 s30, 400000
  s_cbranch_scc1 cA_sc3_r3
  s_branch cA_abort
cA_sc3_r4:
  s_add_u32 s31, s31, 1
  buffer_load_dwordx4 v[24:27], v2, s[8:11], s23 offen offset:0 sc1
  buffer_load_dwordx4 v[28:31], v2, s[8:11], s23 offen offset:1024 sc1
  buffer_load_dwordx4 v[32:35], v2, s[8:11], s23 offen offset:2048 sc1
  s_waitcnt vmcnt(0)
  v_max3_u32 v66, v24, v27, v28
  v_max3_u32 v66, v66, v31, v32
  v_max_u32 v66, v66, v35
  v_cmp_eq_u32 vcc, -1, v66
  s_nop 4
  s_cbranch_vccz cA_sc3_c4
  s_add_u32 s30, s30, 1
  s_cmp_lt_u32 s30, 400000
  s_cbranch_scc1 cA_sc3_r4
  s_branch cA_abort
cA_sc3_retry:
  s_cmp_lg_u32 s62, 0
  s_cbranch_scc1 cA_sc3_cont
  s_waitcnt vmcnt(0) lgkmcnt(0)
cA_sc3_rv:
  buffer_load_dwordx4 v[8:11], v2, s[8:11], s20 offen offset:0 sc1
  buffer_load_dwordx4 v[12:15], v2, s[8:11], s20 offen offset:1024 sc1
  buffer_load_dwordx4 v[16:19], v2, s[8:11], s20 offen offset:2048 sc1
  buffer_load_dwordx4 v[20:23], v2, s[8:11], s20 offen offset:3072 sc1
  buffer_load_dwordx4 v[24:27], v2, s[8:11], s23 offen offset:0 sc1
  buffer_load_dwordx4 v[28:31], v2, s[8:11], s23 offen offset:1024 sc1
  buffer_load_dwordx4 v[32:35], v2, s[8:11], s23 offen offset:2048 sc1
  s_waitcnt vmcnt(0)
  v_max3_u32 v66, v8, v9, v10
  v_max3_u32 v66, v66, v11, v12
  v_max3_u32 v66, v66, v13, v14
  v_max3_u32 v66, v66, v15, v16
  v_max3_u32 v66, v66, v17, v18
  v_max3_u32 v66, v66, v19, v20
  v_max3_u32 v66, v66, v21, v22
  v_max3_u32 v66, v66, v23, v24
  v_max3_u32 v66, v66, v25, v26
  v_max3_u32 v66, v66, v27, v28
  v_max3_u32 v66, v66, v29, v30
  v_max3_u32 v66, v66, v31, v32
  v_max3_u32 v66, v66, v33, v34
  v_max_u32 v66, v66, v35
  v_cmp_eq_u32 vcc, -1, v66
  s_cbranch_vccz cA_sc3_rk
  s_add_u32 s30, s30, 1
  s_cmp_lt_u32 s30, 400000
  s_cbranch_scc1 cA_sc3_rv
  s_branch cA_abort
cA_sc3_rk:
  s_mov_b32 s62, 1
  v_mov_b32 v36, 0
  v_mov_b32 v37, 0
  v_mov_b32 v38, 0
  v_mov_b32 v39, 0
  v_mov_b32 v40, 0
  v_mov_b32 v41, 0
  v_mov_b32 v42, 0
  v_mov_b32 v43, 0
  v_mov_b32 v44, 0
  v_mov_b32 v45, 0
  v_mov_b32 v46, 0
  v_mov_b32 v47, 0
  v_mov_b32 v48, 0
  v_mov_b32 v49, 0
  v_mov_b32 v50, 0
  v_mov_b32 v51, 0
  v_mov_b32 v62, 0
  v_mov_b32 v63, 0
  v_mov_b32 v64, 0
  v_mov_b32 v65, 0
  v_mov_b32 v68, 0
  v_mov_b32 v69, 0
  v_mov_b32 v70, 0
  v_mov_b32 v71, 0
  v_mov_b32 v72, 0
  v_mov_b32 v73, 0
  v_mov_b32 v74, 0
  v_mov_b32 v75, 0
  v_mov_b32 v52, 0
  v_mov_b32 v53, 0
  v_mov_b32 v54, 0
  v_mov_b32 v55, 0
  v_mov_b32 v56, 0
  v_mov_b32 v57, 0
  v_mov_b32 v58, 0
  v_mov_b32 v59, 0
  s_add_u32 s31, s31, 0x100
  s_nop 0
  s_branch cA_sc3_go
.p2align 6
cA_va0_loop:
  s_mov_b32 s30, 0
  s_barrier
  buffer_load_dwordx4 v[24:27], v2, s[8:11], s23 offen offset:0 sc1
  buffer_load_dwordx4 v[28:31], v2, s[8:11], s23 offen offset:1024 sc1
  s_barrier
  s_cmp_lt_u32 s19, 60
  s_cbranch_scc1 cA_va0_m1
  buffer_store_dword v160, v1, s[8:11], s38 offen sc1
  s_cmp_lg_u32 s19, 63
  s_cbranch_scc1 cA_va0_m2
  v_min_u32 v64, -2, v64
  v_min_u32 v65, -2, v65
  v_min_u32 v66, -2, v66
  v_min_u32 v67, -2, v67
  v_min_u32 v68, -2, v68
  v_min_u32 v69, -2, v69
  v_min_u32 v70, -2, v70
  v_min_u32 v71, -2, v71
  v_min_u32 v72, -2, v72
  v_min_u32 v73, -2, v73
  v_min_u32 v74, -2, v74
  v_min_u32 v75, -2, v75
  v_min_u32 v76, -2, v76
  v_min_u32 v77, -2, v77
  v_min_u32 v78, -2, v78
  v_min_u32 v79, -2, v79
  buffer_store_dwordx4 v[64:67], v2, s[8:11], s33 offen offset:0 sc1
  buffer_store_dwordx4 v[68:71], v2, s[8:11], s33 offen offset:2048 sc1
  s_add_u32 s33, s33, 4096
  buffer_store_dwordx4 v[72:75], v2, s[8:11], s33 offen offset:0 sc1
  buffer_store_dwordx4 v[76:79], v2, s[8:11], s33 offen offset:2048 sc1
  s_add_u32 s33, s33, 4096
  s_waitcnt vmcnt(5)
  s_branch cA_va0_m3
cA_va0_m1:
  buffer_store_dword v160, v1, s[8:11], s38 offen nt
cA_va0_m2:
  s_add_u32 s22, s25, 0
  buffer_load_dwordx4 v[80:83], v6, s[8:11], s22 offen offset:0 sc1
  buffer_load_dwordx4 v[84:87], v6, s[8:11], s22 offen offset:1792 sc1
  s_add_u32 s22, s25, 3584
  buffer_load_dwordx4 v[88:91], v6, s[8:11], s22 offen offset:0 sc1
  buffer_load_dwordx4 v[92:95], v6, s[8:11], s22 offen offset:1792 sc1
  s_add_u32 s22, s25, 7168
  buffer_load_dwordx4 v[96:99], v6, s[8:11], s22 offen offset:0 sc1
  s_mul_i32 s38, s18, 7168
  s_add_u32 s38, s38, 65536
  s_waitcnt vmcnt(6)
cA_va0_m3:
  ds_write_b128 v2, v[24:27] offset:12288
  ds_write_b128 v2, v[28:31] offset:13312
  v_smfmac_f32_16x16x64_bf16 v[36:39], v[24:27], a[32:39], v3
  buffer_load_dwordx4 v[100:103], v6, s[8:11], s22 offen offset:1792 sc1
  v_smfmac_f32_16x16x64_bf16 v[40:43], v[24:27], a[88:95], v3
  s_add_u32 s22, s25, 10752
  buffer_load_dwordx4 v[104:107], v6, s[8:11], s22 offen offset:0 sc1
  v_smfmac_f32_16x16x64_bf16 v[44:47], v[24:27], a[144:151], v3
  buffer_load_dwordx4 v[108:111], v6, s[8:11], s22 offen offset:1792 sc1
  v_smfmac_f32_16x16x64_bf16 v[48:51], v[24:27], a[200:207], v3
  s_add_u32 s22, s25, 14336
  buffer_load_dwordx4 v[112:115], v6, s[8:11], s22 offen offset:0 sc1
  v_smfmac_f32_16x16x64_bf16 v[52:55], v[24:27], v[176:183], v3
  s_waitcnt lgkmcnt(0)
  s_barrier
  ds_read_b128 v[8:11], v2 offset:8192
  ds_read_b128 v[12:15], v2 offset:9216
  ds_read_b128 v[16:19], v2 offset:10240
  ds_read_b128 v[20:23], v2 offset:11264
  ds_read_b128 v[32:35], v2 offset:14336
  buffer_load_dwordx4 v[116:119], v6, s[8:11], s22 offen offset:1792 sc1
  v_smfmac_f32_16x16x64_bf16 v[56:59], v[24:27], v[232:239], v3
  s_add_u32 s22, s25, 17920
  buffer_load_dwordx4 v[120:123], v6, s[8:11], s22 offen offset:0 sc1
  v_smfmac_f32_16x16x64_bf16 v[36:39], v[28:31], a[40:47], v3
  buffer_load_dwordx4 v[124:127], v6, s[8:11], s22 offen offset:1792 sc1
  v_smfmac_f32_16x16x64_bf16 v[40:43], v[28:31], a[96:103], v3
  s_add_u32 s22, s25, 21504
  buffer_load_dwordx4 v[128:131], v6, s[8:11], s22 offen offset:0 sc1
  v_smfmac_f32_16x16x64_bf16 v[44:47], v[28:31], a[152:159], v3
  buffer_load_dwordx4 v[132:135], v6, s[8:11], s22 offen offset:1792 sc1
  v_smfmac_f32_16x16x64_bf16 v[48:51], v[28:31], a[208:215], v3
  s_add_u32 s22, s25, 25088
  buffer_load_dwordx4 v[136:139], v6, s[8:11], s22 offen offset:0 sc1
  v_smfmac_f32_16x16x64_bf16 v[52:55], v[28:31], v[184:191], v3
  buffer_load_dwordx4 v[140:143], v6, s[8:11], s22 offen offset:1792 sc1
  v_smfmac_f32_16x16x64_bf16 v[56:59], v[28:31], v[240:247], v3
  s_waitcnt lgkmcnt(4)
  v_smfmac_f32_16x16x64_bf16 v[36:39], v[8:11], a[0:7], v3
  s_waitcnt lgkmcnt(3)
  v_smfmac_f32_16x16x64_bf16 v[36:39], v[12:15], a[8:15], v3
  s_waitcnt lgkmcnt(2)
  v_smfmac_f32_16x16x64_bf16 v[36:39], v[16:19], a[16:23], v3
  s_waitcnt lgkmcnt(1)
  v_smfmac_f32_16x16x64_bf16 v[36:39], v[20:23], a[24:31], v3
  s_waitcnt lgkmcnt(0)
  v_smfmac_f32_16x16x64_bf16 v[36:39], v[32:35], a[48:55], v3
  v_smfmac_f32_16x16x64_bf16 v[40:43], v[8:11], a[56:63], v3
  v_smfmac_f32_16x16x64_bf16 v[40:43], v[12:15], a[64:71], v3
  v_smfmac_f32_16x16x64_bf16 v[40:43], v[16:19], a[72:79], v3
  v_permlane32_swap_b32 v36, v38
  v_smfmac_f32_16x16x64_bf16 v[40:43], v[20:23], a[80:87], v3
  v_permlane32_swap_b32 v37, v39
  v_smfmac_f32_16x16x64_bf16 v[40:43], v[32:35], a[104:111], v3
  v_add_f32 v36, v36, v38
  v_smfmac_f32_16x16x64_bf16 v[44:47], v[8:11], a[112:119], v3
  v_add_f32 v37, v37, v39
  v_smfmac_f32_16x16x64_bf16 v[44:47], v[12:15], a[120:127], v3
  v_cmp_u_f32 vcc, v36, v37
  v_smfmac_f32_16x16x64_bf16 v[44:47], v[16:19], a[128:135], v3
  v_cvt_pk_bf16_f32 v38, v36, v37
  v_smfmac_f32_16x16x64_bf16 v[44:47], v[20:23], a[136:143], v3
  ds_write_b32 v152, v38
  s_cbranch_vccnz cA_va0_slow
  v_permlane32_swap_b32 v40, v42
  v_smfmac_f32_16x16x64_bf16 v[44:47], v[32:35], a[160:167], v3
  v_permlane32_swap_b32 v41, v43
  v_smfmac_f32_16x16x64_bf16 v[48:51], v[8:11], a[168:175], v3
  buffer_store_dword v162, v1, s[8:11], s21 offen
  v_add_f32 v40, v40, v42
  v_smfmac_f32_16x16x64_bf16 v[48:51], v[12:15], a[176:183], v3
  v_add_f32 v41, v41, v43
  v_smfmac_f32_16x16x64_bf16 v[48:51], v[16:19], a[184:191], v3
  buffer_load_dword v164, v4, s[8:11], 0 offen sc1
  v_cvt_pk_bf16_f32 v42, v40, v41
  v_smfmac_f32_16x16x64_bf16 v[48:51], v[20:23], a[192:199], v3
  ds_write_b32 v153, v42
  v_permlane32_swap_b32 v44, v46
  v_smfmac_f32_16x16x64_bf16 v[48:51], v[32:35], a[216:223], v3
  v_permlane32_swap_b32 v45, v47
  v_smfmac_f32_16x16x64_bf16 v[52:55], v[8:11], a[224:231], v3
  buffer_load_dword v164, v4, s[8:11], 0 offen sc1
  v_add_f32 v44, v44, v46
  v_smfmac_f32_16x16x64_bf16 v[52:55], v[12:15], a[232:239], v3
  v_add_f32 v45, v45, v47
  v_smfmac_f32_16x16x64_bf16 v[52:55], v[16:19], a[240:247], v3
  v_cvt_pk_bf16_f32 v46, v44, v45
  v_smfmac_f32_16x16x64_bf16 v[52:55], v[20:23], a[248:255], v3
  ds_write_b32 v154, v46
  buffer_load_dword v164, v4, s[8:11], 0 offen sc1
  v_permlane32_swap_b32 v48, v50
  v_smfmac_f32_16x16x64_bf16 v[52:55], v[32:35], v[192:199], v3
  v_permlane32_swap_b32 v49, v51
  v_smfmac_f32_16x16x64_bf16 v[56:59], v[8:11], v[200:207], v3
  v_add_f32 v48, v48, v50
  v_smfmac_f32_16x16x64_bf16 v[56:59], v[12:15], v[208:215], v3
  buffer_load_dword v164, v4, s[8:11], 0 offen sc1
  v_add_f32 v49, v49, v51
  v_smfmac_f32_16x16x64_bf16 v[56:59], v[16:19], v[216:223], v3
  v_cvt_pk_bf16_f32 v50, v48, v49
  v_smfmac_f32_16x16x64_bf16 v[56:59], v[20:23], v[224:231], v3
  ds_write_b32 v155, v50
  v_permlane32_swap_b32 v52, v54
  v_smfmac_f32_16x16x64_bf16 v[56:59], v[32:35], v[248:255], v3
  buffer_load_dword v164, v4, s[8:11], 0 offen sc1
  v_permlane32_swap_b32 v53, v55
  v_add_f32 v52, v52, v54
  v_add_f32 v53, v53, v55
  v_cvt_pk_bf16_f32 v54, v52, v53
  ds_write_b32 v156, v54
  s_nop 1
  v_permlane32_swap_b32 v56, v58
  v_permlane32_swap_b32 v57, v59
  v_add_f32 v56, v56, v58
  v_add_f32 v57, v57, v59
  v_cvt_pk_bf16_f32 v58, v56, v57
  ds_write_b32 v157, v58
cA_va0_t2d:
  s_add_u32 s22, s20, 9216
  s_add_u32 s34, s20, 13312
  s_add_u32 s36, s20, 7168
  s_mov_b32 s37, 0
  v_mov_b32 v48, 0
  v_mov_b32 v49, 0
  v_mov_b32 v50, 0
  v_mov_b32 v51, 0
  v_mov_b32 v163, s18
  s_cmp_eq_u32 s19, 63
  s_waitcnt lgkmcnt(0)
  s_cbranch_scc1 cA_va0_last
  s_setprio 3
cA_va0_fw_l:
  v_cmp_gt_u32 vcc, s18, v164
  buffer_load_dword v164, v4, s[8:11], 0 offen sc1
  s_cbranch_vccz cA_va0_fw_d
  v_cmp_gt_u32 vcc, s18, v164
  buffer_load_dword v164, v4, s[8:11], 0 offen sc1
  s_cbranch_vccz cA_va0_fw_d
  v_cmp_gt_u32 vcc, s18, v164
  buffer_load_dword v164, v4, s[8:11], 0 offen sc1
  s_cbranch_vccz cA_va0_fw_d
  v_cmp_gt_u32 vcc, s18, v164
  buffer_load_dword v164, v4, s[8:11], 0 offen sc1
  s_cbranch_vccz cA_va0_fw_d
  v_cmp_gt_u32 vcc, s18, v164
  buffer_load_dword v164, v4, s[8:11], 0 offen sc1
  s_cbranch_vccz cA_va0_fw_d
  v_cmp_gt_u32 vcc, s18, v164
  buffer_load_dword v164, v4, s[8:11], 0 offen sc1
  s_cbranch_vccz cA_va0_fw_d
  v_cmp_gt_u32 vcc, s18, v164
  buffer_load_dword v164, v4, s[8:11], 0 offen sc1
  s_cbranch_vccz cA_va0_fw_d
  v_cmp_gt_u32 vcc, s18, v164
  buffer_load_dword v164, v4, s[8:11], 0 offen sc1
  s_cbranch_vccz cA_va0_fw_d
  v_cmp_gt_u32 vcc, s18, v164
  buffer_load_dword v164, v4, s[8:11], 0 offen sc1
  s_cbranch_vccz cA_va0_fw_d
  v_cmp_gt_u32 vcc, s18, v164
  buffer_load_dword v164, v4, s[8:11], 0 offen sc1
  s_cbranch_vccz cA_va0_fw_d
  v_cmp_gt_u32 vcc, s18, v164
  buffer_load_dword v164, v4, s[8:11], 0 offen sc1
  s_cbranch_vccz cA_va0_fw_d
  v_cmp_gt_u32 vcc, s18, v164
  buffer_load_dword v164, v4, s[8:11], 0 offen sc1
  s_cbranch_vccz cA_va0_fw_d
  v_cmp_gt_u32 vcc, s18, v164
  buffer_load_dword v164, v4, s[8:11], 0 offen sc1
  s_cbranch_vccz cA_va0_fw_d
  v_cmp_gt_u32 vcc, s18, v164
  buffer_load_dword v164, v4, s[8:11], 0 offen sc1
  s_cbranch_vccz cA_va0_fw_d
  v_cmp_gt_u32 vcc, s18, v164
  buffer_load_dword v164, v4, s[8:11], 0 offen sc1
  s_cbranch_vccz cA_va0_fw_d
  v_cmp_gt_u32 vcc, s18, v164
  buffer_load_dword v164, v4, s[8:11], 0 offen sc1
  s_cbranch_vccz cA_va0_fw_d
  s_waitcnt vmcnt(24)
  s_add_u32 s30, s30, 1
  s_cmp_lt_u32 s30, 400000
  s_cbranch_scc1 cA_va0_fw_l
  s_branch cA_abort
cA_va0_fw_d:
  buffer_load_dwordx4 v[8:11], v2, s[8:11], s22 offen offset:0 sc1
  buffer_load_dwordx4 v[12:15], v2, s[8:11], s22 offen offset:1024 sc1
  buffer_load_dwordx4 v[16:19], v2, s[8:11], s22 offen offset:2048 sc1
  buffer_load_dwordx4 v[20:23], v2, s[8:11], s22 offen offset:3072 sc1
  buffer_load_dwordx4 v[24:27], v2, s[8:11], s34 offen offset:0 sc1
  buffer_load_dwordx4 v[28:31], v2, s[8:11], s34 offen offset:1024 sc1
  buffer_load_dwordx4 v[32:35], v2, s[8:11], s34 offen offset:2048 sc1
  buffer_load_dwordx4 v[36:39], v2, s[8:11], s34 offen offset:3072 sc1
  buffer_load_dwordx4 v[40:43], v2, s[8:11], s36 offen offset:0 sc1
  buffer_load_dwordx4 v[44:47], v2, s[8:11], s36 offen offset:1024 sc1
  s_barrier
  ds_read_b128 v[64:67], v2 offset:0
  ds_read_b128 v[68:71], v2 offset:1024
  ds_read_b128 v[72:75], v2 offset:2048
  ds_read_b128 v[76:79], v2 offset:3072
cA_va0_lp:
  s_waitcnt vmcnt(9)
  v_smfmac_f32_16x16x64_bf16 v[48:51], v[8:11], v[80:87], v3
  s_waitcnt vmcnt(8)
  v_smfmac_f32_16x16x64_bf16 v[48:51], v[12:15], v[88:95], v3
  s_waitcnt vmcnt(7)
  v_smfmac_f32_16x16x64_bf16 v[48:51], v[16:19], v[96:103], v3
  s_waitcnt vmcnt(6)
  v_smfmac_f32_16x16x64_bf16 v[48:51], v[20:23], v[104:111], v3
  s_waitcnt vmcnt(5)
  v_smfmac_f32_16x16x64_bf16 v[48:51], v[24:27], v[112:119], v3
  s_waitcnt vmcnt(4)
  v_smfmac_f32_16x16x64_bf16 v[48:51], v[28:31], v[120:127], v3
  s_waitcnt vmcnt(3)
  v_smfmac_f32_16x16x64_bf16 v[48:51], v[32:35], v[128:135], v3
  s_waitcnt vmcnt(2)
  v_smfmac_f32_16x16x64_bf16 v[48:51], v[36:39], v[136:143], v3
  s_waitcnt vmcnt(1) lgkmcnt(0)
  v_smfmac_f32_16x16x64_bf16 v[48:51], v[40:43], v[64:71], v3
  s_waitcnt vmcnt(0)
  v_smfmac_f32_16x16x64_bf16 v[48:51], v[44:47], v[72:79], v3
  s_nop 7
  v_permlane32_swap_b32 v48, v50
  v_permlane32_swap_b32 v49, v51
  v_pk_add_f32 v[48:49], v[48:49], v[50:51]
  v_cvt_pk_bf16_f32 v160, v48, v49
  v_cmp_u_f32 vcc, v48, v49
  s_nop 0
  v_mov_b32_dpp v161, v160 quad_perm:[1,0,3,2] row_mask:0xf bank_mask:0xf
  v_perm_b32 v160, v161, v160, v5
  v_cndmask_b32 v161, v160, v162, vcc
  buffer_store_dword v161, v1, s[8:11], s21 offen
  s_cbranch_vccnz cA_va0_rp
cA_va0_cont:
  s_setprio 0
  s_cmp_lg_u32 s19, 62
  s_cbranch_scc1 cA_va0_nl
  s_sleep 4
  buffer_store_dword v160, v1, s[8:11], s38 offen sc1
  s_mov_b32 s38, 0x40000000
  s_mov_b32 s25, 0x40000000
cA_va0_nl:
  s_add_u32 s25, s25, 458752
  v_mov_b32 v36, 0
  v_mov_b32 v37, 0
  v_mov_b32 v38, 0
  v_mov_b32 v39, 0
  v_mov_b32 v40, 0
  v_mov_b32 v41, 0
  v_mov_b32 v42, 0
  v_mov_b32 v43, 0
  v_mov_b32 v44, 0
  v_mov_b32 v45, 0
  v_mov_b32 v46, 0
  v_mov_b32 v47, 0
  v_mov_b32 v48, 0
  v_mov_b32 v49, 0
  v_mov_b32 v50, 0
  v_mov_b32 v51, 0
  v_mov_b32 v52, 0
  v_mov_b32 v53, 0
  v_mov_b32 v54, 0
  v_mov_b32 v55, 0
  v_mov_b32 v56, 0
  v_mov_b32 v57, 0
  v_mov_b32 v58, 0
  v_mov_b32 v59, 0
  v_mov_b32 v60, 0
  v_mov_b32 v61, 0
  v_mov_b32 v62, 0
  v_mov_b32 v63, 0
  s_mov_b32 s19, s18
  s_add_u32 s18, s18, 1
  s_mov_b32 s22, s20
  s_mov_b32 s20, s21
  s_mov_b32 s21, s22
  s_add_u32 s23, s20, 4096
  s_branch cA_va0_loop
cA_va0_slow:
  s_waitcnt lgkmcnt(0)
cA_va0_sl1:
  s_add_u32 s31, s31, 0x1000000
  buffer_load_dwordx4 v[8:11], v2, s[8:11], s20 offen offset:0 sc1
  buffer_load_dwordx4 v[12:15], v2, s[8:11], s20 offen offset:1024 sc1
  buffer_load_dwordx4 v[16:19], v2, s[8:11], s20 offen offset:2048 sc1
  buffer_load_dwordx4 v[20:23], v2, s[8:11], s20 offen offset:3072 sc1
  buffer_load_dwordx4 v[24:27], v2, s[8:11], s23 offen offset:0 sc1
  buffer_load_dwordx4 v[28:31], v2, s[8:11], s23 offen offset:1024 sc1
  buffer_load_dwordx4 v[32:35], v2, s[8:11], s23 offen offset:2048 sc1
  s_waitcnt vmcnt(0)
  v_max3_u32 v36, v8, v9, v10
  v_max3_u32 v36, v36, v11, v12
  v_max3_u32 v36, v36, v13, v14
  v_max3_u32 v36, v36, v15, v16
  v_max3_u32 v36, v36, v17, v18
  v_max3_u32 v36, v36, v19, v20
  v_max3_u32 v36, v36, v21, v22
  v_max3_u32 v36, v36, v23, v24
  v_max3_u32 v36, v36, v25, v26
  v_max3_u32 v36, v36, v27, v28
  v_max3_u32 v36, v36, v29, v30
  v_max3_u32 v36, v36, v31, v32
  v_max3_u32 v36, v36, v33, v34
  v_max_u32 v36, v36, v35
  v_cmp_eq_u32 vcc, -1, v36
  s_cbranch_vccz cA_va0_sl2
  s_add_u32 s30, s30, 1
  s_cmp_lt_u32 s30, 400000
  s_cbranch_scc1 cA_va0_sl1
  s_branch cA_abort
cA_va0_sl2:
  v_mov_b32 v36, 0
  v_mov_b32 v37, 0
  v_mov_b32 v38, 0
  v_mov_b32 v39, 0
  v_mov_b32 v40, 0
  v_mov_b32 v41, 0
  v_mov_b32 v42, 0
  v_mov_b32 v43, 0
  v_mov_b32 v44, 0
  v_mov_b32 v45, 0
  v_mov_b32 v46, 0
  v_mov_b32 v47, 0
  v_mov_b32 v48, 0
  v_mov_b32 v49, 0
  v_mov_b32 v50, 0
  v_mov_b32 v51, 0
  v_mov_b32 v52, 0
  v_mov_b32 v53, 0
  v_mov_b32 v54, 0
  v_mov_b32 v55, 0
  v_mov_b32 v56, 0
  v_mov_b32 v57, 0
  v_mov_b32 v58, 0
  v_mov_b32 v59, 0
  v_mov_b32 v60, 0
  v_mov_b32 v61, 0
  v_mov_b32 v62, 0
  v_mov_b32 v63, 0
  buffer_store_dword v162, v1, s[8:11], s21 offen
  v_smfmac_f32_16x16x64_bf16 v[36:39], v[8:11], a[0:7], v3
  v_smfmac_f32_16x16x64_bf16 v[40:43], v[8:11], a[56:63], v3
  v_smfmac_f32_16x16x64_bf16 v[44:47], v[8:11], a[112:119], v3
  v_smfmac_f32_16x16x64_bf16 v[48:51], v[8:11], a[168:175], v3
  v_smfmac_f32_16x16x64_bf16 v[52:55], v[8:11], a[224:231], v3
  v_smfmac_f32_16x16x64_bf16 v[56:59], v[8:11], v[200:207], v3
  v_smfmac_f32_16x16x64_bf16 v[36:39], v[12:15], a[8:15], v3
  v_smfmac_f32_16x16x64_bf16 v[40:43], v[12:15], a[64:71], v3
  v_smfmac_f32_16x16x64_bf16 v[44:47], v[12:15], a[120:127], v3
  v_smfmac_f32_16x16x64_bf16 v[48:51], v[12:15], a[176:183], v3
  v_smfmac_f32_16x16x64_bf16 v[52:55], v[12:15], a[232:239], v3
  v_smfmac_f32_16x16x64_bf16 v[56:59], v[12:15], v[208:215], v3
  v_smfmac_f32_16x16x64_bf16 v[36:39], v[16:19], a[16:23], v3
  v_smfmac_f32_16x16x64_bf16 v[40:43], v[16:19], a[72:79], v3
  v_smfmac_f32_16x16x64_bf16 v[44:47], v[16:19], a[128:135], v3
  v_smfmac_f32_16x16x64_bf16 v[48:51], v[16:19], a[184:191], v3
  v_smfmac_f32_16x16x64_bf16 v[52:55], v[16:19], a[240:247], v3
  v_smfmac_f32_16x16x64_bf16 v[56:59], v[16:19], v[216:223], v3
  v_smfmac_f32_16x16x64_bf16 v[36:39], v[20:23], a[24:31], v3
  v_smfmac_f32_16x16x64_bf16 v[40:43], v[20:23], a[80:87], v3
  v_smfmac_f32_16x16x64_bf16 v[44:47], v[20:23], a[136:143], v3
  v_smfmac_f32_16x16x64_bf16 v[48:51], v[20:23], a[192:199], v3
  v_smfmac_f32_16x16x64_bf16 v[52:55], v[20:23], a[248:255], v3
  v_smfmac_f32_16x16x64_bf16 v[56:59], v[20:23], v[224:231], v3
  v_smfmac_f32_16x16x64_bf16 v[36:39], v[24:27], a[32:39], v3
  v_smfmac_f32_16x16x64_bf16 v[40:43], v[24:27], a[88:95], v3
  v_smfmac_f32_16x16x64_bf16 v[44:47], v[24:27], a[144:151], v3
  v_smfmac_f32_16x16x64_bf16 v[48:51], v[24:27], a[200:207], v3
  v_smfmac_f32_16x16x64_bf16 v[52:55], v[24:27], v[176:183], v3
  v_smfmac_f32_16x16x64_bf16 v[56:59], v[24:27], v[232:239], v3
  v_smfmac_f32_16x16x64_bf16 v[36:39], v[28:31], a[40:47], v3
  v_smfmac_f32_16x16x64_bf16 v[40:43], v[28:31], a[96:103], v3
  v_smfmac_f32_16x16x64_bf16 v[44:47], v[28:31], a[152:159], v3
  v_smfmac_f32_16x16x64_bf16 v[48:51], v[28:31], a[208:215], v3
  v_smfmac_f32_16x16x64_bf16 v[52:55], v[28:31], v[184:191], v3
  v_smfmac_f32_16x16x64_bf16 v[56:59], v[28:31], v[240:247], v3
  v_smfmac_f32_16x16x64_bf16 v[36:39], v[32:35], a[48:55], v3
  v_smfmac_f32_16x16x64_bf16 v[40:43], v[32:35], a[104:111], v3
  v_smfmac_f32_16x16x64_bf16 v[44:47], v[32:35], a[160:167], v3
  v_smfmac_f32_16x16x64_bf16 v[48:51], v[32:35], a[216:223], v3
  v_smfmac_f32_16x16x64_bf16 v[52:55], v[32:35], v[192:199], v3
  v_smfmac_f32_16x16x64_bf16 v[56:59], v[32:35], v[248:255], v3
  v_permlane32_swap_b32 v36, v38
  v_permlane32_swap_b32 v37, v39
  v_add_f32 v36, v36, v38
  v_add_f32 v37, v37, v39
  v_cvt_pk_bf16_f32 v38, v36, v37
  ds_write_b32 v152, v38
  v_permlane32_swap_b32 v40, v42
  v_permlane32_swap_b32 v41, v43
  v_add_f32 v40, v40, v42
  v_add_f32 v41, v41, v43
  v_cvt_pk_bf16_f32 v42, v40, v41
  ds_write_b32 v153, v42
  v_permlane32_swap_b32 v44, v46
  v_permlane32_swap_b32 v45, v47
  v_add_f32 v44, v44, v46
  v_add_f32 v45, v45, v47
  v_cvt_pk_bf16_f32 v46, v44, v45
  ds_write_b32 v154, v46
  v_permlane32_swap_b32 v48, v50
  v_permlane32_swap_b32 v49, v51
  v_add_f32 v48, v48, v50
  v_add_f32 v49, v49, v51
  v_cvt_pk_bf16_f32 v50, v48, v49
  ds_write_b32 v155, v50
  v_permlane32_swap_b32 v52, v54
  v_permlane32_swap_b32 v53, v55
  v_add_f32 v52, v52, v54
  v_add_f32 v53, v53, v55
  v_cvt_pk_bf16_f32 v54, v52, v53
  ds_write_b32 v156, v54
  v_permlane32_swap_b32 v56, v58
  v_permlane32_swap_b32 v57, v59
  v_add_f32 v56, v56, v58
  v_add_f32 v57, v57, v59
  v_cvt_pk_bf16_f32 v58, v56, v57
  ds_write_b32 v157, v58
  buffer_load_dword v164, v4, s[8:11], 0 offen sc1
  buffer_load_dword v164, v4, s[8:11], 0 offen sc1
  buffer_load_dword v164, v4, s[8:11], 0 offen sc1
  buffer_load_dword v164, v4, s[8:11], 0 offen sc1
  buffer_load_dword v164, v4, s[8:11], 0 offen sc1
  s_branch cA_va0_t2d
cA_va0_last:
  s_barrier
  ds_read_b128 v[64:67], v2 offset:0
  ds_read_b128 v[68:71], v2 offset:1024
  ds_read_b128 v[72:75], v2 offset:2048
  ds_read_b128 v[76:79], v2 offset:3072
  s_waitcnt lgkmcnt(0)
  v_min_u32 v64, -2, v64
  v_min_u32 v65, -2, v65
  v_min_u32 v66, -2, v66
  v_min_u32 v67, -2, v67
  v_min_u32 v68, -2, v68
  v_min_u32 v69, -2, v69
  v_min_u32 v70, -2, v70
  v_min_u32 v71, -2, v71
  v_min_u32 v72, -2, v72
  v_min_u32 v73, -2, v73
  v_min_u32 v74, -2, v74
  v_min_u32 v75, -2, v75
  v_min_u32 v76, -2, v76
  v_min_u32 v77, -2, v77
  v_min_u32 v78, -2, v78
  v_min_u32 v79, -2, v79
  buffer_store_dwordx4 v[64:67], v2, s[8:11], s33 offen offset:0 sc1
  buffer_store_dwordx4 v[68:71], v2, s[8:11], s33 offen offset:2048 sc1
  s_add_u32 s33, s33, 4096
  buffer_store_dwordx4 v[72:75], v2, s[8:11], s33 offen offset:0 sc1
  buffer_store_dwordx4 v[76:79], v2, s[8:11], s33 offen offset:2048 sc1
  s_add_u32 s33, s33, 4096
  s_waitcnt vmcnt(0)
  buffer_wbl2 sc1
  s_branch cA_done
cA_va0_rp:
  s_cmp_eq_u32 s37, 0
  s_cbranch_scc1 cA_va0_rv
  v_min_u32 v160, -2, v160
  buffer_store_dword v160, v1, s[8:11], s21 offen
  s_branch cA_va0_cont
cA_va0_rv:
  s_add_u32 s31, s31, 0x10000
  buffer_load_dwordx4 v[8:11], v2, s[8:11], s22 offen offset:0 sc1
  buffer_load_dwordx4 v[12:15], v2, s[8:11], s22 offen offset:1024 sc1
  buffer_load_dwordx4 v[16:19], v2, s[8:11], s22 offen offset:2048 sc1
  buffer_load_dwordx4 v[20:23], v2, s[8:11], s22 offen offset:3072 sc1
  buffer_load_dwordx4 v[24:27], v2, s[8:11], s34 offen offset:0 sc1
  buffer_load_dwordx4 v[28:31], v2, s[8:11], s34 offen offset:1024 sc1
  buffer_load_dwordx4 v[32:35], v2, s[8:11], s34 offen offset:2048 sc1
  buffer_load_dwordx4 v[36:39], v2, s[8:11], s34 offen offset:3072 sc1
  buffer_load_dwordx4 v[40:43], v2, s[8:11], s36 offen offset:0 sc1
  buffer_load_dwordx4 v[44:47], v2, s[8:11], s36 offen offset:1024 sc1
  s_waitcnt vmcnt(0)
  v_max3_u32 v52, v8, v9, v10
  v_max3_u32 v52, v52, v11, v12
  v_max3_u32 v52, v52, v13, v14
  v_max3_u32 v52, v52, v15, v16
  v_max3_u32 v52, v52, v17, v18
  v_max3_u32 v52, v52, v19, v20
  v_max3_u32 v52, v52, v21, v22
  v_max3_u32 v52, v52, v23, v24
  v_max3_u32 v52, v52, v25, v26
  v_max3_u32 v52, v52, v27, v28
  v_max3_u32 v52, v52, v29, v30
  v_max3_u32 v52, v52, v31, v32
  v_max3_u32 v52, v52, v33, v34
  v_max3_u32 v52, v52, v35, v36
  v_max3_u32 v52, v52, v37, v38
  v_max3_u32 v52, v52, v39, v40
  v_max3_u32 v52, v52, v41, v42
  v_max3_u32 v52, v52, v43, v44
  v_max3_u32 v52, v52, v45, v46
  v_max_u32 v52, v52, v47
  v_cmp_eq_u32 vcc, -1, v52
  s_mov_b32 s37, 1
  v_mov_b32 v48, 0
  v_mov_b32 v49, 0
  v_mov_b32 v50, 0
  v_mov_b32 v51, 0
  s_nop 1
  s_cbranch_vccz cA_va0_lp
  s_add_u32 s30, s30, 1
  s_cmp_lt_u32 s30, 400000
  s_cbranch_scc1 cA_va0_rv
  s_branch cA_abort
.p2align 6
cA_va1_loop:
  s_mov_b32 s30, 0
  s_barrier
  buffer_load_dwordx4 v[28:31], v2, s[8:11], s23 offen offset:1024 sc1
  buffer_load_dwordx4 v[32:35], v2, s[8:11], s23 offen offset:2048 sc1
  s_barrier
  s_cmp_lt_u32 s19, 60
  s_cbranch_scc1 cA_va1_m1
  buffer_store_dword v160, v1, s[8:11], s38 offen sc1
  s_cmp_lg_u32 s19, 63
  s_cbranch_scc1 cA_va1_m2
  v_min_u32 v64, -2, v64
  v_min_u32 v65, -2, v65
  v_min_u32 v66, -2, v66
  v_min_u32 v67, -2, v67
  v_min_u32 v68, -2, v68
  v_min_u32 v69, -2, v69
  v_min_u32 v70, -2, v70
  v_min_u32 v71, -2, v71
  v_min_u32 v72, -2, v72
  v_min_u32 v73, -2, v73
  v_min_u32 v74, -2, v74
  v_min_u32 v75, -2, v75
  v_min_u32 v76, -2, v76
  v_min_u32 v77, -2, v77
  v_min_u32 v78, -2, v78
  v_min_u32 v79, -2, v79
  buffer_store_dwordx4 v[64:67], v2, s[8:11], s33 offen offset:0 sc1
  buffer_store_dwordx4 v[68:71], v2, s[8:11], s33 offen offset:2048 sc1
  s_add_u32 s33, s33, 4096
  buffer_store_dwordx4 v[72:75], v2, s[8:11], s33 offen offset:0 sc1
  buffer_store_dwordx4 v[76:79], v2, s[8:11], s33 offen offset:2048 sc1
  s_add_u32 s33, s33, 4096
  s_waitcnt vmcnt(5)
  s_branch cA_va1_m3
cA_va1_m1:
  buffer_store_dword v160, v1, s[8:11], s38 offen nt
cA_va1_m2:
  s_add_u32 s22, s25, 0
  buffer_load_dwordx4 v[80:83], v6, s[8:11], s22 offen offset:0 sc1
  buffer_load_dwordx4 v[84:87], v6, s[8:11], s22 offen offset:1792 sc1
  s_add_u32 s22, s25, 3584
  buffer_load_dwordx4 v[88:91], v6, s[8:11], s22 offen offset:0 sc1
  buffer_load_dwordx4 v[92:95], v6, s[8:11], s22 offen offset:1792 sc1
  s_add_u32 s22, s25, 7168
  buffer_load_dwordx4 v[96:99], v6, s[8:11], s22 offen offset:0 sc1
  s_mul_i32 s38, s18, 7168
  s_add_u32 s38, s38, 65536
  s_waitcnt vmcnt(6)
cA_va1_m3:
  ds_write_b128 v2, v[32:35] offset:14336
  v_smfmac_f32_16x16x64_bf16 v[36:39], v[28:31], a[40:47], v3
  buffer_load_dwordx4 v[100:103], v6, s[8:11], s22 offen offset:1792 sc1
  v_smfmac_f32_16x16x64_bf16 v[40:43], v[28:31], a[96:103], v3
  s_add_u32 s22, s25, 10752
  buffer_load_dwordx4 v[104:107], v6, s[8:11], s22 offen offset:0 sc1
  v_smfmac_f32_16x16x64_bf16 v[44:47], v[28:31], a[152:159], v3
  buffer_load_dwordx4 v[108:111], v6, s[8:11], s22 offen offset:1792 sc1
  v_smfmac_f32_16x16x64_bf16 v[48:51], v[28:31], a[208:215], v3
  s_add_u32 s22, s25, 14336
  buffer_load_dwordx4 v[112:115], v6, s[8:11], s22 offen offset:0 sc1
  v_smfmac_f32_16x16x64_bf16 v[52:55], v[28:31], v[184:191], v3
  s_waitcnt lgkmcnt(0)
  s_barrier
  ds_read_b128 v[8:11], v2 offset:8192
  ds_read_b128 v[12:15], v2 offset:9216
  ds_read_b128 v[16:19], v2 offset:10240
  ds_read_b128 v[20:23], v2 offset:11264
  ds_read_b128 v[24:27], v2 offset:12288
  buffer_load_dwordx4 v[116:119], v6, s[8:11], s22 offen offset:1792 sc1
  v_smfmac_f32_16x16x64_bf16 v[56:59], v[28:31], v[240:247], v3
  s_add_u32 s22, s25, 17920
  buffer_load_dwordx4 v[120:123], v6, s[8:11], s22 offen offset:0 sc1
  v_smfmac_f32_16x16x64_bf16 v[36:39], v[32:35], a[48:55], v3
  buffer_load_dwordx4 v[124:127], v6, s[8:11], s22 offen offset:1792 sc1
  v_smfmac_f32_16x16x64_bf16 v[40:43], v[32:35], a[104:111], v3
  s_add_u32 s22, s25, 21504
  buffer_load_dwordx4 v[128:131], v6, s[8:11], s22 offen offset:0 sc1
  v_smfmac_f32_16x16x64_bf16 v[44:47], v[32:35], a[160:167], v3
  buffer_load_dwordx4 v[132:135], v6, s[8:11], s22 offen offset:1792 sc1
  v_smfmac_f32_16x16x64_bf16 v[48:51], v[32:35], a[216:223], v3
  s_add_u32 s22, s25, 25088
  buffer_load_dwordx4 v[136:139], v6, s[8:11], s22 offen offset:0 sc1
  v_smfmac_f32_16x16x64_bf16 v[52:55], v[32:35], v[192:199], v3
  ds_read_b128 v[64:67], v0 offset:0
  ds_read_b128 v[68:71], v0 offset:1024
  buffer_load_dwordx4 v[140:143], v6, s[8:11], s22 offen offset:1792 sc1
  v_smfmac_f32_16x16x64_bf16 v[56:59], v[32:35], v[248:255], v3
  s_waitcnt lgkmcnt(6)
  ds_read_b128 v[72:75], v0 offset:2048
  ds_read_b128 v[76:79], v0 offset:3072
  v_smfmac_f32_16x16x64_bf16 v[36:39], v[8:11], a[0:7], v3
  s_waitcnt lgkmcnt(7)
  v_smfmac_f32_16x16x64_bf16 v[36:39], v[12:15], a[8:15], v3
  s_waitcnt lgkmcnt(6)
  v_smfmac_f32_16x16x64_bf16 v[36:39], v[16:19], a[16:23], v3
  s_waitcnt lgkmcnt(2)
  v_smfmac_f32_16x16x64_bf16 v[60:63], v[8:11], v[64:71], v3
  s_waitcnt lgkmcnt(5)
  ds_read_b128 v[144:147], v0 offset:4096
  ds_read_b128 v[148:151], v0 offset:5120
  v_smfmac_f32_16x16x64_bf16 v[36:39], v[20:23], a[24:31], v3
  s_waitcnt lgkmcnt(6)
  v_smfmac_f32_16x16x64_bf16 v[36:39], v[24:27], a[32:39], v3
  v_smfmac_f32_16x16x64_bf16 v[40:43], v[8:11], a[56:63], v3
  s_waitcnt lgkmcnt(2)
  v_smfmac_f32_16x16x64_bf16 v[60:63], v[12:15], v[72:79], v3
  ds_read_b128 v[64:67], v0 offset:6144
  ds_read_b128 v[68:71], v0 offset:7168
  v_smfmac_f32_16x16x64_bf16 v[40:43], v[12:15], a[64:71], v3
  v_permlane32_swap_b32 v36, v38
  v_smfmac_f32_16x16x64_bf16 v[40:43], v[16:19], a[72:79], v3
  v_permlane32_swap_b32 v37, v39
  v_smfmac_f32_16x16x64_bf16 v[40:43], v[20:23], a[80:87], v3
  s_waitcnt lgkmcnt(2)
  v_add_f32 v36, v36, v38
  v_smfmac_f32_16x16x64_bf16 v[60:63], v[16:19], v[144:151], v3
  ds_read_b128 v[72:75], v0 offset:8192
  ds_read_b128 v[76:79], v0 offset:9216
  v_add_f32 v37, v37, v39
  v_smfmac_f32_16x16x64_bf16 v[40:43], v[24:27], a[88:95], v3
  v_cmp_u_f32 vcc, v36, v37
  v_smfmac_f32_16x16x64_bf16 v[44:47], v[8:11], a[112:119], v3
  v_cvt_pk_bf16_f32 v38, v36, v37
  v_smfmac_f32_16x16x64_bf16 v[44:47], v[12:15], a[120:127], v3
  ds_write_b32 v152, v38
  s_waitcnt lgkmcnt(3)
  s_cbranch_vccnz cA_va1_slow
  v_permlane32_swap_b32 v40, v42
  v_smfmac_f32_16x16x64_bf16 v[60:63], v[20:23], v[64:71], v3
  ds_read_b128 v[144:147], v0 offset:10240
  ds_read_b128 v[148:151], v0 offset:11264
  v_permlane32_swap_b32 v41, v43
  v_smfmac_f32_16x16x64_bf16 v[44:47], v[16:19], a[128:135], v3
  buffer_store_dword v162, v1, s[8:11], s21 offen
  v_add_f32 v40, v40, v42
  v_smfmac_f32_16x16x64_bf16 v[44:47], v[20:23], a[136:143], v3
  v_add_f32 v41, v41, v43
  v_smfmac_f32_16x16x64_bf16 v[44:47], v[24:27], a[144:151], v3
  s_waitcnt lgkmcnt(3)
  v_cvt_pk_bf16_f32 v42, v40, v41
  v_smfmac_f32_16x16x64_bf16 v[60:63], v[24:27], v[72:79], v3
  ds_write_b32 v153, v42
  ds_read_b128 v[64:67], v0 offset:12288
  ds_read_b128 v[68:71], v0 offset:13312
  v_smfmac_f32_16x16x64_bf16 v[48:51], v[8:11], a[168:175], v3
  s_nop 0
  v_permlane32_swap_b32 v44, v46
  v_smfmac_f32_16x16x64_bf16 v[48:51], v[12:15], a[176:183], v3
  v_permlane32_swap_b32 v45, v47
  v_smfmac_f32_16x16x64_bf16 v[48:51], v[16:19], a[184:191], v3
  s_waitcnt lgkmcnt(3)
  v_add_f32 v44, v44, v46
  v_smfmac_f32_16x16x64_bf16 v[60:63], v[28:31], v[144:151], v3
  v_add_f32 v45, v45, v47
  v_smfmac_f32_16x16x64_bf16 v[48:51], v[20:23], a[192:199], v3
  v_cvt_pk_bf16_f32 v46, v44, v45
  v_smfmac_f32_16x16x64_bf16 v[48:51], v[24:27], a[200:207], v3
  ds_write_b32 v154, v46
  v_smfmac_f32_16x16x64_bf16 v[52:55], v[8:11], a[224:231], v3
  s_waitcnt lgkmcnt(1)
  v_smfmac_f32_16x16x64_bf16 v[60:63], v[32:35], v[64:71], v3
  v_smfmac_f32_16x16x64_bf16 v[52:55], v[12:15], a[232:239], v3
  v_permlane32_swap_b32 v48, v50
  v_smfmac_f32_16x16x64_bf16 v[52:55], v[16:19], a[240:247], v3
  v_permlane32_swap_b32 v49, v51
  v_smfmac_f32_16x16x64_bf16 v[52:55], v[20:23], a[248:255], v3
  v_add_f32 v48, v48, v50
  v_smfmac_f32_16x16x64_bf16 v[52:55], v[24:27], v[176:183], v3
  v_add_f32 v49, v49, v51
  v_smfmac_f32_16x16x64_bf16 v[56:59], v[8:11], v[200:207], v3
  v_cvt_pk_bf16_f32 v50, v48, v49
  v_smfmac_f32_16x16x64_bf16 v[56:59], v[12:15], v[208:215], v3
  ds_write_b32 v155, v50
  v_permlane32_swap_b32 v60, v62
  v_smfmac_f32_16x16x64_bf16 v[56:59], v[16:19], v[216:223], v3
  v_permlane32_swap_b32 v61, v63
  v_smfmac_f32_16x16x64_bf16 v[56:59], v[20:23], v[224:231], v3
  v_add_f32 v60, v60, v62
  v_smfmac_f32_16x16x64_bf16 v[56:59], v[24:27], v[232:239], v3
  v_add_f32 v61, v61, v63
  v_cvt_pk_bf16_f32 v62, v60, v61
  ds_write_b32 v158, v62
  v_permlane32_swap_b32 v52, v54
  v_permlane32_swap_b32 v53, v55
  v_add_f32 v52, v52, v54
  v_add_f32 v53, v53, v55
  v_cvt_pk_bf16_f32 v54, v52, v53
  ds_write_b32 v156, v54
  v_permlane32_swap_b32 v56, v58
  v_permlane32_swap_b32 v57, v59
  v_add_f32 v56, v56, v58
  v_add_f32 v57, v57, v59
  v_cvt_pk_bf16_f32 v58, v56, v57
  ds_write_b32 v157, v58
cA_va1_t2d:
  s_add_u32 s22, s20, 9216
  s_add_u32 s34, s20, 13312
  s_add_u32 s36, s20, 7168
  s_mov_b32 s37, 0
  v_mov_b32 v48, 0
  v_mov_b32 v49, 0
  v_mov_b32 v50, 0
  v_mov_b32 v51, 0
  v_mov_b32 v163, s18
  s_cmp_eq_u32 s19, 63
  s_waitcnt lgkmcnt(0)
  s_cbranch_scc1 cA_va1_last
  s_barrier
  buffer_load_dwordx4 v[8:11], v2, s[8:11], s22 offen offset:0 sc1
  buffer_load_dwordx4 v[12:15], v2, s[8:11], s22 offen offset:1024 sc1
  buffer_load_dwordx4 v[16:19], v2, s[8:11], s22 offen offset:2048 sc1
  buffer_load_dwordx4 v[20:23], v2, s[8:11], s22 offen offset:3072 sc1
  buffer_load_dwordx4 v[24:27], v2, s[8:11], s34 offen offset:0 sc1
  buffer_load_dwordx4 v[28:31], v2, s[8:11], s34 offen offset:1024 sc1
  buffer_load_dwordx4 v[32:35], v2, s[8:11], s34 offen offset:2048 sc1
  buffer_load_dwordx4 v[36:39], v2, s[8:11], s34 offen offset:3072 sc1
  buffer_load_dwordx4 v[40:43], v2, s[8:11], s36 offen offset:0 sc1
  buffer_load_dwordx4 v[44:47], v2, s[8:11], s36 offen offset:1024 sc1
  ds_read_b128 v[64:67], v2 offset:4096
  ds_read_b128 v[68:71], v2 offset:5120
  ds_read_b128 v[72:75], v2 offset:6144
  ds_read_b128 v[76:79], v2 offset:7168
cA_va1_lp:
  s_waitcnt vmcnt(9)
  v_smfmac_f32_16x16x64_bf16 v[48:51], v[8:11], v[80:87], v3
  s_waitcnt vmcnt(8)
  v_smfmac_f32_16x16x64_bf16 v[48:51], v[12:15], v[88:95], v3
  s_waitcnt vmcnt(7)
  v_smfmac_f32_16x16x64_bf16 v[48:51], v[16:19], v[96:103], v3
  v_max3_u32 v55, v8, v12, v16
  s_waitcnt vmcnt(6)
  v_smfmac_f32_16x16x64_bf16 v[48:51], v[20:23], v[104:111], v3
  v_max_u32 v55, v55, v20
  v_cmp_eq_u32 vcc, -1, v55
  s_waitcnt vmcnt(5)
  v_smfmac_f32_16x16x64_bf16 v[48:51], v[24:27], v[112:119], v3
  s_waitcnt vmcnt(4)
  v_smfmac_f32_16x16x64_bf16 v[48:51], v[28:31], v[120:127], v3
  s_cbranch_vccnz cA_va1_rv
  buffer_store_dword v163, v7, s[8:11], 0 offen
  s_waitcnt vmcnt(4)
  v_smfmac_f32_16x16x64_bf16 v[48:51], v[32:35], v[128:135], v3
  s_waitcnt vmcnt(3)
  v_smfmac_f32_16x16x64_bf16 v[48:51], v[36:39], v[136:143], v3
  s_waitcnt vmcnt(2) lgkmcnt(0)
  v_smfmac_f32_16x16x64_bf16 v[48:51], v[40:43], v[64:71], v3
  s_waitcnt vmcnt(1)
  v_smfmac_f32_16x16x64_bf16 v[48:51], v[44:47], v[72:79], v3
  s_nop 7
  v_permlane32_swap_b32 v48, v50
  v_permlane32_swap_b32 v49, v51
  v_pk_add_f32 v[48:49], v[48:49], v[50:51]
  v_cvt_pk_bf16_f32 v160, v48, v49
  v_cmp_u_f32 vcc, v48, v49
  s_nop 0
  v_mov_b32_dpp v161, v160 quad_perm:[1,0,3,2] row_mask:0xf bank_mask:0xf
  v_perm_b32 v160, v161, v160, v5
  v_cndmask_b32 v161, v160, v162, vcc
  buffer_store_dword v161, v1, s[8:11], s21 offen
  s_cbranch_vccnz cA_va1_rp
cA_va1_cont:
  s_cmp_lg_u32 s19, 62
  s_cbranch_scc1 cA_va1_nl
  buffer_store_dword v160, v1, s[8:11], s38 offen sc1
  s_mov_b32 s38, 0x40000000
  s_mov_b32 s25, 0x40000000
cA_va1_nl:
  s_add_u32 s25, s25, 458752
  v_mov_b32 v36, 0
  v_mov_b32 v37, 0
  v_mov_b32 v38, 0
  v_mov_b32 v39, 0
  v_mov_b32 v40, 0
  v_mov_b32 v41, 0
  v_mov_b32 v42, 0
  v_mov_b32 v43, 0
  v_mov_b32 v44, 0
  v_mov_b32 v45, 0
  v_mov_b32 v46, 0
  v_mov_b32 v47, 0
  v_mov_b32 v48, 0
  v_mov_b32 v49, 0
  v_mov_b32 v50, 0
  v_mov_b32 v51, 0
  v_mov_b32 v52, 0
  v_mov_b32 v53, 0
  v_mov_b32 v54, 0
  v_mov_b32 v55, 0
  v_mov_b32 v56, 0
  v_mov_b32 v57, 0
  v_mov_b32 v58, 0
  v_mov_b32 v59, 0
  v_mov_b32 v60, 0
  v_mov_b32 v61, 0
  v_mov_b32 v62, 0
  v_mov_b32 v63, 0
  s_mov_b32 s19, s18
  s_add_u32 s18, s18, 1
  s_mov_b32 s22, s20
  s_mov_b32 s20, s21
  s_mov_b32 s21, s22
  s_add_u32 s23, s20, 4096
  s_branch cA_va1_loop
cA_va1_slow:
  s_waitcnt lgkmcnt(0)
cA_va1_sl1:
  s_add_u32 s31, s31, 0x1000000
  buffer_load_dwordx4 v[8:11], v2, s[8:11], s20 offen offset:0 sc1
  buffer_load_dwordx4 v[12:15], v2, s[8:11], s20 offen offset:1024 sc1
  buffer_load_dwordx4 v[16:19], v2, s[8:11], s20 offen offset:2048 sc1
  buffer_load_dwordx4 v[20:23], v2, s[8:11], s20 offen offset:3072 sc1
  buffer_load_dwordx4 v[24:27], v2, s[8:11], s23 offen offset:0 sc1
  buffer_load_dwordx4 v[28:31], v2, s[8:11], s23 offen offset:1024 sc1
  buffer_load_dwordx4 v[32:35], v2, s[8:11], s23 offen offset:2048 sc1
  s_waitcnt vmcnt(0)
  v_max3_u32 v36, v8, v9, v10
  v_max3_u32 v36, v36, v11, v12
  v_max3_u32 v36, v36, v13, v14
  v_max3_u32 v36, v36, v15, v16
  v_max3_u32 v36, v36, v17, v18
  v_max3_u32 v36, v36, v19, v20
  v_max3_u32 v36, v36, v21, v22
  v_max3_u32 v36, v36, v23, v24
  v_max3_u32 v36, v36, v25, v26
  v_max3_u32 v36, v36, v27, v28
  v_max3_u32 v36, v36, v29, v30
  v_max3_u32 v36, v36, v31, v32
  v_max3_u32 v36, v36, v33, v34
  v_max_u32 v36, v36, v35
  v_cmp_eq_u32 vcc, -1, v36
  s_cbranch_vccz cA_va1_sl2
  s_add_u32 s30, s30, 1
  s_cmp_lt_u32 s30, 400000
  s_cbranch_scc1 cA_va1_sl1
  s_branch cA_abort
cA_va1_sl2:
  v_mov_b32 v36, 0
  v_mov_b32 v37, 0
  v_mov_b32 v38, 0
  v_mov_b32 v39, 0
  v_mov_b32 v40, 0
  v_mov_b32 v41, 0
  v_mov_b32 v42, 0
  v_mov_b32 v43, 0
  v_mov_b32 v44, 0
  v_mov_b32 v45, 0
  v_mov_b32 v46, 0
  v_mov_b32 v47, 0
  v_mov_b32 v48, 0
  v_mov_b32 v49, 0
  v_mov_b32 v50, 0
  v_mov_b32 v51, 0
  v_mov_b32 v52, 0
  v_mov_b32 v53, 0
  v_mov_b32 v54, 0
  v_mov_b32 v55, 0
  v_mov_b32 v56, 0
  v_mov_b32 v57, 0
  v_mov_b32 v58, 0
  v_mov_b32 v59, 0
  v_mov_b32 v60, 0
  v_mov_b32 v61, 0
  v_mov_b32 v62, 0
  v_mov_b32 v63, 0
  buffer_store_dword v162, v1, s[8:11], s21 offen
  ds_read_b128 v[64:67], v0 offset:0
  ds_read_b128 v[68:71], v0 offset:1024
  v_smfmac_f32_16x16x64_bf16 v[36:39], v[8:11], a[0:7], v3
  v_smfmac_f32_16x16x64_bf16 v[40:43], v[8:11], a[56:63], v3
  v_smfmac_f32_16x16x64_bf16 v[44:47], v[8:11], a[112:119], v3
  v_smfmac_f32_16x16x64_bf16 v[48:51], v[8:11], a[168:175], v3
  v_smfmac_f32_16x16x64_bf16 v[52:55], v[8:11], a[224:231], v3
  v_smfmac_f32_16x16x64_bf16 v[56:59], v[8:11], v[200:207], v3
  s_waitcnt lgkmcnt(0)
  v_smfmac_f32_16x16x64_bf16 v[60:63], v[8:11], v[64:71], v3
  ds_read_b128 v[72:75], v0 offset:2048
  ds_read_b128 v[76:79], v0 offset:3072
  v_smfmac_f32_16x16x64_bf16 v[36:39], v[12:15], a[8:15], v3
  v_smfmac_f32_16x16x64_bf16 v[40:43], v[12:15], a[64:71], v3
  v_smfmac_f32_16x16x64_bf16 v[44:47], v[12:15], a[120:127], v3
  v_smfmac_f32_16x16x64_bf16 v[48:51], v[12:15], a[176:183], v3
  v_smfmac_f32_16x16x64_bf16 v[52:55], v[12:15], a[232:239], v3
  v_smfmac_f32_16x16x64_bf16 v[56:59], v[12:15], v[208:215], v3
  s_waitcnt lgkmcnt(0)
  v_smfmac_f32_16x16x64_bf16 v[60:63], v[12:15], v[72:79], v3
  ds_read_b128 v[144:147], v0 offset:4096
  ds_read_b128 v[148:151], v0 offset:5120
  v_smfmac_f32_16x16x64_bf16 v[36:39], v[16:19], a[16:23], v3
  v_smfmac_f32_16x16x64_bf16 v[40:43], v[16:19], a[72:79], v3
  v_smfmac_f32_16x16x64_bf16 v[44:47], v[16:19], a[128:135], v3
  v_smfmac_f32_16x16x64_bf16 v[48:51], v[16:19], a[184:191], v3
  v_smfmac_f32_16x16x64_bf16 v[52:55], v[16:19], a[240:247], v3
  v_smfmac_f32_16x16x64_bf16 v[56:59], v[16:19], v[216:223], v3
  s_waitcnt lgkmcnt(0)
  v_smfmac_f32_16x16x64_bf16 v[60:63], v[16:19], v[144:151], v3
  ds_read_b128 v[64:67], v0 offset:6144
  ds_read_b128 v[68:71], v0 offset:7168
  v_smfmac_f32_16x16x64_bf16 v[36:39], v[20:23], a[24:31], v3
  v_smfmac_f32_16x16x64_bf16 v[40:43], v[20:23], a[80:87], v3
  v_smfmac_f32_16x16x64_bf16 v[44:47], v[20:23], a[136:143], v3
  v_smfmac_f32_16x16x64_bf16 v[48:51], v[20:23], a[192:199], v3
  v_smfmac_f32_16x16x64_bf16 v[52:55], v[20:23], a[248:255], v3
  v_smfmac_f32_16x16x64_bf16 v[56:59], v[20:23], v[224:231], v3
  s_waitcnt lgkmcnt(0)
  v_smfmac_f32_16x16x64_bf16 v[60:63], v[20:23], v[64:71], v3
  ds_read_b128 v[72:75], v0 offset:8192
  ds_read_b128 v[76:79], v0 offset:9216
  v_smfmac_f32_16x16x64_bf16 v[36:39], v[24:27], a[32:39], v3
  v_smfmac_f32_16x16x64_bf16 v[40:43], v[24:27], a[88:95], v3
  v_smfmac_f32_16x16x64_bf16 v[44:47], v[24:27], a[144:151], v3
  v_smfmac_f32_16x16x64_bf16 v[48:51], v[24:27], a[200:207], v3
  v_smfmac_f32_16x16x64_bf16 v[52:55], v[24:27], v[176:183], v3
  v_smfmac_f32_16x16x64_bf16 v[56:59], v[24:27], v[232:239], v3
  s_waitcnt lgkmcnt(0)
  v_smfmac_f32_16x16x64_bf16 v[60:63], v[24:27], v[72:79], v3
  ds_read_b128 v[144:147], v0 offset:10240
  ds_read_b128 v[148:151], v0 offset:11264
  v_smfmac_f32_16x16x64_bf16 v[36:39], v[28:31], a[40:47], v3
  v_smfmac_f32_16x16x64_bf16 v[40:43], v[28:31], a[96:103], v3
  v_smfmac_f32_16x16x64_bf16 v[44:47], v[28:31], a[152:159], v3
  v_smfmac_f32_16x16x64_bf16 v[48:51], v[28:31], a[208:215], v3
  v_smfmac_f32_16x16x64_bf16 v[52:55], v[28:31], v[184:191], v3
  v_smfmac_f32_16x16x64_bf16 v[56:59], v[28:31], v[240:247], v3
  s_waitcnt lgkmcnt(0)
  v_smfmac_f32_16x16x64_bf16 v[60:63], v[28:31], v[144:151], v3
  ds_read_b128 v[64:67], v0 offset:12288
  ds_read_b128 v[68:71], v0 offset:13312
  v_smfmac_f32_16x16x64_bf16 v[36:39], v[32:35], a[48:55], v3
  v_smfmac_f32_16x16x64_bf16 v[40:43], v[32:35], a[104:111], v3
  v_smfmac_f32_16x16x64_bf16 v[44:47], v[32:35], a[160:167], v3
  v_smfmac_f32_16x16x64_bf16 v[48:51], v[32:35], a[216:223], v3
  v_smfmac_f32_16x16x64_bf16 v[52:55], v[32:35], v[192:199], v3
  v_smfmac_f32_16x16x64_bf16 v[56:59], v[32:35], v[248:255], v3
  s_waitcnt lgkmcnt(0)
  v_smfmac_f32_16x16x64_bf16 v[60:63], v[32:35], v[64:71], v3
  v_permlane32_swap_b32 v36, v38
  v_permlane32_swap_b32 v37, v39
  v_add_f32 v36, v36, v38
  v_add_f32 v37, v37, v39
  v_cvt_pk_bf16_f32 v38, v36, v37
  ds_write_b32 v152, v38
  v_permlane32_swap_b32 v40, v42
  v_permlane32_swap_b32 v41, v43
  v_add_f32 v40, v40, v42
  v_add_f32 v41, v41, v43
  v_cvt_pk_bf16_f32 v42, v40, v41
  ds_write_b32 v153, v42
  v_permlane32_swap_b32 v44, v46
  v_permlane32_swap_b32 v45, v47
  v_add_f32 v44, v44, v46
  v_add_f32 v45, v45, v47
  v_cvt_pk_bf16_f32 v46, v44, v45
  ds_write_b32 v154, v46
  v_permlane32_swap_b32 v48, v50
  v_permlane32_swap_b32 v49, v51
  v_add_f32 v48, v48, v50
  v_add_f32 v49, v49, v51
  v_cvt_pk_bf16_f32 v50, v48, v49
  ds_write_b32 v155, v50
  v_permlane32_swap_b32 v52, v54
  v_permlane32_swap_b32 v53, v55
  v_add_f32 v52, v52, v54
  v_add_f32 v53, v53, v55
  v_cvt_pk_bf16_f32 v54, v52, v53
  ds_write_b32 v156, v54
  v_permlane32_swap_b32 v56, v58
  v_permlane32_swap_b32 v57, v59
  v_add_f32 v56, v56, v58
  v_add_f32 v57, v57, v59
  v_cvt_pk_bf16_f32 v58, v56, v57
  ds_write_b32 v157, v58
  v_permlane32_swap_b32 v60, v62
  v_permlane32_swap_b32 v61, v63
  v_add_f32 v60, v60, v62
  v_add_f32 v61, v61, v63
  v_cvt_pk_bf16_f32 v62, v60, v61
  ds_write_b32 v158, v62
  s_branch cA_va1_t2d
cA_va1_last:
  s_barrier
  ds_read_b128 v[64:67], v2 offset:4096
  ds_read_b128 v[68:71], v2 offset:5120
  ds_read_b128 v[72:75], v2 offset:6144
  ds_read_b128 v[76:79], v2 offset:7168
  s_waitcnt lgkmcnt(0)
  v_min_u32 v64, -2, v64
  v_min_u32 v65, -2, v65
  v_min_u32 v66, -2, v66
  v_min_u32 v67, -2, v67
  v_min_u32 v68, -2, v68
  v_min_u32 v69, -2, v69
  v_min_u32 v70, -2, v70
  v_min_u32 v71, -2, v71
  v_min_u32 v72, -2, v72
  v_min_u32 v73, -2, v73
  v_min_u32 v74, -2, v74
  v_min_u32 v75, -2, v75
  v_min_u32 v76, -2, v76
  v_min_u32 v77, -2, v77
  v_min_u32 v78, -2, v78
  v_min_u32 v79, -2, v79
  buffer_store_dwordx4 v[64:67], v2, s[8:11], s33 offen offset:0 sc1
  buffer_store_dwordx4 v[68:71], v2, s[8:11], s33 offen offset:2048 sc1
  s_add_u32 s33, s33, 4096
  buffer_store_dwordx4 v[72:75], v2, s[8:11], s33 offen offset:0 sc1
  buffer_store_dwordx4 v[76:79], v2, s[8:11], s33 offen offset:2048 sc1
  s_add_u32 s33, s33, 4096
  s_waitcnt vmcnt(0)
  buffer_wbl2 sc1
  s_branch cA_done
cA_va1_rp:
  s_cmp_eq_u32 s37, 0
  s_cbranch_scc1 cA_va1_rv
  v_min_u32 v160, -2, v160
  buffer_store_dword v160, v1, s[8:11], s21 offen
  s_branch cA_va1_cont
cA_va1_rv:
  s_add_u32 s31, s31, 0x10000
  buffer_load_dwordx4 v[8:11], v2, s[8:11], s22 offen offset:0 sc1
  buffer_load_dwordx4 v[12:15], v2, s[8:11], s22 offen offset:1024 sc1
  buffer_load_dwordx4 v[16:19], v2, s[8:11], s22 offen offset:2048 sc1
  buffer_load_dwordx4 v[20:23], v2, s[8:11], s22 offen offset:3072 sc1
  buffer_load_dwordx4 v[24:27], v2, s[8:11], s34 offen offset:0 sc1
  buffer_load_dwordx4 v[28:31], v2, s[8:11], s34 offen offset:1024 sc1
  buffer_load_dwordx4 v[32:35], v2, s[8:11], s34 offen offset:2048 sc1
  buffer_load_dwordx4 v[36:39], v2, s[8:11], s34 offen offset:3072 sc1
  buffer_load_dwordx4 v[40:43], v2, s[8:11], s36 offen offset:0 sc1
  buffer_load_dwordx4 v[44:47], v2, s[8:11], s36 offen offset:1024 sc1
  s_waitcnt vmcnt(0)
  v_max3_u32 v52, v8, v9, v10
  v_max3_u32 v52, v52, v11, v12
  v_max3_u32 v52, v52, v13, v14
  v_max3_u32 v52, v52, v15, v16
  v_max3_u32 v52, v52, v17, v18
  v_max3_u32 v52, v52, v19, v20
  v_max3_u32 v52, v52, v21, v22
  v_max3_u32 v52, v52, v23, v24
  v_max3_u32 v52, v52, v25, v26
  v_max3_u32 v52, v52, v27, v28
  v_max3_u32 v52, v52, v29, v30
  v_max3_u32 v52, v52, v31, v32
  v_max3_u32 v52, v52, v33, v34
  v_max3_u32 v52, v52, v35, v36
  v_max3_u32 v52, v52, v37, v38
  v_max3_u32 v52, v52, v39, v40
  v_max3_u32 v52, v52, v41, v42
  v_max3_u32 v52, v52, v43, v44
  v_max3_u32 v52, v52, v45, v46
  v_max_u32 v52, v52, v47
  v_cmp_eq_u32 vcc, -1, v52
  s_mov_b32 s37, 1
  v_mov_b32 v48, 0
  v_mov_b32 v49, 0
  v_mov_b32 v50, 0
  v_mov_b32 v51, 0
  s_nop 1
  s_cbranch_vccz cA_va1_lp
  s_add_u32 s30, s30, 1
  s_cmp_lt_u32 s30, 400000
  s_cbranch_scc1 cA_va1_rv
  s_branch cA_abort
.p2align 6
cA_va2_loop:
  s_mov_b32 s30, 0
cA_va2_fp_l:
  v_cmp_gt_u32 vcc, s19, v96
  buffer_load_dword v96, v119, s[8:11], 0 offen sc1
  s_cbranch_vccz cA_va2_fp_d
  v_cmp_gt_u32 vcc, s19, v96
  buffer_load_dword v96, v119, s[8:11], 0 offen sc1
  s_cbranch_vccz cA_va2_fp_d
  v_cmp_gt_u32 vcc, s19, v96
  buffer_load_dword v96, v119, s[8:11], 0 offen sc1
  s_cbranch_vccz cA_va2_fp_d
  v_cmp_gt_u32 vcc, s19, v96
  buffer_load_dword v96, v119, s[8:11], 0 offen sc1
  s_cbranch_vccz cA_va2_fp_d
  v_cmp_gt_u32 vcc, s19, v96
  buffer_load_dword v96, v119, s[8:11], 0 offen sc1
  s_cbranch_vccz cA_va2_fp_d
  v_cmp_gt_u32 vcc, s19, v96
  buffer_load_dword v96, v119, s[8:11], 0 offen sc1
  s_cbranch_vccz cA_va2_fp_d
  v_cmp_gt_u32 vcc, s19, v96
  buffer_load_dword v96, v119, s[8:11], 0 offen sc1
  s_cbranch_vccz cA_va2_fp_d
  v_cmp_gt_u32 vcc, s19, v96
  buffer_load_dword v96, v119, s[8:11], 0 offen sc1
  s_cbranch_vccz cA_va2_fp_d
  v_cmp_gt_u32 vcc, s19, v96
  buffer_load_dword v96, v119, s[8:11], 0 offen sc1
  s_cbranch_vccz cA_va2_fp_d
  v_cmp_gt_u32 vcc, s19, v96
  buffer_load_dword v96, v119, s[8:11], 0 offen sc1
  s_cbranch_vccz cA_va2_fp_d
  v_cmp_gt_u32 vcc, s19, v96
  buffer_load_dword v96, v119, s[8:11], 0 offen sc1
  s_cbranch_vccz cA_va2_fp_d
  v_cmp_gt_u32 vcc, s19, v96
  buffer_load_dword v96, v119, s[8:11], 0 offen sc1
  s_cbranch_vccz cA_va2_fp_d
  v_cmp_gt_u32 vcc, s19, v96
  buffer_load_dword v96, v119, s[8:11], 0 offen sc1
  s_cbranch_vccz cA_va2_fp_d
  v_cmp_gt_u32 vcc, s19, v96
  buffer_load_dword v96, v119, s[8:11], 0 offen sc1
  s_cbranch_vccz cA_va2_fp_d
  v_cmp_gt_u32 vcc, s19, v96
  buffer_load_dword v96, v119, s[8:11], 0 offen sc1
  s_cbranch_vccz cA_va2_fp_d
  v_cmp_gt_u32 vcc, s19, v96
  buffer_load_dword v96, v119, s[8:11], 0 offen sc1
  s_cbranch_vccz cA_va2_fp_d
  s_waitcnt vmcnt(24)
  s_add_u32 s30, s30, 1
  s_cmp_lt_u32 s30, 400000
  s_cbranch_scc1 cA_va2_fp_l
  s_branch cA_abort
cA_va2_fp_d:
  buffer_load_dwordx4 v[8:11], v2, s[8:11], s20 offen offset:0 sc1
  buffer_load_dwordx4 v[12:15], v2, s[8:11], s20 offen offset:1024 sc1
  s_barrier
  s_barrier
  s_waitcnt vmcnt(0)
  ds_write_b128 v2, v[8:11] offset:8192
  ds_write_b128 v2, v[12:15] offset:9216
  v_smfmac_f32_16x16x64_bf16 v[36:39], v[8:11], a[0:7], v3
  v_smfmac_f32_16x16x64_bf16 v[40:43], v[8:11], a[56:63], v3
  v_smfmac_f32_16x16x64_bf16 v[44:47], v[8:11], a[112:119], v3
  v_smfmac_f32_16x16x64_bf16 v[48:51], v[8:11], a[168:175], v3
  v_smfmac_f32_16x16x64_bf16 v[52:55], v[8:11], a[224:231], v3
  s_waitcnt lgkmcnt(0)
  s_barrier
  ds_read_b128 v[16:19], v2 offset:10240
  ds_read_b128 v[20:23], v2 offset:11264
  ds_read_b128 v[24:27], v2 offset:12288
  ds_read_b128 v[28:31], v2 offset:13312
  ds_read_b128 v[32:35], v2 offset:14336
  v_smfmac_f32_16x16x64_bf16 v[56:59], v[8:11], v[144:151], v3
  v_smfmac_f32_16x16x64_bf16 v[60:63], v[8:11], v[200:207], v3
  v_smfmac_f32_16x16x64_bf16 v[36:39], v[12:15], a[8:15], v3
  v_smfmac_f32_16x16x64_bf16 v[40:43], v[12:15], a[64:71], v3
  v_smfmac_f32_16x16x64_bf16 v[44:47], v[12:15], a[120:127], v3
  v_smfmac_f32_16x16x64_bf16 v[48:51], v[12:15], a[176:183], v3
  v_smfmac_f32_16x16x64_bf16 v[52:55], v[12:15], a[232:239], v3
  v_smfmac_f32_16x16x64_bf16 v[56:59], v[12:15], v[152:159], v3
  ds_read_b128 v[68:71], v0 offset:0
  ds_read_b128 v[72:75], v0 offset:1024
  v_smfmac_f32_16x16x64_bf16 v[60:63], v[12:15], v[208:215], v3
  s_waitcnt lgkmcnt(6)
  ds_read_b128 v[76:79], v0 offset:2048
  ds_read_b128 v[80:83], v0 offset:3072
  v_smfmac_f32_16x16x64_bf16 v[36:39], v[16:19], a[16:23], v3
  s_waitcnt lgkmcnt(7)
  v_smfmac_f32_16x16x64_bf16 v[36:39], v[20:23], a[24:31], v3
  s_waitcnt lgkmcnt(6)
  v_smfmac_f32_16x16x64_bf16 v[36:39], v[24:27], a[32:39], v3
  s_waitcnt lgkmcnt(2)
  v_smfmac_f32_16x16x64_bf16 v[64:67], v[8:11], v[68:75], v3
  s_waitcnt lgkmcnt(5)
  ds_read_b128 v[84:87], v0 offset:4096
  ds_read_b128 v[88:91], v0 offset:5120
  v_smfmac_f32_16x16x64_bf16 v[36:39], v[28:31], a[40:47], v3
  s_waitcnt lgkmcnt(6)
  v_smfmac_f32_16x16x64_bf16 v[36:39], v[32:35], a[48:55], v3
  v_smfmac_f32_16x16x64_bf16 v[40:43], v[16:19], a[72:79], v3
  s_waitcnt lgkmcnt(2)
  v_smfmac_f32_16x16x64_bf16 v[64:67], v[12:15], v[76:83], v3
  ds_read_b128 v[68:71], v0 offset:6144
  ds_read_b128 v[72:75], v0 offset:7168
  v_smfmac_f32_16x16x64_bf16 v[40:43], v[20:23], a[80:87], v3
  v_permlane32_swap_b32 v36, v38
  v_smfmac_f32_16x16x64_bf16 v[40:43], v[24:27], a[88:95], v3
  v_permlane32_swap_b32 v37, v39
  v_smfmac_f32_16x16x64_bf16 v[40:43], v[28:31], a[96:103], v3
  s_waitcnt lgkmcnt(2)
  v_add_f32 v36, v36, v38
  v_smfmac_f32_16x16x64_bf16 v[64:67], v[16:19], v[84:91], v3
  ds_read_b128 v[76:79], v0 offset:8192
  ds_read_b128 v[80:83], v0 offset:9216
  v_add_f32 v37, v37, v39
  v_smfmac_f32_16x16x64_bf16 v[40:43], v[32:35], a[104:111], v3
  v_cmp_u_f32 vcc, v36, v37
  v_smfmac_f32_16x16x64_bf16 v[44:47], v[16:19], a[128:135], v3
  v_cvt_pk_bf16_f32 v38, v36, v37
  v_smfmac_f32_16x16x64_bf16 v[44:47], v[20:23], a[136:143], v3
  ds_write_b32 v104, v38
  s_waitcnt lgkmcnt(3)
  s_cbranch_vccnz cA_va2_slow
  v_permlane32_swap_b32 v40, v42
  v_smfmac_f32_16x16x64_bf16 v[64:67], v[20:23], v[68:75], v3
  ds_read_b128 v[84:87], v0 offset:10240
  ds_read_b128 v[88:91], v0 offset:11264
  v_permlane32_swap_b32 v41, v43
  v_smfmac_f32_16x16x64_bf16 v[44:47], v[24:27], a[144:151], v3
  v_add_f32 v40, v40, v42
  v_smfmac_f32_16x16x64_bf16 v[44:47], v[28:31], a[152:159], v3
  v_add_f32 v41, v41, v43
  v_smfmac_f32_16x16x64_bf16 v[44:47], v[32:35], a[160:167], v3
  s_waitcnt lgkmcnt(3)
  v_cvt_pk_bf16_f32 v42, v40, v41
  v_smfmac_f32_16x16x64_bf16 v[64:67], v[24:27], v[76:83], v3
  ds_write_b32 v105, v42
  ds_read_b128 v[68:71], v0 offset:12288
  ds_read_b128 v[72:75], v0 offset:13312
  v_smfmac_f32_16x16x64_bf16 v[48:51], v[16:19], a[184:191], v3
  s_nop 0
  v_permlane32_swap_b32 v44, v46
  v_smfmac_f32_16x16x64_bf16 v[48:51], v[20:23], a[192:199], v3
  v_permlane32_swap_b32 v45, v47
  v_smfmac_f32_16x16x64_bf16 v[48:51], v[24:27], a[200:207], v3
  s_waitcnt lgkmcnt(3)
  v_add_f32 v44, v44, v46
  v_smfmac_f32_16x16x64_bf16 v[64:67], v[28:31], v[84:91], v3
  v_add_f32 v45, v45, v47
  v_smfmac_f32_16x16x64_bf16 v[48:51], v[28:31], a[208:215], v3
  v_cvt_pk_bf16_f32 v46, v44, v45
  v_smfmac_f32_16x16x64_bf16 v[48:51], v[32:35], a[216:223], v3
  ds_write_b32 v106, v46
  v_smfmac_f32_16x16x64_bf16 v[52:55], v[16:19], a[240:247], v3
  s_waitcnt lgkmcnt(1)
  v_smfmac_f32_16x16x64_bf16 v[64:67], v[32:35], v[68:75], v3
  v_smfmac_f32_16x16x64_bf16 v[52:55], v[20:23], a[248:255], v3
  v_permlane32_swap_b32 v48, v50
  v_smfmac_f32_16x16x64_bf16 v[52:55], v[24:27], v[120:127], v3
  v_permlane32_swap_b32 v49, v51
  v_smfmac_f32_16x16x64_bf16 v[52:55], v[28:31], v[128:135], v3
  v_add_f32 v48, v48, v50
  v_smfmac_f32_16x16x64_bf16 v[52:55], v[32:35], v[136:143], v3
  v_add_f32 v49, v49, v51
  v_smfmac_f32_16x16x64_bf16 v[56:59], v[16:19], v[160:167], v3
  v_cvt_pk_bf16_f32 v50, v48, v49
  v_smfmac_f32_16x16x64_bf16 v[56:59], v[20:23], v[168:175], v3
  ds_write_b32 v107, v50
  v_permlane32_swap_b32 v64, v66
  v_smfmac_f32_16x16x64_bf16 v[56:59], v[24:27], v[176:183], v3
  v_permlane32_swap_b32 v65, v67
  v_smfmac_f32_16x16x64_bf16 v[56:59], v[28:31], v[184:191], v3
  v_add_f32 v64, v64, v66
  v_smfmac_f32_16x16x64_bf16 v[56:59], v[32:35], v[192:199], v3
  v_add_f32 v65, v65, v67
  v_smfmac_f32_16x16x64_bf16 v[60:63], v[16:19], v[216:223], v3
  v_cvt_pk_bf16_f32 v66, v64, v65
  v_smfmac_f32_16x16x64_bf16 v[60:63], v[20:23], v[224:231], v3
  ds_write_b32 v111, v66
  v_permlane32_swap_b32 v52, v54
  v_smfmac_f32_16x16x64_bf16 v[60:63], v[24:27], v[232:239], v3
  v_permlane32_swap_b32 v53, v55
  v_smfmac_f32_16x16x64_bf16 v[60:63], v[28:31], v[240:247], v3
  v_add_f32 v52, v52, v54
  v_smfmac_f32_16x16x64_bf16 v[60:63], v[32:35], v[248:255], v3
  v_add_f32 v53, v53, v55
  v_cvt_pk_bf16_f32 v54, v52, v53
  ds_write_b32 v108, v54
  v_permlane32_swap_b32 v56, v58
  v_permlane32_swap_b32 v57, v59
  v_add_f32 v56, v56, v58
  v_add_f32 v57, v57, v59
  v_cvt_pk_bf16_f32 v58, v56, v57
  ds_write_b32 v109, v58
  v_permlane32_swap_b32 v60, v62
  v_permlane32_swap_b32 v61, v63
  v_add_f32 v60, v60, v62
  v_add_f32 v61, v61, v63
  v_cvt_pk_bf16_f32 v62, v60, v61
  ds_write_b32 v110, v62
cA_va2_t2d:
  v_mov_b32 v117, s18
  s_waitcnt lgkmcnt(0)
  s_barrier
  s_cmp_eq_u32 s19, 63
  s_cbranch_scc1 cA_done
  s_sleep 1
  v_mov_b32 v36, 0
  v_mov_b32 v37, 0
  v_mov_b32 v38, 0
  v_mov_b32 v39, 0
  v_mov_b32 v40, 0
  v_mov_b32 v41, 0
  v_mov_b32 v42, 0
  v_mov_b32 v43, 0
  v_mov_b32 v44, 0
  v_mov_b32 v45, 0
  v_mov_b32 v46, 0
  v_mov_b32 v47, 0
  v_mov_b32 v48, 0
  v_mov_b32 v49, 0
  v_mov_b32 v50, 0
  v_mov_b32 v51, 0
  v_mov_b32 v52, 0
  v_mov_b32 v53, 0
  v_mov_b32 v54, 0
  v_mov_b32 v55, 0
  v_mov_b32 v56, 0
  v_mov_b32 v57, 0
  v_mov_b32 v58, 0
  v_mov_b32 v59, 0
  v_mov_b32 v60, 0
  v_mov_b32 v61, 0
  v_mov_b32 v62, 0
  v_mov_b32 v63, 0
  v_mov_b32 v64, 0
  v_mov_b32 v65, 0
  v_mov_b32 v66, 0
  v_mov_b32 v67, 0
  s_sleep 5
  s_mov_b32 s19, s18
  s_add_u32 s18, s18, 1
  s_mov_b32 s22, s20
  s_mov_b32 s20, s21
  s_mov_b32 s21, s22
  s_add_u32 s23, s20, 4096
  s_branch cA_va2_loop
cA_va2_slow:
  s_waitcnt lgkmcnt(0)
cA_va2_sl1:
  s_add_u32 s31, s31, 0x1000000
  buffer_load_dwordx4 v[8:11], v2, s[8:11], s20 offen offset:0 sc1
  buffer_load_dwordx4 v[12:15], v2, s[8:11], s20 offen offset:1024 sc1
  buffer_load_dwordx4 v[16:19], v2, s[8:11], s20 offen offset:2048 sc1
  buffer_load_dwordx4 v[20:23], v2, s[8:11], s20 offen offset:3072 sc1
  buffer_load_dwordx4 v[24:27], v2, s[8:11], s23 offen offset:0 sc1
  buffer_load_dwordx4 v[28:31], v2, s[8:11], s23 offen offset:1024 sc1
  buffer_load_dwordx4 v[32:35], v2, s[8:11], s23 offen offset:2048 sc1
  s_waitcnt vmcnt(0)
  v_max3_u32 v36, v8, v9, v10
  v_max3_u32 v36, v36, v11, v12
  v_max3_u32 v36, v36, v13, v14
  v_max3_u32 v36, v36, v15, v16
  v_max3_u32 v36, v36, v17, v18
  v_max3_u32 v36, v36, v19, v20
  v_max3_u32 v36, v36, v21, v22
  v_max3_u32 v36, v36, v23, v24
  v_max3_u32 v36, v36, v25, v26
  v_max3_u32 v36, v36, v27, v28
  v_max3_u32 v36, v36, v29, v30
  v_max3_u32 v36, v36, v31, v32
  v_max3_u32 v36, v36, v33, v34
  v_max_u32 v36, v36, v35
  v_cmp_eq_u32 vcc, -1, v36
  s_cbranch_vccz cA_va2_sl2
  s_add_u32 s30, s30, 1
  s_cmp_lt_u32 s30, 400000
  s_cbranch_scc1 cA_va2_sl1
  s_branch cA_abort
cA_va2_sl2:
  v_mov_b32 v36, 0
  v_mov_b32 v37, 0
  v_mov_b32 v38, 0
  v_mov_b32 v39, 0
  v_mov_b32 v40, 0
  v_mov_b32 v41, 0
  v_mov_b32 v42, 0
  v_mov_b32 v43, 0
  v_mov_b32 v44, 0
  v_mov_b32 v45, 0
  v_mov_b32 v46, 0
  v_mov_b32 v47, 0
  v_mov_b32 v48, 0
  v_mov_b32 v49, 0
  v_mov_b32 v50, 0
  v_mov_b32 v51, 0
  v_mov_b32 v52, 0
  v_mov_b32 v53, 0
  v_mov_b32 v54, 0
  v_mov_b32 v55, 0
  v_mov_b32 v56, 0
  v_mov_b32 v57, 0
  v_mov_b32 v58, 0
  v_mov_b32 v59, 0
  v_mov_b32 v60, 0
  v_mov_b32 v61, 0
  v_mov_b32 v62, 0
  v_mov_b32 v63, 0
  v_mov_b32 v64, 0
  v_mov_b32 v65, 0
  v_mov_b32 v66, 0
  v_mov_b32 v67, 0
  ds_read_b128 v[68:71], v0 offset:0
  ds_read_b128 v[72:75], v0 offset:1024
  v_smfmac_f32_16x16x64_bf16 v[36:39], v[8:11], a[0:7], v3
  v_smfmac_f32_16x16x64_bf16 v[40:43], v[8:11], a[56:63], v3
  v_smfmac_f32_16x16x64_bf16 v[44:47], v[8:11], a[112:119], v3
  v_smfmac_f32_16x16x64_bf16 v[48:51], v[8:11], a[168:175], v3
  v_smfmac_f32_16x16x64_bf16 v[52:55], v[8:11], a[224:231], v3
  v_smfmac_f32_16x16x64_bf16 v[56:59], v[8:11], v[144:151], v3
  v_smfmac_f32_16x16x64_bf16 v[60:63], v[8:11], v[200:207], v3
  s_waitcnt lgkmcnt(0)
  v_smfmac_f32_16x16x64_bf16 v[64:67], v[8:11], v[68:75], v3
  ds_read_b128 v[76:79], v0 offset:2048
  ds_read_b128 v[80:83], v0 offset:3072
  v_smfmac_f32_16x16x64_bf16 v[36:39], v[12:15], a[8:15], v3
  v_smfmac_f32_16x16x64_bf16 v[40:43], v[12:15], a[64:71], v3
  v_smfmac_f32_16x16x64_bf16 v[44:47], v[12:15], a[120:127], v3
  v_smfmac_f32_16x16x64_bf16 v[48:51], v[12:15], a[176:183], v3
  v_smfmac_f32_16x16x64_bf16 v[52:55], v[12:15], a[232:239], v3
  v_smfmac_f32_16x16x64_bf16 v[56:59], v[12:15], v[152:159], v3
  v_smfmac_f32_16x16x64_bf16 v[60:63], v[12:15], v[208:215], v3
  s_waitcnt lgkmcnt(0)
  v_smfmac_f32_16x16x64_bf16 v[64:67], v[12:15], v[76:83], v3
  ds_read_b128 v[84:87], v0 offset:4096
  ds_read_b128 v[88:91], v0 offset:5120
  v_smfmac_f32_16x16x64_bf16 v[36:39], v[16:19], a[16:23], v3
  v_smfmac_f32_16x16x64_bf16 v[40:43], v[16:19], a[72:79], v3
  v_smfmac_f32_16x16x64_bf16 v[44:47], v[16:19], a[128:135], v3
  v_smfmac_f32_16x16x64_bf16 v[48:51], v[16:19], a[184:191], v3
  v_smfmac_f32_16x16x64_bf16 v[52:55], v[16:19], a[240:247], v3
  v_smfmac_f32_16x16x64_bf16 v[56:59], v[16:19], v[160:167], v3
  v_smfmac_f32_16x16x64_bf16 v[60:63], v[16:19], v[216:223], v3
  s_waitcnt lgkmcnt(0)
  v_smfmac_f32_16x16x64_bf16 v[64:67], v[16:19], v[84:91], v3
  ds_read_b128 v[68:71], v0 offset:6144
  ds_read_b128 v[72:75], v0 offset:7168
  v_smfmac_f32_16x16x64_bf16 v[36:39], v[20:23], a[24:31], v3
  v_smfmac_f32_16x16x64_bf16 v[40:43], v[20:23], a[80:87], v3
  v_smfmac_f32_16x16x64_bf16 v[44:47], v[20:23], a[136:143], v3
  v_smfmac_f32_16x16x64_bf16 v[48:51], v[20:23], a[192:199], v3
  v_smfmac_f32_16x16x64_bf16 v[52:55], v[20:23], a[248:255], v3
  v_smfmac_f32_16x16x64_bf16 v[56:59], v[20:23], v[168:175], v3
  v_smfmac_f32_16x16x64_bf16 v[60:63], v[20:23], v[224:231], v3
  s_waitcnt lgkmcnt(0)
  v_smfmac_f32_16x16x64_bf16 v[64:67], v[20:23], v[68:75], v3
  ds_read_b128 v[76:79], v0 offset:8192
  ds_read_b128 v[80:83], v0 offset:9216
  v_smfmac_f32_16x16x64_bf16 v[36:39], v[24:27], a[32:39], v3
  v_smfmac_f32_16x16x64_bf16 v[40:43], v[24:27], a[88:95], v3
  v_smfmac_f32_16x16x64_bf16 v[44:47], v[24:27], a[144:151], v3
  v_smfmac_f32_16x16x64_bf16 v[48:51], v[24:27], a[200:207], v3
  v_smfmac_f32_16x16x64_bf16 v[52:55], v[24:27], v[120:127], v3
  v_smfmac_f32_16x16x64_bf16 v[56:59], v[24:27], v[176:183], v3
  v_smfmac_f32_16x16x64_bf16 v[60:63], v[24:27], v[232:239], v3
  s_waitcnt lgkmcnt(0)
  v_smfmac_f32_16x16x64_bf16 v[64:67], v[24:27], v[76:83], v3
  ds_read_b128 v[84:87], v0 offset:10240
  ds_read_b128 v[88:91], v0 offset:11264
  v_smfmac_f32_16x16x64_bf16 v[36:39], v[28:31], a[40:47], v3
  v_smfmac_f32_16x16x64_bf16 v[40:43], v[28:31], a[96:103], v3
  v_smfmac_f32_16x16x64_bf16 v[44:47], v[28:31], a[152:159], v3
  v_smfmac_f32_16x16x64_bf16 v[48:51], v[28:31], a[208:215], v3
  v_smfmac_f32_16x16x64_bf16 v[52:55], v[28:31], v[128:135], v3
  v_smfmac_f32_16x16x64_bf16 v[56:59], v[28:31], v[184:191], v3
  v_smfmac_f32_16x16x64_bf16 v[60:63], v[28:31], v[240:247], v3
  s_waitcnt lgkmcnt(0)
  v_smfmac_f32_16x16x64_bf16 v[64:67], v[28:31], v[84:91], v3
  ds_read_b128 v[68:71], v0 offset:12288
  ds_read_b128 v[72:75], v0 offset:13312
  v_smfmac_f32_16x16x64_bf16 v[36:39], v[32:35], a[48:55], v3
  v_smfmac_f32_16x16x64_bf16 v[40:43], v[32:35], a[104:111], v3
  v_smfmac_f32_16x16x64_bf16 v[44:47], v[32:35], a[160:167], v3
  v_smfmac_f32_16x16x64_bf16 v[48:51], v[32:35], a[216:223], v3
  v_smfmac_f32_16x16x64_bf16 v[52:55], v[32:35], v[136:143], v3
  v_smfmac_f32_16x16x64_bf16 v[56:59], v[32:35], v[192:199], v3
  v_smfmac_f32_16x16x64_bf16 v[60:63], v[32:35], v[248:255], v3
  s_waitcnt lgkmcnt(0)
  v_smfmac_f32_16x16x64_bf16 v[64:67], v[32:35], v[68:75], v3
  v_permlane32_swap_b32 v36, v38
  v_permlane32_swap_b32 v37, v39
  v_add_f32 v36, v36, v38
  v_add_f32 v37, v37, v39
  v_cvt_pk_bf16_f32 v38, v36, v37
  ds_write_b32 v104, v38
  v_permlane32_swap_b32 v40, v42
  v_permlane32_swap_b32 v41, v43
  v_add_f32 v40, v40, v42
  v_add_f32 v41, v41, v43
  v_cvt_pk_bf16_f32 v42, v40, v41
  ds_write_b32 v105, v42
  v_permlane32_swap_b32 v44, v46
  v_permlane32_swap_b32 v45, v47
  v_add_f32 v44, v44, v46
  v_add_f32 v45, v45, v47
  v_cvt_pk_bf16_f32 v46, v44, v45
  ds_write_b32 v106, v46
  v_permlane32_swap_b32 v48, v50
  v_permlane32_swap_b32 v49, v51
  v_add_f32 v48, v48, v50
  v_add_f32 v49, v49, v51
  v_cvt_pk_bf16_f32 v50, v48, v49
  ds_write_b32 v107, v50
  v_permlane32_swap_b32 v52, v54
  v_permlane32_swap_b32 v53, v55
  v_add_f32 v52, v52, v54
  v_add_f32 v53, v53, v55
  v_cvt_pk_bf16_f32 v54, v52, v53
  ds_write_b32 v108, v54
  v_permlane32_swap_b32 v56, v58
  v_permlane32_swap_b32 v57, v59
  v_add_f32 v56, v56, v58
  v_add_f32 v57, v57, v59
  v_cvt_pk_bf16_f32 v58, v56, v57
  ds_write_b32 v109, v58
  v_permlane32_swap_b32 v60, v62
  v_permlane32_swap_b32 v61, v63
  v_add_f32 v60, v60, v62
  v_add_f32 v61, v61, v63
  v_cvt_pk_bf16_f32 v62, v60, v61
  ds_write_b32 v110, v62
  v_permlane32_swap_b32 v64, v66
  v_permlane32_swap_b32 v65, v67
  v_add_f32 v64, v64, v66
  v_add_f32 v65, v65, v67
  v_cvt_pk_bf16_f32 v66, v64, v65
  ds_write_b32 v111, v66
  s_branch cA_va2_t2d
.p2align 6
cA_va3_loop:
  s_mov_b32 s30, 0
  s_barrier
  buffer_load_dwordx4 v[16:19], v2, s[8:11], s20 offen offset:2048 sc1
  buffer_load_dwordx4 v[20:23], v2, s[8:11], s20 offen offset:3072 sc1
  s_barrier
  buffer_load_dword v100, v116, s[8:11], s39 offen sc1
  s_add_u32 s27, s19, 2
  s_min_u32 s27, s27, 63
  s_lshr_b32 s27, s27, 3
  s_lshl_b32 s27, s27, 11
  s_add_u32 s27, s27, s35
  s_cmp_eq_u32 s27, s28
  s_cselect_b32 s29, 35328, s27
  buffer_load_dword v101, off, s[8:11], s29 sc1
  s_add_u32 s39, s39, 28672
  s_waitcnt vmcnt(2)
  ds_write_b128 v2, v[16:19] offset:10240
  ds_write_b128 v2, v[20:23] offset:11264
  v_smfmac_f32_16x16x64_bf16 v[36:39], v[16:19], a[16:23], v3
  v_smfmac_f32_16x16x64_bf16 v[40:43], v[16:19], a[72:79], v3
  v_smfmac_f32_16x16x64_bf16 v[44:47], v[16:19], a[128:135], v3
  v_smfmac_f32_16x16x64_bf16 v[48:51], v[16:19], a[184:191], v3
  v_smfmac_f32_16x16x64_bf16 v[52:55], v[16:19], a[240:247], v3
  s_waitcnt lgkmcnt(0)
  s_barrier
  ds_read_b128 v[8:11], v2 offset:8192
  ds_read_b128 v[12:15], v2 offset:9216
  ds_read_b128 v[24:27], v2 offset:12288
  ds_read_b128 v[28:31], v2 offset:13312
  ds_read_b128 v[32:35], v2 offset:14336
  v_smfmac_f32_16x16x64_bf16 v[56:59], v[16:19], v[160:167], v3
  v_smfmac_f32_16x16x64_bf16 v[60:63], v[16:19], v[216:223], v3
  v_smfmac_f32_16x16x64_bf16 v[36:39], v[20:23], a[24:31], v3
  v_smfmac_f32_16x16x64_bf16 v[40:43], v[20:23], a[80:87], v3
  v_smfmac_f32_16x16x64_bf16 v[44:47], v[20:23], a[136:143], v3
  v_smfmac_f32_16x16x64_bf16 v[48:51], v[20:23], a[192:199], v3
  v_smfmac_f32_16x16x64_bf16 v[52:55], v[20:23], a[248:255], v3
  v_smfmac_f32_16x16x64_bf16 v[56:59], v[20:23], v[168:175], v3
  v_smfmac_f32_16x16x64_bf16 v[60:63], v[20:23], v[224:231], v3
  s_waitcnt lgkmcnt(4)
  v_smfmac_f32_16x16x64_bf16 v[36:39], v[8:11], a[0:7], v3
  s_waitcnt lgkmcnt(3)
  v_smfmac_f32_16x16x64_bf16 v[36:39], v[12:15], a[8:15], v3
  s_waitcnt lgkmcnt(2)
  v_smfmac_f32_16x16x64_bf16 v[36:39], v[24:27], a[32:39], v3
  s_waitcnt lgkmcnt(1)
  v_smfmac_f32_16x16x64_bf16 v[36:39], v[28:31], a[40:47], v3
  s_waitcnt lgkmcnt(0)
  v_smfmac_f32_16x16x64_bf16 v[36:39], v[32:35], a[48:55], v3
  v_smfmac_f32_16x16x64_bf16 v[40:43], v[8:11], a[56:63], v3
  v_smfmac_f32_16x16x64_bf16 v[40:43], v[12:15], a[64:71], v3
  v_smfmac_f32_16x16x64_bf16 v[40:43], v[24:27], a[88:95], v3
  v_permlane32_swap_b32 v36, v38
  v_smfmac_f32_16x16x64_bf16 v[40:43], v[28:31], a[96:103], v3
  v_permlane32_swap_b32 v37, v39
  v_smfmac_f32_16x16x64_bf16 v[40:43], v[32:35], a[104:111], v3
  v_add_f32 v36, v36, v38
  v_smfmac_f32_16x16x64_bf16 v[44:47], v[8:11], a[112:119], v3
  v_add_f32 v37, v37, v39
  v_smfmac_f32_16x16x64_bf16 v[44:47], v[12:15], a[120:127], v3
  v_cmp_u_f32 vcc, v36, v37
  v_smfmac_f32_16x16x64_bf16 v[44:47], v[24:27], a[144:151], v3
  v_cvt_pk_bf16_f32 v38, v36, v37
  v_smfmac_f32_16x16x64_bf16 v[44:47], v[28:31], a[152:159], v3
  ds_write_b32 v104, v38
  s_cbranch_vccnz cA_va3_slow
  v_permlane32_swap_b32 v40, v42
  v_smfmac_f32_16x16x64_bf16 v[44:47], v[32:35], a[160:167], v3
  v_permlane32_swap_b32 v41, v43
  v_smfmac_f32_16x16x64_bf16 v[48:51], v[8:11], a[168:175], v3
  v_add_f32 v40, v40, v42
  v_smfmac_f32_16x16x64_bf16 v[48:51], v[12:15], a[176:183], v3
  v_add_f32 v41, v41, v43
  v_smfmac_f32_16x16x64_bf16 v[48:51], v[24:27], a[200:207], v3
  v_cvt_pk_bf16_f32 v42, v40, v41
  v_smfmac_f32_16x16x64_bf16 v[48:51], v[28:31], a[208:215], v3
  ds_write_b32 v105, v42
  v_permlane32_swap_b32 v44, v46
  v_smfmac_f32_16x16x64_bf16 v[48:51], v[32:35], a[216:223], v3
  v_permlane32_swap_b32 v45, v47
  v_smfmac_f32_16x16x64_bf16 v[52:55], v[8:11], a[224:231], v3
  v_add_f32 v44, v44, v46
  v_smfmac_f32_16x16x64_bf16 v[52:55], v[12:15], a[232:239], v3
  v_add_f32 v45, v45, v47
  v_smfmac_f32_16x16x64_bf16 v[52:55], v[24:27], v[120:127], v3
  v_cvt_pk_bf16_f32 v46, v44, v45
  v_smfmac_f32_16x16x64_bf16 v[52:55], v[28:31], v[128:135], v3
  ds_write_b32 v106, v46
  v_permlane32_swap_b32 v48, v50
  v_smfmac_f32_16x16x64_bf16 v[52:55], v[32:35], v[136:143], v3
  v_permlane32_swap_b32 v49, v51
  v_smfmac_f32_16x16x64_bf16 v[56:59], v[8:11], v[144:151], v3
  v_add_f32 v48, v48, v50
  v_smfmac_f32_16x16x64_bf16 v[56:59], v[12:15], v[152:159], v3
  v_add_f32 v49, v49, v51
  v_smfmac_f32_16x16x64_bf16 v[56:59], v[24:27], v[176:183], v3
  v_cvt_pk_bf16_f32 v50, v48, v49
  v_smfmac_f32_16x16x64_bf16 v[56:59], v[28:31], v[184:191], v3
  ds_write_b32 v107, v50
  v_permlane32_swap_b32 v52, v54
  v_smfmac_f32_16x16x64_bf16 v[56:59], v[32:35], v[192:199], v3
  v_permlane32_swap_b32 v53, v55
  v_smfmac_f32_16x16x64_bf16 v[60:63], v[8:11], v[200:207], v3
  v_add_f32 v52, v52, v54
  v_smfmac_f32_16x16x64_bf16 v[60:63], v[12:15], v[208:215], v3
  v_add_f32 v53, v53, v55
  v_smfmac_f32_16x16x64_bf16 v[60:63], v[24:27], v[232:239], v3
  v_cvt_pk_bf16_f32 v54, v52, v53
  v_smfmac_f32_16x16x64_bf16 v[60:63], v[28:31], v[240:247], v3
  ds_write_b32 v108, v54
  v_permlane32_swap_b32 v56, v58
  v_smfmac_f32_16x16x64_bf16 v[60:63], v[32:35], v[248:255], v3
  v_permlane32_swap_b32 v57, v59
  v_add_f32 v56, v56, v58
  v_add_f32 v57, v57, v59
  v_cvt_pk_bf16_f32 v58, v56, v57
  ds_write_b32 v109, v58
  s_nop 2
  v_permlane32_swap_b32 v60, v62
  v_permlane32_swap_b32 v61, v63
  v_add_f32 v60, v60, v62
  v_add_f32 v61, v61, v63
  v_cvt_pk_bf16_f32 v62, v60, v61
  ds_write_b32 v110, v62
cA_va3_t2d:
  v_mov_b32 v117, s18
  s_cmp_eq_u32 s27, s28
  s_cbranch_scc1 cA_va3_vok
cA_va3_vow:
  s_waitcnt vmcnt(0)
  v_cmp_ne_u32 vcc, 56, v101
  s_cbranch_vccnz cA_va3_vor
  s_mov_b32 s28, s27
cA_va3_vok:
  s_waitcnt lgkmcnt(0)
  s_setprio 3
  s_barrier
  v_mov_b32 v36, 0
  v_mov_b32 v37, 0
  buffer_store_dword v117, v118, s[8:11], 0 offen
  s_setprio 0
  s_cmp_eq_u32 s19, 63
  s_cbranch_scc1 cA_done
  v_mov_b32 v38, 0
  v_mov_b32 v39, 0
  v_mov_b32 v40, 0
  v_mov_b32 v41, 0
  v_mov_b32 v42, 0
  v_mov_b32 v43, 0
  v_mov_b32 v44, 0
  v_mov_b32 v45, 0
  v_mov_b32 v46, 0
  v_mov_b32 v47, 0
  v_mov_b32 v48, 0
  v_mov_b32 v49, 0
  v_mov_b32 v50, 0
  v_mov_b32 v51, 0
  v_mov_b32 v52, 0
  v_mov_b32 v53, 0
  v_mov_b32 v54, 0
  v_mov_b32 v55, 0
  v_mov_b32 v56, 0
  v_mov_b32 v57, 0
  v_mov_b32 v58, 0
  v_mov_b32 v59, 0
  v_mov_b32 v60, 0
  v_mov_b32 v61, 0
  v_mov_b32 v62, 0
  v_mov_b32 v63, 0
  s_mov_b32 s19, s18
  s_add_u32 s18, s18, 1
  s_mov_b32 s22, s20
  s_mov_b32 s20, s21
  s_mov_b32 s21, s22
  s_add_u32 s23, s20, 4096
  s_branch cA_va3_loop
cA_va3_slow:
  s_waitcnt lgkmcnt(0)
cA_va3_sl1:
  s_add_u32 s31, s31, 0x1000000
  buffer_load_dwordx4 v[8:11], v2, s[8:11], s20 offen offset:0 sc1
  buffer_load_dwordx4 v[12:15], v2, s[8:11], s20 offen offset:1024 sc1
  buffer_load_dwordx4 v[16:19], v2, s[8:11], s20 offen offset:2048 sc1
  buffer_load_dwordx4 v[20:23], v2, s[8:11], s20 offen offset:3072 sc1
  buffer_load_dwordx4 v[24:27], v2, s[8:11], s23 offen offset:0 sc1
  buffer_load_dwordx4 v[28:31], v2, s[8:11], s23 offen offset:1024 sc1
  buffer_load_dwordx4 v[32:35], v2, s[8:11], s23 offen offset:2048 sc1
  s_waitcnt vmcnt(0)
  v_max3_u32 v36, v8, v9, v10
  v_max3_u32 v36, v36, v11, v12
  v_max3_u32 v36, v36, v13, v14
  v_max3_u32 v36, v36, v15, v16
  v_max3_u32 v36, v36, v17, v18
  v_max3_u32 v36, v36, v19, v20
  v_max3_u32 v36, v36, v21, v22
  v_max3_u32 v36, v36, v23, v24
  v_max3_u32 v36, v36, v25, v26
  v_max3_u32 v36, v36, v27, v28
  v_max3_u32 v36, v36, v29, v30
  v_max3_u32 v36, v36, v31, v32
  v_max3_u32 v36, v36, v33, v34
  v_max_u32 v36, v36, v35
  v_cmp_eq_u32 vcc, -1, v36
  s_cbranch_vccz cA_va3_sl2
  s_add_u32 s30, s30, 1
  s_cmp_lt_u32 s30, 400000
  s_cbranch_scc1 cA_va3_sl1
  s_branch cA_abort
cA_va3_sl2:
  v_mov_b32 v36, 0
  v_mov_b32 v37, 0
  v_mov_b32 v38, 0
  v_mov_b32 v39, 0
  v_mov_b32 v40, 0
  v_mov_b32 v41, 0
  v_mov_b32 v42, 0
  v_mov_b32 v43, 0
  v_mov_b32 v44, 0
  v_mov_b32 v45, 0
  v_mov_b32 v46, 0
  v_mov_b32 v47, 0
  v_mov_b32 v48, 0
  v_mov_b32 v49, 0
  v_mov_b32 v50, 0
  v_mov_b32 v51, 0
  v_mov_b32 v52, 0
  v_mov_b32 v53, 0
  v_mov_b32 v54, 0
  v_mov_b32 v55, 0
  v_mov_b32 v56, 0
  v_mov_b32 v57, 0
  v_mov_b32 v58, 0
  v_mov_b32 v59, 0
  v_mov_b32 v60, 0
  v_mov_b32 v61, 0
  v_mov_b32 v62, 0
  v_mov_b32 v63, 0
  v_smfmac_f32_16x16x64_bf16 v[36:39], v[8:11], a[0:7], v3
  v_smfmac_f32_16x16x64_bf16 v[40:43], v[8:11], a[56:63], v3
  v_smfmac_f32_16x16x64_bf16 v[44:47], v[8:11], a[112:119], v3
  v_smfmac_f32_16x16x64_bf16 v[48:51], v[8:11], a[168:175], v3
  v_smfmac_f32_16x16x64_bf16 v[52:55], v[8:11], a[224:231], v3
  v_smfmac_f32_16x16x64_bf16 v[56:59], v[8:11], v[144:151], v3
  v_smfmac_f32_16x16x64_bf16 v[60:63], v[8:11], v[200:207], v3
  v_smfmac_f32_16x16x64_bf16 v[36:39], v[12:15], a[8:15], v3
  v_smfmac_f32_16x16x64_bf16 v[40:43], v[12:15], a[64:71], v3
  v_smfmac_f32_16x16x64_bf16 v[44:47], v[12:15], a[120:127], v3
  v_smfmac_f32_16x16x64_bf16 v[48:51], v[12:15], a[176:183], v3
  v_smfmac_f32_16x16x64_bf16 v[52:55], v[12:15], a[232:239], v3
  v_smfmac_f32_16x16x64_bf16 v[56:59], v[12:15], v[152:159], v3
  v_smfmac_f32_16x16x64_bf16 v[60:63], v[12:15], v[208:215], v3
  v_smfmac_f32_16x16x64_bf16 v[36:39], v[16:19], a[16:23], v3
  v_smfmac_f32_16x16x64_bf16 v[40:43], v[16:19], a[72:79], v3
  v_smfmac_f32_16x16x64_bf16 v[44:47], v[16:19], a[128:135], v3
  v_smfmac_f32_16x16x64_bf16 v[48:51], v[16:19], a[184:191], v3
  v_smfmac_f32_16x16x64_bf16 v[52:55], v[16:19], a[240:247], v3
  v_smfmac_f32_16x16x64_bf16 v[56:59], v[16:19], v[160:167], v3
  v_smfmac_f32_16x16x64_bf16 v[60:63], v[16:19], v[216:223], v3
  v_smfmac_f32_16x16x64_bf16 v[36:39], v[20:23], a[24:31], v3
  v_smfmac_f32_16x16x64_bf16 v[40:43], v[20:23], a[80:87], v3
  v_smfmac_f32_16x16x64_bf16 v[44:47], v[20:23], a[136:143], v3
  v_smfmac_f32_16x16x64_bf16 v[48:51], v[20:23], a[192:199], v3
  v_smfmac_f32_16x16x64_bf16 v[52:55], v[20:23], a[248:255], v3
  v_smfmac_f32_16x16x64_bf16 v[56:59], v[20:23], v[168:175], v3
  v_smfmac_f32_16x16x64_bf16 v[60:63], v[20:23], v[224:231], v3
  v_smfmac_f32_16x16x64_bf16 v[36:39], v[24:27], a[32:39], v3
  v_smfmac_f32_16x16x64_bf16 v[40:43], v[24:27], a[88:95], v3
  v_smfmac_f32_16x16x64_bf16 v[44:47], v[24:27], a[144:151], v3
  v_smfmac_f32_16x16x64_bf16 v[48:51], v[24:27], a[200:207], v3
  v_smfmac_f32_16x16x64_bf16 v[52:55], v[24:27], v[120:127], v3
  v_smfmac_f32_16x16x64_bf16 v[56:59], v[24:27], v[176:183], v3
  v_smfmac_f32_16x16x64_bf16 v[60:63], v[24:27], v[232:239], v3
  v_smfmac_f32_16x16x64_bf16 v[36:39], v[28:31], a[40:47], v3
  v_smfmac_f32_16x16x64_bf16 v[40:43], v[28:31], a[96:103], v3
  v_smfmac_f32_16x16x64_bf16 v[44:47], v[28:31], a[152:159], v3
  v_smfmac_f32_16x16x64_bf16 v[48:51], v[28:31], a[208:215], v3
  v_smfmac_f32_16x16x64_bf16 v[52:55], v[28:31], v[128:135], v3
  v_smfmac_f32_16x16x64_bf16 v[56:59], v[28:31], v[184:191], v3
  v_smfmac_f32_16x16x64_bf16 v[60:63], v[28:31], v[240:247], v3
  v_smfmac_f32_16x16x64_bf16 v[36:39], v[32:35], a[48:55], v3
  v_smfmac_f32_16x16x64_bf16 v[40:43], v[32:35], a[104:111], v3
  v_smfmac_f32_16x16x64_bf16 v[44:47], v[32:35], a[160:167], v3
  v_smfmac_f32_16x16x64_bf16 v[48:51], v[32:35], a[216:223], v3
  v_smfmac_f32_16x16x64_bf16 v[52:55], v[32:35], v[136:143], v3
  v_smfmac_f32_16x16x64_bf16 v[56:59], v[32:35], v[192:199], v3
  v_smfmac_f32_16x16x64_bf16 v[60:63], v[32:35], v[248:255], v3
  v_permlane32_swap_b32 v36, v38
  v_permlane32_swap_b32 v37, v39
  v_add_f32 v36, v36, v38
  v_add_f32 v37, v37, v39
  v_cvt_pk_bf16_f32 v38, v36, v37
  ds_write_b32 v104, v38
  v_permlane32_swap_b32 v40, v42
  v_permlane32_swap_b32 v41, v43
  v_add_f32 v40, v40, v42
  v_add_f32 v41, v41, v43
  v_cvt_pk_bf16_f32 v42, v40, v41
  ds_write_b32 v105, v42
  v_permlane32_swap_b32 v44, v46
  v_permlane32_swap_b32 v45, v47
  v_add_f32 v44, v44, v46
  v_add_f32 v45, v45, v47
  v_cvt_pk_bf16_f32 v46, v44, v45
  ds_write_b32 v106, v46
  v_permlane32_swap_b32 v48, v50
  v_permlane32_swap_b32 v49, v51
  v_add_f32 v48, v48, v50
  v_add_f32 v49, v49, v51
  v_cvt_pk_bf16_f32 v50, v48, v49
  ds_write_b32 v107, v50
  v_permlane32_swap_b32 v52, v54
  v_permlane32_swap_b32 v53, v55
  v_add_f32 v52, v52, v54
  v_add_f32 v53, v53, v55
  v_cvt_pk_bf16_f32 v54, v52, v53
  ds_write_b32 v108, v54
  v_permlane32_swap_b32 v56, v58
  v_permlane32_swap_b32 v57, v59
  v_add_f32 v56, v56, v58
  v_add_f32 v57, v57, v59
  v_cvt_pk_bf16_f32 v58, v56, v57
  ds_write_b32 v109, v58
  v_permlane32_swap_b32 v60, v62
  v_permlane32_swap_b32 v61, v63
  v_add_f32 v60, v60, v62
  v_add_f32 v61, v61, v63
  v_cvt_pk_bf16_f32 v62, v60, v61
  ds_write_b32 v110, v62
  s_branch cA_va3_t2d
cA_va3_vor:
  s_sleep 2
  buffer_load_dword v101, off, s[8:11], s27 sc1
  s_add_u32 s30, s30, 1
  s_cmp_lt_u32 s30, 400000
  s_cbranch_scc1 cA_va3_vow
  s_branch cA_abort
cA_abort:
  v_mov_b32 v4, 0xdead
  v_mov_b32 v5, 16
  buffer_store_dword v4, v5, s[12:15], 0 offen
  s_branch ch_end
cA_done:
  s_branch ch_end
.p2align 6
cB_sc0_loop:
  s_mov_b32 s30, 0
  s_mov_b32 s62, 0
  s_setprio 3
  s_sleep 6
cB_sc0_fp_l:
  v_cmp_gt_u32 vcc, s19, v112
  buffer_load_dword v112, v0, s[8:11], 0 offen sc1
  s_cbranch_vccz cB_sc0_fp_d
  v_cmp_gt_u32 vcc, s19, v112
  buffer_load_dword v112, v0, s[8:11], 0 offen sc1
  s_cbranch_vccz cB_sc0_fp_d
  v_cmp_gt_u32 vcc, s19, v112
  buffer_load_dword v112, v0, s[8:11], 0 offen sc1
  s_cbranch_vccz cB_sc0_fp_d
  v_cmp_gt_u32 vcc, s19, v112
  buffer_load_dword v112, v0, s[8:11], 0 offen sc1
  s_cbranch_vccz cB_sc0_fp_d
  v_cmp_gt_u32 vcc, s19, v112
  buffer_load_dword v112, v0, s[8:11], 0 offen sc1
  s_cbranch_vccz cB_sc0_fp_d
  v_cmp_gt_u32 vcc, s19, v112
  buffer_load_dword v112, v0, s[8:11], 0 offen sc1
  s_cbranch_vccz cB_sc0_fp_d
  v_cmp_gt_u32 vcc, s19, v112
  buffer_load_dword v112, v0, s[8:11], 0 offen sc1
  s_cbranch_vccz cB_sc0_fp_d
  v_cmp_gt_u32 vcc, s19, v112
  buffer_load_dword v112, v0, s[8:11], 0 offen sc1
  s_cbranch_vccz cB_sc0_fp_d
  v_cmp_gt_u32 vcc, s19, v112
  buffer_load_dword v112, v0, s[8:11], 0 offen sc1
  s_cbranch_vccz cB_sc0_fp_d
  v_cmp_gt_u32 vcc, s19, v112
  buffer_load_dword v112, v0, s[8:11], 0 offen sc1
  s_cbranch_vccz cB_sc0_fp_d
  v_cmp_gt_u32 vcc, s19, v112
  buffer_load_dword v112, v0, s[8:11], 0 offen sc1
  s_cbranch_vccz cB_sc0_fp_d
  v_cmp_gt_u32 vcc, s19, v112
  buffer_load_dword v112, v0, s[8:11], 0 offen sc1
  s_cbranch_vccz cB_sc0_fp_d
  v_cmp_gt_u32 vcc, s19, v112
  buffer_load_dword v112, v0, s[8:11], 0 offen sc1
  s_cbranch_vccz cB_sc0_fp_d
  v_cmp_gt_u32 vcc, s19, v112
  buffer_load_dword v112, v0, s[8:11], 0 offen sc1
  s_cbranch_vccz cB_sc0_fp_d
  v_cmp_gt_u32 vcc, s19, v112
  buffer_load_dword v112, v0, s[8:11], 0 offen sc1
  s_cbranch_vccz cB_sc0_fp_d
  v_cmp_gt_u32 vcc, s19, v112
  buffer_load_dword v112, v0, s[8:11], 0 offen sc1
  s_cbranch_vccz cB_sc0_fp_d
  s_waitcnt vmcnt(24)
  s_add_u32 s30, s30, 1
  s_cmp_lt_u32 s30, 400000
  s_cbranch_scc1 cB_sc0_fp_l
  s_branch cB_abort
cB_sc0_fp_d:
  buffer_load_dwordx4 v[8:11], v2, s[8:11], s20 offen offset:0 sc1
  s_barrier
  s_setprio 2
  buffer_load_dwordx4 v[12:15], v2, s[8:11], s20 offen offset:1024 sc1
  s_setprio 1
  buffer_load_dwordx4 v[16:19], v2, s[8:11], s20 offen offset:2048 sc1
  s_setprio 0
  buffer_load_dwordx4 v[20:23], v2, s[8:11], s20 offen offset:3072 sc1
cB_sc0_go:
  s_waitcnt vmcnt(3)
  v_smfmac_f32_16x16x64_bf16 v[36:39], v[8:11], a[0:7], v3
  buffer_load_dwordx4 v[32:35], v2, s[8:11], s23 offen offset:0 sc1
  v_cmp_eq_u32 vcc, -1, v8
  v_smfmac_f32_16x16x64_bf16 v[40:43], v[8:11], a[56:63], v3
  v_smfmac_f32_16x16x64_bf16 v[44:47], v[8:11], a[112:119], v3
  buffer_load_dwordx4 v[24:27], v2, s[8:11], s23 offen offset:1024 sc1
  s_cbranch_vccnz cB_sc0_r0
  v_smfmac_f32_16x16x64_bf16 v[48:51], v[8:11], a[168:175], v3
  v_smfmac_f32_16x16x64_bf16 v[52:55], v[8:11], a[224:231], v3
  s_waitcnt vmcnt(4)
  v_cmp_eq_u32 vcc, -1, v12
  v_smfmac_f32_16x16x64_bf16 v[56:59], v[8:11], v[144:151], v3
  buffer_load_dwordx4 v[28:31], v2, s[8:11], s23 offen offset:2048 sc1
  v_smfmac_f32_16x16x64_bf16 v[60:63], v[8:11], v[200:207], v3
  s_cbranch_vccnz cB_sc0_r1
cB_sc0_c1:
  v_smfmac_f32_16x16x64_bf16 v[36:39], v[12:15], a[8:15], v3
  v_smfmac_f32_16x16x64_bf16 v[40:43], v[12:15], a[64:71], v3
  v_smfmac_f32_16x16x64_bf16 v[44:47], v[12:15], a[120:127], v3
  v_smfmac_f32_16x16x64_bf16 v[48:51], v[12:15], a[176:183], v3
  v_smfmac_f32_16x16x64_bf16 v[52:55], v[12:15], a[232:239], v3
  s_waitcnt vmcnt(4)
  v_cmp_eq_u32 vcc, -1, v16
  v_smfmac_f32_16x16x64_bf16 v[56:59], v[12:15], v[152:159], v3
  buffer_load_dwordx4 v[88:91], v117, s[8:11], s26 offen offset:0 sc1
  v_smfmac_f32_16x16x64_bf16 v[60:63], v[12:15], v[208:215], v3
  s_cbranch_vccnz cB_sc0_r2
cB_sc0_c2:
  v_smfmac_f32_16x16x64_bf16 v[36:39], v[16:19], a[16:23], v3
  v_smfmac_f32_16x16x64_bf16 v[40:43], v[16:19], a[72:79], v3
  v_smfmac_f32_16x16x64_bf16 v[44:47], v[16:19], a[128:135], v3
  buffer_load_dwordx4 v[92:95], v117, s[8:11], s26 offen offset:1024 sc1
  v_smfmac_f32_16x16x64_bf16 v[48:51], v[16:19], a[184:191], v3
  v_smfmac_f32_16x16x64_bf16 v[52:55], v[16:19], a[240:247], v3
  s_waitcnt vmcnt(5)
  v_cmp_eq_u32 vcc, -1, v20
  v_smfmac_f32_16x16x64_bf16 v[56:59], v[16:19], v[160:167], v3
  v_smfmac_f32_16x16x64_bf16 v[60:63], v[16:19], v[216:223], v3
  buffer_load_dwordx4 v[96:99], v2, s[8:11], s24 offen offset:0 sc1
  s_cbranch_vccnz cB_sc0_r3
cB_sc0_c3:
  v_smfmac_f32_16x16x64_bf16 v[36:39], v[20:23], a[24:31], v3
  v_smfmac_f32_16x16x64_bf16 v[40:43], v[20:23], a[80:87], v3
  s_waitcnt vmcnt(3)
  v_max3_u32 v66, v24, v27, v28
  v_smfmac_f32_16x16x64_bf16 v[44:47], v[20:23], a[136:143], v3
  v_max3_u32 v66, v66, v31, v32
  v_smfmac_f32_16x16x64_bf16 v[48:51], v[20:23], a[192:199], v3
  buffer_load_dwordx4 v[100:103], v2, s[8:11], s24 offen offset:1024 sc1
  v_max_u32 v66, v66, v35
  v_smfmac_f32_16x16x64_bf16 v[52:55], v[20:23], a[248:255], v3
  v_cmp_eq_u32 vcc, -1, v66
  v_smfmac_f32_16x16x64_bf16 v[56:59], v[20:23], v[168:175], v3
  v_smfmac_f32_16x16x64_bf16 v[60:63], v[20:23], v[224:231], v3
  s_cbranch_vccnz cB_sc0_r4
cB_sc0_c4:
  v_smfmac_f32_16x16x64_bf16 v[60:63], v[32:35], v[232:239], v3
  buffer_load_dwordx4 v[104:107], v2, s[8:11], s26 offen offset:0 sc1
  v_smfmac_f32_16x16x64_bf16 v[60:63], v[24:27], v[240:247], v3
  v_smfmac_f32_16x16x64_bf16 v[60:63], v[28:31], v[248:255], v3
  v_smfmac_f32_16x16x64_bf16 v[52:55], v[32:35], v[120:127], v3
  v_smfmac_f32_16x16x64_bf16 v[52:55], v[24:27], v[128:135], v3
  buffer_load_dwordx4 v[108:111], v2, s[8:11], s26 offen offset:1024 sc1
  v_smfmac_f32_16x16x64_bf16 v[52:55], v[28:31], v[136:143], v3
  v_cvt_pk_bf16_f32 v63, v62, v63
  v_smfmac_f32_16x16x64_bf16 v[56:59], v[32:35], v[176:183], v3
  v_cvt_pk_bf16_f32 v62, v60, v61
  v_smfmac_f32_16x16x64_bf16 v[56:59], v[24:27], v[184:191], v3
  v_mfma_f32_16x16x32_bf16 v[12:15], v[62:65], v[4:7], 0
  v_cvt_pk_bf16_f32 v55, v54, v55
  v_smfmac_f32_16x16x64_bf16 v[56:59], v[28:31], v[192:199], v3
  v_cvt_pk_bf16_f32 v54, v52, v53
  v_smfmac_f32_16x16x64_bf16 v[36:39], v[32:35], a[32:39], v3
  s_nop 1
  v_cvt_pk_bf16_f32 v76, v12, v13
  v_smfmac_f32_16x16x64_bf16 v[36:39], v[24:27], a[40:47], v3
  v_cvt_pk_bf16_f32 v77, v14, v15
  v_smfmac_f32_16x16x64_bf16 v[36:39], v[28:31], a[48:55], v3
  v_cvt_pk_bf16_f32 v56, v56, v57
  v_smfmac_f32_16x16x64_bf16 v[40:43], v[32:35], a[88:95], v3
  v_cvt_pk_bf16_f32 v57, v58, v59
  v_smfmac_f32_16x16x64_bf16 v[40:43], v[24:27], a[96:103], v3
  v_mfma_f32_16x16x32_bf16 v[16:19], v[54:57], v[4:7], 0
  v_cvt_pk_bf16_f32 v39, v38, v39
  v_smfmac_f32_16x16x64_bf16 v[40:43], v[28:31], a[104:111], v3
  v_cvt_pk_bf16_f32 v38, v36, v37
  v_smfmac_f32_16x16x64_bf16 v[44:47], v[32:35], a[144:151], v3
  s_nop 1
  v_cvt_pk_bf16_f32 v78, v16, v17
  v_smfmac_f32_16x16x64_bf16 v[44:47], v[24:27], a[152:159], v3
  v_cvt_pk_bf16_f32 v79, v18, v19
  v_smfmac_f32_16x16x64_bf16 v[44:47], v[28:31], a[160:167], v3
  v_cvt_pk_bf16_f32 v40, v40, v41
  v_smfmac_f32_16x16x64_bf16 v[48:51], v[32:35], a[200:207], v3
  v_cvt_pk_bf16_f32 v41, v42, v43
  v_smfmac_f32_16x16x64_bf16 v[48:51], v[24:27], a[208:215], v3
  v_smfmac_f32_16x16x64_bf16 v[48:51], v[28:31], a[216:223], v3
  s_waitcnt vmcnt(4)
  v_cvt_pk_bf16_f32 v47, v46, v47
  v_smfmac_f32_16x16x64_bf16 v[68:71], v[76:79], v[80:87], v3
  v_cvt_pk_bf16_f32 v46, v44, v45
  v_mfma_f32_16x16x32_bf16 v[12:15], v[38:41], v[4:7], 0
  s_nop 1
  v_cvt_pk_bf16_f32 v48, v48, v49
  v_cvt_pk_bf16_f32 v49, v50, v51
  s_nop 1
  v_mfma_f32_16x16x32_bf16 v[16:19], v[46:49], v[4:7], 0
  v_smfmac_f32_16x16x64_bf16 v[72:75], v[76:79], v[88:95], v3
  v_cvt_pk_bf16_f32 v20, v12, v13
  v_mfma_f32_16x16x32_bf16 v[52:55], v[30:33], v[76:79], 0
  s_waitcnt vmcnt(0)
  v_cvt_pk_bf16_f32 v21, v14, v15
  v_cvt_pk_bf16_f32 v22, v16, v17
  v_cvt_pk_bf16_f32 v23, v18, v19
  s_nop 1
  v_mfma_f32_16x16x32_bf16 v[52:55], v[8:11], v[20:23], v[52:55]
  v_smfmac_f32_16x16x64_bf16 v[68:71], v[20:23], v[96:103], v3
  v_smfmac_f32_16x16x64_bf16 v[72:75], v[20:23], v[104:111], v3
  s_nop 1
  ds_write_b128 v113, v[52:55]
  s_nop 1
  v_permlane32_swap_b32 v68, v70
  v_permlane32_swap_b32 v69, v71
  v_add_f32 v56, v68, v70
  v_add_f32 v58, v69, v71
  v_permlane32_swap_b32 v72, v74
  v_permlane32_swap_b32 v73, v75
  v_add_f32 v57, v72, v74
  v_add_f32 v59, v73, v75
  ds_write_b128 v2, v[56:59] offset:0
  v_cmp_u_f32 vcc, v57, v59
  v_mov_b32 v68, 0
  v_mov_b32 v69, 0
  v_mov_b32 v70, 0
  v_mov_b32 v71, 0
  s_cbranch_vccnz cB_sc0_retry
cB_sc0_cont:
  s_add_u32 s24, s24, 28672
  s_add_u32 s26, s26, 28672
  buffer_load_dwordx4 v[80:83], v117, s[8:11], s24 offen offset:0 sc1
  buffer_load_dwordx4 v[84:87], v117, s[8:11], s24 offen offset:1024 sc1
  v_mov_b32 v72, 0
  v_mov_b32 v73, 0
  v_mfma_f32_32x32x16_bf16 v[36:51], v[68:71], v[68:71], 0
  s_waitcnt lgkmcnt(0)
  s_barrier
  ds_read_b64 v[8:9], v114 offset:0
  ds_read_b64 v[10:11], v114 offset:1024
  ds_read_b64 v[12:13], v114 offset:2048
  ds_read_b64 v[14:15], v114 offset:3072
  ds_read2_b32 v[16:17], v115 offset0:0 offset1:64
  ds_read2_b32 v[18:19], v115 offset0:128 offset1:192
  v_mfma_f32_32x32x16_bf16 v[52:67], v[68:71], v[68:71], 0
  s_waitcnt lgkmcnt(0)
  v_pk_add_f32 v[16:17], v[16:17], v[18:19]
  v_pk_add_f32 v[8:9], v[8:9], v[10:11]
  v_pk_add_f32 v[12:13], v[12:13], v[14:15]
  v_add_f32 v20, v16, v17
  v_pk_add_f32 v[8:9], v[8:9], v[12:13]
  v_max_f32 v22, v8, v9
  v_add_f32_dpp v20, v20, v20 row_ror:8 row_mask:0xf bank_mask:0xf
  s_nop 0
  v_max_f32_dpp v22, v22, v22 row_ror:8 row_mask:0xf bank_mask:0xf
  v_max_f32 v22, v22, v20
  s_nop 1
  v_max_f32_dpp v22, v22, v22 quad_perm:[1,0,3,2] row_mask:0xf bank_mask:0xf
  s_nop 1
  v_max_f32_dpp v22, v22, v22 quad_perm:[2,3,0,1] row_mask:0xf bank_mask:0xf
  s_nop 1
  v_max_f32_dpp v22, v22, v22 row_half_mirror row_mask:0xf bank_mask:0xf
  v_pk_add_f32 v[8:9], v[8:9], v[22:23] op_sel_hi:[1,0] neg_lo:[0,1] neg_hi:[0,1]
  v_sub_f32 v20, v20, v22
  v_exp_f32 v8, v8
  v_exp_f32 v9, v9
  v_exp_f32 v20, v20
  v_add_f32 v24, v8, v9
  v_fmac_f32 v24, 0.5, v20
  v_mov_b32_dpp v21, v20 quad_perm:[1,0,3,2] row_mask:0xf bank_mask:0xf
  s_nop 0
  v_add_f32_dpp v24, v24, v24 quad_perm:[1,0,3,2] row_mask:0xf bank_mask:0xf
  s_nop 1
  v_add_f32_dpp v24, v24, v24 quad_perm:[2,3,0,1] row_mask:0xf bank_mask:0xf
  s_nop 1
  v_add_f32_dpp v24, v24, v24 row_half_mirror row_mask:0xf bank_mask:0xf
  s_nop 1
  v_add_f32_dpp v24, v24, v24 row_ror:8 row_mask:0xf bank_mask:0xf
  v_rcp_f32 v24, v24
  s_nop 0
  v_pk_mul_f32 v[8:9], v[8:9], v[24:25] op_sel_hi:[1,0]
  v_cvt_pk_bf16_f32 v8, abs(v8), abs(v9)
  buffer_store_dword v8, v1, s[8:11], s20 offen sc1
  v_pk_mul_f32 v[20:21], v[20:21], v[24:25] op_sel_hi:[1,0]
  v_cvt_pk_bf16_f32 v20, abs(v20), abs(v21)
  buffer_store_dword v20, v118, s[8:11], s20 offen sc1
  v_mov_b32 v74, 0
  v_mov_b32 v75, 0
  s_mov_b32 s19, s18
  s_add_u32 s18, s18, 1
  s_mov_b32 s22, s20
  s_mov_b32 s20, s21
  s_mov_b32 s21, s22
  s_add_u32 s23, s20, 4096
  s_cmp_lt_u32 s19, 63
  s_cbranch_scc1 cB_sc0_loop
  s_branch cB_done
cB_sc0_r0:
  s_add_u32 s31, s31, 1
  buffer_load_dwordx4 v[8:11], v2, s[8:11], s20 offen offset:0 sc1
  s_waitcnt vmcnt(0)
  v_cmp_eq_u32 vcc, -1, v8
  v_mov_b32 v36, 0
  v_mov_b32 v37, 0
  v_mov_b32 v38, 0
  v_mov_b32 v39, 0
  v_mov_b32 v40, 0
  v_mov_b32 v41, 0
  v_mov_b32 v42, 0
  v_mov_b32 v43, 0
  v_mov_b32 v44, 0
  v_mov_b32 v45, 0
  v_mov_b32 v46, 0
  v_mov_b32 v47, 0
  v_mov_b32 v48, 0
  v_mov_b32 v49, 0
  v_mov_b32 v50, 0
  v_mov_b32 v51, 0
  s_nop 1
  s_cbranch_vccz cB_sc0_go
  s_add_u32 s30, s30, 1
  s_cmp_lt_u32 s30, 400000
  s_cbranch_scc1 cB_sc0_r0
  s_branch cB_abort
cB_sc0_r1:
  s_add_u32 s31, s31, 1
  buffer_load_dwordx4 v[12:15], v2, s[8:11], s20 offen offset:1024 sc1
  s_waitcnt vmcnt(0)
  v_cmp_eq_u32 vcc, -1, v12
  s_nop 4
  s_cbranch_vccz cB_sc0_c1
  s_add_u32 s30, s30, 1
  s_cmp_lt_u32 s30, 400000
  s_cbranch_scc1 cB_sc0_r1
  s_branch cB_abort
cB_sc0_r2:
  s_add_u32 s31, s31, 1
  buffer_load_dwordx4 v[16:19], v2, s[8:11], s20 offen offset:2048 sc1
  s_waitcnt vmcnt(0)
  v_cmp_eq_u32 vcc, -1, v16
  s_nop 4
  s_cbranch_vccz cB_sc0_c2
  s_add_u32 s30, s30, 1
  s_cmp_lt_u32 s30, 400000
  s_cbranch_scc1 cB_sc0_r2
  s_branch cB_abort
cB_sc0_r3:
  s_add_u32 s31, s31, 1
  buffer_load_dwordx4 v[20:23], v2, s[8:11], s20 offen offset:3072 sc1
  s_waitcnt vmcnt(0)
  v_cmp_eq_u32 vcc, -1, v20
  s_nop 4
  s_cbranch_vccz cB_sc0_c3
  s_add_u32 s30, s30, 1
  s_cmp_lt_u32 s30, 400000
  s_cbranch_scc1 cB_sc0_r3
  s_branch cB_abort
cB_sc0_r4:
  s_add_u32 s31, s31, 1
  buffer_load_dwordx4 v[32:35], v2, s[8:11], s23 offen offset:0 sc1
  buffer_load_dwordx4 v[24:27], v2, s[8:11], s23 offen offset:1024 sc1
  buffer_load_dwordx4 v[28:31], v2, s[8:11], s23 offen offset:2048 sc1
  s_waitcnt vmcnt(0)
  v_max3_u32 v66, v24, v27, v28
  v_max3_u32 v66, v66, v31, v32
  v_max_u32 v66, v66, v35
  v_cmp_eq_u32 vcc, -1, v66
  s_nop 4
  s_cbranch_vccz cB_sc0_c4
  s_add_u32 s30, s30, 1
  s_cmp_lt_u32 s30, 400000
  s_cbranch_scc1 cB_sc0_r4
  s_branch cB_abort
cB_sc0_retry:
  s_cmp_lg_u32 s62, 0
  s_cbranch_scc1 cB_sc0_cont
  s_waitcnt vmcnt(0) lgkmcnt(0)
cB_sc0_rv:
  buffer_load_dwordx4 v[8:11], v2, s[8:11], s20 offen offset:0 sc1
  buffer_load_dwordx4 v[12:15], v2, s[8:11], s20 offen offset:1024 sc1
  buffer_load_dwordx4 v[16:19], v2, s[8:11], s20 offen offset:2048 sc1
  buffer_load_dwordx4 v[20:23], v2, s[8:11], s20 offen offset:3072 sc1
  buffer_load_dwordx4 v[32:35], v2, s[8:11], s23 offen offset:0 sc1
  buffer_load_dwordx4 v[24:27], v2, s[8:11], s23 offen offset:1024 sc1
  buffer_load_dwordx4 v[28:31], v2, s[8:11], s23 offen offset:2048 sc1
  s_waitcnt vmcnt(0)
  v_max3_u32 v66, v8, v9, v10
  v_max3_u32 v66, v66, v11, v12
  v_max3_u32 v66, v66, v13, v14
  v_max3_u32 v66, v66, v15, v16
  v_max3_u32 v66, v66, v17, v18
  v_max3_u32 v66, v66, v19, v20
  v_max3_u32 v66, v66, v21, v22
  v_max3_u32 v66, v66, v23, v24
  v_max3_u32 v66, v66, v25, v26
  v_max3_u32 v66, v66, v27, v28
  v_max3_u32 v66, v66, v29, v30
  v_max3_u32 v66, v66, v31, v32
  v_max3_u32 v66, v66, v33, v34
  v_max_u32 v66, v66, v35
  v_cmp_eq_u32 vcc, -1, v66
  s_cbranch_vccz cB_sc0_rk
  s_add_u32 s30, s30, 1
  s_cmp_lt_u32 s30, 400000
  s_cbranch_scc1 cB_sc0_rv
  s_branch cB_abort
cB_sc0_rk:
  s_mov_b32 s62, 1
  v_mov_b32 v36, 0
  v_mov_b32 v37, 0
  v_mov_b32 v38, 0
  v_mov_b32 v39, 0
  v_mov_b32 v40, 0
  v_mov_b32 v41, 0
  v_mov_b32 v42, 0
  v_mov_b32 v43, 0
  v_mov_b32 v44, 0
  v_mov_b32 v45, 0
  v_mov_b32 v46, 0
  v_mov_b32 v47, 0
  v_mov_b32 v48, 0
  v_mov_b32 v49, 0
  v_mov_b32 v50, 0
  v_mov_b32 v51, 0
  v_mov_b32 v60, 0
  v_mov_b32 v61, 0
  v_mov_b32 v62, 0
  v_mov_b32 v63, 0
  v_mov_b32 v68, 0
  v_mov_b32 v69, 0
  v_mov_b32 v70, 0
  v_mov_b32 v71, 0
  v_mov_b32 v72, 0
  v_mov_b32 v73, 0
  v_mov_b32 v74, 0
  v_mov_b32 v75, 0
  v_mov_b32 v52, 0
  v_mov_b32 v53, 0
  v_mov_b32 v54, 0
  v_mov_b32 v55, 0
  v_mov_b32 v56, 0
  v_mov_b32 v57, 0
  v_mov_b32 v58, 0
  v_mov_b32 v59, 0
  s_add_u32 s31, s31, 0x100
  s_nop 0
  s_branch cB_sc0_go
.p2align 6
cB_sc1_loop:
  s_mov_b32 s30, 0
  s_mov_b32 s62, 0
  s_setprio 3
  s_barrier
  buffer_load_dwordx4 v[8:11], v2, s[8:11], s20 offen offset:0 sc1
  s_setprio 2
  buffer_load_dwordx4 v[12:15], v2, s[8:11], s20 offen offset:1024 sc1
  s_setprio 1
  buffer_load_dwordx4 v[16:19], v2, s[8:11], s20 offen offset:2048 sc1
  s_setprio 0
  buffer_load_dwordx4 v[20:23], v2, s[8:11], s20 offen offset:3072 sc1
cB_sc1_go:
  s_waitcnt vmcnt(3)
  v_smfmac_f32_16x16x64_bf16 v[36:39], v[8:11], a[0:7], v3
  buffer_load_dwordx4 v[28:31], v2, s[8:11], s23 offen offset:0 sc1
  v_cmp_eq_u32 vcc, -1, v8
  v_smfmac_f32_16x16x64_bf16 v[40:43], v[8:11], a[56:63], v3
  v_smfmac_f32_16x16x64_bf16 v[44:47], v[8:11], a[112:119], v3
  buffer_load_dwordx4 v[24:27], v2, s[8:11], s23 offen offset:1024 sc1
  s_cbranch_vccnz cB_sc1_r0
  v_smfmac_f32_16x16x64_bf16 v[48:51], v[8:11], a[168:175], v3
  v_smfmac_f32_16x16x64_bf16 v[52:55], v[8:11], a[224:231], v3
  s_waitcnt vmcnt(4)
  v_cmp_eq_u32 vcc, -1, v12
  v_smfmac_f32_16x16x64_bf16 v[56:59], v[8:11], v[144:151], v3
  buffer_load_dwordx4 v[32:35], v2, s[8:11], s23 offen offset:2048 sc1
  v_smfmac_f32_16x16x64_bf16 v[60:63], v[8:11], v[200:207], v3
  s_cbranch_vccnz cB_sc1_r1
cB_sc1_c1:
  v_smfmac_f32_16x16x64_bf16 v[36:39], v[12:15], a[8:15], v3
  v_smfmac_f32_16x16x64_bf16 v[40:43], v[12:15], a[64:71], v3
  v_smfmac_f32_16x16x64_bf16 v[44:47], v[12:15], a[120:127], v3
  v_smfmac_f32_16x16x64_bf16 v[48:51], v[12:15], a[176:183], v3
  v_smfmac_f32_16x16x64_bf16 v[52:55], v[12:15], a[232:239], v3
  s_waitcnt vmcnt(4)
  v_cmp_eq_u32 vcc, -1, v16
  v_smfmac_f32_16x16x64_bf16 v[56:59], v[12:15], v[152:159], v3
  buffer_load_dwordx4 v[88:91], v117, s[8:11], s26 offen offset:0 sc1
  v_smfmac_f32_16x16x64_bf16 v[60:63], v[12:15], v[208:215], v3
  s_cbranch_vccnz cB_sc1_r2
cB_sc1_c2:
  v_smfmac_f32_16x16x64_bf16 v[36:39], v[16:19], a[16:23], v3
  v_smfmac_f32_16x16x64_bf16 v[40:43], v[16:19], a[72:79], v3
  v_smfmac_f32_16x16x64_bf16 v[44:47], v[16:19], a[128:135], v3
  buffer_load_dwordx4 v[92:95], v117, s[8:11], s26 offen offset:1024 sc1
  v_smfmac_f32_16x16x64_bf16 v[48:51], v[16:19], a[184:191], v3
  v_smfmac_f32_16x16x64_bf16 v[52:55], v[16:19], a[240:247], v3
  s_waitcnt vmcnt(5)
  v_cmp_eq_u32 vcc, -1, v20
  v_smfmac_f32_16x16x64_bf16 v[56:59], v[16:19], v[160:167], v3
  v_smfmac_f32_16x16x64_bf16 v[60:63], v[16:19], v[216:223], v3
  buffer_load_dwordx4 v[96:99], v2, s[8:11], s24 offen offset:0 sc1
  s_cbranch_vccnz cB_sc1_r3
cB_sc1_c3:
  v_smfmac_f32_16x16x64_bf16 v[36:39], v[20:23], a[24:31], v3
  v_smfmac_f32_16x16x64_bf16 v[40:43], v[20:23], a[80:87], v3
  s_waitcnt vmcnt(3)
  v_max3_u32 v66, v24, v27, v28
  v_smfmac_f32_16x16x64_bf16 v[44:47], v[20:23], a[136:143], v3
  v_max3_u32 v66, v66, v31, v32
  v_smfmac_f32_16x16x64_bf16 v[48:51], v[20:23], a[192:199], v3
  buffer_load_dwordx4 v[100:103], v2, s[8:11], s24 offen offset:1024 sc1
  v_max_u32 v66, v66, v35
  v_smfmac_f32_16x16x64_bf16 v[52:55], v[20:23], a[248:255], v3
  v_cmp_eq_u32 vcc, -1, v66
  v_smfmac_f32_16x16x64_bf16 v[56:59], v[20:23], v[168:175], v3
  v_smfmac_f32_16x16x64_bf16 v[60:63], v[20:23], v[224:231], v3
  s_cbranch_vccnz cB_sc1_r4
cB_sc1_c4:
  v_smfmac_f32_16x16x64_bf16 v[60:63], v[28:31], v[232:239], v3
  buffer_load_dwordx4 v[104:107], v2, s[8:11], s26 offen offset:0 sc1
  v_smfmac_f32_16x16x64_bf16 v[60:63], v[24:27], v[240:247], v3
  v_smfmac_f32_16x16x64_bf16 v[60:63], v[32:35], v[248:255], v3
  v_smfmac_f32_16x16x64_bf16 v[52:55], v[28:31], v[120:127], v3
  v_smfmac_f32_16x16x64_bf16 v[52:55], v[24:27], v[128:135], v3
  buffer_load_dwordx4 v[108:111], v2, s[8:11], s26 offen offset:1024 sc1
  v_smfmac_f32_16x16x64_bf16 v[52:55], v[32:35], v[136:143], v3
  v_cvt_pk_bf16_f32 v63, v62, v63
  v_smfmac_f32_16x16x64_bf16 v[56:59], v[28:31], v[176:183], v3
  v_cvt_pk_bf16_f32 v62, v60, v61
  v_smfmac_f32_16x16x64_bf16 v[56:59], v[24:27], v[184:191], v3
  v_mfma_f32_16x16x32_bf16 v[8:11], v[62:65], v[4:7], 0
  v_cvt_pk_bf16_f32 v55, v54, v55
  v_smfmac_f32_16x16x64_bf16 v[56:59], v[32:35], v[192:199], v3
  v_cvt_pk_bf16_f32 v54, v52, v53
  v_smfmac_f32_16x16x64_bf16 v[36:39], v[28:31], a[32:39], v3
  s_nop 1
  v_cvt_pk_bf16_f32 v78, v8, v9
  v_smfmac_f32_16x16x64_bf16 v[36:39], v[24:27], a[40:47], v3
  v_cvt_pk_bf16_f32 v79, v10, v11
  v_smfmac_f32_16x16x64_bf16 v[36:39], v[32:35], a[48:55], v3
  v_cvt_pk_bf16_f32 v56, v56, v57
  v_smfmac_f32_16x16x64_bf16 v[40:43], v[28:31], a[88:95], v3
  v_cvt_pk_bf16_f32 v57, v58, v59
  v_smfmac_f32_16x16x64_bf16 v[40:43], v[24:27], a[96:103], v3
  v_mfma_f32_16x16x32_bf16 v[16:19], v[54:57], v[4:7], 0
  v_cvt_pk_bf16_f32 v39, v38, v39
  v_smfmac_f32_16x16x64_bf16 v[40:43], v[32:35], a[104:111], v3
  v_cvt_pk_bf16_f32 v38, v36, v37
  v_smfmac_f32_16x16x64_bf16 v[44:47], v[28:31], a[144:151], v3
  s_nop 1
  v_cvt_pk_bf16_f32 v76, v16, v17
  v_smfmac_f32_16x16x64_bf16 v[44:47], v[24:27], a[152:159], v3
  v_cvt_pk_bf16_f32 v77, v18, v19
  v_smfmac_f32_16x16x64_bf16 v[44:47], v[32:35], a[160:167], v3
  v_cvt_pk_bf16_f32 v40, v40, v41
  v_smfmac_f32_16x16x64_bf16 v[48:51], v[28:31], a[200:207], v3
  v_cvt_pk_bf16_f32 v41, v42, v43
  v_smfmac_f32_16x16x64_bf16 v[48:51], v[24:27], a[208:215], v3
  v_smfmac_f32_16x16x64_bf16 v[48:51], v[32:35], a[216:223], v3
  s_waitcnt vmcnt(4)
  v_cvt_pk_bf16_f32 v47, v46, v47
  v_smfmac_f32_16x16x64_bf16 v[68:71], v[76:79], v[80:87], v3
  v_cvt_pk_bf16_f32 v46, v44, v45
  v_mfma_f32_16x16x32_bf16 v[8:11], v[38:41], v[4:7], 0
  s_nop 1
  v_cvt_pk_bf16_f32 v48, v48, v49
  v_cvt_pk_bf16_f32 v49, v50, v51
  s_nop 1
  v_mfma_f32_16x16x32_bf16 v[16:19], v[46:49], v[4:7], 0
  v_smfmac_f32_16x16x64_bf16 v[72:75], v[76:79], v[88:95], v3
  v_cvt_pk_bf16_f32 v20, v8, v9
  v_mfma_f32_16x16x32_bf16 v[52:55], v[30:33], v[76:79], 0
  s_waitcnt vmcnt(0)
  v_cvt_pk_bf16_f32 v21, v10, v11
  v_cvt_pk_bf16_f32 v22, v16, v17
  v_cvt_pk_bf16_f32 v23, v18, v19
  s_nop 1
  v_mfma_f32_16x16x32_bf16 v[52:55], v[12:15], v[20:23], v[52:55]
  v_smfmac_f32_16x16x64_bf16 v[68:71], v[20:23], v[96:103], v3
  v_smfmac_f32_16x16x64_bf16 v[72:75], v[20:23], v[104:111], v3
  s_nop 1
  ds_write_b128 v113, v[52:55]
  s_nop 1
  v_permlane32_swap_b32 v68, v70
  v_permlane32_swap_b32 v69, v71
  v_add_f32 v56, v68, v70
  v_add_f32 v58, v69, v71
  v_permlane32_swap_b32 v72, v74
  v_permlane32_swap_b32 v73, v75
  v_add_f32 v57, v72, v74
  v_add_f32 v59, v73, v75
  ds_write_b128 v2, v[56:59] offset:1024
  v_cmp_u_f32 vcc, v57, v59
  v_mov_b32 v68, 0
  v_mov_b32 v69, 0
  v_mov_b32 v70, 0
  v_mov_b32 v71, 0
  s_cbranch_vccnz cB_sc1_retry
cB_sc1_cont:
  s_add_u32 s24, s24, 28672
  s_add_u32 s26, s26, 28672
  buffer_load_dwordx4 v[80:83], v117, s[8:11], s24 offen offset:0 sc1
  buffer_load_dwordx4 v[84:87], v117, s[8:11], s24 offen offset:1024 sc1
  v_mov_b32 v72, 0
  v_mov_b32 v73, 0
  v_mfma_f32_32x32x16_bf16 v[36:51], v[68:71], v[68:71], 0
  s_waitcnt lgkmcnt(0)
  s_barrier
  ds_read_b64 v[8:9], v114 offset:0
  ds_read_b64 v[10:11], v114 offset:1024
  ds_read_b64 v[12:13], v114 offset:2048
  ds_read_b64 v[14:15], v114 offset:3072
  ds_read2_b32 v[16:17], v115 offset0:0 offset1:64
  ds_read2_b32 v[18:19], v115 offset0:128 offset1:192
  v_mfma_f32_32x32x16_bf16 v[52:67], v[68:71], v[68:71], 0
  s_waitcnt lgkmcnt(0)
  v_pk_add_f32 v[16:17], v[16:17], v[18:19]
  v_pk_add_f32 v[8:9], v[8:9], v[10:11]
  v_pk_add_f32 v[12:13], v[12:13], v[14:15]
  v_add_f32 v20, v16, v17
  v_pk_add_f32 v[8:9], v[8:9], v[12:13]
  v_max_f32 v22, v8, v9
  v_add_f32_dpp v20, v20, v20 row_ror:8 row_mask:0xf bank_mask:0xf
  s_nop 0
  v_max_f32_dpp v22, v22, v22 row_ror:8 row_mask:0xf bank_mask:0xf
  v_max_f32 v22, v22, v20
  buffer_store_dword v112, v116, s[8:11], 0 offen sc1
  s_nop 0
  v_max_f32_dpp v22, v22, v22 quad_perm:[1,0,3,2] row_mask:0xf bank_mask:0xf
  s_nop 1
  v_max_f32_dpp v22, v22, v22 quad_perm:[2,3,0,1] row_mask:0xf bank_mask:0xf
  s_nop 1
  v_max_f32_dpp v22, v22, v22 row_half_mirror row_mask:0xf bank_mask:0xf
  v_pk_add_f32 v[8:9], v[8:9], v[22:23] op_sel_hi:[1,0] neg_lo:[0,1] neg_hi:[0,1]
  v_sub_f32 v20, v20, v22
  v_exp_f32 v8, v8
  v_exp_f32 v9, v9
  v_exp_f32 v20, v20
  v_add_f32 v24, v8, v9
  v_fmac_f32 v24, 0.5, v20
  v_mov_b32_dpp v21, v20 quad_perm:[1,0,3,2] row_mask:0xf bank_mask:0xf
  s_nop 0
  v_add_f32_dpp v24, v24, v24 quad_perm:[1,0,3,2] row_mask:0xf bank_mask:0xf
  s_nop 1
  v_add_f32_dpp v24, v24, v24 quad_perm:[2,3,0,1] row_mask:0xf bank_mask:0xf
  s_nop 1
  v_add_f32_dpp v24, v24, v24 row_half_mirror row_mask:0xf bank_mask:0xf
  s_nop 1
  v_add_f32_dpp v24, v24, v24 row_ror:8 row_mask:0xf bank_mask:0xf
  v_rcp_f32 v24, v24
  s_nop 0
  v_pk_mul_f32 v[8:9], v[8:9], v[24:25] op_sel_hi:[1,0]
  v_cvt_pk_bf16_f32 v8, abs(v8), abs(v9)
  buffer_store_dword v8, v1, s[8:11], s20 offen sc1
  v_pk_mul_f32 v[20:21], v[20:21], v[24:25] op_sel_hi:[1,0]
  v_cvt_pk_bf16_f32 v20, abs(v20), abs(v21)
  buffer_store_dword v20, v118, s[8:11], s20 offen sc1
  v_mov_b32 v74, 0
  v_mov_b32 v75, 0
  s_mov_b32 s19, s18
  s_add_u32 s18, s18, 1
  s_mov_b32 s22, s20
  s_mov_b32 s20, s21
  s_mov_b32 s21, s22
  s_add_u32 s23, s20, 4096
  v_mov_b32 v112, s18
  s_cmp_lt_u32 s19, 63
  s_nop 0
  s_cbranch_scc1 cB_sc1_loop
  s_branch cB_done
cB_sc1_r0:
  s_add_u32 s31, s31, 1
  buffer_load_dwordx4 v[8:11], v2, s[8:11], s20 offen offset:0 sc1
  s_waitcnt vmcnt(0)
  v_cmp_eq_u32 vcc, -1, v8
  v_mov_b32 v36, 0
  v_mov_b32 v37, 0
  v_mov_b32 v38, 0
  v_mov_b32 v39, 0
  v_mov_b32 v40, 0
  v_mov_b32 v41, 0
  v_mov_b32 v42, 0
  v_mov_b32 v43, 0
  v_mov_b32 v44, 0
  v_mov_b32 v45, 0
  v_mov_b32 v46, 0
  v_mov_b32 v47, 0
  v_mov_b32 v48, 0
  v_mov_b32 v49, 0
  v_mov_b32 v50, 0
  v_mov_b32 v51, 0
  s_nop 1
  s_cbranch_vccz cB_sc1_go
  s_add_u32 s30, s30, 1
  s_cmp_lt_u32 s30, 400000
  s_cbranch_scc1 cB_sc1_r0
  s_branch cB_abort
cB_sc1_r1:
  s_add_u32 s31, s31, 1
  buffer_load_dwordx4 v[12:15], v2, s[8:11], s20 offen offset:1024 sc1
  s_waitcnt vmcnt(0)
  v_cmp_eq_u32 vcc, -1, v12
  s_nop 4
  s_cbranch_vccz cB_sc1_c1
  s_add_u32 s30, s30, 1
  s_cmp_lt_u32 s30, 400000
  s_cbranch_scc1 cB_sc1_r1
  s_branch cB_abort
cB_sc1_r2:
  s_add_u32 s31, s31, 1
  buffer_load_dwordx4 v[16:19], v2, s[8:11], s20 offen offset:2048 sc1
  s_waitcnt vmcnt(0)
  v_cmp_eq_u32 vcc, -1, v16
  s_nop 4
  s_cbranch_vccz cB_sc1_c2
  s_add_u32 s30, s30, 1
  s_cmp_lt_u32 s30, 400000
  s_cbranch_scc1 cB_sc1_r2
  s_branch cB_abort
cB_sc1_r3:
  s_add_u32 s31, s31, 1
  buffer_load_dwordx4 v[20:23], v2, s[8:11], s20 offen offset:3072 sc1
  s_waitcnt vmcnt(0)
  v_cmp_eq_u32 vcc, -1, v20
  s_nop 4
  s_cbranch_vccz cB_sc1_c3
  s_add_u32 s30, s30, 1
  s_cmp_lt_u32 s30, 400000
  s_cbranch_scc1 cB_sc1_r3
  s_branch cB_abort
cB_sc1_r4:
  s_add_u32 s31, s31, 1
  buffer_load_dwordx4 v[28:31], v2, s[8:11], s23 offen offset:0 sc1
  buffer_load_dwordx4 v[24:27], v2, s[8:11], s23 offen offset:1024 sc1
  buffer_load_dwordx4 v[32:35], v2, s[8:11], s23 offen offset:2048 sc1
  s_waitcnt vmcnt(0)
  v_max3_u32 v66, v24, v27, v28
  v_max3_u32 v66, v66, v31, v32
  v_max_u32 v66, v66, v35
  v_cmp_eq_u32 vcc, -1, v66
  s_nop 4
  s_cbranch_vccz cB_sc1_c4
  s_add_u32 s30, s30, 1
  s_cmp_lt_u32 s30, 400000
  s_cbranch_scc1 cB_sc1_r4
  s_branch cB_abort
cB_sc1_retry:
  s_cmp_lg_u32 s62, 0
  s_cbranch_scc1 cB_sc1_cont
  s_waitcnt vmcnt(0) lgkmcnt(0)
cB_sc1_rv:
  buffer_load_dwordx4 v[8:11], v2, s[8:11], s20 offen offset:0 sc1
  buffer_load_dwordx4 v[12:15], v2, s[8:11], s20 offen offset:1024 sc1
  buffer_load_dwordx4 v[16:19], v2, s[8:11], s20 offen offset:2048 sc1
  buffer_load_dwordx4 v[20:23], v2, s[8:11], s20 offen offset:3072 sc1
  buffer_load_dwordx4 v[28:31], v2, s[8:11], s23 offen offset:0 sc1
  buffer_load_dwordx4 v[24:27], v2, s[8:11], s23 offen offset:1024 sc1
  buffer_load_dwordx4 v[32:35], v2, s[8:11], s23 offen offset:2048 sc1
  s_waitcnt vmcnt(0)
  v_max3_u32 v66, v8, v9, v10
  v_max3_u32 v66, v66, v11, v12
  v_max3_u32 v66, v66, v13, v14
  v_max3_u32 v66, v66, v15, v16
  v_max3_u32 v66, v66, v17, v18
  v_max3_u32 v66, v66, v19, v20
  v_max3_u32 v66, v66, v21, v22
  v_max3_u32 v66, v66, v23, v24
  v_max3_u32 v66, v66, v25, v26
  v_max3_u32 v66, v66, v27, v28
  v_max3_u32 v66, v66, v29, v30
  v_max3_u32 v66, v66, v31, v32
  v_max3_u32 v66, v66, v33, v34
  v_max_u32 v66, v66, v35
  v_cmp_eq_u32 vcc, -1, v66
  s_cbranch_vccz cB_sc1_rk
  s_add_u32 s30, s30, 1
  s_cmp_lt_u32 s30, 400000
  s_cbranch_scc1 cB_sc1_rv
  s_branch cB_abort
cB_sc1_rk:
  s_mov_b32 s62, 1
  v_mov_b32 v36, 0
  v_mov_b32 v37, 0
  v_mov_b32 v38, 0
  v_mov_b32 v39, 0
  v_mov_b32 v40, 0
  v_mov_b32 v41, 0
  v_mov_b32 v42, 0
  v_mov_b32 v43, 0
  v_mov_b32 v44, 0
  v_mov_b32 v45, 0
  v_mov_b32 v46, 0
  v_mov_b32 v47, 0
  v_mov_b32 v48, 0
  v_mov_b32 v49, 0
  v_mov_b32 v50, 0
  v_mov_b32 v51, 0
  v_mov_b32 v60, 0
  v_mov_b32 v61, 0
  v_mov_b32 v62, 0
  v_mov_b32 v63, 0
  v_mov_b32 v68, 0
  v_mov_b32 v69, 0
  v_mov_b32 v70, 0
  v_mov_b32 v71, 0
  v_mov_b32 v72, 0
  v_mov_b32 v73, 0
  v_mov_b32 v74, 0
  v_mov_b32 v75, 0
  v_mov_b32 v52, 0
  v_mov_b32 v53, 0
  v_mov_b32 v54, 0
  v_mov_b32 v55, 0
  v_mov_b32 v56, 0
  v_mov_b32 v57, 0
  v_mov_b32 v58, 0
  v_mov_b32 v59, 0
  s_add_u32 s31, s31, 0x100
  s_nop 0
  s_branch cB_sc1_go
.p2align 6
cB_sc2_loop:
  s_mov_b32 s30, 0
  s_mov_b32 s62, 0
  s_setprio 3
  s_barrier
  buffer_load_dwordx4 v[8:11], v2, s[8:11], s20 offen offset:0 sc1
  s_setprio 2
  buffer_load_dwordx4 v[12:15], v2, s[8:11], s20 offen offset:1024 sc1
  s_setprio 1
  buffer_load_dwordx4 v[16:19], v2, s[8:11], s20 offen offset:2048 sc1
  s_setprio 0
  buffer_load_dwordx4 v[20:23], v2, s[8:11], s20 offen offset:3072 sc1
cB_sc2_go:
  s_waitcnt vmcnt(3)
  v_smfmac_f32_16x16x64_bf16 v[36:39], v[8:11], a[0:7], v3
  buffer_load_dwordx4 v[24:27], v2, s[8:11], s23 offen offset:0 sc1
  v_cmp_eq_u32 vcc, -1, v8
  v_smfmac_f32_16x16x64_bf16 v[40:43], v[8:11], a[56:63], v3
  v_smfmac_f32_16x16x64_bf16 v[44:47], v[8:11], a[112:119], v3
  buffer_load_dwordx4 v[32:35], v2, s[8:11], s23 offen offset:1024 sc1
  s_cbranch_vccnz cB_sc2_r0
  v_smfmac_f32_16x16x64_bf16 v[48:51], v[8:11], a[168:175], v3
  v_smfmac_f32_16x16x64_bf16 v[52:55], v[8:11], a[224:231], v3
  s_waitcnt vmcnt(4)
  v_cmp_eq_u32 vcc, -1, v12
  v_smfmac_f32_16x16x64_bf16 v[56:59], v[8:11], v[144:151], v3
  buffer_load_dwordx4 v[28:31], v2, s[8:11], s23 offen offset:2048 sc1
  v_smfmac_f32_16x16x64_bf16 v[62:65], v[8:11], v[200:207], v3
  s_cbranch_vccnz cB_sc2_r1
cB_sc2_c1:
  v_smfmac_f32_16x16x64_bf16 v[36:39], v[12:15], a[8:15], v3
  v_smfmac_f32_16x16x64_bf16 v[40:43], v[12:15], a[64:71], v3
  v_smfmac_f32_16x16x64_bf16 v[44:47], v[12:15], a[120:127], v3
  v_smfmac_f32_16x16x64_bf16 v[48:51], v[12:15], a[176:183], v3
  v_smfmac_f32_16x16x64_bf16 v[52:55], v[12:15], a[232:239], v3
  s_waitcnt vmcnt(4)
  v_cmp_eq_u32 vcc, -1, v16
  v_smfmac_f32_16x16x64_bf16 v[56:59], v[12:15], v[152:159], v3
  buffer_load_dwordx4 v[88:91], v117, s[8:11], s26 offen offset:0 sc1
  v_smfmac_f32_16x16x64_bf16 v[62:65], v[12:15], v[208:215], v3
  s_cbranch_vccnz cB_sc2_r2
cB_sc2_c2:
  v_smfmac_f32_16x16x64_bf16 v[36:39], v[16:19], a[16:23], v3
  v_smfmac_f32_16x16x64_bf16 v[40:43], v[16:19], a[72:79], v3
  v_smfmac_f32_16x16x64_bf16 v[44:47], v[16:19], a[128:135], v3
  buffer_load_dwordx4 v[92:95], v117, s[8:11], s26 offen offset:1024 sc1
  v_smfmac_f32_16x16x64_bf16 v[48:51], v[16:19], a[184:191], v3
  v_smfmac_f32_16x16x64_bf16 v[52:55], v[16:19], a[240:247], v3
  s_waitcnt vmcnt(5)
  v_cmp_eq_u32 vcc, -1, v20
  v_smfmac_f32_16x16x64_bf16 v[56:59], v[16:19], v[160:167], v3
  v_smfmac_f32_16x16x64_bf16 v[62:65], v[16:19], v[216:223], v3
  buffer_load_dwordx4 v[96:99], v2, s[8:11], s24 offen offset:0 sc1
  s_cbranch_vccnz cB_sc2_r3
cB_sc2_c3:
  v_smfmac_f32_16x16x64_bf16 v[36:39], v[20:23], a[24:31], v3
  v_smfmac_f32_16x16x64_bf16 v[40:43], v[20:23], a[80:87], v3
  s_waitcnt vmcnt(3)
  v_max3_u32 v66, v24, v27, v28
  v_smfmac_f32_16x16x64_bf16 v[44:47], v[20:23], a[136:143], v3
  v_max3_u32 v66, v66, v31, v32
  v_smfmac_f32_16x16x64_bf16 v[48:51], v[20:23], a[192:199], v3
  buffer_load_dwordx4 v[100:103], v2, s[8:11], s24 offen offset:1024 sc1
  v_max_u32 v66, v66, v35
  v_smfmac_f32_16x16x64_bf16 v[52:55], v[20:23], a[248:255], v3
  v_cmp_eq_u32 vcc, -1, v66
  v_smfmac_f32_16x16x64_bf16 v[56:59], v[20:23], v[168:175], v3
  v_smfmac_f32_16x16x64_bf16 v[62:65], v[20:23], v[224:231], v3
  s_cbranch_vccnz cB_sc2_r4
cB_sc2_c4:
  v_smfmac_f32_16x16x64_bf16 v[62:65], v[24:27], v[232:239], v3
  buffer_load_dwordx4 v[104:107], v2, s[8:11], s26 offen offset:0 sc1
  v_smfmac_f32_16x16x64_bf16 v[62:65], v[32:35], v[240:247], v3
  v_smfmac_f32_16x16x64_bf16 v[62:65], v[28:31], v[248:255], v3
  v_smfmac_f32_16x16x64_bf16 v[52:55], v[24:27], v[120:127], v3
  v_smfmac_f32_16x16x64_bf16 v[52:55], v[32:35], v[128:135], v3
  buffer_load_dwordx4 v[108:111], v2, s[8:11], s26 offen offset:1024 sc1
  v_smfmac_f32_16x16x64_bf16 v[52:55], v[28:31], v[136:143], v3
  v_cvt_pk_bf16_f32 v62, v62, v63
  v_smfmac_f32_16x16x64_bf16 v[56:59], v[24:27], v[176:183], v3
  v_cvt_pk_bf16_f32 v63, v64, v65
  v_smfmac_f32_16x16x64_bf16 v[56:59], v[32:35], v[184:191], v3
  v_mfma_f32_16x16x32_bf16 v[8:11], v[60:63], v[4:7], 0
  v_cvt_pk_bf16_f32 v55, v54, v55
  v_smfmac_f32_16x16x64_bf16 v[56:59], v[28:31], v[192:199], v3
  v_cvt_pk_bf16_f32 v54, v52, v53
  v_smfmac_f32_16x16x64_bf16 v[36:39], v[24:27], a[32:39], v3
  s_nop 1
  v_cvt_pk_bf16_f32 v76, v8, v9
  v_smfmac_f32_16x16x64_bf16 v[36:39], v[32:35], a[40:47], v3
  v_cvt_pk_bf16_f32 v77, v10, v11
  v_smfmac_f32_16x16x64_bf16 v[36:39], v[28:31], a[48:55], v3
  v_cvt_pk_bf16_f32 v56, v56, v57
  v_smfmac_f32_16x16x64_bf16 v[40:43], v[24:27], a[88:95], v3
  v_cvt_pk_bf16_f32 v57, v58, v59
  v_smfmac_f32_16x16x64_bf16 v[40:43], v[32:35], a[96:103], v3
  v_mfma_f32_16x16x32_bf16 v[12:15], v[54:57], v[4:7], 0
  v_cvt_pk_bf16_f32 v39, v38, v39
  v_smfmac_f32_16x16x64_bf16 v[40:43], v[28:31], a[104:111], v3
  v_cvt_pk_bf16_f32 v38, v36, v37
  v_smfmac_f32_16x16x64_bf16 v[44:47], v[24:27], a[144:151], v3
  s_nop 1
  v_cvt_pk_bf16_f32 v78, v12, v13
  v_smfmac_f32_16x16x64_bf16 v[44:47], v[32:35], a[152:159], v3
  v_cvt_pk_bf16_f32 v79, v14, v15
  v_smfmac_f32_16x16x64_bf16 v[44:47], v[28:31], a[160:167], v3
  v_cvt_pk_bf16_f32 v40, v40, v41
  v_smfmac_f32_16x16x64_bf16 v[48:51], v[24:27], a[200:207], v3
  v_cvt_pk_bf16_f32 v41, v42, v43
  v_smfmac_f32_16x16x64_bf16 v[48:51], v[32:35], a[208:215], v3
  v_smfmac_f32_16x16x64_bf16 v[48:51], v[28:31], a[216:223], v3
  s_waitcnt vmcnt(4)
  v_cvt_pk_bf16_f32 v47, v46, v47
  v_smfmac_f32_16x16x64_bf16 v[68:71], v[76:79], v[80:87], v3
  v_cvt_pk_bf16_f32 v46, v44, v45
  v_mfma_f32_16x16x32_bf16 v[8:11], v[38:41], v[4:7], 0
  s_nop 1
  v_cvt_pk_bf16_f32 v48, v48, v49
  v_cvt_pk_bf16_f32 v49, v50, v51
  s_nop 1
  v_mfma_f32_16x16x32_bf16 v[12:15], v[46:49], v[4:7], 0
  v_smfmac_f32_16x16x64_bf16 v[72:75], v[76:79], v[88:95], v3
  v_cvt_pk_bf16_f32 v20, v8, v9
  v_mfma_f32_16x16x32_bf16 v[52:55], v[30:33], v[76:79], 0
  s_waitcnt vmcnt(0)
  v_cvt_pk_bf16_f32 v21, v10, v11
  v_cvt_pk_bf16_f32 v22, v12, v13
  v_cvt_pk_bf16_f32 v23, v14, v15
  s_nop 1
  v_mfma_f32_16x16x32_bf16 v[52:55], v[16:19], v[20:23], v[52:55]
  v_smfmac_f32_16x16x64_bf16 v[68:71], v[20:23], v[96:103], v3
  v_smfmac_f32_16x16x64_bf16 v[72:75], v[20:23], v[104:111], v3
  s_nop 1
  ds_write_b128 v113, v[52:55]
  s_nop 1
  v_permlane32_swap_b32 v68, v70
  v_permlane32_swap_b32 v69, v71
  v_add_f32 v56, v68, v70
  v_add_f32 v58, v69, v71
  v_permlane32_swap_b32 v72, v74
  v_permlane32_swap_b32 v73, v75
  v_add_f32 v57, v72, v74
  v_add_f32 v59, v73, v75
  ds_write_b128 v2, v[56:59] offset:2048
  v_cmp_u_f32 vcc, v57, v59
  v_mov_b32 v68, 0
  v_mov_b32 v69, 0
  v_mov_b32 v70, 0
  v_mov_b32 v71, 0
  s_cbranch_vccnz cB_sc2_retry
cB_sc2_cont:
  s_add_u32 s24, s24, 28672
  s_add_u32 s26, s26, 28672
  buffer_load_dwordx4 v[80:83], v117, s[8:11], s24 offen offset:0 sc1
  buffer_load_dwordx4 v[84:87], v117, s[8:11], s24 offen offset:1024 sc1
  v_mov_b32 v72, 0
  v_mov_b32 v73, 0
  v_mfma_f32_32x32x16_bf16 v[36:51], v[68:71], v[68:71], 0
  s_waitcnt lgkmcnt(0)
  s_barrier
  v_mfma_f32_32x32x16_bf16 v[52:67], v[68:71], v[68:71], 0
  buffer_store_dwordx2 v[118:119], v114, s[8:11], s21 offen sc1
  buffer_store_dwordx2 v[118:119], v115, s[8:11], s21 offen sc1
  s_buffer_load_dword s70, s[8:11], s35
  s_add_u32 s22, s24, 114688
  s_buffer_load_dword s71, s[8:11], s22
  s_mul_i32 s22, s18, 7168
  s_add_u32 s22, s22, 87040
  s_buffer_load_dword s72, s[8:11], s22
  s_add_u32 s35, s35, 458752
  v_mov_b32 v74, 0
  v_mov_b32 v75, 0
  s_mov_b32 s19, s18
  s_add_u32 s18, s18, 1
  s_mov_b32 s22, s20
  s_mov_b32 s20, s21
  s_mov_b32 s21, s22
  s_add_u32 s23, s20, 4096
  s_cmp_lt_u32 s19, 63
  s_cbranch_scc1 cB_sc2_loop
  s_branch cB_done
cB_sc2_r0:
  s_add_u32 s31, s31, 1
  buffer_load_dwordx4 v[8:11], v2, s[8:11], s20 offen offset:0 sc1
  s_waitcnt vmcnt(0)
  v_cmp_eq_u32 vcc, -1, v8
  v_mov_b32 v36, 0
  v_mov_b32 v37, 0
  v_mov_b32 v38, 0
  v_mov_b32 v39, 0
  v_mov_b32 v40, 0
  v_mov_b32 v41, 0
  v_mov_b32 v42, 0
  v_mov_b32 v43, 0
  v_mov_b32 v44, 0
  v_mov_b32 v45, 0
  v_mov_b32 v46, 0
  v_mov_b32 v47, 0
  v_mov_b32 v48, 0
  v_mov_b32 v49, 0
  v_mov_b32 v50, 0
  v_mov_b32 v51, 0
  s_nop 1
  s_cbranch_vccz cB_sc2_go
  s_add_u32 s30, s30, 1
  s_cmp_lt_u32 s30, 400000
  s_cbranch_scc1 cB_sc2_r0
  s_branch cB_abort
cB_sc2_r1:
  s_add_u32 s31, s31, 1
  buffer_load_dwordx4 v[12:15], v2, s[8:11], s20 offen offset:1024 sc1
  s_waitcnt vmcnt(0)
  v_cmp_eq_u32 vcc, -1, v12
  s_nop 4
  s_cbranch_vccz cB_sc2_c1
  s_add_u32 s30, s30, 1
  s_cmp_lt_u32 s30, 400000
  s_cbranch_scc1 cB_sc2_r1
  s_branch cB_abort
cB_sc2_r2:
  s_add_u32 s31, s31, 1
  buffer_load_dwordx4 v[16:19], v2, s[8:11], s20 offen offset:2048 sc1
  s_waitcnt vmcnt(0)
  v_cmp_eq_u32 vcc, -1, v16
  s_nop 4
  s_cbranch_vccz cB_sc2_c2
  s_add_u32 s30, s30, 1
  s_cmp_lt_u32 s30, 400000
  s_cbranch_scc1 cB_sc2_r2
  s_branch cB_abort
cB_sc2_r3:
  s_add_u32 s31, s31, 1
  buffer_load_dwordx4 v[20:23], v2, s[8:11], s20 offen offset:3072 sc1
  s_waitcnt vmcnt(0)
  v_cmp_eq_u32 vcc, -1, v20
  s_nop 4
  s_cbranch_vccz cB_sc2_c3
  s_add_u32 s30, s30, 1
  s_cmp_lt_u32 s30, 400000
  s_cbranch_scc1 cB_sc2_r3
  s_branch cB_abort
cB_sc2_r4:
  s_add_u32 s31, s31, 1
  buffer_load_dwordx4 v[24:27], v2, s[8:11], s23 offen offset:0 sc1
  buffer_load_dwordx4 v[32:35], v2, s[8:11], s23 offen offset:1024 sc1
  buffer_load_dwordx4 v[28:31], v2, s[8:11], s23 offen offset:2048 sc1
  s_waitcnt vmcnt(0)
  v_max3_u32 v66, v24, v27, v28
  v_max3_u32 v66, v66, v31, v32
  v_max_u32 v66, v66, v35
  v_cmp_eq_u32 vcc, -1, v66
  s_nop 4
  s_cbranch_vccz cB_sc2_c4
  s_add_u32 s30, s30, 1
  s_cmp_lt_u32 s30, 400000
  s_cbranch_scc1 cB_sc2_r4
  s_branch cB_abort
cB_sc2_retry:
  s_cmp_lg_u32 s62, 0
  s_cbranch_scc1 cB_sc2_cont
  s_waitcnt vmcnt(0) lgkmcnt(0)
cB_sc2_rv:
  buffer_load_dwordx4 v[8:11], v2, s[8:11], s20 offen offset:0 sc1
  buffer_load_dwordx4 v[12:15], v2, s[8:11], s20 offen offset:1024 sc1
  buffer_load_dwordx4 v[16:19], v2, s[8:11], s20 offen offset:2048 sc1
  buffer_load_dwordx4 v[20:23], v2, s[8:11], s20 offen offset:3072 sc1
  buffer_load_dwordx4 v[24:27], v2, s[8:11], s23 offen offset:0 sc1
  buffer_load_dwordx4 v[32:35], v2, s[8:11], s23 offen offset:1024 sc1
  buffer_load_dwordx4 v[28:31], v2, s[8:11], s23 offen offset:2048 sc1
  s_waitcnt vmcnt(0)
  v_max3_u32 v66, v8, v9, v10
  v_max3_u32 v66, v66, v11, v12
  v_max3_u32 v66, v66, v13, v14
  v_max3_u32 v66, v66, v15, v16
  v_max3_u32 v66, v66, v17, v18
  v_max3_u32 v66, v66, v19, v20
  v_max3_u32 v66, v66, v21, v22
  v_max3_u32 v66, v66, v23, v24
  v_max3_u32 v66, v66, v25, v26
  v_max3_u32 v66, v66, v27, v28
  v_max3_u32 v66, v66, v29, v30
  v_max3_u32 v66, v66, v31, v32
  v_max3_u32 v66, v66, v33, v34
  v_max_u32 v66, v66, v35
  v_cmp_eq_u32 vcc, -1, v66
  s_cbranch_vccz cB_sc2_rk
  s_add_u32 s30, s30, 1
  s_cmp_lt_u32 s30, 400000
  s_cbranch_scc1 cB_sc2_rv
  s_branch cB_abort
cB_sc2_rk:
  s_mov_b32 s62, 1
  v_mov_b32 v36, 0
  v_mov_b32 v37, 0
  v_mov_b32 v38, 0
  v_mov_b32 v39, 0
  v_mov_b32 v40, 0
  v_mov_b32 v41, 0
  v_mov_b32 v42, 0
  v_mov_b32 v43, 0
  v_mov_b32 v44, 0
  v_mov_b32 v45, 0
  v_mov_b32 v46, 0
  v_mov_b32 v47, 0
  v_mov_b32 v48, 0
  v_mov_b32 v49, 0
  v_mov_b32 v50, 0
  v_mov_b32 v51, 0
  v_mov_b32 v62, 0
  v_mov_b32 v63, 0
  v_mov_b32 v64, 0
  v_mov_b32 v65, 0
  v_mov_b32 v68, 0
  v_mov_b32 v69, 0
  v_mov_b32 v70, 0
  v_mov_b32 v71, 0
  v_mov_b32 v72, 0
  v_mov_b32 v73, 0
  v_mov_b32 v74, 0
  v_mov_b32 v75, 0
  v_mov_b32 v52, 0
  v_mov_b32 v53, 0
  v_mov_b32 v54, 0
  v_mov_b32 v55, 0
  v_mov_b32 v56, 0
  v_mov_b32 v57, 0
  v_mov_b32 v58, 0
  v_mov_b32 v59, 0
  s_add_u32 s31, s31, 0x100
  s_nop 0
  s_branch cB_sc2_go
.p2align 6
cB_sc3_loop:
  s_mov_b32 s30, 0
  s_mov_b32 s62, 0
  s_setprio 3
  s_barrier
  buffer_load_dwordx4 v[8:11], v2, s[8:11], s20 offen offset:0 sc1
  s_setprio 2
  buffer_load_dwordx4 v[12:15], v2, s[8:11], s20 offen offset:1024 sc1
  s_setprio 1
  buffer_load_dwordx4 v[16:19], v2, s[8:11], s20 offen offset:2048 sc1
  s_setprio 0
  buffer_load_dwordx4 v[20:23], v2, s[8:11], s20 offen offset:3072 sc1
cB_sc3_go:
  s_waitcnt vmcnt(3)
  v_smfmac_f32_16x16x64_bf16 v[36:39], v[8:11], a[0:7], v3
  buffer_load_dwordx4 v[24:27], v2, s[8:11], s23 offen offset:0 sc1
  v_cmp_eq_u32 vcc, -1, v8
  v_smfmac_f32_16x16x64_bf16 v[40:43], v[8:11], a[56:63], v3
  v_smfmac_f32_16x16x64_bf16 v[44:47], v[8:11], a[112:119], v3
  buffer_load_dwordx4 v[28:31], v2, s[8:11], s23 offen offset:1024 sc1
  s_cbranch_vccnz cB_sc3_r0
  v_smfmac_f32_16x16x64_bf16 v[48:51], v[8:11], a[168:175], v3
  v_smfmac_f32_16x16x64_bf16 v[52:55], v[8:11], a[224:231], v3
  s_waitcnt vmcnt(4)
  v_cmp_eq_u32 vcc, -1, v12
  v_smfmac_f32_16x16x64_bf16 v[56:59], v[8:11], v[144:151], v3
  buffer_load_dwordx4 v[32:35], v2, s[8:11], s23 offen offset:2048 sc1
  v_smfmac_f32_16x16x64_bf16 v[62:65], v[8:11], v[200:207], v3
  s_cbranch_vccnz cB_sc3_r1
cB_sc3_c1:
  v_smfmac_f32_16x16x64_bf16 v[36:39], v[12:15], a[8:15], v3
  v_smfmac_f32_16x16x64_bf16 v[40:43], v[12:15], a[64:71], v3
  v_smfmac_f32_16x16x64_bf16 v[44:47], v[12:15], a[120:127], v3
  v_smfmac_f32_16x16x64_bf16 v[48:51], v[12:15], a[176:183], v3
  v_smfmac_f32_16x16x64_bf16 v[52:55], v[12:15], a[232:239], v3
  s_waitcnt vmcnt(4)
  v_cmp_eq_u32 vcc, -1, v16
  v_smfmac_f32_16x16x64_bf16 v[56:59], v[12:15], v[152:159], v3
  buffer_load_dwordx4 v[88:91], v117, s[8:11], s26 offen offset:0 sc1
  v_smfmac_f32_16x16x64_bf16 v[62:65], v[12:15], v[208:215], v3
  s_cbranch_vccnz cB_sc3_r2
cB_sc3_c2:
  v_smfmac_f32_16x16x64_bf16 v[36:39], v[16:19], a[16:23], v3
  v_smfmac_f32_16x16x64_bf16 v[40:43], v[16:19], a[72:79], v3
  v_smfmac_f32_16x16x64_bf16 v[44:47], v[16:19], a[128:135], v3
  buffer_load_dwordx4 v[92:95], v117, s[8:11], s26 offen offset:1024 sc1
  v_smfmac_f32_16x16x64_bf16 v[48:51], v[16:19], a[184:191], v3
  v_smfmac_f32_16x16x64_bf16 v[52:55], v[16:19], a[240:247], v3
  s_waitcnt vmcnt(5)
  v_cmp_eq_u32 vcc, -1, v20
  v_smfmac_f32_16x16x64_bf16 v[56:59], v[16:19], v[160:167], v3
  v_smfmac_f32_16x16x64_bf16 v[62:65], v[16:19], v[216:223], v3
  buffer_load_dwordx4 v[96:99], v2, s[8:11], s24 offen offset:0 sc1
  s_cbranch_vccnz cB_sc3_r3
cB_sc3_c3:
  v_smfmac_f32_16x16x64_bf16 v[36:39], v[20:23], a[24:31], v3
  v_smfmac_f32_16x16x64_bf16 v[40:43], v[20:23], a[80:87], v3
  s_waitcnt vmcnt(3)
  v_max3_u32 v66, v24, v27, v28
  v_smfmac_f32_16x16x64_bf16 v[44:47], v[20:23], a[136:143], v3
  v_max3_u32 v66, v66, v31, v32
  v_smfmac_f32_16x16x64_bf16 v[48:51], v[20:23], a[192:199], v3
  buffer_load_dwordx4 v[100:103], v2, s[8:11], s24 offen offset:1024 sc1
  v_max_u32 v66, v66, v35
  v_smfmac_f32_16x16x64_bf16 v[52:55], v[20:23], a[248:255], v3
  v_cmp_eq_u32 vcc, -1, v66
  v_smfmac_f32_16x16x64_bf16 v[56:59], v[20:23], v[168:175], v3
  v_smfmac_f32_16x16x64_bf16 v[62:65], v[20:23], v[224:231], v3
  s_cbranch_vccnz cB_sc3_r4
cB_sc3_c4:
  v_smfmac_f32_16x16x64_bf16 v[62:65], v[24:27], v[232:239], v3
  buffer_load_dwordx4 v[104:107], v2, s[8:11], s26 offen offset:0 sc1
  v_smfmac_f32_16x16x64_bf16 v[62:65], v[28:31], v[240:247], v3
  v_smfmac_f32_16x16x64_bf16 v[62:65], v[32:35], v[248:255], v3
  v_smfmac_f32_16x16x64_bf16 v[52:55], v[24:27], v[120:127], v3
  v_smfmac_f32_16x16x64_bf16 v[52:55], v[28:31], v[128:135], v3
  buffer_load_dwordx4 v[108:111], v2, s[8:11], s26 offen offset:1024 sc1
  v_smfmac_f32_16x16x64_bf16 v[52:55], v[32:35], v[136:143], v3
  v_cvt_pk_bf16_f32 v62, v62, v63
  v_smfmac_f32_16x16x64_bf16 v[56:59], v[24:27], v[176:183], v3
  v_cvt_pk_bf16_f32 v63, v64, v65
  v_smfmac_f32_16x16x64_bf16 v[56:59], v[28:31], v[184:191], v3
  v_mfma_f32_16x16x32_bf16 v[8:11], v[60:63], v[4:7], 0
  v_cvt_pk_bf16_f32 v55, v54, v55
  v_smfmac_f32_16x16x64_bf16 v[56:59], v[32:35], v[192:199], v3
  v_cvt_pk_bf16_f32 v54, v52, v53
  v_smfmac_f32_16x16x64_bf16 v[36:39], v[24:27], a[32:39], v3
  s_nop 1
  v_cvt_pk_bf16_f32 v78, v8, v9
  v_smfmac_f32_16x16x64_bf16 v[36:39], v[28:31], a[40:47], v3
  v_cvt_pk_bf16_f32 v79, v10, v11
  v_smfmac_f32_16x16x64_bf16 v[36:39], v[32:35], a[48:55], v3
  v_cvt_pk_bf16_f32 v56, v56, v57
  v_smfmac_f32_16x16x64_bf16 v[40:43], v[24:27], a[88:95], v3
  v_cvt_pk_bf16_f32 v57, v58, v59
  v_smfmac_f32_16x16x64_bf16 v[40:43], v[28:31], a[96:103], v3
  v_mfma_f32_16x16x32_bf16 v[12:15], v[54:57], v[4:7], 0
  v_cvt_pk_bf16_f32 v39, v38, v39
  v_smfmac_f32_16x16x64_bf16 v[40:43], v[32:35], a[104:111], v3
  v_cvt_pk_bf16_f32 v38, v36, v37
  v_smfmac_f32_16x16x64_bf16 v[44:47], v[24:27], a[144:151], v3
  s_nop 1
  v_cvt_pk_bf16_f32 v76, v12, v13
  v_smfmac_f32_16x16x64_bf16 v[44:47], v[28:31], a[152:159], v3
  v_cvt_pk_bf16_f32 v77, v14, v15
  v_smfmac_f32_16x16x64_bf16 v[44:47], v[32:35], a[160:167], v3
  v_cvt_pk_bf16_f32 v40, v40, v41
  v_smfmac_f32_16x16x64_bf16 v[48:51], v[24:27], a[200:207], v3
  v_cvt_pk_bf16_f32 v41, v42, v43
  v_smfmac_f32_16x16x64_bf16 v[48:51], v[28:31], a[208:215], v3
  v_smfmac_f32_16x16x64_bf16 v[48:51], v[32:35], a[216:223], v3
  s_waitcnt vmcnt(4)
  v_cvt_pk_bf16_f32 v47, v46, v47
  v_smfmac_f32_16x16x64_bf16 v[68:71], v[76:79], v[80:87], v3
  v_cvt_pk_bf16_f32 v46, v44, v45
  v_mfma_f32_16x16x32_bf16 v[8:11], v[38:41], v[4:7], 0
  s_nop 1
  v_cvt_pk_bf16_f32 v48, v48, v49
  v_cvt_pk_bf16_f32 v49, v50, v51
  s_nop 1
  v_mfma_f32_16x16x32_bf16 v[12:15], v[46:49], v[4:7], 0
  v_smfmac_f32_16x16x64_bf16 v[72:75], v[76:79], v[88:95], v3
  v_cvt_pk_bf16_f32 v16, v8, v9
  v_mfma_f32_16x16x32_bf16 v[52:55], v[30:33], v[76:79], 0
  s_waitcnt vmcnt(0)
  v_cvt_pk_bf16_f32 v17, v10, v11
  v_cvt_pk_bf16_f32 v18, v12, v13
  v_cvt_pk_bf16_f32 v19, v14, v15
  s_nop 1
  v_mfma_f32_16x16x32_bf16 v[52:55], v[20:23], v[16:19], v[52:55]
  v_smfmac_f32_16x16x64_bf16 v[68:71], v[16:19], v[96:103], v3
  v_smfmac_f32_16x16x64_bf16 v[72:75], v[16:19], v[104:111], v3
  s_nop 1
  ds_write_b128 v113, v[52:55]
  s_nop 1
  v_permlane32_swap_b32 v68, v70
  v_permlane32_swap_b32 v69, v71
  v_add_f32 v56, v68, v70
  v_add_f32 v58, v69, v71
  v_permlane32_swap_b32 v72, v74
  v_permlane32_swap_b32 v73, v75
  v_add_f32 v57, v72, v74
  v_add_f32 v59, v73, v75
  ds_write_b128 v2, v[56:59] offset:3072
  v_cmp_u_f32 vcc, v57, v59
  v_mov_b32 v68, 0
  v_mov_b32 v69, 0
  v_mov_b32 v70, 0
  v_mov_b32 v71, 0
  s_cbranch_vccnz cB_sc3_retry
cB_sc3_cont:
  s_add_u32 s24, s24, 28672
  s_add_u32 s26, s26, 28672
  buffer_load_dwordx4 v[80:83], v117, s[8:11], s24 offen offset:0 sc1
  buffer_load_dwordx4 v[84:87], v117, s[8:11], s24 offen offset:1024 sc1
  v_mov_b32 v72, 0
  v_mov_b32 v73, 0
  v_mfma_f32_16x16x32_bf16 v[62:65], v[68:71], v[68:71], 0
  s_waitcnt lgkmcnt(0)
  s_barrier
  v_mov_b32 v52, 0
  v_mov_b32 v53, 0
  v_mov_b32 v54, 0
  v_mov_b32 v55, 0
  v_mov_b32 v56, 0
  v_mov_b32 v57, 0
  v_mov_b32 v58, 0
  v_mov_b32 v59, 0
  v_mfma_f32_32x32x16_bf16 v[36:51], v[68:71], v[68:71], 0
  v_mov_b32 v74, 0
  v_mov_b32 v75, 0
  s_mov_b32 s19, s18
  s_add_u32 s18, s18, 1
  s_mov_b32 s22, s20
  s_mov_b32 s20, s21
  s_mov_b32 s21, s22
  s_add_u32 s23, s20, 4096
  s_cmp_lt_u32 s19, 63
  s_nop 2
  s_cbranch_scc1 cB_sc3_loop
  s_branch cB_done
cB_sc3_r0:
  s_add_u32 s31, s31, 1
  buffer_load_dwordx4 v[8:11], v2, s[8:11], s20 offen offset:0 sc1
  s_waitcnt vmcnt(0)
  v_cmp_eq_u32 vcc, -1, v8
  v_mov_b32 v36, 0
  v_mov_b32 v37, 0
  v_mov_b32 v38, 0
  v_mov_b32 v39, 0
  v_mov_b32 v40, 0
  v_mov_b32 v41, 0
  v_mov_b32 v42, 0
  v_mov_b32 v43, 0
  v_mov_b32 v44, 0
  v_mov_b32 v45, 0
  v_mov_b32 v46, 0
  v_mov_b32 v47, 0
  v_mov_b32 v48, 0
  v_mov_b32 v49, 0
  v_mov_b32 v50, 0
  v_mov_b32 v51, 0
  s_nop 1
  s_cbranch_vccz cB_sc3_go
  s_add_u32 s30, s30, 1
  s_cmp_lt_u32 s30, 400000
  s_cbranch_scc1 cB_sc3_r0
  s_branch cB_abort
cB_sc3_r1:
  s_add_u32 s31, s31, 1
  buffer_load_dwordx4 v[12:15], v2, s[8:11], s20 offen offset:1024 sc1
  s_waitcnt vmcnt(0)
  v_cmp_eq_u32 vcc, -1, v12
  s_nop 4
  s_cbranch_vccz cB_sc3_c1
  s_add_u32 s30, s30, 1
  s_cmp_lt_u32 s30, 400000
  s_cbranch_scc1 cB_sc3_r1
  s_branch cB_abort
cB_sc3_r2:
  s_add_u32 s31, s31, 1
  buffer_load_dwordx4 v[16:19], v2, s[8:11], s20 offen offset:2048 sc1
  s_waitcnt vmcnt(0)
  v_cmp_eq_u32 vcc, -1, v16
  s_nop 4
  s_cbranch_vccz cB_sc3_c2
  s_add_u32 s30, s30, 1
  s_cmp_lt_u32 s30, 400000
  s_cbranch_scc1 cB_sc3_r2
  s_branch cB_abort
cB_sc3_r3:
  s_add_u32 s31, s31, 1
  buffer_load_dwordx4 v[20:23], v2, s[8:11], s20 offen offset:3072 sc1
  s_waitcnt vmcnt(0)
  v_cmp_eq_u32 vcc, -1, v20
  s_nop 4
  s_cbranch_vccz cB_sc3_c3
  s_add_u32 s30, s30, 1
  s_cmp_lt_u32 s30, 400000
  s_cbranch_scc1 cB_sc3_r3
  s_branch cB_abort
cB_sc3_r4:
  s_add_u32 s31, s31, 1
  buffer_load_dwordx4 v[24:27], v2, s[8:11], s23 offen offset:0 sc1
  buffer_load_dwordx4 v[28:31], v2, s[8:11], s23 offen offset:1024 sc1
  buffer_load_dwordx4 v[32:35], v2, s[8:11], s23 offen offset:2048 sc1
  s_waitcnt vmcnt(0)
  v_max3_u32 v66, v24, v27, v28
  v_max3_u32 v66, v66, v31, v32
  v_max_u32 v66, v66, v35
  v_cmp_eq_u32 vcc, -1, v66
  s_nop 4
  s_cbranch_vccz cB_sc3_c4
  s_add_u32 s30, s30, 1
  s_cmp_lt_u32 s30, 400000
  s_cbranch_scc1 cB_sc3_r4
  s_branch cB_abort
cB_sc3_retry:
  s_cmp_lg_u32 s62, 0
  s_cbranch_scc1 cB_sc3_cont
  s_waitcnt vmcnt(0) lgkmcnt(0)
cB_sc3_rv:
  buffer_load_dwordx4 v[8:11], v2, s[8:11], s20 offen offset:0 sc1
  buffer_load_dwordx4 v[12:15], v2, s[8:11], s20 offen offset:1024 sc1
  buffer_load_dwordx4 v[16:19], v2, s[8:11], s20 offen offset:2048 sc1
  buffer_load_dwordx4 v[20:23], v2, s[8:11], s20 offen offset:3072 sc1
  buffer_load_dwordx4 v[24:27], v2, s[8:11], s23 offen offset:0 sc1
  buffer_load_dwordx4 v[28:31], v2, s[8:11], s23 offen offset:1024 sc1
  buffer_load_dwordx4 v[32:35], v2, s[8:11], s23 offen offset:2048 sc1
  s_waitcnt vmcnt(0)
  v_max3_u32 v66, v8, v9, v10
  v_max3_u32 v66, v66, v11, v12
  v_max3_u32 v66, v66, v13, v14
  v_max3_u32 v66, v66, v15, v16
  v_max3_u32 v66, v66, v17, v18
  v_max3_u32 v66, v66, v19, v20
  v_max3_u32 v66, v66, v21, v22
  v_max3_u32 v66, v66, v23, v24
  v_max3_u32 v66, v66, v25, v26
  v_max3_u32 v66, v66, v27, v28
  v_max3_u32 v66, v66, v29, v30
  v_max3_u32 v66, v66, v31, v32
  v_max3_u32 v66, v66, v33, v34
  v_max_u32 v66, v66, v35
  v_cmp_eq_u32 vcc, -1, v66
  s_cbranch_vccz cB_sc3_rk
  s_add_u32 s30, s30, 1
  s_cmp_lt_u32 s30, 400000
  s_cbranch_scc1 cB_sc3_rv
  s_branch cB_abort
cB_sc3_rk:
  s_mov_b32 s62, 1
  v_mov_b32 v36, 0
  v_mov_b32 v37, 0
  v_mov_b32 v38, 0
  v_mov_b32 v39, 0
  v_mov_b32 v40, 0
  v_mov_b32 v41, 0
  v_mov_b32 v42, 0
  v_mov_b32 v43, 0
  v_mov_b32 v44, 0
  v_mov_b32 v45, 0
  v_mov_b32 v46, 0
  v_mov_b32 v47, 0
  v_mov_b32 v48, 0
  v_mov_b32 v49, 0
  v_mov_b32 v50, 0
  v_mov_b32 v51, 0
  v_mov_b32 v62, 0
  v_mov_b32 v63, 0
  v_mov_b32 v64, 0
  v_mov_b32 v65, 0
  v_mov_b32 v68, 0
  v_mov_b32 v69, 0
  v_mov_b32 v70, 0
  v_mov_b32 v71, 0
  v_mov_b32 v72, 0
  v_mov_b32 v73, 0
  v_mov_b32 v74, 0
  v_mov_b32 v75, 0
  v_mov_b32 v52, 0
  v_mov_b32 v53, 0
  v_mov_b32 v54, 0
  v_mov_b32 v55, 0
  v_mov_b32 v56, 0
  v_mov_b32 v57, 0
  v_mov_b32 v58, 0
  v_mov_b32 v59, 0
  s_add_u32 s31, s31, 0x100
  s_nop 0
  s_branch cB_sc3_go
.p2align 6
cB_va0_loop:
  s_mov_b32 s30, 0
  s_barrier
  buffer_load_dwordx4 v[24:27], v2, s[8:11], s23 offen offset:0 sc1
  buffer_load_dwordx4 v[28:31], v2, s[8:11], s23 offen offset:1024 sc1
  s_barrier
  s_cmp_lt_u32 s19, 60
  s_cbranch_scc1 cB_va0_m1
  buffer_store_dword v160, v1, s[8:11], s38 offen sc1
  s_cmp_lg_u32 s19, 63
  s_cbranch_scc1 cB_va0_m2
  v_min_u32 v64, -2, v64
  v_min_u32 v65, -2, v65
  v_min_u32 v66, -2, v66
  v_min_u32 v67, -2, v67
  v_min_u32 v68, -2, v68
  v_min_u32 v69, -2, v69
  v_min_u32 v70, -2, v70
  v_min_u32 v71, -2, v71
  v_min_u32 v72, -2, v72
  v_min_u32 v73, -2, v73
  v_min_u32 v74, -2, v74
  v_min_u32 v75, -2, v75
  v_min_u32 v76, -2, v76
  v_min_u32 v77, -2, v77
  v_min_u32 v78, -2, v78
  v_min_u32 v79, -2, v79
  buffer_store_dwordx4 v[64:67], v2, s[8:11], s33 offen offset:0 sc1
  buffer_store_dwordx4 v[68:71], v2, s[8:11], s33 offen offset:2048 sc1
  s_add_u32 s33, s33, 4096
  buffer_store_dwordx4 v[72:75], v2, s[8:11], s33 offen offset:0 sc1
  buffer_store_dwordx4 v[76:79], v2, s[8:11], s33 offen offset:2048 sc1
  s_add_u32 s33, s33, 4096
  s_waitcnt vmcnt(5)
  s_branch cB_va0_m3
cB_va0_m1:
  buffer_store_dword v160, v1, s[8:11], s38 offen sc1
cB_va0_m2:
  s_add_u32 s22, s25, 0
  buffer_load_dwordx4 v[80:83], v6, s[8:11], s22 offen offset:0 sc1
  buffer_load_dwordx4 v[84:87], v6, s[8:11], s22 offen offset:1792 sc1
  s_add_u32 s22, s25, 3584
  buffer_load_dwordx4 v[88:91], v6, s[8:11], s22 offen offset:0 sc1
  buffer_load_dwordx4 v[92:95], v6, s[8:11], s22 offen offset:1792 sc1
  s_add_u32 s22, s25, 7168
  buffer_load_dwordx4 v[96:99], v6, s[8:11], s22 offen offset:0 sc1
  s_mul_i32 s38, s18, 7168
  s_add_u32 s38, s38, 65536
  s_waitcnt vmcnt(6)
cB_va0_m3:
  ds_write_b128 v2, v[24:27] offset:12288
  ds_write_b128 v2, v[28:31] offset:13312
  v_smfmac_f32_16x16x64_bf16 v[36:39], v[24:27], a[32:39], v3
  buffer_load_dwordx4 v[100:103], v6, s[8:11], s22 offen offset:1792 sc1
  v_smfmac_f32_16x16x64_bf16 v[40:43], v[24:27], a[88:95], v3
  s_add_u32 s22, s25, 10752
  buffer_load_dwordx4 v[104:107], v6, s[8:11], s22 offen offset:0 sc1
  v_smfmac_f32_16x16x64_bf16 v[44:47], v[24:27], a[144:151], v3
  buffer_load_dwordx4 v[108:111], v6, s[8:11], s22 offen offset:1792 sc1
  v_smfmac_f32_16x16x64_bf16 v[48:51], v[24:27], a[200:207], v3
  s_add_u32 s22, s25, 14336
  buffer_load_dwordx4 v[112:115], v6, s[8:11], s22 offen offset:0 sc1
  v_smfmac_f32_16x16x64_bf16 v[52:55], v[24:27], v[176:183], v3
  s_waitcnt lgkmcnt(0)
  s_barrier
  ds_read_b128 v[8:11], v2 offset:8192
  ds_read_b128 v[12:15], v2 offset:9216
  ds_read_b128 v[16:19], v2 offset:10240
  ds_read_b128 v[20:23], v2 offset:11264
  ds_read_b128 v[32:35], v2 offset:14336
  buffer_load_dwordx4 v[116:119], v6, s[8:11], s22 offen offset:1792 sc1
  v_smfmac_f32_16x16x64_bf16 v[56:59], v[24:27], v[232:239], v3
  s_add_u32 s22, s25, 17920
  buffer_load_dwordx4 v[120:123], v6, s[8:11], s22 offen offset:0 sc1
  v_smfmac_f32_16x16x64_bf16 v[36:39], v[28:31], a[40:47], v3
  buffer_load_dwordx4 v[124:127], v6, s[8:11], s22 offen offset:1792 sc1
  v_smfmac_f32_16x16x64_bf16 v[40:43], v[28:31], a[96:103], v3
  s_add_u32 s22, s25, 21504
  buffer_load_dwordx4 v[128:131], v6, s[8:11], s22 offen offset:0 sc1
  v_smfmac_f32_16x16x64_bf16 v[44:47], v[28:31], a[152:159], v3
  buffer_load_dwordx4 v[132:135], v6, s[8:11], s22 offen offset:1792 sc1
  v_smfmac_f32_16x16x64_bf16 v[48:51], v[28:31], a[208:215], v3
  s_add_u32 s22, s25, 25088
  buffer_load_dwordx4 v[136:139], v6, s[8:11], s22 offen offset:0 sc1
  v_smfmac_f32_16x16x64_bf16 v[52:55], v[28:31], v[184:191], v3
  buffer_load_dwordx4 v[140:143], v6, s[8:11], s22 offen offset:1792 sc1
  v_smfmac_f32_16x16x64_bf16 v[56:59], v[28:31], v[240:247], v3
  s_waitcnt lgkmcnt(4)
  v_smfmac_f32_16x16x64_bf16 v[36:39], v[8:11], a[0:7], v3
  s_waitcnt lgkmcnt(3)
  v_smfmac_f32_16x16x64_bf16 v[36:39], v[12:15], a[8:15], v3
  s_waitcnt lgkmcnt(2)
  v_smfmac_f32_16x16x64_bf16 v[36:39], v[16:19], a[16:23], v3
  s_waitcnt lgkmcnt(1)
  v_smfmac_f32_16x16x64_bf16 v[36:39], v[20:23], a[24:31], v3
  s_waitcnt lgkmcnt(0)
  v_smfmac_f32_16x16x64_bf16 v[36:39], v[32:35], a[48:55], v3
  v_smfmac_f32_16x16x64_bf16 v[40:43], v[8:11], a[56:63], v3
  v_smfmac_f32_16x16x64_bf16 v[40:43], v[12:15], a[64:71], v3
  v_smfmac_f32_16x16x64_bf16 v[40:43], v[16:19], a[72:79], v3
  v_permlane32_swap_b32 v36, v38
  v_smfmac_f32_16x16x64_bf16 v[40:43], v[20:23], a[80:87], v3
  v_permlane32_swap_b32 v37, v39
  v_smfmac_f32_16x16x64_bf16 v[40:43], v[32:35], a[104:111], v3
  v_add_f32 v36, v36, v38
  v_smfmac_f32_16x16x64_bf16 v[44:47], v[8:11], a[112:119], v3
  v_add_f32 v37, v37, v39
  v_smfmac_f32_16x16x64_bf16 v[44:47], v[12:15], a[120:127], v3
  v_cmp_u_f32 vcc, v36, v37
  v_smfmac_f32_16x16x64_bf16 v[44:47], v[16:19], a[128:135], v3
  v_cvt_pk_bf16_f32 v38, v36, v37
  v_smfmac_f32_16x16x64_bf16 v[44:47], v[20:23], a[136:143], v3
  ds_write_b32 v152, v38
  s_cbranch_vccnz cB_va0_slow
  v_permlane32_swap_b32 v40, v42
  v_smfmac_f32_16x16x64_bf16 v[44:47], v[32:35], a[160:167], v3
  v_permlane32_swap_b32 v41, v43
  v_smfmac_f32_16x16x64_bf16 v[48:51], v[8:11], a[168:175], v3
  buffer_store_dword v162, v1, s[8:11], s21 offen sc1
  v_add_f32 v40, v40, v42
  v_smfmac_f32_16x16x64_bf16 v[48:51], v[12:15], a[176:183], v3
  v_add_f32 v41, v41, v43
  v_smfmac_f32_16x16x64_bf16 v[48:51], v[16:19], a[184:191], v3
  buffer_load_dword v164, v4, s[8:11], 0 offen sc1
  v_cvt_pk_bf16_f32 v42, v40, v41
  v_smfmac_f32_16x16x64_bf16 v[48:51], v[20:23], a[192:199], v3
  ds_write_b32 v153, v42
  v_permlane32_swap_b32 v44, v46
  v_smfmac_f32_16x16x64_bf16 v[48:51], v[32:35], a[216:223], v3
  v_permlane32_swap_b32 v45, v47
  v_smfmac_f32_16x16x64_bf16 v[52:55], v[8:11], a[224:231], v3
  buffer_load_dword v164, v4, s[8:11], 0 offen sc1
  v_add_f32 v44, v44, v46
  v_smfmac_f32_16x16x64_bf16 v[52:55], v[12:15], a[232:239], v3
  v_add_f32 v45, v45, v47
  v_smfmac_f32_16x16x64_bf16 v[52:55], v[16:19], a[240:247], v3
  v_cvt_pk_bf16_f32 v46, v44, v45
  v_smfmac_f32_16x16x64_bf16 v[52:55], v[20:23], a[248:255], v3
  ds_write_b32 v154, v46
  buffer_load_dword v164, v4, s[8:11], 0 offen sc1
  v_permlane32_swap_b32 v48, v50
  v_smfmac_f32_16x16x64_bf16 v[52:55], v[32:35], v[192:199], v3
  v_permlane32_swap_b32 v49, v51
  v_smfmac_f32_16x16x64_bf16 v[56:59], v[8:11], v[200:207], v3
  v_add_f32 v48, v48, v50
  v_smfmac_f32_16x16x64_bf16 v[56:59], v[12:15], v[208:215], v3
  buffer_load_dword v164, v4, s[8:11], 0 offen sc1
  v_add_f32 v49, v49, v51
  v_smfmac_f32_16x16x64_bf16 v[56:59], v[16:19], v[216:223], v3
  v_cvt_pk_bf16_f32 v50, v48, v49
  v_smfmac_f32_16x16x64_bf16 v[56:59], v[20:23], v[224:231], v3
  ds_write_b32 v155, v50
  v_permlane32_swap_b32 v52, v54
  v_smfmac_f32_16x16x64_bf16 v[56:59], v[32:35], v[248:255], v3
  buffer_load_dword v164, v4, s[8:11], 0 offen sc1
  v_permlane32_swap_b32 v53, v55
  v_add_f32 v52, v52, v54
  v_add_f32 v53, v53, v55
  v_cvt_pk_bf16_f32 v54, v52, v53
  ds_write_b32 v156, v54
  s_nop 1
  v_permlane32_swap_b32 v56, v58
  v_permlane32_swap_b32 v57, v59
  v_add_f32 v56, v56, v58
  v_add_f32 v57, v57, v59
  v_cvt_pk_bf16_f32 v58, v56, v57
  ds_write_b32 v157, v58
cB_va0_t2d:
  s_add_u32 s22, s20, 9216
  s_add_u32 s34, s20, 13312
  s_add_u32 s36, s20, 7168
  s_mov_b32 s37, 0
  v_mov_b32 v48, 0
  v_mov_b32 v49, 0
  v_mov_b32 v50, 0
  v_mov_b32 v51, 0
  v_mov_b32 v163, s18
  s_cmp_eq_u32 s19, 63
  s_waitcnt lgkmcnt(0)
  s_cbranch_scc1 cB_va0_last
  s_setprio 3
cB_va0_fw_l:
  v_cmp_gt_u32 vcc, s18, v164
  buffer_load_dword v164, v4, s[8:11], 0 offen sc1
  s_cbranch_vccz cB_va0_fw_d
  v_cmp_gt_u32 vcc, s18, v164
  buffer_load_dword v164, v4, s[8:11], 0 offen sc1
  s_cbranch_vccz cB_va0_fw_d
  v_cmp_gt_u32 vcc, s18, v164
  buffer_load_dword v164, v4, s[8:11], 0 offen sc1
  s_cbranch_vccz cB_va0_fw_d
  v_cmp_gt_u32 vcc, s18, v164
  buffer_load_dword v164, v4, s[8:11], 0 offen sc1
  s_cbranch_vccz cB_va0_fw_d
  v_cmp_gt_u32 vcc, s18, v164
  buffer_load_dword v164, v4, s[8:11], 0 offen sc1
  s_cbranch_vccz cB_va0_fw_d
  v_cmp_gt_u32 vcc, s18, v164
  buffer_load_dword v164, v4, s[8:11], 0 offen sc1
  s_cbranch_vccz cB_va0_fw_d
  v_cmp_gt_u32 vcc, s18, v164
  buffer_load_dword v164, v4, s[8:11], 0 offen sc1
  s_cbranch_vccz cB_va0_fw_d
  v_cmp_gt_u32 vcc, s18, v164
  buffer_load_dword v164, v4, s[8:11], 0 offen sc1
  s_cbranch_vccz cB_va0_fw_d
  v_cmp_gt_u32 vcc, s18, v164
  buffer_load_dword v164, v4, s[8:11], 0 offen sc1
  s_cbranch_vccz cB_va0_fw_d
  v_cmp_gt_u32 vcc, s18, v164
  buffer_load_dword v164, v4, s[8:11], 0 offen sc1
  s_cbranch_vccz cB_va0_fw_d
  v_cmp_gt_u32 vcc, s18, v164
  buffer_load_dword v164, v4, s[8:11], 0 offen sc1
  s_cbranch_vccz cB_va0_fw_d
  v_cmp_gt_u32 vcc, s18, v164
  buffer_load_dword v164, v4, s[8:11], 0 offen sc1
  s_cbranch_vccz cB_va0_fw_d
  v_cmp_gt_u32 vcc, s18, v164
  buffer_load_dword v164, v4, s[8:11], 0 offen sc1
  s_cbranch_vccz cB_va0_fw_d
  v_cmp_gt_u32 vcc, s18, v164
  buffer_load_dword v164, v4, s[8:11], 0 offen sc1
  s_cbranch_vccz cB_va0_fw_d
  v_cmp_gt_u32 vcc, s18, v164
  buffer_load_dword v164, v4, s[8:11], 0 offen sc1
  s_cbranch_vccz cB_va0_fw_d
  v_cmp_gt_u32 vcc, s18, v164
  buffer_load_dword v164, v4, s[8:11], 0 offen sc1
  s_cbranch_vccz cB_va0_fw_d
  s_waitcnt vmcnt(24)
  s_add_u32 s30, s30, 1
  s_cmp_lt_u32 s30, 400000
  s_cbranch_scc1 cB_va0_fw_l
  s_branch cB_abort
cB_va0_fw_d:
  buffer_load_dwordx4 v[8:11], v2, s[8:11], s22 offen offset:0 sc1
  buffer_load_dwordx4 v[12:15], v2, s[8:11], s22 offen offset:1024 sc1
  buffer_load_dwordx4 v[16:19], v2, s[8:11], s22 offen offset:2048 sc1
  buffer_load_dwordx4 v[20:23], v2, s[8:11], s22 offen offset:3072 sc1
  buffer_load_dwordx4 v[24:27], v2, s[8:11], s34 offen offset:0 sc1
  buffer_load_dwordx4 v[28:31], v2, s[8:11], s34 offen offset:1024 sc1
  buffer_load_dwordx4 v[32:35], v2, s[8:11], s34 offen offset:2048 sc1
  buffer_load_dwordx4 v[36:39], v2, s[8:11], s34 offen offset:3072 sc1
  buffer_load_dwordx4 v[40:43], v2, s[8:11], s36 offen offset:0 sc1
  buffer_load_dwordx4 v[44:47], v2, s[8:11], s36 offen offset:1024 sc1
  s_barrier
  ds_read_b128 v[64:67], v2 offset:0
  ds_read_b128 v[68:71], v2 offset:1024
  ds_read_b128 v[72:75], v2 offset:2048
  ds_read_b128 v[76:79], v2 offset:3072
cB_va0_lp:
  s_waitcnt vmcnt(9)
  v_smfmac_f32_16x16x64_bf16 v[48:51], v[8:11], v[80:87], v3
  s_waitcnt vmcnt(8)
  v_smfmac_f32_16x16x64_bf16 v[48:51], v[12:15], v[88:95], v3
  s_waitcnt vmcnt(7)
  v_smfmac_f32_16x16x64_bf16 v[48:51], v[16:19], v[96:103], v3
  s_waitcnt vmcnt(6)
  v_smfmac_f32_16x16x64_bf16 v[48:51], v[20:23], v[104:111], v3
  s_waitcnt vmcnt(5)
  v_smfmac_f32_16x16x64_bf16 v[48:51], v[24:27], v[112:119], v3
  s_waitcnt vmcnt(4)
  v_smfmac_f32_16x16x64_bf16 v[48:51], v[28:31], v[120:127], v3
  s_waitcnt vmcnt(3)
  v_smfmac_f32_16x16x64_bf16 v[48:51], v[32:35], v[128:135], v3
  s_waitcnt vmcnt(2)
  v_smfmac_f32_16x16x64_bf16 v[48:51], v[36:39], v[136:143], v3
  s_waitcnt vmcnt(1) lgkmcnt(0)
  v_smfmac_f32_16x16x64_bf16 v[48:51], v[40:43], v[64:71], v3
  s_waitcnt vmcnt(0)
  v_smfmac_f32_16x16x64_bf16 v[48:51], v[44:47], v[72:79], v3
  s_nop 7
  v_permlane32_swap_b32 v48, v50
  v_permlane32_swap_b32 v49, v51
  v_pk_add_f32 v[48:49], v[48:49], v[50:51]
  v_cvt_pk_bf16_f32 v160, v48, v49
  v_cmp_u_f32 vcc, v48, v49
  s_nop 0
  v_mov_b32_dpp v161, v160 quad_perm:[1,0,3,2] row_mask:0xf bank_mask:0xf
  v_perm_b32 v160, v161, v160, v5
  v_cndmask_b32 v161, v160, v162, vcc
  buffer_store_dword v161, v1, s[8:11], s21 offen sc1
  s_cbranch_vccnz cB_va0_rp
cB_va0_cont:
  s_setprio 0
  s_cmp_lg_u32 s19, 62
  s_cbranch_scc1 cB_va0_nl
  s_sleep 4
  buffer_store_dword v160, v1, s[8:11], s38 offen sc1
  s_mov_b32 s38, 0x40000000
  s_mov_b32 s25, 0x40000000
cB_va0_nl:
  s_add_u32 s25, s25, 458752
  v_mov_b32 v36, 0
  v_mov_b32 v37, 0
  v_mov_b32 v38, 0
  v_mov_b32 v39, 0
  v_mov_b32 v40, 0
  v_mov_b32 v41, 0
  v_mov_b32 v42, 0
  v_mov_b32 v43, 0
  v_mov_b32 v44, 0
  v_mov_b32 v45, 0
  v_mov_b32 v46, 0
  v_mov_b32 v47, 0
  v_mov_b32 v48, 0
  v_mov_b32 v49, 0
  v_mov_b32 v50, 0
  v_mov_b32 v51, 0
  v_mov_b32 v52, 0
  v_mov_b32 v53, 0
  v_mov_b32 v54, 0
  v_mov_b32 v55, 0
  v_mov_b32 v56, 0
  v_mov_b32 v57, 0
  v_mov_b32 v58, 0
  v_mov_b32 v59, 0
  v_mov_b32 v60, 0
  v_mov_b32 v61, 0
  v_mov_b32 v62, 0
  v_mov_b32 v63, 0
  s_mov_b32 s19, s18
  s_add_u32 s18, s18, 1
  s_mov_b32 s22, s20
  s_mov_b32 s20, s21
  s_mov_b32 s21, s22
  s_add_u32 s23, s20, 4096
  s_branch cB_va0_loop
cB_va0_slow:
  s_waitcnt lgkmcnt(0)
cB_va0_sl1:
  s_add_u32 s31, s31, 0x1000000
  buffer_load_dwordx4 v[8:11], v2, s[8:11], s20 offen offset:0 sc1
  buffer_load_dwordx4 v[12:15], v2, s[8:11], s20 offen offset:1024 sc1
  buffer_load_dwordx4 v[16:19], v2, s[8:11], s20 offen offset:2048 sc1
  buffer_load_dwordx4 v[20:23], v2, s[8:11], s20 offen offset:3072 sc1
  buffer_load_dwordx4 v[24:27], v2, s[8:11], s23 offen offset:0 sc1
  buffer_load_dwordx4 v[28:31], v2, s[8:11], s23 offen offset:1024 sc1
  buffer_load_dwordx4 v[32:35], v2, s[8:11], s23 offen offset:2048 sc1
  s_waitcnt vmcnt(0)
  v_max3_u32 v36, v8, v9, v10
  v_max3_u32 v36, v36, v11, v12
  v_max3_u32 v36, v36, v13, v14
  v_max3_u32 v36, v36, v15, v16
  v_max3_u32 v36, v36, v17, v18
  v_max3_u32 v36, v36, v19, v20
  v_max3_u32 v36, v36, v21, v22
  v_max3_u32 v36, v36, v23, v24
  v_max3_u32 v36, v36, v25, v26
  v_max3_u32 v36, v36, v27, v28
  v_max3_u32 v36, v36, v29, v30
  v_max3_u32 v36, v36, v31, v32
  v_max3_u32 v36, v36, v33, v34
  v_max_u32 v36, v36, v35
  v_cmp_eq_u32 vcc, -1, v36
  s_cbranch_vccz cB_va0_sl2
  s_add_u32 s30, s30, 1
  s_cmp_lt_u32 s30, 400000
  s_cbranch_scc1 cB_va0_sl1
  s_branch cB_abort
cB_va0_sl2:
  v_mov_b32 v36, 0
  v_mov_b32 v37, 0
  v_mov_b32 v38, 0
  v_mov_b32 v39, 0
  v_mov_b32 v40, 0
  v_mov_b32 v41, 0
  v_mov_b32 v42, 0
  v_mov_b32 v43, 0
  v_mov_b32 v44, 0
  v_mov_b32 v45, 0
  v_mov_b32 v46, 0
  v_mov_b32 v47, 0
  v_mov_b32 v48, 0
  v_mov_b32 v49, 0
  v_mov_b32 v50, 0
  v_mov_b32 v51, 0
  v_mov_b32 v52, 0
  v_mov_b32 v53, 0
  v_mov_b32 v54, 0
  v_mov_b32 v55, 0
  v_mov_b32 v56, 0
  v_mov_b32 v57, 0
  v_mov_b32 v58, 0
  v_mov_b32 v59, 0
  v_mov_b32 v60, 0
  v_mov_b32 v61, 0
  v_mov_b32 v62, 0
  v_mov_b32 v63, 0
  buffer_store_dword v162, v1, s[8:11], s21 offen sc1
  v_smfmac_f32_16x16x64_bf16 v[36:39], v[8:11], a[0:7], v3
  v_smfmac_f32_16x16x64_bf16 v[40:43], v[8:11], a[56:63], v3
  v_smfmac_f32_16x16x64_bf16 v[44:47], v[8:11], a[112:119], v3
  v_smfmac_f32_16x16x64_bf16 v[48:51], v[8:11], a[168:175], v3
  v_smfmac_f32_16x16x64_bf16 v[52:55], v[8:11], a[224:231], v3
  v_smfmac_f32_16x16x64_bf16 v[56:59], v[8:11], v[200:207], v3
  v_smfmac_f32_16x16x64_bf16 v[36:39], v[12:15], a[8:15], v3
  v_smfmac_f32_16x16x64_bf16 v[40:43], v[12:15], a[64:71], v3
  v_smfmac_f32_16x16x64_bf16 v[44:47], v[12:15], a[120:127], v3
  v_smfmac_f32_16x16x64_bf16 v[48:51], v[12:15], a[176:183], v3
  v_smfmac_f32_16x16x64_bf16 v[52:55], v[12:15], a[232:239], v3
  v_smfmac_f32_16x16x64_bf16 v[56:59], v[12:15], v[208:215], v3
  v_smfmac_f32_16x16x64_bf16 v[36:39], v[16:19], a[16:23], v3
  v_smfmac_f32_16x16x64_bf16 v[40:43], v[16:19], a[72:79], v3
  v_smfmac_f32_16x16x64_bf16 v[44:47], v[16:19], a[128:135], v3
  v_smfmac_f32_16x16x64_bf16 v[48:51], v[16:19], a[184:191], v3
  v_smfmac_f32_16x16x64_bf16 v[52:55], v[16:19], a[240:247], v3
  v_smfmac_f32_16x16x64_bf16 v[56:59], v[16:19], v[216:223], v3
  v_smfmac_f32_16x16x64_bf16 v[36:39], v[20:23], a[24:31], v3
  v_smfmac_f32_16x16x64_bf16 v[40:43], v[20:23], a[80:87], v3
  v_smfmac_f32_16x16x64_bf16 v[44:47], v[20:23], a[136:143], v3
  v_smfmac_f32_16x16x64_bf16 v[48:51], v[20:23], a[192:199], v3
  v_smfmac_f32_16x16x64_bf16 v[52:55], v[20:23], a[248:255], v3
  v_smfmac_f32_16x16x64_bf16 v[56:59], v[20:23], v[224:231], v3
  v_smfmac_f32_16x16x64_bf16 v[36:39], v[24:27], a[32:39], v3
  v_smfmac_f32_16x16x64_bf16 v[40:43], v[24:27], a[88:95], v3
  v_smfmac_f32_16x16x64_bf16 v[44:47], v[24:27], a[144:151], v3
  v_smfmac_f32_16x16x64_bf16 v[48:51], v[24:27], a[200:207], v3
  v_smfmac_f32_16x16x64_bf16 v[52:55], v[24:27], v[176:183], v3
  v_smfmac_f32_16x16x64_bf16 v[56:59], v[24:27], v[232:239], v3
  v_smfmac_f32_16x16x64_bf16 v[36:39], v[28:31], a[40:47], v3
  v_smfmac_f32_16x16x64_bf16 v[40:43], v[28:31], a[96:103], v3
  v_smfmac_f32_16x16x64_bf16 v[44:47], v[28:31], a[152:159], v3
  v_smfmac_f32_16x16x64_bf16 v[48:51], v[28:31], a[208:215], v3
  v_smfmac_f32_16x16x64_bf16 v[52:55], v[28:31], v[184:191], v3
  v_smfmac_f32_16x16x64_bf16 v[56:59], v[28:31], v[240:247], v3
  v_smfmac_f32_16x16x64_bf16 v[36:39], v[32:35], a[48:55], v3
  v_smfmac_f32_16x16x64_bf16 v[40:43], v[32:35], a[104:111], v3
  v_smfmac_f32_16x16x64_bf16 v[44:47], v[32:35], a[160:167], v3
  v_smfmac_f32_16x16x64_bf16 v[48:51], v[32:35], a[216:223], v3
  v_smfmac_f32_16x16x64_bf16 v[52:55], v[32:35], v[192:199], v3
  v_smfmac_f32_16x16x64_bf16 v[56:59], v[32:35], v[248:255], v3
  v_permlane32_swap_b32 v36, v38
  v_permlane32_swap_b32 v37, v39
  v_add_f32 v36, v36, v38
  v_add_f32 v37, v37, v39
  v_cvt_pk_bf16_f32 v38, v36, v37
  ds_write_b32 v152, v38
  v_permlane32_swap_b32 v40, v42
  v_permlane32_swap_b32 v41, v43
  v_add_f32 v40, v40, v42
  v_add_f32 v41, v41, v43
  v_cvt_pk_bf16_f32 v42, v40, v41
  ds_write_b32 v153, v42
  v_permlane32_swap_b32 v44, v46
  v_permlane32_swap_b32 v45, v47
  v_add_f32 v44, v44, v46
  v_add_f32 v45, v45, v47
  v_cvt_pk_bf16_f32 v46, v44, v45
  ds_write_b32 v154, v46
  v_permlane32_swap_b32 v48, v50
  v_permlane32_swap_b32 v49, v51
  v_add_f32 v48, v48, v50
  v_add_f32 v49, v49, v51
  v_cvt_pk_bf16_f32 v50, v48, v49
  ds_write_b32 v155, v50
  v_permlane32_swap_b32 v52, v54
  v_permlane32_swap_b32 v53, v55
  v_add_f32 v52, v52, v54
  v_add_f32 v53, v53, v55
  v_cvt_pk_bf16_f32 v54, v52, v53
  ds_write_b32 v156, v54
  v_permlane32_swap_b32 v56, v58
  v_permlane32_swap_b32 v57, v59
  v_add_f32 v56, v56, v58
  v_add_f32 v57, v57, v59
  v_cvt_pk_bf16_f32 v58, v56, v57
  ds_write_b32 v157, v58
  buffer_load_dword v164, v4, s[8:11], 0 offen sc1
  buffer_load_dword v164, v4, s[8:11], 0 offen sc1
  buffer_load_dword v164, v4, s[8:11], 0 offen sc1
  buffer_load_dword v164, v4, s[8:11], 0 offen sc1
  buffer_load_dword v164, v4, s[8:11], 0 offen sc1
  s_branch cB_va0_t2d
cB_va0_last:
  s_barrier
  ds_read_b128 v[64:67], v2 offset:0
  ds_read_b128 v[68:71], v2 offset:1024
  ds_read_b128 v[72:75], v2 offset:2048
  ds_read_b128 v[76:79], v2 offset:3072
  s_waitcnt lgkmcnt(0)
  v_min_u32 v64, -2, v64
  v_min_u32 v65, -2, v65
  v_min_u32 v66, -2, v66
  v_min_u32 v67, -2, v67
  v_min_u32 v68, -2, v68
  v_min_u32 v69, -2, v69
  v_min_u32 v70, -2, v70
  v_min_u32 v71, -2, v71
  v_min_u32 v72, -2, v72
  v_min_u32 v73, -2, v73
  v_min_u32 v74, -2, v74
  v_min_u32 v75, -2, v75
  v_min_u32 v76, -2, v76
  v_min_u32 v77, -2, v77
  v_min_u32 v78, -2, v78
  v_min_u32 v79, -2, v79
  buffer_store_dwordx4 v[64:67], v2, s[8:11], s33 offen offset:0 sc1
  buffer_store_dwordx4 v[68:71], v2, s[8:11], s33 offen offset:2048 sc1
  s_add_u32 s33, s33, 4096
  buffer_store_dwordx4 v[72:75], v2, s[8:11], s33 offen offset:0 sc1
  buffer_store_dwordx4 v[76:79], v2, s[8:11], s33 offen offset:2048 sc1
  s_add_u32 s33, s33, 4096
  s_waitcnt vmcnt(0)
  buffer_wbl2 sc1
  s_branch cB_done
cB_va0_rp:
  s_cmp_eq_u32 s37, 0
  s_cbranch_scc1 cB_va0_rv
  v_min_u32 v160, -2, v160
  buffer_store_dword v160, v1, s[8:11], s21 offen sc1
  s_branch cB_va0_cont
cB_va0_rv:
  s_add_u32 s31, s31, 0x10000
  buffer_load_dwordx4 v[8:11], v2, s[8:11], s22 offen offset:0 sc1
  buffer_load_dwordx4 v[12:15], v2, s[8:11], s22 offen offset:1024 sc1
  buffer_load_dwordx4 v[16:19], v2, s[8:11], s22 offen offset:2048 sc1
  buffer_load_dwordx4 v[20:23], v2, s[8:11], s22 offen offset:3072 sc1
  buffer_load_dwordx4 v[24:27], v2, s[8:11], s34 offen offset:0 sc1
  buffer_load_dwordx4 v[28:31], v2, s[8:11], s34 offen offset:1024 sc1
  buffer_load_dwordx4 v[32:35], v2, s[8:11], s34 offen offset:2048 sc1
  buffer_load_dwordx4 v[36:39], v2, s[8:11], s34 offen offset:3072 sc1
  buffer_load_dwordx4 v[40:43], v2, s[8:11], s36 offen offset:0 sc1
  buffer_load_dwordx4 v[44:47], v2, s[8:11], s36 offen offset:1024 sc1
  s_waitcnt vmcnt(0)
  v_max3_u32 v52, v8, v9, v10
  v_max3_u32 v52, v52, v11, v12
  v_max3_u32 v52, v52, v13, v14
  v_max3_u32 v52, v52, v15, v16
  v_max3_u32 v52, v52, v17, v18
  v_max3_u32 v52, v52, v19, v20
  v_max3_u32 v52, v52, v21, v22
  v_max3_u32 v52, v52, v23, v24
  v_max3_u32 v52, v52, v25, v26
  v_max3_u32 v52, v52, v27, v28
  v_max3_u32 v52, v52, v29, v30
  v_max3_u32 v52, v52, v31, v32
  v_max3_u32 v52, v52, v33, v34
  v_max3_u32 v52, v52, v35, v36
  v_max3_u32 v52, v52, v37, v38
  v_max3_u32 v52, v52, v39, v40
  v_max3_u32 v52, v52, v41, v42
  v_max3_u32 v52, v52, v43, v44
  v_max3_u32 v52, v52, v45, v46
  v_max_u32 v52, v52, v47
  v_cmp_eq_u32 vcc, -1, v52
  s_mov_b32 s37, 1
  v_mov_b32 v48, 0
  v_mov_b32 v49, 0
  v_mov_b32 v50, 0
  v_mov_b32 v51, 0
  s_nop 1
  s_cbranch_vccz cB_va0_lp
  s_add_u32 s30, s30, 1
  s_cmp_lt_u32 s30, 400000
  s_cbranch_scc1 cB_va0_rv
  s_branch cB_abort
.p2align 6
cB_va1_loop:
  s_mov_b32 s30, 0
  s_barrier
  buffer_load_dwordx4 v[28:31], v2, s[8:11], s23 offen offset:1024 sc1
  buffer_load_dwordx4 v[32:35], v2, s[8:11], s23 offen offset:2048 sc1
  s_barrier
  s_cmp_lt_u32 s19, 60
  s_cbranch_scc1 cB_va1_m1
  buffer_store_dword v160, v1, s[8:11], s38 offen sc1
  s_cmp_lg_u32 s19, 63
  s_cbranch_scc1 cB_va1_m2
  v_min_u32 v64, -2, v64
  v_min_u32 v65, -2, v65
  v_min_u32 v66, -2, v66
  v_min_u32 v67, -2, v67
  v_min_u32 v68, -2, v68
  v_min_u32 v69, -2, v69
  v_min_u32 v70, -2, v70
  v_min_u32 v71, -2, v71
  v_min_u32 v72, -2, v72
  v_min_u32 v73, -2, v73
  v_min_u32 v74, -2, v74
  v_min_u32 v75, -2, v75
  v_min_u32 v76, -2, v76
  v_min_u32 v77, -2, v77
  v_min_u32 v78, -2, v78
  v_min_u32 v79, -2, v79
  buffer_store_dwordx4 v[64:67], v2, s[8:11], s33 offen offset:0 sc1
  buffer_store_dwordx4 v[68:71], v2, s[8:11], s33 offen offset:2048 sc1
  s_add_u32 s33, s33, 4096
  buffer_store_dwordx4 v[72:75], v2, s[8:11], s33 offen offset:0 sc1
  buffer_store_dwordx4 v[76:79], v2, s[8:11], s33 offen offset:2048 sc1
  s_add_u32 s33, s33, 4096
  s_waitcnt vmcnt(5)
  s_branch cB_va1_m3
cB_va1_m1:
  buffer_store_dword v160, v1, s[8:11], s38 offen sc1
cB_va1_m2:
  s_add_u32 s22, s25, 0
  buffer_load_dwordx4 v[80:83], v6, s[8:11], s22 offen offset:0 sc1
  buffer_load_dwordx4 v[84:87], v6, s[8:11], s22 offen offset:1792 sc1
  s_add_u32 s22, s25, 3584
  buffer_load_dwordx4 v[88:91], v6, s[8:11], s22 offen offset:0 sc1
  buffer_load_dwordx4 v[92:95], v6, s[8:11], s22 offen offset:1792 sc1
  s_add_u32 s22, s25, 7168
  buffer_load_dwordx4 v[96:99], v6, s[8:11], s22 offen offset:0 sc1
  s_mul_i32 s38, s18, 7168
  s_add_u32 s38, s38, 65536
  s_waitcnt vmcnt(6)
cB_va1_m3:
  ds_write_b128 v2, v[32:35] offset:14336
  v_smfmac_f32_16x16x64_bf16 v[36:39], v[28:31], a[40:47], v3
  buffer_load_dwordx4 v[100:103], v6, s[8:11], s22 offen offset:1792 sc1
  v_smfmac_f32_16x16x64_bf16 v[40:43], v[28:31], a[96:103], v3
  s_add_u32 s22, s25, 10752
  buffer_load_dwordx4 v[104:107], v6, s[8:11], s22 offen offset:0 sc1
  v_smfmac_f32_16x16x64_bf16 v[44:47], v[28:31], a[152:159], v3
  buffer_load_dwordx4 v[108:111], v6, s[8:11], s22 offen offset:1792 sc1
  v_smfmac_f32_16x16x64_bf16 v[48:51], v[28:31], a[208:215], v3
  s_add_u32 s22, s25, 14336
  buffer_load_dwordx4 v[112:115], v6, s[8:11], s22 offen offset:0 sc1
  v_smfmac_f32_16x16x64_bf16 v[52:55], v[28:31], v[184:191], v3
  s_waitcnt lgkmcnt(0)
  s_barrier
  ds_read_b128 v[8:11], v2 offset:8192
  ds_read_b128 v[12:15], v2 offset:9216
  ds_read_b128 v[16:19], v2 offset:10240
  ds_read_b128 v[20:23], v2 offset:11264
  ds_read_b128 v[24:27], v2 offset:12288
  buffer_load_dwordx4 v[116:119], v6, s[8:11], s22 offen offset:1792 sc1
  v_smfmac_f32_16x16x64_bf16 v[56:59], v[28:31], v[240:247], v3
  s_add_u32 s22, s25, 17920
  buffer_load_dwordx4 v[120:123], v6, s[8:11], s22 offen offset:0 sc1
  v_smfmac_f32_16x16x64_bf16 v[36:39], v[32:35], a[48:55], v3
  buffer_load_dwordx4 v[124:127], v6, s[8:11], s22 offen offset:1792 sc1
  v_smfmac_f32_16x16x64_bf16 v[40:43], v[32:35], a[104:111], v3
  s_add_u32 s22, s25, 21504
  buffer_load_dwordx4 v[128:131], v6, s[8:11], s22 offen offset:0 sc1
  v_smfmac_f32_16x16x64_bf16 v[44:47], v[32:35], a[160:167], v3
  buffer_load_dwordx4 v[132:135], v6, s[8:11], s22 offen offset:1792 sc1
  v_smfmac_f32_16x16x64_bf16 v[48:51], v[32:35], a[216:223], v3
  s_add_u32 s22, s25, 25088
  buffer_load_dwordx4 v[136:139], v6, s[8:11], s22 offen offset:0 sc1
  v_smfmac_f32_16x16x64_bf16 v[52:55], v[32:35], v[192:199], v3
  ds_read_b128 v[64:67], v0 offset:0
  ds_read_b128 v[68:71], v0 offset:1024
  buffer_load_dwordx4 v[140:143], v6, s[8:11], s22 offen offset:1792 sc1
  v_smfmac_f32_16x16x64_bf16 v[56:59], v[32:35], v[248:255], v3
  s_waitcnt lgkmcnt(6)
  ds_read_b128 v[72:75], v0 offset:2048
  ds_read_b128 v[76:79], v0 offset:3072
  v_smfmac_f32_16x16x64_bf16 v[36:39], v[8:11], a[0:7], v3
  s_waitcnt lgkmcnt(7)
  v_smfmac_f32_16x16x64_bf16 v[36:39], v[12:15], a[8:15], v3
  s_waitcnt lgkmcnt(6)
  v_smfmac_f32_16x16x64_bf16 v[36:39], v[16:19], a[16:23], v3
  s_waitcnt lgkmcnt(2)
  v_smfmac_f32_16x16x64_bf16 v[60:63], v[8:11], v[64:71], v3
  s_waitcnt lgkmcnt(5)
  ds_read_b128 v[144:147], v0 offset:4096
  ds_read_b128 v[148:151], v0 offset:5120
  v_smfmac_f32_16x16x64_bf16 v[36:39], v[20:23], a[24:31], v3
  s_waitcnt lgkmcnt(6)
  v_smfmac_f32_16x16x64_bf16 v[36:39], v[24:27], a[32:39], v3
  v_smfmac_f32_16x16x64_bf16 v[40:43], v[8:11], a[56:63], v3
  s_waitcnt lgkmcnt(2)
  v_smfmac_f32_16x16x64_bf16 v[60:63], v[12:15], v[72:79], v3
  ds_read_b128 v[64:67], v0 offset:6144
  ds_read_b128 v[68:71], v0 offset:7168
  v_smfmac_f32_16x16x64_bf16 v[40:43], v[12:15], a[64:71], v3
  v_permlane32_swap_b32 v36, v38
  v_smfmac_f32_16x16x64_bf16 v[40:43], v[16:19], a[72:79], v3
  v_permlane32_swap_b32 v37, v39
  v_smfmac_f32_16x16x64_bf16 v[40:43], v[20:23], a[80:87], v3
  s_waitcnt lgkmcnt(2)
  v_add_f32 v36, v36, v38
  v_smfmac_f32_16x16x64_bf16 v[60:63], v[16:19], v[144:151], v3
  ds_read_b128 v[72:75], v0 offset:8192
  ds_read_b128 v[76:79], v0 offset:9216
  v_add_f32 v37, v37, v39
  v_smfmac_f32_16x16x64_bf16 v[40:43], v[24:27], a[88:95], v3
  v_cmp_u_f32 vcc, v36, v37
  v_smfmac_f32_16x16x64_bf16 v[44:47], v[8:11], a[112:119], v3
  v_cvt_pk_bf16_f32 v38, v36, v37
  v_smfmac_f32_16x16x64_bf16 v[44:47], v[12:15], a[120:127], v3
  ds_write_b32 v152, v38
  s_waitcnt lgkmcnt(3)
  s_cbranch_vccnz cB_va1_slow
  v_permlane32_swap_b32 v40, v42
  v_smfmac_f32_16x16x64_bf16 v[60:63], v[20:23], v[64:71], v3
  ds_read_b128 v[144:147], v0 offset:10240
  ds_read_b128 v[148:151], v0 offset:11264
  v_permlane32_swap_b32 v41, v43
  v_smfmac_f32_16x16x64_bf16 v[44:47], v[16:19], a[128:135], v3
  buffer_store_dword v162, v1, s[8:11], s21 offen sc1
  v_add_f32 v40, v40, v42
  v_smfmac_f32_16x16x64_bf16 v[44:47], v[20:23], a[136:143], v3
  v_add_f32 v41, v41, v43
  v_smfmac_f32_16x16x64_bf16 v[44:47], v[24:27], a[144:151], v3
  s_waitcnt lgkmcnt(3)
  v_cvt_pk_bf16_f32 v42, v40, v41
  v_smfmac_f32_16x16x64_bf16 v[60:63], v[24:27], v[72:79], v3
  ds_write_b32 v153, v42
  ds_read_b128 v[64:67], v0 offset:12288
  ds_read_b128 v[68:71], v0 offset:13312
  v_smfmac_f32_16x16x64_bf16 v[48:51], v[8:11], a[168:175], v3
  s_nop 0
  v_permlane32_swap_b32 v44, v46
  v_smfmac_f32_16x16x64_bf16 v[48:51], v[12:15], a[176:183], v3
  v_permlane32_swap_b32 v45, v47
  v_smfmac_f32_16x16x64_bf16 v[48:51], v[16:19], a[184:191], v3
  s_waitcnt lgkmcnt(3)
  v_add_f32 v44, v44, v46
  v_smfmac_f32_16x16x64_bf16 v[60:63], v[28:31], v[144:151], v3
  v_add_f32 v45, v45, v47
  v_smfmac_f32_16x16x64_bf16 v[48:51], v[20:23], a[192:199], v3
  v_cvt_pk_bf16_f32 v46, v44, v45
  v_smfmac_f32_16x16x64_bf16 v[48:51], v[24:27], a[200:207], v3
  ds_write_b32 v154, v46
  v_smfmac_f32_16x16x64_bf16 v[52:55], v[8:11], a[224:231], v3
  s_waitcnt lgkmcnt(1)
  v_smfmac_f32_16x16x64_bf16 v[60:63], v[32:35], v[64:71], v3
  v_smfmac_f32_16x16x64_bf16 v[52:55], v[12:15], a[232:239], v3
  v_permlane32_swap_b32 v48, v50
  v_smfmac_f32_16x16x64_bf16 v[52:55], v[16:19], a[240:247], v3
  v_permlane32_swap_b32 v49, v51
  v_smfmac_f32_16x16x64_bf16 v[52:55], v[20:23], a[248:255], v3
  v_add_f32 v48, v48, v50
  v_smfmac_f32_16x16x64_bf16 v[52:55], v[24:27], v[176:183], v3
  v_add_f32 v49, v49, v51
  v_smfmac_f32_16x16x64_bf16 v[56:59], v[8:11], v[200:207], v3
  v_cvt_pk_bf16_f32 v50, v48, v49
  v_smfmac_f32_16x16x64_bf16 v[56:59], v[12:15], v[208:215], v3
  ds_write_b32 v155, v50
  v_permlane32_swap_b32 v60, v62
  v_smfmac_f32_16x16x64_bf16 v[56:59], v[16:19], v[216:223], v3
  v_permlane32_swap_b32 v61, v63
  v_smfmac_f32_16x16x64_bf16 v[56:59], v[20:23], v[224:231], v3
  v_add_f32 v60, v60, v62
  v_smfmac_f32_16x16x64_bf16 v[56:59], v[24:27], v[232:239], v3
  v_add_f32 v61, v61, v63
  v_cvt_pk_bf16_f32 v62, v60, v61
  ds_write_b32 v158, v62
  v_permlane32_swap_b32 v52, v54
  v_permlane32_swap_b32 v53, v55
  v_add_f32 v52, v52, v54
  v_add_f32 v53, v53, v55
  v_cvt_pk_bf16_f32 v54, v52, v53
  ds_write_b32 v156, v54
  v_permlane32_swap_b32 v56, v58
  v_permlane32_swap_b32 v57, v59
  v_add_f32 v56, v56, v58
  v_add_f32 v57, v57, v59
  v_cvt_pk_bf16_f32 v58, v56, v57
  ds_write_b32 v157, v58
cB_va1_t2d:
  s_add_u32 s22, s20, 9216
  s_add_u32 s34, s20, 13312
  s_add_u32 s36, s20, 7168
  s_mov_b32 s37, 0
  v_mov_b32 v48, 0
  v_mov_b32 v49, 0
  v_mov_b32 v50, 0
  v_mov_b32 v51, 0
  v_mov_b32 v163, s18
  s_cmp_eq_u32 s19, 63
  s_waitcnt lgkmcnt(0)
  s_cbranch_scc1 cB_va1_last
  s_barrier
  buffer_load_dwordx4 v[8:11], v2, s[8:11], s22 offen offset:0 sc1
  buffer_load_dwordx4 v[12:15], v2, s[8:11], s22 offen offset:1024 sc1
  buffer_load_dwordx4 v[16:19], v2, s[8:11], s22 offen offset:2048 sc1
  buffer_load_dwordx4 v[20:23], v2, s[8:11], s22 offen offset:3072 sc1
  buffer_load_dwordx4 v[24:27], v2, s[8:11], s34 offen offset:0 sc1
  buffer_load_dwordx4 v[28:31], v2, s[8:11], s34 offen offset:1024 sc1
  buffer_load_dwordx4 v[32:35], v2, s[8:11], s34 offen offset:2048 sc1
  buffer_load_dwordx4 v[36:39], v2, s[8:11], s34 offen offset:3072 sc1
  buffer_load_dwordx4 v[40:43], v2, s[8:11], s36 offen offset:0 sc1
  buffer_load_dwordx4 v[44:47], v2, s[8:11], s36 offen offset:1024 sc1
  ds_read_b128 v[64:67], v2 offset:4096
  ds_read_b128 v[68:71], v2 offset:5120
  ds_read_b128 v[72:75], v2 offset:6144
  ds_read_b128 v[76:79], v2 offset:7168
cB_va1_lp:
  s_waitcnt vmcnt(9)
  v_smfmac_f32_16x16x64_bf16 v[48:51], v[8:11], v[80:87], v3
  s_waitcnt vmcnt(8)
  v_smfmac_f32_16x16x64_bf16 v[48:51], v[12:15], v[88:95], v3
  s_waitcnt vmcnt(7)
  v_smfmac_f32_16x16x64_bf16 v[48:51], v[16:19], v[96:103], v3
  v_max3_u32 v55, v8, v12, v16
  s_waitcnt vmcnt(6)
  v_smfmac_f32_16x16x64_bf16 v[48:51], v[20:23], v[104:111], v3
  v_max_u32 v55, v55, v20
  v_cmp_eq_u32 vcc, -1, v55
  s_waitcnt vmcnt(5)
  v_smfmac_f32_16x16x64_bf16 v[48:51], v[24:27], v[112:119], v3
  s_waitcnt vmcnt(4)
  v_smfmac_f32_16x16x64_bf16 v[48:51], v[28:31], v[120:127], v3
  s_cbranch_vccnz cB_va1_rv
  buffer_store_dword v163, v7, s[8:11], 0 offen sc1
  s_waitcnt vmcnt(4)
  v_smfmac_f32_16x16x64_bf16 v[48:51], v[32:35], v[128:135], v3
  s_waitcnt vmcnt(3)
  v_smfmac_f32_16x16x64_bf16 v[48:51], v[36:39], v[136:143], v3
  s_waitcnt vmcnt(2) lgkmcnt(0)
  v_smfmac_f32_16x16x64_bf16 v[48:51], v[40:43], v[64:71], v3
  s_waitcnt vmcnt(1)
  v_smfmac_f32_16x16x64_bf16 v[48:51], v[44:47], v[72:79], v3
  s_nop 7
  v_permlane32_swap_b32 v48, v50
  v_permlane32_swap_b32 v49, v51
  v_pk_add_f32 v[48:49], v[48:49], v[50:51]
  v_cvt_pk_bf16_f32 v160, v48, v49
  v_cmp_u_f32 vcc, v48, v49
  s_nop 0
  v_mov_b32_dpp v161, v160 quad_perm:[1,0,3,2] row_mask:0xf bank_mask:0xf
  v_perm_b32 v160, v161, v160, v5
  v_cndmask_b32 v161, v160, v162, vcc
  buffer_store_dword v161, v1, s[8:11], s21 offen sc1
  s_cbranch_vccnz cB_va1_rp
cB_va1_cont:
  s_cmp_lg_u32 s19, 62
  s_cbranch_scc1 cB_va1_nl
  buffer_store_dword v160, v1, s[8:11], s38 offen sc1
  s_mov_b32 s38, 0x40000000
  s_mov_b32 s25, 0x40000000
cB_va1_nl:
  s_add_u32 s25, s25, 458752
  v_mov_b32 v36, 0
  v_mov_b32 v37, 0
  v_mov_b32 v38, 0
  v_mov_b32 v39, 0
  v_mov_b32 v40, 0
  v_mov_b32 v41, 0
  v_mov_b32 v42, 0
  v_mov_b32 v43, 0
  v_mov_b32 v44, 0
  v_mov_b32 v45, 0
  v_mov_b32 v46, 0
  v_mov_b32 v47, 0
  v_mov_b32 v48, 0
  v_mov_b32 v49, 0
  v_mov_b32 v50, 0
  v_mov_b32 v51, 0
  v_mov_b32 v52, 0
  v_mov_b32 v53, 0
  v_mov_b32 v54, 0
  v_mov_b32 v55, 0
  v_mov_b32 v56, 0
  v_mov_b32 v57, 0
  v_mov_b32 v58, 0
  v_mov_b32 v59, 0
  v_mov_b32 v60, 0
  v_mov_b32 v61, 0
  v_mov_b32 v62, 0
  v_mov_b32 v63, 0
  s_mov_b32 s19, s18
  s_add_u32 s18, s18, 1
  s_mov_b32 s22, s20
  s_mov_b32 s20, s21
  s_mov_b32 s21, s22
  s_add_u32 s23, s20, 4096
  s_branch cB_va1_loop
cB_va1_slow:
  s_waitcnt lgkmcnt(0)
cB_va1_sl1:
  s_add_u32 s31, s31, 0x1000000
  buffer_load_dwordx4 v[8:11], v2, s[8:11], s20 offen offset:0 sc1
  buffer_load_dwordx4 v[12:15], v2, s[8:11], s20 offen offset:1024 sc1
  buffer_load_dwordx4 v[16:19], v2, s[8:11], s20 offen offset:2048 sc1
  buffer_load_dwordx4 v[20:23], v2, s[8:11], s20 offen offset:3072 sc1
  buffer_load_dwordx4 v[24:27], v2, s[8:11], s23 offen offset:0 sc1
  buffer_load_dwordx4 v[28:31], v2, s[8:11], s23 offen offset:1024 sc1
  buffer_load_dwordx4 v[32:35], v2, s[8:11], s23 offen offset:2048 sc1
  s_waitcnt vmcnt(0)
  v_max3_u32 v36, v8, v9, v10
  v_max3_u32 v36, v36, v11, v12
  v_max3_u32 v36, v36, v13, v14
  v_max3_u32 v36, v36, v15, v16
  v_max3_u32 v36, v36, v17, v18
  v_max3_u32 v36, v36, v19, v20
  v_max3_u32 v36, v36, v21, v22
  v_max3_u32 v36, v36, v23, v24
  v_max3_u32 v36, v36, v25, v26
  v_max3_u32 v36, v36, v27, v28
  v_max3_u32 v36, v36, v29, v30
  v_max3_u32 v36, v36, v31, v32
  v_max3_u32 v36, v36, v33, v34
  v_max_u32 v36, v36, v35
  v_cmp_eq_u32 vcc, -1, v36
  s_cbranch_vccz cB_va1_sl2
  s_add_u32 s30, s30, 1
  s_cmp_lt_u32 s30, 400000
  s_cbranch_scc1 cB_va1_sl1
  s_branch cB_abort
cB_va1_sl2:
  v_mov_b32 v36, 0
  v_mov_b32 v37, 0
  v_mov_b32 v38, 0
  v_mov_b32 v39, 0
  v_mov_b32 v40, 0
  v_mov_b32 v41, 0
  v_mov_b32 v42, 0
  v_mov_b32 v43, 0
  v_mov_b32 v44, 0
  v_mov_b32 v45, 0
  v_mov_b32 v46, 0
  v_mov_b32 v47, 0
  v_mov_b32 v48, 0
  v_mov_b32 v49, 0
  v_mov_b32 v50, 0
  v_mov_b32 v51, 0
  v_mov_b32 v52, 0
  v_mov_b32 v53, 0
  v_mov_b32 v54, 0
  v_mov_b32 v55, 0
  v_mov_b32 v56, 0
  v_mov_b32 v57, 0
  v_mov_b32 v58, 0
  v_mov_b32 v59, 0
  v_mov_b32 v60, 0
  v_mov_b32 v61, 0
  v_mov_b32 v62, 0
  v_mov_b32 v63, 0
  buffer_store_dword v162, v1, s[8:11], s21 offen sc1
  ds_read_b128 v[64:67], v0 offset:0
  ds_read_b128 v[68:71], v0 offset:1024
  v_smfmac_f32_16x16x64_bf16 v[36:39], v[8:11], a[0:7], v3
  v_smfmac_f32_16x16x64_bf16 v[40:43], v[8:11], a[56:63], v3
  v_smfmac_f32_16x16x64_bf16 v[44:47], v[8:11], a[112:119], v3
  v_smfmac_f32_16x16x64_bf16 v[48:51], v[8:11], a[168:175], v3
  v_smfmac_f32_16x16x64_bf16 v[52:55], v[8:11], a[224:231], v3
  v_smfmac_f32_16x16x64_bf16 v[56:59], v[8:11], v[200:207], v3
  s_waitcnt lgkmcnt(0)
  v_smfmac_f32_16x16x64_bf16 v[60:63], v[8:11], v[64:71], v3
  ds_read_b128 v[72:75], v0 offset:2048
  ds_read_b128 v[76:79], v0 offset:3072
  v_smfmac_f32_16x16x64_bf16 v[36:39], v[12:15], a[8:15], v3
  v_smfmac_f32_16x16x64_bf16 v[40:43], v[12:15], a[64:71], v3
  v_smfmac_f32_16x16x64_bf16 v[44:47], v[12:15], a[120:127], v3
  v_smfmac_f32_16x16x64_bf16 v[48:51], v[12:15], a[176:183], v3
  v_smfmac_f32_16x16x64_bf16 v[52:55], v[12:15], a[232:239], v3
  v_smfmac_f32_16x16x64_bf16 v[56:59], v[12:15], v[208:215], v3
  s_waitcnt lgkmcnt(0)
  v_smfmac_f32_16x16x64_bf16 v[60:63], v[12:15], v[72:79], v3
  ds_read_b128 v[144:147], v0 offset:4096
  ds_read_b128 v[148:151], v0 offset:5120
  v_smfmac_f32_16x16x64_bf16 v[36:39], v[16:19], a[16:23], v3
  v_smfmac_f32_16x16x64_bf16 v[40:43], v[16:19], a[72:79], v3
  v_smfmac_f32_16x16x64_bf16 v[44:47], v[16:19], a[128:135], v3
  v_smfmac_f32_16x16x64_bf16 v[48:51], v[16:19], a[184:191], v3
  v_smfmac_f32_16x16x64_bf16 v[52:55], v[16:19], a[240:247], v3
  v_smfmac_f32_16x16x64_bf16 v[56:59], v[16:19], v[216:223], v3
  s_waitcnt lgkmcnt(0)
  v_smfmac_f32_16x16x64_bf16 v[60:63], v[16:19], v[144:151], v3
  ds_read_b128 v[64:67], v0 offset:6144
  ds_read_b128 v[68:71], v0 offset:7168
  v_smfmac_f32_16x16x64_bf16 v[36:39], v[20:23], a[24:31], v3
  v_smfmac_f32_16x16x64_bf16 v[40:43], v[20:23], a[80:87], v3
  v_smfmac_f32_16x16x64_bf16 v[44:47], v[20:23], a[136:143], v3
  v_smfmac_f32_16x16x64_bf16 v[48:51], v[20:23], a[192:199], v3
  v_smfmac_f32_16x16x64_bf16 v[52:55], v[20:23], a[248:255], v3
  v_smfmac_f32_16x16x64_bf16 v[56:59], v[20:23], v[224:231], v3
  s_waitcnt lgkmcnt(0)
  v_smfmac_f32_16x16x64_bf16 v[60:63], v[20:23], v[64:71], v3
  ds_read_b128 v[72:75], v0 offset:8192
  ds_read_b128 v[76:79], v0 offset:9216
  v_smfmac_f32_16x16x64_bf16 v[36:39], v[24:27], a[32:39], v3
  v_smfmac_f32_16x16x64_bf16 v[40:43], v[24:27], a[88:95], v3
  v_smfmac_f32_16x16x64_bf16 v[44:47], v[24:27], a[144:151], v3
  v_smfmac_f32_16x16x64_bf16 v[48:51], v[24:27], a[200:207], v3
  v_smfmac_f32_16x16x64_bf16 v[52:55], v[24:27], v[176:183], v3
  v_smfmac_f32_16x16x64_bf16 v[56:59], v[24:27], v[232:239], v3
  s_waitcnt lgkmcnt(0)
  v_smfmac_f32_16x16x64_bf16 v[60:63], v[24:27], v[72:79], v3
  ds_read_b128 v[144:147], v0 offset:10240
  ds_read_b128 v[148:151], v0 offset:11264
  v_smfmac_f32_16x16x64_bf16 v[36:39], v[28:31], a[40:47], v3
  v_smfmac_f32_16x16x64_bf16 v[40:43], v[28:31], a[96:103], v3
  v_smfmac_f32_16x16x64_bf16 v[44:47], v[28:31], a[152:159], v3
  v_smfmac_f32_16x16x64_bf16 v[48:51], v[28:31], a[208:215], v3
  v_smfmac_f32_16x16x64_bf16 v[52:55], v[28:31], v[184:191], v3
  v_smfmac_f32_16x16x64_bf16 v[56:59], v[28:31], v[240:247], v3
  s_waitcnt lgkmcnt(0)
  v_smfmac_f32_16x16x64_bf16 v[60:63], v[28:31], v[144:151], v3
  ds_read_b128 v[64:67], v0 offset:12288
  ds_read_b128 v[68:71], v0 offset:13312
  v_smfmac_f32_16x16x64_bf16 v[36:39], v[32:35], a[48:55], v3
  v_smfmac_f32_16x16x64_bf16 v[40:43], v[32:35], a[104:111], v3
  v_smfmac_f32_16x16x64_bf16 v[44:47], v[32:35], a[160:167], v3
  v_smfmac_f32_16x16x64_bf16 v[48:51], v[32:35], a[216:223], v3
  v_smfmac_f32_16x16x64_bf16 v[52:55], v[32:35], v[192:199], v3
  v_smfmac_f32_16x16x64_bf16 v[56:59], v[32:35], v[248:255], v3
  s_waitcnt lgkmcnt(0)
  v_smfmac_f32_16x16x64_bf16 v[60:63], v[32:35], v[64:71], v3
  v_permlane32_swap_b32 v36, v38
  v_permlane32_swap_b32 v37, v39
  v_add_f32 v36, v36, v38
  v_add_f32 v37, v37, v39
  v_cvt_pk_bf16_f32 v38, v36, v37
  ds_write_b32 v152, v38
  v_permlane32_swap_b32 v40, v42
  v_permlane32_swap_b32 v41, v43
  v_add_f32 v40, v40, v42
  v_add_f32 v41, v41, v43
  v_cvt_pk_bf16_f32 v42, v40, v41
  ds_write_b32 v153, v42
  v_permlane32_swap_b32 v44, v46
  v_permlane32_swap_b32 v45, v47
  v_add_f32 v44, v44, v46
  v_add_f32 v45, v45, v47
  v_cvt_pk_bf16_f32 v46, v44, v45
  ds_write_b32 v154, v46
  v_permlane32_swap_b32 v48, v50
  v_permlane32_swap_b32 v49, v51
  v_add_f32 v48, v48, v50
  v_add_f32 v49, v49, v51
  v_cvt_pk_bf16_f32 v50, v48, v49
  ds_write_b32 v155, v50
  v_permlane32_swap_b32 v52, v54
  v_permlane32_swap_b32 v53, v55
  v_add_f32 v52, v52, v54
  v_add_f32 v53, v53, v55
  v_cvt_pk_bf16_f32 v54, v52, v53
  ds_write_b32 v156, v54
  v_permlane32_swap_b32 v56, v58
  v_permlane32_swap_b32 v57, v59
  v_add_f32 v56, v56, v58
  v_add_f32 v57, v57, v59
  v_cvt_pk_bf16_f32 v58, v56, v57
  ds_write_b32 v157, v58
  v_permlane32_swap_b32 v60, v62
  v_permlane32_swap_b32 v61, v63
  v_add_f32 v60, v60, v62
  v_add_f32 v61, v61, v63
  v_cvt_pk_bf16_f32 v62, v60, v61
  ds_write_b32 v158, v62
  s_branch cB_va1_t2d
cB_va1_last:
  s_barrier
  ds_read_b128 v[64:67], v2 offset:4096
  ds_read_b128 v[68:71], v2 offset:5120
  ds_read_b128 v[72:75], v2 offset:6144
  ds_read_b128 v[76:79], v2 offset:7168
  s_waitcnt lgkmcnt(0)
  v_min_u32 v64, -2, v64
  v_min_u32 v65, -2, v65
  v_min_u32 v66, -2, v66
  v_min_u32 v67, -2, v67
  v_min_u32 v68, -2, v68
  v_min_u32 v69, -2, v69
  v_min_u32 v70, -2, v70
  v_min_u32 v71, -2, v71
  v_min_u32 v72, -2, v72
  v_min_u32 v73, -2, v73
  v_min_u32 v74, -2, v74
  v_min_u32 v75, -2, v75
  v_min_u32 v76, -2, v76
  v_min_u32 v77, -2, v77
  v_min_u32 v78, -2, v78
  v_min_u32 v79, -2, v79
  buffer_store_dwordx4 v[64:67], v2, s[8:11], s33 offen offset:0 sc1
  buffer_store_dwordx4 v[68:71], v2, s[8:11], s33 offen offset:2048 sc1
  s_add_u32 s33, s33, 4096
  buffer_store_dwordx4 v[72:75], v2, s[8:11], s33 offen offset:0 sc1
  buffer_store_dwordx4 v[76:79], v2, s[8:11], s33 offen offset:2048 sc1
  s_add_u32 s33, s33, 4096
  s_waitcnt vmcnt(0)
  buffer_wbl2 sc1
  s_branch cB_done
cB_va1_rp:
  s_cmp_eq_u32 s37, 0
  s_cbranch_scc1 cB_va1_rv
  v_min_u32 v160, -2, v160
  buffer_store_dword v160, v1, s[8:11], s21 offen sc1
  s_branch cB_va1_cont
cB_va1_rv:
  s_add_u32 s31, s31, 0x10000
  buffer_load_dwordx4 v[8:11], v2, s[8:11], s22 offen offset:0 sc1
  buffer_load_dwordx4 v[12:15], v2, s[8:11], s22 offen offset:1024 sc1
  buffer_load_dwordx4 v[16:19], v2, s[8:11], s22 offen offset:2048 sc1
  buffer_load_dwordx4 v[20:23], v2, s[8:11], s22 offen offset:3072 sc1
  buffer_load_dwordx4 v[24:27], v2, s[8:11], s34 offen offset:0 sc1
  buffer_load_dwordx4 v[28:31], v2, s[8:11], s34 offen offset:1024 sc1
  buffer_load_dwordx4 v[32:35], v2, s[8:11], s34 offen offset:2048 sc1
  buffer_load_dwordx4 v[36:39], v2, s[8:11], s34 offen offset:3072 sc1
  buffer_load_dwordx4 v[40:43], v2, s[8:11], s36 offen offset:0 sc1
  buffer_load_dwordx4 v[44:47], v2, s[8:11], s36 offen offset:1024 sc1
  s_waitcnt vmcnt(0)
  v_max3_u32 v52, v8, v9, v10
  v_max3_u32 v52, v52, v11, v12
  v_max3_u32 v52, v52, v13, v14
  v_max3_u32 v52, v52, v15, v16
  v_max3_u32 v52, v52, v17, v18
  v_max3_u32 v52, v52, v19, v20
  v_max3_u32 v52, v52, v21, v22
  v_max3_u32 v52, v52, v23, v24
  v_max3_u32 v52, v52, v25, v26
  v_max3_u32 v52, v52, v27, v28
  v_max3_u32 v52, v52, v29, v30
  v_max3_u32 v52, v52, v31, v32
  v_max3_u32 v52, v52, v33, v34
  v_max3_u32 v52, v52, v35, v36
  v_max3_u32 v52, v52, v37, v38
  v_max3_u32 v52, v52, v39, v40
  v_max3_u32 v52, v52, v41, v42
  v_max3_u32 v52, v52, v43, v44
  v_max3_u32 v52, v52, v45, v46
  v_max_u32 v52, v52, v47
  v_cmp_eq_u32 vcc, -1, v52
  s_mov_b32 s37, 1
  v_mov_b32 v48, 0
  v_mov_b32 v49, 0
  v_mov_b32 v50, 0
  v_mov_b32 v51, 0
  s_nop 1
  s_cbranch_vccz cB_va1_lp
  s_add_u32 s30, s30, 1
  s_cmp_lt_u32 s30, 400000
  s_cbranch_scc1 cB_va1_rv
  s_branch cB_abort
.p2align 6
cB_va2_loop:
  s_mov_b32 s30, 0
cB_va2_fp_l:
  v_cmp_gt_u32 vcc, s19, v96
  buffer_load_dword v96, v119, s[8:11], 0 offen sc1
  s_cbranch_vccz cB_va2_fp_d
  v_cmp_gt_u32 vcc, s19, v96
  buffer_load_dword v96, v119, s[8:11], 0 offen sc1
  s_cbranch_vccz cB_va2_fp_d
  v_cmp_gt_u32 vcc, s19, v96
  buffer_load_dword v96, v119, s[8:11], 0 offen sc1
  s_cbranch_vccz cB_va2_fp_d
  v_cmp_gt_u32 vcc, s19, v96
  buffer_load_dword v96, v119, s[8:11], 0 offen sc1
  s_cbranch_vccz cB_va2_fp_d
  v_cmp_gt_u32 vcc, s19, v96
  buffer_load_dword v96, v119, s[8:11], 0 offen sc1
  s_cbranch_vccz cB_va2_fp_d
  v_cmp_gt_u32 vcc, s19, v96
  buffer_load_dword v96, v119, s[8:11], 0 offen sc1
  s_cbranch_vccz cB_va2_fp_d
  v_cmp_gt_u32 vcc, s19, v96
  buffer_load_dword v96, v119, s[8:11], 0 offen sc1
  s_cbranch_vccz cB_va2_fp_d
  v_cmp_gt_u32 vcc, s19, v96
  buffer_load_dword v96, v119, s[8:11], 0 offen sc1
  s_cbranch_vccz cB_va2_fp_d
  v_cmp_gt_u32 vcc, s19, v96
  buffer_load_dword v96, v119, s[8:11], 0 offen sc1
  s_cbranch_vccz cB_va2_fp_d
  v_cmp_gt_u32 vcc, s19, v96
  buffer_load_dword v96, v119, s[8:11], 0 offen sc1
  s_cbranch_vccz cB_va2_fp_d
  v_cmp_gt_u32 vcc, s19, v96
  buffer_load_dword v96, v119, s[8:11], 0 offen sc1
  s_cbranch_vccz cB_va2_fp_d
  v_cmp_gt_u32 vcc, s19, v96
  buffer_load_dword v96, v119, s[8:11], 0 offen sc1
  s_cbranch_vccz cB_va2_fp_d
  v_cmp_gt_u32 vcc, s19, v96
  buffer_load_dword v96, v119, s[8:11], 0 offen sc1
  s_cbranch_vccz cB_va2_fp_d
  v_cmp_gt_u32 vcc, s19, v96
  buffer_load_dword v96, v119, s[8:11], 0 offen sc1
  s_cbranch_vccz cB_va2_fp_d
  v_cmp_gt_u32 vcc, s19, v96
  buffer_load_dword v96, v119, s[8:11], 0 offen sc1
  s_cbranch_vccz cB_va2_fp_d
  v_cmp_gt_u32 vcc, s19, v96
  buffer_load_dword v96, v119, s[8:11], 0 offen sc1
  s_cbranch_vccz cB_va2_fp_d
  s_waitcnt vmcnt(24)
  s_add_u32 s30, s30, 1
  s_cmp_lt_u32 s30, 400000
  s_cbranch_scc1 cB_va2_fp_l
  s_branch cB_abort
cB_va2_fp_d:
  buffer_load_dwordx4 v[8:11], v2, s[8:11], s20 offen offset:0 sc1
  buffer_load_dwordx4 v[12:15], v2, s[8:11], s20 offen offset:1024 sc1
  s_barrier
  s_barrier
  s_waitcnt vmcnt(0)
  ds_write_b128 v2, v[8:11] offset:8192
  ds_write_b128 v2, v[12:15] offset:9216
  v_smfmac_f32_16x16x64_bf16 v[36:39], v[8:11], a[0:7], v3
  v_smfmac_f32_16x16x64_bf16 v[40:43], v[8:11], a[56:63], v3
  v_smfmac_f32_16x16x64_bf16 v[44:47], v[8:11], a[112:119], v3
  v_smfmac_f32_16x16x64_bf16 v[48:51], v[8:11], a[168:175], v3
  v_smfmac_f32_16x16x64_bf16 v[52:55], v[8:11], a[224:231], v3
  s_waitcnt lgkmcnt(0)
  s_barrier
  ds_read_b128 v[16:19], v2 offset:10240
  ds_read_b128 v[20:23], v2 offset:11264
  ds_read_b128 v[24:27], v2 offset:12288
  ds_read_b128 v[28:31], v2 offset:13312
  ds_read_b128 v[32:35], v2 offset:14336
  v_smfmac_f32_16x16x64_bf16 v[56:59], v[8:11], v[144:151], v3
  v_smfmac_f32_16x16x64_bf16 v[60:63], v[8:11], v[200:207], v3
  v_smfmac_f32_16x16x64_bf16 v[36:39], v[12:15], a[8:15], v3
  v_smfmac_f32_16x16x64_bf16 v[40:43], v[12:15], a[64:71], v3
  v_smfmac_f32_16x16x64_bf16 v[44:47], v[12:15], a[120:127], v3
  v_smfmac_f32_16x16x64_bf16 v[48:51], v[12:15], a[176:183], v3
  v_smfmac_f32_16x16x64_bf16 v[52:55], v[12:15], a[232:239], v3
  v_smfmac_f32_16x16x64_bf16 v[56:59], v[12:15], v[152:159], v3
  ds_read_b128 v[68:71], v0 offset:0
  ds_read_b128 v[72:75], v0 offset:1024
  v_smfmac_f32_16x16x64_bf16 v[60:63], v[12:15], v[208:215], v3
  s_waitcnt lgkmcnt(6)
  ds_read_b128 v[76:79], v0 offset:2048
  ds_read_b128 v[80:83], v0 offset:3072
  v_smfmac_f32_16x16x64_bf16 v[36:39], v[16:19], a[16:23], v3
  s_waitcnt lgkmcnt(7)
  v_smfmac_f32_16x16x64_bf16 v[36:39], v[20:23], a[24:31], v3
  s_waitcnt lgkmcnt(6)
  v_smfmac_f32_16x16x64_bf16 v[36:39], v[24:27], a[32:39], v3
  s_waitcnt lgkmcnt(2)
  v_smfmac_f32_16x16x64_bf16 v[64:67], v[8:11], v[68:75], v3
  s_waitcnt lgkmcnt(5)
  ds_read_b128 v[84:87], v0 offset:4096
  ds_read_b128 v[88:91], v0 offset:5120
  v_smfmac_f32_16x16x64_bf16 v[36:39], v[28:31], a[40:47], v3
  s_waitcnt lgkmcnt(6)
  v_smfmac_f32_16x16x64_bf16 v[36:39], v[32:35], a[48:55], v3
  v_smfmac_f32_16x16x64_bf16 v[40:43], v[16:19], a[72:79], v3
  s_waitcnt lgkmcnt(2)
  v_smfmac_f32_16x16x64_bf16 v[64:67], v[12:15], v[76:83], v3
  ds_read_b128 v[68:71], v0 offset:6144
  ds_read_b128 v[72:75], v0 offset:7168
  v_smfmac_f32_16x16x64_bf16 v[40:43], v[20:23], a[80:87], v3
  v_permlane32_swap_b32 v36, v38
  v_smfmac_f32_16x16x64_bf16 v[40:43], v[24:27], a[88:95], v3
  v_permlane32_swap_b32 v37, v39
  v_smfmac_f32_16x16x64_bf16 v[40:43], v[28:31], a[96:103], v3
  s_waitcnt lgkmcnt(2)
  v_add_f32 v36, v36, v38
  v_smfmac_f32_16x16x64_bf16 v[64:67], v[16:19], v[84:91], v3
  ds_read_b128 v[76:79], v0 offset:8192
  ds_read_b128 v[80:83], v0 offset:9216
  v_add_f32 v37, v37, v39
  v_smfmac_f32_16x16x64_bf16 v[40:43], v[32:35], a[104:111], v3
  v_cmp_u_f32 vcc, v36, v37
  v_smfmac_f32_16x16x64_bf16 v[44:47], v[16:19], a[128:135], v3
  v_cvt_pk_bf16_f32 v38, v36, v37
  v_smfmac_f32_16x16x64_bf16 v[44:47], v[20:23], a[136:143], v3
  ds_write_b32 v104, v38
  s_waitcnt lgkmcnt(3)
  s_cbranch_vccnz cB_va2_slow
  v_permlane32_swap_b32 v40, v42
  v_smfmac_f32_16x16x64_bf16 v[64:67], v[20:23], v[68:75], v3
  ds_read_b128 v[84:87], v0 offset:10240
  ds_read_b128 v[88:91], v0 offset:11264
  v_permlane32_swap_b32 v41, v43
  v_smfmac_f32_16x16x64_bf16 v[44:47], v[24:27], a[144:151], v3
  v_add_f32 v40, v40, v42
  v_smfmac_f32_16x16x64_bf16 v[44:47], v[28:31], a[152:159], v3
  v_add_f32 v41, v41, v43
  v_smfmac_f32_16x16x64_bf16 v[44:47], v[32:35], a[160:167], v3
  s_waitcnt lgkmcnt(3)
  v_cvt_pk_bf16_f32 v42, v40, v41
  v_smfmac_f32_16x16x64_bf16 v[64:67], v[24:27], v[76:83], v3
  ds_write_b32 v105, v42
  ds_read_b128 v[68:71], v0 offset:12288
  ds_read_b128 v[72:75], v0 offset:13312
  v_smfmac_f32_16x16x64_bf16 v[48:51], v[16:19], a[184:191], v3
  s_nop 0
  v_permlane32_swap_b32 v44, v46
  v_smfmac_f32_16x16x64_bf16 v[48:51], v[20:23], a[192:199], v3
  v_permlane32_swap_b32 v45, v47
  v_smfmac_f32_16x16x64_bf16 v[48:51], v[24:27], a[200:207], v3
  s_waitcnt lgkmcnt(3)
  v_add_f32 v44, v44, v46
  v_smfmac_f32_16x16x64_bf16 v[64:67], v[28:31], v[84:91], v3
  v_add_f32 v45, v45, v47
  v_smfmac_f32_16x16x64_bf16 v[48:51], v[28:31], a[208:215], v3
  v_cvt_pk_bf16_f32 v46, v44, v45
  v_smfmac_f32_16x16x64_bf16 v[48:51], v[32:35], a[216:223], v3
  ds_write_b32 v106, v46
  v_smfmac_f32_16x16x64_bf16 v[52:55], v[16:19], a[240:247], v3
  s_waitcnt lgkmcnt(1)
  v_smfmac_f32_16x16x64_bf16 v[64:67], v[32:35], v[68:75], v3
  v_smfmac_f32_16x16x64_bf16 v[52:55], v[20:23], a[248:255], v3
  v_permlane32_swap_b32 v48, v50
  v_smfmac_f32_16x16x64_bf16 v[52:55], v[24:27], v[120:127], v3
  v_permlane32_swap_b32 v49, v51
  v_smfmac_f32_16x16x64_bf16 v[52:55], v[28:31], v[128:135], v3
  v_add_f32 v48, v48, v50
  v_smfmac_f32_16x16x64_bf16 v[52:55], v[32:35], v[136:143], v3
  v_add_f32 v49, v49, v51
  v_smfmac_f32_16x16x64_bf16 v[56:59], v[16:19], v[160:167], v3
  v_cvt_pk_bf16_f32 v50, v48, v49
  v_smfmac_f32_16x16x64_bf16 v[56:59], v[20:23], v[168:175], v3
  ds_write_b32 v107, v50
  v_permlane32_swap_b32 v64, v66
  v_smfmac_f32_16x16x64_bf16 v[56:59], v[24:27], v[176:183], v3
  v_permlane32_swap_b32 v65, v67
  v_smfmac_f32_16x16x64_bf16 v[56:59], v[28:31], v[184:191], v3
  v_add_f32 v64, v64, v66
  v_smfmac_f32_16x16x64_bf16 v[56:59], v[32:35], v[192:199], v3
  v_add_f32 v65, v65, v67
  v_smfmac_f32_16x16x64_bf16 v[60:63], v[16:19], v[216:223], v3
  v_cvt_pk_bf16_f32 v66, v64, v65
  v_smfmac_f32_16x16x64_bf16 v[60:63], v[20:23], v[224:231], v3
  ds_write_b32 v111, v66
  v_permlane32_swap_b32 v52, v54
  v_smfmac_f32_16x16x64_bf16 v[60:63], v[24:27], v[232:239], v3
  v_permlane32_swap_b32 v53, v55
  v_smfmac_f32_16x16x64_bf16 v[60:63], v[28:31], v[240:247], v3
  v_add_f32 v52, v52, v54
  v_smfmac_f32_16x16x64_bf16 v[60:63], v[32:35], v[248:255], v3
  v_add_f32 v53, v53, v55
  v_cvt_pk_bf16_f32 v54, v52, v53
  ds_write_b32 v108, v54
  v_permlane32_swap_b32 v56, v58
  v_permlane32_swap_b32 v57, v59
  v_add_f32 v56, v56, v58
  v_add_f32 v57, v57, v59
  v_cvt_pk_bf16_f32 v58, v56, v57
  ds_write_b32 v109, v58
  v_permlane32_swap_b32 v60, v62
  v_permlane32_swap_b32 v61, v63
  v_add_f32 v60, v60, v62
  v_add_f32 v61, v61, v63
  v_cvt_pk_bf16_f32 v62, v60, v61
  ds_write_b32 v110, v62
cB_va2_t2d:
  v_mov_b32 v117, s18
  s_waitcnt lgkmcnt(0)
  s_barrier
  s_cmp_eq_u32 s19, 63
  s_cbranch_scc1 cB_done
  s_sleep 1
  v_mov_b32 v36, 0
  v_mov_b32 v37, 0
  v_mov_b32 v38, 0
  v_mov_b32 v39, 0
  v_mov_b32 v40, 0
  v_mov_b32 v41, 0
  v_mov_b32 v42, 0
  v_mov_b32 v43, 0
  v_mov_b32 v44, 0
  v_mov_b32 v45, 0
  v_mov_b32 v46, 0
  v_mov_b32 v47, 0
  v_mov_b32 v48, 0
  v_mov_b32 v49, 0
  v_mov_b32 v50, 0
  v_mov_b32 v51, 0
  v_mov_b32 v52, 0
  v_mov_b32 v53, 0
  v_mov_b32 v54, 0
  v_mov_b32 v55, 0
  v_mov_b32 v56, 0
  v_mov_b32 v57, 0
  v_mov_b32 v58, 0
  v_mov_b32 v59, 0
  v_mov_b32 v60, 0
  v_mov_b32 v61, 0
  v_mov_b32 v62, 0
  v_mov_b32 v63, 0
  v_mov_b32 v64, 0
  v_mov_b32 v65, 0
  v_mov_b32 v66, 0
  v_mov_b32 v67, 0
  s_sleep 5
  s_mov_b32 s19, s18
  s_add_u32 s18, s18, 1
  s_mov_b32 s22, s20
  s_mov_b32 s20, s21
  s_mov_b32 s21, s22
  s_add_u32 s23, s20, 4096
  s_branch cB_va2_loop
cB_va2_slow:
  s_waitcnt lgkmcnt(0)
cB_va2_sl1:
  s_add_u32 s31, s31, 0x1000000
  buffer_load_dwordx4 v[8:11], v2, s[8:11], s20 offen offset:0 sc1
  buffer_load_dwordx4 v[12:15], v2, s[8:11], s20 offen offset:1024 sc1
  buffer_load_dwordx4 v[16:19], v2, s[8:11], s20 offen offset:2048 sc1
  buffer_load_dwordx4 v[20:23], v2, s[8:11], s20 offen offset:3072 sc1
  buffer_load_dwordx4 v[24:27], v2, s[8:11], s23 offen offset:0 sc1
  buffer_load_dwordx4 v[28:31], v2, s[8:11], s23 offen offset:1024 sc1
  buffer_load_dwordx4 v[32:35], v2, s[8:11], s23 offen offset:2048 sc1
  s_waitcnt vmcnt(0)
  v_max3_u32 v36, v8, v9, v10
  v_max3_u32 v36, v36, v11, v12
  v_max3_u32 v36, v36, v13, v14
  v_max3_u32 v36, v36, v15, v16
  v_max3_u32 v36, v36, v17, v18
  v_max3_u32 v36, v36, v19, v20
  v_max3_u32 v36, v36, v21, v22
  v_max3_u32 v36, v36, v23, v24
  v_max3_u32 v36, v36, v25, v26
  v_max3_u32 v36, v36, v27, v28
  v_max3_u32 v36, v36, v29, v30
  v_max3_u32 v36, v36, v31, v32
  v_max3_u32 v36, v36, v33, v34
  v_max_u32 v36, v36, v35
  v_cmp_eq_u32 vcc, -1, v36
  s_cbranch_vccz cB_va2_sl2
  s_add_u32 s30, s30, 1
  s_cmp_lt_u32 s30, 400000
  s_cbranch_scc1 cB_va2_sl1
  s_branch cB_abort
cB_va2_sl2:
  v_mov_b32 v36, 0
  v_mov_b32 v37, 0
  v_mov_b32 v38, 0
  v_mov_b32 v39, 0
  v_mov_b32 v40, 0
  v_mov_b32 v41, 0
  v_mov_b32 v42, 0
  v_mov_b32 v43, 0
  v_mov_b32 v44, 0
  v_mov_b32 v45, 0
  v_mov_b32 v46, 0
  v_mov_b32 v47, 0
  v_mov_b32 v48, 0
  v_mov_b32 v49, 0
  v_mov_b32 v50, 0
  v_mov_b32 v51, 0
  v_mov_b32 v52, 0
  v_mov_b32 v53, 0
  v_mov_b32 v54, 0
  v_mov_b32 v55, 0
  v_mov_b32 v56, 0
  v_mov_b32 v57, 0
  v_mov_b32 v58, 0
  v_mov_b32 v59, 0
  v_mov_b32 v60, 0
  v_mov_b32 v61, 0
  v_mov_b32 v62, 0
  v_mov_b32 v63, 0
  v_mov_b32 v64, 0
  v_mov_b32 v65, 0
  v_mov_b32 v66, 0
  v_mov_b32 v67, 0
  ds_read_b128 v[68:71], v0 offset:0
  ds_read_b128 v[72:75], v0 offset:1024
  v_smfmac_f32_16x16x64_bf16 v[36:39], v[8:11], a[0:7], v3
  v_smfmac_f32_16x16x64_bf16 v[40:43], v[8:11], a[56:63], v3
  v_smfmac_f32_16x16x64_bf16 v[44:47], v[8:11], a[112:119], v3
  v_smfmac_f32_16x16x64_bf16 v[48:51], v[8:11], a[168:175], v3
  v_smfmac_f32_16x16x64_bf16 v[52:55], v[8:11], a[224:231], v3
  v_smfmac_f32_16x16x64_bf16 v[56:59], v[8:11], v[144:151], v3
  v_smfmac_f32_16x16x64_bf16 v[60:63], v[8:11], v[200:207], v3
  s_waitcnt lgkmcnt(0)
  v_smfmac_f32_16x16x64_bf16 v[64:67], v[8:11], v[68:75], v3
  ds_read_b128 v[76:79], v0 offset:2048
  ds_read_b128 v[80:83], v0 offset:3072
  v_smfmac_f32_16x16x64_bf16 v[36:39], v[12:15], a[8:15], v3
  v_smfmac_f32_16x16x64_bf16 v[40:43], v[12:15], a[64:71], v3
  v_smfmac_f32_16x16x64_bf16 v[44:47], v[12:15], a[120:127], v3
  v_smfmac_f32_16x16x64_bf16 v[48:51], v[12:15], a[176:183], v3
  v_smfmac_f32_16x16x64_bf16 v[52:55], v[12:15], a[232:239], v3
  v_smfmac_f32_16x16x64_bf16 v[56:59], v[12:15], v[152:159], v3
  v_smfmac_f32_16x16x64_bf16 v[60:63], v[12:15], v[208:215], v3
  s_waitcnt lgkmcnt(0)
  v_smfmac_f32_16x16x64_bf16 v[64:67], v[12:15], v[76:83], v3
  ds_read_b128 v[84:87], v0 offset:4096
  ds_read_b128 v[88:91], v0 offset:5120
  v_smfmac_f32_16x16x64_bf16 v[36:39], v[16:19], a[16:23], v3
  v_smfmac_f32_16x16x64_bf16 v[40:43], v[16:19], a[72:79], v3
  v_smfmac_f32_16x16x64_bf16 v[44:47], v[16:19], a[128:135], v3
  v_smfmac_f32_16x16x64_bf16 v[48:51], v[16:19], a[184:191], v3
  v_smfmac_f32_16x16x64_bf16 v[52:55], v[16:19], a[240:247], v3
  v_smfmac_f32_16x16x64_bf16 v[56:59], v[16:19], v[160:167], v3
  v_smfmac_f32_16x16x64_bf16 v[60:63], v[16:19], v[216:223], v3
  s_waitcnt lgkmcnt(0)
  v_smfmac_f32_16x16x64_bf16 v[64:67], v[16:19], v[84:91], v3
  ds_read_b128 v[68:71], v0 offset:6144
  ds_read_b128 v[72:75], v0 offset:7168
  v_smfmac_f32_16x16x64_bf16 v[36:39], v[20:23], a[24:31], v3
  v_smfmac_f32_16x16x64_bf16 v[40:43], v[20:23], a[80:87], v3
  v_smfmac_f32_16x16x64_bf16 v[44:47], v[20:23], a[136:143], v3
  v_smfmac_f32_16x16x64_bf16 v[48:51], v[20:23], a[192:199], v3
  v_smfmac_f32_16x16x64_bf16 v[52:55], v[20:23], a[248:255], v3
  v_smfmac_f32_16x16x64_bf16 v[56:59], v[20:23], v[168:175], v3
  v_smfmac_f32_16x16x64_bf16 v[60:63], v[20:23], v[224:231], v3
  s_waitcnt lgkmcnt(0)
  v_smfmac_f32_16x16x64_bf16 v[64:67], v[20:23], v[68:75], v3
  ds_read_b128 v[76:79], v0 offset:8192
  ds_read_b128 v[80:83], v0 offset:9216
  v_smfmac_f32_16x16x64_bf16 v[36:39], v[24:27], a[32:39], v3
  v_smfmac_f32_16x16x64_bf16 v[40:43], v[24:27], a[88:95], v3
  v_smfmac_f32_16x16x64_bf16 v[44:47], v[24:27], a[144:151], v3
  v_smfmac_f32_16x16x64_bf16 v[48:51], v[24:27], a[200:207], v3
  v_smfmac_f32_16x16x64_bf16 v[52:55], v[24:27], v[120:127], v3
  v_smfmac_f32_16x16x64_bf16 v[56:59], v[24:27], v[176:183], v3
  v_smfmac_f32_16x16x64_bf16 v[60:63], v[24:27], v[232:239], v3
  s_waitcnt lgkmcnt(0)
  v_smfmac_f32_16x16x64_bf16 v[64:67], v[24:27], v[76:83], v3
  ds_read_b128 v[84:87], v0 offset:10240
  ds_read_b128 v[88:91], v0 offset:11264
  v_smfmac_f32_16x16x64_bf16 v[36:39], v[28:31], a[40:47], v3
  v_smfmac_f32_16x16x64_bf16 v[40:43], v[28:31], a[96:103], v3
  v_smfmac_f32_16x16x64_bf16 v[44:47], v[28:31], a[152:159], v3
  v_smfmac_f32_16x16x64_bf16 v[48:51], v[28:31], a[208:215], v3
  v_smfmac_f32_16x16x64_bf16 v[52:55], v[28:31], v[128:135], v3
  v_smfmac_f32_16x16x64_bf16 v[56:59], v[28:31], v[184:191], v3
  v_smfmac_f32_16x16x64_bf16 v[60:63], v[28:31], v[240:247], v3
  s_waitcnt lgkmcnt(0)
  v_smfmac_f32_16x16x64_bf16 v[64:67], v[28:31], v[84:91], v3
  ds_read_b128 v[68:71], v0 offset:12288
  ds_read_b128 v[72:75], v0 offset:13312
  v_smfmac_f32_16x16x64_bf16 v[36:39], v[32:35], a[48:55], v3
  v_smfmac_f32_16x16x64_bf16 v[40:43], v[32:35], a[104:111], v3
  v_smfmac_f32_16x16x64_bf16 v[44:47], v[32:35], a[160:167], v3
  v_smfmac_f32_16x16x64_bf16 v[48:51], v[32:35], a[216:223], v3
  v_smfmac_f32_16x16x64_bf16 v[52:55], v[32:35], v[136:143], v3
  v_smfmac_f32_16x16x64_bf16 v[56:59], v[32:35], v[192:199], v3
  v_smfmac_f32_16x16x64_bf16 v[60:63], v[32:35], v[248:255], v3
  s_waitcnt lgkmcnt(0)
  v_smfmac_f32_16x16x64_bf16 v[64:67], v[32:35], v[68:75], v3
  v_permlane32_swap_b32 v36, v38
  v_permlane32_swap_b32 v37, v39
  v_add_f32 v36, v36, v38
  v_add_f32 v37, v37, v39
  v_cvt_pk_bf16_f32 v38, v36, v37
  ds_write_b32 v104, v38
  v_permlane32_swap_b32 v40, v42
  v_permlane32_swap_b32 v41, v43
  v_add_f32 v40, v40, v42
  v_add_f32 v41, v41, v43
  v_cvt_pk_bf16_f32 v42, v40, v41
  ds_write_b32 v105, v42
  v_permlane32_swap_b32 v44, v46
  v_permlane32_swap_b32 v45, v47
  v_add_f32 v44, v44, v46
  v_add_f32 v45, v45, v47
  v_cvt_pk_bf16_f32 v46, v44, v45
  ds_write_b32 v106, v46
  v_permlane32_swap_b32 v48, v50
  v_permlane32_swap_b32 v49, v51
  v_add_f32 v48, v48, v50
  v_add_f32 v49, v49, v51
  v_cvt_pk_bf16_f32 v50, v48, v49
  ds_write_b32 v107, v50
  v_permlane32_swap_b32 v52, v54
  v_permlane32_swap_b32 v53, v55
  v_add_f32 v52, v52, v54
  v_add_f32 v53, v53, v55
  v_cvt_pk_bf16_f32 v54, v52, v53
  ds_write_b32 v108, v54
  v_permlane32_swap_b32 v56, v58
  v_permlane32_swap_b32 v57, v59
  v_add_f32 v56, v56, v58
  v_add_f32 v57, v57, v59
  v_cvt_pk_bf16_f32 v58, v56, v57
  ds_write_b32 v109, v58
  v_permlane32_swap_b32 v60, v62
  v_permlane32_swap_b32 v61, v63
  v_add_f32 v60, v60, v62
  v_add_f32 v61, v61, v63
  v_cvt_pk_bf16_f32 v62, v60, v61
  ds_write_b32 v110, v62
  v_permlane32_swap_b32 v64, v66
  v_permlane32_swap_b32 v65, v67
  v_add_f32 v64, v64, v66
  v_add_f32 v65, v65, v67
  v_cvt_pk_bf16_f32 v66, v64, v65
  ds_write_b32 v111, v66
  s_branch cB_va2_t2d
.p2align 6
cB_va3_loop:
  s_mov_b32 s30, 0
  s_barrier
  buffer_load_dwordx4 v[16:19], v2, s[8:11], s20 offen offset:2048 sc1
  buffer_load_dwordx4 v[20:23], v2, s[8:11], s20 offen offset:3072 sc1
  s_barrier
  buffer_load_dword v100, v116, s[8:11], s39 offen sc1
  s_add_u32 s27, s19, 2
  s_min_u32 s27, s27, 63
  s_lshr_b32 s27, s27, 3
  s_lshl_b32 s27, s27, 11
  s_add_u32 s27, s27, s35
  s_cmp_eq_u32 s27, s28
  s_cselect_b32 s29, 35328, s27
  buffer_load_dword v101, off, s[8:11], s29 sc1
  s_add_u32 s39, s39, 28672
  s_waitcnt vmcnt(2)
  ds_write_b128 v2, v[16:19] offset:10240
  ds_write_b128 v2, v[20:23] offset:11264
  v_smfmac_f32_16x16x64_bf16 v[36:39], v[16:19], a[16:23], v3
  v_smfmac_f32_16x16x64_bf16 v[40:43], v[16:19], a[72:79], v3
  v_smfmac_f32_16x16x64_bf16 v[44:47], v[16:19], a[128:135], v3
  v_smfmac_f32_16x16x64_bf16 v[48:51], v[16:19], a[184:191], v3
  v_smfmac_f32_16x16x64_bf16 v[52:55], v[16:19], a[240:247], v3
  s_waitcnt lgkmcnt(0)
  s_barrier
  ds_read_b128 v[8:11], v2 offset:8192
  ds_read_b128 v[12:15], v2 offset:9216
  ds_read_b128 v[24:27], v2 offset:12288
  ds_read_b128 v[28:31], v2 offset:13312
  ds_read_b128 v[32:35], v2 offset:14336
  v_smfmac_f32_16x16x64_bf16 v[56:59], v[16:19], v[160:167], v3
  v_smfmac_f32_16x16x64_bf16 v[60:63], v[16:19], v[216:223], v3
  v_smfmac_f32_16x16x64_bf16 v[36:39], v[20:23], a[24:31], v3
  v_smfmac_f32_16x16x64_bf16 v[40:43], v[20:23], a[80:87], v3
  v_smfmac_f32_16x16x64_bf16 v[44:47], v[20:23], a[136:143], v3
  v_smfmac_f32_16x16x64_bf16 v[48:51], v[20:23], a[192:199], v3
  v_smfmac_f32_16x16x64_bf16 v[52:55], v[20:23], a[248:255], v3
  v_smfmac_f32_16x16x64_bf16 v[56:59], v[20:23], v[168:175], v3
  v_smfmac_f32_16x16x64_bf16 v[60:63], v[20:23], v[224:231], v3
  s_waitcnt lgkmcnt(4)
  v_smfmac_f32_16x16x64_bf16 v[36:39], v[8:11], a[0:7], v3
  s_waitcnt lgkmcnt(3)
  v_smfmac_f32_16x16x64_bf16 v[36:39], v[12:15], a[8:15], v3
  s_waitcnt lgkmcnt(2)
  v_smfmac_f32_16x16x64_bf16 v[36:39], v[24:27], a[32:39], v3
  s_waitcnt lgkmcnt(1)
  v_smfmac_f32_16x16x64_bf16 v[36:39], v[28:31], a[40:47], v3
  s_waitcnt lgkmcnt(0)
  v_smfmac_f32_16x16x64_bf16 v[36:39], v[32:35], a[48:55], v3
  v_smfmac_f32_16x16x64_bf16 v[40:43], v[8:11], a[56:63], v3
  v_smfmac_f32_16x16x64_bf16 v[40:43], v[12:15], a[64:71], v3
  v_smfmac_f32_16x16x64_bf16 v[40:43], v[24:27], a[88:95], v3
  v_permlane32_swap_b32 v36, v38
  v_smfmac_f32_16x16x64_bf16 v[40:43], v[28:31], a[96:103], v3
  v_permlane32_swap_b32 v37, v39
  v_smfmac_f32_16x16x64_bf16 v[40:43], v[32:35], a[104:111], v3
  v_add_f32 v36, v36, v38
  v_smfmac_f32_16x16x64_bf16 v[44:47], v[8:11], a[112:119], v3
  v_add_f32 v37, v37, v39
  v_smfmac_f32_16x16x64_bf16 v[44:47], v[12:15], a[120:127], v3
  v_cmp_u_f32 vcc, v36, v37
  v_smfmac_f32_16x16x64_bf16 v[44:47], v[24:27], a[144:151], v3
  v_cvt_pk_bf16_f32 v38, v36, v37
  v_smfmac_f32_16x16x64_bf16 v[44:47], v[28:31], a[152:159], v3
  ds_write_b32 v104, v38
  s_cbranch_vccnz cB_va3_slow
  v_permlane32_swap_b32 v40, v42
  v_smfmac_f32_16x16x64_bf16 v[44:47], v[32:35], a[160:167], v3
  v_permlane32_swap_b32 v41, v43
  v_smfmac_f32_16x16x64_bf16 v[48:51], v[8:11], a[168:175], v3
  v_add_f32 v40, v40, v42
  v_smfmac_f32_16x16x64_bf16 v[48:51], v[12:15], a[176:183], v3
  v_add_f32 v41, v41, v43
  v_smfmac_f32_16x16x64_bf16 v[48:51], v[24:27], a[200:207], v3
  v_cvt_pk_bf16_f32 v42, v40, v41
  v_smfmac_f32_16x16x64_bf16 v[48:51], v[28:31], a[208:215], v3
  ds_write_b32 v105, v42
  v_permlane32_swap_b32 v44, v46
  v_smfmac_f32_16x16x64_bf16 v[48:51], v[32:35], a[216:223], v3
  v_permlane32_swap_b32 v45, v47
  v_smfmac_f32_16x16x64_bf16 v[52:55], v[8:11], a[224:231], v3
  v_add_f32 v44, v44, v46
  v_smfmac_f32_16x16x64_bf16 v[52:55], v[12:15], a[232:239], v3
  v_add_f32 v45, v45, v47
  v_smfmac_f32_16x16x64_bf16 v[52:55], v[24:27], v[120:127], v3
  v_cvt_pk_bf16_f32 v46, v44, v45
  v_smfmac_f32_16x16x64_bf16 v[52:55], v[28:31], v[128:135], v3
  ds_write_b32 v106, v46
  v_permlane32_swap_b32 v48, v50
  v_smfmac_f32_16x16x64_bf16 v[52:55], v[32:35], v[136:143], v3
  v_permlane32_swap_b32 v49, v51
  v_smfmac_f32_16x16x64_bf16 v[56:59], v[8:11], v[144:151], v3
  v_add_f32 v48, v48, v50
  v_smfmac_f32_16x16x64_bf16 v[56:59], v[12:15], v[152:159], v3
  v_add_f32 v49, v49, v51
  v_smfmac_f32_16x16x64_bf16 v[56:59], v[24:27], v[176:183], v3
  v_cvt_pk_bf16_f32 v50, v48, v49
  v_smfmac_f32_16x16x64_bf16 v[56:59], v[28:31], v[184:191], v3
  ds_write_b32 v107, v50
  v_permlane32_swap_b32 v52, v54
  v_smfmac_f32_16x16x64_bf16 v[56:59], v[32:35], v[192:199], v3
  v_permlane32_swap_b32 v53, v55
  v_smfmac_f32_16x16x64_bf16 v[60:63], v[8:11], v[200:207], v3
  v_add_f32 v52, v52, v54
  v_smfmac_f32_16x16x64_bf16 v[60:63], v[12:15], v[208:215], v3
  v_add_f32 v53, v53, v55
  v_smfmac_f32_16x16x64_bf16 v[60:63], v[24:27], v[232:239], v3
  v_cvt_pk_bf16_f32 v54, v52, v53
  v_smfmac_f32_16x16x64_bf16 v[60:63], v[28:31], v[240:247], v3
  ds_write_b32 v108, v54
  v_permlane32_swap_b32 v56, v58
  v_smfmac_f32_16x16x64_bf16 v[60:63], v[32:35], v[248:255], v3
  v_permlane32_swap_b32 v57, v59
  v_add_f32 v56, v56, v58
  v_add_f32 v57, v57, v59
  v_cvt_pk_bf16_f32 v58, v56, v57
  ds_write_b32 v109, v58
  s_nop 2
  v_permlane32_swap_b32 v60, v62
  v_permlane32_swap_b32 v61, v63
  v_add_f32 v60, v60, v62
  v_add_f32 v61, v61, v63
  v_cvt_pk_bf16_f32 v62, v60, v61
  ds_write_b32 v110, v62
cB_va3_t2d:
  v_mov_b32 v117, s18
  s_cmp_eq_u32 s27, s28
  s_cbranch_scc1 cB_va3_vok
cB_va3_vow:
  s_waitcnt vmcnt(0)
  v_cmp_ne_u32 vcc, 56, v101
  s_cbranch_vccnz cB_va3_vor
  s_mov_b32 s28, s27
cB_va3_vok:
  s_waitcnt lgkmcnt(0)
  s_setprio 3
  s_barrier
  v_mov_b32 v36, 0
  v_mov_b32 v37, 0
  buffer_store_dword v117, v118, s[8:11], 0 offen sc1
  s_setprio 0
  s_cmp_eq_u32 s19, 63
  s_cbranch_scc1 cB_done
  v_mov_b32 v38, 0
  v_mov_b32 v39, 0
  v_mov_b32 v40, 0
  v_mov_b32 v41, 0
  v_mov_b32 v42, 0
  v_mov_b32 v43, 0
  v_mov_b32 v44, 0
  v_mov_b32 v45, 0
  v_mov_b32 v46, 0
  v_mov_b32 v47, 0
  v_mov_b32 v48, 0
  v_mov_b32 v49, 0
  v_mov_b32 v50, 0
  v_mov_b32 v51, 0
  v_mov_b32 v52, 0
  v_mov_b32 v53, 0
  v_mov_b32 v54, 0
  v_mov_b32 v55, 0
  v_mov_b32 v56, 0
  v_mov_b32 v57, 0
  v_mov_b32 v58, 0
  v_mov_b32 v59, 0
  v_mov_b32 v60, 0
  v_mov_b32 v61, 0
  v_mov_b32 v62, 0
  v_mov_b32 v63, 0
  s_mov_b32 s19, s18
  s_add_u32 s18, s18, 1
  s_mov_b32 s22, s20
  s_mov_b32 s20, s21
  s_mov_b32 s21, s22
  s_add_u32 s23, s20, 4096
  s_branch cB_va3_loop
cB_va3_slow:
  s_waitcnt lgkmcnt(0)
cB_va3_sl1:
  s_add_u32 s31, s31, 0x1000000
  buffer_load_dwordx4 v[8:11], v2, s[8:11], s20 offen offset:0 sc1
  buffer_load_dwordx4 v[12:15], v2, s[8:11], s20 offen offset:1024 sc1
  buffer_load_dwordx4 v[16:19], v2, s[8:11], s20 offen offset:2048 sc1
  buffer_load_dwordx4 v[20:23], v2, s[8:11], s20 offen offset:3072 sc1
  buffer_load_dwordx4 v[24:27], v2, s[8:11], s23 offen offset:0 sc1
  buffer_load_dwordx4 v[28:31], v2, s[8:11], s23 offen offset:1024 sc1
  buffer_load_dwordx4 v[32:35], v2, s[8:11], s23 offen offset:2048 sc1
  s_waitcnt vmcnt(0)
  v_max3_u32 v36, v8, v9, v10
  v_max3_u32 v36, v36, v11, v12
  v_max3_u32 v36, v36, v13, v14
  v_max3_u32 v36, v36, v15, v16
  v_max3_u32 v36, v36, v17, v18
  v_max3_u32 v36, v36, v19, v20
  v_max3_u32 v36, v36, v21, v22
  v_max3_u32 v36, v36, v23, v24
  v_max3_u32 v36, v36, v25, v26
  v_max3_u32 v36, v36, v27, v28
  v_max3_u32 v36, v36, v29, v30
  v_max3_u32 v36, v36, v31, v32
  v_max3_u32 v36, v36, v33, v34
  v_max_u32 v36, v36, v35
  v_cmp_eq_u32 vcc, -1, v36
  s_cbranch_vccz cB_va3_sl2
  s_add_u32 s30, s30, 1
  s_cmp_lt_u32 s30, 400000
  s_cbranch_scc1 cB_va3_sl1
  s_branch cB_abort
cB_va3_sl2:
  v_mov_b32 v36, 0
  v_mov_b32 v37, 0
  v_mov_b32 v38, 0
  v_mov_b32 v39, 0
  v_mov_b32 v40, 0
  v_mov_b32 v41, 0
  v_mov_b32 v42, 0
  v_mov_b32 v43, 0
  v_mov_b32 v44, 0
  v_mov_b32 v45, 0
  v_mov_b32 v46, 0
  v_mov_b32 v47, 0
  v_mov_b32 v48, 0
  v_mov_b32 v49, 0
  v_mov_b32 v50, 0
  v_mov_b32 v51, 0
  v_mov_b32 v52, 0
  v_mov_b32 v53, 0
  v_mov_b32 v54, 0
  v_mov_b32 v55, 0
  v_mov_b32 v56, 0
  v_mov_b32 v57, 0
  v_mov_b32 v58, 0
  v_mov_b32 v59, 0
  v_mov_b32 v60, 0
  v_mov_b32 v61, 0
  v_mov_b32 v62, 0
  v_mov_b32 v63, 0
  v_smfmac_f32_16x16x64_bf16 v[36:39], v[8:11], a[0:7], v3
  v_smfmac_f32_16x16x64_bf16 v[40:43], v[8:11], a[56:63], v3
  v_smfmac_f32_16x16x64_bf16 v[44:47], v[8:11], a[112:119], v3
  v_smfmac_f32_16x16x64_bf16 v[48:51], v[8:11], a[168:175], v3
  v_smfmac_f32_16x16x64_bf16 v[52:55], v[8:11], a[224:231], v3
  v_smfmac_f32_16x16x64_bf16 v[56:59], v[8:11], v[144:151], v3
  v_smfmac_f32_16x16x64_bf16 v[60:63], v[8:11], v[200:207], v3
  v_smfmac_f32_16x16x64_bf16 v[36:39], v[12:15], a[8:15], v3
  v_smfmac_f32_16x16x64_bf16 v[40:43], v[12:15], a[64:71], v3
  v_smfmac_f32_16x16x64_bf16 v[44:47], v[12:15], a[120:127], v3
  v_smfmac_f32_16x16x64_bf16 v[48:51], v[12:15], a[176:183], v3
  v_smfmac_f32_16x16x64_bf16 v[52:55], v[12:15], a[232:239], v3
  v_smfmac_f32_16x16x64_bf16 v[56:59], v[12:15], v[152:159], v3
  v_smfmac_f32_16x16x64_bf16 v[60:63], v[12:15], v[208:215], v3
  v_smfmac_f32_16x16x64_bf16 v[36:39], v[16:19], a[16:23], v3
  v_smfmac_f32_16x16x64_bf16 v[40:43], v[16:19], a[72:79], v3
  v_smfmac_f32_16x16x64_bf16 v[44:47], v[16:19], a[128:135], v3
  v_smfmac_f32_16x16x64_bf16 v[48:51], v[16:19], a[184:191], v3
  v_smfmac_f32_16x16x64_bf16 v[52:55], v[16:19], a[240:247], v3
  v_smfmac_f32_16x16x64_bf16 v[56:59], v[16:19], v[160:167], v3
  v_smfmac_f32_16x16x64_bf16 v[60:63], v[16:19], v[216:223], v3
  v_smfmac_f32_16x16x64_bf16 v[36:39], v[20:23], a[24:31], v3
  v_smfmac_f32_16x16x64_bf16 v[40:43], v[20:23], a[80:87], v3
  v_smfmac_f32_16x16x64_bf16 v[44:47], v[20:23], a[136:143], v3
  v_smfmac_f32_16x16x64_bf16 v[48:51], v[20:23], a[192:199], v3
  v_smfmac_f32_16x16x64_bf16 v[52:55], v[20:23], a[248:255], v3
  v_smfmac_f32_16x16x64_bf16 v[56:59], v[20:23], v[168:175], v3
  v_smfmac_f32_16x16x64_bf16 v[60:63], v[20:23], v[224:231], v3
  v_smfmac_f32_16x16x64_bf16 v[36:39], v[24:27], a[32:39], v3
  v_smfmac_f32_16x16x64_bf16 v[40:43], v[24:27], a[88:95], v3
  v_smfmac_f32_16x16x64_bf16 v[44:47], v[24:27], a[144:151], v3
  v_smfmac_f32_16x16x64_bf16 v[48:51], v[24:27], a[200:207], v3
  v_smfmac_f32_16x16x64_bf16 v[52:55], v[24:27], v[120:127], v3
  v_smfmac_f32_16x16x64_bf16 v[56:59], v[24:27], v[176:183], v3
  v_smfmac_f32_16x16x64_bf16 v[60:63], v[24:27], v[232:239], v3
  v_smfmac_f32_16x16x64_bf16 v[36:39], v[28:31], a[40:47], v3
  v_smfmac_f32_16x16x64_bf16 v[40:43], v[28:31], a[96:103], v3
  v_smfmac_f32_16x16x64_bf16 v[44:47], v[28:31], a[152:159], v3
  v_smfmac_f32_16x16x64_bf16 v[48:51], v[28:31], a[208:215], v3
  v_smfmac_f32_16x16x64_bf16 v[52:55], v[28:31], v[128:135], v3
  v_smfmac_f32_16x16x64_bf16 v[56:59], v[28:31], v[184:191], v3
  v_smfmac_f32_16x16x64_bf16 v[60:63], v[28:31], v[240:247], v3
  v_smfmac_f32_16x16x64_bf16 v[36:39], v[32:35], a[48:55], v3
  v_smfmac_f32_16x16x64_bf16 v[40:43], v[32:35], a[104:111], v3
  v_smfmac_f32_16x16x64_bf16 v[44:47], v[32:35], a[160:167], v3
  v_smfmac_f32_16x16x64_bf16 v[48:51], v[32:35], a[216:223], v3
  v_smfmac_f32_16x16x64_bf16 v[52:55], v[32:35], v[136:143], v3
  v_smfmac_f32_16x16x64_bf16 v[56:59], v[32:35], v[192:199], v3
  v_smfmac_f32_16x16x64_bf16 v[60:63], v[32:35], v[248:255], v3
  v_permlane32_swap_b32 v36, v38
  v_permlane32_swap_b32 v37, v39
  v_add_f32 v36, v36, v38
  v_add_f32 v37, v37, v39
  v_cvt_pk_bf16_f32 v38, v36, v37
  ds_write_b32 v104, v38
  v_permlane32_swap_b32 v40, v42
  v_permlane32_swap_b32 v41, v43
  v_add_f32 v40, v40, v42
  v_add_f32 v41, v41, v43
  v_cvt_pk_bf16_f32 v42, v40, v41
  ds_write_b32 v105, v42
  v_permlane32_swap_b32 v44, v46
  v_permlane32_swap_b32 v45, v47
  v_add_f32 v44, v44, v46
  v_add_f32 v45, v45, v47
  v_cvt_pk_bf16_f32 v46, v44, v45
  ds_write_b32 v106, v46
  v_permlane32_swap_b32 v48, v50
  v_permlane32_swap_b32 v49, v51
  v_add_f32 v48, v48, v50
  v_add_f32 v49, v49, v51
  v_cvt_pk_bf16_f32 v50, v48, v49
  ds_write_b32 v107, v50
  v_permlane32_swap_b32 v52, v54
  v_permlane32_swap_b32 v53, v55
  v_add_f32 v52, v52, v54
  v_add_f32 v53, v53, v55
  v_cvt_pk_bf16_f32 v54, v52, v53
  ds_write_b32 v108, v54
  v_permlane32_swap_b32 v56, v58
  v_permlane32_swap_b32 v57, v59
  v_add_f32 v56, v56, v58
  v_add_f32 v57, v57, v59
  v_cvt_pk_bf16_f32 v58, v56, v57
  ds_write_b32 v109, v58
  v_permlane32_swap_b32 v60, v62
  v_permlane32_swap_b32 v61, v63
  v_add_f32 v60, v60, v62
  v_add_f32 v61, v61, v63
  v_cvt_pk_bf16_f32 v62, v60, v61
  ds_write_b32 v110, v62
  s_branch cB_va3_t2d
cB_va3_vor:
  s_sleep 2
  buffer_load_dword v101, off, s[8:11], s27 sc1
  s_add_u32 s30, s30, 1
  s_cmp_lt_u32 s30, 400000
  s_cbranch_scc1 cB_va3_vow
  s_branch cB_abort
cB_abort:
  v_mov_b32 v4, 0xdead
  v_mov_b32 v5, 16
  buffer_store_dword v4, v5, s[12:15], 0 offen
  s_branch ch_end
cB_done:
  s_branch ch_end
ch_worker:
  s_sub_u32 s35, s3, 4
  s_and_b32 s35, s35, 7
  s_lshr_b32 s36, s2, 3
  s_lshl_b32 s33, s35, 5
  s_add_u32 s33, s33, s36
  s_mov_b32 s97, 0
  s_mov_b32 s96, 0
  s_mov_b32 s37, 0
  s_mov_b32 s38, 0
  s_mov_b32 s39, 0xffff0000
  s_mov_b32 s101, -1
  v_and_b32 v1, 63, v0
  v_lshlrev_b32 v2, 4, v1
  v_lshrrev_b32 v3, 4, v1
  v_and_b32 v4, 15, v1
  s_cmp_ge_u32 s33, 224
  s_cbranch_scc1 wp_all
  s_mov_b32 s68, s44
  s_and_b32 s69, s45, 0xffff
  s_mov_b32 s70, 3670016
  s_mov_b32 s71, 0x20000
  s_and_b32 s20, s33, 0xe0
  s_mul_i32 s20, s20, 9363
  s_lshr_b32 s20, s20, 16
  s_lshl_b32 s20, s20, 10
  s_and_b32 s21, s33, 31
  s_mul_i32 s21, s21, 192
  s_add_u32 s20, s20, s21
  v_min_u32 v7, 191, v0
  v_add_u32 v7, s20, v7
  v_lshrrev_b32 v8, 11, v7
  v_min_u32 v8, 15, v8
  v_bfe_u32 v9, v7, 2, 9
  v_lshlrev_b32 v9, 13, v9
  v_lshl_add_u32 v9, v8, 9, v9
  v_and_b32 v7, 3, v7
  v_lshl_add_u32 v9, v7, 7, v9
  buffer_load_dword v253, v9, s[68:71], 0 offen
  s_mov_b32 s68, s40
  s_and_b32 s69, s41, 0xffff
  s_mov_b32 s70, 3670016
  s_mov_b32 s71, 0x20000
  s_and_b32 s20, s33, 0xe0
  s_mul_i32 s20, s20, 9363
  s_lshr_b32 s20, s20, 16
  s_lshl_b32 s20, s20, 10
  s_and_b32 s21, s33, 31
  s_mul_i32 s21, s21, 192
  s_add_u32 s20, s20, s21
  v_min_u32 v7, 191, v0
  v_add_u32 v7, s20, v7
  v_lshrrev_b32 v8, 11, v7
  v_min_u32 v8, 15, v8
  v_bfe_u32 v9, v7, 2, 9
  v_lshlrev_b32 v9, 13, v9
  v_lshl_add_u32 v9, v8, 9, v9
  v_and_b32 v7, 3, v7
  v_lshl_add_u32 v9, v7, 7, v9
  buffer_load_dword v253, v9, s[68:71], 0 offen
  v_lshrrev_b32 v5, 5, v1
  v_and_b32 v6, 31, v1
  v_xor_b32 v8, v6, v5
  v_lshlrev_b32 v8, 4, v8
  v_lshl_add_u32 v16, v5, 13, v8
  v_xor_b32 v17, 32, v16
  v_xor_b32 v18, 64, v16
  v_xor_b32 v19, 96, v16
  v_xor_b32 v20, 128, v16
  v_xor_b32 v21, 160, v16
  v_xor_b32 v22, 192, v16
  v_xor_b32 v23, 224, v16
  s_lshl_b32 s20, s16, 6
  v_xor_b32 v26, s20, v16
  v_xor_b32 v27, 32, v26
wp_B:
  s_mul_i32 s17, s33, 4682
  s_lshr_b32 s17, s17, 16
  s_mul_i32 s23, s17, 14
  s_sub_u32 s19, s33, s23
  s_cmp_lt_u32 s19, 7
  s_cselect_b32 s18, 0, 7
  s_cselect_b32 s28, 0, 8
  s_sub_u32 s18, s19, s18
  s_add_u32 s28, s28, s16
  s_lshl_b32 s25, s16, 15
  s_add_u32 s25, s25, 32768
  s_lshl_b32 s26, s17, 9
  s_lshl_b32 s20, s33, 2
  s_add_u32 s20, s20, s16
  s_mul_i32 s21, s20, 9363
  s_lshr_b32 s21, s21, 16
  s_mul_i32 s22, s21, 7
  s_sub_u32 s22, s20, s22
  s_mul_i32 s21, s21, 14336
  s_lshl_b32 s20, s22, 7
  s_add_u32 s20, s20, s21
  s_lshl_b32 s22, s22, 11
  s_add_u32 s52, s21, s22
  s_mov_b32 s68, s48
  s_and_b32 s69, s49, 0xffff
  s_mov_b32 s70, 1835008
  s_mov_b32 s71, 0x20000
  v_mul_u32_u24 v7, 896, v4
  v_lshl_add_u32 v7, v3, 5, v7
  buffer_load_dwordx4 v[128:131], v7, s[68:71], s20 offen
  buffer_load_dwordx4 v[132:135], v7, s[68:71], s20 offen offset:16
  s_mov_b32 s60, s44
  s_and_b32 s61, s45, 0xffff
  s_mov_b32 s62, 3670016
  s_mov_b32 s63, 0x20000
  s_mov_b32 s56, s46
  s_and_b32 s57, s47, 0xffff
  s_mov_b32 s58, 3670016
  s_mov_b32 s59, 0x20000
  s_mul_i32 s27, s17, 229376
  s_lshl_b32 s30, s18, 7
  s_add_u32 s27, s27, s30
  s_mul_i32 s30, s16, 57344
  s_add_u32 s27, s27, s30
  v_lshrrev_b32 v7, 3, v1
  v_and_b32 v8, 7, v1
  v_and_b32 v9, 2, v7
  v_xor_b32 v8, v8, v9
  v_mul_u32_u24 v7, 896, v7
  v_lshl_add_u32 v24, v8, 4, v7
  v_xor_b32 v25, 64, v24
  s_lshl_b32 s30, s16, 13
  s_add_u32 m0, s30, 0
  s_nop 0
  buffer_load_dwordx4 v24, s[56:59], s27 offen  lds
  s_add_u32 s27, s27, 7168
  s_add_u32 m0, s30, 1024
  s_nop 0
  buffer_load_dwordx4 v25, s[56:59], s27 offen  lds
  s_add_u32 s27, s27, 7168
  s_add_u32 m0, s30, 2048
  s_nop 0
  buffer_load_dwordx4 v24, s[56:59], s27 offen  lds
  s_add_u32 s27, s27, 7168
  s_add_u32 m0, s30, 3072
  s_nop 0
  buffer_load_dwordx4 v25, s[56:59], s27 offen  lds
  s_add_u32 s27, s27, 7168
  s_add_u32 m0, s30, 4096
  s_nop 0
  buffer_load_dwordx4 v24, s[56:59], s27 offen  lds
  s_add_u32 s27, s27, 7168
  s_add_u32 m0, s30, 5120
  s_nop 0
  buffer_load_dwordx4 v25, s[56:59], s27 offen  lds
  s_add_u32 s27, s27, 7168
  s_add_u32 m0, s30, 6144
  s_nop 0
  buffer_load_dwordx4 v24, s[56:59], s27 offen  lds
  s_add_u32 s27, s27, 7168
  s_add_u32 m0, s30, 7168
  s_nop 0
  buffer_load_dwordx4 v25, s[56:59], s27 offen  lds
  s_add_u32 s27, s27, 7168
  s_add_u32 s27, s28, 0
  s_min_u32 s27, s27, 13
  s_lshl_b32 s27, s27, 18
  s_add_u32 s27, s27, s26
  s_mov_b32 s55, s27
  v_lshrrev_b32 v7, 2, v4
  v_lshlrev_b32 v11, 4, v7
  v_lshlrev_b32 v7, 3, v7
  v_and_b32 v8, 3, v4
  v_add_u32 v7, v7, v8
  v_and_b32 v8, 2, v4
  v_lshl_add_u32 v11, v8, 1, v11
  v_and_b32 v8, 1, v4
  v_add_u32 v11, v11, v8
  v_or_b32 v10, 0, v3
  v_xor_b32 v10, v10, v4
  v_lshlrev_b32 v10, 4, v10
  v_lshl_add_u32 v44, v11, 9, v10
  v_lshl_add_u32 v10, v7, 9, v10
  v_add_u32 v32, s25, v10
  v_or_b32 v10, 4, v3
  v_xor_b32 v10, v10, v4
  v_lshlrev_b32 v10, 4, v10
  v_lshl_add_u32 v45, v11, 9, v10
  v_lshl_add_u32 v10, v7, 9, v10
  v_add_u32 v33, s25, v10
  v_or_b32 v10, 8, v3
  v_xor_b32 v10, v10, v4
  v_lshlrev_b32 v10, 4, v10
  v_lshl_add_u32 v46, v11, 9, v10
  v_lshl_add_u32 v10, v7, 9, v10
  v_add_u32 v34, s25, v10
  v_or_b32 v10, 12, v3
  v_xor_b32 v10, v10, v4
  v_lshlrev_b32 v10, 4, v10
  v_lshl_add_u32 v47, v11, 9, v10
  v_lshl_add_u32 v10, v7, 9, v10
  v_add_u32 v35, s25, v10
  s_mul_i32 s30, s17, 401408
  s_mul_i32 s31, s18, 57344
  s_add_u32 s30, s30, s31
  s_add_u32 s30, s30, 33554432
  v_add_u32 v28, s30, v2
  s_add_u32 s30, s30, 14336
  v_add_u32 v29, s30, v2
  s_add_u32 s30, s30, 14336
  v_add_u32 v30, s30, v2
  s_add_u32 s30, s30, 14336
  v_add_u32 v31, s30, v2
  s_add_u32 s30, s30, 14336
  v_mov_b32 v48, 1035512379
  v_lshrrev_b32 v7, 2, v4
  v_lshl_add_u32 v7, v3, 3, v7
  v_lshlrev_b32 v7, 7, v7
  v_and_b32 v8, 3, v4
  v_lshl_add_u32 v7, v8, 3, v7
  v_lshrrev_b32 v8, 3, v4
  v_and_b32 v9, 1, v3
  v_lshl_add_u32 v8, v9, 1, v8
  v_lshl_add_u32 v40, v8, 5, v7
  s_mul_i32 s31, s17, 28
  s_mov_b32 s29, 401408
  s_lshl_b32 s30, s18, 6
  s_add_u32 s30, s30, 0
  v_add_u32 v8, s30, v4
  v_subrev_u32 v9, 256, v8
  v_mul_u32_u24 v11, 171, v9
  v_lshrrev_b32 v11, 11, v11
  v_mul_u32_u24 v38, 12, v11
  v_sub_u32 v38, v9, v38
  v_add_u32 v38, 16, v38
  v_lshrrev_b32 v10, 4, v8
  v_cmp_gt_i32 vcc, 0, v9
  s_nop 1
  v_cndmask_b32 v10, v11, v10, vcc
  v_cndmask_b32 v39, v38, v4, vcc
  v_add_u32 v39, s31, v39
  v_lshrrev_b32 v38, 4, v39
  v_and_b32 v39, 15, v39
  v_mul_lo_u32 v10, v10, s29
  v_mul_u32_u24 v38, 14336, v38
  v_add_u32 v10, v10, v38
  v_lshl_add_u32 v10, v3, 8, v10
  v_lshl_add_u32 v10, v39, 4, v10
  v_add_u32 v12, 39976960, v10
  v_xor_b32 v41, 32, v40
  s_lshl_b32 s30, s18, 6
  s_add_u32 s30, s30, 16
  v_add_u32 v8, s30, v4
  v_subrev_u32 v9, 256, v8
  v_mul_u32_u24 v11, 171, v9
  v_lshrrev_b32 v11, 11, v11
  v_mul_u32_u24 v38, 12, v11
  v_sub_u32 v38, v9, v38
  v_add_u32 v38, 16, v38
  v_lshrrev_b32 v10, 4, v8
  v_cmp_gt_i32 vcc, 0, v9
  s_nop 1
  v_cndmask_b32 v10, v11, v10, vcc
  v_cndmask_b32 v39, v38, v4, vcc
  v_add_u32 v39, s31, v39
  v_lshrrev_b32 v38, 4, v39
  v_and_b32 v39, 15, v39
  v_mul_lo_u32 v10, v10, s29
  v_mul_u32_u24 v38, 14336, v38
  v_add_u32 v10, v10, v38
  v_lshl_add_u32 v10, v3, 8, v10
  v_lshl_add_u32 v10, v39, 4, v10
  v_add_u32 v13, 39976960, v10
  v_xor_b32 v42, 64, v40
  s_lshl_b32 s30, s18, 6
  s_add_u32 s30, s30, 32
  v_add_u32 v8, s30, v4
  v_subrev_u32 v9, 256, v8
  v_mul_u32_u24 v11, 171, v9
  v_lshrrev_b32 v11, 11, v11
  v_mul_u32_u24 v38, 12, v11
  v_sub_u32 v38, v9, v38
  v_add_u32 v38, 16, v38
  v_lshrrev_b32 v10, 4, v8
  v_cmp_gt_i32 vcc, 0, v9
  s_nop 1
  v_cndmask_b32 v10, v11, v10, vcc
  v_cndmask_b32 v39, v38, v4, vcc
  v_add_u32 v39, s31, v39
  v_lshrrev_b32 v38, 4, v39
  v_and_b32 v39, 15, v39
  v_mul_lo_u32 v10, v10, s29
  v_mul_u32_u24 v38, 14336, v38
  v_add_u32 v10, v10, v38
  v_lshl_add_u32 v10, v3, 8, v10
  v_lshl_add_u32 v10, v39, 4, v10
  v_add_u32 v14, 39976960, v10
  v_xor_b32 v43, 96, v40
  s_lshl_b32 s30, s18, 6
  s_add_u32 s30, s30, 48
  v_add_u32 v8, s30, v4
  v_subrev_u32 v9, 256, v8
  v_mul_u32_u24 v11, 171, v9
  v_lshrrev_b32 v11, 11, v11
  v_mul_u32_u24 v38, 12, v11
  v_sub_u32 v38, v9, v38
  v_add_u32 v38, 16, v38
  v_lshrrev_b32 v10, 4, v8
  v_cmp_gt_i32 vcc, 0, v9
  s_nop 1
  v_cndmask_b32 v10, v11, v10, vcc
  v_cndmask_b32 v39, v38, v4, vcc
  v_add_u32 v39, s31, v39
  v_lshrrev_b32 v38, 4, v39
  v_and_b32 v39, 15, v39
  v_mul_lo_u32 v10, v10, s29
  v_mul_u32_u24 v38, 14336, v38
  v_add_u32 v10, v10, v38
  v_lshl_add_u32 v10, v3, 8, v10
  v_lshl_add_u32 v10, v39, 4, v10
  v_add_u32 v15, 39976960, v10
  s_mov_b32 s27, s55
  s_add_u32 m0, s25, 0
  s_nop 0
  buffer_load_dwordx4 v16, s[60:63], s27 offen  lds
  s_add_u32 s27, s27, 16384
  s_add_u32 m0, s25, 1024
  s_nop 0
  buffer_load_dwordx4 v17, s[60:63], s27 offen  lds
  s_add_u32 s27, s27, 16384
  s_add_u32 m0, s25, 2048
  s_nop 0
  buffer_load_dwordx4 v16, s[60:63], s27 offen  lds
  s_add_u32 s27, s27, 16384
  s_add_u32 m0, s25, 3072
  s_nop 0
  buffer_load_dwordx4 v17, s[60:63], s27 offen  lds
  s_add_u32 s27, s27, 16384
  s_add_u32 m0, s25, 4096
  s_nop 0
  buffer_load_dwordx4 v18, s[60:63], s27 offen  lds
  s_add_u32 s27, s27, 16384
  s_add_u32 m0, s25, 5120
  s_nop 0
  buffer_load_dwordx4 v19, s[60:63], s27 offen  lds
  s_add_u32 s27, s27, 16384
  s_add_u32 m0, s25, 6144
  s_nop 0
  buffer_load_dwordx4 v18, s[60:63], s27 offen  lds
  s_add_u32 s27, s27, 16384
  s_add_u32 m0, s25, 7168
  s_nop 0
  buffer_load_dwordx4 v19, s[60:63], s27 offen  lds
  s_add_u32 s27, s27, 16384
  s_add_u32 m0, s25, 8192
  s_nop 0
  buffer_load_dwordx4 v20, s[60:63], s27 offen  lds
  s_add_u32 s27, s27, 16384
  s_add_u32 m0, s25, 9216
  s_nop 0
  buffer_load_dwordx4 v21, s[60:63], s27 offen  lds
  s_add_u32 s27, s27, 16384
  s_add_u32 m0, s25, 10240
  s_nop 0
  buffer_load_dwordx4 v20, s[60:63], s27 offen  lds
  s_add_u32 s27, s27, 16384
  s_add_u32 m0, s25, 11264
  s_nop 0
  buffer_load_dwordx4 v21, s[60:63], s27 offen  lds
  s_add_u32 s27, s27, 16384
  s_add_u32 m0, s25, 12288
  s_nop 0
  buffer_load_dwordx4 v22, s[60:63], s27 offen  lds
  s_add_u32 s27, s27, 16384
  s_add_u32 m0, s25, 13312
  s_nop 0
  buffer_load_dwordx4 v23, s[60:63], s27 offen  lds
  s_add_u32 s27, s27, 16384
  s_add_u32 m0, s25, 14336
  s_nop 0
  buffer_load_dwordx4 v22, s[60:63], s27 offen  lds
  s_add_u32 s27, s27, 16384
  s_add_u32 m0, s25, 15360
  s_nop 0
  buffer_load_dwordx4 v23, s[60:63], s27 offen  lds
  s_add_u32 s27, s27, 16384
  s_add_u32 s27, s28, 4
  s_min_u32 s27, s27, 13
  s_lshl_b32 s27, s27, 18
  s_add_u32 s27, s27, s26
  s_add_u32 m0, s25, 16384
  s_nop 0
  buffer_load_dwordx4 v16, s[60:63], s27 offen  lds
  s_add_u32 s27, s27, 16384
  s_add_u32 m0, s25, 17408
  s_nop 0
  buffer_load_dwordx4 v17, s[60:63], s27 offen  lds
  s_add_u32 s27, s27, 16384
  s_add_u32 m0, s25, 18432
  s_nop 0
  buffer_load_dwordx4 v16, s[60:63], s27 offen  lds
  s_add_u32 s27, s27, 16384
  s_add_u32 m0, s25, 19456
  s_nop 0
  buffer_load_dwordx4 v17, s[60:63], s27 offen  lds
  s_add_u32 s27, s27, 16384
  s_add_u32 m0, s25, 20480
  s_nop 0
  buffer_load_dwordx4 v18, s[60:63], s27 offen  lds
  s_add_u32 s27, s27, 16384
  s_add_u32 m0, s25, 21504
  s_nop 0
  buffer_load_dwordx4 v19, s[60:63], s27 offen  lds
  s_add_u32 s27, s27, 16384
  s_add_u32 m0, s25, 22528
  s_nop 0
  buffer_load_dwordx4 v18, s[60:63], s27 offen  lds
  s_add_u32 s27, s27, 16384
  s_add_u32 m0, s25, 23552
  s_nop 0
  buffer_load_dwordx4 v19, s[60:63], s27 offen  lds
  s_add_u32 s27, s27, 16384
  s_add_u32 m0, s25, 24576
  s_nop 0
  buffer_load_dwordx4 v20, s[60:63], s27 offen  lds
  s_add_u32 s27, s27, 16384
  s_add_u32 m0, s25, 25600
  s_nop 0
  buffer_load_dwordx4 v21, s[60:63], s27 offen  lds
  s_add_u32 s27, s27, 16384
  s_add_u32 m0, s25, 26624
  s_nop 0
  buffer_load_dwordx4 v20, s[60:63], s27 offen  lds
  s_add_u32 s27, s27, 16384
  s_add_u32 m0, s25, 27648
  s_nop 0
  buffer_load_dwordx4 v21, s[60:63], s27 offen  lds
  s_add_u32 s27, s27, 16384
  s_add_u32 m0, s25, 28672
  s_nop 0
  buffer_load_dwordx4 v22, s[60:63], s27 offen  lds
  s_add_u32 s27, s27, 16384
  s_add_u32 m0, s25, 29696
  s_nop 0
  buffer_load_dwordx4 v23, s[60:63], s27 offen  lds
  s_add_u32 s27, s27, 16384
  s_add_u32 m0, s25, 30720
  s_nop 0
  buffer_load_dwordx4 v22, s[60:63], s27 offen  lds
  s_add_u32 s27, s27, 16384
  s_add_u32 m0, s25, 31744
  s_nop 0
  buffer_load_dwordx4 v23, s[60:63], s27 offen  lds
  s_add_u32 s27, s27, 16384
  s_cmp_lt_u32 s18, 4
  s_cselect_b32 s34, 1, s97
  s_mov_b32 s68, s42
  s_and_b32 s69, s43, 0xffff
  s_mov_b32 s70, 3670016
  s_mov_b32 s71, 0x20000
  s_lshl_b32 s27, s18, 19
  s_add_u32 s27, s27, s26
  s_cmp_lg_u32 s34, 0
  s_cselect_b32 s27, 0x40000000, s27
  v_lshrrev_b32 v7, 2, v0
  v_and_b32 v8, 3, v0
  v_lshlrev_b32 v8, 7, v8
  v_lshl_add_u32 v9, v7, 13, v8
  buffer_load_dword v253, v9, s[68:71], s27 offen
  s_lshl_b32 s29, s28, 10
  s_add_u32 s31, s29, 4096
  s_cmp_lt_u32 s28, 10
  s_cselect_b32 s31, s31, 0x40000000
  s_waitcnt vmcnt(1)
  s_barrier
  ds_read_b64_tr_b16 a[0:1], v40 offset:0
  ds_read_b64_tr_b16 a[2:3], v40 offset:512
  ds_read_b64_tr_b16 a[32:33], v41 offset:0
  ds_read_b64_tr_b16 a[34:35], v41 offset:512
  ds_read_b64_tr_b16 a[64:65], v42 offset:0
  ds_read_b64_tr_b16 a[66:67], v42 offset:512
  ds_read_b64_tr_b16 a[96:97], v43 offset:0
  ds_read_b64_tr_b16 a[98:99], v43 offset:512
  ds_read_b128 a[128:131], v32 offset:0
  ds_read_b128 a[160:163], v32 offset:2048
  ds_read_b128 a[192:195], v32 offset:16384
  ds_read_b128 a[224:227], v32 offset:18432
  v_lshlrev_b32 v144, 9, v3
  v_lshl_add_u32 v144, v4, 4, v144
  s_add_u32 s53, s52, 75759616
  s_add_u32 s52, s52, 655360
  v_mov_b32 v136, v128
  v_mov_b32 v140, v129
  v_mov_b32 v137, v130
  v_mov_b32 v141, v131
  v_mov_b32 v138, v132
  v_mov_b32 v142, v133
  v_mov_b32 v139, v134
  v_mov_b32 v143, v135
  buffer_store_dwordx4 v[128:131], v144, s[8:11], s52 offen sc1
  buffer_store_dwordx4 v[132:135], v144, s[8:11], s52 offen offset:256 sc1
  buffer_store_dwordx4 v[136:139], v2, s[8:11], s53 offen sc1
  buffer_store_dwordx4 v[140:143], v2, s[8:11], s53 offen offset:1024 sc1
  s_waitcnt lgkmcnt(0)
  v_mfma_f32_16x16x32_bf16 v[64:67], a[128:131], a[0:3], 0
  ds_read_b64_tr_b16 a[4:5], v40 offset:4096
  ds_read_b64_tr_b16 a[6:7], v40 offset:4608
  v_mfma_f32_16x16x32_bf16 v[68:71], a[160:163], a[0:3], 0
  ds_read_b64_tr_b16 a[36:37], v41 offset:4096
  ds_read_b64_tr_b16 a[38:39], v41 offset:4608
  v_mfma_f32_16x16x32_bf16 v[72:75], a[128:131], a[32:35], 0
  ds_read_b64_tr_b16 a[68:69], v42 offset:4096
  ds_read_b64_tr_b16 a[70:71], v42 offset:4608
  v_mfma_f32_16x16x32_bf16 v[76:79], a[160:163], a[32:35], 0
  ds_read_b64_tr_b16 a[100:101], v43 offset:4096
  ds_read_b64_tr_b16 a[102:103], v43 offset:4608
  v_mfma_f32_16x16x32_bf16 v[80:83], a[128:131], a[64:67], 0
  ds_read_b128 a[132:135], v33 offset:0
  ds_read_b128 a[164:167], v33 offset:2048
  v_mfma_f32_16x16x32_bf16 v[84:87], a[160:163], a[64:67], 0
  ds_read_b128 a[196:199], v33 offset:16384
  ds_read_b128 a[228:231], v33 offset:18432
  v_mfma_f32_16x16x32_bf16 v[88:91], a[128:131], a[96:99], 0
  v_mfma_f32_16x16x32_bf16 v[92:95], a[160:163], a[96:99], 0
  v_mfma_f32_16x16x32_bf16 v[96:99], a[192:195], a[0:3], 0
  v_mfma_f32_16x16x32_bf16 v[100:103], a[224:227], a[0:3], 0
  v_mfma_f32_16x16x32_bf16 v[104:107], a[192:195], a[32:35], 0
  v_mfma_f32_16x16x32_bf16 v[108:111], a[224:227], a[32:35], 0
  v_mfma_f32_16x16x32_bf16 v[112:115], a[192:195], a[64:67], 0
  v_mfma_f32_16x16x32_bf16 v[116:119], a[224:227], a[64:67], 0
  v_mfma_f32_16x16x32_bf16 v[120:123], a[192:195], a[96:99], 0
  v_mfma_f32_16x16x32_bf16 v[124:127], a[224:227], a[96:99], 0
  s_waitcnt lgkmcnt(0)
  v_mfma_f32_16x16x32_bf16 v[64:67], a[132:135], a[4:7], v[64:67]
  ds_read_b64_tr_b16 a[8:9], v40 offset:8192
  ds_read_b64_tr_b16 a[10:11], v40 offset:8704
  v_mfma_f32_16x16x32_bf16 v[68:71], a[164:167], a[4:7], v[68:71]
  ds_read_b64_tr_b16 a[40:41], v41 offset:8192
  ds_read_b64_tr_b16 a[42:43], v41 offset:8704
  v_mfma_f32_16x16x32_bf16 v[72:75], a[132:135], a[36:39], v[72:75]
  ds_read_b64_tr_b16 a[72:73], v42 offset:8192
  ds_read_b64_tr_b16 a[74:75], v42 offset:8704
  v_mfma_f32_16x16x32_bf16 v[76:79], a[164:167], a[36:39], v[76:79]
  ds_read_b64_tr_b16 a[104:105], v43 offset:8192
  ds_read_b64_tr_b16 a[106:107], v43 offset:8704
  v_mfma_f32_16x16x32_bf16 v[80:83], a[132:135], a[68:71], v[80:83]
  ds_read_b128 a[136:139], v34 offset:0
  ds_read_b128 a[168:171], v34 offset:2048
  v_mfma_f32_16x16x32_bf16 v[84:87], a[164:167], a[68:71], v[84:87]
  ds_read_b128 a[200:203], v34 offset:16384
  ds_read_b128 a[232:235], v34 offset:18432
  v_mfma_f32_16x16x32_bf16 v[88:91], a[132:135], a[100:103], v[88:91]
  v_mfma_f32_16x16x32_bf16 v[92:95], a[164:167], a[100:103], v[92:95]
  v_mfma_f32_16x16x32_bf16 v[96:99], a[196:199], a[4:7], v[96:99]
  v_mfma_f32_16x16x32_bf16 v[100:103], a[228:231], a[4:7], v[100:103]
  v_mfma_f32_16x16x32_bf16 v[104:107], a[196:199], a[36:39], v[104:107]
  v_mfma_f32_16x16x32_bf16 v[108:111], a[228:231], a[36:39], v[108:111]
  v_mfma_f32_16x16x32_bf16 v[112:115], a[196:199], a[68:71], v[112:115]
  v_mfma_f32_16x16x32_bf16 v[116:119], a[228:231], a[68:71], v[116:119]
  v_mfma_f32_16x16x32_bf16 v[120:123], a[196:199], a[100:103], v[120:123]
  v_mfma_f32_16x16x32_bf16 v[124:127], a[228:231], a[100:103], v[124:127]
  s_waitcnt lgkmcnt(0)
  v_mfma_f32_16x16x32_bf16 v[64:67], a[136:139], a[8:11], v[64:67]
  ds_read_b64_tr_b16 a[12:13], v40 offset:12288
  ds_read_b64_tr_b16 a[14:15], v40 offset:12800
  v_mfma_f32_16x16x32_bf16 v[68:71], a[168:171], a[8:11], v[68:71]
  ds_read_b64_tr_b16 a[44:45], v41 offset:12288
  ds_read_b64_tr_b16 a[46:47], v41 offset:12800
  v_mfma_f32_16x16x32_bf16 v[72:75], a[136:139], a[40:43], v[72:75]
  ds_read_b64_tr_b16 a[76:77], v42 offset:12288
  ds_read_b64_tr_b16 a[78:79], v42 offset:12800
  v_mfma_f32_16x16x32_bf16 v[76:79], a[168:171], a[40:43], v[76:79]
  ds_read_b64_tr_b16 a[108:109], v43 offset:12288
  ds_read_b64_tr_b16 a[110:111], v43 offset:12800
  v_mfma_f32_16x16x32_bf16 v[80:83], a[136:139], a[72:75], v[80:83]
  ds_read_b128 a[140:143], v35 offset:0
  ds_read_b128 a[172:175], v35 offset:2048
  v_mfma_f32_16x16x32_bf16 v[84:87], a[168:171], a[72:75], v[84:87]
  ds_read_b128 a[204:207], v35 offset:16384
  ds_read_b128 a[236:239], v35 offset:18432
  v_mfma_f32_16x16x32_bf16 v[88:91], a[136:139], a[104:107], v[88:91]
  v_mfma_f32_16x16x32_bf16 v[92:95], a[168:171], a[104:107], v[92:95]
  v_mfma_f32_16x16x32_bf16 v[96:99], a[200:203], a[8:11], v[96:99]
  v_mfma_f32_16x16x32_bf16 v[100:103], a[232:235], a[8:11], v[100:103]
  v_mfma_f32_16x16x32_bf16 v[104:107], a[200:203], a[40:43], v[104:107]
  v_mfma_f32_16x16x32_bf16 v[108:111], a[232:235], a[40:43], v[108:111]
  v_mfma_f32_16x16x32_bf16 v[112:115], a[200:203], a[72:75], v[112:115]
  v_mfma_f32_16x16x32_bf16 v[116:119], a[232:235], a[72:75], v[116:119]
  v_mfma_f32_16x16x32_bf16 v[120:123], a[200:203], a[104:107], v[120:123]
  v_mfma_f32_16x16x32_bf16 v[124:127], a[232:235], a[104:107], v[124:127]
  s_waitcnt lgkmcnt(0)
  v_mfma_f32_16x16x32_bf16 v[64:67], a[140:143], a[12:15], v[64:67]
  ds_read_b64_tr_b16 a[16:17], v40 offset:16384
  ds_read_b64_tr_b16 a[18:19], v40 offset:16896
  v_mfma_f32_16x16x32_bf16 v[68:71], a[172:175], a[12:15], v[68:71]
  ds_read_b64_tr_b16 a[48:49], v41 offset:16384
  ds_read_b64_tr_b16 a[50:51], v41 offset:16896
  v_mfma_f32_16x16x32_bf16 v[72:75], a[140:143], a[44:47], v[72:75]
  ds_read_b64_tr_b16 a[80:81], v42 offset:16384
  ds_read_b64_tr_b16 a[82:83], v42 offset:16896
  v_mfma_f32_16x16x32_bf16 v[76:79], a[172:175], a[44:47], v[76:79]
  ds_read_b64_tr_b16 a[112:113], v43 offset:16384
  ds_read_b64_tr_b16 a[114:115], v43 offset:16896
  v_mfma_f32_16x16x32_bf16 v[80:83], a[140:143], a[76:79], v[80:83]
  ds_read_b128 a[144:147], v32 offset:256
  ds_read_b128 a[176:179], v32 offset:2304
  v_mfma_f32_16x16x32_bf16 v[84:87], a[172:175], a[76:79], v[84:87]
  ds_read_b128 a[208:211], v32 offset:16640
  ds_read_b128 a[240:243], v32 offset:18688
  v_mfma_f32_16x16x32_bf16 v[88:91], a[140:143], a[108:111], v[88:91]
  v_mfma_f32_16x16x32_bf16 v[92:95], a[172:175], a[108:111], v[92:95]
  v_mfma_f32_16x16x32_bf16 v[96:99], a[204:207], a[12:15], v[96:99]
  v_mfma_f32_16x16x32_bf16 v[100:103], a[236:239], a[12:15], v[100:103]
  v_mfma_f32_16x16x32_bf16 v[104:107], a[204:207], a[44:47], v[104:107]
  v_mfma_f32_16x16x32_bf16 v[108:111], a[236:239], a[44:47], v[108:111]
  v_mfma_f32_16x16x32_bf16 v[112:115], a[204:207], a[76:79], v[112:115]
  v_mfma_f32_16x16x32_bf16 v[116:119], a[236:239], a[76:79], v[116:119]
  v_mfma_f32_16x16x32_bf16 v[120:123], a[204:207], a[108:111], v[120:123]
  v_mfma_f32_16x16x32_bf16 v[124:127], a[236:239], a[108:111], v[124:127]
  s_waitcnt lgkmcnt(0)
  v_mfma_f32_16x16x32_bf16 v[64:67], a[144:147], a[16:19], v[64:67]
  ds_read_b64_tr_b16 a[20:21], v40 offset:20480
  ds_read_b64_tr_b16 a[22:23], v40 offset:20992
  v_mfma_f32_16x16x32_bf16 v[68:71], a[176:179], a[16:19], v[68:71]
  ds_read_b64_tr_b16 a[52:53], v41 offset:20480
  ds_read_b64_tr_b16 a[54:55], v41 offset:20992
  v_mfma_f32_16x16x32_bf16 v[72:75], a[144:147], a[48:51], v[72:75]
  ds_read_b64_tr_b16 a[84:85], v42 offset:20480
  ds_read_b64_tr_b16 a[86:87], v42 offset:20992
  v_mfma_f32_16x16x32_bf16 v[76:79], a[176:179], a[48:51], v[76:79]
  ds_read_b64_tr_b16 a[116:117], v43 offset:20480
  ds_read_b64_tr_b16 a[118:119], v43 offset:20992
  v_mfma_f32_16x16x32_bf16 v[80:83], a[144:147], a[80:83], v[80:83]
  ds_read_b128 a[148:151], v33 offset:256
  ds_read_b128 a[180:183], v33 offset:2304
  v_mfma_f32_16x16x32_bf16 v[84:87], a[176:179], a[80:83], v[84:87]
  ds_read_b128 a[212:215], v33 offset:16640
  ds_read_b128 a[244:247], v33 offset:18688
  v_mfma_f32_16x16x32_bf16 v[88:91], a[144:147], a[112:115], v[88:91]
  v_mfma_f32_16x16x32_bf16 v[92:95], a[176:179], a[112:115], v[92:95]
  v_mfma_f32_16x16x32_bf16 v[96:99], a[208:211], a[16:19], v[96:99]
  v_mfma_f32_16x16x32_bf16 v[100:103], a[240:243], a[16:19], v[100:103]
  v_mfma_f32_16x16x32_bf16 v[104:107], a[208:211], a[48:51], v[104:107]
  v_mfma_f32_16x16x32_bf16 v[108:111], a[240:243], a[48:51], v[108:111]
  v_mfma_f32_16x16x32_bf16 v[112:115], a[208:211], a[80:83], v[112:115]
  v_mfma_f32_16x16x32_bf16 v[116:119], a[240:243], a[80:83], v[116:119]
  v_mfma_f32_16x16x32_bf16 v[120:123], a[208:211], a[112:115], v[120:123]
  v_mfma_f32_16x16x32_bf16 v[124:127], a[240:243], a[112:115], v[124:127]
  s_waitcnt lgkmcnt(0)
  v_mfma_f32_16x16x32_bf16 v[64:67], a[148:151], a[20:23], v[64:67]
  ds_read_b64_tr_b16 a[24:25], v40 offset:24576
  ds_read_b64_tr_b16 a[26:27], v40 offset:25088
  v_mfma_f32_16x16x32_bf16 v[68:71], a[180:183], a[20:23], v[68:71]
  ds_read_b64_tr_b16 a[56:57], v41 offset:24576
  ds_read_b64_tr_b16 a[58:59], v41 offset:25088
  v_mfma_f32_16x16x32_bf16 v[72:75], a[148:151], a[52:55], v[72:75]
  ds_read_b64_tr_b16 a[88:89], v42 offset:24576
  ds_read_b64_tr_b16 a[90:91], v42 offset:25088
  v_mfma_f32_16x16x32_bf16 v[76:79], a[180:183], a[52:55], v[76:79]
  ds_read_b64_tr_b16 a[120:121], v43 offset:24576
  ds_read_b64_tr_b16 a[122:123], v43 offset:25088
  v_mfma_f32_16x16x32_bf16 v[80:83], a[148:151], a[84:87], v[80:83]
  ds_read_b128 a[152:155], v34 offset:256
  ds_read_b128 a[184:187], v34 offset:2304
  v_mfma_f32_16x16x32_bf16 v[84:87], a[180:183], a[84:87], v[84:87]
  ds_read_b128 a[216:219], v34 offset:16640
  ds_read_b128 a[248:251], v34 offset:18688
  v_mfma_f32_16x16x32_bf16 v[88:91], a[148:151], a[116:119], v[88:91]
  v_mfma_f32_16x16x32_bf16 v[92:95], a[180:183], a[116:119], v[92:95]
  v_mfma_f32_16x16x32_bf16 v[96:99], a[212:215], a[20:23], v[96:99]
  v_mfma_f32_16x16x32_bf16 v[100:103], a[244:247], a[20:23], v[100:103]
  v_mfma_f32_16x16x32_bf16 v[104:107], a[212:215], a[52:55], v[104:107]
  v_mfma_f32_16x16x32_bf16 v[108:111], a[244:247], a[52:55], v[108:111]
  v_mfma_f32_16x16x32_bf16 v[112:115], a[212:215], a[84:87], v[112:115]
  v_mfma_f32_16x16x32_bf16 v[116:119], a[244:247], a[84:87], v[116:119]
  v_mfma_f32_16x16x32_bf16 v[120:123], a[212:215], a[116:119], v[120:123]
  v_mfma_f32_16x16x32_bf16 v[124:127], a[244:247], a[116:119], v[124:127]
  s_waitcnt lgkmcnt(0)
  v_mfma_f32_16x16x32_bf16 v[64:67], a[152:155], a[24:27], v[64:67]
  ds_read_b64_tr_b16 a[28:29], v40 offset:28672
  ds_read_b64_tr_b16 a[30:31], v40 offset:29184
  v_mfma_f32_16x16x32_bf16 v[68:71], a[184:187], a[24:27], v[68:71]
  ds_read_b64_tr_b16 a[60:61], v41 offset:28672
  ds_read_b64_tr_b16 a[62:63], v41 offset:29184
  v_mfma_f32_16x16x32_bf16 v[72:75], a[152:155], a[56:59], v[72:75]
  ds_read_b64_tr_b16 a[92:93], v42 offset:28672
  ds_read_b64_tr_b16 a[94:95], v42 offset:29184
  v_mfma_f32_16x16x32_bf16 v[76:79], a[184:187], a[56:59], v[76:79]
  ds_read_b64_tr_b16 a[124:125], v43 offset:28672
  ds_read_b64_tr_b16 a[126:127], v43 offset:29184
  v_mfma_f32_16x16x32_bf16 v[80:83], a[152:155], a[88:91], v[80:83]
  ds_read_b128 a[156:159], v35 offset:256
  ds_read_b128 a[188:191], v35 offset:2304
  v_mfma_f32_16x16x32_bf16 v[84:87], a[184:187], a[88:91], v[84:87]
  ds_read_b128 a[220:223], v35 offset:16640
  ds_read_b128 a[252:255], v35 offset:18688
  v_mfma_f32_16x16x32_bf16 v[88:91], a[152:155], a[120:123], v[88:91]
  v_mfma_f32_16x16x32_bf16 v[92:95], a[184:187], a[120:123], v[92:95]
  v_mfma_f32_16x16x32_bf16 v[96:99], a[216:219], a[24:27], v[96:99]
  v_mfma_f32_16x16x32_bf16 v[100:103], a[248:251], a[24:27], v[100:103]
  v_mfma_f32_16x16x32_bf16 v[104:107], a[216:219], a[56:59], v[104:107]
  v_mfma_f32_16x16x32_bf16 v[108:111], a[248:251], a[56:59], v[108:111]
  v_mfma_f32_16x16x32_bf16 v[112:115], a[216:219], a[88:91], v[112:115]
  v_mfma_f32_16x16x32_bf16 v[116:119], a[248:251], a[88:91], v[116:119]
  v_mfma_f32_16x16x32_bf16 v[120:123], a[216:219], a[120:123], v[120:123]
  v_mfma_f32_16x16x32_bf16 v[124:127], a[248:251], a[120:123], v[124:127]
  s_waitcnt lgkmcnt(0)
  s_barrier
  buffer_load_dwordx2 v[254:255], v252, s[12:15], 0 offen offset:128 sc1
  buffer_load_dword v253, v252, s[12:15], 0 offen sc1
  v_mfma_f32_16x16x32_bf16 v[64:67], a[156:159], a[28:31], v[64:67]
  v_mfma_f32_16x16x32_bf16 v[68:71], a[188:191], a[28:31], v[68:71]
  v_mfma_f32_16x16x32_bf16 v[72:75], a[156:159], a[60:63], v[72:75]
  v_mfma_f32_16x16x32_bf16 v[76:79], a[188:191], a[60:63], v[76:79]
  v_mfma_f32_16x16x32_bf16 v[80:83], a[156:159], a[92:95], v[80:83]
  v_cvt_pk_bf16_f32 v64, v64, v65
  v_cvt_pk_bf16_f32 v65, v66, v67
  v_mfma_f32_16x16x32_bf16 v[84:87], a[188:191], a[92:95], v[84:87]
  v_cvt_pk_bf16_f32 v66, v68, v69
  v_cvt_pk_bf16_f32 v67, v70, v71
  v_mfma_f32_16x16x32_bf16 v[88:91], a[156:159], a[124:127], v[88:91]
  buffer_store_dwordx4 v[64:67], v12, s[8:11], s29 offen sc1
  v_cvt_pk_bf16_f32 v72, v72, v73
  v_mfma_f32_16x16x32_bf16 v[92:95], a[188:191], a[124:127], v[92:95]
  v_cvt_pk_bf16_f32 v73, v74, v75
  v_cvt_pk_bf16_f32 v74, v76, v77
  v_mfma_f32_16x16x32_bf16 v[96:99], a[220:223], a[28:31], v[96:99]
  v_cvt_pk_bf16_f32 v75, v78, v79
  buffer_store_dwordx4 v[72:75], v13, s[8:11], s29 offen sc1
  v_mfma_f32_16x16x32_bf16 v[100:103], a[252:255], a[28:31], v[100:103]
  v_cvt_pk_bf16_f32 v80, v80, v81
  v_cvt_pk_bf16_f32 v81, v82, v83
  v_mfma_f32_16x16x32_bf16 v[104:107], a[220:223], a[60:63], v[104:107]
  v_cvt_pk_bf16_f32 v82, v84, v85
  v_cvt_pk_bf16_f32 v83, v86, v87
  v_mfma_f32_16x16x32_bf16 v[108:111], a[252:255], a[60:63], v[108:111]
  buffer_store_dwordx4 v[80:83], v14, s[8:11], s29 offen sc1
  v_cvt_pk_bf16_f32 v88, v88, v89
  v_mfma_f32_16x16x32_bf16 v[112:115], a[220:223], a[92:95], v[112:115]
  v_cvt_pk_bf16_f32 v89, v90, v91
  v_cvt_pk_bf16_f32 v90, v92, v93
  v_mfma_f32_16x16x32_bf16 v[116:119], a[252:255], a[92:95], v[116:119]
  v_cvt_pk_bf16_f32 v91, v94, v95
  buffer_store_dwordx4 v[88:91], v15, s[8:11], s29 offen sc1
  v_mfma_f32_16x16x32_bf16 v[120:123], a[220:223], a[124:127], v[120:123]
  v_cvt_pk_bf16_f32 v96, v96, v97
  v_cvt_pk_bf16_f32 v97, v98, v99
  v_mfma_f32_16x16x32_bf16 v[124:127], a[252:255], a[124:127], v[124:127]
  v_cvt_pk_bf16_f32 v98, v100, v101
  v_cvt_pk_bf16_f32 v99, v102, v103
  buffer_store_dwordx4 v[96:99], v12, s[8:11], s31 offen sc1
  v_cvt_pk_bf16_f32 v104, v104, v105
  v_cvt_pk_bf16_f32 v105, v106, v107
  v_cvt_pk_bf16_f32 v106, v108, v109
  v_cvt_pk_bf16_f32 v107, v110, v111
  buffer_store_dwordx4 v[104:107], v13, s[8:11], s31 offen sc1
  v_cvt_pk_bf16_f32 v112, v112, v113
  v_cvt_pk_bf16_f32 v113, v114, v115
  v_cvt_pk_bf16_f32 v114, v116, v117
  v_cvt_pk_bf16_f32 v115, v118, v119
  buffer_store_dwordx4 v[112:115], v14, s[8:11], s31 offen sc1
  v_cvt_pk_bf16_f32 v120, v120, v121
  v_cvt_pk_bf16_f32 v121, v122, v123
  v_cvt_pk_bf16_f32 v122, v124, v125
  v_cvt_pk_bf16_f32 v123, v126, v127
  buffer_store_dwordx4 v[120:123], v15, s[8:11], s31 offen sc1
  s_cmp_lg_u32 s34, 0
  s_cbranch_scc1 wp_B2
  s_mov_b32 s60, s40
  s_and_b32 s61, s41, 0xffff
  s_mov_b32 s62, 3670016
  s_mov_b32 s63, 0x20000
  s_mov_b32 s56, s42
  s_and_b32 s57, s43, 0xffff
  s_mov_b32 s58, 3670016
  s_mov_b32 s59, 0x20000
  s_lshl_b32 s27, s18, 2
  s_add_u32 s27, s27, s16
  s_lshl_b32 s27, s27, 17
  s_add_u32 s27, s27, s26
  s_lshl_b32 s30, s16, 13
  s_add_u32 m0, s30, 0
  s_nop 0
  buffer_load_dwordx4 v26, s[56:59], s27 offen  lds
  s_add_u32 s27, s27, 16384
  s_add_u32 m0, s30, 1024
  s_nop 0
  buffer_load_dwordx4 v26, s[56:59], s27 offen  lds
  s_add_u32 s27, s27, 16384
  s_add_u32 m0, s30, 2048
  s_nop 0
  buffer_load_dwordx4 v27, s[56:59], s27 offen  lds
  s_add_u32 s27, s27, 16384
  s_add_u32 m0, s30, 3072
  s_nop 0
  buffer_load_dwordx4 v27, s[56:59], s27 offen  lds
  s_add_u32 s27, s27, 16384
  s_add_u32 m0, s30, 4096
  s_nop 0
  buffer_load_dwordx4 v26, s[56:59], s27 offen  lds
  s_add_u32 s27, s27, 16384
  s_add_u32 m0, s30, 5120
  s_nop 0
  buffer_load_dwordx4 v26, s[56:59], s27 offen  lds
  s_add_u32 s27, s27, 16384
  s_add_u32 m0, s30, 6144
  s_nop 0
  buffer_load_dwordx4 v27, s[56:59], s27 offen  lds
  s_add_u32 s27, s27, 16384
  s_add_u32 m0, s30, 7168
  s_nop 0
  buffer_load_dwordx4 v27, s[56:59], s27 offen  lds
  s_add_u32 s27, s27, 16384
  s_add_u32 s27, s28, 0
  s_min_u32 s27, s27, 13
  s_lshl_b32 s27, s27, 18
  s_add_u32 s27, s27, s26
  s_add_u32 m0, s25, 0
  s_nop 0
  buffer_load_dwordx4 v16, s[60:63], s27 offen  lds
  s_add_u32 s27, s27, 16384
  s_add_u32 m0, s25, 1024
  s_nop 0
  buffer_load_dwordx4 v17, s[60:63], s27 offen  lds
  s_add_u32 s27, s27, 16384
  s_add_u32 m0, s25, 2048
  s_nop 0
  buffer_load_dwordx4 v16, s[60:63], s27 offen  lds
  s_add_u32 s27, s27, 16384
  s_add_u32 m0, s25, 3072
  s_nop 0
  buffer_load_dwordx4 v17, s[60:63], s27 offen  lds
  s_add_u32 s27, s27, 16384
  s_waitcnt vmcnt(12)
  s_barrier
  s_cmp_lg_u32 s16, 0
  s_cbranch_scc1 wp_f1_f
  v_readfirstlane_b32 s20, v254
  s_cmp_eq_u32 s20, 1
  s_cbranch_scc1 wp_f1_w_ok
  s_mov_b32 s30, 0
wp_f1_w:
  buffer_load_dword v254, off, s[12:15], 0 offset:128 sc1
  s_waitcnt vmcnt(0)
  v_cmp_ne_u32 vcc, 1, v254
  s_cbranch_vccz wp_f1_w_ok
  s_sleep 8
  s_add_u32 s30, s30, 1
  s_cmp_lt_u32 s30, 16
  s_cbranch_scc1 wp_f1_w
  s_branch wp_f1_f
wp_f1_w_ok:
  s_lshl_b32 s20, s17, 7
  s_add_u32 s20, s20, 582144
  s_lshl_b32 s21, 1, s19
  v_mov_b32 v248, s21
  s_mov_b64 exec, 1
  buffer_atomic_or v248, v252, s[8:11], s20 offen sc0
  s_mov_b64 exec, -1
  s_mov_b32 s37, s21
wp_f1_f:
  s_add_u32 m0, s25, 4096
  s_nop 0
  buffer_load_dwordx4 v18, s[60:63], s27 offen  lds
  s_add_u32 s27, s27, 16384
  s_add_u32 m0, s25, 5120
  s_nop 0
  buffer_load_dwordx4 v19, s[60:63], s27 offen  lds
  s_add_u32 s27, s27, 16384
  s_add_u32 m0, s25, 6144
  s_nop 0
  buffer_load_dwordx4 v18, s[60:63], s27 offen  lds
  s_add_u32 s27, s27, 16384
  s_add_u32 m0, s25, 7168
  s_nop 0
  buffer_load_dwordx4 v19, s[60:63], s27 offen  lds
  s_add_u32 s27, s27, 16384
  s_add_u32 m0, s25, 8192
  s_nop 0
  buffer_load_dwordx4 v20, s[60:63], s27 offen  lds
  s_add_u32 s27, s27, 16384
  s_add_u32 m0, s25, 9216
  s_nop 0
  buffer_load_dwordx4 v21, s[60:63], s27 offen  lds
  s_add_u32 s27, s27, 16384
  s_add_u32 m0, s25, 10240
  s_nop 0
  buffer_load_dwordx4 v20, s[60:63], s27 offen  lds
  s_add_u32 s27, s27, 16384
  s_add_u32 m0, s25, 11264
  s_nop 0
  buffer_load_dwordx4 v21, s[60:63], s27 offen  lds
  s_add_u32 s27, s27, 16384
  s_add_u32 m0, s25, 12288
  s_nop 0
  buffer_load_dwordx4 v22, s[60:63], s27 offen  lds
  s_add_u32 s27, s27, 16384
  s_add_u32 m0, s25, 13312
  s_nop 0
  buffer_load_dwordx4 v23, s[60:63], s27 offen  lds
  s_add_u32 s27, s27, 16384
  s_add_u32 m0, s25, 14336
  s_nop 0
  buffer_load_dwordx4 v22, s[60:63], s27 offen  lds
  s_add_u32 s27, s27, 16384
  s_add_u32 m0, s25, 15360
  s_nop 0
  buffer_load_dwordx4 v23, s[60:63], s27 offen  lds
  s_add_u32 s27, s27, 16384
  s_add_u32 s27, s28, 4
  s_min_u32 s27, s27, 13
  s_lshl_b32 s27, s27, 18
  s_add_u32 s27, s27, s26
  s_waitcnt vmcnt(12)
  v_readfirstlane_b32 s20, v248
  s_and_b32 s20, s20, 16383
  s_xor_b32 s20, s20, s37
  s_cmp_lg_u32 s20, 16383
  s_cselect_b32 s20, 0, s37
  s_mov_b32 s37, 0
  s_cmp_eq_u32 s20, 0
  s_cbranch_scc1 wp_g1
  s_lshl_b32 s21, 1, s17
  v_mov_b32 v248, s21
  s_mov_b32 s20, 586240
  v_lshlrev_b32 v247, 7, v0
  s_mov_b64 exec, 0xff
  buffer_atomic_or v248, v247, s[8:11], s20 offen
  s_mov_b64 exec, -1
wp_g1:
  s_add_u32 m0, s25, 16384
  s_nop 0
  buffer_load_dwordx4 v16, s[60:63], s27 offen  lds
  s_add_u32 s27, s27, 16384
  s_add_u32 m0, s25, 17408
  s_nop 0
  buffer_load_dwordx4 v17, s[60:63], s27 offen  lds
  s_add_u32 s27, s27, 16384
  s_add_u32 m0, s25, 18432
  s_nop 0
  buffer_load_dwordx4 v16, s[60:63], s27 offen  lds
  s_add_u32 s27, s27, 16384
  s_add_u32 m0, s25, 19456
  s_nop 0
  buffer_load_dwordx4 v17, s[60:63], s27 offen  lds
  s_add_u32 s27, s27, 16384
  s_add_u32 m0, s25, 20480
  s_nop 0
  buffer_load_dwordx4 v18, s[60:63], s27 offen  lds
  s_add_u32 s27, s27, 16384
  s_add_u32 m0, s25, 21504
  s_nop 0
  buffer_load_dwordx4 v19, s[60:63], s27 offen  lds
  s_add_u32 s27, s27, 16384
  s_add_u32 m0, s25, 22528
  s_nop 0
  buffer_load_dwordx4 v18, s[60:63], s27 offen  lds
  s_add_u32 s27, s27, 16384
  s_add_u32 m0, s25, 23552
  s_nop 0
  buffer_load_dwordx4 v19, s[60:63], s27 offen  lds
  s_add_u32 s27, s27, 16384
  s_add_u32 m0, s25, 24576
  s_nop 0
  buffer_load_dwordx4 v20, s[60:63], s27 offen  lds
  s_add_u32 s27, s27, 16384
  s_add_u32 m0, s25, 25600
  s_nop 0
  buffer_load_dwordx4 v21, s[60:63], s27 offen  lds
  s_add_u32 s27, s27, 16384
  s_add_u32 m0, s25, 26624
  s_nop 0
  buffer_load_dwordx4 v20, s[60:63], s27 offen  lds
  s_add_u32 s27, s27, 16384
  s_add_u32 m0, s25, 27648
  s_nop 0
  buffer_load_dwordx4 v21, s[60:63], s27 offen  lds
  s_add_u32 s27, s27, 16384
  s_add_u32 m0, s25, 28672
  s_nop 0
  buffer_load_dwordx4 v22, s[60:63], s27 offen  lds
  s_add_u32 s27, s27, 16384
  s_add_u32 m0, s25, 29696
  s_nop 0
  buffer_load_dwordx4 v23, s[60:63], s27 offen  lds
  s_add_u32 s27, s27, 16384
  s_add_u32 m0, s25, 30720
  s_nop 0
  buffer_load_dwordx4 v22, s[60:63], s27 offen  lds
  s_add_u32 s27, s27, 16384
  s_add_u32 m0, s25, 31744
  s_nop 0
  buffer_load_dwordx4 v23, s[60:63], s27 offen  lds
  s_add_u32 s27, s27, 16384
  s_branch wp_A
wp_B2:
  v_lshlrev_b32 v6, 7, v1
  s_getpc_b64 s[98:99]
ct_5:
  s_add_u32 s98, s98, wp_fin-ct_5
  s_addc_u32 s99, s99, 0
  global_load_dword v7, v6, s[98:99]
  s_getpc_b64 s[98:99]
ct_6:
  s_add_u32 s98, s98, wg_vo-ct_6
  s_addc_u32 s99, s99, 0
  global_load_dword v7, v6, s[98:99]
  s_waitcnt vmcnt(2)
  s_barrier
  s_cmp_lg_u32 s16, 0
  s_cbranch_scc1 wp_f2_f
  v_readfirstlane_b32 s20, v254
  s_cmp_eq_u32 s20, 1
  s_cbranch_scc1 wp_f2_w_ok
  s_mov_b32 s30, 0
wp_f2_w:
  buffer_load_dword v254, off, s[12:15], 0 offset:128 sc1
  s_waitcnt vmcnt(0)
  v_cmp_ne_u32 vcc, 1, v254
  s_cbranch_vccz wp_f2_w_ok
  s_sleep 8
  s_add_u32 s30, s30, 1
  s_cmp_lt_u32 s30, 16
  s_cbranch_scc1 wp_f2_w
  s_branch wp_f2_f
wp_f2_w_ok:
  s_lshl_b32 s20, s17, 7
  s_add_u32 s20, s20, 582144
  s_lshl_b32 s21, 1, s19
  v_mov_b32 v248, s21
  s_mov_b64 exec, 1
  buffer_atomic_or v248, v252, s[8:11], s20 offen sc0
  s_mov_b64 exec, -1
  s_mov_b32 s37, s21
wp_f2_f:
  s_cmp_eq_u32 s97, 0
  s_cselect_b32 s39, -1, s39
  s_branch wp_fin
wp_A0:
  s_mov_b32 s60, s40
  s_and_b32 s61, s41, 0xffff
  s_mov_b32 s62, 3670016
  s_mov_b32 s63, 0x20000
  s_mov_b32 s56, s42
  s_and_b32 s57, s43, 0xffff
  s_mov_b32 s58, 3670016
  s_mov_b32 s59, 0x20000
  s_lshl_b32 s27, s18, 2
  s_add_u32 s27, s27, s16
  s_lshl_b32 s27, s27, 17
  s_add_u32 s27, s27, s26
  s_lshl_b32 s30, s16, 13
  s_add_u32 m0, s30, 0
  s_nop 0
  buffer_load_dwordx4 v26, s[56:59], s27 offen  lds
  s_add_u32 s27, s27, 16384
  s_add_u32 m0, s30, 1024
  s_nop 0
  buffer_load_dwordx4 v26, s[56:59], s27 offen  lds
  s_add_u32 s27, s27, 16384
  s_add_u32 m0, s30, 2048
  s_nop 0
  buffer_load_dwordx4 v27, s[56:59], s27 offen  lds
  s_add_u32 s27, s27, 16384
  s_add_u32 m0, s30, 3072
  s_nop 0
  buffer_load_dwordx4 v27, s[56:59], s27 offen  lds
  s_add_u32 s27, s27, 16384
  s_add_u32 m0, s30, 4096
  s_nop 0
  buffer_load_dwordx4 v26, s[56:59], s27 offen  lds
  s_add_u32 s27, s27, 16384
  s_add_u32 m0, s30, 5120
  s_nop 0
  buffer_load_dwordx4 v26, s[56:59], s27 offen  lds
  s_add_u32 s27, s27, 16384
  s_add_u32 m0, s30, 6144
  s_nop 0
  buffer_load_dwordx4 v27, s[56:59], s27 offen  lds
  s_add_u32 s27, s27, 16384
  s_add_u32 m0, s30, 7168
  s_nop 0
  buffer_load_dwordx4 v27, s[56:59], s27 offen  lds
  s_add_u32 s27, s27, 16384
  s_add_u32 s27, s28, 0
  s_min_u32 s27, s27, 13
  s_lshl_b32 s27, s27, 18
  s_add_u32 s27, s27, s26
  s_add_u32 m0, s25, 0
  s_nop 0
  buffer_load_dwordx4 v16, s[60:63], s27 offen  lds
  s_add_u32 s27, s27, 16384
  s_add_u32 m0, s25, 1024
  s_nop 0
  buffer_load_dwordx4 v17, s[60:63], s27 offen  lds
  s_add_u32 s27, s27, 16384
  s_add_u32 m0, s25, 2048
  s_nop 0
  buffer_load_dwordx4 v16, s[60:63], s27 offen  lds
  s_add_u32 s27, s27, 16384
  s_add_u32 m0, s25, 3072
  s_nop 0
  buffer_load_dwordx4 v17, s[60:63], s27 offen  lds
  s_add_u32 s27, s27, 16384
  s_add_u32 m0, s25, 4096
  s_nop 0
  buffer_load_dwordx4 v18, s[60:63], s27 offen  lds
  s_add_u32 s27, s27, 16384
  s_add_u32 m0, s25, 5120
  s_nop 0
  buffer_load_dwordx4 v19, s[60:63], s27 offen  lds
  s_add_u32 s27, s27, 16384
  s_add_u32 m0, s25, 6144
  s_nop 0
  buffer_load_dwordx4 v18, s[60:63], s27 offen  lds
  s_add_u32 s27, s27, 16384
  s_add_u32 m0, s25, 7168
  s_nop 0
  buffer_load_dwordx4 v19, s[60:63], s27 offen  lds
  s_add_u32 s27, s27, 16384
  s_add_u32 m0, s25, 8192
  s_nop 0
  buffer_load_dwordx4 v20, s[60:63], s27 offen  lds
  s_add_u32 s27, s27, 16384
  s_add_u32 m0, s25, 9216
  s_nop 0
  buffer_load_dwordx4 v21, s[60:63], s27 offen  lds
  s_add_u32 s27, s27, 16384
  s_add_u32 m0, s25, 10240
  s_nop 0
  buffer_load_dwordx4 v20, s[60:63], s27 offen  lds
  s_add_u32 s27, s27, 16384
  s_add_u32 m0, s25, 11264
  s_nop 0
  buffer_load_dwordx4 v21, s[60:63], s27 offen  lds
  s_add_u32 s27, s27, 16384
  s_add_u32 m0, s25, 12288
  s_nop 0
  buffer_load_dwordx4 v22, s[60:63], s27 offen  lds
  s_add_u32 s27, s27, 16384
  s_add_u32 m0, s25, 13312
  s_nop 0
  buffer_load_dwordx4 v23, s[60:63], s27 offen  lds
  s_add_u32 s27, s27, 16384
  s_add_u32 m0, s25, 14336
  s_nop 0
  buffer_load_dwordx4 v22, s[60:63], s27 offen  lds
  s_add_u32 s27, s27, 16384
  s_add_u32 m0, s25, 15360
  s_nop 0
  buffer_load_dwordx4 v23, s[60:63], s27 offen  lds
  s_add_u32 s27, s27, 16384
  s_add_u32 s27, s28, 4
  s_min_u32 s27, s27, 13
  s_lshl_b32 s27, s27, 18
  s_add_u32 s27, s27, s26
  s_add_u32 m0, s25, 16384
  s_nop 0
  buffer_load_dwordx4 v16, s[60:63], s27 offen  lds
  s_add_u32 s27, s27, 16384
  s_add_u32 m0, s25, 17408
  s_nop 0
  buffer_load_dwordx4 v17, s[60:63], s27 offen  lds
  s_add_u32 s27, s27, 16384
  s_add_u32 m0, s25, 18432
  s_nop 0
  buffer_load_dwordx4 v16, s[60:63], s27 offen  lds
  s_add_u32 s27, s27, 16384
  s_add_u32 m0, s25, 19456
  s_nop 0
  buffer_load_dwordx4 v17, s[60:63], s27 offen  lds
  s_add_u32 s27, s27, 16384
  s_add_u32 m0, s25, 20480
  s_nop 0
  buffer_load_dwordx4 v18, s[60:63], s27 offen  lds
  s_add_u32 s27, s27, 16384
  s_add_u32 m0, s25, 21504
  s_nop 0
  buffer_load_dwordx4 v19, s[60:63], s27 offen  lds
  s_add_u32 s27, s27, 16384
  s_add_u32 m0, s25, 22528
  s_nop 0
  buffer_load_dwordx4 v18, s[60:63], s27 offen  lds
  s_add_u32 s27, s27, 16384
  s_add_u32 m0, s25, 23552
  s_nop 0
  buffer_load_dwordx4 v19, s[60:63], s27 offen  lds
  s_add_u32 s27, s27, 16384
  s_add_u32 m0, s25, 24576
  s_nop 0
  buffer_load_dwordx4 v20, s[60:63], s27 offen  lds
  s_add_u32 s27, s27, 16384
  s_add_u32 m0, s25, 25600
  s_nop 0
  buffer_load_dwordx4 v21, s[60:63], s27 offen  lds
  s_add_u32 s27, s27, 16384
  s_add_u32 m0, s25, 26624
  s_nop 0
  buffer_load_dwordx4 v20, s[60:63], s27 offen  lds
  s_add_u32 s27, s27, 16384
  s_add_u32 m0, s25, 27648
  s_nop 0
  buffer_load_dwordx4 v21, s[60:63], s27 offen  lds
  s_add_u32 s27, s27, 16384
  s_add_u32 m0, s25, 28672
  s_nop 0
  buffer_load_dwordx4 v22, s[60:63], s27 offen  lds
  s_add_u32 s27, s27, 16384
  s_add_u32 m0, s25, 29696
  s_nop 0
  buffer_load_dwordx4 v23, s[60:63], s27 offen  lds
  s_add_u32 s27, s27, 16384
  s_add_u32 m0, s25, 30720
  s_nop 0
  buffer_load_dwordx4 v22, s[60:63], s27 offen  lds
  s_add_u32 s27, s27, 16384
  s_add_u32 m0, s25, 31744
  s_nop 0
  buffer_load_dwordx4 v23, s[60:63], s27 offen  lds
  s_add_u32 s27, s27, 16384
  v_lshrrev_b32 v7, 2, v4
  v_lshlrev_b32 v11, 4, v7
  v_lshlrev_b32 v7, 3, v7
  v_and_b32 v8, 3, v4
  v_add_u32 v7, v7, v8
  v_and_b32 v8, 2, v4
  v_lshl_add_u32 v11, v8, 1, v11
  v_and_b32 v8, 1, v4
  v_add_u32 v11, v11, v8
  v_or_b32 v10, 0, v3
  v_xor_b32 v10, v10, v4
  v_lshlrev_b32 v10, 4, v10
  v_lshl_add_u32 v44, v11, 9, v10
  v_lshl_add_u32 v10, v7, 9, v10
  v_add_u32 v32, s25, v10
  v_or_b32 v10, 4, v3
  v_xor_b32 v10, v10, v4
  v_lshlrev_b32 v10, 4, v10
  v_lshl_add_u32 v45, v11, 9, v10
  v_lshl_add_u32 v10, v7, 9, v10
  v_add_u32 v33, s25, v10
  v_or_b32 v10, 8, v3
  v_xor_b32 v10, v10, v4
  v_lshlrev_b32 v10, 4, v10
  v_lshl_add_u32 v46, v11, 9, v10
  v_lshl_add_u32 v10, v7, 9, v10
  v_add_u32 v34, s25, v10
  v_or_b32 v10, 12, v3
  v_xor_b32 v10, v10, v4
  v_lshlrev_b32 v10, 4, v10
  v_lshl_add_u32 v47, v11, 9, v10
  v_lshl_add_u32 v10, v7, 9, v10
  v_add_u32 v35, s25, v10
  s_mul_i32 s30, s17, 401408
  s_mul_i32 s31, s18, 57344
  s_add_u32 s30, s30, s31
  s_add_u32 s30, s30, 33554432
  v_add_u32 v28, s30, v2
  s_add_u32 s30, s30, 14336
  v_add_u32 v29, s30, v2
  s_add_u32 s30, s30, 14336
  v_add_u32 v30, s30, v2
  s_add_u32 s30, s30, 14336
  v_add_u32 v31, s30, v2
  s_add_u32 s30, s30, 14336
  v_mov_b32 v48, 1035512379
wp_A:
  s_lshl_b32 s29, s28, 10
  s_add_u32 s31, s29, 4096
  s_cmp_lt_u32 s28, 10
  s_cselect_b32 s31, s31, 0x40000000
  s_waitcnt vmcnt(0)
  s_barrier
  ds_read_b128 a[0:3], v44 offset:0
  ds_read_b128 a[32:35], v44 offset:1024
  ds_read_b128 a[64:67], v44 offset:4096
  ds_read_b128 a[96:99], v44 offset:5120
  ds_read_b128 a[128:131], v32 offset:0
  ds_read_b128 a[160:163], v32 offset:2048
  ds_read_b128 a[192:195], v32 offset:16384
  ds_read_b128 a[224:227], v32 offset:18432
  s_waitcnt lgkmcnt(0)
  v_mfma_f32_16x16x32_bf16 v[64:67], a[128:131], a[0:3], 0
  ds_read_b128 a[4:7], v45 offset:0
  ds_read_b128 a[36:39], v45 offset:1024
  v_mfma_f32_16x16x32_bf16 v[68:71], a[160:163], a[0:3], 0
  ds_read_b128 a[68:71], v45 offset:4096
  ds_read_b128 a[100:103], v45 offset:5120
  v_mfma_f32_16x16x32_bf16 v[72:75], a[128:131], a[32:35], 0
  ds_read_b128 a[132:135], v33 offset:0
  ds_read_b128 a[164:167], v33 offset:2048
  v_mfma_f32_16x16x32_bf16 v[76:79], a[160:163], a[32:35], 0
  ds_read_b128 a[196:199], v33 offset:16384
  ds_read_b128 a[228:231], v33 offset:18432
  v_mfma_f32_16x16x32_bf16 v[80:83], a[128:131], a[64:67], 0
  v_mfma_f32_16x16x32_bf16 v[84:87], a[160:163], a[64:67], 0
  v_mfma_f32_16x16x32_bf16 v[88:91], a[128:131], a[96:99], 0
  v_mfma_f32_16x16x32_bf16 v[92:95], a[160:163], a[96:99], 0
  v_mfma_f32_16x16x32_bf16 v[96:99], a[192:195], a[0:3], 0
  v_mfma_f32_16x16x32_bf16 v[100:103], a[224:227], a[0:3], 0
  v_mfma_f32_16x16x32_bf16 v[104:107], a[192:195], a[32:35], 0
  v_mfma_f32_16x16x32_bf16 v[108:111], a[224:227], a[32:35], 0
  v_mfma_f32_16x16x32_bf16 v[112:115], a[192:195], a[64:67], 0
  v_mfma_f32_16x16x32_bf16 v[116:119], a[224:227], a[64:67], 0
  v_mfma_f32_16x16x32_bf16 v[120:123], a[192:195], a[96:99], 0
  v_mfma_f32_16x16x32_bf16 v[124:127], a[224:227], a[96:99], 0
  s_waitcnt lgkmcnt(0)
  v_mfma_f32_16x16x32_bf16 v[64:67], a[132:135], a[4:7], v[64:67]
  ds_read_b128 a[8:11], v46 offset:0
  ds_read_b128 a[40:43], v46 offset:1024
  v_mfma_f32_16x16x32_bf16 v[68:71], a[164:167], a[4:7], v[68:71]
  ds_read_b128 a[72:75], v46 offset:4096
  ds_read_b128 a[104:107], v46 offset:5120
  v_mfma_f32_16x16x32_bf16 v[72:75], a[132:135], a[36:39], v[72:75]
  ds_read_b128 a[136:139], v34 offset:0
  ds_read_b128 a[168:171], v34 offset:2048
  v_mfma_f32_16x16x32_bf16 v[76:79], a[164:167], a[36:39], v[76:79]
  ds_read_b128 a[200:203], v34 offset:16384
  ds_read_b128 a[232:235], v34 offset:18432
  v_mfma_f32_16x16x32_bf16 v[80:83], a[132:135], a[68:71], v[80:83]
  v_mfma_f32_16x16x32_bf16 v[84:87], a[164:167], a[68:71], v[84:87]
  v_mfma_f32_16x16x32_bf16 v[88:91], a[132:135], a[100:103], v[88:91]
  v_mfma_f32_16x16x32_bf16 v[92:95], a[164:167], a[100:103], v[92:95]
  v_mfma_f32_16x16x32_bf16 v[96:99], a[196:199], a[4:7], v[96:99]
  v_mfma_f32_16x16x32_bf16 v[100:103], a[228:231], a[4:7], v[100:103]
  v_mfma_f32_16x16x32_bf16 v[104:107], a[196:199], a[36:39], v[104:107]
  v_mfma_f32_16x16x32_bf16 v[108:111], a[228:231], a[36:39], v[108:111]
  v_mfma_f32_16x16x32_bf16 v[112:115], a[196:199], a[68:71], v[112:115]
  v_mfma_f32_16x16x32_bf16 v[116:119], a[228:231], a[68:71], v[116:119]
  v_mfma_f32_16x16x32_bf16 v[120:123], a[196:199], a[100:103], v[120:123]
  v_mfma_f32_16x16x32_bf16 v[124:127], a[228:231], a[100:103], v[124:127]
  s_waitcnt lgkmcnt(0)
  v_mfma_f32_16x16x32_bf16 v[64:67], a[136:139], a[8:11], v[64:67]
  ds_read_b128 a[12:15], v47 offset:0
  ds_read_b128 a[44:47], v47 offset:1024
  v_mfma_f32_16x16x32_bf16 v[68:71], a[168:171], a[8:11], v[68:71]
  ds_read_b128 a[76:79], v47 offset:4096
  ds_read_b128 a[108:111], v47 offset:5120
  v_mfma_f32_16x16x32_bf16 v[72:75], a[136:139], a[40:43], v[72:75]
  ds_read_b128 a[140:143], v35 offset:0
  ds_read_b128 a[172:175], v35 offset:2048
  v_mfma_f32_16x16x32_bf16 v[76:79], a[168:171], a[40:43], v[76:79]
  ds_read_b128 a[204:207], v35 offset:16384
  ds_read_b128 a[236:239], v35 offset:18432
  v_mfma_f32_16x16x32_bf16 v[80:83], a[136:139], a[72:75], v[80:83]
  v_mfma_f32_16x16x32_bf16 v[84:87], a[168:171], a[72:75], v[84:87]
  v_mfma_f32_16x16x32_bf16 v[88:91], a[136:139], a[104:107], v[88:91]
  v_mfma_f32_16x16x32_bf16 v[92:95], a[168:171], a[104:107], v[92:95]
  v_mfma_f32_16x16x32_bf16 v[96:99], a[200:203], a[8:11], v[96:99]
  v_mfma_f32_16x16x32_bf16 v[100:103], a[232:235], a[8:11], v[100:103]
  v_mfma_f32_16x16x32_bf16 v[104:107], a[200:203], a[40:43], v[104:107]
  v_mfma_f32_16x16x32_bf16 v[108:111], a[232:235], a[40:43], v[108:111]
  v_mfma_f32_16x16x32_bf16 v[112:115], a[200:203], a[72:75], v[112:115]
  v_mfma_f32_16x16x32_bf16 v[116:119], a[232:235], a[72:75], v[116:119]
  v_mfma_f32_16x16x32_bf16 v[120:123], a[200:203], a[104:107], v[120:123]
  v_mfma_f32_16x16x32_bf16 v[124:127], a[232:235], a[104:107], v[124:127]
  s_waitcnt lgkmcnt(0)
  v_mfma_f32_16x16x32_bf16 v[64:67], a[140:143], a[12:15], v[64:67]
  ds_read_b128 a[16:19], v44 offset:256
  ds_read_b128 a[48:51], v44 offset:1280
  v_mfma_f32_16x16x32_bf16 v[68:71], a[172:175], a[12:15], v[68:71]
  ds_read_b128 a[80:83], v44 offset:4352
  ds_read_b128 a[112:115], v44 offset:5376
  v_mfma_f32_16x16x32_bf16 v[72:75], a[140:143], a[44:47], v[72:75]
  ds_read_b128 a[144:147], v32 offset:256
  ds_read_b128 a[176:179], v32 offset:2304
  v_mfma_f32_16x16x32_bf16 v[76:79], a[172:175], a[44:47], v[76:79]
  ds_read_b128 a[208:211], v32 offset:16640
  ds_read_b128 a[240:243], v32 offset:18688
  v_mfma_f32_16x16x32_bf16 v[80:83], a[140:143], a[76:79], v[80:83]
  v_mfma_f32_16x16x32_bf16 v[84:87], a[172:175], a[76:79], v[84:87]
  v_mfma_f32_16x16x32_bf16 v[88:91], a[140:143], a[108:111], v[88:91]
  v_mfma_f32_16x16x32_bf16 v[92:95], a[172:175], a[108:111], v[92:95]
  v_mfma_f32_16x16x32_bf16 v[96:99], a[204:207], a[12:15], v[96:99]
  v_mfma_f32_16x16x32_bf16 v[100:103], a[236:239], a[12:15], v[100:103]
  v_mfma_f32_16x16x32_bf16 v[104:107], a[204:207], a[44:47], v[104:107]
  v_mfma_f32_16x16x32_bf16 v[108:111], a[236:239], a[44:47], v[108:111]
  v_mfma_f32_16x16x32_bf16 v[112:115], a[204:207], a[76:79], v[112:115]
  v_mfma_f32_16x16x32_bf16 v[116:119], a[236:239], a[76:79], v[116:119]
  v_mfma_f32_16x16x32_bf16 v[120:123], a[204:207], a[108:111], v[120:123]
  v_mfma_f32_16x16x32_bf16 v[124:127], a[236:239], a[108:111], v[124:127]
  s_waitcnt lgkmcnt(0)
  v_mfma_f32_16x16x32_bf16 v[64:67], a[144:147], a[16:19], v[64:67]
  ds_read_b128 a[20:23], v45 offset:256
  ds_read_b128 a[52:55], v45 offset:1280
  v_mfma_f32_16x16x32_bf16 v[68:71], a[176:179], a[16:19], v[68:71]
  ds_read_b128 a[84:87], v45 offset:4352
  ds_read_b128 a[116:119], v45 offset:5376
  v_mfma_f32_16x16x32_bf16 v[72:75], a[144:147], a[48:51], v[72:75]
  ds_read_b128 a[148:151], v33 offset:256
  ds_read_b128 a[180:183], v33 offset:2304
  v_mfma_f32_16x16x32_bf16 v[76:79], a[176:179], a[48:51], v[76:79]
  ds_read_b128 a[212:215], v33 offset:16640
  ds_read_b128 a[244:247], v33 offset:18688
  v_mfma_f32_16x16x32_bf16 v[80:83], a[144:147], a[80:83], v[80:83]
  v_mfma_f32_16x16x32_bf16 v[84:87], a[176:179], a[80:83], v[84:87]
  v_mfma_f32_16x16x32_bf16 v[88:91], a[144:147], a[112:115], v[88:91]
  v_mfma_f32_16x16x32_bf16 v[92:95], a[176:179], a[112:115], v[92:95]
  v_mfma_f32_16x16x32_bf16 v[96:99], a[208:211], a[16:19], v[96:99]
  v_mfma_f32_16x16x32_bf16 v[100:103], a[240:243], a[16:19], v[100:103]
  v_mfma_f32_16x16x32_bf16 v[104:107], a[208:211], a[48:51], v[104:107]
  v_mfma_f32_16x16x32_bf16 v[108:111], a[240:243], a[48:51], v[108:111]
  v_mfma_f32_16x16x32_bf16 v[112:115], a[208:211], a[80:83], v[112:115]
  v_mfma_f32_16x16x32_bf16 v[116:119], a[240:243], a[80:83], v[116:119]
  v_mfma_f32_16x16x32_bf16 v[120:123], a[208:211], a[112:115], v[120:123]
  v_mfma_f32_16x16x32_bf16 v[124:127], a[240:243], a[112:115], v[124:127]
  s_waitcnt lgkmcnt(0)
  v_mfma_f32_16x16x32_bf16 v[64:67], a[148:151], a[20:23], v[64:67]
  ds_read_b128 a[24:27], v46 offset:256
  ds_read_b128 a[56:59], v46 offset:1280
  v_mfma_f32_16x16x32_bf16 v[68:71], a[180:183], a[20:23], v[68:71]
  ds_read_b128 a[88:91], v46 offset:4352
  ds_read_b128 a[120:123], v46 offset:5376
  v_mfma_f32_16x16x32_bf16 v[72:75], a[148:151], a[52:55], v[72:75]
  ds_read_b128 a[152:155], v34 offset:256
  ds_read_b128 a[184:187], v34 offset:2304
  v_mfma_f32_16x16x32_bf16 v[76:79], a[180:183], a[52:55], v[76:79]
  ds_read_b128 a[216:219], v34 offset:16640
  ds_read_b128 a[248:251], v34 offset:18688
  v_mfma_f32_16x16x32_bf16 v[80:83], a[148:151], a[84:87], v[80:83]
  v_mfma_f32_16x16x32_bf16 v[84:87], a[180:183], a[84:87], v[84:87]
  v_mfma_f32_16x16x32_bf16 v[88:91], a[148:151], a[116:119], v[88:91]
  v_mfma_f32_16x16x32_bf16 v[92:95], a[180:183], a[116:119], v[92:95]
  v_mfma_f32_16x16x32_bf16 v[96:99], a[212:215], a[20:23], v[96:99]
  v_mfma_f32_16x16x32_bf16 v[100:103], a[244:247], a[20:23], v[100:103]
  v_mfma_f32_16x16x32_bf16 v[104:107], a[212:215], a[52:55], v[104:107]
  v_mfma_f32_16x16x32_bf16 v[108:111], a[244:247], a[52:55], v[108:111]
  v_mfma_f32_16x16x32_bf16 v[112:115], a[212:215], a[84:87], v[112:115]
  v_mfma_f32_16x16x32_bf16 v[116:119], a[244:247], a[84:87], v[116:119]
  v_mfma_f32_16x16x32_bf16 v[120:123], a[212:215], a[116:119], v[120:123]
  v_mfma_f32_16x16x32_bf16 v[124:127], a[244:247], a[116:119], v[124:127]
  s_waitcnt lgkmcnt(0)
  v_mfma_f32_16x16x32_bf16 v[64:67], a[152:155], a[24:27], v[64:67]
  ds_read_b128 a[28:31], v47 offset:256
  ds_read_b128 a[60:63], v47 offset:1280
  v_mfma_f32_16x16x32_bf16 v[68:71], a[184:187], a[24:27], v[68:71]
  ds_read_b128 a[92:95], v47 offset:4352
  ds_read_b128 a[124:127], v47 offset:5376
  v_mfma_f32_16x16x32_bf16 v[72:75], a[152:155], a[56:59], v[72:75]
  ds_read_b128 a[156:159], v35 offset:256
  ds_read_b128 a[188:191], v35 offset:2304
  v_mfma_f32_16x16x32_bf16 v[76:79], a[184:187], a[56:59], v[76:79]
  ds_read_b128 a[220:223], v35 offset:16640
  ds_read_b128 a[252:255], v35 offset:18688
  v_mfma_f32_16x16x32_bf16 v[80:83], a[152:155], a[88:91], v[80:83]
  v_mfma_f32_16x16x32_bf16 v[84:87], a[184:187], a[88:91], v[84:87]
  v_mfma_f32_16x16x32_bf16 v[88:91], a[152:155], a[120:123], v[88:91]
  v_mfma_f32_16x16x32_bf16 v[92:95], a[184:187], a[120:123], v[92:95]
  v_mfma_f32_16x16x32_bf16 v[96:99], a[216:219], a[24:27], v[96:99]
  v_mfma_f32_16x16x32_bf16 v[100:103], a[248:251], a[24:27], v[100:103]
  v_mfma_f32_16x16x32_bf16 v[104:107], a[216:219], a[56:59], v[104:107]
  v_mfma_f32_16x16x32_bf16 v[108:111], a[248:251], a[56:59], v[108:111]
  v_mfma_f32_16x16x32_bf16 v[112:115], a[216:219], a[88:91], v[112:115]
  v_mfma_f32_16x16x32_bf16 v[116:119], a[248:251], a[88:91], v[116:119]
  v_mfma_f32_16x16x32_bf16 v[120:123], a[216:219], a[120:123], v[120:123]
  v_mfma_f32_16x16x32_bf16 v[124:127], a[248:251], a[120:123], v[124:127]
  s_waitcnt lgkmcnt(0)
  s_barrier
  buffer_load_dwordx2 v[254:255], v252, s[12:15], 0 offen offset:128 sc1
  buffer_load_dword v253, v252, s[12:15], 0 offen sc1
  v_mfma_f32_16x16x32_bf16 v[64:67], a[156:159], a[28:31], v[64:67]
  v_mfma_f32_16x16x32_bf16 v[68:71], a[188:191], a[28:31], v[68:71]
  v_mfma_f32_16x16x32_bf16 v[72:75], a[156:159], a[60:63], v[72:75]
  v_mfma_f32_16x16x32_bf16 v[76:79], a[188:191], a[60:63], v[76:79]
  v_mfma_f32_16x16x32_bf16 v[80:83], a[156:159], a[92:95], v[80:83]
  v_pk_mul_f32 v[64:65], v[64:65], v[48:49] op_sel_hi:[1,0]
  v_pk_mul_f32 v[66:67], v[66:67], v[48:49] op_sel_hi:[1,0]
  v_mfma_f32_16x16x32_bf16 v[84:87], a[188:191], a[92:95], v[84:87]
  v_pk_mul_f32 v[68:69], v[68:69], v[48:49] op_sel_hi:[1,0]
  v_pk_mul_f32 v[70:71], v[70:71], v[48:49] op_sel_hi:[1,0]
  v_mfma_f32_16x16x32_bf16 v[88:91], a[156:159], a[124:127], v[88:91]
  v_cvt_pk_bf16_f32 v64, v64, v65
  v_cvt_pk_bf16_f32 v65, v66, v67
  v_mfma_f32_16x16x32_bf16 v[92:95], a[188:191], a[124:127], v[92:95]
  v_cvt_pk_bf16_f32 v66, v68, v69
  v_cvt_pk_bf16_f32 v67, v70, v71
  v_mfma_f32_16x16x32_bf16 v[96:99], a[220:223], a[28:31], v[96:99]
  buffer_store_dwordx4 v[64:67], v28, s[8:11], s29 offen sc1
  v_pk_mul_f32 v[72:73], v[72:73], v[48:49] op_sel_hi:[1,0]
  v_mfma_f32_16x16x32_bf16 v[100:103], a[252:255], a[28:31], v[100:103]
  v_pk_mul_f32 v[74:75], v[74:75], v[48:49] op_sel_hi:[1,0]
  v_pk_mul_f32 v[76:77], v[76:77], v[48:49] op_sel_hi:[1,0]
  v_mfma_f32_16x16x32_bf16 v[104:107], a[220:223], a[60:63], v[104:107]
  v_pk_mul_f32 v[78:79], v[78:79], v[48:49] op_sel_hi:[1,0]
  v_cvt_pk_bf16_f32 v72, v72, v73
  v_mfma_f32_16x16x32_bf16 v[108:111], a[252:255], a[60:63], v[108:111]
  v_cvt_pk_bf16_f32 v73, v74, v75
  v_cvt_pk_bf16_f32 v74, v76, v77
  v_mfma_f32_16x16x32_bf16 v[112:115], a[220:223], a[92:95], v[112:115]
  v_cvt_pk_bf16_f32 v75, v78, v79
  buffer_store_dwordx4 v[72:75], v29, s[8:11], s29 offen sc1
  v_mfma_f32_16x16x32_bf16 v[116:119], a[252:255], a[92:95], v[116:119]
  v_pk_mul_f32 v[80:81], v[80:81], v[48:49] op_sel_hi:[1,0]
  v_pk_mul_f32 v[82:83], v[82:83], v[48:49] op_sel_hi:[1,0]
  v_mfma_f32_16x16x32_bf16 v[120:123], a[220:223], a[124:127], v[120:123]
  v_pk_mul_f32 v[84:85], v[84:85], v[48:49] op_sel_hi:[1,0]
  v_pk_mul_f32 v[86:87], v[86:87], v[48:49] op_sel_hi:[1,0]
  v_mfma_f32_16x16x32_bf16 v[124:127], a[252:255], a[124:127], v[124:127]
  v_cvt_pk_bf16_f32 v80, v80, v81
  v_cvt_pk_bf16_f32 v81, v82, v83
  v_cvt_pk_bf16_f32 v82, v84, v85
  v_cvt_pk_bf16_f32 v83, v86, v87
  buffer_store_dwordx4 v[80:83], v30, s[8:11], s29 offen sc1
  v_pk_mul_f32 v[88:89], v[88:89], v[48:49] op_sel_hi:[1,0]
  v_pk_mul_f32 v[90:91], v[90:91], v[48:49] op_sel_hi:[1,0]
  v_pk_mul_f32 v[92:93], v[92:93], v[48:49] op_sel_hi:[1,0]
  v_pk_mul_f32 v[94:95], v[94:95], v[48:49] op_sel_hi:[1,0]
  v_cvt_pk_bf16_f32 v88, v88, v89
  v_cvt_pk_bf16_f32 v89, v90, v91
  v_cvt_pk_bf16_f32 v90, v92, v93
  v_cvt_pk_bf16_f32 v91, v94, v95
  buffer_store_dwordx4 v[88:91], v31, s[8:11], s29 offen sc1
  v_pk_mul_f32 v[96:97], v[96:97], v[48:49] op_sel_hi:[1,0]
  v_pk_mul_f32 v[98:99], v[98:99], v[48:49] op_sel_hi:[1,0]
  v_pk_mul_f32 v[100:101], v[100:101], v[48:49] op_sel_hi:[1,0]
  v_pk_mul_f32 v[102:103], v[102:103], v[48:49] op_sel_hi:[1,0]
  v_cvt_pk_bf16_f32 v96, v96, v97
  v_cvt_pk_bf16_f32 v97, v98, v99
  v_cvt_pk_bf16_f32 v98, v100, v101
  v_cvt_pk_bf16_f32 v99, v102, v103
  buffer_store_dwordx4 v[96:99], v28, s[8:11], s31 offen sc1
  v_pk_mul_f32 v[104:105], v[104:105], v[48:49] op_sel_hi:[1,0]
  v_pk_mul_f32 v[106:107], v[106:107], v[48:49] op_sel_hi:[1,0]
  v_pk_mul_f32 v[108:109], v[108:109], v[48:49] op_sel_hi:[1,0]
  v_pk_mul_f32 v[110:111], v[110:111], v[48:49] op_sel_hi:[1,0]
  v_cvt_pk_bf16_f32 v104, v104, v105
  v_cvt_pk_bf16_f32 v105, v106, v107
  v_cvt_pk_bf16_f32 v106, v108, v109
  v_cvt_pk_bf16_f32 v107, v110, v111
  buffer_store_dwordx4 v[104:107], v29, s[8:11], s31 offen sc1
  v_pk_mul_f32 v[112:113], v[112:113], v[48:49] op_sel_hi:[1,0]
  v_pk_mul_f32 v[114:115], v[114:115], v[48:49] op_sel_hi:[1,0]
  v_pk_mul_f32 v[116:117], v[116:117], v[48:49] op_sel_hi:[1,0]
  v_pk_mul_f32 v[118:119], v[118:119], v[48:49] op_sel_hi:[1,0]
  v_cvt_pk_bf16_f32 v112, v112, v113
  v_cvt_pk_bf16_f32 v113, v114, v115
  v_cvt_pk_bf16_f32 v114, v116, v117
  v_cvt_pk_bf16_f32 v115, v118, v119
  buffer_store_dwordx4 v[112:115], v30, s[8:11], s31 offen sc1
  v_pk_mul_f32 v[120:121], v[120:121], v[48:49] op_sel_hi:[1,0]
  v_pk_mul_f32 v[122:123], v[122:123], v[48:49] op_sel_hi:[1,0]
  v_pk_mul_f32 v[124:125], v[124:125], v[48:49] op_sel_hi:[1,0]
  v_pk_mul_f32 v[126:127], v[126:127], v[48:49] op_sel_hi:[1,0]
  v_cvt_pk_bf16_f32 v120, v120, v121
  v_cvt_pk_bf16_f32 v121, v122, v123
  v_cvt_pk_bf16_f32 v122, v124, v125
  v_cvt_pk_bf16_f32 v123, v126, v127
  buffer_store_dwordx4 v[120:123], v31, s[8:11], s31 offen sc1
  s_waitcnt vmcnt(0)
  s_barrier
  s_cmp_lg_u32 s16, 0
  s_cbranch_scc1 wp_f3_f
  v_readfirstlane_b32 s20, v254
  s_cmp_eq_u32 s20, 1
  s_cbranch_scc1 wp_f3_w_ok
  s_mov_b32 s30, 0
wp_f3_w:
  buffer_load_dword v254, off, s[12:15], 0 offset:128 sc1
  s_waitcnt vmcnt(0)
  v_cmp_ne_u32 vcc, 1, v254
  s_cbranch_vccz wp_f3_w_ok
  s_sleep 8
  s_add_u32 s30, s30, 1
  s_cmp_lt_u32 s30, 16
  s_cbranch_scc1 wp_f3_w
  s_branch wp_f3_f
wp_f3_w_ok:
  s_lshl_b32 s20, s17, 7
  s_add_u32 s20, s20, 584192
  s_lshl_b32 s21, 1, s19
  v_mov_b32 v248, s21
  s_mov_b64 exec, 1
  buffer_atomic_or v248, v252, s[8:11], s20 offen sc0
  s_mov_b64 exec, -1
  s_mov_b32 s38, s21
wp_f3_f:
  s_cmp_eq_u32 s97, 3
  s_cbranch_scc1 wk_adone
wp_fin:
  s_cmp_lg_u32 s97, 0
  s_cbranch_scc1 wp_all
  v_readfirstlane_b32 s20, v254
  v_readfirstlane_b32 s21, v253
  s_and_b32 s21, s21, 0xffe0
  s_cselect_b32 s96, s20, 0
  s_cmp_eq_u32 s96, 0
  s_cbranch_scc1 wp_all
  v_mov_b32 v250, 1
  s_mov_b32 s20, 588288
  s_mov_b64 exec, 1
  buffer_atomic_add v250, v252, s[8:11], s20 offen sc0
  s_mov_b64 exec, -1
wp_all:
  v_mov_b32 v252, 0x40000000
  v_cmp_eq_u32 vcc, 0, v0
  s_nop 1
  v_cndmask_b32 v252, v252, v0, vcc
  s_mov_b32 s34, 0
  s_cmp_lg_u32 s16, 0
  s_cbranch_scc1 wp_w2
  s_getreg_b32 s24, hwreg(HW_REG_XCC_ID)
  s_sub_u32 s24, s24, 3
  s_and_b32 s24, s24, 7
  s_lshl_b32 s24, s24, 7
  s_add_u32 s24, s24, 586240
  s_cmp_lg_u32 s96, 0
  s_cbranch_scc1 wp_v0
  s_waitcnt vmcnt(0)
wp_v0:
  s_cmp_eq_u32 s97, 0
  s_cbranch_scc1 wp_v1
  s_waitcnt vmcnt(0)
wp_v1:
  s_waitcnt vmcnt(1)
  v_readfirstlane_b32 s20, v248
  s_and_b32 s20, s20, 14448
  s_xor_b32 s20, s20, s38
  s_cmp_lg_u32 s20, 14448
  s_cselect_b32 s20, 0, s38
  s_mov_b32 s38, 0
  s_cmp_eq_u32 s20, 0
  s_cbranch_scc1 wp_g3
  s_lshl_b32 s21, 65536, s17
  v_mov_b32 v248, s21
  s_mov_b32 s20, 586240
  v_lshlrev_b32 v247, 7, v0
  s_mov_b64 exec, 0xff
  buffer_atomic_or v248, v247, s[8:11], s20 offen
  s_mov_b64 exec, -1
wp_g3:
  v_readfirstlane_b32 s20, v248
  s_and_b32 s20, s20, 16383
  s_xor_b32 s20, s20, s37
  s_cmp_lg_u32 s20, 16383
  s_cselect_b32 s20, 0, s37
  s_mov_b32 s37, 0
  s_cmp_eq_u32 s20, 0
  s_cbranch_scc1 wp_g2
  s_lshl_b32 s21, 1, s17
  v_mov_b32 v248, s21
  s_mov_b32 s20, 586240
  v_lshlrev_b32 v247, 7, v0
  s_mov_b64 exec, 0xff
  buffer_atomic_or v248, v247, s[8:11], s20 offen
  s_mov_b64 exec, -1
wp_g2:
  s_cmp_lg_u32 s96, 0
  s_cbranch_scc1 wp_v_ok
  s_mov_b32 s30, 0
wp_v:
  buffer_load_dwordx2 v[64:65], off, s[12:15], 0 sc1
  buffer_load_dword v66, off, s[12:15], 0 offset:128 sc1
  s_waitcnt vmcnt(0)
  v_and_b32 v68, 0xffe0, v64
  v_min_u32 v68, v68, v66
  v_cmp_ne_u32 vcc, 1, v68
  s_cbranch_vccz wp_v_ok
  s_sleep 16
  s_add_u32 s30, s30, 1
  s_cmp_lt_u32 s30, 30
  s_cbranch_scc1 wp_v
  s_branch wp_w1
wp_v_ok:
  v_mov_b32 v64, 32
  s_cmp_eq_u32 s97, 2
  s_cselect_b32 s31, 1, 60
  s_cmp_eq_u32 s39, -1
  s_cselect_b32 s20, 4, 0
  s_add_u32 s24, s24, s20
  s_mov_b32 s30, 0
wp_w:
  buffer_load_dword v66, off, s[8:11], s24 sc1
  buffer_load_dword v67, off, s[8:11], s24 offset:4 sc1
  s_waitcnt vmcnt(0)
  v_or_b32 v66, s39, v66
  v_add_u32 v66, v66, v67
  v_cmp_ne_u32 vcc, 0, v66
  s_cbranch_vccz wp_w_ok
  s_sleep 8
  s_add_u32 s30, s30, 1
  s_cmp_lt_u32 s30, s31
  s_cbranch_scc1 wp_w
  s_branch wp_w1
wp_w_ok:
  s_branch wp_w2
wp_w1:
  v_readfirstlane_b32 s20, v64
  v_readfirstlane_b32 s21, v65
  s_and_b32 s20, s20, 0xffff
  s_cmp_lt_u32 s20, 32
  s_cselect_b32 s34, 2, 1
  s_add_u32 s32, s32, 1
  s_cmp_lt_u32 s32, 4000
  s_cselect_b32 s34, s34, 3
wp_w2:
  v_mov_b32 v6, 160032
  v_mov_b32 v7, s34
  s_barrier
  s_cmp_lg_u32 s16, 0
  s_cbranch_scc1 uni_7
  ds_write_b32 v6, v7
  s_waitcnt lgkmcnt(0)
uni_7:
  s_barrier
  ds_read_b32 v7, v6
  s_waitcnt lgkmcnt(0)
  v_readfirstlane_b32 s34, v7
  s_cmp_lg_u32 s34, 0
  s_cbranch_scc1 wp_bad
  s_cmp_lg_u32 s39, -1
  s_cbranch_scc1 wp_done
  s_mov_b32 s101, 0
  s_lshl_b32 s20, s101, 4
  s_lshr_b32 s21, s2, 3
  s_add_u32 s21, s21, s16
  s_and_b32 s21, s21, 3
  s_lshl_b32 s21, s21, 2
  s_add_u32 s20, s20, s21
  s_mul_i32 s21, s20, 14336
  s_add_u32 s21, s21, 655360
  s_add_u32 s22, s21, 0
  buffer_load_dwordx4 a[0:3], v2, s[8:11], s22 offen offset:0 sc1
  buffer_load_dwordx4 a[4:7], v2, s[8:11], s22 offen offset:1024 sc1
  buffer_load_dwordx4 a[8:11], v2, s[8:11], s22 offen offset:2048 sc1
  buffer_load_dwordx4 a[12:15], v2, s[8:11], s22 offen offset:3072 sc1
  s_add_u32 s22, s21, 4096
  buffer_load_dwordx4 a[16:19], v2, s[8:11], s22 offen offset:0 sc1
  buffer_load_dwordx4 a[20:23], v2, s[8:11], s22 offen offset:1024 sc1
  buffer_load_dwordx4 a[24:27], v2, s[8:11], s22 offen offset:2048 sc1
  buffer_load_dwordx4 a[28:31], v2, s[8:11], s22 offen offset:3072 sc1
  s_add_u32 s22, s21, 8192
  buffer_load_dwordx4 a[32:35], v2, s[8:11], s22 offen offset:0 sc1
  buffer_load_dwordx4 a[36:39], v2, s[8:11], s22 offen offset:1024 sc1
  buffer_load_dwordx4 a[40:43], v2, s[8:11], s22 offen offset:2048 sc1
  buffer_load_dwordx4 a[44:47], v2, s[8:11], s22 offen offset:3072 sc1
  s_add_u32 s22, s21, 12288
  buffer_load_dwordx4 a[48:51], v2, s[8:11], s22 offen offset:0 sc1
  buffer_load_dwordx4 a[52:55], v2, s[8:11], s22 offen offset:1024 sc1
  buffer_load_dwordx4 a[56:59], v2, s[8:11], s22 offen offset:2048 sc1
  buffer_load_dwordx4 a[60:63], v2, s[8:11], s22 offen offset:3072 sc1
  s_add_u32 s22, s21, 16384
  buffer_load_dwordx4 a[64:67], v2, s[8:11], s22 offen offset:0 sc1
  buffer_load_dwordx4 a[68:71], v2, s[8:11], s22 offen offset:1024 sc1
  buffer_load_dwordx4 a[72:75], v2, s[8:11], s22 offen offset:2048 sc1
  buffer_load_dwordx4 a[76:79], v2, s[8:11], s22 offen offset:3072 sc1
  s_add_u32 s22, s21, 20480
  buffer_load_dwordx4 a[80:83], v2, s[8:11], s22 offen offset:0 sc1
  buffer_load_dwordx4 a[84:87], v2, s[8:11], s22 offen offset:1024 sc1
  buffer_load_dwordx4 a[88:91], v2, s[8:11], s22 offen offset:2048 sc1
  buffer_load_dwordx4 a[92:95], v2, s[8:11], s22 offen offset:3072 sc1
  s_add_u32 s22, s21, 24576
  buffer_load_dwordx4 a[96:99], v2, s[8:11], s22 offen offset:0 sc1
  buffer_load_dwordx4 a[100:103], v2, s[8:11], s22 offen offset:1024 sc1
  buffer_load_dwordx4 a[104:107], v2, s[8:11], s22 offen offset:2048 sc1
  buffer_load_dwordx4 a[108:111], v2, s[8:11], s22 offen offset:3072 sc1
  s_add_u32 s22, s21, 28672
  buffer_load_dwordx4 a[112:115], v2, s[8:11], s22 offen offset:0 sc1
  buffer_load_dwordx4 a[116:119], v2, s[8:11], s22 offen offset:1024 sc1
  buffer_load_dwordx4 a[120:123], v2, s[8:11], s22 offen offset:2048 sc1
  buffer_load_dwordx4 a[124:127], v2, s[8:11], s22 offen offset:3072 sc1
  s_add_u32 s22, s21, 32768
  buffer_load_dwordx4 a[128:131], v2, s[8:11], s22 offen offset:0 sc1
  buffer_load_dwordx4 a[132:135], v2, s[8:11], s22 offen offset:1024 sc1
  buffer_load_dwordx4 a[136:139], v2, s[8:11], s22 offen offset:2048 sc1
  buffer_load_dwordx4 a[140:143], v2, s[8:11], s22 offen offset:3072 sc1
  s_add_u32 s22, s21, 36864
  buffer_load_dwordx4 a[144:147], v2, s[8:11], s22 offen offset:0 sc1
  buffer_load_dwordx4 a[148:151], v2, s[8:11], s22 offen offset:1024 sc1
  buffer_load_dwordx4 a[152:155], v2, s[8:11], s22 offen offset:2048 sc1
  buffer_load_dwordx4 a[156:159], v2, s[8:11], s22 offen offset:3072 sc1
  s_add_u32 s22, s21, 40960
  s_waitcnt vmcnt(40)
  buffer_load_dwordx4 a[160:163], v2, s[8:11], s22 offen offset:0 sc1
  buffer_load_dwordx4 a[164:167], v2, s[8:11], s22 offen offset:1024 sc1
  buffer_load_dwordx4 a[168:171], v2, s[8:11], s22 offen offset:2048 sc1
  buffer_load_dwordx4 a[172:175], v2, s[8:11], s22 offen offset:3072 sc1
  s_add_u32 s22, s21, 45056
  buffer_load_dwordx4 a[176:179], v2, s[8:11], s22 offen offset:0 sc1
  buffer_load_dwordx4 a[180:183], v2, s[8:11], s22 offen offset:1024 sc1
  buffer_load_dwordx4 a[184:187], v2, s[8:11], s22 offen offset:2048 sc1
  buffer_load_dwordx4 a[188:191], v2, s[8:11], s22 offen offset:3072 sc1
  s_add_u32 s22, s21, 49152
  buffer_load_dwordx4 a[192:195], v2, s[8:11], s22 offen offset:0 sc1
  buffer_load_dwordx4 a[196:199], v2, s[8:11], s22 offen offset:1024 sc1
  buffer_load_dwordx4 a[200:203], v2, s[8:11], s22 offen offset:2048 sc1
  buffer_load_dwordx4 a[204:207], v2, s[8:11], s22 offen offset:3072 sc1
  s_add_u32 s22, s21, 53248
  buffer_load_dwordx4 a[208:211], v2, s[8:11], s22 offen offset:0 sc1
  buffer_load_dwordx4 a[212:215], v2, s[8:11], s22 offen offset:1024 sc1
  buffer_load_dwordx4 a[216:219], v2, s[8:11], s22 offen offset:2048 sc1
  buffer_load_dwordx4 a[220:223], v2, s[8:11], s22 offen offset:3072 sc1
  s_mov_b32 s39, 0xffff0000
  s_branch wp_all
wp_bad:
  s_and_b32 s39, s39, 0xffff0000
  s_mov_b32 s97, 1
  s_cmp_eq_u32 s34, 1
  s_cbranch_scc1 wp_rep
  s_cmp_eq_u32 s34, 3
  s_cbranch_scc1 cA_abort
  s_load_dwordx8 s[40:47], s[0:1], 72
  s_load_dwordx4 s[48:51], s[0:1], 56
  s_waitcnt lgkmcnt(0)
  v_mov_b32 v4, 0x10001
  s_mov_b32 s18, 1
  s_branch ch_take
wp_rep:
  s_mov_b32 s101, -1
  s_load_dwordx8 s[40:47], s[0:1], 72
  s_load_dwordx4 s[48:51], s[0:1], 56
  s_waitcnt vmcnt(0) lgkmcnt(0)
  v_mov_b32 v4, 1
  v_mov_b32 v5, 20
  v_mov_b32 v6, 160000
  s_barrier
  s_cmp_lg_u32 s16, 0
  s_cbranch_scc1 wp_el1
  s_mov_b64 exec, 1
  buffer_atomic_add v4, v5, s[12:15], 0 offen sc0
  s_waitcnt vmcnt(0)
  ds_write_b32 v6, v4
  s_waitcnt lgkmcnt(0)
  s_mov_b64 exec, -1
wp_el1:
  s_barrier
  ds_read_b32 v4, v6
  s_waitcnt lgkmcnt(0)
  v_readfirstlane_b32 s33, v4
  v_and_b32 v1, 63, v0
  v_lshlrev_b32 v2, 4, v1
  v_lshrrev_b32 v3, 4, v1
  v_and_b32 v4, 15, v1
  v_lshrrev_b32 v5, 5, v1
  v_and_b32 v6, 31, v1
  v_xor_b32 v8, v6, v5
  v_lshlrev_b32 v8, 4, v8
  v_lshl_add_u32 v16, v5, 13, v8
  v_xor_b32 v17, 32, v16
  v_xor_b32 v18, 64, v16
  v_xor_b32 v19, 96, v16
  v_xor_b32 v20, 128, v16
  v_xor_b32 v21, 160, v16
  v_xor_b32 v22, 192, v16
  v_xor_b32 v23, 224, v16
  s_lshl_b32 s20, s16, 6
  v_xor_b32 v26, s20, v16
  v_xor_b32 v27, 32, v26
  s_and_b32 s33, s33, 511
  s_and_b32 s20, s33, 255
  s_cmp_ge_u32 s20, 224
  s_cselect_b32 s97, 1, 2
  s_cbranch_scc1 wp_all
  s_mul_i32 s17, s20, 4682
  s_lshr_b32 s17, s17, 16
  s_mul_i32 s23, s17, 14
  s_sub_u32 s19, s20, s23
  s_cmp_lt_u32 s19, 7
  s_cselect_b32 s18, 0, 7
  s_cselect_b32 s28, 0, 8
  s_sub_u32 s18, s19, s18
  s_add_u32 s28, s28, s16
  s_lshl_b32 s25, s16, 15
  s_add_u32 s25, s25, 32768
  s_lshl_b32 s26, s17, 9
  s_lshl_b32 s20, s17, 7
  s_lshr_b32 s21, s33, 8
  s_lshl_b32 s21, s21, 11
  s_add_u32 s20, s20, s21
  s_add_u32 s20, s20, 582144
  buffer_load_dword v5, off, s[8:11], s20 sc1
  s_waitcnt vmcnt(0)
  v_readfirstlane_b32 s34, v5
  v_mov_b32 v6, 160032
  s_nop 0
  v_mov_b32 v7, s34
  s_barrier
  s_cmp_lg_u32 s16, 0
  s_cbranch_scc1 uni_8
  ds_write_b32 v6, v7
  s_waitcnt lgkmcnt(0)
uni_8:
  s_barrier
  ds_read_b32 v7, v6
  s_waitcnt lgkmcnt(0)
  v_readfirstlane_b32 s34, v7
  s_cmp_lt_u32 s33, 256
  s_cselect_b32 s20, 0, 1935
  s_or_b32 s34, s34, s20
  s_bitcmp1_b32 s34, s19
  s_cbranch_scc1 wp_rep
  s_barrier
  s_cmp_lt_u32 s33, 256
  s_cbranch_scc1 wp_B
  s_branch wp_A0
wp_done:
  s_mov_b32 s97, s39
  s_cmp_lg_u32 s96, 0
  s_cbranch_scc1 wk_next
  s_cmp_lg_u32 s16, 0
  s_cbranch_scc1 ask_9
  v_mov_b32 v250, 1
  v_mov_b32 v251, 588288
  s_mov_b64 exec, 1
  buffer_atomic_add v250, v251, s[8:11], 0 offen sc0
  s_mov_b64 exec, -1
ask_9:
  s_branch wk_next
wk_loop:
  s_waitcnt vmcnt(0) lgkmcnt(0)
  s_getreg_b32 s22, hwreg(HW_REG_XCC_ID)
  s_and_b32 s22, s22, 15
  s_bitcmp0_b32 4, s22
  s_cbranch_scc1 wk_ni
  s_cmp_ge_u32 s96, 6
  s_cbranch_scc1 wk_ni
  s_mov_b32 s96, 6
  v_mov_b32 v4, 1
  v_mov_b32 v5, 587520
  v_mov_b32 v6, 160000
  s_barrier
  s_cmp_lg_u32 s16, 0
  s_cbranch_scc1 wk_ide1
  s_mov_b64 exec, 1
  buffer_atomic_add v4, v5, s[8:11], 0 offen sc0
  s_waitcnt vmcnt(0)
  ds_write_b32 v6, v4
  s_waitcnt lgkmcnt(0)
  s_mov_b64 exec, -1
wk_ide1:
  s_barrier
  ds_read_b32 v4, v6
  s_waitcnt lgkmcnt(0)
  v_readfirstlane_b32 s3, v4
  s_cmp_lt_u32 s3, 32
  s_cbranch_scc1 wk_done
wk_ni:
  s_getreg_b32 s22, hwreg(HW_REG_XCC_ID)
  s_and_b32 s22, s22, 15
  s_cmp_lg_u32 s22, 15
  s_cbranch_scc1 wk_ask
  s_cmp_eq_u32 s96, 7
  s_cbranch_scc0 wk_srv
wk_ask:
  v_readfirstlane_b32 s22, v250
  s_cmp_ge_u32 s22, 1264
  s_cbranch_scc1 wk_next
  s_cmp_lg_u32 s16, 0
  s_cbranch_scc1 ask_10
  v_mov_b32 v250, 1
  v_mov_b32 v251, 588288
  s_mov_b64 exec, 1
  buffer_atomic_add v250, v251, s[8:11], 0 offen sc0
  s_mov_b64 exec, -1
ask_10:
wk_next:
  v_mov_b32 v6, 160000
  s_waitcnt vmcnt(0)
  s_barrier
  s_cmp_lg_u32 s16, 0
  s_cbranch_scc1 wk_n1
  s_mov_b64 exec, 1
  ds_write_b32 v6, v250
  s_mov_b64 exec, -1
  s_waitcnt lgkmcnt(0)
wk_n1:
  s_barrier
  ds_read_b32 v4, v6
  s_waitcnt lgkmcnt(0)
  v_readfirstlane_b32 s3, v4
  s_cmp_ge_u32 s3, 1264
  s_cbranch_scc1 wk_done
  v_mov_b32 v250, 0
  v_mov_b32 v251, 587264
  s_cmp_lg_u32 s3, 1263
  s_cbranch_scc1 wk_nl
  v_mov_b32 v5, 1264
  s_mov_b64 exec, 1
  buffer_store_dword v5, v251, s[8:11], 0 offen sc1
  s_mov_b64 exec, -1
wk_nl:
  v_and_b32 v1, 63, v0
  v_lshlrev_b32 v2, 4, v1
  v_lshrrev_b32 v3, 4, v1
  v_and_b32 v4, 15, v1
  s_cmp_lt_u32 s3, 112
  s_cbranch_scc1 wk_n2
  s_cmp_eq_u32 s97, 0
  s_cbranch_scc1 wk_n2
  v_mov_b32 v250, s3
  s_mov_b32 s96, 1
  s_mov_b32 s97, 1
  s_mov_b32 s39, 0
  s_mov_b32 s37, 0
  s_mov_b32 s38, 0
  s_mov_b32 s32, 0
  s_branch wp_all
wk_n2:
  s_sub_u32 s20, s3, 288
  s_cmp_ge_u32 s20, 352
  s_cbranch_scc1 wk_nr
  s_cmp_ge_u32 s20, 320
  s_cbranch_scc1 wk_srv
  s_add_u32 s3, s3, 32
wk_nr:
  s_cmp_ge_u32 s3, 752
  s_cbranch_scc1 wk_tok
  s_cmp_ge_u32 s3, 640
  s_cbranch_scc1 wk_s4d
  s_cmp_ge_u32 s3, 448
  s_cbranch_scc1 wk_full
  s_cmp_ge_u32 s3, 320
  s_cbranch_scc1 wk_adef
  s_cmp_ge_u32 s3, 288
  s_cbranch_scc1 wk_srv
  s_and_b32 s17, s3, 15
  s_add_u32 s17, s17, 16
  s_cmp_ge_u32 s3, 224
  s_cbranch_scc1 wk_half
  s_cmp_ge_u32 s3, 112
  s_cselect_b32 s18, 1, 0
  s_cselect_b32 s20, 112, 0
  s_sub_u32 s34, s3, s20
  s_lshr_b32 s34, s34, 4
  s_lshl_b32 s34, s34, 1
  s_add_u32 s35, s34, 2
  s_branch wk_gemm
wk_adef:
  s_mov_b32 s101, -1
  s_load_dwordx8 s[40:47], s[0:1], 72
  s_sub_u32 s20, s3, 320
  s_getreg_b32 s33, hwreg(HW_REG_XCC_ID)
  s_sub_u32 s33, s33, 4
  s_and_b32 s33, s33, 7
  s_min_u32 s33, s33, 7
  s_mov_b32 s35, 7
wk_adc:
  s_lshl_b32 s34, s33, 7
  s_add_u32 s34, s34, 589312
  v_mov_b32 v4, 1
  v_mov_b32 v5, s34
  v_mov_b32 v6, 160000
  s_barrier
  s_cmp_lg_u32 s16, 0
  s_cbranch_scc1 wk_ade1
  s_mov_b64 exec, 1
  buffer_atomic_add v4, v5, s[8:11], 0 offen sc0
  s_waitcnt vmcnt(0)
  ds_write_b32 v6, v4
  s_waitcnt lgkmcnt(0)
  s_mov_b64 exec, -1
wk_ade1:
  s_barrier
  ds_read_b32 v4, v6
  s_waitcnt lgkmcnt(0)
  v_readfirstlane_b32 s20, v4
  s_cmp_lt_u32 s20, 16
  s_cbranch_scc1 wk_adg
  s_mov_b32 s33, s35
  s_sub_u32 s35, s35, 1
  s_max_i32 s35, s35, 0
  s_branch wk_adc
wk_adg:
  s_lshl_b32 s33, s33, 4
  s_add_u32 s20, s20, s33
  v_and_b32 v1, 63, v0
  v_lshlrev_b32 v2, 4, v1
  v_lshrrev_b32 v3, 4, v1
  v_and_b32 v4, 15, v1
  s_lshr_b32 s33, s20, 2
  s_mul_i32 s33, s33, 7
  s_and_b32 s20, s20, 3
  s_add_u32 s33, s33, s20
  s_mov_b32 s97, 3
  v_mov_b32 v252, 0x40000000
  v_cmp_eq_u32 vcc, 0, v0
  s_nop 1
  v_cndmask_b32 v252, v252, v0, vcc
  v_lshrrev_b32 v5, 5, v1
  v_and_b32 v6, 31, v1
  v_xor_b32 v8, v6, v5
  v_lshlrev_b32 v8, 4, v8
  v_lshl_add_u32 v16, v5, 13, v8
  v_xor_b32 v17, 32, v16
  v_xor_b32 v18, 64, v16
  v_xor_b32 v19, 96, v16
  v_xor_b32 v20, 128, v16
  v_xor_b32 v21, 160, v16
  v_xor_b32 v22, 192, v16
  v_xor_b32 v23, 224, v16
  s_lshl_b32 s20, s16, 6
  v_xor_b32 v26, s20, v16
  v_xor_b32 v27, 32, v26
  s_mul_i32 s17, s33, 4682
  s_lshr_b32 s17, s17, 16
  s_mul_i32 s23, s17, 14
  s_sub_u32 s19, s33, s23
  s_cmp_lt_u32 s19, 7
  s_cselect_b32 s18, 0, 7
  s_cselect_b32 s28, 0, 8
  s_sub_u32 s18, s19, s18
  s_add_u32 s28, s28, s16
  s_lshl_b32 s25, s16, 15
  s_add_u32 s25, s25, 32768
  s_lshl_b32 s26, s17, 9
  s_waitcnt lgkmcnt(0)
  s_barrier
  s_branch wp_A0
wk_adone:
  s_mov_b32 s97, 0
  s_branch wk_loop
wk_half:
  s_sub_u32 s20, s3, 224
  s_lshr_b32 s18, s20, 5
  s_add_u32 s18, s18, 2
  s_bitcmp1_b32 s20, 4
  s_cselect_b32 s34, 7, 0
  s_add_u32 s35, s34, 7
  s_branch wk_gemm
wk_full:
  s_sub_u32 s20, s3, 384
  s_and_b32 s17, s20, 15
  s_lshr_b32 s18, s20, 4
  s_mov_b32 s34, 0
  s_mov_b32 s35, 14
  s_cmp_lt_u32 s18, 8
  s_cselect_b32 s21, 16, 0
  s_add_u32 s17, s17, s21
  s_and_b32 s18, s18, 7
  s_cmp_ge_u32 s17, 16
  s_cbranch_scc1 wk_gemm
  s_load_dwordx8 s[40:47], s[0:1], 0
  s_load_dwordx2 s[48:49], s[0:1], 32
  s_sub_u32 s21, s3, 512
  v_min_u32 v12, 111, v0
  v_lshlrev_b32 v12, 7, v12
  v_min_u32 v13, 13, v0
  v_lshlrev_b32 v13, 7, v13
  s_mul_i32 s22, s21, 14336
  s_mul_i32 s21, s21, 1792
  s_waitcnt lgkmcnt(0)
  s_cmp_ge_u32 s16, 2
  s_cbranch_scc1 wk_up
  s_mov_b32 s60, s40
  s_and_b32 s61, s41, 0xffff
  s_mov_b32 s62, 1835008
  s_mov_b32 s63, 0x20000
  buffer_load_dword v14, v12, s[60:63], s22 offen
  s_mov_b32 s60, s42
  s_and_b32 s61, s43, 0xffff
  s_mov_b32 s62, 229376
  s_mov_b32 s63, 0x20000
  buffer_load_dword v14, v13, s[60:63], s21 offen
  s_mov_b32 s60, s44
  s_and_b32 s61, s45, 0xffff
  s_mov_b32 s62, 229376
  s_mov_b32 s63, 0x20000
  buffer_load_dword v14, v13, s[60:63], s21 offen
  s_mov_b32 s60, s46
  s_and_b32 s61, s47, 0xffff
  s_mov_b32 s62, 229376
  s_mov_b32 s63, 0x20000
  buffer_load_dword v14, v13, s[60:63], s21 offen
  s_mov_b32 s60, s48
  s_and_b32 s61, s49, 0xffff
  s_mov_b32 s62, 229376
  s_mov_b32 s63, 0x20000
  buffer_load_dword v14, v13, s[60:63], s21 offen
wk_up:
  s_lshl_b32 s27, s17, 7
  s_add_u32 s27, s27, 584192
  s_mov_b32 s28, 16383
  s_mov_b32 s30, 0
wk_aw:
  buffer_load_dword v9, off, s[8:11], s27  sc1
  s_waitcnt vmcnt(0)
  v_and_b32 v10, s28, v9
  v_cmp_ne_u32 vcc, s28, v10
  s_cbranch_vccz wk_aw_ok
  s_sleep 3
  s_add_u32 s30, s30, 1
  s_cmp_lt_u32 s30, 400000
  s_cbranch_scc1 wk_aw
  s_branch cA_abort
wk_aw_ok:
wk_gemm:
  s_lshl_b32 s20, s18, 4
  s_lshr_b32 s21, s2, 3
  s_add_u32 s21, s21, s16
  s_and_b32 s21, s21, 3
  s_lshl_b32 s21, s21, 2
  s_add_u32 s20, s20, s21
  s_mul_i32 s21, s20, 14336
  s_add_u32 s21, s21, 655360
  s_mul_i32 s23, s17, 401408
  s_and_b32 s22, s16, 1
  s_mul_i32 s22, s22, 7168
  s_add_u32 s23, s23, s22
  s_add_u32 s23, s23, 33554432
  s_lshr_b32 s22, s16, 1
  s_mul_i32 s22, s22, 14336
  s_add_u32 s23, s23, s22
  s_mul_i32 s27, s16, 7168
  s_lshr_b32 s28, s20, 1
  s_cmp_lt_u32 s17, 16
  s_cbranch_scc0 wg_vo
  s_add_u32 s23, s23, s22
  s_lshl_b32 s29, s28, 4
  s_add_u32 s29, s29, s17
  s_mul_i32 s29, s29, 28672
  s_add_u32 s29, s29, 46399488
  s_mov_b32 s31, 0
  s_lshr_b32 s24, s34, 1
  s_lshl_b32 s24, s24, 2
  s_and_b32 s25, s34, 1
  s_add_u32 s24, s24, s25
  s_mul_i32 s24, s24, 14336
  s_add_u32 s24, s24, s23
  s_add_u32 m0, s31, s27
  s_nop 0
  buffer_load_dwordx4 v2, s[8:11], s24 offen offset:0 sc1 lds
  buffer_load_dwordx4 v2, s[8:11], s24 offen offset:1024 sc1 lds
  buffer_load_dwordx4 v2, s[8:11], s24 offen offset:2048 sc1 lds
  buffer_load_dwordx4 v2, s[8:11], s24 offen offset:3072 sc1 lds
  s_add_u32 m0, m0, 4096
  s_add_u32 s24, s24, 4096
  buffer_load_dwordx4 v2, s[8:11], s24 offen offset:0 sc1 lds
  buffer_load_dwordx4 v2, s[8:11], s24 offen offset:1024 sc1 lds
  buffer_load_dwordx4 v2, s[8:11], s24 offen offset:2048 sc1 lds
  s_sub_u32 s36, s35, 1
  s_add_u32 s30, s34, 1
  s_min_u32 s30, s30, s36
  s_mov_b32 s31, 28672
  s_lshr_b32 s24, s30, 1
  s_lshl_b32 s24, s24, 2
  s_and_b32 s25, s30, 1
  s_add_u32 s24, s24, s25
  s_mul_i32 s24, s24, 14336
  s_add_u32 s24, s24, s23
  s_add_u32 m0, s31, s27
  s_nop 0
  buffer_load_dwordx4 v2, s[8:11], s24 offen offset:0 sc1 lds
  buffer_load_dwordx4 v2, s[8:11], s24 offen offset:1024 sc1 lds
  buffer_load_dwordx4 v2, s[8:11], s24 offen offset:2048 sc1 lds
  buffer_load_dwordx4 v2, s[8:11], s24 offen offset:3072 sc1 lds
  s_add_u32 m0, m0, 4096
  s_add_u32 s24, s24, 4096
  buffer_load_dwordx4 v2, s[8:11], s24 offen offset:0 sc1 lds
  buffer_load_dwordx4 v2, s[8:11], s24 offen offset:1024 sc1 lds
  buffer_load_dwordx4 v2, s[8:11], s24 offen offset:2048 sc1 lds
  s_mov_b32 s19, s34
  s_mov_b32 s32, 0
  s_mov_b32 s33, 57344
  s_cmp_eq_u32 s18, s101
  s_cbranch_scc1 wg_f_hx
  s_add_u32 s22, s21, 0
  buffer_load_dwordx4 a[0:3], v2, s[8:11], s22 offen offset:0 sc1
  buffer_load_dwordx4 a[4:7], v2, s[8:11], s22 offen offset:1024 sc1
  buffer_load_dwordx4 a[8:11], v2, s[8:11], s22 offen offset:2048 sc1
  buffer_load_dwordx4 a[12:15], v2, s[8:11], s22 offen offset:3072 sc1
  s_add_u32 s22, s21, 4096
  buffer_load_dwordx4 a[16:19], v2, s[8:11], s22 offen offset:0 sc1
  buffer_load_dwordx4 a[20:23], v2, s[8:11], s22 offen offset:1024 sc1
  buffer_load_dwordx4 a[24:27], v2, s[8:11], s22 offen offset:2048 sc1
  buffer_load_dwordx4 a[28:31], v2, s[8:11], s22 offen offset:3072 sc1
  s_add_u32 s22, s21, 8192
  buffer_load_dwordx4 a[32:35], v2, s[8:11], s22 offen offset:0 sc1
  buffer_load_dwordx4 a[36:39], v2, s[8:11], s22 offen offset:1024 sc1
  buffer_load_dwordx4 a[40:43], v2, s[8:11], s22 offen offset:2048 sc1
  buffer_load_dwordx4 a[44:47], v2, s[8:11], s22 offen offset:3072 sc1
  s_add_u32 s22, s21, 12288
  buffer_load_dwordx4 a[48:51], v2, s[8:11], s22 offen offset:0 sc1
  buffer_load_dwordx4 a[52:55], v2, s[8:11], s22 offen offset:1024 sc1
  buffer_load_dwordx4 a[56:59], v2, s[8:11], s22 offen offset:2048 sc1
  buffer_load_dwordx4 a[60:63], v2, s[8:11], s22 offen offset:3072 sc1
  s_add_u32 s22, s21, 16384
  buffer_load_dwordx4 a[64:67], v2, s[8:11], s22 offen offset:0 sc1
  buffer_load_dwordx4 a[68:71], v2, s[8:11], s22 offen offset:1024 sc1
  buffer_load_dwordx4 a[72:75], v2, s[8:11], s22 offen offset:2048 sc1
  buffer_load_dwordx4 a[76:79], v2, s[8:11], s22 offen offset:3072 sc1
  s_add_u32 s22, s21, 20480
  buffer_load_dwordx4 a[80:83], v2, s[8:11], s22 offen offset:0 sc1
  buffer_load_dwordx4 a[84:87], v2, s[8:11], s22 offen offset:1024 sc1
  buffer_load_dwordx4 a[88:91], v2, s[8:11], s22 offen offset:2048 sc1
  buffer_load_dwordx4 a[92:95], v2, s[8:11], s22 offen offset:3072 sc1
  s_add_u32 s22, s21, 24576
  buffer_load_dwordx4 a[96:99], v2, s[8:11], s22 offen offset:0 sc1
  buffer_load_dwordx4 a[100:103], v2, s[8:11], s22 offen offset:1024 sc1
  buffer_load_dwordx4 a[104:107], v2, s[8:11], s22 offen offset:2048 sc1
  buffer_load_dwordx4 a[108:111], v2, s[8:11], s22 offen offset:3072 sc1
  s_add_u32 s22, s21, 28672
  buffer_load_dwordx4 a[112:115], v2, s[8:11], s22 offen offset:0 sc1
  buffer_load_dwordx4 a[116:119], v2, s[8:11], s22 offen offset:1024 sc1
  buffer_load_dwordx4 a[120:123], v2, s[8:11], s22 offen offset:2048 sc1
  buffer_load_dwordx4 a[124:127], v2, s[8:11], s22 offen offset:3072 sc1
  s_add_u32 s22, s21, 32768
  buffer_load_dwordx4 a[128:131], v2, s[8:11], s22 offen offset:0 sc1
  buffer_load_dwordx4 a[132:135], v2, s[8:11], s22 offen offset:1024 sc1
  buffer_load_dwordx4 a[136:139], v2, s[8:11], s22 offen offset:2048 sc1
  buffer_load_dwordx4 a[140:143], v2, s[8:11], s22 offen offset:3072 sc1
  s_add_u32 s22, s21, 36864
  buffer_load_dwordx4 a[144:147], v2, s[8:11], s22 offen offset:0 sc1
  buffer_load_dwordx4 a[148:151], v2, s[8:11], s22 offen offset:1024 sc1
  buffer_load_dwordx4 a[152:155], v2, s[8:11], s22 offen offset:2048 sc1
  buffer_load_dwordx4 a[156:159], v2, s[8:11], s22 offen offset:3072 sc1
  s_add_u32 s22, s21, 40960
  s_waitcnt vmcnt(40)
  buffer_load_dwordx4 a[160:163], v2, s[8:11], s22 offen offset:0 sc1
  buffer_load_dwordx4 a[164:167], v2, s[8:11], s22 offen offset:1024 sc1
  buffer_load_dwordx4 a[168:171], v2, s[8:11], s22 offen offset:2048 sc1
  buffer_load_dwordx4 a[172:175], v2, s[8:11], s22 offen offset:3072 sc1
  s_add_u32 s22, s21, 45056
  buffer_load_dwordx4 a[176:179], v2, s[8:11], s22 offen offset:0 sc1
  buffer_load_dwordx4 a[180:183], v2, s[8:11], s22 offen offset:1024 sc1
  buffer_load_dwordx4 a[184:187], v2, s[8:11], s22 offen offset:2048 sc1
  buffer_load_dwordx4 a[188:191], v2, s[8:11], s22 offen offset:3072 sc1
  s_add_u32 s22, s21, 49152
  buffer_load_dwordx4 a[192:195], v2, s[8:11], s22 offen offset:0 sc1
  buffer_load_dwordx4 a[196:199], v2, s[8:11], s22 offen offset:1024 sc1
  buffer_load_dwordx4 a[200:203], v2, s[8:11], s22 offen offset:2048 sc1
  buffer_load_dwordx4 a[204:207], v2, s[8:11], s22 offen offset:3072 sc1
  s_add_u32 s22, s21, 53248
  buffer_load_dwordx4 a[208:211], v2, s[8:11], s22 offen offset:0 sc1
  buffer_load_dwordx4 a[212:215], v2, s[8:11], s22 offen offset:1024 sc1
  buffer_load_dwordx4 a[216:219], v2, s[8:11], s22 offen offset:2048 sc1
  buffer_load_dwordx4 a[220:223], v2, s[8:11], s22 offen offset:3072 sc1
wg_f_hx:
  s_mov_b32 s101, -1
  s_waitcnt vmcnt(0)
  s_barrier
  s_mov_b32 s40, 0
  s_mov_b32 s41, 0x40000000
  v_mov_b32 v5, v2
  ds_read_b128 v[8:11], v5 offset:0
  ds_read_b128 v[12:15], v5 offset:14336
  ds_read_b128 v[16:19], v5 offset:1024
  ds_read_b128 v[20:23], v5 offset:15360
  ds_read_b128 v[24:27], v5 offset:2048
  s_waitcnt lgkmcnt(4)
.p2align 6
wg_f_loop:
  v_mfma_f32_16x16x32_bf16 v[40:43], v[8:11], a[0:3], 0
  ds_read_b128 v[28:31], v5 offset:16384
  v_mfma_f32_16x16x32_bf16 v[44:47], v[8:11], a[56:59], 0
  v_mfma_f32_16x16x32_bf16 v[48:51], v[8:11], a[112:115], 0
  v_mfma_f32_16x16x32_bf16 v[52:55], v[8:11], a[168:171], 0
  s_waitcnt lgkmcnt(4)
  s_lshl_b32 s42, s40, 10
  v_mfma_f32_16x16x32_bf16 v[56:59], v[12:15], a[0:3], 0
  ds_read_b128 v[32:35], v5 offset:3072
  v_mfma_f32_16x16x32_bf16 v[60:63], v[12:15], a[56:59], 0
  s_add_u32 s42, s42, s41
  v_cvt_pk_bf16_f32 v72, v96, v97
  v_mfma_f32_16x16x32_bf16 v[64:67], v[12:15], a[112:115], 0
  v_cvt_pk_bf16_f32 v73, v98, v99
  v_cvt_pk_bf16_f32 v74, v112, v113
  v_mfma_f32_16x16x32_bf16 v[68:71], v[12:15], a[168:171], 0
  s_waitcnt lgkmcnt(4)
  v_cvt_pk_bf16_f32 v75, v114, v115
  v_mfma_f32_16x16x32_bf16 v[40:43], v[16:19], a[4:7], v[40:43]
  ds_read_b128 v[8:11], v5 offset:17408
  v_mfma_f32_16x16x32_bf16 v[44:47], v[16:19], a[60:63], v[44:47]
  s_add_u32 s43, s42, 0
  v_mfma_f32_16x16x32_bf16 v[48:51], v[16:19], a[116:119], v[48:51]
  buffer_store_dwordx4 v[72:75], v2, s[8:11], s43 offen sc1
  v_cvt_pk_bf16_f32 v76, v100, v101
  v_mfma_f32_16x16x32_bf16 v[52:55], v[16:19], a[172:175], v[52:55]
  s_waitcnt lgkmcnt(4)
  v_cvt_pk_bf16_f32 v77, v102, v103
  v_mfma_f32_16x16x32_bf16 v[56:59], v[20:23], a[4:7], v[56:59]
  ds_read_b128 v[12:15], v5 offset:4096
  v_mfma_f32_16x16x32_bf16 v[60:63], v[20:23], a[60:63], v[60:63]
  v_cvt_pk_bf16_f32 v78, v116, v117
  v_cvt_pk_bf16_f32 v79, v118, v119
  v_mfma_f32_16x16x32_bf16 v[64:67], v[20:23], a[116:119], v[64:67]
  s_add_u32 s43, s42, 14336
  v_mfma_f32_16x16x32_bf16 v[68:71], v[20:23], a[172:175], v[68:71]
  s_waitcnt lgkmcnt(4)
  buffer_store_dwordx4 v[76:79], v2, s[8:11], s43 offen sc1
  v_mfma_f32_16x16x32_bf16 v[40:43], v[24:27], a[8:11], v[40:43]
  ds_read_b128 v[16:19], v5 offset:18432
  v_mfma_f32_16x16x32_bf16 v[44:47], v[24:27], a[64:67], v[44:47]
  v_cvt_pk_bf16_f32 v80, v104, v105
  v_cvt_pk_bf16_f32 v81, v106, v107
  v_mfma_f32_16x16x32_bf16 v[48:51], v[24:27], a[120:123], v[48:51]
  v_cvt_pk_bf16_f32 v82, v120, v121
  v_cvt_pk_bf16_f32 v83, v122, v123
  v_mfma_f32_16x16x32_bf16 v[52:55], v[24:27], a[176:179], v[52:55]
  s_waitcnt lgkmcnt(4)
  s_add_u32 s43, s42, 458752
  v_mfma_f32_16x16x32_bf16 v[56:59], v[28:31], a[8:11], v[56:59]
  ds_read_b128 v[20:23], v5 offset:5120
  v_mfma_f32_16x16x32_bf16 v[60:63], v[28:31], a[64:67], v[60:63]
  buffer_store_dwordx4 v[80:83], v2, s[8:11], s43 offen sc1
  v_cvt_pk_bf16_f32 v84, v108, v109
  v_mfma_f32_16x16x32_bf16 v[64:67], v[28:31], a[120:123], v[64:67]
  v_cvt_pk_bf16_f32 v85, v110, v111
  v_cvt_pk_bf16_f32 v86, v124, v125
  v_mfma_f32_16x16x32_bf16 v[68:71], v[28:31], a[176:179], v[68:71]
  s_waitcnt lgkmcnt(4)
  v_cvt_pk_bf16_f32 v87, v126, v127
  v_mfma_f32_16x16x32_bf16 v[40:43], v[32:35], a[12:15], v[40:43]
  ds_read_b128 v[24:27], v5 offset:19456
  v_mfma_f32_16x16x32_bf16 v[44:47], v[32:35], a[68:71], v[44:47]
  s_add_u32 s43, s42, 473088
  v_mfma_f32_16x16x32_bf16 v[48:51], v[32:35], a[124:127], v[48:51]
  buffer_store_dwordx4 v[84:87], v2, s[8:11], s43 offen sc1
  v_mfma_f32_16x16x32_bf16 v[52:55], v[32:35], a[180:183], v[52:55]
  s_waitcnt lgkmcnt(4)
  s_add_u32 s30, s19, 2
  s_lshr_b32 s24, s30, 1
  s_lshl_b32 s24, s24, 2
  s_and_b32 s25, s30, 1
  s_add_u32 s24, s24, s25
  s_mul_i32 s24, s24, 14336
  v_mfma_f32_16x16x32_bf16 v[56:59], v[8:11], a[12:15], v[56:59]
  ds_read_b128 v[28:31], v5 offset:6144
  v_mfma_f32_16x16x32_bf16 v[60:63], v[8:11], a[68:71], v[60:63]
  s_add_u32 s24, s24, s23
  s_cmp_lt_u32 s30, s35
  s_cselect_b32 s24, s24, 0x40000000
  v_mfma_f32_16x16x32_bf16 v[64:67], v[8:11], a[124:127], v[64:67]
  s_add_u32 m0, s33, s27
  s_nop 0
  buffer_load_dwordx4 v2, s[8:11], s24 offen offset:0 sc1 lds
  v_mfma_f32_16x16x32_bf16 v[68:71], v[8:11], a[180:183], v[68:71]
  s_waitcnt lgkmcnt(4)
  v_mfma_f32_16x16x32_bf16 v[40:43], v[12:15], a[16:19], v[40:43]
  ds_read_b128 v[32:35], v5 offset:20480
  v_mfma_f32_16x16x32_bf16 v[44:47], v[12:15], a[72:75], v[44:47]
  v_mfma_f32_16x16x32_bf16 v[48:51], v[12:15], a[128:131], v[48:51]
  v_mfma_f32_16x16x32_bf16 v[52:55], v[12:15], a[184:187], v[52:55]
  s_waitcnt lgkmcnt(4)
  buffer_load_dwordx4 v2, s[8:11], s24 offen offset:1024 sc1 lds
  v_mfma_f32_16x16x32_bf16 v[56:59], v[16:19], a[16:19], v[56:59]
  ds_read_b128 v[8:11], v5 offset:7168
  v_mfma_f32_16x16x32_bf16 v[60:63], v[16:19], a[72:75], v[60:63]
  v_mfma_f32_16x16x32_bf16 v[64:67], v[16:19], a[128:131], v[64:67]
  v_mfma_f32_16x16x32_bf16 v[68:71], v[16:19], a[184:187], v[68:71]
  s_waitcnt lgkmcnt(4)
  v_mfma_f32_16x16x32_bf16 v[40:43], v[20:23], a[20:23], v[40:43]
  ds_read_b128 v[12:15], v5 offset:21504
  v_mfma_f32_16x16x32_bf16 v[44:47], v[20:23], a[76:79], v[44:47]
  buffer_load_dwordx4 v2, s[8:11], s24 offen offset:2048 sc1 lds
  v_mfma_f32_16x16x32_bf16 v[48:51], v[20:23], a[132:135], v[48:51]
  v_mfma_f32_16x16x32_bf16 v[52:55], v[20:23], a[188:191], v[52:55]
  s_waitcnt lgkmcnt(4)
  v_mfma_f32_16x16x32_bf16 v[56:59], v[24:27], a[20:23], v[56:59]
  ds_read_b128 v[16:19], v5 offset:8192
  v_mfma_f32_16x16x32_bf16 v[60:63], v[24:27], a[76:79], v[60:63]
  v_mfma_f32_16x16x32_bf16 v[64:67], v[24:27], a[132:135], v[64:67]
  buffer_load_dwordx4 v2, s[8:11], s24 offen offset:3072 sc1 lds
  v_mfma_f32_16x16x32_bf16 v[68:71], v[24:27], a[188:191], v[68:71]
  s_waitcnt lgkmcnt(4)
  v_mfma_f32_16x16x32_bf16 v[40:43], v[28:31], a[24:27], v[40:43]
  ds_read_b128 v[20:23], v5 offset:22528
  v_mfma_f32_16x16x32_bf16 v[44:47], v[28:31], a[80:83], v[44:47]
  v_mfma_f32_16x16x32_bf16 v[48:51], v[28:31], a[136:139], v[48:51]
  v_mfma_f32_16x16x32_bf16 v[52:55], v[28:31], a[192:195], v[52:55]
  s_waitcnt lgkmcnt(4)
  s_add_u32 m0, m0, 4096
  s_add_u32 s24, s24, 4096
  buffer_load_dwordx4 v2, s[8:11], s24 offen offset:0 sc1 lds
  v_mfma_f32_16x16x32_bf16 v[56:59], v[32:35], a[24:27], v[56:59]
  ds_read_b128 v[24:27], v5 offset:9216
  v_mfma_f32_16x16x32_bf16 v[60:63], v[32:35], a[80:83], v[60:63]
  v_mfma_f32_16x16x32_bf16 v[64:67], v[32:35], a[136:139], v[64:67]
  v_mfma_f32_16x16x32_bf16 v[68:71], v[32:35], a[192:195], v[68:71]
  s_waitcnt lgkmcnt(4)
  v_mfma_f32_16x16x32_bf16 v[40:43], v[8:11], a[28:31], v[40:43]
  ds_read_b128 v[28:31], v5 offset:23552
  v_mfma_f32_16x16x32_bf16 v[44:47], v[8:11], a[84:87], v[44:47]
  buffer_load_dwordx4 v2, s[8:11], s24 offen offset:1024 sc1 lds
  v_mfma_f32_16x16x32_bf16 v[48:51], v[8:11], a[140:143], v[48:51]
  v_mfma_f32_16x16x32_bf16 v[52:55], v[8:11], a[196:199], v[52:55]
  s_waitcnt lgkmcnt(4)
  v_mfma_f32_16x16x32_bf16 v[56:59], v[12:15], a[28:31], v[56:59]
  ds_read_b128 v[32:35], v5 offset:10240
  v_mfma_f32_16x16x32_bf16 v[60:63], v[12:15], a[84:87], v[60:63]
  v_mfma_f32_16x16x32_bf16 v[64:67], v[12:15], a[140:143], v[64:67]
  buffer_load_dwordx4 v2, s[8:11], s24 offen offset:2048 sc1 lds
  v_mfma_f32_16x16x32_bf16 v[68:71], v[12:15], a[196:199], v[68:71]
  s_waitcnt lgkmcnt(4)
  v_mfma_f32_16x16x32_bf16 v[40:43], v[16:19], a[32:35], v[40:43]
  ds_read_b128 v[8:11], v5 offset:24576
  v_mfma_f32_16x16x32_bf16 v[44:47], v[16:19], a[88:91], v[44:47]
  v_mfma_f32_16x16x32_bf16 v[48:51], v[16:19], a[144:147], v[48:51]
  v_mfma_f32_16x16x32_bf16 v[52:55], v[16:19], a[200:203], v[52:55]
  s_waitcnt lgkmcnt(4)
  s_add_u32 s33, s33, 28672
  s_cmp_eq_u32 s33, 114688
  s_cselect_b32 s33, 0, s33
  v_mfma_f32_16x16x32_bf16 v[56:59], v[20:23], a[32:35], v[56:59]
  ds_read_b128 v[12:15], v5 offset:11264
  v_mfma_f32_16x16x32_bf16 v[60:63], v[20:23], a[88:91], v[60:63]
  s_add_u32 s32, s32, 28672
  s_cmp_eq_u32 s32, 114688
  s_cselect_b32 s32, 0, s32
  v_mfma_f32_16x16x32_bf16 v[64:67], v[20:23], a[144:147], v[64:67]
  v_add_u32 v128, s32, v2
  v_mfma_f32_16x16x32_bf16 v[68:71], v[20:23], a[200:203], v[68:71]
  s_waitcnt lgkmcnt(4)
  v_mfma_f32_16x16x32_bf16 v[40:43], v[24:27], a[36:39], v[40:43]
  ds_read_b128 v[16:19], v5 offset:25600
  v_mfma_f32_16x16x32_bf16 v[44:47], v[24:27], a[92:95], v[44:47]
  v_mfma_f32_16x16x32_bf16 v[48:51], v[24:27], a[148:151], v[48:51]
  v_mfma_f32_16x16x32_bf16 v[52:55], v[24:27], a[204:207], v[52:55]
  s_waitcnt lgkmcnt(4)
  v_mfma_f32_16x16x32_bf16 v[56:59], v[28:31], a[36:39], v[56:59]
  ds_read_b128 v[20:23], v5 offset:12288
  v_mfma_f32_16x16x32_bf16 v[60:63], v[28:31], a[92:95], v[60:63]
  v_mfma_f32_16x16x32_bf16 v[64:67], v[28:31], a[148:151], v[64:67]
  v_mfma_f32_16x16x32_bf16 v[68:71], v[28:31], a[204:207], v[68:71]
  s_waitcnt lgkmcnt(4)
  v_mfma_f32_16x16x32_bf16 v[40:43], v[32:35], a[40:43], v[40:43]
  ds_read_b128 v[24:27], v5 offset:26624
  v_mfma_f32_16x16x32_bf16 v[44:47], v[32:35], a[96:99], v[44:47]
  v_mfma_f32_16x16x32_bf16 v[48:51], v[32:35], a[152:155], v[48:51]
  v_mfma_f32_16x16x32_bf16 v[52:55], v[32:35], a[208:211], v[52:55]
  s_waitcnt lgkmcnt(4)
  v_mfma_f32_16x16x32_bf16 v[56:59], v[8:11], a[40:43], v[56:59]
  ds_read_b128 v[28:31], v5 offset:13312
  v_mfma_f32_16x16x32_bf16 v[60:63], v[8:11], a[96:99], v[60:63]
  v_mfma_f32_16x16x32_bf16 v[64:67], v[8:11], a[152:155], v[64:67]
  v_mfma_f32_16x16x32_bf16 v[68:71], v[8:11], a[208:211], v[68:71]
  s_waitcnt lgkmcnt(4)
  v_mfma_f32_16x16x32_bf16 v[40:43], v[12:15], a[44:47], v[40:43]
  ds_read_b128 v[32:35], v5 offset:27648
  v_mfma_f32_16x16x32_bf16 v[44:47], v[12:15], a[100:103], v[44:47]
  v_mfma_f32_16x16x32_bf16 v[48:51], v[12:15], a[156:159], v[48:51]
  v_mfma_f32_16x16x32_bf16 v[52:55], v[12:15], a[212:215], v[52:55]
  s_waitcnt lgkmcnt(4)
  v_mfma_f32_16x16x32_bf16 v[56:59], v[16:19], a[44:47], v[56:59]
  s_waitcnt vmcnt(11)
  s_barrier
  ds_read_b128 v[8:11], v128 offset:0
  v_mfma_f32_16x16x32_bf16 v[60:63], v[16:19], a[100:103], v[60:63]
  v_mfma_f32_16x16x32_bf16 v[64:67], v[16:19], a[156:159], v[64:67]
  v_mfma_f32_16x16x32_bf16 v[68:71], v[16:19], a[212:215], v[68:71]
  s_waitcnt lgkmcnt(4)
  v_mfma_f32_16x16x32_bf16 v[40:43], v[20:23], a[48:51], v[40:43]
  ds_read_b128 v[12:15], v128 offset:14336
  v_mfma_f32_16x16x32_bf16 v[44:47], v[20:23], a[104:107], v[44:47]
  v_mfma_f32_16x16x32_bf16 v[48:51], v[20:23], a[160:163], v[48:51]
  v_mfma_f32_16x16x32_bf16 v[52:55], v[20:23], a[216:219], v[52:55]
  s_waitcnt lgkmcnt(4)
  v_mfma_f32_16x16x32_bf16 v[56:59], v[24:27], a[48:51], v[56:59]
  ds_read_b128 v[16:19], v128 offset:1024
  v_mfma_f32_16x16x32_bf16 v[60:63], v[24:27], a[104:107], v[60:63]
  v_mfma_f32_16x16x32_bf16 v[64:67], v[24:27], a[160:163], v[64:67]
  v_mfma_f32_16x16x32_bf16 v[68:71], v[24:27], a[216:219], v[68:71]
  s_waitcnt lgkmcnt(4)
  v_mfma_f32_16x16x32_bf16 v[40:43], v[28:31], a[52:55], v[40:43]
  ds_read_b128 v[20:23], v128 offset:15360
  v_mfma_f32_16x16x32_bf16 v[44:47], v[28:31], a[108:111], v[44:47]
  v_mfma_f32_16x16x32_bf16 v[48:51], v[28:31], a[164:167], v[48:51]
  v_mfma_f32_16x16x32_bf16 v[52:55], v[28:31], a[220:223], v[52:55]
  s_waitcnt lgkmcnt(4)
  v_mfma_f32_16x16x32_bf16 v[56:59], v[32:35], a[52:55], v[56:59]
  ds_read_b128 v[24:27], v128 offset:2048
  v_mfma_f32_16x16x32_bf16 v[60:63], v[32:35], a[108:111], v[60:63]
  v_mfma_f32_16x16x32_bf16 v[64:67], v[32:35], a[164:167], v[64:67]
  v_mfma_f32_16x16x32_bf16 v[68:71], v[32:35], a[220:223], v[68:71]
  s_waitcnt lgkmcnt(4)
  s_mov_b32 s40, s19
  s_mov_b32 s41, s29
  s_add_u32 s19, s19, 1
  s_cmp_lt_u32 s19, s35
  s_cbranch_scc0 wg_f_e0
  v_mfma_f32_16x16x32_bf16 v[96:99], v[8:11], a[0:3], 0
  ds_read_b128 v[28:31], v128 offset:16384
  v_mfma_f32_16x16x32_bf16 v[100:103], v[8:11], a[56:59], 0
  v_mfma_f32_16x16x32_bf16 v[104:107], v[8:11], a[112:115], 0
  v_mfma_f32_16x16x32_bf16 v[108:111], v[8:11], a[168:171], 0
  s_waitcnt lgkmcnt(4)
  s_lshl_b32 s42, s40, 10
  v_mfma_f32_16x16x32_bf16 v[112:115], v[12:15], a[0:3], 0
  ds_read_b128 v[32:35], v128 offset:3072
  v_mfma_f32_16x16x32_bf16 v[116:119], v[12:15], a[56:59], 0
  s_add_u32 s42, s42, s41
  v_cvt_pk_bf16_f32 v72, v40, v41
  v_mfma_f32_16x16x32_bf16 v[120:123], v[12:15], a[112:115], 0
  v_cvt_pk_bf16_f32 v73, v42, v43
  v_cvt_pk_bf16_f32 v74, v56, v57
  v_mfma_f32_16x16x32_bf16 v[124:127], v[12:15], a[168:171], 0
  s_waitcnt lgkmcnt(4)
  v_cvt_pk_bf16_f32 v75, v58, v59
  v_mfma_f32_16x16x32_bf16 v[96:99], v[16:19], a[4:7], v[96:99]
  ds_read_b128 v[8:11], v128 offset:17408
  v_mfma_f32_16x16x32_bf16 v[100:103], v[16:19], a[60:63], v[100:103]
  s_add_u32 s43, s42, 0
  v_mfma_f32_16x16x32_bf16 v[104:107], v[16:19], a[116:119], v[104:107]
  buffer_store_dwordx4 v[72:75], v2, s[8:11], s43 offen sc1
  v_cvt_pk_bf16_f32 v76, v44, v45
  v_mfma_f32_16x16x32_bf16 v[108:111], v[16:19], a[172:175], v[108:111]
  s_waitcnt lgkmcnt(4)
  v_cvt_pk_bf16_f32 v77, v46, v47
  v_mfma_f32_16x16x32_bf16 v[112:115], v[20:23], a[4:7], v[112:115]
  ds_read_b128 v[12:15], v128 offset:4096
  v_mfma_f32_16x16x32_bf16 v[116:119], v[20:23], a[60:63], v[116:119]
  v_cvt_pk_bf16_f32 v78, v60, v61
  v_cvt_pk_bf16_f32 v79, v62, v63
  v_mfma_f32_16x16x32_bf16 v[120:123], v[20:23], a[116:119], v[120:123]
  s_add_u32 s43, s42, 14336
  v_mfma_f32_16x16x32_bf16 v[124:127], v[20:23], a[172:175], v[124:127]
  s_waitcnt lgkmcnt(4)
  buffer_store_dwordx4 v[76:79], v2, s[8:11], s43 offen sc1
  v_mfma_f32_16x16x32_bf16 v[96:99], v[24:27], a[8:11], v[96:99]
  ds_read_b128 v[16:19], v128 offset:18432
  v_mfma_f32_16x16x32_bf16 v[100:103], v[24:27], a[64:67], v[100:103]
  v_cvt_pk_bf16_f32 v80, v48, v49
  v_cvt_pk_bf16_f32 v81, v50, v51
  v_mfma_f32_16x16x32_bf16 v[104:107], v[24:27], a[120:123], v[104:107]
  v_cvt_pk_bf16_f32 v82, v64, v65
  v_cvt_pk_bf16_f32 v83, v66, v67
  v_mfma_f32_16x16x32_bf16 v[108:111], v[24:27], a[176:179], v[108:111]
  s_waitcnt lgkmcnt(4)
  s_add_u32 s43, s42, 458752
  v_mfma_f32_16x16x32_bf16 v[112:115], v[28:31], a[8:11], v[112:115]
  ds_read_b128 v[20:23], v128 offset:5120
  v_mfma_f32_16x16x32_bf16 v[116:119], v[28:31], a[64:67], v[116:119]
  buffer_store_dwordx4 v[80:83], v2, s[8:11], s43 offen sc1
  v_cvt_pk_bf16_f32 v84, v52, v53
  v_mfma_f32_16x16x32_bf16 v[120:123], v[28:31], a[120:123], v[120:123]
  v_cvt_pk_bf16_f32 v85, v54, v55
  v_cvt_pk_bf16_f32 v86, v68, v69
  v_mfma_f32_16x16x32_bf16 v[124:127], v[28:31], a[176:179], v[124:127]
  s_waitcnt lgkmcnt(4)
  v_cvt_pk_bf16_f32 v87, v70, v71
  v_mfma_f32_16x16x32_bf16 v[96:99], v[32:35], a[12:15], v[96:99]
  ds_read_b128 v[24:27], v128 offset:19456
  v_mfma_f32_16x16x32_bf16 v[100:103], v[32:35], a[68:71], v[100:103]
  s_add_u32 s43, s42, 473088
  v_mfma_f32_16x16x32_bf16 v[104:107], v[32:35], a[124:127], v[104:107]
  buffer_store_dwordx4 v[84:87], v2, s[8:11], s43 offen sc1
  v_mfma_f32_16x16x32_bf16 v[108:111], v[32:35], a[180:183], v[108:111]
  s_waitcnt lgkmcnt(4)
  s_add_u32 s30, s19, 2
  s_lshr_b32 s24, s30, 1
  s_lshl_b32 s24, s24, 2
  s_and_b32 s25, s30, 1
  s_add_u32 s24, s24, s25
  s_mul_i32 s24, s24, 14336
  v_mfma_f32_16x16x32_bf16 v[112:115], v[8:11], a[12:15], v[112:115]
  ds_read_b128 v[28:31], v128 offset:6144
  v_mfma_f32_16x16x32_bf16 v[116:119], v[8:11], a[68:71], v[116:119]
  s_add_u32 s24, s24, s23
  s_cmp_lt_u32 s30, s35
  s_cselect_b32 s24, s24, 0x40000000
  v_mfma_f32_16x16x32_bf16 v[120:123], v[8:11], a[124:127], v[120:123]
  s_add_u32 m0, s33, s27
  s_nop 0
  buffer_load_dwordx4 v2, s[8:11], s24 offen offset:0 sc1 lds
  v_mfma_f32_16x16x32_bf16 v[124:127], v[8:11], a[180:183], v[124:127]
  s_waitcnt lgkmcnt(4)
  v_mfma_f32_16x16x32_bf16 v[96:99], v[12:15], a[16:19], v[96:99]
  ds_read_b128 v[32:35], v128 offset:20480
  v_mfma_f32_16x16x32_bf16 v[100:103], v[12:15], a[72:75], v[100:103]
  v_mfma_f32_16x16x32_bf16 v[104:107], v[12:15], a[128:131], v[104:107]
  v_mfma_f32_16x16x32_bf16 v[108:111], v[12:15], a[184:187], v[108:111]
  s_waitcnt lgkmcnt(4)
  buffer_load_dwordx4 v2, s[8:11], s24 offen offset:1024 sc1 lds
  v_mfma_f32_16x16x32_bf16 v[112:115], v[16:19], a[16:19], v[112:115]
  ds_read_b128 v[8:11], v128 offset:7168
  v_mfma_f32_16x16x32_bf16 v[116:119], v[16:19], a[72:75], v[116:119]
  v_mfma_f32_16x16x32_bf16 v[120:123], v[16:19], a[128:131], v[120:123]
  v_mfma_f32_16x16x32_bf16 v[124:127], v[16:19], a[184:187], v[124:127]
  s_waitcnt lgkmcnt(4)
  v_mfma_f32_16x16x32_bf16 v[96:99], v[20:23], a[20:23], v[96:99]
  ds_read_b128 v[12:15], v128 offset:21504
  v_mfma_f32_16x16x32_bf16 v[100:103], v[20:23], a[76:79], v[100:103]
  buffer_load_dwordx4 v2, s[8:11], s24 offen offset:2048 sc1 lds
  v_mfma_f32_16x16x32_bf16 v[104:107], v[20:23], a[132:135], v[104:107]
  v_mfma_f32_16x16x32_bf16 v[108:111], v[20:23], a[188:191], v[108:111]
  s_waitcnt lgkmcnt(4)
  v_mfma_f32_16x16x32_bf16 v[112:115], v[24:27], a[20:23], v[112:115]
  ds_read_b128 v[16:19], v128 offset:8192
  v_mfma_f32_16x16x32_bf16 v[116:119], v[24:27], a[76:79], v[116:119]
  v_mfma_f32_16x16x32_bf16 v[120:123], v[24:27], a[132:135], v[120:123]
  buffer_load_dwordx4 v2, s[8:11], s24 offen offset:3072 sc1 lds
  v_mfma_f32_16x16x32_bf16 v[124:127], v[24:27], a[188:191], v[124:127]
  s_waitcnt lgkmcnt(4)
  v_mfma_f32_16x16x32_bf16 v[96:99], v[28:31], a[24:27], v[96:99]
  ds_read_b128 v[20:23], v128 offset:22528
  v_mfma_f32_16x16x32_bf16 v[100:103], v[28:31], a[80:83], v[100:103]
  v_mfma_f32_16x16x32_bf16 v[104:107], v[28:31], a[136:139], v[104:107]
  v_mfma_f32_16x16x32_bf16 v[108:111], v[28:31], a[192:195], v[108:111]
  s_waitcnt lgkmcnt(4)
  s_add_u32 m0, m0, 4096
  s_add_u32 s24, s24, 4096
  buffer_load_dwordx4 v2, s[8:11], s24 offen offset:0 sc1 lds
  v_mfma_f32_16x16x32_bf16 v[112:115], v[32:35], a[24:27], v[112:115]
  ds_read_b128 v[24:27], v128 offset:9216
  v_mfma_f32_16x16x32_bf16 v[116:119], v[32:35], a[80:83], v[116:119]
  v_mfma_f32_16x16x32_bf16 v[120:123], v[32:35], a[136:139], v[120:123]
  v_mfma_f32_16x16x32_bf16 v[124:127], v[32:35], a[192:195], v[124:127]
  s_waitcnt lgkmcnt(4)
  v_mfma_f32_16x16x32_bf16 v[96:99], v[8:11], a[28:31], v[96:99]
  ds_read_b128 v[28:31], v128 offset:23552
  v_mfma_f32_16x16x32_bf16 v[100:103], v[8:11], a[84:87], v[100:103]
  buffer_load_dwordx4 v2, s[8:11], s24 offen offset:1024 sc1 lds
  v_mfma_f32_16x16x32_bf16 v[104:107], v[8:11], a[140:143], v[104:107]
  v_mfma_f32_16x16x32_bf16 v[108:111], v[8:11], a[196:199], v[108:111]
  s_waitcnt lgkmcnt(4)
  v_mfma_f32_16x16x32_bf16 v[112:115], v[12:15], a[28:31], v[112:115]
  ds_read_b128 v[32:35], v128 offset:10240
  v_mfma_f32_16x16x32_bf16 v[116:119], v[12:15], a[84:87], v[116:119]
  v_mfma_f32_16x16x32_bf16 v[120:123], v[12:15], a[140:143], v[120:123]
  buffer_load_dwordx4 v2, s[8:11], s24 offen offset:2048 sc1 lds
  v_mfma_f32_16x16x32_bf16 v[124:127], v[12:15], a[196:199], v[124:127]
  s_waitcnt lgkmcnt(4)
  v_mfma_f32_16x16x32_bf16 v[96:99], v[16:19], a[32:35], v[96:99]
  ds_read_b128 v[8:11], v128 offset:24576
  v_mfma_f32_16x16x32_bf16 v[100:103], v[16:19], a[88:91], v[100:103]
  v_mfma_f32_16x16x32_bf16 v[104:107], v[16:19], a[144:147], v[104:107]
  v_mfma_f32_16x16x32_bf16 v[108:111], v[16:19], a[200:203], v[108:111]
  s_waitcnt lgkmcnt(4)
  s_add_u32 s33, s33, 28672
  s_cmp_eq_u32 s33, 114688
  s_cselect_b32 s33, 0, s33
  v_mfma_f32_16x16x32_bf16 v[112:115], v[20:23], a[32:35], v[112:115]
  ds_read_b128 v[12:15], v128 offset:11264
  v_mfma_f32_16x16x32_bf16 v[116:119], v[20:23], a[88:91], v[116:119]
  s_add_u32 s32, s32, 28672
  s_cmp_eq_u32 s32, 114688
  s_cselect_b32 s32, 0, s32
  v_mfma_f32_16x16x32_bf16 v[120:123], v[20:23], a[144:147], v[120:123]
  v_add_u32 v5, s32, v2
  v_mfma_f32_16x16x32_bf16 v[124:127], v[20:23], a[200:203], v[124:127]
  s_waitcnt lgkmcnt(4)
  v_mfma_f32_16x16x32_bf16 v[96:99], v[24:27], a[36:39], v[96:99]
  ds_read_b128 v[16:19], v128 offset:25600
  v_mfma_f32_16x16x32_bf16 v[100:103], v[24:27], a[92:95], v[100:103]
  v_mfma_f32_16x16x32_bf16 v[104:107], v[24:27], a[148:151], v[104:107]
  v_mfma_f32_16x16x32_bf16 v[108:111], v[24:27], a[204:207], v[108:111]
  s_waitcnt lgkmcnt(4)
  v_mfma_f32_16x16x32_bf16 v[112:115], v[28:31], a[36:39], v[112:115]
  ds_read_b128 v[20:23], v128 offset:12288
  v_mfma_f32_16x16x32_bf16 v[116:119], v[28:31], a[92:95], v[116:119]
  v_mfma_f32_16x16x32_bf16 v[120:123], v[28:31], a[148:151], v[120:123]
  v_mfma_f32_16x16x32_bf16 v[124:127], v[28:31], a[204:207], v[124:127]
  s_waitcnt lgkmcnt(4)
  v_mfma_f32_16x16x32_bf16 v[96:99], v[32:35], a[40:43], v[96:99]
  ds_read_b128 v[24:27], v128 offset:26624
  v_mfma_f32_16x16x32_bf16 v[100:103], v[32:35], a[96:99], v[100:103]
  v_mfma_f32_16x16x32_bf16 v[104:107], v[32:35], a[152:155], v[104:107]
  v_mfma_f32_16x16x32_bf16 v[108:111], v[32:35], a[208:211], v[108:111]
  s_waitcnt lgkmcnt(4)
  v_mfma_f32_16x16x32_bf16 v[112:115], v[8:11], a[40:43], v[112:115]
  ds_read_b128 v[28:31], v128 offset:13312
  v_mfma_f32_16x16x32_bf16 v[116:119], v[8:11], a[96:99], v[116:119]
  v_mfma_f32_16x16x32_bf16 v[120:123], v[8:11], a[152:155], v[120:123]
  v_mfma_f32_16x16x32_bf16 v[124:127], v[8:11], a[208:211], v[124:127]
  s_waitcnt lgkmcnt(4)
  v_mfma_f32_16x16x32_bf16 v[96:99], v[12:15], a[44:47], v[96:99]
  ds_read_b128 v[32:35], v128 offset:27648
  v_mfma_f32_16x16x32_bf16 v[100:103], v[12:15], a[100:103], v[100:103]
  v_mfma_f32_16x16x32_bf16 v[104:107], v[12:15], a[156:159], v[104:107]
  v_mfma_f32_16x16x32_bf16 v[108:111], v[12:15], a[212:215], v[108:111]
  s_waitcnt lgkmcnt(4)
  v_mfma_f32_16x16x32_bf16 v[112:115], v[16:19], a[44:47], v[112:115]
  s_waitcnt vmcnt(11)
  s_barrier
  ds_read_b128 v[8:11], v5 offset:0
  v_mfma_f32_16x16x32_bf16 v[116:119], v[16:19], a[100:103], v[116:119]
  v_mfma_f32_16x16x32_bf16 v[120:123], v[16:19], a[156:159], v[120:123]
  v_mfma_f32_16x16x32_bf16 v[124:127], v[16:19], a[212:215], v[124:127]
  s_waitcnt lgkmcnt(4)
  v_mfma_f32_16x16x32_bf16 v[96:99], v[20:23], a[48:51], v[96:99]
  ds_read_b128 v[12:15], v5 offset:14336
  v_mfma_f32_16x16x32_bf16 v[100:103], v[20:23], a[104:107], v[100:103]
  v_mfma_f32_16x16x32_bf16 v[104:107], v[20:23], a[160:163], v[104:107]
  v_mfma_f32_16x16x32_bf16 v[108:111], v[20:23], a[216:219], v[108:111]
  s_waitcnt lgkmcnt(4)
  v_mfma_f32_16x16x32_bf16 v[112:115], v[24:27], a[48:51], v[112:115]
  ds_read_b128 v[16:19], v5 offset:1024
  v_mfma_f32_16x16x32_bf16 v[116:119], v[24:27], a[104:107], v[116:119]
  v_mfma_f32_16x16x32_bf16 v[120:123], v[24:27], a[160:163], v[120:123]
  v_mfma_f32_16x16x32_bf16 v[124:127], v[24:27], a[216:219], v[124:127]
  s_waitcnt lgkmcnt(4)
  v_mfma_f32_16x16x32_bf16 v[96:99], v[28:31], a[52:55], v[96:99]
  ds_read_b128 v[20:23], v5 offset:15360
  v_mfma_f32_16x16x32_bf16 v[100:103], v[28:31], a[108:111], v[100:103]
  v_mfma_f32_16x16x32_bf16 v[104:107], v[28:31], a[164:167], v[104:107]
  v_mfma_f32_16x16x32_bf16 v[108:111], v[28:31], a[220:223], v[108:111]
  s_waitcnt lgkmcnt(4)
  v_mfma_f32_16x16x32_bf16 v[112:115], v[32:35], a[52:55], v[112:115]
  ds_read_b128 v[24:27], v5 offset:2048
  v_mfma_f32_16x16x32_bf16 v[116:119], v[32:35], a[108:111], v[116:119]
  v_mfma_f32_16x16x32_bf16 v[120:123], v[32:35], a[164:167], v[120:123]
  v_mfma_f32_16x16x32_bf16 v[124:127], v[32:35], a[220:223], v[124:127]
  s_waitcnt lgkmcnt(4)
  s_mov_b32 s40, s19
  s_mov_b32 s41, s29
  s_add_u32 s19, s19, 1
  s_cmp_lt_u32 s19, s35
  s_cbranch_scc1 wg_f_loop
  s_nop 3
  s_lshl_b32 s42, s40, 10
  s_add_u32 s42, s42, s41
  v_cvt_pk_bf16_f32 v72, v96, v97
  v_cvt_pk_bf16_f32 v73, v98, v99
  v_cvt_pk_bf16_f32 v74, v112, v113
  v_cvt_pk_bf16_f32 v75, v114, v115
  s_add_u32 s43, s42, 0
  buffer_store_dwordx4 v[72:75], v2, s[8:11], s43 offen sc1
  v_cvt_pk_bf16_f32 v76, v100, v101
  v_cvt_pk_bf16_f32 v77, v102, v103
  v_cvt_pk_bf16_f32 v78, v116, v117
  v_cvt_pk_bf16_f32 v79, v118, v119
  s_add_u32 s43, s42, 14336
  buffer_store_dwordx4 v[76:79], v2, s[8:11], s43 offen sc1
  v_cvt_pk_bf16_f32 v80, v104, v105
  v_cvt_pk_bf16_f32 v81, v106, v107
  v_cvt_pk_bf16_f32 v82, v120, v121
  v_cvt_pk_bf16_f32 v83, v122, v123
  s_add_u32 s43, s42, 458752
  buffer_store_dwordx4 v[80:83], v2, s[8:11], s43 offen sc1
  v_cvt_pk_bf16_f32 v84, v108, v109
  v_cvt_pk_bf16_f32 v85, v110, v111
  v_cvt_pk_bf16_f32 v86, v124, v125
  v_cvt_pk_bf16_f32 v87, v126, v127
  s_add_u32 s43, s42, 473088
  buffer_store_dwordx4 v[84:87], v2, s[8:11], s43 offen sc1
  s_branch wg_done
wg_f_e0:
  s_nop 7
  s_lshl_b32 s42, s40, 10
  s_add_u32 s42, s42, s41
  v_cvt_pk_bf16_f32 v72, v40, v41
  v_cvt_pk_bf16_f32 v73, v42, v43
  v_cvt_pk_bf16_f32 v74, v56, v57
  v_cvt_pk_bf16_f32 v75, v58, v59
  s_add_u32 s43, s42, 0
  buffer_store_dwordx4 v[72:75], v2, s[8:11], s43 offen sc1
  v_cvt_pk_bf16_f32 v76, v44, v45
  v_cvt_pk_bf16_f32 v77, v46, v47
  v_cvt_pk_bf16_f32 v78, v60, v61
  v_cvt_pk_bf16_f32 v79, v62, v63
  s_add_u32 s43, s42, 14336
  buffer_store_dwordx4 v[76:79], v2, s[8:11], s43 offen sc1
  v_cvt_pk_bf16_f32 v80, v48, v49
  v_cvt_pk_bf16_f32 v81, v50, v51
  v_cvt_pk_bf16_f32 v82, v64, v65
  v_cvt_pk_bf16_f32 v83, v66, v67
  s_add_u32 s43, s42, 458752
  buffer_store_dwordx4 v[80:83], v2, s[8:11], s43 offen sc1
  v_cvt_pk_bf16_f32 v84, v52, v53
  v_cvt_pk_bf16_f32 v85, v54, v55
  v_cvt_pk_bf16_f32 v86, v68, v69
  v_cvt_pk_bf16_f32 v87, v70, v71
  s_add_u32 s43, s42, 473088
  buffer_store_dwordx4 v[84:87], v2, s[8:11], s43 offen sc1
  s_branch wg_done
wg_vo:
  s_sub_u32 s29, s17, 16
  s_mul_i32 s29, s29, 28672
  s_mul_i32 s24, s28, 458752
  s_add_u32 s29, s29, s24
  s_add_u32 s29, s29, 2490368
  v_lshlrev_b32 v6, 4, v3
  v_mul_u32_u24 v7, 12, v3
  v_add_u32 v7, 48, v7
  s_mov_b32 s31, 0
  s_lshl_b32 s24, s34, 1
  s_mul_i32 s24, s24, 14336
  s_add_u32 s24, s24, s23
  s_add_u32 m0, s31, s27
  s_nop 0
  buffer_load_dwordx4 v2, s[8:11], s24 offen offset:0 sc1 lds
  buffer_load_dwordx4 v2, s[8:11], s24 offen offset:1024 sc1 lds
  buffer_load_dwordx4 v2, s[8:11], s24 offen offset:2048 sc1 lds
  buffer_load_dwordx4 v2, s[8:11], s24 offen offset:3072 sc1 lds
  s_add_u32 m0, m0, 4096
  s_add_u32 s24, s24, 4096
  buffer_load_dwordx4 v2, s[8:11], s24 offen offset:0 sc1 lds
  buffer_load_dwordx4 v2, s[8:11], s24 offen offset:1024 sc1 lds
  buffer_load_dwordx4 v2, s[8:11], s24 offen offset:2048 sc1 lds
  s_sub_u32 s36, s35, 1
  s_add_u32 s30, s34, 1
  s_min_u32 s30, s30, s36
  s_mov_b32 s31, 28672
  s_lshl_b32 s24, s30, 1
  s_mul_i32 s24, s24, 14336
  s_add_u32 s24, s24, s23
  s_add_u32 m0, s31, s27
  s_nop 0
  buffer_load_dwordx4 v2, s[8:11], s24 offen offset:0 sc1 lds
  buffer_load_dwordx4 v2, s[8:11], s24 offen offset:1024 sc1 lds
  buffer_load_dwordx4 v2, s[8:11], s24 offen offset:2048 sc1 lds
  buffer_load_dwordx4 v2, s[8:11], s24 offen offset:3072 sc1 lds
  s_add_u32 m0, m0, 4096
  s_add_u32 s24, s24, 4096
  buffer_load_dwordx4 v2, s[8:11], s24 offen offset:0 sc1 lds
  buffer_load_dwordx4 v2, s[8:11], s24 offen offset:1024 sc1 lds
  buffer_load_dwordx4 v2, s[8:11], s24 offen offset:2048 sc1 lds
  s_mov_b32 s19, s34
  s_mov_b32 s32, 0
  s_mov_b32 s33, 57344
  s_cmp_eq_u32 s18, s101
  s_cbranch_scc1 wg_vo_hx
  s_add_u32 s22, s21, 0
  buffer_load_dwordx4 a[0:3], v2, s[8:11], s22 offen offset:0 sc1
  buffer_load_dwordx4 a[4:7], v2, s[8:11], s22 offen offset:1024 sc1
  buffer_load_dwordx4 a[8:11], v2, s[8:11], s22 offen offset:2048 sc1
  buffer_load_dwordx4 a[12:15], v2, s[8:11], s22 offen offset:3072 sc1
  s_add_u32 s22, s21, 4096
  buffer_load_dwordx4 a[16:19], v2, s[8:11], s22 offen offset:0 sc1
  buffer_load_dwordx4 a[20:23], v2, s[8:11], s22 offen offset:1024 sc1
  buffer_load_dwordx4 a[24:27], v2, s[8:11], s22 offen offset:2048 sc1
  buffer_load_dwordx4 a[28:31], v2, s[8:11], s22 offen offset:3072 sc1
  s_add_u32 s22, s21, 8192
  buffer_load_dwordx4 a[32:35], v2, s[8:11], s22 offen offset:0 sc1
  buffer_load_dwordx4 a[36:39], v2, s[8:11], s22 offen offset:1024 sc1
  buffer_load_dwordx4 a[40:43], v2, s[8:11], s22 offen offset:2048 sc1
  buffer_load_dwordx4 a[44:47], v2, s[8:11], s22 offen offset:3072 sc1
  s_add_u32 s22, s21, 12288
  buffer_load_dwordx4 a[48:51], v2, s[8:11], s22 offen offset:0 sc1
  buffer_load_dwordx4 a[52:55], v2, s[8:11], s22 offen offset:1024 sc1
  buffer_load_dwordx4 a[56:59], v2, s[8:11], s22 offen offset:2048 sc1
  buffer_load_dwordx4 a[60:63], v2, s[8:11], s22 offen offset:3072 sc1
  s_add_u32 s22, s21, 16384
  buffer_load_dwordx4 a[64:67], v2, s[8:11], s22 offen offset:0 sc1
  buffer_load_dwordx4 a[68:71], v2, s[8:11], s22 offen offset:1024 sc1
  buffer_load_dwordx4 a[72:75], v2, s[8:11], s22 offen offset:2048 sc1
  buffer_load_dwordx4 a[76:79], v2, s[8:11], s22 offen offset:3072 sc1
  s_add_u32 s22, s21, 20480
  buffer_load_dwordx4 a[80:83], v2, s[8:11], s22 offen offset:0 sc1
  buffer_load_dwordx4 a[84:87], v2, s[8:11], s22 offen offset:1024 sc1
  buffer_load_dwordx4 a[88:91], v2, s[8:11], s22 offen offset:2048 sc1
  buffer_load_dwordx4 a[92:95], v2, s[8:11], s22 offen offset:3072 sc1
  s_add_u32 s22, s21, 24576
  buffer_load_dwordx4 a[96:99], v2, s[8:11], s22 offen offset:0 sc1
  buffer_load_dwordx4 a[100:103], v2, s[8:11], s22 offen offset:1024 sc1
  buffer_load_dwordx4 a[104:107], v2, s[8:11], s22 offen offset:2048 sc1
  buffer_load_dwordx4 a[108:111], v2, s[8:11], s22 offen offset:3072 sc1
  s_add_u32 s22, s21, 28672
  buffer_load_dwordx4 a[112:115], v2, s[8:11], s22 offen offset:0 sc1
  buffer_load_dwordx4 a[116:119], v2, s[8:11], s22 offen offset:1024 sc1
  buffer_load_dwordx4 a[120:123], v2, s[8:11], s22 offen offset:2048 sc1
  buffer_load_dwordx4 a[124:127], v2, s[8:11], s22 offen offset:3072 sc1
  s_add_u32 s22, s21, 32768
  buffer_load_dwordx4 a[128:131], v2, s[8:11], s22 offen offset:0 sc1
  buffer_load_dwordx4 a[132:135], v2, s[8:11], s22 offen offset:1024 sc1
  buffer_load_dwordx4 a[136:139], v2, s[8:11], s22 offen offset:2048 sc1
  buffer_load_dwordx4 a[140:143], v2, s[8:11], s22 offen offset:3072 sc1
  s_add_u32 s22, s21, 36864
  buffer_load_dwordx4 a[144:147], v2, s[8:11], s22 offen offset:0 sc1
  buffer_load_dwordx4 a[148:151], v2, s[8:11], s22 offen offset:1024 sc1
  buffer_load_dwordx4 a[152:155], v2, s[8:11], s22 offen offset:2048 sc1
  buffer_load_dwordx4 a[156:159], v2, s[8:11], s22 offen offset:3072 sc1
  s_add_u32 s22, s21, 40960
  s_waitcnt vmcnt(40)
  buffer_load_dwordx4 a[160:163], v2, s[8:11], s22 offen offset:0 sc1
  buffer_load_dwordx4 a[164:167], v2, s[8:11], s22 offen offset:1024 sc1
  buffer_load_dwordx4 a[168:171], v2, s[8:11], s22 offen offset:2048 sc1
  buffer_load_dwordx4 a[172:175], v2, s[8:11], s22 offen offset:3072 sc1
  s_add_u32 s22, s21, 45056
  buffer_load_dwordx4 a[176:179], v2, s[8:11], s22 offen offset:0 sc1
  buffer_load_dwordx4 a[180:183], v2, s[8:11], s22 offen offset:1024 sc1
  buffer_load_dwordx4 a[184:187], v2, s[8:11], s22 offen offset:2048 sc1
  buffer_load_dwordx4 a[188:191], v2, s[8:11], s22 offen offset:3072 sc1
  s_add_u32 s22, s21, 49152
  buffer_load_dwordx4 a[192:195], v2, s[8:11], s22 offen offset:0 sc1
  buffer_load_dwordx4 a[196:199], v2, s[8:11], s22 offen offset:1024 sc1
  buffer_load_dwordx4 a[200:203], v2, s[8:11], s22 offen offset:2048 sc1
  buffer_load_dwordx4 a[204:207], v2, s[8:11], s22 offen offset:3072 sc1
  s_add_u32 s22, s21, 53248
  buffer_load_dwordx4 a[208:211], v2, s[8:11], s22 offen offset:0 sc1
  buffer_load_dwordx4 a[212:215], v2, s[8:11], s22 offen offset:1024 sc1
  buffer_load_dwordx4 a[216:219], v2, s[8:11], s22 offen offset:2048 sc1
  buffer_load_dwordx4 a[220:223], v2, s[8:11], s22 offen offset:3072 sc1
wg_vo_hx:
  s_mov_b32 s101, -1
  s_waitcnt vmcnt(0)
  s_barrier
  s_mov_b32 s40, 0
  s_mov_b32 s41, 0x40000000
  v_mov_b32 v5, v2
  ds_read_b128 v[8:11], v5 offset:0
  ds_read_b128 v[12:15], v5 offset:14336
  ds_read_b128 v[16:19], v5 offset:1024
  ds_read_b128 v[20:23], v5 offset:15360
  ds_read_b128 v[24:27], v5 offset:2048
  s_waitcnt lgkmcnt(4)
.p2align 6
wg_vo_loop:
  v_mfma_f32_16x16x32_bf16 v[40:43], a[0:3], v[8:11], 0
  ds_read_b128 v[28:31], v5 offset:16384
  v_mfma_f32_16x16x32_bf16 v[44:47], a[56:59], v[8:11], 0
  v_mfma_f32_16x16x32_bf16 v[48:51], a[112:115], v[8:11], 0
  v_mfma_f32_16x16x32_bf16 v[52:55], a[168:171], v[8:11], 0
  s_waitcnt lgkmcnt(4)
  s_add_u32 s43, s41, 458752
  v_mfma_f32_16x16x32_bf16 v[56:59], a[0:3], v[12:15], 0
  ds_read_b128 v[32:35], v5 offset:3072
  v_mfma_f32_16x16x32_bf16 v[60:63], a[56:59], v[12:15], 0
  s_lshl_b32 s42, s40, 5
  s_add_u32 s42, s42, 0
  v_mfma_f32_16x16x32_bf16 v[64:67], a[112:115], v[12:15], 0
  v_add_u32 v88, s42, v4
  v_mul_u32_u24 v89, 2341, v88
  v_mfma_f32_16x16x32_bf16 v[68:71], a[168:171], v[12:15], 0
  s_waitcnt lgkmcnt(4)
  v_lshrrev_b32 v89, 16, v89
  v_mfma_f32_16x16x32_bf16 v[40:43], a[4:7], v[16:19], v[40:43]
  ds_read_b128 v[8:11], v5 offset:17408
  v_mfma_f32_16x16x32_bf16 v[44:47], a[60:63], v[16:19], v[44:47]
  v_mul_u32_u24 v92, 28, v89
  v_sub_u32 v92, v88, v92
  v_mfma_f32_16x16x32_bf16 v[48:51], a[116:119], v[16:19], v[48:51]
  v_cmp_gt_u32 vcc, 16, v92
  v_mul_u32_u24 v89, 84, v89
  v_mfma_f32_16x16x32_bf16 v[52:55], a[172:175], v[16:19], v[52:55]
  s_waitcnt lgkmcnt(4)
  v_cndmask_b32 v92, v7, v6, vcc
  v_mfma_f32_16x16x32_bf16 v[56:59], a[4:7], v[20:23], v[56:59]
  ds_read_b128 v[12:15], v5 offset:4096
  v_mfma_f32_16x16x32_bf16 v[60:63], a[60:63], v[20:23], v[60:63]
  v_add3_u32 v88, v88, v89, v92
  v_lshlrev_b32 v90, 4, v88
  v_mfma_f32_16x16x32_bf16 v[64:67], a[116:119], v[20:23], v[64:67]
  v_cvt_pk_bf16_f32 v72, v96, v100
  v_cvt_pk_bf16_f32 v73, v97, v101
  v_mfma_f32_16x16x32_bf16 v[68:71], a[172:175], v[20:23], v[68:71]
  s_waitcnt lgkmcnt(4)
  v_cvt_pk_bf16_f32 v74, v98, v102
  v_mfma_f32_16x16x32_bf16 v[40:43], a[8:11], v[24:27], v[40:43]
  ds_read_b128 v[16:19], v5 offset:18432
  v_mfma_f32_16x16x32_bf16 v[44:47], a[64:67], v[24:27], v[44:47]
  v_cvt_pk_bf16_f32 v75, v99, v103
  v_mfma_f32_16x16x32_bf16 v[48:51], a[120:123], v[24:27], v[48:51]
  buffer_store_dwordx4 v[72:75], v90, s[8:11], s41 offen sc1
  v_cvt_pk_bf16_f32 v76, v104, v108
  v_mfma_f32_16x16x32_bf16 v[52:55], a[176:179], v[24:27], v[52:55]
  s_waitcnt lgkmcnt(4)
  v_cvt_pk_bf16_f32 v77, v105, v109
  v_mfma_f32_16x16x32_bf16 v[56:59], a[8:11], v[28:31], v[56:59]
  ds_read_b128 v[20:23], v5 offset:5120
  v_mfma_f32_16x16x32_bf16 v[60:63], a[64:67], v[28:31], v[60:63]
  v_cvt_pk_bf16_f32 v78, v106, v110
  v_cvt_pk_bf16_f32 v79, v107, v111
  v_mfma_f32_16x16x32_bf16 v[64:67], a[120:123], v[28:31], v[64:67]
  buffer_store_dwordx4 v[76:79], v90, s[8:11], s43 offen sc1
  s_lshl_b32 s42, s40, 5
  v_mfma_f32_16x16x32_bf16 v[68:71], a[176:179], v[28:31], v[68:71]
  s_waitcnt lgkmcnt(4)
  s_add_u32 s42, s42, 16
  v_mfma_f32_16x16x32_bf16 v[40:43], a[12:15], v[32:35], v[40:43]
  ds_read_b128 v[24:27], v5 offset:19456
  v_mfma_f32_16x16x32_bf16 v[44:47], a[68:71], v[32:35], v[44:47]
  v_add_u32 v88, s42, v4
  v_mul_u32_u24 v89, 2341, v88
  v_mfma_f32_16x16x32_bf16 v[48:51], a[124:127], v[32:35], v[48:51]
  v_lshrrev_b32 v89, 16, v89
  v_mul_u32_u24 v92, 28, v89
  v_mfma_f32_16x16x32_bf16 v[52:55], a[180:183], v[32:35], v[52:55]
  s_waitcnt lgkmcnt(4)
  v_sub_u32 v92, v88, v92
  v_mfma_f32_16x16x32_bf16 v[56:59], a[12:15], v[8:11], v[56:59]
  ds_read_b128 v[28:31], v5 offset:6144
  v_mfma_f32_16x16x32_bf16 v[60:63], a[68:71], v[8:11], v[60:63]
  v_cmp_gt_u32 vcc, 16, v92
  v_mul_u32_u24 v89, 84, v89
  v_mfma_f32_16x16x32_bf16 v[64:67], a[124:127], v[8:11], v[64:67]
  v_cndmask_b32 v92, v7, v6, vcc
  v_add3_u32 v88, v88, v89, v92
  v_mfma_f32_16x16x32_bf16 v[68:71], a[180:183], v[8:11], v[68:71]
  s_waitcnt lgkmcnt(4)
  v_lshlrev_b32 v91, 4, v88
  v_mfma_f32_16x16x32_bf16 v[40:43], a[16:19], v[12:15], v[40:43]
  ds_read_b128 v[32:35], v5 offset:20480
  v_mfma_f32_16x16x32_bf16 v[44:47], a[72:75], v[12:15], v[44:47]
  v_cvt_pk_bf16_f32 v80, v112, v116
  v_cvt_pk_bf16_f32 v81, v113, v117
  v_mfma_f32_16x16x32_bf16 v[48:51], a[128:131], v[12:15], v[48:51]
  v_cvt_pk_bf16_f32 v82, v114, v118
  v_cvt_pk_bf16_f32 v83, v115, v119
  v_mfma_f32_16x16x32_bf16 v[52:55], a[184:187], v[12:15], v[52:55]
  s_waitcnt lgkmcnt(4)
  buffer_store_dwordx4 v[80:83], v91, s[8:11], s41 offen sc1
  v_mfma_f32_16x16x32_bf16 v[56:59], a[16:19], v[16:19], v[56:59]
  ds_read_b128 v[8:11], v5 offset:7168
  v_mfma_f32_16x16x32_bf16 v[60:63], a[72:75], v[16:19], v[60:63]
  v_cvt_pk_bf16_f32 v84, v120, v124
  v_cvt_pk_bf16_f32 v85, v121, v125
  v_mfma_f32_16x16x32_bf16 v[64:67], a[128:131], v[16:19], v[64:67]
  v_cvt_pk_bf16_f32 v86, v122, v126
  v_cvt_pk_bf16_f32 v87, v123, v127
  v_mfma_f32_16x16x32_bf16 v[68:71], a[184:187], v[16:19], v[68:71]
  s_waitcnt lgkmcnt(4)
  buffer_store_dwordx4 v[84:87], v91, s[8:11], s43 offen sc1
  v_mfma_f32_16x16x32_bf16 v[40:43], a[20:23], v[20:23], v[40:43]
  ds_read_b128 v[12:15], v5 offset:21504
  v_mfma_f32_16x16x32_bf16 v[44:47], a[76:79], v[20:23], v[44:47]
  s_add_u32 s30, s19, 2
  s_lshl_b32 s24, s30, 1
  s_mul_i32 s24, s24, 14336
  v_mfma_f32_16x16x32_bf16 v[48:51], a[132:135], v[20:23], v[48:51]
  s_add_u32 s24, s24, s23
  s_cmp_lt_u32 s30, s35
  s_cselect_b32 s24, s24, 0x40000000
  v_mfma_f32_16x16x32_bf16 v[52:55], a[188:191], v[20:23], v[52:55]
  s_waitcnt lgkmcnt(4)
  s_add_u32 m0, s33, s27
  s_nop 0
  buffer_load_dwordx4 v2, s[8:11], s24 offen offset:0 sc1 lds
  v_mfma_f32_16x16x32_bf16 v[56:59], a[20:23], v[24:27], v[56:59]
  ds_read_b128 v[16:19], v5 offset:8192
  v_mfma_f32_16x16x32_bf16 v[60:63], a[76:79], v[24:27], v[60:63]
  v_mfma_f32_16x16x32_bf16 v[64:67], a[132:135], v[24:27], v[64:67]
  v_mfma_f32_16x16x32_bf16 v[68:71], a[188:191], v[24:27], v[68:71]
  s_waitcnt lgkmcnt(4)
  v_mfma_f32_16x16x32_bf16 v[40:43], a[24:27], v[28:31], v[40:43]
  ds_read_b128 v[20:23], v5 offset:22528
  v_mfma_f32_16x16x32_bf16 v[44:47], a[80:83], v[28:31], v[44:47]
  buffer_load_dwordx4 v2, s[8:11], s24 offen offset:1024 sc1 lds
  v_mfma_f32_16x16x32_bf16 v[48:51], a[136:139], v[28:31], v[48:51]
  v_mfma_f32_16x16x32_bf16 v[52:55], a[192:195], v[28:31], v[52:55]
  s_waitcnt lgkmcnt(4)
  v_mfma_f32_16x16x32_bf16 v[56:59], a[24:27], v[32:35], v[56:59]
  ds_read_b128 v[24:27], v5 offset:9216
  v_mfma_f32_16x16x32_bf16 v[60:63], a[80:83], v[32:35], v[60:63]
  v_mfma_f32_16x16x32_bf16 v[64:67], a[136:139], v[32:35], v[64:67]
  buffer_load_dwordx4 v2, s[8:11], s24 offen offset:2048 sc1 lds
  v_mfma_f32_16x16x32_bf16 v[68:71], a[192:195], v[32:35], v[68:71]
  s_waitcnt lgkmcnt(4)
  v_mfma_f32_16x16x32_bf16 v[40:43], a[28:31], v[8:11], v[40:43]
  ds_read_b128 v[28:31], v5 offset:23552
  v_mfma_f32_16x16x32_bf16 v[44:47], a[84:87], v[8:11], v[44:47]
  v_mfma_f32_16x16x32_bf16 v[48:51], a[140:143], v[8:11], v[48:51]
  v_mfma_f32_16x16x32_bf16 v[52:55], a[196:199], v[8:11], v[52:55]
  s_waitcnt lgkmcnt(4)
  buffer_load_dwordx4 v2, s[8:11], s24 offen offset:3072 sc1 lds
  v_mfma_f32_16x16x32_bf16 v[56:59], a[28:31], v[12:15], v[56:59]
  ds_read_b128 v[32:35], v5 offset:10240
  v_mfma_f32_16x16x32_bf16 v[60:63], a[84:87], v[12:15], v[60:63]
  v_mfma_f32_16x16x32_bf16 v[64:67], a[140:143], v[12:15], v[64:67]
  v_mfma_f32_16x16x32_bf16 v[68:71], a[196:199], v[12:15], v[68:71]
  s_waitcnt lgkmcnt(4)
  v_mfma_f32_16x16x32_bf16 v[40:43], a[32:35], v[16:19], v[40:43]
  ds_read_b128 v[8:11], v5 offset:24576
  v_mfma_f32_16x16x32_bf16 v[44:47], a[88:91], v[16:19], v[44:47]
  s_add_u32 m0, m0, 4096
  s_add_u32 s24, s24, 4096
  buffer_load_dwordx4 v2, s[8:11], s24 offen offset:0 sc1 lds
  v_mfma_f32_16x16x32_bf16 v[48:51], a[144:147], v[16:19], v[48:51]
  v_mfma_f32_16x16x32_bf16 v[52:55], a[200:203], v[16:19], v[52:55]
  s_waitcnt lgkmcnt(4)
  v_mfma_f32_16x16x32_bf16 v[56:59], a[32:35], v[20:23], v[56:59]
  ds_read_b128 v[12:15], v5 offset:11264
  v_mfma_f32_16x16x32_bf16 v[60:63], a[88:91], v[20:23], v[60:63]
  v_mfma_f32_16x16x32_bf16 v[64:67], a[144:147], v[20:23], v[64:67]
  buffer_load_dwordx4 v2, s[8:11], s24 offen offset:1024 sc1 lds
  v_mfma_f32_16x16x32_bf16 v[68:71], a[200:203], v[20:23], v[68:71]
  s_waitcnt lgkmcnt(4)
  v_mfma_f32_16x16x32_bf16 v[40:43], a[36:39], v[24:27], v[40:43]
  ds_read_b128 v[16:19], v5 offset:25600
  v_mfma_f32_16x16x32_bf16 v[44:47], a[92:95], v[24:27], v[44:47]
  v_mfma_f32_16x16x32_bf16 v[48:51], a[148:151], v[24:27], v[48:51]
  v_mfma_f32_16x16x32_bf16 v[52:55], a[204:207], v[24:27], v[52:55]
  s_waitcnt lgkmcnt(4)
  buffer_load_dwordx4 v2, s[8:11], s24 offen offset:2048 sc1 lds
  v_mfma_f32_16x16x32_bf16 v[56:59], a[36:39], v[28:31], v[56:59]
  ds_read_b128 v[20:23], v5 offset:12288
  v_mfma_f32_16x16x32_bf16 v[60:63], a[92:95], v[28:31], v[60:63]
  v_mfma_f32_16x16x32_bf16 v[64:67], a[148:151], v[28:31], v[64:67]
  v_mfma_f32_16x16x32_bf16 v[68:71], a[204:207], v[28:31], v[68:71]
  s_waitcnt lgkmcnt(4)
  v_mfma_f32_16x16x32_bf16 v[40:43], a[40:43], v[32:35], v[40:43]
  ds_read_b128 v[24:27], v5 offset:26624
  v_mfma_f32_16x16x32_bf16 v[44:47], a[96:99], v[32:35], v[44:47]
  s_add_u32 s33, s33, 28672
  s_cmp_eq_u32 s33, 114688
  s_cselect_b32 s33, 0, s33
  v_mfma_f32_16x16x32_bf16 v[48:51], a[152:155], v[32:35], v[48:51]
  s_add_u32 s32, s32, 28672
  s_cmp_eq_u32 s32, 114688
  s_cselect_b32 s32, 0, s32
  v_mfma_f32_16x16x32_bf16 v[52:55], a[208:211], v[32:35], v[52:55]
  s_waitcnt lgkmcnt(4)
  v_add_u32 v128, s32, v2
  v_mfma_f32_16x16x32_bf16 v[56:59], a[40:43], v[8:11], v[56:59]
  ds_read_b128 v[28:31], v5 offset:13312
  v_mfma_f32_16x16x32_bf16 v[60:63], a[96:99], v[8:11], v[60:63]
  v_mfma_f32_16x16x32_bf16 v[64:67], a[152:155], v[8:11], v[64:67]
  v_mfma_f32_16x16x32_bf16 v[68:71], a[208:211], v[8:11], v[68:71]
  s_waitcnt lgkmcnt(4)
  v_mfma_f32_16x16x32_bf16 v[40:43], a[44:47], v[12:15], v[40:43]
  ds_read_b128 v[32:35], v5 offset:27648
  v_mfma_f32_16x16x32_bf16 v[44:47], a[100:103], v[12:15], v[44:47]
  v_mfma_f32_16x16x32_bf16 v[48:51], a[156:159], v[12:15], v[48:51]
  v_mfma_f32_16x16x32_bf16 v[52:55], a[212:215], v[12:15], v[52:55]
  s_waitcnt lgkmcnt(4)
  v_mfma_f32_16x16x32_bf16 v[56:59], a[44:47], v[16:19], v[56:59]
  s_waitcnt vmcnt(11)
  s_barrier
  ds_read_b128 v[8:11], v128 offset:0
  v_mfma_f32_16x16x32_bf16 v[60:63], a[100:103], v[16:19], v[60:63]
  v_mfma_f32_16x16x32_bf16 v[64:67], a[156:159], v[16:19], v[64:67]
  v_mfma_f32_16x16x32_bf16 v[68:71], a[212:215], v[16:19], v[68:71]
  s_waitcnt lgkmcnt(4)
  v_mfma_f32_16x16x32_bf16 v[40:43], a[48:51], v[20:23], v[40:43]
  ds_read_b128 v[12:15], v128 offset:14336
  v_mfma_f32_16x16x32_bf16 v[44:47], a[104:107], v[20:23], v[44:47]
  v_mfma_f32_16x16x32_bf16 v[48:51], a[160:163], v[20:23], v[48:51]
  v_mfma_f32_16x16x32_bf16 v[52:55], a[216:219], v[20:23], v[52:55]
  s_waitcnt lgkmcnt(4)
  v_mfma_f32_16x16x32_bf16 v[56:59], a[48:51], v[24:27], v[56:59]
  ds_read_b128 v[16:19], v128 offset:1024
  v_mfma_f32_16x16x32_bf16 v[60:63], a[104:107], v[24:27], v[60:63]
  v_mfma_f32_16x16x32_bf16 v[64:67], a[160:163], v[24:27], v[64:67]
  v_mfma_f32_16x16x32_bf16 v[68:71], a[216:219], v[24:27], v[68:71]
  s_waitcnt lgkmcnt(4)
  v_mfma_f32_16x16x32_bf16 v[40:43], a[52:55], v[28:31], v[40:43]
  ds_read_b128 v[20:23], v128 offset:15360
  v_mfma_f32_16x16x32_bf16 v[44:47], a[108:111], v[28:31], v[44:47]
  v_mfma_f32_16x16x32_bf16 v[48:51], a[164:167], v[28:31], v[48:51]
  v_mfma_f32_16x16x32_bf16 v[52:55], a[220:223], v[28:31], v[52:55]
  s_waitcnt lgkmcnt(4)
  v_mfma_f32_16x16x32_bf16 v[56:59], a[52:55], v[32:35], v[56:59]
  ds_read_b128 v[24:27], v128 offset:2048
  v_mfma_f32_16x16x32_bf16 v[60:63], a[108:111], v[32:35], v[60:63]
  v_mfma_f32_16x16x32_bf16 v[64:67], a[164:167], v[32:35], v[64:67]
  v_mfma_f32_16x16x32_bf16 v[68:71], a[220:223], v[32:35], v[68:71]
  s_waitcnt lgkmcnt(4)
  s_mov_b32 s40, s19
  s_mov_b32 s41, s29
  s_add_u32 s19, s19, 1
  s_cmp_lt_u32 s19, s35
  s_cbranch_scc0 wg_vo_e0
  v_mfma_f32_16x16x32_bf16 v[96:99], a[0:3], v[8:11], 0
  ds_read_b128 v[28:31], v128 offset:16384
  v_mfma_f32_16x16x32_bf16 v[100:103], a[56:59], v[8:11], 0
  v_mfma_f32_16x16x32_bf16 v[104:107], a[112:115], v[8:11], 0
  v_mfma_f32_16x16x32_bf16 v[108:111], a[168:171], v[8:11], 0
  s_waitcnt lgkmcnt(4)
  s_add_u32 s43, s41, 458752
  v_mfma_f32_16x16x32_bf16 v[112:115], a[0:3], v[12:15], 0
  ds_read_b128 v[32:35], v128 offset:3072
  v_mfma_f32_16x16x32_bf16 v[116:119], a[56:59], v[12:15], 0
  s_lshl_b32 s42, s40, 5
  s_add_u32 s42, s42, 0
  v_mfma_f32_16x16x32_bf16 v[120:123], a[112:115], v[12:15], 0
  v_add_u32 v88, s42, v4
  v_mul_u32_u24 v89, 2341, v88
  v_mfma_f32_16x16x32_bf16 v[124:127], a[168:171], v[12:15], 0
  s_waitcnt lgkmcnt(4)
  v_lshrrev_b32 v89, 16, v89
  v_mfma_f32_16x16x32_bf16 v[96:99], a[4:7], v[16:19], v[96:99]
  ds_read_b128 v[8:11], v128 offset:17408
  v_mfma_f32_16x16x32_bf16 v[100:103], a[60:63], v[16:19], v[100:103]
  v_mul_u32_u24 v92, 28, v89
  v_sub_u32 v92, v88, v92
  v_mfma_f32_16x16x32_bf16 v[104:107], a[116:119], v[16:19], v[104:107]
  v_cmp_gt_u32 vcc, 16, v92
  v_mul_u32_u24 v89, 84, v89
  v_mfma_f32_16x16x32_bf16 v[108:111], a[172:175], v[16:19], v[108:111]
  s_waitcnt lgkmcnt(4)
  v_cndmask_b32 v92, v7, v6, vcc
  v_mfma_f32_16x16x32_bf16 v[112:115], a[4:7], v[20:23], v[112:115]
  ds_read_b128 v[12:15], v128 offset:4096
  v_mfma_f32_16x16x32_bf16 v[116:119], a[60:63], v[20:23], v[116:119]
  v_add3_u32 v88, v88, v89, v92
  v_lshlrev_b32 v90, 4, v88
  v_mfma_f32_16x16x32_bf16 v[120:123], a[116:119], v[20:23], v[120:123]
  v_cvt_pk_bf16_f32 v72, v40, v44
  v_cvt_pk_bf16_f32 v73, v41, v45
  v_mfma_f32_16x16x32_bf16 v[124:127], a[172:175], v[20:23], v[124:127]
  s_waitcnt lgkmcnt(4)
  v_cvt_pk_bf16_f32 v74, v42, v46
  v_mfma_f32_16x16x32_bf16 v[96:99], a[8:11], v[24:27], v[96:99]
  ds_read_b128 v[16:19], v128 offset:18432
  v_mfma_f32_16x16x32_bf16 v[100:103], a[64:67], v[24:27], v[100:103]
  v_cvt_pk_bf16_f32 v75, v43, v47
  v_mfma_f32_16x16x32_bf16 v[104:107], a[120:123], v[24:27], v[104:107]
  buffer_store_dwordx4 v[72:75], v90, s[8:11], s41 offen sc1
  v_cvt_pk_bf16_f32 v76, v48, v52
  v_mfma_f32_16x16x32_bf16 v[108:111], a[176:179], v[24:27], v[108:111]
  s_waitcnt lgkmcnt(4)
  v_cvt_pk_bf16_f32 v77, v49, v53
  v_mfma_f32_16x16x32_bf16 v[112:115], a[8:11], v[28:31], v[112:115]
  ds_read_b128 v[20:23], v128 offset:5120
  v_mfma_f32_16x16x32_bf16 v[116:119], a[64:67], v[28:31], v[116:119]
  v_cvt_pk_bf16_f32 v78, v50, v54
  v_cvt_pk_bf16_f32 v79, v51, v55
  v_mfma_f32_16x16x32_bf16 v[120:123], a[120:123], v[28:31], v[120:123]
  buffer_store_dwordx4 v[76:79], v90, s[8:11], s43 offen sc1
  s_lshl_b32 s42, s40, 5
  v_mfma_f32_16x16x32_bf16 v[124:127], a[176:179], v[28:31], v[124:127]
  s_waitcnt lgkmcnt(4)
  s_add_u32 s42, s42, 16
  v_mfma_f32_16x16x32_bf16 v[96:99], a[12:15], v[32:35], v[96:99]
  ds_read_b128 v[24:27], v128 offset:19456
  v_mfma_f32_16x16x32_bf16 v[100:103], a[68:71], v[32:35], v[100:103]
  v_add_u32 v88, s42, v4
  v_mul_u32_u24 v89, 2341, v88
  v_mfma_f32_16x16x32_bf16 v[104:107], a[124:127], v[32:35], v[104:107]
  v_lshrrev_b32 v89, 16, v89
  v_mul_u32_u24 v92, 28, v89
  v_mfma_f32_16x16x32_bf16 v[108:111], a[180:183], v[32:35], v[108:111]
  s_waitcnt lgkmcnt(4)
  v_sub_u32 v92, v88, v92
  v_mfma_f32_16x16x32_bf16 v[112:115], a[12:15], v[8:11], v[112:115]
  ds_read_b128 v[28:31], v128 offset:6144
  v_mfma_f32_16x16x32_bf16 v[116:119], a[68:71], v[8:11], v[116:119]
  v_cmp_gt_u32 vcc, 16, v92
  v_mul_u32_u24 v89, 84, v89
  v_mfma_f32_16x16x32_bf16 v[120:123], a[124:127], v[8:11], v[120:123]
  v_cndmask_b32 v92, v7, v6, vcc
  v_add3_u32 v88, v88, v89, v92
  v_mfma_f32_16x16x32_bf16 v[124:127], a[180:183], v[8:11], v[124:127]
  s_waitcnt lgkmcnt(4)
  v_lshlrev_b32 v91, 4, v88
  v_mfma_f32_16x16x32_bf16 v[96:99], a[16:19], v[12:15], v[96:99]
  ds_read_b128 v[32:35], v128 offset:20480
  v_mfma_f32_16x16x32_bf16 v[100:103], a[72:75], v[12:15], v[100:103]
  v_cvt_pk_bf16_f32 v80, v56, v60
  v_cvt_pk_bf16_f32 v81, v57, v61
  v_mfma_f32_16x16x32_bf16 v[104:107], a[128:131], v[12:15], v[104:107]
  v_cvt_pk_bf16_f32 v82, v58, v62
  v_cvt_pk_bf16_f32 v83, v59, v63
  v_mfma_f32_16x16x32_bf16 v[108:111], a[184:187], v[12:15], v[108:111]
  s_waitcnt lgkmcnt(4)
  buffer_store_dwordx4 v[80:83], v91, s[8:11], s41 offen sc1
  v_mfma_f32_16x16x32_bf16 v[112:115], a[16:19], v[16:19], v[112:115]
  ds_read_b128 v[8:11], v128 offset:7168
  v_mfma_f32_16x16x32_bf16 v[116:119], a[72:75], v[16:19], v[116:119]
  v_cvt_pk_bf16_f32 v84, v64, v68
  v_cvt_pk_bf16_f32 v85, v65, v69
  v_mfma_f32_16x16x32_bf16 v[120:123], a[128:131], v[16:19], v[120:123]
  v_cvt_pk_bf16_f32 v86, v66, v70
  v_cvt_pk_bf16_f32 v87, v67, v71
  v_mfma_f32_16x16x32_bf16 v[124:127], a[184:187], v[16:19], v[124:127]
  s_waitcnt lgkmcnt(4)
  buffer_store_dwordx4 v[84:87], v91, s[8:11], s43 offen sc1
  v_mfma_f32_16x16x32_bf16 v[96:99], a[20:23], v[20:23], v[96:99]
  ds_read_b128 v[12:15], v128 offset:21504
  v_mfma_f32_16x16x32_bf16 v[100:103], a[76:79], v[20:23], v[100:103]
  s_add_u32 s30, s19, 2
  s_lshl_b32 s24, s30, 1
  s_mul_i32 s24, s24, 14336
  v_mfma_f32_16x16x32_bf16 v[104:107], a[132:135], v[20:23], v[104:107]
  s_add_u32 s24, s24, s23
  s_cmp_lt_u32 s30, s35
  s_cselect_b32 s24, s24, 0x40000000
  v_mfma_f32_16x16x32_bf16 v[108:111], a[188:191], v[20:23], v[108:111]
  s_waitcnt lgkmcnt(4)
  s_add_u32 m0, s33, s27
  s_nop 0
  buffer_load_dwordx4 v2, s[8:11], s24 offen offset:0 sc1 lds
  v_mfma_f32_16x16x32_bf16 v[112:115], a[20:23], v[24:27], v[112:115]
  ds_read_b128 v[16:19], v128 offset:8192
  v_mfma_f32_16x16x32_bf16 v[116:119], a[76:79], v[24:27], v[116:119]
  v_mfma_f32_16x16x32_bf16 v[120:123], a[132:135], v[24:27], v[120:123]
  v_mfma_f32_16x16x32_bf16 v[124:127], a[188:191], v[24:27], v[124:127]
  s_waitcnt lgkmcnt(4)
  v_mfma_f32_16x16x32_bf16 v[96:99], a[24:27], v[28:31], v[96:99]
  ds_read_b128 v[20:23], v128 offset:22528
  v_mfma_f32_16x16x32_bf16 v[100:103], a[80:83], v[28:31], v[100:103]
  buffer_load_dwordx4 v2, s[8:11], s24 offen offset:1024 sc1 lds
  v_mfma_f32_16x16x32_bf16 v[104:107], a[136:139], v[28:31], v[104:107]
  v_mfma_f32_16x16x32_bf16 v[108:111], a[192:195], v[28:31], v[108:111]
  s_waitcnt lgkmcnt(4)
  v_mfma_f32_16x16x32_bf16 v[112:115], a[24:27], v[32:35], v[112:115]
  ds_read_b128 v[24:27], v128 offset:9216
  v_mfma_f32_16x16x32_bf16 v[116:119], a[80:83], v[32:35], v[116:119]
  v_mfma_f32_16x16x32_bf16 v[120:123], a[136:139], v[32:35], v[120:123]
  buffer_load_dwordx4 v2, s[8:11], s24 offen offset:2048 sc1 lds
  v_mfma_f32_16x16x32_bf16 v[124:127], a[192:195], v[32:35], v[124:127]
  s_waitcnt lgkmcnt(4)
  v_mfma_f32_16x16x32_bf16 v[96:99], a[28:31], v[8:11], v[96:99]
  ds_read_b128 v[28:31], v128 offset:23552
  v_mfma_f32_16x16x32_bf16 v[100:103], a[84:87], v[8:11], v[100:103]
  v_mfma_f32_16x16x32_bf16 v[104:107], a[140:143], v[8:11], v[104:107]
  v_mfma_f32_16x16x32_bf16 v[108:111], a[196:199], v[8:11], v[108:111]
  s_waitcnt lgkmcnt(4)
  buffer_load_dwordx4 v2, s[8:11], s24 offen offset:3072 sc1 lds
  v_mfma_f32_16x16x32_bf16 v[112:115], a[28:31], v[12:15], v[112:115]
  ds_read_b128 v[32:35], v128 offset:10240
  v_mfma_f32_16x16x32_bf16 v[116:119], a[84:87], v[12:15], v[116:119]
  v_mfma_f32_16x16x32_bf16 v[120:123], a[140:143], v[12:15], v[120:123]
  v_mfma_f32_16x16x32_bf16 v[124:127], a[196:199], v[12:15], v[124:127]
  s_waitcnt lgkmcnt(4)
  v_mfma_f32_16x16x32_bf16 v[96:99], a[32:35], v[16:19], v[96:99]
  ds_read_b128 v[8:11], v128 offset:24576
  v_mfma_f32_16x16x32_bf16 v[100:103], a[88:91], v[16:19], v[100:103]
  s_add_u32 m0, m0, 4096
  s_add_u32 s24, s24, 4096
  buffer_load_dwordx4 v2, s[8:11], s24 offen offset:0 sc1 lds
  v_mfma_f32_16x16x32_bf16 v[104:107], a[144:147], v[16:19], v[104:107]
  v_mfma_f32_16x16x32_bf16 v[108:111], a[200:203], v[16:19], v[108:111]
  s_waitcnt lgkmcnt(4)
  v_mfma_f32_16x16x32_bf16 v[112:115], a[32:35], v[20:23], v[112:115]
  ds_read_b128 v[12:15], v128 offset:11264
  v_mfma_f32_16x16x32_bf16 v[116:119], a[88:91], v[20:23], v[116:119]
  v_mfma_f32_16x16x32_bf16 v[120:123], a[144:147], v[20:23], v[120:123]
  buffer_load_dwordx4 v2, s[8:11], s24 offen offset:1024 sc1 lds
  v_mfma_f32_16x16x32_bf16 v[124:127], a[200:203], v[20:23], v[124:127]
  s_waitcnt lgkmcnt(4)
  v_mfma_f32_16x16x32_bf16 v[96:99], a[36:39], v[24:27], v[96:99]
  ds_read_b128 v[16:19], v128 offset:25600
  v_mfma_f32_16x16x32_bf16 v[100:103], a[92:95], v[24:27], v[100:103]
  v_mfma_f32_16x16x32_bf16 v[104:107], a[148:151], v[24:27], v[104:107]
  v_mfma_f32_16x16x32_bf16 v[108:111], a[204:207], v[24:27], v[108:111]
  s_waitcnt lgkmcnt(4)
  buffer_load_dwordx4 v2, s[8:11], s24 offen offset:2048 sc1 lds
  v_mfma_f32_16x16x32_bf16 v[112:115], a[36:39], v[28:31], v[112:115]
  ds_read_b128 v[20:23], v128 offset:12288
  v_mfma_f32_16x16x32_bf16 v[116:119], a[92:95], v[28:31], v[116:119]
  v_mfma_f32_16x16x32_bf16 v[120:123], a[148:151], v[28:31], v[120:123]
  v_mfma_f32_16x16x32_bf16 v[124:127], a[204:207], v[28:31], v[124:127]
  s_waitcnt lgkmcnt(4)
  v_mfma_f32_16x16x32_bf16 v[96:99], a[40:43], v[32:35], v[96:99]
  ds_read_b128 v[24:27], v128 offset:26624
  v_mfma_f32_16x16x32_bf16 v[100:103], a[96:99], v[32:35], v[100:103]
  s_add_u32 s33, s33, 28672
  s_cmp_eq_u32 s33, 114688
  s_cselect_b32 s33, 0, s33
  v_mfma_f32_16x16x32_bf16 v[104:107], a[152:155], v[32:35], v[104:107]
  s_add_u32 s32, s32, 28672
  s_cmp_eq_u32 s32, 114688
  s_cselect_b32 s32, 0, s32
  v_mfma_f32_16x16x32_bf16 v[108:111], a[208:211], v[32:35], v[108:111]
  s_waitcnt lgkmcnt(4)
  v_add_u32 v5, s32, v2
  v_mfma_f32_16x16x32_bf16 v[112:115], a[40:43], v[8:11], v[112:115]
  ds_read_b128 v[28:31], v128 offset:13312
  v_mfma_f32_16x16x32_bf16 v[116:119], a[96:99], v[8:11], v[116:119]
  v_mfma_f32_16x16x32_bf16 v[120:123], a[152:155], v[8:11], v[120:123]
  v_mfma_f32_16x16x32_bf16 v[124:127], a[208:211], v[8:11], v[124:127]
  s_waitcnt lgkmcnt(4)
  v_mfma_f32_16x16x32_bf16 v[96:99], a[44:47], v[12:15], v[96:99]
  ds_read_b128 v[32:35], v128 offset:27648
  v_mfma_f32_16x16x32_bf16 v[100:103], a[100:103], v[12:15], v[100:103]
  v_mfma_f32_16x16x32_bf16 v[104:107], a[156:159], v[12:15], v[104:107]
  v_mfma_f32_16x16x32_bf16 v[108:111], a[212:215], v[12:15], v[108:111]
  s_waitcnt lgkmcnt(4)
  v_mfma_f32_16x16x32_bf16 v[112:115], a[44:47], v[16:19], v[112:115]
  s_waitcnt vmcnt(11)
  s_barrier
  ds_read_b128 v[8:11], v5 offset:0
  v_mfma_f32_16x16x32_bf16 v[116:119], a[100:103], v[16:19], v[116:119]
  v_mfma_f32_16x16x32_bf16 v[120:123], a[156:159], v[16:19], v[120:123]
  v_mfma_f32_16x16x32_bf16 v[124:127], a[212:215], v[16:19], v[124:127]
  s_waitcnt lgkmcnt(4)
  v_mfma_f32_16x16x32_bf16 v[96:99], a[48:51], v[20:23], v[96:99]
  ds_read_b128 v[12:15], v5 offset:14336
  v_mfma_f32_16x16x32_bf16 v[100:103], a[104:107], v[20:23], v[100:103]
  v_mfma_f32_16x16x32_bf16 v[104:107], a[160:163], v[20:23], v[104:107]
  v_mfma_f32_16x16x32_bf16 v[108:111], a[216:219], v[20:23], v[108:111]
  s_waitcnt lgkmcnt(4)
  v_mfma_f32_16x16x32_bf16 v[112:115], a[48:51], v[24:27], v[112:115]
  ds_read_b128 v[16:19], v5 offset:1024
  v_mfma_f32_16x16x32_bf16 v[116:119], a[104:107], v[24:27], v[116:119]
  v_mfma_f32_16x16x32_bf16 v[120:123], a[160:163], v[24:27], v[120:123]
  v_mfma_f32_16x16x32_bf16 v[124:127], a[216:219], v[24:27], v[124:127]
  s_waitcnt lgkmcnt(4)
  v_mfma_f32_16x16x32_bf16 v[96:99], a[52:55], v[28:31], v[96:99]
  ds_read_b128 v[20:23], v5 offset:15360
  v_mfma_f32_16x16x32_bf16 v[100:103], a[108:111], v[28:31], v[100:103]
  v_mfma_f32_16x16x32_bf16 v[104:107], a[164:167], v[28:31], v[104:107]
  v_mfma_f32_16x16x32_bf16 v[108:111], a[220:223], v[28:31], v[108:111]
  s_waitcnt lgkmcnt(4)
  v_mfma_f32_16x16x32_bf16 v[112:115], a[52:55], v[32:35], v[112:115]
  ds_read_b128 v[24:27], v5 offset:2048
  v_mfma_f32_16x16x32_bf16 v[116:119], a[108:111], v[32:35], v[116:119]
  v_mfma_f32_16x16x32_bf16 v[120:123], a[164:167], v[32:35], v[120:123]
  v_mfma_f32_16x16x32_bf16 v[124:127], a[220:223], v[32:35], v[124:127]
  s_waitcnt lgkmcnt(4)
  s_mov_b32 s40, s19
  s_mov_b32 s41, s29
  s_add_u32 s19, s19, 1
  s_cmp_lt_u32 s19, s35
  s_cbranch_scc1 wg_vo_loop
  s_nop 3
  s_add_u32 s43, s41, 458752
  s_lshl_b32 s42, s40, 5
  s_add_u32 s42, s42, 0
  v_add_u32 v88, s42, v4
  v_mul_u32_u24 v89, 2341, v88
  v_lshrrev_b32 v89, 16, v89
  v_mul_u32_u24 v92, 28, v89
  v_sub_u32 v92, v88, v92
  v_cmp_gt_u32 vcc, 16, v92
  v_mul_u32_u24 v89, 84, v89
  s_nop 0
  v_cndmask_b32 v92, v7, v6, vcc
  v_add3_u32 v88, v88, v89, v92
  v_lshlrev_b32 v90, 4, v88
  v_cvt_pk_bf16_f32 v72, v96, v100
  v_cvt_pk_bf16_f32 v73, v97, v101
  v_cvt_pk_bf16_f32 v74, v98, v102
  v_cvt_pk_bf16_f32 v75, v99, v103
  buffer_store_dwordx4 v[72:75], v90, s[8:11], s41 offen sc1
  v_cvt_pk_bf16_f32 v76, v104, v108
  v_cvt_pk_bf16_f32 v77, v105, v109
  v_cvt_pk_bf16_f32 v78, v106, v110
  v_cvt_pk_bf16_f32 v79, v107, v111
  buffer_store_dwordx4 v[76:79], v90, s[8:11], s43 offen sc1
  s_lshl_b32 s42, s40, 5
  s_add_u32 s42, s42, 16
  v_add_u32 v88, s42, v4
  v_mul_u32_u24 v89, 2341, v88
  v_lshrrev_b32 v89, 16, v89
  v_mul_u32_u24 v92, 28, v89
  v_sub_u32 v92, v88, v92
  v_cmp_gt_u32 vcc, 16, v92
  v_mul_u32_u24 v89, 84, v89
  s_nop 0
  v_cndmask_b32 v92, v7, v6, vcc
  v_add3_u32 v88, v88, v89, v92
  v_lshlrev_b32 v91, 4, v88
  v_cvt_pk_bf16_f32 v80, v112, v116
  v_cvt_pk_bf16_f32 v81, v113, v117
  v_cvt_pk_bf16_f32 v82, v114, v118
  v_cvt_pk_bf16_f32 v83, v115, v119
  buffer_store_dwordx4 v[80:83], v91, s[8:11], s41 offen sc1
  v_cvt_pk_bf16_f32 v84, v120, v124
  v_cvt_pk_bf16_f32 v85, v121, v125
  v_cvt_pk_bf16_f32 v86, v122, v126
  v_cvt_pk_bf16_f32 v87, v123, v127
  buffer_store_dwordx4 v[84:87], v91, s[8:11], s43 offen sc1
  s_branch wg_done
wg_vo_e0:
  s_nop 7
  s_add_u32 s43, s41, 458752
  s_lshl_b32 s42, s40, 5
  s_add_u32 s42, s42, 0
  v_add_u32 v88, s42, v4
  v_mul_u32_u24 v89, 2341, v88
  v_lshrrev_b32 v89, 16, v89
  v_mul_u32_u24 v92, 28, v89
  v_sub_u32 v92, v88, v92
  v_cmp_gt_u32 vcc, 16, v92
  v_mul_u32_u24 v89, 84, v89
  s_nop 0
  v_cndmask_b32 v92, v7, v6, vcc
  v_add3_u32 v88, v88, v89, v92
  v_lshlrev_b32 v90, 4, v88
  v_cvt_pk_bf16_f32 v72, v40, v44
  v_cvt_pk_bf16_f32 v73, v41, v45
  v_cvt_pk_bf16_f32 v74, v42, v46
  v_cvt_pk_bf16_f32 v75, v43, v47
  buffer_store_dwordx4 v[72:75], v90, s[8:11], s41 offen sc1
  v_cvt_pk_bf16_f32 v76, v48, v52
  v_cvt_pk_bf16_f32 v77, v49, v53
  v_cvt_pk_bf16_f32 v78, v50, v54
  v_cvt_pk_bf16_f32 v79, v51, v55
  buffer_store_dwordx4 v[76:79], v90, s[8:11], s43 offen sc1
  s_lshl_b32 s42, s40, 5
  s_add_u32 s42, s42, 16
  v_add_u32 v88, s42, v4
  v_mul_u32_u24 v89, 2341, v88
  v_lshrrev_b32 v89, 16, v89
  v_mul_u32_u24 v92, 28, v89
  v_sub_u32 v92, v88, v92
  v_cmp_gt_u32 vcc, 16, v92
  v_mul_u32_u24 v89, 84, v89
  s_nop 0
  v_cndmask_b32 v92, v7, v6, vcc
  v_add3_u32 v88, v88, v89, v92
  v_lshlrev_b32 v91, 4, v88
  v_cvt_pk_bf16_f32 v80, v56, v60
  v_cvt_pk_bf16_f32 v81, v57, v61
  v_cvt_pk_bf16_f32 v82, v58, v62
  v_cvt_pk_bf16_f32 v83, v59, v63
  buffer_store_dwordx4 v[80:83], v91, s[8:11], s41 offen sc1
  v_cvt_pk_bf16_f32 v84, v64, v68
  v_cvt_pk_bf16_f32 v85, v65, v69
  v_cvt_pk_bf16_f32 v86, v66, v70
  v_cvt_pk_bf16_f32 v87, v67, v71
  buffer_store_dwordx4 v[84:87], v91, s[8:11], s43 offen sc1
  s_branch wg_done
wg_done:
  s_lshl_b32 s20, s18, 4
  s_and_b32 s21, s17, 15
  s_add_u32 s20, s20, s21
  s_lshl_b32 s20, s20, 7
  s_cmp_lt_u32 s17, 16
  s_cselect_b32 s21, 16384, 0
  s_add_u32 s20, s20, s21
  s_add_u32 s20, s20, 524288
  s_sub_u32 s21, s35, s34
  s_lshl_b32 s21, s21, 2
  v_mov_b32 v5, s21
  v_mov_b32 v6, 0
  s_waitcnt vmcnt(0) lgkmcnt(0)
  s_barrier
  s_cmp_lg_u32 s16, 0
  s_cbranch_scc1 wg_sg
  s_mov_b64 exec, 1
  buffer_atomic_add v5, v6, s[8:11], s20 offen
  s_mov_b64 exec, -1
wg_sg:
  s_branch wk_loop
wk_srv:
  s_mov_b32 s96, 7
  v_mov_b32 v4, 1
  v_mov_b32 v5, 587392
  v_mov_b32 v6, 160000
  s_barrier
  s_cmp_lg_u32 s16, 0
  s_cbranch_scc1 wk_sve1
  s_mov_b64 exec, 1
  buffer_atomic_add v4, v5, s[8:11], 0 offen sc0
  s_waitcnt vmcnt(0)
  ds_write_b32 v6, v4
  s_waitcnt lgkmcnt(0)
  s_mov_b64 exec, -1
wk_sve1:
  s_barrier
  ds_read_b32 v4, v6
  s_waitcnt lgkmcnt(0)
  v_readfirstlane_b32 s3, v4
  v_and_b32 v1, 63, v0
  v_lshlrev_b32 v2, 4, v1
  v_lshrrev_b32 v3, 4, v1
  v_and_b32 v4, 15, v1
  v_mov_b32 v250, 0
  s_cmp_ge_u32 s3, 32
  s_cbranch_scc1 wk_ask
  s_and_b32 s18, s3, 15
  s_lshr_b32 s19, s3, 4
  s_and_b32 s19, s19, 1
  s_mul_i32 s20, s18, 401408
  s_mul_i32 s21, s16, 100352
  s_add_u32 s20, s20, s21
  s_add_u32 s20, s20, 39976960
  s_add_u32 s22, s20, 0
  buffer_load_dwordx4 a[0:3], v2, s[8:11], s22 offen offset:0 sc1
  buffer_load_dwordx4 a[4:7], v2, s[8:11], s22 offen offset:1024 sc1
  buffer_load_dwordx4 a[8:11], v2, s[8:11], s22 offen offset:2048 sc1
  buffer_load_dwordx4 a[12:15], v2, s[8:11], s22 offen offset:3072 sc1
  s_add_u32 s22, s20, 4096
  buffer_load_dwordx4 a[16:19], v2, s[8:11], s22 offen offset:0 sc1
  buffer_load_dwordx4 a[20:23], v2, s[8:11], s22 offen offset:1024 sc1
  buffer_load_dwordx4 a[24:27], v2, s[8:11], s22 offen offset:2048 sc1
  buffer_load_dwordx4 a[28:31], v2, s[8:11], s22 offen offset:3072 sc1
  s_add_u32 s22, s20, 8192
  buffer_load_dwordx4 a[32:35], v2, s[8:11], s22 offen offset:0 sc1
  buffer_load_dwordx4 a[36:39], v2, s[8:11], s22 offen offset:1024 sc1
  s_waitcnt vmcnt(8)
  buffer_load_dwordx4 a[40:43], v2, s[8:11], s22 offen offset:2048 sc1
  buffer_load_dwordx4 a[44:47], v2, s[8:11], s22 offen offset:3072 sc1
  s_waitcnt vmcnt(8)
  s_add_u32 s22, s20, 12288
  buffer_load_dwordx4 a[48:51], v2, s[8:11], s22 offen offset:0 sc1
  buffer_load_dwordx4 a[52:55], v2, s[8:11], s22 offen offset:1024 sc1
  s_waitcnt vmcnt(8)
  buffer_load_dwordx4 a[56:59], v2, s[8:11], s22 offen offset:2048 sc1
  buffer_load_dwordx4 a[60:63], v2, s[8:11], s22 offen offset:3072 sc1
  s_waitcnt vmcnt(8)
  s_add_u32 s22, s20, 16384
  buffer_load_dwordx4 a[64:67], v2, s[8:11], s22 offen offset:0 sc1
  buffer_load_dwordx4 a[68:71], v2, s[8:11], s22 offen offset:1024 sc1
  s_waitcnt vmcnt(8)
  buffer_load_dwordx4 a[72:75], v2, s[8:11], s22 offen offset:2048 sc1
  buffer_load_dwordx4 a[76:79], v2, s[8:11], s22 offen offset:3072 sc1
  s_waitcnt vmcnt(8)
  s_add_u32 s22, s20, 20480
  buffer_load_dwordx4 a[80:83], v2, s[8:11], s22 offen offset:0 sc1
  buffer_load_dwordx4 a[84:87], v2, s[8:11], s22 offen offset:1024 sc1
  s_waitcnt vmcnt(8)
  buffer_load_dwordx4 a[88:91], v2, s[8:11], s22 offen offset:2048 sc1
  buffer_load_dwordx4 a[92:95], v2, s[8:11], s22 offen offset:3072 sc1
  s_waitcnt vmcnt(8)
  s_add_u32 s22, s20, 24576
  buffer_load_dwordx4 a[96:99], v2, s[8:11], s22 offen offset:0 sc1
  buffer_load_dwordx4 a[100:103], v2, s[8:11], s22 offen offset:1024 sc1
  s_waitcnt vmcnt(8)
  buffer_load_dwordx4 a[104:107], v2, s[8:11], s22 offen offset:2048 sc1
  buffer_load_dwordx4 a[108:111], v2, s[8:11], s22 offen offset:3072 sc1
  s_waitcnt vmcnt(8)
  s_add_u32 s22, s20, 28672
  buffer_load_dwordx4 a[112:115], v2, s[8:11], s22 offen offset:0 sc1
  buffer_load_dwordx4 a[116:119], v2, s[8:11], s22 offen offset:1024 sc1
  s_waitcnt vmcnt(8)
  buffer_load_dwordx4 a[120:123], v2, s[8:11], s22 offen offset:2048 sc1
  buffer_load_dwordx4 a[124:127], v2, s[8:11], s22 offen offset:3072 sc1
  s_waitcnt vmcnt(8)
  s_add_u32 s22, s20, 32768
  buffer_load_dwordx4 a[128:131], v2, s[8:11], s22 offen offset:0 sc1
  buffer_load_dwordx4 a[132:135], v2, s[8:11], s22 offen offset:1024 sc1
  s_waitcnt vmcnt(8)
  buffer_load_dwordx4 a[136:139], v2, s[8:11], s22 offen offset:2048 sc1
  buffer_load_dwordx4 a[140:143], v2, s[8:11], s22 offen offset:3072 sc1
  s_waitcnt vmcnt(8)
  s_add_u32 s22, s20, 36864
  buffer_load_dwordx4 a[144:147], v2, s[8:11], s22 offen offset:0 sc1
  buffer_load_dwordx4 a[148:151], v2, s[8:11], s22 offen offset:1024 sc1
  s_waitcnt vmcnt(8)
  buffer_load_dwordx4 a[152:155], v2, s[8:11], s22 offen offset:2048 sc1
  buffer_load_dwordx4 a[156:159], v2, s[8:11], s22 offen offset:3072 sc1
  s_waitcnt vmcnt(8)
  s_add_u32 s22, s20, 40960
  buffer_load_dwordx4 a[160:163], v2, s[8:11], s22 offen offset:0 sc1
  buffer_load_dwordx4 a[164:167], v2, s[8:11], s22 offen offset:1024 sc1
  s_waitcnt vmcnt(8)
  buffer_load_dwordx4 a[168:171], v2, s[8:11], s22 offen offset:2048 sc1
  buffer_load_dwordx4 a[172:175], v2, s[8:11], s22 offen offset:3072 sc1
  s_waitcnt vmcnt(8)
  s_add_u32 s22, s20, 45056
  buffer_load_dwordx4 a[176:179], v2, s[8:11], s22 offen offset:0 sc1
  buffer_load_dwordx4 a[180:183], v2, s[8:11], s22 offen offset:1024 sc1
  s_waitcnt vmcnt(8)
  buffer_load_dwordx4 a[184:187], v2, s[8:11], s22 offen offset:2048 sc1
  buffer_load_dwordx4 a[188:191], v2, s[8:11], s22 offen offset:3072 sc1
  s_waitcnt vmcnt(8)
  s_add_u32 s22, s20, 49152
  buffer_load_dwordx4 a[192:195], v2, s[8:11], s22 offen offset:0 sc1
  buffer_load_dwordx4 a[196:199], v2, s[8:11], s22 offen offset:1024 sc1
  s_waitcnt vmcnt(8)
  buffer_load_dwordx4 a[200:203], v2, s[8:11], s22 offen offset:2048 sc1
  buffer_load_dwordx4 a[204:207], v2, s[8:11], s22 offen offset:3072 sc1
  s_waitcnt vmcnt(8)
  s_add_u32 s22, s20, 53248
  buffer_load_dwordx4 a[208:211], v2, s[8:11], s22 offen offset:0 sc1
  buffer_load_dwordx4 a[212:215], v2, s[8:11], s22 offen offset:1024 sc1
  s_waitcnt vmcnt(8)
  buffer_load_dwordx4 a[216:219], v2, s[8:11], s22 offen offset:2048 sc1
  buffer_load_dwordx4 a[220:223], v2, s[8:11], s22 offen offset:3072 sc1
  s_waitcnt vmcnt(8)
  s_add_u32 s22, s20, 57344
  buffer_load_dwordx4 a[224:227], v2, s[8:11], s22 offen offset:0 sc1
  buffer_load_dwordx4 a[228:231], v2, s[8:11], s22 offen offset:1024 sc1
  s_waitcnt vmcnt(8)
  buffer_load_dwordx4 a[232:235], v2, s[8:11], s22 offen offset:2048 sc1
  buffer_load_dwordx4 a[236:239], v2, s[8:11], s22 offen offset:3072 sc1
  s_waitcnt vmcnt(8)
  s_add_u32 s22, s20, 61440
  buffer_load_dwordx4 a[240:243], v2, s[8:11], s22 offen offset:0 sc1
  buffer_load_dwordx4 a[244:247], v2, s[8:11], s22 offen offset:1024 sc1
  s_waitcnt vmcnt(8)
  buffer_load_dwordx4 a[248:251], v2, s[8:11], s22 offen offset:2048 sc1
  buffer_load_dwordx4 a[252:255], v2, s[8:11], s22 offen offset:3072 sc1
  s_waitcnt vmcnt(8)
  s_add_u32 s22, s20, 65536
  buffer_load_dwordx4 v[120:123], v2, s[8:11], s22 offen offset:0 sc1
  buffer_load_dwordx4 v[124:127], v2, s[8:11], s22 offen offset:1024 sc1
  s_waitcnt vmcnt(8)
  buffer_load_dwordx4 v[128:131], v2, s[8:11], s22 offen offset:2048 sc1
  buffer_load_dwordx4 v[132:135], v2, s[8:11], s22 offen offset:3072 sc1
  s_waitcnt vmcnt(8)
  s_add_u32 s22, s20, 69632
  buffer_load_dwordx4 v[136:139], v2, s[8:11], s22 offen offset:0 sc1
  buffer_load_dwordx4 v[140:143], v2, s[8:11], s22 offen offset:1024 sc1
  s_waitcnt vmcnt(8)
  buffer_load_dwordx4 v[144:147], v2, s[8:11], s22 offen offset:2048 sc1
  buffer_load_dwordx4 v[148:151], v2, s[8:11], s22 offen offset:3072 sc1
  s_waitcnt vmcnt(8)
  s_add_u32 s22, s20, 73728
  buffer_load_dwordx4 v[152:155], v2, s[8:11], s22 offen offset:0 sc1
  buffer_load_dwordx4 v[156:159], v2, s[8:11], s22 offen offset:1024 sc1
  s_waitcnt vmcnt(8)
  buffer_load_dwordx4 v[160:163], v2, s[8:11], s22 offen offset:2048 sc1
  buffer_load_dwordx4 v[164:167], v2, s[8:11], s22 offen offset:3072 sc1
  s_waitcnt vmcnt(8)
  s_add_u32 s22, s20, 77824
  buffer_load_dwordx4 v[168:171], v2, s[8:11], s22 offen offset:0 sc1
  buffer_load_dwordx4 v[172:175], v2, s[8:11], s22 offen offset:1024 sc1
  s_waitcnt vmcnt(8)
  buffer_load_dwordx4 v[176:179], v2, s[8:11], s22 offen offset:2048 sc1
  buffer_load_dwordx4 v[180:183], v2, s[8:11], s22 offen offset:3072 sc1
  s_waitcnt vmcnt(8)
  s_add_u32 s22, s20, 81920
  buffer_load_dwordx4 v[184:187], v2, s[8:11], s22 offen offset:0 sc1
  buffer_load_dwordx4 v[188:191], v2, s[8:11], s22 offen offset:1024 sc1
  s_waitcnt vmcnt(8)
  buffer_load_dwordx4 v[192:195], v2, s[8:11], s22 offen offset:2048 sc1
  buffer_load_dwordx4 v[196:199], v2, s[8:11], s22 offen offset:3072 sc1
  s_waitcnt vmcnt(8)
  s_add_u32 s22, s20, 86016
  buffer_load_dwordx4 v[200:203], v2, s[8:11], s22 offen offset:0 sc1
  buffer_load_dwordx4 v[204:207], v2, s[8:11], s22 offen offset:1024 sc1
  s_waitcnt vmcnt(8)
  buffer_load_dwordx4 v[208:211], v2, s[8:11], s22 offen offset:2048 sc1
  buffer_load_dwordx4 v[212:215], v2, s[8:11], s22 offen offset:3072 sc1
  s_waitcnt vmcnt(8)
  s_add_u32 s22, s20, 90112
  buffer_load_dwordx4 v[216:219], v2, s[8:11], s22 offen offset:0 sc1
  buffer_load_dwordx4 v[220:223], v2, s[8:11], s22 offen offset:1024 sc1
  s_waitcnt vmcnt(8)
  buffer_load_dwordx4 v[224:227], v2, s[8:11], s22 offen offset:2048 sc1
  buffer_load_dwordx4 v[228:231], v2, s[8:11], s22 offen offset:3072 sc1
  s_waitcnt vmcnt(8)
  s_add_u32 s22, s20, 94208
  buffer_load_dwordx4 v[232:235], v2, s[8:11], s22 offen offset:0 sc1
  buffer_load_dwordx4 v[236:239], v2, s[8:11], s22 offen offset:1024 sc1
  s_waitcnt vmcnt(8)
  buffer_load_dwordx4 v[240:243], v2, s[8:11], s22 offen offset:2048 sc1
  buffer_load_dwordx4 v[244:247], v2, s[8:11], s22 offen offset:3072 sc1
  s_waitcnt vmcnt(8)
  s_add_u32 s22, s20, 98304
  buffer_load_dwordx4 v[248:251], v2, s[8:11], s22 offen offset:0 sc1
  buffer_load_dwordx4 v[252:255], v2, s[8:11], s22 offen offset:1024 sc1
  s_waitcnt vmcnt(8)
  v_mov_b32 v5, 0x4444
  v_mov_b32 v6, 0xeeee
  v_cmp_lt_u32 vcc, 7, v4
  s_nop 1
  v_cndmask_b32 v5, v5, v6, vcc
  s_lshl_b32 s23, s16, 11
  v_lshrrev_b32 v80, 1, v3
  v_and_b32 v81, 1, v3
  v_add_u32 v82, 0, v80
  v_lshl_add_u32 v82, v82, 4, v4
  v_mul_u32_u24 v83, 2341, v82
  v_lshrrev_b32 v83, 16, v83
  v_mul_u32_u24 v84, 28, v83
  v_sub_u32 v84, v82, v84
  v_lshrrev_b32 v85, 4, v84
  v_and_b32 v84, 15, v84
  v_lshlrev_b32 v86, 10, v85
  v_lshl_add_u32 v86, v83, 8, v86
  v_lshl_add_u32 v86, v84, 4, v86
  v_lshl_add_u32 v86, v81, 3, v86
  v_add_u32 v72, s23, v86
  v_add_u32 v82, 2, v80
  v_lshl_add_u32 v82, v82, 4, v4
  v_mul_u32_u24 v83, 2341, v82
  v_lshrrev_b32 v83, 16, v83
  v_mul_u32_u24 v84, 28, v83
  v_sub_u32 v84, v82, v84
  v_lshrrev_b32 v85, 4, v84
  v_and_b32 v84, 15, v84
  v_lshlrev_b32 v86, 10, v85
  v_lshl_add_u32 v86, v83, 8, v86
  v_lshl_add_u32 v86, v84, 4, v86
  v_lshl_add_u32 v86, v81, 3, v86
  v_add_u32 v73, s23, v86
  v_add_u32 v82, 4, v80
  v_lshl_add_u32 v82, v82, 4, v4
  v_mul_u32_u24 v83, 2341, v82
  v_lshrrev_b32 v83, 16, v83
  v_mul_u32_u24 v84, 28, v83
  v_sub_u32 v84, v82, v84
  v_lshrrev_b32 v85, 4, v84
  v_and_b32 v84, 15, v84
  v_lshlrev_b32 v86, 10, v85
  v_lshl_add_u32 v86, v83, 8, v86
  v_lshl_add_u32 v86, v84, 4, v86
  v_lshl_add_u32 v86, v81, 3, v86
  v_add_u32 v74, s23, v86
  v_mov_b32 v82, 6
  v_lshl_add_u32 v82, v82, 4, v4
  v_mul_u32_u24 v83, 2341, v82
  v_lshrrev_b32 v83, 16, v83
  v_mul_u32_u24 v84, 28, v83
  v_sub_u32 v84, v82, v84
  v_lshrrev_b32 v85, 4, v84
  v_and_b32 v84, 15, v84
  v_lshlrev_b32 v86, 10, v85
  v_lshl_add_u32 v86, v83, 8, v86
  v_lshl_add_u32 v86, v84, 4, v86
  v_lshl_add_u32 v86, v81, 3, v86
  v_add_u32 v75, s23, v86
  v_add_u32 v76, s23, v2
  s_mul_i32 s27, s18, 448
  v_mov_b32 v77, s27
  v_mov_b32 v78, 1
  s_mov_b32 s17, s19
  s_mul_i32 s24, s19, 7168
  s_add_u32 s24, s24, 65536
  s_mul_i32 s25, s18, 65
  s_add_u32 s25, s25, s19
  s_lshl_b32 s25, s25, 13
  s_add_u32 s25, s25, s23
  s_add_u32 s25, s25, 77602816
  s_lshl_b32 s26, s18, 6
  s_add_u32 s26, s26, s19
  s_lshl_b32 s26, s26, 4
  s_lshl_b32 s27, s16, 2
  s_add_u32 s26, s26, s27
  s_add_u32 s26, s26, 565248
  v_mov_b32 v88, 0
  v_mov_b32 v89, 0
  v_mov_b32 v90, 0
  v_mov_b32 v91, 0
  v_mov_b32 v92, -1
  v_mov_b32 v93, -1
  v_mov_b32 v94, -1
  v_mov_b32 v95, -1
  ds_write_b128 v76, v[88:91]
  ds_write_b128 v76, v[88:91] offset:1024
  s_mov_b32 s28, s25
  s_mov_b32 s29, 0
ws_arm:
  buffer_store_dwordx4 v[92:95], v2, s[8:11], s28 offen sc1
  buffer_store_dwordx4 v[92:95], v2, s[8:11], s28 offen offset:1024 sc1
  s_waitcnt vmcnt(8)
  s_add_u32 s28, s28, 16384
  s_add_u32 s29, s29, 1
  s_cmp_lt_u32 s29, 31
  s_cbranch_scc1 ws_arm
  s_waitcnt vmcnt(0)
  s_mov_b64 exec, 1
  buffer_store_dword v78, v2, s[8:11], s26 offen sc1
  s_mov_b64 exec, -1
ws_loop:
  v_mov_b32 v36, 0
  v_mov_b32 v37, 0
  v_mov_b32 v38, 0
  v_mov_b32 v39, 0
  v_mov_b32 v40, 0
  v_mov_b32 v41, 0
  v_mov_b32 v42, 0
  v_mov_b32 v43, 0
  v_mov_b32 v44, 0
  v_mov_b32 v45, 0
  v_mov_b32 v46, 0
  v_mov_b32 v47, 0
  v_mov_b32 v48, 0
  v_mov_b32 v49, 0
  v_mov_b32 v50, 0
  v_mov_b32 v51, 0
  v_mov_b32 v52, 0
  v_mov_b32 v53, 0
  v_mov_b32 v54, 0
  v_mov_b32 v55, 0
  v_mov_b32 v56, 0
  v_mov_b32 v57, 0
  v_mov_b32 v58, 0
  v_mov_b32 v59, 0
  v_mov_b32 v60, 0
  v_mov_b32 v61, 0
  v_mov_b32 v62, 0
  v_mov_b32 v63, 0
  s_mov_b32 s30, 0
  s_branch ws_fl
ws_pm:
  s_cmp_ge_u32 s17, 64
  s_cbranch_scc1 ws_fl
  buffer_load_dword v79, v77, s[8:11], s24 offen sc1
  s_waitcnt vmcnt(0)
  v_cmp_eq_u32 vcc, -1, v79
  s_cbranch_vccnz ws_pr
ws_fl:
  s_add_u32 s22, s24, 4096
  buffer_load_dwordx4 v[8:11], v2, s[8:11], s24 offen offset:0 sc1
  buffer_load_dwordx4 v[12:15], v2, s[8:11], s24 offen offset:1024 sc1
  buffer_load_dwordx4 v[16:19], v2, s[8:11], s24 offen offset:2048 sc1
  buffer_load_dwordx4 v[20:23], v2, s[8:11], s24 offen offset:3072 sc1
  buffer_load_dwordx4 v[24:27], v2, s[8:11], s22 offen offset:0 sc1
  buffer_load_dwordx4 v[28:31], v2, s[8:11], s22 offen offset:1024 sc1
  buffer_load_dwordx4 v[32:35], v2, s[8:11], s22 offen offset:2048 sc1
  s_waitcnt vmcnt(0)
  v_max_u32 v79, v8, v9
  v_max3_u32 v79, v79, v10, v11
  v_max3_u32 v79, v79, v12, v13
  v_max3_u32 v79, v79, v14, v15
  v_max3_u32 v79, v79, v16, v17
  v_max3_u32 v79, v79, v18, v19
  v_max3_u32 v79, v79, v20, v21
  v_max3_u32 v79, v79, v22, v23
  v_max3_u32 v79, v79, v24, v25
  v_max3_u32 v79, v79, v26, v27
  v_max3_u32 v79, v79, v28, v29
  v_max3_u32 v79, v79, v30, v31
  v_max3_u32 v79, v79, v32, v33
  v_max3_u32 v79, v79, v34, v35
  v_cmp_eq_u32 vcc, -1, v79
  s_cbranch_vccz ws_pk
ws_pr:
  s_sleep 20
  s_add_u32 s30, s30, 1
  s_cmp_lt_u32 s30, 2000000
  s_cbranch_scc1 ws_pm
  s_branch cA_abort
ws_pk:
  v_smfmac_f32_16x16x64_bf16 v[36:39], v[8:11], a[0:7], v5
  v_smfmac_f32_16x16x64_bf16 v[36:39], v[12:15], a[8:15], v5
  v_smfmac_f32_16x16x64_bf16 v[36:39], v[16:19], a[16:23], v5
  v_smfmac_f32_16x16x64_bf16 v[36:39], v[20:23], a[24:31], v5
  v_smfmac_f32_16x16x64_bf16 v[36:39], v[24:27], a[32:39], v5
  v_smfmac_f32_16x16x64_bf16 v[36:39], v[28:31], a[40:47], v5
  v_smfmac_f32_16x16x64_bf16 v[36:39], v[32:35], a[48:55], v5
  v_smfmac_f32_16x16x64_bf16 v[40:43], v[8:11], a[56:63], v5
  v_smfmac_f32_16x16x64_bf16 v[40:43], v[12:15], a[64:71], v5
  v_smfmac_f32_16x16x64_bf16 v[40:43], v[16:19], a[72:79], v5
  v_smfmac_f32_16x16x64_bf16 v[40:43], v[20:23], a[80:87], v5
  v_smfmac_f32_16x16x64_bf16 v[40:43], v[24:27], a[88:95], v5
  v_smfmac_f32_16x16x64_bf16 v[40:43], v[28:31], a[96:103], v5
  v_smfmac_f32_16x16x64_bf16 v[40:43], v[32:35], a[104:111], v5
  v_smfmac_f32_16x16x64_bf16 v[44:47], v[8:11], a[112:119], v5
  v_smfmac_f32_16x16x64_bf16 v[44:47], v[12:15], a[120:127], v5
  v_smfmac_f32_16x16x64_bf16 v[44:47], v[16:19], a[128:135], v5
  v_smfmac_f32_16x16x64_bf16 v[44:47], v[20:23], a[136:143], v5
  v_smfmac_f32_16x16x64_bf16 v[44:47], v[24:27], a[144:151], v5
  v_smfmac_f32_16x16x64_bf16 v[44:47], v[28:31], a[152:159], v5
  v_smfmac_f32_16x16x64_bf16 v[44:47], v[32:35], a[160:167], v5
  v_smfmac_f32_16x16x64_bf16 v[48:51], v[8:11], a[168:175], v5
  v_smfmac_f32_16x16x64_bf16 v[48:51], v[12:15], a[176:183], v5
  v_smfmac_f32_16x16x64_bf16 v[48:51], v[16:19], a[184:191], v5
  v_smfmac_f32_16x16x64_bf16 v[48:51], v[20:23], a[192:199], v5
  v_smfmac_f32_16x16x64_bf16 v[48:51], v[24:27], a[200:207], v5
  v_smfmac_f32_16x16x64_bf16 v[48:51], v[28:31], a[208:215], v5
  v_smfmac_f32_16x16x64_bf16 v[48:51], v[32:35], a[216:223], v5
  v_smfmac_f32_16x16x64_bf16 v[52:55], v[8:11], a[224:231], v5
  v_smfmac_f32_16x16x64_bf16 v[52:55], v[12:15], a[232:239], v5
  v_smfmac_f32_16x16x64_bf16 v[52:55], v[16:19], a[240:247], v5
  v_smfmac_f32_16x16x64_bf16 v[52:55], v[20:23], a[248:255], v5
  v_smfmac_f32_16x16x64_bf16 v[52:55], v[24:27], v[120:127], v5
  v_smfmac_f32_16x16x64_bf16 v[52:55], v[28:31], v[128:135], v5
  v_smfmac_f32_16x16x64_bf16 v[52:55], v[32:35], v[136:143], v5
  v_smfmac_f32_16x16x64_bf16 v[56:59], v[8:11], v[144:151], v5
  v_smfmac_f32_16x16x64_bf16 v[56:59], v[12:15], v[152:159], v5
  v_smfmac_f32_16x16x64_bf16 v[56:59], v[16:19], v[160:167], v5
  v_smfmac_f32_16x16x64_bf16 v[56:59], v[20:23], v[168:175], v5
  v_smfmac_f32_16x16x64_bf16 v[56:59], v[24:27], v[176:183], v5
  v_smfmac_f32_16x16x64_bf16 v[56:59], v[28:31], v[184:191], v5
  v_smfmac_f32_16x16x64_bf16 v[56:59], v[32:35], v[192:199], v5
  v_smfmac_f32_16x16x64_bf16 v[60:63], v[8:11], v[200:207], v5
  v_smfmac_f32_16x16x64_bf16 v[60:63], v[12:15], v[208:215], v5
  v_smfmac_f32_16x16x64_bf16 v[60:63], v[16:19], v[216:223], v5
  v_smfmac_f32_16x16x64_bf16 v[60:63], v[20:23], v[224:231], v5
  v_smfmac_f32_16x16x64_bf16 v[60:63], v[24:27], v[232:239], v5
  v_smfmac_f32_16x16x64_bf16 v[60:63], v[28:31], v[240:247], v5
  v_smfmac_f32_16x16x64_bf16 v[60:63], v[32:35], v[248:255], v5
  v_permlane32_swap_b32 v36, v40
  v_permlane32_swap_b32 v37, v41
  v_permlane32_swap_b32 v38, v42
  v_permlane32_swap_b32 v39, v43
  v_add_f32 v36, v36, v40
  v_add_f32 v37, v37, v41
  v_add_f32 v38, v38, v42
  v_add_f32 v39, v39, v43
  v_cvt_pk_bf16_f32 v40, v36, v37
  v_cvt_pk_bf16_f32 v41, v38, v39
  v_min_u32 v40, -2, v40
  v_min_u32 v41, -2, v41
  ds_write_b64 v72, v[40:41]
  v_permlane32_swap_b32 v44, v48
  v_permlane32_swap_b32 v45, v49
  v_permlane32_swap_b32 v46, v50
  v_permlane32_swap_b32 v47, v51
  v_add_f32 v44, v44, v48
  v_add_f32 v45, v45, v49
  v_add_f32 v46, v46, v50
  v_add_f32 v47, v47, v51
  v_cvt_pk_bf16_f32 v48, v44, v45
  v_cvt_pk_bf16_f32 v49, v46, v47
  v_min_u32 v48, -2, v48
  v_min_u32 v49, -2, v49
  ds_write_b64 v73, v[48:49]
  v_permlane32_swap_b32 v52, v56
  v_permlane32_swap_b32 v53, v57
  v_permlane32_swap_b32 v54, v58
  v_permlane32_swap_b32 v55, v59
  v_add_f32 v52, v52, v56
  v_add_f32 v53, v53, v57
  v_add_f32 v54, v54, v58
  v_add_f32 v55, v55, v59
  v_cvt_pk_bf16_f32 v56, v52, v53
  v_cvt_pk_bf16_f32 v57, v54, v55
  v_min_u32 v56, -2, v56
  v_min_u32 v57, -2, v57
  ds_write_b64 v74, v[56:57]
  v_mov_b32 v64, v60
  v_mov_b32 v65, v61
  v_mov_b32 v66, v62
  v_mov_b32 v67, v63
  v_permlane32_swap_b32 v60, v64
  v_permlane32_swap_b32 v61, v65
  v_permlane32_swap_b32 v62, v66
  v_permlane32_swap_b32 v63, v67
  v_add_f32 v60, v60, v64
  v_add_f32 v61, v61, v65
  v_add_f32 v62, v62, v66
  v_add_f32 v63, v63, v67
  v_cvt_pk_bf16_f32 v64, v60, v61
  v_cvt_pk_bf16_f32 v65, v62, v63
  v_min_u32 v64, -2, v64
  v_min_u32 v65, -2, v65
  ds_write_b64 v75, v[64:65]
  s_waitcnt lgkmcnt(0)
  ds_read_b128 v[64:67], v76
  ds_read_b128 v[68:71], v76 offset:1024
  s_waitcnt lgkmcnt(0)
  buffer_store_dwordx4 v[64:67], v2, s[8:11], s25 offen sc1
  buffer_store_dwordx4 v[68:71], v2, s[8:11], s25 offen offset:1024 sc1
  s_add_u32 s24, s24, 14336
  s_add_u32 s25, s25, 16384
  s_add_u32 s17, s17, 2
  s_cmp_lt_u32 s17, 62
  s_cbranch_scc1 ws_loop
  v_mov_b32 v250, 0
  s_branch wk_loop
wk_s4d:
  s_sub_u32 s3, s3, 640
  s_getreg_b32 s33, hwreg(HW_REG_XCC_ID)
  s_sub_u32 s33, s33, 4
  s_and_b32 s33, s33, 7
  s_min_u32 s33, s33, 6
  s_mov_b32 s35, 6
wk_s4c:
  s_lshl_b32 s34, s33, 7
  s_add_u32 s34, s34, 588416
  v_mov_b32 v4, 1
  v_mov_b32 v5, s34
  v_mov_b32 v6, 160000
  s_barrier
  s_cmp_lg_u32 s16, 0
  s_cbranch_scc1 wk_s4e1
  s_mov_b64 exec, 1
  buffer_atomic_add v4, v5, s[8:11], 0 offen sc0
  s_waitcnt vmcnt(0)
  ds_write_b32 v6, v4
  s_waitcnt lgkmcnt(0)
  s_mov_b64 exec, -1
wk_s4e1:
  s_barrier
  ds_read_b32 v4, v6
  s_waitcnt lgkmcnt(0)
  v_readfirstlane_b32 s3, v4
  s_cmp_lt_u32 s3, 16
  s_cbranch_scc1 wk_s4g
  s_mov_b32 s33, s35
  s_sub_u32 s35, s35, 1
  s_max_i32 s35, s35, 0
  s_branch wk_s4c
wk_s4g:
  s_lshl_b32 s33, s33, 4
  s_add_u32 s3, s3, s33
  s_load_dwordx8 s[40:47], s[0:1], 0
  s_load_dwordx4 s[48:51], s[0:1], 32
  s_load_dwordx2 s[52:53], s[0:1], 48
  s_load_dwordx2 s[54:55], s[0:1], 112
  v_lshrrev_b32 v1, 6, v0
  s_nop 0
  v_readfirstlane_b32 s16, v1
  v_and_b32 v1, 63, v0
  v_lshrrev_b32 v3, 4, v1
  v_and_b32 v4, 15, v1
  s_mul_i32 s17, s16, 24576
  s_waitcnt lgkmcnt(0)
  s_mov_b32 s60, s40
  s_and_b32 s61, s41, 0xffff
  s_mov_b32 s62, 1835008
  s_mov_b32 s63, 0x20000
  s_mov_b32 s64, s42
  s_and_b32 s65, s43, 0xffff
  s_mov_b32 s66, 229376
  s_mov_b32 s67, 0x20000
  s_mov_b32 s68, s44
  s_and_b32 s69, s45, 0xffff
  s_mov_b32 s70, 229376
  s_mov_b32 s71, 0x20000
  s_mov_b32 s72, s46
  s_and_b32 s73, s47, 0xffff
  s_mov_b32 s74, 229376
  s_mov_b32 s75, 0x20000
  s_mov_b32 s76, s48
  s_and_b32 s77, s49, 0xffff
  s_mov_b32 s78, 229376
  s_mov_b32 s79, 0x20000
  s_mov_b32 s80, s50
  s_and_b32 s81, s51, 0xffff
  s_mov_b32 s82, 896
  s_mov_b32 s83, 0x20000
  s_mov_b32 s84, s52
  s_and_b32 s85, s53, 0xffff
  s_mov_b32 s86, 896
  s_mov_b32 s87, 0x20000
  s_mov_b32 s88, s54
  s_and_b32 s89, s55, 0xffff
  s_mov_b32 s90, 3670016
  s_mov_b32 s91, 0x20000
  v_lshlrev_b32 v5, 5, v1
  v_sub_u32 v5, 2047, v5
  s_add_u32 s18, s17, 13056
  v_subrev_u32 v6, 0, v5
  v_max_i32 v7, 0, v6
  v_cvt_f32_u32 v7, v7
  v_cvt_pk_bf16_f32 v8, v7, v7
  v_and_b32 v7, 0xffff0000, v8
  v_lshrrev_b32 v8, 23, v7
  v_subrev_u32 v8, 134, v8
  v_max_i32 v8, 0, v8
  v_cvt_u32_f32 v7, v7
  v_lshrrev_b32 v7, v8, v7
  v_lshl_add_u32 v7, v8, 8, v7
  v_lshl_add_u32 v200, v7, 2, s18
  v_subrev_u32 v6, 1, v5
  v_max_i32 v7, 0, v6
  v_cvt_f32_u32 v7, v7
  v_cvt_pk_bf16_f32 v8, v7, v7
  v_and_b32 v7, 0xffff0000, v8
  v_lshrrev_b32 v8, 23, v7
  v_subrev_u32 v8, 134, v8
  v_max_i32 v8, 0, v8
  v_cvt_u32_f32 v7, v7
  v_lshrrev_b32 v7, v8, v7
  v_lshl_add_u32 v7, v8, 8, v7
  v_lshl_add_u32 v201, v7, 2, s18
  v_subrev_u32 v6, 2, v5
  v_max_i32 v7, 0, v6
  v_cvt_f32_u32 v7, v7
  v_cvt_pk_bf16_f32 v8, v7, v7
  v_and_b32 v7, 0xffff0000, v8
  v_lshrrev_b32 v8, 23, v7
  v_subrev_u32 v8, 134, v8
  v_max_i32 v8, 0, v8
  v_cvt_u32_f32 v7, v7
  v_lshrrev_b32 v7, v8, v7
  v_lshl_add_u32 v7, v8, 8, v7
  v_lshl_add_u32 v202, v7, 2, s18
  v_subrev_u32 v6, 3, v5
  v_max_i32 v7, 0, v6
  v_cvt_f32_u32 v7, v7
  v_cvt_pk_bf16_f32 v8, v7, v7
  v_and_b32 v7, 0xffff0000, v8
  v_lshrrev_b32 v8, 23, v7
  v_subrev_u32 v8, 134, v8
  v_max_i32 v8, 0, v8
  v_cvt_u32_f32 v7, v7
  v_lshrrev_b32 v7, v8, v7
  v_lshl_add_u32 v7, v8, 8, v7
  v_lshl_add_u32 v203, v7, 2, s18
  v_subrev_u32 v6, 4, v5
  v_max_i32 v7, 0, v6
  v_cvt_f32_u32 v7, v7
  v_cvt_pk_bf16_f32 v8, v7, v7
  v_and_b32 v7, 0xffff0000, v8
  v_lshrrev_b32 v8, 23, v7
  v_subrev_u32 v8, 134, v8
  v_max_i32 v8, 0, v8
  v_cvt_u32_f32 v7, v7
  v_lshrrev_b32 v7, v8, v7
  v_lshl_add_u32 v7, v8, 8, v7
  v_lshl_add_u32 v204, v7, 2, s18
  v_subrev_u32 v6, 5, v5
  v_max_i32 v7, 0, v6
  v_cvt_f32_u32 v7, v7
  v_cvt_pk_bf16_f32 v8, v7, v7
  v_and_b32 v7, 0xffff0000, v8
  v_lshrrev_b32 v8, 23, v7
  v_subrev_u32 v8, 134, v8
  v_max_i32 v8, 0, v8
  v_cvt_u32_f32 v7, v7
  v_lshrrev_b32 v7, v8, v7
  v_lshl_add_u32 v7, v8, 8, v7
  v_lshl_add_u32 v205, v7, 2, s18
  v_subrev_u32 v6, 6, v5
  v_max_i32 v7, 0, v6
  v_cvt_f32_u32 v7, v7
  v_cvt_pk_bf16_f32 v8, v7, v7
  v_and_b32 v7, 0xffff0000, v8
  v_lshrrev_b32 v8, 23, v7
  v_subrev_u32 v8, 134, v8
  v_max_i32 v8, 0, v8
  v_cvt_u32_f32 v7, v7
  v_lshrrev_b32 v7, v8, v7
  v_lshl_add_u32 v7, v8, 8, v7
  v_lshl_add_u32 v206, v7, 2, s18
  v_subrev_u32 v6, 7, v5
  v_max_i32 v7, 0, v6
  v_cvt_f32_u32 v7, v7
  v_cvt_pk_bf16_f32 v8, v7, v7
  v_and_b32 v7, 0xffff0000, v8
  v_lshrrev_b32 v8, 23, v7
  v_subrev_u32 v8, 134, v8
  v_max_i32 v8, 0, v8
  v_cvt_u32_f32 v7, v7
  v_lshrrev_b32 v7, v8, v7
  v_lshl_add_u32 v7, v8, 8, v7
  v_lshl_add_u32 v207, v7, 2, s18
  v_subrev_u32 v6, 8, v5
  v_max_i32 v7, 0, v6
  v_cvt_f32_u32 v7, v7
  v_cvt_pk_bf16_f32 v8, v7, v7
  v_and_b32 v7, 0xffff0000, v8
  v_lshrrev_b32 v8, 23, v7
  v_subrev_u32 v8, 134, v8
  v_max_i32 v8, 0, v8
  v_cvt_u32_f32 v7, v7
  v_lshrrev_b32 v7, v8, v7
  v_lshl_add_u32 v7, v8, 8, v7
  v_lshl_add_u32 v208, v7, 2, s18
  v_subrev_u32 v6, 9, v5
  v_max_i32 v7, 0, v6
  v_cvt_f32_u32 v7, v7
  v_cvt_pk_bf16_f32 v8, v7, v7
  v_and_b32 v7, 0xffff0000, v8
  v_lshrrev_b32 v8, 23, v7
  v_subrev_u32 v8, 134, v8
  v_max_i32 v8, 0, v8
  v_cvt_u32_f32 v7, v7
  v_lshrrev_b32 v7, v8, v7
  v_lshl_add_u32 v7, v8, 8, v7
  v_lshl_add_u32 v209, v7, 2, s18
  v_subrev_u32 v6, 10, v5
  v_max_i32 v7, 0, v6
  v_cvt_f32_u32 v7, v7
  v_cvt_pk_bf16_f32 v8, v7, v7
  v_and_b32 v7, 0xffff0000, v8
  v_lshrrev_b32 v8, 23, v7
  v_subrev_u32 v8, 134, v8
  v_max_i32 v8, 0, v8
  v_cvt_u32_f32 v7, v7
  v_lshrrev_b32 v7, v8, v7
  v_lshl_add_u32 v7, v8, 8, v7
  v_lshl_add_u32 v210, v7, 2, s18
  v_subrev_u32 v6, 11, v5
  v_max_i32 v7, 0, v6
  v_cvt_f32_u32 v7, v7
  v_cvt_pk_bf16_f32 v8, v7, v7
  v_and_b32 v7, 0xffff0000, v8
  v_lshrrev_b32 v8, 23, v7
  v_subrev_u32 v8, 134, v8
  v_max_i32 v8, 0, v8
  v_cvt_u32_f32 v7, v7
  v_lshrrev_b32 v7, v8, v7
  v_lshl_add_u32 v7, v8, 8, v7
  v_lshl_add_u32 v211, v7, 2, s18
  v_subrev_u32 v6, 12, v5
  v_max_i32 v7, 0, v6
  v_cvt_f32_u32 v7, v7
  v_cvt_pk_bf16_f32 v8, v7, v7
  v_and_b32 v7, 0xffff0000, v8
  v_lshrrev_b32 v8, 23, v7
  v_subrev_u32 v8, 134, v8
  v_max_i32 v8, 0, v8
  v_cvt_u32_f32 v7, v7
  v_lshrrev_b32 v7, v8, v7
  v_lshl_add_u32 v7, v8, 8, v7
  v_lshl_add_u32 v212, v7, 2, s18
  v_subrev_u32 v6, 13, v5
  v_max_i32 v7, 0, v6
  v_cvt_f32_u32 v7, v7
  v_cvt_pk_bf16_f32 v8, v7, v7
  v_and_b32 v7, 0xffff0000, v8
  v_lshrrev_b32 v8, 23, v7
  v_subrev_u32 v8, 134, v8
  v_max_i32 v8, 0, v8
  v_cvt_u32_f32 v7, v7
  v_lshrrev_b32 v7, v8, v7
  v_lshl_add_u32 v7, v8, 8, v7
  v_lshl_add_u32 v213, v7, 2, s18
  v_subrev_u32 v6, 14, v5
  v_max_i32 v7, 0, v6
  v_cvt_f32_u32 v7, v7
  v_cvt_pk_bf16_f32 v8, v7, v7
  v_and_b32 v7, 0xffff0000, v8
  v_lshrrev_b32 v8, 23, v7
  v_subrev_u32 v8, 134, v8
  v_max_i32 v8, 0, v8
  v_cvt_u32_f32 v7, v7
  v_lshrrev_b32 v7, v8, v7
  v_lshl_add_u32 v7, v8, 8, v7
  v_lshl_add_u32 v214, v7, 2, s18
  v_subrev_u32 v6, 15, v5
  v_max_i32 v7, 0, v6
  v_cvt_f32_u32 v7, v7
  v_cvt_pk_bf16_f32 v8, v7, v7
  v_and_b32 v7, 0xffff0000, v8
  v_lshrrev_b32 v8, 23, v7
  v_subrev_u32 v8, 134, v8
  v_max_i32 v8, 0, v8
  v_cvt_u32_f32 v7, v7
  v_lshrrev_b32 v7, v8, v7
  v_lshl_add_u32 v7, v8, 8, v7
  v_lshl_add_u32 v215, v7, 2, s18
  v_subrev_u32 v6, 16, v5
  v_max_i32 v7, 0, v6
  v_cvt_f32_u32 v7, v7
  v_cvt_pk_bf16_f32 v8, v7, v7
  v_and_b32 v7, 0xffff0000, v8
  v_lshrrev_b32 v8, 23, v7
  v_subrev_u32 v8, 134, v8
  v_max_i32 v8, 0, v8
  v_cvt_u32_f32 v7, v7
  v_lshrrev_b32 v7, v8, v7
  v_lshl_add_u32 v7, v8, 8, v7
  v_lshl_add_u32 v216, v7, 2, s18
  v_subrev_u32 v6, 17, v5
  v_max_i32 v7, 0, v6
  v_cvt_f32_u32 v7, v7
  v_cvt_pk_bf16_f32 v8, v7, v7
  v_and_b32 v7, 0xffff0000, v8
  v_lshrrev_b32 v8, 23, v7
  v_subrev_u32 v8, 134, v8
  v_max_i32 v8, 0, v8
  v_cvt_u32_f32 v7, v7
  v_lshrrev_b32 v7, v8, v7
  v_lshl_add_u32 v7, v8, 8, v7
  v_lshl_add_u32 v217, v7, 2, s18
  v_subrev_u32 v6, 18, v5
  v_max_i32 v7, 0, v6
  v_cvt_f32_u32 v7, v7
  v_cvt_pk_bf16_f32 v8, v7, v7
  v_and_b32 v7, 0xffff0000, v8
  v_lshrrev_b32 v8, 23, v7
  v_subrev_u32 v8, 134, v8
  v_max_i32 v8, 0, v8
  v_cvt_u32_f32 v7, v7
  v_lshrrev_b32 v7, v8, v7
  v_lshl_add_u32 v7, v8, 8, v7
  v_lshl_add_u32 v218, v7, 2, s18
  v_subrev_u32 v6, 19, v5
  v_max_i32 v7, 0, v6
  v_cvt_f32_u32 v7, v7
  v_cvt_pk_bf16_f32 v8, v7, v7
  v_and_b32 v7, 0xffff0000, v8
  v_lshrrev_b32 v8, 23, v7
  v_subrev_u32 v8, 134, v8
  v_max_i32 v8, 0, v8
  v_cvt_u32_f32 v7, v7
  v_lshrrev_b32 v7, v8, v7
  v_lshl_add_u32 v7, v8, 8, v7
  v_lshl_add_u32 v219, v7, 2, s18
  v_subrev_u32 v6, 20, v5
  v_max_i32 v7, 0, v6
  v_cvt_f32_u32 v7, v7
  v_cvt_pk_bf16_f32 v8, v7, v7
  v_and_b32 v7, 0xffff0000, v8
  v_lshrrev_b32 v8, 23, v7
  v_subrev_u32 v8, 134, v8
  v_max_i32 v8, 0, v8
  v_cvt_u32_f32 v7, v7
  v_lshrrev_b32 v7, v8, v7
  v_lshl_add_u32 v7, v8, 8, v7
  v_lshl_add_u32 v220, v7, 2, s18
  v_subrev_u32 v6, 21, v5
  v_max_i32 v7, 0, v6
  v_cvt_f32_u32 v7, v7
  v_cvt_pk_bf16_f32 v8, v7, v7
  v_and_b32 v7, 0xffff0000, v8
  v_lshrrev_b32 v8, 23, v7
  v_subrev_u32 v8, 134, v8
  v_max_i32 v8, 0, v8
  v_cvt_u32_f32 v7, v7
  v_lshrrev_b32 v7, v8, v7
  v_lshl_add_u32 v7, v8, 8, v7
  v_lshl_add_u32 v221, v7, 2, s18
  v_subrev_u32 v6, 22, v5
  v_max_i32 v7, 0, v6
  v_cvt_f32_u32 v7, v7
  v_cvt_pk_bf16_f32 v8, v7, v7
  v_and_b32 v7, 0xffff0000, v8
  v_lshrrev_b32 v8, 23, v7
  v_subrev_u32 v8, 134, v8
  v_max_i32 v8, 0, v8
  v_cvt_u32_f32 v7, v7
  v_lshrrev_b32 v7, v8, v7
  v_lshl_add_u32 v7, v8, 8, v7
  v_lshl_add_u32 v222, v7, 2, s18
  v_subrev_u32 v6, 23, v5
  v_max_i32 v7, 0, v6
  v_cvt_f32_u32 v7, v7
  v_cvt_pk_bf16_f32 v8, v7, v7
  v_and_b32 v7, 0xffff0000, v8
  v_lshrrev_b32 v8, 23, v7
  v_subrev_u32 v8, 134, v8
  v_max_i32 v8, 0, v8
  v_cvt_u32_f32 v7, v7
  v_lshrrev_b32 v7, v8, v7
  v_lshl_add_u32 v7, v8, 8, v7
  v_lshl_add_u32 v223, v7, 2, s18
  v_subrev_u32 v6, 24, v5
  v_max_i32 v7, 0, v6
  v_cvt_f32_u32 v7, v7
  v_cvt_pk_bf16_f32 v8, v7, v7
  v_and_b32 v7, 0xffff0000, v8
  v_lshrrev_b32 v8, 23, v7
  v_subrev_u32 v8, 134, v8
  v_max_i32 v8, 0, v8
  v_cvt_u32_f32 v7, v7
  v_lshrrev_b32 v7, v8, v7
  v_lshl_add_u32 v7, v8, 8, v7
  v_lshl_add_u32 v224, v7, 2, s18
  v_subrev_u32 v6, 25, v5
  v_max_i32 v7, 0, v6
  v_cvt_f32_u32 v7, v7
  v_cvt_pk_bf16_f32 v8, v7, v7
  v_and_b32 v7, 0xffff0000, v8
  v_lshrrev_b32 v8, 23, v7
  v_subrev_u32 v8, 134, v8
  v_max_i32 v8, 0, v8
  v_cvt_u32_f32 v7, v7
  v_lshrrev_b32 v7, v8, v7
  v_lshl_add_u32 v7, v8, 8, v7
  v_lshl_add_u32 v225, v7, 2, s18
  v_subrev_u32 v6, 26, v5
  v_max_i32 v7, 0, v6
  v_cvt_f32_u32 v7, v7
  v_cvt_pk_bf16_f32 v8, v7, v7
  v_and_b32 v7, 0xffff0000, v8
  v_lshrrev_b32 v8, 23, v7
  v_subrev_u32 v8, 134, v8
  v_max_i32 v8, 0, v8
  v_cvt_u32_f32 v7, v7
  v_lshrrev_b32 v7, v8, v7
  v_lshl_add_u32 v7, v8, 8, v7
  v_lshl_add_u32 v226, v7, 2, s18
  v_subrev_u32 v6, 27, v5
  v_max_i32 v7, 0, v6
  v_cvt_f32_u32 v7, v7
  v_cvt_pk_bf16_f32 v8, v7, v7
  v_and_b32 v7, 0xffff0000, v8
  v_lshrrev_b32 v8, 23, v7
  v_subrev_u32 v8, 134, v8
  v_max_i32 v8, 0, v8
  v_cvt_u32_f32 v7, v7
  v_lshrrev_b32 v7, v8, v7
  v_lshl_add_u32 v7, v8, 8, v7
  v_lshl_add_u32 v227, v7, 2, s18
  v_subrev_u32 v6, 28, v5
  v_max_i32 v7, 0, v6
  v_cvt_f32_u32 v7, v7
  v_cvt_pk_bf16_f32 v8, v7, v7
  v_and_b32 v7, 0xffff0000, v8
  v_lshrrev_b32 v8, 23, v7
  v_subrev_u32 v8, 134, v8
  v_max_i32 v8, 0, v8
  v_cvt_u32_f32 v7, v7
  v_lshrrev_b32 v7, v8, v7
  v_lshl_add_u32 v7, v8, 8, v7
  v_lshl_add_u32 v228, v7, 2, s18
  v_subrev_u32 v6, 29, v5
  v_max_i32 v7, 0, v6
  v_cvt_f32_u32 v7, v7
  v_cvt_pk_bf16_f32 v8, v7, v7
  v_and_b32 v7, 0xffff0000, v8
  v_lshrrev_b32 v8, 23, v7
  v_subrev_u32 v8, 134, v8
  v_max_i32 v8, 0, v8
  v_cvt_u32_f32 v7, v7
  v_lshrrev_b32 v7, v8, v7
  v_lshl_add_u32 v7, v8, 8, v7
  v_lshl_add_u32 v229, v7, 2, s18
  v_subrev_u32 v6, 30, v5
  v_max_i32 v7, 0, v6
  v_cvt_f32_u32 v7, v7
  v_cvt_pk_bf16_f32 v8, v7, v7
  v_and_b32 v7, 0xffff0000, v8
  v_lshrrev_b32 v8, 23, v7
  v_subrev_u32 v8, 134, v8
  v_max_i32 v8, 0, v8
  v_cvt_u32_f32 v7, v7
  v_lshrrev_b32 v7, v8, v7
  v_lshl_add_u32 v7, v8, 8, v7
  v_lshl_add_u32 v230, v7, 2, s18
  v_subrev_u32 v6, 31, v5
  v_max_i32 v7, 0, v6
  v_cvt_f32_u32 v7, v7
  v_cvt_pk_bf16_f32 v8, v7, v7
  v_and_b32 v7, 0xffff0000, v8
  v_lshrrev_b32 v8, 23, v7
  v_subrev_u32 v8, 134, v8
  v_max_i32 v8, 0, v8
  v_cvt_u32_f32 v7, v7
  v_lshrrev_b32 v7, v8, v7
  v_lshl_add_u32 v7, v8, 8, v7
  v_lshl_add_u32 v231, v7, 2, s18
  v_subrev_u32 v6, 32, v5
  v_max_i32 v7, 0, v6
  v_cvt_f32_u32 v7, v7
  v_cvt_pk_bf16_f32 v8, v7, v7
  v_and_b32 v7, 0xffff0000, v8
  v_lshrrev_b32 v8, 23, v7
  v_subrev_u32 v8, 134, v8
  v_max_i32 v8, 0, v8
  v_cvt_u32_f32 v7, v7
  v_lshrrev_b32 v7, v8, v7
  v_lshl_add_u32 v7, v8, 8, v7
  v_mov_b32 v8, 1280
  v_cmp_gt_i32 vcc, 0, v6
  s_nop 1
  v_cndmask_b32 v7, v7, v8, vcc
  v_lshl_add_u32 v232, v7, 2, s18
  v_mov_b32 v8, 0
  v_mov_b32 v9, 0
  v_lshlrev_b32 v5, 3, v1
  v_add_u32 v5, s17, v5
  ds_write_b64 v5, v[8:9]
  v_and_b32 v6, 15, v1
  v_lshlrev_b32 v6, 3, v6
  v_add_u32 v6, s17, v6
  ds_write_b64 v6, v[8:9] offset:8704
  ds_write_b64 v6, v[8:9] offset:12928
  v_mov_b32 v6, s17
  ds_write_b64 v6, v[8:9] offset:18176
  s_lshl_b32 s19, s3, 2
  s_add_u32 s20, s19, s16
  s_lshl_b32 s21, s3, 3
  v_mul_u32_u24 v5, 3584, v0
  s_add_u32 s22, s21, 0
  buffer_load_dwordx2 v[8:9], v5, s[60:63], s22 offen offset:0
  buffer_load_dwordx2 v[10:11], v5, s[60:63], s22 offen offset:896
  buffer_load_dwordx2 v[12:13], v5, s[60:63], s22 offen offset:1792
  buffer_load_dwordx2 v[14:15], v5, s[60:63], s22 offen offset:2688
  s_add_u32 s22, s21, 917504
  buffer_load_dwordx2 v[16:17], v5, s[60:63], s22 offen offset:0
  buffer_load_dwordx2 v[18:19], v5, s[60:63], s22 offen offset:896
  buffer_load_dwordx2 v[20:21], v5, s[60:63], s22 offen offset:1792
  buffer_load_dwordx2 v[22:23], v5, s[60:63], s22 offen offset:2688
  s_lshl_b32 s22, s20, 9
  v_lshlrev_b32 v6, 3, v1
  buffer_load_dwordx2 v[24:25], v6, s[64:67], s22 offen
  buffer_load_dwordx2 v[26:27], v6, s[68:71], s22 offen
  buffer_load_dwordx2 v[28:29], v6, s[72:75], s22 offen
  buffer_load_dwordx2 v[30:31], v6, s[76:79], s22 offen
  s_lshl_b32 s22, s20, 1
  v_mov_b32 v7, 0
  buffer_load_ushort v32, v7, s[80:83], s22 offen
  buffer_load_ushort v33, v7, s[84:87], s22 offen
  s_mov_b32 s24, 0x05040100
  s_mov_b32 s25, 0x07060302
  s_barrier
  s_waitcnt vmcnt(6)
  v_lshlrev_b32 v6, 3, v0
  v_perm_b32 v34, v10, v8, s24
  v_perm_b32 v35, v14, v12, s24
  v_add_u32 v36, 512, v6
  ds_write_b64 v36, v[34:35]
  v_perm_b32 v34, v10, v8, s25
  v_perm_b32 v35, v14, v12, s25
  v_add_u32 v36, 25088, v6
  ds_write_b64 v36, v[34:35]
  v_perm_b32 v34, v11, v9, s24
  v_perm_b32 v35, v15, v13, s24
  v_add_u32 v36, 49664, v6
  ds_write_b64 v36, v[34:35]
  v_perm_b32 v34, v11, v9, s25
  v_perm_b32 v35, v15, v13, s25
  v_add_u32 v36, 74240, v6
  ds_write_b64 v36, v[34:35]
  v_perm_b32 v34, v18, v16, s24
  v_perm_b32 v35, v22, v20, s24
  v_add_u32 v36, 2560, v6
  ds_write_b64 v36, v[34:35]
  v_perm_b32 v34, v18, v16, s25
  v_perm_b32 v35, v22, v20, s25
  v_add_u32 v36, 27136, v6
  ds_write_b64 v36, v[34:35]
  v_perm_b32 v34, v19, v17, s24
  v_perm_b32 v35, v23, v21, s24
  v_add_u32 v36, 51712, v6
  ds_write_b64 v36, v[34:35]
  v_perm_b32 v34, v19, v17, s25
  v_perm_b32 v35, v23, v21, s25
  v_add_u32 v36, 76288, v6
  ds_write_b64 v36, v[34:35]
  s_waitcnt vmcnt(0)
  s_mov_b32 s26, 1069066811
  s_mov_b32 s27, 1042479491
  v_lshlrev_b32 v32, 16, v32
  v_lshlrev_b32 v33, 16, v33
  v_mul_f32 v32, s26, v32
  v_exp_f32 v32, v32
  s_nop 0
  v_cvt_pk_bf16_f32 v34, v32, v32
  v_and_b32 v32, 0xffff0000, v34
  v_lshlrev_b32 v37, 6, v1
  v_add_u32 v37, s17, v37
  v_lshlrev_b32 v40, 16, v24
  v_lshlrev_b32 v41, 16, v26
  v_lshlrev_b32 v42, 16, v28
  v_lshlrev_b32 v43, 16, v30
  v_mul_f32 v40, s26, v40
  v_exp_f32 v40, v40
  s_nop 0
  v_cvt_pk_bf16_f32 v34, v40, v40
  v_and_b32 v40, 0xffff0000, v34
  v_mul_f32 v40, v40, v32
  v_mul_f32 v40, s26, v40
  v_sub_f32 v40, 0, v40
  v_mul_f32 v41, v41, v32
  v_mul_f32 v41, s27, v41
  v_mul_f32 v42, v42, v32
  v_mul_f32 v43, v43, v32
  v_add_f32 v42, v42, v42
  v_add_f32 v43, v43, v43
  ds_write_b128 v37, v[40:43] offset:18240
  v_and_b32 v40, 0xffff0000, v24
  v_and_b32 v41, 0xffff0000, v26
  v_and_b32 v42, 0xffff0000, v28
  v_and_b32 v43, 0xffff0000, v30
  v_mul_f32 v40, s26, v40
  v_exp_f32 v40, v40
  s_nop 0
  v_cvt_pk_bf16_f32 v34, v40, v40
  v_and_b32 v40, 0xffff0000, v34
  v_mul_f32 v40, v40, v32
  v_mul_f32 v40, s26, v40
  v_sub_f32 v40, 0, v40
  v_mul_f32 v41, v41, v32
  v_mul_f32 v41, s27, v41
  v_mul_f32 v42, v42, v32
  v_mul_f32 v43, v43, v32
  v_add_f32 v42, v42, v42
  v_add_f32 v43, v43, v43
  ds_write_b128 v37, v[40:43] offset:18256
  v_lshlrev_b32 v40, 16, v25
  v_lshlrev_b32 v41, 16, v27
  v_lshlrev_b32 v42, 16, v29
  v_lshlrev_b32 v43, 16, v31
  v_mul_f32 v40, s26, v40
  v_exp_f32 v40, v40
  s_nop 0
  v_cvt_pk_bf16_f32 v34, v40, v40
  v_and_b32 v40, 0xffff0000, v34
  v_mul_f32 v40, v40, v32
  v_mul_f32 v40, s26, v40
  v_sub_f32 v40, 0, v40
  v_mul_f32 v41, v41, v32
  v_mul_f32 v41, s27, v41
  v_mul_f32 v42, v42, v32
  v_mul_f32 v43, v43, v32
  v_add_f32 v42, v42, v42
  v_add_f32 v43, v43, v43
  ds_write_b128 v37, v[40:43] offset:18272
  v_and_b32 v40, 0xffff0000, v25
  v_and_b32 v41, 0xffff0000, v27
  v_and_b32 v42, 0xffff0000, v29
  v_and_b32 v43, 0xffff0000, v31
  v_mul_f32 v40, s26, v40
  v_exp_f32 v40, v40
  s_nop 0
  v_cvt_pk_bf16_f32 v34, v40, v40
  v_and_b32 v40, 0xffff0000, v34
  v_mul_f32 v40, v40, v32
  v_mul_f32 v40, s26, v40
  v_sub_f32 v40, 0, v40
  v_mul_f32 v41, v41, v32
  v_mul_f32 v41, s27, v41
  v_mul_f32 v42, v42, v32
  v_mul_f32 v43, v43, v32
  v_add_f32 v42, v42, v42
  v_add_f32 v43, v43, v43
  ds_write_b128 v37, v[40:43] offset:18288
  v_cvt_f32_u32 v44, v4
  v_lshlrev_b32 v45, 4, v4
  v_cvt_f32_u32 v45, v45
  v_lshlrev_b32 v46, 4, v3
  v_add_u32 v46, s17, v46
  v_mov_b32 v48, 0
  v_mov_b32 v49, 0
  v_mov_b32 v50, 0
  v_mov_b32 v51, 0
  v_mov_b32 v52, 0
  v_mov_b32 v53, 0
  v_mov_b32 v54, 0
  v_mov_b32 v55, 0
  v_mov_b32 v56, 0
  v_mov_b32 v57, 0
  v_mov_b32 v58, 0
  v_mov_b32 v59, 0
  v_mov_b32 v60, 0
  v_mov_b32 v61, 0
  v_mov_b32 v62, 0
  v_mov_b32 v63, 0
  v_mov_b32 v64, 0
  v_mov_b32 v65, 0
  v_mov_b32 v66, 0
  v_mov_b32 v67, 0
  s_mov_b32 s28, 0
  s_waitcnt lgkmcnt(0)
  ds_read_b128 v[68:71], v46 offset:18240
wk_kl:
  s_waitcnt lgkmcnt(0)
  v_mov_b32 v72, v68
  v_mov_b32 v73, v69
  v_mov_b32 v74, v70
  v_mov_b32 v75, v71
  v_add_u32 v46, 64, v46
  ds_read_b128 v[68:71], v46 offset:18240
  v_mul_f32 v80, v72, v45
  v_mul_f32 v81, v73, v45
  v_exp_f32 v80, v80
  v_fract_f32 v81, v81
  v_cos_f32 v76, v81
  v_sin_f32 v77, v81
  v_mul_f32 v76, v76, v80
  v_mul_f32 v77, v77, v80
  v_mul_f32 v80, v72, v44
  v_mul_f32 v81, v73, v44
  v_exp_f32 v80, v80
  v_fract_f32 v81, v81
  v_cos_f32 v78, v81
  v_sin_f32 v79, v81
  v_mul_f32 v78, v78, v80
  v_mul_f32 v79, v79, v80
  v_mul_f32 v82, v74, v76
  v_mul_f32 v83, v74, v77
  v_fma_f32 v82, -v75, v77, v82
  v_fma_f32 v83, -v75, v76, -v83
  v_mul_f32 v86, v76, v76
  v_mul_f32 v87, v76, v77
  v_fma_f32 v86, -v77, v77, v86
  v_add_f32 v87, v87, v87
  v_mfma_f32_16x16x4_f32 v[48:51], v82, v78, v[48:51]
  v_mul_f32 v88, v78, v78
  v_mul_f32 v89, v78, v79
  v_fma_f32 v88, -v79, v79, v88
  v_add_f32 v89, v89, v89
  v_mfma_f32_16x16x4_f32 v[48:51], v83, v79, v[48:51]
  v_mul_f32 v84, v74, v86
  v_mul_f32 v85, v74, v87
  v_fma_f32 v84, -v75, v87, v84
  v_fma_f32 v85, -v75, v86, -v85
  v_mul_f32 v76, v86, v86
  v_mul_f32 v77, v86, v87
  v_fma_f32 v76, -v87, v87, v76
  v_add_f32 v77, v77, v77
  v_mfma_f32_16x16x4_f32 v[52:55], v84, v88, v[52:55]
  v_mul_f32 v78, v88, v88
  v_mul_f32 v79, v88, v89
  v_fma_f32 v78, -v89, v89, v78
  v_add_f32 v79, v79, v79
  v_mfma_f32_16x16x4_f32 v[52:55], v85, v89, v[52:55]
  v_mul_f32 v82, v74, v76
  v_mul_f32 v83, v74, v77
  v_fma_f32 v82, -v75, v77, v82
  v_fma_f32 v83, -v75, v76, -v83
  v_mul_f32 v86, v76, v76
  v_mul_f32 v87, v76, v77
  v_fma_f32 v86, -v77, v77, v86
  v_add_f32 v87, v87, v87
  v_mfma_f32_16x16x4_f32 v[56:59], v82, v78, v[56:59]
  v_mul_f32 v88, v78, v78
  v_mul_f32 v89, v78, v79
  v_fma_f32 v88, -v79, v79, v88
  v_add_f32 v89, v89, v89
  v_mfma_f32_16x16x4_f32 v[56:59], v83, v79, v[56:59]
  v_mul_f32 v84, v74, v86
  v_mul_f32 v85, v74, v87
  v_fma_f32 v84, -v75, v87, v84
  v_fma_f32 v85, -v75, v86, -v85
  v_mul_f32 v76, v86, v86
  v_mul_f32 v77, v86, v87
  v_fma_f32 v76, -v87, v87, v76
  v_add_f32 v77, v77, v77
  v_mfma_f32_16x16x4_f32 v[60:63], v84, v88, v[60:63]
  v_mfma_f32_16x16x4_f32 v[60:63], v85, v89, v[60:63]
  v_mul_f32 v82, v74, v76
  v_fma_f32 v82, -v75, v77, v82
  s_nop 1
  v_mfma_f32_16x16x4_f32 v[64:67], v82, v88, v[64:67]
  s_add_u32 s28, s28, 1
  s_cmp_lt_u32 s28, 64
  s_cbranch_scc1 wk_kl
  s_nop 15
  s_nop 3
  v_lshlrev_b32 v46, 8, v3
  v_lshl_add_u32 v46, v4, 2, v46
  v_add_u32 v46, s17, v46
  ds_write_b32 v46, v48 offset:13056
  ds_write_b32 v46, v49 offset:13120
  ds_write_b32 v46, v50 offset:13184
  ds_write_b32 v46, v51 offset:13248
  s_waitcnt lgkmcnt(8)
  ds_write_b32 v46, v52 offset:14080
  ds_write_b32 v46, v53 offset:14144
  ds_write_b32 v46, v54 offset:14208
  ds_write_b32 v46, v55 offset:14272
  s_waitcnt lgkmcnt(8)
  ds_write_b32 v46, v56 offset:15104
  ds_write_b32 v46, v57 offset:15168
  ds_write_b32 v46, v58 offset:15232
  ds_write_b32 v46, v59 offset:15296
  s_waitcnt lgkmcnt(8)
  ds_write_b32 v46, v60 offset:16128
  ds_write_b32 v46, v61 offset:16192
  ds_write_b32 v46, v62 offset:16256
  ds_write_b32 v46, v63 offset:16320
  s_waitcnt lgkmcnt(8)
  ds_write_b32 v46, v64 offset:17152
  ds_write_b32 v46, v65 offset:17216
  ds_write_b32 v46, v66 offset:17280
  ds_write_b32 v46, v67 offset:17344
  s_waitcnt lgkmcnt(8)
  s_waitcnt lgkmcnt(0)
  ds_read_b32 v48, v200
  ds_read_b32 v49, v201
  ds_read_b32 v50, v202
  ds_read_b32 v51, v203
  ds_read_b32 v52, v204
  ds_read_b32 v53, v205
  ds_read_b32 v54, v206
  ds_read_b32 v55, v207
  s_waitcnt lgkmcnt(4)
  ds_read_b32 v56, v208
  ds_read_b32 v57, v209
  ds_read_b32 v58, v210
  ds_read_b32 v59, v211
  ds_read_b32 v60, v212
  ds_read_b32 v61, v213
  ds_read_b32 v62, v214
  ds_read_b32 v63, v215
  s_waitcnt lgkmcnt(4)
  ds_read_b32 v64, v216
  ds_read_b32 v65, v217
  ds_read_b32 v66, v218
  ds_read_b32 v67, v219
  ds_read_b32 v68, v220
  ds_read_b32 v69, v221
  ds_read_b32 v70, v222
  ds_read_b32 v71, v223
  s_waitcnt lgkmcnt(4)
  ds_read_b32 v72, v224
  ds_read_b32 v73, v225
  ds_read_b32 v74, v226
  ds_read_b32 v75, v227
  ds_read_b32 v76, v228
  ds_read_b32 v77, v229
  ds_read_b32 v78, v230
  ds_read_b32 v79, v231
  s_waitcnt lgkmcnt(4)
  ds_read_b32 v80, v232
  s_waitcnt lgkmcnt(0)
  v_lshlrev_b32 v46, 6, v1
  v_add_u32 v46, s17, v46
  v_cvt_pk_bf16_f32 v84, v48, v49
  v_cvt_pk_bf16_f32 v88, v49, v50
  v_cvt_pk_bf16_f32 v85, v50, v51
  v_cvt_pk_bf16_f32 v89, v51, v52
  v_cvt_pk_bf16_f32 v86, v52, v53
  v_cvt_pk_bf16_f32 v90, v53, v54
  v_cvt_pk_bf16_f32 v87, v54, v55
  v_cvt_pk_bf16_f32 v91, v55, v56
  ds_write_b128 v46, v[84:87] offset:4608
  ds_write_b128 v46, v[88:91] offset:8832
  s_waitcnt lgkmcnt(0)
  v_cvt_pk_bf16_f32 v84, v56, v57
  v_cvt_pk_bf16_f32 v88, v57, v58
  v_cvt_pk_bf16_f32 v85, v58, v59
  v_cvt_pk_bf16_f32 v89, v59, v60
  v_cvt_pk_bf16_f32 v86, v60, v61
  v_cvt_pk_bf16_f32 v90, v61, v62
  v_cvt_pk_bf16_f32 v87, v62, v63
  v_cvt_pk_bf16_f32 v91, v63, v64
  ds_write_b128 v46, v[84:87] offset:4624
  ds_write_b128 v46, v[88:91] offset:8848
  s_waitcnt lgkmcnt(0)
  v_cvt_pk_bf16_f32 v84, v64, v65
  v_cvt_pk_bf16_f32 v88, v65, v66
  v_cvt_pk_bf16_f32 v85, v66, v67
  v_cvt_pk_bf16_f32 v89, v67, v68
  v_cvt_pk_bf16_f32 v86, v68, v69
  v_cvt_pk_bf16_f32 v90, v69, v70
  v_cvt_pk_bf16_f32 v87, v70, v71
  v_cvt_pk_bf16_f32 v91, v71, v72
  ds_write_b128 v46, v[84:87] offset:4640
  ds_write_b128 v46, v[88:91] offset:8864
  s_waitcnt lgkmcnt(0)
  v_cvt_pk_bf16_f32 v84, v72, v73
  v_cvt_pk_bf16_f32 v88, v73, v74
  v_cvt_pk_bf16_f32 v85, v74, v75
  v_cvt_pk_bf16_f32 v89, v75, v76
  v_cvt_pk_bf16_f32 v86, v76, v77
  v_cvt_pk_bf16_f32 v90, v77, v78
  v_cvt_pk_bf16_f32 v87, v78, v79
  v_cvt_pk_bf16_f32 v91, v79, v80
  ds_write_b128 v46, v[84:87] offset:4656
  ds_write_b128 v46, v[88:91] offset:8880
  s_waitcnt lgkmcnt(0)
  s_barrier
  v_lshrrev_b32 v47, 1, v3
  v_sub_u32 v46, v4, v47
  v_add_u32 v46, 1, v46
  v_lshlrev_b32 v46, 5, v46
  v_and_b32 v48, 1, v3
  v_lshl_add_u32 v46, v48, 4, v46
  v_add_u32 v46, s17, v46
  ds_read_b128 a[0:3], v46 offset:32
  ds_read_b128 a[4:7], v46 offset:96
  ds_read_b128 a[8:11], v46 offset:160
  ds_read_b128 a[12:15], v46 offset:224
  ds_read_b128 a[16:19], v46 offset:288
  ds_read_b128 a[20:23], v46 offset:352
  ds_read_b128 a[24:27], v46 offset:416
  ds_read_b128 a[28:31], v46 offset:480
  s_waitcnt lgkmcnt(4)
  ds_read_b128 a[32:35], v46 offset:544
  ds_read_b128 a[36:39], v46 offset:608
  ds_read_b128 a[40:43], v46 offset:672
  ds_read_b128 a[44:47], v46 offset:736
  ds_read_b128 a[48:51], v46 offset:800
  ds_read_b128 a[52:55], v46 offset:864
  ds_read_b128 a[56:59], v46 offset:928
  ds_read_b128 a[60:63], v46 offset:992
  s_waitcnt lgkmcnt(4)
  ds_read_b128 a[64:67], v46 offset:1056
  ds_read_b128 a[68:71], v46 offset:1120
  ds_read_b128 a[72:75], v46 offset:1184
  ds_read_b128 a[76:79], v46 offset:1248
  ds_read_b128 a[80:83], v46 offset:1312
  ds_read_b128 a[84:87], v46 offset:1376
  ds_read_b128 a[88:91], v46 offset:1440
  ds_read_b128 a[92:95], v46 offset:1504
  s_waitcnt lgkmcnt(4)
  ds_read_b128 a[96:99], v46 offset:1568
  ds_read_b128 a[100:103], v46 offset:1632
  ds_read_b128 a[104:107], v46 offset:1696
  ds_read_b128 a[108:111], v46 offset:1760
  ds_read_b128 a[112:115], v46 offset:1824
  ds_read_b128 a[116:119], v46 offset:1888
  ds_read_b128 a[120:123], v46 offset:1952
  ds_read_b128 a[124:127], v46 offset:2016
  s_waitcnt lgkmcnt(4)
  ds_read_b128 a[128:131], v46 offset:2080
  ds_read_b128 a[132:135], v46 offset:2144
  ds_read_b128 a[136:139], v46 offset:2208
  ds_read_b128 a[140:143], v46 offset:2272
  ds_read_b128 a[144:147], v46 offset:2336
  ds_read_b128 a[148:151], v46 offset:2400
  ds_read_b128 a[152:155], v46 offset:2464
  ds_read_b128 a[156:159], v46 offset:2528
  s_waitcnt lgkmcnt(4)
  ds_read_b128 a[160:163], v46 offset:2592
  ds_read_b128 a[164:167], v46 offset:2656
  ds_read_b128 a[168:171], v46 offset:2720
  ds_read_b128 a[172:175], v46 offset:2784
  ds_read_b128 a[176:179], v46 offset:2848
  ds_read_b128 a[180:183], v46 offset:2912
  ds_read_b128 a[184:187], v46 offset:2976
  ds_read_b128 a[188:191], v46 offset:3040
  s_waitcnt lgkmcnt(4)
  ds_read_b128 a[192:195], v46 offset:3104
  ds_read_b128 a[196:199], v46 offset:3168
  ds_read_b128 a[200:203], v46 offset:3232
  ds_read_b128 a[204:207], v46 offset:3296
  ds_read_b128 a[208:211], v46 offset:3360
  ds_read_b128 a[212:215], v46 offset:3424
  ds_read_b128 a[216:219], v46 offset:3488
  ds_read_b128 a[220:223], v46 offset:3552
  s_waitcnt lgkmcnt(4)
  ds_read_b128 a[224:227], v46 offset:3616
  ds_read_b128 a[228:231], v46 offset:3680
  ds_read_b128 a[232:235], v46 offset:3744
  ds_read_b128 a[236:239], v46 offset:3808
  ds_read_b128 a[240:243], v46 offset:3872
  ds_read_b128 a[244:247], v46 offset:3936
  ds_read_b128 a[248:251], v46 offset:4000
  ds_read_b128 a[252:255], v46 offset:4064
  s_waitcnt lgkmcnt(4)
  v_lshlrev_b32 v49, 4, v47
  v_add_u32 v49, v49, v4
  v_sub_u32 v49, 2047, v49
  v_lshl_add_u32 v49, v48, 3, v49
  v_and_b32 v50, 1, v49
  v_lshrrev_b32 v49, 1, v49
  v_lshlrev_b32 v49, 2, v49
  v_mul_u32_u24 v50, 4224, v50
  v_add3_u32 v49, v49, v50, s17
  v_add_u32 v49, 4608, v49
  v_subrev_u32 v52, 896, v49
  v_subrev_u32 v53, 1856, v49
  v_subrev_u32 v54, 2816, v49
  v_subrev_u32 v55, 3776, v49
  v_subrev_u32 v56, 4736, v49
  s_waitcnt lgkmcnt(0)
  ds_read2_b32 v[92:93], v52 offset0:224 offset1:225
  ds_read2_b32 v[94:95], v52 offset0:226 offset1:227
  ds_read2_b32 v[96:97], v52 offset0:208 offset1:209
  ds_read2_b32 v[98:99], v52 offset0:210 offset1:211
  ds_read2_b32 v[100:101], v52 offset0:192 offset1:193
  ds_read2_b32 v[102:103], v52 offset0:194 offset1:195
  ds_read2_b32 v[104:105], v52 offset0:176 offset1:177
  ds_read2_b32 v[106:107], v52 offset0:178 offset1:179
  s_waitcnt lgkmcnt(6)
  v_mfma_f32_16x16x32_bf16 v[60:63], v[92:95], a[28:31], 0
  v_mfma_f32_16x16x32_bf16 v[64:67], v[92:95], a[60:63], 0
  v_mfma_f32_16x16x32_bf16 v[68:71], v[92:95], a[92:95], 0
  v_mfma_f32_16x16x32_bf16 v[72:75], v[92:95], a[124:127], 0
  v_mfma_f32_16x16x32_bf16 v[76:79], v[92:95], a[156:159], 0
  v_mfma_f32_16x16x32_bf16 v[80:83], v[92:95], a[188:191], 0
  v_mfma_f32_16x16x32_bf16 v[84:87], v[92:95], a[220:223], 0
  v_mfma_f32_16x16x32_bf16 v[88:91], v[92:95], a[252:255], 0
  ds_read2_b32 v[92:93], v52 offset0:160 offset1:161
  ds_read2_b32 v[94:95], v52 offset0:162 offset1:163
  s_waitcnt lgkmcnt(6)
  v_mfma_f32_16x16x32_bf16 v[60:63], v[96:99], a[24:27], v[60:63]
  v_mfma_f32_16x16x32_bf16 v[64:67], v[96:99], a[56:59], v[64:67]
  v_mfma_f32_16x16x32_bf16 v[68:71], v[96:99], a[88:91], v[68:71]
  v_mfma_f32_16x16x32_bf16 v[72:75], v[96:99], a[120:123], v[72:75]
  v_mfma_f32_16x16x32_bf16 v[76:79], v[96:99], a[152:155], v[76:79]
  v_mfma_f32_16x16x32_bf16 v[80:83], v[96:99], a[184:187], v[80:83]
  v_mfma_f32_16x16x32_bf16 v[84:87], v[96:99], a[216:219], v[84:87]
  v_mfma_f32_16x16x32_bf16 v[88:91], v[96:99], a[248:251], v[88:91]
  ds_read2_b32 v[96:97], v52 offset0:144 offset1:145
  ds_read2_b32 v[98:99], v52 offset0:146 offset1:147
  s_waitcnt lgkmcnt(6)
  v_mfma_f32_16x16x32_bf16 v[60:63], v[100:103], a[20:23], v[60:63]
  v_mfma_f32_16x16x32_bf16 v[64:67], v[100:103], a[52:55], v[64:67]
  v_mfma_f32_16x16x32_bf16 v[68:71], v[100:103], a[84:87], v[68:71]
  v_mfma_f32_16x16x32_bf16 v[72:75], v[100:103], a[116:119], v[72:75]
  v_mfma_f32_16x16x32_bf16 v[76:79], v[100:103], a[148:151], v[76:79]
  v_mfma_f32_16x16x32_bf16 v[80:83], v[100:103], a[180:183], v[80:83]
  v_mfma_f32_16x16x32_bf16 v[84:87], v[100:103], a[212:215], v[84:87]
  v_mfma_f32_16x16x32_bf16 v[88:91], v[100:103], a[244:247], v[88:91]
  ds_read2_b32 v[100:101], v52 offset0:128 offset1:129
  ds_read2_b32 v[102:103], v52 offset0:130 offset1:131
  s_waitcnt lgkmcnt(6)
  v_mfma_f32_16x16x32_bf16 v[60:63], v[104:107], a[16:19], v[60:63]
  v_mfma_f32_16x16x32_bf16 v[64:67], v[104:107], a[48:51], v[64:67]
  v_mfma_f32_16x16x32_bf16 v[68:71], v[104:107], a[80:83], v[68:71]
  v_mfma_f32_16x16x32_bf16 v[72:75], v[104:107], a[112:115], v[72:75]
  v_mfma_f32_16x16x32_bf16 v[76:79], v[104:107], a[144:147], v[76:79]
  v_mfma_f32_16x16x32_bf16 v[80:83], v[104:107], a[176:179], v[80:83]
  v_mfma_f32_16x16x32_bf16 v[84:87], v[104:107], a[208:211], v[84:87]
  v_mfma_f32_16x16x32_bf16 v[88:91], v[104:107], a[240:243], v[88:91]
  ds_read2_b32 v[104:105], v52 offset0:112 offset1:113
  ds_read2_b32 v[106:107], v52 offset0:114 offset1:115
  s_waitcnt lgkmcnt(6)
  v_mfma_f32_16x16x32_bf16 v[60:63], v[92:95], a[12:15], v[60:63]
  v_mfma_f32_16x16x32_bf16 v[64:67], v[92:95], a[44:47], v[64:67]
  v_mfma_f32_16x16x32_bf16 v[68:71], v[92:95], a[76:79], v[68:71]
  v_mfma_f32_16x16x32_bf16 v[72:75], v[92:95], a[108:111], v[72:75]
  v_mfma_f32_16x16x32_bf16 v[76:79], v[92:95], a[140:143], v[76:79]
  v_mfma_f32_16x16x32_bf16 v[80:83], v[92:95], a[172:175], v[80:83]
  v_mfma_f32_16x16x32_bf16 v[84:87], v[92:95], a[204:207], v[84:87]
  v_mfma_f32_16x16x32_bf16 v[88:91], v[92:95], a[236:239], v[88:91]
  ds_read2_b32 v[92:93], v52 offset0:96 offset1:97
  ds_read2_b32 v[94:95], v52 offset0:98 offset1:99
  s_waitcnt lgkmcnt(6)
  v_mfma_f32_16x16x32_bf16 v[60:63], v[96:99], a[8:11], v[60:63]
  v_mfma_f32_16x16x32_bf16 v[64:67], v[96:99], a[40:43], v[64:67]
  v_mfma_f32_16x16x32_bf16 v[68:71], v[96:99], a[72:75], v[68:71]
  v_mfma_f32_16x16x32_bf16 v[72:75], v[96:99], a[104:107], v[72:75]
  v_mfma_f32_16x16x32_bf16 v[76:79], v[96:99], a[136:139], v[76:79]
  v_mfma_f32_16x16x32_bf16 v[80:83], v[96:99], a[168:171], v[80:83]
  v_mfma_f32_16x16x32_bf16 v[84:87], v[96:99], a[200:203], v[84:87]
  v_mfma_f32_16x16x32_bf16 v[88:91], v[96:99], a[232:235], v[88:91]
  ds_read2_b32 v[96:97], v52 offset0:80 offset1:81
  ds_read2_b32 v[98:99], v52 offset0:82 offset1:83
  s_waitcnt lgkmcnt(6)
  v_mfma_f32_16x16x32_bf16 v[60:63], v[100:103], a[4:7], v[60:63]
  v_mfma_f32_16x16x32_bf16 v[64:67], v[100:103], a[36:39], v[64:67]
  v_mfma_f32_16x16x32_bf16 v[68:71], v[100:103], a[68:71], v[68:71]
  v_mfma_f32_16x16x32_bf16 v[72:75], v[100:103], a[100:103], v[72:75]
  v_mfma_f32_16x16x32_bf16 v[76:79], v[100:103], a[132:135], v[76:79]
  v_mfma_f32_16x16x32_bf16 v[80:83], v[100:103], a[164:167], v[80:83]
  v_mfma_f32_16x16x32_bf16 v[84:87], v[100:103], a[196:199], v[84:87]
  v_mfma_f32_16x16x32_bf16 v[88:91], v[100:103], a[228:231], v[88:91]
  ds_read2_b32 v[100:101], v52 offset0:64 offset1:65
  ds_read2_b32 v[102:103], v52 offset0:66 offset1:67
  s_waitcnt lgkmcnt(6)
  v_mfma_f32_16x16x32_bf16 v[60:63], v[104:107], a[0:3], v[60:63]
  v_mfma_f32_16x16x32_bf16 v[64:67], v[104:107], a[32:35], v[64:67]
  v_mfma_f32_16x16x32_bf16 v[68:71], v[104:107], a[64:67], v[68:71]
  v_mfma_f32_16x16x32_bf16 v[72:75], v[104:107], a[96:99], v[72:75]
  v_mfma_f32_16x16x32_bf16 v[76:79], v[104:107], a[128:131], v[76:79]
  v_mfma_f32_16x16x32_bf16 v[80:83], v[104:107], a[160:163], v[80:83]
  v_mfma_f32_16x16x32_bf16 v[84:87], v[104:107], a[192:195], v[84:87]
  v_mfma_f32_16x16x32_bf16 v[88:91], v[104:107], a[224:227], v[88:91]
  ds_read2_b32 v[104:105], v52 offset0:48 offset1:49
  ds_read2_b32 v[106:107], v52 offset0:50 offset1:51
  s_waitcnt lgkmcnt(6)
  v_mfma_f32_16x16x32_bf16 v[64:67], v[92:95], a[28:31], v[64:67]
  v_mfma_f32_16x16x32_bf16 v[68:71], v[92:95], a[60:63], v[68:71]
  v_mfma_f32_16x16x32_bf16 v[72:75], v[92:95], a[92:95], v[72:75]
  v_mfma_f32_16x16x32_bf16 v[76:79], v[92:95], a[124:127], v[76:79]
  v_mfma_f32_16x16x32_bf16 v[80:83], v[92:95], a[156:159], v[80:83]
  v_mfma_f32_16x16x32_bf16 v[84:87], v[92:95], a[188:191], v[84:87]
  v_mfma_f32_16x16x32_bf16 v[88:91], v[92:95], a[220:223], v[88:91]
  ds_read2_b32 v[92:93], v52 offset0:32 offset1:33
  ds_read2_b32 v[94:95], v52 offset0:34 offset1:35
  s_waitcnt lgkmcnt(6)
  v_mfma_f32_16x16x32_bf16 v[64:67], v[96:99], a[24:27], v[64:67]
  v_mfma_f32_16x16x32_bf16 v[68:71], v[96:99], a[56:59], v[68:71]
  v_mfma_f32_16x16x32_bf16 v[72:75], v[96:99], a[88:91], v[72:75]
  v_mfma_f32_16x16x32_bf16 v[76:79], v[96:99], a[120:123], v[76:79]
  v_mfma_f32_16x16x32_bf16 v[80:83], v[96:99], a[152:155], v[80:83]
  v_mfma_f32_16x16x32_bf16 v[84:87], v[96:99], a[184:187], v[84:87]
  v_mfma_f32_16x16x32_bf16 v[88:91], v[96:99], a[216:219], v[88:91]
  ds_read2_b32 v[96:97], v52 offset0:16 offset1:17
  ds_read2_b32 v[98:99], v52 offset0:18 offset1:19
  s_waitcnt lgkmcnt(6)
  v_mfma_f32_16x16x32_bf16 v[64:67], v[100:103], a[20:23], v[64:67]
  v_mfma_f32_16x16x32_bf16 v[68:71], v[100:103], a[52:55], v[68:71]
  v_mfma_f32_16x16x32_bf16 v[72:75], v[100:103], a[84:87], v[72:75]
  v_mfma_f32_16x16x32_bf16 v[76:79], v[100:103], a[116:119], v[76:79]
  v_mfma_f32_16x16x32_bf16 v[80:83], v[100:103], a[148:151], v[80:83]
  v_mfma_f32_16x16x32_bf16 v[84:87], v[100:103], a[180:183], v[84:87]
  v_mfma_f32_16x16x32_bf16 v[88:91], v[100:103], a[212:215], v[88:91]
  ds_read2_b32 v[100:101], v52 offset0:0 offset1:1
  ds_read2_b32 v[102:103], v52 offset0:2 offset1:3
  s_waitcnt lgkmcnt(6)
  v_mfma_f32_16x16x32_bf16 v[64:67], v[104:107], a[16:19], v[64:67]
  v_mfma_f32_16x16x32_bf16 v[68:71], v[104:107], a[48:51], v[68:71]
  v_mfma_f32_16x16x32_bf16 v[72:75], v[104:107], a[80:83], v[72:75]
  v_mfma_f32_16x16x32_bf16 v[76:79], v[104:107], a[112:115], v[76:79]
  v_mfma_f32_16x16x32_bf16 v[80:83], v[104:107], a[144:147], v[80:83]
  v_mfma_f32_16x16x32_bf16 v[84:87], v[104:107], a[176:179], v[84:87]
  v_mfma_f32_16x16x32_bf16 v[88:91], v[104:107], a[208:211], v[88:91]
  ds_read2_b32 v[104:105], v53 offset0:224 offset1:225
  ds_read2_b32 v[106:107], v53 offset0:226 offset1:227
  s_waitcnt lgkmcnt(6)
  v_mfma_f32_16x16x32_bf16 v[64:67], v[92:95], a[12:15], v[64:67]
  v_mfma_f32_16x16x32_bf16 v[68:71], v[92:95], a[44:47], v[68:71]
  v_mfma_f32_16x16x32_bf16 v[72:75], v[92:95], a[76:79], v[72:75]
  v_mfma_f32_16x16x32_bf16 v[76:79], v[92:95], a[108:111], v[76:79]
  v_mfma_f32_16x16x32_bf16 v[80:83], v[92:95], a[140:143], v[80:83]
  v_mfma_f32_16x16x32_bf16 v[84:87], v[92:95], a[172:175], v[84:87]
  v_mfma_f32_16x16x32_bf16 v[88:91], v[92:95], a[204:207], v[88:91]
  ds_read2_b32 v[92:93], v53 offset0:208 offset1:209
  ds_read2_b32 v[94:95], v53 offset0:210 offset1:211
  s_waitcnt lgkmcnt(6)
  v_mfma_f32_16x16x32_bf16 v[64:67], v[96:99], a[8:11], v[64:67]
  v_mfma_f32_16x16x32_bf16 v[68:71], v[96:99], a[40:43], v[68:71]
  v_mfma_f32_16x16x32_bf16 v[72:75], v[96:99], a[72:75], v[72:75]
  v_mfma_f32_16x16x32_bf16 v[76:79], v[96:99], a[104:107], v[76:79]
  v_mfma_f32_16x16x32_bf16 v[80:83], v[96:99], a[136:139], v[80:83]
  v_mfma_f32_16x16x32_bf16 v[84:87], v[96:99], a[168:171], v[84:87]
  v_mfma_f32_16x16x32_bf16 v[88:91], v[96:99], a[200:203], v[88:91]
  ds_read2_b32 v[96:97], v53 offset0:192 offset1:193
  ds_read2_b32 v[98:99], v53 offset0:194 offset1:195
  s_waitcnt lgkmcnt(6)
  v_mfma_f32_16x16x32_bf16 v[64:67], v[100:103], a[4:7], v[64:67]
  v_mfma_f32_16x16x32_bf16 v[68:71], v[100:103], a[36:39], v[68:71]
  v_mfma_f32_16x16x32_bf16 v[72:75], v[100:103], a[68:71], v[72:75]
  v_mfma_f32_16x16x32_bf16 v[76:79], v[100:103], a[100:103], v[76:79]
  v_mfma_f32_16x16x32_bf16 v[80:83], v[100:103], a[132:135], v[80:83]
  v_mfma_f32_16x16x32_bf16 v[84:87], v[100:103], a[164:167], v[84:87]
  v_mfma_f32_16x16x32_bf16 v[88:91], v[100:103], a[196:199], v[88:91]
  ds_read2_b32 v[100:101], v53 offset0:176 offset1:177
  ds_read2_b32 v[102:103], v53 offset0:178 offset1:179
  s_waitcnt lgkmcnt(6)
  v_mfma_f32_16x16x32_bf16 v[64:67], v[104:107], a[0:3], v[64:67]
  v_mfma_f32_16x16x32_bf16 v[68:71], v[104:107], a[32:35], v[68:71]
  v_mfma_f32_16x16x32_bf16 v[72:75], v[104:107], a[64:67], v[72:75]
  v_mfma_f32_16x16x32_bf16 v[76:79], v[104:107], a[96:99], v[76:79]
  v_mfma_f32_16x16x32_bf16 v[80:83], v[104:107], a[128:131], v[80:83]
  v_mfma_f32_16x16x32_bf16 v[84:87], v[104:107], a[160:163], v[84:87]
  v_mfma_f32_16x16x32_bf16 v[88:91], v[104:107], a[192:195], v[88:91]
  ds_read2_b32 v[104:105], v53 offset0:160 offset1:161
  ds_read2_b32 v[106:107], v53 offset0:162 offset1:163
  s_waitcnt lgkmcnt(6)
  v_mfma_f32_16x16x32_bf16 v[68:71], v[92:95], a[28:31], v[68:71]
  v_mfma_f32_16x16x32_bf16 v[72:75], v[92:95], a[60:63], v[72:75]
  v_mfma_f32_16x16x32_bf16 v[76:79], v[92:95], a[92:95], v[76:79]
  v_mfma_f32_16x16x32_bf16 v[80:83], v[92:95], a[124:127], v[80:83]
  v_mfma_f32_16x16x32_bf16 v[84:87], v[92:95], a[156:159], v[84:87]
  v_mfma_f32_16x16x32_bf16 v[88:91], v[92:95], a[188:191], v[88:91]
  ds_read2_b32 v[92:93], v53 offset0:144 offset1:145
  ds_read2_b32 v[94:95], v53 offset0:146 offset1:147
  s_waitcnt lgkmcnt(6)
  v_mfma_f32_16x16x32_bf16 v[68:71], v[96:99], a[24:27], v[68:71]
  v_mfma_f32_16x16x32_bf16 v[72:75], v[96:99], a[56:59], v[72:75]
  v_mfma_f32_16x16x32_bf16 v[76:79], v[96:99], a[88:91], v[76:79]
  v_mfma_f32_16x16x32_bf16 v[80:83], v[96:99], a[120:123], v[80:83]
  v_mfma_f32_16x16x32_bf16 v[84:87], v[96:99], a[152:155], v[84:87]
  v_mfma_f32_16x16x32_bf16 v[88:91], v[96:99], a[184:187], v[88:91]
  ds_read2_b32 v[96:97], v53 offset0:128 offset1:129
  ds_read2_b32 v[98:99], v53 offset0:130 offset1:131
  s_waitcnt lgkmcnt(6)
  v_mfma_f32_16x16x32_bf16 v[68:71], v[100:103], a[20:23], v[68:71]
  v_mfma_f32_16x16x32_bf16 v[72:75], v[100:103], a[52:55], v[72:75]
  v_mfma_f32_16x16x32_bf16 v[76:79], v[100:103], a[84:87], v[76:79]
  v_mfma_f32_16x16x32_bf16 v[80:83], v[100:103], a[116:119], v[80:83]
  v_mfma_f32_16x16x32_bf16 v[84:87], v[100:103], a[148:151], v[84:87]
  v_mfma_f32_16x16x32_bf16 v[88:91], v[100:103], a[180:183], v[88:91]
  ds_read2_b32 v[100:101], v53 offset0:112 offset1:113
  ds_read2_b32 v[102:103], v53 offset0:114 offset1:115
  s_waitcnt lgkmcnt(6)
  v_mfma_f32_16x16x32_bf16 v[68:71], v[104:107], a[16:19], v[68:71]
  v_mfma_f32_16x16x32_bf16 v[72:75], v[104:107], a[48:51], v[72:75]
  v_mfma_f32_16x16x32_bf16 v[76:79], v[104:107], a[80:83], v[76:79]
  v_mfma_f32_16x16x32_bf16 v[80:83], v[104:107], a[112:115], v[80:83]
  v_mfma_f32_16x16x32_bf16 v[84:87], v[104:107], a[144:147], v[84:87]
  v_mfma_f32_16x16x32_bf16 v[88:91], v[104:107], a[176:179], v[88:91]
  ds_read2_b32 v[104:105], v53 offset0:96 offset1:97
  ds_read2_b32 v[106:107], v53 offset0:98 offset1:99
  s_waitcnt lgkmcnt(6)
  v_mfma_f32_16x16x32_bf16 v[68:71], v[92:95], a[12:15], v[68:71]
  v_mfma_f32_16x16x32_bf16 v[72:75], v[92:95], a[44:47], v[72:75]
  v_mfma_f32_16x16x32_bf16 v[76:79], v[92:95], a[76:79], v[76:79]
  v_mfma_f32_16x16x32_bf16 v[80:83], v[92:95], a[108:111], v[80:83]
  v_mfma_f32_16x16x32_bf16 v[84:87], v[92:95], a[140:143], v[84:87]
  v_mfma_f32_16x16x32_bf16 v[88:91], v[92:95], a[172:175], v[88:91]
  ds_read2_b32 v[92:93], v53 offset0:80 offset1:81
  ds_read2_b32 v[94:95], v53 offset0:82 offset1:83
  s_waitcnt lgkmcnt(6)
  v_mfma_f32_16x16x32_bf16 v[68:71], v[96:99], a[8:11], v[68:71]
  v_mfma_f32_16x16x32_bf16 v[72:75], v[96:99], a[40:43], v[72:75]
  v_mfma_f32_16x16x32_bf16 v[76:79], v[96:99], a[72:75], v[76:79]
  v_mfma_f32_16x16x32_bf16 v[80:83], v[96:99], a[104:107], v[80:83]
  v_mfma_f32_16x16x32_bf16 v[84:87], v[96:99], a[136:139], v[84:87]
  v_mfma_f32_16x16x32_bf16 v[88:91], v[96:99], a[168:171], v[88:91]
  ds_read2_b32 v[96:97], v53 offset0:64 offset1:65
  ds_read2_b32 v[98:99], v53 offset0:66 offset1:67
  s_waitcnt lgkmcnt(6)
  v_mfma_f32_16x16x32_bf16 v[68:71], v[100:103], a[4:7], v[68:71]
  v_mfma_f32_16x16x32_bf16 v[72:75], v[100:103], a[36:39], v[72:75]
  v_mfma_f32_16x16x32_bf16 v[76:79], v[100:103], a[68:71], v[76:79]
  v_mfma_f32_16x16x32_bf16 v[80:83], v[100:103], a[100:103], v[80:83]
  v_mfma_f32_16x16x32_bf16 v[84:87], v[100:103], a[132:135], v[84:87]
  v_mfma_f32_16x16x32_bf16 v[88:91], v[100:103], a[164:167], v[88:91]
  ds_read2_b32 v[100:101], v53 offset0:48 offset1:49
  ds_read2_b32 v[102:103], v53 offset0:50 offset1:51
  s_waitcnt lgkmcnt(6)
  v_mfma_f32_16x16x32_bf16 v[68:71], v[104:107], a[0:3], v[68:71]
  v_mfma_f32_16x16x32_bf16 v[72:75], v[104:107], a[32:35], v[72:75]
  v_mfma_f32_16x16x32_bf16 v[76:79], v[104:107], a[64:67], v[76:79]
  v_mfma_f32_16x16x32_bf16 v[80:83], v[104:107], a[96:99], v[80:83]
  v_mfma_f32_16x16x32_bf16 v[84:87], v[104:107], a[128:131], v[84:87]
  v_mfma_f32_16x16x32_bf16 v[88:91], v[104:107], a[160:163], v[88:91]
  ds_read2_b32 v[104:105], v53 offset0:32 offset1:33
  ds_read2_b32 v[106:107], v53 offset0:34 offset1:35
  s_waitcnt lgkmcnt(6)
  v_mfma_f32_16x16x32_bf16 v[72:75], v[92:95], a[28:31], v[72:75]
  v_mfma_f32_16x16x32_bf16 v[76:79], v[92:95], a[60:63], v[76:79]
  v_mfma_f32_16x16x32_bf16 v[80:83], v[92:95], a[92:95], v[80:83]
  v_mfma_f32_16x16x32_bf16 v[84:87], v[92:95], a[124:127], v[84:87]
  v_mfma_f32_16x16x32_bf16 v[88:91], v[92:95], a[156:159], v[88:91]
  ds_read2_b32 v[92:93], v53 offset0:16 offset1:17
  ds_read2_b32 v[94:95], v53 offset0:18 offset1:19
  s_waitcnt lgkmcnt(6)
  v_mfma_f32_16x16x32_bf16 v[72:75], v[96:99], a[24:27], v[72:75]
  v_mfma_f32_16x16x32_bf16 v[76:79], v[96:99], a[56:59], v[76:79]
  v_mfma_f32_16x16x32_bf16 v[80:83], v[96:99], a[88:91], v[80:83]
  v_mfma_f32_16x16x32_bf16 v[84:87], v[96:99], a[120:123], v[84:87]
  v_mfma_f32_16x16x32_bf16 v[88:91], v[96:99], a[152:155], v[88:91]
  ds_read2_b32 v[96:97], v53 offset0:0 offset1:1
  ds_read2_b32 v[98:99], v53 offset0:2 offset1:3
  s_waitcnt lgkmcnt(6)
  v_mfma_f32_16x16x32_bf16 v[72:75], v[100:103], a[20:23], v[72:75]
  v_mfma_f32_16x16x32_bf16 v[76:79], v[100:103], a[52:55], v[76:79]
  v_mfma_f32_16x16x32_bf16 v[80:83], v[100:103], a[84:87], v[80:83]
  v_mfma_f32_16x16x32_bf16 v[84:87], v[100:103], a[116:119], v[84:87]
  v_mfma_f32_16x16x32_bf16 v[88:91], v[100:103], a[148:151], v[88:91]
  ds_read2_b32 v[100:101], v54 offset0:224 offset1:225
  ds_read2_b32 v[102:103], v54 offset0:226 offset1:227
  s_waitcnt lgkmcnt(6)
  v_mfma_f32_16x16x32_bf16 v[72:75], v[104:107], a[16:19], v[72:75]
  v_mfma_f32_16x16x32_bf16 v[76:79], v[104:107], a[48:51], v[76:79]
  v_mfma_f32_16x16x32_bf16 v[80:83], v[104:107], a[80:83], v[80:83]
  v_mfma_f32_16x16x32_bf16 v[84:87], v[104:107], a[112:115], v[84:87]
  v_mfma_f32_16x16x32_bf16 v[88:91], v[104:107], a[144:147], v[88:91]
  ds_read2_b32 v[104:105], v54 offset0:208 offset1:209
  ds_read2_b32 v[106:107], v54 offset0:210 offset1:211
  s_waitcnt lgkmcnt(6)
  v_mfma_f32_16x16x32_bf16 v[72:75], v[92:95], a[12:15], v[72:75]
  v_mfma_f32_16x16x32_bf16 v[76:79], v[92:95], a[44:47], v[76:79]
  v_mfma_f32_16x16x32_bf16 v[80:83], v[92:95], a[76:79], v[80:83]
  v_mfma_f32_16x16x32_bf16 v[84:87], v[92:95], a[108:111], v[84:87]
  v_mfma_f32_16x16x32_bf16 v[88:91], v[92:95], a[140:143], v[88:91]
  ds_read2_b32 v[92:93], v54 offset0:192 offset1:193
  ds_read2_b32 v[94:95], v54 offset0:194 offset1:195
  s_waitcnt lgkmcnt(6)
  v_mfma_f32_16x16x32_bf16 v[72:75], v[96:99], a[8:11], v[72:75]
  v_mfma_f32_16x16x32_bf16 v[76:79], v[96:99], a[40:43], v[76:79]
  v_mfma_f32_16x16x32_bf16 v[80:83], v[96:99], a[72:75], v[80:83]
  v_mfma_f32_16x16x32_bf16 v[84:87], v[96:99], a[104:107], v[84:87]
  v_mfma_f32_16x16x32_bf16 v[88:91], v[96:99], a[136:139], v[88:91]
  ds_read2_b32 v[96:97], v54 offset0:176 offset1:177
  ds_read2_b32 v[98:99], v54 offset0:178 offset1:179
  s_waitcnt lgkmcnt(6)
  v_mfma_f32_16x16x32_bf16 v[72:75], v[100:103], a[4:7], v[72:75]
  v_mfma_f32_16x16x32_bf16 v[76:79], v[100:103], a[36:39], v[76:79]
  v_mfma_f32_16x16x32_bf16 v[80:83], v[100:103], a[68:71], v[80:83]
  v_mfma_f32_16x16x32_bf16 v[84:87], v[100:103], a[100:103], v[84:87]
  v_mfma_f32_16x16x32_bf16 v[88:91], v[100:103], a[132:135], v[88:91]
  ds_read2_b32 v[100:101], v54 offset0:160 offset1:161
  ds_read2_b32 v[102:103], v54 offset0:162 offset1:163
  s_waitcnt lgkmcnt(6)
  v_mfma_f32_16x16x32_bf16 v[72:75], v[104:107], a[0:3], v[72:75]
  v_mfma_f32_16x16x32_bf16 v[76:79], v[104:107], a[32:35], v[76:79]
  v_mfma_f32_16x16x32_bf16 v[80:83], v[104:107], a[64:67], v[80:83]
  v_mfma_f32_16x16x32_bf16 v[84:87], v[104:107], a[96:99], v[84:87]
  v_mfma_f32_16x16x32_bf16 v[88:91], v[104:107], a[128:131], v[88:91]
  ds_read2_b32 v[104:105], v54 offset0:144 offset1:145
  ds_read2_b32 v[106:107], v54 offset0:146 offset1:147
  s_waitcnt lgkmcnt(6)
  v_mfma_f32_16x16x32_bf16 v[76:79], v[92:95], a[28:31], v[76:79]
  v_mfma_f32_16x16x32_bf16 v[80:83], v[92:95], a[60:63], v[80:83]
  v_mfma_f32_16x16x32_bf16 v[84:87], v[92:95], a[92:95], v[84:87]
  v_mfma_f32_16x16x32_bf16 v[88:91], v[92:95], a[124:127], v[88:91]
  ds_read2_b32 v[92:93], v54 offset0:128 offset1:129
  ds_read2_b32 v[94:95], v54 offset0:130 offset1:131
  s_waitcnt lgkmcnt(6)
  v_mfma_f32_16x16x32_bf16 v[76:79], v[96:99], a[24:27], v[76:79]
  v_mfma_f32_16x16x32_bf16 v[80:83], v[96:99], a[56:59], v[80:83]
  v_mfma_f32_16x16x32_bf16 v[84:87], v[96:99], a[88:91], v[84:87]
  v_mfma_f32_16x16x32_bf16 v[88:91], v[96:99], a[120:123], v[88:91]
  ds_read2_b32 v[96:97], v54 offset0:112 offset1:113
  ds_read2_b32 v[98:99], v54 offset0:114 offset1:115
  s_waitcnt lgkmcnt(6)
  v_mfma_f32_16x16x32_bf16 v[76:79], v[100:103], a[20:23], v[76:79]
  v_mfma_f32_16x16x32_bf16 v[80:83], v[100:103], a[52:55], v[80:83]
  v_mfma_f32_16x16x32_bf16 v[84:87], v[100:103], a[84:87], v[84:87]
  v_mfma_f32_16x16x32_bf16 v[88:91], v[100:103], a[116:119], v[88:91]
  ds_read2_b32 v[100:101], v54 offset0:96 offset1:97
  ds_read2_b32 v[102:103], v54 offset0:98 offset1:99
  s_waitcnt lgkmcnt(6)
  v_mfma_f32_16x16x32_bf16 v[76:79], v[104:107], a[16:19], v[76:79]
  v_mfma_f32_16x16x32_bf16 v[80:83], v[104:107], a[48:51], v[80:83]
  v_mfma_f32_16x16x32_bf16 v[84:87], v[104:107], a[80:83], v[84:87]
  v_mfma_f32_16x16x32_bf16 v[88:91], v[104:107], a[112:115], v[88:91]
  ds_read2_b32 v[104:105], v54 offset0:80 offset1:81
  ds_read2_b32 v[106:107], v54 offset0:82 offset1:83
  s_waitcnt lgkmcnt(6)
  v_mfma_f32_16x16x32_bf16 v[76:79], v[92:95], a[12:15], v[76:79]
  v_mfma_f32_16x16x32_bf16 v[80:83], v[92:95], a[44:47], v[80:83]
  v_mfma_f32_16x16x32_bf16 v[84:87], v[92:95], a[76:79], v[84:87]
  v_mfma_f32_16x16x32_bf16 v[88:91], v[92:95], a[108:111], v[88:91]
  ds_read2_b32 v[92:93], v54 offset0:64 offset1:65
  ds_read2_b32 v[94:95], v54 offset0:66 offset1:67
  s_waitcnt lgkmcnt(6)
  v_mfma_f32_16x16x32_bf16 v[76:79], v[96:99], a[8:11], v[76:79]
  v_mfma_f32_16x16x32_bf16 v[80:83], v[96:99], a[40:43], v[80:83]
  v_mfma_f32_16x16x32_bf16 v[84:87], v[96:99], a[72:75], v[84:87]
  v_mfma_f32_16x16x32_bf16 v[88:91], v[96:99], a[104:107], v[88:91]
  ds_read2_b32 v[96:97], v54 offset0:48 offset1:49
  ds_read2_b32 v[98:99], v54 offset0:50 offset1:51
  s_waitcnt lgkmcnt(6)
  v_mfma_f32_16x16x32_bf16 v[76:79], v[100:103], a[4:7], v[76:79]
  v_mfma_f32_16x16x32_bf16 v[80:83], v[100:103], a[36:39], v[80:83]
  v_mfma_f32_16x16x32_bf16 v[84:87], v[100:103], a[68:71], v[84:87]
  v_mfma_f32_16x16x32_bf16 v[88:91], v[100:103], a[100:103], v[88:91]
  ds_read2_b32 v[100:101], v54 offset0:32 offset1:33
  ds_read2_b32 v[102:103], v54 offset0:34 offset1:35
  s_waitcnt lgkmcnt(6)
  v_mfma_f32_16x16x32_bf16 v[76:79], v[104:107], a[0:3], v[76:79]
  v_mfma_f32_16x16x32_bf16 v[80:83], v[104:107], a[32:35], v[80:83]
  v_mfma_f32_16x16x32_bf16 v[84:87], v[104:107], a[64:67], v[84:87]
  v_mfma_f32_16x16x32_bf16 v[88:91], v[104:107], a[96:99], v[88:91]
  ds_read2_b32 v[104:105], v54 offset0:16 offset1:17
  ds_read2_b32 v[106:107], v54 offset0:18 offset1:19
  s_waitcnt lgkmcnt(6)
  v_mfma_f32_16x16x32_bf16 v[80:83], v[92:95], a[28:31], v[80:83]
  v_mfma_f32_16x16x32_bf16 v[84:87], v[92:95], a[60:63], v[84:87]
  v_mfma_f32_16x16x32_bf16 v[88:91], v[92:95], a[92:95], v[88:91]
  ds_read2_b32 v[92:93], v54 offset0:0 offset1:1
  ds_read2_b32 v[94:95], v54 offset0:2 offset1:3
  s_waitcnt lgkmcnt(6)
  v_mfma_f32_16x16x32_bf16 v[80:83], v[96:99], a[24:27], v[80:83]
  v_mfma_f32_16x16x32_bf16 v[84:87], v[96:99], a[56:59], v[84:87]
  v_mfma_f32_16x16x32_bf16 v[88:91], v[96:99], a[88:91], v[88:91]
  ds_read2_b32 v[96:97], v55 offset0:224 offset1:225
  ds_read2_b32 v[98:99], v55 offset0:226 offset1:227
  s_waitcnt lgkmcnt(6)
  v_mfma_f32_16x16x32_bf16 v[80:83], v[100:103], a[20:23], v[80:83]
  v_mfma_f32_16x16x32_bf16 v[84:87], v[100:103], a[52:55], v[84:87]
  v_mfma_f32_16x16x32_bf16 v[88:91], v[100:103], a[84:87], v[88:91]
  ds_read2_b32 v[100:101], v55 offset0:208 offset1:209
  ds_read2_b32 v[102:103], v55 offset0:210 offset1:211
  s_waitcnt lgkmcnt(6)
  v_mfma_f32_16x16x32_bf16 v[80:83], v[104:107], a[16:19], v[80:83]
  v_mfma_f32_16x16x32_bf16 v[84:87], v[104:107], a[48:51], v[84:87]
  v_mfma_f32_16x16x32_bf16 v[88:91], v[104:107], a[80:83], v[88:91]
  ds_read2_b32 v[104:105], v55 offset0:192 offset1:193
  ds_read2_b32 v[106:107], v55 offset0:194 offset1:195
  s_waitcnt lgkmcnt(6)
  v_mfma_f32_16x16x32_bf16 v[80:83], v[92:95], a[12:15], v[80:83]
  v_mfma_f32_16x16x32_bf16 v[84:87], v[92:95], a[44:47], v[84:87]
  v_mfma_f32_16x16x32_bf16 v[88:91], v[92:95], a[76:79], v[88:91]
  ds_read2_b32 v[92:93], v55 offset0:176 offset1:177
  ds_read2_b32 v[94:95], v55 offset0:178 offset1:179
  s_waitcnt lgkmcnt(6)
  v_mfma_f32_16x16x32_bf16 v[80:83], v[96:99], a[8:11], v[80:83]
  v_mfma_f32_16x16x32_bf16 v[84:87], v[96:99], a[40:43], v[84:87]
  v_mfma_f32_16x16x32_bf16 v[88:91], v[96:99], a[72:75], v[88:91]
  ds_read2_b32 v[96:97], v55 offset0:160 offset1:161
  ds_read2_b32 v[98:99], v55 offset0:162 offset1:163
  s_waitcnt lgkmcnt(6)
  v_mfma_f32_16x16x32_bf16 v[80:83], v[100:103], a[4:7], v[80:83]
  v_mfma_f32_16x16x32_bf16 v[84:87], v[100:103], a[36:39], v[84:87]
  v_mfma_f32_16x16x32_bf16 v[88:91], v[100:103], a[68:71], v[88:91]
  ds_read2_b32 v[100:101], v55 offset0:144 offset1:145
  ds_read2_b32 v[102:103], v55 offset0:146 offset1:147
  s_waitcnt lgkmcnt(6)
  v_mfma_f32_16x16x32_bf16 v[80:83], v[104:107], a[0:3], v[80:83]
  v_mfma_f32_16x16x32_bf16 v[84:87], v[104:107], a[32:35], v[84:87]
  v_mfma_f32_16x16x32_bf16 v[88:91], v[104:107], a[64:67], v[88:91]
  ds_read2_b32 v[104:105], v55 offset0:128 offset1:129
  ds_read2_b32 v[106:107], v55 offset0:130 offset1:131
  s_waitcnt lgkmcnt(6)
  v_mfma_f32_16x16x32_bf16 v[84:87], v[92:95], a[28:31], v[84:87]
  v_mfma_f32_16x16x32_bf16 v[88:91], v[92:95], a[60:63], v[88:91]
  ds_read2_b32 v[92:93], v55 offset0:112 offset1:113
  ds_read2_b32 v[94:95], v55 offset0:114 offset1:115
  s_waitcnt lgkmcnt(6)
  v_mfma_f32_16x16x32_bf16 v[84:87], v[96:99], a[24:27], v[84:87]
  v_mfma_f32_16x16x32_bf16 v[88:91], v[96:99], a[56:59], v[88:91]
  ds_read2_b32 v[96:97], v55 offset0:96 offset1:97
  ds_read2_b32 v[98:99], v55 offset0:98 offset1:99
  s_waitcnt lgkmcnt(6)
  v_mfma_f32_16x16x32_bf16 v[84:87], v[100:103], a[20:23], v[84:87]
  v_mfma_f32_16x16x32_bf16 v[88:91], v[100:103], a[52:55], v[88:91]
  ds_read2_b32 v[100:101], v55 offset0:80 offset1:81
  ds_read2_b32 v[102:103], v55 offset0:82 offset1:83
  s_waitcnt lgkmcnt(6)
  v_mfma_f32_16x16x32_bf16 v[84:87], v[104:107], a[16:19], v[84:87]
  v_mfma_f32_16x16x32_bf16 v[88:91], v[104:107], a[48:51], v[88:91]
  ds_read2_b32 v[104:105], v55 offset0:64 offset1:65
  ds_read2_b32 v[106:107], v55 offset0:66 offset1:67
  s_waitcnt lgkmcnt(6)
  v_mfma_f32_16x16x32_bf16 v[84:87], v[92:95], a[12:15], v[84:87]
  v_mfma_f32_16x16x32_bf16 v[88:91], v[92:95], a[44:47], v[88:91]
  ds_read2_b32 v[92:93], v55 offset0:48 offset1:49
  ds_read2_b32 v[94:95], v55 offset0:50 offset1:51
  s_waitcnt lgkmcnt(6)
  v_mfma_f32_16x16x32_bf16 v[84:87], v[96:99], a[8:11], v[84:87]
  v_mfma_f32_16x16x32_bf16 v[88:91], v[96:99], a[40:43], v[88:91]
  ds_read2_b32 v[96:97], v55 offset0:32 offset1:33
  ds_read2_b32 v[98:99], v55 offset0:34 offset1:35
  s_waitcnt lgkmcnt(6)
  v_mfma_f32_16x16x32_bf16 v[84:87], v[100:103], a[4:7], v[84:87]
  v_mfma_f32_16x16x32_bf16 v[88:91], v[100:103], a[36:39], v[88:91]
  ds_read2_b32 v[100:101], v55 offset0:16 offset1:17
  ds_read2_b32 v[102:103], v55 offset0:18 offset1:19
  s_waitcnt lgkmcnt(6)
  v_mfma_f32_16x16x32_bf16 v[84:87], v[104:107], a[0:3], v[84:87]
  v_mfma_f32_16x16x32_bf16 v[88:91], v[104:107], a[32:35], v[88:91]
  ds_read2_b32 v[104:105], v55 offset0:0 offset1:1
  ds_read2_b32 v[106:107], v55 offset0:2 offset1:3
  s_waitcnt lgkmcnt(6)
  v_mfma_f32_16x16x32_bf16 v[88:91], v[92:95], a[28:31], v[88:91]
  ds_read2_b32 v[92:93], v56 offset0:224 offset1:225
  ds_read2_b32 v[94:95], v56 offset0:226 offset1:227
  s_waitcnt lgkmcnt(6)
  v_mfma_f32_16x16x32_bf16 v[88:91], v[96:99], a[24:27], v[88:91]
  ds_read2_b32 v[96:97], v56 offset0:208 offset1:209
  ds_read2_b32 v[98:99], v56 offset0:210 offset1:211
  s_waitcnt lgkmcnt(6)
  v_mfma_f32_16x16x32_bf16 v[88:91], v[100:103], a[20:23], v[88:91]
  ds_read2_b32 v[100:101], v56 offset0:192 offset1:193
  ds_read2_b32 v[102:103], v56 offset0:194 offset1:195
  s_waitcnt lgkmcnt(6)
  v_mfma_f32_16x16x32_bf16 v[88:91], v[104:107], a[16:19], v[88:91]
  ds_read2_b32 v[104:105], v56 offset0:176 offset1:177
  ds_read2_b32 v[106:107], v56 offset0:178 offset1:179
  s_waitcnt lgkmcnt(6)
  v_mfma_f32_16x16x32_bf16 v[88:91], v[92:95], a[12:15], v[88:91]
  s_waitcnt lgkmcnt(4)
  v_mfma_f32_16x16x32_bf16 v[88:91], v[96:99], a[8:11], v[88:91]
  s_waitcnt lgkmcnt(2)
  v_mfma_f32_16x16x32_bf16 v[88:91], v[100:103], a[4:7], v[88:91]
  s_waitcnt lgkmcnt(0)
  v_mfma_f32_16x16x32_bf16 v[88:91], v[104:107], a[0:3], v[88:91]
  v_lshlrev_b32 v46, 5, v4
  v_lshl_add_u32 v46, v3, 3, v46
  v_add_u32 v46, s17, v46
  ds_read_b64 v[108:109], v46 offset:512
  ds_read_b64 v[110:111], v46 offset:1024
  ds_read_b64 v[112:113], v46 offset:1536
  ds_read_b64 v[114:115], v46 offset:2048
  ds_read_b64 v[116:117], v46 offset:2560
  ds_read_b64 v[118:119], v46 offset:3072
  ds_read_b64 v[120:121], v46 offset:3584
  ds_read_b64 v[122:123], v46 offset:4096
  s_waitcnt lgkmcnt(0)
  v_lshlrev_b32 v124, 16, v108
  v_and_b32 v125, 0xffff0000, v108
  v_lshlrev_b32 v126, 16, v109
  v_and_b32 v127, 0xffff0000, v109
  v_mul_f32 v124, v124, v33
  v_mul_f32 v125, v125, v33
  v_mul_f32 v126, v126, v33
  v_mul_f32 v127, v127, v33
  v_cvt_pk_bf16_f32 v128, v124, v125
  v_cvt_pk_bf16_f32 v129, v126, v127
  v_cvt_pk_bf16_f32 v130, v60, v61
  v_cvt_pk_bf16_f32 v131, v62, v63
  v_lshlrev_b32 v124, 16, v128
  v_and_b32 v125, 0xffff0000, v128
  v_lshlrev_b32 v132, 16, v130
  v_and_b32 v133, 0xffff0000, v130
  v_lshlrev_b32 v126, 16, v129
  v_and_b32 v127, 0xffff0000, v129
  v_lshlrev_b32 v134, 16, v131
  v_and_b32 v135, 0xffff0000, v131
  v_add_f32 v124, v124, v132
  v_add_f32 v125, v125, v133
  v_add_f32 v126, v126, v134
  v_add_f32 v127, v127, v135
  v_cvt_pk_bf16_f32 v108, v124, v125
  v_cvt_pk_bf16_f32 v109, v126, v127
  ds_write_b64 v46, v[108:109] offset:512
  v_lshlrev_b32 v124, 16, v110
  v_and_b32 v125, 0xffff0000, v110
  v_lshlrev_b32 v126, 16, v111
  v_and_b32 v127, 0xffff0000, v111
  v_mul_f32 v124, v124, v33
  v_mul_f32 v125, v125, v33
  v_mul_f32 v126, v126, v33
  v_mul_f32 v127, v127, v33
  v_cvt_pk_bf16_f32 v128, v124, v125
  v_cvt_pk_bf16_f32 v129, v126, v127
  v_cvt_pk_bf16_f32 v130, v64, v65
  v_cvt_pk_bf16_f32 v131, v66, v67
  v_lshlrev_b32 v124, 16, v128
  v_and_b32 v125, 0xffff0000, v128
  v_lshlrev_b32 v132, 16, v130
  v_and_b32 v133, 0xffff0000, v130
  v_lshlrev_b32 v126, 16, v129
  v_and_b32 v127, 0xffff0000, v129
  v_lshlrev_b32 v134, 16, v131
  v_and_b32 v135, 0xffff0000, v131
  v_add_f32 v124, v124, v132
  v_add_f32 v125, v125, v133
  v_add_f32 v126, v126, v134
  v_add_f32 v127, v127, v135
  v_cvt_pk_bf16_f32 v110, v124, v125
  v_cvt_pk_bf16_f32 v111, v126, v127
  ds_write_b64 v46, v[110:111] offset:1024
  v_lshlrev_b32 v124, 16, v112
  v_and_b32 v125, 0xffff0000, v112
  v_lshlrev_b32 v126, 16, v113
  v_and_b32 v127, 0xffff0000, v113
  v_mul_f32 v124, v124, v33
  v_mul_f32 v125, v125, v33
  v_mul_f32 v126, v126, v33
  v_mul_f32 v127, v127, v33
  v_cvt_pk_bf16_f32 v128, v124, v125
  v_cvt_pk_bf16_f32 v129, v126, v127
  v_cvt_pk_bf16_f32 v130, v68, v69
  v_cvt_pk_bf16_f32 v131, v70, v71
  v_lshlrev_b32 v124, 16, v128
  v_and_b32 v125, 0xffff0000, v128
  v_lshlrev_b32 v132, 16, v130
  v_and_b32 v133, 0xffff0000, v130
  v_lshlrev_b32 v126, 16, v129
  v_and_b32 v127, 0xffff0000, v129
  v_lshlrev_b32 v134, 16, v131
  v_and_b32 v135, 0xffff0000, v131
  v_add_f32 v124, v124, v132
  v_add_f32 v125, v125, v133
  v_add_f32 v126, v126, v134
  v_add_f32 v127, v127, v135
  v_cvt_pk_bf16_f32 v112, v124, v125
  v_cvt_pk_bf16_f32 v113, v126, v127
  ds_write_b64 v46, v[112:113] offset:1536
  v_lshlrev_b32 v124, 16, v114
  v_and_b32 v125, 0xffff0000, v114
  v_lshlrev_b32 v126, 16, v115
  v_and_b32 v127, 0xffff0000, v115
  v_mul_f32 v124, v124, v33
  v_mul_f32 v125, v125, v33
  v_mul_f32 v126, v126, v33
  v_mul_f32 v127, v127, v33
  v_cvt_pk_bf16_f32 v128, v124, v125
  v_cvt_pk_bf16_f32 v129, v126, v127
  v_cvt_pk_bf16_f32 v130, v72, v73
  v_cvt_pk_bf16_f32 v131, v74, v75
  v_lshlrev_b32 v124, 16, v128
  v_and_b32 v125, 0xffff0000, v128
  v_lshlrev_b32 v132, 16, v130
  v_and_b32 v133, 0xffff0000, v130
  v_lshlrev_b32 v126, 16, v129
  v_and_b32 v127, 0xffff0000, v129
  v_lshlrev_b32 v134, 16, v131
  v_and_b32 v135, 0xffff0000, v131
  v_add_f32 v124, v124, v132
  v_add_f32 v125, v125, v133
  v_add_f32 v126, v126, v134
  v_add_f32 v127, v127, v135
  v_cvt_pk_bf16_f32 v114, v124, v125
  v_cvt_pk_bf16_f32 v115, v126, v127
  ds_write_b64 v46, v[114:115] offset:2048
  v_lshlrev_b32 v124, 16, v116
  v_and_b32 v125, 0xffff0000, v116
  v_lshlrev_b32 v126, 16, v117
  v_and_b32 v127, 0xffff0000, v117
  v_mul_f32 v124, v124, v33
  v_mul_f32 v125, v125, v33
  v_mul_f32 v126, v126, v33
  v_mul_f32 v127, v127, v33
  v_cvt_pk_bf16_f32 v128, v124, v125
  v_cvt_pk_bf16_f32 v129, v126, v127
  v_cvt_pk_bf16_f32 v130, v76, v77
  v_cvt_pk_bf16_f32 v131, v78, v79
  v_lshlrev_b32 v124, 16, v128
  v_and_b32 v125, 0xffff0000, v128
  v_lshlrev_b32 v132, 16, v130
  v_and_b32 v133, 0xffff0000, v130
  v_lshlrev_b32 v126, 16, v129
  v_and_b32 v127, 0xffff0000, v129
  v_lshlrev_b32 v134, 16, v131
  v_and_b32 v135, 0xffff0000, v131
  v_add_f32 v124, v124, v132
  v_add_f32 v125, v125, v133
  v_add_f32 v126, v126, v134
  v_add_f32 v127, v127, v135
  v_cvt_pk_bf16_f32 v116, v124, v125
  v_cvt_pk_bf16_f32 v117, v126, v127
  ds_write_b64 v46, v[116:117] offset:2560
  v_lshlrev_b32 v124, 16, v118
  v_and_b32 v125, 0xffff0000, v118
  v_lshlrev_b32 v126, 16, v119
  v_and_b32 v127, 0xffff0000, v119
  v_mul_f32 v124, v124, v33
  v_mul_f32 v125, v125, v33
  v_mul_f32 v126, v126, v33
  v_mul_f32 v127, v127, v33
  v_cvt_pk_bf16_f32 v128, v124, v125
  v_cvt_pk_bf16_f32 v129, v126, v127
  v_cvt_pk_bf16_f32 v130, v80, v81
  v_cvt_pk_bf16_f32 v131, v82, v83
  v_lshlrev_b32 v124, 16, v128
  v_and_b32 v125, 0xffff0000, v128
  v_lshlrev_b32 v132, 16, v130
  v_and_b32 v133, 0xffff0000, v130
  v_lshlrev_b32 v126, 16, v129
  v_and_b32 v127, 0xffff0000, v129
  v_lshlrev_b32 v134, 16, v131
  v_and_b32 v135, 0xffff0000, v131
  v_add_f32 v124, v124, v132
  v_add_f32 v125, v125, v133
  v_add_f32 v126, v126, v134
  v_add_f32 v127, v127, v135
  v_cvt_pk_bf16_f32 v118, v124, v125
  v_cvt_pk_bf16_f32 v119, v126, v127
  ds_write_b64 v46, v[118:119] offset:3072
  v_lshlrev_b32 v124, 16, v120
  v_and_b32 v125, 0xffff0000, v120
  v_lshlrev_b32 v126, 16, v121
  v_and_b32 v127, 0xffff0000, v121
  v_mul_f32 v124, v124, v33
  v_mul_f32 v125, v125, v33
  v_mul_f32 v126, v126, v33
  v_mul_f32 v127, v127, v33
  v_cvt_pk_bf16_f32 v128, v124, v125
  v_cvt_pk_bf16_f32 v129, v126, v127
  v_cvt_pk_bf16_f32 v130, v84, v85
  v_cvt_pk_bf16_f32 v131, v86, v87
  v_lshlrev_b32 v124, 16, v128
  v_and_b32 v125, 0xffff0000, v128
  v_lshlrev_b32 v132, 16, v130
  v_and_b32 v133, 0xffff0000, v130
  v_lshlrev_b32 v126, 16, v129
  v_and_b32 v127, 0xffff0000, v129
  v_lshlrev_b32 v134, 16, v131
  v_and_b32 v135, 0xffff0000, v131
  v_add_f32 v124, v124, v132
  v_add_f32 v125, v125, v133
  v_add_f32 v126, v126, v134
  v_add_f32 v127, v127, v135
  v_cvt_pk_bf16_f32 v120, v124, v125
  v_cvt_pk_bf16_f32 v121, v126, v127
  ds_write_b64 v46, v[120:121] offset:3584
  v_lshlrev_b32 v124, 16, v122
  v_and_b32 v125, 0xffff0000, v122
  v_lshlrev_b32 v126, 16, v123
  v_and_b32 v127, 0xffff0000, v123
  v_mul_f32 v124, v124, v33
  v_mul_f32 v125, v125, v33
  v_mul_f32 v126, v126, v33
  v_mul_f32 v127, v127, v33
  v_cvt_pk_bf16_f32 v128, v124, v125
  v_cvt_pk_bf16_f32 v129, v126, v127
  v_cvt_pk_bf16_f32 v130, v88, v89
  v_cvt_pk_bf16_f32 v131, v90, v91
  v_lshlrev_b32 v124, 16, v128
  v_and_b32 v125, 0xffff0000, v128
  v_lshlrev_b32 v132, 16, v130
  v_and_b32 v133, 0xffff0000, v130
  v_lshlrev_b32 v126, 16, v129
  v_and_b32 v127, 0xffff0000, v129
  v_lshlrev_b32 v134, 16, v131
  v_and_b32 v135, 0xffff0000, v131
  v_add_f32 v124, v124, v132
  v_add_f32 v125, v125, v133
  v_add_f32 v126, v126, v134
  v_add_f32 v127, v127, v135
  v_cvt_pk_bf16_f32 v122, v124, v125
  v_cvt_pk_bf16_f32 v123, v126, v127
  ds_write_b64 v46, v[122:123] offset:4096
  s_waitcnt lgkmcnt(0)
  s_barrier
  v_lshlrev_b32 v6, 3, v0
  v_mul_u32_u24 v5, 7168, v0
  v_add_u32 v36, 512, v6
  ds_read_b64 v[8:9], v36
  v_add_u32 v36, 25088, v6
  ds_read_b64 v[10:11], v36
  v_add_u32 v36, 49664, v6
  ds_read_b64 v[12:13], v36
  v_add_u32 v36, 74240, v6
  ds_read_b64 v[14:15], v36
  s_waitcnt lgkmcnt(0)
  s_add_u32 s22, s21, 0
  s_add_u32 s23, s22, 3584
  v_perm_b32 v16, v10, v8, s24
  v_perm_b32 v17, v14, v12, s24
  buffer_store_dwordx2 v[16:17], v5, s[88:91], s22 offen offset:0
  v_perm_b32 v18, v10, v8, s25
  v_perm_b32 v19, v14, v12, s25
  buffer_store_dwordx2 v[18:19], v5, s[88:91], s22 offen offset:1792
  v_perm_b32 v20, v11, v9, s24
  v_perm_b32 v21, v15, v13, s24
  buffer_store_dwordx2 v[20:21], v5, s[88:91], s23 offen offset:0
  v_perm_b32 v22, v11, v9, s25
  v_perm_b32 v23, v15, v13, s25
  buffer_store_dwordx2 v[22:23], v5, s[88:91], s23 offen offset:1792
  v_add_u32 v36, 2560, v6
  ds_read_b64 v[8:9], v36
  v_add_u32 v36, 27136, v6
  ds_read_b64 v[10:11], v36
  v_add_u32 v36, 51712, v6
  ds_read_b64 v[12:13], v36
  v_add_u32 v36, 76288, v6
  ds_read_b64 v[14:15], v36
  s_waitcnt lgkmcnt(0)
  s_add_u32 s22, s21, 1835008
  s_add_u32 s23, s22, 3584
  v_perm_b32 v24, v10, v8, s24
  v_perm_b32 v25, v14, v12, s24
  buffer_store_dwordx2 v[24:25], v5, s[88:91], s22 offen offset:0
  v_perm_b32 v26, v10, v8, s25
  v_perm_b32 v27, v14, v12, s25
  buffer_store_dwordx2 v[26:27], v5, s[88:91], s22 offen offset:1792
  v_perm_b32 v28, v11, v9, s24
  v_perm_b32 v29, v15, v13, s24
  buffer_store_dwordx2 v[28:29], v5, s[88:91], s23 offen offset:0
  v_perm_b32 v30, v11, v9, s25
  v_perm_b32 v31, v15, v13, s25
  buffer_store_dwordx2 v[30:31], v5, s[88:91], s23 offen offset:1792
  s_branch wk_loop
wk_tok:
  s_sub_u32 s3, s3, 752
  s_cmp_ge_u32 s3, 512
  s_cbranch_scc1 wk_done
  s_and_b32 s18, s3, 3
  s_lshr_b32 s17, s3, 2
  s_cmp_lt_u32 s17, 8
  s_cbranch_scc1 wk_tokp
  s_sub_u32 s20, s17, 8
  s_sub_u32 s17, s17, 64
  s_cmp_ge_u32 s20, 112
  s_cbranch_scc1 wk_toko
  s_lshr_b32 s17, s20, 1
  s_bitcmp0_b32 s20, 0
  s_cbranch_scc1 wk_toko
  s_add_u32 s17, s17, 8
wk_tokp:
  s_lshl_b32 s20, s18, 2
  s_add_u32 s20, s20, s16
  s_lshl_b32 s21, s17, 4
  s_add_u32 s21, s21, s20
  s_mul_i32 s21, s21, 28672
  s_add_u32 s21, s21, 46399488
  s_mul_i32 s23, s17, 28672
  s_add_u32 s23, s23, 75759616
  s_mul_i32 s24, s17, 7168
  s_add_u32 s24, s24, 65536
  s_lshr_b32 s25, s17, 3
  s_lshl_b32 s25, s25, 4
  s_add_u32 s25, s25, s20
  s_lshl_b32 s25, s25, 7
  s_add_u32 s25, s25, 540672
  v_mov_b32 v60, 0
  s_mov_b32 s30, 0
wp_wf:
  buffer_load_dword v61, v60, s[8:11], s25 offen sc1
  s_waitcnt vmcnt(0)
  v_cmp_ne_u32 vcc, 56, v61
  s_cbranch_vccz wp_wf_ok
  s_sleep 4
  s_cmp_ge_u32 s17, 50
  s_cbranch_scc1 wp_wf_bo
  s_sleep 64
wp_wf_bo:
  s_add_u32 s30, s30, 1
  s_cmp_lt_u32 s30, 2000000
  s_cbranch_scc1 wp_wf
  s_branch wp_abort
wp_wf_ok:
  s_lshl_b32 s25, s17, 1
  s_mul_i32 s25, s25, 20480
  s_add_u32 s25, s25, 86114304
  s_lshl_b32 s26, s20, 10
  s_add_u32 s26, s26, s25
  s_lshl_b32 s27, s18, 10
  s_add_u32 s27, s27, s25
  s_lshr_b32 s28, s16, 1
  s_lshl_b32 s28, s28, 3
  s_add_u32 s27, s27, s28
  s_add_u32 s27, s27, 16384
  s_and_b32 s28, s16, 1
  s_cmp_eq_u32 s28, 0
  s_cselect_b32 s50, -1, 0
  s_cselect_b32 s51, 0, -1
  v_mov_b32 v44, -1
  v_mov_b32 v45, -1
  v_mov_b32 v46, -1
  v_mov_b32 v47, -1
  s_add_u32 s28, s26, 0
  s_add_u32 s29, s27, 0
  buffer_store_dwordx4 v[44:47], v2, s[8:11], s28 offen sc1
  s_mov_b64 exec, s[50:51]
  buffer_store_dwordx2 v[44:45], v2, s[8:11], s29 offen sc1
  s_mov_b64 exec, -1
  s_add_u32 s28, s26, 20480
  s_add_u32 s29, s27, 20480
  buffer_store_dwordx4 v[44:47], v2, s[8:11], s28 offen sc1
  s_mov_b64 exec, s[50:51]
  buffer_store_dwordx2 v[44:45], v2, s[8:11], s29 offen sc1
  s_mov_b64 exec, -1
  s_add_u32 s22, s21, 0
  buffer_load_dwordx4 a[0:3], v2, s[8:11], s22 offen offset:0 sc1
  buffer_load_dwordx4 a[4:7], v2, s[8:11], s22 offen offset:1024 sc1
  buffer_load_dwordx4 a[8:11], v2, s[8:11], s22 offen offset:2048 sc1
  buffer_load_dwordx4 a[12:15], v2, s[8:11], s22 offen offset:3072 sc1
  s_add_u32 s22, s21, 4096
  buffer_load_dwordx4 a[16:19], v2, s[8:11], s22 offen offset:0 sc1
  buffer_load_dwordx4 a[20:23], v2, s[8:11], s22 offen offset:1024 sc1
  buffer_load_dwordx4 a[24:27], v2, s[8:11], s22 offen offset:2048 sc1
  buffer_load_dwordx4 a[28:31], v2, s[8:11], s22 offen offset:3072 sc1
  s_add_u32 s22, s21, 8192
  buffer_load_dwordx4 a[32:35], v2, s[8:11], s22 offen offset:0 sc1
  buffer_load_dwordx4 a[36:39], v2, s[8:11], s22 offen offset:1024 sc1
  buffer_load_dwordx4 a[40:43], v2, s[8:11], s22 offen offset:2048 sc1
  buffer_load_dwordx4 a[44:47], v2, s[8:11], s22 offen offset:3072 sc1
  s_add_u32 s22, s21, 12288
  buffer_load_dwordx4 a[48:51], v2, s[8:11], s22 offen offset:0 sc1
  buffer_load_dwordx4 a[52:55], v2, s[8:11], s22 offen offset:1024 sc1
  buffer_load_dwordx4 a[56:59], v2, s[8:11], s22 offen offset:2048 sc1
  buffer_load_dwordx4 a[60:63], v2, s[8:11], s22 offen offset:3072 sc1
  s_add_u32 s22, s21, 16384
  buffer_load_dwordx4 a[64:67], v2, s[8:11], s22 offen offset:0 sc1
  buffer_load_dwordx4 a[68:71], v2, s[8:11], s22 offen offset:1024 sc1
  buffer_load_dwordx4 a[72:75], v2, s[8:11], s22 offen offset:2048 sc1
  buffer_load_dwordx4 a[76:79], v2, s[8:11], s22 offen offset:3072 sc1
  s_add_u32 s22, s21, 20480
  buffer_load_dwordx4 a[80:83], v2, s[8:11], s22 offen offset:0 sc1
  buffer_load_dwordx4 a[84:87], v2, s[8:11], s22 offen offset:1024 sc1
  buffer_load_dwordx4 a[88:91], v2, s[8:11], s22 offen offset:2048 sc1
  buffer_load_dwordx4 a[92:95], v2, s[8:11], s22 offen offset:3072 sc1
  s_add_u32 s22, s21, 24576
  buffer_load_dwordx4 a[96:99], v2, s[8:11], s22 offen offset:0 sc1
  buffer_load_dwordx4 a[100:103], v2, s[8:11], s22 offen offset:1024 sc1
  buffer_load_dwordx4 a[104:107], v2, s[8:11], s22 offen offset:2048 sc1
  buffer_load_dwordx4 a[108:111], v2, s[8:11], s22 offen offset:3072 sc1
  s_add_u32 s22, s23, 0
  buffer_load_dwordx4 a[112:115], v2, s[8:11], s22 offen offset:0 sc1
  buffer_load_dwordx4 a[116:119], v2, s[8:11], s22 offen offset:1024 sc1
  buffer_load_dwordx4 a[120:123], v2, s[8:11], s22 offen offset:2048 sc1
  buffer_load_dwordx4 a[124:127], v2, s[8:11], s22 offen offset:3072 sc1
  s_add_u32 s22, s23, 4096
  buffer_load_dwordx4 a[128:131], v2, s[8:11], s22 offen offset:0 sc1
  buffer_load_dwordx4 a[132:135], v2, s[8:11], s22 offen offset:1024 sc1
  buffer_load_dwordx4 a[136:139], v2, s[8:11], s22 offen offset:2048 sc1
  buffer_load_dwordx4 a[140:143], v2, s[8:11], s22 offen offset:3072 sc1
  s_add_u32 s22, s23, 8192
  buffer_load_dwordx4 a[144:147], v2, s[8:11], s22 offen offset:0 sc1
  buffer_load_dwordx4 a[148:151], v2, s[8:11], s22 offen offset:1024 sc1
  buffer_load_dwordx4 a[152:155], v2, s[8:11], s22 offen offset:2048 sc1
  buffer_load_dwordx4 a[156:159], v2, s[8:11], s22 offen offset:3072 sc1
  s_add_u32 s22, s23, 12288
  buffer_load_dwordx4 a[160:163], v2, s[8:11], s22 offen offset:0 sc1
  buffer_load_dwordx4 a[164:167], v2, s[8:11], s22 offen offset:1024 sc1
  buffer_load_dwordx4 a[168:171], v2, s[8:11], s22 offen offset:2048 sc1
  buffer_load_dwordx4 a[172:175], v2, s[8:11], s22 offen offset:3072 sc1
  s_add_u32 s22, s23, 16384
  buffer_load_dwordx4 a[176:179], v2, s[8:11], s22 offen offset:0 sc1
  buffer_load_dwordx4 a[180:183], v2, s[8:11], s22 offen offset:1024 sc1
  buffer_load_dwordx4 a[184:187], v2, s[8:11], s22 offen offset:2048 sc1
  buffer_load_dwordx4 a[188:191], v2, s[8:11], s22 offen offset:3072 sc1
  s_add_u32 s22, s23, 20480
  buffer_load_dwordx4 a[192:195], v2, s[8:11], s22 offen offset:0 sc1
  buffer_load_dwordx4 a[196:199], v2, s[8:11], s22 offen offset:1024 sc1
  buffer_load_dwordx4 a[200:203], v2, s[8:11], s22 offen offset:2048 sc1
  buffer_load_dwordx4 a[204:207], v2, s[8:11], s22 offen offset:3072 sc1
  s_add_u32 s22, s23, 24576
  buffer_load_dwordx4 a[208:211], v2, s[8:11], s22 offen offset:0 sc1
  buffer_load_dwordx4 a[212:215], v2, s[8:11], s22 offen offset:1024 sc1
  buffer_load_dwordx4 a[216:219], v2, s[8:11], s22 offen offset:2048 sc1
  buffer_load_dwordx4 a[220:223], v2, s[8:11], s22 offen offset:3072 sc1
  v_lshl_add_u32 v5, v3, 2, 0
  v_cmp_le_u32 s[40:41], v5, v4
  v_lshl_add_u32 v5, v3, 2, 1
  v_cmp_le_u32 s[42:43], v5, v4
  v_lshl_add_u32 v5, v3, 2, 2
  v_cmp_le_u32 s[44:45], v5, v4
  v_lshl_add_u32 v5, v3, 2, 3
  v_cmp_le_u32 s[46:47], v5, v4
  v_cmp_gt_u32 s[48:49], 2, v3
  v_mov_b32 v6, 0xff800000
  s_waitcnt vmcnt(0)
  s_lshl_b32 s25, s17, 7
  s_add_u32 s25, s25, 557056
  v_mov_b32 v5, 1
  v_mov_b32 v7, 0
  s_waitcnt vmcnt(0)
  s_mov_b64 exec, 1
  buffer_atomic_add v5, v7, s[8:11], s25 offen
  s_mov_b64 exec, -1
  v_mfma_f32_16x16x32_bf16 v[8:11], a[112:115], a[0:3], 0
  v_mfma_f32_16x16x32_bf16 v[12:15], a[112:115], a[56:59], 0
  v_mfma_f32_16x16x32_bf16 v[16:19], a[168:171], a[56:59], 0
  v_mfma_f32_16x16x32_bf16 v[8:11], a[116:119], a[4:7], v[8:11]
  v_mfma_f32_16x16x32_bf16 v[12:15], a[116:119], a[60:63], v[12:15]
  v_mfma_f32_16x16x32_bf16 v[16:19], a[172:175], a[60:63], v[16:19]
  v_mfma_f32_16x16x32_bf16 v[8:11], a[120:123], a[8:11], v[8:11]
  v_mfma_f32_16x16x32_bf16 v[12:15], a[120:123], a[64:67], v[12:15]
  v_mfma_f32_16x16x32_bf16 v[16:19], a[176:179], a[64:67], v[16:19]
  v_mfma_f32_16x16x32_bf16 v[8:11], a[124:127], a[12:15], v[8:11]
  v_mfma_f32_16x16x32_bf16 v[12:15], a[124:127], a[68:71], v[12:15]
  v_mfma_f32_16x16x32_bf16 v[16:19], a[180:183], a[68:71], v[16:19]
  v_mfma_f32_16x16x32_bf16 v[8:11], a[128:131], a[16:19], v[8:11]
  v_mfma_f32_16x16x32_bf16 v[12:15], a[128:131], a[72:75], v[12:15]
  v_mfma_f32_16x16x32_bf16 v[16:19], a[184:187], a[72:75], v[16:19]
  v_mfma_f32_16x16x32_bf16 v[8:11], a[132:135], a[20:23], v[8:11]
  v_mfma_f32_16x16x32_bf16 v[12:15], a[132:135], a[76:79], v[12:15]
  v_mfma_f32_16x16x32_bf16 v[16:19], a[188:191], a[76:79], v[16:19]
  v_mfma_f32_16x16x32_bf16 v[8:11], a[136:139], a[24:27], v[8:11]
  v_mfma_f32_16x16x32_bf16 v[12:15], a[136:139], a[80:83], v[12:15]
  v_mfma_f32_16x16x32_bf16 v[16:19], a[192:195], a[80:83], v[16:19]
  v_mfma_f32_16x16x32_bf16 v[8:11], a[140:143], a[28:31], v[8:11]
  v_mfma_f32_16x16x32_bf16 v[12:15], a[140:143], a[84:87], v[12:15]
  v_mfma_f32_16x16x32_bf16 v[16:19], a[196:199], a[84:87], v[16:19]
  v_mfma_f32_16x16x32_bf16 v[8:11], a[144:147], a[32:35], v[8:11]
  v_mfma_f32_16x16x32_bf16 v[12:15], a[144:147], a[88:91], v[12:15]
  v_mfma_f32_16x16x32_bf16 v[16:19], a[200:203], a[88:91], v[16:19]
  v_mfma_f32_16x16x32_bf16 v[8:11], a[148:151], a[36:39], v[8:11]
  v_mfma_f32_16x16x32_bf16 v[12:15], a[148:151], a[92:95], v[12:15]
  v_mfma_f32_16x16x32_bf16 v[16:19], a[204:207], a[92:95], v[16:19]
  v_mfma_f32_16x16x32_bf16 v[8:11], a[152:155], a[40:43], v[8:11]
  v_mfma_f32_16x16x32_bf16 v[12:15], a[152:155], a[96:99], v[12:15]
  v_mfma_f32_16x16x32_bf16 v[16:19], a[208:211], a[96:99], v[16:19]
  v_mfma_f32_16x16x32_bf16 v[8:11], a[156:159], a[44:47], v[8:11]
  v_mfma_f32_16x16x32_bf16 v[12:15], a[156:159], a[100:103], v[12:15]
  v_mfma_f32_16x16x32_bf16 v[16:19], a[212:215], a[100:103], v[16:19]
  v_mfma_f32_16x16x32_bf16 v[8:11], a[160:163], a[48:51], v[8:11]
  v_mfma_f32_16x16x32_bf16 v[12:15], a[160:163], a[104:107], v[12:15]
  v_mfma_f32_16x16x32_bf16 v[16:19], a[216:219], a[104:107], v[16:19]
  v_mfma_f32_16x16x32_bf16 v[8:11], a[164:167], a[52:55], v[8:11]
  v_mfma_f32_16x16x32_bf16 v[12:15], a[164:167], a[108:111], v[12:15]
  v_mfma_f32_16x16x32_bf16 v[16:19], a[220:223], a[108:111], v[16:19]
  s_mul_i32 s22, s20, 448
  s_add_u32 s22, s22, s24
  s_mov_b32 s31, 0
  v_mov_b32 v62, s22
  s_mov_b32 s30, 0
wp_pm:
  s_cmp_ge_u32 s17, 64
  s_cbranch_scc1 wp_pf
  buffer_load_dword v61, v62, s[8:11], 0 offen sc1
  s_waitcnt vmcnt(0)
  v_subrev_u32 v61, s31, v61
  v_cmp_eq_u32 vcc, -1, v61
  s_cbranch_vccnz wp_pr
wp_pf:
  s_add_u32 s22, s24, 4096
  buffer_load_dwordx4 v[64:67], v2, s[8:11], s24 offen offset:0 sc1
  buffer_load_dwordx4 v[68:71], v2, s[8:11], s24 offen offset:1024 sc1
  buffer_load_dwordx4 v[72:75], v2, s[8:11], s24 offen offset:2048 sc1
  buffer_load_dwordx4 v[76:79], v2, s[8:11], s24 offen offset:3072 sc1
  buffer_load_dwordx4 v[80:83], v2, s[8:11], s22 offen offset:0 sc1
  buffer_load_dwordx4 v[84:87], v2, s[8:11], s22 offen offset:1024 sc1
  buffer_load_dwordx4 v[88:91], v2, s[8:11], s22 offen offset:2048 sc1
  s_waitcnt vmcnt(0)
  v_max_u32 v61, v64, v65
  v_max3_u32 v61, v61, v66, v67
  v_max3_u32 v61, v61, v68, v69
  v_max3_u32 v61, v61, v70, v71
  v_max3_u32 v61, v61, v72, v73
  v_max3_u32 v61, v61, v74, v75
  v_max3_u32 v61, v61, v76, v77
  v_max3_u32 v61, v61, v78, v79
  v_max3_u32 v61, v61, v80, v81
  v_max3_u32 v61, v61, v82, v83
  v_max3_u32 v61, v61, v84, v85
  v_max3_u32 v61, v61, v86, v87
  v_max3_u32 v61, v61, v88, v89
  v_max3_u32 v61, v61, v90, v91
  v_cmp_eq_u32 vcc, -1, v61
  s_cbranch_vccz wp_pk
  s_add_u32 s30, s30, 1
  s_cmp_eq_u32 s31, 0
  s_cbranch_scc1 wp_pr
  s_cmp_lt_u32 s30, 2000000
  s_cbranch_scc1 wp_pf
wp_pr:
  s_sleep 4
  s_cmp_ge_u32 s17, 50
  s_cbranch_scc1 wp_pm_bo
  s_sleep 64
wp_pm_bo:
  s_add_u32 s30, s30, 1
  s_cmp_lt_u32 s30, 2000000
  s_cbranch_scc1 wp_pm
  s_branch wp_abort
wp_pk:
  buffer_load_dword v250, v251, s[8:11], 0 offen sc1
  v_mfma_f32_16x16x32_bf16 v[20:23], v[64:67], a[0:3], 0
  v_mfma_f32_16x16x32_bf16 v[24:27], v[64:67], a[4:7], 0
  v_mfma_f32_16x16x32_bf16 v[28:31], v[64:67], a[56:59], 0
  v_mfma_f32_16x16x32_bf16 v[32:35], v[64:67], a[60:63], 0
  v_mfma_f32_16x16x32_bf16 v[20:23], v[68:71], a[8:11], v[20:23]
  v_mfma_f32_16x16x32_bf16 v[24:27], v[68:71], a[12:15], v[24:27]
  v_mfma_f32_16x16x32_bf16 v[28:31], v[68:71], a[64:67], v[28:31]
  v_mfma_f32_16x16x32_bf16 v[32:35], v[68:71], a[68:71], v[32:35]
  v_mfma_f32_16x16x32_bf16 v[20:23], v[72:75], a[16:19], v[20:23]
  v_mfma_f32_16x16x32_bf16 v[24:27], v[72:75], a[20:23], v[24:27]
  v_mfma_f32_16x16x32_bf16 v[28:31], v[72:75], a[72:75], v[28:31]
  v_mfma_f32_16x16x32_bf16 v[32:35], v[72:75], a[76:79], v[32:35]
  v_mfma_f32_16x16x32_bf16 v[20:23], v[76:79], a[24:27], v[20:23]
  v_mfma_f32_16x16x32_bf16 v[24:27], v[76:79], a[28:31], v[24:27]
  v_mfma_f32_16x16x32_bf16 v[28:31], v[76:79], a[80:83], v[28:31]
  v_mfma_f32_16x16x32_bf16 v[32:35], v[76:79], a[84:87], v[32:35]
  v_mfma_f32_16x16x32_bf16 v[20:23], v[80:83], a[32:35], v[20:23]
  v_mfma_f32_16x16x32_bf16 v[24:27], v[80:83], a[36:39], v[24:27]
  v_mfma_f32_16x16x32_bf16 v[28:31], v[80:83], a[88:91], v[28:31]
  v_mfma_f32_16x16x32_bf16 v[32:35], v[80:83], a[92:95], v[32:35]
  v_mfma_f32_16x16x32_bf16 v[20:23], v[84:87], a[40:43], v[20:23]
  v_mfma_f32_16x16x32_bf16 v[24:27], v[84:87], a[44:47], v[24:27]
  v_mfma_f32_16x16x32_bf16 v[28:31], v[84:87], a[96:99], v[28:31]
  v_mfma_f32_16x16x32_bf16 v[32:35], v[84:87], a[100:103], v[32:35]
  v_mfma_f32_16x16x32_bf16 v[20:23], v[88:91], a[48:51], v[20:23]
  v_mfma_f32_16x16x32_bf16 v[24:27], v[88:91], a[52:55], v[24:27]
  v_mfma_f32_16x16x32_bf16 v[28:31], v[88:91], a[104:107], v[28:31]
  v_mfma_f32_16x16x32_bf16 v[32:35], v[88:91], a[108:111], v[32:35]
  v_cndmask_b32 v8, v6, v8, s[40:41]
  v_cndmask_b32 v9, v6, v9, s[42:43]
  v_cndmask_b32 v10, v6, v10, s[44:45]
  v_cndmask_b32 v11, v6, v11, s[46:47]
  v_cndmask_b32 v20, v24, v20, s[48:49]
  v_cndmask_b32 v21, v25, v21, s[48:49]
  v_cndmask_b32 v22, v26, v22, s[48:49]
  v_cndmask_b32 v23, v27, v23, s[48:49]
  v_mov_b32 v24, v20
  v_mov_b32 v25, v21
  v_mov_b32 v26, v22
  v_mov_b32 v27, v23
  v_permlane32_swap_b32 v20, v24
  v_permlane32_swap_b32 v21, v25
  v_permlane32_swap_b32 v22, v26
  v_permlane32_swap_b32 v23, v27
  v_add_f32 v20, v20, v24
  v_add_f32 v21, v21, v25
  v_add_f32 v22, v22, v26
  v_add_f32 v23, v23, v27
  v_max3_f32 v40, v8, v9, v10
  v_max3_f32 v40, v40, v11, v20
  v_max3_f32 v40, v40, v21, v22
  v_max_f32 v40, v40, v23
  v_mov_b32 v41, v40
  s_nop 1
  v_permlane16_swap_b32 v40, v41
  v_max_f32 v40, v40, v41
  v_mov_b32 v41, v40
  s_nop 1
  v_permlane32_swap_b32 v40, v41
  v_max_f32 v40, v40, v41
  v_sub_f32 v8, v8, v40
  v_sub_f32 v9, v9, v40
  v_sub_f32 v10, v10, v40
  v_sub_f32 v11, v11, v40
  v_sub_f32 v20, v20, v40
  v_sub_f32 v21, v21, v40
  v_sub_f32 v22, v22, v40
  v_sub_f32 v23, v23, v40
  v_exp_f32 v8, v8
  v_exp_f32 v9, v9
  v_exp_f32 v10, v10
  v_exp_f32 v11, v11
  v_exp_f32 v20, v20
  v_exp_f32 v21, v21
  v_exp_f32 v22, v22
  v_exp_f32 v23, v23
  v_add_f32 v42, v20, v21
  v_add_f32 v43, v22, v23
  v_add_f32 v42, v42, v43
  v_mul_f32 v42, 0.5, v42
  v_add_f32 v42, v42, v8
  v_add_f32 v42, v42, v9
  v_add_f32 v42, v42, v10
  v_add_f32 v42, v42, v11
  v_mov_b32 v41, v42
  s_nop 1
  v_permlane16_swap_b32 v42, v41
  v_add_f32 v42, v42, v41
  v_mov_b32 v41, v42
  s_nop 1
  v_permlane32_swap_b32 v42, v41
  v_add_f32 v42, v42, v41
  v_rcp_f32 v42, v42
  s_nop 0
  v_mul_f32 v8, v8, v42
  v_mul_f32 v9, v9, v42
  v_mul_f32 v10, v10, v42
  v_mul_f32 v11, v11, v42
  v_mul_f32 v20, v20, v42
  v_mul_f32 v21, v21, v42
  v_mul_f32 v22, v22, v42
  v_mul_f32 v23, v23, v42
  v_cvt_pk_bf16_f32 v44, v8, 0
  v_cvt_pk_bf16_f32 v45, v9, 0
  v_cvt_pk_bf16_f32 v46, v10, 0
  v_cvt_pk_bf16_f32 v47, v11, 0
  v_cvt_pk_bf16_f32 v48, v20, v21
  v_cvt_pk_bf16_f32 v49, v22, v23
  v_min_u32 v44, -2, v44
  v_min_u32 v45, -2, v45
  v_min_u32 v46, -2, v46
  v_min_u32 v47, -2, v47
  v_min_u32 v48, -2, v48
  v_min_u32 v49, -2, v49
  buffer_store_dwordx4 v[44:47], v2, s[8:11], s26 offen sc1
  s_mov_b64 exec, s[50:51]
  buffer_store_dwordx2 v[48:49], v2, s[8:11], s27 offen sc1
  s_mov_b64 exec, -1
  s_add_u32 s26, s26, 20480
  s_add_u32 s27, s27, 20480
  v_cndmask_b32 v16, v6, v16, s[40:41]
  v_cndmask_b32 v17, v6, v17, s[42:43]
  v_cndmask_b32 v18, v6, v18, s[44:45]
  v_cndmask_b32 v19, v6, v19, s[46:47]
  v_cndmask_b32 v28, v32, v28, s[48:49]
  v_cndmask_b32 v29, v33, v29, s[48:49]
  v_cndmask_b32 v30, v34, v30, s[48:49]
  v_cndmask_b32 v31, v35, v31, s[48:49]
  v_mov_b32 v32, v28
  v_mov_b32 v33, v29
  v_mov_b32 v34, v30
  v_mov_b32 v35, v31
  v_permlane32_swap_b32 v28, v32
  v_permlane32_swap_b32 v29, v33
  v_permlane32_swap_b32 v30, v34
  v_permlane32_swap_b32 v31, v35
  v_add_f32 v28, v28, v32
  v_add_f32 v29, v29, v33
  v_add_f32 v30, v30, v34
  v_add_f32 v31, v31, v35
  v_max3_f32 v40, v12, v13, v14
  v_max3_f32 v40, v40, v15, v16
  v_max3_f32 v40, v40, v17, v18
  v_max3_f32 v40, v40, v19, v28
  v_max3_f32 v40, v40, v29, v30
  v_max_f32 v40, v40, v31
  v_mov_b32 v41, v40
  s_nop 1
  v_permlane16_swap_b32 v40, v41
  v_max_f32 v40, v40, v41
  v_mov_b32 v41, v40
  s_nop 1
  v_permlane32_swap_b32 v40, v41
  v_max_f32 v40, v40, v41
  v_sub_f32 v12, v12, v40
  v_sub_f32 v13, v13, v40
  v_sub_f32 v14, v14, v40
  v_sub_f32 v15, v15, v40
  v_sub_f32 v16, v16, v40
  v_sub_f32 v17, v17, v40
  v_sub_f32 v18, v18, v40
  v_sub_f32 v19, v19, v40
  v_sub_f32 v28, v28, v40
  v_sub_f32 v29, v29, v40
  v_sub_f32 v30, v30, v40
  v_sub_f32 v31, v31, v40
  v_exp_f32 v12, v12
  v_exp_f32 v13, v13
  v_exp_f32 v14, v14
  v_exp_f32 v15, v15
  v_exp_f32 v16, v16
  v_exp_f32 v17, v17
  v_exp_f32 v18, v18
  v_exp_f32 v19, v19
  v_exp_f32 v28, v28
  v_exp_f32 v29, v29
  v_exp_f32 v30, v30
  v_exp_f32 v31, v31
  v_add_f32 v42, v28, v29
  v_add_f32 v43, v30, v31
  v_add_f32 v42, v42, v43
  v_mul_f32 v42, 0.5, v42
  v_add_f32 v42, v42, v12
  v_add_f32 v42, v42, v13
  v_add_f32 v42, v42, v14
  v_add_f32 v42, v42, v15
  v_add_f32 v42, v42, v16
  v_add_f32 v42, v42, v17
  v_add_f32 v42, v42, v18
  v_add_f32 v42, v42, v19
  v_mov_b32 v41, v42
  s_nop 1
  v_permlane16_swap_b32 v42, v41
  v_add_f32 v42, v42, v41
  v_mov_b32 v41, v42
  s_nop 1
  v_permlane32_swap_b32 v42, v41
  v_add_f32 v42, v42, v41
  v_rcp_f32 v42, v42
  s_nop 0
  v_mul_f32 v12, v12, v42
  v_mul_f32 v13, v13, v42
  v_mul_f32 v14, v14, v42
  v_mul_f32 v15, v15, v42
  v_mul_f32 v16, v16, v42
  v_mul_f32 v17, v17, v42
  v_mul_f32 v18, v18, v42
  v_mul_f32 v19, v19, v42
  v_mul_f32 v28, v28, v42
  v_mul_f32 v29, v29, v42
  v_mul_f32 v30, v30, v42
  v_mul_f32 v31, v31, v42
  v_cvt_pk_bf16_f32 v52, v12, v16
  v_cvt_pk_bf16_f32 v53, v13, v17
  v_cvt_pk_bf16_f32 v54, v14, v18
  v_cvt_pk_bf16_f32 v55, v15, v19
  v_cvt_pk_bf16_f32 v56, v28, v29
  v_cvt_pk_bf16_f32 v57, v30, v31
  v_min_u32 v52, -2, v52
  v_min_u32 v53, -2, v53
  v_min_u32 v54, -2, v54
  v_min_u32 v55, -2, v55
  v_min_u32 v56, -2, v56
  v_min_u32 v57, -2, v57
  buffer_store_dwordx4 v[52:55], v2, s[8:11], s26 offen sc1
  s_mov_b64 exec, s[50:51]
  buffer_store_dwordx2 v[56:57], v2, s[8:11], s27 offen sc1
  s_mov_b64 exec, -1
  s_branch wk_loop
wk_toko:
  s_load_dwordx2 s[36:37], s[0:1], 112
  s_waitcnt lgkmcnt(0)
  s_mov_b32 s92, s36
  s_and_b32 s93, s37, 0xffff
  s_mov_b32 s94, 3670016
  s_mov_b32 s95, 0x20000
  s_lshl_b32 s20, s18, 2
  s_add_u32 s20, s20, s16
  s_mul_i32 s24, s20, 65
  s_add_u32 s24, s24, s17
  s_lshl_b32 s24, s24, 13
  s_add_u32 s24, s24, 77602816
  s_mul_i32 s21, s20, 28672
  s_mul_i32 s22, s17, 458752
  s_add_u32 s21, s21, s22
  s_add_u32 s21, s21, 2490368
  s_lshl_b32 s25, s17, 1
  s_mul_i32 s25, s25, 20480
  s_add_u32 s25, s25, 86114304
  v_mov_b32 v5, v2
  v_min_u32 v6, 11, v4
  v_mad_u32_u24 v6, v3, 12, v6
  v_lshlrev_b32 v6, 4, v6
  v_add_u32 v6, 1024, v6
  v_lshrrev_b32 v8, 1, v3
  v_lshl_add_u32 v8, v8, 4, v4
  v_lshlrev_b32 v8, 4, v8
  v_and_b32 v9, 1, v3
  v_lshl_add_u32 v7, v9, 3, v8
  s_lshr_b32 s26, s17, 3
  s_lshl_b32 s26, s26, 4
  s_add_u32 s26, s26, s20
  s_lshl_b32 s26, s26, 7
  s_add_u32 s26, s26, 524288
  v_mov_b32 v60, 0
  s_mov_b32 s30, 0
wo_wv:
  buffer_load_dword v61, v60, s[8:11], s26 offen sc1
  s_waitcnt vmcnt(0)
  v_cmp_ne_u32 vcc, 56, v61
  s_cbranch_vccz wo_wv_ok
  s_sleep 4
  s_cmp_ge_u32 s17, 50
  s_cbranch_scc1 wo_wv_bo
  s_sleep 64
wo_wv_bo:
  s_add_u32 s30, s30, 1
  s_cmp_lt_u32 s30, 2000000
  s_cbranch_scc1 wo_wv
  s_branch wo_abort
wo_wv_ok:
  s_add_u32 s22, s21, 0
  buffer_load_dwordx4 a[0:3], v5, s[8:11], s22 offen offset:0 sc1
  buffer_load_dwordx4 a[4:7], v6, s[8:11], s22 offen offset:0 sc1
  buffer_load_dwordx4 a[8:11], v5, s[8:11], s22 offen offset:1792 sc1
  buffer_load_dwordx4 a[12:15], v6, s[8:11], s22 offen offset:1792 sc1
  s_add_u32 s22, s21, 3584
  buffer_load_dwordx4 a[16:19], v5, s[8:11], s22 offen offset:0 sc1
  buffer_load_dwordx4 a[20:23], v6, s[8:11], s22 offen offset:0 sc1
  buffer_load_dwordx4 a[24:27], v5, s[8:11], s22 offen offset:1792 sc1
  buffer_load_dwordx4 a[28:31], v6, s[8:11], s22 offen offset:1792 sc1
  s_add_u32 s22, s21, 7168
  buffer_load_dwordx4 a[32:35], v5, s[8:11], s22 offen offset:0 sc1
  buffer_load_dwordx4 a[36:39], v6, s[8:11], s22 offen offset:0 sc1
  buffer_load_dwordx4 a[40:43], v5, s[8:11], s22 offen offset:1792 sc1
  buffer_load_dwordx4 a[44:47], v6, s[8:11], s22 offen offset:1792 sc1
  s_add_u32 s22, s21, 10752
  buffer_load_dwordx4 a[48:51], v5, s[8:11], s22 offen offset:0 sc1
  buffer_load_dwordx4 a[52:55], v6, s[8:11], s22 offen offset:0 sc1
  buffer_load_dwordx4 a[56:59], v5, s[8:11], s22 offen offset:1792 sc1
  buffer_load_dwordx4 a[60:63], v6, s[8:11], s22 offen offset:1792 sc1
  s_add_u32 s22, s21, 14336
  buffer_load_dwordx4 a[64:67], v5, s[8:11], s22 offen offset:0 sc1
  buffer_load_dwordx4 a[68:71], v6, s[8:11], s22 offen offset:0 sc1
  buffer_load_dwordx4 a[72:75], v5, s[8:11], s22 offen offset:1792 sc1
  buffer_load_dwordx4 a[76:79], v6, s[8:11], s22 offen offset:1792 sc1
  s_add_u32 s22, s21, 17920
  buffer_load_dwordx4 a[80:83], v5, s[8:11], s22 offen offset:0 sc1
  buffer_load_dwordx4 a[84:87], v6, s[8:11], s22 offen offset:0 sc1
  buffer_load_dwordx4 a[88:91], v5, s[8:11], s22 offen offset:1792 sc1
  buffer_load_dwordx4 a[92:95], v6, s[8:11], s22 offen offset:1792 sc1
  s_add_u32 s22, s21, 21504
  buffer_load_dwordx4 a[96:99], v5, s[8:11], s22 offen offset:0 sc1
  buffer_load_dwordx4 a[100:103], v6, s[8:11], s22 offen offset:0 sc1
  buffer_load_dwordx4 a[104:107], v5, s[8:11], s22 offen offset:1792 sc1
  buffer_load_dwordx4 a[108:111], v6, s[8:11], s22 offen offset:1792 sc1
  s_add_u32 s22, s21, 25088
  buffer_load_dwordx4 a[112:115], v5, s[8:11], s22 offen offset:0 sc1
  buffer_load_dwordx4 a[116:119], v6, s[8:11], s22 offen offset:0 sc1
  buffer_load_dwordx4 a[120:123], v5, s[8:11], s22 offen offset:1792 sc1
  buffer_load_dwordx4 a[124:127], v6, s[8:11], s22 offen offset:1792 sc1
  s_and_b32 s27, s17, 1
  s_cmp_ge_u32 s17, 62
  s_cselect_b32 s27, s17, s27
  s_lshl_b32 s26, s20, 6
  s_add_u32 s26, s26, s27
  s_lshl_b32 s26, s26, 4
  s_add_u32 s26, s26, 565248
  v_lshlrev_b32 v60, 2, v3
  s_mov_b32 s30, 0
wo_wt:
  buffer_load_dword v61, v60, s[8:11], s26 offen sc1
  s_waitcnt vmcnt(0)
  v_cmp_ne_u32 vcc, 1, v61
  s_cbranch_vccz wo_wt_ok
  s_sleep 4
  s_cmp_ge_u32 s17, 50
  s_cbranch_scc1 wo_wt_bo
  s_sleep 64
wo_wt_bo:
  s_add_u32 s30, s30, 1
  s_cmp_lt_u32 s30, 2000000
  s_cbranch_scc1 wo_wt
  s_branch wo_abort
wo_wt_ok:
  v_mul_u32_u24 v9, 1792, v4
  v_lshl_add_u32 v9, v3, 3, v9
  s_lshl_b32 s22, s20, 5
  v_add_u32 v8, s22, v9
  s_mul_i32 s22, s20, 24
  s_add_u32 s22, s22, 512
  v_add_u32 v9, s22, v9
  v_mov_b32 v10, 0x40000000
  v_cmp_eq_u32 vcc, 3, v3
  s_nop 1
  v_cndmask_b32 v9, v9, v10, vcc
  s_mul_i32 s44, s17, 57344
  s_add_u32 s44, s44, 896
  s_add_u32 s45, s44, 28672
  s_lshl_b32 s26, s17, 7
  s_add_u32 s26, s26, 557056
  v_mov_b32 v60, 0
  s_mov_b32 s30, 0
wo_wp:
  buffer_load_dword v61, v60, s[8:11], s26 offen sc1
  s_waitcnt vmcnt(0)
  v_cmp_ne_u32 vcc, 16, v61
  s_cbranch_vccz wo_wp_ok
  s_sleep 4
  s_cmp_ge_u32 s17, 50
  s_cbranch_scc1 wo_wp_bo
  s_sleep 64
wo_wp_bo:
  s_add_u32 s30, s30, 1
  s_cmp_lt_u32 s30, 2000000
  s_cbranch_scc1 wo_wp
  s_branch wo_abort
wo_wp_ok:
  s_lshl_b32 s31, s16, 2
  s_add_u32 s31, s31, s26
  s_lshl_b32 s28, s16, 12
  s_add_u32 s26, s25, s28
  s_add_u32 s27, s26, 20480
  s_lshl_b32 s28, s16, 10
  s_add_u32 s28, s28, s25
  s_add_u32 s28, s28, 16384
  s_add_u32 s29, s28, 20480
  s_add_u32 s23, s24, 4096
  s_mov_b32 s30, 0
wo_ps:
  buffer_load_dword v61, off, s[8:11], s24 sc1
  buffer_load_dword v62, off, s[8:11], s26 sc1
  s_waitcnt vmcnt(0)
  v_max_u32 v61, v61, v62
  v_cmp_eq_u32 vcc, -1, v61
  s_cbranch_vccz wo_pl
  s_sleep 2
  s_cmp_ge_u32 s17, 50
  s_cbranch_scc1 wo_ps_bo
  s_sleep 64
wo_ps_bo:
  s_add_u32 s30, s30, 1
  s_cmp_lt_u32 s30, 2000000
  s_cbranch_scc1 wo_ps
  s_branch wo_abort
wo_pl:
  buffer_load_dword v250, v251, s[8:11], 0 offen sc1
  buffer_load_dwordx4 v[64:67], v2, s[8:11], s26 offen offset:0 sc1
  buffer_load_dwordx4 v[68:71], v2, s[8:11], s26 offen offset:1024 sc1
  buffer_load_dwordx4 v[72:75], v2, s[8:11], s26 offen offset:2048 sc1
  buffer_load_dwordx4 v[76:79], v2, s[8:11], s26 offen offset:3072 sc1
  buffer_load_dwordx4 v[80:83], v2, s[8:11], s28 offen sc1
  buffer_load_dwordx4 v[84:87], v2, s[8:11], s27 offen offset:0 sc1
  buffer_load_dwordx4 v[88:91], v2, s[8:11], s27 offen offset:1024 sc1
  buffer_load_dwordx4 v[92:95], v2, s[8:11], s27 offen offset:2048 sc1
  buffer_load_dwordx4 v[96:99], v2, s[8:11], s27 offen offset:3072 sc1
  buffer_load_dwordx4 v[100:103], v2, s[8:11], s29 offen sc1
  buffer_load_dwordx2 v[28:29], v7, s[8:11], s24 offen offset:0 sc1
  buffer_load_dwordx2 v[30:31], v7, s[8:11], s24 offen offset:512 sc1
  buffer_load_dwordx2 v[32:33], v7, s[8:11], s24 offen offset:1024 sc1
  buffer_load_dwordx2 v[34:35], v7, s[8:11], s24 offen offset:1536 sc1
  buffer_load_dwordx2 v[36:37], v7, s[8:11], s24 offen offset:2048 sc1
  buffer_load_dwordx2 v[38:39], v7, s[8:11], s24 offen offset:2560 sc1
  buffer_load_dwordx2 v[40:41], v7, s[8:11], s24 offen offset:3072 sc1
  buffer_load_dwordx2 v[42:43], v7, s[8:11], s24 offen offset:3584 sc1
  buffer_load_dwordx2 v[44:45], v7, s[8:11], s23 offen offset:0 sc1
  buffer_load_dwordx2 v[46:47], v7, s[8:11], s23 offen offset:512 sc1
  buffer_load_dwordx2 v[48:49], v7, s[8:11], s23 offen offset:1024 sc1
  buffer_load_dwordx2 v[50:51], v7, s[8:11], s23 offen offset:1536 sc1
  buffer_load_dwordx2 v[52:53], v7, s[8:11], s23 offen offset:2048 sc1
  buffer_load_dwordx2 v[54:55], v7, s[8:11], s23 offen offset:2560 sc1
  buffer_load_dwordx2 v[56:57], v7, s[8:11], s23 offen offset:3072 sc1
  buffer_load_dwordx2 v[58:59], v7, s[8:11], s23 offen offset:3584 sc1
  s_waitcnt vmcnt(16)
  v_max_u32 v61, v64, v65
  v_max3_u32 v61, v61, v66, v67
  v_max3_u32 v61, v61, v68, v69
  v_max3_u32 v61, v61, v70, v71
  v_max3_u32 v61, v61, v72, v73
  v_max3_u32 v61, v61, v74, v75
  v_max3_u32 v61, v61, v76, v77
  v_max3_u32 v61, v61, v78, v79
  v_max3_u32 v61, v61, v80, v81
  v_max3_u32 v61, v61, v82, v83
  v_max3_u32 v61, v61, v84, v85
  v_max3_u32 v61, v61, v86, v87
  v_max3_u32 v61, v61, v88, v89
  v_max3_u32 v61, v61, v90, v91
  v_max3_u32 v61, v61, v92, v93
  v_max3_u32 v61, v61, v94, v95
  v_max3_u32 v61, v61, v96, v97
  v_max3_u32 v61, v61, v98, v99
  v_max3_u32 v61, v61, v100, v101
  v_max3_u32 v61, v61, v102, v103
  s_mul_i32 s22, s16, 10240
  v_add_u32 v62, s22, v2
  ds_write_b128 v62, v[64:67] offset:0
  ds_write_b128 v62, v[68:71] offset:1024
  ds_write_b128 v62, v[72:75] offset:2048
  ds_write_b128 v62, v[76:79] offset:3072
  ds_write_b128 v62, v[80:83] offset:4096
  ds_write_b128 v62, v[84:87] offset:5120
  ds_write_b128 v62, v[88:91] offset:6144
  ds_write_b128 v62, v[92:95] offset:7168
  ds_write_b128 v62, v[96:99] offset:8192
  ds_write_b128 v62, v[100:103] offset:9216
  s_waitcnt vmcnt(0)
  v_max3_u32 v61, v61, v28, v29
  v_max3_u32 v61, v61, v30, v31
  v_max3_u32 v61, v61, v32, v33
  v_max3_u32 v61, v61, v34, v35
  v_max3_u32 v61, v61, v36, v37
  v_max3_u32 v61, v61, v38, v39
  v_max3_u32 v61, v61, v40, v41
  v_max3_u32 v61, v61, v42, v43
  v_max3_u32 v61, v61, v44, v45
  v_max3_u32 v61, v61, v46, v47
  v_max3_u32 v61, v61, v48, v49
  v_max3_u32 v61, v61, v50, v51
  v_max3_u32 v61, v61, v52, v53
  v_max3_u32 v61, v61, v54, v55
  v_max3_u32 v61, v61, v56, v57
  v_max3_u32 v61, v61, v58, v59
  v_cmp_eq_u32 vcc, -1, v61
  s_cbranch_vccz wo_pk
  s_waitcnt lgkmcnt(0)
  s_sleep 1
  s_add_u32 s30, s30, 1
  s_cmp_lt_u32 s30, 2000000
  s_cbranch_scc1 wo_pl
  s_branch wo_abort
wo_pk:
  s_lshl_b32 s22, s16, 2
  s_add_u32 s22, s22, 49152
  v_mov_b32 v63, s22
  ds_write_b32 v63, v250
  s_waitcnt lgkmcnt(0)
  s_barrier
  v_mov_b32 v63, 49152
  ds_read_b32 v250, v63
  ds_read_b128 v[64:67], v2 offset:0
  ds_read_b128 v[68:71], v2 offset:5120
  ds_read_b128 v[72:75], v2 offset:1024
  ds_read_b128 v[76:79], v2 offset:6144
  ds_read_b128 v[80:83], v2 offset:2048
  ds_read_b128 v[84:87], v2 offset:7168
  ds_read_b128 v[88:91], v2 offset:3072
  ds_read_b128 v[92:95], v2 offset:8192
  s_waitcnt lgkmcnt(7)
  v_mfma_f32_16x16x32_bf16 v[12:15], a[0:3], v[64:67], 0
  ds_read_b128 v[96:99], v2 offset:4096
  v_mfma_f32_16x16x32_bf16 v[20:23], a[4:7], v[64:67], 0
  s_waitcnt lgkmcnt(7)
  v_mfma_f32_16x16x32_bf16 v[16:19], a[0:3], v[68:71], 0
  ds_read_b128 v[100:103], v2 offset:9216
  v_mfma_f32_16x16x32_bf16 v[24:27], a[4:7], v[68:71], 0
  s_waitcnt lgkmcnt(7)
  v_mfma_f32_16x16x32_bf16 v[12:15], a[8:11], v[72:75], v[12:15]
  ds_read_b128 v[64:67], v2 offset:10240
  v_mfma_f32_16x16x32_bf16 v[20:23], a[12:15], v[72:75], v[20:23]
  s_waitcnt lgkmcnt(7)
  v_mfma_f32_16x16x32_bf16 v[16:19], a[8:11], v[76:79], v[16:19]
  ds_read_b128 v[68:71], v2 offset:15360
  v_mfma_f32_16x16x32_bf16 v[24:27], a[12:15], v[76:79], v[24:27]
  s_waitcnt lgkmcnt(7)
  v_mfma_f32_16x16x32_bf16 v[12:15], a[16:19], v[80:83], v[12:15]
  ds_read_b128 v[72:75], v2 offset:11264
  v_mfma_f32_16x16x32_bf16 v[20:23], a[20:23], v[80:83], v[20:23]
  s_waitcnt lgkmcnt(7)
  v_mfma_f32_16x16x32_bf16 v[16:19], a[16:19], v[84:87], v[16:19]
  ds_read_b128 v[76:79], v2 offset:16384
  v_mfma_f32_16x16x32_bf16 v[24:27], a[20:23], v[84:87], v[24:27]
  s_waitcnt lgkmcnt(7)
  v_mfma_f32_16x16x32_bf16 v[12:15], a[24:27], v[88:91], v[12:15]
  ds_read_b128 v[80:83], v2 offset:12288
  v_mfma_f32_16x16x32_bf16 v[20:23], a[28:31], v[88:91], v[20:23]
  s_waitcnt lgkmcnt(7)
  v_mfma_f32_16x16x32_bf16 v[16:19], a[24:27], v[92:95], v[16:19]
  ds_read_b128 v[84:87], v2 offset:17408
  v_mfma_f32_16x16x32_bf16 v[24:27], a[28:31], v[92:95], v[24:27]
  s_waitcnt lgkmcnt(7)
  v_mfma_f32_16x16x32_bf16 v[12:15], v[28:31], v[96:99], v[12:15]
  ds_read_b128 v[88:91], v2 offset:13312
  v_mfma_f32_16x16x32_bf16 v[20:23], v[32:35], v[96:99], v[20:23]
  s_waitcnt lgkmcnt(7)
  v_mfma_f32_16x16x32_bf16 v[16:19], v[28:31], v[100:103], v[16:19]
  ds_read_b128 v[92:95], v2 offset:18432
  v_mfma_f32_16x16x32_bf16 v[24:27], v[32:35], v[100:103], v[24:27]
  s_waitcnt lgkmcnt(7)
  v_mfma_f32_16x16x32_bf16 v[12:15], a[32:35], v[64:67], v[12:15]
  ds_read_b128 v[96:99], v2 offset:14336
  v_mfma_f32_16x16x32_bf16 v[20:23], a[36:39], v[64:67], v[20:23]
  s_waitcnt lgkmcnt(7)
  v_mfma_f32_16x16x32_bf16 v[16:19], a[32:35], v[68:71], v[16:19]
  ds_read_b128 v[100:103], v2 offset:19456
  v_mfma_f32_16x16x32_bf16 v[24:27], a[36:39], v[68:71], v[24:27]
  s_waitcnt lgkmcnt(7)
  v_mfma_f32_16x16x32_bf16 v[12:15], a[40:43], v[72:75], v[12:15]
  ds_read_b128 v[64:67], v2 offset:20480
  v_mfma_f32_16x16x32_bf16 v[20:23], a[44:47], v[72:75], v[20:23]
  s_waitcnt lgkmcnt(7)
  v_mfma_f32_16x16x32_bf16 v[16:19], a[40:43], v[76:79], v[16:19]
  ds_read_b128 v[68:71], v2 offset:25600
  v_mfma_f32_16x16x32_bf16 v[24:27], a[44:47], v[76:79], v[24:27]
  s_waitcnt lgkmcnt(7)
  v_mfma_f32_16x16x32_bf16 v[12:15], a[48:51], v[80:83], v[12:15]
  ds_read_b128 v[72:75], v2 offset:21504
  v_mfma_f32_16x16x32_bf16 v[20:23], a[52:55], v[80:83], v[20:23]
  s_waitcnt lgkmcnt(7)
  v_mfma_f32_16x16x32_bf16 v[16:19], a[48:51], v[84:87], v[16:19]
  ds_read_b128 v[76:79], v2 offset:26624
  v_mfma_f32_16x16x32_bf16 v[24:27], a[52:55], v[84:87], v[24:27]
  s_waitcnt lgkmcnt(7)
  v_mfma_f32_16x16x32_bf16 v[12:15], a[56:59], v[88:91], v[12:15]
  ds_read_b128 v[80:83], v2 offset:22528
  v_mfma_f32_16x16x32_bf16 v[20:23], a[60:63], v[88:91], v[20:23]
  s_waitcnt lgkmcnt(7)
  v_mfma_f32_16x16x32_bf16 v[16:19], a[56:59], v[92:95], v[16:19]
  ds_read_b128 v[84:87], v2 offset:27648
  v_mfma_f32_16x16x32_bf16 v[24:27], a[60:63], v[92:95], v[24:27]
  s_waitcnt lgkmcnt(7)
  v_mfma_f32_16x16x32_bf16 v[12:15], v[36:39], v[96:99], v[12:15]
  ds_read_b128 v[88:91], v2 offset:23552
  v_mfma_f32_16x16x32_bf16 v[20:23], v[40:43], v[96:99], v[20:23]
  s_waitcnt lgkmcnt(7)
  v_mfma_f32_16x16x32_bf16 v[16:19], v[36:39], v[100:103], v[16:19]
  ds_read_b128 v[92:95], v2 offset:28672
  v_mfma_f32_16x16x32_bf16 v[24:27], v[40:43], v[100:103], v[24:27]
  s_waitcnt lgkmcnt(7)
  v_mfma_f32_16x16x32_bf16 v[12:15], a[64:67], v[64:67], v[12:15]
  ds_read_b128 v[96:99], v2 offset:24576
  v_mfma_f32_16x16x32_bf16 v[20:23], a[68:71], v[64:67], v[20:23]
  s_waitcnt lgkmcnt(7)
  v_mfma_f32_16x16x32_bf16 v[16:19], a[64:67], v[68:71], v[16:19]
  ds_read_b128 v[100:103], v2 offset:29696
  v_mfma_f32_16x16x32_bf16 v[24:27], a[68:71], v[68:71], v[24:27]
  s_waitcnt lgkmcnt(7)
  v_mfma_f32_16x16x32_bf16 v[12:15], a[72:75], v[72:75], v[12:15]
  ds_read_b128 v[64:67], v2 offset:30720
  v_mfma_f32_16x16x32_bf16 v[20:23], a[76:79], v[72:75], v[20:23]
  s_waitcnt lgkmcnt(7)
  v_mfma_f32_16x16x32_bf16 v[16:19], a[72:75], v[76:79], v[16:19]
  ds_read_b128 v[68:71], v2 offset:35840
  v_mfma_f32_16x16x32_bf16 v[24:27], a[76:79], v[76:79], v[24:27]
  s_waitcnt lgkmcnt(7)
  v_mfma_f32_16x16x32_bf16 v[12:15], a[80:83], v[80:83], v[12:15]
  ds_read_b128 v[72:75], v2 offset:31744
  v_mfma_f32_16x16x32_bf16 v[20:23], a[84:87], v[80:83], v[20:23]
  s_waitcnt lgkmcnt(7)
  v_mfma_f32_16x16x32_bf16 v[16:19], a[80:83], v[84:87], v[16:19]
  ds_read_b128 v[76:79], v2 offset:36864
  v_mfma_f32_16x16x32_bf16 v[24:27], a[84:87], v[84:87], v[24:27]
  s_waitcnt lgkmcnt(7)
  v_mfma_f32_16x16x32_bf16 v[12:15], a[88:91], v[88:91], v[12:15]
  ds_read_b128 v[80:83], v2 offset:32768
  v_mfma_f32_16x16x32_bf16 v[20:23], a[92:95], v[88:91], v[20:23]
  s_waitcnt lgkmcnt(7)
  v_mfma_f32_16x16x32_bf16 v[16:19], a[88:91], v[92:95], v[16:19]
  ds_read_b128 v[84:87], v2 offset:37888
  v_mfma_f32_16x16x32_bf16 v[24:27], a[92:95], v[92:95], v[24:27]
  s_waitcnt lgkmcnt(7)
  v_mfma_f32_16x16x32_bf16 v[12:15], v[44:47], v[96:99], v[12:15]
  ds_read_b128 v[88:91], v2 offset:33792
  v_mfma_f32_16x16x32_bf16 v[20:23], v[48:51], v[96:99], v[20:23]
  s_waitcnt lgkmcnt(7)
  v_mfma_f32_16x16x32_bf16 v[16:19], v[44:47], v[100:103], v[16:19]
  ds_read_b128 v[92:95], v2 offset:38912
  v_mfma_f32_16x16x32_bf16 v[24:27], v[48:51], v[100:103], v[24:27]
  s_waitcnt lgkmcnt(7)
  v_mfma_f32_16x16x32_bf16 v[12:15], a[96:99], v[64:67], v[12:15]
  ds_read_b128 v[96:99], v2 offset:34816
  v_mfma_f32_16x16x32_bf16 v[20:23], a[100:103], v[64:67], v[20:23]
  s_waitcnt lgkmcnt(7)
  v_mfma_f32_16x16x32_bf16 v[16:19], a[96:99], v[68:71], v[16:19]
  ds_read_b128 v[100:103], v2 offset:39936
  v_mfma_f32_16x16x32_bf16 v[24:27], a[100:103], v[68:71], v[24:27]
  s_waitcnt lgkmcnt(7)
  v_mfma_f32_16x16x32_bf16 v[12:15], a[104:107], v[72:75], v[12:15]
  v_mfma_f32_16x16x32_bf16 v[20:23], a[108:111], v[72:75], v[20:23]
  s_waitcnt lgkmcnt(6)
  v_mfma_f32_16x16x32_bf16 v[16:19], a[104:107], v[76:79], v[16:19]
  v_mfma_f32_16x16x32_bf16 v[24:27], a[108:111], v[76:79], v[24:27]
  s_waitcnt lgkmcnt(5)
  v_mfma_f32_16x16x32_bf16 v[12:15], a[112:115], v[80:83], v[12:15]
  v_mfma_f32_16x16x32_bf16 v[20:23], a[116:119], v[80:83], v[20:23]
  s_waitcnt lgkmcnt(4)
  v_mfma_f32_16x16x32_bf16 v[16:19], a[112:115], v[84:87], v[16:19]
  v_mfma_f32_16x16x32_bf16 v[24:27], a[116:119], v[84:87], v[24:27]
  s_waitcnt lgkmcnt(3)
  v_mfma_f32_16x16x32_bf16 v[12:15], a[120:123], v[88:91], v[12:15]
  v_mfma_f32_16x16x32_bf16 v[20:23], a[124:127], v[88:91], v[20:23]
  s_waitcnt lgkmcnt(2)
  v_mfma_f32_16x16x32_bf16 v[16:19], a[120:123], v[92:95], v[16:19]
  v_mfma_f32_16x16x32_bf16 v[24:27], a[124:127], v[92:95], v[24:27]
  s_waitcnt lgkmcnt(1)
  v_mfma_f32_16x16x32_bf16 v[12:15], v[52:55], v[96:99], v[12:15]
  v_mfma_f32_16x16x32_bf16 v[20:23], v[56:59], v[96:99], v[20:23]
  s_waitcnt lgkmcnt(0)
  v_mfma_f32_16x16x32_bf16 v[16:19], v[52:55], v[100:103], v[16:19]
  v_mfma_f32_16x16x32_bf16 v[24:27], v[56:59], v[100:103], v[24:27]
  v_cvt_pk_bf16_f32 v108, v12, v13
  v_cvt_pk_bf16_f32 v109, v14, v15
  buffer_store_dwordx2 v[108:109], v8, s[92:95], s44 offen
  v_cvt_pk_bf16_f32 v110, v20, v21
  v_cvt_pk_bf16_f32 v111, v22, v23
  buffer_store_dwordx2 v[110:111], v9, s[92:95], s44 offen
  v_cvt_pk_bf16_f32 v112, v16, v17
  v_cvt_pk_bf16_f32 v113, v18, v19
  buffer_store_dwordx2 v[112:113], v8, s[92:95], s45 offen
  v_cvt_pk_bf16_f32 v114, v24, v25
  v_cvt_pk_bf16_f32 v115, v26, v27
  buffer_store_dwordx2 v[114:115], v9, s[92:95], s45 offen
  v_readfirstlane_b32 s22, v250
  s_cmp_ge_u32 s22, 1264
  s_cbranch_scc1 wk_done
  s_branch wk_loop
wp_abort:
wo_abort:
  s_branch cA_abort
wk_done:
ch_end:
  s_endpgm

.section .rodata,"a"
.p2align 6
.amdhsa_kernel main_kernel
  .amdhsa_next_free_vgpr 512
  .amdhsa_next_free_sgpr 102
  .amdhsa_accum_offset 256
  .amdhsa_group_segment_fixed_size 0
  .amdhsa_kernarg_size 136
  .amdhsa_user_sgpr_count 2
  .amdhsa_user_sgpr_kernarg_segment_ptr 1
  .amdhsa_system_sgpr_workgroup_id_x 1
.end_amdhsa_kernel
```

```asm
; @launch kernel=main_kernel grid=(256,1,1) block=(256,1,1) lds=163840
.amdgcn_target "amdgcn-amd-amdhsa--gfx950"
.text
.globl main_kernel
.p2align 8
.type main_kernel,@function
main_kernel:
  s_cmp_ge_u32 s2, 256
  s_cbranch_scc1 ch_end
  s_load_dwordx2 s[4:5], s[0:1], 120
  s_load_dwordx2 s[6:7], s[0:1], 128
  s_load_dwordx8 s[40:47], s[0:1], 72
  s_load_dwordx4 s[48:51], s[0:1], 56
  s_mov_b32 s32, 0
  s_getreg_b32 s3, hwreg(HW_REG_XCC_ID)
  s_and_b32 s3, s3, 15
  s_cmp_lg_u32 s3, 3
  s_cbranch_scc1 ch_pf
  s_cmp_lt_u32 s2, 224
  s_cbranch_scc1 ch_npf
ch_pf:
  s_getpc_b64 s[98:99]
pf_main_kernel_1:
  s_sub_u32 s98, s98, pf_main_kernel_1-main_kernel
  s_subb_u32 s99, s99, 0
  v_lshlrev_b32 v60, 7, v0
  v_min_u32 v61, ch_end-main_kernel-4, v60
  global_load_dword v62, v61, s[98:99]
  v_add_u32 v60, 32768, v60
  v_min_u32 v61, ch_end-main_kernel-4, v60
  global_load_dword v62, v61, s[98:99]
  v_add_u32 v60, 32768, v60
  v_min_u32 v61, ch_end-main_kernel-4, v60
  global_load_dword v62, v61, s[98:99]
  v_add_u32 v60, 32768, v60
  v_min_u32 v61, ch_end-main_kernel-4, v60
  global_load_dword v62, v61, s[98:99]
  v_add_u32 v60, 32768, v60
  v_min_u32 v61, ch_end-main_kernel-4, v60
  global_load_dword v62, v61, s[98:99]
  v_add_u32 v60, 32768, v60
ch_npf:
  v_lshrrev_b32 v1, 6, v0
  s_nop 0
  v_readfirstlane_b32 s16, v1
  s_waitcnt lgkmcnt(0)
  s_mov_b32 s8, s6
  s_and_b32 s9, s7, 0xffff
  s_mov_b32 s10, 0x10000000
  s_mov_b32 s11, 0x20000
  s_mov_b32 s12, s4
  s_and_b32 s13, s5, 0xffff
  s_mov_b32 s14, 256
  s_mov_b32 s15, 0x20000
  v_mov_b32 v252, 0x40000000
  v_cmp_eq_u32 vcc, 0, v0
  s_nop 1
  v_cndmask_b32 v252, v252, v0, vcc
  s_cmp_lg_u32 s3, 3
  s_cbranch_scc1 ch_worker
  s_mov_b32 s18, 0
  v_mov_b32 v249, 1
  s_mov_b64 exec, 1
  buffer_atomic_add v249, v252, s[12:15], 0 offen sc0
  s_mov_b64 exec, -1
  v_and_b32 v1, 63, v0
  v_lshlrev_b32 v2, 4, v1
  v_lshrrev_b32 v3, 4, v1
  v_and_b32 v4, 15, v1
  s_lshr_b32 s33, s2, 3
  s_lshl_b32 s27, s33, 2
  s_add_u32 s27, s27, s16
  s_lshl_b32 s27, s27, 13
  v_lshlrev_b32 v12, 7, v1
  s_mov_b32 s64, s42
  s_and_b32 s65, s43, 0xffff
  s_mov_b32 s66, 2097152
  s_mov_b32 s67, 0x20000
  s_mov_b32 s28, s27
  buffer_load_dword v13, v12, s[64:67], s28 offen
  s_add_u32 s28, s28, 1048576
  buffer_load_dword v13, v12, s[64:67], s28 offen
  s_add_u32 s28, s28, 1048576
  s_waitcnt vmcnt(2)
  v_readfirstlane_b32 s17, v249
  v_mov_b32 v6, 160032
  s_nop 0
  v_mov_b32 v7, s17
  s_barrier
  s_cmp_lg_u32 s16, 0
  s_cbranch_scc1 uni_2
  ds_write_b32 v6, v7
  s_waitcnt lgkmcnt(0)
uni_2:
  s_barrier
  ds_read_b32 v7, v6
  s_waitcnt lgkmcnt(0)
  v_readfirstlane_b32 s17, v7
  s_branch ch_got
ch_take:
  v_mov_b32 v5, 0
  v_mov_b32 v6, 160000
  s_barrier
  s_cmp_lg_u32 s16, 0
  s_cbranch_scc1 ch_el1
  s_mov_b64 exec, 1
  buffer_atomic_add v4, v5, s[12:15], 0 offen sc0
  s_waitcnt vmcnt(0)
  ds_write_b32 v6, v4
  s_waitcnt lgkmcnt(0)
  s_mov_b64 exec, -1
ch_el1:
  s_barrier
  ds_read_b32 v4, v6
  s_waitcnt lgkmcnt(0)
  v_readfirstlane_b32 s17, v4
ch_got:
  s_and_b32 s17, s17, 0xffff
  s_cmp_lt_u32 s17, 32
  s_cbranch_scc1 ch_role
  s_cmp_eq_u32 s18, 0
  s_cbranch_scc1 ch_worker
  v_and_b32 v1, 63, v0
  v_lshlrev_b32 v2, 4, v1
  v_lshrrev_b32 v3, 4, v1
  v_and_b32 v4, 15, v1
  s_branch wp_all
ch_role:
  v_and_b32 v1, 63, v0
  v_lshlrev_b32 v2, 4, v1
  v_lshrrev_b32 v3, 4, v1
  v_and_b32 v4, 15, v1
  s_cmp_lt_u32 s17, 16
  s_cbranch_scc1 ch_self
  s_cmp_lt_u32 s17, 24
  s_cbranch_scc1 ch_tch
  s_sub_u32 s33, s17, 24
  v_mov_b32 v10, 0x40000000
  v_mov_b32 v5, 1
  v_mov_b32 v148, 0
  v_mov_b32 v149, 0
  v_mov_b32 v150, 0
  v_mov_b32 v151, 0
  v_mov_b32 v152, -1
  v_mov_b32 v153, -1
  v_mov_b32 v154, -1
  v_mov_b32 v155, -1
  v_lshlrev_b32 v8, 4, v0
  s_mov_b32 s64, s48
  s_and_b32 s65, s49, 0xffff
  s_mov_b32 s66, 1835008
  s_mov_b32 s67, 0x20000
  s_lshl_b32 s21, s33, 2
  s_add_u32 s21, s21, s16
  s_lshr_b32 s22, s21, 1
  s_mul_i32 s22, s22, 14336
  s_and_b32 s24, s21, 1
  s_mul_i32 s24, s24, 448
  s_add_u32 s22, s22, s24
  s_mul_i32 s21, s21, 7168
  v_mul_u32_u24 v7, 896, v4
  v_lshl_add_u32 v7, v3, 4, v7
  buffer_load_dwordx4 v[64:67], v7, s[64:67], s22 offen offset:0
  buffer_load_dwordx4 v[68:71], v7, s[64:67], s22 offen offset:64
  buffer_load_dwordx4 v[72:75], v7, s[64:67], s22 offen offset:128
  buffer_load_dwordx4 v[76:79], v7, s[64:67], s22 offen offset:192
  buffer_load_dwordx4 v[80:83], v7, s[64:67], s22 offen offset:256
  buffer_load_dwordx4 v[84:87], v7, s[64:67], s22 offen offset:320
  buffer_load_dwordx4 v[88:91], v7, s[64:67], s22 offen offset:384
  s_mov_b32 s68, s50
  s_and_b32 s69, s51, 0xffff
  s_mov_b32 s70, 7168
  s_mov_b32 s71, 0x20000
  v_lshrrev_b32 v6, 3, v0
  v_min_u32 v6, 27, v6
  v_and_b32 v7, 7, v0
  v_mul_u32_u24 v9, 896, v7
  v_lshl_add_u32 v9, v6, 5, v9
  buffer_load_dwordx4 v[176:179], v9, s[68:71], 0 offen
  buffer_load_dwordx4 v[180:183], v9, s[68:71], 0 offen offset:16
  s_cmp_lg_u32 s33, 0
  s_cbranch_scc1 ch_ij_1
  s_mov_b32 s23, 582144
  buffer_store_dwordx4 v[148:151], v8, s[8:11], s23 offen sc1
  s_mov_b32 s23, 586240
  buffer_store_dwordx4 v[148:151], v8, s[8:11], s23 offen sc1
  s_waitcnt vmcnt(0)
  s_barrier
  buffer_store_dword v5, v252, s[12:15], 0 offen offset:128 sc1
ch_ij_1:
  s_waitcnt vmcnt(1)
  s_add_u32 s23, s21, 655360
  buffer_store_dwordx4 v[64:67], v2, s[8:11], s23 offen offset:0 sc1
  buffer_store_dwordx4 v[68:71], v2, s[8:11], s23 offen offset:1024 sc1
  buffer_store_dwordx4 v[72:75], v2, s[8:11], s23 offen offset:2048 sc1
  buffer_store_dwordx4 v[76:79], v2, s[8:11], s23 offen offset:3072 sc1
  s_add_u32 s23, s21, 659456
  buffer_store_dwordx4 v[80:83], v2, s[8:11], s23 offen offset:0 sc1
  buffer_store_dwordx4 v[84:87], v2, s[8:11], s23 offen offset:1024 sc1
  buffer_store_dwordx4 v[88:91], v2, s[8:11], s23 offen offset:2048 sc1
  s_waitcnt vmcnt(0)
  s_barrier
  s_cmp_lg_u32 s16, 0
  s_cbranch_scc1 ch_ij_x_e
  v_mov_b32 v6, 1
  s_mov_b64 exec, 1
  buffer_atomic_add v6, v252, s[12:15], 0 offen offset:4 sc0
  s_waitcnt vmcnt(0)
  v_readfirstlane_b32 s20, v6
  s_cmp_lg_u32 s20, 7
  s_cbranch_scc1 ch_ij_x_e0
  s_mov_b64 exec, 0xff
  v_lshlrev_b32 v6, 7, v0
  s_mov_b32 s20, 586240
  buffer_store_dword v5, v6, s[8:11], s20 offen offset:8 sc1
ch_ij_x_e0:
  s_mov_b64 exec, -1
ch_ij_x_e:
  s_lshl_b32 s20, s33, 12
  v_add_u32 v8, s20, v8
  s_mov_b32 s23, 524288
ch_ijlp_3:
  buffer_store_dwordx4 v[148:151], v8, s[8:11], s23 offen sc1
  s_add_u32 s23, s23, 32768
  s_cmp_lt_u32 s23, 557056
  s_cbranch_scc1 ch_ijlp_3
  v_cmp_gt_u32 vcc, 25088, v8
  s_nop 1
  v_cndmask_b32 v9, v10, v8, vcc
  buffer_store_dwordx4 v[148:151], v9, s[8:11], s23 offen sc1
  s_mov_b32 s23, 35328
  v_cmp_gt_u32 vcc, 6144, v8
  s_nop 1
  v_cndmask_b32 v9, v10, v8, vcc
  buffer_store_dwordx4 v[148:151], v9, s[8:11], s23 offen sc1
  s_mov_b32 s23, 7168
  v_cmp_gt_u32 vcc, 28160, v8
  s_nop 1
  v_cndmask_b32 v9, v10, v8, vcc
  buffer_store_dwordx4 v[152:155], v9, s[8:11], s23 offen sc1
  s_mov_b32 s23, 72704
ch_ijlp_4:
  buffer_store_dwordx4 v[152:155], v8, s[8:11], s23 offen sc1
  s_add_u32 s23, s23, 32768
  s_cmp_lt_u32 s23, 498688
  s_cbranch_scc1 ch_ijlp_4
  v_cmp_gt_u32 vcc, 25600, v8
  s_nop 1
  v_cndmask_b32 v9, v10, v8, vcc
  buffer_store_dwordx4 v[152:155], v9, s[8:11], s23 offen sc1
  s_cmp_lg_u32 s33, 1
  s_cbranch_scc1 ch_ij_nm
  v_lshrrev_b32 v6, 3, v0
  v_and_b32 v7, 7, v0
  v_lshlrev_b32 v8, 8, v6
  v_lshl_add_u32 v8, v7, 4, v8
  v_cmp_gt_u32 vcc, 28, v6
  s_nop 1
  v_cndmask_b32 v8, v10, v8, vcc
  s_waitcnt vmcnt(4)
  v_min_u32 v184, -2, v176
  v_min_u32 v188, -2, v177
  v_min_u32 v185, -2, v178
  v_min_u32 v189, -2, v179
  v_min_u32 v186, -2, v180
  v_min_u32 v190, -2, v181
  v_min_u32 v187, -2, v182
  v_min_u32 v191, -2, v183
  s_mov_b32 s23, 0
  buffer_store_dwordx4 v[184:187], v8, s[8:11], s23 offen sc1
  buffer_store_dwordx4 v[188:191], v8, s[8:11], s23 offen offset:128 sc1
  s_mov_b32 s23, 65536
  buffer_store_dwordx4 v[184:187], v8, s[8:11], s23 offen sc1
  buffer_store_dwordx4 v[188:191], v8, s[8:11], s23 offen offset:128 sc1
ch_ij_nm:
  s_waitcnt vmcnt(0)
  s_barrier
  s_cmp_lg_u32 s16, 0
  s_cbranch_scc1 ch_ij_e
  v_mov_b32 v6, 1
  s_mov_b64 exec, 1
  buffer_atomic_add v6, v252, s[12:15], 0 offen offset:12 sc0
  s_waitcnt vmcnt(0)
  v_readfirstlane_b32 s20, v6
  s_cmp_lg_u32 s20, 7
  s_cbranch_scc1 ch_ij_e0
  buffer_store_dword v5, v252, s[12:15], 0 offen offset:132 sc1
  s_mov_b64 exec, 0xff
  v_lshlrev_b32 v6, 7, v0
  s_mov_b32 s20, 586240
  buffer_store_dword v5, v6, s[8:11], s20 offen offset:4 sc1
ch_ij_e0:
  s_mov_b64 exec, -1
ch_ij_e:
  s_branch ch_role2
ch_tch:
  s_sub_u32 s33, s17, 16
  s_lshl_b32 s27, s33, 2
  s_add_u32 s27, s27, s16
  s_lshl_b32 s27, s27, 13
  v_lshlrev_b32 v12, 7, v1
  s_mov_b32 s64, s40
  s_and_b32 s65, s41, 0xffff
  s_mov_b32 s66, 2097152
  s_mov_b32 s67, 0x20000
  s_mov_b32 s28, s27
  buffer_load_dword v13, v12, s[64:67], s28 offen
  s_add_u32 s28, s28, 262144
  buffer_load_dword v13, v12, s[64:67], s28 offen
  s_add_u32 s28, s28, 262144
  buffer_load_dword v13, v12, s[64:67], s28 offen
  s_add_u32 s28, s28, 262144
  buffer_load_dword v13, v12, s[64:67], s28 offen
  s_add_u32 s28, s28, 262144
  buffer_load_dword v13, v12, s[64:67], s28 offen
  s_add_u32 s28, s28, 262144
  buffer_load_dword v13, v12, s[64:67], s28 offen
  s_add_u32 s28, s28, 262144
  buffer_load_dword v13, v12, s[64:67], s28 offen
  s_add_u32 s28, s28, 262144
  buffer_load_dword v13, v12, s[64:67], s28 offen
  s_add_u32 s28, s28, 262144
  s_branch ch_role2
ch_self:
  v_lshrrev_b32 v5, 5, v1
  v_and_b32 v6, 31, v1
  v_xor_b32 v8, v6, v5
  v_lshlrev_b32 v8, 4, v8
  v_lshl_add_u32 v16, v5, 13, v8
  v_xor_b32 v17, 32, v16
  v_xor_b32 v18, 64, v16
  v_xor_b32 v19, 96, v16
  v_xor_b32 v20, 128, v16
  v_xor_b32 v21, 160, v16
  v_xor_b32 v22, 192, v16
  v_xor_b32 v23, 224, v16
  s_lshl_b32 s20, s16, 6
  v_xor_b32 v26, s20, v16
  v_xor_b32 v27, 32, v26
  s_mov_b32 s60, s40
  s_and_b32 s61, s41, 0xffff
  s_mov_b32 s62, 3670016
  s_mov_b32 s63, 0x20000
  s_mov_b32 s56, s42
  s_and_b32 s57, s43, 0xffff
  s_mov_b32 s58, 3670016
  s_mov_b32 s59, 0x20000
  s_lshl_b32 s26, s17, 9
  s_lshl_b32 s27, s16, 19
  s_add_u32 s27, s27, s26
  s_lshl_b32 s25, s16, 15
  s_add_u32 s25, s25, 32768
  s_barrier
  s_add_u32 m0, s25, 0
  s_nop 0
  buffer_load_dwordx4 v16, s[56:59], s27 offen lds
  s_add_u32 s27, s27, 16384
  s_add_u32 m0, s25, 1024
  s_nop 0
  buffer_load_dwordx4 v16, s[56:59], s27 offen lds
  s_add_u32 s27, s27, 16384
  s_add_u32 m0, s25, 2048
  s_nop 0
  buffer_load_dwordx4 v17, s[56:59], s27 offen lds
  s_add_u32 s27, s27, 16384
  s_add_u32 m0, s25, 3072
  s_nop 0
  buffer_load_dwordx4 v17, s[56:59], s27 offen lds
  s_add_u32 s27, s27, 16384
  s_add_u32 m0, s25, 4096
  s_nop 0
  buffer_load_dwordx4 v16, s[56:59], s27 offen lds
  s_add_u32 s27, s27, 16384
  s_add_u32 m0, s25, 5120
  s_nop 0
  buffer_load_dwordx4 v16, s[56:59], s27 offen lds
  s_add_u32 s27, s27, 16384
  s_add_u32 m0, s25, 6144
  s_nop 0
  buffer_load_dwordx4 v17, s[56:59], s27 offen lds
  s_add_u32 s27, s27, 16384
  s_add_u32 m0, s25, 7168
  s_nop 0
  buffer_load_dwordx4 v17, s[56:59], s27 offen lds
  s_add_u32 s27, s27, 16384
  s_add_u32 m0, s25, 8192
  s_nop 0
  buffer_load_dwordx4 v18, s[56:59], s27 offen lds
  s_add_u32 s27, s27, 16384
  s_add_u32 m0, s25, 9216
  s_nop 0
  buffer_load_dwordx4 v18, s[56:59], s27 offen lds
  s_add_u32 s27, s27, 16384
  s_add_u32 m0, s25, 10240
  s_nop 0
  buffer_load_dwordx4 v19, s[56:59], s27 offen lds
  s_add_u32 s27, s27, 16384
  s_add_u32 m0, s25, 11264
  s_nop 0
  buffer_load_dwordx4 v19, s[56:59], s27 offen lds
  s_add_u32 s27, s27, 16384
  s_add_u32 m0, s25, 12288
  s_nop 0
  buffer_load_dwordx4 v18, s[56:59], s27 offen lds
  s_add_u32 s27, s27, 16384
  s_add_u32 m0, s25, 13312
  s_nop 0
  buffer_load_dwordx4 v18, s[56:59], s27 offen lds
  s_add_u32 s27, s27, 16384
  s_add_u32 m0, s25, 14336
  s_nop 0
  buffer_load_dwordx4 v19, s[56:59], s27 offen lds
  s_add_u32 s27, s27, 16384
  s_add_u32 m0, s25, 15360
  s_nop 0
  buffer_load_dwordx4 v19, s[56:59], s27 offen lds
  s_add_u32 s27, s27, 16384
  s_add_u32 m0, s25, 16384
  s_nop 0
  buffer_load_dwordx4 v20, s[56:59], s27 offen lds
  s_add_u32 s27, s27, 16384
  s_add_u32 m0, s25, 17408
  s_nop 0
  buffer_load_dwordx4 v20, s[56:59], s27 offen lds
  s_add_u32 s27, s27, 16384
  s_add_u32 m0, s25, 18432
  s_nop 0
  buffer_load_dwordx4 v21, s[56:59], s27 offen lds
  s_add_u32 s27, s27, 16384
  s_add_u32 m0, s25, 19456
  s_nop 0
  buffer_load_dwordx4 v21, s[56:59], s27 offen lds
  s_add_u32 s27, s27, 16384
  s_add_u32 m0, s25, 20480
  s_nop 0
  buffer_load_dwordx4 v20, s[56:59], s27 offen lds
  s_add_u32 s27, s27, 16384
  s_add_u32 m0, s25, 21504
  s_nop 0
  buffer_load_dwordx4 v20, s[56:59], s27 offen lds
  s_add_u32 s27, s27, 16384
  s_add_u32 m0, s25, 22528
  s_nop 0
  buffer_load_dwordx4 v21, s[56:59], s27 offen lds
  s_add_u32 s27, s27, 16384
  s_add_u32 m0, s25, 23552
  s_nop 0
  buffer_load_dwordx4 v21, s[56:59], s27 offen lds
  s_add_u32 s27, s27, 16384
  s_add_u32 m0, s25, 24576
  s_nop 0
  buffer_load_dwordx4 v22, s[56:59], s27 offen lds
  s_add_u32 s27, s27, 16384
  s_add_u32 m0, s25, 25600
  s_nop 0
  buffer_load_dwordx4 v22, s[56:59], s27 offen lds
  s_add_u32 s27, s27, 16384
  s_add_u32 m0, s25, 26624
  s_nop 0
  buffer_load_dwordx4 v23, s[56:59], s27 offen lds
  s_add_u32 s27, s27, 16384
  s_add_u32 m0, s25, 27648
  s_nop 0
  buffer_load_dwordx4 v23, s[56:59], s27 offen lds
  s_add_u32 s27, s27, 16384
  s_add_u32 m0, s25, 28672
  s_nop 0
  buffer_load_dwordx4 v22, s[56:59], s27 offen lds
  s_add_u32 s27, s27, 16384
  s_add_u32 m0, s25, 29696
  s_nop 0
  buffer_load_dwordx4 v22, s[56:59], s27 offen lds
  s_add_u32 s27, s27, 16384
  s_add_u32 m0, s25, 30720
  s_nop 0
  buffer_load_dwordx4 v23, s[56:59], s27 offen lds
  s_add_u32 s27, s27, 16384
  s_add_u32 m0, s25, 31744
  s_nop 0
  buffer_load_dwordx4 v23, s[56:59], s27 offen lds
  s_add_u32 s27, s27, 16384
  v_mov_b32 v14, v26
  v_mov_b32 v15, v27
  s_lshl_b32 s28, s16, 16
  s_add_u32 s28, s28, s26
  s_lshl_b32 s29, s16, 12
  s_add_u32 m0, s29, 0
  s_add_u32 s27, s28, 0
  buffer_load_dwordx4 v14, s[60:63], s27 offen lds
  s_add_u32 m0, s29, 1024
  s_add_u32 s27, s28, 16384
  buffer_load_dwordx4 v15, s[60:63], s27 offen lds
  s_add_u32 m0, s29, 2048
  s_add_u32 s27, s28, 32768
  buffer_load_dwordx4 v14, s[60:63], s27 offen lds
  s_add_u32 m0, s29, 3072
  s_add_u32 s27, s28, 49152
  buffer_load_dwordx4 v15, s[60:63], s27 offen lds
  s_add_u32 m0, s29, 16384
  s_add_u32 s27, s28, 262144
  buffer_load_dwordx4 v14, s[60:63], s27 offen lds
  s_add_u32 m0, s29, 17408
  s_add_u32 s27, s28, 278528
  buffer_load_dwordx4 v15, s[60:63], s27 offen lds
  s_add_u32 m0, s29, 18432
  s_add_u32 s27, s28, 294912
  buffer_load_dwordx4 v14, s[60:63], s27 offen lds
  s_add_u32 m0, s29, 19456
  s_add_u32 s27, s28, 311296
  buffer_load_dwordx4 v15, s[60:63], s27 offen lds
  v_lshrrev_b32 v7, 2, v4
  v_lshlrev_b32 v11, 4, v7
  v_lshlrev_b32 v7, 3, v7
  v_and_b32 v8, 3, v4
  v_add_u32 v7, v7, v8
  v_and_b32 v8, 2, v4
  v_lshl_add_u32 v11, v8, 1, v11
  v_and_b32 v8, 1, v4
  v_add_u32 v11, v11, v8
  v_or_b32 v10, 0, v3
  v_xor_b32 v10, v10, v4
  v_lshlrev_b32 v10, 4, v10
  v_lshl_add_u32 v248, v7, 9, v10
  v_add_u32 v252, 65536, v248
  v_add_u32 v16, 131072, v248
  v_lshl_add_u32 v10, v11, 9, v10
  v_add_u32 v20, s25, v10
  v_or_b32 v10, 4, v3
  v_xor_b32 v10, v10, v4
  v_lshlrev_b32 v10, 4, v10
  v_lshl_add_u32 v249, v7, 9, v10
  v_add_u32 v253, 65536, v249
  v_add_u32 v17, 131072, v249
  v_lshl_add_u32 v10, v11, 9, v10
  v_add_u32 v21, s25, v10
  v_or_b32 v10, 8, v3
  v_xor_b32 v10, v10, v4
  v_lshlrev_b32 v10, 4, v10
  v_lshl_add_u32 v250, v7, 9, v10
  v_add_u32 v254, 65536, v250
  v_add_u32 v18, 131072, v250
  v_lshl_add_u32 v10, v11, 9, v10
  v_add_u32 v22, s25, v10
  v_or_b32 v10, 12, v3
  v_xor_b32 v10, v10, v4
  v_lshlrev_b32 v10, 4, v10
  v_lshl_add_u32 v251, v7, 9, v10
  v_add_u32 v255, 65536, v251
  v_add_u32 v19, 131072, v251
  v_lshl_add_u32 v10, v11, 9, v10
  v_add_u32 v23, s25, v10
  v_mov_b32 v12, 1035512379
  v_lshlrev_b32 v6, 7, v1
  s_getpc_b64 s[98:99]
  global_load_dword v7, v6, s[98:99]
  s_waitcnt vmcnt(9)
  ds_read_b128 v[120:123], v20 offset:0
  ds_read_b128 v[124:127], v21 offset:0
  ds_read_b128 v[128:131], v22 offset:0
  ds_read_b128 v[132:135], v23 offset:0
  ds_read_b128 v[136:139], v20 offset:256
  ds_read_b128 v[140:143], v21 offset:256
  ds_read_b128 v[144:147], v22 offset:256
  ds_read_b128 v[148:151], v23 offset:256
  s_waitcnt lgkmcnt(8)
  ds_read_b128 v[152:155], v20 offset:1024
  ds_read_b128 v[156:159], v21 offset:1024
  ds_read_b128 v[160:163], v22 offset:1024
  ds_read_b128 v[164:167], v23 offset:1024
  ds_read_b128 v[168:171], v20 offset:1280
  ds_read_b128 v[172:175], v21 offset:1280
  ds_read_b128 v[176:179], v22 offset:1280
  ds_read_b128 v[180:183], v23 offset:1280
  s_waitcnt lgkmcnt(8)
  ds_read_b128 v[184:187], v20 offset:4096
  ds_read_b128 v[188:191], v21 offset:4096
  ds_read_b128 v[192:195], v22 offset:4096
  ds_read_b128 v[196:199], v23 offset:4096
  ds_read_b128 v[200:203], v20 offset:4352
  ds_read_b128 v[204:207], v21 offset:4352
  ds_read_b128 v[208:211], v22 offset:4352
  ds_read_b128 v[212:215], v23 offset:4352
  s_waitcnt lgkmcnt(8)
  ds_read_b128 v[216:219], v20 offset:5120
  ds_read_b128 v[220:223], v21 offset:5120
  ds_read_b128 v[224:227], v22 offset:5120
  ds_read_b128 v[228:231], v23 offset:5120
  ds_read_b128 v[232:235], v20 offset:5376
  ds_read_b128 v[236:239], v21 offset:5376
  ds_read_b128 v[240:243], v22 offset:5376
  ds_read_b128 v[244:247], v23 offset:5376
  s_waitcnt lgkmcnt(8)
  s_waitcnt vmcnt(4) lgkmcnt(0)
  s_barrier
  s_add_u32 m0, s29, 32768
  s_add_u32 s27, s28, 524288
  buffer_load_dwordx4 v14, s[60:63], s27 offen lds
  s_add_u32 m0, s29, 33792
  s_add_u32 s27, s28, 540672
  buffer_load_dwordx4 v15, s[60:63], s27 offen lds
  s_add_u32 m0, s29, 34816
  s_add_u32 s27, s28, 557056
  buffer_load_dwordx4 v14, s[60:63], s27 offen lds
  s_add_u32 m0, s29, 35840
  s_add_u32 s27, s28, 573440
  buffer_load_dwordx4 v15, s[60:63], s27 offen lds
  s_add_u32 m0, s29, 49152
  s_add_u32 s27, s28, 786432
  buffer_load_dwordx4 v14, s[60:63], s27 offen lds
  s_add_u32 m0, s29, 50176
  s_add_u32 s27, s28, 802816
  buffer_load_dwordx4 v15, s[60:63], s27 offen lds
  s_add_u32 m0, s29, 51200
  s_add_u32 s27, s28, 819200
  buffer_load_dwordx4 v14, s[60:63], s27 offen lds
  s_add_u32 m0, s29, 52224
  s_add_u32 s27, s28, 835584
  buffer_load_dwordx4 v15, s[60:63], s27 offen lds
  s_add_u32 m0, s29, 65536
  s_add_u32 s27, s28, 1048576
  buffer_load_dwordx4 v14, s[60:63], s27 offen lds
  s_add_u32 m0, s29, 66560
  s_add_u32 s27, s28, 1064960
  buffer_load_dwordx4 v15, s[60:63], s27 offen lds
  s_add_u32 m0, s29, 67584
  s_add_u32 s27, s28, 1081344
  buffer_load_dwordx4 v14, s[60:63], s27 offen lds
  s_add_u32 m0, s29, 68608
  s_add_u32 s27, s28, 1097728
  buffer_load_dwordx4 v15, s[60:63], s27 offen lds
  s_add_u32 m0, s29, 81920
  s_add_u32 s27, s28, 1310720
  buffer_load_dwordx4 v14, s[60:63], s27 offen lds
  s_add_u32 m0, s29, 82944
  s_add_u32 s27, s28, 1327104
  buffer_load_dwordx4 v15, s[60:63], s27 offen lds
  s_add_u32 m0, s29, 83968
  s_add_u32 s27, s28, 1343488
  buffer_load_dwordx4 v14, s[60:63], s27 offen lds
  s_add_u32 m0, s29, 84992
  s_add_u32 s27, s28, 1359872
  buffer_load_dwordx4 v15, s[60:63], s27 offen lds
  ds_read_b128 v[24:27], v248 offset:0
  ds_read_b128 v[28:31], v248 offset:2048
  ds_read_b128 v[32:35], v249 offset:0
  ds_read_b128 v[36:39], v249 offset:2048
  ds_read_b128 v[40:43], v250 offset:0
  ds_read_b128 v[44:47], v250 offset:2048
  s_waitcnt lgkmcnt(5)
  s_getpc_b64 s[98:99]
  s_add_u32 s98, s98, 4096
  s_addc_u32 s99, s99, 0
  global_load_dword v7, v6, s[98:99]
  v_mfma_f32_16x16x32_bf16 v[56:59], v[24:27], v[120:123], 0
  ds_read_b128 v[48:51], v251 offset:0
  v_mfma_f32_16x16x32_bf16 v[64:67], v[24:27], v[152:155], 0
  v_mfma_f32_16x16x32_bf16 v[72:75], v[24:27], v[184:187], 0
  s_add_u32 m0, s29, 98304
  s_add_u32 s27, s28, 1572864
  buffer_load_dwordx4 v14, s[60:63], s27 offen lds
  v_mfma_f32_16x16x32_bf16 v[80:83], v[24:27], v[216:219], 0
  s_waitcnt lgkmcnt(5)
  v_mfma_f32_16x16x32_bf16 v[60:63], v[28:31], v[120:123], 0
  ds_read_b128 v[52:55], v251 offset:2048
  v_mfma_f32_16x16x32_bf16 v[68:71], v[28:31], v[152:155], 0
  v_mfma_f32_16x16x32_bf16 v[76:79], v[28:31], v[184:187], 0
  v_mfma_f32_16x16x32_bf16 v[84:87], v[28:31], v[216:219], 0
  s_waitcnt lgkmcnt(5)
  v_mfma_f32_16x16x32_bf16 v[56:59], v[32:35], v[124:127], v[56:59]
  ds_read_b128 v[24:27], v248 offset:256
  v_mfma_f32_16x16x32_bf16 v[64:67], v[32:35], v[156:159], v[64:67]
  v_mfma_f32_16x16x32_bf16 v[72:75], v[32:35], v[188:191], v[72:75]
  s_add_u32 m0, s29, 99328
  s_add_u32 s27, s28, 1589248
  buffer_load_dwordx4 v15, s[60:63], s27 offen lds
  v_mfma_f32_16x16x32_bf16 v[80:83], v[32:35], v[220:223], v[80:83]
  s_waitcnt lgkmcnt(5)
  v_mfma_f32_16x16x32_bf16 v[60:63], v[36:39], v[124:127], v[60:63]
  ds_read_b128 v[28:31], v248 offset:2304
  v_mfma_f32_16x16x32_bf16 v[68:71], v[36:39], v[156:159], v[68:71]
  v_mfma_f32_16x16x32_bf16 v[76:79], v[36:39], v[188:191], v[76:79]
  v_mfma_f32_16x16x32_bf16 v[84:87], v[36:39], v[220:223], v[84:87]
  s_waitcnt lgkmcnt(5)
  v_mfma_f32_16x16x32_bf16 v[56:59], v[40:43], v[128:131], v[56:59]
  ds_read_b128 v[32:35], v249 offset:256
  v_mfma_f32_16x16x32_bf16 v[64:67], v[40:43], v[160:163], v[64:67]
  v_mfma_f32_16x16x32_bf16 v[72:75], v[40:43], v[192:195], v[72:75]
  s_add_u32 m0, s29, 100352
  s_add_u32 s27, s28, 1605632
  buffer_load_dwordx4 v14, s[60:63], s27 offen lds
  v_mfma_f32_16x16x32_bf16 v[80:83], v[40:43], v[224:227], v[80:83]
  s_waitcnt lgkmcnt(5)
  v_mfma_f32_16x16x32_bf16 v[60:63], v[44:47], v[128:131], v[60:63]
  ds_read_b128 v[36:39], v249 offset:2304
  v_mfma_f32_16x16x32_bf16 v[68:71], v[44:47], v[160:163], v[68:71]
  v_mfma_f32_16x16x32_bf16 v[76:79], v[44:47], v[192:195], v[76:79]
  v_mfma_f32_16x16x32_bf16 v[84:87], v[44:47], v[224:227], v[84:87]
  s_waitcnt lgkmcnt(5)
  v_mfma_f32_16x16x32_bf16 v[56:59], v[48:51], v[132:135], v[56:59]
  ds_read_b128 v[40:43], v250 offset:256
  v_mfma_f32_16x16x32_bf16 v[64:67], v[48:51], v[164:167], v[64:67]
  v_mfma_f32_16x16x32_bf16 v[72:75], v[48:51], v[196:199], v[72:75]
  s_add_u32 m0, s29, 101376
  s_add_u32 s27, s28, 1622016
  buffer_load_dwordx4 v15, s[60:63], s27 offen lds
  v_mfma_f32_16x16x32_bf16 v[80:83], v[48:51], v[228:231], v[80:83]
  s_waitcnt lgkmcnt(5)
  v_mfma_f32_16x16x32_bf16 v[60:63], v[52:55], v[132:135], v[60:63]
  ds_read_b128 v[44:47], v250 offset:2304
  v_mfma_f32_16x16x32_bf16 v[68:71], v[52:55], v[164:167], v[68:71]
  v_mfma_f32_16x16x32_bf16 v[76:79], v[52:55], v[196:199], v[76:79]
  v_mfma_f32_16x16x32_bf16 v[84:87], v[52:55], v[228:231], v[84:87]
  s_waitcnt lgkmcnt(5)
  v_mfma_f32_16x16x32_bf16 v[56:59], v[24:27], v[136:139], v[56:59]
  ds_read_b128 v[48:51], v251 offset:256
  v_mfma_f32_16x16x32_bf16 v[64:67], v[24:27], v[168:171], v[64:67]
  v_mfma_f32_16x16x32_bf16 v[72:75], v[24:27], v[200:203], v[72:75]
  v_mfma_f32_16x16x32_bf16 v[80:83], v[24:27], v[232:235], v[80:83]
  s_waitcnt lgkmcnt(5)
  v_mfma_f32_16x16x32_bf16 v[60:63], v[28:31], v[136:139], v[60:63]
  ds_read_b128 v[52:55], v251 offset:2304
  v_mfma_f32_16x16x32_bf16 v[68:71], v[28:31], v[168:171], v[68:71]
  v_mfma_f32_16x16x32_bf16 v[76:79], v[28:31], v[200:203], v[76:79]
  v_mfma_f32_16x16x32_bf16 v[84:87], v[28:31], v[232:235], v[84:87]
  s_waitcnt lgkmcnt(5)
  v_mfma_f32_16x16x32_bf16 v[56:59], v[32:35], v[140:143], v[56:59]
  s_waitcnt vmcnt(20)
  s_barrier
  ds_read_b128 v[24:27], v248 offset:16384
  v_mfma_f32_16x16x32_bf16 v[64:67], v[32:35], v[172:175], v[64:67]
  v_mfma_f32_16x16x32_bf16 v[72:75], v[32:35], v[204:207], v[72:75]
  v_mfma_f32_16x16x32_bf16 v[80:83], v[32:35], v[236:239], v[80:83]
  s_waitcnt lgkmcnt(5)
  v_mfma_f32_16x16x32_bf16 v[60:63], v[36:39], v[140:143], v[60:63]
  ds_read_b128 v[28:31], v248 offset:18432
  v_mfma_f32_16x16x32_bf16 v[68:71], v[36:39], v[172:175], v[68:71]
  v_mfma_f32_16x16x32_bf16 v[76:79], v[36:39], v[204:207], v[76:79]
  v_mfma_f32_16x16x32_bf16 v[84:87], v[36:39], v[236:239], v[84:87]
  s_waitcnt lgkmcnt(5)
  v_mfma_f32_16x16x32_bf16 v[56:59], v[40:43], v[144:147], v[56:59]
  ds_read_b128 v[32:35], v249 offset:16384
  v_mfma_f32_16x16x32_bf16 v[64:67], v[40:43], v[176:179], v[64:67]
  v_mfma_f32_16x16x32_bf16 v[72:75], v[40:43], v[208:211], v[72:75]
  v_mfma_f32_16x16x32_bf16 v[80:83], v[40:43], v[240:243], v[80:83]
  s_waitcnt lgkmcnt(5)
  v_mfma_f32_16x16x32_bf16 v[60:63], v[44:47], v[144:147], v[60:63]
  ds_read_b128 v[36:39], v249 offset:18432
  v_mfma_f32_16x16x32_bf16 v[68:71], v[44:47], v[176:179], v[68:71]
  v_mfma_f32_16x16x32_bf16 v[76:79], v[44:47], v[208:211], v[76:79]
  v_mfma_f32_16x16x32_bf16 v[84:87], v[44:47], v[240:243], v[84:87]
  s_waitcnt lgkmcnt(5)
  v_mfma_f32_16x16x32_bf16 v[56:59], v[48:51], v[148:151], v[56:59]
  ds_read_b128 v[40:43], v250 offset:16384
  v_mfma_f32_16x16x32_bf16 v[64:67], v[48:51], v[180:183], v[64:67]
  v_mfma_f32_16x16x32_bf16 v[72:75], v[48:51], v[212:215], v[72:75]
  v_mfma_f32_16x16x32_bf16 v[80:83], v[48:51], v[244:247], v[80:83]
  s_waitcnt lgkmcnt(5)
  v_mfma_f32_16x16x32_bf16 v[60:63], v[52:55], v[148:151], v[60:63]
  ds_read_b128 v[44:47], v250 offset:18432
  v_mfma_f32_16x16x32_bf16 v[68:71], v[52:55], v[180:183], v[68:71]
  v_mfma_f32_16x16x32_bf16 v[76:79], v[52:55], v[212:215], v[76:79]
  v_mfma_f32_16x16x32_bf16 v[84:87], v[52:55], v[244:247], v[84:87]
  s_waitcnt lgkmcnt(5)
  v_mfma_f32_16x16x32_bf16 v[88:91], v[24:27], v[120:123], 0
  ds_read_b128 v[48:51], v251 offset:16384
  v_mfma_f32_16x16x32_bf16 v[96:99], v[24:27], v[152:155], 0
  v_mfma_f32_16x16x32_bf16 v[104:107], v[24:27], v[184:187], 0
  s_add_u32 m0, s29, 114688
  s_add_u32 s27, s28, 1835008
  buffer_load_dwordx4 v14, s[60:63], s27 offen lds
  v_mfma_f32_16x16x32_bf16 v[112:115], v[24:27], v[216:219], 0
  s_waitcnt lgkmcnt(5)
  v_mul_f32 v56, v12, v56
  v_mfma_f32_16x16x32_bf16 v[92:95], v[28:31], v[120:123], 0
  ds_read_b128 v[52:55], v251 offset:18432
  v_mul_f32 v57, v12, v57
  v_mfma_f32_16x16x32_bf16 v[100:103], v[28:31], v[152:155], 0
  v_mul_f32 v58, v12, v58
  v_mul_f32 v59, v12, v59
  v_mfma_f32_16x16x32_bf16 v[108:111], v[28:31], v[184:187], 0
  v_mul_f32 v60, v12, v60
  v_mfma_f32_16x16x32_bf16 v[116:119], v[28:31], v[216:219], 0
  s_waitcnt lgkmcnt(5)
  v_mul_f32 v61, v12, v61
  v_mfma_f32_16x16x32_bf16 v[88:91], v[32:35], v[124:127], v[88:91]
  ds_read_b128 v[24:27], v248 offset:16640
  v_mul_f32 v62, v12, v62
  v_mfma_f32_16x16x32_bf16 v[96:99], v[32:35], v[156:159], v[96:99]
  v_mul_f32 v63, v12, v63
  v_cvt_pk_bf16_f32 v56, v56, v57
  v_mfma_f32_16x16x32_bf16 v[104:107], v[32:35], v[188:191], v[104:107]
  s_add_u32 m0, s29, 115712
  s_add_u32 s27, s28, 1851392
  buffer_load_dwordx4 v15, s[60:63], s27 offen lds
  v_mfma_f32_16x16x32_bf16 v[112:115], v[32:35], v[220:223], v[112:115]
  s_waitcnt lgkmcnt(5)
  v_cvt_pk_bf16_f32 v57, v58, v59
  v_mfma_f32_16x16x32_bf16 v[92:95], v[36:39], v[124:127], v[92:95]
  ds_read_b128 v[28:31], v248 offset:18688
  v_cvt_pk_bf16_f32 v58, v60, v61
  v_mfma_f32_16x16x32_bf16 v[100:103], v[36:39], v[156:159], v[100:103]
  v_cvt_pk_bf16_f32 v59, v62, v63
  v_accvgpr_write_b32 a0, v56
  v_mfma_f32_16x16x32_bf16 v[108:111], v[36:39], v[188:191], v[108:111]
  v_accvgpr_write_b32 a1, v57
  v_mfma_f32_16x16x32_bf16 v[116:119], v[36:39], v[220:223], v[116:119]
  s_waitcnt lgkmcnt(5)
  v_accvgpr_write_b32 a2, v58
  v_mfma_f32_16x16x32_bf16 v[88:91], v[40:43], v[128:131], v[88:91]
  ds_read_b128 v[32:35], v249 offset:16640
  v_accvgpr_write_b32 a3, v59
  v_mfma_f32_16x16x32_bf16 v[96:99], v[40:43], v[160:163], v[96:99]
  v_mul_f32 v64, v12, v64
  v_mul_f32 v65, v12, v65
  v_mfma_f32_16x16x32_bf16 v[104:107], v[40:43], v[192:195], v[104:107]
  s_add_u32 m0, s29, 116736
  s_add_u32 s27, s28, 1867776
  buffer_load_dwordx4 v14, s[60:63], s27 offen lds
  v_mfma_f32_16x16x32_bf16 v[112:115], v[40:43], v[224:227], v[112:115]
  s_waitcnt lgkmcnt(5)
  v_mul_f32 v66, v12, v66
  v_mfma_f32_16x16x32_bf16 v[92:95], v[44:47], v[128:131], v[92:95]
  ds_read_b128 v[36:39], v249 offset:18688
  v_mul_f32 v67, v12, v67
  v_mfma_f32_16x16x32_bf16 v[100:103], v[44:47], v[160:163], v[100:103]
  v_mul_f32 v68, v12, v68
  v_mul_f32 v69, v12, v69
  v_mfma_f32_16x16x32_bf16 v[108:111], v[44:47], v[192:195], v[108:111]
  v_mul_f32 v70, v12, v70
  v_mfma_f32_16x16x32_bf16 v[116:119], v[44:47], v[224:227], v[116:119]
  s_waitcnt lgkmcnt(5)
  v_mul_f32 v71, v12, v71
  v_mfma_f32_16x16x32_bf16 v[88:91], v[48:51], v[132:135], v[88:91]
  ds_read_b128 v[40:43], v250 offset:16640
  v_cvt_pk_bf16_f32 v64, v64, v65
  v_mfma_f32_16x16x32_bf16 v[96:99], v[48:51], v[164:167], v[96:99]
  v_cvt_pk_bf16_f32 v65, v66, v67
  v_cvt_pk_bf16_f32 v66, v68, v69
  v_mfma_f32_16x16x32_bf16 v[104:107], v[48:51], v[196:199], v[104:107]
  s_add_u32 m0, s29, 117760
  s_add_u32 s27, s28, 1884160
  buffer_load_dwordx4 v15, s[60:63], s27 offen lds
  v_mfma_f32_16x16x32_bf16 v[112:115], v[48:51], v[228:231], v[112:115]
  s_waitcnt lgkmcnt(5)
  v_cvt_pk_bf16_f32 v67, v70, v71
  v_mfma_f32_16x16x32_bf16 v[92:95], v[52:55], v[132:135], v[92:95]
  ds_read_b128 v[44:47], v250 offset:18688
  v_accvgpr_write_b32 a56, v64
  v_mfma_f32_16x16x32_bf16 v[100:103], v[52:55], v[164:167], v[100:103]
  v_accvgpr_write_b32 a57, v65
  v_accvgpr_write_b32 a58, v66
  v_mfma_f32_16x16x32_bf16 v[108:111], v[52:55], v[196:199], v[108:111]
  v_accvgpr_write_b32 a59, v67
  v_mfma_f32_16x16x32_bf16 v[116:119], v[52:55], v[228:231], v[116:119]
  s_waitcnt lgkmcnt(5)
  v_mul_f32 v72, v12, v72
  v_mfma_f32_16x16x32_bf16 v[88:91], v[24:27], v[136:139], v[88:91]
  ds_read_b128 v[48:51], v251 offset:16640
  v_mul_f32 v73, v12, v73
  v_mfma_f32_16x16x32_bf16 v[96:99], v[24:27], v[168:171], v[96:99]
  v_mul_f32 v74, v12, v74
  v_mul_f32 v75, v12, v75
  v_mfma_f32_16x16x32_bf16 v[104:107], v[24:27], v[200:203], v[104:107]
  v_mul_f32 v76, v12, v76
  v_mfma_f32_16x16x32_bf16 v[112:115], v[24:27], v[232:235], v[112:115]
  s_waitcnt lgkmcnt(5)
  v_mul_f32 v77, v12, v77
  v_mfma_f32_16x16x32_bf16 v[92:95], v[28:31], v[136:139], v[92:95]
  ds_read_b128 v[52:55], v251 offset:18688
  v_mul_f32 v78, v12, v78
  v_mfma_f32_16x16x32_bf16 v[100:103], v[28:31], v[168:171], v[100:103]
  v_mul_f32 v79, v12, v79
  v_cvt_pk_bf16_f32 v72, v72, v73
  v_mfma_f32_16x16x32_bf16 v[108:111], v[28:31], v[200:203], v[108:111]
  v_cvt_pk_bf16_f32 v73, v74, v75
  v_mfma_f32_16x16x32_bf16 v[116:119], v[28:31], v[232:235], v[116:119]
  s_waitcnt lgkmcnt(5)
  v_cvt_pk_bf16_f32 v74, v76, v77
  v_mfma_f32_16x16x32_bf16 v[88:91], v[32:35], v[140:143], v[88:91]
  s_waitcnt vmcnt(20)
  s_barrier
  ds_read_b128 v[24:27], v248 offset:32768
  v_cvt_pk_bf16_f32 v75, v78, v79
  v_mfma_f32_16x16x32_bf16 v[96:99], v[32:35], v[172:175], v[96:99]
  v_accvgpr_write_b32 a112, v72
  v_accvgpr_write_b32 a113, v73
  v_mfma_f32_16x16x32_bf16 v[104:107], v[32:35], v[204:207], v[104:107]
  v_accvgpr_write_b32 a114, v74
  v_mfma_f32_16x16x32_bf16 v[112:115], v[32:35], v[236:239], v[112:115]
  s_waitcnt lgkmcnt(5)
  v_accvgpr_write_b32 a115, v75
  v_mfma_f32_16x16x32_bf16 v[92:95], v[36:39], v[140:143], v[92:95]
  ds_read_b128 v[28:31], v248 offset:34816
  v_mul_f32 v80, v12, v80
  v_mfma_f32_16x16x32_bf16 v[100:103], v[36:39], v[172:175], v[100:103]
  v_mul_f32 v81, v12, v81
  v_mul_f32 v82, v12, v82
  v_mfma_f32_16x16x32_bf16 v[108:111], v[36:39], v[204:207], v[108:111]
  v_mul_f32 v83, v12, v83
  v_mfma_f32_16x16x32_bf16 v[116:119], v[36:39], v[236:239], v[116:119]
  s_waitcnt lgkmcnt(5)
  v_mul_f32 v84, v12, v84
  v_mfma_f32_16x16x32_bf16 v[88:91], v[40:43], v[144:147], v[88:91]
  ds_read_b128 v[32:35], v249 offset:32768
  v_mul_f32 v85, v12, v85
  v_mfma_f32_16x16x32_bf16 v[96:99], v[40:43], v[176:179], v[96:99]
  v_mul_f32 v86, v12, v86
  v_mul_f32 v87, v12, v87
  v_mfma_f32_16x16x32_bf16 v[104:107], v[40:43], v[208:211], v[104:107]
  v_cvt_pk_bf16_f32 v80, v80, v81
  v_mfma_f32_16x16x32_bf16 v[112:115], v[40:43], v[240:243], v[112:115]
  s_waitcnt lgkmcnt(5)
  v_cvt_pk_bf16_f32 v81, v82, v83
  v_mfma_f32_16x16x32_bf16 v[92:95], v[44:47], v[144:147], v[92:95]
  ds_read_b128 v[36:39], v249 offset:34816
  v_cvt_pk_bf16_f32 v82, v84, v85
  v_mfma_f32_16x16x32_bf16 v[100:103], v[44:47], v[176:179], v[100:103]
  v_cvt_pk_bf16_f32 v83, v86, v87
  v_accvgpr_write_b32 a168, v80
  v_mfma_f32_16x16x32_bf16 v[108:111], v[44:47], v[208:211], v[108:111]
  v_accvgpr_write_b32 a169, v81
  v_mfma_f32_16x16x32_bf16 v[116:119], v[44:47], v[240:243], v[116:119]
  s_waitcnt lgkmcnt(5)
  v_accvgpr_write_b32 a170, v82
  v_mfma_f32_16x16x32_bf16 v[88:91], v[48:51], v[148:151], v[88:91]
  ds_read_b128 v[40:43], v250 offset:32768
  v_accvgpr_write_b32 a171, v83
  v_mfma_f32_16x16x32_bf16 v[96:99], v[48:51], v[180:183], v[96:99]
  v_mfma_f32_16x16x32_bf16 v[104:107], v[48:51], v[212:215], v[104:107]
  v_mfma_f32_16x16x32_bf16 v[112:115], v[48:51], v[244:247], v[112:115]
  s_waitcnt lgkmcnt(5)
  v_mfma_f32_16x16x32_bf16 v[92:95], v[52:55], v[148:151], v[92:95]
  ds_read_b128 v[44:47], v250 offset:34816
  v_mfma_f32_16x16x32_bf16 v[100:103], v[52:55], v[180:183], v[100:103]
  v_mfma_f32_16x16x32_bf16 v[108:111], v[52:55], v[212:215], v[108:111]
  v_mfma_f32_16x16x32_bf16 v[116:119], v[52:55], v[244:247], v[116:119]
  s_waitcnt lgkmcnt(5)
  v_mfma_f32_16x16x32_bf16 v[56:59], v[24:27], v[120:123], 0
  ds_read_b128 v[48:51], v251 offset:32768
  v_mfma_f32_16x16x32_bf16 v[64:67], v[24:27], v[152:155], 0
  v_mfma_f32_16x16x32_bf16 v[72:75], v[24:27], v[184:187], 0
  s_add_u32 m0, s29, 131072
  s_add_u32 s27, s28, 2097152
  buffer_load_dwordx4 v14, s[60:63], s27 offen lds
  v_mfma_f32_16x16x32_bf16 v[80:83], v[24:27], v[216:219], 0
  s_waitcnt lgkmcnt(5)
  v_mul_f32 v88, v12, v88
  v_mfma_f32_16x16x32_bf16 v[60:63], v[28:31], v[120:123], 0
  ds_read_b128 v[52:55], v251 offset:34816
  v_mul_f32 v89, v12, v89
  v_mfma_f32_16x16x32_bf16 v[68:71], v[28:31], v[152:155], 0
  v_mul_f32 v90, v12, v90
  v_mul_f32 v91, v12, v91
  v_mfma_f32_16x16x32_bf16 v[76:79], v[28:31], v[184:187], 0
  v_mul_f32 v92, v12, v92
  v_mfma_f32_16x16x32_bf16 v[84:87], v[28:31], v[216:219], 0
  s_waitcnt lgkmcnt(5)
  v_mul_f32 v93, v12, v93
  v_mfma_f32_16x16x32_bf16 v[56:59], v[32:35], v[124:127], v[56:59]
  ds_read_b128 v[24:27], v248 offset:33024
  v_mul_f32 v94, v12, v94
  v_mfma_f32_16x16x32_bf16 v[64:67], v[32:35], v[156:159], v[64:67]
  v_mul_f32 v95, v12, v95
  v_cvt_pk_bf16_f32 v88, v88, v89
  v_mfma_f32_16x16x32_bf16 v[72:75], v[32:35], v[188:191], v[72:75]
  s_add_u32 m0, s29, 132096
  s_add_u32 s27, s28, 2113536
  buffer_load_dwordx4 v15, s[60:63], s27 offen lds
  v_mfma_f32_16x16x32_bf16 v[80:83], v[32:35], v[220:223], v[80:83]
  s_waitcnt lgkmcnt(5)
  v_cvt_pk_bf16_f32 v89, v90, v91
  v_mfma_f32_16x16x32_bf16 v[60:63], v[36:39], v[124:127], v[60:63]
  ds_read_b128 v[28:31], v248 offset:35072
  v_cvt_pk_bf16_f32 v90, v92, v93
  v_mfma_f32_16x16x32_bf16 v[68:71], v[36:39], v[156:159], v[68:71]
  v_cvt_pk_bf16_f32 v91, v94, v95
  v_accvgpr_write_b32 a4, v88
  v_mfma_f32_16x16x32_bf16 v[76:79], v[36:39], v[188:191], v[76:79]
  v_accvgpr_write_b32 a5, v89
  v_mfma_f32_16x16x32_bf16 v[84:87], v[36:39], v[220:223], v[84:87]
  s_waitcnt lgkmcnt(5)
  v_accvgpr_write_b32 a6, v90
  v_mfma_f32_16x16x32_bf16 v[56:59], v[40:43], v[128:131], v[56:59]
  ds_read_b128 v[32:35], v249 offset:33024
  v_accvgpr_write_b32 a7, v91
  v_mfma_f32_16x16x32_bf16 v[64:67], v[40:43], v[160:163], v[64:67]
  v_mul_f32 v96, v12, v96
  v_mul_f32 v97, v12, v97
  v_mfma_f32_16x16x32_bf16 v[72:75], v[40:43], v[192:195], v[72:75]
  s_add_u32 m0, s29, 133120
  s_add_u32 s27, s28, 2129920
  buffer_load_dwordx4 v14, s[60:63], s27 offen lds
  v_mfma_f32_16x16x32_bf16 v[80:83], v[40:43], v[224:227], v[80:83]
  s_waitcnt lgkmcnt(5)
  v_mul_f32 v98, v12, v98
  v_mfma_f32_16x16x32_bf16 v[60:63], v[44:47], v[128:131], v[60:63]
  ds_read_b128 v[36:39], v249 offset:35072
  v_mul_f32 v99, v12, v99
  v_mfma_f32_16x16x32_bf16 v[68:71], v[44:47], v[160:163], v[68:71]
  v_mul_f32 v100, v12, v100
  v_mul_f32 v101, v12, v101
  v_mfma_f32_16x16x32_bf16 v[76:79], v[44:47], v[192:195], v[76:79]
  v_mul_f32 v102, v12, v102
  v_mfma_f32_16x16x32_bf16 v[84:87], v[44:47], v[224:227], v[84:87]
  s_waitcnt lgkmcnt(5)
  v_mul_f32 v103, v12, v103
  v_mfma_f32_16x16x32_bf16 v[56:59], v[48:51], v[132:135], v[56:59]
  ds_read_b128 v[40:43], v250 offset:33024
  v_cvt_pk_bf16_f32 v96, v96, v97
  v_mfma_f32_16x16x32_bf16 v[64:67], v[48:51], v[164:167], v[64:67]
  v_cvt_pk_bf16_f32 v97, v98, v99
  v_cvt_pk_bf16_f32 v98, v100, v101
  v_mfma_f32_16x16x32_bf16 v[72:75], v[48:51], v[196:199], v[72:75]
  s_add_u32 m0, s29, 134144
  s_add_u32 s27, s28, 2146304
  buffer_load_dwordx4 v15, s[60:63], s27 offen lds
  v_mfma_f32_16x16x32_bf16 v[80:83], v[48:51], v[228:231], v[80:83]
  s_waitcnt lgkmcnt(5)
  v_cvt_pk_bf16_f32 v99, v102, v103
  v_mfma_f32_16x16x32_bf16 v[60:63], v[52:55], v[132:135], v[60:63]
  ds_read_b128 v[44:47], v250 offset:35072
  v_accvgpr_write_b32 a60, v96
  v_mfma_f32_16x16x32_bf16 v[68:71], v[52:55], v[164:167], v[68:71]
  v_accvgpr_write_b32 a61, v97
  v_accvgpr_write_b32 a62, v98
  v_mfma_f32_16x16x32_bf16 v[76:79], v[52:55], v[196:199], v[76:79]
  v_accvgpr_write_b32 a63, v99
  v_mfma_f32_16x16x32_bf16 v[84:87], v[52:55], v[228:231], v[84:87]
  s_waitcnt lgkmcnt(5)
  v_mul_f32 v104, v12, v104
  v_mfma_f32_16x16x32_bf16 v[56:59], v[24:27], v[136:139], v[56:59]
  ds_read_b128 v[48:51], v251 offset:33024
  v_mul_f32 v105, v12, v105
  v_mfma_f32_16x16x32_bf16 v[64:67], v[24:27], v[168:171], v[64:67]
  v_mul_f32 v106, v12, v106
  v_mul_f32 v107, v12, v107
  v_mfma_f32_16x16x32_bf16 v[72:75], v[24:27], v[200:203], v[72:75]
  v_mul_f32 v108, v12, v108
  v_mfma_f32_16x16x32_bf16 v[80:83], v[24:27], v[232:235], v[80:83]
  s_waitcnt lgkmcnt(5)
  v_mul_f32 v109, v12, v109
  v_mfma_f32_16x16x32_bf16 v[60:63], v[28:31], v[136:139], v[60:63]
  ds_read_b128 v[52:55], v251 offset:35072
  v_mul_f32 v110, v12, v110
  v_mfma_f32_16x16x32_bf16 v[68:71], v[28:31], v[168:171], v[68:71]
  v_mul_f32 v111, v12, v111
  v_cvt_pk_bf16_f32 v104, v104, v105
  v_mfma_f32_16x16x32_bf16 v[76:79], v[28:31], v[200:203], v[76:79]
  v_cvt_pk_bf16_f32 v105, v106, v107
  v_mfma_f32_16x16x32_bf16 v[84:87], v[28:31], v[232:235], v[84:87]
  s_waitcnt lgkmcnt(5)
  v_cvt_pk_bf16_f32 v106, v108, v109
  v_mfma_f32_16x16x32_bf16 v[56:59], v[32:35], v[140:143], v[56:59]
  s_waitcnt vmcnt(20)
  s_barrier
  ds_read_b128 v[24:27], v248 offset:49152
  v_cvt_pk_bf16_f32 v107, v110, v111
  v_mfma_f32_16x16x32_bf16 v[64:67], v[32:35], v[172:175], v[64:67]
  v_accvgpr_write_b32 a116, v104
  v_accvgpr_write_b32 a117, v105
  v_mfma_f32_16x16x32_bf16 v[72:75], v[32:35], v[204:207], v[72:75]
  v_accvgpr_write_b32 a118, v106
  v_mfma_f32_16x16x32_bf16 v[80:83], v[32:35], v[236:239], v[80:83]
  s_waitcnt lgkmcnt(5)
  v_accvgpr_write_b32 a119, v107
  v_mfma_f32_16x16x32_bf16 v[60:63], v[36:39], v[140:143], v[60:63]
  ds_read_b128 v[28:31], v248 offset:51200
  v_mul_f32 v112, v12, v112
  v_mfma_f32_16x16x32_bf16 v[68:71], v[36:39], v[172:175], v[68:71]
  v_mul_f32 v113, v12, v113
  v_mul_f32 v114, v12, v114
  v_mfma_f32_16x16x32_bf16 v[76:79], v[36:39], v[204:207], v[76:79]
  v_mul_f32 v115, v12, v115
  v_mfma_f32_16x16x32_bf16 v[84:87], v[36:39], v[236:239], v[84:87]
  s_waitcnt lgkmcnt(5)
  v_mul_f32 v116, v12, v116
  v_mfma_f32_16x16x32_bf16 v[56:59], v[40:43], v[144:147], v[56:59]
  ds_read_b128 v[32:35], v249 offset:49152
  v_mul_f32 v117, v12, v117
  v_mfma_f32_16x16x32_bf16 v[64:67], v[40:43], v[176:179], v[64:67]
  v_mul_f32 v118, v12, v118
  v_mul_f32 v119, v12, v119
  v_mfma_f32_16x16x32_bf16 v[72:75], v[40:43], v[208:211], v[72:75]
  v_cvt_pk_bf16_f32 v112, v112, v113
  v_mfma_f32_16x16x32_bf16 v[80:83], v[40:43], v[240:243], v[80:83]
  s_waitcnt lgkmcnt(5)
  v_cvt_pk_bf16_f32 v113, v114, v115
  v_mfma_f32_16x16x32_bf16 v[60:63], v[44:47], v[144:147], v[60:63]
  ds_read_b128 v[36:39], v249 offset:51200
  v_cvt_pk_bf16_f32 v114, v116, v117
  v_mfma_f32_16x16x32_bf16 v[68:71], v[44:47], v[176:179], v[68:71]
  v_cvt_pk_bf16_f32 v115, v118, v119
  v_accvgpr_write_b32 a172, v112
  v_mfma_f32_16x16x32_bf16 v[76:79], v[44:47], v[208:211], v[76:79]
  v_accvgpr_write_b32 a173, v113
  v_mfma_f32_16x16x32_bf16 v[84:87], v[44:47], v[240:243], v[84:87]
  s_waitcnt lgkmcnt(5)
  v_accvgpr_write_b32 a174, v114
  v_mfma_f32_16x16x32_bf16 v[56:59], v[48:51], v[148:151], v[56:59]
  ds_read_b128 v[40:43], v250 offset:49152
  v_accvgpr_write_b32 a175, v115
  v_mfma_f32_16x16x32_bf16 v[64:67], v[48:51], v[180:183], v[64:67]
  v_mfma_f32_16x16x32_bf16 v[72:75], v[48:51], v[212:215], v[72:75]
  v_mfma_f32_16x16x32_bf16 v[80:83], v[48:51], v[244:247], v[80:83]
  s_waitcnt lgkmcnt(5)
  v_mfma_f32_16x16x32_bf16 v[60:63], v[52:55], v[148:151], v[60:63]
  ds_read_b128 v[44:47], v250 offset:51200
  v_mfma_f32_16x16x32_bf16 v[68:71], v[52:55], v[180:183], v[68:71]
  v_mfma_f32_16x16x32_bf16 v[76:79], v[52:55], v[212:215], v[76:79]
  v_mfma_f32_16x16x32_bf16 v[84:87], v[52:55], v[244:247], v[84:87]
  s_waitcnt lgkmcnt(5)
  s_getpc_b64 s[98:99]
  s_add_u32 s98, s98, 4096
  s_addc_u32 s99, s99, 0
  global_load_dword v7, v6, s[98:99]
  v_mfma_f32_16x16x32_bf16 v[88:91], v[24:27], v[120:123], 0
  ds_read_b128 v[48:51], v251 offset:49152
  v_mfma_f32_16x16x32_bf16 v[96:99], v[24:27], v[152:155], 0
  v_mfma_f32_16x16x32_bf16 v[104:107], v[24:27], v[184:187], 0
  buffer_load_dword v13, off, s[12:15], 0 offset:128 sc1
  buffer_load_dword v9, off, s[12:15], 0 sc1
  s_add_u32 m0, s29, 147456
  s_add_u32 s27, s28, 2359296
  buffer_load_dwordx4 v14, s[60:63], s27 offen lds
  v_mfma_f32_16x16x32_bf16 v[112:115], v[24:27], v[216:219], 0
  s_waitcnt lgkmcnt(5)
  v_mul_f32 v56, v12, v56
  v_mfma_f32_16x16x32_bf16 v[92:95], v[28:31], v[120:123], 0
  ds_read_b128 v[52:55], v251 offset:51200
  v_mul_f32 v57, v12, v57
  v_mfma_f32_16x16x32_bf16 v[100:103], v[28:31], v[152:155], 0
  v_mul_f32 v58, v12, v58
  v_mul_f32 v59, v12, v59
  v_mfma_f32_16x16x32_bf16 v[108:111], v[28:31], v[184:187], 0
  v_mul_f32 v60, v12, v60
  v_mfma_f32_16x16x32_bf16 v[116:119], v[28:31], v[216:219], 0
  s_waitcnt lgkmcnt(5)
  v_mul_f32 v61, v12, v61
  v_mfma_f32_16x16x32_bf16 v[88:91], v[32:35], v[124:127], v[88:91]
  ds_read_b128 v[24:27], v248 offset:49408
  v_mul_f32 v62, v12, v62
  v_mfma_f32_16x16x32_bf16 v[96:99], v[32:35], v[156:159], v[96:99]
  v_mul_f32 v63, v12, v63
  v_cvt_pk_bf16_f32 v56, v56, v57
  v_mfma_f32_16x16x32_bf16 v[104:107], v[32:35], v[188:191], v[104:107]
  s_add_u32 m0, s29, 148480
  s_add_u32 s27, s28, 2375680
  buffer_load_dwordx4 v15, s[60:63], s27 offen lds
  v_mfma_f32_16x16x32_bf16 v[112:115], v[32:35], v[220:223], v[112:115]
  s_waitcnt lgkmcnt(5)
  v_cvt_pk_bf16_f32 v57, v58, v59
  v_mfma_f32_16x16x32_bf16 v[92:95], v[36:39], v[124:127], v[92:95]
  ds_read_b128 v[28:31], v248 offset:51456
  v_cvt_pk_bf16_f32 v58, v60, v61
  v_mfma_f32_16x16x32_bf16 v[100:103], v[36:39], v[156:159], v[100:103]
  v_cvt_pk_bf16_f32 v59, v62, v63
  v_accvgpr_write_b32 a8, v56
  v_mfma_f32_16x16x32_bf16 v[108:111], v[36:39], v[188:191], v[108:111]
  v_accvgpr_write_b32 a9, v57
  v_mfma_f32_16x16x32_bf16 v[116:119], v[36:39], v[220:223], v[116:119]
  s_waitcnt lgkmcnt(5)
  v_accvgpr_write_b32 a10, v58
  v_mfma_f32_16x16x32_bf16 v[88:91], v[40:43], v[128:131], v[88:91]
  ds_read_b128 v[32:35], v249 offset:49408
  v_accvgpr_write_b32 a11, v59
  v_mfma_f32_16x16x32_bf16 v[96:99], v[40:43], v[160:163], v[96:99]
  v_mul_f32 v64, v12, v64
  v_mul_f32 v65, v12, v65
  v_mfma_f32_16x16x32_bf16 v[104:107], v[40:43], v[192:195], v[104:107]
  s_add_u32 m0, s29, 149504
  s_add_u32 s27, s28, 2392064
  buffer_load_dwordx4 v14, s[60:63], s27 offen lds
  v_mfma_f32_16x16x32_bf16 v[112:115], v[40:43], v[224:227], v[112:115]
  s_waitcnt lgkmcnt(5)
  v_mul_f32 v66, v12, v66
  v_mfma_f32_16x16x32_bf16 v[92:95], v[44:47], v[128:131], v[92:95]
  ds_read_b128 v[36:39], v249 offset:51456
  v_mul_f32 v67, v12, v67
  v_mfma_f32_16x16x32_bf16 v[100:103], v[44:47], v[160:163], v[100:103]
  v_mul_f32 v68, v12, v68
  v_mul_f32 v69, v12, v69
  v_mfma_f32_16x16x32_bf16 v[108:111], v[44:47], v[192:195], v[108:111]
  v_mul_f32 v70, v12, v70
  v_mfma_f32_16x16x32_bf16 v[116:119], v[44:47], v[224:227], v[116:119]
  s_waitcnt lgkmcnt(5)
  v_mul_f32 v71, v12, v71
  v_mfma_f32_16x16x32_bf16 v[88:91], v[48:51], v[132:135], v[88:91]
  ds_read_b128 v[40:43], v250 offset:49408
  v_cvt_pk_bf16_f32 v64, v64, v65
  v_mfma_f32_16x16x32_bf16 v[96:99], v[48:51], v[164:167], v[96:99]
  v_cvt_pk_bf16_f32 v65, v66, v67
  v_cvt_pk_bf16_f32 v66, v68, v69
  v_mfma_f32_16x16x32_bf16 v[104:107], v[48:51], v[196:199], v[104:107]
  s_add_u32 m0, s29, 150528
  s_add_u32 s27, s28, 2408448
  buffer_load_dwordx4 v15, s[60:63], s27 offen lds
  v_mfma_f32_16x16x32_bf16 v[112:115], v[48:51], v[228:231], v[112:115]
  s_waitcnt lgkmcnt(5)
  v_cvt_pk_bf16_f32 v67, v70, v71
  v_mfma_f32_16x16x32_bf16 v[92:95], v[52:55], v[132:135], v[92:95]
  ds_read_b128 v[44:47], v250 offset:51456
  v_accvgpr_write_b32 a64, v64
  v_mfma_f32_16x16x32_bf16 v[100:103], v[52:55], v[164:167], v[100:103]
  v_accvgpr_write_b32 a65, v65
  v_accvgpr_write_b32 a66, v66
  v_mfma_f32_16x16x32_bf16 v[108:111], v[52:55], v[196:199], v[108:111]
  v_accvgpr_write_b32 a67, v67
  v_mfma_f32_16x16x32_bf16 v[116:119], v[52:55], v[228:231], v[116:119]
  s_waitcnt lgkmcnt(5)
  v_mul_f32 v72, v12, v72
  v_mfma_f32_16x16x32_bf16 v[88:91], v[24:27], v[136:139], v[88:91]
  ds_read_b128 v[48:51], v251 offset:49408
  v_mul_f32 v73, v12, v73
  v_mfma_f32_16x16x32_bf16 v[96:99], v[24:27], v[168:171], v[96:99]
  v_mul_f32 v74, v12, v74
  v_mul_f32 v75, v12, v75
  v_mfma_f32_16x16x32_bf16 v[104:107], v[24:27], v[200:203], v[104:107]
  v_mul_f32 v76, v12, v76
  v_mfma_f32_16x16x32_bf16 v[112:115], v[24:27], v[232:235], v[112:115]
  s_waitcnt lgkmcnt(5)
  v_mul_f32 v77, v12, v77
  v_mfma_f32_16x16x32_bf16 v[92:95], v[28:31], v[136:139], v[92:95]
  ds_read_b128 v[52:55], v251 offset:51456
  v_mul_f32 v78, v12, v78
  v_mfma_f32_16x16x32_bf16 v[100:103], v[28:31], v[168:171], v[100:103]
  v_mul_f32 v79, v12, v79
  v_cvt_pk_bf16_f32 v72, v72, v73
  v_mfma_f32_16x16x32_bf16 v[108:111], v[28:31], v[200:203], v[108:111]
  v_cvt_pk_bf16_f32 v73, v74, v75
  v_mfma_f32_16x16x32_bf16 v[116:119], v[28:31], v[232:235], v[116:119]
  s_waitcnt lgkmcnt(5)
  v_cvt_pk_bf16_f32 v74, v76, v77
  v_mfma_f32_16x16x32_bf16 v[88:91], v[32:35], v[140:143], v[88:91]
  s_waitcnt vmcnt(20)
  s_barrier
  ds_read_b128 v[24:27], v252 offset:0
  v_cvt_pk_bf16_f32 v75, v78, v79
  v_mfma_f32_16x16x32_bf16 v[96:99], v[32:35], v[172:175], v[96:99]
  v_accvgpr_write_b32 a120, v72
  v_accvgpr_write_b32 a121, v73
  v_mfma_f32_16x16x32_bf16 v[104:107], v[32:35], v[204:207], v[104:107]
  v_accvgpr_write_b32 a122, v74
  v_mfma_f32_16x16x32_bf16 v[112:115], v[32:35], v[236:239], v[112:115]
  s_waitcnt lgkmcnt(5)
  v_accvgpr_write_b32 a123, v75
  v_mfma_f32_16x16x32_bf16 v[92:95], v[36:39], v[140:143], v[92:95]
  ds_read_b128 v[28:31], v252 offset:2048
  v_mul_f32 v80, v12, v80
  v_mfma_f32_16x16x32_bf16 v[100:103], v[36:39], v[172:175], v[100:103]
  v_mul_f32 v81, v12, v81
  v_mul_f32 v82, v12, v82
  v_mfma_f32_16x16x32_bf16 v[108:111], v[36:39], v[204:207], v[108:111]
  v_mul_f32 v83, v12, v83
  v_mfma_f32_16x16x32_bf16 v[116:119], v[36:39], v[236:239], v[116:119]
  s_waitcnt lgkmcnt(5)
  v_mul_f32 v84, v12, v84
  v_mfma_f32_16x16x32_bf16 v[88:91], v[40:43], v[144:147], v[88:91]
  ds_read_b128 v[32:35], v253 offset:0
  v_mul_f32 v85, v12, v85
  v_mfma_f32_16x16x32_bf16 v[96:99], v[40:43], v[176:179], v[96:99]
  v_mul_f32 v86, v12, v86
  v_mul_f32 v87, v12, v87
  v_mfma_f32_16x16x32_bf16 v[104:107], v[40:43], v[208:211], v[104:107]
  v_cvt_pk_bf16_f32 v80, v80, v81
  v_mfma_f32_16x16x32_bf16 v[112:115], v[40:43], v[240:243], v[112:115]
  s_waitcnt lgkmcnt(5)
  v_cvt_pk_bf16_f32 v81, v82, v83
  v_mfma_f32_16x16x32_bf16 v[92:95], v[44:47], v[144:147], v[92:95]
  ds_read_b128 v[36:39], v253 offset:2048
  v_cvt_pk_bf16_f32 v82, v84, v85
  v_mfma_f32_16x16x32_bf16 v[100:103], v[44:47], v[176:179], v[100:103]
  v_cvt_pk_bf16_f32 v83, v86, v87
  v_accvgpr_write_b32 a176, v80
  v_mfma_f32_16x16x32_bf16 v[108:111], v[44:47], v[208:211], v[108:111]
  v_accvgpr_write_b32 a177, v81
  v_mfma_f32_16x16x32_bf16 v[116:119], v[44:47], v[240:243], v[116:119]
  s_waitcnt lgkmcnt(5)
  v_accvgpr_write_b32 a178, v82
  v_mfma_f32_16x16x32_bf16 v[88:91], v[48:51], v[148:151], v[88:91]
  ds_read_b128 v[40:43], v254 offset:0
  v_accvgpr_write_b32 a179, v83
  v_mfma_f32_16x16x32_bf16 v[96:99], v[48:51], v[180:183], v[96:99]
  v_mfma_f32_16x16x32_bf16 v[104:107], v[48:51], v[212:215], v[104:107]
  v_mfma_f32_16x16x32_bf16 v[112:115], v[48:51], v[244:247], v[112:115]
  s_waitcnt lgkmcnt(5)
  v_mfma_f32_16x16x32_bf16 v[92:95], v[52:55], v[148:151], v[92:95]
  ds_read_b128 v[44:47], v254 offset:2048
  v_mfma_f32_16x16x32_bf16 v[100:103], v[52:55], v[180:183], v[100:103]
  v_mfma_f32_16x16x32_bf16 v[108:111], v[52:55], v[212:215], v[108:111]
  v_mfma_f32_16x16x32_bf16 v[116:119], v[52:55], v[244:247], v[116:119]
  s_waitcnt lgkmcnt(5)
  v_mfma_f32_16x16x32_bf16 v[56:59], v[24:27], v[120:123], 0
  ds_read_b128 v[48:51], v255 offset:0
  v_mfma_f32_16x16x32_bf16 v[64:67], v[24:27], v[152:155], 0
  v_mfma_f32_16x16x32_bf16 v[72:75], v[24:27], v[184:187], 0
  s_add_u32 m0, s29, 0
  s_add_u32 s27, s28, 2621440
  buffer_load_dwordx4 v14, s[60:63], s27 offen lds
  v_mfma_f32_16x16x32_bf16 v[80:83], v[24:27], v[216:219], 0
  s_waitcnt lgkmcnt(5)
  v_mul_f32 v88, v12, v88
  v_mfma_f32_16x16x32_bf16 v[60:63], v[28:31], v[120:123], 0
  ds_read_b128 v[52:55], v255 offset:2048
  v_mul_f32 v89, v12, v89
  v_mfma_f32_16x16x32_bf16 v[68:71], v[28:31], v[152:155], 0
  v_mul_f32 v90, v12, v90
  v_mul_f32 v91, v12, v91
  v_mfma_f32_16x16x32_bf16 v[76:79], v[28:31], v[184:187], 0
  v_mul_f32 v92, v12, v92
  v_mfma_f32_16x16x32_bf16 v[84:87], v[28:31], v[216:219], 0
  s_waitcnt lgkmcnt(5)
  v_mul_f32 v93, v12, v93
  v_mfma_f32_16x16x32_bf16 v[56:59], v[32:35], v[124:127], v[56:59]
  ds_read_b128 v[24:27], v252 offset:256
  v_mul_f32 v94, v12, v94
  v_mfma_f32_16x16x32_bf16 v[64:67], v[32:35], v[156:159], v[64:67]
  v_mul_f32 v95, v12, v95
  v_cvt_pk_bf16_f32 v88, v88, v89
  v_mfma_f32_16x16x32_bf16 v[72:75], v[32:35], v[188:191], v[72:75]
  s_add_u32 m0, s29, 1024
  s_add_u32 s27, s28, 2637824
  buffer_load_dwordx4 v15, s[60:63], s27 offen lds
  v_mfma_f32_16x16x32_bf16 v[80:83], v[32:35], v[220:223], v[80:83]
  s_waitcnt lgkmcnt(5)
  v_cvt_pk_bf16_f32 v89, v90, v91
  v_mfma_f32_16x16x32_bf16 v[60:63], v[36:39], v[124:127], v[60:63]
  ds_read_b128 v[28:31], v252 offset:2304
  v_cvt_pk_bf16_f32 v90, v92, v93
  v_mfma_f32_16x16x32_bf16 v[68:71], v[36:39], v[156:159], v[68:71]
  v_cvt_pk_bf16_f32 v91, v94, v95
  v_accvgpr_write_b32 a12, v88
  v_mfma_f32_16x16x32_bf16 v[76:79], v[36:39], v[188:191], v[76:79]
  v_accvgpr_write_b32 a13, v89
  v_mfma_f32_16x16x32_bf16 v[84:87], v[36:39], v[220:223], v[84:87]
  s_waitcnt lgkmcnt(5)
  v_accvgpr_write_b32 a14, v90
  v_mfma_f32_16x16x32_bf16 v[56:59], v[40:43], v[128:131], v[56:59]
  ds_read_b128 v[32:35], v253 offset:256
  v_accvgpr_write_b32 a15, v91
  v_mfma_f32_16x16x32_bf16 v[64:67], v[40:43], v[160:163], v[64:67]
  v_mul_f32 v96, v12, v96
  v_mul_f32 v97, v12, v97
  v_mfma_f32_16x16x32_bf16 v[72:75], v[40:43], v[192:195], v[72:75]
  s_add_u32 m0, s29, 2048
  s_add_u32 s27, s28, 2654208
  buffer_load_dwordx4 v14, s[60:63], s27 offen lds
  v_mfma_f32_16x16x32_bf16 v[80:83], v[40:43], v[224:227], v[80:83]
  s_waitcnt lgkmcnt(5)
  v_mul_f32 v98, v12, v98
  v_mfma_f32_16x16x32_bf16 v[60:63], v[44:47], v[128:131], v[60:63]
  ds_read_b128 v[36:39], v253 offset:2304
  v_mul_f32 v99, v12, v99
  v_mfma_f32_16x16x32_bf16 v[68:71], v[44:47], v[160:163], v[68:71]
  v_mul_f32 v100, v12, v100
  v_mul_f32 v101, v12, v101
  v_mfma_f32_16x16x32_bf16 v[76:79], v[44:47], v[192:195], v[76:79]
  v_mul_f32 v102, v12, v102
  v_mfma_f32_16x16x32_bf16 v[84:87], v[44:47], v[224:227], v[84:87]
  s_waitcnt lgkmcnt(5)
  v_mul_f32 v103, v12, v103
  v_mfma_f32_16x16x32_bf16 v[56:59], v[48:51], v[132:135], v[56:59]
  ds_read_b128 v[40:43], v254 offset:256
  v_cvt_pk_bf16_f32 v96, v96, v97
  v_mfma_f32_16x16x32_bf16 v[64:67], v[48:51], v[164:167], v[64:67]
  v_cvt_pk_bf16_f32 v97, v98, v99
  v_cvt_pk_bf16_f32 v98, v100, v101
  v_mfma_f32_16x16x32_bf16 v[72:75], v[48:51], v[196:199], v[72:75]
  s_add_u32 m0, s29, 3072
  s_add_u32 s27, s28, 2670592
  buffer_load_dwordx4 v15, s[60:63], s27 offen lds
  v_mfma_f32_16x16x32_bf16 v[80:83], v[48:51], v[228:231], v[80:83]
  s_waitcnt lgkmcnt(5)
  v_cvt_pk_bf16_f32 v99, v102, v103
  v_mfma_f32_16x16x32_bf16 v[60:63], v[52:55], v[132:135], v[60:63]
  ds_read_b128 v[44:47], v254 offset:2304
  v_accvgpr_write_b32 a68, v96
  v_mfma_f32_16x16x32_bf16 v[68:71], v[52:55], v[164:167], v[68:71]
  v_accvgpr_write_b32 a69, v97
  v_accvgpr_write_b32 a70, v98
  v_mfma_f32_16x16x32_bf16 v[76:79], v[52:55], v[196:199], v[76:79]
  v_accvgpr_write_b32 a71, v99
  v_mfma_f32_16x16x32_bf16 v[84:87], v[52:55], v[228:231], v[84:87]
  s_waitcnt lgkmcnt(5)
  v_mul_f32 v104, v12, v104
  v_mfma_f32_16x16x32_bf16 v[56:59], v[24:27], v[136:139], v[56:59]
  ds_read_b128 v[48:51], v255 offset:256
  v_mul_f32 v105, v12, v105
  v_mfma_f32_16x16x32_bf16 v[64:67], v[24:27], v[168:171], v[64:67]
  v_mul_f32 v106, v12, v106
  v_mul_f32 v107, v12, v107
  v_mfma_f32_16x16x32_bf16 v[72:75], v[24:27], v[200:203], v[72:75]
  v_mul_f32 v108, v12, v108
  v_mfma_f32_16x16x32_bf16 v[80:83], v[24:27], v[232:235], v[80:83]
  s_waitcnt lgkmcnt(5)
  v_mul_f32 v109, v12, v109
  v_mfma_f32_16x16x32_bf16 v[60:63], v[28:31], v[136:139], v[60:63]
  ds_read_b128 v[52:55], v255 offset:2304
  v_mul_f32 v110, v12, v110
  v_mfma_f32_16x16x32_bf16 v[68:71], v[28:31], v[168:171], v[68:71]
  v_mul_f32 v111, v12, v111
  v_cvt_pk_bf16_f32 v104, v104, v105
  v_mfma_f32_16x16x32_bf16 v[76:79], v[28:31], v[200:203], v[76:79]
  v_cvt_pk_bf16_f32 v105, v106, v107
  v_mfma_f32_16x16x32_bf16 v[84:87], v[28:31], v[232:235], v[84:87]
  s_waitcnt lgkmcnt(5)
  v_cvt_pk_bf16_f32 v106, v108, v109
  v_mfma_f32_16x16x32_bf16 v[56:59], v[32:35], v[140:143], v[56:59]
  s_waitcnt vmcnt(20)
  s_barrier
  ds_read_b128 v[24:27], v252 offset:16384
  v_cvt_pk_bf16_f32 v107, v110, v111
  v_mfma_f32_16x16x32_bf16 v[64:67], v[32:35], v[172:175], v[64:67]
  v_accvgpr_write_b32 a124, v104
  v_accvgpr_write_b32 a125, v105
  v_mfma_f32_16x16x32_bf16 v[72:75], v[32:35], v[204:207], v[72:75]
  v_accvgpr_write_b32 a126, v106
  v_mfma_f32_16x16x32_bf16 v[80:83], v[32:35], v[236:239], v[80:83]
  s_waitcnt lgkmcnt(5)
  v_accvgpr_write_b32 a127, v107
  v_mfma_f32_16x16x32_bf16 v[60:63], v[36:39], v[140:143], v[60:63]
  ds_read_b128 v[28:31], v252 offset:18432
  v_mul_f32 v112, v12, v112
  v_mfma_f32_16x16x32_bf16 v[68:71], v[36:39], v[172:175], v[68:71]
  v_mul_f32 v113, v12, v113
  v_mul_f32 v114, v12, v114
  v_mfma_f32_16x16x32_bf16 v[76:79], v[36:39], v[204:207], v[76:79]
  v_mul_f32 v115, v12, v115
  v_mfma_f32_16x16x32_bf16 v[84:87], v[36:39], v[236:239], v[84:87]
  s_waitcnt lgkmcnt(5)
  v_mul_f32 v116, v12, v116
  v_mfma_f32_16x16x32_bf16 v[56:59], v[40:43], v[144:147], v[56:59]
  ds_read_b128 v[32:35], v253 offset:16384
  v_mul_f32 v117, v12, v117
  v_mfma_f32_16x16x32_bf16 v[64:67], v[40:43], v[176:179], v[64:67]
  v_mul_f32 v118, v12, v118
  v_mul_f32 v119, v12, v119
  v_mfma_f32_16x16x32_bf16 v[72:75], v[40:43], v[208:211], v[72:75]
  v_cvt_pk_bf16_f32 v112, v112, v113
  v_mfma_f32_16x16x32_bf16 v[80:83], v[40:43], v[240:243], v[80:83]
  s_waitcnt lgkmcnt(5)
  v_cvt_pk_bf16_f32 v113, v114, v115
  v_mfma_f32_16x16x32_bf16 v[60:63], v[44:47], v[144:147], v[60:63]
  ds_read_b128 v[36:39], v253 offset:18432
  v_cvt_pk_bf16_f32 v114, v116, v117
  v_mfma_f32_16x16x32_bf16 v[68:71], v[44:47], v[176:179], v[68:71]
  v_cvt_pk_bf16_f32 v115, v118, v119
  v_accvgpr_write_b32 a180, v112
  v_mfma_f32_16x16x32_bf16 v[76:79], v[44:47], v[208:211], v[76:79]
  v_accvgpr_write_b32 a181, v113
  v_mfma_f32_16x16x32_bf16 v[84:87], v[44:47], v[240:243], v[84:87]
  s_waitcnt lgkmcnt(5)
  v_accvgpr_write_b32 a182, v114
  v_mfma_f32_16x16x32_bf16 v[56:59], v[48:51], v[148:151], v[56:59]
  ds_read_b128 v[40:43], v254 offset:16384
  v_accvgpr_write_b32 a183, v115
  v_mfma_f32_16x16x32_bf16 v[64:67], v[48:51], v[180:183], v[64:67]
  v_mfma_f32_16x16x32_bf16 v[72:75], v[48:51], v[212:215], v[72:75]
  v_mfma_f32_16x16x32_bf16 v[80:83], v[48:51], v[244:247], v[80:83]
  s_waitcnt lgkmcnt(5)
  v_mfma_f32_16x16x32_bf16 v[60:63], v[52:55], v[148:151], v[60:63]
  ds_read_b128 v[44:47], v254 offset:18432
  v_mfma_f32_16x16x32_bf16 v[68:71], v[52:55], v[180:183], v[68:71]
  v_mfma_f32_16x16x32_bf16 v[76:79], v[52:55], v[212:215], v[76:79]
  v_mfma_f32_16x16x32_bf16 v[84:87], v[52:55], v[244:247], v[84:87]
  s_waitcnt lgkmcnt(5)
  v_mfma_f32_16x16x32_bf16 v[88:91], v[24:27], v[120:123], 0
  ds_read_b128 v[48:51], v255 offset:16384
  v_mfma_f32_16x16x32_bf16 v[96:99], v[24:27], v[152:155], 0
  v_mfma_f32_16x16x32_bf16 v[104:107], v[24:27], v[184:187], 0
  s_add_u32 m0, s29, 16384
  s_add_u32 s27, s28, 2883584
  buffer_load_dwordx4 v14, s[60:63], s27 offen lds
  v_mfma_f32_16x16x32_bf16 v[112:115], v[24:27], v[216:219], 0
  s_waitcnt lgkmcnt(5)
  v_mul_f32 v56, v12, v56
  v_mfma_f32_16x16x32_bf16 v[92:95], v[28:31], v[120:123], 0
  ds_read_b128 v[52:55], v255 offset:18432
  v_mul_f32 v57, v12, v57
  v_mfma_f32_16x16x32_bf16 v[100:103], v[28:31], v[152:155], 0
  v_mul_f32 v58, v12, v58
  v_mul_f32 v59, v12, v59
  v_mfma_f32_16x16x32_bf16 v[108:111], v[28:31], v[184:187], 0
  v_mul_f32 v60, v12, v60
  v_mfma_f32_16x16x32_bf16 v[116:119], v[28:31], v[216:219], 0
  s_waitcnt lgkmcnt(5)
  v_mul_f32 v61, v12, v61
  v_mfma_f32_16x16x32_bf16 v[88:91], v[32:35], v[124:127], v[88:91]
  ds_read_b128 v[24:27], v252 offset:16640
  v_mul_f32 v62, v12, v62
  v_mfma_f32_16x16x32_bf16 v[96:99], v[32:35], v[156:159], v[96:99]
  v_mul_f32 v63, v12, v63
  v_cvt_pk_bf16_f32 v56, v56, v57
  v_mfma_f32_16x16x32_bf16 v[104:107], v[32:35], v[188:191], v[104:107]
  s_add_u32 m0, s29, 17408
  s_add_u32 s27, s28, 2899968
  buffer_load_dwordx4 v15, s[60:63], s27 offen lds
  v_mfma_f32_16x16x32_bf16 v[112:115], v[32:35], v[220:223], v[112:115]
  s_waitcnt lgkmcnt(5)
  v_cvt_pk_bf16_f32 v57, v58, v59
  v_mfma_f32_16x16x32_bf16 v[92:95], v[36:39], v[124:127], v[92:95]
  ds_read_b128 v[28:31], v252 offset:18688
  v_cvt_pk_bf16_f32 v58, v60, v61
  v_mfma_f32_16x16x32_bf16 v[100:103], v[36:39], v[156:159], v[100:103]
  v_cvt_pk_bf16_f32 v59, v62, v63
  v_accvgpr_write_b32 a16, v56
  v_mfma_f32_16x16x32_bf16 v[108:111], v[36:39], v[188:191], v[108:111]
  v_accvgpr_write_b32 a17, v57
  v_mfma_f32_16x16x32_bf16 v[116:119], v[36:39], v[220:223], v[116:119]
  s_waitcnt lgkmcnt(5)
  v_accvgpr_write_b32 a18, v58
  v_mfma_f32_16x16x32_bf16 v[88:91], v[40:43], v[128:131], v[88:91]
  ds_read_b128 v[32:35], v253 offset:16640
  v_accvgpr_write_b32 a19, v59
  v_mfma_f32_16x16x32_bf16 v[96:99], v[40:43], v[160:163], v[96:99]
  v_mul_f32 v64, v12, v64
  v_mul_f32 v65, v12, v65
  v_mfma_f32_16x16x32_bf16 v[104:107], v[40:43], v[192:195], v[104:107]
  s_add_u32 m0, s29, 18432
  s_add_u32 s27, s28, 2916352
  buffer_load_dwordx4 v14, s[60:63], s27 offen lds
  v_mfma_f32_16x16x32_bf16 v[112:115], v[40:43], v[224:227], v[112:115]
  s_waitcnt lgkmcnt(5)
  v_mul_f32 v66, v12, v66
  v_mfma_f32_16x16x32_bf16 v[92:95], v[44:47], v[128:131], v[92:95]
  ds_read_b128 v[36:39], v253 offset:18688
  v_mul_f32 v67, v12, v67
  v_mfma_f32_16x16x32_bf16 v[100:103], v[44:47], v[160:163], v[100:103]
  v_mul_f32 v68, v12, v68
  v_mul_f32 v69, v12, v69
  v_mfma_f32_16x16x32_bf16 v[108:111], v[44:47], v[192:195], v[108:111]
  v_mul_f32 v70, v12, v70
  v_mfma_f32_16x16x32_bf16 v[116:119], v[44:47], v[224:227], v[116:119]
  s_waitcnt lgkmcnt(5)
  v_mul_f32 v71, v12, v71
  v_mfma_f32_16x16x32_bf16 v[88:91], v[48:51], v[132:135], v[88:91]
  ds_read_b128 v[40:43], v254 offset:16640
  v_cvt_pk_bf16_f32 v64, v64, v65
  v_mfma_f32_16x16x32_bf16 v[96:99], v[48:51], v[164:167], v[96:99]
  v_cvt_pk_bf16_f32 v65, v66, v67
  v_cvt_pk_bf16_f32 v66, v68, v69
  v_mfma_f32_16x16x32_bf16 v[104:107], v[48:51], v[196:199], v[104:107]
  s_add_u32 m0, s29, 19456
  s_add_u32 s27, s28, 2932736
  buffer_load_dwordx4 v15, s[60:63], s27 offen lds
  v_mfma_f32_16x16x32_bf16 v[112:115], v[48:51], v[228:231], v[112:115]
  s_waitcnt lgkmcnt(5)
  v_cvt_pk_bf16_f32 v67, v70, v71
  v_mfma_f32_16x16x32_bf16 v[92:95], v[52:55], v[132:135], v[92:95]
  ds_read_b128 v[44:47], v254 offset:18688
  v_accvgpr_write_b32 a72, v64
  v_mfma_f32_16x16x32_bf16 v[100:103], v[52:55], v[164:167], v[100:103]
  v_accvgpr_write_b32 a73, v65
  v_accvgpr_write_b32 a74, v66
  v_mfma_f32_16x16x32_bf16 v[108:111], v[52:55], v[196:199], v[108:111]
  v_accvgpr_write_b32 a75, v67
  v_mfma_f32_16x16x32_bf16 v[116:119], v[52:55], v[228:231], v[116:119]
  s_waitcnt lgkmcnt(5)
  v_mul_f32 v72, v12, v72
  v_mfma_f32_16x16x32_bf16 v[88:91], v[24:27], v[136:139], v[88:91]
  ds_read_b128 v[48:51], v255 offset:16640
  v_mul_f32 v73, v12, v73
  v_mfma_f32_16x16x32_bf16 v[96:99], v[24:27], v[168:171], v[96:99]
  v_mul_f32 v74, v12, v74
  v_mul_f32 v75, v12, v75
  v_mfma_f32_16x16x32_bf16 v[104:107], v[24:27], v[200:203], v[104:107]
  v_mul_f32 v76, v12, v76
  v_mfma_f32_16x16x32_bf16 v[112:115], v[24:27], v[232:235], v[112:115]
  s_waitcnt lgkmcnt(5)
  v_mul_f32 v77, v12, v77
  v_mfma_f32_16x16x32_bf16 v[92:95], v[28:31], v[136:139], v[92:95]
  ds_read_b128 v[52:55], v255 offset:18688
  v_mul_f32 v78, v12, v78
  v_mfma_f32_16x16x32_bf16 v[100:103], v[28:31], v[168:171], v[100:103]
  v_mul_f32 v79, v12, v79
  v_cvt_pk_bf16_f32 v72, v72, v73
  v_mfma_f32_16x16x32_bf16 v[108:111], v[28:31], v[200:203], v[108:111]
  v_cvt_pk_bf16_f32 v73, v74, v75
  v_mfma_f32_16x16x32_bf16 v[116:119], v[28:31], v[232:235], v[116:119]
  s_waitcnt lgkmcnt(5)
  v_cvt_pk_bf16_f32 v74, v76, v77
  v_mfma_f32_16x16x32_bf16 v[88:91], v[32:35], v[140:143], v[88:91]
  s_waitcnt vmcnt(20)
  s_barrier
  ds_read_b128 v[24:27], v252 offset:32768
  v_cvt_pk_bf16_f32 v75, v78, v79
  v_mfma_f32_16x16x32_bf16 v[96:99], v[32:35], v[172:175], v[96:99]
  v_accvgpr_write_b32 a128, v72
  v_accvgpr_write_b32 a129, v73
  v_mfma_f32_16x16x32_bf16 v[104:107], v[32:35], v[204:207], v[104:107]
  v_accvgpr_write_b32 a130, v74
  v_mfma_f32_16x16x32_bf16 v[112:115], v[32:35], v[236:239], v[112:115]
  s_waitcnt lgkmcnt(5)
  v_accvgpr_write_b32 a131, v75
  v_mfma_f32_16x16x32_bf16 v[92:95], v[36:39], v[140:143], v[92:95]
  ds_read_b128 v[28:31], v252 offset:34816
  v_mul_f32 v80, v12, v80
  v_mfma_f32_16x16x32_bf16 v[100:103], v[36:39], v[172:175], v[100:103]
  v_mul_f32 v81, v12, v81
  v_mul_f32 v82, v12, v82
  v_mfma_f32_16x16x32_bf16 v[108:111], v[36:39], v[204:207], v[108:111]
  v_mul_f32 v83, v12, v83
  v_mfma_f32_16x16x32_bf16 v[116:119], v[36:39], v[236:239], v[116:119]
  s_waitcnt lgkmcnt(5)
  v_mul_f32 v84, v12, v84
  v_mfma_f32_16x16x32_bf16 v[88:91], v[40:43], v[144:147], v[88:91]
  ds_read_b128 v[32:35], v253 offset:32768
  v_mul_f32 v85, v12, v85
  v_mfma_f32_16x16x32_bf16 v[96:99], v[40:43], v[176:179], v[96:99]
  v_mul_f32 v86, v12, v86
  v_mul_f32 v87, v12, v87
  v_mfma_f32_16x16x32_bf16 v[104:107], v[40:43], v[208:211], v[104:107]
  v_cvt_pk_bf16_f32 v80, v80, v81
  v_mfma_f32_16x16x32_bf16 v[112:115], v[40:43], v[240:243], v[112:115]
  s_waitcnt lgkmcnt(5)
  v_cvt_pk_bf16_f32 v81, v82, v83
  v_mfma_f32_16x16x32_bf16 v[92:95], v[44:47], v[144:147], v[92:95]
  ds_read_b128 v[36:39], v253 offset:34816
  v_cvt_pk_bf16_f32 v82, v84, v85
  v_mfma_f32_16x16x32_bf16 v[100:103], v[44:47], v[176:179], v[100:103]
  v_cvt_pk_bf16_f32 v83, v86, v87
  v_accvgpr_write_b32 a184, v80
  v_mfma_f32_16x16x32_bf16 v[108:111], v[44:47], v[208:211], v[108:111]
  v_accvgpr_write_b32 a185, v81
  v_mfma_f32_16x16x32_bf16 v[116:119], v[44:47], v[240:243], v[116:119]
  s_waitcnt lgkmcnt(5)
  v_accvgpr_write_b32 a186, v82
  v_mfma_f32_16x16x32_bf16 v[88:91], v[48:51], v[148:151], v[88:91]
  ds_read_b128 v[40:43], v254 offset:32768
  v_accvgpr_write_b32 a187, v83
  v_mfma_f32_16x16x32_bf16 v[96:99], v[48:51], v[180:183], v[96:99]
  v_mfma_f32_16x16x32_bf16 v[104:107], v[48:51], v[212:215], v[104:107]
  v_mfma_f32_16x16x32_bf16 v[112:115], v[48:51], v[244:247], v[112:115]
  s_waitcnt lgkmcnt(5)
  v_mfma_f32_16x16x32_bf16 v[92:95], v[52:55], v[148:151], v[92:95]
  ds_read_b128 v[44:47], v254 offset:34816
  v_mfma_f32_16x16x32_bf16 v[100:103], v[52:55], v[180:183], v[100:103]
  v_mfma_f32_16x16x32_bf16 v[108:111], v[52:55], v[212:215], v[108:111]
  v_mfma_f32_16x16x32_bf16 v[116:119], v[52:55], v[244:247], v[116:119]
  s_waitcnt lgkmcnt(5)
  s_getpc_b64 s[98:99]
  s_add_u32 s98, s98, 4096
  s_addc_u32 s99, s99, 0
  global_load_dword v7, v6, s[98:99]
  v_mfma_f32_16x16x32_bf16 v[56:59], v[24:27], v[120:123], 0
  ds_read_b128 v[48:51], v255 offset:32768
  v_mfma_f32_16x16x32_bf16 v[64:67], v[24:27], v[152:155], 0
  v_mfma_f32_16x16x32_bf16 v[72:75], v[24:27], v[184:187], 0
  s_add_u32 m0, s29, 32768
  s_add_u32 s27, s28, 3145728
  buffer_load_dwordx4 v14, s[60:63], s27 offen lds
  v_mfma_f32_16x16x32_bf16 v[80:83], v[24:27], v[216:219], 0
  s_waitcnt lgkmcnt(5)
  v_mul_f32 v88, v12, v88
  v_mfma_f32_16x16x32_bf16 v[60:63], v[28:31], v[120:123], 0
  ds_read_b128 v[52:55], v255 offset:34816
  v_mul_f32 v89, v12, v89
  v_mfma_f32_16x16x32_bf16 v[68:71], v[28:31], v[152:155], 0
  v_mul_f32 v90, v12, v90
  v_mul_f32 v91, v12, v91
  v_mfma_f32_16x16x32_bf16 v[76:79], v[28:31], v[184:187], 0
  v_mul_f32 v92, v12, v92
  v_mfma_f32_16x16x32_bf16 v[84:87], v[28:31], v[216:219], 0
  s_waitcnt lgkmcnt(5)
  v_mul_f32 v93, v12, v93
  v_mfma_f32_16x16x32_bf16 v[56:59], v[32:35], v[124:127], v[56:59]
  ds_read_b128 v[24:27], v252 offset:33024
  v_mul_f32 v94, v12, v94
  v_mfma_f32_16x16x32_bf16 v[64:67], v[32:35], v[156:159], v[64:67]
  v_mul_f32 v95, v12, v95
  v_cvt_pk_bf16_f32 v88, v88, v89
  v_mfma_f32_16x16x32_bf16 v[72:75], v[32:35], v[188:191], v[72:75]
  s_add_u32 m0, s29, 33792
  s_add_u32 s27, s28, 3162112
  buffer_load_dwordx4 v15, s[60:63], s27 offen lds
  v_mfma_f32_16x16x32_bf16 v[80:83], v[32:35], v[220:223], v[80:83]
  s_waitcnt lgkmcnt(5)
  v_cvt_pk_bf16_f32 v89, v90, v91
  v_mfma_f32_16x16x32_bf16 v[60:63], v[36:39], v[124:127], v[60:63]
  ds_read_b128 v[28:31], v252 offset:35072
  v_cvt_pk_bf16_f32 v90, v92, v93
  v_mfma_f32_16x16x32_bf16 v[68:71], v[36:39], v[156:159], v[68:71]
  v_cvt_pk_bf16_f32 v91, v94, v95
  v_accvgpr_write_b32 a20, v88
  v_mfma_f32_16x16x32_bf16 v[76:79], v[36:39], v[188:191], v[76:79]
  v_accvgpr_write_b32 a21, v89
  v_mfma_f32_16x16x32_bf16 v[84:87], v[36:39], v[220:223], v[84:87]
  s_waitcnt lgkmcnt(5)
  v_accvgpr_write_b32 a22, v90
  v_mfma_f32_16x16x32_bf16 v[56:59], v[40:43], v[128:131], v[56:59]
  ds_read_b128 v[32:35], v253 offset:33024
  v_accvgpr_write_b32 a23, v91
  v_mfma_f32_16x16x32_bf16 v[64:67], v[40:43], v[160:163], v[64:67]
  v_mul_f32 v96, v12, v96
  v_mul_f32 v97, v12, v97
  v_mfma_f32_16x16x32_bf16 v[72:75], v[40:43], v[192:195], v[72:75]
  s_add_u32 m0, s29, 34816
  s_add_u32 s27, s28, 3178496
  buffer_load_dwordx4 v14, s[60:63], s27 offen lds
  v_mfma_f32_16x16x32_bf16 v[80:83], v[40:43], v[224:227], v[80:83]
  s_waitcnt lgkmcnt(5)
  v_mul_f32 v98, v12, v98
  v_mfma_f32_16x16x32_bf16 v[60:63], v[44:47], v[128:131], v[60:63]
  ds_read_b128 v[36:39], v253 offset:35072
  v_mul_f32 v99, v12, v99
  v_mfma_f32_16x16x32_bf16 v[68:71], v[44:47], v[160:163], v[68:71]
  v_mul_f32 v100, v12, v100
  v_mul_f32 v101, v12, v101
  v_mfma_f32_16x16x32_bf16 v[76:79], v[44:47], v[192:195], v[76:79]
  v_mul_f32 v102, v12, v102
  v_mfma_f32_16x16x32_bf16 v[84:87], v[44:47], v[224:227], v[84:87]
  s_waitcnt lgkmcnt(5)
  v_mul_f32 v103, v12, v103
  v_mfma_f32_16x16x32_bf16 v[56:59], v[48:51], v[132:135], v[56:59]
  ds_read_b128 v[40:43], v254 offset:33024
  v_cvt_pk_bf16_f32 v96, v96, v97
  v_mfma_f32_16x16x32_bf16 v[64:67], v[48:51], v[164:167], v[64:67]
  v_cvt_pk_bf16_f32 v97, v98, v99
  v_cvt_pk_bf16_f32 v98, v100, v101
  v_mfma_f32_16x16x32_bf16 v[72:75], v[48:51], v[196:199], v[72:75]
  s_add_u32 m0, s29, 35840
  s_add_u32 s27, s28, 3194880
  buffer_load_dwordx4 v15, s[60:63], s27 offen lds
  v_mfma_f32_16x16x32_bf16 v[80:83], v[48:51], v[228:231], v[80:83]
  s_waitcnt lgkmcnt(5)
  v_cvt_pk_bf16_f32 v99, v102, v103
  v_mfma_f32_16x16x32_bf16 v[60:63], v[52:55], v[132:135], v[60:63]
  ds_read_b128 v[44:47], v254 offset:35072
  v_accvgpr_write_b32 a76, v96
  v_mfma_f32_16x16x32_bf16 v[68:71], v[52:55], v[164:167], v[68:71]
  v_accvgpr_write_b32 a77, v97
  v_accvgpr_write_b32 a78, v98
  v_mfma_f32_16x16x32_bf16 v[76:79], v[52:55], v[196:199], v[76:79]
  v_accvgpr_write_b32 a79, v99
  v_mfma_f32_16x16x32_bf16 v[84:87], v[52:55], v[228:231], v[84:87]
  s_waitcnt lgkmcnt(5)
  v_mul_f32 v104, v12, v104
  v_mfma_f32_16x16x32_bf16 v[56:59], v[24:27], v[136:139], v[56:59]
  ds_read_b128 v[48:51], v255 offset:33024
  v_mul_f32 v105, v12, v105
  v_mfma_f32_16x16x32_bf16 v[64:67], v[24:27], v[168:171], v[64:67]
  v_mul_f32 v106, v12, v106
  v_mul_f32 v107, v12, v107
  v_mfma_f32_16x16x32_bf16 v[72:75], v[24:27], v[200:203], v[72:75]
  v_mul_f32 v108, v12, v108
  v_mfma_f32_16x16x32_bf16 v[80:83], v[24:27], v[232:235], v[80:83]
  s_waitcnt lgkmcnt(5)
  v_mul_f32 v109, v12, v109
  v_mfma_f32_16x16x32_bf16 v[60:63], v[28:31], v[136:139], v[60:63]
  ds_read_b128 v[52:55], v255 offset:35072
  v_mul_f32 v110, v12, v110
  v_mfma_f32_16x16x32_bf16 v[68:71], v[28:31], v[168:171], v[68:71]
  v_mul_f32 v111, v12, v111
  v_cvt_pk_bf16_f32 v104, v104, v105
  v_mfma_f32_16x16x32_bf16 v[76:79], v[28:31], v[200:203], v[76:79]
  v_cvt_pk_bf16_f32 v105, v106, v107
  v_mfma_f32_16x16x32_bf16 v[84:87], v[28:31], v[232:235], v[84:87]
  s_waitcnt lgkmcnt(5)
  v_cvt_pk_bf16_f32 v106, v108, v109
  v_mfma_f32_16x16x32_bf16 v[56:59], v[32:35], v[140:143], v[56:59]
  s_waitcnt vmcnt(20)
  s_barrier
  ds_read_b128 v[24:27], v252 offset:49152
  v_cvt_pk_bf16_f32 v107, v110, v111
  v_mfma_f32_16x16x32_bf16 v[64:67], v[32:35], v[172:175], v[64:67]
  v_accvgpr_write_b32 a132, v104
  v_accvgpr_write_b32 a133, v105
  v_mfma_f32_16x16x32_bf16 v[72:75], v[32:35], v[204:207], v[72:75]
  v_accvgpr_write_b32 a134, v106
  v_mfma_f32_16x16x32_bf16 v[80:83], v[32:35], v[236:239], v[80:83]
  s_waitcnt lgkmcnt(5)
  v_accvgpr_write_b32 a135, v107
  v_mfma_f32_16x16x32_bf16 v[60:63], v[36:39], v[140:143], v[60:63]
  ds_read_b128 v[28:31], v252 offset:51200
  v_mul_f32 v112, v12, v112
  v_mfma_f32_16x16x32_bf16 v[68:71], v[36:39], v[172:175], v[68:71]
  v_mul_f32 v113, v12, v113
  v_mul_f32 v114, v12, v114
  v_mfma_f32_16x16x32_bf16 v[76:79], v[36:39], v[204:207], v[76:79]
  v_mul_f32 v115, v12, v115
  v_mfma_f32_16x16x32_bf16 v[84:87], v[36:39], v[236:239], v[84:87]
  s_waitcnt lgkmcnt(5)
  v_mul_f32 v116, v12, v116
  v_mfma_f32_16x16x32_bf16 v[56:59], v[40:43], v[144:147], v[56:59]
  ds_read_b128 v[32:35], v253 offset:49152
  v_mul_f32 v117, v12, v117
  v_mfma_f32_16x16x32_bf16 v[64:67], v[40:43], v[176:179], v[64:67]
  v_mul_f32 v118, v12, v118
  v_mul_f32 v119, v12, v119
  v_mfma_f32_16x16x32_bf16 v[72:75], v[40:43], v[208:211], v[72:75]
  v_cvt_pk_bf16_f32 v112, v112, v113
  v_mfma_f32_16x16x32_bf16 v[80:83], v[40:43], v[240:243], v[80:83]
  s_waitcnt lgkmcnt(5)
  v_cvt_pk_bf16_f32 v113, v114, v115
  v_mfma_f32_16x16x32_bf16 v[60:63], v[44:47], v[144:147], v[60:63]
  ds_read_b128 v[36:39], v253 offset:51200
  v_cvt_pk_bf16_f32 v114, v116, v117
  v_mfma_f32_16x16x32_bf16 v[68:71], v[44:47], v[176:179], v[68:71]
  v_cvt_pk_bf16_f32 v115, v118, v119
  v_accvgpr_write_b32 a188, v112
  v_mfma_f32_16x16x32_bf16 v[76:79], v[44:47], v[208:211], v[76:79]
  v_accvgpr_write_b32 a189, v113
  v_mfma_f32_16x16x32_bf16 v[84:87], v[44:47], v[240:243], v[84:87]
  s_waitcnt lgkmcnt(5)
  v_accvgpr_write_b32 a190, v114
  v_mfma_f32_16x16x32_bf16 v[56:59], v[48:51], v[148:151], v[56:59]
  ds_read_b128 v[40:43], v254 offset:49152
  v_accvgpr_write_b32 a191, v115
  v_mfma_f32_16x16x32_bf16 v[64:67], v[48:51], v[180:183], v[64:67]
  v_mfma_f32_16x16x32_bf16 v[72:75], v[48:51], v[212:215], v[72:75]
  v_mfma_f32_16x16x32_bf16 v[80:83], v[48:51], v[244:247], v[80:83]
  s_waitcnt lgkmcnt(5)
  v_mfma_f32_16x16x32_bf16 v[60:63], v[52:55], v[148:151], v[60:63]
  ds_read_b128 v[44:47], v254 offset:51200
  v_mfma_f32_16x16x32_bf16 v[68:71], v[52:55], v[180:183], v[68:71]
  v_mfma_f32_16x16x32_bf16 v[76:79], v[52:55], v[212:215], v[76:79]
  v_mfma_f32_16x16x32_bf16 v[84:87], v[52:55], v[244:247], v[84:87]
  s_waitcnt lgkmcnt(5)
  v_mfma_f32_16x16x32_bf16 v[88:91], v[24:27], v[120:123], 0
  ds_read_b128 v[48:51], v255 offset:49152
  v_mfma_f32_16x16x32_bf16 v[96:99], v[24:27], v[152:155], 0
  v_mfma_f32_16x16x32_bf16 v[104:107], v[24:27], v[184:187], 0
  s_add_u32 m0, s29, 49152
  s_add_u32 s27, s28, 3407872
  buffer_load_dwordx4 v14, s[60:63], s27 offen lds
  v_mfma_f32_16x16x32_bf16 v[112:115], v[24:27], v[216:219], 0
  s_waitcnt lgkmcnt(5)
  v_mul_f32 v56, v12, v56
  v_mfma_f32_16x16x32_bf16 v[92:95], v[28:31], v[120:123], 0
  ds_read_b128 v[52:55], v255 offset:51200
  v_mul_f32 v57, v12, v57
  v_mfma_f32_16x16x32_bf16 v[100:103], v[28:31], v[152:155], 0
  v_mul_f32 v58, v12, v58
  v_mul_f32 v59, v12, v59
  v_mfma_f32_16x16x32_bf16 v[108:111], v[28:31], v[184:187], 0
  v_mul_f32 v60, v12, v60
  v_mfma_f32_16x16x32_bf16 v[116:119], v[28:31], v[216:219], 0
  s_waitcnt lgkmcnt(5)
  v_mul_f32 v61, v12, v61
  v_mfma_f32_16x16x32_bf16 v[88:91], v[32:35], v[124:127], v[88:91]
  ds_read_b128 v[24:27], v252 offset:49408
  v_mul_f32 v62, v12, v62
  v_mfma_f32_16x16x32_bf16 v[96:99], v[32:35], v[156:159], v[96:99]
  v_mul_f32 v63, v12, v63
  v_cvt_pk_bf16_f32 v56, v56, v57
  v_mfma_f32_16x16x32_bf16 v[104:107], v[32:35], v[188:191], v[104:107]
  s_add_u32 m0, s29, 50176
  s_add_u32 s27, s28, 3424256
  buffer_load_dwordx4 v15, s[60:63], s27 offen lds
  v_mfma_f32_16x16x32_bf16 v[112:115], v[32:35], v[220:223], v[112:115]
  s_waitcnt lgkmcnt(5)
  v_cvt_pk_bf16_f32 v57, v58, v59
  v_mfma_f32_16x16x32_bf16 v[92:95], v[36:39], v[124:127], v[92:95]
  ds_read_b128 v[28:31], v252 offset:51456
  v_cvt_pk_bf16_f32 v58, v60, v61
  v_mfma_f32_16x16x32_bf16 v[100:103], v[36:39], v[156:159], v[100:103]
  v_cvt_pk_bf16_f32 v59, v62, v63
  v_accvgpr_write_b32 a24, v56
  v_mfma_f32_16x16x32_bf16 v[108:111], v[36:39], v[188:191], v[108:111]
  v_accvgpr_write_b32 a25, v57
  v_mfma_f32_16x16x32_bf16 v[116:119], v[36:39], v[220:223], v[116:119]
  s_waitcnt lgkmcnt(5)
  v_accvgpr_write_b32 a26, v58
  v_mfma_f32_16x16x32_bf16 v[88:91], v[40:43], v[128:131], v[88:91]
  ds_read_b128 v[32:35], v253 offset:49408
  v_accvgpr_write_b32 a27, v59
  v_mfma_f32_16x16x32_bf16 v[96:99], v[40:43], v[160:163], v[96:99]
  v_mul_f32 v64, v12, v64
  v_mul_f32 v65, v12, v65
  v_mfma_f32_16x16x32_bf16 v[104:107], v[40:43], v[192:195], v[104:107]
  s_add_u32 m0, s29, 51200
  s_add_u32 s27, s28, 3440640
  buffer_load_dwordx4 v14, s[60:63], s27 offen lds
  v_mfma_f32_16x16x32_bf16 v[112:115], v[40:43], v[224:227], v[112:115]
  s_waitcnt lgkmcnt(5)
  v_mul_f32 v66, v12, v66
  v_mfma_f32_16x16x32_bf16 v[92:95], v[44:47], v[128:131], v[92:95]
  ds_read_b128 v[36:39], v253 offset:51456
  v_mul_f32 v67, v12, v67
  v_mfma_f32_16x16x32_bf16 v[100:103], v[44:47], v[160:163], v[100:103]
  v_mul_f32 v68, v12, v68
  v_mul_f32 v69, v12, v69
  v_mfma_f32_16x16x32_bf16 v[108:111], v[44:47], v[192:195], v[108:111]
  v_mul_f32 v70, v12, v70
  v_mfma_f32_16x16x32_bf16 v[116:119], v[44:47], v[224:227], v[116:119]
  s_waitcnt lgkmcnt(5)
  v_mul_f32 v71, v12, v71
  v_mfma_f32_16x16x32_bf16 v[88:91], v[48:51], v[132:135], v[88:91]
  ds_read_b128 v[40:43], v254 offset:49408
  v_cvt_pk_bf16_f32 v64, v64, v65
  v_mfma_f32_16x16x32_bf16 v[96:99], v[48:51], v[164:167], v[96:99]
  v_cvt_pk_bf16_f32 v65, v66, v67
  v_cvt_pk_bf16_f32 v66, v68, v69
  v_mfma_f32_16x16x32_bf16 v[104:107], v[48:51], v[196:199], v[104:107]
  s_add_u32 m0, s29, 52224
  s_add_u32 s27, s28, 3457024
  buffer_load_dwordx4 v15, s[60:63], s27 offen lds
  v_mfma_f32_16x16x32_bf16 v[112:115], v[48:51], v[228:231], v[112:115]
  s_waitcnt lgkmcnt(5)
  v_cvt_pk_bf16_f32 v67, v70, v71
  v_mfma_f32_16x16x32_bf16 v[92:95], v[52:55], v[132:135], v[92:95]
  ds_read_b128 v[44:47], v254 offset:51456
  v_accvgpr_write_b32 a80, v64
  v_mfma_f32_16x16x32_bf16 v[100:103], v[52:55], v[164:167], v[100:103]
  v_accvgpr_write_b32 a81, v65
  v_accvgpr_write_b32 a82, v66
  v_mfma_f32_16x16x32_bf16 v[108:111], v[52:55], v[196:199], v[108:111]
  v_accvgpr_write_b32 a83, v67
  v_mfma_f32_16x16x32_bf16 v[116:119], v[52:55], v[228:231], v[116:119]
  s_waitcnt lgkmcnt(5)
  v_mul_f32 v72, v12, v72
  v_mfma_f32_16x16x32_bf16 v[88:91], v[24:27], v[136:139], v[88:91]
  ds_read_b128 v[48:51], v255 offset:49408
  v_mul_f32 v73, v12, v73
  v_mfma_f32_16x16x32_bf16 v[96:99], v[24:27], v[168:171], v[96:99]
  v_mul_f32 v74, v12, v74
  v_mul_f32 v75, v12, v75
  v_mfma_f32_16x16x32_bf16 v[104:107], v[24:27], v[200:203], v[104:107]
  v_mul_f32 v76, v12, v76
  v_mfma_f32_16x16x32_bf16 v[112:115], v[24:27], v[232:235], v[112:115]
  s_waitcnt lgkmcnt(5)
  v_mul_f32 v77, v12, v77
  v_mfma_f32_16x16x32_bf16 v[92:95], v[28:31], v[136:139], v[92:95]
  ds_read_b128 v[52:55], v255 offset:51456
  v_mul_f32 v78, v12, v78
  v_mfma_f32_16x16x32_bf16 v[100:103], v[28:31], v[168:171], v[100:103]
  v_mul_f32 v79, v12, v79
  v_cvt_pk_bf16_f32 v72, v72, v73
  v_mfma_f32_16x16x32_bf16 v[108:111], v[28:31], v[200:203], v[108:111]
  v_cvt_pk_bf16_f32 v73, v74, v75
  v_mfma_f32_16x16x32_bf16 v[116:119], v[28:31], v[232:235], v[116:119]
  s_waitcnt lgkmcnt(5)
  v_cvt_pk_bf16_f32 v74, v76, v77
  v_mfma_f32_16x16x32_bf16 v[88:91], v[32:35], v[140:143], v[88:91]
  s_waitcnt vmcnt(20)
  s_barrier
  ds_read_b128 v[24:27], v16 offset:0
  v_cvt_pk_bf16_f32 v75, v78, v79
  v_mfma_f32_16x16x32_bf16 v[96:99], v[32:35], v[172:175], v[96:99]
  v_accvgpr_write_b32 a136, v72
  v_accvgpr_write_b32 a137, v73
  v_mfma_f32_16x16x32_bf16 v[104:107], v[32:35], v[204:207], v[104:107]
  v_accvgpr_write_b32 a138, v74
  v_mfma_f32_16x16x32_bf16 v[112:115], v[32:35], v[236:239], v[112:115]
  s_waitcnt lgkmcnt(5)
  v_accvgpr_write_b32 a139, v75
  v_mfma_f32_16x16x32_bf16 v[92:95], v[36:39], v[140:143], v[92:95]
  ds_read_b128 v[28:31], v16 offset:2048
  v_mul_f32 v80, v12, v80
  v_mfma_f32_16x16x32_bf16 v[100:103], v[36:39], v[172:175], v[100:103]
  v_mul_f32 v81, v12, v81
  v_mul_f32 v82, v12, v82
  v_mfma_f32_16x16x32_bf16 v[108:111], v[36:39], v[204:207], v[108:111]
  v_mul_f32 v83, v12, v83
  v_mfma_f32_16x16x32_bf16 v[116:119], v[36:39], v[236:239], v[116:119]
  s_waitcnt lgkmcnt(5)
  v_mul_f32 v84, v12, v84
  v_mfma_f32_16x16x32_bf16 v[88:91], v[40:43], v[144:147], v[88:91]
  ds_read_b128 v[32:35], v17 offset:0
  v_mul_f32 v85, v12, v85
  v_mfma_f32_16x16x32_bf16 v[96:99], v[40:43], v[176:179], v[96:99]
  v_mul_f32 v86, v12, v86
  v_mul_f32 v87, v12, v87
  v_mfma_f32_16x16x32_bf16 v[104:107], v[40:43], v[208:211], v[104:107]
  v_cvt_pk_bf16_f32 v80, v80, v81
  v_mfma_f32_16x16x32_bf16 v[112:115], v[40:43], v[240:243], v[112:115]
  s_waitcnt lgkmcnt(5)
  v_cvt_pk_bf16_f32 v81, v82, v83
  v_mfma_f32_16x16x32_bf16 v[92:95], v[44:47], v[144:147], v[92:95]
  ds_read_b128 v[36:39], v17 offset:2048
  v_cvt_pk_bf16_f32 v82, v84, v85
  v_mfma_f32_16x16x32_bf16 v[100:103], v[44:47], v[176:179], v[100:103]
  v_cvt_pk_bf16_f32 v83, v86, v87
  v_accvgpr_write_b32 a192, v80
  v_mfma_f32_16x16x32_bf16 v[108:111], v[44:47], v[208:211], v[108:111]
  v_accvgpr_write_b32 a193, v81
  v_mfma_f32_16x16x32_bf16 v[116:119], v[44:47], v[240:243], v[116:119]
  s_waitcnt lgkmcnt(5)
  v_accvgpr_write_b32 a194, v82
  v_mfma_f32_16x16x32_bf16 v[88:91], v[48:51], v[148:151], v[88:91]
  ds_read_b128 v[40:43], v18 offset:0
  v_accvgpr_write_b32 a195, v83
  v_mfma_f32_16x16x32_bf16 v[96:99], v[48:51], v[180:183], v[96:99]
  v_mfma_f32_16x16x32_bf16 v[104:107], v[48:51], v[212:215], v[104:107]
  v_mfma_f32_16x16x32_bf16 v[112:115], v[48:51], v[244:247], v[112:115]
  s_waitcnt lgkmcnt(5)
  v_mfma_f32_16x16x32_bf16 v[92:95], v[52:55], v[148:151], v[92:95]
  ds_read_b128 v[44:47], v18 offset:2048
  v_mfma_f32_16x16x32_bf16 v[100:103], v[52:55], v[180:183], v[100:103]
  v_mfma_f32_16x16x32_bf16 v[108:111], v[52:55], v[212:215], v[108:111]
  v_mfma_f32_16x16x32_bf16 v[116:119], v[52:55], v[244:247], v[116:119]
  s_waitcnt lgkmcnt(5)
  v_mfma_f32_16x16x32_bf16 v[56:59], v[24:27], v[120:123], 0
  ds_read_b128 v[48:51], v19 offset:0
  v_mfma_f32_16x16x32_bf16 v[64:67], v[24:27], v[152:155], 0
  v_mfma_f32_16x16x32_bf16 v[72:75], v[24:27], v[184:187], 0
  v_mfma_f32_16x16x32_bf16 v[80:83], v[24:27], v[216:219], 0
  s_waitcnt lgkmcnt(5)
  v_mul_f32 v88, v12, v88
  v_mfma_f32_16x16x32_bf16 v[60:63], v[28:31], v[120:123], 0
  ds_read_b128 v[52:55], v19 offset:2048
  v_mul_f32 v89, v12, v89
  v_mfma_f32_16x16x32_bf16 v[68:71], v[28:31], v[152:155], 0
  v_mul_f32 v90, v12, v90
  v_mul_f32 v91, v12, v91
  v_mfma_f32_16x16x32_bf16 v[76:79], v[28:31], v[184:187], 0
  v_mul_f32 v92, v12, v92
  v_mfma_f32_16x16x32_bf16 v[84:87], v[28:31], v[216:219], 0
  s_waitcnt lgkmcnt(5)
  v_mul_f32 v93, v12, v93
  v_mfma_f32_16x16x32_bf16 v[56:59], v[32:35], v[124:127], v[56:59]
  ds_read_b128 v[24:27], v16 offset:256
  v_mul_f32 v94, v12, v94
  v_mfma_f32_16x16x32_bf16 v[64:67], v[32:35], v[156:159], v[64:67]
  v_mul_f32 v95, v12, v95
  v_cvt_pk_bf16_f32 v88, v88, v89
  v_mfma_f32_16x16x32_bf16 v[72:75], v[32:35], v[188:191], v[72:75]
  v_cvt_pk_bf16_f32 v89, v90, v91
  v_mfma_f32_16x16x32_bf16 v[80:83], v[32:35], v[220:223], v[80:83]
  s_waitcnt lgkmcnt(5)
  v_cvt_pk_bf16_f32 v90, v92, v93
  v_mfma_f32_16x16x32_bf16 v[60:63], v[36:39], v[124:127], v[60:63]
  ds_read_b128 v[28:31], v16 offset:2304
  v_cvt_pk_bf16_f32 v91, v94, v95
  v_mfma_f32_16x16x32_bf16 v[68:71], v[36:39], v[156:159], v[68:71]
  v_accvgpr_write_b32 a28, v88
  v_accvgpr_write_b32 a29, v89
  v_mfma_f32_16x16x32_bf16 v[76:79], v[36:39], v[188:191], v[76:79]
  v_accvgpr_write_b32 a30, v90
  v_mfma_f32_16x16x32_bf16 v[84:87], v[36:39], v[220:223], v[84:87]
  s_waitcnt lgkmcnt(5)
  v_accvgpr_write_b32 a31, v91
  v_mfma_f32_16x16x32_bf16 v[56:59], v[40:43], v[128:131], v[56:59]
  ds_read_b128 v[32:35], v17 offset:256
  v_mul_f32 v96, v12, v96
  v_mfma_f32_16x16x32_bf16 v[64:67], v[40:43], v[160:163], v[64:67]
  v_mul_f32 v97, v12, v97
  v_mul_f32 v98, v12, v98
  v_mfma_f32_16x16x32_bf16 v[72:75], v[40:43], v[192:195], v[72:75]
  v_mul_f32 v99, v12, v99
  v_mfma_f32_16x16x32_bf16 v[80:83], v[40:43], v[224:227], v[80:83]
  s_waitcnt lgkmcnt(5)
  v_mul_f32 v100, v12, v100
  v_mfma_f32_16x16x32_bf16 v[60:63], v[44:47], v[128:131], v[60:63]
  ds_read_b128 v[36:39], v17 offset:2304
  v_mul_f32 v101, v12, v101
  v_mfma_f32_16x16x32_bf16 v[68:71], v[44:47], v[160:163], v[68:71]
  v_mul_f32 v102, v12, v102
  v_mul_f32 v103, v12, v103
  v_mfma_f32_16x16x32_bf16 v[76:79], v[44:47], v[192:195], v[76:79]
  v_cvt_pk_bf16_f32 v96, v96, v97
  v_mfma_f32_16x16x32_bf16 v[84:87], v[44:47], v[224:227], v[84:87]
  s_waitcnt lgkmcnt(5)
  v_cvt_pk_bf16_f32 v97, v98, v99
  v_mfma_f32_16x16x32_bf16 v[56:59], v[48:51], v[132:135], v[56:59]
  ds_read_b128 v[40:43], v18 offset:256
  v_cvt_pk_bf16_f32 v98, v100, v101
  v_mfma_f32_16x16x32_bf16 v[64:67], v[48:51], v[164:167], v[64:67]
  v_cvt_pk_bf16_f32 v99, v102, v103
  v_accvgpr_write_b32 a84, v96
  v_mfma_f32_16x16x32_bf16 v[72:75], v[48:51], v[196:199], v[72:75]
  v_accvgpr_write_b32 a85, v97
  v_mfma_f32_16x16x32_bf16 v[80:83], v[48:51], v[228:231], v[80:83]
  s_waitcnt lgkmcnt(5)
  v_accvgpr_write_b32 a86, v98
  v_mfma_f32_16x16x32_bf16 v[60:63], v[52:55], v[132:135], v[60:63]
  ds_read_b128 v[44:47], v18 offset:2304
  v_accvgpr_write_b32 a87, v99
  v_mfma_f32_16x16x32_bf16 v[68:71], v[52:55], v[164:167], v[68:71]
  v_mul_f32 v104, v12, v104
  v_mul_f32 v105, v12, v105
  v_mfma_f32_16x16x32_bf16 v[76:79], v[52:55], v[196:199], v[76:79]
  v_mul_f32 v106, v12, v106
  v_mfma_f32_16x16x32_bf16 v[84:87], v[52:55], v[228:231], v[84:87]
  s_waitcnt lgkmcnt(5)
  v_mul_f32 v107, v12, v107
  v_mfma_f32_16x16x32_bf16 v[56:59], v[24:27], v[136:139], v[56:59]
  ds_read_b128 v[48:51], v19 offset:256
  v_mul_f32 v108, v12, v108
  v_mfma_f32_16x16x32_bf16 v[64:67], v[24:27], v[168:171], v[64:67]
  v_mul_f32 v109, v12, v109
  v_mul_f32 v110, v12, v110
  v_mfma_f32_16x16x32_bf16 v[72:75], v[24:27], v[200:203], v[72:75]
  v_mul_f32 v111, v12, v111
  v_mfma_f32_16x16x32_bf16 v[80:83], v[24:27], v[232:235], v[80:83]
  s_waitcnt lgkmcnt(5)
  v_cvt_pk_bf16_f32 v104, v104, v105
  v_mfma_f32_16x16x32_bf16 v[60:63], v[28:31], v[136:139], v[60:63]
  ds_read_b128 v[52:55], v19 offset:2304
  v_cvt_pk_bf16_f32 v105, v106, v107
  v_mfma_f32_16x16x32_bf16 v[68:71], v[28:31], v[168:171], v[68:71]
  v_cvt_pk_bf16_f32 v106, v108, v109
  v_cvt_pk_bf16_f32 v107, v110, v111
  v_mfma_f32_16x16x32_bf16 v[76:79], v[28:31], v[200:203], v[76:79]
  v_accvgpr_write_b32 a140, v104
  v_mfma_f32_16x16x32_bf16 v[84:87], v[28:31], v[232:235], v[84:87]
  s_waitcnt lgkmcnt(5)
  v_accvgpr_write_b32 a141, v105
  v_mfma_f32_16x16x32_bf16 v[56:59], v[32:35], v[140:143], v[56:59]
  s_waitcnt vmcnt(16)
  s_barrier
  ds_read_b128 v[24:27], v16 offset:16384
  v_accvgpr_write_b32 a142, v106
  v_mfma_f32_16x16x32_bf16 v[64:67], v[32:35], v[172:175], v[64:67]
  v_accvgpr_write_b32 a143, v107
  v_mul_f32 v112, v12, v112
  v_mfma_f32_16x16x32_bf16 v[72:75], v[32:35], v[204:207], v[72:75]
  v_mul_f32 v113, v12, v113
  v_mfma_f32_16x16x32_bf16 v[80:83], v[32:35], v[236:239], v[80:83]
  s_waitcnt lgkmcnt(5)
  v_mul_f32 v114, v12, v114
  v_mfma_f32_16x16x32_bf16 v[60:63], v[36:39], v[140:143], v[60:63]
  ds_read_b128 v[28:31], v16 offset:18432
  v_mul_f32 v115, v12, v115
  v_mfma_f32_16x16x32_bf16 v[68:71], v[36:39], v[172:175], v[68:71]
  v_mul_f32 v116, v12, v116
  v_mul_f32 v117, v12, v117
  v_mfma_f32_16x16x32_bf16 v[76:79], v[36:39], v[204:207], v[76:79]
  v_mul_f32 v118, v12, v118
  v_mfma_f32_16x16x32_bf16 v[84:87], v[36:39], v[236:239], v[84:87]
  s_waitcnt lgkmcnt(5)
  v_mul_f32 v119, v12, v119
  v_mfma_f32_16x16x32_bf16 v[56:59], v[40:43], v[144:147], v[56:59]
  ds_read_b128 v[32:35], v17 offset:16384
  v_cvt_pk_bf16_f32 v112, v112, v113
  v_mfma_f32_16x16x32_bf16 v[64:67], v[40:43], v[176:179], v[64:67]
  v_cvt_pk_bf16_f32 v113, v114, v115
  v_cvt_pk_bf16_f32 v114, v116, v117
  v_mfma_f32_16x16x32_bf16 v[72:75], v[40:43], v[208:211], v[72:75]
  v_cvt_pk_bf16_f32 v115, v118, v119
  v_mfma_f32_16x16x32_bf16 v[80:83], v[40:43], v[240:243], v[80:83]
  s_waitcnt lgkmcnt(5)
  v_accvgpr_write_b32 a196, v112
  v_mfma_f32_16x16x32_bf16 v[60:63], v[44:47], v[144:147], v[60:63]
  ds_read_b128 v[36:39], v17 offset:18432
  v_accvgpr_write_b32 a197, v113
  v_mfma_f32_16x16x32_bf16 v[68:71], v[44:47], v[176:179], v[68:71]
  v_accvgpr_write_b32 a198, v114
  v_accvgpr_write_b32 a199, v115
  v_mfma_f32_16x16x32_bf16 v[76:79], v[44:47], v[208:211], v[76:79]
  v_mfma_f32_16x16x32_bf16 v[84:87], v[44:47], v[240:243], v[84:87]
  s_waitcnt lgkmcnt(5)
  v_mfma_f32_16x16x32_bf16 v[56:59], v[48:51], v[148:151], v[56:59]
  ds_read_b128 v[40:43], v18 offset:16384
  v_mfma_f32_16x16x32_bf16 v[64:67], v[48:51], v[180:183], v[64:67]
  v_mfma_f32_16x16x32_bf16 v[72:75], v[48:51], v[212:215], v[72:75]
  v_mfma_f32_16x16x32_bf16 v[80:83], v[48:51], v[244:247], v[80:83]
  s_waitcnt lgkmcnt(5)
  v_mfma_f32_16x16x32_bf16 v[60:63], v[52:55], v[148:151], v[60:63]
  ds_read_b128 v[44:47], v18 offset:18432
  v_mfma_f32_16x16x32_bf16 v[68:71], v[52:55], v[180:183], v[68:71]
  v_mfma_f32_16x16x32_bf16 v[76:79], v[52:55], v[212:215], v[76:79]
  v_mfma_f32_16x16x32_bf16 v[84:87], v[52:55], v[244:247], v[84:87]
  s_waitcnt lgkmcnt(5)
  s_getpc_b64 s[98:99]
  s_add_u32 s98, s98, 4096
  s_addc_u32 s99, s99, 0
  global_load_dword v7, v6, s[98:99]
  v_mfma_f32_16x16x32_bf16 v[88:91], v[24:27], v[120:123], 0
  ds_read_b128 v[48:51], v19 offset:16384
  v_mfma_f32_16x16x32_bf16 v[96:99], v[24:27], v[152:155], 0
  v_mfma_f32_16x16x32_bf16 v[104:107], v[24:27], v[184:187], 0
  v_mfma_f32_16x16x32_bf16 v[112:115], v[24:27], v[216:219], 0
  s_waitcnt lgkmcnt(5)
  v_mul_f32 v56, v12, v56
  v_mfma_f32_16x16x32_bf16 v[92:95], v[28:31], v[120:123], 0
  ds_read_b128 v[52:55], v19 offset:18432
  v_mul_f32 v57, v12, v57
  v_mfma_f32_16x16x32_bf16 v[100:103], v[28:31], v[152:155], 0
  v_mul_f32 v58, v12, v58
  v_mul_f32 v59, v12, v59
  v_mfma_f32_16x16x32_bf16 v[108:111], v[28:31], v[184:187], 0
  v_mul_f32 v60, v12, v60
  v_mfma_f32_16x16x32_bf16 v[116:119], v[28:31], v[216:219], 0
  s_waitcnt lgkmcnt(5)
  v_mul_f32 v61, v12, v61
  v_mfma_f32_16x16x32_bf16 v[88:91], v[32:35], v[124:127], v[88:91]
  ds_read_b128 v[24:27], v16 offset:16640
  v_mul_f32 v62, v12, v62
  v_mfma_f32_16x16x32_bf16 v[96:99], v[32:35], v[156:159], v[96:99]
  v_mul_f32 v63, v12, v63
  v_cvt_pk_bf16_f32 v56, v56, v57
  v_mfma_f32_16x16x32_bf16 v[104:107], v[32:35], v[188:191], v[104:107]
  v_cvt_pk_bf16_f32 v57, v58, v59
  v_mfma_f32_16x16x32_bf16 v[112:115], v[32:35], v[220:223], v[112:115]
  s_waitcnt lgkmcnt(5)
  v_cvt_pk_bf16_f32 v58, v60, v61
  v_mfma_f32_16x16x32_bf16 v[92:95], v[36:39], v[124:127], v[92:95]
  ds_read_b128 v[28:31], v16 offset:18688
  v_cvt_pk_bf16_f32 v59, v62, v63
  v_mfma_f32_16x16x32_bf16 v[100:103], v[36:39], v[156:159], v[100:103]
  v_accvgpr_write_b32 a32, v56
  v_accvgpr_write_b32 a33, v57
  v_mfma_f32_16x16x32_bf16 v[108:111], v[36:39], v[188:191], v[108:111]
  v_accvgpr_write_b32 a34, v58
  v_mfma_f32_16x16x32_bf16 v[116:119], v[36:39], v[220:223], v[116:119]
  s_waitcnt lgkmcnt(5)
  v_accvgpr_write_b32 a35, v59
  v_mfma_f32_16x16x32_bf16 v[88:91], v[40:43], v[128:131], v[88:91]
  ds_read_b128 v[32:35], v17 offset:16640
  v_mul_f32 v64, v12, v64
  v_mfma_f32_16x16x32_bf16 v[96:99], v[40:43], v[160:163], v[96:99]
  v_mul_f32 v65, v12, v65
  v_mul_f32 v66, v12, v66
  v_mfma_f32_16x16x32_bf16 v[104:107], v[40:43], v[192:195], v[104:107]
  v_mul_f32 v67, v12, v67
  v_mfma_f32_16x16x32_bf16 v[112:115], v[40:43], v[224:227], v[112:115]
  s_waitcnt lgkmcnt(5)
  v_mul_f32 v68, v12, v68
  v_mfma_f32_16x16x32_bf16 v[92:95], v[44:47], v[128:131], v[92:95]
  ds_read_b128 v[36:39], v17 offset:18688
  v_mul_f32 v69, v12, v69
  v_mfma_f32_16x16x32_bf16 v[100:103], v[44:47], v[160:163], v[100:103]
  v_mul_f32 v70, v12, v70
  v_mul_f32 v71, v12, v71
  v_mfma_f32_16x16x32_bf16 v[108:111], v[44:47], v[192:195], v[108:111]
  v_cvt_pk_bf16_f32 v64, v64, v65
  v_mfma_f32_16x16x32_bf16 v[116:119], v[44:47], v[224:227], v[116:119]
  s_waitcnt lgkmcnt(5)
  v_cvt_pk_bf16_f32 v65, v66, v67
  v_mfma_f32_16x16x32_bf16 v[88:91], v[48:51], v[132:135], v[88:91]
  ds_read_b128 v[40:43], v18 offset:16640
  v_cvt_pk_bf16_f32 v66, v68, v69
  v_mfma_f32_16x16x32_bf16 v[96:99], v[48:51], v[164:167], v[96:99]
  v_cvt_pk_bf16_f32 v67, v70, v71
  v_accvgpr_write_b32 a88, v64
  v_mfma_f32_16x16x32_bf16 v[104:107], v[48:51], v[196:199], v[104:107]
  v_accvgpr_write_b32 a89, v65
  v_mfma_f32_16x16x32_bf16 v[112:115], v[48:51], v[228:231], v[112:115]
  s_waitcnt lgkmcnt(5)
  v_accvgpr_write_b32 a90, v66
  v_mfma_f32_16x16x32_bf16 v[92:95], v[52:55], v[132:135], v[92:95]
  ds_read_b128 v[44:47], v18 offset:18688
  v_accvgpr_write_b32 a91, v67
  v_mfma_f32_16x16x32_bf16 v[100:103], v[52:55], v[164:167], v[100:103]
  v_mul_f32 v72, v12, v72
  v_mul_f32 v73, v12, v73
  v_mfma_f32_16x16x32_bf16 v[108:111], v[52:55], v[196:199], v[108:111]
  v_mul_f32 v74, v12, v74
  v_mfma_f32_16x16x32_bf16 v[116:119], v[52:55], v[228:231], v[116:119]
  s_waitcnt lgkmcnt(5)
  v_mul_f32 v75, v12, v75
  v_mfma_f32_16x16x32_bf16 v[88:91], v[24:27], v[136:139], v[88:91]
  ds_read_b128 v[48:51], v19 offset:16640
  v_mul_f32 v76, v12, v76
  v_mfma_f32_16x16x32_bf16 v[96:99], v[24:27], v[168:171], v[96:99]
  v_mul_f32 v77, v12, v77
  v_mul_f32 v78, v12, v78
  v_mfma_f32_16x16x32_bf16 v[104:107], v[24:27], v[200:203], v[104:107]
  v_mul_f32 v79, v12, v79
  v_mfma_f32_16x16x32_bf16 v[112:115], v[24:27], v[232:235], v[112:115]
  s_waitcnt lgkmcnt(5)
  v_cvt_pk_bf16_f32 v72, v72, v73
  v_mfma_f32_16x16x32_bf16 v[92:95], v[28:31], v[136:139], v[92:95]
  ds_read_b128 v[52:55], v19 offset:18688
  v_cvt_pk_bf16_f32 v73, v74, v75
  v_mfma_f32_16x16x32_bf16 v[100:103], v[28:31], v[168:171], v[100:103]
  v_cvt_pk_bf16_f32 v74, v76, v77
  v_cvt_pk_bf16_f32 v75, v78, v79
  v_mfma_f32_16x16x32_bf16 v[108:111], v[28:31], v[200:203], v[108:111]
  v_accvgpr_write_b32 a144, v72
  v_mfma_f32_16x16x32_bf16 v[116:119], v[28:31], v[232:235], v[116:119]
  s_waitcnt lgkmcnt(5)
  v_accvgpr_write_b32 a145, v73
  v_mfma_f32_16x16x32_bf16 v[88:91], v[32:35], v[140:143], v[88:91]
  s_waitcnt vmcnt(12)
  s_barrier
  ds_read_b128 v[24:27], v248 offset:0
  v_accvgpr_write_b32 a146, v74
  v_mfma_f32_16x16x32_bf16 v[96:99], v[32:35], v[172:175], v[96:99]
  v_accvgpr_write_b32 a147, v75
  v_mul_f32 v80, v12, v80
  v_mfma_f32_16x16x32_bf16 v[104:107], v[32:35], v[204:207], v[104:107]
  v_mul_f32 v81, v12, v81
  v_mfma_f32_16x16x32_bf16 v[112:115], v[32:35], v[236:239], v[112:115]
  s_waitcnt lgkmcnt(5)
  v_mul_f32 v82, v12, v82
  v_mfma_f32_16x16x32_bf16 v[92:95], v[36:39], v[140:143], v[92:95]
  ds_read_b128 v[28:31], v248 offset:2048
  v_mul_f32 v83, v12, v83
  v_mfma_f32_16x16x32_bf16 v[100:103], v[36:39], v[172:175], v[100:103]
  v_mul_f32 v84, v12, v84
  v_mul_f32 v85, v12, v85
  v_mfma_f32_16x16x32_bf16 v[108:111], v[36:39], v[204:207], v[108:111]
  v_mul_f32 v86, v12, v86
  v_mfma_f32_16x16x32_bf16 v[116:119], v[36:39], v[236:239], v[116:119]
  s_waitcnt lgkmcnt(5)
  v_mul_f32 v87, v12, v87
  v_mfma_f32_16x16x32_bf16 v[88:91], v[40:43], v[144:147], v[88:91]
  ds_read_b128 v[32:35], v249 offset:0
  v_cvt_pk_bf16_f32 v80, v80, v81
  v_mfma_f32_16x16x32_bf16 v[96:99], v[40:43], v[176:179], v[96:99]
  v_cvt_pk_bf16_f32 v81, v82, v83
  v_cvt_pk_bf16_f32 v82, v84, v85
  v_mfma_f32_16x16x32_bf16 v[104:107], v[40:43], v[208:211], v[104:107]
  v_cvt_pk_bf16_f32 v83, v86, v87
  v_mfma_f32_16x16x32_bf16 v[112:115], v[40:43], v[240:243], v[112:115]
  s_waitcnt lgkmcnt(5)
  v_accvgpr_write_b32 a200, v80
  v_mfma_f32_16x16x32_bf16 v[92:95], v[44:47], v[144:147], v[92:95]
  ds_read_b128 v[36:39], v249 offset:2048
  v_accvgpr_write_b32 a201, v81
  v_mfma_f32_16x16x32_bf16 v[100:103], v[44:47], v[176:179], v[100:103]
  v_accvgpr_write_b32 a202, v82
  v_accvgpr_write_b32 a203, v83
  v_mfma_f32_16x16x32_bf16 v[108:111], v[44:47], v[208:211], v[108:111]
  v_mfma_f32_16x16x32_bf16 v[116:119], v[44:47], v[240:243], v[116:119]
  s_waitcnt lgkmcnt(5)
  v_mfma_f32_16x16x32_bf16 v[88:91], v[48:51], v[148:151], v[88:91]
  ds_read_b128 v[40:43], v250 offset:0
  v_mfma_f32_16x16x32_bf16 v[96:99], v[48:51], v[180:183], v[96:99]
  v_mfma_f32_16x16x32_bf16 v[104:107], v[48:51], v[212:215], v[104:107]
  v_mfma_f32_16x16x32_bf16 v[112:115], v[48:51], v[244:247], v[112:115]
  s_waitcnt lgkmcnt(5)
  v_mfma_f32_16x16x32_bf16 v[92:95], v[52:55], v[148:151], v[92:95]
  ds_read_b128 v[44:47], v250 offset:2048
  v_mfma_f32_16x16x32_bf16 v[100:103], v[52:55], v[180:183], v[100:103]
  v_mfma_f32_16x16x32_bf16 v[108:111], v[52:55], v[212:215], v[108:111]
  v_mfma_f32_16x16x32_bf16 v[116:119], v[52:55], v[244:247], v[116:119]
  s_waitcnt lgkmcnt(5)
  v_mfma_f32_16x16x32_bf16 v[56:59], v[24:27], v[120:123], 0
  ds_read_b128 v[48:51], v251 offset:0
  v_mfma_f32_16x16x32_bf16 v[64:67], v[24:27], v[152:155], 0
  v_mfma_f32_16x16x32_bf16 v[72:75], v[24:27], v[184:187], 0
  v_mfma_f32_16x16x32_bf16 v[80:83], v[24:27], v[216:219], 0
  s_waitcnt lgkmcnt(5)
  v_mul_f32 v88, v12, v88
  v_mfma_f32_16x16x32_bf16 v[60:63], v[28:31], v[120:123], 0
  ds_read_b128 v[52:55], v251 offset:2048
  v_mul_f32 v89, v12, v89
  v_mfma_f32_16x16x32_bf16 v[68:71], v[28:31], v[152:155], 0
  v_mul_f32 v90, v12, v90
  v_mul_f32 v91, v12, v91
  v_mfma_f32_16x16x32_bf16 v[76:79], v[28:31], v[184:187], 0
  v_mul_f32 v92, v12, v92
  v_mfma_f32_16x16x32_bf16 v[84:87], v[28:31], v[216:219], 0
  s_waitcnt lgkmcnt(5)
  v_mul_f32 v93, v12, v93
  v_mfma_f32_16x16x32_bf16 v[56:59], v[32:35], v[124:127], v[56:59]
  ds_read_b128 v[24:27], v248 offset:256
  v_mul_f32 v94, v12, v94
  v_mfma_f32_16x16x32_bf16 v[64:67], v[32:35], v[156:159], v[64:67]
  v_mul_f32 v95, v12, v95
  v_cvt_pk_bf16_f32 v88, v88, v89
  v_mfma_f32_16x16x32_bf16 v[72:75], v[32:35], v[188:191], v[72:75]
  v_cvt_pk_bf16_f32 v89, v90, v91
  v_mfma_f32_16x16x32_bf16 v[80:83], v[32:35], v[220:223], v[80:83]
  s_waitcnt lgkmcnt(5)
  v_cvt_pk_bf16_f32 v90, v92, v93
  v_mfma_f32_16x16x32_bf16 v[60:63], v[36:39], v[124:127], v[60:63]
  ds_read_b128 v[28:31], v248 offset:2304
  v_cvt_pk_bf16_f32 v91, v94, v95
  v_mfma_f32_16x16x32_bf16 v[68:71], v[36:39], v[156:159], v[68:71]
  v_accvgpr_write_b32 a36, v88
  v_accvgpr_write_b32 a37, v89
  v_mfma_f32_16x16x32_bf16 v[76:79], v[36:39], v[188:191], v[76:79]
  v_accvgpr_write_b32 a38, v90
  v_mfma_f32_16x16x32_bf16 v[84:87], v[36:39], v[220:223], v[84:87]
  s_waitcnt lgkmcnt(5)
  v_accvgpr_write_b32 a39, v91
  v_mfma_f32_16x16x32_bf16 v[56:59], v[40:43], v[128:131], v[56:59]
  ds_read_b128 v[32:35], v249 offset:256
  v_mul_f32 v96, v12, v96
  v_mfma_f32_16x16x32_bf16 v[64:67], v[40:43], v[160:163], v[64:67]
  v_mul_f32 v97, v12, v97
  v_mul_f32 v98, v12, v98
  v_mfma_f32_16x16x32_bf16 v[72:75], v[40:43], v[192:195], v[72:75]
  v_mul_f32 v99, v12, v99
  v_mfma_f32_16x16x32_bf16 v[80:83], v[40:43], v[224:227], v[80:83]
  s_waitcnt lgkmcnt(5)
  v_mul_f32 v100, v12, v100
  v_mfma_f32_16x16x32_bf16 v[60:63], v[44:47], v[128:131], v[60:63]
  ds_read_b128 v[36:39], v249 offset:2304
  v_mul_f32 v101, v12, v101
  v_mfma_f32_16x16x32_bf16 v[68:71], v[44:47], v[160:163], v[68:71]
  v_mul_f32 v102, v12, v102
  v_mul_f32 v103, v12, v103
  v_mfma_f32_16x16x32_bf16 v[76:79], v[44:47], v[192:195], v[76:79]
  v_cvt_pk_bf16_f32 v96, v96, v97
  v_mfma_f32_16x16x32_bf16 v[84:87], v[44:47], v[224:227], v[84:87]
  s_waitcnt lgkmcnt(5)
  v_cvt_pk_bf16_f32 v97, v98, v99
  v_mfma_f32_16x16x32_bf16 v[56:59], v[48:51], v[132:135], v[56:59]
  ds_read_b128 v[40:43], v250 offset:256
  v_cvt_pk_bf16_f32 v98, v100, v101
  v_mfma_f32_16x16x32_bf16 v[64:67], v[48:51], v[164:167], v[64:67]
  v_cvt_pk_bf16_f32 v99, v102, v103
  v_accvgpr_write_b32 a92, v96
  v_mfma_f32_16x16x32_bf16 v[72:75], v[48:51], v[196:199], v[72:75]
  v_accvgpr_write_b32 a93, v97
  v_mfma_f32_16x16x32_bf16 v[80:83], v[48:51], v[228:231], v[80:83]
  s_waitcnt lgkmcnt(5)
  v_accvgpr_write_b32 a94, v98
  v_mfma_f32_16x16x32_bf16 v[60:63], v[52:55], v[132:135], v[60:63]
  ds_read_b128 v[44:47], v250 offset:2304
  v_accvgpr_write_b32 a95, v99
  v_mfma_f32_16x16x32_bf16 v[68:71], v[52:55], v[164:167], v[68:71]
  v_mul_f32 v104, v12, v104
  v_mul_f32 v105, v12, v105
  v_mfma_f32_16x16x32_bf16 v[76:79], v[52:55], v[196:199], v[76:79]
  v_mul_f32 v106, v12, v106
  v_mfma_f32_16x16x32_bf16 v[84:87], v[52:55], v[228:231], v[84:87]
  s_waitcnt lgkmcnt(5)
  v_mul_f32 v107, v12, v107
  v_mfma_f32_16x16x32_bf16 v[56:59], v[24:27], v[136:139], v[56:59]
  ds_read_b128 v[48:51], v251 offset:256
  v_mul_f32 v108, v12, v108
  v_mfma_f32_16x16x32_bf16 v[64:67], v[24:27], v[168:171], v[64:67]
  v_mul_f32 v109, v12, v109
  v_mul_f32 v110, v12, v110
  v_mfma_f32_16x16x32_bf16 v[72:75], v[24:27], v[200:203], v[72:75]
  v_mul_f32 v111, v12, v111
  v_mfma_f32_16x16x32_bf16 v[80:83], v[24:27], v[232:235], v[80:83]
  s_waitcnt lgkmcnt(5)
  v_cvt_pk_bf16_f32 v104, v104, v105
  v_mfma_f32_16x16x32_bf16 v[60:63], v[28:31], v[136:139], v[60:63]
  ds_read_b128 v[52:55], v251 offset:2304
  v_cvt_pk_bf16_f32 v105, v106, v107
  v_mfma_f32_16x16x32_bf16 v[68:71], v[28:31], v[168:171], v[68:71]
  v_cvt_pk_bf16_f32 v106, v108, v109
  v_cvt_pk_bf16_f32 v107, v110, v111
  v_mfma_f32_16x16x32_bf16 v[76:79], v[28:31], v[200:203], v[76:79]
  v_accvgpr_write_b32 a148, v104
  v_mfma_f32_16x16x32_bf16 v[84:87], v[28:31], v[232:235], v[84:87]
  s_waitcnt lgkmcnt(5)
  v_accvgpr_write_b32 a149, v105
  v_mfma_f32_16x16x32_bf16 v[56:59], v[32:35], v[140:143], v[56:59]
  s_waitcnt vmcnt(8)
  s_barrier
  ds_read_b128 v[24:27], v248 offset:16384
  v_accvgpr_write_b32 a150, v106
  v_mfma_f32_16x16x32_bf16 v[64:67], v[32:35], v[172:175], v[64:67]
  v_accvgpr_write_b32 a151, v107
  v_mul_f32 v112, v12, v112
  v_mfma_f32_16x16x32_bf16 v[72:75], v[32:35], v[204:207], v[72:75]
  v_mul_f32 v113, v12, v113
  v_mfma_f32_16x16x32_bf16 v[80:83], v[32:35], v[236:239], v[80:83]
  s_waitcnt lgkmcnt(5)
  v_mul_f32 v114, v12, v114
  v_mfma_f32_16x16x32_bf16 v[60:63], v[36:39], v[140:143], v[60:63]
  ds_read_b128 v[28:31], v248 offset:18432
  v_mul_f32 v115, v12, v115
  v_mfma_f32_16x16x32_bf16 v[68:71], v[36:39], v[172:175], v[68:71]
  v_mul_f32 v116, v12, v116
  v_mul_f32 v117, v12, v117
  v_mfma_f32_16x16x32_bf16 v[76:79], v[36:39], v[204:207], v[76:79]
  v_mul_f32 v118, v12, v118
  v_mfma_f32_16x16x32_bf16 v[84:87], v[36:39], v[236:239], v[84:87]
  s_waitcnt lgkmcnt(5)
  v_mul_f32 v119, v12, v119
  v_mfma_f32_16x16x32_bf16 v[56:59], v[40:43], v[144:147], v[56:59]
  ds_read_b128 v[32:35], v249 offset:16384
  v_cvt_pk_bf16_f32 v112, v112, v113
  v_mfma_f32_16x16x32_bf16 v[64:67], v[40:43], v[176:179], v[64:67]
  v_cvt_pk_bf16_f32 v113, v114, v115
  v_cvt_pk_bf16_f32 v114, v116, v117
  v_mfma_f32_16x16x32_bf16 v[72:75], v[40:43], v[208:211], v[72:75]
  v_cvt_pk_bf16_f32 v115, v118, v119
  v_mfma_f32_16x16x32_bf16 v[80:83], v[40:43], v[240:243], v[80:83]
  s_waitcnt lgkmcnt(5)
  v_accvgpr_write_b32 a204, v112
  v_mfma_f32_16x16x32_bf16 v[60:63], v[44:47], v[144:147], v[60:63]
  ds_read_b128 v[36:39], v249 offset:18432
  v_accvgpr_write_b32 a205, v113
  v_mfma_f32_16x16x32_bf16 v[68:71], v[44:47], v[176:179], v[68:71]
  v_accvgpr_write_b32 a206, v114
  v_accvgpr_write_b32 a207, v115
  v_mfma_f32_16x16x32_bf16 v[76:79], v[44:47], v[208:211], v[76:79]
  v_mfma_f32_16x16x32_bf16 v[84:87], v[44:47], v[240:243], v[84:87]
  s_waitcnt lgkmcnt(5)
  v_mfma_f32_16x16x32_bf16 v[56:59], v[48:51], v[148:151], v[56:59]
  ds_read_b128 v[40:43], v250 offset:16384
  v_mfma_f32_16x16x32_bf16 v[64:67], v[48:51], v[180:183], v[64:67]
  v_mfma_f32_16x16x32_bf16 v[72:75], v[48:51], v[212:215], v[72:75]
  v_mfma_f32_16x16x32_bf16 v[80:83], v[48:51], v[244:247], v[80:83]
  s_waitcnt lgkmcnt(5)
  v_mfma_f32_16x16x32_bf16 v[60:63], v[52:55], v[148:151], v[60:63]
  ds_read_b128 v[44:47], v250 offset:18432
  v_mfma_f32_16x16x32_bf16 v[68:71], v[52:55], v[180:183], v[68:71]
  v_mfma_f32_16x16x32_bf16 v[76:79], v[52:55], v[212:215], v[76:79]
  v_mfma_f32_16x16x32_bf16 v[84:87], v[52:55], v[244:247], v[84:87]
  s_waitcnt lgkmcnt(5)
  v_mfma_f32_16x16x32_bf16 v[88:91], v[24:27], v[120:123], 0
  ds_read_b128 v[48:51], v251 offset:16384
  v_mfma_f32_16x16x32_bf16 v[96:99], v[24:27], v[152:155], 0
  v_mfma_f32_16x16x32_bf16 v[104:107], v[24:27], v[184:187], 0
  v_mfma_f32_16x16x32_bf16 v[112:115], v[24:27], v[216:219], 0
  s_waitcnt lgkmcnt(5)
  v_mul_f32 v56, v12, v56
  v_mfma_f32_16x16x32_bf16 v[92:95], v[28:31], v[120:123], 0
  ds_read_b128 v[52:55], v251 offset:18432
  v_mul_f32 v57, v12, v57
  v_mfma_f32_16x16x32_bf16 v[100:103], v[28:31], v[152:155], 0
  v_mul_f32 v58, v12, v58
  v_mul_f32 v59, v12, v59
  v_mfma_f32_16x16x32_bf16 v[108:111], v[28:31], v[184:187], 0
  v_mul_f32 v60, v12, v60
  v_mfma_f32_16x16x32_bf16 v[116:119], v[28:31], v[216:219], 0
  s_waitcnt lgkmcnt(5)
  v_mul_f32 v61, v12, v61
  v_mfma_f32_16x16x32_bf16 v[88:91], v[32:35], v[124:127], v[88:91]
  ds_read_b128 v[24:27], v248 offset:16640
  v_mul_f32 v62, v12, v62
  v_mfma_f32_16x16x32_bf16 v[96:99], v[32:35], v[156:159], v[96:99]
  v_mul_f32 v63, v12, v63
  v_cvt_pk_bf16_f32 v56, v56, v57
  v_mfma_f32_16x16x32_bf16 v[104:107], v[32:35], v[188:191], v[104:107]
  v_cvt_pk_bf16_f32 v57, v58, v59
  v_mfma_f32_16x16x32_bf16 v[112:115], v[32:35], v[220:223], v[112:115]
  s_waitcnt lgkmcnt(5)
  v_cvt_pk_bf16_f32 v58, v60, v61
  v_mfma_f32_16x16x32_bf16 v[92:95], v[36:39], v[124:127], v[92:95]
  ds_read_b128 v[28:31], v248 offset:18688
  v_cvt_pk_bf16_f32 v59, v62, v63
  v_mfma_f32_16x16x32_bf16 v[100:103], v[36:39], v[156:159], v[100:103]
  v_accvgpr_write_b32 a40, v56
  v_accvgpr_write_b32 a41, v57
  v_mfma_f32_16x16x32_bf16 v[108:111], v[36:39], v[188:191], v[108:111]
  v_accvgpr_write_b32 a42, v58
  v_mfma_f32_16x16x32_bf16 v[116:119], v[36:39], v[220:223], v[116:119]
  s_waitcnt lgkmcnt(5)
  v_accvgpr_write_b32 a43, v59
  v_mfma_f32_16x16x32_bf16 v[88:91], v[40:43], v[128:131], v[88:91]
  ds_read_b128 v[32:35], v249 offset:16640
  v_mul_f32 v64, v12, v64
  v_mfma_f32_16x16x32_bf16 v[96:99], v[40:43], v[160:163], v[96:99]
  v_mul_f32 v65, v12, v65
  v_mul_f32 v66, v12, v66
  v_mfma_f32_16x16x32_bf16 v[104:107], v[40:43], v[192:195], v[104:107]
  v_mul_f32 v67, v12, v67
  v_mfma_f32_16x16x32_bf16 v[112:115], v[40:43], v[224:227], v[112:115]
  s_waitcnt lgkmcnt(5)
  v_mul_f32 v68, v12, v68
  v_mfma_f32_16x16x32_bf16 v[92:95], v[44:47], v[128:131], v[92:95]
  ds_read_b128 v[36:39], v249 offset:18688
  v_mul_f32 v69, v12, v69
  v_mfma_f32_16x16x32_bf16 v[100:103], v[44:47], v[160:163], v[100:103]
  v_mul_f32 v70, v12, v70
  v_mul_f32 v71, v12, v71
  v_mfma_f32_16x16x32_bf16 v[108:111], v[44:47], v[192:195], v[108:111]
  v_cvt_pk_bf16_f32 v64, v64, v65
  v_mfma_f32_16x16x32_bf16 v[116:119], v[44:47], v[224:227], v[116:119]
  s_waitcnt lgkmcnt(5)
  v_cvt_pk_bf16_f32 v65, v66, v67
  v_mfma_f32_16x16x32_bf16 v[88:91], v[48:51], v[132:135], v[88:91]
  ds_read_b128 v[40:43], v250 offset:16640
  v_cvt_pk_bf16_f32 v66, v68, v69
  v_mfma_f32_16x16x32_bf16 v[96:99], v[48:51], v[164:167], v[96:99]
  v_cvt_pk_bf16_f32 v67, v70, v71
  v_accvgpr_write_b32 a96, v64
  v_mfma_f32_16x16x32_bf16 v[104:107], v[48:51], v[196:199], v[104:107]
  v_accvgpr_write_b32 a97, v65
  v_mfma_f32_16x16x32_bf16 v[112:115], v[48:51], v[228:231], v[112:115]
  s_waitcnt lgkmcnt(5)
  v_accvgpr_write_b32 a98, v66
  v_mfma_f32_16x16x32_bf16 v[92:95], v[52:55], v[132:135], v[92:95]
  ds_read_b128 v[44:47], v250 offset:18688
  v_accvgpr_write_b32 a99, v67
  v_mfma_f32_16x16x32_bf16 v[100:103], v[52:55], v[164:167], v[100:103]
  v_mul_f32 v72, v12, v72
  v_mul_f32 v73, v12, v73
  v_mfma_f32_16x16x32_bf16 v[108:111], v[52:55], v[196:199], v[108:111]
  v_mul_f32 v74, v12, v74
  v_mfma_f32_16x16x32_bf16 v[116:119], v[52:55], v[228:231], v[116:119]
  s_waitcnt lgkmcnt(5)
  v_mul_f32 v75, v12, v75
  v_mfma_f32_16x16x32_bf16 v[88:91], v[24:27], v[136:139], v[88:91]
  ds_read_b128 v[48:51], v251 offset:16640
  v_mul_f32 v76, v12, v76
  v_mfma_f32_16x16x32_bf16 v[96:99], v[24:27], v[168:171], v[96:99]
  v_mul_f32 v77, v12, v77
  v_mul_f32 v78, v12, v78
  v_mfma_f32_16x16x32_bf16 v[104:107], v[24:27], v[200:203], v[104:107]
  v_mul_f32 v79, v12, v79
  v_mfma_f32_16x16x32_bf16 v[112:115], v[24:27], v[232:235], v[112:115]
  s_waitcnt lgkmcnt(5)
  v_cvt_pk_bf16_f32 v72, v72, v73
  v_mfma_f32_16x16x32_bf16 v[92:95], v[28:31], v[136:139], v[92:95]
  ds_read_b128 v[52:55], v251 offset:18688
  v_cvt_pk_bf16_f32 v73, v74, v75
  v_mfma_f32_16x16x32_bf16 v[100:103], v[28:31], v[168:171], v[100:103]
  v_cvt_pk_bf16_f32 v74, v76, v77
  v_cvt_pk_bf16_f32 v75, v78, v79
  v_mfma_f32_16x16x32_bf16 v[108:111], v[28:31], v[200:203], v[108:111]
  v_accvgpr_write_b32 a152, v72
  v_mfma_f32_16x16x32_bf16 v[116:119], v[28:31], v[232:235], v[116:119]
  s_waitcnt lgkmcnt(5)
  v_accvgpr_write_b32 a153, v73
  v_mfma_f32_16x16x32_bf16 v[88:91], v[32:35], v[140:143], v[88:91]
  s_waitcnt vmcnt(4)
  s_barrier
  ds_read_b128 v[24:27], v248 offset:32768
  v_accvgpr_write_b32 a154, v74
  v_mfma_f32_16x16x32_bf16 v[96:99], v[32:35], v[172:175], v[96:99]
  v_accvgpr_write_b32 a155, v75
  v_mul_f32 v80, v12, v80
  v_mfma_f32_16x16x32_bf16 v[104:107], v[32:35], v[204:207], v[104:107]
  v_mul_f32 v81, v12, v81
  v_mfma_f32_16x16x32_bf16 v[112:115], v[32:35], v[236:239], v[112:115]
  s_waitcnt lgkmcnt(5)
  v_mul_f32 v82, v12, v82
  v_mfma_f32_16x16x32_bf16 v[92:95], v[36:39], v[140:143], v[92:95]
  ds_read_b128 v[28:31], v248 offset:34816
  v_mul_f32 v83, v12, v83
  v_mfma_f32_16x16x32_bf16 v[100:103], v[36:39], v[172:175], v[100:103]
  v_mul_f32 v84, v12, v84
  v_mul_f32 v85, v12, v85
  v_mfma_f32_16x16x32_bf16 v[108:111], v[36:39], v[204:207], v[108:111]
  v_mul_f32 v86, v12, v86
  v_mfma_f32_16x16x32_bf16 v[116:119], v[36:39], v[236:239], v[116:119]
  s_waitcnt lgkmcnt(5)
  v_mul_f32 v87, v12, v87
  v_mfma_f32_16x16x32_bf16 v[88:91], v[40:43], v[144:147], v[88:91]
  ds_read_b128 v[32:35], v249 offset:32768
  v_cvt_pk_bf16_f32 v80, v80, v81
  v_mfma_f32_16x16x32_bf16 v[96:99], v[40:43], v[176:179], v[96:99]
  v_cvt_pk_bf16_f32 v81, v82, v83
  v_cvt_pk_bf16_f32 v82, v84, v85
  v_mfma_f32_16x16x32_bf16 v[104:107], v[40:43], v[208:211], v[104:107]
  v_cvt_pk_bf16_f32 v83, v86, v87
  v_mfma_f32_16x16x32_bf16 v[112:115], v[40:43], v[240:243], v[112:115]
  s_waitcnt lgkmcnt(5)
  v_accvgpr_write_b32 a208, v80
  v_mfma_f32_16x16x32_bf16 v[92:95], v[44:47], v[144:147], v[92:95]
  ds_read_b128 v[36:39], v249 offset:34816
  v_accvgpr_write_b32 a209, v81
  v_mfma_f32_16x16x32_bf16 v[100:103], v[44:47], v[176:179], v[100:103]
  v_accvgpr_write_b32 a210, v82
  v_accvgpr_write_b32 a211, v83
  v_mfma_f32_16x16x32_bf16 v[108:111], v[44:47], v[208:211], v[108:111]
  v_mfma_f32_16x16x32_bf16 v[116:119], v[44:47], v[240:243], v[116:119]
  s_waitcnt lgkmcnt(5)
  v_mfma_f32_16x16x32_bf16 v[88:91], v[48:51], v[148:151], v[88:91]
  ds_read_b128 v[40:43], v250 offset:32768
  v_mfma_f32_16x16x32_bf16 v[96:99], v[48:51], v[180:183], v[96:99]
  v_mfma_f32_16x16x32_bf16 v[104:107], v[48:51], v[212:215], v[104:107]
  v_mfma_f32_16x16x32_bf16 v[112:115], v[48:51], v[244:247], v[112:115]
  s_waitcnt lgkmcnt(5)
  v_mfma_f32_16x16x32_bf16 v[92:95], v[52:55], v[148:151], v[92:95]
  ds_read_b128 v[44:47], v250 offset:34816
  v_mfma_f32_16x16x32_bf16 v[100:103], v[52:55], v[180:183], v[100:103]
  v_mfma_f32_16x16x32_bf16 v[108:111], v[52:55], v[212:215], v[108:111]
  v_mfma_f32_16x16x32_bf16 v[116:119], v[52:55], v[244:247], v[116:119]
  s_waitcnt lgkmcnt(5)
  v_mfma_f32_16x16x32_bf16 v[56:59], v[24:27], v[120:123], 0
  ds_read_b128 v[48:51], v251 offset:32768
  v_mfma_f32_16x16x32_bf16 v[64:67], v[24:27], v[152:155], 0
  v_mfma_f32_16x16x32_bf16 v[72:75], v[24:27], v[184:187], 0
  v_mfma_f32_16x16x32_bf16 v[80:83], v[24:27], v[216:219], 0
  s_waitcnt lgkmcnt(5)
  v_mul_f32 v88, v12, v88
  v_mfma_f32_16x16x32_bf16 v[60:63], v[28:31], v[120:123], 0
  ds_read_b128 v[52:55], v251 offset:34816
  v_mul_f32 v89, v12, v89
  v_mfma_f32_16x16x32_bf16 v[68:71], v[28:31], v[152:155], 0
  v_mul_f32 v90, v12, v90
  v_mul_f32 v91, v12, v91
  v_mfma_f32_16x16x32_bf16 v[76:79], v[28:31], v[184:187], 0
  v_mul_f32 v92, v12, v92
  v_mfma_f32_16x16x32_bf16 v[84:87], v[28:31], v[216:219], 0
  s_waitcnt lgkmcnt(5)
  v_mul_f32 v93, v12, v93
  v_mfma_f32_16x16x32_bf16 v[56:59], v[32:35], v[124:127], v[56:59]
  ds_read_b128 v[24:27], v248 offset:33024
  v_mul_f32 v94, v12, v94
  v_mfma_f32_16x16x32_bf16 v[64:67], v[32:35], v[156:159], v[64:67]
  v_mul_f32 v95, v12, v95
  v_cvt_pk_bf16_f32 v88, v88, v89
  v_mfma_f32_16x16x32_bf16 v[72:75], v[32:35], v[188:191], v[72:75]
  v_mfma_f32_16x16x32_bf16 v[80:83], v[32:35], v[220:223], v[80:83]
  s_waitcnt lgkmcnt(5)
  v_cvt_pk_bf16_f32 v89, v90, v91
  v_mfma_f32_16x16x32_bf16 v[60:63], v[36:39], v[124:127], v[60:63]
  ds_read_b128 v[28:31], v248 offset:35072
  v_cvt_pk_bf16_f32 v90, v92, v93
  v_mfma_f32_16x16x32_bf16 v[68:71], v[36:39], v[156:159], v[68:71]
  v_cvt_pk_bf16_f32 v91, v94, v95
  v_accvgpr_write_b32 a44, v88
  v_mfma_f32_16x16x32_bf16 v[76:79], v[36:39], v[188:191], v[76:79]
  v_accvgpr_write_b32 a45, v89
  v_mfma_f32_16x16x32_bf16 v[84:87], v[36:39], v[220:223], v[84:87]
  s_waitcnt lgkmcnt(5)
  v_accvgpr_write_b32 a46, v90
  v_mfma_f32_16x16x32_bf16 v[56:59], v[40:43], v[128:131], v[56:59]
  ds_read_b128 v[32:35], v249 offset:33024
  v_accvgpr_write_b32 a47, v91
  v_mfma_f32_16x16x32_bf16 v[64:67], v[40:43], v[160:163], v[64:67]
  v_mul_f32 v96, v12, v96
  v_mul_f32 v97, v12, v97
  v_mfma_f32_16x16x32_bf16 v[72:75], v[40:43], v[192:195], v[72:75]
  v_mfma_f32_16x16x32_bf16 v[80:83], v[40:43], v[224:227], v[80:83]
  s_waitcnt lgkmcnt(5)
  v_mul_f32 v98, v12, v98
  v_mfma_f32_16x16x32_bf16 v[60:63], v[44:47], v[128:131], v[60:63]
  ds_read_b128 v[36:39], v249 offset:35072
  v_mul_f32 v99, v12, v99
  v_mfma_f32_16x16x32_bf16 v[68:71], v[44:47], v[160:163], v[68:71]
  v_mul_f32 v100, v12, v100
  v_mul_f32 v101, v12, v101
  v_mfma_f32_16x16x32_bf16 v[76:79], v[44:47], v[192:195], v[76:79]
  v_mul_f32 v102, v12, v102
  v_mfma_f32_16x16x32_bf16 v[84:87], v[44:47], v[224:227], v[84:87]
  s_waitcnt lgkmcnt(5)
  v_mul_f32 v103, v12, v103
  v_mfma_f32_16x16x32_bf16 v[56:59], v[48:51], v[132:135], v[56:59]
  ds_read_b128 v[40:43], v250 offset:33024
  v_cvt_pk_bf16_f32 v96, v96, v97
  v_mfma_f32_16x16x32_bf16 v[64:67], v[48:51], v[164:167], v[64:67]
  v_cvt_pk_bf16_f32 v97, v98, v99
  v_cvt_pk_bf16_f32 v98, v100, v101
  v_mfma_f32_16x16x32_bf16 v[72:75], v[48:51], v[196:199], v[72:75]
  v_mfma_f32_16x16x32_bf16 v[80:83], v[48:51], v[228:231], v[80:83]
  s_waitcnt lgkmcnt(5)
  v_cvt_pk_bf16_f32 v99, v102, v103
  v_mfma_f32_16x16x32_bf16 v[60:63], v[52:55], v[132:135], v[60:63]
  ds_read_b128 v[44:47], v250 offset:35072
  v_accvgpr_write_b32 a100, v96
  v_mfma_f32_16x16x32_bf16 v[68:71], v[52:55], v[164:167], v[68:71]
  v_accvgpr_write_b32 a101, v97
  v_accvgpr_write_b32 a102, v98
  v_mfma_f32_16x16x32_bf16 v[76:79], v[52:55], v[196:199], v[76:79]
  v_accvgpr_write_b32 a103, v99
  v_mfma_f32_16x16x32_bf16 v[84:87], v[52:55], v[228:231], v[84:87]
  s_waitcnt lgkmcnt(5)
  v_mul_f32 v104, v12, v104
  v_mfma_f32_16x16x32_bf16 v[56:59], v[24:27], v[136:139], v[56:59]
  ds_read_b128 v[48:51], v251 offset:33024
  v_mul_f32 v105, v12, v105
  v_mfma_f32_16x16x32_bf16 v[64:67], v[24:27], v[168:171], v[64:67]
  v_mul_f32 v106, v12, v106
  v_mul_f32 v107, v12, v107
  v_mfma_f32_16x16x32_bf16 v[72:75], v[24:27], v[200:203], v[72:75]
  v_mfma_f32_16x16x32_bf16 v[80:83], v[24:27], v[232:235], v[80:83]
  s_waitcnt lgkmcnt(5)
  v_mul_f32 v108, v12, v108
  v_mfma_f32_16x16x32_bf16 v[60:63], v[28:31], v[136:139], v[60:63]
  ds_read_b128 v[52:55], v251 offset:35072
  v_mul_f32 v109, v12, v109
  v_mfma_f32_16x16x32_bf16 v[68:71], v[28:31], v[168:171], v[68:71]
  v_mul_f32 v110, v12, v110
  v_mul_f32 v111, v12, v111
  v_mfma_f32_16x16x32_bf16 v[76:79], v[28:31], v[200:203], v[76:79]
  v_cvt_pk_bf16_f32 v104, v104, v105
  v_mfma_f32_16x16x32_bf16 v[84:87], v[28:31], v[232:235], v[84:87]
  s_waitcnt lgkmcnt(5)
  v_cvt_pk_bf16_f32 v105, v106, v107
  v_mfma_f32_16x16x32_bf16 v[56:59], v[32:35], v[140:143], v[56:59]
  s_waitcnt vmcnt(0)
  s_barrier
  ds_read_b128 v[24:27], v248 offset:49152
  v_cvt_pk_bf16_f32 v106, v108, v109
  v_mfma_f32_16x16x32_bf16 v[64:67], v[32:35], v[172:175], v[64:67]
  v_cvt_pk_bf16_f32 v107, v110, v111
  v_accvgpr_write_b32 a156, v104
  v_mfma_f32_16x16x32_bf16 v[72:75], v[32:35], v[204:207], v[72:75]
  v_mfma_f32_16x16x32_bf16 v[80:83], v[32:35], v[236:239], v[80:83]
  s_waitcnt lgkmcnt(5)
  v_accvgpr_write_b32 a157, v105
  v_mfma_f32_16x16x32_bf16 v[60:63], v[36:39], v[140:143], v[60:63]
  ds_read_b128 v[28:31], v248 offset:51200
  v_accvgpr_write_b32 a158, v106
  v_mfma_f32_16x16x32_bf16 v[68:71], v[36:39], v[172:175], v[68:71]
  v_accvgpr_write_b32 a159, v107
  v_mul_f32 v112, v12, v112
  v_mfma_f32_16x16x32_bf16 v[76:79], v[36:39], v[204:207], v[76:79]
  v_mul_f32 v113, v12, v113
  v_mfma_f32_16x16x32_bf16 v[84:87], v[36:39], v[236:239], v[84:87]
  s_waitcnt lgkmcnt(5)
  v_mul_f32 v114, v12, v114
  v_mfma_f32_16x16x32_bf16 v[56:59], v[40:43], v[144:147], v[56:59]
  ds_read_b128 v[32:35], v249 offset:49152
  v_mul_f32 v115, v12, v115
  v_mfma_f32_16x16x32_bf16 v[64:67], v[40:43], v[176:179], v[64:67]
  v_mul_f32 v116, v12, v116
  v_mul_f32 v117, v12, v117
  v_mfma_f32_16x16x32_bf16 v[72:75], v[40:43], v[208:211], v[72:75]
  v_readfirstlane_b32 s86, v13
  s_lshl_b32 s22, s17, 7
  s_add_u32 s22, s22, 584192
  s_mov_b32 s23, 586240
  buffer_load_dword v13, off, s[8:11], s22 sc1
  buffer_load_dwordx2 v[10:11], off, s[8:11], s23 sc1
  v_mfma_f32_16x16x32_bf16 v[80:83], v[40:43], v[240:243], v[80:83]
  s_waitcnt lgkmcnt(5)
  v_mul_f32 v118, v12, v118
  v_mfma_f32_16x16x32_bf16 v[60:63], v[44:47], v[144:147], v[60:63]
  ds_read_b128 v[36:39], v249 offset:51200
  v_mul_f32 v119, v12, v119
  v_mfma_f32_16x16x32_bf16 v[68:71], v[44:47], v[176:179], v[68:71]
  v_cvt_pk_bf16_f32 v112, v112, v113
  v_cvt_pk_bf16_f32 v113, v114, v115
  v_mfma_f32_16x16x32_bf16 v[76:79], v[44:47], v[208:211], v[76:79]
  v_cvt_pk_bf16_f32 v114, v116, v117
  v_mfma_f32_16x16x32_bf16 v[84:87], v[44:47], v[240:243], v[84:87]
  s_waitcnt lgkmcnt(5)
  v_cvt_pk_bf16_f32 v115, v118, v119
  v_mfma_f32_16x16x32_bf16 v[56:59], v[48:51], v[148:151], v[56:59]
  ds_read_b128 v[40:43], v250 offset:49152
  v_accvgpr_write_b32 a212, v112
  v_mfma_f32_16x16x32_bf16 v[64:67], v[48:51], v[180:183], v[64:67]
  v_accvgpr_write_b32 a213, v113
  v_accvgpr_write_b32 a214, v114
  v_mfma_f32_16x16x32_bf16 v[72:75], v[48:51], v[212:215], v[72:75]
  v_accvgpr_write_b32 a215, v115
  v_mfma_f32_16x16x32_bf16 v[80:83], v[48:51], v[244:247], v[80:83]
  s_waitcnt lgkmcnt(5)
  v_mfma_f32_16x16x32_bf16 v[60:63], v[52:55], v[148:151], v[60:63]
  ds_read_b128 v[44:47], v250 offset:51200
  v_mfma_f32_16x16x32_bf16 v[68:71], v[52:55], v[180:183], v[68:71]
  v_mfma_f32_16x16x32_bf16 v[76:79], v[52:55], v[212:215], v[76:79]
  v_mfma_f32_16x16x32_bf16 v[84:87], v[52:55], v[244:247], v[84:87]
  s_waitcnt lgkmcnt(5)
  v_mfma_f32_16x16x32_bf16 v[88:91], v[24:27], v[120:123], 0
  ds_read_b128 v[48:51], v251 offset:49152
  v_mfma_f32_16x16x32_bf16 v[96:99], v[24:27], v[152:155], 0
  v_mfma_f32_16x16x32_bf16 v[104:107], v[24:27], v[184:187], 0
  v_mfma_f32_16x16x32_bf16 v[112:115], v[24:27], v[216:219], 0
  s_waitcnt lgkmcnt(5)
  v_mul_f32 v56, v12, v56
  v_mfma_f32_16x16x32_bf16 v[92:95], v[28:31], v[120:123], 0
  ds_read_b128 v[52:55], v251 offset:51200
  v_mul_f32 v57, v12, v57
  v_mfma_f32_16x16x32_bf16 v[100:103], v[28:31], v[152:155], 0
  v_mul_f32 v58, v12, v58
  v_mul_f32 v59, v12, v59
  v_mfma_f32_16x16x32_bf16 v[108:111], v[28:31], v[184:187], 0
  v_mul_f32 v60, v12, v60
  v_mfma_f32_16x16x32_bf16 v[116:119], v[28:31], v[216:219], 0
  s_waitcnt lgkmcnt(5)
  v_mul_f32 v61, v12, v61
  v_mfma_f32_16x16x32_bf16 v[88:91], v[32:35], v[124:127], v[88:91]
  ds_read_b128 v[24:27], v248 offset:49408
  v_mul_f32 v62, v12, v62
  v_mfma_f32_16x16x32_bf16 v[96:99], v[32:35], v[156:159], v[96:99]
  v_mul_f32 v63, v12, v63
  v_cvt_pk_bf16_f32 v56, v56, v57
  v_mfma_f32_16x16x32_bf16 v[104:107], v[32:35], v[188:191], v[104:107]
  v_cvt_pk_bf16_f32 v57, v58, v59
  v_mfma_f32_16x16x32_bf16 v[112:115], v[32:35], v[220:223], v[112:115]
  s_waitcnt lgkmcnt(5)
  v_cvt_pk_bf16_f32 v58, v60, v61
  v_mfma_f32_16x16x32_bf16 v[92:95], v[36:39], v[124:127], v[92:95]
  ds_read_b128 v[28:31], v248 offset:51456
  v_cvt_pk_bf16_f32 v59, v62, v63
  v_mfma_f32_16x16x32_bf16 v[100:103], v[36:39], v[156:159], v[100:103]
  v_accvgpr_write_b32 a48, v56
  v_accvgpr_write_b32 a49, v57
  v_mfma_f32_16x16x32_bf16 v[108:111], v[36:39], v[188:191], v[108:111]
  v_accvgpr_write_b32 a50, v58
  v_mfma_f32_16x16x32_bf16 v[116:119], v[36:39], v[220:223], v[116:119]
  s_waitcnt lgkmcnt(5)
  v_accvgpr_write_b32 a51, v59
  v_mfma_f32_16x16x32_bf16 v[88:91], v[40:43], v[128:131], v[88:91]
  ds_read_b128 v[32:35], v249 offset:49408
  v_mul_f32 v64, v12, v64
  v_mfma_f32_16x16x32_bf16 v[96:99], v[40:43], v[160:163], v[96:99]
  v_mul_f32 v65, v12, v65
  v_mul_f32 v66, v12, v66
  v_mfma_f32_16x16x32_bf16 v[104:107], v[40:43], v[192:195], v[104:107]
  v_mul_f32 v67, v12, v67
  v_mfma_f32_16x16x32_bf16 v[112:115], v[40:43], v[224:227], v[112:115]
  s_waitcnt lgkmcnt(5)
  v_mul_f32 v68, v12, v68
  v_mfma_f32_16x16x32_bf16 v[92:95], v[44:47], v[128:131], v[92:95]
  ds_read_b128 v[36:39], v249 offset:51456
  v_mul_f32 v69, v12, v69
  v_mfma_f32_16x16x32_bf16 v[100:103], v[44:47], v[160:163], v[100:103]
  v_mul_f32 v70, v12, v70
  v_mul_f32 v71, v12, v71
  v_mfma_f32_16x16x32_bf16 v[108:111], v[44:47], v[192:195], v[108:111]
  v_cvt_pk_bf16_f32 v64, v64, v65
  v_mfma_f32_16x16x32_bf16 v[116:119], v[44:47], v[224:227], v[116:119]
  s_waitcnt lgkmcnt(5)
  v_cvt_pk_bf16_f32 v65, v66, v67
  v_mfma_f32_16x16x32_bf16 v[88:91], v[48:51], v[132:135], v[88:91]
  ds_read_b128 v[40:43], v250 offset:49408
  v_cvt_pk_bf16_f32 v66, v68, v69
  v_mfma_f32_16x16x32_bf16 v[96:99], v[48:51], v[164:167], v[96:99]
  v_cvt_pk_bf16_f32 v67, v70, v71
  v_accvgpr_write_b32 a104, v64
  v_mfma_f32_16x16x32_bf16 v[104:107], v[48:51], v[196:199], v[104:107]
  v_accvgpr_write_b32 a105, v65
  v_mfma_f32_16x16x32_bf16 v[112:115], v[48:51], v[228:231], v[112:115]
  s_waitcnt lgkmcnt(5)
  v_accvgpr_write_b32 a106, v66
  v_mfma_f32_16x16x32_bf16 v[92:95], v[52:55], v[132:135], v[92:95]
  ds_read_b128 v[44:47], v250 offset:51456
  v_accvgpr_write_b32 a107, v67
  v_mfma_f32_16x16x32_bf16 v[100:103], v[52:55], v[164:167], v[100:103]
  v_mul_f32 v72, v12, v72
  v_mul_f32 v73, v12, v73
  v_mfma_f32_16x16x32_bf16 v[108:111], v[52:55], v[196:199], v[108:111]
  v_mul_f32 v74, v12, v74
  v_mfma_f32_16x16x32_bf16 v[116:119], v[52:55], v[228:231], v[116:119]
  s_waitcnt lgkmcnt(5)
  v_mul_f32 v75, v12, v75
  v_mfma_f32_16x16x32_bf16 v[88:91], v[24:27], v[136:139], v[88:91]
  ds_read_b128 v[48:51], v251 offset:49408
  v_mul_f32 v76, v12, v76
  v_mfma_f32_16x16x32_bf16 v[96:99], v[24:27], v[168:171], v[96:99]
  v_mul_f32 v77, v12, v77
  v_mul_f32 v78, v12, v78
  v_mfma_f32_16x16x32_bf16 v[104:107], v[24:27], v[200:203], v[104:107]
  v_mul_f32 v79, v12, v79
  v_mfma_f32_16x16x32_bf16 v[112:115], v[24:27], v[232:235], v[112:115]
  s_waitcnt lgkmcnt(5)
  v_cvt_pk_bf16_f32 v72, v72, v73
  v_mfma_f32_16x16x32_bf16 v[92:95], v[28:31], v[136:139], v[92:95]
  ds_read_b128 v[52:55], v251 offset:51456
  v_cvt_pk_bf16_f32 v73, v74, v75
  v_mfma_f32_16x16x32_bf16 v[100:103], v[28:31], v[168:171], v[100:103]
  v_cvt_pk_bf16_f32 v74, v76, v77
  v_cvt_pk_bf16_f32 v75, v78, v79
  v_mfma_f32_16x16x32_bf16 v[108:111], v[28:31], v[200:203], v[108:111]
  v_accvgpr_write_b32 a160, v72
  v_mfma_f32_16x16x32_bf16 v[116:119], v[28:31], v[232:235], v[116:119]
  s_waitcnt lgkmcnt(5)
  v_accvgpr_write_b32 a161, v73
  v_mfma_f32_16x16x32_bf16 v[88:91], v[32:35], v[140:143], v[88:91]
  v_accvgpr_write_b32 a162, v74
  v_mfma_f32_16x16x32_bf16 v[96:99], v[32:35], v[172:175], v[96:99]
  v_accvgpr_write_b32 a163, v75
  v_mul_f32 v80, v12, v80
  v_mfma_f32_16x16x32_bf16 v[104:107], v[32:35], v[204:207], v[104:107]
  v_mul_f32 v81, v12, v81
  v_mfma_f32_16x16x32_bf16 v[112:115], v[32:35], v[236:239], v[112:115]
  s_waitcnt lgkmcnt(4)
  v_mul_f32 v82, v12, v82
  v_mfma_f32_16x16x32_bf16 v[92:95], v[36:39], v[140:143], v[92:95]
  v_mul_f32 v83, v12, v83
  v_mfma_f32_16x16x32_bf16 v[100:103], v[36:39], v[172:175], v[100:103]
  v_mul_f32 v84, v12, v84
  v_mul_f32 v85, v12, v85
  v_mfma_f32_16x16x32_bf16 v[108:111], v[36:39], v[204:207], v[108:111]
  v_mul_f32 v86, v12, v86
  v_mfma_f32_16x16x32_bf16 v[116:119], v[36:39], v[236:239], v[116:119]
  s_waitcnt lgkmcnt(3)
  v_mul_f32 v87, v12, v87
  v_mfma_f32_16x16x32_bf16 v[88:91], v[40:43], v[144:147], v[88:91]
  v_cvt_pk_bf16_f32 v80, v80, v81
  v_mfma_f32_16x16x32_bf16 v[96:99], v[40:43], v[176:179], v[96:99]
  v_cvt_pk_bf16_f32 v81, v82, v83
  v_cvt_pk_bf16_f32 v82, v84, v85
  v_mfma_f32_16x16x32_bf16 v[104:107], v[40:43], v[208:211], v[104:107]
  v_cvt_pk_bf16_f32 v83, v86, v87
  v_mfma_f32_16x16x32_bf16 v[112:115], v[40:43], v[240:243], v[112:115]
  s_waitcnt lgkmcnt(2)
  v_accvgpr_write_b32 a216, v80
  v_mfma_f32_16x16x32_bf16 v[92:95], v[44:47], v[144:147], v[92:95]
  v_accvgpr_write_b32 a217, v81
  v_mfma_f32_16x16x32_bf16 v[100:103], v[44:47], v[176:179], v[100:103]
  v_accvgpr_write_b32 a218, v82
  v_accvgpr_write_b32 a219, v83
  v_mfma_f32_16x16x32_bf16 v[108:111], v[44:47], v[208:211], v[108:111]
  v_mfma_f32_16x16x32_bf16 v[116:119], v[44:47], v[240:243], v[116:119]
  s_waitcnt lgkmcnt(1)
  v_mfma_f32_16x16x32_bf16 v[88:91], v[48:51], v[148:151], v[88:91]
  v_mfma_f32_16x16x32_bf16 v[96:99], v[48:51], v[180:183], v[96:99]
  v_mfma_f32_16x16x32_bf16 v[104:107], v[48:51], v[212:215], v[104:107]
  v_mfma_f32_16x16x32_bf16 v[112:115], v[48:51], v[244:247], v[112:115]
  s_waitcnt lgkmcnt(0)
  v_mfma_f32_16x16x32_bf16 v[92:95], v[52:55], v[148:151], v[92:95]
  v_mfma_f32_16x16x32_bf16 v[100:103], v[52:55], v[180:183], v[100:103]
  v_mfma_f32_16x16x32_bf16 v[108:111], v[52:55], v[212:215], v[108:111]
  v_mfma_f32_16x16x32_bf16 v[116:119], v[52:55], v[244:247], v[116:119]
  v_mul_f32 v88, v12, v88
  v_mul_f32 v89, v12, v89
  v_mul_f32 v90, v12, v90
  v_mul_f32 v91, v12, v91
  v_mul_f32 v92, v12, v92
  v_mul_f32 v93, v12, v93
  v_mul_f32 v94, v12, v94
  v_mul_f32 v95, v12, v95
  v_cvt_pk_bf16_f32 v88, v88, v89
  v_cvt_pk_bf16_f32 v89, v90, v91
  v_cvt_pk_bf16_f32 v90, v92, v93
  v_cvt_pk_bf16_f32 v91, v94, v95
  v_accvgpr_write_b32 a52, v88
  v_accvgpr_write_b32 a53, v89
  v_accvgpr_write_b32 a54, v90
  v_accvgpr_write_b32 a55, v91
  v_mul_f32 v96, v12, v96
  v_mul_f32 v97, v12, v97
  v_mul_f32 v98, v12, v98
  v_mul_f32 v99, v12, v99
  v_mul_f32 v100, v12, v100
  v_mul_f32 v101, v12, v101
  v_mul_f32 v102, v12, v102
  v_mul_f32 v103, v12, v103
  v_cvt_pk_bf16_f32 v96, v96, v97
  v_cvt_pk_bf16_f32 v97, v98, v99
  v_cvt_pk_bf16_f32 v98, v100, v101
  v_cvt_pk_bf16_f32 v99, v102, v103
  v_accvgpr_write_b32 a108, v96
  v_accvgpr_write_b32 a109, v97
  v_accvgpr_write_b32 a110, v98
  v_accvgpr_write_b32 a111, v99
  v_mul_f32 v104, v12, v104
  v_mul_f32 v105, v12, v105
  v_mul_f32 v106, v12, v106
  v_mul_f32 v107, v12, v107
  v_mul_f32 v108, v12, v108
  v_mul_f32 v109, v12, v109
  v_mul_f32 v110, v12, v110
  v_mul_f32 v111, v12, v111
  v_cvt_pk_bf16_f32 v104, v104, v105
  v_cvt_pk_bf16_f32 v105, v106, v107
  v_cvt_pk_bf16_f32 v106, v108, v109
  v_cvt_pk_bf16_f32 v107, v110, v111
  v_accvgpr_write_b32 a164, v104
  v_accvgpr_write_b32 a165, v105
  v_accvgpr_write_b32 a166, v106
  v_accvgpr_write_b32 a167, v107
  v_mul_f32 v112, v12, v112
  v_mul_f32 v113, v12, v113
  v_mul_f32 v114, v12, v114
  v_mul_f32 v115, v12, v115
  v_mul_f32 v116, v12, v116
  v_mul_f32 v117, v12, v117
  v_mul_f32 v118, v12, v118
  v_mul_f32 v119, v12, v119
  v_cvt_pk_bf16_f32 v112, v112, v113
  v_cvt_pk_bf16_f32 v113, v114, v115
  v_cvt_pk_bf16_f32 v114, v116, v117
  v_cvt_pk_bf16_f32 v115, v118, v119
  v_accvgpr_write_b32 a220, v112
  v_accvgpr_write_b32 a221, v113
  v_accvgpr_write_b32 a222, v114
  v_accvgpr_write_b32 a223, v115
  s_waitcnt vmcnt(0)
  s_barrier
  v_readfirstlane_b32 s84, v13
  v_readfirstlane_b32 s85, v10
  v_readfirstlane_b32 s22, v11
  s_and_b32 s86, s86, s22
  s_cmp_eq_u32 s86, 1
  s_cselect_b32 s84, s84, 0
  v_and_b32 v10, 0xffe0, v9
  v_cmp_eq_u32 vcc, 0, v10
  s_cbranch_vccz ch_md_ok
ch_role2:
  s_mov_b32 s30, 0
ch_md:
  buffer_load_dword v9, off, s[12:15], 0 sc1
  s_waitcnt vmcnt(0)
  v_and_b32 v10, 0xffe0, v9
  v_cmp_eq_u32 vcc, 0, v10
  s_cbranch_vccz ch_md_ok
  s_sleep 4
  s_add_u32 s30, s30, 1
  s_cmp_lt_u32 s30, 1600000
  s_cbranch_scc1 ch_md
  s_branch ch_end
ch_md_ok:
  v_readfirstlane_b32 s88, v9
  s_lshr_b32 s88, s88, 16
  v_and_b32 v1, 63, v0
  v_lshlrev_b32 v2, 4, v1
  v_lshrrev_b32 v116, 4, v1
  v_and_b32 v117, 15, v1
  v_mov_b32 v3, 0x4444
  v_mov_b32 v118, 0xeeee
  v_cmp_lt_u32 vcc, 7, v117
  s_nop 1
  v_cndmask_b32 v3, v3, v118, vcc
  s_mov_b32 s19, 0
  s_mov_b32 s18, 1
  s_mov_b32 s20, 0
  s_mov_b32 s21, 17664
  s_mov_b32 s23, 4096
  s_lshr_b32 s89, s17, 4
  s_lshl_b32 s89, s89, 2
  s_add_u32 s89, s89, s16
  s_and_b32 s17, s17, 15
  s_cmp_eq_u32 s89, 0
  s_cbranch_scc1 ch_init0
  s_cmp_eq_u32 s89, 1
  s_cbranch_scc1 ch_init1
  s_cmp_eq_u32 s89, 2
  s_cbranch_scc1 ch_init2
  s_cmp_eq_u32 s89, 3
  s_cbranch_scc1 ch_init3
  s_cmp_eq_u32 s89, 4
  s_cbranch_scc1 ch_init4
  s_cmp_eq_u32 s89, 5
  s_cbranch_scc1 ch_init5
  s_cmp_eq_u32 s89, 6
  s_cbranch_scc1 ch_init6
  s_cmp_eq_u32 s89, 7
  s_cbranch_scc1 ch_init7
  s_branch ch_end
ch_init0:
  s_mul_i32 s31, s17, 401408
  s_add_u32 s31, s31, 33554432
  s_and_b32 s28, s84, 10320
  s_lshl_b32 s22, s85, 16
  s_or_b32 s28, s28, s22
  s_cmp_eq_u32 s28, 4294912080
  s_cbranch_scc1 ch_wx0_ok
  s_mov_b32 s30, 0
ch_wr0:
  buffer_load_dword v9, off, s[12:15], 0 offset:132 sc1
  s_waitcnt vmcnt(0)
  v_cmp_ne_u32 vcc, 1, v9
  s_cbranch_vccz ch_wr0_ok
  s_sleep 8
  s_add_u32 s30, s30, 1
  s_cmp_lt_u32 s30, 400000
  s_cbranch_scc1 ch_wr0
  s_branch cA_abort
ch_wr0_ok:
  s_lshl_b32 s27, s17, 7
  s_add_u32 s27, s27, 584192
  s_mov_b32 s28, 10320
  s_mov_b32 s30, 0
ch_wb0:
  buffer_load_dword v9, off, s[8:11], s27  sc1
  s_waitcnt vmcnt(0)
  v_and_b32 v10, s28, v9
  v_cmp_ne_u32 vcc, s28, v10
  s_cbranch_vccz ch_wb0_ok
  s_sleep 3
  s_add_u32 s30, s30, 1
  s_cmp_lt_u32 s30, 400000
  s_cbranch_scc1 ch_wb0
  s_branch cA_abort
ch_wb0_ok:
  s_mov_b32 s29, 586240
  s_mov_b32 s28, 0xffff
  s_mov_b32 s30, 0
ch_wx0:
  buffer_load_dword v9, off, s[8:11], s29  sc1
  s_waitcnt vmcnt(0)
  v_and_b32 v10, s28, v9
  v_cmp_ne_u32 vcc, s28, v10
  s_cbranch_vccz ch_wx0_ok
  s_sleep 8
  s_add_u32 s30, s30, 1
  s_cmp_lt_u32 s30, 400000
  s_cbranch_scc1 ch_wx0
  s_branch cA_abort
ch_wx0_ok:
  s_add_u32 s22, s31, 229376
  buffer_load_dwordx4 a[224:227], v2, s[8:11], s22 offen offset:0 sc1
  buffer_load_dwordx4 a[228:231], v2, s[8:11], s22 offen offset:1024 sc1
  buffer_load_dwordx4 a[232:235], v2, s[8:11], s22 offen offset:2048 sc1
  buffer_load_dwordx4 a[236:239], v2, s[8:11], s22 offen offset:3072 sc1
  s_add_u32 s22, s31, 233472
  buffer_load_dwordx4 a[240:243], v2, s[8:11], s22 offen offset:0 sc1
  buffer_load_dwordx4 a[244:247], v2, s[8:11], s22 offen offset:1024 sc1
  buffer_load_dwordx4 a[248:251], v2, s[8:11], s22 offen offset:2048 sc1
  buffer_load_dwordx4 a[252:255], v2, s[8:11], s22 offen offset:3072 sc1
  s_add_u32 s22, s31, 237568
  buffer_load_dwordx4 v[120:123], v2, s[8:11], s22 offen offset:0 sc1
  buffer_load_dwordx4 v[124:127], v2, s[8:11], s22 offen offset:1024 sc1
  buffer_load_dwordx4 v[128:131], v2, s[8:11], s22 offen offset:2048 sc1
  buffer_load_dwordx4 v[132:135], v2, s[8:11], s22 offen offset:3072 sc1
  s_add_u32 s22, s31, 241664
  buffer_load_dwordx4 v[136:139], v2, s[8:11], s22 offen offset:0 sc1
  buffer_load_dwordx4 v[140:143], v2, s[8:11], s22 offen offset:1024 sc1
  buffer_load_dwordx4 v[144:147], v2, s[8:11], s22 offen offset:2048 sc1
  buffer_load_dwordx4 v[148:151], v2, s[8:11], s22 offen offset:3072 sc1
  s_add_u32 s22, s31, 245760
  buffer_load_dwordx4 v[152:155], v2, s[8:11], s22 offen offset:0 sc1
  buffer_load_dwordx4 v[156:159], v2, s[8:11], s22 offen offset:1024 sc1
  buffer_load_dwordx4 v[160:163], v2, s[8:11], s22 offen offset:2048 sc1
  buffer_load_dwordx4 v[164:167], v2, s[8:11], s22 offen offset:3072 sc1
  s_add_u32 s22, s31, 249856
  buffer_load_dwordx4 v[168:171], v2, s[8:11], s22 offen offset:0 sc1
  buffer_load_dwordx4 v[172:175], v2, s[8:11], s22 offen offset:1024 sc1
  buffer_load_dwordx4 v[176:179], v2, s[8:11], s22 offen offset:2048 sc1
  buffer_load_dwordx4 v[180:183], v2, s[8:11], s22 offen offset:3072 sc1
  s_mov_b32 s24, 655360
  s_mov_b32 s26, 669696
  v_and_b32 v64, 7, v117
  v_and_b32 v65, 1, v116
  v_lshlrev_b32 v65, 2, v65
  v_sub_u32 v64, v64, v65
  v_lshrrev_b32 v65, 3, v117
  v_lshl_add_u32 v66, v65, 2, v64
  v_cmp_gt_u32 vcc, 4, v64
  v_mov_b32 v67, 99
  s_nop 0
  v_cndmask_b32 v66, v67, v66, vcc
  v_mov_b32 v68, 0x3f80
  v_mov_b32 v69, 0x3f800000
  v_mov_b32 v4, 0
  v_cmp_eq_u32 vcc, 0, v66
  s_nop 1
  v_cndmask_b32 v4, v4, v68, vcc
  v_cmp_eq_u32 vcc, 1, v66
  s_nop 1
  v_cndmask_b32 v4, v4, v69, vcc
  v_mov_b32 v5, 0
  v_cmp_eq_u32 vcc, 2, v66
  s_nop 1
  v_cndmask_b32 v5, v5, v68, vcc
  v_cmp_eq_u32 vcc, 3, v66
  s_nop 1
  v_cndmask_b32 v5, v5, v69, vcc
  v_mov_b32 v6, 0
  v_cmp_eq_u32 vcc, 4, v66
  s_nop 1
  v_cndmask_b32 v6, v6, v68, vcc
  v_cmp_eq_u32 vcc, 5, v66
  s_nop 1
  v_cndmask_b32 v6, v6, v69, vcc
  v_mov_b32 v7, 0
  v_cmp_eq_u32 vcc, 6, v66
  s_nop 1
  v_cndmask_b32 v7, v7, v68, vcc
  v_cmp_eq_u32 vcc, 7, v66
  s_nop 1
  v_cndmask_b32 v7, v7, v69, vcc
  v_lshrrev_b32 v64, 1, v116
  v_lshrrev_b32 v65, 3, v117
  v_and_b32 v66, 1, v116
  v_and_b32 v68, 7, v117
  v_lshlrev_b32 v67, 8, v65
  v_lshl_add_u32 v67, v68, 5, v67
  v_lshl_add_u32 v67, v66, 4, v67
  v_add_u32 v69, 4096, v67
  v_add_u32 v70, 6400, v67
  v_cmp_eq_u32 vcc, v64, v65
  s_nop 1
  v_cndmask_b32 v113, v70, v69, vcc
  v_and_b32 v74, 3, v117
  v_lshlrev_b32 v74, 1, v74
  v_bfe_u32 v75, v117, 2, 1
  v_or_b32 v74, v74, v75
  v_and_b32 v75, 8, v117
  v_or_b32 v74, v74, v75
  v_lshlrev_b32 v67, 9, v64
  v_lshl_add_u32 v67, v74, 4, v67
  v_lshl_add_u32 v67, v66, 3, v67
  v_add_u32 v114, 0, v67
  v_mul_u32_u24 v67, 1088, v65
  v_lshl_add_u32 v67, v116, 5, v67
  v_and_b32 v75, 1, v117
  v_and_b32 v76, 2, v117
  v_lshl_add_u32 v75, v76, 1, v75
  v_bfe_u32 v76, v117, 2, 1
  v_lshl_add_u32 v75, v76, 1, v75
  v_lshl_add_u32 v67, v75, 2, v67
  v_add_u32 v115, 4096, v67
  v_and_b32 v69, 1, v74
  v_lshlrev_b32 v67, 7, v69
  v_lshl_add_u32 v67, v116, 4, v67
  v_lshl_add_u32 v67, v65, 8, v67
  v_bfe_u32 v69, v74, 1, 2
  v_lshl_add_u32 v67, v69, 2, v67
  s_lshl_b32 s22, s17, 9
  s_add_u32 s22, s22, 9216
  v_add_u32 v72, s22, v67
  v_bfe_u32 v69, v75, 1, 1
  v_lshlrev_b32 v67, 7, v69
  v_lshl_add_u32 v67, v116, 4, v67
  v_and_b32 v69, 4, v75
  v_add_u32 v67, v67, v69
  s_lshr_b32 s22, s17, 1
  s_lshl_b32 s22, s22, 8
  s_and_b32 s27, s17, 1
  s_lshl_b32 s27, s27, 3
  s_add_u32 s22, s22, s27
  s_add_u32 s22, s22, 7168
  v_add_u32 v67, s22, v67
  v_and_b32 v69, 9, v117
  v_mov_b32 v70, 0x40000000
  v_cmp_eq_u32 vcc, 0, v69
  s_nop 1
  v_cndmask_b32 v118, v70, v67, vcc
  v_mov_b32 v119, -1
  v_and_b32 v0, 15, v1
  s_and_b32 s22, s17, 0
  s_lshl_b32 s22, s22, 7
  s_add_u32 s22, s22, 37376
  v_lshl_add_u32 v0, v0, 2, s22
  v_xor_b32 v69, 256, v2
  v_mul_i32_i24 v70, -4096, v66
  v_add_u32 v69, v69, v70
  v_add_u32 v117, 12288, v69
  v_mov_b32 v116, v73
  v_mov_b32 v112, 0
  s_mul_i32 s35, s17, 28672
  s_add_u32 s35, s35, 4325376
  v_mov_b32 v1, v72
  v_mov_b32 v36, 0
  v_mov_b32 v37, 0
  v_mov_b32 v38, 0
  v_mov_b32 v39, 0
  v_mov_b32 v40, 0
  v_mov_b32 v41, 0
  v_mov_b32 v42, 0
  v_mov_b32 v43, 0
  v_mov_b32 v44, 0
  v_mov_b32 v45, 0
  v_mov_b32 v46, 0
  v_mov_b32 v47, 0
  v_mov_b32 v48, 0
  v_mov_b32 v49, 0
  v_mov_b32 v50, 0
  v_mov_b32 v51, 0
  v_mov_b32 v52, 0
  v_mov_b32 v53, 0
  v_mov_b32 v54, 0
  v_mov_b32 v55, 0
  v_mov_b32 v56, 0
  v_mov_b32 v57, 0
  v_mov_b32 v58, 0
  v_mov_b32 v59, 0
  v_mov_b32 v60, 0
  v_mov_b32 v61, 0
  v_mov_b32 v62, 0
  v_mov_b32 v63, 0
  v_mov_b32 v64, 0
  v_mov_b32 v65, 0
  v_mov_b32 v66, 0
  v_mov_b32 v67, 0
  v_mov_b32 v68, 0
  v_mov_b32 v69, 0
  v_mov_b32 v70, 0
  v_mov_b32 v71, 0
  v_mov_b32 v72, 0
  v_mov_b32 v73, 0
  v_mov_b32 v74, 0
  v_mov_b32 v75, 0
  v_mov_b32 v76, 0
  v_mov_b32 v77, 0
  v_mov_b32 v78, 0
  v_mov_b32 v79, 0
  s_mov_b32 s22, 0
  v_lshrrev_b32 v14, 4, v2
  v_add_u32 v14, 0, v14
  v_min_u32 v14, 308, v14
  v_lshlrev_b32 v14, 7, v14
  buffer_load_dword v15, v14, s[8:11], s22 offen sc1
  v_lshrrev_b32 v14, 4, v2
  v_add_u32 v14, 256, v14
  v_min_u32 v14, 308, v14
  v_lshlrev_b32 v14, 7, v14
  buffer_load_dword v15, v14, s[8:11], s22 offen sc1
  buffer_load_dwordx4 v[80:83], v117, s[8:11], s24 offen offset:0 sc1
  buffer_load_dwordx4 v[84:87], v117, s[8:11], s24 offen offset:1024 sc1
  buffer_load_dwordx4 v[88:91], v117, s[8:11], s26 offen offset:0 sc1
  buffer_load_dwordx4 v[92:95], v117, s[8:11], s26 offen offset:1024 sc1
  buffer_load_dwordx4 v[96:99], v2, s[8:11], s24 offen offset:0 sc1
  buffer_load_dwordx4 v[100:103], v2, s[8:11], s24 offen offset:1024 sc1
  buffer_load_dwordx4 v[104:107], v2, s[8:11], s26 offen offset:0 sc1
  buffer_load_dwordx4 v[108:111], v2, s[8:11], s26 offen offset:1024 sc1
  s_add_u32 s22, s31, 253952
  buffer_load_dwordx4 v[184:187], v2, s[8:11], s22 offen offset:0 sc1
  buffer_load_dwordx4 v[188:191], v2, s[8:11], s22 offen offset:1024 sc1
  buffer_load_dwordx4 v[192:195], v2, s[8:11], s22 offen offset:2048 sc1
  buffer_load_dwordx4 v[196:199], v2, s[8:11], s22 offen offset:3072 sc1
  s_add_u32 s22, s31, 372736
  buffer_load_dwordx4 v[200:203], v2, s[8:11], s22 offen offset:0 sc1
  buffer_load_dwordx4 v[204:207], v2, s[8:11], s22 offen offset:1024 sc1
  buffer_load_dwordx4 v[208:211], v2, s[8:11], s22 offen offset:2048 sc1
  buffer_load_dwordx4 v[212:215], v2, s[8:11], s22 offen offset:3072 sc1
  s_add_u32 s22, s31, 376832
  buffer_load_dwordx4 v[216:219], v2, s[8:11], s22 offen offset:0 sc1
  buffer_load_dwordx4 v[220:223], v2, s[8:11], s22 offen offset:1024 sc1
  buffer_load_dwordx4 v[224:227], v2, s[8:11], s22 offen offset:2048 sc1
  buffer_load_dwordx4 v[228:231], v2, s[8:11], s22 offen offset:3072 sc1
  s_add_u32 s22, s31, 380928
  buffer_load_dwordx4 v[232:235], v2, s[8:11], s22 offen offset:0 sc1
  buffer_load_dwordx4 v[236:239], v2, s[8:11], s22 offen offset:1024 sc1
  buffer_load_dwordx4 v[240:243], v2, s[8:11], s22 offen offset:2048 sc1
  buffer_load_dwordx4 v[244:247], v2, s[8:11], s22 offen offset:3072 sc1
  s_add_u32 s22, s31, 385024
  buffer_load_dwordx4 v[248:251], v2, s[8:11], s22 offen offset:0 sc1
  buffer_load_dwordx4 v[252:255], v2, s[8:11], s22 offen offset:1024 sc1
  s_waitcnt vmcnt(0) lgkmcnt(0)
  s_mov_b32 s31, 0
  s_cmp_lg_u32 s88, 0
  s_cbranch_scc1 cB_sc0_loop
  s_branch cA_sc0_loop
ch_init1:
  s_mul_i32 s31, s17, 401408
  s_add_u32 s31, s31, 33554432
  s_and_b32 s28, s84, 10320
  s_lshl_b32 s22, s85, 16
  s_or_b32 s28, s28, s22
  s_cmp_eq_u32 s28, 4294912080
  s_cbranch_scc1 ch_wx1_ok
  s_mov_b32 s30, 0
ch_wr1:
  buffer_load_dword v9, off, s[12:15], 0 offset:132 sc1
  s_waitcnt vmcnt(0)
  v_cmp_ne_u32 vcc, 1, v9
  s_cbranch_vccz ch_wr1_ok
  s_sleep 8
  s_add_u32 s30, s30, 1
  s_cmp_lt_u32 s30, 400000
  s_cbranch_scc1 ch_wr1
  s_branch cA_abort
ch_wr1_ok:
  s_lshl_b32 s27, s17, 7
  s_add_u32 s27, s27, 584192
  s_mov_b32 s28, 10320
  s_mov_b32 s30, 0
ch_wb1:
  buffer_load_dword v9, off, s[8:11], s27  sc1
  s_waitcnt vmcnt(0)
  v_and_b32 v10, s28, v9
  v_cmp_ne_u32 vcc, s28, v10
  s_cbranch_vccz ch_wb1_ok
  s_sleep 3
  s_add_u32 s30, s30, 1
  s_cmp_lt_u32 s30, 400000
  s_cbranch_scc1 ch_wb1
  s_branch cA_abort
ch_wb1_ok:
  s_mov_b32 s29, 586240
  s_mov_b32 s28, 0xffff
  s_mov_b32 s30, 0
ch_wx1:
  buffer_load_dword v9, off, s[8:11], s29  sc1
  s_waitcnt vmcnt(0)
  v_and_b32 v10, s28, v9
  v_cmp_ne_u32 vcc, s28, v10
  s_cbranch_vccz ch_wx1_ok
  s_sleep 8
  s_add_u32 s30, s30, 1
  s_cmp_lt_u32 s30, 400000
  s_cbranch_scc1 ch_wx1
  s_branch cA_abort
ch_wx1_ok:
  s_add_u32 s22, s31, 258048
  buffer_load_dwordx4 a[224:227], v2, s[8:11], s22 offen offset:0 sc1
  buffer_load_dwordx4 a[228:231], v2, s[8:11], s22 offen offset:1024 sc1
  buffer_load_dwordx4 a[232:235], v2, s[8:11], s22 offen offset:2048 sc1
  buffer_load_dwordx4 a[236:239], v2, s[8:11], s22 offen offset:3072 sc1
  s_add_u32 s22, s31, 262144
  buffer_load_dwordx4 a[240:243], v2, s[8:11], s22 offen offset:0 sc1
  buffer_load_dwordx4 a[244:247], v2, s[8:11], s22 offen offset:1024 sc1
  buffer_load_dwordx4 a[248:251], v2, s[8:11], s22 offen offset:2048 sc1
  buffer_load_dwordx4 a[252:255], v2, s[8:11], s22 offen offset:3072 sc1
  s_add_u32 s22, s31, 266240
  buffer_load_dwordx4 v[120:123], v2, s[8:11], s22 offen offset:0 sc1
  buffer_load_dwordx4 v[124:127], v2, s[8:11], s22 offen offset:1024 sc1
  buffer_load_dwordx4 v[128:131], v2, s[8:11], s22 offen offset:2048 sc1
  buffer_load_dwordx4 v[132:135], v2, s[8:11], s22 offen offset:3072 sc1
  s_add_u32 s22, s31, 270336
  buffer_load_dwordx4 v[136:139], v2, s[8:11], s22 offen offset:0 sc1
  buffer_load_dwordx4 v[140:143], v2, s[8:11], s22 offen offset:1024 sc1
  buffer_load_dwordx4 v[144:147], v2, s[8:11], s22 offen offset:2048 sc1
  buffer_load_dwordx4 v[148:151], v2, s[8:11], s22 offen offset:3072 sc1
  s_add_u32 s22, s31, 274432
  buffer_load_dwordx4 v[152:155], v2, s[8:11], s22 offen offset:0 sc1
  buffer_load_dwordx4 v[156:159], v2, s[8:11], s22 offen offset:1024 sc1
  buffer_load_dwordx4 v[160:163], v2, s[8:11], s22 offen offset:2048 sc1
  buffer_load_dwordx4 v[164:167], v2, s[8:11], s22 offen offset:3072 sc1
  s_add_u32 s22, s31, 278528
  buffer_load_dwordx4 v[168:171], v2, s[8:11], s22 offen offset:0 sc1
  buffer_load_dwordx4 v[172:175], v2, s[8:11], s22 offen offset:1024 sc1
  buffer_load_dwordx4 v[176:179], v2, s[8:11], s22 offen offset:2048 sc1
  buffer_load_dwordx4 v[180:183], v2, s[8:11], s22 offen offset:3072 sc1
  s_mov_b32 s24, 657408
  s_mov_b32 s26, 671744
  v_and_b32 v64, 7, v117
  v_and_b32 v65, 1, v116
  v_lshlrev_b32 v65, 2, v65
  v_sub_u32 v64, v64, v65
  v_lshrrev_b32 v65, 3, v117
  v_lshl_add_u32 v66, v65, 2, v64
  v_cmp_gt_u32 vcc, 4, v64
  v_mov_b32 v67, 99
  s_nop 0
  v_cndmask_b32 v66, v67, v66, vcc
  v_mov_b32 v68, 0x3f80
  v_mov_b32 v69, 0x3f800000
  v_mov_b32 v4, 0
  v_cmp_eq_u32 vcc, 0, v66
  s_nop 1
  v_cndmask_b32 v4, v4, v68, vcc
  v_cmp_eq_u32 vcc, 1, v66
  s_nop 1
  v_cndmask_b32 v4, v4, v69, vcc
  v_mov_b32 v5, 0
  v_cmp_eq_u32 vcc, 2, v66
  s_nop 1
  v_cndmask_b32 v5, v5, v68, vcc
  v_cmp_eq_u32 vcc, 3, v66
  s_nop 1
  v_cndmask_b32 v5, v5, v69, vcc
  v_mov_b32 v6, 0
  v_cmp_eq_u32 vcc, 4, v66
  s_nop 1
  v_cndmask_b32 v6, v6, v68, vcc
  v_cmp_eq_u32 vcc, 5, v66
  s_nop 1
  v_cndmask_b32 v6, v6, v69, vcc
  v_mov_b32 v7, 0
  v_cmp_eq_u32 vcc, 6, v66
  s_nop 1
  v_cndmask_b32 v7, v7, v68, vcc
  v_cmp_eq_u32 vcc, 7, v66
  s_nop 1
  v_cndmask_b32 v7, v7, v69, vcc
  v_lshrrev_b32 v64, 1, v116
  v_lshrrev_b32 v65, 3, v117
  v_and_b32 v66, 1, v116
  v_and_b32 v68, 7, v117
  v_lshlrev_b32 v67, 8, v65
  v_lshl_add_u32 v67, v68, 5, v67
  v_lshl_add_u32 v67, v66, 4, v67
  v_add_u32 v69, 4608, v67
  v_add_u32 v70, 6400, v67
  v_cmp_eq_u32 vcc, v64, v65
  s_nop 1
  v_cndmask_b32 v113, v70, v69, vcc
  v_and_b32 v74, 3, v117
  v_lshlrev_b32 v74, 1, v74
  v_bfe_u32 v75, v117, 2, 1
  v_or_b32 v74, v74, v75
  v_and_b32 v75, 8, v117
  v_or_b32 v74, v74, v75
  v_lshlrev_b32 v67, 9, v64
  v_lshl_add_u32 v67, v74, 4, v67
  v_lshl_add_u32 v67, v66, 3, v67
  v_add_u32 v114, 256, v67
  v_mul_u32_u24 v67, 1088, v65
  v_lshl_add_u32 v67, v116, 5, v67
  v_and_b32 v75, 1, v117
  v_and_b32 v76, 2, v117
  v_lshl_add_u32 v75, v76, 1, v75
  v_bfe_u32 v76, v117, 2, 1
  v_lshl_add_u32 v75, v76, 1, v75
  v_lshl_add_u32 v67, v75, 2, v67
  v_add_u32 v115, 4224, v67
  v_and_b32 v69, 1, v74
  v_lshlrev_b32 v67, 7, v69
  v_lshl_add_u32 v67, v116, 4, v67
  v_lshl_add_u32 v67, v65, 8, v67
  v_bfe_u32 v69, v74, 1, 2
  v_lshl_add_u32 v67, v69, 2, v67
  s_lshl_b32 s22, s17, 9
  s_add_u32 s22, s22, 9280
  v_add_u32 v72, s22, v67
  v_bfe_u32 v69, v75, 1, 1
  v_lshlrev_b32 v67, 7, v69
  v_lshl_add_u32 v67, v116, 4, v67
  v_and_b32 v69, 4, v75
  v_add_u32 v67, v67, v69
  s_lshr_b32 s22, s17, 1
  s_lshl_b32 s22, s22, 8
  s_and_b32 s27, s17, 1
  s_lshl_b32 s27, s27, 3
  s_add_u32 s22, s22, s27
  s_add_u32 s22, s22, 7232
  v_add_u32 v67, s22, v67
  v_and_b32 v69, 9, v117
  v_mov_b32 v70, 0x40000000
  v_cmp_eq_u32 vcc, 0, v69
  s_nop 1
  v_cndmask_b32 v118, v70, v67, vcc
  v_mov_b32 v119, -1
  s_lshl_b32 s22, s17, 2
  s_add_u32 s22, s22, 35328
  v_lshl_add_u32 v67, v1, 7, s22
  v_mov_b32 v70, 0x40000000
  v_cmp_gt_u32 vcc, 1, v1
  s_nop 1
  v_cndmask_b32 v73, v70, v67, vcc
  v_mov_b32 v112, 1
  v_and_b32 v0, 15, v1
  s_and_b32 s22, s17, 0
  s_lshl_b32 s22, s22, 7
  s_add_u32 s22, s22, 37376
  v_lshl_add_u32 v0, v0, 2, s22
  v_xor_b32 v69, 256, v2
  v_mul_i32_i24 v70, 4096, v66
  v_add_u32 v69, v69, v70
  v_add_u32 v117, 6144, v69
  v_mov_b32 v116, v73
  s_mul_i32 s35, s17, 28672
  s_add_u32 s35, s35, 4325376
  v_mov_b32 v1, v72
  v_mov_b32 v36, 0
  v_mov_b32 v37, 0
  v_mov_b32 v38, 0
  v_mov_b32 v39, 0
  v_mov_b32 v40, 0
  v_mov_b32 v41, 0
  v_mov_b32 v42, 0
  v_mov_b32 v43, 0
  v_mov_b32 v44, 0
  v_mov_b32 v45, 0
  v_mov_b32 v46, 0
  v_mov_b32 v47, 0
  v_mov_b32 v48, 0
  v_mov_b32 v49, 0
  v_mov_b32 v50, 0
  v_mov_b32 v51, 0
  v_mov_b32 v52, 0
  v_mov_b32 v53, 0
  v_mov_b32 v54, 0
  v_mov_b32 v55, 0
  v_mov_b32 v56, 0
  v_mov_b32 v57, 0
  v_mov_b32 v58, 0
  v_mov_b32 v59, 0
  v_mov_b32 v60, 0
  v_mov_b32 v61, 0
  v_mov_b32 v62, 0
  v_mov_b32 v63, 0
  v_mov_b32 v64, 0
  v_mov_b32 v65, 0
  v_mov_b32 v66, 0
  v_mov_b32 v67, 0
  v_mov_b32 v68, 0
  v_mov_b32 v69, 0
  v_mov_b32 v70, 0
  v_mov_b32 v71, 0
  v_mov_b32 v72, 0
  v_mov_b32 v73, 0
  v_mov_b32 v74, 0
  v_mov_b32 v75, 0
  v_mov_b32 v76, 0
  v_mov_b32 v77, 0
  v_mov_b32 v78, 0
  v_mov_b32 v79, 0
  s_mov_b32 s22, 0
  v_lshrrev_b32 v14, 4, v2
  v_add_u32 v14, 64, v14
  v_min_u32 v14, 308, v14
  v_lshlrev_b32 v14, 7, v14
  buffer_load_dword v15, v14, s[8:11], s22 offen sc1
  buffer_load_dwordx4 v[80:83], v117, s[8:11], s24 offen offset:0 sc1
  buffer_load_dwordx4 v[84:87], v117, s[8:11], s24 offen offset:1024 sc1
  buffer_load_dwordx4 v[88:91], v117, s[8:11], s26 offen offset:0 sc1
  buffer_load_dwordx4 v[92:95], v117, s[8:11], s26 offen offset:1024 sc1
  buffer_load_dwordx4 v[96:99], v2, s[8:11], s24 offen offset:0 sc1
  buffer_load_dwordx4 v[100:103], v2, s[8:11], s24 offen offset:1024 sc1
  buffer_load_dwordx4 v[104:107], v2, s[8:11], s26 offen offset:0 sc1
  buffer_load_dwordx4 v[108:111], v2, s[8:11], s26 offen offset:1024 sc1
  s_add_u32 s22, s31, 282624
  buffer_load_dwordx4 v[184:187], v2, s[8:11], s22 offen offset:0 sc1
  buffer_load_dwordx4 v[188:191], v2, s[8:11], s22 offen offset:1024 sc1
  buffer_load_dwordx4 v[192:195], v2, s[8:11], s22 offen offset:2048 sc1
  buffer_load_dwordx4 v[196:199], v2, s[8:11], s22 offen offset:3072 sc1
  s_add_u32 s22, s31, 344064
  buffer_load_dwordx4 v[200:203], v2, s[8:11], s22 offen offset:0 sc1
  buffer_load_dwordx4 v[204:207], v2, s[8:11], s22 offen offset:1024 sc1
  buffer_load_dwordx4 v[208:211], v2, s[8:11], s22 offen offset:2048 sc1
  buffer_load_dwordx4 v[212:215], v2, s[8:11], s22 offen offset:3072 sc1
  s_add_u32 s22, s31, 348160
  buffer_load_dwordx4 v[216:219], v2, s[8:11], s22 offen offset:0 sc1
  buffer_load_dwordx4 v[220:223], v2, s[8:11], s22 offen offset:1024 sc1
  buffer_load_dwordx4 v[224:227], v2, s[8:11], s22 offen offset:2048 sc1
  buffer_load_dwordx4 v[228:231], v2, s[8:11], s22 offen offset:3072 sc1
  s_add_u32 s22, s31, 352256
  buffer_load_dwordx4 v[232:235], v2, s[8:11], s22 offen offset:0 sc1
  buffer_load_dwordx4 v[236:239], v2, s[8:11], s22 offen offset:1024 sc1
  buffer_load_dwordx4 v[240:243], v2, s[8:11], s22 offen offset:2048 sc1
  buffer_load_dwordx4 v[244:247], v2, s[8:11], s22 offen offset:3072 sc1
  s_add_u32 s22, s31, 356352
  buffer_load_dwordx4 v[248:251], v2, s[8:11], s22 offen offset:0 sc1
  buffer_load_dwordx4 v[252:255], v2, s[8:11], s22 offen offset:1024 sc1
  s_waitcnt vmcnt(0) lgkmcnt(0)
  s_mov_b32 s31, 0
  s_cmp_lg_u32 s88, 0
  s_cbranch_scc1 cB_sc1_loop
  s_branch cA_sc1_loop
ch_init2:
  s_mul_i32 s31, s17, 401408
  s_add_u32 s31, s31, 33554432
  s_and_b32 s28, s84, 12384
  s_lshl_b32 s22, s85, 16
  s_or_b32 s28, s28, s22
  s_cmp_eq_u32 s28, 4294914144
  s_cbranch_scc1 ch_wx2_ok
  s_mov_b32 s30, 0
ch_wr2:
  buffer_load_dword v9, off, s[12:15], 0 offset:132 sc1
  s_waitcnt vmcnt(0)
  v_cmp_ne_u32 vcc, 1, v9
  s_cbranch_vccz ch_wr2_ok
  s_sleep 8
  s_add_u32 s30, s30, 1
  s_cmp_lt_u32 s30, 400000
  s_cbranch_scc1 ch_wr2
  s_branch cA_abort
ch_wr2_ok:
  s_lshl_b32 s27, s17, 7
  s_add_u32 s27, s27, 584192
  s_mov_b32 s28, 12384
  s_mov_b32 s30, 0
ch_wb2:
  buffer_load_dword v9, off, s[8:11], s27  sc1
  s_waitcnt vmcnt(0)
  v_and_b32 v10, s28, v9
  v_cmp_ne_u32 vcc, s28, v10
  s_cbranch_vccz ch_wb2_ok
  s_sleep 3
  s_add_u32 s30, s30, 1
  s_cmp_lt_u32 s30, 400000
  s_cbranch_scc1 ch_wb2
  s_branch cA_abort
ch_wb2_ok:
  s_mov_b32 s29, 586240
  s_mov_b32 s28, 0xffff
  s_mov_b32 s30, 0
ch_wx2:
  buffer_load_dword v9, off, s[8:11], s29  sc1
  s_waitcnt vmcnt(0)
  v_and_b32 v10, s28, v9
  v_cmp_ne_u32 vcc, s28, v10
  s_cbranch_vccz ch_wx2_ok
  s_sleep 8
  s_add_u32 s30, s30, 1
  s_cmp_lt_u32 s30, 400000
  s_cbranch_scc1 ch_wx2
  s_branch cA_abort
ch_wx2_ok:
  s_add_u32 s22, s31, 286720
  buffer_load_dwordx4 a[224:227], v2, s[8:11], s22 offen offset:0 sc1
  buffer_load_dwordx4 a[228:231], v2, s[8:11], s22 offen offset:1024 sc1
  buffer_load_dwordx4 a[232:235], v2, s[8:11], s22 offen offset:2048 sc1
  buffer_load_dwordx4 a[236:239], v2, s[8:11], s22 offen offset:3072 sc1
  s_add_u32 s22, s31, 290816
  buffer_load_dwordx4 a[240:243], v2, s[8:11], s22 offen offset:0 sc1
  buffer_load_dwordx4 a[244:247], v2, s[8:11], s22 offen offset:1024 sc1
  buffer_load_dwordx4 a[248:251], v2, s[8:11], s22 offen offset:2048 sc1
  buffer_load_dwordx4 a[252:255], v2, s[8:11], s22 offen offset:3072 sc1
  s_add_u32 s22, s31, 294912
  buffer_load_dwordx4 v[120:123], v2, s[8:11], s22 offen offset:0 sc1
  buffer_load_dwordx4 v[124:127], v2, s[8:11], s22 offen offset:1024 sc1
  buffer_load_dwordx4 v[128:131], v2, s[8:11], s22 offen offset:2048 sc1
  buffer_load_dwordx4 v[132:135], v2, s[8:11], s22 offen offset:3072 sc1
  s_add_u32 s22, s31, 299008
  buffer_load_dwordx4 v[136:139], v2, s[8:11], s22 offen offset:0 sc1
  buffer_load_dwordx4 v[140:143], v2, s[8:11], s22 offen offset:1024 sc1
  buffer_load_dwordx4 v[144:147], v2, s[8:11], s22 offen offset:2048 sc1
  buffer_load_dwordx4 v[148:151], v2, s[8:11], s22 offen offset:3072 sc1
  s_add_u32 s22, s31, 303104
  buffer_load_dwordx4 v[152:155], v2, s[8:11], s22 offen offset:0 sc1
  buffer_load_dwordx4 v[156:159], v2, s[8:11], s22 offen offset:1024 sc1
  buffer_load_dwordx4 v[160:163], v2, s[8:11], s22 offen offset:2048 sc1
  buffer_load_dwordx4 v[164:167], v2, s[8:11], s22 offen offset:3072 sc1
  s_add_u32 s22, s31, 307200
  buffer_load_dwordx4 v[168:171], v2, s[8:11], s22 offen offset:0 sc1
  buffer_load_dwordx4 v[172:175], v2, s[8:11], s22 offen offset:1024 sc1
  buffer_load_dwordx4 v[176:179], v2, s[8:11], s22 offen offset:2048 sc1
  buffer_load_dwordx4 v[180:183], v2, s[8:11], s22 offen offset:3072 sc1
  s_mov_b32 s24, 659456
  s_mov_b32 s26, 673792
  v_and_b32 v64, 7, v117
  v_and_b32 v65, 1, v116
  v_lshlrev_b32 v65, 2, v65
  v_sub_u32 v64, v64, v65
  v_lshrrev_b32 v65, 3, v117
  v_lshl_add_u32 v66, v65, 2, v64
  v_cmp_gt_u32 vcc, 4, v64
  v_mov_b32 v67, 99
  s_nop 0
  v_cndmask_b32 v66, v67, v66, vcc
  v_mov_b32 v68, 0x3f80
  v_mov_b32 v69, 0x3f800000
  v_mov_b32 v4, 0
  v_cmp_eq_u32 vcc, 0, v66
  s_nop 1
  v_cndmask_b32 v4, v4, v68, vcc
  v_cmp_eq_u32 vcc, 1, v66
  s_nop 1
  v_cndmask_b32 v4, v4, v69, vcc
  v_mov_b32 v5, 0
  v_cmp_eq_u32 vcc, 2, v66
  s_nop 1
  v_cndmask_b32 v5, v5, v68, vcc
  v_cmp_eq_u32 vcc, 3, v66
  s_nop 1
  v_cndmask_b32 v5, v5, v69, vcc
  v_mov_b32 v6, 0
  v_cmp_eq_u32 vcc, 4, v66
  s_nop 1
  v_cndmask_b32 v6, v6, v68, vcc
  v_cmp_eq_u32 vcc, 5, v66
  s_nop 1
  v_cndmask_b32 v6, v6, v69, vcc
  v_mov_b32 v7, 0
  v_cmp_eq_u32 vcc, 6, v66
  s_nop 1
  v_cndmask_b32 v7, v7, v68, vcc
  v_cmp_eq_u32 vcc, 7, v66
  s_nop 1
  v_cndmask_b32 v7, v7, v69, vcc
  v_lshrrev_b32 v64, 1, v116
  v_lshrrev_b32 v65, 3, v117
  v_and_b32 v66, 1, v116
  v_and_b32 v68, 7, v117
  v_lshlrev_b32 v67, 8, v65
  v_lshl_add_u32 v67, v68, 5, v67
  v_lshl_add_u32 v67, v66, 4, v67
  v_add_u32 v69, 5184, v67
  v_add_u32 v70, 6400, v67
  v_cmp_eq_u32 vcc, v64, v65
  s_nop 1
  v_cndmask_b32 v113, v70, v69, vcc
  s_lshl_b32 s22, s17, 9
  s_add_u32 s22, s22, 9216
  v_lshl_add_u32 v114, v1, 3, s22
  s_lshr_b32 s22, s17, 1
  s_lshl_b32 s22, s22, 8
  s_and_b32 s27, s17, 1
  s_lshl_b32 s27, s27, 3
  s_add_u32 s22, s22, s27
  s_add_u32 s22, s22, 7168
  v_add_u32 v115, s22, v2
  v_mov_b32 v70, 0x40000000
  v_cmp_gt_u32 vcc, 16, v1
  s_nop 1
  v_cndmask_b32 v115, v70, v115, vcc
  v_mov_b32 v118, -1
  v_mov_b32 v119, -1
  v_and_b32 v0, 15, v1
  s_and_b32 s22, s17, 0
  s_lshl_b32 s22, s22, 7
  s_add_u32 s22, s22, 37376
  v_lshl_add_u32 v0, v0, 2, s22
  v_xor_b32 v69, 256, v2
  v_mul_i32_i24 v70, -2048, v66
  v_add_u32 v69, v69, v70
  v_add_u32 v117, 8192, v69
  v_mov_b32 v116, v73
  s_mul_i32 s35, s17, 28672
  s_add_u32 s35, s35, 4325376
  v_mov_b32 v36, 0
  v_mov_b32 v37, 0
  v_mov_b32 v38, 0
  v_mov_b32 v39, 0
  v_mov_b32 v40, 0
  v_mov_b32 v41, 0
  v_mov_b32 v42, 0
  v_mov_b32 v43, 0
  v_mov_b32 v44, 0
  v_mov_b32 v45, 0
  v_mov_b32 v46, 0
  v_mov_b32 v47, 0
  v_mov_b32 v48, 0
  v_mov_b32 v49, 0
  v_mov_b32 v50, 0
  v_mov_b32 v51, 0
  v_mov_b32 v52, 0
  v_mov_b32 v53, 0
  v_mov_b32 v54, 0
  v_mov_b32 v55, 0
  v_mov_b32 v56, 0
  v_mov_b32 v57, 0
  v_mov_b32 v58, 0
  v_mov_b32 v59, 0
  v_mov_b32 v60, 0
  v_mov_b32 v61, 0
  v_mov_b32 v62, 0
  v_mov_b32 v63, 0
  v_mov_b32 v64, 0
  v_mov_b32 v65, 0
  v_mov_b32 v66, 0
  v_mov_b32 v67, 0
  v_mov_b32 v68, 0
  v_mov_b32 v69, 0
  v_mov_b32 v70, 0
  v_mov_b32 v71, 0
  v_mov_b32 v72, 0
  v_mov_b32 v73, 0
  v_mov_b32 v74, 0
  v_mov_b32 v75, 0
  v_mov_b32 v76, 0
  v_mov_b32 v77, 0
  v_mov_b32 v78, 0
  v_mov_b32 v79, 0
  s_mov_b32 s22, 0
  v_lshrrev_b32 v14, 4, v2
  v_add_u32 v14, 128, v14
  v_min_u32 v14, 308, v14
  v_lshlrev_b32 v14, 7, v14
  buffer_load_dword v15, v14, s[8:11], s22 offen sc1
  buffer_load_dwordx4 v[80:83], v117, s[8:11], s24 offen offset:0 sc1
  buffer_load_dwordx4 v[84:87], v117, s[8:11], s24 offen offset:1024 sc1
  buffer_load_dwordx4 v[88:91], v117, s[8:11], s26 offen offset:0 sc1
  buffer_load_dwordx4 v[92:95], v117, s[8:11], s26 offen offset:1024 sc1
  buffer_load_dwordx4 v[96:99], v2, s[8:11], s24 offen offset:0 sc1
  buffer_load_dwordx4 v[100:103], v2, s[8:11], s24 offen offset:1024 sc1
  buffer_load_dwordx4 v[104:107], v2, s[8:11], s26 offen offset:0 sc1
  buffer_load_dwordx4 v[108:111], v2, s[8:11], s26 offen offset:1024 sc1
  s_add_u32 s22, s31, 311296
  buffer_load_dwordx4 v[184:187], v2, s[8:11], s22 offen offset:0 sc1
  buffer_load_dwordx4 v[188:191], v2, s[8:11], s22 offen offset:1024 sc1
  buffer_load_dwordx4 v[192:195], v2, s[8:11], s22 offen offset:2048 sc1
  buffer_load_dwordx4 v[196:199], v2, s[8:11], s22 offen offset:3072 sc1
  s_add_u32 s22, s31, 385024
  buffer_load_dwordx4 v[200:203], v2, s[8:11], s22 offen offset:2048 sc1
  buffer_load_dwordx4 v[204:207], v2, s[8:11], s22 offen offset:3072 sc1
  s_add_u32 s22, s31, 389120
  buffer_load_dwordx4 v[208:211], v2, s[8:11], s22 offen offset:0 sc1
  buffer_load_dwordx4 v[212:215], v2, s[8:11], s22 offen offset:1024 sc1
  buffer_load_dwordx4 v[216:219], v2, s[8:11], s22 offen offset:2048 sc1
  buffer_load_dwordx4 v[220:223], v2, s[8:11], s22 offen offset:3072 sc1
  s_add_u32 s22, s31, 393216
  buffer_load_dwordx4 v[224:227], v2, s[8:11], s22 offen offset:0 sc1
  buffer_load_dwordx4 v[228:231], v2, s[8:11], s22 offen offset:1024 sc1
  buffer_load_dwordx4 v[232:235], v2, s[8:11], s22 offen offset:2048 sc1
  buffer_load_dwordx4 v[236:239], v2, s[8:11], s22 offen offset:3072 sc1
  s_add_u32 s22, s31, 397312
  buffer_load_dwordx4 v[240:243], v2, s[8:11], s22 offen offset:0 sc1
  buffer_load_dwordx4 v[244:247], v2, s[8:11], s22 offen offset:1024 sc1
  buffer_load_dwordx4 v[248:251], v2, s[8:11], s22 offen offset:2048 sc1
  buffer_load_dwordx4 v[252:255], v2, s[8:11], s22 offen offset:3072 sc1
  s_waitcnt vmcnt(0) lgkmcnt(0)
  s_mov_b32 s31, 0
  s_cmp_lg_u32 s88, 0
  s_cbranch_scc1 cB_sc2_loop
  s_branch cA_sc2_loop
ch_init3:
  s_mul_i32 s31, s17, 401408
  s_add_u32 s31, s31, 33554432
  s_and_b32 s28, s84, 12384
  s_lshl_b32 s22, s85, 16
  s_or_b32 s28, s28, s22
  s_cmp_eq_u32 s28, 4294914144
  s_cbranch_scc1 ch_wx3_ok
  s_mov_b32 s30, 0
ch_wr3:
  buffer_load_dword v9, off, s[12:15], 0 offset:132 sc1
  s_waitcnt vmcnt(0)
  v_cmp_ne_u32 vcc, 1, v9
  s_cbranch_vccz ch_wr3_ok
  s_sleep 8
  s_add_u32 s30, s30, 1
  s_cmp_lt_u32 s30, 400000
  s_cbranch_scc1 ch_wr3
  s_branch cA_abort
ch_wr3_ok:
  s_lshl_b32 s27, s17, 7
  s_add_u32 s27, s27, 584192
  s_mov_b32 s28, 12384
  s_mov_b32 s30, 0
ch_wb3:
  buffer_load_dword v9, off, s[8:11], s27  sc1
  s_waitcnt vmcnt(0)
  v_and_b32 v10, s28, v9
  v_cmp_ne_u32 vcc, s28, v10
  s_cbranch_vccz ch_wb3_ok
  s_sleep 3
  s_add_u32 s30, s30, 1
  s_cmp_lt_u32 s30, 400000
  s_cbranch_scc1 ch_wb3
  s_branch cA_abort
ch_wb3_ok:
  s_mov_b32 s29, 586240
  s_mov_b32 s28, 0xffff
  s_mov_b32 s30, 0
ch_wx3:
  buffer_load_dword v9, off, s[8:11], s29  sc1
  s_waitcnt vmcnt(0)
  v_and_b32 v10, s28, v9
  v_cmp_ne_u32 vcc, s28, v10
  s_cbranch_vccz ch_wx3_ok
  s_sleep 8
  s_add_u32 s30, s30, 1
  s_cmp_lt_u32 s30, 400000
  s_cbranch_scc1 ch_wx3
  s_branch cA_abort
ch_wx3_ok:
  s_add_u32 s22, s31, 315392
  buffer_load_dwordx4 a[224:227], v2, s[8:11], s22 offen offset:0 sc1
  buffer_load_dwordx4 a[228:231], v2, s[8:11], s22 offen offset:1024 sc1
  buffer_load_dwordx4 a[232:235], v2, s[8:11], s22 offen offset:2048 sc1
  buffer_load_dwordx4 a[236:239], v2, s[8:11], s22 offen offset:3072 sc1
  s_add_u32 s22, s31, 319488
  buffer_load_dwordx4 a[240:243], v2, s[8:11], s22 offen offset:0 sc1
  buffer_load_dwordx4 a[244:247], v2, s[8:11], s22 offen offset:1024 sc1
  buffer_load_dwordx4 a[248:251], v2, s[8:11], s22 offen offset:2048 sc1
  buffer_load_dwordx4 a[252:255], v2, s[8:11], s22 offen offset:3072 sc1
  s_add_u32 s22, s31, 323584
  buffer_load_dwordx4 v[120:123], v2, s[8:11], s22 offen offset:0 sc1
  buffer_load_dwordx4 v[124:127], v2, s[8:11], s22 offen offset:1024 sc1
  buffer_load_dwordx4 v[128:131], v2, s[8:11], s22 offen offset:2048 sc1
  buffer_load_dwordx4 v[132:135], v2, s[8:11], s22 offen offset:3072 sc1
  s_add_u32 s22, s31, 327680
  buffer_load_dwordx4 v[136:139], v2, s[8:11], s22 offen offset:0 sc1
  buffer_load_dwordx4 v[140:143], v2, s[8:11], s22 offen offset:1024 sc1
  buffer_load_dwordx4 v[144:147], v2, s[8:11], s22 offen offset:2048 sc1
  buffer_load_dwordx4 v[148:151], v2, s[8:11], s22 offen offset:3072 sc1
  s_add_u32 s22, s31, 331776
  buffer_load_dwordx4 v[152:155], v2, s[8:11], s22 offen offset:0 sc1
  buffer_load_dwordx4 v[156:159], v2, s[8:11], s22 offen offset:1024 sc1
  buffer_load_dwordx4 v[160:163], v2, s[8:11], s22 offen offset:2048 sc1
  buffer_load_dwordx4 v[164:167], v2, s[8:11], s22 offen offset:3072 sc1
  s_add_u32 s22, s31, 335872
  buffer_load_dwordx4 v[168:171], v2, s[8:11], s22 offen offset:0 sc1
  buffer_load_dwordx4 v[172:175], v2, s[8:11], s22 offen offset:1024 sc1
  buffer_load_dwordx4 v[176:179], v2, s[8:11], s22 offen offset:2048 sc1
  buffer_load_dwordx4 v[180:183], v2, s[8:11], s22 offen offset:3072 sc1
  s_mov_b32 s24, 661504
  s_mov_b32 s26, 675840
  v_and_b32 v64, 7, v117
  v_and_b32 v65, 1, v116
  v_lshlrev_b32 v65, 2, v65
  v_sub_u32 v64, v64, v65
  v_lshrrev_b32 v65, 3, v117
  v_lshl_add_u32 v66, v65, 2, v64
  v_cmp_gt_u32 vcc, 4, v64
  v_mov_b32 v67, 99
  s_nop 0
  v_cndmask_b32 v66, v67, v66, vcc
  v_mov_b32 v68, 0x3f80
  v_mov_b32 v69, 0x3f800000
  v_mov_b32 v4, 0
  v_cmp_eq_u32 vcc, 0, v66
  s_nop 1
  v_cndmask_b32 v4, v4, v68, vcc
  v_cmp_eq_u32 vcc, 1, v66
  s_nop 1
  v_cndmask_b32 v4, v4, v69, vcc
  v_mov_b32 v5, 0
  v_cmp_eq_u32 vcc, 2, v66
  s_nop 1
  v_cndmask_b32 v5, v5, v68, vcc
  v_cmp_eq_u32 vcc, 3, v66
  s_nop 1
  v_cndmask_b32 v5, v5, v69, vcc
  v_mov_b32 v6, 0
  v_cmp_eq_u32 vcc, 4, v66
  s_nop 1
  v_cndmask_b32 v6, v6, v68, vcc
  v_cmp_eq_u32 vcc, 5, v66
  s_nop 1
  v_cndmask_b32 v6, v6, v69, vcc
  v_mov_b32 v7, 0
  v_cmp_eq_u32 vcc, 6, v66
  s_nop 1
  v_cndmask_b32 v7, v7, v68, vcc
  v_cmp_eq_u32 vcc, 7, v66
  s_nop 1
  v_cndmask_b32 v7, v7, v69, vcc
  v_lshrrev_b32 v64, 1, v116
  v_lshrrev_b32 v65, 3, v117
  v_and_b32 v66, 1, v116
  v_and_b32 v68, 7, v117
  v_lshlrev_b32 v67, 8, v65
  v_lshl_add_u32 v67, v68, 5, v67
  v_lshl_add_u32 v67, v66, 4, v67
  v_add_u32 v69, 5696, v67
  v_add_u32 v70, 6400, v67
  v_cmp_eq_u32 vcc, v64, v65
  s_nop 1
  v_cndmask_b32 v113, v70, v69, vcc
  v_and_b32 v0, 15, v1
  s_and_b32 s22, s17, 0
  s_lshl_b32 s22, s22, 7
  s_add_u32 s22, s22, 37376
  v_lshl_add_u32 v0, v0, 2, s22
  v_xor_b32 v69, 256, v2
  v_mul_i32_i24 v70, 2048, v66
  v_add_u32 v69, v69, v70
  v_add_u32 v117, 4096, v69
  v_mov_b32 v116, v73
  s_mul_i32 s35, s17, 28672
  s_add_u32 s35, s35, 4325376
  v_mov_b32 v36, 0
  v_mov_b32 v37, 0
  v_mov_b32 v38, 0
  v_mov_b32 v39, 0
  v_mov_b32 v40, 0
  v_mov_b32 v41, 0
  v_mov_b32 v42, 0
  v_mov_b32 v43, 0
  v_mov_b32 v44, 0
  v_mov_b32 v45, 0
  v_mov_b32 v46, 0
  v_mov_b32 v47, 0
  v_mov_b32 v48, 0
  v_mov_b32 v49, 0
  v_mov_b32 v50, 0
  v_mov_b32 v51, 0
  v_mov_b32 v52, 0
  v_mov_b32 v53, 0
  v_mov_b32 v54, 0
  v_mov_b32 v55, 0
  v_mov_b32 v56, 0
  v_mov_b32 v57, 0
  v_mov_b32 v58, 0
  v_mov_b32 v59, 0
  v_mov_b32 v60, 0
  v_mov_b32 v61, 0
  v_mov_b32 v62, 0
  v_mov_b32 v63, 0
  v_mov_b32 v64, 0
  v_mov_b32 v65, 0
  v_mov_b32 v66, 0
  v_mov_b32 v67, 0
  v_mov_b32 v68, 0
  v_mov_b32 v69, 0
  v_mov_b32 v70, 0
  v_mov_b32 v71, 0
  v_mov_b32 v72, 0
  v_mov_b32 v73, 0
  v_mov_b32 v74, 0
  v_mov_b32 v75, 0
  v_mov_b32 v76, 0
  v_mov_b32 v77, 0
  v_mov_b32 v78, 0
  v_mov_b32 v79, 0
  s_mov_b32 s22, 0
  v_lshrrev_b32 v14, 4, v2
  v_add_u32 v14, 192, v14
  v_min_u32 v14, 308, v14
  v_lshlrev_b32 v14, 7, v14
  buffer_load_dword v15, v14, s[8:11], s22 offen sc1
  buffer_load_dwordx4 v[80:83], v117, s[8:11], s24 offen offset:0 sc1
  buffer_load_dwordx4 v[84:87], v117, s[8:11], s24 offen offset:1024 sc1
  buffer_load_dwordx4 v[88:91], v117, s[8:11], s26 offen offset:0 sc1
  buffer_load_dwordx4 v[92:95], v117, s[8:11], s26 offen offset:1024 sc1
  buffer_load_dwordx4 v[96:99], v2, s[8:11], s24 offen offset:0 sc1
  buffer_load_dwordx4 v[100:103], v2, s[8:11], s24 offen offset:1024 sc1
  buffer_load_dwordx4 v[104:107], v2, s[8:11], s26 offen offset:0 sc1
  buffer_load_dwordx4 v[108:111], v2, s[8:11], s26 offen offset:1024 sc1
  s_add_u32 s22, s31, 339968
  buffer_load_dwordx4 v[184:187], v2, s[8:11], s22 offen offset:0 sc1
  buffer_load_dwordx4 v[188:191], v2, s[8:11], s22 offen offset:1024 sc1
  buffer_load_dwordx4 v[192:195], v2, s[8:11], s22 offen offset:2048 sc1
  buffer_load_dwordx4 v[196:199], v2, s[8:11], s22 offen offset:3072 sc1
  s_add_u32 s22, s31, 356352
  buffer_load_dwordx4 v[200:203], v2, s[8:11], s22 offen offset:2048 sc1
  buffer_load_dwordx4 v[204:207], v2, s[8:11], s22 offen offset:3072 sc1
  s_add_u32 s22, s31, 360448
  buffer_load_dwordx4 v[208:211], v2, s[8:11], s22 offen offset:0 sc1
  buffer_load_dwordx4 v[212:215], v2, s[8:11], s22 offen offset:1024 sc1
  buffer_load_dwordx4 v[216:219], v2, s[8:11], s22 offen offset:2048 sc1
  buffer_load_dwordx4 v[220:223], v2, s[8:11], s22 offen offset:3072 sc1
  s_add_u32 s22, s31, 364544
  buffer_load_dwordx4 v[224:227], v2, s[8:11], s22 offen offset:0 sc1
  buffer_load_dwordx4 v[228:231], v2, s[8:11], s22 offen offset:1024 sc1
  buffer_load_dwordx4 v[232:235], v2, s[8:11], s22 offen offset:2048 sc1
  buffer_load_dwordx4 v[236:239], v2, s[8:11], s22 offen offset:3072 sc1
  s_add_u32 s22, s31, 368640
  buffer_load_dwordx4 v[240:243], v2, s[8:11], s22 offen offset:0 sc1
  buffer_load_dwordx4 v[244:247], v2, s[8:11], s22 offen offset:1024 sc1
  buffer_load_dwordx4 v[248:251], v2, s[8:11], s22 offen offset:2048 sc1
  buffer_load_dwordx4 v[252:255], v2, s[8:11], s22 offen offset:3072 sc1
  s_waitcnt vmcnt(0) lgkmcnt(0)
  s_mov_b32 s31, 0
  s_cmp_lg_u32 s88, 0
  s_cbranch_scc1 cB_sc3_loop
  s_branch cA_sc3_loop
ch_init4:
  v_mov_b32 v72, v116
  v_mov_b32 v73, v117
  v_lshrrev_b32 v65, 1, v72
  v_and_b32 v66, 1, v72
  v_mov_b32 v36, 0
  v_mov_b32 v37, 0
  v_mov_b32 v38, 0
  v_mov_b32 v39, 0
  v_mov_b32 v40, 0
  v_mov_b32 v41, 0
  v_mov_b32 v42, 0
  v_mov_b32 v43, 0
  v_mov_b32 v44, 0
  v_mov_b32 v45, 0
  v_mov_b32 v46, 0
  v_mov_b32 v47, 0
  v_mov_b32 v48, 0
  v_mov_b32 v49, 0
  v_mov_b32 v50, 0
  v_mov_b32 v51, 0
  v_mov_b32 v52, 0
  v_mov_b32 v53, 0
  v_mov_b32 v54, 0
  v_mov_b32 v55, 0
  v_mov_b32 v56, 0
  v_mov_b32 v57, 0
  v_mov_b32 v58, 0
  v_mov_b32 v59, 0
  v_mov_b32 v60, 0
  v_mov_b32 v61, 0
  v_mov_b32 v62, 0
  v_mov_b32 v63, 0
  v_lshlrev_b32 v75, 2, v65
  v_lshl_add_u32 v75, v66, 3, v75
  v_add_u32 v67, 0, v73
  v_mul_u32_u24 v68, 2341, v67
  v_lshrrev_b32 v68, 16, v68
  v_mul_u32_u24 v69, 28, v68
  v_sub_u32 v69, v67, v69
  v_lshrrev_b32 v70, 4, v69
  v_and_b32 v69, 15, v69
  v_lshlrev_b32 v71, 12, v70
  v_lshl_add_u32 v71, v68, 8, v71
  v_lshl_add_u32 v71, v69, 4, v71
  v_add_u32 v152, v71, v75
  v_add_u32 v67, 16, v73
  v_mul_u32_u24 v68, 2341, v67
  v_lshrrev_b32 v68, 16, v68
  v_mul_u32_u24 v69, 28, v68
  v_sub_u32 v69, v67, v69
  v_lshrrev_b32 v70, 4, v69
  v_and_b32 v69, 15, v69
  v_lshlrev_b32 v71, 12, v70
  v_lshl_add_u32 v71, v68, 8, v71
  v_lshl_add_u32 v71, v69, 4, v71
  v_add_u32 v153, v71, v75
  v_add_u32 v67, 32, v73
  v_mul_u32_u24 v68, 2341, v67
  v_lshrrev_b32 v68, 16, v68
  v_mul_u32_u24 v69, 28, v68
  v_sub_u32 v69, v67, v69
  v_lshrrev_b32 v70, 4, v69
  v_and_b32 v69, 15, v69
  v_lshlrev_b32 v71, 12, v70
  v_lshl_add_u32 v71, v68, 8, v71
  v_lshl_add_u32 v71, v69, 4, v71
  v_add_u32 v154, v71, v75
  v_add_u32 v67, 48, v73
  v_mul_u32_u24 v68, 2341, v67
  v_lshrrev_b32 v68, 16, v68
  v_mul_u32_u24 v69, 28, v68
  v_sub_u32 v69, v67, v69
  v_lshrrev_b32 v70, 4, v69
  v_and_b32 v69, 15, v69
  v_lshlrev_b32 v71, 12, v70
  v_lshl_add_u32 v71, v68, 8, v71
  v_lshl_add_u32 v71, v69, 4, v71
  v_add_u32 v155, v71, v75
  v_add_u32 v67, 64, v73
  v_mul_u32_u24 v68, 2341, v67
  v_lshrrev_b32 v68, 16, v68
  v_mul_u32_u24 v69, 28, v68
  v_sub_u32 v69, v67, v69
  v_lshrrev_b32 v70, 4, v69
  v_and_b32 v69, 15, v69
  v_lshlrev_b32 v71, 12, v70
  v_lshl_add_u32 v71, v68, 8, v71
  v_lshl_add_u32 v71, v69, 4, v71
  v_add_u32 v156, v71, v75
  v_add_u32 v67, 80, v73
  v_mul_u32_u24 v68, 2341, v67
  v_lshrrev_b32 v68, 16, v68
  v_mul_u32_u24 v69, 28, v68
  v_sub_u32 v69, v67, v69
  v_lshrrev_b32 v70, 4, v69
  v_and_b32 v69, 15, v69
  v_lshlrev_b32 v71, 12, v70
  v_lshl_add_u32 v71, v68, 8, v71
  v_lshl_add_u32 v71, v69, 4, v71
  v_add_u32 v157, v71, v75
  v_mov_b32 v74, 0x40000000
  v_mov_b32 v164, 0
  v_mov_b32 v76, 0
  v_mov_b32 v77, 0
  v_mov_b32 v78, 0
  v_mov_b32 v79, 0
  ds_write_b128 v2, v[76:79] offset:0
  ds_write_b128 v2, v[76:79] offset:1024
  ds_write_b128 v2, v[76:79] offset:2048
  ds_write_b128 v2, v[76:79] offset:3072
  s_and_b32 s22, s17, 0
  s_lshl_b32 s22, s22, 7
  s_add_u32 s22, s22, 35328
  v_lshl_add_u32 v4, v73, 2, s22
  v_and_b32 v64, 1, v73
  v_mov_b32 v5, 0x05040100
  v_mov_b32 v65, 0x03020706
  v_cmp_eq_u32 vcc, 1, v64
  s_nop 1
  v_cndmask_b32 v5, v5, v65, vcc
  s_lshl_b32 s22, s17, 2
  s_add_u32 s22, s22, 37376
  v_lshl_add_u32 v7, v1, 7, s22
  v_cmp_gt_u32 vcc, 1, v1
  s_nop 1
  v_cndmask_b32 v7, v74, v7, vcc
  v_mov_b32 v6, v2
  v_lshl_add_u32 v64, v66, 2, v64
  v_and_b32 v65, 2, v72
  v_add_u32 v64, v64, v65
  s_mul_i32 s22, s17, 16
  v_add_u32 v75, s22, v73
  v_lshrrev_b32 v68, 4, v75
  v_lshlrev_b32 v68, 8, v68
  v_bfe_u32 v69, v75, 1, 1
  v_lshl_add_u32 v68, v69, 7, v68
  v_lshl_add_u32 v68, v64, 4, v68
  v_and_b32 v69, 12, v75
  v_add_u32 v1, v68, v69
  s_mul_i32 s22, s17, 28672
  s_add_u32 s25, s22, 2490368
  s_and_b32 s27, s17, 0
  s_xor_b32 s22, s27, 0
  s_mul_i32 s80, s22, 7168
  s_lshl_b32 s22, s22, 11
  s_add_u32 s76, s22, 9216
  s_xor_b32 s22, s27, 1
  s_mul_i32 s81, s22, 7168
  s_lshl_b32 s22, s22, 11
  s_add_u32 s77, s22, 9216
  s_xor_b32 s22, s27, 2
  s_mul_i32 s82, s22, 7168
  s_lshl_b32 s22, s22, 11
  s_add_u32 s78, s22, 9216
  s_xor_b32 s22, s27, 3
  s_mul_i32 s83, s22, 7168
  s_lshl_b32 s22, s22, 11
  s_add_u32 s79, s22, 9216
  v_mov_b32 v162, -1
  s_mov_b32 s38, 0x40000000
  s_mul_i32 s31, s17, 401408
  s_add_u32 s31, s31, 39976960
  s_mov_b32 s30, 0
ch_wr4:
  buffer_load_dword v9, off, s[12:15], 0 offset:128 sc1
  s_waitcnt vmcnt(0)
  v_cmp_ne_u32 vcc, 1, v9
  s_cbranch_vccz ch_wr4_ok
  s_sleep 8
  s_add_u32 s30, s30, 1
  s_cmp_lt_u32 s30, 400000
  s_cbranch_scc1 ch_wr4
  s_branch cA_abort
ch_wr4_ok:
  s_lshr_b32 s22, s17, 2
  s_lshl_b32 s28, 0x81, s22
  s_mul_i32 s27, s17, 12
  s_add_u32 s22, s27, 256
  s_lshr_b32 s22, s22, 6
  s_lshl_b32 s22, 0x81, s22
  s_or_b32 s28, s28, s22
  s_add_u32 s22, s27, 267
  s_lshr_b32 s22, s22, 6
  s_lshl_b32 s22, 0x81, s22
  s_or_b32 s28, s28, s22
  v_lshrrev_b32 v12, 8, v2
  v_lshlrev_b32 v12, 7, v12
  s_mov_b32 s27, 582144
  s_mov_b32 s30, 0
ch_ww4:
  buffer_load_dword v9, v12, s[8:11], s27 offen sc1
  s_waitcnt vmcnt(0)
  v_and_b32 v10, s28, v9
  v_cmp_ne_u32 vcc, s28, v10
  s_cbranch_vccz ch_ww4_ok
  s_sleep 3
  s_add_u32 s30, s30, 1
  s_cmp_lt_u32 s30, 400000
  s_cbranch_scc1 ch_ww4
  s_branch cA_abort
ch_ww4_ok:
  s_add_u32 s22, s31, 0
  buffer_load_dwordx4 a[0:3], v2, s[8:11], s22 offen offset:0 sc1
  buffer_load_dwordx4 a[4:7], v2, s[8:11], s22 offen offset:1024 sc1
  buffer_load_dwordx4 a[8:11], v2, s[8:11], s22 offen offset:2048 sc1
  buffer_load_dwordx4 a[12:15], v2, s[8:11], s22 offen offset:3072 sc1
  s_add_u32 s22, s31, 4096
  buffer_load_dwordx4 a[16:19], v2, s[8:11], s22 offen offset:0 sc1
  buffer_load_dwordx4 a[20:23], v2, s[8:11], s22 offen offset:1024 sc1
  buffer_load_dwordx4 a[24:27], v2, s[8:11], s22 offen offset:2048 sc1
  buffer_load_dwordx4 a[28:31], v2, s[8:11], s22 offen offset:3072 sc1
  s_add_u32 s22, s31, 8192
  buffer_load_dwordx4 a[32:35], v2, s[8:11], s22 offen offset:0 sc1
  buffer_load_dwordx4 a[36:39], v2, s[8:11], s22 offen offset:1024 sc1
  buffer_load_dwordx4 a[40:43], v2, s[8:11], s22 offen offset:2048 sc1
  buffer_load_dwordx4 a[44:47], v2, s[8:11], s22 offen offset:3072 sc1
  s_add_u32 s22, s31, 12288
  buffer_load_dwordx4 a[48:51], v2, s[8:11], s22 offen offset:0 sc1
  buffer_load_dwordx4 a[52:55], v2, s[8:11], s22 offen offset:1024 sc1
  buffer_load_dwordx4 a[56:59], v2, s[8:11], s22 offen offset:2048 sc1
  buffer_load_dwordx4 a[60:63], v2, s[8:11], s22 offen offset:3072 sc1
  s_add_u32 s22, s31, 16384
  buffer_load_dwordx4 a[64:67], v2, s[8:11], s22 offen offset:0 sc1
  buffer_load_dwordx4 a[68:71], v2, s[8:11], s22 offen offset:1024 sc1
  buffer_load_dwordx4 a[72:75], v2, s[8:11], s22 offen offset:2048 sc1
  buffer_load_dwordx4 a[76:79], v2, s[8:11], s22 offen offset:3072 sc1
  s_add_u32 s22, s31, 20480
  buffer_load_dwordx4 a[80:83], v2, s[8:11], s22 offen offset:0 sc1
  buffer_load_dwordx4 a[84:87], v2, s[8:11], s22 offen offset:1024 sc1
  buffer_load_dwordx4 a[88:91], v2, s[8:11], s22 offen offset:2048 sc1
  buffer_load_dwordx4 a[92:95], v2, s[8:11], s22 offen offset:3072 sc1
  s_add_u32 s22, s31, 24576
  buffer_load_dwordx4 a[96:99], v2, s[8:11], s22 offen offset:0 sc1
  buffer_load_dwordx4 a[100:103], v2, s[8:11], s22 offen offset:1024 sc1
  buffer_load_dwordx4 a[104:107], v2, s[8:11], s22 offen offset:2048 sc1
  buffer_load_dwordx4 a[108:111], v2, s[8:11], s22 offen offset:3072 sc1
  s_add_u32 s22, s31, 28672
  buffer_load_dwordx4 a[112:115], v2, s[8:11], s22 offen offset:0 sc1
  buffer_load_dwordx4 a[116:119], v2, s[8:11], s22 offen offset:1024 sc1
  buffer_load_dwordx4 a[120:123], v2, s[8:11], s22 offen offset:2048 sc1
  buffer_load_dwordx4 a[124:127], v2, s[8:11], s22 offen offset:3072 sc1
  s_waitcnt vmcnt(24)
  s_add_u32 s22, s31, 32768
  buffer_load_dwordx4 a[128:131], v2, s[8:11], s22 offen offset:0 sc1
  buffer_load_dwordx4 a[132:135], v2, s[8:11], s22 offen offset:1024 sc1
  buffer_load_dwordx4 a[136:139], v2, s[8:11], s22 offen offset:2048 sc1
  buffer_load_dwordx4 a[140:143], v2, s[8:11], s22 offen offset:3072 sc1
  s_add_u32 s22, s31, 36864
  buffer_load_dwordx4 a[144:147], v2, s[8:11], s22 offen offset:0 sc1
  buffer_load_dwordx4 a[148:151], v2, s[8:11], s22 offen offset:1024 sc1
  buffer_load_dwordx4 a[152:155], v2, s[8:11], s22 offen offset:2048 sc1
  buffer_load_dwordx4 a[156:159], v2, s[8:11], s22 offen offset:3072 sc1
  s_add_u32 s22, s31, 40960
  buffer_load_dwordx4 a[160:163], v2, s[8:11], s22 offen offset:0 sc1
  buffer_load_dwordx4 a[164:167], v2, s[8:11], s22 offen offset:1024 sc1
  buffer_load_dwordx4 a[168:171], v2, s[8:11], s22 offen offset:2048 sc1
  buffer_load_dwordx4 a[172:175], v2, s[8:11], s22 offen offset:3072 sc1
  s_add_u32 s22, s31, 45056
  buffer_load_dwordx4 a[176:179], v2, s[8:11], s22 offen offset:0 sc1
  buffer_load_dwordx4 a[180:183], v2, s[8:11], s22 offen offset:1024 sc1
  buffer_load_dwordx4 a[184:187], v2, s[8:11], s22 offen offset:2048 sc1
  buffer_load_dwordx4 a[188:191], v2, s[8:11], s22 offen offset:3072 sc1
  s_add_u32 s22, s31, 49152
  buffer_load_dwordx4 a[192:195], v2, s[8:11], s22 offen offset:0 sc1
  buffer_load_dwordx4 a[196:199], v2, s[8:11], s22 offen offset:1024 sc1
  buffer_load_dwordx4 a[200:203], v2, s[8:11], s22 offen offset:2048 sc1
  buffer_load_dwordx4 a[204:207], v2, s[8:11], s22 offen offset:3072 sc1
  s_add_u32 s22, s31, 53248
  buffer_load_dwordx4 a[208:211], v2, s[8:11], s22 offen offset:0 sc1
  buffer_load_dwordx4 a[212:215], v2, s[8:11], s22 offen offset:1024 sc1
  buffer_load_dwordx4 a[216:219], v2, s[8:11], s22 offen offset:2048 sc1
  buffer_load_dwordx4 a[220:223], v2, s[8:11], s22 offen offset:3072 sc1
  s_add_u32 s22, s31, 57344
  buffer_load_dwordx4 a[224:227], v2, s[8:11], s22 offen offset:0 sc1
  buffer_load_dwordx4 a[228:231], v2, s[8:11], s22 offen offset:1024 sc1
  buffer_load_dwordx4 a[232:235], v2, s[8:11], s22 offen offset:2048 sc1
  buffer_load_dwordx4 a[236:239], v2, s[8:11], s22 offen offset:3072 sc1
  s_add_u32 s22, s31, 61440
  buffer_load_dwordx4 a[240:243], v2, s[8:11], s22 offen offset:0 sc1
  buffer_load_dwordx4 a[244:247], v2, s[8:11], s22 offen offset:1024 sc1
  buffer_load_dwordx4 a[248:251], v2, s[8:11], s22 offen offset:2048 sc1
  buffer_load_dwordx4 a[252:255], v2, s[8:11], s22 offen offset:3072 sc1
  s_waitcnt vmcnt(24)
  s_add_u32 s22, s31, 65536
  buffer_load_dwordx4 v[176:179], v2, s[8:11], s22 offen offset:0 sc1
  buffer_load_dwordx4 v[180:183], v2, s[8:11], s22 offen offset:1024 sc1
  buffer_load_dwordx4 v[184:187], v2, s[8:11], s22 offen offset:2048 sc1
  buffer_load_dwordx4 v[188:191], v2, s[8:11], s22 offen offset:3072 sc1
  s_add_u32 s22, s31, 69632
  buffer_load_dwordx4 v[192:195], v2, s[8:11], s22 offen offset:0 sc1
  buffer_load_dwordx4 v[196:199], v2, s[8:11], s22 offen offset:1024 sc1
  buffer_load_dwordx4 v[200:203], v2, s[8:11], s22 offen offset:2048 sc1
  buffer_load_dwordx4 v[204:207], v2, s[8:11], s22 offen offset:3072 sc1
  s_add_u32 s22, s31, 73728
  buffer_load_dwordx4 v[208:211], v2, s[8:11], s22 offen offset:0 sc1
  buffer_load_dwordx4 v[212:215], v2, s[8:11], s22 offen offset:1024 sc1
  buffer_load_dwordx4 v[216:219], v2, s[8:11], s22 offen offset:2048 sc1
  buffer_load_dwordx4 v[220:223], v2, s[8:11], s22 offen offset:3072 sc1
  s_add_u32 s22, s31, 77824
  buffer_load_dwordx4 v[224:227], v2, s[8:11], s22 offen offset:0 sc1
  buffer_load_dwordx4 v[228:231], v2, s[8:11], s22 offen offset:1024 sc1
  buffer_load_dwordx4 v[232:235], v2, s[8:11], s22 offen offset:2048 sc1
  buffer_load_dwordx4 v[236:239], v2, s[8:11], s22 offen offset:3072 sc1
  s_add_u32 s22, s31, 81920
  buffer_load_dwordx4 v[240:243], v2, s[8:11], s22 offen offset:0 sc1
  buffer_load_dwordx4 v[244:247], v2, s[8:11], s22 offen offset:1024 sc1
  buffer_load_dwordx4 v[248:251], v2, s[8:11], s22 offen offset:2048 sc1
  buffer_load_dwordx4 v[252:255], v2, s[8:11], s22 offen offset:3072 sc1
  s_mov_b32 m0, 16384
  s_add_u32 s22, s31, 86016
  buffer_load_dwordx4 v2, s[8:11], s22 offen offset:0 sc1 lds
  buffer_load_dwordx4 v2, s[8:11], s22 offen offset:1024 sc1 lds
  buffer_load_dwordx4 v2, s[8:11], s22 offen offset:2048 sc1 lds
  buffer_load_dwordx4 v2, s[8:11], s22 offen offset:3072 sc1 lds
  s_mov_b32 m0, 20480
  s_add_u32 s22, s31, 90112
  buffer_load_dwordx4 v2, s[8:11], s22 offen offset:0 sc1 lds
  buffer_load_dwordx4 v2, s[8:11], s22 offen offset:1024 sc1 lds
  buffer_load_dwordx4 v2, s[8:11], s22 offen offset:2048 sc1 lds
  buffer_load_dwordx4 v2, s[8:11], s22 offen offset:3072 sc1 lds
  s_mov_b32 m0, 24576
  s_add_u32 s22, s31, 94208
  buffer_load_dwordx4 v2, s[8:11], s22 offen offset:0 sc1 lds
  buffer_load_dwordx4 v2, s[8:11], s22 offen offset:1024 sc1 lds
  buffer_load_dwordx4 v2, s[8:11], s22 offen offset:2048 sc1 lds
  buffer_load_dwordx4 v2, s[8:11], s22 offen offset:3072 sc1 lds
  s_mov_b32 m0, 28672
  s_add_u32 s22, s31, 98304
  buffer_load_dwordx4 v2, s[8:11], s22 offen offset:0 sc1 lds
  buffer_load_dwordx4 v2, s[8:11], s22 offen offset:1024 sc1 lds
  s_mov_b32 s30, 0
ch_ws4:
  buffer_load_dword v9, off, s[12:15], 0 offset:132 sc1
  s_waitcnt vmcnt(0)
  v_cmp_ne_u32 vcc, 1, v9
  s_cbranch_vccz ch_ws4_ok
  s_sleep 8
  s_add_u32 s30, s30, 1
  s_cmp_lt_u32 s30, 400000
  s_cbranch_scc1 ch_ws4
  s_branch cA_abort
ch_ws4_ok:
  s_mul_i32 s33, s17, 532480
  s_add_u32 s33, s33, 78110720
  v_mov_b32 v12, -1
  v_mov_b32 v13, -1
  v_mov_b32 v14, -1
  v_mov_b32 v15, -1
  s_add_u32 s22, s33, 0
  buffer_store_dwordx4 v[12:15], v2, s[8:11], s22 offen sc1
  s_add_u32 s22, s33, 2048
  buffer_store_dwordx4 v[12:15], v2, s[8:11], s22 offen sc1
  s_add_u32 s22, s33, 4096
  buffer_store_dwordx4 v[12:15], v2, s[8:11], s22 offen sc1
  s_add_u32 s22, s33, 6144
  buffer_store_dwordx4 v[12:15], v2, s[8:11], s22 offen sc1
  s_add_u32 s22, s33, 8192
  buffer_store_dwordx4 v[12:15], v2, s[8:11], s22 offen sc1
  s_add_u32 s22, s33, 10240
  buffer_store_dwordx4 v[12:15], v2, s[8:11], s22 offen sc1
  s_add_u32 s22, s33, 12288
  buffer_store_dwordx4 v[12:15], v2, s[8:11], s22 offen sc1
  s_add_u32 s22, s33, 14336
  buffer_store_dwordx4 v[12:15], v2, s[8:11], s22 offen sc1
  v_mov_b32 v16, 1
  v_mov_b32 v17, 1
  s_lshl_b32 s22, s17, 10
  s_add_u32 s22, s22, 566240
  s_waitcnt vmcnt(0)
  s_mov_b64 exec, 3
  buffer_store_dwordx2 v[16:17], v2, s[8:11], s22 offen sc1
  s_mov_b64 exec, -1
  s_mov_b32 s28, s35
  s_waitcnt vmcnt(0) lgkmcnt(0)
  s_mov_b32 s31, 0
  s_cmp_lg_u32 s88, 0
  s_cbranch_scc1 cB_va0_loop
  s_branch cA_va0_loop
ch_init5:
  v_mov_b32 v72, v116
  v_mov_b32 v73, v117
  v_lshrrev_b32 v65, 1, v72
  v_and_b32 v66, 1, v72
  v_mov_b32 v36, 0
  v_mov_b32 v37, 0
  v_mov_b32 v38, 0
  v_mov_b32 v39, 0
  v_mov_b32 v40, 0
  v_mov_b32 v41, 0
  v_mov_b32 v42, 0
  v_mov_b32 v43, 0
  v_mov_b32 v44, 0
  v_mov_b32 v45, 0
  v_mov_b32 v46, 0
  v_mov_b32 v47, 0
  v_mov_b32 v48, 0
  v_mov_b32 v49, 0
  v_mov_b32 v50, 0
  v_mov_b32 v51, 0
  v_mov_b32 v52, 0
  v_mov_b32 v53, 0
  v_mov_b32 v54, 0
  v_mov_b32 v55, 0
  v_mov_b32 v56, 0
  v_mov_b32 v57, 0
  v_mov_b32 v58, 0
  v_mov_b32 v59, 0
  v_mov_b32 v60, 0
  v_mov_b32 v61, 0
  v_mov_b32 v62, 0
  v_mov_b32 v63, 0
  v_lshlrev_b32 v75, 2, v65
  v_lshl_add_u32 v75, v66, 3, v75
  v_add_u32 v67, 112, v73
  v_mul_u32_u24 v68, 2341, v67
  v_lshrrev_b32 v68, 16, v68
  v_mul_u32_u24 v69, 28, v68
  v_sub_u32 v69, v67, v69
  v_lshrrev_b32 v70, 4, v69
  v_and_b32 v69, 15, v69
  v_lshlrev_b32 v71, 12, v70
  v_lshl_add_u32 v71, v68, 8, v71
  v_lshl_add_u32 v71, v69, 4, v71
  v_add_u32 v152, v71, v75
  v_add_u32 v67, 128, v73
  v_mul_u32_u24 v68, 2341, v67
  v_lshrrev_b32 v68, 16, v68
  v_mul_u32_u24 v69, 28, v68
  v_sub_u32 v69, v67, v69
  v_lshrrev_b32 v70, 4, v69
  v_and_b32 v69, 15, v69
  v_lshlrev_b32 v71, 12, v70
  v_lshl_add_u32 v71, v68, 8, v71
  v_lshl_add_u32 v71, v69, 4, v71
  v_add_u32 v153, v71, v75
  v_add_u32 v67, 144, v73
  v_mul_u32_u24 v68, 2341, v67
  v_lshrrev_b32 v68, 16, v68
  v_mul_u32_u24 v69, 28, v68
  v_sub_u32 v69, v67, v69
  v_lshrrev_b32 v70, 4, v69
  v_and_b32 v69, 15, v69
  v_lshlrev_b32 v71, 12, v70
  v_lshl_add_u32 v71, v68, 8, v71
  v_lshl_add_u32 v71, v69, 4, v71
  v_add_u32 v154, v71, v75
  v_add_u32 v67, 160, v73
  v_mul_u32_u24 v68, 2341, v67
  v_lshrrev_b32 v68, 16, v68
  v_mul_u32_u24 v69, 28, v68
  v_sub_u32 v69, v67, v69
  v_lshrrev_b32 v70, 4, v69
  v_and_b32 v69, 15, v69
  v_lshlrev_b32 v71, 12, v70
  v_lshl_add_u32 v71, v68, 8, v71
  v_lshl_add_u32 v71, v69, 4, v71
  v_add_u32 v155, v71, v75
  v_add_u32 v67, 176, v73
  v_mul_u32_u24 v68, 2341, v67
  v_lshrrev_b32 v68, 16, v68
  v_mul_u32_u24 v69, 28, v68
  v_sub_u32 v69, v67, v69
  v_lshrrev_b32 v70, 4, v69
  v_and_b32 v69, 15, v69
  v_lshlrev_b32 v71, 12, v70
  v_lshl_add_u32 v71, v68, 8, v71
  v_lshl_add_u32 v71, v69, 4, v71
  v_add_u32 v156, v71, v75
  v_add_u32 v67, 192, v73
  v_mul_u32_u24 v68, 2341, v67
  v_lshrrev_b32 v68, 16, v68
  v_mul_u32_u24 v69, 28, v68
  v_sub_u32 v69, v67, v69
  v_lshrrev_b32 v70, 4, v69
  v_and_b32 v69, 15, v69
  v_lshlrev_b32 v71, 12, v70
  v_lshl_add_u32 v71, v68, 8, v71
  v_lshl_add_u32 v71, v69, 4, v71
  v_add_u32 v157, v71, v75
  v_add_u32 v67, 208, v73
  v_mul_u32_u24 v68, 2341, v67
  v_lshrrev_b32 v68, 16, v68
  v_mul_u32_u24 v69, 28, v68
  v_sub_u32 v69, v67, v69
  v_lshrrev_b32 v70, 4, v69
  v_and_b32 v69, 15, v69
  v_lshlrev_b32 v71, 12, v70
  v_lshl_add_u32 v71, v68, 8, v71
  v_lshl_add_u32 v71, v69, 4, v71
  v_add_u32 v158, v71, v75
  v_mov_b32 v74, 0x40000000
  v_mov_b32 v164, 0
  v_add_u32 v0, 30720, v2
  v_mov_b32 v76, 0
  v_mov_b32 v77, 0
  v_mov_b32 v78, 0
  v_mov_b32 v79, 0
  ds_write_b128 v2, v[76:79] offset:4096
  ds_write_b128 v2, v[76:79] offset:5120
  ds_write_b128 v2, v[76:79] offset:6144
  ds_write_b128 v2, v[76:79] offset:7168
  s_and_b32 s22, s17, 0
  s_lshl_b32 s22, s22, 7
  s_add_u32 s22, s22, 35328
  v_lshl_add_u32 v4, v73, 2, s22
  v_and_b32 v64, 1, v73
  v_mov_b32 v5, 0x05040100
  v_mov_b32 v65, 0x03020706
  v_cmp_eq_u32 vcc, 1, v64
  s_nop 1
  v_cndmask_b32 v5, v5, v65, vcc
  s_lshl_b32 s22, s17, 2
  s_add_u32 s22, s22, 39424
  v_lshl_add_u32 v7, v1, 7, s22
  v_cmp_gt_u32 vcc, 1, v1
  s_nop 1
  v_cndmask_b32 v7, v74, v7, vcc
  v_min_u32 v65, 11, v73
  v_mad_u32_u24 v65, v72, 12, v65
  v_lshlrev_b32 v6, 4, v65
  v_add_u32 v6, 1024, v6
  v_lshl_add_u32 v64, v66, 2, v64
  v_and_b32 v65, 2, v72
  v_add_u32 v64, v64, v65
  s_mul_i32 s22, s17, 12
  s_add_u32 s22, s22, 256
  v_add_u32 v75, s22, v73
  v_lshrrev_b32 v68, 4, v75
  v_lshlrev_b32 v68, 8, v68
  v_bfe_u32 v69, v75, 1, 1
  v_lshl_add_u32 v68, v69, 7, v68
  v_lshl_add_u32 v68, v64, 4, v68
  v_and_b32 v69, 12, v75
  v_add_u32 v1, v68, v69
  v_cmp_gt_u32 vcc, 12, v73
  s_nop 1
  v_cndmask_b32 v1, v74, v1, vcc
  s_mul_i32 s22, s17, 28672
  s_add_u32 s25, s22, 2490368
  s_and_b32 s27, s17, 0
  s_xor_b32 s22, s27, 0
  s_mul_i32 s80, s22, 7168
  s_lshl_b32 s22, s22, 11
  s_add_u32 s76, s22, 9216
  s_xor_b32 s22, s27, 1
  s_mul_i32 s81, s22, 7168
  s_lshl_b32 s22, s22, 11
  s_add_u32 s77, s22, 9216
  s_xor_b32 s22, s27, 2
  s_mul_i32 s82, s22, 7168
  s_lshl_b32 s22, s22, 11
  s_add_u32 s78, s22, 9216
  s_xor_b32 s22, s27, 3
  s_mul_i32 s83, s22, 7168
  s_lshl_b32 s22, s22, 11
  s_add_u32 s79, s22, 9216
  v_mov_b32 v162, -1
  s_mov_b32 s38, 0x40000000
  s_mul_i32 s31, s17, 401408
  s_add_u32 s31, s31, 40077312
  s_mov_b32 s30, 0
ch_wr5:
  buffer_load_dword v9, off, s[12:15], 0 offset:128 sc1
  s_waitcnt vmcnt(0)
  v_cmp_ne_u32 vcc, 1, v9
  s_cbranch_vccz ch_wr5_ok
  s_sleep 8
  s_add_u32 s30, s30, 1
  s_cmp_lt_u32 s30, 400000
  s_cbranch_scc1 ch_wr5
  s_branch cA_abort
ch_wr5_ok:
  s_lshr_b32 s22, s17, 2
  s_lshl_b32 s28, 0x81, s22
  s_mul_i32 s27, s17, 12
  s_add_u32 s22, s27, 256
  s_lshr_b32 s22, s22, 6
  s_lshl_b32 s22, 0x81, s22
  s_or_b32 s28, s28, s22
  s_add_u32 s22, s27, 267
  s_lshr_b32 s22, s22, 6
  s_lshl_b32 s22, 0x81, s22
  s_or_b32 s28, s28, s22
  v_lshrrev_b32 v12, 8, v2
  v_lshlrev_b32 v12, 7, v12
  s_mov_b32 s27, 582656
  s_mov_b32 s30, 0
ch_ww5:
  buffer_load_dword v9, v12, s[8:11], s27 offen sc1
  s_waitcnt vmcnt(0)
  v_and_b32 v10, s28, v9
  v_cmp_ne_u32 vcc, s28, v10
  s_cbranch_vccz ch_ww5_ok
  s_sleep 3
  s_add_u32 s30, s30, 1
  s_cmp_lt_u32 s30, 400000
  s_cbranch_scc1 ch_ww5
  s_branch cA_abort
ch_ww5_ok:
  s_add_u32 s22, s31, 0
  buffer_load_dwordx4 a[0:3], v2, s[8:11], s22 offen offset:0 sc1
  buffer_load_dwordx4 a[4:7], v2, s[8:11], s22 offen offset:1024 sc1
  buffer_load_dwordx4 a[8:11], v2, s[8:11], s22 offen offset:2048 sc1
  buffer_load_dwordx4 a[12:15], v2, s[8:11], s22 offen offset:3072 sc1
  s_add_u32 s22, s31, 4096
  buffer_load_dwordx4 a[16:19], v2, s[8:11], s22 offen offset:0 sc1
  buffer_load_dwordx4 a[20:23], v2, s[8:11], s22 offen offset:1024 sc1
  buffer_load_dwordx4 a[24:27], v2, s[8:11], s22 offen offset:2048 sc1
  buffer_load_dwordx4 a[28:31], v2, s[8:11], s22 offen offset:3072 sc1
  s_add_u32 s22, s31, 8192
  buffer_load_dwordx4 a[32:35], v2, s[8:11], s22 offen offset:0 sc1
  buffer_load_dwordx4 a[36:39], v2, s[8:11], s22 offen offset:1024 sc1
  buffer_load_dwordx4 a[40:43], v2, s[8:11], s22 offen offset:2048 sc1
  buffer_load_dwordx4 a[44:47], v2, s[8:11], s22 offen offset:3072 sc1
  s_add_u32 s22, s31, 12288
  buffer_load_dwordx4 a[48:51], v2, s[8:11], s22 offen offset:0 sc1
  buffer_load_dwordx4 a[52:55], v2, s[8:11], s22 offen offset:1024 sc1
  buffer_load_dwordx4 a[56:59], v2, s[8:11], s22 offen offset:2048 sc1
  buffer_load_dwordx4 a[60:63], v2, s[8:11], s22 offen offset:3072 sc1
  s_add_u32 s22, s31, 16384
  buffer_load_dwordx4 a[64:67], v2, s[8:11], s22 offen offset:0 sc1
  buffer_load_dwordx4 a[68:71], v2, s[8:11], s22 offen offset:1024 sc1
  buffer_load_dwordx4 a[72:75], v2, s[8:11], s22 offen offset:2048 sc1
  buffer_load_dwordx4 a[76:79], v2, s[8:11], s22 offen offset:3072 sc1
  s_add_u32 s22, s31, 20480
  buffer_load_dwordx4 a[80:83], v2, s[8:11], s22 offen offset:0 sc1
  buffer_load_dwordx4 a[84:87], v2, s[8:11], s22 offen offset:1024 sc1
  buffer_load_dwordx4 a[88:91], v2, s[8:11], s22 offen offset:2048 sc1
  buffer_load_dwordx4 a[92:95], v2, s[8:11], s22 offen offset:3072 sc1
  s_add_u32 s22, s31, 24576
  buffer_load_dwordx4 a[96:99], v2, s[8:11], s22 offen offset:0 sc1
  buffer_load_dwordx4 a[100:103], v2, s[8:11], s22 offen offset:1024 sc1
  buffer_load_dwordx4 a[104:107], v2, s[8:11], s22 offen offset:2048 sc1
  buffer_load_dwordx4 a[108:111], v2, s[8:11], s22 offen offset:3072 sc1
  s_add_u32 s22, s31, 28672
  buffer_load_dwordx4 a[112:115], v2, s[8:11], s22 offen offset:0 sc1
  buffer_load_dwordx4 a[116:119], v2, s[8:11], s22 offen offset:1024 sc1
  buffer_load_dwordx4 a[120:123], v2, s[8:11], s22 offen offset:2048 sc1
  buffer_load_dwordx4 a[124:127], v2, s[8:11], s22 offen offset:3072 sc1
  s_waitcnt vmcnt(24)
  s_add_u32 s22, s31, 32768
  buffer_load_dwordx4 a[128:131], v2, s[8:11], s22 offen offset:0 sc1
  buffer_load_dwordx4 a[132:135], v2, s[8:11], s22 offen offset:1024 sc1
  buffer_load_dwordx4 a[136:139], v2, s[8:11], s22 offen offset:2048 sc1
  buffer_load_dwordx4 a[140:143], v2, s[8:11], s22 offen offset:3072 sc1
  s_add_u32 s22, s31, 36864
  buffer_load_dwordx4 a[144:147], v2, s[8:11], s22 offen offset:0 sc1
  buffer_load_dwordx4 a[148:151], v2, s[8:11], s22 offen offset:1024 sc1
  buffer_load_dwordx4 a[152:155], v2, s[8:11], s22 offen offset:2048 sc1
  buffer_load_dwordx4 a[156:159], v2, s[8:11], s22 offen offset:3072 sc1
  s_add_u32 s22, s31, 40960
  buffer_load_dwordx4 a[160:163], v2, s[8:11], s22 offen offset:0 sc1
  buffer_load_dwordx4 a[164:167], v2, s[8:11], s22 offen offset:1024 sc1
  buffer_load_dwordx4 a[168:171], v2, s[8:11], s22 offen offset:2048 sc1
  buffer_load_dwordx4 a[172:175], v2, s[8:11], s22 offen offset:3072 sc1
  s_add_u32 s22, s31, 45056
  buffer_load_dwordx4 a[176:179], v2, s[8:11], s22 offen offset:0 sc1
  buffer_load_dwordx4 a[180:183], v2, s[8:11], s22 offen offset:1024 sc1
  buffer_load_dwordx4 a[184:187], v2, s[8:11], s22 offen offset:2048 sc1
  buffer_load_dwordx4 a[188:191], v2, s[8:11], s22 offen offset:3072 sc1
  s_add_u32 s22, s31, 49152
  buffer_load_dwordx4 a[192:195], v2, s[8:11], s22 offen offset:0 sc1
  buffer_load_dwordx4 a[196:199], v2, s[8:11], s22 offen offset:1024 sc1
  buffer_load_dwordx4 a[200:203], v2, s[8:11], s22 offen offset:2048 sc1
  buffer_load_dwordx4 a[204:207], v2, s[8:11], s22 offen offset:3072 sc1
  s_add_u32 s22, s31, 53248
  buffer_load_dwordx4 a[208:211], v2, s[8:11], s22 offen offset:0 sc1
  buffer_load_dwordx4 a[212:215], v2, s[8:11], s22 offen offset:1024 sc1
  buffer_load_dwordx4 a[216:219], v2, s[8:11], s22 offen offset:2048 sc1
  buffer_load_dwordx4 a[220:223], v2, s[8:11], s22 offen offset:3072 sc1
  s_add_u32 s22, s31, 57344
  buffer_load_dwordx4 a[224:227], v2, s[8:11], s22 offen offset:0 sc1
  buffer_load_dwordx4 a[228:231], v2, s[8:11], s22 offen offset:1024 sc1
  buffer_load_dwordx4 a[232:235], v2, s[8:11], s22 offen offset:2048 sc1
  buffer_load_dwordx4 a[236:239], v2, s[8:11], s22 offen offset:3072 sc1
  s_add_u32 s22, s31, 61440
  buffer_load_dwordx4 a[240:243], v2, s[8:11], s22 offen offset:0 sc1
  buffer_load_dwordx4 a[244:247], v2, s[8:11], s22 offen offset:1024 sc1
  buffer_load_dwordx4 a[248:251], v2, s[8:11], s22 offen offset:2048 sc1
  buffer_load_dwordx4 a[252:255], v2, s[8:11], s22 offen offset:3072 sc1
  s_waitcnt vmcnt(24)
  s_add_u32 s22, s31, 65536
  buffer_load_dwordx4 v[176:179], v2, s[8:11], s22 offen offset:0 sc1
  buffer_load_dwordx4 v[180:183], v2, s[8:11], s22 offen offset:1024 sc1
  buffer_load_dwordx4 v[184:187], v2, s[8:11], s22 offen offset:2048 sc1
  buffer_load_dwordx4 v[188:191], v2, s[8:11], s22 offen offset:3072 sc1
  s_add_u32 s22, s31, 69632
  buffer_load_dwordx4 v[192:195], v2, s[8:11], s22 offen offset:0 sc1
  buffer_load_dwordx4 v[196:199], v2, s[8:11], s22 offen offset:1024 sc1
  buffer_load_dwordx4 v[200:203], v2, s[8:11], s22 offen offset:2048 sc1
  buffer_load_dwordx4 v[204:207], v2, s[8:11], s22 offen offset:3072 sc1
  s_add_u32 s22, s31, 73728
  buffer_load_dwordx4 v[208:211], v2, s[8:11], s22 offen offset:0 sc1
  buffer_load_dwordx4 v[212:215], v2, s[8:11], s22 offen offset:1024 sc1
  buffer_load_dwordx4 v[216:219], v2, s[8:11], s22 offen offset:2048 sc1
  buffer_load_dwordx4 v[220:223], v2, s[8:11], s22 offen offset:3072 sc1
  s_add_u32 s22, s31, 77824
  buffer_load_dwordx4 v[224:227], v2, s[8:11], s22 offen offset:0 sc1
  buffer_load_dwordx4 v[228:231], v2, s[8:11], s22 offen offset:1024 sc1
  buffer_load_dwordx4 v[232:235], v2, s[8:11], s22 offen offset:2048 sc1
  buffer_load_dwordx4 v[236:239], v2, s[8:11], s22 offen offset:3072 sc1
  s_add_u32 s22, s31, 81920
  buffer_load_dwordx4 v[240:243], v2, s[8:11], s22 offen offset:0 sc1
  buffer_load_dwordx4 v[244:247], v2, s[8:11], s22 offen offset:1024 sc1
  buffer_load_dwordx4 v[248:251], v2, s[8:11], s22 offen offset:2048 sc1
  buffer_load_dwordx4 v[252:255], v2, s[8:11], s22 offen offset:3072 sc1
  s_mov_b32 m0, 30720
  s_add_u32 s22, s31, 86016
  buffer_load_dwordx4 v2, s[8:11], s22 offen offset:0 sc1 lds
  buffer_load_dwordx4 v2, s[8:11], s22 offen offset:1024 sc1 lds
  buffer_load_dwordx4 v2, s[8:11], s22 offen offset:2048 sc1 lds
  buffer_load_dwordx4 v2, s[8:11], s22 offen offset:3072 sc1 lds
  s_mov_b32 m0, 34816
  s_add_u32 s22, s31, 90112
  buffer_load_dwordx4 v2, s[8:11], s22 offen offset:0 sc1 lds
  buffer_load_dwordx4 v2, s[8:11], s22 offen offset:1024 sc1 lds
  buffer_load_dwordx4 v2, s[8:11], s22 offen offset:2048 sc1 lds
  buffer_load_dwordx4 v2, s[8:11], s22 offen offset:3072 sc1 lds
  s_mov_b32 m0, 38912
  s_add_u32 s22, s31, 94208
  buffer_load_dwordx4 v2, s[8:11], s22 offen offset:0 sc1 lds
  buffer_load_dwordx4 v2, s[8:11], s22 offen offset:1024 sc1 lds
  buffer_load_dwordx4 v2, s[8:11], s22 offen offset:2048 sc1 lds
  buffer_load_dwordx4 v2, s[8:11], s22 offen offset:3072 sc1 lds
  s_mov_b32 m0, 43008
  s_add_u32 s22, s31, 98304
  buffer_load_dwordx4 v2, s[8:11], s22 offen offset:0 sc1 lds
  buffer_load_dwordx4 v2, s[8:11], s22 offen offset:1024 sc1 lds
  s_mov_b32 s30, 0
ch_ws5:
  buffer_load_dword v9, off, s[12:15], 0 offset:132 sc1
  s_waitcnt vmcnt(0)
  v_cmp_ne_u32 vcc, 1, v9
  s_cbranch_vccz ch_ws5_ok
  s_sleep 8
  s_add_u32 s30, s30, 1
  s_cmp_lt_u32 s30, 400000
  s_cbranch_scc1 ch_ws5
  s_branch cA_abort
ch_ws5_ok:
  s_mul_i32 s33, s17, 532480
  s_add_u32 s33, s33, 78111744
  v_mov_b32 v12, -1
  v_mov_b32 v13, -1
  v_mov_b32 v14, -1
  v_mov_b32 v15, -1
  s_add_u32 s22, s33, 0
  buffer_store_dwordx4 v[12:15], v2, s[8:11], s22 offen sc1
  s_add_u32 s22, s33, 2048
  buffer_store_dwordx4 v[12:15], v2, s[8:11], s22 offen sc1
  s_add_u32 s22, s33, 4096
  buffer_store_dwordx4 v[12:15], v2, s[8:11], s22 offen sc1
  s_add_u32 s22, s33, 6144
  buffer_store_dwordx4 v[12:15], v2, s[8:11], s22 offen sc1
  s_add_u32 s22, s33, 8192
  buffer_store_dwordx4 v[12:15], v2, s[8:11], s22 offen sc1
  s_add_u32 s22, s33, 10240
  buffer_store_dwordx4 v[12:15], v2, s[8:11], s22 offen sc1
  s_add_u32 s22, s33, 12288
  buffer_store_dwordx4 v[12:15], v2, s[8:11], s22 offen sc1
  s_add_u32 s22, s33, 14336
  buffer_store_dwordx4 v[12:15], v2, s[8:11], s22 offen sc1
  v_mov_b32 v16, 1
  v_mov_b32 v17, 1
  s_lshl_b32 s22, s17, 10
  s_add_u32 s22, s22, 566248
  s_waitcnt vmcnt(0)
  s_mov_b64 exec, 3
  buffer_store_dwordx2 v[16:17], v2, s[8:11], s22 offen sc1
  s_mov_b64 exec, -1
  s_mov_b32 s28, s35
  s_waitcnt vmcnt(0) lgkmcnt(0)
  s_mov_b32 s31, 0
  s_cmp_lg_u32 s88, 0
  s_cbranch_scc1 cB_va1_loop
  s_branch cA_va1_loop
ch_init6:
  v_mov_b32 v72, v116
  v_mov_b32 v73, v117
  v_lshrrev_b32 v65, 1, v72
  v_and_b32 v66, 1, v72
  v_mov_b32 v36, 0
  v_mov_b32 v37, 0
  v_mov_b32 v38, 0
  v_mov_b32 v39, 0
  v_mov_b32 v40, 0
  v_mov_b32 v41, 0
  v_mov_b32 v42, 0
  v_mov_b32 v43, 0
  v_mov_b32 v44, 0
  v_mov_b32 v45, 0
  v_mov_b32 v46, 0
  v_mov_b32 v47, 0
  v_mov_b32 v48, 0
  v_mov_b32 v49, 0
  v_mov_b32 v50, 0
  v_mov_b32 v51, 0
  v_mov_b32 v52, 0
  v_mov_b32 v53, 0
  v_mov_b32 v54, 0
  v_mov_b32 v55, 0
  v_mov_b32 v56, 0
  v_mov_b32 v57, 0
  v_mov_b32 v58, 0
  v_mov_b32 v59, 0
  v_mov_b32 v60, 0
  v_mov_b32 v61, 0
  v_mov_b32 v62, 0
  v_mov_b32 v63, 0
  v_lshlrev_b32 v75, 2, v65
  v_lshl_add_u32 v75, v66, 3, v75
  v_add_u32 v67, 224, v73
  v_mul_u32_u24 v68, 2341, v67
  v_lshrrev_b32 v68, 16, v68
  v_mul_u32_u24 v69, 28, v68
  v_sub_u32 v69, v67, v69
  v_lshrrev_b32 v70, 4, v69
  v_and_b32 v69, 15, v69
  v_lshlrev_b32 v71, 12, v70
  v_lshl_add_u32 v71, v68, 8, v71
  v_lshl_add_u32 v71, v69, 4, v71
  v_add_u32 v104, v71, v75
  v_add_u32 v67, 240, v73
  v_mul_u32_u24 v68, 2341, v67
  v_lshrrev_b32 v68, 16, v68
  v_mul_u32_u24 v69, 28, v68
  v_sub_u32 v69, v67, v69
  v_lshrrev_b32 v70, 4, v69
  v_and_b32 v69, 15, v69
  v_lshlrev_b32 v71, 12, v70
  v_lshl_add_u32 v71, v68, 8, v71
  v_lshl_add_u32 v71, v69, 4, v71
  v_add_u32 v105, v71, v75
  v_add_u32 v67, 256, v73
  v_mul_u32_u24 v68, 2341, v67
  v_lshrrev_b32 v68, 16, v68
  v_mul_u32_u24 v69, 28, v68
  v_sub_u32 v69, v67, v69
  v_lshrrev_b32 v70, 4, v69
  v_and_b32 v69, 15, v69
  v_lshlrev_b32 v71, 12, v70
  v_lshl_add_u32 v71, v68, 8, v71
  v_lshl_add_u32 v71, v69, 4, v71
  v_add_u32 v106, v71, v75
  v_add_u32 v67, 272, v73
  v_mul_u32_u24 v68, 2341, v67
  v_lshrrev_b32 v68, 16, v68
  v_mul_u32_u24 v69, 28, v68
  v_sub_u32 v69, v67, v69
  v_lshrrev_b32 v70, 4, v69
  v_and_b32 v69, 15, v69
  v_lshlrev_b32 v71, 12, v70
  v_lshl_add_u32 v71, v68, 8, v71
  v_lshl_add_u32 v71, v69, 4, v71
  v_add_u32 v107, v71, v75
  v_add_u32 v67, 288, v73
  v_mul_u32_u24 v68, 2341, v67
  v_lshrrev_b32 v68, 16, v68
  v_mul_u32_u24 v69, 28, v68
  v_sub_u32 v69, v67, v69
  v_lshrrev_b32 v70, 4, v69
  v_and_b32 v69, 15, v69
  v_lshlrev_b32 v71, 12, v70
  v_lshl_add_u32 v71, v68, 8, v71
  v_lshl_add_u32 v71, v69, 4, v71
  v_add_u32 v108, v71, v75
  v_add_u32 v67, 304, v73
  v_mul_u32_u24 v68, 2341, v67
  v_lshrrev_b32 v68, 16, v68
  v_mul_u32_u24 v69, 28, v68
  v_sub_u32 v69, v67, v69
  v_lshrrev_b32 v70, 4, v69
  v_and_b32 v69, 15, v69
  v_lshlrev_b32 v71, 12, v70
  v_lshl_add_u32 v71, v68, 8, v71
  v_lshl_add_u32 v71, v69, 4, v71
  v_add_u32 v109, v71, v75
  v_add_u32 v67, 320, v73
  v_mul_u32_u24 v68, 2341, v67
  v_lshrrev_b32 v68, 16, v68
  v_mul_u32_u24 v69, 28, v68
  v_sub_u32 v69, v67, v69
  v_lshrrev_b32 v70, 4, v69
  v_and_b32 v69, 15, v69
  v_lshlrev_b32 v71, 12, v70
  v_lshl_add_u32 v71, v68, 8, v71
  v_lshl_add_u32 v71, v69, 4, v71
  v_add_u32 v110, v71, v75
  v_add_u32 v67, 96, v73
  v_mul_u32_u24 v68, 2341, v67
  v_lshrrev_b32 v68, 16, v68
  v_mul_u32_u24 v69, 28, v68
  v_sub_u32 v69, v67, v69
  v_lshrrev_b32 v70, 4, v69
  v_and_b32 v69, 15, v69
  v_lshlrev_b32 v71, 12, v70
  v_lshl_add_u32 v71, v68, 8, v71
  v_lshl_add_u32 v71, v69, 4, v71
  v_add_u32 v111, v71, v75
  v_mov_b32 v74, 0x40000000
  v_mov_b32 v96, 0
  v_add_u32 v0, 16384, v2
  v_and_b32 v119, 15, v1
  s_and_b32 s22, s17, 0
  s_lshl_b32 s22, s22, 7
  s_add_u32 s22, s22, 39424
  v_lshl_add_u32 v119, v119, 2, s22
  s_lshl_b32 s22, s17, 2
  s_add_u32 s22, s22, 37376
  v_lshl_add_u32 v118, v1, 7, s22
  v_cmp_gt_u32 vcc, 1, v1
  s_nop 1
  v_cndmask_b32 v118, v74, v118, vcc
  s_lshl_b32 s35, s17, 7
  s_add_u32 s35, s35, 524288
  v_mov_b32 v64, 0
  v_mov_b32 v65, 0
  v_mov_b32 v66, 0
  v_mov_b32 v67, 0
  v_min_u32 v116, 13, v1
  s_mul_i32 s22, s17, 14
  v_add_u32 v116, s22, v116
  v_lshlrev_b32 v116, 7, v116
  s_mul_i32 s31, s17, 401408
  s_add_u32 s31, s31, 40177664
  s_mov_b32 s30, 0
ch_wr6:
  buffer_load_dword v9, off, s[12:15], 0 offset:128 sc1
  s_waitcnt vmcnt(0)
  v_cmp_ne_u32 vcc, 1, v9
  s_cbranch_vccz ch_wr6_ok
  s_sleep 8
  s_add_u32 s30, s30, 1
  s_cmp_lt_u32 s30, 400000
  s_cbranch_scc1 ch_wr6
  s_branch cA_abort
ch_wr6_ok:
  s_lshr_b32 s22, s17, 2
  s_lshl_b32 s28, 0x81, s22
  s_mul_i32 s27, s17, 12
  s_add_u32 s22, s27, 256
  s_lshr_b32 s22, s22, 6
  s_lshl_b32 s22, 0x81, s22
  s_or_b32 s28, s28, s22
  s_add_u32 s22, s27, 267
  s_lshr_b32 s22, s22, 6
  s_lshl_b32 s22, 0x81, s22
  s_or_b32 s28, s28, s22
  v_lshrrev_b32 v12, 8, v2
  v_lshlrev_b32 v12, 7, v12
  s_mov_b32 s27, 583168
  s_mov_b32 s30, 0
ch_ww6:
  buffer_load_dword v9, v12, s[8:11], s27 offen sc1
  s_waitcnt vmcnt(0)
  v_and_b32 v10, s28, v9
  v_cmp_ne_u32 vcc, s28, v10
  s_cbranch_vccz ch_ww6_ok
  s_sleep 3
  s_add_u32 s30, s30, 1
  s_cmp_lt_u32 s30, 400000
  s_cbranch_scc1 ch_ww6
  s_branch cA_abort
ch_ww6_ok:
  s_add_u32 s22, s31, 0
  buffer_load_dwordx4 a[0:3], v2, s[8:11], s22 offen offset:0 sc1
  buffer_load_dwordx4 a[4:7], v2, s[8:11], s22 offen offset:1024 sc1
  buffer_load_dwordx4 a[8:11], v2, s[8:11], s22 offen offset:2048 sc1
  buffer_load_dwordx4 a[12:15], v2, s[8:11], s22 offen offset:3072 sc1
  s_add_u32 s22, s31, 4096
  buffer_load_dwordx4 a[16:19], v2, s[8:11], s22 offen offset:0 sc1
  buffer_load_dwordx4 a[20:23], v2, s[8:11], s22 offen offset:1024 sc1
  buffer_load_dwordx4 a[24:27], v2, s[8:11], s22 offen offset:2048 sc1
  buffer_load_dwordx4 a[28:31], v2, s[8:11], s22 offen offset:3072 sc1
  s_add_u32 s22, s31, 8192
  buffer_load_dwordx4 a[32:35], v2, s[8:11], s22 offen offset:0 sc1
  buffer_load_dwordx4 a[36:39], v2, s[8:11], s22 offen offset:1024 sc1
  buffer_load_dwordx4 a[40:43], v2, s[8:11], s22 offen offset:2048 sc1
  buffer_load_dwordx4 a[44:47], v2, s[8:11], s22 offen offset:3072 sc1
  s_add_u32 s22, s31, 12288
  buffer_load_dwordx4 a[48:51], v2, s[8:11], s22 offen offset:0 sc1
  buffer_load_dwordx4 a[52:55], v2, s[8:11], s22 offen offset:1024 sc1
  buffer_load_dwordx4 a[56:59], v2, s[8:11], s22 offen offset:2048 sc1
  buffer_load_dwordx4 a[60:63], v2, s[8:11], s22 offen offset:3072 sc1
  s_add_u32 s22, s31, 16384
  buffer_load_dwordx4 a[64:67], v2, s[8:11], s22 offen offset:0 sc1
  buffer_load_dwordx4 a[68:71], v2, s[8:11], s22 offen offset:1024 sc1
  buffer_load_dwordx4 a[72:75], v2, s[8:11], s22 offen offset:2048 sc1
  buffer_load_dwordx4 a[76:79], v2, s[8:11], s22 offen offset:3072 sc1
  s_add_u32 s22, s31, 20480
  buffer_load_dwordx4 a[80:83], v2, s[8:11], s22 offen offset:0 sc1
  buffer_load_dwordx4 a[84:87], v2, s[8:11], s22 offen offset:1024 sc1
  buffer_load_dwordx4 a[88:91], v2, s[8:11], s22 offen offset:2048 sc1
  buffer_load_dwordx4 a[92:95], v2, s[8:11], s22 offen offset:3072 sc1
  s_add_u32 s22, s31, 24576
  buffer_load_dwordx4 a[96:99], v2, s[8:11], s22 offen offset:0 sc1
  buffer_load_dwordx4 a[100:103], v2, s[8:11], s22 offen offset:1024 sc1
  buffer_load_dwordx4 a[104:107], v2, s[8:11], s22 offen offset:2048 sc1
  buffer_load_dwordx4 a[108:111], v2, s[8:11], s22 offen offset:3072 sc1
  s_add_u32 s22, s31, 28672
  buffer_load_dwordx4 a[112:115], v2, s[8:11], s22 offen offset:0 sc1
  buffer_load_dwordx4 a[116:119], v2, s[8:11], s22 offen offset:1024 sc1
  buffer_load_dwordx4 a[120:123], v2, s[8:11], s22 offen offset:2048 sc1
  buffer_load_dwordx4 a[124:127], v2, s[8:11], s22 offen offset:3072 sc1
  s_waitcnt vmcnt(24)
  s_add_u32 s22, s31, 32768
  buffer_load_dwordx4 a[128:131], v2, s[8:11], s22 offen offset:0 sc1
  buffer_load_dwordx4 a[132:135], v2, s[8:11], s22 offen offset:1024 sc1
  buffer_load_dwordx4 a[136:139], v2, s[8:11], s22 offen offset:2048 sc1
  buffer_load_dwordx4 a[140:143], v2, s[8:11], s22 offen offset:3072 sc1
  s_add_u32 s22, s31, 36864
  buffer_load_dwordx4 a[144:147], v2, s[8:11], s22 offen offset:0 sc1
  buffer_load_dwordx4 a[148:151], v2, s[8:11], s22 offen offset:1024 sc1
  buffer_load_dwordx4 a[152:155], v2, s[8:11], s22 offen offset:2048 sc1
  buffer_load_dwordx4 a[156:159], v2, s[8:11], s22 offen offset:3072 sc1
  s_add_u32 s22, s31, 40960
  buffer_load_dwordx4 a[160:163], v2, s[8:11], s22 offen offset:0 sc1
  buffer_load_dwordx4 a[164:167], v2, s[8:11], s22 offen offset:1024 sc1
  buffer_load_dwordx4 a[168:171], v2, s[8:11], s22 offen offset:2048 sc1
  buffer_load_dwordx4 a[172:175], v2, s[8:11], s22 offen offset:3072 sc1
  s_add_u32 s22, s31, 45056
  buffer_load_dwordx4 a[176:179], v2, s[8:11], s22 offen offset:0 sc1
  buffer_load_dwordx4 a[180:183], v2, s[8:11], s22 offen offset:1024 sc1
  buffer_load_dwordx4 a[184:187], v2, s[8:11], s22 offen offset:2048 sc1
  buffer_load_dwordx4 a[188:191], v2, s[8:11], s22 offen offset:3072 sc1
  s_add_u32 s22, s31, 49152
  buffer_load_dwordx4 a[192:195], v2, s[8:11], s22 offen offset:0 sc1
  buffer_load_dwordx4 a[196:199], v2, s[8:11], s22 offen offset:1024 sc1
  buffer_load_dwordx4 a[200:203], v2, s[8:11], s22 offen offset:2048 sc1
  buffer_load_dwordx4 a[204:207], v2, s[8:11], s22 offen offset:3072 sc1
  s_add_u32 s22, s31, 53248
  buffer_load_dwordx4 a[208:211], v2, s[8:11], s22 offen offset:0 sc1
  buffer_load_dwordx4 a[212:215], v2, s[8:11], s22 offen offset:1024 sc1
  buffer_load_dwordx4 a[216:219], v2, s[8:11], s22 offen offset:2048 sc1
  buffer_load_dwordx4 a[220:223], v2, s[8:11], s22 offen offset:3072 sc1
  s_add_u32 s22, s31, 57344
  buffer_load_dwordx4 a[224:227], v2, s[8:11], s22 offen offset:0 sc1
  buffer_load_dwordx4 a[228:231], v2, s[8:11], s22 offen offset:1024 sc1
  buffer_load_dwordx4 a[232:235], v2, s[8:11], s22 offen offset:2048 sc1
  buffer_load_dwordx4 a[236:239], v2, s[8:11], s22 offen offset:3072 sc1
  s_add_u32 s22, s31, 61440
  buffer_load_dwordx4 a[240:243], v2, s[8:11], s22 offen offset:0 sc1
  buffer_load_dwordx4 a[244:247], v2, s[8:11], s22 offen offset:1024 sc1
  buffer_load_dwordx4 a[248:251], v2, s[8:11], s22 offen offset:2048 sc1
  buffer_load_dwordx4 a[252:255], v2, s[8:11], s22 offen offset:3072 sc1
  s_waitcnt vmcnt(24)
  s_add_u32 s22, s31, 65536
  buffer_load_dwordx4 v[120:123], v2, s[8:11], s22 offen offset:0 sc1
  buffer_load_dwordx4 v[124:127], v2, s[8:11], s22 offen offset:1024 sc1
  buffer_load_dwordx4 v[128:131], v2, s[8:11], s22 offen offset:2048 sc1
  buffer_load_dwordx4 v[132:135], v2, s[8:11], s22 offen offset:3072 sc1
  s_add_u32 s22, s31, 69632
  buffer_load_dwordx4 v[136:139], v2, s[8:11], s22 offen offset:0 sc1
  buffer_load_dwordx4 v[140:143], v2, s[8:11], s22 offen offset:1024 sc1
  buffer_load_dwordx4 v[144:147], v2, s[8:11], s22 offen offset:2048 sc1
  buffer_load_dwordx4 v[148:151], v2, s[8:11], s22 offen offset:3072 sc1
  s_add_u32 s22, s31, 73728
  buffer_load_dwordx4 v[152:155], v2, s[8:11], s22 offen offset:0 sc1
  buffer_load_dwordx4 v[156:159], v2, s[8:11], s22 offen offset:1024 sc1
  buffer_load_dwordx4 v[160:163], v2, s[8:11], s22 offen offset:2048 sc1
  buffer_load_dwordx4 v[164:167], v2, s[8:11], s22 offen offset:3072 sc1
  s_add_u32 s22, s31, 77824
  buffer_load_dwordx4 v[168:171], v2, s[8:11], s22 offen offset:0 sc1
  buffer_load_dwordx4 v[172:175], v2, s[8:11], s22 offen offset:1024 sc1
  buffer_load_dwordx4 v[176:179], v2, s[8:11], s22 offen offset:2048 sc1
  buffer_load_dwordx4 v[180:183], v2, s[8:11], s22 offen offset:3072 sc1
  s_add_u32 s22, s31, 81920
  buffer_load_dwordx4 v[184:187], v2, s[8:11], s22 offen offset:0 sc1
  buffer_load_dwordx4 v[188:191], v2, s[8:11], s22 offen offset:1024 sc1
  buffer_load_dwordx4 v[192:195], v2, s[8:11], s22 offen offset:2048 sc1
  buffer_load_dwordx4 v[196:199], v2, s[8:11], s22 offen offset:3072 sc1
  s_add_u32 s22, s31, 86016
  buffer_load_dwordx4 v[200:203], v2, s[8:11], s22 offen offset:0 sc1
  buffer_load_dwordx4 v[204:207], v2, s[8:11], s22 offen offset:1024 sc1
  buffer_load_dwordx4 v[208:211], v2, s[8:11], s22 offen offset:2048 sc1
  buffer_load_dwordx4 v[212:215], v2, s[8:11], s22 offen offset:3072 sc1
  s_add_u32 s22, s31, 90112
  buffer_load_dwordx4 v[216:219], v2, s[8:11], s22 offen offset:0 sc1
  buffer_load_dwordx4 v[220:223], v2, s[8:11], s22 offen offset:1024 sc1
  buffer_load_dwordx4 v[224:227], v2, s[8:11], s22 offen offset:2048 sc1
  buffer_load_dwordx4 v[228:231], v2, s[8:11], s22 offen offset:3072 sc1
  s_add_u32 s22, s31, 94208
  buffer_load_dwordx4 v[232:235], v2, s[8:11], s22 offen offset:0 sc1
  buffer_load_dwordx4 v[236:239], v2, s[8:11], s22 offen offset:1024 sc1
  buffer_load_dwordx4 v[240:243], v2, s[8:11], s22 offen offset:2048 sc1
  buffer_load_dwordx4 v[244:247], v2, s[8:11], s22 offen offset:3072 sc1
  s_waitcnt vmcnt(24)
  s_add_u32 s22, s31, 98304
  buffer_load_dwordx4 v[248:251], v2, s[8:11], s22 offen offset:0 sc1
  buffer_load_dwordx4 v[252:255], v2, s[8:11], s22 offen offset:1024 sc1
  s_mov_b32 s30, 0
ch_ws6:
  buffer_load_dword v9, off, s[12:15], 0 offset:132 sc1
  s_waitcnt vmcnt(0)
  v_cmp_ne_u32 vcc, 1, v9
  s_cbranch_vccz ch_ws6_ok
  s_sleep 8
  s_add_u32 s30, s30, 1
  s_cmp_lt_u32 s30, 400000
  s_cbranch_scc1 ch_ws6
  s_branch cA_abort
ch_ws6_ok:
  s_lshl_b32 s27, s17, 7
  s_add_u32 s27, s27, 524288
  s_mov_b32 s30, 0
ch_vw2:
  buffer_load_dword v9, off, s[8:11], s27 sc1
  s_waitcnt vmcnt(0)
  v_cmp_ne_u32 vcc, 56, v9
  s_cbranch_vccz ch_vw2_d
  s_sleep 2
  s_add_u32 s30, s30, 1
  s_cmp_lt_u32 s30, 400000
  s_cbranch_scc1 ch_vw2
  s_branch cA_abort
ch_vw2_d:
  s_mov_b32 s28, s35
  s_waitcnt vmcnt(0) lgkmcnt(0)
  s_mov_b32 s31, 0
  s_cmp_lg_u32 s88, 0
  s_cbranch_scc1 cB_va2_loop
  s_branch cA_va2_loop
ch_init7:
  v_mov_b32 v72, v116
  v_mov_b32 v73, v117
  v_lshrrev_b32 v65, 1, v72
  v_and_b32 v66, 1, v72
  v_mov_b32 v36, 0
  v_mov_b32 v37, 0
  v_mov_b32 v38, 0
  v_mov_b32 v39, 0
  v_mov_b32 v40, 0
  v_mov_b32 v41, 0
  v_mov_b32 v42, 0
  v_mov_b32 v43, 0
  v_mov_b32 v44, 0
  v_mov_b32 v45, 0
  v_mov_b32 v46, 0
  v_mov_b32 v47, 0
  v_mov_b32 v48, 0
  v_mov_b32 v49, 0
  v_mov_b32 v50, 0
  v_mov_b32 v51, 0
  v_mov_b32 v52, 0
  v_mov_b32 v53, 0
  v_mov_b32 v54, 0
  v_mov_b32 v55, 0
  v_mov_b32 v56, 0
  v_mov_b32 v57, 0
  v_mov_b32 v58, 0
  v_mov_b32 v59, 0
  v_mov_b32 v60, 0
  v_mov_b32 v61, 0
  v_mov_b32 v62, 0
  v_mov_b32 v63, 0
  v_lshlrev_b32 v75, 2, v65
  v_lshl_add_u32 v75, v66, 3, v75
  v_add_u32 v67, 336, v73
  v_mul_u32_u24 v68, 2341, v67
  v_lshrrev_b32 v68, 16, v68
  v_mul_u32_u24 v69, 28, v68
  v_sub_u32 v69, v67, v69
  v_lshrrev_b32 v70, 4, v69
  v_and_b32 v69, 15, v69
  v_lshlrev_b32 v71, 12, v70
  v_lshl_add_u32 v71, v68, 8, v71
  v_lshl_add_u32 v71, v69, 4, v71
  v_add_u32 v104, v71, v75
  v_add_u32 v67, 352, v73
  v_mul_u32_u24 v68, 2341, v67
  v_lshrrev_b32 v68, 16, v68
  v_mul_u32_u24 v69, 28, v68
  v_sub_u32 v69, v67, v69
  v_lshrrev_b32 v70, 4, v69
  v_and_b32 v69, 15, v69
  v_lshlrev_b32 v71, 12, v70
  v_lshl_add_u32 v71, v68, 8, v71
  v_lshl_add_u32 v71, v69, 4, v71
  v_add_u32 v105, v71, v75
  v_add_u32 v67, 368, v73
  v_mul_u32_u24 v68, 2341, v67
  v_lshrrev_b32 v68, 16, v68
  v_mul_u32_u24 v69, 28, v68
  v_sub_u32 v69, v67, v69
  v_lshrrev_b32 v70, 4, v69
  v_and_b32 v69, 15, v69
  v_lshlrev_b32 v71, 12, v70
  v_lshl_add_u32 v71, v68, 8, v71
  v_lshl_add_u32 v71, v69, 4, v71
  v_add_u32 v106, v71, v75
  v_add_u32 v67, 384, v73
  v_mul_u32_u24 v68, 2341, v67
  v_lshrrev_b32 v68, 16, v68
  v_mul_u32_u24 v69, 28, v68
  v_sub_u32 v69, v67, v69
  v_lshrrev_b32 v70, 4, v69
  v_and_b32 v69, 15, v69
  v_lshlrev_b32 v71, 12, v70
  v_lshl_add_u32 v71, v68, 8, v71
  v_lshl_add_u32 v71, v69, 4, v71
  v_add_u32 v107, v71, v75
  v_add_u32 v67, 400, v73
  v_mul_u32_u24 v68, 2341, v67
  v_lshrrev_b32 v68, 16, v68
  v_mul_u32_u24 v69, 28, v68
  v_sub_u32 v69, v67, v69
  v_lshrrev_b32 v70, 4, v69
  v_and_b32 v69, 15, v69
  v_lshlrev_b32 v71, 12, v70
  v_lshl_add_u32 v71, v68, 8, v71
  v_lshl_add_u32 v71, v69, 4, v71
  v_add_u32 v108, v71, v75
  v_add_u32 v67, 416, v73
  v_mul_u32_u24 v68, 2341, v67
  v_lshrrev_b32 v68, 16, v68
  v_mul_u32_u24 v69, 28, v68
  v_sub_u32 v69, v67, v69
  v_lshrrev_b32 v70, 4, v69
  v_and_b32 v69, 15, v69
  v_lshlrev_b32 v71, 12, v70
  v_lshl_add_u32 v71, v68, 8, v71
  v_lshl_add_u32 v71, v69, 4, v71
  v_add_u32 v109, v71, v75
  v_add_u32 v67, 432, v73
  v_mul_u32_u24 v68, 2341, v67
  v_lshrrev_b32 v68, 16, v68
  v_mul_u32_u24 v69, 28, v68
  v_sub_u32 v69, v67, v69
  v_lshrrev_b32 v70, 4, v69
  v_and_b32 v69, 15, v69
  v_lshlrev_b32 v71, 12, v70
  v_lshl_add_u32 v71, v68, 8, v71
  v_lshl_add_u32 v71, v69, 4, v71
  v_add_u32 v110, v71, v75
  v_mov_b32 v74, 0x40000000
  v_mov_b32 v96, 0
  v_and_b32 v119, 15, v1
  s_and_b32 s22, s17, 0
  s_lshl_b32 s22, s22, 7
  s_add_u32 s22, s22, 39424
  v_lshl_add_u32 v119, v119, 2, s22
  s_lshl_b32 s22, s17, 2
  s_add_u32 s22, s22, 37376
  v_lshl_add_u32 v118, v1, 7, s22
  v_cmp_gt_u32 vcc, 1, v1
  s_nop 1
  v_cndmask_b32 v118, v74, v118, vcc
  s_lshl_b32 s35, s17, 7
  s_add_u32 s35, s35, 524288
  v_mov_b32 v64, 0
  v_mov_b32 v65, 0
  v_mov_b32 v66, 0
  v_mov_b32 v67, 0
  v_min_u32 v116, 13, v1
  s_mul_i32 s22, s17, 14
  v_add_u32 v116, s22, v116
  v_lshlrev_b32 v116, 7, v116
  s_mul_i32 s31, s17, 401408
  s_add_u32 s31, s31, 40278016
  s_mov_b32 s30, 0
ch_wr7:
  buffer_load_dword v9, off, s[12:15], 0 offset:128 sc1
  s_waitcnt vmcnt(0)
  v_cmp_ne_u32 vcc, 1, v9
  s_cbranch_vccz ch_wr7_ok
  s_sleep 8
  s_add_u32 s30, s30, 1
  s_cmp_lt_u32 s30, 400000
  s_cbranch_scc1 ch_wr7
  s_branch cA_abort
ch_wr7_ok:
  s_lshr_b32 s22, s17, 2
  s_lshl_b32 s28, 0x81, s22
  s_mul_i32 s27, s17, 12
  s_add_u32 s22, s27, 256
  s_lshr_b32 s22, s22, 6
  s_lshl_b32 s22, 0x81, s22
  s_or_b32 s28, s28, s22
  s_add_u32 s22, s27, 267
  s_lshr_b32 s22, s22, 6
  s_lshl_b32 s22, 0x81, s22
  s_or_b32 s28, s28, s22
  v_lshrrev_b32 v12, 8, v2
  v_lshlrev_b32 v12, 7, v12
  s_mov_b32 s27, 583680
  s_mov_b32 s30, 0
ch_ww7:
  buffer_load_dword v9, v12, s[8:11], s27 offen sc1
  s_waitcnt vmcnt(0)
  v_and_b32 v10, s28, v9
  v_cmp_ne_u32 vcc, s28, v10
  s_cbranch_vccz ch_ww7_ok
  s_sleep 3
  s_add_u32 s30, s30, 1
  s_cmp_lt_u32 s30, 400000
  s_cbranch_scc1 ch_ww7
  s_branch cA_abort
ch_ww7_ok:
  s_add_u32 s22, s31, 0
  buffer_load_dwordx4 a[0:3], v2, s[8:11], s22 offen offset:0 sc1
  buffer_load_dwordx4 a[4:7], v2, s[8:11], s22 offen offset:1024 sc1
  buffer_load_dwordx4 a[8:11], v2, s[8:11], s22 offen offset:2048 sc1
  buffer_load_dwordx4 a[12:15], v2, s[8:11], s22 offen offset:3072 sc1
  s_add_u32 s22, s31, 4096
  buffer_load_dwordx4 a[16:19], v2, s[8:11], s22 offen offset:0 sc1
  buffer_load_dwordx4 a[20:23], v2, s[8:11], s22 offen offset:1024 sc1
  buffer_load_dwordx4 a[24:27], v2, s[8:11], s22 offen offset:2048 sc1
  buffer_load_dwordx4 a[28:31], v2, s[8:11], s22 offen offset:3072 sc1
  s_add_u32 s22, s31, 8192
  buffer_load_dwordx4 a[32:35], v2, s[8:11], s22 offen offset:0 sc1
  buffer_load_dwordx4 a[36:39], v2, s[8:11], s22 offen offset:1024 sc1
  buffer_load_dwordx4 a[40:43], v2, s[8:11], s22 offen offset:2048 sc1
  buffer_load_dwordx4 a[44:47], v2, s[8:11], s22 offen offset:3072 sc1
  s_add_u32 s22, s31, 12288
  buffer_load_dwordx4 a[48:51], v2, s[8:11], s22 offen offset:0 sc1
  buffer_load_dwordx4 a[52:55], v2, s[8:11], s22 offen offset:1024 sc1
  buffer_load_dwordx4 a[56:59], v2, s[8:11], s22 offen offset:2048 sc1
  buffer_load_dwordx4 a[60:63], v2, s[8:11], s22 offen offset:3072 sc1
  s_add_u32 s22, s31, 16384
  buffer_load_dwordx4 a[64:67], v2, s[8:11], s22 offen offset:0 sc1
  buffer_load_dwordx4 a[68:71], v2, s[8:11], s22 offen offset:1024 sc1
  buffer_load_dwordx4 a[72:75], v2, s[8:11], s22 offen offset:2048 sc1
  buffer_load_dwordx4 a[76:79], v2, s[8:11], s22 offen offset:3072 sc1
  s_add_u32 s22, s31, 20480
  buffer_load_dwordx4 a[80:83], v2, s[8:11], s22 offen offset:0 sc1
  buffer_load_dwordx4 a[84:87], v2, s[8:11], s22 offen offset:1024 sc1
  buffer_load_dwordx4 a[88:91], v2, s[8:11], s22 offen offset:2048 sc1
  buffer_load_dwordx4 a[92:95], v2, s[8:11], s22 offen offset:3072 sc1
  s_add_u32 s22, s31, 24576
  buffer_load_dwordx4 a[96:99], v2, s[8:11], s22 offen offset:0 sc1
  buffer_load_dwordx4 a[100:103], v2, s[8:11], s22 offen offset:1024 sc1
  buffer_load_dwordx4 a[104:107], v2, s[8:11], s22 offen offset:2048 sc1
  buffer_load_dwordx4 a[108:111], v2, s[8:11], s22 offen offset:3072 sc1
  s_add_u32 s22, s31, 28672
  buffer_load_dwordx4 a[112:115], v2, s[8:11], s22 offen offset:0 sc1
  buffer_load_dwordx4 a[116:119], v2, s[8:11], s22 offen offset:1024 sc1
  buffer_load_dwordx4 a[120:123], v2, s[8:11], s22 offen offset:2048 sc1
  buffer_load_dwordx4 a[124:127], v2, s[8:11], s22 offen offset:3072 sc1
  s_waitcnt vmcnt(24)
  s_add_u32 s22, s31, 32768
  buffer_load_dwordx4 a[128:131], v2, s[8:11], s22 offen offset:0 sc1
  buffer_load_dwordx4 a[132:135], v2, s[8:11], s22 offen offset:1024 sc1
  buffer_load_dwordx4 a[136:139], v2, s[8:11], s22 offen offset:2048 sc1
  buffer_load_dwordx4 a[140:143], v2, s[8:11], s22 offen offset:3072 sc1
  s_add_u32 s22, s31, 36864
  buffer_load_dwordx4 a[144:147], v2, s[8:11], s22 offen offset:0 sc1
  buffer_load_dwordx4 a[148:151], v2, s[8:11], s22 offen offset:1024 sc1
  buffer_load_dwordx4 a[152:155], v2, s[8:11], s22 offen offset:2048 sc1
  buffer_load_dwordx4 a[156:159], v2, s[8:11], s22 offen offset:3072 sc1
  s_add_u32 s22, s31, 40960
  buffer_load_dwordx4 a[160:163], v2, s[8:11], s22 offen offset:0 sc1
  buffer_load_dwordx4 a[164:167], v2, s[8:11], s22 offen offset:1024 sc1
  buffer_load_dwordx4 a[168:171], v2, s[8:11], s22 offen offset:2048 sc1
  buffer_load_dwordx4 a[172:175], v2, s[8:11], s22 offen offset:3072 sc1
  s_add_u32 s22, s31, 45056
  buffer_load_dwordx4 a[176:179], v2, s[8:11], s22 offen offset:0 sc1
  buffer_load_dwordx4 a[180:183], v2, s[8:11], s22 offen offset:1024 sc1
  buffer_load_dwordx4 a[184:187], v2, s[8:11], s22 offen offset:2048 sc1
  buffer_load_dwordx4 a[188:191], v2, s[8:11], s22 offen offset:3072 sc1
  s_add_u32 s22, s31, 49152
  buffer_load_dwordx4 a[192:195], v2, s[8:11], s22 offen offset:0 sc1
  buffer_load_dwordx4 a[196:199], v2, s[8:11], s22 offen offset:1024 sc1
  buffer_load_dwordx4 a[200:203], v2, s[8:11], s22 offen offset:2048 sc1
  buffer_load_dwordx4 a[204:207], v2, s[8:11], s22 offen offset:3072 sc1
  s_add_u32 s22, s31, 53248
  buffer_load_dwordx4 a[208:211], v2, s[8:11], s22 offen offset:0 sc1
  buffer_load_dwordx4 a[212:215], v2, s[8:11], s22 offen offset:1024 sc1
  buffer_load_dwordx4 a[216:219], v2, s[8:11], s22 offen offset:2048 sc1
  buffer_load_dwordx4 a[220:223], v2, s[8:11], s22 offen offset:3072 sc1
  s_add_u32 s22, s31, 57344
  buffer_load_dwordx4 a[224:227], v2, s[8:11], s22 offen offset:0 sc1
  buffer_load_dwordx4 a[228:231], v2, s[8:11], s22 offen offset:1024 sc1
  buffer_load_dwordx4 a[232:235], v2, s[8:11], s22 offen offset:2048 sc1
  buffer_load_dwordx4 a[236:239], v2, s[8:11], s22 offen offset:3072 sc1
  s_add_u32 s22, s31, 61440
  buffer_load_dwordx4 a[240:243], v2, s[8:11], s22 offen offset:0 sc1
  buffer_load_dwordx4 a[244:247], v2, s[8:11], s22 offen offset:1024 sc1
  buffer_load_dwordx4 a[248:251], v2, s[8:11], s22 offen offset:2048 sc1
  buffer_load_dwordx4 a[252:255], v2, s[8:11], s22 offen offset:3072 sc1
  s_waitcnt vmcnt(24)
  s_add_u32 s22, s31, 65536
  buffer_load_dwordx4 v[120:123], v2, s[8:11], s22 offen offset:0 sc1
  buffer_load_dwordx4 v[124:127], v2, s[8:11], s22 offen offset:1024 sc1
  buffer_load_dwordx4 v[128:131], v2, s[8:11], s22 offen offset:2048 sc1
  buffer_load_dwordx4 v[132:135], v2, s[8:11], s22 offen offset:3072 sc1
  s_add_u32 s22, s31, 69632
  buffer_load_dwordx4 v[136:139], v2, s[8:11], s22 offen offset:0 sc1
  buffer_load_dwordx4 v[140:143], v2, s[8:11], s22 offen offset:1024 sc1
  buffer_load_dwordx4 v[144:147], v2, s[8:11], s22 offen offset:2048 sc1
  buffer_load_dwordx4 v[148:151], v2, s[8:11], s22 offen offset:3072 sc1
  s_add_u32 s22, s31, 73728
  buffer_load_dwordx4 v[152:155], v2, s[8:11], s22 offen offset:0 sc1
  buffer_load_dwordx4 v[156:159], v2, s[8:11], s22 offen offset:1024 sc1
  buffer_load_dwordx4 v[160:163], v2, s[8:11], s22 offen offset:2048 sc1
  buffer_load_dwordx4 v[164:167], v2, s[8:11], s22 offen offset:3072 sc1
  s_add_u32 s22, s31, 77824
  buffer_load_dwordx4 v[168:171], v2, s[8:11], s22 offen offset:0 sc1
  buffer_load_dwordx4 v[172:175], v2, s[8:11], s22 offen offset:1024 sc1
  buffer_load_dwordx4 v[176:179], v2, s[8:11], s22 offen offset:2048 sc1
  buffer_load_dwordx4 v[180:183], v2, s[8:11], s22 offen offset:3072 sc1
  s_add_u32 s22, s31, 81920
  buffer_load_dwordx4 v[184:187], v2, s[8:11], s22 offen offset:0 sc1
  buffer_load_dwordx4 v[188:191], v2, s[8:11], s22 offen offset:1024 sc1
  buffer_load_dwordx4 v[192:195], v2, s[8:11], s22 offen offset:2048 sc1
  buffer_load_dwordx4 v[196:199], v2, s[8:11], s22 offen offset:3072 sc1
  s_add_u32 s22, s31, 86016
  buffer_load_dwordx4 v[200:203], v2, s[8:11], s22 offen offset:0 sc1
  buffer_load_dwordx4 v[204:207], v2, s[8:11], s22 offen offset:1024 sc1
  buffer_load_dwordx4 v[208:211], v2, s[8:11], s22 offen offset:2048 sc1
  buffer_load_dwordx4 v[212:215], v2, s[8:11], s22 offen offset:3072 sc1
  s_add_u32 s22, s31, 90112
  buffer_load_dwordx4 v[216:219], v2, s[8:11], s22 offen offset:0 sc1
  buffer_load_dwordx4 v[220:223], v2, s[8:11], s22 offen offset:1024 sc1
  buffer_load_dwordx4 v[224:227], v2, s[8:11], s22 offen offset:2048 sc1
  buffer_load_dwordx4 v[228:231], v2, s[8:11], s22 offen offset:3072 sc1
  s_add_u32 s22, s31, 94208
  buffer_load_dwordx4 v[232:235], v2, s[8:11], s22 offen offset:0 sc1
  buffer_load_dwordx4 v[236:239], v2, s[8:11], s22 offen offset:1024 sc1
  buffer_load_dwordx4 v[240:243], v2, s[8:11], s22 offen offset:2048 sc1
  buffer_load_dwordx4 v[244:247], v2, s[8:11], s22 offen offset:3072 sc1
  s_waitcnt vmcnt(24)
  s_add_u32 s22, s31, 98304
  buffer_load_dwordx4 v[248:251], v2, s[8:11], s22 offen offset:0 sc1
  buffer_load_dwordx4 v[252:255], v2, s[8:11], s22 offen offset:1024 sc1
  s_mov_b32 s30, 0
ch_ws7:
  buffer_load_dword v9, off, s[12:15], 0 offset:132 sc1
  s_waitcnt vmcnt(0)
  v_cmp_ne_u32 vcc, 1, v9
  s_cbranch_vccz ch_ws7_ok
  s_sleep 8
  s_add_u32 s30, s30, 1
  s_cmp_lt_u32 s30, 400000
  s_cbranch_scc1 ch_ws7
  s_branch cA_abort
ch_ws7_ok:
  s_lshl_b32 s27, s17, 7
  s_add_u32 s27, s27, 524288
  s_mov_b32 s30, 0
ch_vw3:
  buffer_load_dword v9, off, s[8:11], s27 sc1
  s_waitcnt vmcnt(0)
  v_cmp_ne_u32 vcc, 56, v9
  s_cbranch_vccz ch_vw3_d
  s_sleep 2
  s_add_u32 s30, s30, 1
  s_cmp_lt_u32 s30, 400000
  s_cbranch_scc1 ch_vw3
  s_branch cA_abort
ch_vw3_d:
  s_mov_b32 s28, s35
  s_mov_b32 s39, 684032
  buffer_load_dword v100, v116, s[8:11], s39 offen sc1
  s_mov_b32 s39, 712704
  s_waitcnt vmcnt(1) lgkmcnt(0)
  s_mov_b32 s31, 0
  s_cmp_lg_u32 s88, 0
  s_cbranch_scc1 cB_va3_loop
  s_branch cA_va3_loop
.p2align 6
cA_sc0_loop:
  s_mov_b32 s30, 0
  s_mov_b32 s62, 0
  s_setprio 3
  s_sleep 6
cA_sc0_fp_l:
  v_cmp_gt_u32 vcc, s19, v112
  buffer_load_dword v112, v0, s[8:11], 0 offen sc1
  s_cbranch_vccz cA_sc0_fp_d
  v_cmp_gt_u32 vcc, s19, v112
  buffer_load_dword v112, v0, s[8:11], 0 offen sc1
  s_cbranch_vccz cA_sc0_fp_d
  v_cmp_gt_u32 vcc, s19, v112
  buffer_load_dword v112, v0, s[8:11], 0 offen sc1
  s_cbranch_vccz cA_sc0_fp_d
  v_cmp_gt_u32 vcc, s19, v112
  buffer_load_dword v112, v0, s[8:11], 0 offen sc1
  s_cbranch_vccz cA_sc0_fp_d
  v_cmp_gt_u32 vcc, s19, v112
  buffer_load_dword v112, v0, s[8:11], 0 offen sc1
  s_cbranch_vccz cA_sc0_fp_d
  v_cmp_gt_u32 vcc, s19, v112
  buffer_load_dword v112, v0, s[8:11], 0 offen sc1
  s_cbranch_vccz cA_sc0_fp_d
  v_cmp_gt_u32 vcc, s19, v112
  buffer_load_dword v112, v0, s[8:11], 0 offen sc1
  s_cbranch_vccz cA_sc0_fp_d
  v_cmp_gt_u32 vcc, s19, v112
  buffer_load_dword v112, v0, s[8:11], 0 offen sc1
  s_cbranch_vccz cA_sc0_fp_d
  v_cmp_gt_u32 vcc, s19, v112
  buffer_load_dword v112, v0, s[8:11], 0 offen sc1
  s_cbranch_vccz cA_sc0_fp_d
  v_cmp_gt_u32 vcc, s19, v112
  buffer_load_dword v112, v0, s[8:11], 0 offen sc1
  s_cbranch_vccz cA_sc0_fp_d
  v_cmp_gt_u32 vcc, s19, v112
  buffer_load_dword v112, v0, s[8:11], 0 offen sc1
  s_cbranch_vccz cA_sc0_fp_d
  v_cmp_gt_u32 vcc, s19, v112
  buffer_load_dword v112, v0, s[8:11], 0 offen sc1
  s_cbranch_vccz cA_sc0_fp_d
  v_cmp_gt_u32 vcc, s19, v112
  buffer_load_dword v112, v0, s[8:11], 0 offen sc1
  s_cbranch_vccz cA_sc0_fp_d
  v_cmp_gt_u32 vcc, s19, v112
  buffer_load_dword v112, v0, s[8:11], 0 offen sc1
  s_cbranch_vccz cA_sc0_fp_d
  v_cmp_gt_u32 vcc, s19, v112
  buffer_load_dword v112, v0, s[8:11], 0 offen sc1
  s_cbranch_vccz cA_sc0_fp_d
  v_cmp_gt_u32 vcc, s19, v112
  buffer_load_dword v112, v0, s[8:11], 0 offen sc1
  s_cbranch_vccz cA_sc0_fp_d
  s_waitcnt vmcnt(24)
  s_add_u32 s30, s30, 1
  s_cmp_lt_u32 s30, 400000
  s_cbranch_scc1 cA_sc0_fp_l
  s_branch cA_abort
cA_sc0_fp_d:
  buffer_load_dwordx4 v[8:11], v2, s[8:11], s20 offen offset:0 sc1
  s_barrier
  s_setprio 2
  buffer_load_dwordx4 v[12:15], v2, s[8:11], s20 offen offset:1024 sc1
  s_setprio 1
  buffer_load_dwordx4 v[16:19], v2, s[8:11], s20 offen offset:2048 sc1
  s_setprio 0
  buffer_load_dwordx4 v[20:23], v2, s[8:11], s20 offen offset:3072 sc1
cA_sc0_go:
  s_waitcnt vmcnt(3)
  v_smfmac_f32_16x16x64_bf16 v[36:39], v[8:11], a[0:7], v3
  buffer_load_dwordx4 v[32:35], v2, s[8:11], s23 offen offset:0 sc1
  v_cmp_eq_u32 vcc, -1, v8
  v_smfmac_f32_16x16x64_bf16 v[40:43], v[8:11], a[56:63], v3
  v_smfmac_f32_16x16x64_bf16 v[44:47], v[8:11], a[112:119], v3
  buffer_load_dwordx4 v[24:27], v2, s[8:11], s23 offen offset:1024 sc1
  s_cbranch_vccnz cA_sc0_r0
  v_smfmac_f32_16x16x64_bf16 v[48:51], v[8:11], a[168:175], v3
  v_smfmac_f32_16x16x64_bf16 v[52:55], v[8:11], a[224:231], v3
  s_waitcnt vmcnt(4)
  v_cmp_eq_u32 vcc, -1, v12
  v_smfmac_f32_16x16x64_bf16 v[56:59], v[8:11], v[144:151], v3
  buffer_load_dwordx4 v[28:31], v2, s[8:11], s23 offen offset:2048 sc1
  v_smfmac_f32_16x16x64_bf16 v[60:63], v[8:11], v[200:207], v3
  s_cbranch_vccnz cA_sc0_r1
cA_sc0_c1:
  v_smfmac_f32_16x16x64_bf16 v[36:39], v[12:15], a[8:15], v3
  v_smfmac_f32_16x16x64_bf16 v[40:43], v[12:15], a[64:71], v3
  v_smfmac_f32_16x16x64_bf16 v[44:47], v[12:15], a[120:127], v3
  v_smfmac_f32_16x16x64_bf16 v[48:51], v[12:15], a[176:183], v3
  v_smfmac_f32_16x16x64_bf16 v[52:55], v[12:15], a[232:239], v3
  s_waitcnt vmcnt(4)
  v_cmp_eq_u32 vcc, -1, v16
  v_smfmac_f32_16x16x64_bf16 v[56:59], v[12:15], v[152:159], v3
  buffer_load_dwordx4 v[88:91], v117, s[8:11], s26 offen offset:0 sc1
  v_smfmac_f32_16x16x64_bf16 v[60:63], v[12:15], v[208:215], v3
  s_cbranch_vccnz cA_sc0_r2
cA_sc0_c2:
  v_smfmac_f32_16x16x64_bf16 v[36:39], v[16:19], a[16:23], v3
  v_smfmac_f32_16x16x64_bf16 v[40:43], v[16:19], a[72:79], v3
  v_smfmac_f32_16x16x64_bf16 v[44:47], v[16:19], a[128:135], v3
  buffer_load_dwordx4 v[92:95], v117, s[8:11], s26 offen offset:1024 sc1
  v_smfmac_f32_16x16x64_bf16 v[48:51], v[16:19], a[184:191], v3
  v_smfmac_f32_16x16x64_bf16 v[52:55], v[16:19], a[240:247], v3
  s_waitcnt vmcnt(5)
  v_cmp_eq_u32 vcc, -1, v20
  v_smfmac_f32_16x16x64_bf16 v[56:59], v[16:19], v[160:167], v3
  v_smfmac_f32_16x16x64_bf16 v[60:63], v[16:19], v[216:223], v3
  buffer_load_dwordx4 v[96:99], v2, s[8:11], s24 offen offset:0 sc1
  s_cbranch_vccnz cA_sc0_r3
cA_sc0_c3:
  v_smfmac_f32_16x16x64_bf16 v[36:39], v[20:23], a[24:31], v3
  v_smfmac_f32_16x16x64_bf16 v[40:43], v[20:23], a[80:87], v3
  s_waitcnt vmcnt(3)
  v_max3_u32 v66, v24, v27, v28
  v_smfmac_f32_16x16x64_bf16 v[44:47], v[20:23], a[136:143], v3
  v_max3_u32 v66, v66, v31, v32
  v_smfmac_f32_16x16x64_bf16 v[48:51], v[20:23], a[192:199], v3
  buffer_load_dwordx4 v[100:103], v2, s[8:11], s24 offen offset:1024 sc1
  v_max_u32 v66, v66, v35
  v_smfmac_f32_16x16x64_bf16 v[52:55], v[20:23], a[248:255], v3
  v_cmp_eq_u32 vcc, -1, v66
  v_smfmac_f32_16x16x64_bf16 v[56:59], v[20:23], v[168:175], v3
  v_smfmac_f32_16x16x64_bf16 v[60:63], v[20:23], v[224:231], v3
  s_cbranch_vccnz cA_sc0_r4
cA_sc0_c4:
  v_smfmac_f32_16x16x64_bf16 v[60:63], v[32:35], v[232:239], v3
  buffer_load_dwordx4 v[104:107], v2, s[8:11], s26 offen offset:0 sc1
  v_smfmac_f32_16x16x64_bf16 v[60:63], v[24:27], v[240:247], v3
  v_smfmac_f32_16x16x64_bf16 v[60:63], v[28:31], v[248:255], v3
  v_smfmac_f32_16x16x64_bf16 v[52:55], v[32:35], v[120:127], v3
  v_smfmac_f32_16x16x64_bf16 v[52:55], v[24:27], v[128:135], v3
  buffer_load_dwordx4 v[108:111], v2, s[8:11], s26 offen offset:1024 sc1
  v_smfmac_f32_16x16x64_bf16 v[52:55], v[28:31], v[136:143], v3
  v_cvt_pk_bf16_f32 v63, v62, v63
  v_smfmac_f32_16x16x64_bf16 v[56:59], v[32:35], v[176:183], v3
  v_cvt_pk_bf16_f32 v62, v60, v61
  v_smfmac_f32_16x16x64_bf16 v[56:59], v[24:27], v[184:191], v3
  v_mfma_f32_16x16x32_bf16 v[12:15], v[62:65], v[4:7], 0
  v_cvt_pk_bf16_f32 v55, v54, v55
  v_smfmac_f32_16x16x64_bf16 v[56:59], v[28:31], v[192:199], v3
  v_cvt_pk_bf16_f32 v54, v52, v53
  v_smfmac_f32_16x16x64_bf16 v[36:39], v[32:35], a[32:39], v3
  s_nop 1
  v_cvt_pk_bf16_f32 v76, v12, v13
  v_smfmac_f32_16x16x64_bf16 v[36:39], v[24:27], a[40:47], v3
  v_cvt_pk_bf16_f32 v77, v14, v15
  v_smfmac_f32_16x16x64_bf16 v[36:39], v[28:31], a[48:55], v3
  v_cvt_pk_bf16_f32 v56, v56, v57
  v_smfmac_f32_16x16x64_bf16 v[40:43], v[32:35], a[88:95], v3
  v_cvt_pk_bf16_f32 v57, v58, v59
  v_smfmac_f32_16x16x64_bf16 v[40:43], v[24:27], a[96:103], v3
  v_mfma_f32_16x16x32_bf16 v[16:19], v[54:57], v[4:7], 0
  v_cvt_pk_bf16_f32 v39, v38, v39
  v_smfmac_f32_16x16x64_bf16 v[40:43], v[28:31], a[104:111], v3
  v_cvt_pk_bf16_f32 v38, v36, v37
  v_smfmac_f32_16x16x64_bf16 v[44:47], v[32:35], a[144:151], v3
  s_nop 1
  v_cvt_pk_bf16_f32 v78, v16, v17
  v_smfmac_f32_16x16x64_bf16 v[44:47], v[24:27], a[152:159], v3
  v_cvt_pk_bf16_f32 v79, v18, v19
  v_smfmac_f32_16x16x64_bf16 v[44:47], v[28:31], a[160:167], v3
  v_cvt_pk_bf16_f32 v40, v40, v41
  v_smfmac_f32_16x16x64_bf16 v[48:51], v[32:35], a[200:207], v3
  v_cvt_pk_bf16_f32 v41, v42, v43
  v_smfmac_f32_16x16x64_bf16 v[48:51], v[24:27], a[208:215], v3
  v_smfmac_f32_16x16x64_bf16 v[48:51], v[28:31], a[216:223], v3
  s_waitcnt vmcnt(4)
  v_cvt_pk_bf16_f32 v47, v46, v47
  v_smfmac_f32_16x16x64_bf16 v[68:71], v[76:79], v[80:87], v3
  v_cvt_pk_bf16_f32 v46, v44, v45
  v_mfma_f32_16x16x32_bf16 v[12:15], v[38:41], v[4:7], 0
  s_nop 1
  v_cvt_pk_bf16_f32 v48, v48, v49
  v_cvt_pk_bf16_f32 v49, v50, v51
  s_nop 1
  v_mfma_f32_16x16x32_bf16 v[16:19], v[46:49], v[4:7], 0
  v_smfmac_f32_16x16x64_bf16 v[72:75], v[76:79], v[88:95], v3
  v_cvt_pk_bf16_f32 v20, v12, v13
  v_mfma_f32_16x16x32_bf16 v[52:55], v[30:33], v[76:79], 0
  s_waitcnt vmcnt(0)
  v_cvt_pk_bf16_f32 v21, v14, v15
  v_cvt_pk_bf16_f32 v22, v16, v17
  v_cvt_pk_bf16_f32 v23, v18, v19
  s_nop 1
  v_mfma_f32_16x16x32_bf16 v[52:55], v[8:11], v[20:23], v[52:55]
  v_smfmac_f32_16x16x64_bf16 v[68:71], v[20:23], v[96:103], v3
  v_smfmac_f32_16x16x64_bf16 v[72:75], v[20:23], v[104:111], v3
  s_nop 1
  ds_write_b128 v113, v[52:55]
  s_nop 1
  v_permlane32_swap_b32 v68, v70
  v_permlane32_swap_b32 v69, v71
  v_add_f32 v56, v68, v70
  v_add_f32 v58, v69, v71
  v_permlane32_swap_b32 v72, v74
  v_permlane32_swap_b32 v73, v75
  v_add_f32 v57, v72, v74
  v_add_f32 v59, v73, v75
  ds_write_b128 v2, v[56:59] offset:0
  v_cmp_u_f32 vcc, v57, v59
  v_mov_b32 v68, 0
  v_mov_b32 v69, 0
  v_mov_b32 v70, 0
  v_mov_b32 v71, 0
  s_cbranch_vccnz cA_sc0_retry
cA_sc0_cont:
  s_add_u32 s24, s24, 28672
  s_add_u32 s26, s26, 28672
  buffer_load_dwordx4 v[80:83], v117, s[8:11], s24 offen offset:0 sc1
  buffer_load_dwordx4 v[84:87], v117, s[8:11], s24 offen offset:1024 sc1
  v_mov_b32 v72, 0
  v_mov_b32 v73, 0
  v_mfma_f32_32x32x16_bf16 v[36:51], v[68:71], v[68:71], 0
  s_waitcnt lgkmcnt(0)
  s_barrier
  ds_read_b64 v[8:9], v114 offset:0
  ds_read_b64 v[10:11], v114 offset:1024
  ds_read_b64 v[12:13], v114 offset:2048
  ds_read_b64 v[14:15], v114 offset:3072
  ds_read2_b32 v[16:17], v115 offset0:0 offset1:64
  ds_read2_b32 v[18:19], v115 offset0:128 offset1:192
  v_mfma_f32_32x32x16_bf16 v[52:67], v[68:71], v[68:71], 0
  s_waitcnt lgkmcnt(0)
  v_pk_add_f32 v[16:17], v[16:17], v[18:19]
  v_pk_add_f32 v[8:9], v[8:9], v[10:11]
  v_pk_add_f32 v[12:13], v[12:13], v[14:15]
  v_add_f32 v20, v16, v17
  v_pk_add_f32 v[8:9], v[8:9], v[12:13]
  v_max_f32 v22, v8, v9
  v_add_f32_dpp v20, v20, v20 row_ror:8 row_mask:0xf bank_mask:0xf
  s_nop 0
  v_max_f32_dpp v22, v22, v22 row_ror:8 row_mask:0xf bank_mask:0xf
  v_max_f32 v22, v22, v20
  s_nop 1
  v_max_f32_dpp v22, v22, v22 quad_perm:[1,0,3,2] row_mask:0xf bank_mask:0xf
  s_nop 1
  v_max_f32_dpp v22, v22, v22 quad_perm:[2,3,0,1] row_mask:0xf bank_mask:0xf
  s_nop 1
  v_max_f32_dpp v22, v22, v22 row_half_mirror row_mask:0xf bank_mask:0xf
  v_pk_add_f32 v[8:9], v[8:9], v[22:23] op_sel_hi:[1,0] neg_lo:[0,1] neg_hi:[0,1]
  v_sub_f32 v20, v20, v22
  v_exp_f32 v8, v8
  v_exp_f32 v9, v9
  v_exp_f32 v20, v20
  v_add_f32 v24, v8, v9
  v_fmac_f32 v24, 0.5, v20
  v_mov_b32_dpp v21, v20 quad_perm:[1,0,3,2] row_mask:0xf bank_mask:0xf
  s_nop 0
  v_add_f32_dpp v24, v24, v24 quad_perm:[1,0,3,2] row_mask:0xf bank_mask:0xf
  s_nop 1
  v_add_f32_dpp v24, v24, v24 quad_perm:[2,3,0,1] row_mask:0xf bank_mask:0xf
  s_nop 1
  v_add_f32_dpp v24, v24, v24 row_half_mirror row_mask:0xf bank_mask:0xf
  s_nop 1
  v_add_f32_dpp v24, v24, v24 row_ror:8 row_mask:0xf bank_mask:0xf
  v_rcp_f32 v24, v24
  s_nop 0
  v_pk_mul_f32 v[8:9], v[8:9], v[24:25] op_sel_hi:[1,0]
  v_cvt_pk_bf16_f32 v8, abs(v8), abs(v9)
  buffer_store_dword v8, v1, s[8:11], s20 offen
  v_pk_mul_f32 v[20:21], v[20:21], v[24:25] op_sel_hi:[1,0]
  v_cvt_pk_bf16_f32 v20, abs(v20), abs(v21)
  buffer_store_dword v20, v118, s[8:11], s20 offen
  v_mov_b32 v74, 0
  v_mov_b32 v75, 0
  s_mov_b32 s19, s18
  s_add_u32 s18, s18, 1
  s_mov_b32 s22, s20
  s_mov_b32 s20, s21
  s_mov_b32 s21, s22
  s_add_u32 s23, s20, 4096
  s_cmp_lt_u32 s19, 63
  s_cbranch_scc1 cA_sc0_loop
  s_branch cA_done
cA_sc0_r0:
  s_add_u32 s31, s31, 1
  buffer_load_dwordx4 v[8:11], v2, s[8:11], s20 offen offset:0 sc1
  s_waitcnt vmcnt(0)
  v_cmp_eq_u32 vcc, -1, v8
  v_mov_b32 v36, 0
  v_mov_b32 v37, 0
  v_mov_b32 v38, 0
  v_mov_b32 v39, 0
  v_mov_b32 v40, 0
  v_mov_b32 v41, 0
  v_mov_b32 v42, 0
  v_mov_b32 v43, 0
  v_mov_b32 v44, 0
  v_mov_b32 v45, 0
  v_mov_b32 v46, 0
  v_mov_b32 v47, 0
  v_mov_b32 v48, 0
  v_mov_b32 v49, 0
  v_mov_b32 v50, 0
  v_mov_b32 v51, 0
  s_nop 1
  s_cbranch_vccz cA_sc0_go
  s_add_u32 s30, s30, 1
  s_cmp_lt_u32 s30, 400000
  s_cbranch_scc1 cA_sc0_r0
  s_branch cA_abort
cA_sc0_r1:
  s_add_u32 s31, s31, 1
  buffer_load_dwordx4 v[12:15], v2, s[8:11], s20 offen offset:1024 sc1
  s_waitcnt vmcnt(0)
  v_cmp_eq_u32 vcc, -1, v12
  s_nop 4
  s_cbranch_vccz cA_sc0_c1
  s_add_u32 s30, s30, 1
  s_cmp_lt_u32 s30, 400000
  s_cbranch_scc1 cA_sc0_r1
  s_branch cA_abort
cA_sc0_r2:
  s_add_u32 s31, s31, 1
  buffer_load_dwordx4 v[16:19], v2, s[8:11], s20 offen offset:2048 sc1
  s_waitcnt vmcnt(0)
  v_cmp_eq_u32 vcc, -1, v16
  s_nop 4
  s_cbranch_vccz cA_sc0_c2
  s_add_u32 s30, s30, 1
  s_cmp_lt_u32 s30, 400000
  s_cbranch_scc1 cA_sc0_r2
  s_branch cA_abort
cA_sc0_r3:
  s_add_u32 s31, s31, 1
  buffer_load_dwordx4 v[20:23], v2, s[8:11], s20 offen offset:3072 sc1
  s_waitcnt vmcnt(0)
  v_cmp_eq_u32 vcc, -1, v20
  s_nop 4
  s_cbranch_vccz cA_sc0_c3
  s_add_u32 s30, s30, 1
  s_cmp_lt_u32 s30, 400000
  s_cbranch_scc1 cA_sc0_r3
  s_branch cA_abort
cA_sc0_r4:
  s_add_u32 s31, s31, 1
  buffer_load_dwordx4 v[32:35], v2, s[8:11], s23 offen offset:0 sc1
  buffer_load_dwordx4 v[24:27], v2, s[8:11], s23 offen offset:1024 sc1
  buffer_load_dwordx4 v[28:31], v2, s[8:11], s23 offen offset:2048 sc1
  s_waitcnt vmcnt(0)
  v_max3_u32 v66, v24, v27, v28
  v_max3_u32 v66, v66, v31, v32
  v_max_u32 v66, v66, v35
  v_cmp_eq_u32 vcc, -1, v66
  s_nop 4
  s_cbranch_vccz cA_sc0_c4
  s_add_u32 s30, s30, 1
  s_cmp_lt_u32 s30, 400000
  s_cbranch_scc1 cA_sc0_r4
  s_branch cA_abort
cA_sc0_retry:
  s_cmp_lg_u32 s62, 0
  s_cbranch_scc1 cA_sc0_cont
  s_waitcnt vmcnt(0) lgkmcnt(0)
cA_sc0_rv:
  buffer_load_dwordx4 v[8:11], v2, s[8:11], s20 offen offset:0 sc1
  buffer_load_dwordx4 v[12:15], v2, s[8:11], s20 offen offset:1024 sc1
  buffer_load_dwordx4 v[16:19], v2, s[8:11], s20 offen offset:2048 sc1
  buffer_load_dwordx4 v[20:23], v2, s[8:11], s20 offen offset:3072 sc1
  buffer_load_dwordx4 v[32:35], v2, s[8:11], s23 offen offset:0 sc1
  buffer_load_dwordx4 v[24:27], v2, s[8:11], s23 offen offset:1024 sc1
  buffer_load_dwordx4 v[28:31], v2, s[8:11], s23 offen offset:2048 sc1
  s_waitcnt vmcnt(0)
  v_max3_u32 v66, v8, v9, v10
  v_max3_u32 v66, v66, v11, v12
  v_max3_u32 v66, v66, v13, v14
  v_max3_u32 v66, v66, v15, v16
  v_max3_u32 v66, v66, v17, v18
  v_max3_u32 v66, v66, v19, v20
  v_max3_u32 v66, v66, v21, v22
  v_max3_u32 v66, v66, v23, v24
  v_max3_u32 v66, v66, v25, v26
  v_max3_u32 v66, v66, v27, v28
  v_max3_u32 v66, v66, v29, v30
  v_max3_u32 v66, v66, v31, v32
  v_max3_u32 v66, v66, v33, v34
  v_max_u32 v66, v66, v35
  v_cmp_eq_u32 vcc, -1, v66
  s_cbranch_vccz cA_sc0_rk
  s_add_u32 s30, s30, 1
  s_cmp_lt_u32 s30, 400000
  s_cbranch_scc1 cA_sc0_rv
  s_branch cA_abort
cA_sc0_rk:
  s_mov_b32 s62, 1
  v_mov_b32 v36, 0
  v_mov_b32 v37, 0
  v_mov_b32 v38, 0
  v_mov_b32 v39, 0
  v_mov_b32 v40, 0
  v_mov_b32 v41, 0
  v_mov_b32 v42, 0
  v_mov_b32 v43, 0
  v_mov_b32 v44, 0
  v_mov_b32 v45, 0
  v_mov_b32 v46, 0
  v_mov_b32 v47, 0
  v_mov_b32 v48, 0
  v_mov_b32 v49, 0
  v_mov_b32 v50, 0
  v_mov_b32 v51, 0
  v_mov_b32 v60, 0
  v_mov_b32 v61, 0
  v_mov_b32 v62, 0
  v_mov_b32 v63, 0
  v_mov_b32 v68, 0
  v_mov_b32 v69, 0
  v_mov_b32 v70, 0
  v_mov_b32 v71, 0
  v_mov_b32 v72, 0
  v_mov_b32 v73, 0
  v_mov_b32 v74, 0
  v_mov_b32 v75, 0
  v_mov_b32 v52, 0
  v_mov_b32 v53, 0
  v_mov_b32 v54, 0
  v_mov_b32 v55, 0
  v_mov_b32 v56, 0
  v_mov_b32 v57, 0
  v_mov_b32 v58, 0
  v_mov_b32 v59, 0
  s_add_u32 s31, s31, 0x100
  s_nop 0
  s_branch cA_sc0_go
.p2align 6
cA_sc1_loop:
  s_mov_b32 s30, 0
  s_mov_b32 s62, 0
  s_setprio 3
  s_barrier
  buffer_load_dwordx4 v[8:11], v2, s[8:11], s20 offen offset:0 sc1
  s_setprio 2
  buffer_load_dwordx4 v[12:15], v2, s[8:11], s20 offen offset:1024 sc1
  s_setprio 1
  buffer_load_dwordx4 v[16:19], v2, s[8:11], s20 offen offset:2048 sc1
  s_setprio 0
  buffer_load_dwordx4 v[20:23], v2, s[8:11], s20 offen offset:3072 sc1
cA_sc1_go:
  s_waitcnt vmcnt(3)
  v_smfmac_f32_16x16x64_bf16 v[36:39], v[8:11], a[0:7], v3
  buffer_load_dwordx4 v[28:31], v2, s[8:11], s23 offen offset:0 sc1
  v_cmp_eq_u32 vcc, -1, v8
  v_smfmac_f32_16x16x64_bf16 v[40:43], v[8:11], a[56:63], v3
  v_smfmac_f32_16x16x64_bf16 v[44:47], v[8:11], a[112:119], v3
  buffer_load_dwordx4 v[24:27], v2, s[8:11], s23 offen offset:1024 sc1
  s_cbranch_vccnz cA_sc1_r0
  v_smfmac_f32_16x16x64_bf16 v[48:51], v[8:11], a[168:175], v3
  v_smfmac_f32_16x16x64_bf16 v[52:55], v[8:11], a[224:231], v3
  s_waitcnt vmcnt(4)
  v_cmp_eq_u32 vcc, -1, v12
  v_smfmac_f32_16x16x64_bf16 v[56:59], v[8:11], v[144:151], v3
  buffer_load_dwordx4 v[32:35], v2, s[8:11], s23 offen offset:2048 sc1
  v_smfmac_f32_16x16x64_bf16 v[60:63], v[8:11], v[200:207], v3
  s_cbranch_vccnz cA_sc1_r1
cA_sc1_c1:
  v_smfmac_f32_16x16x64_bf16 v[36:39], v[12:15], a[8:15], v3
  v_smfmac_f32_16x16x64_bf16 v[40:43], v[12:15], a[64:71], v3
  v_smfmac_f32_16x16x64_bf16 v[44:47], v[12:15], a[120:127], v3
  v_smfmac_f32_16x16x64_bf16 v[48:51], v[12:15], a[176:183], v3
  v_smfmac_f32_16x16x64_bf16 v[52:55], v[12:15], a[232:239], v3
  s_waitcnt vmcnt(4)
  v_cmp_eq_u32 vcc, -1, v16
  v_smfmac_f32_16x16x64_bf16 v[56:59], v[12:15], v[152:159], v3
  buffer_load_dwordx4 v[88:91], v117, s[8:11], s26 offen offset:0 sc1
  v_smfmac_f32_16x16x64_bf16 v[60:63], v[12:15], v[208:215], v3
  s_cbranch_vccnz cA_sc1_r2
cA_sc1_c2:
  v_smfmac_f32_16x16x64_bf16 v[36:39], v[16:19], a[16:23], v3
  v_smfmac_f32_16x16x64_bf16 v[40:43], v[16:19], a[72:79], v3
  v_smfmac_f32_16x16x64_bf16 v[44:47], v[16:19], a[128:135], v3
  buffer_load_dwordx4 v[92:95], v117, s[8:11], s26 offen offset:1024 sc1
  v_smfmac_f32_16x16x64_bf16 v[48:51], v[16:19], a[184:191], v3
  v_smfmac_f32_16x16x64_bf16 v[52:55], v[16:19], a[240:247], v3
  s_waitcnt vmcnt(5)
  v_cmp_eq_u32 vcc, -1, v20
  v_smfmac_f32_16x16x64_bf16 v[56:59], v[16:19], v[160:167], v3
  v_smfmac_f32_16x16x64_bf16 v[60:63], v[16:19], v[216:223], v3
  buffer_load_dwordx4 v[96:99], v2, s[8:11], s24 offen offset:0 sc1
  s_cbranch_vccnz cA_sc1_r3
cA_sc1_c3:
  v_smfmac_f32_16x16x64_bf16 v[36:39], v[20:23], a[24:31], v3
  v_smfmac_f32_16x16x64_bf16 v[40:43], v[20:23], a[80:87], v3
  s_waitcnt vmcnt(3)
  v_max3_u32 v66, v24, v27, v28
  v_smfmac_f32_16x16x64_bf16 v[44:47], v[20:23], a[136:143], v3
  v_max3_u32 v66, v66, v31, v32
  v_smfmac_f32_16x16x64_bf16 v[48:51], v[20:23], a[192:199], v3
  buffer_load_dwordx4 v[100:103], v2, s[8:11], s24 offen offset:1024 sc1
  v_max_u32 v66, v66, v35
  v_smfmac_f32_16x16x64_bf16 v[52:55], v[20:23], a[248:255], v3
  v_cmp_eq_u32 vcc, -1, v66
  v_smfmac_f32_16x16x64_bf16 v[56:59], v[20:23], v[168:175], v3
  v_smfmac_f32_16x16x64_bf16 v[60:63], v[20:23], v[224:231], v3
  s_cbranch_vccnz cA_sc1_r4
cA_sc1_c4:
  v_smfmac_f32_16x16x64_bf16 v[60:63], v[28:31], v[232:239], v3
  buffer_load_dwordx4 v[104:107], v2, s[8:11], s26 offen offset:0 sc1
  v_smfmac_f32_16x16x64_bf16 v[60:63], v[24:27], v[240:247], v3
  v_smfmac_f32_16x16x64_bf16 v[60:63], v[32:35], v[248:255], v3
  v_smfmac_f32_16x16x64_bf16 v[52:55], v[28:31], v[120:127], v3
  v_smfmac_f32_16x16x64_bf16 v[52:55], v[24:27], v[128:135], v3
  buffer_load_dwordx4 v[108:111], v2, s[8:11], s26 offen offset:1024 sc1
  v_smfmac_f32_16x16x64_bf16 v[52:55], v[32:35], v[136:143], v3
  v_cvt_pk_bf16_f32 v63, v62, v63
  v_smfmac_f32_16x16x64_bf16 v[56:59], v[28:31], v[176:183], v3
  v_cvt_pk_bf16_f32 v62, v60, v61
  v_smfmac_f32_16x16x64_bf16 v[56:59], v[24:27], v[184:191], v3
  v_mfma_f32_16x16x32_bf16 v[8:11], v[62:65], v[4:7], 0
  v_cvt_pk_bf16_f32 v55, v54, v55
  v_smfmac_f32_16x16x64_bf16 v[56:59], v[32:35], v[192:199], v3
  v_cvt_pk_bf16_f32 v54, v52, v53
  v_smfmac_f32_16x16x64_bf16 v[36:39], v[28:31], a[32:39], v3
  s_nop 1
  v_cvt_pk_bf16_f32 v78, v8, v9
  v_smfmac_f32_16x16x64_bf16 v[36:39], v[24:27], a[40:47], v3
  v_cvt_pk_bf16_f32 v79, v10, v11
  v_smfmac_f32_16x16x64_bf16 v[36:39], v[32:35], a[48:55], v3
  v_cvt_pk_bf16_f32 v56, v56, v57
  v_smfmac_f32_16x16x64_bf16 v[40:43], v[28:31], a[88:95], v3
  v_cvt_pk_bf16_f32 v57, v58, v59
  v_smfmac_f32_16x16x64_bf16 v[40:43], v[24:27], a[96:103], v3
  v_mfma_f32_16x16x32_bf16 v[16:19], v[54:57], v[4:7], 0
  v_cvt_pk_bf16_f32 v39, v38, v39
  v_smfmac_f32_16x16x64_bf16 v[40:43], v[32:35], a[104:111], v3
  v_cvt_pk_bf16_f32 v38, v36, v37
  v_smfmac_f32_16x16x64_bf16 v[44:47], v[28:31], a[144:151], v3
  s_nop 1
  v_cvt_pk_bf16_f32 v76, v16, v17
  v_smfmac_f32_16x16x64_bf16 v[44:47], v[24:27], a[152:159], v3
  v_cvt_pk_bf16_f32 v77, v18, v19
  v_smfmac_f32_16x16x64_bf16 v[44:47], v[32:35], a[160:167], v3
  v_cvt_pk_bf16_f32 v40, v40, v41
  v_smfmac_f32_16x16x64_bf16 v[48:51], v[28:31], a[200:207], v3
  v_cvt_pk_bf16_f32 v41, v42, v43
  v_smfmac_f32_16x16x64_bf16 v[48:51], v[24:27], a[208:215], v3
  v_smfmac_f32_16x16x64_bf16 v[48:51], v[32:35], a[216:223], v3
  s_waitcnt vmcnt(4)
  v_cvt_pk_bf16_f32 v47, v46, v47
  v_smfmac_f32_16x16x64_bf16 v[68:71], v[76:79], v[80:87], v3
  v_cvt_pk_bf16_f32 v46, v44, v45
  v_mfma_f32_16x16x32_bf16 v[8:11], v[38:41], v[4:7], 0
  s_nop 1
  v_cvt_pk_bf16_f32 v48, v48, v49
  v_cvt_pk_bf16_f32 v49, v50, v51
  s_nop 1
  v_mfma_f32_16x16x32_bf16 v[16:19], v[46:49], v[4:7], 0
  v_smfmac_f32_16x16x64_bf16 v[72:75], v[76:79], v[88:95], v3
  v_cvt_pk_bf16_f32 v20, v8, v9
  v_mfma_f32_16x16x32_bf16 v[52:55], v[30:33], v[76:79], 0
  s_waitcnt vmcnt(0)
  v_cvt_pk_bf16_f32 v21, v10, v11
  v_cvt_pk_bf16_f32 v22, v16, v17
  v_cvt_pk_bf16_f32 v23, v18, v19
  s_nop 1
  v_mfma_f32_16x16x32_bf16 v[52:55], v[12:15], v[20:23], v[52:55]
  v_smfmac_f32_16x16x64_bf16 v[68:71], v[20:23], v[96:103], v3
  v_smfmac_f32_16x16x64_bf16 v[72:75], v[20:23], v[104:111], v3
  s_nop 1
  ds_write_b128 v113, v[52:55]
  s_nop 1
  v_permlane32_swap_b32 v68, v70
  v_permlane32_swap_b32 v69, v71
  v_add_f32 v56, v68, v70
  v_add_f32 v58, v69, v71
  v_permlane32_swap_b32 v72, v74
  v_permlane32_swap_b32 v73, v75
  v_add_f32 v57, v72, v74
  v_add_f32 v59, v73, v75
  ds_write_b128 v2, v[56:59] offset:1024
  v_cmp_u_f32 vcc, v57, v59
  v_mov_b32 v68, 0
  v_mov_b32 v69, 0
  v_mov_b32 v70, 0
  v_mov_b32 v71, 0
  s_cbranch_vccnz cA_sc1_retry
cA_sc1_cont:
  s_add_u32 s24, s24, 28672
  s_add_u32 s26, s26, 28672
  buffer_load_dwordx4 v[80:83], v117, s[8:11], s24 offen offset:0 sc1
  buffer_load_dwordx4 v[84:87], v117, s[8:11], s24 offen offset:1024 sc1
  v_mov_b32 v72, 0
  v_mov_b32 v73, 0
  v_mfma_f32_32x32x16_bf16 v[36:51], v[68:71], v[68:71], 0
  s_waitcnt lgkmcnt(0)
  s_barrier
  ds_read_b64 v[8:9], v114 offset:0
  ds_read_b64 v[10:11], v114 offset:1024
  ds_read_b64 v[12:13], v114 offset:2048
  ds_read_b64 v[14:15], v114 offset:3072
  ds_read2_b32 v[16:17], v115 offset0:0 offset1:64
  ds_read2_b32 v[18:19], v115 offset0:128 offset1:192
  v_mfma_f32_32x32x16_bf16 v[52:67], v[68:71], v[68:71], 0
  s_waitcnt lgkmcnt(0)
  v_pk_add_f32 v[16:17], v[16:17], v[18:19]
  v_pk_add_f32 v[8:9], v[8:9], v[10:11]
  v_pk_add_f32 v[12:13], v[12:13], v[14:15]
  v_add_f32 v20, v16, v17
  v_pk_add_f32 v[8:9], v[8:9], v[12:13]
  v_max_f32 v22, v8, v9
  v_add_f32_dpp v20, v20, v20 row_ror:8 row_mask:0xf bank_mask:0xf
  s_nop 0
  v_max_f32_dpp v22, v22, v22 row_ror:8 row_mask:0xf bank_mask:0xf
  v_max_f32 v22, v22, v20
  buffer_store_dword v112, v116, s[8:11], 0 offen
  s_nop 0
  v_max_f32_dpp v22, v22, v22 quad_perm:[1,0,3,2] row_mask:0xf bank_mask:0xf
  s_nop 1
  v_max_f32_dpp v22, v22, v22 quad_perm:[2,3,0,1] row_mask:0xf bank_mask:0xf
  s_nop 1
  v_max_f32_dpp v22, v22, v22 row_half_mirror row_mask:0xf bank_mask:0xf
  v_pk_add_f32 v[8:9], v[8:9], v[22:23] op_sel_hi:[1,0] neg_lo:[0,1] neg_hi:[0,1]
  v_sub_f32 v20, v20, v22
  v_exp_f32 v8, v8
  v_exp_f32 v9, v9
  v_exp_f32 v20, v20
  v_add_f32 v24, v8, v9
  v_fmac_f32 v24, 0.5, v20
  v_mov_b32_dpp v21, v20 quad_perm:[1,0,3,2] row_mask:0xf bank_mask:0xf
  s_nop 0
  v_add_f32_dpp v24, v24, v24 quad_perm:[1,0,3,2] row_mask:0xf bank_mask:0xf
  s_nop 1
  v_add_f32_dpp v24, v24, v24 quad_perm:[2,3,0,1] row_mask:0xf bank_mask:0xf
  s_nop 1
  v_add_f32_dpp v24, v24, v24 row_half_mirror row_mask:0xf bank_mask:0xf
  s_nop 1
  v_add_f32_dpp v24, v24, v24 row_ror:8 row_mask:0xf bank_mask:0xf
  v_rcp_f32 v24, v24
  s_nop 0
  v_pk_mul_f32 v[8:9], v[8:9], v[24:25] op_sel_hi:[1,0]
  v_cvt_pk_bf16_f32 v8, abs(v8), abs(v9)
  buffer_store_dword v8, v1, s[8:11], s20 offen
  v_pk_mul_f32 v[20:21], v[20:21], v[24:25] op_sel_hi:[1,0]
  v_cvt_pk_bf16_f32 v20, abs(v20), abs(v21)
  buffer_store_dword v20, v118, s[8:11], s20 offen
  v_mov_b32 v74, 0
  v_mov_b32 v75, 0
  s_mov_b32 s19, s18
  s_add_u32 s18, s18, 1
  s_mov_b32 s22, s20
  s_mov_b32 s20, s21
  s_mov_b32 s21, s22
  s_add_u32 s23, s20, 4096
  v_mov_b32 v112, s18
  s_cmp_lt_u32 s19, 63
  s_nop 0
  s_cbranch_scc1 cA_sc1_loop
  s_branch cA_done
cA_sc1_r0:
  s_add_u32 s31, s31, 1
  buffer_load_dwordx4 v[8:11], v2, s[8:11], s20 offen offset:0 sc1
  s_waitcnt vmcnt(0)
  v_cmp_eq_u32 vcc, -1, v8
  v_mov_b32 v36, 0
  v_mov_b32 v37, 0
  v_mov_b32 v38, 0
  v_mov_b32 v39, 0
  v_mov_b32 v40, 0
  v_mov_b32 v41, 0
  v_mov_b32 v42, 0
  v_mov_b32 v43, 0
  v_mov_b32 v44, 0
  v_mov_b32 v45, 0
  v_mov_b32 v46, 0
  v_mov_b32 v47, 0
  v_mov_b32 v48, 0
  v_mov_b32 v49, 0
  v_mov_b32 v50, 0
  v_mov_b32 v51, 0
  s_nop 1
  s_cbranch_vccz cA_sc1_go
  s_add_u32 s30, s30, 1
  s_cmp_lt_u32 s30, 400000
  s_cbranch_scc1 cA_sc1_r0
  s_branch cA_abort
cA_sc1_r1:
  s_add_u32 s31, s31, 1
  buffer_load_dwordx4 v[12:15], v2, s[8:11], s20 offen offset:1024 sc1
  s_waitcnt vmcnt(0)
  v_cmp_eq_u32 vcc, -1, v12
  s_nop 4
  s_cbranch_vccz cA_sc1_c1
  s_add_u32 s30, s30, 1
  s_cmp_lt_u32 s30, 400000
  s_cbranch_scc1 cA_sc1_r1
  s_branch cA_abort
cA_sc1_r2:
  s_add_u32 s31, s31, 1
  buffer_load_dwordx4 v[16:19], v2, s[8:11], s20 offen offset:2048 sc1
  s_waitcnt vmcnt(0)
  v_cmp_eq_u32 vcc, -1, v16
  s_nop 4
  s_cbranch_vccz cA_sc1_c2
  s_add_u32 s30, s30, 1
  s_cmp_lt_u32 s30, 400000
  s_cbranch_scc1 cA_sc1_r2
  s_branch cA_abort
cA_sc1_r3:
  s_add_u32 s31, s31, 1
  buffer_load_dwordx4 v[20:23], v2, s[8:11], s20 offen offset:3072 sc1
  s_waitcnt vmcnt(0)
  v_cmp_eq_u32 vcc, -1, v20
  s_nop 4
  s_cbranch_vccz cA_sc1_c3
  s_add_u32 s30, s30, 1
  s_cmp_lt_u32 s30, 400000
  s_cbranch_scc1 cA_sc1_r3
  s_branch cA_abort
cA_sc1_r4:
  s_add_u32 s31, s31, 1
  buffer_load_dwordx4 v[28:31], v2, s[8:11], s23 offen offset:0 sc1
  buffer_load_dwordx4 v[24:27], v2, s[8:11], s23 offen offset:1024 sc1
  buffer_load_dwordx4 v[32:35], v2, s[8:11], s23 offen offset:2048 sc1
  s_waitcnt vmcnt(0)
  v_max3_u32 v66, v24, v27, v28
  v_max3_u32 v66, v66, v31, v32
  v_max_u32 v66, v66, v35
  v_cmp_eq_u32 vcc, -1, v66
  s_nop 4
  s_cbranch_vccz cA_sc1_c4
  s_add_u32 s30, s30, 1
  s_cmp_lt_u32 s30, 400000
  s_cbranch_scc1 cA_sc1_r4
  s_branch cA_abort
cA_sc1_retry:
  s_cmp_lg_u32 s62, 0
  s_cbranch_scc1 cA_sc1_cont
  s_waitcnt vmcnt(0) lgkmcnt(0)
cA_sc1_rv:
  buffer_load_dwordx4 v[8:11], v2, s[8:11], s20 offen offset:0 sc1
  buffer_load_dwordx4 v[12:15], v2, s[8:11], s20 offen offset:1024 sc1
  buffer_load_dwordx4 v[16:19], v2, s[8:11], s20 offen offset:2048 sc1
  buffer_load_dwordx4 v[20:23], v2, s[8:11], s20 offen offset:3072 sc1
  buffer_load_dwordx4 v[28:31], v2, s[8:11], s23 offen offset:0 sc1
  buffer_load_dwordx4 v[24:27], v2, s[8:11], s23 offen offset:1024 sc1
  buffer_load_dwordx4 v[32:35], v2, s[8:11], s23 offen offset:2048 sc1
  s_waitcnt vmcnt(0)
  v_max3_u32 v66, v8, v9, v10
  v_max3_u32 v66, v66, v11, v12
  v_max3_u32 v66, v66, v13, v14
  v_max3_u32 v66, v66, v15, v16
  v_max3_u32 v66, v66, v17, v18
  v_max3_u32 v66, v66, v19, v20
  v_max3_u32 v66, v66, v21, v22
  v_max3_u32 v66, v66, v23, v24
  v_max3_u32 v66, v66, v25, v26
  v_max3_u32 v66, v66, v27, v28
  v_max3_u32 v66, v66, v29, v30
  v_max3_u32 v66, v66, v31, v32
  v_max3_u32 v66, v66, v33, v34
  v_max_u32 v66, v66, v35
  v_cmp_eq_u32 vcc, -1, v66
  s_cbranch_vccz cA_sc1_rk
  s_add_u32 s30, s30, 1
  s_cmp_lt_u32 s30, 400000
  s_cbranch_scc1 cA_sc1_rv
  s_branch cA_abort
cA_sc1_rk:
  s_mov_b32 s62, 1
  v_mov_b32 v36, 0
  v_mov_b32 v37, 0
  v_mov_b32 v38, 0
  v_mov_b32 v39, 0
  v_mov_b32 v40, 0
  v_mov_b32 v41, 0
  v_mov_b32 v42, 0
  v_mov_b32 v43, 0
  v_mov_b32 v44, 0
  v_mov_b32 v45, 0
  v_mov_b32 v46, 0
  v_mov_b32 v47, 0
  v_mov_b32 v48, 0
  v_mov_b32 v49, 0
  v_mov_b32 v50, 0
  v_mov_b32 v51, 0
  v_mov_b32 v60, 0
  v_mov_b32 v61, 0
  v_mov_b32 v62, 0
  v_mov_b32 v63, 0
  v_mov_b32 v68, 0
  v_mov_b32 v69, 0
  v_mov_b32 v70, 0
  v_mov_b32 v71, 0
  v_mov_b32 v72, 0
  v_mov_b32 v73, 0
  v_mov_b32 v74, 0
  v_mov_b32 v75, 0
  v_mov_b32 v52, 0
  v_mov_b32 v53, 0
  v_mov_b32 v54, 0
  v_mov_b32 v55, 0
  v_mov_b32 v56, 0
  v_mov_b32 v57, 0
  v_mov_b32 v58, 0
  v_mov_b32 v59, 0
  s_add_u32 s31, s31, 0x100
  s_nop 0
  s_branch cA_sc1_go
.p2align 6
cA_sc2_loop:
  s_mov_b32 s30, 0
  s_mov_b32 s62, 0
  s_setprio 3
  s_barrier
  buffer_load_dwordx4 v[8:11], v2, s[8:11], s20 offen offset:0 sc1
  s_setprio 2
  buffer_load_dwordx4 v[12:15], v2, s[8:11], s20 offen offset:1024 sc1
  s_setprio 1
  buffer_load_dwordx4 v[16:19], v2, s[8:11], s20 offen offset:2048 sc1
  s_setprio 0
  buffer_load_dwordx4 v[20:23], v2, s[8:11], s20 offen offset:3072 sc1
cA_sc2_go:
  s_waitcnt vmcnt(3)
  v_smfmac_f32_16x16x64_bf16 v[36:39], v[8:11], a[0:7], v3
  buffer_load_dwordx4 v[24:27], v2, s[8:11], s23 offen offset:0 sc1
  v_cmp_eq_u32 vcc, -1, v8
  v_smfmac_f32_16x16x64_bf16 v[40:43], v[8:11], a[56:63], v3
  v_smfmac_f32_16x16x64_bf16 v[44:47], v[8:11], a[112:119], v3
  buffer_load_dwordx4 v[32:35], v2, s[8:11], s23 offen offset:1024 sc1
  s_cbranch_vccnz cA_sc2_r0
  v_smfmac_f32_16x16x64_bf16 v[48:51], v[8:11], a[168:175], v3
  v_smfmac_f32_16x16x64_bf16 v[52:55], v[8:11], a[224:231], v3
  s_waitcnt vmcnt(4)
  v_cmp_eq_u32 vcc, -1, v12
  v_smfmac_f32_16x16x64_bf16 v[56:59], v[8:11], v[144:151], v3
  buffer_load_dwordx4 v[28:31], v2, s[8:11], s23 offen offset:2048 sc1
  v_smfmac_f32_16x16x64_bf16 v[62:65], v[8:11], v[200:207], v3
  s_cbranch_vccnz cA_sc2_r1
cA_sc2_c1:
  v_smfmac_f32_16x16x64_bf16 v[36:39], v[12:15], a[8:15], v3
  v_smfmac_f32_16x16x64_bf16 v[40:43], v[12:15], a[64:71], v3
  v_smfmac_f32_16x16x64_bf16 v[44:47], v[12:15], a[120:127], v3
  v_smfmac_f32_16x16x64_bf16 v[48:51], v[12:15], a[176:183], v3
  v_smfmac_f32_16x16x64_bf16 v[52:55], v[12:15], a[232:239], v3
  s_waitcnt vmcnt(4)
  v_cmp_eq_u32 vcc, -1, v16
  v_smfmac_f32_16x16x64_bf16 v[56:59], v[12:15], v[152:159], v3
  buffer_load_dwordx4 v[88:91], v117, s[8:11], s26 offen offset:0 sc1
  v_smfmac_f32_16x16x64_bf16 v[62:65], v[12:15], v[208:215], v3
  s_cbranch_vccnz cA_sc2_r2
cA_sc2_c2:
  v_smfmac_f32_16x16x64_bf16 v[36:39], v[16:19], a[16:23], v3
  v_smfmac_f32_16x16x64_bf16 v[40:43], v[16:19], a[72:79], v3
  v_smfmac_f32_16x16x64_bf16 v[44:47], v[16:19], a[128:135], v3
  buffer_load_dwordx4 v[92:95], v117, s[8:11], s26 offen offset:1024 sc1
  v_smfmac_f32_16x16x64_bf16 v[48:51], v[16:19], a[184:191], v3
  v_smfmac_f32_16x16x64_bf16 v[52:55], v[16:19], a[240:247], v3
  s_waitcnt vmcnt(5)
  v_cmp_eq_u32 vcc, -1, v20
  v_smfmac_f32_16x16x64_bf16 v[56:59], v[16:19], v[160:167], v3
  v_smfmac_f32_16x16x64_bf16 v[62:65], v[16:19], v[216:223], v3
  buffer_load_dwordx4 v[96:99], v2, s[8:11], s24 offen offset:0 sc1
  s_cbranch_vccnz cA_sc2_r3
cA_sc2_c3:
  v_smfmac_f32_16x16x64_bf16 v[36:39], v[20:23], a[24:31], v3
  v_smfmac_f32_16x16x64_bf16 v[40:43], v[20:23], a[80:87], v3
  s_waitcnt vmcnt(3)
  v_max3_u32 v66, v24, v27, v28
  v_smfmac_f32_16x16x64_bf16 v[44:47], v[20:23], a[136:143], v3
  v_max3_u32 v66, v66, v31, v32
  v_smfmac_f32_16x16x64_bf16 v[48:51], v[20:23], a[192:199], v3
  buffer_load_dwordx4 v[100:103], v2, s[8:11], s24 offen offset:1024 sc1
  v_max_u32 v66, v66, v35
  v_smfmac_f32_16x16x64_bf16 v[52:55], v[20:23], a[248:255], v3
  v_cmp_eq_u32 vcc, -1, v66
  v_smfmac_f32_16x16x64_bf16 v[56:59], v[20:23], v[168:175], v3
  v_smfmac_f32_16x16x64_bf16 v[62:65], v[20:23], v[224:231], v3
  s_cbranch_vccnz cA_sc2_r4
cA_sc2_c4:
  v_smfmac_f32_16x16x64_bf16 v[62:65], v[24:27], v[232:239], v3
  buffer_load_dwordx4 v[104:107], v2, s[8:11], s26 offen offset:0 sc1
  v_smfmac_f32_16x16x64_bf16 v[62:65], v[32:35], v[240:247], v3
  v_smfmac_f32_16x16x64_bf16 v[62:65], v[28:31], v[248:255], v3
  v_smfmac_f32_16x16x64_bf16 v[52:55], v[24:27], v[120:127], v3
  v_smfmac_f32_16x16x64_bf16 v[52:55], v[32:35], v[128:135], v3
  buffer_load_dwordx4 v[108:111], v2, s[8:11], s26 offen offset:1024 sc1
  v_smfmac_f32_16x16x64_bf16 v[52:55], v[28:31], v[136:143], v3
  v_cvt_pk_bf16_f32 v62, v62, v63
  v_smfmac_f32_16x16x64_bf16 v[56:59], v[24:27], v[176:183], v3
  v_cvt_pk_bf16_f32 v63, v64, v65
  v_smfmac_f32_16x16x64_bf16 v[56:59], v[32:35], v[184:191], v3
  v_mfma_f32_16x16x32_bf16 v[8:11], v[60:63], v[4:7], 0
  v_cvt_pk_bf16_f32 v55, v54, v55
  v_smfmac_f32_16x16x64_bf16 v[56:59], v[28:31], v[192:199], v3
  v_cvt_pk_bf16_f32 v54, v52, v53
  v_smfmac_f32_16x16x64_bf16 v[36:39], v[24:27], a[32:39], v3
  s_nop 1
  v_cvt_pk_bf16_f32 v76, v8, v9
  v_smfmac_f32_16x16x64_bf16 v[36:39], v[32:35], a[40:47], v3
  v_cvt_pk_bf16_f32 v77, v10, v11
  v_smfmac_f32_16x16x64_bf16 v[36:39], v[28:31], a[48:55], v3
  v_cvt_pk_bf16_f32 v56, v56, v57
  v_smfmac_f32_16x16x64_bf16 v[40:43], v[24:27], a[88:95], v3
  v_cvt_pk_bf16_f32 v57, v58, v59
  v_smfmac_f32_16x16x64_bf16 v[40:43], v[32:35], a[96:103], v3
  v_mfma_f32_16x16x32_bf16 v[12:15], v[54:57], v[4:7], 0
  v_cvt_pk_bf16_f32 v39, v38, v39
  v_smfmac_f32_16x16x64_bf16 v[40:43], v[28:31], a[104:111], v3
  v_cvt_pk_bf16_f32 v38, v36, v37
  v_smfmac_f32_16x16x64_bf16 v[44:47], v[24:27], a[144:151], v3
  s_nop 1
  v_cvt_pk_bf16_f32 v78, v12, v13
  v_smfmac_f32_16x16x64_bf16 v[44:47], v[32:35], a[152:159], v3
  v_cvt_pk_bf16_f32 v79, v14, v15
  v_smfmac_f32_16x16x64_bf16 v[44:47], v[28:31], a[160:167], v3
  v_cvt_pk_bf16_f32 v40, v40, v41
  v_smfmac_f32_16x16x64_bf16 v[48:51], v[24:27], a[200:207], v3
  v_cvt_pk_bf16_f32 v41, v42, v43
  v_smfmac_f32_16x16x64_bf16 v[48:51], v[32:35], a[208:215], v3
  v_smfmac_f32_16x16x64_bf16 v[48:51], v[28:31], a[216:223], v3
  s_waitcnt vmcnt(4)
  v_cvt_pk_bf16_f32 v47, v46, v47
  v_smfmac_f32_16x16x64_bf16 v[68:71], v[76:79], v[80:87], v3
  v_cvt_pk_bf16_f32 v46, v44, v45
  v_mfma_f32_16x16x32_bf16 v[8:11], v[38:41], v[4:7], 0
  s_nop 1
  v_cvt_pk_bf16_f32 v48, v48, v49
  v_cvt_pk_bf16_f32 v49, v50, v51
  s_nop 1
  v_mfma_f32_16x16x32_bf16 v[12:15], v[46:49], v[4:7], 0
  v_smfmac_f32_16x16x64_bf16 v[72:75], v[76:79], v[88:95], v3
  v_cvt_pk_bf16_f32 v20, v8, v9
  v_mfma_f32_16x16x32_bf16 v[52:55], v[30:33], v[76:79], 0
  s_waitcnt vmcnt(0)
  v_cvt_pk_bf16_f32 v21, v10, v11
  v_cvt_pk_bf16_f32 v22, v12, v13
  v_cvt_pk_bf16_f32 v23, v14, v15
  s_nop 1
  v_mfma_f32_16x16x32_bf16 v[52:55], v[16:19], v[20:23], v[52:55]
  v_smfmac_f32_16x16x64_bf16 v[68:71], v[20:23], v[96:103], v3
  v_smfmac_f32_16x16x64_bf16 v[72:75], v[20:23], v[104:111], v3
  s_nop 1
  ds_write_b128 v113, v[52:55]
  s_nop 1
  v_permlane32_swap_b32 v68, v70
  v_permlane32_swap_b32 v69, v71
  v_add_f32 v56, v68, v70
  v_add_f32 v58, v69, v71
  v_permlane32_swap_b32 v72, v74
  v_permlane32_swap_b32 v73, v75
  v_add_f32 v57, v72, v74
  v_add_f32 v59, v73, v75
  ds_write_b128 v2, v[56:59] offset:2048
  v_cmp_u_f32 vcc, v57, v59
  v_mov_b32 v68, 0
  v_mov_b32 v69, 0
  v_mov_b32 v70, 0
  v_mov_b32 v71, 0
  s_cbranch_vccnz cA_sc2_retry
cA_sc2_cont:
  s_add_u32 s24, s24, 28672
  s_add_u32 s26, s26, 28672
  buffer_load_dwordx4 v[80:83], v117, s[8:11], s24 offen offset:0 sc1
  buffer_load_dwordx4 v[84:87], v117, s[8:11], s24 offen offset:1024 sc1
  v_mov_b32 v72, 0
  v_mov_b32 v73, 0
  v_mfma_f32_32x32x16_bf16 v[36:51], v[68:71], v[68:71], 0
  s_waitcnt lgkmcnt(0)
  s_barrier
  v_mfma_f32_32x32x16_bf16 v[52:67], v[68:71], v[68:71], 0
  buffer_store_dwordx2 v[118:119], v114, s[8:11], s21 offen
  buffer_store_dwordx2 v[118:119], v115, s[8:11], s21 offen
  s_buffer_load_dword s70, s[8:11], s35
  s_add_u32 s22, s24, 114688
  s_buffer_load_dword s71, s[8:11], s22
  s_mul_i32 s22, s18, 7168
  s_add_u32 s22, s22, 87040
  s_buffer_load_dword s72, s[8:11], s22
  s_add_u32 s35, s35, 458752
  v_mov_b32 v74, 0
  v_mov_b32 v75, 0
  s_mov_b32 s19, s18
  s_add_u32 s18, s18, 1
  s_mov_b32 s22, s20
  s_mov_b32 s20, s21
  s_mov_b32 s21, s22
  s_add_u32 s23, s20, 4096
  s_cmp_lt_u32 s19, 63
  s_cbranch_scc1 cA_sc2_loop
  s_branch cA_done
cA_sc2_r0:
  s_add_u32 s31, s31, 1
  buffer_load_dwordx4 v[8:11], v2, s[8:11], s20 offen offset:0 sc1
  s_waitcnt vmcnt(0)
  v_cmp_eq_u32 vcc, -1, v8
  v_mov_b32 v36, 0
  v_mov_b32 v37, 0
  v_mov_b32 v38, 0
  v_mov_b32 v39, 0
  v_mov_b32 v40, 0
  v_mov_b32 v41, 0
  v_mov_b32 v42, 0
  v_mov_b32 v43, 0
  v_mov_b32 v44, 0
  v_mov_b32 v45, 0
  v_mov_b32 v46, 0
  v_mov_b32 v47, 0
  v_mov_b32 v48, 0
  v_mov_b32 v49, 0
  v_mov_b32 v50, 0
  v_mov_b32 v51, 0
  s_nop 1
  s_cbranch_vccz cA_sc2_go
  s_add_u32 s30, s30, 1
  s_cmp_lt_u32 s30, 400000
  s_cbranch_scc1 cA_sc2_r0
  s_branch cA_abort
cA_sc2_r1:
  s_add_u32 s31, s31, 1
  buffer_load_dwordx4 v[12:15], v2, s[8:11], s20 offen offset:1024 sc1
  s_waitcnt vmcnt(0)
  v_cmp_eq_u32 vcc, -1, v12
  s_nop 4
  s_cbranch_vccz cA_sc2_c1
  s_add_u32 s30, s30, 1
  s_cmp_lt_u32 s30, 400000
  s_cbranch_scc1 cA_sc2_r1
  s_branch cA_abort
cA_sc2_r2:
  s_add_u32 s31, s31, 1
  buffer_load_dwordx4 v[16:19], v2, s[8:11], s20 offen offset:2048 sc1
  s_waitcnt vmcnt(0)
  v_cmp_eq_u32 vcc, -1, v16
  s_nop 4
  s_cbranch_vccz cA_sc2_c2
  s_add_u32 s30, s30, 1
  s_cmp_lt_u32 s30, 400000
  s_cbranch_scc1 cA_sc2_r2
  s_branch cA_abort
cA_sc2_r3:
  s_add_u32 s31, s31, 1
  buffer_load_dwordx4 v[20:23], v2, s[8:11], s20 offen offset:3072 sc1
  s_waitcnt vmcnt(0)
  v_cmp_eq_u32 vcc, -1, v20
  s_nop 4
  s_cbranch_vccz cA_sc2_c3
  s_add_u32 s30, s30, 1
  s_cmp_lt_u32 s30, 400000
  s_cbranch_scc1 cA_sc2_r3
  s_branch cA_abort
cA_sc2_r4:
  s_add_u32 s31, s31, 1
  buffer_load_dwordx4 v[24:27], v2, s[8:11], s23 offen offset:0 sc1
  buffer_load_dwordx4 v[32:35], v2, s[8:11], s23 offen offset:1024 sc1
  buffer_load_dwordx4 v[28:31], v2, s[8:11], s23 offen offset:2048 sc1
  s_waitcnt vmcnt(0)
  v_max3_u32 v66, v24, v27, v28
  v_max3_u32 v66, v66, v31, v32
  v_max_u32 v66, v66, v35
  v_cmp_eq_u32 vcc, -1, v66
  s_nop 4
  s_cbranch_vccz cA_sc2_c4
  s_add_u32 s30, s30, 1
  s_cmp_lt_u32 s30, 400000
  s_cbranch_scc1 cA_sc2_r4
  s_branch cA_abort
cA_sc2_retry:
  s_cmp_lg_u32 s62, 0
  s_cbranch_scc1 cA_sc2_cont
  s_waitcnt vmcnt(0) lgkmcnt(0)
cA_sc2_rv:
  buffer_load_dwordx4 v[8:11], v2, s[8:11], s20 offen offset:0 sc1
  buffer_load_dwordx4 v[12:15], v2, s[8:11], s20 offen offset:1024 sc1
  buffer_load_dwordx4 v[16:19], v2, s[8:11], s20 offen offset:2048 sc1
  buffer_load_dwordx4 v[20:23], v2, s[8:11], s20 offen offset:3072 sc1
  buffer_load_dwordx4 v[24:27], v2, s[8:11], s23 offen offset:0 sc1
  buffer_load_dwordx4 v[32:35], v2, s[8:11], s23 offen offset:1024 sc1
  buffer_load_dwordx4 v[28:31], v2, s[8:11], s23 offen offset:2048 sc1
  s_waitcnt vmcnt(0)
  v_max3_u32 v66, v8, v9, v10
  v_max3_u32 v66, v66, v11, v12
  v_max3_u32 v66, v66, v13, v14
  v_max3_u32 v66, v66, v15, v16
  v_max3_u32 v66, v66, v17, v18
  v_max3_u32 v66, v66, v19, v20
  v_max3_u32 v66, v66, v21, v22
  v_max3_u32 v66, v66, v23, v24
  v_max3_u32 v66, v66, v25, v26
  v_max3_u32 v66, v66, v27, v28
  v_max3_u32 v66, v66, v29, v30
  v_max3_u32 v66, v66, v31, v32
  v_max3_u32 v66, v66, v33, v34
  v_max_u32 v66, v66, v35
  v_cmp_eq_u32 vcc, -1, v66
  s_cbranch_vccz cA_sc2_rk
  s_add_u32 s30, s30, 1
  s_cmp_lt_u32 s30, 400000
  s_cbranch_scc1 cA_sc2_rv
  s_branch cA_abort
cA_sc2_rk:
  s_mov_b32 s62, 1
  v_mov_b32 v36, 0
  v_mov_b32 v37, 0
  v_mov_b32 v38, 0
  v_mov_b32 v39, 0
  v_mov_b32 v40, 0
  v_mov_b32 v41, 0
  v_mov_b32 v42, 0
  v_mov_b32 v43, 0
  v_mov_b32 v44, 0
  v_mov_b32 v45, 0
  v_mov_b32 v46, 0
  v_mov_b32 v47, 0
  v_mov_b32 v48, 0
  v_mov_b32 v49, 0
  v_mov_b32 v50, 0
  v_mov_b32 v51, 0
  v_mov_b32 v62, 0
  v_mov_b32 v63, 0
  v_mov_b32 v64, 0
  v_mov_b32 v65, 0
  v_mov_b32 v68, 0
  v_mov_b32 v69, 0
  v_mov_b32 v70, 0
  v_mov_b32 v71, 0
  v_mov_b32 v72, 0
  v_mov_b32 v73, 0
  v_mov_b32 v74, 0
  v_mov_b32 v75, 0
  v_mov_b32 v52, 0
  v_mov_b32 v53, 0
  v_mov_b32 v54, 0
  v_mov_b32 v55, 0
  v_mov_b32 v56, 0
  v_mov_b32 v57, 0
  v_mov_b32 v58, 0
  v_mov_b32 v59, 0
  s_add_u32 s31, s31, 0x100
  s_nop 0
  s_branch cA_sc2_go
.p2align 6
cA_sc3_loop:
  s_mov_b32 s30, 0
  s_mov_b32 s62, 0
  s_setprio 3
  s_barrier
  buffer_load_dwordx4 v[8:11], v2, s[8:11], s20 offen offset:0 sc1
  s_setprio 2
  buffer_load_dwordx4 v[12:15], v2, s[8:11], s20 offen offset:1024 sc1
  s_setprio 1
  buffer_load_dwordx4 v[16:19], v2, s[8:11], s20 offen offset:2048 sc1
  s_setprio 0
  buffer_load_dwordx4 v[20:23], v2, s[8:11], s20 offen offset:3072 sc1
cA_sc3_go:
  s_waitcnt vmcnt(3)
  v_smfmac_f32_16x16x64_bf16 v[36:39], v[8:11], a[0:7], v3
  buffer_load_dwordx4 v[24:27], v2, s[8:11], s23 offen offset:0 sc1
  v_cmp_eq_u32 vcc, -1, v8
  v_smfmac_f32_16x16x64_bf16 v[40:43], v[8:11], a[56:63], v3
  v_smfmac_f32_16x16x64_bf16 v[44:47], v[8:11], a[112:119], v3
  buffer_load_dwordx4 v[28:31], v2, s[8:11], s23 offen offset:1024 sc1
  s_cbranch_vccnz cA_sc3_r0
  v_smfmac_f32_16x16x64_bf16 v[48:51], v[8:11], a[168:175], v3
  v_smfmac_f32_16x16x64_bf16 v[52:55], v[8:11], a[224:231], v3
  s_waitcnt vmcnt(4)
  v_cmp_eq_u32 vcc, -1, v12
  v_smfmac_f32_16x16x64_bf16 v[56:59], v[8:11], v[144:151], v3
  buffer_load_dwordx4 v[32:35], v2, s[8:11], s23 offen offset:2048 sc1
  v_smfmac_f32_16x16x64_bf16 v[62:65], v[8:11], v[200:207], v3
  s_cbranch_vccnz cA_sc3_r1
cA_sc3_c1:
  v_smfmac_f32_16x16x64_bf16 v[36:39], v[12:15], a[8:15], v3
  v_smfmac_f32_16x16x64_bf16 v[40:43], v[12:15], a[64:71], v3
  v_smfmac_f32_16x16x64_bf16 v[44:47], v[12:15], a[120:127], v3
  v_smfmac_f32_16x16x64_bf16 v[48:51], v[12:15], a[176:183], v3
  v_smfmac_f32_16x16x64_bf16 v[52:55], v[12:15], a[232:239], v3
  s_waitcnt vmcnt(4)
  v_cmp_eq_u32 vcc, -1, v16
  v_smfmac_f32_16x16x64_bf16 v[56:59], v[12:15], v[152:159], v3
  buffer_load_dwordx4 v[88:91], v117, s[8:11], s26 offen offset:0 sc1
  v_smfmac_f32_16x16x64_bf16 v[62:65], v[12:15], v[208:215], v3
  s_cbranch_vccnz cA_sc3_r2
cA_sc3_c2:
  v_smfmac_f32_16x16x64_bf16 v[36:39], v[16:19], a[16:23], v3
  v_smfmac_f32_16x16x64_bf16 v[40:43], v[16:19], a[72:79], v3
  v_smfmac_f32_16x16x64_bf16 v[44:47], v[16:19], a[128:135], v3
  buffer_load_dwordx4 v[92:95], v117, s[8:11], s26 offen offset:1024 sc1
  v_smfmac_f32_16x16x64_bf16 v[48:51], v[16:19], a[184:191], v3
  v_smfmac_f32_16x16x64_bf16 v[52:55], v[16:19], a[240:247], v3
  s_waitcnt vmcnt(5)
  v_cmp_eq_u32 vcc, -1, v20
  v_smfmac_f32_16x16x64_bf16 v[56:59], v[16:19], v[160:167], v3
  v_smfmac_f32_16x16x64_bf16 v[62:65], v[16:19], v[216:223], v3
  buffer_load_dwordx4 v[96:99], v2, s[8:11], s24 offen offset:0 sc1
  s_cbranch_vccnz cA_sc3_r3
cA_sc3_c3:
  v_smfmac_f32_16x16x64_bf16 v[36:39], v[20:23], a[24:31], v3
  v_smfmac_f32_16x16x64_bf16 v[40:43], v[20:23], a[80:87], v3
  s_waitcnt vmcnt(3)
  v_max3_u32 v66, v24, v27, v28
  v_smfmac_f32_16x16x64_bf16 v[44:47], v[20:23], a[136:143], v3
  v_max3_u32 v66, v66, v31, v32
  v_smfmac_f32_16x16x64_bf16 v[48:51], v[20:23], a[192:199], v3
  buffer_load_dwordx4 v[100:103], v2, s[8:11], s24 offen offset:1024 sc1
  v_max_u32 v66, v66, v35
  v_smfmac_f32_16x16x64_bf16 v[52:55], v[20:23], a[248:255], v3
  v_cmp_eq_u32 vcc, -1, v66
  v_smfmac_f32_16x16x64_bf16 v[56:59], v[20:23], v[168:175], v3
  v_smfmac_f32_16x16x64_bf16 v[62:65], v[20:23], v[224:231], v3
  s_cbranch_vccnz cA_sc3_r4
cA_sc3_c4:
  v_smfmac_f32_16x16x64_bf16 v[62:65], v[24:27], v[232:239], v3
  buffer_load_dwordx4 v[104:107], v2, s[8:11], s26 offen offset:0 sc1
  v_smfmac_f32_16x16x64_bf16 v[62:65], v[28:31], v[240:247], v3
  v_smfmac_f32_16x16x64_bf16 v[62:65], v[32:35], v[248:255], v3
  v_smfmac_f32_16x16x64_bf16 v[52:55], v[24:27], v[120:127], v3
  v_smfmac_f32_16x16x64_bf16 v[52:55], v[28:31], v[128:135], v3
  buffer_load_dwordx4 v[108:111], v2, s[8:11], s26 offen offset:1024 sc1
  v_smfmac_f32_16x16x64_bf16 v[52:55], v[32:35], v[136:143], v3
  v_cvt_pk_bf16_f32 v62, v62, v63
  v_smfmac_f32_16x16x64_bf16 v[56:59], v[24:27], v[176:183], v3
  v_cvt_pk_bf16_f32 v63, v64, v65
  v_smfmac_f32_16x16x64_bf16 v[56:59], v[28:31], v[184:191], v3
  v_mfma_f32_16x16x32_bf16 v[8:11], v[60:63], v[4:7], 0
  v_cvt_pk_bf16_f32 v55, v54, v55
  v_smfmac_f32_16x16x64_bf16 v[56:59], v[32:35], v[192:199], v3
  v_cvt_pk_bf16_f32 v54, v52, v53
  v_smfmac_f32_16x16x64_bf16 v[36:39], v[24:27], a[32:39], v3
  s_nop 1
  v_cvt_pk_bf16_f32 v78, v8, v9
  v_smfmac_f32_16x16x64_bf16 v[36:39], v[28:31], a[40:47], v3
  v_cvt_pk_bf16_f32 v79, v10, v11
  v_smfmac_f32_16x16x64_bf16 v[36:39], v[32:35], a[48:55], v3
  v_cvt_pk_bf16_f32 v56, v56, v57
  v_smfmac_f32_16x16x64_bf16 v[40:43], v[24:27], a[88:95], v3
  v_cvt_pk_bf16_f32 v57, v58, v59
  v_smfmac_f32_16x16x64_bf16 v[40:43], v[28:31], a[96:103], v3
  v_mfma_f32_16x16x32_bf16 v[12:15], v[54:57], v[4:7], 0
  v_cvt_pk_bf16_f32 v39, v38, v39
  v_smfmac_f32_16x16x64_bf16 v[40:43], v[32:35], a[104:111], v3
  v_cvt_pk_bf16_f32 v38, v36, v37
  v_smfmac_f32_16x16x64_bf16 v[44:47], v[24:27], a[144:151], v3
  s_nop 1
  v_cvt_pk_bf16_f32 v76, v12, v13
  v_smfmac_f32_16x16x64_bf16 v[44:47], v[28:31], a[152:159], v3
  v_cvt_pk_bf16_f32 v77, v14, v15
  v_smfmac_f32_16x16x64_bf16 v[44:47], v[32:35], a[160:167], v3
  v_cvt_pk_bf16_f32 v40, v40, v41
  v_smfmac_f32_16x16x64_bf16 v[48:51], v[24:27], a[200:207], v3
  v_cvt_pk_bf16_f32 v41, v42, v43
  v_smfmac_f32_16x16x64_bf16 v[48:51], v[28:31], a[208:215], v3
  v_smfmac_f32_16x16x64_bf16 v[48:51], v[32:35], a[216:223], v3
  s_waitcnt vmcnt(4)
  v_cvt_pk_bf16_f32 v47, v46, v47
  v_smfmac_f32_16x16x64_bf16 v[68:71], v[76:79], v[80:87], v3
  v_cvt_pk_bf16_f32 v46, v44, v45
  v_mfma_f32_16x16x32_bf16 v[8:11], v[38:41], v[4:7], 0
  s_nop 1
  v_cvt_pk_bf16_f32 v48, v48, v49
  v_cvt_pk_bf16_f32 v49, v50, v51
  s_nop 1
  v_mfma_f32_16x16x32_bf16 v[12:15], v[46:49], v[4:7], 0
  v_smfmac_f32_16x16x64_bf16 v[72:75], v[76:79], v[88:95], v3
  v_cvt_pk_bf16_f32 v16, v8, v9
  v_mfma_f32_16x16x32_bf16 v[52:55], v[30:33], v[76:79], 0
  s_waitcnt vmcnt(0)
  v_cvt_pk_bf16_f32 v17, v10, v11
  v_cvt_pk_bf16_f32 v18, v12, v13
  v_cvt_pk_bf16_f32 v19, v14, v15
  s_nop 1
  v_mfma_f32_16x16x32_bf16 v[52:55], v[20:23], v[16:19], v[52:55]
  v_smfmac_f32_16x16x64_bf16 v[68:71], v[16:19], v[96:103], v3
  v_smfmac_f32_16x16x64_bf16 v[72:75], v[16:19], v[104:111], v3
  s_nop 1
  ds_write_b128 v113, v[52:55]
  s_nop 1
  v_permlane32_swap_b32 v68, v70
  v_permlane32_swap_b32 v69, v71
  v_add_f32 v56, v68, v70
  v_add_f32 v58, v69, v71
  v_permlane32_swap_b32 v72, v74
  v_permlane32_swap_b32 v73, v75
  v_add_f32 v57, v72, v74
  v_add_f32 v59, v73, v75
  ds_write_b128 v2, v[56:59] offset:3072
  v_cmp_u_f32 vcc, v57, v59
  v_mov_b32 v68, 0
  v_mov_b32 v69, 0
  v_mov_b32 v70, 0
  v_mov_b32 v71, 0
  s_cbranch_vccnz cA_sc3_retry
cA_sc3_cont:
  s_add_u32 s24, s24, 28672
  s_add_u32 s26, s26, 28672
  buffer_load_dwordx4 v[80:83], v117, s[8:11], s24 offen offset:0 sc1
  buffer_load_dwordx4 v[84:87], v117, s[8:11], s24 offen offset:1024 sc1
  v_mov_b32 v72, 0
  v_mov_b32 v73, 0
  v_mfma_f32_16x16x32_bf16 v[62:65], v[68:71], v[68:71], 0
  s_waitcnt lgkmcnt(0)
  s_barrier
  v_mov_b32 v52, 0
  v_mov_b32 v53, 0
  v_mov_b32 v54, 0
  v_mov_b32 v55, 0
  v_mov_b32 v56, 0
  v_mov_b32 v57, 0
  v_mov_b32 v58, 0
  v_mov_b32 v59, 0
  v_mfma_f32_32x32x16_bf16 v[36:51], v[68:71], v[68:71], 0
  v_mov_b32 v74, 0
  v_mov_b32 v75, 0
  s_mov_b32 s19, s18
  s_add_u32 s18, s18, 1
  s_mov_b32 s22, s20
  s_mov_b32 s20, s21
  s_mov_b32 s21, s22
  s_add_u32 s23, s20, 4096
  s_cmp_lt_u32 s19, 63
  s_nop 2
  s_cbranch_scc1 cA_sc3_loop
  s_branch cA_done
cA_sc3_r0:
  s_add_u32 s31, s31, 1
  buffer_load_dwordx4 v[8:11], v2, s[8:11], s20 offen offset:0 sc1
  s_waitcnt vmcnt(0)
  v_cmp_eq_u32 vcc, -1, v8
  v_mov_b32 v36, 0
  v_mov_b32 v37, 0
  v_mov_b32 v38, 0
  v_mov_b32 v39, 0
  v_mov_b32 v40, 0
  v_mov_b32 v41, 0
  v_mov_b32 v42, 0
  v_mov_b32 v43, 0
  v_mov_b32 v44, 0
  v_mov_b32 v45, 0
  v_mov_b32 v46, 0
  v_mov_b32 v47, 0
  v_mov_b32 v48, 0
  v_mov_b32 v49, 0
  v_mov_b32 v50, 0
  v_mov_b32 v51, 0
  s_nop 1
  s_cbranch_vccz cA_sc3_go
  s_add_u32 s30, s30, 1
  s_cmp_lt_u32 s30, 400000
  s_cbranch_scc1 cA_sc3_r0
  s_branch cA_abort
cA_sc3_r1:
  s_add_u32 s31, s31, 1
  buffer_load_dwordx4 v[12:15], v2, s[8:11], s20 offen offset:1024 sc1
  s_waitcnt vmcnt(0)
  v_cmp_eq_u32 vcc, -1, v12
  s_nop 4
  s_cbranch_vccz cA_sc3_c1
  s_add_u32 s30, s30, 1
  s_cmp_lt_u32 s30, 400000
  s_cbranch_scc1 cA_sc3_r1
  s_branch cA_abort
cA_sc3_r2:
  s_add_u32 s31, s31, 1
  buffer_load_dwordx4 v[16:19], v2, s[8:11], s20 offen offset:2048 sc1
  s_waitcnt vmcnt(0)
  v_cmp_eq_u32 vcc, -1, v16
  s_nop 4
  s_cbranch_vccz cA_sc3_c2
  s_add_u32 s30, s30, 1
  s_cmp_lt_u32 s30, 400000
  s_cbranch_scc1 cA_sc3_r2
  s_branch cA_abort
cA_sc3_r3:
  s_add_u32 s31, s31, 1
  buffer_load_dwordx4 v[20:23], v2, s[8:11], s20 offen offset:3072 sc1
  s_waitcnt vmcnt(0)
  v_cmp_eq_u32 vcc, -1, v20
  s_nop 4
  s_cbranch_vccz cA_sc3_c3
  s_add_u32 s30, s30, 1
  s_cmp_lt_u32 s30, 400000
  s_cbranch_scc1 cA_sc3_r3
  s_branch cA_abort
cA_sc3_r4:
  s_add_u32 s31, s31, 1
  buffer_load_dwordx4 v[24:27], v2, s[8:11], s23 offen offset:0 sc1
  buffer_load_dwordx4 v[28:31], v2, s[8:11], s23 offen offset:1024 sc1
  buffer_load_dwordx4 v[32:35], v2, s[8:11], s23 offen offset:2048 sc1
  s_waitcnt vmcnt(0)
  v_max3_u32 v66, v24, v27, v28
  v_max3_u32 v66, v66, v31, v32
  v_max_u32 v66, v66, v35
  v_cmp_eq_u32 vcc, -1, v66
  s_nop 4
  s_cbranch_vccz cA_sc3_c4
  s_add_u32 s30, s30, 1
  s_cmp_lt_u32 s30, 400000
  s_cbranch_scc1 cA_sc3_r4
  s_branch cA_abort
cA_sc3_retry:
  s_cmp_lg_u32 s62, 0
  s_cbranch_scc1 cA_sc3_cont
  s_waitcnt vmcnt(0) lgkmcnt(0)
cA_sc3_rv:
  buffer_load_dwordx4 v[8:11], v2, s[8:11], s20 offen offset:0 sc1
  buffer_load_dwordx4 v[12:15], v2, s[8:11], s20 offen offset:1024 sc1
  buffer_load_dwordx4 v[16:19], v2, s[8:11], s20 offen offset:2048 sc1
  buffer_load_dwordx4 v[20:23], v2, s[8:11], s20 offen offset:3072 sc1
  buffer_load_dwordx4 v[24:27], v2, s[8:11], s23 offen offset:0 sc1
  buffer_load_dwordx4 v[28:31], v2, s[8:11], s23 offen offset:1024 sc1
  buffer_load_dwordx4 v[32:35], v2, s[8:11], s23 offen offset:2048 sc1
  s_waitcnt vmcnt(0)
  v_max3_u32 v66, v8, v9, v10
  v_max3_u32 v66, v66, v11, v12
  v_max3_u32 v66, v66, v13, v14
  v_max3_u32 v66, v66, v15, v16
  v_max3_u32 v66, v66, v17, v18
  v_max3_u32 v66, v66, v19, v20
  v_max3_u32 v66, v66, v21, v22
  v_max3_u32 v66, v66, v23, v24
  v_max3_u32 v66, v66, v25, v26
  v_max3_u32 v66, v66, v27, v28
  v_max3_u32 v66, v66, v29, v30
  v_max3_u32 v66, v66, v31, v32
  v_max3_u32 v66, v66, v33, v34
  v_max_u32 v66, v66, v35
  v_cmp_eq_u32 vcc, -1, v66
  s_cbranch_vccz cA_sc3_rk
  s_add_u32 s30, s30, 1
  s_cmp_lt_u32 s30, 400000
  s_cbranch_scc1 cA_sc3_rv
  s_branch cA_abort
cA_sc3_rk:
  s_mov_b32 s62, 1
  v_mov_b32 v36, 0
  v_mov_b32 v37, 0
  v_mov_b32 v38, 0
  v_mov_b32 v39, 0
  v_mov_b32 v40, 0
  v_mov_b32 v41, 0
  v_mov_b32 v42, 0
  v_mov_b32 v43, 0
  v_mov_b32 v44, 0
  v_mov_b32 v45, 0
  v_mov_b32 v46, 0
  v_mov_b32 v47, 0
  v_mov_b32 v48, 0
  v_mov_b32 v49, 0
  v_mov_b32 v50, 0
  v_mov_b32 v51, 0
  v_mov_b32 v62, 0
  v_mov_b32 v63, 0
  v_mov_b32 v64, 0
  v_mov_b32 v65, 0
  v_mov_b32 v68, 0
  v_mov_b32 v69, 0
  v_mov_b32 v70, 0
  v_mov_b32 v71, 0
  v_mov_b32 v72, 0
  v_mov_b32 v73, 0
  v_mov_b32 v74, 0
  v_mov_b32 v75, 0
  v_mov_b32 v52, 0
  v_mov_b32 v53, 0
  v_mov_b32 v54, 0
  v_mov_b32 v55, 0
  v_mov_b32 v56, 0
  v_mov_b32 v57, 0
  v_mov_b32 v58, 0
  v_mov_b32 v59, 0
  s_add_u32 s31, s31, 0x100
  s_nop 0
  s_branch cA_sc3_go
.p2align 6
cA_va0_loop:
  s_mov_b32 s30, 0
  s_barrier
  buffer_load_dwordx4 v[24:27], v2, s[8:11], s23 offen offset:0 sc1
  buffer_load_dwordx4 v[28:31], v2, s[8:11], s23 offen offset:1024 sc1
  s_barrier
  s_cmp_lt_u32 s19, 60
  s_cbranch_scc1 cA_va0_m1
  buffer_store_dword v160, v1, s[8:11], s38 offen sc1
  s_cmp_lg_u32 s19, 63
  s_cbranch_scc1 cA_va0_m2
  v_min_u32 v64, -2, v64
  v_min_u32 v65, -2, v65
  v_min_u32 v66, -2, v66
  v_min_u32 v67, -2, v67
  v_min_u32 v68, -2, v68
  v_min_u32 v69, -2, v69
  v_min_u32 v70, -2, v70
  v_min_u32 v71, -2, v71
  v_min_u32 v72, -2, v72
  v_min_u32 v73, -2, v73
  v_min_u32 v74, -2, v74
  v_min_u32 v75, -2, v75
  v_min_u32 v76, -2, v76
  v_min_u32 v77, -2, v77
  v_min_u32 v78, -2, v78
  v_min_u32 v79, -2, v79
  buffer_store_dwordx4 v[64:67], v2, s[8:11], s33 offen offset:0 sc1
  buffer_store_dwordx4 v[68:71], v2, s[8:11], s33 offen offset:2048 sc1
  s_add_u32 s33, s33, 4096
  buffer_store_dwordx4 v[72:75], v2, s[8:11], s33 offen offset:0 sc1
  buffer_store_dwordx4 v[76:79], v2, s[8:11], s33 offen offset:2048 sc1
  s_add_u32 s33, s33, 4096
  s_waitcnt vmcnt(5)
  s_branch cA_va0_m3
cA_va0_m1:
  buffer_store_dword v160, v1, s[8:11], s38 offen nt
cA_va0_m2:
  s_add_u32 s22, s25, 0
  buffer_load_dwordx4 v[80:83], v6, s[8:11], s22 offen offset:0 sc1
  buffer_load_dwordx4 v[84:87], v6, s[8:11], s22 offen offset:1792 sc1
  s_add_u32 s22, s25, 3584
  buffer_load_dwordx4 v[88:91], v6, s[8:11], s22 offen offset:0 sc1
  buffer_load_dwordx4 v[92:95], v6, s[8:11], s22 offen offset:1792 sc1
  s_add_u32 s22, s25, 7168
  buffer_load_dwordx4 v[96:99], v6, s[8:11], s22 offen offset:0 sc1
  s_mul_i32 s38, s18, 7168
  s_add_u32 s38, s38, 65536
  s_waitcnt vmcnt(6)
cA_va0_m3:
  ds_write_b128 v2, v[24:27] offset:12288
  ds_write_b128 v2, v[28:31] offset:13312
  v_smfmac_f32_16x16x64_bf16 v[36:39], v[24:27], a[32:39], v3
  buffer_load_dwordx4 v[100:103], v6, s[8:11], s22 offen offset:1792 sc1
  v_smfmac_f32_16x16x64_bf16 v[40:43], v[24:27], a[88:95], v3
  s_add_u32 s22, s25, 10752
  buffer_load_dwordx4 v[104:107], v6, s[8:11], s22 offen offset:0 sc1
  v_smfmac_f32_16x16x64_bf16 v[44:47], v[24:27], a[144:151], v3
  buffer_load_dwordx4 v[108:111], v6, s[8:11], s22 offen offset:1792 sc1
  v_smfmac_f32_16x16x64_bf16 v[48:51], v[24:27], a[200:207], v3
  s_add_u32 s22, s25, 14336
  buffer_load_dwordx4 v[112:115], v6, s[8:11], s22 offen offset:0 sc1
  v_smfmac_f32_16x16x64_bf16 v[52:55], v[24:27], v[176:183], v3
  s_waitcnt lgkmcnt(0)
  s_barrier
  ds_read_b128 v[8:11], v2 offset:8192
  ds_read_b128 v[12:15], v2 offset:9216
  ds_read_b128 v[16:19], v2 offset:10240
  ds_read_b128 v[20:23], v2 offset:11264
  ds_read_b128 v[32:35], v2 offset:14336
  buffer_load_dwordx4 v[116:119], v6, s[8:11], s22 offen offset:1792 sc1
  v_smfmac_f32_16x16x64_bf16 v[56:59], v[24:27], v[232:239], v3
  s_add_u32 s22, s25, 17920
  buffer_load_dwordx4 v[120:123], v6, s[8:11], s22 offen offset:0 sc1
  v_smfmac_f32_16x16x64_bf16 v[36:39], v[28:31], a[40:47], v3
  buffer_load_dwordx4 v[124:127], v6, s[8:11], s22 offen offset:1792 sc1
  v_smfmac_f32_16x16x64_bf16 v[40:43], v[28:31], a[96:103], v3
  s_add_u32 s22, s25, 21504
  buffer_load_dwordx4 v[128:131], v6, s[8:11], s22 offen offset:0 sc1
  v_smfmac_f32_16x16x64_bf16 v[44:47], v[28:31], a[152:159], v3
  buffer_load_dwordx4 v[132:135], v6, s[8:11], s22 offen offset:1792 sc1
  v_smfmac_f32_16x16x64_bf16 v[48:51], v[28:31], a[208:215], v3
  s_add_u32 s22, s25, 25088
  buffer_load_dwordx4 v[136:139], v6, s[8:11], s22 offen offset:0 sc1
  v_smfmac_f32_16x16x64_bf16 v[52:55], v[28:31], v[184:191], v3
  buffer_load_dwordx4 v[140:143], v6, s[8:11], s22 offen offset:1792 sc1
  v_smfmac_f32_16x16x64_bf16 v[56:59], v[28:31], v[240:247], v3
  s_waitcnt lgkmcnt(4)
  v_smfmac_f32_16x16x64_bf16 v[36:39], v[8:11], a[0:7], v3
  s_waitcnt lgkmcnt(3)
  v_smfmac_f32_16x16x64_bf16 v[36:39], v[12:15], a[8:15], v3
  s_waitcnt lgkmcnt(2)
  v_smfmac_f32_16x16x64_bf16 v[36:39], v[16:19], a[16:23], v3
  s_waitcnt lgkmcnt(1)
  v_smfmac_f32_16x16x64_bf16 v[36:39], v[20:23], a[24:31], v3
  s_waitcnt lgkmcnt(0)
  v_smfmac_f32_16x16x64_bf16 v[36:39], v[32:35], a[48:55], v3
  v_smfmac_f32_16x16x64_bf16 v[40:43], v[8:11], a[56:63], v3
  v_smfmac_f32_16x16x64_bf16 v[40:43], v[12:15], a[64:71], v3
  v_smfmac_f32_16x16x64_bf16 v[40:43], v[16:19], a[72:79], v3
  v_permlane32_swap_b32 v36, v38
  v_smfmac_f32_16x16x64_bf16 v[40:43], v[20:23], a[80:87], v3
  v_permlane32_swap_b32 v37, v39
  v_smfmac_f32_16x16x64_bf16 v[40:43], v[32:35], a[104:111], v3
  v_add_f32 v36, v36, v38
  v_smfmac_f32_16x16x64_bf16 v[44:47], v[8:11], a[112:119], v3
  v_add_f32 v37, v37, v39
  v_smfmac_f32_16x16x64_bf16 v[44:47], v[12:15], a[120:127], v3
  v_cmp_u_f32 vcc, v36, v37
  v_smfmac_f32_16x16x64_bf16 v[44:47], v[16:19], a[128:135], v3
  v_cvt_pk_bf16_f32 v38, v36, v37
  v_smfmac_f32_16x16x64_bf16 v[44:47], v[20:23], a[136:143], v3
  ds_write_b32 v152, v38
  s_cbranch_vccnz cA_va0_slow
  v_permlane32_swap_b32 v40, v42
  v_smfmac_f32_16x16x64_bf16 v[44:47], v[32:35], a[160:167], v3
  v_permlane32_swap_b32 v41, v43
  v_smfmac_f32_16x16x64_bf16 v[48:51], v[8:11], a[168:175], v3
  buffer_store_dword v162, v1, s[8:11], s21 offen
  v_add_f32 v40, v40, v42
  v_smfmac_f32_16x16x64_bf16 v[48:51], v[12:15], a[176:183], v3
  v_add_f32 v41, v41, v43
  v_smfmac_f32_16x16x64_bf16 v[48:51], v[16:19], a[184:191], v3
  buffer_load_dword v164, v4, s[8:11], 0 offen sc1
  v_cvt_pk_bf16_f32 v42, v40, v41
  v_smfmac_f32_16x16x64_bf16 v[48:51], v[20:23], a[192:199], v3
  ds_write_b32 v153, v42
  v_permlane32_swap_b32 v44, v46
  v_smfmac_f32_16x16x64_bf16 v[48:51], v[32:35], a[216:223], v3
  v_permlane32_swap_b32 v45, v47
  v_smfmac_f32_16x16x64_bf16 v[52:55], v[8:11], a[224:231], v3
  buffer_load_dword v164, v4, s[8:11], 0 offen sc1
  v_add_f32 v44, v44, v46
  v_smfmac_f32_16x16x64_bf16 v[52:55], v[12:15], a[232:239], v3
  v_add_f32 v45, v45, v47
  v_smfmac_f32_16x16x64_bf16 v[52:55], v[16:19], a[240:247], v3
  v_cvt_pk_bf16_f32 v46, v44, v45
  v_smfmac_f32_16x16x64_bf16 v[52:55], v[20:23], a[248:255], v3
  ds_write_b32 v154, v46
  buffer_load_dword v164, v4, s[8:11], 0 offen sc1
  v_permlane32_swap_b32 v48, v50
  v_smfmac_f32_16x16x64_bf16 v[52:55], v[32:35], v[192:199], v3
  v_permlane32_swap_b32 v49, v51
  v_smfmac_f32_16x16x64_bf16 v[56:59], v[8:11], v[200:207], v3
  v_add_f32 v48, v48, v50
  v_smfmac_f32_16x16x64_bf16 v[56:59], v[12:15], v[208:215], v3
  buffer_load_dword v164, v4, s[8:11], 0 offen sc1
  v_add_f32 v49, v49, v51
  v_smfmac_f32_16x16x64_bf16 v[56:59], v[16:19], v[216:223], v3
  v_cvt_pk_bf16_f32 v50, v48, v49
  v_smfmac_f32_16x16x64_bf16 v[56:59], v[20:23], v[224:231], v3
  ds_write_b32 v155, v50
  v_permlane32_swap_b32 v52, v54
  v_smfmac_f32_16x16x64_bf16 v[56:59], v[32:35], v[248:255], v3
  buffer_load_dword v164, v4, s[8:11], 0 offen sc1
  v_permlane32_swap_b32 v53, v55
  v_add_f32 v52, v52, v54
  v_add_f32 v53, v53, v55
  v_cvt_pk_bf16_f32 v54, v52, v53
  ds_write_b32 v156, v54
  s_nop 1
  v_permlane32_swap_b32 v56, v58
  v_permlane32_swap_b32 v57, v59
  v_add_f32 v56, v56, v58
  v_add_f32 v57, v57, v59
  v_cvt_pk_bf16_f32 v58, v56, v57
  ds_write_b32 v157, v58
cA_va0_t2d:
  s_add_u32 s22, s20, 9216
  s_add_u32 s34, s20, 13312
  s_add_u32 s36, s20, 7168
  s_mov_b32 s37, 0
  v_mov_b32 v48, 0
  v_mov_b32 v49, 0
  v_mov_b32 v50, 0
  v_mov_b32 v51, 0
  v_mov_b32 v163, s18
  s_cmp_eq_u32 s19, 63
  s_waitcnt lgkmcnt(0)
  s_cbranch_scc1 cA_va0_last
  s_setprio 3
cA_va0_fw_l:
  v_cmp_gt_u32 vcc, s18, v164
  buffer_load_dword v164, v4, s[8:11], 0 offen sc1
  s_cbranch_vccz cA_va0_fw_d
  v_cmp_gt_u32 vcc, s18, v164
  buffer_load_dword v164, v4, s[8:11], 0 offen sc1
  s_cbranch_vccz cA_va0_fw_d
  v_cmp_gt_u32 vcc, s18, v164
  buffer_load_dword v164, v4, s[8:11], 0 offen sc1
  s_cbranch_vccz cA_va0_fw_d
  v_cmp_gt_u32 vcc, s18, v164
  buffer_load_dword v164, v4, s[8:11], 0 offen sc1
  s_cbranch_vccz cA_va0_fw_d
  v_cmp_gt_u32 vcc, s18, v164
  buffer_load_dword v164, v4, s[8:11], 0 offen sc1
  s_cbranch_vccz cA_va0_fw_d
  v_cmp_gt_u32 vcc, s18, v164
  buffer_load_dword v164, v4, s[8:11], 0 offen sc1
  s_cbranch_vccz cA_va0_fw_d
  v_cmp_gt_u32 vcc, s18, v164
  buffer_load_dword v164, v4, s[8:11], 0 offen sc1
  s_cbranch_vccz cA_va0_fw_d
  v_cmp_gt_u32 vcc, s18, v164
  buffer_load_dword v164, v4, s[8:11], 0 offen sc1
  s_cbranch_vccz cA_va0_fw_d
  v_cmp_gt_u32 vcc, s18, v164
  buffer_load_dword v164, v4, s[8:11], 0 offen sc1
  s_cbranch_vccz cA_va0_fw_d
  v_cmp_gt_u32 vcc, s18, v164
  buffer_load_dword v164, v4, s[8:11], 0 offen sc1
  s_cbranch_vccz cA_va0_fw_d
  v_cmp_gt_u32 vcc, s18, v164
  buffer_load_dword v164, v4, s[8:11], 0 offen sc1
  s_cbranch_vccz cA_va0_fw_d
  v_cmp_gt_u32 vcc, s18, v164
  buffer_load_dword v164, v4, s[8:11], 0 offen sc1
  s_cbranch_vccz cA_va0_fw_d
  v_cmp_gt_u32 vcc, s18, v164
  buffer_load_dword v164, v4, s[8:11], 0 offen sc1
  s_cbranch_vccz cA_va0_fw_d
  v_cmp_gt_u32 vcc, s18, v164
  buffer_load_dword v164, v4, s[8:11], 0 offen sc1
  s_cbranch_vccz cA_va0_fw_d
  v_cmp_gt_u32 vcc, s18, v164
  buffer_load_dword v164, v4, s[8:11], 0 offen sc1
  s_cbranch_vccz cA_va0_fw_d
  v_cmp_gt_u32 vcc, s18, v164
  buffer_load_dword v164, v4, s[8:11], 0 offen sc1
  s_cbranch_vccz cA_va0_fw_d
  s_waitcnt vmcnt(24)
  s_add_u32 s30, s30, 1
  s_cmp_lt_u32 s30, 400000
  s_cbranch_scc1 cA_va0_fw_l
  s_branch cA_abort
cA_va0_fw_d:
  buffer_load_dwordx4 v[8:11], v2, s[8:11], s22 offen offset:0 sc1
  buffer_load_dwordx4 v[12:15], v2, s[8:11], s22 offen offset:1024 sc1
  buffer_load_dwordx4 v[16:19], v2, s[8:11], s22 offen offset:2048 sc1
  buffer_load_dwordx4 v[20:23], v2, s[8:11], s22 offen offset:3072 sc1
  buffer_load_dwordx4 v[24:27], v2, s[8:11], s34 offen offset:0 sc1
  buffer_load_dwordx4 v[28:31], v2, s[8:11], s34 offen offset:1024 sc1
  buffer_load_dwordx4 v[32:35], v2, s[8:11], s34 offen offset:2048 sc1
  buffer_load_dwordx4 v[36:39], v2, s[8:11], s34 offen offset:3072 sc1
  buffer_load_dwordx4 v[40:43], v2, s[8:11], s36 offen offset:0 sc1
  buffer_load_dwordx4 v[44:47], v2, s[8:11], s36 offen offset:1024 sc1
  s_barrier
  ds_read_b128 v[64:67], v2 offset:0
  ds_read_b128 v[68:71], v2 offset:1024
  ds_read_b128 v[72:75], v2 offset:2048
  ds_read_b128 v[76:79], v2 offset:3072
cA_va0_lp:
  s_waitcnt vmcnt(9)
  v_smfmac_f32_16x16x64_bf16 v[48:51], v[8:11], v[80:87], v3
  s_waitcnt vmcnt(8)
  v_smfmac_f32_16x16x64_bf16 v[48:51], v[12:15], v[88:95], v3
  s_waitcnt vmcnt(7)
  v_smfmac_f32_16x16x64_bf16 v[48:51], v[16:19], v[96:103], v3
  s_waitcnt vmcnt(6)
  v_smfmac_f32_16x16x64_bf16 v[48:51], v[20:23], v[104:111], v3
  s_waitcnt vmcnt(5)
  v_smfmac_f32_16x16x64_bf16 v[48:51], v[24:27], v[112:119], v3
  s_waitcnt vmcnt(4)
  v_smfmac_f32_16x16x64_bf16 v[48:51], v[28:31], v[120:127], v3
  s_waitcnt vmcnt(3)
  v_smfmac_f32_16x16x64_bf16 v[48:51], v[32:35], v[128:135], v3
  s_waitcnt vmcnt(2)
  v_smfmac_f32_16x16x64_bf16 v[48:51], v[36:39], v[136:143], v3
  s_waitcnt vmcnt(1) lgkmcnt(0)
  v_smfmac_f32_16x16x64_bf16 v[48:51], v[40:43], v[64:71], v3
  s_waitcnt vmcnt(0)
  v_smfmac_f32_16x16x64_bf16 v[48:51], v[44:47], v[72:79], v3
  s_nop 7
  v_permlane32_swap_b32 v48, v50
  v_permlane32_swap_b32 v49, v51
  v_pk_add_f32 v[48:49], v[48:49], v[50:51]
  v_cvt_pk_bf16_f32 v160, v48, v49
  v_cmp_u_f32 vcc, v48, v49
  s_nop 0
  v_mov_b32_dpp v161, v160 quad_perm:[1,0,3,2] row_mask:0xf bank_mask:0xf
  v_perm_b32 v160, v161, v160, v5
  v_cndmask_b32 v161, v160, v162, vcc
  buffer_store_dword v161, v1, s[8:11], s21 offen
  s_cbranch_vccnz cA_va0_rp
cA_va0_cont:
  s_setprio 0
  s_cmp_lg_u32 s19, 62
  s_cbranch_scc1 cA_va0_nl
  s_sleep 4
  buffer_store_dword v160, v1, s[8:11], s38 offen sc1
  s_mov_b32 s38, 0x40000000
  s_mov_b32 s25, 0x40000000
cA_va0_nl:
  s_add_u32 s25, s25, 458752
  v_mov_b32 v36, 0
  v_mov_b32 v37, 0
  v_mov_b32 v38, 0
  v_mov_b32 v39, 0
  v_mov_b32 v40, 0
  v_mov_b32 v41, 0
  v_mov_b32 v42, 0
  v_mov_b32 v43, 0
  v_mov_b32 v44, 0
  v_mov_b32 v45, 0
  v_mov_b32 v46, 0
  v_mov_b32 v47, 0
  v_mov_b32 v48, 0
  v_mov_b32 v49, 0
  v_mov_b32 v50, 0
  v_mov_b32 v51, 0
  v_mov_b32 v52, 0
  v_mov_b32 v53, 0
  v_mov_b32 v54, 0
  v_mov_b32 v55, 0
  v_mov_b32 v56, 0
  v_mov_b32 v57, 0
  v_mov_b32 v58, 0
  v_mov_b32 v59, 0
  v_mov_b32 v60, 0
  v_mov_b32 v61, 0
  v_mov_b32 v62, 0
  v_mov_b32 v63, 0
  s_mov_b32 s19, s18
  s_add_u32 s18, s18, 1
  s_mov_b32 s22, s20
  s_mov_b32 s20, s21
  s_mov_b32 s21, s22
  s_add_u32 s23, s20, 4096
  s_branch cA_va0_loop
cA_va0_slow:
  s_waitcnt lgkmcnt(0)
cA_va0_sl1:
  s_add_u32 s31, s31, 0x1000000
  buffer_load_dwordx4 v[8:11], v2, s[8:11], s20 offen offset:0 sc1
  buffer_load_dwordx4 v[12:15], v2, s[8:11], s20 offen offset:1024 sc1
  buffer_load_dwordx4 v[16:19], v2, s[8:11], s20 offen offset:2048 sc1
  buffer_load_dwordx4 v[20:23], v2, s[8:11], s20 offen offset:3072 sc1
  buffer_load_dwordx4 v[24:27], v2, s[8:11], s23 offen offset:0 sc1
  buffer_load_dwordx4 v[28:31], v2, s[8:11], s23 offen offset:1024 sc1
  buffer_load_dwordx4 v[32:35], v2, s[8:11], s23 offen offset:2048 sc1
  s_waitcnt vmcnt(0)
  v_max3_u32 v36, v8, v9, v10
  v_max3_u32 v36, v36, v11, v12
  v_max3_u32 v36, v36, v13, v14
  v_max3_u32 v36, v36, v15, v16
  v_max3_u32 v36, v36, v17, v18
  v_max3_u32 v36, v36, v19, v20
  v_max3_u32 v36, v36, v21, v22
  v_max3_u32 v36, v36, v23, v24
  v_max3_u32 v36, v36, v25, v26
  v_max3_u32 v36, v36, v27, v28
  v_max3_u32 v36, v36, v29, v30
  v_max3_u32 v36, v36, v31, v32
  v_max3_u32 v36, v36, v33, v34
  v_max_u32 v36, v36, v35
  v_cmp_eq_u32 vcc, -1, v36
  s_cbranch_vccz cA_va0_sl2
  s_add_u32 s30, s30, 1
  s_cmp_lt_u32 s30, 400000
  s_cbranch_scc1 cA_va0_sl1
  s_branch cA_abort
cA_va0_sl2:
  v_mov_b32 v36, 0
  v_mov_b32 v37, 0
  v_mov_b32 v38, 0
  v_mov_b32 v39, 0
  v_mov_b32 v40, 0
  v_mov_b32 v41, 0
  v_mov_b32 v42, 0
  v_mov_b32 v43, 0
  v_mov_b32 v44, 0
  v_mov_b32 v45, 0
  v_mov_b32 v46, 0
  v_mov_b32 v47, 0
  v_mov_b32 v48, 0
  v_mov_b32 v49, 0
  v_mov_b32 v50, 0
  v_mov_b32 v51, 0
  v_mov_b32 v52, 0
  v_mov_b32 v53, 0
  v_mov_b32 v54, 0
  v_mov_b32 v55, 0
  v_mov_b32 v56, 0
  v_mov_b32 v57, 0
  v_mov_b32 v58, 0
  v_mov_b32 v59, 0
  v_mov_b32 v60, 0
  v_mov_b32 v61, 0
  v_mov_b32 v62, 0
  v_mov_b32 v63, 0
  buffer_store_dword v162, v1, s[8:11], s21 offen
  v_smfmac_f32_16x16x64_bf16 v[36:39], v[8:11], a[0:7], v3
  v_smfmac_f32_16x16x64_bf16 v[40:43], v[8:11], a[56:63], v3
  v_smfmac_f32_16x16x64_bf16 v[44:47], v[8:11], a[112:119], v3
  v_smfmac_f32_16x16x64_bf16 v[48:51], v[8:11], a[168:175], v3
  v_smfmac_f32_16x16x64_bf16 v[52:55], v[8:11], a[224:231], v3
  v_smfmac_f32_16x16x64_bf16 v[56:59], v[8:11], v[200:207], v3
  v_smfmac_f32_16x16x64_bf16 v[36:39], v[12:15], a[8:15], v3
  v_smfmac_f32_16x16x64_bf16 v[40:43], v[12:15], a[64:71], v3
  v_smfmac_f32_16x16x64_bf16 v[44:47], v[12:15], a[120:127], v3
  v_smfmac_f32_16x16x64_bf16 v[48:51], v[12:15], a[176:183], v3
  v_smfmac_f32_16x16x64_bf16 v[52:55], v[12:15], a[232:239], v3
  v_smfmac_f32_16x16x64_bf16 v[56:59], v[12:15], v[208:215], v3
  v_smfmac_f32_16x16x64_bf16 v[36:39], v[16:19], a[16:23], v3
  v_smfmac_f32_16x16x64_bf16 v[40:43], v[16:19], a[72:79], v3
  v_smfmac_f32_16x16x64_bf16 v[44:47], v[16:19], a[128:135], v3
  v_smfmac_f32_16x16x64_bf16 v[48:51], v[16:19], a[184:191], v3
  v_smfmac_f32_16x16x64_bf16 v[52:55], v[16:19], a[240:247], v3
  v_smfmac_f32_16x16x64_bf16 v[56:59], v[16:19], v[216:223], v3
  v_smfmac_f32_16x16x64_bf16 v[36:39], v[20:23], a[24:31], v3
  v_smfmac_f32_16x16x64_bf16 v[40:43], v[20:23], a[80:87], v3
  v_smfmac_f32_16x16x64_bf16 v[44:47], v[20:23], a[136:143], v3
  v_smfmac_f32_16x16x64_bf16 v[48:51], v[20:23], a[192:199], v3
  v_smfmac_f32_16x16x64_bf16 v[52:55], v[20:23], a[248:255], v3
  v_smfmac_f32_16x16x64_bf16 v[56:59], v[20:23], v[224:231], v3
  v_smfmac_f32_16x16x64_bf16 v[36:39], v[24:27], a[32:39], v3
  v_smfmac_f32_16x16x64_bf16 v[40:43], v[24:27], a[88:95], v3
  v_smfmac_f32_16x16x64_bf16 v[44:47], v[24:27], a[144:151], v3
  v_smfmac_f32_16x16x64_bf16 v[48:51], v[24:27], a[200:207], v3
  v_smfmac_f32_16x16x64_bf16 v[52:55], v[24:27], v[176:183], v3
  v_smfmac_f32_16x16x64_bf16 v[56:59], v[24:27], v[232:239], v3
  v_smfmac_f32_16x16x64_bf16 v[36:39], v[28:31], a[40:47], v3
  v_smfmac_f32_16x16x64_bf16 v[40:43], v[28:31], a[96:103], v3
  v_smfmac_f32_16x16x64_bf16 v[44:47], v[28:31], a[152:159], v3
  v_smfmac_f32_16x16x64_bf16 v[48:51], v[28:31], a[208:215], v3
  v_smfmac_f32_16x16x64_bf16 v[52:55], v[28:31], v[184:191], v3
  v_smfmac_f32_16x16x64_bf16 v[56:59], v[28:31], v[240:247], v3
  v_smfmac_f32_16x16x64_bf16 v[36:39], v[32:35], a[48:55], v3
  v_smfmac_f32_16x16x64_bf16 v[40:43], v[32:35], a[104:111], v3
  v_smfmac_f32_16x16x64_bf16 v[44:47], v[32:35], a[160:167], v3
  v_smfmac_f32_16x16x64_bf16 v[48:51], v[32:35], a[216:223], v3
  v_smfmac_f32_16x16x64_bf16 v[52:55], v[32:35], v[192:199], v3
  v_smfmac_f32_16x16x64_bf16 v[56:59], v[32:35], v[248:255], v3
  v_permlane32_swap_b32 v36, v38
  v_permlane32_swap_b32 v37, v39
  v_add_f32 v36, v36, v38
  v_add_f32 v37, v37, v39
  v_cvt_pk_bf16_f32 v38, v36, v37
  ds_write_b32 v152, v38
  v_permlane32_swap_b32 v40, v42
  v_permlane32_swap_b32 v41, v43
  v_add_f32 v40, v40, v42
  v_add_f32 v41, v41, v43
  v_cvt_pk_bf16_f32 v42, v40, v41
  ds_write_b32 v153, v42
  v_permlane32_swap_b32 v44, v46
  v_permlane32_swap_b32 v45, v47
  v_add_f32 v44, v44, v46
  v_add_f32 v45, v45, v47
  v_cvt_pk_bf16_f32 v46, v44, v45
  ds_write_b32 v154, v46
  v_permlane32_swap_b32 v48, v50
  v_permlane32_swap_b32 v49, v51
  v_add_f32 v48, v48, v50
  v_add_f32 v49, v49, v51
  v_cvt_pk_bf16_f32 v50, v48, v49
  ds_write_b32 v155, v50
  v_permlane32_swap_b32 v52, v54
  v_permlane32_swap_b32 v53, v55
  v_add_f32 v52, v52, v54
  v_add_f32 v53, v53, v55
  v_cvt_pk_bf16_f32 v54, v52, v53
  ds_write_b32 v156, v54
  v_permlane32_swap_b32 v56, v58
  v_permlane32_swap_b32 v57, v59
  v_add_f32 v56, v56, v58
  v_add_f32 v57, v57, v59
  v_cvt_pk_bf16_f32 v58, v56, v57
  ds_write_b32 v157, v58
  buffer_load_dword v164, v4, s[8:11], 0 offen sc1
  buffer_load_dword v164, v4, s[8:11], 0 offen sc1
  buffer_load_dword v164, v4, s[8:11], 0 offen sc1
  buffer_load_dword v164, v4, s[8:11], 0 offen sc1
  buffer_load_dword v164, v4, s[8:11], 0 offen sc1
  s_branch cA_va0_t2d
cA_va0_last:
  s_barrier
  ds_read_b128 v[64:67], v2 offset:0
  ds_read_b128 v[68:71], v2 offset:1024
  ds_read_b128 v[72:75], v2 offset:2048
  ds_read_b128 v[76:79], v2 offset:3072
  s_waitcnt lgkmcnt(0)
  v_min_u32 v64, -2, v64
  v_min_u32 v65, -2, v65
  v_min_u32 v66, -2, v66
  v_min_u32 v67, -2, v67
  v_min_u32 v68, -2, v68
  v_min_u32 v69, -2, v69
  v_min_u32 v70, -2, v70
  v_min_u32 v71, -2, v71
  v_min_u32 v72, -2, v72
  v_min_u32 v73, -2, v73
  v_min_u32 v74, -2, v74
  v_min_u32 v75, -2, v75
  v_min_u32 v76, -2, v76
  v_min_u32 v77, -2, v77
  v_min_u32 v78, -2, v78
  v_min_u32 v79, -2, v79
  buffer_store_dwordx4 v[64:67], v2, s[8:11], s33 offen offset:0 sc1
  buffer_store_dwordx4 v[68:71], v2, s[8:11], s33 offen offset:2048 sc1
  s_add_u32 s33, s33, 4096
  buffer_store_dwordx4 v[72:75], v2, s[8:11], s33 offen offset:0 sc1
  buffer_store_dwordx4 v[76:79], v2, s[8:11], s33 offen offset:2048 sc1
  s_add_u32 s33, s33, 4096
  s_cmp_lg_u32 s17, 0
  s_cbranch_scc1 cA_done
  s_waitcnt vmcnt(0)
  buffer_wbl2 sc1
  s_branch cA_done
cA_va0_rp:
  s_cmp_eq_u32 s37, 0
  s_cbranch_scc1 cA_va0_rv
  v_min_u32 v160, -2, v160
  buffer_store_dword v160, v1, s[8:11], s21 offen
  s_branch cA_va0_cont
cA_va0_rv:
  s_add_u32 s31, s31, 0x10000
  buffer_load_dwordx4 v[8:11], v2, s[8:11], s22 offen offset:0 sc1
  buffer_load_dwordx4 v[12:15], v2, s[8:11], s22 offen offset:1024 sc1
  buffer_load_dwordx4 v[16:19], v2, s[8:11], s22 offen offset:2048 sc1
  buffer_load_dwordx4 v[20:23], v2, s[8:11], s22 offen offset:3072 sc1
  buffer_load_dwordx4 v[24:27], v2, s[8:11], s34 offen offset:0 sc1
  buffer_load_dwordx4 v[28:31], v2, s[8:11], s34 offen offset:1024 sc1
  buffer_load_dwordx4 v[32:35], v2, s[8:11], s34 offen offset:2048 sc1
  buffer_load_dwordx4 v[36:39], v2, s[8:11], s34 offen offset:3072 sc1
  buffer_load_dwordx4 v[40:43], v2, s[8:11], s36 offen offset:0 sc1
  buffer_load_dwordx4 v[44:47], v2, s[8:11], s36 offen offset:1024 sc1
  s_waitcnt vmcnt(0)
  v_max3_u32 v52, v8, v9, v10
  v_max3_u32 v52, v52, v11, v12
  v_max3_u32 v52, v52, v13, v14
  v_max3_u32 v52, v52, v15, v16
  v_max3_u32 v52, v52, v17, v18
  v_max3_u32 v52, v52, v19, v20
  v_max3_u32 v52, v52, v21, v22
  v_max3_u32 v52, v52, v23, v24
  v_max3_u32 v52, v52, v25, v26
  v_max3_u32 v52, v52, v27, v28
  v_max3_u32 v52, v52, v29, v30
  v_max3_u32 v52, v52, v31, v32
  v_max3_u32 v52, v52, v33, v34
  v_max3_u32 v52, v52, v35, v36
  v_max3_u32 v52, v52, v37, v38
  v_max3_u32 v52, v52, v39, v40
  v_max3_u32 v52, v52, v41, v42
  v_max3_u32 v52, v52, v43, v44
  v_max3_u32 v52, v52, v45, v46
  v_max_u32 v52, v52, v47
  v_cmp_eq_u32 vcc, -1, v52
  s_mov_b32 s37, 1
  v_mov_b32 v48, 0
  v_mov_b32 v49, 0
  v_mov_b32 v50, 0
  v_mov_b32 v51, 0
  s_nop 1
  s_cbranch_vccz cA_va0_lp
  s_add_u32 s30, s30, 1
  s_cmp_lt_u32 s30, 400000
  s_cbranch_scc1 cA_va0_rv
  s_branch cA_abort
.p2align 6
cA_va1_loop:
  s_mov_b32 s30, 0
  s_barrier
  buffer_load_dwordx4 v[28:31], v2, s[8:11], s23 offen offset:1024 sc1
  buffer_load_dwordx4 v[32:35], v2, s[8:11], s23 offen offset:2048 sc1
  s_barrier
  s_cmp_lt_u32 s19, 60
  s_cbranch_scc1 cA_va1_m1
  buffer_store_dword v160, v1, s[8:11], s38 offen sc1
  s_cmp_lg_u32 s19, 63
  s_cbranch_scc1 cA_va1_m2
  v_min_u32 v64, -2, v64
  v_min_u32 v65, -2, v65
  v_min_u32 v66, -2, v66
  v_min_u32 v67, -2, v67
  v_min_u32 v68, -2, v68
  v_min_u32 v69, -2, v69
  v_min_u32 v70, -2, v70
  v_min_u32 v71, -2, v71
  v_min_u32 v72, -2, v72
  v_min_u32 v73, -2, v73
  v_min_u32 v74, -2, v74
  v_min_u32 v75, -2, v75
  v_min_u32 v76, -2, v76
  v_min_u32 v77, -2, v77
  v_min_u32 v78, -2, v78
  v_min_u32 v79, -2, v79
  buffer_store_dwordx4 v[64:67], v2, s[8:11], s33 offen offset:0 sc1
  buffer_store_dwordx4 v[68:71], v2, s[8:11], s33 offen offset:2048 sc1
  s_add_u32 s33, s33, 4096
  buffer_store_dwordx4 v[72:75], v2, s[8:11], s33 offen offset:0 sc1
  buffer_store_dwordx4 v[76:79], v2, s[8:11], s33 offen offset:2048 sc1
  s_add_u32 s33, s33, 4096
  s_waitcnt vmcnt(5)
  s_branch cA_va1_m3
cA_va1_m1:
  buffer_store_dword v160, v1, s[8:11], s38 offen nt
cA_va1_m2:
  s_add_u32 s22, s25, 0
  buffer_load_dwordx4 v[80:83], v6, s[8:11], s22 offen offset:0 sc1
  buffer_load_dwordx4 v[84:87], v6, s[8:11], s22 offen offset:1792 sc1
  s_add_u32 s22, s25, 3584
  buffer_load_dwordx4 v[88:91], v6, s[8:11], s22 offen offset:0 sc1
  buffer_load_dwordx4 v[92:95], v6, s[8:11], s22 offen offset:1792 sc1
  s_add_u32 s22, s25, 7168
  buffer_load_dwordx4 v[96:99], v6, s[8:11], s22 offen offset:0 sc1
  s_mul_i32 s38, s18, 7168
  s_add_u32 s38, s38, 65536
  s_waitcnt vmcnt(6)
cA_va1_m3:
  ds_write_b128 v2, v[32:35] offset:14336
  v_smfmac_f32_16x16x64_bf16 v[36:39], v[28:31], a[40:47], v3
  buffer_load_dwordx4 v[100:103], v6, s[8:11], s22 offen offset:1792 sc1
  v_smfmac_f32_16x16x64_bf16 v[40:43], v[28:31], a[96:103], v3
  s_add_u32 s22, s25, 10752
  buffer_load_dwordx4 v[104:107], v6, s[8:11], s22 offen offset:0 sc1
  v_smfmac_f32_16x16x64_bf16 v[44:47], v[28:31], a[152:159], v3
  buffer_load_dwordx4 v[108:111], v6, s[8:11], s22 offen offset:1792 sc1
  v_smfmac_f32_16x16x64_bf16 v[48:51], v[28:31], a[208:215], v3
  s_add_u32 s22, s25, 14336
  buffer_load_dwordx4 v[112:115], v6, s[8:11], s22 offen offset:0 sc1
  v_smfmac_f32_16x16x64_bf16 v[52:55], v[28:31], v[184:191], v3
  s_waitcnt lgkmcnt(0)
  s_barrier
  ds_read_b128 v[8:11], v2 offset:8192
  ds_read_b128 v[12:15], v2 offset:9216
  ds_read_b128 v[16:19], v2 offset:10240
  ds_read_b128 v[20:23], v2 offset:11264
  ds_read_b128 v[24:27], v2 offset:12288
  buffer_load_dwordx4 v[116:119], v6, s[8:11], s22 offen offset:1792 sc1
  v_smfmac_f32_16x16x64_bf16 v[56:59], v[28:31], v[240:247], v3
  s_add_u32 s22, s25, 17920
  buffer_load_dwordx4 v[120:123], v6, s[8:11], s22 offen offset:0 sc1
  v_smfmac_f32_16x16x64_bf16 v[36:39], v[32:35], a[48:55], v3
  buffer_load_dwordx4 v[124:127], v6, s[8:11], s22 offen offset:1792 sc1
  v_smfmac_f32_16x16x64_bf16 v[40:43], v[32:35], a[104:111], v3
  s_add_u32 s22, s25, 21504
  buffer_load_dwordx4 v[128:131], v6, s[8:11], s22 offen offset:0 sc1
  v_smfmac_f32_16x16x64_bf16 v[44:47], v[32:35], a[160:167], v3
  buffer_load_dwordx4 v[132:135], v6, s[8:11], s22 offen offset:1792 sc1
  v_smfmac_f32_16x16x64_bf16 v[48:51], v[32:35], a[216:223], v3
  s_add_u32 s22, s25, 25088
  buffer_load_dwordx4 v[136:139], v6, s[8:11], s22 offen offset:0 sc1
  v_smfmac_f32_16x16x64_bf16 v[52:55], v[32:35], v[192:199], v3
  ds_read_b128 v[64:67], v0 offset:0
  ds_read_b128 v[68:71], v0 offset:1024
  buffer_load_dwordx4 v[140:143], v6, s[8:11], s22 offen offset:1792 sc1
  v_smfmac_f32_16x16x64_bf16 v[56:59], v[32:35], v[248:255], v3
  s_waitcnt lgkmcnt(6)
  ds_read_b128 v[72:75], v0 offset:2048
  ds_read_b128 v[76:79], v0 offset:3072
  v_smfmac_f32_16x16x64_bf16 v[36:39], v[8:11], a[0:7], v3
  s_waitcnt lgkmcnt(7)
  v_smfmac_f32_16x16x64_bf16 v[36:39], v[12:15], a[8:15], v3
  s_waitcnt lgkmcnt(6)
  v_smfmac_f32_16x16x64_bf16 v[36:39], v[16:19], a[16:23], v3
  s_waitcnt lgkmcnt(2)
  v_smfmac_f32_16x16x64_bf16 v[60:63], v[8:11], v[64:71], v3
  s_waitcnt lgkmcnt(5)
  ds_read_b128 v[144:147], v0 offset:4096
  ds_read_b128 v[148:151], v0 offset:5120
  v_smfmac_f32_16x16x64_bf16 v[36:39], v[20:23], a[24:31], v3
  s_waitcnt lgkmcnt(6)
  v_smfmac_f32_16x16x64_bf16 v[36:39], v[24:27], a[32:39], v3
  v_smfmac_f32_16x16x64_bf16 v[40:43], v[8:11], a[56:63], v3
  s_waitcnt lgkmcnt(2)
  v_smfmac_f32_16x16x64_bf16 v[60:63], v[12:15], v[72:79], v3
  ds_read_b128 v[64:67], v0 offset:6144
  ds_read_b128 v[68:71], v0 offset:7168
  v_smfmac_f32_16x16x64_bf16 v[40:43], v[12:15], a[64:71], v3
  v_permlane32_swap_b32 v36, v38
  v_smfmac_f32_16x16x64_bf16 v[40:43], v[16:19], a[72:79], v3
  v_permlane32_swap_b32 v37, v39
  v_smfmac_f32_16x16x64_bf16 v[40:43], v[20:23], a[80:87], v3
  s_waitcnt lgkmcnt(2)
  v_add_f32 v36, v36, v38
  v_smfmac_f32_16x16x64_bf16 v[60:63], v[16:19], v[144:151], v3
  ds_read_b128 v[72:75], v0 offset:8192
  ds_read_b128 v[76:79], v0 offset:9216
  v_add_f32 v37, v37, v39
  v_smfmac_f32_16x16x64_bf16 v[40:43], v[24:27], a[88:95], v3
  v_cmp_u_f32 vcc, v36, v37
  v_smfmac_f32_16x16x64_bf16 v[44:47], v[8:11], a[112:119], v3
  v_cvt_pk_bf16_f32 v38, v36, v37
  v_smfmac_f32_16x16x64_bf16 v[44:47], v[12:15], a[120:127], v3
  ds_write_b32 v152, v38
  s_waitcnt lgkmcnt(3)
  s_cbranch_vccnz cA_va1_slow
  v_permlane32_swap_b32 v40, v42
  v_smfmac_f32_16x16x64_bf16 v[60:63], v[20:23], v[64:71], v3
  ds_read_b128 v[144:147], v0 offset:10240
  ds_read_b128 v[148:151], v0 offset:11264
  v_permlane32_swap_b32 v41, v43
  v_smfmac_f32_16x16x64_bf16 v[44:47], v[16:19], a[128:135], v3
  buffer_store_dword v162, v1, s[8:11], s21 offen
  v_add_f32 v40, v40, v42
  v_smfmac_f32_16x16x64_bf16 v[44:47], v[20:23], a[136:143], v3
  v_add_f32 v41, v41, v43
  v_smfmac_f32_16x16x64_bf16 v[44:47], v[24:27], a[144:151], v3
  s_waitcnt lgkmcnt(3)
  v_cvt_pk_bf16_f32 v42, v40, v41
  v_smfmac_f32_16x16x64_bf16 v[60:63], v[24:27], v[72:79], v3
  ds_write_b32 v153, v42
  ds_read_b128 v[64:67], v0 offset:12288
  ds_read_b128 v[68:71], v0 offset:13312
  v_smfmac_f32_16x16x64_bf16 v[48:51], v[8:11], a[168:175], v3
  s_nop 0
  v_permlane32_swap_b32 v44, v46
  v_smfmac_f32_16x16x64_bf16 v[48:51], v[12:15], a[176:183], v3
  v_permlane32_swap_b32 v45, v47
  v_smfmac_f32_16x16x64_bf16 v[48:51], v[16:19], a[184:191], v3
  s_waitcnt lgkmcnt(3)
  v_add_f32 v44, v44, v46
  v_smfmac_f32_16x16x64_bf16 v[60:63], v[28:31], v[144:151], v3
  v_add_f32 v45, v45, v47
  v_smfmac_f32_16x16x64_bf16 v[48:51], v[20:23], a[192:199], v3
  v_cvt_pk_bf16_f32 v46, v44, v45
  v_smfmac_f32_16x16x64_bf16 v[48:51], v[24:27], a[200:207], v3
  ds_write_b32 v154, v46
  v_smfmac_f32_16x16x64_bf16 v[52:55], v[8:11], a[224:231], v3
  s_waitcnt lgkmcnt(1)
  v_smfmac_f32_16x16x64_bf16 v[60:63], v[32:35], v[64:71], v3
  v_smfmac_f32_16x16x64_bf16 v[52:55], v[12:15], a[232:239], v3
  v_permlane32_swap_b32 v48, v50
  v_smfmac_f32_16x16x64_bf16 v[52:55], v[16:19], a[240:247], v3
  v_permlane32_swap_b32 v49, v51
  v_smfmac_f32_16x16x64_bf16 v[52:55], v[20:23], a[248:255], v3
  v_add_f32 v48, v48, v50
  v_smfmac_f32_16x16x64_bf16 v[52:55], v[24:27], v[176:183], v3
  v_add_f32 v49, v49, v51
  v_smfmac_f32_16x16x64_bf16 v[56:59], v[8:11], v[200:207], v3
  v_cvt_pk_bf16_f32 v50, v48, v49
  v_smfmac_f32_16x16x64_bf16 v[56:59], v[12:15], v[208:215], v3
  ds_write_b32 v155, v50
  v_permlane32_swap_b32 v60, v62
  v_smfmac_f32_16x16x64_bf16 v[56:59], v[16:19], v[216:223], v3
  v_permlane32_swap_b32 v61, v63
  v_smfmac_f32_16x16x64_bf16 v[56:59], v[20:23], v[224:231], v3
  v_add_f32 v60, v60, v62
  v_smfmac_f32_16x16x64_bf16 v[56:59], v[24:27], v[232:239], v3
  v_add_f32 v61, v61, v63
  v_cvt_pk_bf16_f32 v62, v60, v61
  ds_write_b32 v158, v62
  v_permlane32_swap_b32 v52, v54
  v_permlane32_swap_b32 v53, v55
  v_add_f32 v52, v52, v54
  v_add_f32 v53, v53, v55
  v_cvt_pk_bf16_f32 v54, v52, v53
  ds_write_b32 v156, v54
  v_permlane32_swap_b32 v56, v58
  v_permlane32_swap_b32 v57, v59
  v_add_f32 v56, v56, v58
  v_add_f32 v57, v57, v59
  v_cvt_pk_bf16_f32 v58, v56, v57
  ds_write_b32 v157, v58
cA_va1_t2d:
  s_add_u32 s22, s20, 9216
  s_add_u32 s34, s20, 13312
  s_add_u32 s36, s20, 7168
  s_mov_b32 s37, 0
  v_mov_b32 v48, 0
  v_mov_b32 v49, 0
  v_mov_b32 v50, 0
  v_mov_b32 v51, 0
  v_mov_b32 v163, s18
  s_cmp_eq_u32 s19, 63
  s_waitcnt lgkmcnt(0)
  s_cbranch_scc1 cA_va1_last
  s_barrier
  buffer_load_dwordx4 v[8:11], v2, s[8:11], s22 offen offset:0 sc1
  buffer_load_dwordx4 v[12:15], v2, s[8:11], s22 offen offset:1024 sc1
  buffer_load_dwordx4 v[16:19], v2, s[8:11], s22 offen offset:2048 sc1
  buffer_load_dwordx4 v[20:23], v2, s[8:11], s22 offen offset:3072 sc1
  buffer_load_dwordx4 v[24:27], v2, s[8:11], s34 offen offset:0 sc1
  buffer_load_dwordx4 v[28:31], v2, s[8:11], s34 offen offset:1024 sc1
  buffer_load_dwordx4 v[32:35], v2, s[8:11], s34 offen offset:2048 sc1
  buffer_load_dwordx4 v[36:39], v2, s[8:11], s34 offen offset:3072 sc1
  buffer_load_dwordx4 v[40:43], v2, s[8:11], s36 offen offset:0 sc1
  buffer_load_dwordx4 v[44:47], v2, s[8:11], s36 offen offset:1024 sc1
  ds_read_b128 v[64:67], v2 offset:4096
  ds_read_b128 v[68:71], v2 offset:5120
  ds_read_b128 v[72:75], v2 offset:6144
  ds_read_b128 v[76:79], v2 offset:7168
cA_va1_lp:
  s_waitcnt vmcnt(9)
  v_smfmac_f32_16x16x64_bf16 v[48:51], v[8:11], v[80:87], v3
  s_waitcnt vmcnt(8)
  v_smfmac_f32_16x16x64_bf16 v[48:51], v[12:15], v[88:95], v3
  s_waitcnt vmcnt(7)
  v_smfmac_f32_16x16x64_bf16 v[48:51], v[16:19], v[96:103], v3
  v_max3_u32 v55, v8, v12, v16
  s_waitcnt vmcnt(6)
  v_smfmac_f32_16x16x64_bf16 v[48:51], v[20:23], v[104:111], v3
  v_max_u32 v55, v55, v20
  v_cmp_eq_u32 vcc, -1, v55
  s_waitcnt vmcnt(5)
  v_smfmac_f32_16x16x64_bf16 v[48:51], v[24:27], v[112:119], v3
  s_waitcnt vmcnt(4)
  v_smfmac_f32_16x16x64_bf16 v[48:51], v[28:31], v[120:127], v3
  s_cbranch_vccnz cA_va1_rv
  buffer_store_dword v163, v7, s[8:11], 0 offen
  s_waitcnt vmcnt(4)
  v_smfmac_f32_16x16x64_bf16 v[48:51], v[32:35], v[128:135], v3
  s_waitcnt vmcnt(3)
  v_smfmac_f32_16x16x64_bf16 v[48:51], v[36:39], v[136:143], v3
  s_waitcnt vmcnt(2) lgkmcnt(0)
  v_smfmac_f32_16x16x64_bf16 v[48:51], v[40:43], v[64:71], v3
  s_waitcnt vmcnt(1)
  v_smfmac_f32_16x16x64_bf16 v[48:51], v[44:47], v[72:79], v3
  s_nop 7
  v_permlane32_swap_b32 v48, v50
  v_permlane32_swap_b32 v49, v51
  v_pk_add_f32 v[48:49], v[48:49], v[50:51]
  v_cvt_pk_bf16_f32 v160, v48, v49
  v_cmp_u_f32 vcc, v48, v49
  s_nop 0
  v_mov_b32_dpp v161, v160 quad_perm:[1,0,3,2] row_mask:0xf bank_mask:0xf
  v_perm_b32 v160, v161, v160, v5
  v_cndmask_b32 v161, v160, v162, vcc
  buffer_store_dword v161, v1, s[8:11], s21 offen
  s_cbranch_vccnz cA_va1_rp
cA_va1_cont:
  s_cmp_lg_u32 s19, 62
  s_cbranch_scc1 cA_va1_nl
  buffer_store_dword v160, v1, s[8:11], s38 offen sc1
  s_mov_b32 s38, 0x40000000
  s_mov_b32 s25, 0x40000000
cA_va1_nl:
  s_add_u32 s25, s25, 458752
  v_mov_b32 v36, 0
  v_mov_b32 v37, 0
  v_mov_b32 v38, 0
  v_mov_b32 v39, 0
  v_mov_b32 v40, 0
  v_mov_b32 v41, 0
  v_mov_b32 v42, 0
  v_mov_b32 v43, 0
  v_mov_b32 v44, 0
  v_mov_b32 v45, 0
  v_mov_b32 v46, 0
  v_mov_b32 v47, 0
  v_mov_b32 v48, 0
  v_mov_b32 v49, 0
  v_mov_b32 v50, 0
  v_mov_b32 v51, 0
  v_mov_b32 v52, 0
  v_mov_b32 v53, 0
  v_mov_b32 v54, 0
  v_mov_b32 v55, 0
  v_mov_b32 v56, 0
  v_mov_b32 v57, 0
  v_mov_b32 v58, 0
  v_mov_b32 v59, 0
  v_mov_b32 v60, 0
  v_mov_b32 v61, 0
  v_mov_b32 v62, 0
  v_mov_b32 v63, 0
  s_mov_b32 s19, s18
  s_add_u32 s18, s18, 1
  s_mov_b32 s22, s20
  s_mov_b32 s20, s21
  s_mov_b32 s21, s22
  s_add_u32 s23, s20, 4096
  s_branch cA_va1_loop
cA_va1_slow:
  s_waitcnt lgkmcnt(0)
cA_va1_sl1:
  s_add_u32 s31, s31, 0x1000000
  buffer_load_dwordx4 v[8:11], v2, s[8:11], s20 offen offset:0 sc1
  buffer_load_dwordx4 v[12:15], v2, s[8:11], s20 offen offset:1024 sc1
  buffer_load_dwordx4 v[16:19], v2, s[8:11], s20 offen offset:2048 sc1
  buffer_load_dwordx4 v[20:23], v2, s[8:11], s20 offen offset:3072 sc1
  buffer_load_dwordx4 v[24:27], v2, s[8:11], s23 offen offset:0 sc1
  buffer_load_dwordx4 v[28:31], v2, s[8:11], s23 offen offset:1024 sc1
  buffer_load_dwordx4 v[32:35], v2, s[8:11], s23 offen offset:2048 sc1
  s_waitcnt vmcnt(0)
  v_max3_u32 v36, v8, v9, v10
  v_max3_u32 v36, v36, v11, v12
  v_max3_u32 v36, v36, v13, v14
  v_max3_u32 v36, v36, v15, v16
  v_max3_u32 v36, v36, v17, v18
  v_max3_u32 v36, v36, v19, v20
  v_max3_u32 v36, v36, v21, v22
  v_max3_u32 v36, v36, v23, v24
  v_max3_u32 v36, v36, v25, v26
  v_max3_u32 v36, v36, v27, v28
  v_max3_u32 v36, v36, v29, v30
  v_max3_u32 v36, v36, v31, v32
  v_max3_u32 v36, v36, v33, v34
  v_max_u32 v36, v36, v35
  v_cmp_eq_u32 vcc, -1, v36
  s_cbranch_vccz cA_va1_sl2
  s_add_u32 s30, s30, 1
  s_cmp_lt_u32 s30, 400000
  s_cbranch_scc1 cA_va1_sl1
  s_branch cA_abort
cA_va1_sl2:
  v_mov_b32 v36, 0
  v_mov_b32 v37, 0
  v_mov_b32 v38, 0
  v_mov_b32 v39, 0
  v_mov_b32 v40, 0
  v_mov_b32 v41, 0
  v_mov_b32 v42, 0
  v_mov_b32 v43, 0
  v_mov_b32 v44, 0
  v_mov_b32 v45, 0
  v_mov_b32 v46, 0
  v_mov_b32 v47, 0
  v_mov_b32 v48, 0
  v_mov_b32 v49, 0
  v_mov_b32 v50, 0
  v_mov_b32 v51, 0
  v_mov_b32 v52, 0
  v_mov_b32 v53, 0
  v_mov_b32 v54, 0
  v_mov_b32 v55, 0
  v_mov_b32 v56, 0
  v_mov_b32 v57, 0
  v_mov_b32 v58, 0
  v_mov_b32 v59, 0
  v_mov_b32 v60, 0
  v_mov_b32 v61, 0
  v_mov_b32 v62, 0
  v_mov_b32 v63, 0
  buffer_store_dword v162, v1, s[8:11], s21 offen
  ds_read_b128 v[64:67], v0 offset:0
  ds_read_b128 v[68:71], v0 offset:1024
  v_smfmac_f32_16x16x64_bf16 v[36:39], v[8:11], a[0:7], v3
  v_smfmac_f32_16x16x64_bf16 v[40:43], v[8:11], a[56:63], v3
  v_smfmac_f32_16x16x64_bf16 v[44:47], v[8:11], a[112:119], v3
  v_smfmac_f32_16x16x64_bf16 v[48:51], v[8:11], a[168:175], v3
  v_smfmac_f32_16x16x64_bf16 v[52:55], v[8:11], a[224:231], v3
  v_smfmac_f32_16x16x64_bf16 v[56:59], v[8:11], v[200:207], v3
  s_waitcnt lgkmcnt(0)
  v_smfmac_f32_16x16x64_bf16 v[60:63], v[8:11], v[64:71], v3
  ds_read_b128 v[72:75], v0 offset:2048
  ds_read_b128 v[76:79], v0 offset:3072
  v_smfmac_f32_16x16x64_bf16 v[36:39], v[12:15], a[8:15], v3
  v_smfmac_f32_16x16x64_bf16 v[40:43], v[12:15], a[64:71], v3
  v_smfmac_f32_16x16x64_bf16 v[44:47], v[12:15], a[120:127], v3
  v_smfmac_f32_16x16x64_bf16 v[48:51], v[12:15], a[176:183], v3
  v_smfmac_f32_16x16x64_bf16 v[52:55], v[12:15], a[232:239], v3
  v_smfmac_f32_16x16x64_bf16 v[56:59], v[12:15], v[208:215], v3
  s_waitcnt lgkmcnt(0)
  v_smfmac_f32_16x16x64_bf16 v[60:63], v[12:15], v[72:79], v3
  ds_read_b128 v[144:147], v0 offset:4096
  ds_read_b128 v[148:151], v0 offset:5120
  v_smfmac_f32_16x16x64_bf16 v[36:39], v[16:19], a[16:23], v3
  v_smfmac_f32_16x16x64_bf16 v[40:43], v[16:19], a[72:79], v3
  v_smfmac_f32_16x16x64_bf16 v[44:47], v[16:19], a[128:135], v3
  v_smfmac_f32_16x16x64_bf16 v[48:51], v[16:19], a[184:191], v3
  v_smfmac_f32_16x16x64_bf16 v[52:55], v[16:19], a[240:247], v3
  v_smfmac_f32_16x16x64_bf16 v[56:59], v[16:19], v[216:223], v3
  s_waitcnt lgkmcnt(0)
  v_smfmac_f32_16x16x64_bf16 v[60:63], v[16:19], v[144:151], v3
  ds_read_b128 v[64:67], v0 offset:6144
  ds_read_b128 v[68:71], v0 offset:7168
  v_smfmac_f32_16x16x64_bf16 v[36:39], v[20:23], a[24:31], v3
  v_smfmac_f32_16x16x64_bf16 v[40:43], v[20:23], a[80:87], v3
  v_smfmac_f32_16x16x64_bf16 v[44:47], v[20:23], a[136:143], v3
  v_smfmac_f32_16x16x64_bf16 v[48:51], v[20:23], a[192:199], v3
  v_smfmac_f32_16x16x64_bf16 v[52:55], v[20:23], a[248:255], v3
  v_smfmac_f32_16x16x64_bf16 v[56:59], v[20:23], v[224:231], v3
  s_waitcnt lgkmcnt(0)
  v_smfmac_f32_16x16x64_bf16 v[60:63], v[20:23], v[64:71], v3
  ds_read_b128 v[72:75], v0 offset:8192
  ds_read_b128 v[76:79], v0 offset:9216
  v_smfmac_f32_16x16x64_bf16 v[36:39], v[24:27], a[32:39], v3
  v_smfmac_f32_16x16x64_bf16 v[40:43], v[24:27], a[88:95], v3
  v_smfmac_f32_16x16x64_bf16 v[44:47], v[24:27], a[144:151], v3
  v_smfmac_f32_16x16x64_bf16 v[48:51], v[24:27], a[200:207], v3
  v_smfmac_f32_16x16x64_bf16 v[52:55], v[24:27], v[176:183], v3
  v_smfmac_f32_16x16x64_bf16 v[56:59], v[24:27], v[232:239], v3
  s_waitcnt lgkmcnt(0)
  v_smfmac_f32_16x16x64_bf16 v[60:63], v[24:27], v[72:79], v3
  ds_read_b128 v[144:147], v0 offset:10240
  ds_read_b128 v[148:151], v0 offset:11264
  v_smfmac_f32_16x16x64_bf16 v[36:39], v[28:31], a[40:47], v3
  v_smfmac_f32_16x16x64_bf16 v[40:43], v[28:31], a[96:103], v3
  v_smfmac_f32_16x16x64_bf16 v[44:47], v[28:31], a[152:159], v3
  v_smfmac_f32_16x16x64_bf16 v[48:51], v[28:31], a[208:215], v3
  v_smfmac_f32_16x16x64_bf16 v[52:55], v[28:31], v[184:191], v3
  v_smfmac_f32_16x16x64_bf16 v[56:59], v[28:31], v[240:247], v3
  s_waitcnt lgkmcnt(0)
  v_smfmac_f32_16x16x64_bf16 v[60:63], v[28:31], v[144:151], v3
  ds_read_b128 v[64:67], v0 offset:12288
  ds_read_b128 v[68:71], v0 offset:13312
  v_smfmac_f32_16x16x64_bf16 v[36:39], v[32:35], a[48:55], v3
  v_smfmac_f32_16x16x64_bf16 v[40:43], v[32:35], a[104:111], v3
  v_smfmac_f32_16x16x64_bf16 v[44:47], v[32:35], a[160:167], v3
  v_smfmac_f32_16x16x64_bf16 v[48:51], v[32:35], a[216:223], v3
  v_smfmac_f32_16x16x64_bf16 v[52:55], v[32:35], v[192:199], v3
  v_smfmac_f32_16x16x64_bf16 v[56:59], v[32:35], v[248:255], v3
  s_waitcnt lgkmcnt(0)
  v_smfmac_f32_16x16x64_bf16 v[60:63], v[32:35], v[64:71], v3
  v_permlane32_swap_b32 v36, v38
  v_permlane32_swap_b32 v37, v39
  v_add_f32 v36, v36, v38
  v_add_f32 v37, v37, v39
  v_cvt_pk_bf16_f32 v38, v36, v37
  ds_write_b32 v152, v38
  v_permlane32_swap_b32 v40, v42
  v_permlane32_swap_b32 v41, v43
  v_add_f32 v40, v40, v42
  v_add_f32 v41, v41, v43
  v_cvt_pk_bf16_f32 v42, v40, v41
  ds_write_b32 v153, v42
  v_permlane32_swap_b32 v44, v46
  v_permlane32_swap_b32 v45, v47
  v_add_f32 v44, v44, v46
  v_add_f32 v45, v45, v47
  v_cvt_pk_bf16_f32 v46, v44, v45
  ds_write_b32 v154, v46
  v_permlane32_swap_b32 v48, v50
  v_permlane32_swap_b32 v49, v51
  v_add_f32 v48, v48, v50
  v_add_f32 v49, v49, v51
  v_cvt_pk_bf16_f32 v50, v48, v49
  ds_write_b32 v155, v50
  v_permlane32_swap_b32 v52, v54
  v_permlane32_swap_b32 v53, v55
  v_add_f32 v52, v52, v54
  v_add_f32 v53, v53, v55
  v_cvt_pk_bf16_f32 v54, v52, v53
  ds_write_b32 v156, v54
  v_permlane32_swap_b32 v56, v58
  v_permlane32_swap_b32 v57, v59
  v_add_f32 v56, v56, v58
  v_add_f32 v57, v57, v59
  v_cvt_pk_bf16_f32 v58, v56, v57
  ds_write_b32 v157, v58
  v_permlane32_swap_b32 v60, v62
  v_permlane32_swap_b32 v61, v63
  v_add_f32 v60, v60, v62
  v_add_f32 v61, v61, v63
  v_cvt_pk_bf16_f32 v62, v60, v61
  ds_write_b32 v158, v62
  s_branch cA_va1_t2d
cA_va1_last:
  s_barrier
  ds_read_b128 v[64:67], v2 offset:4096
  ds_read_b128 v[68:71], v2 offset:5120
  ds_read_b128 v[72:75], v2 offset:6144
  ds_read_b128 v[76:79], v2 offset:7168
  s_waitcnt lgkmcnt(0)
  v_min_u32 v64, -2, v64
  v_min_u32 v65, -2, v65
  v_min_u32 v66, -2, v66
  v_min_u32 v67, -2, v67
  v_min_u32 v68, -2, v68
  v_min_u32 v69, -2, v69
  v_min_u32 v70, -2, v70
  v_min_u32 v71, -2, v71
  v_min_u32 v72, -2, v72
  v_min_u32 v73, -2, v73
  v_min_u32 v74, -2, v74
  v_min_u32 v75, -2, v75
  v_min_u32 v76, -2, v76
  v_min_u32 v77, -2, v77
  v_min_u32 v78, -2, v78
  v_min_u32 v79, -2, v79
  buffer_store_dwordx4 v[64:67], v2, s[8:11], s33 offen offset:0 sc1
  buffer_store_dwordx4 v[68:71], v2, s[8:11], s33 offen offset:2048 sc1
  s_add_u32 s33, s33, 4096
  buffer_store_dwordx4 v[72:75], v2, s[8:11], s33 offen offset:0 sc1
  buffer_store_dwordx4 v[76:79], v2, s[8:11], s33 offen offset:2048 sc1
  s_add_u32 s33, s33, 4096
  s_branch cA_done
cA_va1_rp:
  s_cmp_eq_u32 s37, 0
  s_cbranch_scc1 cA_va1_rv
  v_min_u32 v160, -2, v160
  buffer_store_dword v160, v1, s[8:11], s21 offen
  s_branch cA_va1_cont
cA_va1_rv:
  s_add_u32 s31, s31, 0x10000
  buffer_load_dwordx4 v[8:11], v2, s[8:11], s22 offen offset:0 sc1
  buffer_load_dwordx4 v[12:15], v2, s[8:11], s22 offen offset:1024 sc1
  buffer_load_dwordx4 v[16:19], v2, s[8:11], s22 offen offset:2048 sc1
  buffer_load_dwordx4 v[20:23], v2, s[8:11], s22 offen offset:3072 sc1
  buffer_load_dwordx4 v[24:27], v2, s[8:11], s34 offen offset:0 sc1
  buffer_load_dwordx4 v[28:31], v2, s[8:11], s34 offen offset:1024 sc1
  buffer_load_dwordx4 v[32:35], v2, s[8:11], s34 offen offset:2048 sc1
  buffer_load_dwordx4 v[36:39], v2, s[8:11], s34 offen offset:3072 sc1
  buffer_load_dwordx4 v[40:43], v2, s[8:11], s36 offen offset:0 sc1
  buffer_load_dwordx4 v[44:47], v2, s[8:11], s36 offen offset:1024 sc1
  s_waitcnt vmcnt(0)
  v_max3_u32 v52, v8, v9, v10
  v_max3_u32 v52, v52, v11, v12
  v_max3_u32 v52, v52, v13, v14
  v_max3_u32 v52, v52, v15, v16
  v_max3_u32 v52, v52, v17, v18
  v_max3_u32 v52, v52, v19, v20
  v_max3_u32 v52, v52, v21, v22
  v_max3_u32 v52, v52, v23, v24
  v_max3_u32 v52, v52, v25, v26
  v_max3_u32 v52, v52, v27, v28
  v_max3_u32 v52, v52, v29, v30
  v_max3_u32 v52, v52, v31, v32
  v_max3_u32 v52, v52, v33, v34
  v_max3_u32 v52, v52, v35, v36
  v_max3_u32 v52, v52, v37, v38
  v_max3_u32 v52, v52, v39, v40
  v_max3_u32 v52, v52, v41, v42
  v_max3_u32 v52, v52, v43, v44
  v_max3_u32 v52, v52, v45, v46
  v_max_u32 v52, v52, v47
  v_cmp_eq_u32 vcc, -1, v52
  s_mov_b32 s37, 1
  v_mov_b32 v48, 0
  v_mov_b32 v49, 0
  v_mov_b32 v50, 0
  v_mov_b32 v51, 0
  s_nop 1
  s_cbranch_vccz cA_va1_lp
  s_add_u32 s30, s30, 1
  s_cmp_lt_u32 s30, 400000
  s_cbranch_scc1 cA_va1_rv
  s_branch cA_abort
.p2align 6
cA_va2_loop:
  s_mov_b32 s30, 0
cA_va2_fp_l:
  v_cmp_gt_u32 vcc, s19, v96
  buffer_load_dword v96, v119, s[8:11], 0 offen sc1
  s_cbranch_vccz cA_va2_fp_d
  v_cmp_gt_u32 vcc, s19, v96
  buffer_load_dword v96, v119, s[8:11], 0 offen sc1
  s_cbranch_vccz cA_va2_fp_d
  v_cmp_gt_u32 vcc, s19, v96
  buffer_load_dword v96, v119, s[8:11], 0 offen sc1
  s_cbranch_vccz cA_va2_fp_d
  v_cmp_gt_u32 vcc, s19, v96
  buffer_load_dword v96, v119, s[8:11], 0 offen sc1
  s_cbranch_vccz cA_va2_fp_d
  v_cmp_gt_u32 vcc, s19, v96
  buffer_load_dword v96, v119, s[8:11], 0 offen sc1
  s_cbranch_vccz cA_va2_fp_d
  v_cmp_gt_u32 vcc, s19, v96
  buffer_load_dword v96, v119, s[8:11], 0 offen sc1
  s_cbranch_vccz cA_va2_fp_d
  v_cmp_gt_u32 vcc, s19, v96
  buffer_load_dword v96, v119, s[8:11], 0 offen sc1
  s_cbranch_vccz cA_va2_fp_d
  v_cmp_gt_u32 vcc, s19, v96
  buffer_load_dword v96, v119, s[8:11], 0 offen sc1
  s_cbranch_vccz cA_va2_fp_d
  v_cmp_gt_u32 vcc, s19, v96
  buffer_load_dword v96, v119, s[8:11], 0 offen sc1
  s_cbranch_vccz cA_va2_fp_d
  v_cmp_gt_u32 vcc, s19, v96
  buffer_load_dword v96, v119, s[8:11], 0 offen sc1
  s_cbranch_vccz cA_va2_fp_d
  v_cmp_gt_u32 vcc, s19, v96
  buffer_load_dword v96, v119, s[8:11], 0 offen sc1
  s_cbranch_vccz cA_va2_fp_d
  v_cmp_gt_u32 vcc, s19, v96
  buffer_load_dword v96, v119, s[8:11], 0 offen sc1
  s_cbranch_vccz cA_va2_fp_d
  v_cmp_gt_u32 vcc, s19, v96
  buffer_load_dword v96, v119, s[8:11], 0 offen sc1
  s_cbranch_vccz cA_va2_fp_d
  v_cmp_gt_u32 vcc, s19, v96
  buffer_load_dword v96, v119, s[8:11], 0 offen sc1
  s_cbranch_vccz cA_va2_fp_d
  v_cmp_gt_u32 vcc, s19, v96
  buffer_load_dword v96, v119, s[8:11], 0 offen sc1
  s_cbranch_vccz cA_va2_fp_d
  v_cmp_gt_u32 vcc, s19, v96
  buffer_load_dword v96, v119, s[8:11], 0 offen sc1
  s_cbranch_vccz cA_va2_fp_d
  s_waitcnt vmcnt(24)
  s_add_u32 s30, s30, 1
  s_cmp_lt_u32 s30, 400000
  s_cbranch_scc1 cA_va2_fp_l
  s_branch cA_abort
cA_va2_fp_d:
  buffer_load_dwordx4 v[8:11], v2, s[8:11], s20 offen offset:0 sc1
  buffer_load_dwordx4 v[12:15], v2, s[8:11], s20 offen offset:1024 sc1
  s_barrier
  s_barrier
  s_waitcnt vmcnt(0)
  ds_write_b128 v2, v[8:11] offset:8192
  ds_write_b128 v2, v[12:15] offset:9216
  v_smfmac_f32_16x16x64_bf16 v[36:39], v[8:11], a[0:7], v3
  v_smfmac_f32_16x16x64_bf16 v[40:43], v[8:11], a[56:63], v3
  v_smfmac_f32_16x16x64_bf16 v[44:47], v[8:11], a[112:119], v3
  v_smfmac_f32_16x16x64_bf16 v[48:51], v[8:11], a[168:175], v3
  v_smfmac_f32_16x16x64_bf16 v[52:55], v[8:11], a[224:231], v3
  s_waitcnt lgkmcnt(0)
  s_barrier
  ds_read_b128 v[16:19], v2 offset:10240
  ds_read_b128 v[20:23], v2 offset:11264
  ds_read_b128 v[24:27], v2 offset:12288
  ds_read_b128 v[28:31], v2 offset:13312
  ds_read_b128 v[32:35], v2 offset:14336
  v_smfmac_f32_16x16x64_bf16 v[56:59], v[8:11], v[144:151], v3
  v_smfmac_f32_16x16x64_bf16 v[60:63], v[8:11], v[200:207], v3
  v_smfmac_f32_16x16x64_bf16 v[36:39], v[12:15], a[8:15], v3
  v_smfmac_f32_16x16x64_bf16 v[40:43], v[12:15], a[64:71], v3
  v_smfmac_f32_16x16x64_bf16 v[44:47], v[12:15], a[120:127], v3
  v_smfmac_f32_16x16x64_bf16 v[48:51], v[12:15], a[176:183], v3
  v_smfmac_f32_16x16x64_bf16 v[52:55], v[12:15], a[232:239], v3
  v_smfmac_f32_16x16x64_bf16 v[56:59], v[12:15], v[152:159], v3
  ds_read_b128 v[68:71], v0 offset:0
  ds_read_b128 v[72:75], v0 offset:1024
  v_smfmac_f32_16x16x64_bf16 v[60:63], v[12:15], v[208:215], v3
  s_waitcnt lgkmcnt(6)
  ds_read_b128 v[76:79], v0 offset:2048
  ds_read_b128 v[80:83], v0 offset:3072
  v_smfmac_f32_16x16x64_bf16 v[36:39], v[16:19], a[16:23], v3
  s_waitcnt lgkmcnt(7)
  v_smfmac_f32_16x16x64_bf16 v[36:39], v[20:23], a[24:31], v3
  s_waitcnt lgkmcnt(6)
  v_smfmac_f32_16x16x64_bf16 v[36:39], v[24:27], a[32:39], v3
  s_waitcnt lgkmcnt(2)
  v_smfmac_f32_16x16x64_bf16 v[64:67], v[8:11], v[68:75], v3
  s_waitcnt lgkmcnt(5)
  ds_read_b128 v[84:87], v0 offset:4096
  ds_read_b128 v[88:91], v0 offset:5120
  v_smfmac_f32_16x16x64_bf16 v[36:39], v[28:31], a[40:47], v3
  s_waitcnt lgkmcnt(6)
  v_smfmac_f32_16x16x64_bf16 v[36:39], v[32:35], a[48:55], v3
  v_smfmac_f32_16x16x64_bf16 v[40:43], v[16:19], a[72:79], v3
  s_waitcnt lgkmcnt(2)
  v_smfmac_f32_16x16x64_bf16 v[64:67], v[12:15], v[76:83], v3
  ds_read_b128 v[68:71], v0 offset:6144
  ds_read_b128 v[72:75], v0 offset:7168
  v_smfmac_f32_16x16x64_bf16 v[40:43], v[20:23], a[80:87], v3
  v_permlane32_swap_b32 v36, v38
  v_smfmac_f32_16x16x64_bf16 v[40:43], v[24:27], a[88:95], v3
  v_permlane32_swap_b32 v37, v39
  v_smfmac_f32_16x16x64_bf16 v[40:43], v[28:31], a[96:103], v3
  s_waitcnt lgkmcnt(2)
  v_add_f32 v36, v36, v38
  v_smfmac_f32_16x16x64_bf16 v[64:67], v[16:19], v[84:91], v3
  ds_read_b128 v[76:79], v0 offset:8192
  ds_read_b128 v[80:83], v0 offset:9216
  v_add_f32 v37, v37, v39
  v_smfmac_f32_16x16x64_bf16 v[40:43], v[32:35], a[104:111], v3
  v_cmp_u_f32 vcc, v36, v37
  v_smfmac_f32_16x16x64_bf16 v[44:47], v[16:19], a[128:135], v3
  v_cvt_pk_bf16_f32 v38, v36, v37
  v_smfmac_f32_16x16x64_bf16 v[44:47], v[20:23], a[136:143], v3
  ds_write_b32 v104, v38
  s_waitcnt lgkmcnt(3)
  s_cbranch_vccnz cA_va2_slow
  v_permlane32_swap_b32 v40, v42
  v_smfmac_f32_16x16x64_bf16 v[64:67], v[20:23], v[68:75], v3
  ds_read_b128 v[84:87], v0 offset:10240
  ds_read_b128 v[88:91], v0 offset:11264
  v_permlane32_swap_b32 v41, v43
  v_smfmac_f32_16x16x64_bf16 v[44:47], v[24:27], a[144:151], v3
  v_add_f32 v40, v40, v42
  v_smfmac_f32_16x16x64_bf16 v[44:47], v[28:31], a[152:159], v3
  v_add_f32 v41, v41, v43
  v_smfmac_f32_16x16x64_bf16 v[44:47], v[32:35], a[160:167], v3
  s_waitcnt lgkmcnt(3)
  v_cvt_pk_bf16_f32 v42, v40, v41
  v_smfmac_f32_16x16x64_bf16 v[64:67], v[24:27], v[76:83], v3
  ds_write_b32 v105, v42
  ds_read_b128 v[68:71], v0 offset:12288
  ds_read_b128 v[72:75], v0 offset:13312
  v_smfmac_f32_16x16x64_bf16 v[48:51], v[16:19], a[184:191], v3
  s_nop 0
  v_permlane32_swap_b32 v44, v46
  v_smfmac_f32_16x16x64_bf16 v[48:51], v[20:23], a[192:199], v3
  v_permlane32_swap_b32 v45, v47
  v_smfmac_f32_16x16x64_bf16 v[48:51], v[24:27], a[200:207], v3
  s_waitcnt lgkmcnt(3)
  v_add_f32 v44, v44, v46
  v_smfmac_f32_16x16x64_bf16 v[64:67], v[28:31], v[84:91], v3
  v_add_f32 v45, v45, v47
  v_smfmac_f32_16x16x64_bf16 v[48:51], v[28:31], a[208:215], v3
  v_cvt_pk_bf16_f32 v46, v44, v45
  v_smfmac_f32_16x16x64_bf16 v[48:51], v[32:35], a[216:223], v3
  ds_write_b32 v106, v46
  v_smfmac_f32_16x16x64_bf16 v[52:55], v[16:19], a[240:247], v3
  s_waitcnt lgkmcnt(1)
  v_smfmac_f32_16x16x64_bf16 v[64:67], v[32:35], v[68:75], v3
  v_smfmac_f32_16x16x64_bf16 v[52:55], v[20:23], a[248:255], v3
  v_permlane32_swap_b32 v48, v50
  v_smfmac_f32_16x16x64_bf16 v[52:55], v[24:27], v[120:127], v3
  v_permlane32_swap_b32 v49, v51
  v_smfmac_f32_16x16x64_bf16 v[52:55], v[28:31], v[128:135], v3
  v_add_f32 v48, v48, v50
  v_smfmac_f32_16x16x64_bf16 v[52:55], v[32:35], v[136:143], v3
  v_add_f32 v49, v49, v51
  v_smfmac_f32_16x16x64_bf16 v[56:59], v[16:19], v[160:167], v3
  v_cvt_pk_bf16_f32 v50, v48, v49
  v_smfmac_f32_16x16x64_bf16 v[56:59], v[20:23], v[168:175], v3
  ds_write_b32 v107, v50
  v_permlane32_swap_b32 v64, v66
  v_smfmac_f32_16x16x64_bf16 v[56:59], v[24:27], v[176:183], v3
  v_permlane32_swap_b32 v65, v67
  v_smfmac_f32_16x16x64_bf16 v[56:59], v[28:31], v[184:191], v3
  v_add_f32 v64, v64, v66
  v_smfmac_f32_16x16x64_bf16 v[56:59], v[32:35], v[192:199], v3
  v_add_f32 v65, v65, v67
  v_smfmac_f32_16x16x64_bf16 v[60:63], v[16:19], v[216:223], v3
  v_cvt_pk_bf16_f32 v66, v64, v65
  v_smfmac_f32_16x16x64_bf16 v[60:63], v[20:23], v[224:231], v3
  ds_write_b32 v111, v66
  v_permlane32_swap_b32 v52, v54
  v_smfmac_f32_16x16x64_bf16 v[60:63], v[24:27], v[232:239], v3
  v_permlane32_swap_b32 v53, v55
  v_smfmac_f32_16x16x64_bf16 v[60:63], v[28:31], v[240:247], v3
  v_add_f32 v52, v52, v54
  v_smfmac_f32_16x16x64_bf16 v[60:63], v[32:35], v[248:255], v3
  v_add_f32 v53, v53, v55
  v_cvt_pk_bf16_f32 v54, v52, v53
  ds_write_b32 v108, v54
  v_permlane32_swap_b32 v56, v58
  v_permlane32_swap_b32 v57, v59
  v_add_f32 v56, v56, v58
  v_add_f32 v57, v57, v59
  v_cvt_pk_bf16_f32 v58, v56, v57
  ds_write_b32 v109, v58
  v_permlane32_swap_b32 v60, v62
  v_permlane32_swap_b32 v61, v63
  v_add_f32 v60, v60, v62
  v_add_f32 v61, v61, v63
  v_cvt_pk_bf16_f32 v62, v60, v61
  ds_write_b32 v110, v62
cA_va2_t2d:
  v_mov_b32 v117, s18
  s_waitcnt lgkmcnt(0)
  s_barrier
  s_cmp_eq_u32 s19, 63
  s_cbranch_scc1 cA_done
  s_sleep 1
  v_mov_b32 v36, 0
  v_mov_b32 v37, 0
  v_mov_b32 v38, 0
  v_mov_b32 v39, 0
  v_mov_b32 v40, 0
  v_mov_b32 v41, 0
  v_mov_b32 v42, 0
  v_mov_b32 v43, 0
  v_mov_b32 v44, 0
  v_mov_b32 v45, 0
  v_mov_b32 v46, 0
  v_mov_b32 v47, 0
  v_mov_b32 v48, 0
  v_mov_b32 v49, 0
  v_mov_b32 v50, 0
  v_mov_b32 v51, 0
  v_mov_b32 v52, 0
  v_mov_b32 v53, 0
  v_mov_b32 v54, 0
  v_mov_b32 v55, 0
  v_mov_b32 v56, 0
  v_mov_b32 v57, 0
  v_mov_b32 v58, 0
  v_mov_b32 v59, 0
  v_mov_b32 v60, 0
  v_mov_b32 v61, 0
  v_mov_b32 v62, 0
  v_mov_b32 v63, 0
  v_mov_b32 v64, 0
  v_mov_b32 v65, 0
  v_mov_b32 v66, 0
  v_mov_b32 v67, 0
  s_sleep 5
  s_mov_b32 s19, s18
  s_add_u32 s18, s18, 1
  s_mov_b32 s22, s20
  s_mov_b32 s20, s21
  s_mov_b32 s21, s22
  s_add_u32 s23, s20, 4096
  s_branch cA_va2_loop
cA_va2_slow:
  s_waitcnt lgkmcnt(0)
cA_va2_sl1:
  s_add_u32 s31, s31, 0x1000000
  buffer_load_dwordx4 v[8:11], v2, s[8:11], s20 offen offset:0 sc1
  buffer_load_dwordx4 v[12:15], v2, s[8:11], s20 offen offset:1024 sc1
  buffer_load_dwordx4 v[16:19], v2, s[8:11], s20 offen offset:2048 sc1
  buffer_load_dwordx4 v[20:23], v2, s[8:11], s20 offen offset:3072 sc1
  buffer_load_dwordx4 v[24:27], v2, s[8:11], s23 offen offset:0 sc1
  buffer_load_dwordx4 v[28:31], v2, s[8:11], s23 offen offset:1024 sc1
  buffer_load_dwordx4 v[32:35], v2, s[8:11], s23 offen offset:2048 sc1
  s_waitcnt vmcnt(0)
  v_max3_u32 v36, v8, v9, v10
  v_max3_u32 v36, v36, v11, v12
  v_max3_u32 v36, v36, v13, v14
  v_max3_u32 v36, v36, v15, v16
  v_max3_u32 v36, v36, v17, v18
  v_max3_u32 v36, v36, v19, v20
  v_max3_u32 v36, v36, v21, v22
  v_max3_u32 v36, v36, v23, v24
  v_max3_u32 v36, v36, v25, v26
  v_max3_u32 v36, v36, v27, v28
  v_max3_u32 v36, v36, v29, v30
  v_max3_u32 v36, v36, v31, v32
  v_max3_u32 v36, v36, v33, v34
  v_max_u32 v36, v36, v35
  v_cmp_eq_u32 vcc, -1, v36
  s_cbranch_vccz cA_va2_sl2
  s_add_u32 s30, s30, 1
  s_cmp_lt_u32 s30, 400000
  s_cbranch_scc1 cA_va2_sl1
  s_branch cA_abort
cA_va2_sl2:
  v_mov_b32 v36, 0
  v_mov_b32 v37, 0
  v_mov_b32 v38, 0
  v_mov_b32 v39, 0
  v_mov_b32 v40, 0
  v_mov_b32 v41, 0
  v_mov_b32 v42, 0
  v_mov_b32 v43, 0
  v_mov_b32 v44, 0
  v_mov_b32 v45, 0
  v_mov_b32 v46, 0
  v_mov_b32 v47, 0
  v_mov_b32 v48, 0
  v_mov_b32 v49, 0
  v_mov_b32 v50, 0
  v_mov_b32 v51, 0
  v_mov_b32 v52, 0
  v_mov_b32 v53, 0
  v_mov_b32 v54, 0
  v_mov_b32 v55, 0
  v_mov_b32 v56, 0
  v_mov_b32 v57, 0
  v_mov_b32 v58, 0
  v_mov_b32 v59, 0
  v_mov_b32 v60, 0
  v_mov_b32 v61, 0
  v_mov_b32 v62, 0
  v_mov_b32 v63, 0
  v_mov_b32 v64, 0
  v_mov_b32 v65, 0
  v_mov_b32 v66, 0
  v_mov_b32 v67, 0
  ds_read_b128 v[68:71], v0 offset:0
  ds_read_b128 v[72:75], v0 offset:1024
  v_smfmac_f32_16x16x64_bf16 v[36:39], v[8:11], a[0:7], v3
  v_smfmac_f32_16x16x64_bf16 v[40:43], v[8:11], a[56:63], v3
  v_smfmac_f32_16x16x64_bf16 v[44:47], v[8:11], a[112:119], v3
  v_smfmac_f32_16x16x64_bf16 v[48:51], v[8:11], a[168:175], v3
  v_smfmac_f32_16x16x64_bf16 v[52:55], v[8:11], a[224:231], v3
  v_smfmac_f32_16x16x64_bf16 v[56:59], v[8:11], v[144:151], v3
  v_smfmac_f32_16x16x64_bf16 v[60:63], v[8:11], v[200:207], v3
  s_waitcnt lgkmcnt(0)
  v_smfmac_f32_16x16x64_bf16 v[64:67], v[8:11], v[68:75], v3
  ds_read_b128 v[76:79], v0 offset:2048
  ds_read_b128 v[80:83], v0 offset:3072
  v_smfmac_f32_16x16x64_bf16 v[36:39], v[12:15], a[8:15], v3
  v_smfmac_f32_16x16x64_bf16 v[40:43], v[12:15], a[64:71], v3
  v_smfmac_f32_16x16x64_bf16 v[44:47], v[12:15], a[120:127], v3
  v_smfmac_f32_16x16x64_bf16 v[48:51], v[12:15], a[176:183], v3
  v_smfmac_f32_16x16x64_bf16 v[52:55], v[12:15], a[232:239], v3
  v_smfmac_f32_16x16x64_bf16 v[56:59], v[12:15], v[152:159], v3
  v_smfmac_f32_16x16x64_bf16 v[60:63], v[12:15], v[208:215], v3
  s_waitcnt lgkmcnt(0)
  v_smfmac_f32_16x16x64_bf16 v[64:67], v[12:15], v[76:83], v3
  ds_read_b128 v[84:87], v0 offset:4096
  ds_read_b128 v[88:91], v0 offset:5120
  v_smfmac_f32_16x16x64_bf16 v[36:39], v[16:19], a[16:23], v3
  v_smfmac_f32_16x16x64_bf16 v[40:43], v[16:19], a[72:79], v3
  v_smfmac_f32_16x16x64_bf16 v[44:47], v[16:19], a[128:135], v3
  v_smfmac_f32_16x16x64_bf16 v[48:51], v[16:19], a[184:191], v3
  v_smfmac_f32_16x16x64_bf16 v[52:55], v[16:19], a[240:247], v3
  v_smfmac_f32_16x16x64_bf16 v[56:59], v[16:19], v[160:167], v3
  v_smfmac_f32_16x16x64_bf16 v[60:63], v[16:19], v[216:223], v3
  s_waitcnt lgkmcnt(0)
  v_smfmac_f32_16x16x64_bf16 v[64:67], v[16:19], v[84:91], v3
  ds_read_b128 v[68:71], v0 offset:6144
  ds_read_b128 v[72:75], v0 offset:7168
  v_smfmac_f32_16x16x64_bf16 v[36:39], v[20:23], a[24:31], v3
  v_smfmac_f32_16x16x64_bf16 v[40:43], v[20:23], a[80:87], v3
  v_smfmac_f32_16x16x64_bf16 v[44:47], v[20:23], a[136:143], v3
  v_smfmac_f32_16x16x64_bf16 v[48:51], v[20:23], a[192:199], v3
  v_smfmac_f32_16x16x64_bf16 v[52:55], v[20:23], a[248:255], v3
  v_smfmac_f32_16x16x64_bf16 v[56:59], v[20:23], v[168:175], v3
  v_smfmac_f32_16x16x64_bf16 v[60:63], v[20:23], v[224:231], v3
  s_waitcnt lgkmcnt(0)
  v_smfmac_f32_16x16x64_bf16 v[64:67], v[20:23], v[68:75], v3
  ds_read_b128 v[76:79], v0 offset:8192
  ds_read_b128 v[80:83], v0 offset:9216
  v_smfmac_f32_16x16x64_bf16 v[36:39], v[24:27], a[32:39], v3
  v_smfmac_f32_16x16x64_bf16 v[40:43], v[24:27], a[88:95], v3
  v_smfmac_f32_16x16x64_bf16 v[44:47], v[24:27], a[144:151], v3
  v_smfmac_f32_16x16x64_bf16 v[48:51], v[24:27], a[200:207], v3
  v_smfmac_f32_16x16x64_bf16 v[52:55], v[24:27], v[120:127], v3
  v_smfmac_f32_16x16x64_bf16 v[56:59], v[24:27], v[176:183], v3
  v_smfmac_f32_16x16x64_bf16 v[60:63], v[24:27], v[232:239], v3
  s_waitcnt lgkmcnt(0)
  v_smfmac_f32_16x16x64_bf16 v[64:67], v[24:27], v[76:83], v3
  ds_read_b128 v[84:87], v0 offset:10240
  ds_read_b128 v[88:91], v0 offset:11264
  v_smfmac_f32_16x16x64_bf16 v[36:39], v[28:31], a[40:47], v3
  v_smfmac_f32_16x16x64_bf16 v[40:43], v[28:31], a[96:103], v3
  v_smfmac_f32_16x16x64_bf16 v[44:47], v[28:31], a[152:159], v3
  v_smfmac_f32_16x16x64_bf16 v[48:51], v[28:31], a[208:215], v3
  v_smfmac_f32_16x16x64_bf16 v[52:55], v[28:31], v[128:135], v3
  v_smfmac_f32_16x16x64_bf16 v[56:59], v[28:31], v[184:191], v3
  v_smfmac_f32_16x16x64_bf16 v[60:63], v[28:31], v[240:247], v3
  s_waitcnt lgkmcnt(0)
  v_smfmac_f32_16x16x64_bf16 v[64:67], v[28:31], v[84:91], v3
  ds_read_b128 v[68:71], v0 offset:12288
  ds_read_b128 v[72:75], v0 offset:13312
  v_smfmac_f32_16x16x64_bf16 v[36:39], v[32:35], a[48:55], v3
  v_smfmac_f32_16x16x64_bf16 v[40:43], v[32:35], a[104:111], v3
  v_smfmac_f32_16x16x64_bf16 v[44:47], v[32:35], a[160:167], v3
  v_smfmac_f32_16x16x64_bf16 v[48:51], v[32:35], a[216:223], v3
  v_smfmac_f32_16x16x64_bf16 v[52:55], v[32:35], v[136:143], v3
  v_smfmac_f32_16x16x64_bf16 v[56:59], v[32:35], v[192:199], v3
  v_smfmac_f32_16x16x64_bf16 v[60:63], v[32:35], v[248:255], v3
  s_waitcnt lgkmcnt(0)
  v_smfmac_f32_16x16x64_bf16 v[64:67], v[32:35], v[68:75], v3
  v_permlane32_swap_b32 v36, v38
  v_permlane32_swap_b32 v37, v39
  v_add_f32 v36, v36, v38
  v_add_f32 v37, v37, v39
  v_cvt_pk_bf16_f32 v38, v36, v37
  ds_write_b32 v104, v38
  v_permlane32_swap_b32 v40, v42
  v_permlane32_swap_b32 v41, v43
  v_add_f32 v40, v40, v42
  v_add_f32 v41, v41, v43
  v_cvt_pk_bf16_f32 v42, v40, v41
  ds_write_b32 v105, v42
  v_permlane32_swap_b32 v44, v46
  v_permlane32_swap_b32 v45, v47
  v_add_f32 v44, v44, v46
  v_add_f32 v45, v45, v47
  v_cvt_pk_bf16_f32 v46, v44, v45
  ds_write_b32 v106, v46
  v_permlane32_swap_b32 v48, v50
  v_permlane32_swap_b32 v49, v51
  v_add_f32 v48, v48, v50
  v_add_f32 v49, v49, v51
  v_cvt_pk_bf16_f32 v50, v48, v49
  ds_write_b32 v107, v50
  v_permlane32_swap_b32 v52, v54
  v_permlane32_swap_b32 v53, v55
  v_add_f32 v52, v52, v54
  v_add_f32 v53, v53, v55
  v_cvt_pk_bf16_f32 v54, v52, v53
  ds_write_b32 v108, v54
  v_permlane32_swap_b32 v56, v58
  v_permlane32_swap_b32 v57, v59
  v_add_f32 v56, v56, v58
  v_add_f32 v57, v57, v59
  v_cvt_pk_bf16_f32 v58, v56, v57
  ds_write_b32 v109, v58
  v_permlane32_swap_b32 v60, v62
  v_permlane32_swap_b32 v61, v63
  v_add_f32 v60, v60, v62
  v_add_f32 v61, v61, v63
  v_cvt_pk_bf16_f32 v62, v60, v61
  ds_write_b32 v110, v62
  v_permlane32_swap_b32 v64, v66
  v_permlane32_swap_b32 v65, v67
  v_add_f32 v64, v64, v66
  v_add_f32 v65, v65, v67
  v_cvt_pk_bf16_f32 v66, v64, v65
  ds_write_b32 v111, v66
  s_branch cA_va2_t2d
.p2align 6
cA_va3_loop:
  s_mov_b32 s30, 0
  s_barrier
  buffer_load_dwordx4 v[16:19], v2, s[8:11], s20 offen offset:2048 sc1
  buffer_load_dwordx4 v[20:23], v2, s[8:11], s20 offen offset:3072 sc1
  s_barrier
  buffer_load_dword v100, v116, s[8:11], s39 offen sc1
  s_add_u32 s27, s19, 2
  s_min_u32 s27, s27, 63
  s_lshr_b32 s27, s27, 3
  s_lshl_b32 s27, s27, 11
  s_add_u32 s27, s27, s35
  s_cmp_eq_u32 s27, s28
  s_cselect_b32 s29, 35328, s27
  buffer_load_dword v101, off, s[8:11], s29 sc1
  s_add_u32 s39, s39, 28672
  s_waitcnt vmcnt(2)
  ds_write_b128 v2, v[16:19] offset:10240
  ds_write_b128 v2, v[20:23] offset:11264
  v_smfmac_f32_16x16x64_bf16 v[36:39], v[16:19], a[16:23], v3
  v_smfmac_f32_16x16x64_bf16 v[40:43], v[16:19], a[72:79], v3
  v_smfmac_f32_16x16x64_bf16 v[44:47], v[16:19], a[128:135], v3
  v_smfmac_f32_16x16x64_bf16 v[48:51], v[16:19], a[184:191], v3
  v_smfmac_f32_16x16x64_bf16 v[52:55], v[16:19], a[240:247], v3
  s_waitcnt lgkmcnt(0)
  s_barrier
  ds_read_b128 v[8:11], v2 offset:8192
  ds_read_b128 v[12:15], v2 offset:9216
  ds_read_b128 v[24:27], v2 offset:12288
  ds_read_b128 v[28:31], v2 offset:13312
  ds_read_b128 v[32:35], v2 offset:14336
  v_smfmac_f32_16x16x64_bf16 v[56:59], v[16:19], v[160:167], v3
  v_smfmac_f32_16x16x64_bf16 v[60:63], v[16:19], v[216:223], v3
  v_smfmac_f32_16x16x64_bf16 v[36:39], v[20:23], a[24:31], v3
  v_smfmac_f32_16x16x64_bf16 v[40:43], v[20:23], a[80:87], v3
  v_smfmac_f32_16x16x64_bf16 v[44:47], v[20:23], a[136:143], v3
  v_smfmac_f32_16x16x64_bf16 v[48:51], v[20:23], a[192:199], v3
  v_smfmac_f32_16x16x64_bf16 v[52:55], v[20:23], a[248:255], v3
  v_smfmac_f32_16x16x64_bf16 v[56:59], v[20:23], v[168:175], v3
  v_smfmac_f32_16x16x64_bf16 v[60:63], v[20:23], v[224:231], v3
  s_waitcnt lgkmcnt(4)
  v_smfmac_f32_16x16x64_bf16 v[36:39], v[8:11], a[0:7], v3
  s_waitcnt lgkmcnt(3)
  v_smfmac_f32_16x16x64_bf16 v[36:39], v[12:15], a[8:15], v3
  s_waitcnt lgkmcnt(2)
  v_smfmac_f32_16x16x64_bf16 v[36:39], v[24:27], a[32:39], v3
  s_waitcnt lgkmcnt(1)
  v_smfmac_f32_16x16x64_bf16 v[36:39], v[28:31], a[40:47], v3
  s_waitcnt lgkmcnt(0)
  v_smfmac_f32_16x16x64_bf16 v[36:39], v[32:35], a[48:55], v3
  v_smfmac_f32_16x16x64_bf16 v[40:43], v[8:11], a[56:63], v3
  v_smfmac_f32_16x16x64_bf16 v[40:43], v[12:15], a[64:71], v3
  v_smfmac_f32_16x16x64_bf16 v[40:43], v[24:27], a[88:95], v3
  v_permlane32_swap_b32 v36, v38
  v_smfmac_f32_16x16x64_bf16 v[40:43], v[28:31], a[96:103], v3
  v_permlane32_swap_b32 v37, v39
  v_smfmac_f32_16x16x64_bf16 v[40:43], v[32:35], a[104:111], v3
  v_add_f32 v36, v36, v38
  v_smfmac_f32_16x16x64_bf16 v[44:47], v[8:11], a[112:119], v3
  v_add_f32 v37, v37, v39
  v_smfmac_f32_16x16x64_bf16 v[44:47], v[12:15], a[120:127], v3
  v_cmp_u_f32 vcc, v36, v37
  v_smfmac_f32_16x16x64_bf16 v[44:47], v[24:27], a[144:151], v3
  v_cvt_pk_bf16_f32 v38, v36, v37
  v_smfmac_f32_16x16x64_bf16 v[44:47], v[28:31], a[152:159], v3
  ds_write_b32 v104, v38
  s_cbranch_vccnz cA_va3_slow
  v_permlane32_swap_b32 v40, v42
  v_smfmac_f32_16x16x64_bf16 v[44:47], v[32:35], a[160:167], v3
  v_permlane32_swap_b32 v41, v43
  v_smfmac_f32_16x16x64_bf16 v[48:51], v[8:11], a[168:175], v3
  v_add_f32 v40, v40, v42
  v_smfmac_f32_16x16x64_bf16 v[48:51], v[12:15], a[176:183], v3
  v_add_f32 v41, v41, v43
  v_smfmac_f32_16x16x64_bf16 v[48:51], v[24:27], a[200:207], v3
  v_cvt_pk_bf16_f32 v42, v40, v41
  v_smfmac_f32_16x16x64_bf16 v[48:51], v[28:31], a[208:215], v3
  ds_write_b32 v105, v42
  v_permlane32_swap_b32 v44, v46
  v_smfmac_f32_16x16x64_bf16 v[48:51], v[32:35], a[216:223], v3
  v_permlane32_swap_b32 v45, v47
  v_smfmac_f32_16x16x64_bf16 v[52:55], v[8:11], a[224:231], v3
  v_add_f32 v44, v44, v46
  v_smfmac_f32_16x16x64_bf16 v[52:55], v[12:15], a[232:239], v3
  v_add_f32 v45, v45, v47
  v_smfmac_f32_16x16x64_bf16 v[52:55], v[24:27], v[120:127], v3
  v_cvt_pk_bf16_f32 v46, v44, v45
  v_smfmac_f32_16x16x64_bf16 v[52:55], v[28:31], v[128:135], v3
  ds_write_b32 v106, v46
  v_permlane32_swap_b32 v48, v50
  v_smfmac_f32_16x16x64_bf16 v[52:55], v[32:35], v[136:143], v3
  v_permlane32_swap_b32 v49, v51
  v_smfmac_f32_16x16x64_bf16 v[56:59], v[8:11], v[144:151], v3
  v_add_f32 v48, v48, v50
  v_smfmac_f32_16x16x64_bf16 v[56:59], v[12:15], v[152:159], v3
  v_add_f32 v49, v49, v51
  v_smfmac_f32_16x16x64_bf16 v[56:59], v[24:27], v[176:183], v3
  v_cvt_pk_bf16_f32 v50, v48, v49
  v_smfmac_f32_16x16x64_bf16 v[56:59], v[28:31], v[184:191], v3
  ds_write_b32 v107, v50
  v_permlane32_swap_b32 v52, v54
  v_smfmac_f32_16x16x64_bf16 v[56:59], v[32:35], v[192:199], v3
  v_permlane32_swap_b32 v53, v55
  v_smfmac_f32_16x16x64_bf16 v[60:63], v[8:11], v[200:207], v3
  v_add_f32 v52, v52, v54
  v_smfmac_f32_16x16x64_bf16 v[60:63], v[12:15], v[208:215], v3
  v_add_f32 v53, v53, v55
  v_smfmac_f32_16x16x64_bf16 v[60:63], v[24:27], v[232:239], v3
  v_cvt_pk_bf16_f32 v54, v52, v53
  v_smfmac_f32_16x16x64_bf16 v[60:63], v[28:31], v[240:247], v3
  ds_write_b32 v108, v54
  v_permlane32_swap_b32 v56, v58
  v_smfmac_f32_16x16x64_bf16 v[60:63], v[32:35], v[248:255], v3
  v_permlane32_swap_b32 v57, v59
  v_add_f32 v56, v56, v58
  v_add_f32 v57, v57, v59
  v_cvt_pk_bf16_f32 v58, v56, v57
  ds_write_b32 v109, v58
  s_nop 2
  v_permlane32_swap_b32 v60, v62
  v_permlane32_swap_b32 v61, v63
  v_add_f32 v60, v60, v62
  v_add_f32 v61, v61, v63
  v_cvt_pk_bf16_f32 v62, v60, v61
  ds_write_b32 v110, v62
cA_va3_t2d:
  v_mov_b32 v117, s18
  s_cmp_eq_u32 s27, s28
  s_cbranch_scc1 cA_va3_vok
cA_va3_vow:
  s_waitcnt vmcnt(0)
  v_cmp_ne_u32 vcc, 56, v101
  s_cbranch_vccnz cA_va3_vor
  s_mov_b32 s28, s27
cA_va3_vok:
  s_waitcnt lgkmcnt(0)
  s_setprio 3
  s_barrier
  v_mov_b32 v36, 0
  v_mov_b32 v37, 0
  buffer_store_dword v117, v118, s[8:11], 0 offen
  s_setprio 0
  s_cmp_eq_u32 s19, 63
  s_cbranch_scc1 cA_done
  v_mov_b32 v38, 0
  v_mov_b32 v39, 0
  v_mov_b32 v40, 0
  v_mov_b32 v41, 0
  v_mov_b32 v42, 0
  v_mov_b32 v43, 0
  v_mov_b32 v44, 0
  v_mov_b32 v45, 0
  v_mov_b32 v46, 0
  v_mov_b32 v47, 0
  v_mov_b32 v48, 0
  v_mov_b32 v49, 0
  v_mov_b32 v50, 0
  v_mov_b32 v51, 0
  v_mov_b32 v52, 0
  v_mov_b32 v53, 0
  v_mov_b32 v54, 0
  v_mov_b32 v55, 0
  v_mov_b32 v56, 0
  v_mov_b32 v57, 0
  v_mov_b32 v58, 0
  v_mov_b32 v59, 0
  v_mov_b32 v60, 0
  v_mov_b32 v61, 0
  v_mov_b32 v62, 0
  v_mov_b32 v63, 0
  s_mov_b32 s19, s18
  s_add_u32 s18, s18, 1
  s_mov_b32 s22, s20
  s_mov_b32 s20, s21
  s_mov_b32 s21, s22
  s_add_u32 s23, s20, 4096
  s_branch cA_va3_loop
cA_va3_slow:
  s_waitcnt lgkmcnt(0)
cA_va3_sl1:
  s_add_u32 s31, s31, 0x1000000
  buffer_load_dwordx4 v[8:11], v2, s[8:11], s20 offen offset:0 sc1
  buffer_load_dwordx4 v[12:15], v2, s[8:11], s20 offen offset:1024 sc1
  buffer_load_dwordx4 v[16:19], v2, s[8:11], s20 offen offset:2048 sc1
  buffer_load_dwordx4 v[20:23], v2, s[8:11], s20 offen offset:3072 sc1
  buffer_load_dwordx4 v[24:27], v2, s[8:11], s23 offen offset:0 sc1
  buffer_load_dwordx4 v[28:31], v2, s[8:11], s23 offen offset:1024 sc1
  buffer_load_dwordx4 v[32:35], v2, s[8:11], s23 offen offset:2048 sc1
  s_waitcnt vmcnt(0)
  v_max3_u32 v36, v8, v9, v10
  v_max3_u32 v36, v36, v11, v12
  v_max3_u32 v36, v36, v13, v14
  v_max3_u32 v36, v36, v15, v16
  v_max3_u32 v36, v36, v17, v18
  v_max3_u32 v36, v36, v19, v20
  v_max3_u32 v36, v36, v21, v22
  v_max3_u32 v36, v36, v23, v24
  v_max3_u32 v36, v36, v25, v26
  v_max3_u32 v36, v36, v27, v28
  v_max3_u32 v36, v36, v29, v30
  v_max3_u32 v36, v36, v31, v32
  v_max3_u32 v36, v36, v33, v34
  v_max_u32 v36, v36, v35
  v_cmp_eq_u32 vcc, -1, v36
  s_cbranch_vccz cA_va3_sl2
  s_add_u32 s30, s30, 1
  s_cmp_lt_u32 s30, 400000
  s_cbranch_scc1 cA_va3_sl1
  s_branch cA_abort
cA_va3_sl2:
  v_mov_b32 v36, 0
  v_mov_b32 v37, 0
  v_mov_b32 v38, 0
  v_mov_b32 v39, 0
  v_mov_b32 v40, 0
  v_mov_b32 v41, 0
  v_mov_b32 v42, 0
  v_mov_b32 v43, 0
  v_mov_b32 v44, 0
  v_mov_b32 v45, 0
  v_mov_b32 v46, 0
  v_mov_b32 v47, 0
  v_mov_b32 v48, 0
  v_mov_b32 v49, 0
  v_mov_b32 v50, 0
  v_mov_b32 v51, 0
  v_mov_b32 v52, 0
  v_mov_b32 v53, 0
  v_mov_b32 v54, 0
  v_mov_b32 v55, 0
  v_mov_b32 v56, 0
  v_mov_b32 v57, 0
  v_mov_b32 v58, 0
  v_mov_b32 v59, 0
  v_mov_b32 v60, 0
  v_mov_b32 v61, 0
  v_mov_b32 v62, 0
  v_mov_b32 v63, 0
  v_smfmac_f32_16x16x64_bf16 v[36:39], v[8:11], a[0:7], v3
  v_smfmac_f32_16x16x64_bf16 v[40:43], v[8:11], a[56:63], v3
  v_smfmac_f32_16x16x64_bf16 v[44:47], v[8:11], a[112:119], v3
  v_smfmac_f32_16x16x64_bf16 v[48:51], v[8:11], a[168:175], v3
  v_smfmac_f32_16x16x64_bf16 v[52:55], v[8:11], a[224:231], v3
  v_smfmac_f32_16x16x64_bf16 v[56:59], v[8:11], v[144:151], v3
  v_smfmac_f32_16x16x64_bf16 v[60:63], v[8:11], v[200:207], v3
  v_smfmac_f32_16x16x64_bf16 v[36:39], v[12:15], a[8:15], v3
  v_smfmac_f32_16x16x64_bf16 v[40:43], v[12:15], a[64:71], v3
  v_smfmac_f32_16x16x64_bf16 v[44:47], v[12:15], a[120:127], v3
  v_smfmac_f32_16x16x64_bf16 v[48:51], v[12:15], a[176:183], v3
  v_smfmac_f32_16x16x64_bf16 v[52:55], v[12:15], a[232:239], v3
  v_smfmac_f32_16x16x64_bf16 v[56:59], v[12:15], v[152:159], v3
  v_smfmac_f32_16x16x64_bf16 v[60:63], v[12:15], v[208:215], v3
  v_smfmac_f32_16x16x64_bf16 v[36:39], v[16:19], a[16:23], v3
  v_smfmac_f32_16x16x64_bf16 v[40:43], v[16:19], a[72:79], v3
  v_smfmac_f32_16x16x64_bf16 v[44:47], v[16:19], a[128:135], v3
  v_smfmac_f32_16x16x64_bf16 v[48:51], v[16:19], a[184:191], v3
  v_smfmac_f32_16x16x64_bf16 v[52:55], v[16:19], a[240:247], v3
  v_smfmac_f32_16x16x64_bf16 v[56:59], v[16:19], v[160:167], v3
  v_smfmac_f32_16x16x64_bf16 v[60:63], v[16:19], v[216:223], v3
  v_smfmac_f32_16x16x64_bf16 v[36:39], v[20:23], a[24:31], v3
  v_smfmac_f32_16x16x64_bf16 v[40:43], v[20:23], a[80:87], v3
  v_smfmac_f32_16x16x64_bf16 v[44:47], v[20:23], a[136:143], v3
  v_smfmac_f32_16x16x64_bf16 v[48:51], v[20:23], a[192:199], v3
  v_smfmac_f32_16x16x64_bf16 v[52:55], v[20:23], a[248:255], v3
  v_smfmac_f32_16x16x64_bf16 v[56:59], v[20:23], v[168:175], v3
  v_smfmac_f32_16x16x64_bf16 v[60:63], v[20:23], v[224:231], v3
  v_smfmac_f32_16x16x64_bf16 v[36:39], v[24:27], a[32:39], v3
  v_smfmac_f32_16x16x64_bf16 v[40:43], v[24:27], a[88:95], v3
  v_smfmac_f32_16x16x64_bf16 v[44:47], v[24:27], a[144:151], v3
  v_smfmac_f32_16x16x64_bf16 v[48:51], v[24:27], a[200:207], v3
  v_smfmac_f32_16x16x64_bf16 v[52:55], v[24:27], v[120:127], v3
  v_smfmac_f32_16x16x64_bf16 v[56:59], v[24:27], v[176:183], v3
  v_smfmac_f32_16x16x64_bf16 v[60:63], v[24:27], v[232:239], v3
  v_smfmac_f32_16x16x64_bf16 v[36:39], v[28:31], a[40:47], v3
  v_smfmac_f32_16x16x64_bf16 v[40:43], v[28:31], a[96:103], v3
  v_smfmac_f32_16x16x64_bf16 v[44:47], v[28:31], a[152:159], v3
  v_smfmac_f32_16x16x64_bf16 v[48:51], v[28:31], a[208:215], v3
  v_smfmac_f32_16x16x64_bf16 v[52:55], v[28:31], v[128:135], v3
  v_smfmac_f32_16x16x64_bf16 v[56:59], v[28:31], v[184:191], v3
  v_smfmac_f32_16x16x64_bf16 v[60:63], v[28:31], v[240:247], v3
  v_smfmac_f32_16x16x64_bf16 v[36:39], v[32:35], a[48:55], v3
  v_smfmac_f32_16x16x64_bf16 v[40:43], v[32:35], a[104:111], v3
  v_smfmac_f32_16x16x64_bf16 v[44:47], v[32:35], a[160:167], v3
  v_smfmac_f32_16x16x64_bf16 v[48:51], v[32:35], a[216:223], v3
  v_smfmac_f32_16x16x64_bf16 v[52:55], v[32:35], v[136:143], v3
  v_smfmac_f32_16x16x64_bf16 v[56:59], v[32:35], v[192:199], v3
  v_smfmac_f32_16x16x64_bf16 v[60:63], v[32:35], v[248:255], v3
  v_permlane32_swap_b32 v36, v38
  v_permlane32_swap_b32 v37, v39
  v_add_f32 v36, v36, v38
  v_add_f32 v37, v37, v39
  v_cvt_pk_bf16_f32 v38, v36, v37
  ds_write_b32 v104, v38
  v_permlane32_swap_b32 v40, v42
  v_permlane32_swap_b32 v41, v43
  v_add_f32 v40, v40, v42
  v_add_f32 v41, v41, v43
  v_cvt_pk_bf16_f32 v42, v40, v41
  ds_write_b32 v105, v42
  v_permlane32_swap_b32 v44, v46
  v_permlane32_swap_b32 v45, v47
  v_add_f32 v44, v44, v46
  v_add_f32 v45, v45, v47
  v_cvt_pk_bf16_f32 v46, v44, v45
  ds_write_b32 v106, v46
  v_permlane32_swap_b32 v48, v50
  v_permlane32_swap_b32 v49, v51
  v_add_f32 v48, v48, v50
  v_add_f32 v49, v49, v51
  v_cvt_pk_bf16_f32 v50, v48, v49
  ds_write_b32 v107, v50
  v_permlane32_swap_b32 v52, v54
  v_permlane32_swap_b32 v53, v55
  v_add_f32 v52, v52, v54
  v_add_f32 v53, v53, v55
  v_cvt_pk_bf16_f32 v54, v52, v53
  ds_write_b32 v108, v54
  v_permlane32_swap_b32 v56, v58
  v_permlane32_swap_b32 v57, v59
  v_add_f32 v56, v56, v58
  v_add_f32 v57, v57, v59
  v_cvt_pk_bf16_f32 v58, v56, v57
  ds_write_b32 v109, v58
  v_permlane32_swap_b32 v60, v62
  v_permlane32_swap_b32 v61, v63
  v_add_f32 v60, v60, v62
  v_add_f32 v61, v61, v63
  v_cvt_pk_bf16_f32 v62, v60, v61
  ds_write_b32 v110, v62
  s_branch cA_va3_t2d
cA_va3_vor:
  s_sleep 2
  buffer_load_dword v101, off, s[8:11], s27 sc1
  s_add_u32 s30, s30, 1
  s_cmp_lt_u32 s30, 400000
  s_cbranch_scc1 cA_va3_vow
  s_branch cA_abort
cA_abort:
  v_mov_b32 v4, 0xdead
  v_mov_b32 v5, 16
  buffer_store_dword v4, v5, s[12:15], 0 offen
  s_branch ch_end
cA_done:
  s_branch ch_end
.p2align 6
cB_sc0_loop:
  s_mov_b32 s30, 0
  s_mov_b32 s62, 0
  s_setprio 3
  s_sleep 6
cB_sc0_fp_l:
  v_cmp_gt_u32 vcc, s19, v112
  buffer_load_dword v112, v0, s[8:11], 0 offen sc1
  s_cbranch_vccz cB_sc0_fp_d
  v_cmp_gt_u32 vcc, s19, v112
  buffer_load_dword v112, v0, s[8:11], 0 offen sc1
  s_cbranch_vccz cB_sc0_fp_d
  v_cmp_gt_u32 vcc, s19, v112
  buffer_load_dword v112, v0, s[8:11], 0 offen sc1
  s_cbranch_vccz cB_sc0_fp_d
  v_cmp_gt_u32 vcc, s19, v112
  buffer_load_dword v112, v0, s[8:11], 0 offen sc1
  s_cbranch_vccz cB_sc0_fp_d
  v_cmp_gt_u32 vcc, s19, v112
  buffer_load_dword v112, v0, s[8:11], 0 offen sc1
  s_cbranch_vccz cB_sc0_fp_d
  v_cmp_gt_u32 vcc, s19, v112
  buffer_load_dword v112, v0, s[8:11], 0 offen sc1
  s_cbranch_vccz cB_sc0_fp_d
  v_cmp_gt_u32 vcc, s19, v112
  buffer_load_dword v112, v0, s[8:11], 0 offen sc1
  s_cbranch_vccz cB_sc0_fp_d
  v_cmp_gt_u32 vcc, s19, v112
  buffer_load_dword v112, v0, s[8:11], 0 offen sc1
  s_cbranch_vccz cB_sc0_fp_d
  v_cmp_gt_u32 vcc, s19, v112
  buffer_load_dword v112, v0, s[8:11], 0 offen sc1
  s_cbranch_vccz cB_sc0_fp_d
  v_cmp_gt_u32 vcc, s19, v112
  buffer_load_dword v112, v0, s[8:11], 0 offen sc1
  s_cbranch_vccz cB_sc0_fp_d
  v_cmp_gt_u32 vcc, s19, v112
  buffer_load_dword v112, v0, s[8:11], 0 offen sc1
  s_cbranch_vccz cB_sc0_fp_d
  v_cmp_gt_u32 vcc, s19, v112
  buffer_load_dword v112, v0, s[8:11], 0 offen sc1
  s_cbranch_vccz cB_sc0_fp_d
  v_cmp_gt_u32 vcc, s19, v112
  buffer_load_dword v112, v0, s[8:11], 0 offen sc1
  s_cbranch_vccz cB_sc0_fp_d
  v_cmp_gt_u32 vcc, s19, v112
  buffer_load_dword v112, v0, s[8:11], 0 offen sc1
  s_cbranch_vccz cB_sc0_fp_d
  v_cmp_gt_u32 vcc, s19, v112
  buffer_load_dword v112, v0, s[8:11], 0 offen sc1
  s_cbranch_vccz cB_sc0_fp_d
  v_cmp_gt_u32 vcc, s19, v112
  buffer_load_dword v112, v0, s[8:11], 0 offen sc1
  s_cbranch_vccz cB_sc0_fp_d
  s_waitcnt vmcnt(24)
  s_add_u32 s30, s30, 1
  s_cmp_lt_u32 s30, 400000
  s_cbranch_scc1 cB_sc0_fp_l
  s_branch cB_abort
cB_sc0_fp_d:
  buffer_load_dwordx4 v[8:11], v2, s[8:11], s20 offen offset:0 sc1
  s_barrier
  s_setprio 2
  buffer_load_dwordx4 v[12:15], v2, s[8:11], s20 offen offset:1024 sc1
  s_setprio 1
  buffer_load_dwordx4 v[16:19], v2, s[8:11], s20 offen offset:2048 sc1
  s_setprio 0
  buffer_load_dwordx4 v[20:23], v2, s[8:11], s20 offen offset:3072 sc1
cB_sc0_go:
  s_waitcnt vmcnt(3)
  v_smfmac_f32_16x16x64_bf16 v[36:39], v[8:11], a[0:7], v3
  buffer_load_dwordx4 v[32:35], v2, s[8:11], s23 offen offset:0 sc1
  v_cmp_eq_u32 vcc, -1, v8
  v_smfmac_f32_16x16x64_bf16 v[40:43], v[8:11], a[56:63], v3
  v_smfmac_f32_16x16x64_bf16 v[44:47], v[8:11], a[112:119], v3
  buffer_load_dwordx4 v[24:27], v2, s[8:11], s23 offen offset:1024 sc1
  s_cbranch_vccnz cB_sc0_r0
  v_smfmac_f32_16x16x64_bf16 v[48:51], v[8:11], a[168:175], v3
  v_smfmac_f32_16x16x64_bf16 v[52:55], v[8:11], a[224:231], v3
  s_waitcnt vmcnt(4)
  v_cmp_eq_u32 vcc, -1, v12
  v_smfmac_f32_16x16x64_bf16 v[56:59], v[8:11], v[144:151], v3
  buffer_load_dwordx4 v[28:31], v2, s[8:11], s23 offen offset:2048 sc1
  v_smfmac_f32_16x16x64_bf16 v[60:63], v[8:11], v[200:207], v3
  s_cbranch_vccnz cB_sc0_r1
cB_sc0_c1:
  v_smfmac_f32_16x16x64_bf16 v[36:39], v[12:15], a[8:15], v3
  v_smfmac_f32_16x16x64_bf16 v[40:43], v[12:15], a[64:71], v3
  v_smfmac_f32_16x16x64_bf16 v[44:47], v[12:15], a[120:127], v3
  v_smfmac_f32_16x16x64_bf16 v[48:51], v[12:15], a[176:183], v3
  v_smfmac_f32_16x16x64_bf16 v[52:55], v[12:15], a[232:239], v3
  s_waitcnt vmcnt(4)
  v_cmp_eq_u32 vcc, -1, v16
  v_smfmac_f32_16x16x64_bf16 v[56:59], v[12:15], v[152:159], v3
  buffer_load_dwordx4 v[88:91], v117, s[8:11], s26 offen offset:0 sc1
  v_smfmac_f32_16x16x64_bf16 v[60:63], v[12:15], v[208:215], v3
  s_cbranch_vccnz cB_sc0_r2
cB_sc0_c2:
  v_smfmac_f32_16x16x64_bf16 v[36:39], v[16:19], a[16:23], v3
  v_smfmac_f32_16x16x64_bf16 v[40:43], v[16:19], a[72:79], v3
  v_smfmac_f32_16x16x64_bf16 v[44:47], v[16:19], a[128:135], v3
  buffer_load_dwordx4 v[92:95], v117, s[8:11], s26 offen offset:1024 sc1
  v_smfmac_f32_16x16x64_bf16 v[48:51], v[16:19], a[184:191], v3
  v_smfmac_f32_16x16x64_bf16 v[52:55], v[16:19], a[240:247], v3
  s_waitcnt vmcnt(5)
  v_cmp_eq_u32 vcc, -1, v20
  v_smfmac_f32_16x16x64_bf16 v[56:59], v[16:19], v[160:167], v3
  v_smfmac_f32_16x16x64_bf16 v[60:63], v[16:19], v[216:223], v3
  buffer_load_dwordx4 v[96:99], v2, s[8:11], s24 offen offset:0 sc1
  s_cbranch_vccnz cB_sc0_r3
cB_sc0_c3:
  v_smfmac_f32_16x16x64_bf16 v[36:39], v[20:23], a[24:31], v3
  v_smfmac_f32_16x16x64_bf16 v[40:43], v[20:23], a[80:87], v3
  s_waitcnt vmcnt(3)
  v_max3_u32 v66, v24, v27, v28
  v_smfmac_f32_16x16x64_bf16 v[44:47], v[20:23], a[136:143], v3
  v_max3_u32 v66, v66, v31, v32
  v_smfmac_f32_16x16x64_bf16 v[48:51], v[20:23], a[192:199], v3
  buffer_load_dwordx4 v[100:103], v2, s[8:11], s24 offen offset:1024 sc1
  v_max_u32 v66, v66, v35
  v_smfmac_f32_16x16x64_bf16 v[52:55], v[20:23], a[248:255], v3
  v_cmp_eq_u32 vcc, -1, v66
  v_smfmac_f32_16x16x64_bf16 v[56:59], v[20:23], v[168:175], v3
  v_smfmac_f32_16x16x64_bf16 v[60:63], v[20:23], v[224:231], v3
  s_cbranch_vccnz cB_sc0_r4
cB_sc0_c4:
  v_smfmac_f32_16x16x64_bf16 v[60:63], v[32:35], v[232:239], v3
  buffer_load_dwordx4 v[104:107], v2, s[8:11], s26 offen offset:0 sc1
  v_smfmac_f32_16x16x64_bf16 v[60:63], v[24:27], v[240:247], v3
  v_smfmac_f32_16x16x64_bf16 v[60:63], v[28:31], v[248:255], v3
  v_smfmac_f32_16x16x64_bf16 v[52:55], v[32:35], v[120:127], v3
  v_smfmac_f32_16x16x64_bf16 v[52:55], v[24:27], v[128:135], v3
  buffer_load_dwordx4 v[108:111], v2, s[8:11], s26 offen offset:1024 sc1
  v_smfmac_f32_16x16x64_bf16 v[52:55], v[28:31], v[136:143], v3
  v_cvt_pk_bf16_f32 v63, v62, v63
  v_smfmac_f32_16x16x64_bf16 v[56:59], v[32:35], v[176:183], v3
  v_cvt_pk_bf16_f32 v62, v60, v61
  v_smfmac_f32_16x16x64_bf16 v[56:59], v[24:27], v[184:191], v3
  v_mfma_f32_16x16x32_bf16 v[12:15], v[62:65], v[4:7], 0
  v_cvt_pk_bf16_f32 v55, v54, v55
  v_smfmac_f32_16x16x64_bf16 v[56:59], v[28:31], v[192:199], v3
  v_cvt_pk_bf16_f32 v54, v52, v53
  v_smfmac_f32_16x16x64_bf16 v[36:39], v[32:35], a[32:39], v3
  s_nop 1
  v_cvt_pk_bf16_f32 v76, v12, v13
  v_smfmac_f32_16x16x64_bf16 v[36:39], v[24:27], a[40:47], v3
  v_cvt_pk_bf16_f32 v77, v14, v15
  v_smfmac_f32_16x16x64_bf16 v[36:39], v[28:31], a[48:55], v3
  v_cvt_pk_bf16_f32 v56, v56, v57
  v_smfmac_f32_16x16x64_bf16 v[40:43], v[32:35], a[88:95], v3
  v_cvt_pk_bf16_f32 v57, v58, v59
  v_smfmac_f32_16x16x64_bf16 v[40:43], v[24:27], a[96:103], v3
  v_mfma_f32_16x16x32_bf16 v[16:19], v[54:57], v[4:7], 0
  v_cvt_pk_bf16_f32 v39, v38, v39
  v_smfmac_f32_16x16x64_bf16 v[40:43], v[28:31], a[104:111], v3
  v_cvt_pk_bf16_f32 v38, v36, v37
  v_smfmac_f32_16x16x64_bf16 v[44:47], v[32:35], a[144:151], v3
  s_nop 1
  v_cvt_pk_bf16_f32 v78, v16, v17
  v_smfmac_f32_16x16x64_bf16 v[44:47], v[24:27], a[152:159], v3
  v_cvt_pk_bf16_f32 v79, v18, v19
  v_smfmac_f32_16x16x64_bf16 v[44:47], v[28:31], a[160:167], v3
  v_cvt_pk_bf16_f32 v40, v40, v41
  v_smfmac_f32_16x16x64_bf16 v[48:51], v[32:35], a[200:207], v3
  v_cvt_pk_bf16_f32 v41, v42, v43
  v_smfmac_f32_16x16x64_bf16 v[48:51], v[24:27], a[208:215], v3
  v_smfmac_f32_16x16x64_bf16 v[48:51], v[28:31], a[216:223], v3
  s_waitcnt vmcnt(4)
  v_cvt_pk_bf16_f32 v47, v46, v47
  v_smfmac_f32_16x16x64_bf16 v[68:71], v[76:79], v[80:87], v3
  v_cvt_pk_bf16_f32 v46, v44, v45
  v_mfma_f32_16x16x32_bf16 v[12:15], v[38:41], v[4:7], 0
  s_nop 1
  v_cvt_pk_bf16_f32 v48, v48, v49
  v_cvt_pk_bf16_f32 v49, v50, v51
  s_nop 1
  v_mfma_f32_16x16x32_bf16 v[16:19], v[46:49], v[4:7], 0
  v_smfmac_f32_16x16x64_bf16 v[72:75], v[76:79], v[88:95], v3
  v_cvt_pk_bf16_f32 v20, v12, v13
  v_mfma_f32_16x16x32_bf16 v[52:55], v[30:33], v[76:79], 0
  s_waitcnt vmcnt(0)
  v_cvt_pk_bf16_f32 v21, v14, v15
  v_cvt_pk_bf16_f32 v22, v16, v17
  v_cvt_pk_bf16_f32 v23, v18, v19
  s_nop 1
  v_mfma_f32_16x16x32_bf16 v[52:55], v[8:11], v[20:23], v[52:55]
  v_smfmac_f32_16x16x64_bf16 v[68:71], v[20:23], v[96:103], v3
  v_smfmac_f32_16x16x64_bf16 v[72:75], v[20:23], v[104:111], v3
  s_nop 1
  ds_write_b128 v113, v[52:55]
  s_nop 1
  v_permlane32_swap_b32 v68, v70
  v_permlane32_swap_b32 v69, v71
  v_add_f32 v56, v68, v70
  v_add_f32 v58, v69, v71
  v_permlane32_swap_b32 v72, v74
  v_permlane32_swap_b32 v73, v75
  v_add_f32 v57, v72, v74
  v_add_f32 v59, v73, v75
  ds_write_b128 v2, v[56:59] offset:0
  v_cmp_u_f32 vcc, v57, v59
  v_mov_b32 v68, 0
  v_mov_b32 v69, 0
  v_mov_b32 v70, 0
  v_mov_b32 v71, 0
  s_cbranch_vccnz cB_sc0_retry
cB_sc0_cont:
  s_add_u32 s24, s24, 28672
  s_add_u32 s26, s26, 28672
  buffer_load_dwordx4 v[80:83], v117, s[8:11], s24 offen offset:0 sc1
  buffer_load_dwordx4 v[84:87], v117, s[8:11], s24 offen offset:1024 sc1
  v_mov_b32 v72, 0
  v_mov_b32 v73, 0
  v_mfma_f32_32x32x16_bf16 v[36:51], v[68:71], v[68:71], 0
  s_waitcnt lgkmcnt(0)
  s_barrier
  ds_read_b64 v[8:9], v114 offset:0
  ds_read_b64 v[10:11], v114 offset:1024
  ds_read_b64 v[12:13], v114 offset:2048
  ds_read_b64 v[14:15], v114 offset:3072
  ds_read2_b32 v[16:17], v115 offset0:0 offset1:64
  ds_read2_b32 v[18:19], v115 offset0:128 offset1:192
  v_mfma_f32_32x32x16_bf16 v[52:67], v[68:71], v[68:71], 0
  s_waitcnt lgkmcnt(0)
  v_pk_add_f32 v[16:17], v[16:17], v[18:19]
  v_pk_add_f32 v[8:9], v[8:9], v[10:11]
  v_pk_add_f32 v[12:13], v[12:13], v[14:15]
  v_add_f32 v20, v16, v17
  v_pk_add_f32 v[8:9], v[8:9], v[12:13]
  v_max_f32 v22, v8, v9
  v_add_f32_dpp v20, v20, v20 row_ror:8 row_mask:0xf bank_mask:0xf
  s_nop 0
  v_max_f32_dpp v22, v22, v22 row_ror:8 row_mask:0xf bank_mask:0xf
  v_max_f32 v22, v22, v20
  s_nop 1
  v_max_f32_dpp v22, v22, v22 quad_perm:[1,0,3,2] row_mask:0xf bank_mask:0xf
  s_nop 1
  v_max_f32_dpp v22, v22, v22 quad_perm:[2,3,0,1] row_mask:0xf bank_mask:0xf
  s_nop 1
  v_max_f32_dpp v22, v22, v22 row_half_mirror row_mask:0xf bank_mask:0xf
  v_pk_add_f32 v[8:9], v[8:9], v[22:23] op_sel_hi:[1,0] neg_lo:[0,1] neg_hi:[0,1]
  v_sub_f32 v20, v20, v22
  v_exp_f32 v8, v8
  v_exp_f32 v9, v9
  v_exp_f32 v20, v20
  v_add_f32 v24, v8, v9
  v_fmac_f32 v24, 0.5, v20
  v_mov_b32_dpp v21, v20 quad_perm:[1,0,3,2] row_mask:0xf bank_mask:0xf
  s_nop 0
  v_add_f32_dpp v24, v24, v24 quad_perm:[1,0,3,2] row_mask:0xf bank_mask:0xf
  s_nop 1
  v_add_f32_dpp v24, v24, v24 quad_perm:[2,3,0,1] row_mask:0xf bank_mask:0xf
  s_nop 1
  v_add_f32_dpp v24, v24, v24 row_half_mirror row_mask:0xf bank_mask:0xf
  s_nop 1
  v_add_f32_dpp v24, v24, v24 row_ror:8 row_mask:0xf bank_mask:0xf
  v_rcp_f32 v24, v24
  s_nop 0
  v_pk_mul_f32 v[8:9], v[8:9], v[24:25] op_sel_hi:[1,0]
  v_cvt_pk_bf16_f32 v8, abs(v8), abs(v9)
  buffer_store_dword v8, v1, s[8:11], s20 offen sc1
  v_pk_mul_f32 v[20:21], v[20:21], v[24:25] op_sel_hi:[1,0]
  v_cvt_pk_bf16_f32 v20, abs(v20), abs(v21)
  buffer_store_dword v20, v118, s[8:11], s20 offen sc1
  v_mov_b32 v74, 0
  v_mov_b32 v75, 0
  s_mov_b32 s19, s18
  s_add_u32 s18, s18, 1
  s_mov_b32 s22, s20
  s_mov_b32 s20, s21
  s_mov_b32 s21, s22
  s_add_u32 s23, s20, 4096
  s_cmp_lt_u32 s19, 63
  s_cbranch_scc1 cB_sc0_loop
  s_branch cB_done
cB_sc0_r0:
  s_add_u32 s31, s31, 1
  buffer_load_dwordx4 v[8:11], v2, s[8:11], s20 offen offset:0 sc1
  s_waitcnt vmcnt(0)
  v_cmp_eq_u32 vcc, -1, v8
  v_mov_b32 v36, 0
  v_mov_b32 v37, 0
  v_mov_b32 v38, 0
  v_mov_b32 v39, 0
  v_mov_b32 v40, 0
  v_mov_b32 v41, 0
  v_mov_b32 v42, 0
  v_mov_b32 v43, 0
  v_mov_b32 v44, 0
  v_mov_b32 v45, 0
  v_mov_b32 v46, 0
  v_mov_b32 v47, 0
  v_mov_b32 v48, 0
  v_mov_b32 v49, 0
  v_mov_b32 v50, 0
  v_mov_b32 v51, 0
  s_nop 1
  s_cbranch_vccz cB_sc0_go
  s_add_u32 s30, s30, 1
  s_cmp_lt_u32 s30, 400000
  s_cbranch_scc1 cB_sc0_r0
  s_branch cB_abort
cB_sc0_r1:
  s_add_u32 s31, s31, 1
  buffer_load_dwordx4 v[12:15], v2, s[8:11], s20 offen offset:1024 sc1
  s_waitcnt vmcnt(0)
  v_cmp_eq_u32 vcc, -1, v12
  s_nop 4
  s_cbranch_vccz cB_sc0_c1
  s_add_u32 s30, s30, 1
  s_cmp_lt_u32 s30, 400000
  s_cbranch_scc1 cB_sc0_r1
  s_branch cB_abort
cB_sc0_r2:
  s_add_u32 s31, s31, 1
  buffer_load_dwordx4 v[16:19], v2, s[8:11], s20 offen offset:2048 sc1
  s_waitcnt vmcnt(0)
  v_cmp_eq_u32 vcc, -1, v16
  s_nop 4
  s_cbranch_vccz cB_sc0_c2
  s_add_u32 s30, s30, 1
  s_cmp_lt_u32 s30, 400000
  s_cbranch_scc1 cB_sc0_r2
  s_branch cB_abort
cB_sc0_r3:
  s_add_u32 s31, s31, 1
  buffer_load_dwordx4 v[20:23], v2, s[8:11], s20 offen offset:3072 sc1
  s_waitcnt vmcnt(0)
  v_cmp_eq_u32 vcc, -1, v20
  s_nop 4
  s_cbranch_vccz cB_sc0_c3
  s_add_u32 s30, s30, 1
  s_cmp_lt_u32 s30, 400000
  s_cbranch_scc1 cB_sc0_r3
  s_branch cB_abort
cB_sc0_r4:
  s_add_u32 s31, s31, 1
  buffer_load_dwordx4 v[32:35], v2, s[8:11], s23 offen offset:0 sc1
  buffer_load_dwordx4 v[24:27], v2, s[8:11], s23 offen offset:1024 sc1
  buffer_load_dwordx4 v[28:31], v2, s[8:11], s23 offen offset:2048 sc1
  s_waitcnt vmcnt(0)
  v_max3_u32 v66, v24, v27, v28
  v_max3_u32 v66, v66, v31, v32
  v_max_u32 v66, v66, v35
  v_cmp_eq_u32 vcc, -1, v66
  s_nop 4
  s_cbranch_vccz cB_sc0_c4
  s_add_u32 s30, s30, 1
  s_cmp_lt_u32 s30, 400000
  s_cbranch_scc1 cB_sc0_r4
  s_branch cB_abort
cB_sc0_retry:
  s_cmp_lg_u32 s62, 0
  s_cbranch_scc1 cB_sc0_cont
  s_waitcnt vmcnt(0) lgkmcnt(0)
cB_sc0_rv:
  buffer_load_dwordx4 v[8:11], v2, s[8:11], s20 offen offset:0 sc1
  buffer_load_dwordx4 v[12:15], v2, s[8:11], s20 offen offset:1024 sc1
  buffer_load_dwordx4 v[16:19], v2, s[8:11], s20 offen offset:2048 sc1
  buffer_load_dwordx4 v[20:23], v2, s[8:11], s20 offen offset:3072 sc1
  buffer_load_dwordx4 v[32:35], v2, s[8:11], s23 offen offset:0 sc1
  buffer_load_dwordx4 v[24:27], v2, s[8:11], s23 offen offset:1024 sc1
  buffer_load_dwordx4 v[28:31], v2, s[8:11], s23 offen offset:2048 sc1
  s_waitcnt vmcnt(0)
  v_max3_u32 v66, v8, v9, v10
  v_max3_u32 v66, v66, v11, v12
  v_max3_u32 v66, v66, v13, v14
  v_max3_u32 v66, v66, v15, v16
  v_max3_u32 v66, v66, v17, v18
  v_max3_u32 v66, v66, v19, v20
  v_max3_u32 v66, v66, v21, v22
  v_max3_u32 v66, v66, v23, v24
  v_max3_u32 v66, v66, v25, v26
  v_max3_u32 v66, v66, v27, v28
  v_max3_u32 v66, v66, v29, v30
  v_max3_u32 v66, v66, v31, v32
  v_max3_u32 v66, v66, v33, v34
  v_max_u32 v66, v66, v35
  v_cmp_eq_u32 vcc, -1, v66
  s_cbranch_vccz cB_sc0_rk
  s_add_u32 s30, s30, 1
  s_cmp_lt_u32 s30, 400000
  s_cbranch_scc1 cB_sc0_rv
  s_branch cB_abort
cB_sc0_rk:
  s_mov_b32 s62, 1
  v_mov_b32 v36, 0
  v_mov_b32 v37, 0
  v_mov_b32 v38, 0
  v_mov_b32 v39, 0
  v_mov_b32 v40, 0
  v_mov_b32 v41, 0
  v_mov_b32 v42, 0
  v_mov_b32 v43, 0
  v_mov_b32 v44, 0
  v_mov_b32 v45, 0
  v_mov_b32 v46, 0
  v_mov_b32 v47, 0
  v_mov_b32 v48, 0
  v_mov_b32 v49, 0
  v_mov_b32 v50, 0
  v_mov_b32 v51, 0
  v_mov_b32 v60, 0
  v_mov_b32 v61, 0
  v_mov_b32 v62, 0
  v_mov_b32 v63, 0
  v_mov_b32 v68, 0
  v_mov_b32 v69, 0
  v_mov_b32 v70, 0
  v_mov_b32 v71, 0
  v_mov_b32 v72, 0
  v_mov_b32 v73, 0
  v_mov_b32 v74, 0
  v_mov_b32 v75, 0
  v_mov_b32 v52, 0
  v_mov_b32 v53, 0
  v_mov_b32 v54, 0
  v_mov_b32 v55, 0
  v_mov_b32 v56, 0
  v_mov_b32 v57, 0
  v_mov_b32 v58, 0
  v_mov_b32 v59, 0
  s_add_u32 s31, s31, 0x100
  s_nop 0
  s_branch cB_sc0_go
.p2align 6
cB_sc1_loop:
  s_mov_b32 s30, 0
  s_mov_b32 s62, 0
  s_setprio 3
  s_barrier
  buffer_load_dwordx4 v[8:11], v2, s[8:11], s20 offen offset:0 sc1
  s_setprio 2
  buffer_load_dwordx4 v[12:15], v2, s[8:11], s20 offen offset:1024 sc1
  s_setprio 1
  buffer_load_dwordx4 v[16:19], v2, s[8:11], s20 offen offset:2048 sc1
  s_setprio 0
  buffer_load_dwordx4 v[20:23], v2, s[8:11], s20 offen offset:3072 sc1
cB_sc1_go:
  s_waitcnt vmcnt(3)
  v_smfmac_f32_16x16x64_bf16 v[36:39], v[8:11], a[0:7], v3
  buffer_load_dwordx4 v[28:31], v2, s[8:11], s23 offen offset:0 sc1
  v_cmp_eq_u32 vcc, -1, v8
  v_smfmac_f32_16x16x64_bf16 v[40:43], v[8:11], a[56:63], v3
  v_smfmac_f32_16x16x64_bf16 v[44:47], v[8:11], a[112:119], v3
  buffer_load_dwordx4 v[24:27], v2, s[8:11], s23 offen offset:1024 sc1
  s_cbranch_vccnz cB_sc1_r0
  v_smfmac_f32_16x16x64_bf16 v[48:51], v[8:11], a[168:175], v3
  v_smfmac_f32_16x16x64_bf16 v[52:55], v[8:11], a[224:231], v3
  s_waitcnt vmcnt(4)
  v_cmp_eq_u32 vcc, -1, v12
  v_smfmac_f32_16x16x64_bf16 v[56:59], v[8:11], v[144:151], v3
  buffer_load_dwordx4 v[32:35], v2, s[8:11], s23 offen offset:2048 sc1
  v_smfmac_f32_16x16x64_bf16 v[60:63], v[8:11], v[200:207], v3
  s_cbranch_vccnz cB_sc1_r1
cB_sc1_c1:
  v_smfmac_f32_16x16x64_bf16 v[36:39], v[12:15], a[8:15], v3
  v_smfmac_f32_16x16x64_bf16 v[40:43], v[12:15], a[64:71], v3
  v_smfmac_f32_16x16x64_bf16 v[44:47], v[12:15], a[120:127], v3
  v_smfmac_f32_16x16x64_bf16 v[48:51], v[12:15], a[176:183], v3
  v_smfmac_f32_16x16x64_bf16 v[52:55], v[12:15], a[232:239], v3
  s_waitcnt vmcnt(4)
  v_cmp_eq_u32 vcc, -1, v16
  v_smfmac_f32_16x16x64_bf16 v[56:59], v[12:15], v[152:159], v3
  buffer_load_dwordx4 v[88:91], v117, s[8:11], s26 offen offset:0 sc1
  v_smfmac_f32_16x16x64_bf16 v[60:63], v[12:15], v[208:215], v3
  s_cbranch_vccnz cB_sc1_r2
cB_sc1_c2:
  v_smfmac_f32_16x16x64_bf16 v[36:39], v[16:19], a[16:23], v3
  v_smfmac_f32_16x16x64_bf16 v[40:43], v[16:19], a[72:79], v3
  v_smfmac_f32_16x16x64_bf16 v[44:47], v[16:19], a[128:135], v3
  buffer_load_dwordx4 v[92:95], v117, s[8:11], s26 offen offset:1024 sc1
  v_smfmac_f32_16x16x64_bf16 v[48:51], v[16:19], a[184:191], v3
  v_smfmac_f32_16x16x64_bf16 v[52:55], v[16:19], a[240:247], v3
  s_waitcnt vmcnt(5)
  v_cmp_eq_u32 vcc, -1, v20
  v_smfmac_f32_16x16x64_bf16 v[56:59], v[16:19], v[160:167], v3
  v_smfmac_f32_16x16x64_bf16 v[60:63], v[16:19], v[216:223], v3
  buffer_load_dwordx4 v[96:99], v2, s[8:11], s24 offen offset:0 sc1
  s_cbranch_vccnz cB_sc1_r3
cB_sc1_c3:
  v_smfmac_f32_16x16x64_bf16 v[36:39], v[20:23], a[24:31], v3
  v_smfmac_f32_16x16x64_bf16 v[40:43], v[20:23], a[80:87], v3
  s_waitcnt vmcnt(3)
  v_max3_u32 v66, v24, v27, v28
  v_smfmac_f32_16x16x64_bf16 v[44:47], v[20:23], a[136:143], v3
  v_max3_u32 v66, v66, v31, v32
  v_smfmac_f32_16x16x64_bf16 v[48:51], v[20:23], a[192:199], v3
  buffer_load_dwordx4 v[100:103], v2, s[8:11], s24 offen offset:1024 sc1
  v_max_u32 v66, v66, v35
  v_smfmac_f32_16x16x64_bf16 v[52:55], v[20:23], a[248:255], v3
  v_cmp_eq_u32 vcc, -1, v66
  v_smfmac_f32_16x16x64_bf16 v[56:59], v[20:23], v[168:175], v3
  v_smfmac_f32_16x16x64_bf16 v[60:63], v[20:23], v[224:231], v3
  s_cbranch_vccnz cB_sc1_r4
cB_sc1_c4:
  v_smfmac_f32_16x16x64_bf16 v[60:63], v[28:31], v[232:239], v3
  buffer_load_dwordx4 v[104:107], v2, s[8:11], s26 offen offset:0 sc1
  v_smfmac_f32_16x16x64_bf16 v[60:63], v[24:27], v[240:247], v3
  v_smfmac_f32_16x16x64_bf16 v[60:63], v[32:35], v[248:255], v3
  v_smfmac_f32_16x16x64_bf16 v[52:55], v[28:31], v[120:127], v3
  v_smfmac_f32_16x16x64_bf16 v[52:55], v[24:27], v[128:135], v3
  buffer_load_dwordx4 v[108:111], v2, s[8:11], s26 offen offset:1024 sc1
  v_smfmac_f32_16x16x64_bf16 v[52:55], v[32:35], v[136:143], v3
  v_cvt_pk_bf16_f32 v63, v62, v63
  v_smfmac_f32_16x16x64_bf16 v[56:59], v[28:31], v[176:183], v3
  v_cvt_pk_bf16_f32 v62, v60, v61
  v_smfmac_f32_16x16x64_bf16 v[56:59], v[24:27], v[184:191], v3
  v_mfma_f32_16x16x32_bf16 v[8:11], v[62:65], v[4:7], 0
  v_cvt_pk_bf16_f32 v55, v54, v55
  v_smfmac_f32_16x16x64_bf16 v[56:59], v[32:35], v[192:199], v3
  v_cvt_pk_bf16_f32 v54, v52, v53
  v_smfmac_f32_16x16x64_bf16 v[36:39], v[28:31], a[32:39], v3
  s_nop 1
  v_cvt_pk_bf16_f32 v78, v8, v9
  v_smfmac_f32_16x16x64_bf16 v[36:39], v[24:27], a[40:47], v3
  v_cvt_pk_bf16_f32 v79, v10, v11
  v_smfmac_f32_16x16x64_bf16 v[36:39], v[32:35], a[48:55], v3
  v_cvt_pk_bf16_f32 v56, v56, v57
  v_smfmac_f32_16x16x64_bf16 v[40:43], v[28:31], a[88:95], v3
  v_cvt_pk_bf16_f32 v57, v58, v59
  v_smfmac_f32_16x16x64_bf16 v[40:43], v[24:27], a[96:103], v3
  v_mfma_f32_16x16x32_bf16 v[16:19], v[54:57], v[4:7], 0
  v_cvt_pk_bf16_f32 v39, v38, v39
  v_smfmac_f32_16x16x64_bf16 v[40:43], v[32:35], a[104:111], v3
  v_cvt_pk_bf16_f32 v38, v36, v37
  v_smfmac_f32_16x16x64_bf16 v[44:47], v[28:31], a[144:151], v3
  s_nop 1
  v_cvt_pk_bf16_f32 v76, v16, v17
  v_smfmac_f32_16x16x64_bf16 v[44:47], v[24:27], a[152:159], v3
  v_cvt_pk_bf16_f32 v77, v18, v19
  v_smfmac_f32_16x16x64_bf16 v[44:47], v[32:35], a[160:167], v3
  v_cvt_pk_bf16_f32 v40, v40, v41
  v_smfmac_f32_16x16x64_bf16 v[48:51], v[28:31], a[200:207], v3
  v_cvt_pk_bf16_f32 v41, v42, v43
  v_smfmac_f32_16x16x64_bf16 v[48:51], v[24:27], a[208:215], v3
  v_smfmac_f32_16x16x64_bf16 v[48:51], v[32:35], a[216:223], v3
  s_waitcnt vmcnt(4)
  v_cvt_pk_bf16_f32 v47, v46, v47
  v_smfmac_f32_16x16x64_bf16 v[68:71], v[76:79], v[80:87], v3
  v_cvt_pk_bf16_f32 v46, v44, v45
  v_mfma_f32_16x16x32_bf16 v[8:11], v[38:41], v[4:7], 0
  s_nop 1
  v_cvt_pk_bf16_f32 v48, v48, v49
  v_cvt_pk_bf16_f32 v49, v50, v51
  s_nop 1
  v_mfma_f32_16x16x32_bf16 v[16:19], v[46:49], v[4:7], 0
  v_smfmac_f32_16x16x64_bf16 v[72:75], v[76:79], v[88:95], v3
  v_cvt_pk_bf16_f32 v20, v8, v9
  v_mfma_f32_16x16x32_bf16 v[52:55], v[30:33], v[76:79], 0
  s_waitcnt vmcnt(0)
  v_cvt_pk_bf16_f32 v21, v10, v11
  v_cvt_pk_bf16_f32 v22, v16, v17
  v_cvt_pk_bf16_f32 v23, v18, v19
  s_nop 1
  v_mfma_f32_16x16x32_bf16 v[52:55], v[12:15], v[20:23], v[52:55]
  v_smfmac_f32_16x16x64_bf16 v[68:71], v[20:23], v[96:103], v3
  v_smfmac_f32_16x16x64_bf16 v[72:75], v[20:23], v[104:111], v3
  s_nop 1
  ds_write_b128 v113, v[52:55]
  s_nop 1
  v_permlane32_swap_b32 v68, v70
  v_permlane32_swap_b32 v69, v71
  v_add_f32 v56, v68, v70
  v_add_f32 v58, v69, v71
  v_permlane32_swap_b32 v72, v74
  v_permlane32_swap_b32 v73, v75
  v_add_f32 v57, v72, v74
  v_add_f32 v59, v73, v75
  ds_write_b128 v2, v[56:59] offset:1024
  v_cmp_u_f32 vcc, v57, v59
  v_mov_b32 v68, 0
  v_mov_b32 v69, 0
  v_mov_b32 v70, 0
  v_mov_b32 v71, 0
  s_cbranch_vccnz cB_sc1_retry
cB_sc1_cont:
  s_add_u32 s24, s24, 28672
  s_add_u32 s26, s26, 28672
  buffer_load_dwordx4 v[80:83], v117, s[8:11], s24 offen offset:0 sc1
  buffer_load_dwordx4 v[84:87], v117, s[8:11], s24 offen offset:1024 sc1
  v_mov_b32 v72, 0
  v_mov_b32 v73, 0
  v_mfma_f32_32x32x16_bf16 v[36:51], v[68:71], v[68:71], 0
  s_waitcnt lgkmcnt(0)
  s_barrier
  ds_read_b64 v[8:9], v114 offset:0
  ds_read_b64 v[10:11], v114 offset:1024
  ds_read_b64 v[12:13], v114 offset:2048
  ds_read_b64 v[14:15], v114 offset:3072
  ds_read2_b32 v[16:17], v115 offset0:0 offset1:64
  ds_read2_b32 v[18:19], v115 offset0:128 offset1:192
  v_mfma_f32_32x32x16_bf16 v[52:67], v[68:71], v[68:71], 0
  s_waitcnt lgkmcnt(0)
  v_pk_add_f32 v[16:17], v[16:17], v[18:19]
  v_pk_add_f32 v[8:9], v[8:9], v[10:11]
  v_pk_add_f32 v[12:13], v[12:13], v[14:15]
  v_add_f32 v20, v16, v17
  v_pk_add_f32 v[8:9], v[8:9], v[12:13]
  v_max_f32 v22, v8, v9
  v_add_f32_dpp v20, v20, v20 row_ror:8 row_mask:0xf bank_mask:0xf
  s_nop 0
  v_max_f32_dpp v22, v22, v22 row_ror:8 row_mask:0xf bank_mask:0xf
  v_max_f32 v22, v22, v20
  buffer_store_dword v112, v116, s[8:11], 0 offen sc1
  s_nop 0
  v_max_f32_dpp v22, v22, v22 quad_perm:[1,0,3,2] row_mask:0xf bank_mask:0xf
  s_nop 1
  v_max_f32_dpp v22, v22, v22 quad_perm:[2,3,0,1] row_mask:0xf bank_mask:0xf
  s_nop 1
  v_max_f32_dpp v22, v22, v22 row_half_mirror row_mask:0xf bank_mask:0xf
  v_pk_add_f32 v[8:9], v[8:9], v[22:23] op_sel_hi:[1,0] neg_lo:[0,1] neg_hi:[0,1]
  v_sub_f32 v20, v20, v22
  v_exp_f32 v8, v8
  v_exp_f32 v9, v9
  v_exp_f32 v20, v20
  v_add_f32 v24, v8, v9
  v_fmac_f32 v24, 0.5, v20
  v_mov_b32_dpp v21, v20 quad_perm:[1,0,3,2] row_mask:0xf bank_mask:0xf
  s_nop 0
  v_add_f32_dpp v24, v24, v24 quad_perm:[1,0,3,2] row_mask:0xf bank_mask:0xf
  s_nop 1
  v_add_f32_dpp v24, v24, v24 quad_perm:[2,3,0,1] row_mask:0xf bank_mask:0xf
  s_nop 1
  v_add_f32_dpp v24, v24, v24 row_half_mirror row_mask:0xf bank_mask:0xf
  s_nop 1
  v_add_f32_dpp v24, v24, v24 row_ror:8 row_mask:0xf bank_mask:0xf
  v_rcp_f32 v24, v24
  s_nop 0
  v_pk_mul_f32 v[8:9], v[8:9], v[24:25] op_sel_hi:[1,0]
  v_cvt_pk_bf16_f32 v8, abs(v8), abs(v9)
  buffer_store_dword v8, v1, s[8:11], s20 offen sc1
  v_pk_mul_f32 v[20:21], v[20:21], v[24:25] op_sel_hi:[1,0]
  v_cvt_pk_bf16_f32 v20, abs(v20), abs(v21)
  buffer_store_dword v20, v118, s[8:11], s20 offen sc1
  v_mov_b32 v74, 0
  v_mov_b32 v75, 0
  s_mov_b32 s19, s18
  s_add_u32 s18, s18, 1
  s_mov_b32 s22, s20
  s_mov_b32 s20, s21
  s_mov_b32 s21, s22
  s_add_u32 s23, s20, 4096
  v_mov_b32 v112, s18
  s_cmp_lt_u32 s19, 63
  s_nop 0
  s_cbranch_scc1 cB_sc1_loop
  s_branch cB_done
cB_sc1_r0:
  s_add_u32 s31, s31, 1
  buffer_load_dwordx4 v[8:11], v2, s[8:11], s20 offen offset:0 sc1
  s_waitcnt vmcnt(0)
  v_cmp_eq_u32 vcc, -1, v8
  v_mov_b32 v36, 0
  v_mov_b32 v37, 0
  v_mov_b32 v38, 0
  v_mov_b32 v39, 0
  v_mov_b32 v40, 0
  v_mov_b32 v41, 0
  v_mov_b32 v42, 0
  v_mov_b32 v43, 0
  v_mov_b32 v44, 0
  v_mov_b32 v45, 0
  v_mov_b32 v46, 0
  v_mov_b32 v47, 0
  v_mov_b32 v48, 0
  v_mov_b32 v49, 0
  v_mov_b32 v50, 0
  v_mov_b32 v51, 0
  s_nop 1
  s_cbranch_vccz cB_sc1_go
  s_add_u32 s30, s30, 1
  s_cmp_lt_u32 s30, 400000
  s_cbranch_scc1 cB_sc1_r0
  s_branch cB_abort
cB_sc1_r1:
  s_add_u32 s31, s31, 1
  buffer_load_dwordx4 v[12:15], v2, s[8:11], s20 offen offset:1024 sc1
  s_waitcnt vmcnt(0)
  v_cmp_eq_u32 vcc, -1, v12
  s_nop 4
  s_cbranch_vccz cB_sc1_c1
  s_add_u32 s30, s30, 1
  s_cmp_lt_u32 s30, 400000
  s_cbranch_scc1 cB_sc1_r1
  s_branch cB_abort
cB_sc1_r2:
  s_add_u32 s31, s31, 1
  buffer_load_dwordx4 v[16:19], v2, s[8:11], s20 offen offset:2048 sc1
  s_waitcnt vmcnt(0)
  v_cmp_eq_u32 vcc, -1, v16
  s_nop 4
  s_cbranch_vccz cB_sc1_c2
  s_add_u32 s30, s30, 1
  s_cmp_lt_u32 s30, 400000
  s_cbranch_scc1 cB_sc1_r2
  s_branch cB_abort
cB_sc1_r3:
  s_add_u32 s31, s31, 1
  buffer_load_dwordx4 v[20:23], v2, s[8:11], s20 offen offset:3072 sc1
  s_waitcnt vmcnt(0)
  v_cmp_eq_u32 vcc, -1, v20
  s_nop 4
  s_cbranch_vccz cB_sc1_c3
  s_add_u32 s30, s30, 1
  s_cmp_lt_u32 s30, 400000
  s_cbranch_scc1 cB_sc1_r3
  s_branch cB_abort
cB_sc1_r4:
  s_add_u32 s31, s31, 1
  buffer_load_dwordx4 v[28:31], v2, s[8:11], s23 offen offset:0 sc1
  buffer_load_dwordx4 v[24:27], v2, s[8:11], s23 offen offset:1024 sc1
  buffer_load_dwordx4 v[32:35], v2, s[8:11], s23 offen offset:2048 sc1
  s_waitcnt vmcnt(0)
  v_max3_u32 v66, v24, v27, v28
  v_max3_u32 v66, v66, v31, v32
  v_max_u32 v66, v66, v35
  v_cmp_eq_u32 vcc, -1, v66
  s_nop 4
  s_cbranch_vccz cB_sc1_c4
  s_add_u32 s30, s30, 1
  s_cmp_lt_u32 s30, 400000
  s_cbranch_scc1 cB_sc1_r4
  s_branch cB_abort
cB_sc1_retry:
  s_cmp_lg_u32 s62, 0
  s_cbranch_scc1 cB_sc1_cont
  s_waitcnt vmcnt(0) lgkmcnt(0)
cB_sc1_rv:
  buffer_load_dwordx4 v[8:11], v2, s[8:11], s20 offen offset:0 sc1
  buffer_load_dwordx4 v[12:15], v2, s[8:11], s20 offen offset:1024 sc1
  buffer_load_dwordx4 v[16:19], v2, s[8:11], s20 offen offset:2048 sc1
  buffer_load_dwordx4 v[20:23], v2, s[8:11], s20 offen offset:3072 sc1
  buffer_load_dwordx4 v[28:31], v2, s[8:11], s23 offen offset:0 sc1
  buffer_load_dwordx4 v[24:27], v2, s[8:11], s23 offen offset:1024 sc1
  buffer_load_dwordx4 v[32:35], v2, s[8:11], s23 offen offset:2048 sc1
  s_waitcnt vmcnt(0)
  v_max3_u32 v66, v8, v9, v10
  v_max3_u32 v66, v66, v11, v12
  v_max3_u32 v66, v66, v13, v14
  v_max3_u32 v66, v66, v15, v16
  v_max3_u32 v66, v66, v17, v18
  v_max3_u32 v66, v66, v19, v20
  v_max3_u32 v66, v66, v21, v22
  v_max3_u32 v66, v66, v23, v24
  v_max3_u32 v66, v66, v25, v26
  v_max3_u32 v66, v66, v27, v28
  v_max3_u32 v66, v66, v29, v30
  v_max3_u32 v66, v66, v31, v32
  v_max3_u32 v66, v66, v33, v34
  v_max_u32 v66, v66, v35
  v_cmp_eq_u32 vcc, -1, v66
  s_cbranch_vccz cB_sc1_rk
  s_add_u32 s30, s30, 1
  s_cmp_lt_u32 s30, 400000
  s_cbranch_scc1 cB_sc1_rv
  s_branch cB_abort
cB_sc1_rk:
  s_mov_b32 s62, 1
  v_mov_b32 v36, 0
  v_mov_b32 v37, 0
  v_mov_b32 v38, 0
  v_mov_b32 v39, 0
  v_mov_b32 v40, 0
  v_mov_b32 v41, 0
  v_mov_b32 v42, 0
  v_mov_b32 v43, 0
  v_mov_b32 v44, 0
  v_mov_b32 v45, 0
  v_mov_b32 v46, 0
  v_mov_b32 v47, 0
  v_mov_b32 v48, 0
  v_mov_b32 v49, 0
  v_mov_b32 v50, 0
  v_mov_b32 v51, 0
  v_mov_b32 v60, 0
  v_mov_b32 v61, 0
  v_mov_b32 v62, 0
  v_mov_b32 v63, 0
  v_mov_b32 v68, 0
  v_mov_b32 v69, 0
  v_mov_b32 v70, 0
  v_mov_b32 v71, 0
  v_mov_b32 v72, 0
  v_mov_b32 v73, 0
  v_mov_b32 v74, 0
  v_mov_b32 v75, 0
  v_mov_b32 v52, 0
  v_mov_b32 v53, 0
  v_mov_b32 v54, 0
  v_mov_b32 v55, 0
  v_mov_b32 v56, 0
  v_mov_b32 v57, 0
  v_mov_b32 v58, 0
  v_mov_b32 v59, 0
  s_add_u32 s31, s31, 0x100
  s_nop 0
  s_branch cB_sc1_go
.p2align 6
cB_sc2_loop:
  s_mov_b32 s30, 0
  s_mov_b32 s62, 0
  s_setprio 3
  s_barrier
  buffer_load_dwordx4 v[8:11], v2, s[8:11], s20 offen offset:0 sc1
  s_setprio 2
  buffer_load_dwordx4 v[12:15], v2, s[8:11], s20 offen offset:1024 sc1
  s_setprio 1
  buffer_load_dwordx4 v[16:19], v2, s[8:11], s20 offen offset:2048 sc1
  s_setprio 0
  buffer_load_dwordx4 v[20:23], v2, s[8:11], s20 offen offset:3072 sc1
cB_sc2_go:
  s_waitcnt vmcnt(3)
  v_smfmac_f32_16x16x64_bf16 v[36:39], v[8:11], a[0:7], v3
  buffer_load_dwordx4 v[24:27], v2, s[8:11], s23 offen offset:0 sc1
  v_cmp_eq_u32 vcc, -1, v8
  v_smfmac_f32_16x16x64_bf16 v[40:43], v[8:11], a[56:63], v3
  v_smfmac_f32_16x16x64_bf16 v[44:47], v[8:11], a[112:119], v3
  buffer_load_dwordx4 v[32:35], v2, s[8:11], s23 offen offset:1024 sc1
  s_cbranch_vccnz cB_sc2_r0
  v_smfmac_f32_16x16x64_bf16 v[48:51], v[8:11], a[168:175], v3
  v_smfmac_f32_16x16x64_bf16 v[52:55], v[8:11], a[224:231], v3
  s_waitcnt vmcnt(4)
  v_cmp_eq_u32 vcc, -1, v12
  v_smfmac_f32_16x16x64_bf16 v[56:59], v[8:11], v[144:151], v3
  buffer_load_dwordx4 v[28:31], v2, s[8:11], s23 offen offset:2048 sc1
  v_smfmac_f32_16x16x64_bf16 v[62:65], v[8:11], v[200:207], v3
  s_cbranch_vccnz cB_sc2_r1
cB_sc2_c1:
  v_smfmac_f32_16x16x64_bf16 v[36:39], v[12:15], a[8:15], v3
  v_smfmac_f32_16x16x64_bf16 v[40:43], v[12:15], a[64:71], v3
  v_smfmac_f32_16x16x64_bf16 v[44:47], v[12:15], a[120:127], v3
  v_smfmac_f32_16x16x64_bf16 v[48:51], v[12:15], a[176:183], v3
  v_smfmac_f32_16x16x64_bf16 v[52:55], v[12:15], a[232:239], v3
  s_waitcnt vmcnt(4)
  v_cmp_eq_u32 vcc, -1, v16
  v_smfmac_f32_16x16x64_bf16 v[56:59], v[12:15], v[152:159], v3
  buffer_load_dwordx4 v[88:91], v117, s[8:11], s26 offen offset:0 sc1
  v_smfmac_f32_16x16x64_bf16 v[62:65], v[12:15], v[208:215], v3
  s_cbranch_vccnz cB_sc2_r2
cB_sc2_c2:
  v_smfmac_f32_16x16x64_bf16 v[36:39], v[16:19], a[16:23], v3
  v_smfmac_f32_16x16x64_bf16 v[40:43], v[16:19], a[72:79], v3
  v_smfmac_f32_16x16x64_bf16 v[44:47], v[16:19], a[128:135], v3
  buffer_load_dwordx4 v[92:95], v117, s[8:11], s26 offen offset:1024 sc1
  v_smfmac_f32_16x16x64_bf16 v[48:51], v[16:19], a[184:191], v3
  v_smfmac_f32_16x16x64_bf16 v[52:55], v[16:19], a[240:247], v3
  s_waitcnt vmcnt(5)
  v_cmp_eq_u32 vcc, -1, v20
  v_smfmac_f32_16x16x64_bf16 v[56:59], v[16:19], v[160:167], v3
  v_smfmac_f32_16x16x64_bf16 v[62:65], v[16:19], v[216:223], v3
  buffer_load_dwordx4 v[96:99], v2, s[8:11], s24 offen offset:0 sc1
  s_cbranch_vccnz cB_sc2_r3
cB_sc2_c3:
  v_smfmac_f32_16x16x64_bf16 v[36:39], v[20:23], a[24:31], v3
  v_smfmac_f32_16x16x64_bf16 v[40:43], v[20:23], a[80:87], v3
  s_waitcnt vmcnt(3)
  v_max3_u32 v66, v24, v27, v28
  v_smfmac_f32_16x16x64_bf16 v[44:47], v[20:23], a[136:143], v3
  v_max3_u32 v66, v66, v31, v32
  v_smfmac_f32_16x16x64_bf16 v[48:51], v[20:23], a[192:199], v3
  buffer_load_dwordx4 v[100:103], v2, s[8:11], s24 offen offset:1024 sc1
  v_max_u32 v66, v66, v35
  v_smfmac_f32_16x16x64_bf16 v[52:55], v[20:23], a[248:255], v3
  v_cmp_eq_u32 vcc, -1, v66
  v_smfmac_f32_16x16x64_bf16 v[56:59], v[20:23], v[168:175], v3
  v_smfmac_f32_16x16x64_bf16 v[62:65], v[20:23], v[224:231], v3
  s_cbranch_vccnz cB_sc2_r4
cB_sc2_c4:
  v_smfmac_f32_16x16x64_bf16 v[62:65], v[24:27], v[232:239], v3
  buffer_load_dwordx4 v[104:107], v2, s[8:11], s26 offen offset:0 sc1
  v_smfmac_f32_16x16x64_bf16 v[62:65], v[32:35], v[240:247], v3
  v_smfmac_f32_16x16x64_bf16 v[62:65], v[28:31], v[248:255], v3
  v_smfmac_f32_16x16x64_bf16 v[52:55], v[24:27], v[120:127], v3
  v_smfmac_f32_16x16x64_bf16 v[52:55], v[32:35], v[128:135], v3
  buffer_load_dwordx4 v[108:111], v2, s[8:11], s26 offen offset:1024 sc1
  v_smfmac_f32_16x16x64_bf16 v[52:55], v[28:31], v[136:143], v3
  v_cvt_pk_bf16_f32 v62, v62, v63
  v_smfmac_f32_16x16x64_bf16 v[56:59], v[24:27], v[176:183], v3
  v_cvt_pk_bf16_f32 v63, v64, v65
  v_smfmac_f32_16x16x64_bf16 v[56:59], v[32:35], v[184:191], v3
  v_mfma_f32_16x16x32_bf16 v[8:11], v[60:63], v[4:7], 0
  v_cvt_pk_bf16_f32 v55, v54, v55
  v_smfmac_f32_16x16x64_bf16 v[56:59], v[28:31], v[192:199], v3
  v_cvt_pk_bf16_f32 v54, v52, v53
  v_smfmac_f32_16x16x64_bf16 v[36:39], v[24:27], a[32:39], v3
  s_nop 1
  v_cvt_pk_bf16_f32 v76, v8, v9
  v_smfmac_f32_16x16x64_bf16 v[36:39], v[32:35], a[40:47], v3
  v_cvt_pk_bf16_f32 v77, v10, v11
  v_smfmac_f32_16x16x64_bf16 v[36:39], v[28:31], a[48:55], v3
  v_cvt_pk_bf16_f32 v56, v56, v57
  v_smfmac_f32_16x16x64_bf16 v[40:43], v[24:27], a[88:95], v3
  v_cvt_pk_bf16_f32 v57, v58, v59
  v_smfmac_f32_16x16x64_bf16 v[40:43], v[32:35], a[96:103], v3
  v_mfma_f32_16x16x32_bf16 v[12:15], v[54:57], v[4:7], 0
  v_cvt_pk_bf16_f32 v39, v38, v39
  v_smfmac_f32_16x16x64_bf16 v[40:43], v[28:31], a[104:111], v3
  v_cvt_pk_bf16_f32 v38, v36, v37
  v_smfmac_f32_16x16x64_bf16 v[44:47], v[24:27], a[144:151], v3
  s_nop 1
  v_cvt_pk_bf16_f32 v78, v12, v13
  v_smfmac_f32_16x16x64_bf16 v[44:47], v[32:35], a[152:159], v3
  v_cvt_pk_bf16_f32 v79, v14, v15
  v_smfmac_f32_16x16x64_bf16 v[44:47], v[28:31], a[160:167], v3
  v_cvt_pk_bf16_f32 v40, v40, v41
  v_smfmac_f32_16x16x64_bf16 v[48:51], v[24:27], a[200:207], v3
  v_cvt_pk_bf16_f32 v41, v42, v43
  v_smfmac_f32_16x16x64_bf16 v[48:51], v[32:35], a[208:215], v3
  v_smfmac_f32_16x16x64_bf16 v[48:51], v[28:31], a[216:223], v3
  s_waitcnt vmcnt(4)
  v_cvt_pk_bf16_f32 v47, v46, v47
  v_smfmac_f32_16x16x64_bf16 v[68:71], v[76:79], v[80:87], v3
  v_cvt_pk_bf16_f32 v46, v44, v45
  v_mfma_f32_16x16x32_bf16 v[8:11], v[38:41], v[4:7], 0
  s_nop 1
  v_cvt_pk_bf16_f32 v48, v48, v49
  v_cvt_pk_bf16_f32 v49, v50, v51
  s_nop 1
  v_mfma_f32_16x16x32_bf16 v[12:15], v[46:49], v[4:7], 0
  v_smfmac_f32_16x16x64_bf16 v[72:75], v[76:79], v[88:95], v3
  v_cvt_pk_bf16_f32 v20, v8, v9
  v_mfma_f32_16x16x32_bf16 v[52:55], v[30:33], v[76:79], 0
  s_waitcnt vmcnt(0)
  v_cvt_pk_bf16_f32 v21, v10, v11
  v_cvt_pk_bf16_f32 v22, v12, v13
  v_cvt_pk_bf16_f32 v23, v14, v15
  s_nop 1
  v_mfma_f32_16x16x32_bf16 v[52:55], v[16:19], v[20:23], v[52:55]
  v_smfmac_f32_16x16x64_bf16 v[68:71], v[20:23], v[96:103], v3
  v_smfmac_f32_16x16x64_bf16 v[72:75], v[20:23], v[104:111], v3
  s_nop 1
  ds_write_b128 v113, v[52:55]
  s_nop 1
  v_permlane32_swap_b32 v68, v70
  v_permlane32_swap_b32 v69, v71
  v_add_f32 v56, v68, v70
  v_add_f32 v58, v69, v71
  v_permlane32_swap_b32 v72, v74
  v_permlane32_swap_b32 v73, v75
  v_add_f32 v57, v72, v74
  v_add_f32 v59, v73, v75
  ds_write_b128 v2, v[56:59] offset:2048
  v_cmp_u_f32 vcc, v57, v59
  v_mov_b32 v68, 0
  v_mov_b32 v69, 0
  v_mov_b32 v70, 0
  v_mov_b32 v71, 0
  s_cbranch_vccnz cB_sc2_retry
cB_sc2_cont:
  s_add_u32 s24, s24, 28672
  s_add_u32 s26, s26, 28672
  buffer_load_dwordx4 v[80:83], v117, s[8:11], s24 offen offset:0 sc1
  buffer_load_dwordx4 v[84:87], v117, s[8:11], s24 offen offset:1024 sc1
  v_mov_b32 v72, 0
  v_mov_b32 v73, 0
  v_mfma_f32_32x32x16_bf16 v[36:51], v[68:71], v[68:71], 0
  s_waitcnt lgkmcnt(0)
  s_barrier
  v_mfma_f32_32x32x16_bf16 v[52:67], v[68:71], v[68:71], 0
  buffer_store_dwordx2 v[118:119], v114, s[8:11], s21 offen sc1
  buffer_store_dwordx2 v[118:119], v115, s[8:11], s21 offen sc1
  s_buffer_load_dword s70, s[8:11], s35
  s_add_u32 s22, s24, 114688
  s_buffer_load_dword s71, s[8:11], s22
  s_mul_i32 s22, s18, 7168
  s_add_u32 s22, s22, 87040
  s_buffer_load_dword s72, s[8:11], s22
  s_add_u32 s35, s35, 458752
  v_mov_b32 v74, 0
  v_mov_b32 v75, 0
  s_mov_b32 s19, s18
  s_add_u32 s18, s18, 1
  s_mov_b32 s22, s20
  s_mov_b32 s20, s21
  s_mov_b32 s21, s22
  s_add_u32 s23, s20, 4096
  s_cmp_lt_u32 s19, 63
  s_cbranch_scc1 cB_sc2_loop
  s_branch cB_done
cB_sc2_r0:
  s_add_u32 s31, s31, 1
  buffer_load_dwordx4 v[8:11], v2, s[8:11], s20 offen offset:0 sc1
  s_waitcnt vmcnt(0)
  v_cmp_eq_u32 vcc, -1, v8
  v_mov_b32 v36, 0
  v_mov_b32 v37, 0
  v_mov_b32 v38, 0
  v_mov_b32 v39, 0
  v_mov_b32 v40, 0
  v_mov_b32 v41, 0
  v_mov_b32 v42, 0
  v_mov_b32 v43, 0
  v_mov_b32 v44, 0
  v_mov_b32 v45, 0
  v_mov_b32 v46, 0
  v_mov_b32 v47, 0
  v_mov_b32 v48, 0
  v_mov_b32 v49, 0
  v_mov_b32 v50, 0
  v_mov_b32 v51, 0
  s_nop 1
  s_cbranch_vccz cB_sc2_go
  s_add_u32 s30, s30, 1
  s_cmp_lt_u32 s30, 400000
  s_cbranch_scc1 cB_sc2_r0
  s_branch cB_abort
cB_sc2_r1:
  s_add_u32 s31, s31, 1
  buffer_load_dwordx4 v[12:15], v2, s[8:11], s20 offen offset:1024 sc1
  s_waitcnt vmcnt(0)
  v_cmp_eq_u32 vcc, -1, v12
  s_nop 4
  s_cbranch_vccz cB_sc2_c1
  s_add_u32 s30, s30, 1
  s_cmp_lt_u32 s30, 400000
  s_cbranch_scc1 cB_sc2_r1
  s_branch cB_abort
cB_sc2_r2:
  s_add_u32 s31, s31, 1
  buffer_load_dwordx4 v[16:19], v2, s[8:11], s20 offen offset:2048 sc1
  s_waitcnt vmcnt(0)
  v_cmp_eq_u32 vcc, -1, v16
  s_nop 4
  s_cbranch_vccz cB_sc2_c2
  s_add_u32 s30, s30, 1
  s_cmp_lt_u32 s30, 400000
  s_cbranch_scc1 cB_sc2_r2
  s_branch cB_abort
cB_sc2_r3:
  s_add_u32 s31, s31, 1
  buffer_load_dwordx4 v[20:23], v2, s[8:11], s20 offen offset:3072 sc1
  s_waitcnt vmcnt(0)
  v_cmp_eq_u32 vcc, -1, v20
  s_nop 4
  s_cbranch_vccz cB_sc2_c3
  s_add_u32 s30, s30, 1
  s_cmp_lt_u32 s30, 400000
  s_cbranch_scc1 cB_sc2_r3
  s_branch cB_abort
cB_sc2_r4:
  s_add_u32 s31, s31, 1
  buffer_load_dwordx4 v[24:27], v2, s[8:11], s23 offen offset:0 sc1
  buffer_load_dwordx4 v[32:35], v2, s[8:11], s23 offen offset:1024 sc1
  buffer_load_dwordx4 v[28:31], v2, s[8:11], s23 offen offset:2048 sc1
  s_waitcnt vmcnt(0)
  v_max3_u32 v66, v24, v27, v28
  v_max3_u32 v66, v66, v31, v32
  v_max_u32 v66, v66, v35
  v_cmp_eq_u32 vcc, -1, v66
  s_nop 4
  s_cbranch_vccz cB_sc2_c4
  s_add_u32 s30, s30, 1
  s_cmp_lt_u32 s30, 400000
  s_cbranch_scc1 cB_sc2_r4
  s_branch cB_abort
cB_sc2_retry:
  s_cmp_lg_u32 s62, 0
  s_cbranch_scc1 cB_sc2_cont
  s_waitcnt vmcnt(0) lgkmcnt(0)
cB_sc2_rv:
  buffer_load_dwordx4 v[8:11], v2, s[8:11], s20 offen offset:0 sc1
  buffer_load_dwordx4 v[12:15], v2, s[8:11], s20 offen offset:1024 sc1
  buffer_load_dwordx4 v[16:19], v2, s[8:11], s20 offen offset:2048 sc1
  buffer_load_dwordx4 v[20:23], v2, s[8:11], s20 offen offset:3072 sc1
  buffer_load_dwordx4 v[24:27], v2, s[8:11], s23 offen offset:0 sc1
  buffer_load_dwordx4 v[32:35], v2, s[8:11], s23 offen offset:1024 sc1
  buffer_load_dwordx4 v[28:31], v2, s[8:11], s23 offen offset:2048 sc1
  s_waitcnt vmcnt(0)
  v_max3_u32 v66, v8, v9, v10
  v_max3_u32 v66, v66, v11, v12
  v_max3_u32 v66, v66, v13, v14
  v_max3_u32 v66, v66, v15, v16
  v_max3_u32 v66, v66, v17, v18
  v_max3_u32 v66, v66, v19, v20
  v_max3_u32 v66, v66, v21, v22
  v_max3_u32 v66, v66, v23, v24
  v_max3_u32 v66, v66, v25, v26
  v_max3_u32 v66, v66, v27, v28
  v_max3_u32 v66, v66, v29, v30
  v_max3_u32 v66, v66, v31, v32
  v_max3_u32 v66, v66, v33, v34
  v_max_u32 v66, v66, v35
  v_cmp_eq_u32 vcc, -1, v66
  s_cbranch_vccz cB_sc2_rk
  s_add_u32 s30, s30, 1
  s_cmp_lt_u32 s30, 400000
  s_cbranch_scc1 cB_sc2_rv
  s_branch cB_abort
cB_sc2_rk:
  s_mov_b32 s62, 1
  v_mov_b32 v36, 0
  v_mov_b32 v37, 0
  v_mov_b32 v38, 0
  v_mov_b32 v39, 0
  v_mov_b32 v40, 0
  v_mov_b32 v41, 0
  v_mov_b32 v42, 0
  v_mov_b32 v43, 0
  v_mov_b32 v44, 0
  v_mov_b32 v45, 0
  v_mov_b32 v46, 0
  v_mov_b32 v47, 0
  v_mov_b32 v48, 0
  v_mov_b32 v49, 0
  v_mov_b32 v50, 0
  v_mov_b32 v51, 0
  v_mov_b32 v62, 0
  v_mov_b32 v63, 0
  v_mov_b32 v64, 0
  v_mov_b32 v65, 0
  v_mov_b32 v68, 0
  v_mov_b32 v69, 0
  v_mov_b32 v70, 0
  v_mov_b32 v71, 0
  v_mov_b32 v72, 0
  v_mov_b32 v73, 0
  v_mov_b32 v74, 0
  v_mov_b32 v75, 0
  v_mov_b32 v52, 0
  v_mov_b32 v53, 0
  v_mov_b32 v54, 0
  v_mov_b32 v55, 0
  v_mov_b32 v56, 0
  v_mov_b32 v57, 0
  v_mov_b32 v58, 0
  v_mov_b32 v59, 0
  s_add_u32 s31, s31, 0x100
  s_nop 0
  s_branch cB_sc2_go
.p2align 6
cB_sc3_loop:
  s_mov_b32 s30, 0
  s_mov_b32 s62, 0
  s_setprio 3
  s_barrier
  buffer_load_dwordx4 v[8:11], v2, s[8:11], s20 offen offset:0 sc1
  s_setprio 2
  buffer_load_dwordx4 v[12:15], v2, s[8:11], s20 offen offset:1024 sc1
  s_setprio 1
  buffer_load_dwordx4 v[16:19], v2, s[8:11], s20 offen offset:2048 sc1
  s_setprio 0
  buffer_load_dwordx4 v[20:23], v2, s[8:11], s20 offen offset:3072 sc1
cB_sc3_go:
  s_waitcnt vmcnt(3)
  v_smfmac_f32_16x16x64_bf16 v[36:39], v[8:11], a[0:7], v3
  buffer_load_dwordx4 v[24:27], v2, s[8:11], s23 offen offset:0 sc1
  v_cmp_eq_u32 vcc, -1, v8
  v_smfmac_f32_16x16x64_bf16 v[40:43], v[8:11], a[56:63], v3
  v_smfmac_f32_16x16x64_bf16 v[44:47], v[8:11], a[112:119], v3
  buffer_load_dwordx4 v[28:31], v2, s[8:11], s23 offen offset:1024 sc1
  s_cbranch_vccnz cB_sc3_r0
  v_smfmac_f32_16x16x64_bf16 v[48:51], v[8:11], a[168:175], v3
  v_smfmac_f32_16x16x64_bf16 v[52:55], v[8:11], a[224:231], v3
  s_waitcnt vmcnt(4)
  v_cmp_eq_u32 vcc, -1, v12
  v_smfmac_f32_16x16x64_bf16 v[56:59], v[8:11], v[144:151], v3
  buffer_load_dwordx4 v[32:35], v2, s[8:11], s23 offen offset:2048 sc1
  v_smfmac_f32_16x16x64_bf16 v[62:65], v[8:11], v[200:207], v3
  s_cbranch_vccnz cB_sc3_r1
cB_sc3_c1:
  v_smfmac_f32_16x16x64_bf16 v[36:39], v[12:15], a[8:15], v3
  v_smfmac_f32_16x16x64_bf16 v[40:43], v[12:15], a[64:71], v3
  v_smfmac_f32_16x16x64_bf16 v[44:47], v[12:15], a[120:127], v3
  v_smfmac_f32_16x16x64_bf16 v[48:51], v[12:15], a[176:183], v3
  v_smfmac_f32_16x16x64_bf16 v[52:55], v[12:15], a[232:239], v3
  s_waitcnt vmcnt(4)
  v_cmp_eq_u32 vcc, -1, v16
  v_smfmac_f32_16x16x64_bf16 v[56:59], v[12:15], v[152:159], v3
  buffer_load_dwordx4 v[88:91], v117, s[8:11], s26 offen offset:0 sc1
  v_smfmac_f32_16x16x64_bf16 v[62:65], v[12:15], v[208:215], v3
  s_cbranch_vccnz cB_sc3_r2
cB_sc3_c2:
  v_smfmac_f32_16x16x64_bf16 v[36:39], v[16:19], a[16:23], v3
  v_smfmac_f32_16x16x64_bf16 v[40:43], v[16:19], a[72:79], v3
  v_smfmac_f32_16x16x64_bf16 v[44:47], v[16:19], a[128:135], v3
  buffer_load_dwordx4 v[92:95], v117, s[8:11], s26 offen offset:1024 sc1
  v_smfmac_f32_16x16x64_bf16 v[48:51], v[16:19], a[184:191], v3
  v_smfmac_f32_16x16x64_bf16 v[52:55], v[16:19], a[240:247], v3
  s_waitcnt vmcnt(5)
  v_cmp_eq_u32 vcc, -1, v20
  v_smfmac_f32_16x16x64_bf16 v[56:59], v[16:19], v[160:167], v3
  v_smfmac_f32_16x16x64_bf16 v[62:65], v[16:19], v[216:223], v3
  buffer_load_dwordx4 v[96:99], v2, s[8:11], s24 offen offset:0 sc1
  s_cbranch_vccnz cB_sc3_r3
cB_sc3_c3:
  v_smfmac_f32_16x16x64_bf16 v[36:39], v[20:23], a[24:31], v3
  v_smfmac_f32_16x16x64_bf16 v[40:43], v[20:23], a[80:87], v3
  s_waitcnt vmcnt(3)
  v_max3_u32 v66, v24, v27, v28
  v_smfmac_f32_16x16x64_bf16 v[44:47], v[20:23], a[136:143], v3
  v_max3_u32 v66, v66, v31, v32
  v_smfmac_f32_16x16x64_bf16 v[48:51], v[20:23], a[192:199], v3
  buffer_load_dwordx4 v[100:103], v2, s[8:11], s24 offen offset:1024 sc1
  v_max_u32 v66, v66, v35
  v_smfmac_f32_16x16x64_bf16 v[52:55], v[20:23], a[248:255], v3
  v_cmp_eq_u32 vcc, -1, v66
  v_smfmac_f32_16x16x64_bf16 v[56:59], v[20:23], v[168:175], v3
  v_smfmac_f32_16x16x64_bf16 v[62:65], v[20:23], v[224:231], v3
  s_cbranch_vccnz cB_sc3_r4
cB_sc3_c4:
  v_smfmac_f32_16x16x64_bf16 v[62:65], v[24:27], v[232:239], v3
  buffer_load_dwordx4 v[104:107], v2, s[8:11], s26 offen offset:0 sc1
  v_smfmac_f32_16x16x64_bf16 v[62:65], v[28:31], v[240:247], v3
  v_smfmac_f32_16x16x64_bf16 v[62:65], v[32:35], v[248:255], v3
  v_smfmac_f32_16x16x64_bf16 v[52:55], v[24:27], v[120:127], v3
  v_smfmac_f32_16x16x64_bf16 v[52:55], v[28:31], v[128:135], v3
  buffer_load_dwordx4 v[108:111], v2, s[8:11], s26 offen offset:1024 sc1
  v_smfmac_f32_16x16x64_bf16 v[52:55], v[32:35], v[136:143], v3
  v_cvt_pk_bf16_f32 v62, v62, v63
  v_smfmac_f32_16x16x64_bf16 v[56:59], v[24:27], v[176:183], v3
  v_cvt_pk_bf16_f32 v63, v64, v65
  v_smfmac_f32_16x16x64_bf16 v[56:59], v[28:31], v[184:191], v3
  v_mfma_f32_16x16x32_bf16 v[8:11], v[60:63], v[4:7], 0
  v_cvt_pk_bf16_f32 v55, v54, v55
  v_smfmac_f32_16x16x64_bf16 v[56:59], v[32:35], v[192:199], v3
  v_cvt_pk_bf16_f32 v54, v52, v53
  v_smfmac_f32_16x16x64_bf16 v[36:39], v[24:27], a[32:39], v3
  s_nop 1
  v_cvt_pk_bf16_f32 v78, v8, v9
  v_smfmac_f32_16x16x64_bf16 v[36:39], v[28:31], a[40:47], v3
  v_cvt_pk_bf16_f32 v79, v10, v11
  v_smfmac_f32_16x16x64_bf16 v[36:39], v[32:35], a[48:55], v3
  v_cvt_pk_bf16_f32 v56, v56, v57
  v_smfmac_f32_16x16x64_bf16 v[40:43], v[24:27], a[88:95], v3
  v_cvt_pk_bf16_f32 v57, v58, v59
  v_smfmac_f32_16x16x64_bf16 v[40:43], v[28:31], a[96:103], v3
  v_mfma_f32_16x16x32_bf16 v[12:15], v[54:57], v[4:7], 0
  v_cvt_pk_bf16_f32 v39, v38, v39
  v_smfmac_f32_16x16x64_bf16 v[40:43], v[32:35], a[104:111], v3
  v_cvt_pk_bf16_f32 v38, v36, v37
  v_smfmac_f32_16x16x64_bf16 v[44:47], v[24:27], a[144:151], v3
  s_nop 1
  v_cvt_pk_bf16_f32 v76, v12, v13
  v_smfmac_f32_16x16x64_bf16 v[44:47], v[28:31], a[152:159], v3
  v_cvt_pk_bf16_f32 v77, v14, v15
  v_smfmac_f32_16x16x64_bf16 v[44:47], v[32:35], a[160:167], v3
  v_cvt_pk_bf16_f32 v40, v40, v41
  v_smfmac_f32_16x16x64_bf16 v[48:51], v[24:27], a[200:207], v3
  v_cvt_pk_bf16_f32 v41, v42, v43
  v_smfmac_f32_16x16x64_bf16 v[48:51], v[28:31], a[208:215], v3
  v_smfmac_f32_16x16x64_bf16 v[48:51], v[32:35], a[216:223], v3
  s_waitcnt vmcnt(4)
  v_cvt_pk_bf16_f32 v47, v46, v47
  v_smfmac_f32_16x16x64_bf16 v[68:71], v[76:79], v[80:87], v3
  v_cvt_pk_bf16_f32 v46, v44, v45
  v_mfma_f32_16x16x32_bf16 v[8:11], v[38:41], v[4:7], 0
  s_nop 1
  v_cvt_pk_bf16_f32 v48, v48, v49
  v_cvt_pk_bf16_f32 v49, v50, v51
  s_nop 1
  v_mfma_f32_16x16x32_bf16 v[12:15], v[46:49], v[4:7], 0
  v_smfmac_f32_16x16x64_bf16 v[72:75], v[76:79], v[88:95], v3
  v_cvt_pk_bf16_f32 v16, v8, v9
  v_mfma_f32_16x16x32_bf16 v[52:55], v[30:33], v[76:79], 0
  s_waitcnt vmcnt(0)
  v_cvt_pk_bf16_f32 v17, v10, v11
  v_cvt_pk_bf16_f32 v18, v12, v13
  v_cvt_pk_bf16_f32 v19, v14, v15
  s_nop 1
  v_mfma_f32_16x16x32_bf16 v[52:55], v[20:23], v[16:19], v[52:55]
  v_smfmac_f32_16x16x64_bf16 v[68:71], v[16:19], v[96:103], v3
  v_smfmac_f32_16x16x64_bf16 v[72:75], v[16:19], v[104:111], v3
  s_nop 1
  ds_write_b128 v113, v[52:55]
  s_nop 1
  v_permlane32_swap_b32 v68, v70
  v_permlane32_swap_b32 v69, v71
  v_add_f32 v56, v68, v70
  v_add_f32 v58, v69, v71
  v_permlane32_swap_b32 v72, v74
  v_permlane32_swap_b32 v73, v75
  v_add_f32 v57, v72, v74
  v_add_f32 v59, v73, v75
  ds_write_b128 v2, v[56:59] offset:3072
  v_cmp_u_f32 vcc, v57, v59
  v_mov_b32 v68, 0
  v_mov_b32 v69, 0
  v_mov_b32 v70, 0
  v_mov_b32 v71, 0
  s_cbranch_vccnz cB_sc3_retry
cB_sc3_cont:
  s_add_u32 s24, s24, 28672
  s_add_u32 s26, s26, 28672
  buffer_load_dwordx4 v[80:83], v117, s[8:11], s24 offen offset:0 sc1
  buffer_load_dwordx4 v[84:87], v117, s[8:11], s24 offen offset:1024 sc1
  v_mov_b32 v72, 0
  v_mov_b32 v73, 0
  v_mfma_f32_16x16x32_bf16 v[62:65], v[68:71], v[68:71], 0
  s_waitcnt lgkmcnt(0)
  s_barrier
  v_mov_b32 v52, 0
  v_mov_b32 v53, 0
  v_mov_b32 v54, 0
  v_mov_b32 v55, 0
  v_mov_b32 v56, 0
  v_mov_b32 v57, 0
  v_mov_b32 v58, 0
  v_mov_b32 v59, 0
  v_mfma_f32_32x32x16_bf16 v[36:51], v[68:71], v[68:71], 0
  v_mov_b32 v74, 0
  v_mov_b32 v75, 0
  s_mov_b32 s19, s18
  s_add_u32 s18, s18, 1
  s_mov_b32 s22, s20
  s_mov_b32 s20, s21
  s_mov_b32 s21, s22
  s_add_u32 s23, s20, 4096
  s_cmp_lt_u32 s19, 63
  s_nop 2
  s_cbranch_scc1 cB_sc3_loop
  s_branch cB_done
cB_sc3_r0:
  s_add_u32 s31, s31, 1
  buffer_load_dwordx4 v[8:11], v2, s[8:11], s20 offen offset:0 sc1
  s_waitcnt vmcnt(0)
  v_cmp_eq_u32 vcc, -1, v8
  v_mov_b32 v36, 0
  v_mov_b32 v37, 0
  v_mov_b32 v38, 0
  v_mov_b32 v39, 0
  v_mov_b32 v40, 0
  v_mov_b32 v41, 0
  v_mov_b32 v42, 0
  v_mov_b32 v43, 0
  v_mov_b32 v44, 0
  v_mov_b32 v45, 0
  v_mov_b32 v46, 0
  v_mov_b32 v47, 0
  v_mov_b32 v48, 0
  v_mov_b32 v49, 0
  v_mov_b32 v50, 0
  v_mov_b32 v51, 0
  s_nop 1
  s_cbranch_vccz cB_sc3_go
  s_add_u32 s30, s30, 1
  s_cmp_lt_u32 s30, 400000
  s_cbranch_scc1 cB_sc3_r0
  s_branch cB_abort
cB_sc3_r1:
  s_add_u32 s31, s31, 1
  buffer_load_dwordx4 v[12:15], v2, s[8:11], s20 offen offset:1024 sc1
  s_waitcnt vmcnt(0)
  v_cmp_eq_u32 vcc, -1, v12
  s_nop 4
  s_cbranch_vccz cB_sc3_c1
  s_add_u32 s30, s30, 1
  s_cmp_lt_u32 s30, 400000
  s_cbranch_scc1 cB_sc3_r1
  s_branch cB_abort
cB_sc3_r2:
  s_add_u32 s31, s31, 1
  buffer_load_dwordx4 v[16:19], v2, s[8:11], s20 offen offset:2048 sc1
  s_waitcnt vmcnt(0)
  v_cmp_eq_u32 vcc, -1, v16
  s_nop 4
  s_cbranch_vccz cB_sc3_c2
  s_add_u32 s30, s30, 1
  s_cmp_lt_u32 s30, 400000
  s_cbranch_scc1 cB_sc3_r2
  s_branch cB_abort
cB_sc3_r3:
  s_add_u32 s31, s31, 1
  buffer_load_dwordx4 v[20:23], v2, s[8:11], s20 offen offset:3072 sc1
  s_waitcnt vmcnt(0)
  v_cmp_eq_u32 vcc, -1, v20
  s_nop 4
  s_cbranch_vccz cB_sc3_c3
  s_add_u32 s30, s30, 1
  s_cmp_lt_u32 s30, 400000
  s_cbranch_scc1 cB_sc3_r3
  s_branch cB_abort
cB_sc3_r4:
  s_add_u32 s31, s31, 1
  buffer_load_dwordx4 v[24:27], v2, s[8:11], s23 offen offset:0 sc1
  buffer_load_dwordx4 v[28:31], v2, s[8:11], s23 offen offset:1024 sc1
  buffer_load_dwordx4 v[32:35], v2, s[8:11], s23 offen offset:2048 sc1
  s_waitcnt vmcnt(0)
  v_max3_u32 v66, v24, v27, v28
  v_max3_u32 v66, v66, v31, v32
  v_max_u32 v66, v66, v35
  v_cmp_eq_u32 vcc, -1, v66
  s_nop 4
  s_cbranch_vccz cB_sc3_c4
  s_add_u32 s30, s30, 1
  s_cmp_lt_u32 s30, 400000
  s_cbranch_scc1 cB_sc3_r4
  s_branch cB_abort
cB_sc3_retry:
  s_cmp_lg_u32 s62, 0
  s_cbranch_scc1 cB_sc3_cont
  s_waitcnt vmcnt(0) lgkmcnt(0)
cB_sc3_rv:
  buffer_load_dwordx4 v[8:11], v2, s[8:11], s20 offen offset:0 sc1
  buffer_load_dwordx4 v[12:15], v2, s[8:11], s20 offen offset:1024 sc1
  buffer_load_dwordx4 v[16:19], v2, s[8:11], s20 offen offset:2048 sc1
  buffer_load_dwordx4 v[20:23], v2, s[8:11], s20 offen offset:3072 sc1
  buffer_load_dwordx4 v[24:27], v2, s[8:11], s23 offen offset:0 sc1
  buffer_load_dwordx4 v[28:31], v2, s[8:11], s23 offen offset:1024 sc1
  buffer_load_dwordx4 v[32:35], v2, s[8:11], s23 offen offset:2048 sc1
  s_waitcnt vmcnt(0)
  v_max3_u32 v66, v8, v9, v10
  v_max3_u32 v66, v66, v11, v12
  v_max3_u32 v66, v66, v13, v14
  v_max3_u32 v66, v66, v15, v16
  v_max3_u32 v66, v66, v17, v18
  v_max3_u32 v66, v66, v19, v20
  v_max3_u32 v66, v66, v21, v22
  v_max3_u32 v66, v66, v23, v24
  v_max3_u32 v66, v66, v25, v26
  v_max3_u32 v66, v66, v27, v28
  v_max3_u32 v66, v66, v29, v30
  v_max3_u32 v66, v66, v31, v32
  v_max3_u32 v66, v66, v33, v34
  v_max_u32 v66, v66, v35
  v_cmp_eq_u32 vcc, -1, v66
  s_cbranch_vccz cB_sc3_rk
  s_add_u32 s30, s30, 1
  s_cmp_lt_u32 s30, 400000
  s_cbranch_scc1 cB_sc3_rv
  s_branch cB_abort
cB_sc3_rk:
  s_mov_b32 s62, 1
  v_mov_b32 v36, 0
  v_mov_b32 v37, 0
  v_mov_b32 v38, 0
  v_mov_b32 v39, 0
  v_mov_b32 v40, 0
  v_mov_b32 v41, 0
  v_mov_b32 v42, 0
  v_mov_b32 v43, 0
  v_mov_b32 v44, 0
  v_mov_b32 v45, 0
  v_mov_b32 v46, 0
  v_mov_b32 v47, 0
  v_mov_b32 v48, 0
  v_mov_b32 v49, 0
  v_mov_b32 v50, 0
  v_mov_b32 v51, 0
  v_mov_b32 v62, 0
  v_mov_b32 v63, 0
  v_mov_b32 v64, 0
  v_mov_b32 v65, 0
  v_mov_b32 v68, 0
  v_mov_b32 v69, 0
  v_mov_b32 v70, 0
  v_mov_b32 v71, 0
  v_mov_b32 v72, 0
  v_mov_b32 v73, 0
  v_mov_b32 v74, 0
  v_mov_b32 v75, 0
  v_mov_b32 v52, 0
  v_mov_b32 v53, 0
  v_mov_b32 v54, 0
  v_mov_b32 v55, 0
  v_mov_b32 v56, 0
  v_mov_b32 v57, 0
  v_mov_b32 v58, 0
  v_mov_b32 v59, 0
  s_add_u32 s31, s31, 0x100
  s_nop 0
  s_branch cB_sc3_go
.p2align 6
cB_va0_loop:
  s_mov_b32 s30, 0
  s_barrier
  buffer_load_dwordx4 v[24:27], v2, s[8:11], s23 offen offset:0 sc1
  buffer_load_dwordx4 v[28:31], v2, s[8:11], s23 offen offset:1024 sc1
  s_barrier
  s_cmp_lt_u32 s19, 60
  s_cbranch_scc1 cB_va0_m1
  buffer_store_dword v160, v1, s[8:11], s38 offen sc1
  s_cmp_lg_u32 s19, 63
  s_cbranch_scc1 cB_va0_m2
  v_min_u32 v64, -2, v64
  v_min_u32 v65, -2, v65
  v_min_u32 v66, -2, v66
  v_min_u32 v67, -2, v67
  v_min_u32 v68, -2, v68
  v_min_u32 v69, -2, v69
  v_min_u32 v70, -2, v70
  v_min_u32 v71, -2, v71
  v_min_u32 v72, -2, v72
  v_min_u32 v73, -2, v73
  v_min_u32 v74, -2, v74
  v_min_u32 v75, -2, v75
  v_min_u32 v76, -2, v76
  v_min_u32 v77, -2, v77
  v_min_u32 v78, -2, v78
  v_min_u32 v79, -2, v79
  buffer_store_dwordx4 v[64:67], v2, s[8:11], s33 offen offset:0 sc1
  buffer_store_dwordx4 v[68:71], v2, s[8:11], s33 offen offset:2048 sc1
  s_add_u32 s33, s33, 4096
  buffer_store_dwordx4 v[72:75], v2, s[8:11], s33 offen offset:0 sc1
  buffer_store_dwordx4 v[76:79], v2, s[8:11], s33 offen offset:2048 sc1
  s_add_u32 s33, s33, 4096
  s_waitcnt vmcnt(5)
  s_branch cB_va0_m3
cB_va0_m1:
  buffer_store_dword v160, v1, s[8:11], s38 offen sc1
cB_va0_m2:
  s_add_u32 s22, s25, 0
  buffer_load_dwordx4 v[80:83], v6, s[8:11], s22 offen offset:0 sc1
  buffer_load_dwordx4 v[84:87], v6, s[8:11], s22 offen offset:1792 sc1
  s_add_u32 s22, s25, 3584
  buffer_load_dwordx4 v[88:91], v6, s[8:11], s22 offen offset:0 sc1
  buffer_load_dwordx4 v[92:95], v6, s[8:11], s22 offen offset:1792 sc1
  s_add_u32 s22, s25, 7168
  buffer_load_dwordx4 v[96:99], v6, s[8:11], s22 offen offset:0 sc1
  s_mul_i32 s38, s18, 7168
  s_add_u32 s38, s38, 65536
  s_waitcnt vmcnt(6)
cB_va0_m3:
  ds_write_b128 v2, v[24:27] offset:12288
  ds_write_b128 v2, v[28:31] offset:13312
  v_smfmac_f32_16x16x64_bf16 v[36:39], v[24:27], a[32:39], v3
  buffer_load_dwordx4 v[100:103], v6, s[8:11], s22 offen offset:1792 sc1
  v_smfmac_f32_16x16x64_bf16 v[40:43], v[24:27], a[88:95], v3
  s_add_u32 s22, s25, 10752
  buffer_load_dwordx4 v[104:107], v6, s[8:11], s22 offen offset:0 sc1
  v_smfmac_f32_16x16x64_bf16 v[44:47], v[24:27], a[144:151], v3
  buffer_load_dwordx4 v[108:111], v6, s[8:11], s22 offen offset:1792 sc1
  v_smfmac_f32_16x16x64_bf16 v[48:51], v[24:27], a[200:207], v3
  s_add_u32 s22, s25, 14336
  buffer_load_dwordx4 v[112:115], v6, s[8:11], s22 offen offset:0 sc1
  v_smfmac_f32_16x16x64_bf16 v[52:55], v[24:27], v[176:183], v3
  s_waitcnt lgkmcnt(0)
  s_barrier
  ds_read_b128 v[8:11], v2 offset:8192
  ds_read_b128 v[12:15], v2 offset:9216
  ds_read_b128 v[16:19], v2 offset:10240
  ds_read_b128 v[20:23], v2 offset:11264
  ds_read_b128 v[32:35], v2 offset:14336
  buffer_load_dwordx4 v[116:119], v6, s[8:11], s22 offen offset:1792 sc1
  v_smfmac_f32_16x16x64_bf16 v[56:59], v[24:27], v[232:239], v3
  s_add_u32 s22, s25, 17920
  buffer_load_dwordx4 v[120:123], v6, s[8:11], s22 offen offset:0 sc1
  v_smfmac_f32_16x16x64_bf16 v[36:39], v[28:31], a[40:47], v3
  buffer_load_dwordx4 v[124:127], v6, s[8:11], s22 offen offset:1792 sc1
  v_smfmac_f32_16x16x64_bf16 v[40:43], v[28:31], a[96:103], v3
  s_add_u32 s22, s25, 21504
  buffer_load_dwordx4 v[128:131], v6, s[8:11], s22 offen offset:0 sc1
  v_smfmac_f32_16x16x64_bf16 v[44:47], v[28:31], a[152:159], v3
  buffer_load_dwordx4 v[132:135], v6, s[8:11], s22 offen offset:1792 sc1
  v_smfmac_f32_16x16x64_bf16 v[48:51], v[28:31], a[208:215], v3
  s_add_u32 s22, s25, 25088
  buffer_load_dwordx4 v[136:139], v6, s[8:11], s22 offen offset:0 sc1
  v_smfmac_f32_16x16x64_bf16 v[52:55], v[28:31], v[184:191], v3
  buffer_load_dwordx4 v[140:143], v6, s[8:11], s22 offen offset:1792 sc1
  v_smfmac_f32_16x16x64_bf16 v[56:59], v[28:31], v[240:247], v3
  s_waitcnt lgkmcnt(4)
  v_smfmac_f32_16x16x64_bf16 v[36:39], v[8:11], a[0:7], v3
  s_waitcnt lgkmcnt(3)
  v_smfmac_f32_16x16x64_bf16 v[36:39], v[12:15], a[8:15], v3
  s_waitcnt lgkmcnt(2)
  v_smfmac_f32_16x16x64_bf16 v[36:39], v[16:19], a[16:23], v3
  s_waitcnt lgkmcnt(1)
  v_smfmac_f32_16x16x64_bf16 v[36:39], v[20:23], a[24:31], v3
  s_waitcnt lgkmcnt(0)
  v_smfmac_f32_16x16x64_bf16 v[36:39], v[32:35], a[48:55], v3
  v_smfmac_f32_16x16x64_bf16 v[40:43], v[8:11], a[56:63], v3
  v_smfmac_f32_16x16x64_bf16 v[40:43], v[12:15], a[64:71], v3
  v_smfmac_f32_16x16x64_bf16 v[40:43], v[16:19], a[72:79], v3
  v_permlane32_swap_b32 v36, v38
  v_smfmac_f32_16x16x64_bf16 v[40:43], v[20:23], a[80:87], v3
  v_permlane32_swap_b32 v37, v39
  v_smfmac_f32_16x16x64_bf16 v[40:43], v[32:35], a[104:111], v3
  v_add_f32 v36, v36, v38
  v_smfmac_f32_16x16x64_bf16 v[44:47], v[8:11], a[112:119], v3
  v_add_f32 v37, v37, v39
  v_smfmac_f32_16x16x64_bf16 v[44:47], v[12:15], a[120:127], v3
  v_cmp_u_f32 vcc, v36, v37
  v_smfmac_f32_16x16x64_bf16 v[44:47], v[16:19], a[128:135], v3
  v_cvt_pk_bf16_f32 v38, v36, v37
  v_smfmac_f32_16x16x64_bf16 v[44:47], v[20:23], a[136:143], v3
  ds_write_b32 v152, v38
  s_cbranch_vccnz cB_va0_slow
  v_permlane32_swap_b32 v40, v42
  v_smfmac_f32_16x16x64_bf16 v[44:47], v[32:35], a[160:167], v3
  v_permlane32_swap_b32 v41, v43
  v_smfmac_f32_16x16x64_bf16 v[48:51], v[8:11], a[168:175], v3
  buffer_store_dword v162, v1, s[8:11], s21 offen sc1
  v_add_f32 v40, v40, v42
  v_smfmac_f32_16x16x64_bf16 v[48:51], v[12:15], a[176:183], v3
  v_add_f32 v41, v41, v43
  v_smfmac_f32_16x16x64_bf16 v[48:51], v[16:19], a[184:191], v3
  buffer_load_dword v164, v4, s[8:11], 0 offen sc1
  v_cvt_pk_bf16_f32 v42, v40, v41
  v_smfmac_f32_16x16x64_bf16 v[48:51], v[20:23], a[192:199], v3
  ds_write_b32 v153, v42
  v_permlane32_swap_b32 v44, v46
  v_smfmac_f32_16x16x64_bf16 v[48:51], v[32:35], a[216:223], v3
  v_permlane32_swap_b32 v45, v47
  v_smfmac_f32_16x16x64_bf16 v[52:55], v[8:11], a[224:231], v3
  buffer_load_dword v164, v4, s[8:11], 0 offen sc1
  v_add_f32 v44, v44, v46
  v_smfmac_f32_16x16x64_bf16 v[52:55], v[12:15], a[232:239], v3
  v_add_f32 v45, v45, v47
  v_smfmac_f32_16x16x64_bf16 v[52:55], v[16:19], a[240:247], v3
  v_cvt_pk_bf16_f32 v46, v44, v45
  v_smfmac_f32_16x16x64_bf16 v[52:55], v[20:23], a[248:255], v3
  ds_write_b32 v154, v46
  buffer_load_dword v164, v4, s[8:11], 0 offen sc1
  v_permlane32_swap_b32 v48, v50
  v_smfmac_f32_16x16x64_bf16 v[52:55], v[32:35], v[192:199], v3
  v_permlane32_swap_b32 v49, v51
  v_smfmac_f32_16x16x64_bf16 v[56:59], v[8:11], v[200:207], v3
  v_add_f32 v48, v48, v50
  v_smfmac_f32_16x16x64_bf16 v[56:59], v[12:15], v[208:215], v3
  buffer_load_dword v164, v4, s[8:11], 0 offen sc1
  v_add_f32 v49, v49, v51
  v_smfmac_f32_16x16x64_bf16 v[56:59], v[16:19], v[216:223], v3
  v_cvt_pk_bf16_f32 v50, v48, v49
  v_smfmac_f32_16x16x64_bf16 v[56:59], v[20:23], v[224:231], v3
  ds_write_b32 v155, v50
  v_permlane32_swap_b32 v52, v54
  v_smfmac_f32_16x16x64_bf16 v[56:59], v[32:35], v[248:255], v3
  buffer_load_dword v164, v4, s[8:11], 0 offen sc1
  v_permlane32_swap_b32 v53, v55
  v_add_f32 v52, v52, v54
  v_add_f32 v53, v53, v55
  v_cvt_pk_bf16_f32 v54, v52, v53
  ds_write_b32 v156, v54
  s_nop 1
  v_permlane32_swap_b32 v56, v58
  v_permlane32_swap_b32 v57, v59
  v_add_f32 v56, v56, v58
  v_add_f32 v57, v57, v59
  v_cvt_pk_bf16_f32 v58, v56, v57
  ds_write_b32 v157, v58
cB_va0_t2d:
  s_add_u32 s22, s20, 9216
  s_add_u32 s34, s20, 13312
  s_add_u32 s36, s20, 7168
  s_mov_b32 s37, 0
  v_mov_b32 v48, 0
  v_mov_b32 v49, 0
  v_mov_b32 v50, 0
  v_mov_b32 v51, 0
  v_mov_b32 v163, s18
  s_cmp_eq_u32 s19, 63
  s_waitcnt lgkmcnt(0)
  s_cbranch_scc1 cB_va0_last
  s_setprio 3
cB_va0_fw_l:
  v_cmp_gt_u32 vcc, s18, v164
  buffer_load_dword v164, v4, s[8:11], 0 offen sc1
  s_cbranch_vccz cB_va0_fw_d
  v_cmp_gt_u32 vcc, s18, v164
  buffer_load_dword v164, v4, s[8:11], 0 offen sc1
  s_cbranch_vccz cB_va0_fw_d
  v_cmp_gt_u32 vcc, s18, v164
  buffer_load_dword v164, v4, s[8:11], 0 offen sc1
  s_cbranch_vccz cB_va0_fw_d
  v_cmp_gt_u32 vcc, s18, v164
  buffer_load_dword v164, v4, s[8:11], 0 offen sc1
  s_cbranch_vccz cB_va0_fw_d
  v_cmp_gt_u32 vcc, s18, v164
  buffer_load_dword v164, v4, s[8:11], 0 offen sc1
  s_cbranch_vccz cB_va0_fw_d
  v_cmp_gt_u32 vcc, s18, v164
  buffer_load_dword v164, v4, s[8:11], 0 offen sc1
  s_cbranch_vccz cB_va0_fw_d
  v_cmp_gt_u32 vcc, s18, v164
  buffer_load_dword v164, v4, s[8:11], 0 offen sc1
  s_cbranch_vccz cB_va0_fw_d
  v_cmp_gt_u32 vcc, s18, v164
  buffer_load_dword v164, v4, s[8:11], 0 offen sc1
  s_cbranch_vccz cB_va0_fw_d
  v_cmp_gt_u32 vcc, s18, v164
  buffer_load_dword v164, v4, s[8:11], 0 offen sc1
  s_cbranch_vccz cB_va0_fw_d
  v_cmp_gt_u32 vcc, s18, v164
  buffer_load_dword v164, v4, s[8:11], 0 offen sc1
  s_cbranch_vccz cB_va0_fw_d
  v_cmp_gt_u32 vcc, s18, v164
  buffer_load_dword v164, v4, s[8:11], 0 offen sc1
  s_cbranch_vccz cB_va0_fw_d
  v_cmp_gt_u32 vcc, s18, v164
  buffer_load_dword v164, v4, s[8:11], 0 offen sc1
  s_cbranch_vccz cB_va0_fw_d
  v_cmp_gt_u32 vcc, s18, v164
  buffer_load_dword v164, v4, s[8:11], 0 offen sc1
  s_cbranch_vccz cB_va0_fw_d
  v_cmp_gt_u32 vcc, s18, v164
  buffer_load_dword v164, v4, s[8:11], 0 offen sc1
  s_cbranch_vccz cB_va0_fw_d
  v_cmp_gt_u32 vcc, s18, v164
  buffer_load_dword v164, v4, s[8:11], 0 offen sc1
  s_cbranch_vccz cB_va0_fw_d
  v_cmp_gt_u32 vcc, s18, v164
  buffer_load_dword v164, v4, s[8:11], 0 offen sc1
  s_cbranch_vccz cB_va0_fw_d
  s_waitcnt vmcnt(24)
  s_add_u32 s30, s30, 1
  s_cmp_lt_u32 s30, 400000
  s_cbranch_scc1 cB_va0_fw_l
  s_branch cB_abort
cB_va0_fw_d:
  buffer_load_dwordx4 v[8:11], v2, s[8:11], s22 offen offset:0 sc1
  buffer_load_dwordx4 v[12:15], v2, s[8:11], s22 offen offset:1024 sc1
  buffer_load_dwordx4 v[16:19], v2, s[8:11], s22 offen offset:2048 sc1
  buffer_load_dwordx4 v[20:23], v2, s[8:11], s22 offen offset:3072 sc1
  buffer_load_dwordx4 v[24:27], v2, s[8:11], s34 offen offset:0 sc1
  buffer_load_dwordx4 v[28:31], v2, s[8:11], s34 offen offset:1024 sc1
  buffer_load_dwordx4 v[32:35], v2, s[8:11], s34 offen offset:2048 sc1
  buffer_load_dwordx4 v[36:39], v2, s[8:11], s34 offen offset:3072 sc1
  buffer_load_dwordx4 v[40:43], v2, s[8:11], s36 offen offset:0 sc1
  buffer_load_dwordx4 v[44:47], v2, s[8:11], s36 offen offset:1024 sc1
  s_barrier
  ds_read_b128 v[64:67], v2 offset:0
  ds_read_b128 v[68:71], v2 offset:1024
  ds_read_b128 v[72:75], v2 offset:2048
  ds_read_b128 v[76:79], v2 offset:3072
cB_va0_lp:
  s_waitcnt vmcnt(9)
  v_smfmac_f32_16x16x64_bf16 v[48:51], v[8:11], v[80:87], v3
  s_waitcnt vmcnt(8)
  v_smfmac_f32_16x16x64_bf16 v[48:51], v[12:15], v[88:95], v3
  s_waitcnt vmcnt(7)
  v_smfmac_f32_16x16x64_bf16 v[48:51], v[16:19], v[96:103], v3
  s_waitcnt vmcnt(6)
  v_smfmac_f32_16x16x64_bf16 v[48:51], v[20:23], v[104:111], v3
  s_waitcnt vmcnt(5)
  v_smfmac_f32_16x16x64_bf16 v[48:51], v[24:27], v[112:119], v3
  s_waitcnt vmcnt(4)
  v_smfmac_f32_16x16x64_bf16 v[48:51], v[28:31], v[120:127], v3
  s_waitcnt vmcnt(3)
  v_smfmac_f32_16x16x64_bf16 v[48:51], v[32:35], v[128:135], v3
  s_waitcnt vmcnt(2)
  v_smfmac_f32_16x16x64_bf16 v[48:51], v[36:39], v[136:143], v3
  s_waitcnt vmcnt(1) lgkmcnt(0)
  v_smfmac_f32_16x16x64_bf16 v[48:51], v[40:43], v[64:71], v3
  s_waitcnt vmcnt(0)
  v_smfmac_f32_16x16x64_bf16 v[48:51], v[44:47], v[72:79], v3
  s_nop 7
  v_permlane32_swap_b32 v48, v50
  v_permlane32_swap_b32 v49, v51
  v_pk_add_f32 v[48:49], v[48:49], v[50:51]
  v_cvt_pk_bf16_f32 v160, v48, v49
  v_cmp_u_f32 vcc, v48, v49
  s_nop 0
  v_mov_b32_dpp v161, v160 quad_perm:[1,0,3,2] row_mask:0xf bank_mask:0xf
  v_perm_b32 v160, v161, v160, v5
  v_cndmask_b32 v161, v160, v162, vcc
  buffer_store_dword v161, v1, s[8:11], s21 offen sc1
  s_cbranch_vccnz cB_va0_rp
cB_va0_cont:
  s_setprio 0
  s_cmp_lg_u32 s19, 62
  s_cbranch_scc1 cB_va0_nl
  s_sleep 4
  buffer_store_dword v160, v1, s[8:11], s38 offen sc1
  s_mov_b32 s38, 0x40000000
  s_mov_b32 s25, 0x40000000
cB_va0_nl:
  s_add_u32 s25, s25, 458752
  v_mov_b32 v36, 0
  v_mov_b32 v37, 0
  v_mov_b32 v38, 0
  v_mov_b32 v39, 0
  v_mov_b32 v40, 0
  v_mov_b32 v41, 0
  v_mov_b32 v42, 0
  v_mov_b32 v43, 0
  v_mov_b32 v44, 0
  v_mov_b32 v45, 0
  v_mov_b32 v46, 0
  v_mov_b32 v47, 0
  v_mov_b32 v48, 0
  v_mov_b32 v49, 0
  v_mov_b32 v50, 0
  v_mov_b32 v51, 0
  v_mov_b32 v52, 0
  v_mov_b32 v53, 0
  v_mov_b32 v54, 0
  v_mov_b32 v55, 0
  v_mov_b32 v56, 0
  v_mov_b32 v57, 0
  v_mov_b32 v58, 0
  v_mov_b32 v59, 0
  v_mov_b32 v60, 0
  v_mov_b32 v61, 0
  v_mov_b32 v62, 0
  v_mov_b32 v63, 0
  s_mov_b32 s19, s18
  s_add_u32 s18, s18, 1
  s_mov_b32 s22, s20
  s_mov_b32 s20, s21
  s_mov_b32 s21, s22
  s_add_u32 s23, s20, 4096
  s_branch cB_va0_loop
cB_va0_slow:
  s_waitcnt lgkmcnt(0)
cB_va0_sl1:
  s_add_u32 s31, s31, 0x1000000
  buffer_load_dwordx4 v[8:11], v2, s[8:11], s20 offen offset:0 sc1
  buffer_load_dwordx4 v[12:15], v2, s[8:11], s20 offen offset:1024 sc1
  buffer_load_dwordx4 v[16:19], v2, s[8:11], s20 offen offset:2048 sc1
  buffer_load_dwordx4 v[20:23], v2, s[8:11], s20 offen offset:3072 sc1
  buffer_load_dwordx4 v[24:27], v2, s[8:11], s23 offen offset:0 sc1
  buffer_load_dwordx4 v[28:31], v2, s[8:11], s23 offen offset:1024 sc1
  buffer_load_dwordx4 v[32:35], v2, s[8:11], s23 offen offset:2048 sc1
  s_waitcnt vmcnt(0)
  v_max3_u32 v36, v8, v9, v10
  v_max3_u32 v36, v36, v11, v12
  v_max3_u32 v36, v36, v13, v14
  v_max3_u32 v36, v36, v15, v16
  v_max3_u32 v36, v36, v17, v18
  v_max3_u32 v36, v36, v19, v20
  v_max3_u32 v36, v36, v21, v22
  v_max3_u32 v36, v36, v23, v24
  v_max3_u32 v36, v36, v25, v26
  v_max3_u32 v36, v36, v27, v28
  v_max3_u32 v36, v36, v29, v30
  v_max3_u32 v36, v36, v31, v32
  v_max3_u32 v36, v36, v33, v34
  v_max_u32 v36, v36, v35
  v_cmp_eq_u32 vcc, -1, v36
  s_cbranch_vccz cB_va0_sl2
  s_add_u32 s30, s30, 1
  s_cmp_lt_u32 s30, 400000
  s_cbranch_scc1 cB_va0_sl1
  s_branch cB_abort
cB_va0_sl2:
  v_mov_b32 v36, 0
  v_mov_b32 v37, 0
  v_mov_b32 v38, 0
  v_mov_b32 v39, 0
  v_mov_b32 v40, 0
  v_mov_b32 v41, 0
  v_mov_b32 v42, 0
  v_mov_b32 v43, 0
  v_mov_b32 v44, 0
  v_mov_b32 v45, 0
  v_mov_b32 v46, 0
  v_mov_b32 v47, 0
  v_mov_b32 v48, 0
  v_mov_b32 v49, 0
  v_mov_b32 v50, 0
  v_mov_b32 v51, 0
  v_mov_b32 v52, 0
  v_mov_b32 v53, 0
  v_mov_b32 v54, 0
  v_mov_b32 v55, 0
  v_mov_b32 v56, 0
  v_mov_b32 v57, 0
  v_mov_b32 v58, 0
  v_mov_b32 v59, 0
  v_mov_b32 v60, 0
  v_mov_b32 v61, 0
  v_mov_b32 v62, 0
  v_mov_b32 v63, 0
  buffer_store_dword v162, v1, s[8:11], s21 offen sc1
  v_smfmac_f32_16x16x64_bf16 v[36:39], v[8:11], a[0:7], v3
  v_smfmac_f32_16x16x64_bf16 v[40:43], v[8:11], a[56:63], v3
  v_smfmac_f32_16x16x64_bf16 v[44:47], v[8:11], a[112:119], v3
  v_smfmac_f32_16x16x64_bf16 v[48:51], v[8:11], a[168:175], v3
  v_smfmac_f32_16x16x64_bf16 v[52:55], v[8:11], a[224:231], v3
  v_smfmac_f32_16x16x64_bf16 v[56:59], v[8:11], v[200:207], v3
  v_smfmac_f32_16x16x64_bf16 v[36:39], v[12:15], a[8:15], v3
  v_smfmac_f32_16x16x64_bf16 v[40:43], v[12:15], a[64:71], v3
  v_smfmac_f32_16x16x64_bf16 v[44:47], v[12:15], a[120:127], v3
  v_smfmac_f32_16x16x64_bf16 v[48:51], v[12:15], a[176:183], v3
  v_smfmac_f32_16x16x64_bf16 v[52:55], v[12:15], a[232:239], v3
  v_smfmac_f32_16x16x64_bf16 v[56:59], v[12:15], v[208:215], v3
  v_smfmac_f32_16x16x64_bf16 v[36:39], v[16:19], a[16:23], v3
  v_smfmac_f32_16x16x64_bf16 v[40:43], v[16:19], a[72:79], v3
  v_smfmac_f32_16x16x64_bf16 v[44:47], v[16:19], a[128:135], v3
  v_smfmac_f32_16x16x64_bf16 v[48:51], v[16:19], a[184:191], v3
  v_smfmac_f32_16x16x64_bf16 v[52:55], v[16:19], a[240:247], v3
  v_smfmac_f32_16x16x64_bf16 v[56:59], v[16:19], v[216:223], v3
  v_smfmac_f32_16x16x64_bf16 v[36:39], v[20:23], a[24:31], v3
  v_smfmac_f32_16x16x64_bf16 v[40:43], v[20:23], a[80:87], v3
  v_smfmac_f32_16x16x64_bf16 v[44:47], v[20:23], a[136:143], v3
  v_smfmac_f32_16x16x64_bf16 v[48:51], v[20:23], a[192:199], v3
  v_smfmac_f32_16x16x64_bf16 v[52:55], v[20:23], a[248:255], v3
  v_smfmac_f32_16x16x64_bf16 v[56:59], v[20:23], v[224:231], v3
  v_smfmac_f32_16x16x64_bf16 v[36:39], v[24:27], a[32:39], v3
  v_smfmac_f32_16x16x64_bf16 v[40:43], v[24:27], a[88:95], v3
  v_smfmac_f32_16x16x64_bf16 v[44:47], v[24:27], a[144:151], v3
  v_smfmac_f32_16x16x64_bf16 v[48:51], v[24:27], a[200:207], v3
  v_smfmac_f32_16x16x64_bf16 v[52:55], v[24:27], v[176:183], v3
  v_smfmac_f32_16x16x64_bf16 v[56:59], v[24:27], v[232:239], v3
  v_smfmac_f32_16x16x64_bf16 v[36:39], v[28:31], a[40:47], v3
  v_smfmac_f32_16x16x64_bf16 v[40:43], v[28:31], a[96:103], v3
  v_smfmac_f32_16x16x64_bf16 v[44:47], v[28:31], a[152:159], v3
  v_smfmac_f32_16x16x64_bf16 v[48:51], v[28:31], a[208:215], v3
  v_smfmac_f32_16x16x64_bf16 v[52:55], v[28:31], v[184:191], v3
  v_smfmac_f32_16x16x64_bf16 v[56:59], v[28:31], v[240:247], v3
  v_smfmac_f32_16x16x64_bf16 v[36:39], v[32:35], a[48:55], v3
  v_smfmac_f32_16x16x64_bf16 v[40:43], v[32:35], a[104:111], v3
  v_smfmac_f32_16x16x64_bf16 v[44:47], v[32:35], a[160:167], v3
  v_smfmac_f32_16x16x64_bf16 v[48:51], v[32:35], a[216:223], v3
  v_smfmac_f32_16x16x64_bf16 v[52:55], v[32:35], v[192:199], v3
  v_smfmac_f32_16x16x64_bf16 v[56:59], v[32:35], v[248:255], v3
  v_permlane32_swap_b32 v36, v38
  v_permlane32_swap_b32 v37, v39
  v_add_f32 v36, v36, v38
  v_add_f32 v37, v37, v39
  v_cvt_pk_bf16_f32 v38, v36, v37
  ds_write_b32 v152, v38
  v_permlane32_swap_b32 v40, v42
  v_permlane32_swap_b32 v41, v43
  v_add_f32 v40, v40, v42
  v_add_f32 v41, v41, v43
  v_cvt_pk_bf16_f32 v42, v40, v41
  ds_write_b32 v153, v42
  v_permlane32_swap_b32 v44, v46
  v_permlane32_swap_b32 v45, v47
  v_add_f32 v44, v44, v46
  v_add_f32 v45, v45, v47
  v_cvt_pk_bf16_f32 v46, v44, v45
  ds_write_b32 v154, v46
  v_permlane32_swap_b32 v48, v50
  v_permlane32_swap_b32 v49, v51
  v_add_f32 v48, v48, v50
  v_add_f32 v49, v49, v51
  v_cvt_pk_bf16_f32 v50, v48, v49
  ds_write_b32 v155, v50
  v_permlane32_swap_b32 v52, v54
  v_permlane32_swap_b32 v53, v55
  v_add_f32 v52, v52, v54
  v_add_f32 v53, v53, v55
  v_cvt_pk_bf16_f32 v54, v52, v53
  ds_write_b32 v156, v54
  v_permlane32_swap_b32 v56, v58
  v_permlane32_swap_b32 v57, v59
  v_add_f32 v56, v56, v58
  v_add_f32 v57, v57, v59
  v_cvt_pk_bf16_f32 v58, v56, v57
  ds_write_b32 v157, v58
  buffer_load_dword v164, v4, s[8:11], 0 offen sc1
  buffer_load_dword v164, v4, s[8:11], 0 offen sc1
  buffer_load_dword v164, v4, s[8:11], 0 offen sc1
  buffer_load_dword v164, v4, s[8:11], 0 offen sc1
  buffer_load_dword v164, v4, s[8:11], 0 offen sc1
  s_branch cB_va0_t2d
cB_va0_last:
  s_barrier
  ds_read_b128 v[64:67], v2 offset:0
  ds_read_b128 v[68:71], v2 offset:1024
  ds_read_b128 v[72:75], v2 offset:2048
  ds_read_b128 v[76:79], v2 offset:3072
  s_waitcnt lgkmcnt(0)
  v_min_u32 v64, -2, v64
  v_min_u32 v65, -2, v65
  v_min_u32 v66, -2, v66
  v_min_u32 v67, -2, v67
  v_min_u32 v68, -2, v68
  v_min_u32 v69, -2, v69
  v_min_u32 v70, -2, v70
  v_min_u32 v71, -2, v71
  v_min_u32 v72, -2, v72
  v_min_u32 v73, -2, v73
  v_min_u32 v74, -2, v74
  v_min_u32 v75, -2, v75
  v_min_u32 v76, -2, v76
  v_min_u32 v77, -2, v77
  v_min_u32 v78, -2, v78
  v_min_u32 v79, -2, v79
  buffer_store_dwordx4 v[64:67], v2, s[8:11], s33 offen offset:0 sc1
  buffer_store_dwordx4 v[68:71], v2, s[8:11], s33 offen offset:2048 sc1
  s_add_u32 s33, s33, 4096
  buffer_store_dwordx4 v[72:75], v2, s[8:11], s33 offen offset:0 sc1
  buffer_store_dwordx4 v[76:79], v2, s[8:11], s33 offen offset:2048 sc1
  s_add_u32 s33, s33, 4096
  s_cmp_lg_u32 s17, 0
  s_cbranch_scc1 cB_done
  s_waitcnt vmcnt(0)
  buffer_wbl2 sc1
  s_branch cB_done
cB_va0_rp:
  s_cmp_eq_u32 s37, 0
  s_cbranch_scc1 cB_va0_rv
  v_min_u32 v160, -2, v160
  buffer_store_dword v160, v1, s[8:11], s21 offen sc1
  s_branch cB_va0_cont
cB_va0_rv:
  s_add_u32 s31, s31, 0x10000
  buffer_load_dwordx4 v[8:11], v2, s[8:11], s22 offen offset:0 sc1
  buffer_load_dwordx4 v[12:15], v2, s[8:11], s22 offen offset:1024 sc1
  buffer_load_dwordx4 v[16:19], v2, s[8:11], s22 offen offset:2048 sc1
  buffer_load_dwordx4 v[20:23], v2, s[8:11], s22 offen offset:3072 sc1
  buffer_load_dwordx4 v[24:27], v2, s[8:11], s34 offen offset:0 sc1
  buffer_load_dwordx4 v[28:31], v2, s[8:11], s34 offen offset:1024 sc1
  buffer_load_dwordx4 v[32:35], v2, s[8:11], s34 offen offset:2048 sc1
  buffer_load_dwordx4 v[36:39], v2, s[8:11], s34 offen offset:3072 sc1
  buffer_load_dwordx4 v[40:43], v2, s[8:11], s36 offen offset:0 sc1
  buffer_load_dwordx4 v[44:47], v2, s[8:11], s36 offen offset:1024 sc1
  s_waitcnt vmcnt(0)
  v_max3_u32 v52, v8, v9, v10
  v_max3_u32 v52, v52, v11, v12
  v_max3_u32 v52, v52, v13, v14
  v_max3_u32 v52, v52, v15, v16
  v_max3_u32 v52, v52, v17, v18
  v_max3_u32 v52, v52, v19, v20
  v_max3_u32 v52, v52, v21, v22
  v_max3_u32 v52, v52, v23, v24
  v_max3_u32 v52, v52, v25, v26
  v_max3_u32 v52, v52, v27, v28
  v_max3_u32 v52, v52, v29, v30
  v_max3_u32 v52, v52, v31, v32
  v_max3_u32 v52, v52, v33, v34
  v_max3_u32 v52, v52, v35, v36
  v_max3_u32 v52, v52, v37, v38
  v_max3_u32 v52, v52, v39, v40
  v_max3_u32 v52, v52, v41, v42
  v_max3_u32 v52, v52, v43, v44
  v_max3_u32 v52, v52, v45, v46
  v_max_u32 v52, v52, v47
  v_cmp_eq_u32 vcc, -1, v52
  s_mov_b32 s37, 1
  v_mov_b32 v48, 0
  v_mov_b32 v49, 0
  v_mov_b32 v50, 0
  v_mov_b32 v51, 0
  s_nop 1
  s_cbranch_vccz cB_va0_lp
  s_add_u32 s30, s30, 1
  s_cmp_lt_u32 s30, 400000
  s_cbranch_scc1 cB_va0_rv
  s_branch cB_abort
.p2align 6
cB_va1_loop:
  s_mov_b32 s30, 0
  s_barrier
  buffer_load_dwordx4 v[28:31], v2, s[8:11], s23 offen offset:1024 sc1
  buffer_load_dwordx4 v[32:35], v2, s[8:11], s23 offen offset:2048 sc1
  s_barrier
  s_cmp_lt_u32 s19, 60
  s_cbranch_scc1 cB_va1_m1
  buffer_store_dword v160, v1, s[8:11], s38 offen sc1
  s_cmp_lg_u32 s19, 63
  s_cbranch_scc1 cB_va1_m2
  v_min_u32 v64, -2, v64
  v_min_u32 v65, -2, v65
  v_min_u32 v66, -2, v66
  v_min_u32 v67, -2, v67
  v_min_u32 v68, -2, v68
  v_min_u32 v69, -2, v69
  v_min_u32 v70, -2, v70
  v_min_u32 v71, -2, v71
  v_min_u32 v72, -2, v72
  v_min_u32 v73, -2, v73
  v_min_u32 v74, -2, v74
  v_min_u32 v75, -2, v75
  v_min_u32 v76, -2, v76
  v_min_u32 v77, -2, v77
  v_min_u32 v78, -2, v78
  v_min_u32 v79, -2, v79
  buffer_store_dwordx4 v[64:67], v2, s[8:11], s33 offen offset:0 sc1
  buffer_store_dwordx4 v[68:71], v2, s[8:11], s33 offen offset:2048 sc1
  s_add_u32 s33, s33, 4096
  buffer_store_dwordx4 v[72:75], v2, s[8:11], s33 offen offset:0 sc1
  buffer_store_dwordx4 v[76:79], v2, s[8:11], s33 offen offset:2048 sc1
  s_add_u32 s33, s33, 4096
  s_waitcnt vmcnt(5)
  s_branch cB_va1_m3
cB_va1_m1:
  buffer_store_dword v160, v1, s[8:11], s38 offen sc1
cB_va1_m2:
  s_add_u32 s22, s25, 0
  buffer_load_dwordx4 v[80:83], v6, s[8:11], s22 offen offset:0 sc1
  buffer_load_dwordx4 v[84:87], v6, s[8:11], s22 offen offset:1792 sc1
  s_add_u32 s22, s25, 3584
  buffer_load_dwordx4 v[88:91], v6, s[8:11], s22 offen offset:0 sc1
  buffer_load_dwordx4 v[92:95], v6, s[8:11], s22 offen offset:1792 sc1
  s_add_u32 s22, s25, 7168
  buffer_load_dwordx4 v[96:99], v6, s[8:11], s22 offen offset:0 sc1
  s_mul_i32 s38, s18, 7168
  s_add_u32 s38, s38, 65536
  s_waitcnt vmcnt(6)
cB_va1_m3:
  ds_write_b128 v2, v[32:35] offset:14336
  v_smfmac_f32_16x16x64_bf16 v[36:39], v[28:31], a[40:47], v3
  buffer_load_dwordx4 v[100:103], v6, s[8:11], s22 offen offset:1792 sc1
  v_smfmac_f32_16x16x64_bf16 v[40:43], v[28:31], a[96:103], v3
  s_add_u32 s22, s25, 10752
  buffer_load_dwordx4 v[104:107], v6, s[8:11], s22 offen offset:0 sc1
  v_smfmac_f32_16x16x64_bf16 v[44:47], v[28:31], a[152:159], v3
  buffer_load_dwordx4 v[108:111], v6, s[8:11], s22 offen offset:1792 sc1
  v_smfmac_f32_16x16x64_bf16 v[48:51], v[28:31], a[208:215], v3
  s_add_u32 s22, s25, 14336
  buffer_load_dwordx4 v[112:115], v6, s[8:11], s22 offen offset:0 sc1
  v_smfmac_f32_16x16x64_bf16 v[52:55], v[28:31], v[184:191], v3
  s_waitcnt lgkmcnt(0)
  s_barrier
  ds_read_b128 v[8:11], v2 offset:8192
  ds_read_b128 v[12:15], v2 offset:9216
  ds_read_b128 v[16:19], v2 offset:10240
  ds_read_b128 v[20:23], v2 offset:11264
  ds_read_b128 v[24:27], v2 offset:12288
  buffer_load_dwordx4 v[116:119], v6, s[8:11], s22 offen offset:1792 sc1
  v_smfmac_f32_16x16x64_bf16 v[56:59], v[28:31], v[240:247], v3
  s_add_u32 s22, s25, 17920
  buffer_load_dwordx4 v[120:123], v6, s[8:11], s22 offen offset:0 sc1
  v_smfmac_f32_16x16x64_bf16 v[36:39], v[32:35], a[48:55], v3
  buffer_load_dwordx4 v[124:127], v6, s[8:11], s22 offen offset:1792 sc1
  v_smfmac_f32_16x16x64_bf16 v[40:43], v[32:35], a[104:111], v3
  s_add_u32 s22, s25, 21504
  buffer_load_dwordx4 v[128:131], v6, s[8:11], s22 offen offset:0 sc1
  v_smfmac_f32_16x16x64_bf16 v[44:47], v[32:35], a[160:167], v3
  buffer_load_dwordx4 v[132:135], v6, s[8:11], s22 offen offset:1792 sc1
  v_smfmac_f32_16x16x64_bf16 v[48:51], v[32:35], a[216:223], v3
  s_add_u32 s22, s25, 25088
  buffer_load_dwordx4 v[136:139], v6, s[8:11], s22 offen offset:0 sc1
  v_smfmac_f32_16x16x64_bf16 v[52:55], v[32:35], v[192:199], v3
  ds_read_b128 v[64:67], v0 offset:0
  ds_read_b128 v[68:71], v0 offset:1024
  buffer_load_dwordx4 v[140:143], v6, s[8:11], s22 offen offset:1792 sc1
  v_smfmac_f32_16x16x64_bf16 v[56:59], v[32:35], v[248:255], v3
  s_waitcnt lgkmcnt(6)
  ds_read_b128 v[72:75], v0 offset:2048
  ds_read_b128 v[76:79], v0 offset:3072
  v_smfmac_f32_16x16x64_bf16 v[36:39], v[8:11], a[0:7], v3
  s_waitcnt lgkmcnt(7)
  v_smfmac_f32_16x16x64_bf16 v[36:39], v[12:15], a[8:15], v3
  s_waitcnt lgkmcnt(6)
  v_smfmac_f32_16x16x64_bf16 v[36:39], v[16:19], a[16:23], v3
  s_waitcnt lgkmcnt(2)
  v_smfmac_f32_16x16x64_bf16 v[60:63], v[8:11], v[64:71], v3
  s_waitcnt lgkmcnt(5)
  ds_read_b128 v[144:147], v0 offset:4096
  ds_read_b128 v[148:151], v0 offset:5120
  v_smfmac_f32_16x16x64_bf16 v[36:39], v[20:23], a[24:31], v3
  s_waitcnt lgkmcnt(6)
  v_smfmac_f32_16x16x64_bf16 v[36:39], v[24:27], a[32:39], v3
  v_smfmac_f32_16x16x64_bf16 v[40:43], v[8:11], a[56:63], v3
  s_waitcnt lgkmcnt(2)
  v_smfmac_f32_16x16x64_bf16 v[60:63], v[12:15], v[72:79], v3
  ds_read_b128 v[64:67], v0 offset:6144
  ds_read_b128 v[68:71], v0 offset:7168
  v_smfmac_f32_16x16x64_bf16 v[40:43], v[12:15], a[64:71], v3
  v_permlane32_swap_b32 v36, v38
  v_smfmac_f32_16x16x64_bf16 v[40:43], v[16:19], a[72:79], v3
  v_permlane32_swap_b32 v37, v39
  v_smfmac_f32_16x16x64_bf16 v[40:43], v[20:23], a[80:87], v3
  s_waitcnt lgkmcnt(2)
  v_add_f32 v36, v36, v38
  v_smfmac_f32_16x16x64_bf16 v[60:63], v[16:19], v[144:151], v3
  ds_read_b128 v[72:75], v0 offset:8192
  ds_read_b128 v[76:79], v0 offset:9216
  v_add_f32 v37, v37, v39
  v_smfmac_f32_16x16x64_bf16 v[40:43], v[24:27], a[88:95], v3
  v_cmp_u_f32 vcc, v36, v37
  v_smfmac_f32_16x16x64_bf16 v[44:47], v[8:11], a[112:119], v3
  v_cvt_pk_bf16_f32 v38, v36, v37
  v_smfmac_f32_16x16x64_bf16 v[44:47], v[12:15], a[120:127], v3
  ds_write_b32 v152, v38
  s_waitcnt lgkmcnt(3)
  s_cbranch_vccnz cB_va1_slow
  v_permlane32_swap_b32 v40, v42
  v_smfmac_f32_16x16x64_bf16 v[60:63], v[20:23], v[64:71], v3
  ds_read_b128 v[144:147], v0 offset:10240
  ds_read_b128 v[148:151], v0 offset:11264
  v_permlane32_swap_b32 v41, v43
  v_smfmac_f32_16x16x64_bf16 v[44:47], v[16:19], a[128:135], v3
  buffer_store_dword v162, v1, s[8:11], s21 offen sc1
  v_add_f32 v40, v40, v42
  v_smfmac_f32_16x16x64_bf16 v[44:47], v[20:23], a[136:143], v3
  v_add_f32 v41, v41, v43
  v_smfmac_f32_16x16x64_bf16 v[44:47], v[24:27], a[144:151], v3
  s_waitcnt lgkmcnt(3)
  v_cvt_pk_bf16_f32 v42, v40, v41
  v_smfmac_f32_16x16x64_bf16 v[60:63], v[24:27], v[72:79], v3
  ds_write_b32 v153, v42
  ds_read_b128 v[64:67], v0 offset:12288
  ds_read_b128 v[68:71], v0 offset:13312
  v_smfmac_f32_16x16x64_bf16 v[48:51], v[8:11], a[168:175], v3
  s_nop 0
  v_permlane32_swap_b32 v44, v46
  v_smfmac_f32_16x16x64_bf16 v[48:51], v[12:15], a[176:183], v3
  v_permlane32_swap_b32 v45, v47
  v_smfmac_f32_16x16x64_bf16 v[48:51], v[16:19], a[184:191], v3
  s_waitcnt lgkmcnt(3)
  v_add_f32 v44, v44, v46
  v_smfmac_f32_16x16x64_bf16 v[60:63], v[28:31], v[144:151], v3
  v_add_f32 v45, v45, v47
  v_smfmac_f32_16x16x64_bf16 v[48:51], v[20:23], a[192:199], v3
  v_cvt_pk_bf16_f32 v46, v44, v45
  v_smfmac_f32_16x16x64_bf16 v[48:51], v[24:27], a[200:207], v3
  ds_write_b32 v154, v46
  v_smfmac_f32_16x16x64_bf16 v[52:55], v[8:11], a[224:231], v3
  s_waitcnt lgkmcnt(1)
  v_smfmac_f32_16x16x64_bf16 v[60:63], v[32:35], v[64:71], v3
  v_smfmac_f32_16x16x64_bf16 v[52:55], v[12:15], a[232:239], v3
  v_permlane32_swap_b32 v48, v50
  v_smfmac_f32_16x16x64_bf16 v[52:55], v[16:19], a[240:247], v3
  v_permlane32_swap_b32 v49, v51
  v_smfmac_f32_16x16x64_bf16 v[52:55], v[20:23], a[248:255], v3
  v_add_f32 v48, v48, v50
  v_smfmac_f32_16x16x64_bf16 v[52:55], v[24:27], v[176:183], v3
  v_add_f32 v49, v49, v51
  v_smfmac_f32_16x16x64_bf16 v[56:59], v[8:11], v[200:207], v3
  v_cvt_pk_bf16_f32 v50, v48, v49
  v_smfmac_f32_16x16x64_bf16 v[56:59], v[12:15], v[208:215], v3
  ds_write_b32 v155, v50
  v_permlane32_swap_b32 v60, v62
  v_smfmac_f32_16x16x64_bf16 v[56:59], v[16:19], v[216:223], v3
  v_permlane32_swap_b32 v61, v63
  v_smfmac_f32_16x16x64_bf16 v[56:59], v[20:23], v[224:231], v3
  v_add_f32 v60, v60, v62
  v_smfmac_f32_16x16x64_bf16 v[56:59], v[24:27], v[232:239], v3
  v_add_f32 v61, v61, v63
  v_cvt_pk_bf16_f32 v62, v60, v61
  ds_write_b32 v158, v62
  v_permlane32_swap_b32 v52, v54
  v_permlane32_swap_b32 v53, v55
  v_add_f32 v52, v52, v54
  v_add_f32 v53, v53, v55
  v_cvt_pk_bf16_f32 v54, v52, v53
  ds_write_b32 v156, v54
  v_permlane32_swap_b32 v56, v58
  v_permlane32_swap_b32 v57, v59
  v_add_f32 v56, v56, v58
  v_add_f32 v57, v57, v59
  v_cvt_pk_bf16_f32 v58, v56, v57
  ds_write_b32 v157, v58
cB_va1_t2d:
  s_add_u32 s22, s20, 9216
  s_add_u32 s34, s20, 13312
  s_add_u32 s36, s20, 7168
  s_mov_b32 s37, 0
  v_mov_b32 v48, 0
  v_mov_b32 v49, 0
  v_mov_b32 v50, 0
  v_mov_b32 v51, 0
  v_mov_b32 v163, s18
  s_cmp_eq_u32 s19, 63
  s_waitcnt lgkmcnt(0)
  s_cbranch_scc1 cB_va1_last
  s_barrier
  buffer_load_dwordx4 v[8:11], v2, s[8:11], s22 offen offset:0 sc1
  buffer_load_dwordx4 v[12:15], v2, s[8:11], s22 offen offset:1024 sc1
  buffer_load_dwordx4 v[16:19], v2, s[8:11], s22 offen offset:2048 sc1
  buffer_load_dwordx4 v[20:23], v2, s[8:11], s22 offen offset:3072 sc1
  buffer_load_dwordx4 v[24:27], v2, s[8:11], s34 offen offset:0 sc1
  buffer_load_dwordx4 v[28:31], v2, s[8:11], s34 offen offset:1024 sc1
  buffer_load_dwordx4 v[32:35], v2, s[8:11], s34 offen offset:2048 sc1
  buffer_load_dwordx4 v[36:39], v2, s[8:11], s34 offen offset:3072 sc1
  buffer_load_dwordx4 v[40:43], v2, s[8:11], s36 offen offset:0 sc1
  buffer_load_dwordx4 v[44:47], v2, s[8:11], s36 offen offset:1024 sc1
  ds_read_b128 v[64:67], v2 offset:4096
  ds_read_b128 v[68:71], v2 offset:5120
  ds_read_b128 v[72:75], v2 offset:6144
  ds_read_b128 v[76:79], v2 offset:7168
cB_va1_lp:
  s_waitcnt vmcnt(9)
  v_smfmac_f32_16x16x64_bf16 v[48:51], v[8:11], v[80:87], v3
  s_waitcnt vmcnt(8)
  v_smfmac_f32_16x16x64_bf16 v[48:51], v[12:15], v[88:95], v3
  s_waitcnt vmcnt(7)
  v_smfmac_f32_16x16x64_bf16 v[48:51], v[16:19], v[96:103], v3
  v_max3_u32 v55, v8, v12, v16
  s_waitcnt vmcnt(6)
  v_smfmac_f32_16x16x64_bf16 v[48:51], v[20:23], v[104:111], v3
  v_max_u32 v55, v55, v20
  v_cmp_eq_u32 vcc, -1, v55
  s_waitcnt vmcnt(5)
  v_smfmac_f32_16x16x64_bf16 v[48:51], v[24:27], v[112:119], v3
  s_waitcnt vmcnt(4)
  v_smfmac_f32_16x16x64_bf16 v[48:51], v[28:31], v[120:127], v3
  s_cbranch_vccnz cB_va1_rv
  buffer_store_dword v163, v7, s[8:11], 0 offen sc1
  s_waitcnt vmcnt(4)
  v_smfmac_f32_16x16x64_bf16 v[48:51], v[32:35], v[128:135], v3
  s_waitcnt vmcnt(3)
  v_smfmac_f32_16x16x64_bf16 v[48:51], v[36:39], v[136:143], v3
  s_waitcnt vmcnt(2) lgkmcnt(0)
  v_smfmac_f32_16x16x64_bf16 v[48:51], v[40:43], v[64:71], v3
  s_waitcnt vmcnt(1)
  v_smfmac_f32_16x16x64_bf16 v[48:51], v[44:47], v[72:79], v3
  s_nop 7
  v_permlane32_swap_b32 v48, v50
  v_permlane32_swap_b32 v49, v51
  v_pk_add_f32 v[48:49], v[48:49], v[50:51]
  v_cvt_pk_bf16_f32 v160, v48, v49
  v_cmp_u_f32 vcc, v48, v49
  s_nop 0
  v_mov_b32_dpp v161, v160 quad_perm:[1,0,3,2] row_mask:0xf bank_mask:0xf
  v_perm_b32 v160, v161, v160, v5
  v_cndmask_b32 v161, v160, v162, vcc
  buffer_store_dword v161, v1, s[8:11], s21 offen sc1
  s_cbranch_vccnz cB_va1_rp
cB_va1_cont:
  s_cmp_lg_u32 s19, 62
  s_cbranch_scc1 cB_va1_nl
  buffer_store_dword v160, v1, s[8:11], s38 offen sc1
  s_mov_b32 s38, 0x40000000
  s_mov_b32 s25, 0x40000000
cB_va1_nl:
  s_add_u32 s25, s25, 458752
  v_mov_b32 v36, 0
  v_mov_b32 v37, 0
  v_mov_b32 v38, 0
  v_mov_b32 v39, 0
  v_mov_b32 v40, 0
  v_mov_b32 v41, 0
  v_mov_b32 v42, 0
  v_mov_b32 v43, 0
  v_mov_b32 v44, 0
  v_mov_b32 v45, 0
  v_mov_b32 v46, 0
  v_mov_b32 v47, 0
  v_mov_b32 v48, 0
  v_mov_b32 v49, 0
  v_mov_b32 v50, 0
  v_mov_b32 v51, 0
  v_mov_b32 v52, 0
  v_mov_b32 v53, 0
  v_mov_b32 v54, 0
  v_mov_b32 v55, 0
  v_mov_b32 v56, 0
  v_mov_b32 v57, 0
  v_mov_b32 v58, 0
  v_mov_b32 v59, 0
  v_mov_b32 v60, 0
  v_mov_b32 v61, 0
  v_mov_b32 v62, 0
  v_mov_b32 v63, 0
  s_mov_b32 s19, s18
  s_add_u32 s18, s18, 1
  s_mov_b32 s22, s20
  s_mov_b32 s20, s21
  s_mov_b32 s21, s22
  s_add_u32 s23, s20, 4096
  s_branch cB_va1_loop
cB_va1_slow:
  s_waitcnt lgkmcnt(0)
cB_va1_sl1:
  s_add_u32 s31, s31, 0x1000000
  buffer_load_dwordx4 v[8:11], v2, s[8:11], s20 offen offset:0 sc1
  buffer_load_dwordx4 v[12:15], v2, s[8:11], s20 offen offset:1024 sc1
  buffer_load_dwordx4 v[16:19], v2, s[8:11], s20 offen offset:2048 sc1
  buffer_load_dwordx4 v[20:23], v2, s[8:11], s20 offen offset:3072 sc1
  buffer_load_dwordx4 v[24:27], v2, s[8:11], s23 offen offset:0 sc1
  buffer_load_dwordx4 v[28:31], v2, s[8:11], s23 offen offset:1024 sc1
  buffer_load_dwordx4 v[32:35], v2, s[8:11], s23 offen offset:2048 sc1
  s_waitcnt vmcnt(0)
  v_max3_u32 v36, v8, v9, v10
  v_max3_u32 v36, v36, v11, v12
  v_max3_u32 v36, v36, v13, v14
  v_max3_u32 v36, v36, v15, v16
  v_max3_u32 v36, v36, v17, v18
  v_max3_u32 v36, v36, v19, v20
  v_max3_u32 v36, v36, v21, v22
  v_max3_u32 v36, v36, v23, v24
  v_max3_u32 v36, v36, v25, v26
  v_max3_u32 v36, v36, v27, v28
  v_max3_u32 v36, v36, v29, v30
  v_max3_u32 v36, v36, v31, v32
  v_max3_u32 v36, v36, v33, v34
  v_max_u32 v36, v36, v35
  v_cmp_eq_u32 vcc, -1, v36
  s_cbranch_vccz cB_va1_sl2
  s_add_u32 s30, s30, 1
  s_cmp_lt_u32 s30, 400000
  s_cbranch_scc1 cB_va1_sl1
  s_branch cB_abort
cB_va1_sl2:
  v_mov_b32 v36, 0
  v_mov_b32 v37, 0
  v_mov_b32 v38, 0
  v_mov_b32 v39, 0
  v_mov_b32 v40, 0
  v_mov_b32 v41, 0
  v_mov_b32 v42, 0
  v_mov_b32 v43, 0
  v_mov_b32 v44, 0
  v_mov_b32 v45, 0
  v_mov_b32 v46, 0
  v_mov_b32 v47, 0
  v_mov_b32 v48, 0
  v_mov_b32 v49, 0
  v_mov_b32 v50, 0
  v_mov_b32 v51, 0
  v_mov_b32 v52, 0
  v_mov_b32 v53, 0
  v_mov_b32 v54, 0
  v_mov_b32 v55, 0
  v_mov_b32 v56, 0
  v_mov_b32 v57, 0
  v_mov_b32 v58, 0
  v_mov_b32 v59, 0
  v_mov_b32 v60, 0
  v_mov_b32 v61, 0
  v_mov_b32 v62, 0
  v_mov_b32 v63, 0
  buffer_store_dword v162, v1, s[8:11], s21 offen sc1
  ds_read_b128 v[64:67], v0 offset:0
  ds_read_b128 v[68:71], v0 offset:1024
  v_smfmac_f32_16x16x64_bf16 v[36:39], v[8:11], a[0:7], v3
  v_smfmac_f32_16x16x64_bf16 v[40:43], v[8:11], a[56:63], v3
  v_smfmac_f32_16x16x64_bf16 v[44:47], v[8:11], a[112:119], v3
  v_smfmac_f32_16x16x64_bf16 v[48:51], v[8:11], a[168:175], v3
  v_smfmac_f32_16x16x64_bf16 v[52:55], v[8:11], a[224:231], v3
  v_smfmac_f32_16x16x64_bf16 v[56:59], v[8:11], v[200:207], v3
  s_waitcnt lgkmcnt(0)
  v_smfmac_f32_16x16x64_bf16 v[60:63], v[8:11], v[64:71], v3
  ds_read_b128 v[72:75], v0 offset:2048
  ds_read_b128 v[76:79], v0 offset:3072
  v_smfmac_f32_16x16x64_bf16 v[36:39], v[12:15], a[8:15], v3
  v_smfmac_f32_16x16x64_bf16 v[40:43], v[12:15], a[64:71], v3
  v_smfmac_f32_16x16x64_bf16 v[44:47], v[12:15], a[120:127], v3
  v_smfmac_f32_16x16x64_bf16 v[48:51], v[12:15], a[176:183], v3
  v_smfmac_f32_16x16x64_bf16 v[52:55], v[12:15], a[232:239], v3
  v_smfmac_f32_16x16x64_bf16 v[56:59], v[12:15], v[208:215], v3
  s_waitcnt lgkmcnt(0)
  v_smfmac_f32_16x16x64_bf16 v[60:63], v[12:15], v[72:79], v3
  ds_read_b128 v[144:147], v0 offset:4096
  ds_read_b128 v[148:151], v0 offset:5120
  v_smfmac_f32_16x16x64_bf16 v[36:39], v[16:19], a[16:23], v3
  v_smfmac_f32_16x16x64_bf16 v[40:43], v[16:19], a[72:79], v3
  v_smfmac_f32_16x16x64_bf16 v[44:47], v[16:19], a[128:135], v3
  v_smfmac_f32_16x16x64_bf16 v[48:51], v[16:19], a[184:191], v3
  v_smfmac_f32_16x16x64_bf16 v[52:55], v[16:19], a[240:247], v3
  v_smfmac_f32_16x16x64_bf16 v[56:59], v[16:19], v[216:223], v3
  s_waitcnt lgkmcnt(0)
  v_smfmac_f32_16x16x64_bf16 v[60:63], v[16:19], v[144:151], v3
  ds_read_b128 v[64:67], v0 offset:6144
  ds_read_b128 v[68:71], v0 offset:7168
  v_smfmac_f32_16x16x64_bf16 v[36:39], v[20:23], a[24:31], v3
  v_smfmac_f32_16x16x64_bf16 v[40:43], v[20:23], a[80:87], v3
  v_smfmac_f32_16x16x64_bf16 v[44:47], v[20:23], a[136:143], v3
  v_smfmac_f32_16x16x64_bf16 v[48:51], v[20:23], a[192:199], v3
  v_smfmac_f32_16x16x64_bf16 v[52:55], v[20:23], a[248:255], v3
  v_smfmac_f32_16x16x64_bf16 v[56:59], v[20:23], v[224:231], v3
  s_waitcnt lgkmcnt(0)
  v_smfmac_f32_16x16x64_bf16 v[60:63], v[20:23], v[64:71], v3
  ds_read_b128 v[72:75], v0 offset:8192
  ds_read_b128 v[76:79], v0 offset:9216
  v_smfmac_f32_16x16x64_bf16 v[36:39], v[24:27], a[32:39], v3
  v_smfmac_f32_16x16x64_bf16 v[40:43], v[24:27], a[88:95], v3
  v_smfmac_f32_16x16x64_bf16 v[44:47], v[24:27], a[144:151], v3
  v_smfmac_f32_16x16x64_bf16 v[48:51], v[24:27], a[200:207], v3
  v_smfmac_f32_16x16x64_bf16 v[52:55], v[24:27], v[176:183], v3
  v_smfmac_f32_16x16x64_bf16 v[56:59], v[24:27], v[232:239], v3
  s_waitcnt lgkmcnt(0)
  v_smfmac_f32_16x16x64_bf16 v[60:63], v[24:27], v[72:79], v3
  ds_read_b128 v[144:147], v0 offset:10240
  ds_read_b128 v[148:151], v0 offset:11264
  v_smfmac_f32_16x16x64_bf16 v[36:39], v[28:31], a[40:47], v3
  v_smfmac_f32_16x16x64_bf16 v[40:43], v[28:31], a[96:103], v3
  v_smfmac_f32_16x16x64_bf16 v[44:47], v[28:31], a[152:159], v3
  v_smfmac_f32_16x16x64_bf16 v[48:51], v[28:31], a[208:215], v3
  v_smfmac_f32_16x16x64_bf16 v[52:55], v[28:31], v[184:191], v3
  v_smfmac_f32_16x16x64_bf16 v[56:59], v[28:31], v[240:247], v3
  s_waitcnt lgkmcnt(0)
  v_smfmac_f32_16x16x64_bf16 v[60:63], v[28:31], v[144:151], v3
  ds_read_b128 v[64:67], v0 offset:12288
  ds_read_b128 v[68:71], v0 offset:13312
  v_smfmac_f32_16x16x64_bf16 v[36:39], v[32:35], a[48:55], v3
  v_smfmac_f32_16x16x64_bf16 v[40:43], v[32:35], a[104:111], v3
  v_smfmac_f32_16x16x64_bf16 v[44:47], v[32:35], a[160:167], v3
  v_smfmac_f32_16x16x64_bf16 v[48:51], v[32:35], a[216:223], v3
  v_smfmac_f32_16x16x64_bf16 v[52:55], v[32:35], v[192:199], v3
  v_smfmac_f32_16x16x64_bf16 v[56:59], v[32:35], v[248:255], v3
  s_waitcnt lgkmcnt(0)
  v_smfmac_f32_16x16x64_bf16 v[60:63], v[32:35], v[64:71], v3
  v_permlane32_swap_b32 v36, v38
  v_permlane32_swap_b32 v37, v39
  v_add_f32 v36, v36, v38
  v_add_f32 v37, v37, v39
  v_cvt_pk_bf16_f32 v38, v36, v37
  ds_write_b32 v152, v38
  v_permlane32_swap_b32 v40, v42
  v_permlane32_swap_b32 v41, v43
  v_add_f32 v40, v40, v42
  v_add_f32 v41, v41, v43
  v_cvt_pk_bf16_f32 v42, v40, v41
  ds_write_b32 v153, v42
  v_permlane32_swap_b32 v44, v46
  v_permlane32_swap_b32 v45, v47
  v_add_f32 v44, v44, v46
  v_add_f32 v45, v45, v47
  v_cvt_pk_bf16_f32 v46, v44, v45
  ds_write_b32 v154, v46
  v_permlane32_swap_b32 v48, v50
  v_permlane32_swap_b32 v49, v51
  v_add_f32 v48, v48, v50
  v_add_f32 v49, v49, v51
  v_cvt_pk_bf16_f32 v50, v48, v49
  ds_write_b32 v155, v50
  v_permlane32_swap_b32 v52, v54
  v_permlane32_swap_b32 v53, v55
  v_add_f32 v52, v52, v54
  v_add_f32 v53, v53, v55
  v_cvt_pk_bf16_f32 v54, v52, v53
  ds_write_b32 v156, v54
  v_permlane32_swap_b32 v56, v58
  v_permlane32_swap_b32 v57, v59
  v_add_f32 v56, v56, v58
  v_add_f32 v57, v57, v59
  v_cvt_pk_bf16_f32 v58, v56, v57
  ds_write_b32 v157, v58
  v_permlane32_swap_b32 v60, v62
  v_permlane32_swap_b32 v61, v63
  v_add_f32 v60, v60, v62
  v_add_f32 v61, v61, v63
  v_cvt_pk_bf16_f32 v62, v60, v61
  ds_write_b32 v158, v62
  s_branch cB_va1_t2d
cB_va1_last:
  s_barrier
  ds_read_b128 v[64:67], v2 offset:4096
  ds_read_b128 v[68:71], v2 offset:5120
  ds_read_b128 v[72:75], v2 offset:6144
  ds_read_b128 v[76:79], v2 offset:7168
  s_waitcnt lgkmcnt(0)
  v_min_u32 v64, -2, v64
  v_min_u32 v65, -2, v65
  v_min_u32 v66, -2, v66
  v_min_u32 v67, -2, v67
  v_min_u32 v68, -2, v68
  v_min_u32 v69, -2, v69
  v_min_u32 v70, -2, v70
  v_min_u32 v71, -2, v71
  v_min_u32 v72, -2, v72
  v_min_u32 v73, -2, v73
  v_min_u32 v74, -2, v74
  v_min_u32 v75, -2, v75
  v_min_u32 v76, -2, v76
  v_min_u32 v77, -2, v77
  v_min_u32 v78, -2, v78
  v_min_u32 v79, -2, v79
  buffer_store_dwordx4 v[64:67], v2, s[8:11], s33 offen offset:0 sc1
  buffer_store_dwordx4 v[68:71], v2, s[8:11], s33 offen offset:2048 sc1
  s_add_u32 s33, s33, 4096
  buffer_store_dwordx4 v[72:75], v2, s[8:11], s33 offen offset:0 sc1
  buffer_store_dwordx4 v[76:79], v2, s[8:11], s33 offen offset:2048 sc1
  s_add_u32 s33, s33, 4096
  s_branch cB_done
cB_va1_rp:
  s_cmp_eq_u32 s37, 0
  s_cbranch_scc1 cB_va1_rv
  v_min_u32 v160, -2, v160
  buffer_store_dword v160, v1, s[8:11], s21 offen sc1
  s_branch cB_va1_cont
cB_va1_rv:
  s_add_u32 s31, s31, 0x10000
  buffer_load_dwordx4 v[8:11], v2, s[8:11], s22 offen offset:0 sc1
  buffer_load_dwordx4 v[12:15], v2, s[8:11], s22 offen offset:1024 sc1
  buffer_load_dwordx4 v[16:19], v2, s[8:11], s22 offen offset:2048 sc1
  buffer_load_dwordx4 v[20:23], v2, s[8:11], s22 offen offset:3072 sc1
  buffer_load_dwordx4 v[24:27], v2, s[8:11], s34 offen offset:0 sc1
  buffer_load_dwordx4 v[28:31], v2, s[8:11], s34 offen offset:1024 sc1
  buffer_load_dwordx4 v[32:35], v2, s[8:11], s34 offen offset:2048 sc1
  buffer_load_dwordx4 v[36:39], v2, s[8:11], s34 offen offset:3072 sc1
  buffer_load_dwordx4 v[40:43], v2, s[8:11], s36 offen offset:0 sc1
  buffer_load_dwordx4 v[44:47], v2, s[8:11], s36 offen offset:1024 sc1
  s_waitcnt vmcnt(0)
  v_max3_u32 v52, v8, v9, v10
  v_max3_u32 v52, v52, v11, v12
  v_max3_u32 v52, v52, v13, v14
  v_max3_u32 v52, v52, v15, v16
  v_max3_u32 v52, v52, v17, v18
  v_max3_u32 v52, v52, v19, v20
  v_max3_u32 v52, v52, v21, v22
  v_max3_u32 v52, v52, v23, v24
  v_max3_u32 v52, v52, v25, v26
  v_max3_u32 v52, v52, v27, v28
  v_max3_u32 v52, v52, v29, v30
  v_max3_u32 v52, v52, v31, v32
  v_max3_u32 v52, v52, v33, v34
  v_max3_u32 v52, v52, v35, v36
  v_max3_u32 v52, v52, v37, v38
  v_max3_u32 v52, v52, v39, v40
  v_max3_u32 v52, v52, v41, v42
  v_max3_u32 v52, v52, v43, v44
  v_max3_u32 v52, v52, v45, v46
  v_max_u32 v52, v52, v47
  v_cmp_eq_u32 vcc, -1, v52
  s_mov_b32 s37, 1
  v_mov_b32 v48, 0
  v_mov_b32 v49, 0
  v_mov_b32 v50, 0
  v_mov_b32 v51, 0
  s_nop 1
  s_cbranch_vccz cB_va1_lp
  s_add_u32 s30, s30, 1
  s_cmp_lt_u32 s30, 400000
  s_cbranch_scc1 cB_va1_rv
  s_branch cB_abort
.p2align 6
cB_va2_loop:
  s_mov_b32 s30, 0
cB_va2_fp_l:
  v_cmp_gt_u32 vcc, s19, v96
  buffer_load_dword v96, v119, s[8:11], 0 offen sc1
  s_cbranch_vccz cB_va2_fp_d
  v_cmp_gt_u32 vcc, s19, v96
  buffer_load_dword v96, v119, s[8:11], 0 offen sc1
  s_cbranch_vccz cB_va2_fp_d
  v_cmp_gt_u32 vcc, s19, v96
  buffer_load_dword v96, v119, s[8:11], 0 offen sc1
  s_cbranch_vccz cB_va2_fp_d
  v_cmp_gt_u32 vcc, s19, v96
  buffer_load_dword v96, v119, s[8:11], 0 offen sc1
  s_cbranch_vccz cB_va2_fp_d
  v_cmp_gt_u32 vcc, s19, v96
  buffer_load_dword v96, v119, s[8:11], 0 offen sc1
  s_cbranch_vccz cB_va2_fp_d
  v_cmp_gt_u32 vcc, s19, v96
  buffer_load_dword v96, v119, s[8:11], 0 offen sc1
  s_cbranch_vccz cB_va2_fp_d
  v_cmp_gt_u32 vcc, s19, v96
  buffer_load_dword v96, v119, s[8:11], 0 offen sc1
  s_cbranch_vccz cB_va2_fp_d
  v_cmp_gt_u32 vcc, s19, v96
  buffer_load_dword v96, v119, s[8:11], 0 offen sc1
  s_cbranch_vccz cB_va2_fp_d
  v_cmp_gt_u32 vcc, s19, v96
  buffer_load_dword v96, v119, s[8:11], 0 offen sc1
  s_cbranch_vccz cB_va2_fp_d
  v_cmp_gt_u32 vcc, s19, v96
  buffer_load_dword v96, v119, s[8:11], 0 offen sc1
  s_cbranch_vccz cB_va2_fp_d
  v_cmp_gt_u32 vcc, s19, v96
  buffer_load_dword v96, v119, s[8:11], 0 offen sc1
  s_cbranch_vccz cB_va2_fp_d
  v_cmp_gt_u32 vcc, s19, v96
  buffer_load_dword v96, v119, s[8:11], 0 offen sc1
  s_cbranch_vccz cB_va2_fp_d
  v_cmp_gt_u32 vcc, s19, v96
  buffer_load_dword v96, v119, s[8:11], 0 offen sc1
  s_cbranch_vccz cB_va2_fp_d
  v_cmp_gt_u32 vcc, s19, v96
  buffer_load_dword v96, v119, s[8:11], 0 offen sc1
  s_cbranch_vccz cB_va2_fp_d
  v_cmp_gt_u32 vcc, s19, v96
  buffer_load_dword v96, v119, s[8:11], 0 offen sc1
  s_cbranch_vccz cB_va2_fp_d
  v_cmp_gt_u32 vcc, s19, v96
  buffer_load_dword v96, v119, s[8:11], 0 offen sc1
  s_cbranch_vccz cB_va2_fp_d
  s_waitcnt vmcnt(24)
  s_add_u32 s30, s30, 1
  s_cmp_lt_u32 s30, 400000
  s_cbranch_scc1 cB_va2_fp_l
  s_branch cB_abort
cB_va2_fp_d:
  buffer_load_dwordx4 v[8:11], v2, s[8:11], s20 offen offset:0 sc1
  buffer_load_dwordx4 v[12:15], v2, s[8:11], s20 offen offset:1024 sc1
  s_barrier
  s_barrier
  s_waitcnt vmcnt(0)
  ds_write_b128 v2, v[8:11] offset:8192
  ds_write_b128 v2, v[12:15] offset:9216
  v_smfmac_f32_16x16x64_bf16 v[36:39], v[8:11], a[0:7], v3
  v_smfmac_f32_16x16x64_bf16 v[40:43], v[8:11], a[56:63], v3
  v_smfmac_f32_16x16x64_bf16 v[44:47], v[8:11], a[112:119], v3
  v_smfmac_f32_16x16x64_bf16 v[48:51], v[8:11], a[168:175], v3
  v_smfmac_f32_16x16x64_bf16 v[52:55], v[8:11], a[224:231], v3
  s_waitcnt lgkmcnt(0)
  s_barrier
  ds_read_b128 v[16:19], v2 offset:10240
  ds_read_b128 v[20:23], v2 offset:11264
  ds_read_b128 v[24:27], v2 offset:12288
  ds_read_b128 v[28:31], v2 offset:13312
  ds_read_b128 v[32:35], v2 offset:14336
  v_smfmac_f32_16x16x64_bf16 v[56:59], v[8:11], v[144:151], v3
  v_smfmac_f32_16x16x64_bf16 v[60:63], v[8:11], v[200:207], v3
  v_smfmac_f32_16x16x64_bf16 v[36:39], v[12:15], a[8:15], v3
  v_smfmac_f32_16x16x64_bf16 v[40:43], v[12:15], a[64:71], v3
  v_smfmac_f32_16x16x64_bf16 v[44:47], v[12:15], a[120:127], v3
  v_smfmac_f32_16x16x64_bf16 v[48:51], v[12:15], a[176:183], v3
  v_smfmac_f32_16x16x64_bf16 v[52:55], v[12:15], a[232:239], v3
  v_smfmac_f32_16x16x64_bf16 v[56:59], v[12:15], v[152:159], v3
  ds_read_b128 v[68:71], v0 offset:0
  ds_read_b128 v[72:75], v0 offset:1024
  v_smfmac_f32_16x16x64_bf16 v[60:63], v[12:15], v[208:215], v3
  s_waitcnt lgkmcnt(6)
  ds_read_b128 v[76:79], v0 offset:2048
  ds_read_b128 v[80:83], v0 offset:3072
  v_smfmac_f32_16x16x64_bf16 v[36:39], v[16:19], a[16:23], v3
  s_waitcnt lgkmcnt(7)
  v_smfmac_f32_16x16x64_bf16 v[36:39], v[20:23], a[24:31], v3
  s_waitcnt lgkmcnt(6)
  v_smfmac_f32_16x16x64_bf16 v[36:39], v[24:27], a[32:39], v3
  s_waitcnt lgkmcnt(2)
  v_smfmac_f32_16x16x64_bf16 v[64:67], v[8:11], v[68:75], v3
  s_waitcnt lgkmcnt(5)
  ds_read_b128 v[84:87], v0 offset:4096
  ds_read_b128 v[88:91], v0 offset:5120
  v_smfmac_f32_16x16x64_bf16 v[36:39], v[28:31], a[40:47], v3
  s_waitcnt lgkmcnt(6)
  v_smfmac_f32_16x16x64_bf16 v[36:39], v[32:35], a[48:55], v3
  v_smfmac_f32_16x16x64_bf16 v[40:43], v[16:19], a[72:79], v3
  s_waitcnt lgkmcnt(2)
  v_smfmac_f32_16x16x64_bf16 v[64:67], v[12:15], v[76:83], v3
  ds_read_b128 v[68:71], v0 offset:6144
  ds_read_b128 v[72:75], v0 offset:7168
  v_smfmac_f32_16x16x64_bf16 v[40:43], v[20:23], a[80:87], v3
  v_permlane32_swap_b32 v36, v38
  v_smfmac_f32_16x16x64_bf16 v[40:43], v[24:27], a[88:95], v3
  v_permlane32_swap_b32 v37, v39
  v_smfmac_f32_16x16x64_bf16 v[40:43], v[28:31], a[96:103], v3
  s_waitcnt lgkmcnt(2)
  v_add_f32 v36, v36, v38
  v_smfmac_f32_16x16x64_bf16 v[64:67], v[16:19], v[84:91], v3
  ds_read_b128 v[76:79], v0 offset:8192
  ds_read_b128 v[80:83], v0 offset:9216
  v_add_f32 v37, v37, v39
  v_smfmac_f32_16x16x64_bf16 v[40:43], v[32:35], a[104:111], v3
  v_cmp_u_f32 vcc, v36, v37
  v_smfmac_f32_16x16x64_bf16 v[44:47], v[16:19], a[128:135], v3
  v_cvt_pk_bf16_f32 v38, v36, v37
  v_smfmac_f32_16x16x64_bf16 v[44:47], v[20:23], a[136:143], v3
  ds_write_b32 v104, v38
  s_waitcnt lgkmcnt(3)
  s_cbranch_vccnz cB_va2_slow
  v_permlane32_swap_b32 v40, v42
  v_smfmac_f32_16x16x64_bf16 v[64:67], v[20:23], v[68:75], v3
  ds_read_b128 v[84:87], v0 offset:10240
  ds_read_b128 v[88:91], v0 offset:11264
  v_permlane32_swap_b32 v41, v43
  v_smfmac_f32_16x16x64_bf16 v[44:47], v[24:27], a[144:151], v3
  v_add_f32 v40, v40, v42
  v_smfmac_f32_16x16x64_bf16 v[44:47], v[28:31], a[152:159], v3
  v_add_f32 v41, v41, v43
  v_smfmac_f32_16x16x64_bf16 v[44:47], v[32:35], a[160:167], v3
  s_waitcnt lgkmcnt(3)
  v_cvt_pk_bf16_f32 v42, v40, v41
  v_smfmac_f32_16x16x64_bf16 v[64:67], v[24:27], v[76:83], v3
  ds_write_b32 v105, v42
  ds_read_b128 v[68:71], v0 offset:12288
  ds_read_b128 v[72:75], v0 offset:13312
  v_smfmac_f32_16x16x64_bf16 v[48:51], v[16:19], a[184:191], v3
  s_nop 0
  v_permlane32_swap_b32 v44, v46
  v_smfmac_f32_16x16x64_bf16 v[48:51], v[20:23], a[192:199], v3
  v_permlane32_swap_b32 v45, v47
  v_smfmac_f32_16x16x64_bf16 v[48:51], v[24:27], a[200:207], v3
  s_waitcnt lgkmcnt(3)
  v_add_f32 v44, v44, v46
  v_smfmac_f32_16x16x64_bf16 v[64:67], v[28:31], v[84:91], v3
  v_add_f32 v45, v45, v47
  v_smfmac_f32_16x16x64_bf16 v[48:51], v[28:31], a[208:215], v3
  v_cvt_pk_bf16_f32 v46, v44, v45
  v_smfmac_f32_16x16x64_bf16 v[48:51], v[32:35], a[216:223], v3
  ds_write_b32 v106, v46
  v_smfmac_f32_16x16x64_bf16 v[52:55], v[16:19], a[240:247], v3
  s_waitcnt lgkmcnt(1)
  v_smfmac_f32_16x16x64_bf16 v[64:67], v[32:35], v[68:75], v3
  v_smfmac_f32_16x16x64_bf16 v[52:55], v[20:23], a[248:255], v3
  v_permlane32_swap_b32 v48, v50
  v_smfmac_f32_16x16x64_bf16 v[52:55], v[24:27], v[120:127], v3
  v_permlane32_swap_b32 v49, v51
  v_smfmac_f32_16x16x64_bf16 v[52:55], v[28:31], v[128:135], v3
  v_add_f32 v48, v48, v50
  v_smfmac_f32_16x16x64_bf16 v[52:55], v[32:35], v[136:143], v3
  v_add_f32 v49, v49, v51
  v_smfmac_f32_16x16x64_bf16 v[56:59], v[16:19], v[160:167], v3
  v_cvt_pk_bf16_f32 v50, v48, v49
  v_smfmac_f32_16x16x64_bf16 v[56:59], v[20:23], v[168:175], v3
  ds_write_b32 v107, v50
  v_permlane32_swap_b32 v64, v66
  v_smfmac_f32_16x16x64_bf16 v[56:59], v[24:27], v[176:183], v3
  v_permlane32_swap_b32 v65, v67
  v_smfmac_f32_16x16x64_bf16 v[56:59], v[28:31], v[184:191], v3
  v_add_f32 v64, v64, v66
  v_smfmac_f32_16x16x64_bf16 v[56:59], v[32:35], v[192:199], v3
  v_add_f32 v65, v65, v67
  v_smfmac_f32_16x16x64_bf16 v[60:63], v[16:19], v[216:223], v3
  v_cvt_pk_bf16_f32 v66, v64, v65
  v_smfmac_f32_16x16x64_bf16 v[60:63], v[20:23], v[224:231], v3
  ds_write_b32 v111, v66
  v_permlane32_swap_b32 v52, v54
  v_smfmac_f32_16x16x64_bf16 v[60:63], v[24:27], v[232:239], v3
  v_permlane32_swap_b32 v53, v55
  v_smfmac_f32_16x16x64_bf16 v[60:63], v[28:31], v[240:247], v3
  v_add_f32 v52, v52, v54
  v_smfmac_f32_16x16x64_bf16 v[60:63], v[32:35], v[248:255], v3
  v_add_f32 v53, v53, v55
  v_cvt_pk_bf16_f32 v54, v52, v53
  ds_write_b32 v108, v54
  v_permlane32_swap_b32 v56, v58
  v_permlane32_swap_b32 v57, v59
  v_add_f32 v56, v56, v58
  v_add_f32 v57, v57, v59
  v_cvt_pk_bf16_f32 v58, v56, v57
  ds_write_b32 v109, v58
  v_permlane32_swap_b32 v60, v62
  v_permlane32_swap_b32 v61, v63
  v_add_f32 v60, v60, v62
  v_add_f32 v61, v61, v63
  v_cvt_pk_bf16_f32 v62, v60, v61
  ds_write_b32 v110, v62
cB_va2_t2d:
  v_mov_b32 v117, s18
  s_waitcnt lgkmcnt(0)
  s_barrier
  s_cmp_eq_u32 s19, 63
  s_cbranch_scc1 cB_done
  s_sleep 1
  v_mov_b32 v36, 0
  v_mov_b32 v37, 0
  v_mov_b32 v38, 0
  v_mov_b32 v39, 0
  v_mov_b32 v40, 0
  v_mov_b32 v41, 0
  v_mov_b32 v42, 0
  v_mov_b32 v43, 0
  v_mov_b32 v44, 0
  v_mov_b32 v45, 0
  v_mov_b32 v46, 0
  v_mov_b32 v47, 0
  v_mov_b32 v48, 0
  v_mov_b32 v49, 0
  v_mov_b32 v50, 0
  v_mov_b32 v51, 0
  v_mov_b32 v52, 0
  v_mov_b32 v53, 0
  v_mov_b32 v54, 0
  v_mov_b32 v55, 0
  v_mov_b32 v56, 0
  v_mov_b32 v57, 0
  v_mov_b32 v58, 0
  v_mov_b32 v59, 0
  v_mov_b32 v60, 0
  v_mov_b32 v61, 0
  v_mov_b32 v62, 0
  v_mov_b32 v63, 0
  v_mov_b32 v64, 0
  v_mov_b32 v65, 0
  v_mov_b32 v66, 0
  v_mov_b32 v67, 0
  s_sleep 5
  s_mov_b32 s19, s18
  s_add_u32 s18, s18, 1
  s_mov_b32 s22, s20
  s_mov_b32 s20, s21
  s_mov_b32 s21, s22
  s_add_u32 s23, s20, 4096
  s_branch cB_va2_loop
cB_va2_slow:
  s_waitcnt lgkmcnt(0)
cB_va2_sl1:
  s_add_u32 s31, s31, 0x1000000
  buffer_load_dwordx4 v[8:11], v2, s[8:11], s20 offen offset:0 sc1
  buffer_load_dwordx4 v[12:15], v2, s[8:11], s20 offen offset:1024 sc1
  buffer_load_dwordx4 v[16:19], v2, s[8:11], s20 offen offset:2048 sc1
  buffer_load_dwordx4 v[20:23], v2, s[8:11], s20 offen offset:3072 sc1
  buffer_load_dwordx4 v[24:27], v2, s[8:11], s23 offen offset:0 sc1
  buffer_load_dwordx4 v[28:31], v2, s[8:11], s23 offen offset:1024 sc1
  buffer_load_dwordx4 v[32:35], v2, s[8:11], s23 offen offset:2048 sc1
  s_waitcnt vmcnt(0)
  v_max3_u32 v36, v8, v9, v10
  v_max3_u32 v36, v36, v11, v12
  v_max3_u32 v36, v36, v13, v14
  v_max3_u32 v36, v36, v15, v16
  v_max3_u32 v36, v36, v17, v18
  v_max3_u32 v36, v36, v19, v20
  v_max3_u32 v36, v36, v21, v22
  v_max3_u32 v36, v36, v23, v24
  v_max3_u32 v36, v36, v25, v26
  v_max3_u32 v36, v36, v27, v28
  v_max3_u32 v36, v36, v29, v30
  v_max3_u32 v36, v36, v31, v32
  v_max3_u32 v36, v36, v33, v34
  v_max_u32 v36, v36, v35
  v_cmp_eq_u32 vcc, -1, v36
  s_cbranch_vccz cB_va2_sl2
  s_add_u32 s30, s30, 1
  s_cmp_lt_u32 s30, 400000
  s_cbranch_scc1 cB_va2_sl1
  s_branch cB_abort
cB_va2_sl2:
  v_mov_b32 v36, 0
  v_mov_b32 v37, 0
  v_mov_b32 v38, 0
  v_mov_b32 v39, 0
  v_mov_b32 v40, 0
  v_mov_b32 v41, 0
  v_mov_b32 v42, 0
  v_mov_b32 v43, 0
  v_mov_b32 v44, 0
  v_mov_b32 v45, 0
  v_mov_b32 v46, 0
  v_mov_b32 v47, 0
  v_mov_b32 v48, 0
  v_mov_b32 v49, 0
  v_mov_b32 v50, 0
  v_mov_b32 v51, 0
  v_mov_b32 v52, 0
  v_mov_b32 v53, 0
  v_mov_b32 v54, 0
  v_mov_b32 v55, 0
  v_mov_b32 v56, 0
  v_mov_b32 v57, 0
  v_mov_b32 v58, 0
  v_mov_b32 v59, 0
  v_mov_b32 v60, 0
  v_mov_b32 v61, 0
  v_mov_b32 v62, 0
  v_mov_b32 v63, 0
  v_mov_b32 v64, 0
  v_mov_b32 v65, 0
  v_mov_b32 v66, 0
  v_mov_b32 v67, 0
  ds_read_b128 v[68:71], v0 offset:0
  ds_read_b128 v[72:75], v0 offset:1024
  v_smfmac_f32_16x16x64_bf16 v[36:39], v[8:11], a[0:7], v3
  v_smfmac_f32_16x16x64_bf16 v[40:43], v[8:11], a[56:63], v3
  v_smfmac_f32_16x16x64_bf16 v[44:47], v[8:11], a[112:119], v3
  v_smfmac_f32_16x16x64_bf16 v[48:51], v[8:11], a[168:175], v3
  v_smfmac_f32_16x16x64_bf16 v[52:55], v[8:11], a[224:231], v3
  v_smfmac_f32_16x16x64_bf16 v[56:59], v[8:11], v[144:151], v3
  v_smfmac_f32_16x16x64_bf16 v[60:63], v[8:11], v[200:207], v3
  s_waitcnt lgkmcnt(0)
  v_smfmac_f32_16x16x64_bf16 v[64:67], v[8:11], v[68:75], v3
  ds_read_b128 v[76:79], v0 offset:2048
  ds_read_b128 v[80:83], v0 offset:3072
  v_smfmac_f32_16x16x64_bf16 v[36:39], v[12:15], a[8:15], v3
  v_smfmac_f32_16x16x64_bf16 v[40:43], v[12:15], a[64:71], v3
  v_smfmac_f32_16x16x64_bf16 v[44:47], v[12:15], a[120:127], v3
  v_smfmac_f32_16x16x64_bf16 v[48:51], v[12:15], a[176:183], v3
  v_smfmac_f32_16x16x64_bf16 v[52:55], v[12:15], a[232:239], v3
  v_smfmac_f32_16x16x64_bf16 v[56:59], v[12:15], v[152:159], v3
  v_smfmac_f32_16x16x64_bf16 v[60:63], v[12:15], v[208:215], v3
  s_waitcnt lgkmcnt(0)
  v_smfmac_f32_16x16x64_bf16 v[64:67], v[12:15], v[76:83], v3
  ds_read_b128 v[84:87], v0 offset:4096
  ds_read_b128 v[88:91], v0 offset:5120
  v_smfmac_f32_16x16x64_bf16 v[36:39], v[16:19], a[16:23], v3
  v_smfmac_f32_16x16x64_bf16 v[40:43], v[16:19], a[72:79], v3
  v_smfmac_f32_16x16x64_bf16 v[44:47], v[16:19], a[128:135], v3
  v_smfmac_f32_16x16x64_bf16 v[48:51], v[16:19], a[184:191], v3
  v_smfmac_f32_16x16x64_bf16 v[52:55], v[16:19], a[240:247], v3
  v_smfmac_f32_16x16x64_bf16 v[56:59], v[16:19], v[160:167], v3
  v_smfmac_f32_16x16x64_bf16 v[60:63], v[16:19], v[216:223], v3
  s_waitcnt lgkmcnt(0)
  v_smfmac_f32_16x16x64_bf16 v[64:67], v[16:19], v[84:91], v3
  ds_read_b128 v[68:71], v0 offset:6144
  ds_read_b128 v[72:75], v0 offset:7168
  v_smfmac_f32_16x16x64_bf16 v[36:39], v[20:23], a[24:31], v3
  v_smfmac_f32_16x16x64_bf16 v[40:43], v[20:23], a[80:87], v3
  v_smfmac_f32_16x16x64_bf16 v[44:47], v[20:23], a[136:143], v3
  v_smfmac_f32_16x16x64_bf16 v[48:51], v[20:23], a[192:199], v3
  v_smfmac_f32_16x16x64_bf16 v[52:55], v[20:23], a[248:255], v3
  v_smfmac_f32_16x16x64_bf16 v[56:59], v[20:23], v[168:175], v3
  v_smfmac_f32_16x16x64_bf16 v[60:63], v[20:23], v[224:231], v3
  s_waitcnt lgkmcnt(0)
  v_smfmac_f32_16x16x64_bf16 v[64:67], v[20:23], v[68:75], v3
  ds_read_b128 v[76:79], v0 offset:8192
  ds_read_b128 v[80:83], v0 offset:9216
  v_smfmac_f32_16x16x64_bf16 v[36:39], v[24:27], a[32:39], v3
  v_smfmac_f32_16x16x64_bf16 v[40:43], v[24:27], a[88:95], v3
  v_smfmac_f32_16x16x64_bf16 v[44:47], v[24:27], a[144:151], v3
  v_smfmac_f32_16x16x64_bf16 v[48:51], v[24:27], a[200:207], v3
  v_smfmac_f32_16x16x64_bf16 v[52:55], v[24:27], v[120:127], v3
  v_smfmac_f32_16x16x64_bf16 v[56:59], v[24:27], v[176:183], v3
  v_smfmac_f32_16x16x64_bf16 v[60:63], v[24:27], v[232:239], v3
  s_waitcnt lgkmcnt(0)
  v_smfmac_f32_16x16x64_bf16 v[64:67], v[24:27], v[76:83], v3
  ds_read_b128 v[84:87], v0 offset:10240
  ds_read_b128 v[88:91], v0 offset:11264
  v_smfmac_f32_16x16x64_bf16 v[36:39], v[28:31], a[40:47], v3
  v_smfmac_f32_16x16x64_bf16 v[40:43], v[28:31], a[96:103], v3
  v_smfmac_f32_16x16x64_bf16 v[44:47], v[28:31], a[152:159], v3
  v_smfmac_f32_16x16x64_bf16 v[48:51], v[28:31], a[208:215], v3
  v_smfmac_f32_16x16x64_bf16 v[52:55], v[28:31], v[128:135], v3
  v_smfmac_f32_16x16x64_bf16 v[56:59], v[28:31], v[184:191], v3
  v_smfmac_f32_16x16x64_bf16 v[60:63], v[28:31], v[240:247], v3
  s_waitcnt lgkmcnt(0)
  v_smfmac_f32_16x16x64_bf16 v[64:67], v[28:31], v[84:91], v3
  ds_read_b128 v[68:71], v0 offset:12288
  ds_read_b128 v[72:75], v0 offset:13312
  v_smfmac_f32_16x16x64_bf16 v[36:39], v[32:35], a[48:55], v3
  v_smfmac_f32_16x16x64_bf16 v[40:43], v[32:35], a[104:111], v3
  v_smfmac_f32_16x16x64_bf16 v[44:47], v[32:35], a[160:167], v3
  v_smfmac_f32_16x16x64_bf16 v[48:51], v[32:35], a[216:223], v3
  v_smfmac_f32_16x16x64_bf16 v[52:55], v[32:35], v[136:143], v3
  v_smfmac_f32_16x16x64_bf16 v[56:59], v[32:35], v[192:199], v3
  v_smfmac_f32_16x16x64_bf16 v[60:63], v[32:35], v[248:255], v3
  s_waitcnt lgkmcnt(0)
  v_smfmac_f32_16x16x64_bf16 v[64:67], v[32:35], v[68:75], v3
  v_permlane32_swap_b32 v36, v38
  v_permlane32_swap_b32 v37, v39
  v_add_f32 v36, v36, v38
  v_add_f32 v37, v37, v39
  v_cvt_pk_bf16_f32 v38, v36, v37
  ds_write_b32 v104, v38
  v_permlane32_swap_b32 v40, v42
  v_permlane32_swap_b32 v41, v43
  v_add_f32 v40, v40, v42
  v_add_f32 v41, v41, v43
  v_cvt_pk_bf16_f32 v42, v40, v41
  ds_write_b32 v105, v42
  v_permlane32_swap_b32 v44, v46
  v_permlane32_swap_b32 v45, v47
  v_add_f32 v44, v44, v46
  v_add_f32 v45, v45, v47
  v_cvt_pk_bf16_f32 v46, v44, v45
  ds_write_b32 v106, v46
  v_permlane32_swap_b32 v48, v50
  v_permlane32_swap_b32 v49, v51
  v_add_f32 v48, v48, v50
  v_add_f32 v49, v49, v51
  v_cvt_pk_bf16_f32 v50, v48, v49
  ds_write_b32 v107, v50
  v_permlane32_swap_b32 v52, v54
  v_permlane32_swap_b32 v53, v55
  v_add_f32 v52, v52, v54
  v_add_f32 v53, v53, v55
  v_cvt_pk_bf16_f32 v54, v52, v53
  ds_write_b32 v108, v54
  v_permlane32_swap_b32 v56, v58
  v_permlane32_swap_b32 v57, v59
  v_add_f32 v56, v56, v58
  v_add_f32 v57, v57, v59
  v_cvt_pk_bf16_f32 v58, v56, v57
  ds_write_b32 v109, v58
  v_permlane32_swap_b32 v60, v62
  v_permlane32_swap_b32 v61, v63
  v_add_f32 v60, v60, v62
  v_add_f32 v61, v61, v63
  v_cvt_pk_bf16_f32 v62, v60, v61
  ds_write_b32 v110, v62
  v_permlane32_swap_b32 v64, v66
  v_permlane32_swap_b32 v65, v67
  v_add_f32 v64, v64, v66
  v_add_f32 v65, v65, v67
  v_cvt_pk_bf16_f32 v66, v64, v65
  ds_write_b32 v111, v66
  s_branch cB_va2_t2d
.p2align 6
cB_va3_loop:
  s_mov_b32 s30, 0
  s_barrier
  buffer_load_dwordx4 v[16:19], v2, s[8:11], s20 offen offset:2048 sc1
  buffer_load_dwordx4 v[20:23], v2, s[8:11], s20 offen offset:3072 sc1
  s_barrier
  buffer_load_dword v100, v116, s[8:11], s39 offen sc1
  s_add_u32 s27, s19, 2
  s_min_u32 s27, s27, 63
  s_lshr_b32 s27, s27, 3
  s_lshl_b32 s27, s27, 11
  s_add_u32 s27, s27, s35
  s_cmp_eq_u32 s27, s28
  s_cselect_b32 s29, 35328, s27
  buffer_load_dword v101, off, s[8:11], s29 sc1
  s_add_u32 s39, s39, 28672
  s_waitcnt vmcnt(2)
  ds_write_b128 v2, v[16:19] offset:10240
  ds_write_b128 v2, v[20:23] offset:11264
  v_smfmac_f32_16x16x64_bf16 v[36:39], v[16:19], a[16:23], v3
  v_smfmac_f32_16x16x64_bf16 v[40:43], v[16:19], a[72:79], v3
  v_smfmac_f32_16x16x64_bf16 v[44:47], v[16:19], a[128:135], v3
  v_smfmac_f32_16x16x64_bf16 v[48:51], v[16:19], a[184:191], v3
  v_smfmac_f32_16x16x64_bf16 v[52:55], v[16:19], a[240:247], v3
  s_waitcnt lgkmcnt(0)
  s_barrier
  ds_read_b128 v[8:11], v2 offset:8192
  ds_read_b128 v[12:15], v2 offset:9216
  ds_read_b128 v[24:27], v2 offset:12288
  ds_read_b128 v[28:31], v2 offset:13312
  ds_read_b128 v[32:35], v2 offset:14336
  v_smfmac_f32_16x16x64_bf16 v[56:59], v[16:19], v[160:167], v3
  v_smfmac_f32_16x16x64_bf16 v[60:63], v[16:19], v[216:223], v3
  v_smfmac_f32_16x16x64_bf16 v[36:39], v[20:23], a[24:31], v3
  v_smfmac_f32_16x16x64_bf16 v[40:43], v[20:23], a[80:87], v3
  v_smfmac_f32_16x16x64_bf16 v[44:47], v[20:23], a[136:143], v3
  v_smfmac_f32_16x16x64_bf16 v[48:51], v[20:23], a[192:199], v3
  v_smfmac_f32_16x16x64_bf16 v[52:55], v[20:23], a[248:255], v3
  v_smfmac_f32_16x16x64_bf16 v[56:59], v[20:23], v[168:175], v3
  v_smfmac_f32_16x16x64_bf16 v[60:63], v[20:23], v[224:231], v3
  s_waitcnt lgkmcnt(4)
  v_smfmac_f32_16x16x64_bf16 v[36:39], v[8:11], a[0:7], v3
  s_waitcnt lgkmcnt(3)
  v_smfmac_f32_16x16x64_bf16 v[36:39], v[12:15], a[8:15], v3
  s_waitcnt lgkmcnt(2)
  v_smfmac_f32_16x16x64_bf16 v[36:39], v[24:27], a[32:39], v3
  s_waitcnt lgkmcnt(1)
  v_smfmac_f32_16x16x64_bf16 v[36:39], v[28:31], a[40:47], v3
  s_waitcnt lgkmcnt(0)
  v_smfmac_f32_16x16x64_bf16 v[36:39], v[32:35], a[48:55], v3
  v_smfmac_f32_16x16x64_bf16 v[40:43], v[8:11], a[56:63], v3
  v_smfmac_f32_16x16x64_bf16 v[40:43], v[12:15], a[64:71], v3
  v_smfmac_f32_16x16x64_bf16 v[40:43], v[24:27], a[88:95], v3
  v_permlane32_swap_b32 v36, v38
  v_smfmac_f32_16x16x64_bf16 v[40:43], v[28:31], a[96:103], v3
  v_permlane32_swap_b32 v37, v39
  v_smfmac_f32_16x16x64_bf16 v[40:43], v[32:35], a[104:111], v3
  v_add_f32 v36, v36, v38
  v_smfmac_f32_16x16x64_bf16 v[44:47], v[8:11], a[112:119], v3
  v_add_f32 v37, v37, v39
  v_smfmac_f32_16x16x64_bf16 v[44:47], v[12:15], a[120:127], v3
  v_cmp_u_f32 vcc, v36, v37
  v_smfmac_f32_16x16x64_bf16 v[44:47], v[24:27], a[144:151], v3
  v_cvt_pk_bf16_f32 v38, v36, v37
  v_smfmac_f32_16x16x64_bf16 v[44:47], v[28:31], a[152:159], v3
  ds_write_b32 v104, v38
  s_cbranch_vccnz cB_va3_slow
  v_permlane32_swap_b32 v40, v42
  v_smfmac_f32_16x16x64_bf16 v[44:47], v[32:35], a[160:167], v3
  v_permlane32_swap_b32 v41, v43
  v_smfmac_f32_16x16x64_bf16 v[48:51], v[8:11], a[168:175], v3
  v_add_f32 v40, v40, v42
  v_smfmac_f32_16x16x64_bf16 v[48:51], v[12:15], a[176:183], v3
  v_add_f32 v41, v41, v43
  v_smfmac_f32_16x16x64_bf16 v[48:51], v[24:27], a[200:207], v3
  v_cvt_pk_bf16_f32 v42, v40, v41
  v_smfmac_f32_16x16x64_bf16 v[48:51], v[28:31], a[208:215], v3
  ds_write_b32 v105, v42
  v_permlane32_swap_b32 v44, v46
  v_smfmac_f32_16x16x64_bf16 v[48:51], v[32:35], a[216:223], v3
  v_permlane32_swap_b32 v45, v47
  v_smfmac_f32_16x16x64_bf16 v[52:55], v[8:11], a[224:231], v3
  v_add_f32 v44, v44, v46
  v_smfmac_f32_16x16x64_bf16 v[52:55], v[12:15], a[232:239], v3
  v_add_f32 v45, v45, v47
  v_smfmac_f32_16x16x64_bf16 v[52:55], v[24:27], v[120:127], v3
  v_cvt_pk_bf16_f32 v46, v44, v45
  v_smfmac_f32_16x16x64_bf16 v[52:55], v[28:31], v[128:135], v3
  ds_write_b32 v106, v46
  v_permlane32_swap_b32 v48, v50
  v_smfmac_f32_16x16x64_bf16 v[52:55], v[32:35], v[136:143], v3
  v_permlane32_swap_b32 v49, v51
  v_smfmac_f32_16x16x64_bf16 v[56:59], v[8:11], v[144:151], v3
  v_add_f32 v48, v48, v50
  v_smfmac_f32_16x16x64_bf16 v[56:59], v[12:15], v[152:159], v3
  v_add_f32 v49, v49, v51
  v_smfmac_f32_16x16x64_bf16 v[56:59], v[24:27], v[176:183], v3
  v_cvt_pk_bf16_f32 v50, v48, v49
  v_smfmac_f32_16x16x64_bf16 v[56:59], v[28:31], v[184:191], v3
  ds_write_b32 v107, v50
  v_permlane32_swap_b32 v52, v54
  v_smfmac_f32_16x16x64_bf16 v[56:59], v[32:35], v[192:199], v3
  v_permlane32_swap_b32 v53, v55
  v_smfmac_f32_16x16x64_bf16 v[60:63], v[8:11], v[200:207], v3
  v_add_f32 v52, v52, v54
  v_smfmac_f32_16x16x64_bf16 v[60:63], v[12:15], v[208:215], v3
  v_add_f32 v53, v53, v55
  v_smfmac_f32_16x16x64_bf16 v[60:63], v[24:27], v[232:239], v3
  v_cvt_pk_bf16_f32 v54, v52, v53
  v_smfmac_f32_16x16x64_bf16 v[60:63], v[28:31], v[240:247], v3
  ds_write_b32 v108, v54
  v_permlane32_swap_b32 v56, v58
  v_smfmac_f32_16x16x64_bf16 v[60:63], v[32:35], v[248:255], v3
  v_permlane32_swap_b32 v57, v59
  v_add_f32 v56, v56, v58
  v_add_f32 v57, v57, v59
  v_cvt_pk_bf16_f32 v58, v56, v57
  ds_write_b32 v109, v58
  s_nop 2
  v_permlane32_swap_b32 v60, v62
  v_permlane32_swap_b32 v61, v63
  v_add_f32 v60, v60, v62
  v_add_f32 v61, v61, v63
  v_cvt_pk_bf16_f32 v62, v60, v61
  ds_write_b32 v110, v62
cB_va3_t2d:
  v_mov_b32 v117, s18
  s_cmp_eq_u32 s27, s28
  s_cbranch_scc1 cB_va3_vok
cB_va3_vow:
  s_waitcnt vmcnt(0)
  v_cmp_ne_u32 vcc, 56, v101
  s_cbranch_vccnz cB_va3_vor
  s_mov_b32 s28, s27
cB_va3_vok:
  s_waitcnt lgkmcnt(0)
  s_setprio 3
  s_barrier
  v_mov_b32 v36, 0
  v_mov_b32 v37, 0
  buffer_store_dword v117, v118, s[8:11], 0 offen sc1
  s_setprio 0
  s_cmp_eq_u32 s19, 63
  s_cbranch_scc1 cB_done
  v_mov_b32 v38, 0
  v_mov_b32 v39, 0
  v_mov_b32 v40, 0
  v_mov_b32 v41, 0
  v_mov_b32 v42, 0
  v_mov_b32 v43, 0
  v_mov_b32 v44, 0
  v_mov_b32 v45, 0
  v_mov_b32 v46, 0
  v_mov_b32 v47, 0
  v_mov_b32 v48, 0
  v_mov_b32 v49, 0
  v_mov_b32 v50, 0
  v_mov_b32 v51, 0
  v_mov_b32 v52, 0
  v_mov_b32 v53, 0
  v_mov_b32 v54, 0
  v_mov_b32 v55, 0
  v_mov_b32 v56, 0
  v_mov_b32 v57, 0
  v_mov_b32 v58, 0
  v_mov_b32 v59, 0
  v_mov_b32 v60, 0
  v_mov_b32 v61, 0
  v_mov_b32 v62, 0
  v_mov_b32 v63, 0
  s_mov_b32 s19, s18
  s_add_u32 s18, s18, 1
  s_mov_b32 s22, s20
  s_mov_b32 s20, s21
  s_mov_b32 s21, s22
  s_add_u32 s23, s20, 4096
  s_branch cB_va3_loop
cB_va3_slow:
  s_waitcnt lgkmcnt(0)
cB_va3_sl1:
  s_add_u32 s31, s31, 0x1000000
  buffer_load_dwordx4 v[8:11], v2, s[8:11], s20 offen offset:0 sc1
  buffer_load_dwordx4 v[12:15], v2, s[8:11], s20 offen offset:1024 sc1
  buffer_load_dwordx4 v[16:19], v2, s[8:11], s20 offen offset:2048 sc1
  buffer_load_dwordx4 v[20:23], v2, s[8:11], s20 offen offset:3072 sc1
  buffer_load_dwordx4 v[24:27], v2, s[8:11], s23 offen offset:0 sc1
  buffer_load_dwordx4 v[28:31], v2, s[8:11], s23 offen offset:1024 sc1
  buffer_load_dwordx4 v[32:35], v2, s[8:11], s23 offen offset:2048 sc1
  s_waitcnt vmcnt(0)
  v_max3_u32 v36, v8, v9, v10
  v_max3_u32 v36, v36, v11, v12
  v_max3_u32 v36, v36, v13, v14
  v_max3_u32 v36, v36, v15, v16
  v_max3_u32 v36, v36, v17, v18
  v_max3_u32 v36, v36, v19, v20
  v_max3_u32 v36, v36, v21, v22
  v_max3_u32 v36, v36, v23, v24
  v_max3_u32 v36, v36, v25, v26
  v_max3_u32 v36, v36, v27, v28
  v_max3_u32 v36, v36, v29, v30
  v_max3_u32 v36, v36, v31, v32
  v_max3_u32 v36, v36, v33, v34
  v_max_u32 v36, v36, v35
  v_cmp_eq_u32 vcc, -1, v36
  s_cbranch_vccz cB_va3_sl2
  s_add_u32 s30, s30, 1
  s_cmp_lt_u32 s30, 400000
  s_cbranch_scc1 cB_va3_sl1
  s_branch cB_abort
cB_va3_sl2:
  v_mov_b32 v36, 0
  v_mov_b32 v37, 0
  v_mov_b32 v38, 0
  v_mov_b32 v39, 0
  v_mov_b32 v40, 0
  v_mov_b32 v41, 0
  v_mov_b32 v42, 0
  v_mov_b32 v43, 0
  v_mov_b32 v44, 0
  v_mov_b32 v45, 0
  v_mov_b32 v46, 0
  v_mov_b32 v47, 0
  v_mov_b32 v48, 0
  v_mov_b32 v49, 0
  v_mov_b32 v50, 0
  v_mov_b32 v51, 0
  v_mov_b32 v52, 0
  v_mov_b32 v53, 0
  v_mov_b32 v54, 0
  v_mov_b32 v55, 0
  v_mov_b32 v56, 0
  v_mov_b32 v57, 0
  v_mov_b32 v58, 0
  v_mov_b32 v59, 0
  v_mov_b32 v60, 0
  v_mov_b32 v61, 0
  v_mov_b32 v62, 0
  v_mov_b32 v63, 0
  v_smfmac_f32_16x16x64_bf16 v[36:39], v[8:11], a[0:7], v3
  v_smfmac_f32_16x16x64_bf16 v[40:43], v[8:11], a[56:63], v3
  v_smfmac_f32_16x16x64_bf16 v[44:47], v[8:11], a[112:119], v3
  v_smfmac_f32_16x16x64_bf16 v[48:51], v[8:11], a[168:175], v3
  v_smfmac_f32_16x16x64_bf16 v[52:55], v[8:11], a[224:231], v3
  v_smfmac_f32_16x16x64_bf16 v[56:59], v[8:11], v[144:151], v3
  v_smfmac_f32_16x16x64_bf16 v[60:63], v[8:11], v[200:207], v3
  v_smfmac_f32_16x16x64_bf16 v[36:39], v[12:15], a[8:15], v3
  v_smfmac_f32_16x16x64_bf16 v[40:43], v[12:15], a[64:71], v3
  v_smfmac_f32_16x16x64_bf16 v[44:47], v[12:15], a[120:127], v3
  v_smfmac_f32_16x16x64_bf16 v[48:51], v[12:15], a[176:183], v3
  v_smfmac_f32_16x16x64_bf16 v[52:55], v[12:15], a[232:239], v3
  v_smfmac_f32_16x16x64_bf16 v[56:59], v[12:15], v[152:159], v3
  v_smfmac_f32_16x16x64_bf16 v[60:63], v[12:15], v[208:215], v3
  v_smfmac_f32_16x16x64_bf16 v[36:39], v[16:19], a[16:23], v3
  v_smfmac_f32_16x16x64_bf16 v[40:43], v[16:19], a[72:79], v3
  v_smfmac_f32_16x16x64_bf16 v[44:47], v[16:19], a[128:135], v3
  v_smfmac_f32_16x16x64_bf16 v[48:51], v[16:19], a[184:191], v3
  v_smfmac_f32_16x16x64_bf16 v[52:55], v[16:19], a[240:247], v3
  v_smfmac_f32_16x16x64_bf16 v[56:59], v[16:19], v[160:167], v3
  v_smfmac_f32_16x16x64_bf16 v[60:63], v[16:19], v[216:223], v3
  v_smfmac_f32_16x16x64_bf16 v[36:39], v[20:23], a[24:31], v3
  v_smfmac_f32_16x16x64_bf16 v[40:43], v[20:23], a[80:87], v3
  v_smfmac_f32_16x16x64_bf16 v[44:47], v[20:23], a[136:143], v3
  v_smfmac_f32_16x16x64_bf16 v[48:51], v[20:23], a[192:199], v3
  v_smfmac_f32_16x16x64_bf16 v[52:55], v[20:23], a[248:255], v3
  v_smfmac_f32_16x16x64_bf16 v[56:59], v[20:23], v[168:175], v3
  v_smfmac_f32_16x16x64_bf16 v[60:63], v[20:23], v[224:231], v3
  v_smfmac_f32_16x16x64_bf16 v[36:39], v[24:27], a[32:39], v3
  v_smfmac_f32_16x16x64_bf16 v[40:43], v[24:27], a[88:95], v3
  v_smfmac_f32_16x16x64_bf16 v[44:47], v[24:27], a[144:151], v3
  v_smfmac_f32_16x16x64_bf16 v[48:51], v[24:27], a[200:207], v3
  v_smfmac_f32_16x16x64_bf16 v[52:55], v[24:27], v[120:127], v3
  v_smfmac_f32_16x16x64_bf16 v[56:59], v[24:27], v[176:183], v3
  v_smfmac_f32_16x16x64_bf16 v[60:63], v[24:27], v[232:239], v3
  v_smfmac_f32_16x16x64_bf16 v[36:39], v[28:31], a[40:47], v3
  v_smfmac_f32_16x16x64_bf16 v[40:43], v[28:31], a[96:103], v3
  v_smfmac_f32_16x16x64_bf16 v[44:47], v[28:31], a[152:159], v3
  v_smfmac_f32_16x16x64_bf16 v[48:51], v[28:31], a[208:215], v3
  v_smfmac_f32_16x16x64_bf16 v[52:55], v[28:31], v[128:135], v3
  v_smfmac_f32_16x16x64_bf16 v[56:59], v[28:31], v[184:191], v3
  v_smfmac_f32_16x16x64_bf16 v[60:63], v[28:31], v[240:247], v3
  v_smfmac_f32_16x16x64_bf16 v[36:39], v[32:35], a[48:55], v3
  v_smfmac_f32_16x16x64_bf16 v[40:43], v[32:35], a[104:111], v3
  v_smfmac_f32_16x16x64_bf16 v[44:47], v[32:35], a[160:167], v3
  v_smfmac_f32_16x16x64_bf16 v[48:51], v[32:35], a[216:223], v3
  v_smfmac_f32_16x16x64_bf16 v[52:55], v[32:35], v[136:143], v3
  v_smfmac_f32_16x16x64_bf16 v[56:59], v[32:35], v[192:199], v3
  v_smfmac_f32_16x16x64_bf16 v[60:63], v[32:35], v[248:255], v3
  v_permlane32_swap_b32 v36, v38
  v_permlane32_swap_b32 v37, v39
  v_add_f32 v36, v36, v38
  v_add_f32 v37, v37, v39
  v_cvt_pk_bf16_f32 v38, v36, v37
  ds_write_b32 v104, v38
  v_permlane32_swap_b32 v40, v42
  v_permlane32_swap_b32 v41, v43
  v_add_f32 v40, v40, v42
  v_add_f32 v41, v41, v43
  v_cvt_pk_bf16_f32 v42, v40, v41
  ds_write_b32 v105, v42
  v_permlane32_swap_b32 v44, v46
  v_permlane32_swap_b32 v45, v47
  v_add_f32 v44, v44, v46
  v_add_f32 v45, v45, v47
  v_cvt_pk_bf16_f32 v46, v44, v45
  ds_write_b32 v106, v46
  v_permlane32_swap_b32 v48, v50
  v_permlane32_swap_b32 v49, v51
  v_add_f32 v48, v48, v50
  v_add_f32 v49, v49, v51
  v_cvt_pk_bf16_f32 v50, v48, v49
  ds_write_b32 v107, v50
  v_permlane32_swap_b32 v52, v54
  v_permlane32_swap_b32 v53, v55
  v_add_f32 v52, v52, v54
  v_add_f32 v53, v53, v55
  v_cvt_pk_bf16_f32 v54, v52, v53
  ds_write_b32 v108, v54
  v_permlane32_swap_b32 v56, v58
  v_permlane32_swap_b32 v57, v59
  v_add_f32 v56, v56, v58
  v_add_f32 v57, v57, v59
  v_cvt_pk_bf16_f32 v58, v56, v57
  ds_write_b32 v109, v58
  v_permlane32_swap_b32 v60, v62
  v_permlane32_swap_b32 v61, v63
  v_add_f32 v60, v60, v62
  v_add_f32 v61, v61, v63
  v_cvt_pk_bf16_f32 v62, v60, v61
  ds_write_b32 v110, v62
  s_branch cB_va3_t2d
cB_va3_vor:
  s_sleep 2
  buffer_load_dword v101, off, s[8:11], s27 sc1
  s_add_u32 s30, s30, 1
  s_cmp_lt_u32 s30, 400000
  s_cbranch_scc1 cB_va3_vow
  s_branch cB_abort
cB_abort:
  v_mov_b32 v4, 0xdead
  v_mov_b32 v5, 16
  buffer_store_dword v4, v5, s[12:15], 0 offen
  s_branch ch_end
cB_done:
  s_branch ch_end
ch_worker:
  s_sub_u32 s35, s3, 4
  s_and_b32 s35, s35, 7
  s_lshr_b32 s36, s2, 3
  s_lshl_b32 s33, s35, 5
  s_add_u32 s33, s33, s36
  s_mov_b32 s97, 0
  s_mov_b32 s96, 0
  s_mov_b32 s37, 0
  s_mov_b32 s38, 0
  s_mov_b32 s39, 0xffff0000
  s_mov_b32 s101, -1
  v_and_b32 v1, 63, v0
  v_lshlrev_b32 v2, 4, v1
  v_lshrrev_b32 v3, 4, v1
  v_and_b32 v4, 15, v1
  s_cmp_ge_u32 s33, 224
  s_cbranch_scc1 wp_all
  s_mov_b32 s68, s44
  s_and_b32 s69, s45, 0xffff
  s_mov_b32 s70, 3670016
  s_mov_b32 s71, 0x20000
  s_and_b32 s20, s33, 0xe0
  s_mul_i32 s20, s20, 9363
  s_lshr_b32 s20, s20, 16
  s_lshl_b32 s20, s20, 10
  s_and_b32 s21, s33, 31
  s_mul_i32 s21, s21, 192
  s_add_u32 s20, s20, s21
  v_min_u32 v7, 191, v0
  v_add_u32 v7, s20, v7
  v_lshrrev_b32 v8, 11, v7
  v_min_u32 v8, 15, v8
  v_bfe_u32 v9, v7, 2, 9
  v_lshlrev_b32 v9, 13, v9
  v_lshl_add_u32 v9, v8, 9, v9
  v_and_b32 v7, 3, v7
  v_lshl_add_u32 v9, v7, 7, v9
  buffer_load_dword v253, v9, s[68:71], 0 offen
  s_mov_b32 s68, s40
  s_and_b32 s69, s41, 0xffff
  s_mov_b32 s70, 3670016
  s_mov_b32 s71, 0x20000
  s_and_b32 s20, s33, 0xe0
  s_mul_i32 s20, s20, 9363
  s_lshr_b32 s20, s20, 16
  s_lshl_b32 s20, s20, 10
  s_and_b32 s21, s33, 31
  s_mul_i32 s21, s21, 192
  s_add_u32 s20, s20, s21
  v_min_u32 v7, 191, v0
  v_add_u32 v7, s20, v7
  v_lshrrev_b32 v8, 11, v7
  v_min_u32 v8, 15, v8
  v_bfe_u32 v9, v7, 2, 9
  v_lshlrev_b32 v9, 13, v9
  v_lshl_add_u32 v9, v8, 9, v9
  v_and_b32 v7, 3, v7
  v_lshl_add_u32 v9, v7, 7, v9
  buffer_load_dword v253, v9, s[68:71], 0 offen
  v_lshrrev_b32 v5, 5, v1
  v_and_b32 v6, 31, v1
  v_xor_b32 v8, v6, v5
  v_lshlrev_b32 v8, 4, v8
  v_lshl_add_u32 v16, v5, 13, v8
  v_xor_b32 v17, 32, v16
  v_xor_b32 v18, 64, v16
  v_xor_b32 v19, 96, v16
  v_xor_b32 v20, 128, v16
  v_xor_b32 v21, 160, v16
  v_xor_b32 v22, 192, v16
  v_xor_b32 v23, 224, v16
  s_lshl_b32 s20, s16, 6
  v_xor_b32 v26, s20, v16
  v_xor_b32 v27, 32, v26
wp_B:
  s_mul_i32 s17, s33, 4682
  s_lshr_b32 s17, s17, 16
  s_mul_i32 s23, s17, 14
  s_sub_u32 s19, s33, s23
  s_cmp_lt_u32 s19, 7
  s_cselect_b32 s18, 0, 7
  s_cselect_b32 s28, 0, 8
  s_sub_u32 s18, s19, s18
  s_add_u32 s28, s28, s16
  s_lshl_b32 s25, s16, 15
  s_add_u32 s25, s25, 32768
  s_lshl_b32 s26, s17, 9
  s_lshl_b32 s20, s33, 2
  s_add_u32 s20, s20, s16
  s_mul_i32 s21, s20, 9363
  s_lshr_b32 s21, s21, 16
  s_mul_i32 s22, s21, 7
  s_sub_u32 s22, s20, s22
  s_mul_i32 s21, s21, 14336
  s_lshl_b32 s20, s22, 7
  s_add_u32 s20, s20, s21
  s_lshl_b32 s22, s22, 11
  s_add_u32 s52, s21, s22
  s_mov_b32 s68, s48
  s_and_b32 s69, s49, 0xffff
  s_mov_b32 s70, 1835008
  s_mov_b32 s71, 0x20000
  v_mul_u32_u24 v7, 896, v4
  v_lshl_add_u32 v7, v3, 5, v7
  buffer_load_dwordx4 v[128:131], v7, s[68:71], s20 offen
  buffer_load_dwordx4 v[132:135], v7, s[68:71], s20 offen offset:16
  s_mov_b32 s60, s44
  s_and_b32 s61, s45, 0xffff
  s_mov_b32 s62, 3670016
  s_mov_b32 s63, 0x20000
  s_mov_b32 s56, s46
  s_and_b32 s57, s47, 0xffff
  s_mov_b32 s58, 3670016
  s_mov_b32 s59, 0x20000
  s_mul_i32 s27, s17, 229376
  s_lshl_b32 s30, s18, 7
  s_add_u32 s27, s27, s30
  s_mul_i32 s30, s16, 57344
  s_add_u32 s27, s27, s30
  v_lshrrev_b32 v7, 3, v1
  v_and_b32 v8, 7, v1
  v_and_b32 v9, 2, v7
  v_xor_b32 v8, v8, v9
  v_mul_u32_u24 v7, 896, v7
  v_lshl_add_u32 v24, v8, 4, v7
  v_xor_b32 v25, 64, v24
  s_lshl_b32 s30, s16, 13
  s_add_u32 m0, s30, 0
  s_nop 0
  buffer_load_dwordx4 v24, s[56:59], s27 offen  lds
  s_add_u32 s27, s27, 7168
  s_add_u32 m0, s30, 1024
  s_nop 0
  buffer_load_dwordx4 v25, s[56:59], s27 offen  lds
  s_add_u32 s27, s27, 7168
  s_add_u32 m0, s30, 2048
  s_nop 0
  buffer_load_dwordx4 v24, s[56:59], s27 offen  lds
  s_add_u32 s27, s27, 7168
  s_add_u32 m0, s30, 3072
  s_nop 0
  buffer_load_dwordx4 v25, s[56:59], s27 offen  lds
  s_add_u32 s27, s27, 7168
  s_add_u32 m0, s30, 4096
  s_nop 0
  buffer_load_dwordx4 v24, s[56:59], s27 offen  lds
  s_add_u32 s27, s27, 7168
  s_add_u32 m0, s30, 5120
  s_nop 0
  buffer_load_dwordx4 v25, s[56:59], s27 offen  lds
  s_add_u32 s27, s27, 7168
  s_add_u32 m0, s30, 6144
  s_nop 0
  buffer_load_dwordx4 v24, s[56:59], s27 offen  lds
  s_add_u32 s27, s27, 7168
  s_add_u32 m0, s30, 7168
  s_nop 0
  buffer_load_dwordx4 v25, s[56:59], s27 offen  lds
  s_add_u32 s27, s27, 7168
  s_add_u32 s27, s28, 0
  s_min_u32 s27, s27, 13
  s_lshl_b32 s27, s27, 18
  s_add_u32 s27, s27, s26
  s_mov_b32 s55, s27
  v_lshrrev_b32 v7, 2, v4
  v_lshlrev_b32 v11, 4, v7
  v_lshlrev_b32 v7, 3, v7
  v_and_b32 v8, 3, v4
  v_add_u32 v7, v7, v8
  v_and_b32 v8, 2, v4
  v_lshl_add_u32 v11, v8, 1, v11
  v_and_b32 v8, 1, v4
  v_add_u32 v11, v11, v8
  v_or_b32 v10, 0, v3
  v_xor_b32 v10, v10, v4
  v_lshlrev_b32 v10, 4, v10
  v_lshl_add_u32 v44, v11, 9, v10
  v_lshl_add_u32 v10, v7, 9, v10
  v_add_u32 v32, s25, v10
  v_or_b32 v10, 4, v3
  v_xor_b32 v10, v10, v4
  v_lshlrev_b32 v10, 4, v10
  v_lshl_add_u32 v45, v11, 9, v10
  v_lshl_add_u32 v10, v7, 9, v10
  v_add_u32 v33, s25, v10
  v_or_b32 v10, 8, v3
  v_xor_b32 v10, v10, v4
  v_lshlrev_b32 v10, 4, v10
  v_lshl_add_u32 v46, v11, 9, v10
  v_lshl_add_u32 v10, v7, 9, v10
  v_add_u32 v34, s25, v10
  v_or_b32 v10, 12, v3
  v_xor_b32 v10, v10, v4
  v_lshlrev_b32 v10, 4, v10
  v_lshl_add_u32 v47, v11, 9, v10
  v_lshl_add_u32 v10, v7, 9, v10
  v_add_u32 v35, s25, v10
  s_mul_i32 s30, s17, 401408
  s_mul_i32 s31, s18, 57344
  s_add_u32 s30, s30, s31
  s_add_u32 s30, s30, 33554432
  v_add_u32 v28, s30, v2
  s_add_u32 s30, s30, 14336
  v_add_u32 v29, s30, v2
  s_add_u32 s30, s30, 14336
  v_add_u32 v30, s30, v2
  s_add_u32 s30, s30, 14336
  v_add_u32 v31, s30, v2
  s_add_u32 s30, s30, 14336
  v_mov_b32 v48, 1035512379
  v_lshrrev_b32 v7, 2, v4
  v_lshl_add_u32 v7, v3, 3, v7
  v_lshlrev_b32 v7, 7, v7
  v_and_b32 v8, 3, v4
  v_lshl_add_u32 v7, v8, 3, v7
  v_lshrrev_b32 v8, 3, v4
  v_and_b32 v9, 1, v3
  v_lshl_add_u32 v8, v9, 1, v8
  v_lshl_add_u32 v40, v8, 5, v7
  s_mul_i32 s31, s17, 28
  s_mov_b32 s29, 401408
  s_lshl_b32 s30, s18, 6
  s_add_u32 s30, s30, 0
  v_add_u32 v8, s30, v4
  v_subrev_u32 v9, 256, v8
  v_mul_u32_u24 v11, 171, v9
  v_lshrrev_b32 v11, 11, v11
  v_mul_u32_u24 v38, 12, v11
  v_sub_u32 v38, v9, v38
  v_add_u32 v38, 16, v38
  v_lshrrev_b32 v10, 4, v8
  v_cmp_gt_i32 vcc, 0, v9
  s_nop 1
  v_cndmask_b32 v10, v11, v10, vcc
  v_cndmask_b32 v39, v38, v4, vcc
  v_add_u32 v39, s31, v39
  v_lshrrev_b32 v38, 4, v39
  v_and_b32 v39, 15, v39
  v_mul_lo_u32 v10, v10, s29
  v_mul_u32_u24 v38, 14336, v38
  v_add_u32 v10, v10, v38
  v_lshl_add_u32 v10, v3, 8, v10
  v_lshl_add_u32 v10, v39, 4, v10
  v_add_u32 v12, 39976960, v10
  v_xor_b32 v41, 32, v40
  s_lshl_b32 s30, s18, 6
  s_add_u32 s30, s30, 16
  v_add_u32 v8, s30, v4
  v_subrev_u32 v9, 256, v8
  v_mul_u32_u24 v11, 171, v9
  v_lshrrev_b32 v11, 11, v11
  v_mul_u32_u24 v38, 12, v11
  v_sub_u32 v38, v9, v38
  v_add_u32 v38, 16, v38
  v_lshrrev_b32 v10, 4, v8
  v_cmp_gt_i32 vcc, 0, v9
  s_nop 1
  v_cndmask_b32 v10, v11, v10, vcc
  v_cndmask_b32 v39, v38, v4, vcc
  v_add_u32 v39, s31, v39
  v_lshrrev_b32 v38, 4, v39
  v_and_b32 v39, 15, v39
  v_mul_lo_u32 v10, v10, s29
  v_mul_u32_u24 v38, 14336, v38
  v_add_u32 v10, v10, v38
  v_lshl_add_u32 v10, v3, 8, v10
  v_lshl_add_u32 v10, v39, 4, v10
  v_add_u32 v13, 39976960, v10
  v_xor_b32 v42, 64, v40
  s_lshl_b32 s30, s18, 6
  s_add_u32 s30, s30, 32
  v_add_u32 v8, s30, v4
  v_subrev_u32 v9, 256, v8
  v_mul_u32_u24 v11, 171, v9
  v_lshrrev_b32 v11, 11, v11
  v_mul_u32_u24 v38, 12, v11
  v_sub_u32 v38, v9, v38
  v_add_u32 v38, 16, v38
  v_lshrrev_b32 v10, 4, v8
  v_cmp_gt_i32 vcc, 0, v9
  s_nop 1
  v_cndmask_b32 v10, v11, v10, vcc
  v_cndmask_b32 v39, v38, v4, vcc
  v_add_u32 v39, s31, v39
  v_lshrrev_b32 v38, 4, v39
  v_and_b32 v39, 15, v39
  v_mul_lo_u32 v10, v10, s29
  v_mul_u32_u24 v38, 14336, v38
  v_add_u32 v10, v10, v38
  v_lshl_add_u32 v10, v3, 8, v10
  v_lshl_add_u32 v10, v39, 4, v10
  v_add_u32 v14, 39976960, v10
  v_xor_b32 v43, 96, v40
  s_lshl_b32 s30, s18, 6
  s_add_u32 s30, s30, 48
  v_add_u32 v8, s30, v4
  v_subrev_u32 v9, 256, v8
  v_mul_u32_u24 v11, 171, v9
  v_lshrrev_b32 v11, 11, v11
  v_mul_u32_u24 v38, 12, v11
  v_sub_u32 v38, v9, v38
  v_add_u32 v38, 16, v38
  v_lshrrev_b32 v10, 4, v8
  v_cmp_gt_i32 vcc, 0, v9
  s_nop 1
  v_cndmask_b32 v10, v11, v10, vcc
  v_cndmask_b32 v39, v38, v4, vcc
  v_add_u32 v39, s31, v39
  v_lshrrev_b32 v38, 4, v39
  v_and_b32 v39, 15, v39
  v_mul_lo_u32 v10, v10, s29
  v_mul_u32_u24 v38, 14336, v38
  v_add_u32 v10, v10, v38
  v_lshl_add_u32 v10, v3, 8, v10
  v_lshl_add_u32 v10, v39, 4, v10
  v_add_u32 v15, 39976960, v10
  s_mov_b32 s27, s55
  s_add_u32 m0, s25, 0
  s_nop 0
  buffer_load_dwordx4 v16, s[60:63], s27 offen  lds
  s_add_u32 s27, s27, 16384
  s_add_u32 m0, s25, 1024
  s_nop 0
  buffer_load_dwordx4 v17, s[60:63], s27 offen  lds
  s_add_u32 s27, s27, 16384
  s_add_u32 m0, s25, 2048
  s_nop 0
  buffer_load_dwordx4 v16, s[60:63], s27 offen  lds
  s_add_u32 s27, s27, 16384
  s_add_u32 m0, s25, 3072
  s_nop 0
  buffer_load_dwordx4 v17, s[60:63], s27 offen  lds
  s_add_u32 s27, s27, 16384
  s_add_u32 m0, s25, 4096
  s_nop 0
  buffer_load_dwordx4 v18, s[60:63], s27 offen  lds
  s_add_u32 s27, s27, 16384
  s_add_u32 m0, s25, 5120
  s_nop 0
  buffer_load_dwordx4 v19, s[60:63], s27 offen  lds
  s_add_u32 s27, s27, 16384
  s_add_u32 m0, s25, 6144
  s_nop 0
  buffer_load_dwordx4 v18, s[60:63], s27 offen  lds
  s_add_u32 s27, s27, 16384
  s_add_u32 m0, s25, 7168
  s_nop 0
  buffer_load_dwordx4 v19, s[60:63], s27 offen  lds
  s_add_u32 s27, s27, 16384
  s_add_u32 m0, s25, 8192
  s_nop 0
  buffer_load_dwordx4 v20, s[60:63], s27 offen  lds
  s_add_u32 s27, s27, 16384
  s_add_u32 m0, s25, 9216
  s_nop 0
  buffer_load_dwordx4 v21, s[60:63], s27 offen  lds
  s_add_u32 s27, s27, 16384
  s_add_u32 m0, s25, 10240
  s_nop 0
  buffer_load_dwordx4 v20, s[60:63], s27 offen  lds
  s_add_u32 s27, s27, 16384
  s_add_u32 m0, s25, 11264
  s_nop 0
  buffer_load_dwordx4 v21, s[60:63], s27 offen  lds
  s_add_u32 s27, s27, 16384
  s_add_u32 m0, s25, 12288
  s_nop 0
  buffer_load_dwordx4 v22, s[60:63], s27 offen  lds
  s_add_u32 s27, s27, 16384
  s_add_u32 m0, s25, 13312
  s_nop 0
  buffer_load_dwordx4 v23, s[60:63], s27 offen  lds
  s_add_u32 s27, s27, 16384
  s_add_u32 m0, s25, 14336
  s_nop 0
  buffer_load_dwordx4 v22, s[60:63], s27 offen  lds
  s_add_u32 s27, s27, 16384
  s_add_u32 m0, s25, 15360
  s_nop 0
  buffer_load_dwordx4 v23, s[60:63], s27 offen  lds
  s_add_u32 s27, s27, 16384
  s_add_u32 s27, s28, 4
  s_min_u32 s27, s27, 13
  s_lshl_b32 s27, s27, 18
  s_add_u32 s27, s27, s26
  s_add_u32 m0, s25, 16384
  s_nop 0
  buffer_load_dwordx4 v16, s[60:63], s27 offen  lds
  s_add_u32 s27, s27, 16384
  s_add_u32 m0, s25, 17408
  s_nop 0
  buffer_load_dwordx4 v17, s[60:63], s27 offen  lds
  s_add_u32 s27, s27, 16384
  s_add_u32 m0, s25, 18432
  s_nop 0
  buffer_load_dwordx4 v16, s[60:63], s27 offen  lds
  s_add_u32 s27, s27, 16384
  s_add_u32 m0, s25, 19456
  s_nop 0
  buffer_load_dwordx4 v17, s[60:63], s27 offen  lds
  s_add_u32 s27, s27, 16384
  s_add_u32 m0, s25, 20480
  s_nop 0
  buffer_load_dwordx4 v18, s[60:63], s27 offen  lds
  s_add_u32 s27, s27, 16384
  s_add_u32 m0, s25, 21504
  s_nop 0
  buffer_load_dwordx4 v19, s[60:63], s27 offen  lds
  s_add_u32 s27, s27, 16384
  s_add_u32 m0, s25, 22528
  s_nop 0
  buffer_load_dwordx4 v18, s[60:63], s27 offen  lds
  s_add_u32 s27, s27, 16384
  s_add_u32 m0, s25, 23552
  s_nop 0
  buffer_load_dwordx4 v19, s[60:63], s27 offen  lds
  s_add_u32 s27, s27, 16384
  s_add_u32 m0, s25, 24576
  s_nop 0
  buffer_load_dwordx4 v20, s[60:63], s27 offen  lds
  s_add_u32 s27, s27, 16384
  s_add_u32 m0, s25, 25600
  s_nop 0
  buffer_load_dwordx4 v21, s[60:63], s27 offen  lds
  s_add_u32 s27, s27, 16384
  s_add_u32 m0, s25, 26624
  s_nop 0
  buffer_load_dwordx4 v20, s[60:63], s27 offen  lds
  s_add_u32 s27, s27, 16384
  s_add_u32 m0, s25, 27648
  s_nop 0
  buffer_load_dwordx4 v21, s[60:63], s27 offen  lds
  s_add_u32 s27, s27, 16384
  s_add_u32 m0, s25, 28672
  s_nop 0
  buffer_load_dwordx4 v22, s[60:63], s27 offen  lds
  s_add_u32 s27, s27, 16384
  s_add_u32 m0, s25, 29696
  s_nop 0
  buffer_load_dwordx4 v23, s[60:63], s27 offen  lds
  s_add_u32 s27, s27, 16384
  s_add_u32 m0, s25, 30720
  s_nop 0
  buffer_load_dwordx4 v22, s[60:63], s27 offen  lds
  s_add_u32 s27, s27, 16384
  s_add_u32 m0, s25, 31744
  s_nop 0
  buffer_load_dwordx4 v23, s[60:63], s27 offen  lds
  s_add_u32 s27, s27, 16384
  s_cmp_lt_u32 s18, 4
  s_cselect_b32 s34, 1, s97
  s_mov_b32 s68, s42
  s_and_b32 s69, s43, 0xffff
  s_mov_b32 s70, 3670016
  s_mov_b32 s71, 0x20000
  s_lshl_b32 s27, s18, 19
  s_add_u32 s27, s27, s26
  s_cmp_lg_u32 s34, 0
  s_cselect_b32 s27, 0x40000000, s27
  v_lshrrev_b32 v7, 2, v0
  v_and_b32 v8, 3, v0
  v_lshlrev_b32 v8, 7, v8
  v_lshl_add_u32 v9, v7, 13, v8
  buffer_load_dword v253, v9, s[68:71], s27 offen
  s_lshl_b32 s29, s28, 10
  s_add_u32 s31, s29, 4096
  s_cmp_lt_u32 s28, 10
  s_cselect_b32 s31, s31, 0x40000000
  s_waitcnt vmcnt(1)
  s_barrier
  ds_read_b64_tr_b16 a[0:1], v40 offset:0
  ds_read_b64_tr_b16 a[2:3], v40 offset:512
  ds_read_b64_tr_b16 a[32:33], v41 offset:0
  ds_read_b64_tr_b16 a[34:35], v41 offset:512
  ds_read_b64_tr_b16 a[64:65], v42 offset:0
  ds_read_b64_tr_b16 a[66:67], v42 offset:512
  ds_read_b64_tr_b16 a[96:97], v43 offset:0
  ds_read_b64_tr_b16 a[98:99], v43 offset:512
  ds_read_b128 a[128:131], v32 offset:0
  ds_read_b128 a[160:163], v32 offset:2048
  ds_read_b128 a[192:195], v32 offset:16384
  ds_read_b128 a[224:227], v32 offset:18432
  v_lshlrev_b32 v144, 9, v3
  v_lshl_add_u32 v144, v4, 4, v144
  s_add_u32 s53, s52, 75759616
  s_add_u32 s52, s52, 655360
  v_mov_b32 v136, v128
  v_mov_b32 v140, v129
  v_mov_b32 v137, v130
  v_mov_b32 v141, v131
  v_mov_b32 v138, v132
  v_mov_b32 v142, v133
  v_mov_b32 v139, v134
  v_mov_b32 v143, v135
  buffer_store_dwordx4 v[128:131], v144, s[8:11], s52 offen sc1
  buffer_store_dwordx4 v[132:135], v144, s[8:11], s52 offen offset:256 sc1
  buffer_store_dwordx4 v[136:139], v2, s[8:11], s53 offen sc1
  buffer_store_dwordx4 v[140:143], v2, s[8:11], s53 offen offset:1024 sc1
  s_waitcnt lgkmcnt(0)
  v_mfma_f32_16x16x32_bf16 v[64:67], a[128:131], a[0:3], 0
  ds_read_b64_tr_b16 a[4:5], v40 offset:4096
  ds_read_b64_tr_b16 a[6:7], v40 offset:4608
  v_mfma_f32_16x16x32_bf16 v[68:71], a[160:163], a[0:3], 0
  ds_read_b64_tr_b16 a[36:37], v41 offset:4096
  ds_read_b64_tr_b16 a[38:39], v41 offset:4608
  v_mfma_f32_16x16x32_bf16 v[72:75], a[128:131], a[32:35], 0
  ds_read_b64_tr_b16 a[68:69], v42 offset:4096
  ds_read_b64_tr_b16 a[70:71], v42 offset:4608
  v_mfma_f32_16x16x32_bf16 v[76:79], a[160:163], a[32:35], 0
  ds_read_b64_tr_b16 a[100:101], v43 offset:4096
  ds_read_b64_tr_b16 a[102:103], v43 offset:4608
  v_mfma_f32_16x16x32_bf16 v[80:83], a[128:131], a[64:67], 0
  ds_read_b128 a[132:135], v33 offset:0
  ds_read_b128 a[164:167], v33 offset:2048
  v_mfma_f32_16x16x32_bf16 v[84:87], a[160:163], a[64:67], 0
  ds_read_b128 a[196:199], v33 offset:16384
  ds_read_b128 a[228:231], v33 offset:18432
  v_mfma_f32_16x16x32_bf16 v[88:91], a[128:131], a[96:99], 0
  v_mfma_f32_16x16x32_bf16 v[92:95], a[160:163], a[96:99], 0
  v_mfma_f32_16x16x32_bf16 v[96:99], a[192:195], a[0:3], 0
  v_mfma_f32_16x16x32_bf16 v[100:103], a[224:227], a[0:3], 0
  v_mfma_f32_16x16x32_bf16 v[104:107], a[192:195], a[32:35], 0
  v_mfma_f32_16x16x32_bf16 v[108:111], a[224:227], a[32:35], 0
  v_mfma_f32_16x16x32_bf16 v[112:115], a[192:195], a[64:67], 0
  v_mfma_f32_16x16x32_bf16 v[116:119], a[224:227], a[64:67], 0
  v_mfma_f32_16x16x32_bf16 v[120:123], a[192:195], a[96:99], 0
  v_mfma_f32_16x16x32_bf16 v[124:127], a[224:227], a[96:99], 0
  s_waitcnt lgkmcnt(0)
  v_mfma_f32_16x16x32_bf16 v[64:67], a[132:135], a[4:7], v[64:67]
  ds_read_b64_tr_b16 a[8:9], v40 offset:8192
  ds_read_b64_tr_b16 a[10:11], v40 offset:8704
  v_mfma_f32_16x16x32_bf16 v[68:71], a[164:167], a[4:7], v[68:71]
  ds_read_b64_tr_b16 a[40:41], v41 offset:8192
  ds_read_b64_tr_b16 a[42:43], v41 offset:8704
  v_mfma_f32_16x16x32_bf16 v[72:75], a[132:135], a[36:39], v[72:75]
  ds_read_b64_tr_b16 a[72:73], v42 offset:8192
  ds_read_b64_tr_b16 a[74:75], v42 offset:8704
  v_mfma_f32_16x16x32_bf16 v[76:79], a[164:167], a[36:39], v[76:79]
  ds_read_b64_tr_b16 a[104:105], v43 offset:8192
  ds_read_b64_tr_b16 a[106:107], v43 offset:8704
  v_mfma_f32_16x16x32_bf16 v[80:83], a[132:135], a[68:71], v[80:83]
  ds_read_b128 a[136:139], v34 offset:0
  ds_read_b128 a[168:171], v34 offset:2048
  v_mfma_f32_16x16x32_bf16 v[84:87], a[164:167], a[68:71], v[84:87]
  ds_read_b128 a[200:203], v34 offset:16384
  ds_read_b128 a[232:235], v34 offset:18432
  v_mfma_f32_16x16x32_bf16 v[88:91], a[132:135], a[100:103], v[88:91]
  v_mfma_f32_16x16x32_bf16 v[92:95], a[164:167], a[100:103], v[92:95]
  v_mfma_f32_16x16x32_bf16 v[96:99], a[196:199], a[4:7], v[96:99]
  v_mfma_f32_16x16x32_bf16 v[100:103], a[228:231], a[4:7], v[100:103]
  v_mfma_f32_16x16x32_bf16 v[104:107], a[196:199], a[36:39], v[104:107]
  v_mfma_f32_16x16x32_bf16 v[108:111], a[228:231], a[36:39], v[108:111]
  v_mfma_f32_16x16x32_bf16 v[112:115], a[196:199], a[68:71], v[112:115]
  v_mfma_f32_16x16x32_bf16 v[116:119], a[228:231], a[68:71], v[116:119]
  v_mfma_f32_16x16x32_bf16 v[120:123], a[196:199], a[100:103], v[120:123]
  v_mfma_f32_16x16x32_bf16 v[124:127], a[228:231], a[100:103], v[124:127]
  s_waitcnt lgkmcnt(0)
  v_mfma_f32_16x16x32_bf16 v[64:67], a[136:139], a[8:11], v[64:67]
  ds_read_b64_tr_b16 a[12:13], v40 offset:12288
  ds_read_b64_tr_b16 a[14:15], v40 offset:12800
  v_mfma_f32_16x16x32_bf16 v[68:71], a[168:171], a[8:11], v[68:71]
  ds_read_b64_tr_b16 a[44:45], v41 offset:12288
  ds_read_b64_tr_b16 a[46:47], v41 offset:12800
  v_mfma_f32_16x16x32_bf16 v[72:75], a[136:139], a[40:43], v[72:75]
  ds_read_b64_tr_b16 a[76:77], v42 offset:12288
  ds_read_b64_tr_b16 a[78:79], v42 offset:12800
  v_mfma_f32_16x16x32_bf16 v[76:79], a[168:171], a[40:43], v[76:79]
  ds_read_b64_tr_b16 a[108:109], v43 offset:12288
  ds_read_b64_tr_b16 a[110:111], v43 offset:12800
  v_mfma_f32_16x16x32_bf16 v[80:83], a[136:139], a[72:75], v[80:83]
  ds_read_b128 a[140:143], v35 offset:0
  ds_read_b128 a[172:175], v35 offset:2048
  v_mfma_f32_16x16x32_bf16 v[84:87], a[168:171], a[72:75], v[84:87]
  ds_read_b128 a[204:207], v35 offset:16384
  ds_read_b128 a[236:239], v35 offset:18432
  v_mfma_f32_16x16x32_bf16 v[88:91], a[136:139], a[104:107], v[88:91]
  v_mfma_f32_16x16x32_bf16 v[92:95], a[168:171], a[104:107], v[92:95]
  v_mfma_f32_16x16x32_bf16 v[96:99], a[200:203], a[8:11], v[96:99]
  v_mfma_f32_16x16x32_bf16 v[100:103], a[232:235], a[8:11], v[100:103]
  v_mfma_f32_16x16x32_bf16 v[104:107], a[200:203], a[40:43], v[104:107]
  v_mfma_f32_16x16x32_bf16 v[108:111], a[232:235], a[40:43], v[108:111]
  v_mfma_f32_16x16x32_bf16 v[112:115], a[200:203], a[72:75], v[112:115]
  v_mfma_f32_16x16x32_bf16 v[116:119], a[232:235], a[72:75], v[116:119]
  v_mfma_f32_16x16x32_bf16 v[120:123], a[200:203], a[104:107], v[120:123]
  v_mfma_f32_16x16x32_bf16 v[124:127], a[232:235], a[104:107], v[124:127]
  s_waitcnt lgkmcnt(0)
  v_mfma_f32_16x16x32_bf16 v[64:67], a[140:143], a[12:15], v[64:67]
  ds_read_b64_tr_b16 a[16:17], v40 offset:16384
  ds_read_b64_tr_b16 a[18:19], v40 offset:16896
  v_mfma_f32_16x16x32_bf16 v[68:71], a[172:175], a[12:15], v[68:71]
  ds_read_b64_tr_b16 a[48:49], v41 offset:16384
  ds_read_b64_tr_b16 a[50:51], v41 offset:16896
  v_mfma_f32_16x16x32_bf16 v[72:75], a[140:143], a[44:47], v[72:75]
  ds_read_b64_tr_b16 a[80:81], v42 offset:16384
  ds_read_b64_tr_b16 a[82:83], v42 offset:16896
  v_mfma_f32_16x16x32_bf16 v[76:79], a[172:175], a[44:47], v[76:79]
  ds_read_b64_tr_b16 a[112:113], v43 offset:16384
  ds_read_b64_tr_b16 a[114:115], v43 offset:16896
  v_mfma_f32_16x16x32_bf16 v[80:83], a[140:143], a[76:79], v[80:83]
  ds_read_b128 a[144:147], v32 offset:256
  ds_read_b128 a[176:179], v32 offset:2304
  v_mfma_f32_16x16x32_bf16 v[84:87], a[172:175], a[76:79], v[84:87]
  ds_read_b128 a[208:211], v32 offset:16640
  ds_read_b128 a[240:243], v32 offset:18688
  v_mfma_f32_16x16x32_bf16 v[88:91], a[140:143], a[108:111], v[88:91]
  v_mfma_f32_16x16x32_bf16 v[92:95], a[172:175], a[108:111], v[92:95]
  v_mfma_f32_16x16x32_bf16 v[96:99], a[204:207], a[12:15], v[96:99]
  v_mfma_f32_16x16x32_bf16 v[100:103], a[236:239], a[12:15], v[100:103]
  v_mfma_f32_16x16x32_bf16 v[104:107], a[204:207], a[44:47], v[104:107]
  v_mfma_f32_16x16x32_bf16 v[108:111], a[236:239], a[44:47], v[108:111]
  v_mfma_f32_16x16x32_bf16 v[112:115], a[204:207], a[76:79], v[112:115]
  v_mfma_f32_16x16x32_bf16 v[116:119], a[236:239], a[76:79], v[116:119]
  v_mfma_f32_16x16x32_bf16 v[120:123], a[204:207], a[108:111], v[120:123]
  v_mfma_f32_16x16x32_bf16 v[124:127], a[236:239], a[108:111], v[124:127]
  s_waitcnt lgkmcnt(0)
  v_mfma_f32_16x16x32_bf16 v[64:67], a[144:147], a[16:19], v[64:67]
  ds_read_b64_tr_b16 a[20:21], v40 offset:20480
  ds_read_b64_tr_b16 a[22:23], v40 offset:20992
  v_mfma_f32_16x16x32_bf16 v[68:71], a[176:179], a[16:19], v[68:71]
  ds_read_b64_tr_b16 a[52:53], v41 offset:20480
  ds_read_b64_tr_b16 a[54:55], v41 offset:20992
  v_mfma_f32_16x16x32_bf16 v[72:75], a[144:147], a[48:51], v[72:75]
  ds_read_b64_tr_b16 a[84:85], v42 offset:20480
  ds_read_b64_tr_b16 a[86:87], v42 offset:20992
  v_mfma_f32_16x16x32_bf16 v[76:79], a[176:179], a[48:51], v[76:79]
  ds_read_b64_tr_b16 a[116:117], v43 offset:20480
  ds_read_b64_tr_b16 a[118:119], v43 offset:20992
  v_mfma_f32_16x16x32_bf16 v[80:83], a[144:147], a[80:83], v[80:83]
  ds_read_b128 a[148:151], v33 offset:256
  ds_read_b128 a[180:183], v33 offset:2304
  v_mfma_f32_16x16x32_bf16 v[84:87], a[176:179], a[80:83], v[84:87]
  ds_read_b128 a[212:215], v33 offset:16640
  ds_read_b128 a[244:247], v33 offset:18688
  v_mfma_f32_16x16x32_bf16 v[88:91], a[144:147], a[112:115], v[88:91]
  v_mfma_f32_16x16x32_bf16 v[92:95], a[176:179], a[112:115], v[92:95]
  v_mfma_f32_16x16x32_bf16 v[96:99], a[208:211], a[16:19], v[96:99]
  v_mfma_f32_16x16x32_bf16 v[100:103], a[240:243], a[16:19], v[100:103]
  v_mfma_f32_16x16x32_bf16 v[104:107], a[208:211], a[48:51], v[104:107]
  v_mfma_f32_16x16x32_bf16 v[108:111], a[240:243], a[48:51], v[108:111]
  v_mfma_f32_16x16x32_bf16 v[112:115], a[208:211], a[80:83], v[112:115]
  v_mfma_f32_16x16x32_bf16 v[116:119], a[240:243], a[80:83], v[116:119]
  v_mfma_f32_16x16x32_bf16 v[120:123], a[208:211], a[112:115], v[120:123]
  v_mfma_f32_16x16x32_bf16 v[124:127], a[240:243], a[112:115], v[124:127]
  s_waitcnt lgkmcnt(0)
  v_mfma_f32_16x16x32_bf16 v[64:67], a[148:151], a[20:23], v[64:67]
  ds_read_b64_tr_b16 a[24:25], v40 offset:24576
  ds_read_b64_tr_b16 a[26:27], v40 offset:25088
  v_mfma_f32_16x16x32_bf16 v[68:71], a[180:183], a[20:23], v[68:71]
  ds_read_b64_tr_b16 a[56:57], v41 offset:24576
  ds_read_b64_tr_b16 a[58:59], v41 offset:25088
  v_mfma_f32_16x16x32_bf16 v[72:75], a[148:151], a[52:55], v[72:75]
  ds_read_b64_tr_b16 a[88:89], v42 offset:24576
  ds_read_b64_tr_b16 a[90:91], v42 offset:25088
  v_mfma_f32_16x16x32_bf16 v[76:79], a[180:183], a[52:55], v[76:79]
  ds_read_b64_tr_b16 a[120:121], v43 offset:24576
  ds_read_b64_tr_b16 a[122:123], v43 offset:25088
  v_mfma_f32_16x16x32_bf16 v[80:83], a[148:151], a[84:87], v[80:83]
  ds_read_b128 a[152:155], v34 offset:256
  ds_read_b128 a[184:187], v34 offset:2304
  v_mfma_f32_16x16x32_bf16 v[84:87], a[180:183], a[84:87], v[84:87]
  ds_read_b128 a[216:219], v34 offset:16640
  ds_read_b128 a[248:251], v34 offset:18688
  v_mfma_f32_16x16x32_bf16 v[88:91], a[148:151], a[116:119], v[88:91]
  v_mfma_f32_16x16x32_bf16 v[92:95], a[180:183], a[116:119], v[92:95]
  v_mfma_f32_16x16x32_bf16 v[96:99], a[212:215], a[20:23], v[96:99]
  v_mfma_f32_16x16x32_bf16 v[100:103], a[244:247], a[20:23], v[100:103]
  v_mfma_f32_16x16x32_bf16 v[104:107], a[212:215], a[52:55], v[104:107]
  v_mfma_f32_16x16x32_bf16 v[108:111], a[244:247], a[52:55], v[108:111]
  v_mfma_f32_16x16x32_bf16 v[112:115], a[212:215], a[84:87], v[112:115]
  v_mfma_f32_16x16x32_bf16 v[116:119], a[244:247], a[84:87], v[116:119]
  v_mfma_f32_16x16x32_bf16 v[120:123], a[212:215], a[116:119], v[120:123]
  v_mfma_f32_16x16x32_bf16 v[124:127], a[244:247], a[116:119], v[124:127]
  s_waitcnt lgkmcnt(0)
  v_mfma_f32_16x16x32_bf16 v[64:67], a[152:155], a[24:27], v[64:67]
  ds_read_b64_tr_b16 a[28:29], v40 offset:28672
  ds_read_b64_tr_b16 a[30:31], v40 offset:29184
  v_mfma_f32_16x16x32_bf16 v[68:71], a[184:187], a[24:27], v[68:71]
  ds_read_b64_tr_b16 a[60:61], v41 offset:28672
  ds_read_b64_tr_b16 a[62:63], v41 offset:29184
  v_mfma_f32_16x16x32_bf16 v[72:75], a[152:155], a[56:59], v[72:75]
  ds_read_b64_tr_b16 a[92:93], v42 offset:28672
  ds_read_b64_tr_b16 a[94:95], v42 offset:29184
  v_mfma_f32_16x16x32_bf16 v[76:79], a[184:187], a[56:59], v[76:79]
  ds_read_b64_tr_b16 a[124:125], v43 offset:28672
  ds_read_b64_tr_b16 a[126:127], v43 offset:29184
  v_mfma_f32_16x16x32_bf16 v[80:83], a[152:155], a[88:91], v[80:83]
  ds_read_b128 a[156:159], v35 offset:256
  ds_read_b128 a[188:191], v35 offset:2304
  v_mfma_f32_16x16x32_bf16 v[84:87], a[184:187], a[88:91], v[84:87]
  ds_read_b128 a[220:223], v35 offset:16640
  ds_read_b128 a[252:255], v35 offset:18688
  v_mfma_f32_16x16x32_bf16 v[88:91], a[152:155], a[120:123], v[88:91]
  v_mfma_f32_16x16x32_bf16 v[92:95], a[184:187], a[120:123], v[92:95]
  v_mfma_f32_16x16x32_bf16 v[96:99], a[216:219], a[24:27], v[96:99]
  v_mfma_f32_16x16x32_bf16 v[100:103], a[248:251], a[24:27], v[100:103]
  v_mfma_f32_16x16x32_bf16 v[104:107], a[216:219], a[56:59], v[104:107]
  v_mfma_f32_16x16x32_bf16 v[108:111], a[248:251], a[56:59], v[108:111]
  v_mfma_f32_16x16x32_bf16 v[112:115], a[216:219], a[88:91], v[112:115]
  v_mfma_f32_16x16x32_bf16 v[116:119], a[248:251], a[88:91], v[116:119]
  v_mfma_f32_16x16x32_bf16 v[120:123], a[216:219], a[120:123], v[120:123]
  v_mfma_f32_16x16x32_bf16 v[124:127], a[248:251], a[120:123], v[124:127]
  s_waitcnt lgkmcnt(0)
  s_barrier
  buffer_load_dwordx2 v[254:255], v252, s[12:15], 0 offen offset:128 sc1
  buffer_load_dword v253, v252, s[12:15], 0 offen sc1
  v_mfma_f32_16x16x32_bf16 v[64:67], a[156:159], a[28:31], v[64:67]
  v_mfma_f32_16x16x32_bf16 v[68:71], a[188:191], a[28:31], v[68:71]
  v_mfma_f32_16x16x32_bf16 v[72:75], a[156:159], a[60:63], v[72:75]
  v_mfma_f32_16x16x32_bf16 v[76:79], a[188:191], a[60:63], v[76:79]
  v_mfma_f32_16x16x32_bf16 v[80:83], a[156:159], a[92:95], v[80:83]
  v_cvt_pk_bf16_f32 v64, v64, v65
  v_cvt_pk_bf16_f32 v65, v66, v67
  v_mfma_f32_16x16x32_bf16 v[84:87], a[188:191], a[92:95], v[84:87]
  v_cvt_pk_bf16_f32 v66, v68, v69
  v_cvt_pk_bf16_f32 v67, v70, v71
  v_mfma_f32_16x16x32_bf16 v[88:91], a[156:159], a[124:127], v[88:91]
  buffer_store_dwordx4 v[64:67], v12, s[8:11], s29 offen sc1
  v_cvt_pk_bf16_f32 v72, v72, v73
  v_mfma_f32_16x16x32_bf16 v[92:95], a[188:191], a[124:127], v[92:95]
  v_cvt_pk_bf16_f32 v73, v74, v75
  v_cvt_pk_bf16_f32 v74, v76, v77
  v_mfma_f32_16x16x32_bf16 v[96:99], a[220:223], a[28:31], v[96:99]
  v_cvt_pk_bf16_f32 v75, v78, v79
  buffer_store_dwordx4 v[72:75], v13, s[8:11], s29 offen sc1
  v_mfma_f32_16x16x32_bf16 v[100:103], a[252:255], a[28:31], v[100:103]
  v_cvt_pk_bf16_f32 v80, v80, v81
  v_cvt_pk_bf16_f32 v81, v82, v83
  v_mfma_f32_16x16x32_bf16 v[104:107], a[220:223], a[60:63], v[104:107]
  v_cvt_pk_bf16_f32 v82, v84, v85
  v_cvt_pk_bf16_f32 v83, v86, v87
  v_mfma_f32_16x16x32_bf16 v[108:111], a[252:255], a[60:63], v[108:111]
  buffer_store_dwordx4 v[80:83], v14, s[8:11], s29 offen sc1
  v_cvt_pk_bf16_f32 v88, v88, v89
  v_mfma_f32_16x16x32_bf16 v[112:115], a[220:223], a[92:95], v[112:115]
  v_cvt_pk_bf16_f32 v89, v90, v91
  v_cvt_pk_bf16_f32 v90, v92, v93
  v_mfma_f32_16x16x32_bf16 v[116:119], a[252:255], a[92:95], v[116:119]
  v_cvt_pk_bf16_f32 v91, v94, v95
  buffer_store_dwordx4 v[88:91], v15, s[8:11], s29 offen sc1
  v_mfma_f32_16x16x32_bf16 v[120:123], a[220:223], a[124:127], v[120:123]
  v_cvt_pk_bf16_f32 v96, v96, v97
  v_cvt_pk_bf16_f32 v97, v98, v99
  v_mfma_f32_16x16x32_bf16 v[124:127], a[252:255], a[124:127], v[124:127]
  v_cvt_pk_bf16_f32 v98, v100, v101
  v_cvt_pk_bf16_f32 v99, v102, v103
  buffer_store_dwordx4 v[96:99], v12, s[8:11], s31 offen sc1
  v_cvt_pk_bf16_f32 v104, v104, v105
  v_cvt_pk_bf16_f32 v105, v106, v107
  v_cvt_pk_bf16_f32 v106, v108, v109
  v_cvt_pk_bf16_f32 v107, v110, v111
  buffer_store_dwordx4 v[104:107], v13, s[8:11], s31 offen sc1
  v_cvt_pk_bf16_f32 v112, v112, v113
  v_cvt_pk_bf16_f32 v113, v114, v115
  v_cvt_pk_bf16_f32 v114, v116, v117
  v_cvt_pk_bf16_f32 v115, v118, v119
  buffer_store_dwordx4 v[112:115], v14, s[8:11], s31 offen sc1
  v_cvt_pk_bf16_f32 v120, v120, v121
  v_cvt_pk_bf16_f32 v121, v122, v123
  v_cvt_pk_bf16_f32 v122, v124, v125
  v_cvt_pk_bf16_f32 v123, v126, v127
  buffer_store_dwordx4 v[120:123], v15, s[8:11], s31 offen sc1
  s_cmp_lg_u32 s34, 0
  s_cbranch_scc1 wp_B2
  s_mov_b32 s60, s40
  s_and_b32 s61, s41, 0xffff
  s_mov_b32 s62, 3670016
  s_mov_b32 s63, 0x20000
  s_mov_b32 s56, s42
  s_and_b32 s57, s43, 0xffff
  s_mov_b32 s58, 3670016
  s_mov_b32 s59, 0x20000
  s_lshl_b32 s27, s18, 2
  s_add_u32 s27, s27, s16
  s_lshl_b32 s27, s27, 17
  s_add_u32 s27, s27, s26
  s_lshl_b32 s30, s16, 13
  s_add_u32 m0, s30, 0
  s_nop 0
  buffer_load_dwordx4 v26, s[56:59], s27 offen  lds
  s_add_u32 s27, s27, 16384
  s_add_u32 m0, s30, 1024
  s_nop 0
  buffer_load_dwordx4 v26, s[56:59], s27 offen  lds
  s_add_u32 s27, s27, 16384
  s_add_u32 m0, s30, 2048
  s_nop 0
  buffer_load_dwordx4 v27, s[56:59], s27 offen  lds
  s_add_u32 s27, s27, 16384
  s_add_u32 m0, s30, 3072
  s_nop 0
  buffer_load_dwordx4 v27, s[56:59], s27 offen  lds
  s_add_u32 s27, s27, 16384
  s_add_u32 m0, s30, 4096
  s_nop 0
  buffer_load_dwordx4 v26, s[56:59], s27 offen  lds
  s_add_u32 s27, s27, 16384
  s_add_u32 m0, s30, 5120
  s_nop 0
  buffer_load_dwordx4 v26, s[56:59], s27 offen  lds
  s_add_u32 s27, s27, 16384
  s_add_u32 m0, s30, 6144
  s_nop 0
  buffer_load_dwordx4 v27, s[56:59], s27 offen  lds
  s_add_u32 s27, s27, 16384
  s_add_u32 m0, s30, 7168
  s_nop 0
  buffer_load_dwordx4 v27, s[56:59], s27 offen  lds
  s_add_u32 s27, s27, 16384
  s_add_u32 s27, s28, 0
  s_min_u32 s27, s27, 13
  s_lshl_b32 s27, s27, 18
  s_add_u32 s27, s27, s26
  s_add_u32 m0, s25, 0
  s_nop 0
  buffer_load_dwordx4 v16, s[60:63], s27 offen  lds
  s_add_u32 s27, s27, 16384
  s_add_u32 m0, s25, 1024
  s_nop 0
  buffer_load_dwordx4 v17, s[60:63], s27 offen  lds
  s_add_u32 s27, s27, 16384
  s_add_u32 m0, s25, 2048
  s_nop 0
  buffer_load_dwordx4 v16, s[60:63], s27 offen  lds
  s_add_u32 s27, s27, 16384
  s_add_u32 m0, s25, 3072
  s_nop 0
  buffer_load_dwordx4 v17, s[60:63], s27 offen  lds
  s_add_u32 s27, s27, 16384
  s_waitcnt vmcnt(12)
  s_barrier
  s_cmp_lg_u32 s16, 0
  s_cbranch_scc1 wp_f1_f
  v_readfirstlane_b32 s20, v254
  s_cmp_eq_u32 s20, 1
  s_cbranch_scc1 wp_f1_w_ok
  s_mov_b32 s30, 0
wp_f1_w:
  buffer_load_dword v254, off, s[12:15], 0 offset:128 sc1
  s_waitcnt vmcnt(0)
  v_cmp_ne_u32 vcc, 1, v254
  s_cbranch_vccz wp_f1_w_ok
  s_sleep 8
  s_add_u32 s30, s30, 1
  s_cmp_lt_u32 s30, 16
  s_cbranch_scc1 wp_f1_w
  s_branch wp_f1_f
wp_f1_w_ok:
  s_lshl_b32 s20, s17, 7
  s_add_u32 s20, s20, 582144
  s_lshl_b32 s21, 1, s19
  v_mov_b32 v248, s21
  s_mov_b64 exec, 1
  buffer_atomic_or v248, v252, s[8:11], s20 offen sc0
  s_mov_b64 exec, -1
  s_mov_b32 s37, s21
wp_f1_f:
  s_add_u32 m0, s25, 4096
  s_nop 0
  buffer_load_dwordx4 v18, s[60:63], s27 offen  lds
  s_add_u32 s27, s27, 16384
  s_add_u32 m0, s25, 5120
  s_nop 0
  buffer_load_dwordx4 v19, s[60:63], s27 offen  lds
  s_add_u32 s27, s27, 16384
  s_add_u32 m0, s25, 6144
  s_nop 0
  buffer_load_dwordx4 v18, s[60:63], s27 offen  lds
  s_add_u32 s27, s27, 16384
  s_add_u32 m0, s25, 7168
  s_nop 0
  buffer_load_dwordx4 v19, s[60:63], s27 offen  lds
  s_add_u32 s27, s27, 16384
  s_add_u32 m0, s25, 8192
  s_nop 0
  buffer_load_dwordx4 v20, s[60:63], s27 offen  lds
  s_add_u32 s27, s27, 16384
  s_add_u32 m0, s25, 9216
  s_nop 0
  buffer_load_dwordx4 v21, s[60:63], s27 offen  lds
  s_add_u32 s27, s27, 16384
  s_add_u32 m0, s25, 10240
  s_nop 0
  buffer_load_dwordx4 v20, s[60:63], s27 offen  lds
  s_add_u32 s27, s27, 16384
  s_add_u32 m0, s25, 11264
  s_nop 0
  buffer_load_dwordx4 v21, s[60:63], s27 offen  lds
  s_add_u32 s27, s27, 16384
  s_add_u32 m0, s25, 12288
  s_nop 0
  buffer_load_dwordx4 v22, s[60:63], s27 offen  lds
  s_add_u32 s27, s27, 16384
  s_add_u32 m0, s25, 13312
  s_nop 0
  buffer_load_dwordx4 v23, s[60:63], s27 offen  lds
  s_add_u32 s27, s27, 16384
  s_add_u32 m0, s25, 14336
  s_nop 0
  buffer_load_dwordx4 v22, s[60:63], s27 offen  lds
  s_add_u32 s27, s27, 16384
  s_add_u32 m0, s25, 15360
  s_nop 0
  buffer_load_dwordx4 v23, s[60:63], s27 offen  lds
  s_add_u32 s27, s27, 16384
  s_add_u32 s27, s28, 4
  s_min_u32 s27, s27, 13
  s_lshl_b32 s27, s27, 18
  s_add_u32 s27, s27, s26
  s_waitcnt vmcnt(12)
  v_readfirstlane_b32 s20, v248
  s_and_b32 s20, s20, 16383
  s_xor_b32 s20, s20, s37
  s_cmp_lg_u32 s20, 16383
  s_cselect_b32 s20, 0, s37
  s_mov_b32 s37, 0
  s_cmp_eq_u32 s20, 0
  s_cbranch_scc1 wp_g1
  s_lshl_b32 s21, 1, s17
  v_mov_b32 v248, s21
  s_mov_b32 s20, 586240
  v_lshlrev_b32 v247, 7, v0
  s_mov_b64 exec, 0xff
  buffer_atomic_or v248, v247, s[8:11], s20 offen
  s_mov_b64 exec, -1
wp_g1:
  s_add_u32 m0, s25, 16384
  s_nop 0
  buffer_load_dwordx4 v16, s[60:63], s27 offen  lds
  s_add_u32 s27, s27, 16384
  s_add_u32 m0, s25, 17408
  s_nop 0
  buffer_load_dwordx4 v17, s[60:63], s27 offen  lds
  s_add_u32 s27, s27, 16384
  s_add_u32 m0, s25, 18432
  s_nop 0
  buffer_load_dwordx4 v16, s[60:63], s27 offen  lds
  s_add_u32 s27, s27, 16384
  s_add_u32 m0, s25, 19456
  s_nop 0
  buffer_load_dwordx4 v17, s[60:63], s27 offen  lds
  s_add_u32 s27, s27, 16384
  s_add_u32 m0, s25, 20480
  s_nop 0
  buffer_load_dwordx4 v18, s[60:63], s27 offen  lds
  s_add_u32 s27, s27, 16384
  s_add_u32 m0, s25, 21504
  s_nop 0
  buffer_load_dwordx4 v19, s[60:63], s27 offen  lds
  s_add_u32 s27, s27, 16384
  s_add_u32 m0, s25, 22528
  s_nop 0
  buffer_load_dwordx4 v18, s[60:63], s27 offen  lds
  s_add_u32 s27, s27, 16384
  s_add_u32 m0, s25, 23552
  s_nop 0
  buffer_load_dwordx4 v19, s[60:63], s27 offen  lds
  s_add_u32 s27, s27, 16384
  s_add_u32 m0, s25, 24576
  s_nop 0
  buffer_load_dwordx4 v20, s[60:63], s27 offen  lds
  s_add_u32 s27, s27, 16384
  s_add_u32 m0, s25, 25600
  s_nop 0
  buffer_load_dwordx4 v21, s[60:63], s27 offen  lds
  s_add_u32 s27, s27, 16384
  s_add_u32 m0, s25, 26624
  s_nop 0
  buffer_load_dwordx4 v20, s[60:63], s27 offen  lds
  s_add_u32 s27, s27, 16384
  s_add_u32 m0, s25, 27648
  s_nop 0
  buffer_load_dwordx4 v21, s[60:63], s27 offen  lds
  s_add_u32 s27, s27, 16384
  s_add_u32 m0, s25, 28672
  s_nop 0
  buffer_load_dwordx4 v22, s[60:63], s27 offen  lds
  s_add_u32 s27, s27, 16384
  s_add_u32 m0, s25, 29696
  s_nop 0
  buffer_load_dwordx4 v23, s[60:63], s27 offen  lds
  s_add_u32 s27, s27, 16384
  s_add_u32 m0, s25, 30720
  s_nop 0
  buffer_load_dwordx4 v22, s[60:63], s27 offen  lds
  s_add_u32 s27, s27, 16384
  s_add_u32 m0, s25, 31744
  s_nop 0
  buffer_load_dwordx4 v23, s[60:63], s27 offen  lds
  s_add_u32 s27, s27, 16384
  s_branch wp_A
wp_B2:
  v_lshlrev_b32 v6, 7, v1
  s_getpc_b64 s[98:99]
ct_5:
  s_add_u32 s98, s98, wp_fin-ct_5
  s_addc_u32 s99, s99, 0
  global_load_dword v7, v6, s[98:99]
  s_getpc_b64 s[98:99]
ct_6:
  s_add_u32 s98, s98, wg_vo-ct_6
  s_addc_u32 s99, s99, 0
  global_load_dword v7, v6, s[98:99]
  s_waitcnt vmcnt(2)
  s_barrier
  s_cmp_lg_u32 s16, 0
  s_cbranch_scc1 wp_f2_f
  v_readfirstlane_b32 s20, v254
  s_cmp_eq_u32 s20, 1
  s_cbranch_scc1 wp_f2_w_ok
  s_mov_b32 s30, 0
wp_f2_w:
  buffer_load_dword v254, off, s[12:15], 0 offset:128 sc1
  s_waitcnt vmcnt(0)
  v_cmp_ne_u32 vcc, 1, v254
  s_cbranch_vccz wp_f2_w_ok
  s_sleep 8
  s_add_u32 s30, s30, 1
  s_cmp_lt_u32 s30, 16
  s_cbranch_scc1 wp_f2_w
  s_branch wp_f2_f
wp_f2_w_ok:
  s_lshl_b32 s20, s17, 7
  s_add_u32 s20, s20, 582144
  s_lshl_b32 s21, 1, s19
  v_mov_b32 v248, s21
  s_mov_b64 exec, 1
  buffer_atomic_or v248, v252, s[8:11], s20 offen sc0
  s_mov_b64 exec, -1
  s_mov_b32 s37, s21
wp_f2_f:
  s_cmp_eq_u32 s97, 0
  s_cselect_b32 s39, -1, s39
  s_branch wp_fin
wp_A0:
  s_mov_b32 s60, s40
  s_and_b32 s61, s41, 0xffff
  s_mov_b32 s62, 3670016
  s_mov_b32 s63, 0x20000
  s_mov_b32 s56, s42
  s_and_b32 s57, s43, 0xffff
  s_mov_b32 s58, 3670016
  s_mov_b32 s59, 0x20000
  s_lshl_b32 s27, s18, 2
  s_add_u32 s27, s27, s16
  s_lshl_b32 s27, s27, 17
  s_add_u32 s27, s27, s26
  s_lshl_b32 s30, s16, 13
  s_add_u32 m0, s30, 0
  s_nop 0
  buffer_load_dwordx4 v26, s[56:59], s27 offen  lds
  s_add_u32 s27, s27, 16384
  s_add_u32 m0, s30, 1024
  s_nop 0
  buffer_load_dwordx4 v26, s[56:59], s27 offen  lds
  s_add_u32 s27, s27, 16384
  s_add_u32 m0, s30, 2048
  s_nop 0
  buffer_load_dwordx4 v27, s[56:59], s27 offen  lds
  s_add_u32 s27, s27, 16384
  s_add_u32 m0, s30, 3072
  s_nop 0
  buffer_load_dwordx4 v27, s[56:59], s27 offen  lds
  s_add_u32 s27, s27, 16384
  s_add_u32 m0, s30, 4096
  s_nop 0
  buffer_load_dwordx4 v26, s[56:59], s27 offen  lds
  s_add_u32 s27, s27, 16384
  s_add_u32 m0, s30, 5120
  s_nop 0
  buffer_load_dwordx4 v26, s[56:59], s27 offen  lds
  s_add_u32 s27, s27, 16384
  s_add_u32 m0, s30, 6144
  s_nop 0
  buffer_load_dwordx4 v27, s[56:59], s27 offen  lds
  s_add_u32 s27, s27, 16384
  s_add_u32 m0, s30, 7168
  s_nop 0
  buffer_load_dwordx4 v27, s[56:59], s27 offen  lds
  s_add_u32 s27, s27, 16384
  s_add_u32 s27, s28, 0
  s_min_u32 s27, s27, 13
  s_lshl_b32 s27, s27, 18
  s_add_u32 s27, s27, s26
  s_add_u32 m0, s25, 0
  s_nop 0
  buffer_load_dwordx4 v16, s[60:63], s27 offen  lds
  s_add_u32 s27, s27, 16384
  s_add_u32 m0, s25, 1024
  s_nop 0
  buffer_load_dwordx4 v17, s[60:63], s27 offen  lds
  s_add_u32 s27, s27, 16384
  s_add_u32 m0, s25, 2048
  s_nop 0
  buffer_load_dwordx4 v16, s[60:63], s27 offen  lds
  s_add_u32 s27, s27, 16384
  s_add_u32 m0, s25, 3072
  s_nop 0
  buffer_load_dwordx4 v17, s[60:63], s27 offen  lds
  s_add_u32 s27, s27, 16384
  s_add_u32 m0, s25, 4096
  s_nop 0
  buffer_load_dwordx4 v18, s[60:63], s27 offen  lds
  s_add_u32 s27, s27, 16384
  s_add_u32 m0, s25, 5120
  s_nop 0
  buffer_load_dwordx4 v19, s[60:63], s27 offen  lds
  s_add_u32 s27, s27, 16384
  s_add_u32 m0, s25, 6144
  s_nop 0
  buffer_load_dwordx4 v18, s[60:63], s27 offen  lds
  s_add_u32 s27, s27, 16384
  s_add_u32 m0, s25, 7168
  s_nop 0
  buffer_load_dwordx4 v19, s[60:63], s27 offen  lds
  s_add_u32 s27, s27, 16384
  s_add_u32 m0, s25, 8192
  s_nop 0
  buffer_load_dwordx4 v20, s[60:63], s27 offen  lds
  s_add_u32 s27, s27, 16384
  s_add_u32 m0, s25, 9216
  s_nop 0
  buffer_load_dwordx4 v21, s[60:63], s27 offen  lds
  s_add_u32 s27, s27, 16384
  s_add_u32 m0, s25, 10240
  s_nop 0
  buffer_load_dwordx4 v20, s[60:63], s27 offen  lds
  s_add_u32 s27, s27, 16384
  s_add_u32 m0, s25, 11264
  s_nop 0
  buffer_load_dwordx4 v21, s[60:63], s27 offen  lds
  s_add_u32 s27, s27, 16384
  s_add_u32 m0, s25, 12288
  s_nop 0
  buffer_load_dwordx4 v22, s[60:63], s27 offen  lds
  s_add_u32 s27, s27, 16384
  s_add_u32 m0, s25, 13312
  s_nop 0
  buffer_load_dwordx4 v23, s[60:63], s27 offen  lds
  s_add_u32 s27, s27, 16384
  s_add_u32 m0, s25, 14336
  s_nop 0
  buffer_load_dwordx4 v22, s[60:63], s27 offen  lds
  s_add_u32 s27, s27, 16384
  s_add_u32 m0, s25, 15360
  s_nop 0
  buffer_load_dwordx4 v23, s[60:63], s27 offen  lds
  s_add_u32 s27, s27, 16384
  s_add_u32 s27, s28, 4
  s_min_u32 s27, s27, 13
  s_lshl_b32 s27, s27, 18
  s_add_u32 s27, s27, s26
  s_add_u32 m0, s25, 16384
  s_nop 0
  buffer_load_dwordx4 v16, s[60:63], s27 offen  lds
  s_add_u32 s27, s27, 16384
  s_add_u32 m0, s25, 17408
  s_nop 0
  buffer_load_dwordx4 v17, s[60:63], s27 offen  lds
  s_add_u32 s27, s27, 16384
  s_add_u32 m0, s25, 18432
  s_nop 0
  buffer_load_dwordx4 v16, s[60:63], s27 offen  lds
  s_add_u32 s27, s27, 16384
  s_add_u32 m0, s25, 19456
  s_nop 0
  buffer_load_dwordx4 v17, s[60:63], s27 offen  lds
  s_add_u32 s27, s27, 16384
  s_add_u32 m0, s25, 20480
  s_nop 0
  buffer_load_dwordx4 v18, s[60:63], s27 offen  lds
  s_add_u32 s27, s27, 16384
  s_add_u32 m0, s25, 21504
  s_nop 0
  buffer_load_dwordx4 v19, s[60:63], s27 offen  lds
  s_add_u32 s27, s27, 16384
  s_add_u32 m0, s25, 22528
  s_nop 0
  buffer_load_dwordx4 v18, s[60:63], s27 offen  lds
  s_add_u32 s27, s27, 16384
  s_add_u32 m0, s25, 23552
  s_nop 0
  buffer_load_dwordx4 v19, s[60:63], s27 offen  lds
  s_add_u32 s27, s27, 16384
  s_add_u32 m0, s25, 24576
  s_nop 0
  buffer_load_dwordx4 v20, s[60:63], s27 offen  lds
  s_add_u32 s27, s27, 16384
  s_add_u32 m0, s25, 25600
  s_nop 0
  buffer_load_dwordx4 v21, s[60:63], s27 offen  lds
  s_add_u32 s27, s27, 16384
  s_add_u32 m0, s25, 26624
  s_nop 0
  buffer_load_dwordx4 v20, s[60:63], s27 offen  lds
  s_add_u32 s27, s27, 16384
  s_add_u32 m0, s25, 27648
  s_nop 0
  buffer_load_dwordx4 v21, s[60:63], s27 offen  lds
  s_add_u32 s27, s27, 16384
  s_add_u32 m0, s25, 28672
  s_nop 0
  buffer_load_dwordx4 v22, s[60:63], s27 offen  lds
  s_add_u32 s27, s27, 16384
  s_add_u32 m0, s25, 29696
  s_nop 0
  buffer_load_dwordx4 v23, s[60:63], s27 offen  lds
  s_add_u32 s27, s27, 16384
  s_add_u32 m0, s25, 30720
  s_nop 0
  buffer_load_dwordx4 v22, s[60:63], s27 offen  lds
  s_add_u32 s27, s27, 16384
  s_add_u32 m0, s25, 31744
  s_nop 0
  buffer_load_dwordx4 v23, s[60:63], s27 offen  lds
  s_add_u32 s27, s27, 16384
  v_lshrrev_b32 v7, 2, v4
  v_lshlrev_b32 v11, 4, v7
  v_lshlrev_b32 v7, 3, v7
  v_and_b32 v8, 3, v4
  v_add_u32 v7, v7, v8
  v_and_b32 v8, 2, v4
  v_lshl_add_u32 v11, v8, 1, v11
  v_and_b32 v8, 1, v4
  v_add_u32 v11, v11, v8
  v_or_b32 v10, 0, v3
  v_xor_b32 v10, v10, v4
  v_lshlrev_b32 v10, 4, v10
  v_lshl_add_u32 v44, v11, 9, v10
  v_lshl_add_u32 v10, v7, 9, v10
  v_add_u32 v32, s25, v10
  v_or_b32 v10, 4, v3
  v_xor_b32 v10, v10, v4
  v_lshlrev_b32 v10, 4, v10
  v_lshl_add_u32 v45, v11, 9, v10
  v_lshl_add_u32 v10, v7, 9, v10
  v_add_u32 v33, s25, v10
  v_or_b32 v10, 8, v3
  v_xor_b32 v10, v10, v4
  v_lshlrev_b32 v10, 4, v10
  v_lshl_add_u32 v46, v11, 9, v10
  v_lshl_add_u32 v10, v7, 9, v10
  v_add_u32 v34, s25, v10
  v_or_b32 v10, 12, v3
  v_xor_b32 v10, v10, v4
  v_lshlrev_b32 v10, 4, v10
  v_lshl_add_u32 v47, v11, 9, v10
  v_lshl_add_u32 v10, v7, 9, v10
  v_add_u32 v35, s25, v10
  s_mul_i32 s30, s17, 401408
  s_mul_i32 s31, s18, 57344
  s_add_u32 s30, s30, s31
  s_add_u32 s30, s30, 33554432
  v_add_u32 v28, s30, v2
  s_add_u32 s30, s30, 14336
  v_add_u32 v29, s30, v2
  s_add_u32 s30, s30, 14336
  v_add_u32 v30, s30, v2
  s_add_u32 s30, s30, 14336
  v_add_u32 v31, s30, v2
  s_add_u32 s30, s30, 14336
  v_mov_b32 v48, 1035512379
wp_A:
  s_lshl_b32 s29, s28, 10
  s_add_u32 s31, s29, 4096
  s_cmp_lt_u32 s28, 10
  s_cselect_b32 s31, s31, 0x40000000
  s_waitcnt vmcnt(0)
  s_barrier
  ds_read_b128 a[0:3], v44 offset:0
  ds_read_b128 a[32:35], v44 offset:1024
  ds_read_b128 a[64:67], v44 offset:4096
  ds_read_b128 a[96:99], v44 offset:5120
  ds_read_b128 a[128:131], v32 offset:0
  ds_read_b128 a[160:163], v32 offset:2048
  ds_read_b128 a[192:195], v32 offset:16384
  ds_read_b128 a[224:227], v32 offset:18432
  s_waitcnt lgkmcnt(0)
  v_mfma_f32_16x16x32_bf16 v[64:67], a[128:131], a[0:3], 0
  ds_read_b128 a[4:7], v45 offset:0
  ds_read_b128 a[36:39], v45 offset:1024
  v_mfma_f32_16x16x32_bf16 v[68:71], a[160:163], a[0:3], 0
  ds_read_b128 a[68:71], v45 offset:4096
  ds_read_b128 a[100:103], v45 offset:5120
  v_mfma_f32_16x16x32_bf16 v[72:75], a[128:131], a[32:35], 0
  ds_read_b128 a[132:135], v33 offset:0
  ds_read_b128 a[164:167], v33 offset:2048
  v_mfma_f32_16x16x32_bf16 v[76:79], a[160:163], a[32:35], 0
  ds_read_b128 a[196:199], v33 offset:16384
  ds_read_b128 a[228:231], v33 offset:18432
  v_mfma_f32_16x16x32_bf16 v[80:83], a[128:131], a[64:67], 0
  v_mfma_f32_16x16x32_bf16 v[84:87], a[160:163], a[64:67], 0
  v_mfma_f32_16x16x32_bf16 v[88:91], a[128:131], a[96:99], 0
  v_mfma_f32_16x16x32_bf16 v[92:95], a[160:163], a[96:99], 0
  v_mfma_f32_16x16x32_bf16 v[96:99], a[192:195], a[0:3], 0
  v_mfma_f32_16x16x32_bf16 v[100:103], a[224:227], a[0:3], 0
  v_mfma_f32_16x16x32_bf16 v[104:107], a[192:195], a[32:35], 0
  v_mfma_f32_16x16x32_bf16 v[108:111], a[224:227], a[32:35], 0
  v_mfma_f32_16x16x32_bf16 v[112:115], a[192:195], a[64:67], 0
  v_mfma_f32_16x16x32_bf16 v[116:119], a[224:227], a[64:67], 0
  v_mfma_f32_16x16x32_bf16 v[120:123], a[192:195], a[96:99], 0
  v_mfma_f32_16x16x32_bf16 v[124:127], a[224:227], a[96:99], 0
  s_waitcnt lgkmcnt(0)
  v_mfma_f32_16x16x32_bf16 v[64:67], a[132:135], a[4:7], v[64:67]
  ds_read_b128 a[8:11], v46 offset:0
  ds_read_b128 a[40:43], v46 offset:1024
  v_mfma_f32_16x16x32_bf16 v[68:71], a[164:167], a[4:7], v[68:71]
  ds_read_b128 a[72:75], v46 offset:4096
  ds_read_b128 a[104:107], v46 offset:5120
  v_mfma_f32_16x16x32_bf16 v[72:75], a[132:135], a[36:39], v[72:75]
  ds_read_b128 a[136:139], v34 offset:0
  ds_read_b128 a[168:171], v34 offset:2048
  v_mfma_f32_16x16x32_bf16 v[76:79], a[164:167], a[36:39], v[76:79]
  ds_read_b128 a[200:203], v34 offset:16384
  ds_read_b128 a[232:235], v34 offset:18432
  v_mfma_f32_16x16x32_bf16 v[80:83], a[132:135], a[68:71], v[80:83]
  v_mfma_f32_16x16x32_bf16 v[84:87], a[164:167], a[68:71], v[84:87]
  v_mfma_f32_16x16x32_bf16 v[88:91], a[132:135], a[100:103], v[88:91]
  v_mfma_f32_16x16x32_bf16 v[92:95], a[164:167], a[100:103], v[92:95]
  v_mfma_f32_16x16x32_bf16 v[96:99], a[196:199], a[4:7], v[96:99]
  v_mfma_f32_16x16x32_bf16 v[100:103], a[228:231], a[4:7], v[100:103]
  v_mfma_f32_16x16x32_bf16 v[104:107], a[196:199], a[36:39], v[104:107]
  v_mfma_f32_16x16x32_bf16 v[108:111], a[228:231], a[36:39], v[108:111]
  v_mfma_f32_16x16x32_bf16 v[112:115], a[196:199], a[68:71], v[112:115]
  v_mfma_f32_16x16x32_bf16 v[116:119], a[228:231], a[68:71], v[116:119]
  v_mfma_f32_16x16x32_bf16 v[120:123], a[196:199], a[100:103], v[120:123]
  v_mfma_f32_16x16x32_bf16 v[124:127], a[228:231], a[100:103], v[124:127]
  s_waitcnt lgkmcnt(0)
  v_mfma_f32_16x16x32_bf16 v[64:67], a[136:139], a[8:11], v[64:67]
  ds_read_b128 a[12:15], v47 offset:0
  ds_read_b128 a[44:47], v47 offset:1024
  v_mfma_f32_16x16x32_bf16 v[68:71], a[168:171], a[8:11], v[68:71]
  ds_read_b128 a[76:79], v47 offset:4096
  ds_read_b128 a[108:111], v47 offset:5120
  v_mfma_f32_16x16x32_bf16 v[72:75], a[136:139], a[40:43], v[72:75]
  ds_read_b128 a[140:143], v35 offset:0
  ds_read_b128 a[172:175], v35 offset:2048
  v_mfma_f32_16x16x32_bf16 v[76:79], a[168:171], a[40:43], v[76:79]
  ds_read_b128 a[204:207], v35 offset:16384
  ds_read_b128 a[236:239], v35 offset:18432
  v_mfma_f32_16x16x32_bf16 v[80:83], a[136:139], a[72:75], v[80:83]
  v_mfma_f32_16x16x32_bf16 v[84:87], a[168:171], a[72:75], v[84:87]
  v_mfma_f32_16x16x32_bf16 v[88:91], a[136:139], a[104:107], v[88:91]
  v_mfma_f32_16x16x32_bf16 v[92:95], a[168:171], a[104:107], v[92:95]
  v_mfma_f32_16x16x32_bf16 v[96:99], a[200:203], a[8:11], v[96:99]
  v_mfma_f32_16x16x32_bf16 v[100:103], a[232:235], a[8:11], v[100:103]
  v_mfma_f32_16x16x32_bf16 v[104:107], a[200:203], a[40:43], v[104:107]
  v_mfma_f32_16x16x32_bf16 v[108:111], a[232:235], a[40:43], v[108:111]
  v_mfma_f32_16x16x32_bf16 v[112:115], a[200:203], a[72:75], v[112:115]
  v_mfma_f32_16x16x32_bf16 v[116:119], a[232:235], a[72:75], v[116:119]
  v_mfma_f32_16x16x32_bf16 v[120:123], a[200:203], a[104:107], v[120:123]
  v_mfma_f32_16x16x32_bf16 v[124:127], a[232:235], a[104:107], v[124:127]
  s_waitcnt lgkmcnt(0)
  v_mfma_f32_16x16x32_bf16 v[64:67], a[140:143], a[12:15], v[64:67]
  ds_read_b128 a[16:19], v44 offset:256
  ds_read_b128 a[48:51], v44 offset:1280
  v_mfma_f32_16x16x32_bf16 v[68:71], a[172:175], a[12:15], v[68:71]
  ds_read_b128 a[80:83], v44 offset:4352
  ds_read_b128 a[112:115], v44 offset:5376
  v_mfma_f32_16x16x32_bf16 v[72:75], a[140:143], a[44:47], v[72:75]
  ds_read_b128 a[144:147], v32 offset:256
  ds_read_b128 a[176:179], v32 offset:2304
  v_mfma_f32_16x16x32_bf16 v[76:79], a[172:175], a[44:47], v[76:79]
  ds_read_b128 a[208:211], v32 offset:16640
  ds_read_b128 a[240:243], v32 offset:18688
  v_mfma_f32_16x16x32_bf16 v[80:83], a[140:143], a[76:79], v[80:83]
  v_mfma_f32_16x16x32_bf16 v[84:87], a[172:175], a[76:79], v[84:87]
  v_mfma_f32_16x16x32_bf16 v[88:91], a[140:143], a[108:111], v[88:91]
  v_mfma_f32_16x16x32_bf16 v[92:95], a[172:175], a[108:111], v[92:95]
  v_mfma_f32_16x16x32_bf16 v[96:99], a[204:207], a[12:15], v[96:99]
  v_mfma_f32_16x16x32_bf16 v[100:103], a[236:239], a[12:15], v[100:103]
  v_mfma_f32_16x16x32_bf16 v[104:107], a[204:207], a[44:47], v[104:107]
  v_mfma_f32_16x16x32_bf16 v[108:111], a[236:239], a[44:47], v[108:111]
  v_mfma_f32_16x16x32_bf16 v[112:115], a[204:207], a[76:79], v[112:115]
  v_mfma_f32_16x16x32_bf16 v[116:119], a[236:239], a[76:79], v[116:119]
  v_mfma_f32_16x16x32_bf16 v[120:123], a[204:207], a[108:111], v[120:123]
  v_mfma_f32_16x16x32_bf16 v[124:127], a[236:239], a[108:111], v[124:127]
  s_waitcnt lgkmcnt(0)
  v_mfma_f32_16x16x32_bf16 v[64:67], a[144:147], a[16:19], v[64:67]
  ds_read_b128 a[20:23], v45 offset:256
  ds_read_b128 a[52:55], v45 offset:1280
  v_mfma_f32_16x16x32_bf16 v[68:71], a[176:179], a[16:19], v[68:71]
  ds_read_b128 a[84:87], v45 offset:4352
  ds_read_b128 a[116:119], v45 offset:5376
  v_mfma_f32_16x16x32_bf16 v[72:75], a[144:147], a[48:51], v[72:75]
  ds_read_b128 a[148:151], v33 offset:256
  ds_read_b128 a[180:183], v33 offset:2304
  v_mfma_f32_16x16x32_bf16 v[76:79], a[176:179], a[48:51], v[76:79]
  ds_read_b128 a[212:215], v33 offset:16640
  ds_read_b128 a[244:247], v33 offset:18688
  v_mfma_f32_16x16x32_bf16 v[80:83], a[144:147], a[80:83], v[80:83]
  v_mfma_f32_16x16x32_bf16 v[84:87], a[176:179], a[80:83], v[84:87]
  v_mfma_f32_16x16x32_bf16 v[88:91], a[144:147], a[112:115], v[88:91]
  v_mfma_f32_16x16x32_bf16 v[92:95], a[176:179], a[112:115], v[92:95]
  v_mfma_f32_16x16x32_bf16 v[96:99], a[208:211], a[16:19], v[96:99]
  v_mfma_f32_16x16x32_bf16 v[100:103], a[240:243], a[16:19], v[100:103]
  v_mfma_f32_16x16x32_bf16 v[104:107], a[208:211], a[48:51], v[104:107]
  v_mfma_f32_16x16x32_bf16 v[108:111], a[240:243], a[48:51], v[108:111]
  v_mfma_f32_16x16x32_bf16 v[112:115], a[208:211], a[80:83], v[112:115]
  v_mfma_f32_16x16x32_bf16 v[116:119], a[240:243], a[80:83], v[116:119]
  v_mfma_f32_16x16x32_bf16 v[120:123], a[208:211], a[112:115], v[120:123]
  v_mfma_f32_16x16x32_bf16 v[124:127], a[240:243], a[112:115], v[124:127]
  s_waitcnt lgkmcnt(0)
  v_mfma_f32_16x16x32_bf16 v[64:67], a[148:151], a[20:23], v[64:67]
  ds_read_b128 a[24:27], v46 offset:256
  ds_read_b128 a[56:59], v46 offset:1280
  v_mfma_f32_16x16x32_bf16 v[68:71], a[180:183], a[20:23], v[68:71]
  ds_read_b128 a[88:91], v46 offset:4352
  ds_read_b128 a[120:123], v46 offset:5376
  v_mfma_f32_16x16x32_bf16 v[72:75], a[148:151], a[52:55], v[72:75]
  ds_read_b128 a[152:155], v34 offset:256
  ds_read_b128 a[184:187], v34 offset:2304
  v_mfma_f32_16x16x32_bf16 v[76:79], a[180:183], a[52:55], v[76:79]
  ds_read_b128 a[216:219], v34 offset:16640
  ds_read_b128 a[248:251], v34 offset:18688
  v_mfma_f32_16x16x32_bf16 v[80:83], a[148:151], a[84:87], v[80:83]
  v_mfma_f32_16x16x32_bf16 v[84:87], a[180:183], a[84:87], v[84:87]
  v_mfma_f32_16x16x32_bf16 v[88:91], a[148:151], a[116:119], v[88:91]
  v_mfma_f32_16x16x32_bf16 v[92:95], a[180:183], a[116:119], v[92:95]
  v_mfma_f32_16x16x32_bf16 v[96:99], a[212:215], a[20:23], v[96:99]
  v_mfma_f32_16x16x32_bf16 v[100:103], a[244:247], a[20:23], v[100:103]
  v_mfma_f32_16x16x32_bf16 v[104:107], a[212:215], a[52:55], v[104:107]
  v_mfma_f32_16x16x32_bf16 v[108:111], a[244:247], a[52:55], v[108:111]
  v_mfma_f32_16x16x32_bf16 v[112:115], a[212:215], a[84:87], v[112:115]
  v_mfma_f32_16x16x32_bf16 v[116:119], a[244:247], a[84:87], v[116:119]
  v_mfma_f32_16x16x32_bf16 v[120:123], a[212:215], a[116:119], v[120:123]
  v_mfma_f32_16x16x32_bf16 v[124:127], a[244:247], a[116:119], v[124:127]
  s_waitcnt lgkmcnt(0)
  v_mfma_f32_16x16x32_bf16 v[64:67], a[152:155], a[24:27], v[64:67]
  ds_read_b128 a[28:31], v47 offset:256
  ds_read_b128 a[60:63], v47 offset:1280
  v_mfma_f32_16x16x32_bf16 v[68:71], a[184:187], a[24:27], v[68:71]
  ds_read_b128 a[92:95], v47 offset:4352
  ds_read_b128 a[124:127], v47 offset:5376
  v_mfma_f32_16x16x32_bf16 v[72:75], a[152:155], a[56:59], v[72:75]
  ds_read_b128 a[156:159], v35 offset:256
  ds_read_b128 a[188:191], v35 offset:2304
  v_mfma_f32_16x16x32_bf16 v[76:79], a[184:187], a[56:59], v[76:79]
  ds_read_b128 a[220:223], v35 offset:16640
  ds_read_b128 a[252:255], v35 offset:18688
  v_mfma_f32_16x16x32_bf16 v[80:83], a[152:155], a[88:91], v[80:83]
  v_mfma_f32_16x16x32_bf16 v[84:87], a[184:187], a[88:91], v[84:87]
  v_mfma_f32_16x16x32_bf16 v[88:91], a[152:155], a[120:123], v[88:91]
  v_mfma_f32_16x16x32_bf16 v[92:95], a[184:187], a[120:123], v[92:95]
  v_mfma_f32_16x16x32_bf16 v[96:99], a[216:219], a[24:27], v[96:99]
  v_mfma_f32_16x16x32_bf16 v[100:103], a[248:251], a[24:27], v[100:103]
  v_mfma_f32_16x16x32_bf16 v[104:107], a[216:219], a[56:59], v[104:107]
  v_mfma_f32_16x16x32_bf16 v[108:111], a[248:251], a[56:59], v[108:111]
  v_mfma_f32_16x16x32_bf16 v[112:115], a[216:219], a[88:91], v[112:115]
  v_mfma_f32_16x16x32_bf16 v[116:119], a[248:251], a[88:91], v[116:119]
  v_mfma_f32_16x16x32_bf16 v[120:123], a[216:219], a[120:123], v[120:123]
  v_mfma_f32_16x16x32_bf16 v[124:127], a[248:251], a[120:123], v[124:127]
  s_waitcnt lgkmcnt(0)
  s_barrier
  buffer_load_dwordx2 v[254:255], v252, s[12:15], 0 offen offset:128 sc1
  buffer_load_dword v253, v252, s[12:15], 0 offen sc1
  v_mfma_f32_16x16x32_bf16 v[64:67], a[156:159], a[28:31], v[64:67]
  v_mfma_f32_16x16x32_bf16 v[68:71], a[188:191], a[28:31], v[68:71]
  v_mfma_f32_16x16x32_bf16 v[72:75], a[156:159], a[60:63], v[72:75]
  v_mfma_f32_16x16x32_bf16 v[76:79], a[188:191], a[60:63], v[76:79]
  v_mfma_f32_16x16x32_bf16 v[80:83], a[156:159], a[92:95], v[80:83]
  v_pk_mul_f32 v[64:65], v[64:65], v[48:49] op_sel_hi:[1,0]
  v_pk_mul_f32 v[66:67], v[66:67], v[48:49] op_sel_hi:[1,0]
  v_mfma_f32_16x16x32_bf16 v[84:87], a[188:191], a[92:95], v[84:87]
  v_pk_mul_f32 v[68:69], v[68:69], v[48:49] op_sel_hi:[1,0]
  v_pk_mul_f32 v[70:71], v[70:71], v[48:49] op_sel_hi:[1,0]
  v_mfma_f32_16x16x32_bf16 v[88:91], a[156:159], a[124:127], v[88:91]
  v_cvt_pk_bf16_f32 v64, v64, v65
  v_cvt_pk_bf16_f32 v65, v66, v67
  v_mfma_f32_16x16x32_bf16 v[92:95], a[188:191], a[124:127], v[92:95]
  v_cvt_pk_bf16_f32 v66, v68, v69
  v_cvt_pk_bf16_f32 v67, v70, v71
  v_mfma_f32_16x16x32_bf16 v[96:99], a[220:223], a[28:31], v[96:99]
  buffer_store_dwordx4 v[64:67], v28, s[8:11], s29 offen sc1
  v_pk_mul_f32 v[72:73], v[72:73], v[48:49] op_sel_hi:[1,0]
  v_mfma_f32_16x16x32_bf16 v[100:103], a[252:255], a[28:31], v[100:103]
  v_pk_mul_f32 v[74:75], v[74:75], v[48:49] op_sel_hi:[1,0]
  v_pk_mul_f32 v[76:77], v[76:77], v[48:49] op_sel_hi:[1,0]
  v_mfma_f32_16x16x32_bf16 v[104:107], a[220:223], a[60:63], v[104:107]
  v_pk_mul_f32 v[78:79], v[78:79], v[48:49] op_sel_hi:[1,0]
  v_cvt_pk_bf16_f32 v72, v72, v73
  v_mfma_f32_16x16x32_bf16 v[108:111], a[252:255], a[60:63], v[108:111]
  v_cvt_pk_bf16_f32 v73, v74, v75
  v_cvt_pk_bf16_f32 v74, v76, v77
  v_mfma_f32_16x16x32_bf16 v[112:115], a[220:223], a[92:95], v[112:115]
  v_cvt_pk_bf16_f32 v75, v78, v79
  buffer_store_dwordx4 v[72:75], v29, s[8:11], s29 offen sc1
  v_mfma_f32_16x16x32_bf16 v[116:119], a[252:255], a[92:95], v[116:119]
  v_pk_mul_f32 v[80:81], v[80:81], v[48:49] op_sel_hi:[1,0]
  v_pk_mul_f32 v[82:83], v[82:83], v[48:49] op_sel_hi:[1,0]
  v_mfma_f32_16x16x32_bf16 v[120:123], a[220:223], a[124:127], v[120:123]
  v_pk_mul_f32 v[84:85], v[84:85], v[48:49] op_sel_hi:[1,0]
  v_pk_mul_f32 v[86:87], v[86:87], v[48:49] op_sel_hi:[1,0]
  v_mfma_f32_16x16x32_bf16 v[124:127], a[252:255], a[124:127], v[124:127]
  v_cvt_pk_bf16_f32 v80, v80, v81
  v_cvt_pk_bf16_f32 v81, v82, v83
  v_cvt_pk_bf16_f32 v82, v84, v85
  v_cvt_pk_bf16_f32 v83, v86, v87
  buffer_store_dwordx4 v[80:83], v30, s[8:11], s29 offen sc1
  v_pk_mul_f32 v[88:89], v[88:89], v[48:49] op_sel_hi:[1,0]
  v_pk_mul_f32 v[90:91], v[90:91], v[48:49] op_sel_hi:[1,0]
  v_pk_mul_f32 v[92:93], v[92:93], v[48:49] op_sel_hi:[1,0]
  v_pk_mul_f32 v[94:95], v[94:95], v[48:49] op_sel_hi:[1,0]
  v_cvt_pk_bf16_f32 v88, v88, v89
  v_cvt_pk_bf16_f32 v89, v90, v91
  v_cvt_pk_bf16_f32 v90, v92, v93
  v_cvt_pk_bf16_f32 v91, v94, v95
  buffer_store_dwordx4 v[88:91], v31, s[8:11], s29 offen sc1
  v_pk_mul_f32 v[96:97], v[96:97], v[48:49] op_sel_hi:[1,0]
  v_pk_mul_f32 v[98:99], v[98:99], v[48:49] op_sel_hi:[1,0]
  v_pk_mul_f32 v[100:101], v[100:101], v[48:49] op_sel_hi:[1,0]
  v_pk_mul_f32 v[102:103], v[102:103], v[48:49] op_sel_hi:[1,0]
  v_cvt_pk_bf16_f32 v96, v96, v97
  v_cvt_pk_bf16_f32 v97, v98, v99
  v_cvt_pk_bf16_f32 v98, v100, v101
  v_cvt_pk_bf16_f32 v99, v102, v103
  buffer_store_dwordx4 v[96:99], v28, s[8:11], s31 offen sc1
  v_pk_mul_f32 v[104:105], v[104:105], v[48:49] op_sel_hi:[1,0]
  v_pk_mul_f32 v[106:107], v[106:107], v[48:49] op_sel_hi:[1,0]
  v_pk_mul_f32 v[108:109], v[108:109], v[48:49] op_sel_hi:[1,0]
  v_pk_mul_f32 v[110:111], v[110:111], v[48:49] op_sel_hi:[1,0]
  v_cvt_pk_bf16_f32 v104, v104, v105
  v_cvt_pk_bf16_f32 v105, v106, v107
  v_cvt_pk_bf16_f32 v106, v108, v109
  v_cvt_pk_bf16_f32 v107, v110, v111
  buffer_store_dwordx4 v[104:107], v29, s[8:11], s31 offen sc1
  v_pk_mul_f32 v[112:113], v[112:113], v[48:49] op_sel_hi:[1,0]
  v_pk_mul_f32 v[114:115], v[114:115], v[48:49] op_sel_hi:[1,0]
  v_pk_mul_f32 v[116:117], v[116:117], v[48:49] op_sel_hi:[1,0]
  v_pk_mul_f32 v[118:119], v[118:119], v[48:49] op_sel_hi:[1,0]
  v_cvt_pk_bf16_f32 v112, v112, v113
  v_cvt_pk_bf16_f32 v113, v114, v115
  v_cvt_pk_bf16_f32 v114, v116, v117
  v_cvt_pk_bf16_f32 v115, v118, v119
  buffer_store_dwordx4 v[112:115], v30, s[8:11], s31 offen sc1
  v_pk_mul_f32 v[120:121], v[120:121], v[48:49] op_sel_hi:[1,0]
  v_pk_mul_f32 v[122:123], v[122:123], v[48:49] op_sel_hi:[1,0]
  v_pk_mul_f32 v[124:125], v[124:125], v[48:49] op_sel_hi:[1,0]
  v_pk_mul_f32 v[126:127], v[126:127], v[48:49] op_sel_hi:[1,0]
  v_cvt_pk_bf16_f32 v120, v120, v121
  v_cvt_pk_bf16_f32 v121, v122, v123
  v_cvt_pk_bf16_f32 v122, v124, v125
  v_cvt_pk_bf16_f32 v123, v126, v127
  buffer_store_dwordx4 v[120:123], v31, s[8:11], s31 offen sc1
  s_waitcnt vmcnt(0)
  s_barrier
  s_cmp_lg_u32 s16, 0
  s_cbranch_scc1 wp_f3_f
  v_readfirstlane_b32 s20, v254
  s_cmp_eq_u32 s20, 1
  s_cbranch_scc1 wp_f3_w_ok
  s_mov_b32 s30, 0
wp_f3_w:
  buffer_load_dword v254, off, s[12:15], 0 offset:128 sc1
  s_waitcnt vmcnt(0)
  v_cmp_ne_u32 vcc, 1, v254
  s_cbranch_vccz wp_f3_w_ok
  s_sleep 8
  s_add_u32 s30, s30, 1
  s_cmp_lt_u32 s30, 16
  s_cbranch_scc1 wp_f3_w
  s_branch wp_f3_f
wp_f3_w_ok:
  s_lshl_b32 s20, s17, 7
  s_add_u32 s20, s20, 584192
  s_lshl_b32 s21, 1, s19
  v_mov_b32 v248, s21
  s_mov_b64 exec, 1
  buffer_atomic_or v248, v252, s[8:11], s20 offen sc0
  s_mov_b64 exec, -1
  s_mov_b32 s38, s21
wp_f3_f:
  s_cmp_eq_u32 s97, 3
  s_cbranch_scc1 wk_adone
wp_fin:
  s_cmp_lg_u32 s97, 0
  s_cbranch_scc1 wp_all
  v_readfirstlane_b32 s20, v254
  v_readfirstlane_b32 s21, v253
  s_and_b32 s21, s21, 0xffe0
  s_cselect_b32 s96, s20, 0
  s_cmp_eq_u32 s96, 0
  s_cbranch_scc1 wp_all
  v_mov_b32 v250, 1
  s_mov_b32 s20, 588288
  s_mov_b64 exec, 1
  buffer_atomic_add v250, v252, s[8:11], s20 offen sc0
  s_mov_b64 exec, -1
wp_all:
  v_mov_b32 v252, 0x40000000
  v_cmp_eq_u32 vcc, 0, v0
  s_nop 1
  v_cndmask_b32 v252, v252, v0, vcc
  s_mov_b32 s34, 0
  s_cmp_lg_u32 s16, 0
  s_cbranch_scc1 wp_w2
  s_getreg_b32 s24, hwreg(HW_REG_XCC_ID)
  s_sub_u32 s24, s24, 3
  s_and_b32 s24, s24, 7
  s_lshl_b32 s24, s24, 7
  s_add_u32 s24, s24, 586240
  s_cmp_lg_u32 s96, 0
  s_cbranch_scc1 wp_v0
  s_waitcnt vmcnt(0)
wp_v0:
  s_cmp_eq_u32 s97, 0
  s_cbranch_scc1 wp_v1
  s_waitcnt vmcnt(0)
wp_v1:
  s_waitcnt vmcnt(1)
  v_readfirstlane_b32 s20, v248
  s_and_b32 s20, s20, 14448
  s_xor_b32 s20, s20, s38
  s_cmp_lg_u32 s20, 14448
  s_cselect_b32 s20, 0, s38
  s_mov_b32 s38, 0
  s_cmp_eq_u32 s20, 0
  s_cbranch_scc1 wp_g3
  s_lshl_b32 s21, 65536, s17
  v_mov_b32 v248, s21
  s_mov_b32 s20, 586240
  v_lshlrev_b32 v247, 7, v0
  s_mov_b64 exec, 0xff
  buffer_atomic_or v248, v247, s[8:11], s20 offen
  s_mov_b64 exec, -1
wp_g3:
  v_readfirstlane_b32 s20, v248
  s_and_b32 s20, s20, 16383
  s_xor_b32 s20, s20, s37
  s_cmp_lg_u32 s20, 16383
  s_cselect_b32 s20, 0, s37
  s_mov_b32 s37, 0
  s_cmp_eq_u32 s20, 0
  s_cbranch_scc1 wp_g2
  s_lshl_b32 s21, 1, s17
  v_mov_b32 v248, s21
  s_mov_b32 s20, 586240
  v_lshlrev_b32 v247, 7, v0
  s_mov_b64 exec, 0xff
  buffer_atomic_or v248, v247, s[8:11], s20 offen
  s_mov_b64 exec, -1
wp_g2:
  s_cmp_lg_u32 s96, 0
  s_cbranch_scc1 wp_v_ok
  s_mov_b32 s30, 0
wp_v:
  buffer_load_dwordx2 v[64:65], off, s[12:15], 0 sc1
  buffer_load_dword v66, off, s[12:15], 0 offset:128 sc1
  s_waitcnt vmcnt(0)
  v_and_b32 v68, 0xffe0, v64
  v_min_u32 v68, v68, v66
  v_cmp_ne_u32 vcc, 1, v68
  s_cbranch_vccz wp_v_ok
  s_sleep 16
  s_add_u32 s30, s30, 1
  s_cmp_lt_u32 s30, 30
  s_cbranch_scc1 wp_v
  s_branch wp_w1
wp_v_ok:
  v_mov_b32 v64, 32
  s_cmp_eq_u32 s97, 2
  s_cselect_b32 s31, 1, 60
  s_cmp_eq_u32 s39, -1
  s_cselect_b32 s20, 4, 0
  s_add_u32 s24, s24, s20
  s_mov_b32 s30, 0
wp_w:
  buffer_load_dword v66, off, s[8:11], s24 sc1
  buffer_load_dword v67, off, s[8:11], s24 offset:4 sc1
  s_waitcnt vmcnt(0)
  v_or_b32 v66, s39, v66
  v_add_u32 v66, v66, v67
  v_cmp_ne_u32 vcc, 0, v66
  s_cbranch_vccz wp_w_ok
  s_sleep 8
  s_add_u32 s30, s30, 1
  s_cmp_lt_u32 s30, s31
  s_cbranch_scc1 wp_w
  s_branch wp_w1
wp_w_ok:
  s_branch wp_w2
wp_w1:
  v_readfirstlane_b32 s20, v64
  v_readfirstlane_b32 s21, v65
  s_and_b32 s20, s20, 0xffff
  s_cmp_lt_u32 s20, 32
  s_cselect_b32 s34, 2, 1
  s_add_u32 s32, s32, 1
  s_cmp_lt_u32 s32, 4000
  s_cselect_b32 s34, s34, 3
wp_w2:
  v_mov_b32 v6, 160032
  v_mov_b32 v7, s34
  s_barrier
  s_cmp_lg_u32 s16, 0
  s_cbranch_scc1 uni_7
  ds_write_b32 v6, v7
  s_waitcnt lgkmcnt(0)
uni_7:
  s_barrier
  ds_read_b32 v7, v6
  s_waitcnt lgkmcnt(0)
  v_readfirstlane_b32 s34, v7
  s_cmp_lg_u32 s34, 0
  s_cbranch_scc1 wp_bad
  s_cmp_lg_u32 s39, -1
  s_cbranch_scc1 wp_done
  s_mov_b32 s101, 0
  s_lshl_b32 s20, s101, 4
  s_lshr_b32 s21, s2, 3
  s_add_u32 s21, s21, s16
  s_and_b32 s21, s21, 3
  s_lshl_b32 s21, s21, 2
  s_add_u32 s20, s20, s21
  s_mul_i32 s21, s20, 14336
  s_add_u32 s21, s21, 655360
  s_add_u32 s22, s21, 0
  buffer_load_dwordx4 a[0:3], v2, s[8:11], s22 offen offset:0 sc1
  buffer_load_dwordx4 a[4:7], v2, s[8:11], s22 offen offset:1024 sc1
  buffer_load_dwordx4 a[8:11], v2, s[8:11], s22 offen offset:2048 sc1
  buffer_load_dwordx4 a[12:15], v2, s[8:11], s22 offen offset:3072 sc1
  s_add_u32 s22, s21, 4096
  buffer_load_dwordx4 a[16:19], v2, s[8:11], s22 offen offset:0 sc1
  buffer_load_dwordx4 a[20:23], v2, s[8:11], s22 offen offset:1024 sc1
  buffer_load_dwordx4 a[24:27], v2, s[8:11], s22 offen offset:2048 sc1
  buffer_load_dwordx4 a[28:31], v2, s[8:11], s22 offen offset:3072 sc1
  s_add_u32 s22, s21, 8192
  buffer_load_dwordx4 a[32:35], v2, s[8:11], s22 offen offset:0 sc1
  buffer_load_dwordx4 a[36:39], v2, s[8:11], s22 offen offset:1024 sc1
  buffer_load_dwordx4 a[40:43], v2, s[8:11], s22 offen offset:2048 sc1
  buffer_load_dwordx4 a[44:47], v2, s[8:11], s22 offen offset:3072 sc1
  s_add_u32 s22, s21, 12288
  buffer_load_dwordx4 a[48:51], v2, s[8:11], s22 offen offset:0 sc1
  buffer_load_dwordx4 a[52:55], v2, s[8:11], s22 offen offset:1024 sc1
  buffer_load_dwordx4 a[56:59], v2, s[8:11], s22 offen offset:2048 sc1
  buffer_load_dwordx4 a[60:63], v2, s[8:11], s22 offen offset:3072 sc1
  s_add_u32 s22, s21, 16384
  buffer_load_dwordx4 a[64:67], v2, s[8:11], s22 offen offset:0 sc1
  buffer_load_dwordx4 a[68:71], v2, s[8:11], s22 offen offset:1024 sc1
  buffer_load_dwordx4 a[72:75], v2, s[8:11], s22 offen offset:2048 sc1
  buffer_load_dwordx4 a[76:79], v2, s[8:11], s22 offen offset:3072 sc1
  s_add_u32 s22, s21, 20480
  buffer_load_dwordx4 a[80:83], v2, s[8:11], s22 offen offset:0 sc1
  buffer_load_dwordx4 a[84:87], v2, s[8:11], s22 offen offset:1024 sc1
  buffer_load_dwordx4 a[88:91], v2, s[8:11], s22 offen offset:2048 sc1
  buffer_load_dwordx4 a[92:95], v2, s[8:11], s22 offen offset:3072 sc1
  s_add_u32 s22, s21, 24576
  buffer_load_dwordx4 a[96:99], v2, s[8:11], s22 offen offset:0 sc1
  buffer_load_dwordx4 a[100:103], v2, s[8:11], s22 offen offset:1024 sc1
  buffer_load_dwordx4 a[104:107], v2, s[8:11], s22 offen offset:2048 sc1
  buffer_load_dwordx4 a[108:111], v2, s[8:11], s22 offen offset:3072 sc1
  s_add_u32 s22, s21, 28672
  buffer_load_dwordx4 a[112:115], v2, s[8:11], s22 offen offset:0 sc1
  buffer_load_dwordx4 a[116:119], v2, s[8:11], s22 offen offset:1024 sc1
  buffer_load_dwordx4 a[120:123], v2, s[8:11], s22 offen offset:2048 sc1
  buffer_load_dwordx4 a[124:127], v2, s[8:11], s22 offen offset:3072 sc1
  s_add_u32 s22, s21, 32768
  buffer_load_dwordx4 a[128:131], v2, s[8:11], s22 offen offset:0 sc1
  buffer_load_dwordx4 a[132:135], v2, s[8:11], s22 offen offset:1024 sc1
  buffer_load_dwordx4 a[136:139], v2, s[8:11], s22 offen offset:2048 sc1
  buffer_load_dwordx4 a[140:143], v2, s[8:11], s22 offen offset:3072 sc1
  s_add_u32 s22, s21, 36864
  buffer_load_dwordx4 a[144:147], v2, s[8:11], s22 offen offset:0 sc1
  buffer_load_dwordx4 a[148:151], v2, s[8:11], s22 offen offset:1024 sc1
  buffer_load_dwordx4 a[152:155], v2, s[8:11], s22 offen offset:2048 sc1
  buffer_load_dwordx4 a[156:159], v2, s[8:11], s22 offen offset:3072 sc1
  s_add_u32 s22, s21, 40960
  s_waitcnt vmcnt(40)
  buffer_load_dwordx4 a[160:163], v2, s[8:11], s22 offen offset:0 sc1
  buffer_load_dwordx4 a[164:167], v2, s[8:11], s22 offen offset:1024 sc1
  buffer_load_dwordx4 a[168:171], v2, s[8:11], s22 offen offset:2048 sc1
  buffer_load_dwordx4 a[172:175], v2, s[8:11], s22 offen offset:3072 sc1
  s_add_u32 s22, s21, 45056
  buffer_load_dwordx4 a[176:179], v2, s[8:11], s22 offen offset:0 sc1
  buffer_load_dwordx4 a[180:183], v2, s[8:11], s22 offen offset:1024 sc1
  buffer_load_dwordx4 a[184:187], v2, s[8:11], s22 offen offset:2048 sc1
  buffer_load_dwordx4 a[188:191], v2, s[8:11], s22 offen offset:3072 sc1
  s_add_u32 s22, s21, 49152
  buffer_load_dwordx4 a[192:195], v2, s[8:11], s22 offen offset:0 sc1
  buffer_load_dwordx4 a[196:199], v2, s[8:11], s22 offen offset:1024 sc1
  buffer_load_dwordx4 a[200:203], v2, s[8:11], s22 offen offset:2048 sc1
  buffer_load_dwordx4 a[204:207], v2, s[8:11], s22 offen offset:3072 sc1
  s_add_u32 s22, s21, 53248
  buffer_load_dwordx4 a[208:211], v2, s[8:11], s22 offen offset:0 sc1
  buffer_load_dwordx4 a[212:215], v2, s[8:11], s22 offen offset:1024 sc1
  buffer_load_dwordx4 a[216:219], v2, s[8:11], s22 offen offset:2048 sc1
  buffer_load_dwordx4 a[220:223], v2, s[8:11], s22 offen offset:3072 sc1
  s_mov_b32 s39, 0xffff0000
  s_branch wp_all
wp_bad:
  s_and_b32 s39, s39, 0xffff0000
  s_mov_b32 s97, 1
  s_cmp_eq_u32 s34, 1
  s_cbranch_scc1 wp_rep
  s_cmp_eq_u32 s34, 3
  s_cbranch_scc1 cA_abort
  s_load_dwordx8 s[40:47], s[0:1], 72
  s_load_dwordx4 s[48:51], s[0:1], 56
  s_waitcnt lgkmcnt(0)
  v_mov_b32 v4, 0x10001
  s_mov_b32 s18, 1
  s_branch ch_take
wp_rep:
  s_mov_b32 s101, -1
  s_load_dwordx8 s[40:47], s[0:1], 72
  s_load_dwordx4 s[48:51], s[0:1], 56
  s_waitcnt vmcnt(0) lgkmcnt(0)
  v_mov_b32 v4, 1
  v_mov_b32 v5, 20
  v_mov_b32 v6, 160000
  s_barrier
  s_cmp_lg_u32 s16, 0
  s_cbranch_scc1 wp_el1
  s_mov_b64 exec, 1
  buffer_atomic_add v4, v5, s[12:15], 0 offen sc0
  s_waitcnt vmcnt(0)
  ds_write_b32 v6, v4
  s_waitcnt lgkmcnt(0)
  s_mov_b64 exec, -1
wp_el1:
  s_barrier
  ds_read_b32 v4, v6
  s_waitcnt lgkmcnt(0)
  v_readfirstlane_b32 s33, v4
  v_and_b32 v1, 63, v0
  v_lshlrev_b32 v2, 4, v1
  v_lshrrev_b32 v3, 4, v1
  v_and_b32 v4, 15, v1
  v_lshrrev_b32 v5, 5, v1
  v_and_b32 v6, 31, v1
  v_xor_b32 v8, v6, v5
  v_lshlrev_b32 v8, 4, v8
  v_lshl_add_u32 v16, v5, 13, v8
  v_xor_b32 v17, 32, v16
  v_xor_b32 v18, 64, v16
  v_xor_b32 v19, 96, v16
  v_xor_b32 v20, 128, v16
  v_xor_b32 v21, 160, v16
  v_xor_b32 v22, 192, v16
  v_xor_b32 v23, 224, v16
  s_lshl_b32 s20, s16, 6
  v_xor_b32 v26, s20, v16
  v_xor_b32 v27, 32, v26
  s_and_b32 s33, s33, 511
  s_and_b32 s20, s33, 255
  s_cmp_ge_u32 s20, 224
  s_cselect_b32 s97, 1, 2
  s_cbranch_scc1 wp_all
  s_mul_i32 s17, s20, 4682
  s_lshr_b32 s17, s17, 16
  s_mul_i32 s23, s17, 14
  s_sub_u32 s19, s20, s23
  s_cmp_lt_u32 s19, 7
  s_cselect_b32 s18, 0, 7
  s_cselect_b32 s28, 0, 8
  s_sub_u32 s18, s19, s18
  s_add_u32 s28, s28, s16
  s_lshl_b32 s25, s16, 15
  s_add_u32 s25, s25, 32768
  s_lshl_b32 s26, s17, 9
  s_lshl_b32 s20, s17, 7
  s_lshr_b32 s21, s33, 8
  s_lshl_b32 s21, s21, 11
  s_add_u32 s20, s20, s21
  s_add_u32 s20, s20, 582144
  buffer_load_dword v5, off, s[8:11], s20 sc1
  s_waitcnt vmcnt(0)
  v_readfirstlane_b32 s34, v5
  v_mov_b32 v6, 160032
  s_nop 0
  v_mov_b32 v7, s34
  s_barrier
  s_cmp_lg_u32 s16, 0
  s_cbranch_scc1 uni_8
  ds_write_b32 v6, v7
  s_waitcnt lgkmcnt(0)
uni_8:
  s_barrier
  ds_read_b32 v7, v6
  s_waitcnt lgkmcnt(0)
  v_readfirstlane_b32 s34, v7
  s_cmp_lt_u32 s33, 256
  s_cselect_b32 s20, 0, 1935
  s_or_b32 s34, s34, s20
  s_bitcmp1_b32 s34, s19
  s_cbranch_scc1 wp_rep
  s_barrier
  s_cmp_lt_u32 s33, 256
  s_cbranch_scc1 wp_B
  s_branch wp_A0
wp_done:
  s_mov_b32 s97, s39
  s_cmp_lg_u32 s96, 0
  s_cbranch_scc1 wk_next
  s_cmp_lg_u32 s16, 0
  s_cbranch_scc1 ask_9
  v_mov_b32 v250, 1
  v_mov_b32 v251, 588288
  s_mov_b64 exec, 1
  buffer_atomic_add v250, v251, s[8:11], 0 offen sc0
  s_mov_b64 exec, -1
ask_9:
  s_branch wk_next
wk_loop:
  s_waitcnt vmcnt(0) lgkmcnt(0)
  s_getreg_b32 s22, hwreg(HW_REG_XCC_ID)
  s_and_b32 s22, s22, 15
  s_bitcmp0_b32 4, s22
  s_cbranch_scc1 wk_ni
  s_cmp_ge_u32 s96, 6
  s_cbranch_scc1 wk_ni
  s_mov_b32 s96, 6
  v_mov_b32 v4, 1
  v_mov_b32 v5, 587520
  v_mov_b32 v6, 160000
  s_barrier
  s_cmp_lg_u32 s16, 0
  s_cbranch_scc1 wk_ide1
  s_mov_b64 exec, 1
  buffer_atomic_add v4, v5, s[8:11], 0 offen sc0
  s_waitcnt vmcnt(0)
  ds_write_b32 v6, v4
  s_waitcnt lgkmcnt(0)
  s_mov_b64 exec, -1
wk_ide1:
  s_barrier
  ds_read_b32 v4, v6
  s_waitcnt lgkmcnt(0)
  v_readfirstlane_b32 s3, v4
  s_cmp_lt_u32 s3, 32
  s_cbranch_scc1 wk_done
wk_ni:
  s_getreg_b32 s22, hwreg(HW_REG_XCC_ID)
  s_and_b32 s22, s22, 15
  s_cmp_lg_u32 s22, 15
  s_cbranch_scc1 wk_ask
  s_cmp_eq_u32 s96, 7
  s_cbranch_scc0 wk_srv
wk_ask:
  v_readfirstlane_b32 s22, v250
  s_cmp_ge_u32 s22, 1264
  s_cbranch_scc1 wk_next
  s_cmp_lg_u32 s16, 0
  s_cbranch_scc1 ask_10
  v_mov_b32 v250, 1
  v_mov_b32 v251, 588288
  s_mov_b64 exec, 1
  buffer_atomic_add v250, v251, s[8:11], 0 offen sc0
  s_mov_b64 exec, -1
ask_10:
wk_next:
  v_mov_b32 v6, 160000
  s_waitcnt vmcnt(0)
  s_barrier
  s_cmp_lg_u32 s16, 0
  s_cbranch_scc1 wk_n1
  s_mov_b64 exec, 1
  ds_write_b32 v6, v250
  s_mov_b64 exec, -1
  s_waitcnt lgkmcnt(0)
wk_n1:
  s_barrier
  ds_read_b32 v4, v6
  s_waitcnt lgkmcnt(0)
  v_readfirstlane_b32 s3, v4
  s_cmp_ge_u32 s3, 1264
  s_cbranch_scc1 wk_done
  v_mov_b32 v250, 0
  v_mov_b32 v251, 587264
  s_cmp_lg_u32 s3, 1263
  s_cbranch_scc1 wk_nl
  v_mov_b32 v5, 1264
  s_mov_b64 exec, 1
  buffer_store_dword v5, v251, s[8:11], 0 offen sc1
  s_mov_b64 exec, -1
wk_nl:
  v_and_b32 v1, 63, v0
  v_lshlrev_b32 v2, 4, v1
  v_lshrrev_b32 v3, 4, v1
  v_and_b32 v4, 15, v1
  s_cmp_lt_u32 s3, 112
  s_cbranch_scc1 wk_n2
  s_cmp_eq_u32 s97, 0
  s_cbranch_scc1 wk_n2
  v_mov_b32 v250, s3
  s_mov_b32 s96, 1
  s_mov_b32 s97, 1
  s_mov_b32 s39, 0
  s_mov_b32 s37, 0
  s_mov_b32 s38, 0
  s_mov_b32 s32, 0
  s_branch wp_all
wk_n2:
  s_sub_u32 s20, s3, 288
  s_cmp_ge_u32 s20, 352
  s_cbranch_scc1 wk_nr
  s_cmp_ge_u32 s20, 320
  s_cbranch_scc1 wk_srv
  s_add_u32 s3, s3, 32
wk_nr:
  s_cmp_ge_u32 s3, 752
  s_cbranch_scc1 wk_tok
  s_cmp_ge_u32 s3, 640
  s_cbranch_scc1 wk_s4d
  s_cmp_ge_u32 s3, 448
  s_cbranch_scc1 wk_full
  s_cmp_ge_u32 s3, 320
  s_cbranch_scc1 wk_adef
  s_cmp_ge_u32 s3, 288
  s_cbranch_scc1 wk_srv
  s_and_b32 s17, s3, 15
  s_add_u32 s17, s17, 16
  s_cmp_ge_u32 s3, 224
  s_cbranch_scc1 wk_half
  s_cmp_ge_u32 s3, 112
  s_cselect_b32 s18, 1, 0
  s_cselect_b32 s20, 112, 0
  s_sub_u32 s34, s3, s20
  s_lshr_b32 s34, s34, 4
  s_lshl_b32 s34, s34, 1
  s_add_u32 s35, s34, 2
  s_branch wk_gemm
wk_adef:
  s_mov_b32 s101, -1
  s_load_dwordx8 s[40:47], s[0:1], 72
  s_sub_u32 s20, s3, 320
  s_getreg_b32 s33, hwreg(HW_REG_XCC_ID)
  s_sub_u32 s33, s33, 4
  s_and_b32 s33, s33, 7
  s_min_u32 s33, s33, 7
  s_mov_b32 s35, 7
wk_adc:
  s_lshl_b32 s34, s33, 7
  s_add_u32 s34, s34, 589312
  v_mov_b32 v4, 1
  v_mov_b32 v5, s34
  v_mov_b32 v6, 160000
  s_barrier
  s_cmp_lg_u32 s16, 0
  s_cbranch_scc1 wk_ade1
  s_mov_b64 exec, 1
  buffer_atomic_add v4, v5, s[8:11], 0 offen sc0
  s_waitcnt vmcnt(0)
  ds_write_b32 v6, v4
  s_waitcnt lgkmcnt(0)
  s_mov_b64 exec, -1
wk_ade1:
  s_barrier
  ds_read_b32 v4, v6
  s_waitcnt lgkmcnt(0)
  v_readfirstlane_b32 s20, v4
  s_cmp_lt_u32 s20, 16
  s_cbranch_scc1 wk_adg
  s_mov_b32 s33, s35
  s_sub_u32 s35, s35, 1
  s_max_i32 s35, s35, 0
  s_branch wk_adc
wk_adg:
  s_lshl_b32 s33, s33, 4
  s_add_u32 s20, s20, s33
  v_and_b32 v1, 63, v0
  v_lshlrev_b32 v2, 4, v1
  v_lshrrev_b32 v3, 4, v1
  v_and_b32 v4, 15, v1
  s_lshr_b32 s33, s20, 2
  s_mul_i32 s33, s33, 7
  s_and_b32 s20, s20, 3
  s_add_u32 s33, s33, s20
  s_mov_b32 s97, 3
  v_mov_b32 v252, 0x40000000
  v_cmp_eq_u32 vcc, 0, v0
  s_nop 1
  v_cndmask_b32 v252, v252, v0, vcc
  v_lshrrev_b32 v5, 5, v1
  v_and_b32 v6, 31, v1
  v_xor_b32 v8, v6, v5
  v_lshlrev_b32 v8, 4, v8
  v_lshl_add_u32 v16, v5, 13, v8
  v_xor_b32 v17, 32, v16
  v_xor_b32 v18, 64, v16
  v_xor_b32 v19, 96, v16
  v_xor_b32 v20, 128, v16
  v_xor_b32 v21, 160, v16
  v_xor_b32 v22, 192, v16
  v_xor_b32 v23, 224, v16
  s_lshl_b32 s20, s16, 6
  v_xor_b32 v26, s20, v16
  v_xor_b32 v27, 32, v26
  s_mul_i32 s17, s33, 4682
  s_lshr_b32 s17, s17, 16
  s_mul_i32 s23, s17, 14
  s_sub_u32 s19, s33, s23
  s_cmp_lt_u32 s19, 7
  s_cselect_b32 s18, 0, 7
  s_cselect_b32 s28, 0, 8
  s_sub_u32 s18, s19, s18
  s_add_u32 s28, s28, s16
  s_lshl_b32 s25, s16, 15
  s_add_u32 s25, s25, 32768
  s_lshl_b32 s26, s17, 9
  s_waitcnt lgkmcnt(0)
  s_barrier
  s_branch wp_A0
wk_adone:
  s_mov_b32 s97, 0
  s_branch wk_loop
wk_half:
  s_sub_u32 s20, s3, 224
  s_lshr_b32 s18, s20, 5
  s_add_u32 s18, s18, 2
  s_bitcmp1_b32 s20, 4
  s_cselect_b32 s34, 7, 0
  s_add_u32 s35, s34, 7
  s_branch wk_gemm
wk_full:
  s_sub_u32 s20, s3, 384
  s_and_b32 s17, s20, 15
  s_lshr_b32 s18, s20, 4
  s_mov_b32 s34, 0
  s_mov_b32 s35, 14
  s_cmp_lt_u32 s18, 8
  s_cselect_b32 s21, 16, 0
  s_add_u32 s17, s17, s21
  s_and_b32 s18, s18, 7
  s_cmp_ge_u32 s17, 16
  s_cbranch_scc1 wk_gemm
  s_getreg_b32 s33, hwreg(HW_REG_XCC_ID)
  s_sub_u32 s33, s33, 4
  s_and_b32 s33, s33, 7
  s_min_u32 s33, s33, 7
  s_mov_b32 s35, 7
wk_fxc:
  s_lshl_b32 s34, s33, 7
  s_add_u32 s34, s34, 565312
  v_mov_b32 v4, 1
  v_mov_b32 v5, s34
  v_mov_b32 v6, 160000
  s_barrier
  s_cmp_lg_u32 s16, 0
  s_cbranch_scc1 wk_fxe1
  s_mov_b64 exec, 1
  buffer_atomic_add v4, v5, s[8:11], 0 offen sc0
  s_waitcnt vmcnt(0)
  ds_write_b32 v6, v4
  s_waitcnt lgkmcnt(0)
  s_mov_b64 exec, -1
wk_fxe1:
  s_barrier
  ds_read_b32 v4, v6
  s_waitcnt lgkmcnt(0)
  v_readfirstlane_b32 s20, v4
  s_cmp_lt_u32 s20, 16
  s_cbranch_scc1 wk_fxg
  s_mov_b32 s33, s35
  s_sub_u32 s35, s35, 1
  s_max_i32 s35, s35, 0
  s_branch wk_fxc
wk_fxg:
  s_lshl_b32 s33, s33, 4
  s_add_u32 s20, s20, s33
  v_and_b32 v1, 63, v0
  v_lshlrev_b32 v2, 4, v1
  v_lshrrev_b32 v3, 4, v1
  v_and_b32 v4, 15, v1
  s_lshr_b32 s17, s20, 4
  s_lshl_b32 s17, s17, 1
  s_and_b32 s21, s20, 1
  s_add_u32 s17, s17, s21
  s_bfe_u32 s18, s20, 0x30001
  s_mov_b32 s34, 0
  s_mov_b32 s35, 14
  s_load_dwordx8 s[40:47], s[0:1], 0
  s_load_dwordx2 s[48:49], s[0:1], 32
  s_sub_u32 s21, s3, 512
  v_min_u32 v12, 111, v0
  v_lshlrev_b32 v12, 7, v12
  v_min_u32 v13, 13, v0
  v_lshlrev_b32 v13, 7, v13
  s_mul_i32 s22, s21, 14336
  s_mul_i32 s21, s21, 1792
  s_waitcnt lgkmcnt(0)
  s_cmp_ge_u32 s16, 2
  s_cbranch_scc1 wk_up
  s_mov_b32 s60, s40
  s_and_b32 s61, s41, 0xffff
  s_mov_b32 s62, 1835008
  s_mov_b32 s63, 0x20000
  buffer_load_dword v14, v12, s[60:63], s22 offen
  s_mov_b32 s60, s42
  s_and_b32 s61, s43, 0xffff
  s_mov_b32 s62, 229376
  s_mov_b32 s63, 0x20000
  buffer_load_dword v14, v13, s[60:63], s21 offen
  s_mov_b32 s60, s44
  s_and_b32 s61, s45, 0xffff
  s_mov_b32 s62, 229376
  s_mov_b32 s63, 0x20000
  buffer_load_dword v14, v13, s[60:63], s21 offen
  s_mov_b32 s60, s46
  s_and_b32 s61, s47, 0xffff
  s_mov_b32 s62, 229376
  s_mov_b32 s63, 0x20000
  buffer_load_dword v14, v13, s[60:63], s21 offen
  s_mov_b32 s60, s48
  s_and_b32 s61, s49, 0xffff
  s_mov_b32 s62, 229376
  s_mov_b32 s63, 0x20000
  buffer_load_dword v14, v13, s[60:63], s21 offen
wk_up:
  s_lshl_b32 s27, s17, 7
  s_add_u32 s27, s27, 584192
  s_mov_b32 s28, 16383
  s_mov_b32 s30, 0
wk_aw:
  buffer_load_dword v9, off, s[8:11], s27  sc1
  s_waitcnt vmcnt(0)
  v_and_b32 v10, s28, v9
  v_cmp_ne_u32 vcc, s28, v10
  s_cbranch_vccz wk_aw_ok
  s_sleep 3
  s_add_u32 s30, s30, 1
  s_cmp_lt_u32 s30, 400000
  s_cbranch_scc1 wk_aw
  s_branch cA_abort
wk_aw_ok:
wk_gemm:
  s_lshl_b32 s20, s18, 4
  s_lshr_b32 s21, s2, 3
  s_add_u32 s21, s21, s16
  s_and_b32 s21, s21, 3
  s_lshl_b32 s21, s21, 2
  s_add_u32 s20, s20, s21
  s_mul_i32 s21, s20, 14336
  s_add_u32 s21, s21, 655360
  s_mul_i32 s23, s17, 401408
  s_and_b32 s22, s16, 1
  s_mul_i32 s22, s22, 7168
  s_add_u32 s23, s23, s22
  s_add_u32 s23, s23, 33554432
  s_lshr_b32 s22, s16, 1
  s_mul_i32 s22, s22, 14336
  s_add_u32 s23, s23, s22
  s_mul_i32 s27, s16, 7168
  s_lshr_b32 s28, s20, 1
  s_cmp_lt_u32 s17, 16
  s_cbranch_scc0 wg_vo
  s_add_u32 s23, s23, s22
  s_lshl_b32 s29, s28, 4
  s_add_u32 s29, s29, s17
  s_mul_i32 s29, s29, 28672
  s_add_u32 s29, s29, 46399488
  s_mov_b32 s31, 0
  s_lshr_b32 s24, s34, 1
  s_lshl_b32 s24, s24, 2
  s_and_b32 s25, s34, 1
  s_add_u32 s24, s24, s25
  s_mul_i32 s24, s24, 14336
  s_add_u32 s24, s24, s23
  s_add_u32 m0, s31, s27
  s_nop 0
  buffer_load_dwordx4 v2, s[8:11], s24 offen offset:0 sc1 lds
  buffer_load_dwordx4 v2, s[8:11], s24 offen offset:1024 sc1 lds
  buffer_load_dwordx4 v2, s[8:11], s24 offen offset:2048 sc1 lds
  buffer_load_dwordx4 v2, s[8:11], s24 offen offset:3072 sc1 lds
  s_add_u32 m0, m0, 4096
  s_add_u32 s24, s24, 4096
  buffer_load_dwordx4 v2, s[8:11], s24 offen offset:0 sc1 lds
  buffer_load_dwordx4 v2, s[8:11], s24 offen offset:1024 sc1 lds
  buffer_load_dwordx4 v2, s[8:11], s24 offen offset:2048 sc1 lds
  s_sub_u32 s36, s35, 1
  s_add_u32 s30, s34, 1
  s_min_u32 s30, s30, s36
  s_mov_b32 s31, 28672
  s_lshr_b32 s24, s30, 1
  s_lshl_b32 s24, s24, 2
  s_and_b32 s25, s30, 1
  s_add_u32 s24, s24, s25
  s_mul_i32 s24, s24, 14336
  s_add_u32 s24, s24, s23
  s_add_u32 m0, s31, s27
  s_nop 0
  buffer_load_dwordx4 v2, s[8:11], s24 offen offset:0 sc1 lds
  buffer_load_dwordx4 v2, s[8:11], s24 offen offset:1024 sc1 lds
  buffer_load_dwordx4 v2, s[8:11], s24 offen offset:2048 sc1 lds
  buffer_load_dwordx4 v2, s[8:11], s24 offen offset:3072 sc1 lds
  s_add_u32 m0, m0, 4096
  s_add_u32 s24, s24, 4096
  buffer_load_dwordx4 v2, s[8:11], s24 offen offset:0 sc1 lds
  buffer_load_dwordx4 v2, s[8:11], s24 offen offset:1024 sc1 lds
  buffer_load_dwordx4 v2, s[8:11], s24 offen offset:2048 sc1 lds
  s_mov_b32 s19, s34
  s_mov_b32 s32, 0
  s_mov_b32 s33, 57344
  s_cmp_eq_u32 s18, s101
  s_cbranch_scc1 wg_f_hx
  s_add_u32 s22, s21, 0
  buffer_load_dwordx4 a[0:3], v2, s[8:11], s22 offen offset:0 sc1
  buffer_load_dwordx4 a[4:7], v2, s[8:11], s22 offen offset:1024 sc1
  buffer_load_dwordx4 a[8:11], v2, s[8:11], s22 offen offset:2048 sc1
  buffer_load_dwordx4 a[12:15], v2, s[8:11], s22 offen offset:3072 sc1
  s_add_u32 s22, s21, 4096
  buffer_load_dwordx4 a[16:19], v2, s[8:11], s22 offen offset:0 sc1
  buffer_load_dwordx4 a[20:23], v2, s[8:11], s22 offen offset:1024 sc1
  buffer_load_dwordx4 a[24:27], v2, s[8:11], s22 offen offset:2048 sc1
  buffer_load_dwordx4 a[28:31], v2, s[8:11], s22 offen offset:3072 sc1
  s_add_u32 s22, s21, 8192
  buffer_load_dwordx4 a[32:35], v2, s[8:11], s22 offen offset:0 sc1
  buffer_load_dwordx4 a[36:39], v2, s[8:11], s22 offen offset:1024 sc1
  buffer_load_dwordx4 a[40:43], v2, s[8:11], s22 offen offset:2048 sc1
  buffer_load_dwordx4 a[44:47], v2, s[8:11], s22 offen offset:3072 sc1
  s_add_u32 s22, s21, 12288
  buffer_load_dwordx4 a[48:51], v2, s[8:11], s22 offen offset:0 sc1
  buffer_load_dwordx4 a[52:55], v2, s[8:11], s22 offen offset:1024 sc1
  buffer_load_dwordx4 a[56:59], v2, s[8:11], s22 offen offset:2048 sc1
  buffer_load_dwordx4 a[60:63], v2, s[8:11], s22 offen offset:3072 sc1
  s_add_u32 s22, s21, 16384
  buffer_load_dwordx4 a[64:67], v2, s[8:11], s22 offen offset:0 sc1
  buffer_load_dwordx4 a[68:71], v2, s[8:11], s22 offen offset:1024 sc1
  buffer_load_dwordx4 a[72:75], v2, s[8:11], s22 offen offset:2048 sc1
  buffer_load_dwordx4 a[76:79], v2, s[8:11], s22 offen offset:3072 sc1
  s_add_u32 s22, s21, 20480
  buffer_load_dwordx4 a[80:83], v2, s[8:11], s22 offen offset:0 sc1
  buffer_load_dwordx4 a[84:87], v2, s[8:11], s22 offen offset:1024 sc1
  buffer_load_dwordx4 a[88:91], v2, s[8:11], s22 offen offset:2048 sc1
  buffer_load_dwordx4 a[92:95], v2, s[8:11], s22 offen offset:3072 sc1
  s_add_u32 s22, s21, 24576
  buffer_load_dwordx4 a[96:99], v2, s[8:11], s22 offen offset:0 sc1
  buffer_load_dwordx4 a[100:103], v2, s[8:11], s22 offen offset:1024 sc1
  buffer_load_dwordx4 a[104:107], v2, s[8:11], s22 offen offset:2048 sc1
  buffer_load_dwordx4 a[108:111], v2, s[8:11], s22 offen offset:3072 sc1
  s_add_u32 s22, s21, 28672
  buffer_load_dwordx4 a[112:115], v2, s[8:11], s22 offen offset:0 sc1
  buffer_load_dwordx4 a[116:119], v2, s[8:11], s22 offen offset:1024 sc1
  buffer_load_dwordx4 a[120:123], v2, s[8:11], s22 offen offset:2048 sc1
  buffer_load_dwordx4 a[124:127], v2, s[8:11], s22 offen offset:3072 sc1
  s_add_u32 s22, s21, 32768
  buffer_load_dwordx4 a[128:131], v2, s[8:11], s22 offen offset:0 sc1
  buffer_load_dwordx4 a[132:135], v2, s[8:11], s22 offen offset:1024 sc1
  buffer_load_dwordx4 a[136:139], v2, s[8:11], s22 offen offset:2048 sc1
  buffer_load_dwordx4 a[140:143], v2, s[8:11], s22 offen offset:3072 sc1
  s_add_u32 s22, s21, 36864
  buffer_load_dwordx4 a[144:147], v2, s[8:11], s22 offen offset:0 sc1
  buffer_load_dwordx4 a[148:151], v2, s[8:11], s22 offen offset:1024 sc1
  buffer_load_dwordx4 a[152:155], v2, s[8:11], s22 offen offset:2048 sc1
  buffer_load_dwordx4 a[156:159], v2, s[8:11], s22 offen offset:3072 sc1
  s_add_u32 s22, s21, 40960
  s_waitcnt vmcnt(40)
  buffer_load_dwordx4 a[160:163], v2, s[8:11], s22 offen offset:0 sc1
  buffer_load_dwordx4 a[164:167], v2, s[8:11], s22 offen offset:1024 sc1
  buffer_load_dwordx4 a[168:171], v2, s[8:11], s22 offen offset:2048 sc1
  buffer_load_dwordx4 a[172:175], v2, s[8:11], s22 offen offset:3072 sc1
  s_add_u32 s22, s21, 45056
  buffer_load_dwordx4 a[176:179], v2, s[8:11], s22 offen offset:0 sc1
  buffer_load_dwordx4 a[180:183], v2, s[8:11], s22 offen offset:1024 sc1
  buffer_load_dwordx4 a[184:187], v2, s[8:11], s22 offen offset:2048 sc1
  buffer_load_dwordx4 a[188:191], v2, s[8:11], s22 offen offset:3072 sc1
  s_add_u32 s22, s21, 49152
  buffer_load_dwordx4 a[192:195], v2, s[8:11], s22 offen offset:0 sc1
  buffer_load_dwordx4 a[196:199], v2, s[8:11], s22 offen offset:1024 sc1
  buffer_load_dwordx4 a[200:203], v2, s[8:11], s22 offen offset:2048 sc1
  buffer_load_dwordx4 a[204:207], v2, s[8:11], s22 offen offset:3072 sc1
  s_add_u32 s22, s21, 53248
  buffer_load_dwordx4 a[208:211], v2, s[8:11], s22 offen offset:0 sc1
  buffer_load_dwordx4 a[212:215], v2, s[8:11], s22 offen offset:1024 sc1
  buffer_load_dwordx4 a[216:219], v2, s[8:11], s22 offen offset:2048 sc1
  buffer_load_dwordx4 a[220:223], v2, s[8:11], s22 offen offset:3072 sc1
wg_f_hx:
  s_mov_b32 s101, -1
  s_waitcnt vmcnt(0)
  s_barrier
  s_mov_b32 s40, 0
  s_mov_b32 s41, 0x40000000
  v_mov_b32 v5, v2
  ds_read_b128 v[8:11], v5 offset:0
  ds_read_b128 v[12:15], v5 offset:14336
  ds_read_b128 v[16:19], v5 offset:1024
  ds_read_b128 v[20:23], v5 offset:15360
  ds_read_b128 v[24:27], v5 offset:2048
  s_waitcnt lgkmcnt(4)
.p2align 6
wg_f_loop:
  v_mfma_f32_16x16x32_bf16 v[40:43], v[8:11], a[0:3], 0
  ds_read_b128 v[28:31], v5 offset:16384
  v_mfma_f32_16x16x32_bf16 v[44:47], v[8:11], a[56:59], 0
  v_mfma_f32_16x16x32_bf16 v[48:51], v[8:11], a[112:115], 0
  v_mfma_f32_16x16x32_bf16 v[52:55], v[8:11], a[168:171], 0
  s_waitcnt lgkmcnt(4)
  s_lshl_b32 s42, s40, 10
  v_mfma_f32_16x16x32_bf16 v[56:59], v[12:15], a[0:3], 0
  ds_read_b128 v[32:35], v5 offset:3072
  v_mfma_f32_16x16x32_bf16 v[60:63], v[12:15], a[56:59], 0
  s_add_u32 s42, s42, s41
  v_cvt_pk_bf16_f32 v72, v96, v97
  v_mfma_f32_16x16x32_bf16 v[64:67], v[12:15], a[112:115], 0
  v_cvt_pk_bf16_f32 v73, v98, v99
  v_cvt_pk_bf16_f32 v74, v112, v113
  v_mfma_f32_16x16x32_bf16 v[68:71], v[12:15], a[168:171], 0
  s_waitcnt lgkmcnt(4)
  v_cvt_pk_bf16_f32 v75, v114, v115
  v_mfma_f32_16x16x32_bf16 v[40:43], v[16:19], a[4:7], v[40:43]
  ds_read_b128 v[8:11], v5 offset:17408
  v_mfma_f32_16x16x32_bf16 v[44:47], v[16:19], a[60:63], v[44:47]
  s_add_u32 s43, s42, 0
  v_mfma_f32_16x16x32_bf16 v[48:51], v[16:19], a[116:119], v[48:51]
  buffer_store_dwordx4 v[72:75], v2, s[8:11], s43 offen sc1
  v_cvt_pk_bf16_f32 v76, v100, v101
  v_mfma_f32_16x16x32_bf16 v[52:55], v[16:19], a[172:175], v[52:55]
  s_waitcnt lgkmcnt(4)
  v_cvt_pk_bf16_f32 v77, v102, v103
  v_mfma_f32_16x16x32_bf16 v[56:59], v[20:23], a[4:7], v[56:59]
  ds_read_b128 v[12:15], v5 offset:4096
  v_mfma_f32_16x16x32_bf16 v[60:63], v[20:23], a[60:63], v[60:63]
  v_cvt_pk_bf16_f32 v78, v116, v117
  v_cvt_pk_bf16_f32 v79, v118, v119
  v_mfma_f32_16x16x32_bf16 v[64:67], v[20:23], a[116:119], v[64:67]
  s_add_u32 s43, s42, 14336
  v_mfma_f32_16x16x32_bf16 v[68:71], v[20:23], a[172:175], v[68:71]
  s_waitcnt lgkmcnt(4)
  buffer_store_dwordx4 v[76:79], v2, s[8:11], s43 offen sc1
  v_mfma_f32_16x16x32_bf16 v[40:43], v[24:27], a[8:11], v[40:43]
  ds_read_b128 v[16:19], v5 offset:18432
  v_mfma_f32_16x16x32_bf16 v[44:47], v[24:27], a[64:67], v[44:47]
  v_cvt_pk_bf16_f32 v80, v104, v105
  v_cvt_pk_bf16_f32 v81, v106, v107
  v_mfma_f32_16x16x32_bf16 v[48:51], v[24:27], a[120:123], v[48:51]
  v_cvt_pk_bf16_f32 v82, v120, v121
  v_cvt_pk_bf16_f32 v83, v122, v123
  v_mfma_f32_16x16x32_bf16 v[52:55], v[24:27], a[176:179], v[52:55]
  s_waitcnt lgkmcnt(4)
  s_add_u32 s43, s42, 458752
  v_mfma_f32_16x16x32_bf16 v[56:59], v[28:31], a[8:11], v[56:59]
  ds_read_b128 v[20:23], v5 offset:5120
  v_mfma_f32_16x16x32_bf16 v[60:63], v[28:31], a[64:67], v[60:63]
  buffer_store_dwordx4 v[80:83], v2, s[8:11], s43 offen sc1
  v_cvt_pk_bf16_f32 v84, v108, v109
  v_mfma_f32_16x16x32_bf16 v[64:67], v[28:31], a[120:123], v[64:67]
  v_cvt_pk_bf16_f32 v85, v110, v111
  v_cvt_pk_bf16_f32 v86, v124, v125
  v_mfma_f32_16x16x32_bf16 v[68:71], v[28:31], a[176:179], v[68:71]
  s_waitcnt lgkmcnt(4)
  v_cvt_pk_bf16_f32 v87, v126, v127
  v_mfma_f32_16x16x32_bf16 v[40:43], v[32:35], a[12:15], v[40:43]
  ds_read_b128 v[24:27], v5 offset:19456
  v_mfma_f32_16x16x32_bf16 v[44:47], v[32:35], a[68:71], v[44:47]
  s_add_u32 s43, s42, 473088
  v_mfma_f32_16x16x32_bf16 v[48:51], v[32:35], a[124:127], v[48:51]
  buffer_store_dwordx4 v[84:87], v2, s[8:11], s43 offen sc1
  v_mfma_f32_16x16x32_bf16 v[52:55], v[32:35], a[180:183], v[52:55]
  s_waitcnt lgkmcnt(4)
  s_add_u32 s30, s19, 2
  s_lshr_b32 s24, s30, 1
  s_lshl_b32 s24, s24, 2
  s_and_b32 s25, s30, 1
  s_add_u32 s24, s24, s25
  s_mul_i32 s24, s24, 14336
  v_mfma_f32_16x16x32_bf16 v[56:59], v[8:11], a[12:15], v[56:59]
  ds_read_b128 v[28:31], v5 offset:6144
  v_mfma_f32_16x16x32_bf16 v[60:63], v[8:11], a[68:71], v[60:63]
  s_add_u32 s24, s24, s23
  s_cmp_lt_u32 s30, s35
  s_cselect_b32 s24, s24, 0x40000000
  v_mfma_f32_16x16x32_bf16 v[64:67], v[8:11], a[124:127], v[64:67]
  s_add_u32 m0, s33, s27
  s_nop 0
  buffer_load_dwordx4 v2, s[8:11], s24 offen offset:0 sc1 lds
  v_mfma_f32_16x16x32_bf16 v[68:71], v[8:11], a[180:183], v[68:71]
  s_waitcnt lgkmcnt(4)
  v_mfma_f32_16x16x32_bf16 v[40:43], v[12:15], a[16:19], v[40:43]
  ds_read_b128 v[32:35], v5 offset:20480
  v_mfma_f32_16x16x32_bf16 v[44:47], v[12:15], a[72:75], v[44:47]
  v_mfma_f32_16x16x32_bf16 v[48:51], v[12:15], a[128:131], v[48:51]
  v_mfma_f32_16x16x32_bf16 v[52:55], v[12:15], a[184:187], v[52:55]
  s_waitcnt lgkmcnt(4)
  buffer_load_dwordx4 v2, s[8:11], s24 offen offset:1024 sc1 lds
  v_mfma_f32_16x16x32_bf16 v[56:59], v[16:19], a[16:19], v[56:59]
  ds_read_b128 v[8:11], v5 offset:7168
  v_mfma_f32_16x16x32_bf16 v[60:63], v[16:19], a[72:75], v[60:63]
  v_mfma_f32_16x16x32_bf16 v[64:67], v[16:19], a[128:131], v[64:67]
  v_mfma_f32_16x16x32_bf16 v[68:71], v[16:19], a[184:187], v[68:71]
  s_waitcnt lgkmcnt(4)
  v_mfma_f32_16x16x32_bf16 v[40:43], v[20:23], a[20:23], v[40:43]
  ds_read_b128 v[12:15], v5 offset:21504
  v_mfma_f32_16x16x32_bf16 v[44:47], v[20:23], a[76:79], v[44:47]
  buffer_load_dwordx4 v2, s[8:11], s24 offen offset:2048 sc1 lds
  v_mfma_f32_16x16x32_bf16 v[48:51], v[20:23], a[132:135], v[48:51]
  v_mfma_f32_16x16x32_bf16 v[52:55], v[20:23], a[188:191], v[52:55]
  s_waitcnt lgkmcnt(4)
  v_mfma_f32_16x16x32_bf16 v[56:59], v[24:27], a[20:23], v[56:59]
  ds_read_b128 v[16:19], v5 offset:8192
  v_mfma_f32_16x16x32_bf16 v[60:63], v[24:27], a[76:79], v[60:63]
  v_mfma_f32_16x16x32_bf16 v[64:67], v[24:27], a[132:135], v[64:67]
  buffer_load_dwordx4 v2, s[8:11], s24 offen offset:3072 sc1 lds
  v_mfma_f32_16x16x32_bf16 v[68:71], v[24:27], a[188:191], v[68:71]
  s_waitcnt lgkmcnt(4)
  v_mfma_f32_16x16x32_bf16 v[40:43], v[28:31], a[24:27], v[40:43]
  ds_read_b128 v[20:23], v5 offset:22528
  v_mfma_f32_16x16x32_bf16 v[44:47], v[28:31], a[80:83], v[44:47]
  v_mfma_f32_16x16x32_bf16 v[48:51], v[28:31], a[136:139], v[48:51]
  v_mfma_f32_16x16x32_bf16 v[52:55], v[28:31], a[192:195], v[52:55]
  s_waitcnt lgkmcnt(4)
  s_add_u32 m0, m0, 4096
  s_add_u32 s24, s24, 4096
  buffer_load_dwordx4 v2, s[8:11], s24 offen offset:0 sc1 lds
  v_mfma_f32_16x16x32_bf16 v[56:59], v[32:35], a[24:27], v[56:59]
  ds_read_b128 v[24:27], v5 offset:9216
  v_mfma_f32_16x16x32_bf16 v[60:63], v[32:35], a[80:83], v[60:63]
  v_mfma_f32_16x16x32_bf16 v[64:67], v[32:35], a[136:139], v[64:67]
  v_mfma_f32_16x16x32_bf16 v[68:71], v[32:35], a[192:195], v[68:71]
  s_waitcnt lgkmcnt(4)
  v_mfma_f32_16x16x32_bf16 v[40:43], v[8:11], a[28:31], v[40:43]
  ds_read_b128 v[28:31], v5 offset:23552
  v_mfma_f32_16x16x32_bf16 v[44:47], v[8:11], a[84:87], v[44:47]
  buffer_load_dwordx4 v2, s[8:11], s24 offen offset:1024 sc1 lds
  v_mfma_f32_16x16x32_bf16 v[48:51], v[8:11], a[140:143], v[48:51]
  v_mfma_f32_16x16x32_bf16 v[52:55], v[8:11], a[196:199], v[52:55]
  s_waitcnt lgkmcnt(4)
  v_mfma_f32_16x16x32_bf16 v[56:59], v[12:15], a[28:31], v[56:59]
  ds_read_b128 v[32:35], v5 offset:10240
  v_mfma_f32_16x16x32_bf16 v[60:63], v[12:15], a[84:87], v[60:63]
  v_mfma_f32_16x16x32_bf16 v[64:67], v[12:15], a[140:143], v[64:67]
  buffer_load_dwordx4 v2, s[8:11], s24 offen offset:2048 sc1 lds
  v_mfma_f32_16x16x32_bf16 v[68:71], v[12:15], a[196:199], v[68:71]
  s_waitcnt lgkmcnt(4)
  v_mfma_f32_16x16x32_bf16 v[40:43], v[16:19], a[32:35], v[40:43]
  ds_read_b128 v[8:11], v5 offset:24576
  v_mfma_f32_16x16x32_bf16 v[44:47], v[16:19], a[88:91], v[44:47]
  v_mfma_f32_16x16x32_bf16 v[48:51], v[16:19], a[144:147], v[48:51]
  v_mfma_f32_16x16x32_bf16 v[52:55], v[16:19], a[200:203], v[52:55]
  s_waitcnt lgkmcnt(4)
  s_add_u32 s33, s33, 28672
  s_cmp_eq_u32 s33, 114688
  s_cselect_b32 s33, 0, s33
  v_mfma_f32_16x16x32_bf16 v[56:59], v[20:23], a[32:35], v[56:59]
  ds_read_b128 v[12:15], v5 offset:11264
  v_mfma_f32_16x16x32_bf16 v[60:63], v[20:23], a[88:91], v[60:63]
  s_add_u32 s32, s32, 28672
  s_cmp_eq_u32 s32, 114688
  s_cselect_b32 s32, 0, s32
  v_mfma_f32_16x16x32_bf16 v[64:67], v[20:23], a[144:147], v[64:67]
  v_add_u32 v128, s32, v2
  v_mfma_f32_16x16x32_bf16 v[68:71], v[20:23], a[200:203], v[68:71]
  s_waitcnt lgkmcnt(4)
  v_mfma_f32_16x16x32_bf16 v[40:43], v[24:27], a[36:39], v[40:43]
  ds_read_b128 v[16:19], v5 offset:25600
  v_mfma_f32_16x16x32_bf16 v[44:47], v[24:27], a[92:95], v[44:47]
  v_mfma_f32_16x16x32_bf16 v[48:51], v[24:27], a[148:151], v[48:51]
  v_mfma_f32_16x16x32_bf16 v[52:55], v[24:27], a[204:207], v[52:55]
  s_waitcnt lgkmcnt(4)
  v_mfma_f32_16x16x32_bf16 v[56:59], v[28:31], a[36:39], v[56:59]
  ds_read_b128 v[20:23], v5 offset:12288
  v_mfma_f32_16x16x32_bf16 v[60:63], v[28:31], a[92:95], v[60:63]
  v_mfma_f32_16x16x32_bf16 v[64:67], v[28:31], a[148:151], v[64:67]
  v_mfma_f32_16x16x32_bf16 v[68:71], v[28:31], a[204:207], v[68:71]
  s_waitcnt lgkmcnt(4)
  v_mfma_f32_16x16x32_bf16 v[40:43], v[32:35], a[40:43], v[40:43]
  ds_read_b128 v[24:27], v5 offset:26624
  v_mfma_f32_16x16x32_bf16 v[44:47], v[32:35], a[96:99], v[44:47]
  v_mfma_f32_16x16x32_bf16 v[48:51], v[32:35], a[152:155], v[48:51]
  v_mfma_f32_16x16x32_bf16 v[52:55], v[32:35], a[208:211], v[52:55]
  s_waitcnt lgkmcnt(4)
  v_mfma_f32_16x16x32_bf16 v[56:59], v[8:11], a[40:43], v[56:59]
  ds_read_b128 v[28:31], v5 offset:13312
  v_mfma_f32_16x16x32_bf16 v[60:63], v[8:11], a[96:99], v[60:63]
  v_mfma_f32_16x16x32_bf16 v[64:67], v[8:11], a[152:155], v[64:67]
  v_mfma_f32_16x16x32_bf16 v[68:71], v[8:11], a[208:211], v[68:71]
  s_waitcnt lgkmcnt(4)
  v_mfma_f32_16x16x32_bf16 v[40:43], v[12:15], a[44:47], v[40:43]
  ds_read_b128 v[32:35], v5 offset:27648
  v_mfma_f32_16x16x32_bf16 v[44:47], v[12:15], a[100:103], v[44:47]
  v_mfma_f32_16x16x32_bf16 v[48:51], v[12:15], a[156:159], v[48:51]
  v_mfma_f32_16x16x32_bf16 v[52:55], v[12:15], a[212:215], v[52:55]
  s_waitcnt lgkmcnt(4)
  v_mfma_f32_16x16x32_bf16 v[56:59], v[16:19], a[44:47], v[56:59]
  s_waitcnt vmcnt(11)
  s_barrier
  ds_read_b128 v[8:11], v128 offset:0
  v_mfma_f32_16x16x32_bf16 v[60:63], v[16:19], a[100:103], v[60:63]
  v_mfma_f32_16x16x32_bf16 v[64:67], v[16:19], a[156:159], v[64:67]
  v_mfma_f32_16x16x32_bf16 v[68:71], v[16:19], a[212:215], v[68:71]
  s_waitcnt lgkmcnt(4)
  v_mfma_f32_16x16x32_bf16 v[40:43], v[20:23], a[48:51], v[40:43]
  ds_read_b128 v[12:15], v128 offset:14336
  v_mfma_f32_16x16x32_bf16 v[44:47], v[20:23], a[104:107], v[44:47]
  v_mfma_f32_16x16x32_bf16 v[48:51], v[20:23], a[160:163], v[48:51]
  v_mfma_f32_16x16x32_bf16 v[52:55], v[20:23], a[216:219], v[52:55]
  s_waitcnt lgkmcnt(4)
  v_mfma_f32_16x16x32_bf16 v[56:59], v[24:27], a[48:51], v[56:59]
  ds_read_b128 v[16:19], v128 offset:1024
  v_mfma_f32_16x16x32_bf16 v[60:63], v[24:27], a[104:107], v[60:63]
  v_mfma_f32_16x16x32_bf16 v[64:67], v[24:27], a[160:163], v[64:67]
  v_mfma_f32_16x16x32_bf16 v[68:71], v[24:27], a[216:219], v[68:71]
  s_waitcnt lgkmcnt(4)
  v_mfma_f32_16x16x32_bf16 v[40:43], v[28:31], a[52:55], v[40:43]
  ds_read_b128 v[20:23], v128 offset:15360
  v_mfma_f32_16x16x32_bf16 v[44:47], v[28:31], a[108:111], v[44:47]
  v_mfma_f32_16x16x32_bf16 v[48:51], v[28:31], a[164:167], v[48:51]
  v_mfma_f32_16x16x32_bf16 v[52:55], v[28:31], a[220:223], v[52:55]
  s_waitcnt lgkmcnt(4)
  v_mfma_f32_16x16x32_bf16 v[56:59], v[32:35], a[52:55], v[56:59]
  ds_read_b128 v[24:27], v128 offset:2048
  v_mfma_f32_16x16x32_bf16 v[60:63], v[32:35], a[108:111], v[60:63]
  v_mfma_f32_16x16x32_bf16 v[64:67], v[32:35], a[164:167], v[64:67]
  v_mfma_f32_16x16x32_bf16 v[68:71], v[32:35], a[220:223], v[68:71]
  s_waitcnt lgkmcnt(4)
  s_mov_b32 s40, s19
  s_mov_b32 s41, s29
  s_add_u32 s19, s19, 1
  s_cmp_lt_u32 s19, s35
  s_cbranch_scc0 wg_f_e0
  v_mfma_f32_16x16x32_bf16 v[96:99], v[8:11], a[0:3], 0
  ds_read_b128 v[28:31], v128 offset:16384
  v_mfma_f32_16x16x32_bf16 v[100:103], v[8:11], a[56:59], 0
  v_mfma_f32_16x16x32_bf16 v[104:107], v[8:11], a[112:115], 0
  v_mfma_f32_16x16x32_bf16 v[108:111], v[8:11], a[168:171], 0
  s_waitcnt lgkmcnt(4)
  s_lshl_b32 s42, s40, 10
  v_mfma_f32_16x16x32_bf16 v[112:115], v[12:15], a[0:3], 0
  ds_read_b128 v[32:35], v128 offset:3072
  v_mfma_f32_16x16x32_bf16 v[116:119], v[12:15], a[56:59], 0
  s_add_u32 s42, s42, s41
  v_cvt_pk_bf16_f32 v72, v40, v41
  v_mfma_f32_16x16x32_bf16 v[120:123], v[12:15], a[112:115], 0
  v_cvt_pk_bf16_f32 v73, v42, v43
  v_cvt_pk_bf16_f32 v74, v56, v57
  v_mfma_f32_16x16x32_bf16 v[124:127], v[12:15], a[168:171], 0
  s_waitcnt lgkmcnt(4)
  v_cvt_pk_bf16_f32 v75, v58, v59
  v_mfma_f32_16x16x32_bf16 v[96:99], v[16:19], a[4:7], v[96:99]
  ds_read_b128 v[8:11], v128 offset:17408
  v_mfma_f32_16x16x32_bf16 v[100:103], v[16:19], a[60:63], v[100:103]
  s_add_u32 s43, s42, 0
  v_mfma_f32_16x16x32_bf16 v[104:107], v[16:19], a[116:119], v[104:107]
  buffer_store_dwordx4 v[72:75], v2, s[8:11], s43 offen sc1
  v_cvt_pk_bf16_f32 v76, v44, v45
  v_mfma_f32_16x16x32_bf16 v[108:111], v[16:19], a[172:175], v[108:111]
  s_waitcnt lgkmcnt(4)
  v_cvt_pk_bf16_f32 v77, v46, v47
  v_mfma_f32_16x16x32_bf16 v[112:115], v[20:23], a[4:7], v[112:115]
  ds_read_b128 v[12:15], v128 offset:4096
  v_mfma_f32_16x16x32_bf16 v[116:119], v[20:23], a[60:63], v[116:119]
  v_cvt_pk_bf16_f32 v78, v60, v61
  v_cvt_pk_bf16_f32 v79, v62, v63
  v_mfma_f32_16x16x32_bf16 v[120:123], v[20:23], a[116:119], v[120:123]
  s_add_u32 s43, s42, 14336
  v_mfma_f32_16x16x32_bf16 v[124:127], v[20:23], a[172:175], v[124:127]
  s_waitcnt lgkmcnt(4)
  buffer_store_dwordx4 v[76:79], v2, s[8:11], s43 offen sc1
  v_mfma_f32_16x16x32_bf16 v[96:99], v[24:27], a[8:11], v[96:99]
  ds_read_b128 v[16:19], v128 offset:18432
  v_mfma_f32_16x16x32_bf16 v[100:103], v[24:27], a[64:67], v[100:103]
  v_cvt_pk_bf16_f32 v80, v48, v49
  v_cvt_pk_bf16_f32 v81, v50, v51
  v_mfma_f32_16x16x32_bf16 v[104:107], v[24:27], a[120:123], v[104:107]
  v_cvt_pk_bf16_f32 v82, v64, v65
  v_cvt_pk_bf16_f32 v83, v66, v67
  v_mfma_f32_16x16x32_bf16 v[108:111], v[24:27], a[176:179], v[108:111]
  s_waitcnt lgkmcnt(4)
  s_add_u32 s43, s42, 458752
  v_mfma_f32_16x16x32_bf16 v[112:115], v[28:31], a[8:11], v[112:115]
  ds_read_b128 v[20:23], v128 offset:5120
  v_mfma_f32_16x16x32_bf16 v[116:119], v[28:31], a[64:67], v[116:119]
  buffer_store_dwordx4 v[80:83], v2, s[8:11], s43 offen sc1
  v_cvt_pk_bf16_f32 v84, v52, v53
  v_mfma_f32_16x16x32_bf16 v[120:123], v[28:31], a[120:123], v[120:123]
  v_cvt_pk_bf16_f32 v85, v54, v55
  v_cvt_pk_bf16_f32 v86, v68, v69
  v_mfma_f32_16x16x32_bf16 v[124:127], v[28:31], a[176:179], v[124:127]
  s_waitcnt lgkmcnt(4)
  v_cvt_pk_bf16_f32 v87, v70, v71
  v_mfma_f32_16x16x32_bf16 v[96:99], v[32:35], a[12:15], v[96:99]
  ds_read_b128 v[24:27], v128 offset:19456
  v_mfma_f32_16x16x32_bf16 v[100:103], v[32:35], a[68:71], v[100:103]
  s_add_u32 s43, s42, 473088
  v_mfma_f32_16x16x32_bf16 v[104:107], v[32:35], a[124:127], v[104:107]
  buffer_store_dwordx4 v[84:87], v2, s[8:11], s43 offen sc1
  v_mfma_f32_16x16x32_bf16 v[108:111], v[32:35], a[180:183], v[108:111]
  s_waitcnt lgkmcnt(4)
  s_add_u32 s30, s19, 2
  s_lshr_b32 s24, s30, 1
  s_lshl_b32 s24, s24, 2
  s_and_b32 s25, s30, 1
  s_add_u32 s24, s24, s25
  s_mul_i32 s24, s24, 14336
  v_mfma_f32_16x16x32_bf16 v[112:115], v[8:11], a[12:15], v[112:115]
  ds_read_b128 v[28:31], v128 offset:6144
  v_mfma_f32_16x16x32_bf16 v[116:119], v[8:11], a[68:71], v[116:119]
  s_add_u32 s24, s24, s23
  s_cmp_lt_u32 s30, s35
  s_cselect_b32 s24, s24, 0x40000000
  v_mfma_f32_16x16x32_bf16 v[120:123], v[8:11], a[124:127], v[120:123]
  s_add_u32 m0, s33, s27
  s_nop 0
  buffer_load_dwordx4 v2, s[8:11], s24 offen offset:0 sc1 lds
  v_mfma_f32_16x16x32_bf16 v[124:127], v[8:11], a[180:183], v[124:127]
  s_waitcnt lgkmcnt(4)
  v_mfma_f32_16x16x32_bf16 v[96:99], v[12:15], a[16:19], v[96:99]
  ds_read_b128 v[32:35], v128 offset:20480
  v_mfma_f32_16x16x32_bf16 v[100:103], v[12:15], a[72:75], v[100:103]
  v_mfma_f32_16x16x32_bf16 v[104:107], v[12:15], a[128:131], v[104:107]
  v_mfma_f32_16x16x32_bf16 v[108:111], v[12:15], a[184:187], v[108:111]
  s_waitcnt lgkmcnt(4)
  buffer_load_dwordx4 v2, s[8:11], s24 offen offset:1024 sc1 lds
  v_mfma_f32_16x16x32_bf16 v[112:115], v[16:19], a[16:19], v[112:115]
  ds_read_b128 v[8:11], v128 offset:7168
  v_mfma_f32_16x16x32_bf16 v[116:119], v[16:19], a[72:75], v[116:119]
  v_mfma_f32_16x16x32_bf16 v[120:123], v[16:19], a[128:131], v[120:123]
  v_mfma_f32_16x16x32_bf16 v[124:127], v[16:19], a[184:187], v[124:127]
  s_waitcnt lgkmcnt(4)
  v_mfma_f32_16x16x32_bf16 v[96:99], v[20:23], a[20:23], v[96:99]
  ds_read_b128 v[12:15], v128 offset:21504
  v_mfma_f32_16x16x32_bf16 v[100:103], v[20:23], a[76:79], v[100:103]
  buffer_load_dwordx4 v2, s[8:11], s24 offen offset:2048 sc1 lds
  v_mfma_f32_16x16x32_bf16 v[104:107], v[20:23], a[132:135], v[104:107]
  v_mfma_f32_16x16x32_bf16 v[108:111], v[20:23], a[188:191], v[108:111]
  s_waitcnt lgkmcnt(4)
  v_mfma_f32_16x16x32_bf16 v[112:115], v[24:27], a[20:23], v[112:115]
  ds_read_b128 v[16:19], v128 offset:8192
  v_mfma_f32_16x16x32_bf16 v[116:119], v[24:27], a[76:79], v[116:119]
  v_mfma_f32_16x16x32_bf16 v[120:123], v[24:27], a[132:135], v[120:123]
  buffer_load_dwordx4 v2, s[8:11], s24 offen offset:3072 sc1 lds
  v_mfma_f32_16x16x32_bf16 v[124:127], v[24:27], a[188:191], v[124:127]
  s_waitcnt lgkmcnt(4)
  v_mfma_f32_16x16x32_bf16 v[96:99], v[28:31], a[24:27], v[96:99]
  ds_read_b128 v[20:23], v128 offset:22528
  v_mfma_f32_16x16x32_bf16 v[100:103], v[28:31], a[80:83], v[100:103]
  v_mfma_f32_16x16x32_bf16 v[104:107], v[28:31], a[136:139], v[104:107]
  v_mfma_f32_16x16x32_bf16 v[108:111], v[28:31], a[192:195], v[108:111]
  s_waitcnt lgkmcnt(4)
  s_add_u32 m0, m0, 4096
  s_add_u32 s24, s24, 4096
  buffer_load_dwordx4 v2, s[8:11], s24 offen offset:0 sc1 lds
  v_mfma_f32_16x16x32_bf16 v[112:115], v[32:35], a[24:27], v[112:115]
  ds_read_b128 v[24:27], v128 offset:9216
  v_mfma_f32_16x16x32_bf16 v[116:119], v[32:35], a[80:83], v[116:119]
  v_mfma_f32_16x16x32_bf16 v[120:123], v[32:35], a[136:139], v[120:123]
  v_mfma_f32_16x16x32_bf16 v[124:127], v[32:35], a[192:195], v[124:127]
  s_waitcnt lgkmcnt(4)
  v_mfma_f32_16x16x32_bf16 v[96:99], v[8:11], a[28:31], v[96:99]
  ds_read_b128 v[28:31], v128 offset:23552
  v_mfma_f32_16x16x32_bf16 v[100:103], v[8:11], a[84:87], v[100:103]
  buffer_load_dwordx4 v2, s[8:11], s24 offen offset:1024 sc1 lds
  v_mfma_f32_16x16x32_bf16 v[104:107], v[8:11], a[140:143], v[104:107]
  v_mfma_f32_16x16x32_bf16 v[108:111], v[8:11], a[196:199], v[108:111]
  s_waitcnt lgkmcnt(4)
  v_mfma_f32_16x16x32_bf16 v[112:115], v[12:15], a[28:31], v[112:115]
  ds_read_b128 v[32:35], v128 offset:10240
  v_mfma_f32_16x16x32_bf16 v[116:119], v[12:15], a[84:87], v[116:119]
  v_mfma_f32_16x16x32_bf16 v[120:123], v[12:15], a[140:143], v[120:123]
  buffer_load_dwordx4 v2, s[8:11], s24 offen offset:2048 sc1 lds
  v_mfma_f32_16x16x32_bf16 v[124:127], v[12:15], a[196:199], v[124:127]
  s_waitcnt lgkmcnt(4)
  v_mfma_f32_16x16x32_bf16 v[96:99], v[16:19], a[32:35], v[96:99]
  ds_read_b128 v[8:11], v128 offset:24576
  v_mfma_f32_16x16x32_bf16 v[100:103], v[16:19], a[88:91], v[100:103]
  v_mfma_f32_16x16x32_bf16 v[104:107], v[16:19], a[144:147], v[104:107]
  v_mfma_f32_16x16x32_bf16 v[108:111], v[16:19], a[200:203], v[108:111]
  s_waitcnt lgkmcnt(4)
  s_add_u32 s33, s33, 28672
  s_cmp_eq_u32 s33, 114688
  s_cselect_b32 s33, 0, s33
  v_mfma_f32_16x16x32_bf16 v[112:115], v[20:23], a[32:35], v[112:115]
  ds_read_b128 v[12:15], v128 offset:11264
  v_mfma_f32_16x16x32_bf16 v[116:119], v[20:23], a[88:91], v[116:119]
  s_add_u32 s32, s32, 28672
  s_cmp_eq_u32 s32, 114688
  s_cselect_b32 s32, 0, s32
  v_mfma_f32_16x16x32_bf16 v[120:123], v[20:23], a[144:147], v[120:123]
  v_add_u32 v5, s32, v2
  v_mfma_f32_16x16x32_bf16 v[124:127], v[20:23], a[200:203], v[124:127]
  s_waitcnt lgkmcnt(4)
  v_mfma_f32_16x16x32_bf16 v[96:99], v[24:27], a[36:39], v[96:99]
  ds_read_b128 v[16:19], v128 offset:25600
  v_mfma_f32_16x16x32_bf16 v[100:103], v[24:27], a[92:95], v[100:103]
  v_mfma_f32_16x16x32_bf16 v[104:107], v[24:27], a[148:151], v[104:107]
  v_mfma_f32_16x16x32_bf16 v[108:111], v[24:27], a[204:207], v[108:111]
  s_waitcnt lgkmcnt(4)
  v_mfma_f32_16x16x32_bf16 v[112:115], v[28:31], a[36:39], v[112:115]
  ds_read_b128 v[20:23], v128 offset:12288
  v_mfma_f32_16x16x32_bf16 v[116:119], v[28:31], a[92:95], v[116:119]
  v_mfma_f32_16x16x32_bf16 v[120:123], v[28:31], a[148:151], v[120:123]
  v_mfma_f32_16x16x32_bf16 v[124:127], v[28:31], a[204:207], v[124:127]
  s_waitcnt lgkmcnt(4)
  v_mfma_f32_16x16x32_bf16 v[96:99], v[32:35], a[40:43], v[96:99]
  ds_read_b128 v[24:27], v128 offset:26624
  v_mfma_f32_16x16x32_bf16 v[100:103], v[32:35], a[96:99], v[100:103]
  v_mfma_f32_16x16x32_bf16 v[104:107], v[32:35], a[152:155], v[104:107]
  v_mfma_f32_16x16x32_bf16 v[108:111], v[32:35], a[208:211], v[108:111]
  s_waitcnt lgkmcnt(4)
  v_mfma_f32_16x16x32_bf16 v[112:115], v[8:11], a[40:43], v[112:115]
  ds_read_b128 v[28:31], v128 offset:13312
  v_mfma_f32_16x16x32_bf16 v[116:119], v[8:11], a[96:99], v[116:119]
  v_mfma_f32_16x16x32_bf16 v[120:123], v[8:11], a[152:155], v[120:123]
  v_mfma_f32_16x16x32_bf16 v[124:127], v[8:11], a[208:211], v[124:127]
  s_waitcnt lgkmcnt(4)
  v_mfma_f32_16x16x32_bf16 v[96:99], v[12:15], a[44:47], v[96:99]
  ds_read_b128 v[32:35], v128 offset:27648
  v_mfma_f32_16x16x32_bf16 v[100:103], v[12:15], a[100:103], v[100:103]
  v_mfma_f32_16x16x32_bf16 v[104:107], v[12:15], a[156:159], v[104:107]
  v_mfma_f32_16x16x32_bf16 v[108:111], v[12:15], a[212:215], v[108:111]
  s_waitcnt lgkmcnt(4)
  v_mfma_f32_16x16x32_bf16 v[112:115], v[16:19], a[44:47], v[112:115]
  s_waitcnt vmcnt(11)
  s_barrier
  ds_read_b128 v[8:11], v5 offset:0
  v_mfma_f32_16x16x32_bf16 v[116:119], v[16:19], a[100:103], v[116:119]
  v_mfma_f32_16x16x32_bf16 v[120:123], v[16:19], a[156:159], v[120:123]
  v_mfma_f32_16x16x32_bf16 v[124:127], v[16:19], a[212:215], v[124:127]
  s_waitcnt lgkmcnt(4)
  v_mfma_f32_16x16x32_bf16 v[96:99], v[20:23], a[48:51], v[96:99]
  ds_read_b128 v[12:15], v5 offset:14336
  v_mfma_f32_16x16x32_bf16 v[100:103], v[20:23], a[104:107], v[100:103]
  v_mfma_f32_16x16x32_bf16 v[104:107], v[20:23], a[160:163], v[104:107]
  v_mfma_f32_16x16x32_bf16 v[108:111], v[20:23], a[216:219], v[108:111]
  s_waitcnt lgkmcnt(4)
  v_mfma_f32_16x16x32_bf16 v[112:115], v[24:27], a[48:51], v[112:115]
  ds_read_b128 v[16:19], v5 offset:1024
  v_mfma_f32_16x16x32_bf16 v[116:119], v[24:27], a[104:107], v[116:119]
  v_mfma_f32_16x16x32_bf16 v[120:123], v[24:27], a[160:163], v[120:123]
  v_mfma_f32_16x16x32_bf16 v[124:127], v[24:27], a[216:219], v[124:127]
  s_waitcnt lgkmcnt(4)
  v_mfma_f32_16x16x32_bf16 v[96:99], v[28:31], a[52:55], v[96:99]
  ds_read_b128 v[20:23], v5 offset:15360
  v_mfma_f32_16x16x32_bf16 v[100:103], v[28:31], a[108:111], v[100:103]
  v_mfma_f32_16x16x32_bf16 v[104:107], v[28:31], a[164:167], v[104:107]
  v_mfma_f32_16x16x32_bf16 v[108:111], v[28:31], a[220:223], v[108:111]
  s_waitcnt lgkmcnt(4)
  v_mfma_f32_16x16x32_bf16 v[112:115], v[32:35], a[52:55], v[112:115]
  ds_read_b128 v[24:27], v5 offset:2048
  v_mfma_f32_16x16x32_bf16 v[116:119], v[32:35], a[108:111], v[116:119]
  v_mfma_f32_16x16x32_bf16 v[120:123], v[32:35], a[164:167], v[120:123]
  v_mfma_f32_16x16x32_bf16 v[124:127], v[32:35], a[220:223], v[124:127]
  s_waitcnt lgkmcnt(4)
  s_mov_b32 s40, s19
  s_mov_b32 s41, s29
  s_add_u32 s19, s19, 1
  s_cmp_lt_u32 s19, s35
  s_cbranch_scc1 wg_f_loop
  s_nop 3
  s_lshl_b32 s42, s40, 10
  s_add_u32 s42, s42, s41
  v_cvt_pk_bf16_f32 v72, v96, v97
  v_cvt_pk_bf16_f32 v73, v98, v99
  v_cvt_pk_bf16_f32 v74, v112, v113
  v_cvt_pk_bf16_f32 v75, v114, v115
  s_add_u32 s43, s42, 0
  buffer_store_dwordx4 v[72:75], v2, s[8:11], s43 offen sc1
  v_cvt_pk_bf16_f32 v76, v100, v101
  v_cvt_pk_bf16_f32 v77, v102, v103
  v_cvt_pk_bf16_f32 v78, v116, v117
  v_cvt_pk_bf16_f32 v79, v118, v119
  s_add_u32 s43, s42, 14336
  buffer_store_dwordx4 v[76:79], v2, s[8:11], s43 offen sc1
  v_cvt_pk_bf16_f32 v80, v104, v105
  v_cvt_pk_bf16_f32 v81, v106, v107
  v_cvt_pk_bf16_f32 v82, v120, v121
  v_cvt_pk_bf16_f32 v83, v122, v123
  s_add_u32 s43, s42, 458752
  buffer_store_dwordx4 v[80:83], v2, s[8:11], s43 offen sc1
  v_cvt_pk_bf16_f32 v84, v108, v109
  v_cvt_pk_bf16_f32 v85, v110, v111
  v_cvt_pk_bf16_f32 v86, v124, v125
  v_cvt_pk_bf16_f32 v87, v126, v127
  s_add_u32 s43, s42, 473088
  buffer_store_dwordx4 v[84:87], v2, s[8:11], s43 offen sc1
  s_branch wg_done
wg_f_e0:
  s_nop 7
  s_lshl_b32 s42, s40, 10
  s_add_u32 s42, s42, s41
  v_cvt_pk_bf16_f32 v72, v40, v41
  v_cvt_pk_bf16_f32 v73, v42, v43
  v_cvt_pk_bf16_f32 v74, v56, v57
  v_cvt_pk_bf16_f32 v75, v58, v59
  s_add_u32 s43, s42, 0
  buffer_store_dwordx4 v[72:75], v2, s[8:11], s43 offen sc1
  v_cvt_pk_bf16_f32 v76, v44, v45
  v_cvt_pk_bf16_f32 v77, v46, v47
  v_cvt_pk_bf16_f32 v78, v60, v61
  v_cvt_pk_bf16_f32 v79, v62, v63
  s_add_u32 s43, s42, 14336
  buffer_store_dwordx4 v[76:79], v2, s[8:11], s43 offen sc1
  v_cvt_pk_bf16_f32 v80, v48, v49
  v_cvt_pk_bf16_f32 v81, v50, v51
  v_cvt_pk_bf16_f32 v82, v64, v65
  v_cvt_pk_bf16_f32 v83, v66, v67
  s_add_u32 s43, s42, 458752
  buffer_store_dwordx4 v[80:83], v2, s[8:11], s43 offen sc1
  v_cvt_pk_bf16_f32 v84, v52, v53
  v_cvt_pk_bf16_f32 v85, v54, v55
  v_cvt_pk_bf16_f32 v86, v68, v69
  v_cvt_pk_bf16_f32 v87, v70, v71
  s_add_u32 s43, s42, 473088
  buffer_store_dwordx4 v[84:87], v2, s[8:11], s43 offen sc1
  s_branch wg_done
wg_vo:
  s_sub_u32 s29, s17, 16
  s_mul_i32 s29, s29, 28672
  s_mul_i32 s24, s28, 458752
  s_add_u32 s29, s29, s24
  s_add_u32 s29, s29, 2490368
  v_lshlrev_b32 v6, 4, v3
  v_mul_u32_u24 v7, 12, v3
  v_add_u32 v7, 48, v7
  s_mov_b32 s31, 0
  s_lshl_b32 s24, s34, 1
  s_mul_i32 s24, s24, 14336
  s_add_u32 s24, s24, s23
  s_add_u32 m0, s31, s27
  s_nop 0
  buffer_load_dwordx4 v2, s[8:11], s24 offen offset:0 sc1 lds
  buffer_load_dwordx4 v2, s[8:11], s24 offen offset:1024 sc1 lds
  buffer_load_dwordx4 v2, s[8:11], s24 offen offset:2048 sc1 lds
  buffer_load_dwordx4 v2, s[8:11], s24 offen offset:3072 sc1 lds
  s_add_u32 m0, m0, 4096
  s_add_u32 s24, s24, 4096
  buffer_load_dwordx4 v2, s[8:11], s24 offen offset:0 sc1 lds
  buffer_load_dwordx4 v2, s[8:11], s24 offen offset:1024 sc1 lds
  buffer_load_dwordx4 v2, s[8:11], s24 offen offset:2048 sc1 lds
  s_sub_u32 s36, s35, 1
  s_add_u32 s30, s34, 1
  s_min_u32 s30, s30, s36
  s_mov_b32 s31, 28672
  s_lshl_b32 s24, s30, 1
  s_mul_i32 s24, s24, 14336
  s_add_u32 s24, s24, s23
  s_add_u32 m0, s31, s27
  s_nop 0
  buffer_load_dwordx4 v2, s[8:11], s24 offen offset:0 sc1 lds
  buffer_load_dwordx4 v2, s[8:11], s24 offen offset:1024 sc1 lds
  buffer_load_dwordx4 v2, s[8:11], s24 offen offset:2048 sc1 lds
  buffer_load_dwordx4 v2, s[8:11], s24 offen offset:3072 sc1 lds
  s_add_u32 m0, m0, 4096
  s_add_u32 s24, s24, 4096
  buffer_load_dwordx4 v2, s[8:11], s24 offen offset:0 sc1 lds
  buffer_load_dwordx4 v2, s[8:11], s24 offen offset:1024 sc1 lds
  buffer_load_dwordx4 v2, s[8:11], s24 offen offset:2048 sc1 lds
  s_mov_b32 s19, s34
  s_mov_b32 s32, 0
  s_mov_b32 s33, 57344
  s_cmp_eq_u32 s18, s101
  s_cbranch_scc1 wg_vo_hx
  s_add_u32 s22, s21, 0
  buffer_load_dwordx4 a[0:3], v2, s[8:11], s22 offen offset:0 sc1
  buffer_load_dwordx4 a[4:7], v2, s[8:11], s22 offen offset:1024 sc1
  buffer_load_dwordx4 a[8:11], v2, s[8:11], s22 offen offset:2048 sc1
  buffer_load_dwordx4 a[12:15], v2, s[8:11], s22 offen offset:3072 sc1
  s_add_u32 s22, s21, 4096
  buffer_load_dwordx4 a[16:19], v2, s[8:11], s22 offen offset:0 sc1
  buffer_load_dwordx4 a[20:23], v2, s[8:11], s22 offen offset:1024 sc1
  buffer_load_dwordx4 a[24:27], v2, s[8:11], s22 offen offset:2048 sc1
  buffer_load_dwordx4 a[28:31], v2, s[8:11], s22 offen offset:3072 sc1
  s_add_u32 s22, s21, 8192
  buffer_load_dwordx4 a[32:35], v2, s[8:11], s22 offen offset:0 sc1
  buffer_load_dwordx4 a[36:39], v2, s[8:11], s22 offen offset:1024 sc1
  buffer_load_dwordx4 a[40:43], v2, s[8:11], s22 offen offset:2048 sc1
  buffer_load_dwordx4 a[44:47], v2, s[8:11], s22 offen offset:3072 sc1
  s_add_u32 s22, s21, 12288
  buffer_load_dwordx4 a[48:51], v2, s[8:11], s22 offen offset:0 sc1
  buffer_load_dwordx4 a[52:55], v2, s[8:11], s22 offen offset:1024 sc1
  buffer_load_dwordx4 a[56:59], v2, s[8:11], s22 offen offset:2048 sc1
  buffer_load_dwordx4 a[60:63], v2, s[8:11], s22 offen offset:3072 sc1
  s_add_u32 s22, s21, 16384
  buffer_load_dwordx4 a[64:67], v2, s[8:11], s22 offen offset:0 sc1
  buffer_load_dwordx4 a[68:71], v2, s[8:11], s22 offen offset:1024 sc1
  buffer_load_dwordx4 a[72:75], v2, s[8:11], s22 offen offset:2048 sc1
  buffer_load_dwordx4 a[76:79], v2, s[8:11], s22 offen offset:3072 sc1
  s_add_u32 s22, s21, 20480
  buffer_load_dwordx4 a[80:83], v2, s[8:11], s22 offen offset:0 sc1
  buffer_load_dwordx4 a[84:87], v2, s[8:11], s22 offen offset:1024 sc1
  buffer_load_dwordx4 a[88:91], v2, s[8:11], s22 offen offset:2048 sc1
  buffer_load_dwordx4 a[92:95], v2, s[8:11], s22 offen offset:3072 sc1
  s_add_u32 s22, s21, 24576
  buffer_load_dwordx4 a[96:99], v2, s[8:11], s22 offen offset:0 sc1
  buffer_load_dwordx4 a[100:103], v2, s[8:11], s22 offen offset:1024 sc1
  buffer_load_dwordx4 a[104:107], v2, s[8:11], s22 offen offset:2048 sc1
  buffer_load_dwordx4 a[108:111], v2, s[8:11], s22 offen offset:3072 sc1
  s_add_u32 s22, s21, 28672
  buffer_load_dwordx4 a[112:115], v2, s[8:11], s22 offen offset:0 sc1
  buffer_load_dwordx4 a[116:119], v2, s[8:11], s22 offen offset:1024 sc1
  buffer_load_dwordx4 a[120:123], v2, s[8:11], s22 offen offset:2048 sc1
  buffer_load_dwordx4 a[124:127], v2, s[8:11], s22 offen offset:3072 sc1
  s_add_u32 s22, s21, 32768
  buffer_load_dwordx4 a[128:131], v2, s[8:11], s22 offen offset:0 sc1
  buffer_load_dwordx4 a[132:135], v2, s[8:11], s22 offen offset:1024 sc1
  buffer_load_dwordx4 a[136:139], v2, s[8:11], s22 offen offset:2048 sc1
  buffer_load_dwordx4 a[140:143], v2, s[8:11], s22 offen offset:3072 sc1
  s_add_u32 s22, s21, 36864
  buffer_load_dwordx4 a[144:147], v2, s[8:11], s22 offen offset:0 sc1
  buffer_load_dwordx4 a[148:151], v2, s[8:11], s22 offen offset:1024 sc1
  buffer_load_dwordx4 a[152:155], v2, s[8:11], s22 offen offset:2048 sc1
  buffer_load_dwordx4 a[156:159], v2, s[8:11], s22 offen offset:3072 sc1
  s_add_u32 s22, s21, 40960
  s_waitcnt vmcnt(40)
  buffer_load_dwordx4 a[160:163], v2, s[8:11], s22 offen offset:0 sc1
  buffer_load_dwordx4 a[164:167], v2, s[8:11], s22 offen offset:1024 sc1
  buffer_load_dwordx4 a[168:171], v2, s[8:11], s22 offen offset:2048 sc1
  buffer_load_dwordx4 a[172:175], v2, s[8:11], s22 offen offset:3072 sc1
  s_add_u32 s22, s21, 45056
  buffer_load_dwordx4 a[176:179], v2, s[8:11], s22 offen offset:0 sc1
  buffer_load_dwordx4 a[180:183], v2, s[8:11], s22 offen offset:1024 sc1
  buffer_load_dwordx4 a[184:187], v2, s[8:11], s22 offen offset:2048 sc1
  buffer_load_dwordx4 a[188:191], v2, s[8:11], s22 offen offset:3072 sc1
  s_add_u32 s22, s21, 49152
  buffer_load_dwordx4 a[192:195], v2, s[8:11], s22 offen offset:0 sc1
  buffer_load_dwordx4 a[196:199], v2, s[8:11], s22 offen offset:1024 sc1
  buffer_load_dwordx4 a[200:203], v2, s[8:11], s22 offen offset:2048 sc1
  buffer_load_dwordx4 a[204:207], v2, s[8:11], s22 offen offset:3072 sc1
  s_add_u32 s22, s21, 53248
  buffer_load_dwordx4 a[208:211], v2, s[8:11], s22 offen offset:0 sc1
  buffer_load_dwordx4 a[212:215], v2, s[8:11], s22 offen offset:1024 sc1
  buffer_load_dwordx4 a[216:219], v2, s[8:11], s22 offen offset:2048 sc1
  buffer_load_dwordx4 a[220:223], v2, s[8:11], s22 offen offset:3072 sc1
wg_vo_hx:
  s_mov_b32 s101, -1
  s_waitcnt vmcnt(0)
  s_barrier
  s_mov_b32 s40, 0
  s_mov_b32 s41, 0x40000000
  v_mov_b32 v5, v2
  ds_read_b128 v[8:11], v5 offset:0
  ds_read_b128 v[12:15], v5 offset:14336
  ds_read_b128 v[16:19], v5 offset:1024
  ds_read_b128 v[20:23], v5 offset:15360
  ds_read_b128 v[24:27], v5 offset:2048
  s_waitcnt lgkmcnt(4)
.p2align 6
wg_vo_loop:
  v_mfma_f32_16x16x32_bf16 v[40:43], a[0:3], v[8:11], 0
  ds_read_b128 v[28:31], v5 offset:16384
  v_mfma_f32_16x16x32_bf16 v[44:47], a[56:59], v[8:11], 0
  v_mfma_f32_16x16x32_bf16 v[48:51], a[112:115], v[8:11], 0
  v_mfma_f32_16x16x32_bf16 v[52:55], a[168:171], v[8:11], 0
  s_waitcnt lgkmcnt(4)
  s_add_u32 s43, s41, 458752
  v_mfma_f32_16x16x32_bf16 v[56:59], a[0:3], v[12:15], 0
  ds_read_b128 v[32:35], v5 offset:3072
  v_mfma_f32_16x16x32_bf16 v[60:63], a[56:59], v[12:15], 0
  s_lshl_b32 s42, s40, 5
  s_add_u32 s42, s42, 0
  v_mfma_f32_16x16x32_bf16 v[64:67], a[112:115], v[12:15], 0
  v_add_u32 v88, s42, v4
  v_mul_u32_u24 v89, 2341, v88
  v_mfma_f32_16x16x32_bf16 v[68:71], a[168:171], v[12:15], 0
  s_waitcnt lgkmcnt(4)
  v_lshrrev_b32 v89, 16, v89
  v_mfma_f32_16x16x32_bf16 v[40:43], a[4:7], v[16:19], v[40:43]
  ds_read_b128 v[8:11], v5 offset:17408
  v_mfma_f32_16x16x32_bf16 v[44:47], a[60:63], v[16:19], v[44:47]
  v_mul_u32_u24 v92, 28, v89
  v_sub_u32 v92, v88, v92
  v_mfma_f32_16x16x32_bf16 v[48:51], a[116:119], v[16:19], v[48:51]
  v_cmp_gt_u32 vcc, 16, v92
  v_mul_u32_u24 v89, 84, v89
  v_mfma_f32_16x16x32_bf16 v[52:55], a[172:175], v[16:19], v[52:55]
  s_waitcnt lgkmcnt(4)
  v_cndmask_b32 v92, v7, v6, vcc
  v_mfma_f32_16x16x32_bf16 v[56:59], a[4:7], v[20:23], v[56:59]
  ds_read_b128 v[12:15], v5 offset:4096
  v_mfma_f32_16x16x32_bf16 v[60:63], a[60:63], v[20:23], v[60:63]
  v_add3_u32 v88, v88, v89, v92
  v_lshlrev_b32 v90, 4, v88
  v_mfma_f32_16x16x32_bf16 v[64:67], a[116:119], v[20:23], v[64:67]
  v_cvt_pk_bf16_f32 v72, v96, v100
  v_cvt_pk_bf16_f32 v73, v97, v101
  v_mfma_f32_16x16x32_bf16 v[68:71], a[172:175], v[20:23], v[68:71]
  s_waitcnt lgkmcnt(4)
  v_cvt_pk_bf16_f32 v74, v98, v102
  v_mfma_f32_16x16x32_bf16 v[40:43], a[8:11], v[24:27], v[40:43]
  ds_read_b128 v[16:19], v5 offset:18432
  v_mfma_f32_16x16x32_bf16 v[44:47], a[64:67], v[24:27], v[44:47]
  v_cvt_pk_bf16_f32 v75, v99, v103
  v_mfma_f32_16x16x32_bf16 v[48:51], a[120:123], v[24:27], v[48:51]
  buffer_store_dwordx4 v[72:75], v90, s[8:11], s41 offen sc1
  v_cvt_pk_bf16_f32 v76, v104, v108
  v_mfma_f32_16x16x32_bf16 v[52:55], a[176:179], v[24:27], v[52:55]
  s_waitcnt lgkmcnt(4)
  v_cvt_pk_bf16_f32 v77, v105, v109
  v_mfma_f32_16x16x32_bf16 v[56:59], a[8:11], v[28:31], v[56:59]
  ds_read_b128 v[20:23], v5 offset:5120
  v_mfma_f32_16x16x32_bf16 v[60:63], a[64:67], v[28:31], v[60:63]
  v_cvt_pk_bf16_f32 v78, v106, v110
  v_cvt_pk_bf16_f32 v79, v107, v111
  v_mfma_f32_16x16x32_bf16 v[64:67], a[120:123], v[28:31], v[64:67]
  buffer_store_dwordx4 v[76:79], v90, s[8:11], s43 offen sc1
  s_lshl_b32 s42, s40, 5
  v_mfma_f32_16x16x32_bf16 v[68:71], a[176:179], v[28:31], v[68:71]
  s_waitcnt lgkmcnt(4)
  s_add_u32 s42, s42, 16
  v_mfma_f32_16x16x32_bf16 v[40:43], a[12:15], v[32:35], v[40:43]
  ds_read_b128 v[24:27], v5 offset:19456
  v_mfma_f32_16x16x32_bf16 v[44:47], a[68:71], v[32:35], v[44:47]
  v_add_u32 v88, s42, v4
  v_mul_u32_u24 v89, 2341, v88
  v_mfma_f32_16x16x32_bf16 v[48:51], a[124:127], v[32:35], v[48:51]
  v_lshrrev_b32 v89, 16, v89
  v_mul_u32_u24 v92, 28, v89
  v_mfma_f32_16x16x32_bf16 v[52:55], a[180:183], v[32:35], v[52:55]
  s_waitcnt lgkmcnt(4)
  v_sub_u32 v92, v88, v92
  v_mfma_f32_16x16x32_bf16 v[56:59], a[12:15], v[8:11], v[56:59]
  ds_read_b128 v[28:31], v5 offset:6144
  v_mfma_f32_16x16x32_bf16 v[60:63], a[68:71], v[8:11], v[60:63]
  v_cmp_gt_u32 vcc, 16, v92
  v_mul_u32_u24 v89, 84, v89
  v_mfma_f32_16x16x32_bf16 v[64:67], a[124:127], v[8:11], v[64:67]
  v_cndmask_b32 v92, v7, v6, vcc
  v_add3_u32 v88, v88, v89, v92
  v_mfma_f32_16x16x32_bf16 v[68:71], a[180:183], v[8:11], v[68:71]
  s_waitcnt lgkmcnt(4)
  v_lshlrev_b32 v91, 4, v88
  v_mfma_f32_16x16x32_bf16 v[40:43], a[16:19], v[12:15], v[40:43]
  ds_read_b128 v[32:35], v5 offset:20480
  v_mfma_f32_16x16x32_bf16 v[44:47], a[72:75], v[12:15], v[44:47]
  v_cvt_pk_bf16_f32 v80, v112, v116
  v_cvt_pk_bf16_f32 v81, v113, v117
  v_mfma_f32_16x16x32_bf16 v[48:51], a[128:131], v[12:15], v[48:51]
  v_cvt_pk_bf16_f32 v82, v114, v118
  v_cvt_pk_bf16_f32 v83, v115, v119
  v_mfma_f32_16x16x32_bf16 v[52:55], a[184:187], v[12:15], v[52:55]
  s_waitcnt lgkmcnt(4)
  buffer_store_dwordx4 v[80:83], v91, s[8:11], s41 offen sc1
  v_mfma_f32_16x16x32_bf16 v[56:59], a[16:19], v[16:19], v[56:59]
  ds_read_b128 v[8:11], v5 offset:7168
  v_mfma_f32_16x16x32_bf16 v[60:63], a[72:75], v[16:19], v[60:63]
  v_cvt_pk_bf16_f32 v84, v120, v124
  v_cvt_pk_bf16_f32 v85, v121, v125
  v_mfma_f32_16x16x32_bf16 v[64:67], a[128:131], v[16:19], v[64:67]
  v_cvt_pk_bf16_f32 v86, v122, v126
  v_cvt_pk_bf16_f32 v87, v123, v127
  v_mfma_f32_16x16x32_bf16 v[68:71], a[184:187], v[16:19], v[68:71]
  s_waitcnt lgkmcnt(4)
  buffer_store_dwordx4 v[84:87], v91, s[8:11], s43 offen sc1
  v_mfma_f32_16x16x32_bf16 v[40:43], a[20:23], v[20:23], v[40:43]
  ds_read_b128 v[12:15], v5 offset:21504
  v_mfma_f32_16x16x32_bf16 v[44:47], a[76:79], v[20:23], v[44:47]
  s_add_u32 s30, s19, 2
  s_lshl_b32 s24, s30, 1
  s_mul_i32 s24, s24, 14336
  v_mfma_f32_16x16x32_bf16 v[48:51], a[132:135], v[20:23], v[48:51]
  s_add_u32 s24, s24, s23
  s_cmp_lt_u32 s30, s35
  s_cselect_b32 s24, s24, 0x40000000
  v_mfma_f32_16x16x32_bf16 v[52:55], a[188:191], v[20:23], v[52:55]
  s_waitcnt lgkmcnt(4)
  s_add_u32 m0, s33, s27
  s_nop 0
  buffer_load_dwordx4 v2, s[8:11], s24 offen offset:0 sc1 lds
  v_mfma_f32_16x16x32_bf16 v[56:59], a[20:23], v[24:27], v[56:59]
  ds_read_b128 v[16:19], v5 offset:8192
  v_mfma_f32_16x16x32_bf16 v[60:63], a[76:79], v[24:27], v[60:63]
  v_mfma_f32_16x16x32_bf16 v[64:67], a[132:135], v[24:27], v[64:67]
  v_mfma_f32_16x16x32_bf16 v[68:71], a[188:191], v[24:27], v[68:71]
  s_waitcnt lgkmcnt(4)
  v_mfma_f32_16x16x32_bf16 v[40:43], a[24:27], v[28:31], v[40:43]
  ds_read_b128 v[20:23], v5 offset:22528
  v_mfma_f32_16x16x32_bf16 v[44:47], a[80:83], v[28:31], v[44:47]
  buffer_load_dwordx4 v2, s[8:11], s24 offen offset:1024 sc1 lds
  v_mfma_f32_16x16x32_bf16 v[48:51], a[136:139], v[28:31], v[48:51]
  v_mfma_f32_16x16x32_bf16 v[52:55], a[192:195], v[28:31], v[52:55]
  s_waitcnt lgkmcnt(4)
  v_mfma_f32_16x16x32_bf16 v[56:59], a[24:27], v[32:35], v[56:59]
  ds_read_b128 v[24:27], v5 offset:9216
  v_mfma_f32_16x16x32_bf16 v[60:63], a[80:83], v[32:35], v[60:63]
  v_mfma_f32_16x16x32_bf16 v[64:67], a[136:139], v[32:35], v[64:67]
  buffer_load_dwordx4 v2, s[8:11], s24 offen offset:2048 sc1 lds
  v_mfma_f32_16x16x32_bf16 v[68:71], a[192:195], v[32:35], v[68:71]
  s_waitcnt lgkmcnt(4)
  v_mfma_f32_16x16x32_bf16 v[40:43], a[28:31], v[8:11], v[40:43]
  ds_read_b128 v[28:31], v5 offset:23552
  v_mfma_f32_16x16x32_bf16 v[44:47], a[84:87], v[8:11], v[44:47]
  v_mfma_f32_16x16x32_bf16 v[48:51], a[140:143], v[8:11], v[48:51]
  v_mfma_f32_16x16x32_bf16 v[52:55], a[196:199], v[8:11], v[52:55]
  s_waitcnt lgkmcnt(4)
  buffer_load_dwordx4 v2, s[8:11], s24 offen offset:3072 sc1 lds
  v_mfma_f32_16x16x32_bf16 v[56:59], a[28:31], v[12:15], v[56:59]
  ds_read_b128 v[32:35], v5 offset:10240
  v_mfma_f32_16x16x32_bf16 v[60:63], a[84:87], v[12:15], v[60:63]
  v_mfma_f32_16x16x32_bf16 v[64:67], a[140:143], v[12:15], v[64:67]
  v_mfma_f32_16x16x32_bf16 v[68:71], a[196:199], v[12:15], v[68:71]
  s_waitcnt lgkmcnt(4)
  v_mfma_f32_16x16x32_bf16 v[40:43], a[32:35], v[16:19], v[40:43]
  ds_read_b128 v[8:11], v5 offset:24576
  v_mfma_f32_16x16x32_bf16 v[44:47], a[88:91], v[16:19], v[44:47]
  s_add_u32 m0, m0, 4096
  s_add_u32 s24, s24, 4096
  buffer_load_dwordx4 v2, s[8:11], s24 offen offset:0 sc1 lds
  v_mfma_f32_16x16x32_bf16 v[48:51], a[144:147], v[16:19], v[48:51]
  v_mfma_f32_16x16x32_bf16 v[52:55], a[200:203], v[16:19], v[52:55]
  s_waitcnt lgkmcnt(4)
  v_mfma_f32_16x16x32_bf16 v[56:59], a[32:35], v[20:23], v[56:59]
  ds_read_b128 v[12:15], v5 offset:11264
  v_mfma_f32_16x16x32_bf16 v[60:63], a[88:91], v[20:23], v[60:63]
  v_mfma_f32_16x16x32_bf16 v[64:67], a[144:147], v[20:23], v[64:67]
  buffer_load_dwordx4 v2, s[8:11], s24 offen offset:1024 sc1 lds
  v_mfma_f32_16x16x32_bf16 v[68:71], a[200:203], v[20:23], v[68:71]
  s_waitcnt lgkmcnt(4)
  v_mfma_f32_16x16x32_bf16 v[40:43], a[36:39], v[24:27], v[40:43]
  ds_read_b128 v[16:19], v5 offset:25600
  v_mfma_f32_16x16x32_bf16 v[44:47], a[92:95], v[24:27], v[44:47]
  v_mfma_f32_16x16x32_bf16 v[48:51], a[148:151], v[24:27], v[48:51]
  v_mfma_f32_16x16x32_bf16 v[52:55], a[204:207], v[24:27], v[52:55]
  s_waitcnt lgkmcnt(4)
  buffer_load_dwordx4 v2, s[8:11], s24 offen offset:2048 sc1 lds
  v_mfma_f32_16x16x32_bf16 v[56:59], a[36:39], v[28:31], v[56:59]
  ds_read_b128 v[20:23], v5 offset:12288
  v_mfma_f32_16x16x32_bf16 v[60:63], a[92:95], v[28:31], v[60:63]
  v_mfma_f32_16x16x32_bf16 v[64:67], a[148:151], v[28:31], v[64:67]
  v_mfma_f32_16x16x32_bf16 v[68:71], a[204:207], v[28:31], v[68:71]
  s_waitcnt lgkmcnt(4)
  v_mfma_f32_16x16x32_bf16 v[40:43], a[40:43], v[32:35], v[40:43]
  ds_read_b128 v[24:27], v5 offset:26624
  v_mfma_f32_16x16x32_bf16 v[44:47], a[96:99], v[32:35], v[44:47]
  s_add_u32 s33, s33, 28672
  s_cmp_eq_u32 s33, 114688
  s_cselect_b32 s33, 0, s33
  v_mfma_f32_16x16x32_bf16 v[48:51], a[152:155], v[32:35], v[48:51]
  s_add_u32 s32, s32, 28672
  s_cmp_eq_u32 s32, 114688
  s_cselect_b32 s32, 0, s32
  v_mfma_f32_16x16x32_bf16 v[52:55], a[208:211], v[32:35], v[52:55]
  s_waitcnt lgkmcnt(4)
  v_add_u32 v128, s32, v2
  v_mfma_f32_16x16x32_bf16 v[56:59], a[40:43], v[8:11], v[56:59]
  ds_read_b128 v[28:31], v5 offset:13312
  v_mfma_f32_16x16x32_bf16 v[60:63], a[96:99], v[8:11], v[60:63]
  v_mfma_f32_16x16x32_bf16 v[64:67], a[152:155], v[8:11], v[64:67]
  v_mfma_f32_16x16x32_bf16 v[68:71], a[208:211], v[8:11], v[68:71]
  s_waitcnt lgkmcnt(4)
  v_mfma_f32_16x16x32_bf16 v[40:43], a[44:47], v[12:15], v[40:43]
  ds_read_b128 v[32:35], v5 offset:27648
  v_mfma_f32_16x16x32_bf16 v[44:47], a[100:103], v[12:15], v[44:47]
  v_mfma_f32_16x16x32_bf16 v[48:51], a[156:159], v[12:15], v[48:51]
  v_mfma_f32_16x16x32_bf16 v[52:55], a[212:215], v[12:15], v[52:55]
  s_waitcnt lgkmcnt(4)
  v_mfma_f32_16x16x32_bf16 v[56:59], a[44:47], v[16:19], v[56:59]
  s_waitcnt vmcnt(11)
  s_barrier
  ds_read_b128 v[8:11], v128 offset:0
  v_mfma_f32_16x16x32_bf16 v[60:63], a[100:103], v[16:19], v[60:63]
  v_mfma_f32_16x16x32_bf16 v[64:67], a[156:159], v[16:19], v[64:67]
  v_mfma_f32_16x16x32_bf16 v[68:71], a[212:215], v[16:19], v[68:71]
  s_waitcnt lgkmcnt(4)
  v_mfma_f32_16x16x32_bf16 v[40:43], a[48:51], v[20:23], v[40:43]
  ds_read_b128 v[12:15], v128 offset:14336
  v_mfma_f32_16x16x32_bf16 v[44:47], a[104:107], v[20:23], v[44:47]
  v_mfma_f32_16x16x32_bf16 v[48:51], a[160:163], v[20:23], v[48:51]
  v_mfma_f32_16x16x32_bf16 v[52:55], a[216:219], v[20:23], v[52:55]
  s_waitcnt lgkmcnt(4)
  v_mfma_f32_16x16x32_bf16 v[56:59], a[48:51], v[24:27], v[56:59]
  ds_read_b128 v[16:19], v128 offset:1024
  v_mfma_f32_16x16x32_bf16 v[60:63], a[104:107], v[24:27], v[60:63]
  v_mfma_f32_16x16x32_bf16 v[64:67], a[160:163], v[24:27], v[64:67]
  v_mfma_f32_16x16x32_bf16 v[68:71], a[216:219], v[24:27], v[68:71]
  s_waitcnt lgkmcnt(4)
  v_mfma_f32_16x16x32_bf16 v[40:43], a[52:55], v[28:31], v[40:43]
  ds_read_b128 v[20:23], v128 offset:15360
  v_mfma_f32_16x16x32_bf16 v[44:47], a[108:111], v[28:31], v[44:47]
  v_mfma_f32_16x16x32_bf16 v[48:51], a[164:167], v[28:31], v[48:51]
  v_mfma_f32_16x16x32_bf16 v[52:55], a[220:223], v[28:31], v[52:55]
  s_waitcnt lgkmcnt(4)
  v_mfma_f32_16x16x32_bf16 v[56:59], a[52:55], v[32:35], v[56:59]
  ds_read_b128 v[24:27], v128 offset:2048
  v_mfma_f32_16x16x32_bf16 v[60:63], a[108:111], v[32:35], v[60:63]
  v_mfma_f32_16x16x32_bf16 v[64:67], a[164:167], v[32:35], v[64:67]
  v_mfma_f32_16x16x32_bf16 v[68:71], a[220:223], v[32:35], v[68:71]
  s_waitcnt lgkmcnt(4)
  s_mov_b32 s40, s19
  s_mov_b32 s41, s29
  s_add_u32 s19, s19, 1
  s_cmp_lt_u32 s19, s35
  s_cbranch_scc0 wg_vo_e0
  v_mfma_f32_16x16x32_bf16 v[96:99], a[0:3], v[8:11], 0
  ds_read_b128 v[28:31], v128 offset:16384
  v_mfma_f32_16x16x32_bf16 v[100:103], a[56:59], v[8:11], 0
  v_mfma_f32_16x16x32_bf16 v[104:107], a[112:115], v[8:11], 0
  v_mfma_f32_16x16x32_bf16 v[108:111], a[168:171], v[8:11], 0
  s_waitcnt lgkmcnt(4)
  s_add_u32 s43, s41, 458752
  v_mfma_f32_16x16x32_bf16 v[112:115], a[0:3], v[12:15], 0
  ds_read_b128 v[32:35], v128 offset:3072
  v_mfma_f32_16x16x32_bf16 v[116:119], a[56:59], v[12:15], 0
  s_lshl_b32 s42, s40, 5
  s_add_u32 s42, s42, 0
  v_mfma_f32_16x16x32_bf16 v[120:123], a[112:115], v[12:15], 0
  v_add_u32 v88, s42, v4
  v_mul_u32_u24 v89, 2341, v88
  v_mfma_f32_16x16x32_bf16 v[124:127], a[168:171], v[12:15], 0
  s_waitcnt lgkmcnt(4)
  v_lshrrev_b32 v89, 16, v89
  v_mfma_f32_16x16x32_bf16 v[96:99], a[4:7], v[16:19], v[96:99]
  ds_read_b128 v[8:11], v128 offset:17408
  v_mfma_f32_16x16x32_bf16 v[100:103], a[60:63], v[16:19], v[100:103]
  v_mul_u32_u24 v92, 28, v89
  v_sub_u32 v92, v88, v92
  v_mfma_f32_16x16x32_bf16 v[104:107], a[116:119], v[16:19], v[104:107]
  v_cmp_gt_u32 vcc, 16, v92
  v_mul_u32_u24 v89, 84, v89
  v_mfma_f32_16x16x32_bf16 v[108:111], a[172:175], v[16:19], v[108:111]
  s_waitcnt lgkmcnt(4)
  v_cndmask_b32 v92, v7, v6, vcc
  v_mfma_f32_16x16x32_bf16 v[112:115], a[4:7], v[20:23], v[112:115]
  ds_read_b128 v[12:15], v128 offset:4096
  v_mfma_f32_16x16x32_bf16 v[116:119], a[60:63], v[20:23], v[116:119]
  v_add3_u32 v88, v88, v89, v92
  v_lshlrev_b32 v90, 4, v88
  v_mfma_f32_16x16x32_bf16 v[120:123], a[116:119], v[20:23], v[120:123]
  v_cvt_pk_bf16_f32 v72, v40, v44
  v_cvt_pk_bf16_f32 v73, v41, v45
  v_mfma_f32_16x16x32_bf16 v[124:127], a[172:175], v[20:23], v[124:127]
  s_waitcnt lgkmcnt(4)
  v_cvt_pk_bf16_f32 v74, v42, v46
  v_mfma_f32_16x16x32_bf16 v[96:99], a[8:11], v[24:27], v[96:99]
  ds_read_b128 v[16:19], v128 offset:18432
  v_mfma_f32_16x16x32_bf16 v[100:103], a[64:67], v[24:27], v[100:103]
  v_cvt_pk_bf16_f32 v75, v43, v47
  v_mfma_f32_16x16x32_bf16 v[104:107], a[120:123], v[24:27], v[104:107]
  buffer_store_dwordx4 v[72:75], v90, s[8:11], s41 offen sc1
  v_cvt_pk_bf16_f32 v76, v48, v52
  v_mfma_f32_16x16x32_bf16 v[108:111], a[176:179], v[24:27], v[108:111]
  s_waitcnt lgkmcnt(4)
  v_cvt_pk_bf16_f32 v77, v49, v53
  v_mfma_f32_16x16x32_bf16 v[112:115], a[8:11], v[28:31], v[112:115]
  ds_read_b128 v[20:23], v128 offset:5120
  v_mfma_f32_16x16x32_bf16 v[116:119], a[64:67], v[28:31], v[116:119]
  v_cvt_pk_bf16_f32 v78, v50, v54
  v_cvt_pk_bf16_f32 v79, v51, v55
  v_mfma_f32_16x16x32_bf16 v[120:123], a[120:123], v[28:31], v[120:123]
  buffer_store_dwordx4 v[76:79], v90, s[8:11], s43 offen sc1
  s_lshl_b32 s42, s40, 5
  v_mfma_f32_16x16x32_bf16 v[124:127], a[176:179], v[28:31], v[124:127]
  s_waitcnt lgkmcnt(4)
  s_add_u32 s42, s42, 16
  v_mfma_f32_16x16x32_bf16 v[96:99], a[12:15], v[32:35], v[96:99]
  ds_read_b128 v[24:27], v128 offset:19456
  v_mfma_f32_16x16x32_bf16 v[100:103], a[68:71], v[32:35], v[100:103]
  v_add_u32 v88, s42, v4
  v_mul_u32_u24 v89, 2341, v88
  v_mfma_f32_16x16x32_bf16 v[104:107], a[124:127], v[32:35], v[104:107]
  v_lshrrev_b32 v89, 16, v89
  v_mul_u32_u24 v92, 28, v89
  v_mfma_f32_16x16x32_bf16 v[108:111], a[180:183], v[32:35], v[108:111]
  s_waitcnt lgkmcnt(4)
  v_sub_u32 v92, v88, v92
  v_mfma_f32_16x16x32_bf16 v[112:115], a[12:15], v[8:11], v[112:115]
  ds_read_b128 v[28:31], v128 offset:6144
  v_mfma_f32_16x16x32_bf16 v[116:119], a[68:71], v[8:11], v[116:119]
  v_cmp_gt_u32 vcc, 16, v92
  v_mul_u32_u24 v89, 84, v89
  v_mfma_f32_16x16x32_bf16 v[120:123], a[124:127], v[8:11], v[120:123]
  v_cndmask_b32 v92, v7, v6, vcc
  v_add3_u32 v88, v88, v89, v92
  v_mfma_f32_16x16x32_bf16 v[124:127], a[180:183], v[8:11], v[124:127]
  s_waitcnt lgkmcnt(4)
  v_lshlrev_b32 v91, 4, v88
  v_mfma_f32_16x16x32_bf16 v[96:99], a[16:19], v[12:15], v[96:99]
  ds_read_b128 v[32:35], v128 offset:20480
  v_mfma_f32_16x16x32_bf16 v[100:103], a[72:75], v[12:15], v[100:103]
  v_cvt_pk_bf16_f32 v80, v56, v60
  v_cvt_pk_bf16_f32 v81, v57, v61
  v_mfma_f32_16x16x32_bf16 v[104:107], a[128:131], v[12:15], v[104:107]
  v_cvt_pk_bf16_f32 v82, v58, v62
  v_cvt_pk_bf16_f32 v83, v59, v63
  v_mfma_f32_16x16x32_bf16 v[108:111], a[184:187], v[12:15], v[108:111]
  s_waitcnt lgkmcnt(4)
  buffer_store_dwordx4 v[80:83], v91, s[8:11], s41 offen sc1
  v_mfma_f32_16x16x32_bf16 v[112:115], a[16:19], v[16:19], v[112:115]
  ds_read_b128 v[8:11], v128 offset:7168
  v_mfma_f32_16x16x32_bf16 v[116:119], a[72:75], v[16:19], v[116:119]
  v_cvt_pk_bf16_f32 v84, v64, v68
  v_cvt_pk_bf16_f32 v85, v65, v69
  v_mfma_f32_16x16x32_bf16 v[120:123], a[128:131], v[16:19], v[120:123]
  v_cvt_pk_bf16_f32 v86, v66, v70
  v_cvt_pk_bf16_f32 v87, v67, v71
  v_mfma_f32_16x16x32_bf16 v[124:127], a[184:187], v[16:19], v[124:127]
  s_waitcnt lgkmcnt(4)
  buffer_store_dwordx4 v[84:87], v91, s[8:11], s43 offen sc1
  v_mfma_f32_16x16x32_bf16 v[96:99], a[20:23], v[20:23], v[96:99]
  ds_read_b128 v[12:15], v128 offset:21504
  v_mfma_f32_16x16x32_bf16 v[100:103], a[76:79], v[20:23], v[100:103]
  s_add_u32 s30, s19, 2
  s_lshl_b32 s24, s30, 1
  s_mul_i32 s24, s24, 14336
  v_mfma_f32_16x16x32_bf16 v[104:107], a[132:135], v[20:23], v[104:107]
  s_add_u32 s24, s24, s23
  s_cmp_lt_u32 s30, s35
  s_cselect_b32 s24, s24, 0x40000000
  v_mfma_f32_16x16x32_bf16 v[108:111], a[188:191], v[20:23], v[108:111]
  s_waitcnt lgkmcnt(4)
  s_add_u32 m0, s33, s27
  s_nop 0
  buffer_load_dwordx4 v2, s[8:11], s24 offen offset:0 sc1 lds
  v_mfma_f32_16x16x32_bf16 v[112:115], a[20:23], v[24:27], v[112:115]
  ds_read_b128 v[16:19], v128 offset:8192
  v_mfma_f32_16x16x32_bf16 v[116:119], a[76:79], v[24:27], v[116:119]
  v_mfma_f32_16x16x32_bf16 v[120:123], a[132:135], v[24:27], v[120:123]
  v_mfma_f32_16x16x32_bf16 v[124:127], a[188:191], v[24:27], v[124:127]
  s_waitcnt lgkmcnt(4)
  v_mfma_f32_16x16x32_bf16 v[96:99], a[24:27], v[28:31], v[96:99]
  ds_read_b128 v[20:23], v128 offset:22528
  v_mfma_f32_16x16x32_bf16 v[100:103], a[80:83], v[28:31], v[100:103]
  buffer_load_dwordx4 v2, s[8:11], s24 offen offset:1024 sc1 lds
  v_mfma_f32_16x16x32_bf16 v[104:107], a[136:139], v[28:31], v[104:107]
  v_mfma_f32_16x16x32_bf16 v[108:111], a[192:195], v[28:31], v[108:111]
  s_waitcnt lgkmcnt(4)
  v_mfma_f32_16x16x32_bf16 v[112:115], a[24:27], v[32:35], v[112:115]
  ds_read_b128 v[24:27], v128 offset:9216
  v_mfma_f32_16x16x32_bf16 v[116:119], a[80:83], v[32:35], v[116:119]
  v_mfma_f32_16x16x32_bf16 v[120:123], a[136:139], v[32:35], v[120:123]
  buffer_load_dwordx4 v2, s[8:11], s24 offen offset:2048 sc1 lds
  v_mfma_f32_16x16x32_bf16 v[124:127], a[192:195], v[32:35], v[124:127]
  s_waitcnt lgkmcnt(4)
  v_mfma_f32_16x16x32_bf16 v[96:99], a[28:31], v[8:11], v[96:99]
  ds_read_b128 v[28:31], v128 offset:23552
  v_mfma_f32_16x16x32_bf16 v[100:103], a[84:87], v[8:11], v[100:103]
  v_mfma_f32_16x16x32_bf16 v[104:107], a[140:143], v[8:11], v[104:107]
  v_mfma_f32_16x16x32_bf16 v[108:111], a[196:199], v[8:11], v[108:111]
  s_waitcnt lgkmcnt(4)
  buffer_load_dwordx4 v2, s[8:11], s24 offen offset:3072 sc1 lds
  v_mfma_f32_16x16x32_bf16 v[112:115], a[28:31], v[12:15], v[112:115]
  ds_read_b128 v[32:35], v128 offset:10240
  v_mfma_f32_16x16x32_bf16 v[116:119], a[84:87], v[12:15], v[116:119]
  v_mfma_f32_16x16x32_bf16 v[120:123], a[140:143], v[12:15], v[120:123]
  v_mfma_f32_16x16x32_bf16 v[124:127], a[196:199], v[12:15], v[124:127]
  s_waitcnt lgkmcnt(4)
  v_mfma_f32_16x16x32_bf16 v[96:99], a[32:35], v[16:19], v[96:99]
  ds_read_b128 v[8:11], v128 offset:24576
  v_mfma_f32_16x16x32_bf16 v[100:103], a[88:91], v[16:19], v[100:103]
  s_add_u32 m0, m0, 4096
  s_add_u32 s24, s24, 4096
  buffer_load_dwordx4 v2, s[8:11], s24 offen offset:0 sc1 lds
  v_mfma_f32_16x16x32_bf16 v[104:107], a[144:147], v[16:19], v[104:107]
  v_mfma_f32_16x16x32_bf16 v[108:111], a[200:203], v[16:19], v[108:111]
  s_waitcnt lgkmcnt(4)
  v_mfma_f32_16x16x32_bf16 v[112:115], a[32:35], v[20:23], v[112:115]
  ds_read_b128 v[12:15], v128 offset:11264
  v_mfma_f32_16x16x32_bf16 v[116:119], a[88:91], v[20:23], v[116:119]
  v_mfma_f32_16x16x32_bf16 v[120:123], a[144:147], v[20:23], v[120:123]
  buffer_load_dwordx4 v2, s[8:11], s24 offen offset:1024 sc1 lds
  v_mfma_f32_16x16x32_bf16 v[124:127], a[200:203], v[20:23], v[124:127]
  s_waitcnt lgkmcnt(4)
  v_mfma_f32_16x16x32_bf16 v[96:99], a[36:39], v[24:27], v[96:99]
  ds_read_b128 v[16:19], v128 offset:25600
  v_mfma_f32_16x16x32_bf16 v[100:103], a[92:95], v[24:27], v[100:103]
  v_mfma_f32_16x16x32_bf16 v[104:107], a[148:151], v[24:27], v[104:107]
  v_mfma_f32_16x16x32_bf16 v[108:111], a[204:207], v[24:27], v[108:111]
  s_waitcnt lgkmcnt(4)
  buffer_load_dwordx4 v2, s[8:11], s24 offen offset:2048 sc1 lds
  v_mfma_f32_16x16x32_bf16 v[112:115], a[36:39], v[28:31], v[112:115]
  ds_read_b128 v[20:23], v128 offset:12288
  v_mfma_f32_16x16x32_bf16 v[116:119], a[92:95], v[28:31], v[116:119]
  v_mfma_f32_16x16x32_bf16 v[120:123], a[148:151], v[28:31], v[120:123]
  v_mfma_f32_16x16x32_bf16 v[124:127], a[204:207], v[28:31], v[124:127]
  s_waitcnt lgkmcnt(4)
  v_mfma_f32_16x16x32_bf16 v[96:99], a[40:43], v[32:35], v[96:99]
  ds_read_b128 v[24:27], v128 offset:26624
  v_mfma_f32_16x16x32_bf16 v[100:103], a[96:99], v[32:35], v[100:103]
  s_add_u32 s33, s33, 28672
  s_cmp_eq_u32 s33, 114688
  s_cselect_b32 s33, 0, s33
  v_mfma_f32_16x16x32_bf16 v[104:107], a[152:155], v[32:35], v[104:107]
  s_add_u32 s32, s32, 28672
  s_cmp_eq_u32 s32, 114688
  s_cselect_b32 s32, 0, s32
  v_mfma_f32_16x16x32_bf16 v[108:111], a[208:211], v[32:35], v[108:111]
  s_waitcnt lgkmcnt(4)
  v_add_u32 v5, s32, v2
  v_mfma_f32_16x16x32_bf16 v[112:115], a[40:43], v[8:11], v[112:115]
  ds_read_b128 v[28:31], v128 offset:13312
  v_mfma_f32_16x16x32_bf16 v[116:119], a[96:99], v[8:11], v[116:119]
  v_mfma_f32_16x16x32_bf16 v[120:123], a[152:155], v[8:11], v[120:123]
  v_mfma_f32_16x16x32_bf16 v[124:127], a[208:211], v[8:11], v[124:127]
  s_waitcnt lgkmcnt(4)
  v_mfma_f32_16x16x32_bf16 v[96:99], a[44:47], v[12:15], v[96:99]
  ds_read_b128 v[32:35], v128 offset:27648
  v_mfma_f32_16x16x32_bf16 v[100:103], a[100:103], v[12:15], v[100:103]
  v_mfma_f32_16x16x32_bf16 v[104:107], a[156:159], v[12:15], v[104:107]
  v_mfma_f32_16x16x32_bf16 v[108:111], a[212:215], v[12:15], v[108:111]
  s_waitcnt lgkmcnt(4)
  v_mfma_f32_16x16x32_bf16 v[112:115], a[44:47], v[16:19], v[112:115]
  s_waitcnt vmcnt(11)
  s_barrier
  ds_read_b128 v[8:11], v5 offset:0
  v_mfma_f32_16x16x32_bf16 v[116:119], a[100:103], v[16:19], v[116:119]
  v_mfma_f32_16x16x32_bf16 v[120:123], a[156:159], v[16:19], v[120:123]
  v_mfma_f32_16x16x32_bf16 v[124:127], a[212:215], v[16:19], v[124:127]
  s_waitcnt lgkmcnt(4)
  v_mfma_f32_16x16x32_bf16 v[96:99], a[48:51], v[20:23], v[96:99]
  ds_read_b128 v[12:15], v5 offset:14336
  v_mfma_f32_16x16x32_bf16 v[100:103], a[104:107], v[20:23], v[100:103]
  v_mfma_f32_16x16x32_bf16 v[104:107], a[160:163], v[20:23], v[104:107]
  v_mfma_f32_16x16x32_bf16 v[108:111], a[216:219], v[20:23], v[108:111]
  s_waitcnt lgkmcnt(4)
  v_mfma_f32_16x16x32_bf16 v[112:115], a[48:51], v[24:27], v[112:115]
  ds_read_b128 v[16:19], v5 offset:1024
  v_mfma_f32_16x16x32_bf16 v[116:119], a[104:107], v[24:27], v[116:119]
  v_mfma_f32_16x16x32_bf16 v[120:123], a[160:163], v[24:27], v[120:123]
  v_mfma_f32_16x16x32_bf16 v[124:127], a[216:219], v[24:27], v[124:127]
  s_waitcnt lgkmcnt(4)
  v_mfma_f32_16x16x32_bf16 v[96:99], a[52:55], v[28:31], v[96:99]
  ds_read_b128 v[20:23], v5 offset:15360
  v_mfma_f32_16x16x32_bf16 v[100:103], a[108:111], v[28:31], v[100:103]
  v_mfma_f32_16x16x32_bf16 v[104:107], a[164:167], v[28:31], v[104:107]
  v_mfma_f32_16x16x32_bf16 v[108:111], a[220:223], v[28:31], v[108:111]
  s_waitcnt lgkmcnt(4)
  v_mfma_f32_16x16x32_bf16 v[112:115], a[52:55], v[32:35], v[112:115]
  ds_read_b128 v[24:27], v5 offset:2048
  v_mfma_f32_16x16x32_bf16 v[116:119], a[108:111], v[32:35], v[116:119]
  v_mfma_f32_16x16x32_bf16 v[120:123], a[164:167], v[32:35], v[120:123]
  v_mfma_f32_16x16x32_bf16 v[124:127], a[220:223], v[32:35], v[124:127]
  s_waitcnt lgkmcnt(4)
  s_mov_b32 s40, s19
  s_mov_b32 s41, s29
  s_add_u32 s19, s19, 1
  s_cmp_lt_u32 s19, s35
  s_cbranch_scc1 wg_vo_loop
  s_nop 3
  s_add_u32 s43, s41, 458752
  s_lshl_b32 s42, s40, 5
  s_add_u32 s42, s42, 0
  v_add_u32 v88, s42, v4
  v_mul_u32_u24 v89, 2341, v88
  v_lshrrev_b32 v89, 16, v89
  v_mul_u32_u24 v92, 28, v89
  v_sub_u32 v92, v88, v92
  v_cmp_gt_u32 vcc, 16, v92
  v_mul_u32_u24 v89, 84, v89
  s_nop 0
  v_cndmask_b32 v92, v7, v6, vcc
  v_add3_u32 v88, v88, v89, v92
  v_lshlrev_b32 v90, 4, v88
  v_cvt_pk_bf16_f32 v72, v96, v100
  v_cvt_pk_bf16_f32 v73, v97, v101
  v_cvt_pk_bf16_f32 v74, v98, v102
  v_cvt_pk_bf16_f32 v75, v99, v103
  buffer_store_dwordx4 v[72:75], v90, s[8:11], s41 offen sc1
  v_cvt_pk_bf16_f32 v76, v104, v108
  v_cvt_pk_bf16_f32 v77, v105, v109
  v_cvt_pk_bf16_f32 v78, v106, v110
  v_cvt_pk_bf16_f32 v79, v107, v111
  buffer_store_dwordx4 v[76:79], v90, s[8:11], s43 offen sc1
  s_lshl_b32 s42, s40, 5
  s_add_u32 s42, s42, 16
  v_add_u32 v88, s42, v4
  v_mul_u32_u24 v89, 2341, v88
  v_lshrrev_b32 v89, 16, v89
  v_mul_u32_u24 v92, 28, v89
  v_sub_u32 v92, v88, v92
  v_cmp_gt_u32 vcc, 16, v92
  v_mul_u32_u24 v89, 84, v89
  s_nop 0
  v_cndmask_b32 v92, v7, v6, vcc
  v_add3_u32 v88, v88, v89, v92
  v_lshlrev_b32 v91, 4, v88
  v_cvt_pk_bf16_f32 v80, v112, v116
  v_cvt_pk_bf16_f32 v81, v113, v117
  v_cvt_pk_bf16_f32 v82, v114, v118
  v_cvt_pk_bf16_f32 v83, v115, v119
  buffer_store_dwordx4 v[80:83], v91, s[8:11], s41 offen sc1
  v_cvt_pk_bf16_f32 v84, v120, v124
  v_cvt_pk_bf16_f32 v85, v121, v125
  v_cvt_pk_bf16_f32 v86, v122, v126
  v_cvt_pk_bf16_f32 v87, v123, v127
  buffer_store_dwordx4 v[84:87], v91, s[8:11], s43 offen sc1
  s_branch wg_done
wg_vo_e0:
  s_nop 7
  s_add_u32 s43, s41, 458752
  s_lshl_b32 s42, s40, 5
  s_add_u32 s42, s42, 0
  v_add_u32 v88, s42, v4
  v_mul_u32_u24 v89, 2341, v88
  v_lshrrev_b32 v89, 16, v89
  v_mul_u32_u24 v92, 28, v89
  v_sub_u32 v92, v88, v92
  v_cmp_gt_u32 vcc, 16, v92
  v_mul_u32_u24 v89, 84, v89
  s_nop 0
  v_cndmask_b32 v92, v7, v6, vcc
  v_add3_u32 v88, v88, v89, v92
  v_lshlrev_b32 v90, 4, v88
  v_cvt_pk_bf16_f32 v72, v40, v44
  v_cvt_pk_bf16_f32 v73, v41, v45
  v_cvt_pk_bf16_f32 v74, v42, v46
  v_cvt_pk_bf16_f32 v75, v43, v47
  buffer_store_dwordx4 v[72:75], v90, s[8:11], s41 offen sc1
  v_cvt_pk_bf16_f32 v76, v48, v52
  v_cvt_pk_bf16_f32 v77, v49, v53
  v_cvt_pk_bf16_f32 v78, v50, v54
  v_cvt_pk_bf16_f32 v79, v51, v55
  buffer_store_dwordx4 v[76:79], v90, s[8:11], s43 offen sc1
  s_lshl_b32 s42, s40, 5
  s_add_u32 s42, s42, 16
  v_add_u32 v88, s42, v4
  v_mul_u32_u24 v89, 2341, v88
  v_lshrrev_b32 v89, 16, v89
  v_mul_u32_u24 v92, 28, v89
  v_sub_u32 v92, v88, v92
  v_cmp_gt_u32 vcc, 16, v92
  v_mul_u32_u24 v89, 84, v89
  s_nop 0
  v_cndmask_b32 v92, v7, v6, vcc
  v_add3_u32 v88, v88, v89, v92
  v_lshlrev_b32 v91, 4, v88
  v_cvt_pk_bf16_f32 v80, v56, v60
  v_cvt_pk_bf16_f32 v81, v57, v61
  v_cvt_pk_bf16_f32 v82, v58, v62
  v_cvt_pk_bf16_f32 v83, v59, v63
  buffer_store_dwordx4 v[80:83], v91, s[8:11], s41 offen sc1
  v_cvt_pk_bf16_f32 v84, v64, v68
  v_cvt_pk_bf16_f32 v85, v65, v69
  v_cvt_pk_bf16_f32 v86, v66, v70
  v_cvt_pk_bf16_f32 v87, v67, v71
  buffer_store_dwordx4 v[84:87], v91, s[8:11], s43 offen sc1
  s_branch wg_done
wg_done:
  s_lshl_b32 s20, s18, 4
  s_and_b32 s21, s17, 15
  s_add_u32 s20, s20, s21
  s_lshl_b32 s20, s20, 7
  s_cmp_lt_u32 s17, 16
  s_cselect_b32 s21, 16384, 0
  s_add_u32 s20, s20, s21
  s_add_u32 s20, s20, 524288
  s_sub_u32 s21, s35, s34
  s_lshl_b32 s21, s21, 2
  v_mov_b32 v5, s21
  v_mov_b32 v6, 0
  s_waitcnt vmcnt(0) lgkmcnt(0)
  s_barrier
  s_cmp_lg_u32 s16, 0
  s_cbranch_scc1 wg_sg
  s_mov_b64 exec, 1
  buffer_atomic_add v5, v6, s[8:11], s20 offen
  s_mov_b64 exec, -1
wg_sg:
  s_branch wk_loop
wk_srv:
  s_mov_b32 s96, 7
  v_mov_b32 v4, 1
  v_mov_b32 v5, 587392
  v_mov_b32 v6, 160000
  s_barrier
  s_cmp_lg_u32 s16, 0
  s_cbranch_scc1 wk_sve1
  s_mov_b64 exec, 1
  buffer_atomic_add v4, v5, s[8:11], 0 offen sc0
  s_waitcnt vmcnt(0)
  ds_write_b32 v6, v4
  s_waitcnt lgkmcnt(0)
  s_mov_b64 exec, -1
wk_sve1:
  s_barrier
  ds_read_b32 v4, v6
  s_waitcnt lgkmcnt(0)
  v_readfirstlane_b32 s3, v4
  v_and_b32 v1, 63, v0
  v_lshlrev_b32 v2, 4, v1
  v_lshrrev_b32 v3, 4, v1
  v_and_b32 v4, 15, v1
  v_mov_b32 v250, 0
  s_cmp_ge_u32 s3, 32
  s_cbranch_scc1 wk_ask
  s_and_b32 s18, s3, 15
  s_lshr_b32 s19, s3, 4
  s_and_b32 s19, s19, 1
  s_mul_i32 s20, s18, 401408
  s_mul_i32 s21, s16, 100352
  s_add_u32 s20, s20, s21
  s_add_u32 s20, s20, 39976960
  s_add_u32 s22, s20, 0
  buffer_load_dwordx4 a[0:3], v2, s[8:11], s22 offen offset:0 sc1
  buffer_load_dwordx4 a[4:7], v2, s[8:11], s22 offen offset:1024 sc1
  buffer_load_dwordx4 a[8:11], v2, s[8:11], s22 offen offset:2048 sc1
  buffer_load_dwordx4 a[12:15], v2, s[8:11], s22 offen offset:3072 sc1
  s_add_u32 s22, s20, 4096
  buffer_load_dwordx4 a[16:19], v2, s[8:11], s22 offen offset:0 sc1
  buffer_load_dwordx4 a[20:23], v2, s[8:11], s22 offen offset:1024 sc1
  buffer_load_dwordx4 a[24:27], v2, s[8:11], s22 offen offset:2048 sc1
  buffer_load_dwordx4 a[28:31], v2, s[8:11], s22 offen offset:3072 sc1
  s_add_u32 s22, s20, 8192
  buffer_load_dwordx4 a[32:35], v2, s[8:11], s22 offen offset:0 sc1
  buffer_load_dwordx4 a[36:39], v2, s[8:11], s22 offen offset:1024 sc1
  s_waitcnt vmcnt(8)
  buffer_load_dwordx4 a[40:43], v2, s[8:11], s22 offen offset:2048 sc1
  buffer_load_dwordx4 a[44:47], v2, s[8:11], s22 offen offset:3072 sc1
  s_waitcnt vmcnt(8)
  s_add_u32 s22, s20, 12288
  buffer_load_dwordx4 a[48:51], v2, s[8:11], s22 offen offset:0 sc1
  buffer_load_dwordx4 a[52:55], v2, s[8:11], s22 offen offset:1024 sc1
  s_waitcnt vmcnt(8)
  buffer_load_dwordx4 a[56:59], v2, s[8:11], s22 offen offset:2048 sc1
  buffer_load_dwordx4 a[60:63], v2, s[8:11], s22 offen offset:3072 sc1
  s_waitcnt vmcnt(8)
  s_add_u32 s22, s20, 16384
  buffer_load_dwordx4 a[64:67], v2, s[8:11], s22 offen offset:0 sc1
  buffer_load_dwordx4 a[68:71], v2, s[8:11], s22 offen offset:1024 sc1
  s_waitcnt vmcnt(8)
  buffer_load_dwordx4 a[72:75], v2, s[8:11], s22 offen offset:2048 sc1
  buffer_load_dwordx4 a[76:79], v2, s[8:11], s22 offen offset:3072 sc1
  s_waitcnt vmcnt(8)
  s_add_u32 s22, s20, 20480
  buffer_load_dwordx4 a[80:83], v2, s[8:11], s22 offen offset:0 sc1
  buffer_load_dwordx4 a[84:87], v2, s[8:11], s22 offen offset:1024 sc1
  s_waitcnt vmcnt(8)
  buffer_load_dwordx4 a[88:91], v2, s[8:11], s22 offen offset:2048 sc1
  buffer_load_dwordx4 a[92:95], v2, s[8:11], s22 offen offset:3072 sc1
  s_waitcnt vmcnt(8)
  s_add_u32 s22, s20, 24576
  buffer_load_dwordx4 a[96:99], v2, s[8:11], s22 offen offset:0 sc1
  buffer_load_dwordx4 a[100:103], v2, s[8:11], s22 offen offset:1024 sc1
  s_waitcnt vmcnt(8)
  buffer_load_dwordx4 a[104:107], v2, s[8:11], s22 offen offset:2048 sc1
  buffer_load_dwordx4 a[108:111], v2, s[8:11], s22 offen offset:3072 sc1
  s_waitcnt vmcnt(8)
  s_add_u32 s22, s20, 28672
  buffer_load_dwordx4 a[112:115], v2, s[8:11], s22 offen offset:0 sc1
  buffer_load_dwordx4 a[116:119], v2, s[8:11], s22 offen offset:1024 sc1
  s_waitcnt vmcnt(8)
  buffer_load_dwordx4 a[120:123], v2, s[8:11], s22 offen offset:2048 sc1
  buffer_load_dwordx4 a[124:127], v2, s[8:11], s22 offen offset:3072 sc1
  s_waitcnt vmcnt(8)
  s_add_u32 s22, s20, 32768
  buffer_load_dwordx4 a[128:131], v2, s[8:11], s22 offen offset:0 sc1
  buffer_load_dwordx4 a[132:135], v2, s[8:11], s22 offen offset:1024 sc1
  s_waitcnt vmcnt(8)
  buffer_load_dwordx4 a[136:139], v2, s[8:11], s22 offen offset:2048 sc1
  buffer_load_dwordx4 a[140:143], v2, s[8:11], s22 offen offset:3072 sc1
  s_waitcnt vmcnt(8)
  s_add_u32 s22, s20, 36864
  buffer_load_dwordx4 a[144:147], v2, s[8:11], s22 offen offset:0 sc1
  buffer_load_dwordx4 a[148:151], v2, s[8:11], s22 offen offset:1024 sc1
  s_waitcnt vmcnt(8)
  buffer_load_dwordx4 a[152:155], v2, s[8:11], s22 offen offset:2048 sc1
  buffer_load_dwordx4 a[156:159], v2, s[8:11], s22 offen offset:3072 sc1
  s_waitcnt vmcnt(8)
  s_add_u32 s22, s20, 40960
  buffer_load_dwordx4 a[160:163], v2, s[8:11], s22 offen offset:0 sc1
  buffer_load_dwordx4 a[164:167], v2, s[8:11], s22 offen offset:1024 sc1
  s_waitcnt vmcnt(8)
  buffer_load_dwordx4 a[168:171], v2, s[8:11], s22 offen offset:2048 sc1
  buffer_load_dwordx4 a[172:175], v2, s[8:11], s22 offen offset:3072 sc1
  s_waitcnt vmcnt(8)
  s_add_u32 s22, s20, 45056
  buffer_load_dwordx4 a[176:179], v2, s[8:11], s22 offen offset:0 sc1
  buffer_load_dwordx4 a[180:183], v2, s[8:11], s22 offen offset:1024 sc1
  s_waitcnt vmcnt(8)
  buffer_load_dwordx4 a[184:187], v2, s[8:11], s22 offen offset:2048 sc1
  buffer_load_dwordx4 a[188:191], v2, s[8:11], s22 offen offset:3072 sc1
  s_waitcnt vmcnt(8)
  s_add_u32 s22, s20, 49152
  buffer_load_dwordx4 a[192:195], v2, s[8:11], s22 offen offset:0 sc1
  buffer_load_dwordx4 a[196:199], v2, s[8:11], s22 offen offset:1024 sc1
  s_waitcnt vmcnt(8)
  buffer_load_dwordx4 a[200:203], v2, s[8:11], s22 offen offset:2048 sc1
  buffer_load_dwordx4 a[204:207], v2, s[8:11], s22 offen offset:3072 sc1
  s_waitcnt vmcnt(8)
  s_add_u32 s22, s20, 53248
  buffer_load_dwordx4 a[208:211], v2, s[8:11], s22 offen offset:0 sc1
  buffer_load_dwordx4 a[212:215], v2, s[8:11], s22 offen offset:1024 sc1
  s_waitcnt vmcnt(8)
  buffer_load_dwordx4 a[216:219], v2, s[8:11], s22 offen offset:2048 sc1
  buffer_load_dwordx4 a[220:223], v2, s[8:11], s22 offen offset:3072 sc1
  s_waitcnt vmcnt(8)
  s_add_u32 s22, s20, 57344
  buffer_load_dwordx4 a[224:227], v2, s[8:11], s22 offen offset:0 sc1
  buffer_load_dwordx4 a[228:231], v2, s[8:11], s22 offen offset:1024 sc1
  s_waitcnt vmcnt(8)
  buffer_load_dwordx4 a[232:235], v2, s[8:11], s22 offen offset:2048 sc1
  buffer_load_dwordx4 a[236:239], v2, s[8:11], s22 offen offset:3072 sc1
  s_waitcnt vmcnt(8)
  s_add_u32 s22, s20, 61440
  buffer_load_dwordx4 a[240:243], v2, s[8:11], s22 offen offset:0 sc1
  buffer_load_dwordx4 a[244:247], v2, s[8:11], s22 offen offset:1024 sc1
  s_waitcnt vmcnt(8)
  buffer_load_dwordx4 a[248:251], v2, s[8:11], s22 offen offset:2048 sc1
  buffer_load_dwordx4 a[252:255], v2, s[8:11], s22 offen offset:3072 sc1
  s_waitcnt vmcnt(8)
  s_add_u32 s22, s20, 65536
  buffer_load_dwordx4 v[120:123], v2, s[8:11], s22 offen offset:0 sc1
  buffer_load_dwordx4 v[124:127], v2, s[8:11], s22 offen offset:1024 sc1
  s_waitcnt vmcnt(8)
  buffer_load_dwordx4 v[128:131], v2, s[8:11], s22 offen offset:2048 sc1
  buffer_load_dwordx4 v[132:135], v2, s[8:11], s22 offen offset:3072 sc1
  s_waitcnt vmcnt(8)
  s_add_u32 s22, s20, 69632
  buffer_load_dwordx4 v[136:139], v2, s[8:11], s22 offen offset:0 sc1
  buffer_load_dwordx4 v[140:143], v2, s[8:11], s22 offen offset:1024 sc1
  s_waitcnt vmcnt(8)
  buffer_load_dwordx4 v[144:147], v2, s[8:11], s22 offen offset:2048 sc1
  buffer_load_dwordx4 v[148:151], v2, s[8:11], s22 offen offset:3072 sc1
  s_waitcnt vmcnt(8)
  s_add_u32 s22, s20, 73728
  buffer_load_dwordx4 v[152:155], v2, s[8:11], s22 offen offset:0 sc1
  buffer_load_dwordx4 v[156:159], v2, s[8:11], s22 offen offset:1024 sc1
  s_waitcnt vmcnt(8)
  buffer_load_dwordx4 v[160:163], v2, s[8:11], s22 offen offset:2048 sc1
  buffer_load_dwordx4 v[164:167], v2, s[8:11], s22 offen offset:3072 sc1
  s_waitcnt vmcnt(8)
  s_add_u32 s22, s20, 77824
  buffer_load_dwordx4 v[168:171], v2, s[8:11], s22 offen offset:0 sc1
  buffer_load_dwordx4 v[172:175], v2, s[8:11], s22 offen offset:1024 sc1
  s_waitcnt vmcnt(8)
  buffer_load_dwordx4 v[176:179], v2, s[8:11], s22 offen offset:2048 sc1
  buffer_load_dwordx4 v[180:183], v2, s[8:11], s22 offen offset:3072 sc1
  s_waitcnt vmcnt(8)
  s_add_u32 s22, s20, 81920
  buffer_load_dwordx4 v[184:187], v2, s[8:11], s22 offen offset:0 sc1
  buffer_load_dwordx4 v[188:191], v2, s[8:11], s22 offen offset:1024 sc1
  s_waitcnt vmcnt(8)
  buffer_load_dwordx4 v[192:195], v2, s[8:11], s22 offen offset:2048 sc1
  buffer_load_dwordx4 v[196:199], v2, s[8:11], s22 offen offset:3072 sc1
  s_waitcnt vmcnt(8)
  s_add_u32 s22, s20, 86016
  buffer_load_dwordx4 v[200:203], v2, s[8:11], s22 offen offset:0 sc1
  buffer_load_dwordx4 v[204:207], v2, s[8:11], s22 offen offset:1024 sc1
  s_waitcnt vmcnt(8)
  buffer_load_dwordx4 v[208:211], v2, s[8:11], s22 offen offset:2048 sc1
  buffer_load_dwordx4 v[212:215], v2, s[8:11], s22 offen offset:3072 sc1
  s_waitcnt vmcnt(8)
  s_add_u32 s22, s20, 90112
  buffer_load_dwordx4 v[216:219], v2, s[8:11], s22 offen offset:0 sc1
  buffer_load_dwordx4 v[220:223], v2, s[8:11], s22 offen offset:1024 sc1
  s_waitcnt vmcnt(8)
  buffer_load_dwordx4 v[224:227], v2, s[8:11], s22 offen offset:2048 sc1
  buffer_load_dwordx4 v[228:231], v2, s[8:11], s22 offen offset:3072 sc1
  s_waitcnt vmcnt(8)
  s_add_u32 s22, s20, 94208
  buffer_load_dwordx4 v[232:235], v2, s[8:11], s22 offen offset:0 sc1
  buffer_load_dwordx4 v[236:239], v2, s[8:11], s22 offen offset:1024 sc1
  s_waitcnt vmcnt(8)
  buffer_load_dwordx4 v[240:243], v2, s[8:11], s22 offen offset:2048 sc1
  buffer_load_dwordx4 v[244:247], v2, s[8:11], s22 offen offset:3072 sc1
  s_waitcnt vmcnt(8)
  s_add_u32 s22, s20, 98304
  buffer_load_dwordx4 v[248:251], v2, s[8:11], s22 offen offset:0 sc1
  buffer_load_dwordx4 v[252:255], v2, s[8:11], s22 offen offset:1024 sc1
  s_waitcnt vmcnt(8)
  v_mov_b32 v5, 0x4444
  v_mov_b32 v6, 0xeeee
  v_cmp_lt_u32 vcc, 7, v4
  s_nop 1
  v_cndmask_b32 v5, v5, v6, vcc
  s_lshl_b32 s23, s16, 11
  v_lshrrev_b32 v80, 1, v3
  v_and_b32 v81, 1, v3
  v_add_u32 v82, 0, v80
  v_lshl_add_u32 v82, v82, 4, v4
  v_mul_u32_u24 v83, 2341, v82
  v_lshrrev_b32 v83, 16, v83
  v_mul_u32_u24 v84, 28, v83
  v_sub_u32 v84, v82, v84
  v_lshrrev_b32 v85, 4, v84
  v_and_b32 v84, 15, v84
  v_lshlrev_b32 v86, 10, v85
  v_lshl_add_u32 v86, v83, 8, v86
  v_lshl_add_u32 v86, v84, 4, v86
  v_lshl_add_u32 v86, v81, 3, v86
  v_add_u32 v72, s23, v86
  v_add_u32 v82, 2, v80
  v_lshl_add_u32 v82, v82, 4, v4
  v_mul_u32_u24 v83, 2341, v82
  v_lshrrev_b32 v83, 16, v83
  v_mul_u32_u24 v84, 28, v83
  v_sub_u32 v84, v82, v84
  v_lshrrev_b32 v85, 4, v84
  v_and_b32 v84, 15, v84
  v_lshlrev_b32 v86, 10, v85
  v_lshl_add_u32 v86, v83, 8, v86
  v_lshl_add_u32 v86, v84, 4, v86
  v_lshl_add_u32 v86, v81, 3, v86
  v_add_u32 v73, s23, v86
  v_add_u32 v82, 4, v80
  v_lshl_add_u32 v82, v82, 4, v4
  v_mul_u32_u24 v83, 2341, v82
  v_lshrrev_b32 v83, 16, v83
  v_mul_u32_u24 v84, 28, v83
  v_sub_u32 v84, v82, v84
  v_lshrrev_b32 v85, 4, v84
  v_and_b32 v84, 15, v84
  v_lshlrev_b32 v86, 10, v85
  v_lshl_add_u32 v86, v83, 8, v86
  v_lshl_add_u32 v86, v84, 4, v86
  v_lshl_add_u32 v86, v81, 3, v86
  v_add_u32 v74, s23, v86
  v_mov_b32 v82, 6
  v_lshl_add_u32 v82, v82, 4, v4
  v_mul_u32_u24 v83, 2341, v82
  v_lshrrev_b32 v83, 16, v83
  v_mul_u32_u24 v84, 28, v83
  v_sub_u32 v84, v82, v84
  v_lshrrev_b32 v85, 4, v84
  v_and_b32 v84, 15, v84
  v_lshlrev_b32 v86, 10, v85
  v_lshl_add_u32 v86, v83, 8, v86
  v_lshl_add_u32 v86, v84, 4, v86
  v_lshl_add_u32 v86, v81, 3, v86
  v_add_u32 v75, s23, v86
  v_add_u32 v76, s23, v2
  s_mul_i32 s27, s18, 448
  v_mov_b32 v77, s27
  v_mov_b32 v78, 1
  s_mov_b32 s17, s19
  s_mul_i32 s24, s19, 7168
  s_add_u32 s24, s24, 65536
  s_mul_i32 s25, s18, 65
  s_add_u32 s25, s25, s19
  s_lshl_b32 s25, s25, 13
  s_add_u32 s25, s25, s23
  s_add_u32 s25, s25, 77602816
  s_lshl_b32 s26, s18, 6
  s_add_u32 s26, s26, s19
  s_lshl_b32 s26, s26, 4
  s_lshl_b32 s27, s16, 2
  s_add_u32 s26, s26, s27
  s_add_u32 s26, s26, 565248
  v_mov_b32 v88, 0
  v_mov_b32 v89, 0
  v_mov_b32 v90, 0
  v_mov_b32 v91, 0
  v_mov_b32 v92, -1
  v_mov_b32 v93, -1
  v_mov_b32 v94, -1
  v_mov_b32 v95, -1
  ds_write_b128 v76, v[88:91]
  ds_write_b128 v76, v[88:91] offset:1024
  s_mov_b32 s28, s25
  s_mov_b32 s29, 0
ws_arm:
  buffer_store_dwordx4 v[92:95], v2, s[8:11], s28 offen sc1
  buffer_store_dwordx4 v[92:95], v2, s[8:11], s28 offen offset:1024 sc1
  s_waitcnt vmcnt(8)
  s_add_u32 s28, s28, 16384
  s_add_u32 s29, s29, 1
  s_cmp_lt_u32 s29, 31
  s_cbranch_scc1 ws_arm
  s_waitcnt vmcnt(0)
  s_mov_b64 exec, 1
  buffer_store_dword v78, v2, s[8:11], s26 offen sc1
  s_mov_b64 exec, -1
ws_loop:
  v_mov_b32 v36, 0
  v_mov_b32 v37, 0
  v_mov_b32 v38, 0
  v_mov_b32 v39, 0
  v_mov_b32 v40, 0
  v_mov_b32 v41, 0
  v_mov_b32 v42, 0
  v_mov_b32 v43, 0
  v_mov_b32 v44, 0
  v_mov_b32 v45, 0
  v_mov_b32 v46, 0
  v_mov_b32 v47, 0
  v_mov_b32 v48, 0
  v_mov_b32 v49, 0
  v_mov_b32 v50, 0
  v_mov_b32 v51, 0
  v_mov_b32 v52, 0
  v_mov_b32 v53, 0
  v_mov_b32 v54, 0
  v_mov_b32 v55, 0
  v_mov_b32 v56, 0
  v_mov_b32 v57, 0
  v_mov_b32 v58, 0
  v_mov_b32 v59, 0
  v_mov_b32 v60, 0
  v_mov_b32 v61, 0
  v_mov_b32 v62, 0
  v_mov_b32 v63, 0
  s_mov_b32 s30, 0
  s_branch ws_fl
ws_pm:
  s_cmp_ge_u32 s17, 64
  s_cbranch_scc1 ws_fl
  buffer_load_dword v79, v77, s[8:11], s24 offen sc1
  s_waitcnt vmcnt(0)
  v_cmp_eq_u32 vcc, -1, v79
  s_cbranch_vccnz ws_pr
ws_fl:
  s_add_u32 s22, s24, 4096
  buffer_load_dwordx4 v[8:11], v2, s[8:11], s24 offen offset:0 sc1
  buffer_load_dwordx4 v[12:15], v2, s[8:11], s24 offen offset:1024 sc1
  buffer_load_dwordx4 v[16:19], v2, s[8:11], s24 offen offset:2048 sc1
  buffer_load_dwordx4 v[20:23], v2, s[8:11], s24 offen offset:3072 sc1
  buffer_load_dwordx4 v[24:27], v2, s[8:11], s22 offen offset:0 sc1
  buffer_load_dwordx4 v[28:31], v2, s[8:11], s22 offen offset:1024 sc1
  buffer_load_dwordx4 v[32:35], v2, s[8:11], s22 offen offset:2048 sc1
  s_waitcnt vmcnt(0)
  v_max_u32 v79, v8, v9
  v_max3_u32 v79, v79, v10, v11
  v_max3_u32 v79, v79, v12, v13
  v_max3_u32 v79, v79, v14, v15
  v_max3_u32 v79, v79, v16, v17
  v_max3_u32 v79, v79, v18, v19
  v_max3_u32 v79, v79, v20, v21
  v_max3_u32 v79, v79, v22, v23
  v_max3_u32 v79, v79, v24, v25
  v_max3_u32 v79, v79, v26, v27
  v_max3_u32 v79, v79, v28, v29
  v_max3_u32 v79, v79, v30, v31
  v_max3_u32 v79, v79, v32, v33
  v_max3_u32 v79, v79, v34, v35
  v_cmp_eq_u32 vcc, -1, v79
  s_cbranch_vccz ws_pk
ws_pr:
  s_sleep 20
  s_add_u32 s30, s30, 1
  s_cmp_lt_u32 s30, 2000000
  s_cbranch_scc1 ws_pm
  s_branch cA_abort
ws_pk:
  v_smfmac_f32_16x16x64_bf16 v[36:39], v[8:11], a[0:7], v5
  v_smfmac_f32_16x16x64_bf16 v[36:39], v[12:15], a[8:15], v5
  v_smfmac_f32_16x16x64_bf16 v[36:39], v[16:19], a[16:23], v5
  v_smfmac_f32_16x16x64_bf16 v[36:39], v[20:23], a[24:31], v5
  v_smfmac_f32_16x16x64_bf16 v[36:39], v[24:27], a[32:39], v5
  v_smfmac_f32_16x16x64_bf16 v[36:39], v[28:31], a[40:47], v5
  v_smfmac_f32_16x16x64_bf16 v[36:39], v[32:35], a[48:55], v5
  v_smfmac_f32_16x16x64_bf16 v[40:43], v[8:11], a[56:63], v5
  v_smfmac_f32_16x16x64_bf16 v[40:43], v[12:15], a[64:71], v5
  v_smfmac_f32_16x16x64_bf16 v[40:43], v[16:19], a[72:79], v5
  v_smfmac_f32_16x16x64_bf16 v[40:43], v[20:23], a[80:87], v5
  v_smfmac_f32_16x16x64_bf16 v[40:43], v[24:27], a[88:95], v5
  v_smfmac_f32_16x16x64_bf16 v[40:43], v[28:31], a[96:103], v5
  v_smfmac_f32_16x16x64_bf16 v[40:43], v[32:35], a[104:111], v5
  v_smfmac_f32_16x16x64_bf16 v[44:47], v[8:11], a[112:119], v5
  v_smfmac_f32_16x16x64_bf16 v[44:47], v[12:15], a[120:127], v5
  v_smfmac_f32_16x16x64_bf16 v[44:47], v[16:19], a[128:135], v5
  v_smfmac_f32_16x16x64_bf16 v[44:47], v[20:23], a[136:143], v5
  v_smfmac_f32_16x16x64_bf16 v[44:47], v[24:27], a[144:151], v5
  v_smfmac_f32_16x16x64_bf16 v[44:47], v[28:31], a[152:159], v5
  v_smfmac_f32_16x16x64_bf16 v[44:47], v[32:35], a[160:167], v5
  v_smfmac_f32_16x16x64_bf16 v[48:51], v[8:11], a[168:175], v5
  v_smfmac_f32_16x16x64_bf16 v[48:51], v[12:15], a[176:183], v5
  v_smfmac_f32_16x16x64_bf16 v[48:51], v[16:19], a[184:191], v5
  v_smfmac_f32_16x16x64_bf16 v[48:51], v[20:23], a[192:199], v5
  v_smfmac_f32_16x16x64_bf16 v[48:51], v[24:27], a[200:207], v5
  v_smfmac_f32_16x16x64_bf16 v[48:51], v[28:31], a[208:215], v5
  v_smfmac_f32_16x16x64_bf16 v[48:51], v[32:35], a[216:223], v5
  v_smfmac_f32_16x16x64_bf16 v[52:55], v[8:11], a[224:231], v5
  v_smfmac_f32_16x16x64_bf16 v[52:55], v[12:15], a[232:239], v5
  v_smfmac_f32_16x16x64_bf16 v[52:55], v[16:19], a[240:247], v5
  v_smfmac_f32_16x16x64_bf16 v[52:55], v[20:23], a[248:255], v5
  v_smfmac_f32_16x16x64_bf16 v[52:55], v[24:27], v[120:127], v5
  v_smfmac_f32_16x16x64_bf16 v[52:55], v[28:31], v[128:135], v5
  v_smfmac_f32_16x16x64_bf16 v[52:55], v[32:35], v[136:143], v5
  v_smfmac_f32_16x16x64_bf16 v[56:59], v[8:11], v[144:151], v5
  v_smfmac_f32_16x16x64_bf16 v[56:59], v[12:15], v[152:159], v5
  v_smfmac_f32_16x16x64_bf16 v[56:59], v[16:19], v[160:167], v5
  v_smfmac_f32_16x16x64_bf16 v[56:59], v[20:23], v[168:175], v5
  v_smfmac_f32_16x16x64_bf16 v[56:59], v[24:27], v[176:183], v5
  v_smfmac_f32_16x16x64_bf16 v[56:59], v[28:31], v[184:191], v5
  v_smfmac_f32_16x16x64_bf16 v[56:59], v[32:35], v[192:199], v5
  v_smfmac_f32_16x16x64_bf16 v[60:63], v[8:11], v[200:207], v5
  v_smfmac_f32_16x16x64_bf16 v[60:63], v[12:15], v[208:215], v5
  v_smfmac_f32_16x16x64_bf16 v[60:63], v[16:19], v[216:223], v5
  v_smfmac_f32_16x16x64_bf16 v[60:63], v[20:23], v[224:231], v5
  v_smfmac_f32_16x16x64_bf16 v[60:63], v[24:27], v[232:239], v5
  v_smfmac_f32_16x16x64_bf16 v[60:63], v[28:31], v[240:247], v5
  v_smfmac_f32_16x16x64_bf16 v[60:63], v[32:35], v[248:255], v5
  v_permlane32_swap_b32 v36, v40
  v_permlane32_swap_b32 v37, v41
  v_permlane32_swap_b32 v38, v42
  v_permlane32_swap_b32 v39, v43
  v_add_f32 v36, v36, v40
  v_add_f32 v37, v37, v41
  v_add_f32 v38, v38, v42
  v_add_f32 v39, v39, v43
  v_cvt_pk_bf16_f32 v40, v36, v37
  v_cvt_pk_bf16_f32 v41, v38, v39
  v_min_u32 v40, -2, v40
  v_min_u32 v41, -2, v41
  ds_write_b64 v72, v[40:41]
  v_permlane32_swap_b32 v44, v48
  v_permlane32_swap_b32 v45, v49
  v_permlane32_swap_b32 v46, v50
  v_permlane32_swap_b32 v47, v51
  v_add_f32 v44, v44, v48
  v_add_f32 v45, v45, v49
  v_add_f32 v46, v46, v50
  v_add_f32 v47, v47, v51
  v_cvt_pk_bf16_f32 v48, v44, v45
  v_cvt_pk_bf16_f32 v49, v46, v47
  v_min_u32 v48, -2, v48
  v_min_u32 v49, -2, v49
  ds_write_b64 v73, v[48:49]
  v_permlane32_swap_b32 v52, v56
  v_permlane32_swap_b32 v53, v57
  v_permlane32_swap_b32 v54, v58
  v_permlane32_swap_b32 v55, v59
  v_add_f32 v52, v52, v56
  v_add_f32 v53, v53, v57
  v_add_f32 v54, v54, v58
  v_add_f32 v55, v55, v59
  v_cvt_pk_bf16_f32 v56, v52, v53
  v_cvt_pk_bf16_f32 v57, v54, v55
  v_min_u32 v56, -2, v56
  v_min_u32 v57, -2, v57
  ds_write_b64 v74, v[56:57]
  v_mov_b32 v64, v60
  v_mov_b32 v65, v61
  v_mov_b32 v66, v62
  v_mov_b32 v67, v63
  v_permlane32_swap_b32 v60, v64
  v_permlane32_swap_b32 v61, v65
  v_permlane32_swap_b32 v62, v66
  v_permlane32_swap_b32 v63, v67
  v_add_f32 v60, v60, v64
  v_add_f32 v61, v61, v65
  v_add_f32 v62, v62, v66
  v_add_f32 v63, v63, v67
  v_cvt_pk_bf16_f32 v64, v60, v61
  v_cvt_pk_bf16_f32 v65, v62, v63
  v_min_u32 v64, -2, v64
  v_min_u32 v65, -2, v65
  ds_write_b64 v75, v[64:65]
  s_waitcnt lgkmcnt(0)
  ds_read_b128 v[64:67], v76
  ds_read_b128 v[68:71], v76 offset:1024
  s_waitcnt lgkmcnt(0)
  buffer_store_dwordx4 v[64:67], v2, s[8:11], s25 offen sc1
  buffer_store_dwordx4 v[68:71], v2, s[8:11], s25 offen offset:1024 sc1
  s_add_u32 s24, s24, 14336
  s_add_u32 s25, s25, 16384
  s_add_u32 s17, s17, 2
  s_cmp_lt_u32 s17, 62
  s_cbranch_scc1 ws_loop
  v_mov_b32 v250, 0
  s_branch wk_loop
wk_s4d:
  s_sub_u32 s3, s3, 640
  s_getreg_b32 s33, hwreg(HW_REG_XCC_ID)
  s_sub_u32 s33, s33, 4
  s_and_b32 s33, s33, 7
  s_min_u32 s33, s33, 6
  s_mov_b32 s35, 6
wk_s4c:
  s_lshl_b32 s34, s33, 7
  s_add_u32 s34, s34, 588416
  v_mov_b32 v4, 1
  v_mov_b32 v5, s34
  v_mov_b32 v6, 160000
  s_barrier
  s_cmp_lg_u32 s16, 0
  s_cbranch_scc1 wk_s4e1
  s_mov_b64 exec, 1
  buffer_atomic_add v4, v5, s[8:11], 0 offen sc0
  s_waitcnt vmcnt(0)
  ds_write_b32 v6, v4
  s_waitcnt lgkmcnt(0)
  s_mov_b64 exec, -1
wk_s4e1:
  s_barrier
  ds_read_b32 v4, v6
  s_waitcnt lgkmcnt(0)
  v_readfirstlane_b32 s3, v4
  s_cmp_lt_u32 s3, 16
  s_cbranch_scc1 wk_s4g
  s_mov_b32 s33, s35
  s_sub_u32 s35, s35, 1
  s_max_i32 s35, s35, 0
  s_branch wk_s4c
wk_s4g:
  s_lshl_b32 s33, s33, 4
  s_add_u32 s3, s3, s33
  s_load_dwordx8 s[40:47], s[0:1], 0
  s_load_dwordx4 s[48:51], s[0:1], 32
  s_load_dwordx2 s[52:53], s[0:1], 48
  s_load_dwordx2 s[54:55], s[0:1], 112
  v_lshrrev_b32 v1, 6, v0
  s_nop 0
  v_readfirstlane_b32 s16, v1
  v_and_b32 v1, 63, v0
  v_lshrrev_b32 v3, 4, v1
  v_and_b32 v4, 15, v1
  s_mul_i32 s17, s16, 24576
  s_waitcnt lgkmcnt(0)
  s_mov_b32 s60, s40
  s_and_b32 s61, s41, 0xffff
  s_mov_b32 s62, 1835008
  s_mov_b32 s63, 0x20000
  s_mov_b32 s64, s42
  s_and_b32 s65, s43, 0xffff
  s_mov_b32 s66, 229376
  s_mov_b32 s67, 0x20000
  s_mov_b32 s68, s44
  s_and_b32 s69, s45, 0xffff
  s_mov_b32 s70, 229376
  s_mov_b32 s71, 0x20000
  s_mov_b32 s72, s46
  s_and_b32 s73, s47, 0xffff
  s_mov_b32 s74, 229376
  s_mov_b32 s75, 0x20000
  s_mov_b32 s76, s48
  s_and_b32 s77, s49, 0xffff
  s_mov_b32 s78, 229376
  s_mov_b32 s79, 0x20000
  s_mov_b32 s80, s50
  s_and_b32 s81, s51, 0xffff
  s_mov_b32 s82, 896
  s_mov_b32 s83, 0x20000
  s_mov_b32 s84, s52
  s_and_b32 s85, s53, 0xffff
  s_mov_b32 s86, 896
  s_mov_b32 s87, 0x20000
  s_mov_b32 s88, s54
  s_and_b32 s89, s55, 0xffff
  s_mov_b32 s90, 3670016
  s_mov_b32 s91, 0x20000
  v_lshlrev_b32 v5, 5, v1
  v_sub_u32 v5, 2047, v5
  s_add_u32 s18, s17, 13056
  v_subrev_u32 v6, 0, v5
  v_max_i32 v7, 0, v6
  v_cvt_f32_u32 v7, v7
  v_cvt_pk_bf16_f32 v8, v7, v7
  v_and_b32 v7, 0xffff0000, v8
  v_lshrrev_b32 v8, 23, v7
  v_subrev_u32 v8, 134, v8
  v_max_i32 v8, 0, v8
  v_cvt_u32_f32 v7, v7
  v_lshrrev_b32 v7, v8, v7
  v_lshl_add_u32 v7, v8, 8, v7
  v_lshl_add_u32 v200, v7, 2, s18
  v_subrev_u32 v6, 1, v5
  v_max_i32 v7, 0, v6
  v_cvt_f32_u32 v7, v7
  v_cvt_pk_bf16_f32 v8, v7, v7
  v_and_b32 v7, 0xffff0000, v8
  v_lshrrev_b32 v8, 23, v7
  v_subrev_u32 v8, 134, v8
  v_max_i32 v8, 0, v8
  v_cvt_u32_f32 v7, v7
  v_lshrrev_b32 v7, v8, v7
  v_lshl_add_u32 v7, v8, 8, v7
  v_lshl_add_u32 v201, v7, 2, s18
  v_subrev_u32 v6, 2, v5
  v_max_i32 v7, 0, v6
  v_cvt_f32_u32 v7, v7
  v_cvt_pk_bf16_f32 v8, v7, v7
  v_and_b32 v7, 0xffff0000, v8
  v_lshrrev_b32 v8, 23, v7
  v_subrev_u32 v8, 134, v8
  v_max_i32 v8, 0, v8
  v_cvt_u32_f32 v7, v7
  v_lshrrev_b32 v7, v8, v7
  v_lshl_add_u32 v7, v8, 8, v7
  v_lshl_add_u32 v202, v7, 2, s18
  v_subrev_u32 v6, 3, v5
  v_max_i32 v7, 0, v6
  v_cvt_f32_u32 v7, v7
  v_cvt_pk_bf16_f32 v8, v7, v7
  v_and_b32 v7, 0xffff0000, v8
  v_lshrrev_b32 v8, 23, v7
  v_subrev_u32 v8, 134, v8
  v_max_i32 v8, 0, v8
  v_cvt_u32_f32 v7, v7
  v_lshrrev_b32 v7, v8, v7
  v_lshl_add_u32 v7, v8, 8, v7
  v_lshl_add_u32 v203, v7, 2, s18
  v_subrev_u32 v6, 4, v5
  v_max_i32 v7, 0, v6
  v_cvt_f32_u32 v7, v7
  v_cvt_pk_bf16_f32 v8, v7, v7
  v_and_b32 v7, 0xffff0000, v8
  v_lshrrev_b32 v8, 23, v7
  v_subrev_u32 v8, 134, v8
  v_max_i32 v8, 0, v8
  v_cvt_u32_f32 v7, v7
  v_lshrrev_b32 v7, v8, v7
  v_lshl_add_u32 v7, v8, 8, v7
  v_lshl_add_u32 v204, v7, 2, s18
  v_subrev_u32 v6, 5, v5
  v_max_i32 v7, 0, v6
  v_cvt_f32_u32 v7, v7
  v_cvt_pk_bf16_f32 v8, v7, v7
  v_and_b32 v7, 0xffff0000, v8
  v_lshrrev_b32 v8, 23, v7
  v_subrev_u32 v8, 134, v8
  v_max_i32 v8, 0, v8
  v_cvt_u32_f32 v7, v7
  v_lshrrev_b32 v7, v8, v7
  v_lshl_add_u32 v7, v8, 8, v7
  v_lshl_add_u32 v205, v7, 2, s18
  v_subrev_u32 v6, 6, v5
  v_max_i32 v7, 0, v6
  v_cvt_f32_u32 v7, v7
  v_cvt_pk_bf16_f32 v8, v7, v7
  v_and_b32 v7, 0xffff0000, v8
  v_lshrrev_b32 v8, 23, v7
  v_subrev_u32 v8, 134, v8
  v_max_i32 v8, 0, v8
  v_cvt_u32_f32 v7, v7
  v_lshrrev_b32 v7, v8, v7
  v_lshl_add_u32 v7, v8, 8, v7
  v_lshl_add_u32 v206, v7, 2, s18
  v_subrev_u32 v6, 7, v5
  v_max_i32 v7, 0, v6
  v_cvt_f32_u32 v7, v7
  v_cvt_pk_bf16_f32 v8, v7, v7
  v_and_b32 v7, 0xffff0000, v8
  v_lshrrev_b32 v8, 23, v7
  v_subrev_u32 v8, 134, v8
  v_max_i32 v8, 0, v8
  v_cvt_u32_f32 v7, v7
  v_lshrrev_b32 v7, v8, v7
  v_lshl_add_u32 v7, v8, 8, v7
  v_lshl_add_u32 v207, v7, 2, s18
  v_subrev_u32 v6, 8, v5
  v_max_i32 v7, 0, v6
  v_cvt_f32_u32 v7, v7
  v_cvt_pk_bf16_f32 v8, v7, v7
  v_and_b32 v7, 0xffff0000, v8
  v_lshrrev_b32 v8, 23, v7
  v_subrev_u32 v8, 134, v8
  v_max_i32 v8, 0, v8
  v_cvt_u32_f32 v7, v7
  v_lshrrev_b32 v7, v8, v7
  v_lshl_add_u32 v7, v8, 8, v7
  v_lshl_add_u32 v208, v7, 2, s18
  v_subrev_u32 v6, 9, v5
  v_max_i32 v7, 0, v6
  v_cvt_f32_u32 v7, v7
  v_cvt_pk_bf16_f32 v8, v7, v7
  v_and_b32 v7, 0xffff0000, v8
  v_lshrrev_b32 v8, 23, v7
  v_subrev_u32 v8, 134, v8
  v_max_i32 v8, 0, v8
  v_cvt_u32_f32 v7, v7
  v_lshrrev_b32 v7, v8, v7
  v_lshl_add_u32 v7, v8, 8, v7
  v_lshl_add_u32 v209, v7, 2, s18
  v_subrev_u32 v6, 10, v5
  v_max_i32 v7, 0, v6
  v_cvt_f32_u32 v7, v7
  v_cvt_pk_bf16_f32 v8, v7, v7
  v_and_b32 v7, 0xffff0000, v8
  v_lshrrev_b32 v8, 23, v7
  v_subrev_u32 v8, 134, v8
  v_max_i32 v8, 0, v8
  v_cvt_u32_f32 v7, v7
  v_lshrrev_b32 v7, v8, v7
  v_lshl_add_u32 v7, v8, 8, v7
  v_lshl_add_u32 v210, v7, 2, s18
  v_subrev_u32 v6, 11, v5
  v_max_i32 v7, 0, v6
  v_cvt_f32_u32 v7, v7
  v_cvt_pk_bf16_f32 v8, v7, v7
  v_and_b32 v7, 0xffff0000, v8
  v_lshrrev_b32 v8, 23, v7
  v_subrev_u32 v8, 134, v8
  v_max_i32 v8, 0, v8
  v_cvt_u32_f32 v7, v7
  v_lshrrev_b32 v7, v8, v7
  v_lshl_add_u32 v7, v8, 8, v7
  v_lshl_add_u32 v211, v7, 2, s18
  v_subrev_u32 v6, 12, v5
  v_max_i32 v7, 0, v6
  v_cvt_f32_u32 v7, v7
  v_cvt_pk_bf16_f32 v8, v7, v7
  v_and_b32 v7, 0xffff0000, v8
  v_lshrrev_b32 v8, 23, v7
  v_subrev_u32 v8, 134, v8
  v_max_i32 v8, 0, v8
  v_cvt_u32_f32 v7, v7
  v_lshrrev_b32 v7, v8, v7
  v_lshl_add_u32 v7, v8, 8, v7
  v_lshl_add_u32 v212, v7, 2, s18
  v_subrev_u32 v6, 13, v5
  v_max_i32 v7, 0, v6
  v_cvt_f32_u32 v7, v7
  v_cvt_pk_bf16_f32 v8, v7, v7
  v_and_b32 v7, 0xffff0000, v8
  v_lshrrev_b32 v8, 23, v7
  v_subrev_u32 v8, 134, v8
  v_max_i32 v8, 0, v8
  v_cvt_u32_f32 v7, v7
  v_lshrrev_b32 v7, v8, v7
  v_lshl_add_u32 v7, v8, 8, v7
  v_lshl_add_u32 v213, v7, 2, s18
  v_subrev_u32 v6, 14, v5
  v_max_i32 v7, 0, v6
  v_cvt_f32_u32 v7, v7
  v_cvt_pk_bf16_f32 v8, v7, v7
  v_and_b32 v7, 0xffff0000, v8
  v_lshrrev_b32 v8, 23, v7
  v_subrev_u32 v8, 134, v8
  v_max_i32 v8, 0, v8
  v_cvt_u32_f32 v7, v7
  v_lshrrev_b32 v7, v8, v7
  v_lshl_add_u32 v7, v8, 8, v7
  v_lshl_add_u32 v214, v7, 2, s18
  v_subrev_u32 v6, 15, v5
  v_max_i32 v7, 0, v6
  v_cvt_f32_u32 v7, v7
  v_cvt_pk_bf16_f32 v8, v7, v7
  v_and_b32 v7, 0xffff0000, v8
  v_lshrrev_b32 v8, 23, v7
  v_subrev_u32 v8, 134, v8
  v_max_i32 v8, 0, v8
  v_cvt_u32_f32 v7, v7
  v_lshrrev_b32 v7, v8, v7
  v_lshl_add_u32 v7, v8, 8, v7
  v_lshl_add_u32 v215, v7, 2, s18
  v_subrev_u32 v6, 16, v5
  v_max_i32 v7, 0, v6
  v_cvt_f32_u32 v7, v7
  v_cvt_pk_bf16_f32 v8, v7, v7
  v_and_b32 v7, 0xffff0000, v8
  v_lshrrev_b32 v8, 23, v7
  v_subrev_u32 v8, 134, v8
  v_max_i32 v8, 0, v8
  v_cvt_u32_f32 v7, v7
  v_lshrrev_b32 v7, v8, v7
  v_lshl_add_u32 v7, v8, 8, v7
  v_lshl_add_u32 v216, v7, 2, s18
  v_subrev_u32 v6, 17, v5
  v_max_i32 v7, 0, v6
  v_cvt_f32_u32 v7, v7
  v_cvt_pk_bf16_f32 v8, v7, v7
  v_and_b32 v7, 0xffff0000, v8
  v_lshrrev_b32 v8, 23, v7
  v_subrev_u32 v8, 134, v8
  v_max_i32 v8, 0, v8
  v_cvt_u32_f32 v7, v7
  v_lshrrev_b32 v7, v8, v7
  v_lshl_add_u32 v7, v8, 8, v7
  v_lshl_add_u32 v217, v7, 2, s18
  v_subrev_u32 v6, 18, v5
  v_max_i32 v7, 0, v6
  v_cvt_f32_u32 v7, v7
  v_cvt_pk_bf16_f32 v8, v7, v7
  v_and_b32 v7, 0xffff0000, v8
  v_lshrrev_b32 v8, 23, v7
  v_subrev_u32 v8, 134, v8
  v_max_i32 v8, 0, v8
  v_cvt_u32_f32 v7, v7
  v_lshrrev_b32 v7, v8, v7
  v_lshl_add_u32 v7, v8, 8, v7
  v_lshl_add_u32 v218, v7, 2, s18
  v_subrev_u32 v6, 19, v5
  v_max_i32 v7, 0, v6
  v_cvt_f32_u32 v7, v7
  v_cvt_pk_bf16_f32 v8, v7, v7
  v_and_b32 v7, 0xffff0000, v8
  v_lshrrev_b32 v8, 23, v7
  v_subrev_u32 v8, 134, v8
  v_max_i32 v8, 0, v8
  v_cvt_u32_f32 v7, v7
  v_lshrrev_b32 v7, v8, v7
  v_lshl_add_u32 v7, v8, 8, v7
  v_lshl_add_u32 v219, v7, 2, s18
  v_subrev_u32 v6, 20, v5
  v_max_i32 v7, 0, v6
  v_cvt_f32_u32 v7, v7
  v_cvt_pk_bf16_f32 v8, v7, v7
  v_and_b32 v7, 0xffff0000, v8
  v_lshrrev_b32 v8, 23, v7
  v_subrev_u32 v8, 134, v8
  v_max_i32 v8, 0, v8
  v_cvt_u32_f32 v7, v7
  v_lshrrev_b32 v7, v8, v7
  v_lshl_add_u32 v7, v8, 8, v7
  v_lshl_add_u32 v220, v7, 2, s18
  v_subrev_u32 v6, 21, v5
  v_max_i32 v7, 0, v6
  v_cvt_f32_u32 v7, v7
  v_cvt_pk_bf16_f32 v8, v7, v7
  v_and_b32 v7, 0xffff0000, v8
  v_lshrrev_b32 v8, 23, v7
  v_subrev_u32 v8, 134, v8
  v_max_i32 v8, 0, v8
  v_cvt_u32_f32 v7, v7
  v_lshrrev_b32 v7, v8, v7
  v_lshl_add_u32 v7, v8, 8, v7
  v_lshl_add_u32 v221, v7, 2, s18
  v_subrev_u32 v6, 22, v5
  v_max_i32 v7, 0, v6
  v_cvt_f32_u32 v7, v7
  v_cvt_pk_bf16_f32 v8, v7, v7
  v_and_b32 v7, 0xffff0000, v8
  v_lshrrev_b32 v8, 23, v7
  v_subrev_u32 v8, 134, v8
  v_max_i32 v8, 0, v8
  v_cvt_u32_f32 v7, v7
  v_lshrrev_b32 v7, v8, v7
  v_lshl_add_u32 v7, v8, 8, v7
  v_lshl_add_u32 v222, v7, 2, s18
  v_subrev_u32 v6, 23, v5
  v_max_i32 v7, 0, v6
  v_cvt_f32_u32 v7, v7
  v_cvt_pk_bf16_f32 v8, v7, v7
  v_and_b32 v7, 0xffff0000, v8
  v_lshrrev_b32 v8, 23, v7
  v_subrev_u32 v8, 134, v8
  v_max_i32 v8, 0, v8
  v_cvt_u32_f32 v7, v7
  v_lshrrev_b32 v7, v8, v7
  v_lshl_add_u32 v7, v8, 8, v7
  v_lshl_add_u32 v223, v7, 2, s18
  v_subrev_u32 v6, 24, v5
  v_max_i32 v7, 0, v6
  v_cvt_f32_u32 v7, v7
  v_cvt_pk_bf16_f32 v8, v7, v7
  v_and_b32 v7, 0xffff0000, v8
  v_lshrrev_b32 v8, 23, v7
  v_subrev_u32 v8, 134, v8
  v_max_i32 v8, 0, v8
  v_cvt_u32_f32 v7, v7
  v_lshrrev_b32 v7, v8, v7
  v_lshl_add_u32 v7, v8, 8, v7
  v_lshl_add_u32 v224, v7, 2, s18
  v_subrev_u32 v6, 25, v5
  v_max_i32 v7, 0, v6
  v_cvt_f32_u32 v7, v7
  v_cvt_pk_bf16_f32 v8, v7, v7
  v_and_b32 v7, 0xffff0000, v8
  v_lshrrev_b32 v8, 23, v7
  v_subrev_u32 v8, 134, v8
  v_max_i32 v8, 0, v8
  v_cvt_u32_f32 v7, v7
  v_lshrrev_b32 v7, v8, v7
  v_lshl_add_u32 v7, v8, 8, v7
  v_lshl_add_u32 v225, v7, 2, s18
  v_subrev_u32 v6, 26, v5
  v_max_i32 v7, 0, v6
  v_cvt_f32_u32 v7, v7
  v_cvt_pk_bf16_f32 v8, v7, v7
  v_and_b32 v7, 0xffff0000, v8
  v_lshrrev_b32 v8, 23, v7
  v_subrev_u32 v8, 134, v8
  v_max_i32 v8, 0, v8
  v_cvt_u32_f32 v7, v7
  v_lshrrev_b32 v7, v8, v7
  v_lshl_add_u32 v7, v8, 8, v7
  v_lshl_add_u32 v226, v7, 2, s18
  v_subrev_u32 v6, 27, v5
  v_max_i32 v7, 0, v6
  v_cvt_f32_u32 v7, v7
  v_cvt_pk_bf16_f32 v8, v7, v7
  v_and_b32 v7, 0xffff0000, v8
  v_lshrrev_b32 v8, 23, v7
  v_subrev_u32 v8, 134, v8
  v_max_i32 v8, 0, v8
  v_cvt_u32_f32 v7, v7
  v_lshrrev_b32 v7, v8, v7
  v_lshl_add_u32 v7, v8, 8, v7
  v_lshl_add_u32 v227, v7, 2, s18
  v_subrev_u32 v6, 28, v5
  v_max_i32 v7, 0, v6
  v_cvt_f32_u32 v7, v7
  v_cvt_pk_bf16_f32 v8, v7, v7
  v_and_b32 v7, 0xffff0000, v8
  v_lshrrev_b32 v8, 23, v7
  v_subrev_u32 v8, 134, v8
  v_max_i32 v8, 0, v8
  v_cvt_u32_f32 v7, v7
  v_lshrrev_b32 v7, v8, v7
  v_lshl_add_u32 v7, v8, 8, v7
  v_lshl_add_u32 v228, v7, 2, s18
  v_subrev_u32 v6, 29, v5
  v_max_i32 v7, 0, v6
  v_cvt_f32_u32 v7, v7
  v_cvt_pk_bf16_f32 v8, v7, v7
  v_and_b32 v7, 0xffff0000, v8
  v_lshrrev_b32 v8, 23, v7
  v_subrev_u32 v8, 134, v8
  v_max_i32 v8, 0, v8
  v_cvt_u32_f32 v7, v7
  v_lshrrev_b32 v7, v8, v7
  v_lshl_add_u32 v7, v8, 8, v7
  v_lshl_add_u32 v229, v7, 2, s18
  v_subrev_u32 v6, 30, v5
  v_max_i32 v7, 0, v6
  v_cvt_f32_u32 v7, v7
  v_cvt_pk_bf16_f32 v8, v7, v7
  v_and_b32 v7, 0xffff0000, v8
  v_lshrrev_b32 v8, 23, v7
  v_subrev_u32 v8, 134, v8
  v_max_i32 v8, 0, v8
  v_cvt_u32_f32 v7, v7
  v_lshrrev_b32 v7, v8, v7
  v_lshl_add_u32 v7, v8, 8, v7
  v_lshl_add_u32 v230, v7, 2, s18
  v_subrev_u32 v6, 31, v5
  v_max_i32 v7, 0, v6
  v_cvt_f32_u32 v7, v7
  v_cvt_pk_bf16_f32 v8, v7, v7
  v_and_b32 v7, 0xffff0000, v8
  v_lshrrev_b32 v8, 23, v7
  v_subrev_u32 v8, 134, v8
  v_max_i32 v8, 0, v8
  v_cvt_u32_f32 v7, v7
  v_lshrrev_b32 v7, v8, v7
  v_lshl_add_u32 v7, v8, 8, v7
  v_lshl_add_u32 v231, v7, 2, s18
  v_subrev_u32 v6, 32, v5
  v_max_i32 v7, 0, v6
  v_cvt_f32_u32 v7, v7
  v_cvt_pk_bf16_f32 v8, v7, v7
  v_and_b32 v7, 0xffff0000, v8
  v_lshrrev_b32 v8, 23, v7
  v_subrev_u32 v8, 134, v8
  v_max_i32 v8, 0, v8
  v_cvt_u32_f32 v7, v7
  v_lshrrev_b32 v7, v8, v7
  v_lshl_add_u32 v7, v8, 8, v7
  v_mov_b32 v8, 1280
  v_cmp_gt_i32 vcc, 0, v6
  s_nop 1
  v_cndmask_b32 v7, v7, v8, vcc
  v_lshl_add_u32 v232, v7, 2, s18
  v_mov_b32 v8, 0
  v_mov_b32 v9, 0
  v_lshlrev_b32 v5, 3, v1
  v_add_u32 v5, s17, v5
  ds_write_b64 v5, v[8:9]
  v_and_b32 v6, 15, v1
  v_lshlrev_b32 v6, 3, v6
  v_add_u32 v6, s17, v6
  ds_write_b64 v6, v[8:9] offset:8704
  ds_write_b64 v6, v[8:9] offset:12928
  v_mov_b32 v6, s17
  ds_write_b64 v6, v[8:9] offset:18176
  s_lshl_b32 s19, s3, 2
  s_add_u32 s20, s19, s16
  s_lshl_b32 s21, s3, 3
  v_mul_u32_u24 v5, 3584, v0
  s_add_u32 s22, s21, 0
  buffer_load_dwordx2 v[8:9], v5, s[60:63], s22 offen offset:0
  buffer_load_dwordx2 v[10:11], v5, s[60:63], s22 offen offset:896
  buffer_load_dwordx2 v[12:13], v5, s[60:63], s22 offen offset:1792
  buffer_load_dwordx2 v[14:15], v5, s[60:63], s22 offen offset:2688
  s_add_u32 s22, s21, 917504
  buffer_load_dwordx2 v[16:17], v5, s[60:63], s22 offen offset:0
  buffer_load_dwordx2 v[18:19], v5, s[60:63], s22 offen offset:896
  buffer_load_dwordx2 v[20:21], v5, s[60:63], s22 offen offset:1792
  buffer_load_dwordx2 v[22:23], v5, s[60:63], s22 offen offset:2688
  s_lshl_b32 s22, s20, 9
  v_lshlrev_b32 v6, 3, v1
  buffer_load_dwordx2 v[24:25], v6, s[64:67], s22 offen
  buffer_load_dwordx2 v[26:27], v6, s[68:71], s22 offen
  buffer_load_dwordx2 v[28:29], v6, s[72:75], s22 offen
  buffer_load_dwordx2 v[30:31], v6, s[76:79], s22 offen
  s_lshl_b32 s22, s20, 1
  v_mov_b32 v7, 0
  buffer_load_ushort v32, v7, s[80:83], s22 offen
  buffer_load_ushort v33, v7, s[84:87], s22 offen
  s_mov_b32 s24, 0x05040100
  s_mov_b32 s25, 0x07060302
  s_barrier
  s_waitcnt vmcnt(6)
  v_lshlrev_b32 v6, 3, v0
  v_perm_b32 v34, v10, v8, s24
  v_perm_b32 v35, v14, v12, s24
  v_add_u32 v36, 512, v6
  ds_write_b64 v36, v[34:35]
  v_perm_b32 v34, v10, v8, s25
  v_perm_b32 v35, v14, v12, s25
  v_add_u32 v36, 25088, v6
  ds_write_b64 v36, v[34:35]
  v_perm_b32 v34, v11, v9, s24
  v_perm_b32 v35, v15, v13, s24
  v_add_u32 v36, 49664, v6
  ds_write_b64 v36, v[34:35]
  v_perm_b32 v34, v11, v9, s25
  v_perm_b32 v35, v15, v13, s25
  v_add_u32 v36, 74240, v6
  ds_write_b64 v36, v[34:35]
  v_perm_b32 v34, v18, v16, s24
  v_perm_b32 v35, v22, v20, s24
  v_add_u32 v36, 2560, v6
  ds_write_b64 v36, v[34:35]
  v_perm_b32 v34, v18, v16, s25
  v_perm_b32 v35, v22, v20, s25
  v_add_u32 v36, 27136, v6
  ds_write_b64 v36, v[34:35]
  v_perm_b32 v34, v19, v17, s24
  v_perm_b32 v35, v23, v21, s24
  v_add_u32 v36, 51712, v6
  ds_write_b64 v36, v[34:35]
  v_perm_b32 v34, v19, v17, s25
  v_perm_b32 v35, v23, v21, s25
  v_add_u32 v36, 76288, v6
  ds_write_b64 v36, v[34:35]
  s_waitcnt vmcnt(0)
  s_mov_b32 s26, 1069066811
  s_mov_b32 s27, 1042479491
  v_lshlrev_b32 v32, 16, v32
  v_lshlrev_b32 v33, 16, v33
  v_mul_f32 v32, s26, v32
  v_exp_f32 v32, v32
  s_nop 0
  v_cvt_pk_bf16_f32 v34, v32, v32
  v_and_b32 v32, 0xffff0000, v34
  v_lshlrev_b32 v37, 6, v1
  v_add_u32 v37, s17, v37
  v_lshlrev_b32 v40, 16, v24
  v_lshlrev_b32 v41, 16, v26
  v_lshlrev_b32 v42, 16, v28
  v_lshlrev_b32 v43, 16, v30
  v_mul_f32 v40, s26, v40
  v_exp_f32 v40, v40
  s_nop 0
  v_cvt_pk_bf16_f32 v34, v40, v40
  v_and_b32 v40, 0xffff0000, v34
  v_mul_f32 v40, v40, v32
  v_mul_f32 v40, s26, v40
  v_sub_f32 v40, 0, v40
  v_mul_f32 v41, v41, v32
  v_mul_f32 v41, s27, v41
  v_mul_f32 v42, v42, v32
  v_mul_f32 v43, v43, v32
  v_add_f32 v42, v42, v42
  v_add_f32 v43, v43, v43
  ds_write_b128 v37, v[40:43] offset:18240
  v_and_b32 v40, 0xffff0000, v24
  v_and_b32 v41, 0xffff0000, v26
  v_and_b32 v42, 0xffff0000, v28
  v_and_b32 v43, 0xffff0000, v30
  v_mul_f32 v40, s26, v40
  v_exp_f32 v40, v40
  s_nop 0
  v_cvt_pk_bf16_f32 v34, v40, v40
  v_and_b32 v40, 0xffff0000, v34
  v_mul_f32 v40, v40, v32
  v_mul_f32 v40, s26, v40
  v_sub_f32 v40, 0, v40
  v_mul_f32 v41, v41, v32
  v_mul_f32 v41, s27, v41
  v_mul_f32 v42, v42, v32
  v_mul_f32 v43, v43, v32
  v_add_f32 v42, v42, v42
  v_add_f32 v43, v43, v43
  ds_write_b128 v37, v[40:43] offset:18256
  v_lshlrev_b32 v40, 16, v25
  v_lshlrev_b32 v41, 16, v27
  v_lshlrev_b32 v42, 16, v29
  v_lshlrev_b32 v43, 16, v31
  v_mul_f32 v40, s26, v40
  v_exp_f32 v40, v40
  s_nop 0
  v_cvt_pk_bf16_f32 v34, v40, v40
  v_and_b32 v40, 0xffff0000, v34
  v_mul_f32 v40, v40, v32
  v_mul_f32 v40, s26, v40
  v_sub_f32 v40, 0, v40
  v_mul_f32 v41, v41, v32
  v_mul_f32 v41, s27, v41
  v_mul_f32 v42, v42, v32
  v_mul_f32 v43, v43, v32
  v_add_f32 v42, v42, v42
  v_add_f32 v43, v43, v43
  ds_write_b128 v37, v[40:43] offset:18272
  v_and_b32 v40, 0xffff0000, v25
  v_and_b32 v41, 0xffff0000, v27
  v_and_b32 v42, 0xffff0000, v29
  v_and_b32 v43, 0xffff0000, v31
  v_mul_f32 v40, s26, v40
  v_exp_f32 v40, v40
  s_nop 0
  v_cvt_pk_bf16_f32 v34, v40, v40
  v_and_b32 v40, 0xffff0000, v34
  v_mul_f32 v40, v40, v32
  v_mul_f32 v40, s26, v40
  v_sub_f32 v40, 0, v40
  v_mul_f32 v41, v41, v32
  v_mul_f32 v41, s27, v41
  v_mul_f32 v42, v42, v32
  v_mul_f32 v43, v43, v32
  v_add_f32 v42, v42, v42
  v_add_f32 v43, v43, v43
  ds_write_b128 v37, v[40:43] offset:18288
  v_cvt_f32_u32 v44, v4
  v_lshlrev_b32 v45, 4, v4
  v_cvt_f32_u32 v45, v45
  v_lshlrev_b32 v46, 4, v3
  v_add_u32 v46, s17, v46
  v_mov_b32 v48, 0
  v_mov_b32 v49, 0
  v_mov_b32 v50, 0
  v_mov_b32 v51, 0
  v_mov_b32 v52, 0
  v_mov_b32 v53, 0
  v_mov_b32 v54, 0
  v_mov_b32 v55, 0
  v_mov_b32 v56, 0
  v_mov_b32 v57, 0
  v_mov_b32 v58, 0
  v_mov_b32 v59, 0
  v_mov_b32 v60, 0
  v_mov_b32 v61, 0
  v_mov_b32 v62, 0
  v_mov_b32 v63, 0
  v_mov_b32 v64, 0
  v_mov_b32 v65, 0
  v_mov_b32 v66, 0
  v_mov_b32 v67, 0
  s_mov_b32 s28, 0
  s_waitcnt lgkmcnt(0)
  ds_read_b128 v[68:71], v46 offset:18240
wk_kl:
  s_waitcnt lgkmcnt(0)
  v_mov_b32 v72, v68
  v_mov_b32 v73, v69
  v_mov_b32 v74, v70
  v_mov_b32 v75, v71
  v_add_u32 v46, 64, v46
  ds_read_b128 v[68:71], v46 offset:18240
  v_mul_f32 v80, v72, v45
  v_mul_f32 v81, v73, v45
  v_exp_f32 v80, v80
  v_fract_f32 v81, v81
  v_cos_f32 v76, v81
  v_sin_f32 v77, v81
  v_mul_f32 v76, v76, v80
  v_mul_f32 v77, v77, v80
  v_mul_f32 v80, v72, v44
  v_mul_f32 v81, v73, v44
  v_exp_f32 v80, v80
  v_fract_f32 v81, v81
  v_cos_f32 v78, v81
  v_sin_f32 v79, v81
  v_mul_f32 v78, v78, v80
  v_mul_f32 v79, v79, v80
  v_mul_f32 v82, v74, v76
  v_mul_f32 v83, v74, v77
  v_fma_f32 v82, -v75, v77, v82
  v_fma_f32 v83, -v75, v76, -v83
  v_mul_f32 v86, v76, v76
  v_mul_f32 v87, v76, v77
  v_fma_f32 v86, -v77, v77, v86
  v_add_f32 v87, v87, v87
  v_mfma_f32_16x16x4_f32 v[48:51], v82, v78, v[48:51]
  v_mul_f32 v88, v78, v78
  v_mul_f32 v89, v78, v79
  v_fma_f32 v88, -v79, v79, v88
  v_add_f32 v89, v89, v89
  v_mfma_f32_16x16x4_f32 v[48:51], v83, v79, v[48:51]
  v_mul_f32 v84, v74, v86
  v_mul_f32 v85, v74, v87
  v_fma_f32 v84, -v75, v87, v84
  v_fma_f32 v85, -v75, v86, -v85
  v_mul_f32 v76, v86, v86
  v_mul_f32 v77, v86, v87
  v_fma_f32 v76, -v87, v87, v76
  v_add_f32 v77, v77, v77
  v_mfma_f32_16x16x4_f32 v[52:55], v84, v88, v[52:55]
  v_mul_f32 v78, v88, v88
  v_mul_f32 v79, v88, v89
  v_fma_f32 v78, -v89, v89, v78
  v_add_f32 v79, v79, v79
  v_mfma_f32_16x16x4_f32 v[52:55], v85, v89, v[52:55]
  v_mul_f32 v82, v74, v76
  v_mul_f32 v83, v74, v77
  v_fma_f32 v82, -v75, v77, v82
  v_fma_f32 v83, -v75, v76, -v83
  v_mul_f32 v86, v76, v76
  v_mul_f32 v87, v76, v77
  v_fma_f32 v86, -v77, v77, v86
  v_add_f32 v87, v87, v87
  v_mfma_f32_16x16x4_f32 v[56:59], v82, v78, v[56:59]
  v_mul_f32 v88, v78, v78
  v_mul_f32 v89, v78, v79
  v_fma_f32 v88, -v79, v79, v88
  v_add_f32 v89, v89, v89
  v_mfma_f32_16x16x4_f32 v[56:59], v83, v79, v[56:59]
  v_mul_f32 v84, v74, v86
  v_mul_f32 v85, v74, v87
  v_fma_f32 v84, -v75, v87, v84
  v_fma_f32 v85, -v75, v86, -v85
  v_mul_f32 v76, v86, v86
  v_mul_f32 v77, v86, v87
  v_fma_f32 v76, -v87, v87, v76
  v_add_f32 v77, v77, v77
  v_mfma_f32_16x16x4_f32 v[60:63], v84, v88, v[60:63]
  v_mfma_f32_16x16x4_f32 v[60:63], v85, v89, v[60:63]
  v_mul_f32 v82, v74, v76
  v_fma_f32 v82, -v75, v77, v82
  s_nop 1
  v_mfma_f32_16x16x4_f32 v[64:67], v82, v88, v[64:67]
  s_add_u32 s28, s28, 1
  s_cmp_lt_u32 s28, 64
  s_cbranch_scc1 wk_kl
  s_nop 15
  s_nop 3
  v_lshlrev_b32 v46, 8, v3
  v_lshl_add_u32 v46, v4, 2, v46
  v_add_u32 v46, s17, v46
  ds_write_b32 v46, v48 offset:13056
  ds_write_b32 v46, v49 offset:13120
  ds_write_b32 v46, v50 offset:13184
  ds_write_b32 v46, v51 offset:13248
  s_waitcnt lgkmcnt(8)
  ds_write_b32 v46, v52 offset:14080
  ds_write_b32 v46, v53 offset:14144
  ds_write_b32 v46, v54 offset:14208
  ds_write_b32 v46, v55 offset:14272
  s_waitcnt lgkmcnt(8)
  ds_write_b32 v46, v56 offset:15104
  ds_write_b32 v46, v57 offset:15168
  ds_write_b32 v46, v58 offset:15232
  ds_write_b32 v46, v59 offset:15296
  s_waitcnt lgkmcnt(8)
  ds_write_b32 v46, v60 offset:16128
  ds_write_b32 v46, v61 offset:16192
  ds_write_b32 v46, v62 offset:16256
  ds_write_b32 v46, v63 offset:16320
  s_waitcnt lgkmcnt(8)
  ds_write_b32 v46, v64 offset:17152
  ds_write_b32 v46, v65 offset:17216
  ds_write_b32 v46, v66 offset:17280
  ds_write_b32 v46, v67 offset:17344
  s_waitcnt lgkmcnt(8)
  s_waitcnt lgkmcnt(0)
  ds_read_b32 v48, v200
  ds_read_b32 v49, v201
  ds_read_b32 v50, v202
  ds_read_b32 v51, v203
  ds_read_b32 v52, v204
  ds_read_b32 v53, v205
  ds_read_b32 v54, v206
  ds_read_b32 v55, v207
  s_waitcnt lgkmcnt(4)
  ds_read_b32 v56, v208
  ds_read_b32 v57, v209
  ds_read_b32 v58, v210
  ds_read_b32 v59, v211
  ds_read_b32 v60, v212
  ds_read_b32 v61, v213
  ds_read_b32 v62, v214
  ds_read_b32 v63, v215
  s_waitcnt lgkmcnt(4)
  ds_read_b32 v64, v216
  ds_read_b32 v65, v217
  ds_read_b32 v66, v218
  ds_read_b32 v67, v219
  ds_read_b32 v68, v220
  ds_read_b32 v69, v221
  ds_read_b32 v70, v222
  ds_read_b32 v71, v223
  s_waitcnt lgkmcnt(4)
  ds_read_b32 v72, v224
  ds_read_b32 v73, v225
  ds_read_b32 v74, v226
  ds_read_b32 v75, v227
  ds_read_b32 v76, v228
  ds_read_b32 v77, v229
  ds_read_b32 v78, v230
  ds_read_b32 v79, v231
  s_waitcnt lgkmcnt(4)
  ds_read_b32 v80, v232
  s_waitcnt lgkmcnt(0)
  v_lshlrev_b32 v46, 6, v1
  v_add_u32 v46, s17, v46
  v_cvt_pk_bf16_f32 v84, v48, v49
  v_cvt_pk_bf16_f32 v88, v49, v50
  v_cvt_pk_bf16_f32 v85, v50, v51
  v_cvt_pk_bf16_f32 v89, v51, v52
  v_cvt_pk_bf16_f32 v86, v52, v53
  v_cvt_pk_bf16_f32 v90, v53, v54
  v_cvt_pk_bf16_f32 v87, v54, v55
  v_cvt_pk_bf16_f32 v91, v55, v56
  ds_write_b128 v46, v[84:87] offset:4608
  ds_write_b128 v46, v[88:91] offset:8832
  s_waitcnt lgkmcnt(0)
  v_cvt_pk_bf16_f32 v84, v56, v57
  v_cvt_pk_bf16_f32 v88, v57, v58
  v_cvt_pk_bf16_f32 v85, v58, v59
  v_cvt_pk_bf16_f32 v89, v59, v60
  v_cvt_pk_bf16_f32 v86, v60, v61
  v_cvt_pk_bf16_f32 v90, v61, v62
  v_cvt_pk_bf16_f32 v87, v62, v63
  v_cvt_pk_bf16_f32 v91, v63, v64
  ds_write_b128 v46, v[84:87] offset:4624
  ds_write_b128 v46, v[88:91] offset:8848
  s_waitcnt lgkmcnt(0)
  v_cvt_pk_bf16_f32 v84, v64, v65
  v_cvt_pk_bf16_f32 v88, v65, v66
  v_cvt_pk_bf16_f32 v85, v66, v67
  v_cvt_pk_bf16_f32 v89, v67, v68
  v_cvt_pk_bf16_f32 v86, v68, v69
  v_cvt_pk_bf16_f32 v90, v69, v70
  v_cvt_pk_bf16_f32 v87, v70, v71
  v_cvt_pk_bf16_f32 v91, v71, v72
  ds_write_b128 v46, v[84:87] offset:4640
  ds_write_b128 v46, v[88:91] offset:8864
  s_waitcnt lgkmcnt(0)
  v_cvt_pk_bf16_f32 v84, v72, v73
  v_cvt_pk_bf16_f32 v88, v73, v74
  v_cvt_pk_bf16_f32 v85, v74, v75
  v_cvt_pk_bf16_f32 v89, v75, v76
  v_cvt_pk_bf16_f32 v86, v76, v77
  v_cvt_pk_bf16_f32 v90, v77, v78
  v_cvt_pk_bf16_f32 v87, v78, v79
  v_cvt_pk_bf16_f32 v91, v79, v80
  ds_write_b128 v46, v[84:87] offset:4656
  ds_write_b128 v46, v[88:91] offset:8880
  s_waitcnt lgkmcnt(0)
  s_barrier
  v_lshrrev_b32 v47, 1, v3
  v_sub_u32 v46, v4, v47
  v_add_u32 v46, 1, v46
  v_lshlrev_b32 v46, 5, v46
  v_and_b32 v48, 1, v3
  v_lshl_add_u32 v46, v48, 4, v46
  v_add_u32 v46, s17, v46
  ds_read_b128 a[0:3], v46 offset:32
  ds_read_b128 a[4:7], v46 offset:96
  ds_read_b128 a[8:11], v46 offset:160
  ds_read_b128 a[12:15], v46 offset:224
  ds_read_b128 a[16:19], v46 offset:288
  ds_read_b128 a[20:23], v46 offset:352
  ds_read_b128 a[24:27], v46 offset:416
  ds_read_b128 a[28:31], v46 offset:480
  s_waitcnt lgkmcnt(4)
  ds_read_b128 a[32:35], v46 offset:544
  ds_read_b128 a[36:39], v46 offset:608
  ds_read_b128 a[40:43], v46 offset:672
  ds_read_b128 a[44:47], v46 offset:736
  ds_read_b128 a[48:51], v46 offset:800
  ds_read_b128 a[52:55], v46 offset:864
  ds_read_b128 a[56:59], v46 offset:928
  ds_read_b128 a[60:63], v46 offset:992
  s_waitcnt lgkmcnt(4)
  ds_read_b128 a[64:67], v46 offset:1056
  ds_read_b128 a[68:71], v46 offset:1120
  ds_read_b128 a[72:75], v46 offset:1184
  ds_read_b128 a[76:79], v46 offset:1248
  ds_read_b128 a[80:83], v46 offset:1312
  ds_read_b128 a[84:87], v46 offset:1376
  ds_read_b128 a[88:91], v46 offset:1440
  ds_read_b128 a[92:95], v46 offset:1504
  s_waitcnt lgkmcnt(4)
  ds_read_b128 a[96:99], v46 offset:1568
  ds_read_b128 a[100:103], v46 offset:1632
  ds_read_b128 a[104:107], v46 offset:1696
  ds_read_b128 a[108:111], v46 offset:1760
  ds_read_b128 a[112:115], v46 offset:1824
  ds_read_b128 a[116:119], v46 offset:1888
  ds_read_b128 a[120:123], v46 offset:1952
  ds_read_b128 a[124:127], v46 offset:2016
  s_waitcnt lgkmcnt(4)
  ds_read_b128 a[128:131], v46 offset:2080
  ds_read_b128 a[132:135], v46 offset:2144
  ds_read_b128 a[136:139], v46 offset:2208
  ds_read_b128 a[140:143], v46 offset:2272
  ds_read_b128 a[144:147], v46 offset:2336
  ds_read_b128 a[148:151], v46 offset:2400
  ds_read_b128 a[152:155], v46 offset:2464
  ds_read_b128 a[156:159], v46 offset:2528
  s_waitcnt lgkmcnt(4)
  ds_read_b128 a[160:163], v46 offset:2592
  ds_read_b128 a[164:167], v46 offset:2656
  ds_read_b128 a[168:171], v46 offset:2720
  ds_read_b128 a[172:175], v46 offset:2784
  ds_read_b128 a[176:179], v46 offset:2848
  ds_read_b128 a[180:183], v46 offset:2912
  ds_read_b128 a[184:187], v46 offset:2976
  ds_read_b128 a[188:191], v46 offset:3040
  s_waitcnt lgkmcnt(4)
  ds_read_b128 a[192:195], v46 offset:3104
  ds_read_b128 a[196:199], v46 offset:3168
  ds_read_b128 a[200:203], v46 offset:3232
  ds_read_b128 a[204:207], v46 offset:3296
  ds_read_b128 a[208:211], v46 offset:3360
  ds_read_b128 a[212:215], v46 offset:3424
  ds_read_b128 a[216:219], v46 offset:3488
  ds_read_b128 a[220:223], v46 offset:3552
  s_waitcnt lgkmcnt(4)
  ds_read_b128 a[224:227], v46 offset:3616
  ds_read_b128 a[228:231], v46 offset:3680
  ds_read_b128 a[232:235], v46 offset:3744
  ds_read_b128 a[236:239], v46 offset:3808
  ds_read_b128 a[240:243], v46 offset:3872
  ds_read_b128 a[244:247], v46 offset:3936
  ds_read_b128 a[248:251], v46 offset:4000
  ds_read_b128 a[252:255], v46 offset:4064
  s_waitcnt lgkmcnt(4)
  v_lshlrev_b32 v49, 4, v47
  v_add_u32 v49, v49, v4
  v_sub_u32 v49, 2047, v49
  v_lshl_add_u32 v49, v48, 3, v49
  v_and_b32 v50, 1, v49
  v_lshrrev_b32 v49, 1, v49
  v_lshlrev_b32 v49, 2, v49
  v_mul_u32_u24 v50, 4224, v50
  v_add3_u32 v49, v49, v50, s17
  v_add_u32 v49, 4608, v49
  v_subrev_u32 v52, 896, v49
  v_subrev_u32 v53, 1856, v49
  v_subrev_u32 v54, 2816, v49
  v_subrev_u32 v55, 3776, v49
  v_subrev_u32 v56, 4736, v49
  s_waitcnt lgkmcnt(0)
  ds_read2_b32 v[92:93], v52 offset0:224 offset1:225
  ds_read2_b32 v[94:95], v52 offset0:226 offset1:227
  ds_read2_b32 v[96:97], v52 offset0:208 offset1:209
  ds_read2_b32 v[98:99], v52 offset0:210 offset1:211
  ds_read2_b32 v[100:101], v52 offset0:192 offset1:193
  ds_read2_b32 v[102:103], v52 offset0:194 offset1:195
  ds_read2_b32 v[104:105], v52 offset0:176 offset1:177
  ds_read2_b32 v[106:107], v52 offset0:178 offset1:179
  s_waitcnt lgkmcnt(6)
  v_mfma_f32_16x16x32_bf16 v[60:63], v[92:95], a[28:31], 0
  v_mfma_f32_16x16x32_bf16 v[64:67], v[92:95], a[60:63], 0
  v_mfma_f32_16x16x32_bf16 v[68:71], v[92:95], a[92:95], 0
  v_mfma_f32_16x16x32_bf16 v[72:75], v[92:95], a[124:127], 0
  v_mfma_f32_16x16x32_bf16 v[76:79], v[92:95], a[156:159], 0
  v_mfma_f32_16x16x32_bf16 v[80:83], v[92:95], a[188:191], 0
  v_mfma_f32_16x16x32_bf16 v[84:87], v[92:95], a[220:223], 0
  v_mfma_f32_16x16x32_bf16 v[88:91], v[92:95], a[252:255], 0
  ds_read2_b32 v[92:93], v52 offset0:160 offset1:161
  ds_read2_b32 v[94:95], v52 offset0:162 offset1:163
  s_waitcnt lgkmcnt(6)
  v_mfma_f32_16x16x32_bf16 v[60:63], v[96:99], a[24:27], v[60:63]
  v_mfma_f32_16x16x32_bf16 v[64:67], v[96:99], a[56:59], v[64:67]
  v_mfma_f32_16x16x32_bf16 v[68:71], v[96:99], a[88:91], v[68:71]
  v_mfma_f32_16x16x32_bf16 v[72:75], v[96:99], a[120:123], v[72:75]
  v_mfma_f32_16x16x32_bf16 v[76:79], v[96:99], a[152:155], v[76:79]
  v_mfma_f32_16x16x32_bf16 v[80:83], v[96:99], a[184:187], v[80:83]
  v_mfma_f32_16x16x32_bf16 v[84:87], v[96:99], a[216:219], v[84:87]
  v_mfma_f32_16x16x32_bf16 v[88:91], v[96:99], a[248:251], v[88:91]
  ds_read2_b32 v[96:97], v52 offset0:144 offset1:145
  ds_read2_b32 v[98:99], v52 offset0:146 offset1:147
  s_waitcnt lgkmcnt(6)
  v_mfma_f32_16x16x32_bf16 v[60:63], v[100:103], a[20:23], v[60:63]
  v_mfma_f32_16x16x32_bf16 v[64:67], v[100:103], a[52:55], v[64:67]
  v_mfma_f32_16x16x32_bf16 v[68:71], v[100:103], a[84:87], v[68:71]
  v_mfma_f32_16x16x32_bf16 v[72:75], v[100:103], a[116:119], v[72:75]
  v_mfma_f32_16x16x32_bf16 v[76:79], v[100:103], a[148:151], v[76:79]
  v_mfma_f32_16x16x32_bf16 v[80:83], v[100:103], a[180:183], v[80:83]
  v_mfma_f32_16x16x32_bf16 v[84:87], v[100:103], a[212:215], v[84:87]
  v_mfma_f32_16x16x32_bf16 v[88:91], v[100:103], a[244:247], v[88:91]
  ds_read2_b32 v[100:101], v52 offset0:128 offset1:129
  ds_read2_b32 v[102:103], v52 offset0:130 offset1:131
  s_waitcnt lgkmcnt(6)
  v_mfma_f32_16x16x32_bf16 v[60:63], v[104:107], a[16:19], v[60:63]
  v_mfma_f32_16x16x32_bf16 v[64:67], v[104:107], a[48:51], v[64:67]
  v_mfma_f32_16x16x32_bf16 v[68:71], v[104:107], a[80:83], v[68:71]
  v_mfma_f32_16x16x32_bf16 v[72:75], v[104:107], a[112:115], v[72:75]
  v_mfma_f32_16x16x32_bf16 v[76:79], v[104:107], a[144:147], v[76:79]
  v_mfma_f32_16x16x32_bf16 v[80:83], v[104:107], a[176:179], v[80:83]
  v_mfma_f32_16x16x32_bf16 v[84:87], v[104:107], a[208:211], v[84:87]
  v_mfma_f32_16x16x32_bf16 v[88:91], v[104:107], a[240:243], v[88:91]
  ds_read2_b32 v[104:105], v52 offset0:112 offset1:113
  ds_read2_b32 v[106:107], v52 offset0:114 offset1:115
  s_waitcnt lgkmcnt(6)
  v_mfma_f32_16x16x32_bf16 v[60:63], v[92:95], a[12:15], v[60:63]
  v_mfma_f32_16x16x32_bf16 v[64:67], v[92:95], a[44:47], v[64:67]
  v_mfma_f32_16x16x32_bf16 v[68:71], v[92:95], a[76:79], v[68:71]
  v_mfma_f32_16x16x32_bf16 v[72:75], v[92:95], a[108:111], v[72:75]
  v_mfma_f32_16x16x32_bf16 v[76:79], v[92:95], a[140:143], v[76:79]
  v_mfma_f32_16x16x32_bf16 v[80:83], v[92:95], a[172:175], v[80:83]
  v_mfma_f32_16x16x32_bf16 v[84:87], v[92:95], a[204:207], v[84:87]
  v_mfma_f32_16x16x32_bf16 v[88:91], v[92:95], a[236:239], v[88:91]
  ds_read2_b32 v[92:93], v52 offset0:96 offset1:97
  ds_read2_b32 v[94:95], v52 offset0:98 offset1:99
  s_waitcnt lgkmcnt(6)
  v_mfma_f32_16x16x32_bf16 v[60:63], v[96:99], a[8:11], v[60:63]
  v_mfma_f32_16x16x32_bf16 v[64:67], v[96:99], a[40:43], v[64:67]
  v_mfma_f32_16x16x32_bf16 v[68:71], v[96:99], a[72:75], v[68:71]
  v_mfma_f32_16x16x32_bf16 v[72:75], v[96:99], a[104:107], v[72:75]
  v_mfma_f32_16x16x32_bf16 v[76:79], v[96:99], a[136:139], v[76:79]
  v_mfma_f32_16x16x32_bf16 v[80:83], v[96:99], a[168:171], v[80:83]
  v_mfma_f32_16x16x32_bf16 v[84:87], v[96:99], a[200:203], v[84:87]
  v_mfma_f32_16x16x32_bf16 v[88:91], v[96:99], a[232:235], v[88:91]
  ds_read2_b32 v[96:97], v52 offset0:80 offset1:81
  ds_read2_b32 v[98:99], v52 offset0:82 offset1:83
  s_waitcnt lgkmcnt(6)
  v_mfma_f32_16x16x32_bf16 v[60:63], v[100:103], a[4:7], v[60:63]
  v_mfma_f32_16x16x32_bf16 v[64:67], v[100:103], a[36:39], v[64:67]
  v_mfma_f32_16x16x32_bf16 v[68:71], v[100:103], a[68:71], v[68:71]
  v_mfma_f32_16x16x32_bf16 v[72:75], v[100:103], a[100:103], v[72:75]
  v_mfma_f32_16x16x32_bf16 v[76:79], v[100:103], a[132:135], v[76:79]
  v_mfma_f32_16x16x32_bf16 v[80:83], v[100:103], a[164:167], v[80:83]
  v_mfma_f32_16x16x32_bf16 v[84:87], v[100:103], a[196:199], v[84:87]
  v_mfma_f32_16x16x32_bf16 v[88:91], v[100:103], a[228:231], v[88:91]
  ds_read2_b32 v[100:101], v52 offset0:64 offset1:65
  ds_read2_b32 v[102:103], v52 offset0:66 offset1:67
  s_waitcnt lgkmcnt(6)
  v_mfma_f32_16x16x32_bf16 v[60:63], v[104:107], a[0:3], v[60:63]
  v_mfma_f32_16x16x32_bf16 v[64:67], v[104:107], a[32:35], v[64:67]
  v_mfma_f32_16x16x32_bf16 v[68:71], v[104:107], a[64:67], v[68:71]
  v_mfma_f32_16x16x32_bf16 v[72:75], v[104:107], a[96:99], v[72:75]
  v_mfma_f32_16x16x32_bf16 v[76:79], v[104:107], a[128:131], v[76:79]
  v_mfma_f32_16x16x32_bf16 v[80:83], v[104:107], a[160:163], v[80:83]
  v_mfma_f32_16x16x32_bf16 v[84:87], v[104:107], a[192:195], v[84:87]
  v_mfma_f32_16x16x32_bf16 v[88:91], v[104:107], a[224:227], v[88:91]
  ds_read2_b32 v[104:105], v52 offset0:48 offset1:49
  ds_read2_b32 v[106:107], v52 offset0:50 offset1:51
  s_waitcnt lgkmcnt(6)
  v_mfma_f32_16x16x32_bf16 v[64:67], v[92:95], a[28:31], v[64:67]
  v_mfma_f32_16x16x32_bf16 v[68:71], v[92:95], a[60:63], v[68:71]
  v_mfma_f32_16x16x32_bf16 v[72:75], v[92:95], a[92:95], v[72:75]
  v_mfma_f32_16x16x32_bf16 v[76:79], v[92:95], a[124:127], v[76:79]
  v_mfma_f32_16x16x32_bf16 v[80:83], v[92:95], a[156:159], v[80:83]
  v_mfma_f32_16x16x32_bf16 v[84:87], v[92:95], a[188:191], v[84:87]
  v_mfma_f32_16x16x32_bf16 v[88:91], v[92:95], a[220:223], v[88:91]
  ds_read2_b32 v[92:93], v52 offset0:32 offset1:33
  ds_read2_b32 v[94:95], v52 offset0:34 offset1:35
  s_waitcnt lgkmcnt(6)
  v_mfma_f32_16x16x32_bf16 v[64:67], v[96:99], a[24:27], v[64:67]
  v_mfma_f32_16x16x32_bf16 v[68:71], v[96:99], a[56:59], v[68:71]
  v_mfma_f32_16x16x32_bf16 v[72:75], v[96:99], a[88:91], v[72:75]
  v_mfma_f32_16x16x32_bf16 v[76:79], v[96:99], a[120:123], v[76:79]
  v_mfma_f32_16x16x32_bf16 v[80:83], v[96:99], a[152:155], v[80:83]
  v_mfma_f32_16x16x32_bf16 v[84:87], v[96:99], a[184:187], v[84:87]
  v_mfma_f32_16x16x32_bf16 v[88:91], v[96:99], a[216:219], v[88:91]
  ds_read2_b32 v[96:97], v52 offset0:16 offset1:17
  ds_read2_b32 v[98:99], v52 offset0:18 offset1:19
  s_waitcnt lgkmcnt(6)
  v_mfma_f32_16x16x32_bf16 v[64:67], v[100:103], a[20:23], v[64:67]
  v_mfma_f32_16x16x32_bf16 v[68:71], v[100:103], a[52:55], v[68:71]
  v_mfma_f32_16x16x32_bf16 v[72:75], v[100:103], a[84:87], v[72:75]
  v_mfma_f32_16x16x32_bf16 v[76:79], v[100:103], a[116:119], v[76:79]
  v_mfma_f32_16x16x32_bf16 v[80:83], v[100:103], a[148:151], v[80:83]
  v_mfma_f32_16x16x32_bf16 v[84:87], v[100:103], a[180:183], v[84:87]
  v_mfma_f32_16x16x32_bf16 v[88:91], v[100:103], a[212:215], v[88:91]
  ds_read2_b32 v[100:101], v52 offset0:0 offset1:1
  ds_read2_b32 v[102:103], v52 offset0:2 offset1:3
  s_waitcnt lgkmcnt(6)
  v_mfma_f32_16x16x32_bf16 v[64:67], v[104:107], a[16:19], v[64:67]
  v_mfma_f32_16x16x32_bf16 v[68:71], v[104:107], a[48:51], v[68:71]
  v_mfma_f32_16x16x32_bf16 v[72:75], v[104:107], a[80:83], v[72:75]
  v_mfma_f32_16x16x32_bf16 v[76:79], v[104:107], a[112:115], v[76:79]
  v_mfma_f32_16x16x32_bf16 v[80:83], v[104:107], a[144:147], v[80:83]
  v_mfma_f32_16x16x32_bf16 v[84:87], v[104:107], a[176:179], v[84:87]
  v_mfma_f32_16x16x32_bf16 v[88:91], v[104:107], a[208:211], v[88:91]
  ds_read2_b32 v[104:105], v53 offset0:224 offset1:225
  ds_read2_b32 v[106:107], v53 offset0:226 offset1:227
  s_waitcnt lgkmcnt(6)
  v_mfma_f32_16x16x32_bf16 v[64:67], v[92:95], a[12:15], v[64:67]
  v_mfma_f32_16x16x32_bf16 v[68:71], v[92:95], a[44:47], v[68:71]
  v_mfma_f32_16x16x32_bf16 v[72:75], v[92:95], a[76:79], v[72:75]
  v_mfma_f32_16x16x32_bf16 v[76:79], v[92:95], a[108:111], v[76:79]
  v_mfma_f32_16x16x32_bf16 v[80:83], v[92:95], a[140:143], v[80:83]
  v_mfma_f32_16x16x32_bf16 v[84:87], v[92:95], a[172:175], v[84:87]
  v_mfma_f32_16x16x32_bf16 v[88:91], v[92:95], a[204:207], v[88:91]
  ds_read2_b32 v[92:93], v53 offset0:208 offset1:209
  ds_read2_b32 v[94:95], v53 offset0:210 offset1:211
  s_waitcnt lgkmcnt(6)
  v_mfma_f32_16x16x32_bf16 v[64:67], v[96:99], a[8:11], v[64:67]
  v_mfma_f32_16x16x32_bf16 v[68:71], v[96:99], a[40:43], v[68:71]
  v_mfma_f32_16x16x32_bf16 v[72:75], v[96:99], a[72:75], v[72:75]
  v_mfma_f32_16x16x32_bf16 v[76:79], v[96:99], a[104:107], v[76:79]
  v_mfma_f32_16x16x32_bf16 v[80:83], v[96:99], a[136:139], v[80:83]
  v_mfma_f32_16x16x32_bf16 v[84:87], v[96:99], a[168:171], v[84:87]
  v_mfma_f32_16x16x32_bf16 v[88:91], v[96:99], a[200:203], v[88:91]
  ds_read2_b32 v[96:97], v53 offset0:192 offset1:193
  ds_read2_b32 v[98:99], v53 offset0:194 offset1:195
  s_waitcnt lgkmcnt(6)
  v_mfma_f32_16x16x32_bf16 v[64:67], v[100:103], a[4:7], v[64:67]
  v_mfma_f32_16x16x32_bf16 v[68:71], v[100:103], a[36:39], v[68:71]
  v_mfma_f32_16x16x32_bf16 v[72:75], v[100:103], a[68:71], v[72:75]
  v_mfma_f32_16x16x32_bf16 v[76:79], v[100:103], a[100:103], v[76:79]
  v_mfma_f32_16x16x32_bf16 v[80:83], v[100:103], a[132:135], v[80:83]
  v_mfma_f32_16x16x32_bf16 v[84:87], v[100:103], a[164:167], v[84:87]
  v_mfma_f32_16x16x32_bf16 v[88:91], v[100:103], a[196:199], v[88:91]
  ds_read2_b32 v[100:101], v53 offset0:176 offset1:177
  ds_read2_b32 v[102:103], v53 offset0:178 offset1:179
  s_waitcnt lgkmcnt(6)
  v_mfma_f32_16x16x32_bf16 v[64:67], v[104:107], a[0:3], v[64:67]
  v_mfma_f32_16x16x32_bf16 v[68:71], v[104:107], a[32:35], v[68:71]
  v_mfma_f32_16x16x32_bf16 v[72:75], v[104:107], a[64:67], v[72:75]
  v_mfma_f32_16x16x32_bf16 v[76:79], v[104:107], a[96:99], v[76:79]
  v_mfma_f32_16x16x32_bf16 v[80:83], v[104:107], a[128:131], v[80:83]
  v_mfma_f32_16x16x32_bf16 v[84:87], v[104:107], a[160:163], v[84:87]
  v_mfma_f32_16x16x32_bf16 v[88:91], v[104:107], a[192:195], v[88:91]
  ds_read2_b32 v[104:105], v53 offset0:160 offset1:161
  ds_read2_b32 v[106:107], v53 offset0:162 offset1:163
  s_waitcnt lgkmcnt(6)
  v_mfma_f32_16x16x32_bf16 v[68:71], v[92:95], a[28:31], v[68:71]
  v_mfma_f32_16x16x32_bf16 v[72:75], v[92:95], a[60:63], v[72:75]
  v_mfma_f32_16x16x32_bf16 v[76:79], v[92:95], a[92:95], v[76:79]
  v_mfma_f32_16x16x32_bf16 v[80:83], v[92:95], a[124:127], v[80:83]
  v_mfma_f32_16x16x32_bf16 v[84:87], v[92:95], a[156:159], v[84:87]
  v_mfma_f32_16x16x32_bf16 v[88:91], v[92:95], a[188:191], v[88:91]
  ds_read2_b32 v[92:93], v53 offset0:144 offset1:145
  ds_read2_b32 v[94:95], v53 offset0:146 offset1:147
  s_waitcnt lgkmcnt(6)
  v_mfma_f32_16x16x32_bf16 v[68:71], v[96:99], a[24:27], v[68:71]
  v_mfma_f32_16x16x32_bf16 v[72:75], v[96:99], a[56:59], v[72:75]
  v_mfma_f32_16x16x32_bf16 v[76:79], v[96:99], a[88:91], v[76:79]
  v_mfma_f32_16x16x32_bf16 v[80:83], v[96:99], a[120:123], v[80:83]
  v_mfma_f32_16x16x32_bf16 v[84:87], v[96:99], a[152:155], v[84:87]
  v_mfma_f32_16x16x32_bf16 v[88:91], v[96:99], a[184:187], v[88:91]
  ds_read2_b32 v[96:97], v53 offset0:128 offset1:129
  ds_read2_b32 v[98:99], v53 offset0:130 offset1:131
  s_waitcnt lgkmcnt(6)
  v_mfma_f32_16x16x32_bf16 v[68:71], v[100:103], a[20:23], v[68:71]
  v_mfma_f32_16x16x32_bf16 v[72:75], v[100:103], a[52:55], v[72:75]
  v_mfma_f32_16x16x32_bf16 v[76:79], v[100:103], a[84:87], v[76:79]
  v_mfma_f32_16x16x32_bf16 v[80:83], v[100:103], a[116:119], v[80:83]
  v_mfma_f32_16x16x32_bf16 v[84:87], v[100:103], a[148:151], v[84:87]
  v_mfma_f32_16x16x32_bf16 v[88:91], v[100:103], a[180:183], v[88:91]
  ds_read2_b32 v[100:101], v53 offset0:112 offset1:113
  ds_read2_b32 v[102:103], v53 offset0:114 offset1:115
  s_waitcnt lgkmcnt(6)
  v_mfma_f32_16x16x32_bf16 v[68:71], v[104:107], a[16:19], v[68:71]
  v_mfma_f32_16x16x32_bf16 v[72:75], v[104:107], a[48:51], v[72:75]
  v_mfma_f32_16x16x32_bf16 v[76:79], v[104:107], a[80:83], v[76:79]
  v_mfma_f32_16x16x32_bf16 v[80:83], v[104:107], a[112:115], v[80:83]
  v_mfma_f32_16x16x32_bf16 v[84:87], v[104:107], a[144:147], v[84:87]
  v_mfma_f32_16x16x32_bf16 v[88:91], v[104:107], a[176:179], v[88:91]
  ds_read2_b32 v[104:105], v53 offset0:96 offset1:97
  ds_read2_b32 v[106:107], v53 offset0:98 offset1:99
  s_waitcnt lgkmcnt(6)
  v_mfma_f32_16x16x32_bf16 v[68:71], v[92:95], a[12:15], v[68:71]
  v_mfma_f32_16x16x32_bf16 v[72:75], v[92:95], a[44:47], v[72:75]
  v_mfma_f32_16x16x32_bf16 v[76:79], v[92:95], a[76:79], v[76:79]
  v_mfma_f32_16x16x32_bf16 v[80:83], v[92:95], a[108:111], v[80:83]
  v_mfma_f32_16x16x32_bf16 v[84:87], v[92:95], a[140:143], v[84:87]
  v_mfma_f32_16x16x32_bf16 v[88:91], v[92:95], a[172:175], v[88:91]
  ds_read2_b32 v[92:93], v53 offset0:80 offset1:81
  ds_read2_b32 v[94:95], v53 offset0:82 offset1:83
  s_waitcnt lgkmcnt(6)
  v_mfma_f32_16x16x32_bf16 v[68:71], v[96:99], a[8:11], v[68:71]
  v_mfma_f32_16x16x32_bf16 v[72:75], v[96:99], a[40:43], v[72:75]
  v_mfma_f32_16x16x32_bf16 v[76:79], v[96:99], a[72:75], v[76:79]
  v_mfma_f32_16x16x32_bf16 v[80:83], v[96:99], a[104:107], v[80:83]
  v_mfma_f32_16x16x32_bf16 v[84:87], v[96:99], a[136:139], v[84:87]
  v_mfma_f32_16x16x32_bf16 v[88:91], v[96:99], a[168:171], v[88:91]
  ds_read2_b32 v[96:97], v53 offset0:64 offset1:65
  ds_read2_b32 v[98:99], v53 offset0:66 offset1:67
  s_waitcnt lgkmcnt(6)
  v_mfma_f32_16x16x32_bf16 v[68:71], v[100:103], a[4:7], v[68:71]
  v_mfma_f32_16x16x32_bf16 v[72:75], v[100:103], a[36:39], v[72:75]
  v_mfma_f32_16x16x32_bf16 v[76:79], v[100:103], a[68:71], v[76:79]
  v_mfma_f32_16x16x32_bf16 v[80:83], v[100:103], a[100:103], v[80:83]
  v_mfma_f32_16x16x32_bf16 v[84:87], v[100:103], a[132:135], v[84:87]
  v_mfma_f32_16x16x32_bf16 v[88:91], v[100:103], a[164:167], v[88:91]
  ds_read2_b32 v[100:101], v53 offset0:48 offset1:49
  ds_read2_b32 v[102:103], v53 offset0:50 offset1:51
  s_waitcnt lgkmcnt(6)
  v_mfma_f32_16x16x32_bf16 v[68:71], v[104:107], a[0:3], v[68:71]
  v_mfma_f32_16x16x32_bf16 v[72:75], v[104:107], a[32:35], v[72:75]
  v_mfma_f32_16x16x32_bf16 v[76:79], v[104:107], a[64:67], v[76:79]
  v_mfma_f32_16x16x32_bf16 v[80:83], v[104:107], a[96:99], v[80:83]
  v_mfma_f32_16x16x32_bf16 v[84:87], v[104:107], a[128:131], v[84:87]
  v_mfma_f32_16x16x32_bf16 v[88:91], v[104:107], a[160:163], v[88:91]
  ds_read2_b32 v[104:105], v53 offset0:32 offset1:33
  ds_read2_b32 v[106:107], v53 offset0:34 offset1:35
  s_waitcnt lgkmcnt(6)
  v_mfma_f32_16x16x32_bf16 v[72:75], v[92:95], a[28:31], v[72:75]
  v_mfma_f32_16x16x32_bf16 v[76:79], v[92:95], a[60:63], v[76:79]
  v_mfma_f32_16x16x32_bf16 v[80:83], v[92:95], a[92:95], v[80:83]
  v_mfma_f32_16x16x32_bf16 v[84:87], v[92:95], a[124:127], v[84:87]
  v_mfma_f32_16x16x32_bf16 v[88:91], v[92:95], a[156:159], v[88:91]
  ds_read2_b32 v[92:93], v53 offset0:16 offset1:17
  ds_read2_b32 v[94:95], v53 offset0:18 offset1:19
  s_waitcnt lgkmcnt(6)
  v_mfma_f32_16x16x32_bf16 v[72:75], v[96:99], a[24:27], v[72:75]
  v_mfma_f32_16x16x32_bf16 v[76:79], v[96:99], a[56:59], v[76:79]
  v_mfma_f32_16x16x32_bf16 v[80:83], v[96:99], a[88:91], v[80:83]
  v_mfma_f32_16x16x32_bf16 v[84:87], v[96:99], a[120:123], v[84:87]
  v_mfma_f32_16x16x32_bf16 v[88:91], v[96:99], a[152:155], v[88:91]
  ds_read2_b32 v[96:97], v53 offset0:0 offset1:1
  ds_read2_b32 v[98:99], v53 offset0:2 offset1:3
  s_waitcnt lgkmcnt(6)
  v_mfma_f32_16x16x32_bf16 v[72:75], v[100:103], a[20:23], v[72:75]
  v_mfma_f32_16x16x32_bf16 v[76:79], v[100:103], a[52:55], v[76:79]
  v_mfma_f32_16x16x32_bf16 v[80:83], v[100:103], a[84:87], v[80:83]
  v_mfma_f32_16x16x32_bf16 v[84:87], v[100:103], a[116:119], v[84:87]
  v_mfma_f32_16x16x32_bf16 v[88:91], v[100:103], a[148:151], v[88:91]
  ds_read2_b32 v[100:101], v54 offset0:224 offset1:225
  ds_read2_b32 v[102:103], v54 offset0:226 offset1:227
  s_waitcnt lgkmcnt(6)
  v_mfma_f32_16x16x32_bf16 v[72:75], v[104:107], a[16:19], v[72:75]
  v_mfma_f32_16x16x32_bf16 v[76:79], v[104:107], a[48:51], v[76:79]
  v_mfma_f32_16x16x32_bf16 v[80:83], v[104:107], a[80:83], v[80:83]
  v_mfma_f32_16x16x32_bf16 v[84:87], v[104:107], a[112:115], v[84:87]
  v_mfma_f32_16x16x32_bf16 v[88:91], v[104:107], a[144:147], v[88:91]
  ds_read2_b32 v[104:105], v54 offset0:208 offset1:209
  ds_read2_b32 v[106:107], v54 offset0:210 offset1:211
  s_waitcnt lgkmcnt(6)
  v_mfma_f32_16x16x32_bf16 v[72:75], v[92:95], a[12:15], v[72:75]
  v_mfma_f32_16x16x32_bf16 v[76:79], v[92:95], a[44:47], v[76:79]
  v_mfma_f32_16x16x32_bf16 v[80:83], v[92:95], a[76:79], v[80:83]
  v_mfma_f32_16x16x32_bf16 v[84:87], v[92:95], a[108:111], v[84:87]
  v_mfma_f32_16x16x32_bf16 v[88:91], v[92:95], a[140:143], v[88:91]
  ds_read2_b32 v[92:93], v54 offset0:192 offset1:193
  ds_read2_b32 v[94:95], v54 offset0:194 offset1:195
  s_waitcnt lgkmcnt(6)
  v_mfma_f32_16x16x32_bf16 v[72:75], v[96:99], a[8:11], v[72:75]
  v_mfma_f32_16x16x32_bf16 v[76:79], v[96:99], a[40:43], v[76:79]
  v_mfma_f32_16x16x32_bf16 v[80:83], v[96:99], a[72:75], v[80:83]
  v_mfma_f32_16x16x32_bf16 v[84:87], v[96:99], a[104:107], v[84:87]
  v_mfma_f32_16x16x32_bf16 v[88:91], v[96:99], a[136:139], v[88:91]
  ds_read2_b32 v[96:97], v54 offset0:176 offset1:177
  ds_read2_b32 v[98:99], v54 offset0:178 offset1:179
  s_waitcnt lgkmcnt(6)
  v_mfma_f32_16x16x32_bf16 v[72:75], v[100:103], a[4:7], v[72:75]
  v_mfma_f32_16x16x32_bf16 v[76:79], v[100:103], a[36:39], v[76:79]
  v_mfma_f32_16x16x32_bf16 v[80:83], v[100:103], a[68:71], v[80:83]
  v_mfma_f32_16x16x32_bf16 v[84:87], v[100:103], a[100:103], v[84:87]
  v_mfma_f32_16x16x32_bf16 v[88:91], v[100:103], a[132:135], v[88:91]
  ds_read2_b32 v[100:101], v54 offset0:160 offset1:161
  ds_read2_b32 v[102:103], v54 offset0:162 offset1:163
  s_waitcnt lgkmcnt(6)
  v_mfma_f32_16x16x32_bf16 v[72:75], v[104:107], a[0:3], v[72:75]
  v_mfma_f32_16x16x32_bf16 v[76:79], v[104:107], a[32:35], v[76:79]
  v_mfma_f32_16x16x32_bf16 v[80:83], v[104:107], a[64:67], v[80:83]
  v_mfma_f32_16x16x32_bf16 v[84:87], v[104:107], a[96:99], v[84:87]
  v_mfma_f32_16x16x32_bf16 v[88:91], v[104:107], a[128:131], v[88:91]
  ds_read2_b32 v[104:105], v54 offset0:144 offset1:145
  ds_read2_b32 v[106:107], v54 offset0:146 offset1:147
  s_waitcnt lgkmcnt(6)
  v_mfma_f32_16x16x32_bf16 v[76:79], v[92:95], a[28:31], v[76:79]
  v_mfma_f32_16x16x32_bf16 v[80:83], v[92:95], a[60:63], v[80:83]
  v_mfma_f32_16x16x32_bf16 v[84:87], v[92:95], a[92:95], v[84:87]
  v_mfma_f32_16x16x32_bf16 v[88:91], v[92:95], a[124:127], v[88:91]
  ds_read2_b32 v[92:93], v54 offset0:128 offset1:129
  ds_read2_b32 v[94:95], v54 offset0:130 offset1:131
  s_waitcnt lgkmcnt(6)
  v_mfma_f32_16x16x32_bf16 v[76:79], v[96:99], a[24:27], v[76:79]
  v_mfma_f32_16x16x32_bf16 v[80:83], v[96:99], a[56:59], v[80:83]
  v_mfma_f32_16x16x32_bf16 v[84:87], v[96:99], a[88:91], v[84:87]
  v_mfma_f32_16x16x32_bf16 v[88:91], v[96:99], a[120:123], v[88:91]
  ds_read2_b32 v[96:97], v54 offset0:112 offset1:113
  ds_read2_b32 v[98:99], v54 offset0:114 offset1:115
  s_waitcnt lgkmcnt(6)
  v_mfma_f32_16x16x32_bf16 v[76:79], v[100:103], a[20:23], v[76:79]
  v_mfma_f32_16x16x32_bf16 v[80:83], v[100:103], a[52:55], v[80:83]
  v_mfma_f32_16x16x32_bf16 v[84:87], v[100:103], a[84:87], v[84:87]
  v_mfma_f32_16x16x32_bf16 v[88:91], v[100:103], a[116:119], v[88:91]
  ds_read2_b32 v[100:101], v54 offset0:96 offset1:97
  ds_read2_b32 v[102:103], v54 offset0:98 offset1:99
  s_waitcnt lgkmcnt(6)
  v_mfma_f32_16x16x32_bf16 v[76:79], v[104:107], a[16:19], v[76:79]
  v_mfma_f32_16x16x32_bf16 v[80:83], v[104:107], a[48:51], v[80:83]
  v_mfma_f32_16x16x32_bf16 v[84:87], v[104:107], a[80:83], v[84:87]
  v_mfma_f32_16x16x32_bf16 v[88:91], v[104:107], a[112:115], v[88:91]
  ds_read2_b32 v[104:105], v54 offset0:80 offset1:81
  ds_read2_b32 v[106:107], v54 offset0:82 offset1:83
  s_waitcnt lgkmcnt(6)
  v_mfma_f32_16x16x32_bf16 v[76:79], v[92:95], a[12:15], v[76:79]
  v_mfma_f32_16x16x32_bf16 v[80:83], v[92:95], a[44:47], v[80:83]
  v_mfma_f32_16x16x32_bf16 v[84:87], v[92:95], a[76:79], v[84:87]
  v_mfma_f32_16x16x32_bf16 v[88:91], v[92:95], a[108:111], v[88:91]
  ds_read2_b32 v[92:93], v54 offset0:64 offset1:65
  ds_read2_b32 v[94:95], v54 offset0:66 offset1:67
  s_waitcnt lgkmcnt(6)
  v_mfma_f32_16x16x32_bf16 v[76:79], v[96:99], a[8:11], v[76:79]
  v_mfma_f32_16x16x32_bf16 v[80:83], v[96:99], a[40:43], v[80:83]
  v_mfma_f32_16x16x32_bf16 v[84:87], v[96:99], a[72:75], v[84:87]
  v_mfma_f32_16x16x32_bf16 v[88:91], v[96:99], a[104:107], v[88:91]
  ds_read2_b32 v[96:97], v54 offset0:48 offset1:49
  ds_read2_b32 v[98:99], v54 offset0:50 offset1:51
  s_waitcnt lgkmcnt(6)
  v_mfma_f32_16x16x32_bf16 v[76:79], v[100:103], a[4:7], v[76:79]
  v_mfma_f32_16x16x32_bf16 v[80:83], v[100:103], a[36:39], v[80:83]
  v_mfma_f32_16x16x32_bf16 v[84:87], v[100:103], a[68:71], v[84:87]
  v_mfma_f32_16x16x32_bf16 v[88:91], v[100:103], a[100:103], v[88:91]
  ds_read2_b32 v[100:101], v54 offset0:32 offset1:33
  ds_read2_b32 v[102:103], v54 offset0:34 offset1:35
  s_waitcnt lgkmcnt(6)
  v_mfma_f32_16x16x32_bf16 v[76:79], v[104:107], a[0:3], v[76:79]
  v_mfma_f32_16x16x32_bf16 v[80:83], v[104:107], a[32:35], v[80:83]
  v_mfma_f32_16x16x32_bf16 v[84:87], v[104:107], a[64:67], v[84:87]
  v_mfma_f32_16x16x32_bf16 v[88:91], v[104:107], a[96:99], v[88:91]
  ds_read2_b32 v[104:105], v54 offset0:16 offset1:17
  ds_read2_b32 v[106:107], v54 offset0:18 offset1:19
  s_waitcnt lgkmcnt(6)
  v_mfma_f32_16x16x32_bf16 v[80:83], v[92:95], a[28:31], v[80:83]
  v_mfma_f32_16x16x32_bf16 v[84:87], v[92:95], a[60:63], v[84:87]
  v_mfma_f32_16x16x32_bf16 v[88:91], v[92:95], a[92:95], v[88:91]
  ds_read2_b32 v[92:93], v54 offset0:0 offset1:1
  ds_read2_b32 v[94:95], v54 offset0:2 offset1:3
  s_waitcnt lgkmcnt(6)
  v_mfma_f32_16x16x32_bf16 v[80:83], v[96:99], a[24:27], v[80:83]
  v_mfma_f32_16x16x32_bf16 v[84:87], v[96:99], a[56:59], v[84:87]
  v_mfma_f32_16x16x32_bf16 v[88:91], v[96:99], a[88:91], v[88:91]
  ds_read2_b32 v[96:97], v55 offset0:224 offset1:225
  ds_read2_b32 v[98:99], v55 offset0:226 offset1:227
  s_waitcnt lgkmcnt(6)
  v_mfma_f32_16x16x32_bf16 v[80:83], v[100:103], a[20:23], v[80:83]
  v_mfma_f32_16x16x32_bf16 v[84:87], v[100:103], a[52:55], v[84:87]
  v_mfma_f32_16x16x32_bf16 v[88:91], v[100:103], a[84:87], v[88:91]
  ds_read2_b32 v[100:101], v55 offset0:208 offset1:209
  ds_read2_b32 v[102:103], v55 offset0:210 offset1:211
  s_waitcnt lgkmcnt(6)
  v_mfma_f32_16x16x32_bf16 v[80:83], v[104:107], a[16:19], v[80:83]
  v_mfma_f32_16x16x32_bf16 v[84:87], v[104:107], a[48:51], v[84:87]
  v_mfma_f32_16x16x32_bf16 v[88:91], v[104:107], a[80:83], v[88:91]
  ds_read2_b32 v[104:105], v55 offset0:192 offset1:193
  ds_read2_b32 v[106:107], v55 offset0:194 offset1:195
  s_waitcnt lgkmcnt(6)
  v_mfma_f32_16x16x32_bf16 v[80:83], v[92:95], a[12:15], v[80:83]
  v_mfma_f32_16x16x32_bf16 v[84:87], v[92:95], a[44:47], v[84:87]
  v_mfma_f32_16x16x32_bf16 v[88:91], v[92:95], a[76:79], v[88:91]
  ds_read2_b32 v[92:93], v55 offset0:176 offset1:177
  ds_read2_b32 v[94:95], v55 offset0:178 offset1:179
  s_waitcnt lgkmcnt(6)
  v_mfma_f32_16x16x32_bf16 v[80:83], v[96:99], a[8:11], v[80:83]
  v_mfma_f32_16x16x32_bf16 v[84:87], v[96:99], a[40:43], v[84:87]
  v_mfma_f32_16x16x32_bf16 v[88:91], v[96:99], a[72:75], v[88:91]
  ds_read2_b32 v[96:97], v55 offset0:160 offset1:161
  ds_read2_b32 v[98:99], v55 offset0:162 offset1:163
  s_waitcnt lgkmcnt(6)
  v_mfma_f32_16x16x32_bf16 v[80:83], v[100:103], a[4:7], v[80:83]
  v_mfma_f32_16x16x32_bf16 v[84:87], v[100:103], a[36:39], v[84:87]
  v_mfma_f32_16x16x32_bf16 v[88:91], v[100:103], a[68:71], v[88:91]
  ds_read2_b32 v[100:101], v55 offset0:144 offset1:145
  ds_read2_b32 v[102:103], v55 offset0:146 offset1:147
  s_waitcnt lgkmcnt(6)
  v_mfma_f32_16x16x32_bf16 v[80:83], v[104:107], a[0:3], v[80:83]
  v_mfma_f32_16x16x32_bf16 v[84:87], v[104:107], a[32:35], v[84:87]
  v_mfma_f32_16x16x32_bf16 v[88:91], v[104:107], a[64:67], v[88:91]
  ds_read2_b32 v[104:105], v55 offset0:128 offset1:129
  ds_read2_b32 v[106:107], v55 offset0:130 offset1:131
  s_waitcnt lgkmcnt(6)
  v_mfma_f32_16x16x32_bf16 v[84:87], v[92:95], a[28:31], v[84:87]
  v_mfma_f32_16x16x32_bf16 v[88:91], v[92:95], a[60:63], v[88:91]
  ds_read2_b32 v[92:93], v55 offset0:112 offset1:113
  ds_read2_b32 v[94:95], v55 offset0:114 offset1:115
  s_waitcnt lgkmcnt(6)
  v_mfma_f32_16x16x32_bf16 v[84:87], v[96:99], a[24:27], v[84:87]
  v_mfma_f32_16x16x32_bf16 v[88:91], v[96:99], a[56:59], v[88:91]
  ds_read2_b32 v[96:97], v55 offset0:96 offset1:97
  ds_read2_b32 v[98:99], v55 offset0:98 offset1:99
  s_waitcnt lgkmcnt(6)
  v_mfma_f32_16x16x32_bf16 v[84:87], v[100:103], a[20:23], v[84:87]
  v_mfma_f32_16x16x32_bf16 v[88:91], v[100:103], a[52:55], v[88:91]
  ds_read2_b32 v[100:101], v55 offset0:80 offset1:81
  ds_read2_b32 v[102:103], v55 offset0:82 offset1:83
  s_waitcnt lgkmcnt(6)
  v_mfma_f32_16x16x32_bf16 v[84:87], v[104:107], a[16:19], v[84:87]
  v_mfma_f32_16x16x32_bf16 v[88:91], v[104:107], a[48:51], v[88:91]
  ds_read2_b32 v[104:105], v55 offset0:64 offset1:65
  ds_read2_b32 v[106:107], v55 offset0:66 offset1:67
  s_waitcnt lgkmcnt(6)
  v_mfma_f32_16x16x32_bf16 v[84:87], v[92:95], a[12:15], v[84:87]
  v_mfma_f32_16x16x32_bf16 v[88:91], v[92:95], a[44:47], v[88:91]
  ds_read2_b32 v[92:93], v55 offset0:48 offset1:49
  ds_read2_b32 v[94:95], v55 offset0:50 offset1:51
  s_waitcnt lgkmcnt(6)
  v_mfma_f32_16x16x32_bf16 v[84:87], v[96:99], a[8:11], v[84:87]
  v_mfma_f32_16x16x32_bf16 v[88:91], v[96:99], a[40:43], v[88:91]
  ds_read2_b32 v[96:97], v55 offset0:32 offset1:33
  ds_read2_b32 v[98:99], v55 offset0:34 offset1:35
  s_waitcnt lgkmcnt(6)
  v_mfma_f32_16x16x32_bf16 v[84:87], v[100:103], a[4:7], v[84:87]
  v_mfma_f32_16x16x32_bf16 v[88:91], v[100:103], a[36:39], v[88:91]
  ds_read2_b32 v[100:101], v55 offset0:16 offset1:17
  ds_read2_b32 v[102:103], v55 offset0:18 offset1:19
  s_waitcnt lgkmcnt(6)
  v_mfma_f32_16x16x32_bf16 v[84:87], v[104:107], a[0:3], v[84:87]
  v_mfma_f32_16x16x32_bf16 v[88:91], v[104:107], a[32:35], v[88:91]
  ds_read2_b32 v[104:105], v55 offset0:0 offset1:1
  ds_read2_b32 v[106:107], v55 offset0:2 offset1:3
  s_waitcnt lgkmcnt(6)
  v_mfma_f32_16x16x32_bf16 v[88:91], v[92:95], a[28:31], v[88:91]
  ds_read2_b32 v[92:93], v56 offset0:224 offset1:225
  ds_read2_b32 v[94:95], v56 offset0:226 offset1:227
  s_waitcnt lgkmcnt(6)
  v_mfma_f32_16x16x32_bf16 v[88:91], v[96:99], a[24:27], v[88:91]
  ds_read2_b32 v[96:97], v56 offset0:208 offset1:209
  ds_read2_b32 v[98:99], v56 offset0:210 offset1:211
  s_waitcnt lgkmcnt(6)
  v_mfma_f32_16x16x32_bf16 v[88:91], v[100:103], a[20:23], v[88:91]
  ds_read2_b32 v[100:101], v56 offset0:192 offset1:193
  ds_read2_b32 v[102:103], v56 offset0:194 offset1:195
  s_waitcnt lgkmcnt(6)
  v_mfma_f32_16x16x32_bf16 v[88:91], v[104:107], a[16:19], v[88:91]
  ds_read2_b32 v[104:105], v56 offset0:176 offset1:177
  ds_read2_b32 v[106:107], v56 offset0:178 offset1:179
  s_waitcnt lgkmcnt(6)
  v_mfma_f32_16x16x32_bf16 v[88:91], v[92:95], a[12:15], v[88:91]
  s_waitcnt lgkmcnt(4)
  v_mfma_f32_16x16x32_bf16 v[88:91], v[96:99], a[8:11], v[88:91]
  s_waitcnt lgkmcnt(2)
  v_mfma_f32_16x16x32_bf16 v[88:91], v[100:103], a[4:7], v[88:91]
  s_waitcnt lgkmcnt(0)
  v_mfma_f32_16x16x32_bf16 v[88:91], v[104:107], a[0:3], v[88:91]
  v_lshlrev_b32 v46, 5, v4
  v_lshl_add_u32 v46, v3, 3, v46
  v_add_u32 v46, s17, v46
  ds_read_b64 v[108:109], v46 offset:512
  ds_read_b64 v[110:111], v46 offset:1024
  ds_read_b64 v[112:113], v46 offset:1536
  ds_read_b64 v[114:115], v46 offset:2048
  ds_read_b64 v[116:117], v46 offset:2560
  ds_read_b64 v[118:119], v46 offset:3072
  ds_read_b64 v[120:121], v46 offset:3584
  ds_read_b64 v[122:123], v46 offset:4096
  s_waitcnt lgkmcnt(0)
  v_lshlrev_b32 v124, 16, v108
  v_and_b32 v125, 0xffff0000, v108
  v_lshlrev_b32 v126, 16, v109
  v_and_b32 v127, 0xffff0000, v109
  v_mul_f32 v124, v124, v33
  v_mul_f32 v125, v125, v33
  v_mul_f32 v126, v126, v33
  v_mul_f32 v127, v127, v33
  v_cvt_pk_bf16_f32 v128, v124, v125
  v_cvt_pk_bf16_f32 v129, v126, v127
  v_cvt_pk_bf16_f32 v130, v60, v61
  v_cvt_pk_bf16_f32 v131, v62, v63
  v_lshlrev_b32 v124, 16, v128
  v_and_b32 v125, 0xffff0000, v128
  v_lshlrev_b32 v132, 16, v130
  v_and_b32 v133, 0xffff0000, v130
  v_lshlrev_b32 v126, 16, v129
  v_and_b32 v127, 0xffff0000, v129
  v_lshlrev_b32 v134, 16, v131
  v_and_b32 v135, 0xffff0000, v131
  v_add_f32 v124, v124, v132
  v_add_f32 v125, v125, v133
  v_add_f32 v126, v126, v134
  v_add_f32 v127, v127, v135
  v_cvt_pk_bf16_f32 v108, v124, v125
  v_cvt_pk_bf16_f32 v109, v126, v127
  ds_write_b64 v46, v[108:109] offset:512
  v_lshlrev_b32 v124, 16, v110
  v_and_b32 v125, 0xffff0000, v110
  v_lshlrev_b32 v126, 16, v111
  v_and_b32 v127, 0xffff0000, v111
  v_mul_f32 v124, v124, v33
  v_mul_f32 v125, v125, v33
  v_mul_f32 v126, v126, v33
  v_mul_f32 v127, v127, v33
  v_cvt_pk_bf16_f32 v128, v124, v125
  v_cvt_pk_bf16_f32 v129, v126, v127
  v_cvt_pk_bf16_f32 v130, v64, v65
  v_cvt_pk_bf16_f32 v131, v66, v67
  v_lshlrev_b32 v124, 16, v128
  v_and_b32 v125, 0xffff0000, v128
  v_lshlrev_b32 v132, 16, v130
  v_and_b32 v133, 0xffff0000, v130
  v_lshlrev_b32 v126, 16, v129
  v_and_b32 v127, 0xffff0000, v129
  v_lshlrev_b32 v134, 16, v131
  v_and_b32 v135, 0xffff0000, v131
  v_add_f32 v124, v124, v132
  v_add_f32 v125, v125, v133
  v_add_f32 v126, v126, v134
  v_add_f32 v127, v127, v135
  v_cvt_pk_bf16_f32 v110, v124, v125
  v_cvt_pk_bf16_f32 v111, v126, v127
  ds_write_b64 v46, v[110:111] offset:1024
  v_lshlrev_b32 v124, 16, v112
  v_and_b32 v125, 0xffff0000, v112
  v_lshlrev_b32 v126, 16, v113
  v_and_b32 v127, 0xffff0000, v113
  v_mul_f32 v124, v124, v33
  v_mul_f32 v125, v125, v33
  v_mul_f32 v126, v126, v33
  v_mul_f32 v127, v127, v33
  v_cvt_pk_bf16_f32 v128, v124, v125
  v_cvt_pk_bf16_f32 v129, v126, v127
  v_cvt_pk_bf16_f32 v130, v68, v69
  v_cvt_pk_bf16_f32 v131, v70, v71
  v_lshlrev_b32 v124, 16, v128
  v_and_b32 v125, 0xffff0000, v128
  v_lshlrev_b32 v132, 16, v130
  v_and_b32 v133, 0xffff0000, v130
  v_lshlrev_b32 v126, 16, v129
  v_and_b32 v127, 0xffff0000, v129
  v_lshlrev_b32 v134, 16, v131
  v_and_b32 v135, 0xffff0000, v131
  v_add_f32 v124, v124, v132
  v_add_f32 v125, v125, v133
  v_add_f32 v126, v126, v134
  v_add_f32 v127, v127, v135
  v_cvt_pk_bf16_f32 v112, v124, v125
  v_cvt_pk_bf16_f32 v113, v126, v127
  ds_write_b64 v46, v[112:113] offset:1536
  v_lshlrev_b32 v124, 16, v114
  v_and_b32 v125, 0xffff0000, v114
  v_lshlrev_b32 v126, 16, v115
  v_and_b32 v127, 0xffff0000, v115
  v_mul_f32 v124, v124, v33
  v_mul_f32 v125, v125, v33
  v_mul_f32 v126, v126, v33
  v_mul_f32 v127, v127, v33
  v_cvt_pk_bf16_f32 v128, v124, v125
  v_cvt_pk_bf16_f32 v129, v126, v127
  v_cvt_pk_bf16_f32 v130, v72, v73
  v_cvt_pk_bf16_f32 v131, v74, v75
  v_lshlrev_b32 v124, 16, v128
  v_and_b32 v125, 0xffff0000, v128
  v_lshlrev_b32 v132, 16, v130
  v_and_b32 v133, 0xffff0000, v130
  v_lshlrev_b32 v126, 16, v129
  v_and_b32 v127, 0xffff0000, v129
  v_lshlrev_b32 v134, 16, v131
  v_and_b32 v135, 0xffff0000, v131
  v_add_f32 v124, v124, v132
  v_add_f32 v125, v125, v133
  v_add_f32 v126, v126, v134
  v_add_f32 v127, v127, v135
  v_cvt_pk_bf16_f32 v114, v124, v125
  v_cvt_pk_bf16_f32 v115, v126, v127
  ds_write_b64 v46, v[114:115] offset:2048
  v_lshlrev_b32 v124, 16, v116
  v_and_b32 v125, 0xffff0000, v116
  v_lshlrev_b32 v126, 16, v117
  v_and_b32 v127, 0xffff0000, v117
  v_mul_f32 v124, v124, v33
  v_mul_f32 v125, v125, v33
  v_mul_f32 v126, v126, v33
  v_mul_f32 v127, v127, v33
  v_cvt_pk_bf16_f32 v128, v124, v125
  v_cvt_pk_bf16_f32 v129, v126, v127
  v_cvt_pk_bf16_f32 v130, v76, v77
  v_cvt_pk_bf16_f32 v131, v78, v79
  v_lshlrev_b32 v124, 16, v128
  v_and_b32 v125, 0xffff0000, v128
  v_lshlrev_b32 v132, 16, v130
  v_and_b32 v133, 0xffff0000, v130
  v_lshlrev_b32 v126, 16, v129
  v_and_b32 v127, 0xffff0000, v129
  v_lshlrev_b32 v134, 16, v131
  v_and_b32 v135, 0xffff0000, v131
  v_add_f32 v124, v124, v132
  v_add_f32 v125, v125, v133
  v_add_f32 v126, v126, v134
  v_add_f32 v127, v127, v135
  v_cvt_pk_bf16_f32 v116, v124, v125
  v_cvt_pk_bf16_f32 v117, v126, v127
  ds_write_b64 v46, v[116:117] offset:2560
  v_lshlrev_b32 v124, 16, v118
  v_and_b32 v125, 0xffff0000, v118
  v_lshlrev_b32 v126, 16, v119
  v_and_b32 v127, 0xffff0000, v119
  v_mul_f32 v124, v124, v33
  v_mul_f32 v125, v125, v33
  v_mul_f32 v126, v126, v33
  v_mul_f32 v127, v127, v33
  v_cvt_pk_bf16_f32 v128, v124, v125
  v_cvt_pk_bf16_f32 v129, v126, v127
  v_cvt_pk_bf16_f32 v130, v80, v81
  v_cvt_pk_bf16_f32 v131, v82, v83
  v_lshlrev_b32 v124, 16, v128
  v_and_b32 v125, 0xffff0000, v128
  v_lshlrev_b32 v132, 16, v130
  v_and_b32 v133, 0xffff0000, v130
  v_lshlrev_b32 v126, 16, v129
  v_and_b32 v127, 0xffff0000, v129
  v_lshlrev_b32 v134, 16, v131
  v_and_b32 v135, 0xffff0000, v131
  v_add_f32 v124, v124, v132
  v_add_f32 v125, v125, v133
  v_add_f32 v126, v126, v134
  v_add_f32 v127, v127, v135
  v_cvt_pk_bf16_f32 v118, v124, v125
  v_cvt_pk_bf16_f32 v119, v126, v127
  ds_write_b64 v46, v[118:119] offset:3072
  v_lshlrev_b32 v124, 16, v120
  v_and_b32 v125, 0xffff0000, v120
  v_lshlrev_b32 v126, 16, v121
  v_and_b32 v127, 0xffff0000, v121
  v_mul_f32 v124, v124, v33
  v_mul_f32 v125, v125, v33
  v_mul_f32 v126, v126, v33
  v_mul_f32 v127, v127, v33
  v_cvt_pk_bf16_f32 v128, v124, v125
  v_cvt_pk_bf16_f32 v129, v126, v127
  v_cvt_pk_bf16_f32 v130, v84, v85
  v_cvt_pk_bf16_f32 v131, v86, v87
  v_lshlrev_b32 v124, 16, v128
  v_and_b32 v125, 0xffff0000, v128
  v_lshlrev_b32 v132, 16, v130
  v_and_b32 v133, 0xffff0000, v130
  v_lshlrev_b32 v126, 16, v129
  v_and_b32 v127, 0xffff0000, v129
  v_lshlrev_b32 v134, 16, v131
  v_and_b32 v135, 0xffff0000, v131
  v_add_f32 v124, v124, v132
  v_add_f32 v125, v125, v133
  v_add_f32 v126, v126, v134
  v_add_f32 v127, v127, v135
  v_cvt_pk_bf16_f32 v120, v124, v125
  v_cvt_pk_bf16_f32 v121, v126, v127
  ds_write_b64 v46, v[120:121] offset:3584
  v_lshlrev_b32 v124, 16, v122
  v_and_b32 v125, 0xffff0000, v122
  v_lshlrev_b32 v126, 16, v123
  v_and_b32 v127, 0xffff0000, v123
  v_mul_f32 v124, v124, v33
  v_mul_f32 v125, v125, v33
  v_mul_f32 v126, v126, v33
  v_mul_f32 v127, v127, v33
  v_cvt_pk_bf16_f32 v128, v124, v125
  v_cvt_pk_bf16_f32 v129, v126, v127
  v_cvt_pk_bf16_f32 v130, v88, v89
  v_cvt_pk_bf16_f32 v131, v90, v91
  v_lshlrev_b32 v124, 16, v128
  v_and_b32 v125, 0xffff0000, v128
  v_lshlrev_b32 v132, 16, v130
  v_and_b32 v133, 0xffff0000, v130
  v_lshlrev_b32 v126, 16, v129
  v_and_b32 v127, 0xffff0000, v129
  v_lshlrev_b32 v134, 16, v131
  v_and_b32 v135, 0xffff0000, v131
  v_add_f32 v124, v124, v132
  v_add_f32 v125, v125, v133
  v_add_f32 v126, v126, v134
  v_add_f32 v127, v127, v135
  v_cvt_pk_bf16_f32 v122, v124, v125
  v_cvt_pk_bf16_f32 v123, v126, v127
  ds_write_b64 v46, v[122:123] offset:4096
  s_waitcnt lgkmcnt(0)
  s_barrier
  v_lshlrev_b32 v6, 3, v0
  v_mul_u32_u24 v5, 7168, v0
  v_add_u32 v36, 512, v6
  ds_read_b64 v[8:9], v36
  v_add_u32 v36, 25088, v6
  ds_read_b64 v[10:11], v36
  v_add_u32 v36, 49664, v6
  ds_read_b64 v[12:13], v36
  v_add_u32 v36, 74240, v6
  ds_read_b64 v[14:15], v36
  s_waitcnt lgkmcnt(0)
  s_add_u32 s22, s21, 0
  s_add_u32 s23, s22, 3584
  v_perm_b32 v16, v10, v8, s24
  v_perm_b32 v17, v14, v12, s24
  buffer_store_dwordx2 v[16:17], v5, s[88:91], s22 offen offset:0
  v_perm_b32 v18, v10, v8, s25
  v_perm_b32 v19, v14, v12, s25
  buffer_store_dwordx2 v[18:19], v5, s[88:91], s22 offen offset:1792
  v_perm_b32 v20, v11, v9, s24
  v_perm_b32 v21, v15, v13, s24
  buffer_store_dwordx2 v[20:21], v5, s[88:91], s23 offen offset:0
  v_perm_b32 v22, v11, v9, s25
  v_perm_b32 v23, v15, v13, s25
  buffer_store_dwordx2 v[22:23], v5, s[88:91], s23 offen offset:1792
  v_add_u32 v36, 2560, v6
  ds_read_b64 v[8:9], v36
  v_add_u32 v36, 27136, v6
  ds_read_b64 v[10:11], v36
  v_add_u32 v36, 51712, v6
  ds_read_b64 v[12:13], v36
  v_add_u32 v36, 76288, v6
  ds_read_b64 v[14:15], v36
  s_waitcnt lgkmcnt(0)
  s_add_u32 s22, s21, 1835008
  s_add_u32 s23, s22, 3584
  v_perm_b32 v24, v10, v8, s24
  v_perm_b32 v25, v14, v12, s24
  buffer_store_dwordx2 v[24:25], v5, s[88:91], s22 offen offset:0
  v_perm_b32 v26, v10, v8, s25
  v_perm_b32 v27, v14, v12, s25
  buffer_store_dwordx2 v[26:27], v5, s[88:91], s22 offen offset:1792
  v_perm_b32 v28, v11, v9, s24
  v_perm_b32 v29, v15, v13, s24
  buffer_store_dwordx2 v[28:29], v5, s[88:91], s23 offen offset:0
  v_perm_b32 v30, v11, v9, s25
  v_perm_b32 v31, v15, v13, s25
  buffer_store_dwordx2 v[30:31], v5, s[88:91], s23 offen offset:1792
  s_branch wk_loop
wk_tok:
  s_sub_u32 s3, s3, 752
  s_cmp_ge_u32 s3, 512
  s_cbranch_scc1 wk_done
  s_and_b32 s18, s3, 3
  s_lshr_b32 s17, s3, 2
  s_cmp_lt_u32 s17, 8
  s_cbranch_scc1 wk_tokp
  s_sub_u32 s20, s17, 8
  s_sub_u32 s17, s17, 64
  s_cmp_ge_u32 s20, 112
  s_cbranch_scc1 wk_toko
  s_lshr_b32 s17, s20, 1
  s_bitcmp0_b32 s20, 0
  s_cbranch_scc1 wk_toko
  s_add_u32 s17, s17, 8
wk_tokp:
  s_lshl_b32 s20, s18, 2
  s_add_u32 s20, s20, s16
  s_lshl_b32 s21, s17, 4
  s_add_u32 s21, s21, s20
  s_mul_i32 s21, s21, 28672
  s_add_u32 s21, s21, 46399488
  s_mul_i32 s23, s17, 28672
  s_add_u32 s23, s23, 75759616
  s_mul_i32 s24, s17, 7168
  s_add_u32 s24, s24, 65536
  s_lshr_b32 s25, s17, 3
  s_lshl_b32 s25, s25, 4
  s_add_u32 s25, s25, s20
  s_lshl_b32 s25, s25, 7
  s_add_u32 s25, s25, 540672
  v_mov_b32 v60, 0
  s_mov_b32 s30, 0
wp_wf:
  buffer_load_dword v61, v60, s[8:11], s25 offen sc1
  s_waitcnt vmcnt(0)
  v_cmp_ne_u32 vcc, 56, v61
  s_cbranch_vccz wp_wf_ok
  s_sleep 4
  s_cmp_ge_u32 s17, 50
  s_cbranch_scc1 wp_wf_bo
  s_sleep 64
wp_wf_bo:
  s_add_u32 s30, s30, 1
  s_cmp_lt_u32 s30, 2000000
  s_cbranch_scc1 wp_wf
  s_branch wp_abort
wp_wf_ok:
  s_lshl_b32 s25, s17, 1
  s_mul_i32 s25, s25, 20480
  s_add_u32 s25, s25, 86114304
  s_lshl_b32 s26, s20, 10
  s_add_u32 s26, s26, s25
  s_lshl_b32 s27, s18, 10
  s_add_u32 s27, s27, s25
  s_lshr_b32 s28, s16, 1
  s_lshl_b32 s28, s28, 3
  s_add_u32 s27, s27, s28
  s_add_u32 s27, s27, 16384
  s_and_b32 s28, s16, 1
  s_cmp_eq_u32 s28, 0
  s_cselect_b32 s50, -1, 0
  s_cselect_b32 s51, 0, -1
  v_mov_b32 v44, -1
  v_mov_b32 v45, -1
  v_mov_b32 v46, -1
  v_mov_b32 v47, -1
  s_add_u32 s28, s26, 0
  s_add_u32 s29, s27, 0
  buffer_store_dwordx4 v[44:47], v2, s[8:11], s28 offen sc1
  s_mov_b64 exec, s[50:51]
  buffer_store_dwordx2 v[44:45], v2, s[8:11], s29 offen sc1
  s_mov_b64 exec, -1
  s_add_u32 s28, s26, 20480
  s_add_u32 s29, s27, 20480
  buffer_store_dwordx4 v[44:47], v2, s[8:11], s28 offen sc1
  s_mov_b64 exec, s[50:51]
  buffer_store_dwordx2 v[44:45], v2, s[8:11], s29 offen sc1
  s_mov_b64 exec, -1
  s_add_u32 s22, s21, 0
  buffer_load_dwordx4 a[0:3], v2, s[8:11], s22 offen offset:0 sc1
  buffer_load_dwordx4 a[4:7], v2, s[8:11], s22 offen offset:1024 sc1
  buffer_load_dwordx4 a[8:11], v2, s[8:11], s22 offen offset:2048 sc1
  buffer_load_dwordx4 a[12:15], v2, s[8:11], s22 offen offset:3072 sc1
  s_add_u32 s22, s21, 4096
  buffer_load_dwordx4 a[16:19], v2, s[8:11], s22 offen offset:0 sc1
  buffer_load_dwordx4 a[20:23], v2, s[8:11], s22 offen offset:1024 sc1
  buffer_load_dwordx4 a[24:27], v2, s[8:11], s22 offen offset:2048 sc1
  buffer_load_dwordx4 a[28:31], v2, s[8:11], s22 offen offset:3072 sc1
  s_add_u32 s22, s21, 8192
  buffer_load_dwordx4 a[32:35], v2, s[8:11], s22 offen offset:0 sc1
  buffer_load_dwordx4 a[36:39], v2, s[8:11], s22 offen offset:1024 sc1
  buffer_load_dwordx4 a[40:43], v2, s[8:11], s22 offen offset:2048 sc1
  buffer_load_dwordx4 a[44:47], v2, s[8:11], s22 offen offset:3072 sc1
  s_add_u32 s22, s21, 12288
  buffer_load_dwordx4 a[48:51], v2, s[8:11], s22 offen offset:0 sc1
  buffer_load_dwordx4 a[52:55], v2, s[8:11], s22 offen offset:1024 sc1
  buffer_load_dwordx4 a[56:59], v2, s[8:11], s22 offen offset:2048 sc1
  buffer_load_dwordx4 a[60:63], v2, s[8:11], s22 offen offset:3072 sc1
  s_add_u32 s22, s21, 16384
  buffer_load_dwordx4 a[64:67], v2, s[8:11], s22 offen offset:0 sc1
  buffer_load_dwordx4 a[68:71], v2, s[8:11], s22 offen offset:1024 sc1
  buffer_load_dwordx4 a[72:75], v2, s[8:11], s22 offen offset:2048 sc1
  buffer_load_dwordx4 a[76:79], v2, s[8:11], s22 offen offset:3072 sc1
  s_add_u32 s22, s21, 20480
  buffer_load_dwordx4 a[80:83], v2, s[8:11], s22 offen offset:0 sc1
  buffer_load_dwordx4 a[84:87], v2, s[8:11], s22 offen offset:1024 sc1
  buffer_load_dwordx4 a[88:91], v2, s[8:11], s22 offen offset:2048 sc1
  buffer_load_dwordx4 a[92:95], v2, s[8:11], s22 offen offset:3072 sc1
  s_add_u32 s22, s21, 24576
  buffer_load_dwordx4 a[96:99], v2, s[8:11], s22 offen offset:0 sc1
  buffer_load_dwordx4 a[100:103], v2, s[8:11], s22 offen offset:1024 sc1
  buffer_load_dwordx4 a[104:107], v2, s[8:11], s22 offen offset:2048 sc1
  buffer_load_dwordx4 a[108:111], v2, s[8:11], s22 offen offset:3072 sc1
  s_add_u32 s22, s23, 0
  buffer_load_dwordx4 a[112:115], v2, s[8:11], s22 offen offset:0 sc1
  buffer_load_dwordx4 a[116:119], v2, s[8:11], s22 offen offset:1024 sc1
  buffer_load_dwordx4 a[120:123], v2, s[8:11], s22 offen offset:2048 sc1
  buffer_load_dwordx4 a[124:127], v2, s[8:11], s22 offen offset:3072 sc1
  s_add_u32 s22, s23, 4096
  buffer_load_dwordx4 a[128:131], v2, s[8:11], s22 offen offset:0 sc1
  buffer_load_dwordx4 a[132:135], v2, s[8:11], s22 offen offset:1024 sc1
  buffer_load_dwordx4 a[136:139], v2, s[8:11], s22 offen offset:2048 sc1
  buffer_load_dwordx4 a[140:143], v2, s[8:11], s22 offen offset:3072 sc1
  s_add_u32 s22, s23, 8192
  buffer_load_dwordx4 a[144:147], v2, s[8:11], s22 offen offset:0 sc1
  buffer_load_dwordx4 a[148:151], v2, s[8:11], s22 offen offset:1024 sc1
  buffer_load_dwordx4 a[152:155], v2, s[8:11], s22 offen offset:2048 sc1
  buffer_load_dwordx4 a[156:159], v2, s[8:11], s22 offen offset:3072 sc1
  s_add_u32 s22, s23, 12288
  buffer_load_dwordx4 a[160:163], v2, s[8:11], s22 offen offset:0 sc1
  buffer_load_dwordx4 a[164:167], v2, s[8:11], s22 offen offset:1024 sc1
  buffer_load_dwordx4 a[168:171], v2, s[8:11], s22 offen offset:2048 sc1
  buffer_load_dwordx4 a[172:175], v2, s[8:11], s22 offen offset:3072 sc1
  s_add_u32 s22, s23, 16384
  buffer_load_dwordx4 a[176:179], v2, s[8:11], s22 offen offset:0 sc1
  buffer_load_dwordx4 a[180:183], v2, s[8:11], s22 offen offset:1024 sc1
  buffer_load_dwordx4 a[184:187], v2, s[8:11], s22 offen offset:2048 sc1
  buffer_load_dwordx4 a[188:191], v2, s[8:11], s22 offen offset:3072 sc1
  s_add_u32 s22, s23, 20480
  buffer_load_dwordx4 a[192:195], v2, s[8:11], s22 offen offset:0 sc1
  buffer_load_dwordx4 a[196:199], v2, s[8:11], s22 offen offset:1024 sc1
  buffer_load_dwordx4 a[200:203], v2, s[8:11], s22 offen offset:2048 sc1
  buffer_load_dwordx4 a[204:207], v2, s[8:11], s22 offen offset:3072 sc1
  s_add_u32 s22, s23, 24576
  buffer_load_dwordx4 a[208:211], v2, s[8:11], s22 offen offset:0 sc1
  buffer_load_dwordx4 a[212:215], v2, s[8:11], s22 offen offset:1024 sc1
  buffer_load_dwordx4 a[216:219], v2, s[8:11], s22 offen offset:2048 sc1
  buffer_load_dwordx4 a[220:223], v2, s[8:11], s22 offen offset:3072 sc1
  v_lshl_add_u32 v5, v3, 2, 0
  v_cmp_le_u32 s[40:41], v5, v4
  v_lshl_add_u32 v5, v3, 2, 1
  v_cmp_le_u32 s[42:43], v5, v4
  v_lshl_add_u32 v5, v3, 2, 2
  v_cmp_le_u32 s[44:45], v5, v4
  v_lshl_add_u32 v5, v3, 2, 3
  v_cmp_le_u32 s[46:47], v5, v4
  v_cmp_gt_u32 s[48:49], 2, v3
  v_mov_b32 v6, 0xff800000
  s_waitcnt vmcnt(0)
  s_lshl_b32 s25, s17, 7
  s_add_u32 s25, s25, 557056
  v_mov_b32 v5, 1
  v_mov_b32 v7, 0
  s_waitcnt vmcnt(0)
  s_mov_b64 exec, 1
  buffer_atomic_add v5, v7, s[8:11], s25 offen
  s_mov_b64 exec, -1
  v_mfma_f32_16x16x32_bf16 v[8:11], a[112:115], a[0:3], 0
  v_mfma_f32_16x16x32_bf16 v[12:15], a[112:115], a[56:59], 0
  v_mfma_f32_16x16x32_bf16 v[16:19], a[168:171], a[56:59], 0
  v_mfma_f32_16x16x32_bf16 v[8:11], a[116:119], a[4:7], v[8:11]
  v_mfma_f32_16x16x32_bf16 v[12:15], a[116:119], a[60:63], v[12:15]
  v_mfma_f32_16x16x32_bf16 v[16:19], a[172:175], a[60:63], v[16:19]
  v_mfma_f32_16x16x32_bf16 v[8:11], a[120:123], a[8:11], v[8:11]
  v_mfma_f32_16x16x32_bf16 v[12:15], a[120:123], a[64:67], v[12:15]
  v_mfma_f32_16x16x32_bf16 v[16:19], a[176:179], a[64:67], v[16:19]
  v_mfma_f32_16x16x32_bf16 v[8:11], a[124:127], a[12:15], v[8:11]
  v_mfma_f32_16x16x32_bf16 v[12:15], a[124:127], a[68:71], v[12:15]
  v_mfma_f32_16x16x32_bf16 v[16:19], a[180:183], a[68:71], v[16:19]
  v_mfma_f32_16x16x32_bf16 v[8:11], a[128:131], a[16:19], v[8:11]
  v_mfma_f32_16x16x32_bf16 v[12:15], a[128:131], a[72:75], v[12:15]
  v_mfma_f32_16x16x32_bf16 v[16:19], a[184:187], a[72:75], v[16:19]
  v_mfma_f32_16x16x32_bf16 v[8:11], a[132:135], a[20:23], v[8:11]
  v_mfma_f32_16x16x32_bf16 v[12:15], a[132:135], a[76:79], v[12:15]
  v_mfma_f32_16x16x32_bf16 v[16:19], a[188:191], a[76:79], v[16:19]
  v_mfma_f32_16x16x32_bf16 v[8:11], a[136:139], a[24:27], v[8:11]
  v_mfma_f32_16x16x32_bf16 v[12:15], a[136:139], a[80:83], v[12:15]
  v_mfma_f32_16x16x32_bf16 v[16:19], a[192:195], a[80:83], v[16:19]
  v_mfma_f32_16x16x32_bf16 v[8:11], a[140:143], a[28:31], v[8:11]
  v_mfma_f32_16x16x32_bf16 v[12:15], a[140:143], a[84:87], v[12:15]
  v_mfma_f32_16x16x32_bf16 v[16:19], a[196:199], a[84:87], v[16:19]
  v_mfma_f32_16x16x32_bf16 v[8:11], a[144:147], a[32:35], v[8:11]
  v_mfma_f32_16x16x32_bf16 v[12:15], a[144:147], a[88:91], v[12:15]
  v_mfma_f32_16x16x32_bf16 v[16:19], a[200:203], a[88:91], v[16:19]
  v_mfma_f32_16x16x32_bf16 v[8:11], a[148:151], a[36:39], v[8:11]
  v_mfma_f32_16x16x32_bf16 v[12:15], a[148:151], a[92:95], v[12:15]
  v_mfma_f32_16x16x32_bf16 v[16:19], a[204:207], a[92:95], v[16:19]
  v_mfma_f32_16x16x32_bf16 v[8:11], a[152:155], a[40:43], v[8:11]
  v_mfma_f32_16x16x32_bf16 v[12:15], a[152:155], a[96:99], v[12:15]
  v_mfma_f32_16x16x32_bf16 v[16:19], a[208:211], a[96:99], v[16:19]
  v_mfma_f32_16x16x32_bf16 v[8:11], a[156:159], a[44:47], v[8:11]
  v_mfma_f32_16x16x32_bf16 v[12:15], a[156:159], a[100:103], v[12:15]
  v_mfma_f32_16x16x32_bf16 v[16:19], a[212:215], a[100:103], v[16:19]
  v_mfma_f32_16x16x32_bf16 v[8:11], a[160:163], a[48:51], v[8:11]
  v_mfma_f32_16x16x32_bf16 v[12:15], a[160:163], a[104:107], v[12:15]
  v_mfma_f32_16x16x32_bf16 v[16:19], a[216:219], a[104:107], v[16:19]
  v_mfma_f32_16x16x32_bf16 v[8:11], a[164:167], a[52:55], v[8:11]
  v_mfma_f32_16x16x32_bf16 v[12:15], a[164:167], a[108:111], v[12:15]
  v_mfma_f32_16x16x32_bf16 v[16:19], a[220:223], a[108:111], v[16:19]
  s_mul_i32 s22, s20, 448
  s_add_u32 s22, s22, s24
  s_mov_b32 s31, 0
  v_mov_b32 v62, s22
  s_mov_b32 s30, 0
wp_pm:
  s_cmp_ge_u32 s17, 64
  s_cbranch_scc1 wp_pf
  buffer_load_dword v61, v62, s[8:11], 0 offen sc1
  s_waitcnt vmcnt(0)
  v_subrev_u32 v61, s31, v61
  v_cmp_eq_u32 vcc, -1, v61
  s_cbranch_vccnz wp_pr
wp_pf:
  s_add_u32 s22, s24, 4096
  buffer_load_dwordx4 v[64:67], v2, s[8:11], s24 offen offset:0 sc1
  buffer_load_dwordx4 v[68:71], v2, s[8:11], s24 offen offset:1024 sc1
  buffer_load_dwordx4 v[72:75], v2, s[8:11], s24 offen offset:2048 sc1
  buffer_load_dwordx4 v[76:79], v2, s[8:11], s24 offen offset:3072 sc1
  buffer_load_dwordx4 v[80:83], v2, s[8:11], s22 offen offset:0 sc1
  buffer_load_dwordx4 v[84:87], v2, s[8:11], s22 offen offset:1024 sc1
  buffer_load_dwordx4 v[88:91], v2, s[8:11], s22 offen offset:2048 sc1
  s_waitcnt vmcnt(0)
  v_max_u32 v61, v64, v65
  v_max3_u32 v61, v61, v66, v67
  v_max3_u32 v61, v61, v68, v69
  v_max3_u32 v61, v61, v70, v71
  v_max3_u32 v61, v61, v72, v73
  v_max3_u32 v61, v61, v74, v75
  v_max3_u32 v61, v61, v76, v77
  v_max3_u32 v61, v61, v78, v79
  v_max3_u32 v61, v61, v80, v81
  v_max3_u32 v61, v61, v82, v83
  v_max3_u32 v61, v61, v84, v85
  v_max3_u32 v61, v61, v86, v87
  v_max3_u32 v61, v61, v88, v89
  v_max3_u32 v61, v61, v90, v91
  v_cmp_eq_u32 vcc, -1, v61
  s_cbranch_vccz wp_pk
  s_add_u32 s30, s30, 1
  s_cmp_eq_u32 s31, 0
  s_cbranch_scc1 wp_pr
  s_cmp_lt_u32 s30, 2000000
  s_cbranch_scc1 wp_pf
wp_pr:
  s_sleep 4
  s_cmp_ge_u32 s17, 50
  s_cbranch_scc1 wp_pm_bo
  s_sleep 64
wp_pm_bo:
  s_add_u32 s30, s30, 1
  s_cmp_lt_u32 s30, 2000000
  s_cbranch_scc1 wp_pm
  s_branch wp_abort
wp_pk:
  buffer_load_dword v250, v251, s[8:11], 0 offen sc1
  v_mfma_f32_16x16x32_bf16 v[20:23], v[64:67], a[0:3], 0
  v_mfma_f32_16x16x32_bf16 v[24:27], v[64:67], a[4:7], 0
  v_mfma_f32_16x16x32_bf16 v[28:31], v[64:67], a[56:59], 0
  v_mfma_f32_16x16x32_bf16 v[32:35], v[64:67], a[60:63], 0
  v_mfma_f32_16x16x32_bf16 v[20:23], v[68:71], a[8:11], v[20:23]
  v_mfma_f32_16x16x32_bf16 v[24:27], v[68:71], a[12:15], v[24:27]
  v_mfma_f32_16x16x32_bf16 v[28:31], v[68:71], a[64:67], v[28:31]
  v_mfma_f32_16x16x32_bf16 v[32:35], v[68:71], a[68:71], v[32:35]
  v_mfma_f32_16x16x32_bf16 v[20:23], v[72:75], a[16:19], v[20:23]
  v_mfma_f32_16x16x32_bf16 v[24:27], v[72:75], a[20:23], v[24:27]
  v_mfma_f32_16x16x32_bf16 v[28:31], v[72:75], a[72:75], v[28:31]
  v_mfma_f32_16x16x32_bf16 v[32:35], v[72:75], a[76:79], v[32:35]
  v_mfma_f32_16x16x32_bf16 v[20:23], v[76:79], a[24:27], v[20:23]
  v_mfma_f32_16x16x32_bf16 v[24:27], v[76:79], a[28:31], v[24:27]
  v_mfma_f32_16x16x32_bf16 v[28:31], v[76:79], a[80:83], v[28:31]
  v_mfma_f32_16x16x32_bf16 v[32:35], v[76:79], a[84:87], v[32:35]
  v_mfma_f32_16x16x32_bf16 v[20:23], v[80:83], a[32:35], v[20:23]
  v_mfma_f32_16x16x32_bf16 v[24:27], v[80:83], a[36:39], v[24:27]
  v_mfma_f32_16x16x32_bf16 v[28:31], v[80:83], a[88:91], v[28:31]
  v_mfma_f32_16x16x32_bf16 v[32:35], v[80:83], a[92:95], v[32:35]
  v_mfma_f32_16x16x32_bf16 v[20:23], v[84:87], a[40:43], v[20:23]
  v_mfma_f32_16x16x32_bf16 v[24:27], v[84:87], a[44:47], v[24:27]
  v_mfma_f32_16x16x32_bf16 v[28:31], v[84:87], a[96:99], v[28:31]
  v_mfma_f32_16x16x32_bf16 v[32:35], v[84:87], a[100:103], v[32:35]
  v_mfma_f32_16x16x32_bf16 v[20:23], v[88:91], a[48:51], v[20:23]
  v_mfma_f32_16x16x32_bf16 v[24:27], v[88:91], a[52:55], v[24:27]
  v_mfma_f32_16x16x32_bf16 v[28:31], v[88:91], a[104:107], v[28:31]
  v_mfma_f32_16x16x32_bf16 v[32:35], v[88:91], a[108:111], v[32:35]
  v_cndmask_b32 v8, v6, v8, s[40:41]
  v_cndmask_b32 v9, v6, v9, s[42:43]
  v_cndmask_b32 v10, v6, v10, s[44:45]
  v_cndmask_b32 v11, v6, v11, s[46:47]
  v_cndmask_b32 v20, v24, v20, s[48:49]
  v_cndmask_b32 v21, v25, v21, s[48:49]
  v_cndmask_b32 v22, v26, v22, s[48:49]
  v_cndmask_b32 v23, v27, v23, s[48:49]
  v_mov_b32 v24, v20
  v_mov_b32 v25, v21
  v_mov_b32 v26, v22
  v_mov_b32 v27, v23
  v_permlane32_swap_b32 v20, v24
  v_permlane32_swap_b32 v21, v25
  v_permlane32_swap_b32 v22, v26
  v_permlane32_swap_b32 v23, v27
  v_add_f32 v20, v20, v24
  v_add_f32 v21, v21, v25
  v_add_f32 v22, v22, v26
  v_add_f32 v23, v23, v27
  v_max3_f32 v40, v8, v9, v10
  v_max3_f32 v40, v40, v11, v20
  v_max3_f32 v40, v40, v21, v22
  v_max_f32 v40, v40, v23
  v_mov_b32 v41, v40
  s_nop 1
  v_permlane16_swap_b32 v40, v41
  v_max_f32 v40, v40, v41
  v_mov_b32 v41, v40
  s_nop 1
  v_permlane32_swap_b32 v40, v41
  v_max_f32 v40, v40, v41
  v_sub_f32 v8, v8, v40
  v_sub_f32 v9, v9, v40
  v_sub_f32 v10, v10, v40
  v_sub_f32 v11, v11, v40
  v_sub_f32 v20, v20, v40
  v_sub_f32 v21, v21, v40
  v_sub_f32 v22, v22, v40
  v_sub_f32 v23, v23, v40
  v_exp_f32 v8, v8
  v_exp_f32 v9, v9
  v_exp_f32 v10, v10
  v_exp_f32 v11, v11
  v_exp_f32 v20, v20
  v_exp_f32 v21, v21
  v_exp_f32 v22, v22
  v_exp_f32 v23, v23
  v_add_f32 v42, v20, v21
  v_add_f32 v43, v22, v23
  v_add_f32 v42, v42, v43
  v_mul_f32 v42, 0.5, v42
  v_add_f32 v42, v42, v8
  v_add_f32 v42, v42, v9
  v_add_f32 v42, v42, v10
  v_add_f32 v42, v42, v11
  v_mov_b32 v41, v42
  s_nop 1
  v_permlane16_swap_b32 v42, v41
  v_add_f32 v42, v42, v41
  v_mov_b32 v41, v42
  s_nop 1
  v_permlane32_swap_b32 v42, v41
  v_add_f32 v42, v42, v41
  v_rcp_f32 v42, v42
  s_nop 0
  v_mul_f32 v8, v8, v42
  v_mul_f32 v9, v9, v42
  v_mul_f32 v10, v10, v42
  v_mul_f32 v11, v11, v42
  v_mul_f32 v20, v20, v42
  v_mul_f32 v21, v21, v42
  v_mul_f32 v22, v22, v42
  v_mul_f32 v23, v23, v42
  v_cvt_pk_bf16_f32 v44, v8, 0
  v_cvt_pk_bf16_f32 v45, v9, 0
  v_cvt_pk_bf16_f32 v46, v10, 0
  v_cvt_pk_bf16_f32 v47, v11, 0
  v_cvt_pk_bf16_f32 v48, v20, v21
  v_cvt_pk_bf16_f32 v49, v22, v23
  v_min_u32 v44, -2, v44
  v_min_u32 v45, -2, v45
  v_min_u32 v46, -2, v46
  v_min_u32 v47, -2, v47
  v_min_u32 v48, -2, v48
  v_min_u32 v49, -2, v49
  buffer_store_dwordx4 v[44:47], v2, s[8:11], s26 offen sc1
  s_mov_b64 exec, s[50:51]
  buffer_store_dwordx2 v[48:49], v2, s[8:11], s27 offen sc1
  s_mov_b64 exec, -1
  s_add_u32 s26, s26, 20480
  s_add_u32 s27, s27, 20480
  v_cndmask_b32 v16, v6, v16, s[40:41]
  v_cndmask_b32 v17, v6, v17, s[42:43]
  v_cndmask_b32 v18, v6, v18, s[44:45]
  v_cndmask_b32 v19, v6, v19, s[46:47]
  v_cndmask_b32 v28, v32, v28, s[48:49]
  v_cndmask_b32 v29, v33, v29, s[48:49]
  v_cndmask_b32 v30, v34, v30, s[48:49]
  v_cndmask_b32 v31, v35, v31, s[48:49]
  v_mov_b32 v32, v28
  v_mov_b32 v33, v29
  v_mov_b32 v34, v30
  v_mov_b32 v35, v31
  v_permlane32_swap_b32 v28, v32
  v_permlane32_swap_b32 v29, v33
  v_permlane32_swap_b32 v30, v34
  v_permlane32_swap_b32 v31, v35
  v_add_f32 v28, v28, v32
  v_add_f32 v29, v29, v33
  v_add_f32 v30, v30, v34
  v_add_f32 v31, v31, v35
  v_max3_f32 v40, v12, v13, v14
  v_max3_f32 v40, v40, v15, v16
  v_max3_f32 v40, v40, v17, v18
  v_max3_f32 v40, v40, v19, v28
  v_max3_f32 v40, v40, v29, v30
  v_max_f32 v40, v40, v31
  v_mov_b32 v41, v40
  s_nop 1
  v_permlane16_swap_b32 v40, v41
  v_max_f32 v40, v40, v41
  v_mov_b32 v41, v40
  s_nop 1
  v_permlane32_swap_b32 v40, v41
  v_max_f32 v40, v40, v41
  v_sub_f32 v12, v12, v40
  v_sub_f32 v13, v13, v40
  v_sub_f32 v14, v14, v40
  v_sub_f32 v15, v15, v40
  v_sub_f32 v16, v16, v40
  v_sub_f32 v17, v17, v40
  v_sub_f32 v18, v18, v40
  v_sub_f32 v19, v19, v40
  v_sub_f32 v28, v28, v40
  v_sub_f32 v29, v29, v40
  v_sub_f32 v30, v30, v40
  v_sub_f32 v31, v31, v40
  v_exp_f32 v12, v12
  v_exp_f32 v13, v13
  v_exp_f32 v14, v14
  v_exp_f32 v15, v15
  v_exp_f32 v16, v16
  v_exp_f32 v17, v17
  v_exp_f32 v18, v18
  v_exp_f32 v19, v19
  v_exp_f32 v28, v28
  v_exp_f32 v29, v29
  v_exp_f32 v30, v30
  v_exp_f32 v31, v31
  v_add_f32 v42, v28, v29
  v_add_f32 v43, v30, v31
  v_add_f32 v42, v42, v43
  v_mul_f32 v42, 0.5, v42
  v_add_f32 v42, v42, v12
  v_add_f32 v42, v42, v13
  v_add_f32 v42, v42, v14
  v_add_f32 v42, v42, v15
  v_add_f32 v42, v42, v16
  v_add_f32 v42, v42, v17
  v_add_f32 v42, v42, v18
  v_add_f32 v42, v42, v19
  v_mov_b32 v41, v42
  s_nop 1
  v_permlane16_swap_b32 v42, v41
  v_add_f32 v42, v42, v41
  v_mov_b32 v41, v42
  s_nop 1
  v_permlane32_swap_b32 v42, v41
  v_add_f32 v42, v42, v41
  v_rcp_f32 v42, v42
  s_nop 0
  v_mul_f32 v12, v12, v42
  v_mul_f32 v13, v13, v42
  v_mul_f32 v14, v14, v42
  v_mul_f32 v15, v15, v42
  v_mul_f32 v16, v16, v42
  v_mul_f32 v17, v17, v42
  v_mul_f32 v18, v18, v42
  v_mul_f32 v19, v19, v42
  v_mul_f32 v28, v28, v42
  v_mul_f32 v29, v29, v42
  v_mul_f32 v30, v30, v42
  v_mul_f32 v31, v31, v42
  v_cvt_pk_bf16_f32 v52, v12, v16
  v_cvt_pk_bf16_f32 v53, v13, v17
  v_cvt_pk_bf16_f32 v54, v14, v18
  v_cvt_pk_bf16_f32 v55, v15, v19
  v_cvt_pk_bf16_f32 v56, v28, v29
  v_cvt_pk_bf16_f32 v57, v30, v31
  v_min_u32 v52, -2, v52
  v_min_u32 v53, -2, v53
  v_min_u32 v54, -2, v54
  v_min_u32 v55, -2, v55
  v_min_u32 v56, -2, v56
  v_min_u32 v57, -2, v57
  buffer_store_dwordx4 v[52:55], v2, s[8:11], s26 offen sc1
  s_mov_b64 exec, s[50:51]
  buffer_store_dwordx2 v[56:57], v2, s[8:11], s27 offen sc1
  s_mov_b64 exec, -1
  s_branch wk_loop
wk_toko:
  s_load_dwordx2 s[36:37], s[0:1], 112
  s_waitcnt lgkmcnt(0)
  s_mov_b32 s92, s36
  s_and_b32 s93, s37, 0xffff
  s_mov_b32 s94, 3670016
  s_mov_b32 s95, 0x20000
  s_lshl_b32 s20, s18, 2
  s_add_u32 s20, s20, s16
  s_mul_i32 s24, s20, 65
  s_add_u32 s24, s24, s17
  s_lshl_b32 s24, s24, 13
  s_add_u32 s24, s24, 77602816
  s_mul_i32 s21, s20, 28672
  s_mul_i32 s22, s17, 458752
  s_add_u32 s21, s21, s22
  s_add_u32 s21, s21, 2490368
  s_lshl_b32 s25, s17, 1
  s_mul_i32 s25, s25, 20480
  s_add_u32 s25, s25, 86114304
  v_mov_b32 v5, v2
  v_min_u32 v6, 11, v4
  v_mad_u32_u24 v6, v3, 12, v6
  v_lshlrev_b32 v6, 4, v6
  v_add_u32 v6, 1024, v6
  v_lshrrev_b32 v8, 1, v3
  v_lshl_add_u32 v8, v8, 4, v4
  v_lshlrev_b32 v8, 4, v8
  v_and_b32 v9, 1, v3
  v_lshl_add_u32 v7, v9, 3, v8
  s_lshr_b32 s26, s17, 3
  s_lshl_b32 s26, s26, 4
  s_add_u32 s26, s26, s20
  s_lshl_b32 s26, s26, 7
  s_add_u32 s26, s26, 524288
  v_mov_b32 v60, 0
  s_mov_b32 s30, 0
wo_wv:
  buffer_load_dword v61, v60, s[8:11], s26 offen sc1
  s_waitcnt vmcnt(0)
  v_cmp_ne_u32 vcc, 56, v61
  s_cbranch_vccz wo_wv_ok
  s_sleep 4
  s_cmp_ge_u32 s17, 50
  s_cbranch_scc1 wo_wv_bo
  s_sleep 64
wo_wv_bo:
  s_add_u32 s30, s30, 1
  s_cmp_lt_u32 s30, 2000000
  s_cbranch_scc1 wo_wv
  s_branch wo_abort
wo_wv_ok:
  s_add_u32 s22, s21, 0
  buffer_load_dwordx4 a[0:3], v5, s[8:11], s22 offen offset:0 sc1
  buffer_load_dwordx4 a[4:7], v6, s[8:11], s22 offen offset:0 sc1
  buffer_load_dwordx4 a[8:11], v5, s[8:11], s22 offen offset:1792 sc1
  buffer_load_dwordx4 a[12:15], v6, s[8:11], s22 offen offset:1792 sc1
  s_add_u32 s22, s21, 3584
  buffer_load_dwordx4 a[16:19], v5, s[8:11], s22 offen offset:0 sc1
  buffer_load_dwordx4 a[20:23], v6, s[8:11], s22 offen offset:0 sc1
  buffer_load_dwordx4 a[24:27], v5, s[8:11], s22 offen offset:1792 sc1
  buffer_load_dwordx4 a[28:31], v6, s[8:11], s22 offen offset:1792 sc1
  s_add_u32 s22, s21, 7168
  buffer_load_dwordx4 a[32:35], v5, s[8:11], s22 offen offset:0 sc1
  buffer_load_dwordx4 a[36:39], v6, s[8:11], s22 offen offset:0 sc1
  buffer_load_dwordx4 a[40:43], v5, s[8:11], s22 offen offset:1792 sc1
  buffer_load_dwordx4 a[44:47], v6, s[8:11], s22 offen offset:1792 sc1
  s_add_u32 s22, s21, 10752
  buffer_load_dwordx4 a[48:51], v5, s[8:11], s22 offen offset:0 sc1
  buffer_load_dwordx4 a[52:55], v6, s[8:11], s22 offen offset:0 sc1
  buffer_load_dwordx4 a[56:59], v5, s[8:11], s22 offen offset:1792 sc1
  buffer_load_dwordx4 a[60:63], v6, s[8:11], s22 offen offset:1792 sc1
  s_add_u32 s22, s21, 14336
  buffer_load_dwordx4 a[64:67], v5, s[8:11], s22 offen offset:0 sc1
  buffer_load_dwordx4 a[68:71], v6, s[8:11], s22 offen offset:0 sc1
  buffer_load_dwordx4 a[72:75], v5, s[8:11], s22 offen offset:1792 sc1
  buffer_load_dwordx4 a[76:79], v6, s[8:11], s22 offen offset:1792 sc1
  s_add_u32 s22, s21, 17920
  buffer_load_dwordx4 a[80:83], v5, s[8:11], s22 offen offset:0 sc1
  buffer_load_dwordx4 a[84:87], v6, s[8:11], s22 offen offset:0 sc1
  buffer_load_dwordx4 a[88:91], v5, s[8:11], s22 offen offset:1792 sc1
  buffer_load_dwordx4 a[92:95], v6, s[8:11], s22 offen offset:1792 sc1
  s_add_u32 s22, s21, 21504
  buffer_load_dwordx4 a[96:99], v5, s[8:11], s22 offen offset:0 sc1
  buffer_load_dwordx4 a[100:103], v6, s[8:11], s22 offen offset:0 sc1
  buffer_load_dwordx4 a[104:107], v5, s[8:11], s22 offen offset:1792 sc1
  buffer_load_dwordx4 a[108:111], v6, s[8:11], s22 offen offset:1792 sc1
  s_add_u32 s22, s21, 25088
  buffer_load_dwordx4 a[112:115], v5, s[8:11], s22 offen offset:0 sc1
  buffer_load_dwordx4 a[116:119], v6, s[8:11], s22 offen offset:0 sc1
  buffer_load_dwordx4 a[120:123], v5, s[8:11], s22 offen offset:1792 sc1
  buffer_load_dwordx4 a[124:127], v6, s[8:11], s22 offen offset:1792 sc1
  s_and_b32 s27, s17, 1
  s_cmp_ge_u32 s17, 62
  s_cselect_b32 s27, s17, s27
  s_lshl_b32 s26, s20, 6
  s_add_u32 s26, s26, s27
  s_lshl_b32 s26, s26, 4
  s_add_u32 s26, s26, 565248
  v_lshlrev_b32 v60, 2, v3
  s_mov_b32 s30, 0
wo_wt:
  buffer_load_dword v61, v60, s[8:11], s26 offen sc1
  s_waitcnt vmcnt(0)
  v_cmp_ne_u32 vcc, 1, v61
  s_cbranch_vccz wo_wt_ok
  s_sleep 4
  s_cmp_ge_u32 s17, 50
  s_cbranch_scc1 wo_wt_bo
  s_sleep 64
wo_wt_bo:
  s_add_u32 s30, s30, 1
  s_cmp_lt_u32 s30, 2000000
  s_cbranch_scc1 wo_wt
  s_branch wo_abort
wo_wt_ok:
  v_mul_u32_u24 v9, 1792, v4
  v_lshl_add_u32 v9, v3, 3, v9
  s_lshl_b32 s22, s20, 5
  v_add_u32 v8, s22, v9
  s_mul_i32 s22, s20, 24
  s_add_u32 s22, s22, 512
  v_add_u32 v9, s22, v9
  v_mov_b32 v10, 0x40000000
  v_cmp_eq_u32 vcc, 3, v3
  s_nop 1
  v_cndmask_b32 v9, v9, v10, vcc
  s_mul_i32 s44, s17, 57344
  s_add_u32 s44, s44, 896
  s_add_u32 s45, s44, 28672
  s_lshl_b32 s26, s17, 7
  s_add_u32 s26, s26, 557056
  v_mov_b32 v60, 0
  s_mov_b32 s30, 0
wo_wp:
  buffer_load_dword v61, v60, s[8:11], s26 offen sc1
  s_waitcnt vmcnt(0)
  v_cmp_ne_u32 vcc, 16, v61
  s_cbranch_vccz wo_wp_ok
  s_sleep 4
  s_cmp_ge_u32 s17, 50
  s_cbranch_scc1 wo_wp_bo
  s_sleep 64
wo_wp_bo:
  s_add_u32 s30, s30, 1
  s_cmp_lt_u32 s30, 2000000
  s_cbranch_scc1 wo_wp
  s_branch wo_abort
wo_wp_ok:
  s_lshl_b32 s31, s16, 2
  s_add_u32 s31, s31, s26
  s_lshl_b32 s28, s16, 12
  s_add_u32 s26, s25, s28
  s_add_u32 s27, s26, 20480
  s_lshl_b32 s28, s16, 10
  s_add_u32 s28, s28, s25
  s_add_u32 s28, s28, 16384
  s_add_u32 s29, s28, 20480
  s_add_u32 s23, s24, 4096
  s_mov_b32 s30, 0
wo_ps:
  buffer_load_dword v61, off, s[8:11], s24 sc1
  buffer_load_dword v62, off, s[8:11], s26 sc1
  s_waitcnt vmcnt(0)
  v_max_u32 v61, v61, v62
  v_cmp_eq_u32 vcc, -1, v61
  s_cbranch_vccz wo_pl
  s_sleep 2
  s_cmp_ge_u32 s17, 50
  s_cbranch_scc1 wo_ps_bo
  s_sleep 64
wo_ps_bo:
  s_add_u32 s30, s30, 1
  s_cmp_lt_u32 s30, 2000000
  s_cbranch_scc1 wo_ps
  s_branch wo_abort
wo_pl:
  buffer_load_dword v250, v251, s[8:11], 0 offen sc1
  buffer_load_dwordx4 v[64:67], v2, s[8:11], s26 offen offset:0 sc1
  buffer_load_dwordx4 v[68:71], v2, s[8:11], s26 offen offset:1024 sc1
  buffer_load_dwordx4 v[72:75], v2, s[8:11], s26 offen offset:2048 sc1
  buffer_load_dwordx4 v[76:79], v2, s[8:11], s26 offen offset:3072 sc1
  buffer_load_dwordx4 v[80:83], v2, s[8:11], s28 offen sc1
  buffer_load_dwordx4 v[84:87], v2, s[8:11], s27 offen offset:0 sc1
  buffer_load_dwordx4 v[88:91], v2, s[8:11], s27 offen offset:1024 sc1
  buffer_load_dwordx4 v[92:95], v2, s[8:11], s27 offen offset:2048 sc1
  buffer_load_dwordx4 v[96:99], v2, s[8:11], s27 offen offset:3072 sc1
  buffer_load_dwordx4 v[100:103], v2, s[8:11], s29 offen sc1
  buffer_load_dwordx2 v[28:29], v7, s[8:11], s24 offen offset:0 sc1
  buffer_load_dwordx2 v[30:31], v7, s[8:11], s24 offen offset:512 sc1
  buffer_load_dwordx2 v[32:33], v7, s[8:11], s24 offen offset:1024 sc1
  buffer_load_dwordx2 v[34:35], v7, s[8:11], s24 offen offset:1536 sc1
  buffer_load_dwordx2 v[36:37], v7, s[8:11], s24 offen offset:2048 sc1
  buffer_load_dwordx2 v[38:39], v7, s[8:11], s24 offen offset:2560 sc1
  buffer_load_dwordx2 v[40:41], v7, s[8:11], s24 offen offset:3072 sc1
  buffer_load_dwordx2 v[42:43], v7, s[8:11], s24 offen offset:3584 sc1
  buffer_load_dwordx2 v[44:45], v7, s[8:11], s23 offen offset:0 sc1
  buffer_load_dwordx2 v[46:47], v7, s[8:11], s23 offen offset:512 sc1
  buffer_load_dwordx2 v[48:49], v7, s[8:11], s23 offen offset:1024 sc1
  buffer_load_dwordx2 v[50:51], v7, s[8:11], s23 offen offset:1536 sc1
  buffer_load_dwordx2 v[52:53], v7, s[8:11], s23 offen offset:2048 sc1
  buffer_load_dwordx2 v[54:55], v7, s[8:11], s23 offen offset:2560 sc1
  buffer_load_dwordx2 v[56:57], v7, s[8:11], s23 offen offset:3072 sc1
  buffer_load_dwordx2 v[58:59], v7, s[8:11], s23 offen offset:3584 sc1
  s_waitcnt vmcnt(16)
  v_max_u32 v61, v64, v65
  v_max3_u32 v61, v61, v66, v67
  v_max3_u32 v61, v61, v68, v69
  v_max3_u32 v61, v61, v70, v71
  v_max3_u32 v61, v61, v72, v73
  v_max3_u32 v61, v61, v74, v75
  v_max3_u32 v61, v61, v76, v77
  v_max3_u32 v61, v61, v78, v79
  v_max3_u32 v61, v61, v80, v81
  v_max3_u32 v61, v61, v82, v83
  v_max3_u32 v61, v61, v84, v85
  v_max3_u32 v61, v61, v86, v87
  v_max3_u32 v61, v61, v88, v89
  v_max3_u32 v61, v61, v90, v91
  v_max3_u32 v61, v61, v92, v93
  v_max3_u32 v61, v61, v94, v95
  v_max3_u32 v61, v61, v96, v97
  v_max3_u32 v61, v61, v98, v99
  v_max3_u32 v61, v61, v100, v101
  v_max3_u32 v61, v61, v102, v103
  s_mul_i32 s22, s16, 10240
  v_add_u32 v62, s22, v2
  ds_write_b128 v62, v[64:67] offset:0
  ds_write_b128 v62, v[68:71] offset:1024
  ds_write_b128 v62, v[72:75] offset:2048
  ds_write_b128 v62, v[76:79] offset:3072
  ds_write_b128 v62, v[80:83] offset:4096
  ds_write_b128 v62, v[84:87] offset:5120
  ds_write_b128 v62, v[88:91] offset:6144
  ds_write_b128 v62, v[92:95] offset:7168
  ds_write_b128 v62, v[96:99] offset:8192
  ds_write_b128 v62, v[100:103] offset:9216
  s_waitcnt vmcnt(0)
  v_max3_u32 v61, v61, v28, v29
  v_max3_u32 v61, v61, v30, v31
  v_max3_u32 v61, v61, v32, v33
  v_max3_u32 v61, v61, v34, v35
  v_max3_u32 v61, v61, v36, v37
  v_max3_u32 v61, v61, v38, v39
  v_max3_u32 v61, v61, v40, v41
  v_max3_u32 v61, v61, v42, v43
  v_max3_u32 v61, v61, v44, v45
  v_max3_u32 v61, v61, v46, v47
  v_max3_u32 v61, v61, v48, v49
  v_max3_u32 v61, v61, v50, v51
  v_max3_u32 v61, v61, v52, v53
  v_max3_u32 v61, v61, v54, v55
  v_max3_u32 v61, v61, v56, v57
  v_max3_u32 v61, v61, v58, v59
  v_cmp_eq_u32 vcc, -1, v61
  s_cbranch_vccz wo_pk
  s_waitcnt lgkmcnt(0)
  s_sleep 1
  s_add_u32 s30, s30, 1
  s_cmp_lt_u32 s30, 2000000
  s_cbranch_scc1 wo_pl
  s_branch wo_abort
wo_pk:
  s_lshl_b32 s22, s16, 2
  s_add_u32 s22, s22, 49152
  v_mov_b32 v63, s22
  ds_write_b32 v63, v250
  s_waitcnt lgkmcnt(0)
  s_barrier
  v_mov_b32 v63, 49152
  ds_read_b32 v250, v63
  ds_read_b128 v[64:67], v2 offset:0
  ds_read_b128 v[68:71], v2 offset:5120
  ds_read_b128 v[72:75], v2 offset:1024
  ds_read_b128 v[76:79], v2 offset:6144
  ds_read_b128 v[80:83], v2 offset:2048
  ds_read_b128 v[84:87], v2 offset:7168
  ds_read_b128 v[88:91], v2 offset:3072
  ds_read_b128 v[92:95], v2 offset:8192
  s_waitcnt lgkmcnt(7)
  v_mfma_f32_16x16x32_bf16 v[12:15], a[0:3], v[64:67], 0
  ds_read_b128 v[96:99], v2 offset:4096
  v_mfma_f32_16x16x32_bf16 v[20:23], a[4:7], v[64:67], 0
  s_waitcnt lgkmcnt(7)
  v_mfma_f32_16x16x32_bf16 v[16:19], a[0:3], v[68:71], 0
  ds_read_b128 v[100:103], v2 offset:9216
  v_mfma_f32_16x16x32_bf16 v[24:27], a[4:7], v[68:71], 0
  s_waitcnt lgkmcnt(7)
  v_mfma_f32_16x16x32_bf16 v[12:15], a[8:11], v[72:75], v[12:15]
  ds_read_b128 v[64:67], v2 offset:10240
  v_mfma_f32_16x16x32_bf16 v[20:23], a[12:15], v[72:75], v[20:23]
  s_waitcnt lgkmcnt(7)
  v_mfma_f32_16x16x32_bf16 v[16:19], a[8:11], v[76:79], v[16:19]
  ds_read_b128 v[68:71], v2 offset:15360
  v_mfma_f32_16x16x32_bf16 v[24:27], a[12:15], v[76:79], v[24:27]
  s_waitcnt lgkmcnt(7)
  v_mfma_f32_16x16x32_bf16 v[12:15], a[16:19], v[80:83], v[12:15]
  ds_read_b128 v[72:75], v2 offset:11264
  v_mfma_f32_16x16x32_bf16 v[20:23], a[20:23], v[80:83], v[20:23]
  s_waitcnt lgkmcnt(7)
  v_mfma_f32_16x16x32_bf16 v[16:19], a[16:19], v[84:87], v[16:19]
  ds_read_b128 v[76:79], v2 offset:16384
  v_mfma_f32_16x16x32_bf16 v[24:27], a[20:23], v[84:87], v[24:27]
  s_waitcnt lgkmcnt(7)
  v_mfma_f32_16x16x32_bf16 v[12:15], a[24:27], v[88:91], v[12:15]
  ds_read_b128 v[80:83], v2 offset:12288
  v_mfma_f32_16x16x32_bf16 v[20:23], a[28:31], v[88:91], v[20:23]
  s_waitcnt lgkmcnt(7)
  v_mfma_f32_16x16x32_bf16 v[16:19], a[24:27], v[92:95], v[16:19]
  ds_read_b128 v[84:87], v2 offset:17408
  v_mfma_f32_16x16x32_bf16 v[24:27], a[28:31], v[92:95], v[24:27]
  s_waitcnt lgkmcnt(7)
  v_mfma_f32_16x16x32_bf16 v[12:15], v[28:31], v[96:99], v[12:15]
  ds_read_b128 v[88:91], v2 offset:13312
  v_mfma_f32_16x16x32_bf16 v[20:23], v[32:35], v[96:99], v[20:23]
  s_waitcnt lgkmcnt(7)
  v_mfma_f32_16x16x32_bf16 v[16:19], v[28:31], v[100:103], v[16:19]
  ds_read_b128 v[92:95], v2 offset:18432
  v_mfma_f32_16x16x32_bf16 v[24:27], v[32:35], v[100:103], v[24:27]
  s_waitcnt lgkmcnt(7)
  v_mfma_f32_16x16x32_bf16 v[12:15], a[32:35], v[64:67], v[12:15]
  ds_read_b128 v[96:99], v2 offset:14336
  v_mfma_f32_16x16x32_bf16 v[20:23], a[36:39], v[64:67], v[20:23]
  s_waitcnt lgkmcnt(7)
  v_mfma_f32_16x16x32_bf16 v[16:19], a[32:35], v[68:71], v[16:19]
  ds_read_b128 v[100:103], v2 offset:19456
  v_mfma_f32_16x16x32_bf16 v[24:27], a[36:39], v[68:71], v[24:27]
  s_waitcnt lgkmcnt(7)
  v_mfma_f32_16x16x32_bf16 v[12:15], a[40:43], v[72:75], v[12:15]
  ds_read_b128 v[64:67], v2 offset:20480
  v_mfma_f32_16x16x32_bf16 v[20:23], a[44:47], v[72:75], v[20:23]
  s_waitcnt lgkmcnt(7)
  v_mfma_f32_16x16x32_bf16 v[16:19], a[40:43], v[76:79], v[16:19]
  ds_read_b128 v[68:71], v2 offset:25600
  v_mfma_f32_16x16x32_bf16 v[24:27], a[44:47], v[76:79], v[24:27]
  s_waitcnt lgkmcnt(7)
  v_mfma_f32_16x16x32_bf16 v[12:15], a[48:51], v[80:83], v[12:15]
  ds_read_b128 v[72:75], v2 offset:21504
  v_mfma_f32_16x16x32_bf16 v[20:23], a[52:55], v[80:83], v[20:23]
  s_waitcnt lgkmcnt(7)
  v_mfma_f32_16x16x32_bf16 v[16:19], a[48:51], v[84:87], v[16:19]
  ds_read_b128 v[76:79], v2 offset:26624
  v_mfma_f32_16x16x32_bf16 v[24:27], a[52:55], v[84:87], v[24:27]
  s_waitcnt lgkmcnt(7)
  v_mfma_f32_16x16x32_bf16 v[12:15], a[56:59], v[88:91], v[12:15]
  ds_read_b128 v[80:83], v2 offset:22528
  v_mfma_f32_16x16x32_bf16 v[20:23], a[60:63], v[88:91], v[20:23]
  s_waitcnt lgkmcnt(7)
  v_mfma_f32_16x16x32_bf16 v[16:19], a[56:59], v[92:95], v[16:19]
  ds_read_b128 v[84:87], v2 offset:27648
  v_mfma_f32_16x16x32_bf16 v[24:27], a[60:63], v[92:95], v[24:27]
  s_waitcnt lgkmcnt(7)
  v_mfma_f32_16x16x32_bf16 v[12:15], v[36:39], v[96:99], v[12:15]
  ds_read_b128 v[88:91], v2 offset:23552
  v_mfma_f32_16x16x32_bf16 v[20:23], v[40:43], v[96:99], v[20:23]
  s_waitcnt lgkmcnt(7)
  v_mfma_f32_16x16x32_bf16 v[16:19], v[36:39], v[100:103], v[16:19]
  ds_read_b128 v[92:95], v2 offset:28672
  v_mfma_f32_16x16x32_bf16 v[24:27], v[40:43], v[100:103], v[24:27]
  s_waitcnt lgkmcnt(7)
  v_mfma_f32_16x16x32_bf16 v[12:15], a[64:67], v[64:67], v[12:15]
  ds_read_b128 v[96:99], v2 offset:24576
  v_mfma_f32_16x16x32_bf16 v[20:23], a[68:71], v[64:67], v[20:23]
  s_waitcnt lgkmcnt(7)
  v_mfma_f32_16x16x32_bf16 v[16:19], a[64:67], v[68:71], v[16:19]
  ds_read_b128 v[100:103], v2 offset:29696
  v_mfma_f32_16x16x32_bf16 v[24:27], a[68:71], v[68:71], v[24:27]
  s_waitcnt lgkmcnt(7)
  v_mfma_f32_16x16x32_bf16 v[12:15], a[72:75], v[72:75], v[12:15]
  ds_read_b128 v[64:67], v2 offset:30720
  v_mfma_f32_16x16x32_bf16 v[20:23], a[76:79], v[72:75], v[20:23]
  s_waitcnt lgkmcnt(7)
  v_mfma_f32_16x16x32_bf16 v[16:19], a[72:75], v[76:79], v[16:19]
  ds_read_b128 v[68:71], v2 offset:35840
  v_mfma_f32_16x16x32_bf16 v[24:27], a[76:79], v[76:79], v[24:27]
  s_waitcnt lgkmcnt(7)
  v_mfma_f32_16x16x32_bf16 v[12:15], a[80:83], v[80:83], v[12:15]
  ds_read_b128 v[72:75], v2 offset:31744
  v_mfma_f32_16x16x32_bf16 v[20:23], a[84:87], v[80:83], v[20:23]
  s_waitcnt lgkmcnt(7)
  v_mfma_f32_16x16x32_bf16 v[16:19], a[80:83], v[84:87], v[16:19]
  ds_read_b128 v[76:79], v2 offset:36864
  v_mfma_f32_16x16x32_bf16 v[24:27], a[84:87], v[84:87], v[24:27]
  s_waitcnt lgkmcnt(7)
  v_mfma_f32_16x16x32_bf16 v[12:15], a[88:91], v[88:91], v[12:15]
  ds_read_b128 v[80:83], v2 offset:32768
  v_mfma_f32_16x16x32_bf16 v[20:23], a[92:95], v[88:91], v[20:23]
  s_waitcnt lgkmcnt(7)
  v_mfma_f32_16x16x32_bf16 v[16:19], a[88:91], v[92:95], v[16:19]
  ds_read_b128 v[84:87], v2 offset:37888
  v_mfma_f32_16x16x32_bf16 v[24:27], a[92:95], v[92:95], v[24:27]
  s_waitcnt lgkmcnt(7)
  v_mfma_f32_16x16x32_bf16 v[12:15], v[44:47], v[96:99], v[12:15]
  ds_read_b128 v[88:91], v2 offset:33792
  v_mfma_f32_16x16x32_bf16 v[20:23], v[48:51], v[96:99], v[20:23]
  s_waitcnt lgkmcnt(7)
  v_mfma_f32_16x16x32_bf16 v[16:19], v[44:47], v[100:103], v[16:19]
  ds_read_b128 v[92:95], v2 offset:38912
  v_mfma_f32_16x16x32_bf16 v[24:27], v[48:51], v[100:103], v[24:27]
  s_waitcnt lgkmcnt(7)
  v_mfma_f32_16x16x32_bf16 v[12:15], a[96:99], v[64:67], v[12:15]
  ds_read_b128 v[96:99], v2 offset:34816
  v_mfma_f32_16x16x32_bf16 v[20:23], a[100:103], v[64:67], v[20:23]
  s_waitcnt lgkmcnt(7)
  v_mfma_f32_16x16x32_bf16 v[16:19], a[96:99], v[68:71], v[16:19]
  ds_read_b128 v[100:103], v2 offset:39936
  v_mfma_f32_16x16x32_bf16 v[24:27], a[100:103], v[68:71], v[24:27]
  s_waitcnt lgkmcnt(7)
  v_mfma_f32_16x16x32_bf16 v[12:15], a[104:107], v[72:75], v[12:15]
  v_mfma_f32_16x16x32_bf16 v[20:23], a[108:111], v[72:75], v[20:23]
  s_waitcnt lgkmcnt(6)
  v_mfma_f32_16x16x32_bf16 v[16:19], a[104:107], v[76:79], v[16:19]
  v_mfma_f32_16x16x32_bf16 v[24:27], a[108:111], v[76:79], v[24:27]
  s_waitcnt lgkmcnt(5)
  v_mfma_f32_16x16x32_bf16 v[12:15], a[112:115], v[80:83], v[12:15]
  v_mfma_f32_16x16x32_bf16 v[20:23], a[116:119], v[80:83], v[20:23]
  s_waitcnt lgkmcnt(4)
  v_mfma_f32_16x16x32_bf16 v[16:19], a[112:115], v[84:87], v[16:19]
  v_mfma_f32_16x16x32_bf16 v[24:27], a[116:119], v[84:87], v[24:27]
  s_waitcnt lgkmcnt(3)
  v_mfma_f32_16x16x32_bf16 v[12:15], a[120:123], v[88:91], v[12:15]
  v_mfma_f32_16x16x32_bf16 v[20:23], a[124:127], v[88:91], v[20:23]
  s_waitcnt lgkmcnt(2)
  v_mfma_f32_16x16x32_bf16 v[16:19], a[120:123], v[92:95], v[16:19]
  v_mfma_f32_16x16x32_bf16 v[24:27], a[124:127], v[92:95], v[24:27]
  s_waitcnt lgkmcnt(1)
  v_mfma_f32_16x16x32_bf16 v[12:15], v[52:55], v[96:99], v[12:15]
  v_mfma_f32_16x16x32_bf16 v[20:23], v[56:59], v[96:99], v[20:23]
  s_waitcnt lgkmcnt(0)
  v_mfma_f32_16x16x32_bf16 v[16:19], v[52:55], v[100:103], v[16:19]
  v_mfma_f32_16x16x32_bf16 v[24:27], v[56:59], v[100:103], v[24:27]
  v_cvt_pk_bf16_f32 v108, v12, v13
  v_cvt_pk_bf16_f32 v109, v14, v15
  buffer_store_dwordx2 v[108:109], v8, s[92:95], s44 offen
  v_cvt_pk_bf16_f32 v110, v20, v21
  v_cvt_pk_bf16_f32 v111, v22, v23
  buffer_store_dwordx2 v[110:111], v9, s[92:95], s44 offen
  v_cvt_pk_bf16_f32 v112, v16, v17
  v_cvt_pk_bf16_f32 v113, v18, v19
  buffer_store_dwordx2 v[112:113], v8, s[92:95], s45 offen
  v_cvt_pk_bf16_f32 v114, v24, v25
  v_cvt_pk_bf16_f32 v115, v26, v27
  buffer_store_dwordx2 v[114:115], v9, s[92:95], s45 offen
  v_readfirstlane_b32 s22, v250
  s_cmp_ge_u32 s22, 1264
  s_cbranch_scc1 wk_done
  s_branch wk_loop
wp_abort:
wo_abort:
  s_branch cA_abort
wk_done:
ch_end:
  s_endpgm

.section .rodata,"a"
.p2align 6
.amdhsa_kernel main_kernel
  .amdhsa_next_free_vgpr 512
  .amdhsa_next_free_sgpr 102
  .amdhsa_accum_offset 256
  .amdhsa_group_segment_fixed_size 0
  .amdhsa_kernarg_size 136
  .amdhsa_user_sgpr_count 2
  .amdhsa_user_sgpr_kernarg_segment_ptr 1
  .amdhsa_system_sgpr_workgroup_id_x 1
.end_amdhsa_kernel
```

```asm
; @launch kernel=main_kernel grid=(256,1,1) block=(256,1,1) lds=163840
.amdgcn_target "amdgcn-amd-amdhsa--gfx950"
.text
.globl main_kernel
.p2align 8
.type main_kernel,@function
main_kernel:
  s_cmp_ge_u32 s2, 256
  s_cbranch_scc1 ch_end
  s_load_dwordx2 s[4:5], s[0:1], 120
  s_load_dwordx2 s[6:7], s[0:1], 128
  s_load_dwordx8 s[40:47], s[0:1], 72
  s_load_dwordx4 s[48:51], s[0:1], 56
  s_mov_b32 s32, 0
  s_getreg_b32 s3, hwreg(HW_REG_XCC_ID)
  s_and_b32 s3, s3, 15
  s_cmp_lg_u32 s3, 3
  s_cbranch_scc1 ch_pf
  s_cmp_lt_u32 s2, 224
  s_cbranch_scc1 ch_npf
ch_pf:
  s_getpc_b64 s[98:99]
pf_main_kernel_1:
  s_sub_u32 s98, s98, pf_main_kernel_1-main_kernel
  s_subb_u32 s99, s99, 0
  v_lshlrev_b32 v60, 7, v0
  v_min_u32 v61, ch_end-main_kernel-4, v60
  global_load_dword v62, v61, s[98:99]
  v_add_u32 v60, 32768, v60
  v_min_u32 v61, ch_end-main_kernel-4, v60
  global_load_dword v62, v61, s[98:99]
  v_add_u32 v60, 32768, v60
  v_min_u32 v61, ch_end-main_kernel-4, v60
  global_load_dword v62, v61, s[98:99]
  v_add_u32 v60, 32768, v60
  v_min_u32 v61, ch_end-main_kernel-4, v60
  global_load_dword v62, v61, s[98:99]
  v_add_u32 v60, 32768, v60
  v_min_u32 v61, ch_end-main_kernel-4, v60
  global_load_dword v62, v61, s[98:99]
  v_add_u32 v60, 32768, v60
ch_npf:
  v_lshrrev_b32 v1, 6, v0
  s_nop 0
  v_readfirstlane_b32 s16, v1
  s_waitcnt lgkmcnt(0)
  s_mov_b32 s8, s6
  s_and_b32 s9, s7, 0xffff
  s_mov_b32 s10, 0x10000000
  s_mov_b32 s11, 0x20000
  s_mov_b32 s12, s4
  s_and_b32 s13, s5, 0xffff
  s_mov_b32 s14, 256
  s_mov_b32 s15, 0x20000
  v_mov_b32 v252, 0x40000000
  v_cmp_eq_u32 vcc, 0, v0
  s_nop 1
  v_cndmask_b32 v252, v252, v0, vcc
  s_cmp_lg_u32 s3, 3
  s_cbranch_scc1 ch_worker
  s_mov_b32 s18, 0
  v_mov_b32 v249, 1
  s_mov_b64 exec, 1
  buffer_atomic_add v249, v252, s[12:15], 0 offen sc0
  s_mov_b64 exec, -1
  v_and_b32 v1, 63, v0
  v_lshlrev_b32 v2, 4, v1
  v_lshrrev_b32 v3, 4, v1
  v_and_b32 v4, 15, v1
  s_lshr_b32 s33, s2, 3
  s_lshl_b32 s27, s33, 2
  s_add_u32 s27, s27, s16
  s_lshl_b32 s27, s27, 13
  v_lshlrev_b32 v12, 7, v1
  s_mov_b32 s64, s42
  s_and_b32 s65, s43, 0xffff
  s_mov_b32 s66, 2097152
  s_mov_b32 s67, 0x20000
  s_mov_b32 s28, s27
  buffer_load_dword v13, v12, s[64:67], s28 offen
  s_add_u32 s28, s28, 1048576
  buffer_load_dword v13, v12, s[64:67], s28 offen
  s_add_u32 s28, s28, 1048576
  s_waitcnt vmcnt(2)
  v_readfirstlane_b32 s17, v249
  v_mov_b32 v6, 160032
  s_nop 0
  v_mov_b32 v7, s17
  s_barrier
  s_cmp_lg_u32 s16, 0
  s_cbranch_scc1 uni_2
  ds_write_b32 v6, v7
  s_waitcnt lgkmcnt(0)
uni_2:
  s_barrier
  ds_read_b32 v7, v6
  s_waitcnt lgkmcnt(0)
  v_readfirstlane_b32 s17, v7
  s_branch ch_got
ch_take:
  v_mov_b32 v5, 0
  v_mov_b32 v6, 160000
  s_barrier
  s_cmp_lg_u32 s16, 0
  s_cbranch_scc1 ch_el1
  s_mov_b64 exec, 1
  buffer_atomic_add v4, v5, s[12:15], 0 offen sc0
  s_waitcnt vmcnt(0)
  ds_write_b32 v6, v4
  s_waitcnt lgkmcnt(0)
  s_mov_b64 exec, -1
ch_el1:
  s_barrier
  ds_read_b32 v4, v6
  s_waitcnt lgkmcnt(0)
  v_readfirstlane_b32 s17, v4
ch_got:
  s_and_b32 s17, s17, 0xffff
  s_cmp_lt_u32 s17, 32
  s_cbranch_scc1 ch_role
  s_cmp_eq_u32 s18, 0
  s_cbranch_scc1 ch_worker
  v_and_b32 v1, 63, v0
  v_lshlrev_b32 v2, 4, v1
  v_lshrrev_b32 v3, 4, v1
  v_and_b32 v4, 15, v1
  s_branch wp_all
ch_role:
  v_and_b32 v1, 63, v0
  v_lshlrev_b32 v2, 4, v1
  v_lshrrev_b32 v3, 4, v1
  v_and_b32 v4, 15, v1
  s_cmp_lt_u32 s17, 16
  s_cbranch_scc1 ch_self
  s_cmp_lt_u32 s17, 24
  s_cbranch_scc1 ch_tch
  s_sub_u32 s33, s17, 24
  v_mov_b32 v10, 0x40000000
  v_mov_b32 v5, 1
  v_mov_b32 v148, 0
  v_mov_b32 v149, 0
  v_mov_b32 v150, 0
  v_mov_b32 v151, 0
  v_mov_b32 v152, -1
  v_mov_b32 v153, -1
  v_mov_b32 v154, -1
  v_mov_b32 v155, -1
  v_lshlrev_b32 v8, 4, v0
  s_mov_b32 s64, s48
  s_and_b32 s65, s49, 0xffff
  s_mov_b32 s66, 1835008
  s_mov_b32 s67, 0x20000
  s_lshl_b32 s21, s33, 2
  s_add_u32 s21, s21, s16
  s_lshr_b32 s22, s21, 1
  s_mul_i32 s22, s22, 14336
  s_and_b32 s24, s21, 1
  s_mul_i32 s24, s24, 448
  s_add_u32 s22, s22, s24
  s_mul_i32 s21, s21, 7168
  v_mul_u32_u24 v7, 896, v4
  v_lshl_add_u32 v7, v3, 4, v7
  buffer_load_dwordx4 v[64:67], v7, s[64:67], s22 offen offset:0
  buffer_load_dwordx4 v[68:71], v7, s[64:67], s22 offen offset:64
  buffer_load_dwordx4 v[72:75], v7, s[64:67], s22 offen offset:128
  buffer_load_dwordx4 v[76:79], v7, s[64:67], s22 offen offset:192
  buffer_load_dwordx4 v[80:83], v7, s[64:67], s22 offen offset:256
  buffer_load_dwordx4 v[84:87], v7, s[64:67], s22 offen offset:320
  buffer_load_dwordx4 v[88:91], v7, s[64:67], s22 offen offset:384
  s_mov_b32 s68, s50
  s_and_b32 s69, s51, 0xffff
  s_mov_b32 s70, 7168
  s_mov_b32 s71, 0x20000
  v_lshrrev_b32 v6, 3, v0
  v_min_u32 v6, 27, v6
  v_and_b32 v7, 7, v0
  v_mul_u32_u24 v9, 896, v7
  v_lshl_add_u32 v9, v6, 5, v9
  buffer_load_dwordx4 v[176:179], v9, s[68:71], 0 offen
  buffer_load_dwordx4 v[180:183], v9, s[68:71], 0 offen offset:16
  s_cmp_lg_u32 s33, 0
  s_cbranch_scc1 ch_ij_1
  s_mov_b32 s23, 582144
  buffer_store_dwordx4 v[148:151], v8, s[8:11], s23 offen sc1
  s_mov_b32 s23, 586240
  buffer_store_dwordx4 v[148:151], v8, s[8:11], s23 offen sc1
  s_waitcnt vmcnt(0)
  s_barrier
  buffer_store_dword v5, v252, s[12:15], 0 offen offset:128 sc1
ch_ij_1:
  s_waitcnt vmcnt(1)
  s_add_u32 s23, s21, 655360
  buffer_store_dwordx4 v[64:67], v2, s[8:11], s23 offen offset:0 sc1
  buffer_store_dwordx4 v[68:71], v2, s[8:11], s23 offen offset:1024 sc1
  buffer_store_dwordx4 v[72:75], v2, s[8:11], s23 offen offset:2048 sc1
  buffer_store_dwordx4 v[76:79], v2, s[8:11], s23 offen offset:3072 sc1
  s_add_u32 s23, s21, 659456
  buffer_store_dwordx4 v[80:83], v2, s[8:11], s23 offen offset:0 sc1
  buffer_store_dwordx4 v[84:87], v2, s[8:11], s23 offen offset:1024 sc1
  buffer_store_dwordx4 v[88:91], v2, s[8:11], s23 offen offset:2048 sc1
  s_waitcnt vmcnt(0)
  s_barrier
  s_cmp_lg_u32 s16, 0
  s_cbranch_scc1 ch_ij_x_e
  v_mov_b32 v6, 1
  s_mov_b64 exec, 1
  buffer_atomic_add v6, v252, s[12:15], 0 offen offset:4 sc0
  s_waitcnt vmcnt(0)
  v_readfirstlane_b32 s20, v6
  s_cmp_lg_u32 s20, 7
  s_cbranch_scc1 ch_ij_x_e0
  s_mov_b64 exec, 0xff
  v_lshlrev_b32 v6, 7, v0
  s_mov_b32 s20, 586240
  buffer_store_dword v5, v6, s[8:11], s20 offen offset:8 sc1
ch_ij_x_e0:
  s_mov_b64 exec, -1
ch_ij_x_e:
  s_lshl_b32 s20, s33, 12
  v_add_u32 v8, s20, v8
  s_mov_b32 s23, 524288
ch_ijlp_3:
  buffer_store_dwordx4 v[148:151], v8, s[8:11], s23 offen sc1
  s_add_u32 s23, s23, 32768
  s_cmp_lt_u32 s23, 557056
  s_cbranch_scc1 ch_ijlp_3
  v_cmp_gt_u32 vcc, 25088, v8
  s_nop 1
  v_cndmask_b32 v9, v10, v8, vcc
  buffer_store_dwordx4 v[148:151], v9, s[8:11], s23 offen sc1
  s_mov_b32 s23, 35328
  v_cmp_gt_u32 vcc, 6144, v8
  s_nop 1
  v_cndmask_b32 v9, v10, v8, vcc
  buffer_store_dwordx4 v[148:151], v9, s[8:11], s23 offen sc1
  s_mov_b32 s23, 7168
  v_cmp_gt_u32 vcc, 28160, v8
  s_nop 1
  v_cndmask_b32 v9, v10, v8, vcc
  buffer_store_dwordx4 v[152:155], v9, s[8:11], s23 offen sc1
  s_mov_b32 s23, 72704
ch_ijlp_4:
  buffer_store_dwordx4 v[152:155], v8, s[8:11], s23 offen sc1
  s_add_u32 s23, s23, 32768
  s_cmp_lt_u32 s23, 498688
  s_cbranch_scc1 ch_ijlp_4
  v_cmp_gt_u32 vcc, 25600, v8
  s_nop 1
  v_cndmask_b32 v9, v10, v8, vcc
  buffer_store_dwordx4 v[152:155], v9, s[8:11], s23 offen sc1
  s_cmp_lg_u32 s33, 1
  s_cbranch_scc1 ch_ij_nm
  v_lshrrev_b32 v6, 3, v0
  v_and_b32 v7, 7, v0
  v_lshlrev_b32 v8, 8, v6
  v_lshl_add_u32 v8, v7, 4, v8
  v_cmp_gt_u32 vcc, 28, v6
  s_nop 1
  v_cndmask_b32 v8, v10, v8, vcc
  s_waitcnt vmcnt(4)
  v_min_u32 v184, -2, v176
  v_min_u32 v188, -2, v177
  v_min_u32 v185, -2, v178
  v_min_u32 v189, -2, v179
  v_min_u32 v186, -2, v180
  v_min_u32 v190, -2, v181
  v_min_u32 v187, -2, v182
  v_min_u32 v191, -2, v183
  s_mov_b32 s23, 0
  buffer_store_dwordx4 v[184:187], v8, s[8:11], s23 offen sc1
  buffer_store_dwordx4 v[188:191], v8, s[8:11], s23 offen offset:128 sc1
  s_mov_b32 s23, 65536
  buffer_store_dwordx4 v[184:187], v8, s[8:11], s23 offen sc1
  buffer_store_dwordx4 v[188:191], v8, s[8:11], s23 offen offset:128 sc1
ch_ij_nm:
  s_waitcnt vmcnt(0)
  s_barrier
  s_cmp_lg_u32 s16, 0
  s_cbranch_scc1 ch_ij_e
  v_mov_b32 v6, 1
  s_mov_b64 exec, 1
  buffer_atomic_add v6, v252, s[12:15], 0 offen offset:12 sc0
  s_waitcnt vmcnt(0)
  v_readfirstlane_b32 s20, v6
  s_cmp_lg_u32 s20, 7
  s_cbranch_scc1 ch_ij_e0
  buffer_store_dword v5, v252, s[12:15], 0 offen offset:132 sc1
  s_mov_b64 exec, 0xff
  v_lshlrev_b32 v6, 7, v0
  s_mov_b32 s20, 586240
  buffer_store_dword v5, v6, s[8:11], s20 offen offset:4 sc1
ch_ij_e0:
  s_mov_b64 exec, -1
ch_ij_e:
  s_branch ch_role2
ch_tch:
  s_sub_u32 s33, s17, 16
  s_lshl_b32 s27, s33, 2
  s_add_u32 s27, s27, s16
  s_lshl_b32 s27, s27, 13
  v_lshlrev_b32 v12, 7, v1
  s_mov_b32 s64, s40
  s_and_b32 s65, s41, 0xffff
  s_mov_b32 s66, 2097152
  s_mov_b32 s67, 0x20000
  s_mov_b32 s28, s27
  buffer_load_dword v13, v12, s[64:67], s28 offen
  s_add_u32 s28, s28, 262144
  buffer_load_dword v13, v12, s[64:67], s28 offen
  s_add_u32 s28, s28, 262144
  buffer_load_dword v13, v12, s[64:67], s28 offen
  s_add_u32 s28, s28, 262144
  buffer_load_dword v13, v12, s[64:67], s28 offen
  s_add_u32 s28, s28, 262144
  buffer_load_dword v13, v12, s[64:67], s28 offen
  s_add_u32 s28, s28, 262144
  buffer_load_dword v13, v12, s[64:67], s28 offen
  s_add_u32 s28, s28, 262144
  buffer_load_dword v13, v12, s[64:67], s28 offen
  s_add_u32 s28, s28, 262144
  buffer_load_dword v13, v12, s[64:67], s28 offen
  s_add_u32 s28, s28, 262144
  s_branch ch_role2
ch_self:
  v_lshrrev_b32 v5, 5, v1
  v_and_b32 v6, 31, v1
  v_xor_b32 v8, v6, v5
  v_lshlrev_b32 v8, 4, v8
  v_lshl_add_u32 v16, v5, 13, v8
  v_xor_b32 v17, 32, v16
  v_xor_b32 v18, 64, v16
  v_xor_b32 v19, 96, v16
  v_xor_b32 v20, 128, v16
  v_xor_b32 v21, 160, v16
  v_xor_b32 v22, 192, v16
  v_xor_b32 v23, 224, v16
  s_lshl_b32 s20, s16, 6
  v_xor_b32 v26, s20, v16
  v_xor_b32 v27, 32, v26
  s_mov_b32 s60, s40
  s_and_b32 s61, s41, 0xffff
  s_mov_b32 s62, 3670016
  s_mov_b32 s63, 0x20000
  s_mov_b32 s56, s42
  s_and_b32 s57, s43, 0xffff
  s_mov_b32 s58, 3670016
  s_mov_b32 s59, 0x20000
  s_lshl_b32 s26, s17, 9
  s_lshl_b32 s27, s16, 19
  s_add_u32 s27, s27, s26
  s_lshl_b32 s25, s16, 15
  s_add_u32 s25, s25, 32768
  s_barrier
  s_add_u32 m0, s25, 0
  s_nop 0
  buffer_load_dwordx4 v16, s[56:59], s27 offen lds
  s_add_u32 s27, s27, 16384
  s_add_u32 m0, s25, 1024
  s_nop 0
  buffer_load_dwordx4 v16, s[56:59], s27 offen lds
  s_add_u32 s27, s27, 16384
  s_add_u32 m0, s25, 2048
  s_nop 0
  buffer_load_dwordx4 v17, s[56:59], s27 offen lds
  s_add_u32 s27, s27, 16384
  s_add_u32 m0, s25, 3072
  s_nop 0
  buffer_load_dwordx4 v17, s[56:59], s27 offen lds
  s_add_u32 s27, s27, 16384
  s_add_u32 m0, s25, 4096
  s_nop 0
  buffer_load_dwordx4 v16, s[56:59], s27 offen lds
  s_add_u32 s27, s27, 16384
  s_add_u32 m0, s25, 5120
  s_nop 0
  buffer_load_dwordx4 v16, s[56:59], s27 offen lds
  s_add_u32 s27, s27, 16384
  s_add_u32 m0, s25, 6144
  s_nop 0
  buffer_load_dwordx4 v17, s[56:59], s27 offen lds
  s_add_u32 s27, s27, 16384
  s_add_u32 m0, s25, 7168
  s_nop 0
  buffer_load_dwordx4 v17, s[56:59], s27 offen lds
  s_add_u32 s27, s27, 16384
  s_add_u32 m0, s25, 8192
  s_nop 0
  buffer_load_dwordx4 v18, s[56:59], s27 offen lds
  s_add_u32 s27, s27, 16384
  s_add_u32 m0, s25, 9216
  s_nop 0
  buffer_load_dwordx4 v18, s[56:59], s27 offen lds
  s_add_u32 s27, s27, 16384
  s_add_u32 m0, s25, 10240
  s_nop 0
  buffer_load_dwordx4 v19, s[56:59], s27 offen lds
  s_add_u32 s27, s27, 16384
  s_add_u32 m0, s25, 11264
  s_nop 0
  buffer_load_dwordx4 v19, s[56:59], s27 offen lds
  s_add_u32 s27, s27, 16384
  s_add_u32 m0, s25, 12288
  s_nop 0
  buffer_load_dwordx4 v18, s[56:59], s27 offen lds
  s_add_u32 s27, s27, 16384
  s_add_u32 m0, s25, 13312
  s_nop 0
  buffer_load_dwordx4 v18, s[56:59], s27 offen lds
  s_add_u32 s27, s27, 16384
  s_add_u32 m0, s25, 14336
  s_nop 0
  buffer_load_dwordx4 v19, s[56:59], s27 offen lds
  s_add_u32 s27, s27, 16384
  s_add_u32 m0, s25, 15360
  s_nop 0
  buffer_load_dwordx4 v19, s[56:59], s27 offen lds
  s_add_u32 s27, s27, 16384
  s_add_u32 m0, s25, 16384
  s_nop 0
  buffer_load_dwordx4 v20, s[56:59], s27 offen lds
  s_add_u32 s27, s27, 16384
  s_add_u32 m0, s25, 17408
  s_nop 0
  buffer_load_dwordx4 v20, s[56:59], s27 offen lds
  s_add_u32 s27, s27, 16384
  s_add_u32 m0, s25, 18432
  s_nop 0
  buffer_load_dwordx4 v21, s[56:59], s27 offen lds
  s_add_u32 s27, s27, 16384
  s_add_u32 m0, s25, 19456
  s_nop 0
  buffer_load_dwordx4 v21, s[56:59], s27 offen lds
  s_add_u32 s27, s27, 16384
  s_add_u32 m0, s25, 20480
  s_nop 0
  buffer_load_dwordx4 v20, s[56:59], s27 offen lds
  s_add_u32 s27, s27, 16384
  s_add_u32 m0, s25, 21504
  s_nop 0
  buffer_load_dwordx4 v20, s[56:59], s27 offen lds
  s_add_u32 s27, s27, 16384
  s_add_u32 m0, s25, 22528
  s_nop 0
  buffer_load_dwordx4 v21, s[56:59], s27 offen lds
  s_add_u32 s27, s27, 16384
  s_add_u32 m0, s25, 23552
  s_nop 0
  buffer_load_dwordx4 v21, s[56:59], s27 offen lds
  s_add_u32 s27, s27, 16384
  s_add_u32 m0, s25, 24576
  s_nop 0
  buffer_load_dwordx4 v22, s[56:59], s27 offen lds
  s_add_u32 s27, s27, 16384
  s_add_u32 m0, s25, 25600
  s_nop 0
  buffer_load_dwordx4 v22, s[56:59], s27 offen lds
  s_add_u32 s27, s27, 16384
  s_add_u32 m0, s25, 26624
  s_nop 0
  buffer_load_dwordx4 v23, s[56:59], s27 offen lds
  s_add_u32 s27, s27, 16384
  s_add_u32 m0, s25, 27648
  s_nop 0
  buffer_load_dwordx4 v23, s[56:59], s27 offen lds
  s_add_u32 s27, s27, 16384
  s_add_u32 m0, s25, 28672
  s_nop 0
  buffer_load_dwordx4 v22, s[56:59], s27 offen lds
  s_add_u32 s27, s27, 16384
  s_add_u32 m0, s25, 29696
  s_nop 0
  buffer_load_dwordx4 v22, s[56:59], s27 offen lds
  s_add_u32 s27, s27, 16384
  s_add_u32 m0, s25, 30720
  s_nop 0
  buffer_load_dwordx4 v23, s[56:59], s27 offen lds
  s_add_u32 s27, s27, 16384
  s_add_u32 m0, s25, 31744
  s_nop 0
  buffer_load_dwordx4 v23, s[56:59], s27 offen lds
  s_add_u32 s27, s27, 16384
  v_mov_b32 v14, v26
  v_mov_b32 v15, v27
  s_lshl_b32 s28, s16, 16
  s_add_u32 s28, s28, s26
  s_lshl_b32 s29, s16, 12
  s_add_u32 m0, s29, 0
  s_add_u32 s27, s28, 0
  buffer_load_dwordx4 v14, s[60:63], s27 offen lds
  s_add_u32 m0, s29, 1024
  s_add_u32 s27, s28, 16384
  buffer_load_dwordx4 v15, s[60:63], s27 offen lds
  s_add_u32 m0, s29, 2048
  s_add_u32 s27, s28, 32768
  buffer_load_dwordx4 v14, s[60:63], s27 offen lds
  s_add_u32 m0, s29, 3072
  s_add_u32 s27, s28, 49152
  buffer_load_dwordx4 v15, s[60:63], s27 offen lds
  s_add_u32 m0, s29, 16384
  s_add_u32 s27, s28, 262144
  buffer_load_dwordx4 v14, s[60:63], s27 offen lds
  s_add_u32 m0, s29, 17408
  s_add_u32 s27, s28, 278528
  buffer_load_dwordx4 v15, s[60:63], s27 offen lds
  s_add_u32 m0, s29, 18432
  s_add_u32 s27, s28, 294912
  buffer_load_dwordx4 v14, s[60:63], s27 offen lds
  s_add_u32 m0, s29, 19456
  s_add_u32 s27, s28, 311296
  buffer_load_dwordx4 v15, s[60:63], s27 offen lds
  v_lshrrev_b32 v7, 2, v4
  v_lshlrev_b32 v11, 4, v7
  v_lshlrev_b32 v7, 3, v7
  v_and_b32 v8, 3, v4
  v_add_u32 v7, v7, v8
  v_and_b32 v8, 2, v4
  v_lshl_add_u32 v11, v8, 1, v11
  v_and_b32 v8, 1, v4
  v_add_u32 v11, v11, v8
  v_or_b32 v10, 0, v3
  v_xor_b32 v10, v10, v4
  v_lshlrev_b32 v10, 4, v10
  v_lshl_add_u32 v248, v7, 9, v10
  v_add_u32 v252, 65536, v248
  v_add_u32 v16, 131072, v248
  v_lshl_add_u32 v10, v11, 9, v10
  v_add_u32 v20, s25, v10
  v_or_b32 v10, 4, v3
  v_xor_b32 v10, v10, v4
  v_lshlrev_b32 v10, 4, v10
  v_lshl_add_u32 v249, v7, 9, v10
  v_add_u32 v253, 65536, v249
  v_add_u32 v17, 131072, v249
  v_lshl_add_u32 v10, v11, 9, v10
  v_add_u32 v21, s25, v10
  v_or_b32 v10, 8, v3
  v_xor_b32 v10, v10, v4
  v_lshlrev_b32 v10, 4, v10
  v_lshl_add_u32 v250, v7, 9, v10
  v_add_u32 v254, 65536, v250
  v_add_u32 v18, 131072, v250
  v_lshl_add_u32 v10, v11, 9, v10
  v_add_u32 v22, s25, v10
  v_or_b32 v10, 12, v3
  v_xor_b32 v10, v10, v4
  v_lshlrev_b32 v10, 4, v10
  v_lshl_add_u32 v251, v7, 9, v10
  v_add_u32 v255, 65536, v251
  v_add_u32 v19, 131072, v251
  v_lshl_add_u32 v10, v11, 9, v10
  v_add_u32 v23, s25, v10
  v_mov_b32 v12, 1035512379
  v_lshlrev_b32 v6, 7, v1
  s_getpc_b64 s[98:99]
  global_load_dword v7, v6, s[98:99]
  s_waitcnt vmcnt(9)
  ds_read_b128 v[120:123], v20 offset:0
  ds_read_b128 v[124:127], v21 offset:0
  ds_read_b128 v[128:131], v22 offset:0
  ds_read_b128 v[132:135], v23 offset:0
  ds_read_b128 v[136:139], v20 offset:256
  ds_read_b128 v[140:143], v21 offset:256
  ds_read_b128 v[144:147], v22 offset:256
  ds_read_b128 v[148:151], v23 offset:256
  s_waitcnt lgkmcnt(8)
  ds_read_b128 v[152:155], v20 offset:1024
  ds_read_b128 v[156:159], v21 offset:1024
  ds_read_b128 v[160:163], v22 offset:1024
  ds_read_b128 v[164:167], v23 offset:1024
  ds_read_b128 v[168:171], v20 offset:1280
  ds_read_b128 v[172:175], v21 offset:1280
  ds_read_b128 v[176:179], v22 offset:1280
  ds_read_b128 v[180:183], v23 offset:1280
  s_waitcnt lgkmcnt(8)
  ds_read_b128 v[184:187], v20 offset:4096
  ds_read_b128 v[188:191], v21 offset:4096
  ds_read_b128 v[192:195], v22 offset:4096
  ds_read_b128 v[196:199], v23 offset:4096
  ds_read_b128 v[200:203], v20 offset:4352
  ds_read_b128 v[204:207], v21 offset:4352
  ds_read_b128 v[208:211], v22 offset:4352
  ds_read_b128 v[212:215], v23 offset:4352
  s_waitcnt lgkmcnt(8)
  ds_read_b128 v[216:219], v20 offset:5120
  ds_read_b128 v[220:223], v21 offset:5120
  ds_read_b128 v[224:227], v22 offset:5120
  ds_read_b128 v[228:231], v23 offset:5120
  ds_read_b128 v[232:235], v20 offset:5376
  ds_read_b128 v[236:239], v21 offset:5376
  ds_read_b128 v[240:243], v22 offset:5376
  ds_read_b128 v[244:247], v23 offset:5376
  s_waitcnt lgkmcnt(8)
  s_waitcnt vmcnt(4) lgkmcnt(0)
  s_barrier
  s_add_u32 m0, s29, 32768
  s_add_u32 s27, s28, 524288
  buffer_load_dwordx4 v14, s[60:63], s27 offen lds
  s_add_u32 m0, s29, 33792
  s_add_u32 s27, s28, 540672
  buffer_load_dwordx4 v15, s[60:63], s27 offen lds
  s_add_u32 m0, s29, 34816
  s_add_u32 s27, s28, 557056
  buffer_load_dwordx4 v14, s[60:63], s27 offen lds
  s_add_u32 m0, s29, 35840
  s_add_u32 s27, s28, 573440
  buffer_load_dwordx4 v15, s[60:63], s27 offen lds
  s_add_u32 m0, s29, 49152
  s_add_u32 s27, s28, 786432
  buffer_load_dwordx4 v14, s[60:63], s27 offen lds
  s_add_u32 m0, s29, 50176
  s_add_u32 s27, s28, 802816
  buffer_load_dwordx4 v15, s[60:63], s27 offen lds
  s_add_u32 m0, s29, 51200
  s_add_u32 s27, s28, 819200
  buffer_load_dwordx4 v14, s[60:63], s27 offen lds
  s_add_u32 m0, s29, 52224
  s_add_u32 s27, s28, 835584
  buffer_load_dwordx4 v15, s[60:63], s27 offen lds
  s_add_u32 m0, s29, 65536
  s_add_u32 s27, s28, 1048576
  buffer_load_dwordx4 v14, s[60:63], s27 offen lds
  s_add_u32 m0, s29, 66560
  s_add_u32 s27, s28, 1064960
  buffer_load_dwordx4 v15, s[60:63], s27 offen lds
  s_add_u32 m0, s29, 67584
  s_add_u32 s27, s28, 1081344
  buffer_load_dwordx4 v14, s[60:63], s27 offen lds
  s_add_u32 m0, s29, 68608
  s_add_u32 s27, s28, 1097728
  buffer_load_dwordx4 v15, s[60:63], s27 offen lds
  s_add_u32 m0, s29, 81920
  s_add_u32 s27, s28, 1310720
  buffer_load_dwordx4 v14, s[60:63], s27 offen lds
  s_add_u32 m0, s29, 82944
  s_add_u32 s27, s28, 1327104
  buffer_load_dwordx4 v15, s[60:63], s27 offen lds
  s_add_u32 m0, s29, 83968
  s_add_u32 s27, s28, 1343488
  buffer_load_dwordx4 v14, s[60:63], s27 offen lds
  s_add_u32 m0, s29, 84992
  s_add_u32 s27, s28, 1359872
  buffer_load_dwordx4 v15, s[60:63], s27 offen lds
  ds_read_b128 v[24:27], v248 offset:0
  ds_read_b128 v[28:31], v248 offset:2048
  ds_read_b128 v[32:35], v249 offset:0
  ds_read_b128 v[36:39], v249 offset:2048
  ds_read_b128 v[40:43], v250 offset:0
  ds_read_b128 v[44:47], v250 offset:2048
  s_waitcnt lgkmcnt(5)
  s_getpc_b64 s[98:99]
  s_add_u32 s98, s98, 4096
  s_addc_u32 s99, s99, 0
  global_load_dword v7, v6, s[98:99]
  v_mfma_f32_16x16x32_bf16 v[56:59], v[24:27], v[120:123], 0
  ds_read_b128 v[48:51], v251 offset:0
  v_mfma_f32_16x16x32_bf16 v[64:67], v[24:27], v[152:155], 0
  v_mfma_f32_16x16x32_bf16 v[72:75], v[24:27], v[184:187], 0
  s_add_u32 m0, s29, 98304
  s_add_u32 s27, s28, 1572864
  buffer_load_dwordx4 v14, s[60:63], s27 offen lds
  v_mfma_f32_16x16x32_bf16 v[80:83], v[24:27], v[216:219], 0
  s_waitcnt lgkmcnt(5)
  v_mfma_f32_16x16x32_bf16 v[60:63], v[28:31], v[120:123], 0
  ds_read_b128 v[52:55], v251 offset:2048
  v_mfma_f32_16x16x32_bf16 v[68:71], v[28:31], v[152:155], 0
  v_mfma_f32_16x16x32_bf16 v[76:79], v[28:31], v[184:187], 0
  v_mfma_f32_16x16x32_bf16 v[84:87], v[28:31], v[216:219], 0
  s_waitcnt lgkmcnt(5)
  v_mfma_f32_16x16x32_bf16 v[56:59], v[32:35], v[124:127], v[56:59]
  ds_read_b128 v[24:27], v248 offset:256
  v_mfma_f32_16x16x32_bf16 v[64:67], v[32:35], v[156:159], v[64:67]
  v_mfma_f32_16x16x32_bf16 v[72:75], v[32:35], v[188:191], v[72:75]
  s_add_u32 m0, s29, 99328
  s_add_u32 s27, s28, 1589248
  buffer_load_dwordx4 v15, s[60:63], s27 offen lds
  v_mfma_f32_16x16x32_bf16 v[80:83], v[32:35], v[220:223], v[80:83]
  s_waitcnt lgkmcnt(5)
  v_mfma_f32_16x16x32_bf16 v[60:63], v[36:39], v[124:127], v[60:63]
  ds_read_b128 v[28:31], v248 offset:2304
  v_mfma_f32_16x16x32_bf16 v[68:71], v[36:39], v[156:159], v[68:71]
  v_mfma_f32_16x16x32_bf16 v[76:79], v[36:39], v[188:191], v[76:79]
  v_mfma_f32_16x16x32_bf16 v[84:87], v[36:39], v[220:223], v[84:87]
  s_waitcnt lgkmcnt(5)
  v_mfma_f32_16x16x32_bf16 v[56:59], v[40:43], v[128:131], v[56:59]
  ds_read_b128 v[32:35], v249 offset:256
  v_mfma_f32_16x16x32_bf16 v[64:67], v[40:43], v[160:163], v[64:67]
  v_mfma_f32_16x16x32_bf16 v[72:75], v[40:43], v[192:195], v[72:75]
  s_add_u32 m0, s29, 100352
  s_add_u32 s27, s28, 1605632
  buffer_load_dwordx4 v14, s[60:63], s27 offen lds
  v_mfma_f32_16x16x32_bf16 v[80:83], v[40:43], v[224:227], v[80:83]
  s_waitcnt lgkmcnt(5)
  v_mfma_f32_16x16x32_bf16 v[60:63], v[44:47], v[128:131], v[60:63]
  ds_read_b128 v[36:39], v249 offset:2304
  v_mfma_f32_16x16x32_bf16 v[68:71], v[44:47], v[160:163], v[68:71]
  v_mfma_f32_16x16x32_bf16 v[76:79], v[44:47], v[192:195], v[76:79]
  v_mfma_f32_16x16x32_bf16 v[84:87], v[44:47], v[224:227], v[84:87]
  s_waitcnt lgkmcnt(5)
  v_mfma_f32_16x16x32_bf16 v[56:59], v[48:51], v[132:135], v[56:59]
  ds_read_b128 v[40:43], v250 offset:256
  v_mfma_f32_16x16x32_bf16 v[64:67], v[48:51], v[164:167], v[64:67]
  v_mfma_f32_16x16x32_bf16 v[72:75], v[48:51], v[196:199], v[72:75]
  s_add_u32 m0, s29, 101376
  s_add_u32 s27, s28, 1622016
  buffer_load_dwordx4 v15, s[60:63], s27 offen lds
  v_mfma_f32_16x16x32_bf16 v[80:83], v[48:51], v[228:231], v[80:83]
  s_waitcnt lgkmcnt(5)
  v_mfma_f32_16x16x32_bf16 v[60:63], v[52:55], v[132:135], v[60:63]
  ds_read_b128 v[44:47], v250 offset:2304
  v_mfma_f32_16x16x32_bf16 v[68:71], v[52:55], v[164:167], v[68:71]
  v_mfma_f32_16x16x32_bf16 v[76:79], v[52:55], v[196:199], v[76:79]
  v_mfma_f32_16x16x32_bf16 v[84:87], v[52:55], v[228:231], v[84:87]
  s_waitcnt lgkmcnt(5)
  v_mfma_f32_16x16x32_bf16 v[56:59], v[24:27], v[136:139], v[56:59]
  ds_read_b128 v[48:51], v251 offset:256
  v_mfma_f32_16x16x32_bf16 v[64:67], v[24:27], v[168:171], v[64:67]
  v_mfma_f32_16x16x32_bf16 v[72:75], v[24:27], v[200:203], v[72:75]
  v_mfma_f32_16x16x32_bf16 v[80:83], v[24:27], v[232:235], v[80:83]
  s_waitcnt lgkmcnt(5)
  v_mfma_f32_16x16x32_bf16 v[60:63], v[28:31], v[136:139], v[60:63]
  ds_read_b128 v[52:55], v251 offset:2304
  v_mfma_f32_16x16x32_bf16 v[68:71], v[28:31], v[168:171], v[68:71]
  v_mfma_f32_16x16x32_bf16 v[76:79], v[28:31], v[200:203], v[76:79]
  v_mfma_f32_16x16x32_bf16 v[84:87], v[28:31], v[232:235], v[84:87]
  s_waitcnt lgkmcnt(5)
  v_mfma_f32_16x16x32_bf16 v[56:59], v[32:35], v[140:143], v[56:59]
  s_waitcnt vmcnt(20)
  s_barrier
  ds_read_b128 v[24:27], v248 offset:16384
  v_mfma_f32_16x16x32_bf16 v[64:67], v[32:35], v[172:175], v[64:67]
  v_mfma_f32_16x16x32_bf16 v[72:75], v[32:35], v[204:207], v[72:75]
  v_mfma_f32_16x16x32_bf16 v[80:83], v[32:35], v[236:239], v[80:83]
  s_waitcnt lgkmcnt(5)
  v_mfma_f32_16x16x32_bf16 v[60:63], v[36:39], v[140:143], v[60:63]
  ds_read_b128 v[28:31], v248 offset:18432
  v_mfma_f32_16x16x32_bf16 v[68:71], v[36:39], v[172:175], v[68:71]
  v_mfma_f32_16x16x32_bf16 v[76:79], v[36:39], v[204:207], v[76:79]
  v_mfma_f32_16x16x32_bf16 v[84:87], v[36:39], v[236:239], v[84:87]
  s_waitcnt lgkmcnt(5)
  v_mfma_f32_16x16x32_bf16 v[56:59], v[40:43], v[144:147], v[56:59]
  ds_read_b128 v[32:35], v249 offset:16384
  v_mfma_f32_16x16x32_bf16 v[64:67], v[40:43], v[176:179], v[64:67]
  v_mfma_f32_16x16x32_bf16 v[72:75], v[40:43], v[208:211], v[72:75]
  v_mfma_f32_16x16x32_bf16 v[80:83], v[40:43], v[240:243], v[80:83]
  s_waitcnt lgkmcnt(5)
  v_mfma_f32_16x16x32_bf16 v[60:63], v[44:47], v[144:147], v[60:63]
  ds_read_b128 v[36:39], v249 offset:18432
  v_mfma_f32_16x16x32_bf16 v[68:71], v[44:47], v[176:179], v[68:71]
  v_mfma_f32_16x16x32_bf16 v[76:79], v[44:47], v[208:211], v[76:79]
  v_mfma_f32_16x16x32_bf16 v[84:87], v[44:47], v[240:243], v[84:87]
  s_waitcnt lgkmcnt(5)
  v_mfma_f32_16x16x32_bf16 v[56:59], v[48:51], v[148:151], v[56:59]
  ds_read_b128 v[40:43], v250 offset:16384
  v_mfma_f32_16x16x32_bf16 v[64:67], v[48:51], v[180:183], v[64:67]
  v_mfma_f32_16x16x32_bf16 v[72:75], v[48:51], v[212:215], v[72:75]
  v_mfma_f32_16x16x32_bf16 v[80:83], v[48:51], v[244:247], v[80:83]
  s_waitcnt lgkmcnt(5)
  v_mfma_f32_16x16x32_bf16 v[60:63], v[52:55], v[148:151], v[60:63]
  ds_read_b128 v[44:47], v250 offset:18432
  v_mfma_f32_16x16x32_bf16 v[68:71], v[52:55], v[180:183], v[68:71]
  v_mfma_f32_16x16x32_bf16 v[76:79], v[52:55], v[212:215], v[76:79]
  v_mfma_f32_16x16x32_bf16 v[84:87], v[52:55], v[244:247], v[84:87]
  s_waitcnt lgkmcnt(5)
  v_mfma_f32_16x16x32_bf16 v[88:91], v[24:27], v[120:123], 0
  ds_read_b128 v[48:51], v251 offset:16384
  v_mfma_f32_16x16x32_bf16 v[96:99], v[24:27], v[152:155], 0
  v_mfma_f32_16x16x32_bf16 v[104:107], v[24:27], v[184:187], 0
  s_add_u32 m0, s29, 114688
  s_add_u32 s27, s28, 1835008
  buffer_load_dwordx4 v14, s[60:63], s27 offen lds
  v_mfma_f32_16x16x32_bf16 v[112:115], v[24:27], v[216:219], 0
  s_waitcnt lgkmcnt(5)
  v_mul_f32 v56, v12, v56
  v_mfma_f32_16x16x32_bf16 v[92:95], v[28:31], v[120:123], 0
  ds_read_b128 v[52:55], v251 offset:18432
  v_mul_f32 v57, v12, v57
  v_mfma_f32_16x16x32_bf16 v[100:103], v[28:31], v[152:155], 0
  v_mul_f32 v58, v12, v58
  v_mul_f32 v59, v12, v59
  v_mfma_f32_16x16x32_bf16 v[108:111], v[28:31], v[184:187], 0
  v_mul_f32 v60, v12, v60
  v_mfma_f32_16x16x32_bf16 v[116:119], v[28:31], v[216:219], 0
  s_waitcnt lgkmcnt(5)
  v_mul_f32 v61, v12, v61
  v_mfma_f32_16x16x32_bf16 v[88:91], v[32:35], v[124:127], v[88:91]
  ds_read_b128 v[24:27], v248 offset:16640
  v_mul_f32 v62, v12, v62
  v_mfma_f32_16x16x32_bf16 v[96:99], v[32:35], v[156:159], v[96:99]
  v_mul_f32 v63, v12, v63
  v_cvt_pk_bf16_f32 v56, v56, v57
  v_mfma_f32_16x16x32_bf16 v[104:107], v[32:35], v[188:191], v[104:107]
  s_add_u32 m0, s29, 115712
  s_add_u32 s27, s28, 1851392
  buffer_load_dwordx4 v15, s[60:63], s27 offen lds
  v_mfma_f32_16x16x32_bf16 v[112:115], v[32:35], v[220:223], v[112:115]
  s_waitcnt lgkmcnt(5)
  v_cvt_pk_bf16_f32 v57, v58, v59
  v_mfma_f32_16x16x32_bf16 v[92:95], v[36:39], v[124:127], v[92:95]
  ds_read_b128 v[28:31], v248 offset:18688
  v_cvt_pk_bf16_f32 v58, v60, v61
  v_mfma_f32_16x16x32_bf16 v[100:103], v[36:39], v[156:159], v[100:103]
  v_cvt_pk_bf16_f32 v59, v62, v63
  v_accvgpr_write_b32 a0, v56
  v_mfma_f32_16x16x32_bf16 v[108:111], v[36:39], v[188:191], v[108:111]
  v_accvgpr_write_b32 a1, v57
  v_mfma_f32_16x16x32_bf16 v[116:119], v[36:39], v[220:223], v[116:119]
  s_waitcnt lgkmcnt(5)
  v_accvgpr_write_b32 a2, v58
  v_mfma_f32_16x16x32_bf16 v[88:91], v[40:43], v[128:131], v[88:91]
  ds_read_b128 v[32:35], v249 offset:16640
  v_accvgpr_write_b32 a3, v59
  v_mfma_f32_16x16x32_bf16 v[96:99], v[40:43], v[160:163], v[96:99]
  v_mul_f32 v64, v12, v64
  v_mul_f32 v65, v12, v65
  v_mfma_f32_16x16x32_bf16 v[104:107], v[40:43], v[192:195], v[104:107]
  s_add_u32 m0, s29, 116736
  s_add_u32 s27, s28, 1867776
  buffer_load_dwordx4 v14, s[60:63], s27 offen lds
  v_mfma_f32_16x16x32_bf16 v[112:115], v[40:43], v[224:227], v[112:115]
  s_waitcnt lgkmcnt(5)
  v_mul_f32 v66, v12, v66
  v_mfma_f32_16x16x32_bf16 v[92:95], v[44:47], v[128:131], v[92:95]
  ds_read_b128 v[36:39], v249 offset:18688
  v_mul_f32 v67, v12, v67
  v_mfma_f32_16x16x32_bf16 v[100:103], v[44:47], v[160:163], v[100:103]
  v_mul_f32 v68, v12, v68
  v_mul_f32 v69, v12, v69
  v_mfma_f32_16x16x32_bf16 v[108:111], v[44:47], v[192:195], v[108:111]
  v_mul_f32 v70, v12, v70
  v_mfma_f32_16x16x32_bf16 v[116:119], v[44:47], v[224:227], v[116:119]
  s_waitcnt lgkmcnt(5)
  v_mul_f32 v71, v12, v71
  v_mfma_f32_16x16x32_bf16 v[88:91], v[48:51], v[132:135], v[88:91]
  ds_read_b128 v[40:43], v250 offset:16640
  v_cvt_pk_bf16_f32 v64, v64, v65
  v_mfma_f32_16x16x32_bf16 v[96:99], v[48:51], v[164:167], v[96:99]
  v_cvt_pk_bf16_f32 v65, v66, v67
  v_cvt_pk_bf16_f32 v66, v68, v69
  v_mfma_f32_16x16x32_bf16 v[104:107], v[48:51], v[196:199], v[104:107]
  s_add_u32 m0, s29, 117760
  s_add_u32 s27, s28, 1884160
  buffer_load_dwordx4 v15, s[60:63], s27 offen lds
  v_mfma_f32_16x16x32_bf16 v[112:115], v[48:51], v[228:231], v[112:115]
  s_waitcnt lgkmcnt(5)
  v_cvt_pk_bf16_f32 v67, v70, v71
  v_mfma_f32_16x16x32_bf16 v[92:95], v[52:55], v[132:135], v[92:95]
  ds_read_b128 v[44:47], v250 offset:18688
  v_accvgpr_write_b32 a56, v64
  v_mfma_f32_16x16x32_bf16 v[100:103], v[52:55], v[164:167], v[100:103]
  v_accvgpr_write_b32 a57, v65
  v_accvgpr_write_b32 a58, v66
  v_mfma_f32_16x16x32_bf16 v[108:111], v[52:55], v[196:199], v[108:111]
  v_accvgpr_write_b32 a59, v67
  v_mfma_f32_16x16x32_bf16 v[116:119], v[52:55], v[228:231], v[116:119]
  s_waitcnt lgkmcnt(5)
  v_mul_f32 v72, v12, v72
  v_mfma_f32_16x16x32_bf16 v[88:91], v[24:27], v[136:139], v[88:91]
  ds_read_b128 v[48:51], v251 offset:16640
  v_mul_f32 v73, v12, v73
  v_mfma_f32_16x16x32_bf16 v[96:99], v[24:27], v[168:171], v[96:99]
  v_mul_f32 v74, v12, v74
  v_mul_f32 v75, v12, v75
  v_mfma_f32_16x16x32_bf16 v[104:107], v[24:27], v[200:203], v[104:107]
  v_mul_f32 v76, v12, v76
  v_mfma_f32_16x16x32_bf16 v[112:115], v[24:27], v[232:235], v[112:115]
  s_waitcnt lgkmcnt(5)
  v_mul_f32 v77, v12, v77
  v_mfma_f32_16x16x32_bf16 v[92:95], v[28:31], v[136:139], v[92:95]
  ds_read_b128 v[52:55], v251 offset:18688
  v_mul_f32 v78, v12, v78
  v_mfma_f32_16x16x32_bf16 v[100:103], v[28:31], v[168:171], v[100:103]
  v_mul_f32 v79, v12, v79
  v_cvt_pk_bf16_f32 v72, v72, v73
  v_mfma_f32_16x16x32_bf16 v[108:111], v[28:31], v[200:203], v[108:111]
  v_cvt_pk_bf16_f32 v73, v74, v75
  v_mfma_f32_16x16x32_bf16 v[116:119], v[28:31], v[232:235], v[116:119]
  s_waitcnt lgkmcnt(5)
  v_cvt_pk_bf16_f32 v74, v76, v77
  v_mfma_f32_16x16x32_bf16 v[88:91], v[32:35], v[140:143], v[88:91]
  s_waitcnt vmcnt(20)
  s_barrier
  ds_read_b128 v[24:27], v248 offset:32768
  v_cvt_pk_bf16_f32 v75, v78, v79
  v_mfma_f32_16x16x32_bf16 v[96:99], v[32:35], v[172:175], v[96:99]
  v_accvgpr_write_b32 a112, v72
  v_accvgpr_write_b32 a113, v73
  v_mfma_f32_16x16x32_bf16 v[104:107], v[32:35], v[204:207], v[104:107]
  v_accvgpr_write_b32 a114, v74
  v_mfma_f32_16x16x32_bf16 v[112:115], v[32:35], v[236:239], v[112:115]
  s_waitcnt lgkmcnt(5)
  v_accvgpr_write_b32 a115, v75
  v_mfma_f32_16x16x32_bf16 v[92:95], v[36:39], v[140:143], v[92:95]
  ds_read_b128 v[28:31], v248 offset:34816
  v_mul_f32 v80, v12, v80
  v_mfma_f32_16x16x32_bf16 v[100:103], v[36:39], v[172:175], v[100:103]
  v_mul_f32 v81, v12, v81
  v_mul_f32 v82, v12, v82
  v_mfma_f32_16x16x32_bf16 v[108:111], v[36:39], v[204:207], v[108:111]
  v_mul_f32 v83, v12, v83
  v_mfma_f32_16x16x32_bf16 v[116:119], v[36:39], v[236:239], v[116:119]
  s_waitcnt lgkmcnt(5)
  v_mul_f32 v84, v12, v84
  v_mfma_f32_16x16x32_bf16 v[88:91], v[40:43], v[144:147], v[88:91]
  ds_read_b128 v[32:35], v249 offset:32768
  v_mul_f32 v85, v12, v85
  v_mfma_f32_16x16x32_bf16 v[96:99], v[40:43], v[176:179], v[96:99]
  v_mul_f32 v86, v12, v86
  v_mul_f32 v87, v12, v87
  v_mfma_f32_16x16x32_bf16 v[104:107], v[40:43], v[208:211], v[104:107]
  v_cvt_pk_bf16_f32 v80, v80, v81
  v_mfma_f32_16x16x32_bf16 v[112:115], v[40:43], v[240:243], v[112:115]
  s_waitcnt lgkmcnt(5)
  v_cvt_pk_bf16_f32 v81, v82, v83
  v_mfma_f32_16x16x32_bf16 v[92:95], v[44:47], v[144:147], v[92:95]
  ds_read_b128 v[36:39], v249 offset:34816
  v_cvt_pk_bf16_f32 v82, v84, v85
  v_mfma_f32_16x16x32_bf16 v[100:103], v[44:47], v[176:179], v[100:103]
  v_cvt_pk_bf16_f32 v83, v86, v87
  v_accvgpr_write_b32 a168, v80
  v_mfma_f32_16x16x32_bf16 v[108:111], v[44:47], v[208:211], v[108:111]
  v_accvgpr_write_b32 a169, v81
  v_mfma_f32_16x16x32_bf16 v[116:119], v[44:47], v[240:243], v[116:119]
  s_waitcnt lgkmcnt(5)
  v_accvgpr_write_b32 a170, v82
  v_mfma_f32_16x16x32_bf16 v[88:91], v[48:51], v[148:151], v[88:91]
  ds_read_b128 v[40:43], v250 offset:32768
  v_accvgpr_write_b32 a171, v83
  v_mfma_f32_16x16x32_bf16 v[96:99], v[48:51], v[180:183], v[96:99]
  v_mfma_f32_16x16x32_bf16 v[104:107], v[48:51], v[212:215], v[104:107]
  v_mfma_f32_16x16x32_bf16 v[112:115], v[48:51], v[244:247], v[112:115]
  s_waitcnt lgkmcnt(5)
  v_mfma_f32_16x16x32_bf16 v[92:95], v[52:55], v[148:151], v[92:95]
  ds_read_b128 v[44:47], v250 offset:34816
  v_mfma_f32_16x16x32_bf16 v[100:103], v[52:55], v[180:183], v[100:103]
  v_mfma_f32_16x16x32_bf16 v[108:111], v[52:55], v[212:215], v[108:111]
  v_mfma_f32_16x16x32_bf16 v[116:119], v[52:55], v[244:247], v[116:119]
  s_waitcnt lgkmcnt(5)
  v_mfma_f32_16x16x32_bf16 v[56:59], v[24:27], v[120:123], 0
  ds_read_b128 v[48:51], v251 offset:32768
  v_mfma_f32_16x16x32_bf16 v[64:67], v[24:27], v[152:155], 0
  v_mfma_f32_16x16x32_bf16 v[72:75], v[24:27], v[184:187], 0
  s_add_u32 m0, s29, 131072
  s_add_u32 s27, s28, 2097152
  buffer_load_dwordx4 v14, s[60:63], s27 offen lds
  v_mfma_f32_16x16x32_bf16 v[80:83], v[24:27], v[216:219], 0
  s_waitcnt lgkmcnt(5)
  v_mul_f32 v88, v12, v88
  v_mfma_f32_16x16x32_bf16 v[60:63], v[28:31], v[120:123], 0
  ds_read_b128 v[52:55], v251 offset:34816
  v_mul_f32 v89, v12, v89
  v_mfma_f32_16x16x32_bf16 v[68:71], v[28:31], v[152:155], 0
  v_mul_f32 v90, v12, v90
  v_mul_f32 v91, v12, v91
  v_mfma_f32_16x16x32_bf16 v[76:79], v[28:31], v[184:187], 0
  v_mul_f32 v92, v12, v92
  v_mfma_f32_16x16x32_bf16 v[84:87], v[28:31], v[216:219], 0
  s_waitcnt lgkmcnt(5)
  v_mul_f32 v93, v12, v93
  v_mfma_f32_16x16x32_bf16 v[56:59], v[32:35], v[124:127], v[56:59]
  ds_read_b128 v[24:27], v248 offset:33024
  v_mul_f32 v94, v12, v94
  v_mfma_f32_16x16x32_bf16 v[64:67], v[32:35], v[156:159], v[64:67]
  v_mul_f32 v95, v12, v95
  v_cvt_pk_bf16_f32 v88, v88, v89
  v_mfma_f32_16x16x32_bf16 v[72:75], v[32:35], v[188:191], v[72:75]
  s_add_u32 m0, s29, 132096
  s_add_u32 s27, s28, 2113536
  buffer_load_dwordx4 v15, s[60:63], s27 offen lds
  v_mfma_f32_16x16x32_bf16 v[80:83], v[32:35], v[220:223], v[80:83]
  s_waitcnt lgkmcnt(5)
  v_cvt_pk_bf16_f32 v89, v90, v91
  v_mfma_f32_16x16x32_bf16 v[60:63], v[36:39], v[124:127], v[60:63]
  ds_read_b128 v[28:31], v248 offset:35072
  v_cvt_pk_bf16_f32 v90, v92, v93
  v_mfma_f32_16x16x32_bf16 v[68:71], v[36:39], v[156:159], v[68:71]
  v_cvt_pk_bf16_f32 v91, v94, v95
  v_accvgpr_write_b32 a4, v88
  v_mfma_f32_16x16x32_bf16 v[76:79], v[36:39], v[188:191], v[76:79]
  v_accvgpr_write_b32 a5, v89
  v_mfma_f32_16x16x32_bf16 v[84:87], v[36:39], v[220:223], v[84:87]
  s_waitcnt lgkmcnt(5)
  v_accvgpr_write_b32 a6, v90
  v_mfma_f32_16x16x32_bf16 v[56:59], v[40:43], v[128:131], v[56:59]
  ds_read_b128 v[32:35], v249 offset:33024
  v_accvgpr_write_b32 a7, v91
  v_mfma_f32_16x16x32_bf16 v[64:67], v[40:43], v[160:163], v[64:67]
  v_mul_f32 v96, v12, v96
  v_mul_f32 v97, v12, v97
  v_mfma_f32_16x16x32_bf16 v[72:75], v[40:43], v[192:195], v[72:75]
  s_add_u32 m0, s29, 133120
  s_add_u32 s27, s28, 2129920
  buffer_load_dwordx4 v14, s[60:63], s27 offen lds
  v_mfma_f32_16x16x32_bf16 v[80:83], v[40:43], v[224:227], v[80:83]
  s_waitcnt lgkmcnt(5)
  v_mul_f32 v98, v12, v98
  v_mfma_f32_16x16x32_bf16 v[60:63], v[44:47], v[128:131], v[60:63]
  ds_read_b128 v[36:39], v249 offset:35072
  v_mul_f32 v99, v12, v99
  v_mfma_f32_16x16x32_bf16 v[68:71], v[44:47], v[160:163], v[68:71]
  v_mul_f32 v100, v12, v100
  v_mul_f32 v101, v12, v101
  v_mfma_f32_16x16x32_bf16 v[76:79], v[44:47], v[192:195], v[76:79]
  v_mul_f32 v102, v12, v102
  v_mfma_f32_16x16x32_bf16 v[84:87], v[44:47], v[224:227], v[84:87]
  s_waitcnt lgkmcnt(5)
  v_mul_f32 v103, v12, v103
  v_mfma_f32_16x16x32_bf16 v[56:59], v[48:51], v[132:135], v[56:59]
  ds_read_b128 v[40:43], v250 offset:33024
  v_cvt_pk_bf16_f32 v96, v96, v97
  v_mfma_f32_16x16x32_bf16 v[64:67], v[48:51], v[164:167], v[64:67]
  v_cvt_pk_bf16_f32 v97, v98, v99
  v_cvt_pk_bf16_f32 v98, v100, v101
  v_mfma_f32_16x16x32_bf16 v[72:75], v[48:51], v[196:199], v[72:75]
  s_add_u32 m0, s29, 134144
  s_add_u32 s27, s28, 2146304
  buffer_load_dwordx4 v15, s[60:63], s27 offen lds
  v_mfma_f32_16x16x32_bf16 v[80:83], v[48:51], v[228:231], v[80:83]
  s_waitcnt lgkmcnt(5)
  v_cvt_pk_bf16_f32 v99, v102, v103
  v_mfma_f32_16x16x32_bf16 v[60:63], v[52:55], v[132:135], v[60:63]
  ds_read_b128 v[44:47], v250 offset:35072
  v_accvgpr_write_b32 a60, v96
  v_mfma_f32_16x16x32_bf16 v[68:71], v[52:55], v[164:167], v[68:71]
  v_accvgpr_write_b32 a61, v97
  v_accvgpr_write_b32 a62, v98
  v_mfma_f32_16x16x32_bf16 v[76:79], v[52:55], v[196:199], v[76:79]
  v_accvgpr_write_b32 a63, v99
  v_mfma_f32_16x16x32_bf16 v[84:87], v[52:55], v[228:231], v[84:87]
  s_waitcnt lgkmcnt(5)
  v_mul_f32 v104, v12, v104
  v_mfma_f32_16x16x32_bf16 v[56:59], v[24:27], v[136:139], v[56:59]
  ds_read_b128 v[48:51], v251 offset:33024
  v_mul_f32 v105, v12, v105
  v_mfma_f32_16x16x32_bf16 v[64:67], v[24:27], v[168:171], v[64:67]
  v_mul_f32 v106, v12, v106
  v_mul_f32 v107, v12, v107
  v_mfma_f32_16x16x32_bf16 v[72:75], v[24:27], v[200:203], v[72:75]
  v_mul_f32 v108, v12, v108
  v_mfma_f32_16x16x32_bf16 v[80:83], v[24:27], v[232:235], v[80:83]
  s_waitcnt lgkmcnt(5)
  v_mul_f32 v109, v12, v109
  v_mfma_f32_16x16x32_bf16 v[60:63], v[28:31], v[136:139], v[60:63]
  ds_read_b128 v[52:55], v251 offset:35072
  v_mul_f32 v110, v12, v110
  v_mfma_f32_16x16x32_bf16 v[68:71], v[28:31], v[168:171], v[68:71]
  v_mul_f32 v111, v12, v111
  v_cvt_pk_bf16_f32 v104, v104, v105
  v_mfma_f32_16x16x32_bf16 v[76:79], v[28:31], v[200:203], v[76:79]
  v_cvt_pk_bf16_f32 v105, v106, v107
  v_mfma_f32_16x16x32_bf16 v[84:87], v[28:31], v[232:235], v[84:87]
  s_waitcnt lgkmcnt(5)
  v_cvt_pk_bf16_f32 v106, v108, v109
  v_mfma_f32_16x16x32_bf16 v[56:59], v[32:35], v[140:143], v[56:59]
  s_waitcnt vmcnt(20)
  s_barrier
  ds_read_b128 v[24:27], v248 offset:49152
  v_cvt_pk_bf16_f32 v107, v110, v111
  v_mfma_f32_16x16x32_bf16 v[64:67], v[32:35], v[172:175], v[64:67]
  v_accvgpr_write_b32 a116, v104
  v_accvgpr_write_b32 a117, v105
  v_mfma_f32_16x16x32_bf16 v[72:75], v[32:35], v[204:207], v[72:75]
  v_accvgpr_write_b32 a118, v106
  v_mfma_f32_16x16x32_bf16 v[80:83], v[32:35], v[236:239], v[80:83]
  s_waitcnt lgkmcnt(5)
  v_accvgpr_write_b32 a119, v107
  v_mfma_f32_16x16x32_bf16 v[60:63], v[36:39], v[140:143], v[60:63]
  ds_read_b128 v[28:31], v248 offset:51200
  v_mul_f32 v112, v12, v112
  v_mfma_f32_16x16x32_bf16 v[68:71], v[36:39], v[172:175], v[68:71]
  v_mul_f32 v113, v12, v113
  v_mul_f32 v114, v12, v114
  v_mfma_f32_16x16x32_bf16 v[76:79], v[36:39], v[204:207], v[76:79]
  v_mul_f32 v115, v12, v115
  v_mfma_f32_16x16x32_bf16 v[84:87], v[36:39], v[236:239], v[84:87]
  s_waitcnt lgkmcnt(5)
  v_mul_f32 v116, v12, v116
  v_mfma_f32_16x16x32_bf16 v[56:59], v[40:43], v[144:147], v[56:59]
  ds_read_b128 v[32:35], v249 offset:49152
  v_mul_f32 v117, v12, v117
  v_mfma_f32_16x16x32_bf16 v[64:67], v[40:43], v[176:179], v[64:67]
  v_mul_f32 v118, v12, v118
  v_mul_f32 v119, v12, v119
  v_mfma_f32_16x16x32_bf16 v[72:75], v[40:43], v[208:211], v[72:75]
  v_cvt_pk_bf16_f32 v112, v112, v113
  v_mfma_f32_16x16x32_bf16 v[80:83], v[40:43], v[240:243], v[80:83]
  s_waitcnt lgkmcnt(5)
  v_cvt_pk_bf16_f32 v113, v114, v115
  v_mfma_f32_16x16x32_bf16 v[60:63], v[44:47], v[144:147], v[60:63]
  ds_read_b128 v[36:39], v249 offset:51200
  v_cvt_pk_bf16_f32 v114, v116, v117
  v_mfma_f32_16x16x32_bf16 v[68:71], v[44:47], v[176:179], v[68:71]
  v_cvt_pk_bf16_f32 v115, v118, v119
  v_accvgpr_write_b32 a172, v112
  v_mfma_f32_16x16x32_bf16 v[76:79], v[44:47], v[208:211], v[76:79]
  v_accvgpr_write_b32 a173, v113
  v_mfma_f32_16x16x32_bf16 v[84:87], v[44:47], v[240:243], v[84:87]
  s_waitcnt lgkmcnt(5)
  v_accvgpr_write_b32 a174, v114
  v_mfma_f32_16x16x32_bf16 v[56:59], v[48:51], v[148:151], v[56:59]
  ds_read_b128 v[40:43], v250 offset:49152
  v_accvgpr_write_b32 a175, v115
  v_mfma_f32_16x16x32_bf16 v[64:67], v[48:51], v[180:183], v[64:67]
  v_mfma_f32_16x16x32_bf16 v[72:75], v[48:51], v[212:215], v[72:75]
  v_mfma_f32_16x16x32_bf16 v[80:83], v[48:51], v[244:247], v[80:83]
  s_waitcnt lgkmcnt(5)
  v_mfma_f32_16x16x32_bf16 v[60:63], v[52:55], v[148:151], v[60:63]
  ds_read_b128 v[44:47], v250 offset:51200
  v_mfma_f32_16x16x32_bf16 v[68:71], v[52:55], v[180:183], v[68:71]
  v_mfma_f32_16x16x32_bf16 v[76:79], v[52:55], v[212:215], v[76:79]
  v_mfma_f32_16x16x32_bf16 v[84:87], v[52:55], v[244:247], v[84:87]
  s_waitcnt lgkmcnt(5)
  s_getpc_b64 s[98:99]
  s_add_u32 s98, s98, 4096
  s_addc_u32 s99, s99, 0
  global_load_dword v7, v6, s[98:99]
  v_mfma_f32_16x16x32_bf16 v[88:91], v[24:27], v[120:123], 0
  ds_read_b128 v[48:51], v251 offset:49152
  v_mfma_f32_16x16x32_bf16 v[96:99], v[24:27], v[152:155], 0
  v_mfma_f32_16x16x32_bf16 v[104:107], v[24:27], v[184:187], 0
  buffer_load_dword v13, off, s[12:15], 0 offset:128 sc1
  buffer_load_dword v9, off, s[12:15], 0 sc1
  s_add_u32 m0, s29, 147456
  s_add_u32 s27, s28, 2359296
  buffer_load_dwordx4 v14, s[60:63], s27 offen lds
  v_mfma_f32_16x16x32_bf16 v[112:115], v[24:27], v[216:219], 0
  s_waitcnt lgkmcnt(5)
  v_mul_f32 v56, v12, v56
  v_mfma_f32_16x16x32_bf16 v[92:95], v[28:31], v[120:123], 0
  ds_read_b128 v[52:55], v251 offset:51200
  v_mul_f32 v57, v12, v57
  v_mfma_f32_16x16x32_bf16 v[100:103], v[28:31], v[152:155], 0
  v_mul_f32 v58, v12, v58
  v_mul_f32 v59, v12, v59
  v_mfma_f32_16x16x32_bf16 v[108:111], v[28:31], v[184:187], 0
  v_mul_f32 v60, v12, v60
  v_mfma_f32_16x16x32_bf16 v[116:119], v[28:31], v[216:219], 0
  s_waitcnt lgkmcnt(5)
  v_mul_f32 v61, v12, v61
  v_mfma_f32_16x16x32_bf16 v[88:91], v[32:35], v[124:127], v[88:91]
  ds_read_b128 v[24:27], v248 offset:49408
  v_mul_f32 v62, v12, v62
  v_mfma_f32_16x16x32_bf16 v[96:99], v[32:35], v[156:159], v[96:99]
  v_mul_f32 v63, v12, v63
  v_cvt_pk_bf16_f32 v56, v56, v57
  v_mfma_f32_16x16x32_bf16 v[104:107], v[32:35], v[188:191], v[104:107]
  s_add_u32 m0, s29, 148480
  s_add_u32 s27, s28, 2375680
  buffer_load_dwordx4 v15, s[60:63], s27 offen lds
  v_mfma_f32_16x16x32_bf16 v[112:115], v[32:35], v[220:223], v[112:115]
  s_waitcnt lgkmcnt(5)
  v_cvt_pk_bf16_f32 v57, v58, v59
  v_mfma_f32_16x16x32_bf16 v[92:95], v[36:39], v[124:127], v[92:95]
  ds_read_b128 v[28:31], v248 offset:51456
  v_cvt_pk_bf16_f32 v58, v60, v61
  v_mfma_f32_16x16x32_bf16 v[100:103], v[36:39], v[156:159], v[100:103]
  v_cvt_pk_bf16_f32 v59, v62, v63
  v_accvgpr_write_b32 a8, v56
  v_mfma_f32_16x16x32_bf16 v[108:111], v[36:39], v[188:191], v[108:111]
  v_accvgpr_write_b32 a9, v57
  v_mfma_f32_16x16x32_bf16 v[116:119], v[36:39], v[220:223], v[116:119]
  s_waitcnt lgkmcnt(5)
  v_accvgpr_write_b32 a10, v58
  v_mfma_f32_16x16x32_bf16 v[88:91], v[40:43], v[128:131], v[88:91]
  ds_read_b128 v[32:35], v249 offset:49408
  v_accvgpr_write_b32 a11, v59
  v_mfma_f32_16x16x32_bf16 v[96:99], v[40:43], v[160:163], v[96:99]
  v_mul_f32 v64, v12, v64
  v_mul_f32 v65, v12, v65
  v_mfma_f32_16x16x32_bf16 v[104:107], v[40:43], v[192:195], v[104:107]
  s_add_u32 m0, s29, 149504
  s_add_u32 s27, s28, 2392064
  buffer_load_dwordx4 v14, s[60:63], s27 offen lds
  v_mfma_f32_16x16x32_bf16 v[112:115], v[40:43], v[224:227], v[112:115]
  s_waitcnt lgkmcnt(5)
  v_mul_f32 v66, v12, v66
  v_mfma_f32_16x16x32_bf16 v[92:95], v[44:47], v[128:131], v[92:95]
  ds_read_b128 v[36:39], v249 offset:51456
  v_mul_f32 v67, v12, v67
  v_mfma_f32_16x16x32_bf16 v[100:103], v[44:47], v[160:163], v[100:103]
  v_mul_f32 v68, v12, v68
  v_mul_f32 v69, v12, v69
  v_mfma_f32_16x16x32_bf16 v[108:111], v[44:47], v[192:195], v[108:111]
  v_mul_f32 v70, v12, v70
  v_mfma_f32_16x16x32_bf16 v[116:119], v[44:47], v[224:227], v[116:119]
  s_waitcnt lgkmcnt(5)
  v_mul_f32 v71, v12, v71
  v_mfma_f32_16x16x32_bf16 v[88:91], v[48:51], v[132:135], v[88:91]
  ds_read_b128 v[40:43], v250 offset:49408
  v_cvt_pk_bf16_f32 v64, v64, v65
  v_mfma_f32_16x16x32_bf16 v[96:99], v[48:51], v[164:167], v[96:99]
  v_cvt_pk_bf16_f32 v65, v66, v67
  v_cvt_pk_bf16_f32 v66, v68, v69
  v_mfma_f32_16x16x32_bf16 v[104:107], v[48:51], v[196:199], v[104:107]
  s_add_u32 m0, s29, 150528
  s_add_u32 s27, s28, 2408448
  buffer_load_dwordx4 v15, s[60:63], s27 offen lds
  v_mfma_f32_16x16x32_bf16 v[112:115], v[48:51], v[228:231], v[112:115]
  s_waitcnt lgkmcnt(5)
  v_cvt_pk_bf16_f32 v67, v70, v71
  v_mfma_f32_16x16x32_bf16 v[92:95], v[52:55], v[132:135], v[92:95]
  ds_read_b128 v[44:47], v250 offset:51456
  v_accvgpr_write_b32 a64, v64
  v_mfma_f32_16x16x32_bf16 v[100:103], v[52:55], v[164:167], v[100:103]
  v_accvgpr_write_b32 a65, v65
  v_accvgpr_write_b32 a66, v66
  v_mfma_f32_16x16x32_bf16 v[108:111], v[52:55], v[196:199], v[108:111]
  v_accvgpr_write_b32 a67, v67
  v_mfma_f32_16x16x32_bf16 v[116:119], v[52:55], v[228:231], v[116:119]
  s_waitcnt lgkmcnt(5)
  v_mul_f32 v72, v12, v72
  v_mfma_f32_16x16x32_bf16 v[88:91], v[24:27], v[136:139], v[88:91]
  ds_read_b128 v[48:51], v251 offset:49408
  v_mul_f32 v73, v12, v73
  v_mfma_f32_16x16x32_bf16 v[96:99], v[24:27], v[168:171], v[96:99]
  v_mul_f32 v74, v12, v74
  v_mul_f32 v75, v12, v75
  v_mfma_f32_16x16x32_bf16 v[104:107], v[24:27], v[200:203], v[104:107]
  v_mul_f32 v76, v12, v76
  v_mfma_f32_16x16x32_bf16 v[112:115], v[24:27], v[232:235], v[112:115]
  s_waitcnt lgkmcnt(5)
  v_mul_f32 v77, v12, v77
  v_mfma_f32_16x16x32_bf16 v[92:95], v[28:31], v[136:139], v[92:95]
  ds_read_b128 v[52:55], v251 offset:51456
  v_mul_f32 v78, v12, v78
  v_mfma_f32_16x16x32_bf16 v[100:103], v[28:31], v[168:171], v[100:103]
  v_mul_f32 v79, v12, v79
  v_cvt_pk_bf16_f32 v72, v72, v73
  v_mfma_f32_16x16x32_bf16 v[108:111], v[28:31], v[200:203], v[108:111]
  v_cvt_pk_bf16_f32 v73, v74, v75
  v_mfma_f32_16x16x32_bf16 v[116:119], v[28:31], v[232:235], v[116:119]
  s_waitcnt lgkmcnt(5)
  v_cvt_pk_bf16_f32 v74, v76, v77
  v_mfma_f32_16x16x32_bf16 v[88:91], v[32:35], v[140:143], v[88:91]
  s_waitcnt vmcnt(20)
  s_barrier
  ds_read_b128 v[24:27], v252 offset:0
  v_cvt_pk_bf16_f32 v75, v78, v79
  v_mfma_f32_16x16x32_bf16 v[96:99], v[32:35], v[172:175], v[96:99]
  v_accvgpr_write_b32 a120, v72
  v_accvgpr_write_b32 a121, v73
  v_mfma_f32_16x16x32_bf16 v[104:107], v[32:35], v[204:207], v[104:107]
  v_accvgpr_write_b32 a122, v74
  v_mfma_f32_16x16x32_bf16 v[112:115], v[32:35], v[236:239], v[112:115]
  s_waitcnt lgkmcnt(5)
  v_accvgpr_write_b32 a123, v75
  v_mfma_f32_16x16x32_bf16 v[92:95], v[36:39], v[140:143], v[92:95]
  ds_read_b128 v[28:31], v252 offset:2048
  v_mul_f32 v80, v12, v80
  v_mfma_f32_16x16x32_bf16 v[100:103], v[36:39], v[172:175], v[100:103]
  v_mul_f32 v81, v12, v81
  v_mul_f32 v82, v12, v82
  v_mfma_f32_16x16x32_bf16 v[108:111], v[36:39], v[204:207], v[108:111]
  v_mul_f32 v83, v12, v83
  v_mfma_f32_16x16x32_bf16 v[116:119], v[36:39], v[236:239], v[116:119]
  s_waitcnt lgkmcnt(5)
  v_mul_f32 v84, v12, v84
  v_mfma_f32_16x16x32_bf16 v[88:91], v[40:43], v[144:147], v[88:91]
  ds_read_b128 v[32:35], v253 offset:0
  v_mul_f32 v85, v12, v85
  v_mfma_f32_16x16x32_bf16 v[96:99], v[40:43], v[176:179], v[96:99]
  v_mul_f32 v86, v12, v86
  v_mul_f32 v87, v12, v87
  v_mfma_f32_16x16x32_bf16 v[104:107], v[40:43], v[208:211], v[104:107]
  v_cvt_pk_bf16_f32 v80, v80, v81
  v_mfma_f32_16x16x32_bf16 v[112:115], v[40:43], v[240:243], v[112:115]
  s_waitcnt lgkmcnt(5)
  v_cvt_pk_bf16_f32 v81, v82, v83
  v_mfma_f32_16x16x32_bf16 v[92:95], v[44:47], v[144:147], v[92:95]
  ds_read_b128 v[36:39], v253 offset:2048
  v_cvt_pk_bf16_f32 v82, v84, v85
  v_mfma_f32_16x16x32_bf16 v[100:103], v[44:47], v[176:179], v[100:103]
  v_cvt_pk_bf16_f32 v83, v86, v87
  v_accvgpr_write_b32 a176, v80
  v_mfma_f32_16x16x32_bf16 v[108:111], v[44:47], v[208:211], v[108:111]
  v_accvgpr_write_b32 a177, v81
  v_mfma_f32_16x16x32_bf16 v[116:119], v[44:47], v[240:243], v[116:119]
  s_waitcnt lgkmcnt(5)
  v_accvgpr_write_b32 a178, v82
  v_mfma_f32_16x16x32_bf16 v[88:91], v[48:51], v[148:151], v[88:91]
  ds_read_b128 v[40:43], v254 offset:0
  v_accvgpr_write_b32 a179, v83
  v_mfma_f32_16x16x32_bf16 v[96:99], v[48:51], v[180:183], v[96:99]
  v_mfma_f32_16x16x32_bf16 v[104:107], v[48:51], v[212:215], v[104:107]
  v_mfma_f32_16x16x32_bf16 v[112:115], v[48:51], v[244:247], v[112:115]
  s_waitcnt lgkmcnt(5)
  v_mfma_f32_16x16x32_bf16 v[92:95], v[52:55], v[148:151], v[92:95]
  ds_read_b128 v[44:47], v254 offset:2048
  v_mfma_f32_16x16x32_bf16 v[100:103], v[52:55], v[180:183], v[100:103]
  v_mfma_f32_16x16x32_bf16 v[108:111], v[52:55], v[212:215], v[108:111]
  v_mfma_f32_16x16x32_bf16 v[116:119], v[52:55], v[244:247], v[116:119]
  s_waitcnt lgkmcnt(5)
  v_mfma_f32_16x16x32_bf16 v[56:59], v[24:27], v[120:123], 0
  ds_read_b128 v[48:51], v255 offset:0
  v_mfma_f32_16x16x32_bf16 v[64:67], v[24:27], v[152:155], 0
  v_mfma_f32_16x16x32_bf16 v[72:75], v[24:27], v[184:187], 0
  s_add_u32 m0, s29, 0
  s_add_u32 s27, s28, 2621440
  buffer_load_dwordx4 v14, s[60:63], s27 offen lds
  v_mfma_f32_16x16x32_bf16 v[80:83], v[24:27], v[216:219], 0
  s_waitcnt lgkmcnt(5)
  v_mul_f32 v88, v12, v88
  v_mfma_f32_16x16x32_bf16 v[60:63], v[28:31], v[120:123], 0
  ds_read_b128 v[52:55], v255 offset:2048
  v_mul_f32 v89, v12, v89
  v_mfma_f32_16x16x32_bf16 v[68:71], v[28:31], v[152:155], 0
  v_mul_f32 v90, v12, v90
  v_mul_f32 v91, v12, v91
  v_mfma_f32_16x16x32_bf16 v[76:79], v[28:31], v[184:187], 0
  v_mul_f32 v92, v12, v92
  v_mfma_f32_16x16x32_bf16 v[84:87], v[28:31], v[216:219], 0
  s_waitcnt lgkmcnt(5)
  v_mul_f32 v93, v12, v93
  v_mfma_f32_16x16x32_bf16 v[56:59], v[32:35], v[124:127], v[56:59]
  ds_read_b128 v[24:27], v252 offset:256
  v_mul_f32 v94, v12, v94
  v_mfma_f32_16x16x32_bf16 v[64:67], v[32:35], v[156:159], v[64:67]
  v_mul_f32 v95, v12, v95
  v_cvt_pk_bf16_f32 v88, v88, v89
  v_mfma_f32_16x16x32_bf16 v[72:75], v[32:35], v[188:191], v[72:75]
  s_add_u32 m0, s29, 1024
  s_add_u32 s27, s28, 2637824
  buffer_load_dwordx4 v15, s[60:63], s27 offen lds
  v_mfma_f32_16x16x32_bf16 v[80:83], v[32:35], v[220:223], v[80:83]
  s_waitcnt lgkmcnt(5)
  v_cvt_pk_bf16_f32 v89, v90, v91
  v_mfma_f32_16x16x32_bf16 v[60:63], v[36:39], v[124:127], v[60:63]
  ds_read_b128 v[28:31], v252 offset:2304
  v_cvt_pk_bf16_f32 v90, v92, v93
  v_mfma_f32_16x16x32_bf16 v[68:71], v[36:39], v[156:159], v[68:71]
  v_cvt_pk_bf16_f32 v91, v94, v95
  v_accvgpr_write_b32 a12, v88
  v_mfma_f32_16x16x32_bf16 v[76:79], v[36:39], v[188:191], v[76:79]
  v_accvgpr_write_b32 a13, v89
  v_mfma_f32_16x16x32_bf16 v[84:87], v[36:39], v[220:223], v[84:87]
  s_waitcnt lgkmcnt(5)
  v_accvgpr_write_b32 a14, v90
  v_mfma_f32_16x16x32_bf16 v[56:59], v[40:43], v[128:131], v[56:59]
  ds_read_b128 v[32:35], v253 offset:256
  v_accvgpr_write_b32 a15, v91
  v_mfma_f32_16x16x32_bf16 v[64:67], v[40:43], v[160:163], v[64:67]
  v_mul_f32 v96, v12, v96
  v_mul_f32 v97, v12, v97
  v_mfma_f32_16x16x32_bf16 v[72:75], v[40:43], v[192:195], v[72:75]
  s_add_u32 m0, s29, 2048
  s_add_u32 s27, s28, 2654208
  buffer_load_dwordx4 v14, s[60:63], s27 offen lds
  v_mfma_f32_16x16x32_bf16 v[80:83], v[40:43], v[224:227], v[80:83]
  s_waitcnt lgkmcnt(5)
  v_mul_f32 v98, v12, v98
  v_mfma_f32_16x16x32_bf16 v[60:63], v[44:47], v[128:131], v[60:63]
  ds_read_b128 v[36:39], v253 offset:2304
  v_mul_f32 v99, v12, v99
  v_mfma_f32_16x16x32_bf16 v[68:71], v[44:47], v[160:163], v[68:71]
  v_mul_f32 v100, v12, v100
  v_mul_f32 v101, v12, v101
  v_mfma_f32_16x16x32_bf16 v[76:79], v[44:47], v[192:195], v[76:79]
  v_mul_f32 v102, v12, v102
  v_mfma_f32_16x16x32_bf16 v[84:87], v[44:47], v[224:227], v[84:87]
  s_waitcnt lgkmcnt(5)
  v_mul_f32 v103, v12, v103
  v_mfma_f32_16x16x32_bf16 v[56:59], v[48:51], v[132:135], v[56:59]
  ds_read_b128 v[40:43], v254 offset:256
  v_cvt_pk_bf16_f32 v96, v96, v97
  v_mfma_f32_16x16x32_bf16 v[64:67], v[48:51], v[164:167], v[64:67]
  v_cvt_pk_bf16_f32 v97, v98, v99
  v_cvt_pk_bf16_f32 v98, v100, v101
  v_mfma_f32_16x16x32_bf16 v[72:75], v[48:51], v[196:199], v[72:75]
  s_add_u32 m0, s29, 3072
  s_add_u32 s27, s28, 2670592
  buffer_load_dwordx4 v15, s[60:63], s27 offen lds
  v_mfma_f32_16x16x32_bf16 v[80:83], v[48:51], v[228:231], v[80:83]
  s_waitcnt lgkmcnt(5)
  v_cvt_pk_bf16_f32 v99, v102, v103
  v_mfma_f32_16x16x32_bf16 v[60:63], v[52:55], v[132:135], v[60:63]
  ds_read_b128 v[44:47], v254 offset:2304
  v_accvgpr_write_b32 a68, v96
  v_mfma_f32_16x16x32_bf16 v[68:71], v[52:55], v[164:167], v[68:71]
  v_accvgpr_write_b32 a69, v97
  v_accvgpr_write_b32 a70, v98
  v_mfma_f32_16x16x32_bf16 v[76:79], v[52:55], v[196:199], v[76:79]
  v_accvgpr_write_b32 a71, v99
  v_mfma_f32_16x16x32_bf16 v[84:87], v[52:55], v[228:231], v[84:87]
  s_waitcnt lgkmcnt(5)
  v_mul_f32 v104, v12, v104
  v_mfma_f32_16x16x32_bf16 v[56:59], v[24:27], v[136:139], v[56:59]
  ds_read_b128 v[48:51], v255 offset:256
  v_mul_f32 v105, v12, v105
  v_mfma_f32_16x16x32_bf16 v[64:67], v[24:27], v[168:171], v[64:67]
  v_mul_f32 v106, v12, v106
  v_mul_f32 v107, v12, v107
  v_mfma_f32_16x16x32_bf16 v[72:75], v[24:27], v[200:203], v[72:75]
  v_mul_f32 v108, v12, v108
  v_mfma_f32_16x16x32_bf16 v[80:83], v[24:27], v[232:235], v[80:83]
  s_waitcnt lgkmcnt(5)
  v_mul_f32 v109, v12, v109
  v_mfma_f32_16x16x32_bf16 v[60:63], v[28:31], v[136:139], v[60:63]
  ds_read_b128 v[52:55], v255 offset:2304
  v_mul_f32 v110, v12, v110
  v_mfma_f32_16x16x32_bf16 v[68:71], v[28:31], v[168:171], v[68:71]
  v_mul_f32 v111, v12, v111
  v_cvt_pk_bf16_f32 v104, v104, v105
  v_mfma_f32_16x16x32_bf16 v[76:79], v[28:31], v[200:203], v[76:79]
  v_cvt_pk_bf16_f32 v105, v106, v107
  v_mfma_f32_16x16x32_bf16 v[84:87], v[28:31], v[232:235], v[84:87]
  s_waitcnt lgkmcnt(5)
  v_cvt_pk_bf16_f32 v106, v108, v109
  v_mfma_f32_16x16x32_bf16 v[56:59], v[32:35], v[140:143], v[56:59]
  s_waitcnt vmcnt(20)
  s_barrier
  ds_read_b128 v[24:27], v252 offset:16384
  v_cvt_pk_bf16_f32 v107, v110, v111
  v_mfma_f32_16x16x32_bf16 v[64:67], v[32:35], v[172:175], v[64:67]
  v_accvgpr_write_b32 a124, v104
  v_accvgpr_write_b32 a125, v105
  v_mfma_f32_16x16x32_bf16 v[72:75], v[32:35], v[204:207], v[72:75]
  v_accvgpr_write_b32 a126, v106
  v_mfma_f32_16x16x32_bf16 v[80:83], v[32:35], v[236:239], v[80:83]
  s_waitcnt lgkmcnt(5)
  v_accvgpr_write_b32 a127, v107
  v_mfma_f32_16x16x32_bf16 v[60:63], v[36:39], v[140:143], v[60:63]
  ds_read_b128 v[28:31], v252 offset:18432
  v_mul_f32 v112, v12, v112
  v_mfma_f32_16x16x32_bf16 v[68:71], v[36:39], v[172:175], v[68:71]
  v_mul_f32 v113, v12, v113
  v_mul_f32 v114, v12, v114
  v_mfma_f32_16x16x32_bf16 v[76:79], v[36:39], v[204:207], v[76:79]
  v_mul_f32 v115, v12, v115
  v_mfma_f32_16x16x32_bf16 v[84:87], v[36:39], v[236:239], v[84:87]
  s_waitcnt lgkmcnt(5)
  v_mul_f32 v116, v12, v116
  v_mfma_f32_16x16x32_bf16 v[56:59], v[40:43], v[144:147], v[56:59]
  ds_read_b128 v[32:35], v253 offset:16384
  v_mul_f32 v117, v12, v117
  v_mfma_f32_16x16x32_bf16 v[64:67], v[40:43], v[176:179], v[64:67]
  v_mul_f32 v118, v12, v118
  v_mul_f32 v119, v12, v119
  v_mfma_f32_16x16x32_bf16 v[72:75], v[40:43], v[208:211], v[72:75]
  v_cvt_pk_bf16_f32 v112, v112, v113
  v_mfma_f32_16x16x32_bf16 v[80:83], v[40:43], v[240:243], v[80:83]
  s_waitcnt lgkmcnt(5)
  v_cvt_pk_bf16_f32 v113, v114, v115
  v_mfma_f32_16x16x32_bf16 v[60:63], v[44:47], v[144:147], v[60:63]
  ds_read_b128 v[36:39], v253 offset:18432
  v_cvt_pk_bf16_f32 v114, v116, v117
  v_mfma_f32_16x16x32_bf16 v[68:71], v[44:47], v[176:179], v[68:71]
  v_cvt_pk_bf16_f32 v115, v118, v119
  v_accvgpr_write_b32 a180, v112
  v_mfma_f32_16x16x32_bf16 v[76:79], v[44:47], v[208:211], v[76:79]
  v_accvgpr_write_b32 a181, v113
  v_mfma_f32_16x16x32_bf16 v[84:87], v[44:47], v[240:243], v[84:87]
  s_waitcnt lgkmcnt(5)
  v_accvgpr_write_b32 a182, v114
  v_mfma_f32_16x16x32_bf16 v[56:59], v[48:51], v[148:151], v[56:59]
  ds_read_b128 v[40:43], v254 offset:16384
  v_accvgpr_write_b32 a183, v115
  v_mfma_f32_16x16x32_bf16 v[64:67], v[48:51], v[180:183], v[64:67]
  v_mfma_f32_16x16x32_bf16 v[72:75], v[48:51], v[212:215], v[72:75]
  v_mfma_f32_16x16x32_bf16 v[80:83], v[48:51], v[244:247], v[80:83]
  s_waitcnt lgkmcnt(5)
  v_mfma_f32_16x16x32_bf16 v[60:63], v[52:55], v[148:151], v[60:63]
  ds_read_b128 v[44:47], v254 offset:18432
  v_mfma_f32_16x16x32_bf16 v[68:71], v[52:55], v[180:183], v[68:71]
  v_mfma_f32_16x16x32_bf16 v[76:79], v[52:55], v[212:215], v[76:79]
  v_mfma_f32_16x16x32_bf16 v[84:87], v[52:55], v[244:247], v[84:87]
  s_waitcnt lgkmcnt(5)
  v_mfma_f32_16x16x32_bf16 v[88:91], v[24:27], v[120:123], 0
  ds_read_b128 v[48:51], v255 offset:16384
  v_mfma_f32_16x16x32_bf16 v[96:99], v[24:27], v[152:155], 0
  v_mfma_f32_16x16x32_bf16 v[104:107], v[24:27], v[184:187], 0
  s_add_u32 m0, s29, 16384
  s_add_u32 s27, s28, 2883584
  buffer_load_dwordx4 v14, s[60:63], s27 offen lds
  v_mfma_f32_16x16x32_bf16 v[112:115], v[24:27], v[216:219], 0
  s_waitcnt lgkmcnt(5)
  v_mul_f32 v56, v12, v56
  v_mfma_f32_16x16x32_bf16 v[92:95], v[28:31], v[120:123], 0
  ds_read_b128 v[52:55], v255 offset:18432
  v_mul_f32 v57, v12, v57
  v_mfma_f32_16x16x32_bf16 v[100:103], v[28:31], v[152:155], 0
  v_mul_f32 v58, v12, v58
  v_mul_f32 v59, v12, v59
  v_mfma_f32_16x16x32_bf16 v[108:111], v[28:31], v[184:187], 0
  v_mul_f32 v60, v12, v60
  v_mfma_f32_16x16x32_bf16 v[116:119], v[28:31], v[216:219], 0
  s_waitcnt lgkmcnt(5)
  v_mul_f32 v61, v12, v61
  v_mfma_f32_16x16x32_bf16 v[88:91], v[32:35], v[124:127], v[88:91]
  ds_read_b128 v[24:27], v252 offset:16640
  v_mul_f32 v62, v12, v62
  v_mfma_f32_16x16x32_bf16 v[96:99], v[32:35], v[156:159], v[96:99]
  v_mul_f32 v63, v12, v63
  v_cvt_pk_bf16_f32 v56, v56, v57
  v_mfma_f32_16x16x32_bf16 v[104:107], v[32:35], v[188:191], v[104:107]
  s_add_u32 m0, s29, 17408
  s_add_u32 s27, s28, 2899968
  buffer_load_dwordx4 v15, s[60:63], s27 offen lds
  v_mfma_f32_16x16x32_bf16 v[112:115], v[32:35], v[220:223], v[112:115]
  s_waitcnt lgkmcnt(5)
  v_cvt_pk_bf16_f32 v57, v58, v59
  v_mfma_f32_16x16x32_bf16 v[92:95], v[36:39], v[124:127], v[92:95]
  ds_read_b128 v[28:31], v252 offset:18688
  v_cvt_pk_bf16_f32 v58, v60, v61
  v_mfma_f32_16x16x32_bf16 v[100:103], v[36:39], v[156:159], v[100:103]
  v_cvt_pk_bf16_f32 v59, v62, v63
  v_accvgpr_write_b32 a16, v56
  v_mfma_f32_16x16x32_bf16 v[108:111], v[36:39], v[188:191], v[108:111]
  v_accvgpr_write_b32 a17, v57
  v_mfma_f32_16x16x32_bf16 v[116:119], v[36:39], v[220:223], v[116:119]
  s_waitcnt lgkmcnt(5)
  v_accvgpr_write_b32 a18, v58
  v_mfma_f32_16x16x32_bf16 v[88:91], v[40:43], v[128:131], v[88:91]
  ds_read_b128 v[32:35], v253 offset:16640
  v_accvgpr_write_b32 a19, v59
  v_mfma_f32_16x16x32_bf16 v[96:99], v[40:43], v[160:163], v[96:99]
  v_mul_f32 v64, v12, v64
  v_mul_f32 v65, v12, v65
  v_mfma_f32_16x16x32_bf16 v[104:107], v[40:43], v[192:195], v[104:107]
  s_add_u32 m0, s29, 18432
  s_add_u32 s27, s28, 2916352
  buffer_load_dwordx4 v14, s[60:63], s27 offen lds
  v_mfma_f32_16x16x32_bf16 v[112:115], v[40:43], v[224:227], v[112:115]
  s_waitcnt lgkmcnt(5)
  v_mul_f32 v66, v12, v66
  v_mfma_f32_16x16x32_bf16 v[92:95], v[44:47], v[128:131], v[92:95]
  ds_read_b128 v[36:39], v253 offset:18688
  v_mul_f32 v67, v12, v67
  v_mfma_f32_16x16x32_bf16 v[100:103], v[44:47], v[160:163], v[100:103]
  v_mul_f32 v68, v12, v68
  v_mul_f32 v69, v12, v69
  v_mfma_f32_16x16x32_bf16 v[108:111], v[44:47], v[192:195], v[108:111]
  v_mul_f32 v70, v12, v70
  v_mfma_f32_16x16x32_bf16 v[116:119], v[44:47], v[224:227], v[116:119]
  s_waitcnt lgkmcnt(5)
  v_mul_f32 v71, v12, v71
  v_mfma_f32_16x16x32_bf16 v[88:91], v[48:51], v[132:135], v[88:91]
  ds_read_b128 v[40:43], v254 offset:16640
  v_cvt_pk_bf16_f32 v64, v64, v65
  v_mfma_f32_16x16x32_bf16 v[96:99], v[48:51], v[164:167], v[96:99]
  v_cvt_pk_bf16_f32 v65, v66, v67
  v_cvt_pk_bf16_f32 v66, v68, v69
  v_mfma_f32_16x16x32_bf16 v[104:107], v[48:51], v[196:199], v[104:107]
  s_add_u32 m0, s29, 19456
  s_add_u32 s27, s28, 2932736
  buffer_load_dwordx4 v15, s[60:63], s27 offen lds
  v_mfma_f32_16x16x32_bf16 v[112:115], v[48:51], v[228:231], v[112:115]
  s_waitcnt lgkmcnt(5)
  v_cvt_pk_bf16_f32 v67, v70, v71
  v_mfma_f32_16x16x32_bf16 v[92:95], v[52:55], v[132:135], v[92:95]
  ds_read_b128 v[44:47], v254 offset:18688
  v_accvgpr_write_b32 a72, v64
  v_mfma_f32_16x16x32_bf16 v[100:103], v[52:55], v[164:167], v[100:103]
  v_accvgpr_write_b32 a73, v65
  v_accvgpr_write_b32 a74, v66
  v_mfma_f32_16x16x32_bf16 v[108:111], v[52:55], v[196:199], v[108:111]
  v_accvgpr_write_b32 a75, v67
  v_mfma_f32_16x16x32_bf16 v[116:119], v[52:55], v[228:231], v[116:119]
  s_waitcnt lgkmcnt(5)
  v_mul_f32 v72, v12, v72
  v_mfma_f32_16x16x32_bf16 v[88:91], v[24:27], v[136:139], v[88:91]
  ds_read_b128 v[48:51], v255 offset:16640
  v_mul_f32 v73, v12, v73
  v_mfma_f32_16x16x32_bf16 v[96:99], v[24:27], v[168:171], v[96:99]
  v_mul_f32 v74, v12, v74
  v_mul_f32 v75, v12, v75
  v_mfma_f32_16x16x32_bf16 v[104:107], v[24:27], v[200:203], v[104:107]
  v_mul_f32 v76, v12, v76
  v_mfma_f32_16x16x32_bf16 v[112:115], v[24:27], v[232:235], v[112:115]
  s_waitcnt lgkmcnt(5)
  v_mul_f32 v77, v12, v77
  v_mfma_f32_16x16x32_bf16 v[92:95], v[28:31], v[136:139], v[92:95]
  ds_read_b128 v[52:55], v255 offset:18688
  v_mul_f32 v78, v12, v78
  v_mfma_f32_16x16x32_bf16 v[100:103], v[28:31], v[168:171], v[100:103]
  v_mul_f32 v79, v12, v79
  v_cvt_pk_bf16_f32 v72, v72, v73
  v_mfma_f32_16x16x32_bf16 v[108:111], v[28:31], v[200:203], v[108:111]
  v_cvt_pk_bf16_f32 v73, v74, v75
  v_mfma_f32_16x16x32_bf16 v[116:119], v[28:31], v[232:235], v[116:119]
  s_waitcnt lgkmcnt(5)
  v_cvt_pk_bf16_f32 v74, v76, v77
  v_mfma_f32_16x16x32_bf16 v[88:91], v[32:35], v[140:143], v[88:91]
  s_waitcnt vmcnt(20)
  s_barrier
  ds_read_b128 v[24:27], v252 offset:32768
  v_cvt_pk_bf16_f32 v75, v78, v79
  v_mfma_f32_16x16x32_bf16 v[96:99], v[32:35], v[172:175], v[96:99]
  v_accvgpr_write_b32 a128, v72
  v_accvgpr_write_b32 a129, v73
  v_mfma_f32_16x16x32_bf16 v[104:107], v[32:35], v[204:207], v[104:107]
  v_accvgpr_write_b32 a130, v74
  v_mfma_f32_16x16x32_bf16 v[112:115], v[32:35], v[236:239], v[112:115]
  s_waitcnt lgkmcnt(5)
  v_accvgpr_write_b32 a131, v75
  v_mfma_f32_16x16x32_bf16 v[92:95], v[36:39], v[140:143], v[92:95]
  ds_read_b128 v[28:31], v252 offset:34816
  v_mul_f32 v80, v12, v80
  v_mfma_f32_16x16x32_bf16 v[100:103], v[36:39], v[172:175], v[100:103]
  v_mul_f32 v81, v12, v81
  v_mul_f32 v82, v12, v82
  v_mfma_f32_16x16x32_bf16 v[108:111], v[36:39], v[204:207], v[108:111]
  v_mul_f32 v83, v12, v83
  v_mfma_f32_16x16x32_bf16 v[116:119], v[36:39], v[236:239], v[116:119]
  s_waitcnt lgkmcnt(5)
  v_mul_f32 v84, v12, v84
  v_mfma_f32_16x16x32_bf16 v[88:91], v[40:43], v[144:147], v[88:91]
  ds_read_b128 v[32:35], v253 offset:32768
  v_mul_f32 v85, v12, v85
  v_mfma_f32_16x16x32_bf16 v[96:99], v[40:43], v[176:179], v[96:99]
  v_mul_f32 v86, v12, v86
  v_mul_f32 v87, v12, v87
  v_mfma_f32_16x16x32_bf16 v[104:107], v[40:43], v[208:211], v[104:107]
  v_cvt_pk_bf16_f32 v80, v80, v81
  v_mfma_f32_16x16x32_bf16 v[112:115], v[40:43], v[240:243], v[112:115]
  s_waitcnt lgkmcnt(5)
  v_cvt_pk_bf16_f32 v81, v82, v83
  v_mfma_f32_16x16x32_bf16 v[92:95], v[44:47], v[144:147], v[92:95]
  ds_read_b128 v[36:39], v253 offset:34816
  v_cvt_pk_bf16_f32 v82, v84, v85
  v_mfma_f32_16x16x32_bf16 v[100:103], v[44:47], v[176:179], v[100:103]
  v_cvt_pk_bf16_f32 v83, v86, v87
  v_accvgpr_write_b32 a184, v80
  v_mfma_f32_16x16x32_bf16 v[108:111], v[44:47], v[208:211], v[108:111]
  v_accvgpr_write_b32 a185, v81
  v_mfma_f32_16x16x32_bf16 v[116:119], v[44:47], v[240:243], v[116:119]
  s_waitcnt lgkmcnt(5)
  v_accvgpr_write_b32 a186, v82
  v_mfma_f32_16x16x32_bf16 v[88:91], v[48:51], v[148:151], v[88:91]
  ds_read_b128 v[40:43], v254 offset:32768
  v_accvgpr_write_b32 a187, v83
  v_mfma_f32_16x16x32_bf16 v[96:99], v[48:51], v[180:183], v[96:99]
  v_mfma_f32_16x16x32_bf16 v[104:107], v[48:51], v[212:215], v[104:107]
  v_mfma_f32_16x16x32_bf16 v[112:115], v[48:51], v[244:247], v[112:115]
  s_waitcnt lgkmcnt(5)
  v_mfma_f32_16x16x32_bf16 v[92:95], v[52:55], v[148:151], v[92:95]
  ds_read_b128 v[44:47], v254 offset:34816
  v_mfma_f32_16x16x32_bf16 v[100:103], v[52:55], v[180:183], v[100:103]
  v_mfma_f32_16x16x32_bf16 v[108:111], v[52:55], v[212:215], v[108:111]
  v_mfma_f32_16x16x32_bf16 v[116:119], v[52:55], v[244:247], v[116:119]
  s_waitcnt lgkmcnt(5)
  s_getpc_b64 s[98:99]
  s_add_u32 s98, s98, 4096
  s_addc_u32 s99, s99, 0
  global_load_dword v7, v6, s[98:99]
  v_mfma_f32_16x16x32_bf16 v[56:59], v[24:27], v[120:123], 0
  ds_read_b128 v[48:51], v255 offset:32768
  v_mfma_f32_16x16x32_bf16 v[64:67], v[24:27], v[152:155], 0
  v_mfma_f32_16x16x32_bf16 v[72:75], v[24:27], v[184:187], 0
  s_add_u32 m0, s29, 32768
  s_add_u32 s27, s28, 3145728
  buffer_load_dwordx4 v14, s[60:63], s27 offen lds
  v_mfma_f32_16x16x32_bf16 v[80:83], v[24:27], v[216:219], 0
  s_waitcnt lgkmcnt(5)
  v_mul_f32 v88, v12, v88
  v_mfma_f32_16x16x32_bf16 v[60:63], v[28:31], v[120:123], 0
  ds_read_b128 v[52:55], v255 offset:34816
  v_mul_f32 v89, v12, v89
  v_mfma_f32_16x16x32_bf16 v[68:71], v[28:31], v[152:155], 0
  v_mul_f32 v90, v12, v90
  v_mul_f32 v91, v12, v91
  v_mfma_f32_16x16x32_bf16 v[76:79], v[28:31], v[184:187], 0
  v_mul_f32 v92, v12, v92
  v_mfma_f32_16x16x32_bf16 v[84:87], v[28:31], v[216:219], 0
  s_waitcnt lgkmcnt(5)
  v_mul_f32 v93, v12, v93
  v_mfma_f32_16x16x32_bf16 v[56:59], v[32:35], v[124:127], v[56:59]
  ds_read_b128 v[24:27], v252 offset:33024
  v_mul_f32 v94, v12, v94
  v_mfma_f32_16x16x32_bf16 v[64:67], v[32:35], v[156:159], v[64:67]
  v_mul_f32 v95, v12, v95
  v_cvt_pk_bf16_f32 v88, v88, v89
  v_mfma_f32_16x16x32_bf16 v[72:75], v[32:35], v[188:191], v[72:75]
  s_add_u32 m0, s29, 33792
  s_add_u32 s27, s28, 3162112
  buffer_load_dwordx4 v15, s[60:63], s27 offen lds
  v_mfma_f32_16x16x32_bf16 v[80:83], v[32:35], v[220:223], v[80:83]
  s_waitcnt lgkmcnt(5)
  v_cvt_pk_bf16_f32 v89, v90, v91
  v_mfma_f32_16x16x32_bf16 v[60:63], v[36:39], v[124:127], v[60:63]
  ds_read_b128 v[28:31], v252 offset:35072
  v_cvt_pk_bf16_f32 v90, v92, v93
  v_mfma_f32_16x16x32_bf16 v[68:71], v[36:39], v[156:159], v[68:71]
  v_cvt_pk_bf16_f32 v91, v94, v95
  v_accvgpr_write_b32 a20, v88
  v_mfma_f32_16x16x32_bf16 v[76:79], v[36:39], v[188:191], v[76:79]
  v_accvgpr_write_b32 a21, v89
  v_mfma_f32_16x16x32_bf16 v[84:87], v[36:39], v[220:223], v[84:87]
  s_waitcnt lgkmcnt(5)
  v_accvgpr_write_b32 a22, v90
  v_mfma_f32_16x16x32_bf16 v[56:59], v[40:43], v[128:131], v[56:59]
  ds_read_b128 v[32:35], v253 offset:33024
  v_accvgpr_write_b32 a23, v91
  v_mfma_f32_16x16x32_bf16 v[64:67], v[40:43], v[160:163], v[64:67]
  v_mul_f32 v96, v12, v96
  v_mul_f32 v97, v12, v97
  v_mfma_f32_16x16x32_bf16 v[72:75], v[40:43], v[192:195], v[72:75]
  s_add_u32 m0, s29, 34816
  s_add_u32 s27, s28, 3178496
  buffer_load_dwordx4 v14, s[60:63], s27 offen lds
  v_mfma_f32_16x16x32_bf16 v[80:83], v[40:43], v[224:227], v[80:83]
  s_waitcnt lgkmcnt(5)
  v_mul_f32 v98, v12, v98
  v_mfma_f32_16x16x32_bf16 v[60:63], v[44:47], v[128:131], v[60:63]
  ds_read_b128 v[36:39], v253 offset:35072
  v_mul_f32 v99, v12, v99
  v_mfma_f32_16x16x32_bf16 v[68:71], v[44:47], v[160:163], v[68:71]
  v_mul_f32 v100, v12, v100
  v_mul_f32 v101, v12, v101
  v_mfma_f32_16x16x32_bf16 v[76:79], v[44:47], v[192:195], v[76:79]
  v_mul_f32 v102, v12, v102
  v_mfma_f32_16x16x32_bf16 v[84:87], v[44:47], v[224:227], v[84:87]
  s_waitcnt lgkmcnt(5)
  v_mul_f32 v103, v12, v103
  v_mfma_f32_16x16x32_bf16 v[56:59], v[48:51], v[132:135], v[56:59]
  ds_read_b128 v[40:43], v254 offset:33024
  v_cvt_pk_bf16_f32 v96, v96, v97
  v_mfma_f32_16x16x32_bf16 v[64:67], v[48:51], v[164:167], v[64:67]
  v_cvt_pk_bf16_f32 v97, v98, v99
  v_cvt_pk_bf16_f32 v98, v100, v101
  v_mfma_f32_16x16x32_bf16 v[72:75], v[48:51], v[196:199], v[72:75]
  s_add_u32 m0, s29, 35840
  s_add_u32 s27, s28, 3194880
  buffer_load_dwordx4 v15, s[60:63], s27 offen lds
  v_mfma_f32_16x16x32_bf16 v[80:83], v[48:51], v[228:231], v[80:83]
  s_waitcnt lgkmcnt(5)
  v_cvt_pk_bf16_f32 v99, v102, v103
  v_mfma_f32_16x16x32_bf16 v[60:63], v[52:55], v[132:135], v[60:63]
  ds_read_b128 v[44:47], v254 offset:35072
  v_accvgpr_write_b32 a76, v96
  v_mfma_f32_16x16x32_bf16 v[68:71], v[52:55], v[164:167], v[68:71]
  v_accvgpr_write_b32 a77, v97
  v_accvgpr_write_b32 a78, v98
  v_mfma_f32_16x16x32_bf16 v[76:79], v[52:55], v[196:199], v[76:79]
  v_accvgpr_write_b32 a79, v99
  v_mfma_f32_16x16x32_bf16 v[84:87], v[52:55], v[228:231], v[84:87]
  s_waitcnt lgkmcnt(5)
  v_mul_f32 v104, v12, v104
  v_mfma_f32_16x16x32_bf16 v[56:59], v[24:27], v[136:139], v[56:59]
  ds_read_b128 v[48:51], v255 offset:33024
  v_mul_f32 v105, v12, v105
  v_mfma_f32_16x16x32_bf16 v[64:67], v[24:27], v[168:171], v[64:67]
  v_mul_f32 v106, v12, v106
  v_mul_f32 v107, v12, v107
  v_mfma_f32_16x16x32_bf16 v[72:75], v[24:27], v[200:203], v[72:75]
  v_mul_f32 v108, v12, v108
  v_mfma_f32_16x16x32_bf16 v[80:83], v[24:27], v[232:235], v[80:83]
  s_waitcnt lgkmcnt(5)
  v_mul_f32 v109, v12, v109
  v_mfma_f32_16x16x32_bf16 v[60:63], v[28:31], v[136:139], v[60:63]
  ds_read_b128 v[52:55], v255 offset:35072
  v_mul_f32 v110, v12, v110
  v_mfma_f32_16x16x32_bf16 v[68:71], v[28:31], v[168:171], v[68:71]
  v_mul_f32 v111, v12, v111
  v_cvt_pk_bf16_f32 v104, v104, v105
  v_mfma_f32_16x16x32_bf16 v[76:79], v[28:31], v[200:203], v[76:79]
  v_cvt_pk_bf16_f32 v105, v106, v107
  v_mfma_f32_16x16x32_bf16 v[84:87], v[28:31], v[232:235], v[84:87]
  s_waitcnt lgkmcnt(5)
  v_cvt_pk_bf16_f32 v106, v108, v109
  v_mfma_f32_16x16x32_bf16 v[56:59], v[32:35], v[140:143], v[56:59]
  s_waitcnt vmcnt(20)
  s_barrier
  ds_read_b128 v[24:27], v252 offset:49152
  v_cvt_pk_bf16_f32 v107, v110, v111
  v_mfma_f32_16x16x32_bf16 v[64:67], v[32:35], v[172:175], v[64:67]
  v_accvgpr_write_b32 a132, v104
  v_accvgpr_write_b32 a133, v105
  v_mfma_f32_16x16x32_bf16 v[72:75], v[32:35], v[204:207], v[72:75]
  v_accvgpr_write_b32 a134, v106
  v_mfma_f32_16x16x32_bf16 v[80:83], v[32:35], v[236:239], v[80:83]
  s_waitcnt lgkmcnt(5)
  v_accvgpr_write_b32 a135, v107
  v_mfma_f32_16x16x32_bf16 v[60:63], v[36:39], v[140:143], v[60:63]
  ds_read_b128 v[28:31], v252 offset:51200
  v_mul_f32 v112, v12, v112
  v_mfma_f32_16x16x32_bf16 v[68:71], v[36:39], v[172:175], v[68:71]
  v_mul_f32 v113, v12, v113
  v_mul_f32 v114, v12, v114
  v_mfma_f32_16x16x32_bf16 v[76:79], v[36:39], v[204:207], v[76:79]
  v_mul_f32 v115, v12, v115
  v_mfma_f32_16x16x32_bf16 v[84:87], v[36:39], v[236:239], v[84:87]
  s_waitcnt lgkmcnt(5)
  v_mul_f32 v116, v12, v116
  v_mfma_f32_16x16x32_bf16 v[56:59], v[40:43], v[144:147], v[56:59]
  ds_read_b128 v[32:35], v253 offset:49152
  v_mul_f32 v117, v12, v117
  v_mfma_f32_16x16x32_bf16 v[64:67], v[40:43], v[176:179], v[64:67]
  v_mul_f32 v118, v12, v118
  v_mul_f32 v119, v12, v119
  v_mfma_f32_16x16x32_bf16 v[72:75], v[40:43], v[208:211], v[72:75]
  v_cvt_pk_bf16_f32 v112, v112, v113
  v_mfma_f32_16x16x32_bf16 v[80:83], v[40:43], v[240:243], v[80:83]
  s_waitcnt lgkmcnt(5)
  v_cvt_pk_bf16_f32 v113, v114, v115
  v_mfma_f32_16x16x32_bf16 v[60:63], v[44:47], v[144:147], v[60:63]
  ds_read_b128 v[36:39], v253 offset:51200
  v_cvt_pk_bf16_f32 v114, v116, v117
  v_mfma_f32_16x16x32_bf16 v[68:71], v[44:47], v[176:179], v[68:71]
  v_cvt_pk_bf16_f32 v115, v118, v119
  v_accvgpr_write_b32 a188, v112
  v_mfma_f32_16x16x32_bf16 v[76:79], v[44:47], v[208:211], v[76:79]
  v_accvgpr_write_b32 a189, v113
  v_mfma_f32_16x16x32_bf16 v[84:87], v[44:47], v[240:243], v[84:87]
  s_waitcnt lgkmcnt(5)
  v_accvgpr_write_b32 a190, v114
  v_mfma_f32_16x16x32_bf16 v[56:59], v[48:51], v[148:151], v[56:59]
  ds_read_b128 v[40:43], v254 offset:49152
  v_accvgpr_write_b32 a191, v115
  v_mfma_f32_16x16x32_bf16 v[64:67], v[48:51], v[180:183], v[64:67]
  v_mfma_f32_16x16x32_bf16 v[72:75], v[48:51], v[212:215], v[72:75]
  v_mfma_f32_16x16x32_bf16 v[80:83], v[48:51], v[244:247], v[80:83]
  s_waitcnt lgkmcnt(5)
  v_mfma_f32_16x16x32_bf16 v[60:63], v[52:55], v[148:151], v[60:63]
  ds_read_b128 v[44:47], v254 offset:51200
  v_mfma_f32_16x16x32_bf16 v[68:71], v[52:55], v[180:183], v[68:71]
  v_mfma_f32_16x16x32_bf16 v[76:79], v[52:55], v[212:215], v[76:79]
  v_mfma_f32_16x16x32_bf16 v[84:87], v[52:55], v[244:247], v[84:87]
  s_waitcnt lgkmcnt(5)
  v_mfma_f32_16x16x32_bf16 v[88:91], v[24:27], v[120:123], 0
  ds_read_b128 v[48:51], v255 offset:49152
  v_mfma_f32_16x16x32_bf16 v[96:99], v[24:27], v[152:155], 0
  v_mfma_f32_16x16x32_bf16 v[104:107], v[24:27], v[184:187], 0
  s_add_u32 m0, s29, 49152
  s_add_u32 s27, s28, 3407872
  buffer_load_dwordx4 v14, s[60:63], s27 offen lds
  v_mfma_f32_16x16x32_bf16 v[112:115], v[24:27], v[216:219], 0
  s_waitcnt lgkmcnt(5)
  v_mul_f32 v56, v12, v56
  v_mfma_f32_16x16x32_bf16 v[92:95], v[28:31], v[120:123], 0
  ds_read_b128 v[52:55], v255 offset:51200
  v_mul_f32 v57, v12, v57
  v_mfma_f32_16x16x32_bf16 v[100:103], v[28:31], v[152:155], 0
  v_mul_f32 v58, v12, v58
  v_mul_f32 v59, v12, v59
  v_mfma_f32_16x16x32_bf16 v[108:111], v[28:31], v[184:187], 0
  v_mul_f32 v60, v12, v60
  v_mfma_f32_16x16x32_bf16 v[116:119], v[28:31], v[216:219], 0
  s_waitcnt lgkmcnt(5)
  v_mul_f32 v61, v12, v61
  v_mfma_f32_16x16x32_bf16 v[88:91], v[32:35], v[124:127], v[88:91]
  ds_read_b128 v[24:27], v252 offset:49408
  v_mul_f32 v62, v12, v62
  v_mfma_f32_16x16x32_bf16 v[96:99], v[32:35], v[156:159], v[96:99]
  v_mul_f32 v63, v12, v63
  v_cvt_pk_bf16_f32 v56, v56, v57
  v_mfma_f32_16x16x32_bf16 v[104:107], v[32:35], v[188:191], v[104:107]
  s_add_u32 m0, s29, 50176
  s_add_u32 s27, s28, 3424256
  buffer_load_dwordx4 v15, s[60:63], s27 offen lds
  v_mfma_f32_16x16x32_bf16 v[112:115], v[32:35], v[220:223], v[112:115]
  s_waitcnt lgkmcnt(5)
  v_cvt_pk_bf16_f32 v57, v58, v59
  v_mfma_f32_16x16x32_bf16 v[92:95], v[36:39], v[124:127], v[92:95]
  ds_read_b128 v[28:31], v252 offset:51456
  v_cvt_pk_bf16_f32 v58, v60, v61
  v_mfma_f32_16x16x32_bf16 v[100:103], v[36:39], v[156:159], v[100:103]
  v_cvt_pk_bf16_f32 v59, v62, v63
  v_accvgpr_write_b32 a24, v56
  v_mfma_f32_16x16x32_bf16 v[108:111], v[36:39], v[188:191], v[108:111]
  v_accvgpr_write_b32 a25, v57
  v_mfma_f32_16x16x32_bf16 v[116:119], v[36:39], v[220:223], v[116:119]
  s_waitcnt lgkmcnt(5)
  v_accvgpr_write_b32 a26, v58
  v_mfma_f32_16x16x32_bf16 v[88:91], v[40:43], v[128:131], v[88:91]
  ds_read_b128 v[32:35], v253 offset:49408
  v_accvgpr_write_b32 a27, v59
  v_mfma_f32_16x16x32_bf16 v[96:99], v[40:43], v[160:163], v[96:99]
  v_mul_f32 v64, v12, v64
  v_mul_f32 v65, v12, v65
  v_mfma_f32_16x16x32_bf16 v[104:107], v[40:43], v[192:195], v[104:107]
  s_add_u32 m0, s29, 51200
  s_add_u32 s27, s28, 3440640
  buffer_load_dwordx4 v14, s[60:63], s27 offen lds
  v_mfma_f32_16x16x32_bf16 v[112:115], v[40:43], v[224:227], v[112:115]
  s_waitcnt lgkmcnt(5)
  v_mul_f32 v66, v12, v66
  v_mfma_f32_16x16x32_bf16 v[92:95], v[44:47], v[128:131], v[92:95]
  ds_read_b128 v[36:39], v253 offset:51456
  v_mul_f32 v67, v12, v67
  v_mfma_f32_16x16x32_bf16 v[100:103], v[44:47], v[160:163], v[100:103]
  v_mul_f32 v68, v12, v68
  v_mul_f32 v69, v12, v69
  v_mfma_f32_16x16x32_bf16 v[108:111], v[44:47], v[192:195], v[108:111]
  v_mul_f32 v70, v12, v70
  v_mfma_f32_16x16x32_bf16 v[116:119], v[44:47], v[224:227], v[116:119]
  s_waitcnt lgkmcnt(5)
  v_mul_f32 v71, v12, v71
  v_mfma_f32_16x16x32_bf16 v[88:91], v[48:51], v[132:135], v[88:91]
  ds_read_b128 v[40:43], v254 offset:49408
  v_cvt_pk_bf16_f32 v64, v64, v65
  v_mfma_f32_16x16x32_bf16 v[96:99], v[48:51], v[164:167], v[96:99]
  v_cvt_pk_bf16_f32 v65, v66, v67
  v_cvt_pk_bf16_f32 v66, v68, v69
  v_mfma_f32_16x16x32_bf16 v[104:107], v[48:51], v[196:199], v[104:107]
  s_add_u32 m0, s29, 52224
  s_add_u32 s27, s28, 3457024
  buffer_load_dwordx4 v15, s[60:63], s27 offen lds
  v_mfma_f32_16x16x32_bf16 v[112:115], v[48:51], v[228:231], v[112:115]
  s_waitcnt lgkmcnt(5)
  v_cvt_pk_bf16_f32 v67, v70, v71
  v_mfma_f32_16x16x32_bf16 v[92:95], v[52:55], v[132:135], v[92:95]
  ds_read_b128 v[44:47], v254 offset:51456
  v_accvgpr_write_b32 a80, v64
  v_mfma_f32_16x16x32_bf16 v[100:103], v[52:55], v[164:167], v[100:103]
  v_accvgpr_write_b32 a81, v65
  v_accvgpr_write_b32 a82, v66
  v_mfma_f32_16x16x32_bf16 v[108:111], v[52:55], v[196:199], v[108:111]
  v_accvgpr_write_b32 a83, v67
  v_mfma_f32_16x16x32_bf16 v[116:119], v[52:55], v[228:231], v[116:119]
  s_waitcnt lgkmcnt(5)
  v_mul_f32 v72, v12, v72
  v_mfma_f32_16x16x32_bf16 v[88:91], v[24:27], v[136:139], v[88:91]
  ds_read_b128 v[48:51], v255 offset:49408
  v_mul_f32 v73, v12, v73
  v_mfma_f32_16x16x32_bf16 v[96:99], v[24:27], v[168:171], v[96:99]
  v_mul_f32 v74, v12, v74
  v_mul_f32 v75, v12, v75
  v_mfma_f32_16x16x32_bf16 v[104:107], v[24:27], v[200:203], v[104:107]
  v_mul_f32 v76, v12, v76
  v_mfma_f32_16x16x32_bf16 v[112:115], v[24:27], v[232:235], v[112:115]
  s_waitcnt lgkmcnt(5)
  v_mul_f32 v77, v12, v77
  v_mfma_f32_16x16x32_bf16 v[92:95], v[28:31], v[136:139], v[92:95]
  ds_read_b128 v[52:55], v255 offset:51456
  v_mul_f32 v78, v12, v78
  v_mfma_f32_16x16x32_bf16 v[100:103], v[28:31], v[168:171], v[100:103]
  v_mul_f32 v79, v12, v79
  v_cvt_pk_bf16_f32 v72, v72, v73
  v_mfma_f32_16x16x32_bf16 v[108:111], v[28:31], v[200:203], v[108:111]
  v_cvt_pk_bf16_f32 v73, v74, v75
  v_mfma_f32_16x16x32_bf16 v[116:119], v[28:31], v[232:235], v[116:119]
  s_waitcnt lgkmcnt(5)
  v_cvt_pk_bf16_f32 v74, v76, v77
  v_mfma_f32_16x16x32_bf16 v[88:91], v[32:35], v[140:143], v[88:91]
  s_waitcnt vmcnt(20)
  s_barrier
  ds_read_b128 v[24:27], v16 offset:0
  v_cvt_pk_bf16_f32 v75, v78, v79
  v_mfma_f32_16x16x32_bf16 v[96:99], v[32:35], v[172:175], v[96:99]
  v_accvgpr_write_b32 a136, v72
  v_accvgpr_write_b32 a137, v73
  v_mfma_f32_16x16x32_bf16 v[104:107], v[32:35], v[204:207], v[104:107]
  v_accvgpr_write_b32 a138, v74
  v_mfma_f32_16x16x32_bf16 v[112:115], v[32:35], v[236:239], v[112:115]
  s_waitcnt lgkmcnt(5)
  v_accvgpr_write_b32 a139, v75
  v_mfma_f32_16x16x32_bf16 v[92:95], v[36:39], v[140:143], v[92:95]
  ds_read_b128 v[28:31], v16 offset:2048
  v_mul_f32 v80, v12, v80
  v_mfma_f32_16x16x32_bf16 v[100:103], v[36:39], v[172:175], v[100:103]
  v_mul_f32 v81, v12, v81
  v_mul_f32 v82, v12, v82
  v_mfma_f32_16x16x32_bf16 v[108:111], v[36:39], v[204:207], v[108:111]
  v_mul_f32 v83, v12, v83
  v_mfma_f32_16x16x32_bf16 v[116:119], v[36:39], v[236:239], v[116:119]
  s_waitcnt lgkmcnt(5)
  v_mul_f32 v84, v12, v84
  v_mfma_f32_16x16x32_bf16 v[88:91], v[40:43], v[144:147], v[88:91]
  ds_read_b128 v[32:35], v17 offset:0
  v_mul_f32 v85, v12, v85
  v_mfma_f32_16x16x32_bf16 v[96:99], v[40:43], v[176:179], v[96:99]
  v_mul_f32 v86, v12, v86
  v_mul_f32 v87, v12, v87
  v_mfma_f32_16x16x32_bf16 v[104:107], v[40:43], v[208:211], v[104:107]
  v_cvt_pk_bf16_f32 v80, v80, v81
  v_mfma_f32_16x16x32_bf16 v[112:115], v[40:43], v[240:243], v[112:115]
  s_waitcnt lgkmcnt(5)
  v_cvt_pk_bf16_f32 v81, v82, v83
  v_mfma_f32_16x16x32_bf16 v[92:95], v[44:47], v[144:147], v[92:95]
  ds_read_b128 v[36:39], v17 offset:2048
  v_cvt_pk_bf16_f32 v82, v84, v85
  v_mfma_f32_16x16x32_bf16 v[100:103], v[44:47], v[176:179], v[100:103]
  v_cvt_pk_bf16_f32 v83, v86, v87
  v_accvgpr_write_b32 a192, v80
  v_mfma_f32_16x16x32_bf16 v[108:111], v[44:47], v[208:211], v[108:111]
  v_accvgpr_write_b32 a193, v81
  v_mfma_f32_16x16x32_bf16 v[116:119], v[44:47], v[240:243], v[116:119]
  s_waitcnt lgkmcnt(5)
  v_accvgpr_write_b32 a194, v82
  v_mfma_f32_16x16x32_bf16 v[88:91], v[48:51], v[148:151], v[88:91]
  ds_read_b128 v[40:43], v18 offset:0
  v_accvgpr_write_b32 a195, v83
  v_mfma_f32_16x16x32_bf16 v[96:99], v[48:51], v[180:183], v[96:99]
  v_mfma_f32_16x16x32_bf16 v[104:107], v[48:51], v[212:215], v[104:107]
  v_mfma_f32_16x16x32_bf16 v[112:115], v[48:51], v[244:247], v[112:115]
  s_waitcnt lgkmcnt(5)
  v_mfma_f32_16x16x32_bf16 v[92:95], v[52:55], v[148:151], v[92:95]
  ds_read_b128 v[44:47], v18 offset:2048
  v_mfma_f32_16x16x32_bf16 v[100:103], v[52:55], v[180:183], v[100:103]
  v_mfma_f32_16x16x32_bf16 v[108:111], v[52:55], v[212:215], v[108:111]
  v_mfma_f32_16x16x32_bf16 v[116:119], v[52:55], v[244:247], v[116:119]
  s_waitcnt lgkmcnt(5)
  v_mfma_f32_16x16x32_bf16 v[56:59], v[24:27], v[120:123], 0
  ds_read_b128 v[48:51], v19 offset:0
  v_mfma_f32_16x16x32_bf16 v[64:67], v[24:27], v[152:155], 0
  v_mfma_f32_16x16x32_bf16 v[72:75], v[24:27], v[184:187], 0
  v_mfma_f32_16x16x32_bf16 v[80:83], v[24:27], v[216:219], 0
  s_waitcnt lgkmcnt(5)
  v_mul_f32 v88, v12, v88
  v_mfma_f32_16x16x32_bf16 v[60:63], v[28:31], v[120:123], 0
  ds_read_b128 v[52:55], v19 offset:2048
  v_mul_f32 v89, v12, v89
  v_mfma_f32_16x16x32_bf16 v[68:71], v[28:31], v[152:155], 0
  v_mul_f32 v90, v12, v90
  v_mul_f32 v91, v12, v91
  v_mfma_f32_16x16x32_bf16 v[76:79], v[28:31], v[184:187], 0
  v_mul_f32 v92, v12, v92
  v_mfma_f32_16x16x32_bf16 v[84:87], v[28:31], v[216:219], 0
  s_waitcnt lgkmcnt(5)
  v_mul_f32 v93, v12, v93
  v_mfma_f32_16x16x32_bf16 v[56:59], v[32:35], v[124:127], v[56:59]
  ds_read_b128 v[24:27], v16 offset:256
  v_mul_f32 v94, v12, v94
  v_mfma_f32_16x16x32_bf16 v[64:67], v[32:35], v[156:159], v[64:67]
  v_mul_f32 v95, v12, v95
  v_cvt_pk_bf16_f32 v88, v88, v89
  v_mfma_f32_16x16x32_bf16 v[72:75], v[32:35], v[188:191], v[72:75]
  v_cvt_pk_bf16_f32 v89, v90, v91
  v_mfma_f32_16x16x32_bf16 v[80:83], v[32:35], v[220:223], v[80:83]
  s_waitcnt lgkmcnt(5)
  v_cvt_pk_bf16_f32 v90, v92, v93
  v_mfma_f32_16x16x32_bf16 v[60:63], v[36:39], v[124:127], v[60:63]
  ds_read_b128 v[28:31], v16 offset:2304
  v_cvt_pk_bf16_f32 v91, v94, v95
  v_mfma_f32_16x16x32_bf16 v[68:71], v[36:39], v[156:159], v[68:71]
  v_accvgpr_write_b32 a28, v88
  v_accvgpr_write_b32 a29, v89
  v_mfma_f32_16x16x32_bf16 v[76:79], v[36:39], v[188:191], v[76:79]
  v_accvgpr_write_b32 a30, v90
  v_mfma_f32_16x16x32_bf16 v[84:87], v[36:39], v[220:223], v[84:87]
  s_waitcnt lgkmcnt(5)
  v_accvgpr_write_b32 a31, v91
  v_mfma_f32_16x16x32_bf16 v[56:59], v[40:43], v[128:131], v[56:59]
  ds_read_b128 v[32:35], v17 offset:256
  v_mul_f32 v96, v12, v96
  v_mfma_f32_16x16x32_bf16 v[64:67], v[40:43], v[160:163], v[64:67]
  v_mul_f32 v97, v12, v97
  v_mul_f32 v98, v12, v98
  v_mfma_f32_16x16x32_bf16 v[72:75], v[40:43], v[192:195], v[72:75]
  v_mul_f32 v99, v12, v99
  v_mfma_f32_16x16x32_bf16 v[80:83], v[40:43], v[224:227], v[80:83]
  s_waitcnt lgkmcnt(5)
  v_mul_f32 v100, v12, v100
  v_mfma_f32_16x16x32_bf16 v[60:63], v[44:47], v[128:131], v[60:63]
  ds_read_b128 v[36:39], v17 offset:2304
  v_mul_f32 v101, v12, v101
  v_mfma_f32_16x16x32_bf16 v[68:71], v[44:47], v[160:163], v[68:71]
  v_mul_f32 v102, v12, v102
  v_mul_f32 v103, v12, v103
  v_mfma_f32_16x16x32_bf16 v[76:79], v[44:47], v[192:195], v[76:79]
  v_cvt_pk_bf16_f32 v96, v96, v97
  v_mfma_f32_16x16x32_bf16 v[84:87], v[44:47], v[224:227], v[84:87]
  s_waitcnt lgkmcnt(5)
  v_cvt_pk_bf16_f32 v97, v98, v99
  v_mfma_f32_16x16x32_bf16 v[56:59], v[48:51], v[132:135], v[56:59]
  ds_read_b128 v[40:43], v18 offset:256
  v_cvt_pk_bf16_f32 v98, v100, v101
  v_mfma_f32_16x16x32_bf16 v[64:67], v[48:51], v[164:167], v[64:67]
  v_cvt_pk_bf16_f32 v99, v102, v103
  v_accvgpr_write_b32 a84, v96
  v_mfma_f32_16x16x32_bf16 v[72:75], v[48:51], v[196:199], v[72:75]
  v_accvgpr_write_b32 a85, v97
  v_mfma_f32_16x16x32_bf16 v[80:83], v[48:51], v[228:231], v[80:83]
  s_waitcnt lgkmcnt(5)
  v_accvgpr_write_b32 a86, v98
  v_mfma_f32_16x16x32_bf16 v[60:63], v[52:55], v[132:135], v[60:63]
  ds_read_b128 v[44:47], v18 offset:2304
  v_accvgpr_write_b32 a87, v99
  v_mfma_f32_16x16x32_bf16 v[68:71], v[52:55], v[164:167], v[68:71]
  v_mul_f32 v104, v12, v104
  v_mul_f32 v105, v12, v105
  v_mfma_f32_16x16x32_bf16 v[76:79], v[52:55], v[196:199], v[76:79]
  v_mul_f32 v106, v12, v106
  v_mfma_f32_16x16x32_bf16 v[84:87], v[52:55], v[228:231], v[84:87]
  s_waitcnt lgkmcnt(5)
  v_mul_f32 v107, v12, v107
  v_mfma_f32_16x16x32_bf16 v[56:59], v[24:27], v[136:139], v[56:59]
  ds_read_b128 v[48:51], v19 offset:256
  v_mul_f32 v108, v12, v108
  v_mfma_f32_16x16x32_bf16 v[64:67], v[24:27], v[168:171], v[64:67]
  v_mul_f32 v109, v12, v109
  v_mul_f32 v110, v12, v110
  v_mfma_f32_16x16x32_bf16 v[72:75], v[24:27], v[200:203], v[72:75]
  v_mul_f32 v111, v12, v111
  v_mfma_f32_16x16x32_bf16 v[80:83], v[24:27], v[232:235], v[80:83]
  s_waitcnt lgkmcnt(5)
  v_cvt_pk_bf16_f32 v104, v104, v105
  v_mfma_f32_16x16x32_bf16 v[60:63], v[28:31], v[136:139], v[60:63]
  ds_read_b128 v[52:55], v19 offset:2304
  v_cvt_pk_bf16_f32 v105, v106, v107
  v_mfma_f32_16x16x32_bf16 v[68:71], v[28:31], v[168:171], v[68:71]
  v_cvt_pk_bf16_f32 v106, v108, v109
  v_cvt_pk_bf16_f32 v107, v110, v111
  v_mfma_f32_16x16x32_bf16 v[76:79], v[28:31], v[200:203], v[76:79]
  v_accvgpr_write_b32 a140, v104
  v_mfma_f32_16x16x32_bf16 v[84:87], v[28:31], v[232:235], v[84:87]
  s_waitcnt lgkmcnt(5)
  v_accvgpr_write_b32 a141, v105
  v_mfma_f32_16x16x32_bf16 v[56:59], v[32:35], v[140:143], v[56:59]
  s_waitcnt vmcnt(16)
  s_barrier
  ds_read_b128 v[24:27], v16 offset:16384
  v_accvgpr_write_b32 a142, v106
  v_mfma_f32_16x16x32_bf16 v[64:67], v[32:35], v[172:175], v[64:67]
  v_accvgpr_write_b32 a143, v107
  v_mul_f32 v112, v12, v112
  v_mfma_f32_16x16x32_bf16 v[72:75], v[32:35], v[204:207], v[72:75]
  v_mul_f32 v113, v12, v113
  v_mfma_f32_16x16x32_bf16 v[80:83], v[32:35], v[236:239], v[80:83]
  s_waitcnt lgkmcnt(5)
  v_mul_f32 v114, v12, v114
  v_mfma_f32_16x16x32_bf16 v[60:63], v[36:39], v[140:143], v[60:63]
  ds_read_b128 v[28:31], v16 offset:18432
  v_mul_f32 v115, v12, v115
  v_mfma_f32_16x16x32_bf16 v[68:71], v[36:39], v[172:175], v[68:71]
  v_mul_f32 v116, v12, v116
  v_mul_f32 v117, v12, v117
  v_mfma_f32_16x16x32_bf16 v[76:79], v[36:39], v[204:207], v[76:79]
  v_mul_f32 v118, v12, v118
  v_mfma_f32_16x16x32_bf16 v[84:87], v[36:39], v[236:239], v[84:87]
  s_waitcnt lgkmcnt(5)
  v_mul_f32 v119, v12, v119
  v_mfma_f32_16x16x32_bf16 v[56:59], v[40:43], v[144:147], v[56:59]
  ds_read_b128 v[32:35], v17 offset:16384
  v_cvt_pk_bf16_f32 v112, v112, v113
  v_mfma_f32_16x16x32_bf16 v[64:67], v[40:43], v[176:179], v[64:67]
  v_cvt_pk_bf16_f32 v113, v114, v115
  v_cvt_pk_bf16_f32 v114, v116, v117
  v_mfma_f32_16x16x32_bf16 v[72:75], v[40:43], v[208:211], v[72:75]
  v_cvt_pk_bf16_f32 v115, v118, v119
  v_mfma_f32_16x16x32_bf16 v[80:83], v[40:43], v[240:243], v[80:83]
  s_waitcnt lgkmcnt(5)
  v_accvgpr_write_b32 a196, v112
  v_mfma_f32_16x16x32_bf16 v[60:63], v[44:47], v[144:147], v[60:63]
  ds_read_b128 v[36:39], v17 offset:18432
  v_accvgpr_write_b32 a197, v113
  v_mfma_f32_16x16x32_bf16 v[68:71], v[44:47], v[176:179], v[68:71]
  v_accvgpr_write_b32 a198, v114
  v_accvgpr_write_b32 a199, v115
  v_mfma_f32_16x16x32_bf16 v[76:79], v[44:47], v[208:211], v[76:79]
  v_mfma_f32_16x16x32_bf16 v[84:87], v[44:47], v[240:243], v[84:87]
  s_waitcnt lgkmcnt(5)
  v_mfma_f32_16x16x32_bf16 v[56:59], v[48:51], v[148:151], v[56:59]
  ds_read_b128 v[40:43], v18 offset:16384
  v_mfma_f32_16x16x32_bf16 v[64:67], v[48:51], v[180:183], v[64:67]
  v_mfma_f32_16x16x32_bf16 v[72:75], v[48:51], v[212:215], v[72:75]
  v_mfma_f32_16x16x32_bf16 v[80:83], v[48:51], v[244:247], v[80:83]
  s_waitcnt lgkmcnt(5)
  v_mfma_f32_16x16x32_bf16 v[60:63], v[52:55], v[148:151], v[60:63]
  ds_read_b128 v[44:47], v18 offset:18432
  v_mfma_f32_16x16x32_bf16 v[68:71], v[52:55], v[180:183], v[68:71]
  v_mfma_f32_16x16x32_bf16 v[76:79], v[52:55], v[212:215], v[76:79]
  v_mfma_f32_16x16x32_bf16 v[84:87], v[52:55], v[244:247], v[84:87]
  s_waitcnt lgkmcnt(5)
  s_getpc_b64 s[98:99]
  s_add_u32 s98, s98, 4096
  s_addc_u32 s99, s99, 0
  global_load_dword v7, v6, s[98:99]
  v_mfma_f32_16x16x32_bf16 v[88:91], v[24:27], v[120:123], 0
  ds_read_b128 v[48:51], v19 offset:16384
  v_mfma_f32_16x16x32_bf16 v[96:99], v[24:27], v[152:155], 0
  v_mfma_f32_16x16x32_bf16 v[104:107], v[24:27], v[184:187], 0
  v_mfma_f32_16x16x32_bf16 v[112:115], v[24:27], v[216:219], 0
  s_waitcnt lgkmcnt(5)
  v_mul_f32 v56, v12, v56
  v_mfma_f32_16x16x32_bf16 v[92:95], v[28:31], v[120:123], 0
  ds_read_b128 v[52:55], v19 offset:18432
  v_mul_f32 v57, v12, v57
  v_mfma_f32_16x16x32_bf16 v[100:103], v[28:31], v[152:155], 0
  v_mul_f32 v58, v12, v58
  v_mul_f32 v59, v12, v59
  v_mfma_f32_16x16x32_bf16 v[108:111], v[28:31], v[184:187], 0
  v_mul_f32 v60, v12, v60
  v_mfma_f32_16x16x32_bf16 v[116:119], v[28:31], v[216:219], 0
  s_waitcnt lgkmcnt(5)
  v_mul_f32 v61, v12, v61
  v_mfma_f32_16x16x32_bf16 v[88:91], v[32:35], v[124:127], v[88:91]
  ds_read_b128 v[24:27], v16 offset:16640
  v_mul_f32 v62, v12, v62
  v_mfma_f32_16x16x32_bf16 v[96:99], v[32:35], v[156:159], v[96:99]
  v_mul_f32 v63, v12, v63
  v_cvt_pk_bf16_f32 v56, v56, v57
  v_mfma_f32_16x16x32_bf16 v[104:107], v[32:35], v[188:191], v[104:107]
  v_cvt_pk_bf16_f32 v57, v58, v59
  v_mfma_f32_16x16x32_bf16 v[112:115], v[32:35], v[220:223], v[112:115]
  s_waitcnt lgkmcnt(5)
  v_cvt_pk_bf16_f32 v58, v60, v61
  v_mfma_f32_16x16x32_bf16 v[92:95], v[36:39], v[124:127], v[92:95]
  ds_read_b128 v[28:31], v16 offset:18688
  v_cvt_pk_bf16_f32 v59, v62, v63
  v_mfma_f32_16x16x32_bf16 v[100:103], v[36:39], v[156:159], v[100:103]
  v_accvgpr_write_b32 a32, v56
  v_accvgpr_write_b32 a33, v57
  v_mfma_f32_16x16x32_bf16 v[108:111], v[36:39], v[188:191], v[108:111]
  v_accvgpr_write_b32 a34, v58
  v_mfma_f32_16x16x32_bf16 v[116:119], v[36:39], v[220:223], v[116:119]
  s_waitcnt lgkmcnt(5)
  v_accvgpr_write_b32 a35, v59
  v_mfma_f32_16x16x32_bf16 v[88:91], v[40:43], v[128:131], v[88:91]
  ds_read_b128 v[32:35], v17 offset:16640
  v_mul_f32 v64, v12, v64
  v_mfma_f32_16x16x32_bf16 v[96:99], v[40:43], v[160:163], v[96:99]
  v_mul_f32 v65, v12, v65
  v_mul_f32 v66, v12, v66
  v_mfma_f32_16x16x32_bf16 v[104:107], v[40:43], v[192:195], v[104:107]
  v_mul_f32 v67, v12, v67
  v_mfma_f32_16x16x32_bf16 v[112:115], v[40:43], v[224:227], v[112:115]
  s_waitcnt lgkmcnt(5)
  v_mul_f32 v68, v12, v68
  v_mfma_f32_16x16x32_bf16 v[92:95], v[44:47], v[128:131], v[92:95]
  ds_read_b128 v[36:39], v17 offset:18688
  v_mul_f32 v69, v12, v69
  v_mfma_f32_16x16x32_bf16 v[100:103], v[44:47], v[160:163], v[100:103]
  v_mul_f32 v70, v12, v70
  v_mul_f32 v71, v12, v71
  v_mfma_f32_16x16x32_bf16 v[108:111], v[44:47], v[192:195], v[108:111]
  v_cvt_pk_bf16_f32 v64, v64, v65
  v_mfma_f32_16x16x32_bf16 v[116:119], v[44:47], v[224:227], v[116:119]
  s_waitcnt lgkmcnt(5)
  v_cvt_pk_bf16_f32 v65, v66, v67
  v_mfma_f32_16x16x32_bf16 v[88:91], v[48:51], v[132:135], v[88:91]
  ds_read_b128 v[40:43], v18 offset:16640
  v_cvt_pk_bf16_f32 v66, v68, v69
  v_mfma_f32_16x16x32_bf16 v[96:99], v[48:51], v[164:167], v[96:99]
  v_cvt_pk_bf16_f32 v67, v70, v71
  v_accvgpr_write_b32 a88, v64
  v_mfma_f32_16x16x32_bf16 v[104:107], v[48:51], v[196:199], v[104:107]
  v_accvgpr_write_b32 a89, v65
  v_mfma_f32_16x16x32_bf16 v[112:115], v[48:51], v[228:231], v[112:115]
  s_waitcnt lgkmcnt(5)
  v_accvgpr_write_b32 a90, v66
  v_mfma_f32_16x16x32_bf16 v[92:95], v[52:55], v[132:135], v[92:95]
  ds_read_b128 v[44:47], v18 offset:18688
  v_accvgpr_write_b32 a91, v67
  v_mfma_f32_16x16x32_bf16 v[100:103], v[52:55], v[164:167], v[100:103]
  v_mul_f32 v72, v12, v72
  v_mul_f32 v73, v12, v73
  v_mfma_f32_16x16x32_bf16 v[108:111], v[52:55], v[196:199], v[108:111]
  v_mul_f32 v74, v12, v74
  v_mfma_f32_16x16x32_bf16 v[116:119], v[52:55], v[228:231], v[116:119]
  s_waitcnt lgkmcnt(5)
  v_mul_f32 v75, v12, v75
  v_mfma_f32_16x16x32_bf16 v[88:91], v[24:27], v[136:139], v[88:91]
  ds_read_b128 v[48:51], v19 offset:16640
  v_mul_f32 v76, v12, v76
  v_mfma_f32_16x16x32_bf16 v[96:99], v[24:27], v[168:171], v[96:99]
  v_mul_f32 v77, v12, v77
  v_mul_f32 v78, v12, v78
  v_mfma_f32_16x16x32_bf16 v[104:107], v[24:27], v[200:203], v[104:107]
  v_mul_f32 v79, v12, v79
  v_mfma_f32_16x16x32_bf16 v[112:115], v[24:27], v[232:235], v[112:115]
  s_waitcnt lgkmcnt(5)
  v_cvt_pk_bf16_f32 v72, v72, v73
  v_mfma_f32_16x16x32_bf16 v[92:95], v[28:31], v[136:139], v[92:95]
  ds_read_b128 v[52:55], v19 offset:18688
  v_cvt_pk_bf16_f32 v73, v74, v75
  v_mfma_f32_16x16x32_bf16 v[100:103], v[28:31], v[168:171], v[100:103]
  v_cvt_pk_bf16_f32 v74, v76, v77
  v_cvt_pk_bf16_f32 v75, v78, v79
  v_mfma_f32_16x16x32_bf16 v[108:111], v[28:31], v[200:203], v[108:111]
  v_accvgpr_write_b32 a144, v72
  v_mfma_f32_16x16x32_bf16 v[116:119], v[28:31], v[232:235], v[116:119]
  s_waitcnt lgkmcnt(5)
  v_accvgpr_write_b32 a145, v73
  v_mfma_f32_16x16x32_bf16 v[88:91], v[32:35], v[140:143], v[88:91]
  s_waitcnt vmcnt(12)
  s_barrier
  ds_read_b128 v[24:27], v248 offset:0
  v_accvgpr_write_b32 a146, v74
  v_mfma_f32_16x16x32_bf16 v[96:99], v[32:35], v[172:175], v[96:99]
  v_accvgpr_write_b32 a147, v75
  v_mul_f32 v80, v12, v80
  v_mfma_f32_16x16x32_bf16 v[104:107], v[32:35], v[204:207], v[104:107]
  v_mul_f32 v81, v12, v81
  v_mfma_f32_16x16x32_bf16 v[112:115], v[32:35], v[236:239], v[112:115]
  s_waitcnt lgkmcnt(5)
  v_mul_f32 v82, v12, v82
  v_mfma_f32_16x16x32_bf16 v[92:95], v[36:39], v[140:143], v[92:95]
  ds_read_b128 v[28:31], v248 offset:2048
  v_mul_f32 v83, v12, v83
  v_mfma_f32_16x16x32_bf16 v[100:103], v[36:39], v[172:175], v[100:103]
  v_mul_f32 v84, v12, v84
  v_mul_f32 v85, v12, v85
  v_mfma_f32_16x16x32_bf16 v[108:111], v[36:39], v[204:207], v[108:111]
  v_mul_f32 v86, v12, v86
  v_mfma_f32_16x16x32_bf16 v[116:119], v[36:39], v[236:239], v[116:119]
  s_waitcnt lgkmcnt(5)
  v_mul_f32 v87, v12, v87
  v_mfma_f32_16x16x32_bf16 v[88:91], v[40:43], v[144:147], v[88:91]
  ds_read_b128 v[32:35], v249 offset:0
  v_cvt_pk_bf16_f32 v80, v80, v81
  v_mfma_f32_16x16x32_bf16 v[96:99], v[40:43], v[176:179], v[96:99]
  v_cvt_pk_bf16_f32 v81, v82, v83
  v_cvt_pk_bf16_f32 v82, v84, v85
  v_mfma_f32_16x16x32_bf16 v[104:107], v[40:43], v[208:211], v[104:107]
  v_cvt_pk_bf16_f32 v83, v86, v87
  v_mfma_f32_16x16x32_bf16 v[112:115], v[40:43], v[240:243], v[112:115]
  s_waitcnt lgkmcnt(5)
  v_accvgpr_write_b32 a200, v80
  v_mfma_f32_16x16x32_bf16 v[92:95], v[44:47], v[144:147], v[92:95]
  ds_read_b128 v[36:39], v249 offset:2048
  v_accvgpr_write_b32 a201, v81
  v_mfma_f32_16x16x32_bf16 v[100:103], v[44:47], v[176:179], v[100:103]
  v_accvgpr_write_b32 a202, v82
  v_accvgpr_write_b32 a203, v83
  v_mfma_f32_16x16x32_bf16 v[108:111], v[44:47], v[208:211], v[108:111]
  v_mfma_f32_16x16x32_bf16 v[116:119], v[44:47], v[240:243], v[116:119]
  s_waitcnt lgkmcnt(5)
  v_mfma_f32_16x16x32_bf16 v[88:91], v[48:51], v[148:151], v[88:91]
  ds_read_b128 v[40:43], v250 offset:0
  v_mfma_f32_16x16x32_bf16 v[96:99], v[48:51], v[180:183], v[96:99]
  v_mfma_f32_16x16x32_bf16 v[104:107], v[48:51], v[212:215], v[104:107]
  v_mfma_f32_16x16x32_bf16 v[112:115], v[48:51], v[244:247], v[112:115]
  s_waitcnt lgkmcnt(5)
  v_mfma_f32_16x16x32_bf16 v[92:95], v[52:55], v[148:151], v[92:95]
  ds_read_b128 v[44:47], v250 offset:2048
  v_mfma_f32_16x16x32_bf16 v[100:103], v[52:55], v[180:183], v[100:103]
  v_mfma_f32_16x16x32_bf16 v[108:111], v[52:55], v[212:215], v[108:111]
  v_mfma_f32_16x16x32_bf16 v[116:119], v[52:55], v[244:247], v[116:119]
  s_waitcnt lgkmcnt(5)
  v_mfma_f32_16x16x32_bf16 v[56:59], v[24:27], v[120:123], 0
  ds_read_b128 v[48:51], v251 offset:0
  v_mfma_f32_16x16x32_bf16 v[64:67], v[24:27], v[152:155], 0
  v_mfma_f32_16x16x32_bf16 v[72:75], v[24:27], v[184:187], 0
  v_mfma_f32_16x16x32_bf16 v[80:83], v[24:27], v[216:219], 0
  s_waitcnt lgkmcnt(5)
  v_mul_f32 v88, v12, v88
  v_mfma_f32_16x16x32_bf16 v[60:63], v[28:31], v[120:123], 0
  ds_read_b128 v[52:55], v251 offset:2048
  v_mul_f32 v89, v12, v89
  v_mfma_f32_16x16x32_bf16 v[68:71], v[28:31], v[152:155], 0
  v_mul_f32 v90, v12, v90
  v_mul_f32 v91, v12, v91
  v_mfma_f32_16x16x32_bf16 v[76:79], v[28:31], v[184:187], 0
  v_mul_f32 v92, v12, v92
  v_mfma_f32_16x16x32_bf16 v[84:87], v[28:31], v[216:219], 0
  s_waitcnt lgkmcnt(5)
  v_mul_f32 v93, v12, v93
  v_mfma_f32_16x16x32_bf16 v[56:59], v[32:35], v[124:127], v[56:59]
  ds_read_b128 v[24:27], v248 offset:256
  v_mul_f32 v94, v12, v94
  v_mfma_f32_16x16x32_bf16 v[64:67], v[32:35], v[156:159], v[64:67]
  v_mul_f32 v95, v12, v95
  v_cvt_pk_bf16_f32 v88, v88, v89
  v_mfma_f32_16x16x32_bf16 v[72:75], v[32:35], v[188:191], v[72:75]
  v_cvt_pk_bf16_f32 v89, v90, v91
  v_mfma_f32_16x16x32_bf16 v[80:83], v[32:35], v[220:223], v[80:83]
  s_waitcnt lgkmcnt(5)
  v_cvt_pk_bf16_f32 v90, v92, v93
  v_mfma_f32_16x16x32_bf16 v[60:63], v[36:39], v[124:127], v[60:63]
  ds_read_b128 v[28:31], v248 offset:2304
  v_cvt_pk_bf16_f32 v91, v94, v95
  v_mfma_f32_16x16x32_bf16 v[68:71], v[36:39], v[156:159], v[68:71]
  v_accvgpr_write_b32 a36, v88
  v_accvgpr_write_b32 a37, v89
  v_mfma_f32_16x16x32_bf16 v[76:79], v[36:39], v[188:191], v[76:79]
  v_accvgpr_write_b32 a38, v90
  v_mfma_f32_16x16x32_bf16 v[84:87], v[36:39], v[220:223], v[84:87]
  s_waitcnt lgkmcnt(5)
  v_accvgpr_write_b32 a39, v91
  v_mfma_f32_16x16x32_bf16 v[56:59], v[40:43], v[128:131], v[56:59]
  ds_read_b128 v[32:35], v249 offset:256
  v_mul_f32 v96, v12, v96
  v_mfma_f32_16x16x32_bf16 v[64:67], v[40:43], v[160:163], v[64:67]
  v_mul_f32 v97, v12, v97
  v_mul_f32 v98, v12, v98
  v_mfma_f32_16x16x32_bf16 v[72:75], v[40:43], v[192:195], v[72:75]
  v_mul_f32 v99, v12, v99
  v_mfma_f32_16x16x32_bf16 v[80:83], v[40:43], v[224:227], v[80:83]
  s_waitcnt lgkmcnt(5)
  v_mul_f32 v100, v12, v100
  v_mfma_f32_16x16x32_bf16 v[60:63], v[44:47], v[128:131], v[60:63]
  ds_read_b128 v[36:39], v249 offset:2304
  v_mul_f32 v101, v12, v101
  v_mfma_f32_16x16x32_bf16 v[68:71], v[44:47], v[160:163], v[68:71]
  v_mul_f32 v102, v12, v102
  v_mul_f32 v103, v12, v103
  v_mfma_f32_16x16x32_bf16 v[76:79], v[44:47], v[192:195], v[76:79]
  v_cvt_pk_bf16_f32 v96, v96, v97
  v_mfma_f32_16x16x32_bf16 v[84:87], v[44:47], v[224:227], v[84:87]
  s_waitcnt lgkmcnt(5)
  v_cvt_pk_bf16_f32 v97, v98, v99
  v_mfma_f32_16x16x32_bf16 v[56:59], v[48:51], v[132:135], v[56:59]
  ds_read_b128 v[40:43], v250 offset:256
  v_cvt_pk_bf16_f32 v98, v100, v101
  v_mfma_f32_16x16x32_bf16 v[64:67], v[48:51], v[164:167], v[64:67]
  v_cvt_pk_bf16_f32 v99, v102, v103
  v_accvgpr_write_b32 a92, v96
  v_mfma_f32_16x16x32_bf16 v[72:75], v[48:51], v[196:199], v[72:75]
  v_accvgpr_write_b32 a93, v97
  v_mfma_f32_16x16x32_bf16 v[80:83], v[48:51], v[228:231], v[80:83]
  s_waitcnt lgkmcnt(5)
  v_accvgpr_write_b32 a94, v98
  v_mfma_f32_16x16x32_bf16 v[60:63], v[52:55], v[132:135], v[60:63]
  ds_read_b128 v[44:47], v250 offset:2304
  v_accvgpr_write_b32 a95, v99
  v_mfma_f32_16x16x32_bf16 v[68:71], v[52:55], v[164:167], v[68:71]
  v_mul_f32 v104, v12, v104
  v_mul_f32 v105, v12, v105
  v_mfma_f32_16x16x32_bf16 v[76:79], v[52:55], v[196:199], v[76:79]
  v_mul_f32 v106, v12, v106
  v_mfma_f32_16x16x32_bf16 v[84:87], v[52:55], v[228:231], v[84:87]
  s_waitcnt lgkmcnt(5)
  v_mul_f32 v107, v12, v107
  v_mfma_f32_16x16x32_bf16 v[56:59], v[24:27], v[136:139], v[56:59]
  ds_read_b128 v[48:51], v251 offset:256
  v_mul_f32 v108, v12, v108
  v_mfma_f32_16x16x32_bf16 v[64:67], v[24:27], v[168:171], v[64:67]
  v_mul_f32 v109, v12, v109
  v_mul_f32 v110, v12, v110
  v_mfma_f32_16x16x32_bf16 v[72:75], v[24:27], v[200:203], v[72:75]
  v_mul_f32 v111, v12, v111
  v_mfma_f32_16x16x32_bf16 v[80:83], v[24:27], v[232:235], v[80:83]
  s_waitcnt lgkmcnt(5)
  v_cvt_pk_bf16_f32 v104, v104, v105
  v_mfma_f32_16x16x32_bf16 v[60:63], v[28:31], v[136:139], v[60:63]
  ds_read_b128 v[52:55], v251 offset:2304
  v_cvt_pk_bf16_f32 v105, v106, v107
  v_mfma_f32_16x16x32_bf16 v[68:71], v[28:31], v[168:171], v[68:71]
  v_cvt_pk_bf16_f32 v106, v108, v109
  v_cvt_pk_bf16_f32 v107, v110, v111
  v_mfma_f32_16x16x32_bf16 v[76:79], v[28:31], v[200:203], v[76:79]
  v_accvgpr_write_b32 a148, v104
  v_mfma_f32_16x16x32_bf16 v[84:87], v[28:31], v[232:235], v[84:87]
  s_waitcnt lgkmcnt(5)
  v_accvgpr_write_b32 a149, v105
  v_mfma_f32_16x16x32_bf16 v[56:59], v[32:35], v[140:143], v[56:59]
  s_waitcnt vmcnt(8)
  s_barrier
  ds_read_b128 v[24:27], v248 offset:16384
  v_accvgpr_write_b32 a150, v106
  v_mfma_f32_16x16x32_bf16 v[64:67], v[32:35], v[172:175], v[64:67]
  v_accvgpr_write_b32 a151, v107
  v_mul_f32 v112, v12, v112
  v_mfma_f32_16x16x32_bf16 v[72:75], v[32:35], v[204:207], v[72:75]
  v_mul_f32 v113, v12, v113
  v_mfma_f32_16x16x32_bf16 v[80:83], v[32:35], v[236:239], v[80:83]
  s_waitcnt lgkmcnt(5)
  v_mul_f32 v114, v12, v114
  v_mfma_f32_16x16x32_bf16 v[60:63], v[36:39], v[140:143], v[60:63]
  ds_read_b128 v[28:31], v248 offset:18432
  v_mul_f32 v115, v12, v115
  v_mfma_f32_16x16x32_bf16 v[68:71], v[36:39], v[172:175], v[68:71]
  v_mul_f32 v116, v12, v116
  v_mul_f32 v117, v12, v117
  v_mfma_f32_16x16x32_bf16 v[76:79], v[36:39], v[204:207], v[76:79]
  v_mul_f32 v118, v12, v118
  v_mfma_f32_16x16x32_bf16 v[84:87], v[36:39], v[236:239], v[84:87]
  s_waitcnt lgkmcnt(5)
  v_mul_f32 v119, v12, v119
  v_mfma_f32_16x16x32_bf16 v[56:59], v[40:43], v[144:147], v[56:59]
  ds_read_b128 v[32:35], v249 offset:16384
  v_cvt_pk_bf16_f32 v112, v112, v113
  v_mfma_f32_16x16x32_bf16 v[64:67], v[40:43], v[176:179], v[64:67]
  v_cvt_pk_bf16_f32 v113, v114, v115
  v_cvt_pk_bf16_f32 v114, v116, v117
  v_mfma_f32_16x16x32_bf16 v[72:75], v[40:43], v[208:211], v[72:75]
  v_cvt_pk_bf16_f32 v115, v118, v119
  v_mfma_f32_16x16x32_bf16 v[80:83], v[40:43], v[240:243], v[80:83]
  s_waitcnt lgkmcnt(5)
  v_accvgpr_write_b32 a204, v112
  v_mfma_f32_16x16x32_bf16 v[60:63], v[44:47], v[144:147], v[60:63]
  ds_read_b128 v[36:39], v249 offset:18432
  v_accvgpr_write_b32 a205, v113
  v_mfma_f32_16x16x32_bf16 v[68:71], v[44:47], v[176:179], v[68:71]
  v_accvgpr_write_b32 a206, v114
  v_accvgpr_write_b32 a207, v115
  v_mfma_f32_16x16x32_bf16 v[76:79], v[44:47], v[208:211], v[76:79]
  v_mfma_f32_16x16x32_bf16 v[84:87], v[44:47], v[240:243], v[84:87]
  s_waitcnt lgkmcnt(5)
  v_mfma_f32_16x16x32_bf16 v[56:59], v[48:51], v[148:151], v[56:59]
  ds_read_b128 v[40:43], v250 offset:16384
  v_mfma_f32_16x16x32_bf16 v[64:67], v[48:51], v[180:183], v[64:67]
  v_mfma_f32_16x16x32_bf16 v[72:75], v[48:51], v[212:215], v[72:75]
  v_mfma_f32_16x16x32_bf16 v[80:83], v[48:51], v[244:247], v[80:83]
  s_waitcnt lgkmcnt(5)
  v_mfma_f32_16x16x32_bf16 v[60:63], v[52:55], v[148:151], v[60:63]
  ds_read_b128 v[44:47], v250 offset:18432
  v_mfma_f32_16x16x32_bf16 v[68:71], v[52:55], v[180:183], v[68:71]
  v_mfma_f32_16x16x32_bf16 v[76:79], v[52:55], v[212:215], v[76:79]
  v_mfma_f32_16x16x32_bf16 v[84:87], v[52:55], v[244:247], v[84:87]
  s_waitcnt lgkmcnt(5)
  v_mfma_f32_16x16x32_bf16 v[88:91], v[24:27], v[120:123], 0
  ds_read_b128 v[48:51], v251 offset:16384
  v_mfma_f32_16x16x32_bf16 v[96:99], v[24:27], v[152:155], 0
  v_mfma_f32_16x16x32_bf16 v[104:107], v[24:27], v[184:187], 0
  v_mfma_f32_16x16x32_bf16 v[112:115], v[24:27], v[216:219], 0
  s_waitcnt lgkmcnt(5)
  v_mul_f32 v56, v12, v56
  v_mfma_f32_16x16x32_bf16 v[92:95], v[28:31], v[120:123], 0
  ds_read_b128 v[52:55], v251 offset:18432
  v_mul_f32 v57, v12, v57
  v_mfma_f32_16x16x32_bf16 v[100:103], v[28:31], v[152:155], 0
  v_mul_f32 v58, v12, v58
  v_mul_f32 v59, v12, v59
  v_mfma_f32_16x16x32_bf16 v[108:111], v[28:31], v[184:187], 0
  v_mul_f32 v60, v12, v60
  v_mfma_f32_16x16x32_bf16 v[116:119], v[28:31], v[216:219], 0
  s_waitcnt lgkmcnt(5)
  v_mul_f32 v61, v12, v61
  v_mfma_f32_16x16x32_bf16 v[88:91], v[32:35], v[124:127], v[88:91]
  ds_read_b128 v[24:27], v248 offset:16640
  v_mul_f32 v62, v12, v62
  v_mfma_f32_16x16x32_bf16 v[96:99], v[32:35], v[156:159], v[96:99]
  v_mul_f32 v63, v12, v63
  v_cvt_pk_bf16_f32 v56, v56, v57
  v_mfma_f32_16x16x32_bf16 v[104:107], v[32:35], v[188:191], v[104:107]
  v_cvt_pk_bf16_f32 v57, v58, v59
  v_mfma_f32_16x16x32_bf16 v[112:115], v[32:35], v[220:223], v[112:115]
  s_waitcnt lgkmcnt(5)
  v_cvt_pk_bf16_f32 v58, v60, v61
  v_mfma_f32_16x16x32_bf16 v[92:95], v[36:39], v[124:127], v[92:95]
  ds_read_b128 v[28:31], v248 offset:18688
  v_cvt_pk_bf16_f32 v59, v62, v63
  v_mfma_f32_16x16x32_bf16 v[100:103], v[36:39], v[156:159], v[100:103]
  v_accvgpr_write_b32 a40, v56
  v_accvgpr_write_b32 a41, v57
  v_mfma_f32_16x16x32_bf16 v[108:111], v[36:39], v[188:191], v[108:111]
  v_accvgpr_write_b32 a42, v58
  v_mfma_f32_16x16x32_bf16 v[116:119], v[36:39], v[220:223], v[116:119]
  s_waitcnt lgkmcnt(5)
  v_accvgpr_write_b32 a43, v59
  v_mfma_f32_16x16x32_bf16 v[88:91], v[40:43], v[128:131], v[88:91]
  ds_read_b128 v[32:35], v249 offset:16640
  v_mul_f32 v64, v12, v64
  v_mfma_f32_16x16x32_bf16 v[96:99], v[40:43], v[160:163], v[96:99]
  v_mul_f32 v65, v12, v65
  v_mul_f32 v66, v12, v66
  v_mfma_f32_16x16x32_bf16 v[104:107], v[40:43], v[192:195], v[104:107]
  v_mul_f32 v67, v12, v67
  v_mfma_f32_16x16x32_bf16 v[112:115], v[40:43], v[224:227], v[112:115]
  s_waitcnt lgkmcnt(5)
  v_mul_f32 v68, v12, v68
  v_mfma_f32_16x16x32_bf16 v[92:95], v[44:47], v[128:131], v[92:95]
  ds_read_b128 v[36:39], v249 offset:18688
  v_mul_f32 v69, v12, v69
  v_mfma_f32_16x16x32_bf16 v[100:103], v[44:47], v[160:163], v[100:103]
  v_mul_f32 v70, v12, v70
  v_mul_f32 v71, v12, v71
  v_mfma_f32_16x16x32_bf16 v[108:111], v[44:47], v[192:195], v[108:111]
  v_cvt_pk_bf16_f32 v64, v64, v65
  v_mfma_f32_16x16x32_bf16 v[116:119], v[44:47], v[224:227], v[116:119]
  s_waitcnt lgkmcnt(5)
  v_cvt_pk_bf16_f32 v65, v66, v67
  v_mfma_f32_16x16x32_bf16 v[88:91], v[48:51], v[132:135], v[88:91]
  ds_read_b128 v[40:43], v250 offset:16640
  v_cvt_pk_bf16_f32 v66, v68, v69
  v_mfma_f32_16x16x32_bf16 v[96:99], v[48:51], v[164:167], v[96:99]
  v_cvt_pk_bf16_f32 v67, v70, v71
  v_accvgpr_write_b32 a96, v64
  v_mfma_f32_16x16x32_bf16 v[104:107], v[48:51], v[196:199], v[104:107]
  v_accvgpr_write_b32 a97, v65
  v_mfma_f32_16x16x32_bf16 v[112:115], v[48:51], v[228:231], v[112:115]
  s_waitcnt lgkmcnt(5)
  v_accvgpr_write_b32 a98, v66
  v_mfma_f32_16x16x32_bf16 v[92:95], v[52:55], v[132:135], v[92:95]
  ds_read_b128 v[44:47], v250 offset:18688
  v_accvgpr_write_b32 a99, v67
  v_mfma_f32_16x16x32_bf16 v[100:103], v[52:55], v[164:167], v[100:103]
  v_mul_f32 v72, v12, v72
  v_mul_f32 v73, v12, v73
  v_mfma_f32_16x16x32_bf16 v[108:111], v[52:55], v[196:199], v[108:111]
  v_mul_f32 v74, v12, v74
  v_mfma_f32_16x16x32_bf16 v[116:119], v[52:55], v[228:231], v[116:119]
  s_waitcnt lgkmcnt(5)
  v_mul_f32 v75, v12, v75
  v_mfma_f32_16x16x32_bf16 v[88:91], v[24:27], v[136:139], v[88:91]
  ds_read_b128 v[48:51], v251 offset:16640
  v_mul_f32 v76, v12, v76
  v_mfma_f32_16x16x32_bf16 v[96:99], v[24:27], v[168:171], v[96:99]
  v_mul_f32 v77, v12, v77
  v_mul_f32 v78, v12, v78
  v_mfma_f32_16x16x32_bf16 v[104:107], v[24:27], v[200:203], v[104:107]
  v_mul_f32 v79, v12, v79
  v_mfma_f32_16x16x32_bf16 v[112:115], v[24:27], v[232:235], v[112:115]
  s_waitcnt lgkmcnt(5)
  v_cvt_pk_bf16_f32 v72, v72, v73
  v_mfma_f32_16x16x32_bf16 v[92:95], v[28:31], v[136:139], v[92:95]
  ds_read_b128 v[52:55], v251 offset:18688
  v_cvt_pk_bf16_f32 v73, v74, v75
  v_mfma_f32_16x16x32_bf16 v[100:103], v[28:31], v[168:171], v[100:103]
  v_cvt_pk_bf16_f32 v74, v76, v77
  v_cvt_pk_bf16_f32 v75, v78, v79
  v_mfma_f32_16x16x32_bf16 v[108:111], v[28:31], v[200:203], v[108:111]
  v_accvgpr_write_b32 a152, v72
  v_mfma_f32_16x16x32_bf16 v[116:119], v[28:31], v[232:235], v[116:119]
  s_waitcnt lgkmcnt(5)
  v_accvgpr_write_b32 a153, v73
  v_mfma_f32_16x16x32_bf16 v[88:91], v[32:35], v[140:143], v[88:91]
  s_waitcnt vmcnt(4)
  s_barrier
  ds_read_b128 v[24:27], v248 offset:32768
  v_accvgpr_write_b32 a154, v74
  v_mfma_f32_16x16x32_bf16 v[96:99], v[32:35], v[172:175], v[96:99]
  v_accvgpr_write_b32 a155, v75
  v_mul_f32 v80, v12, v80
  v_mfma_f32_16x16x32_bf16 v[104:107], v[32:35], v[204:207], v[104:107]
  v_mul_f32 v81, v12, v81
  v_mfma_f32_16x16x32_bf16 v[112:115], v[32:35], v[236:239], v[112:115]
  s_waitcnt lgkmcnt(5)
  v_mul_f32 v82, v12, v82
  v_mfma_f32_16x16x32_bf16 v[92:95], v[36:39], v[140:143], v[92:95]
  ds_read_b128 v[28:31], v248 offset:34816
  v_mul_f32 v83, v12, v83
  v_mfma_f32_16x16x32_bf16 v[100:103], v[36:39], v[172:175], v[100:103]
  v_mul_f32 v84, v12, v84
  v_mul_f32 v85, v12, v85
  v_mfma_f32_16x16x32_bf16 v[108:111], v[36:39], v[204:207], v[108:111]
  v_mul_f32 v86, v12, v86
  v_mfma_f32_16x16x32_bf16 v[116:119], v[36:39], v[236:239], v[116:119]
  s_waitcnt lgkmcnt(5)
  v_mul_f32 v87, v12, v87
  v_mfma_f32_16x16x32_bf16 v[88:91], v[40:43], v[144:147], v[88:91]
  ds_read_b128 v[32:35], v249 offset:32768
  v_cvt_pk_bf16_f32 v80, v80, v81
  v_mfma_f32_16x16x32_bf16 v[96:99], v[40:43], v[176:179], v[96:99]
  v_cvt_pk_bf16_f32 v81, v82, v83
  v_cvt_pk_bf16_f32 v82, v84, v85
  v_mfma_f32_16x16x32_bf16 v[104:107], v[40:43], v[208:211], v[104:107]
  v_cvt_pk_bf16_f32 v83, v86, v87
  v_mfma_f32_16x16x32_bf16 v[112:115], v[40:43], v[240:243], v[112:115]
  s_waitcnt lgkmcnt(5)
  v_accvgpr_write_b32 a208, v80
  v_mfma_f32_16x16x32_bf16 v[92:95], v[44:47], v[144:147], v[92:95]
  ds_read_b128 v[36:39], v249 offset:34816
  v_accvgpr_write_b32 a209, v81
  v_mfma_f32_16x16x32_bf16 v[100:103], v[44:47], v[176:179], v[100:103]
  v_accvgpr_write_b32 a210, v82
  v_accvgpr_write_b32 a211, v83
  v_mfma_f32_16x16x32_bf16 v[108:111], v[44:47], v[208:211], v[108:111]
  v_mfma_f32_16x16x32_bf16 v[116:119], v[44:47], v[240:243], v[116:119]
  s_waitcnt lgkmcnt(5)
  v_mfma_f32_16x16x32_bf16 v[88:91], v[48:51], v[148:151], v[88:91]
  ds_read_b128 v[40:43], v250 offset:32768
  v_mfma_f32_16x16x32_bf16 v[96:99], v[48:51], v[180:183], v[96:99]
  v_mfma_f32_16x16x32_bf16 v[104:107], v[48:51], v[212:215], v[104:107]
  v_mfma_f32_16x16x32_bf16 v[112:115], v[48:51], v[244:247], v[112:115]
  s_waitcnt lgkmcnt(5)
  v_mfma_f32_16x16x32_bf16 v[92:95], v[52:55], v[148:151], v[92:95]
  ds_read_b128 v[44:47], v250 offset:34816
  v_mfma_f32_16x16x32_bf16 v[100:103], v[52:55], v[180:183], v[100:103]
  v_mfma_f32_16x16x32_bf16 v[108:111], v[52:55], v[212:215], v[108:111]
  v_mfma_f32_16x16x32_bf16 v[116:119], v[52:55], v[244:247], v[116:119]
  s_waitcnt lgkmcnt(5)
  v_mfma_f32_16x16x32_bf16 v[56:59], v[24:27], v[120:123], 0
  ds_read_b128 v[48:51], v251 offset:32768
  v_mfma_f32_16x16x32_bf16 v[64:67], v[24:27], v[152:155], 0
  v_mfma_f32_16x16x32_bf16 v[72:75], v[24:27], v[184:187], 0
  v_mfma_f32_16x16x32_bf16 v[80:83], v[24:27], v[216:219], 0
  s_waitcnt lgkmcnt(5)
  v_mul_f32 v88, v12, v88
  v_mfma_f32_16x16x32_bf16 v[60:63], v[28:31], v[120:123], 0
  ds_read_b128 v[52:55], v251 offset:34816
  v_mul_f32 v89, v12, v89
  v_mfma_f32_16x16x32_bf16 v[68:71], v[28:31], v[152:155], 0
  v_mul_f32 v90, v12, v90
  v_mul_f32 v91, v12, v91
  v_mfma_f32_16x16x32_bf16 v[76:79], v[28:31], v[184:187], 0
  v_mul_f32 v92, v12, v92
  v_mfma_f32_16x16x32_bf16 v[84:87], v[28:31], v[216:219], 0
  s_waitcnt lgkmcnt(5)
  v_mul_f32 v93, v12, v93
  v_mfma_f32_16x16x32_bf16 v[56:59], v[32:35], v[124:127], v[56:59]
  ds_read_b128 v[24:27], v248 offset:33024
  v_mul_f32 v94, v12, v94
  v_mfma_f32_16x16x32_bf16 v[64:67], v[32:35], v[156:159], v[64:67]
  v_mul_f32 v95, v12, v95
  v_cvt_pk_bf16_f32 v88, v88, v89
  v_mfma_f32_16x16x32_bf16 v[72:75], v[32:35], v[188:191], v[72:75]
  v_mfma_f32_16x16x32_bf16 v[80:83], v[32:35], v[220:223], v[80:83]
  s_waitcnt lgkmcnt(5)
  v_cvt_pk_bf16_f32 v89, v90, v91
  v_mfma_f32_16x16x32_bf16 v[60:63], v[36:39], v[124:127], v[60:63]
  ds_read_b128 v[28:31], v248 offset:35072
  v_cvt_pk_bf16_f32 v90, v92, v93
  v_mfma_f32_16x16x32_bf16 v[68:71], v[36:39], v[156:159], v[68:71]
  v_cvt_pk_bf16_f32 v91, v94, v95
  v_accvgpr_write_b32 a44, v88
  v_mfma_f32_16x16x32_bf16 v[76:79], v[36:39], v[188:191], v[76:79]
  v_accvgpr_write_b32 a45, v89
  v_mfma_f32_16x16x32_bf16 v[84:87], v[36:39], v[220:223], v[84:87]
  s_waitcnt lgkmcnt(5)
  v_accvgpr_write_b32 a46, v90
  v_mfma_f32_16x16x32_bf16 v[56:59], v[40:43], v[128:131], v[56:59]
  ds_read_b128 v[32:35], v249 offset:33024
  v_accvgpr_write_b32 a47, v91
  v_mfma_f32_16x16x32_bf16 v[64:67], v[40:43], v[160:163], v[64:67]
  v_mul_f32 v96, v12, v96
  v_mul_f32 v97, v12, v97
  v_mfma_f32_16x16x32_bf16 v[72:75], v[40:43], v[192:195], v[72:75]
  v_mfma_f32_16x16x32_bf16 v[80:83], v[40:43], v[224:227], v[80:83]
  s_waitcnt lgkmcnt(5)
  v_mul_f32 v98, v12, v98
  v_mfma_f32_16x16x32_bf16 v[60:63], v[44:47], v[128:131], v[60:63]
  ds_read_b128 v[36:39], v249 offset:35072
  v_mul_f32 v99, v12, v99
  v_mfma_f32_16x16x32_bf16 v[68:71], v[44:47], v[160:163], v[68:71]
  v_mul_f32 v100, v12, v100
  v_mul_f32 v101, v12, v101
  v_mfma_f32_16x16x32_bf16 v[76:79], v[44:47], v[192:195], v[76:79]
  v_mul_f32 v102, v12, v102
  v_mfma_f32_16x16x32_bf16 v[84:87], v[44:47], v[224:227], v[84:87]
  s_waitcnt lgkmcnt(5)
  v_mul_f32 v103, v12, v103
  v_mfma_f32_16x16x32_bf16 v[56:59], v[48:51], v[132:135], v[56:59]
  ds_read_b128 v[40:43], v250 offset:33024
  v_cvt_pk_bf16_f32 v96, v96, v97
  v_mfma_f32_16x16x32_bf16 v[64:67], v[48:51], v[164:167], v[64:67]
  v_cvt_pk_bf16_f32 v97, v98, v99
  v_cvt_pk_bf16_f32 v98, v100, v101
  v_mfma_f32_16x16x32_bf16 v[72:75], v[48:51], v[196:199], v[72:75]
  v_mfma_f32_16x16x32_bf16 v[80:83], v[48:51], v[228:231], v[80:83]
  s_waitcnt lgkmcnt(5)
  v_cvt_pk_bf16_f32 v99, v102, v103
  v_mfma_f32_16x16x32_bf16 v[60:63], v[52:55], v[132:135], v[60:63]
  ds_read_b128 v[44:47], v250 offset:35072
  v_accvgpr_write_b32 a100, v96
  v_mfma_f32_16x16x32_bf16 v[68:71], v[52:55], v[164:167], v[68:71]
  v_accvgpr_write_b32 a101, v97
  v_accvgpr_write_b32 a102, v98
  v_mfma_f32_16x16x32_bf16 v[76:79], v[52:55], v[196:199], v[76:79]
  v_accvgpr_write_b32 a103, v99
  v_mfma_f32_16x16x32_bf16 v[84:87], v[52:55], v[228:231], v[84:87]
  s_waitcnt lgkmcnt(5)
  v_mul_f32 v104, v12, v104
  v_mfma_f32_16x16x32_bf16 v[56:59], v[24:27], v[136:139], v[56:59]
  ds_read_b128 v[48:51], v251 offset:33024
  v_mul_f32 v105, v12, v105
  v_mfma_f32_16x16x32_bf16 v[64:67], v[24:27], v[168:171], v[64:67]
  v_mul_f32 v106, v12, v106
  v_mul_f32 v107, v12, v107
  v_mfma_f32_16x16x32_bf16 v[72:75], v[24:27], v[200:203], v[72:75]
  v_mfma_f32_16x16x32_bf16 v[80:83], v[24:27], v[232:235], v[80:83]
  s_waitcnt lgkmcnt(5)
  v_mul_f32 v108, v12, v108
  v_mfma_f32_16x16x32_bf16 v[60:63], v[28:31], v[136:139], v[60:63]
  ds_read_b128 v[52:55], v251 offset:35072
  v_mul_f32 v109, v12, v109
  v_mfma_f32_16x16x32_bf16 v[68:71], v[28:31], v[168:171], v[68:71]
  v_mul_f32 v110, v12, v110
  v_mul_f32 v111, v12, v111
  v_mfma_f32_16x16x32_bf16 v[76:79], v[28:31], v[200:203], v[76:79]
  v_cvt_pk_bf16_f32 v104, v104, v105
  v_mfma_f32_16x16x32_bf16 v[84:87], v[28:31], v[232:235], v[84:87]
  s_waitcnt lgkmcnt(5)
  v_cvt_pk_bf16_f32 v105, v106, v107
  v_mfma_f32_16x16x32_bf16 v[56:59], v[32:35], v[140:143], v[56:59]
  s_waitcnt vmcnt(0)
  s_barrier
  ds_read_b128 v[24:27], v248 offset:49152
  v_cvt_pk_bf16_f32 v106, v108, v109
  v_mfma_f32_16x16x32_bf16 v[64:67], v[32:35], v[172:175], v[64:67]
  v_cvt_pk_bf16_f32 v107, v110, v111
  v_accvgpr_write_b32 a156, v104
  v_mfma_f32_16x16x32_bf16 v[72:75], v[32:35], v[204:207], v[72:75]
  v_mfma_f32_16x16x32_bf16 v[80:83], v[32:35], v[236:239], v[80:83]
  s_waitcnt lgkmcnt(5)
  v_accvgpr_write_b32 a157, v105
  v_mfma_f32_16x16x32_bf16 v[60:63], v[36:39], v[140:143], v[60:63]
  ds_read_b128 v[28:31], v248 offset:51200
  v_accvgpr_write_b32 a158, v106
  v_mfma_f32_16x16x32_bf16 v[68:71], v[36:39], v[172:175], v[68:71]
  v_accvgpr_write_b32 a159, v107
  v_mul_f32 v112, v12, v112
  v_mfma_f32_16x16x32_bf16 v[76:79], v[36:39], v[204:207], v[76:79]
  v_mul_f32 v113, v12, v113
  v_mfma_f32_16x16x32_bf16 v[84:87], v[36:39], v[236:239], v[84:87]
  s_waitcnt lgkmcnt(5)
  v_mul_f32 v114, v12, v114
  v_mfma_f32_16x16x32_bf16 v[56:59], v[40:43], v[144:147], v[56:59]
  ds_read_b128 v[32:35], v249 offset:49152
  v_mul_f32 v115, v12, v115
  v_mfma_f32_16x16x32_bf16 v[64:67], v[40:43], v[176:179], v[64:67]
  v_mul_f32 v116, v12, v116
  v_mul_f32 v117, v12, v117
  v_mfma_f32_16x16x32_bf16 v[72:75], v[40:43], v[208:211], v[72:75]
  v_readfirstlane_b32 s86, v13
  s_lshl_b32 s22, s17, 7
  s_add_u32 s22, s22, 584192
  s_mov_b32 s23, 586240
  buffer_load_dword v13, off, s[8:11], s22 sc1
  buffer_load_dwordx2 v[10:11], off, s[8:11], s23 sc1
  v_mfma_f32_16x16x32_bf16 v[80:83], v[40:43], v[240:243], v[80:83]
  s_waitcnt lgkmcnt(5)
  v_mul_f32 v118, v12, v118
  v_mfma_f32_16x16x32_bf16 v[60:63], v[44:47], v[144:147], v[60:63]
  ds_read_b128 v[36:39], v249 offset:51200
  v_mul_f32 v119, v12, v119
  v_mfma_f32_16x16x32_bf16 v[68:71], v[44:47], v[176:179], v[68:71]
  v_cvt_pk_bf16_f32 v112, v112, v113
  v_cvt_pk_bf16_f32 v113, v114, v115
  v_mfma_f32_16x16x32_bf16 v[76:79], v[44:47], v[208:211], v[76:79]
  v_cvt_pk_bf16_f32 v114, v116, v117
  v_mfma_f32_16x16x32_bf16 v[84:87], v[44:47], v[240:243], v[84:87]
  s_waitcnt lgkmcnt(5)
  v_cvt_pk_bf16_f32 v115, v118, v119
  v_mfma_f32_16x16x32_bf16 v[56:59], v[48:51], v[148:151], v[56:59]
  ds_read_b128 v[40:43], v250 offset:49152
  v_accvgpr_write_b32 a212, v112
  v_mfma_f32_16x16x32_bf16 v[64:67], v[48:51], v[180:183], v[64:67]
  v_accvgpr_write_b32 a213, v113
  v_accvgpr_write_b32 a214, v114
  v_mfma_f32_16x16x32_bf16 v[72:75], v[48:51], v[212:215], v[72:75]
  v_accvgpr_write_b32 a215, v115
  v_mfma_f32_16x16x32_bf16 v[80:83], v[48:51], v[244:247], v[80:83]
  s_waitcnt lgkmcnt(5)
  v_mfma_f32_16x16x32_bf16 v[60:63], v[52:55], v[148:151], v[60:63]
  ds_read_b128 v[44:47], v250 offset:51200
  v_mfma_f32_16x16x32_bf16 v[68:71], v[52:55], v[180:183], v[68:71]
  v_mfma_f32_16x16x32_bf16 v[76:79], v[52:55], v[212:215], v[76:79]
  v_mfma_f32_16x16x32_bf16 v[84:87], v[52:55], v[244:247], v[84:87]
  s_waitcnt lgkmcnt(5)
  v_mfma_f32_16x16x32_bf16 v[88:91], v[24:27], v[120:123], 0
  ds_read_b128 v[48:51], v251 offset:49152
  v_mfma_f32_16x16x32_bf16 v[96:99], v[24:27], v[152:155], 0
  v_mfma_f32_16x16x32_bf16 v[104:107], v[24:27], v[184:187], 0
  v_mfma_f32_16x16x32_bf16 v[112:115], v[24:27], v[216:219], 0
  s_waitcnt lgkmcnt(5)
  v_mul_f32 v56, v12, v56
  v_mfma_f32_16x16x32_bf16 v[92:95], v[28:31], v[120:123], 0
  ds_read_b128 v[52:55], v251 offset:51200
  v_mul_f32 v57, v12, v57
  v_mfma_f32_16x16x32_bf16 v[100:103], v[28:31], v[152:155], 0
  v_mul_f32 v58, v12, v58
  v_mul_f32 v59, v12, v59
  v_mfma_f32_16x16x32_bf16 v[108:111], v[28:31], v[184:187], 0
  v_mul_f32 v60, v12, v60
  v_mfma_f32_16x16x32_bf16 v[116:119], v[28:31], v[216:219], 0
  s_waitcnt lgkmcnt(5)
  v_mul_f32 v61, v12, v61
  v_mfma_f32_16x16x32_bf16 v[88:91], v[32:35], v[124:127], v[88:91]
  ds_read_b128 v[24:27], v248 offset:49408
  v_mul_f32 v62, v12, v62
  v_mfma_f32_16x16x32_bf16 v[96:99], v[32:35], v[156:159], v[96:99]
  v_mul_f32 v63, v12, v63
  v_cvt_pk_bf16_f32 v56, v56, v57
  v_mfma_f32_16x16x32_bf16 v[104:107], v[32:35], v[188:191], v[104:107]
  v_cvt_pk_bf16_f32 v57, v58, v59
  v_mfma_f32_16x16x32_bf16 v[112:115], v[32:35], v[220:223], v[112:115]
  s_waitcnt lgkmcnt(5)
  v_cvt_pk_bf16_f32 v58, v60, v61
  v_mfma_f32_16x16x32_bf16 v[92:95], v[36:39], v[124:127], v[92:95]
  ds_read_b128 v[28:31], v248 offset:51456
  v_cvt_pk_bf16_f32 v59, v62, v63
  v_mfma_f32_16x16x32_bf16 v[100:103], v[36:39], v[156:159], v[100:103]
  v_accvgpr_write_b32 a48, v56
  v_accvgpr_write_b32 a49, v57
  v_mfma_f32_16x16x32_bf16 v[108:111], v[36:39], v[188:191], v[108:111]
  v_accvgpr_write_b32 a50, v58
  v_mfma_f32_16x16x32_bf16 v[116:119], v[36:39], v[220:223], v[116:119]
  s_waitcnt lgkmcnt(5)
  v_accvgpr_write_b32 a51, v59
  v_mfma_f32_16x16x32_bf16 v[88:91], v[40:43], v[128:131], v[88:91]
  ds_read_b128 v[32:35], v249 offset:49408
  v_mul_f32 v64, v12, v64
  v_mfma_f32_16x16x32_bf16 v[96:99], v[40:43], v[160:163], v[96:99]
  v_mul_f32 v65, v12, v65
  v_mul_f32 v66, v12, v66
  v_mfma_f32_16x16x32_bf16 v[104:107], v[40:43], v[192:195], v[104:107]
  v_mul_f32 v67, v12, v67
  v_mfma_f32_16x16x32_bf16 v[112:115], v[40:43], v[224:227], v[112:115]
  s_waitcnt lgkmcnt(5)
  v_mul_f32 v68, v12, v68
  v_mfma_f32_16x16x32_bf16 v[92:95], v[44:47], v[128:131], v[92:95]
  ds_read_b128 v[36:39], v249 offset:51456
  v_mul_f32 v69, v12, v69
  v_mfma_f32_16x16x32_bf16 v[100:103], v[44:47], v[160:163], v[100:103]
  v_mul_f32 v70, v12, v70
  v_mul_f32 v71, v12, v71
  v_mfma_f32_16x16x32_bf16 v[108:111], v[44:47], v[192:195], v[108:111]
  v_cvt_pk_bf16_f32 v64, v64, v65
  v_mfma_f32_16x16x32_bf16 v[116:119], v[44:47], v[224:227], v[116:119]
  s_waitcnt lgkmcnt(5)
  v_cvt_pk_bf16_f32 v65, v66, v67
  v_mfma_f32_16x16x32_bf16 v[88:91], v[48:51], v[132:135], v[88:91]
  ds_read_b128 v[40:43], v250 offset:49408
  v_cvt_pk_bf16_f32 v66, v68, v69
  v_mfma_f32_16x16x32_bf16 v[96:99], v[48:51], v[164:167], v[96:99]
  v_cvt_pk_bf16_f32 v67, v70, v71
  v_accvgpr_write_b32 a104, v64
  v_mfma_f32_16x16x32_bf16 v[104:107], v[48:51], v[196:199], v[104:107]
  v_accvgpr_write_b32 a105, v65
  v_mfma_f32_16x16x32_bf16 v[112:115], v[48:51], v[228:231], v[112:115]
  s_waitcnt lgkmcnt(5)
  v_accvgpr_write_b32 a106, v66
  v_mfma_f32_16x16x32_bf16 v[92:95], v[52:55], v[132:135], v[92:95]
  ds_read_b128 v[44:47], v250 offset:51456
  v_accvgpr_write_b32 a107, v67
  v_mfma_f32_16x16x32_bf16 v[100:103], v[52:55], v[164:167], v[100:103]
  v_mul_f32 v72, v12, v72
  v_mul_f32 v73, v12, v73
  v_mfma_f32_16x16x32_bf16 v[108:111], v[52:55], v[196:199], v[108:111]
  v_mul_f32 v74, v12, v74
  v_mfma_f32_16x16x32_bf16 v[116:119], v[52:55], v[228:231], v[116:119]
  s_waitcnt lgkmcnt(5)
  v_mul_f32 v75, v12, v75
  v_mfma_f32_16x16x32_bf16 v[88:91], v[24:27], v[136:139], v[88:91]
  ds_read_b128 v[48:51], v251 offset:49408
  v_mul_f32 v76, v12, v76
  v_mfma_f32_16x16x32_bf16 v[96:99], v[24:27], v[168:171], v[96:99]
  v_mul_f32 v77, v12, v77
  v_mul_f32 v78, v12, v78
  v_mfma_f32_16x16x32_bf16 v[104:107], v[24:27], v[200:203], v[104:107]
  v_mul_f32 v79, v12, v79
  v_mfma_f32_16x16x32_bf16 v[112:115], v[24:27], v[232:235], v[112:115]
  s_waitcnt lgkmcnt(5)
  v_cvt_pk_bf16_f32 v72, v72, v73
  v_mfma_f32_16x16x32_bf16 v[92:95], v[28:31], v[136:139], v[92:95]
  ds_read_b128 v[52:55], v251 offset:51456
  v_cvt_pk_bf16_f32 v73, v74, v75
  v_mfma_f32_16x16x32_bf16 v[100:103], v[28:31], v[168:171], v[100:103]
  v_cvt_pk_bf16_f32 v74, v76, v77
  v_cvt_pk_bf16_f32 v75, v78, v79
  v_mfma_f32_16x16x32_bf16 v[108:111], v[28:31], v[200:203], v[108:111]
  v_accvgpr_write_b32 a160, v72
  v_mfma_f32_16x16x32_bf16 v[116:119], v[28:31], v[232:235], v[116:119]
  s_waitcnt lgkmcnt(5)
  v_accvgpr_write_b32 a161, v73
  v_mfma_f32_16x16x32_bf16 v[88:91], v[32:35], v[140:143], v[88:91]
  v_accvgpr_write_b32 a162, v74
  v_mfma_f32_16x16x32_bf16 v[96:99], v[32:35], v[172:175], v[96:99]
  v_accvgpr_write_b32 a163, v75
  v_mul_f32 v80, v12, v80
  v_mfma_f32_16x16x32_bf16 v[104:107], v[32:35], v[204:207], v[104:107]
  v_mul_f32 v81, v12, v81
  v_mfma_f32_16x16x32_bf16 v[112:115], v[32:35], v[236:239], v[112:115]
  s_waitcnt lgkmcnt(4)
  v_mul_f32 v82, v12, v82
  v_mfma_f32_16x16x32_bf16 v[92:95], v[36:39], v[140:143], v[92:95]
  v_mul_f32 v83, v12, v83
  v_mfma_f32_16x16x32_bf16 v[100:103], v[36:39], v[172:175], v[100:103]
  v_mul_f32 v84, v12, v84
  v_mul_f32 v85, v12, v85
  v_mfma_f32_16x16x32_bf16 v[108:111], v[36:39], v[204:207], v[108:111]
  v_mul_f32 v86, v12, v86
  v_mfma_f32_16x16x32_bf16 v[116:119], v[36:39], v[236:239], v[116:119]
  s_waitcnt lgkmcnt(3)
  v_mul_f32 v87, v12, v87
  v_mfma_f32_16x16x32_bf16 v[88:91], v[40:43], v[144:147], v[88:91]
  v_cvt_pk_bf16_f32 v80, v80, v81
  v_mfma_f32_16x16x32_bf16 v[96:99], v[40:43], v[176:179], v[96:99]
  v_cvt_pk_bf16_f32 v81, v82, v83
  v_cvt_pk_bf16_f32 v82, v84, v85
  v_mfma_f32_16x16x32_bf16 v[104:107], v[40:43], v[208:211], v[104:107]
  v_cvt_pk_bf16_f32 v83, v86, v87
  v_mfma_f32_16x16x32_bf16 v[112:115], v[40:43], v[240:243], v[112:115]
  s_waitcnt lgkmcnt(2)
  v_accvgpr_write_b32 a216, v80
  v_mfma_f32_16x16x32_bf16 v[92:95], v[44:47], v[144:147], v[92:95]
  v_accvgpr_write_b32 a217, v81
  v_mfma_f32_16x16x32_bf16 v[100:103], v[44:47], v[176:179], v[100:103]
  v_accvgpr_write_b32 a218, v82
  v_accvgpr_write_b32 a219, v83
  v_mfma_f32_16x16x32_bf16 v[108:111], v[44:47], v[208:211], v[108:111]
  v_mfma_f32_16x16x32_bf16 v[116:119], v[44:47], v[240:243], v[116:119]
  s_waitcnt lgkmcnt(1)
  v_mfma_f32_16x16x32_bf16 v[88:91], v[48:51], v[148:151], v[88:91]
  v_mfma_f32_16x16x32_bf16 v[96:99], v[48:51], v[180:183], v[96:99]
  v_mfma_f32_16x16x32_bf16 v[104:107], v[48:51], v[212:215], v[104:107]
  v_mfma_f32_16x16x32_bf16 v[112:115], v[48:51], v[244:247], v[112:115]
  s_waitcnt lgkmcnt(0)
  v_mfma_f32_16x16x32_bf16 v[92:95], v[52:55], v[148:151], v[92:95]
  v_mfma_f32_16x16x32_bf16 v[100:103], v[52:55], v[180:183], v[100:103]
  v_mfma_f32_16x16x32_bf16 v[108:111], v[52:55], v[212:215], v[108:111]
  v_mfma_f32_16x16x32_bf16 v[116:119], v[52:55], v[244:247], v[116:119]
  v_mul_f32 v88, v12, v88
  v_mul_f32 v89, v12, v89
  v_mul_f32 v90, v12, v90
  v_mul_f32 v91, v12, v91
  v_mul_f32 v92, v12, v92
  v_mul_f32 v93, v12, v93
  v_mul_f32 v94, v12, v94
  v_mul_f32 v95, v12, v95
  v_cvt_pk_bf16_f32 v88, v88, v89
  v_cvt_pk_bf16_f32 v89, v90, v91
  v_cvt_pk_bf16_f32 v90, v92, v93
  v_cvt_pk_bf16_f32 v91, v94, v95
  v_accvgpr_write_b32 a52, v88
  v_accvgpr_write_b32 a53, v89
  v_accvgpr_write_b32 a54, v90
  v_accvgpr_write_b32 a55, v91
  v_mul_f32 v96, v12, v96
  v_mul_f32 v97, v12, v97
  v_mul_f32 v98, v12, v98
  v_mul_f32 v99, v12, v99
  v_mul_f32 v100, v12, v100
  v_mul_f32 v101, v12, v101
  v_mul_f32 v102, v12, v102
  v_mul_f32 v103, v12, v103
  v_cvt_pk_bf16_f32 v96, v96, v97
  v_cvt_pk_bf16_f32 v97, v98, v99
  v_cvt_pk_bf16_f32 v98, v100, v101
  v_cvt_pk_bf16_f32 v99, v102, v103
  v_accvgpr_write_b32 a108, v96
  v_accvgpr_write_b32 a109, v97
  v_accvgpr_write_b32 a110, v98
  v_accvgpr_write_b32 a111, v99
  v_mul_f32 v104, v12, v104
  v_mul_f32 v105, v12, v105
  v_mul_f32 v106, v12, v106
  v_mul_f32 v107, v12, v107
  v_mul_f32 v108, v12, v108
  v_mul_f32 v109, v12, v109
  v_mul_f32 v110, v12, v110
  v_mul_f32 v111, v12, v111
  v_cvt_pk_bf16_f32 v104, v104, v105
  v_cvt_pk_bf16_f32 v105, v106, v107
  v_cvt_pk_bf16_f32 v106, v108, v109
  v_cvt_pk_bf16_f32 v107, v110, v111
  v_accvgpr_write_b32 a164, v104
  v_accvgpr_write_b32 a165, v105
  v_accvgpr_write_b32 a166, v106
  v_accvgpr_write_b32 a167, v107
  v_mul_f32 v112, v12, v112
  v_mul_f32 v113, v12, v113
  v_mul_f32 v114, v12, v114
  v_mul_f32 v115, v12, v115
  v_mul_f32 v116, v12, v116
  v_mul_f32 v117, v12, v117
  v_mul_f32 v118, v12, v118
  v_mul_f32 v119, v12, v119
  v_cvt_pk_bf16_f32 v112, v112, v113
  v_cvt_pk_bf16_f32 v113, v114, v115
  v_cvt_pk_bf16_f32 v114, v116, v117
  v_cvt_pk_bf16_f32 v115, v118, v119
  v_accvgpr_write_b32 a220, v112
  v_accvgpr_write_b32 a221, v113
  v_accvgpr_write_b32 a222, v114
  v_accvgpr_write_b32 a223, v115
  s_waitcnt vmcnt(0)
  s_barrier
  v_readfirstlane_b32 s84, v13
  v_readfirstlane_b32 s85, v10
  v_readfirstlane_b32 s22, v11
  s_and_b32 s86, s86, s22
  s_cmp_eq_u32 s86, 1
  s_cselect_b32 s84, s84, 0
  v_and_b32 v10, 0xffe0, v9
  v_cmp_eq_u32 vcc, 0, v10
  s_cbranch_vccz ch_md_ok
ch_role2:
  s_mov_b32 s30, 0
ch_md:
  buffer_load_dword v9, off, s[12:15], 0 sc1
  s_waitcnt vmcnt(0)
  v_and_b32 v10, 0xffe0, v9
  v_cmp_eq_u32 vcc, 0, v10
  s_cbranch_vccz ch_md_ok
  s_sleep 4
  s_add_u32 s30, s30, 1
  s_cmp_lt_u32 s30, 1600000
  s_cbranch_scc1 ch_md
  s_branch ch_end
ch_md_ok:
  v_readfirstlane_b32 s88, v9
  s_lshr_b32 s88, s88, 16
  v_and_b32 v1, 63, v0
  v_lshlrev_b32 v2, 4, v1
  v_lshrrev_b32 v116, 4, v1
  v_and_b32 v117, 15, v1
  v_mov_b32 v3, 0x4444
  v_mov_b32 v118, 0xeeee
  v_cmp_lt_u32 vcc, 7, v117
  s_nop 1
  v_cndmask_b32 v3, v3, v118, vcc
  s_mov_b32 s19, 0
  s_mov_b32 s18, 1
  s_mov_b32 s20, 0
  s_mov_b32 s21, 17664
  s_mov_b32 s23, 4096
  s_lshr_b32 s89, s17, 4
  s_lshl_b32 s89, s89, 2
  s_add_u32 s89, s89, s16
  s_and_b32 s17, s17, 15
  s_cmp_eq_u32 s89, 0
  s_cbranch_scc1 ch_init0
  s_cmp_eq_u32 s89, 1
  s_cbranch_scc1 ch_init1
  s_cmp_eq_u32 s89, 2
  s_cbranch_scc1 ch_init2
  s_cmp_eq_u32 s89, 3
  s_cbranch_scc1 ch_init3
  s_cmp_eq_u32 s89, 4
  s_cbranch_scc1 ch_init4
  s_cmp_eq_u32 s89, 5
  s_cbranch_scc1 ch_init5
  s_cmp_eq_u32 s89, 6
  s_cbranch_scc1 ch_init6
  s_cmp_eq_u32 s89, 7
  s_cbranch_scc1 ch_init7
  s_branch ch_end
ch_init0:
  s_mul_i32 s31, s17, 401408
  s_add_u32 s31, s31, 33554432
  s_and_b32 s28, s84, 10320
  s_lshl_b32 s22, s85, 16
  s_or_b32 s28, s28, s22
  s_cmp_eq_u32 s28, 4294912080
  s_cbranch_scc1 ch_wx0_ok
  s_mov_b32 s30, 0
ch_wr0:
  buffer_load_dword v9, off, s[12:15], 0 offset:132 sc1
  s_waitcnt vmcnt(0)
  v_cmp_ne_u32 vcc, 1, v9
  s_cbranch_vccz ch_wr0_ok
  s_sleep 8
  s_add_u32 s30, s30, 1
  s_cmp_lt_u32 s30, 400000
  s_cbranch_scc1 ch_wr0
  s_branch cA_abort
ch_wr0_ok:
  s_lshl_b32 s27, s17, 7
  s_add_u32 s27, s27, 584192
  s_mov_b32 s28, 10320
  s_mov_b32 s30, 0
ch_wb0:
  buffer_load_dword v9, off, s[8:11], s27  sc1
  s_waitcnt vmcnt(0)
  v_and_b32 v10, s28, v9
  v_cmp_ne_u32 vcc, s28, v10
  s_cbranch_vccz ch_wb0_ok
  s_sleep 3
  s_add_u32 s30, s30, 1
  s_cmp_lt_u32 s30, 400000
  s_cbranch_scc1 ch_wb0
  s_branch cA_abort
ch_wb0_ok:
  s_mov_b32 s29, 586240
  s_mov_b32 s28, 0xffff
  s_mov_b32 s30, 0
ch_wx0:
  buffer_load_dword v9, off, s[8:11], s29  sc1
  s_waitcnt vmcnt(0)
  v_and_b32 v10, s28, v9
  v_cmp_ne_u32 vcc, s28, v10
  s_cbranch_vccz ch_wx0_ok
  s_sleep 8
  s_add_u32 s30, s30, 1
  s_cmp_lt_u32 s30, 400000
  s_cbranch_scc1 ch_wx0
  s_branch cA_abort
ch_wx0_ok:
  s_add_u32 s22, s31, 229376
  buffer_load_dwordx4 a[224:227], v2, s[8:11], s22 offen offset:0 sc1
  buffer_load_dwordx4 a[228:231], v2, s[8:11], s22 offen offset:1024 sc1
  buffer_load_dwordx4 a[232:235], v2, s[8:11], s22 offen offset:2048 sc1
  buffer_load_dwordx4 a[236:239], v2, s[8:11], s22 offen offset:3072 sc1
  s_add_u32 s22, s31, 233472
  buffer_load_dwordx4 a[240:243], v2, s[8:11], s22 offen offset:0 sc1
  buffer_load_dwordx4 a[244:247], v2, s[8:11], s22 offen offset:1024 sc1
  buffer_load_dwordx4 a[248:251], v2, s[8:11], s22 offen offset:2048 sc1
  buffer_load_dwordx4 a[252:255], v2, s[8:11], s22 offen offset:3072 sc1
  s_add_u32 s22, s31, 237568
  buffer_load_dwordx4 v[120:123], v2, s[8:11], s22 offen offset:0 sc1
  buffer_load_dwordx4 v[124:127], v2, s[8:11], s22 offen offset:1024 sc1
  buffer_load_dwordx4 v[128:131], v2, s[8:11], s22 offen offset:2048 sc1
  buffer_load_dwordx4 v[132:135], v2, s[8:11], s22 offen offset:3072 sc1
  s_add_u32 s22, s31, 241664
  buffer_load_dwordx4 v[136:139], v2, s[8:11], s22 offen offset:0 sc1
  buffer_load_dwordx4 v[140:143], v2, s[8:11], s22 offen offset:1024 sc1
  buffer_load_dwordx4 v[144:147], v2, s[8:11], s22 offen offset:2048 sc1
  buffer_load_dwordx4 v[148:151], v2, s[8:11], s22 offen offset:3072 sc1
  s_add_u32 s22, s31, 245760
  buffer_load_dwordx4 v[152:155], v2, s[8:11], s22 offen offset:0 sc1
  buffer_load_dwordx4 v[156:159], v2, s[8:11], s22 offen offset:1024 sc1
  buffer_load_dwordx4 v[160:163], v2, s[8:11], s22 offen offset:2048 sc1
  buffer_load_dwordx4 v[164:167], v2, s[8:11], s22 offen offset:3072 sc1
  s_add_u32 s22, s31, 249856
  buffer_load_dwordx4 v[168:171], v2, s[8:11], s22 offen offset:0 sc1
  buffer_load_dwordx4 v[172:175], v2, s[8:11], s22 offen offset:1024 sc1
  buffer_load_dwordx4 v[176:179], v2, s[8:11], s22 offen offset:2048 sc1
  buffer_load_dwordx4 v[180:183], v2, s[8:11], s22 offen offset:3072 sc1
  s_mov_b32 s24, 655360
  s_mov_b32 s26, 669696
  v_and_b32 v64, 7, v117
  v_and_b32 v65, 1, v116
  v_lshlrev_b32 v65, 2, v65
  v_sub_u32 v64, v64, v65
  v_lshrrev_b32 v65, 3, v117
  v_lshl_add_u32 v66, v65, 2, v64
  v_cmp_gt_u32 vcc, 4, v64
  v_mov_b32 v67, 99
  s_nop 0
  v_cndmask_b32 v66, v67, v66, vcc
  v_mov_b32 v68, 0x3f80
  v_mov_b32 v69, 0x3f800000
  v_mov_b32 v4, 0
  v_cmp_eq_u32 vcc, 0, v66
  s_nop 1
  v_cndmask_b32 v4, v4, v68, vcc
  v_cmp_eq_u32 vcc, 1, v66
  s_nop 1
  v_cndmask_b32 v4, v4, v69, vcc
  v_mov_b32 v5, 0
  v_cmp_eq_u32 vcc, 2, v66
  s_nop 1
  v_cndmask_b32 v5, v5, v68, vcc
  v_cmp_eq_u32 vcc, 3, v66
  s_nop 1
  v_cndmask_b32 v5, v5, v69, vcc
  v_mov_b32 v6, 0
  v_cmp_eq_u32 vcc, 4, v66
  s_nop 1
  v_cndmask_b32 v6, v6, v68, vcc
  v_cmp_eq_u32 vcc, 5, v66
  s_nop 1
  v_cndmask_b32 v6, v6, v69, vcc
  v_mov_b32 v7, 0
  v_cmp_eq_u32 vcc, 6, v66
  s_nop 1
  v_cndmask_b32 v7, v7, v68, vcc
  v_cmp_eq_u32 vcc, 7, v66
  s_nop 1
  v_cndmask_b32 v7, v7, v69, vcc
  v_lshrrev_b32 v64, 1, v116
  v_lshrrev_b32 v65, 3, v117
  v_and_b32 v66, 1, v116
  v_and_b32 v68, 7, v117
  v_lshlrev_b32 v67, 8, v65
  v_lshl_add_u32 v67, v68, 5, v67
  v_lshl_add_u32 v67, v66, 4, v67
  v_add_u32 v69, 4096, v67
  v_add_u32 v70, 6400, v67
  v_cmp_eq_u32 vcc, v64, v65
  s_nop 1
  v_cndmask_b32 v113, v70, v69, vcc
  v_and_b32 v74, 3, v117
  v_lshlrev_b32 v74, 1, v74
  v_bfe_u32 v75, v117, 2, 1
  v_or_b32 v74, v74, v75
  v_and_b32 v75, 8, v117
  v_or_b32 v74, v74, v75
  v_lshlrev_b32 v67, 9, v64
  v_lshl_add_u32 v67, v74, 4, v67
  v_lshl_add_u32 v67, v66, 3, v67
  v_add_u32 v114, 0, v67
  v_mul_u32_u24 v67, 1088, v65
  v_lshl_add_u32 v67, v116, 5, v67
  v_and_b32 v75, 1, v117
  v_and_b32 v76, 2, v117
  v_lshl_add_u32 v75, v76, 1, v75
  v_bfe_u32 v76, v117, 2, 1
  v_lshl_add_u32 v75, v76, 1, v75
  v_lshl_add_u32 v67, v75, 2, v67
  v_add_u32 v115, 4096, v67
  v_and_b32 v69, 1, v74
  v_lshlrev_b32 v67, 7, v69
  v_lshl_add_u32 v67, v116, 4, v67
  v_lshl_add_u32 v67, v65, 8, v67
  v_bfe_u32 v69, v74, 1, 2
  v_lshl_add_u32 v67, v69, 2, v67
  s_lshl_b32 s22, s17, 9
  s_add_u32 s22, s22, 9216
  v_add_u32 v72, s22, v67
  v_bfe_u32 v69, v75, 1, 1
  v_lshlrev_b32 v67, 7, v69
  v_lshl_add_u32 v67, v116, 4, v67
  v_and_b32 v69, 4, v75
  v_add_u32 v67, v67, v69
  s_lshr_b32 s22, s17, 1
  s_lshl_b32 s22, s22, 8
  s_and_b32 s27, s17, 1
  s_lshl_b32 s27, s27, 3
  s_add_u32 s22, s22, s27
  s_add_u32 s22, s22, 7168
  v_add_u32 v67, s22, v67
  v_and_b32 v69, 9, v117
  v_mov_b32 v70, 0x40000000
  v_cmp_eq_u32 vcc, 0, v69
  s_nop 1
  v_cndmask_b32 v118, v70, v67, vcc
  v_mov_b32 v119, -1
  v_and_b32 v0, 15, v1
  s_and_b32 s22, s17, 0
  s_lshl_b32 s22, s22, 7
  s_add_u32 s22, s22, 37376
  v_lshl_add_u32 v0, v0, 2, s22
  v_xor_b32 v69, 256, v2
  v_mul_i32_i24 v70, -4096, v66
  v_add_u32 v69, v69, v70
  v_add_u32 v117, 12288, v69
  v_mov_b32 v116, v73
  v_mov_b32 v112, 0
  s_mul_i32 s35, s17, 28672
  s_add_u32 s35, s35, 4325376
  v_mov_b32 v1, v72
  v_mov_b32 v36, 0
  v_mov_b32 v37, 0
  v_mov_b32 v38, 0
  v_mov_b32 v39, 0
  v_mov_b32 v40, 0
  v_mov_b32 v41, 0
  v_mov_b32 v42, 0
  v_mov_b32 v43, 0
  v_mov_b32 v44, 0
  v_mov_b32 v45, 0
  v_mov_b32 v46, 0
  v_mov_b32 v47, 0
  v_mov_b32 v48, 0
  v_mov_b32 v49, 0
  v_mov_b32 v50, 0
  v_mov_b32 v51, 0
  v_mov_b32 v52, 0
  v_mov_b32 v53, 0
  v_mov_b32 v54, 0
  v_mov_b32 v55, 0
  v_mov_b32 v56, 0
  v_mov_b32 v57, 0
  v_mov_b32 v58, 0
  v_mov_b32 v59, 0
  v_mov_b32 v60, 0
  v_mov_b32 v61, 0
  v_mov_b32 v62, 0
  v_mov_b32 v63, 0
  v_mov_b32 v64, 0
  v_mov_b32 v65, 0
  v_mov_b32 v66, 0
  v_mov_b32 v67, 0
  v_mov_b32 v68, 0
  v_mov_b32 v69, 0
  v_mov_b32 v70, 0
  v_mov_b32 v71, 0
  v_mov_b32 v72, 0
  v_mov_b32 v73, 0
  v_mov_b32 v74, 0
  v_mov_b32 v75, 0
  v_mov_b32 v76, 0
  v_mov_b32 v77, 0
  v_mov_b32 v78, 0
  v_mov_b32 v79, 0
  s_mov_b32 s22, 0
  v_lshrrev_b32 v14, 4, v2
  v_add_u32 v14, 0, v14
  v_min_u32 v14, 308, v14
  v_lshlrev_b32 v14, 7, v14
  buffer_load_dword v15, v14, s[8:11], s22 offen sc1
  v_lshrrev_b32 v14, 4, v2
  v_add_u32 v14, 256, v14
  v_min_u32 v14, 308, v14
  v_lshlrev_b32 v14, 7, v14
  buffer_load_dword v15, v14, s[8:11], s22 offen sc1
  buffer_load_dwordx4 v[80:83], v117, s[8:11], s24 offen offset:0 sc1
  buffer_load_dwordx4 v[84:87], v117, s[8:11], s24 offen offset:1024 sc1
  buffer_load_dwordx4 v[88:91], v117, s[8:11], s26 offen offset:0 sc1
  buffer_load_dwordx4 v[92:95], v117, s[8:11], s26 offen offset:1024 sc1
  buffer_load_dwordx4 v[96:99], v2, s[8:11], s24 offen offset:0 sc1
  buffer_load_dwordx4 v[100:103], v2, s[8:11], s24 offen offset:1024 sc1
  buffer_load_dwordx4 v[104:107], v2, s[8:11], s26 offen offset:0 sc1
  buffer_load_dwordx4 v[108:111], v2, s[8:11], s26 offen offset:1024 sc1
  s_add_u32 s22, s31, 253952
  buffer_load_dwordx4 v[184:187], v2, s[8:11], s22 offen offset:0 sc1
  buffer_load_dwordx4 v[188:191], v2, s[8:11], s22 offen offset:1024 sc1
  buffer_load_dwordx4 v[192:195], v2, s[8:11], s22 offen offset:2048 sc1
  buffer_load_dwordx4 v[196:199], v2, s[8:11], s22 offen offset:3072 sc1
  s_add_u32 s22, s31, 372736
  buffer_load_dwordx4 v[200:203], v2, s[8:11], s22 offen offset:0 sc1
  buffer_load_dwordx4 v[204:207], v2, s[8:11], s22 offen offset:1024 sc1
  buffer_load_dwordx4 v[208:211], v2, s[8:11], s22 offen offset:2048 sc1
  buffer_load_dwordx4 v[212:215], v2, s[8:11], s22 offen offset:3072 sc1
  s_add_u32 s22, s31, 376832
  buffer_load_dwordx4 v[216:219], v2, s[8:11], s22 offen offset:0 sc1
  buffer_load_dwordx4 v[220:223], v2, s[8:11], s22 offen offset:1024 sc1
  buffer_load_dwordx4 v[224:227], v2, s[8:11], s22 offen offset:2048 sc1
  buffer_load_dwordx4 v[228:231], v2, s[8:11], s22 offen offset:3072 sc1
  s_add_u32 s22, s31, 380928
  buffer_load_dwordx4 v[232:235], v2, s[8:11], s22 offen offset:0 sc1
  buffer_load_dwordx4 v[236:239], v2, s[8:11], s22 offen offset:1024 sc1
  buffer_load_dwordx4 v[240:243], v2, s[8:11], s22 offen offset:2048 sc1
  buffer_load_dwordx4 v[244:247], v2, s[8:11], s22 offen offset:3072 sc1
  s_add_u32 s22, s31, 385024
  buffer_load_dwordx4 v[248:251], v2, s[8:11], s22 offen offset:0 sc1
  buffer_load_dwordx4 v[252:255], v2, s[8:11], s22 offen offset:1024 sc1
  s_waitcnt vmcnt(0) lgkmcnt(0)
  s_mov_b32 s31, 0
  s_cmp_lg_u32 s88, 0
  s_cbranch_scc1 cB_sc0_loop
  s_branch cA_sc0_loop
ch_init1:
  s_mul_i32 s31, s17, 401408
  s_add_u32 s31, s31, 33554432
  s_and_b32 s28, s84, 10320
  s_lshl_b32 s22, s85, 16
  s_or_b32 s28, s28, s22
  s_cmp_eq_u32 s28, 4294912080
  s_cbranch_scc1 ch_wx1_ok
  s_mov_b32 s30, 0
ch_wr1:
  buffer_load_dword v9, off, s[12:15], 0 offset:132 sc1
  s_waitcnt vmcnt(0)
  v_cmp_ne_u32 vcc, 1, v9
  s_cbranch_vccz ch_wr1_ok
  s_sleep 8
  s_add_u32 s30, s30, 1
  s_cmp_lt_u32 s30, 400000
  s_cbranch_scc1 ch_wr1
  s_branch cA_abort
ch_wr1_ok:
  s_lshl_b32 s27, s17, 7
  s_add_u32 s27, s27, 584192
  s_mov_b32 s28, 10320
  s_mov_b32 s30, 0
ch_wb1:
  buffer_load_dword v9, off, s[8:11], s27  sc1
  s_waitcnt vmcnt(0)
  v_and_b32 v10, s28, v9
  v_cmp_ne_u32 vcc, s28, v10
  s_cbranch_vccz ch_wb1_ok
  s_sleep 3
  s_add_u32 s30, s30, 1
  s_cmp_lt_u32 s30, 400000
  s_cbranch_scc1 ch_wb1
  s_branch cA_abort
ch_wb1_ok:
  s_mov_b32 s29, 586240
  s_mov_b32 s28, 0xffff
  s_mov_b32 s30, 0
ch_wx1:
  buffer_load_dword v9, off, s[8:11], s29  sc1
  s_waitcnt vmcnt(0)
  v_and_b32 v10, s28, v9
  v_cmp_ne_u32 vcc, s28, v10
  s_cbranch_vccz ch_wx1_ok
  s_sleep 8
  s_add_u32 s30, s30, 1
  s_cmp_lt_u32 s30, 400000
  s_cbranch_scc1 ch_wx1
  s_branch cA_abort
ch_wx1_ok:
  s_add_u32 s22, s31, 258048
  buffer_load_dwordx4 a[224:227], v2, s[8:11], s22 offen offset:0 sc1
  buffer_load_dwordx4 a[228:231], v2, s[8:11], s22 offen offset:1024 sc1
  buffer_load_dwordx4 a[232:235], v2, s[8:11], s22 offen offset:2048 sc1
  buffer_load_dwordx4 a[236:239], v2, s[8:11], s22 offen offset:3072 sc1
  s_add_u32 s22, s31, 262144
  buffer_load_dwordx4 a[240:243], v2, s[8:11], s22 offen offset:0 sc1
  buffer_load_dwordx4 a[244:247], v2, s[8:11], s22 offen offset:1024 sc1
  buffer_load_dwordx4 a[248:251], v2, s[8:11], s22 offen offset:2048 sc1
  buffer_load_dwordx4 a[252:255], v2, s[8:11], s22 offen offset:3072 sc1
  s_add_u32 s22, s31, 266240
  buffer_load_dwordx4 v[120:123], v2, s[8:11], s22 offen offset:0 sc1
  buffer_load_dwordx4 v[124:127], v2, s[8:11], s22 offen offset:1024 sc1
  buffer_load_dwordx4 v[128:131], v2, s[8:11], s22 offen offset:2048 sc1
  buffer_load_dwordx4 v[132:135], v2, s[8:11], s22 offen offset:3072 sc1
  s_add_u32 s22, s31, 270336
  buffer_load_dwordx4 v[136:139], v2, s[8:11], s22 offen offset:0 sc1
  buffer_load_dwordx4 v[140:143], v2, s[8:11], s22 offen offset:1024 sc1
  buffer_load_dwordx4 v[144:147], v2, s[8:11], s22 offen offset:2048 sc1
  buffer_load_dwordx4 v[148:151], v2, s[8:11], s22 offen offset:3072 sc1
  s_add_u32 s22, s31, 274432
  buffer_load_dwordx4 v[152:155], v2, s[8:11], s22 offen offset:0 sc1
  buffer_load_dwordx4 v[156:159], v2, s[8:11], s22 offen offset:1024 sc1
  buffer_load_dwordx4 v[160:163], v2, s[8:11], s22 offen offset:2048 sc1
  buffer_load_dwordx4 v[164:167], v2, s[8:11], s22 offen offset:3072 sc1
  s_add_u32 s22, s31, 278528
  buffer_load_dwordx4 v[168:171], v2, s[8:11], s22 offen offset:0 sc1
  buffer_load_dwordx4 v[172:175], v2, s[8:11], s22 offen offset:1024 sc1
  buffer_load_dwordx4 v[176:179], v2, s[8:11], s22 offen offset:2048 sc1
  buffer_load_dwordx4 v[180:183], v2, s[8:11], s22 offen offset:3072 sc1
  s_mov_b32 s24, 657408
  s_mov_b32 s26, 671744
  v_and_b32 v64, 7, v117
  v_and_b32 v65, 1, v116
  v_lshlrev_b32 v65, 2, v65
  v_sub_u32 v64, v64, v65
  v_lshrrev_b32 v65, 3, v117
  v_lshl_add_u32 v66, v65, 2, v64
  v_cmp_gt_u32 vcc, 4, v64
  v_mov_b32 v67, 99
  s_nop 0
  v_cndmask_b32 v66, v67, v66, vcc
  v_mov_b32 v68, 0x3f80
  v_mov_b32 v69, 0x3f800000
  v_mov_b32 v4, 0
  v_cmp_eq_u32 vcc, 0, v66
  s_nop 1
  v_cndmask_b32 v4, v4, v68, vcc
  v_cmp_eq_u32 vcc, 1, v66
  s_nop 1
  v_cndmask_b32 v4, v4, v69, vcc
  v_mov_b32 v5, 0
  v_cmp_eq_u32 vcc, 2, v66
  s_nop 1
  v_cndmask_b32 v5, v5, v68, vcc
  v_cmp_eq_u32 vcc, 3, v66
  s_nop 1
  v_cndmask_b32 v5, v5, v69, vcc
  v_mov_b32 v6, 0
  v_cmp_eq_u32 vcc, 4, v66
  s_nop 1
  v_cndmask_b32 v6, v6, v68, vcc
  v_cmp_eq_u32 vcc, 5, v66
  s_nop 1
  v_cndmask_b32 v6, v6, v69, vcc
  v_mov_b32 v7, 0
  v_cmp_eq_u32 vcc, 6, v66
  s_nop 1
  v_cndmask_b32 v7, v7, v68, vcc
  v_cmp_eq_u32 vcc, 7, v66
  s_nop 1
  v_cndmask_b32 v7, v7, v69, vcc
  v_lshrrev_b32 v64, 1, v116
  v_lshrrev_b32 v65, 3, v117
  v_and_b32 v66, 1, v116
  v_and_b32 v68, 7, v117
  v_lshlrev_b32 v67, 8, v65
  v_lshl_add_u32 v67, v68, 5, v67
  v_lshl_add_u32 v67, v66, 4, v67
  v_add_u32 v69, 4608, v67
  v_add_u32 v70, 6400, v67
  v_cmp_eq_u32 vcc, v64, v65
  s_nop 1
  v_cndmask_b32 v113, v70, v69, vcc
  v_and_b32 v74, 3, v117
  v_lshlrev_b32 v74, 1, v74
  v_bfe_u32 v75, v117, 2, 1
  v_or_b32 v74, v74, v75
  v_and_b32 v75, 8, v117
  v_or_b32 v74, v74, v75
  v_lshlrev_b32 v67, 9, v64
  v_lshl_add_u32 v67, v74, 4, v67
  v_lshl_add_u32 v67, v66, 3, v67
  v_add_u32 v114, 256, v67
  v_mul_u32_u24 v67, 1088, v65
  v_lshl_add_u32 v67, v116, 5, v67
  v_and_b32 v75, 1, v117
  v_and_b32 v76, 2, v117
  v_lshl_add_u32 v75, v76, 1, v75
  v_bfe_u32 v76, v117, 2, 1
  v_lshl_add_u32 v75, v76, 1, v75
  v_lshl_add_u32 v67, v75, 2, v67
  v_add_u32 v115, 4224, v67
  v_and_b32 v69, 1, v74
  v_lshlrev_b32 v67, 7, v69
  v_lshl_add_u32 v67, v116, 4, v67
  v_lshl_add_u32 v67, v65, 8, v67
  v_bfe_u32 v69, v74, 1, 2
  v_lshl_add_u32 v67, v69, 2, v67
  s_lshl_b32 s22, s17, 9
  s_add_u32 s22, s22, 9280
  v_add_u32 v72, s22, v67
  v_bfe_u32 v69, v75, 1, 1
  v_lshlrev_b32 v67, 7, v69
  v_lshl_add_u32 v67, v116, 4, v67
  v_and_b32 v69, 4, v75
  v_add_u32 v67, v67, v69
  s_lshr_b32 s22, s17, 1
  s_lshl_b32 s22, s22, 8
  s_and_b32 s27, s17, 1
  s_lshl_b32 s27, s27, 3
  s_add_u32 s22, s22, s27
  s_add_u32 s22, s22, 7232
  v_add_u32 v67, s22, v67
  v_and_b32 v69, 9, v117
  v_mov_b32 v70, 0x40000000
  v_cmp_eq_u32 vcc, 0, v69
  s_nop 1
  v_cndmask_b32 v118, v70, v67, vcc
  v_mov_b32 v119, -1
  s_lshl_b32 s22, s17, 2
  s_add_u32 s22, s22, 35328
  v_lshl_add_u32 v67, v1, 7, s22
  v_mov_b32 v70, 0x40000000
  v_cmp_gt_u32 vcc, 1, v1
  s_nop 1
  v_cndmask_b32 v73, v70, v67, vcc
  v_mov_b32 v112, 1
  v_and_b32 v0, 15, v1
  s_and_b32 s22, s17, 0
  s_lshl_b32 s22, s22, 7
  s_add_u32 s22, s22, 37376
  v_lshl_add_u32 v0, v0, 2, s22
  v_xor_b32 v69, 256, v2
  v_mul_i32_i24 v70, 4096, v66
  v_add_u32 v69, v69, v70
  v_add_u32 v117, 6144, v69
  v_mov_b32 v116, v73
  s_mul_i32 s35, s17, 28672
  s_add_u32 s35, s35, 4325376
  v_mov_b32 v1, v72
  v_mov_b32 v36, 0
  v_mov_b32 v37, 0
  v_mov_b32 v38, 0
  v_mov_b32 v39, 0
  v_mov_b32 v40, 0
  v_mov_b32 v41, 0
  v_mov_b32 v42, 0
  v_mov_b32 v43, 0
  v_mov_b32 v44, 0
  v_mov_b32 v45, 0
  v_mov_b32 v46, 0
  v_mov_b32 v47, 0
  v_mov_b32 v48, 0
  v_mov_b32 v49, 0
  v_mov_b32 v50, 0
  v_mov_b32 v51, 0
  v_mov_b32 v52, 0
  v_mov_b32 v53, 0
  v_mov_b32 v54, 0
  v_mov_b32 v55, 0
  v_mov_b32 v56, 0
  v_mov_b32 v57, 0
  v_mov_b32 v58, 0
  v_mov_b32 v59, 0
  v_mov_b32 v60, 0
  v_mov_b32 v61, 0
  v_mov_b32 v62, 0
  v_mov_b32 v63, 0
  v_mov_b32 v64, 0
  v_mov_b32 v65, 0
  v_mov_b32 v66, 0
  v_mov_b32 v67, 0
  v_mov_b32 v68, 0
  v_mov_b32 v69, 0
  v_mov_b32 v70, 0
  v_mov_b32 v71, 0
  v_mov_b32 v72, 0
  v_mov_b32 v73, 0
  v_mov_b32 v74, 0
  v_mov_b32 v75, 0
  v_mov_b32 v76, 0
  v_mov_b32 v77, 0
  v_mov_b32 v78, 0
  v_mov_b32 v79, 0
  s_mov_b32 s22, 0
  v_lshrrev_b32 v14, 4, v2
  v_add_u32 v14, 64, v14
  v_min_u32 v14, 308, v14
  v_lshlrev_b32 v14, 7, v14
  buffer_load_dword v15, v14, s[8:11], s22 offen sc1
  buffer_load_dwordx4 v[80:83], v117, s[8:11], s24 offen offset:0 sc1
  buffer_load_dwordx4 v[84:87], v117, s[8:11], s24 offen offset:1024 sc1
  buffer_load_dwordx4 v[88:91], v117, s[8:11], s26 offen offset:0 sc1
  buffer_load_dwordx4 v[92:95], v117, s[8:11], s26 offen offset:1024 sc1
  buffer_load_dwordx4 v[96:99], v2, s[8:11], s24 offen offset:0 sc1
  buffer_load_dwordx4 v[100:103], v2, s[8:11], s24 offen offset:1024 sc1
  buffer_load_dwordx4 v[104:107], v2, s[8:11], s26 offen offset:0 sc1
  buffer_load_dwordx4 v[108:111], v2, s[8:11], s26 offen offset:1024 sc1
  s_add_u32 s22, s31, 282624
  buffer_load_dwordx4 v[184:187], v2, s[8:11], s22 offen offset:0 sc1
  buffer_load_dwordx4 v[188:191], v2, s[8:11], s22 offen offset:1024 sc1
  buffer_load_dwordx4 v[192:195], v2, s[8:11], s22 offen offset:2048 sc1
  buffer_load_dwordx4 v[196:199], v2, s[8:11], s22 offen offset:3072 sc1
  s_add_u32 s22, s31, 344064
  buffer_load_dwordx4 v[200:203], v2, s[8:11], s22 offen offset:0 sc1
  buffer_load_dwordx4 v[204:207], v2, s[8:11], s22 offen offset:1024 sc1
  buffer_load_dwordx4 v[208:211], v2, s[8:11], s22 offen offset:2048 sc1
  buffer_load_dwordx4 v[212:215], v2, s[8:11], s22 offen offset:3072 sc1
  s_add_u32 s22, s31, 348160
  buffer_load_dwordx4 v[216:219], v2, s[8:11], s22 offen offset:0 sc1
  buffer_load_dwordx4 v[220:223], v2, s[8:11], s22 offen offset:1024 sc1
  buffer_load_dwordx4 v[224:227], v2, s[8:11], s22 offen offset:2048 sc1
  buffer_load_dwordx4 v[228:231], v2, s[8:11], s22 offen offset:3072 sc1
  s_add_u32 s22, s31, 352256
  buffer_load_dwordx4 v[232:235], v2, s[8:11], s22 offen offset:0 sc1
  buffer_load_dwordx4 v[236:239], v2, s[8:11], s22 offen offset:1024 sc1
  buffer_load_dwordx4 v[240:243], v2, s[8:11], s22 offen offset:2048 sc1
  buffer_load_dwordx4 v[244:247], v2, s[8:11], s22 offen offset:3072 sc1
  s_add_u32 s22, s31, 356352
  buffer_load_dwordx4 v[248:251], v2, s[8:11], s22 offen offset:0 sc1
  buffer_load_dwordx4 v[252:255], v2, s[8:11], s22 offen offset:1024 sc1
  s_waitcnt vmcnt(0) lgkmcnt(0)
  s_mov_b32 s31, 0
  s_cmp_lg_u32 s88, 0
  s_cbranch_scc1 cB_sc1_loop
  s_branch cA_sc1_loop
ch_init2:
  s_mul_i32 s31, s17, 401408
  s_add_u32 s31, s31, 33554432
  s_and_b32 s28, s84, 12384
  s_lshl_b32 s22, s85, 16
  s_or_b32 s28, s28, s22
  s_cmp_eq_u32 s28, 4294914144
  s_cbranch_scc1 ch_wx2_ok
  s_mov_b32 s30, 0
ch_wr2:
  buffer_load_dword v9, off, s[12:15], 0 offset:132 sc1
  s_waitcnt vmcnt(0)
  v_cmp_ne_u32 vcc, 1, v9
  s_cbranch_vccz ch_wr2_ok
  s_sleep 8
  s_add_u32 s30, s30, 1
  s_cmp_lt_u32 s30, 400000
  s_cbranch_scc1 ch_wr2
  s_branch cA_abort
ch_wr2_ok:
  s_lshl_b32 s27, s17, 7
  s_add_u32 s27, s27, 584192
  s_mov_b32 s28, 12384
  s_mov_b32 s30, 0
ch_wb2:
  buffer_load_dword v9, off, s[8:11], s27  sc1
  s_waitcnt vmcnt(0)
  v_and_b32 v10, s28, v9
  v_cmp_ne_u32 vcc, s28, v10
  s_cbranch_vccz ch_wb2_ok
  s_sleep 3
  s_add_u32 s30, s30, 1
  s_cmp_lt_u32 s30, 400000
  s_cbranch_scc1 ch_wb2
  s_branch cA_abort
ch_wb2_ok:
  s_mov_b32 s29, 586240
  s_mov_b32 s28, 0xffff
  s_mov_b32 s30, 0
ch_wx2:
  buffer_load_dword v9, off, s[8:11], s29  sc1
  s_waitcnt vmcnt(0)
  v_and_b32 v10, s28, v9
  v_cmp_ne_u32 vcc, s28, v10
  s_cbranch_vccz ch_wx2_ok
  s_sleep 8
  s_add_u32 s30, s30, 1
  s_cmp_lt_u32 s30, 400000
  s_cbranch_scc1 ch_wx2
  s_branch cA_abort
ch_wx2_ok:
  s_add_u32 s22, s31, 286720
  buffer_load_dwordx4 a[224:227], v2, s[8:11], s22 offen offset:0 sc1
  buffer_load_dwordx4 a[228:231], v2, s[8:11], s22 offen offset:1024 sc1
  buffer_load_dwordx4 a[232:235], v2, s[8:11], s22 offen offset:2048 sc1
  buffer_load_dwordx4 a[236:239], v2, s[8:11], s22 offen offset:3072 sc1
  s_add_u32 s22, s31, 290816
  buffer_load_dwordx4 a[240:243], v2, s[8:11], s22 offen offset:0 sc1
  buffer_load_dwordx4 a[244:247], v2, s[8:11], s22 offen offset:1024 sc1
  buffer_load_dwordx4 a[248:251], v2, s[8:11], s22 offen offset:2048 sc1
  buffer_load_dwordx4 a[252:255], v2, s[8:11], s22 offen offset:3072 sc1
  s_add_u32 s22, s31, 294912
  buffer_load_dwordx4 v[120:123], v2, s[8:11], s22 offen offset:0 sc1
  buffer_load_dwordx4 v[124:127], v2, s[8:11], s22 offen offset:1024 sc1
  buffer_load_dwordx4 v[128:131], v2, s[8:11], s22 offen offset:2048 sc1
  buffer_load_dwordx4 v[132:135], v2, s[8:11], s22 offen offset:3072 sc1
  s_add_u32 s22, s31, 299008
  buffer_load_dwordx4 v[136:139], v2, s[8:11], s22 offen offset:0 sc1
  buffer_load_dwordx4 v[140:143], v2, s[8:11], s22 offen offset:1024 sc1
  buffer_load_dwordx4 v[144:147], v2, s[8:11], s22 offen offset:2048 sc1
  buffer_load_dwordx4 v[148:151], v2, s[8:11], s22 offen offset:3072 sc1
  s_add_u32 s22, s31, 303104
  buffer_load_dwordx4 v[152:155], v2, s[8:11], s22 offen offset:0 sc1
  buffer_load_dwordx4 v[156:159], v2, s[8:11], s22 offen offset:1024 sc1
  buffer_load_dwordx4 v[160:163], v2, s[8:11], s22 offen offset:2048 sc1
  buffer_load_dwordx4 v[164:167], v2, s[8:11], s22 offen offset:3072 sc1
  s_add_u32 s22, s31, 307200
  buffer_load_dwordx4 v[168:171], v2, s[8:11], s22 offen offset:0 sc1
  buffer_load_dwordx4 v[172:175], v2, s[8:11], s22 offen offset:1024 sc1
  buffer_load_dwordx4 v[176:179], v2, s[8:11], s22 offen offset:2048 sc1
  buffer_load_dwordx4 v[180:183], v2, s[8:11], s22 offen offset:3072 sc1
  s_mov_b32 s24, 659456
  s_mov_b32 s26, 673792
  v_and_b32 v64, 7, v117
  v_and_b32 v65, 1, v116
  v_lshlrev_b32 v65, 2, v65
  v_sub_u32 v64, v64, v65
  v_lshrrev_b32 v65, 3, v117
  v_lshl_add_u32 v66, v65, 2, v64
  v_cmp_gt_u32 vcc, 4, v64
  v_mov_b32 v67, 99
  s_nop 0
  v_cndmask_b32 v66, v67, v66, vcc
  v_mov_b32 v68, 0x3f80
  v_mov_b32 v69, 0x3f800000
  v_mov_b32 v4, 0
  v_cmp_eq_u32 vcc, 0, v66
  s_nop 1
  v_cndmask_b32 v4, v4, v68, vcc
  v_cmp_eq_u32 vcc, 1, v66
  s_nop 1
  v_cndmask_b32 v4, v4, v69, vcc
  v_mov_b32 v5, 0
  v_cmp_eq_u32 vcc, 2, v66
  s_nop 1
  v_cndmask_b32 v5, v5, v68, vcc
  v_cmp_eq_u32 vcc, 3, v66
  s_nop 1
  v_cndmask_b32 v5, v5, v69, vcc
  v_mov_b32 v6, 0
  v_cmp_eq_u32 vcc, 4, v66
  s_nop 1
  v_cndmask_b32 v6, v6, v68, vcc
  v_cmp_eq_u32 vcc, 5, v66
  s_nop 1
  v_cndmask_b32 v6, v6, v69, vcc
  v_mov_b32 v7, 0
  v_cmp_eq_u32 vcc, 6, v66
  s_nop 1
  v_cndmask_b32 v7, v7, v68, vcc
  v_cmp_eq_u32 vcc, 7, v66
  s_nop 1
  v_cndmask_b32 v7, v7, v69, vcc
  v_lshrrev_b32 v64, 1, v116
  v_lshrrev_b32 v65, 3, v117
  v_and_b32 v66, 1, v116
  v_and_b32 v68, 7, v117
  v_lshlrev_b32 v67, 8, v65
  v_lshl_add_u32 v67, v68, 5, v67
  v_lshl_add_u32 v67, v66, 4, v67
  v_add_u32 v69, 5184, v67
  v_add_u32 v70, 6400, v67
  v_cmp_eq_u32 vcc, v64, v65
  s_nop 1
  v_cndmask_b32 v113, v70, v69, vcc
  s_lshl_b32 s22, s17, 9
  s_add_u32 s22, s22, 9216
  v_lshl_add_u32 v114, v1, 3, s22
  s_lshr_b32 s22, s17, 1
  s_lshl_b32 s22, s22, 8
  s_and_b32 s27, s17, 1
  s_lshl_b32 s27, s27, 3
  s_add_u32 s22, s22, s27
  s_add_u32 s22, s22, 7168
  v_add_u32 v115, s22, v2
  v_mov_b32 v70, 0x40000000
  v_cmp_gt_u32 vcc, 16, v1
  s_nop 1
  v_cndmask_b32 v115, v70, v115, vcc
  v_mov_b32 v118, -1
  v_mov_b32 v119, -1
  v_and_b32 v0, 15, v1
  s_and_b32 s22, s17, 0
  s_lshl_b32 s22, s22, 7
  s_add_u32 s22, s22, 37376
  v_lshl_add_u32 v0, v0, 2, s22
  v_xor_b32 v69, 256, v2
  v_mul_i32_i24 v70, -2048, v66
  v_add_u32 v69, v69, v70
  v_add_u32 v117, 8192, v69
  v_mov_b32 v116, v73
  s_mul_i32 s35, s17, 28672
  s_add_u32 s35, s35, 4325376
  v_mov_b32 v36, 0
  v_mov_b32 v37, 0
  v_mov_b32 v38, 0
  v_mov_b32 v39, 0
  v_mov_b32 v40, 0
  v_mov_b32 v41, 0
  v_mov_b32 v42, 0
  v_mov_b32 v43, 0
  v_mov_b32 v44, 0
  v_mov_b32 v45, 0
  v_mov_b32 v46, 0
  v_mov_b32 v47, 0
  v_mov_b32 v48, 0
  v_mov_b32 v49, 0
  v_mov_b32 v50, 0
  v_mov_b32 v51, 0
  v_mov_b32 v52, 0
  v_mov_b32 v53, 0
  v_mov_b32 v54, 0
  v_mov_b32 v55, 0
  v_mov_b32 v56, 0
  v_mov_b32 v57, 0
  v_mov_b32 v58, 0
  v_mov_b32 v59, 0
  v_mov_b32 v60, 0
  v_mov_b32 v61, 0
  v_mov_b32 v62, 0
  v_mov_b32 v63, 0
  v_mov_b32 v64, 0
  v_mov_b32 v65, 0
  v_mov_b32 v66, 0
  v_mov_b32 v67, 0
  v_mov_b32 v68, 0
  v_mov_b32 v69, 0
  v_mov_b32 v70, 0
  v_mov_b32 v71, 0
  v_mov_b32 v72, 0
  v_mov_b32 v73, 0
  v_mov_b32 v74, 0
  v_mov_b32 v75, 0
  v_mov_b32 v76, 0
  v_mov_b32 v77, 0
  v_mov_b32 v78, 0
  v_mov_b32 v79, 0
  s_mov_b32 s22, 0
  v_lshrrev_b32 v14, 4, v2
  v_add_u32 v14, 128, v14
  v_min_u32 v14, 308, v14
  v_lshlrev_b32 v14, 7, v14
  buffer_load_dword v15, v14, s[8:11], s22 offen sc1
  buffer_load_dwordx4 v[80:83], v117, s[8:11], s24 offen offset:0 sc1
  buffer_load_dwordx4 v[84:87], v117, s[8:11], s24 offen offset:1024 sc1
  buffer_load_dwordx4 v[88:91], v117, s[8:11], s26 offen offset:0 sc1
  buffer_load_dwordx4 v[92:95], v117, s[8:11], s26 offen offset:1024 sc1
  buffer_load_dwordx4 v[96:99], v2, s[8:11], s24 offen offset:0 sc1
  buffer_load_dwordx4 v[100:103], v2, s[8:11], s24 offen offset:1024 sc1
  buffer_load_dwordx4 v[104:107], v2, s[8:11], s26 offen offset:0 sc1
  buffer_load_dwordx4 v[108:111], v2, s[8:11], s26 offen offset:1024 sc1
  s_add_u32 s22, s31, 311296
  buffer_load_dwordx4 v[184:187], v2, s[8:11], s22 offen offset:0 sc1
  buffer_load_dwordx4 v[188:191], v2, s[8:11], s22 offen offset:1024 sc1
  buffer_load_dwordx4 v[192:195], v2, s[8:11], s22 offen offset:2048 sc1
  buffer_load_dwordx4 v[196:199], v2, s[8:11], s22 offen offset:3072 sc1
  s_add_u32 s22, s31, 385024
  buffer_load_dwordx4 v[200:203], v2, s[8:11], s22 offen offset:2048 sc1
  buffer_load_dwordx4 v[204:207], v2, s[8:11], s22 offen offset:3072 sc1
  s_add_u32 s22, s31, 389120
  buffer_load_dwordx4 v[208:211], v2, s[8:11], s22 offen offset:0 sc1
  buffer_load_dwordx4 v[212:215], v2, s[8:11], s22 offen offset:1024 sc1
  buffer_load_dwordx4 v[216:219], v2, s[8:11], s22 offen offset:2048 sc1
  buffer_load_dwordx4 v[220:223], v2, s[8:11], s22 offen offset:3072 sc1
  s_add_u32 s22, s31, 393216
  buffer_load_dwordx4 v[224:227], v2, s[8:11], s22 offen offset:0 sc1
  buffer_load_dwordx4 v[228:231], v2, s[8:11], s22 offen offset:1024 sc1
  buffer_load_dwordx4 v[232:235], v2, s[8:11], s22 offen offset:2048 sc1
  buffer_load_dwordx4 v[236:239], v2, s[8:11], s22 offen offset:3072 sc1
  s_add_u32 s22, s31, 397312
  buffer_load_dwordx4 v[240:243], v2, s[8:11], s22 offen offset:0 sc1
  buffer_load_dwordx4 v[244:247], v2, s[8:11], s22 offen offset:1024 sc1
  buffer_load_dwordx4 v[248:251], v2, s[8:11], s22 offen offset:2048 sc1
  buffer_load_dwordx4 v[252:255], v2, s[8:11], s22 offen offset:3072 sc1
  s_waitcnt vmcnt(0) lgkmcnt(0)
  s_mov_b32 s31, 0
  s_cmp_lg_u32 s88, 0
  s_cbranch_scc1 cB_sc2_loop
  s_branch cA_sc2_loop
ch_init3:
  s_mul_i32 s31, s17, 401408
  s_add_u32 s31, s31, 33554432
  s_and_b32 s28, s84, 12384
  s_lshl_b32 s22, s85, 16
  s_or_b32 s28, s28, s22
  s_cmp_eq_u32 s28, 4294914144
  s_cbranch_scc1 ch_wx3_ok
  s_mov_b32 s30, 0
ch_wr3:
  buffer_load_dword v9, off, s[12:15], 0 offset:132 sc1
  s_waitcnt vmcnt(0)
  v_cmp_ne_u32 vcc, 1, v9
  s_cbranch_vccz ch_wr3_ok
  s_sleep 8
  s_add_u32 s30, s30, 1
  s_cmp_lt_u32 s30, 400000
  s_cbranch_scc1 ch_wr3
  s_branch cA_abort
ch_wr3_ok:
  s_lshl_b32 s27, s17, 7
  s_add_u32 s27, s27, 584192
  s_mov_b32 s28, 12384
  s_mov_b32 s30, 0
ch_wb3:
  buffer_load_dword v9, off, s[8:11], s27  sc1
  s_waitcnt vmcnt(0)
  v_and_b32 v10, s28, v9
  v_cmp_ne_u32 vcc, s28, v10
  s_cbranch_vccz ch_wb3_ok
  s_sleep 3
  s_add_u32 s30, s30, 1
  s_cmp_lt_u32 s30, 400000
  s_cbranch_scc1 ch_wb3
  s_branch cA_abort
ch_wb3_ok:
  s_mov_b32 s29, 586240
  s_mov_b32 s28, 0xffff
  s_mov_b32 s30, 0
ch_wx3:
  buffer_load_dword v9, off, s[8:11], s29  sc1
  s_waitcnt vmcnt(0)
  v_and_b32 v10, s28, v9
  v_cmp_ne_u32 vcc, s28, v10
  s_cbranch_vccz ch_wx3_ok
  s_sleep 8
  s_add_u32 s30, s30, 1
  s_cmp_lt_u32 s30, 400000
  s_cbranch_scc1 ch_wx3
  s_branch cA_abort
ch_wx3_ok:
  s_add_u32 s22, s31, 315392
  buffer_load_dwordx4 a[224:227], v2, s[8:11], s22 offen offset:0 sc1
  buffer_load_dwordx4 a[228:231], v2, s[8:11], s22 offen offset:1024 sc1
  buffer_load_dwordx4 a[232:235], v2, s[8:11], s22 offen offset:2048 sc1
  buffer_load_dwordx4 a[236:239], v2, s[8:11], s22 offen offset:3072 sc1
  s_add_u32 s22, s31, 319488
  buffer_load_dwordx4 a[240:243], v2, s[8:11], s22 offen offset:0 sc1
  buffer_load_dwordx4 a[244:247], v2, s[8:11], s22 offen offset:1024 sc1
  buffer_load_dwordx4 a[248:251], v2, s[8:11], s22 offen offset:2048 sc1
  buffer_load_dwordx4 a[252:255], v2, s[8:11], s22 offen offset:3072 sc1
  s_add_u32 s22, s31, 323584
  buffer_load_dwordx4 v[120:123], v2, s[8:11], s22 offen offset:0 sc1
  buffer_load_dwordx4 v[124:127], v2, s[8:11], s22 offen offset:1024 sc1
  buffer_load_dwordx4 v[128:131], v2, s[8:11], s22 offen offset:2048 sc1
  buffer_load_dwordx4 v[132:135], v2, s[8:11], s22 offen offset:3072 sc1
  s_add_u32 s22, s31, 327680
  buffer_load_dwordx4 v[136:139], v2, s[8:11], s22 offen offset:0 sc1
  buffer_load_dwordx4 v[140:143], v2, s[8:11], s22 offen offset:1024 sc1
  buffer_load_dwordx4 v[144:147], v2, s[8:11], s22 offen offset:2048 sc1
  buffer_load_dwordx4 v[148:151], v2, s[8:11], s22 offen offset:3072 sc1
  s_add_u32 s22, s31, 331776
  buffer_load_dwordx4 v[152:155], v2, s[8:11], s22 offen offset:0 sc1
  buffer_load_dwordx4 v[156:159], v2, s[8:11], s22 offen offset:1024 sc1
  buffer_load_dwordx4 v[160:163], v2, s[8:11], s22 offen offset:2048 sc1
  buffer_load_dwordx4 v[164:167], v2, s[8:11], s22 offen offset:3072 sc1
  s_add_u32 s22, s31, 335872
  buffer_load_dwordx4 v[168:171], v2, s[8:11], s22 offen offset:0 sc1
  buffer_load_dwordx4 v[172:175], v2, s[8:11], s22 offen offset:1024 sc1
  buffer_load_dwordx4 v[176:179], v2, s[8:11], s22 offen offset:2048 sc1
  buffer_load_dwordx4 v[180:183], v2, s[8:11], s22 offen offset:3072 sc1
  s_mov_b32 s24, 661504
  s_mov_b32 s26, 675840
  v_and_b32 v64, 7, v117
  v_and_b32 v65, 1, v116
  v_lshlrev_b32 v65, 2, v65
  v_sub_u32 v64, v64, v65
  v_lshrrev_b32 v65, 3, v117
  v_lshl_add_u32 v66, v65, 2, v64
  v_cmp_gt_u32 vcc, 4, v64
  v_mov_b32 v67, 99
  s_nop 0
  v_cndmask_b32 v66, v67, v66, vcc
  v_mov_b32 v68, 0x3f80
  v_mov_b32 v69, 0x3f800000
  v_mov_b32 v4, 0
  v_cmp_eq_u32 vcc, 0, v66
  s_nop 1
  v_cndmask_b32 v4, v4, v68, vcc
  v_cmp_eq_u32 vcc, 1, v66
  s_nop 1
  v_cndmask_b32 v4, v4, v69, vcc
  v_mov_b32 v5, 0
  v_cmp_eq_u32 vcc, 2, v66
  s_nop 1
  v_cndmask_b32 v5, v5, v68, vcc
  v_cmp_eq_u32 vcc, 3, v66
  s_nop 1
  v_cndmask_b32 v5, v5, v69, vcc
  v_mov_b32 v6, 0
  v_cmp_eq_u32 vcc, 4, v66
  s_nop 1
  v_cndmask_b32 v6, v6, v68, vcc
  v_cmp_eq_u32 vcc, 5, v66
  s_nop 1
  v_cndmask_b32 v6, v6, v69, vcc
  v_mov_b32 v7, 0
  v_cmp_eq_u32 vcc, 6, v66
  s_nop 1
  v_cndmask_b32 v7, v7, v68, vcc
  v_cmp_eq_u32 vcc, 7, v66
  s_nop 1
  v_cndmask_b32 v7, v7, v69, vcc
  v_lshrrev_b32 v64, 1, v116
  v_lshrrev_b32 v65, 3, v117
  v_and_b32 v66, 1, v116
  v_and_b32 v68, 7, v117
  v_lshlrev_b32 v67, 8, v65
  v_lshl_add_u32 v67, v68, 5, v67
  v_lshl_add_u32 v67, v66, 4, v67
  v_add_u32 v69, 5696, v67
  v_add_u32 v70, 6400, v67
  v_cmp_eq_u32 vcc, v64, v65
  s_nop 1
  v_cndmask_b32 v113, v70, v69, vcc
  v_and_b32 v0, 15, v1
  s_and_b32 s22, s17, 0
  s_lshl_b32 s22, s22, 7
  s_add_u32 s22, s22, 37376
  v_lshl_add_u32 v0, v0, 2, s22
  v_xor_b32 v69, 256, v2
  v_mul_i32_i24 v70, 2048, v66
  v_add_u32 v69, v69, v70
  v_add_u32 v117, 4096, v69
  v_mov_b32 v116, v73
  s_mul_i32 s35, s17, 28672
  s_add_u32 s35, s35, 4325376
  v_mov_b32 v36, 0
  v_mov_b32 v37, 0
  v_mov_b32 v38, 0
  v_mov_b32 v39, 0
  v_mov_b32 v40, 0
  v_mov_b32 v41, 0
  v_mov_b32 v42, 0
  v_mov_b32 v43, 0
  v_mov_b32 v44, 0
  v_mov_b32 v45, 0
  v_mov_b32 v46, 0
  v_mov_b32 v47, 0
  v_mov_b32 v48, 0
  v_mov_b32 v49, 0
  v_mov_b32 v50, 0
  v_mov_b32 v51, 0
  v_mov_b32 v52, 0
  v_mov_b32 v53, 0
  v_mov_b32 v54, 0
  v_mov_b32 v55, 0
  v_mov_b32 v56, 0
  v_mov_b32 v57, 0
  v_mov_b32 v58, 0
  v_mov_b32 v59, 0
  v_mov_b32 v60, 0
  v_mov_b32 v61, 0
  v_mov_b32 v62, 0
  v_mov_b32 v63, 0
  v_mov_b32 v64, 0
  v_mov_b32 v65, 0
  v_mov_b32 v66, 0
  v_mov_b32 v67, 0
  v_mov_b32 v68, 0
  v_mov_b32 v69, 0
  v_mov_b32 v70, 0
  v_mov_b32 v71, 0
  v_mov_b32 v72, 0
  v_mov_b32 v73, 0
  v_mov_b32 v74, 0
  v_mov_b32 v75, 0
  v_mov_b32 v76, 0
  v_mov_b32 v77, 0
  v_mov_b32 v78, 0
  v_mov_b32 v79, 0
  s_mov_b32 s22, 0
  v_lshrrev_b32 v14, 4, v2
  v_add_u32 v14, 192, v14
  v_min_u32 v14, 308, v14
  v_lshlrev_b32 v14, 7, v14
  buffer_load_dword v15, v14, s[8:11], s22 offen sc1
  buffer_load_dwordx4 v[80:83], v117, s[8:11], s24 offen offset:0 sc1
  buffer_load_dwordx4 v[84:87], v117, s[8:11], s24 offen offset:1024 sc1
  buffer_load_dwordx4 v[88:91], v117, s[8:11], s26 offen offset:0 sc1
  buffer_load_dwordx4 v[92:95], v117, s[8:11], s26 offen offset:1024 sc1
  buffer_load_dwordx4 v[96:99], v2, s[8:11], s24 offen offset:0 sc1
  buffer_load_dwordx4 v[100:103], v2, s[8:11], s24 offen offset:1024 sc1
  buffer_load_dwordx4 v[104:107], v2, s[8:11], s26 offen offset:0 sc1
  buffer_load_dwordx4 v[108:111], v2, s[8:11], s26 offen offset:1024 sc1
  s_add_u32 s22, s31, 339968
  buffer_load_dwordx4 v[184:187], v2, s[8:11], s22 offen offset:0 sc1
  buffer_load_dwordx4 v[188:191], v2, s[8:11], s22 offen offset:1024 sc1
  buffer_load_dwordx4 v[192:195], v2, s[8:11], s22 offen offset:2048 sc1
  buffer_load_dwordx4 v[196:199], v2, s[8:11], s22 offen offset:3072 sc1
  s_add_u32 s22, s31, 356352
  buffer_load_dwordx4 v[200:203], v2, s[8:11], s22 offen offset:2048 sc1
  buffer_load_dwordx4 v[204:207], v2, s[8:11], s22 offen offset:3072 sc1
  s_add_u32 s22, s31, 360448
  buffer_load_dwordx4 v[208:211], v2, s[8:11], s22 offen offset:0 sc1
  buffer_load_dwordx4 v[212:215], v2, s[8:11], s22 offen offset:1024 sc1
  buffer_load_dwordx4 v[216:219], v2, s[8:11], s22 offen offset:2048 sc1
  buffer_load_dwordx4 v[220:223], v2, s[8:11], s22 offen offset:3072 sc1
  s_add_u32 s22, s31, 364544
  buffer_load_dwordx4 v[224:227], v2, s[8:11], s22 offen offset:0 sc1
  buffer_load_dwordx4 v[228:231], v2, s[8:11], s22 offen offset:1024 sc1
  buffer_load_dwordx4 v[232:235], v2, s[8:11], s22 offen offset:2048 sc1
  buffer_load_dwordx4 v[236:239], v2, s[8:11], s22 offen offset:3072 sc1
  s_add_u32 s22, s31, 368640
  buffer_load_dwordx4 v[240:243], v2, s[8:11], s22 offen offset:0 sc1
  buffer_load_dwordx4 v[244:247], v2, s[8:11], s22 offen offset:1024 sc1
  buffer_load_dwordx4 v[248:251], v2, s[8:11], s22 offen offset:2048 sc1
  buffer_load_dwordx4 v[252:255], v2, s[8:11], s22 offen offset:3072 sc1
  s_waitcnt vmcnt(0) lgkmcnt(0)
  s_mov_b32 s31, 0
  s_cmp_lg_u32 s88, 0
  s_cbranch_scc1 cB_sc3_loop
  s_branch cA_sc3_loop
ch_init4:
  v_mov_b32 v72, v116
  v_mov_b32 v73, v117
  v_lshrrev_b32 v65, 1, v72
  v_and_b32 v66, 1, v72
  v_mov_b32 v36, 0
  v_mov_b32 v37, 0
  v_mov_b32 v38, 0
  v_mov_b32 v39, 0
  v_mov_b32 v40, 0
  v_mov_b32 v41, 0
  v_mov_b32 v42, 0
  v_mov_b32 v43, 0
  v_mov_b32 v44, 0
  v_mov_b32 v45, 0
  v_mov_b32 v46, 0
  v_mov_b32 v47, 0
  v_mov_b32 v48, 0
  v_mov_b32 v49, 0
  v_mov_b32 v50, 0
  v_mov_b32 v51, 0
  v_mov_b32 v52, 0
  v_mov_b32 v53, 0
  v_mov_b32 v54, 0
  v_mov_b32 v55, 0
  v_mov_b32 v56, 0
  v_mov_b32 v57, 0
  v_mov_b32 v58, 0
  v_mov_b32 v59, 0
  v_mov_b32 v60, 0
  v_mov_b32 v61, 0
  v_mov_b32 v62, 0
  v_mov_b32 v63, 0
  v_lshlrev_b32 v75, 2, v65
  v_lshl_add_u32 v75, v66, 3, v75
  v_add_u32 v67, 0, v73
  v_mul_u32_u24 v68, 2341, v67
  v_lshrrev_b32 v68, 16, v68
  v_mul_u32_u24 v69, 28, v68
  v_sub_u32 v69, v67, v69
  v_lshrrev_b32 v70, 4, v69
  v_and_b32 v69, 15, v69
  v_lshlrev_b32 v71, 12, v70
  v_lshl_add_u32 v71, v68, 8, v71
  v_lshl_add_u32 v71, v69, 4, v71
  v_add_u32 v152, v71, v75
  v_add_u32 v67, 16, v73
  v_mul_u32_u24 v68, 2341, v67
  v_lshrrev_b32 v68, 16, v68
  v_mul_u32_u24 v69, 28, v68
  v_sub_u32 v69, v67, v69
  v_lshrrev_b32 v70, 4, v69
  v_and_b32 v69, 15, v69
  v_lshlrev_b32 v71, 12, v70
  v_lshl_add_u32 v71, v68, 8, v71
  v_lshl_add_u32 v71, v69, 4, v71
  v_add_u32 v153, v71, v75
  v_add_u32 v67, 32, v73
  v_mul_u32_u24 v68, 2341, v67
  v_lshrrev_b32 v68, 16, v68
  v_mul_u32_u24 v69, 28, v68
  v_sub_u32 v69, v67, v69
  v_lshrrev_b32 v70, 4, v69
  v_and_b32 v69, 15, v69
  v_lshlrev_b32 v71, 12, v70
  v_lshl_add_u32 v71, v68, 8, v71
  v_lshl_add_u32 v71, v69, 4, v71
  v_add_u32 v154, v71, v75
  v_add_u32 v67, 48, v73
  v_mul_u32_u24 v68, 2341, v67
  v_lshrrev_b32 v68, 16, v68
  v_mul_u32_u24 v69, 28, v68
  v_sub_u32 v69, v67, v69
  v_lshrrev_b32 v70, 4, v69
  v_and_b32 v69, 15, v69
  v_lshlrev_b32 v71, 12, v70
  v_lshl_add_u32 v71, v68, 8, v71
  v_lshl_add_u32 v71, v69, 4, v71
  v_add_u32 v155, v71, v75
  v_add_u32 v67, 64, v73
  v_mul_u32_u24 v68, 2341, v67
  v_lshrrev_b32 v68, 16, v68
  v_mul_u32_u24 v69, 28, v68
  v_sub_u32 v69, v67, v69
  v_lshrrev_b32 v70, 4, v69
  v_and_b32 v69, 15, v69
  v_lshlrev_b32 v71, 12, v70
  v_lshl_add_u32 v71, v68, 8, v71
  v_lshl_add_u32 v71, v69, 4, v71
  v_add_u32 v156, v71, v75
  v_add_u32 v67, 80, v73
  v_mul_u32_u24 v68, 2341, v67
  v_lshrrev_b32 v68, 16, v68
  v_mul_u32_u24 v69, 28, v68
  v_sub_u32 v69, v67, v69
  v_lshrrev_b32 v70, 4, v69
  v_and_b32 v69, 15, v69
  v_lshlrev_b32 v71, 12, v70
  v_lshl_add_u32 v71, v68, 8, v71
  v_lshl_add_u32 v71, v69, 4, v71
  v_add_u32 v157, v71, v75
  v_mov_b32 v74, 0x40000000
  v_mov_b32 v164, 0
  v_mov_b32 v76, 0
  v_mov_b32 v77, 0
  v_mov_b32 v78, 0
  v_mov_b32 v79, 0
  ds_write_b128 v2, v[76:79] offset:0
  ds_write_b128 v2, v[76:79] offset:1024
  ds_write_b128 v2, v[76:79] offset:2048
  ds_write_b128 v2, v[76:79] offset:3072
  s_and_b32 s22, s17, 0
  s_lshl_b32 s22, s22, 7
  s_add_u32 s22, s22, 35328
  v_lshl_add_u32 v4, v73, 2, s22
  v_and_b32 v64, 1, v73
  v_mov_b32 v5, 0x05040100
  v_mov_b32 v65, 0x03020706
  v_cmp_eq_u32 vcc, 1, v64
  s_nop 1
  v_cndmask_b32 v5, v5, v65, vcc
  s_lshl_b32 s22, s17, 2
  s_add_u32 s22, s22, 37376
  v_lshl_add_u32 v7, v1, 7, s22
  v_cmp_gt_u32 vcc, 1, v1
  s_nop 1
  v_cndmask_b32 v7, v74, v7, vcc
  v_mov_b32 v6, v2
  v_lshl_add_u32 v64, v66, 2, v64
  v_and_b32 v65, 2, v72
  v_add_u32 v64, v64, v65
  s_mul_i32 s22, s17, 16
  v_add_u32 v75, s22, v73
  v_lshrrev_b32 v68, 4, v75
  v_lshlrev_b32 v68, 8, v68
  v_bfe_u32 v69, v75, 1, 1
  v_lshl_add_u32 v68, v69, 7, v68
  v_lshl_add_u32 v68, v64, 4, v68
  v_and_b32 v69, 12, v75
  v_add_u32 v1, v68, v69
  s_mul_i32 s22, s17, 28672
  s_add_u32 s25, s22, 2490368
  s_and_b32 s27, s17, 3
  s_xor_b32 s22, s27, 0
  s_mul_i32 s80, s22, 7168
  s_lshl_b32 s22, s22, 11
  s_add_u32 s76, s22, 9216
  s_xor_b32 s22, s27, 1
  s_mul_i32 s81, s22, 7168
  s_lshl_b32 s22, s22, 11
  s_add_u32 s77, s22, 9216
  s_xor_b32 s22, s27, 2
  s_mul_i32 s82, s22, 7168
  s_lshl_b32 s22, s22, 11
  s_add_u32 s78, s22, 9216
  s_xor_b32 s22, s27, 3
  s_mul_i32 s83, s22, 7168
  s_lshl_b32 s22, s22, 11
  s_add_u32 s79, s22, 9216
  v_mov_b32 v162, -1
  s_mov_b32 s38, 0x40000000
  s_mul_i32 s31, s17, 401408
  s_add_u32 s31, s31, 39976960
  s_mov_b32 s30, 0
ch_wr4:
  buffer_load_dword v9, off, s[12:15], 0 offset:128 sc1
  s_waitcnt vmcnt(0)
  v_cmp_ne_u32 vcc, 1, v9
  s_cbranch_vccz ch_wr4_ok
  s_sleep 8
  s_add_u32 s30, s30, 1
  s_cmp_lt_u32 s30, 400000
  s_cbranch_scc1 ch_wr4
  s_branch cA_abort
ch_wr4_ok:
  s_lshr_b32 s22, s17, 2
  s_lshl_b32 s28, 0x81, s22
  s_mul_i32 s27, s17, 12
  s_add_u32 s22, s27, 256
  s_lshr_b32 s22, s22, 6
  s_lshl_b32 s22, 0x81, s22
  s_or_b32 s28, s28, s22
  s_add_u32 s22, s27, 267
  s_lshr_b32 s22, s22, 6
  s_lshl_b32 s22, 0x81, s22
  s_or_b32 s28, s28, s22
  v_lshrrev_b32 v12, 8, v2
  v_lshlrev_b32 v12, 7, v12
  s_mov_b32 s27, 582144
  s_mov_b32 s30, 0
ch_ww4:
  buffer_load_dword v9, v12, s[8:11], s27 offen sc1
  s_waitcnt vmcnt(0)
  v_and_b32 v10, s28, v9
  v_cmp_ne_u32 vcc, s28, v10
  s_cbranch_vccz ch_ww4_ok
  s_sleep 3
  s_add_u32 s30, s30, 1
  s_cmp_lt_u32 s30, 400000
  s_cbranch_scc1 ch_ww4
  s_branch cA_abort
ch_ww4_ok:
  s_add_u32 s22, s31, 0
  buffer_load_dwordx4 a[0:3], v2, s[8:11], s22 offen offset:0 sc1
  buffer_load_dwordx4 a[4:7], v2, s[8:11], s22 offen offset:1024 sc1
  buffer_load_dwordx4 a[8:11], v2, s[8:11], s22 offen offset:2048 sc1
  buffer_load_dwordx4 a[12:15], v2, s[8:11], s22 offen offset:3072 sc1
  s_add_u32 s22, s31, 4096
  buffer_load_dwordx4 a[16:19], v2, s[8:11], s22 offen offset:0 sc1
  buffer_load_dwordx4 a[20:23], v2, s[8:11], s22 offen offset:1024 sc1
  buffer_load_dwordx4 a[24:27], v2, s[8:11], s22 offen offset:2048 sc1
  buffer_load_dwordx4 a[28:31], v2, s[8:11], s22 offen offset:3072 sc1
  s_add_u32 s22, s31, 8192
  buffer_load_dwordx4 a[32:35], v2, s[8:11], s22 offen offset:0 sc1
  buffer_load_dwordx4 a[36:39], v2, s[8:11], s22 offen offset:1024 sc1
  buffer_load_dwordx4 a[40:43], v2, s[8:11], s22 offen offset:2048 sc1
  buffer_load_dwordx4 a[44:47], v2, s[8:11], s22 offen offset:3072 sc1
  s_add_u32 s22, s31, 12288
  buffer_load_dwordx4 a[48:51], v2, s[8:11], s22 offen offset:0 sc1
  buffer_load_dwordx4 a[52:55], v2, s[8:11], s22 offen offset:1024 sc1
  buffer_load_dwordx4 a[56:59], v2, s[8:11], s22 offen offset:2048 sc1
  buffer_load_dwordx4 a[60:63], v2, s[8:11], s22 offen offset:3072 sc1
  s_add_u32 s22, s31, 16384
  buffer_load_dwordx4 a[64:67], v2, s[8:11], s22 offen offset:0 sc1
  buffer_load_dwordx4 a[68:71], v2, s[8:11], s22 offen offset:1024 sc1
  buffer_load_dwordx4 a[72:75], v2, s[8:11], s22 offen offset:2048 sc1
  buffer_load_dwordx4 a[76:79], v2, s[8:11], s22 offen offset:3072 sc1
  s_add_u32 s22, s31, 20480
  buffer_load_dwordx4 a[80:83], v2, s[8:11], s22 offen offset:0 sc1
  buffer_load_dwordx4 a[84:87], v2, s[8:11], s22 offen offset:1024 sc1
  buffer_load_dwordx4 a[88:91], v2, s[8:11], s22 offen offset:2048 sc1
  buffer_load_dwordx4 a[92:95], v2, s[8:11], s22 offen offset:3072 sc1
  s_add_u32 s22, s31, 24576
  buffer_load_dwordx4 a[96:99], v2, s[8:11], s22 offen offset:0 sc1
  buffer_load_dwordx4 a[100:103], v2, s[8:11], s22 offen offset:1024 sc1
  buffer_load_dwordx4 a[104:107], v2, s[8:11], s22 offen offset:2048 sc1
  buffer_load_dwordx4 a[108:111], v2, s[8:11], s22 offen offset:3072 sc1
  s_add_u32 s22, s31, 28672
  buffer_load_dwordx4 a[112:115], v2, s[8:11], s22 offen offset:0 sc1
  buffer_load_dwordx4 a[116:119], v2, s[8:11], s22 offen offset:1024 sc1
  buffer_load_dwordx4 a[120:123], v2, s[8:11], s22 offen offset:2048 sc1
  buffer_load_dwordx4 a[124:127], v2, s[8:11], s22 offen offset:3072 sc1
  s_waitcnt vmcnt(24)
  s_add_u32 s22, s31, 32768
  buffer_load_dwordx4 a[128:131], v2, s[8:11], s22 offen offset:0 sc1
  buffer_load_dwordx4 a[132:135], v2, s[8:11], s22 offen offset:1024 sc1
  buffer_load_dwordx4 a[136:139], v2, s[8:11], s22 offen offset:2048 sc1
  buffer_load_dwordx4 a[140:143], v2, s[8:11], s22 offen offset:3072 sc1
  s_add_u32 s22, s31, 36864
  buffer_load_dwordx4 a[144:147], v2, s[8:11], s22 offen offset:0 sc1
  buffer_load_dwordx4 a[148:151], v2, s[8:11], s22 offen offset:1024 sc1
  buffer_load_dwordx4 a[152:155], v2, s[8:11], s22 offen offset:2048 sc1
  buffer_load_dwordx4 a[156:159], v2, s[8:11], s22 offen offset:3072 sc1
  s_add_u32 s22, s31, 40960
  buffer_load_dwordx4 a[160:163], v2, s[8:11], s22 offen offset:0 sc1
  buffer_load_dwordx4 a[164:167], v2, s[8:11], s22 offen offset:1024 sc1
  buffer_load_dwordx4 a[168:171], v2, s[8:11], s22 offen offset:2048 sc1
  buffer_load_dwordx4 a[172:175], v2, s[8:11], s22 offen offset:3072 sc1
  s_add_u32 s22, s31, 45056
  buffer_load_dwordx4 a[176:179], v2, s[8:11], s22 offen offset:0 sc1
  buffer_load_dwordx4 a[180:183], v2, s[8:11], s22 offen offset:1024 sc1
  buffer_load_dwordx4 a[184:187], v2, s[8:11], s22 offen offset:2048 sc1
  buffer_load_dwordx4 a[188:191], v2, s[8:11], s22 offen offset:3072 sc1
  s_add_u32 s22, s31, 49152
  buffer_load_dwordx4 a[192:195], v2, s[8:11], s22 offen offset:0 sc1
  buffer_load_dwordx4 a[196:199], v2, s[8:11], s22 offen offset:1024 sc1
  buffer_load_dwordx4 a[200:203], v2, s[8:11], s22 offen offset:2048 sc1
  buffer_load_dwordx4 a[204:207], v2, s[8:11], s22 offen offset:3072 sc1
  s_add_u32 s22, s31, 53248
  buffer_load_dwordx4 a[208:211], v2, s[8:11], s22 offen offset:0 sc1
  buffer_load_dwordx4 a[212:215], v2, s[8:11], s22 offen offset:1024 sc1
  buffer_load_dwordx4 a[216:219], v2, s[8:11], s22 offen offset:2048 sc1
  buffer_load_dwordx4 a[220:223], v2, s[8:11], s22 offen offset:3072 sc1
  s_add_u32 s22, s31, 57344
  buffer_load_dwordx4 a[224:227], v2, s[8:11], s22 offen offset:0 sc1
  buffer_load_dwordx4 a[228:231], v2, s[8:11], s22 offen offset:1024 sc1
  buffer_load_dwordx4 a[232:235], v2, s[8:11], s22 offen offset:2048 sc1
  buffer_load_dwordx4 a[236:239], v2, s[8:11], s22 offen offset:3072 sc1
  s_add_u32 s22, s31, 61440
  buffer_load_dwordx4 a[240:243], v2, s[8:11], s22 offen offset:0 sc1
  buffer_load_dwordx4 a[244:247], v2, s[8:11], s22 offen offset:1024 sc1
  buffer_load_dwordx4 a[248:251], v2, s[8:11], s22 offen offset:2048 sc1
  buffer_load_dwordx4 a[252:255], v2, s[8:11], s22 offen offset:3072 sc1
  s_waitcnt vmcnt(24)
  s_add_u32 s22, s31, 65536
  buffer_load_dwordx4 v[176:179], v2, s[8:11], s22 offen offset:0 sc1
  buffer_load_dwordx4 v[180:183], v2, s[8:11], s22 offen offset:1024 sc1
  buffer_load_dwordx4 v[184:187], v2, s[8:11], s22 offen offset:2048 sc1
  buffer_load_dwordx4 v[188:191], v2, s[8:11], s22 offen offset:3072 sc1
  s_add_u32 s22, s31, 69632
  buffer_load_dwordx4 v[192:195], v2, s[8:11], s22 offen offset:0 sc1
  buffer_load_dwordx4 v[196:199], v2, s[8:11], s22 offen offset:1024 sc1
  buffer_load_dwordx4 v[200:203], v2, s[8:11], s22 offen offset:2048 sc1
  buffer_load_dwordx4 v[204:207], v2, s[8:11], s22 offen offset:3072 sc1
  s_add_u32 s22, s31, 73728
  buffer_load_dwordx4 v[208:211], v2, s[8:11], s22 offen offset:0 sc1
  buffer_load_dwordx4 v[212:215], v2, s[8:11], s22 offen offset:1024 sc1
  buffer_load_dwordx4 v[216:219], v2, s[8:11], s22 offen offset:2048 sc1
  buffer_load_dwordx4 v[220:223], v2, s[8:11], s22 offen offset:3072 sc1
  s_add_u32 s22, s31, 77824
  buffer_load_dwordx4 v[224:227], v2, s[8:11], s22 offen offset:0 sc1
  buffer_load_dwordx4 v[228:231], v2, s[8:11], s22 offen offset:1024 sc1
  buffer_load_dwordx4 v[232:235], v2, s[8:11], s22 offen offset:2048 sc1
  buffer_load_dwordx4 v[236:239], v2, s[8:11], s22 offen offset:3072 sc1
  s_add_u32 s22, s31, 81920
  buffer_load_dwordx4 v[240:243], v2, s[8:11], s22 offen offset:0 sc1
  buffer_load_dwordx4 v[244:247], v2, s[8:11], s22 offen offset:1024 sc1
  buffer_load_dwordx4 v[248:251], v2, s[8:11], s22 offen offset:2048 sc1
  buffer_load_dwordx4 v[252:255], v2, s[8:11], s22 offen offset:3072 sc1
  s_mov_b32 m0, 16384
  s_add_u32 s22, s31, 86016
  buffer_load_dwordx4 v2, s[8:11], s22 offen offset:0 sc1 lds
  buffer_load_dwordx4 v2, s[8:11], s22 offen offset:1024 sc1 lds
  buffer_load_dwordx4 v2, s[8:11], s22 offen offset:2048 sc1 lds
  buffer_load_dwordx4 v2, s[8:11], s22 offen offset:3072 sc1 lds
  s_mov_b32 m0, 20480
  s_add_u32 s22, s31, 90112
  buffer_load_dwordx4 v2, s[8:11], s22 offen offset:0 sc1 lds
  buffer_load_dwordx4 v2, s[8:11], s22 offen offset:1024 sc1 lds
  buffer_load_dwordx4 v2, s[8:11], s22 offen offset:2048 sc1 lds
  buffer_load_dwordx4 v2, s[8:11], s22 offen offset:3072 sc1 lds
  s_mov_b32 m0, 24576
  s_add_u32 s22, s31, 94208
  buffer_load_dwordx4 v2, s[8:11], s22 offen offset:0 sc1 lds
  buffer_load_dwordx4 v2, s[8:11], s22 offen offset:1024 sc1 lds
  buffer_load_dwordx4 v2, s[8:11], s22 offen offset:2048 sc1 lds
  buffer_load_dwordx4 v2, s[8:11], s22 offen offset:3072 sc1 lds
  s_mov_b32 m0, 28672
  s_add_u32 s22, s31, 98304
  buffer_load_dwordx4 v2, s[8:11], s22 offen offset:0 sc1 lds
  buffer_load_dwordx4 v2, s[8:11], s22 offen offset:1024 sc1 lds
  s_mov_b32 s30, 0
ch_ws4:
  buffer_load_dword v9, off, s[12:15], 0 offset:132 sc1
  s_waitcnt vmcnt(0)
  v_cmp_ne_u32 vcc, 1, v9
  s_cbranch_vccz ch_ws4_ok
  s_sleep 8
  s_add_u32 s30, s30, 1
  s_cmp_lt_u32 s30, 400000
  s_cbranch_scc1 ch_ws4
  s_branch cA_abort
ch_ws4_ok:
  s_mul_i32 s33, s17, 532480
  s_add_u32 s33, s33, 78110720
  v_mov_b32 v12, -1
  v_mov_b32 v13, -1
  v_mov_b32 v14, -1
  v_mov_b32 v15, -1
  s_add_u32 s22, s33, 0
  buffer_store_dwordx4 v[12:15], v2, s[8:11], s22 offen sc1
  s_add_u32 s22, s33, 2048
  buffer_store_dwordx4 v[12:15], v2, s[8:11], s22 offen sc1
  s_add_u32 s22, s33, 4096
  buffer_store_dwordx4 v[12:15], v2, s[8:11], s22 offen sc1
  s_add_u32 s22, s33, 6144
  buffer_store_dwordx4 v[12:15], v2, s[8:11], s22 offen sc1
  s_add_u32 s22, s33, 8192
  buffer_store_dwordx4 v[12:15], v2, s[8:11], s22 offen sc1
  s_add_u32 s22, s33, 10240
  buffer_store_dwordx4 v[12:15], v2, s[8:11], s22 offen sc1
  s_add_u32 s22, s33, 12288
  buffer_store_dwordx4 v[12:15], v2, s[8:11], s22 offen sc1
  s_add_u32 s22, s33, 14336
  buffer_store_dwordx4 v[12:15], v2, s[8:11], s22 offen sc1
  v_mov_b32 v16, 1
  v_mov_b32 v17, 1
  s_lshl_b32 s22, s17, 10
  s_add_u32 s22, s22, 566240
  s_waitcnt vmcnt(0)
  s_mov_b64 exec, 3
  buffer_store_dwordx2 v[16:17], v2, s[8:11], s22 offen sc1
  s_mov_b64 exec, -1
  s_mov_b32 s28, s35
  s_waitcnt vmcnt(0) lgkmcnt(0)
  s_mov_b32 s31, 0
  s_cmp_lg_u32 s88, 0
  s_cbranch_scc1 cB_va0_loop
  s_branch cA_va0_loop
ch_init5:
  v_mov_b32 v72, v116
  v_mov_b32 v73, v117
  v_lshrrev_b32 v65, 1, v72
  v_and_b32 v66, 1, v72
  v_mov_b32 v36, 0
  v_mov_b32 v37, 0
  v_mov_b32 v38, 0
  v_mov_b32 v39, 0
  v_mov_b32 v40, 0
  v_mov_b32 v41, 0
  v_mov_b32 v42, 0
  v_mov_b32 v43, 0
  v_mov_b32 v44, 0
  v_mov_b32 v45, 0
  v_mov_b32 v46, 0
  v_mov_b32 v47, 0
  v_mov_b32 v48, 0
  v_mov_b32 v49, 0
  v_mov_b32 v50, 0
  v_mov_b32 v51, 0
  v_mov_b32 v52, 0
  v_mov_b32 v53, 0
  v_mov_b32 v54, 0
  v_mov_b32 v55, 0
  v_mov_b32 v56, 0
  v_mov_b32 v57, 0
  v_mov_b32 v58, 0
  v_mov_b32 v59, 0
  v_mov_b32 v60, 0
  v_mov_b32 v61, 0
  v_mov_b32 v62, 0
  v_mov_b32 v63, 0
  v_lshlrev_b32 v75, 2, v65
  v_lshl_add_u32 v75, v66, 3, v75
  v_add_u32 v67, 112, v73
  v_mul_u32_u24 v68, 2341, v67
  v_lshrrev_b32 v68, 16, v68
  v_mul_u32_u24 v69, 28, v68
  v_sub_u32 v69, v67, v69
  v_lshrrev_b32 v70, 4, v69
  v_and_b32 v69, 15, v69
  v_lshlrev_b32 v71, 12, v70
  v_lshl_add_u32 v71, v68, 8, v71
  v_lshl_add_u32 v71, v69, 4, v71
  v_add_u32 v152, v71, v75
  v_add_u32 v67, 128, v73
  v_mul_u32_u24 v68, 2341, v67
  v_lshrrev_b32 v68, 16, v68
  v_mul_u32_u24 v69, 28, v68
  v_sub_u32 v69, v67, v69
  v_lshrrev_b32 v70, 4, v69
  v_and_b32 v69, 15, v69
  v_lshlrev_b32 v71, 12, v70
  v_lshl_add_u32 v71, v68, 8, v71
  v_lshl_add_u32 v71, v69, 4, v71
  v_add_u32 v153, v71, v75
  v_add_u32 v67, 144, v73
  v_mul_u32_u24 v68, 2341, v67
  v_lshrrev_b32 v68, 16, v68
  v_mul_u32_u24 v69, 28, v68
  v_sub_u32 v69, v67, v69
  v_lshrrev_b32 v70, 4, v69
  v_and_b32 v69, 15, v69
  v_lshlrev_b32 v71, 12, v70
  v_lshl_add_u32 v71, v68, 8, v71
  v_lshl_add_u32 v71, v69, 4, v71
  v_add_u32 v154, v71, v75
  v_add_u32 v67, 160, v73
  v_mul_u32_u24 v68, 2341, v67
  v_lshrrev_b32 v68, 16, v68
  v_mul_u32_u24 v69, 28, v68
  v_sub_u32 v69, v67, v69
  v_lshrrev_b32 v70, 4, v69
  v_and_b32 v69, 15, v69
  v_lshlrev_b32 v71, 12, v70
  v_lshl_add_u32 v71, v68, 8, v71
  v_lshl_add_u32 v71, v69, 4, v71
  v_add_u32 v155, v71, v75
  v_add_u32 v67, 176, v73
  v_mul_u32_u24 v68, 2341, v67
  v_lshrrev_b32 v68, 16, v68
  v_mul_u32_u24 v69, 28, v68
  v_sub_u32 v69, v67, v69
  v_lshrrev_b32 v70, 4, v69
  v_and_b32 v69, 15, v69
  v_lshlrev_b32 v71, 12, v70
  v_lshl_add_u32 v71, v68, 8, v71
  v_lshl_add_u32 v71, v69, 4, v71
  v_add_u32 v156, v71, v75
  v_add_u32 v67, 192, v73
  v_mul_u32_u24 v68, 2341, v67
  v_lshrrev_b32 v68, 16, v68
  v_mul_u32_u24 v69, 28, v68
  v_sub_u32 v69, v67, v69
  v_lshrrev_b32 v70, 4, v69
  v_and_b32 v69, 15, v69
  v_lshlrev_b32 v71, 12, v70
  v_lshl_add_u32 v71, v68, 8, v71
  v_lshl_add_u32 v71, v69, 4, v71
  v_add_u32 v157, v71, v75
  v_add_u32 v67, 208, v73
  v_mul_u32_u24 v68, 2341, v67
  v_lshrrev_b32 v68, 16, v68
  v_mul_u32_u24 v69, 28, v68
  v_sub_u32 v69, v67, v69
  v_lshrrev_b32 v70, 4, v69
  v_and_b32 v69, 15, v69
  v_lshlrev_b32 v71, 12, v70
  v_lshl_add_u32 v71, v68, 8, v71
  v_lshl_add_u32 v71, v69, 4, v71
  v_add_u32 v158, v71, v75
  v_mov_b32 v74, 0x40000000
  v_mov_b32 v164, 0
  v_add_u32 v0, 30720, v2
  v_mov_b32 v76, 0
  v_mov_b32 v77, 0
  v_mov_b32 v78, 0
  v_mov_b32 v79, 0
  ds_write_b128 v2, v[76:79] offset:4096
  ds_write_b128 v2, v[76:79] offset:5120
  ds_write_b128 v2, v[76:79] offset:6144
  ds_write_b128 v2, v[76:79] offset:7168
  s_and_b32 s22, s17, 0
  s_lshl_b32 s22, s22, 7
  s_add_u32 s22, s22, 35328
  v_lshl_add_u32 v4, v73, 2, s22
  v_and_b32 v64, 1, v73
  v_mov_b32 v5, 0x05040100
  v_mov_b32 v65, 0x03020706
  v_cmp_eq_u32 vcc, 1, v64
  s_nop 1
  v_cndmask_b32 v5, v5, v65, vcc
  s_lshl_b32 s22, s17, 2
  s_add_u32 s22, s22, 39424
  v_lshl_add_u32 v7, v1, 7, s22
  v_cmp_gt_u32 vcc, 1, v1
  s_nop 1
  v_cndmask_b32 v7, v74, v7, vcc
  v_min_u32 v65, 11, v73
  v_mad_u32_u24 v65, v72, 12, v65
  v_lshlrev_b32 v6, 4, v65
  v_add_u32 v6, 1024, v6
  v_lshl_add_u32 v64, v66, 2, v64
  v_and_b32 v65, 2, v72
  v_add_u32 v64, v64, v65
  s_mul_i32 s22, s17, 12
  s_add_u32 s22, s22, 256
  v_add_u32 v75, s22, v73
  v_lshrrev_b32 v68, 4, v75
  v_lshlrev_b32 v68, 8, v68
  v_bfe_u32 v69, v75, 1, 1
  v_lshl_add_u32 v68, v69, 7, v68
  v_lshl_add_u32 v68, v64, 4, v68
  v_and_b32 v69, 12, v75
  v_add_u32 v1, v68, v69
  v_cmp_gt_u32 vcc, 12, v73
  s_nop 1
  v_cndmask_b32 v1, v74, v1, vcc
  s_mul_i32 s22, s17, 28672
  s_add_u32 s25, s22, 2490368
  s_and_b32 s27, s17, 3
  s_xor_b32 s22, s27, 0
  s_mul_i32 s80, s22, 7168
  s_lshl_b32 s22, s22, 11
  s_add_u32 s76, s22, 9216
  s_xor_b32 s22, s27, 1
  s_mul_i32 s81, s22, 7168
  s_lshl_b32 s22, s22, 11
  s_add_u32 s77, s22, 9216
  s_xor_b32 s22, s27, 2
  s_mul_i32 s82, s22, 7168
  s_lshl_b32 s22, s22, 11
  s_add_u32 s78, s22, 9216
  s_xor_b32 s22, s27, 3
  s_mul_i32 s83, s22, 7168
  s_lshl_b32 s22, s22, 11
  s_add_u32 s79, s22, 9216
  v_mov_b32 v162, -1
  s_mov_b32 s38, 0x40000000
  s_mul_i32 s31, s17, 401408
  s_add_u32 s31, s31, 40077312
  s_mov_b32 s30, 0
ch_wr5:
  buffer_load_dword v9, off, s[12:15], 0 offset:128 sc1
  s_waitcnt vmcnt(0)
  v_cmp_ne_u32 vcc, 1, v9
  s_cbranch_vccz ch_wr5_ok
  s_sleep 8
  s_add_u32 s30, s30, 1
  s_cmp_lt_u32 s30, 400000
  s_cbranch_scc1 ch_wr5
  s_branch cA_abort
ch_wr5_ok:
  s_lshr_b32 s22, s17, 2
  s_lshl_b32 s28, 0x81, s22
  s_mul_i32 s27, s17, 12
  s_add_u32 s22, s27, 256
  s_lshr_b32 s22, s22, 6
  s_lshl_b32 s22, 0x81, s22
  s_or_b32 s28, s28, s22
  s_add_u32 s22, s27, 267
  s_lshr_b32 s22, s22, 6
  s_lshl_b32 s22, 0x81, s22
  s_or_b32 s28, s28, s22
  v_lshrrev_b32 v12, 8, v2
  v_lshlrev_b32 v12, 7, v12
  s_mov_b32 s27, 582656
  s_mov_b32 s30, 0
ch_ww5:
  buffer_load_dword v9, v12, s[8:11], s27 offen sc1
  s_waitcnt vmcnt(0)
  v_and_b32 v10, s28, v9
  v_cmp_ne_u32 vcc, s28, v10
  s_cbranch_vccz ch_ww5_ok
  s_sleep 3
  s_add_u32 s30, s30, 1
  s_cmp_lt_u32 s30, 400000
  s_cbranch_scc1 ch_ww5
  s_branch cA_abort
ch_ww5_ok:
  s_add_u32 s22, s31, 0
  buffer_load_dwordx4 a[0:3], v2, s[8:11], s22 offen offset:0 sc1
  buffer_load_dwordx4 a[4:7], v2, s[8:11], s22 offen offset:1024 sc1
  buffer_load_dwordx4 a[8:11], v2, s[8:11], s22 offen offset:2048 sc1
  buffer_load_dwordx4 a[12:15], v2, s[8:11], s22 offen offset:3072 sc1
  s_add_u32 s22, s31, 4096
  buffer_load_dwordx4 a[16:19], v2, s[8:11], s22 offen offset:0 sc1
  buffer_load_dwordx4 a[20:23], v2, s[8:11], s22 offen offset:1024 sc1
  buffer_load_dwordx4 a[24:27], v2, s[8:11], s22 offen offset:2048 sc1
  buffer_load_dwordx4 a[28:31], v2, s[8:11], s22 offen offset:3072 sc1
  s_add_u32 s22, s31, 8192
  buffer_load_dwordx4 a[32:35], v2, s[8:11], s22 offen offset:0 sc1
  buffer_load_dwordx4 a[36:39], v2, s[8:11], s22 offen offset:1024 sc1
  buffer_load_dwordx4 a[40:43], v2, s[8:11], s22 offen offset:2048 sc1
  buffer_load_dwordx4 a[44:47], v2, s[8:11], s22 offen offset:3072 sc1
  s_add_u32 s22, s31, 12288
  buffer_load_dwordx4 a[48:51], v2, s[8:11], s22 offen offset:0 sc1
  buffer_load_dwordx4 a[52:55], v2, s[8:11], s22 offen offset:1024 sc1
  buffer_load_dwordx4 a[56:59], v2, s[8:11], s22 offen offset:2048 sc1
  buffer_load_dwordx4 a[60:63], v2, s[8:11], s22 offen offset:3072 sc1
  s_add_u32 s22, s31, 16384
  buffer_load_dwordx4 a[64:67], v2, s[8:11], s22 offen offset:0 sc1
  buffer_load_dwordx4 a[68:71], v2, s[8:11], s22 offen offset:1024 sc1
  buffer_load_dwordx4 a[72:75], v2, s[8:11], s22 offen offset:2048 sc1
  buffer_load_dwordx4 a[76:79], v2, s[8:11], s22 offen offset:3072 sc1
  s_add_u32 s22, s31, 20480
  buffer_load_dwordx4 a[80:83], v2, s[8:11], s22 offen offset:0 sc1
  buffer_load_dwordx4 a[84:87], v2, s[8:11], s22 offen offset:1024 sc1
  buffer_load_dwordx4 a[88:91], v2, s[8:11], s22 offen offset:2048 sc1
  buffer_load_dwordx4 a[92:95], v2, s[8:11], s22 offen offset:3072 sc1
  s_add_u32 s22, s31, 24576
  buffer_load_dwordx4 a[96:99], v2, s[8:11], s22 offen offset:0 sc1
  buffer_load_dwordx4 a[100:103], v2, s[8:11], s22 offen offset:1024 sc1
  buffer_load_dwordx4 a[104:107], v2, s[8:11], s22 offen offset:2048 sc1
  buffer_load_dwordx4 a[108:111], v2, s[8:11], s22 offen offset:3072 sc1
  s_add_u32 s22, s31, 28672
  buffer_load_dwordx4 a[112:115], v2, s[8:11], s22 offen offset:0 sc1
  buffer_load_dwordx4 a[116:119], v2, s[8:11], s22 offen offset:1024 sc1
  buffer_load_dwordx4 a[120:123], v2, s[8:11], s22 offen offset:2048 sc1
  buffer_load_dwordx4 a[124:127], v2, s[8:11], s22 offen offset:3072 sc1
  s_waitcnt vmcnt(24)
  s_add_u32 s22, s31, 32768
  buffer_load_dwordx4 a[128:131], v2, s[8:11], s22 offen offset:0 sc1
  buffer_load_dwordx4 a[132:135], v2, s[8:11], s22 offen offset:1024 sc1
  buffer_load_dwordx4 a[136:139], v2, s[8:11], s22 offen offset:2048 sc1
  buffer_load_dwordx4 a[140:143], v2, s[8:11], s22 offen offset:3072 sc1
  s_add_u32 s22, s31, 36864
  buffer_load_dwordx4 a[144:147], v2, s[8:11], s22 offen offset:0 sc1
  buffer_load_dwordx4 a[148:151], v2, s[8:11], s22 offen offset:1024 sc1
  buffer_load_dwordx4 a[152:155], v2, s[8:11], s22 offen offset:2048 sc1
  buffer_load_dwordx4 a[156:159], v2, s[8:11], s22 offen offset:3072 sc1
  s_add_u32 s22, s31, 40960
  buffer_load_dwordx4 a[160:163], v2, s[8:11], s22 offen offset:0 sc1
  buffer_load_dwordx4 a[164:167], v2, s[8:11], s22 offen offset:1024 sc1
  buffer_load_dwordx4 a[168:171], v2, s[8:11], s22 offen offset:2048 sc1
  buffer_load_dwordx4 a[172:175], v2, s[8:11], s22 offen offset:3072 sc1
  s_add_u32 s22, s31, 45056
  buffer_load_dwordx4 a[176:179], v2, s[8:11], s22 offen offset:0 sc1
  buffer_load_dwordx4 a[180:183], v2, s[8:11], s22 offen offset:1024 sc1
  buffer_load_dwordx4 a[184:187], v2, s[8:11], s22 offen offset:2048 sc1
  buffer_load_dwordx4 a[188:191], v2, s[8:11], s22 offen offset:3072 sc1
  s_add_u32 s22, s31, 49152
  buffer_load_dwordx4 a[192:195], v2, s[8:11], s22 offen offset:0 sc1
  buffer_load_dwordx4 a[196:199], v2, s[8:11], s22 offen offset:1024 sc1
  buffer_load_dwordx4 a[200:203], v2, s[8:11], s22 offen offset:2048 sc1
  buffer_load_dwordx4 a[204:207], v2, s[8:11], s22 offen offset:3072 sc1
  s_add_u32 s22, s31, 53248
  buffer_load_dwordx4 a[208:211], v2, s[8:11], s22 offen offset:0 sc1
  buffer_load_dwordx4 a[212:215], v2, s[8:11], s22 offen offset:1024 sc1
  buffer_load_dwordx4 a[216:219], v2, s[8:11], s22 offen offset:2048 sc1
  buffer_load_dwordx4 a[220:223], v2, s[8:11], s22 offen offset:3072 sc1
  s_add_u32 s22, s31, 57344
  buffer_load_dwordx4 a[224:227], v2, s[8:11], s22 offen offset:0 sc1
  buffer_load_dwordx4 a[228:231], v2, s[8:11], s22 offen offset:1024 sc1
  buffer_load_dwordx4 a[232:235], v2, s[8:11], s22 offen offset:2048 sc1
  buffer_load_dwordx4 a[236:239], v2, s[8:11], s22 offen offset:3072 sc1
  s_add_u32 s22, s31, 61440
  buffer_load_dwordx4 a[240:243], v2, s[8:11], s22 offen offset:0 sc1
  buffer_load_dwordx4 a[244:247], v2, s[8:11], s22 offen offset:1024 sc1
  buffer_load_dwordx4 a[248:251], v2, s[8:11], s22 offen offset:2048 sc1
  buffer_load_dwordx4 a[252:255], v2, s[8:11], s22 offen offset:3072 sc1
  s_waitcnt vmcnt(24)
  s_add_u32 s22, s31, 65536
  buffer_load_dwordx4 v[176:179], v2, s[8:11], s22 offen offset:0 sc1
  buffer_load_dwordx4 v[180:183], v2, s[8:11], s22 offen offset:1024 sc1
  buffer_load_dwordx4 v[184:187], v2, s[8:11], s22 offen offset:2048 sc1
  buffer_load_dwordx4 v[188:191], v2, s[8:11], s22 offen offset:3072 sc1
  s_add_u32 s22, s31, 69632
  buffer_load_dwordx4 v[192:195], v2, s[8:11], s22 offen offset:0 sc1
  buffer_load_dwordx4 v[196:199], v2, s[8:11], s22 offen offset:1024 sc1
  buffer_load_dwordx4 v[200:203], v2, s[8:11], s22 offen offset:2048 sc1
  buffer_load_dwordx4 v[204:207], v2, s[8:11], s22 offen offset:3072 sc1
  s_add_u32 s22, s31, 73728
  buffer_load_dwordx4 v[208:211], v2, s[8:11], s22 offen offset:0 sc1
  buffer_load_dwordx4 v[212:215], v2, s[8:11], s22 offen offset:1024 sc1
  buffer_load_dwordx4 v[216:219], v2, s[8:11], s22 offen offset:2048 sc1
  buffer_load_dwordx4 v[220:223], v2, s[8:11], s22 offen offset:3072 sc1
  s_add_u32 s22, s31, 77824
  buffer_load_dwordx4 v[224:227], v2, s[8:11], s22 offen offset:0 sc1
  buffer_load_dwordx4 v[228:231], v2, s[8:11], s22 offen offset:1024 sc1
  buffer_load_dwordx4 v[232:235], v2, s[8:11], s22 offen offset:2048 sc1
  buffer_load_dwordx4 v[236:239], v2, s[8:11], s22 offen offset:3072 sc1
  s_add_u32 s22, s31, 81920
  buffer_load_dwordx4 v[240:243], v2, s[8:11], s22 offen offset:0 sc1
  buffer_load_dwordx4 v[244:247], v2, s[8:11], s22 offen offset:1024 sc1
  buffer_load_dwordx4 v[248:251], v2, s[8:11], s22 offen offset:2048 sc1
  buffer_load_dwordx4 v[252:255], v2, s[8:11], s22 offen offset:3072 sc1
  s_mov_b32 m0, 30720
  s_add_u32 s22, s31, 86016
  buffer_load_dwordx4 v2, s[8:11], s22 offen offset:0 sc1 lds
  buffer_load_dwordx4 v2, s[8:11], s22 offen offset:1024 sc1 lds
  buffer_load_dwordx4 v2, s[8:11], s22 offen offset:2048 sc1 lds
  buffer_load_dwordx4 v2, s[8:11], s22 offen offset:3072 sc1 lds
  s_mov_b32 m0, 34816
  s_add_u32 s22, s31, 90112
  buffer_load_dwordx4 v2, s[8:11], s22 offen offset:0 sc1 lds
  buffer_load_dwordx4 v2, s[8:11], s22 offen offset:1024 sc1 lds
  buffer_load_dwordx4 v2, s[8:11], s22 offen offset:2048 sc1 lds
  buffer_load_dwordx4 v2, s[8:11], s22 offen offset:3072 sc1 lds
  s_mov_b32 m0, 38912
  s_add_u32 s22, s31, 94208
  buffer_load_dwordx4 v2, s[8:11], s22 offen offset:0 sc1 lds
  buffer_load_dwordx4 v2, s[8:11], s22 offen offset:1024 sc1 lds
  buffer_load_dwordx4 v2, s[8:11], s22 offen offset:2048 sc1 lds
  buffer_load_dwordx4 v2, s[8:11], s22 offen offset:3072 sc1 lds
  s_mov_b32 m0, 43008
  s_add_u32 s22, s31, 98304
  buffer_load_dwordx4 v2, s[8:11], s22 offen offset:0 sc1 lds
  buffer_load_dwordx4 v2, s[8:11], s22 offen offset:1024 sc1 lds
  s_mov_b32 s30, 0
ch_ws5:
  buffer_load_dword v9, off, s[12:15], 0 offset:132 sc1
  s_waitcnt vmcnt(0)
  v_cmp_ne_u32 vcc, 1, v9
  s_cbranch_vccz ch_ws5_ok
  s_sleep 8
  s_add_u32 s30, s30, 1
  s_cmp_lt_u32 s30, 400000
  s_cbranch_scc1 ch_ws5
  s_branch cA_abort
ch_ws5_ok:
  s_mul_i32 s33, s17, 532480
  s_add_u32 s33, s33, 78111744
  v_mov_b32 v12, -1
  v_mov_b32 v13, -1
  v_mov_b32 v14, -1
  v_mov_b32 v15, -1
  s_add_u32 s22, s33, 0
  buffer_store_dwordx4 v[12:15], v2, s[8:11], s22 offen sc1
  s_add_u32 s22, s33, 2048
  buffer_store_dwordx4 v[12:15], v2, s[8:11], s22 offen sc1
  s_add_u32 s22, s33, 4096
  buffer_store_dwordx4 v[12:15], v2, s[8:11], s22 offen sc1
  s_add_u32 s22, s33, 6144
  buffer_store_dwordx4 v[12:15], v2, s[8:11], s22 offen sc1
  s_add_u32 s22, s33, 8192
  buffer_store_dwordx4 v[12:15], v2, s[8:11], s22 offen sc1
  s_add_u32 s22, s33, 10240
  buffer_store_dwordx4 v[12:15], v2, s[8:11], s22 offen sc1
  s_add_u32 s22, s33, 12288
  buffer_store_dwordx4 v[12:15], v2, s[8:11], s22 offen sc1
  s_add_u32 s22, s33, 14336
  buffer_store_dwordx4 v[12:15], v2, s[8:11], s22 offen sc1
  v_mov_b32 v16, 1
  v_mov_b32 v17, 1
  s_lshl_b32 s22, s17, 10
  s_add_u32 s22, s22, 566248
  s_waitcnt vmcnt(0)
  s_mov_b64 exec, 3
  buffer_store_dwordx2 v[16:17], v2, s[8:11], s22 offen sc1
  s_mov_b64 exec, -1
  s_mov_b32 s28, s35
  s_waitcnt vmcnt(0) lgkmcnt(0)
  s_mov_b32 s31, 0
  s_cmp_lg_u32 s88, 0
  s_cbranch_scc1 cB_va1_loop
  s_branch cA_va1_loop
ch_init6:
  v_mov_b32 v72, v116
  v_mov_b32 v73, v117
  v_lshrrev_b32 v65, 1, v72
  v_and_b32 v66, 1, v72
  v_mov_b32 v36, 0
  v_mov_b32 v37, 0
  v_mov_b32 v38, 0
  v_mov_b32 v39, 0
  v_mov_b32 v40, 0
  v_mov_b32 v41, 0
  v_mov_b32 v42, 0
  v_mov_b32 v43, 0
  v_mov_b32 v44, 0
  v_mov_b32 v45, 0
  v_mov_b32 v46, 0
  v_mov_b32 v47, 0
  v_mov_b32 v48, 0
  v_mov_b32 v49, 0
  v_mov_b32 v50, 0
  v_mov_b32 v51, 0
  v_mov_b32 v52, 0
  v_mov_b32 v53, 0
  v_mov_b32 v54, 0
  v_mov_b32 v55, 0
  v_mov_b32 v56, 0
  v_mov_b32 v57, 0
  v_mov_b32 v58, 0
  v_mov_b32 v59, 0
  v_mov_b32 v60, 0
  v_mov_b32 v61, 0
  v_mov_b32 v62, 0
  v_mov_b32 v63, 0
  v_lshlrev_b32 v75, 2, v65
  v_lshl_add_u32 v75, v66, 3, v75
  v_add_u32 v67, 224, v73
  v_mul_u32_u24 v68, 2341, v67
  v_lshrrev_b32 v68, 16, v68
  v_mul_u32_u24 v69, 28, v68
  v_sub_u32 v69, v67, v69
  v_lshrrev_b32 v70, 4, v69
  v_and_b32 v69, 15, v69
  v_lshlrev_b32 v71, 12, v70
  v_lshl_add_u32 v71, v68, 8, v71
  v_lshl_add_u32 v71, v69, 4, v71
  v_add_u32 v104, v71, v75
  v_add_u32 v67, 240, v73
  v_mul_u32_u24 v68, 2341, v67
  v_lshrrev_b32 v68, 16, v68
  v_mul_u32_u24 v69, 28, v68
  v_sub_u32 v69, v67, v69
  v_lshrrev_b32 v70, 4, v69
  v_and_b32 v69, 15, v69
  v_lshlrev_b32 v71, 12, v70
  v_lshl_add_u32 v71, v68, 8, v71
  v_lshl_add_u32 v71, v69, 4, v71
  v_add_u32 v105, v71, v75
  v_add_u32 v67, 256, v73
  v_mul_u32_u24 v68, 2341, v67
  v_lshrrev_b32 v68, 16, v68
  v_mul_u32_u24 v69, 28, v68
  v_sub_u32 v69, v67, v69
  v_lshrrev_b32 v70, 4, v69
  v_and_b32 v69, 15, v69
  v_lshlrev_b32 v71, 12, v70
  v_lshl_add_u32 v71, v68, 8, v71
  v_lshl_add_u32 v71, v69, 4, v71
  v_add_u32 v106, v71, v75
  v_add_u32 v67, 272, v73
  v_mul_u32_u24 v68, 2341, v67
  v_lshrrev_b32 v68, 16, v68
  v_mul_u32_u24 v69, 28, v68
  v_sub_u32 v69, v67, v69
  v_lshrrev_b32 v70, 4, v69
  v_and_b32 v69, 15, v69
  v_lshlrev_b32 v71, 12, v70
  v_lshl_add_u32 v71, v68, 8, v71
  v_lshl_add_u32 v71, v69, 4, v71
  v_add_u32 v107, v71, v75
  v_add_u32 v67, 288, v73
  v_mul_u32_u24 v68, 2341, v67
  v_lshrrev_b32 v68, 16, v68
  v_mul_u32_u24 v69, 28, v68
  v_sub_u32 v69, v67, v69
  v_lshrrev_b32 v70, 4, v69
  v_and_b32 v69, 15, v69
  v_lshlrev_b32 v71, 12, v70
  v_lshl_add_u32 v71, v68, 8, v71
  v_lshl_add_u32 v71, v69, 4, v71
  v_add_u32 v108, v71, v75
  v_add_u32 v67, 304, v73
  v_mul_u32_u24 v68, 2341, v67
  v_lshrrev_b32 v68, 16, v68
  v_mul_u32_u24 v69, 28, v68
  v_sub_u32 v69, v67, v69
  v_lshrrev_b32 v70, 4, v69
  v_and_b32 v69, 15, v69
  v_lshlrev_b32 v71, 12, v70
  v_lshl_add_u32 v71, v68, 8, v71
  v_lshl_add_u32 v71, v69, 4, v71
  v_add_u32 v109, v71, v75
  v_add_u32 v67, 320, v73
  v_mul_u32_u24 v68, 2341, v67
  v_lshrrev_b32 v68, 16, v68
  v_mul_u32_u24 v69, 28, v68
  v_sub_u32 v69, v67, v69
  v_lshrrev_b32 v70, 4, v69
  v_and_b32 v69, 15, v69
  v_lshlrev_b32 v71, 12, v70
  v_lshl_add_u32 v71, v68, 8, v71
  v_lshl_add_u32 v71, v69, 4, v71
  v_add_u32 v110, v71, v75
  v_add_u32 v67, 96, v73
  v_mul_u32_u24 v68, 2341, v67
  v_lshrrev_b32 v68, 16, v68
  v_mul_u32_u24 v69, 28, v68
  v_sub_u32 v69, v67, v69
  v_lshrrev_b32 v70, 4, v69
  v_and_b32 v69, 15, v69
  v_lshlrev_b32 v71, 12, v70
  v_lshl_add_u32 v71, v68, 8, v71
  v_lshl_add_u32 v71, v69, 4, v71
  v_add_u32 v111, v71, v75
  v_mov_b32 v74, 0x40000000
  v_mov_b32 v96, 0
  v_add_u32 v0, 16384, v2
  v_and_b32 v119, 15, v1
  s_and_b32 s22, s17, 0
  s_lshl_b32 s22, s22, 7
  s_add_u32 s22, s22, 39424
  v_lshl_add_u32 v119, v119, 2, s22
  s_lshl_b32 s22, s17, 2
  s_add_u32 s22, s22, 37376
  v_lshl_add_u32 v118, v1, 7, s22
  v_cmp_gt_u32 vcc, 1, v1
  s_nop 1
  v_cndmask_b32 v118, v74, v118, vcc
  s_lshl_b32 s35, s17, 7
  s_add_u32 s35, s35, 524288
  v_mov_b32 v64, 0
  v_mov_b32 v65, 0
  v_mov_b32 v66, 0
  v_mov_b32 v67, 0
  v_min_u32 v116, 13, v1
  s_mul_i32 s22, s17, 14
  v_add_u32 v116, s22, v116
  v_lshlrev_b32 v116, 7, v116
  s_mul_i32 s31, s17, 401408
  s_add_u32 s31, s31, 40177664
  s_mov_b32 s30, 0
ch_wr6:
  buffer_load_dword v9, off, s[12:15], 0 offset:128 sc1
  s_waitcnt vmcnt(0)
  v_cmp_ne_u32 vcc, 1, v9
  s_cbranch_vccz ch_wr6_ok
  s_sleep 8
  s_add_u32 s30, s30, 1
  s_cmp_lt_u32 s30, 400000
  s_cbranch_scc1 ch_wr6
  s_branch cA_abort
ch_wr6_ok:
  s_lshr_b32 s22, s17, 2
  s_lshl_b32 s28, 0x81, s22
  s_mul_i32 s27, s17, 12
  s_add_u32 s22, s27, 256
  s_lshr_b32 s22, s22, 6
  s_lshl_b32 s22, 0x81, s22
  s_or_b32 s28, s28, s22
  s_add_u32 s22, s27, 267
  s_lshr_b32 s22, s22, 6
  s_lshl_b32 s22, 0x81, s22
  s_or_b32 s28, s28, s22
  v_lshrrev_b32 v12, 8, v2
  v_lshlrev_b32 v12, 7, v12
  s_mov_b32 s27, 583168
  s_mov_b32 s30, 0
ch_ww6:
  buffer_load_dword v9, v12, s[8:11], s27 offen sc1
  s_waitcnt vmcnt(0)
  v_and_b32 v10, s28, v9
  v_cmp_ne_u32 vcc, s28, v10
  s_cbranch_vccz ch_ww6_ok
  s_sleep 3
  s_add_u32 s30, s30, 1
  s_cmp_lt_u32 s30, 400000
  s_cbranch_scc1 ch_ww6
  s_branch cA_abort
ch_ww6_ok:
  s_add_u32 s22, s31, 0
  buffer_load_dwordx4 a[0:3], v2, s[8:11], s22 offen offset:0 sc1
  buffer_load_dwordx4 a[4:7], v2, s[8:11], s22 offen offset:1024 sc1
  buffer_load_dwordx4 a[8:11], v2, s[8:11], s22 offen offset:2048 sc1
  buffer_load_dwordx4 a[12:15], v2, s[8:11], s22 offen offset:3072 sc1
  s_add_u32 s22, s31, 4096
  buffer_load_dwordx4 a[16:19], v2, s[8:11], s22 offen offset:0 sc1
  buffer_load_dwordx4 a[20:23], v2, s[8:11], s22 offen offset:1024 sc1
  buffer_load_dwordx4 a[24:27], v2, s[8:11], s22 offen offset:2048 sc1
  buffer_load_dwordx4 a[28:31], v2, s[8:11], s22 offen offset:3072 sc1
  s_add_u32 s22, s31, 8192
  buffer_load_dwordx4 a[32:35], v2, s[8:11], s22 offen offset:0 sc1
  buffer_load_dwordx4 a[36:39], v2, s[8:11], s22 offen offset:1024 sc1
  buffer_load_dwordx4 a[40:43], v2, s[8:11], s22 offen offset:2048 sc1
  buffer_load_dwordx4 a[44:47], v2, s[8:11], s22 offen offset:3072 sc1
  s_add_u32 s22, s31, 12288
  buffer_load_dwordx4 a[48:51], v2, s[8:11], s22 offen offset:0 sc1
  buffer_load_dwordx4 a[52:55], v2, s[8:11], s22 offen offset:1024 sc1
  buffer_load_dwordx4 a[56:59], v2, s[8:11], s22 offen offset:2048 sc1
  buffer_load_dwordx4 a[60:63], v2, s[8:11], s22 offen offset:3072 sc1
  s_add_u32 s22, s31, 16384
  buffer_load_dwordx4 a[64:67], v2, s[8:11], s22 offen offset:0 sc1
  buffer_load_dwordx4 a[68:71], v2, s[8:11], s22 offen offset:1024 sc1
  buffer_load_dwordx4 a[72:75], v2, s[8:11], s22 offen offset:2048 sc1
  buffer_load_dwordx4 a[76:79], v2, s[8:11], s22 offen offset:3072 sc1
  s_add_u32 s22, s31, 20480
  buffer_load_dwordx4 a[80:83], v2, s[8:11], s22 offen offset:0 sc1
  buffer_load_dwordx4 a[84:87], v2, s[8:11], s22 offen offset:1024 sc1
  buffer_load_dwordx4 a[88:91], v2, s[8:11], s22 offen offset:2048 sc1
  buffer_load_dwordx4 a[92:95], v2, s[8:11], s22 offen offset:3072 sc1
  s_add_u32 s22, s31, 24576
  buffer_load_dwordx4 a[96:99], v2, s[8:11], s22 offen offset:0 sc1
  buffer_load_dwordx4 a[100:103], v2, s[8:11], s22 offen offset:1024 sc1
  buffer_load_dwordx4 a[104:107], v2, s[8:11], s22 offen offset:2048 sc1
  buffer_load_dwordx4 a[108:111], v2, s[8:11], s22 offen offset:3072 sc1
  s_add_u32 s22, s31, 28672
  buffer_load_dwordx4 a[112:115], v2, s[8:11], s22 offen offset:0 sc1
  buffer_load_dwordx4 a[116:119], v2, s[8:11], s22 offen offset:1024 sc1
  buffer_load_dwordx4 a[120:123], v2, s[8:11], s22 offen offset:2048 sc1
  buffer_load_dwordx4 a[124:127], v2, s[8:11], s22 offen offset:3072 sc1
  s_waitcnt vmcnt(24)
  s_add_u32 s22, s31, 32768
  buffer_load_dwordx4 a[128:131], v2, s[8:11], s22 offen offset:0 sc1
  buffer_load_dwordx4 a[132:135], v2, s[8:11], s22 offen offset:1024 sc1
  buffer_load_dwordx4 a[136:139], v2, s[8:11], s22 offen offset:2048 sc1
  buffer_load_dwordx4 a[140:143], v2, s[8:11], s22 offen offset:3072 sc1
  s_add_u32 s22, s31, 36864
  buffer_load_dwordx4 a[144:147], v2, s[8:11], s22 offen offset:0 sc1
  buffer_load_dwordx4 a[148:151], v2, s[8:11], s22 offen offset:1024 sc1
  buffer_load_dwordx4 a[152:155], v2, s[8:11], s22 offen offset:2048 sc1
  buffer_load_dwordx4 a[156:159], v2, s[8:11], s22 offen offset:3072 sc1
  s_add_u32 s22, s31, 40960
  buffer_load_dwordx4 a[160:163], v2, s[8:11], s22 offen offset:0 sc1
  buffer_load_dwordx4 a[164:167], v2, s[8:11], s22 offen offset:1024 sc1
  buffer_load_dwordx4 a[168:171], v2, s[8:11], s22 offen offset:2048 sc1
  buffer_load_dwordx4 a[172:175], v2, s[8:11], s22 offen offset:3072 sc1
  s_add_u32 s22, s31, 45056
  buffer_load_dwordx4 a[176:179], v2, s[8:11], s22 offen offset:0 sc1
  buffer_load_dwordx4 a[180:183], v2, s[8:11], s22 offen offset:1024 sc1
  buffer_load_dwordx4 a[184:187], v2, s[8:11], s22 offen offset:2048 sc1
  buffer_load_dwordx4 a[188:191], v2, s[8:11], s22 offen offset:3072 sc1
  s_add_u32 s22, s31, 49152
  buffer_load_dwordx4 a[192:195], v2, s[8:11], s22 offen offset:0 sc1
  buffer_load_dwordx4 a[196:199], v2, s[8:11], s22 offen offset:1024 sc1
  buffer_load_dwordx4 a[200:203], v2, s[8:11], s22 offen offset:2048 sc1
  buffer_load_dwordx4 a[204:207], v2, s[8:11], s22 offen offset:3072 sc1
  s_add_u32 s22, s31, 53248
  buffer_load_dwordx4 a[208:211], v2, s[8:11], s22 offen offset:0 sc1
  buffer_load_dwordx4 a[212:215], v2, s[8:11], s22 offen offset:1024 sc1
  buffer_load_dwordx4 a[216:219], v2, s[8:11], s22 offen offset:2048 sc1
  buffer_load_dwordx4 a[220:223], v2, s[8:11], s22 offen offset:3072 sc1
  s_add_u32 s22, s31, 57344
  buffer_load_dwordx4 a[224:227], v2, s[8:11], s22 offen offset:0 sc1
  buffer_load_dwordx4 a[228:231], v2, s[8:11], s22 offen offset:1024 sc1
  buffer_load_dwordx4 a[232:235], v2, s[8:11], s22 offen offset:2048 sc1
  buffer_load_dwordx4 a[236:239], v2, s[8:11], s22 offen offset:3072 sc1
  s_add_u32 s22, s31, 61440
  buffer_load_dwordx4 a[240:243], v2, s[8:11], s22 offen offset:0 sc1
  buffer_load_dwordx4 a[244:247], v2, s[8:11], s22 offen offset:1024 sc1
  buffer_load_dwordx4 a[248:251], v2, s[8:11], s22 offen offset:2048 sc1
  buffer_load_dwordx4 a[252:255], v2, s[8:11], s22 offen offset:3072 sc1
  s_waitcnt vmcnt(24)
  s_add_u32 s22, s31, 65536
  buffer_load_dwordx4 v[120:123], v2, s[8:11], s22 offen offset:0 sc1
  buffer_load_dwordx4 v[124:127], v2, s[8:11], s22 offen offset:1024 sc1
  buffer_load_dwordx4 v[128:131], v2, s[8:11], s22 offen offset:2048 sc1
  buffer_load_dwordx4 v[132:135], v2, s[8:11], s22 offen offset:3072 sc1
  s_add_u32 s22, s31, 69632
  buffer_load_dwordx4 v[136:139], v2, s[8:11], s22 offen offset:0 sc1
  buffer_load_dwordx4 v[140:143], v2, s[8:11], s22 offen offset:1024 sc1
  buffer_load_dwordx4 v[144:147], v2, s[8:11], s22 offen offset:2048 sc1
  buffer_load_dwordx4 v[148:151], v2, s[8:11], s22 offen offset:3072 sc1
  s_add_u32 s22, s31, 73728
  buffer_load_dwordx4 v[152:155], v2, s[8:11], s22 offen offset:0 sc1
  buffer_load_dwordx4 v[156:159], v2, s[8:11], s22 offen offset:1024 sc1
  buffer_load_dwordx4 v[160:163], v2, s[8:11], s22 offen offset:2048 sc1
  buffer_load_dwordx4 v[164:167], v2, s[8:11], s22 offen offset:3072 sc1
  s_add_u32 s22, s31, 77824
  buffer_load_dwordx4 v[168:171], v2, s[8:11], s22 offen offset:0 sc1
  buffer_load_dwordx4 v[172:175], v2, s[8:11], s22 offen offset:1024 sc1
  buffer_load_dwordx4 v[176:179], v2, s[8:11], s22 offen offset:2048 sc1
  buffer_load_dwordx4 v[180:183], v2, s[8:11], s22 offen offset:3072 sc1
  s_add_u32 s22, s31, 81920
  buffer_load_dwordx4 v[184:187], v2, s[8:11], s22 offen offset:0 sc1
  buffer_load_dwordx4 v[188:191], v2, s[8:11], s22 offen offset:1024 sc1
  buffer_load_dwordx4 v[192:195], v2, s[8:11], s22 offen offset:2048 sc1
  buffer_load_dwordx4 v[196:199], v2, s[8:11], s22 offen offset:3072 sc1
  s_add_u32 s22, s31, 86016
  buffer_load_dwordx4 v[200:203], v2, s[8:11], s22 offen offset:0 sc1
  buffer_load_dwordx4 v[204:207], v2, s[8:11], s22 offen offset:1024 sc1
  buffer_load_dwordx4 v[208:211], v2, s[8:11], s22 offen offset:2048 sc1
  buffer_load_dwordx4 v[212:215], v2, s[8:11], s22 offen offset:3072 sc1
  s_add_u32 s22, s31, 90112
  buffer_load_dwordx4 v[216:219], v2, s[8:11], s22 offen offset:0 sc1
  buffer_load_dwordx4 v[220:223], v2, s[8:11], s22 offen offset:1024 sc1
  buffer_load_dwordx4 v[224:227], v2, s[8:11], s22 offen offset:2048 sc1
  buffer_load_dwordx4 v[228:231], v2, s[8:11], s22 offen offset:3072 sc1
  s_add_u32 s22, s31, 94208
  buffer_load_dwordx4 v[232:235], v2, s[8:11], s22 offen offset:0 sc1
  buffer_load_dwordx4 v[236:239], v2, s[8:11], s22 offen offset:1024 sc1
  buffer_load_dwordx4 v[240:243], v2, s[8:11], s22 offen offset:2048 sc1
  buffer_load_dwordx4 v[244:247], v2, s[8:11], s22 offen offset:3072 sc1
  s_waitcnt vmcnt(24)
  s_add_u32 s22, s31, 98304
  buffer_load_dwordx4 v[248:251], v2, s[8:11], s22 offen offset:0 sc1
  buffer_load_dwordx4 v[252:255], v2, s[8:11], s22 offen offset:1024 sc1
  s_mov_b32 s30, 0
ch_ws6:
  buffer_load_dword v9, off, s[12:15], 0 offset:132 sc1
  s_waitcnt vmcnt(0)
  v_cmp_ne_u32 vcc, 1, v9
  s_cbranch_vccz ch_ws6_ok
  s_sleep 8
  s_add_u32 s30, s30, 1
  s_cmp_lt_u32 s30, 400000
  s_cbranch_scc1 ch_ws6
  s_branch cA_abort
ch_ws6_ok:
  s_lshl_b32 s27, s17, 7
  s_add_u32 s27, s27, 524288
  s_mov_b32 s30, 0
ch_vw2:
  buffer_load_dword v9, off, s[8:11], s27 sc1
  s_waitcnt vmcnt(0)
  v_cmp_ne_u32 vcc, 56, v9
  s_cbranch_vccz ch_vw2_d
  s_sleep 2
  s_add_u32 s30, s30, 1
  s_cmp_lt_u32 s30, 400000
  s_cbranch_scc1 ch_vw2
  s_branch cA_abort
ch_vw2_d:
  s_mov_b32 s28, s35
  s_waitcnt vmcnt(0) lgkmcnt(0)
  s_mov_b32 s31, 0
  s_cmp_lg_u32 s88, 0
  s_cbranch_scc1 cB_va2_loop
  s_branch cA_va2_loop
ch_init7:
  v_mov_b32 v72, v116
  v_mov_b32 v73, v117
  v_lshrrev_b32 v65, 1, v72
  v_and_b32 v66, 1, v72
  v_mov_b32 v36, 0
  v_mov_b32 v37, 0
  v_mov_b32 v38, 0
  v_mov_b32 v39, 0
  v_mov_b32 v40, 0
  v_mov_b32 v41, 0
  v_mov_b32 v42, 0
  v_mov_b32 v43, 0
  v_mov_b32 v44, 0
  v_mov_b32 v45, 0
  v_mov_b32 v46, 0
  v_mov_b32 v47, 0
  v_mov_b32 v48, 0
  v_mov_b32 v49, 0
  v_mov_b32 v50, 0
  v_mov_b32 v51, 0
  v_mov_b32 v52, 0
  v_mov_b32 v53, 0
  v_mov_b32 v54, 0
  v_mov_b32 v55, 0
  v_mov_b32 v56, 0
  v_mov_b32 v57, 0
  v_mov_b32 v58, 0
  v_mov_b32 v59, 0
  v_mov_b32 v60, 0
  v_mov_b32 v61, 0
  v_mov_b32 v62, 0
  v_mov_b32 v63, 0
  v_lshlrev_b32 v75, 2, v65
  v_lshl_add_u32 v75, v66, 3, v75
  v_add_u32 v67, 336, v73
  v_mul_u32_u24 v68, 2341, v67
  v_lshrrev_b32 v68, 16, v68
  v_mul_u32_u24 v69, 28, v68
  v_sub_u32 v69, v67, v69
  v_lshrrev_b32 v70, 4, v69
  v_and_b32 v69, 15, v69
  v_lshlrev_b32 v71, 12, v70
  v_lshl_add_u32 v71, v68, 8, v71
  v_lshl_add_u32 v71, v69, 4, v71
  v_add_u32 v104, v71, v75
  v_add_u32 v67, 352, v73
  v_mul_u32_u24 v68, 2341, v67
  v_lshrrev_b32 v68, 16, v68
  v_mul_u32_u24 v69, 28, v68
  v_sub_u32 v69, v67, v69
  v_lshrrev_b32 v70, 4, v69
  v_and_b32 v69, 15, v69
  v_lshlrev_b32 v71, 12, v70
  v_lshl_add_u32 v71, v68, 8, v71
  v_lshl_add_u32 v71, v69, 4, v71
  v_add_u32 v105, v71, v75
  v_add_u32 v67, 368, v73
  v_mul_u32_u24 v68, 2341, v67
  v_lshrrev_b32 v68, 16, v68
  v_mul_u32_u24 v69, 28, v68
  v_sub_u32 v69, v67, v69
  v_lshrrev_b32 v70, 4, v69
  v_and_b32 v69, 15, v69
  v_lshlrev_b32 v71, 12, v70
  v_lshl_add_u32 v71, v68, 8, v71
  v_lshl_add_u32 v71, v69, 4, v71
  v_add_u32 v106, v71, v75
  v_add_u32 v67, 384, v73
  v_mul_u32_u24 v68, 2341, v67
  v_lshrrev_b32 v68, 16, v68
  v_mul_u32_u24 v69, 28, v68
  v_sub_u32 v69, v67, v69
  v_lshrrev_b32 v70, 4, v69
  v_and_b32 v69, 15, v69
  v_lshlrev_b32 v71, 12, v70
  v_lshl_add_u32 v71, v68, 8, v71
  v_lshl_add_u32 v71, v69, 4, v71
  v_add_u32 v107, v71, v75
  v_add_u32 v67, 400, v73
  v_mul_u32_u24 v68, 2341, v67
  v_lshrrev_b32 v68, 16, v68
  v_mul_u32_u24 v69, 28, v68
  v_sub_u32 v69, v67, v69
  v_lshrrev_b32 v70, 4, v69
  v_and_b32 v69, 15, v69
  v_lshlrev_b32 v71, 12, v70
  v_lshl_add_u32 v71, v68, 8, v71
  v_lshl_add_u32 v71, v69, 4, v71
  v_add_u32 v108, v71, v75
  v_add_u32 v67, 416, v73
  v_mul_u32_u24 v68, 2341, v67
  v_lshrrev_b32 v68, 16, v68
  v_mul_u32_u24 v69, 28, v68
  v_sub_u32 v69, v67, v69
  v_lshrrev_b32 v70, 4, v69
  v_and_b32 v69, 15, v69
  v_lshlrev_b32 v71, 12, v70
  v_lshl_add_u32 v71, v68, 8, v71
  v_lshl_add_u32 v71, v69, 4, v71
  v_add_u32 v109, v71, v75
  v_add_u32 v67, 432, v73
  v_mul_u32_u24 v68, 2341, v67
  v_lshrrev_b32 v68, 16, v68
  v_mul_u32_u24 v69, 28, v68
  v_sub_u32 v69, v67, v69
  v_lshrrev_b32 v70, 4, v69
  v_and_b32 v69, 15, v69
  v_lshlrev_b32 v71, 12, v70
  v_lshl_add_u32 v71, v68, 8, v71
  v_lshl_add_u32 v71, v69, 4, v71
  v_add_u32 v110, v71, v75
  v_mov_b32 v74, 0x40000000
  v_mov_b32 v96, 0
  v_and_b32 v119, 15, v1
  s_and_b32 s22, s17, 0
  s_lshl_b32 s22, s22, 7
  s_add_u32 s22, s22, 39424
  v_lshl_add_u32 v119, v119, 2, s22
  s_lshl_b32 s22, s17, 2
  s_add_u32 s22, s22, 37376
  v_lshl_add_u32 v118, v1, 7, s22
  v_cmp_gt_u32 vcc, 1, v1
  s_nop 1
  v_cndmask_b32 v118, v74, v118, vcc
  s_lshl_b32 s35, s17, 7
  s_add_u32 s35, s35, 524288
  v_mov_b32 v64, 0
  v_mov_b32 v65, 0
  v_mov_b32 v66, 0
  v_mov_b32 v67, 0
  v_min_u32 v116, 13, v1
  s_mul_i32 s22, s17, 14
  v_add_u32 v116, s22, v116
  v_lshlrev_b32 v116, 7, v116
  s_mul_i32 s31, s17, 401408
  s_add_u32 s31, s31, 40278016
  s_mov_b32 s30, 0
ch_wr7:
  buffer_load_dword v9, off, s[12:15], 0 offset:128 sc1
  s_waitcnt vmcnt(0)
  v_cmp_ne_u32 vcc, 1, v9
  s_cbranch_vccz ch_wr7_ok
  s_sleep 8
  s_add_u32 s30, s30, 1
  s_cmp_lt_u32 s30, 400000
  s_cbranch_scc1 ch_wr7
  s_branch cA_abort
ch_wr7_ok:
  s_lshr_b32 s22, s17, 2
  s_lshl_b32 s28, 0x81, s22
  s_mul_i32 s27, s17, 12
  s_add_u32 s22, s27, 256
  s_lshr_b32 s22, s22, 6
  s_lshl_b32 s22, 0x81, s22
  s_or_b32 s28, s28, s22
  s_add_u32 s22, s27, 267
  s_lshr_b32 s22, s22, 6
  s_lshl_b32 s22, 0x81, s22
  s_or_b32 s28, s28, s22
  v_lshrrev_b32 v12, 8, v2
  v_lshlrev_b32 v12, 7, v12
  s_mov_b32 s27, 583680
  s_mov_b32 s30, 0
ch_ww7:
  buffer_load_dword v9, v12, s[8:11], s27 offen sc1
  s_waitcnt vmcnt(0)
  v_and_b32 v10, s28, v9
  v_cmp_ne_u32 vcc, s28, v10
  s_cbranch_vccz ch_ww7_ok
  s_sleep 3
  s_add_u32 s30, s30, 1
  s_cmp_lt_u32 s30, 400000
  s_cbranch_scc1 ch_ww7
  s_branch cA_abort
ch_ww7_ok:
  s_add_u32 s22, s31, 0
  buffer_load_dwordx4 a[0:3], v2, s[8:11], s22 offen offset:0 sc1
  buffer_load_dwordx4 a[4:7], v2, s[8:11], s22 offen offset:1024 sc1
  buffer_load_dwordx4 a[8:11], v2, s[8:11], s22 offen offset:2048 sc1
  buffer_load_dwordx4 a[12:15], v2, s[8:11], s22 offen offset:3072 sc1
  s_add_u32 s22, s31, 4096
  buffer_load_dwordx4 a[16:19], v2, s[8:11], s22 offen offset:0 sc1
  buffer_load_dwordx4 a[20:23], v2, s[8:11], s22 offen offset:1024 sc1
  buffer_load_dwordx4 a[24:27], v2, s[8:11], s22 offen offset:2048 sc1
  buffer_load_dwordx4 a[28:31], v2, s[8:11], s22 offen offset:3072 sc1
  s_add_u32 s22, s31, 8192
  buffer_load_dwordx4 a[32:35], v2, s[8:11], s22 offen offset:0 sc1
  buffer_load_dwordx4 a[36:39], v2, s[8:11], s22 offen offset:1024 sc1
  buffer_load_dwordx4 a[40:43], v2, s[8:11], s22 offen offset:2048 sc1
  buffer_load_dwordx4 a[44:47], v2, s[8:11], s22 offen offset:3072 sc1
  s_add_u32 s22, s31, 12288
  buffer_load_dwordx4 a[48:51], v2, s[8:11], s22 offen offset:0 sc1
  buffer_load_dwordx4 a[52:55], v2, s[8:11], s22 offen offset:1024 sc1
  buffer_load_dwordx4 a[56:59], v2, s[8:11], s22 offen offset:2048 sc1
  buffer_load_dwordx4 a[60:63], v2, s[8:11], s22 offen offset:3072 sc1
  s_add_u32 s22, s31, 16384
  buffer_load_dwordx4 a[64:67], v2, s[8:11], s22 offen offset:0 sc1
  buffer_load_dwordx4 a[68:71], v2, s[8:11], s22 offen offset:1024 sc1
  buffer_load_dwordx4 a[72:75], v2, s[8:11], s22 offen offset:2048 sc1
  buffer_load_dwordx4 a[76:79], v2, s[8:11], s22 offen offset:3072 sc1
  s_add_u32 s22, s31, 20480
  buffer_load_dwordx4 a[80:83], v2, s[8:11], s22 offen offset:0 sc1
  buffer_load_dwordx4 a[84:87], v2, s[8:11], s22 offen offset:1024 sc1
  buffer_load_dwordx4 a[88:91], v2, s[8:11], s22 offen offset:2048 sc1
  buffer_load_dwordx4 a[92:95], v2, s[8:11], s22 offen offset:3072 sc1
  s_add_u32 s22, s31, 24576
  buffer_load_dwordx4 a[96:99], v2, s[8:11], s22 offen offset:0 sc1
  buffer_load_dwordx4 a[100:103], v2, s[8:11], s22 offen offset:1024 sc1
  buffer_load_dwordx4 a[104:107], v2, s[8:11], s22 offen offset:2048 sc1
  buffer_load_dwordx4 a[108:111], v2, s[8:11], s22 offen offset:3072 sc1
  s_add_u32 s22, s31, 28672
  buffer_load_dwordx4 a[112:115], v2, s[8:11], s22 offen offset:0 sc1
  buffer_load_dwordx4 a[116:119], v2, s[8:11], s22 offen offset:1024 sc1
  buffer_load_dwordx4 a[120:123], v2, s[8:11], s22 offen offset:2048 sc1
  buffer_load_dwordx4 a[124:127], v2, s[8:11], s22 offen offset:3072 sc1
  s_waitcnt vmcnt(24)
  s_add_u32 s22, s31, 32768
  buffer_load_dwordx4 a[128:131], v2, s[8:11], s22 offen offset:0 sc1
  buffer_load_dwordx4 a[132:135], v2, s[8:11], s22 offen offset:1024 sc1
  buffer_load_dwordx4 a[136:139], v2, s[8:11], s22 offen offset:2048 sc1
  buffer_load_dwordx4 a[140:143], v2, s[8:11], s22 offen offset:3072 sc1
  s_add_u32 s22, s31, 36864
  buffer_load_dwordx4 a[144:147], v2, s[8:11], s22 offen offset:0 sc1
  buffer_load_dwordx4 a[148:151], v2, s[8:11], s22 offen offset:1024 sc1
  buffer_load_dwordx4 a[152:155], v2, s[8:11], s22 offen offset:2048 sc1
  buffer_load_dwordx4 a[156:159], v2, s[8:11], s22 offen offset:3072 sc1
  s_add_u32 s22, s31, 40960
  buffer_load_dwordx4 a[160:163], v2, s[8:11], s22 offen offset:0 sc1
  buffer_load_dwordx4 a[164:167], v2, s[8:11], s22 offen offset:1024 sc1
  buffer_load_dwordx4 a[168:171], v2, s[8:11], s22 offen offset:2048 sc1
  buffer_load_dwordx4 a[172:175], v2, s[8:11], s22 offen offset:3072 sc1
  s_add_u32 s22, s31, 45056
  buffer_load_dwordx4 a[176:179], v2, s[8:11], s22 offen offset:0 sc1
  buffer_load_dwordx4 a[180:183], v2, s[8:11], s22 offen offset:1024 sc1
  buffer_load_dwordx4 a[184:187], v2, s[8:11], s22 offen offset:2048 sc1
  buffer_load_dwordx4 a[188:191], v2, s[8:11], s22 offen offset:3072 sc1
  s_add_u32 s22, s31, 49152
  buffer_load_dwordx4 a[192:195], v2, s[8:11], s22 offen offset:0 sc1
  buffer_load_dwordx4 a[196:199], v2, s[8:11], s22 offen offset:1024 sc1
  buffer_load_dwordx4 a[200:203], v2, s[8:11], s22 offen offset:2048 sc1
  buffer_load_dwordx4 a[204:207], v2, s[8:11], s22 offen offset:3072 sc1
  s_add_u32 s22, s31, 53248
  buffer_load_dwordx4 a[208:211], v2, s[8:11], s22 offen offset:0 sc1
  buffer_load_dwordx4 a[212:215], v2, s[8:11], s22 offen offset:1024 sc1
  buffer_load_dwordx4 a[216:219], v2, s[8:11], s22 offen offset:2048 sc1
  buffer_load_dwordx4 a[220:223], v2, s[8:11], s22 offen offset:3072 sc1
  s_add_u32 s22, s31, 57344
  buffer_load_dwordx4 a[224:227], v2, s[8:11], s22 offen offset:0 sc1
  buffer_load_dwordx4 a[228:231], v2, s[8:11], s22 offen offset:1024 sc1
  buffer_load_dwordx4 a[232:235], v2, s[8:11], s22 offen offset:2048 sc1
  buffer_load_dwordx4 a[236:239], v2, s[8:11], s22 offen offset:3072 sc1
  s_add_u32 s22, s31, 61440
  buffer_load_dwordx4 a[240:243], v2, s[8:11], s22 offen offset:0 sc1
  buffer_load_dwordx4 a[244:247], v2, s[8:11], s22 offen offset:1024 sc1
  buffer_load_dwordx4 a[248:251], v2, s[8:11], s22 offen offset:2048 sc1
  buffer_load_dwordx4 a[252:255], v2, s[8:11], s22 offen offset:3072 sc1
  s_waitcnt vmcnt(24)
  s_add_u32 s22, s31, 65536
  buffer_load_dwordx4 v[120:123], v2, s[8:11], s22 offen offset:0 sc1
  buffer_load_dwordx4 v[124:127], v2, s[8:11], s22 offen offset:1024 sc1
  buffer_load_dwordx4 v[128:131], v2, s[8:11], s22 offen offset:2048 sc1
  buffer_load_dwordx4 v[132:135], v2, s[8:11], s22 offen offset:3072 sc1
  s_add_u32 s22, s31, 69632
  buffer_load_dwordx4 v[136:139], v2, s[8:11], s22 offen offset:0 sc1
  buffer_load_dwordx4 v[140:143], v2, s[8:11], s22 offen offset:1024 sc1
  buffer_load_dwordx4 v[144:147], v2, s[8:11], s22 offen offset:2048 sc1
  buffer_load_dwordx4 v[148:151], v2, s[8:11], s22 offen offset:3072 sc1
  s_add_u32 s22, s31, 73728
  buffer_load_dwordx4 v[152:155], v2, s[8:11], s22 offen offset:0 sc1
  buffer_load_dwordx4 v[156:159], v2, s[8:11], s22 offen offset:1024 sc1
  buffer_load_dwordx4 v[160:163], v2, s[8:11], s22 offen offset:2048 sc1
  buffer_load_dwordx4 v[164:167], v2, s[8:11], s22 offen offset:3072 sc1
  s_add_u32 s22, s31, 77824
  buffer_load_dwordx4 v[168:171], v2, s[8:11], s22 offen offset:0 sc1
  buffer_load_dwordx4 v[172:175], v2, s[8:11], s22 offen offset:1024 sc1
  buffer_load_dwordx4 v[176:179], v2, s[8:11], s22 offen offset:2048 sc1
  buffer_load_dwordx4 v[180:183], v2, s[8:11], s22 offen offset:3072 sc1
  s_add_u32 s22, s31, 81920
  buffer_load_dwordx4 v[184:187], v2, s[8:11], s22 offen offset:0 sc1
  buffer_load_dwordx4 v[188:191], v2, s[8:11], s22 offen offset:1024 sc1
  buffer_load_dwordx4 v[192:195], v2, s[8:11], s22 offen offset:2048 sc1
  buffer_load_dwordx4 v[196:199], v2, s[8:11], s22 offen offset:3072 sc1
  s_add_u32 s22, s31, 86016
  buffer_load_dwordx4 v[200:203], v2, s[8:11], s22 offen offset:0 sc1
  buffer_load_dwordx4 v[204:207], v2, s[8:11], s22 offen offset:1024 sc1
  buffer_load_dwordx4 v[208:211], v2, s[8:11], s22 offen offset:2048 sc1
  buffer_load_dwordx4 v[212:215], v2, s[8:11], s22 offen offset:3072 sc1
  s_add_u32 s22, s31, 90112
  buffer_load_dwordx4 v[216:219], v2, s[8:11], s22 offen offset:0 sc1
  buffer_load_dwordx4 v[220:223], v2, s[8:11], s22 offen offset:1024 sc1
  buffer_load_dwordx4 v[224:227], v2, s[8:11], s22 offen offset:2048 sc1
  buffer_load_dwordx4 v[228:231], v2, s[8:11], s22 offen offset:3072 sc1
  s_add_u32 s22, s31, 94208
  buffer_load_dwordx4 v[232:235], v2, s[8:11], s22 offen offset:0 sc1
  buffer_load_dwordx4 v[236:239], v2, s[8:11], s22 offen offset:1024 sc1
  buffer_load_dwordx4 v[240:243], v2, s[8:11], s22 offen offset:2048 sc1
  buffer_load_dwordx4 v[244:247], v2, s[8:11], s22 offen offset:3072 sc1
  s_waitcnt vmcnt(24)
  s_add_u32 s22, s31, 98304
  buffer_load_dwordx4 v[248:251], v2, s[8:11], s22 offen offset:0 sc1
  buffer_load_dwordx4 v[252:255], v2, s[8:11], s22 offen offset:1024 sc1
  s_mov_b32 s30, 0
ch_ws7:
  buffer_load_dword v9, off, s[12:15], 0 offset:132 sc1
  s_waitcnt vmcnt(0)
  v_cmp_ne_u32 vcc, 1, v9
  s_cbranch_vccz ch_ws7_ok
  s_sleep 8
  s_add_u32 s30, s30, 1
  s_cmp_lt_u32 s30, 400000
  s_cbranch_scc1 ch_ws7
  s_branch cA_abort
ch_ws7_ok:
  s_lshl_b32 s27, s17, 7
  s_add_u32 s27, s27, 524288
  s_mov_b32 s30, 0
ch_vw3:
  buffer_load_dword v9, off, s[8:11], s27 sc1
  s_waitcnt vmcnt(0)
  v_cmp_ne_u32 vcc, 56, v9
  s_cbranch_vccz ch_vw3_d
  s_sleep 2
  s_add_u32 s30, s30, 1
  s_cmp_lt_u32 s30, 400000
  s_cbranch_scc1 ch_vw3
  s_branch cA_abort
ch_vw3_d:
  s_mov_b32 s28, s35
  s_mov_b32 s39, 684032
  buffer_load_dword v100, v116, s[8:11], s39 offen sc1
  s_mov_b32 s39, 712704
  s_waitcnt vmcnt(1) lgkmcnt(0)
  s_mov_b32 s31, 0
  s_cmp_lg_u32 s88, 0
  s_cbranch_scc1 cB_va3_loop
  s_branch cA_va3_loop
.p2align 6
cA_sc0_loop:
  s_mov_b32 s30, 0
  s_mov_b32 s62, 0
  s_setprio 3
  s_sleep 6
cA_sc0_fp_l:
  v_cmp_gt_u32 vcc, s19, v112
  buffer_load_dword v112, v0, s[8:11], 0 offen sc1
  s_cbranch_vccz cA_sc0_fp_d
  v_cmp_gt_u32 vcc, s19, v112
  buffer_load_dword v112, v0, s[8:11], 0 offen sc1
  s_cbranch_vccz cA_sc0_fp_d
  v_cmp_gt_u32 vcc, s19, v112
  buffer_load_dword v112, v0, s[8:11], 0 offen sc1
  s_cbranch_vccz cA_sc0_fp_d
  v_cmp_gt_u32 vcc, s19, v112
  buffer_load_dword v112, v0, s[8:11], 0 offen sc1
  s_cbranch_vccz cA_sc0_fp_d
  v_cmp_gt_u32 vcc, s19, v112
  buffer_load_dword v112, v0, s[8:11], 0 offen sc1
  s_cbranch_vccz cA_sc0_fp_d
  v_cmp_gt_u32 vcc, s19, v112
  buffer_load_dword v112, v0, s[8:11], 0 offen sc1
  s_cbranch_vccz cA_sc0_fp_d
  v_cmp_gt_u32 vcc, s19, v112
  buffer_load_dword v112, v0, s[8:11], 0 offen sc1
  s_cbranch_vccz cA_sc0_fp_d
  v_cmp_gt_u32 vcc, s19, v112
  buffer_load_dword v112, v0, s[8:11], 0 offen sc1
  s_cbranch_vccz cA_sc0_fp_d
  v_cmp_gt_u32 vcc, s19, v112
  buffer_load_dword v112, v0, s[8:11], 0 offen sc1
  s_cbranch_vccz cA_sc0_fp_d
  v_cmp_gt_u32 vcc, s19, v112
  buffer_load_dword v112, v0, s[8:11], 0 offen sc1
  s_cbranch_vccz cA_sc0_fp_d
  v_cmp_gt_u32 vcc, s19, v112
  buffer_load_dword v112, v0, s[8:11], 0 offen sc1
  s_cbranch_vccz cA_sc0_fp_d
  v_cmp_gt_u32 vcc, s19, v112
  buffer_load_dword v112, v0, s[8:11], 0 offen sc1
  s_cbranch_vccz cA_sc0_fp_d
  v_cmp_gt_u32 vcc, s19, v112
  buffer_load_dword v112, v0, s[8:11], 0 offen sc1
  s_cbranch_vccz cA_sc0_fp_d
  v_cmp_gt_u32 vcc, s19, v112
  buffer_load_dword v112, v0, s[8:11], 0 offen sc1
  s_cbranch_vccz cA_sc0_fp_d
  v_cmp_gt_u32 vcc, s19, v112
  buffer_load_dword v112, v0, s[8:11], 0 offen sc1
  s_cbranch_vccz cA_sc0_fp_d
  v_cmp_gt_u32 vcc, s19, v112
  buffer_load_dword v112, v0, s[8:11], 0 offen sc1
  s_cbranch_vccz cA_sc0_fp_d
  s_waitcnt vmcnt(24)
  s_add_u32 s30, s30, 1
  s_cmp_lt_u32 s30, 400000
  s_cbranch_scc1 cA_sc0_fp_l
  s_branch cA_abort
cA_sc0_fp_d:
  buffer_load_dwordx4 v[8:11], v2, s[8:11], s20 offen offset:0 sc1
  s_barrier
  s_setprio 2
  buffer_load_dwordx4 v[12:15], v2, s[8:11], s20 offen offset:1024 sc1
  s_setprio 1
  buffer_load_dwordx4 v[16:19], v2, s[8:11], s20 offen offset:2048 sc1
  s_setprio 0
  buffer_load_dwordx4 v[20:23], v2, s[8:11], s20 offen offset:3072 sc1
cA_sc0_go:
  s_waitcnt vmcnt(3)
  v_smfmac_f32_16x16x64_bf16 v[36:39], v[8:11], a[0:7], v3
  buffer_load_dwordx4 v[32:35], v2, s[8:11], s23 offen offset:0 sc1
  v_cmp_eq_u32 vcc, -1, v8
  v_smfmac_f32_16x16x64_bf16 v[40:43], v[8:11], a[56:63], v3
  v_smfmac_f32_16x16x64_bf16 v[44:47], v[8:11], a[112:119], v3
  buffer_load_dwordx4 v[24:27], v2, s[8:11], s23 offen offset:1024 sc1
  s_cbranch_vccnz cA_sc0_r0
  v_smfmac_f32_16x16x64_bf16 v[48:51], v[8:11], a[168:175], v3
  v_smfmac_f32_16x16x64_bf16 v[52:55], v[8:11], a[224:231], v3
  v_smfmac_f32_16x16x64_bf16 v[56:59], v[8:11], v[144:151], v3
  buffer_load_dwordx4 v[28:31], v2, s[8:11], s23 offen offset:2048 sc1
  v_smfmac_f32_16x16x64_bf16 v[60:63], v[8:11], v[200:207], v3
  s_waitcnt vmcnt(5)
  v_smfmac_f32_16x16x64_bf16 v[36:39], v[12:15], a[8:15], v3
  v_cmp_eq_u32 vcc, -1, v12
  v_smfmac_f32_16x16x64_bf16 v[40:43], v[12:15], a[64:71], v3
  v_smfmac_f32_16x16x64_bf16 v[44:47], v[12:15], a[120:127], v3
  s_cbranch_vccnz cA_sc0_r1
  v_smfmac_f32_16x16x64_bf16 v[48:51], v[12:15], a[176:183], v3
  v_smfmac_f32_16x16x64_bf16 v[52:55], v[12:15], a[232:239], v3
  v_smfmac_f32_16x16x64_bf16 v[56:59], v[12:15], v[152:159], v3
  buffer_load_dwordx4 v[88:91], v117, s[8:11], s26 offen offset:0 sc1
  v_smfmac_f32_16x16x64_bf16 v[60:63], v[12:15], v[208:215], v3
  s_waitcnt vmcnt(5)
  v_smfmac_f32_16x16x64_bf16 v[36:39], v[16:19], a[16:23], v3
  v_cmp_eq_u32 vcc, -1, v16
  v_smfmac_f32_16x16x64_bf16 v[40:43], v[16:19], a[72:79], v3
  v_smfmac_f32_16x16x64_bf16 v[44:47], v[16:19], a[128:135], v3
  s_cbranch_vccnz cA_sc0_r2
  buffer_load_dwordx4 v[92:95], v117, s[8:11], s26 offen offset:1024 sc1
  v_smfmac_f32_16x16x64_bf16 v[48:51], v[16:19], a[184:191], v3
  v_smfmac_f32_16x16x64_bf16 v[52:55], v[16:19], a[240:247], v3
  v_smfmac_f32_16x16x64_bf16 v[56:59], v[16:19], v[160:167], v3
  v_smfmac_f32_16x16x64_bf16 v[60:63], v[16:19], v[216:223], v3
  s_waitcnt vmcnt(5)
  buffer_load_dwordx4 v[96:99], v2, s[8:11], s24 offen offset:0 sc1
  v_smfmac_f32_16x16x64_bf16 v[36:39], v[20:23], a[24:31], v3
  v_cmp_eq_u32 vcc, -1, v20
  v_smfmac_f32_16x16x64_bf16 v[40:43], v[20:23], a[80:87], v3
  s_waitcnt vmcnt(3)
  v_max3_u32 v66, v24, v27, v28
  v_smfmac_f32_16x16x64_bf16 v[44:47], v[20:23], a[136:143], v3
  s_cbranch_vccnz cA_sc0_r3
  v_max3_u32 v66, v66, v31, v32
  v_smfmac_f32_16x16x64_bf16 v[48:51], v[20:23], a[192:199], v3
  buffer_load_dwordx4 v[100:103], v2, s[8:11], s24 offen offset:1024 sc1
  v_max_u32 v66, v66, v35
  v_smfmac_f32_16x16x64_bf16 v[52:55], v[20:23], a[248:255], v3
  v_cmp_eq_u32 vcc, -1, v66
  v_smfmac_f32_16x16x64_bf16 v[56:59], v[20:23], v[168:175], v3
  v_smfmac_f32_16x16x64_bf16 v[60:63], v[20:23], v[224:231], v3
  s_cbranch_vccnz cA_sc0_r4
cA_sc0_c4:
  v_smfmac_f32_16x16x64_bf16 v[60:63], v[32:35], v[232:239], v3
  buffer_load_dwordx4 v[104:107], v2, s[8:11], s26 offen offset:0 sc1
  v_smfmac_f32_16x16x64_bf16 v[60:63], v[24:27], v[240:247], v3
  v_smfmac_f32_16x16x64_bf16 v[60:63], v[28:31], v[248:255], v3
  v_smfmac_f32_16x16x64_bf16 v[52:55], v[32:35], v[120:127], v3
  v_smfmac_f32_16x16x64_bf16 v[52:55], v[24:27], v[128:135], v3
  buffer_load_dwordx4 v[108:111], v2, s[8:11], s26 offen offset:1024 sc1
  v_smfmac_f32_16x16x64_bf16 v[52:55], v[28:31], v[136:143], v3
  v_cvt_pk_bf16_f32 v63, v62, v63
  v_smfmac_f32_16x16x64_bf16 v[56:59], v[32:35], v[176:183], v3
  v_cvt_pk_bf16_f32 v62, v60, v61
  v_smfmac_f32_16x16x64_bf16 v[56:59], v[24:27], v[184:191], v3
  v_mfma_f32_16x16x32_bf16 v[12:15], v[62:65], v[4:7], 0
  v_cvt_pk_bf16_f32 v55, v54, v55
  v_smfmac_f32_16x16x64_bf16 v[56:59], v[28:31], v[192:199], v3
  v_cvt_pk_bf16_f32 v54, v52, v53
  v_smfmac_f32_16x16x64_bf16 v[36:39], v[32:35], a[32:39], v3
  s_nop 1
  v_cvt_pk_bf16_f32 v76, v12, v13
  v_smfmac_f32_16x16x64_bf16 v[36:39], v[24:27], a[40:47], v3
  v_cvt_pk_bf16_f32 v77, v14, v15
  v_smfmac_f32_16x16x64_bf16 v[36:39], v[28:31], a[48:55], v3
  v_cvt_pk_bf16_f32 v56, v56, v57
  v_smfmac_f32_16x16x64_bf16 v[40:43], v[32:35], a[88:95], v3
  v_cvt_pk_bf16_f32 v57, v58, v59
  v_smfmac_f32_16x16x64_bf16 v[40:43], v[24:27], a[96:103], v3
  v_mfma_f32_16x16x32_bf16 v[16:19], v[54:57], v[4:7], 0
  v_cvt_pk_bf16_f32 v39, v38, v39
  v_smfmac_f32_16x16x64_bf16 v[40:43], v[28:31], a[104:111], v3
  v_cvt_pk_bf16_f32 v38, v36, v37
  v_smfmac_f32_16x16x64_bf16 v[44:47], v[32:35], a[144:151], v3
  s_nop 1
  v_cvt_pk_bf16_f32 v78, v16, v17
  v_smfmac_f32_16x16x64_bf16 v[44:47], v[24:27], a[152:159], v3
  v_cvt_pk_bf16_f32 v79, v18, v19
  v_smfmac_f32_16x16x64_bf16 v[44:47], v[28:31], a[160:167], v3
  v_cvt_pk_bf16_f32 v40, v40, v41
  v_smfmac_f32_16x16x64_bf16 v[48:51], v[32:35], a[200:207], v3
  v_cvt_pk_bf16_f32 v41, v42, v43
  v_smfmac_f32_16x16x64_bf16 v[48:51], v[24:27], a[208:215], v3
  v_smfmac_f32_16x16x64_bf16 v[48:51], v[28:31], a[216:223], v3
  s_waitcnt vmcnt(4)
  v_cvt_pk_bf16_f32 v47, v46, v47
  v_smfmac_f32_16x16x64_bf16 v[68:71], v[76:79], v[80:87], v3
  v_cvt_pk_bf16_f32 v46, v44, v45
  v_mfma_f32_16x16x32_bf16 v[12:15], v[38:41], v[4:7], 0
  s_nop 1
  v_cvt_pk_bf16_f32 v48, v48, v49
  v_cvt_pk_bf16_f32 v49, v50, v51
  s_nop 1
  v_mfma_f32_16x16x32_bf16 v[16:19], v[46:49], v[4:7], 0
  v_smfmac_f32_16x16x64_bf16 v[72:75], v[76:79], v[88:95], v3
  v_cvt_pk_bf16_f32 v20, v12, v13
  v_mfma_f32_16x16x32_bf16 v[52:55], v[30:33], v[76:79], 0
  s_waitcnt vmcnt(0)
  v_cvt_pk_bf16_f32 v21, v14, v15
  v_cvt_pk_bf16_f32 v22, v16, v17
  v_cvt_pk_bf16_f32 v23, v18, v19
  s_nop 1
  v_mfma_f32_16x16x32_bf16 v[52:55], v[8:11], v[20:23], v[52:55]
  v_smfmac_f32_16x16x64_bf16 v[68:71], v[20:23], v[96:103], v3
  v_smfmac_f32_16x16x64_bf16 v[72:75], v[20:23], v[104:111], v3
  s_nop 1
  ds_write_b128 v113, v[52:55]
  s_nop 1
  v_permlane32_swap_b32 v68, v70
  v_permlane32_swap_b32 v69, v71
  v_add_f32 v56, v68, v70
  v_add_f32 v58, v69, v71
  v_permlane32_swap_b32 v72, v74
  v_permlane32_swap_b32 v73, v75
  v_add_f32 v57, v72, v74
  v_add_f32 v59, v73, v75
  ds_write_b128 v2, v[56:59] offset:0
  v_cmp_u_f32 vcc, v57, v59
  v_mov_b32 v68, 0
  v_mov_b32 v69, 0
  v_mov_b32 v70, 0
  v_mov_b32 v71, 0
  s_cbranch_vccnz cA_sc0_retry
cA_sc0_cont:
  s_add_u32 s24, s24, 28672
  s_add_u32 s26, s26, 28672
  buffer_load_dwordx4 v[80:83], v117, s[8:11], s24 offen offset:0 sc1
  buffer_load_dwordx4 v[84:87], v117, s[8:11], s24 offen offset:1024 sc1
  v_mov_b32 v72, 0
  v_mov_b32 v73, 0
  v_mfma_f32_32x32x16_bf16 v[36:51], v[68:71], v[68:71], 0
  s_waitcnt lgkmcnt(0)
  s_barrier
  ds_read_b64 v[8:9], v114 offset:0
  ds_read_b64 v[10:11], v114 offset:1024
  ds_read_b64 v[12:13], v114 offset:2048
  ds_read_b64 v[14:15], v114 offset:3072
  ds_read2_b32 v[16:17], v115 offset0:0 offset1:64
  ds_read2_b32 v[18:19], v115 offset0:128 offset1:192
  v_mfma_f32_32x32x16_bf16 v[52:67], v[68:71], v[68:71], 0
  s_waitcnt lgkmcnt(0)
  v_pk_add_f32 v[16:17], v[16:17], v[18:19]
  v_pk_add_f32 v[8:9], v[8:9], v[10:11]
  v_pk_add_f32 v[12:13], v[12:13], v[14:15]
  v_add_f32 v20, v16, v17
  v_pk_add_f32 v[8:9], v[8:9], v[12:13]
  v_max_f32 v22, v8, v9
  v_add_f32_dpp v20, v20, v20 row_ror:8 row_mask:0xf bank_mask:0xf
  s_nop 0
  v_max_f32_dpp v22, v22, v22 row_ror:8 row_mask:0xf bank_mask:0xf
  v_max_f32 v22, v22, v20
  s_nop 1
  v_max_f32_dpp v22, v22, v22 quad_perm:[1,0,3,2] row_mask:0xf bank_mask:0xf
  s_nop 1
  v_max_f32_dpp v22, v22, v22 quad_perm:[2,3,0,1] row_mask:0xf bank_mask:0xf
  s_nop 1
  v_max_f32_dpp v22, v22, v22 row_half_mirror row_mask:0xf bank_mask:0xf
  v_pk_add_f32 v[8:9], v[8:9], v[22:23] op_sel_hi:[1,0] neg_lo:[0,1] neg_hi:[0,1]
  v_sub_f32 v20, v20, v22
  v_exp_f32 v8, v8
  v_exp_f32 v9, v9
  v_exp_f32 v20, v20
  v_add_f32 v24, v8, v9
  v_fmac_f32 v24, 0.5, v20
  v_mov_b32_dpp v21, v20 quad_perm:[1,0,3,2] row_mask:0xf bank_mask:0xf
  s_nop 0
  v_add_f32_dpp v24, v24, v24 quad_perm:[1,0,3,2] row_mask:0xf bank_mask:0xf
  s_nop 1
  v_add_f32_dpp v24, v24, v24 quad_perm:[2,3,0,1] row_mask:0xf bank_mask:0xf
  s_nop 1
  v_add_f32_dpp v24, v24, v24 row_half_mirror row_mask:0xf bank_mask:0xf
  s_nop 1
  v_add_f32_dpp v24, v24, v24 row_ror:8 row_mask:0xf bank_mask:0xf
  v_rcp_f32 v24, v24
  s_nop 0
  v_pk_mul_f32 v[8:9], v[8:9], v[24:25] op_sel_hi:[1,0]
  v_cvt_pk_bf16_f32 v8, abs(v8), abs(v9)
  buffer_store_dword v8, v1, s[8:11], s20 offen
  v_pk_mul_f32 v[20:21], v[20:21], v[24:25] op_sel_hi:[1,0]
  v_cvt_pk_bf16_f32 v20, abs(v20), abs(v21)
  buffer_store_dword v20, v118, s[8:11], s20 offen
  v_mov_b32 v74, 0
  v_mov_b32 v75, 0
  s_mov_b32 s19, s18
  s_add_u32 s18, s18, 1
  s_mov_b32 s22, s20
  s_mov_b32 s20, s21
  s_mov_b32 s21, s22
  s_add_u32 s23, s20, 4096
  s_cmp_lt_u32 s19, 63
  s_cbranch_scc1 cA_sc0_loop
  s_branch cA_done
cA_sc0_r0:
  s_add_u32 s31, s31, 1
  buffer_load_dwordx4 v[8:11], v2, s[8:11], s20 offen offset:0 sc1
  s_waitcnt vmcnt(0)
  v_cmp_eq_u32 vcc, -1, v8
  v_mov_b32 v36, 0
  v_mov_b32 v37, 0
  v_mov_b32 v38, 0
  v_mov_b32 v39, 0
  v_mov_b32 v40, 0
  v_mov_b32 v41, 0
  v_mov_b32 v42, 0
  v_mov_b32 v43, 0
  v_mov_b32 v44, 0
  v_mov_b32 v45, 0
  v_mov_b32 v46, 0
  v_mov_b32 v47, 0
  v_mov_b32 v48, 0
  v_mov_b32 v49, 0
  v_mov_b32 v50, 0
  v_mov_b32 v51, 0
  s_nop 1
  s_cbranch_vccz cA_sc0_go
  s_add_u32 s30, s30, 1
  s_cmp_lt_u32 s30, 400000
  s_cbranch_scc1 cA_sc0_r0
  s_branch cA_abort
cA_sc0_r1:
  s_add_u32 s31, s31, 1
  buffer_load_dwordx4 v[12:15], v2, s[8:11], s20 offen offset:1024 sc1
  s_waitcnt vmcnt(0)
  v_cmp_eq_u32 vcc, -1, v12
  s_nop 4
  s_cbranch_vccz cA_sc0_rz
  s_add_u32 s30, s30, 1
  s_cmp_lt_u32 s30, 400000
  s_cbranch_scc1 cA_sc0_r1
  s_branch cA_abort
cA_sc0_r2:
  s_add_u32 s31, s31, 1
  buffer_load_dwordx4 v[16:19], v2, s[8:11], s20 offen offset:2048 sc1
  s_waitcnt vmcnt(0)
  v_cmp_eq_u32 vcc, -1, v16
  s_nop 4
  s_cbranch_vccz cA_sc0_rz
  s_add_u32 s30, s30, 1
  s_cmp_lt_u32 s30, 400000
  s_cbranch_scc1 cA_sc0_r2
  s_branch cA_abort
cA_sc0_r3:
  s_add_u32 s31, s31, 1
  buffer_load_dwordx4 v[20:23], v2, s[8:11], s20 offen offset:3072 sc1
  s_waitcnt vmcnt(0)
  v_cmp_eq_u32 vcc, -1, v20
  s_nop 4
  s_cbranch_vccz cA_sc0_rz
  s_add_u32 s30, s30, 1
  s_cmp_lt_u32 s30, 400000
  s_cbranch_scc1 cA_sc0_r3
  s_branch cA_abort
cA_sc0_r4:
  s_add_u32 s31, s31, 1
  buffer_load_dwordx4 v[32:35], v2, s[8:11], s23 offen offset:0 sc1
  buffer_load_dwordx4 v[24:27], v2, s[8:11], s23 offen offset:1024 sc1
  buffer_load_dwordx4 v[28:31], v2, s[8:11], s23 offen offset:2048 sc1
  s_waitcnt vmcnt(0)
  v_max3_u32 v66, v24, v27, v28
  v_max3_u32 v66, v66, v31, v32
  v_max_u32 v66, v66, v35
  v_cmp_eq_u32 vcc, -1, v66
  s_nop 4
  s_cbranch_vccz cA_sc0_c4
  s_add_u32 s30, s30, 1
  s_cmp_lt_u32 s30, 400000
  s_cbranch_scc1 cA_sc0_r4
  s_branch cA_abort
cA_sc0_retry:
  s_cmp_lg_u32 s62, 0
  s_cbranch_scc1 cA_sc0_cont
  s_waitcnt vmcnt(0) lgkmcnt(0)
cA_sc0_rv:
  buffer_load_dwordx4 v[8:11], v2, s[8:11], s20 offen offset:0 sc1
  buffer_load_dwordx4 v[12:15], v2, s[8:11], s20 offen offset:1024 sc1
  buffer_load_dwordx4 v[16:19], v2, s[8:11], s20 offen offset:2048 sc1
  buffer_load_dwordx4 v[20:23], v2, s[8:11], s20 offen offset:3072 sc1
  buffer_load_dwordx4 v[32:35], v2, s[8:11], s23 offen offset:0 sc1
  buffer_load_dwordx4 v[24:27], v2, s[8:11], s23 offen offset:1024 sc1
  buffer_load_dwordx4 v[28:31], v2, s[8:11], s23 offen offset:2048 sc1
  s_waitcnt vmcnt(0)
  v_max3_u32 v66, v8, v9, v10
  v_max3_u32 v66, v66, v11, v12
  v_max3_u32 v66, v66, v13, v14
  v_max3_u32 v66, v66, v15, v16
  v_max3_u32 v66, v66, v17, v18
  v_max3_u32 v66, v66, v19, v20
  v_max3_u32 v66, v66, v21, v22
  v_max3_u32 v66, v66, v23, v24
  v_max3_u32 v66, v66, v25, v26
  v_max3_u32 v66, v66, v27, v28
  v_max3_u32 v66, v66, v29, v30
  v_max3_u32 v66, v66, v31, v32
  v_max3_u32 v66, v66, v33, v34
  v_max_u32 v66, v66, v35
  v_cmp_eq_u32 vcc, -1, v66
  s_cbranch_vccz cA_sc0_rk
  s_add_u32 s30, s30, 1
  s_cmp_lt_u32 s30, 400000
  s_cbranch_scc1 cA_sc0_rv
  s_branch cA_abort
cA_sc0_rk:
  s_mov_b32 s62, 1
  s_add_u32 s31, s31, 0x100
cA_sc0_rz:
  v_mov_b32 v36, 0
  v_mov_b32 v37, 0
  v_mov_b32 v38, 0
  v_mov_b32 v39, 0
  v_mov_b32 v40, 0
  v_mov_b32 v41, 0
  v_mov_b32 v42, 0
  v_mov_b32 v43, 0
  v_mov_b32 v44, 0
  v_mov_b32 v45, 0
  v_mov_b32 v46, 0
  v_mov_b32 v47, 0
  v_mov_b32 v48, 0
  v_mov_b32 v49, 0
  v_mov_b32 v50, 0
  v_mov_b32 v51, 0
  v_mov_b32 v60, 0
  v_mov_b32 v61, 0
  v_mov_b32 v62, 0
  v_mov_b32 v63, 0
  v_mov_b32 v68, 0
  v_mov_b32 v69, 0
  v_mov_b32 v70, 0
  v_mov_b32 v71, 0
  v_mov_b32 v72, 0
  v_mov_b32 v73, 0
  v_mov_b32 v74, 0
  v_mov_b32 v75, 0
  v_mov_b32 v52, 0
  v_mov_b32 v53, 0
  v_mov_b32 v54, 0
  v_mov_b32 v55, 0
  v_mov_b32 v56, 0
  v_mov_b32 v57, 0
  v_mov_b32 v58, 0
  v_mov_b32 v59, 0
  s_nop 1
  s_branch cA_sc0_go
.p2align 6
cA_sc1_loop:
  s_mov_b32 s30, 0
  s_mov_b32 s62, 0
  s_setprio 3
  s_barrier
  buffer_load_dwordx4 v[12:15], v2, s[8:11], s20 offen offset:1024 sc1
  s_setprio 2
  buffer_load_dwordx4 v[16:19], v2, s[8:11], s20 offen offset:2048 sc1
  s_setprio 1
  buffer_load_dwordx4 v[20:23], v2, s[8:11], s20 offen offset:3072 sc1
  s_setprio 0
  buffer_load_dwordx4 v[8:11], v2, s[8:11], s20 offen offset:0 sc1
cA_sc1_go:
  s_waitcnt vmcnt(3)
  v_smfmac_f32_16x16x64_bf16 v[36:39], v[12:15], a[8:15], v3
  buffer_load_dwordx4 v[24:27], v2, s[8:11], s23 offen offset:1024 sc1
  v_cmp_eq_u32 vcc, -1, v12
  v_smfmac_f32_16x16x64_bf16 v[40:43], v[12:15], a[64:71], v3
  v_smfmac_f32_16x16x64_bf16 v[44:47], v[12:15], a[120:127], v3
  buffer_load_dwordx4 v[32:35], v2, s[8:11], s23 offen offset:2048 sc1
  s_cbranch_vccnz cA_sc1_r0
  v_smfmac_f32_16x16x64_bf16 v[48:51], v[12:15], a[176:183], v3
  v_smfmac_f32_16x16x64_bf16 v[52:55], v[12:15], a[232:239], v3
  v_smfmac_f32_16x16x64_bf16 v[56:59], v[12:15], v[152:159], v3
  buffer_load_dwordx4 v[28:31], v2, s[8:11], s23 offen offset:0 sc1
  v_smfmac_f32_16x16x64_bf16 v[60:63], v[12:15], v[208:215], v3
  s_waitcnt vmcnt(5)
  v_smfmac_f32_16x16x64_bf16 v[36:39], v[16:19], a[16:23], v3
  v_cmp_eq_u32 vcc, -1, v16
  v_smfmac_f32_16x16x64_bf16 v[40:43], v[16:19], a[72:79], v3
  v_smfmac_f32_16x16x64_bf16 v[44:47], v[16:19], a[128:135], v3
  s_cbranch_vccnz cA_sc1_r1
  v_smfmac_f32_16x16x64_bf16 v[48:51], v[16:19], a[184:191], v3
  v_smfmac_f32_16x16x64_bf16 v[52:55], v[16:19], a[240:247], v3
  v_smfmac_f32_16x16x64_bf16 v[56:59], v[16:19], v[160:167], v3
  buffer_load_dwordx4 v[88:91], v117, s[8:11], s26 offen offset:0 sc1
  v_smfmac_f32_16x16x64_bf16 v[60:63], v[16:19], v[216:223], v3
  s_waitcnt vmcnt(5)
  v_smfmac_f32_16x16x64_bf16 v[36:39], v[20:23], a[24:31], v3
  v_cmp_eq_u32 vcc, -1, v20
  v_smfmac_f32_16x16x64_bf16 v[40:43], v[20:23], a[80:87], v3
  v_smfmac_f32_16x16x64_bf16 v[44:47], v[20:23], a[136:143], v3
  s_cbranch_vccnz cA_sc1_r2
  buffer_load_dwordx4 v[92:95], v117, s[8:11], s26 offen offset:1024 sc1
  v_smfmac_f32_16x16x64_bf16 v[48:51], v[20:23], a[192:199], v3
  v_smfmac_f32_16x16x64_bf16 v[52:55], v[20:23], a[248:255], v3
  v_smfmac_f32_16x16x64_bf16 v[56:59], v[20:23], v[168:175], v3
  v_smfmac_f32_16x16x64_bf16 v[60:63], v[20:23], v[224:231], v3
  s_waitcnt vmcnt(5)
  buffer_load_dwordx4 v[96:99], v2, s[8:11], s24 offen offset:0 sc1
  v_smfmac_f32_16x16x64_bf16 v[36:39], v[8:11], a[0:7], v3
  v_cmp_eq_u32 vcc, -1, v8
  v_smfmac_f32_16x16x64_bf16 v[40:43], v[8:11], a[56:63], v3
  s_waitcnt vmcnt(3)
  v_max3_u32 v66, v24, v27, v28
  v_smfmac_f32_16x16x64_bf16 v[44:47], v[8:11], a[112:119], v3
  s_cbranch_vccnz cA_sc1_r3
  v_max3_u32 v66, v66, v31, v32
  v_smfmac_f32_16x16x64_bf16 v[48:51], v[8:11], a[168:175], v3
  buffer_load_dwordx4 v[100:103], v2, s[8:11], s24 offen offset:1024 sc1
  v_max_u32 v66, v66, v35
  v_smfmac_f32_16x16x64_bf16 v[52:55], v[8:11], a[224:231], v3
  v_cmp_eq_u32 vcc, -1, v66
  v_smfmac_f32_16x16x64_bf16 v[56:59], v[8:11], v[144:151], v3
  v_smfmac_f32_16x16x64_bf16 v[60:63], v[8:11], v[200:207], v3
  s_cbranch_vccnz cA_sc1_r4
cA_sc1_c4:
  v_smfmac_f32_16x16x64_bf16 v[60:63], v[28:31], v[232:239], v3
  buffer_load_dwordx4 v[104:107], v2, s[8:11], s26 offen offset:0 sc1
  v_smfmac_f32_16x16x64_bf16 v[60:63], v[24:27], v[240:247], v3
  v_smfmac_f32_16x16x64_bf16 v[60:63], v[32:35], v[248:255], v3
  v_smfmac_f32_16x16x64_bf16 v[52:55], v[28:31], v[120:127], v3
  v_smfmac_f32_16x16x64_bf16 v[52:55], v[24:27], v[128:135], v3
  buffer_load_dwordx4 v[108:111], v2, s[8:11], s26 offen offset:1024 sc1
  v_smfmac_f32_16x16x64_bf16 v[52:55], v[32:35], v[136:143], v3
  v_cvt_pk_bf16_f32 v63, v62, v63
  v_smfmac_f32_16x16x64_bf16 v[56:59], v[28:31], v[176:183], v3
  v_cvt_pk_bf16_f32 v62, v60, v61
  v_smfmac_f32_16x16x64_bf16 v[56:59], v[24:27], v[184:191], v3
  v_mfma_f32_16x16x32_bf16 v[8:11], v[62:65], v[4:7], 0
  v_cvt_pk_bf16_f32 v55, v54, v55
  v_smfmac_f32_16x16x64_bf16 v[56:59], v[32:35], v[192:199], v3
  v_cvt_pk_bf16_f32 v54, v52, v53
  v_smfmac_f32_16x16x64_bf16 v[36:39], v[28:31], a[32:39], v3
  s_nop 1
  v_cvt_pk_bf16_f32 v78, v8, v9
  v_smfmac_f32_16x16x64_bf16 v[36:39], v[24:27], a[40:47], v3
  v_cvt_pk_bf16_f32 v79, v10, v11
  v_smfmac_f32_16x16x64_bf16 v[36:39], v[32:35], a[48:55], v3
  v_cvt_pk_bf16_f32 v56, v56, v57
  v_smfmac_f32_16x16x64_bf16 v[40:43], v[28:31], a[88:95], v3
  v_cvt_pk_bf16_f32 v57, v58, v59
  v_smfmac_f32_16x16x64_bf16 v[40:43], v[24:27], a[96:103], v3
  v_mfma_f32_16x16x32_bf16 v[16:19], v[54:57], v[4:7], 0
  v_cvt_pk_bf16_f32 v39, v38, v39
  v_smfmac_f32_16x16x64_bf16 v[40:43], v[32:35], a[104:111], v3
  v_cvt_pk_bf16_f32 v38, v36, v37
  v_smfmac_f32_16x16x64_bf16 v[44:47], v[28:31], a[144:151], v3
  s_nop 1
  v_cvt_pk_bf16_f32 v76, v16, v17
  v_smfmac_f32_16x16x64_bf16 v[44:47], v[24:27], a[152:159], v3
  v_cvt_pk_bf16_f32 v77, v18, v19
  v_smfmac_f32_16x16x64_bf16 v[44:47], v[32:35], a[160:167], v3
  v_cvt_pk_bf16_f32 v40, v40, v41
  v_smfmac_f32_16x16x64_bf16 v[48:51], v[28:31], a[200:207], v3
  v_cvt_pk_bf16_f32 v41, v42, v43
  v_smfmac_f32_16x16x64_bf16 v[48:51], v[24:27], a[208:215], v3
  v_smfmac_f32_16x16x64_bf16 v[48:51], v[32:35], a[216:223], v3
  s_waitcnt vmcnt(4)
  v_cvt_pk_bf16_f32 v47, v46, v47
  v_smfmac_f32_16x16x64_bf16 v[68:71], v[76:79], v[80:87], v3
  v_cvt_pk_bf16_f32 v46, v44, v45
  v_mfma_f32_16x16x32_bf16 v[8:11], v[38:41], v[4:7], 0
  s_nop 1
  v_cvt_pk_bf16_f32 v48, v48, v49
  v_cvt_pk_bf16_f32 v49, v50, v51
  s_nop 1
  v_mfma_f32_16x16x32_bf16 v[16:19], v[46:49], v[4:7], 0
  v_smfmac_f32_16x16x64_bf16 v[72:75], v[76:79], v[88:95], v3
  v_cvt_pk_bf16_f32 v20, v8, v9
  v_mfma_f32_16x16x32_bf16 v[52:55], v[30:33], v[76:79], 0
  s_waitcnt vmcnt(0)
  v_cvt_pk_bf16_f32 v21, v10, v11
  v_cvt_pk_bf16_f32 v22, v16, v17
  v_cvt_pk_bf16_f32 v23, v18, v19
  s_nop 1
  v_mfma_f32_16x16x32_bf16 v[52:55], v[12:15], v[20:23], v[52:55]
  v_smfmac_f32_16x16x64_bf16 v[68:71], v[20:23], v[96:103], v3
  v_smfmac_f32_16x16x64_bf16 v[72:75], v[20:23], v[104:111], v3
  s_nop 1
  ds_write_b128 v113, v[52:55]
  s_nop 1
  v_permlane32_swap_b32 v68, v70
  v_permlane32_swap_b32 v69, v71
  v_add_f32 v56, v68, v70
  v_add_f32 v58, v69, v71
  v_permlane32_swap_b32 v72, v74
  v_permlane32_swap_b32 v73, v75
  v_add_f32 v57, v72, v74
  v_add_f32 v59, v73, v75
  ds_write_b128 v2, v[56:59] offset:1024
  v_cmp_u_f32 vcc, v57, v59
  v_mov_b32 v68, 0
  v_mov_b32 v69, 0
  v_mov_b32 v70, 0
  v_mov_b32 v71, 0
  s_cbranch_vccnz cA_sc1_retry
cA_sc1_cont:
  s_add_u32 s24, s24, 28672
  s_add_u32 s26, s26, 28672
  buffer_load_dwordx4 v[80:83], v117, s[8:11], s24 offen offset:0 sc1
  buffer_load_dwordx4 v[84:87], v117, s[8:11], s24 offen offset:1024 sc1
  v_mov_b32 v72, 0
  v_mov_b32 v73, 0
  v_mfma_f32_32x32x16_bf16 v[36:51], v[68:71], v[68:71], 0
  s_waitcnt lgkmcnt(0)
  s_barrier
  ds_read_b64 v[8:9], v114 offset:0
  ds_read_b64 v[10:11], v114 offset:1024
  ds_read_b64 v[12:13], v114 offset:2048
  ds_read_b64 v[14:15], v114 offset:3072
  ds_read2_b32 v[16:17], v115 offset0:0 offset1:64
  ds_read2_b32 v[18:19], v115 offset0:128 offset1:192
  v_mfma_f32_32x32x16_bf16 v[52:67], v[68:71], v[68:71], 0
  s_waitcnt lgkmcnt(0)
  v_pk_add_f32 v[16:17], v[16:17], v[18:19]
  v_pk_add_f32 v[8:9], v[8:9], v[10:11]
  v_pk_add_f32 v[12:13], v[12:13], v[14:15]
  v_add_f32 v20, v16, v17
  v_pk_add_f32 v[8:9], v[8:9], v[12:13]
  v_max_f32 v22, v8, v9
  v_add_f32_dpp v20, v20, v20 row_ror:8 row_mask:0xf bank_mask:0xf
  s_nop 0
  v_max_f32_dpp v22, v22, v22 row_ror:8 row_mask:0xf bank_mask:0xf
  v_max_f32 v22, v22, v20
  s_nop 1
  v_max_f32_dpp v22, v22, v22 quad_perm:[1,0,3,2] row_mask:0xf bank_mask:0xf
  buffer_store_dword v112, v116, s[8:11], 0 offen
  s_nop 0
  v_max_f32_dpp v22, v22, v22 quad_perm:[2,3,0,1] row_mask:0xf bank_mask:0xf
  s_nop 1
  v_max_f32_dpp v22, v22, v22 row_half_mirror row_mask:0xf bank_mask:0xf
  v_pk_add_f32 v[8:9], v[8:9], v[22:23] op_sel_hi:[1,0] neg_lo:[0,1] neg_hi:[0,1]
  v_sub_f32 v20, v20, v22
  v_exp_f32 v8, v8
  v_exp_f32 v9, v9
  v_exp_f32 v20, v20
  v_add_f32 v24, v8, v9
  v_fmac_f32 v24, 0.5, v20
  v_mov_b32_dpp v21, v20 quad_perm:[1,0,3,2] row_mask:0xf bank_mask:0xf
  s_nop 0
  v_add_f32_dpp v24, v24, v24 quad_perm:[1,0,3,2] row_mask:0xf bank_mask:0xf
  s_nop 1
  v_add_f32_dpp v24, v24, v24 quad_perm:[2,3,0,1] row_mask:0xf bank_mask:0xf
  s_nop 1
  v_add_f32_dpp v24, v24, v24 row_half_mirror row_mask:0xf bank_mask:0xf
  s_nop 1
  v_add_f32_dpp v24, v24, v24 row_ror:8 row_mask:0xf bank_mask:0xf
  v_rcp_f32 v24, v24
  s_nop 0
  v_pk_mul_f32 v[8:9], v[8:9], v[24:25] op_sel_hi:[1,0]
  v_cvt_pk_bf16_f32 v8, abs(v8), abs(v9)
  buffer_store_dword v8, v1, s[8:11], s20 offen
  v_pk_mul_f32 v[20:21], v[20:21], v[24:25] op_sel_hi:[1,0]
  v_cvt_pk_bf16_f32 v20, abs(v20), abs(v21)
  buffer_store_dword v20, v118, s[8:11], s20 offen
  v_mov_b32 v74, 0
  v_mov_b32 v75, 0
  s_mov_b32 s19, s18
  s_add_u32 s18, s18, 1
  s_mov_b32 s22, s20
  s_mov_b32 s20, s21
  s_mov_b32 s21, s22
  s_add_u32 s23, s20, 4096
  v_mov_b32 v112, s18
  s_cmp_lt_u32 s19, 63
  s_nop 0
  s_cbranch_scc1 cA_sc1_loop
  s_branch cA_done
cA_sc1_r0:
  s_add_u32 s31, s31, 1
  buffer_load_dwordx4 v[12:15], v2, s[8:11], s20 offen offset:1024 sc1
  s_waitcnt vmcnt(0)
  v_cmp_eq_u32 vcc, -1, v12
  v_mov_b32 v36, 0
  v_mov_b32 v37, 0
  v_mov_b32 v38, 0
  v_mov_b32 v39, 0
  v_mov_b32 v40, 0
  v_mov_b32 v41, 0
  v_mov_b32 v42, 0
  v_mov_b32 v43, 0
  v_mov_b32 v44, 0
  v_mov_b32 v45, 0
  v_mov_b32 v46, 0
  v_mov_b32 v47, 0
  v_mov_b32 v48, 0
  v_mov_b32 v49, 0
  v_mov_b32 v50, 0
  v_mov_b32 v51, 0
  s_nop 1
  s_cbranch_vccz cA_sc1_go
  s_add_u32 s30, s30, 1
  s_cmp_lt_u32 s30, 400000
  s_cbranch_scc1 cA_sc1_r0
  s_branch cA_abort
cA_sc1_r1:
  s_add_u32 s31, s31, 1
  buffer_load_dwordx4 v[16:19], v2, s[8:11], s20 offen offset:2048 sc1
  s_waitcnt vmcnt(0)
  v_cmp_eq_u32 vcc, -1, v16
  s_nop 4
  s_cbranch_vccz cA_sc1_rz
  s_add_u32 s30, s30, 1
  s_cmp_lt_u32 s30, 400000
  s_cbranch_scc1 cA_sc1_r1
  s_branch cA_abort
cA_sc1_r2:
  s_add_u32 s31, s31, 1
  buffer_load_dwordx4 v[20:23], v2, s[8:11], s20 offen offset:3072 sc1
  s_waitcnt vmcnt(0)
  v_cmp_eq_u32 vcc, -1, v20
  s_nop 4
  s_cbranch_vccz cA_sc1_rz
  s_add_u32 s30, s30, 1
  s_cmp_lt_u32 s30, 400000
  s_cbranch_scc1 cA_sc1_r2
  s_branch cA_abort
cA_sc1_r3:
  s_add_u32 s31, s31, 1
  buffer_load_dwordx4 v[8:11], v2, s[8:11], s20 offen offset:0 sc1
  s_waitcnt vmcnt(0)
  v_cmp_eq_u32 vcc, -1, v8
  s_nop 4
  s_cbranch_vccz cA_sc1_rz
  s_add_u32 s30, s30, 1
  s_cmp_lt_u32 s30, 400000
  s_cbranch_scc1 cA_sc1_r3
  s_branch cA_abort
cA_sc1_r4:
  s_add_u32 s31, s31, 1
  buffer_load_dwordx4 v[28:31], v2, s[8:11], s23 offen offset:0 sc1
  buffer_load_dwordx4 v[24:27], v2, s[8:11], s23 offen offset:1024 sc1
  buffer_load_dwordx4 v[32:35], v2, s[8:11], s23 offen offset:2048 sc1
  s_waitcnt vmcnt(0)
  v_max3_u32 v66, v24, v27, v28
  v_max3_u32 v66, v66, v31, v32
  v_max_u32 v66, v66, v35
  v_cmp_eq_u32 vcc, -1, v66
  s_nop 4
  s_cbranch_vccz cA_sc1_c4
  s_add_u32 s30, s30, 1
  s_cmp_lt_u32 s30, 400000
  s_cbranch_scc1 cA_sc1_r4
  s_branch cA_abort
cA_sc1_retry:
  s_cmp_lg_u32 s62, 0
  s_cbranch_scc1 cA_sc1_cont
  s_waitcnt vmcnt(0) lgkmcnt(0)
cA_sc1_rv:
  buffer_load_dwordx4 v[8:11], v2, s[8:11], s20 offen offset:0 sc1
  buffer_load_dwordx4 v[12:15], v2, s[8:11], s20 offen offset:1024 sc1
  buffer_load_dwordx4 v[16:19], v2, s[8:11], s20 offen offset:2048 sc1
  buffer_load_dwordx4 v[20:23], v2, s[8:11], s20 offen offset:3072 sc1
  buffer_load_dwordx4 v[28:31], v2, s[8:11], s23 offen offset:0 sc1
  buffer_load_dwordx4 v[24:27], v2, s[8:11], s23 offen offset:1024 sc1
  buffer_load_dwordx4 v[32:35], v2, s[8:11], s23 offen offset:2048 sc1
  s_waitcnt vmcnt(0)
  v_max3_u32 v66, v8, v9, v10
  v_max3_u32 v66, v66, v11, v12
  v_max3_u32 v66, v66, v13, v14
  v_max3_u32 v66, v66, v15, v16
  v_max3_u32 v66, v66, v17, v18
  v_max3_u32 v66, v66, v19, v20
  v_max3_u32 v66, v66, v21, v22
  v_max3_u32 v66, v66, v23, v24
  v_max3_u32 v66, v66, v25, v26
  v_max3_u32 v66, v66, v27, v28
  v_max3_u32 v66, v66, v29, v30
  v_max3_u32 v66, v66, v31, v32
  v_max3_u32 v66, v66, v33, v34
  v_max_u32 v66, v66, v35
  v_cmp_eq_u32 vcc, -1, v66
  s_cbranch_vccz cA_sc1_rk
  s_add_u32 s30, s30, 1
  s_cmp_lt_u32 s30, 400000
  s_cbranch_scc1 cA_sc1_rv
  s_branch cA_abort
cA_sc1_rk:
  s_mov_b32 s62, 1
  s_add_u32 s31, s31, 0x100
cA_sc1_rz:
  v_mov_b32 v36, 0
  v_mov_b32 v37, 0
  v_mov_b32 v38, 0
  v_mov_b32 v39, 0
  v_mov_b32 v40, 0
  v_mov_b32 v41, 0
  v_mov_b32 v42, 0
  v_mov_b32 v43, 0
  v_mov_b32 v44, 0
  v_mov_b32 v45, 0
  v_mov_b32 v46, 0
  v_mov_b32 v47, 0
  v_mov_b32 v48, 0
  v_mov_b32 v49, 0
  v_mov_b32 v50, 0
  v_mov_b32 v51, 0
  v_mov_b32 v60, 0
  v_mov_b32 v61, 0
  v_mov_b32 v62, 0
  v_mov_b32 v63, 0
  v_mov_b32 v68, 0
  v_mov_b32 v69, 0
  v_mov_b32 v70, 0
  v_mov_b32 v71, 0
  v_mov_b32 v72, 0
  v_mov_b32 v73, 0
  v_mov_b32 v74, 0
  v_mov_b32 v75, 0
  v_mov_b32 v52, 0
  v_mov_b32 v53, 0
  v_mov_b32 v54, 0
  v_mov_b32 v55, 0
  v_mov_b32 v56, 0
  v_mov_b32 v57, 0
  v_mov_b32 v58, 0
  v_mov_b32 v59, 0
  s_nop 1
  s_branch cA_sc1_go
.p2align 6
cA_sc2_loop:
  s_mov_b32 s30, 0
  s_mov_b32 s62, 0
  s_setprio 3
  s_barrier
  buffer_load_dwordx4 v[16:19], v2, s[8:11], s20 offen offset:2048 sc1
  s_setprio 2
  buffer_load_dwordx4 v[20:23], v2, s[8:11], s20 offen offset:3072 sc1
  s_setprio 1
  buffer_load_dwordx4 v[8:11], v2, s[8:11], s20 offen offset:0 sc1
  s_setprio 0
  buffer_load_dwordx4 v[12:15], v2, s[8:11], s20 offen offset:1024 sc1
cA_sc2_go:
  s_waitcnt vmcnt(3)
  v_smfmac_f32_16x16x64_bf16 v[36:39], v[16:19], a[16:23], v3
  buffer_load_dwordx4 v[28:31], v2, s[8:11], s23 offen offset:2048 sc1
  v_cmp_eq_u32 vcc, -1, v16
  v_smfmac_f32_16x16x64_bf16 v[40:43], v[16:19], a[72:79], v3
  v_smfmac_f32_16x16x64_bf16 v[44:47], v[16:19], a[128:135], v3
  buffer_load_dwordx4 v[24:27], v2, s[8:11], s23 offen offset:0 sc1
  s_cbranch_vccnz cA_sc2_r0
  v_smfmac_f32_16x16x64_bf16 v[48:51], v[16:19], a[184:191], v3
  v_smfmac_f32_16x16x64_bf16 v[52:55], v[16:19], a[240:247], v3
  v_smfmac_f32_16x16x64_bf16 v[56:59], v[16:19], v[160:167], v3
  buffer_load_dwordx4 v[32:35], v2, s[8:11], s23 offen offset:1024 sc1
  v_smfmac_f32_16x16x64_bf16 v[62:65], v[16:19], v[216:223], v3
  s_waitcnt vmcnt(5)
  v_smfmac_f32_16x16x64_bf16 v[36:39], v[20:23], a[24:31], v3
  v_cmp_eq_u32 vcc, -1, v20
  v_smfmac_f32_16x16x64_bf16 v[40:43], v[20:23], a[80:87], v3
  v_smfmac_f32_16x16x64_bf16 v[44:47], v[20:23], a[136:143], v3
  s_cbranch_vccnz cA_sc2_r1
  v_smfmac_f32_16x16x64_bf16 v[48:51], v[20:23], a[192:199], v3
  v_smfmac_f32_16x16x64_bf16 v[52:55], v[20:23], a[248:255], v3
  v_smfmac_f32_16x16x64_bf16 v[56:59], v[20:23], v[168:175], v3
  buffer_load_dwordx4 v[88:91], v117, s[8:11], s26 offen offset:0 sc1
  v_smfmac_f32_16x16x64_bf16 v[62:65], v[20:23], v[224:231], v3
  s_waitcnt vmcnt(5)
  v_smfmac_f32_16x16x64_bf16 v[36:39], v[8:11], a[0:7], v3
  v_cmp_eq_u32 vcc, -1, v8
  v_smfmac_f32_16x16x64_bf16 v[40:43], v[8:11], a[56:63], v3
  v_smfmac_f32_16x16x64_bf16 v[44:47], v[8:11], a[112:119], v3
  s_cbranch_vccnz cA_sc2_r2
  buffer_load_dwordx4 v[92:95], v117, s[8:11], s26 offen offset:1024 sc1
  v_smfmac_f32_16x16x64_bf16 v[48:51], v[8:11], a[168:175], v3
  v_smfmac_f32_16x16x64_bf16 v[52:55], v[8:11], a[224:231], v3
  v_smfmac_f32_16x16x64_bf16 v[56:59], v[8:11], v[144:151], v3
  v_smfmac_f32_16x16x64_bf16 v[62:65], v[8:11], v[200:207], v3
  s_waitcnt vmcnt(5)
  buffer_load_dwordx4 v[96:99], v2, s[8:11], s24 offen offset:0 sc1
  v_smfmac_f32_16x16x64_bf16 v[36:39], v[12:15], a[8:15], v3
  v_cmp_eq_u32 vcc, -1, v12
  v_smfmac_f32_16x16x64_bf16 v[40:43], v[12:15], a[64:71], v3
  s_waitcnt vmcnt(3)
  v_max3_u32 v66, v24, v27, v28
  v_smfmac_f32_16x16x64_bf16 v[44:47], v[12:15], a[120:127], v3
  s_cbranch_vccnz cA_sc2_r3
  v_max3_u32 v66, v66, v31, v32
  v_smfmac_f32_16x16x64_bf16 v[48:51], v[12:15], a[176:183], v3
  buffer_load_dwordx4 v[100:103], v2, s[8:11], s24 offen offset:1024 sc1
  v_max_u32 v66, v66, v35
  v_smfmac_f32_16x16x64_bf16 v[52:55], v[12:15], a[232:239], v3
  v_cmp_eq_u32 vcc, -1, v66
  v_smfmac_f32_16x16x64_bf16 v[56:59], v[12:15], v[152:159], v3
  v_smfmac_f32_16x16x64_bf16 v[62:65], v[12:15], v[208:215], v3
  s_cbranch_vccnz cA_sc2_r4
cA_sc2_c4:
  v_smfmac_f32_16x16x64_bf16 v[62:65], v[24:27], v[232:239], v3
  buffer_load_dwordx4 v[104:107], v2, s[8:11], s26 offen offset:0 sc1
  v_smfmac_f32_16x16x64_bf16 v[62:65], v[32:35], v[240:247], v3
  v_smfmac_f32_16x16x64_bf16 v[62:65], v[28:31], v[248:255], v3
  v_smfmac_f32_16x16x64_bf16 v[52:55], v[24:27], v[120:127], v3
  v_smfmac_f32_16x16x64_bf16 v[52:55], v[32:35], v[128:135], v3
  buffer_load_dwordx4 v[108:111], v2, s[8:11], s26 offen offset:1024 sc1
  v_smfmac_f32_16x16x64_bf16 v[52:55], v[28:31], v[136:143], v3
  v_cvt_pk_bf16_f32 v62, v62, v63
  v_smfmac_f32_16x16x64_bf16 v[56:59], v[24:27], v[176:183], v3
  v_cvt_pk_bf16_f32 v63, v64, v65
  v_smfmac_f32_16x16x64_bf16 v[56:59], v[32:35], v[184:191], v3
  v_mfma_f32_16x16x32_bf16 v[8:11], v[60:63], v[4:7], 0
  v_cvt_pk_bf16_f32 v55, v54, v55
  v_smfmac_f32_16x16x64_bf16 v[56:59], v[28:31], v[192:199], v3
  v_cvt_pk_bf16_f32 v54, v52, v53
  v_smfmac_f32_16x16x64_bf16 v[36:39], v[24:27], a[32:39], v3
  s_nop 1
  v_cvt_pk_bf16_f32 v76, v8, v9
  v_smfmac_f32_16x16x64_bf16 v[36:39], v[32:35], a[40:47], v3
  v_cvt_pk_bf16_f32 v77, v10, v11
  v_smfmac_f32_16x16x64_bf16 v[36:39], v[28:31], a[48:55], v3
  v_cvt_pk_bf16_f32 v56, v56, v57
  v_smfmac_f32_16x16x64_bf16 v[40:43], v[24:27], a[88:95], v3
  v_cvt_pk_bf16_f32 v57, v58, v59
  v_smfmac_f32_16x16x64_bf16 v[40:43], v[32:35], a[96:103], v3
  v_mfma_f32_16x16x32_bf16 v[12:15], v[54:57], v[4:7], 0
  v_cvt_pk_bf16_f32 v39, v38, v39
  v_smfmac_f32_16x16x64_bf16 v[40:43], v[28:31], a[104:111], v3
  v_cvt_pk_bf16_f32 v38, v36, v37
  v_smfmac_f32_16x16x64_bf16 v[44:47], v[24:27], a[144:151], v3
  s_nop 1
  v_cvt_pk_bf16_f32 v78, v12, v13
  v_smfmac_f32_16x16x64_bf16 v[44:47], v[32:35], a[152:159], v3
  v_cvt_pk_bf16_f32 v79, v14, v15
  v_smfmac_f32_16x16x64_bf16 v[44:47], v[28:31], a[160:167], v3
  v_cvt_pk_bf16_f32 v40, v40, v41
  v_smfmac_f32_16x16x64_bf16 v[48:51], v[24:27], a[200:207], v3
  v_cvt_pk_bf16_f32 v41, v42, v43
  v_smfmac_f32_16x16x64_bf16 v[48:51], v[32:35], a[208:215], v3
  v_smfmac_f32_16x16x64_bf16 v[48:51], v[28:31], a[216:223], v3
  s_waitcnt vmcnt(4)
  v_cvt_pk_bf16_f32 v47, v46, v47
  v_smfmac_f32_16x16x64_bf16 v[68:71], v[76:79], v[80:87], v3
  v_cvt_pk_bf16_f32 v46, v44, v45
  v_mfma_f32_16x16x32_bf16 v[8:11], v[38:41], v[4:7], 0
  s_nop 1
  v_cvt_pk_bf16_f32 v48, v48, v49
  v_cvt_pk_bf16_f32 v49, v50, v51
  s_nop 1
  v_mfma_f32_16x16x32_bf16 v[12:15], v[46:49], v[4:7], 0
  v_smfmac_f32_16x16x64_bf16 v[72:75], v[76:79], v[88:95], v3
  v_cvt_pk_bf16_f32 v20, v8, v9
  v_mfma_f32_16x16x32_bf16 v[52:55], v[30:33], v[76:79], 0
  s_waitcnt vmcnt(0)
  v_cvt_pk_bf16_f32 v21, v10, v11
  v_cvt_pk_bf16_f32 v22, v12, v13
  v_cvt_pk_bf16_f32 v23, v14, v15
  s_nop 1
  v_mfma_f32_16x16x32_bf16 v[52:55], v[16:19], v[20:23], v[52:55]
  v_smfmac_f32_16x16x64_bf16 v[68:71], v[20:23], v[96:103], v3
  v_smfmac_f32_16x16x64_bf16 v[72:75], v[20:23], v[104:111], v3
  s_nop 1
  ds_write_b128 v113, v[52:55]
  s_nop 1
  v_permlane32_swap_b32 v68, v70
  v_permlane32_swap_b32 v69, v71
  v_add_f32 v56, v68, v70
  v_add_f32 v58, v69, v71
  v_permlane32_swap_b32 v72, v74
  v_permlane32_swap_b32 v73, v75
  v_add_f32 v57, v72, v74
  v_add_f32 v59, v73, v75
  ds_write_b128 v2, v[56:59] offset:2048
  v_cmp_u_f32 vcc, v57, v59
  v_mov_b32 v68, 0
  v_mov_b32 v69, 0
  v_mov_b32 v70, 0
  v_mov_b32 v71, 0
  s_cbranch_vccnz cA_sc2_retry
cA_sc2_cont:
  s_add_u32 s24, s24, 28672
  s_add_u32 s26, s26, 28672
  buffer_load_dwordx4 v[80:83], v117, s[8:11], s24 offen offset:0 sc1
  buffer_load_dwordx4 v[84:87], v117, s[8:11], s24 offen offset:1024 sc1
  v_mov_b32 v72, 0
  v_mov_b32 v73, 0
  v_mfma_f32_32x32x16_bf16 v[36:51], v[68:71], v[68:71], 0
  s_waitcnt lgkmcnt(0)
  s_barrier
  v_mfma_f32_32x32x16_bf16 v[52:67], v[68:71], v[68:71], 0
  buffer_store_dwordx2 v[118:119], v114, s[8:11], s21 offen
  buffer_store_dwordx2 v[118:119], v115, s[8:11], s21 offen
  s_buffer_load_dword s70, s[8:11], s35
  s_add_u32 s22, s24, 114688
  s_buffer_load_dword s71, s[8:11], s22
  s_mul_i32 s22, s18, 7168
  s_add_u32 s22, s22, 87040
  s_buffer_load_dword s72, s[8:11], s22
  s_add_u32 s35, s35, 458752
  v_mov_b32 v74, 0
  v_mov_b32 v75, 0
  s_mov_b32 s19, s18
  s_add_u32 s18, s18, 1
  s_mov_b32 s22, s20
  s_mov_b32 s20, s21
  s_mov_b32 s21, s22
  s_add_u32 s23, s20, 4096
  s_cmp_lt_u32 s19, 63
  s_cbranch_scc1 cA_sc2_loop
  s_branch cA_done
cA_sc2_r0:
  s_add_u32 s31, s31, 1
  buffer_load_dwordx4 v[16:19], v2, s[8:11], s20 offen offset:2048 sc1
  s_waitcnt vmcnt(0)
  v_cmp_eq_u32 vcc, -1, v16
  v_mov_b32 v36, 0
  v_mov_b32 v37, 0
  v_mov_b32 v38, 0
  v_mov_b32 v39, 0
  v_mov_b32 v40, 0
  v_mov_b32 v41, 0
  v_mov_b32 v42, 0
  v_mov_b32 v43, 0
  v_mov_b32 v44, 0
  v_mov_b32 v45, 0
  v_mov_b32 v46, 0
  v_mov_b32 v47, 0
  v_mov_b32 v48, 0
  v_mov_b32 v49, 0
  v_mov_b32 v50, 0
  v_mov_b32 v51, 0
  s_nop 1
  s_cbranch_vccz cA_sc2_go
  s_add_u32 s30, s30, 1
  s_cmp_lt_u32 s30, 400000
  s_cbranch_scc1 cA_sc2_r0
  s_branch cA_abort
cA_sc2_r1:
  s_add_u32 s31, s31, 1
  buffer_load_dwordx4 v[20:23], v2, s[8:11], s20 offen offset:3072 sc1
  s_waitcnt vmcnt(0)
  v_cmp_eq_u32 vcc, -1, v20
  s_nop 4
  s_cbranch_vccz cA_sc2_rz
  s_add_u32 s30, s30, 1
  s_cmp_lt_u32 s30, 400000
  s_cbranch_scc1 cA_sc2_r1
  s_branch cA_abort
cA_sc2_r2:
  s_add_u32 s31, s31, 1
  buffer_load_dwordx4 v[8:11], v2, s[8:11], s20 offen offset:0 sc1
  s_waitcnt vmcnt(0)
  v_cmp_eq_u32 vcc, -1, v8
  s_nop 4
  s_cbranch_vccz cA_sc2_rz
  s_add_u32 s30, s30, 1
  s_cmp_lt_u32 s30, 400000
  s_cbranch_scc1 cA_sc2_r2
  s_branch cA_abort
cA_sc2_r3:
  s_add_u32 s31, s31, 1
  buffer_load_dwordx4 v[12:15], v2, s[8:11], s20 offen offset:1024 sc1
  s_waitcnt vmcnt(0)
  v_cmp_eq_u32 vcc, -1, v12
  s_nop 4
  s_cbranch_vccz cA_sc2_rz
  s_add_u32 s30, s30, 1
  s_cmp_lt_u32 s30, 400000
  s_cbranch_scc1 cA_sc2_r3
  s_branch cA_abort
cA_sc2_r4:
  s_add_u32 s31, s31, 1
  buffer_load_dwordx4 v[24:27], v2, s[8:11], s23 offen offset:0 sc1
  buffer_load_dwordx4 v[32:35], v2, s[8:11], s23 offen offset:1024 sc1
  buffer_load_dwordx4 v[28:31], v2, s[8:11], s23 offen offset:2048 sc1
  s_waitcnt vmcnt(0)
  v_max3_u32 v66, v24, v27, v28
  v_max3_u32 v66, v66, v31, v32
  v_max_u32 v66, v66, v35
  v_cmp_eq_u32 vcc, -1, v66
  s_nop 4
  s_cbranch_vccz cA_sc2_c4
  s_add_u32 s30, s30, 1
  s_cmp_lt_u32 s30, 400000
  s_cbranch_scc1 cA_sc2_r4
  s_branch cA_abort
cA_sc2_retry:
  s_cmp_lg_u32 s62, 0
  s_cbranch_scc1 cA_sc2_cont
  s_waitcnt vmcnt(0) lgkmcnt(0)
cA_sc2_rv:
  buffer_load_dwordx4 v[8:11], v2, s[8:11], s20 offen offset:0 sc1
  buffer_load_dwordx4 v[12:15], v2, s[8:11], s20 offen offset:1024 sc1
  buffer_load_dwordx4 v[16:19], v2, s[8:11], s20 offen offset:2048 sc1
  buffer_load_dwordx4 v[20:23], v2, s[8:11], s20 offen offset:3072 sc1
  buffer_load_dwordx4 v[24:27], v2, s[8:11], s23 offen offset:0 sc1
  buffer_load_dwordx4 v[32:35], v2, s[8:11], s23 offen offset:1024 sc1
  buffer_load_dwordx4 v[28:31], v2, s[8:11], s23 offen offset:2048 sc1
  s_waitcnt vmcnt(0)
  v_max3_u32 v66, v8, v9, v10
  v_max3_u32 v66, v66, v11, v12
  v_max3_u32 v66, v66, v13, v14
  v_max3_u32 v66, v66, v15, v16
  v_max3_u32 v66, v66, v17, v18
  v_max3_u32 v66, v66, v19, v20
  v_max3_u32 v66, v66, v21, v22
  v_max3_u32 v66, v66, v23, v24
  v_max3_u32 v66, v66, v25, v26
  v_max3_u32 v66, v66, v27, v28
  v_max3_u32 v66, v66, v29, v30
  v_max3_u32 v66, v66, v31, v32
  v_max3_u32 v66, v66, v33, v34
  v_max_u32 v66, v66, v35
  v_cmp_eq_u32 vcc, -1, v66
  s_cbranch_vccz cA_sc2_rk
  s_add_u32 s30, s30, 1
  s_cmp_lt_u32 s30, 400000
  s_cbranch_scc1 cA_sc2_rv
  s_branch cA_abort
cA_sc2_rk:
  s_mov_b32 s62, 1
  s_add_u32 s31, s31, 0x100
cA_sc2_rz:
  v_mov_b32 v36, 0
  v_mov_b32 v37, 0
  v_mov_b32 v38, 0
  v_mov_b32 v39, 0
  v_mov_b32 v40, 0
  v_mov_b32 v41, 0
  v_mov_b32 v42, 0
  v_mov_b32 v43, 0
  v_mov_b32 v44, 0
  v_mov_b32 v45, 0
  v_mov_b32 v46, 0
  v_mov_b32 v47, 0
  v_mov_b32 v48, 0
  v_mov_b32 v49, 0
  v_mov_b32 v50, 0
  v_mov_b32 v51, 0
  v_mov_b32 v62, 0
  v_mov_b32 v63, 0
  v_mov_b32 v64, 0
  v_mov_b32 v65, 0
  v_mov_b32 v68, 0
  v_mov_b32 v69, 0
  v_mov_b32 v70, 0
  v_mov_b32 v71, 0
  v_mov_b32 v72, 0
  v_mov_b32 v73, 0
  v_mov_b32 v74, 0
  v_mov_b32 v75, 0
  v_mov_b32 v52, 0
  v_mov_b32 v53, 0
  v_mov_b32 v54, 0
  v_mov_b32 v55, 0
  v_mov_b32 v56, 0
  v_mov_b32 v57, 0
  v_mov_b32 v58, 0
  v_mov_b32 v59, 0
  s_nop 1
  s_branch cA_sc2_go
.p2align 6
cA_sc3_loop:
  s_mov_b32 s30, 0
  s_mov_b32 s62, 0
  s_setprio 3
  s_barrier
  buffer_load_dwordx4 v[20:23], v2, s[8:11], s20 offen offset:3072 sc1
  s_setprio 2
  buffer_load_dwordx4 v[8:11], v2, s[8:11], s20 offen offset:0 sc1
  s_setprio 1
  buffer_load_dwordx4 v[12:15], v2, s[8:11], s20 offen offset:1024 sc1
  s_setprio 0
  buffer_load_dwordx4 v[16:19], v2, s[8:11], s20 offen offset:2048 sc1
cA_sc3_go:
  s_waitcnt vmcnt(3)
  v_smfmac_f32_16x16x64_bf16 v[36:39], v[20:23], a[24:31], v3
  buffer_load_dwordx4 v[24:27], v2, s[8:11], s23 offen offset:0 sc1
  v_cmp_eq_u32 vcc, -1, v20
  v_smfmac_f32_16x16x64_bf16 v[40:43], v[20:23], a[80:87], v3
  v_smfmac_f32_16x16x64_bf16 v[44:47], v[20:23], a[136:143], v3
  buffer_load_dwordx4 v[28:31], v2, s[8:11], s23 offen offset:1024 sc1
  s_cbranch_vccnz cA_sc3_r0
  v_smfmac_f32_16x16x64_bf16 v[48:51], v[20:23], a[192:199], v3
  v_smfmac_f32_16x16x64_bf16 v[52:55], v[20:23], a[248:255], v3
  v_smfmac_f32_16x16x64_bf16 v[56:59], v[20:23], v[168:175], v3
  buffer_load_dwordx4 v[32:35], v2, s[8:11], s23 offen offset:2048 sc1
  v_smfmac_f32_16x16x64_bf16 v[62:65], v[20:23], v[224:231], v3
  s_waitcnt vmcnt(5)
  v_smfmac_f32_16x16x64_bf16 v[36:39], v[8:11], a[0:7], v3
  v_cmp_eq_u32 vcc, -1, v8
  v_smfmac_f32_16x16x64_bf16 v[40:43], v[8:11], a[56:63], v3
  v_smfmac_f32_16x16x64_bf16 v[44:47], v[8:11], a[112:119], v3
  s_cbranch_vccnz cA_sc3_r1
  v_smfmac_f32_16x16x64_bf16 v[48:51], v[8:11], a[168:175], v3
  v_smfmac_f32_16x16x64_bf16 v[52:55], v[8:11], a[224:231], v3
  v_smfmac_f32_16x16x64_bf16 v[56:59], v[8:11], v[144:151], v3
  buffer_load_dwordx4 v[88:91], v117, s[8:11], s26 offen offset:0 sc1
  v_smfmac_f32_16x16x64_bf16 v[62:65], v[8:11], v[200:207], v3
  s_waitcnt vmcnt(5)
  v_smfmac_f32_16x16x64_bf16 v[36:39], v[12:15], a[8:15], v3
  v_cmp_eq_u32 vcc, -1, v12
  v_smfmac_f32_16x16x64_bf16 v[40:43], v[12:15], a[64:71], v3
  v_smfmac_f32_16x16x64_bf16 v[44:47], v[12:15], a[120:127], v3
  s_cbranch_vccnz cA_sc3_r2
  buffer_load_dwordx4 v[92:95], v117, s[8:11], s26 offen offset:1024 sc1
  v_smfmac_f32_16x16x64_bf16 v[48:51], v[12:15], a[176:183], v3
  v_smfmac_f32_16x16x64_bf16 v[52:55], v[12:15], a[232:239], v3
  v_smfmac_f32_16x16x64_bf16 v[56:59], v[12:15], v[152:159], v3
  v_smfmac_f32_16x16x64_bf16 v[62:65], v[12:15], v[208:215], v3
  s_waitcnt vmcnt(5)
  buffer_load_dwordx4 v[96:99], v2, s[8:11], s24 offen offset:0 sc1
  v_smfmac_f32_16x16x64_bf16 v[36:39], v[16:19], a[16:23], v3
  v_cmp_eq_u32 vcc, -1, v16
  v_smfmac_f32_16x16x64_bf16 v[40:43], v[16:19], a[72:79], v3
  s_waitcnt vmcnt(3)
  v_max3_u32 v66, v24, v27, v28
  v_smfmac_f32_16x16x64_bf16 v[44:47], v[16:19], a[128:135], v3
  s_cbranch_vccnz cA_sc3_r3
  v_max3_u32 v66, v66, v31, v32
  v_smfmac_f32_16x16x64_bf16 v[48:51], v[16:19], a[184:191], v3
  buffer_load_dwordx4 v[100:103], v2, s[8:11], s24 offen offset:1024 sc1
  v_max_u32 v66, v66, v35
  v_smfmac_f32_16x16x64_bf16 v[52:55], v[16:19], a[240:247], v3
  v_cmp_eq_u32 vcc, -1, v66
  v_smfmac_f32_16x16x64_bf16 v[56:59], v[16:19], v[160:167], v3
  v_smfmac_f32_16x16x64_bf16 v[62:65], v[16:19], v[216:223], v3
  s_cbranch_vccnz cA_sc3_r4
cA_sc3_c4:
  v_smfmac_f32_16x16x64_bf16 v[62:65], v[24:27], v[232:239], v3
  buffer_load_dwordx4 v[104:107], v2, s[8:11], s26 offen offset:0 sc1
  v_smfmac_f32_16x16x64_bf16 v[62:65], v[28:31], v[240:247], v3
  v_smfmac_f32_16x16x64_bf16 v[62:65], v[32:35], v[248:255], v3
  v_smfmac_f32_16x16x64_bf16 v[52:55], v[24:27], v[120:127], v3
  v_smfmac_f32_16x16x64_bf16 v[52:55], v[28:31], v[128:135], v3
  buffer_load_dwordx4 v[108:111], v2, s[8:11], s26 offen offset:1024 sc1
  v_smfmac_f32_16x16x64_bf16 v[52:55], v[32:35], v[136:143], v3
  v_cvt_pk_bf16_f32 v62, v62, v63
  v_smfmac_f32_16x16x64_bf16 v[56:59], v[24:27], v[176:183], v3
  v_cvt_pk_bf16_f32 v63, v64, v65
  v_smfmac_f32_16x16x64_bf16 v[56:59], v[28:31], v[184:191], v3
  v_mfma_f32_16x16x32_bf16 v[8:11], v[60:63], v[4:7], 0
  v_cvt_pk_bf16_f32 v55, v54, v55
  v_smfmac_f32_16x16x64_bf16 v[56:59], v[32:35], v[192:199], v3
  v_cvt_pk_bf16_f32 v54, v52, v53
  v_smfmac_f32_16x16x64_bf16 v[36:39], v[24:27], a[32:39], v3
  s_nop 1
  v_cvt_pk_bf16_f32 v78, v8, v9
  v_smfmac_f32_16x16x64_bf16 v[36:39], v[28:31], a[40:47], v3
  v_cvt_pk_bf16_f32 v79, v10, v11
  v_smfmac_f32_16x16x64_bf16 v[36:39], v[32:35], a[48:55], v3
  v_cvt_pk_bf16_f32 v56, v56, v57
  v_smfmac_f32_16x16x64_bf16 v[40:43], v[24:27], a[88:95], v3
  v_cvt_pk_bf16_f32 v57, v58, v59
  v_smfmac_f32_16x16x64_bf16 v[40:43], v[28:31], a[96:103], v3
  v_mfma_f32_16x16x32_bf16 v[12:15], v[54:57], v[4:7], 0
  v_cvt_pk_bf16_f32 v39, v38, v39
  v_smfmac_f32_16x16x64_bf16 v[40:43], v[32:35], a[104:111], v3
  v_cvt_pk_bf16_f32 v38, v36, v37
  v_smfmac_f32_16x16x64_bf16 v[44:47], v[24:27], a[144:151], v3
  s_nop 1
  v_cvt_pk_bf16_f32 v76, v12, v13
  v_smfmac_f32_16x16x64_bf16 v[44:47], v[28:31], a[152:159], v3
  v_cvt_pk_bf16_f32 v77, v14, v15
  v_smfmac_f32_16x16x64_bf16 v[44:47], v[32:35], a[160:167], v3
  v_cvt_pk_bf16_f32 v40, v40, v41
  v_smfmac_f32_16x16x64_bf16 v[48:51], v[24:27], a[200:207], v3
  v_cvt_pk_bf16_f32 v41, v42, v43
  v_smfmac_f32_16x16x64_bf16 v[48:51], v[28:31], a[208:215], v3
  v_smfmac_f32_16x16x64_bf16 v[48:51], v[32:35], a[216:223], v3
  s_waitcnt vmcnt(4)
  v_cvt_pk_bf16_f32 v47, v46, v47
  v_smfmac_f32_16x16x64_bf16 v[68:71], v[76:79], v[80:87], v3
  v_cvt_pk_bf16_f32 v46, v44, v45
  v_mfma_f32_16x16x32_bf16 v[8:11], v[38:41], v[4:7], 0
  s_nop 1
  v_cvt_pk_bf16_f32 v48, v48, v49
  v_cvt_pk_bf16_f32 v49, v50, v51
  s_nop 1
  v_mfma_f32_16x16x32_bf16 v[12:15], v[46:49], v[4:7], 0
  v_smfmac_f32_16x16x64_bf16 v[72:75], v[76:79], v[88:95], v3
  v_cvt_pk_bf16_f32 v16, v8, v9
  v_mfma_f32_16x16x32_bf16 v[52:55], v[30:33], v[76:79], 0
  s_waitcnt vmcnt(0)
  v_cvt_pk_bf16_f32 v17, v10, v11
  v_cvt_pk_bf16_f32 v18, v12, v13
  v_cvt_pk_bf16_f32 v19, v14, v15
  s_nop 1
  v_mfma_f32_16x16x32_bf16 v[52:55], v[20:23], v[16:19], v[52:55]
  v_smfmac_f32_16x16x64_bf16 v[68:71], v[16:19], v[96:103], v3
  v_smfmac_f32_16x16x64_bf16 v[72:75], v[16:19], v[104:111], v3
  s_nop 1
  ds_write_b128 v113, v[52:55]
  s_nop 1
  v_permlane32_swap_b32 v68, v70
  v_permlane32_swap_b32 v69, v71
  v_add_f32 v56, v68, v70
  v_add_f32 v58, v69, v71
  v_permlane32_swap_b32 v72, v74
  v_permlane32_swap_b32 v73, v75
  v_add_f32 v57, v72, v74
  v_add_f32 v59, v73, v75
  ds_write_b128 v2, v[56:59] offset:3072
  v_cmp_u_f32 vcc, v57, v59
  v_mov_b32 v68, 0
  v_mov_b32 v69, 0
  v_mov_b32 v70, 0
  v_mov_b32 v71, 0
  s_cbranch_vccnz cA_sc3_retry
cA_sc3_cont:
  s_add_u32 s24, s24, 28672
  s_add_u32 s26, s26, 28672
  buffer_load_dwordx4 v[80:83], v117, s[8:11], s24 offen offset:0 sc1
  buffer_load_dwordx4 v[84:87], v117, s[8:11], s24 offen offset:1024 sc1
  v_mov_b32 v72, 0
  v_mov_b32 v73, 0
  v_mfma_f32_16x16x32_bf16 v[62:65], v[68:71], v[68:71], 0
  s_waitcnt lgkmcnt(0)
  s_barrier
  v_mov_b32 v52, 0
  v_mov_b32 v53, 0
  v_mov_b32 v54, 0
  v_mov_b32 v55, 0
  v_mov_b32 v56, 0
  v_mov_b32 v57, 0
  v_mov_b32 v58, 0
  v_mov_b32 v59, 0
  v_mfma_f32_32x32x16_bf16 v[36:51], v[68:71], v[68:71], 0
  v_mov_b32 v74, 0
  v_mov_b32 v75, 0
  s_mov_b32 s19, s18
  s_add_u32 s18, s18, 1
  s_mov_b32 s22, s20
  s_mov_b32 s20, s21
  s_mov_b32 s21, s22
  s_add_u32 s23, s20, 4096
  s_cmp_lt_u32 s19, 63
  s_nop 2
  s_cbranch_scc1 cA_sc3_loop
  s_branch cA_done
cA_sc3_r0:
  s_add_u32 s31, s31, 1
  buffer_load_dwordx4 v[20:23], v2, s[8:11], s20 offen offset:3072 sc1
  s_waitcnt vmcnt(0)
  v_cmp_eq_u32 vcc, -1, v20
  v_mov_b32 v36, 0
  v_mov_b32 v37, 0
  v_mov_b32 v38, 0
  v_mov_b32 v39, 0
  v_mov_b32 v40, 0
  v_mov_b32 v41, 0
  v_mov_b32 v42, 0
  v_mov_b32 v43, 0
  v_mov_b32 v44, 0
  v_mov_b32 v45, 0
  v_mov_b32 v46, 0
  v_mov_b32 v47, 0
  v_mov_b32 v48, 0
  v_mov_b32 v49, 0
  v_mov_b32 v50, 0
  v_mov_b32 v51, 0
  s_nop 1
  s_cbranch_vccz cA_sc3_go
  s_add_u32 s30, s30, 1
  s_cmp_lt_u32 s30, 400000
  s_cbranch_scc1 cA_sc3_r0
  s_branch cA_abort
cA_sc3_r1:
  s_add_u32 s31, s31, 1
  buffer_load_dwordx4 v[8:11], v2, s[8:11], s20 offen offset:0 sc1
  s_waitcnt vmcnt(0)
  v_cmp_eq_u32 vcc, -1, v8
  s_nop 4
  s_cbranch_vccz cA_sc3_rz
  s_add_u32 s30, s30, 1
  s_cmp_lt_u32 s30, 400000
  s_cbranch_scc1 cA_sc3_r1
  s_branch cA_abort
cA_sc3_r2:
  s_add_u32 s31, s31, 1
  buffer_load_dwordx4 v[12:15], v2, s[8:11], s20 offen offset:1024 sc1
  s_waitcnt vmcnt(0)
  v_cmp_eq_u32 vcc, -1, v12
  s_nop 4
  s_cbranch_vccz cA_sc3_rz
  s_add_u32 s30, s30, 1
  s_cmp_lt_u32 s30, 400000
  s_cbranch_scc1 cA_sc3_r2
  s_branch cA_abort
cA_sc3_r3:
  s_add_u32 s31, s31, 1
  buffer_load_dwordx4 v[16:19], v2, s[8:11], s20 offen offset:2048 sc1
  s_waitcnt vmcnt(0)
  v_cmp_eq_u32 vcc, -1, v16
  s_nop 4
  s_cbranch_vccz cA_sc3_rz
  s_add_u32 s30, s30, 1
  s_cmp_lt_u32 s30, 400000
  s_cbranch_scc1 cA_sc3_r3
  s_branch cA_abort
cA_sc3_r4:
  s_add_u32 s31, s31, 1
  buffer_load_dwordx4 v[24:27], v2, s[8:11], s23 offen offset:0 sc1
  buffer_load_dwordx4 v[28:31], v2, s[8:11], s23 offen offset:1024 sc1
  buffer_load_dwordx4 v[32:35], v2, s[8:11], s23 offen offset:2048 sc1
  s_waitcnt vmcnt(0)
  v_max3_u32 v66, v24, v27, v28
  v_max3_u32 v66, v66, v31, v32
  v_max_u32 v66, v66, v35
  v_cmp_eq_u32 vcc, -1, v66
  s_nop 4
  s_cbranch_vccz cA_sc3_c4
  s_add_u32 s30, s30, 1
  s_cmp_lt_u32 s30, 400000
  s_cbranch_scc1 cA_sc3_r4
  s_branch cA_abort
cA_sc3_retry:
  s_cmp_lg_u32 s62, 0
  s_cbranch_scc1 cA_sc3_cont
  s_waitcnt vmcnt(0) lgkmcnt(0)
cA_sc3_rv:
  buffer_load_dwordx4 v[8:11], v2, s[8:11], s20 offen offset:0 sc1
  buffer_load_dwordx4 v[12:15], v2, s[8:11], s20 offen offset:1024 sc1
  buffer_load_dwordx4 v[16:19], v2, s[8:11], s20 offen offset:2048 sc1
  buffer_load_dwordx4 v[20:23], v2, s[8:11], s20 offen offset:3072 sc1
  buffer_load_dwordx4 v[24:27], v2, s[8:11], s23 offen offset:0 sc1
  buffer_load_dwordx4 v[28:31], v2, s[8:11], s23 offen offset:1024 sc1
  buffer_load_dwordx4 v[32:35], v2, s[8:11], s23 offen offset:2048 sc1
  s_waitcnt vmcnt(0)
  v_max3_u32 v66, v8, v9, v10
  v_max3_u32 v66, v66, v11, v12
  v_max3_u32 v66, v66, v13, v14
  v_max3_u32 v66, v66, v15, v16
  v_max3_u32 v66, v66, v17, v18
  v_max3_u32 v66, v66, v19, v20
  v_max3_u32 v66, v66, v21, v22
  v_max3_u32 v66, v66, v23, v24
  v_max3_u32 v66, v66, v25, v26
  v_max3_u32 v66, v66, v27, v28
  v_max3_u32 v66, v66, v29, v30
  v_max3_u32 v66, v66, v31, v32
  v_max3_u32 v66, v66, v33, v34
  v_max_u32 v66, v66, v35
  v_cmp_eq_u32 vcc, -1, v66
  s_cbranch_vccz cA_sc3_rk
  s_add_u32 s30, s30, 1
  s_cmp_lt_u32 s30, 400000
  s_cbranch_scc1 cA_sc3_rv
  s_branch cA_abort
cA_sc3_rk:
  s_mov_b32 s62, 1
  s_add_u32 s31, s31, 0x100
cA_sc3_rz:
  v_mov_b32 v36, 0
  v_mov_b32 v37, 0
  v_mov_b32 v38, 0
  v_mov_b32 v39, 0
  v_mov_b32 v40, 0
  v_mov_b32 v41, 0
  v_mov_b32 v42, 0
  v_mov_b32 v43, 0
  v_mov_b32 v44, 0
  v_mov_b32 v45, 0
  v_mov_b32 v46, 0
  v_mov_b32 v47, 0
  v_mov_b32 v48, 0
  v_mov_b32 v49, 0
  v_mov_b32 v50, 0
  v_mov_b32 v51, 0
  v_mov_b32 v62, 0
  v_mov_b32 v63, 0
  v_mov_b32 v64, 0
  v_mov_b32 v65, 0
  v_mov_b32 v68, 0
  v_mov_b32 v69, 0
  v_mov_b32 v70, 0
  v_mov_b32 v71, 0
  v_mov_b32 v72, 0
  v_mov_b32 v73, 0
  v_mov_b32 v74, 0
  v_mov_b32 v75, 0
  v_mov_b32 v52, 0
  v_mov_b32 v53, 0
  v_mov_b32 v54, 0
  v_mov_b32 v55, 0
  v_mov_b32 v56, 0
  v_mov_b32 v57, 0
  v_mov_b32 v58, 0
  v_mov_b32 v59, 0
  s_nop 1
  s_branch cA_sc3_go
.p2align 6
cA_va0_loop:
  s_mov_b32 s30, 0
  s_barrier
  buffer_load_dwordx4 v[24:27], v2, s[8:11], s23 offen offset:0 sc1
  buffer_load_dwordx4 v[28:31], v2, s[8:11], s23 offen offset:1024 sc1
  s_barrier
  s_cmp_lt_u32 s19, 60
  s_cbranch_scc1 cA_va0_m1
  buffer_store_dword v160, v1, s[8:11], s38 offen sc1
  s_cmp_lg_u32 s19, 63
  s_cbranch_scc1 cA_va0_m2
  v_min_u32 v64, -2, v64
  v_min_u32 v65, -2, v65
  v_min_u32 v66, -2, v66
  v_min_u32 v67, -2, v67
  v_min_u32 v68, -2, v68
  v_min_u32 v69, -2, v69
  v_min_u32 v70, -2, v70
  v_min_u32 v71, -2, v71
  v_min_u32 v72, -2, v72
  v_min_u32 v73, -2, v73
  v_min_u32 v74, -2, v74
  v_min_u32 v75, -2, v75
  v_min_u32 v76, -2, v76
  v_min_u32 v77, -2, v77
  v_min_u32 v78, -2, v78
  v_min_u32 v79, -2, v79
  buffer_store_dwordx4 v[64:67], v2, s[8:11], s33 offen offset:0 sc1
  buffer_store_dwordx4 v[68:71], v2, s[8:11], s33 offen offset:2048 sc1
  s_add_u32 s33, s33, 4096
  buffer_store_dwordx4 v[72:75], v2, s[8:11], s33 offen offset:0 sc1
  buffer_store_dwordx4 v[76:79], v2, s[8:11], s33 offen offset:2048 sc1
  s_add_u32 s33, s33, 4096
  s_waitcnt vmcnt(5)
  s_branch cA_va0_m3
cA_va0_m1:
  buffer_store_dword v160, v1, s[8:11], s38 offen nt
cA_va0_m2:
  s_add_u32 s22, s25, s80
  buffer_load_dwordx4 v[80:83], v6, s[8:11], s22 offen offset:0 sc1
  buffer_load_dwordx4 v[84:87], v6, s[8:11], s22 offen offset:1792 sc1
  s_add_u32 s22, s22, 3584
  buffer_load_dwordx4 v[88:91], v6, s[8:11], s22 offen offset:0 sc1
  buffer_load_dwordx4 v[92:95], v6, s[8:11], s22 offen offset:1792 sc1
  s_add_u32 s22, s25, s81
  buffer_load_dwordx4 v[96:99], v6, s[8:11], s22 offen offset:0 sc1
  s_mul_i32 s38, s18, 7168
  s_add_u32 s38, s38, 65536
  s_waitcnt vmcnt(6)
cA_va0_m3:
  ds_write_b128 v2, v[24:27] offset:12288
  ds_write_b128 v2, v[28:31] offset:13312
  v_smfmac_f32_16x16x64_bf16 v[36:39], v[24:27], a[32:39], v3
  buffer_load_dwordx4 v[100:103], v6, s[8:11], s22 offen offset:1792 sc1
  v_smfmac_f32_16x16x64_bf16 v[40:43], v[24:27], a[88:95], v3
  s_add_u32 s22, s22, 3584
  buffer_load_dwordx4 v[104:107], v6, s[8:11], s22 offen offset:0 sc1
  v_smfmac_f32_16x16x64_bf16 v[44:47], v[24:27], a[144:151], v3
  buffer_load_dwordx4 v[108:111], v6, s[8:11], s22 offen offset:1792 sc1
  v_smfmac_f32_16x16x64_bf16 v[48:51], v[24:27], a[200:207], v3
  s_add_u32 s22, s25, s82
  buffer_load_dwordx4 v[112:115], v6, s[8:11], s22 offen offset:0 sc1
  v_smfmac_f32_16x16x64_bf16 v[52:55], v[24:27], v[176:183], v3
  s_waitcnt lgkmcnt(0)
  s_barrier
  ds_read_b128 v[8:11], v2 offset:8192
  ds_read_b128 v[12:15], v2 offset:9216
  ds_read_b128 v[16:19], v2 offset:10240
  ds_read_b128 v[20:23], v2 offset:11264
  ds_read_b128 v[32:35], v2 offset:14336
  buffer_load_dwordx4 v[116:119], v6, s[8:11], s22 offen offset:1792 sc1
  v_smfmac_f32_16x16x64_bf16 v[56:59], v[24:27], v[232:239], v3
  s_add_u32 s22, s22, 3584
  buffer_load_dwordx4 v[120:123], v6, s[8:11], s22 offen offset:0 sc1
  v_smfmac_f32_16x16x64_bf16 v[36:39], v[28:31], a[40:47], v3
  buffer_load_dwordx4 v[124:127], v6, s[8:11], s22 offen offset:1792 sc1
  v_smfmac_f32_16x16x64_bf16 v[40:43], v[28:31], a[96:103], v3
  s_add_u32 s22, s25, s83
  buffer_load_dwordx4 v[128:131], v6, s[8:11], s22 offen offset:0 sc1
  v_smfmac_f32_16x16x64_bf16 v[44:47], v[28:31], a[152:159], v3
  buffer_load_dwordx4 v[132:135], v6, s[8:11], s22 offen offset:1792 sc1
  v_smfmac_f32_16x16x64_bf16 v[48:51], v[28:31], a[208:215], v3
  s_add_u32 s22, s22, 3584
  buffer_load_dwordx4 v[136:139], v6, s[8:11], s22 offen offset:0 sc1
  v_smfmac_f32_16x16x64_bf16 v[52:55], v[28:31], v[184:191], v3
  buffer_load_dwordx4 v[140:143], v6, s[8:11], s22 offen offset:1792 sc1
  v_smfmac_f32_16x16x64_bf16 v[56:59], v[28:31], v[240:247], v3
  s_waitcnt lgkmcnt(4)
  v_smfmac_f32_16x16x64_bf16 v[36:39], v[8:11], a[0:7], v3
  s_waitcnt lgkmcnt(3)
  v_smfmac_f32_16x16x64_bf16 v[36:39], v[12:15], a[8:15], v3
  s_waitcnt lgkmcnt(2)
  v_smfmac_f32_16x16x64_bf16 v[36:39], v[16:19], a[16:23], v3
  s_waitcnt lgkmcnt(1)
  v_smfmac_f32_16x16x64_bf16 v[36:39], v[20:23], a[24:31], v3
  s_waitcnt lgkmcnt(0)
  v_smfmac_f32_16x16x64_bf16 v[36:39], v[32:35], a[48:55], v3
  v_smfmac_f32_16x16x64_bf16 v[40:43], v[8:11], a[56:63], v3
  v_smfmac_f32_16x16x64_bf16 v[40:43], v[12:15], a[64:71], v3
  v_smfmac_f32_16x16x64_bf16 v[40:43], v[16:19], a[72:79], v3
  v_permlane32_swap_b32 v36, v38
  v_smfmac_f32_16x16x64_bf16 v[40:43], v[20:23], a[80:87], v3
  v_permlane32_swap_b32 v37, v39
  v_smfmac_f32_16x16x64_bf16 v[40:43], v[32:35], a[104:111], v3
  v_add_f32 v36, v36, v38
  v_smfmac_f32_16x16x64_bf16 v[44:47], v[8:11], a[112:119], v3
  v_add_f32 v37, v37, v39
  v_smfmac_f32_16x16x64_bf16 v[44:47], v[12:15], a[120:127], v3
  v_cmp_u_f32 vcc, v36, v37
  v_smfmac_f32_16x16x64_bf16 v[44:47], v[16:19], a[128:135], v3
  v_cvt_pk_bf16_f32 v38, v36, v37
  v_smfmac_f32_16x16x64_bf16 v[44:47], v[20:23], a[136:143], v3
  ds_write_b32 v152, v38
  s_cbranch_vccnz cA_va0_slow
  v_permlane32_swap_b32 v40, v42
  v_smfmac_f32_16x16x64_bf16 v[44:47], v[32:35], a[160:167], v3
  v_permlane32_swap_b32 v41, v43
  v_smfmac_f32_16x16x64_bf16 v[48:51], v[8:11], a[168:175], v3
  buffer_store_dword v162, v1, s[8:11], s21 offen
  v_add_f32 v40, v40, v42
  v_smfmac_f32_16x16x64_bf16 v[48:51], v[12:15], a[176:183], v3
  v_add_f32 v41, v41, v43
  v_smfmac_f32_16x16x64_bf16 v[48:51], v[16:19], a[184:191], v3
  buffer_load_dword v164, v4, s[8:11], 0 offen sc1
  v_cvt_pk_bf16_f32 v42, v40, v41
  v_smfmac_f32_16x16x64_bf16 v[48:51], v[20:23], a[192:199], v3
  ds_write_b32 v153, v42
  v_permlane32_swap_b32 v44, v46
  v_smfmac_f32_16x16x64_bf16 v[48:51], v[32:35], a[216:223], v3
  v_permlane32_swap_b32 v45, v47
  v_smfmac_f32_16x16x64_bf16 v[52:55], v[8:11], a[224:231], v3
  buffer_load_dword v164, v4, s[8:11], 0 offen sc1
  v_add_f32 v44, v44, v46
  v_smfmac_f32_16x16x64_bf16 v[52:55], v[12:15], a[232:239], v3
  v_add_f32 v45, v45, v47
  v_smfmac_f32_16x16x64_bf16 v[52:55], v[16:19], a[240:247], v3
  v_cvt_pk_bf16_f32 v46, v44, v45
  v_smfmac_f32_16x16x64_bf16 v[52:55], v[20:23], a[248:255], v3
  ds_write_b32 v154, v46
  buffer_load_dword v164, v4, s[8:11], 0 offen sc1
  v_permlane32_swap_b32 v48, v50
  v_smfmac_f32_16x16x64_bf16 v[52:55], v[32:35], v[192:199], v3
  v_permlane32_swap_b32 v49, v51
  v_smfmac_f32_16x16x64_bf16 v[56:59], v[8:11], v[200:207], v3
  v_add_f32 v48, v48, v50
  v_smfmac_f32_16x16x64_bf16 v[56:59], v[12:15], v[208:215], v3
  buffer_load_dword v164, v4, s[8:11], 0 offen sc1
  v_add_f32 v49, v49, v51
  v_smfmac_f32_16x16x64_bf16 v[56:59], v[16:19], v[216:223], v3
  v_cvt_pk_bf16_f32 v50, v48, v49
  v_smfmac_f32_16x16x64_bf16 v[56:59], v[20:23], v[224:231], v3
  ds_write_b32 v155, v50
  v_permlane32_swap_b32 v52, v54
  v_smfmac_f32_16x16x64_bf16 v[56:59], v[32:35], v[248:255], v3
  buffer_load_dword v164, v4, s[8:11], 0 offen sc1
  v_permlane32_swap_b32 v53, v55
  v_add_f32 v52, v52, v54
  v_add_f32 v53, v53, v55
  v_cvt_pk_bf16_f32 v54, v52, v53
  ds_write_b32 v156, v54
  s_nop 1
  v_permlane32_swap_b32 v56, v58
  v_permlane32_swap_b32 v57, v59
  v_add_f32 v56, v56, v58
  v_add_f32 v57, v57, v59
  v_cvt_pk_bf16_f32 v58, v56, v57
  ds_write_b32 v157, v58
cA_va0_t2d:
  s_add_u32 s72, s20, s76
  s_add_u32 s73, s20, s77
  s_add_u32 s74, s20, s78
  s_add_u32 s75, s20, s79
  s_add_u32 s22, s20, 9216
  s_add_u32 s34, s20, 13312
  s_add_u32 s36, s20, 7168
  s_mov_b32 s37, 0
  v_mov_b32 v48, 0
  v_mov_b32 v49, 0
  v_mov_b32 v50, 0
  v_mov_b32 v51, 0
  v_mov_b32 v163, s18
  s_cmp_eq_u32 s19, 63
  s_waitcnt lgkmcnt(0)
  s_cbranch_scc1 cA_va0_last
  s_setprio 3
cA_va0_fw_l:
  v_cmp_gt_u32 vcc, s18, v164
  buffer_load_dword v164, v4, s[8:11], 0 offen sc1
  s_cbranch_vccz cA_va0_fw_d
  v_cmp_gt_u32 vcc, s18, v164
  buffer_load_dword v164, v4, s[8:11], 0 offen sc1
  s_cbranch_vccz cA_va0_fw_d
  v_cmp_gt_u32 vcc, s18, v164
  buffer_load_dword v164, v4, s[8:11], 0 offen sc1
  s_cbranch_vccz cA_va0_fw_d
  v_cmp_gt_u32 vcc, s18, v164
  buffer_load_dword v164, v4, s[8:11], 0 offen sc1
  s_cbranch_vccz cA_va0_fw_d
  v_cmp_gt_u32 vcc, s18, v164
  buffer_load_dword v164, v4, s[8:11], 0 offen sc1
  s_cbranch_vccz cA_va0_fw_d
  v_cmp_gt_u32 vcc, s18, v164
  buffer_load_dword v164, v4, s[8:11], 0 offen sc1
  s_cbranch_vccz cA_va0_fw_d
  v_cmp_gt_u32 vcc, s18, v164
  buffer_load_dword v164, v4, s[8:11], 0 offen sc1
  s_cbranch_vccz cA_va0_fw_d
  v_cmp_gt_u32 vcc, s18, v164
  buffer_load_dword v164, v4, s[8:11], 0 offen sc1
  s_cbranch_vccz cA_va0_fw_d
  v_cmp_gt_u32 vcc, s18, v164
  buffer_load_dword v164, v4, s[8:11], 0 offen sc1
  s_cbranch_vccz cA_va0_fw_d
  v_cmp_gt_u32 vcc, s18, v164
  buffer_load_dword v164, v4, s[8:11], 0 offen sc1
  s_cbranch_vccz cA_va0_fw_d
  v_cmp_gt_u32 vcc, s18, v164
  buffer_load_dword v164, v4, s[8:11], 0 offen sc1
  s_cbranch_vccz cA_va0_fw_d
  v_cmp_gt_u32 vcc, s18, v164
  buffer_load_dword v164, v4, s[8:11], 0 offen sc1
  s_cbranch_vccz cA_va0_fw_d
  v_cmp_gt_u32 vcc, s18, v164
  buffer_load_dword v164, v4, s[8:11], 0 offen sc1
  s_cbranch_vccz cA_va0_fw_d
  v_cmp_gt_u32 vcc, s18, v164
  buffer_load_dword v164, v4, s[8:11], 0 offen sc1
  s_cbranch_vccz cA_va0_fw_d
  v_cmp_gt_u32 vcc, s18, v164
  buffer_load_dword v164, v4, s[8:11], 0 offen sc1
  s_cbranch_vccz cA_va0_fw_d
  v_cmp_gt_u32 vcc, s18, v164
  buffer_load_dword v164, v4, s[8:11], 0 offen sc1
  s_cbranch_vccz cA_va0_fw_d
  s_waitcnt vmcnt(24)
  s_add_u32 s30, s30, 1
  s_cmp_lt_u32 s30, 400000
  s_cbranch_scc1 cA_va0_fw_l
  s_branch cA_abort
cA_va0_fw_d:
  buffer_load_dwordx4 v[8:11], v2, s[8:11], s72 offen offset:0 sc1
  buffer_load_dwordx4 v[12:15], v2, s[8:11], s72 offen offset:1024 sc1
  buffer_load_dwordx4 v[16:19], v2, s[8:11], s73 offen offset:0 sc1
  buffer_load_dwordx4 v[20:23], v2, s[8:11], s73 offen offset:1024 sc1
  buffer_load_dwordx4 v[24:27], v2, s[8:11], s74 offen offset:0 sc1
  buffer_load_dwordx4 v[28:31], v2, s[8:11], s74 offen offset:1024 sc1
  buffer_load_dwordx4 v[32:35], v2, s[8:11], s75 offen offset:0 sc1
  buffer_load_dwordx4 v[36:39], v2, s[8:11], s75 offen offset:1024 sc1
  buffer_load_dwordx4 v[40:43], v2, s[8:11], s36 offen offset:0 sc1
  buffer_load_dwordx4 v[44:47], v2, s[8:11], s36 offen offset:1024 sc1
  s_barrier
  ds_read_b128 v[64:67], v2 offset:0
  ds_read_b128 v[68:71], v2 offset:1024
  ds_read_b128 v[72:75], v2 offset:2048
  ds_read_b128 v[76:79], v2 offset:3072
cA_va0_lp:
  s_waitcnt vmcnt(9)
  v_smfmac_f32_16x16x64_bf16 v[48:51], v[8:11], v[80:87], v3
  s_waitcnt vmcnt(8)
  v_smfmac_f32_16x16x64_bf16 v[48:51], v[12:15], v[88:95], v3
  s_waitcnt vmcnt(7)
  v_smfmac_f32_16x16x64_bf16 v[48:51], v[16:19], v[96:103], v3
  s_waitcnt vmcnt(6)
  v_smfmac_f32_16x16x64_bf16 v[48:51], v[20:23], v[104:111], v3
  s_waitcnt vmcnt(5)
  v_smfmac_f32_16x16x64_bf16 v[48:51], v[24:27], v[112:119], v3
  s_waitcnt vmcnt(4)
  v_smfmac_f32_16x16x64_bf16 v[48:51], v[28:31], v[120:127], v3
  s_waitcnt vmcnt(3)
  v_smfmac_f32_16x16x64_bf16 v[48:51], v[32:35], v[128:135], v3
  s_waitcnt vmcnt(2)
  v_smfmac_f32_16x16x64_bf16 v[48:51], v[36:39], v[136:143], v3
  s_waitcnt vmcnt(1) lgkmcnt(0)
  v_smfmac_f32_16x16x64_bf16 v[48:51], v[40:43], v[64:71], v3
  s_waitcnt vmcnt(0)
  v_smfmac_f32_16x16x64_bf16 v[48:51], v[44:47], v[72:79], v3
  s_nop 7
  v_permlane32_swap_b32 v48, v50
  v_permlane32_swap_b32 v49, v51
  v_pk_add_f32 v[48:49], v[48:49], v[50:51]
  v_cvt_pk_bf16_f32 v160, v48, v49
  v_cmp_u_f32 vcc, v48, v49
  s_nop 0
  v_mov_b32_dpp v161, v160 quad_perm:[1,0,3,2] row_mask:0xf bank_mask:0xf
  v_perm_b32 v160, v161, v160, v5
  v_cndmask_b32 v161, v160, v162, vcc
  buffer_store_dword v161, v1, s[8:11], s21 offen
  s_cbranch_vccnz cA_va0_rp
cA_va0_cont:
  s_setprio 0
  s_cmp_lg_u32 s19, 62
  s_cbranch_scc1 cA_va0_nl
  s_mov_b32 s25, 0x40000000
cA_va0_nl:
  s_add_u32 s25, s25, 458752
  v_mov_b32 v36, 0
  v_mov_b32 v37, 0
  v_mov_b32 v38, 0
  v_mov_b32 v39, 0
  v_mov_b32 v40, 0
  v_mov_b32 v41, 0
  v_mov_b32 v42, 0
  v_mov_b32 v43, 0
  v_mov_b32 v44, 0
  v_mov_b32 v45, 0
  v_mov_b32 v46, 0
  v_mov_b32 v47, 0
  v_mov_b32 v48, 0
  v_mov_b32 v49, 0
  v_mov_b32 v50, 0
  v_mov_b32 v51, 0
  v_mov_b32 v52, 0
  v_mov_b32 v53, 0
  v_mov_b32 v54, 0
  v_mov_b32 v55, 0
  v_mov_b32 v56, 0
  v_mov_b32 v57, 0
  v_mov_b32 v58, 0
  v_mov_b32 v59, 0
  v_mov_b32 v60, 0
  v_mov_b32 v61, 0
  v_mov_b32 v62, 0
  v_mov_b32 v63, 0
  s_mov_b32 s19, s18
  s_add_u32 s18, s18, 1
  s_mov_b32 s22, s20
  s_mov_b32 s20, s21
  s_mov_b32 s21, s22
  s_add_u32 s23, s20, 4096
  s_branch cA_va0_loop
cA_va0_slow:
  s_waitcnt lgkmcnt(0)
cA_va0_sl1:
  s_add_u32 s31, s31, 0x1000000
  buffer_load_dwordx4 v[8:11], v2, s[8:11], s20 offen offset:0 sc1
  buffer_load_dwordx4 v[12:15], v2, s[8:11], s20 offen offset:1024 sc1
  buffer_load_dwordx4 v[16:19], v2, s[8:11], s20 offen offset:2048 sc1
  buffer_load_dwordx4 v[20:23], v2, s[8:11], s20 offen offset:3072 sc1
  buffer_load_dwordx4 v[24:27], v2, s[8:11], s23 offen offset:0 sc1
  buffer_load_dwordx4 v[28:31], v2, s[8:11], s23 offen offset:1024 sc1
  buffer_load_dwordx4 v[32:35], v2, s[8:11], s23 offen offset:2048 sc1
  s_waitcnt vmcnt(0)
  v_max3_u32 v36, v8, v9, v10
  v_max3_u32 v36, v36, v11, v12
  v_max3_u32 v36, v36, v13, v14
  v_max3_u32 v36, v36, v15, v16
  v_max3_u32 v36, v36, v17, v18
  v_max3_u32 v36, v36, v19, v20
  v_max3_u32 v36, v36, v21, v22
  v_max3_u32 v36, v36, v23, v24
  v_max3_u32 v36, v36, v25, v26
  v_max3_u32 v36, v36, v27, v28
  v_max3_u32 v36, v36, v29, v30
  v_max3_u32 v36, v36, v31, v32
  v_max3_u32 v36, v36, v33, v34
  v_max_u32 v36, v36, v35
  v_cmp_eq_u32 vcc, -1, v36
  s_cbranch_vccz cA_va0_sl2
  s_add_u32 s30, s30, 1
  s_cmp_lt_u32 s30, 400000
  s_cbranch_scc1 cA_va0_sl1
  s_branch cA_abort
cA_va0_sl2:
  v_mov_b32 v36, 0
  v_mov_b32 v37, 0
  v_mov_b32 v38, 0
  v_mov_b32 v39, 0
  v_mov_b32 v40, 0
  v_mov_b32 v41, 0
  v_mov_b32 v42, 0
  v_mov_b32 v43, 0
  v_mov_b32 v44, 0
  v_mov_b32 v45, 0
  v_mov_b32 v46, 0
  v_mov_b32 v47, 0
  v_mov_b32 v48, 0
  v_mov_b32 v49, 0
  v_mov_b32 v50, 0
  v_mov_b32 v51, 0
  v_mov_b32 v52, 0
  v_mov_b32 v53, 0
  v_mov_b32 v54, 0
  v_mov_b32 v55, 0
  v_mov_b32 v56, 0
  v_mov_b32 v57, 0
  v_mov_b32 v58, 0
  v_mov_b32 v59, 0
  v_mov_b32 v60, 0
  v_mov_b32 v61, 0
  v_mov_b32 v62, 0
  v_mov_b32 v63, 0
  buffer_store_dword v162, v1, s[8:11], s21 offen
  v_smfmac_f32_16x16x64_bf16 v[36:39], v[8:11], a[0:7], v3
  v_smfmac_f32_16x16x64_bf16 v[40:43], v[8:11], a[56:63], v3
  v_smfmac_f32_16x16x64_bf16 v[44:47], v[8:11], a[112:119], v3
  v_smfmac_f32_16x16x64_bf16 v[48:51], v[8:11], a[168:175], v3
  v_smfmac_f32_16x16x64_bf16 v[52:55], v[8:11], a[224:231], v3
  v_smfmac_f32_16x16x64_bf16 v[56:59], v[8:11], v[200:207], v3
  v_smfmac_f32_16x16x64_bf16 v[36:39], v[12:15], a[8:15], v3
  v_smfmac_f32_16x16x64_bf16 v[40:43], v[12:15], a[64:71], v3
  v_smfmac_f32_16x16x64_bf16 v[44:47], v[12:15], a[120:127], v3
  v_smfmac_f32_16x16x64_bf16 v[48:51], v[12:15], a[176:183], v3
  v_smfmac_f32_16x16x64_bf16 v[52:55], v[12:15], a[232:239], v3
  v_smfmac_f32_16x16x64_bf16 v[56:59], v[12:15], v[208:215], v3
  v_smfmac_f32_16x16x64_bf16 v[36:39], v[16:19], a[16:23], v3
  v_smfmac_f32_16x16x64_bf16 v[40:43], v[16:19], a[72:79], v3
  v_smfmac_f32_16x16x64_bf16 v[44:47], v[16:19], a[128:135], v3
  v_smfmac_f32_16x16x64_bf16 v[48:51], v[16:19], a[184:191], v3
  v_smfmac_f32_16x16x64_bf16 v[52:55], v[16:19], a[240:247], v3
  v_smfmac_f32_16x16x64_bf16 v[56:59], v[16:19], v[216:223], v3
  v_smfmac_f32_16x16x64_bf16 v[36:39], v[20:23], a[24:31], v3
  v_smfmac_f32_16x16x64_bf16 v[40:43], v[20:23], a[80:87], v3
  v_smfmac_f32_16x16x64_bf16 v[44:47], v[20:23], a[136:143], v3
  v_smfmac_f32_16x16x64_bf16 v[48:51], v[20:23], a[192:199], v3
  v_smfmac_f32_16x16x64_bf16 v[52:55], v[20:23], a[248:255], v3
  v_smfmac_f32_16x16x64_bf16 v[56:59], v[20:23], v[224:231], v3
  v_smfmac_f32_16x16x64_bf16 v[36:39], v[24:27], a[32:39], v3
  v_smfmac_f32_16x16x64_bf16 v[40:43], v[24:27], a[88:95], v3
  v_smfmac_f32_16x16x64_bf16 v[44:47], v[24:27], a[144:151], v3
  v_smfmac_f32_16x16x64_bf16 v[48:51], v[24:27], a[200:207], v3
  v_smfmac_f32_16x16x64_bf16 v[52:55], v[24:27], v[176:183], v3
  v_smfmac_f32_16x16x64_bf16 v[56:59], v[24:27], v[232:239], v3
  v_smfmac_f32_16x16x64_bf16 v[36:39], v[28:31], a[40:47], v3
  v_smfmac_f32_16x16x64_bf16 v[40:43], v[28:31], a[96:103], v3
  v_smfmac_f32_16x16x64_bf16 v[44:47], v[28:31], a[152:159], v3
  v_smfmac_f32_16x16x64_bf16 v[48:51], v[28:31], a[208:215], v3
  v_smfmac_f32_16x16x64_bf16 v[52:55], v[28:31], v[184:191], v3
  v_smfmac_f32_16x16x64_bf16 v[56:59], v[28:31], v[240:247], v3
  v_smfmac_f32_16x16x64_bf16 v[36:39], v[32:35], a[48:55], v3
  v_smfmac_f32_16x16x64_bf16 v[40:43], v[32:35], a[104:111], v3
  v_smfmac_f32_16x16x64_bf16 v[44:47], v[32:35], a[160:167], v3
  v_smfmac_f32_16x16x64_bf16 v[48:51], v[32:35], a[216:223], v3
  v_smfmac_f32_16x16x64_bf16 v[52:55], v[32:35], v[192:199], v3
  v_smfmac_f32_16x16x64_bf16 v[56:59], v[32:35], v[248:255], v3
  v_permlane32_swap_b32 v36, v38
  v_permlane32_swap_b32 v37, v39
  v_add_f32 v36, v36, v38
  v_add_f32 v37, v37, v39
  v_cvt_pk_bf16_f32 v38, v36, v37
  ds_write_b32 v152, v38
  v_permlane32_swap_b32 v40, v42
  v_permlane32_swap_b32 v41, v43
  v_add_f32 v40, v40, v42
  v_add_f32 v41, v41, v43
  v_cvt_pk_bf16_f32 v42, v40, v41
  ds_write_b32 v153, v42
  v_permlane32_swap_b32 v44, v46
  v_permlane32_swap_b32 v45, v47
  v_add_f32 v44, v44, v46
  v_add_f32 v45, v45, v47
  v_cvt_pk_bf16_f32 v46, v44, v45
  ds_write_b32 v154, v46
  v_permlane32_swap_b32 v48, v50
  v_permlane32_swap_b32 v49, v51
  v_add_f32 v48, v48, v50
  v_add_f32 v49, v49, v51
  v_cvt_pk_bf16_f32 v50, v48, v49
  ds_write_b32 v155, v50
  v_permlane32_swap_b32 v52, v54
  v_permlane32_swap_b32 v53, v55
  v_add_f32 v52, v52, v54
  v_add_f32 v53, v53, v55
  v_cvt_pk_bf16_f32 v54, v52, v53
  ds_write_b32 v156, v54
  v_permlane32_swap_b32 v56, v58
  v_permlane32_swap_b32 v57, v59
  v_add_f32 v56, v56, v58
  v_add_f32 v57, v57, v59
  v_cvt_pk_bf16_f32 v58, v56, v57
  ds_write_b32 v157, v58
  buffer_load_dword v164, v4, s[8:11], 0 offen sc1
  buffer_load_dword v164, v4, s[8:11], 0 offen sc1
  buffer_load_dword v164, v4, s[8:11], 0 offen sc1
  buffer_load_dword v164, v4, s[8:11], 0 offen sc1
  buffer_load_dword v164, v4, s[8:11], 0 offen sc1
  s_branch cA_va0_t2d
cA_va0_last:
  s_barrier
  ds_read_b128 v[64:67], v2 offset:0
  ds_read_b128 v[68:71], v2 offset:1024
  ds_read_b128 v[72:75], v2 offset:2048
  ds_read_b128 v[76:79], v2 offset:3072
  s_waitcnt lgkmcnt(0)
  v_min_u32 v64, -2, v64
  v_min_u32 v65, -2, v65
  v_min_u32 v66, -2, v66
  v_min_u32 v67, -2, v67
  v_min_u32 v68, -2, v68
  v_min_u32 v69, -2, v69
  v_min_u32 v70, -2, v70
  v_min_u32 v71, -2, v71
  v_min_u32 v72, -2, v72
  v_min_u32 v73, -2, v73
  v_min_u32 v74, -2, v74
  v_min_u32 v75, -2, v75
  v_min_u32 v76, -2, v76
  v_min_u32 v77, -2, v77
  v_min_u32 v78, -2, v78
  v_min_u32 v79, -2, v79
  buffer_store_dwordx4 v[64:67], v2, s[8:11], s33 offen offset:0 sc1
  buffer_store_dwordx4 v[68:71], v2, s[8:11], s33 offen offset:2048 sc1
  s_add_u32 s33, s33, 4096
  buffer_store_dwordx4 v[72:75], v2, s[8:11], s33 offen offset:0 sc1
  buffer_store_dwordx4 v[76:79], v2, s[8:11], s33 offen offset:2048 sc1
  s_add_u32 s33, s33, 4096
  s_cmp_lg_u32 s17, 0
  s_cbranch_scc1 cA_done
  s_waitcnt vmcnt(0)
  buffer_wbl2 sc1
  s_branch cA_done
cA_va0_rp:
  s_cmp_eq_u32 s37, 0
  s_cbranch_scc1 cA_va0_rv
  v_min_u32 v160, -2, v160
  buffer_store_dword v160, v1, s[8:11], s21 offen
  s_branch cA_va0_cont
cA_va0_rv:
  s_add_u32 s31, s31, 0x10000
  buffer_load_dwordx4 v[8:11], v2, s[8:11], s72 offen offset:0 sc1
  buffer_load_dwordx4 v[12:15], v2, s[8:11], s72 offen offset:1024 sc1
  buffer_load_dwordx4 v[16:19], v2, s[8:11], s73 offen offset:0 sc1
  buffer_load_dwordx4 v[20:23], v2, s[8:11], s73 offen offset:1024 sc1
  buffer_load_dwordx4 v[24:27], v2, s[8:11], s74 offen offset:0 sc1
  buffer_load_dwordx4 v[28:31], v2, s[8:11], s74 offen offset:1024 sc1
  buffer_load_dwordx4 v[32:35], v2, s[8:11], s75 offen offset:0 sc1
  buffer_load_dwordx4 v[36:39], v2, s[8:11], s75 offen offset:1024 sc1
  buffer_load_dwordx4 v[40:43], v2, s[8:11], s36 offen offset:0 sc1
  buffer_load_dwordx4 v[44:47], v2, s[8:11], s36 offen offset:1024 sc1
  s_waitcnt vmcnt(0)
  v_max3_u32 v52, v8, v9, v10
  v_max3_u32 v52, v52, v11, v12
  v_max3_u32 v52, v52, v13, v14
  v_max3_u32 v52, v52, v15, v16
  v_max3_u32 v52, v52, v17, v18
  v_max3_u32 v52, v52, v19, v20
  v_max3_u32 v52, v52, v21, v22
  v_max3_u32 v52, v52, v23, v24
  v_max3_u32 v52, v52, v25, v26
  v_max3_u32 v52, v52, v27, v28
  v_max3_u32 v52, v52, v29, v30
  v_max3_u32 v52, v52, v31, v32
  v_max3_u32 v52, v52, v33, v34
  v_max3_u32 v52, v52, v35, v36
  v_max3_u32 v52, v52, v37, v38
  v_max3_u32 v52, v52, v39, v40
  v_max3_u32 v52, v52, v41, v42
  v_max3_u32 v52, v52, v43, v44
  v_max3_u32 v52, v52, v45, v46
  v_max_u32 v52, v52, v47
  v_cmp_eq_u32 vcc, -1, v52
  s_mov_b32 s37, 1
  v_mov_b32 v48, 0
  v_mov_b32 v49, 0
  v_mov_b32 v50, 0
  v_mov_b32 v51, 0
  s_nop 1
  s_cbranch_vccz cA_va0_lp
  s_add_u32 s30, s30, 1
  s_cmp_lt_u32 s30, 400000
  s_cbranch_scc1 cA_va0_rv
  s_branch cA_abort
.p2align 6
cA_va1_loop:
  s_mov_b32 s30, 0
  s_barrier
  buffer_load_dwordx4 v[28:31], v2, s[8:11], s23 offen offset:1024 sc1
  buffer_load_dwordx4 v[32:35], v2, s[8:11], s23 offen offset:2048 sc1
  s_barrier
  s_cmp_lt_u32 s19, 60
  s_cbranch_scc1 cA_va1_m1
  buffer_store_dword v160, v1, s[8:11], s38 offen sc1
  s_cmp_lg_u32 s19, 63
  s_cbranch_scc1 cA_va1_m2
  v_min_u32 v64, -2, v64
  v_min_u32 v65, -2, v65
  v_min_u32 v66, -2, v66
  v_min_u32 v67, -2, v67
  v_min_u32 v68, -2, v68
  v_min_u32 v69, -2, v69
  v_min_u32 v70, -2, v70
  v_min_u32 v71, -2, v71
  v_min_u32 v72, -2, v72
  v_min_u32 v73, -2, v73
  v_min_u32 v74, -2, v74
  v_min_u32 v75, -2, v75
  v_min_u32 v76, -2, v76
  v_min_u32 v77, -2, v77
  v_min_u32 v78, -2, v78
  v_min_u32 v79, -2, v79
  buffer_store_dwordx4 v[64:67], v2, s[8:11], s33 offen offset:0 sc1
  buffer_store_dwordx4 v[68:71], v2, s[8:11], s33 offen offset:2048 sc1
  s_add_u32 s33, s33, 4096
  buffer_store_dwordx4 v[72:75], v2, s[8:11], s33 offen offset:0 sc1
  buffer_store_dwordx4 v[76:79], v2, s[8:11], s33 offen offset:2048 sc1
  s_add_u32 s33, s33, 4096
  s_waitcnt vmcnt(5)
  s_branch cA_va1_m3
cA_va1_m1:
  buffer_store_dword v160, v1, s[8:11], s38 offen nt
cA_va1_m2:
  s_add_u32 s22, s25, s80
  buffer_load_dwordx4 v[80:83], v6, s[8:11], s22 offen offset:0 sc1
  buffer_load_dwordx4 v[84:87], v6, s[8:11], s22 offen offset:1792 sc1
  s_add_u32 s22, s22, 3584
  buffer_load_dwordx4 v[88:91], v6, s[8:11], s22 offen offset:0 sc1
  buffer_load_dwordx4 v[92:95], v6, s[8:11], s22 offen offset:1792 sc1
  s_add_u32 s22, s25, s81
  buffer_load_dwordx4 v[96:99], v6, s[8:11], s22 offen offset:0 sc1
  s_mul_i32 s38, s18, 7168
  s_add_u32 s38, s38, 65536
  s_waitcnt vmcnt(6)
cA_va1_m3:
  ds_write_b128 v2, v[32:35] offset:14336
  v_smfmac_f32_16x16x64_bf16 v[36:39], v[28:31], a[40:47], v3
  buffer_load_dwordx4 v[100:103], v6, s[8:11], s22 offen offset:1792 sc1
  v_smfmac_f32_16x16x64_bf16 v[40:43], v[28:31], a[96:103], v3
  s_add_u32 s22, s22, 3584
  buffer_load_dwordx4 v[104:107], v6, s[8:11], s22 offen offset:0 sc1
  v_smfmac_f32_16x16x64_bf16 v[44:47], v[28:31], a[152:159], v3
  buffer_load_dwordx4 v[108:111], v6, s[8:11], s22 offen offset:1792 sc1
  v_smfmac_f32_16x16x64_bf16 v[48:51], v[28:31], a[208:215], v3
  s_add_u32 s22, s25, s82
  buffer_load_dwordx4 v[112:115], v6, s[8:11], s22 offen offset:0 sc1
  v_smfmac_f32_16x16x64_bf16 v[52:55], v[28:31], v[184:191], v3
  s_waitcnt lgkmcnt(0)
  s_barrier
  ds_read_b128 v[8:11], v2 offset:8192
  ds_read_b128 v[12:15], v2 offset:9216
  ds_read_b128 v[16:19], v2 offset:10240
  ds_read_b128 v[20:23], v2 offset:11264
  ds_read_b128 v[24:27], v2 offset:12288
  buffer_load_dwordx4 v[116:119], v6, s[8:11], s22 offen offset:1792 sc1
  v_smfmac_f32_16x16x64_bf16 v[56:59], v[28:31], v[240:247], v3
  s_add_u32 s22, s22, 3584
  buffer_load_dwordx4 v[120:123], v6, s[8:11], s22 offen offset:0 sc1
  v_smfmac_f32_16x16x64_bf16 v[36:39], v[32:35], a[48:55], v3
  buffer_load_dwordx4 v[124:127], v6, s[8:11], s22 offen offset:1792 sc1
  v_smfmac_f32_16x16x64_bf16 v[40:43], v[32:35], a[104:111], v3
  s_add_u32 s22, s25, s83
  buffer_load_dwordx4 v[128:131], v6, s[8:11], s22 offen offset:0 sc1
  v_smfmac_f32_16x16x64_bf16 v[44:47], v[32:35], a[160:167], v3
  buffer_load_dwordx4 v[132:135], v6, s[8:11], s22 offen offset:1792 sc1
  v_smfmac_f32_16x16x64_bf16 v[48:51], v[32:35], a[216:223], v3
  s_add_u32 s22, s22, 3584
  buffer_load_dwordx4 v[136:139], v6, s[8:11], s22 offen offset:0 sc1
  v_smfmac_f32_16x16x64_bf16 v[52:55], v[32:35], v[192:199], v3
  ds_read_b128 v[64:67], v0 offset:0
  ds_read_b128 v[68:71], v0 offset:1024
  buffer_load_dwordx4 v[140:143], v6, s[8:11], s22 offen offset:1792 sc1
  v_smfmac_f32_16x16x64_bf16 v[56:59], v[32:35], v[248:255], v3
  s_waitcnt lgkmcnt(6)
  ds_read_b128 v[72:75], v0 offset:2048
  ds_read_b128 v[76:79], v0 offset:3072
  v_smfmac_f32_16x16x64_bf16 v[36:39], v[8:11], a[0:7], v3
  s_waitcnt lgkmcnt(7)
  v_smfmac_f32_16x16x64_bf16 v[36:39], v[12:15], a[8:15], v3
  s_waitcnt lgkmcnt(6)
  v_smfmac_f32_16x16x64_bf16 v[36:39], v[16:19], a[16:23], v3
  s_waitcnt lgkmcnt(2)
  v_smfmac_f32_16x16x64_bf16 v[60:63], v[8:11], v[64:71], v3
  s_waitcnt lgkmcnt(5)
  ds_read_b128 v[144:147], v0 offset:4096
  ds_read_b128 v[148:151], v0 offset:5120
  v_smfmac_f32_16x16x64_bf16 v[36:39], v[20:23], a[24:31], v3
  s_waitcnt lgkmcnt(6)
  v_smfmac_f32_16x16x64_bf16 v[36:39], v[24:27], a[32:39], v3
  v_smfmac_f32_16x16x64_bf16 v[40:43], v[8:11], a[56:63], v3
  s_waitcnt lgkmcnt(2)
  v_smfmac_f32_16x16x64_bf16 v[60:63], v[12:15], v[72:79], v3
  ds_read_b128 v[64:67], v0 offset:6144
  ds_read_b128 v[68:71], v0 offset:7168
  v_smfmac_f32_16x16x64_bf16 v[40:43], v[12:15], a[64:71], v3
  v_permlane32_swap_b32 v36, v38
  v_smfmac_f32_16x16x64_bf16 v[40:43], v[16:19], a[72:79], v3
  v_permlane32_swap_b32 v37, v39
  v_smfmac_f32_16x16x64_bf16 v[40:43], v[20:23], a[80:87], v3
  s_waitcnt lgkmcnt(2)
  v_add_f32 v36, v36, v38
  v_smfmac_f32_16x16x64_bf16 v[60:63], v[16:19], v[144:151], v3
  ds_read_b128 v[72:75], v0 offset:8192
  ds_read_b128 v[76:79], v0 offset:9216
  v_add_f32 v37, v37, v39
  v_smfmac_f32_16x16x64_bf16 v[40:43], v[24:27], a[88:95], v3
  v_cmp_u_f32 vcc, v36, v37
  v_smfmac_f32_16x16x64_bf16 v[44:47], v[8:11], a[112:119], v3
  v_cvt_pk_bf16_f32 v38, v36, v37
  v_smfmac_f32_16x16x64_bf16 v[44:47], v[12:15], a[120:127], v3
  ds_write_b32 v152, v38
  s_waitcnt lgkmcnt(3)
  s_cbranch_vccnz cA_va1_slow
  v_permlane32_swap_b32 v40, v42
  v_smfmac_f32_16x16x64_bf16 v[60:63], v[20:23], v[64:71], v3
  ds_read_b128 v[144:147], v0 offset:10240
  ds_read_b128 v[148:151], v0 offset:11264
  v_permlane32_swap_b32 v41, v43
  v_smfmac_f32_16x16x64_bf16 v[44:47], v[16:19], a[128:135], v3
  buffer_store_dword v162, v1, s[8:11], s21 offen
  v_add_f32 v40, v40, v42
  v_smfmac_f32_16x16x64_bf16 v[44:47], v[20:23], a[136:143], v3
  v_add_f32 v41, v41, v43
  v_smfmac_f32_16x16x64_bf16 v[44:47], v[24:27], a[144:151], v3
  s_waitcnt lgkmcnt(3)
  v_cvt_pk_bf16_f32 v42, v40, v41
  v_smfmac_f32_16x16x64_bf16 v[60:63], v[24:27], v[72:79], v3
  ds_write_b32 v153, v42
  ds_read_b128 v[64:67], v0 offset:12288
  ds_read_b128 v[68:71], v0 offset:13312
  v_smfmac_f32_16x16x64_bf16 v[48:51], v[8:11], a[168:175], v3
  s_nop 0
  v_permlane32_swap_b32 v44, v46
  v_smfmac_f32_16x16x64_bf16 v[48:51], v[12:15], a[176:183], v3
  v_permlane32_swap_b32 v45, v47
  v_smfmac_f32_16x16x64_bf16 v[48:51], v[16:19], a[184:191], v3
  s_waitcnt lgkmcnt(3)
  v_add_f32 v44, v44, v46
  v_smfmac_f32_16x16x64_bf16 v[60:63], v[28:31], v[144:151], v3
  v_add_f32 v45, v45, v47
  v_smfmac_f32_16x16x64_bf16 v[48:51], v[20:23], a[192:199], v3
  v_cvt_pk_bf16_f32 v46, v44, v45
  v_smfmac_f32_16x16x64_bf16 v[48:51], v[24:27], a[200:207], v3
  ds_write_b32 v154, v46
  v_smfmac_f32_16x16x64_bf16 v[52:55], v[8:11], a[224:231], v3
  s_waitcnt lgkmcnt(1)
  v_smfmac_f32_16x16x64_bf16 v[60:63], v[32:35], v[64:71], v3
  v_smfmac_f32_16x16x64_bf16 v[52:55], v[12:15], a[232:239], v3
  v_permlane32_swap_b32 v48, v50
  v_smfmac_f32_16x16x64_bf16 v[52:55], v[16:19], a[240:247], v3
  v_permlane32_swap_b32 v49, v51
  v_smfmac_f32_16x16x64_bf16 v[52:55], v[20:23], a[248:255], v3
  v_add_f32 v48, v48, v50
  v_smfmac_f32_16x16x64_bf16 v[52:55], v[24:27], v[176:183], v3
  v_add_f32 v49, v49, v51
  v_smfmac_f32_16x16x64_bf16 v[56:59], v[8:11], v[200:207], v3
  v_cvt_pk_bf16_f32 v50, v48, v49
  v_smfmac_f32_16x16x64_bf16 v[56:59], v[12:15], v[208:215], v3
  ds_write_b32 v155, v50
  v_permlane32_swap_b32 v60, v62
  v_smfmac_f32_16x16x64_bf16 v[56:59], v[16:19], v[216:223], v3
  v_permlane32_swap_b32 v61, v63
  v_smfmac_f32_16x16x64_bf16 v[56:59], v[20:23], v[224:231], v3
  v_add_f32 v60, v60, v62
  v_smfmac_f32_16x16x64_bf16 v[56:59], v[24:27], v[232:239], v3
  v_add_f32 v61, v61, v63
  v_cvt_pk_bf16_f32 v62, v60, v61
  ds_write_b32 v158, v62
  v_permlane32_swap_b32 v52, v54
  v_permlane32_swap_b32 v53, v55
  v_add_f32 v52, v52, v54
  v_add_f32 v53, v53, v55
  v_cvt_pk_bf16_f32 v54, v52, v53
  ds_write_b32 v156, v54
  v_permlane32_swap_b32 v56, v58
  v_permlane32_swap_b32 v57, v59
  v_add_f32 v56, v56, v58
  v_add_f32 v57, v57, v59
  v_cvt_pk_bf16_f32 v58, v56, v57
  ds_write_b32 v157, v58
cA_va1_t2d:
  s_add_u32 s72, s20, s76
  s_add_u32 s73, s20, s77
  s_add_u32 s74, s20, s78
  s_add_u32 s75, s20, s79
  s_add_u32 s22, s20, 9216
  s_add_u32 s34, s20, 13312
  s_add_u32 s36, s20, 7168
  s_mov_b32 s37, 0
  v_mov_b32 v48, 0
  v_mov_b32 v49, 0
  v_mov_b32 v50, 0
  v_mov_b32 v51, 0
  v_mov_b32 v163, s18
  s_cmp_eq_u32 s19, 63
  s_waitcnt lgkmcnt(0)
  s_cbranch_scc1 cA_va1_last
  s_barrier
  buffer_load_dwordx4 v[8:11], v2, s[8:11], s72 offen offset:0 sc1
  buffer_load_dwordx4 v[12:15], v2, s[8:11], s72 offen offset:1024 sc1
  buffer_load_dwordx4 v[16:19], v2, s[8:11], s73 offen offset:0 sc1
  buffer_load_dwordx4 v[20:23], v2, s[8:11], s73 offen offset:1024 sc1
  buffer_load_dwordx4 v[24:27], v2, s[8:11], s74 offen offset:0 sc1
  buffer_load_dwordx4 v[28:31], v2, s[8:11], s74 offen offset:1024 sc1
  buffer_load_dwordx4 v[32:35], v2, s[8:11], s75 offen offset:0 sc1
  buffer_load_dwordx4 v[36:39], v2, s[8:11], s75 offen offset:1024 sc1
  buffer_load_dwordx4 v[40:43], v2, s[8:11], s36 offen offset:0 sc1
  buffer_load_dwordx4 v[44:47], v2, s[8:11], s36 offen offset:1024 sc1
  ds_read_b128 v[64:67], v2 offset:4096
  ds_read_b128 v[68:71], v2 offset:5120
  ds_read_b128 v[72:75], v2 offset:6144
  ds_read_b128 v[76:79], v2 offset:7168
cA_va1_lp:
  s_waitcnt vmcnt(9)
  v_smfmac_f32_16x16x64_bf16 v[48:51], v[8:11], v[80:87], v3
  s_waitcnt vmcnt(8)
  v_smfmac_f32_16x16x64_bf16 v[48:51], v[12:15], v[88:95], v3
  s_waitcnt vmcnt(7)
  v_smfmac_f32_16x16x64_bf16 v[48:51], v[16:19], v[96:103], v3
  v_max3_u32 v55, v8, v12, v16
  s_waitcnt vmcnt(6)
  v_smfmac_f32_16x16x64_bf16 v[48:51], v[20:23], v[104:111], v3
  s_waitcnt vmcnt(5)
  v_smfmac_f32_16x16x64_bf16 v[48:51], v[24:27], v[112:119], v3
  v_max3_u32 v55, v55, v20, v24
  s_waitcnt vmcnt(4)
  v_smfmac_f32_16x16x64_bf16 v[48:51], v[28:31], v[120:127], v3
  v_max_u32 v55, v55, v28
  v_cmp_eq_u32 vcc, -1, v55
  s_waitcnt vmcnt(3)
  v_smfmac_f32_16x16x64_bf16 v[48:51], v[32:35], v[128:135], v3
  s_waitcnt vmcnt(2)
  v_smfmac_f32_16x16x64_bf16 v[48:51], v[36:39], v[136:143], v3
  s_cbranch_vccnz cA_va1_rv
  buffer_store_dword v163, v7, s[8:11], 0 offen
  s_waitcnt vmcnt(2) lgkmcnt(0)
  v_smfmac_f32_16x16x64_bf16 v[48:51], v[40:43], v[64:71], v3
  s_waitcnt vmcnt(1)
  v_smfmac_f32_16x16x64_bf16 v[48:51], v[44:47], v[72:79], v3
  s_nop 7
  v_permlane32_swap_b32 v48, v50
  v_permlane32_swap_b32 v49, v51
  v_pk_add_f32 v[48:49], v[48:49], v[50:51]
  v_cvt_pk_bf16_f32 v160, v48, v49
  v_cmp_u_f32 vcc, v48, v49
  s_nop 0
  v_mov_b32_dpp v161, v160 quad_perm:[1,0,3,2] row_mask:0xf bank_mask:0xf
  v_perm_b32 v160, v161, v160, v5
  v_cndmask_b32 v161, v160, v162, vcc
  buffer_store_dword v161, v1, s[8:11], s21 offen
  s_cbranch_vccnz cA_va1_rp
cA_va1_cont:
  s_cmp_lg_u32 s19, 62
  s_cbranch_scc1 cA_va1_nl
  s_mov_b32 s25, 0x40000000
cA_va1_nl:
  s_add_u32 s25, s25, 458752
  v_mov_b32 v36, 0
  v_mov_b32 v37, 0
  v_mov_b32 v38, 0
  v_mov_b32 v39, 0
  v_mov_b32 v40, 0
  v_mov_b32 v41, 0
  v_mov_b32 v42, 0
  v_mov_b32 v43, 0
  v_mov_b32 v44, 0
  v_mov_b32 v45, 0
  v_mov_b32 v46, 0
  v_mov_b32 v47, 0
  v_mov_b32 v48, 0
  v_mov_b32 v49, 0
  v_mov_b32 v50, 0
  v_mov_b32 v51, 0
  v_mov_b32 v52, 0
  v_mov_b32 v53, 0
  v_mov_b32 v54, 0
  v_mov_b32 v55, 0
  v_mov_b32 v56, 0
  v_mov_b32 v57, 0
  v_mov_b32 v58, 0
  v_mov_b32 v59, 0
  v_mov_b32 v60, 0
  v_mov_b32 v61, 0
  v_mov_b32 v62, 0
  v_mov_b32 v63, 0
  s_mov_b32 s19, s18
  s_add_u32 s18, s18, 1
  s_mov_b32 s22, s20
  s_mov_b32 s20, s21
  s_mov_b32 s21, s22
  s_add_u32 s23, s20, 4096
  s_branch cA_va1_loop
cA_va1_slow:
  s_waitcnt lgkmcnt(0)
cA_va1_sl1:
  s_add_u32 s31, s31, 0x1000000
  buffer_load_dwordx4 v[8:11], v2, s[8:11], s20 offen offset:0 sc1
  buffer_load_dwordx4 v[12:15], v2, s[8:11], s20 offen offset:1024 sc1
  buffer_load_dwordx4 v[16:19], v2, s[8:11], s20 offen offset:2048 sc1
  buffer_load_dwordx4 v[20:23], v2, s[8:11], s20 offen offset:3072 sc1
  buffer_load_dwordx4 v[24:27], v2, s[8:11], s23 offen offset:0 sc1
  buffer_load_dwordx4 v[28:31], v2, s[8:11], s23 offen offset:1024 sc1
  buffer_load_dwordx4 v[32:35], v2, s[8:11], s23 offen offset:2048 sc1
  s_waitcnt vmcnt(0)
  v_max3_u32 v36, v8, v9, v10
  v_max3_u32 v36, v36, v11, v12
  v_max3_u32 v36, v36, v13, v14
  v_max3_u32 v36, v36, v15, v16
  v_max3_u32 v36, v36, v17, v18
  v_max3_u32 v36, v36, v19, v20
  v_max3_u32 v36, v36, v21, v22
  v_max3_u32 v36, v36, v23, v24
  v_max3_u32 v36, v36, v25, v26
  v_max3_u32 v36, v36, v27, v28
  v_max3_u32 v36, v36, v29, v30
  v_max3_u32 v36, v36, v31, v32
  v_max3_u32 v36, v36, v33, v34
  v_max_u32 v36, v36, v35
  v_cmp_eq_u32 vcc, -1, v36
  s_cbranch_vccz cA_va1_sl2
  s_add_u32 s30, s30, 1
  s_cmp_lt_u32 s30, 400000
  s_cbranch_scc1 cA_va1_sl1
  s_branch cA_abort
cA_va1_sl2:
  v_mov_b32 v36, 0
  v_mov_b32 v37, 0
  v_mov_b32 v38, 0
  v_mov_b32 v39, 0
  v_mov_b32 v40, 0
  v_mov_b32 v41, 0
  v_mov_b32 v42, 0
  v_mov_b32 v43, 0
  v_mov_b32 v44, 0
  v_mov_b32 v45, 0
  v_mov_b32 v46, 0
  v_mov_b32 v47, 0
  v_mov_b32 v48, 0
  v_mov_b32 v49, 0
  v_mov_b32 v50, 0
  v_mov_b32 v51, 0
  v_mov_b32 v52, 0
  v_mov_b32 v53, 0
  v_mov_b32 v54, 0
  v_mov_b32 v55, 0
  v_mov_b32 v56, 0
  v_mov_b32 v57, 0
  v_mov_b32 v58, 0
  v_mov_b32 v59, 0
  v_mov_b32 v60, 0
  v_mov_b32 v61, 0
  v_mov_b32 v62, 0
  v_mov_b32 v63, 0
  buffer_store_dword v162, v1, s[8:11], s21 offen
  ds_read_b128 v[64:67], v0 offset:0
  ds_read_b128 v[68:71], v0 offset:1024
  v_smfmac_f32_16x16x64_bf16 v[36:39], v[8:11], a[0:7], v3
  v_smfmac_f32_16x16x64_bf16 v[40:43], v[8:11], a[56:63], v3
  v_smfmac_f32_16x16x64_bf16 v[44:47], v[8:11], a[112:119], v3
  v_smfmac_f32_16x16x64_bf16 v[48:51], v[8:11], a[168:175], v3
  v_smfmac_f32_16x16x64_bf16 v[52:55], v[8:11], a[224:231], v3
  v_smfmac_f32_16x16x64_bf16 v[56:59], v[8:11], v[200:207], v3
  s_waitcnt lgkmcnt(0)
  v_smfmac_f32_16x16x64_bf16 v[60:63], v[8:11], v[64:71], v3
  ds_read_b128 v[72:75], v0 offset:2048
  ds_read_b128 v[76:79], v0 offset:3072
  v_smfmac_f32_16x16x64_bf16 v[36:39], v[12:15], a[8:15], v3
  v_smfmac_f32_16x16x64_bf16 v[40:43], v[12:15], a[64:71], v3
  v_smfmac_f32_16x16x64_bf16 v[44:47], v[12:15], a[120:127], v3
  v_smfmac_f32_16x16x64_bf16 v[48:51], v[12:15], a[176:183], v3
  v_smfmac_f32_16x16x64_bf16 v[52:55], v[12:15], a[232:239], v3
  v_smfmac_f32_16x16x64_bf16 v[56:59], v[12:15], v[208:215], v3
  s_waitcnt lgkmcnt(0)
  v_smfmac_f32_16x16x64_bf16 v[60:63], v[12:15], v[72:79], v3
  ds_read_b128 v[144:147], v0 offset:4096
  ds_read_b128 v[148:151], v0 offset:5120
  v_smfmac_f32_16x16x64_bf16 v[36:39], v[16:19], a[16:23], v3
  v_smfmac_f32_16x16x64_bf16 v[40:43], v[16:19], a[72:79], v3
  v_smfmac_f32_16x16x64_bf16 v[44:47], v[16:19], a[128:135], v3
  v_smfmac_f32_16x16x64_bf16 v[48:51], v[16:19], a[184:191], v3
  v_smfmac_f32_16x16x64_bf16 v[52:55], v[16:19], a[240:247], v3
  v_smfmac_f32_16x16x64_bf16 v[56:59], v[16:19], v[216:223], v3
  s_waitcnt lgkmcnt(0)
  v_smfmac_f32_16x16x64_bf16 v[60:63], v[16:19], v[144:151], v3
  ds_read_b128 v[64:67], v0 offset:6144
  ds_read_b128 v[68:71], v0 offset:7168
  v_smfmac_f32_16x16x64_bf16 v[36:39], v[20:23], a[24:31], v3
  v_smfmac_f32_16x16x64_bf16 v[40:43], v[20:23], a[80:87], v3
  v_smfmac_f32_16x16x64_bf16 v[44:47], v[20:23], a[136:143], v3
  v_smfmac_f32_16x16x64_bf16 v[48:51], v[20:23], a[192:199], v3
  v_smfmac_f32_16x16x64_bf16 v[52:55], v[20:23], a[248:255], v3
  v_smfmac_f32_16x16x64_bf16 v[56:59], v[20:23], v[224:231], v3
  s_waitcnt lgkmcnt(0)
  v_smfmac_f32_16x16x64_bf16 v[60:63], v[20:23], v[64:71], v3
  ds_read_b128 v[72:75], v0 offset:8192
  ds_read_b128 v[76:79], v0 offset:9216
  v_smfmac_f32_16x16x64_bf16 v[36:39], v[24:27], a[32:39], v3
  v_smfmac_f32_16x16x64_bf16 v[40:43], v[24:27], a[88:95], v3
  v_smfmac_f32_16x16x64_bf16 v[44:47], v[24:27], a[144:151], v3
  v_smfmac_f32_16x16x64_bf16 v[48:51], v[24:27], a[200:207], v3
  v_smfmac_f32_16x16x64_bf16 v[52:55], v[24:27], v[176:183], v3
  v_smfmac_f32_16x16x64_bf16 v[56:59], v[24:27], v[232:239], v3
  s_waitcnt lgkmcnt(0)
  v_smfmac_f32_16x16x64_bf16 v[60:63], v[24:27], v[72:79], v3
  ds_read_b128 v[144:147], v0 offset:10240
  ds_read_b128 v[148:151], v0 offset:11264
  v_smfmac_f32_16x16x64_bf16 v[36:39], v[28:31], a[40:47], v3
  v_smfmac_f32_16x16x64_bf16 v[40:43], v[28:31], a[96:103], v3
  v_smfmac_f32_16x16x64_bf16 v[44:47], v[28:31], a[152:159], v3
  v_smfmac_f32_16x16x64_bf16 v[48:51], v[28:31], a[208:215], v3
  v_smfmac_f32_16x16x64_bf16 v[52:55], v[28:31], v[184:191], v3
  v_smfmac_f32_16x16x64_bf16 v[56:59], v[28:31], v[240:247], v3
  s_waitcnt lgkmcnt(0)
  v_smfmac_f32_16x16x64_bf16 v[60:63], v[28:31], v[144:151], v3
  ds_read_b128 v[64:67], v0 offset:12288
  ds_read_b128 v[68:71], v0 offset:13312
  v_smfmac_f32_16x16x64_bf16 v[36:39], v[32:35], a[48:55], v3
  v_smfmac_f32_16x16x64_bf16 v[40:43], v[32:35], a[104:111], v3
  v_smfmac_f32_16x16x64_bf16 v[44:47], v[32:35], a[160:167], v3
  v_smfmac_f32_16x16x64_bf16 v[48:51], v[32:35], a[216:223], v3
  v_smfmac_f32_16x16x64_bf16 v[52:55], v[32:35], v[192:199], v3
  v_smfmac_f32_16x16x64_bf16 v[56:59], v[32:35], v[248:255], v3
  s_waitcnt lgkmcnt(0)
  v_smfmac_f32_16x16x64_bf16 v[60:63], v[32:35], v[64:71], v3
  v_permlane32_swap_b32 v36, v38
  v_permlane32_swap_b32 v37, v39
  v_add_f32 v36, v36, v38
  v_add_f32 v37, v37, v39
  v_cvt_pk_bf16_f32 v38, v36, v37
  ds_write_b32 v152, v38
  v_permlane32_swap_b32 v40, v42
  v_permlane32_swap_b32 v41, v43
  v_add_f32 v40, v40, v42
  v_add_f32 v41, v41, v43
  v_cvt_pk_bf16_f32 v42, v40, v41
  ds_write_b32 v153, v42
  v_permlane32_swap_b32 v44, v46
  v_permlane32_swap_b32 v45, v47
  v_add_f32 v44, v44, v46
  v_add_f32 v45, v45, v47
  v_cvt_pk_bf16_f32 v46, v44, v45
  ds_write_b32 v154, v46
  v_permlane32_swap_b32 v48, v50
  v_permlane32_swap_b32 v49, v51
  v_add_f32 v48, v48, v50
  v_add_f32 v49, v49, v51
  v_cvt_pk_bf16_f32 v50, v48, v49
  ds_write_b32 v155, v50
  v_permlane32_swap_b32 v52, v54
  v_permlane32_swap_b32 v53, v55
  v_add_f32 v52, v52, v54
  v_add_f32 v53, v53, v55
  v_cvt_pk_bf16_f32 v54, v52, v53
  ds_write_b32 v156, v54
  v_permlane32_swap_b32 v56, v58
  v_permlane32_swap_b32 v57, v59
  v_add_f32 v56, v56, v58
  v_add_f32 v57, v57, v59
  v_cvt_pk_bf16_f32 v58, v56, v57
  ds_write_b32 v157, v58
  v_permlane32_swap_b32 v60, v62
  v_permlane32_swap_b32 v61, v63
  v_add_f32 v60, v60, v62
  v_add_f32 v61, v61, v63
  v_cvt_pk_bf16_f32 v62, v60, v61
  ds_write_b32 v158, v62
  s_branch cA_va1_t2d
cA_va1_last:
  s_barrier
  ds_read_b128 v[64:67], v2 offset:4096
  ds_read_b128 v[68:71], v2 offset:5120
  ds_read_b128 v[72:75], v2 offset:6144
  ds_read_b128 v[76:79], v2 offset:7168
  s_waitcnt lgkmcnt(0)
  v_min_u32 v64, -2, v64
  v_min_u32 v65, -2, v65
  v_min_u32 v66, -2, v66
  v_min_u32 v67, -2, v67
  v_min_u32 v68, -2, v68
  v_min_u32 v69, -2, v69
  v_min_u32 v70, -2, v70
  v_min_u32 v71, -2, v71
  v_min_u32 v72, -2, v72
  v_min_u32 v73, -2, v73
  v_min_u32 v74, -2, v74
  v_min_u32 v75, -2, v75
  v_min_u32 v76, -2, v76
  v_min_u32 v77, -2, v77
  v_min_u32 v78, -2, v78
  v_min_u32 v79, -2, v79
  buffer_store_dwordx4 v[64:67], v2, s[8:11], s33 offen offset:0 sc1
  buffer_store_dwordx4 v[68:71], v2, s[8:11], s33 offen offset:2048 sc1
  s_add_u32 s33, s33, 4096
  buffer_store_dwordx4 v[72:75], v2, s[8:11], s33 offen offset:0 sc1
  buffer_store_dwordx4 v[76:79], v2, s[8:11], s33 offen offset:2048 sc1
  s_add_u32 s33, s33, 4096
  s_branch cA_done
cA_va1_rp:
  s_cmp_eq_u32 s37, 0
  s_cbranch_scc1 cA_va1_rv
  v_min_u32 v160, -2, v160
  buffer_store_dword v160, v1, s[8:11], s21 offen
  s_branch cA_va1_cont
cA_va1_rv:
  s_add_u32 s31, s31, 0x10000
  buffer_load_dwordx4 v[8:11], v2, s[8:11], s72 offen offset:0 sc1
  buffer_load_dwordx4 v[12:15], v2, s[8:11], s72 offen offset:1024 sc1
  buffer_load_dwordx4 v[16:19], v2, s[8:11], s73 offen offset:0 sc1
  buffer_load_dwordx4 v[20:23], v2, s[8:11], s73 offen offset:1024 sc1
  buffer_load_dwordx4 v[24:27], v2, s[8:11], s74 offen offset:0 sc1
  buffer_load_dwordx4 v[28:31], v2, s[8:11], s74 offen offset:1024 sc1
  buffer_load_dwordx4 v[32:35], v2, s[8:11], s75 offen offset:0 sc1
  buffer_load_dwordx4 v[36:39], v2, s[8:11], s75 offen offset:1024 sc1
  buffer_load_dwordx4 v[40:43], v2, s[8:11], s36 offen offset:0 sc1
  buffer_load_dwordx4 v[44:47], v2, s[8:11], s36 offen offset:1024 sc1
  s_waitcnt vmcnt(0)
  v_max3_u32 v52, v8, v9, v10
  v_max3_u32 v52, v52, v11, v12
  v_max3_u32 v52, v52, v13, v14
  v_max3_u32 v52, v52, v15, v16
  v_max3_u32 v52, v52, v17, v18
  v_max3_u32 v52, v52, v19, v20
  v_max3_u32 v52, v52, v21, v22
  v_max3_u32 v52, v52, v23, v24
  v_max3_u32 v52, v52, v25, v26
  v_max3_u32 v52, v52, v27, v28
  v_max3_u32 v52, v52, v29, v30
  v_max3_u32 v52, v52, v31, v32
  v_max3_u32 v52, v52, v33, v34
  v_max3_u32 v52, v52, v35, v36
  v_max3_u32 v52, v52, v37, v38
  v_max3_u32 v52, v52, v39, v40
  v_max3_u32 v52, v52, v41, v42
  v_max3_u32 v52, v52, v43, v44
  v_max3_u32 v52, v52, v45, v46
  v_max_u32 v52, v52, v47
  v_cmp_eq_u32 vcc, -1, v52
  s_mov_b32 s37, 1
  v_mov_b32 v48, 0
  v_mov_b32 v49, 0
  v_mov_b32 v50, 0
  v_mov_b32 v51, 0
  s_nop 1
  s_cbranch_vccz cA_va1_lp
  s_add_u32 s30, s30, 1
  s_cmp_lt_u32 s30, 400000
  s_cbranch_scc1 cA_va1_rv
  s_branch cA_abort
.p2align 6
cA_va2_loop:
  s_mov_b32 s30, 0
cA_va2_fp_l:
  v_cmp_gt_u32 vcc, s19, v96
  buffer_load_dword v96, v119, s[8:11], 0 offen sc1
  s_cbranch_vccz cA_va2_fp_d
  v_cmp_gt_u32 vcc, s19, v96
  buffer_load_dword v96, v119, s[8:11], 0 offen sc1
  s_cbranch_vccz cA_va2_fp_d
  v_cmp_gt_u32 vcc, s19, v96
  buffer_load_dword v96, v119, s[8:11], 0 offen sc1
  s_cbranch_vccz cA_va2_fp_d
  v_cmp_gt_u32 vcc, s19, v96
  buffer_load_dword v96, v119, s[8:11], 0 offen sc1
  s_cbranch_vccz cA_va2_fp_d
  v_cmp_gt_u32 vcc, s19, v96
  buffer_load_dword v96, v119, s[8:11], 0 offen sc1
  s_cbranch_vccz cA_va2_fp_d
  v_cmp_gt_u32 vcc, s19, v96
  buffer_load_dword v96, v119, s[8:11], 0 offen sc1
  s_cbranch_vccz cA_va2_fp_d
  v_cmp_gt_u32 vcc, s19, v96
  buffer_load_dword v96, v119, s[8:11], 0 offen sc1
  s_cbranch_vccz cA_va2_fp_d
  v_cmp_gt_u32 vcc, s19, v96
  buffer_load_dword v96, v119, s[8:11], 0 offen sc1
  s_cbranch_vccz cA_va2_fp_d
  v_cmp_gt_u32 vcc, s19, v96
  buffer_load_dword v96, v119, s[8:11], 0 offen sc1
  s_cbranch_vccz cA_va2_fp_d
  v_cmp_gt_u32 vcc, s19, v96
  buffer_load_dword v96, v119, s[8:11], 0 offen sc1
  s_cbranch_vccz cA_va2_fp_d
  v_cmp_gt_u32 vcc, s19, v96
  buffer_load_dword v96, v119, s[8:11], 0 offen sc1
  s_cbranch_vccz cA_va2_fp_d
  v_cmp_gt_u32 vcc, s19, v96
  buffer_load_dword v96, v119, s[8:11], 0 offen sc1
  s_cbranch_vccz cA_va2_fp_d
  v_cmp_gt_u32 vcc, s19, v96
  buffer_load_dword v96, v119, s[8:11], 0 offen sc1
  s_cbranch_vccz cA_va2_fp_d
  v_cmp_gt_u32 vcc, s19, v96
  buffer_load_dword v96, v119, s[8:11], 0 offen sc1
  s_cbranch_vccz cA_va2_fp_d
  v_cmp_gt_u32 vcc, s19, v96
  buffer_load_dword v96, v119, s[8:11], 0 offen sc1
  s_cbranch_vccz cA_va2_fp_d
  v_cmp_gt_u32 vcc, s19, v96
  buffer_load_dword v96, v119, s[8:11], 0 offen sc1
  s_cbranch_vccz cA_va2_fp_d
  s_waitcnt vmcnt(24)
  s_add_u32 s30, s30, 1
  s_cmp_lt_u32 s30, 400000
  s_cbranch_scc1 cA_va2_fp_l
  s_branch cA_abort
cA_va2_fp_d:
  buffer_load_dwordx4 v[8:11], v2, s[8:11], s20 offen offset:0 sc1
  buffer_load_dwordx4 v[12:15], v2, s[8:11], s20 offen offset:1024 sc1
  s_barrier
  s_barrier
  s_waitcnt vmcnt(0)
  ds_write_b128 v2, v[8:11] offset:8192
  ds_write_b128 v2, v[12:15] offset:9216
  v_smfmac_f32_16x16x64_bf16 v[36:39], v[8:11], a[0:7], v3
  v_smfmac_f32_16x16x64_bf16 v[40:43], v[8:11], a[56:63], v3
  v_smfmac_f32_16x16x64_bf16 v[44:47], v[8:11], a[112:119], v3
  v_smfmac_f32_16x16x64_bf16 v[48:51], v[8:11], a[168:175], v3
  v_smfmac_f32_16x16x64_bf16 v[52:55], v[8:11], a[224:231], v3
  s_waitcnt lgkmcnt(0)
  s_barrier
  ds_read_b128 v[16:19], v2 offset:10240
  ds_read_b128 v[20:23], v2 offset:11264
  ds_read_b128 v[24:27], v2 offset:12288
  ds_read_b128 v[28:31], v2 offset:13312
  ds_read_b128 v[32:35], v2 offset:14336
  v_smfmac_f32_16x16x64_bf16 v[56:59], v[8:11], v[144:151], v3
  v_smfmac_f32_16x16x64_bf16 v[60:63], v[8:11], v[200:207], v3
  v_smfmac_f32_16x16x64_bf16 v[36:39], v[12:15], a[8:15], v3
  v_smfmac_f32_16x16x64_bf16 v[40:43], v[12:15], a[64:71], v3
  v_smfmac_f32_16x16x64_bf16 v[44:47], v[12:15], a[120:127], v3
  v_smfmac_f32_16x16x64_bf16 v[48:51], v[12:15], a[176:183], v3
  v_smfmac_f32_16x16x64_bf16 v[52:55], v[12:15], a[232:239], v3
  v_smfmac_f32_16x16x64_bf16 v[56:59], v[12:15], v[152:159], v3
  ds_read_b128 v[68:71], v0 offset:0
  ds_read_b128 v[72:75], v0 offset:1024
  v_smfmac_f32_16x16x64_bf16 v[60:63], v[12:15], v[208:215], v3
  s_waitcnt lgkmcnt(6)
  ds_read_b128 v[76:79], v0 offset:2048
  ds_read_b128 v[80:83], v0 offset:3072
  v_smfmac_f32_16x16x64_bf16 v[36:39], v[16:19], a[16:23], v3
  s_waitcnt lgkmcnt(7)
  v_smfmac_f32_16x16x64_bf16 v[36:39], v[20:23], a[24:31], v3
  s_waitcnt lgkmcnt(6)
  v_smfmac_f32_16x16x64_bf16 v[36:39], v[24:27], a[32:39], v3
  s_waitcnt lgkmcnt(2)
  v_smfmac_f32_16x16x64_bf16 v[64:67], v[8:11], v[68:75], v3
  s_waitcnt lgkmcnt(5)
  ds_read_b128 v[84:87], v0 offset:4096
  ds_read_b128 v[88:91], v0 offset:5120
  v_smfmac_f32_16x16x64_bf16 v[36:39], v[28:31], a[40:47], v3
  s_waitcnt lgkmcnt(6)
  v_smfmac_f32_16x16x64_bf16 v[36:39], v[32:35], a[48:55], v3
  v_smfmac_f32_16x16x64_bf16 v[40:43], v[16:19], a[72:79], v3
  s_waitcnt lgkmcnt(2)
  v_smfmac_f32_16x16x64_bf16 v[64:67], v[12:15], v[76:83], v3
  ds_read_b128 v[68:71], v0 offset:6144
  ds_read_b128 v[72:75], v0 offset:7168
  v_smfmac_f32_16x16x64_bf16 v[40:43], v[20:23], a[80:87], v3
  v_permlane32_swap_b32 v36, v38
  v_smfmac_f32_16x16x64_bf16 v[40:43], v[24:27], a[88:95], v3
  v_permlane32_swap_b32 v37, v39
  v_smfmac_f32_16x16x64_bf16 v[40:43], v[28:31], a[96:103], v3
  s_waitcnt lgkmcnt(2)
  v_add_f32 v36, v36, v38
  v_smfmac_f32_16x16x64_bf16 v[64:67], v[16:19], v[84:91], v3
  ds_read_b128 v[76:79], v0 offset:8192
  ds_read_b128 v[80:83], v0 offset:9216
  v_add_f32 v37, v37, v39
  v_smfmac_f32_16x16x64_bf16 v[40:43], v[32:35], a[104:111], v3
  v_cmp_u_f32 vcc, v36, v37
  v_smfmac_f32_16x16x64_bf16 v[44:47], v[16:19], a[128:135], v3
  v_cvt_pk_bf16_f32 v38, v36, v37
  v_smfmac_f32_16x16x64_bf16 v[44:47], v[20:23], a[136:143], v3
  ds_write_b32 v104, v38
  s_waitcnt lgkmcnt(3)
  s_cbranch_vccnz cA_va2_slow
  v_permlane32_swap_b32 v40, v42
  v_smfmac_f32_16x16x64_bf16 v[64:67], v[20:23], v[68:75], v3
  ds_read_b128 v[84:87], v0 offset:10240
  ds_read_b128 v[88:91], v0 offset:11264
  v_permlane32_swap_b32 v41, v43
  v_smfmac_f32_16x16x64_bf16 v[44:47], v[24:27], a[144:151], v3
  v_add_f32 v40, v40, v42
  v_smfmac_f32_16x16x64_bf16 v[44:47], v[28:31], a[152:159], v3
  v_add_f32 v41, v41, v43
  v_smfmac_f32_16x16x64_bf16 v[44:47], v[32:35], a[160:167], v3
  s_waitcnt lgkmcnt(3)
  v_cvt_pk_bf16_f32 v42, v40, v41
  v_smfmac_f32_16x16x64_bf16 v[64:67], v[24:27], v[76:83], v3
  ds_write_b32 v105, v42
  ds_read_b128 v[68:71], v0 offset:12288
  ds_read_b128 v[72:75], v0 offset:13312
  v_smfmac_f32_16x16x64_bf16 v[48:51], v[16:19], a[184:191], v3
  s_nop 0
  v_permlane32_swap_b32 v44, v46
  v_smfmac_f32_16x16x64_bf16 v[48:51], v[20:23], a[192:199], v3
  v_permlane32_swap_b32 v45, v47
  v_smfmac_f32_16x16x64_bf16 v[48:51], v[24:27], a[200:207], v3
  s_waitcnt lgkmcnt(3)
  v_add_f32 v44, v44, v46
  v_smfmac_f32_16x16x64_bf16 v[64:67], v[28:31], v[84:91], v3
  v_add_f32 v45, v45, v47
  v_smfmac_f32_16x16x64_bf16 v[48:51], v[28:31], a[208:215], v3
  v_cvt_pk_bf16_f32 v46, v44, v45
  v_smfmac_f32_16x16x64_bf16 v[48:51], v[32:35], a[216:223], v3
  ds_write_b32 v106, v46
  v_smfmac_f32_16x16x64_bf16 v[52:55], v[16:19], a[240:247], v3
  s_waitcnt lgkmcnt(1)
  v_smfmac_f32_16x16x64_bf16 v[64:67], v[32:35], v[68:75], v3
  v_smfmac_f32_16x16x64_bf16 v[52:55], v[20:23], a[248:255], v3
  v_permlane32_swap_b32 v48, v50
  v_smfmac_f32_16x16x64_bf16 v[52:55], v[24:27], v[120:127], v3
  v_permlane32_swap_b32 v49, v51
  v_smfmac_f32_16x16x64_bf16 v[52:55], v[28:31], v[128:135], v3
  v_add_f32 v48, v48, v50
  v_smfmac_f32_16x16x64_bf16 v[52:55], v[32:35], v[136:143], v3
  v_add_f32 v49, v49, v51
  v_smfmac_f32_16x16x64_bf16 v[56:59], v[16:19], v[160:167], v3
  v_cvt_pk_bf16_f32 v50, v48, v49
  v_smfmac_f32_16x16x64_bf16 v[56:59], v[20:23], v[168:175], v3
  ds_write_b32 v107, v50
  v_permlane32_swap_b32 v64, v66
  v_smfmac_f32_16x16x64_bf16 v[56:59], v[24:27], v[176:183], v3
  v_permlane32_swap_b32 v65, v67
  v_smfmac_f32_16x16x64_bf16 v[56:59], v[28:31], v[184:191], v3
  v_add_f32 v64, v64, v66
  v_smfmac_f32_16x16x64_bf16 v[56:59], v[32:35], v[192:199], v3
  v_add_f32 v65, v65, v67
  v_smfmac_f32_16x16x64_bf16 v[60:63], v[16:19], v[216:223], v3
  v_cvt_pk_bf16_f32 v66, v64, v65
  v_smfmac_f32_16x16x64_bf16 v[60:63], v[20:23], v[224:231], v3
  ds_write_b32 v111, v66
  v_permlane32_swap_b32 v52, v54
  v_smfmac_f32_16x16x64_bf16 v[60:63], v[24:27], v[232:239], v3
  v_permlane32_swap_b32 v53, v55
  v_smfmac_f32_16x16x64_bf16 v[60:63], v[28:31], v[240:247], v3
  v_add_f32 v52, v52, v54
  v_smfmac_f32_16x16x64_bf16 v[60:63], v[32:35], v[248:255], v3
  v_add_f32 v53, v53, v55
  v_cvt_pk_bf16_f32 v54, v52, v53
  ds_write_b32 v108, v54
  v_permlane32_swap_b32 v56, v58
  v_permlane32_swap_b32 v57, v59
  v_add_f32 v56, v56, v58
  v_add_f32 v57, v57, v59
  v_cvt_pk_bf16_f32 v58, v56, v57
  ds_write_b32 v109, v58
  v_permlane32_swap_b32 v60, v62
  v_permlane32_swap_b32 v61, v63
  v_add_f32 v60, v60, v62
  v_add_f32 v61, v61, v63
  v_cvt_pk_bf16_f32 v62, v60, v61
  ds_write_b32 v110, v62
cA_va2_t2d:
  v_mov_b32 v117, s18
  s_waitcnt lgkmcnt(0)
  s_barrier
  s_cmp_eq_u32 s19, 63
  s_cbranch_scc1 cA_done
  s_sleep 1
  v_mov_b32 v36, 0
  v_mov_b32 v37, 0
  v_mov_b32 v38, 0
  v_mov_b32 v39, 0
  v_mov_b32 v40, 0
  v_mov_b32 v41, 0
  v_mov_b32 v42, 0
  v_mov_b32 v43, 0
  v_mov_b32 v44, 0
  v_mov_b32 v45, 0
  v_mov_b32 v46, 0
  v_mov_b32 v47, 0
  v_mov_b32 v48, 0
  v_mov_b32 v49, 0
  v_mov_b32 v50, 0
  v_mov_b32 v51, 0
  v_mov_b32 v52, 0
  v_mov_b32 v53, 0
  v_mov_b32 v54, 0
  v_mov_b32 v55, 0
  v_mov_b32 v56, 0
  v_mov_b32 v57, 0
  v_mov_b32 v58, 0
  v_mov_b32 v59, 0
  v_mov_b32 v60, 0
  v_mov_b32 v61, 0
  v_mov_b32 v62, 0
  v_mov_b32 v63, 0
  v_mov_b32 v64, 0
  v_mov_b32 v65, 0
  v_mov_b32 v66, 0
  v_mov_b32 v67, 0
  s_sleep 5
  s_mov_b32 s19, s18
  s_add_u32 s18, s18, 1
  s_mov_b32 s22, s20
  s_mov_b32 s20, s21
  s_mov_b32 s21, s22
  s_add_u32 s23, s20, 4096
  s_branch cA_va2_loop
cA_va2_slow:
  s_waitcnt lgkmcnt(0)
cA_va2_sl1:
  s_add_u32 s31, s31, 0x1000000
  buffer_load_dwordx4 v[8:11], v2, s[8:11], s20 offen offset:0 sc1
  buffer_load_dwordx4 v[12:15], v2, s[8:11], s20 offen offset:1024 sc1
  buffer_load_dwordx4 v[16:19], v2, s[8:11], s20 offen offset:2048 sc1
  buffer_load_dwordx4 v[20:23], v2, s[8:11], s20 offen offset:3072 sc1
  buffer_load_dwordx4 v[24:27], v2, s[8:11], s23 offen offset:0 sc1
  buffer_load_dwordx4 v[28:31], v2, s[8:11], s23 offen offset:1024 sc1
  buffer_load_dwordx4 v[32:35], v2, s[8:11], s23 offen offset:2048 sc1
  s_waitcnt vmcnt(0)
  v_max3_u32 v36, v8, v9, v10
  v_max3_u32 v36, v36, v11, v12
  v_max3_u32 v36, v36, v13, v14
  v_max3_u32 v36, v36, v15, v16
  v_max3_u32 v36, v36, v17, v18
  v_max3_u32 v36, v36, v19, v20
  v_max3_u32 v36, v36, v21, v22
  v_max3_u32 v36, v36, v23, v24
  v_max3_u32 v36, v36, v25, v26
  v_max3_u32 v36, v36, v27, v28
  v_max3_u32 v36, v36, v29, v30
  v_max3_u32 v36, v36, v31, v32
  v_max3_u32 v36, v36, v33, v34
  v_max_u32 v36, v36, v35
  v_cmp_eq_u32 vcc, -1, v36
  s_cbranch_vccz cA_va2_sl2
  s_add_u32 s30, s30, 1
  s_cmp_lt_u32 s30, 400000
  s_cbranch_scc1 cA_va2_sl1
  s_branch cA_abort
cA_va2_sl2:
  v_mov_b32 v36, 0
  v_mov_b32 v37, 0
  v_mov_b32 v38, 0
  v_mov_b32 v39, 0
  v_mov_b32 v40, 0
  v_mov_b32 v41, 0
  v_mov_b32 v42, 0
  v_mov_b32 v43, 0
  v_mov_b32 v44, 0
  v_mov_b32 v45, 0
  v_mov_b32 v46, 0
  v_mov_b32 v47, 0
  v_mov_b32 v48, 0
  v_mov_b32 v49, 0
  v_mov_b32 v50, 0
  v_mov_b32 v51, 0
  v_mov_b32 v52, 0
  v_mov_b32 v53, 0
  v_mov_b32 v54, 0
  v_mov_b32 v55, 0
  v_mov_b32 v56, 0
  v_mov_b32 v57, 0
  v_mov_b32 v58, 0
  v_mov_b32 v59, 0
  v_mov_b32 v60, 0
  v_mov_b32 v61, 0
  v_mov_b32 v62, 0
  v_mov_b32 v63, 0
  v_mov_b32 v64, 0
  v_mov_b32 v65, 0
  v_mov_b32 v66, 0
  v_mov_b32 v67, 0
  ds_read_b128 v[68:71], v0 offset:0
  ds_read_b128 v[72:75], v0 offset:1024
  v_smfmac_f32_16x16x64_bf16 v[36:39], v[8:11], a[0:7], v3
  v_smfmac_f32_16x16x64_bf16 v[40:43], v[8:11], a[56:63], v3
  v_smfmac_f32_16x16x64_bf16 v[44:47], v[8:11], a[112:119], v3
  v_smfmac_f32_16x16x64_bf16 v[48:51], v[8:11], a[168:175], v3
  v_smfmac_f32_16x16x64_bf16 v[52:55], v[8:11], a[224:231], v3
  v_smfmac_f32_16x16x64_bf16 v[56:59], v[8:11], v[144:151], v3
  v_smfmac_f32_16x16x64_bf16 v[60:63], v[8:11], v[200:207], v3
  s_waitcnt lgkmcnt(0)
  v_smfmac_f32_16x16x64_bf16 v[64:67], v[8:11], v[68:75], v3
  ds_read_b128 v[76:79], v0 offset:2048
  ds_read_b128 v[80:83], v0 offset:3072
  v_smfmac_f32_16x16x64_bf16 v[36:39], v[12:15], a[8:15], v3
  v_smfmac_f32_16x16x64_bf16 v[40:43], v[12:15], a[64:71], v3
  v_smfmac_f32_16x16x64_bf16 v[44:47], v[12:15], a[120:127], v3
  v_smfmac_f32_16x16x64_bf16 v[48:51], v[12:15], a[176:183], v3
  v_smfmac_f32_16x16x64_bf16 v[52:55], v[12:15], a[232:239], v3
  v_smfmac_f32_16x16x64_bf16 v[56:59], v[12:15], v[152:159], v3
  v_smfmac_f32_16x16x64_bf16 v[60:63], v[12:15], v[208:215], v3
  s_waitcnt lgkmcnt(0)
  v_smfmac_f32_16x16x64_bf16 v[64:67], v[12:15], v[76:83], v3
  ds_read_b128 v[84:87], v0 offset:4096
  ds_read_b128 v[88:91], v0 offset:5120
  v_smfmac_f32_16x16x64_bf16 v[36:39], v[16:19], a[16:23], v3
  v_smfmac_f32_16x16x64_bf16 v[40:43], v[16:19], a[72:79], v3
  v_smfmac_f32_16x16x64_bf16 v[44:47], v[16:19], a[128:135], v3
  v_smfmac_f32_16x16x64_bf16 v[48:51], v[16:19], a[184:191], v3
  v_smfmac_f32_16x16x64_bf16 v[52:55], v[16:19], a[240:247], v3
  v_smfmac_f32_16x16x64_bf16 v[56:59], v[16:19], v[160:167], v3
  v_smfmac_f32_16x16x64_bf16 v[60:63], v[16:19], v[216:223], v3
  s_waitcnt lgkmcnt(0)
  v_smfmac_f32_16x16x64_bf16 v[64:67], v[16:19], v[84:91], v3
  ds_read_b128 v[68:71], v0 offset:6144
  ds_read_b128 v[72:75], v0 offset:7168
  v_smfmac_f32_16x16x64_bf16 v[36:39], v[20:23], a[24:31], v3
  v_smfmac_f32_16x16x64_bf16 v[40:43], v[20:23], a[80:87], v3
  v_smfmac_f32_16x16x64_bf16 v[44:47], v[20:23], a[136:143], v3
  v_smfmac_f32_16x16x64_bf16 v[48:51], v[20:23], a[192:199], v3
  v_smfmac_f32_16x16x64_bf16 v[52:55], v[20:23], a[248:255], v3
  v_smfmac_f32_16x16x64_bf16 v[56:59], v[20:23], v[168:175], v3
  v_smfmac_f32_16x16x64_bf16 v[60:63], v[20:23], v[224:231], v3
  s_waitcnt lgkmcnt(0)
  v_smfmac_f32_16x16x64_bf16 v[64:67], v[20:23], v[68:75], v3
  ds_read_b128 v[76:79], v0 offset:8192
  ds_read_b128 v[80:83], v0 offset:9216
  v_smfmac_f32_16x16x64_bf16 v[36:39], v[24:27], a[32:39], v3
  v_smfmac_f32_16x16x64_bf16 v[40:43], v[24:27], a[88:95], v3
  v_smfmac_f32_16x16x64_bf16 v[44:47], v[24:27], a[144:151], v3
  v_smfmac_f32_16x16x64_bf16 v[48:51], v[24:27], a[200:207], v3
  v_smfmac_f32_16x16x64_bf16 v[52:55], v[24:27], v[120:127], v3
  v_smfmac_f32_16x16x64_bf16 v[56:59], v[24:27], v[176:183], v3
  v_smfmac_f32_16x16x64_bf16 v[60:63], v[24:27], v[232:239], v3
  s_waitcnt lgkmcnt(0)
  v_smfmac_f32_16x16x64_bf16 v[64:67], v[24:27], v[76:83], v3
  ds_read_b128 v[84:87], v0 offset:10240
  ds_read_b128 v[88:91], v0 offset:11264
  v_smfmac_f32_16x16x64_bf16 v[36:39], v[28:31], a[40:47], v3
  v_smfmac_f32_16x16x64_bf16 v[40:43], v[28:31], a[96:103], v3
  v_smfmac_f32_16x16x64_bf16 v[44:47], v[28:31], a[152:159], v3
  v_smfmac_f32_16x16x64_bf16 v[48:51], v[28:31], a[208:215], v3
  v_smfmac_f32_16x16x64_bf16 v[52:55], v[28:31], v[128:135], v3
  v_smfmac_f32_16x16x64_bf16 v[56:59], v[28:31], v[184:191], v3
  v_smfmac_f32_16x16x64_bf16 v[60:63], v[28:31], v[240:247], v3
  s_waitcnt lgkmcnt(0)
  v_smfmac_f32_16x16x64_bf16 v[64:67], v[28:31], v[84:91], v3
  ds_read_b128 v[68:71], v0 offset:12288
  ds_read_b128 v[72:75], v0 offset:13312
  v_smfmac_f32_16x16x64_bf16 v[36:39], v[32:35], a[48:55], v3
  v_smfmac_f32_16x16x64_bf16 v[40:43], v[32:35], a[104:111], v3
  v_smfmac_f32_16x16x64_bf16 v[44:47], v[32:35], a[160:167], v3
  v_smfmac_f32_16x16x64_bf16 v[48:51], v[32:35], a[216:223], v3
  v_smfmac_f32_16x16x64_bf16 v[52:55], v[32:35], v[136:143], v3
  v_smfmac_f32_16x16x64_bf16 v[56:59], v[32:35], v[192:199], v3
  v_smfmac_f32_16x16x64_bf16 v[60:63], v[32:35], v[248:255], v3
  s_waitcnt lgkmcnt(0)
  v_smfmac_f32_16x16x64_bf16 v[64:67], v[32:35], v[68:75], v3
  v_permlane32_swap_b32 v36, v38
  v_permlane32_swap_b32 v37, v39
  v_add_f32 v36, v36, v38
  v_add_f32 v37, v37, v39
  v_cvt_pk_bf16_f32 v38, v36, v37
  ds_write_b32 v104, v38
  v_permlane32_swap_b32 v40, v42
  v_permlane32_swap_b32 v41, v43
  v_add_f32 v40, v40, v42
  v_add_f32 v41, v41, v43
  v_cvt_pk_bf16_f32 v42, v40, v41
  ds_write_b32 v105, v42
  v_permlane32_swap_b32 v44, v46
  v_permlane32_swap_b32 v45, v47
  v_add_f32 v44, v44, v46
  v_add_f32 v45, v45, v47
  v_cvt_pk_bf16_f32 v46, v44, v45
  ds_write_b32 v106, v46
  v_permlane32_swap_b32 v48, v50
  v_permlane32_swap_b32 v49, v51
  v_add_f32 v48, v48, v50
  v_add_f32 v49, v49, v51
  v_cvt_pk_bf16_f32 v50, v48, v49
  ds_write_b32 v107, v50
  v_permlane32_swap_b32 v52, v54
  v_permlane32_swap_b32 v53, v55
  v_add_f32 v52, v52, v54
  v_add_f32 v53, v53, v55
  v_cvt_pk_bf16_f32 v54, v52, v53
  ds_write_b32 v108, v54
  v_permlane32_swap_b32 v56, v58
  v_permlane32_swap_b32 v57, v59
  v_add_f32 v56, v56, v58
  v_add_f32 v57, v57, v59
  v_cvt_pk_bf16_f32 v58, v56, v57
  ds_write_b32 v109, v58
  v_permlane32_swap_b32 v60, v62
  v_permlane32_swap_b32 v61, v63
  v_add_f32 v60, v60, v62
  v_add_f32 v61, v61, v63
  v_cvt_pk_bf16_f32 v62, v60, v61
  ds_write_b32 v110, v62
  v_permlane32_swap_b32 v64, v66
  v_permlane32_swap_b32 v65, v67
  v_add_f32 v64, v64, v66
  v_add_f32 v65, v65, v67
  v_cvt_pk_bf16_f32 v66, v64, v65
  ds_write_b32 v111, v66
  s_branch cA_va2_t2d
.p2align 6
cA_va3_loop:
  s_mov_b32 s30, 0
  s_barrier
  buffer_load_dwordx4 v[16:19], v2, s[8:11], s20 offen offset:2048 sc1
  buffer_load_dwordx4 v[20:23], v2, s[8:11], s20 offen offset:3072 sc1
  s_barrier
  buffer_load_dword v100, v116, s[8:11], s39 offen sc1
  s_add_u32 s27, s19, 2
  s_min_u32 s27, s27, 63
  s_lshr_b32 s27, s27, 3
  s_lshl_b32 s27, s27, 11
  s_add_u32 s27, s27, s35
  s_cmp_eq_u32 s27, s28
  s_cselect_b32 s29, 35328, s27
  buffer_load_dword v101, off, s[8:11], s29 sc1
  s_add_u32 s39, s39, 28672
  s_waitcnt vmcnt(2)
  ds_write_b128 v2, v[16:19] offset:10240
  ds_write_b128 v2, v[20:23] offset:11264
  v_smfmac_f32_16x16x64_bf16 v[36:39], v[16:19], a[16:23], v3
  v_smfmac_f32_16x16x64_bf16 v[40:43], v[16:19], a[72:79], v3
  v_smfmac_f32_16x16x64_bf16 v[44:47], v[16:19], a[128:135], v3
  v_smfmac_f32_16x16x64_bf16 v[48:51], v[16:19], a[184:191], v3
  v_smfmac_f32_16x16x64_bf16 v[52:55], v[16:19], a[240:247], v3
  s_waitcnt lgkmcnt(0)
  s_barrier
  ds_read_b128 v[8:11], v2 offset:8192
  ds_read_b128 v[12:15], v2 offset:9216
  ds_read_b128 v[24:27], v2 offset:12288
  ds_read_b128 v[28:31], v2 offset:13312
  ds_read_b128 v[32:35], v2 offset:14336
  v_smfmac_f32_16x16x64_bf16 v[56:59], v[16:19], v[160:167], v3
  v_smfmac_f32_16x16x64_bf16 v[60:63], v[16:19], v[216:223], v3
  v_smfmac_f32_16x16x64_bf16 v[36:39], v[20:23], a[24:31], v3
  v_smfmac_f32_16x16x64_bf16 v[40:43], v[20:23], a[80:87], v3
  v_smfmac_f32_16x16x64_bf16 v[44:47], v[20:23], a[136:143], v3
  v_smfmac_f32_16x16x64_bf16 v[48:51], v[20:23], a[192:199], v3
  v_smfmac_f32_16x16x64_bf16 v[52:55], v[20:23], a[248:255], v3
  v_smfmac_f32_16x16x64_bf16 v[56:59], v[20:23], v[168:175], v3
  v_smfmac_f32_16x16x64_bf16 v[60:63], v[20:23], v[224:231], v3
  s_waitcnt lgkmcnt(4)
  v_smfmac_f32_16x16x64_bf16 v[36:39], v[8:11], a[0:7], v3
  s_waitcnt lgkmcnt(3)
  v_smfmac_f32_16x16x64_bf16 v[36:39], v[12:15], a[8:15], v3
  s_waitcnt lgkmcnt(2)
  v_smfmac_f32_16x16x64_bf16 v[36:39], v[24:27], a[32:39], v3
  s_waitcnt lgkmcnt(1)
  v_smfmac_f32_16x16x64_bf16 v[36:39], v[28:31], a[40:47], v3
  s_waitcnt lgkmcnt(0)
  v_smfmac_f32_16x16x64_bf16 v[36:39], v[32:35], a[48:55], v3
  v_smfmac_f32_16x16x64_bf16 v[40:43], v[8:11], a[56:63], v3
  v_smfmac_f32_16x16x64_bf16 v[40:43], v[12:15], a[64:71], v3
  v_smfmac_f32_16x16x64_bf16 v[40:43], v[24:27], a[88:95], v3
  v_permlane32_swap_b32 v36, v38
  v_smfmac_f32_16x16x64_bf16 v[40:43], v[28:31], a[96:103], v3
  v_permlane32_swap_b32 v37, v39
  v_smfmac_f32_16x16x64_bf16 v[40:43], v[32:35], a[104:111], v3
  v_add_f32 v36, v36, v38
  v_smfmac_f32_16x16x64_bf16 v[44:47], v[8:11], a[112:119], v3
  v_add_f32 v37, v37, v39
  v_smfmac_f32_16x16x64_bf16 v[44:47], v[12:15], a[120:127], v3
  v_cmp_u_f32 vcc, v36, v37
  v_smfmac_f32_16x16x64_bf16 v[44:47], v[24:27], a[144:151], v3
  v_cvt_pk_bf16_f32 v38, v36, v37
  v_smfmac_f32_16x16x64_bf16 v[44:47], v[28:31], a[152:159], v3
  ds_write_b32 v104, v38
  s_cbranch_vccnz cA_va3_slow
  v_permlane32_swap_b32 v40, v42
  v_smfmac_f32_16x16x64_bf16 v[44:47], v[32:35], a[160:167], v3
  v_permlane32_swap_b32 v41, v43
  v_smfmac_f32_16x16x64_bf16 v[48:51], v[8:11], a[168:175], v3
  v_add_f32 v40, v40, v42
  v_smfmac_f32_16x16x64_bf16 v[48:51], v[12:15], a[176:183], v3
  v_add_f32 v41, v41, v43
  v_smfmac_f32_16x16x64_bf16 v[48:51], v[24:27], a[200:207], v3
  v_cvt_pk_bf16_f32 v42, v40, v41
  v_smfmac_f32_16x16x64_bf16 v[48:51], v[28:31], a[208:215], v3
  ds_write_b32 v105, v42
  v_permlane32_swap_b32 v44, v46
  v_smfmac_f32_16x16x64_bf16 v[48:51], v[32:35], a[216:223], v3
  v_permlane32_swap_b32 v45, v47
  v_smfmac_f32_16x16x64_bf16 v[52:55], v[8:11], a[224:231], v3
  v_add_f32 v44, v44, v46
  v_smfmac_f32_16x16x64_bf16 v[52:55], v[12:15], a[232:239], v3
  v_add_f32 v45, v45, v47
  v_smfmac_f32_16x16x64_bf16 v[52:55], v[24:27], v[120:127], v3
  v_cvt_pk_bf16_f32 v46, v44, v45
  v_smfmac_f32_16x16x64_bf16 v[52:55], v[28:31], v[128:135], v3
  ds_write_b32 v106, v46
  v_permlane32_swap_b32 v48, v50
  v_smfmac_f32_16x16x64_bf16 v[52:55], v[32:35], v[136:143], v3
  v_permlane32_swap_b32 v49, v51
  v_smfmac_f32_16x16x64_bf16 v[56:59], v[8:11], v[144:151], v3
  v_add_f32 v48, v48, v50
  v_smfmac_f32_16x16x64_bf16 v[56:59], v[12:15], v[152:159], v3
  v_add_f32 v49, v49, v51
  v_smfmac_f32_16x16x64_bf16 v[56:59], v[24:27], v[176:183], v3
  v_cvt_pk_bf16_f32 v50, v48, v49
  v_smfmac_f32_16x16x64_bf16 v[56:59], v[28:31], v[184:191], v3
  ds_write_b32 v107, v50
  v_permlane32_swap_b32 v52, v54
  v_smfmac_f32_16x16x64_bf16 v[56:59], v[32:35], v[192:199], v3
  v_permlane32_swap_b32 v53, v55
  v_smfmac_f32_16x16x64_bf16 v[60:63], v[8:11], v[200:207], v3
  v_add_f32 v52, v52, v54
  v_smfmac_f32_16x16x64_bf16 v[60:63], v[12:15], v[208:215], v3
  v_add_f32 v53, v53, v55
  v_smfmac_f32_16x16x64_bf16 v[60:63], v[24:27], v[232:239], v3
  v_cvt_pk_bf16_f32 v54, v52, v53
  v_smfmac_f32_16x16x64_bf16 v[60:63], v[28:31], v[240:247], v3
  ds_write_b32 v108, v54
  v_permlane32_swap_b32 v56, v58
  v_smfmac_f32_16x16x64_bf16 v[60:63], v[32:35], v[248:255], v3
  v_permlane32_swap_b32 v57, v59
  v_add_f32 v56, v56, v58
  v_add_f32 v57, v57, v59
  v_cvt_pk_bf16_f32 v58, v56, v57
  ds_write_b32 v109, v58
  s_nop 2
  v_permlane32_swap_b32 v60, v62
  v_permlane32_swap_b32 v61, v63
  v_add_f32 v60, v60, v62
  v_add_f32 v61, v61, v63
  v_cvt_pk_bf16_f32 v62, v60, v61
  ds_write_b32 v110, v62
cA_va3_t2d:
  v_mov_b32 v117, s18
  s_cmp_eq_u32 s27, s28
  s_cbranch_scc1 cA_va3_vok
cA_va3_vow:
  s_waitcnt vmcnt(0)
  v_cmp_ne_u32 vcc, 56, v101
  s_cbranch_vccnz cA_va3_vor
  s_mov_b32 s28, s27
cA_va3_vok:
  s_waitcnt lgkmcnt(0)
  s_setprio 3
  s_barrier
  v_mov_b32 v36, 0
  v_mov_b32 v37, 0
  buffer_store_dword v117, v118, s[8:11], 0 offen
  s_setprio 0
  s_cmp_eq_u32 s19, 63
  s_cbranch_scc1 cA_done
  v_mov_b32 v38, 0
  v_mov_b32 v39, 0
  v_mov_b32 v40, 0
  v_mov_b32 v41, 0
  v_mov_b32 v42, 0
  v_mov_b32 v43, 0
  v_mov_b32 v44, 0
  v_mov_b32 v45, 0
  v_mov_b32 v46, 0
  v_mov_b32 v47, 0
  v_mov_b32 v48, 0
  v_mov_b32 v49, 0
  v_mov_b32 v50, 0
  v_mov_b32 v51, 0
  v_mov_b32 v52, 0
  v_mov_b32 v53, 0
  v_mov_b32 v54, 0
  v_mov_b32 v55, 0
  v_mov_b32 v56, 0
  v_mov_b32 v57, 0
  v_mov_b32 v58, 0
  v_mov_b32 v59, 0
  v_mov_b32 v60, 0
  v_mov_b32 v61, 0
  v_mov_b32 v62, 0
  v_mov_b32 v63, 0
  s_mov_b32 s19, s18
  s_add_u32 s18, s18, 1
  s_mov_b32 s22, s20
  s_mov_b32 s20, s21
  s_mov_b32 s21, s22
  s_add_u32 s23, s20, 4096
  s_branch cA_va3_loop
cA_va3_slow:
  s_waitcnt lgkmcnt(0)
cA_va3_sl1:
  s_add_u32 s31, s31, 0x1000000
  buffer_load_dwordx4 v[8:11], v2, s[8:11], s20 offen offset:0 sc1
  buffer_load_dwordx4 v[12:15], v2, s[8:11], s20 offen offset:1024 sc1
  buffer_load_dwordx4 v[16:19], v2, s[8:11], s20 offen offset:2048 sc1
  buffer_load_dwordx4 v[20:23], v2, s[8:11], s20 offen offset:3072 sc1
  buffer_load_dwordx4 v[24:27], v2, s[8:11], s23 offen offset:0 sc1
  buffer_load_dwordx4 v[28:31], v2, s[8:11], s23 offen offset:1024 sc1
  buffer_load_dwordx4 v[32:35], v2, s[8:11], s23 offen offset:2048 sc1
  s_waitcnt vmcnt(0)
  v_max3_u32 v36, v8, v9, v10
  v_max3_u32 v36, v36, v11, v12
  v_max3_u32 v36, v36, v13, v14
  v_max3_u32 v36, v36, v15, v16
  v_max3_u32 v36, v36, v17, v18
  v_max3_u32 v36, v36, v19, v20
  v_max3_u32 v36, v36, v21, v22
  v_max3_u32 v36, v36, v23, v24
  v_max3_u32 v36, v36, v25, v26
  v_max3_u32 v36, v36, v27, v28
  v_max3_u32 v36, v36, v29, v30
  v_max3_u32 v36, v36, v31, v32
  v_max3_u32 v36, v36, v33, v34
  v_max_u32 v36, v36, v35
  v_cmp_eq_u32 vcc, -1, v36
  s_cbranch_vccz cA_va3_sl2
  s_add_u32 s30, s30, 1
  s_cmp_lt_u32 s30, 400000
  s_cbranch_scc1 cA_va3_sl1
  s_branch cA_abort
cA_va3_sl2:
  v_mov_b32 v36, 0
  v_mov_b32 v37, 0
  v_mov_b32 v38, 0
  v_mov_b32 v39, 0
  v_mov_b32 v40, 0
  v_mov_b32 v41, 0
  v_mov_b32 v42, 0
  v_mov_b32 v43, 0
  v_mov_b32 v44, 0
  v_mov_b32 v45, 0
  v_mov_b32 v46, 0
  v_mov_b32 v47, 0
  v_mov_b32 v48, 0
  v_mov_b32 v49, 0
  v_mov_b32 v50, 0
  v_mov_b32 v51, 0
  v_mov_b32 v52, 0
  v_mov_b32 v53, 0
  v_mov_b32 v54, 0
  v_mov_b32 v55, 0
  v_mov_b32 v56, 0
  v_mov_b32 v57, 0
  v_mov_b32 v58, 0
  v_mov_b32 v59, 0
  v_mov_b32 v60, 0
  v_mov_b32 v61, 0
  v_mov_b32 v62, 0
  v_mov_b32 v63, 0
  v_smfmac_f32_16x16x64_bf16 v[36:39], v[8:11], a[0:7], v3
  v_smfmac_f32_16x16x64_bf16 v[40:43], v[8:11], a[56:63], v3
  v_smfmac_f32_16x16x64_bf16 v[44:47], v[8:11], a[112:119], v3
  v_smfmac_f32_16x16x64_bf16 v[48:51], v[8:11], a[168:175], v3
  v_smfmac_f32_16x16x64_bf16 v[52:55], v[8:11], a[224:231], v3
  v_smfmac_f32_16x16x64_bf16 v[56:59], v[8:11], v[144:151], v3
  v_smfmac_f32_16x16x64_bf16 v[60:63], v[8:11], v[200:207], v3
  v_smfmac_f32_16x16x64_bf16 v[36:39], v[12:15], a[8:15], v3
  v_smfmac_f32_16x16x64_bf16 v[40:43], v[12:15], a[64:71], v3
  v_smfmac_f32_16x16x64_bf16 v[44:47], v[12:15], a[120:127], v3
  v_smfmac_f32_16x16x64_bf16 v[48:51], v[12:15], a[176:183], v3
  v_smfmac_f32_16x16x64_bf16 v[52:55], v[12:15], a[232:239], v3
  v_smfmac_f32_16x16x64_bf16 v[56:59], v[12:15], v[152:159], v3
  v_smfmac_f32_16x16x64_bf16 v[60:63], v[12:15], v[208:215], v3
  v_smfmac_f32_16x16x64_bf16 v[36:39], v[16:19], a[16:23], v3
  v_smfmac_f32_16x16x64_bf16 v[40:43], v[16:19], a[72:79], v3
  v_smfmac_f32_16x16x64_bf16 v[44:47], v[16:19], a[128:135], v3
  v_smfmac_f32_16x16x64_bf16 v[48:51], v[16:19], a[184:191], v3
  v_smfmac_f32_16x16x64_bf16 v[52:55], v[16:19], a[240:247], v3
  v_smfmac_f32_16x16x64_bf16 v[56:59], v[16:19], v[160:167], v3
  v_smfmac_f32_16x16x64_bf16 v[60:63], v[16:19], v[216:223], v3
  v_smfmac_f32_16x16x64_bf16 v[36:39], v[20:23], a[24:31], v3
  v_smfmac_f32_16x16x64_bf16 v[40:43], v[20:23], a[80:87], v3
  v_smfmac_f32_16x16x64_bf16 v[44:47], v[20:23], a[136:143], v3
  v_smfmac_f32_16x16x64_bf16 v[48:51], v[20:23], a[192:199], v3
  v_smfmac_f32_16x16x64_bf16 v[52:55], v[20:23], a[248:255], v3
  v_smfmac_f32_16x16x64_bf16 v[56:59], v[20:23], v[168:175], v3
  v_smfmac_f32_16x16x64_bf16 v[60:63], v[20:23], v[224:231], v3
  v_smfmac_f32_16x16x64_bf16 v[36:39], v[24:27], a[32:39], v3
  v_smfmac_f32_16x16x64_bf16 v[40:43], v[24:27], a[88:95], v3
  v_smfmac_f32_16x16x64_bf16 v[44:47], v[24:27], a[144:151], v3
  v_smfmac_f32_16x16x64_bf16 v[48:51], v[24:27], a[200:207], v3
  v_smfmac_f32_16x16x64_bf16 v[52:55], v[24:27], v[120:127], v3
  v_smfmac_f32_16x16x64_bf16 v[56:59], v[24:27], v[176:183], v3
  v_smfmac_f32_16x16x64_bf16 v[60:63], v[24:27], v[232:239], v3
  v_smfmac_f32_16x16x64_bf16 v[36:39], v[28:31], a[40:47], v3
  v_smfmac_f32_16x16x64_bf16 v[40:43], v[28:31], a[96:103], v3
  v_smfmac_f32_16x16x64_bf16 v[44:47], v[28:31], a[152:159], v3
  v_smfmac_f32_16x16x64_bf16 v[48:51], v[28:31], a[208:215], v3
  v_smfmac_f32_16x16x64_bf16 v[52:55], v[28:31], v[128:135], v3
  v_smfmac_f32_16x16x64_bf16 v[56:59], v[28:31], v[184:191], v3
  v_smfmac_f32_16x16x64_bf16 v[60:63], v[28:31], v[240:247], v3
  v_smfmac_f32_16x16x64_bf16 v[36:39], v[32:35], a[48:55], v3
  v_smfmac_f32_16x16x64_bf16 v[40:43], v[32:35], a[104:111], v3
  v_smfmac_f32_16x16x64_bf16 v[44:47], v[32:35], a[160:167], v3
  v_smfmac_f32_16x16x64_bf16 v[48:51], v[32:35], a[216:223], v3
  v_smfmac_f32_16x16x64_bf16 v[52:55], v[32:35], v[136:143], v3
  v_smfmac_f32_16x16x64_bf16 v[56:59], v[32:35], v[192:199], v3
  v_smfmac_f32_16x16x64_bf16 v[60:63], v[32:35], v[248:255], v3
  v_permlane32_swap_b32 v36, v38
  v_permlane32_swap_b32 v37, v39
  v_add_f32 v36, v36, v38
  v_add_f32 v37, v37, v39
  v_cvt_pk_bf16_f32 v38, v36, v37
  ds_write_b32 v104, v38
  v_permlane32_swap_b32 v40, v42
  v_permlane32_swap_b32 v41, v43
  v_add_f32 v40, v40, v42
  v_add_f32 v41, v41, v43
  v_cvt_pk_bf16_f32 v42, v40, v41
  ds_write_b32 v105, v42
  v_permlane32_swap_b32 v44, v46
  v_permlane32_swap_b32 v45, v47
  v_add_f32 v44, v44, v46
  v_add_f32 v45, v45, v47
  v_cvt_pk_bf16_f32 v46, v44, v45
  ds_write_b32 v106, v46
  v_permlane32_swap_b32 v48, v50
  v_permlane32_swap_b32 v49, v51
  v_add_f32 v48, v48, v50
  v_add_f32 v49, v49, v51
  v_cvt_pk_bf16_f32 v50, v48, v49
  ds_write_b32 v107, v50
  v_permlane32_swap_b32 v52, v54
  v_permlane32_swap_b32 v53, v55
  v_add_f32 v52, v52, v54
  v_add_f32 v53, v53, v55
  v_cvt_pk_bf16_f32 v54, v52, v53
  ds_write_b32 v108, v54
  v_permlane32_swap_b32 v56, v58
  v_permlane32_swap_b32 v57, v59
  v_add_f32 v56, v56, v58
  v_add_f32 v57, v57, v59
  v_cvt_pk_bf16_f32 v58, v56, v57
  ds_write_b32 v109, v58
  v_permlane32_swap_b32 v60, v62
  v_permlane32_swap_b32 v61, v63
  v_add_f32 v60, v60, v62
  v_add_f32 v61, v61, v63
  v_cvt_pk_bf16_f32 v62, v60, v61
  ds_write_b32 v110, v62
  s_branch cA_va3_t2d
cA_va3_vor:
  s_sleep 2
  buffer_load_dword v101, off, s[8:11], s27 sc1
  s_add_u32 s30, s30, 1
  s_cmp_lt_u32 s30, 400000
  s_cbranch_scc1 cA_va3_vow
  s_branch cA_abort
cA_abort:
  v_mov_b32 v4, 0xdead
  v_mov_b32 v5, 16
  buffer_store_dword v4, v5, s[12:15], 0 offen
  s_branch ch_end
cA_done:
  s_branch ch_end
.p2align 6
cB_sc0_loop:
  s_mov_b32 s30, 0
  s_mov_b32 s62, 0
  s_setprio 3
  s_sleep 6
cB_sc0_fp_l:
  v_cmp_gt_u32 vcc, s19, v112
  buffer_load_dword v112, v0, s[8:11], 0 offen sc1
  s_cbranch_vccz cB_sc0_fp_d
  v_cmp_gt_u32 vcc, s19, v112
  buffer_load_dword v112, v0, s[8:11], 0 offen sc1
  s_cbranch_vccz cB_sc0_fp_d
  v_cmp_gt_u32 vcc, s19, v112
  buffer_load_dword v112, v0, s[8:11], 0 offen sc1
  s_cbranch_vccz cB_sc0_fp_d
  v_cmp_gt_u32 vcc, s19, v112
  buffer_load_dword v112, v0, s[8:11], 0 offen sc1
  s_cbranch_vccz cB_sc0_fp_d
  v_cmp_gt_u32 vcc, s19, v112
  buffer_load_dword v112, v0, s[8:11], 0 offen sc1
  s_cbranch_vccz cB_sc0_fp_d
  v_cmp_gt_u32 vcc, s19, v112
  buffer_load_dword v112, v0, s[8:11], 0 offen sc1
  s_cbranch_vccz cB_sc0_fp_d
  v_cmp_gt_u32 vcc, s19, v112
  buffer_load_dword v112, v0, s[8:11], 0 offen sc1
  s_cbranch_vccz cB_sc0_fp_d
  v_cmp_gt_u32 vcc, s19, v112
  buffer_load_dword v112, v0, s[8:11], 0 offen sc1
  s_cbranch_vccz cB_sc0_fp_d
  v_cmp_gt_u32 vcc, s19, v112
  buffer_load_dword v112, v0, s[8:11], 0 offen sc1
  s_cbranch_vccz cB_sc0_fp_d
  v_cmp_gt_u32 vcc, s19, v112
  buffer_load_dword v112, v0, s[8:11], 0 offen sc1
  s_cbranch_vccz cB_sc0_fp_d
  v_cmp_gt_u32 vcc, s19, v112
  buffer_load_dword v112, v0, s[8:11], 0 offen sc1
  s_cbranch_vccz cB_sc0_fp_d
  v_cmp_gt_u32 vcc, s19, v112
  buffer_load_dword v112, v0, s[8:11], 0 offen sc1
  s_cbranch_vccz cB_sc0_fp_d
  v_cmp_gt_u32 vcc, s19, v112
  buffer_load_dword v112, v0, s[8:11], 0 offen sc1
  s_cbranch_vccz cB_sc0_fp_d
  v_cmp_gt_u32 vcc, s19, v112
  buffer_load_dword v112, v0, s[8:11], 0 offen sc1
  s_cbranch_vccz cB_sc0_fp_d
  v_cmp_gt_u32 vcc, s19, v112
  buffer_load_dword v112, v0, s[8:11], 0 offen sc1
  s_cbranch_vccz cB_sc0_fp_d
  v_cmp_gt_u32 vcc, s19, v112
  buffer_load_dword v112, v0, s[8:11], 0 offen sc1
  s_cbranch_vccz cB_sc0_fp_d
  s_waitcnt vmcnt(24)
  s_add_u32 s30, s30, 1
  s_cmp_lt_u32 s30, 400000
  s_cbranch_scc1 cB_sc0_fp_l
  s_branch cB_abort
cB_sc0_fp_d:
  buffer_load_dwordx4 v[8:11], v2, s[8:11], s20 offen offset:0 sc1
  s_barrier
  s_setprio 2
  buffer_load_dwordx4 v[12:15], v2, s[8:11], s20 offen offset:1024 sc1
  s_setprio 1
  buffer_load_dwordx4 v[16:19], v2, s[8:11], s20 offen offset:2048 sc1
  s_setprio 0
  buffer_load_dwordx4 v[20:23], v2, s[8:11], s20 offen offset:3072 sc1
cB_sc0_go:
  s_waitcnt vmcnt(3)
  v_smfmac_f32_16x16x64_bf16 v[36:39], v[8:11], a[0:7], v3
  buffer_load_dwordx4 v[32:35], v2, s[8:11], s23 offen offset:0 sc1
  v_cmp_eq_u32 vcc, -1, v8
  v_smfmac_f32_16x16x64_bf16 v[40:43], v[8:11], a[56:63], v3
  v_smfmac_f32_16x16x64_bf16 v[44:47], v[8:11], a[112:119], v3
  buffer_load_dwordx4 v[24:27], v2, s[8:11], s23 offen offset:1024 sc1
  s_cbranch_vccnz cB_sc0_r0
  v_smfmac_f32_16x16x64_bf16 v[48:51], v[8:11], a[168:175], v3
  v_smfmac_f32_16x16x64_bf16 v[52:55], v[8:11], a[224:231], v3
  v_smfmac_f32_16x16x64_bf16 v[56:59], v[8:11], v[144:151], v3
  buffer_load_dwordx4 v[28:31], v2, s[8:11], s23 offen offset:2048 sc1
  v_smfmac_f32_16x16x64_bf16 v[60:63], v[8:11], v[200:207], v3
  s_waitcnt vmcnt(5)
  v_smfmac_f32_16x16x64_bf16 v[36:39], v[12:15], a[8:15], v3
  v_cmp_eq_u32 vcc, -1, v12
  v_smfmac_f32_16x16x64_bf16 v[40:43], v[12:15], a[64:71], v3
  v_smfmac_f32_16x16x64_bf16 v[44:47], v[12:15], a[120:127], v3
  s_cbranch_vccnz cB_sc0_r1
  v_smfmac_f32_16x16x64_bf16 v[48:51], v[12:15], a[176:183], v3
  v_smfmac_f32_16x16x64_bf16 v[52:55], v[12:15], a[232:239], v3
  v_smfmac_f32_16x16x64_bf16 v[56:59], v[12:15], v[152:159], v3
  buffer_load_dwordx4 v[88:91], v117, s[8:11], s26 offen offset:0 sc1
  v_smfmac_f32_16x16x64_bf16 v[60:63], v[12:15], v[208:215], v3
  s_waitcnt vmcnt(5)
  v_smfmac_f32_16x16x64_bf16 v[36:39], v[16:19], a[16:23], v3
  v_cmp_eq_u32 vcc, -1, v16
  v_smfmac_f32_16x16x64_bf16 v[40:43], v[16:19], a[72:79], v3
  v_smfmac_f32_16x16x64_bf16 v[44:47], v[16:19], a[128:135], v3
  s_cbranch_vccnz cB_sc0_r2
  buffer_load_dwordx4 v[92:95], v117, s[8:11], s26 offen offset:1024 sc1
  v_smfmac_f32_16x16x64_bf16 v[48:51], v[16:19], a[184:191], v3
  v_smfmac_f32_16x16x64_bf16 v[52:55], v[16:19], a[240:247], v3
  v_smfmac_f32_16x16x64_bf16 v[56:59], v[16:19], v[160:167], v3
  v_smfmac_f32_16x16x64_bf16 v[60:63], v[16:19], v[216:223], v3
  s_waitcnt vmcnt(5)
  buffer_load_dwordx4 v[96:99], v2, s[8:11], s24 offen offset:0 sc1
  v_smfmac_f32_16x16x64_bf16 v[36:39], v[20:23], a[24:31], v3
  v_cmp_eq_u32 vcc, -1, v20
  v_smfmac_f32_16x16x64_bf16 v[40:43], v[20:23], a[80:87], v3
  s_waitcnt vmcnt(3)
  v_max3_u32 v66, v24, v27, v28
  v_smfmac_f32_16x16x64_bf16 v[44:47], v[20:23], a[136:143], v3
  s_cbranch_vccnz cB_sc0_r3
  v_max3_u32 v66, v66, v31, v32
  v_smfmac_f32_16x16x64_bf16 v[48:51], v[20:23], a[192:199], v3
  buffer_load_dwordx4 v[100:103], v2, s[8:11], s24 offen offset:1024 sc1
  v_max_u32 v66, v66, v35
  v_smfmac_f32_16x16x64_bf16 v[52:55], v[20:23], a[248:255], v3
  v_cmp_eq_u32 vcc, -1, v66
  v_smfmac_f32_16x16x64_bf16 v[56:59], v[20:23], v[168:175], v3
  v_smfmac_f32_16x16x64_bf16 v[60:63], v[20:23], v[224:231], v3
  s_cbranch_vccnz cB_sc0_r4
cB_sc0_c4:
  v_smfmac_f32_16x16x64_bf16 v[60:63], v[32:35], v[232:239], v3
  buffer_load_dwordx4 v[104:107], v2, s[8:11], s26 offen offset:0 sc1
  v_smfmac_f32_16x16x64_bf16 v[60:63], v[24:27], v[240:247], v3
  v_smfmac_f32_16x16x64_bf16 v[60:63], v[28:31], v[248:255], v3
  v_smfmac_f32_16x16x64_bf16 v[52:55], v[32:35], v[120:127], v3
  v_smfmac_f32_16x16x64_bf16 v[52:55], v[24:27], v[128:135], v3
  buffer_load_dwordx4 v[108:111], v2, s[8:11], s26 offen offset:1024 sc1
  v_smfmac_f32_16x16x64_bf16 v[52:55], v[28:31], v[136:143], v3
  v_cvt_pk_bf16_f32 v63, v62, v63
  v_smfmac_f32_16x16x64_bf16 v[56:59], v[32:35], v[176:183], v3
  v_cvt_pk_bf16_f32 v62, v60, v61
  v_smfmac_f32_16x16x64_bf16 v[56:59], v[24:27], v[184:191], v3
  v_mfma_f32_16x16x32_bf16 v[12:15], v[62:65], v[4:7], 0
  v_cvt_pk_bf16_f32 v55, v54, v55
  v_smfmac_f32_16x16x64_bf16 v[56:59], v[28:31], v[192:199], v3
  v_cvt_pk_bf16_f32 v54, v52, v53
  v_smfmac_f32_16x16x64_bf16 v[36:39], v[32:35], a[32:39], v3
  s_nop 1
  v_cvt_pk_bf16_f32 v76, v12, v13
  v_smfmac_f32_16x16x64_bf16 v[36:39], v[24:27], a[40:47], v3
  v_cvt_pk_bf16_f32 v77, v14, v15
  v_smfmac_f32_16x16x64_bf16 v[36:39], v[28:31], a[48:55], v3
  v_cvt_pk_bf16_f32 v56, v56, v57
  v_smfmac_f32_16x16x64_bf16 v[40:43], v[32:35], a[88:95], v3
  v_cvt_pk_bf16_f32 v57, v58, v59
  v_smfmac_f32_16x16x64_bf16 v[40:43], v[24:27], a[96:103], v3
  v_mfma_f32_16x16x32_bf16 v[16:19], v[54:57], v[4:7], 0
  v_cvt_pk_bf16_f32 v39, v38, v39
  v_smfmac_f32_16x16x64_bf16 v[40:43], v[28:31], a[104:111], v3
  v_cvt_pk_bf16_f32 v38, v36, v37
  v_smfmac_f32_16x16x64_bf16 v[44:47], v[32:35], a[144:151], v3
  s_nop 1
  v_cvt_pk_bf16_f32 v78, v16, v17
  v_smfmac_f32_16x16x64_bf16 v[44:47], v[24:27], a[152:159], v3
  v_cvt_pk_bf16_f32 v79, v18, v19
  v_smfmac_f32_16x16x64_bf16 v[44:47], v[28:31], a[160:167], v3
  v_cvt_pk_bf16_f32 v40, v40, v41
  v_smfmac_f32_16x16x64_bf16 v[48:51], v[32:35], a[200:207], v3
  v_cvt_pk_bf16_f32 v41, v42, v43
  v_smfmac_f32_16x16x64_bf16 v[48:51], v[24:27], a[208:215], v3
  v_smfmac_f32_16x16x64_bf16 v[48:51], v[28:31], a[216:223], v3
  s_waitcnt vmcnt(4)
  v_cvt_pk_bf16_f32 v47, v46, v47
  v_smfmac_f32_16x16x64_bf16 v[68:71], v[76:79], v[80:87], v3
  v_cvt_pk_bf16_f32 v46, v44, v45
  v_mfma_f32_16x16x32_bf16 v[12:15], v[38:41], v[4:7], 0
  s_nop 1
  v_cvt_pk_bf16_f32 v48, v48, v49
  v_cvt_pk_bf16_f32 v49, v50, v51
  s_nop 1
  v_mfma_f32_16x16x32_bf16 v[16:19], v[46:49], v[4:7], 0
  v_smfmac_f32_16x16x64_bf16 v[72:75], v[76:79], v[88:95], v3
  v_cvt_pk_bf16_f32 v20, v12, v13
  v_mfma_f32_16x16x32_bf16 v[52:55], v[30:33], v[76:79], 0
  s_waitcnt vmcnt(0)
  v_cvt_pk_bf16_f32 v21, v14, v15
  v_cvt_pk_bf16_f32 v22, v16, v17
  v_cvt_pk_bf16_f32 v23, v18, v19
  s_nop 1
  v_mfma_f32_16x16x32_bf16 v[52:55], v[8:11], v[20:23], v[52:55]
  v_smfmac_f32_16x16x64_bf16 v[68:71], v[20:23], v[96:103], v3
  v_smfmac_f32_16x16x64_bf16 v[72:75], v[20:23], v[104:111], v3
  s_nop 1
  ds_write_b128 v113, v[52:55]
  s_nop 1
  v_permlane32_swap_b32 v68, v70
  v_permlane32_swap_b32 v69, v71
  v_add_f32 v56, v68, v70
  v_add_f32 v58, v69, v71
  v_permlane32_swap_b32 v72, v74
  v_permlane32_swap_b32 v73, v75
  v_add_f32 v57, v72, v74
  v_add_f32 v59, v73, v75
  ds_write_b128 v2, v[56:59] offset:0
  v_cmp_u_f32 vcc, v57, v59
  v_mov_b32 v68, 0
  v_mov_b32 v69, 0
  v_mov_b32 v70, 0
  v_mov_b32 v71, 0
  s_cbranch_vccnz cB_sc0_retry
cB_sc0_cont:
  s_add_u32 s24, s24, 28672
  s_add_u32 s26, s26, 28672
  buffer_load_dwordx4 v[80:83], v117, s[8:11], s24 offen offset:0 sc1
  buffer_load_dwordx4 v[84:87], v117, s[8:11], s24 offen offset:1024 sc1
  v_mov_b32 v72, 0
  v_mov_b32 v73, 0
  v_mfma_f32_32x32x16_bf16 v[36:51], v[68:71], v[68:71], 0
  s_waitcnt lgkmcnt(0)
  s_barrier
  ds_read_b64 v[8:9], v114 offset:0
  ds_read_b64 v[10:11], v114 offset:1024
  ds_read_b64 v[12:13], v114 offset:2048
  ds_read_b64 v[14:15], v114 offset:3072
  ds_read2_b32 v[16:17], v115 offset0:0 offset1:64
  ds_read2_b32 v[18:19], v115 offset0:128 offset1:192
  v_mfma_f32_32x32x16_bf16 v[52:67], v[68:71], v[68:71], 0
  s_waitcnt lgkmcnt(0)
  v_pk_add_f32 v[16:17], v[16:17], v[18:19]
  v_pk_add_f32 v[8:9], v[8:9], v[10:11]
  v_pk_add_f32 v[12:13], v[12:13], v[14:15]
  v_add_f32 v20, v16, v17
  v_pk_add_f32 v[8:9], v[8:9], v[12:13]
  v_max_f32 v22, v8, v9
  v_add_f32_dpp v20, v20, v20 row_ror:8 row_mask:0xf bank_mask:0xf
  s_nop 0
  v_max_f32_dpp v22, v22, v22 row_ror:8 row_mask:0xf bank_mask:0xf
  v_max_f32 v22, v22, v20
  s_nop 1
  v_max_f32_dpp v22, v22, v22 quad_perm:[1,0,3,2] row_mask:0xf bank_mask:0xf
  s_nop 1
  v_max_f32_dpp v22, v22, v22 quad_perm:[2,3,0,1] row_mask:0xf bank_mask:0xf
  s_nop 1
  v_max_f32_dpp v22, v22, v22 row_half_mirror row_mask:0xf bank_mask:0xf
  v_pk_add_f32 v[8:9], v[8:9], v[22:23] op_sel_hi:[1,0] neg_lo:[0,1] neg_hi:[0,1]
  v_sub_f32 v20, v20, v22
  v_exp_f32 v8, v8
  v_exp_f32 v9, v9
  v_exp_f32 v20, v20
  v_add_f32 v24, v8, v9
  v_fmac_f32 v24, 0.5, v20
  v_mov_b32_dpp v21, v20 quad_perm:[1,0,3,2] row_mask:0xf bank_mask:0xf
  s_nop 0
  v_add_f32_dpp v24, v24, v24 quad_perm:[1,0,3,2] row_mask:0xf bank_mask:0xf
  s_nop 1
  v_add_f32_dpp v24, v24, v24 quad_perm:[2,3,0,1] row_mask:0xf bank_mask:0xf
  s_nop 1
  v_add_f32_dpp v24, v24, v24 row_half_mirror row_mask:0xf bank_mask:0xf
  s_nop 1
  v_add_f32_dpp v24, v24, v24 row_ror:8 row_mask:0xf bank_mask:0xf
  v_rcp_f32 v24, v24
  s_nop 0
  v_pk_mul_f32 v[8:9], v[8:9], v[24:25] op_sel_hi:[1,0]
  v_cvt_pk_bf16_f32 v8, abs(v8), abs(v9)
  buffer_store_dword v8, v1, s[8:11], s20 offen sc1
  v_pk_mul_f32 v[20:21], v[20:21], v[24:25] op_sel_hi:[1,0]
  v_cvt_pk_bf16_f32 v20, abs(v20), abs(v21)
  buffer_store_dword v20, v118, s[8:11], s20 offen sc1
  v_mov_b32 v74, 0
  v_mov_b32 v75, 0
  s_mov_b32 s19, s18
  s_add_u32 s18, s18, 1
  s_mov_b32 s22, s20
  s_mov_b32 s20, s21
  s_mov_b32 s21, s22
  s_add_u32 s23, s20, 4096
  s_cmp_lt_u32 s19, 63
  s_cbranch_scc1 cB_sc0_loop
  s_branch cB_done
cB_sc0_r0:
  s_add_u32 s31, s31, 1
  buffer_load_dwordx4 v[8:11], v2, s[8:11], s20 offen offset:0 sc1
  s_waitcnt vmcnt(0)
  v_cmp_eq_u32 vcc, -1, v8
  v_mov_b32 v36, 0
  v_mov_b32 v37, 0
  v_mov_b32 v38, 0
  v_mov_b32 v39, 0
  v_mov_b32 v40, 0
  v_mov_b32 v41, 0
  v_mov_b32 v42, 0
  v_mov_b32 v43, 0
  v_mov_b32 v44, 0
  v_mov_b32 v45, 0
  v_mov_b32 v46, 0
  v_mov_b32 v47, 0
  v_mov_b32 v48, 0
  v_mov_b32 v49, 0
  v_mov_b32 v50, 0
  v_mov_b32 v51, 0
  s_nop 1
  s_cbranch_vccz cB_sc0_go
  s_add_u32 s30, s30, 1
  s_cmp_lt_u32 s30, 400000
  s_cbranch_scc1 cB_sc0_r0
  s_branch cB_abort
cB_sc0_r1:
  s_add_u32 s31, s31, 1
  buffer_load_dwordx4 v[12:15], v2, s[8:11], s20 offen offset:1024 sc1
  s_waitcnt vmcnt(0)
  v_cmp_eq_u32 vcc, -1, v12
  s_nop 4
  s_cbranch_vccz cB_sc0_rz
  s_add_u32 s30, s30, 1
  s_cmp_lt_u32 s30, 400000
  s_cbranch_scc1 cB_sc0_r1
  s_branch cB_abort
cB_sc0_r2:
  s_add_u32 s31, s31, 1
  buffer_load_dwordx4 v[16:19], v2, s[8:11], s20 offen offset:2048 sc1
  s_waitcnt vmcnt(0)
  v_cmp_eq_u32 vcc, -1, v16
  s_nop 4
  s_cbranch_vccz cB_sc0_rz
  s_add_u32 s30, s30, 1
  s_cmp_lt_u32 s30, 400000
  s_cbranch_scc1 cB_sc0_r2
  s_branch cB_abort
cB_sc0_r3:
  s_add_u32 s31, s31, 1
  buffer_load_dwordx4 v[20:23], v2, s[8:11], s20 offen offset:3072 sc1
  s_waitcnt vmcnt(0)
  v_cmp_eq_u32 vcc, -1, v20
  s_nop 4
  s_cbranch_vccz cB_sc0_rz
  s_add_u32 s30, s30, 1
  s_cmp_lt_u32 s30, 400000
  s_cbranch_scc1 cB_sc0_r3
  s_branch cB_abort
cB_sc0_r4:
  s_add_u32 s31, s31, 1
  buffer_load_dwordx4 v[32:35], v2, s[8:11], s23 offen offset:0 sc1
  buffer_load_dwordx4 v[24:27], v2, s[8:11], s23 offen offset:1024 sc1
  buffer_load_dwordx4 v[28:31], v2, s[8:11], s23 offen offset:2048 sc1
  s_waitcnt vmcnt(0)
  v_max3_u32 v66, v24, v27, v28
  v_max3_u32 v66, v66, v31, v32
  v_max_u32 v66, v66, v35
  v_cmp_eq_u32 vcc, -1, v66
  s_nop 4
  s_cbranch_vccz cB_sc0_c4
  s_add_u32 s30, s30, 1
  s_cmp_lt_u32 s30, 400000
  s_cbranch_scc1 cB_sc0_r4
  s_branch cB_abort
cB_sc0_retry:
  s_cmp_lg_u32 s62, 0
  s_cbranch_scc1 cB_sc0_cont
  s_waitcnt vmcnt(0) lgkmcnt(0)
cB_sc0_rv:
  buffer_load_dwordx4 v[8:11], v2, s[8:11], s20 offen offset:0 sc1
  buffer_load_dwordx4 v[12:15], v2, s[8:11], s20 offen offset:1024 sc1
  buffer_load_dwordx4 v[16:19], v2, s[8:11], s20 offen offset:2048 sc1
  buffer_load_dwordx4 v[20:23], v2, s[8:11], s20 offen offset:3072 sc1
  buffer_load_dwordx4 v[32:35], v2, s[8:11], s23 offen offset:0 sc1
  buffer_load_dwordx4 v[24:27], v2, s[8:11], s23 offen offset:1024 sc1
  buffer_load_dwordx4 v[28:31], v2, s[8:11], s23 offen offset:2048 sc1
  s_waitcnt vmcnt(0)
  v_max3_u32 v66, v8, v9, v10
  v_max3_u32 v66, v66, v11, v12
  v_max3_u32 v66, v66, v13, v14
  v_max3_u32 v66, v66, v15, v16
  v_max3_u32 v66, v66, v17, v18
  v_max3_u32 v66, v66, v19, v20
  v_max3_u32 v66, v66, v21, v22
  v_max3_u32 v66, v66, v23, v24
  v_max3_u32 v66, v66, v25, v26
  v_max3_u32 v66, v66, v27, v28
  v_max3_u32 v66, v66, v29, v30
  v_max3_u32 v66, v66, v31, v32
  v_max3_u32 v66, v66, v33, v34
  v_max_u32 v66, v66, v35
  v_cmp_eq_u32 vcc, -1, v66
  s_cbranch_vccz cB_sc0_rk
  s_add_u32 s30, s30, 1
  s_cmp_lt_u32 s30, 400000
  s_cbranch_scc1 cB_sc0_rv
  s_branch cB_abort
cB_sc0_rk:
  s_mov_b32 s62, 1
  s_add_u32 s31, s31, 0x100
cB_sc0_rz:
  v_mov_b32 v36, 0
  v_mov_b32 v37, 0
  v_mov_b32 v38, 0
  v_mov_b32 v39, 0
  v_mov_b32 v40, 0
  v_mov_b32 v41, 0
  v_mov_b32 v42, 0
  v_mov_b32 v43, 0
  v_mov_b32 v44, 0
  v_mov_b32 v45, 0
  v_mov_b32 v46, 0
  v_mov_b32 v47, 0
  v_mov_b32 v48, 0
  v_mov_b32 v49, 0
  v_mov_b32 v50, 0
  v_mov_b32 v51, 0
  v_mov_b32 v60, 0
  v_mov_b32 v61, 0
  v_mov_b32 v62, 0
  v_mov_b32 v63, 0
  v_mov_b32 v68, 0
  v_mov_b32 v69, 0
  v_mov_b32 v70, 0
  v_mov_b32 v71, 0
  v_mov_b32 v72, 0
  v_mov_b32 v73, 0
  v_mov_b32 v74, 0
  v_mov_b32 v75, 0
  v_mov_b32 v52, 0
  v_mov_b32 v53, 0
  v_mov_b32 v54, 0
  v_mov_b32 v55, 0
  v_mov_b32 v56, 0
  v_mov_b32 v57, 0
  v_mov_b32 v58, 0
  v_mov_b32 v59, 0
  s_nop 1
  s_branch cB_sc0_go
.p2align 6
cB_sc1_loop:
  s_mov_b32 s30, 0
  s_mov_b32 s62, 0
  s_setprio 3
  s_barrier
  buffer_load_dwordx4 v[12:15], v2, s[8:11], s20 offen offset:1024 sc1
  s_setprio 2
  buffer_load_dwordx4 v[16:19], v2, s[8:11], s20 offen offset:2048 sc1
  s_setprio 1
  buffer_load_dwordx4 v[20:23], v2, s[8:11], s20 offen offset:3072 sc1
  s_setprio 0
  buffer_load_dwordx4 v[8:11], v2, s[8:11], s20 offen offset:0 sc1
cB_sc1_go:
  s_waitcnt vmcnt(3)
  v_smfmac_f32_16x16x64_bf16 v[36:39], v[12:15], a[8:15], v3
  buffer_load_dwordx4 v[24:27], v2, s[8:11], s23 offen offset:1024 sc1
  v_cmp_eq_u32 vcc, -1, v12
  v_smfmac_f32_16x16x64_bf16 v[40:43], v[12:15], a[64:71], v3
  v_smfmac_f32_16x16x64_bf16 v[44:47], v[12:15], a[120:127], v3
  buffer_load_dwordx4 v[32:35], v2, s[8:11], s23 offen offset:2048 sc1
  s_cbranch_vccnz cB_sc1_r0
  v_smfmac_f32_16x16x64_bf16 v[48:51], v[12:15], a[176:183], v3
  v_smfmac_f32_16x16x64_bf16 v[52:55], v[12:15], a[232:239], v3
  v_smfmac_f32_16x16x64_bf16 v[56:59], v[12:15], v[152:159], v3
  buffer_load_dwordx4 v[28:31], v2, s[8:11], s23 offen offset:0 sc1
  v_smfmac_f32_16x16x64_bf16 v[60:63], v[12:15], v[208:215], v3
  s_waitcnt vmcnt(5)
  v_smfmac_f32_16x16x64_bf16 v[36:39], v[16:19], a[16:23], v3
  v_cmp_eq_u32 vcc, -1, v16
  v_smfmac_f32_16x16x64_bf16 v[40:43], v[16:19], a[72:79], v3
  v_smfmac_f32_16x16x64_bf16 v[44:47], v[16:19], a[128:135], v3
  s_cbranch_vccnz cB_sc1_r1
  v_smfmac_f32_16x16x64_bf16 v[48:51], v[16:19], a[184:191], v3
  v_smfmac_f32_16x16x64_bf16 v[52:55], v[16:19], a[240:247], v3
  v_smfmac_f32_16x16x64_bf16 v[56:59], v[16:19], v[160:167], v3
  buffer_load_dwordx4 v[88:91], v117, s[8:11], s26 offen offset:0 sc1
  v_smfmac_f32_16x16x64_bf16 v[60:63], v[16:19], v[216:223], v3
  s_waitcnt vmcnt(5)
  v_smfmac_f32_16x16x64_bf16 v[36:39], v[20:23], a[24:31], v3
  v_cmp_eq_u32 vcc, -1, v20
  v_smfmac_f32_16x16x64_bf16 v[40:43], v[20:23], a[80:87], v3
  v_smfmac_f32_16x16x64_bf16 v[44:47], v[20:23], a[136:143], v3
  s_cbranch_vccnz cB_sc1_r2
  buffer_load_dwordx4 v[92:95], v117, s[8:11], s26 offen offset:1024 sc1
  v_smfmac_f32_16x16x64_bf16 v[48:51], v[20:23], a[192:199], v3
  v_smfmac_f32_16x16x64_bf16 v[52:55], v[20:23], a[248:255], v3
  v_smfmac_f32_16x16x64_bf16 v[56:59], v[20:23], v[168:175], v3
  v_smfmac_f32_16x16x64_bf16 v[60:63], v[20:23], v[224:231], v3
  s_waitcnt vmcnt(5)
  buffer_load_dwordx4 v[96:99], v2, s[8:11], s24 offen offset:0 sc1
  v_smfmac_f32_16x16x64_bf16 v[36:39], v[8:11], a[0:7], v3
  v_cmp_eq_u32 vcc, -1, v8
  v_smfmac_f32_16x16x64_bf16 v[40:43], v[8:11], a[56:63], v3
  s_waitcnt vmcnt(3)
  v_max3_u32 v66, v24, v27, v28
  v_smfmac_f32_16x16x64_bf16 v[44:47], v[8:11], a[112:119], v3
  s_cbranch_vccnz cB_sc1_r3
  v_max3_u32 v66, v66, v31, v32
  v_smfmac_f32_16x16x64_bf16 v[48:51], v[8:11], a[168:175], v3
  buffer_load_dwordx4 v[100:103], v2, s[8:11], s24 offen offset:1024 sc1
  v_max_u32 v66, v66, v35
  v_smfmac_f32_16x16x64_bf16 v[52:55], v[8:11], a[224:231], v3
  v_cmp_eq_u32 vcc, -1, v66
  v_smfmac_f32_16x16x64_bf16 v[56:59], v[8:11], v[144:151], v3
  v_smfmac_f32_16x16x64_bf16 v[60:63], v[8:11], v[200:207], v3
  s_cbranch_vccnz cB_sc1_r4
cB_sc1_c4:
  v_smfmac_f32_16x16x64_bf16 v[60:63], v[28:31], v[232:239], v3
  buffer_load_dwordx4 v[104:107], v2, s[8:11], s26 offen offset:0 sc1
  v_smfmac_f32_16x16x64_bf16 v[60:63], v[24:27], v[240:247], v3
  v_smfmac_f32_16x16x64_bf16 v[60:63], v[32:35], v[248:255], v3
  v_smfmac_f32_16x16x64_bf16 v[52:55], v[28:31], v[120:127], v3
  v_smfmac_f32_16x16x64_bf16 v[52:55], v[24:27], v[128:135], v3
  buffer_load_dwordx4 v[108:111], v2, s[8:11], s26 offen offset:1024 sc1
  v_smfmac_f32_16x16x64_bf16 v[52:55], v[32:35], v[136:143], v3
  v_cvt_pk_bf16_f32 v63, v62, v63
  v_smfmac_f32_16x16x64_bf16 v[56:59], v[28:31], v[176:183], v3
  v_cvt_pk_bf16_f32 v62, v60, v61
  v_smfmac_f32_16x16x64_bf16 v[56:59], v[24:27], v[184:191], v3
  v_mfma_f32_16x16x32_bf16 v[8:11], v[62:65], v[4:7], 0
  v_cvt_pk_bf16_f32 v55, v54, v55
  v_smfmac_f32_16x16x64_bf16 v[56:59], v[32:35], v[192:199], v3
  v_cvt_pk_bf16_f32 v54, v52, v53
  v_smfmac_f32_16x16x64_bf16 v[36:39], v[28:31], a[32:39], v3
  s_nop 1
  v_cvt_pk_bf16_f32 v78, v8, v9
  v_smfmac_f32_16x16x64_bf16 v[36:39], v[24:27], a[40:47], v3
  v_cvt_pk_bf16_f32 v79, v10, v11
  v_smfmac_f32_16x16x64_bf16 v[36:39], v[32:35], a[48:55], v3
  v_cvt_pk_bf16_f32 v56, v56, v57
  v_smfmac_f32_16x16x64_bf16 v[40:43], v[28:31], a[88:95], v3
  v_cvt_pk_bf16_f32 v57, v58, v59
  v_smfmac_f32_16x16x64_bf16 v[40:43], v[24:27], a[96:103], v3
  v_mfma_f32_16x16x32_bf16 v[16:19], v[54:57], v[4:7], 0
  v_cvt_pk_bf16_f32 v39, v38, v39
  v_smfmac_f32_16x16x64_bf16 v[40:43], v[32:35], a[104:111], v3
  v_cvt_pk_bf16_f32 v38, v36, v37
  v_smfmac_f32_16x16x64_bf16 v[44:47], v[28:31], a[144:151], v3
  s_nop 1
  v_cvt_pk_bf16_f32 v76, v16, v17
  v_smfmac_f32_16x16x64_bf16 v[44:47], v[24:27], a[152:159], v3
  v_cvt_pk_bf16_f32 v77, v18, v19
  v_smfmac_f32_16x16x64_bf16 v[44:47], v[32:35], a[160:167], v3
  v_cvt_pk_bf16_f32 v40, v40, v41
  v_smfmac_f32_16x16x64_bf16 v[48:51], v[28:31], a[200:207], v3
  v_cvt_pk_bf16_f32 v41, v42, v43
  v_smfmac_f32_16x16x64_bf16 v[48:51], v[24:27], a[208:215], v3
  v_smfmac_f32_16x16x64_bf16 v[48:51], v[32:35], a[216:223], v3
  s_waitcnt vmcnt(4)
  v_cvt_pk_bf16_f32 v47, v46, v47
  v_smfmac_f32_16x16x64_bf16 v[68:71], v[76:79], v[80:87], v3
  v_cvt_pk_bf16_f32 v46, v44, v45
  v_mfma_f32_16x16x32_bf16 v[8:11], v[38:41], v[4:7], 0
  s_nop 1
  v_cvt_pk_bf16_f32 v48, v48, v49
  v_cvt_pk_bf16_f32 v49, v50, v51
  s_nop 1
  v_mfma_f32_16x16x32_bf16 v[16:19], v[46:49], v[4:7], 0
  v_smfmac_f32_16x16x64_bf16 v[72:75], v[76:79], v[88:95], v3
  v_cvt_pk_bf16_f32 v20, v8, v9
  v_mfma_f32_16x16x32_bf16 v[52:55], v[30:33], v[76:79], 0
  s_waitcnt vmcnt(0)
  v_cvt_pk_bf16_f32 v21, v10, v11
  v_cvt_pk_bf16_f32 v22, v16, v17
  v_cvt_pk_bf16_f32 v23, v18, v19
  s_nop 1
  v_mfma_f32_16x16x32_bf16 v[52:55], v[12:15], v[20:23], v[52:55]
  v_smfmac_f32_16x16x64_bf16 v[68:71], v[20:23], v[96:103], v3
  v_smfmac_f32_16x16x64_bf16 v[72:75], v[20:23], v[104:111], v3
  s_nop 1
  ds_write_b128 v113, v[52:55]
  s_nop 1
  v_permlane32_swap_b32 v68, v70
  v_permlane32_swap_b32 v69, v71
  v_add_f32 v56, v68, v70
  v_add_f32 v58, v69, v71
  v_permlane32_swap_b32 v72, v74
  v_permlane32_swap_b32 v73, v75
  v_add_f32 v57, v72, v74
  v_add_f32 v59, v73, v75
  ds_write_b128 v2, v[56:59] offset:1024
  v_cmp_u_f32 vcc, v57, v59
  v_mov_b32 v68, 0
  v_mov_b32 v69, 0
  v_mov_b32 v70, 0
  v_mov_b32 v71, 0
  s_cbranch_vccnz cB_sc1_retry
cB_sc1_cont:
  s_add_u32 s24, s24, 28672
  s_add_u32 s26, s26, 28672
  buffer_load_dwordx4 v[80:83], v117, s[8:11], s24 offen offset:0 sc1
  buffer_load_dwordx4 v[84:87], v117, s[8:11], s24 offen offset:1024 sc1
  v_mov_b32 v72, 0
  v_mov_b32 v73, 0
  v_mfma_f32_32x32x16_bf16 v[36:51], v[68:71], v[68:71], 0
  s_waitcnt lgkmcnt(0)
  s_barrier
  ds_read_b64 v[8:9], v114 offset:0
  ds_read_b64 v[10:11], v114 offset:1024
  ds_read_b64 v[12:13], v114 offset:2048
  ds_read_b64 v[14:15], v114 offset:3072
  ds_read2_b32 v[16:17], v115 offset0:0 offset1:64
  ds_read2_b32 v[18:19], v115 offset0:128 offset1:192
  v_mfma_f32_32x32x16_bf16 v[52:67], v[68:71], v[68:71], 0
  s_waitcnt lgkmcnt(0)
  v_pk_add_f32 v[16:17], v[16:17], v[18:19]
  v_pk_add_f32 v[8:9], v[8:9], v[10:11]
  v_pk_add_f32 v[12:13], v[12:13], v[14:15]
  v_add_f32 v20, v16, v17
  v_pk_add_f32 v[8:9], v[8:9], v[12:13]
  v_max_f32 v22, v8, v9
  v_add_f32_dpp v20, v20, v20 row_ror:8 row_mask:0xf bank_mask:0xf
  s_nop 0
  v_max_f32_dpp v22, v22, v22 row_ror:8 row_mask:0xf bank_mask:0xf
  v_max_f32 v22, v22, v20
  s_nop 1
  v_max_f32_dpp v22, v22, v22 quad_perm:[1,0,3,2] row_mask:0xf bank_mask:0xf
  buffer_store_dword v112, v116, s[8:11], 0 offen sc1
  s_nop 0
  v_max_f32_dpp v22, v22, v22 quad_perm:[2,3,0,1] row_mask:0xf bank_mask:0xf
  s_nop 1
  v_max_f32_dpp v22, v22, v22 row_half_mirror row_mask:0xf bank_mask:0xf
  v_pk_add_f32 v[8:9], v[8:9], v[22:23] op_sel_hi:[1,0] neg_lo:[0,1] neg_hi:[0,1]
  v_sub_f32 v20, v20, v22
  v_exp_f32 v8, v8
  v_exp_f32 v9, v9
  v_exp_f32 v20, v20
  v_add_f32 v24, v8, v9
  v_fmac_f32 v24, 0.5, v20
  v_mov_b32_dpp v21, v20 quad_perm:[1,0,3,2] row_mask:0xf bank_mask:0xf
  s_nop 0
  v_add_f32_dpp v24, v24, v24 quad_perm:[1,0,3,2] row_mask:0xf bank_mask:0xf
  s_nop 1
  v_add_f32_dpp v24, v24, v24 quad_perm:[2,3,0,1] row_mask:0xf bank_mask:0xf
  s_nop 1
  v_add_f32_dpp v24, v24, v24 row_half_mirror row_mask:0xf bank_mask:0xf
  s_nop 1
  v_add_f32_dpp v24, v24, v24 row_ror:8 row_mask:0xf bank_mask:0xf
  v_rcp_f32 v24, v24
  s_nop 0
  v_pk_mul_f32 v[8:9], v[8:9], v[24:25] op_sel_hi:[1,0]
  v_cvt_pk_bf16_f32 v8, abs(v8), abs(v9)
  buffer_store_dword v8, v1, s[8:11], s20 offen sc1
  v_pk_mul_f32 v[20:21], v[20:21], v[24:25] op_sel_hi:[1,0]
  v_cvt_pk_bf16_f32 v20, abs(v20), abs(v21)
  buffer_store_dword v20, v118, s[8:11], s20 offen sc1
  v_mov_b32 v74, 0
  v_mov_b32 v75, 0
  s_mov_b32 s19, s18
  s_add_u32 s18, s18, 1
  s_mov_b32 s22, s20
  s_mov_b32 s20, s21
  s_mov_b32 s21, s22
  s_add_u32 s23, s20, 4096
  v_mov_b32 v112, s18
  s_cmp_lt_u32 s19, 63
  s_nop 0
  s_cbranch_scc1 cB_sc1_loop
  s_branch cB_done
cB_sc1_r0:
  s_add_u32 s31, s31, 1
  buffer_load_dwordx4 v[12:15], v2, s[8:11], s20 offen offset:1024 sc1
  s_waitcnt vmcnt(0)
  v_cmp_eq_u32 vcc, -1, v12
  v_mov_b32 v36, 0
  v_mov_b32 v37, 0
  v_mov_b32 v38, 0
  v_mov_b32 v39, 0
  v_mov_b32 v40, 0
  v_mov_b32 v41, 0
  v_mov_b32 v42, 0
  v_mov_b32 v43, 0
  v_mov_b32 v44, 0
  v_mov_b32 v45, 0
  v_mov_b32 v46, 0
  v_mov_b32 v47, 0
  v_mov_b32 v48, 0
  v_mov_b32 v49, 0
  v_mov_b32 v50, 0
  v_mov_b32 v51, 0
  s_nop 1
  s_cbranch_vccz cB_sc1_go
  s_add_u32 s30, s30, 1
  s_cmp_lt_u32 s30, 400000
  s_cbranch_scc1 cB_sc1_r0
  s_branch cB_abort
cB_sc1_r1:
  s_add_u32 s31, s31, 1
  buffer_load_dwordx4 v[16:19], v2, s[8:11], s20 offen offset:2048 sc1
  s_waitcnt vmcnt(0)
  v_cmp_eq_u32 vcc, -1, v16
  s_nop 4
  s_cbranch_vccz cB_sc1_rz
  s_add_u32 s30, s30, 1
  s_cmp_lt_u32 s30, 400000
  s_cbranch_scc1 cB_sc1_r1
  s_branch cB_abort
cB_sc1_r2:
  s_add_u32 s31, s31, 1
  buffer_load_dwordx4 v[20:23], v2, s[8:11], s20 offen offset:3072 sc1
  s_waitcnt vmcnt(0)
  v_cmp_eq_u32 vcc, -1, v20
  s_nop 4
  s_cbranch_vccz cB_sc1_rz
  s_add_u32 s30, s30, 1
  s_cmp_lt_u32 s30, 400000
  s_cbranch_scc1 cB_sc1_r2
  s_branch cB_abort
cB_sc1_r3:
  s_add_u32 s31, s31, 1
  buffer_load_dwordx4 v[8:11], v2, s[8:11], s20 offen offset:0 sc1
  s_waitcnt vmcnt(0)
  v_cmp_eq_u32 vcc, -1, v8
  s_nop 4
  s_cbranch_vccz cB_sc1_rz
  s_add_u32 s30, s30, 1
  s_cmp_lt_u32 s30, 400000
  s_cbranch_scc1 cB_sc1_r3
  s_branch cB_abort
cB_sc1_r4:
  s_add_u32 s31, s31, 1
  buffer_load_dwordx4 v[28:31], v2, s[8:11], s23 offen offset:0 sc1
  buffer_load_dwordx4 v[24:27], v2, s[8:11], s23 offen offset:1024 sc1
  buffer_load_dwordx4 v[32:35], v2, s[8:11], s23 offen offset:2048 sc1
  s_waitcnt vmcnt(0)
  v_max3_u32 v66, v24, v27, v28
  v_max3_u32 v66, v66, v31, v32
  v_max_u32 v66, v66, v35
  v_cmp_eq_u32 vcc, -1, v66
  s_nop 4
  s_cbranch_vccz cB_sc1_c4
  s_add_u32 s30, s30, 1
  s_cmp_lt_u32 s30, 400000
  s_cbranch_scc1 cB_sc1_r4
  s_branch cB_abort
cB_sc1_retry:
  s_cmp_lg_u32 s62, 0
  s_cbranch_scc1 cB_sc1_cont
  s_waitcnt vmcnt(0) lgkmcnt(0)
cB_sc1_rv:
  buffer_load_dwordx4 v[8:11], v2, s[8:11], s20 offen offset:0 sc1
  buffer_load_dwordx4 v[12:15], v2, s[8:11], s20 offen offset:1024 sc1
  buffer_load_dwordx4 v[16:19], v2, s[8:11], s20 offen offset:2048 sc1
  buffer_load_dwordx4 v[20:23], v2, s[8:11], s20 offen offset:3072 sc1
  buffer_load_dwordx4 v[28:31], v2, s[8:11], s23 offen offset:0 sc1
  buffer_load_dwordx4 v[24:27], v2, s[8:11], s23 offen offset:1024 sc1
  buffer_load_dwordx4 v[32:35], v2, s[8:11], s23 offen offset:2048 sc1
  s_waitcnt vmcnt(0)
  v_max3_u32 v66, v8, v9, v10
  v_max3_u32 v66, v66, v11, v12
  v_max3_u32 v66, v66, v13, v14
  v_max3_u32 v66, v66, v15, v16
  v_max3_u32 v66, v66, v17, v18
  v_max3_u32 v66, v66, v19, v20
  v_max3_u32 v66, v66, v21, v22
  v_max3_u32 v66, v66, v23, v24
  v_max3_u32 v66, v66, v25, v26
  v_max3_u32 v66, v66, v27, v28
  v_max3_u32 v66, v66, v29, v30
  v_max3_u32 v66, v66, v31, v32
  v_max3_u32 v66, v66, v33, v34
  v_max_u32 v66, v66, v35
  v_cmp_eq_u32 vcc, -1, v66
  s_cbranch_vccz cB_sc1_rk
  s_add_u32 s30, s30, 1
  s_cmp_lt_u32 s30, 400000
  s_cbranch_scc1 cB_sc1_rv
  s_branch cB_abort
cB_sc1_rk:
  s_mov_b32 s62, 1
  s_add_u32 s31, s31, 0x100
cB_sc1_rz:
  v_mov_b32 v36, 0
  v_mov_b32 v37, 0
  v_mov_b32 v38, 0
  v_mov_b32 v39, 0
  v_mov_b32 v40, 0
  v_mov_b32 v41, 0
  v_mov_b32 v42, 0
  v_mov_b32 v43, 0
  v_mov_b32 v44, 0
  v_mov_b32 v45, 0
  v_mov_b32 v46, 0
  v_mov_b32 v47, 0
  v_mov_b32 v48, 0
  v_mov_b32 v49, 0
  v_mov_b32 v50, 0
  v_mov_b32 v51, 0
  v_mov_b32 v60, 0
  v_mov_b32 v61, 0
  v_mov_b32 v62, 0
  v_mov_b32 v63, 0
  v_mov_b32 v68, 0
  v_mov_b32 v69, 0
  v_mov_b32 v70, 0
  v_mov_b32 v71, 0
  v_mov_b32 v72, 0
  v_mov_b32 v73, 0
  v_mov_b32 v74, 0
  v_mov_b32 v75, 0
  v_mov_b32 v52, 0
  v_mov_b32 v53, 0
  v_mov_b32 v54, 0
  v_mov_b32 v55, 0
  v_mov_b32 v56, 0
  v_mov_b32 v57, 0
  v_mov_b32 v58, 0
  v_mov_b32 v59, 0
  s_nop 1
  s_branch cB_sc1_go
.p2align 6
cB_sc2_loop:
  s_mov_b32 s30, 0
  s_mov_b32 s62, 0
  s_setprio 3
  s_barrier
  buffer_load_dwordx4 v[16:19], v2, s[8:11], s20 offen offset:2048 sc1
  s_setprio 2
  buffer_load_dwordx4 v[20:23], v2, s[8:11], s20 offen offset:3072 sc1
  s_setprio 1
  buffer_load_dwordx4 v[8:11], v2, s[8:11], s20 offen offset:0 sc1
  s_setprio 0
  buffer_load_dwordx4 v[12:15], v2, s[8:11], s20 offen offset:1024 sc1
cB_sc2_go:
  s_waitcnt vmcnt(3)
  v_smfmac_f32_16x16x64_bf16 v[36:39], v[16:19], a[16:23], v3
  buffer_load_dwordx4 v[28:31], v2, s[8:11], s23 offen offset:2048 sc1
  v_cmp_eq_u32 vcc, -1, v16
  v_smfmac_f32_16x16x64_bf16 v[40:43], v[16:19], a[72:79], v3
  v_smfmac_f32_16x16x64_bf16 v[44:47], v[16:19], a[128:135], v3
  buffer_load_dwordx4 v[24:27], v2, s[8:11], s23 offen offset:0 sc1
  s_cbranch_vccnz cB_sc2_r0
  v_smfmac_f32_16x16x64_bf16 v[48:51], v[16:19], a[184:191], v3
  v_smfmac_f32_16x16x64_bf16 v[52:55], v[16:19], a[240:247], v3
  v_smfmac_f32_16x16x64_bf16 v[56:59], v[16:19], v[160:167], v3
  buffer_load_dwordx4 v[32:35], v2, s[8:11], s23 offen offset:1024 sc1
  v_smfmac_f32_16x16x64_bf16 v[62:65], v[16:19], v[216:223], v3
  s_waitcnt vmcnt(5)
  v_smfmac_f32_16x16x64_bf16 v[36:39], v[20:23], a[24:31], v3
  v_cmp_eq_u32 vcc, -1, v20
  v_smfmac_f32_16x16x64_bf16 v[40:43], v[20:23], a[80:87], v3
  v_smfmac_f32_16x16x64_bf16 v[44:47], v[20:23], a[136:143], v3
  s_cbranch_vccnz cB_sc2_r1
  v_smfmac_f32_16x16x64_bf16 v[48:51], v[20:23], a[192:199], v3
  v_smfmac_f32_16x16x64_bf16 v[52:55], v[20:23], a[248:255], v3
  v_smfmac_f32_16x16x64_bf16 v[56:59], v[20:23], v[168:175], v3
  buffer_load_dwordx4 v[88:91], v117, s[8:11], s26 offen offset:0 sc1
  v_smfmac_f32_16x16x64_bf16 v[62:65], v[20:23], v[224:231], v3
  s_waitcnt vmcnt(5)
  v_smfmac_f32_16x16x64_bf16 v[36:39], v[8:11], a[0:7], v3
  v_cmp_eq_u32 vcc, -1, v8
  v_smfmac_f32_16x16x64_bf16 v[40:43], v[8:11], a[56:63], v3
  v_smfmac_f32_16x16x64_bf16 v[44:47], v[8:11], a[112:119], v3
  s_cbranch_vccnz cB_sc2_r2
  buffer_load_dwordx4 v[92:95], v117, s[8:11], s26 offen offset:1024 sc1
  v_smfmac_f32_16x16x64_bf16 v[48:51], v[8:11], a[168:175], v3
  v_smfmac_f32_16x16x64_bf16 v[52:55], v[8:11], a[224:231], v3
  v_smfmac_f32_16x16x64_bf16 v[56:59], v[8:11], v[144:151], v3
  v_smfmac_f32_16x16x64_bf16 v[62:65], v[8:11], v[200:207], v3
  s_waitcnt vmcnt(5)
  buffer_load_dwordx4 v[96:99], v2, s[8:11], s24 offen offset:0 sc1
  v_smfmac_f32_16x16x64_bf16 v[36:39], v[12:15], a[8:15], v3
  v_cmp_eq_u32 vcc, -1, v12
  v_smfmac_f32_16x16x64_bf16 v[40:43], v[12:15], a[64:71], v3
  s_waitcnt vmcnt(3)
  v_max3_u32 v66, v24, v27, v28
  v_smfmac_f32_16x16x64_bf16 v[44:47], v[12:15], a[120:127], v3
  s_cbranch_vccnz cB_sc2_r3
  v_max3_u32 v66, v66, v31, v32
  v_smfmac_f32_16x16x64_bf16 v[48:51], v[12:15], a[176:183], v3
  buffer_load_dwordx4 v[100:103], v2, s[8:11], s24 offen offset:1024 sc1
  v_max_u32 v66, v66, v35
  v_smfmac_f32_16x16x64_bf16 v[52:55], v[12:15], a[232:239], v3
  v_cmp_eq_u32 vcc, -1, v66
  v_smfmac_f32_16x16x64_bf16 v[56:59], v[12:15], v[152:159], v3
  v_smfmac_f32_16x16x64_bf16 v[62:65], v[12:15], v[208:215], v3
  s_cbranch_vccnz cB_sc2_r4
cB_sc2_c4:
  v_smfmac_f32_16x16x64_bf16 v[62:65], v[24:27], v[232:239], v3
  buffer_load_dwordx4 v[104:107], v2, s[8:11], s26 offen offset:0 sc1
  v_smfmac_f32_16x16x64_bf16 v[62:65], v[32:35], v[240:247], v3
  v_smfmac_f32_16x16x64_bf16 v[62:65], v[28:31], v[248:255], v3
  v_smfmac_f32_16x16x64_bf16 v[52:55], v[24:27], v[120:127], v3
  v_smfmac_f32_16x16x64_bf16 v[52:55], v[32:35], v[128:135], v3
  buffer_load_dwordx4 v[108:111], v2, s[8:11], s26 offen offset:1024 sc1
  v_smfmac_f32_16x16x64_bf16 v[52:55], v[28:31], v[136:143], v3
  v_cvt_pk_bf16_f32 v62, v62, v63
  v_smfmac_f32_16x16x64_bf16 v[56:59], v[24:27], v[176:183], v3
  v_cvt_pk_bf16_f32 v63, v64, v65
  v_smfmac_f32_16x16x64_bf16 v[56:59], v[32:35], v[184:191], v3
  v_mfma_f32_16x16x32_bf16 v[8:11], v[60:63], v[4:7], 0
  v_cvt_pk_bf16_f32 v55, v54, v55
  v_smfmac_f32_16x16x64_bf16 v[56:59], v[28:31], v[192:199], v3
  v_cvt_pk_bf16_f32 v54, v52, v53
  v_smfmac_f32_16x16x64_bf16 v[36:39], v[24:27], a[32:39], v3
  s_nop 1
  v_cvt_pk_bf16_f32 v76, v8, v9
  v_smfmac_f32_16x16x64_bf16 v[36:39], v[32:35], a[40:47], v3
  v_cvt_pk_bf16_f32 v77, v10, v11
  v_smfmac_f32_16x16x64_bf16 v[36:39], v[28:31], a[48:55], v3
  v_cvt_pk_bf16_f32 v56, v56, v57
  v_smfmac_f32_16x16x64_bf16 v[40:43], v[24:27], a[88:95], v3
  v_cvt_pk_bf16_f32 v57, v58, v59
  v_smfmac_f32_16x16x64_bf16 v[40:43], v[32:35], a[96:103], v3
  v_mfma_f32_16x16x32_bf16 v[12:15], v[54:57], v[4:7], 0
  v_cvt_pk_bf16_f32 v39, v38, v39
  v_smfmac_f32_16x16x64_bf16 v[40:43], v[28:31], a[104:111], v3
  v_cvt_pk_bf16_f32 v38, v36, v37
  v_smfmac_f32_16x16x64_bf16 v[44:47], v[24:27], a[144:151], v3
  s_nop 1
  v_cvt_pk_bf16_f32 v78, v12, v13
  v_smfmac_f32_16x16x64_bf16 v[44:47], v[32:35], a[152:159], v3
  v_cvt_pk_bf16_f32 v79, v14, v15
  v_smfmac_f32_16x16x64_bf16 v[44:47], v[28:31], a[160:167], v3
  v_cvt_pk_bf16_f32 v40, v40, v41
  v_smfmac_f32_16x16x64_bf16 v[48:51], v[24:27], a[200:207], v3
  v_cvt_pk_bf16_f32 v41, v42, v43
  v_smfmac_f32_16x16x64_bf16 v[48:51], v[32:35], a[208:215], v3
  v_smfmac_f32_16x16x64_bf16 v[48:51], v[28:31], a[216:223], v3
  s_waitcnt vmcnt(4)
  v_cvt_pk_bf16_f32 v47, v46, v47
  v_smfmac_f32_16x16x64_bf16 v[68:71], v[76:79], v[80:87], v3
  v_cvt_pk_bf16_f32 v46, v44, v45
  v_mfma_f32_16x16x32_bf16 v[8:11], v[38:41], v[4:7], 0
  s_nop 1
  v_cvt_pk_bf16_f32 v48, v48, v49
  v_cvt_pk_bf16_f32 v49, v50, v51
  s_nop 1
  v_mfma_f32_16x16x32_bf16 v[12:15], v[46:49], v[4:7], 0
  v_smfmac_f32_16x16x64_bf16 v[72:75], v[76:79], v[88:95], v3
  v_cvt_pk_bf16_f32 v20, v8, v9
  v_mfma_f32_16x16x32_bf16 v[52:55], v[30:33], v[76:79], 0
  s_waitcnt vmcnt(0)
  v_cvt_pk_bf16_f32 v21, v10, v11
  v_cvt_pk_bf16_f32 v22, v12, v13
  v_cvt_pk_bf16_f32 v23, v14, v15
  s_nop 1
  v_mfma_f32_16x16x32_bf16 v[52:55], v[16:19], v[20:23], v[52:55]
  v_smfmac_f32_16x16x64_bf16 v[68:71], v[20:23], v[96:103], v3
  v_smfmac_f32_16x16x64_bf16 v[72:75], v[20:23], v[104:111], v3
  s_nop 1
  ds_write_b128 v113, v[52:55]
  s_nop 1
  v_permlane32_swap_b32 v68, v70
  v_permlane32_swap_b32 v69, v71
  v_add_f32 v56, v68, v70
  v_add_f32 v58, v69, v71
  v_permlane32_swap_b32 v72, v74
  v_permlane32_swap_b32 v73, v75
  v_add_f32 v57, v72, v74
  v_add_f32 v59, v73, v75
  ds_write_b128 v2, v[56:59] offset:2048
  v_cmp_u_f32 vcc, v57, v59
  v_mov_b32 v68, 0
  v_mov_b32 v69, 0
  v_mov_b32 v70, 0
  v_mov_b32 v71, 0
  s_cbranch_vccnz cB_sc2_retry
cB_sc2_cont:
  s_add_u32 s24, s24, 28672
  s_add_u32 s26, s26, 28672
  buffer_load_dwordx4 v[80:83], v117, s[8:11], s24 offen offset:0 sc1
  buffer_load_dwordx4 v[84:87], v117, s[8:11], s24 offen offset:1024 sc1
  v_mov_b32 v72, 0
  v_mov_b32 v73, 0
  v_mfma_f32_32x32x16_bf16 v[36:51], v[68:71], v[68:71], 0
  s_waitcnt lgkmcnt(0)
  s_barrier
  v_mfma_f32_32x32x16_bf16 v[52:67], v[68:71], v[68:71], 0
  buffer_store_dwordx2 v[118:119], v114, s[8:11], s21 offen sc1
  buffer_store_dwordx2 v[118:119], v115, s[8:11], s21 offen sc1
  s_buffer_load_dword s70, s[8:11], s35
  s_add_u32 s22, s24, 114688
  s_buffer_load_dword s71, s[8:11], s22
  s_mul_i32 s22, s18, 7168
  s_add_u32 s22, s22, 87040
  s_buffer_load_dword s72, s[8:11], s22
  s_add_u32 s35, s35, 458752
  v_mov_b32 v74, 0
  v_mov_b32 v75, 0
  s_mov_b32 s19, s18
  s_add_u32 s18, s18, 1
  s_mov_b32 s22, s20
  s_mov_b32 s20, s21
  s_mov_b32 s21, s22
  s_add_u32 s23, s20, 4096
  s_cmp_lt_u32 s19, 63
  s_cbranch_scc1 cB_sc2_loop
  s_branch cB_done
cB_sc2_r0:
  s_add_u32 s31, s31, 1
  buffer_load_dwordx4 v[16:19], v2, s[8:11], s20 offen offset:2048 sc1
  s_waitcnt vmcnt(0)
  v_cmp_eq_u32 vcc, -1, v16
  v_mov_b32 v36, 0
  v_mov_b32 v37, 0
  v_mov_b32 v38, 0
  v_mov_b32 v39, 0
  v_mov_b32 v40, 0
  v_mov_b32 v41, 0
  v_mov_b32 v42, 0
  v_mov_b32 v43, 0
  v_mov_b32 v44, 0
  v_mov_b32 v45, 0
  v_mov_b32 v46, 0
  v_mov_b32 v47, 0
  v_mov_b32 v48, 0
  v_mov_b32 v49, 0
  v_mov_b32 v50, 0
  v_mov_b32 v51, 0
  s_nop 1
  s_cbranch_vccz cB_sc2_go
  s_add_u32 s30, s30, 1
  s_cmp_lt_u32 s30, 400000
  s_cbranch_scc1 cB_sc2_r0
  s_branch cB_abort
cB_sc2_r1:
  s_add_u32 s31, s31, 1
  buffer_load_dwordx4 v[20:23], v2, s[8:11], s20 offen offset:3072 sc1
  s_waitcnt vmcnt(0)
  v_cmp_eq_u32 vcc, -1, v20
  s_nop 4
  s_cbranch_vccz cB_sc2_rz
  s_add_u32 s30, s30, 1
  s_cmp_lt_u32 s30, 400000
  s_cbranch_scc1 cB_sc2_r1
  s_branch cB_abort
cB_sc2_r2:
  s_add_u32 s31, s31, 1
  buffer_load_dwordx4 v[8:11], v2, s[8:11], s20 offen offset:0 sc1
  s_waitcnt vmcnt(0)
  v_cmp_eq_u32 vcc, -1, v8
  s_nop 4
  s_cbranch_vccz cB_sc2_rz
  s_add_u32 s30, s30, 1
  s_cmp_lt_u32 s30, 400000
  s_cbranch_scc1 cB_sc2_r2
  s_branch cB_abort
cB_sc2_r3:
  s_add_u32 s31, s31, 1
  buffer_load_dwordx4 v[12:15], v2, s[8:11], s20 offen offset:1024 sc1
  s_waitcnt vmcnt(0)
  v_cmp_eq_u32 vcc, -1, v12
  s_nop 4
  s_cbranch_vccz cB_sc2_rz
  s_add_u32 s30, s30, 1
  s_cmp_lt_u32 s30, 400000
  s_cbranch_scc1 cB_sc2_r3
  s_branch cB_abort
cB_sc2_r4:
  s_add_u32 s31, s31, 1
  buffer_load_dwordx4 v[24:27], v2, s[8:11], s23 offen offset:0 sc1
  buffer_load_dwordx4 v[32:35], v2, s[8:11], s23 offen offset:1024 sc1
  buffer_load_dwordx4 v[28:31], v2, s[8:11], s23 offen offset:2048 sc1
  s_waitcnt vmcnt(0)
  v_max3_u32 v66, v24, v27, v28
  v_max3_u32 v66, v66, v31, v32
  v_max_u32 v66, v66, v35
  v_cmp_eq_u32 vcc, -1, v66
  s_nop 4
  s_cbranch_vccz cB_sc2_c4
  s_add_u32 s30, s30, 1
  s_cmp_lt_u32 s30, 400000
  s_cbranch_scc1 cB_sc2_r4
  s_branch cB_abort
cB_sc2_retry:
  s_cmp_lg_u32 s62, 0
  s_cbranch_scc1 cB_sc2_cont
  s_waitcnt vmcnt(0) lgkmcnt(0)
cB_sc2_rv:
  buffer_load_dwordx4 v[8:11], v2, s[8:11], s20 offen offset:0 sc1
  buffer_load_dwordx4 v[12:15], v2, s[8:11], s20 offen offset:1024 sc1
  buffer_load_dwordx4 v[16:19], v2, s[8:11], s20 offen offset:2048 sc1
  buffer_load_dwordx4 v[20:23], v2, s[8:11], s20 offen offset:3072 sc1
  buffer_load_dwordx4 v[24:27], v2, s[8:11], s23 offen offset:0 sc1
  buffer_load_dwordx4 v[32:35], v2, s[8:11], s23 offen offset:1024 sc1
  buffer_load_dwordx4 v[28:31], v2, s[8:11], s23 offen offset:2048 sc1
  s_waitcnt vmcnt(0)
  v_max3_u32 v66, v8, v9, v10
  v_max3_u32 v66, v66, v11, v12
  v_max3_u32 v66, v66, v13, v14
  v_max3_u32 v66, v66, v15, v16
  v_max3_u32 v66, v66, v17, v18
  v_max3_u32 v66, v66, v19, v20
  v_max3_u32 v66, v66, v21, v22
  v_max3_u32 v66, v66, v23, v24
  v_max3_u32 v66, v66, v25, v26
  v_max3_u32 v66, v66, v27, v28
  v_max3_u32 v66, v66, v29, v30
  v_max3_u32 v66, v66, v31, v32
  v_max3_u32 v66, v66, v33, v34
  v_max_u32 v66, v66, v35
  v_cmp_eq_u32 vcc, -1, v66
  s_cbranch_vccz cB_sc2_rk
  s_add_u32 s30, s30, 1
  s_cmp_lt_u32 s30, 400000
  s_cbranch_scc1 cB_sc2_rv
  s_branch cB_abort
cB_sc2_rk:
  s_mov_b32 s62, 1
  s_add_u32 s31, s31, 0x100
cB_sc2_rz:
  v_mov_b32 v36, 0
  v_mov_b32 v37, 0
  v_mov_b32 v38, 0
  v_mov_b32 v39, 0
  v_mov_b32 v40, 0
  v_mov_b32 v41, 0
  v_mov_b32 v42, 0
  v_mov_b32 v43, 0
  v_mov_b32 v44, 0
  v_mov_b32 v45, 0
  v_mov_b32 v46, 0
  v_mov_b32 v47, 0
  v_mov_b32 v48, 0
  v_mov_b32 v49, 0
  v_mov_b32 v50, 0
  v_mov_b32 v51, 0
  v_mov_b32 v62, 0
  v_mov_b32 v63, 0
  v_mov_b32 v64, 0
  v_mov_b32 v65, 0
  v_mov_b32 v68, 0
  v_mov_b32 v69, 0
  v_mov_b32 v70, 0
  v_mov_b32 v71, 0
  v_mov_b32 v72, 0
  v_mov_b32 v73, 0
  v_mov_b32 v74, 0
  v_mov_b32 v75, 0
  v_mov_b32 v52, 0
  v_mov_b32 v53, 0
  v_mov_b32 v54, 0
  v_mov_b32 v55, 0
  v_mov_b32 v56, 0
  v_mov_b32 v57, 0
  v_mov_b32 v58, 0
  v_mov_b32 v59, 0
  s_nop 1
  s_branch cB_sc2_go
.p2align 6
cB_sc3_loop:
  s_mov_b32 s30, 0
  s_mov_b32 s62, 0
  s_setprio 3
  s_barrier
  buffer_load_dwordx4 v[20:23], v2, s[8:11], s20 offen offset:3072 sc1
  s_setprio 2
  buffer_load_dwordx4 v[8:11], v2, s[8:11], s20 offen offset:0 sc1
  s_setprio 1
  buffer_load_dwordx4 v[12:15], v2, s[8:11], s20 offen offset:1024 sc1
  s_setprio 0
  buffer_load_dwordx4 v[16:19], v2, s[8:11], s20 offen offset:2048 sc1
cB_sc3_go:
  s_waitcnt vmcnt(3)
  v_smfmac_f32_16x16x64_bf16 v[36:39], v[20:23], a[24:31], v3
  buffer_load_dwordx4 v[24:27], v2, s[8:11], s23 offen offset:0 sc1
  v_cmp_eq_u32 vcc, -1, v20
  v_smfmac_f32_16x16x64_bf16 v[40:43], v[20:23], a[80:87], v3
  v_smfmac_f32_16x16x64_bf16 v[44:47], v[20:23], a[136:143], v3
  buffer_load_dwordx4 v[28:31], v2, s[8:11], s23 offen offset:1024 sc1
  s_cbranch_vccnz cB_sc3_r0
  v_smfmac_f32_16x16x64_bf16 v[48:51], v[20:23], a[192:199], v3
  v_smfmac_f32_16x16x64_bf16 v[52:55], v[20:23], a[248:255], v3
  v_smfmac_f32_16x16x64_bf16 v[56:59], v[20:23], v[168:175], v3
  buffer_load_dwordx4 v[32:35], v2, s[8:11], s23 offen offset:2048 sc1
  v_smfmac_f32_16x16x64_bf16 v[62:65], v[20:23], v[224:231], v3
  s_waitcnt vmcnt(5)
  v_smfmac_f32_16x16x64_bf16 v[36:39], v[8:11], a[0:7], v3
  v_cmp_eq_u32 vcc, -1, v8
  v_smfmac_f32_16x16x64_bf16 v[40:43], v[8:11], a[56:63], v3
  v_smfmac_f32_16x16x64_bf16 v[44:47], v[8:11], a[112:119], v3
  s_cbranch_vccnz cB_sc3_r1
  v_smfmac_f32_16x16x64_bf16 v[48:51], v[8:11], a[168:175], v3
  v_smfmac_f32_16x16x64_bf16 v[52:55], v[8:11], a[224:231], v3
  v_smfmac_f32_16x16x64_bf16 v[56:59], v[8:11], v[144:151], v3
  buffer_load_dwordx4 v[88:91], v117, s[8:11], s26 offen offset:0 sc1
  v_smfmac_f32_16x16x64_bf16 v[62:65], v[8:11], v[200:207], v3
  s_waitcnt vmcnt(5)
  v_smfmac_f32_16x16x64_bf16 v[36:39], v[12:15], a[8:15], v3
  v_cmp_eq_u32 vcc, -1, v12
  v_smfmac_f32_16x16x64_bf16 v[40:43], v[12:15], a[64:71], v3
  v_smfmac_f32_16x16x64_bf16 v[44:47], v[12:15], a[120:127], v3
  s_cbranch_vccnz cB_sc3_r2
  buffer_load_dwordx4 v[92:95], v117, s[8:11], s26 offen offset:1024 sc1
  v_smfmac_f32_16x16x64_bf16 v[48:51], v[12:15], a[176:183], v3
  v_smfmac_f32_16x16x64_bf16 v[52:55], v[12:15], a[232:239], v3
  v_smfmac_f32_16x16x64_bf16 v[56:59], v[12:15], v[152:159], v3
  v_smfmac_f32_16x16x64_bf16 v[62:65], v[12:15], v[208:215], v3
  s_waitcnt vmcnt(5)
  buffer_load_dwordx4 v[96:99], v2, s[8:11], s24 offen offset:0 sc1
  v_smfmac_f32_16x16x64_bf16 v[36:39], v[16:19], a[16:23], v3
  v_cmp_eq_u32 vcc, -1, v16
  v_smfmac_f32_16x16x64_bf16 v[40:43], v[16:19], a[72:79], v3
  s_waitcnt vmcnt(3)
  v_max3_u32 v66, v24, v27, v28
  v_smfmac_f32_16x16x64_bf16 v[44:47], v[16:19], a[128:135], v3
  s_cbranch_vccnz cB_sc3_r3
  v_max3_u32 v66, v66, v31, v32
  v_smfmac_f32_16x16x64_bf16 v[48:51], v[16:19], a[184:191], v3
  buffer_load_dwordx4 v[100:103], v2, s[8:11], s24 offen offset:1024 sc1
  v_max_u32 v66, v66, v35
  v_smfmac_f32_16x16x64_bf16 v[52:55], v[16:19], a[240:247], v3
  v_cmp_eq_u32 vcc, -1, v66
  v_smfmac_f32_16x16x64_bf16 v[56:59], v[16:19], v[160:167], v3
  v_smfmac_f32_16x16x64_bf16 v[62:65], v[16:19], v[216:223], v3
  s_cbranch_vccnz cB_sc3_r4
cB_sc3_c4:
  v_smfmac_f32_16x16x64_bf16 v[62:65], v[24:27], v[232:239], v3
  buffer_load_dwordx4 v[104:107], v2, s[8:11], s26 offen offset:0 sc1
  v_smfmac_f32_16x16x64_bf16 v[62:65], v[28:31], v[240:247], v3
  v_smfmac_f32_16x16x64_bf16 v[62:65], v[32:35], v[248:255], v3
  v_smfmac_f32_16x16x64_bf16 v[52:55], v[24:27], v[120:127], v3
  v_smfmac_f32_16x16x64_bf16 v[52:55], v[28:31], v[128:135], v3
  buffer_load_dwordx4 v[108:111], v2, s[8:11], s26 offen offset:1024 sc1
  v_smfmac_f32_16x16x64_bf16 v[52:55], v[32:35], v[136:143], v3
  v_cvt_pk_bf16_f32 v62, v62, v63
  v_smfmac_f32_16x16x64_bf16 v[56:59], v[24:27], v[176:183], v3
  v_cvt_pk_bf16_f32 v63, v64, v65
  v_smfmac_f32_16x16x64_bf16 v[56:59], v[28:31], v[184:191], v3
  v_mfma_f32_16x16x32_bf16 v[8:11], v[60:63], v[4:7], 0
  v_cvt_pk_bf16_f32 v55, v54, v55
  v_smfmac_f32_16x16x64_bf16 v[56:59], v[32:35], v[192:199], v3
  v_cvt_pk_bf16_f32 v54, v52, v53
  v_smfmac_f32_16x16x64_bf16 v[36:39], v[24:27], a[32:39], v3
  s_nop 1
  v_cvt_pk_bf16_f32 v78, v8, v9
  v_smfmac_f32_16x16x64_bf16 v[36:39], v[28:31], a[40:47], v3
  v_cvt_pk_bf16_f32 v79, v10, v11
  v_smfmac_f32_16x16x64_bf16 v[36:39], v[32:35], a[48:55], v3
  v_cvt_pk_bf16_f32 v56, v56, v57
  v_smfmac_f32_16x16x64_bf16 v[40:43], v[24:27], a[88:95], v3
  v_cvt_pk_bf16_f32 v57, v58, v59
  v_smfmac_f32_16x16x64_bf16 v[40:43], v[28:31], a[96:103], v3
  v_mfma_f32_16x16x32_bf16 v[12:15], v[54:57], v[4:7], 0
  v_cvt_pk_bf16_f32 v39, v38, v39
  v_smfmac_f32_16x16x64_bf16 v[40:43], v[32:35], a[104:111], v3
  v_cvt_pk_bf16_f32 v38, v36, v37
  v_smfmac_f32_16x16x64_bf16 v[44:47], v[24:27], a[144:151], v3
  s_nop 1
  v_cvt_pk_bf16_f32 v76, v12, v13
  v_smfmac_f32_16x16x64_bf16 v[44:47], v[28:31], a[152:159], v3
  v_cvt_pk_bf16_f32 v77, v14, v15
  v_smfmac_f32_16x16x64_bf16 v[44:47], v[32:35], a[160:167], v3
  v_cvt_pk_bf16_f32 v40, v40, v41
  v_smfmac_f32_16x16x64_bf16 v[48:51], v[24:27], a[200:207], v3
  v_cvt_pk_bf16_f32 v41, v42, v43
  v_smfmac_f32_16x16x64_bf16 v[48:51], v[28:31], a[208:215], v3
  v_smfmac_f32_16x16x64_bf16 v[48:51], v[32:35], a[216:223], v3
  s_waitcnt vmcnt(4)
  v_cvt_pk_bf16_f32 v47, v46, v47
  v_smfmac_f32_16x16x64_bf16 v[68:71], v[76:79], v[80:87], v3
  v_cvt_pk_bf16_f32 v46, v44, v45
  v_mfma_f32_16x16x32_bf16 v[8:11], v[38:41], v[4:7], 0
  s_nop 1
  v_cvt_pk_bf16_f32 v48, v48, v49
  v_cvt_pk_bf16_f32 v49, v50, v51
  s_nop 1
  v_mfma_f32_16x16x32_bf16 v[12:15], v[46:49], v[4:7], 0
  v_smfmac_f32_16x16x64_bf16 v[72:75], v[76:79], v[88:95], v3
  v_cvt_pk_bf16_f32 v16, v8, v9
  v_mfma_f32_16x16x32_bf16 v[52:55], v[30:33], v[76:79], 0
  s_waitcnt vmcnt(0)
  v_cvt_pk_bf16_f32 v17, v10, v11
  v_cvt_pk_bf16_f32 v18, v12, v13
  v_cvt_pk_bf16_f32 v19, v14, v15
  s_nop 1
  v_mfma_f32_16x16x32_bf16 v[52:55], v[20:23], v[16:19], v[52:55]
  v_smfmac_f32_16x16x64_bf16 v[68:71], v[16:19], v[96:103], v3
  v_smfmac_f32_16x16x64_bf16 v[72:75], v[16:19], v[104:111], v3
  s_nop 1
  ds_write_b128 v113, v[52:55]
  s_nop 1
  v_permlane32_swap_b32 v68, v70
  v_permlane32_swap_b32 v69, v71
  v_add_f32 v56, v68, v70
  v_add_f32 v58, v69, v71
  v_permlane32_swap_b32 v72, v74
  v_permlane32_swap_b32 v73, v75
  v_add_f32 v57, v72, v74
  v_add_f32 v59, v73, v75
  ds_write_b128 v2, v[56:59] offset:3072
  v_cmp_u_f32 vcc, v57, v59
  v_mov_b32 v68, 0
  v_mov_b32 v69, 0
  v_mov_b32 v70, 0
  v_mov_b32 v71, 0
  s_cbranch_vccnz cB_sc3_retry
cB_sc3_cont:
  s_add_u32 s24, s24, 28672
  s_add_u32 s26, s26, 28672
  buffer_load_dwordx4 v[80:83], v117, s[8:11], s24 offen offset:0 sc1
  buffer_load_dwordx4 v[84:87], v117, s[8:11], s24 offen offset:1024 sc1
  v_mov_b32 v72, 0
  v_mov_b32 v73, 0
  v_mfma_f32_16x16x32_bf16 v[62:65], v[68:71], v[68:71], 0
  s_waitcnt lgkmcnt(0)
  s_barrier
  v_mov_b32 v52, 0
  v_mov_b32 v53, 0
  v_mov_b32 v54, 0
  v_mov_b32 v55, 0
  v_mov_b32 v56, 0
  v_mov_b32 v57, 0
  v_mov_b32 v58, 0
  v_mov_b32 v59, 0
  v_mfma_f32_32x32x16_bf16 v[36:51], v[68:71], v[68:71], 0
  v_mov_b32 v74, 0
  v_mov_b32 v75, 0
  s_mov_b32 s19, s18
  s_add_u32 s18, s18, 1
  s_mov_b32 s22, s20
  s_mov_b32 s20, s21
  s_mov_b32 s21, s22
  s_add_u32 s23, s20, 4096
  s_cmp_lt_u32 s19, 63
  s_nop 2
  s_cbranch_scc1 cB_sc3_loop
  s_branch cB_done
cB_sc3_r0:
  s_add_u32 s31, s31, 1
  buffer_load_dwordx4 v[20:23], v2, s[8:11], s20 offen offset:3072 sc1
  s_waitcnt vmcnt(0)
  v_cmp_eq_u32 vcc, -1, v20
  v_mov_b32 v36, 0
  v_mov_b32 v37, 0
  v_mov_b32 v38, 0
  v_mov_b32 v39, 0
  v_mov_b32 v40, 0
  v_mov_b32 v41, 0
  v_mov_b32 v42, 0
  v_mov_b32 v43, 0
  v_mov_b32 v44, 0
  v_mov_b32 v45, 0
  v_mov_b32 v46, 0
  v_mov_b32 v47, 0
  v_mov_b32 v48, 0
  v_mov_b32 v49, 0
  v_mov_b32 v50, 0
  v_mov_b32 v51, 0
  s_nop 1
  s_cbranch_vccz cB_sc3_go
  s_add_u32 s30, s30, 1
  s_cmp_lt_u32 s30, 400000
  s_cbranch_scc1 cB_sc3_r0
  s_branch cB_abort
cB_sc3_r1:
  s_add_u32 s31, s31, 1
  buffer_load_dwordx4 v[8:11], v2, s[8:11], s20 offen offset:0 sc1
  s_waitcnt vmcnt(0)
  v_cmp_eq_u32 vcc, -1, v8
  s_nop 4
  s_cbranch_vccz cB_sc3_rz
  s_add_u32 s30, s30, 1
  s_cmp_lt_u32 s30, 400000
  s_cbranch_scc1 cB_sc3_r1
  s_branch cB_abort
cB_sc3_r2:
  s_add_u32 s31, s31, 1
  buffer_load_dwordx4 v[12:15], v2, s[8:11], s20 offen offset:1024 sc1
  s_waitcnt vmcnt(0)
  v_cmp_eq_u32 vcc, -1, v12
  s_nop 4
  s_cbranch_vccz cB_sc3_rz
  s_add_u32 s30, s30, 1
  s_cmp_lt_u32 s30, 400000
  s_cbranch_scc1 cB_sc3_r2
  s_branch cB_abort
cB_sc3_r3:
  s_add_u32 s31, s31, 1
  buffer_load_dwordx4 v[16:19], v2, s[8:11], s20 offen offset:2048 sc1
  s_waitcnt vmcnt(0)
  v_cmp_eq_u32 vcc, -1, v16
  s_nop 4
  s_cbranch_vccz cB_sc3_rz
  s_add_u32 s30, s30, 1
  s_cmp_lt_u32 s30, 400000
  s_cbranch_scc1 cB_sc3_r3
  s_branch cB_abort
cB_sc3_r4:
  s_add_u32 s31, s31, 1
  buffer_load_dwordx4 v[24:27], v2, s[8:11], s23 offen offset:0 sc1
  buffer_load_dwordx4 v[28:31], v2, s[8:11], s23 offen offset:1024 sc1
  buffer_load_dwordx4 v[32:35], v2, s[8:11], s23 offen offset:2048 sc1
  s_waitcnt vmcnt(0)
  v_max3_u32 v66, v24, v27, v28
  v_max3_u32 v66, v66, v31, v32
  v_max_u32 v66, v66, v35
  v_cmp_eq_u32 vcc, -1, v66
  s_nop 4
  s_cbranch_vccz cB_sc3_c4
  s_add_u32 s30, s30, 1
  s_cmp_lt_u32 s30, 400000
  s_cbranch_scc1 cB_sc3_r4
  s_branch cB_abort
cB_sc3_retry:
  s_cmp_lg_u32 s62, 0
  s_cbranch_scc1 cB_sc3_cont
  s_waitcnt vmcnt(0) lgkmcnt(0)
cB_sc3_rv:
  buffer_load_dwordx4 v[8:11], v2, s[8:11], s20 offen offset:0 sc1
  buffer_load_dwordx4 v[12:15], v2, s[8:11], s20 offen offset:1024 sc1
  buffer_load_dwordx4 v[16:19], v2, s[8:11], s20 offen offset:2048 sc1
  buffer_load_dwordx4 v[20:23], v2, s[8:11], s20 offen offset:3072 sc1
  buffer_load_dwordx4 v[24:27], v2, s[8:11], s23 offen offset:0 sc1
  buffer_load_dwordx4 v[28:31], v2, s[8:11], s23 offen offset:1024 sc1
  buffer_load_dwordx4 v[32:35], v2, s[8:11], s23 offen offset:2048 sc1
  s_waitcnt vmcnt(0)
  v_max3_u32 v66, v8, v9, v10
  v_max3_u32 v66, v66, v11, v12
  v_max3_u32 v66, v66, v13, v14
  v_max3_u32 v66, v66, v15, v16
  v_max3_u32 v66, v66, v17, v18
  v_max3_u32 v66, v66, v19, v20
  v_max3_u32 v66, v66, v21, v22
  v_max3_u32 v66, v66, v23, v24
  v_max3_u32 v66, v66, v25, v26
  v_max3_u32 v66, v66, v27, v28
  v_max3_u32 v66, v66, v29, v30
  v_max3_u32 v66, v66, v31, v32
  v_max3_u32 v66, v66, v33, v34
  v_max_u32 v66, v66, v35
  v_cmp_eq_u32 vcc, -1, v66
  s_cbranch_vccz cB_sc3_rk
  s_add_u32 s30, s30, 1
  s_cmp_lt_u32 s30, 400000
  s_cbranch_scc1 cB_sc3_rv
  s_branch cB_abort
cB_sc3_rk:
  s_mov_b32 s62, 1
  s_add_u32 s31, s31, 0x100
cB_sc3_rz:
  v_mov_b32 v36, 0
  v_mov_b32 v37, 0
  v_mov_b32 v38, 0
  v_mov_b32 v39, 0
  v_mov_b32 v40, 0
  v_mov_b32 v41, 0
  v_mov_b32 v42, 0
  v_mov_b32 v43, 0
  v_mov_b32 v44, 0
  v_mov_b32 v45, 0
  v_mov_b32 v46, 0
  v_mov_b32 v47, 0
  v_mov_b32 v48, 0
  v_mov_b32 v49, 0
  v_mov_b32 v50, 0
  v_mov_b32 v51, 0
  v_mov_b32 v62, 0
  v_mov_b32 v63, 0
  v_mov_b32 v64, 0
  v_mov_b32 v65, 0
  v_mov_b32 v68, 0
  v_mov_b32 v69, 0
  v_mov_b32 v70, 0
  v_mov_b32 v71, 0
  v_mov_b32 v72, 0
  v_mov_b32 v73, 0
  v_mov_b32 v74, 0
  v_mov_b32 v75, 0
  v_mov_b32 v52, 0
  v_mov_b32 v53, 0
  v_mov_b32 v54, 0
  v_mov_b32 v55, 0
  v_mov_b32 v56, 0
  v_mov_b32 v57, 0
  v_mov_b32 v58, 0
  v_mov_b32 v59, 0
  s_nop 1
  s_branch cB_sc3_go
.p2align 6
cB_va0_loop:
  s_mov_b32 s30, 0
  s_barrier
  buffer_load_dwordx4 v[24:27], v2, s[8:11], s23 offen offset:0 sc1
  buffer_load_dwordx4 v[28:31], v2, s[8:11], s23 offen offset:1024 sc1
  s_barrier
  s_cmp_lt_u32 s19, 60
  s_cbranch_scc1 cB_va0_m1
  buffer_store_dword v160, v1, s[8:11], s38 offen sc1
  s_cmp_lg_u32 s19, 63
  s_cbranch_scc1 cB_va0_m2
  v_min_u32 v64, -2, v64
  v_min_u32 v65, -2, v65
  v_min_u32 v66, -2, v66
  v_min_u32 v67, -2, v67
  v_min_u32 v68, -2, v68
  v_min_u32 v69, -2, v69
  v_min_u32 v70, -2, v70
  v_min_u32 v71, -2, v71
  v_min_u32 v72, -2, v72
  v_min_u32 v73, -2, v73
  v_min_u32 v74, -2, v74
  v_min_u32 v75, -2, v75
  v_min_u32 v76, -2, v76
  v_min_u32 v77, -2, v77
  v_min_u32 v78, -2, v78
  v_min_u32 v79, -2, v79
  buffer_store_dwordx4 v[64:67], v2, s[8:11], s33 offen offset:0 sc1
  buffer_store_dwordx4 v[68:71], v2, s[8:11], s33 offen offset:2048 sc1
  s_add_u32 s33, s33, 4096
  buffer_store_dwordx4 v[72:75], v2, s[8:11], s33 offen offset:0 sc1
  buffer_store_dwordx4 v[76:79], v2, s[8:11], s33 offen offset:2048 sc1
  s_add_u32 s33, s33, 4096
  s_waitcnt vmcnt(5)
  s_branch cB_va0_m3
cB_va0_m1:
  buffer_store_dword v160, v1, s[8:11], s38 offen sc1
cB_va0_m2:
  s_add_u32 s22, s25, s80
  buffer_load_dwordx4 v[80:83], v6, s[8:11], s22 offen offset:0 sc1
  buffer_load_dwordx4 v[84:87], v6, s[8:11], s22 offen offset:1792 sc1
  s_add_u32 s22, s22, 3584
  buffer_load_dwordx4 v[88:91], v6, s[8:11], s22 offen offset:0 sc1
  buffer_load_dwordx4 v[92:95], v6, s[8:11], s22 offen offset:1792 sc1
  s_add_u32 s22, s25, s81
  buffer_load_dwordx4 v[96:99], v6, s[8:11], s22 offen offset:0 sc1
  s_mul_i32 s38, s18, 7168
  s_add_u32 s38, s38, 65536
  s_waitcnt vmcnt(6)
cB_va0_m3:
  ds_write_b128 v2, v[24:27] offset:12288
  ds_write_b128 v2, v[28:31] offset:13312
  v_smfmac_f32_16x16x64_bf16 v[36:39], v[24:27], a[32:39], v3
  buffer_load_dwordx4 v[100:103], v6, s[8:11], s22 offen offset:1792 sc1
  v_smfmac_f32_16x16x64_bf16 v[40:43], v[24:27], a[88:95], v3
  s_add_u32 s22, s22, 3584
  buffer_load_dwordx4 v[104:107], v6, s[8:11], s22 offen offset:0 sc1
  v_smfmac_f32_16x16x64_bf16 v[44:47], v[24:27], a[144:151], v3
  buffer_load_dwordx4 v[108:111], v6, s[8:11], s22 offen offset:1792 sc1
  v_smfmac_f32_16x16x64_bf16 v[48:51], v[24:27], a[200:207], v3
  s_add_u32 s22, s25, s82
  buffer_load_dwordx4 v[112:115], v6, s[8:11], s22 offen offset:0 sc1
  v_smfmac_f32_16x16x64_bf16 v[52:55], v[24:27], v[176:183], v3
  s_waitcnt lgkmcnt(0)
  s_barrier
  ds_read_b128 v[8:11], v2 offset:8192
  ds_read_b128 v[12:15], v2 offset:9216
  ds_read_b128 v[16:19], v2 offset:10240
  ds_read_b128 v[20:23], v2 offset:11264
  ds_read_b128 v[32:35], v2 offset:14336
  buffer_load_dwordx4 v[116:119], v6, s[8:11], s22 offen offset:1792 sc1
  v_smfmac_f32_16x16x64_bf16 v[56:59], v[24:27], v[232:239], v3
  s_add_u32 s22, s22, 3584
  buffer_load_dwordx4 v[120:123], v6, s[8:11], s22 offen offset:0 sc1
  v_smfmac_f32_16x16x64_bf16 v[36:39], v[28:31], a[40:47], v3
  buffer_load_dwordx4 v[124:127], v6, s[8:11], s22 offen offset:1792 sc1
  v_smfmac_f32_16x16x64_bf16 v[40:43], v[28:31], a[96:103], v3
  s_add_u32 s22, s25, s83
  buffer_load_dwordx4 v[128:131], v6, s[8:11], s22 offen offset:0 sc1
  v_smfmac_f32_16x16x64_bf16 v[44:47], v[28:31], a[152:159], v3
  buffer_load_dwordx4 v[132:135], v6, s[8:11], s22 offen offset:1792 sc1
  v_smfmac_f32_16x16x64_bf16 v[48:51], v[28:31], a[208:215], v3
  s_add_u32 s22, s22, 3584
  buffer_load_dwordx4 v[136:139], v6, s[8:11], s22 offen offset:0 sc1
  v_smfmac_f32_16x16x64_bf16 v[52:55], v[28:31], v[184:191], v3
  buffer_load_dwordx4 v[140:143], v6, s[8:11], s22 offen offset:1792 sc1
  v_smfmac_f32_16x16x64_bf16 v[56:59], v[28:31], v[240:247], v3
  s_waitcnt lgkmcnt(4)
  v_smfmac_f32_16x16x64_bf16 v[36:39], v[8:11], a[0:7], v3
  s_waitcnt lgkmcnt(3)
  v_smfmac_f32_16x16x64_bf16 v[36:39], v[12:15], a[8:15], v3
  s_waitcnt lgkmcnt(2)
  v_smfmac_f32_16x16x64_bf16 v[36:39], v[16:19], a[16:23], v3
  s_waitcnt lgkmcnt(1)
  v_smfmac_f32_16x16x64_bf16 v[36:39], v[20:23], a[24:31], v3
  s_waitcnt lgkmcnt(0)
  v_smfmac_f32_16x16x64_bf16 v[36:39], v[32:35], a[48:55], v3
  v_smfmac_f32_16x16x64_bf16 v[40:43], v[8:11], a[56:63], v3
  v_smfmac_f32_16x16x64_bf16 v[40:43], v[12:15], a[64:71], v3
  v_smfmac_f32_16x16x64_bf16 v[40:43], v[16:19], a[72:79], v3
  v_permlane32_swap_b32 v36, v38
  v_smfmac_f32_16x16x64_bf16 v[40:43], v[20:23], a[80:87], v3
  v_permlane32_swap_b32 v37, v39
  v_smfmac_f32_16x16x64_bf16 v[40:43], v[32:35], a[104:111], v3
  v_add_f32 v36, v36, v38
  v_smfmac_f32_16x16x64_bf16 v[44:47], v[8:11], a[112:119], v3
  v_add_f32 v37, v37, v39
  v_smfmac_f32_16x16x64_bf16 v[44:47], v[12:15], a[120:127], v3
  v_cmp_u_f32 vcc, v36, v37
  v_smfmac_f32_16x16x64_bf16 v[44:47], v[16:19], a[128:135], v3
  v_cvt_pk_bf16_f32 v38, v36, v37
  v_smfmac_f32_16x16x64_bf16 v[44:47], v[20:23], a[136:143], v3
  ds_write_b32 v152, v38
  s_cbranch_vccnz cB_va0_slow
  v_permlane32_swap_b32 v40, v42
  v_smfmac_f32_16x16x64_bf16 v[44:47], v[32:35], a[160:167], v3
  v_permlane32_swap_b32 v41, v43
  v_smfmac_f32_16x16x64_bf16 v[48:51], v[8:11], a[168:175], v3
  buffer_store_dword v162, v1, s[8:11], s21 offen sc1
  v_add_f32 v40, v40, v42
  v_smfmac_f32_16x16x64_bf16 v[48:51], v[12:15], a[176:183], v3
  v_add_f32 v41, v41, v43
  v_smfmac_f32_16x16x64_bf16 v[48:51], v[16:19], a[184:191], v3
  buffer_load_dword v164, v4, s[8:11], 0 offen sc1
  v_cvt_pk_bf16_f32 v42, v40, v41
  v_smfmac_f32_16x16x64_bf16 v[48:51], v[20:23], a[192:199], v3
  ds_write_b32 v153, v42
  v_permlane32_swap_b32 v44, v46
  v_smfmac_f32_16x16x64_bf16 v[48:51], v[32:35], a[216:223], v3
  v_permlane32_swap_b32 v45, v47
  v_smfmac_f32_16x16x64_bf16 v[52:55], v[8:11], a[224:231], v3
  buffer_load_dword v164, v4, s[8:11], 0 offen sc1
  v_add_f32 v44, v44, v46
  v_smfmac_f32_16x16x64_bf16 v[52:55], v[12:15], a[232:239], v3
  v_add_f32 v45, v45, v47
  v_smfmac_f32_16x16x64_bf16 v[52:55], v[16:19], a[240:247], v3
  v_cvt_pk_bf16_f32 v46, v44, v45
  v_smfmac_f32_16x16x64_bf16 v[52:55], v[20:23], a[248:255], v3
  ds_write_b32 v154, v46
  buffer_load_dword v164, v4, s[8:11], 0 offen sc1
  v_permlane32_swap_b32 v48, v50
  v_smfmac_f32_16x16x64_bf16 v[52:55], v[32:35], v[192:199], v3
  v_permlane32_swap_b32 v49, v51
  v_smfmac_f32_16x16x64_bf16 v[56:59], v[8:11], v[200:207], v3
  v_add_f32 v48, v48, v50
  v_smfmac_f32_16x16x64_bf16 v[56:59], v[12:15], v[208:215], v3
  buffer_load_dword v164, v4, s[8:11], 0 offen sc1
  v_add_f32 v49, v49, v51
  v_smfmac_f32_16x16x64_bf16 v[56:59], v[16:19], v[216:223], v3
  v_cvt_pk_bf16_f32 v50, v48, v49
  v_smfmac_f32_16x16x64_bf16 v[56:59], v[20:23], v[224:231], v3
  ds_write_b32 v155, v50
  v_permlane32_swap_b32 v52, v54
  v_smfmac_f32_16x16x64_bf16 v[56:59], v[32:35], v[248:255], v3
  buffer_load_dword v164, v4, s[8:11], 0 offen sc1
  v_permlane32_swap_b32 v53, v55
  v_add_f32 v52, v52, v54
  v_add_f32 v53, v53, v55
  v_cvt_pk_bf16_f32 v54, v52, v53
  ds_write_b32 v156, v54
  s_nop 1
  v_permlane32_swap_b32 v56, v58
  v_permlane32_swap_b32 v57, v59
  v_add_f32 v56, v56, v58
  v_add_f32 v57, v57, v59
  v_cvt_pk_bf16_f32 v58, v56, v57
  ds_write_b32 v157, v58
cB_va0_t2d:
  s_add_u32 s72, s20, s76
  s_add_u32 s73, s20, s77
  s_add_u32 s74, s20, s78
  s_add_u32 s75, s20, s79
  s_add_u32 s22, s20, 9216
  s_add_u32 s34, s20, 13312
  s_add_u32 s36, s20, 7168
  s_mov_b32 s37, 0
  v_mov_b32 v48, 0
  v_mov_b32 v49, 0
  v_mov_b32 v50, 0
  v_mov_b32 v51, 0
  v_mov_b32 v163, s18
  s_cmp_eq_u32 s19, 63
  s_waitcnt lgkmcnt(0)
  s_cbranch_scc1 cB_va0_last
  s_setprio 3
cB_va0_fw_l:
  v_cmp_gt_u32 vcc, s18, v164
  buffer_load_dword v164, v4, s[8:11], 0 offen sc1
  s_cbranch_vccz cB_va0_fw_d
  v_cmp_gt_u32 vcc, s18, v164
  buffer_load_dword v164, v4, s[8:11], 0 offen sc1
  s_cbranch_vccz cB_va0_fw_d
  v_cmp_gt_u32 vcc, s18, v164
  buffer_load_dword v164, v4, s[8:11], 0 offen sc1
  s_cbranch_vccz cB_va0_fw_d
  v_cmp_gt_u32 vcc, s18, v164
  buffer_load_dword v164, v4, s[8:11], 0 offen sc1
  s_cbranch_vccz cB_va0_fw_d
  v_cmp_gt_u32 vcc, s18, v164
  buffer_load_dword v164, v4, s[8:11], 0 offen sc1
  s_cbranch_vccz cB_va0_fw_d
  v_cmp_gt_u32 vcc, s18, v164
  buffer_load_dword v164, v4, s[8:11], 0 offen sc1
  s_cbranch_vccz cB_va0_fw_d
  v_cmp_gt_u32 vcc, s18, v164
  buffer_load_dword v164, v4, s[8:11], 0 offen sc1
  s_cbranch_vccz cB_va0_fw_d
  v_cmp_gt_u32 vcc, s18, v164
  buffer_load_dword v164, v4, s[8:11], 0 offen sc1
  s_cbranch_vccz cB_va0_fw_d
  v_cmp_gt_u32 vcc, s18, v164
  buffer_load_dword v164, v4, s[8:11], 0 offen sc1
  s_cbranch_vccz cB_va0_fw_d
  v_cmp_gt_u32 vcc, s18, v164
  buffer_load_dword v164, v4, s[8:11], 0 offen sc1
  s_cbranch_vccz cB_va0_fw_d
  v_cmp_gt_u32 vcc, s18, v164
  buffer_load_dword v164, v4, s[8:11], 0 offen sc1
  s_cbranch_vccz cB_va0_fw_d
  v_cmp_gt_u32 vcc, s18, v164
  buffer_load_dword v164, v4, s[8:11], 0 offen sc1
  s_cbranch_vccz cB_va0_fw_d
  v_cmp_gt_u32 vcc, s18, v164
  buffer_load_dword v164, v4, s[8:11], 0 offen sc1
  s_cbranch_vccz cB_va0_fw_d
  v_cmp_gt_u32 vcc, s18, v164
  buffer_load_dword v164, v4, s[8:11], 0 offen sc1
  s_cbranch_vccz cB_va0_fw_d
  v_cmp_gt_u32 vcc, s18, v164
  buffer_load_dword v164, v4, s[8:11], 0 offen sc1
  s_cbranch_vccz cB_va0_fw_d
  v_cmp_gt_u32 vcc, s18, v164
  buffer_load_dword v164, v4, s[8:11], 0 offen sc1
  s_cbranch_vccz cB_va0_fw_d
  s_waitcnt vmcnt(24)
  s_add_u32 s30, s30, 1
  s_cmp_lt_u32 s30, 400000
  s_cbranch_scc1 cB_va0_fw_l
  s_branch cB_abort
cB_va0_fw_d:
  buffer_load_dwordx4 v[8:11], v2, s[8:11], s72 offen offset:0 sc1
  buffer_load_dwordx4 v[12:15], v2, s[8:11], s72 offen offset:1024 sc1
  buffer_load_dwordx4 v[16:19], v2, s[8:11], s73 offen offset:0 sc1
  buffer_load_dwordx4 v[20:23], v2, s[8:11], s73 offen offset:1024 sc1
  buffer_load_dwordx4 v[24:27], v2, s[8:11], s74 offen offset:0 sc1
  buffer_load_dwordx4 v[28:31], v2, s[8:11], s74 offen offset:1024 sc1
  buffer_load_dwordx4 v[32:35], v2, s[8:11], s75 offen offset:0 sc1
  buffer_load_dwordx4 v[36:39], v2, s[8:11], s75 offen offset:1024 sc1
  buffer_load_dwordx4 v[40:43], v2, s[8:11], s36 offen offset:0 sc1
  buffer_load_dwordx4 v[44:47], v2, s[8:11], s36 offen offset:1024 sc1
  s_barrier
  ds_read_b128 v[64:67], v2 offset:0
  ds_read_b128 v[68:71], v2 offset:1024
  ds_read_b128 v[72:75], v2 offset:2048
  ds_read_b128 v[76:79], v2 offset:3072
cB_va0_lp:
  s_waitcnt vmcnt(9)
  v_smfmac_f32_16x16x64_bf16 v[48:51], v[8:11], v[80:87], v3
  s_waitcnt vmcnt(8)
  v_smfmac_f32_16x16x64_bf16 v[48:51], v[12:15], v[88:95], v3
  s_waitcnt vmcnt(7)
  v_smfmac_f32_16x16x64_bf16 v[48:51], v[16:19], v[96:103], v3
  s_waitcnt vmcnt(6)
  v_smfmac_f32_16x16x64_bf16 v[48:51], v[20:23], v[104:111], v3
  s_waitcnt vmcnt(5)
  v_smfmac_f32_16x16x64_bf16 v[48:51], v[24:27], v[112:119], v3
  s_waitcnt vmcnt(4)
  v_smfmac_f32_16x16x64_bf16 v[48:51], v[28:31], v[120:127], v3
  s_waitcnt vmcnt(3)
  v_smfmac_f32_16x16x64_bf16 v[48:51], v[32:35], v[128:135], v3
  s_waitcnt vmcnt(2)
  v_smfmac_f32_16x16x64_bf16 v[48:51], v[36:39], v[136:143], v3
  s_waitcnt vmcnt(1) lgkmcnt(0)
  v_smfmac_f32_16x16x64_bf16 v[48:51], v[40:43], v[64:71], v3
  s_waitcnt vmcnt(0)
  v_smfmac_f32_16x16x64_bf16 v[48:51], v[44:47], v[72:79], v3
  s_nop 7
  v_permlane32_swap_b32 v48, v50
  v_permlane32_swap_b32 v49, v51
  v_pk_add_f32 v[48:49], v[48:49], v[50:51]
  v_cvt_pk_bf16_f32 v160, v48, v49
  v_cmp_u_f32 vcc, v48, v49
  s_nop 0
  v_mov_b32_dpp v161, v160 quad_perm:[1,0,3,2] row_mask:0xf bank_mask:0xf
  v_perm_b32 v160, v161, v160, v5
  v_cndmask_b32 v161, v160, v162, vcc
  buffer_store_dword v161, v1, s[8:11], s21 offen sc1
  s_cbranch_vccnz cB_va0_rp
cB_va0_cont:
  s_setprio 0
  s_cmp_lg_u32 s19, 62
  s_cbranch_scc1 cB_va0_nl
  s_mov_b32 s25, 0x40000000
cB_va0_nl:
  s_add_u32 s25, s25, 458752
  v_mov_b32 v36, 0
  v_mov_b32 v37, 0
  v_mov_b32 v38, 0
  v_mov_b32 v39, 0
  v_mov_b32 v40, 0
  v_mov_b32 v41, 0
  v_mov_b32 v42, 0
  v_mov_b32 v43, 0
  v_mov_b32 v44, 0
  v_mov_b32 v45, 0
  v_mov_b32 v46, 0
  v_mov_b32 v47, 0
  v_mov_b32 v48, 0
  v_mov_b32 v49, 0
  v_mov_b32 v50, 0
  v_mov_b32 v51, 0
  v_mov_b32 v52, 0
  v_mov_b32 v53, 0
  v_mov_b32 v54, 0
  v_mov_b32 v55, 0
  v_mov_b32 v56, 0
  v_mov_b32 v57, 0
  v_mov_b32 v58, 0
  v_mov_b32 v59, 0
  v_mov_b32 v60, 0
  v_mov_b32 v61, 0
  v_mov_b32 v62, 0
  v_mov_b32 v63, 0
  s_mov_b32 s19, s18
  s_add_u32 s18, s18, 1
  s_mov_b32 s22, s20
  s_mov_b32 s20, s21
  s_mov_b32 s21, s22
  s_add_u32 s23, s20, 4096
  s_branch cB_va0_loop
cB_va0_slow:
  s_waitcnt lgkmcnt(0)
cB_va0_sl1:
  s_add_u32 s31, s31, 0x1000000
  buffer_load_dwordx4 v[8:11], v2, s[8:11], s20 offen offset:0 sc1
  buffer_load_dwordx4 v[12:15], v2, s[8:11], s20 offen offset:1024 sc1
  buffer_load_dwordx4 v[16:19], v2, s[8:11], s20 offen offset:2048 sc1
  buffer_load_dwordx4 v[20:23], v2, s[8:11], s20 offen offset:3072 sc1
  buffer_load_dwordx4 v[24:27], v2, s[8:11], s23 offen offset:0 sc1
  buffer_load_dwordx4 v[28:31], v2, s[8:11], s23 offen offset:1024 sc1
  buffer_load_dwordx4 v[32:35], v2, s[8:11], s23 offen offset:2048 sc1
  s_waitcnt vmcnt(0)
  v_max3_u32 v36, v8, v9, v10
  v_max3_u32 v36, v36, v11, v12
  v_max3_u32 v36, v36, v13, v14
  v_max3_u32 v36, v36, v15, v16
  v_max3_u32 v36, v36, v17, v18
  v_max3_u32 v36, v36, v19, v20
  v_max3_u32 v36, v36, v21, v22
  v_max3_u32 v36, v36, v23, v24
  v_max3_u32 v36, v36, v25, v26
  v_max3_u32 v36, v36, v27, v28
  v_max3_u32 v36, v36, v29, v30
  v_max3_u32 v36, v36, v31, v32
  v_max3_u32 v36, v36, v33, v34
  v_max_u32 v36, v36, v35
  v_cmp_eq_u32 vcc, -1, v36
  s_cbranch_vccz cB_va0_sl2
  s_add_u32 s30, s30, 1
  s_cmp_lt_u32 s30, 400000
  s_cbranch_scc1 cB_va0_sl1
  s_branch cB_abort
cB_va0_sl2:
  v_mov_b32 v36, 0
  v_mov_b32 v37, 0
  v_mov_b32 v38, 0
  v_mov_b32 v39, 0
  v_mov_b32 v40, 0
  v_mov_b32 v41, 0
  v_mov_b32 v42, 0
  v_mov_b32 v43, 0
  v_mov_b32 v44, 0
  v_mov_b32 v45, 0
  v_mov_b32 v46, 0
  v_mov_b32 v47, 0
  v_mov_b32 v48, 0
  v_mov_b32 v49, 0
  v_mov_b32 v50, 0
  v_mov_b32 v51, 0
  v_mov_b32 v52, 0
  v_mov_b32 v53, 0
  v_mov_b32 v54, 0
  v_mov_b32 v55, 0
  v_mov_b32 v56, 0
  v_mov_b32 v57, 0
  v_mov_b32 v58, 0
  v_mov_b32 v59, 0
  v_mov_b32 v60, 0
  v_mov_b32 v61, 0
  v_mov_b32 v62, 0
  v_mov_b32 v63, 0
  buffer_store_dword v162, v1, s[8:11], s21 offen sc1
  v_smfmac_f32_16x16x64_bf16 v[36:39], v[8:11], a[0:7], v3
  v_smfmac_f32_16x16x64_bf16 v[40:43], v[8:11], a[56:63], v3
  v_smfmac_f32_16x16x64_bf16 v[44:47], v[8:11], a[112:119], v3
  v_smfmac_f32_16x16x64_bf16 v[48:51], v[8:11], a[168:175], v3
  v_smfmac_f32_16x16x64_bf16 v[52:55], v[8:11], a[224:231], v3
  v_smfmac_f32_16x16x64_bf16 v[56:59], v[8:11], v[200:207], v3
  v_smfmac_f32_16x16x64_bf16 v[36:39], v[12:15], a[8:15], v3
  v_smfmac_f32_16x16x64_bf16 v[40:43], v[12:15], a[64:71], v3
  v_smfmac_f32_16x16x64_bf16 v[44:47], v[12:15], a[120:127], v3
  v_smfmac_f32_16x16x64_bf16 v[48:51], v[12:15], a[176:183], v3
  v_smfmac_f32_16x16x64_bf16 v[52:55], v[12:15], a[232:239], v3
  v_smfmac_f32_16x16x64_bf16 v[56:59], v[12:15], v[208:215], v3
  v_smfmac_f32_16x16x64_bf16 v[36:39], v[16:19], a[16:23], v3
  v_smfmac_f32_16x16x64_bf16 v[40:43], v[16:19], a[72:79], v3
  v_smfmac_f32_16x16x64_bf16 v[44:47], v[16:19], a[128:135], v3
  v_smfmac_f32_16x16x64_bf16 v[48:51], v[16:19], a[184:191], v3
  v_smfmac_f32_16x16x64_bf16 v[52:55], v[16:19], a[240:247], v3
  v_smfmac_f32_16x16x64_bf16 v[56:59], v[16:19], v[216:223], v3
  v_smfmac_f32_16x16x64_bf16 v[36:39], v[20:23], a[24:31], v3
  v_smfmac_f32_16x16x64_bf16 v[40:43], v[20:23], a[80:87], v3
  v_smfmac_f32_16x16x64_bf16 v[44:47], v[20:23], a[136:143], v3
  v_smfmac_f32_16x16x64_bf16 v[48:51], v[20:23], a[192:199], v3
  v_smfmac_f32_16x16x64_bf16 v[52:55], v[20:23], a[248:255], v3
  v_smfmac_f32_16x16x64_bf16 v[56:59], v[20:23], v[224:231], v3
  v_smfmac_f32_16x16x64_bf16 v[36:39], v[24:27], a[32:39], v3
  v_smfmac_f32_16x16x64_bf16 v[40:43], v[24:27], a[88:95], v3
  v_smfmac_f32_16x16x64_bf16 v[44:47], v[24:27], a[144:151], v3
  v_smfmac_f32_16x16x64_bf16 v[48:51], v[24:27], a[200:207], v3
  v_smfmac_f32_16x16x64_bf16 v[52:55], v[24:27], v[176:183], v3
  v_smfmac_f32_16x16x64_bf16 v[56:59], v[24:27], v[232:239], v3
  v_smfmac_f32_16x16x64_bf16 v[36:39], v[28:31], a[40:47], v3
  v_smfmac_f32_16x16x64_bf16 v[40:43], v[28:31], a[96:103], v3
  v_smfmac_f32_16x16x64_bf16 v[44:47], v[28:31], a[152:159], v3
  v_smfmac_f32_16x16x64_bf16 v[48:51], v[28:31], a[208:215], v3
  v_smfmac_f32_16x16x64_bf16 v[52:55], v[28:31], v[184:191], v3
  v_smfmac_f32_16x16x64_bf16 v[56:59], v[28:31], v[240:247], v3
  v_smfmac_f32_16x16x64_bf16 v[36:39], v[32:35], a[48:55], v3
  v_smfmac_f32_16x16x64_bf16 v[40:43], v[32:35], a[104:111], v3
  v_smfmac_f32_16x16x64_bf16 v[44:47], v[32:35], a[160:167], v3
  v_smfmac_f32_16x16x64_bf16 v[48:51], v[32:35], a[216:223], v3
  v_smfmac_f32_16x16x64_bf16 v[52:55], v[32:35], v[192:199], v3
  v_smfmac_f32_16x16x64_bf16 v[56:59], v[32:35], v[248:255], v3
  v_permlane32_swap_b32 v36, v38
  v_permlane32_swap_b32 v37, v39
  v_add_f32 v36, v36, v38
  v_add_f32 v37, v37, v39
  v_cvt_pk_bf16_f32 v38, v36, v37
  ds_write_b32 v152, v38
  v_permlane32_swap_b32 v40, v42
  v_permlane32_swap_b32 v41, v43
  v_add_f32 v40, v40, v42
  v_add_f32 v41, v41, v43
  v_cvt_pk_bf16_f32 v42, v40, v41
  ds_write_b32 v153, v42
  v_permlane32_swap_b32 v44, v46
  v_permlane32_swap_b32 v45, v47
  v_add_f32 v44, v44, v46
  v_add_f32 v45, v45, v47
  v_cvt_pk_bf16_f32 v46, v44, v45
  ds_write_b32 v154, v46
  v_permlane32_swap_b32 v48, v50
  v_permlane32_swap_b32 v49, v51
  v_add_f32 v48, v48, v50
  v_add_f32 v49, v49, v51
  v_cvt_pk_bf16_f32 v50, v48, v49
  ds_write_b32 v155, v50
  v_permlane32_swap_b32 v52, v54
  v_permlane32_swap_b32 v53, v55
  v_add_f32 v52, v52, v54
  v_add_f32 v53, v53, v55
  v_cvt_pk_bf16_f32 v54, v52, v53
  ds_write_b32 v156, v54
  v_permlane32_swap_b32 v56, v58
  v_permlane32_swap_b32 v57, v59
  v_add_f32 v56, v56, v58
  v_add_f32 v57, v57, v59
  v_cvt_pk_bf16_f32 v58, v56, v57
  ds_write_b32 v157, v58
  buffer_load_dword v164, v4, s[8:11], 0 offen sc1
  buffer_load_dword v164, v4, s[8:11], 0 offen sc1
  buffer_load_dword v164, v4, s[8:11], 0 offen sc1
  buffer_load_dword v164, v4, s[8:11], 0 offen sc1
  buffer_load_dword v164, v4, s[8:11], 0 offen sc1
  s_branch cB_va0_t2d
cB_va0_last:
  s_barrier
  ds_read_b128 v[64:67], v2 offset:0
  ds_read_b128 v[68:71], v2 offset:1024
  ds_read_b128 v[72:75], v2 offset:2048
  ds_read_b128 v[76:79], v2 offset:3072
  s_waitcnt lgkmcnt(0)
  v_min_u32 v64, -2, v64
  v_min_u32 v65, -2, v65
  v_min_u32 v66, -2, v66
  v_min_u32 v67, -2, v67
  v_min_u32 v68, -2, v68
  v_min_u32 v69, -2, v69
  v_min_u32 v70, -2, v70
  v_min_u32 v71, -2, v71
  v_min_u32 v72, -2, v72
  v_min_u32 v73, -2, v73
  v_min_u32 v74, -2, v74
  v_min_u32 v75, -2, v75
  v_min_u32 v76, -2, v76
  v_min_u32 v77, -2, v77
  v_min_u32 v78, -2, v78
  v_min_u32 v79, -2, v79
  buffer_store_dwordx4 v[64:67], v2, s[8:11], s33 offen offset:0 sc1
  buffer_store_dwordx4 v[68:71], v2, s[8:11], s33 offen offset:2048 sc1
  s_add_u32 s33, s33, 4096
  buffer_store_dwordx4 v[72:75], v2, s[8:11], s33 offen offset:0 sc1
  buffer_store_dwordx4 v[76:79], v2, s[8:11], s33 offen offset:2048 sc1
  s_add_u32 s33, s33, 4096
  s_cmp_lg_u32 s17, 0
  s_cbranch_scc1 cB_done
  s_waitcnt vmcnt(0)
  buffer_wbl2 sc1
  s_branch cB_done
cB_va0_rp:
  s_cmp_eq_u32 s37, 0
  s_cbranch_scc1 cB_va0_rv
  v_min_u32 v160, -2, v160
  buffer_store_dword v160, v1, s[8:11], s21 offen sc1
  s_branch cB_va0_cont
cB_va0_rv:
  s_add_u32 s31, s31, 0x10000
  buffer_load_dwordx4 v[8:11], v2, s[8:11], s72 offen offset:0 sc1
  buffer_load_dwordx4 v[12:15], v2, s[8:11], s72 offen offset:1024 sc1
  buffer_load_dwordx4 v[16:19], v2, s[8:11], s73 offen offset:0 sc1
  buffer_load_dwordx4 v[20:23], v2, s[8:11], s73 offen offset:1024 sc1
  buffer_load_dwordx4 v[24:27], v2, s[8:11], s74 offen offset:0 sc1
  buffer_load_dwordx4 v[28:31], v2, s[8:11], s74 offen offset:1024 sc1
  buffer_load_dwordx4 v[32:35], v2, s[8:11], s75 offen offset:0 sc1
  buffer_load_dwordx4 v[36:39], v2, s[8:11], s75 offen offset:1024 sc1
  buffer_load_dwordx4 v[40:43], v2, s[8:11], s36 offen offset:0 sc1
  buffer_load_dwordx4 v[44:47], v2, s[8:11], s36 offen offset:1024 sc1
  s_waitcnt vmcnt(0)
  v_max3_u32 v52, v8, v9, v10
  v_max3_u32 v52, v52, v11, v12
  v_max3_u32 v52, v52, v13, v14
  v_max3_u32 v52, v52, v15, v16
  v_max3_u32 v52, v52, v17, v18
  v_max3_u32 v52, v52, v19, v20
  v_max3_u32 v52, v52, v21, v22
  v_max3_u32 v52, v52, v23, v24
  v_max3_u32 v52, v52, v25, v26
  v_max3_u32 v52, v52, v27, v28
  v_max3_u32 v52, v52, v29, v30
  v_max3_u32 v52, v52, v31, v32
  v_max3_u32 v52, v52, v33, v34
  v_max3_u32 v52, v52, v35, v36
  v_max3_u32 v52, v52, v37, v38
  v_max3_u32 v52, v52, v39, v40
  v_max3_u32 v52, v52, v41, v42
  v_max3_u32 v52, v52, v43, v44
  v_max3_u32 v52, v52, v45, v46
  v_max_u32 v52, v52, v47
  v_cmp_eq_u32 vcc, -1, v52
  s_mov_b32 s37, 1
  v_mov_b32 v48, 0
  v_mov_b32 v49, 0
  v_mov_b32 v50, 0
  v_mov_b32 v51, 0
  s_nop 1
  s_cbranch_vccz cB_va0_lp
  s_add_u32 s30, s30, 1
  s_cmp_lt_u32 s30, 400000
  s_cbranch_scc1 cB_va0_rv
  s_branch cB_abort
.p2align 6
cB_va1_loop:
  s_mov_b32 s30, 0
  s_barrier
  buffer_load_dwordx4 v[28:31], v2, s[8:11], s23 offen offset:1024 sc1
  buffer_load_dwordx4 v[32:35], v2, s[8:11], s23 offen offset:2048 sc1
  s_barrier
  s_cmp_lt_u32 s19, 60
  s_cbranch_scc1 cB_va1_m1
  buffer_store_dword v160, v1, s[8:11], s38 offen sc1
  s_cmp_lg_u32 s19, 63
  s_cbranch_scc1 cB_va1_m2
  v_min_u32 v64, -2, v64
  v_min_u32 v65, -2, v65
  v_min_u32 v66, -2, v66
  v_min_u32 v67, -2, v67
  v_min_u32 v68, -2, v68
  v_min_u32 v69, -2, v69
  v_min_u32 v70, -2, v70
  v_min_u32 v71, -2, v71
  v_min_u32 v72, -2, v72
  v_min_u32 v73, -2, v73
  v_min_u32 v74, -2, v74
  v_min_u32 v75, -2, v75
  v_min_u32 v76, -2, v76
  v_min_u32 v77, -2, v77
  v_min_u32 v78, -2, v78
  v_min_u32 v79, -2, v79
  buffer_store_dwordx4 v[64:67], v2, s[8:11], s33 offen offset:0 sc1
  buffer_store_dwordx4 v[68:71], v2, s[8:11], s33 offen offset:2048 sc1
  s_add_u32 s33, s33, 4096
  buffer_store_dwordx4 v[72:75], v2, s[8:11], s33 offen offset:0 sc1
  buffer_store_dwordx4 v[76:79], v2, s[8:11], s33 offen offset:2048 sc1
  s_add_u32 s33, s33, 4096
  s_waitcnt vmcnt(5)
  s_branch cB_va1_m3
cB_va1_m1:
  buffer_store_dword v160, v1, s[8:11], s38 offen sc1
cB_va1_m2:
  s_add_u32 s22, s25, s80
  buffer_load_dwordx4 v[80:83], v6, s[8:11], s22 offen offset:0 sc1
  buffer_load_dwordx4 v[84:87], v6, s[8:11], s22 offen offset:1792 sc1
  s_add_u32 s22, s22, 3584
  buffer_load_dwordx4 v[88:91], v6, s[8:11], s22 offen offset:0 sc1
  buffer_load_dwordx4 v[92:95], v6, s[8:11], s22 offen offset:1792 sc1
  s_add_u32 s22, s25, s81
  buffer_load_dwordx4 v[96:99], v6, s[8:11], s22 offen offset:0 sc1
  s_mul_i32 s38, s18, 7168
  s_add_u32 s38, s38, 65536
  s_waitcnt vmcnt(6)
cB_va1_m3:
  ds_write_b128 v2, v[32:35] offset:14336
  v_smfmac_f32_16x16x64_bf16 v[36:39], v[28:31], a[40:47], v3
  buffer_load_dwordx4 v[100:103], v6, s[8:11], s22 offen offset:1792 sc1
  v_smfmac_f32_16x16x64_bf16 v[40:43], v[28:31], a[96:103], v3
  s_add_u32 s22, s22, 3584
  buffer_load_dwordx4 v[104:107], v6, s[8:11], s22 offen offset:0 sc1
  v_smfmac_f32_16x16x64_bf16 v[44:47], v[28:31], a[152:159], v3
  buffer_load_dwordx4 v[108:111], v6, s[8:11], s22 offen offset:1792 sc1
  v_smfmac_f32_16x16x64_bf16 v[48:51], v[28:31], a[208:215], v3
  s_add_u32 s22, s25, s82
  buffer_load_dwordx4 v[112:115], v6, s[8:11], s22 offen offset:0 sc1
  v_smfmac_f32_16x16x64_bf16 v[52:55], v[28:31], v[184:191], v3
  s_waitcnt lgkmcnt(0)
  s_barrier
  ds_read_b128 v[8:11], v2 offset:8192
  ds_read_b128 v[12:15], v2 offset:9216
  ds_read_b128 v[16:19], v2 offset:10240
  ds_read_b128 v[20:23], v2 offset:11264
  ds_read_b128 v[24:27], v2 offset:12288
  buffer_load_dwordx4 v[116:119], v6, s[8:11], s22 offen offset:1792 sc1
  v_smfmac_f32_16x16x64_bf16 v[56:59], v[28:31], v[240:247], v3
  s_add_u32 s22, s22, 3584
  buffer_load_dwordx4 v[120:123], v6, s[8:11], s22 offen offset:0 sc1
  v_smfmac_f32_16x16x64_bf16 v[36:39], v[32:35], a[48:55], v3
  buffer_load_dwordx4 v[124:127], v6, s[8:11], s22 offen offset:1792 sc1
  v_smfmac_f32_16x16x64_bf16 v[40:43], v[32:35], a[104:111], v3
  s_add_u32 s22, s25, s83
  buffer_load_dwordx4 v[128:131], v6, s[8:11], s22 offen offset:0 sc1
  v_smfmac_f32_16x16x64_bf16 v[44:47], v[32:35], a[160:167], v3
  buffer_load_dwordx4 v[132:135], v6, s[8:11], s22 offen offset:1792 sc1
  v_smfmac_f32_16x16x64_bf16 v[48:51], v[32:35], a[216:223], v3
  s_add_u32 s22, s22, 3584
  buffer_load_dwordx4 v[136:139], v6, s[8:11], s22 offen offset:0 sc1
  v_smfmac_f32_16x16x64_bf16 v[52:55], v[32:35], v[192:199], v3
  ds_read_b128 v[64:67], v0 offset:0
  ds_read_b128 v[68:71], v0 offset:1024
  buffer_load_dwordx4 v[140:143], v6, s[8:11], s22 offen offset:1792 sc1
  v_smfmac_f32_16x16x64_bf16 v[56:59], v[32:35], v[248:255], v3
  s_waitcnt lgkmcnt(6)
  ds_read_b128 v[72:75], v0 offset:2048
  ds_read_b128 v[76:79], v0 offset:3072
  v_smfmac_f32_16x16x64_bf16 v[36:39], v[8:11], a[0:7], v3
  s_waitcnt lgkmcnt(7)
  v_smfmac_f32_16x16x64_bf16 v[36:39], v[12:15], a[8:15], v3
  s_waitcnt lgkmcnt(6)
  v_smfmac_f32_16x16x64_bf16 v[36:39], v[16:19], a[16:23], v3
  s_waitcnt lgkmcnt(2)
  v_smfmac_f32_16x16x64_bf16 v[60:63], v[8:11], v[64:71], v3
  s_waitcnt lgkmcnt(5)
  ds_read_b128 v[144:147], v0 offset:4096
  ds_read_b128 v[148:151], v0 offset:5120
  v_smfmac_f32_16x16x64_bf16 v[36:39], v[20:23], a[24:31], v3
  s_waitcnt lgkmcnt(6)
  v_smfmac_f32_16x16x64_bf16 v[36:39], v[24:27], a[32:39], v3
  v_smfmac_f32_16x16x64_bf16 v[40:43], v[8:11], a[56:63], v3
  s_waitcnt lgkmcnt(2)
  v_smfmac_f32_16x16x64_bf16 v[60:63], v[12:15], v[72:79], v3
  ds_read_b128 v[64:67], v0 offset:6144
  ds_read_b128 v[68:71], v0 offset:7168
  v_smfmac_f32_16x16x64_bf16 v[40:43], v[12:15], a[64:71], v3
  v_permlane32_swap_b32 v36, v38
  v_smfmac_f32_16x16x64_bf16 v[40:43], v[16:19], a[72:79], v3
  v_permlane32_swap_b32 v37, v39
  v_smfmac_f32_16x16x64_bf16 v[40:43], v[20:23], a[80:87], v3
  s_waitcnt lgkmcnt(2)
  v_add_f32 v36, v36, v38
  v_smfmac_f32_16x16x64_bf16 v[60:63], v[16:19], v[144:151], v3
  ds_read_b128 v[72:75], v0 offset:8192
  ds_read_b128 v[76:79], v0 offset:9216
  v_add_f32 v37, v37, v39
  v_smfmac_f32_16x16x64_bf16 v[40:43], v[24:27], a[88:95], v3
  v_cmp_u_f32 vcc, v36, v37
  v_smfmac_f32_16x16x64_bf16 v[44:47], v[8:11], a[112:119], v3
  v_cvt_pk_bf16_f32 v38, v36, v37
  v_smfmac_f32_16x16x64_bf16 v[44:47], v[12:15], a[120:127], v3
  ds_write_b32 v152, v38
  s_waitcnt lgkmcnt(3)
  s_cbranch_vccnz cB_va1_slow
  v_permlane32_swap_b32 v40, v42
  v_smfmac_f32_16x16x64_bf16 v[60:63], v[20:23], v[64:71], v3
  ds_read_b128 v[144:147], v0 offset:10240
  ds_read_b128 v[148:151], v0 offset:11264
  v_permlane32_swap_b32 v41, v43
  v_smfmac_f32_16x16x64_bf16 v[44:47], v[16:19], a[128:135], v3
  buffer_store_dword v162, v1, s[8:11], s21 offen sc1
  v_add_f32 v40, v40, v42
  v_smfmac_f32_16x16x64_bf16 v[44:47], v[20:23], a[136:143], v3
  v_add_f32 v41, v41, v43
  v_smfmac_f32_16x16x64_bf16 v[44:47], v[24:27], a[144:151], v3
  s_waitcnt lgkmcnt(3)
  v_cvt_pk_bf16_f32 v42, v40, v41
  v_smfmac_f32_16x16x64_bf16 v[60:63], v[24:27], v[72:79], v3
  ds_write_b32 v153, v42
  ds_read_b128 v[64:67], v0 offset:12288
  ds_read_b128 v[68:71], v0 offset:13312
  v_smfmac_f32_16x16x64_bf16 v[48:51], v[8:11], a[168:175], v3
  s_nop 0
  v_permlane32_swap_b32 v44, v46
  v_smfmac_f32_16x16x64_bf16 v[48:51], v[12:15], a[176:183], v3
  v_permlane32_swap_b32 v45, v47
  v_smfmac_f32_16x16x64_bf16 v[48:51], v[16:19], a[184:191], v3
  s_waitcnt lgkmcnt(3)
  v_add_f32 v44, v44, v46
  v_smfmac_f32_16x16x64_bf16 v[60:63], v[28:31], v[144:151], v3
  v_add_f32 v45, v45, v47
  v_smfmac_f32_16x16x64_bf16 v[48:51], v[20:23], a[192:199], v3
  v_cvt_pk_bf16_f32 v46, v44, v45
  v_smfmac_f32_16x16x64_bf16 v[48:51], v[24:27], a[200:207], v3
  ds_write_b32 v154, v46
  v_smfmac_f32_16x16x64_bf16 v[52:55], v[8:11], a[224:231], v3
  s_waitcnt lgkmcnt(1)
  v_smfmac_f32_16x16x64_bf16 v[60:63], v[32:35], v[64:71], v3
  v_smfmac_f32_16x16x64_bf16 v[52:55], v[12:15], a[232:239], v3
  v_permlane32_swap_b32 v48, v50
  v_smfmac_f32_16x16x64_bf16 v[52:55], v[16:19], a[240:247], v3
  v_permlane32_swap_b32 v49, v51
  v_smfmac_f32_16x16x64_bf16 v[52:55], v[20:23], a[248:255], v3
  v_add_f32 v48, v48, v50
  v_smfmac_f32_16x16x64_bf16 v[52:55], v[24:27], v[176:183], v3
  v_add_f32 v49, v49, v51
  v_smfmac_f32_16x16x64_bf16 v[56:59], v[8:11], v[200:207], v3
  v_cvt_pk_bf16_f32 v50, v48, v49
  v_smfmac_f32_16x16x64_bf16 v[56:59], v[12:15], v[208:215], v3
  ds_write_b32 v155, v50
  v_permlane32_swap_b32 v60, v62
  v_smfmac_f32_16x16x64_bf16 v[56:59], v[16:19], v[216:223], v3
  v_permlane32_swap_b32 v61, v63
  v_smfmac_f32_16x16x64_bf16 v[56:59], v[20:23], v[224:231], v3
  v_add_f32 v60, v60, v62
  v_smfmac_f32_16x16x64_bf16 v[56:59], v[24:27], v[232:239], v3
  v_add_f32 v61, v61, v63
  v_cvt_pk_bf16_f32 v62, v60, v61
  ds_write_b32 v158, v62
  v_permlane32_swap_b32 v52, v54
  v_permlane32_swap_b32 v53, v55
  v_add_f32 v52, v52, v54
  v_add_f32 v53, v53, v55
  v_cvt_pk_bf16_f32 v54, v52, v53
  ds_write_b32 v156, v54
  v_permlane32_swap_b32 v56, v58
  v_permlane32_swap_b32 v57, v59
  v_add_f32 v56, v56, v58
  v_add_f32 v57, v57, v59
  v_cvt_pk_bf16_f32 v58, v56, v57
  ds_write_b32 v157, v58
cB_va1_t2d:
  s_add_u32 s72, s20, s76
  s_add_u32 s73, s20, s77
  s_add_u32 s74, s20, s78
  s_add_u32 s75, s20, s79
  s_add_u32 s22, s20, 9216
  s_add_u32 s34, s20, 13312
  s_add_u32 s36, s20, 7168
  s_mov_b32 s37, 0
  v_mov_b32 v48, 0
  v_mov_b32 v49, 0
  v_mov_b32 v50, 0
  v_mov_b32 v51, 0
  v_mov_b32 v163, s18
  s_cmp_eq_u32 s19, 63
  s_waitcnt lgkmcnt(0)
  s_cbranch_scc1 cB_va1_last
  s_barrier
  buffer_load_dwordx4 v[8:11], v2, s[8:11], s72 offen offset:0 sc1
  buffer_load_dwordx4 v[12:15], v2, s[8:11], s72 offen offset:1024 sc1
  buffer_load_dwordx4 v[16:19], v2, s[8:11], s73 offen offset:0 sc1
  buffer_load_dwordx4 v[20:23], v2, s[8:11], s73 offen offset:1024 sc1
  buffer_load_dwordx4 v[24:27], v2, s[8:11], s74 offen offset:0 sc1
  buffer_load_dwordx4 v[28:31], v2, s[8:11], s74 offen offset:1024 sc1
  buffer_load_dwordx4 v[32:35], v2, s[8:11], s75 offen offset:0 sc1
  buffer_load_dwordx4 v[36:39], v2, s[8:11], s75 offen offset:1024 sc1
  buffer_load_dwordx4 v[40:43], v2, s[8:11], s36 offen offset:0 sc1
  buffer_load_dwordx4 v[44:47], v2, s[8:11], s36 offen offset:1024 sc1
  ds_read_b128 v[64:67], v2 offset:4096
  ds_read_b128 v[68:71], v2 offset:5120
  ds_read_b128 v[72:75], v2 offset:6144
  ds_read_b128 v[76:79], v2 offset:7168
cB_va1_lp:
  s_waitcnt vmcnt(9)
  v_smfmac_f32_16x16x64_bf16 v[48:51], v[8:11], v[80:87], v3
  s_waitcnt vmcnt(8)
  v_smfmac_f32_16x16x64_bf16 v[48:51], v[12:15], v[88:95], v3
  s_waitcnt vmcnt(7)
  v_smfmac_f32_16x16x64_bf16 v[48:51], v[16:19], v[96:103], v3
  v_max3_u32 v55, v8, v12, v16
  s_waitcnt vmcnt(6)
  v_smfmac_f32_16x16x64_bf16 v[48:51], v[20:23], v[104:111], v3
  s_waitcnt vmcnt(5)
  v_smfmac_f32_16x16x64_bf16 v[48:51], v[24:27], v[112:119], v3
  v_max3_u32 v55, v55, v20, v24
  s_waitcnt vmcnt(4)
  v_smfmac_f32_16x16x64_bf16 v[48:51], v[28:31], v[120:127], v3
  v_max_u32 v55, v55, v28
  v_cmp_eq_u32 vcc, -1, v55
  s_waitcnt vmcnt(3)
  v_smfmac_f32_16x16x64_bf16 v[48:51], v[32:35], v[128:135], v3
  s_waitcnt vmcnt(2)
  v_smfmac_f32_16x16x64_bf16 v[48:51], v[36:39], v[136:143], v3
  s_cbranch_vccnz cB_va1_rv
  buffer_store_dword v163, v7, s[8:11], 0 offen sc1
  s_waitcnt vmcnt(2) lgkmcnt(0)
  v_smfmac_f32_16x16x64_bf16 v[48:51], v[40:43], v[64:71], v3
  s_waitcnt vmcnt(1)
  v_smfmac_f32_16x16x64_bf16 v[48:51], v[44:47], v[72:79], v3
  s_nop 7
  v_permlane32_swap_b32 v48, v50
  v_permlane32_swap_b32 v49, v51
  v_pk_add_f32 v[48:49], v[48:49], v[50:51]
  v_cvt_pk_bf16_f32 v160, v48, v49
  v_cmp_u_f32 vcc, v48, v49
  s_nop 0
  v_mov_b32_dpp v161, v160 quad_perm:[1,0,3,2] row_mask:0xf bank_mask:0xf
  v_perm_b32 v160, v161, v160, v5
  v_cndmask_b32 v161, v160, v162, vcc
  buffer_store_dword v161, v1, s[8:11], s21 offen sc1
  s_cbranch_vccnz cB_va1_rp
cB_va1_cont:
  s_cmp_lg_u32 s19, 62
  s_cbranch_scc1 cB_va1_nl
  s_mov_b32 s25, 0x40000000
cB_va1_nl:
  s_add_u32 s25, s25, 458752
  v_mov_b32 v36, 0
  v_mov_b32 v37, 0
  v_mov_b32 v38, 0
  v_mov_b32 v39, 0
  v_mov_b32 v40, 0
  v_mov_b32 v41, 0
  v_mov_b32 v42, 0
  v_mov_b32 v43, 0
  v_mov_b32 v44, 0
  v_mov_b32 v45, 0
  v_mov_b32 v46, 0
  v_mov_b32 v47, 0
  v_mov_b32 v48, 0
  v_mov_b32 v49, 0
  v_mov_b32 v50, 0
  v_mov_b32 v51, 0
  v_mov_b32 v52, 0
  v_mov_b32 v53, 0
  v_mov_b32 v54, 0
  v_mov_b32 v55, 0
  v_mov_b32 v56, 0
  v_mov_b32 v57, 0
  v_mov_b32 v58, 0
  v_mov_b32 v59, 0
  v_mov_b32 v60, 0
  v_mov_b32 v61, 0
  v_mov_b32 v62, 0
  v_mov_b32 v63, 0
  s_mov_b32 s19, s18
  s_add_u32 s18, s18, 1
  s_mov_b32 s22, s20
  s_mov_b32 s20, s21
  s_mov_b32 s21, s22
  s_add_u32 s23, s20, 4096
  s_branch cB_va1_loop
cB_va1_slow:
  s_waitcnt lgkmcnt(0)
cB_va1_sl1:
  s_add_u32 s31, s31, 0x1000000
  buffer_load_dwordx4 v[8:11], v2, s[8:11], s20 offen offset:0 sc1
  buffer_load_dwordx4 v[12:15], v2, s[8:11], s20 offen offset:1024 sc1
  buffer_load_dwordx4 v[16:19], v2, s[8:11], s20 offen offset:2048 sc1
  buffer_load_dwordx4 v[20:23], v2, s[8:11], s20 offen offset:3072 sc1
  buffer_load_dwordx4 v[24:27], v2, s[8:11], s23 offen offset:0 sc1
  buffer_load_dwordx4 v[28:31], v2, s[8:11], s23 offen offset:1024 sc1
  buffer_load_dwordx4 v[32:35], v2, s[8:11], s23 offen offset:2048 sc1
  s_waitcnt vmcnt(0)
  v_max3_u32 v36, v8, v9, v10
  v_max3_u32 v36, v36, v11, v12
  v_max3_u32 v36, v36, v13, v14
  v_max3_u32 v36, v36, v15, v16
  v_max3_u32 v36, v36, v17, v18
  v_max3_u32 v36, v36, v19, v20
  v_max3_u32 v36, v36, v21, v22
  v_max3_u32 v36, v36, v23, v24
  v_max3_u32 v36, v36, v25, v26
  v_max3_u32 v36, v36, v27, v28
  v_max3_u32 v36, v36, v29, v30
  v_max3_u32 v36, v36, v31, v32
  v_max3_u32 v36, v36, v33, v34
  v_max_u32 v36, v36, v35
  v_cmp_eq_u32 vcc, -1, v36
  s_cbranch_vccz cB_va1_sl2
  s_add_u32 s30, s30, 1
  s_cmp_lt_u32 s30, 400000
  s_cbranch_scc1 cB_va1_sl1
  s_branch cB_abort
cB_va1_sl2:
  v_mov_b32 v36, 0
  v_mov_b32 v37, 0
  v_mov_b32 v38, 0
  v_mov_b32 v39, 0
  v_mov_b32 v40, 0
  v_mov_b32 v41, 0
  v_mov_b32 v42, 0
  v_mov_b32 v43, 0
  v_mov_b32 v44, 0
  v_mov_b32 v45, 0
  v_mov_b32 v46, 0
  v_mov_b32 v47, 0
  v_mov_b32 v48, 0
  v_mov_b32 v49, 0
  v_mov_b32 v50, 0
  v_mov_b32 v51, 0
  v_mov_b32 v52, 0
  v_mov_b32 v53, 0
  v_mov_b32 v54, 0
  v_mov_b32 v55, 0
  v_mov_b32 v56, 0
  v_mov_b32 v57, 0
  v_mov_b32 v58, 0
  v_mov_b32 v59, 0
  v_mov_b32 v60, 0
  v_mov_b32 v61, 0
  v_mov_b32 v62, 0
  v_mov_b32 v63, 0
  buffer_store_dword v162, v1, s[8:11], s21 offen sc1
  ds_read_b128 v[64:67], v0 offset:0
  ds_read_b128 v[68:71], v0 offset:1024
  v_smfmac_f32_16x16x64_bf16 v[36:39], v[8:11], a[0:7], v3
  v_smfmac_f32_16x16x64_bf16 v[40:43], v[8:11], a[56:63], v3
  v_smfmac_f32_16x16x64_bf16 v[44:47], v[8:11], a[112:119], v3
  v_smfmac_f32_16x16x64_bf16 v[48:51], v[8:11], a[168:175], v3
  v_smfmac_f32_16x16x64_bf16 v[52:55], v[8:11], a[224:231], v3
  v_smfmac_f32_16x16x64_bf16 v[56:59], v[8:11], v[200:207], v3
  s_waitcnt lgkmcnt(0)
  v_smfmac_f32_16x16x64_bf16 v[60:63], v[8:11], v[64:71], v3
  ds_read_b128 v[72:75], v0 offset:2048
  ds_read_b128 v[76:79], v0 offset:3072
  v_smfmac_f32_16x16x64_bf16 v[36:39], v[12:15], a[8:15], v3
  v_smfmac_f32_16x16x64_bf16 v[40:43], v[12:15], a[64:71], v3
  v_smfmac_f32_16x16x64_bf16 v[44:47], v[12:15], a[120:127], v3
  v_smfmac_f32_16x16x64_bf16 v[48:51], v[12:15], a[176:183], v3
  v_smfmac_f32_16x16x64_bf16 v[52:55], v[12:15], a[232:239], v3
  v_smfmac_f32_16x16x64_bf16 v[56:59], v[12:15], v[208:215], v3
  s_waitcnt lgkmcnt(0)
  v_smfmac_f32_16x16x64_bf16 v[60:63], v[12:15], v[72:79], v3
  ds_read_b128 v[144:147], v0 offset:4096
  ds_read_b128 v[148:151], v0 offset:5120
  v_smfmac_f32_16x16x64_bf16 v[36:39], v[16:19], a[16:23], v3
  v_smfmac_f32_16x16x64_bf16 v[40:43], v[16:19], a[72:79], v3
  v_smfmac_f32_16x16x64_bf16 v[44:47], v[16:19], a[128:135], v3
  v_smfmac_f32_16x16x64_bf16 v[48:51], v[16:19], a[184:191], v3
  v_smfmac_f32_16x16x64_bf16 v[52:55], v[16:19], a[240:247], v3
  v_smfmac_f32_16x16x64_bf16 v[56:59], v[16:19], v[216:223], v3
  s_waitcnt lgkmcnt(0)
  v_smfmac_f32_16x16x64_bf16 v[60:63], v[16:19], v[144:151], v3
  ds_read_b128 v[64:67], v0 offset:6144
  ds_read_b128 v[68:71], v0 offset:7168
  v_smfmac_f32_16x16x64_bf16 v[36:39], v[20:23], a[24:31], v3
  v_smfmac_f32_16x16x64_bf16 v[40:43], v[20:23], a[80:87], v3
  v_smfmac_f32_16x16x64_bf16 v[44:47], v[20:23], a[136:143], v3
  v_smfmac_f32_16x16x64_bf16 v[48:51], v[20:23], a[192:199], v3
  v_smfmac_f32_16x16x64_bf16 v[52:55], v[20:23], a[248:255], v3
  v_smfmac_f32_16x16x64_bf16 v[56:59], v[20:23], v[224:231], v3
  s_waitcnt lgkmcnt(0)
  v_smfmac_f32_16x16x64_bf16 v[60:63], v[20:23], v[64:71], v3
  ds_read_b128 v[72:75], v0 offset:8192
  ds_read_b128 v[76:79], v0 offset:9216
  v_smfmac_f32_16x16x64_bf16 v[36:39], v[24:27], a[32:39], v3
  v_smfmac_f32_16x16x64_bf16 v[40:43], v[24:27], a[88:95], v3
  v_smfmac_f32_16x16x64_bf16 v[44:47], v[24:27], a[144:151], v3
  v_smfmac_f32_16x16x64_bf16 v[48:51], v[24:27], a[200:207], v3
  v_smfmac_f32_16x16x64_bf16 v[52:55], v[24:27], v[176:183], v3
  v_smfmac_f32_16x16x64_bf16 v[56:59], v[24:27], v[232:239], v3
  s_waitcnt lgkmcnt(0)
  v_smfmac_f32_16x16x64_bf16 v[60:63], v[24:27], v[72:79], v3
  ds_read_b128 v[144:147], v0 offset:10240
  ds_read_b128 v[148:151], v0 offset:11264
  v_smfmac_f32_16x16x64_bf16 v[36:39], v[28:31], a[40:47], v3
  v_smfmac_f32_16x16x64_bf16 v[40:43], v[28:31], a[96:103], v3
  v_smfmac_f32_16x16x64_bf16 v[44:47], v[28:31], a[152:159], v3
  v_smfmac_f32_16x16x64_bf16 v[48:51], v[28:31], a[208:215], v3
  v_smfmac_f32_16x16x64_bf16 v[52:55], v[28:31], v[184:191], v3
  v_smfmac_f32_16x16x64_bf16 v[56:59], v[28:31], v[240:247], v3
  s_waitcnt lgkmcnt(0)
  v_smfmac_f32_16x16x64_bf16 v[60:63], v[28:31], v[144:151], v3
  ds_read_b128 v[64:67], v0 offset:12288
  ds_read_b128 v[68:71], v0 offset:13312
  v_smfmac_f32_16x16x64_bf16 v[36:39], v[32:35], a[48:55], v3
  v_smfmac_f32_16x16x64_bf16 v[40:43], v[32:35], a[104:111], v3
  v_smfmac_f32_16x16x64_bf16 v[44:47], v[32:35], a[160:167], v3
  v_smfmac_f32_16x16x64_bf16 v[48:51], v[32:35], a[216:223], v3
  v_smfmac_f32_16x16x64_bf16 v[52:55], v[32:35], v[192:199], v3
  v_smfmac_f32_16x16x64_bf16 v[56:59], v[32:35], v[248:255], v3
  s_waitcnt lgkmcnt(0)
  v_smfmac_f32_16x16x64_bf16 v[60:63], v[32:35], v[64:71], v3
  v_permlane32_swap_b32 v36, v38
  v_permlane32_swap_b32 v37, v39
  v_add_f32 v36, v36, v38
  v_add_f32 v37, v37, v39
  v_cvt_pk_bf16_f32 v38, v36, v37
  ds_write_b32 v152, v38
  v_permlane32_swap_b32 v40, v42
  v_permlane32_swap_b32 v41, v43
  v_add_f32 v40, v40, v42
  v_add_f32 v41, v41, v43
  v_cvt_pk_bf16_f32 v42, v40, v41
  ds_write_b32 v153, v42
  v_permlane32_swap_b32 v44, v46
  v_permlane32_swap_b32 v45, v47
  v_add_f32 v44, v44, v46
  v_add_f32 v45, v45, v47
  v_cvt_pk_bf16_f32 v46, v44, v45
  ds_write_b32 v154, v46
  v_permlane32_swap_b32 v48, v50
  v_permlane32_swap_b32 v49, v51
  v_add_f32 v48, v48, v50
  v_add_f32 v49, v49, v51
  v_cvt_pk_bf16_f32 v50, v48, v49
  ds_write_b32 v155, v50
  v_permlane32_swap_b32 v52, v54
  v_permlane32_swap_b32 v53, v55
  v_add_f32 v52, v52, v54
  v_add_f32 v53, v53, v55
  v_cvt_pk_bf16_f32 v54, v52, v53
  ds_write_b32 v156, v54
  v_permlane32_swap_b32 v56, v58
  v_permlane32_swap_b32 v57, v59
  v_add_f32 v56, v56, v58
  v_add_f32 v57, v57, v59
  v_cvt_pk_bf16_f32 v58, v56, v57
  ds_write_b32 v157, v58
  v_permlane32_swap_b32 v60, v62
  v_permlane32_swap_b32 v61, v63
  v_add_f32 v60, v60, v62
  v_add_f32 v61, v61, v63
  v_cvt_pk_bf16_f32 v62, v60, v61
  ds_write_b32 v158, v62
  s_branch cB_va1_t2d
cB_va1_last:
  s_barrier
  ds_read_b128 v[64:67], v2 offset:4096
  ds_read_b128 v[68:71], v2 offset:5120
  ds_read_b128 v[72:75], v2 offset:6144
  ds_read_b128 v[76:79], v2 offset:7168
  s_waitcnt lgkmcnt(0)
  v_min_u32 v64, -2, v64
  v_min_u32 v65, -2, v65
  v_min_u32 v66, -2, v66
  v_min_u32 v67, -2, v67
  v_min_u32 v68, -2, v68
  v_min_u32 v69, -2, v69
  v_min_u32 v70, -2, v70
  v_min_u32 v71, -2, v71
  v_min_u32 v72, -2, v72
  v_min_u32 v73, -2, v73
  v_min_u32 v74, -2, v74
  v_min_u32 v75, -2, v75
  v_min_u32 v76, -2, v76
  v_min_u32 v77, -2, v77
  v_min_u32 v78, -2, v78
  v_min_u32 v79, -2, v79
  buffer_store_dwordx4 v[64:67], v2, s[8:11], s33 offen offset:0 sc1
  buffer_store_dwordx4 v[68:71], v2, s[8:11], s33 offen offset:2048 sc1
  s_add_u32 s33, s33, 4096
  buffer_store_dwordx4 v[72:75], v2, s[8:11], s33 offen offset:0 sc1
  buffer_store_dwordx4 v[76:79], v2, s[8:11], s33 offen offset:2048 sc1
  s_add_u32 s33, s33, 4096
  s_branch cB_done
cB_va1_rp:
  s_cmp_eq_u32 s37, 0
  s_cbranch_scc1 cB_va1_rv
  v_min_u32 v160, -2, v160
  buffer_store_dword v160, v1, s[8:11], s21 offen sc1
  s_branch cB_va1_cont
cB_va1_rv:
  s_add_u32 s31, s31, 0x10000
  buffer_load_dwordx4 v[8:11], v2, s[8:11], s72 offen offset:0 sc1
  buffer_load_dwordx4 v[12:15], v2, s[8:11], s72 offen offset:1024 sc1
  buffer_load_dwordx4 v[16:19], v2, s[8:11], s73 offen offset:0 sc1
  buffer_load_dwordx4 v[20:23], v2, s[8:11], s73 offen offset:1024 sc1
  buffer_load_dwordx4 v[24:27], v2, s[8:11], s74 offen offset:0 sc1
  buffer_load_dwordx4 v[28:31], v2, s[8:11], s74 offen offset:1024 sc1
  buffer_load_dwordx4 v[32:35], v2, s[8:11], s75 offen offset:0 sc1
  buffer_load_dwordx4 v[36:39], v2, s[8:11], s75 offen offset:1024 sc1
  buffer_load_dwordx4 v[40:43], v2, s[8:11], s36 offen offset:0 sc1
  buffer_load_dwordx4 v[44:47], v2, s[8:11], s36 offen offset:1024 sc1
  s_waitcnt vmcnt(0)
  v_max3_u32 v52, v8, v9, v10
  v_max3_u32 v52, v52, v11, v12
  v_max3_u32 v52, v52, v13, v14
  v_max3_u32 v52, v52, v15, v16
  v_max3_u32 v52, v52, v17, v18
  v_max3_u32 v52, v52, v19, v20
  v_max3_u32 v52, v52, v21, v22
  v_max3_u32 v52, v52, v23, v24
  v_max3_u32 v52, v52, v25, v26
  v_max3_u32 v52, v52, v27, v28
  v_max3_u32 v52, v52, v29, v30
  v_max3_u32 v52, v52, v31, v32
  v_max3_u32 v52, v52, v33, v34
  v_max3_u32 v52, v52, v35, v36
  v_max3_u32 v52, v52, v37, v38
  v_max3_u32 v52, v52, v39, v40
  v_max3_u32 v52, v52, v41, v42
  v_max3_u32 v52, v52, v43, v44
  v_max3_u32 v52, v52, v45, v46
  v_max_u32 v52, v52, v47
  v_cmp_eq_u32 vcc, -1, v52
  s_mov_b32 s37, 1
  v_mov_b32 v48, 0
  v_mov_b32 v49, 0
  v_mov_b32 v50, 0
  v_mov_b32 v51, 0
  s_nop 1
  s_cbranch_vccz cB_va1_lp
  s_add_u32 s30, s30, 1
  s_cmp_lt_u32 s30, 400000
  s_cbranch_scc1 cB_va1_rv
  s_branch cB_abort
.p2align 6
cB_va2_loop:
  s_mov_b32 s30, 0
cB_va2_fp_l:
  v_cmp_gt_u32 vcc, s19, v96
  buffer_load_dword v96, v119, s[8:11], 0 offen sc1
  s_cbranch_vccz cB_va2_fp_d
  v_cmp_gt_u32 vcc, s19, v96
  buffer_load_dword v96, v119, s[8:11], 0 offen sc1
  s_cbranch_vccz cB_va2_fp_d
  v_cmp_gt_u32 vcc, s19, v96
  buffer_load_dword v96, v119, s[8:11], 0 offen sc1
  s_cbranch_vccz cB_va2_fp_d
  v_cmp_gt_u32 vcc, s19, v96
  buffer_load_dword v96, v119, s[8:11], 0 offen sc1
  s_cbranch_vccz cB_va2_fp_d
  v_cmp_gt_u32 vcc, s19, v96
  buffer_load_dword v96, v119, s[8:11], 0 offen sc1
  s_cbranch_vccz cB_va2_fp_d
  v_cmp_gt_u32 vcc, s19, v96
  buffer_load_dword v96, v119, s[8:11], 0 offen sc1
  s_cbranch_vccz cB_va2_fp_d
  v_cmp_gt_u32 vcc, s19, v96
  buffer_load_dword v96, v119, s[8:11], 0 offen sc1
  s_cbranch_vccz cB_va2_fp_d
  v_cmp_gt_u32 vcc, s19, v96
  buffer_load_dword v96, v119, s[8:11], 0 offen sc1
  s_cbranch_vccz cB_va2_fp_d
  v_cmp_gt_u32 vcc, s19, v96
  buffer_load_dword v96, v119, s[8:11], 0 offen sc1
  s_cbranch_vccz cB_va2_fp_d
  v_cmp_gt_u32 vcc, s19, v96
  buffer_load_dword v96, v119, s[8:11], 0 offen sc1
  s_cbranch_vccz cB_va2_fp_d
  v_cmp_gt_u32 vcc, s19, v96
  buffer_load_dword v96, v119, s[8:11], 0 offen sc1
  s_cbranch_vccz cB_va2_fp_d
  v_cmp_gt_u32 vcc, s19, v96
  buffer_load_dword v96, v119, s[8:11], 0 offen sc1
  s_cbranch_vccz cB_va2_fp_d
  v_cmp_gt_u32 vcc, s19, v96
  buffer_load_dword v96, v119, s[8:11], 0 offen sc1
  s_cbranch_vccz cB_va2_fp_d
  v_cmp_gt_u32 vcc, s19, v96
  buffer_load_dword v96, v119, s[8:11], 0 offen sc1
  s_cbranch_vccz cB_va2_fp_d
  v_cmp_gt_u32 vcc, s19, v96
  buffer_load_dword v96, v119, s[8:11], 0 offen sc1
  s_cbranch_vccz cB_va2_fp_d
  v_cmp_gt_u32 vcc, s19, v96
  buffer_load_dword v96, v119, s[8:11], 0 offen sc1
  s_cbranch_vccz cB_va2_fp_d
  s_waitcnt vmcnt(24)
  s_add_u32 s30, s30, 1
  s_cmp_lt_u32 s30, 400000
  s_cbranch_scc1 cB_va2_fp_l
  s_branch cB_abort
cB_va2_fp_d:
  buffer_load_dwordx4 v[8:11], v2, s[8:11], s20 offen offset:0 sc1
  buffer_load_dwordx4 v[12:15], v2, s[8:11], s20 offen offset:1024 sc1
  s_barrier
  s_barrier
  s_waitcnt vmcnt(0)
  ds_write_b128 v2, v[8:11] offset:8192
  ds_write_b128 v2, v[12:15] offset:9216
  v_smfmac_f32_16x16x64_bf16 v[36:39], v[8:11], a[0:7], v3
  v_smfmac_f32_16x16x64_bf16 v[40:43], v[8:11], a[56:63], v3
  v_smfmac_f32_16x16x64_bf16 v[44:47], v[8:11], a[112:119], v3
  v_smfmac_f32_16x16x64_bf16 v[48:51], v[8:11], a[168:175], v3
  v_smfmac_f32_16x16x64_bf16 v[52:55], v[8:11], a[224:231], v3
  s_waitcnt lgkmcnt(0)
  s_barrier
  ds_read_b128 v[16:19], v2 offset:10240
  ds_read_b128 v[20:23], v2 offset:11264
  ds_read_b128 v[24:27], v2 offset:12288
  ds_read_b128 v[28:31], v2 offset:13312
  ds_read_b128 v[32:35], v2 offset:14336
  v_smfmac_f32_16x16x64_bf16 v[56:59], v[8:11], v[144:151], v3
  v_smfmac_f32_16x16x64_bf16 v[60:63], v[8:11], v[200:207], v3
  v_smfmac_f32_16x16x64_bf16 v[36:39], v[12:15], a[8:15], v3
  v_smfmac_f32_16x16x64_bf16 v[40:43], v[12:15], a[64:71], v3
  v_smfmac_f32_16x16x64_bf16 v[44:47], v[12:15], a[120:127], v3
  v_smfmac_f32_16x16x64_bf16 v[48:51], v[12:15], a[176:183], v3
  v_smfmac_f32_16x16x64_bf16 v[52:55], v[12:15], a[232:239], v3
  v_smfmac_f32_16x16x64_bf16 v[56:59], v[12:15], v[152:159], v3
  ds_read_b128 v[68:71], v0 offset:0
  ds_read_b128 v[72:75], v0 offset:1024
  v_smfmac_f32_16x16x64_bf16 v[60:63], v[12:15], v[208:215], v3
  s_waitcnt lgkmcnt(6)
  ds_read_b128 v[76:79], v0 offset:2048
  ds_read_b128 v[80:83], v0 offset:3072
  v_smfmac_f32_16x16x64_bf16 v[36:39], v[16:19], a[16:23], v3
  s_waitcnt lgkmcnt(7)
  v_smfmac_f32_16x16x64_bf16 v[36:39], v[20:23], a[24:31], v3
  s_waitcnt lgkmcnt(6)
  v_smfmac_f32_16x16x64_bf16 v[36:39], v[24:27], a[32:39], v3
  s_waitcnt lgkmcnt(2)
  v_smfmac_f32_16x16x64_bf16 v[64:67], v[8:11], v[68:75], v3
  s_waitcnt lgkmcnt(5)
  ds_read_b128 v[84:87], v0 offset:4096
  ds_read_b128 v[88:91], v0 offset:5120
  v_smfmac_f32_16x16x64_bf16 v[36:39], v[28:31], a[40:47], v3
  s_waitcnt lgkmcnt(6)
  v_smfmac_f32_16x16x64_bf16 v[36:39], v[32:35], a[48:55], v3
  v_smfmac_f32_16x16x64_bf16 v[40:43], v[16:19], a[72:79], v3
  s_waitcnt lgkmcnt(2)
  v_smfmac_f32_16x16x64_bf16 v[64:67], v[12:15], v[76:83], v3
  ds_read_b128 v[68:71], v0 offset:6144
  ds_read_b128 v[72:75], v0 offset:7168
  v_smfmac_f32_16x16x64_bf16 v[40:43], v[20:23], a[80:87], v3
  v_permlane32_swap_b32 v36, v38
  v_smfmac_f32_16x16x64_bf16 v[40:43], v[24:27], a[88:95], v3
  v_permlane32_swap_b32 v37, v39
  v_smfmac_f32_16x16x64_bf16 v[40:43], v[28:31], a[96:103], v3
  s_waitcnt lgkmcnt(2)
  v_add_f32 v36, v36, v38
  v_smfmac_f32_16x16x64_bf16 v[64:67], v[16:19], v[84:91], v3
  ds_read_b128 v[76:79], v0 offset:8192
  ds_read_b128 v[80:83], v0 offset:9216
  v_add_f32 v37, v37, v39
  v_smfmac_f32_16x16x64_bf16 v[40:43], v[32:35], a[104:111], v3
  v_cmp_u_f32 vcc, v36, v37
  v_smfmac_f32_16x16x64_bf16 v[44:47], v[16:19], a[128:135], v3
  v_cvt_pk_bf16_f32 v38, v36, v37
  v_smfmac_f32_16x16x64_bf16 v[44:47], v[20:23], a[136:143], v3
  ds_write_b32 v104, v38
  s_waitcnt lgkmcnt(3)
  s_cbranch_vccnz cB_va2_slow
  v_permlane32_swap_b32 v40, v42
  v_smfmac_f32_16x16x64_bf16 v[64:67], v[20:23], v[68:75], v3
  ds_read_b128 v[84:87], v0 offset:10240
  ds_read_b128 v[88:91], v0 offset:11264
  v_permlane32_swap_b32 v41, v43
  v_smfmac_f32_16x16x64_bf16 v[44:47], v[24:27], a[144:151], v3
  v_add_f32 v40, v40, v42
  v_smfmac_f32_16x16x64_bf16 v[44:47], v[28:31], a[152:159], v3
  v_add_f32 v41, v41, v43
  v_smfmac_f32_16x16x64_bf16 v[44:47], v[32:35], a[160:167], v3
  s_waitcnt lgkmcnt(3)
  v_cvt_pk_bf16_f32 v42, v40, v41
  v_smfmac_f32_16x16x64_bf16 v[64:67], v[24:27], v[76:83], v3
  ds_write_b32 v105, v42
  ds_read_b128 v[68:71], v0 offset:12288
  ds_read_b128 v[72:75], v0 offset:13312
  v_smfmac_f32_16x16x64_bf16 v[48:51], v[16:19], a[184:191], v3
  s_nop 0
  v_permlane32_swap_b32 v44, v46
  v_smfmac_f32_16x16x64_bf16 v[48:51], v[20:23], a[192:199], v3
  v_permlane32_swap_b32 v45, v47
  v_smfmac_f32_16x16x64_bf16 v[48:51], v[24:27], a[200:207], v3
  s_waitcnt lgkmcnt(3)
  v_add_f32 v44, v44, v46
  v_smfmac_f32_16x16x64_bf16 v[64:67], v[28:31], v[84:91], v3
  v_add_f32 v45, v45, v47
  v_smfmac_f32_16x16x64_bf16 v[48:51], v[28:31], a[208:215], v3
  v_cvt_pk_bf16_f32 v46, v44, v45
  v_smfmac_f32_16x16x64_bf16 v[48:51], v[32:35], a[216:223], v3
  ds_write_b32 v106, v46
  v_smfmac_f32_16x16x64_bf16 v[52:55], v[16:19], a[240:247], v3
  s_waitcnt lgkmcnt(1)
  v_smfmac_f32_16x16x64_bf16 v[64:67], v[32:35], v[68:75], v3
  v_smfmac_f32_16x16x64_bf16 v[52:55], v[20:23], a[248:255], v3
  v_permlane32_swap_b32 v48, v50
  v_smfmac_f32_16x16x64_bf16 v[52:55], v[24:27], v[120:127], v3
  v_permlane32_swap_b32 v49, v51
  v_smfmac_f32_16x16x64_bf16 v[52:55], v[28:31], v[128:135], v3
  v_add_f32 v48, v48, v50
  v_smfmac_f32_16x16x64_bf16 v[52:55], v[32:35], v[136:143], v3
  v_add_f32 v49, v49, v51
  v_smfmac_f32_16x16x64_bf16 v[56:59], v[16:19], v[160:167], v3
  v_cvt_pk_bf16_f32 v50, v48, v49
  v_smfmac_f32_16x16x64_bf16 v[56:59], v[20:23], v[168:175], v3
  ds_write_b32 v107, v50
  v_permlane32_swap_b32 v64, v66
  v_smfmac_f32_16x16x64_bf16 v[56:59], v[24:27], v[176:183], v3
  v_permlane32_swap_b32 v65, v67
  v_smfmac_f32_16x16x64_bf16 v[56:59], v[28:31], v[184:191], v3
  v_add_f32 v64, v64, v66
  v_smfmac_f32_16x16x64_bf16 v[56:59], v[32:35], v[192:199], v3
  v_add_f32 v65, v65, v67
  v_smfmac_f32_16x16x64_bf16 v[60:63], v[16:19], v[216:223], v3
  v_cvt_pk_bf16_f32 v66, v64, v65
  v_smfmac_f32_16x16x64_bf16 v[60:63], v[20:23], v[224:231], v3
  ds_write_b32 v111, v66
  v_permlane32_swap_b32 v52, v54
  v_smfmac_f32_16x16x64_bf16 v[60:63], v[24:27], v[232:239], v3
  v_permlane32_swap_b32 v53, v55
  v_smfmac_f32_16x16x64_bf16 v[60:63], v[28:31], v[240:247], v3
  v_add_f32 v52, v52, v54
  v_smfmac_f32_16x16x64_bf16 v[60:63], v[32:35], v[248:255], v3
  v_add_f32 v53, v53, v55
  v_cvt_pk_bf16_f32 v54, v52, v53
  ds_write_b32 v108, v54
  v_permlane32_swap_b32 v56, v58
  v_permlane32_swap_b32 v57, v59
  v_add_f32 v56, v56, v58
  v_add_f32 v57, v57, v59
  v_cvt_pk_bf16_f32 v58, v56, v57
  ds_write_b32 v109, v58
  v_permlane32_swap_b32 v60, v62
  v_permlane32_swap_b32 v61, v63
  v_add_f32 v60, v60, v62
  v_add_f32 v61, v61, v63
  v_cvt_pk_bf16_f32 v62, v60, v61
  ds_write_b32 v110, v62
cB_va2_t2d:
  v_mov_b32 v117, s18
  s_waitcnt lgkmcnt(0)
  s_barrier
  s_cmp_eq_u32 s19, 63
  s_cbranch_scc1 cB_done
  s_sleep 1
  v_mov_b32 v36, 0
  v_mov_b32 v37, 0
  v_mov_b32 v38, 0
  v_mov_b32 v39, 0
  v_mov_b32 v40, 0
  v_mov_b32 v41, 0
  v_mov_b32 v42, 0
  v_mov_b32 v43, 0
  v_mov_b32 v44, 0
  v_mov_b32 v45, 0
  v_mov_b32 v46, 0
  v_mov_b32 v47, 0
  v_mov_b32 v48, 0
  v_mov_b32 v49, 0
  v_mov_b32 v50, 0
  v_mov_b32 v51, 0
  v_mov_b32 v52, 0
  v_mov_b32 v53, 0
  v_mov_b32 v54, 0
  v_mov_b32 v55, 0
  v_mov_b32 v56, 0
  v_mov_b32 v57, 0
  v_mov_b32 v58, 0
  v_mov_b32 v59, 0
  v_mov_b32 v60, 0
  v_mov_b32 v61, 0
  v_mov_b32 v62, 0
  v_mov_b32 v63, 0
  v_mov_b32 v64, 0
  v_mov_b32 v65, 0
  v_mov_b32 v66, 0
  v_mov_b32 v67, 0
  s_sleep 5
  s_mov_b32 s19, s18
  s_add_u32 s18, s18, 1
  s_mov_b32 s22, s20
  s_mov_b32 s20, s21
  s_mov_b32 s21, s22
  s_add_u32 s23, s20, 4096
  s_branch cB_va2_loop
cB_va2_slow:
  s_waitcnt lgkmcnt(0)
cB_va2_sl1:
  s_add_u32 s31, s31, 0x1000000
  buffer_load_dwordx4 v[8:11], v2, s[8:11], s20 offen offset:0 sc1
  buffer_load_dwordx4 v[12:15], v2, s[8:11], s20 offen offset:1024 sc1
  buffer_load_dwordx4 v[16:19], v2, s[8:11], s20 offen offset:2048 sc1
  buffer_load_dwordx4 v[20:23], v2, s[8:11], s20 offen offset:3072 sc1
  buffer_load_dwordx4 v[24:27], v2, s[8:11], s23 offen offset:0 sc1
  buffer_load_dwordx4 v[28:31], v2, s[8:11], s23 offen offset:1024 sc1
  buffer_load_dwordx4 v[32:35], v2, s[8:11], s23 offen offset:2048 sc1
  s_waitcnt vmcnt(0)
  v_max3_u32 v36, v8, v9, v10
  v_max3_u32 v36, v36, v11, v12
  v_max3_u32 v36, v36, v13, v14
  v_max3_u32 v36, v36, v15, v16
  v_max3_u32 v36, v36, v17, v18
  v_max3_u32 v36, v36, v19, v20
  v_max3_u32 v36, v36, v21, v22
  v_max3_u32 v36, v36, v23, v24
  v_max3_u32 v36, v36, v25, v26
  v_max3_u32 v36, v36, v27, v28
  v_max3_u32 v36, v36, v29, v30
  v_max3_u32 v36, v36, v31, v32
  v_max3_u32 v36, v36, v33, v34
  v_max_u32 v36, v36, v35
  v_cmp_eq_u32 vcc, -1, v36
  s_cbranch_vccz cB_va2_sl2
  s_add_u32 s30, s30, 1
  s_cmp_lt_u32 s30, 400000
  s_cbranch_scc1 cB_va2_sl1
  s_branch cB_abort
cB_va2_sl2:
  v_mov_b32 v36, 0
  v_mov_b32 v37, 0
  v_mov_b32 v38, 0
  v_mov_b32 v39, 0
  v_mov_b32 v40, 0
  v_mov_b32 v41, 0
  v_mov_b32 v42, 0
  v_mov_b32 v43, 0
  v_mov_b32 v44, 0
  v_mov_b32 v45, 0
  v_mov_b32 v46, 0
  v_mov_b32 v47, 0
  v_mov_b32 v48, 0
  v_mov_b32 v49, 0
  v_mov_b32 v50, 0
  v_mov_b32 v51, 0
  v_mov_b32 v52, 0
  v_mov_b32 v53, 0
  v_mov_b32 v54, 0
  v_mov_b32 v55, 0
  v_mov_b32 v56, 0
  v_mov_b32 v57, 0
  v_mov_b32 v58, 0
  v_mov_b32 v59, 0
  v_mov_b32 v60, 0
  v_mov_b32 v61, 0
  v_mov_b32 v62, 0
  v_mov_b32 v63, 0
  v_mov_b32 v64, 0
  v_mov_b32 v65, 0
  v_mov_b32 v66, 0
  v_mov_b32 v67, 0
  ds_read_b128 v[68:71], v0 offset:0
  ds_read_b128 v[72:75], v0 offset:1024
  v_smfmac_f32_16x16x64_bf16 v[36:39], v[8:11], a[0:7], v3
  v_smfmac_f32_16x16x64_bf16 v[40:43], v[8:11], a[56:63], v3
  v_smfmac_f32_16x16x64_bf16 v[44:47], v[8:11], a[112:119], v3
  v_smfmac_f32_16x16x64_bf16 v[48:51], v[8:11], a[168:175], v3
  v_smfmac_f32_16x16x64_bf16 v[52:55], v[8:11], a[224:231], v3
  v_smfmac_f32_16x16x64_bf16 v[56:59], v[8:11], v[144:151], v3
  v_smfmac_f32_16x16x64_bf16 v[60:63], v[8:11], v[200:207], v3
  s_waitcnt lgkmcnt(0)
  v_smfmac_f32_16x16x64_bf16 v[64:67], v[8:11], v[68:75], v3
  ds_read_b128 v[76:79], v0 offset:2048
  ds_read_b128 v[80:83], v0 offset:3072
  v_smfmac_f32_16x16x64_bf16 v[36:39], v[12:15], a[8:15], v3
  v_smfmac_f32_16x16x64_bf16 v[40:43], v[12:15], a[64:71], v3
  v_smfmac_f32_16x16x64_bf16 v[44:47], v[12:15], a[120:127], v3
  v_smfmac_f32_16x16x64_bf16 v[48:51], v[12:15], a[176:183], v3
  v_smfmac_f32_16x16x64_bf16 v[52:55], v[12:15], a[232:239], v3
  v_smfmac_f32_16x16x64_bf16 v[56:59], v[12:15], v[152:159], v3
  v_smfmac_f32_16x16x64_bf16 v[60:63], v[12:15], v[208:215], v3
  s_waitcnt lgkmcnt(0)
  v_smfmac_f32_16x16x64_bf16 v[64:67], v[12:15], v[76:83], v3
  ds_read_b128 v[84:87], v0 offset:4096
  ds_read_b128 v[88:91], v0 offset:5120
  v_smfmac_f32_16x16x64_bf16 v[36:39], v[16:19], a[16:23], v3
  v_smfmac_f32_16x16x64_bf16 v[40:43], v[16:19], a[72:79], v3
  v_smfmac_f32_16x16x64_bf16 v[44:47], v[16:19], a[128:135], v3
  v_smfmac_f32_16x16x64_bf16 v[48:51], v[16:19], a[184:191], v3
  v_smfmac_f32_16x16x64_bf16 v[52:55], v[16:19], a[240:247], v3
  v_smfmac_f32_16x16x64_bf16 v[56:59], v[16:19], v[160:167], v3
  v_smfmac_f32_16x16x64_bf16 v[60:63], v[16:19], v[216:223], v3
  s_waitcnt lgkmcnt(0)
  v_smfmac_f32_16x16x64_bf16 v[64:67], v[16:19], v[84:91], v3
  ds_read_b128 v[68:71], v0 offset:6144
  ds_read_b128 v[72:75], v0 offset:7168
  v_smfmac_f32_16x16x64_bf16 v[36:39], v[20:23], a[24:31], v3
  v_smfmac_f32_16x16x64_bf16 v[40:43], v[20:23], a[80:87], v3
  v_smfmac_f32_16x16x64_bf16 v[44:47], v[20:23], a[136:143], v3
  v_smfmac_f32_16x16x64_bf16 v[48:51], v[20:23], a[192:199], v3
  v_smfmac_f32_16x16x64_bf16 v[52:55], v[20:23], a[248:255], v3
  v_smfmac_f32_16x16x64_bf16 v[56:59], v[20:23], v[168:175], v3
  v_smfmac_f32_16x16x64_bf16 v[60:63], v[20:23], v[224:231], v3
  s_waitcnt lgkmcnt(0)
  v_smfmac_f32_16x16x64_bf16 v[64:67], v[20:23], v[68:75], v3
  ds_read_b128 v[76:79], v0 offset:8192
  ds_read_b128 v[80:83], v0 offset:9216
  v_smfmac_f32_16x16x64_bf16 v[36:39], v[24:27], a[32:39], v3
  v_smfmac_f32_16x16x64_bf16 v[40:43], v[24:27], a[88:95], v3
  v_smfmac_f32_16x16x64_bf16 v[44:47], v[24:27], a[144:151], v3
  v_smfmac_f32_16x16x64_bf16 v[48:51], v[24:27], a[200:207], v3
  v_smfmac_f32_16x16x64_bf16 v[52:55], v[24:27], v[120:127], v3
  v_smfmac_f32_16x16x64_bf16 v[56:59], v[24:27], v[176:183], v3
  v_smfmac_f32_16x16x64_bf16 v[60:63], v[24:27], v[232:239], v3
  s_waitcnt lgkmcnt(0)
  v_smfmac_f32_16x16x64_bf16 v[64:67], v[24:27], v[76:83], v3
  ds_read_b128 v[84:87], v0 offset:10240
  ds_read_b128 v[88:91], v0 offset:11264
  v_smfmac_f32_16x16x64_bf16 v[36:39], v[28:31], a[40:47], v3
  v_smfmac_f32_16x16x64_bf16 v[40:43], v[28:31], a[96:103], v3
  v_smfmac_f32_16x16x64_bf16 v[44:47], v[28:31], a[152:159], v3
  v_smfmac_f32_16x16x64_bf16 v[48:51], v[28:31], a[208:215], v3
  v_smfmac_f32_16x16x64_bf16 v[52:55], v[28:31], v[128:135], v3
  v_smfmac_f32_16x16x64_bf16 v[56:59], v[28:31], v[184:191], v3
  v_smfmac_f32_16x16x64_bf16 v[60:63], v[28:31], v[240:247], v3
  s_waitcnt lgkmcnt(0)
  v_smfmac_f32_16x16x64_bf16 v[64:67], v[28:31], v[84:91], v3
  ds_read_b128 v[68:71], v0 offset:12288
  ds_read_b128 v[72:75], v0 offset:13312
  v_smfmac_f32_16x16x64_bf16 v[36:39], v[32:35], a[48:55], v3
  v_smfmac_f32_16x16x64_bf16 v[40:43], v[32:35], a[104:111], v3
  v_smfmac_f32_16x16x64_bf16 v[44:47], v[32:35], a[160:167], v3
  v_smfmac_f32_16x16x64_bf16 v[48:51], v[32:35], a[216:223], v3
  v_smfmac_f32_16x16x64_bf16 v[52:55], v[32:35], v[136:143], v3
  v_smfmac_f32_16x16x64_bf16 v[56:59], v[32:35], v[192:199], v3
  v_smfmac_f32_16x16x64_bf16 v[60:63], v[32:35], v[248:255], v3
  s_waitcnt lgkmcnt(0)
  v_smfmac_f32_16x16x64_bf16 v[64:67], v[32:35], v[68:75], v3
  v_permlane32_swap_b32 v36, v38
  v_permlane32_swap_b32 v37, v39
  v_add_f32 v36, v36, v38
  v_add_f32 v37, v37, v39
  v_cvt_pk_bf16_f32 v38, v36, v37
  ds_write_b32 v104, v38
  v_permlane32_swap_b32 v40, v42
  v_permlane32_swap_b32 v41, v43
  v_add_f32 v40, v40, v42
  v_add_f32 v41, v41, v43
  v_cvt_pk_bf16_f32 v42, v40, v41
  ds_write_b32 v105, v42
  v_permlane32_swap_b32 v44, v46
  v_permlane32_swap_b32 v45, v47
  v_add_f32 v44, v44, v46
  v_add_f32 v45, v45, v47
  v_cvt_pk_bf16_f32 v46, v44, v45
  ds_write_b32 v106, v46
  v_permlane32_swap_b32 v48, v50
  v_permlane32_swap_b32 v49, v51
  v_add_f32 v48, v48, v50
  v_add_f32 v49, v49, v51
  v_cvt_pk_bf16_f32 v50, v48, v49
  ds_write_b32 v107, v50
  v_permlane32_swap_b32 v52, v54
  v_permlane32_swap_b32 v53, v55
  v_add_f32 v52, v52, v54
  v_add_f32 v53, v53, v55
  v_cvt_pk_bf16_f32 v54, v52, v53
  ds_write_b32 v108, v54
  v_permlane32_swap_b32 v56, v58
  v_permlane32_swap_b32 v57, v59
  v_add_f32 v56, v56, v58
  v_add_f32 v57, v57, v59
  v_cvt_pk_bf16_f32 v58, v56, v57
  ds_write_b32 v109, v58
  v_permlane32_swap_b32 v60, v62
  v_permlane32_swap_b32 v61, v63
  v_add_f32 v60, v60, v62
  v_add_f32 v61, v61, v63
  v_cvt_pk_bf16_f32 v62, v60, v61
  ds_write_b32 v110, v62
  v_permlane32_swap_b32 v64, v66
  v_permlane32_swap_b32 v65, v67
  v_add_f32 v64, v64, v66
  v_add_f32 v65, v65, v67
  v_cvt_pk_bf16_f32 v66, v64, v65
  ds_write_b32 v111, v66
  s_branch cB_va2_t2d
.p2align 6
cB_va3_loop:
  s_mov_b32 s30, 0
  s_barrier
  buffer_load_dwordx4 v[16:19], v2, s[8:11], s20 offen offset:2048 sc1
  buffer_load_dwordx4 v[20:23], v2, s[8:11], s20 offen offset:3072 sc1
  s_barrier
  buffer_load_dword v100, v116, s[8:11], s39 offen sc1
  s_add_u32 s27, s19, 2
  s_min_u32 s27, s27, 63
  s_lshr_b32 s27, s27, 3
  s_lshl_b32 s27, s27, 11
  s_add_u32 s27, s27, s35
  s_cmp_eq_u32 s27, s28
  s_cselect_b32 s29, 35328, s27
  buffer_load_dword v101, off, s[8:11], s29 sc1
  s_add_u32 s39, s39, 28672
  s_waitcnt vmcnt(2)
  ds_write_b128 v2, v[16:19] offset:10240
  ds_write_b128 v2, v[20:23] offset:11264
  v_smfmac_f32_16x16x64_bf16 v[36:39], v[16:19], a[16:23], v3
  v_smfmac_f32_16x16x64_bf16 v[40:43], v[16:19], a[72:79], v3
  v_smfmac_f32_16x16x64_bf16 v[44:47], v[16:19], a[128:135], v3
  v_smfmac_f32_16x16x64_bf16 v[48:51], v[16:19], a[184:191], v3
  v_smfmac_f32_16x16x64_bf16 v[52:55], v[16:19], a[240:247], v3
  s_waitcnt lgkmcnt(0)
  s_barrier
  ds_read_b128 v[8:11], v2 offset:8192
  ds_read_b128 v[12:15], v2 offset:9216
  ds_read_b128 v[24:27], v2 offset:12288
  ds_read_b128 v[28:31], v2 offset:13312
  ds_read_b128 v[32:35], v2 offset:14336
  v_smfmac_f32_16x16x64_bf16 v[56:59], v[16:19], v[160:167], v3
  v_smfmac_f32_16x16x64_bf16 v[60:63], v[16:19], v[216:223], v3
  v_smfmac_f32_16x16x64_bf16 v[36:39], v[20:23], a[24:31], v3
  v_smfmac_f32_16x16x64_bf16 v[40:43], v[20:23], a[80:87], v3
  v_smfmac_f32_16x16x64_bf16 v[44:47], v[20:23], a[136:143], v3
  v_smfmac_f32_16x16x64_bf16 v[48:51], v[20:23], a[192:199], v3
  v_smfmac_f32_16x16x64_bf16 v[52:55], v[20:23], a[248:255], v3
  v_smfmac_f32_16x16x64_bf16 v[56:59], v[20:23], v[168:175], v3
  v_smfmac_f32_16x16x64_bf16 v[60:63], v[20:23], v[224:231], v3
  s_waitcnt lgkmcnt(4)
  v_smfmac_f32_16x16x64_bf16 v[36:39], v[8:11], a[0:7], v3
  s_waitcnt lgkmcnt(3)
  v_smfmac_f32_16x16x64_bf16 v[36:39], v[12:15], a[8:15], v3
  s_waitcnt lgkmcnt(2)
  v_smfmac_f32_16x16x64_bf16 v[36:39], v[24:27], a[32:39], v3
  s_waitcnt lgkmcnt(1)
  v_smfmac_f32_16x16x64_bf16 v[36:39], v[28:31], a[40:47], v3
  s_waitcnt lgkmcnt(0)
  v_smfmac_f32_16x16x64_bf16 v[36:39], v[32:35], a[48:55], v3
  v_smfmac_f32_16x16x64_bf16 v[40:43], v[8:11], a[56:63], v3
  v_smfmac_f32_16x16x64_bf16 v[40:43], v[12:15], a[64:71], v3
  v_smfmac_f32_16x16x64_bf16 v[40:43], v[24:27], a[88:95], v3
  v_permlane32_swap_b32 v36, v38
  v_smfmac_f32_16x16x64_bf16 v[40:43], v[28:31], a[96:103], v3
  v_permlane32_swap_b32 v37, v39
  v_smfmac_f32_16x16x64_bf16 v[40:43], v[32:35], a[104:111], v3
  v_add_f32 v36, v36, v38
  v_smfmac_f32_16x16x64_bf16 v[44:47], v[8:11], a[112:119], v3
  v_add_f32 v37, v37, v39
  v_smfmac_f32_16x16x64_bf16 v[44:47], v[12:15], a[120:127], v3
  v_cmp_u_f32 vcc, v36, v37
  v_smfmac_f32_16x16x64_bf16 v[44:47], v[24:27], a[144:151], v3
  v_cvt_pk_bf16_f32 v38, v36, v37
  v_smfmac_f32_16x16x64_bf16 v[44:47], v[28:31], a[152:159], v3
  ds_write_b32 v104, v38
  s_cbranch_vccnz cB_va3_slow
  v_permlane32_swap_b32 v40, v42
  v_smfmac_f32_16x16x64_bf16 v[44:47], v[32:35], a[160:167], v3
  v_permlane32_swap_b32 v41, v43
  v_smfmac_f32_16x16x64_bf16 v[48:51], v[8:11], a[168:175], v3
  v_add_f32 v40, v40, v42
  v_smfmac_f32_16x16x64_bf16 v[48:51], v[12:15], a[176:183], v3
  v_add_f32 v41, v41, v43
  v_smfmac_f32_16x16x64_bf16 v[48:51], v[24:27], a[200:207], v3
  v_cvt_pk_bf16_f32 v42, v40, v41
  v_smfmac_f32_16x16x64_bf16 v[48:51], v[28:31], a[208:215], v3
  ds_write_b32 v105, v42
  v_permlane32_swap_b32 v44, v46
  v_smfmac_f32_16x16x64_bf16 v[48:51], v[32:35], a[216:223], v3
  v_permlane32_swap_b32 v45, v47
  v_smfmac_f32_16x16x64_bf16 v[52:55], v[8:11], a[224:231], v3
  v_add_f32 v44, v44, v46
  v_smfmac_f32_16x16x64_bf16 v[52:55], v[12:15], a[232:239], v3
  v_add_f32 v45, v45, v47
  v_smfmac_f32_16x16x64_bf16 v[52:55], v[24:27], v[120:127], v3
  v_cvt_pk_bf16_f32 v46, v44, v45
  v_smfmac_f32_16x16x64_bf16 v[52:55], v[28:31], v[128:135], v3
  ds_write_b32 v106, v46
  v_permlane32_swap_b32 v48, v50
  v_smfmac_f32_16x16x64_bf16 v[52:55], v[32:35], v[136:143], v3
  v_permlane32_swap_b32 v49, v51
  v_smfmac_f32_16x16x64_bf16 v[56:59], v[8:11], v[144:151], v3
  v_add_f32 v48, v48, v50
  v_smfmac_f32_16x16x64_bf16 v[56:59], v[12:15], v[152:159], v3
  v_add_f32 v49, v49, v51
  v_smfmac_f32_16x16x64_bf16 v[56:59], v[24:27], v[176:183], v3
  v_cvt_pk_bf16_f32 v50, v48, v49
  v_smfmac_f32_16x16x64_bf16 v[56:59], v[28:31], v[184:191], v3
  ds_write_b32 v107, v50
  v_permlane32_swap_b32 v52, v54
  v_smfmac_f32_16x16x64_bf16 v[56:59], v[32:35], v[192:199], v3
  v_permlane32_swap_b32 v53, v55
  v_smfmac_f32_16x16x64_bf16 v[60:63], v[8:11], v[200:207], v3
  v_add_f32 v52, v52, v54
  v_smfmac_f32_16x16x64_bf16 v[60:63], v[12:15], v[208:215], v3
  v_add_f32 v53, v53, v55
  v_smfmac_f32_16x16x64_bf16 v[60:63], v[24:27], v[232:239], v3
  v_cvt_pk_bf16_f32 v54, v52, v53
  v_smfmac_f32_16x16x64_bf16 v[60:63], v[28:31], v[240:247], v3
  ds_write_b32 v108, v54
  v_permlane32_swap_b32 v56, v58
  v_smfmac_f32_16x16x64_bf16 v[60:63], v[32:35], v[248:255], v3
  v_permlane32_swap_b32 v57, v59
  v_add_f32 v56, v56, v58
  v_add_f32 v57, v57, v59
  v_cvt_pk_bf16_f32 v58, v56, v57
  ds_write_b32 v109, v58
  s_nop 2
  v_permlane32_swap_b32 v60, v62
  v_permlane32_swap_b32 v61, v63
  v_add_f32 v60, v60, v62
  v_add_f32 v61, v61, v63
  v_cvt_pk_bf16_f32 v62, v60, v61
  ds_write_b32 v110, v62
cB_va3_t2d:
  v_mov_b32 v117, s18
  s_cmp_eq_u32 s27, s28
  s_cbranch_scc1 cB_va3_vok
cB_va3_vow:
  s_waitcnt vmcnt(0)
  v_cmp_ne_u32 vcc, 56, v101
  s_cbranch_vccnz cB_va3_vor
  s_mov_b32 s28, s27
cB_va3_vok:
  s_waitcnt lgkmcnt(0)
  s_setprio 3
  s_barrier
  v_mov_b32 v36, 0
  v_mov_b32 v37, 0
  buffer_store_dword v117, v118, s[8:11], 0 offen sc1
  s_setprio 0
  s_cmp_eq_u32 s19, 63
  s_cbranch_scc1 cB_done
  v_mov_b32 v38, 0
  v_mov_b32 v39, 0
  v_mov_b32 v40, 0
  v_mov_b32 v41, 0
  v_mov_b32 v42, 0
  v_mov_b32 v43, 0
  v_mov_b32 v44, 0
  v_mov_b32 v45, 0
  v_mov_b32 v46, 0
  v_mov_b32 v47, 0
  v_mov_b32 v48, 0
  v_mov_b32 v49, 0
  v_mov_b32 v50, 0
  v_mov_b32 v51, 0
  v_mov_b32 v52, 0
  v_mov_b32 v53, 0
  v_mov_b32 v54, 0
  v_mov_b32 v55, 0
  v_mov_b32 v56, 0
  v_mov_b32 v57, 0
  v_mov_b32 v58, 0
  v_mov_b32 v59, 0
  v_mov_b32 v60, 0
  v_mov_b32 v61, 0
  v_mov_b32 v62, 0
  v_mov_b32 v63, 0
  s_mov_b32 s19, s18
  s_add_u32 s18, s18, 1
  s_mov_b32 s22, s20
  s_mov_b32 s20, s21
  s_mov_b32 s21, s22
  s_add_u32 s23, s20, 4096
  s_branch cB_va3_loop
cB_va3_slow:
  s_waitcnt lgkmcnt(0)
cB_va3_sl1:
  s_add_u32 s31, s31, 0x1000000
  buffer_load_dwordx4 v[8:11], v2, s[8:11], s20 offen offset:0 sc1
  buffer_load_dwordx4 v[12:15], v2, s[8:11], s20 offen offset:1024 sc1
  buffer_load_dwordx4 v[16:19], v2, s[8:11], s20 offen offset:2048 sc1
  buffer_load_dwordx4 v[20:23], v2, s[8:11], s20 offen offset:3072 sc1
  buffer_load_dwordx4 v[24:27], v2, s[8:11], s23 offen offset:0 sc1
  buffer_load_dwordx4 v[28:31], v2, s[8:11], s23 offen offset:1024 sc1
  buffer_load_dwordx4 v[32:35], v2, s[8:11], s23 offen offset:2048 sc1
  s_waitcnt vmcnt(0)
  v_max3_u32 v36, v8, v9, v10
  v_max3_u32 v36, v36, v11, v12
  v_max3_u32 v36, v36, v13, v14
  v_max3_u32 v36, v36, v15, v16
  v_max3_u32 v36, v36, v17, v18
  v_max3_u32 v36, v36, v19, v20
  v_max3_u32 v36, v36, v21, v22
  v_max3_u32 v36, v36, v23, v24
  v_max3_u32 v36, v36, v25, v26
  v_max3_u32 v36, v36, v27, v28
  v_max3_u32 v36, v36, v29, v30
  v_max3_u32 v36, v36, v31, v32
  v_max3_u32 v36, v36, v33, v34
  v_max_u32 v36, v36, v35
  v_cmp_eq_u32 vcc, -1, v36
  s_cbranch_vccz cB_va3_sl2
  s_add_u32 s30, s30, 1
  s_cmp_lt_u32 s30, 400000
  s_cbranch_scc1 cB_va3_sl1
  s_branch cB_abort
cB_va3_sl2:
  v_mov_b32 v36, 0
  v_mov_b32 v37, 0
  v_mov_b32 v38, 0
  v_mov_b32 v39, 0
  v_mov_b32 v40, 0
  v_mov_b32 v41, 0
  v_mov_b32 v42, 0
  v_mov_b32 v43, 0
  v_mov_b32 v44, 0
  v_mov_b32 v45, 0
  v_mov_b32 v46, 0
  v_mov_b32 v47, 0
  v_mov_b32 v48, 0
  v_mov_b32 v49, 0
  v_mov_b32 v50, 0
  v_mov_b32 v51, 0
  v_mov_b32 v52, 0
  v_mov_b32 v53, 0
  v_mov_b32 v54, 0
  v_mov_b32 v55, 0
  v_mov_b32 v56, 0
  v_mov_b32 v57, 0
  v_mov_b32 v58, 0
  v_mov_b32 v59, 0
  v_mov_b32 v60, 0
  v_mov_b32 v61, 0
  v_mov_b32 v62, 0
  v_mov_b32 v63, 0
  v_smfmac_f32_16x16x64_bf16 v[36:39], v[8:11], a[0:7], v3
  v_smfmac_f32_16x16x64_bf16 v[40:43], v[8:11], a[56:63], v3
  v_smfmac_f32_16x16x64_bf16 v[44:47], v[8:11], a[112:119], v3
  v_smfmac_f32_16x16x64_bf16 v[48:51], v[8:11], a[168:175], v3
  v_smfmac_f32_16x16x64_bf16 v[52:55], v[8:11], a[224:231], v3
  v_smfmac_f32_16x16x64_bf16 v[56:59], v[8:11], v[144:151], v3
  v_smfmac_f32_16x16x64_bf16 v[60:63], v[8:11], v[200:207], v3
  v_smfmac_f32_16x16x64_bf16 v[36:39], v[12:15], a[8:15], v3
  v_smfmac_f32_16x16x64_bf16 v[40:43], v[12:15], a[64:71], v3
  v_smfmac_f32_16x16x64_bf16 v[44:47], v[12:15], a[120:127], v3
  v_smfmac_f32_16x16x64_bf16 v[48:51], v[12:15], a[176:183], v3
  v_smfmac_f32_16x16x64_bf16 v[52:55], v[12:15], a[232:239], v3
  v_smfmac_f32_16x16x64_bf16 v[56:59], v[12:15], v[152:159], v3
  v_smfmac_f32_16x16x64_bf16 v[60:63], v[12:15], v[208:215], v3
  v_smfmac_f32_16x16x64_bf16 v[36:39], v[16:19], a[16:23], v3
  v_smfmac_f32_16x16x64_bf16 v[40:43], v[16:19], a[72:79], v3
  v_smfmac_f32_16x16x64_bf16 v[44:47], v[16:19], a[128:135], v3
  v_smfmac_f32_16x16x64_bf16 v[48:51], v[16:19], a[184:191], v3
  v_smfmac_f32_16x16x64_bf16 v[52:55], v[16:19], a[240:247], v3
  v_smfmac_f32_16x16x64_bf16 v[56:59], v[16:19], v[160:167], v3
  v_smfmac_f32_16x16x64_bf16 v[60:63], v[16:19], v[216:223], v3
  v_smfmac_f32_16x16x64_bf16 v[36:39], v[20:23], a[24:31], v3
  v_smfmac_f32_16x16x64_bf16 v[40:43], v[20:23], a[80:87], v3
  v_smfmac_f32_16x16x64_bf16 v[44:47], v[20:23], a[136:143], v3
  v_smfmac_f32_16x16x64_bf16 v[48:51], v[20:23], a[192:199], v3
  v_smfmac_f32_16x16x64_bf16 v[52:55], v[20:23], a[248:255], v3
  v_smfmac_f32_16x16x64_bf16 v[56:59], v[20:23], v[168:175], v3
  v_smfmac_f32_16x16x64_bf16 v[60:63], v[20:23], v[224:231], v3
  v_smfmac_f32_16x16x64_bf16 v[36:39], v[24:27], a[32:39], v3
  v_smfmac_f32_16x16x64_bf16 v[40:43], v[24:27], a[88:95], v3
  v_smfmac_f32_16x16x64_bf16 v[44:47], v[24:27], a[144:151], v3
  v_smfmac_f32_16x16x64_bf16 v[48:51], v[24:27], a[200:207], v3
  v_smfmac_f32_16x16x64_bf16 v[52:55], v[24:27], v[120:127], v3
  v_smfmac_f32_16x16x64_bf16 v[56:59], v[24:27], v[176:183], v3
  v_smfmac_f32_16x16x64_bf16 v[60:63], v[24:27], v[232:239], v3
  v_smfmac_f32_16x16x64_bf16 v[36:39], v[28:31], a[40:47], v3
  v_smfmac_f32_16x16x64_bf16 v[40:43], v[28:31], a[96:103], v3
  v_smfmac_f32_16x16x64_bf16 v[44:47], v[28:31], a[152:159], v3
  v_smfmac_f32_16x16x64_bf16 v[48:51], v[28:31], a[208:215], v3
  v_smfmac_f32_16x16x64_bf16 v[52:55], v[28:31], v[128:135], v3
  v_smfmac_f32_16x16x64_bf16 v[56:59], v[28:31], v[184:191], v3
  v_smfmac_f32_16x16x64_bf16 v[60:63], v[28:31], v[240:247], v3
  v_smfmac_f32_16x16x64_bf16 v[36:39], v[32:35], a[48:55], v3
  v_smfmac_f32_16x16x64_bf16 v[40:43], v[32:35], a[104:111], v3
  v_smfmac_f32_16x16x64_bf16 v[44:47], v[32:35], a[160:167], v3
  v_smfmac_f32_16x16x64_bf16 v[48:51], v[32:35], a[216:223], v3
  v_smfmac_f32_16x16x64_bf16 v[52:55], v[32:35], v[136:143], v3
  v_smfmac_f32_16x16x64_bf16 v[56:59], v[32:35], v[192:199], v3
  v_smfmac_f32_16x16x64_bf16 v[60:63], v[32:35], v[248:255], v3
  v_permlane32_swap_b32 v36, v38
  v_permlane32_swap_b32 v37, v39
  v_add_f32 v36, v36, v38
  v_add_f32 v37, v37, v39
  v_cvt_pk_bf16_f32 v38, v36, v37
  ds_write_b32 v104, v38
  v_permlane32_swap_b32 v40, v42
  v_permlane32_swap_b32 v41, v43
  v_add_f32 v40, v40, v42
  v_add_f32 v41, v41, v43
  v_cvt_pk_bf16_f32 v42, v40, v41
  ds_write_b32 v105, v42
  v_permlane32_swap_b32 v44, v46
  v_permlane32_swap_b32 v45, v47
  v_add_f32 v44, v44, v46
  v_add_f32 v45, v45, v47
  v_cvt_pk_bf16_f32 v46, v44, v45
  ds_write_b32 v106, v46
  v_permlane32_swap_b32 v48, v50
  v_permlane32_swap_b32 v49, v51
  v_add_f32 v48, v48, v50
  v_add_f32 v49, v49, v51
  v_cvt_pk_bf16_f32 v50, v48, v49
  ds_write_b32 v107, v50
  v_permlane32_swap_b32 v52, v54
  v_permlane32_swap_b32 v53, v55
  v_add_f32 v52, v52, v54
  v_add_f32 v53, v53, v55
  v_cvt_pk_bf16_f32 v54, v52, v53
  ds_write_b32 v108, v54
  v_permlane32_swap_b32 v56, v58
  v_permlane32_swap_b32 v57, v59
  v_add_f32 v56, v56, v58
  v_add_f32 v57, v57, v59
  v_cvt_pk_bf16_f32 v58, v56, v57
  ds_write_b32 v109, v58
  v_permlane32_swap_b32 v60, v62
  v_permlane32_swap_b32 v61, v63
  v_add_f32 v60, v60, v62
  v_add_f32 v61, v61, v63
  v_cvt_pk_bf16_f32 v62, v60, v61
  ds_write_b32 v110, v62
  s_branch cB_va3_t2d
cB_va3_vor:
  s_sleep 2
  buffer_load_dword v101, off, s[8:11], s27 sc1
  s_add_u32 s30, s30, 1
  s_cmp_lt_u32 s30, 400000
  s_cbranch_scc1 cB_va3_vow
  s_branch cB_abort
cB_abort:
  v_mov_b32 v4, 0xdead
  v_mov_b32 v5, 16
  buffer_store_dword v4, v5, s[12:15], 0 offen
  s_branch ch_end
cB_done:
  s_branch ch_end
ch_worker:
  s_sub_u32 s35, s3, 4
  s_and_b32 s35, s35, 7
  s_lshr_b32 s36, s2, 3
  s_lshl_b32 s33, s35, 5
  s_add_u32 s33, s33, s36
  s_mov_b32 s97, 0
  s_mov_b32 s96, 0
  s_mov_b32 s37, 0
  s_mov_b32 s38, 0
  s_mov_b32 s39, 0xffff0000
  s_mov_b32 s101, -1
  v_and_b32 v1, 63, v0
  v_lshlrev_b32 v2, 4, v1
  v_lshrrev_b32 v3, 4, v1
  v_and_b32 v4, 15, v1
  s_cmp_ge_u32 s33, 224
  s_cbranch_scc1 wp_all
  s_mov_b32 s68, s44
  s_and_b32 s69, s45, 0xffff
  s_mov_b32 s70, 3670016
  s_mov_b32 s71, 0x20000
  s_and_b32 s20, s33, 0xe0
  s_mul_i32 s20, s20, 9363
  s_lshr_b32 s20, s20, 16
  s_lshl_b32 s20, s20, 10
  s_and_b32 s21, s33, 31
  s_mul_i32 s21, s21, 192
  s_add_u32 s20, s20, s21
  v_min_u32 v7, 191, v0
  v_add_u32 v7, s20, v7
  v_lshrrev_b32 v8, 11, v7
  v_min_u32 v8, 15, v8
  v_bfe_u32 v9, v7, 2, 9
  v_lshlrev_b32 v9, 13, v9
  v_lshl_add_u32 v9, v8, 9, v9
  v_and_b32 v7, 3, v7
  v_lshl_add_u32 v9, v7, 7, v9
  buffer_load_dword v253, v9, s[68:71], 0 offen
  s_mov_b32 s68, s40
  s_and_b32 s69, s41, 0xffff
  s_mov_b32 s70, 3670016
  s_mov_b32 s71, 0x20000
  s_and_b32 s20, s33, 0xe0
  s_mul_i32 s20, s20, 9363
  s_lshr_b32 s20, s20, 16
  s_lshl_b32 s20, s20, 10
  s_and_b32 s21, s33, 31
  s_mul_i32 s21, s21, 192
  s_add_u32 s20, s20, s21
  v_min_u32 v7, 191, v0
  v_add_u32 v7, s20, v7
  v_lshrrev_b32 v8, 11, v7
  v_min_u32 v8, 15, v8
  v_bfe_u32 v9, v7, 2, 9
  v_lshlrev_b32 v9, 13, v9
  v_lshl_add_u32 v9, v8, 9, v9
  v_and_b32 v7, 3, v7
  v_lshl_add_u32 v9, v7, 7, v9
  buffer_load_dword v253, v9, s[68:71], 0 offen
  v_lshrrev_b32 v5, 5, v1
  v_and_b32 v6, 31, v1
  v_xor_b32 v8, v6, v5
  v_lshlrev_b32 v8, 4, v8
  v_lshl_add_u32 v16, v5, 13, v8
  v_xor_b32 v17, 32, v16
  v_xor_b32 v18, 64, v16
  v_xor_b32 v19, 96, v16
  v_xor_b32 v20, 128, v16
  v_xor_b32 v21, 160, v16
  v_xor_b32 v22, 192, v16
  v_xor_b32 v23, 224, v16
  s_lshl_b32 s20, s16, 6
  v_xor_b32 v26, s20, v16
  v_xor_b32 v27, 32, v26
wp_B:
  s_mul_i32 s17, s33, 4682
  s_lshr_b32 s17, s17, 16
  s_mul_i32 s23, s17, 14
  s_sub_u32 s19, s33, s23
  s_cmp_lt_u32 s19, 7
  s_cselect_b32 s18, 0, 7
  s_cselect_b32 s28, 0, 8
  s_sub_u32 s18, s19, s18
  s_add_u32 s28, s28, s16
  s_lshl_b32 s25, s16, 15
  s_add_u32 s25, s25, 32768
  s_lshl_b32 s26, s17, 9
  s_lshl_b32 s20, s33, 2
  s_add_u32 s20, s20, s16
  s_mul_i32 s21, s20, 9363
  s_lshr_b32 s21, s21, 16
  s_mul_i32 s22, s21, 7
  s_sub_u32 s22, s20, s22
  s_mul_i32 s21, s21, 14336
  s_lshl_b32 s20, s22, 7
  s_add_u32 s20, s20, s21
  s_lshl_b32 s22, s22, 11
  s_add_u32 s52, s21, s22
  s_mov_b32 s68, s48
  s_and_b32 s69, s49, 0xffff
  s_mov_b32 s70, 1835008
  s_mov_b32 s71, 0x20000
  v_mul_u32_u24 v7, 896, v4
  v_lshl_add_u32 v7, v3, 5, v7
  buffer_load_dwordx4 v[128:131], v7, s[68:71], s20 offen
  buffer_load_dwordx4 v[132:135], v7, s[68:71], s20 offen offset:16
  s_mov_b32 s60, s44
  s_and_b32 s61, s45, 0xffff
  s_mov_b32 s62, 3670016
  s_mov_b32 s63, 0x20000
  s_mov_b32 s56, s46
  s_and_b32 s57, s47, 0xffff
  s_mov_b32 s58, 3670016
  s_mov_b32 s59, 0x20000
  s_mul_i32 s27, s17, 229376
  s_lshl_b32 s30, s18, 7
  s_add_u32 s27, s27, s30
  s_mul_i32 s30, s16, 57344
  s_add_u32 s27, s27, s30
  v_lshrrev_b32 v7, 3, v1
  v_and_b32 v8, 7, v1
  v_and_b32 v9, 2, v7
  v_xor_b32 v8, v8, v9
  v_mul_u32_u24 v7, 896, v7
  v_lshl_add_u32 v24, v8, 4, v7
  v_xor_b32 v25, 64, v24
  s_lshl_b32 s30, s16, 13
  s_add_u32 m0, s30, 0
  s_nop 0
  buffer_load_dwordx4 v24, s[56:59], s27 offen  lds
  s_add_u32 s27, s27, 7168
  s_add_u32 m0, s30, 1024
  s_nop 0
  buffer_load_dwordx4 v25, s[56:59], s27 offen  lds
  s_add_u32 s27, s27, 7168
  s_add_u32 m0, s30, 2048
  s_nop 0
  buffer_load_dwordx4 v24, s[56:59], s27 offen  lds
  s_add_u32 s27, s27, 7168
  s_add_u32 m0, s30, 3072
  s_nop 0
  buffer_load_dwordx4 v25, s[56:59], s27 offen  lds
  s_add_u32 s27, s27, 7168
  s_add_u32 m0, s30, 4096
  s_nop 0
  buffer_load_dwordx4 v24, s[56:59], s27 offen  lds
  s_add_u32 s27, s27, 7168
  s_add_u32 m0, s30, 5120
  s_nop 0
  buffer_load_dwordx4 v25, s[56:59], s27 offen  lds
  s_add_u32 s27, s27, 7168
  s_add_u32 m0, s30, 6144
  s_nop 0
  buffer_load_dwordx4 v24, s[56:59], s27 offen  lds
  s_add_u32 s27, s27, 7168
  s_add_u32 m0, s30, 7168
  s_nop 0
  buffer_load_dwordx4 v25, s[56:59], s27 offen  lds
  s_add_u32 s27, s27, 7168
  s_add_u32 s27, s28, 0
  s_min_u32 s27, s27, 13
  s_lshl_b32 s27, s27, 18
  s_add_u32 s27, s27, s26
  s_mov_b32 s55, s27
  v_lshrrev_b32 v7, 2, v4
  v_lshlrev_b32 v11, 4, v7
  v_lshlrev_b32 v7, 3, v7
  v_and_b32 v8, 3, v4
  v_add_u32 v7, v7, v8
  v_and_b32 v8, 2, v4
  v_lshl_add_u32 v11, v8, 1, v11
  v_and_b32 v8, 1, v4
  v_add_u32 v11, v11, v8
  v_or_b32 v10, 0, v3
  v_xor_b32 v10, v10, v4
  v_lshlrev_b32 v10, 4, v10
  v_lshl_add_u32 v44, v11, 9, v10
  v_lshl_add_u32 v10, v7, 9, v10
  v_add_u32 v32, s25, v10
  v_or_b32 v10, 4, v3
  v_xor_b32 v10, v10, v4
  v_lshlrev_b32 v10, 4, v10
  v_lshl_add_u32 v45, v11, 9, v10
  v_lshl_add_u32 v10, v7, 9, v10
  v_add_u32 v33, s25, v10
  v_or_b32 v10, 8, v3
  v_xor_b32 v10, v10, v4
  v_lshlrev_b32 v10, 4, v10
  v_lshl_add_u32 v46, v11, 9, v10
  v_lshl_add_u32 v10, v7, 9, v10
  v_add_u32 v34, s25, v10
  v_or_b32 v10, 12, v3
  v_xor_b32 v10, v10, v4
  v_lshlrev_b32 v10, 4, v10
  v_lshl_add_u32 v47, v11, 9, v10
  v_lshl_add_u32 v10, v7, 9, v10
  v_add_u32 v35, s25, v10
  s_mul_i32 s30, s17, 401408
  s_mul_i32 s31, s18, 57344
  s_add_u32 s30, s30, s31
  s_add_u32 s30, s30, 33554432
  v_add_u32 v28, s30, v2
  s_add_u32 s30, s30, 14336
  v_add_u32 v29, s30, v2
  s_add_u32 s30, s30, 14336
  v_add_u32 v30, s30, v2
  s_add_u32 s30, s30, 14336
  v_add_u32 v31, s30, v2
  s_add_u32 s30, s30, 14336
  v_mov_b32 v48, 1035512379
  v_lshrrev_b32 v7, 2, v4
  v_lshl_add_u32 v7, v3, 3, v7
  v_lshlrev_b32 v7, 7, v7
  v_and_b32 v8, 3, v4
  v_lshl_add_u32 v7, v8, 3, v7
  v_lshrrev_b32 v8, 3, v4
  v_and_b32 v9, 1, v3
  v_lshl_add_u32 v8, v9, 1, v8
  v_lshl_add_u32 v40, v8, 5, v7
  s_mul_i32 s31, s17, 28
  s_mov_b32 s29, 401408
  s_lshl_b32 s30, s18, 6
  s_add_u32 s30, s30, 0
  v_add_u32 v8, s30, v4
  v_subrev_u32 v9, 256, v8
  v_mul_u32_u24 v11, 171, v9
  v_lshrrev_b32 v11, 11, v11
  v_mul_u32_u24 v38, 12, v11
  v_sub_u32 v38, v9, v38
  v_add_u32 v38, 16, v38
  v_lshrrev_b32 v10, 4, v8
  v_cmp_gt_i32 vcc, 0, v9
  s_nop 1
  v_cndmask_b32 v10, v11, v10, vcc
  v_cndmask_b32 v39, v38, v4, vcc
  v_add_u32 v39, s31, v39
  v_lshrrev_b32 v38, 4, v39
  v_and_b32 v39, 15, v39
  v_mul_lo_u32 v10, v10, s29
  v_mul_u32_u24 v38, 14336, v38
  v_add_u32 v10, v10, v38
  v_lshl_add_u32 v10, v3, 8, v10
  v_lshl_add_u32 v10, v39, 4, v10
  v_add_u32 v12, 39976960, v10
  v_xor_b32 v41, 32, v40
  s_lshl_b32 s30, s18, 6
  s_add_u32 s30, s30, 16
  v_add_u32 v8, s30, v4
  v_subrev_u32 v9, 256, v8
  v_mul_u32_u24 v11, 171, v9
  v_lshrrev_b32 v11, 11, v11
  v_mul_u32_u24 v38, 12, v11
  v_sub_u32 v38, v9, v38
  v_add_u32 v38, 16, v38
  v_lshrrev_b32 v10, 4, v8
  v_cmp_gt_i32 vcc, 0, v9
  s_nop 1
  v_cndmask_b32 v10, v11, v10, vcc
  v_cndmask_b32 v39, v38, v4, vcc
  v_add_u32 v39, s31, v39
  v_lshrrev_b32 v38, 4, v39
  v_and_b32 v39, 15, v39
  v_mul_lo_u32 v10, v10, s29
  v_mul_u32_u24 v38, 14336, v38
  v_add_u32 v10, v10, v38
  v_lshl_add_u32 v10, v3, 8, v10
  v_lshl_add_u32 v10, v39, 4, v10
  v_add_u32 v13, 39976960, v10
  v_xor_b32 v42, 64, v40
  s_lshl_b32 s30, s18, 6
  s_add_u32 s30, s30, 32
  v_add_u32 v8, s30, v4
  v_subrev_u32 v9, 256, v8
  v_mul_u32_u24 v11, 171, v9
  v_lshrrev_b32 v11, 11, v11
  v_mul_u32_u24 v38, 12, v11
  v_sub_u32 v38, v9, v38
  v_add_u32 v38, 16, v38
  v_lshrrev_b32 v10, 4, v8
  v_cmp_gt_i32 vcc, 0, v9
  s_nop 1
  v_cndmask_b32 v10, v11, v10, vcc
  v_cndmask_b32 v39, v38, v4, vcc
  v_add_u32 v39, s31, v39
  v_lshrrev_b32 v38, 4, v39
  v_and_b32 v39, 15, v39
  v_mul_lo_u32 v10, v10, s29
  v_mul_u32_u24 v38, 14336, v38
  v_add_u32 v10, v10, v38
  v_lshl_add_u32 v10, v3, 8, v10
  v_lshl_add_u32 v10, v39, 4, v10
  v_add_u32 v14, 39976960, v10
  v_xor_b32 v43, 96, v40
  s_lshl_b32 s30, s18, 6
  s_add_u32 s30, s30, 48
  v_add_u32 v8, s30, v4
  v_subrev_u32 v9, 256, v8
  v_mul_u32_u24 v11, 171, v9
  v_lshrrev_b32 v11, 11, v11
  v_mul_u32_u24 v38, 12, v11
  v_sub_u32 v38, v9, v38
  v_add_u32 v38, 16, v38
  v_lshrrev_b32 v10, 4, v8
  v_cmp_gt_i32 vcc, 0, v9
  s_nop 1
  v_cndmask_b32 v10, v11, v10, vcc
  v_cndmask_b32 v39, v38, v4, vcc
  v_add_u32 v39, s31, v39
  v_lshrrev_b32 v38, 4, v39
  v_and_b32 v39, 15, v39
  v_mul_lo_u32 v10, v10, s29
  v_mul_u32_u24 v38, 14336, v38
  v_add_u32 v10, v10, v38
  v_lshl_add_u32 v10, v3, 8, v10
  v_lshl_add_u32 v10, v39, 4, v10
  v_add_u32 v15, 39976960, v10
  s_mov_b32 s27, s55
  s_add_u32 m0, s25, 0
  s_nop 0
  buffer_load_dwordx4 v16, s[60:63], s27 offen  lds
  s_add_u32 s27, s27, 16384
  s_add_u32 m0, s25, 1024
  s_nop 0
  buffer_load_dwordx4 v17, s[60:63], s27 offen  lds
  s_add_u32 s27, s27, 16384
  s_add_u32 m0, s25, 2048
  s_nop 0
  buffer_load_dwordx4 v16, s[60:63], s27 offen  lds
  s_add_u32 s27, s27, 16384
  s_add_u32 m0, s25, 3072
  s_nop 0
  buffer_load_dwordx4 v17, s[60:63], s27 offen  lds
  s_add_u32 s27, s27, 16384
  s_add_u32 m0, s25, 4096
  s_nop 0
  buffer_load_dwordx4 v18, s[60:63], s27 offen  lds
  s_add_u32 s27, s27, 16384
  s_add_u32 m0, s25, 5120
  s_nop 0
  buffer_load_dwordx4 v19, s[60:63], s27 offen  lds
  s_add_u32 s27, s27, 16384
  s_add_u32 m0, s25, 6144
  s_nop 0
  buffer_load_dwordx4 v18, s[60:63], s27 offen  lds
  s_add_u32 s27, s27, 16384
  s_add_u32 m0, s25, 7168
  s_nop 0
  buffer_load_dwordx4 v19, s[60:63], s27 offen  lds
  s_add_u32 s27, s27, 16384
  s_add_u32 m0, s25, 8192
  s_nop 0
  buffer_load_dwordx4 v20, s[60:63], s27 offen  lds
  s_add_u32 s27, s27, 16384
  s_add_u32 m0, s25, 9216
  s_nop 0
  buffer_load_dwordx4 v21, s[60:63], s27 offen  lds
  s_add_u32 s27, s27, 16384
  s_add_u32 m0, s25, 10240
  s_nop 0
  buffer_load_dwordx4 v20, s[60:63], s27 offen  lds
  s_add_u32 s27, s27, 16384
  s_add_u32 m0, s25, 11264
  s_nop 0
  buffer_load_dwordx4 v21, s[60:63], s27 offen  lds
  s_add_u32 s27, s27, 16384
  s_add_u32 m0, s25, 12288
  s_nop 0
  buffer_load_dwordx4 v22, s[60:63], s27 offen  lds
  s_add_u32 s27, s27, 16384
  s_add_u32 m0, s25, 13312
  s_nop 0
  buffer_load_dwordx4 v23, s[60:63], s27 offen  lds
  s_add_u32 s27, s27, 16384
  s_add_u32 m0, s25, 14336
  s_nop 0
  buffer_load_dwordx4 v22, s[60:63], s27 offen  lds
  s_add_u32 s27, s27, 16384
  s_add_u32 m0, s25, 15360
  s_nop 0
  buffer_load_dwordx4 v23, s[60:63], s27 offen  lds
  s_add_u32 s27, s27, 16384
  s_add_u32 s27, s28, 4
  s_min_u32 s27, s27, 13
  s_lshl_b32 s27, s27, 18
  s_add_u32 s27, s27, s26
  s_add_u32 m0, s25, 16384
  s_nop 0
  buffer_load_dwordx4 v16, s[60:63], s27 offen  lds
  s_add_u32 s27, s27, 16384
  s_add_u32 m0, s25, 17408
  s_nop 0
  buffer_load_dwordx4 v17, s[60:63], s27 offen  lds
  s_add_u32 s27, s27, 16384
  s_add_u32 m0, s25, 18432
  s_nop 0
  buffer_load_dwordx4 v16, s[60:63], s27 offen  lds
  s_add_u32 s27, s27, 16384
  s_add_u32 m0, s25, 19456
  s_nop 0
  buffer_load_dwordx4 v17, s[60:63], s27 offen  lds
  s_add_u32 s27, s27, 16384
  s_add_u32 m0, s25, 20480
  s_nop 0
  buffer_load_dwordx4 v18, s[60:63], s27 offen  lds
  s_add_u32 s27, s27, 16384
  s_add_u32 m0, s25, 21504
  s_nop 0
  buffer_load_dwordx4 v19, s[60:63], s27 offen  lds
  s_add_u32 s27, s27, 16384
  s_add_u32 m0, s25, 22528
  s_nop 0
  buffer_load_dwordx4 v18, s[60:63], s27 offen  lds
  s_add_u32 s27, s27, 16384
  s_add_u32 m0, s25, 23552
  s_nop 0
  buffer_load_dwordx4 v19, s[60:63], s27 offen  lds
  s_add_u32 s27, s27, 16384
  s_add_u32 m0, s25, 24576
  s_nop 0
  buffer_load_dwordx4 v20, s[60:63], s27 offen  lds
  s_add_u32 s27, s27, 16384
  s_add_u32 m0, s25, 25600
  s_nop 0
  buffer_load_dwordx4 v21, s[60:63], s27 offen  lds
  s_add_u32 s27, s27, 16384
  s_add_u32 m0, s25, 26624
  s_nop 0
  buffer_load_dwordx4 v20, s[60:63], s27 offen  lds
  s_add_u32 s27, s27, 16384
  s_add_u32 m0, s25, 27648
  s_nop 0
  buffer_load_dwordx4 v21, s[60:63], s27 offen  lds
  s_add_u32 s27, s27, 16384
  s_add_u32 m0, s25, 28672
  s_nop 0
  buffer_load_dwordx4 v22, s[60:63], s27 offen  lds
  s_add_u32 s27, s27, 16384
  s_add_u32 m0, s25, 29696
  s_nop 0
  buffer_load_dwordx4 v23, s[60:63], s27 offen  lds
  s_add_u32 s27, s27, 16384
  s_add_u32 m0, s25, 30720
  s_nop 0
  buffer_load_dwordx4 v22, s[60:63], s27 offen  lds
  s_add_u32 s27, s27, 16384
  s_add_u32 m0, s25, 31744
  s_nop 0
  buffer_load_dwordx4 v23, s[60:63], s27 offen  lds
  s_add_u32 s27, s27, 16384
  s_cmp_lt_u32 s18, 4
  s_cselect_b32 s34, 1, s97
  s_mov_b32 s68, s42
  s_and_b32 s69, s43, 0xffff
  s_mov_b32 s70, 3670016
  s_mov_b32 s71, 0x20000
  s_lshl_b32 s27, s18, 19
  s_add_u32 s27, s27, s26
  s_cmp_lg_u32 s34, 0
  s_cselect_b32 s27, 0x40000000, s27
  v_lshrrev_b32 v7, 2, v0
  v_and_b32 v8, 3, v0
  v_lshlrev_b32 v8, 7, v8
  v_lshl_add_u32 v9, v7, 13, v8
  buffer_load_dword v253, v9, s[68:71], s27 offen
  s_lshl_b32 s29, s28, 10
  s_add_u32 s31, s29, 4096
  s_cmp_lt_u32 s28, 10
  s_cselect_b32 s31, s31, 0x40000000
  s_waitcnt vmcnt(1)
  s_barrier
  ds_read_b64_tr_b16 a[0:1], v40 offset:0
  ds_read_b64_tr_b16 a[2:3], v40 offset:512
  ds_read_b64_tr_b16 a[32:33], v41 offset:0
  ds_read_b64_tr_b16 a[34:35], v41 offset:512
  ds_read_b64_tr_b16 a[64:65], v42 offset:0
  ds_read_b64_tr_b16 a[66:67], v42 offset:512
  ds_read_b64_tr_b16 a[96:97], v43 offset:0
  ds_read_b64_tr_b16 a[98:99], v43 offset:512
  ds_read_b128 a[128:131], v32 offset:0
  ds_read_b128 a[160:163], v32 offset:2048
  ds_read_b128 a[192:195], v32 offset:16384
  ds_read_b128 a[224:227], v32 offset:18432
  v_lshlrev_b32 v144, 9, v3
  v_lshl_add_u32 v144, v4, 4, v144
  s_add_u32 s53, s52, 75759616
  s_add_u32 s52, s52, 655360
  v_mov_b32 v136, v128
  v_mov_b32 v140, v129
  v_mov_b32 v137, v130
  v_mov_b32 v141, v131
  v_mov_b32 v138, v132
  v_mov_b32 v142, v133
  v_mov_b32 v139, v134
  v_mov_b32 v143, v135
  buffer_store_dwordx4 v[128:131], v144, s[8:11], s52 offen sc1
  buffer_store_dwordx4 v[132:135], v144, s[8:11], s52 offen offset:256 sc1
  buffer_store_dwordx4 v[136:139], v2, s[8:11], s53 offen sc1
  buffer_store_dwordx4 v[140:143], v2, s[8:11], s53 offen offset:1024 sc1
  s_waitcnt lgkmcnt(0)
  v_mfma_f32_16x16x32_bf16 v[64:67], a[128:131], a[0:3], 0
  ds_read_b64_tr_b16 a[4:5], v40 offset:4096
  ds_read_b64_tr_b16 a[6:7], v40 offset:4608
  v_mfma_f32_16x16x32_bf16 v[68:71], a[160:163], a[0:3], 0
  ds_read_b64_tr_b16 a[36:37], v41 offset:4096
  ds_read_b64_tr_b16 a[38:39], v41 offset:4608
  v_mfma_f32_16x16x32_bf16 v[72:75], a[128:131], a[32:35], 0
  ds_read_b64_tr_b16 a[68:69], v42 offset:4096
  ds_read_b64_tr_b16 a[70:71], v42 offset:4608
  v_mfma_f32_16x16x32_bf16 v[76:79], a[160:163], a[32:35], 0
  ds_read_b64_tr_b16 a[100:101], v43 offset:4096
  ds_read_b64_tr_b16 a[102:103], v43 offset:4608
  v_mfma_f32_16x16x32_bf16 v[80:83], a[128:131], a[64:67], 0
  ds_read_b128 a[132:135], v33 offset:0
  ds_read_b128 a[164:167], v33 offset:2048
  v_mfma_f32_16x16x32_bf16 v[84:87], a[160:163], a[64:67], 0
  ds_read_b128 a[196:199], v33 offset:16384
  ds_read_b128 a[228:231], v33 offset:18432
  v_mfma_f32_16x16x32_bf16 v[88:91], a[128:131], a[96:99], 0
  v_mfma_f32_16x16x32_bf16 v[92:95], a[160:163], a[96:99], 0
  v_mfma_f32_16x16x32_bf16 v[96:99], a[192:195], a[0:3], 0
  v_mfma_f32_16x16x32_bf16 v[100:103], a[224:227], a[0:3], 0
  v_mfma_f32_16x16x32_bf16 v[104:107], a[192:195], a[32:35], 0
  v_mfma_f32_16x16x32_bf16 v[108:111], a[224:227], a[32:35], 0
  v_mfma_f32_16x16x32_bf16 v[112:115], a[192:195], a[64:67], 0
  v_mfma_f32_16x16x32_bf16 v[116:119], a[224:227], a[64:67], 0
  v_mfma_f32_16x16x32_bf16 v[120:123], a[192:195], a[96:99], 0
  v_mfma_f32_16x16x32_bf16 v[124:127], a[224:227], a[96:99], 0
  s_waitcnt lgkmcnt(0)
  v_mfma_f32_16x16x32_bf16 v[64:67], a[132:135], a[4:7], v[64:67]
  ds_read_b64_tr_b16 a[8:9], v40 offset:8192
  ds_read_b64_tr_b16 a[10:11], v40 offset:8704
  v_mfma_f32_16x16x32_bf16 v[68:71], a[164:167], a[4:7], v[68:71]
  ds_read_b64_tr_b16 a[40:41], v41 offset:8192
  ds_read_b64_tr_b16 a[42:43], v41 offset:8704
  v_mfma_f32_16x16x32_bf16 v[72:75], a[132:135], a[36:39], v[72:75]
  ds_read_b64_tr_b16 a[72:73], v42 offset:8192
  ds_read_b64_tr_b16 a[74:75], v42 offset:8704
  v_mfma_f32_16x16x32_bf16 v[76:79], a[164:167], a[36:39], v[76:79]
  ds_read_b64_tr_b16 a[104:105], v43 offset:8192
  ds_read_b64_tr_b16 a[106:107], v43 offset:8704
  v_mfma_f32_16x16x32_bf16 v[80:83], a[132:135], a[68:71], v[80:83]
  ds_read_b128 a[136:139], v34 offset:0
  ds_read_b128 a[168:171], v34 offset:2048
  v_mfma_f32_16x16x32_bf16 v[84:87], a[164:167], a[68:71], v[84:87]
  ds_read_b128 a[200:203], v34 offset:16384
  ds_read_b128 a[232:235], v34 offset:18432
  v_mfma_f32_16x16x32_bf16 v[88:91], a[132:135], a[100:103], v[88:91]
  v_mfma_f32_16x16x32_bf16 v[92:95], a[164:167], a[100:103], v[92:95]
  v_mfma_f32_16x16x32_bf16 v[96:99], a[196:199], a[4:7], v[96:99]
  v_mfma_f32_16x16x32_bf16 v[100:103], a[228:231], a[4:7], v[100:103]
  v_mfma_f32_16x16x32_bf16 v[104:107], a[196:199], a[36:39], v[104:107]
  v_mfma_f32_16x16x32_bf16 v[108:111], a[228:231], a[36:39], v[108:111]
  v_mfma_f32_16x16x32_bf16 v[112:115], a[196:199], a[68:71], v[112:115]
  v_mfma_f32_16x16x32_bf16 v[116:119], a[228:231], a[68:71], v[116:119]
  v_mfma_f32_16x16x32_bf16 v[120:123], a[196:199], a[100:103], v[120:123]
  v_mfma_f32_16x16x32_bf16 v[124:127], a[228:231], a[100:103], v[124:127]
  s_waitcnt lgkmcnt(0)
  v_mfma_f32_16x16x32_bf16 v[64:67], a[136:139], a[8:11], v[64:67]
  ds_read_b64_tr_b16 a[12:13], v40 offset:12288
  ds_read_b64_tr_b16 a[14:15], v40 offset:12800
  v_mfma_f32_16x16x32_bf16 v[68:71], a[168:171], a[8:11], v[68:71]
  ds_read_b64_tr_b16 a[44:45], v41 offset:12288
  ds_read_b64_tr_b16 a[46:47], v41 offset:12800
  v_mfma_f32_16x16x32_bf16 v[72:75], a[136:139], a[40:43], v[72:75]
  ds_read_b64_tr_b16 a[76:77], v42 offset:12288
  ds_read_b64_tr_b16 a[78:79], v42 offset:12800
  v_mfma_f32_16x16x32_bf16 v[76:79], a[168:171], a[40:43], v[76:79]
  ds_read_b64_tr_b16 a[108:109], v43 offset:12288
  ds_read_b64_tr_b16 a[110:111], v43 offset:12800
  v_mfma_f32_16x16x32_bf16 v[80:83], a[136:139], a[72:75], v[80:83]
  ds_read_b128 a[140:143], v35 offset:0
  ds_read_b128 a[172:175], v35 offset:2048
  v_mfma_f32_16x16x32_bf16 v[84:87], a[168:171], a[72:75], v[84:87]
  ds_read_b128 a[204:207], v35 offset:16384
  ds_read_b128 a[236:239], v35 offset:18432
  v_mfma_f32_16x16x32_bf16 v[88:91], a[136:139], a[104:107], v[88:91]
  v_mfma_f32_16x16x32_bf16 v[92:95], a[168:171], a[104:107], v[92:95]
  v_mfma_f32_16x16x32_bf16 v[96:99], a[200:203], a[8:11], v[96:99]
  v_mfma_f32_16x16x32_bf16 v[100:103], a[232:235], a[8:11], v[100:103]
  v_mfma_f32_16x16x32_bf16 v[104:107], a[200:203], a[40:43], v[104:107]
  v_mfma_f32_16x16x32_bf16 v[108:111], a[232:235], a[40:43], v[108:111]
  v_mfma_f32_16x16x32_bf16 v[112:115], a[200:203], a[72:75], v[112:115]
  v_mfma_f32_16x16x32_bf16 v[116:119], a[232:235], a[72:75], v[116:119]
  v_mfma_f32_16x16x32_bf16 v[120:123], a[200:203], a[104:107], v[120:123]
  v_mfma_f32_16x16x32_bf16 v[124:127], a[232:235], a[104:107], v[124:127]
  s_waitcnt lgkmcnt(0)
  v_mfma_f32_16x16x32_bf16 v[64:67], a[140:143], a[12:15], v[64:67]
  ds_read_b64_tr_b16 a[16:17], v40 offset:16384
  ds_read_b64_tr_b16 a[18:19], v40 offset:16896
  v_mfma_f32_16x16x32_bf16 v[68:71], a[172:175], a[12:15], v[68:71]
  ds_read_b64_tr_b16 a[48:49], v41 offset:16384
  ds_read_b64_tr_b16 a[50:51], v41 offset:16896
  v_mfma_f32_16x16x32_bf16 v[72:75], a[140:143], a[44:47], v[72:75]
  ds_read_b64_tr_b16 a[80:81], v42 offset:16384
  ds_read_b64_tr_b16 a[82:83], v42 offset:16896
  v_mfma_f32_16x16x32_bf16 v[76:79], a[172:175], a[44:47], v[76:79]
  ds_read_b64_tr_b16 a[112:113], v43 offset:16384
  ds_read_b64_tr_b16 a[114:115], v43 offset:16896
  v_mfma_f32_16x16x32_bf16 v[80:83], a[140:143], a[76:79], v[80:83]
  ds_read_b128 a[144:147], v32 offset:256
  ds_read_b128 a[176:179], v32 offset:2304
  v_mfma_f32_16x16x32_bf16 v[84:87], a[172:175], a[76:79], v[84:87]
  ds_read_b128 a[208:211], v32 offset:16640
  ds_read_b128 a[240:243], v32 offset:18688
  v_mfma_f32_16x16x32_bf16 v[88:91], a[140:143], a[108:111], v[88:91]
  v_mfma_f32_16x16x32_bf16 v[92:95], a[172:175], a[108:111], v[92:95]
  v_mfma_f32_16x16x32_bf16 v[96:99], a[204:207], a[12:15], v[96:99]
  v_mfma_f32_16x16x32_bf16 v[100:103], a[236:239], a[12:15], v[100:103]
  v_mfma_f32_16x16x32_bf16 v[104:107], a[204:207], a[44:47], v[104:107]
  v_mfma_f32_16x16x32_bf16 v[108:111], a[236:239], a[44:47], v[108:111]
  v_mfma_f32_16x16x32_bf16 v[112:115], a[204:207], a[76:79], v[112:115]
  v_mfma_f32_16x16x32_bf16 v[116:119], a[236:239], a[76:79], v[116:119]
  v_mfma_f32_16x16x32_bf16 v[120:123], a[204:207], a[108:111], v[120:123]
  v_mfma_f32_16x16x32_bf16 v[124:127], a[236:239], a[108:111], v[124:127]
  s_waitcnt lgkmcnt(0)
  v_mfma_f32_16x16x32_bf16 v[64:67], a[144:147], a[16:19], v[64:67]
  ds_read_b64_tr_b16 a[20:21], v40 offset:20480
  ds_read_b64_tr_b16 a[22:23], v40 offset:20992
  v_mfma_f32_16x16x32_bf16 v[68:71], a[176:179], a[16:19], v[68:71]
  ds_read_b64_tr_b16 a[52:53], v41 offset:20480
  ds_read_b64_tr_b16 a[54:55], v41 offset:20992
  v_mfma_f32_16x16x32_bf16 v[72:75], a[144:147], a[48:51], v[72:75]
  ds_read_b64_tr_b16 a[84:85], v42 offset:20480
  ds_read_b64_tr_b16 a[86:87], v42 offset:20992
  v_mfma_f32_16x16x32_bf16 v[76:79], a[176:179], a[48:51], v[76:79]
  ds_read_b64_tr_b16 a[116:117], v43 offset:20480
  ds_read_b64_tr_b16 a[118:119], v43 offset:20992
  v_mfma_f32_16x16x32_bf16 v[80:83], a[144:147], a[80:83], v[80:83]
  ds_read_b128 a[148:151], v33 offset:256
  ds_read_b128 a[180:183], v33 offset:2304
  v_mfma_f32_16x16x32_bf16 v[84:87], a[176:179], a[80:83], v[84:87]
  ds_read_b128 a[212:215], v33 offset:16640
  ds_read_b128 a[244:247], v33 offset:18688
  v_mfma_f32_16x16x32_bf16 v[88:91], a[144:147], a[112:115], v[88:91]
  v_mfma_f32_16x16x32_bf16 v[92:95], a[176:179], a[112:115], v[92:95]
  v_mfma_f32_16x16x32_bf16 v[96:99], a[208:211], a[16:19], v[96:99]
  v_mfma_f32_16x16x32_bf16 v[100:103], a[240:243], a[16:19], v[100:103]
  v_mfma_f32_16x16x32_bf16 v[104:107], a[208:211], a[48:51], v[104:107]
  v_mfma_f32_16x16x32_bf16 v[108:111], a[240:243], a[48:51], v[108:111]
  v_mfma_f32_16x16x32_bf16 v[112:115], a[208:211], a[80:83], v[112:115]
  v_mfma_f32_16x16x32_bf16 v[116:119], a[240:243], a[80:83], v[116:119]
  v_mfma_f32_16x16x32_bf16 v[120:123], a[208:211], a[112:115], v[120:123]
  v_mfma_f32_16x16x32_bf16 v[124:127], a[240:243], a[112:115], v[124:127]
  s_waitcnt lgkmcnt(0)
  v_mfma_f32_16x16x32_bf16 v[64:67], a[148:151], a[20:23], v[64:67]
  ds_read_b64_tr_b16 a[24:25], v40 offset:24576
  ds_read_b64_tr_b16 a[26:27], v40 offset:25088
  v_mfma_f32_16x16x32_bf16 v[68:71], a[180:183], a[20:23], v[68:71]
  ds_read_b64_tr_b16 a[56:57], v41 offset:24576
  ds_read_b64_tr_b16 a[58:59], v41 offset:25088
  v_mfma_f32_16x16x32_bf16 v[72:75], a[148:151], a[52:55], v[72:75]
  ds_read_b64_tr_b16 a[88:89], v42 offset:24576
  ds_read_b64_tr_b16 a[90:91], v42 offset:25088
  v_mfma_f32_16x16x32_bf16 v[76:79], a[180:183], a[52:55], v[76:79]
  ds_read_b64_tr_b16 a[120:121], v43 offset:24576
  ds_read_b64_tr_b16 a[122:123], v43 offset:25088
  v_mfma_f32_16x16x32_bf16 v[80:83], a[148:151], a[84:87], v[80:83]
  ds_read_b128 a[152:155], v34 offset:256
  ds_read_b128 a[184:187], v34 offset:2304
  v_mfma_f32_16x16x32_bf16 v[84:87], a[180:183], a[84:87], v[84:87]
  ds_read_b128 a[216:219], v34 offset:16640
  ds_read_b128 a[248:251], v34 offset:18688
  v_mfma_f32_16x16x32_bf16 v[88:91], a[148:151], a[116:119], v[88:91]
  v_mfma_f32_16x16x32_bf16 v[92:95], a[180:183], a[116:119], v[92:95]
  v_mfma_f32_16x16x32_bf16 v[96:99], a[212:215], a[20:23], v[96:99]
  v_mfma_f32_16x16x32_bf16 v[100:103], a[244:247], a[20:23], v[100:103]
  v_mfma_f32_16x16x32_bf16 v[104:107], a[212:215], a[52:55], v[104:107]
  v_mfma_f32_16x16x32_bf16 v[108:111], a[244:247], a[52:55], v[108:111]
  v_mfma_f32_16x16x32_bf16 v[112:115], a[212:215], a[84:87], v[112:115]
  v_mfma_f32_16x16x32_bf16 v[116:119], a[244:247], a[84:87], v[116:119]
  v_mfma_f32_16x16x32_bf16 v[120:123], a[212:215], a[116:119], v[120:123]
  v_mfma_f32_16x16x32_bf16 v[124:127], a[244:247], a[116:119], v[124:127]
  s_waitcnt lgkmcnt(0)
  v_mfma_f32_16x16x32_bf16 v[64:67], a[152:155], a[24:27], v[64:67]
  ds_read_b64_tr_b16 a[28:29], v40 offset:28672
  ds_read_b64_tr_b16 a[30:31], v40 offset:29184
  v_mfma_f32_16x16x32_bf16 v[68:71], a[184:187], a[24:27], v[68:71]
  ds_read_b64_tr_b16 a[60:61], v41 offset:28672
  ds_read_b64_tr_b16 a[62:63], v41 offset:29184
  v_mfma_f32_16x16x32_bf16 v[72:75], a[152:155], a[56:59], v[72:75]
  ds_read_b64_tr_b16 a[92:93], v42 offset:28672
  ds_read_b64_tr_b16 a[94:95], v42 offset:29184
  v_mfma_f32_16x16x32_bf16 v[76:79], a[184:187], a[56:59], v[76:79]
  ds_read_b64_tr_b16 a[124:125], v43 offset:28672
  ds_read_b64_tr_b16 a[126:127], v43 offset:29184
  v_mfma_f32_16x16x32_bf16 v[80:83], a[152:155], a[88:91], v[80:83]
  ds_read_b128 a[156:159], v35 offset:256
  ds_read_b128 a[188:191], v35 offset:2304
  v_mfma_f32_16x16x32_bf16 v[84:87], a[184:187], a[88:91], v[84:87]
  ds_read_b128 a[220:223], v35 offset:16640
  ds_read_b128 a[252:255], v35 offset:18688
  v_mfma_f32_16x16x32_bf16 v[88:91], a[152:155], a[120:123], v[88:91]
  v_mfma_f32_16x16x32_bf16 v[92:95], a[184:187], a[120:123], v[92:95]
  v_mfma_f32_16x16x32_bf16 v[96:99], a[216:219], a[24:27], v[96:99]
  v_mfma_f32_16x16x32_bf16 v[100:103], a[248:251], a[24:27], v[100:103]
  v_mfma_f32_16x16x32_bf16 v[104:107], a[216:219], a[56:59], v[104:107]
  v_mfma_f32_16x16x32_bf16 v[108:111], a[248:251], a[56:59], v[108:111]
  v_mfma_f32_16x16x32_bf16 v[112:115], a[216:219], a[88:91], v[112:115]
  v_mfma_f32_16x16x32_bf16 v[116:119], a[248:251], a[88:91], v[116:119]
  v_mfma_f32_16x16x32_bf16 v[120:123], a[216:219], a[120:123], v[120:123]
  v_mfma_f32_16x16x32_bf16 v[124:127], a[248:251], a[120:123], v[124:127]
  s_waitcnt lgkmcnt(0)
  s_barrier
  buffer_load_dwordx2 v[254:255], v252, s[12:15], 0 offen offset:128 sc1
  buffer_load_dword v253, v252, s[12:15], 0 offen sc1
  v_mfma_f32_16x16x32_bf16 v[64:67], a[156:159], a[28:31], v[64:67]
  v_mfma_f32_16x16x32_bf16 v[68:71], a[188:191], a[28:31], v[68:71]
  v_mfma_f32_16x16x32_bf16 v[72:75], a[156:159], a[60:63], v[72:75]
  v_mfma_f32_16x16x32_bf16 v[76:79], a[188:191], a[60:63], v[76:79]
  v_mfma_f32_16x16x32_bf16 v[80:83], a[156:159], a[92:95], v[80:83]
  v_cvt_pk_bf16_f32 v64, v64, v65
  v_cvt_pk_bf16_f32 v65, v66, v67
  v_mfma_f32_16x16x32_bf16 v[84:87], a[188:191], a[92:95], v[84:87]
  v_cvt_pk_bf16_f32 v66, v68, v69
  v_cvt_pk_bf16_f32 v67, v70, v71
  v_mfma_f32_16x16x32_bf16 v[88:91], a[156:159], a[124:127], v[88:91]
  buffer_store_dwordx4 v[64:67], v12, s[8:11], s29 offen sc1
  v_cvt_pk_bf16_f32 v72, v72, v73
  v_mfma_f32_16x16x32_bf16 v[92:95], a[188:191], a[124:127], v[92:95]
  v_cvt_pk_bf16_f32 v73, v74, v75
  v_cvt_pk_bf16_f32 v74, v76, v77
  v_mfma_f32_16x16x32_bf16 v[96:99], a[220:223], a[28:31], v[96:99]
  v_cvt_pk_bf16_f32 v75, v78, v79
  buffer_store_dwordx4 v[72:75], v13, s[8:11], s29 offen sc1
  v_mfma_f32_16x16x32_bf16 v[100:103], a[252:255], a[28:31], v[100:103]
  v_cvt_pk_bf16_f32 v80, v80, v81
  v_cvt_pk_bf16_f32 v81, v82, v83
  v_mfma_f32_16x16x32_bf16 v[104:107], a[220:223], a[60:63], v[104:107]
  v_cvt_pk_bf16_f32 v82, v84, v85
  v_cvt_pk_bf16_f32 v83, v86, v87
  v_mfma_f32_16x16x32_bf16 v[108:111], a[252:255], a[60:63], v[108:111]
  buffer_store_dwordx4 v[80:83], v14, s[8:11], s29 offen sc1
  v_cvt_pk_bf16_f32 v88, v88, v89
  v_mfma_f32_16x16x32_bf16 v[112:115], a[220:223], a[92:95], v[112:115]
  v_cvt_pk_bf16_f32 v89, v90, v91
  v_cvt_pk_bf16_f32 v90, v92, v93
  v_mfma_f32_16x16x32_bf16 v[116:119], a[252:255], a[92:95], v[116:119]
  v_cvt_pk_bf16_f32 v91, v94, v95
  buffer_store_dwordx4 v[88:91], v15, s[8:11], s29 offen sc1
  v_mfma_f32_16x16x32_bf16 v[120:123], a[220:223], a[124:127], v[120:123]
  v_cvt_pk_bf16_f32 v96, v96, v97
  v_cvt_pk_bf16_f32 v97, v98, v99
  v_mfma_f32_16x16x32_bf16 v[124:127], a[252:255], a[124:127], v[124:127]
  v_cvt_pk_bf16_f32 v98, v100, v101
  v_cvt_pk_bf16_f32 v99, v102, v103
  buffer_store_dwordx4 v[96:99], v12, s[8:11], s31 offen sc1
  v_cvt_pk_bf16_f32 v104, v104, v105
  v_cvt_pk_bf16_f32 v105, v106, v107
  v_cvt_pk_bf16_f32 v106, v108, v109
  v_cvt_pk_bf16_f32 v107, v110, v111
  buffer_store_dwordx4 v[104:107], v13, s[8:11], s31 offen sc1
  v_cvt_pk_bf16_f32 v112, v112, v113
  v_cvt_pk_bf16_f32 v113, v114, v115
  v_cvt_pk_bf16_f32 v114, v116, v117
  v_cvt_pk_bf16_f32 v115, v118, v119
  buffer_store_dwordx4 v[112:115], v14, s[8:11], s31 offen sc1
  v_cvt_pk_bf16_f32 v120, v120, v121
  v_cvt_pk_bf16_f32 v121, v122, v123
  v_cvt_pk_bf16_f32 v122, v124, v125
  v_cvt_pk_bf16_f32 v123, v126, v127
  buffer_store_dwordx4 v[120:123], v15, s[8:11], s31 offen sc1
  s_cmp_lg_u32 s34, 0
  s_cbranch_scc1 wp_B2
  s_mov_b32 s60, s40
  s_and_b32 s61, s41, 0xffff
  s_mov_b32 s62, 3670016
  s_mov_b32 s63, 0x20000
  s_mov_b32 s56, s42
  s_and_b32 s57, s43, 0xffff
  s_mov_b32 s58, 3670016
  s_mov_b32 s59, 0x20000
  s_lshl_b32 s27, s18, 2
  s_add_u32 s27, s27, s16
  s_lshl_b32 s27, s27, 17
  s_add_u32 s27, s27, s26
  s_lshl_b32 s30, s16, 13
  s_add_u32 m0, s30, 0
  s_nop 0
  buffer_load_dwordx4 v26, s[56:59], s27 offen  lds
  s_add_u32 s27, s27, 16384
  s_add_u32 m0, s30, 1024
  s_nop 0
  buffer_load_dwordx4 v26, s[56:59], s27 offen  lds
  s_add_u32 s27, s27, 16384
  s_add_u32 m0, s30, 2048
  s_nop 0
  buffer_load_dwordx4 v27, s[56:59], s27 offen  lds
  s_add_u32 s27, s27, 16384
  s_add_u32 m0, s30, 3072
  s_nop 0
  buffer_load_dwordx4 v27, s[56:59], s27 offen  lds
  s_add_u32 s27, s27, 16384
  s_add_u32 m0, s30, 4096
  s_nop 0
  buffer_load_dwordx4 v26, s[56:59], s27 offen  lds
  s_add_u32 s27, s27, 16384
  s_add_u32 m0, s30, 5120
  s_nop 0
  buffer_load_dwordx4 v26, s[56:59], s27 offen  lds
  s_add_u32 s27, s27, 16384
  s_add_u32 m0, s30, 6144
  s_nop 0
  buffer_load_dwordx4 v27, s[56:59], s27 offen  lds
  s_add_u32 s27, s27, 16384
  s_add_u32 m0, s30, 7168
  s_nop 0
  buffer_load_dwordx4 v27, s[56:59], s27 offen  lds
  s_add_u32 s27, s27, 16384
  s_add_u32 s27, s28, 0
  s_min_u32 s27, s27, 13
  s_lshl_b32 s27, s27, 18
  s_add_u32 s27, s27, s26
  s_add_u32 m0, s25, 0
  s_nop 0
  buffer_load_dwordx4 v16, s[60:63], s27 offen  lds
  s_add_u32 s27, s27, 16384
  s_add_u32 m0, s25, 1024
  s_nop 0
  buffer_load_dwordx4 v17, s[60:63], s27 offen  lds
  s_add_u32 s27, s27, 16384
  s_add_u32 m0, s25, 2048
  s_nop 0
  buffer_load_dwordx4 v16, s[60:63], s27 offen  lds
  s_add_u32 s27, s27, 16384
  s_add_u32 m0, s25, 3072
  s_nop 0
  buffer_load_dwordx4 v17, s[60:63], s27 offen  lds
  s_add_u32 s27, s27, 16384
  s_waitcnt vmcnt(12)
  s_barrier
  s_cmp_lg_u32 s16, 0
  s_cbranch_scc1 wp_f1_f
  v_readfirstlane_b32 s20, v254
  s_cmp_eq_u32 s20, 1
  s_cbranch_scc1 wp_f1_w_ok
  s_mov_b32 s30, 0
wp_f1_w:
  buffer_load_dword v254, off, s[12:15], 0 offset:128 sc1
  s_waitcnt vmcnt(0)
  v_cmp_ne_u32 vcc, 1, v254
  s_cbranch_vccz wp_f1_w_ok
  s_sleep 8
  s_add_u32 s30, s30, 1
  s_cmp_lt_u32 s30, 16
  s_cbranch_scc1 wp_f1_w
  s_branch wp_f1_f
wp_f1_w_ok:
  s_lshl_b32 s20, s17, 7
  s_add_u32 s20, s20, 582144
  s_lshl_b32 s21, 1, s19
  v_mov_b32 v248, s21
  s_mov_b64 exec, 1
  buffer_atomic_or v248, v252, s[8:11], s20 offen sc0
  s_mov_b64 exec, -1
  s_mov_b32 s37, s21
wp_f1_f:
  s_add_u32 m0, s25, 4096
  s_nop 0
  buffer_load_dwordx4 v18, s[60:63], s27 offen  lds
  s_add_u32 s27, s27, 16384
  s_add_u32 m0, s25, 5120
  s_nop 0
  buffer_load_dwordx4 v19, s[60:63], s27 offen  lds
  s_add_u32 s27, s27, 16384
  s_add_u32 m0, s25, 6144
  s_nop 0
  buffer_load_dwordx4 v18, s[60:63], s27 offen  lds
  s_add_u32 s27, s27, 16384
  s_add_u32 m0, s25, 7168
  s_nop 0
  buffer_load_dwordx4 v19, s[60:63], s27 offen  lds
  s_add_u32 s27, s27, 16384
  s_add_u32 m0, s25, 8192
  s_nop 0
  buffer_load_dwordx4 v20, s[60:63], s27 offen  lds
  s_add_u32 s27, s27, 16384
  s_add_u32 m0, s25, 9216
  s_nop 0
  buffer_load_dwordx4 v21, s[60:63], s27 offen  lds
  s_add_u32 s27, s27, 16384
  s_add_u32 m0, s25, 10240
  s_nop 0
  buffer_load_dwordx4 v20, s[60:63], s27 offen  lds
  s_add_u32 s27, s27, 16384
  s_add_u32 m0, s25, 11264
  s_nop 0
  buffer_load_dwordx4 v21, s[60:63], s27 offen  lds
  s_add_u32 s27, s27, 16384
  s_add_u32 m0, s25, 12288
  s_nop 0
  buffer_load_dwordx4 v22, s[60:63], s27 offen  lds
  s_add_u32 s27, s27, 16384
  s_add_u32 m0, s25, 13312
  s_nop 0
  buffer_load_dwordx4 v23, s[60:63], s27 offen  lds
  s_add_u32 s27, s27, 16384
  s_add_u32 m0, s25, 14336
  s_nop 0
  buffer_load_dwordx4 v22, s[60:63], s27 offen  lds
  s_add_u32 s27, s27, 16384
  s_add_u32 m0, s25, 15360
  s_nop 0
  buffer_load_dwordx4 v23, s[60:63], s27 offen  lds
  s_add_u32 s27, s27, 16384
  s_add_u32 s27, s28, 4
  s_min_u32 s27, s27, 13
  s_lshl_b32 s27, s27, 18
  s_add_u32 s27, s27, s26
  s_waitcnt vmcnt(12)
  v_readfirstlane_b32 s20, v248
  s_and_b32 s20, s20, 16383
  s_xor_b32 s20, s20, s37
  s_cmp_lg_u32 s20, 16383
  s_cselect_b32 s20, 0, s37
  s_mov_b32 s37, 0
  s_cmp_eq_u32 s20, 0
  s_cbranch_scc1 wp_g1
  s_lshl_b32 s21, 1, s17
  v_mov_b32 v248, s21
  s_mov_b32 s20, 586240
  v_lshlrev_b32 v247, 7, v0
  s_mov_b64 exec, 0xff
  buffer_atomic_or v248, v247, s[8:11], s20 offen
  s_mov_b64 exec, -1
wp_g1:
  s_add_u32 m0, s25, 16384
  s_nop 0
  buffer_load_dwordx4 v16, s[60:63], s27 offen  lds
  s_add_u32 s27, s27, 16384
  s_add_u32 m0, s25, 17408
  s_nop 0
  buffer_load_dwordx4 v17, s[60:63], s27 offen  lds
  s_add_u32 s27, s27, 16384
  s_add_u32 m0, s25, 18432
  s_nop 0
  buffer_load_dwordx4 v16, s[60:63], s27 offen  lds
  s_add_u32 s27, s27, 16384
  s_add_u32 m0, s25, 19456
  s_nop 0
  buffer_load_dwordx4 v17, s[60:63], s27 offen  lds
  s_add_u32 s27, s27, 16384
  s_add_u32 m0, s25, 20480
  s_nop 0
  buffer_load_dwordx4 v18, s[60:63], s27 offen  lds
  s_add_u32 s27, s27, 16384
  s_add_u32 m0, s25, 21504
  s_nop 0
  buffer_load_dwordx4 v19, s[60:63], s27 offen  lds
  s_add_u32 s27, s27, 16384
  s_add_u32 m0, s25, 22528
  s_nop 0
  buffer_load_dwordx4 v18, s[60:63], s27 offen  lds
  s_add_u32 s27, s27, 16384
  s_add_u32 m0, s25, 23552
  s_nop 0
  buffer_load_dwordx4 v19, s[60:63], s27 offen  lds
  s_add_u32 s27, s27, 16384
  s_add_u32 m0, s25, 24576
  s_nop 0
  buffer_load_dwordx4 v20, s[60:63], s27 offen  lds
  s_add_u32 s27, s27, 16384
  s_add_u32 m0, s25, 25600
  s_nop 0
  buffer_load_dwordx4 v21, s[60:63], s27 offen  lds
  s_add_u32 s27, s27, 16384
  s_add_u32 m0, s25, 26624
  s_nop 0
  buffer_load_dwordx4 v20, s[60:63], s27 offen  lds
  s_add_u32 s27, s27, 16384
  s_add_u32 m0, s25, 27648
  s_nop 0
  buffer_load_dwordx4 v21, s[60:63], s27 offen  lds
  s_add_u32 s27, s27, 16384
  s_add_u32 m0, s25, 28672
  s_nop 0
  buffer_load_dwordx4 v22, s[60:63], s27 offen  lds
  s_add_u32 s27, s27, 16384
  s_add_u32 m0, s25, 29696
  s_nop 0
  buffer_load_dwordx4 v23, s[60:63], s27 offen  lds
  s_add_u32 s27, s27, 16384
  s_add_u32 m0, s25, 30720
  s_nop 0
  buffer_load_dwordx4 v22, s[60:63], s27 offen  lds
  s_add_u32 s27, s27, 16384
  s_add_u32 m0, s25, 31744
  s_nop 0
  buffer_load_dwordx4 v23, s[60:63], s27 offen  lds
  s_add_u32 s27, s27, 16384
  s_branch wp_A
wp_B2:
  v_lshlrev_b32 v6, 7, v1
  s_getpc_b64 s[98:99]
ct_5:
  s_add_u32 s98, s98, wp_fin-ct_5
  s_addc_u32 s99, s99, 0
  global_load_dword v7, v6, s[98:99]
  s_getpc_b64 s[98:99]
ct_6:
  s_add_u32 s98, s98, wg_vo-ct_6
  s_addc_u32 s99, s99, 0
  global_load_dword v7, v6, s[98:99]
  s_waitcnt vmcnt(2)
  s_barrier
  s_cmp_lg_u32 s16, 0
  s_cbranch_scc1 wp_f2_f
  v_readfirstlane_b32 s20, v254
  s_cmp_eq_u32 s20, 1
  s_cbranch_scc1 wp_f2_w_ok
  s_mov_b32 s30, 0
wp_f2_w:
  buffer_load_dword v254, off, s[12:15], 0 offset:128 sc1
  s_waitcnt vmcnt(0)
  v_cmp_ne_u32 vcc, 1, v254
  s_cbranch_vccz wp_f2_w_ok
  s_sleep 8
  s_add_u32 s30, s30, 1
  s_cmp_lt_u32 s30, 16
  s_cbranch_scc1 wp_f2_w
  s_branch wp_f2_f
wp_f2_w_ok:
  s_lshl_b32 s20, s17, 7
  s_add_u32 s20, s20, 582144
  s_lshl_b32 s21, 1, s19
  v_mov_b32 v248, s21
  s_mov_b64 exec, 1
  buffer_atomic_or v248, v252, s[8:11], s20 offen sc0
  s_mov_b64 exec, -1
  s_mov_b32 s37, s21
wp_f2_f:
  s_cmp_eq_u32 s97, 0
  s_cselect_b32 s39, -1, s39
  s_branch wp_fin
wp_A0:
  s_mov_b32 s60, s40
  s_and_b32 s61, s41, 0xffff
  s_mov_b32 s62, 3670016
  s_mov_b32 s63, 0x20000
  s_mov_b32 s56, s42
  s_and_b32 s57, s43, 0xffff
  s_mov_b32 s58, 3670016
  s_mov_b32 s59, 0x20000
  s_lshl_b32 s27, s18, 2
  s_add_u32 s27, s27, s16
  s_lshl_b32 s27, s27, 17
  s_add_u32 s27, s27, s26
  s_lshl_b32 s30, s16, 13
  s_add_u32 m0, s30, 0
  s_nop 0
  buffer_load_dwordx4 v26, s[56:59], s27 offen  lds
  s_add_u32 s27, s27, 16384
  s_add_u32 m0, s30, 1024
  s_nop 0
  buffer_load_dwordx4 v26, s[56:59], s27 offen  lds
  s_add_u32 s27, s27, 16384
  s_add_u32 m0, s30, 2048
  s_nop 0
  buffer_load_dwordx4 v27, s[56:59], s27 offen  lds
  s_add_u32 s27, s27, 16384
  s_add_u32 m0, s30, 3072
  s_nop 0
  buffer_load_dwordx4 v27, s[56:59], s27 offen  lds
  s_add_u32 s27, s27, 16384
  s_add_u32 m0, s30, 4096
  s_nop 0
  buffer_load_dwordx4 v26, s[56:59], s27 offen  lds
  s_add_u32 s27, s27, 16384
  s_add_u32 m0, s30, 5120
  s_nop 0
  buffer_load_dwordx4 v26, s[56:59], s27 offen  lds
  s_add_u32 s27, s27, 16384
  s_add_u32 m0, s30, 6144
  s_nop 0
  buffer_load_dwordx4 v27, s[56:59], s27 offen  lds
  s_add_u32 s27, s27, 16384
  s_add_u32 m0, s30, 7168
  s_nop 0
  buffer_load_dwordx4 v27, s[56:59], s27 offen  lds
  s_add_u32 s27, s27, 16384
  s_add_u32 s27, s28, 0
  s_min_u32 s27, s27, 13
  s_lshl_b32 s27, s27, 18
  s_add_u32 s27, s27, s26
  s_add_u32 m0, s25, 0
  s_nop 0
  buffer_load_dwordx4 v16, s[60:63], s27 offen  lds
  s_add_u32 s27, s27, 16384
  s_add_u32 m0, s25, 1024
  s_nop 0
  buffer_load_dwordx4 v17, s[60:63], s27 offen  lds
  s_add_u32 s27, s27, 16384
  s_add_u32 m0, s25, 2048
  s_nop 0
  buffer_load_dwordx4 v16, s[60:63], s27 offen  lds
  s_add_u32 s27, s27, 16384
  s_add_u32 m0, s25, 3072
  s_nop 0
  buffer_load_dwordx4 v17, s[60:63], s27 offen  lds
  s_add_u32 s27, s27, 16384
  s_add_u32 m0, s25, 4096
  s_nop 0
  buffer_load_dwordx4 v18, s[60:63], s27 offen  lds
  s_add_u32 s27, s27, 16384
  s_add_u32 m0, s25, 5120
  s_nop 0
  buffer_load_dwordx4 v19, s[60:63], s27 offen  lds
  s_add_u32 s27, s27, 16384
  s_add_u32 m0, s25, 6144
  s_nop 0
  buffer_load_dwordx4 v18, s[60:63], s27 offen  lds
  s_add_u32 s27, s27, 16384
  s_add_u32 m0, s25, 7168
  s_nop 0
  buffer_load_dwordx4 v19, s[60:63], s27 offen  lds
  s_add_u32 s27, s27, 16384
  s_add_u32 m0, s25, 8192
  s_nop 0
  buffer_load_dwordx4 v20, s[60:63], s27 offen  lds
  s_add_u32 s27, s27, 16384
  s_add_u32 m0, s25, 9216
  s_nop 0
  buffer_load_dwordx4 v21, s[60:63], s27 offen  lds
  s_add_u32 s27, s27, 16384
  s_add_u32 m0, s25, 10240
  s_nop 0
  buffer_load_dwordx4 v20, s[60:63], s27 offen  lds
  s_add_u32 s27, s27, 16384
  s_add_u32 m0, s25, 11264
  s_nop 0
  buffer_load_dwordx4 v21, s[60:63], s27 offen  lds
  s_add_u32 s27, s27, 16384
  s_add_u32 m0, s25, 12288
  s_nop 0
  buffer_load_dwordx4 v22, s[60:63], s27 offen  lds
  s_add_u32 s27, s27, 16384
  s_add_u32 m0, s25, 13312
  s_nop 0
  buffer_load_dwordx4 v23, s[60:63], s27 offen  lds
  s_add_u32 s27, s27, 16384
  s_add_u32 m0, s25, 14336
  s_nop 0
  buffer_load_dwordx4 v22, s[60:63], s27 offen  lds
  s_add_u32 s27, s27, 16384
  s_add_u32 m0, s25, 15360
  s_nop 0
  buffer_load_dwordx4 v23, s[60:63], s27 offen  lds
  s_add_u32 s27, s27, 16384
  s_add_u32 s27, s28, 4
  s_min_u32 s27, s27, 13
  s_lshl_b32 s27, s27, 18
  s_add_u32 s27, s27, s26
  s_add_u32 m0, s25, 16384
  s_nop 0
  buffer_load_dwordx4 v16, s[60:63], s27 offen  lds
  s_add_u32 s27, s27, 16384
  s_add_u32 m0, s25, 17408
  s_nop 0
  buffer_load_dwordx4 v17, s[60:63], s27 offen  lds
  s_add_u32 s27, s27, 16384
  s_add_u32 m0, s25, 18432
  s_nop 0
  buffer_load_dwordx4 v16, s[60:63], s27 offen  lds
  s_add_u32 s27, s27, 16384
  s_add_u32 m0, s25, 19456
  s_nop 0
  buffer_load_dwordx4 v17, s[60:63], s27 offen  lds
  s_add_u32 s27, s27, 16384
  s_add_u32 m0, s25, 20480
  s_nop 0
  buffer_load_dwordx4 v18, s[60:63], s27 offen  lds
  s_add_u32 s27, s27, 16384
  s_add_u32 m0, s25, 21504
  s_nop 0
  buffer_load_dwordx4 v19, s[60:63], s27 offen  lds
  s_add_u32 s27, s27, 16384
  s_add_u32 m0, s25, 22528
  s_nop 0
  buffer_load_dwordx4 v18, s[60:63], s27 offen  lds
  s_add_u32 s27, s27, 16384
  s_add_u32 m0, s25, 23552
  s_nop 0
  buffer_load_dwordx4 v19, s[60:63], s27 offen  lds
  s_add_u32 s27, s27, 16384
  s_add_u32 m0, s25, 24576
  s_nop 0
  buffer_load_dwordx4 v20, s[60:63], s27 offen  lds
  s_add_u32 s27, s27, 16384
  s_add_u32 m0, s25, 25600
  s_nop 0
  buffer_load_dwordx4 v21, s[60:63], s27 offen  lds
  s_add_u32 s27, s27, 16384
  s_add_u32 m0, s25, 26624
  s_nop 0
  buffer_load_dwordx4 v20, s[60:63], s27 offen  lds
  s_add_u32 s27, s27, 16384
  s_add_u32 m0, s25, 27648
  s_nop 0
  buffer_load_dwordx4 v21, s[60:63], s27 offen  lds
  s_add_u32 s27, s27, 16384
  s_add_u32 m0, s25, 28672
  s_nop 0
  buffer_load_dwordx4 v22, s[60:63], s27 offen  lds
  s_add_u32 s27, s27, 16384
  s_add_u32 m0, s25, 29696
  s_nop 0
  buffer_load_dwordx4 v23, s[60:63], s27 offen  lds
  s_add_u32 s27, s27, 16384
  s_add_u32 m0, s25, 30720
  s_nop 0
  buffer_load_dwordx4 v22, s[60:63], s27 offen  lds
  s_add_u32 s27, s27, 16384
  s_add_u32 m0, s25, 31744
  s_nop 0
  buffer_load_dwordx4 v23, s[60:63], s27 offen  lds
  s_add_u32 s27, s27, 16384
  v_lshrrev_b32 v7, 2, v4
  v_lshlrev_b32 v11, 4, v7
  v_lshlrev_b32 v7, 3, v7
  v_and_b32 v8, 3, v4
  v_add_u32 v7, v7, v8
  v_and_b32 v8, 2, v4
  v_lshl_add_u32 v11, v8, 1, v11
  v_and_b32 v8, 1, v4
  v_add_u32 v11, v11, v8
  v_or_b32 v10, 0, v3
  v_xor_b32 v10, v10, v4
  v_lshlrev_b32 v10, 4, v10
  v_lshl_add_u32 v44, v11, 9, v10
  v_lshl_add_u32 v10, v7, 9, v10
  v_add_u32 v32, s25, v10
  v_or_b32 v10, 4, v3
  v_xor_b32 v10, v10, v4
  v_lshlrev_b32 v10, 4, v10
  v_lshl_add_u32 v45, v11, 9, v10
  v_lshl_add_u32 v10, v7, 9, v10
  v_add_u32 v33, s25, v10
  v_or_b32 v10, 8, v3
  v_xor_b32 v10, v10, v4
  v_lshlrev_b32 v10, 4, v10
  v_lshl_add_u32 v46, v11, 9, v10
  v_lshl_add_u32 v10, v7, 9, v10
  v_add_u32 v34, s25, v10
  v_or_b32 v10, 12, v3
  v_xor_b32 v10, v10, v4
  v_lshlrev_b32 v10, 4, v10
  v_lshl_add_u32 v47, v11, 9, v10
  v_lshl_add_u32 v10, v7, 9, v10
  v_add_u32 v35, s25, v10
  s_mul_i32 s30, s17, 401408
  s_mul_i32 s31, s18, 57344
  s_add_u32 s30, s30, s31
  s_add_u32 s30, s30, 33554432
  v_add_u32 v28, s30, v2
  s_add_u32 s30, s30, 14336
  v_add_u32 v29, s30, v2
  s_add_u32 s30, s30, 14336
  v_add_u32 v30, s30, v2
  s_add_u32 s30, s30, 14336
  v_add_u32 v31, s30, v2
  s_add_u32 s30, s30, 14336
  v_mov_b32 v48, 1035512379
wp_A:
  s_lshl_b32 s29, s28, 10
  s_add_u32 s31, s29, 4096
  s_cmp_lt_u32 s28, 10
  s_cselect_b32 s31, s31, 0x40000000
  s_waitcnt vmcnt(0)
  s_barrier
  ds_read_b128 a[0:3], v44 offset:0
  ds_read_b128 a[32:35], v44 offset:1024
  ds_read_b128 a[64:67], v44 offset:4096
  ds_read_b128 a[96:99], v44 offset:5120
  ds_read_b128 a[128:131], v32 offset:0
  ds_read_b128 a[160:163], v32 offset:2048
  ds_read_b128 a[192:195], v32 offset:16384
  ds_read_b128 a[224:227], v32 offset:18432
  s_waitcnt lgkmcnt(0)
  v_mfma_f32_16x16x32_bf16 v[64:67], a[128:131], a[0:3], 0
  ds_read_b128 a[4:7], v45 offset:0
  ds_read_b128 a[36:39], v45 offset:1024
  v_mfma_f32_16x16x32_bf16 v[68:71], a[160:163], a[0:3], 0
  ds_read_b128 a[68:71], v45 offset:4096
  ds_read_b128 a[100:103], v45 offset:5120
  v_mfma_f32_16x16x32_bf16 v[72:75], a[128:131], a[32:35], 0
  ds_read_b128 a[132:135], v33 offset:0
  ds_read_b128 a[164:167], v33 offset:2048
  v_mfma_f32_16x16x32_bf16 v[76:79], a[160:163], a[32:35], 0
  ds_read_b128 a[196:199], v33 offset:16384
  ds_read_b128 a[228:231], v33 offset:18432
  v_mfma_f32_16x16x32_bf16 v[80:83], a[128:131], a[64:67], 0
  v_mfma_f32_16x16x32_bf16 v[84:87], a[160:163], a[64:67], 0
  v_mfma_f32_16x16x32_bf16 v[88:91], a[128:131], a[96:99], 0
  v_mfma_f32_16x16x32_bf16 v[92:95], a[160:163], a[96:99], 0
  v_mfma_f32_16x16x32_bf16 v[96:99], a[192:195], a[0:3], 0
  v_mfma_f32_16x16x32_bf16 v[100:103], a[224:227], a[0:3], 0
  v_mfma_f32_16x16x32_bf16 v[104:107], a[192:195], a[32:35], 0
  v_mfma_f32_16x16x32_bf16 v[108:111], a[224:227], a[32:35], 0
  v_mfma_f32_16x16x32_bf16 v[112:115], a[192:195], a[64:67], 0
  v_mfma_f32_16x16x32_bf16 v[116:119], a[224:227], a[64:67], 0
  v_mfma_f32_16x16x32_bf16 v[120:123], a[192:195], a[96:99], 0
  v_mfma_f32_16x16x32_bf16 v[124:127], a[224:227], a[96:99], 0
  s_waitcnt lgkmcnt(0)
  v_mfma_f32_16x16x32_bf16 v[64:67], a[132:135], a[4:7], v[64:67]
  ds_read_b128 a[8:11], v46 offset:0
  ds_read_b128 a[40:43], v46 offset:1024
  v_mfma_f32_16x16x32_bf16 v[68:71], a[164:167], a[4:7], v[68:71]
  ds_read_b128 a[72:75], v46 offset:4096
  ds_read_b128 a[104:107], v46 offset:5120
  v_mfma_f32_16x16x32_bf16 v[72:75], a[132:135], a[36:39], v[72:75]
  ds_read_b128 a[136:139], v34 offset:0
  ds_read_b128 a[168:171], v34 offset:2048
  v_mfma_f32_16x16x32_bf16 v[76:79], a[164:167], a[36:39], v[76:79]
  ds_read_b128 a[200:203], v34 offset:16384
  ds_read_b128 a[232:235], v34 offset:18432
  v_mfma_f32_16x16x32_bf16 v[80:83], a[132:135], a[68:71], v[80:83]
  v_mfma_f32_16x16x32_bf16 v[84:87], a[164:167], a[68:71], v[84:87]
  v_mfma_f32_16x16x32_bf16 v[88:91], a[132:135], a[100:103], v[88:91]
  v_mfma_f32_16x16x32_bf16 v[92:95], a[164:167], a[100:103], v[92:95]
  v_mfma_f32_16x16x32_bf16 v[96:99], a[196:199], a[4:7], v[96:99]
  v_mfma_f32_16x16x32_bf16 v[100:103], a[228:231], a[4:7], v[100:103]
  v_mfma_f32_16x16x32_bf16 v[104:107], a[196:199], a[36:39], v[104:107]
  v_mfma_f32_16x16x32_bf16 v[108:111], a[228:231], a[36:39], v[108:111]
  v_mfma_f32_16x16x32_bf16 v[112:115], a[196:199], a[68:71], v[112:115]
  v_mfma_f32_16x16x32_bf16 v[116:119], a[228:231], a[68:71], v[116:119]
  v_mfma_f32_16x16x32_bf16 v[120:123], a[196:199], a[100:103], v[120:123]
  v_mfma_f32_16x16x32_bf16 v[124:127], a[228:231], a[100:103], v[124:127]
  s_waitcnt lgkmcnt(0)
  v_mfma_f32_16x16x32_bf16 v[64:67], a[136:139], a[8:11], v[64:67]
  ds_read_b128 a[12:15], v47 offset:0
  ds_read_b128 a[44:47], v47 offset:1024
  v_mfma_f32_16x16x32_bf16 v[68:71], a[168:171], a[8:11], v[68:71]
  ds_read_b128 a[76:79], v47 offset:4096
  ds_read_b128 a[108:111], v47 offset:5120
  v_mfma_f32_16x16x32_bf16 v[72:75], a[136:139], a[40:43], v[72:75]
  ds_read_b128 a[140:143], v35 offset:0
  ds_read_b128 a[172:175], v35 offset:2048
  v_mfma_f32_16x16x32_bf16 v[76:79], a[168:171], a[40:43], v[76:79]
  ds_read_b128 a[204:207], v35 offset:16384
  ds_read_b128 a[236:239], v35 offset:18432
  v_mfma_f32_16x16x32_bf16 v[80:83], a[136:139], a[72:75], v[80:83]
  v_mfma_f32_16x16x32_bf16 v[84:87], a[168:171], a[72:75], v[84:87]
  v_mfma_f32_16x16x32_bf16 v[88:91], a[136:139], a[104:107], v[88:91]
  v_mfma_f32_16x16x32_bf16 v[92:95], a[168:171], a[104:107], v[92:95]
  v_mfma_f32_16x16x32_bf16 v[96:99], a[200:203], a[8:11], v[96:99]
  v_mfma_f32_16x16x32_bf16 v[100:103], a[232:235], a[8:11], v[100:103]
  v_mfma_f32_16x16x32_bf16 v[104:107], a[200:203], a[40:43], v[104:107]
  v_mfma_f32_16x16x32_bf16 v[108:111], a[232:235], a[40:43], v[108:111]
  v_mfma_f32_16x16x32_bf16 v[112:115], a[200:203], a[72:75], v[112:115]
  v_mfma_f32_16x16x32_bf16 v[116:119], a[232:235], a[72:75], v[116:119]
  v_mfma_f32_16x16x32_bf16 v[120:123], a[200:203], a[104:107], v[120:123]
  v_mfma_f32_16x16x32_bf16 v[124:127], a[232:235], a[104:107], v[124:127]
  s_waitcnt lgkmcnt(0)
  v_mfma_f32_16x16x32_bf16 v[64:67], a[140:143], a[12:15], v[64:67]
  ds_read_b128 a[16:19], v44 offset:256
  ds_read_b128 a[48:51], v44 offset:1280
  v_mfma_f32_16x16x32_bf16 v[68:71], a[172:175], a[12:15], v[68:71]
  ds_read_b128 a[80:83], v44 offset:4352
  ds_read_b128 a[112:115], v44 offset:5376
  v_mfma_f32_16x16x32_bf16 v[72:75], a[140:143], a[44:47], v[72:75]
  ds_read_b128 a[144:147], v32 offset:256
  ds_read_b128 a[176:179], v32 offset:2304
  v_mfma_f32_16x16x32_bf16 v[76:79], a[172:175], a[44:47], v[76:79]
  ds_read_b128 a[208:211], v32 offset:16640
  ds_read_b128 a[240:243], v32 offset:18688
  v_mfma_f32_16x16x32_bf16 v[80:83], a[140:143], a[76:79], v[80:83]
  v_mfma_f32_16x16x32_bf16 v[84:87], a[172:175], a[76:79], v[84:87]
  v_mfma_f32_16x16x32_bf16 v[88:91], a[140:143], a[108:111], v[88:91]
  v_mfma_f32_16x16x32_bf16 v[92:95], a[172:175], a[108:111], v[92:95]
  v_mfma_f32_16x16x32_bf16 v[96:99], a[204:207], a[12:15], v[96:99]
  v_mfma_f32_16x16x32_bf16 v[100:103], a[236:239], a[12:15], v[100:103]
  v_mfma_f32_16x16x32_bf16 v[104:107], a[204:207], a[44:47], v[104:107]
  v_mfma_f32_16x16x32_bf16 v[108:111], a[236:239], a[44:47], v[108:111]
  v_mfma_f32_16x16x32_bf16 v[112:115], a[204:207], a[76:79], v[112:115]
  v_mfma_f32_16x16x32_bf16 v[116:119], a[236:239], a[76:79], v[116:119]
  v_mfma_f32_16x16x32_bf16 v[120:123], a[204:207], a[108:111], v[120:123]
  v_mfma_f32_16x16x32_bf16 v[124:127], a[236:239], a[108:111], v[124:127]
  s_waitcnt lgkmcnt(0)
  v_mfma_f32_16x16x32_bf16 v[64:67], a[144:147], a[16:19], v[64:67]
  ds_read_b128 a[20:23], v45 offset:256
  ds_read_b128 a[52:55], v45 offset:1280
  v_mfma_f32_16x16x32_bf16 v[68:71], a[176:179], a[16:19], v[68:71]
  ds_read_b128 a[84:87], v45 offset:4352
  ds_read_b128 a[116:119], v45 offset:5376
  v_mfma_f32_16x16x32_bf16 v[72:75], a[144:147], a[48:51], v[72:75]
  ds_read_b128 a[148:151], v33 offset:256
  ds_read_b128 a[180:183], v33 offset:2304
  v_mfma_f32_16x16x32_bf16 v[76:79], a[176:179], a[48:51], v[76:79]
  ds_read_b128 a[212:215], v33 offset:16640
  ds_read_b128 a[244:247], v33 offset:18688
  v_mfma_f32_16x16x32_bf16 v[80:83], a[144:147], a[80:83], v[80:83]
  v_mfma_f32_16x16x32_bf16 v[84:87], a[176:179], a[80:83], v[84:87]
  v_mfma_f32_16x16x32_bf16 v[88:91], a[144:147], a[112:115], v[88:91]
  v_mfma_f32_16x16x32_bf16 v[92:95], a[176:179], a[112:115], v[92:95]
  v_mfma_f32_16x16x32_bf16 v[96:99], a[208:211], a[16:19], v[96:99]
  v_mfma_f32_16x16x32_bf16 v[100:103], a[240:243], a[16:19], v[100:103]
  v_mfma_f32_16x16x32_bf16 v[104:107], a[208:211], a[48:51], v[104:107]
  v_mfma_f32_16x16x32_bf16 v[108:111], a[240:243], a[48:51], v[108:111]
  v_mfma_f32_16x16x32_bf16 v[112:115], a[208:211], a[80:83], v[112:115]
  v_mfma_f32_16x16x32_bf16 v[116:119], a[240:243], a[80:83], v[116:119]
  v_mfma_f32_16x16x32_bf16 v[120:123], a[208:211], a[112:115], v[120:123]
  v_mfma_f32_16x16x32_bf16 v[124:127], a[240:243], a[112:115], v[124:127]
  s_waitcnt lgkmcnt(0)
  v_mfma_f32_16x16x32_bf16 v[64:67], a[148:151], a[20:23], v[64:67]
  ds_read_b128 a[24:27], v46 offset:256
  ds_read_b128 a[56:59], v46 offset:1280
  v_mfma_f32_16x16x32_bf16 v[68:71], a[180:183], a[20:23], v[68:71]
  ds_read_b128 a[88:91], v46 offset:4352
  ds_read_b128 a[120:123], v46 offset:5376
  v_mfma_f32_16x16x32_bf16 v[72:75], a[148:151], a[52:55], v[72:75]
  ds_read_b128 a[152:155], v34 offset:256
  ds_read_b128 a[184:187], v34 offset:2304
  v_mfma_f32_16x16x32_bf16 v[76:79], a[180:183], a[52:55], v[76:79]
  ds_read_b128 a[216:219], v34 offset:16640
  ds_read_b128 a[248:251], v34 offset:18688
  v_mfma_f32_16x16x32_bf16 v[80:83], a[148:151], a[84:87], v[80:83]
  v_mfma_f32_16x16x32_bf16 v[84:87], a[180:183], a[84:87], v[84:87]
  v_mfma_f32_16x16x32_bf16 v[88:91], a[148:151], a[116:119], v[88:91]
  v_mfma_f32_16x16x32_bf16 v[92:95], a[180:183], a[116:119], v[92:95]
  v_mfma_f32_16x16x32_bf16 v[96:99], a[212:215], a[20:23], v[96:99]
  v_mfma_f32_16x16x32_bf16 v[100:103], a[244:247], a[20:23], v[100:103]
  v_mfma_f32_16x16x32_bf16 v[104:107], a[212:215], a[52:55], v[104:107]
  v_mfma_f32_16x16x32_bf16 v[108:111], a[244:247], a[52:55], v[108:111]
  v_mfma_f32_16x16x32_bf16 v[112:115], a[212:215], a[84:87], v[112:115]
  v_mfma_f32_16x16x32_bf16 v[116:119], a[244:247], a[84:87], v[116:119]
  v_mfma_f32_16x16x32_bf16 v[120:123], a[212:215], a[116:119], v[120:123]
  v_mfma_f32_16x16x32_bf16 v[124:127], a[244:247], a[116:119], v[124:127]
  s_waitcnt lgkmcnt(0)
  v_mfma_f32_16x16x32_bf16 v[64:67], a[152:155], a[24:27], v[64:67]
  ds_read_b128 a[28:31], v47 offset:256
  ds_read_b128 a[60:63], v47 offset:1280
  v_mfma_f32_16x16x32_bf16 v[68:71], a[184:187], a[24:27], v[68:71]
  ds_read_b128 a[92:95], v47 offset:4352
  ds_read_b128 a[124:127], v47 offset:5376
  v_mfma_f32_16x16x32_bf16 v[72:75], a[152:155], a[56:59], v[72:75]
  ds_read_b128 a[156:159], v35 offset:256
  ds_read_b128 a[188:191], v35 offset:2304
  v_mfma_f32_16x16x32_bf16 v[76:79], a[184:187], a[56:59], v[76:79]
  ds_read_b128 a[220:223], v35 offset:16640
  ds_read_b128 a[252:255], v35 offset:18688
  v_mfma_f32_16x16x32_bf16 v[80:83], a[152:155], a[88:91], v[80:83]
  v_mfma_f32_16x16x32_bf16 v[84:87], a[184:187], a[88:91], v[84:87]
  v_mfma_f32_16x16x32_bf16 v[88:91], a[152:155], a[120:123], v[88:91]
  v_mfma_f32_16x16x32_bf16 v[92:95], a[184:187], a[120:123], v[92:95]
  v_mfma_f32_16x16x32_bf16 v[96:99], a[216:219], a[24:27], v[96:99]
  v_mfma_f32_16x16x32_bf16 v[100:103], a[248:251], a[24:27], v[100:103]
  v_mfma_f32_16x16x32_bf16 v[104:107], a[216:219], a[56:59], v[104:107]
  v_mfma_f32_16x16x32_bf16 v[108:111], a[248:251], a[56:59], v[108:111]
  v_mfma_f32_16x16x32_bf16 v[112:115], a[216:219], a[88:91], v[112:115]
  v_mfma_f32_16x16x32_bf16 v[116:119], a[248:251], a[88:91], v[116:119]
  v_mfma_f32_16x16x32_bf16 v[120:123], a[216:219], a[120:123], v[120:123]
  v_mfma_f32_16x16x32_bf16 v[124:127], a[248:251], a[120:123], v[124:127]
  s_waitcnt lgkmcnt(0)
  s_barrier
  buffer_load_dwordx2 v[254:255], v252, s[12:15], 0 offen offset:128 sc1
  buffer_load_dword v253, v252, s[12:15], 0 offen sc1
  v_mfma_f32_16x16x32_bf16 v[64:67], a[156:159], a[28:31], v[64:67]
  v_mfma_f32_16x16x32_bf16 v[68:71], a[188:191], a[28:31], v[68:71]
  v_mfma_f32_16x16x32_bf16 v[72:75], a[156:159], a[60:63], v[72:75]
  v_mfma_f32_16x16x32_bf16 v[76:79], a[188:191], a[60:63], v[76:79]
  v_mfma_f32_16x16x32_bf16 v[80:83], a[156:159], a[92:95], v[80:83]
  v_pk_mul_f32 v[64:65], v[64:65], v[48:49] op_sel_hi:[1,0]
  v_pk_mul_f32 v[66:67], v[66:67], v[48:49] op_sel_hi:[1,0]
  v_mfma_f32_16x16x32_bf16 v[84:87], a[188:191], a[92:95], v[84:87]
  v_pk_mul_f32 v[68:69], v[68:69], v[48:49] op_sel_hi:[1,0]
  v_pk_mul_f32 v[70:71], v[70:71], v[48:49] op_sel_hi:[1,0]
  v_mfma_f32_16x16x32_bf16 v[88:91], a[156:159], a[124:127], v[88:91]
  v_cvt_pk_bf16_f32 v64, v64, v65
  v_cvt_pk_bf16_f32 v65, v66, v67
  v_mfma_f32_16x16x32_bf16 v[92:95], a[188:191], a[124:127], v[92:95]
  v_cvt_pk_bf16_f32 v66, v68, v69
  v_cvt_pk_bf16_f32 v67, v70, v71
  v_mfma_f32_16x16x32_bf16 v[96:99], a[220:223], a[28:31], v[96:99]
  buffer_store_dwordx4 v[64:67], v28, s[8:11], s29 offen sc1
  v_pk_mul_f32 v[72:73], v[72:73], v[48:49] op_sel_hi:[1,0]
  v_mfma_f32_16x16x32_bf16 v[100:103], a[252:255], a[28:31], v[100:103]
  v_pk_mul_f32 v[74:75], v[74:75], v[48:49] op_sel_hi:[1,0]
  v_pk_mul_f32 v[76:77], v[76:77], v[48:49] op_sel_hi:[1,0]
  v_mfma_f32_16x16x32_bf16 v[104:107], a[220:223], a[60:63], v[104:107]
  v_pk_mul_f32 v[78:79], v[78:79], v[48:49] op_sel_hi:[1,0]
  v_cvt_pk_bf16_f32 v72, v72, v73
  v_mfma_f32_16x16x32_bf16 v[108:111], a[252:255], a[60:63], v[108:111]
  v_cvt_pk_bf16_f32 v73, v74, v75
  v_cvt_pk_bf16_f32 v74, v76, v77
  v_mfma_f32_16x16x32_bf16 v[112:115], a[220:223], a[92:95], v[112:115]
  v_cvt_pk_bf16_f32 v75, v78, v79
  buffer_store_dwordx4 v[72:75], v29, s[8:11], s29 offen sc1
  v_mfma_f32_16x16x32_bf16 v[116:119], a[252:255], a[92:95], v[116:119]
  v_pk_mul_f32 v[80:81], v[80:81], v[48:49] op_sel_hi:[1,0]
  v_pk_mul_f32 v[82:83], v[82:83], v[48:49] op_sel_hi:[1,0]
  v_mfma_f32_16x16x32_bf16 v[120:123], a[220:223], a[124:127], v[120:123]
  v_pk_mul_f32 v[84:85], v[84:85], v[48:49] op_sel_hi:[1,0]
  v_pk_mul_f32 v[86:87], v[86:87], v[48:49] op_sel_hi:[1,0]
  v_mfma_f32_16x16x32_bf16 v[124:127], a[252:255], a[124:127], v[124:127]
  v_cvt_pk_bf16_f32 v80, v80, v81
  v_cvt_pk_bf16_f32 v81, v82, v83
  v_cvt_pk_bf16_f32 v82, v84, v85
  v_cvt_pk_bf16_f32 v83, v86, v87
  buffer_store_dwordx4 v[80:83], v30, s[8:11], s29 offen sc1
  v_pk_mul_f32 v[88:89], v[88:89], v[48:49] op_sel_hi:[1,0]
  v_pk_mul_f32 v[90:91], v[90:91], v[48:49] op_sel_hi:[1,0]
  v_pk_mul_f32 v[92:93], v[92:93], v[48:49] op_sel_hi:[1,0]
  v_pk_mul_f32 v[94:95], v[94:95], v[48:49] op_sel_hi:[1,0]
  v_cvt_pk_bf16_f32 v88, v88, v89
  v_cvt_pk_bf16_f32 v89, v90, v91
  v_cvt_pk_bf16_f32 v90, v92, v93
  v_cvt_pk_bf16_f32 v91, v94, v95
  buffer_store_dwordx4 v[88:91], v31, s[8:11], s29 offen sc1
  v_pk_mul_f32 v[96:97], v[96:97], v[48:49] op_sel_hi:[1,0]
  v_pk_mul_f32 v[98:99], v[98:99], v[48:49] op_sel_hi:[1,0]
  v_pk_mul_f32 v[100:101], v[100:101], v[48:49] op_sel_hi:[1,0]
  v_pk_mul_f32 v[102:103], v[102:103], v[48:49] op_sel_hi:[1,0]
  v_cvt_pk_bf16_f32 v96, v96, v97
  v_cvt_pk_bf16_f32 v97, v98, v99
  v_cvt_pk_bf16_f32 v98, v100, v101
  v_cvt_pk_bf16_f32 v99, v102, v103
  buffer_store_dwordx4 v[96:99], v28, s[8:11], s31 offen sc1
  v_pk_mul_f32 v[104:105], v[104:105], v[48:49] op_sel_hi:[1,0]
  v_pk_mul_f32 v[106:107], v[106:107], v[48:49] op_sel_hi:[1,0]
  v_pk_mul_f32 v[108:109], v[108:109], v[48:49] op_sel_hi:[1,0]
  v_pk_mul_f32 v[110:111], v[110:111], v[48:49] op_sel_hi:[1,0]
  v_cvt_pk_bf16_f32 v104, v104, v105
  v_cvt_pk_bf16_f32 v105, v106, v107
  v_cvt_pk_bf16_f32 v106, v108, v109
  v_cvt_pk_bf16_f32 v107, v110, v111
  buffer_store_dwordx4 v[104:107], v29, s[8:11], s31 offen sc1
  v_pk_mul_f32 v[112:113], v[112:113], v[48:49] op_sel_hi:[1,0]
  v_pk_mul_f32 v[114:115], v[114:115], v[48:49] op_sel_hi:[1,0]
  v_pk_mul_f32 v[116:117], v[116:117], v[48:49] op_sel_hi:[1,0]
  v_pk_mul_f32 v[118:119], v[118:119], v[48:49] op_sel_hi:[1,0]
  v_cvt_pk_bf16_f32 v112, v112, v113
  v_cvt_pk_bf16_f32 v113, v114, v115
  v_cvt_pk_bf16_f32 v114, v116, v117
  v_cvt_pk_bf16_f32 v115, v118, v119
  buffer_store_dwordx4 v[112:115], v30, s[8:11], s31 offen sc1
  v_pk_mul_f32 v[120:121], v[120:121], v[48:49] op_sel_hi:[1,0]
  v_pk_mul_f32 v[122:123], v[122:123], v[48:49] op_sel_hi:[1,0]
  v_pk_mul_f32 v[124:125], v[124:125], v[48:49] op_sel_hi:[1,0]
  v_pk_mul_f32 v[126:127], v[126:127], v[48:49] op_sel_hi:[1,0]
  v_cvt_pk_bf16_f32 v120, v120, v121
  v_cvt_pk_bf16_f32 v121, v122, v123
  v_cvt_pk_bf16_f32 v122, v124, v125
  v_cvt_pk_bf16_f32 v123, v126, v127
  buffer_store_dwordx4 v[120:123], v31, s[8:11], s31 offen sc1
  s_waitcnt vmcnt(0)
  s_barrier
  s_cmp_lg_u32 s16, 0
  s_cbranch_scc1 wp_f3_f
  v_readfirstlane_b32 s20, v254
  s_cmp_eq_u32 s20, 1
  s_cbranch_scc1 wp_f3_w_ok
  s_mov_b32 s30, 0
wp_f3_w:
  buffer_load_dword v254, off, s[12:15], 0 offset:128 sc1
  s_waitcnt vmcnt(0)
  v_cmp_ne_u32 vcc, 1, v254
  s_cbranch_vccz wp_f3_w_ok
  s_sleep 8
  s_add_u32 s30, s30, 1
  s_cmp_lt_u32 s30, 16
  s_cbranch_scc1 wp_f3_w
  s_branch wp_f3_f
wp_f3_w_ok:
  s_lshl_b32 s20, s17, 7
  s_add_u32 s20, s20, 584192
  s_lshl_b32 s21, 1, s19
  v_mov_b32 v248, s21
  s_mov_b64 exec, 1
  buffer_atomic_or v248, v252, s[8:11], s20 offen sc0
  s_mov_b64 exec, -1
  s_mov_b32 s38, s21
wp_f3_f:
  s_cmp_eq_u32 s97, 3
  s_cbranch_scc1 wk_adone
wp_fin:
  s_cmp_lg_u32 s97, 0
  s_cbranch_scc1 wp_all
  v_readfirstlane_b32 s20, v254
  v_readfirstlane_b32 s21, v253
  s_and_b32 s21, s21, 0xffe0
  s_cselect_b32 s96, s20, 0
  s_cmp_eq_u32 s96, 0
  s_cbranch_scc1 wp_all
  v_mov_b32 v250, 1
  s_mov_b32 s20, 588288
  s_mov_b64 exec, 1
  buffer_atomic_add v250, v252, s[8:11], s20 offen sc0
  s_mov_b64 exec, -1
wp_all:
  v_mov_b32 v252, 0x40000000
  v_cmp_eq_u32 vcc, 0, v0
  s_nop 1
  v_cndmask_b32 v252, v252, v0, vcc
  s_mov_b32 s34, 0
  s_cmp_lg_u32 s16, 0
  s_cbranch_scc1 wp_w2
  s_getreg_b32 s24, hwreg(HW_REG_XCC_ID)
  s_sub_u32 s24, s24, 3
  s_and_b32 s24, s24, 7
  s_lshl_b32 s24, s24, 7
  s_add_u32 s24, s24, 586240
  s_cmp_lg_u32 s96, 0
  s_cbranch_scc1 wp_v0
  s_waitcnt vmcnt(0)
wp_v0:
  s_cmp_eq_u32 s97, 0
  s_cbranch_scc1 wp_v1
  s_waitcnt vmcnt(0)
wp_v1:
  s_waitcnt vmcnt(1)
  v_readfirstlane_b32 s20, v248
  s_and_b32 s20, s20, 14448
  s_xor_b32 s20, s20, s38
  s_cmp_lg_u32 s20, 14448
  s_cselect_b32 s20, 0, s38
  s_mov_b32 s38, 0
  s_cmp_eq_u32 s20, 0
  s_cbranch_scc1 wp_g3
  s_lshl_b32 s21, 65536, s17
  v_mov_b32 v248, s21
  s_mov_b32 s20, 586240
  v_lshlrev_b32 v247, 7, v0
  s_mov_b64 exec, 0xff
  buffer_atomic_or v248, v247, s[8:11], s20 offen
  s_mov_b64 exec, -1
wp_g3:
  v_readfirstlane_b32 s20, v248
  s_and_b32 s20, s20, 16383
  s_xor_b32 s20, s20, s37
  s_cmp_lg_u32 s20, 16383
  s_cselect_b32 s20, 0, s37
  s_mov_b32 s37, 0
  s_cmp_eq_u32 s20, 0
  s_cbranch_scc1 wp_g2
  s_lshl_b32 s21, 1, s17
  v_mov_b32 v248, s21
  s_mov_b32 s20, 586240
  v_lshlrev_b32 v247, 7, v0
  s_mov_b64 exec, 0xff
  buffer_atomic_or v248, v247, s[8:11], s20 offen
  s_mov_b64 exec, -1
wp_g2:
  s_cmp_lg_u32 s96, 0
  s_cbranch_scc1 wp_v_ok
  s_mov_b32 s30, 0
wp_v:
  buffer_load_dwordx2 v[64:65], off, s[12:15], 0 sc1
  buffer_load_dword v66, off, s[12:15], 0 offset:128 sc1
  s_waitcnt vmcnt(0)
  v_and_b32 v68, 0xffe0, v64
  v_min_u32 v68, v68, v66
  v_cmp_ne_u32 vcc, 1, v68
  s_cbranch_vccz wp_v_ok
  s_sleep 16
  s_add_u32 s30, s30, 1
  s_cmp_lt_u32 s30, 30
  s_cbranch_scc1 wp_v
  s_branch wp_w1
wp_v_ok:
  v_mov_b32 v64, 32
  s_cmp_eq_u32 s97, 2
  s_cselect_b32 s31, 1, 60
  s_cmp_eq_u32 s39, -1
  s_cselect_b32 s20, 4, 0
  s_add_u32 s24, s24, s20
  s_mov_b32 s30, 0
wp_w:
  buffer_load_dword v66, off, s[8:11], s24 sc1
  buffer_load_dword v67, off, s[8:11], s24 offset:4 sc1
  s_waitcnt vmcnt(0)
  v_or_b32 v66, s39, v66
  v_add_u32 v66, v66, v67
  v_cmp_ne_u32 vcc, 0, v66
  s_cbranch_vccz wp_w_ok
  s_sleep 8
  s_add_u32 s30, s30, 1
  s_cmp_lt_u32 s30, s31
  s_cbranch_scc1 wp_w
  s_branch wp_w1
wp_w_ok:
  s_branch wp_w2
wp_w1:
  v_readfirstlane_b32 s20, v64
  v_readfirstlane_b32 s21, v65
  s_and_b32 s20, s20, 0xffff
  s_cmp_lt_u32 s20, 32
  s_cselect_b32 s34, 2, 1
  s_add_u32 s32, s32, 1
  s_cmp_lt_u32 s32, 4000
  s_cselect_b32 s34, s34, 3
wp_w2:
  v_mov_b32 v6, 160032
  v_mov_b32 v7, s34
  s_barrier
  s_cmp_lg_u32 s16, 0
  s_cbranch_scc1 uni_7
  ds_write_b32 v6, v7
  s_waitcnt lgkmcnt(0)
uni_7:
  s_barrier
  ds_read_b32 v7, v6
  s_waitcnt lgkmcnt(0)
  v_readfirstlane_b32 s34, v7
  s_cmp_lg_u32 s34, 0
  s_cbranch_scc1 wp_bad
  s_cmp_lg_u32 s39, -1
  s_cbranch_scc1 wp_done
  s_mov_b32 s101, 0
  s_lshl_b32 s20, s101, 4
  s_lshr_b32 s21, s2, 3
  s_add_u32 s21, s21, s16
  s_and_b32 s21, s21, 3
  s_lshl_b32 s21, s21, 2
  s_add_u32 s20, s20, s21
  s_mul_i32 s21, s20, 14336
  s_add_u32 s21, s21, 655360
  s_add_u32 s22, s21, 0
  buffer_load_dwordx4 a[0:3], v2, s[8:11], s22 offen offset:0 sc1
  buffer_load_dwordx4 a[4:7], v2, s[8:11], s22 offen offset:1024 sc1
  buffer_load_dwordx4 a[8:11], v2, s[8:11], s22 offen offset:2048 sc1
  buffer_load_dwordx4 a[12:15], v2, s[8:11], s22 offen offset:3072 sc1
  s_add_u32 s22, s21, 4096
  buffer_load_dwordx4 a[16:19], v2, s[8:11], s22 offen offset:0 sc1
  buffer_load_dwordx4 a[20:23], v2, s[8:11], s22 offen offset:1024 sc1
  buffer_load_dwordx4 a[24:27], v2, s[8:11], s22 offen offset:2048 sc1
  buffer_load_dwordx4 a[28:31], v2, s[8:11], s22 offen offset:3072 sc1
  s_add_u32 s22, s21, 8192
  buffer_load_dwordx4 a[32:35], v2, s[8:11], s22 offen offset:0 sc1
  buffer_load_dwordx4 a[36:39], v2, s[8:11], s22 offen offset:1024 sc1
  buffer_load_dwordx4 a[40:43], v2, s[8:11], s22 offen offset:2048 sc1
  buffer_load_dwordx4 a[44:47], v2, s[8:11], s22 offen offset:3072 sc1
  s_add_u32 s22, s21, 12288
  buffer_load_dwordx4 a[48:51], v2, s[8:11], s22 offen offset:0 sc1
  buffer_load_dwordx4 a[52:55], v2, s[8:11], s22 offen offset:1024 sc1
  buffer_load_dwordx4 a[56:59], v2, s[8:11], s22 offen offset:2048 sc1
  buffer_load_dwordx4 a[60:63], v2, s[8:11], s22 offen offset:3072 sc1
  s_add_u32 s22, s21, 16384
  buffer_load_dwordx4 a[64:67], v2, s[8:11], s22 offen offset:0 sc1
  buffer_load_dwordx4 a[68:71], v2, s[8:11], s22 offen offset:1024 sc1
  buffer_load_dwordx4 a[72:75], v2, s[8:11], s22 offen offset:2048 sc1
  buffer_load_dwordx4 a[76:79], v2, s[8:11], s22 offen offset:3072 sc1
  s_add_u32 s22, s21, 20480
  buffer_load_dwordx4 a[80:83], v2, s[8:11], s22 offen offset:0 sc1
  buffer_load_dwordx4 a[84:87], v2, s[8:11], s22 offen offset:1024 sc1
  buffer_load_dwordx4 a[88:91], v2, s[8:11], s22 offen offset:2048 sc1
  buffer_load_dwordx4 a[92:95], v2, s[8:11], s22 offen offset:3072 sc1
  s_add_u32 s22, s21, 24576
  buffer_load_dwordx4 a[96:99], v2, s[8:11], s22 offen offset:0 sc1
  buffer_load_dwordx4 a[100:103], v2, s[8:11], s22 offen offset:1024 sc1
  buffer_load_dwordx4 a[104:107], v2, s[8:11], s22 offen offset:2048 sc1
  buffer_load_dwordx4 a[108:111], v2, s[8:11], s22 offen offset:3072 sc1
  s_add_u32 s22, s21, 28672
  buffer_load_dwordx4 a[112:115], v2, s[8:11], s22 offen offset:0 sc1
  buffer_load_dwordx4 a[116:119], v2, s[8:11], s22 offen offset:1024 sc1
  buffer_load_dwordx4 a[120:123], v2, s[8:11], s22 offen offset:2048 sc1
  buffer_load_dwordx4 a[124:127], v2, s[8:11], s22 offen offset:3072 sc1
  s_add_u32 s22, s21, 32768
  buffer_load_dwordx4 a[128:131], v2, s[8:11], s22 offen offset:0 sc1
  buffer_load_dwordx4 a[132:135], v2, s[8:11], s22 offen offset:1024 sc1
  buffer_load_dwordx4 a[136:139], v2, s[8:11], s22 offen offset:2048 sc1
  buffer_load_dwordx4 a[140:143], v2, s[8:11], s22 offen offset:3072 sc1
  s_add_u32 s22, s21, 36864
  buffer_load_dwordx4 a[144:147], v2, s[8:11], s22 offen offset:0 sc1
  buffer_load_dwordx4 a[148:151], v2, s[8:11], s22 offen offset:1024 sc1
  buffer_load_dwordx4 a[152:155], v2, s[8:11], s22 offen offset:2048 sc1
  buffer_load_dwordx4 a[156:159], v2, s[8:11], s22 offen offset:3072 sc1
  s_add_u32 s22, s21, 40960
  s_waitcnt vmcnt(40)
  buffer_load_dwordx4 a[160:163], v2, s[8:11], s22 offen offset:0 sc1
  buffer_load_dwordx4 a[164:167], v2, s[8:11], s22 offen offset:1024 sc1
  buffer_load_dwordx4 a[168:171], v2, s[8:11], s22 offen offset:2048 sc1
  buffer_load_dwordx4 a[172:175], v2, s[8:11], s22 offen offset:3072 sc1
  s_add_u32 s22, s21, 45056
  buffer_load_dwordx4 a[176:179], v2, s[8:11], s22 offen offset:0 sc1
  buffer_load_dwordx4 a[180:183], v2, s[8:11], s22 offen offset:1024 sc1
  buffer_load_dwordx4 a[184:187], v2, s[8:11], s22 offen offset:2048 sc1
  buffer_load_dwordx4 a[188:191], v2, s[8:11], s22 offen offset:3072 sc1
  s_add_u32 s22, s21, 49152
  buffer_load_dwordx4 a[192:195], v2, s[8:11], s22 offen offset:0 sc1
  buffer_load_dwordx4 a[196:199], v2, s[8:11], s22 offen offset:1024 sc1
  buffer_load_dwordx4 a[200:203], v2, s[8:11], s22 offen offset:2048 sc1
  buffer_load_dwordx4 a[204:207], v2, s[8:11], s22 offen offset:3072 sc1
  s_add_u32 s22, s21, 53248
  buffer_load_dwordx4 a[208:211], v2, s[8:11], s22 offen offset:0 sc1
  buffer_load_dwordx4 a[212:215], v2, s[8:11], s22 offen offset:1024 sc1
  buffer_load_dwordx4 a[216:219], v2, s[8:11], s22 offen offset:2048 sc1
  buffer_load_dwordx4 a[220:223], v2, s[8:11], s22 offen offset:3072 sc1
  s_mov_b32 s39, 0xffff0000
  s_branch wp_all
wp_bad:
  s_and_b32 s39, s39, 0xffff0000
  s_mov_b32 s97, 1
  s_cmp_eq_u32 s34, 1
  s_cbranch_scc1 wp_rep
  s_cmp_eq_u32 s34, 3
  s_cbranch_scc1 cA_abort
  s_load_dwordx8 s[40:47], s[0:1], 72
  s_load_dwordx4 s[48:51], s[0:1], 56
  s_waitcnt lgkmcnt(0)
  v_mov_b32 v4, 0x10001
  s_mov_b32 s18, 1
  s_branch ch_take
wp_rep:
  s_mov_b32 s101, -1
  s_load_dwordx8 s[40:47], s[0:1], 72
  s_load_dwordx4 s[48:51], s[0:1], 56
  s_waitcnt vmcnt(0) lgkmcnt(0)
  v_mov_b32 v4, 1
  v_mov_b32 v5, 20
  v_mov_b32 v6, 160000
  s_barrier
  s_cmp_lg_u32 s16, 0
  s_cbranch_scc1 wp_el1
  s_mov_b64 exec, 1
  buffer_atomic_add v4, v5, s[12:15], 0 offen sc0
  s_waitcnt vmcnt(0)
  ds_write_b32 v6, v4
  s_waitcnt lgkmcnt(0)
  s_mov_b64 exec, -1
wp_el1:
  s_barrier
  ds_read_b32 v4, v6
  s_waitcnt lgkmcnt(0)
  v_readfirstlane_b32 s33, v4
  v_and_b32 v1, 63, v0
  v_lshlrev_b32 v2, 4, v1
  v_lshrrev_b32 v3, 4, v1
  v_and_b32 v4, 15, v1
  v_lshrrev_b32 v5, 5, v1
  v_and_b32 v6, 31, v1
  v_xor_b32 v8, v6, v5
  v_lshlrev_b32 v8, 4, v8
  v_lshl_add_u32 v16, v5, 13, v8
  v_xor_b32 v17, 32, v16
  v_xor_b32 v18, 64, v16
  v_xor_b32 v19, 96, v16
  v_xor_b32 v20, 128, v16
  v_xor_b32 v21, 160, v16
  v_xor_b32 v22, 192, v16
  v_xor_b32 v23, 224, v16
  s_lshl_b32 s20, s16, 6
  v_xor_b32 v26, s20, v16
  v_xor_b32 v27, 32, v26
  s_and_b32 s33, s33, 511
  s_and_b32 s20, s33, 255
  s_cmp_ge_u32 s20, 224
  s_cselect_b32 s97, 1, 2
  s_cbranch_scc1 wp_all
  s_mul_i32 s17, s20, 4682
  s_lshr_b32 s17, s17, 16
  s_mul_i32 s23, s17, 14
  s_sub_u32 s19, s20, s23
  s_cmp_lt_u32 s19, 7
  s_cselect_b32 s18, 0, 7
  s_cselect_b32 s28, 0, 8
  s_sub_u32 s18, s19, s18
  s_add_u32 s28, s28, s16
  s_lshl_b32 s25, s16, 15
  s_add_u32 s25, s25, 32768
  s_lshl_b32 s26, s17, 9
  s_lshl_b32 s20, s17, 7
  s_lshr_b32 s21, s33, 8
  s_lshl_b32 s21, s21, 11
  s_add_u32 s20, s20, s21
  s_add_u32 s20, s20, 582144
  buffer_load_dword v5, off, s[8:11], s20 sc1
  s_waitcnt vmcnt(0)
  v_readfirstlane_b32 s34, v5
  v_mov_b32 v6, 160032
  s_nop 0
  v_mov_b32 v7, s34
  s_barrier
  s_cmp_lg_u32 s16, 0
  s_cbranch_scc1 uni_8
  ds_write_b32 v6, v7
  s_waitcnt lgkmcnt(0)
uni_8:
  s_barrier
  ds_read_b32 v7, v6
  s_waitcnt lgkmcnt(0)
  v_readfirstlane_b32 s34, v7
  s_cmp_lt_u32 s33, 256
  s_cselect_b32 s20, 0, 1935
  s_or_b32 s34, s34, s20
  s_bitcmp1_b32 s34, s19
  s_cbranch_scc1 wp_rep
  s_barrier
  s_cmp_lt_u32 s33, 256
  s_cbranch_scc1 wp_B
  s_branch wp_A0
wp_done:
  s_mov_b32 s97, s39
  s_cmp_lg_u32 s96, 0
  s_cbranch_scc1 wk_next
  s_cmp_lg_u32 s16, 0
  s_cbranch_scc1 ask_9
  v_mov_b32 v250, 1
  v_mov_b32 v251, 588288
  s_mov_b64 exec, 1
  buffer_atomic_add v250, v251, s[8:11], 0 offen sc0
  s_mov_b64 exec, -1
ask_9:
  s_branch wk_next
wk_loop:
  s_waitcnt vmcnt(0) lgkmcnt(0)
  s_getreg_b32 s22, hwreg(HW_REG_XCC_ID)
  s_and_b32 s22, s22, 15
  s_bitcmp0_b32 4, s22
  s_cbranch_scc1 wk_ni
  s_cmp_ge_u32 s96, 6
  s_cbranch_scc1 wk_ni
  s_mov_b32 s96, 6
  v_mov_b32 v4, 1
  v_mov_b32 v5, 587520
  v_mov_b32 v6, 160000
  s_barrier
  s_cmp_lg_u32 s16, 0
  s_cbranch_scc1 wk_ide1
  s_mov_b64 exec, 1
  buffer_atomic_add v4, v5, s[8:11], 0 offen sc0
  s_waitcnt vmcnt(0)
  ds_write_b32 v6, v4
  s_waitcnt lgkmcnt(0)
  s_mov_b64 exec, -1
wk_ide1:
  s_barrier
  ds_read_b32 v4, v6
  s_waitcnt lgkmcnt(0)
  v_readfirstlane_b32 s3, v4
  s_cmp_lt_u32 s3, 32
  s_cbranch_scc1 wk_done
wk_ni:
  s_getreg_b32 s22, hwreg(HW_REG_XCC_ID)
  s_and_b32 s22, s22, 15
  s_cmp_lg_u32 s22, 15
  s_cbranch_scc1 wk_ask
  s_cmp_eq_u32 s96, 7
  s_cbranch_scc0 wk_srv
wk_ask:
  v_readfirstlane_b32 s22, v250
  s_cmp_ge_u32 s22, 1264
  s_cbranch_scc1 wk_next
  s_cmp_lg_u32 s16, 0
  s_cbranch_scc1 ask_10
  v_mov_b32 v250, 1
  v_mov_b32 v251, 588288
  s_mov_b64 exec, 1
  buffer_atomic_add v250, v251, s[8:11], 0 offen sc0
  s_mov_b64 exec, -1
ask_10:
wk_next:
  v_mov_b32 v6, 160000
  s_waitcnt vmcnt(0)
  s_barrier
  s_cmp_lg_u32 s16, 0
  s_cbranch_scc1 wk_n1
  s_mov_b64 exec, 1
  ds_write_b32 v6, v250
  s_mov_b64 exec, -1
  s_waitcnt lgkmcnt(0)
wk_n1:
  s_barrier
  ds_read_b32 v4, v6
  s_waitcnt lgkmcnt(0)
  v_readfirstlane_b32 s3, v4
  s_cmp_ge_u32 s3, 1264
  s_cbranch_scc1 wk_done
  v_mov_b32 v250, 0
  v_mov_b32 v251, 587264
  s_cmp_lg_u32 s3, 1263
  s_cbranch_scc1 wk_nl
  v_mov_b32 v5, 1264
  s_mov_b64 exec, 1
  buffer_store_dword v5, v251, s[8:11], 0 offen sc1
  s_mov_b64 exec, -1
wk_nl:
  v_and_b32 v1, 63, v0
  v_lshlrev_b32 v2, 4, v1
  v_lshrrev_b32 v3, 4, v1
  v_and_b32 v4, 15, v1
  s_cmp_lt_u32 s3, 112
  s_cbranch_scc1 wk_n2
  s_cmp_eq_u32 s97, 0
  s_cbranch_scc1 wk_n2
  v_mov_b32 v250, s3
  s_mov_b32 s96, 1
  s_mov_b32 s97, 1
  s_mov_b32 s39, 0
  s_mov_b32 s37, 0
  s_mov_b32 s38, 0
  s_mov_b32 s32, 0
  s_branch wp_all
wk_n2:
  s_sub_u32 s20, s3, 288
  s_cmp_ge_u32 s20, 352
  s_cbranch_scc1 wk_nr
  s_cmp_ge_u32 s20, 320
  s_cbranch_scc1 wk_srv
  s_add_u32 s3, s3, 32
wk_nr:
  s_cmp_ge_u32 s3, 752
  s_cbranch_scc1 wk_tok
  s_cmp_ge_u32 s3, 640
  s_cbranch_scc1 wk_s4d
  s_cmp_ge_u32 s3, 448
  s_cbranch_scc1 wk_full
  s_cmp_ge_u32 s3, 320
  s_cbranch_scc1 wk_adef
  s_cmp_ge_u32 s3, 288
  s_cbranch_scc1 wk_srv
  s_and_b32 s17, s3, 15
  s_add_u32 s17, s17, 16
  s_cmp_ge_u32 s3, 224
  s_cbranch_scc1 wk_half
  s_cmp_ge_u32 s3, 112
  s_cselect_b32 s18, 1, 0
  s_cselect_b32 s20, 112, 0
  s_sub_u32 s34, s3, s20
  s_lshr_b32 s34, s34, 4
  s_lshl_b32 s34, s34, 1
  s_add_u32 s35, s34, 2
  s_branch wk_gemm
wk_adef:
  s_mov_b32 s101, -1
  s_load_dwordx8 s[40:47], s[0:1], 72
  s_sub_u32 s20, s3, 320
  s_getreg_b32 s33, hwreg(HW_REG_XCC_ID)
  s_sub_u32 s33, s33, 4
  s_and_b32 s33, s33, 7
  s_min_u32 s33, s33, 7
  s_mov_b32 s35, 7
wk_adc:
  s_lshl_b32 s34, s33, 7
  s_add_u32 s34, s34, 589312
  v_mov_b32 v4, 1
  v_mov_b32 v5, s34
  v_mov_b32 v6, 160000
  s_barrier
  s_cmp_lg_u32 s16, 0
  s_cbranch_scc1 wk_ade1
  s_mov_b64 exec, 1
  buffer_atomic_add v4, v5, s[8:11], 0 offen sc0
  s_waitcnt vmcnt(0)
  ds_write_b32 v6, v4
  s_waitcnt lgkmcnt(0)
  s_mov_b64 exec, -1
wk_ade1:
  s_barrier
  ds_read_b32 v4, v6
  s_waitcnt lgkmcnt(0)
  v_readfirstlane_b32 s20, v4
  s_cmp_lt_u32 s20, 16
  s_cbranch_scc1 wk_adg
  s_mov_b32 s33, s35
  s_sub_u32 s35, s35, 1
  s_max_i32 s35, s35, 0
  s_branch wk_adc
wk_adg:
  s_lshl_b32 s33, s33, 4
  s_add_u32 s20, s20, s33
  v_and_b32 v1, 63, v0
  v_lshlrev_b32 v2, 4, v1
  v_lshrrev_b32 v3, 4, v1
  v_and_b32 v4, 15, v1
  s_lshr_b32 s33, s20, 2
  s_mul_i32 s33, s33, 7
  s_and_b32 s20, s20, 3
  s_add_u32 s33, s33, s20
  s_mov_b32 s97, 3
  v_mov_b32 v252, 0x40000000
  v_cmp_eq_u32 vcc, 0, v0
  s_nop 1
  v_cndmask_b32 v252, v252, v0, vcc
  v_lshrrev_b32 v5, 5, v1
  v_and_b32 v6, 31, v1
  v_xor_b32 v8, v6, v5
  v_lshlrev_b32 v8, 4, v8
  v_lshl_add_u32 v16, v5, 13, v8
  v_xor_b32 v17, 32, v16
  v_xor_b32 v18, 64, v16
  v_xor_b32 v19, 96, v16
  v_xor_b32 v20, 128, v16
  v_xor_b32 v21, 160, v16
  v_xor_b32 v22, 192, v16
  v_xor_b32 v23, 224, v16
  s_lshl_b32 s20, s16, 6
  v_xor_b32 v26, s20, v16
  v_xor_b32 v27, 32, v26
  s_mul_i32 s17, s33, 4682
  s_lshr_b32 s17, s17, 16
  s_mul_i32 s23, s17, 14
  s_sub_u32 s19, s33, s23
  s_cmp_lt_u32 s19, 7
  s_cselect_b32 s18, 0, 7
  s_cselect_b32 s28, 0, 8
  s_sub_u32 s18, s19, s18
  s_add_u32 s28, s28, s16
  s_lshl_b32 s25, s16, 15
  s_add_u32 s25, s25, 32768
  s_lshl_b32 s26, s17, 9
  s_waitcnt lgkmcnt(0)
  s_barrier
  s_branch wp_A0
wk_adone:
  s_mov_b32 s97, 0
  s_branch wk_loop
wk_half:
  s_sub_u32 s20, s3, 224
  s_lshr_b32 s18, s20, 5
  s_add_u32 s18, s18, 2
  s_bitcmp1_b32 s20, 4
  s_cselect_b32 s34, 7, 0
  s_add_u32 s35, s34, 7
  s_branch wk_gemm
wk_full:
  s_sub_u32 s20, s3, 384
  s_and_b32 s17, s20, 15
  s_lshr_b32 s18, s20, 4
  s_mov_b32 s34, 0
  s_mov_b32 s35, 14
  s_cmp_lt_u32 s18, 8
  s_cselect_b32 s21, 16, 0
  s_add_u32 s17, s17, s21
  s_and_b32 s18, s18, 7
  s_cmp_ge_u32 s17, 16
  s_cbranch_scc1 wk_gemm
  s_getreg_b32 s33, hwreg(HW_REG_XCC_ID)
  s_sub_u32 s33, s33, 4
  s_and_b32 s33, s33, 7
  s_min_u32 s33, s33, 7
  s_mov_b32 s35, 7
wk_fxc:
  s_lshl_b32 s34, s33, 7
  s_add_u32 s34, s34, 565312
  v_mov_b32 v4, 1
  v_mov_b32 v5, s34
  v_mov_b32 v6, 160000
  s_barrier
  s_cmp_lg_u32 s16, 0
  s_cbranch_scc1 wk_fxe1
  s_mov_b64 exec, 1
  buffer_atomic_add v4, v5, s[8:11], 0 offen sc0
  s_waitcnt vmcnt(0)
  ds_write_b32 v6, v4
  s_waitcnt lgkmcnt(0)
  s_mov_b64 exec, -1
wk_fxe1:
  s_barrier
  ds_read_b32 v4, v6
  s_waitcnt lgkmcnt(0)
  v_readfirstlane_b32 s20, v4
  s_cmp_lt_u32 s20, 16
  s_cbranch_scc1 wk_fxg
  s_mov_b32 s33, s35
  s_sub_u32 s35, s35, 1
  s_max_i32 s35, s35, 0
  s_branch wk_fxc
wk_fxg:
  s_lshl_b32 s33, s33, 4
  s_add_u32 s20, s20, s33
  v_and_b32 v1, 63, v0
  v_lshlrev_b32 v2, 4, v1
  v_lshrrev_b32 v3, 4, v1
  v_and_b32 v4, 15, v1
  s_lshr_b32 s17, s20, 4
  s_lshl_b32 s17, s17, 1
  s_and_b32 s21, s20, 1
  s_add_u32 s17, s17, s21
  s_bfe_u32 s18, s20, 0x30001
  s_mov_b32 s34, 0
  s_mov_b32 s35, 14
  s_load_dwordx8 s[40:47], s[0:1], 0
  s_load_dwordx2 s[48:49], s[0:1], 32
  s_sub_u32 s21, s3, 512
  v_min_u32 v12, 111, v0
  v_lshlrev_b32 v12, 7, v12
  v_min_u32 v13, 13, v0
  v_lshlrev_b32 v13, 7, v13
  s_mul_i32 s22, s21, 14336
  s_mul_i32 s21, s21, 1792
  s_waitcnt lgkmcnt(0)
  s_cmp_ge_u32 s16, 2
  s_cbranch_scc1 wk_up
  s_mov_b32 s60, s40
  s_and_b32 s61, s41, 0xffff
  s_mov_b32 s62, 1835008
  s_mov_b32 s63, 0x20000
  buffer_load_dword v14, v12, s[60:63], s22 offen
  s_mov_b32 s60, s42
  s_and_b32 s61, s43, 0xffff
  s_mov_b32 s62, 229376
  s_mov_b32 s63, 0x20000
  buffer_load_dword v14, v13, s[60:63], s21 offen
  s_mov_b32 s60, s44
  s_and_b32 s61, s45, 0xffff
  s_mov_b32 s62, 229376
  s_mov_b32 s63, 0x20000
  buffer_load_dword v14, v13, s[60:63], s21 offen
  s_mov_b32 s60, s46
  s_and_b32 s61, s47, 0xffff
  s_mov_b32 s62, 229376
  s_mov_b32 s63, 0x20000
  buffer_load_dword v14, v13, s[60:63], s21 offen
  s_mov_b32 s60, s48
  s_and_b32 s61, s49, 0xffff
  s_mov_b32 s62, 229376
  s_mov_b32 s63, 0x20000
  buffer_load_dword v14, v13, s[60:63], s21 offen
wk_up:
  s_lshl_b32 s27, s17, 7
  s_add_u32 s27, s27, 584192
  s_mov_b32 s28, 16383
  s_mov_b32 s30, 0
wk_aw:
  buffer_load_dword v9, off, s[8:11], s27  sc1
  s_waitcnt vmcnt(0)
  v_and_b32 v10, s28, v9
  v_cmp_ne_u32 vcc, s28, v10
  s_cbranch_vccz wk_aw_ok
  s_sleep 3
  s_add_u32 s30, s30, 1
  s_cmp_lt_u32 s30, 400000
  s_cbranch_scc1 wk_aw
  s_branch cA_abort
wk_aw_ok:
wk_gemm:
  s_lshl_b32 s20, s18, 4
  s_lshr_b32 s21, s2, 3
  s_add_u32 s21, s21, s16
  s_and_b32 s21, s21, 3
  s_lshl_b32 s21, s21, 2
  s_add_u32 s20, s20, s21
  s_mul_i32 s21, s20, 14336
  s_add_u32 s21, s21, 655360
  s_mul_i32 s23, s17, 401408
  s_and_b32 s22, s16, 1
  s_mul_i32 s22, s22, 7168
  s_add_u32 s23, s23, s22
  s_add_u32 s23, s23, 33554432
  s_lshr_b32 s22, s16, 1
  s_mul_i32 s22, s22, 14336
  s_add_u32 s23, s23, s22
  s_mul_i32 s27, s16, 7168
  s_lshr_b32 s28, s20, 1
  s_cmp_lt_u32 s17, 16
  s_cbranch_scc0 wg_vo
  s_add_u32 s23, s23, s22
  s_lshl_b32 s29, s28, 4
  s_add_u32 s29, s29, s17
  s_mul_i32 s29, s29, 28672
  s_add_u32 s29, s29, 46399488
  s_mov_b32 s31, 0
  s_lshr_b32 s24, s34, 1
  s_lshl_b32 s24, s24, 2
  s_and_b32 s25, s34, 1
  s_add_u32 s24, s24, s25
  s_mul_i32 s24, s24, 14336
  s_add_u32 s24, s24, s23
  s_add_u32 m0, s31, s27
  s_nop 0
  buffer_load_dwordx4 v2, s[8:11], s24 offen offset:0 sc1 lds
  buffer_load_dwordx4 v2, s[8:11], s24 offen offset:1024 sc1 lds
  buffer_load_dwordx4 v2, s[8:11], s24 offen offset:2048 sc1 lds
  buffer_load_dwordx4 v2, s[8:11], s24 offen offset:3072 sc1 lds
  s_add_u32 m0, m0, 4096
  s_add_u32 s24, s24, 4096
  buffer_load_dwordx4 v2, s[8:11], s24 offen offset:0 sc1 lds
  buffer_load_dwordx4 v2, s[8:11], s24 offen offset:1024 sc1 lds
  buffer_load_dwordx4 v2, s[8:11], s24 offen offset:2048 sc1 lds
  s_sub_u32 s36, s35, 1
  s_add_u32 s30, s34, 1
  s_min_u32 s30, s30, s36
  s_mov_b32 s31, 28672
  s_lshr_b32 s24, s30, 1
  s_lshl_b32 s24, s24, 2
  s_and_b32 s25, s30, 1
  s_add_u32 s24, s24, s25
  s_mul_i32 s24, s24, 14336
  s_add_u32 s24, s24, s23
  s_add_u32 m0, s31, s27
  s_nop 0
  buffer_load_dwordx4 v2, s[8:11], s24 offen offset:0 sc1 lds
  buffer_load_dwordx4 v2, s[8:11], s24 offen offset:1024 sc1 lds
  buffer_load_dwordx4 v2, s[8:11], s24 offen offset:2048 sc1 lds
  buffer_load_dwordx4 v2, s[8:11], s24 offen offset:3072 sc1 lds
  s_add_u32 m0, m0, 4096
  s_add_u32 s24, s24, 4096
  buffer_load_dwordx4 v2, s[8:11], s24 offen offset:0 sc1 lds
  buffer_load_dwordx4 v2, s[8:11], s24 offen offset:1024 sc1 lds
  buffer_load_dwordx4 v2, s[8:11], s24 offen offset:2048 sc1 lds
  s_mov_b32 s19, s34
  s_mov_b32 s32, 0
  s_mov_b32 s33, 57344
  s_cmp_eq_u32 s18, s101
  s_cbranch_scc1 wg_f_hx
  s_add_u32 s22, s21, 0
  buffer_load_dwordx4 a[0:3], v2, s[8:11], s22 offen offset:0 sc1
  buffer_load_dwordx4 a[4:7], v2, s[8:11], s22 offen offset:1024 sc1
  buffer_load_dwordx4 a[8:11], v2, s[8:11], s22 offen offset:2048 sc1
  buffer_load_dwordx4 a[12:15], v2, s[8:11], s22 offen offset:3072 sc1
  s_add_u32 s22, s21, 4096
  buffer_load_dwordx4 a[16:19], v2, s[8:11], s22 offen offset:0 sc1
  buffer_load_dwordx4 a[20:23], v2, s[8:11], s22 offen offset:1024 sc1
  buffer_load_dwordx4 a[24:27], v2, s[8:11], s22 offen offset:2048 sc1
  buffer_load_dwordx4 a[28:31], v2, s[8:11], s22 offen offset:3072 sc1
  s_add_u32 s22, s21, 8192
  buffer_load_dwordx4 a[32:35], v2, s[8:11], s22 offen offset:0 sc1
  buffer_load_dwordx4 a[36:39], v2, s[8:11], s22 offen offset:1024 sc1
  buffer_load_dwordx4 a[40:43], v2, s[8:11], s22 offen offset:2048 sc1
  buffer_load_dwordx4 a[44:47], v2, s[8:11], s22 offen offset:3072 sc1
  s_add_u32 s22, s21, 12288
  buffer_load_dwordx4 a[48:51], v2, s[8:11], s22 offen offset:0 sc1
  buffer_load_dwordx4 a[52:55], v2, s[8:11], s22 offen offset:1024 sc1
  buffer_load_dwordx4 a[56:59], v2, s[8:11], s22 offen offset:2048 sc1
  buffer_load_dwordx4 a[60:63], v2, s[8:11], s22 offen offset:3072 sc1
  s_add_u32 s22, s21, 16384
  buffer_load_dwordx4 a[64:67], v2, s[8:11], s22 offen offset:0 sc1
  buffer_load_dwordx4 a[68:71], v2, s[8:11], s22 offen offset:1024 sc1
  buffer_load_dwordx4 a[72:75], v2, s[8:11], s22 offen offset:2048 sc1
  buffer_load_dwordx4 a[76:79], v2, s[8:11], s22 offen offset:3072 sc1
  s_add_u32 s22, s21, 20480
  buffer_load_dwordx4 a[80:83], v2, s[8:11], s22 offen offset:0 sc1
  buffer_load_dwordx4 a[84:87], v2, s[8:11], s22 offen offset:1024 sc1
  buffer_load_dwordx4 a[88:91], v2, s[8:11], s22 offen offset:2048 sc1
  buffer_load_dwordx4 a[92:95], v2, s[8:11], s22 offen offset:3072 sc1
  s_add_u32 s22, s21, 24576
  buffer_load_dwordx4 a[96:99], v2, s[8:11], s22 offen offset:0 sc1
  buffer_load_dwordx4 a[100:103], v2, s[8:11], s22 offen offset:1024 sc1
  buffer_load_dwordx4 a[104:107], v2, s[8:11], s22 offen offset:2048 sc1
  buffer_load_dwordx4 a[108:111], v2, s[8:11], s22 offen offset:3072 sc1
  s_add_u32 s22, s21, 28672
  buffer_load_dwordx4 a[112:115], v2, s[8:11], s22 offen offset:0 sc1
  buffer_load_dwordx4 a[116:119], v2, s[8:11], s22 offen offset:1024 sc1
  buffer_load_dwordx4 a[120:123], v2, s[8:11], s22 offen offset:2048 sc1
  buffer_load_dwordx4 a[124:127], v2, s[8:11], s22 offen offset:3072 sc1
  s_add_u32 s22, s21, 32768
  buffer_load_dwordx4 a[128:131], v2, s[8:11], s22 offen offset:0 sc1
  buffer_load_dwordx4 a[132:135], v2, s[8:11], s22 offen offset:1024 sc1
  buffer_load_dwordx4 a[136:139], v2, s[8:11], s22 offen offset:2048 sc1
  buffer_load_dwordx4 a[140:143], v2, s[8:11], s22 offen offset:3072 sc1
  s_add_u32 s22, s21, 36864
  buffer_load_dwordx4 a[144:147], v2, s[8:11], s22 offen offset:0 sc1
  buffer_load_dwordx4 a[148:151], v2, s[8:11], s22 offen offset:1024 sc1
  buffer_load_dwordx4 a[152:155], v2, s[8:11], s22 offen offset:2048 sc1
  buffer_load_dwordx4 a[156:159], v2, s[8:11], s22 offen offset:3072 sc1
  s_add_u32 s22, s21, 40960
  s_waitcnt vmcnt(40)
  buffer_load_dwordx4 a[160:163], v2, s[8:11], s22 offen offset:0 sc1
  buffer_load_dwordx4 a[164:167], v2, s[8:11], s22 offen offset:1024 sc1
  buffer_load_dwordx4 a[168:171], v2, s[8:11], s22 offen offset:2048 sc1
  buffer_load_dwordx4 a[172:175], v2, s[8:11], s22 offen offset:3072 sc1
  s_add_u32 s22, s21, 45056
  buffer_load_dwordx4 a[176:179], v2, s[8:11], s22 offen offset:0 sc1
  buffer_load_dwordx4 a[180:183], v2, s[8:11], s22 offen offset:1024 sc1
  buffer_load_dwordx4 a[184:187], v2, s[8:11], s22 offen offset:2048 sc1
  buffer_load_dwordx4 a[188:191], v2, s[8:11], s22 offen offset:3072 sc1
  s_add_u32 s22, s21, 49152
  buffer_load_dwordx4 a[192:195], v2, s[8:11], s22 offen offset:0 sc1
  buffer_load_dwordx4 a[196:199], v2, s[8:11], s22 offen offset:1024 sc1
  buffer_load_dwordx4 a[200:203], v2, s[8:11], s22 offen offset:2048 sc1
  buffer_load_dwordx4 a[204:207], v2, s[8:11], s22 offen offset:3072 sc1
  s_add_u32 s22, s21, 53248
  buffer_load_dwordx4 a[208:211], v2, s[8:11], s22 offen offset:0 sc1
  buffer_load_dwordx4 a[212:215], v2, s[8:11], s22 offen offset:1024 sc1
  buffer_load_dwordx4 a[216:219], v2, s[8:11], s22 offen offset:2048 sc1
  buffer_load_dwordx4 a[220:223], v2, s[8:11], s22 offen offset:3072 sc1
wg_f_hx:
  s_mov_b32 s101, -1
  s_waitcnt vmcnt(0)
  s_barrier
  s_mov_b32 s40, 0
  s_mov_b32 s41, 0x40000000
  v_mov_b32 v5, v2
  ds_read_b128 v[8:11], v5 offset:0
  ds_read_b128 v[12:15], v5 offset:14336
  ds_read_b128 v[16:19], v5 offset:1024
  ds_read_b128 v[20:23], v5 offset:15360
  ds_read_b128 v[24:27], v5 offset:2048
  s_waitcnt lgkmcnt(4)
.p2align 6
wg_f_loop:
  v_mfma_f32_16x16x32_bf16 v[40:43], v[8:11], a[0:3], 0
  ds_read_b128 v[28:31], v5 offset:16384
  v_mfma_f32_16x16x32_bf16 v[44:47], v[8:11], a[56:59], 0
  v_mfma_f32_16x16x32_bf16 v[48:51], v[8:11], a[112:115], 0
  v_mfma_f32_16x16x32_bf16 v[52:55], v[8:11], a[168:171], 0
  s_waitcnt lgkmcnt(4)
  s_lshl_b32 s42, s40, 10
  v_mfma_f32_16x16x32_bf16 v[56:59], v[12:15], a[0:3], 0
  ds_read_b128 v[32:35], v5 offset:3072
  v_mfma_f32_16x16x32_bf16 v[60:63], v[12:15], a[56:59], 0
  s_add_u32 s42, s42, s41
  v_cvt_pk_bf16_f32 v72, v96, v97
  v_mfma_f32_16x16x32_bf16 v[64:67], v[12:15], a[112:115], 0
  v_cvt_pk_bf16_f32 v73, v98, v99
  v_cvt_pk_bf16_f32 v74, v112, v113
  v_mfma_f32_16x16x32_bf16 v[68:71], v[12:15], a[168:171], 0
  s_waitcnt lgkmcnt(4)
  v_cvt_pk_bf16_f32 v75, v114, v115
  v_mfma_f32_16x16x32_bf16 v[40:43], v[16:19], a[4:7], v[40:43]
  ds_read_b128 v[8:11], v5 offset:17408
  v_mfma_f32_16x16x32_bf16 v[44:47], v[16:19], a[60:63], v[44:47]
  s_add_u32 s43, s42, 0
  v_mfma_f32_16x16x32_bf16 v[48:51], v[16:19], a[116:119], v[48:51]
  buffer_store_dwordx4 v[72:75], v2, s[8:11], s43 offen sc1
  v_cvt_pk_bf16_f32 v76, v100, v101
  v_mfma_f32_16x16x32_bf16 v[52:55], v[16:19], a[172:175], v[52:55]
  s_waitcnt lgkmcnt(4)
  v_cvt_pk_bf16_f32 v77, v102, v103
  v_mfma_f32_16x16x32_bf16 v[56:59], v[20:23], a[4:7], v[56:59]
  ds_read_b128 v[12:15], v5 offset:4096
  v_mfma_f32_16x16x32_bf16 v[60:63], v[20:23], a[60:63], v[60:63]
  v_cvt_pk_bf16_f32 v78, v116, v117
  v_cvt_pk_bf16_f32 v79, v118, v119
  v_mfma_f32_16x16x32_bf16 v[64:67], v[20:23], a[116:119], v[64:67]
  s_add_u32 s43, s42, 14336
  v_mfma_f32_16x16x32_bf16 v[68:71], v[20:23], a[172:175], v[68:71]
  s_waitcnt lgkmcnt(4)
  buffer_store_dwordx4 v[76:79], v2, s[8:11], s43 offen sc1
  v_mfma_f32_16x16x32_bf16 v[40:43], v[24:27], a[8:11], v[40:43]
  ds_read_b128 v[16:19], v5 offset:18432
  v_mfma_f32_16x16x32_bf16 v[44:47], v[24:27], a[64:67], v[44:47]
  v_cvt_pk_bf16_f32 v80, v104, v105
  v_cvt_pk_bf16_f32 v81, v106, v107
  v_mfma_f32_16x16x32_bf16 v[48:51], v[24:27], a[120:123], v[48:51]
  v_cvt_pk_bf16_f32 v82, v120, v121
  v_cvt_pk_bf16_f32 v83, v122, v123
  v_mfma_f32_16x16x32_bf16 v[52:55], v[24:27], a[176:179], v[52:55]
  s_waitcnt lgkmcnt(4)
  s_add_u32 s43, s42, 458752
  v_mfma_f32_16x16x32_bf16 v[56:59], v[28:31], a[8:11], v[56:59]
  ds_read_b128 v[20:23], v5 offset:5120
  v_mfma_f32_16x16x32_bf16 v[60:63], v[28:31], a[64:67], v[60:63]
  buffer_store_dwordx4 v[80:83], v2, s[8:11], s43 offen sc1
  v_cvt_pk_bf16_f32 v84, v108, v109
  v_mfma_f32_16x16x32_bf16 v[64:67], v[28:31], a[120:123], v[64:67]
  v_cvt_pk_bf16_f32 v85, v110, v111
  v_cvt_pk_bf16_f32 v86, v124, v125
  v_mfma_f32_16x16x32_bf16 v[68:71], v[28:31], a[176:179], v[68:71]
  s_waitcnt lgkmcnt(4)
  v_cvt_pk_bf16_f32 v87, v126, v127
  v_mfma_f32_16x16x32_bf16 v[40:43], v[32:35], a[12:15], v[40:43]
  ds_read_b128 v[24:27], v5 offset:19456
  v_mfma_f32_16x16x32_bf16 v[44:47], v[32:35], a[68:71], v[44:47]
  s_add_u32 s43, s42, 473088
  v_mfma_f32_16x16x32_bf16 v[48:51], v[32:35], a[124:127], v[48:51]
  buffer_store_dwordx4 v[84:87], v2, s[8:11], s43 offen sc1
  v_mfma_f32_16x16x32_bf16 v[52:55], v[32:35], a[180:183], v[52:55]
  s_waitcnt lgkmcnt(4)
  s_add_u32 s30, s19, 2
  s_lshr_b32 s24, s30, 1
  s_lshl_b32 s24, s24, 2
  s_and_b32 s25, s30, 1
  s_add_u32 s24, s24, s25
  s_mul_i32 s24, s24, 14336
  v_mfma_f32_16x16x32_bf16 v[56:59], v[8:11], a[12:15], v[56:59]
  ds_read_b128 v[28:31], v5 offset:6144
  v_mfma_f32_16x16x32_bf16 v[60:63], v[8:11], a[68:71], v[60:63]
  s_add_u32 s24, s24, s23
  s_cmp_lt_u32 s30, s35
  s_cselect_b32 s24, s24, 0x40000000
  v_mfma_f32_16x16x32_bf16 v[64:67], v[8:11], a[124:127], v[64:67]
  s_add_u32 m0, s33, s27
  s_nop 0
  buffer_load_dwordx4 v2, s[8:11], s24 offen offset:0 sc1 lds
  v_mfma_f32_16x16x32_bf16 v[68:71], v[8:11], a[180:183], v[68:71]
  s_waitcnt lgkmcnt(4)
  v_mfma_f32_16x16x32_bf16 v[40:43], v[12:15], a[16:19], v[40:43]
  ds_read_b128 v[32:35], v5 offset:20480
  v_mfma_f32_16x16x32_bf16 v[44:47], v[12:15], a[72:75], v[44:47]
  v_mfma_f32_16x16x32_bf16 v[48:51], v[12:15], a[128:131], v[48:51]
  v_mfma_f32_16x16x32_bf16 v[52:55], v[12:15], a[184:187], v[52:55]
  s_waitcnt lgkmcnt(4)
  buffer_load_dwordx4 v2, s[8:11], s24 offen offset:1024 sc1 lds
  v_mfma_f32_16x16x32_bf16 v[56:59], v[16:19], a[16:19], v[56:59]
  ds_read_b128 v[8:11], v5 offset:7168
  v_mfma_f32_16x16x32_bf16 v[60:63], v[16:19], a[72:75], v[60:63]
  v_mfma_f32_16x16x32_bf16 v[64:67], v[16:19], a[128:131], v[64:67]
  v_mfma_f32_16x16x32_bf16 v[68:71], v[16:19], a[184:187], v[68:71]
  s_waitcnt lgkmcnt(4)
  v_mfma_f32_16x16x32_bf16 v[40:43], v[20:23], a[20:23], v[40:43]
  ds_read_b128 v[12:15], v5 offset:21504
  v_mfma_f32_16x16x32_bf16 v[44:47], v[20:23], a[76:79], v[44:47]
  buffer_load_dwordx4 v2, s[8:11], s24 offen offset:2048 sc1 lds
  v_mfma_f32_16x16x32_bf16 v[48:51], v[20:23], a[132:135], v[48:51]
  v_mfma_f32_16x16x32_bf16 v[52:55], v[20:23], a[188:191], v[52:55]
  s_waitcnt lgkmcnt(4)
  v_mfma_f32_16x16x32_bf16 v[56:59], v[24:27], a[20:23], v[56:59]
  ds_read_b128 v[16:19], v5 offset:8192
  v_mfma_f32_16x16x32_bf16 v[60:63], v[24:27], a[76:79], v[60:63]
  v_mfma_f32_16x16x32_bf16 v[64:67], v[24:27], a[132:135], v[64:67]
  buffer_load_dwordx4 v2, s[8:11], s24 offen offset:3072 sc1 lds
  v_mfma_f32_16x16x32_bf16 v[68:71], v[24:27], a[188:191], v[68:71]
  s_waitcnt lgkmcnt(4)
  v_mfma_f32_16x16x32_bf16 v[40:43], v[28:31], a[24:27], v[40:43]
  ds_read_b128 v[20:23], v5 offset:22528
  v_mfma_f32_16x16x32_bf16 v[44:47], v[28:31], a[80:83], v[44:47]
  v_mfma_f32_16x16x32_bf16 v[48:51], v[28:31], a[136:139], v[48:51]
  v_mfma_f32_16x16x32_bf16 v[52:55], v[28:31], a[192:195], v[52:55]
  s_waitcnt lgkmcnt(4)
  s_add_u32 m0, m0, 4096
  s_add_u32 s24, s24, 4096
  buffer_load_dwordx4 v2, s[8:11], s24 offen offset:0 sc1 lds
  v_mfma_f32_16x16x32_bf16 v[56:59], v[32:35], a[24:27], v[56:59]
  ds_read_b128 v[24:27], v5 offset:9216
  v_mfma_f32_16x16x32_bf16 v[60:63], v[32:35], a[80:83], v[60:63]
  v_mfma_f32_16x16x32_bf16 v[64:67], v[32:35], a[136:139], v[64:67]
  v_mfma_f32_16x16x32_bf16 v[68:71], v[32:35], a[192:195], v[68:71]
  s_waitcnt lgkmcnt(4)
  v_mfma_f32_16x16x32_bf16 v[40:43], v[8:11], a[28:31], v[40:43]
  ds_read_b128 v[28:31], v5 offset:23552
  v_mfma_f32_16x16x32_bf16 v[44:47], v[8:11], a[84:87], v[44:47]
  buffer_load_dwordx4 v2, s[8:11], s24 offen offset:1024 sc1 lds
  v_mfma_f32_16x16x32_bf16 v[48:51], v[8:11], a[140:143], v[48:51]
  v_mfma_f32_16x16x32_bf16 v[52:55], v[8:11], a[196:199], v[52:55]
  s_waitcnt lgkmcnt(4)
  v_mfma_f32_16x16x32_bf16 v[56:59], v[12:15], a[28:31], v[56:59]
  ds_read_b128 v[32:35], v5 offset:10240
  v_mfma_f32_16x16x32_bf16 v[60:63], v[12:15], a[84:87], v[60:63]
  v_mfma_f32_16x16x32_bf16 v[64:67], v[12:15], a[140:143], v[64:67]
  buffer_load_dwordx4 v2, s[8:11], s24 offen offset:2048 sc1 lds
  v_mfma_f32_16x16x32_bf16 v[68:71], v[12:15], a[196:199], v[68:71]
  s_waitcnt lgkmcnt(4)
  v_mfma_f32_16x16x32_bf16 v[40:43], v[16:19], a[32:35], v[40:43]
  ds_read_b128 v[8:11], v5 offset:24576
  v_mfma_f32_16x16x32_bf16 v[44:47], v[16:19], a[88:91], v[44:47]
  v_mfma_f32_16x16x32_bf16 v[48:51], v[16:19], a[144:147], v[48:51]
  v_mfma_f32_16x16x32_bf16 v[52:55], v[16:19], a[200:203], v[52:55]
  s_waitcnt lgkmcnt(4)
  s_add_u32 s33, s33, 28672
  s_cmp_eq_u32 s33, 114688
  s_cselect_b32 s33, 0, s33
  v_mfma_f32_16x16x32_bf16 v[56:59], v[20:23], a[32:35], v[56:59]
  ds_read_b128 v[12:15], v5 offset:11264
  v_mfma_f32_16x16x32_bf16 v[60:63], v[20:23], a[88:91], v[60:63]
  s_add_u32 s32, s32, 28672
  s_cmp_eq_u32 s32, 114688
  s_cselect_b32 s32, 0, s32
  v_mfma_f32_16x16x32_bf16 v[64:67], v[20:23], a[144:147], v[64:67]
  v_add_u32 v128, s32, v2
  v_mfma_f32_16x16x32_bf16 v[68:71], v[20:23], a[200:203], v[68:71]
  s_waitcnt lgkmcnt(4)
  v_mfma_f32_16x16x32_bf16 v[40:43], v[24:27], a[36:39], v[40:43]
  ds_read_b128 v[16:19], v5 offset:25600
  v_mfma_f32_16x16x32_bf16 v[44:47], v[24:27], a[92:95], v[44:47]
  v_mfma_f32_16x16x32_bf16 v[48:51], v[24:27], a[148:151], v[48:51]
  v_mfma_f32_16x16x32_bf16 v[52:55], v[24:27], a[204:207], v[52:55]
  s_waitcnt lgkmcnt(4)
  v_mfma_f32_16x16x32_bf16 v[56:59], v[28:31], a[36:39], v[56:59]
  ds_read_b128 v[20:23], v5 offset:12288
  v_mfma_f32_16x16x32_bf16 v[60:63], v[28:31], a[92:95], v[60:63]
  v_mfma_f32_16x16x32_bf16 v[64:67], v[28:31], a[148:151], v[64:67]
  v_mfma_f32_16x16x32_bf16 v[68:71], v[28:31], a[204:207], v[68:71]
  s_waitcnt lgkmcnt(4)
  v_mfma_f32_16x16x32_bf16 v[40:43], v[32:35], a[40:43], v[40:43]
  ds_read_b128 v[24:27], v5 offset:26624
  v_mfma_f32_16x16x32_bf16 v[44:47], v[32:35], a[96:99], v[44:47]
  v_mfma_f32_16x16x32_bf16 v[48:51], v[32:35], a[152:155], v[48:51]
  v_mfma_f32_16x16x32_bf16 v[52:55], v[32:35], a[208:211], v[52:55]
  s_waitcnt lgkmcnt(4)
  v_mfma_f32_16x16x32_bf16 v[56:59], v[8:11], a[40:43], v[56:59]
  ds_read_b128 v[28:31], v5 offset:13312
  v_mfma_f32_16x16x32_bf16 v[60:63], v[8:11], a[96:99], v[60:63]
  v_mfma_f32_16x16x32_bf16 v[64:67], v[8:11], a[152:155], v[64:67]
  v_mfma_f32_16x16x32_bf16 v[68:71], v[8:11], a[208:211], v[68:71]
  s_waitcnt lgkmcnt(4)
  v_mfma_f32_16x16x32_bf16 v[40:43], v[12:15], a[44:47], v[40:43]
  ds_read_b128 v[32:35], v5 offset:27648
  v_mfma_f32_16x16x32_bf16 v[44:47], v[12:15], a[100:103], v[44:47]
  v_mfma_f32_16x16x32_bf16 v[48:51], v[12:15], a[156:159], v[48:51]
  v_mfma_f32_16x16x32_bf16 v[52:55], v[12:15], a[212:215], v[52:55]
  s_waitcnt lgkmcnt(4)
  v_mfma_f32_16x16x32_bf16 v[56:59], v[16:19], a[44:47], v[56:59]
  s_waitcnt vmcnt(11)
  s_barrier
  ds_read_b128 v[8:11], v128 offset:0
  v_mfma_f32_16x16x32_bf16 v[60:63], v[16:19], a[100:103], v[60:63]
  v_mfma_f32_16x16x32_bf16 v[64:67], v[16:19], a[156:159], v[64:67]
  v_mfma_f32_16x16x32_bf16 v[68:71], v[16:19], a[212:215], v[68:71]
  s_waitcnt lgkmcnt(4)
  v_mfma_f32_16x16x32_bf16 v[40:43], v[20:23], a[48:51], v[40:43]
  ds_read_b128 v[12:15], v128 offset:14336
  v_mfma_f32_16x16x32_bf16 v[44:47], v[20:23], a[104:107], v[44:47]
  v_mfma_f32_16x16x32_bf16 v[48:51], v[20:23], a[160:163], v[48:51]
  v_mfma_f32_16x16x32_bf16 v[52:55], v[20:23], a[216:219], v[52:55]
  s_waitcnt lgkmcnt(4)
  v_mfma_f32_16x16x32_bf16 v[56:59], v[24:27], a[48:51], v[56:59]
  ds_read_b128 v[16:19], v128 offset:1024
  v_mfma_f32_16x16x32_bf16 v[60:63], v[24:27], a[104:107], v[60:63]
  v_mfma_f32_16x16x32_bf16 v[64:67], v[24:27], a[160:163], v[64:67]
  v_mfma_f32_16x16x32_bf16 v[68:71], v[24:27], a[216:219], v[68:71]
  s_waitcnt lgkmcnt(4)
  v_mfma_f32_16x16x32_bf16 v[40:43], v[28:31], a[52:55], v[40:43]
  ds_read_b128 v[20:23], v128 offset:15360
  v_mfma_f32_16x16x32_bf16 v[44:47], v[28:31], a[108:111], v[44:47]
  v_mfma_f32_16x16x32_bf16 v[48:51], v[28:31], a[164:167], v[48:51]
  v_mfma_f32_16x16x32_bf16 v[52:55], v[28:31], a[220:223], v[52:55]
  s_waitcnt lgkmcnt(4)
  v_mfma_f32_16x16x32_bf16 v[56:59], v[32:35], a[52:55], v[56:59]
  ds_read_b128 v[24:27], v128 offset:2048
  v_mfma_f32_16x16x32_bf16 v[60:63], v[32:35], a[108:111], v[60:63]
  v_mfma_f32_16x16x32_bf16 v[64:67], v[32:35], a[164:167], v[64:67]
  v_mfma_f32_16x16x32_bf16 v[68:71], v[32:35], a[220:223], v[68:71]
  s_waitcnt lgkmcnt(4)
  s_mov_b32 s40, s19
  s_mov_b32 s41, s29
  s_add_u32 s19, s19, 1
  s_cmp_lt_u32 s19, s35
  s_cbranch_scc0 wg_f_e0
  v_mfma_f32_16x16x32_bf16 v[96:99], v[8:11], a[0:3], 0
  ds_read_b128 v[28:31], v128 offset:16384
  v_mfma_f32_16x16x32_bf16 v[100:103], v[8:11], a[56:59], 0
  v_mfma_f32_16x16x32_bf16 v[104:107], v[8:11], a[112:115], 0
  v_mfma_f32_16x16x32_bf16 v[108:111], v[8:11], a[168:171], 0
  s_waitcnt lgkmcnt(4)
  s_lshl_b32 s42, s40, 10
  v_mfma_f32_16x16x32_bf16 v[112:115], v[12:15], a[0:3], 0
  ds_read_b128 v[32:35], v128 offset:3072
  v_mfma_f32_16x16x32_bf16 v[116:119], v[12:15], a[56:59], 0
  s_add_u32 s42, s42, s41
  v_cvt_pk_bf16_f32 v72, v40, v41
  v_mfma_f32_16x16x32_bf16 v[120:123], v[12:15], a[112:115], 0
  v_cvt_pk_bf16_f32 v73, v42, v43
  v_cvt_pk_bf16_f32 v74, v56, v57
  v_mfma_f32_16x16x32_bf16 v[124:127], v[12:15], a[168:171], 0
  s_waitcnt lgkmcnt(4)
  v_cvt_pk_bf16_f32 v75, v58, v59
  v_mfma_f32_16x16x32_bf16 v[96:99], v[16:19], a[4:7], v[96:99]
  ds_read_b128 v[8:11], v128 offset:17408
  v_mfma_f32_16x16x32_bf16 v[100:103], v[16:19], a[60:63], v[100:103]
  s_add_u32 s43, s42, 0
  v_mfma_f32_16x16x32_bf16 v[104:107], v[16:19], a[116:119], v[104:107]
  buffer_store_dwordx4 v[72:75], v2, s[8:11], s43 offen sc1
  v_cvt_pk_bf16_f32 v76, v44, v45
  v_mfma_f32_16x16x32_bf16 v[108:111], v[16:19], a[172:175], v[108:111]
  s_waitcnt lgkmcnt(4)
  v_cvt_pk_bf16_f32 v77, v46, v47
  v_mfma_f32_16x16x32_bf16 v[112:115], v[20:23], a[4:7], v[112:115]
  ds_read_b128 v[12:15], v128 offset:4096
  v_mfma_f32_16x16x32_bf16 v[116:119], v[20:23], a[60:63], v[116:119]
  v_cvt_pk_bf16_f32 v78, v60, v61
  v_cvt_pk_bf16_f32 v79, v62, v63
  v_mfma_f32_16x16x32_bf16 v[120:123], v[20:23], a[116:119], v[120:123]
  s_add_u32 s43, s42, 14336
  v_mfma_f32_16x16x32_bf16 v[124:127], v[20:23], a[172:175], v[124:127]
  s_waitcnt lgkmcnt(4)
  buffer_store_dwordx4 v[76:79], v2, s[8:11], s43 offen sc1
  v_mfma_f32_16x16x32_bf16 v[96:99], v[24:27], a[8:11], v[96:99]
  ds_read_b128 v[16:19], v128 offset:18432
  v_mfma_f32_16x16x32_bf16 v[100:103], v[24:27], a[64:67], v[100:103]
  v_cvt_pk_bf16_f32 v80, v48, v49
  v_cvt_pk_bf16_f32 v81, v50, v51
  v_mfma_f32_16x16x32_bf16 v[104:107], v[24:27], a[120:123], v[104:107]
  v_cvt_pk_bf16_f32 v82, v64, v65
  v_cvt_pk_bf16_f32 v83, v66, v67
  v_mfma_f32_16x16x32_bf16 v[108:111], v[24:27], a[176:179], v[108:111]
  s_waitcnt lgkmcnt(4)
  s_add_u32 s43, s42, 458752
  v_mfma_f32_16x16x32_bf16 v[112:115], v[28:31], a[8:11], v[112:115]
  ds_read_b128 v[20:23], v128 offset:5120
  v_mfma_f32_16x16x32_bf16 v[116:119], v[28:31], a[64:67], v[116:119]
  buffer_store_dwordx4 v[80:83], v2, s[8:11], s43 offen sc1
  v_cvt_pk_bf16_f32 v84, v52, v53
  v_mfma_f32_16x16x32_bf16 v[120:123], v[28:31], a[120:123], v[120:123]
  v_cvt_pk_bf16_f32 v85, v54, v55
  v_cvt_pk_bf16_f32 v86, v68, v69
  v_mfma_f32_16x16x32_bf16 v[124:127], v[28:31], a[176:179], v[124:127]
  s_waitcnt lgkmcnt(4)
  v_cvt_pk_bf16_f32 v87, v70, v71
  v_mfma_f32_16x16x32_bf16 v[96:99], v[32:35], a[12:15], v[96:99]
  ds_read_b128 v[24:27], v128 offset:19456
  v_mfma_f32_16x16x32_bf16 v[100:103], v[32:35], a[68:71], v[100:103]
  s_add_u32 s43, s42, 473088
  v_mfma_f32_16x16x32_bf16 v[104:107], v[32:35], a[124:127], v[104:107]
  buffer_store_dwordx4 v[84:87], v2, s[8:11], s43 offen sc1
  v_mfma_f32_16x16x32_bf16 v[108:111], v[32:35], a[180:183], v[108:111]
  s_waitcnt lgkmcnt(4)
  s_add_u32 s30, s19, 2
  s_lshr_b32 s24, s30, 1
  s_lshl_b32 s24, s24, 2
  s_and_b32 s25, s30, 1
  s_add_u32 s24, s24, s25
  s_mul_i32 s24, s24, 14336
  v_mfma_f32_16x16x32_bf16 v[112:115], v[8:11], a[12:15], v[112:115]
  ds_read_b128 v[28:31], v128 offset:6144
  v_mfma_f32_16x16x32_bf16 v[116:119], v[8:11], a[68:71], v[116:119]
  s_add_u32 s24, s24, s23
  s_cmp_lt_u32 s30, s35
  s_cselect_b32 s24, s24, 0x40000000
  v_mfma_f32_16x16x32_bf16 v[120:123], v[8:11], a[124:127], v[120:123]
  s_add_u32 m0, s33, s27
  s_nop 0
  buffer_load_dwordx4 v2, s[8:11], s24 offen offset:0 sc1 lds
  v_mfma_f32_16x16x32_bf16 v[124:127], v[8:11], a[180:183], v[124:127]
  s_waitcnt lgkmcnt(4)
  v_mfma_f32_16x16x32_bf16 v[96:99], v[12:15], a[16:19], v[96:99]
  ds_read_b128 v[32:35], v128 offset:20480
  v_mfma_f32_16x16x32_bf16 v[100:103], v[12:15], a[72:75], v[100:103]
  v_mfma_f32_16x16x32_bf16 v[104:107], v[12:15], a[128:131], v[104:107]
  v_mfma_f32_16x16x32_bf16 v[108:111], v[12:15], a[184:187], v[108:111]
  s_waitcnt lgkmcnt(4)
  buffer_load_dwordx4 v2, s[8:11], s24 offen offset:1024 sc1 lds
  v_mfma_f32_16x16x32_bf16 v[112:115], v[16:19], a[16:19], v[112:115]
  ds_read_b128 v[8:11], v128 offset:7168
  v_mfma_f32_16x16x32_bf16 v[116:119], v[16:19], a[72:75], v[116:119]
  v_mfma_f32_16x16x32_bf16 v[120:123], v[16:19], a[128:131], v[120:123]
  v_mfma_f32_16x16x32_bf16 v[124:127], v[16:19], a[184:187], v[124:127]
  s_waitcnt lgkmcnt(4)
  v_mfma_f32_16x16x32_bf16 v[96:99], v[20:23], a[20:23], v[96:99]
  ds_read_b128 v[12:15], v128 offset:21504
  v_mfma_f32_16x16x32_bf16 v[100:103], v[20:23], a[76:79], v[100:103]
  buffer_load_dwordx4 v2, s[8:11], s24 offen offset:2048 sc1 lds
  v_mfma_f32_16x16x32_bf16 v[104:107], v[20:23], a[132:135], v[104:107]
  v_mfma_f32_16x16x32_bf16 v[108:111], v[20:23], a[188:191], v[108:111]
  s_waitcnt lgkmcnt(4)
  v_mfma_f32_16x16x32_bf16 v[112:115], v[24:27], a[20:23], v[112:115]
  ds_read_b128 v[16:19], v128 offset:8192
  v_mfma_f32_16x16x32_bf16 v[116:119], v[24:27], a[76:79], v[116:119]
  v_mfma_f32_16x16x32_bf16 v[120:123], v[24:27], a[132:135], v[120:123]
  buffer_load_dwordx4 v2, s[8:11], s24 offen offset:3072 sc1 lds
  v_mfma_f32_16x16x32_bf16 v[124:127], v[24:27], a[188:191], v[124:127]
  s_waitcnt lgkmcnt(4)
  v_mfma_f32_16x16x32_bf16 v[96:99], v[28:31], a[24:27], v[96:99]
  ds_read_b128 v[20:23], v128 offset:22528
  v_mfma_f32_16x16x32_bf16 v[100:103], v[28:31], a[80:83], v[100:103]
  v_mfma_f32_16x16x32_bf16 v[104:107], v[28:31], a[136:139], v[104:107]
  v_mfma_f32_16x16x32_bf16 v[108:111], v[28:31], a[192:195], v[108:111]
  s_waitcnt lgkmcnt(4)
  s_add_u32 m0, m0, 4096
  s_add_u32 s24, s24, 4096
  buffer_load_dwordx4 v2, s[8:11], s24 offen offset:0 sc1 lds
  v_mfma_f32_16x16x32_bf16 v[112:115], v[32:35], a[24:27], v[112:115]
  ds_read_b128 v[24:27], v128 offset:9216
  v_mfma_f32_16x16x32_bf16 v[116:119], v[32:35], a[80:83], v[116:119]
  v_mfma_f32_16x16x32_bf16 v[120:123], v[32:35], a[136:139], v[120:123]
  v_mfma_f32_16x16x32_bf16 v[124:127], v[32:35], a[192:195], v[124:127]
  s_waitcnt lgkmcnt(4)
  v_mfma_f32_16x16x32_bf16 v[96:99], v[8:11], a[28:31], v[96:99]
  ds_read_b128 v[28:31], v128 offset:23552
  v_mfma_f32_16x16x32_bf16 v[100:103], v[8:11], a[84:87], v[100:103]
  buffer_load_dwordx4 v2, s[8:11], s24 offen offset:1024 sc1 lds
  v_mfma_f32_16x16x32_bf16 v[104:107], v[8:11], a[140:143], v[104:107]
  v_mfma_f32_16x16x32_bf16 v[108:111], v[8:11], a[196:199], v[108:111]
  s_waitcnt lgkmcnt(4)
  v_mfma_f32_16x16x32_bf16 v[112:115], v[12:15], a[28:31], v[112:115]
  ds_read_b128 v[32:35], v128 offset:10240
  v_mfma_f32_16x16x32_bf16 v[116:119], v[12:15], a[84:87], v[116:119]
  v_mfma_f32_16x16x32_bf16 v[120:123], v[12:15], a[140:143], v[120:123]
  buffer_load_dwordx4 v2, s[8:11], s24 offen offset:2048 sc1 lds
  v_mfma_f32_16x16x32_bf16 v[124:127], v[12:15], a[196:199], v[124:127]
  s_waitcnt lgkmcnt(4)
  v_mfma_f32_16x16x32_bf16 v[96:99], v[16:19], a[32:35], v[96:99]
  ds_read_b128 v[8:11], v128 offset:24576
  v_mfma_f32_16x16x32_bf16 v[100:103], v[16:19], a[88:91], v[100:103]
  v_mfma_f32_16x16x32_bf16 v[104:107], v[16:19], a[144:147], v[104:107]
  v_mfma_f32_16x16x32_bf16 v[108:111], v[16:19], a[200:203], v[108:111]
  s_waitcnt lgkmcnt(4)
  s_add_u32 s33, s33, 28672
  s_cmp_eq_u32 s33, 114688
  s_cselect_b32 s33, 0, s33
  v_mfma_f32_16x16x32_bf16 v[112:115], v[20:23], a[32:35], v[112:115]
  ds_read_b128 v[12:15], v128 offset:11264
  v_mfma_f32_16x16x32_bf16 v[116:119], v[20:23], a[88:91], v[116:119]
  s_add_u32 s32, s32, 28672
  s_cmp_eq_u32 s32, 114688
  s_cselect_b32 s32, 0, s32
  v_mfma_f32_16x16x32_bf16 v[120:123], v[20:23], a[144:147], v[120:123]
  v_add_u32 v5, s32, v2
  v_mfma_f32_16x16x32_bf16 v[124:127], v[20:23], a[200:203], v[124:127]
  s_waitcnt lgkmcnt(4)
  v_mfma_f32_16x16x32_bf16 v[96:99], v[24:27], a[36:39], v[96:99]
  ds_read_b128 v[16:19], v128 offset:25600
  v_mfma_f32_16x16x32_bf16 v[100:103], v[24:27], a[92:95], v[100:103]
  v_mfma_f32_16x16x32_bf16 v[104:107], v[24:27], a[148:151], v[104:107]
  v_mfma_f32_16x16x32_bf16 v[108:111], v[24:27], a[204:207], v[108:111]
  s_waitcnt lgkmcnt(4)
  v_mfma_f32_16x16x32_bf16 v[112:115], v[28:31], a[36:39], v[112:115]
  ds_read_b128 v[20:23], v128 offset:12288
  v_mfma_f32_16x16x32_bf16 v[116:119], v[28:31], a[92:95], v[116:119]
  v_mfma_f32_16x16x32_bf16 v[120:123], v[28:31], a[148:151], v[120:123]
  v_mfma_f32_16x16x32_bf16 v[124:127], v[28:31], a[204:207], v[124:127]
  s_waitcnt lgkmcnt(4)
  v_mfma_f32_16x16x32_bf16 v[96:99], v[32:35], a[40:43], v[96:99]
  ds_read_b128 v[24:27], v128 offset:26624
  v_mfma_f32_16x16x32_bf16 v[100:103], v[32:35], a[96:99], v[100:103]
  v_mfma_f32_16x16x32_bf16 v[104:107], v[32:35], a[152:155], v[104:107]
  v_mfma_f32_16x16x32_bf16 v[108:111], v[32:35], a[208:211], v[108:111]
  s_waitcnt lgkmcnt(4)
  v_mfma_f32_16x16x32_bf16 v[112:115], v[8:11], a[40:43], v[112:115]
  ds_read_b128 v[28:31], v128 offset:13312
  v_mfma_f32_16x16x32_bf16 v[116:119], v[8:11], a[96:99], v[116:119]
  v_mfma_f32_16x16x32_bf16 v[120:123], v[8:11], a[152:155], v[120:123]
  v_mfma_f32_16x16x32_bf16 v[124:127], v[8:11], a[208:211], v[124:127]
  s_waitcnt lgkmcnt(4)
  v_mfma_f32_16x16x32_bf16 v[96:99], v[12:15], a[44:47], v[96:99]
  ds_read_b128 v[32:35], v128 offset:27648
  v_mfma_f32_16x16x32_bf16 v[100:103], v[12:15], a[100:103], v[100:103]
  v_mfma_f32_16x16x32_bf16 v[104:107], v[12:15], a[156:159], v[104:107]
  v_mfma_f32_16x16x32_bf16 v[108:111], v[12:15], a[212:215], v[108:111]
  s_waitcnt lgkmcnt(4)
  v_mfma_f32_16x16x32_bf16 v[112:115], v[16:19], a[44:47], v[112:115]
  s_waitcnt vmcnt(11)
  s_barrier
  ds_read_b128 v[8:11], v5 offset:0
  v_mfma_f32_16x16x32_bf16 v[116:119], v[16:19], a[100:103], v[116:119]
  v_mfma_f32_16x16x32_bf16 v[120:123], v[16:19], a[156:159], v[120:123]
  v_mfma_f32_16x16x32_bf16 v[124:127], v[16:19], a[212:215], v[124:127]
  s_waitcnt lgkmcnt(4)
  v_mfma_f32_16x16x32_bf16 v[96:99], v[20:23], a[48:51], v[96:99]
  ds_read_b128 v[12:15], v5 offset:14336
  v_mfma_f32_16x16x32_bf16 v[100:103], v[20:23], a[104:107], v[100:103]
  v_mfma_f32_16x16x32_bf16 v[104:107], v[20:23], a[160:163], v[104:107]
  v_mfma_f32_16x16x32_bf16 v[108:111], v[20:23], a[216:219], v[108:111]
  s_waitcnt lgkmcnt(4)
  v_mfma_f32_16x16x32_bf16 v[112:115], v[24:27], a[48:51], v[112:115]
  ds_read_b128 v[16:19], v5 offset:1024
  v_mfma_f32_16x16x32_bf16 v[116:119], v[24:27], a[104:107], v[116:119]
  v_mfma_f32_16x16x32_bf16 v[120:123], v[24:27], a[160:163], v[120:123]
  v_mfma_f32_16x16x32_bf16 v[124:127], v[24:27], a[216:219], v[124:127]
  s_waitcnt lgkmcnt(4)
  v_mfma_f32_16x16x32_bf16 v[96:99], v[28:31], a[52:55], v[96:99]
  ds_read_b128 v[20:23], v5 offset:15360
  v_mfma_f32_16x16x32_bf16 v[100:103], v[28:31], a[108:111], v[100:103]
  v_mfma_f32_16x16x32_bf16 v[104:107], v[28:31], a[164:167], v[104:107]
  v_mfma_f32_16x16x32_bf16 v[108:111], v[28:31], a[220:223], v[108:111]
  s_waitcnt lgkmcnt(4)
  v_mfma_f32_16x16x32_bf16 v[112:115], v[32:35], a[52:55], v[112:115]
  ds_read_b128 v[24:27], v5 offset:2048
  v_mfma_f32_16x16x32_bf16 v[116:119], v[32:35], a[108:111], v[116:119]
  v_mfma_f32_16x16x32_bf16 v[120:123], v[32:35], a[164:167], v[120:123]
  v_mfma_f32_16x16x32_bf16 v[124:127], v[32:35], a[220:223], v[124:127]
  s_waitcnt lgkmcnt(4)
  s_mov_b32 s40, s19
  s_mov_b32 s41, s29
  s_add_u32 s19, s19, 1
  s_cmp_lt_u32 s19, s35
  s_cbranch_scc1 wg_f_loop
  s_nop 3
  s_lshl_b32 s42, s40, 10
  s_add_u32 s42, s42, s41
  v_cvt_pk_bf16_f32 v72, v96, v97
  v_cvt_pk_bf16_f32 v73, v98, v99
  v_cvt_pk_bf16_f32 v74, v112, v113
  v_cvt_pk_bf16_f32 v75, v114, v115
  s_add_u32 s43, s42, 0
  buffer_store_dwordx4 v[72:75], v2, s[8:11], s43 offen sc1
  v_cvt_pk_bf16_f32 v76, v100, v101
  v_cvt_pk_bf16_f32 v77, v102, v103
  v_cvt_pk_bf16_f32 v78, v116, v117
  v_cvt_pk_bf16_f32 v79, v118, v119
  s_add_u32 s43, s42, 14336
  buffer_store_dwordx4 v[76:79], v2, s[8:11], s43 offen sc1
  v_cvt_pk_bf16_f32 v80, v104, v105
  v_cvt_pk_bf16_f32 v81, v106, v107
  v_cvt_pk_bf16_f32 v82, v120, v121
  v_cvt_pk_bf16_f32 v83, v122, v123
  s_add_u32 s43, s42, 458752
  buffer_store_dwordx4 v[80:83], v2, s[8:11], s43 offen sc1
  v_cvt_pk_bf16_f32 v84, v108, v109
  v_cvt_pk_bf16_f32 v85, v110, v111
  v_cvt_pk_bf16_f32 v86, v124, v125
  v_cvt_pk_bf16_f32 v87, v126, v127
  s_add_u32 s43, s42, 473088
  buffer_store_dwordx4 v[84:87], v2, s[8:11], s43 offen sc1
  s_branch wg_done
wg_f_e0:
  s_nop 7
  s_lshl_b32 s42, s40, 10
  s_add_u32 s42, s42, s41
  v_cvt_pk_bf16_f32 v72, v40, v41
  v_cvt_pk_bf16_f32 v73, v42, v43
  v_cvt_pk_bf16_f32 v74, v56, v57
  v_cvt_pk_bf16_f32 v75, v58, v59
  s_add_u32 s43, s42, 0
  buffer_store_dwordx4 v[72:75], v2, s[8:11], s43 offen sc1
  v_cvt_pk_bf16_f32 v76, v44, v45
  v_cvt_pk_bf16_f32 v77, v46, v47
  v_cvt_pk_bf16_f32 v78, v60, v61
  v_cvt_pk_bf16_f32 v79, v62, v63
  s_add_u32 s43, s42, 14336
  buffer_store_dwordx4 v[76:79], v2, s[8:11], s43 offen sc1
  v_cvt_pk_bf16_f32 v80, v48, v49
  v_cvt_pk_bf16_f32 v81, v50, v51
  v_cvt_pk_bf16_f32 v82, v64, v65
  v_cvt_pk_bf16_f32 v83, v66, v67
  s_add_u32 s43, s42, 458752
  buffer_store_dwordx4 v[80:83], v2, s[8:11], s43 offen sc1
  v_cvt_pk_bf16_f32 v84, v52, v53
  v_cvt_pk_bf16_f32 v85, v54, v55
  v_cvt_pk_bf16_f32 v86, v68, v69
  v_cvt_pk_bf16_f32 v87, v70, v71
  s_add_u32 s43, s42, 473088
  buffer_store_dwordx4 v[84:87], v2, s[8:11], s43 offen sc1
  s_branch wg_done
wg_vo:
  s_sub_u32 s29, s17, 16
  s_mul_i32 s29, s29, 28672
  s_mul_i32 s24, s28, 458752
  s_add_u32 s29, s29, s24
  s_add_u32 s29, s29, 2490368
  v_lshlrev_b32 v6, 4, v3
  v_mul_u32_u24 v7, 12, v3
  v_add_u32 v7, 48, v7
  s_mov_b32 s31, 0
  s_lshl_b32 s24, s34, 1
  s_mul_i32 s24, s24, 14336
  s_add_u32 s24, s24, s23
  s_add_u32 m0, s31, s27
  s_nop 0
  buffer_load_dwordx4 v2, s[8:11], s24 offen offset:0 sc1 lds
  buffer_load_dwordx4 v2, s[8:11], s24 offen offset:1024 sc1 lds
  buffer_load_dwordx4 v2, s[8:11], s24 offen offset:2048 sc1 lds
  buffer_load_dwordx4 v2, s[8:11], s24 offen offset:3072 sc1 lds
  s_add_u32 m0, m0, 4096
  s_add_u32 s24, s24, 4096
  buffer_load_dwordx4 v2, s[8:11], s24 offen offset:0 sc1 lds
  buffer_load_dwordx4 v2, s[8:11], s24 offen offset:1024 sc1 lds
  buffer_load_dwordx4 v2, s[8:11], s24 offen offset:2048 sc1 lds
  s_sub_u32 s36, s35, 1
  s_add_u32 s30, s34, 1
  s_min_u32 s30, s30, s36
  s_mov_b32 s31, 28672
  s_lshl_b32 s24, s30, 1
  s_mul_i32 s24, s24, 14336
  s_add_u32 s24, s24, s23
  s_add_u32 m0, s31, s27
  s_nop 0
  buffer_load_dwordx4 v2, s[8:11], s24 offen offset:0 sc1 lds
  buffer_load_dwordx4 v2, s[8:11], s24 offen offset:1024 sc1 lds
  buffer_load_dwordx4 v2, s[8:11], s24 offen offset:2048 sc1 lds
  buffer_load_dwordx4 v2, s[8:11], s24 offen offset:3072 sc1 lds
  s_add_u32 m0, m0, 4096
  s_add_u32 s24, s24, 4096
  buffer_load_dwordx4 v2, s[8:11], s24 offen offset:0 sc1 lds
  buffer_load_dwordx4 v2, s[8:11], s24 offen offset:1024 sc1 lds
  buffer_load_dwordx4 v2, s[8:11], s24 offen offset:2048 sc1 lds
  s_mov_b32 s19, s34
  s_mov_b32 s32, 0
  s_mov_b32 s33, 57344
  s_cmp_eq_u32 s18, s101
  s_cbranch_scc1 wg_vo_hx
  s_add_u32 s22, s21, 0
  buffer_load_dwordx4 a[0:3], v2, s[8:11], s22 offen offset:0 sc1
  buffer_load_dwordx4 a[4:7], v2, s[8:11], s22 offen offset:1024 sc1
  buffer_load_dwordx4 a[8:11], v2, s[8:11], s22 offen offset:2048 sc1
  buffer_load_dwordx4 a[12:15], v2, s[8:11], s22 offen offset:3072 sc1
  s_add_u32 s22, s21, 4096
  buffer_load_dwordx4 a[16:19], v2, s[8:11], s22 offen offset:0 sc1
  buffer_load_dwordx4 a[20:23], v2, s[8:11], s22 offen offset:1024 sc1
  buffer_load_dwordx4 a[24:27], v2, s[8:11], s22 offen offset:2048 sc1
  buffer_load_dwordx4 a[28:31], v2, s[8:11], s22 offen offset:3072 sc1
  s_add_u32 s22, s21, 8192
  buffer_load_dwordx4 a[32:35], v2, s[8:11], s22 offen offset:0 sc1
  buffer_load_dwordx4 a[36:39], v2, s[8:11], s22 offen offset:1024 sc1
  buffer_load_dwordx4 a[40:43], v2, s[8:11], s22 offen offset:2048 sc1
  buffer_load_dwordx4 a[44:47], v2, s[8:11], s22 offen offset:3072 sc1
  s_add_u32 s22, s21, 12288
  buffer_load_dwordx4 a[48:51], v2, s[8:11], s22 offen offset:0 sc1
  buffer_load_dwordx4 a[52:55], v2, s[8:11], s22 offen offset:1024 sc1
  buffer_load_dwordx4 a[56:59], v2, s[8:11], s22 offen offset:2048 sc1
  buffer_load_dwordx4 a[60:63], v2, s[8:11], s22 offen offset:3072 sc1
  s_add_u32 s22, s21, 16384
  buffer_load_dwordx4 a[64:67], v2, s[8:11], s22 offen offset:0 sc1
  buffer_load_dwordx4 a[68:71], v2, s[8:11], s22 offen offset:1024 sc1
  buffer_load_dwordx4 a[72:75], v2, s[8:11], s22 offen offset:2048 sc1
  buffer_load_dwordx4 a[76:79], v2, s[8:11], s22 offen offset:3072 sc1
  s_add_u32 s22, s21, 20480
  buffer_load_dwordx4 a[80:83], v2, s[8:11], s22 offen offset:0 sc1
  buffer_load_dwordx4 a[84:87], v2, s[8:11], s22 offen offset:1024 sc1
  buffer_load_dwordx4 a[88:91], v2, s[8:11], s22 offen offset:2048 sc1
  buffer_load_dwordx4 a[92:95], v2, s[8:11], s22 offen offset:3072 sc1
  s_add_u32 s22, s21, 24576
  buffer_load_dwordx4 a[96:99], v2, s[8:11], s22 offen offset:0 sc1
  buffer_load_dwordx4 a[100:103], v2, s[8:11], s22 offen offset:1024 sc1
  buffer_load_dwordx4 a[104:107], v2, s[8:11], s22 offen offset:2048 sc1
  buffer_load_dwordx4 a[108:111], v2, s[8:11], s22 offen offset:3072 sc1
  s_add_u32 s22, s21, 28672
  buffer_load_dwordx4 a[112:115], v2, s[8:11], s22 offen offset:0 sc1
  buffer_load_dwordx4 a[116:119], v2, s[8:11], s22 offen offset:1024 sc1
  buffer_load_dwordx4 a[120:123], v2, s[8:11], s22 offen offset:2048 sc1
  buffer_load_dwordx4 a[124:127], v2, s[8:11], s22 offen offset:3072 sc1
  s_add_u32 s22, s21, 32768
  buffer_load_dwordx4 a[128:131], v2, s[8:11], s22 offen offset:0 sc1
  buffer_load_dwordx4 a[132:135], v2, s[8:11], s22 offen offset:1024 sc1
  buffer_load_dwordx4 a[136:139], v2, s[8:11], s22 offen offset:2048 sc1
  buffer_load_dwordx4 a[140:143], v2, s[8:11], s22 offen offset:3072 sc1
  s_add_u32 s22, s21, 36864
  buffer_load_dwordx4 a[144:147], v2, s[8:11], s22 offen offset:0 sc1
  buffer_load_dwordx4 a[148:151], v2, s[8:11], s22 offen offset:1024 sc1
  buffer_load_dwordx4 a[152:155], v2, s[8:11], s22 offen offset:2048 sc1
  buffer_load_dwordx4 a[156:159], v2, s[8:11], s22 offen offset:3072 sc1
  s_add_u32 s22, s21, 40960
  s_waitcnt vmcnt(40)
  buffer_load_dwordx4 a[160:163], v2, s[8:11], s22 offen offset:0 sc1
  buffer_load_dwordx4 a[164:167], v2, s[8:11], s22 offen offset:1024 sc1
  buffer_load_dwordx4 a[168:171], v2, s[8:11], s22 offen offset:2048 sc1
  buffer_load_dwordx4 a[172:175], v2, s[8:11], s22 offen offset:3072 sc1
  s_add_u32 s22, s21, 45056
  buffer_load_dwordx4 a[176:179], v2, s[8:11], s22 offen offset:0 sc1
  buffer_load_dwordx4 a[180:183], v2, s[8:11], s22 offen offset:1024 sc1
  buffer_load_dwordx4 a[184:187], v2, s[8:11], s22 offen offset:2048 sc1
  buffer_load_dwordx4 a[188:191], v2, s[8:11], s22 offen offset:3072 sc1
  s_add_u32 s22, s21, 49152
  buffer_load_dwordx4 a[192:195], v2, s[8:11], s22 offen offset:0 sc1
  buffer_load_dwordx4 a[196:199], v2, s[8:11], s22 offen offset:1024 sc1
  buffer_load_dwordx4 a[200:203], v2, s[8:11], s22 offen offset:2048 sc1
  buffer_load_dwordx4 a[204:207], v2, s[8:11], s22 offen offset:3072 sc1
  s_add_u32 s22, s21, 53248
  buffer_load_dwordx4 a[208:211], v2, s[8:11], s22 offen offset:0 sc1
  buffer_load_dwordx4 a[212:215], v2, s[8:11], s22 offen offset:1024 sc1
  buffer_load_dwordx4 a[216:219], v2, s[8:11], s22 offen offset:2048 sc1
  buffer_load_dwordx4 a[220:223], v2, s[8:11], s22 offen offset:3072 sc1
wg_vo_hx:
  s_mov_b32 s101, -1
  s_waitcnt vmcnt(0)
  s_barrier
  s_mov_b32 s40, 0
  s_mov_b32 s41, 0x40000000
  v_mov_b32 v5, v2
  ds_read_b128 v[8:11], v5 offset:0
  ds_read_b128 v[12:15], v5 offset:14336
  ds_read_b128 v[16:19], v5 offset:1024
  ds_read_b128 v[20:23], v5 offset:15360
  ds_read_b128 v[24:27], v5 offset:2048
  s_waitcnt lgkmcnt(4)
.p2align 6
wg_vo_loop:
  v_mfma_f32_16x16x32_bf16 v[40:43], a[0:3], v[8:11], 0
  ds_read_b128 v[28:31], v5 offset:16384
  v_mfma_f32_16x16x32_bf16 v[44:47], a[56:59], v[8:11], 0
  v_mfma_f32_16x16x32_bf16 v[48:51], a[112:115], v[8:11], 0
  v_mfma_f32_16x16x32_bf16 v[52:55], a[168:171], v[8:11], 0
  s_waitcnt lgkmcnt(4)
  s_add_u32 s43, s41, 458752
  v_mfma_f32_16x16x32_bf16 v[56:59], a[0:3], v[12:15], 0
  ds_read_b128 v[32:35], v5 offset:3072
  v_mfma_f32_16x16x32_bf16 v[60:63], a[56:59], v[12:15], 0
  s_lshl_b32 s42, s40, 5
  s_add_u32 s42, s42, 0
  v_mfma_f32_16x16x32_bf16 v[64:67], a[112:115], v[12:15], 0
  v_add_u32 v88, s42, v4
  v_mul_u32_u24 v89, 2341, v88
  v_mfma_f32_16x16x32_bf16 v[68:71], a[168:171], v[12:15], 0
  s_waitcnt lgkmcnt(4)
  v_lshrrev_b32 v89, 16, v89
  v_mfma_f32_16x16x32_bf16 v[40:43], a[4:7], v[16:19], v[40:43]
  ds_read_b128 v[8:11], v5 offset:17408
  v_mfma_f32_16x16x32_bf16 v[44:47], a[60:63], v[16:19], v[44:47]
  v_mul_u32_u24 v92, 28, v89
  v_sub_u32 v92, v88, v92
  v_mfma_f32_16x16x32_bf16 v[48:51], a[116:119], v[16:19], v[48:51]
  v_cmp_gt_u32 vcc, 16, v92
  v_mul_u32_u24 v89, 84, v89
  v_mfma_f32_16x16x32_bf16 v[52:55], a[172:175], v[16:19], v[52:55]
  s_waitcnt lgkmcnt(4)
  v_cndmask_b32 v92, v7, v6, vcc
  v_mfma_f32_16x16x32_bf16 v[56:59], a[4:7], v[20:23], v[56:59]
  ds_read_b128 v[12:15], v5 offset:4096
  v_mfma_f32_16x16x32_bf16 v[60:63], a[60:63], v[20:23], v[60:63]
  v_add3_u32 v88, v88, v89, v92
  v_lshlrev_b32 v90, 4, v88
  v_mfma_f32_16x16x32_bf16 v[64:67], a[116:119], v[20:23], v[64:67]
  v_cvt_pk_bf16_f32 v72, v96, v100
  v_cvt_pk_bf16_f32 v73, v97, v101
  v_mfma_f32_16x16x32_bf16 v[68:71], a[172:175], v[20:23], v[68:71]
  s_waitcnt lgkmcnt(4)
  v_cvt_pk_bf16_f32 v74, v98, v102
  v_mfma_f32_16x16x32_bf16 v[40:43], a[8:11], v[24:27], v[40:43]
  ds_read_b128 v[16:19], v5 offset:18432
  v_mfma_f32_16x16x32_bf16 v[44:47], a[64:67], v[24:27], v[44:47]
  v_cvt_pk_bf16_f32 v75, v99, v103
  v_mfma_f32_16x16x32_bf16 v[48:51], a[120:123], v[24:27], v[48:51]
  buffer_store_dwordx4 v[72:75], v90, s[8:11], s41 offen sc1
  v_cvt_pk_bf16_f32 v76, v104, v108
  v_mfma_f32_16x16x32_bf16 v[52:55], a[176:179], v[24:27], v[52:55]
  s_waitcnt lgkmcnt(4)
  v_cvt_pk_bf16_f32 v77, v105, v109
  v_mfma_f32_16x16x32_bf16 v[56:59], a[8:11], v[28:31], v[56:59]
  ds_read_b128 v[20:23], v5 offset:5120
  v_mfma_f32_16x16x32_bf16 v[60:63], a[64:67], v[28:31], v[60:63]
  v_cvt_pk_bf16_f32 v78, v106, v110
  v_cvt_pk_bf16_f32 v79, v107, v111
  v_mfma_f32_16x16x32_bf16 v[64:67], a[120:123], v[28:31], v[64:67]
  buffer_store_dwordx4 v[76:79], v90, s[8:11], s43 offen sc1
  s_lshl_b32 s42, s40, 5
  v_mfma_f32_16x16x32_bf16 v[68:71], a[176:179], v[28:31], v[68:71]
  s_waitcnt lgkmcnt(4)
  s_add_u32 s42, s42, 16
  v_mfma_f32_16x16x32_bf16 v[40:43], a[12:15], v[32:35], v[40:43]
  ds_read_b128 v[24:27], v5 offset:19456
  v_mfma_f32_16x16x32_bf16 v[44:47], a[68:71], v[32:35], v[44:47]
  v_add_u32 v88, s42, v4
  v_mul_u32_u24 v89, 2341, v88
  v_mfma_f32_16x16x32_bf16 v[48:51], a[124:127], v[32:35], v[48:51]
  v_lshrrev_b32 v89, 16, v89
  v_mul_u32_u24 v92, 28, v89
  v_mfma_f32_16x16x32_bf16 v[52:55], a[180:183], v[32:35], v[52:55]
  s_waitcnt lgkmcnt(4)
  v_sub_u32 v92, v88, v92
  v_mfma_f32_16x16x32_bf16 v[56:59], a[12:15], v[8:11], v[56:59]
  ds_read_b128 v[28:31], v5 offset:6144
  v_mfma_f32_16x16x32_bf16 v[60:63], a[68:71], v[8:11], v[60:63]
  v_cmp_gt_u32 vcc, 16, v92
  v_mul_u32_u24 v89, 84, v89
  v_mfma_f32_16x16x32_bf16 v[64:67], a[124:127], v[8:11], v[64:67]
  v_cndmask_b32 v92, v7, v6, vcc
  v_add3_u32 v88, v88, v89, v92
  v_mfma_f32_16x16x32_bf16 v[68:71], a[180:183], v[8:11], v[68:71]
  s_waitcnt lgkmcnt(4)
  v_lshlrev_b32 v91, 4, v88
  v_mfma_f32_16x16x32_bf16 v[40:43], a[16:19], v[12:15], v[40:43]
  ds_read_b128 v[32:35], v5 offset:20480
  v_mfma_f32_16x16x32_bf16 v[44:47], a[72:75], v[12:15], v[44:47]
  v_cvt_pk_bf16_f32 v80, v112, v116
  v_cvt_pk_bf16_f32 v81, v113, v117
  v_mfma_f32_16x16x32_bf16 v[48:51], a[128:131], v[12:15], v[48:51]
  v_cvt_pk_bf16_f32 v82, v114, v118
  v_cvt_pk_bf16_f32 v83, v115, v119
  v_mfma_f32_16x16x32_bf16 v[52:55], a[184:187], v[12:15], v[52:55]
  s_waitcnt lgkmcnt(4)
  buffer_store_dwordx4 v[80:83], v91, s[8:11], s41 offen sc1
  v_mfma_f32_16x16x32_bf16 v[56:59], a[16:19], v[16:19], v[56:59]
  ds_read_b128 v[8:11], v5 offset:7168
  v_mfma_f32_16x16x32_bf16 v[60:63], a[72:75], v[16:19], v[60:63]
  v_cvt_pk_bf16_f32 v84, v120, v124
  v_cvt_pk_bf16_f32 v85, v121, v125
  v_mfma_f32_16x16x32_bf16 v[64:67], a[128:131], v[16:19], v[64:67]
  v_cvt_pk_bf16_f32 v86, v122, v126
  v_cvt_pk_bf16_f32 v87, v123, v127
  v_mfma_f32_16x16x32_bf16 v[68:71], a[184:187], v[16:19], v[68:71]
  s_waitcnt lgkmcnt(4)
  buffer_store_dwordx4 v[84:87], v91, s[8:11], s43 offen sc1
  v_mfma_f32_16x16x32_bf16 v[40:43], a[20:23], v[20:23], v[40:43]
  ds_read_b128 v[12:15], v5 offset:21504
  v_mfma_f32_16x16x32_bf16 v[44:47], a[76:79], v[20:23], v[44:47]
  s_add_u32 s30, s19, 2
  s_lshl_b32 s24, s30, 1
  s_mul_i32 s24, s24, 14336
  v_mfma_f32_16x16x32_bf16 v[48:51], a[132:135], v[20:23], v[48:51]
  s_add_u32 s24, s24, s23
  s_cmp_lt_u32 s30, s35
  s_cselect_b32 s24, s24, 0x40000000
  v_mfma_f32_16x16x32_bf16 v[52:55], a[188:191], v[20:23], v[52:55]
  s_waitcnt lgkmcnt(4)
  s_add_u32 m0, s33, s27
  s_nop 0
  buffer_load_dwordx4 v2, s[8:11], s24 offen offset:0 sc1 lds
  v_mfma_f32_16x16x32_bf16 v[56:59], a[20:23], v[24:27], v[56:59]
  ds_read_b128 v[16:19], v5 offset:8192
  v_mfma_f32_16x16x32_bf16 v[60:63], a[76:79], v[24:27], v[60:63]
  v_mfma_f32_16x16x32_bf16 v[64:67], a[132:135], v[24:27], v[64:67]
  v_mfma_f32_16x16x32_bf16 v[68:71], a[188:191], v[24:27], v[68:71]
  s_waitcnt lgkmcnt(4)
  v_mfma_f32_16x16x32_bf16 v[40:43], a[24:27], v[28:31], v[40:43]
  ds_read_b128 v[20:23], v5 offset:22528
  v_mfma_f32_16x16x32_bf16 v[44:47], a[80:83], v[28:31], v[44:47]
  buffer_load_dwordx4 v2, s[8:11], s24 offen offset:1024 sc1 lds
  v_mfma_f32_16x16x32_bf16 v[48:51], a[136:139], v[28:31], v[48:51]
  v_mfma_f32_16x16x32_bf16 v[52:55], a[192:195], v[28:31], v[52:55]
  s_waitcnt lgkmcnt(4)
  v_mfma_f32_16x16x32_bf16 v[56:59], a[24:27], v[32:35], v[56:59]
  ds_read_b128 v[24:27], v5 offset:9216
  v_mfma_f32_16x16x32_bf16 v[60:63], a[80:83], v[32:35], v[60:63]
  v_mfma_f32_16x16x32_bf16 v[64:67], a[136:139], v[32:35], v[64:67]
  buffer_load_dwordx4 v2, s[8:11], s24 offen offset:2048 sc1 lds
  v_mfma_f32_16x16x32_bf16 v[68:71], a[192:195], v[32:35], v[68:71]
  s_waitcnt lgkmcnt(4)
  v_mfma_f32_16x16x32_bf16 v[40:43], a[28:31], v[8:11], v[40:43]
  ds_read_b128 v[28:31], v5 offset:23552
  v_mfma_f32_16x16x32_bf16 v[44:47], a[84:87], v[8:11], v[44:47]
  v_mfma_f32_16x16x32_bf16 v[48:51], a[140:143], v[8:11], v[48:51]
  v_mfma_f32_16x16x32_bf16 v[52:55], a[196:199], v[8:11], v[52:55]
  s_waitcnt lgkmcnt(4)
  buffer_load_dwordx4 v2, s[8:11], s24 offen offset:3072 sc1 lds
  v_mfma_f32_16x16x32_bf16 v[56:59], a[28:31], v[12:15], v[56:59]
  ds_read_b128 v[32:35], v5 offset:10240
  v_mfma_f32_16x16x32_bf16 v[60:63], a[84:87], v[12:15], v[60:63]
  v_mfma_f32_16x16x32_bf16 v[64:67], a[140:143], v[12:15], v[64:67]
  v_mfma_f32_16x16x32_bf16 v[68:71], a[196:199], v[12:15], v[68:71]
  s_waitcnt lgkmcnt(4)
  v_mfma_f32_16x16x32_bf16 v[40:43], a[32:35], v[16:19], v[40:43]
  ds_read_b128 v[8:11], v5 offset:24576
  v_mfma_f32_16x16x32_bf16 v[44:47], a[88:91], v[16:19], v[44:47]
  s_add_u32 m0, m0, 4096
  s_add_u32 s24, s24, 4096
  buffer_load_dwordx4 v2, s[8:11], s24 offen offset:0 sc1 lds
  v_mfma_f32_16x16x32_bf16 v[48:51], a[144:147], v[16:19], v[48:51]
  v_mfma_f32_16x16x32_bf16 v[52:55], a[200:203], v[16:19], v[52:55]
  s_waitcnt lgkmcnt(4)
  v_mfma_f32_16x16x32_bf16 v[56:59], a[32:35], v[20:23], v[56:59]
  ds_read_b128 v[12:15], v5 offset:11264
  v_mfma_f32_16x16x32_bf16 v[60:63], a[88:91], v[20:23], v[60:63]
  v_mfma_f32_16x16x32_bf16 v[64:67], a[144:147], v[20:23], v[64:67]
  buffer_load_dwordx4 v2, s[8:11], s24 offen offset:1024 sc1 lds
  v_mfma_f32_16x16x32_bf16 v[68:71], a[200:203], v[20:23], v[68:71]
  s_waitcnt lgkmcnt(4)
  v_mfma_f32_16x16x32_bf16 v[40:43], a[36:39], v[24:27], v[40:43]
  ds_read_b128 v[16:19], v5 offset:25600
  v_mfma_f32_16x16x32_bf16 v[44:47], a[92:95], v[24:27], v[44:47]
  v_mfma_f32_16x16x32_bf16 v[48:51], a[148:151], v[24:27], v[48:51]
  v_mfma_f32_16x16x32_bf16 v[52:55], a[204:207], v[24:27], v[52:55]
  s_waitcnt lgkmcnt(4)
  buffer_load_dwordx4 v2, s[8:11], s24 offen offset:2048 sc1 lds
  v_mfma_f32_16x16x32_bf16 v[56:59], a[36:39], v[28:31], v[56:59]
  ds_read_b128 v[20:23], v5 offset:12288
  v_mfma_f32_16x16x32_bf16 v[60:63], a[92:95], v[28:31], v[60:63]
  v_mfma_f32_16x16x32_bf16 v[64:67], a[148:151], v[28:31], v[64:67]
  v_mfma_f32_16x16x32_bf16 v[68:71], a[204:207], v[28:31], v[68:71]
  s_waitcnt lgkmcnt(4)
  v_mfma_f32_16x16x32_bf16 v[40:43], a[40:43], v[32:35], v[40:43]
  ds_read_b128 v[24:27], v5 offset:26624
  v_mfma_f32_16x16x32_bf16 v[44:47], a[96:99], v[32:35], v[44:47]
  s_add_u32 s33, s33, 28672
  s_cmp_eq_u32 s33, 114688
  s_cselect_b32 s33, 0, s33
  v_mfma_f32_16x16x32_bf16 v[48:51], a[152:155], v[32:35], v[48:51]
  s_add_u32 s32, s32, 28672
  s_cmp_eq_u32 s32, 114688
  s_cselect_b32 s32, 0, s32
  v_mfma_f32_16x16x32_bf16 v[52:55], a[208:211], v[32:35], v[52:55]
  s_waitcnt lgkmcnt(4)
  v_add_u32 v128, s32, v2
  v_mfma_f32_16x16x32_bf16 v[56:59], a[40:43], v[8:11], v[56:59]
  ds_read_b128 v[28:31], v5 offset:13312
  v_mfma_f32_16x16x32_bf16 v[60:63], a[96:99], v[8:11], v[60:63]
  v_mfma_f32_16x16x32_bf16 v[64:67], a[152:155], v[8:11], v[64:67]
  v_mfma_f32_16x16x32_bf16 v[68:71], a[208:211], v[8:11], v[68:71]
  s_waitcnt lgkmcnt(4)
  v_mfma_f32_16x16x32_bf16 v[40:43], a[44:47], v[12:15], v[40:43]
  ds_read_b128 v[32:35], v5 offset:27648
  v_mfma_f32_16x16x32_bf16 v[44:47], a[100:103], v[12:15], v[44:47]
  v_mfma_f32_16x16x32_bf16 v[48:51], a[156:159], v[12:15], v[48:51]
  v_mfma_f32_16x16x32_bf16 v[52:55], a[212:215], v[12:15], v[52:55]
  s_waitcnt lgkmcnt(4)
  v_mfma_f32_16x16x32_bf16 v[56:59], a[44:47], v[16:19], v[56:59]
  s_waitcnt vmcnt(11)
  s_barrier
  ds_read_b128 v[8:11], v128 offset:0
  v_mfma_f32_16x16x32_bf16 v[60:63], a[100:103], v[16:19], v[60:63]
  v_mfma_f32_16x16x32_bf16 v[64:67], a[156:159], v[16:19], v[64:67]
  v_mfma_f32_16x16x32_bf16 v[68:71], a[212:215], v[16:19], v[68:71]
  s_waitcnt lgkmcnt(4)
  v_mfma_f32_16x16x32_bf16 v[40:43], a[48:51], v[20:23], v[40:43]
  ds_read_b128 v[12:15], v128 offset:14336
  v_mfma_f32_16x16x32_bf16 v[44:47], a[104:107], v[20:23], v[44:47]
  v_mfma_f32_16x16x32_bf16 v[48:51], a[160:163], v[20:23], v[48:51]
  v_mfma_f32_16x16x32_bf16 v[52:55], a[216:219], v[20:23], v[52:55]
  s_waitcnt lgkmcnt(4)
  v_mfma_f32_16x16x32_bf16 v[56:59], a[48:51], v[24:27], v[56:59]
  ds_read_b128 v[16:19], v128 offset:1024
  v_mfma_f32_16x16x32_bf16 v[60:63], a[104:107], v[24:27], v[60:63]
  v_mfma_f32_16x16x32_bf16 v[64:67], a[160:163], v[24:27], v[64:67]
  v_mfma_f32_16x16x32_bf16 v[68:71], a[216:219], v[24:27], v[68:71]
  s_waitcnt lgkmcnt(4)
  v_mfma_f32_16x16x32_bf16 v[40:43], a[52:55], v[28:31], v[40:43]
  ds_read_b128 v[20:23], v128 offset:15360
  v_mfma_f32_16x16x32_bf16 v[44:47], a[108:111], v[28:31], v[44:47]
  v_mfma_f32_16x16x32_bf16 v[48:51], a[164:167], v[28:31], v[48:51]
  v_mfma_f32_16x16x32_bf16 v[52:55], a[220:223], v[28:31], v[52:55]
  s_waitcnt lgkmcnt(4)
  v_mfma_f32_16x16x32_bf16 v[56:59], a[52:55], v[32:35], v[56:59]
  ds_read_b128 v[24:27], v128 offset:2048
  v_mfma_f32_16x16x32_bf16 v[60:63], a[108:111], v[32:35], v[60:63]
  v_mfma_f32_16x16x32_bf16 v[64:67], a[164:167], v[32:35], v[64:67]
  v_mfma_f32_16x16x32_bf16 v[68:71], a[220:223], v[32:35], v[68:71]
  s_waitcnt lgkmcnt(4)
  s_mov_b32 s40, s19
  s_mov_b32 s41, s29
  s_add_u32 s19, s19, 1
  s_cmp_lt_u32 s19, s35
  s_cbranch_scc0 wg_vo_e0
  v_mfma_f32_16x16x32_bf16 v[96:99], a[0:3], v[8:11], 0
  ds_read_b128 v[28:31], v128 offset:16384
  v_mfma_f32_16x16x32_bf16 v[100:103], a[56:59], v[8:11], 0
  v_mfma_f32_16x16x32_bf16 v[104:107], a[112:115], v[8:11], 0
  v_mfma_f32_16x16x32_bf16 v[108:111], a[168:171], v[8:11], 0
  s_waitcnt lgkmcnt(4)
  s_add_u32 s43, s41, 458752
  v_mfma_f32_16x16x32_bf16 v[112:115], a[0:3], v[12:15], 0
  ds_read_b128 v[32:35], v128 offset:3072
  v_mfma_f32_16x16x32_bf16 v[116:119], a[56:59], v[12:15], 0
  s_lshl_b32 s42, s40, 5
  s_add_u32 s42, s42, 0
  v_mfma_f32_16x16x32_bf16 v[120:123], a[112:115], v[12:15], 0
  v_add_u32 v88, s42, v4
  v_mul_u32_u24 v89, 2341, v88
  v_mfma_f32_16x16x32_bf16 v[124:127], a[168:171], v[12:15], 0
  s_waitcnt lgkmcnt(4)
  v_lshrrev_b32 v89, 16, v89
  v_mfma_f32_16x16x32_bf16 v[96:99], a[4:7], v[16:19], v[96:99]
  ds_read_b128 v[8:11], v128 offset:17408
  v_mfma_f32_16x16x32_bf16 v[100:103], a[60:63], v[16:19], v[100:103]
  v_mul_u32_u24 v92, 28, v89
  v_sub_u32 v92, v88, v92
  v_mfma_f32_16x16x32_bf16 v[104:107], a[116:119], v[16:19], v[104:107]
  v_cmp_gt_u32 vcc, 16, v92
  v_mul_u32_u24 v89, 84, v89
  v_mfma_f32_16x16x32_bf16 v[108:111], a[172:175], v[16:19], v[108:111]
  s_waitcnt lgkmcnt(4)
  v_cndmask_b32 v92, v7, v6, vcc
  v_mfma_f32_16x16x32_bf16 v[112:115], a[4:7], v[20:23], v[112:115]
  ds_read_b128 v[12:15], v128 offset:4096
  v_mfma_f32_16x16x32_bf16 v[116:119], a[60:63], v[20:23], v[116:119]
  v_add3_u32 v88, v88, v89, v92
  v_lshlrev_b32 v90, 4, v88
  v_mfma_f32_16x16x32_bf16 v[120:123], a[116:119], v[20:23], v[120:123]
  v_cvt_pk_bf16_f32 v72, v40, v44
  v_cvt_pk_bf16_f32 v73, v41, v45
  v_mfma_f32_16x16x32_bf16 v[124:127], a[172:175], v[20:23], v[124:127]
  s_waitcnt lgkmcnt(4)
  v_cvt_pk_bf16_f32 v74, v42, v46
  v_mfma_f32_16x16x32_bf16 v[96:99], a[8:11], v[24:27], v[96:99]
  ds_read_b128 v[16:19], v128 offset:18432
  v_mfma_f32_16x16x32_bf16 v[100:103], a[64:67], v[24:27], v[100:103]
  v_cvt_pk_bf16_f32 v75, v43, v47
  v_mfma_f32_16x16x32_bf16 v[104:107], a[120:123], v[24:27], v[104:107]
  buffer_store_dwordx4 v[72:75], v90, s[8:11], s41 offen sc1
  v_cvt_pk_bf16_f32 v76, v48, v52
  v_mfma_f32_16x16x32_bf16 v[108:111], a[176:179], v[24:27], v[108:111]
  s_waitcnt lgkmcnt(4)
  v_cvt_pk_bf16_f32 v77, v49, v53
  v_mfma_f32_16x16x32_bf16 v[112:115], a[8:11], v[28:31], v[112:115]
  ds_read_b128 v[20:23], v128 offset:5120
  v_mfma_f32_16x16x32_bf16 v[116:119], a[64:67], v[28:31], v[116:119]
  v_cvt_pk_bf16_f32 v78, v50, v54
  v_cvt_pk_bf16_f32 v79, v51, v55
  v_mfma_f32_16x16x32_bf16 v[120:123], a[120:123], v[28:31], v[120:123]
  buffer_store_dwordx4 v[76:79], v90, s[8:11], s43 offen sc1
  s_lshl_b32 s42, s40, 5
  v_mfma_f32_16x16x32_bf16 v[124:127], a[176:179], v[28:31], v[124:127]
  s_waitcnt lgkmcnt(4)
  s_add_u32 s42, s42, 16
  v_mfma_f32_16x16x32_bf16 v[96:99], a[12:15], v[32:35], v[96:99]
  ds_read_b128 v[24:27], v128 offset:19456
  v_mfma_f32_16x16x32_bf16 v[100:103], a[68:71], v[32:35], v[100:103]
  v_add_u32 v88, s42, v4
  v_mul_u32_u24 v89, 2341, v88
  v_mfma_f32_16x16x32_bf16 v[104:107], a[124:127], v[32:35], v[104:107]
  v_lshrrev_b32 v89, 16, v89
  v_mul_u32_u24 v92, 28, v89
  v_mfma_f32_16x16x32_bf16 v[108:111], a[180:183], v[32:35], v[108:111]
  s_waitcnt lgkmcnt(4)
  v_sub_u32 v92, v88, v92
  v_mfma_f32_16x16x32_bf16 v[112:115], a[12:15], v[8:11], v[112:115]
  ds_read_b128 v[28:31], v128 offset:6144
  v_mfma_f32_16x16x32_bf16 v[116:119], a[68:71], v[8:11], v[116:119]
  v_cmp_gt_u32 vcc, 16, v92
  v_mul_u32_u24 v89, 84, v89
  v_mfma_f32_16x16x32_bf16 v[120:123], a[124:127], v[8:11], v[120:123]
  v_cndmask_b32 v92, v7, v6, vcc
  v_add3_u32 v88, v88, v89, v92
  v_mfma_f32_16x16x32_bf16 v[124:127], a[180:183], v[8:11], v[124:127]
  s_waitcnt lgkmcnt(4)
  v_lshlrev_b32 v91, 4, v88
  v_mfma_f32_16x16x32_bf16 v[96:99], a[16:19], v[12:15], v[96:99]
  ds_read_b128 v[32:35], v128 offset:20480
  v_mfma_f32_16x16x32_bf16 v[100:103], a[72:75], v[12:15], v[100:103]
  v_cvt_pk_bf16_f32 v80, v56, v60
  v_cvt_pk_bf16_f32 v81, v57, v61
  v_mfma_f32_16x16x32_bf16 v[104:107], a[128:131], v[12:15], v[104:107]
  v_cvt_pk_bf16_f32 v82, v58, v62
  v_cvt_pk_bf16_f32 v83, v59, v63
  v_mfma_f32_16x16x32_bf16 v[108:111], a[184:187], v[12:15], v[108:111]
  s_waitcnt lgkmcnt(4)
  buffer_store_dwordx4 v[80:83], v91, s[8:11], s41 offen sc1
  v_mfma_f32_16x16x32_bf16 v[112:115], a[16:19], v[16:19], v[112:115]
  ds_read_b128 v[8:11], v128 offset:7168
  v_mfma_f32_16x16x32_bf16 v[116:119], a[72:75], v[16:19], v[116:119]
  v_cvt_pk_bf16_f32 v84, v64, v68
  v_cvt_pk_bf16_f32 v85, v65, v69
  v_mfma_f32_16x16x32_bf16 v[120:123], a[128:131], v[16:19], v[120:123]
  v_cvt_pk_bf16_f32 v86, v66, v70
  v_cvt_pk_bf16_f32 v87, v67, v71
  v_mfma_f32_16x16x32_bf16 v[124:127], a[184:187], v[16:19], v[124:127]
  s_waitcnt lgkmcnt(4)
  buffer_store_dwordx4 v[84:87], v91, s[8:11], s43 offen sc1
  v_mfma_f32_16x16x32_bf16 v[96:99], a[20:23], v[20:23], v[96:99]
  ds_read_b128 v[12:15], v128 offset:21504
  v_mfma_f32_16x16x32_bf16 v[100:103], a[76:79], v[20:23], v[100:103]
  s_add_u32 s30, s19, 2
  s_lshl_b32 s24, s30, 1
  s_mul_i32 s24, s24, 14336
  v_mfma_f32_16x16x32_bf16 v[104:107], a[132:135], v[20:23], v[104:107]
  s_add_u32 s24, s24, s23
  s_cmp_lt_u32 s30, s35
  s_cselect_b32 s24, s24, 0x40000000
  v_mfma_f32_16x16x32_bf16 v[108:111], a[188:191], v[20:23], v[108:111]
  s_waitcnt lgkmcnt(4)
  s_add_u32 m0, s33, s27
  s_nop 0
  buffer_load_dwordx4 v2, s[8:11], s24 offen offset:0 sc1 lds
  v_mfma_f32_16x16x32_bf16 v[112:115], a[20:23], v[24:27], v[112:115]
  ds_read_b128 v[16:19], v128 offset:8192
  v_mfma_f32_16x16x32_bf16 v[116:119], a[76:79], v[24:27], v[116:119]
  v_mfma_f32_16x16x32_bf16 v[120:123], a[132:135], v[24:27], v[120:123]
  v_mfma_f32_16x16x32_bf16 v[124:127], a[188:191], v[24:27], v[124:127]
  s_waitcnt lgkmcnt(4)
  v_mfma_f32_16x16x32_bf16 v[96:99], a[24:27], v[28:31], v[96:99]
  ds_read_b128 v[20:23], v128 offset:22528
  v_mfma_f32_16x16x32_bf16 v[100:103], a[80:83], v[28:31], v[100:103]
  buffer_load_dwordx4 v2, s[8:11], s24 offen offset:1024 sc1 lds
  v_mfma_f32_16x16x32_bf16 v[104:107], a[136:139], v[28:31], v[104:107]
  v_mfma_f32_16x16x32_bf16 v[108:111], a[192:195], v[28:31], v[108:111]
  s_waitcnt lgkmcnt(4)
  v_mfma_f32_16x16x32_bf16 v[112:115], a[24:27], v[32:35], v[112:115]
  ds_read_b128 v[24:27], v128 offset:9216
  v_mfma_f32_16x16x32_bf16 v[116:119], a[80:83], v[32:35], v[116:119]
  v_mfma_f32_16x16x32_bf16 v[120:123], a[136:139], v[32:35], v[120:123]
  buffer_load_dwordx4 v2, s[8:11], s24 offen offset:2048 sc1 lds
  v_mfma_f32_16x16x32_bf16 v[124:127], a[192:195], v[32:35], v[124:127]
  s_waitcnt lgkmcnt(4)
  v_mfma_f32_16x16x32_bf16 v[96:99], a[28:31], v[8:11], v[96:99]
  ds_read_b128 v[28:31], v128 offset:23552
  v_mfma_f32_16x16x32_bf16 v[100:103], a[84:87], v[8:11], v[100:103]
  v_mfma_f32_16x16x32_bf16 v[104:107], a[140:143], v[8:11], v[104:107]
  v_mfma_f32_16x16x32_bf16 v[108:111], a[196:199], v[8:11], v[108:111]
  s_waitcnt lgkmcnt(4)
  buffer_load_dwordx4 v2, s[8:11], s24 offen offset:3072 sc1 lds
  v_mfma_f32_16x16x32_bf16 v[112:115], a[28:31], v[12:15], v[112:115]
  ds_read_b128 v[32:35], v128 offset:10240
  v_mfma_f32_16x16x32_bf16 v[116:119], a[84:87], v[12:15], v[116:119]
  v_mfma_f32_16x16x32_bf16 v[120:123], a[140:143], v[12:15], v[120:123]
  v_mfma_f32_16x16x32_bf16 v[124:127], a[196:199], v[12:15], v[124:127]
  s_waitcnt lgkmcnt(4)
  v_mfma_f32_16x16x32_bf16 v[96:99], a[32:35], v[16:19], v[96:99]
  ds_read_b128 v[8:11], v128 offset:24576
  v_mfma_f32_16x16x32_bf16 v[100:103], a[88:91], v[16:19], v[100:103]
  s_add_u32 m0, m0, 4096
  s_add_u32 s24, s24, 4096
  buffer_load_dwordx4 v2, s[8:11], s24 offen offset:0 sc1 lds
  v_mfma_f32_16x16x32_bf16 v[104:107], a[144:147], v[16:19], v[104:107]
  v_mfma_f32_16x16x32_bf16 v[108:111], a[200:203], v[16:19], v[108:111]
  s_waitcnt lgkmcnt(4)
  v_mfma_f32_16x16x32_bf16 v[112:115], a[32:35], v[20:23], v[112:115]
  ds_read_b128 v[12:15], v128 offset:11264
  v_mfma_f32_16x16x32_bf16 v[116:119], a[88:91], v[20:23], v[116:119]
  v_mfma_f32_16x16x32_bf16 v[120:123], a[144:147], v[20:23], v[120:123]
  buffer_load_dwordx4 v2, s[8:11], s24 offen offset:1024 sc1 lds
  v_mfma_f32_16x16x32_bf16 v[124:127], a[200:203], v[20:23], v[124:127]
  s_waitcnt lgkmcnt(4)
  v_mfma_f32_16x16x32_bf16 v[96:99], a[36:39], v[24:27], v[96:99]
  ds_read_b128 v[16:19], v128 offset:25600
  v_mfma_f32_16x16x32_bf16 v[100:103], a[92:95], v[24:27], v[100:103]
  v_mfma_f32_16x16x32_bf16 v[104:107], a[148:151], v[24:27], v[104:107]
  v_mfma_f32_16x16x32_bf16 v[108:111], a[204:207], v[24:27], v[108:111]
  s_waitcnt lgkmcnt(4)
  buffer_load_dwordx4 v2, s[8:11], s24 offen offset:2048 sc1 lds
  v_mfma_f32_16x16x32_bf16 v[112:115], a[36:39], v[28:31], v[112:115]
  ds_read_b128 v[20:23], v128 offset:12288
  v_mfma_f32_16x16x32_bf16 v[116:119], a[92:95], v[28:31], v[116:119]
  v_mfma_f32_16x16x32_bf16 v[120:123], a[148:151], v[28:31], v[120:123]
  v_mfma_f32_16x16x32_bf16 v[124:127], a[204:207], v[28:31], v[124:127]
  s_waitcnt lgkmcnt(4)
  v_mfma_f32_16x16x32_bf16 v[96:99], a[40:43], v[32:35], v[96:99]
  ds_read_b128 v[24:27], v128 offset:26624
  v_mfma_f32_16x16x32_bf16 v[100:103], a[96:99], v[32:35], v[100:103]
  s_add_u32 s33, s33, 28672
  s_cmp_eq_u32 s33, 114688
  s_cselect_b32 s33, 0, s33
  v_mfma_f32_16x16x32_bf16 v[104:107], a[152:155], v[32:35], v[104:107]
  s_add_u32 s32, s32, 28672
  s_cmp_eq_u32 s32, 114688
  s_cselect_b32 s32, 0, s32
  v_mfma_f32_16x16x32_bf16 v[108:111], a[208:211], v[32:35], v[108:111]
  s_waitcnt lgkmcnt(4)
  v_add_u32 v5, s32, v2
  v_mfma_f32_16x16x32_bf16 v[112:115], a[40:43], v[8:11], v[112:115]
  ds_read_b128 v[28:31], v128 offset:13312
  v_mfma_f32_16x16x32_bf16 v[116:119], a[96:99], v[8:11], v[116:119]
  v_mfma_f32_16x16x32_bf16 v[120:123], a[152:155], v[8:11], v[120:123]
  v_mfma_f32_16x16x32_bf16 v[124:127], a[208:211], v[8:11], v[124:127]
  s_waitcnt lgkmcnt(4)
  v_mfma_f32_16x16x32_bf16 v[96:99], a[44:47], v[12:15], v[96:99]
  ds_read_b128 v[32:35], v128 offset:27648
  v_mfma_f32_16x16x32_bf16 v[100:103], a[100:103], v[12:15], v[100:103]
  v_mfma_f32_16x16x32_bf16 v[104:107], a[156:159], v[12:15], v[104:107]
  v_mfma_f32_16x16x32_bf16 v[108:111], a[212:215], v[12:15], v[108:111]
  s_waitcnt lgkmcnt(4)
  v_mfma_f32_16x16x32_bf16 v[112:115], a[44:47], v[16:19], v[112:115]
  s_waitcnt vmcnt(11)
  s_barrier
  ds_read_b128 v[8:11], v5 offset:0
  v_mfma_f32_16x16x32_bf16 v[116:119], a[100:103], v[16:19], v[116:119]
  v_mfma_f32_16x16x32_bf16 v[120:123], a[156:159], v[16:19], v[120:123]
  v_mfma_f32_16x16x32_bf16 v[124:127], a[212:215], v[16:19], v[124:127]
  s_waitcnt lgkmcnt(4)
  v_mfma_f32_16x16x32_bf16 v[96:99], a[48:51], v[20:23], v[96:99]
  ds_read_b128 v[12:15], v5 offset:14336
  v_mfma_f32_16x16x32_bf16 v[100:103], a[104:107], v[20:23], v[100:103]
  v_mfma_f32_16x16x32_bf16 v[104:107], a[160:163], v[20:23], v[104:107]
  v_mfma_f32_16x16x32_bf16 v[108:111], a[216:219], v[20:23], v[108:111]
  s_waitcnt lgkmcnt(4)
  v_mfma_f32_16x16x32_bf16 v[112:115], a[48:51], v[24:27], v[112:115]
  ds_read_b128 v[16:19], v5 offset:1024
  v_mfma_f32_16x16x32_bf16 v[116:119], a[104:107], v[24:27], v[116:119]
  v_mfma_f32_16x16x32_bf16 v[120:123], a[160:163], v[24:27], v[120:123]
  v_mfma_f32_16x16x32_bf16 v[124:127], a[216:219], v[24:27], v[124:127]
  s_waitcnt lgkmcnt(4)
  v_mfma_f32_16x16x32_bf16 v[96:99], a[52:55], v[28:31], v[96:99]
  ds_read_b128 v[20:23], v5 offset:15360
  v_mfma_f32_16x16x32_bf16 v[100:103], a[108:111], v[28:31], v[100:103]
  v_mfma_f32_16x16x32_bf16 v[104:107], a[164:167], v[28:31], v[104:107]
  v_mfma_f32_16x16x32_bf16 v[108:111], a[220:223], v[28:31], v[108:111]
  s_waitcnt lgkmcnt(4)
  v_mfma_f32_16x16x32_bf16 v[112:115], a[52:55], v[32:35], v[112:115]
  ds_read_b128 v[24:27], v5 offset:2048
  v_mfma_f32_16x16x32_bf16 v[116:119], a[108:111], v[32:35], v[116:119]
  v_mfma_f32_16x16x32_bf16 v[120:123], a[164:167], v[32:35], v[120:123]
  v_mfma_f32_16x16x32_bf16 v[124:127], a[220:223], v[32:35], v[124:127]
  s_waitcnt lgkmcnt(4)
  s_mov_b32 s40, s19
  s_mov_b32 s41, s29
  s_add_u32 s19, s19, 1
  s_cmp_lt_u32 s19, s35
  s_cbranch_scc1 wg_vo_loop
  s_nop 3
  s_add_u32 s43, s41, 458752
  s_lshl_b32 s42, s40, 5
  s_add_u32 s42, s42, 0
  v_add_u32 v88, s42, v4
  v_mul_u32_u24 v89, 2341, v88
  v_lshrrev_b32 v89, 16, v89
  v_mul_u32_u24 v92, 28, v89
  v_sub_u32 v92, v88, v92
  v_cmp_gt_u32 vcc, 16, v92
  v_mul_u32_u24 v89, 84, v89
  s_nop 0
  v_cndmask_b32 v92, v7, v6, vcc
  v_add3_u32 v88, v88, v89, v92
  v_lshlrev_b32 v90, 4, v88
  v_cvt_pk_bf16_f32 v72, v96, v100
  v_cvt_pk_bf16_f32 v73, v97, v101
  v_cvt_pk_bf16_f32 v74, v98, v102
  v_cvt_pk_bf16_f32 v75, v99, v103
  buffer_store_dwordx4 v[72:75], v90, s[8:11], s41 offen sc1
  v_cvt_pk_bf16_f32 v76, v104, v108
  v_cvt_pk_bf16_f32 v77, v105, v109
  v_cvt_pk_bf16_f32 v78, v106, v110
  v_cvt_pk_bf16_f32 v79, v107, v111
  buffer_store_dwordx4 v[76:79], v90, s[8:11], s43 offen sc1
  s_lshl_b32 s42, s40, 5
  s_add_u32 s42, s42, 16
  v_add_u32 v88, s42, v4
  v_mul_u32_u24 v89, 2341, v88
  v_lshrrev_b32 v89, 16, v89
  v_mul_u32_u24 v92, 28, v89
  v_sub_u32 v92, v88, v92
  v_cmp_gt_u32 vcc, 16, v92
  v_mul_u32_u24 v89, 84, v89
  s_nop 0
  v_cndmask_b32 v92, v7, v6, vcc
  v_add3_u32 v88, v88, v89, v92
  v_lshlrev_b32 v91, 4, v88
  v_cvt_pk_bf16_f32 v80, v112, v116
  v_cvt_pk_bf16_f32 v81, v113, v117
  v_cvt_pk_bf16_f32 v82, v114, v118
  v_cvt_pk_bf16_f32 v83, v115, v119
  buffer_store_dwordx4 v[80:83], v91, s[8:11], s41 offen sc1
  v_cvt_pk_bf16_f32 v84, v120, v124
  v_cvt_pk_bf16_f32 v85, v121, v125
  v_cvt_pk_bf16_f32 v86, v122, v126
  v_cvt_pk_bf16_f32 v87, v123, v127
  buffer_store_dwordx4 v[84:87], v91, s[8:11], s43 offen sc1
  s_branch wg_done
wg_vo_e0:
  s_nop 7
  s_add_u32 s43, s41, 458752
  s_lshl_b32 s42, s40, 5
  s_add_u32 s42, s42, 0
  v_add_u32 v88, s42, v4
  v_mul_u32_u24 v89, 2341, v88
  v_lshrrev_b32 v89, 16, v89
  v_mul_u32_u24 v92, 28, v89
  v_sub_u32 v92, v88, v92
  v_cmp_gt_u32 vcc, 16, v92
  v_mul_u32_u24 v89, 84, v89
  s_nop 0
  v_cndmask_b32 v92, v7, v6, vcc
  v_add3_u32 v88, v88, v89, v92
  v_lshlrev_b32 v90, 4, v88
  v_cvt_pk_bf16_f32 v72, v40, v44
  v_cvt_pk_bf16_f32 v73, v41, v45
  v_cvt_pk_bf16_f32 v74, v42, v46
  v_cvt_pk_bf16_f32 v75, v43, v47
  buffer_store_dwordx4 v[72:75], v90, s[8:11], s41 offen sc1
  v_cvt_pk_bf16_f32 v76, v48, v52
  v_cvt_pk_bf16_f32 v77, v49, v53
  v_cvt_pk_bf16_f32 v78, v50, v54
  v_cvt_pk_bf16_f32 v79, v51, v55
  buffer_store_dwordx4 v[76:79], v90, s[8:11], s43 offen sc1
  s_lshl_b32 s42, s40, 5
  s_add_u32 s42, s42, 16
  v_add_u32 v88, s42, v4
  v_mul_u32_u24 v89, 2341, v88
  v_lshrrev_b32 v89, 16, v89
  v_mul_u32_u24 v92, 28, v89
  v_sub_u32 v92, v88, v92
  v_cmp_gt_u32 vcc, 16, v92
  v_mul_u32_u24 v89, 84, v89
  s_nop 0
  v_cndmask_b32 v92, v7, v6, vcc
  v_add3_u32 v88, v88, v89, v92
  v_lshlrev_b32 v91, 4, v88
  v_cvt_pk_bf16_f32 v80, v56, v60
  v_cvt_pk_bf16_f32 v81, v57, v61
  v_cvt_pk_bf16_f32 v82, v58, v62
  v_cvt_pk_bf16_f32 v83, v59, v63
  buffer_store_dwordx4 v[80:83], v91, s[8:11], s41 offen sc1
  v_cvt_pk_bf16_f32 v84, v64, v68
  v_cvt_pk_bf16_f32 v85, v65, v69
  v_cvt_pk_bf16_f32 v86, v66, v70
  v_cvt_pk_bf16_f32 v87, v67, v71
  buffer_store_dwordx4 v[84:87], v91, s[8:11], s43 offen sc1
  s_branch wg_done
wg_done:
  s_lshl_b32 s20, s18, 4
  s_and_b32 s21, s17, 15
  s_add_u32 s20, s20, s21
  s_lshl_b32 s20, s20, 7
  s_cmp_lt_u32 s17, 16
  s_cselect_b32 s21, 16384, 0
  s_add_u32 s20, s20, s21
  s_add_u32 s20, s20, 524288
  s_sub_u32 s21, s35, s34
  s_lshl_b32 s21, s21, 2
  v_mov_b32 v5, s21
  v_mov_b32 v6, 0
  s_waitcnt vmcnt(0) lgkmcnt(0)
  s_barrier
  s_cmp_lg_u32 s16, 0
  s_cbranch_scc1 wg_sg
  s_mov_b64 exec, 1
  buffer_atomic_add v5, v6, s[8:11], s20 offen
  s_mov_b64 exec, -1
wg_sg:
  s_branch wk_loop
wk_srv:
  s_mov_b32 s96, 7
  v_mov_b32 v4, 1
  v_mov_b32 v5, 587392
  v_mov_b32 v6, 160000
  s_barrier
  s_cmp_lg_u32 s16, 0
  s_cbranch_scc1 wk_sve1
  s_mov_b64 exec, 1
  buffer_atomic_add v4, v5, s[8:11], 0 offen sc0
  s_waitcnt vmcnt(0)
  ds_write_b32 v6, v4
  s_waitcnt lgkmcnt(0)
  s_mov_b64 exec, -1
wk_sve1:
  s_barrier
  ds_read_b32 v4, v6
  s_waitcnt lgkmcnt(0)
  v_readfirstlane_b32 s3, v4
  v_and_b32 v1, 63, v0
  v_lshlrev_b32 v2, 4, v1
  v_lshrrev_b32 v3, 4, v1
  v_and_b32 v4, 15, v1
  v_mov_b32 v250, 0
  s_cmp_ge_u32 s3, 32
  s_cbranch_scc1 wk_ask
  s_and_b32 s18, s3, 15
  s_lshr_b32 s19, s3, 4
  s_and_b32 s19, s19, 1
  s_mul_i32 s20, s18, 401408
  s_mul_i32 s21, s16, 100352
  s_add_u32 s20, s20, s21
  s_add_u32 s20, s20, 39976960
  s_add_u32 s22, s20, 0
  buffer_load_dwordx4 a[0:3], v2, s[8:11], s22 offen offset:0 sc1
  buffer_load_dwordx4 a[4:7], v2, s[8:11], s22 offen offset:1024 sc1
  buffer_load_dwordx4 a[8:11], v2, s[8:11], s22 offen offset:2048 sc1
  buffer_load_dwordx4 a[12:15], v2, s[8:11], s22 offen offset:3072 sc1
  s_add_u32 s22, s20, 4096
  buffer_load_dwordx4 a[16:19], v2, s[8:11], s22 offen offset:0 sc1
  buffer_load_dwordx4 a[20:23], v2, s[8:11], s22 offen offset:1024 sc1
  buffer_load_dwordx4 a[24:27], v2, s[8:11], s22 offen offset:2048 sc1
  buffer_load_dwordx4 a[28:31], v2, s[8:11], s22 offen offset:3072 sc1
  s_add_u32 s22, s20, 8192
  buffer_load_dwordx4 a[32:35], v2, s[8:11], s22 offen offset:0 sc1
  buffer_load_dwordx4 a[36:39], v2, s[8:11], s22 offen offset:1024 sc1
  s_waitcnt vmcnt(8)
  buffer_load_dwordx4 a[40:43], v2, s[8:11], s22 offen offset:2048 sc1
  buffer_load_dwordx4 a[44:47], v2, s[8:11], s22 offen offset:3072 sc1
  s_waitcnt vmcnt(8)
  s_add_u32 s22, s20, 12288
  buffer_load_dwordx4 a[48:51], v2, s[8:11], s22 offen offset:0 sc1
  buffer_load_dwordx4 a[52:55], v2, s[8:11], s22 offen offset:1024 sc1
  s_waitcnt vmcnt(8)
  buffer_load_dwordx4 a[56:59], v2, s[8:11], s22 offen offset:2048 sc1
  buffer_load_dwordx4 a[60:63], v2, s[8:11], s22 offen offset:3072 sc1
  s_waitcnt vmcnt(8)
  s_add_u32 s22, s20, 16384
  buffer_load_dwordx4 a[64:67], v2, s[8:11], s22 offen offset:0 sc1
  buffer_load_dwordx4 a[68:71], v2, s[8:11], s22 offen offset:1024 sc1
  s_waitcnt vmcnt(8)
  buffer_load_dwordx4 a[72:75], v2, s[8:11], s22 offen offset:2048 sc1
  buffer_load_dwordx4 a[76:79], v2, s[8:11], s22 offen offset:3072 sc1
  s_waitcnt vmcnt(8)
  s_add_u32 s22, s20, 20480
  buffer_load_dwordx4 a[80:83], v2, s[8:11], s22 offen offset:0 sc1
  buffer_load_dwordx4 a[84:87], v2, s[8:11], s22 offen offset:1024 sc1
  s_waitcnt vmcnt(8)
  buffer_load_dwordx4 a[88:91], v2, s[8:11], s22 offen offset:2048 sc1
  buffer_load_dwordx4 a[92:95], v2, s[8:11], s22 offen offset:3072 sc1
  s_waitcnt vmcnt(8)
  s_add_u32 s22, s20, 24576
  buffer_load_dwordx4 a[96:99], v2, s[8:11], s22 offen offset:0 sc1
  buffer_load_dwordx4 a[100:103], v2, s[8:11], s22 offen offset:1024 sc1
  s_waitcnt vmcnt(8)
  buffer_load_dwordx4 a[104:107], v2, s[8:11], s22 offen offset:2048 sc1
  buffer_load_dwordx4 a[108:111], v2, s[8:11], s22 offen offset:3072 sc1
  s_waitcnt vmcnt(8)
  s_add_u32 s22, s20, 28672
  buffer_load_dwordx4 a[112:115], v2, s[8:11], s22 offen offset:0 sc1
  buffer_load_dwordx4 a[116:119], v2, s[8:11], s22 offen offset:1024 sc1
  s_waitcnt vmcnt(8)
  buffer_load_dwordx4 a[120:123], v2, s[8:11], s22 offen offset:2048 sc1
  buffer_load_dwordx4 a[124:127], v2, s[8:11], s22 offen offset:3072 sc1
  s_waitcnt vmcnt(8)
  s_add_u32 s22, s20, 32768
  buffer_load_dwordx4 a[128:131], v2, s[8:11], s22 offen offset:0 sc1
  buffer_load_dwordx4 a[132:135], v2, s[8:11], s22 offen offset:1024 sc1
  s_waitcnt vmcnt(8)
  buffer_load_dwordx4 a[136:139], v2, s[8:11], s22 offen offset:2048 sc1
  buffer_load_dwordx4 a[140:143], v2, s[8:11], s22 offen offset:3072 sc1
  s_waitcnt vmcnt(8)
  s_add_u32 s22, s20, 36864
  buffer_load_dwordx4 a[144:147], v2, s[8:11], s22 offen offset:0 sc1
  buffer_load_dwordx4 a[148:151], v2, s[8:11], s22 offen offset:1024 sc1
  s_waitcnt vmcnt(8)
  buffer_load_dwordx4 a[152:155], v2, s[8:11], s22 offen offset:2048 sc1
  buffer_load_dwordx4 a[156:159], v2, s[8:11], s22 offen offset:3072 sc1
  s_waitcnt vmcnt(8)
  s_add_u32 s22, s20, 40960
  buffer_load_dwordx4 a[160:163], v2, s[8:11], s22 offen offset:0 sc1
  buffer_load_dwordx4 a[164:167], v2, s[8:11], s22 offen offset:1024 sc1
  s_waitcnt vmcnt(8)
  buffer_load_dwordx4 a[168:171], v2, s[8:11], s22 offen offset:2048 sc1
  buffer_load_dwordx4 a[172:175], v2, s[8:11], s22 offen offset:3072 sc1
  s_waitcnt vmcnt(8)
  s_add_u32 s22, s20, 45056
  buffer_load_dwordx4 a[176:179], v2, s[8:11], s22 offen offset:0 sc1
  buffer_load_dwordx4 a[180:183], v2, s[8:11], s22 offen offset:1024 sc1
  s_waitcnt vmcnt(8)
  buffer_load_dwordx4 a[184:187], v2, s[8:11], s22 offen offset:2048 sc1
  buffer_load_dwordx4 a[188:191], v2, s[8:11], s22 offen offset:3072 sc1
  s_waitcnt vmcnt(8)
  s_add_u32 s22, s20, 49152
  buffer_load_dwordx4 a[192:195], v2, s[8:11], s22 offen offset:0 sc1
  buffer_load_dwordx4 a[196:199], v2, s[8:11], s22 offen offset:1024 sc1
  s_waitcnt vmcnt(8)
  buffer_load_dwordx4 a[200:203], v2, s[8:11], s22 offen offset:2048 sc1
  buffer_load_dwordx4 a[204:207], v2, s[8:11], s22 offen offset:3072 sc1
  s_waitcnt vmcnt(8)
  s_add_u32 s22, s20, 53248
  buffer_load_dwordx4 a[208:211], v2, s[8:11], s22 offen offset:0 sc1
  buffer_load_dwordx4 a[212:215], v2, s[8:11], s22 offen offset:1024 sc1
  s_waitcnt vmcnt(8)
  buffer_load_dwordx4 a[216:219], v2, s[8:11], s22 offen offset:2048 sc1
  buffer_load_dwordx4 a[220:223], v2, s[8:11], s22 offen offset:3072 sc1
  s_waitcnt vmcnt(8)
  s_add_u32 s22, s20, 57344
  buffer_load_dwordx4 a[224:227], v2, s[8:11], s22 offen offset:0 sc1
  buffer_load_dwordx4 a[228:231], v2, s[8:11], s22 offen offset:1024 sc1
  s_waitcnt vmcnt(8)
  buffer_load_dwordx4 a[232:235], v2, s[8:11], s22 offen offset:2048 sc1
  buffer_load_dwordx4 a[236:239], v2, s[8:11], s22 offen offset:3072 sc1
  s_waitcnt vmcnt(8)
  s_add_u32 s22, s20, 61440
  buffer_load_dwordx4 a[240:243], v2, s[8:11], s22 offen offset:0 sc1
  buffer_load_dwordx4 a[244:247], v2, s[8:11], s22 offen offset:1024 sc1
  s_waitcnt vmcnt(8)
  buffer_load_dwordx4 a[248:251], v2, s[8:11], s22 offen offset:2048 sc1
  buffer_load_dwordx4 a[252:255], v2, s[8:11], s22 offen offset:3072 sc1
  s_waitcnt vmcnt(8)
  s_add_u32 s22, s20, 65536
  buffer_load_dwordx4 v[120:123], v2, s[8:11], s22 offen offset:0 sc1
  buffer_load_dwordx4 v[124:127], v2, s[8:11], s22 offen offset:1024 sc1
  s_waitcnt vmcnt(8)
  buffer_load_dwordx4 v[128:131], v2, s[8:11], s22 offen offset:2048 sc1
  buffer_load_dwordx4 v[132:135], v2, s[8:11], s22 offen offset:3072 sc1
  s_waitcnt vmcnt(8)
  s_add_u32 s22, s20, 69632
  buffer_load_dwordx4 v[136:139], v2, s[8:11], s22 offen offset:0 sc1
  buffer_load_dwordx4 v[140:143], v2, s[8:11], s22 offen offset:1024 sc1
  s_waitcnt vmcnt(8)
  buffer_load_dwordx4 v[144:147], v2, s[8:11], s22 offen offset:2048 sc1
  buffer_load_dwordx4 v[148:151], v2, s[8:11], s22 offen offset:3072 sc1
  s_waitcnt vmcnt(8)
  s_add_u32 s22, s20, 73728
  buffer_load_dwordx4 v[152:155], v2, s[8:11], s22 offen offset:0 sc1
  buffer_load_dwordx4 v[156:159], v2, s[8:11], s22 offen offset:1024 sc1
  s_waitcnt vmcnt(8)
  buffer_load_dwordx4 v[160:163], v2, s[8:11], s22 offen offset:2048 sc1
  buffer_load_dwordx4 v[164:167], v2, s[8:11], s22 offen offset:3072 sc1
  s_waitcnt vmcnt(8)
  s_add_u32 s22, s20, 77824
  buffer_load_dwordx4 v[168:171], v2, s[8:11], s22 offen offset:0 sc1
  buffer_load_dwordx4 v[172:175], v2, s[8:11], s22 offen offset:1024 sc1
  s_waitcnt vmcnt(8)
  buffer_load_dwordx4 v[176:179], v2, s[8:11], s22 offen offset:2048 sc1
  buffer_load_dwordx4 v[180:183], v2, s[8:11], s22 offen offset:3072 sc1
  s_waitcnt vmcnt(8)
  s_add_u32 s22, s20, 81920
  buffer_load_dwordx4 v[184:187], v2, s[8:11], s22 offen offset:0 sc1
  buffer_load_dwordx4 v[188:191], v2, s[8:11], s22 offen offset:1024 sc1
  s_waitcnt vmcnt(8)
  buffer_load_dwordx4 v[192:195], v2, s[8:11], s22 offen offset:2048 sc1
  buffer_load_dwordx4 v[196:199], v2, s[8:11], s22 offen offset:3072 sc1
  s_waitcnt vmcnt(8)
  s_add_u32 s22, s20, 86016
  buffer_load_dwordx4 v[200:203], v2, s[8:11], s22 offen offset:0 sc1
  buffer_load_dwordx4 v[204:207], v2, s[8:11], s22 offen offset:1024 sc1
  s_waitcnt vmcnt(8)
  buffer_load_dwordx4 v[208:211], v2, s[8:11], s22 offen offset:2048 sc1
  buffer_load_dwordx4 v[212:215], v2, s[8:11], s22 offen offset:3072 sc1
  s_waitcnt vmcnt(8)
  s_add_u32 s22, s20, 90112
  buffer_load_dwordx4 v[216:219], v2, s[8:11], s22 offen offset:0 sc1
  buffer_load_dwordx4 v[220:223], v2, s[8:11], s22 offen offset:1024 sc1
  s_waitcnt vmcnt(8)
  buffer_load_dwordx4 v[224:227], v2, s[8:11], s22 offen offset:2048 sc1
  buffer_load_dwordx4 v[228:231], v2, s[8:11], s22 offen offset:3072 sc1
  s_waitcnt vmcnt(8)
  s_add_u32 s22, s20, 94208
  buffer_load_dwordx4 v[232:235], v2, s[8:11], s22 offen offset:0 sc1
  buffer_load_dwordx4 v[236:239], v2, s[8:11], s22 offen offset:1024 sc1
  s_waitcnt vmcnt(8)
  buffer_load_dwordx4 v[240:243], v2, s[8:11], s22 offen offset:2048 sc1
  buffer_load_dwordx4 v[244:247], v2, s[8:11], s22 offen offset:3072 sc1
  s_waitcnt vmcnt(8)
  s_add_u32 s22, s20, 98304
  buffer_load_dwordx4 v[248:251], v2, s[8:11], s22 offen offset:0 sc1
  buffer_load_dwordx4 v[252:255], v2, s[8:11], s22 offen offset:1024 sc1
  s_waitcnt vmcnt(8)
  v_mov_b32 v5, 0x4444
  v_mov_b32 v6, 0xeeee
  v_cmp_lt_u32 vcc, 7, v4
  s_nop 1
  v_cndmask_b32 v5, v5, v6, vcc
  s_lshl_b32 s23, s16, 11
  v_lshrrev_b32 v80, 1, v3
  v_and_b32 v81, 1, v3
  v_add_u32 v82, 0, v80
  v_lshl_add_u32 v82, v82, 4, v4
  v_mul_u32_u24 v83, 2341, v82
  v_lshrrev_b32 v83, 16, v83
  v_mul_u32_u24 v84, 28, v83
  v_sub_u32 v84, v82, v84
  v_lshrrev_b32 v85, 4, v84
  v_and_b32 v84, 15, v84
  v_lshlrev_b32 v86, 10, v85
  v_lshl_add_u32 v86, v83, 8, v86
  v_lshl_add_u32 v86, v84, 4, v86
  v_lshl_add_u32 v86, v81, 3, v86
  v_add_u32 v72, s23, v86
  v_add_u32 v82, 2, v80
  v_lshl_add_u32 v82, v82, 4, v4
  v_mul_u32_u24 v83, 2341, v82
  v_lshrrev_b32 v83, 16, v83
  v_mul_u32_u24 v84, 28, v83
  v_sub_u32 v84, v82, v84
  v_lshrrev_b32 v85, 4, v84
  v_and_b32 v84, 15, v84
  v_lshlrev_b32 v86, 10, v85
  v_lshl_add_u32 v86, v83, 8, v86
  v_lshl_add_u32 v86, v84, 4, v86
  v_lshl_add_u32 v86, v81, 3, v86
  v_add_u32 v73, s23, v86
  v_add_u32 v82, 4, v80
  v_lshl_add_u32 v82, v82, 4, v4
  v_mul_u32_u24 v83, 2341, v82
  v_lshrrev_b32 v83, 16, v83
  v_mul_u32_u24 v84, 28, v83
  v_sub_u32 v84, v82, v84
  v_lshrrev_b32 v85, 4, v84
  v_and_b32 v84, 15, v84
  v_lshlrev_b32 v86, 10, v85
  v_lshl_add_u32 v86, v83, 8, v86
  v_lshl_add_u32 v86, v84, 4, v86
  v_lshl_add_u32 v86, v81, 3, v86
  v_add_u32 v74, s23, v86
  v_mov_b32 v82, 6
  v_lshl_add_u32 v82, v82, 4, v4
  v_mul_u32_u24 v83, 2341, v82
  v_lshrrev_b32 v83, 16, v83
  v_mul_u32_u24 v84, 28, v83
  v_sub_u32 v84, v82, v84
  v_lshrrev_b32 v85, 4, v84
  v_and_b32 v84, 15, v84
  v_lshlrev_b32 v86, 10, v85
  v_lshl_add_u32 v86, v83, 8, v86
  v_lshl_add_u32 v86, v84, 4, v86
  v_lshl_add_u32 v86, v81, 3, v86
  v_add_u32 v75, s23, v86
  v_add_u32 v76, s23, v2
  s_mul_i32 s27, s18, 448
  v_mov_b32 v77, s27
  v_mov_b32 v78, 1
  s_mov_b32 s17, s19
  s_mul_i32 s24, s19, 7168
  s_add_u32 s24, s24, 65536
  s_mul_i32 s25, s18, 65
  s_add_u32 s25, s25, s19
  s_lshl_b32 s25, s25, 13
  s_add_u32 s25, s25, s23
  s_add_u32 s25, s25, 77602816
  s_lshl_b32 s26, s18, 6
  s_add_u32 s26, s26, s19
  s_lshl_b32 s26, s26, 4
  s_lshl_b32 s27, s16, 2
  s_add_u32 s26, s26, s27
  s_add_u32 s26, s26, 565248
  v_mov_b32 v88, 0
  v_mov_b32 v89, 0
  v_mov_b32 v90, 0
  v_mov_b32 v91, 0
  v_mov_b32 v92, -1
  v_mov_b32 v93, -1
  v_mov_b32 v94, -1
  v_mov_b32 v95, -1
  ds_write_b128 v76, v[88:91]
  ds_write_b128 v76, v[88:91] offset:1024
  s_mov_b32 s28, s25
  s_mov_b32 s29, 0
ws_arm:
  buffer_store_dwordx4 v[92:95], v2, s[8:11], s28 offen sc1
  buffer_store_dwordx4 v[92:95], v2, s[8:11], s28 offen offset:1024 sc1
  s_waitcnt vmcnt(8)
  s_add_u32 s28, s28, 16384
  s_add_u32 s29, s29, 1
  s_cmp_lt_u32 s29, 31
  s_cbranch_scc1 ws_arm
  s_waitcnt vmcnt(0)
  s_mov_b64 exec, 1
  buffer_store_dword v78, v2, s[8:11], s26 offen sc1
  s_mov_b64 exec, -1
ws_loop:
  v_mov_b32 v36, 0
  v_mov_b32 v37, 0
  v_mov_b32 v38, 0
  v_mov_b32 v39, 0
  v_mov_b32 v40, 0
  v_mov_b32 v41, 0
  v_mov_b32 v42, 0
  v_mov_b32 v43, 0
  v_mov_b32 v44, 0
  v_mov_b32 v45, 0
  v_mov_b32 v46, 0
  v_mov_b32 v47, 0
  v_mov_b32 v48, 0
  v_mov_b32 v49, 0
  v_mov_b32 v50, 0
  v_mov_b32 v51, 0
  v_mov_b32 v52, 0
  v_mov_b32 v53, 0
  v_mov_b32 v54, 0
  v_mov_b32 v55, 0
  v_mov_b32 v56, 0
  v_mov_b32 v57, 0
  v_mov_b32 v58, 0
  v_mov_b32 v59, 0
  v_mov_b32 v60, 0
  v_mov_b32 v61, 0
  v_mov_b32 v62, 0
  v_mov_b32 v63, 0
  s_mov_b32 s30, 0
  s_branch ws_fl
ws_pm:
  s_cmp_ge_u32 s17, 64
  s_cbranch_scc1 ws_fl
  buffer_load_dword v79, v77, s[8:11], s24 offen sc1
  s_waitcnt vmcnt(0)
  v_cmp_eq_u32 vcc, -1, v79
  s_cbranch_vccnz ws_pr
ws_fl:
  s_add_u32 s22, s24, 4096
  buffer_load_dwordx4 v[8:11], v2, s[8:11], s24 offen offset:0 sc1
  buffer_load_dwordx4 v[12:15], v2, s[8:11], s24 offen offset:1024 sc1
  buffer_load_dwordx4 v[16:19], v2, s[8:11], s24 offen offset:2048 sc1
  buffer_load_dwordx4 v[20:23], v2, s[8:11], s24 offen offset:3072 sc1
  buffer_load_dwordx4 v[24:27], v2, s[8:11], s22 offen offset:0 sc1
  buffer_load_dwordx4 v[28:31], v2, s[8:11], s22 offen offset:1024 sc1
  buffer_load_dwordx4 v[32:35], v2, s[8:11], s22 offen offset:2048 sc1
  s_waitcnt vmcnt(0)
  v_max_u32 v79, v8, v9
  v_max3_u32 v79, v79, v10, v11
  v_max3_u32 v79, v79, v12, v13
  v_max3_u32 v79, v79, v14, v15
  v_max3_u32 v79, v79, v16, v17
  v_max3_u32 v79, v79, v18, v19
  v_max3_u32 v79, v79, v20, v21
  v_max3_u32 v79, v79, v22, v23
  v_max3_u32 v79, v79, v24, v25
  v_max3_u32 v79, v79, v26, v27
  v_max3_u32 v79, v79, v28, v29
  v_max3_u32 v79, v79, v30, v31
  v_max3_u32 v79, v79, v32, v33
  v_max3_u32 v79, v79, v34, v35
  v_cmp_eq_u32 vcc, -1, v79
  s_cbranch_vccz ws_pk
ws_pr:
  s_sleep 20
  s_add_u32 s30, s30, 1
  s_cmp_lt_u32 s30, 2000000
  s_cbranch_scc1 ws_pm
  s_branch cA_abort
ws_pk:
  v_smfmac_f32_16x16x64_bf16 v[36:39], v[8:11], a[0:7], v5
  v_smfmac_f32_16x16x64_bf16 v[36:39], v[12:15], a[8:15], v5
  v_smfmac_f32_16x16x64_bf16 v[36:39], v[16:19], a[16:23], v5
  v_smfmac_f32_16x16x64_bf16 v[36:39], v[20:23], a[24:31], v5
  v_smfmac_f32_16x16x64_bf16 v[36:39], v[24:27], a[32:39], v5
  v_smfmac_f32_16x16x64_bf16 v[36:39], v[28:31], a[40:47], v5
  v_smfmac_f32_16x16x64_bf16 v[36:39], v[32:35], a[48:55], v5
  v_smfmac_f32_16x16x64_bf16 v[40:43], v[8:11], a[56:63], v5
  v_smfmac_f32_16x16x64_bf16 v[40:43], v[12:15], a[64:71], v5
  v_smfmac_f32_16x16x64_bf16 v[40:43], v[16:19], a[72:79], v5
  v_smfmac_f32_16x16x64_bf16 v[40:43], v[20:23], a[80:87], v5
  v_smfmac_f32_16x16x64_bf16 v[40:43], v[24:27], a[88:95], v5
  v_smfmac_f32_16x16x64_bf16 v[40:43], v[28:31], a[96:103], v5
  v_smfmac_f32_16x16x64_bf16 v[40:43], v[32:35], a[104:111], v5
  v_smfmac_f32_16x16x64_bf16 v[44:47], v[8:11], a[112:119], v5
  v_smfmac_f32_16x16x64_bf16 v[44:47], v[12:15], a[120:127], v5
  v_smfmac_f32_16x16x64_bf16 v[44:47], v[16:19], a[128:135], v5
  v_smfmac_f32_16x16x64_bf16 v[44:47], v[20:23], a[136:143], v5
  v_smfmac_f32_16x16x64_bf16 v[44:47], v[24:27], a[144:151], v5
  v_smfmac_f32_16x16x64_bf16 v[44:47], v[28:31], a[152:159], v5
  v_smfmac_f32_16x16x64_bf16 v[44:47], v[32:35], a[160:167], v5
  v_smfmac_f32_16x16x64_bf16 v[48:51], v[8:11], a[168:175], v5
  v_smfmac_f32_16x16x64_bf16 v[48:51], v[12:15], a[176:183], v5
  v_smfmac_f32_16x16x64_bf16 v[48:51], v[16:19], a[184:191], v5
  v_smfmac_f32_16x16x64_bf16 v[48:51], v[20:23], a[192:199], v5
  v_smfmac_f32_16x16x64_bf16 v[48:51], v[24:27], a[200:207], v5
  v_smfmac_f32_16x16x64_bf16 v[48:51], v[28:31], a[208:215], v5
  v_smfmac_f32_16x16x64_bf16 v[48:51], v[32:35], a[216:223], v5
  v_smfmac_f32_16x16x64_bf16 v[52:55], v[8:11], a[224:231], v5
  v_smfmac_f32_16x16x64_bf16 v[52:55], v[12:15], a[232:239], v5
  v_smfmac_f32_16x16x64_bf16 v[52:55], v[16:19], a[240:247], v5
  v_smfmac_f32_16x16x64_bf16 v[52:55], v[20:23], a[248:255], v5
  v_smfmac_f32_16x16x64_bf16 v[52:55], v[24:27], v[120:127], v5
  v_smfmac_f32_16x16x64_bf16 v[52:55], v[28:31], v[128:135], v5
  v_smfmac_f32_16x16x64_bf16 v[52:55], v[32:35], v[136:143], v5
  v_smfmac_f32_16x16x64_bf16 v[56:59], v[8:11], v[144:151], v5
  v_smfmac_f32_16x16x64_bf16 v[56:59], v[12:15], v[152:159], v5
  v_smfmac_f32_16x16x64_bf16 v[56:59], v[16:19], v[160:167], v5
  v_smfmac_f32_16x16x64_bf16 v[56:59], v[20:23], v[168:175], v5
  v_smfmac_f32_16x16x64_bf16 v[56:59], v[24:27], v[176:183], v5
  v_smfmac_f32_16x16x64_bf16 v[56:59], v[28:31], v[184:191], v5
  v_smfmac_f32_16x16x64_bf16 v[56:59], v[32:35], v[192:199], v5
  v_smfmac_f32_16x16x64_bf16 v[60:63], v[8:11], v[200:207], v5
  v_smfmac_f32_16x16x64_bf16 v[60:63], v[12:15], v[208:215], v5
  v_smfmac_f32_16x16x64_bf16 v[60:63], v[16:19], v[216:223], v5
  v_smfmac_f32_16x16x64_bf16 v[60:63], v[20:23], v[224:231], v5
  v_smfmac_f32_16x16x64_bf16 v[60:63], v[24:27], v[232:239], v5
  v_smfmac_f32_16x16x64_bf16 v[60:63], v[28:31], v[240:247], v5
  v_smfmac_f32_16x16x64_bf16 v[60:63], v[32:35], v[248:255], v5
  v_permlane32_swap_b32 v36, v40
  v_permlane32_swap_b32 v37, v41
  v_permlane32_swap_b32 v38, v42
  v_permlane32_swap_b32 v39, v43
  v_add_f32 v36, v36, v40
  v_add_f32 v37, v37, v41
  v_add_f32 v38, v38, v42
  v_add_f32 v39, v39, v43
  v_cvt_pk_bf16_f32 v40, v36, v37
  v_cvt_pk_bf16_f32 v41, v38, v39
  v_min_u32 v40, -2, v40
  v_min_u32 v41, -2, v41
  ds_write_b64 v72, v[40:41]
  v_permlane32_swap_b32 v44, v48
  v_permlane32_swap_b32 v45, v49
  v_permlane32_swap_b32 v46, v50
  v_permlane32_swap_b32 v47, v51
  v_add_f32 v44, v44, v48
  v_add_f32 v45, v45, v49
  v_add_f32 v46, v46, v50
  v_add_f32 v47, v47, v51
  v_cvt_pk_bf16_f32 v48, v44, v45
  v_cvt_pk_bf16_f32 v49, v46, v47
  v_min_u32 v48, -2, v48
  v_min_u32 v49, -2, v49
  ds_write_b64 v73, v[48:49]
  v_permlane32_swap_b32 v52, v56
  v_permlane32_swap_b32 v53, v57
  v_permlane32_swap_b32 v54, v58
  v_permlane32_swap_b32 v55, v59
  v_add_f32 v52, v52, v56
  v_add_f32 v53, v53, v57
  v_add_f32 v54, v54, v58
  v_add_f32 v55, v55, v59
  v_cvt_pk_bf16_f32 v56, v52, v53
  v_cvt_pk_bf16_f32 v57, v54, v55
  v_min_u32 v56, -2, v56
  v_min_u32 v57, -2, v57
  ds_write_b64 v74, v[56:57]
  v_mov_b32 v64, v60
  v_mov_b32 v65, v61
  v_mov_b32 v66, v62
  v_mov_b32 v67, v63
  v_permlane32_swap_b32 v60, v64
  v_permlane32_swap_b32 v61, v65
  v_permlane32_swap_b32 v62, v66
  v_permlane32_swap_b32 v63, v67
  v_add_f32 v60, v60, v64
  v_add_f32 v61, v61, v65
  v_add_f32 v62, v62, v66
  v_add_f32 v63, v63, v67
  v_cvt_pk_bf16_f32 v64, v60, v61
  v_cvt_pk_bf16_f32 v65, v62, v63
  v_min_u32 v64, -2, v64
  v_min_u32 v65, -2, v65
  ds_write_b64 v75, v[64:65]
  s_waitcnt lgkmcnt(0)
  ds_read_b128 v[64:67], v76
  ds_read_b128 v[68:71], v76 offset:1024
  s_waitcnt lgkmcnt(0)
  buffer_store_dwordx4 v[64:67], v2, s[8:11], s25 offen sc1
  buffer_store_dwordx4 v[68:71], v2, s[8:11], s25 offen offset:1024 sc1
  s_add_u32 s24, s24, 14336
  s_add_u32 s25, s25, 16384
  s_add_u32 s17, s17, 2
  s_cmp_lt_u32 s17, 62
  s_cbranch_scc1 ws_loop
  v_mov_b32 v250, 0
  s_branch wk_loop
wk_s4d:
  s_sub_u32 s3, s3, 640
  s_getreg_b32 s33, hwreg(HW_REG_XCC_ID)
  s_sub_u32 s33, s33, 4
  s_and_b32 s33, s33, 7
  s_min_u32 s33, s33, 6
  s_mov_b32 s35, 6
wk_s4c:
  s_lshl_b32 s34, s33, 7
  s_add_u32 s34, s34, 588416
  v_mov_b32 v4, 1
  v_mov_b32 v5, s34
  v_mov_b32 v6, 160000
  s_barrier
  s_cmp_lg_u32 s16, 0
  s_cbranch_scc1 wk_s4e1
  s_mov_b64 exec, 1
  buffer_atomic_add v4, v5, s[8:11], 0 offen sc0
  s_waitcnt vmcnt(0)
  ds_write_b32 v6, v4
  s_waitcnt lgkmcnt(0)
  s_mov_b64 exec, -1
wk_s4e1:
  s_barrier
  ds_read_b32 v4, v6
  s_waitcnt lgkmcnt(0)
  v_readfirstlane_b32 s3, v4
  s_cmp_lt_u32 s3, 16
  s_cbranch_scc1 wk_s4g
  s_mov_b32 s33, s35
  s_sub_u32 s35, s35, 1
  s_max_i32 s35, s35, 0
  s_branch wk_s4c
wk_s4g:
  s_lshl_b32 s33, s33, 4
  s_add_u32 s3, s3, s33
  s_load_dwordx8 s[40:47], s[0:1], 0
  s_load_dwordx4 s[48:51], s[0:1], 32
  s_load_dwordx2 s[52:53], s[0:1], 48
  s_load_dwordx2 s[54:55], s[0:1], 112
  v_lshrrev_b32 v1, 6, v0
  s_nop 0
  v_readfirstlane_b32 s16, v1
  v_and_b32 v1, 63, v0
  v_lshrrev_b32 v3, 4, v1
  v_and_b32 v4, 15, v1
  s_mul_i32 s17, s16, 24576
  s_waitcnt lgkmcnt(0)
  s_mov_b32 s60, s40
  s_and_b32 s61, s41, 0xffff
  s_mov_b32 s62, 1835008
  s_mov_b32 s63, 0x20000
  s_mov_b32 s64, s42
  s_and_b32 s65, s43, 0xffff
  s_mov_b32 s66, 229376
  s_mov_b32 s67, 0x20000
  s_mov_b32 s68, s44
  s_and_b32 s69, s45, 0xffff
  s_mov_b32 s70, 229376
  s_mov_b32 s71, 0x20000
  s_mov_b32 s72, s46
  s_and_b32 s73, s47, 0xffff
  s_mov_b32 s74, 229376
  s_mov_b32 s75, 0x20000
  s_mov_b32 s76, s48
  s_and_b32 s77, s49, 0xffff
  s_mov_b32 s78, 229376
  s_mov_b32 s79, 0x20000
  s_mov_b32 s80, s50
  s_and_b32 s81, s51, 0xffff
  s_mov_b32 s82, 896
  s_mov_b32 s83, 0x20000
  s_mov_b32 s84, s52
  s_and_b32 s85, s53, 0xffff
  s_mov_b32 s86, 896
  s_mov_b32 s87, 0x20000
  s_mov_b32 s88, s54
  s_and_b32 s89, s55, 0xffff
  s_mov_b32 s90, 3670016
  s_mov_b32 s91, 0x20000
  v_lshlrev_b32 v5, 5, v1
  v_sub_u32 v5, 2047, v5
  s_add_u32 s18, s17, 13056
  v_subrev_u32 v6, 0, v5
  v_max_i32 v7, 0, v6
  v_cvt_f32_u32 v7, v7
  v_cvt_pk_bf16_f32 v8, v7, v7
  v_and_b32 v7, 0xffff0000, v8
  v_lshrrev_b32 v8, 23, v7
  v_subrev_u32 v8, 134, v8
  v_max_i32 v8, 0, v8
  v_cvt_u32_f32 v7, v7
  v_lshrrev_b32 v7, v8, v7
  v_lshl_add_u32 v7, v8, 8, v7
  v_lshl_add_u32 v200, v7, 2, s18
  v_subrev_u32 v6, 1, v5
  v_max_i32 v7, 0, v6
  v_cvt_f32_u32 v7, v7
  v_cvt_pk_bf16_f32 v8, v7, v7
  v_and_b32 v7, 0xffff0000, v8
  v_lshrrev_b32 v8, 23, v7
  v_subrev_u32 v8, 134, v8
  v_max_i32 v8, 0, v8
  v_cvt_u32_f32 v7, v7
  v_lshrrev_b32 v7, v8, v7
  v_lshl_add_u32 v7, v8, 8, v7
  v_lshl_add_u32 v201, v7, 2, s18
  v_subrev_u32 v6, 2, v5
  v_max_i32 v7, 0, v6
  v_cvt_f32_u32 v7, v7
  v_cvt_pk_bf16_f32 v8, v7, v7
  v_and_b32 v7, 0xffff0000, v8
  v_lshrrev_b32 v8, 23, v7
  v_subrev_u32 v8, 134, v8
  v_max_i32 v8, 0, v8
  v_cvt_u32_f32 v7, v7
  v_lshrrev_b32 v7, v8, v7
  v_lshl_add_u32 v7, v8, 8, v7
  v_lshl_add_u32 v202, v7, 2, s18
  v_subrev_u32 v6, 3, v5
  v_max_i32 v7, 0, v6
  v_cvt_f32_u32 v7, v7
  v_cvt_pk_bf16_f32 v8, v7, v7
  v_and_b32 v7, 0xffff0000, v8
  v_lshrrev_b32 v8, 23, v7
  v_subrev_u32 v8, 134, v8
  v_max_i32 v8, 0, v8
  v_cvt_u32_f32 v7, v7
  v_lshrrev_b32 v7, v8, v7
  v_lshl_add_u32 v7, v8, 8, v7
  v_lshl_add_u32 v203, v7, 2, s18
  v_subrev_u32 v6, 4, v5
  v_max_i32 v7, 0, v6
  v_cvt_f32_u32 v7, v7
  v_cvt_pk_bf16_f32 v8, v7, v7
  v_and_b32 v7, 0xffff0000, v8
  v_lshrrev_b32 v8, 23, v7
  v_subrev_u32 v8, 134, v8
  v_max_i32 v8, 0, v8
  v_cvt_u32_f32 v7, v7
  v_lshrrev_b32 v7, v8, v7
  v_lshl_add_u32 v7, v8, 8, v7
  v_lshl_add_u32 v204, v7, 2, s18
  v_subrev_u32 v6, 5, v5
  v_max_i32 v7, 0, v6
  v_cvt_f32_u32 v7, v7
  v_cvt_pk_bf16_f32 v8, v7, v7
  v_and_b32 v7, 0xffff0000, v8
  v_lshrrev_b32 v8, 23, v7
  v_subrev_u32 v8, 134, v8
  v_max_i32 v8, 0, v8
  v_cvt_u32_f32 v7, v7
  v_lshrrev_b32 v7, v8, v7
  v_lshl_add_u32 v7, v8, 8, v7
  v_lshl_add_u32 v205, v7, 2, s18
  v_subrev_u32 v6, 6, v5
  v_max_i32 v7, 0, v6
  v_cvt_f32_u32 v7, v7
  v_cvt_pk_bf16_f32 v8, v7, v7
  v_and_b32 v7, 0xffff0000, v8
  v_lshrrev_b32 v8, 23, v7
  v_subrev_u32 v8, 134, v8
  v_max_i32 v8, 0, v8
  v_cvt_u32_f32 v7, v7
  v_lshrrev_b32 v7, v8, v7
  v_lshl_add_u32 v7, v8, 8, v7
  v_lshl_add_u32 v206, v7, 2, s18
  v_subrev_u32 v6, 7, v5
  v_max_i32 v7, 0, v6
  v_cvt_f32_u32 v7, v7
  v_cvt_pk_bf16_f32 v8, v7, v7
  v_and_b32 v7, 0xffff0000, v8
  v_lshrrev_b32 v8, 23, v7
  v_subrev_u32 v8, 134, v8
  v_max_i32 v8, 0, v8
  v_cvt_u32_f32 v7, v7
  v_lshrrev_b32 v7, v8, v7
  v_lshl_add_u32 v7, v8, 8, v7
  v_lshl_add_u32 v207, v7, 2, s18
  v_subrev_u32 v6, 8, v5
  v_max_i32 v7, 0, v6
  v_cvt_f32_u32 v7, v7
  v_cvt_pk_bf16_f32 v8, v7, v7
  v_and_b32 v7, 0xffff0000, v8
  v_lshrrev_b32 v8, 23, v7
  v_subrev_u32 v8, 134, v8
  v_max_i32 v8, 0, v8
  v_cvt_u32_f32 v7, v7
  v_lshrrev_b32 v7, v8, v7
  v_lshl_add_u32 v7, v8, 8, v7
  v_lshl_add_u32 v208, v7, 2, s18
  v_subrev_u32 v6, 9, v5
  v_max_i32 v7, 0, v6
  v_cvt_f32_u32 v7, v7
  v_cvt_pk_bf16_f32 v8, v7, v7
  v_and_b32 v7, 0xffff0000, v8
  v_lshrrev_b32 v8, 23, v7
  v_subrev_u32 v8, 134, v8
  v_max_i32 v8, 0, v8
  v_cvt_u32_f32 v7, v7
  v_lshrrev_b32 v7, v8, v7
  v_lshl_add_u32 v7, v8, 8, v7
  v_lshl_add_u32 v209, v7, 2, s18
  v_subrev_u32 v6, 10, v5
  v_max_i32 v7, 0, v6
  v_cvt_f32_u32 v7, v7
  v_cvt_pk_bf16_f32 v8, v7, v7
  v_and_b32 v7, 0xffff0000, v8
  v_lshrrev_b32 v8, 23, v7
  v_subrev_u32 v8, 134, v8
  v_max_i32 v8, 0, v8
  v_cvt_u32_f32 v7, v7
  v_lshrrev_b32 v7, v8, v7
  v_lshl_add_u32 v7, v8, 8, v7
  v_lshl_add_u32 v210, v7, 2, s18
  v_subrev_u32 v6, 11, v5
  v_max_i32 v7, 0, v6
  v_cvt_f32_u32 v7, v7
  v_cvt_pk_bf16_f32 v8, v7, v7
  v_and_b32 v7, 0xffff0000, v8
  v_lshrrev_b32 v8, 23, v7
  v_subrev_u32 v8, 134, v8
  v_max_i32 v8, 0, v8
  v_cvt_u32_f32 v7, v7
  v_lshrrev_b32 v7, v8, v7
  v_lshl_add_u32 v7, v8, 8, v7
  v_lshl_add_u32 v211, v7, 2, s18
  v_subrev_u32 v6, 12, v5
  v_max_i32 v7, 0, v6
  v_cvt_f32_u32 v7, v7
  v_cvt_pk_bf16_f32 v8, v7, v7
  v_and_b32 v7, 0xffff0000, v8
  v_lshrrev_b32 v8, 23, v7
  v_subrev_u32 v8, 134, v8
  v_max_i32 v8, 0, v8
  v_cvt_u32_f32 v7, v7
  v_lshrrev_b32 v7, v8, v7
  v_lshl_add_u32 v7, v8, 8, v7
  v_lshl_add_u32 v212, v7, 2, s18
  v_subrev_u32 v6, 13, v5
  v_max_i32 v7, 0, v6
  v_cvt_f32_u32 v7, v7
  v_cvt_pk_bf16_f32 v8, v7, v7
  v_and_b32 v7, 0xffff0000, v8
  v_lshrrev_b32 v8, 23, v7
  v_subrev_u32 v8, 134, v8
  v_max_i32 v8, 0, v8
  v_cvt_u32_f32 v7, v7
  v_lshrrev_b32 v7, v8, v7
  v_lshl_add_u32 v7, v8, 8, v7
  v_lshl_add_u32 v213, v7, 2, s18
  v_subrev_u32 v6, 14, v5
  v_max_i32 v7, 0, v6
  v_cvt_f32_u32 v7, v7
  v_cvt_pk_bf16_f32 v8, v7, v7
  v_and_b32 v7, 0xffff0000, v8
  v_lshrrev_b32 v8, 23, v7
  v_subrev_u32 v8, 134, v8
  v_max_i32 v8, 0, v8
  v_cvt_u32_f32 v7, v7
  v_lshrrev_b32 v7, v8, v7
  v_lshl_add_u32 v7, v8, 8, v7
  v_lshl_add_u32 v214, v7, 2, s18
  v_subrev_u32 v6, 15, v5
  v_max_i32 v7, 0, v6
  v_cvt_f32_u32 v7, v7
  v_cvt_pk_bf16_f32 v8, v7, v7
  v_and_b32 v7, 0xffff0000, v8
  v_lshrrev_b32 v8, 23, v7
  v_subrev_u32 v8, 134, v8
  v_max_i32 v8, 0, v8
  v_cvt_u32_f32 v7, v7
  v_lshrrev_b32 v7, v8, v7
  v_lshl_add_u32 v7, v8, 8, v7
  v_lshl_add_u32 v215, v7, 2, s18
  v_subrev_u32 v6, 16, v5
  v_max_i32 v7, 0, v6
  v_cvt_f32_u32 v7, v7
  v_cvt_pk_bf16_f32 v8, v7, v7
  v_and_b32 v7, 0xffff0000, v8
  v_lshrrev_b32 v8, 23, v7
  v_subrev_u32 v8, 134, v8
  v_max_i32 v8, 0, v8
  v_cvt_u32_f32 v7, v7
  v_lshrrev_b32 v7, v8, v7
  v_lshl_add_u32 v7, v8, 8, v7
  v_lshl_add_u32 v216, v7, 2, s18
  v_subrev_u32 v6, 17, v5
  v_max_i32 v7, 0, v6
  v_cvt_f32_u32 v7, v7
  v_cvt_pk_bf16_f32 v8, v7, v7
  v_and_b32 v7, 0xffff0000, v8
  v_lshrrev_b32 v8, 23, v7
  v_subrev_u32 v8, 134, v8
  v_max_i32 v8, 0, v8
  v_cvt_u32_f32 v7, v7
  v_lshrrev_b32 v7, v8, v7
  v_lshl_add_u32 v7, v8, 8, v7
  v_lshl_add_u32 v217, v7, 2, s18
  v_subrev_u32 v6, 18, v5
  v_max_i32 v7, 0, v6
  v_cvt_f32_u32 v7, v7
  v_cvt_pk_bf16_f32 v8, v7, v7
  v_and_b32 v7, 0xffff0000, v8
  v_lshrrev_b32 v8, 23, v7
  v_subrev_u32 v8, 134, v8
  v_max_i32 v8, 0, v8
  v_cvt_u32_f32 v7, v7
  v_lshrrev_b32 v7, v8, v7
  v_lshl_add_u32 v7, v8, 8, v7
  v_lshl_add_u32 v218, v7, 2, s18
  v_subrev_u32 v6, 19, v5
  v_max_i32 v7, 0, v6
  v_cvt_f32_u32 v7, v7
  v_cvt_pk_bf16_f32 v8, v7, v7
  v_and_b32 v7, 0xffff0000, v8
  v_lshrrev_b32 v8, 23, v7
  v_subrev_u32 v8, 134, v8
  v_max_i32 v8, 0, v8
  v_cvt_u32_f32 v7, v7
  v_lshrrev_b32 v7, v8, v7
  v_lshl_add_u32 v7, v8, 8, v7
  v_lshl_add_u32 v219, v7, 2, s18
  v_subrev_u32 v6, 20, v5
  v_max_i32 v7, 0, v6
  v_cvt_f32_u32 v7, v7
  v_cvt_pk_bf16_f32 v8, v7, v7
  v_and_b32 v7, 0xffff0000, v8
  v_lshrrev_b32 v8, 23, v7
  v_subrev_u32 v8, 134, v8
  v_max_i32 v8, 0, v8
  v_cvt_u32_f32 v7, v7
  v_lshrrev_b32 v7, v8, v7
  v_lshl_add_u32 v7, v8, 8, v7
  v_lshl_add_u32 v220, v7, 2, s18
  v_subrev_u32 v6, 21, v5
  v_max_i32 v7, 0, v6
  v_cvt_f32_u32 v7, v7
  v_cvt_pk_bf16_f32 v8, v7, v7
  v_and_b32 v7, 0xffff0000, v8
  v_lshrrev_b32 v8, 23, v7
  v_subrev_u32 v8, 134, v8
  v_max_i32 v8, 0, v8
  v_cvt_u32_f32 v7, v7
  v_lshrrev_b32 v7, v8, v7
  v_lshl_add_u32 v7, v8, 8, v7
  v_lshl_add_u32 v221, v7, 2, s18
  v_subrev_u32 v6, 22, v5
  v_max_i32 v7, 0, v6
  v_cvt_f32_u32 v7, v7
  v_cvt_pk_bf16_f32 v8, v7, v7
  v_and_b32 v7, 0xffff0000, v8
  v_lshrrev_b32 v8, 23, v7
  v_subrev_u32 v8, 134, v8
  v_max_i32 v8, 0, v8
  v_cvt_u32_f32 v7, v7
  v_lshrrev_b32 v7, v8, v7
  v_lshl_add_u32 v7, v8, 8, v7
  v_lshl_add_u32 v222, v7, 2, s18
  v_subrev_u32 v6, 23, v5
  v_max_i32 v7, 0, v6
  v_cvt_f32_u32 v7, v7
  v_cvt_pk_bf16_f32 v8, v7, v7
  v_and_b32 v7, 0xffff0000, v8
  v_lshrrev_b32 v8, 23, v7
  v_subrev_u32 v8, 134, v8
  v_max_i32 v8, 0, v8
  v_cvt_u32_f32 v7, v7
  v_lshrrev_b32 v7, v8, v7
  v_lshl_add_u32 v7, v8, 8, v7
  v_lshl_add_u32 v223, v7, 2, s18
  v_subrev_u32 v6, 24, v5
  v_max_i32 v7, 0, v6
  v_cvt_f32_u32 v7, v7
  v_cvt_pk_bf16_f32 v8, v7, v7
  v_and_b32 v7, 0xffff0000, v8
  v_lshrrev_b32 v8, 23, v7
  v_subrev_u32 v8, 134, v8
  v_max_i32 v8, 0, v8
  v_cvt_u32_f32 v7, v7
  v_lshrrev_b32 v7, v8, v7
  v_lshl_add_u32 v7, v8, 8, v7
  v_lshl_add_u32 v224, v7, 2, s18
  v_subrev_u32 v6, 25, v5
  v_max_i32 v7, 0, v6
  v_cvt_f32_u32 v7, v7
  v_cvt_pk_bf16_f32 v8, v7, v7
  v_and_b32 v7, 0xffff0000, v8
  v_lshrrev_b32 v8, 23, v7
  v_subrev_u32 v8, 134, v8
  v_max_i32 v8, 0, v8
  v_cvt_u32_f32 v7, v7
  v_lshrrev_b32 v7, v8, v7
  v_lshl_add_u32 v7, v8, 8, v7
  v_lshl_add_u32 v225, v7, 2, s18
  v_subrev_u32 v6, 26, v5
  v_max_i32 v7, 0, v6
  v_cvt_f32_u32 v7, v7
  v_cvt_pk_bf16_f32 v8, v7, v7
  v_and_b32 v7, 0xffff0000, v8
  v_lshrrev_b32 v8, 23, v7
  v_subrev_u32 v8, 134, v8
  v_max_i32 v8, 0, v8
  v_cvt_u32_f32 v7, v7
  v_lshrrev_b32 v7, v8, v7
  v_lshl_add_u32 v7, v8, 8, v7
  v_lshl_add_u32 v226, v7, 2, s18
  v_subrev_u32 v6, 27, v5
  v_max_i32 v7, 0, v6
  v_cvt_f32_u32 v7, v7
  v_cvt_pk_bf16_f32 v8, v7, v7
  v_and_b32 v7, 0xffff0000, v8
  v_lshrrev_b32 v8, 23, v7
  v_subrev_u32 v8, 134, v8
  v_max_i32 v8, 0, v8
  v_cvt_u32_f32 v7, v7
  v_lshrrev_b32 v7, v8, v7
  v_lshl_add_u32 v7, v8, 8, v7
  v_lshl_add_u32 v227, v7, 2, s18
  v_subrev_u32 v6, 28, v5
  v_max_i32 v7, 0, v6
  v_cvt_f32_u32 v7, v7
  v_cvt_pk_bf16_f32 v8, v7, v7
  v_and_b32 v7, 0xffff0000, v8
  v_lshrrev_b32 v8, 23, v7
  v_subrev_u32 v8, 134, v8
  v_max_i32 v8, 0, v8
  v_cvt_u32_f32 v7, v7
  v_lshrrev_b32 v7, v8, v7
  v_lshl_add_u32 v7, v8, 8, v7
  v_lshl_add_u32 v228, v7, 2, s18
  v_subrev_u32 v6, 29, v5
  v_max_i32 v7, 0, v6
  v_cvt_f32_u32 v7, v7
  v_cvt_pk_bf16_f32 v8, v7, v7
  v_and_b32 v7, 0xffff0000, v8
  v_lshrrev_b32 v8, 23, v7
  v_subrev_u32 v8, 134, v8
  v_max_i32 v8, 0, v8
  v_cvt_u32_f32 v7, v7
  v_lshrrev_b32 v7, v8, v7
  v_lshl_add_u32 v7, v8, 8, v7
  v_lshl_add_u32 v229, v7, 2, s18
  v_subrev_u32 v6, 30, v5
  v_max_i32 v7, 0, v6
  v_cvt_f32_u32 v7, v7
  v_cvt_pk_bf16_f32 v8, v7, v7
  v_and_b32 v7, 0xffff0000, v8
  v_lshrrev_b32 v8, 23, v7
  v_subrev_u32 v8, 134, v8
  v_max_i32 v8, 0, v8
  v_cvt_u32_f32 v7, v7
  v_lshrrev_b32 v7, v8, v7
  v_lshl_add_u32 v7, v8, 8, v7
  v_lshl_add_u32 v230, v7, 2, s18
  v_subrev_u32 v6, 31, v5
  v_max_i32 v7, 0, v6
  v_cvt_f32_u32 v7, v7
  v_cvt_pk_bf16_f32 v8, v7, v7
  v_and_b32 v7, 0xffff0000, v8
  v_lshrrev_b32 v8, 23, v7
  v_subrev_u32 v8, 134, v8
  v_max_i32 v8, 0, v8
  v_cvt_u32_f32 v7, v7
  v_lshrrev_b32 v7, v8, v7
  v_lshl_add_u32 v7, v8, 8, v7
  v_lshl_add_u32 v231, v7, 2, s18
  v_subrev_u32 v6, 32, v5
  v_max_i32 v7, 0, v6
  v_cvt_f32_u32 v7, v7
  v_cvt_pk_bf16_f32 v8, v7, v7
  v_and_b32 v7, 0xffff0000, v8
  v_lshrrev_b32 v8, 23, v7
  v_subrev_u32 v8, 134, v8
  v_max_i32 v8, 0, v8
  v_cvt_u32_f32 v7, v7
  v_lshrrev_b32 v7, v8, v7
  v_lshl_add_u32 v7, v8, 8, v7
  v_mov_b32 v8, 1280
  v_cmp_gt_i32 vcc, 0, v6
  s_nop 1
  v_cndmask_b32 v7, v7, v8, vcc
  v_lshl_add_u32 v232, v7, 2, s18
  v_mov_b32 v8, 0
  v_mov_b32 v9, 0
  v_lshlrev_b32 v5, 3, v1
  v_add_u32 v5, s17, v5
  ds_write_b64 v5, v[8:9]
  v_and_b32 v6, 15, v1
  v_lshlrev_b32 v6, 3, v6
  v_add_u32 v6, s17, v6
  ds_write_b64 v6, v[8:9] offset:8704
  ds_write_b64 v6, v[8:9] offset:12928
  v_mov_b32 v6, s17
  ds_write_b64 v6, v[8:9] offset:18176
  s_lshl_b32 s19, s3, 2
  s_add_u32 s20, s19, s16
  s_lshl_b32 s21, s3, 3
  v_mul_u32_u24 v5, 3584, v0
  s_add_u32 s22, s21, 0
  buffer_load_dwordx2 v[8:9], v5, s[60:63], s22 offen offset:0
  buffer_load_dwordx2 v[10:11], v5, s[60:63], s22 offen offset:896
  buffer_load_dwordx2 v[12:13], v5, s[60:63], s22 offen offset:1792
  buffer_load_dwordx2 v[14:15], v5, s[60:63], s22 offen offset:2688
  s_add_u32 s22, s21, 917504
  buffer_load_dwordx2 v[16:17], v5, s[60:63], s22 offen offset:0
  buffer_load_dwordx2 v[18:19], v5, s[60:63], s22 offen offset:896
  buffer_load_dwordx2 v[20:21], v5, s[60:63], s22 offen offset:1792
  buffer_load_dwordx2 v[22:23], v5, s[60:63], s22 offen offset:2688
  s_lshl_b32 s22, s20, 9
  v_lshlrev_b32 v6, 3, v1
  buffer_load_dwordx2 v[24:25], v6, s[64:67], s22 offen
  buffer_load_dwordx2 v[26:27], v6, s[68:71], s22 offen
  buffer_load_dwordx2 v[28:29], v6, s[72:75], s22 offen
  buffer_load_dwordx2 v[30:31], v6, s[76:79], s22 offen
  s_lshl_b32 s22, s20, 1
  v_mov_b32 v7, 0
  buffer_load_ushort v32, v7, s[80:83], s22 offen
  buffer_load_ushort v33, v7, s[84:87], s22 offen
  s_mov_b32 s24, 0x05040100
  s_mov_b32 s25, 0x07060302
  s_barrier
  s_waitcnt vmcnt(6)
  v_lshlrev_b32 v6, 3, v0
  v_perm_b32 v34, v10, v8, s24
  v_perm_b32 v35, v14, v12, s24
  v_add_u32 v36, 512, v6
  ds_write_b64 v36, v[34:35]
  v_perm_b32 v34, v10, v8, s25
  v_perm_b32 v35, v14, v12, s25
  v_add_u32 v36, 25088, v6
  ds_write_b64 v36, v[34:35]
  v_perm_b32 v34, v11, v9, s24
  v_perm_b32 v35, v15, v13, s24
  v_add_u32 v36, 49664, v6
  ds_write_b64 v36, v[34:35]
  v_perm_b32 v34, v11, v9, s25
  v_perm_b32 v35, v15, v13, s25
  v_add_u32 v36, 74240, v6
  ds_write_b64 v36, v[34:35]
  v_perm_b32 v34, v18, v16, s24
  v_perm_b32 v35, v22, v20, s24
  v_add_u32 v36, 2560, v6
  ds_write_b64 v36, v[34:35]
  v_perm_b32 v34, v18, v16, s25
  v_perm_b32 v35, v22, v20, s25
  v_add_u32 v36, 27136, v6
  ds_write_b64 v36, v[34:35]
  v_perm_b32 v34, v19, v17, s24
  v_perm_b32 v35, v23, v21, s24
  v_add_u32 v36, 51712, v6
  ds_write_b64 v36, v[34:35]
  v_perm_b32 v34, v19, v17, s25
  v_perm_b32 v35, v23, v21, s25
  v_add_u32 v36, 76288, v6
  ds_write_b64 v36, v[34:35]
  s_waitcnt vmcnt(0)
  s_mov_b32 s26, 1069066811
  s_mov_b32 s27, 1042479491
  v_lshlrev_b32 v32, 16, v32
  v_lshlrev_b32 v33, 16, v33
  v_mul_f32 v32, s26, v32
  v_exp_f32 v32, v32
  s_nop 0
  v_cvt_pk_bf16_f32 v34, v32, v32
  v_and_b32 v32, 0xffff0000, v34
  v_lshlrev_b32 v37, 6, v1
  v_add_u32 v37, s17, v37
  v_lshlrev_b32 v40, 16, v24
  v_lshlrev_b32 v41, 16, v26
  v_lshlrev_b32 v42, 16, v28
  v_lshlrev_b32 v43, 16, v30
  v_mul_f32 v40, s26, v40
  v_exp_f32 v40, v40
  s_nop 0
  v_cvt_pk_bf16_f32 v34, v40, v40
  v_and_b32 v40, 0xffff0000, v34
  v_mul_f32 v40, v40, v32
  v_mul_f32 v40, s26, v40
  v_sub_f32 v40, 0, v40
  v_mul_f32 v41, v41, v32
  v_mul_f32 v41, s27, v41
  v_mul_f32 v42, v42, v32
  v_mul_f32 v43, v43, v32
  v_add_f32 v42, v42, v42
  v_add_f32 v43, v43, v43
  ds_write_b128 v37, v[40:43] offset:18240
  v_and_b32 v40, 0xffff0000, v24
  v_and_b32 v41, 0xffff0000, v26
  v_and_b32 v42, 0xffff0000, v28
  v_and_b32 v43, 0xffff0000, v30
  v_mul_f32 v40, s26, v40
  v_exp_f32 v40, v40
  s_nop 0
  v_cvt_pk_bf16_f32 v34, v40, v40
  v_and_b32 v40, 0xffff0000, v34
  v_mul_f32 v40, v40, v32
  v_mul_f32 v40, s26, v40
  v_sub_f32 v40, 0, v40
  v_mul_f32 v41, v41, v32
  v_mul_f32 v41, s27, v41
  v_mul_f32 v42, v42, v32
  v_mul_f32 v43, v43, v32
  v_add_f32 v42, v42, v42
  v_add_f32 v43, v43, v43
  ds_write_b128 v37, v[40:43] offset:18256
  v_lshlrev_b32 v40, 16, v25
  v_lshlrev_b32 v41, 16, v27
  v_lshlrev_b32 v42, 16, v29
  v_lshlrev_b32 v43, 16, v31
  v_mul_f32 v40, s26, v40
  v_exp_f32 v40, v40
  s_nop 0
  v_cvt_pk_bf16_f32 v34, v40, v40
  v_and_b32 v40, 0xffff0000, v34
  v_mul_f32 v40, v40, v32
  v_mul_f32 v40, s26, v40
  v_sub_f32 v40, 0, v40
  v_mul_f32 v41, v41, v32
  v_mul_f32 v41, s27, v41
  v_mul_f32 v42, v42, v32
  v_mul_f32 v43, v43, v32
  v_add_f32 v42, v42, v42
  v_add_f32 v43, v43, v43
  ds_write_b128 v37, v[40:43] offset:18272
  v_and_b32 v40, 0xffff0000, v25
  v_and_b32 v41, 0xffff0000, v27
  v_and_b32 v42, 0xffff0000, v29
  v_and_b32 v43, 0xffff0000, v31
  v_mul_f32 v40, s26, v40
  v_exp_f32 v40, v40
  s_nop 0
  v_cvt_pk_bf16_f32 v34, v40, v40
  v_and_b32 v40, 0xffff0000, v34
  v_mul_f32 v40, v40, v32
  v_mul_f32 v40, s26, v40
  v_sub_f32 v40, 0, v40
  v_mul_f32 v41, v41, v32
  v_mul_f32 v41, s27, v41
  v_mul_f32 v42, v42, v32
  v_mul_f32 v43, v43, v32
  v_add_f32 v42, v42, v42
  v_add_f32 v43, v43, v43
  ds_write_b128 v37, v[40:43] offset:18288
  v_cvt_f32_u32 v44, v4
  v_lshlrev_b32 v45, 4, v4
  v_cvt_f32_u32 v45, v45
  v_lshlrev_b32 v46, 4, v3
  v_add_u32 v46, s17, v46
  v_mov_b32 v48, 0
  v_mov_b32 v49, 0
  v_mov_b32 v50, 0
  v_mov_b32 v51, 0
  v_mov_b32 v52, 0
  v_mov_b32 v53, 0
  v_mov_b32 v54, 0
  v_mov_b32 v55, 0
  v_mov_b32 v56, 0
  v_mov_b32 v57, 0
  v_mov_b32 v58, 0
  v_mov_b32 v59, 0
  v_mov_b32 v60, 0
  v_mov_b32 v61, 0
  v_mov_b32 v62, 0
  v_mov_b32 v63, 0
  v_mov_b32 v64, 0
  v_mov_b32 v65, 0
  v_mov_b32 v66, 0
  v_mov_b32 v67, 0
  s_mov_b32 s28, 0
  s_waitcnt lgkmcnt(0)
  ds_read_b128 v[68:71], v46 offset:18240
wk_kl:
  s_waitcnt lgkmcnt(0)
  v_mov_b32 v72, v68
  v_mov_b32 v73, v69
  v_mov_b32 v74, v70
  v_mov_b32 v75, v71
  v_add_u32 v46, 64, v46
  ds_read_b128 v[68:71], v46 offset:18240
  v_mul_f32 v80, v72, v45
  v_mul_f32 v81, v73, v45
  v_exp_f32 v80, v80
  v_fract_f32 v81, v81
  v_cos_f32 v76, v81
  v_sin_f32 v77, v81
  v_mul_f32 v76, v76, v80
  v_mul_f32 v77, v77, v80
  v_mul_f32 v80, v72, v44
  v_mul_f32 v81, v73, v44
  v_exp_f32 v80, v80
  v_fract_f32 v81, v81
  v_cos_f32 v78, v81
  v_sin_f32 v79, v81
  v_mul_f32 v78, v78, v80
  v_mul_f32 v79, v79, v80
  v_mul_f32 v82, v74, v76
  v_mul_f32 v83, v74, v77
  v_fma_f32 v82, -v75, v77, v82
  v_fma_f32 v83, -v75, v76, -v83
  v_mul_f32 v86, v76, v76
  v_mul_f32 v87, v76, v77
  v_fma_f32 v86, -v77, v77, v86
  v_add_f32 v87, v87, v87
  v_mfma_f32_16x16x4_f32 v[48:51], v82, v78, v[48:51]
  v_mul_f32 v88, v78, v78
  v_mul_f32 v89, v78, v79
  v_fma_f32 v88, -v79, v79, v88
  v_add_f32 v89, v89, v89
  v_mfma_f32_16x16x4_f32 v[48:51], v83, v79, v[48:51]
  v_mul_f32 v84, v74, v86
  v_mul_f32 v85, v74, v87
  v_fma_f32 v84, -v75, v87, v84
  v_fma_f32 v85, -v75, v86, -v85
  v_mul_f32 v76, v86, v86
  v_mul_f32 v77, v86, v87
  v_fma_f32 v76, -v87, v87, v76
  v_add_f32 v77, v77, v77
  v_mfma_f32_16x16x4_f32 v[52:55], v84, v88, v[52:55]
  v_mul_f32 v78, v88, v88
  v_mul_f32 v79, v88, v89
  v_fma_f32 v78, -v89, v89, v78
  v_add_f32 v79, v79, v79
  v_mfma_f32_16x16x4_f32 v[52:55], v85, v89, v[52:55]
  v_mul_f32 v82, v74, v76
  v_mul_f32 v83, v74, v77
  v_fma_f32 v82, -v75, v77, v82
  v_fma_f32 v83, -v75, v76, -v83
  v_mul_f32 v86, v76, v76
  v_mul_f32 v87, v76, v77
  v_fma_f32 v86, -v77, v77, v86
  v_add_f32 v87, v87, v87
  v_mfma_f32_16x16x4_f32 v[56:59], v82, v78, v[56:59]
  v_mul_f32 v88, v78, v78
  v_mul_f32 v89, v78, v79
  v_fma_f32 v88, -v79, v79, v88
  v_add_f32 v89, v89, v89
  v_mfma_f32_16x16x4_f32 v[56:59], v83, v79, v[56:59]
  v_mul_f32 v84, v74, v86
  v_mul_f32 v85, v74, v87
  v_fma_f32 v84, -v75, v87, v84
  v_fma_f32 v85, -v75, v86, -v85
  v_mul_f32 v76, v86, v86
  v_mul_f32 v77, v86, v87
  v_fma_f32 v76, -v87, v87, v76
  v_add_f32 v77, v77, v77
  v_mfma_f32_16x16x4_f32 v[60:63], v84, v88, v[60:63]
  v_mfma_f32_16x16x4_f32 v[60:63], v85, v89, v[60:63]
  v_mul_f32 v82, v74, v76
  v_fma_f32 v82, -v75, v77, v82
  s_nop 1
  v_mfma_f32_16x16x4_f32 v[64:67], v82, v88, v[64:67]
  s_add_u32 s28, s28, 1
  s_cmp_lt_u32 s28, 64
  s_cbranch_scc1 wk_kl
  s_nop 15
  s_nop 3
  v_lshlrev_b32 v46, 8, v3
  v_lshl_add_u32 v46, v4, 2, v46
  v_add_u32 v46, s17, v46
  ds_write_b32 v46, v48 offset:13056
  ds_write_b32 v46, v49 offset:13120
  ds_write_b32 v46, v50 offset:13184
  ds_write_b32 v46, v51 offset:13248
  s_waitcnt lgkmcnt(8)
  ds_write_b32 v46, v52 offset:14080
  ds_write_b32 v46, v53 offset:14144
  ds_write_b32 v46, v54 offset:14208
  ds_write_b32 v46, v55 offset:14272
  s_waitcnt lgkmcnt(8)
  ds_write_b32 v46, v56 offset:15104
  ds_write_b32 v46, v57 offset:15168
  ds_write_b32 v46, v58 offset:15232
  ds_write_b32 v46, v59 offset:15296
  s_waitcnt lgkmcnt(8)
  ds_write_b32 v46, v60 offset:16128
  ds_write_b32 v46, v61 offset:16192
  ds_write_b32 v46, v62 offset:16256
  ds_write_b32 v46, v63 offset:16320
  s_waitcnt lgkmcnt(8)
  ds_write_b32 v46, v64 offset:17152
  ds_write_b32 v46, v65 offset:17216
  ds_write_b32 v46, v66 offset:17280
  ds_write_b32 v46, v67 offset:17344
  s_waitcnt lgkmcnt(8)
  s_waitcnt lgkmcnt(0)
  ds_read_b32 v48, v200
  ds_read_b32 v49, v201
  ds_read_b32 v50, v202
  ds_read_b32 v51, v203
  ds_read_b32 v52, v204
  ds_read_b32 v53, v205
  ds_read_b32 v54, v206
  ds_read_b32 v55, v207
  s_waitcnt lgkmcnt(4)
  ds_read_b32 v56, v208
  ds_read_b32 v57, v209
  ds_read_b32 v58, v210
  ds_read_b32 v59, v211
  ds_read_b32 v60, v212
  ds_read_b32 v61, v213
  ds_read_b32 v62, v214
  ds_read_b32 v63, v215
  s_waitcnt lgkmcnt(4)
  ds_read_b32 v64, v216
  ds_read_b32 v65, v217
  ds_read_b32 v66, v218
  ds_read_b32 v67, v219
  ds_read_b32 v68, v220
  ds_read_b32 v69, v221
  ds_read_b32 v70, v222
  ds_read_b32 v71, v223
  s_waitcnt lgkmcnt(4)
  ds_read_b32 v72, v224
  ds_read_b32 v73, v225
  ds_read_b32 v74, v226
  ds_read_b32 v75, v227
  ds_read_b32 v76, v228
  ds_read_b32 v77, v229
  ds_read_b32 v78, v230
  ds_read_b32 v79, v231
  s_waitcnt lgkmcnt(4)
  ds_read_b32 v80, v232
  s_waitcnt lgkmcnt(0)
  v_lshlrev_b32 v46, 6, v1
  v_add_u32 v46, s17, v46
  v_cvt_pk_bf16_f32 v84, v48, v49
  v_cvt_pk_bf16_f32 v88, v49, v50
  v_cvt_pk_bf16_f32 v85, v50, v51
  v_cvt_pk_bf16_f32 v89, v51, v52
  v_cvt_pk_bf16_f32 v86, v52, v53
  v_cvt_pk_bf16_f32 v90, v53, v54
  v_cvt_pk_bf16_f32 v87, v54, v55
  v_cvt_pk_bf16_f32 v91, v55, v56
  ds_write_b128 v46, v[84:87] offset:4608
  ds_write_b128 v46, v[88:91] offset:8832
  s_waitcnt lgkmcnt(0)
  v_cvt_pk_bf16_f32 v84, v56, v57
  v_cvt_pk_bf16_f32 v88, v57, v58
  v_cvt_pk_bf16_f32 v85, v58, v59
  v_cvt_pk_bf16_f32 v89, v59, v60
  v_cvt_pk_bf16_f32 v86, v60, v61
  v_cvt_pk_bf16_f32 v90, v61, v62
  v_cvt_pk_bf16_f32 v87, v62, v63
  v_cvt_pk_bf16_f32 v91, v63, v64
  ds_write_b128 v46, v[84:87] offset:4624
  ds_write_b128 v46, v[88:91] offset:8848
  s_waitcnt lgkmcnt(0)
  v_cvt_pk_bf16_f32 v84, v64, v65
  v_cvt_pk_bf16_f32 v88, v65, v66
  v_cvt_pk_bf16_f32 v85, v66, v67
  v_cvt_pk_bf16_f32 v89, v67, v68
  v_cvt_pk_bf16_f32 v86, v68, v69
  v_cvt_pk_bf16_f32 v90, v69, v70
  v_cvt_pk_bf16_f32 v87, v70, v71
  v_cvt_pk_bf16_f32 v91, v71, v72
  ds_write_b128 v46, v[84:87] offset:4640
  ds_write_b128 v46, v[88:91] offset:8864
  s_waitcnt lgkmcnt(0)
  v_cvt_pk_bf16_f32 v84, v72, v73
  v_cvt_pk_bf16_f32 v88, v73, v74
  v_cvt_pk_bf16_f32 v85, v74, v75
  v_cvt_pk_bf16_f32 v89, v75, v76
  v_cvt_pk_bf16_f32 v86, v76, v77
  v_cvt_pk_bf16_f32 v90, v77, v78
  v_cvt_pk_bf16_f32 v87, v78, v79
  v_cvt_pk_bf16_f32 v91, v79, v80
  ds_write_b128 v46, v[84:87] offset:4656
  ds_write_b128 v46, v[88:91] offset:8880
  s_waitcnt lgkmcnt(0)
  s_barrier
  v_lshrrev_b32 v47, 1, v3
  v_sub_u32 v46, v4, v47
  v_add_u32 v46, 1, v46
  v_lshlrev_b32 v46, 5, v46
  v_and_b32 v48, 1, v3
  v_lshl_add_u32 v46, v48, 4, v46
  v_add_u32 v46, s17, v46
  ds_read_b128 a[0:3], v46 offset:32
  ds_read_b128 a[4:7], v46 offset:96
  ds_read_b128 a[8:11], v46 offset:160
  ds_read_b128 a[12:15], v46 offset:224
  ds_read_b128 a[16:19], v46 offset:288
  ds_read_b128 a[20:23], v46 offset:352
  ds_read_b128 a[24:27], v46 offset:416
  ds_read_b128 a[28:31], v46 offset:480
  s_waitcnt lgkmcnt(4)
  ds_read_b128 a[32:35], v46 offset:544
  ds_read_b128 a[36:39], v46 offset:608
  ds_read_b128 a[40:43], v46 offset:672
  ds_read_b128 a[44:47], v46 offset:736
  ds_read_b128 a[48:51], v46 offset:800
  ds_read_b128 a[52:55], v46 offset:864
  ds_read_b128 a[56:59], v46 offset:928
  ds_read_b128 a[60:63], v46 offset:992
  s_waitcnt lgkmcnt(4)
  ds_read_b128 a[64:67], v46 offset:1056
  ds_read_b128 a[68:71], v46 offset:1120
  ds_read_b128 a[72:75], v46 offset:1184
  ds_read_b128 a[76:79], v46 offset:1248
  ds_read_b128 a[80:83], v46 offset:1312
  ds_read_b128 a[84:87], v46 offset:1376
  ds_read_b128 a[88:91], v46 offset:1440
  ds_read_b128 a[92:95], v46 offset:1504
  s_waitcnt lgkmcnt(4)
  ds_read_b128 a[96:99], v46 offset:1568
  ds_read_b128 a[100:103], v46 offset:1632
  ds_read_b128 a[104:107], v46 offset:1696
  ds_read_b128 a[108:111], v46 offset:1760
  ds_read_b128 a[112:115], v46 offset:1824
  ds_read_b128 a[116:119], v46 offset:1888
  ds_read_b128 a[120:123], v46 offset:1952
  ds_read_b128 a[124:127], v46 offset:2016
  s_waitcnt lgkmcnt(4)
  ds_read_b128 a[128:131], v46 offset:2080
  ds_read_b128 a[132:135], v46 offset:2144
  ds_read_b128 a[136:139], v46 offset:2208
  ds_read_b128 a[140:143], v46 offset:2272
  ds_read_b128 a[144:147], v46 offset:2336
  ds_read_b128 a[148:151], v46 offset:2400
  ds_read_b128 a[152:155], v46 offset:2464
  ds_read_b128 a[156:159], v46 offset:2528
  s_waitcnt lgkmcnt(4)
  ds_read_b128 a[160:163], v46 offset:2592
  ds_read_b128 a[164:167], v46 offset:2656
  ds_read_b128 a[168:171], v46 offset:2720
  ds_read_b128 a[172:175], v46 offset:2784
  ds_read_b128 a[176:179], v46 offset:2848
  ds_read_b128 a[180:183], v46 offset:2912
  ds_read_b128 a[184:187], v46 offset:2976
  ds_read_b128 a[188:191], v46 offset:3040
  s_waitcnt lgkmcnt(4)
  ds_read_b128 a[192:195], v46 offset:3104
  ds_read_b128 a[196:199], v46 offset:3168
  ds_read_b128 a[200:203], v46 offset:3232
  ds_read_b128 a[204:207], v46 offset:3296
  ds_read_b128 a[208:211], v46 offset:3360
  ds_read_b128 a[212:215], v46 offset:3424
  ds_read_b128 a[216:219], v46 offset:3488
  ds_read_b128 a[220:223], v46 offset:3552
  s_waitcnt lgkmcnt(4)
  ds_read_b128 a[224:227], v46 offset:3616
  ds_read_b128 a[228:231], v46 offset:3680
  ds_read_b128 a[232:235], v46 offset:3744
  ds_read_b128 a[236:239], v46 offset:3808
  ds_read_b128 a[240:243], v46 offset:3872
  ds_read_b128 a[244:247], v46 offset:3936
  ds_read_b128 a[248:251], v46 offset:4000
  ds_read_b128 a[252:255], v46 offset:4064
  s_waitcnt lgkmcnt(4)
  v_lshlrev_b32 v49, 4, v47
  v_add_u32 v49, v49, v4
  v_sub_u32 v49, 2047, v49
  v_lshl_add_u32 v49, v48, 3, v49
  v_and_b32 v50, 1, v49
  v_lshrrev_b32 v49, 1, v49
  v_lshlrev_b32 v49, 2, v49
  v_mul_u32_u24 v50, 4224, v50
  v_add3_u32 v49, v49, v50, s17
  v_add_u32 v49, 4608, v49
  v_subrev_u32 v52, 896, v49
  v_subrev_u32 v53, 1856, v49
  v_subrev_u32 v54, 2816, v49
  v_subrev_u32 v55, 3776, v49
  v_subrev_u32 v56, 4736, v49
  s_waitcnt lgkmcnt(0)
  ds_read2_b32 v[92:93], v52 offset0:224 offset1:225
  ds_read2_b32 v[94:95], v52 offset0:226 offset1:227
  ds_read2_b32 v[96:97], v52 offset0:208 offset1:209
  ds_read2_b32 v[98:99], v52 offset0:210 offset1:211
  ds_read2_b32 v[100:101], v52 offset0:192 offset1:193
  ds_read2_b32 v[102:103], v52 offset0:194 offset1:195
  ds_read2_b32 v[104:105], v52 offset0:176 offset1:177
  ds_read2_b32 v[106:107], v52 offset0:178 offset1:179
  s_waitcnt lgkmcnt(6)
  v_mfma_f32_16x16x32_bf16 v[60:63], v[92:95], a[28:31], 0
  v_mfma_f32_16x16x32_bf16 v[64:67], v[92:95], a[60:63], 0
  v_mfma_f32_16x16x32_bf16 v[68:71], v[92:95], a[92:95], 0
  v_mfma_f32_16x16x32_bf16 v[72:75], v[92:95], a[124:127], 0
  v_mfma_f32_16x16x32_bf16 v[76:79], v[92:95], a[156:159], 0
  v_mfma_f32_16x16x32_bf16 v[80:83], v[92:95], a[188:191], 0
  v_mfma_f32_16x16x32_bf16 v[84:87], v[92:95], a[220:223], 0
  v_mfma_f32_16x16x32_bf16 v[88:91], v[92:95], a[252:255], 0
  ds_read2_b32 v[92:93], v52 offset0:160 offset1:161
  ds_read2_b32 v[94:95], v52 offset0:162 offset1:163
  s_waitcnt lgkmcnt(6)
  v_mfma_f32_16x16x32_bf16 v[60:63], v[96:99], a[24:27], v[60:63]
  v_mfma_f32_16x16x32_bf16 v[64:67], v[96:99], a[56:59], v[64:67]
  v_mfma_f32_16x16x32_bf16 v[68:71], v[96:99], a[88:91], v[68:71]
  v_mfma_f32_16x16x32_bf16 v[72:75], v[96:99], a[120:123], v[72:75]
  v_mfma_f32_16x16x32_bf16 v[76:79], v[96:99], a[152:155], v[76:79]
  v_mfma_f32_16x16x32_bf16 v[80:83], v[96:99], a[184:187], v[80:83]
  v_mfma_f32_16x16x32_bf16 v[84:87], v[96:99], a[216:219], v[84:87]
  v_mfma_f32_16x16x32_bf16 v[88:91], v[96:99], a[248:251], v[88:91]
  ds_read2_b32 v[96:97], v52 offset0:144 offset1:145
  ds_read2_b32 v[98:99], v52 offset0:146 offset1:147
  s_waitcnt lgkmcnt(6)
  v_mfma_f32_16x16x32_bf16 v[60:63], v[100:103], a[20:23], v[60:63]
  v_mfma_f32_16x16x32_bf16 v[64:67], v[100:103], a[52:55], v[64:67]
  v_mfma_f32_16x16x32_bf16 v[68:71], v[100:103], a[84:87], v[68:71]
  v_mfma_f32_16x16x32_bf16 v[72:75], v[100:103], a[116:119], v[72:75]
  v_mfma_f32_16x16x32_bf16 v[76:79], v[100:103], a[148:151], v[76:79]
  v_mfma_f32_16x16x32_bf16 v[80:83], v[100:103], a[180:183], v[80:83]
  v_mfma_f32_16x16x32_bf16 v[84:87], v[100:103], a[212:215], v[84:87]
  v_mfma_f32_16x16x32_bf16 v[88:91], v[100:103], a[244:247], v[88:91]
  ds_read2_b32 v[100:101], v52 offset0:128 offset1:129
  ds_read2_b32 v[102:103], v52 offset0:130 offset1:131
  s_waitcnt lgkmcnt(6)
  v_mfma_f32_16x16x32_bf16 v[60:63], v[104:107], a[16:19], v[60:63]
  v_mfma_f32_16x16x32_bf16 v[64:67], v[104:107], a[48:51], v[64:67]
  v_mfma_f32_16x16x32_bf16 v[68:71], v[104:107], a[80:83], v[68:71]
  v_mfma_f32_16x16x32_bf16 v[72:75], v[104:107], a[112:115], v[72:75]
  v_mfma_f32_16x16x32_bf16 v[76:79], v[104:107], a[144:147], v[76:79]
  v_mfma_f32_16x16x32_bf16 v[80:83], v[104:107], a[176:179], v[80:83]
  v_mfma_f32_16x16x32_bf16 v[84:87], v[104:107], a[208:211], v[84:87]
  v_mfma_f32_16x16x32_bf16 v[88:91], v[104:107], a[240:243], v[88:91]
  ds_read2_b32 v[104:105], v52 offset0:112 offset1:113
  ds_read2_b32 v[106:107], v52 offset0:114 offset1:115
  s_waitcnt lgkmcnt(6)
  v_mfma_f32_16x16x32_bf16 v[60:63], v[92:95], a[12:15], v[60:63]
  v_mfma_f32_16x16x32_bf16 v[64:67], v[92:95], a[44:47], v[64:67]
  v_mfma_f32_16x16x32_bf16 v[68:71], v[92:95], a[76:79], v[68:71]
  v_mfma_f32_16x16x32_bf16 v[72:75], v[92:95], a[108:111], v[72:75]
  v_mfma_f32_16x16x32_bf16 v[76:79], v[92:95], a[140:143], v[76:79]
  v_mfma_f32_16x16x32_bf16 v[80:83], v[92:95], a[172:175], v[80:83]
  v_mfma_f32_16x16x32_bf16 v[84:87], v[92:95], a[204:207], v[84:87]
  v_mfma_f32_16x16x32_bf16 v[88:91], v[92:95], a[236:239], v[88:91]
  ds_read2_b32 v[92:93], v52 offset0:96 offset1:97
  ds_read2_b32 v[94:95], v52 offset0:98 offset1:99
  s_waitcnt lgkmcnt(6)
  v_mfma_f32_16x16x32_bf16 v[60:63], v[96:99], a[8:11], v[60:63]
  v_mfma_f32_16x16x32_bf16 v[64:67], v[96:99], a[40:43], v[64:67]
  v_mfma_f32_16x16x32_bf16 v[68:71], v[96:99], a[72:75], v[68:71]
  v_mfma_f32_16x16x32_bf16 v[72:75], v[96:99], a[104:107], v[72:75]
  v_mfma_f32_16x16x32_bf16 v[76:79], v[96:99], a[136:139], v[76:79]
  v_mfma_f32_16x16x32_bf16 v[80:83], v[96:99], a[168:171], v[80:83]
  v_mfma_f32_16x16x32_bf16 v[84:87], v[96:99], a[200:203], v[84:87]
  v_mfma_f32_16x16x32_bf16 v[88:91], v[96:99], a[232:235], v[88:91]
  ds_read2_b32 v[96:97], v52 offset0:80 offset1:81
  ds_read2_b32 v[98:99], v52 offset0:82 offset1:83
  s_waitcnt lgkmcnt(6)
  v_mfma_f32_16x16x32_bf16 v[60:63], v[100:103], a[4:7], v[60:63]
  v_mfma_f32_16x16x32_bf16 v[64:67], v[100:103], a[36:39], v[64:67]
  v_mfma_f32_16x16x32_bf16 v[68:71], v[100:103], a[68:71], v[68:71]
  v_mfma_f32_16x16x32_bf16 v[72:75], v[100:103], a[100:103], v[72:75]
  v_mfma_f32_16x16x32_bf16 v[76:79], v[100:103], a[132:135], v[76:79]
  v_mfma_f32_16x16x32_bf16 v[80:83], v[100:103], a[164:167], v[80:83]
  v_mfma_f32_16x16x32_bf16 v[84:87], v[100:103], a[196:199], v[84:87]
  v_mfma_f32_16x16x32_bf16 v[88:91], v[100:103], a[228:231], v[88:91]
  ds_read2_b32 v[100:101], v52 offset0:64 offset1:65
  ds_read2_b32 v[102:103], v52 offset0:66 offset1:67
  s_waitcnt lgkmcnt(6)
  v_mfma_f32_16x16x32_bf16 v[60:63], v[104:107], a[0:3], v[60:63]
  v_mfma_f32_16x16x32_bf16 v[64:67], v[104:107], a[32:35], v[64:67]
  v_mfma_f32_16x16x32_bf16 v[68:71], v[104:107], a[64:67], v[68:71]
  v_mfma_f32_16x16x32_bf16 v[72:75], v[104:107], a[96:99], v[72:75]
  v_mfma_f32_16x16x32_bf16 v[76:79], v[104:107], a[128:131], v[76:79]
  v_mfma_f32_16x16x32_bf16 v[80:83], v[104:107], a[160:163], v[80:83]
  v_mfma_f32_16x16x32_bf16 v[84:87], v[104:107], a[192:195], v[84:87]
  v_mfma_f32_16x16x32_bf16 v[88:91], v[104:107], a[224:227], v[88:91]
  ds_read2_b32 v[104:105], v52 offset0:48 offset1:49
  ds_read2_b32 v[106:107], v52 offset0:50 offset1:51
  s_waitcnt lgkmcnt(6)
  v_mfma_f32_16x16x32_bf16 v[64:67], v[92:95], a[28:31], v[64:67]
  v_mfma_f32_16x16x32_bf16 v[68:71], v[92:95], a[60:63], v[68:71]
  v_mfma_f32_16x16x32_bf16 v[72:75], v[92:95], a[92:95], v[72:75]
  v_mfma_f32_16x16x32_bf16 v[76:79], v[92:95], a[124:127], v[76:79]
  v_mfma_f32_16x16x32_bf16 v[80:83], v[92:95], a[156:159], v[80:83]
  v_mfma_f32_16x16x32_bf16 v[84:87], v[92:95], a[188:191], v[84:87]
  v_mfma_f32_16x16x32_bf16 v[88:91], v[92:95], a[220:223], v[88:91]
  ds_read2_b32 v[92:93], v52 offset0:32 offset1:33
  ds_read2_b32 v[94:95], v52 offset0:34 offset1:35
  s_waitcnt lgkmcnt(6)
  v_mfma_f32_16x16x32_bf16 v[64:67], v[96:99], a[24:27], v[64:67]
  v_mfma_f32_16x16x32_bf16 v[68:71], v[96:99], a[56:59], v[68:71]
  v_mfma_f32_16x16x32_bf16 v[72:75], v[96:99], a[88:91], v[72:75]
  v_mfma_f32_16x16x32_bf16 v[76:79], v[96:99], a[120:123], v[76:79]
  v_mfma_f32_16x16x32_bf16 v[80:83], v[96:99], a[152:155], v[80:83]
  v_mfma_f32_16x16x32_bf16 v[84:87], v[96:99], a[184:187], v[84:87]
  v_mfma_f32_16x16x32_bf16 v[88:91], v[96:99], a[216:219], v[88:91]
  ds_read2_b32 v[96:97], v52 offset0:16 offset1:17
  ds_read2_b32 v[98:99], v52 offset0:18 offset1:19
  s_waitcnt lgkmcnt(6)
  v_mfma_f32_16x16x32_bf16 v[64:67], v[100:103], a[20:23], v[64:67]
  v_mfma_f32_16x16x32_bf16 v[68:71], v[100:103], a[52:55], v[68:71]
  v_mfma_f32_16x16x32_bf16 v[72:75], v[100:103], a[84:87], v[72:75]
  v_mfma_f32_16x16x32_bf16 v[76:79], v[100:103], a[116:119], v[76:79]
  v_mfma_f32_16x16x32_bf16 v[80:83], v[100:103], a[148:151], v[80:83]
  v_mfma_f32_16x16x32_bf16 v[84:87], v[100:103], a[180:183], v[84:87]
  v_mfma_f32_16x16x32_bf16 v[88:91], v[100:103], a[212:215], v[88:91]
  ds_read2_b32 v[100:101], v52 offset0:0 offset1:1
  ds_read2_b32 v[102:103], v52 offset0:2 offset1:3
  s_waitcnt lgkmcnt(6)
  v_mfma_f32_16x16x32_bf16 v[64:67], v[104:107], a[16:19], v[64:67]
  v_mfma_f32_16x16x32_bf16 v[68:71], v[104:107], a[48:51], v[68:71]
  v_mfma_f32_16x16x32_bf16 v[72:75], v[104:107], a[80:83], v[72:75]
  v_mfma_f32_16x16x32_bf16 v[76:79], v[104:107], a[112:115], v[76:79]
  v_mfma_f32_16x16x32_bf16 v[80:83], v[104:107], a[144:147], v[80:83]
  v_mfma_f32_16x16x32_bf16 v[84:87], v[104:107], a[176:179], v[84:87]
  v_mfma_f32_16x16x32_bf16 v[88:91], v[104:107], a[208:211], v[88:91]
  ds_read2_b32 v[104:105], v53 offset0:224 offset1:225
  ds_read2_b32 v[106:107], v53 offset0:226 offset1:227
  s_waitcnt lgkmcnt(6)
  v_mfma_f32_16x16x32_bf16 v[64:67], v[92:95], a[12:15], v[64:67]
  v_mfma_f32_16x16x32_bf16 v[68:71], v[92:95], a[44:47], v[68:71]
  v_mfma_f32_16x16x32_bf16 v[72:75], v[92:95], a[76:79], v[72:75]
  v_mfma_f32_16x16x32_bf16 v[76:79], v[92:95], a[108:111], v[76:79]
  v_mfma_f32_16x16x32_bf16 v[80:83], v[92:95], a[140:143], v[80:83]
  v_mfma_f32_16x16x32_bf16 v[84:87], v[92:95], a[172:175], v[84:87]
  v_mfma_f32_16x16x32_bf16 v[88:91], v[92:95], a[204:207], v[88:91]
  ds_read2_b32 v[92:93], v53 offset0:208 offset1:209
  ds_read2_b32 v[94:95], v53 offset0:210 offset1:211
  s_waitcnt lgkmcnt(6)
  v_mfma_f32_16x16x32_bf16 v[64:67], v[96:99], a[8:11], v[64:67]
  v_mfma_f32_16x16x32_bf16 v[68:71], v[96:99], a[40:43], v[68:71]
  v_mfma_f32_16x16x32_bf16 v[72:75], v[96:99], a[72:75], v[72:75]
  v_mfma_f32_16x16x32_bf16 v[76:79], v[96:99], a[104:107], v[76:79]
  v_mfma_f32_16x16x32_bf16 v[80:83], v[96:99], a[136:139], v[80:83]
  v_mfma_f32_16x16x32_bf16 v[84:87], v[96:99], a[168:171], v[84:87]
  v_mfma_f32_16x16x32_bf16 v[88:91], v[96:99], a[200:203], v[88:91]
  ds_read2_b32 v[96:97], v53 offset0:192 offset1:193
  ds_read2_b32 v[98:99], v53 offset0:194 offset1:195
  s_waitcnt lgkmcnt(6)
  v_mfma_f32_16x16x32_bf16 v[64:67], v[100:103], a[4:7], v[64:67]
  v_mfma_f32_16x16x32_bf16 v[68:71], v[100:103], a[36:39], v[68:71]
  v_mfma_f32_16x16x32_bf16 v[72:75], v[100:103], a[68:71], v[72:75]
  v_mfma_f32_16x16x32_bf16 v[76:79], v[100:103], a[100:103], v[76:79]
  v_mfma_f32_16x16x32_bf16 v[80:83], v[100:103], a[132:135], v[80:83]
  v_mfma_f32_16x16x32_bf16 v[84:87], v[100:103], a[164:167], v[84:87]
  v_mfma_f32_16x16x32_bf16 v[88:91], v[100:103], a[196:199], v[88:91]
  ds_read2_b32 v[100:101], v53 offset0:176 offset1:177
  ds_read2_b32 v[102:103], v53 offset0:178 offset1:179
  s_waitcnt lgkmcnt(6)
  v_mfma_f32_16x16x32_bf16 v[64:67], v[104:107], a[0:3], v[64:67]
  v_mfma_f32_16x16x32_bf16 v[68:71], v[104:107], a[32:35], v[68:71]
  v_mfma_f32_16x16x32_bf16 v[72:75], v[104:107], a[64:67], v[72:75]
  v_mfma_f32_16x16x32_bf16 v[76:79], v[104:107], a[96:99], v[76:79]
  v_mfma_f32_16x16x32_bf16 v[80:83], v[104:107], a[128:131], v[80:83]
  v_mfma_f32_16x16x32_bf16 v[84:87], v[104:107], a[160:163], v[84:87]
  v_mfma_f32_16x16x32_bf16 v[88:91], v[104:107], a[192:195], v[88:91]
  ds_read2_b32 v[104:105], v53 offset0:160 offset1:161
  ds_read2_b32 v[106:107], v53 offset0:162 offset1:163
  s_waitcnt lgkmcnt(6)
  v_mfma_f32_16x16x32_bf16 v[68:71], v[92:95], a[28:31], v[68:71]
  v_mfma_f32_16x16x32_bf16 v[72:75], v[92:95], a[60:63], v[72:75]
  v_mfma_f32_16x16x32_bf16 v[76:79], v[92:95], a[92:95], v[76:79]
  v_mfma_f32_16x16x32_bf16 v[80:83], v[92:95], a[124:127], v[80:83]
  v_mfma_f32_16x16x32_bf16 v[84:87], v[92:95], a[156:159], v[84:87]
  v_mfma_f32_16x16x32_bf16 v[88:91], v[92:95], a[188:191], v[88:91]
  ds_read2_b32 v[92:93], v53 offset0:144 offset1:145
  ds_read2_b32 v[94:95], v53 offset0:146 offset1:147
  s_waitcnt lgkmcnt(6)
  v_mfma_f32_16x16x32_bf16 v[68:71], v[96:99], a[24:27], v[68:71]
  v_mfma_f32_16x16x32_bf16 v[72:75], v[96:99], a[56:59], v[72:75]
  v_mfma_f32_16x16x32_bf16 v[76:79], v[96:99], a[88:91], v[76:79]
  v_mfma_f32_16x16x32_bf16 v[80:83], v[96:99], a[120:123], v[80:83]
  v_mfma_f32_16x16x32_bf16 v[84:87], v[96:99], a[152:155], v[84:87]
  v_mfma_f32_16x16x32_bf16 v[88:91], v[96:99], a[184:187], v[88:91]
  ds_read2_b32 v[96:97], v53 offset0:128 offset1:129
  ds_read2_b32 v[98:99], v53 offset0:130 offset1:131
  s_waitcnt lgkmcnt(6)
  v_mfma_f32_16x16x32_bf16 v[68:71], v[100:103], a[20:23], v[68:71]
  v_mfma_f32_16x16x32_bf16 v[72:75], v[100:103], a[52:55], v[72:75]
  v_mfma_f32_16x16x32_bf16 v[76:79], v[100:103], a[84:87], v[76:79]
  v_mfma_f32_16x16x32_bf16 v[80:83], v[100:103], a[116:119], v[80:83]
  v_mfma_f32_16x16x32_bf16 v[84:87], v[100:103], a[148:151], v[84:87]
  v_mfma_f32_16x16x32_bf16 v[88:91], v[100:103], a[180:183], v[88:91]
  ds_read2_b32 v[100:101], v53 offset0:112 offset1:113
  ds_read2_b32 v[102:103], v53 offset0:114 offset1:115
  s_waitcnt lgkmcnt(6)
  v_mfma_f32_16x16x32_bf16 v[68:71], v[104:107], a[16:19], v[68:71]
  v_mfma_f32_16x16x32_bf16 v[72:75], v[104:107], a[48:51], v[72:75]
  v_mfma_f32_16x16x32_bf16 v[76:79], v[104:107], a[80:83], v[76:79]
  v_mfma_f32_16x16x32_bf16 v[80:83], v[104:107], a[112:115], v[80:83]
  v_mfma_f32_16x16x32_bf16 v[84:87], v[104:107], a[144:147], v[84:87]
  v_mfma_f32_16x16x32_bf16 v[88:91], v[104:107], a[176:179], v[88:91]
  ds_read2_b32 v[104:105], v53 offset0:96 offset1:97
  ds_read2_b32 v[106:107], v53 offset0:98 offset1:99
  s_waitcnt lgkmcnt(6)
  v_mfma_f32_16x16x32_bf16 v[68:71], v[92:95], a[12:15], v[68:71]
  v_mfma_f32_16x16x32_bf16 v[72:75], v[92:95], a[44:47], v[72:75]
  v_mfma_f32_16x16x32_bf16 v[76:79], v[92:95], a[76:79], v[76:79]
  v_mfma_f32_16x16x32_bf16 v[80:83], v[92:95], a[108:111], v[80:83]
  v_mfma_f32_16x16x32_bf16 v[84:87], v[92:95], a[140:143], v[84:87]
  v_mfma_f32_16x16x32_bf16 v[88:91], v[92:95], a[172:175], v[88:91]
  ds_read2_b32 v[92:93], v53 offset0:80 offset1:81
  ds_read2_b32 v[94:95], v53 offset0:82 offset1:83
  s_waitcnt lgkmcnt(6)
  v_mfma_f32_16x16x32_bf16 v[68:71], v[96:99], a[8:11], v[68:71]
  v_mfma_f32_16x16x32_bf16 v[72:75], v[96:99], a[40:43], v[72:75]
  v_mfma_f32_16x16x32_bf16 v[76:79], v[96:99], a[72:75], v[76:79]
  v_mfma_f32_16x16x32_bf16 v[80:83], v[96:99], a[104:107], v[80:83]
  v_mfma_f32_16x16x32_bf16 v[84:87], v[96:99], a[136:139], v[84:87]
  v_mfma_f32_16x16x32_bf16 v[88:91], v[96:99], a[168:171], v[88:91]
  ds_read2_b32 v[96:97], v53 offset0:64 offset1:65
  ds_read2_b32 v[98:99], v53 offset0:66 offset1:67
  s_waitcnt lgkmcnt(6)
  v_mfma_f32_16x16x32_bf16 v[68:71], v[100:103], a[4:7], v[68:71]
  v_mfma_f32_16x16x32_bf16 v[72:75], v[100:103], a[36:39], v[72:75]
  v_mfma_f32_16x16x32_bf16 v[76:79], v[100:103], a[68:71], v[76:79]
  v_mfma_f32_16x16x32_bf16 v[80:83], v[100:103], a[100:103], v[80:83]
  v_mfma_f32_16x16x32_bf16 v[84:87], v[100:103], a[132:135], v[84:87]
  v_mfma_f32_16x16x32_bf16 v[88:91], v[100:103], a[164:167], v[88:91]
  ds_read2_b32 v[100:101], v53 offset0:48 offset1:49
  ds_read2_b32 v[102:103], v53 offset0:50 offset1:51
  s_waitcnt lgkmcnt(6)
  v_mfma_f32_16x16x32_bf16 v[68:71], v[104:107], a[0:3], v[68:71]
  v_mfma_f32_16x16x32_bf16 v[72:75], v[104:107], a[32:35], v[72:75]
  v_mfma_f32_16x16x32_bf16 v[76:79], v[104:107], a[64:67], v[76:79]
  v_mfma_f32_16x16x32_bf16 v[80:83], v[104:107], a[96:99], v[80:83]
  v_mfma_f32_16x16x32_bf16 v[84:87], v[104:107], a[128:131], v[84:87]
  v_mfma_f32_16x16x32_bf16 v[88:91], v[104:107], a[160:163], v[88:91]
  ds_read2_b32 v[104:105], v53 offset0:32 offset1:33
  ds_read2_b32 v[106:107], v53 offset0:34 offset1:35
  s_waitcnt lgkmcnt(6)
  v_mfma_f32_16x16x32_bf16 v[72:75], v[92:95], a[28:31], v[72:75]
  v_mfma_f32_16x16x32_bf16 v[76:79], v[92:95], a[60:63], v[76:79]
  v_mfma_f32_16x16x32_bf16 v[80:83], v[92:95], a[92:95], v[80:83]
  v_mfma_f32_16x16x32_bf16 v[84:87], v[92:95], a[124:127], v[84:87]
  v_mfma_f32_16x16x32_bf16 v[88:91], v[92:95], a[156:159], v[88:91]
  ds_read2_b32 v[92:93], v53 offset0:16 offset1:17
  ds_read2_b32 v[94:95], v53 offset0:18 offset1:19
  s_waitcnt lgkmcnt(6)
  v_mfma_f32_16x16x32_bf16 v[72:75], v[96:99], a[24:27], v[72:75]
  v_mfma_f32_16x16x32_bf16 v[76:79], v[96:99], a[56:59], v[76:79]
  v_mfma_f32_16x16x32_bf16 v[80:83], v[96:99], a[88:91], v[80:83]
  v_mfma_f32_16x16x32_bf16 v[84:87], v[96:99], a[120:123], v[84:87]
  v_mfma_f32_16x16x32_bf16 v[88:91], v[96:99], a[152:155], v[88:91]
  ds_read2_b32 v[96:97], v53 offset0:0 offset1:1
  ds_read2_b32 v[98:99], v53 offset0:2 offset1:3
  s_waitcnt lgkmcnt(6)
  v_mfma_f32_16x16x32_bf16 v[72:75], v[100:103], a[20:23], v[72:75]
  v_mfma_f32_16x16x32_bf16 v[76:79], v[100:103], a[52:55], v[76:79]
  v_mfma_f32_16x16x32_bf16 v[80:83], v[100:103], a[84:87], v[80:83]
  v_mfma_f32_16x16x32_bf16 v[84:87], v[100:103], a[116:119], v[84:87]
  v_mfma_f32_16x16x32_bf16 v[88:91], v[100:103], a[148:151], v[88:91]
  ds_read2_b32 v[100:101], v54 offset0:224 offset1:225
  ds_read2_b32 v[102:103], v54 offset0:226 offset1:227
  s_waitcnt lgkmcnt(6)
  v_mfma_f32_16x16x32_bf16 v[72:75], v[104:107], a[16:19], v[72:75]
  v_mfma_f32_16x16x32_bf16 v[76:79], v[104:107], a[48:51], v[76:79]
  v_mfma_f32_16x16x32_bf16 v[80:83], v[104:107], a[80:83], v[80:83]
  v_mfma_f32_16x16x32_bf16 v[84:87], v[104:107], a[112:115], v[84:87]
  v_mfma_f32_16x16x32_bf16 v[88:91], v[104:107], a[144:147], v[88:91]
  ds_read2_b32 v[104:105], v54 offset0:208 offset1:209
  ds_read2_b32 v[106:107], v54 offset0:210 offset1:211
  s_waitcnt lgkmcnt(6)
  v_mfma_f32_16x16x32_bf16 v[72:75], v[92:95], a[12:15], v[72:75]
  v_mfma_f32_16x16x32_bf16 v[76:79], v[92:95], a[44:47], v[76:79]
  v_mfma_f32_16x16x32_bf16 v[80:83], v[92:95], a[76:79], v[80:83]
  v_mfma_f32_16x16x32_bf16 v[84:87], v[92:95], a[108:111], v[84:87]
  v_mfma_f32_16x16x32_bf16 v[88:91], v[92:95], a[140:143], v[88:91]
  ds_read2_b32 v[92:93], v54 offset0:192 offset1:193
  ds_read2_b32 v[94:95], v54 offset0:194 offset1:195
  s_waitcnt lgkmcnt(6)
  v_mfma_f32_16x16x32_bf16 v[72:75], v[96:99], a[8:11], v[72:75]
  v_mfma_f32_16x16x32_bf16 v[76:79], v[96:99], a[40:43], v[76:79]
  v_mfma_f32_16x16x32_bf16 v[80:83], v[96:99], a[72:75], v[80:83]
  v_mfma_f32_16x16x32_bf16 v[84:87], v[96:99], a[104:107], v[84:87]
  v_mfma_f32_16x16x32_bf16 v[88:91], v[96:99], a[136:139], v[88:91]
  ds_read2_b32 v[96:97], v54 offset0:176 offset1:177
  ds_read2_b32 v[98:99], v54 offset0:178 offset1:179
  s_waitcnt lgkmcnt(6)
  v_mfma_f32_16x16x32_bf16 v[72:75], v[100:103], a[4:7], v[72:75]
  v_mfma_f32_16x16x32_bf16 v[76:79], v[100:103], a[36:39], v[76:79]
  v_mfma_f32_16x16x32_bf16 v[80:83], v[100:103], a[68:71], v[80:83]
  v_mfma_f32_16x16x32_bf16 v[84:87], v[100:103], a[100:103], v[84:87]
  v_mfma_f32_16x16x32_bf16 v[88:91], v[100:103], a[132:135], v[88:91]
  ds_read2_b32 v[100:101], v54 offset0:160 offset1:161
  ds_read2_b32 v[102:103], v54 offset0:162 offset1:163
  s_waitcnt lgkmcnt(6)
  v_mfma_f32_16x16x32_bf16 v[72:75], v[104:107], a[0:3], v[72:75]
  v_mfma_f32_16x16x32_bf16 v[76:79], v[104:107], a[32:35], v[76:79]
  v_mfma_f32_16x16x32_bf16 v[80:83], v[104:107], a[64:67], v[80:83]
  v_mfma_f32_16x16x32_bf16 v[84:87], v[104:107], a[96:99], v[84:87]
  v_mfma_f32_16x16x32_bf16 v[88:91], v[104:107], a[128:131], v[88:91]
  ds_read2_b32 v[104:105], v54 offset0:144 offset1:145
  ds_read2_b32 v[106:107], v54 offset0:146 offset1:147
  s_waitcnt lgkmcnt(6)
  v_mfma_f32_16x16x32_bf16 v[76:79], v[92:95], a[28:31], v[76:79]
  v_mfma_f32_16x16x32_bf16 v[80:83], v[92:95], a[60:63], v[80:83]
  v_mfma_f32_16x16x32_bf16 v[84:87], v[92:95], a[92:95], v[84:87]
  v_mfma_f32_16x16x32_bf16 v[88:91], v[92:95], a[124:127], v[88:91]
  ds_read2_b32 v[92:93], v54 offset0:128 offset1:129
  ds_read2_b32 v[94:95], v54 offset0:130 offset1:131
  s_waitcnt lgkmcnt(6)
  v_mfma_f32_16x16x32_bf16 v[76:79], v[96:99], a[24:27], v[76:79]
  v_mfma_f32_16x16x32_bf16 v[80:83], v[96:99], a[56:59], v[80:83]
  v_mfma_f32_16x16x32_bf16 v[84:87], v[96:99], a[88:91], v[84:87]
  v_mfma_f32_16x16x32_bf16 v[88:91], v[96:99], a[120:123], v[88:91]
  ds_read2_b32 v[96:97], v54 offset0:112 offset1:113
  ds_read2_b32 v[98:99], v54 offset0:114 offset1:115
  s_waitcnt lgkmcnt(6)
  v_mfma_f32_16x16x32_bf16 v[76:79], v[100:103], a[20:23], v[76:79]
  v_mfma_f32_16x16x32_bf16 v[80:83], v[100:103], a[52:55], v[80:83]
  v_mfma_f32_16x16x32_bf16 v[84:87], v[100:103], a[84:87], v[84:87]
  v_mfma_f32_16x16x32_bf16 v[88:91], v[100:103], a[116:119], v[88:91]
  ds_read2_b32 v[100:101], v54 offset0:96 offset1:97
  ds_read2_b32 v[102:103], v54 offset0:98 offset1:99
  s_waitcnt lgkmcnt(6)
  v_mfma_f32_16x16x32_bf16 v[76:79], v[104:107], a[16:19], v[76:79]
  v_mfma_f32_16x16x32_bf16 v[80:83], v[104:107], a[48:51], v[80:83]
  v_mfma_f32_16x16x32_bf16 v[84:87], v[104:107], a[80:83], v[84:87]
  v_mfma_f32_16x16x32_bf16 v[88:91], v[104:107], a[112:115], v[88:91]
  ds_read2_b32 v[104:105], v54 offset0:80 offset1:81
  ds_read2_b32 v[106:107], v54 offset0:82 offset1:83
  s_waitcnt lgkmcnt(6)
  v_mfma_f32_16x16x32_bf16 v[76:79], v[92:95], a[12:15], v[76:79]
  v_mfma_f32_16x16x32_bf16 v[80:83], v[92:95], a[44:47], v[80:83]
  v_mfma_f32_16x16x32_bf16 v[84:87], v[92:95], a[76:79], v[84:87]
  v_mfma_f32_16x16x32_bf16 v[88:91], v[92:95], a[108:111], v[88:91]
  ds_read2_b32 v[92:93], v54 offset0:64 offset1:65
  ds_read2_b32 v[94:95], v54 offset0:66 offset1:67
  s_waitcnt lgkmcnt(6)
  v_mfma_f32_16x16x32_bf16 v[76:79], v[96:99], a[8:11], v[76:79]
  v_mfma_f32_16x16x32_bf16 v[80:83], v[96:99], a[40:43], v[80:83]
  v_mfma_f32_16x16x32_bf16 v[84:87], v[96:99], a[72:75], v[84:87]
  v_mfma_f32_16x16x32_bf16 v[88:91], v[96:99], a[104:107], v[88:91]
  ds_read2_b32 v[96:97], v54 offset0:48 offset1:49
  ds_read2_b32 v[98:99], v54 offset0:50 offset1:51
  s_waitcnt lgkmcnt(6)
  v_mfma_f32_16x16x32_bf16 v[76:79], v[100:103], a[4:7], v[76:79]
  v_mfma_f32_16x16x32_bf16 v[80:83], v[100:103], a[36:39], v[80:83]
  v_mfma_f32_16x16x32_bf16 v[84:87], v[100:103], a[68:71], v[84:87]
  v_mfma_f32_16x16x32_bf16 v[88:91], v[100:103], a[100:103], v[88:91]
  ds_read2_b32 v[100:101], v54 offset0:32 offset1:33
  ds_read2_b32 v[102:103], v54 offset0:34 offset1:35
  s_waitcnt lgkmcnt(6)
  v_mfma_f32_16x16x32_bf16 v[76:79], v[104:107], a[0:3], v[76:79]
  v_mfma_f32_16x16x32_bf16 v[80:83], v[104:107], a[32:35], v[80:83]
  v_mfma_f32_16x16x32_bf16 v[84:87], v[104:107], a[64:67], v[84:87]
  v_mfma_f32_16x16x32_bf16 v[88:91], v[104:107], a[96:99], v[88:91]
  ds_read2_b32 v[104:105], v54 offset0:16 offset1:17
  ds_read2_b32 v[106:107], v54 offset0:18 offset1:19
  s_waitcnt lgkmcnt(6)
  v_mfma_f32_16x16x32_bf16 v[80:83], v[92:95], a[28:31], v[80:83]
  v_mfma_f32_16x16x32_bf16 v[84:87], v[92:95], a[60:63], v[84:87]
  v_mfma_f32_16x16x32_bf16 v[88:91], v[92:95], a[92:95], v[88:91]
  ds_read2_b32 v[92:93], v54 offset0:0 offset1:1
  ds_read2_b32 v[94:95], v54 offset0:2 offset1:3
  s_waitcnt lgkmcnt(6)
  v_mfma_f32_16x16x32_bf16 v[80:83], v[96:99], a[24:27], v[80:83]
  v_mfma_f32_16x16x32_bf16 v[84:87], v[96:99], a[56:59], v[84:87]
  v_mfma_f32_16x16x32_bf16 v[88:91], v[96:99], a[88:91], v[88:91]
  ds_read2_b32 v[96:97], v55 offset0:224 offset1:225
  ds_read2_b32 v[98:99], v55 offset0:226 offset1:227
  s_waitcnt lgkmcnt(6)
  v_mfma_f32_16x16x32_bf16 v[80:83], v[100:103], a[20:23], v[80:83]
  v_mfma_f32_16x16x32_bf16 v[84:87], v[100:103], a[52:55], v[84:87]
  v_mfma_f32_16x16x32_bf16 v[88:91], v[100:103], a[84:87], v[88:91]
  ds_read2_b32 v[100:101], v55 offset0:208 offset1:209
  ds_read2_b32 v[102:103], v55 offset0:210 offset1:211
  s_waitcnt lgkmcnt(6)
  v_mfma_f32_16x16x32_bf16 v[80:83], v[104:107], a[16:19], v[80:83]
  v_mfma_f32_16x16x32_bf16 v[84:87], v[104:107], a[48:51], v[84:87]
  v_mfma_f32_16x16x32_bf16 v[88:91], v[104:107], a[80:83], v[88:91]
  ds_read2_b32 v[104:105], v55 offset0:192 offset1:193
  ds_read2_b32 v[106:107], v55 offset0:194 offset1:195
  s_waitcnt lgkmcnt(6)
  v_mfma_f32_16x16x32_bf16 v[80:83], v[92:95], a[12:15], v[80:83]
  v_mfma_f32_16x16x32_bf16 v[84:87], v[92:95], a[44:47], v[84:87]
  v_mfma_f32_16x16x32_bf16 v[88:91], v[92:95], a[76:79], v[88:91]
  ds_read2_b32 v[92:93], v55 offset0:176 offset1:177
  ds_read2_b32 v[94:95], v55 offset0:178 offset1:179
  s_waitcnt lgkmcnt(6)
  v_mfma_f32_16x16x32_bf16 v[80:83], v[96:99], a[8:11], v[80:83]
  v_mfma_f32_16x16x32_bf16 v[84:87], v[96:99], a[40:43], v[84:87]
  v_mfma_f32_16x16x32_bf16 v[88:91], v[96:99], a[72:75], v[88:91]
  ds_read2_b32 v[96:97], v55 offset0:160 offset1:161
  ds_read2_b32 v[98:99], v55 offset0:162 offset1:163
  s_waitcnt lgkmcnt(6)
  v_mfma_f32_16x16x32_bf16 v[80:83], v[100:103], a[4:7], v[80:83]
  v_mfma_f32_16x16x32_bf16 v[84:87], v[100:103], a[36:39], v[84:87]
  v_mfma_f32_16x16x32_bf16 v[88:91], v[100:103], a[68:71], v[88:91]
  ds_read2_b32 v[100:101], v55 offset0:144 offset1:145
  ds_read2_b32 v[102:103], v55 offset0:146 offset1:147
  s_waitcnt lgkmcnt(6)
  v_mfma_f32_16x16x32_bf16 v[80:83], v[104:107], a[0:3], v[80:83]
  v_mfma_f32_16x16x32_bf16 v[84:87], v[104:107], a[32:35], v[84:87]
  v_mfma_f32_16x16x32_bf16 v[88:91], v[104:107], a[64:67], v[88:91]
  ds_read2_b32 v[104:105], v55 offset0:128 offset1:129
  ds_read2_b32 v[106:107], v55 offset0:130 offset1:131
  s_waitcnt lgkmcnt(6)
  v_mfma_f32_16x16x32_bf16 v[84:87], v[92:95], a[28:31], v[84:87]
  v_mfma_f32_16x16x32_bf16 v[88:91], v[92:95], a[60:63], v[88:91]
  ds_read2_b32 v[92:93], v55 offset0:112 offset1:113
  ds_read2_b32 v[94:95], v55 offset0:114 offset1:115
  s_waitcnt lgkmcnt(6)
  v_mfma_f32_16x16x32_bf16 v[84:87], v[96:99], a[24:27], v[84:87]
  v_mfma_f32_16x16x32_bf16 v[88:91], v[96:99], a[56:59], v[88:91]
  ds_read2_b32 v[96:97], v55 offset0:96 offset1:97
  ds_read2_b32 v[98:99], v55 offset0:98 offset1:99
  s_waitcnt lgkmcnt(6)
  v_mfma_f32_16x16x32_bf16 v[84:87], v[100:103], a[20:23], v[84:87]
  v_mfma_f32_16x16x32_bf16 v[88:91], v[100:103], a[52:55], v[88:91]
  ds_read2_b32 v[100:101], v55 offset0:80 offset1:81
  ds_read2_b32 v[102:103], v55 offset0:82 offset1:83
  s_waitcnt lgkmcnt(6)
  v_mfma_f32_16x16x32_bf16 v[84:87], v[104:107], a[16:19], v[84:87]
  v_mfma_f32_16x16x32_bf16 v[88:91], v[104:107], a[48:51], v[88:91]
  ds_read2_b32 v[104:105], v55 offset0:64 offset1:65
  ds_read2_b32 v[106:107], v55 offset0:66 offset1:67
  s_waitcnt lgkmcnt(6)
  v_mfma_f32_16x16x32_bf16 v[84:87], v[92:95], a[12:15], v[84:87]
  v_mfma_f32_16x16x32_bf16 v[88:91], v[92:95], a[44:47], v[88:91]
  ds_read2_b32 v[92:93], v55 offset0:48 offset1:49
  ds_read2_b32 v[94:95], v55 offset0:50 offset1:51
  s_waitcnt lgkmcnt(6)
  v_mfma_f32_16x16x32_bf16 v[84:87], v[96:99], a[8:11], v[84:87]
  v_mfma_f32_16x16x32_bf16 v[88:91], v[96:99], a[40:43], v[88:91]
  ds_read2_b32 v[96:97], v55 offset0:32 offset1:33
  ds_read2_b32 v[98:99], v55 offset0:34 offset1:35
  s_waitcnt lgkmcnt(6)
  v_mfma_f32_16x16x32_bf16 v[84:87], v[100:103], a[4:7], v[84:87]
  v_mfma_f32_16x16x32_bf16 v[88:91], v[100:103], a[36:39], v[88:91]
  ds_read2_b32 v[100:101], v55 offset0:16 offset1:17
  ds_read2_b32 v[102:103], v55 offset0:18 offset1:19
  s_waitcnt lgkmcnt(6)
  v_mfma_f32_16x16x32_bf16 v[84:87], v[104:107], a[0:3], v[84:87]
  v_mfma_f32_16x16x32_bf16 v[88:91], v[104:107], a[32:35], v[88:91]
  ds_read2_b32 v[104:105], v55 offset0:0 offset1:1
  ds_read2_b32 v[106:107], v55 offset0:2 offset1:3
  s_waitcnt lgkmcnt(6)
  v_mfma_f32_16x16x32_bf16 v[88:91], v[92:95], a[28:31], v[88:91]
  ds_read2_b32 v[92:93], v56 offset0:224 offset1:225
  ds_read2_b32 v[94:95], v56 offset0:226 offset1:227
  s_waitcnt lgkmcnt(6)
  v_mfma_f32_16x16x32_bf16 v[88:91], v[96:99], a[24:27], v[88:91]
  ds_read2_b32 v[96:97], v56 offset0:208 offset1:209
  ds_read2_b32 v[98:99], v56 offset0:210 offset1:211
  s_waitcnt lgkmcnt(6)
  v_mfma_f32_16x16x32_bf16 v[88:91], v[100:103], a[20:23], v[88:91]
  ds_read2_b32 v[100:101], v56 offset0:192 offset1:193
  ds_read2_b32 v[102:103], v56 offset0:194 offset1:195
  s_waitcnt lgkmcnt(6)
  v_mfma_f32_16x16x32_bf16 v[88:91], v[104:107], a[16:19], v[88:91]
  ds_read2_b32 v[104:105], v56 offset0:176 offset1:177
  ds_read2_b32 v[106:107], v56 offset0:178 offset1:179
  s_waitcnt lgkmcnt(6)
  v_mfma_f32_16x16x32_bf16 v[88:91], v[92:95], a[12:15], v[88:91]
  s_waitcnt lgkmcnt(4)
  v_mfma_f32_16x16x32_bf16 v[88:91], v[96:99], a[8:11], v[88:91]
  s_waitcnt lgkmcnt(2)
  v_mfma_f32_16x16x32_bf16 v[88:91], v[100:103], a[4:7], v[88:91]
  s_waitcnt lgkmcnt(0)
  v_mfma_f32_16x16x32_bf16 v[88:91], v[104:107], a[0:3], v[88:91]
  v_lshlrev_b32 v46, 5, v4
  v_lshl_add_u32 v46, v3, 3, v46
  v_add_u32 v46, s17, v46
  ds_read_b64 v[108:109], v46 offset:512
  ds_read_b64 v[110:111], v46 offset:1024
  ds_read_b64 v[112:113], v46 offset:1536
  ds_read_b64 v[114:115], v46 offset:2048
  ds_read_b64 v[116:117], v46 offset:2560
  ds_read_b64 v[118:119], v46 offset:3072
  ds_read_b64 v[120:121], v46 offset:3584
  ds_read_b64 v[122:123], v46 offset:4096
  s_waitcnt lgkmcnt(0)
  v_lshlrev_b32 v124, 16, v108
  v_and_b32 v125, 0xffff0000, v108
  v_lshlrev_b32 v126, 16, v109
  v_and_b32 v127, 0xffff0000, v109
  v_mul_f32 v124, v124, v33
  v_mul_f32 v125, v125, v33
  v_mul_f32 v126, v126, v33
  v_mul_f32 v127, v127, v33
  v_cvt_pk_bf16_f32 v128, v124, v125
  v_cvt_pk_bf16_f32 v129, v126, v127
  v_cvt_pk_bf16_f32 v130, v60, v61
  v_cvt_pk_bf16_f32 v131, v62, v63
  v_lshlrev_b32 v124, 16, v128
  v_and_b32 v125, 0xffff0000, v128
  v_lshlrev_b32 v132, 16, v130
  v_and_b32 v133, 0xffff0000, v130
  v_lshlrev_b32 v126, 16, v129
  v_and_b32 v127, 0xffff0000, v129
  v_lshlrev_b32 v134, 16, v131
  v_and_b32 v135, 0xffff0000, v131
  v_add_f32 v124, v124, v132
  v_add_f32 v125, v125, v133
  v_add_f32 v126, v126, v134
  v_add_f32 v127, v127, v135
  v_cvt_pk_bf16_f32 v108, v124, v125
  v_cvt_pk_bf16_f32 v109, v126, v127
  ds_write_b64 v46, v[108:109] offset:512
  v_lshlrev_b32 v124, 16, v110
  v_and_b32 v125, 0xffff0000, v110
  v_lshlrev_b32 v126, 16, v111
  v_and_b32 v127, 0xffff0000, v111
  v_mul_f32 v124, v124, v33
  v_mul_f32 v125, v125, v33
  v_mul_f32 v126, v126, v33
  v_mul_f32 v127, v127, v33
  v_cvt_pk_bf16_f32 v128, v124, v125
  v_cvt_pk_bf16_f32 v129, v126, v127
  v_cvt_pk_bf16_f32 v130, v64, v65
  v_cvt_pk_bf16_f32 v131, v66, v67
  v_lshlrev_b32 v124, 16, v128
  v_and_b32 v125, 0xffff0000, v128
  v_lshlrev_b32 v132, 16, v130
  v_and_b32 v133, 0xffff0000, v130
  v_lshlrev_b32 v126, 16, v129
  v_and_b32 v127, 0xffff0000, v129
  v_lshlrev_b32 v134, 16, v131
  v_and_b32 v135, 0xffff0000, v131
  v_add_f32 v124, v124, v132
  v_add_f32 v125, v125, v133
  v_add_f32 v126, v126, v134
  v_add_f32 v127, v127, v135
  v_cvt_pk_bf16_f32 v110, v124, v125
  v_cvt_pk_bf16_f32 v111, v126, v127
  ds_write_b64 v46, v[110:111] offset:1024
  v_lshlrev_b32 v124, 16, v112
  v_and_b32 v125, 0xffff0000, v112
  v_lshlrev_b32 v126, 16, v113
  v_and_b32 v127, 0xffff0000, v113
  v_mul_f32 v124, v124, v33
  v_mul_f32 v125, v125, v33
  v_mul_f32 v126, v126, v33
  v_mul_f32 v127, v127, v33
  v_cvt_pk_bf16_f32 v128, v124, v125
  v_cvt_pk_bf16_f32 v129, v126, v127
  v_cvt_pk_bf16_f32 v130, v68, v69
  v_cvt_pk_bf16_f32 v131, v70, v71
  v_lshlrev_b32 v124, 16, v128
  v_and_b32 v125, 0xffff0000, v128
  v_lshlrev_b32 v132, 16, v130
  v_and_b32 v133, 0xffff0000, v130
  v_lshlrev_b32 v126, 16, v129
  v_and_b32 v127, 0xffff0000, v129
  v_lshlrev_b32 v134, 16, v131
  v_and_b32 v135, 0xffff0000, v131
  v_add_f32 v124, v124, v132
  v_add_f32 v125, v125, v133
  v_add_f32 v126, v126, v134
  v_add_f32 v127, v127, v135
  v_cvt_pk_bf16_f32 v112, v124, v125
  v_cvt_pk_bf16_f32 v113, v126, v127
  ds_write_b64 v46, v[112:113] offset:1536
  v_lshlrev_b32 v124, 16, v114
  v_and_b32 v125, 0xffff0000, v114
  v_lshlrev_b32 v126, 16, v115
  v_and_b32 v127, 0xffff0000, v115
  v_mul_f32 v124, v124, v33
  v_mul_f32 v125, v125, v33
  v_mul_f32 v126, v126, v33
  v_mul_f32 v127, v127, v33
  v_cvt_pk_bf16_f32 v128, v124, v125
  v_cvt_pk_bf16_f32 v129, v126, v127
  v_cvt_pk_bf16_f32 v130, v72, v73
  v_cvt_pk_bf16_f32 v131, v74, v75
  v_lshlrev_b32 v124, 16, v128
  v_and_b32 v125, 0xffff0000, v128
  v_lshlrev_b32 v132, 16, v130
  v_and_b32 v133, 0xffff0000, v130
  v_lshlrev_b32 v126, 16, v129
  v_and_b32 v127, 0xffff0000, v129
  v_lshlrev_b32 v134, 16, v131
  v_and_b32 v135, 0xffff0000, v131
  v_add_f32 v124, v124, v132
  v_add_f32 v125, v125, v133
  v_add_f32 v126, v126, v134
  v_add_f32 v127, v127, v135
  v_cvt_pk_bf16_f32 v114, v124, v125
  v_cvt_pk_bf16_f32 v115, v126, v127
  ds_write_b64 v46, v[114:115] offset:2048
  v_lshlrev_b32 v124, 16, v116
  v_and_b32 v125, 0xffff0000, v116
  v_lshlrev_b32 v126, 16, v117
  v_and_b32 v127, 0xffff0000, v117
  v_mul_f32 v124, v124, v33
  v_mul_f32 v125, v125, v33
  v_mul_f32 v126, v126, v33
  v_mul_f32 v127, v127, v33
  v_cvt_pk_bf16_f32 v128, v124, v125
  v_cvt_pk_bf16_f32 v129, v126, v127
  v_cvt_pk_bf16_f32 v130, v76, v77
  v_cvt_pk_bf16_f32 v131, v78, v79
  v_lshlrev_b32 v124, 16, v128
  v_and_b32 v125, 0xffff0000, v128
  v_lshlrev_b32 v132, 16, v130
  v_and_b32 v133, 0xffff0000, v130
  v_lshlrev_b32 v126, 16, v129
  v_and_b32 v127, 0xffff0000, v129
  v_lshlrev_b32 v134, 16, v131
  v_and_b32 v135, 0xffff0000, v131
  v_add_f32 v124, v124, v132
  v_add_f32 v125, v125, v133
  v_add_f32 v126, v126, v134
  v_add_f32 v127, v127, v135
  v_cvt_pk_bf16_f32 v116, v124, v125
  v_cvt_pk_bf16_f32 v117, v126, v127
  ds_write_b64 v46, v[116:117] offset:2560
  v_lshlrev_b32 v124, 16, v118
  v_and_b32 v125, 0xffff0000, v118
  v_lshlrev_b32 v126, 16, v119
  v_and_b32 v127, 0xffff0000, v119
  v_mul_f32 v124, v124, v33
  v_mul_f32 v125, v125, v33
  v_mul_f32 v126, v126, v33
  v_mul_f32 v127, v127, v33
  v_cvt_pk_bf16_f32 v128, v124, v125
  v_cvt_pk_bf16_f32 v129, v126, v127
  v_cvt_pk_bf16_f32 v130, v80, v81
  v_cvt_pk_bf16_f32 v131, v82, v83
  v_lshlrev_b32 v124, 16, v128
  v_and_b32 v125, 0xffff0000, v128
  v_lshlrev_b32 v132, 16, v130
  v_and_b32 v133, 0xffff0000, v130
  v_lshlrev_b32 v126, 16, v129
  v_and_b32 v127, 0xffff0000, v129
  v_lshlrev_b32 v134, 16, v131
  v_and_b32 v135, 0xffff0000, v131
  v_add_f32 v124, v124, v132
  v_add_f32 v125, v125, v133
  v_add_f32 v126, v126, v134
  v_add_f32 v127, v127, v135
  v_cvt_pk_bf16_f32 v118, v124, v125
  v_cvt_pk_bf16_f32 v119, v126, v127
  ds_write_b64 v46, v[118:119] offset:3072
  v_lshlrev_b32 v124, 16, v120
  v_and_b32 v125, 0xffff0000, v120
  v_lshlrev_b32 v126, 16, v121
  v_and_b32 v127, 0xffff0000, v121
  v_mul_f32 v124, v124, v33
  v_mul_f32 v125, v125, v33
  v_mul_f32 v126, v126, v33
  v_mul_f32 v127, v127, v33
  v_cvt_pk_bf16_f32 v128, v124, v125
  v_cvt_pk_bf16_f32 v129, v126, v127
  v_cvt_pk_bf16_f32 v130, v84, v85
  v_cvt_pk_bf16_f32 v131, v86, v87
  v_lshlrev_b32 v124, 16, v128
  v_and_b32 v125, 0xffff0000, v128
  v_lshlrev_b32 v132, 16, v130
  v_and_b32 v133, 0xffff0000, v130
  v_lshlrev_b32 v126, 16, v129
  v_and_b32 v127, 0xffff0000, v129
  v_lshlrev_b32 v134, 16, v131
  v_and_b32 v135, 0xffff0000, v131
  v_add_f32 v124, v124, v132
  v_add_f32 v125, v125, v133
  v_add_f32 v126, v126, v134
  v_add_f32 v127, v127, v135
  v_cvt_pk_bf16_f32 v120, v124, v125
  v_cvt_pk_bf16_f32 v121, v126, v127
  ds_write_b64 v46, v[120:121] offset:3584
  v_lshlrev_b32 v124, 16, v122
  v_and_b32 v125, 0xffff0000, v122
  v_lshlrev_b32 v126, 16, v123
  v_and_b32 v127, 0xffff0000, v123
  v_mul_f32 v124, v124, v33
  v_mul_f32 v125, v125, v33
  v_mul_f32 v126, v126, v33
  v_mul_f32 v127, v127, v33
  v_cvt_pk_bf16_f32 v128, v124, v125
  v_cvt_pk_bf16_f32 v129, v126, v127
  v_cvt_pk_bf16_f32 v130, v88, v89
  v_cvt_pk_bf16_f32 v131, v90, v91
  v_lshlrev_b32 v124, 16, v128
  v_and_b32 v125, 0xffff0000, v128
  v_lshlrev_b32 v132, 16, v130
  v_and_b32 v133, 0xffff0000, v130
  v_lshlrev_b32 v126, 16, v129
  v_and_b32 v127, 0xffff0000, v129
  v_lshlrev_b32 v134, 16, v131
  v_and_b32 v135, 0xffff0000, v131
  v_add_f32 v124, v124, v132
  v_add_f32 v125, v125, v133
  v_add_f32 v126, v126, v134
  v_add_f32 v127, v127, v135
  v_cvt_pk_bf16_f32 v122, v124, v125
  v_cvt_pk_bf16_f32 v123, v126, v127
  ds_write_b64 v46, v[122:123] offset:4096
  s_waitcnt lgkmcnt(0)
  s_barrier
  v_lshlrev_b32 v6, 3, v0
  v_mul_u32_u24 v5, 7168, v0
  v_add_u32 v36, 512, v6
  ds_read_b64 v[8:9], v36
  v_add_u32 v36, 25088, v6
  ds_read_b64 v[10:11], v36
  v_add_u32 v36, 49664, v6
  ds_read_b64 v[12:13], v36
  v_add_u32 v36, 74240, v6
  ds_read_b64 v[14:15], v36
  s_waitcnt lgkmcnt(0)
  s_add_u32 s22, s21, 0
  s_add_u32 s23, s22, 3584
  v_perm_b32 v16, v10, v8, s24
  v_perm_b32 v17, v14, v12, s24
  buffer_store_dwordx2 v[16:17], v5, s[88:91], s22 offen offset:0
  v_perm_b32 v18, v10, v8, s25
  v_perm_b32 v19, v14, v12, s25
  buffer_store_dwordx2 v[18:19], v5, s[88:91], s22 offen offset:1792
  v_perm_b32 v20, v11, v9, s24
  v_perm_b32 v21, v15, v13, s24
  buffer_store_dwordx2 v[20:21], v5, s[88:91], s23 offen offset:0
  v_perm_b32 v22, v11, v9, s25
  v_perm_b32 v23, v15, v13, s25
  buffer_store_dwordx2 v[22:23], v5, s[88:91], s23 offen offset:1792
  v_add_u32 v36, 2560, v6
  ds_read_b64 v[8:9], v36
  v_add_u32 v36, 27136, v6
  ds_read_b64 v[10:11], v36
  v_add_u32 v36, 51712, v6
  ds_read_b64 v[12:13], v36
  v_add_u32 v36, 76288, v6
  ds_read_b64 v[14:15], v36
  s_waitcnt lgkmcnt(0)
  s_add_u32 s22, s21, 1835008
  s_add_u32 s23, s22, 3584
  v_perm_b32 v24, v10, v8, s24
  v_perm_b32 v25, v14, v12, s24
  buffer_store_dwordx2 v[24:25], v5, s[88:91], s22 offen offset:0
  v_perm_b32 v26, v10, v8, s25
  v_perm_b32 v27, v14, v12, s25
  buffer_store_dwordx2 v[26:27], v5, s[88:91], s22 offen offset:1792
  v_perm_b32 v28, v11, v9, s24
  v_perm_b32 v29, v15, v13, s24
  buffer_store_dwordx2 v[28:29], v5, s[88:91], s23 offen offset:0
  v_perm_b32 v30, v11, v9, s25
  v_perm_b32 v31, v15, v13, s25
  buffer_store_dwordx2 v[30:31], v5, s[88:91], s23 offen offset:1792
  s_branch wk_loop
wk_tok:
  s_sub_u32 s3, s3, 752
  s_cmp_ge_u32 s3, 512
  s_cbranch_scc1 wk_done
  s_and_b32 s18, s3, 3
  s_lshr_b32 s17, s3, 2
  s_cmp_lt_u32 s17, 8
  s_cbranch_scc1 wk_tokp
  s_sub_u32 s20, s17, 8
  s_sub_u32 s17, s17, 64
  s_cmp_ge_u32 s20, 112
  s_cbranch_scc1 wk_toko
  s_lshr_b32 s17, s20, 1
  s_bitcmp0_b32 s20, 0
  s_cbranch_scc1 wk_toko
  s_add_u32 s17, s17, 8
wk_tokp:
  s_lshl_b32 s20, s18, 2
  s_add_u32 s20, s20, s16
  s_lshl_b32 s21, s17, 4
  s_add_u32 s21, s21, s20
  s_mul_i32 s21, s21, 28672
  s_add_u32 s21, s21, 46399488
  s_mul_i32 s23, s17, 28672
  s_add_u32 s23, s23, 75759616
  s_mul_i32 s24, s17, 7168
  s_add_u32 s24, s24, 65536
  s_lshr_b32 s25, s17, 3
  s_lshl_b32 s25, s25, 4
  s_add_u32 s25, s25, s20
  s_lshl_b32 s25, s25, 7
  s_add_u32 s25, s25, 540672
  v_mov_b32 v60, 0
  s_mov_b32 s30, 0
wp_wf:
  buffer_load_dword v61, v60, s[8:11], s25 offen sc1
  s_waitcnt vmcnt(0)
  v_cmp_ne_u32 vcc, 56, v61
  s_cbranch_vccz wp_wf_ok
  s_sleep 4
  s_cmp_ge_u32 s17, 50
  s_cbranch_scc1 wp_wf_bo
  s_sleep 64
wp_wf_bo:
  s_add_u32 s30, s30, 1
  s_cmp_lt_u32 s30, 2000000
  s_cbranch_scc1 wp_wf
  s_branch wp_abort
wp_wf_ok:
  s_lshl_b32 s25, s17, 1
  s_mul_i32 s25, s25, 20480
  s_add_u32 s25, s25, 86114304
  s_lshl_b32 s26, s20, 10
  s_add_u32 s26, s26, s25
  s_lshl_b32 s27, s18, 10
  s_add_u32 s27, s27, s25
  s_lshl_b32 s28, s16, 8
  s_add_u32 s27, s27, s28
  s_add_u32 s27, s27, 16384
  s_mov_b32 s50, -1
  s_mov_b32 s51, 0
  v_lshlrev_b32 v63, 4, v4
  v_lshl_add_u32 v63, v3, 3, v63
  v_mov_b32 v44, -1
  v_mov_b32 v45, -1
  v_mov_b32 v46, -1
  v_mov_b32 v47, -1
  s_add_u32 s28, s26, 0
  s_add_u32 s29, s27, 0
  buffer_store_dwordx4 v[44:47], v2, s[8:11], s28 offen sc1
  s_mov_b64 exec, s[50:51]
  buffer_store_dwordx2 v[44:45], v63, s[8:11], s29 offen sc1
  s_mov_b64 exec, -1
  s_add_u32 s28, s26, 20480
  s_add_u32 s29, s27, 20480
  buffer_store_dwordx4 v[44:47], v2, s[8:11], s28 offen sc1
  s_mov_b64 exec, s[50:51]
  buffer_store_dwordx2 v[44:45], v63, s[8:11], s29 offen sc1
  s_mov_b64 exec, -1
  s_add_u32 s22, s21, 0
  buffer_load_dwordx4 a[0:3], v2, s[8:11], s22 offen offset:0 sc1
  buffer_load_dwordx4 a[4:7], v2, s[8:11], s22 offen offset:1024 sc1
  buffer_load_dwordx4 a[8:11], v2, s[8:11], s22 offen offset:2048 sc1
  buffer_load_dwordx4 a[12:15], v2, s[8:11], s22 offen offset:3072 sc1
  s_add_u32 s22, s21, 4096
  buffer_load_dwordx4 a[16:19], v2, s[8:11], s22 offen offset:0 sc1
  buffer_load_dwordx4 a[20:23], v2, s[8:11], s22 offen offset:1024 sc1
  buffer_load_dwordx4 a[24:27], v2, s[8:11], s22 offen offset:2048 sc1
  buffer_load_dwordx4 a[28:31], v2, s[8:11], s22 offen offset:3072 sc1
  s_add_u32 s22, s21, 8192
  buffer_load_dwordx4 a[32:35], v2, s[8:11], s22 offen offset:0 sc1
  buffer_load_dwordx4 a[36:39], v2, s[8:11], s22 offen offset:1024 sc1
  buffer_load_dwordx4 a[40:43], v2, s[8:11], s22 offen offset:2048 sc1
  buffer_load_dwordx4 a[44:47], v2, s[8:11], s22 offen offset:3072 sc1
  s_add_u32 s22, s21, 12288
  buffer_load_dwordx4 a[48:51], v2, s[8:11], s22 offen offset:0 sc1
  buffer_load_dwordx4 a[52:55], v2, s[8:11], s22 offen offset:1024 sc1
  buffer_load_dwordx4 a[56:59], v2, s[8:11], s22 offen offset:2048 sc1
  buffer_load_dwordx4 a[60:63], v2, s[8:11], s22 offen offset:3072 sc1
  s_add_u32 s22, s21, 16384
  buffer_load_dwordx4 a[64:67], v2, s[8:11], s22 offen offset:0 sc1
  buffer_load_dwordx4 a[68:71], v2, s[8:11], s22 offen offset:1024 sc1
  buffer_load_dwordx4 a[72:75], v2, s[8:11], s22 offen offset:2048 sc1
  buffer_load_dwordx4 a[76:79], v2, s[8:11], s22 offen offset:3072 sc1
  s_add_u32 s22, s21, 20480
  buffer_load_dwordx4 a[80:83], v2, s[8:11], s22 offen offset:0 sc1
  buffer_load_dwordx4 a[84:87], v2, s[8:11], s22 offen offset:1024 sc1
  buffer_load_dwordx4 a[88:91], v2, s[8:11], s22 offen offset:2048 sc1
  buffer_load_dwordx4 a[92:95], v2, s[8:11], s22 offen offset:3072 sc1
  s_add_u32 s22, s21, 24576
  buffer_load_dwordx4 a[96:99], v2, s[8:11], s22 offen offset:0 sc1
  buffer_load_dwordx4 a[100:103], v2, s[8:11], s22 offen offset:1024 sc1
  buffer_load_dwordx4 a[104:107], v2, s[8:11], s22 offen offset:2048 sc1
  buffer_load_dwordx4 a[108:111], v2, s[8:11], s22 offen offset:3072 sc1
  s_add_u32 s22, s23, 0
  buffer_load_dwordx4 a[112:115], v2, s[8:11], s22 offen offset:0 sc1
  buffer_load_dwordx4 a[116:119], v2, s[8:11], s22 offen offset:1024 sc1
  buffer_load_dwordx4 a[120:123], v2, s[8:11], s22 offen offset:2048 sc1
  buffer_load_dwordx4 a[124:127], v2, s[8:11], s22 offen offset:3072 sc1
  s_add_u32 s22, s23, 4096
  buffer_load_dwordx4 a[128:131], v2, s[8:11], s22 offen offset:0 sc1
  buffer_load_dwordx4 a[132:135], v2, s[8:11], s22 offen offset:1024 sc1
  buffer_load_dwordx4 a[136:139], v2, s[8:11], s22 offen offset:2048 sc1
  buffer_load_dwordx4 a[140:143], v2, s[8:11], s22 offen offset:3072 sc1
  s_add_u32 s22, s23, 8192
  buffer_load_dwordx4 a[144:147], v2, s[8:11], s22 offen offset:0 sc1
  buffer_load_dwordx4 a[148:151], v2, s[8:11], s22 offen offset:1024 sc1
  buffer_load_dwordx4 a[152:155], v2, s[8:11], s22 offen offset:2048 sc1
  buffer_load_dwordx4 a[156:159], v2, s[8:11], s22 offen offset:3072 sc1
  s_add_u32 s22, s23, 12288
  buffer_load_dwordx4 a[160:163], v2, s[8:11], s22 offen offset:0 sc1
  buffer_load_dwordx4 a[164:167], v2, s[8:11], s22 offen offset:1024 sc1
  buffer_load_dwordx4 a[168:171], v2, s[8:11], s22 offen offset:2048 sc1
  buffer_load_dwordx4 a[172:175], v2, s[8:11], s22 offen offset:3072 sc1
  s_add_u32 s22, s23, 16384
  buffer_load_dwordx4 a[176:179], v2, s[8:11], s22 offen offset:0 sc1
  buffer_load_dwordx4 a[180:183], v2, s[8:11], s22 offen offset:1024 sc1
  buffer_load_dwordx4 a[184:187], v2, s[8:11], s22 offen offset:2048 sc1
  buffer_load_dwordx4 a[188:191], v2, s[8:11], s22 offen offset:3072 sc1
  s_add_u32 s22, s23, 20480
  buffer_load_dwordx4 a[192:195], v2, s[8:11], s22 offen offset:0 sc1
  buffer_load_dwordx4 a[196:199], v2, s[8:11], s22 offen offset:1024 sc1
  buffer_load_dwordx4 a[200:203], v2, s[8:11], s22 offen offset:2048 sc1
  buffer_load_dwordx4 a[204:207], v2, s[8:11], s22 offen offset:3072 sc1
  s_add_u32 s22, s23, 24576
  buffer_load_dwordx4 a[208:211], v2, s[8:11], s22 offen offset:0 sc1
  buffer_load_dwordx4 a[212:215], v2, s[8:11], s22 offen offset:1024 sc1
  buffer_load_dwordx4 a[216:219], v2, s[8:11], s22 offen offset:2048 sc1
  buffer_load_dwordx4 a[220:223], v2, s[8:11], s22 offen offset:3072 sc1
  v_lshl_add_u32 v5, v3, 2, 0
  v_cmp_le_u32 s[40:41], v5, v4
  v_lshl_add_u32 v5, v3, 2, 1
  v_cmp_le_u32 s[42:43], v5, v4
  v_lshl_add_u32 v5, v3, 2, 2
  v_cmp_le_u32 s[44:45], v5, v4
  v_lshl_add_u32 v5, v3, 2, 3
  v_cmp_le_u32 s[46:47], v5, v4
  v_cmp_gt_u32 s[48:49], 2, v3
  v_mov_b32 v6, 0xff800000
  s_waitcnt vmcnt(0)
  s_lshl_b32 s25, s17, 7
  s_add_u32 s25, s25, 557056
  v_mov_b32 v5, 1
  v_mov_b32 v7, 0
  s_waitcnt vmcnt(0)
  s_mov_b64 exec, 1
  buffer_atomic_add v5, v7, s[8:11], s25 offen
  s_mov_b64 exec, -1
  v_mfma_f32_16x16x32_bf16 v[8:11], a[112:115], a[0:3], 0
  v_mfma_f32_16x16x32_bf16 v[12:15], a[112:115], a[56:59], 0
  v_mfma_f32_16x16x32_bf16 v[16:19], a[168:171], a[56:59], 0
  v_mfma_f32_16x16x32_bf16 v[8:11], a[116:119], a[4:7], v[8:11]
  v_mfma_f32_16x16x32_bf16 v[12:15], a[116:119], a[60:63], v[12:15]
  v_mfma_f32_16x16x32_bf16 v[16:19], a[172:175], a[60:63], v[16:19]
  v_mfma_f32_16x16x32_bf16 v[8:11], a[120:123], a[8:11], v[8:11]
  v_mfma_f32_16x16x32_bf16 v[12:15], a[120:123], a[64:67], v[12:15]
  v_mfma_f32_16x16x32_bf16 v[16:19], a[176:179], a[64:67], v[16:19]
  v_mfma_f32_16x16x32_bf16 v[8:11], a[124:127], a[12:15], v[8:11]
  v_mfma_f32_16x16x32_bf16 v[12:15], a[124:127], a[68:71], v[12:15]
  v_mfma_f32_16x16x32_bf16 v[16:19], a[180:183], a[68:71], v[16:19]
  v_mfma_f32_16x16x32_bf16 v[8:11], a[128:131], a[16:19], v[8:11]
  v_mfma_f32_16x16x32_bf16 v[12:15], a[128:131], a[72:75], v[12:15]
  v_mfma_f32_16x16x32_bf16 v[16:19], a[184:187], a[72:75], v[16:19]
  v_mfma_f32_16x16x32_bf16 v[8:11], a[132:135], a[20:23], v[8:11]
  v_mfma_f32_16x16x32_bf16 v[12:15], a[132:135], a[76:79], v[12:15]
  v_mfma_f32_16x16x32_bf16 v[16:19], a[188:191], a[76:79], v[16:19]
  v_mfma_f32_16x16x32_bf16 v[8:11], a[136:139], a[24:27], v[8:11]
  v_mfma_f32_16x16x32_bf16 v[12:15], a[136:139], a[80:83], v[12:15]
  v_mfma_f32_16x16x32_bf16 v[16:19], a[192:195], a[80:83], v[16:19]
  v_mfma_f32_16x16x32_bf16 v[8:11], a[140:143], a[28:31], v[8:11]
  v_mfma_f32_16x16x32_bf16 v[12:15], a[140:143], a[84:87], v[12:15]
  v_mfma_f32_16x16x32_bf16 v[16:19], a[196:199], a[84:87], v[16:19]
  v_mfma_f32_16x16x32_bf16 v[8:11], a[144:147], a[32:35], v[8:11]
  v_mfma_f32_16x16x32_bf16 v[12:15], a[144:147], a[88:91], v[12:15]
  v_mfma_f32_16x16x32_bf16 v[16:19], a[200:203], a[88:91], v[16:19]
  v_mfma_f32_16x16x32_bf16 v[8:11], a[148:151], a[36:39], v[8:11]
  v_mfma_f32_16x16x32_bf16 v[12:15], a[148:151], a[92:95], v[12:15]
  v_mfma_f32_16x16x32_bf16 v[16:19], a[204:207], a[92:95], v[16:19]
  v_mfma_f32_16x16x32_bf16 v[8:11], a[152:155], a[40:43], v[8:11]
  v_mfma_f32_16x16x32_bf16 v[12:15], a[152:155], a[96:99], v[12:15]
  v_mfma_f32_16x16x32_bf16 v[16:19], a[208:211], a[96:99], v[16:19]
  v_mfma_f32_16x16x32_bf16 v[8:11], a[156:159], a[44:47], v[8:11]
  v_mfma_f32_16x16x32_bf16 v[12:15], a[156:159], a[100:103], v[12:15]
  v_mfma_f32_16x16x32_bf16 v[16:19], a[212:215], a[100:103], v[16:19]
  v_mfma_f32_16x16x32_bf16 v[8:11], a[160:163], a[48:51], v[8:11]
  v_mfma_f32_16x16x32_bf16 v[12:15], a[160:163], a[104:107], v[12:15]
  v_mfma_f32_16x16x32_bf16 v[16:19], a[216:219], a[104:107], v[16:19]
  v_mfma_f32_16x16x32_bf16 v[8:11], a[164:167], a[52:55], v[8:11]
  v_mfma_f32_16x16x32_bf16 v[12:15], a[164:167], a[108:111], v[12:15]
  v_mfma_f32_16x16x32_bf16 v[16:19], a[220:223], a[108:111], v[16:19]
  s_mul_i32 s22, s20, 448
  s_add_u32 s22, s22, s24
  s_mov_b32 s31, 0
  s_cmp_ge_u32 s17, 63
  s_cselect_b32 s23, 7168, 0
  s_cselect_b32 s29, 1, 0
  s_sub_u32 s22, s22, s23
  v_mov_b32 v62, s22
  s_mov_b32 s30, 0
wp_pm:
  s_cmp_ge_u32 s17, 64
  s_cbranch_scc1 wp_pf
  buffer_load_dword v61, v62, s[8:11], 0 offen sc1
  s_waitcnt vmcnt(0)
  v_subrev_u32 v61, s31, v61
  v_cmp_eq_u32 vcc, -1, v61
  s_cbranch_vccnz wp_pr
wp_pf:
  s_add_u32 s22, s24, 4096
  buffer_load_dwordx4 v[64:67], v2, s[8:11], s24 offen offset:0 sc1
  buffer_load_dwordx4 v[68:71], v2, s[8:11], s24 offen offset:1024 sc1
  buffer_load_dwordx4 v[72:75], v2, s[8:11], s24 offen offset:2048 sc1
  buffer_load_dwordx4 v[76:79], v2, s[8:11], s24 offen offset:3072 sc1
  buffer_load_dwordx4 v[80:83], v2, s[8:11], s22 offen offset:0 sc1
  buffer_load_dwordx4 v[84:87], v2, s[8:11], s22 offen offset:1024 sc1
  buffer_load_dwordx4 v[88:91], v2, s[8:11], s22 offen offset:2048 sc1
  s_waitcnt vmcnt(0)
  v_max_u32 v61, v64, v65
  v_max3_u32 v61, v61, v66, v67
  v_max3_u32 v61, v61, v68, v69
  v_max3_u32 v61, v61, v70, v71
  v_max3_u32 v61, v61, v72, v73
  v_max3_u32 v61, v61, v74, v75
  v_max3_u32 v61, v61, v76, v77
  v_max3_u32 v61, v61, v78, v79
  v_max3_u32 v61, v61, v80, v81
  v_max3_u32 v61, v61, v82, v83
  v_max3_u32 v61, v61, v84, v85
  v_max3_u32 v61, v61, v86, v87
  v_max3_u32 v61, v61, v88, v89
  v_max3_u32 v61, v61, v90, v91
  v_cmp_eq_u32 vcc, -1, v61
  s_cbranch_vccz wp_pk
  s_add_u32 s30, s30, 1
  s_cmp_eq_u32 s29, 0
  s_cbranch_scc1 wp_pr
  s_cmp_lt_u32 s30, 2000000
  s_cbranch_scc1 wp_pf
wp_pr:
  s_sleep 4
  s_cmp_ge_u32 s17, 50
  s_cbranch_scc1 wp_pm_bo
  s_sleep 64
wp_pm_bo:
  s_add_u32 s30, s30, 1
  s_cmp_lt_u32 s30, 2000000
  s_cbranch_scc1 wp_pm
  s_branch wp_abort
wp_pk:
  buffer_load_dword v250, v251, s[8:11], 0 offen sc1
  v_mfma_f32_16x16x32_bf16 v[20:23], v[64:67], a[0:3], 0
  v_mfma_f32_16x16x32_bf16 v[24:27], v[64:67], a[4:7], 0
  v_mfma_f32_16x16x32_bf16 v[28:31], v[64:67], a[56:59], 0
  v_mfma_f32_16x16x32_bf16 v[32:35], v[64:67], a[60:63], 0
  v_mfma_f32_16x16x32_bf16 v[20:23], v[68:71], a[8:11], v[20:23]
  v_mfma_f32_16x16x32_bf16 v[24:27], v[68:71], a[12:15], v[24:27]
  v_mfma_f32_16x16x32_bf16 v[28:31], v[68:71], a[64:67], v[28:31]
  v_mfma_f32_16x16x32_bf16 v[32:35], v[68:71], a[68:71], v[32:35]
  v_mfma_f32_16x16x32_bf16 v[20:23], v[72:75], a[16:19], v[20:23]
  v_mfma_f32_16x16x32_bf16 v[24:27], v[72:75], a[20:23], v[24:27]
  v_mfma_f32_16x16x32_bf16 v[28:31], v[72:75], a[72:75], v[28:31]
  v_mfma_f32_16x16x32_bf16 v[32:35], v[72:75], a[76:79], v[32:35]
  v_mfma_f32_16x16x32_bf16 v[20:23], v[76:79], a[24:27], v[20:23]
  v_mfma_f32_16x16x32_bf16 v[24:27], v[76:79], a[28:31], v[24:27]
  v_mfma_f32_16x16x32_bf16 v[28:31], v[76:79], a[80:83], v[28:31]
  v_mfma_f32_16x16x32_bf16 v[32:35], v[76:79], a[84:87], v[32:35]
  v_mfma_f32_16x16x32_bf16 v[20:23], v[80:83], a[32:35], v[20:23]
  v_mfma_f32_16x16x32_bf16 v[24:27], v[80:83], a[36:39], v[24:27]
  v_mfma_f32_16x16x32_bf16 v[28:31], v[80:83], a[88:91], v[28:31]
  v_mfma_f32_16x16x32_bf16 v[32:35], v[80:83], a[92:95], v[32:35]
  v_mfma_f32_16x16x32_bf16 v[20:23], v[84:87], a[40:43], v[20:23]
  v_mfma_f32_16x16x32_bf16 v[24:27], v[84:87], a[44:47], v[24:27]
  v_mfma_f32_16x16x32_bf16 v[28:31], v[84:87], a[96:99], v[28:31]
  v_mfma_f32_16x16x32_bf16 v[32:35], v[84:87], a[100:103], v[32:35]
  v_mfma_f32_16x16x32_bf16 v[20:23], v[88:91], a[48:51], v[20:23]
  v_mfma_f32_16x16x32_bf16 v[24:27], v[88:91], a[52:55], v[24:27]
  v_mfma_f32_16x16x32_bf16 v[28:31], v[88:91], a[104:107], v[28:31]
  v_mfma_f32_16x16x32_bf16 v[32:35], v[88:91], a[108:111], v[32:35]
  v_cndmask_b32 v8, v6, v8, s[40:41]
  v_cndmask_b32 v9, v6, v9, s[42:43]
  v_cndmask_b32 v10, v6, v10, s[44:45]
  v_cndmask_b32 v11, v6, v11, s[46:47]
  v_cndmask_b32 v20, v24, v20, s[48:49]
  v_cndmask_b32 v21, v25, v21, s[48:49]
  v_cndmask_b32 v22, v26, v22, s[48:49]
  v_cndmask_b32 v23, v27, v23, s[48:49]
  v_mov_b32 v24, v20
  v_mov_b32 v25, v21
  v_mov_b32 v26, v22
  v_mov_b32 v27, v23
  v_permlane32_swap_b32 v20, v24
  v_permlane32_swap_b32 v21, v25
  v_permlane32_swap_b32 v22, v26
  v_permlane32_swap_b32 v23, v27
  v_add_f32 v20, v20, v24
  v_add_f32 v21, v21, v25
  v_add_f32 v22, v22, v26
  v_add_f32 v23, v23, v27
  v_max3_f32 v40, v8, v9, v10
  v_max3_f32 v40, v40, v11, v20
  v_max3_f32 v40, v40, v21, v22
  v_max_f32 v40, v40, v23
  v_mov_b32 v41, v40
  s_nop 1
  v_permlane16_swap_b32 v40, v41
  v_max_f32 v40, v40, v41
  v_mov_b32 v41, v40
  s_nop 1
  v_permlane32_swap_b32 v40, v41
  v_max_f32 v40, v40, v41
  v_sub_f32 v8, v8, v40
  v_sub_f32 v9, v9, v40
  v_sub_f32 v10, v10, v40
  v_sub_f32 v11, v11, v40
  v_sub_f32 v20, v20, v40
  v_sub_f32 v21, v21, v40
  v_sub_f32 v22, v22, v40
  v_sub_f32 v23, v23, v40
  v_exp_f32 v8, v8
  v_exp_f32 v9, v9
  v_exp_f32 v10, v10
  v_exp_f32 v11, v11
  v_exp_f32 v20, v20
  v_exp_f32 v21, v21
  v_exp_f32 v22, v22
  v_exp_f32 v23, v23
  v_add_f32 v42, v20, v21
  v_add_f32 v43, v22, v23
  v_add_f32 v42, v42, v43
  v_mul_f32 v42, 0.5, v42
  v_add_f32 v42, v42, v8
  v_add_f32 v42, v42, v9
  v_add_f32 v42, v42, v10
  v_add_f32 v42, v42, v11
  v_mov_b32 v41, v42
  s_nop 1
  v_permlane16_swap_b32 v42, v41
  v_add_f32 v42, v42, v41
  v_mov_b32 v41, v42
  s_nop 1
  v_permlane32_swap_b32 v42, v41
  v_add_f32 v42, v42, v41
  v_rcp_f32 v42, v42
  s_nop 0
  v_mul_f32 v8, v8, v42
  v_mul_f32 v9, v9, v42
  v_mul_f32 v10, v10, v42
  v_mul_f32 v11, v11, v42
  v_mul_f32 v20, v20, v42
  v_mul_f32 v21, v21, v42
  v_mul_f32 v22, v22, v42
  v_mul_f32 v23, v23, v42
  v_cvt_pk_bf16_f32 v44, v8, 0
  v_cvt_pk_bf16_f32 v45, v9, 0
  v_cvt_pk_bf16_f32 v46, v10, 0
  v_cvt_pk_bf16_f32 v47, v11, 0
  v_cvt_pk_bf16_f32 v48, v20, v21
  v_cvt_pk_bf16_f32 v49, v22, v23
  v_min_u32 v44, -2, v44
  v_min_u32 v45, -2, v45
  v_min_u32 v46, -2, v46
  v_min_u32 v47, -2, v47
  v_min_u32 v48, -2, v48
  v_min_u32 v49, -2, v49
  buffer_store_dwordx4 v[44:47], v2, s[8:11], s26 offen sc1
  s_mov_b64 exec, s[50:51]
  buffer_store_dwordx2 v[48:49], v63, s[8:11], s27 offen sc1
  s_mov_b64 exec, -1
  s_add_u32 s26, s26, 20480
  s_add_u32 s27, s27, 20480
  v_cndmask_b32 v16, v6, v16, s[40:41]
  v_cndmask_b32 v17, v6, v17, s[42:43]
  v_cndmask_b32 v18, v6, v18, s[44:45]
  v_cndmask_b32 v19, v6, v19, s[46:47]
  v_cndmask_b32 v28, v32, v28, s[48:49]
  v_cndmask_b32 v29, v33, v29, s[48:49]
  v_cndmask_b32 v30, v34, v30, s[48:49]
  v_cndmask_b32 v31, v35, v31, s[48:49]
  v_mov_b32 v32, v28
  v_mov_b32 v33, v29
  v_mov_b32 v34, v30
  v_mov_b32 v35, v31
  v_permlane32_swap_b32 v28, v32
  v_permlane32_swap_b32 v29, v33
  v_permlane32_swap_b32 v30, v34
  v_permlane32_swap_b32 v31, v35
  v_add_f32 v28, v28, v32
  v_add_f32 v29, v29, v33
  v_add_f32 v30, v30, v34
  v_add_f32 v31, v31, v35
  v_max3_f32 v40, v12, v13, v14
  v_max3_f32 v40, v40, v15, v16
  v_max3_f32 v40, v40, v17, v18
  v_max3_f32 v40, v40, v19, v28
  v_max3_f32 v40, v40, v29, v30
  v_max_f32 v40, v40, v31
  v_mov_b32 v41, v40
  s_nop 1
  v_permlane16_swap_b32 v40, v41
  v_max_f32 v40, v40, v41
  v_mov_b32 v41, v40
  s_nop 1
  v_permlane32_swap_b32 v40, v41
  v_max_f32 v40, v40, v41
  v_sub_f32 v12, v12, v40
  v_sub_f32 v13, v13, v40
  v_sub_f32 v14, v14, v40
  v_sub_f32 v15, v15, v40
  v_sub_f32 v16, v16, v40
  v_sub_f32 v17, v17, v40
  v_sub_f32 v18, v18, v40
  v_sub_f32 v19, v19, v40
  v_sub_f32 v28, v28, v40
  v_sub_f32 v29, v29, v40
  v_sub_f32 v30, v30, v40
  v_sub_f32 v31, v31, v40
  v_exp_f32 v12, v12
  v_exp_f32 v13, v13
  v_exp_f32 v14, v14
  v_exp_f32 v15, v15
  v_exp_f32 v16, v16
  v_exp_f32 v17, v17
  v_exp_f32 v18, v18
  v_exp_f32 v19, v19
  v_exp_f32 v28, v28
  v_exp_f32 v29, v29
  v_exp_f32 v30, v30
  v_exp_f32 v31, v31
  v_add_f32 v42, v28, v29
  v_add_f32 v43, v30, v31
  v_add_f32 v42, v42, v43
  v_mul_f32 v42, 0.5, v42
  v_add_f32 v42, v42, v12
  v_add_f32 v42, v42, v13
  v_add_f32 v42, v42, v14
  v_add_f32 v42, v42, v15
  v_add_f32 v42, v42, v16
  v_add_f32 v42, v42, v17
  v_add_f32 v42, v42, v18
  v_add_f32 v42, v42, v19
  v_mov_b32 v41, v42
  s_nop 1
  v_permlane16_swap_b32 v42, v41
  v_add_f32 v42, v42, v41
  v_mov_b32 v41, v42
  s_nop 1
  v_permlane32_swap_b32 v42, v41
  v_add_f32 v42, v42, v41
  v_rcp_f32 v42, v42
  s_nop 0
  v_mul_f32 v12, v12, v42
  v_mul_f32 v13, v13, v42
  v_mul_f32 v14, v14, v42
  v_mul_f32 v15, v15, v42
  v_mul_f32 v16, v16, v42
  v_mul_f32 v17, v17, v42
  v_mul_f32 v18, v18, v42
  v_mul_f32 v19, v19, v42
  v_mul_f32 v28, v28, v42
  v_mul_f32 v29, v29, v42
  v_mul_f32 v30, v30, v42
  v_mul_f32 v31, v31, v42
  v_cvt_pk_bf16_f32 v52, v12, v16
  v_cvt_pk_bf16_f32 v53, v13, v17
  v_cvt_pk_bf16_f32 v54, v14, v18
  v_cvt_pk_bf16_f32 v55, v15, v19
  v_cvt_pk_bf16_f32 v56, v28, v29
  v_cvt_pk_bf16_f32 v57, v30, v31
  v_min_u32 v52, -2, v52
  v_min_u32 v53, -2, v53
  v_min_u32 v54, -2, v54
  v_min_u32 v55, -2, v55
  v_min_u32 v56, -2, v56
  v_min_u32 v57, -2, v57
  buffer_store_dwordx4 v[52:55], v2, s[8:11], s26 offen sc1
  s_mov_b64 exec, s[50:51]
  buffer_store_dwordx2 v[56:57], v63, s[8:11], s27 offen sc1
  s_mov_b64 exec, -1
  s_branch wk_loop
wk_toko:
  s_load_dwordx2 s[36:37], s[0:1], 112
  s_waitcnt lgkmcnt(0)
  s_mov_b32 s92, s36
  s_and_b32 s93, s37, 0xffff
  s_mov_b32 s94, 3670016
  s_mov_b32 s95, 0x20000
  s_lshl_b32 s20, s18, 2
  s_add_u32 s20, s20, s16
  s_mul_i32 s24, s20, 65
  s_add_u32 s24, s24, s17
  s_lshl_b32 s24, s24, 13
  s_add_u32 s24, s24, 77602816
  s_mul_i32 s21, s20, 28672
  s_mul_i32 s22, s17, 458752
  s_add_u32 s21, s21, s22
  s_add_u32 s21, s21, 2490368
  s_lshl_b32 s25, s17, 1
  s_mul_i32 s25, s25, 20480
  s_add_u32 s25, s25, 86114304
  v_mov_b32 v5, v2
  v_min_u32 v6, 11, v4
  v_mad_u32_u24 v6, v3, 12, v6
  v_lshlrev_b32 v6, 4, v6
  v_add_u32 v6, 1024, v6
  v_lshrrev_b32 v8, 1, v3
  v_lshl_add_u32 v8, v8, 4, v4
  v_lshlrev_b32 v8, 4, v8
  v_and_b32 v9, 1, v3
  v_lshl_add_u32 v7, v9, 3, v8
  s_lshr_b32 s26, s17, 3
  s_lshl_b32 s26, s26, 4
  s_add_u32 s26, s26, s20
  s_lshl_b32 s26, s26, 7
  s_add_u32 s26, s26, 524288
  v_mov_b32 v60, 0
  s_mov_b32 s30, 0
wo_wv:
  buffer_load_dword v61, v60, s[8:11], s26 offen sc1
  s_waitcnt vmcnt(0)
  v_cmp_ne_u32 vcc, 56, v61
  s_cbranch_vccz wo_wv_ok
  s_sleep 4
  s_cmp_ge_u32 s17, 50
  s_cbranch_scc1 wo_wv_bo
  s_sleep 64
wo_wv_bo:
  s_add_u32 s30, s30, 1
  s_cmp_lt_u32 s30, 2000000
  s_cbranch_scc1 wo_wv
  s_branch wo_abort
wo_wv_ok:
  s_add_u32 s22, s21, 0
  buffer_load_dwordx4 a[0:3], v5, s[8:11], s22 offen offset:0 sc1
  buffer_load_dwordx4 a[4:7], v6, s[8:11], s22 offen offset:0 sc1
  buffer_load_dwordx4 a[8:11], v5, s[8:11], s22 offen offset:1792 sc1
  buffer_load_dwordx4 a[12:15], v6, s[8:11], s22 offen offset:1792 sc1
  s_add_u32 s22, s21, 3584
  buffer_load_dwordx4 a[16:19], v5, s[8:11], s22 offen offset:0 sc1
  buffer_load_dwordx4 a[20:23], v6, s[8:11], s22 offen offset:0 sc1
  buffer_load_dwordx4 a[24:27], v5, s[8:11], s22 offen offset:1792 sc1
  buffer_load_dwordx4 a[28:31], v6, s[8:11], s22 offen offset:1792 sc1
  s_add_u32 s22, s21, 7168
  buffer_load_dwordx4 a[32:35], v5, s[8:11], s22 offen offset:0 sc1
  buffer_load_dwordx4 a[36:39], v6, s[8:11], s22 offen offset:0 sc1
  buffer_load_dwordx4 a[40:43], v5, s[8:11], s22 offen offset:1792 sc1
  buffer_load_dwordx4 a[44:47], v6, s[8:11], s22 offen offset:1792 sc1
  s_add_u32 s22, s21, 10752
  buffer_load_dwordx4 a[48:51], v5, s[8:11], s22 offen offset:0 sc1
  buffer_load_dwordx4 a[52:55], v6, s[8:11], s22 offen offset:0 sc1
  buffer_load_dwordx4 a[56:59], v5, s[8:11], s22 offen offset:1792 sc1
  buffer_load_dwordx4 a[60:63], v6, s[8:11], s22 offen offset:1792 sc1
  s_add_u32 s22, s21, 14336
  buffer_load_dwordx4 a[64:67], v5, s[8:11], s22 offen offset:0 sc1
  buffer_load_dwordx4 a[68:71], v6, s[8:11], s22 offen offset:0 sc1
  buffer_load_dwordx4 a[72:75], v5, s[8:11], s22 offen offset:1792 sc1
  buffer_load_dwordx4 a[76:79], v6, s[8:11], s22 offen offset:1792 sc1
  s_add_u32 s22, s21, 17920
  buffer_load_dwordx4 a[80:83], v5, s[8:11], s22 offen offset:0 sc1
  buffer_load_dwordx4 a[84:87], v6, s[8:11], s22 offen offset:0 sc1
  buffer_load_dwordx4 a[88:91], v5, s[8:11], s22 offen offset:1792 sc1
  buffer_load_dwordx4 a[92:95], v6, s[8:11], s22 offen offset:1792 sc1
  s_add_u32 s22, s21, 21504
  buffer_load_dwordx4 a[96:99], v5, s[8:11], s22 offen offset:0 sc1
  buffer_load_dwordx4 a[100:103], v6, s[8:11], s22 offen offset:0 sc1
  buffer_load_dwordx4 a[104:107], v5, s[8:11], s22 offen offset:1792 sc1
  buffer_load_dwordx4 a[108:111], v6, s[8:11], s22 offen offset:1792 sc1
  s_add_u32 s22, s21, 25088
  buffer_load_dwordx4 a[112:115], v5, s[8:11], s22 offen offset:0 sc1
  buffer_load_dwordx4 a[116:119], v6, s[8:11], s22 offen offset:0 sc1
  buffer_load_dwordx4 a[120:123], v5, s[8:11], s22 offen offset:1792 sc1
  buffer_load_dwordx4 a[124:127], v6, s[8:11], s22 offen offset:1792 sc1
  s_and_b32 s27, s17, 1
  s_cmp_ge_u32 s17, 62
  s_cselect_b32 s27, s17, s27
  s_lshl_b32 s26, s20, 6
  s_add_u32 s26, s26, s27
  s_lshl_b32 s26, s26, 4
  s_add_u32 s26, s26, 565248
  v_lshlrev_b32 v60, 2, v3
  s_mov_b32 s30, 0
wo_wt:
  buffer_load_dword v61, v60, s[8:11], s26 offen sc1
  s_waitcnt vmcnt(0)
  v_cmp_ne_u32 vcc, 1, v61
  s_cbranch_vccz wo_wt_ok
  s_sleep 4
  s_cmp_ge_u32 s17, 50
  s_cbranch_scc1 wo_wt_bo
  s_sleep 64
wo_wt_bo:
  s_add_u32 s30, s30, 1
  s_cmp_lt_u32 s30, 2000000
  s_cbranch_scc1 wo_wt
  s_branch wo_abort
wo_wt_ok:
  v_mul_u32_u24 v9, 1792, v4
  v_lshl_add_u32 v9, v3, 3, v9
  s_lshl_b32 s22, s20, 5
  v_add_u32 v8, s22, v9
  s_mul_i32 s22, s20, 24
  s_add_u32 s22, s22, 512
  v_add_u32 v9, s22, v9
  v_mov_b32 v10, 0x40000000
  v_cmp_eq_u32 vcc, 3, v3
  s_nop 1
  v_cndmask_b32 v9, v9, v10, vcc
  s_mul_i32 s44, s17, 57344
  s_add_u32 s44, s44, 896
  s_add_u32 s45, s44, 28672
  s_lshl_b32 s26, s17, 7
  s_add_u32 s26, s26, 557056
  v_mov_b32 v60, 0
  s_mov_b32 s30, 0
wo_wp:
  buffer_load_dword v61, v60, s[8:11], s26 offen sc1
  s_waitcnt vmcnt(0)
  v_cmp_ne_u32 vcc, 16, v61
  s_cbranch_vccz wo_wp_ok
  s_sleep 4
  s_cmp_ge_u32 s17, 50
  s_cbranch_scc1 wo_wp_bo
  s_sleep 64
wo_wp_bo:
  s_add_u32 s30, s30, 1
  s_cmp_lt_u32 s30, 2000000
  s_cbranch_scc1 wo_wp
  s_branch wo_abort
wo_wp_ok:
  s_lshl_b32 s31, s16, 2
  s_add_u32 s31, s31, s26
  s_lshl_b32 s28, s16, 12
  s_add_u32 s26, s25, s28
  s_add_u32 s27, s26, 20480
  s_lshl_b32 s28, s16, 10
  s_add_u32 s28, s28, s25
  s_add_u32 s28, s28, 16384
  s_add_u32 s29, s28, 20480
  s_add_u32 s23, s24, 4096
  s_mov_b32 s30, 0
  s_sub_u32 s33, s24, 0
  s_cmp_ge_u32 s17, 63
  s_cselect_b32 s31, s33, s26
  s_cselect_b32 s33, s33, s24
wo_ps:
  buffer_load_dword v61, off, s[8:11], s33 sc1
  buffer_load_dword v62, off, s[8:11], s31 sc1
  s_waitcnt vmcnt(0)
  v_max_u32 v61, v61, v62
  v_cmp_eq_u32 vcc, -1, v61
  s_cbranch_vccz wo_pl
  s_sleep 2
  s_cmp_ge_u32 s17, 50
  s_cbranch_scc1 wo_ps_bo
  s_sleep 64
wo_ps_bo:
  s_add_u32 s30, s30, 1
  s_cmp_lt_u32 s30, 2000000
  s_cbranch_scc1 wo_ps
  s_branch wo_abort
wo_pl:
  buffer_load_dword v250, v251, s[8:11], 0 offen sc1
  buffer_load_dwordx4 v[28:31], v2, s[8:11], s24 offen offset:0 sc1
  buffer_load_dwordx4 v[32:35], v2, s[8:11], s24 offen offset:1024 sc1
  buffer_load_dwordx4 v[36:39], v2, s[8:11], s24 offen offset:2048 sc1
  buffer_load_dwordx4 v[40:43], v2, s[8:11], s24 offen offset:3072 sc1
  buffer_load_dwordx4 v[44:47], v2, s[8:11], s23 offen offset:0 sc1
  buffer_load_dwordx4 v[48:51], v2, s[8:11], s23 offen offset:1024 sc1
  buffer_load_dwordx4 v[52:55], v2, s[8:11], s23 offen offset:2048 sc1
  buffer_load_dwordx4 v[56:59], v2, s[8:11], s23 offen offset:3072 sc1
  buffer_load_dwordx4 v[64:67], v2, s[8:11], s26 offen offset:0 sc1
  buffer_load_dwordx4 v[68:71], v2, s[8:11], s26 offen offset:1024 sc1
  buffer_load_dwordx4 v[72:75], v2, s[8:11], s26 offen offset:2048 sc1
  buffer_load_dwordx4 v[76:79], v2, s[8:11], s26 offen offset:3072 sc1
  buffer_load_dwordx4 v[80:83], v2, s[8:11], s28 offen sc1
  buffer_load_dwordx4 v[84:87], v2, s[8:11], s27 offen offset:0 sc1
  buffer_load_dwordx4 v[88:91], v2, s[8:11], s27 offen offset:1024 sc1
  buffer_load_dwordx4 v[92:95], v2, s[8:11], s27 offen offset:2048 sc1
  buffer_load_dwordx4 v[96:99], v2, s[8:11], s27 offen offset:3072 sc1
  buffer_load_dwordx4 v[100:103], v2, s[8:11], s29 offen sc1
  s_waitcnt vmcnt(10)
  v_max_u32 v61, v28, v29
  v_max3_u32 v61, v61, v30, v31
  v_max3_u32 v61, v61, v32, v33
  v_max3_u32 v61, v61, v34, v35
  v_max3_u32 v61, v61, v36, v37
  v_max3_u32 v61, v61, v38, v39
  v_max3_u32 v61, v61, v40, v41
  v_max3_u32 v61, v61, v42, v43
  v_max3_u32 v61, v61, v44, v45
  v_max3_u32 v61, v61, v46, v47
  v_max3_u32 v61, v61, v48, v49
  v_max3_u32 v61, v61, v50, v51
  v_max3_u32 v61, v61, v52, v53
  v_max3_u32 v61, v61, v54, v55
  v_max3_u32 v61, v61, v56, v57
  v_max3_u32 v61, v61, v58, v59
  v_cmp_eq_u32 vcc, -1, v61
  s_cbranch_vccz wo_p2
  s_add_u32 s30, s30, 1
  s_cmp_lt_u32 s30, 2000000
  s_cbranch_scc1 wo_pl
  s_branch wo_abort
wo_p1:
  buffer_load_dwordx4 v[64:67], v2, s[8:11], s26 offen offset:0 sc1
  buffer_load_dwordx4 v[68:71], v2, s[8:11], s26 offen offset:1024 sc1
  buffer_load_dwordx4 v[72:75], v2, s[8:11], s26 offen offset:2048 sc1
  buffer_load_dwordx4 v[76:79], v2, s[8:11], s26 offen offset:3072 sc1
  buffer_load_dwordx4 v[80:83], v2, s[8:11], s28 offen sc1
  buffer_load_dwordx4 v[84:87], v2, s[8:11], s27 offen offset:0 sc1
  buffer_load_dwordx4 v[88:91], v2, s[8:11], s27 offen offset:1024 sc1
  buffer_load_dwordx4 v[92:95], v2, s[8:11], s27 offen offset:2048 sc1
  buffer_load_dwordx4 v[96:99], v2, s[8:11], s27 offen offset:3072 sc1
  buffer_load_dwordx4 v[100:103], v2, s[8:11], s29 offen sc1
wo_p2:
  s_waitcnt vmcnt(0)
  v_max_u32 v61, v64, v65
  v_max3_u32 v61, v61, v66, v67
  v_max3_u32 v61, v61, v68, v69
  v_max3_u32 v61, v61, v70, v71
  v_max3_u32 v61, v61, v72, v73
  v_max3_u32 v61, v61, v74, v75
  v_max3_u32 v61, v61, v76, v77
  v_max3_u32 v61, v61, v78, v79
  v_max3_u32 v61, v61, v80, v81
  v_max3_u32 v61, v61, v82, v83
  v_max3_u32 v61, v61, v84, v85
  v_max3_u32 v61, v61, v86, v87
  v_max3_u32 v61, v61, v88, v89
  v_max3_u32 v61, v61, v90, v91
  v_max3_u32 v61, v61, v92, v93
  v_max3_u32 v61, v61, v94, v95
  v_max3_u32 v61, v61, v96, v97
  v_max3_u32 v61, v61, v98, v99
  v_max3_u32 v61, v61, v100, v101
  v_max3_u32 v61, v61, v102, v103
  v_cmp_eq_u32 vcc, -1, v61
  s_cbranch_vccz wo_p3
  s_add_u32 s30, s30, 1
  s_cmp_lt_u32 s30, 2000000
  s_cbranch_scc1 wo_p1
  s_branch wo_abort
wo_p3:
  s_mul_i32 s22, s16, 10240
  v_add_u32 v62, s22, v2
  ds_write_b128 v62, v[64:67] offset:0
  ds_write_b128 v62, v[68:71] offset:1024
  ds_write_b128 v62, v[72:75] offset:2048
  ds_write_b128 v62, v[76:79] offset:3072
  ds_write_b128 v62, v[80:83] offset:4096
  ds_write_b128 v62, v[84:87] offset:5120
  ds_write_b128 v62, v[88:91] offset:6144
  ds_write_b128 v62, v[92:95] offset:7168
  ds_write_b128 v62, v[96:99] offset:8192
  ds_write_b128 v62, v[100:103] offset:9216
wo_pk:
  s_lshl_b32 s22, s16, 2
  s_add_u32 s22, s22, 49152
  v_mov_b32 v63, s22
  ds_write_b32 v63, v250
  s_waitcnt lgkmcnt(0)
  s_barrier
  v_mov_b32 v63, 49152
  ds_read_b32 v250, v63
  ds_read_b128 v[64:67], v2 offset:0
  ds_read_b128 v[68:71], v2 offset:5120
  ds_read_b128 v[72:75], v2 offset:1024
  ds_read_b128 v[76:79], v2 offset:6144
  ds_read_b128 v[80:83], v2 offset:2048
  ds_read_b128 v[84:87], v2 offset:7168
  ds_read_b128 v[88:91], v2 offset:3072
  ds_read_b128 v[92:95], v2 offset:8192
  s_waitcnt lgkmcnt(7)
  v_mfma_f32_16x16x32_bf16 v[12:15], a[0:3], v[64:67], 0
  ds_read_b128 v[96:99], v2 offset:4096
  v_mfma_f32_16x16x32_bf16 v[20:23], a[4:7], v[64:67], 0
  s_waitcnt lgkmcnt(7)
  v_mfma_f32_16x16x32_bf16 v[16:19], a[0:3], v[68:71], 0
  ds_read_b128 v[100:103], v2 offset:9216
  v_mfma_f32_16x16x32_bf16 v[24:27], a[4:7], v[68:71], 0
  s_waitcnt lgkmcnt(7)
  v_mfma_f32_16x16x32_bf16 v[12:15], a[8:11], v[72:75], v[12:15]
  ds_read_b128 v[64:67], v2 offset:10240
  v_mfma_f32_16x16x32_bf16 v[20:23], a[12:15], v[72:75], v[20:23]
  s_waitcnt lgkmcnt(7)
  v_mfma_f32_16x16x32_bf16 v[16:19], a[8:11], v[76:79], v[16:19]
  ds_read_b128 v[68:71], v2 offset:15360
  v_mfma_f32_16x16x32_bf16 v[24:27], a[12:15], v[76:79], v[24:27]
  s_waitcnt lgkmcnt(7)
  v_mfma_f32_16x16x32_bf16 v[12:15], a[16:19], v[80:83], v[12:15]
  ds_read_b128 v[72:75], v2 offset:11264
  v_mfma_f32_16x16x32_bf16 v[20:23], a[20:23], v[80:83], v[20:23]
  s_waitcnt lgkmcnt(7)
  v_mfma_f32_16x16x32_bf16 v[16:19], a[16:19], v[84:87], v[16:19]
  ds_read_b128 v[76:79], v2 offset:16384
  v_mfma_f32_16x16x32_bf16 v[24:27], a[20:23], v[84:87], v[24:27]
  s_waitcnt lgkmcnt(7)
  v_mfma_f32_16x16x32_bf16 v[12:15], a[24:27], v[88:91], v[12:15]
  ds_read_b128 v[80:83], v2 offset:12288
  v_mfma_f32_16x16x32_bf16 v[20:23], a[28:31], v[88:91], v[20:23]
  s_waitcnt lgkmcnt(7)
  v_mfma_f32_16x16x32_bf16 v[16:19], a[24:27], v[92:95], v[16:19]
  ds_read_b128 v[84:87], v2 offset:17408
  v_mfma_f32_16x16x32_bf16 v[24:27], a[28:31], v[92:95], v[24:27]
  s_waitcnt lgkmcnt(7)
  v_mfma_f32_16x16x32_bf16 v[12:15], v[28:31], v[96:99], v[12:15]
  ds_read_b128 v[88:91], v2 offset:13312
  v_mfma_f32_16x16x32_bf16 v[20:23], v[32:35], v[96:99], v[20:23]
  s_waitcnt lgkmcnt(7)
  v_mfma_f32_16x16x32_bf16 v[16:19], v[28:31], v[100:103], v[16:19]
  ds_read_b128 v[92:95], v2 offset:18432
  v_mfma_f32_16x16x32_bf16 v[24:27], v[32:35], v[100:103], v[24:27]
  s_waitcnt lgkmcnt(7)
  v_mfma_f32_16x16x32_bf16 v[12:15], a[32:35], v[64:67], v[12:15]
  ds_read_b128 v[96:99], v2 offset:14336
  v_mfma_f32_16x16x32_bf16 v[20:23], a[36:39], v[64:67], v[20:23]
  s_waitcnt lgkmcnt(7)
  v_mfma_f32_16x16x32_bf16 v[16:19], a[32:35], v[68:71], v[16:19]
  ds_read_b128 v[100:103], v2 offset:19456
  v_mfma_f32_16x16x32_bf16 v[24:27], a[36:39], v[68:71], v[24:27]
  s_waitcnt lgkmcnt(7)
  v_mfma_f32_16x16x32_bf16 v[12:15], a[40:43], v[72:75], v[12:15]
  ds_read_b128 v[64:67], v2 offset:20480
  v_mfma_f32_16x16x32_bf16 v[20:23], a[44:47], v[72:75], v[20:23]
  s_waitcnt lgkmcnt(7)
  v_mfma_f32_16x16x32_bf16 v[16:19], a[40:43], v[76:79], v[16:19]
  ds_read_b128 v[68:71], v2 offset:25600
  v_mfma_f32_16x16x32_bf16 v[24:27], a[44:47], v[76:79], v[24:27]
  s_waitcnt lgkmcnt(7)
  v_mfma_f32_16x16x32_bf16 v[12:15], a[48:51], v[80:83], v[12:15]
  ds_read_b128 v[72:75], v2 offset:21504
  v_mfma_f32_16x16x32_bf16 v[20:23], a[52:55], v[80:83], v[20:23]
  s_waitcnt lgkmcnt(7)
  v_mfma_f32_16x16x32_bf16 v[16:19], a[48:51], v[84:87], v[16:19]
  ds_read_b128 v[76:79], v2 offset:26624
  v_mfma_f32_16x16x32_bf16 v[24:27], a[52:55], v[84:87], v[24:27]
  s_waitcnt lgkmcnt(7)
  v_mfma_f32_16x16x32_bf16 v[12:15], a[56:59], v[88:91], v[12:15]
  ds_read_b128 v[80:83], v2 offset:22528
  v_mfma_f32_16x16x32_bf16 v[20:23], a[60:63], v[88:91], v[20:23]
  s_waitcnt lgkmcnt(7)
  v_mfma_f32_16x16x32_bf16 v[16:19], a[56:59], v[92:95], v[16:19]
  ds_read_b128 v[84:87], v2 offset:27648
  v_mfma_f32_16x16x32_bf16 v[24:27], a[60:63], v[92:95], v[24:27]
  s_waitcnt lgkmcnt(7)
  v_mfma_f32_16x16x32_bf16 v[12:15], v[36:39], v[96:99], v[12:15]
  ds_read_b128 v[88:91], v2 offset:23552
  v_mfma_f32_16x16x32_bf16 v[20:23], v[40:43], v[96:99], v[20:23]
  s_waitcnt lgkmcnt(7)
  v_mfma_f32_16x16x32_bf16 v[16:19], v[36:39], v[100:103], v[16:19]
  ds_read_b128 v[92:95], v2 offset:28672
  v_mfma_f32_16x16x32_bf16 v[24:27], v[40:43], v[100:103], v[24:27]
  s_waitcnt lgkmcnt(7)
  v_mfma_f32_16x16x32_bf16 v[12:15], a[64:67], v[64:67], v[12:15]
  ds_read_b128 v[96:99], v2 offset:24576
  v_mfma_f32_16x16x32_bf16 v[20:23], a[68:71], v[64:67], v[20:23]
  s_waitcnt lgkmcnt(7)
  v_mfma_f32_16x16x32_bf16 v[16:19], a[64:67], v[68:71], v[16:19]
  ds_read_b128 v[100:103], v2 offset:29696
  v_mfma_f32_16x16x32_bf16 v[24:27], a[68:71], v[68:71], v[24:27]
  s_waitcnt lgkmcnt(7)
  v_mfma_f32_16x16x32_bf16 v[12:15], a[72:75], v[72:75], v[12:15]
  ds_read_b128 v[64:67], v2 offset:30720
  v_mfma_f32_16x16x32_bf16 v[20:23], a[76:79], v[72:75], v[20:23]
  s_waitcnt lgkmcnt(7)
  v_mfma_f32_16x16x32_bf16 v[16:19], a[72:75], v[76:79], v[16:19]
  ds_read_b128 v[68:71], v2 offset:35840
  v_mfma_f32_16x16x32_bf16 v[24:27], a[76:79], v[76:79], v[24:27]
  s_waitcnt lgkmcnt(7)
  v_mfma_f32_16x16x32_bf16 v[12:15], a[80:83], v[80:83], v[12:15]
  ds_read_b128 v[72:75], v2 offset:31744
  v_mfma_f32_16x16x32_bf16 v[20:23], a[84:87], v[80:83], v[20:23]
  s_waitcnt lgkmcnt(7)
  v_mfma_f32_16x16x32_bf16 v[16:19], a[80:83], v[84:87], v[16:19]
  ds_read_b128 v[76:79], v2 offset:36864
  v_mfma_f32_16x16x32_bf16 v[24:27], a[84:87], v[84:87], v[24:27]
  s_waitcnt lgkmcnt(7)
  v_mfma_f32_16x16x32_bf16 v[12:15], a[88:91], v[88:91], v[12:15]
  ds_read_b128 v[80:83], v2 offset:32768
  v_mfma_f32_16x16x32_bf16 v[20:23], a[92:95], v[88:91], v[20:23]
  s_waitcnt lgkmcnt(7)
  v_mfma_f32_16x16x32_bf16 v[16:19], a[88:91], v[92:95], v[16:19]
  ds_read_b128 v[84:87], v2 offset:37888
  v_mfma_f32_16x16x32_bf16 v[24:27], a[92:95], v[92:95], v[24:27]
  s_waitcnt lgkmcnt(7)
  v_mfma_f32_16x16x32_bf16 v[12:15], v[44:47], v[96:99], v[12:15]
  ds_read_b128 v[88:91], v2 offset:33792
  v_mfma_f32_16x16x32_bf16 v[20:23], v[48:51], v[96:99], v[20:23]
  s_waitcnt lgkmcnt(7)
  v_mfma_f32_16x16x32_bf16 v[16:19], v[44:47], v[100:103], v[16:19]
  ds_read_b128 v[92:95], v2 offset:38912
  v_mfma_f32_16x16x32_bf16 v[24:27], v[48:51], v[100:103], v[24:27]
  s_waitcnt lgkmcnt(7)
  v_mfma_f32_16x16x32_bf16 v[12:15], a[96:99], v[64:67], v[12:15]
  ds_read_b128 v[96:99], v2 offset:34816
  v_mfma_f32_16x16x32_bf16 v[20:23], a[100:103], v[64:67], v[20:23]
  s_waitcnt lgkmcnt(7)
  v_mfma_f32_16x16x32_bf16 v[16:19], a[96:99], v[68:71], v[16:19]
  ds_read_b128 v[100:103], v2 offset:39936
  v_mfma_f32_16x16x32_bf16 v[24:27], a[100:103], v[68:71], v[24:27]
  s_waitcnt lgkmcnt(7)
  v_mfma_f32_16x16x32_bf16 v[12:15], a[104:107], v[72:75], v[12:15]
  v_mfma_f32_16x16x32_bf16 v[20:23], a[108:111], v[72:75], v[20:23]
  s_waitcnt lgkmcnt(6)
  v_mfma_f32_16x16x32_bf16 v[16:19], a[104:107], v[76:79], v[16:19]
  v_mfma_f32_16x16x32_bf16 v[24:27], a[108:111], v[76:79], v[24:27]
  s_waitcnt lgkmcnt(5)
  v_mfma_f32_16x16x32_bf16 v[12:15], a[112:115], v[80:83], v[12:15]
  v_mfma_f32_16x16x32_bf16 v[20:23], a[116:119], v[80:83], v[20:23]
  s_waitcnt lgkmcnt(4)
  v_mfma_f32_16x16x32_bf16 v[16:19], a[112:115], v[84:87], v[16:19]
  v_mfma_f32_16x16x32_bf16 v[24:27], a[116:119], v[84:87], v[24:27]
  s_waitcnt lgkmcnt(3)
  v_mfma_f32_16x16x32_bf16 v[12:15], a[120:123], v[88:91], v[12:15]
  v_mfma_f32_16x16x32_bf16 v[20:23], a[124:127], v[88:91], v[20:23]
  s_waitcnt lgkmcnt(2)
  v_mfma_f32_16x16x32_bf16 v[16:19], a[120:123], v[92:95], v[16:19]
  v_mfma_f32_16x16x32_bf16 v[24:27], a[124:127], v[92:95], v[24:27]
  s_waitcnt lgkmcnt(1)
  v_mfma_f32_16x16x32_bf16 v[12:15], v[52:55], v[96:99], v[12:15]
  v_mfma_f32_16x16x32_bf16 v[20:23], v[56:59], v[96:99], v[20:23]
  s_waitcnt lgkmcnt(0)
  v_mfma_f32_16x16x32_bf16 v[16:19], v[52:55], v[100:103], v[16:19]
  v_mfma_f32_16x16x32_bf16 v[24:27], v[56:59], v[100:103], v[24:27]
  v_cvt_pk_bf16_f32 v108, v12, v13
  v_cvt_pk_bf16_f32 v109, v14, v15
  buffer_store_dwordx2 v[108:109], v8, s[92:95], s44 offen
  v_cvt_pk_bf16_f32 v110, v20, v21
  v_cvt_pk_bf16_f32 v111, v22, v23
  buffer_store_dwordx2 v[110:111], v9, s[92:95], s44 offen
  v_cvt_pk_bf16_f32 v112, v16, v17
  v_cvt_pk_bf16_f32 v113, v18, v19
  buffer_store_dwordx2 v[112:113], v8, s[92:95], s45 offen
  v_cvt_pk_bf16_f32 v114, v24, v25
  v_cvt_pk_bf16_f32 v115, v26, v27
  buffer_store_dwordx2 v[114:115], v9, s[92:95], s45 offen
  v_readfirstlane_b32 s22, v250
  s_cmp_ge_u32 s22, 1264
  s_cbranch_scc1 wk_done
  s_branch wk_loop
wp_abort:
wo_abort:
  s_branch cA_abort
wk_done:
ch_end:
  s_endpgm

.section .rodata,"a"
.p2align 6
.amdhsa_kernel main_kernel
  .amdhsa_next_free_vgpr 512
  .amdhsa_next_free_sgpr 102
  .amdhsa_accum_offset 256
  .amdhsa_group_segment_fixed_size 0
  .amdhsa_kernarg_size 136
  .amdhsa_user_sgpr_count 2
  .amdhsa_user_sgpr_kernarg_segment_ptr 1
  .amdhsa_system_sgpr_workgroup_id_x 1
.end_amdhsa_kernel
```

```asm
; @launch kernel=main_kernel grid=(256,1,1) block=(256,1,1) lds=163840
.amdgcn_target "amdgcn-amd-amdhsa--gfx950"
.text
.globl main_kernel
.p2align 8
.type main_kernel,@function
main_kernel:
  s_cmp_ge_u32 s2, 256
  s_cbranch_scc1 ch_end
  s_load_dwordx2 s[4:5], s[0:1], 120
  s_load_dwordx2 s[6:7], s[0:1], 128
  s_load_dwordx8 s[40:47], s[0:1], 72
  s_load_dwordx4 s[48:51], s[0:1], 56
  s_mov_b32 s32, 0
  s_getreg_b32 s3, hwreg(HW_REG_XCC_ID)
  s_and_b32 s3, s3, 15
  s_cmp_lg_u32 s3, 3
  s_cbranch_scc1 ch_pf
  s_cmp_lt_u32 s2, 224
  s_cbranch_scc1 ch_npf
ch_pf:
  s_getpc_b64 s[98:99]
pf_main_kernel_1:
  s_sub_u32 s98, s98, pf_main_kernel_1-main_kernel
  s_subb_u32 s99, s99, 0
  v_lshlrev_b32 v60, 7, v0
  v_min_u32 v61, ch_end-main_kernel-4, v60
  global_load_dword v62, v61, s[98:99]
  v_add_u32 v60, 32768, v60
  v_min_u32 v61, ch_end-main_kernel-4, v60
  global_load_dword v62, v61, s[98:99]
  v_add_u32 v60, 32768, v60
  v_min_u32 v61, ch_end-main_kernel-4, v60
  global_load_dword v62, v61, s[98:99]
  v_add_u32 v60, 32768, v60
  v_min_u32 v61, ch_end-main_kernel-4, v60
  global_load_dword v62, v61, s[98:99]
  v_add_u32 v60, 32768, v60
  v_min_u32 v61, ch_end-main_kernel-4, v60
  global_load_dword v62, v61, s[98:99]
  v_add_u32 v60, 32768, v60
ch_npf:
  v_lshrrev_b32 v1, 6, v0
  s_nop 0
  v_readfirstlane_b32 s16, v1
  s_waitcnt lgkmcnt(0)
  s_mov_b32 s8, s6
  s_and_b32 s9, s7, 0xffff
  s_mov_b32 s10, 0x10000000
  s_mov_b32 s11, 0x20000
  s_mov_b32 s12, s4
  s_and_b32 s13, s5, 0xffff
  s_mov_b32 s14, 256
  s_mov_b32 s15, 0x20000
  v_mov_b32 v252, 0x40000000
  v_cmp_eq_u32 vcc, 0, v0
  s_nop 1
  v_cndmask_b32 v252, v252, v0, vcc
  s_cmp_lg_u32 s3, 3
  s_cbranch_scc1 ch_worker
  s_mov_b32 s18, 0
  v_mov_b32 v249, 1
  s_mov_b64 exec, 1
  buffer_atomic_add v249, v252, s[12:15], 0 offen sc0
  s_mov_b64 exec, -1
  v_and_b32 v1, 63, v0
  v_lshlrev_b32 v2, 4, v1
  v_lshrrev_b32 v3, 4, v1
  v_and_b32 v4, 15, v1
  s_lshr_b32 s33, s2, 3
  s_lshl_b32 s27, s33, 2
  s_add_u32 s27, s27, s16
  s_lshl_b32 s27, s27, 13
  v_lshlrev_b32 v12, 7, v1
  s_mov_b32 s64, s42
  s_and_b32 s65, s43, 0xffff
  s_mov_b32 s66, 2097152
  s_mov_b32 s67, 0x20000
  s_mov_b32 s28, s27
  buffer_load_dword v13, v12, s[64:67], s28 offen
  s_add_u32 s28, s28, 1048576
  buffer_load_dword v13, v12, s[64:67], s28 offen
  s_add_u32 s28, s28, 1048576
  s_waitcnt vmcnt(2)
  v_readfirstlane_b32 s17, v249
  v_mov_b32 v6, 160032
  s_nop 0
  v_mov_b32 v7, s17
  s_barrier
  s_cmp_lg_u32 s16, 0
  s_cbranch_scc1 uni_2
  ds_write_b32 v6, v7
  s_waitcnt lgkmcnt(0)
uni_2:
  s_barrier
  ds_read_b32 v7, v6
  s_waitcnt lgkmcnt(0)
  v_readfirstlane_b32 s17, v7
  s_branch ch_got
ch_take:
  v_mov_b32 v5, 0
  v_mov_b32 v6, 160000
  s_barrier
  s_cmp_lg_u32 s16, 0
  s_cbranch_scc1 ch_el1
  s_mov_b64 exec, 1
  buffer_atomic_add v4, v5, s[12:15], 0 offen sc0
  s_waitcnt vmcnt(0)
  ds_write_b32 v6, v4
  s_waitcnt lgkmcnt(0)
  s_mov_b64 exec, -1
ch_el1:
  s_barrier
  ds_read_b32 v4, v6
  s_waitcnt lgkmcnt(0)
  v_readfirstlane_b32 s17, v4
ch_got:
  s_and_b32 s17, s17, 0xffff
  s_cmp_lt_u32 s17, 32
  s_cbranch_scc1 ch_role
  s_cmp_eq_u32 s18, 0
  s_cbranch_scc1 ch_worker
  v_and_b32 v1, 63, v0
  v_lshlrev_b32 v2, 4, v1
  v_lshrrev_b32 v3, 4, v1
  v_and_b32 v4, 15, v1
  s_branch wp_all
ch_role:
  v_and_b32 v1, 63, v0
  v_lshlrev_b32 v2, 4, v1
  v_lshrrev_b32 v3, 4, v1
  v_and_b32 v4, 15, v1
  s_cmp_lt_u32 s17, 16
  s_cbranch_scc1 ch_self
  s_cmp_lt_u32 s17, 24
  s_cbranch_scc1 ch_tch
  s_sub_u32 s33, s17, 24
  v_mov_b32 v10, 0x40000000
  v_mov_b32 v5, 1
  v_mov_b32 v148, 0
  v_mov_b32 v149, 0
  v_mov_b32 v150, 0
  v_mov_b32 v151, 0
  v_mov_b32 v152, -1
  v_mov_b32 v153, -1
  v_mov_b32 v154, -1
  v_mov_b32 v155, -1
  v_lshlrev_b32 v8, 4, v0
  s_mov_b32 s64, s48
  s_and_b32 s65, s49, 0xffff
  s_mov_b32 s66, 1835008
  s_mov_b32 s67, 0x20000
  s_lshl_b32 s21, s33, 2
  s_add_u32 s21, s21, s16
  s_lshr_b32 s22, s21, 1
  s_mul_i32 s22, s22, 14336
  s_and_b32 s24, s21, 1
  s_mul_i32 s24, s24, 448
  s_add_u32 s22, s22, s24
  s_mul_i32 s21, s21, 7168
  v_mul_u32_u24 v7, 896, v4
  v_lshl_add_u32 v7, v3, 4, v7
  buffer_load_dwordx4 v[64:67], v7, s[64:67], s22 offen offset:0
  buffer_load_dwordx4 v[68:71], v7, s[64:67], s22 offen offset:64
  buffer_load_dwordx4 v[72:75], v7, s[64:67], s22 offen offset:128
  buffer_load_dwordx4 v[76:79], v7, s[64:67], s22 offen offset:192
  buffer_load_dwordx4 v[80:83], v7, s[64:67], s22 offen offset:256
  buffer_load_dwordx4 v[84:87], v7, s[64:67], s22 offen offset:320
  buffer_load_dwordx4 v[88:91], v7, s[64:67], s22 offen offset:384
  s_mov_b32 s68, s50
  s_and_b32 s69, s51, 0xffff
  s_mov_b32 s70, 7168
  s_mov_b32 s71, 0x20000
  v_lshrrev_b32 v6, 3, v0
  v_min_u32 v6, 27, v6
  v_and_b32 v7, 7, v0
  v_mul_u32_u24 v9, 896, v7
  v_lshl_add_u32 v9, v6, 5, v9
  buffer_load_dwordx4 v[176:179], v9, s[68:71], 0 offen
  buffer_load_dwordx4 v[180:183], v9, s[68:71], 0 offen offset:16
  s_cmp_lg_u32 s33, 0
  s_cbranch_scc1 ch_ij_1
  s_mov_b32 s23, 582144
  buffer_store_dwordx4 v[148:151], v8, s[8:11], s23 offen sc1
  s_mov_b32 s23, 586240
  buffer_store_dwordx4 v[148:151], v8, s[8:11], s23 offen sc1
  s_waitcnt vmcnt(0)
  s_barrier
  buffer_store_dword v5, v252, s[12:15], 0 offen offset:128 sc1
ch_ij_1:
  s_waitcnt vmcnt(1)
  s_add_u32 s23, s21, 655360
  buffer_store_dwordx4 v[64:67], v2, s[8:11], s23 offen offset:0 sc1
  buffer_store_dwordx4 v[68:71], v2, s[8:11], s23 offen offset:1024 sc1
  buffer_store_dwordx4 v[72:75], v2, s[8:11], s23 offen offset:2048 sc1
  buffer_store_dwordx4 v[76:79], v2, s[8:11], s23 offen offset:3072 sc1
  s_add_u32 s23, s21, 659456
  buffer_store_dwordx4 v[80:83], v2, s[8:11], s23 offen offset:0 sc1
  buffer_store_dwordx4 v[84:87], v2, s[8:11], s23 offen offset:1024 sc1
  buffer_store_dwordx4 v[88:91], v2, s[8:11], s23 offen offset:2048 sc1
  s_waitcnt vmcnt(0)
  s_barrier
  s_cmp_lg_u32 s16, 0
  s_cbranch_scc1 ch_ij_x_e
  v_mov_b32 v6, 1
  s_mov_b64 exec, 1
  buffer_atomic_add v6, v252, s[12:15], 0 offen offset:4 sc0
  s_waitcnt vmcnt(0)
  v_readfirstlane_b32 s20, v6
  s_cmp_lg_u32 s20, 7
  s_cbranch_scc1 ch_ij_x_e0
  s_mov_b64 exec, 0xff
  v_lshlrev_b32 v6, 7, v0
  s_mov_b32 s20, 586240
  buffer_store_dword v5, v6, s[8:11], s20 offen offset:8 sc1
ch_ij_x_e0:
  s_mov_b64 exec, -1
ch_ij_x_e:
  s_lshl_b32 s20, s33, 12
  v_add_u32 v8, s20, v8
  s_mov_b32 s23, 524288
ch_ijlp_3:
  buffer_store_dwordx4 v[148:151], v8, s[8:11], s23 offen sc1
  s_add_u32 s23, s23, 32768
  s_cmp_lt_u32 s23, 557056
  s_cbranch_scc1 ch_ijlp_3
  v_cmp_gt_u32 vcc, 25088, v8
  s_nop 1
  v_cndmask_b32 v9, v10, v8, vcc
  buffer_store_dwordx4 v[148:151], v9, s[8:11], s23 offen sc1
  s_mov_b32 s23, 35328
  v_cmp_gt_u32 vcc, 6144, v8
  s_nop 1
  v_cndmask_b32 v9, v10, v8, vcc
  buffer_store_dwordx4 v[148:151], v9, s[8:11], s23 offen sc1
  s_mov_b32 s23, 7168
  v_cmp_gt_u32 vcc, 28160, v8
  s_nop 1
  v_cndmask_b32 v9, v10, v8, vcc
  buffer_store_dwordx4 v[152:155], v9, s[8:11], s23 offen sc1
  s_mov_b32 s23, 72704
ch_ijlp_4:
  buffer_store_dwordx4 v[152:155], v8, s[8:11], s23 offen sc1
  s_add_u32 s23, s23, 32768
  s_cmp_lt_u32 s23, 498688
  s_cbranch_scc1 ch_ijlp_4
  v_cmp_gt_u32 vcc, 25600, v8
  s_nop 1
  v_cndmask_b32 v9, v10, v8, vcc
  buffer_store_dwordx4 v[152:155], v9, s[8:11], s23 offen sc1
  s_cmp_lg_u32 s33, 1
  s_cbranch_scc1 ch_ij_nm
  v_lshrrev_b32 v6, 3, v0
  v_and_b32 v7, 7, v0
  v_lshlrev_b32 v8, 8, v6
  v_lshl_add_u32 v8, v7, 4, v8
  v_cmp_gt_u32 vcc, 28, v6
  s_nop 1
  v_cndmask_b32 v8, v10, v8, vcc
  s_waitcnt vmcnt(4)
  v_min_u32 v184, -2, v176
  v_min_u32 v188, -2, v177
  v_min_u32 v185, -2, v178
  v_min_u32 v189, -2, v179
  v_min_u32 v186, -2, v180
  v_min_u32 v190, -2, v181
  v_min_u32 v187, -2, v182
  v_min_u32 v191, -2, v183
  s_mov_b32 s23, 0
  buffer_store_dwordx4 v[184:187], v8, s[8:11], s23 offen sc1
  buffer_store_dwordx4 v[188:191], v8, s[8:11], s23 offen offset:128 sc1
  s_mov_b32 s23, 65536
  buffer_store_dwordx4 v[184:187], v8, s[8:11], s23 offen sc1
  buffer_store_dwordx4 v[188:191], v8, s[8:11], s23 offen offset:128 sc1
ch_ij_nm:
  s_waitcnt vmcnt(0)
  s_barrier
  s_cmp_lg_u32 s16, 0
  s_cbranch_scc1 ch_ij_e
  v_mov_b32 v6, 1
  s_mov_b64 exec, 1
  buffer_atomic_add v6, v252, s[12:15], 0 offen offset:12 sc0
  s_waitcnt vmcnt(0)
  v_readfirstlane_b32 s20, v6
  s_cmp_lg_u32 s20, 7
  s_cbranch_scc1 ch_ij_e0
  buffer_store_dword v5, v252, s[12:15], 0 offen offset:132 sc1
  s_mov_b64 exec, 0xff
  v_lshlrev_b32 v6, 7, v0
  s_mov_b32 s20, 586240
  buffer_store_dword v5, v6, s[8:11], s20 offen offset:4 sc1
ch_ij_e0:
  s_mov_b64 exec, -1
ch_ij_e:
  s_branch ch_role2
ch_tch:
  s_sub_u32 s33, s17, 16
  s_lshl_b32 s27, s33, 2
  s_add_u32 s27, s27, s16
  s_lshl_b32 s27, s27, 13
  v_lshlrev_b32 v12, 7, v1
  s_mov_b32 s64, s40
  s_and_b32 s65, s41, 0xffff
  s_mov_b32 s66, 2097152
  s_mov_b32 s67, 0x20000
  s_mov_b32 s28, s27
  buffer_load_dword v13, v12, s[64:67], s28 offen
  s_add_u32 s28, s28, 262144
  buffer_load_dword v13, v12, s[64:67], s28 offen
  s_add_u32 s28, s28, 262144
  buffer_load_dword v13, v12, s[64:67], s28 offen
  s_add_u32 s28, s28, 262144
  buffer_load_dword v13, v12, s[64:67], s28 offen
  s_add_u32 s28, s28, 262144
  buffer_load_dword v13, v12, s[64:67], s28 offen
  s_add_u32 s28, s28, 262144
  buffer_load_dword v13, v12, s[64:67], s28 offen
  s_add_u32 s28, s28, 262144
  buffer_load_dword v13, v12, s[64:67], s28 offen
  s_add_u32 s28, s28, 262144
  buffer_load_dword v13, v12, s[64:67], s28 offen
  s_add_u32 s28, s28, 262144
  s_branch ch_role2
ch_self:
  v_lshrrev_b32 v5, 5, v1
  v_and_b32 v6, 31, v1
  v_xor_b32 v8, v6, v5
  v_lshlrev_b32 v8, 4, v8
  v_lshl_add_u32 v16, v5, 13, v8
  v_xor_b32 v17, 32, v16
  v_xor_b32 v18, 64, v16
  v_xor_b32 v19, 96, v16
  v_xor_b32 v20, 128, v16
  v_xor_b32 v21, 160, v16
  v_xor_b32 v22, 192, v16
  v_xor_b32 v23, 224, v16
  s_lshl_b32 s20, s16, 6
  v_xor_b32 v26, s20, v16
  v_xor_b32 v27, 32, v26
  s_mov_b32 s60, s40
  s_and_b32 s61, s41, 0xffff
  s_mov_b32 s62, 3670016
  s_mov_b32 s63, 0x20000
  s_mov_b32 s56, s42
  s_and_b32 s57, s43, 0xffff
  s_mov_b32 s58, 3670016
  s_mov_b32 s59, 0x20000
  s_lshl_b32 s26, s17, 9
  s_lshl_b32 s27, s16, 19
  s_add_u32 s27, s27, s26
  s_lshl_b32 s25, s16, 15
  s_add_u32 s25, s25, 32768
  s_barrier
  s_add_u32 m0, s25, 0
  s_nop 0
  buffer_load_dwordx4 v16, s[56:59], s27 offen lds
  s_add_u32 s27, s27, 16384
  s_add_u32 m0, s25, 1024
  s_nop 0
  buffer_load_dwordx4 v16, s[56:59], s27 offen lds
  s_add_u32 s27, s27, 16384
  s_add_u32 m0, s25, 2048
  s_nop 0
  buffer_load_dwordx4 v17, s[56:59], s27 offen lds
  s_add_u32 s27, s27, 16384
  s_add_u32 m0, s25, 3072
  s_nop 0
  buffer_load_dwordx4 v17, s[56:59], s27 offen lds
  s_add_u32 s27, s27, 16384
  s_add_u32 m0, s25, 4096
  s_nop 0
  buffer_load_dwordx4 v16, s[56:59], s27 offen lds
  s_add_u32 s27, s27, 16384
  s_add_u32 m0, s25, 5120
  s_nop 0
  buffer_load_dwordx4 v16, s[56:59], s27 offen lds
  s_add_u32 s27, s27, 16384
  s_add_u32 m0, s25, 6144
  s_nop 0
  buffer_load_dwordx4 v17, s[56:59], s27 offen lds
  s_add_u32 s27, s27, 16384
  s_add_u32 m0, s25, 7168
  s_nop 0
  buffer_load_dwordx4 v17, s[56:59], s27 offen lds
  s_add_u32 s27, s27, 16384
  s_add_u32 m0, s25, 8192
  s_nop 0
  buffer_load_dwordx4 v18, s[56:59], s27 offen lds
  s_add_u32 s27, s27, 16384
  s_add_u32 m0, s25, 9216
  s_nop 0
  buffer_load_dwordx4 v18, s[56:59], s27 offen lds
  s_add_u32 s27, s27, 16384
  s_add_u32 m0, s25, 10240
  s_nop 0
  buffer_load_dwordx4 v19, s[56:59], s27 offen lds
  s_add_u32 s27, s27, 16384
  s_add_u32 m0, s25, 11264
  s_nop 0
  buffer_load_dwordx4 v19, s[56:59], s27 offen lds
  s_add_u32 s27, s27, 16384
  s_add_u32 m0, s25, 12288
  s_nop 0
  buffer_load_dwordx4 v18, s[56:59], s27 offen lds
  s_add_u32 s27, s27, 16384
  s_add_u32 m0, s25, 13312
  s_nop 0
  buffer_load_dwordx4 v18, s[56:59], s27 offen lds
  s_add_u32 s27, s27, 16384
  s_add_u32 m0, s25, 14336
  s_nop 0
  buffer_load_dwordx4 v19, s[56:59], s27 offen lds
  s_add_u32 s27, s27, 16384
  s_add_u32 m0, s25, 15360
  s_nop 0
  buffer_load_dwordx4 v19, s[56:59], s27 offen lds
  s_add_u32 s27, s27, 16384
  s_add_u32 m0, s25, 16384
  s_nop 0
  buffer_load_dwordx4 v20, s[56:59], s27 offen lds
  s_add_u32 s27, s27, 16384
  s_add_u32 m0, s25, 17408
  s_nop 0
  buffer_load_dwordx4 v20, s[56:59], s27 offen lds
  s_add_u32 s27, s27, 16384
  s_add_u32 m0, s25, 18432
  s_nop 0
  buffer_load_dwordx4 v21, s[56:59], s27 offen lds
  s_add_u32 s27, s27, 16384
  s_add_u32 m0, s25, 19456
  s_nop 0
  buffer_load_dwordx4 v21, s[56:59], s27 offen lds
  s_add_u32 s27, s27, 16384
  s_add_u32 m0, s25, 20480
  s_nop 0
  buffer_load_dwordx4 v20, s[56:59], s27 offen lds
  s_add_u32 s27, s27, 16384
  s_add_u32 m0, s25, 21504
  s_nop 0
  buffer_load_dwordx4 v20, s[56:59], s27 offen lds
  s_add_u32 s27, s27, 16384
  s_add_u32 m0, s25, 22528
  s_nop 0
  buffer_load_dwordx4 v21, s[56:59], s27 offen lds
  s_add_u32 s27, s27, 16384
  s_add_u32 m0, s25, 23552
  s_nop 0
  buffer_load_dwordx4 v21, s[56:59], s27 offen lds
  s_add_u32 s27, s27, 16384
  s_add_u32 m0, s25, 24576
  s_nop 0
  buffer_load_dwordx4 v22, s[56:59], s27 offen lds
  s_add_u32 s27, s27, 16384
  s_add_u32 m0, s25, 25600
  s_nop 0
  buffer_load_dwordx4 v22, s[56:59], s27 offen lds
  s_add_u32 s27, s27, 16384
  s_add_u32 m0, s25, 26624
  s_nop 0
  buffer_load_dwordx4 v23, s[56:59], s27 offen lds
  s_add_u32 s27, s27, 16384
  s_add_u32 m0, s25, 27648
  s_nop 0
  buffer_load_dwordx4 v23, s[56:59], s27 offen lds
  s_add_u32 s27, s27, 16384
  s_add_u32 m0, s25, 28672
  s_nop 0
  buffer_load_dwordx4 v22, s[56:59], s27 offen lds
  s_add_u32 s27, s27, 16384
  s_add_u32 m0, s25, 29696
  s_nop 0
  buffer_load_dwordx4 v22, s[56:59], s27 offen lds
  s_add_u32 s27, s27, 16384
  s_add_u32 m0, s25, 30720
  s_nop 0
  buffer_load_dwordx4 v23, s[56:59], s27 offen lds
  s_add_u32 s27, s27, 16384
  s_add_u32 m0, s25, 31744
  s_nop 0
  buffer_load_dwordx4 v23, s[56:59], s27 offen lds
  s_add_u32 s27, s27, 16384
  v_mov_b32 v14, v26
  v_mov_b32 v15, v27
  s_lshl_b32 s28, s16, 16
  s_add_u32 s28, s28, s26
  s_lshl_b32 s29, s16, 12
  s_add_u32 m0, s29, 0
  s_add_u32 s27, s28, 0
  buffer_load_dwordx4 v14, s[60:63], s27 offen lds
  s_add_u32 m0, s29, 1024
  s_add_u32 s27, s28, 16384
  buffer_load_dwordx4 v15, s[60:63], s27 offen lds
  s_add_u32 m0, s29, 2048
  s_add_u32 s27, s28, 32768
  buffer_load_dwordx4 v14, s[60:63], s27 offen lds
  s_add_u32 m0, s29, 3072
  s_add_u32 s27, s28, 49152
  buffer_load_dwordx4 v15, s[60:63], s27 offen lds
  s_add_u32 m0, s29, 16384
  s_add_u32 s27, s28, 262144
  buffer_load_dwordx4 v14, s[60:63], s27 offen lds
  s_add_u32 m0, s29, 17408
  s_add_u32 s27, s28, 278528
  buffer_load_dwordx4 v15, s[60:63], s27 offen lds
  s_add_u32 m0, s29, 18432
  s_add_u32 s27, s28, 294912
  buffer_load_dwordx4 v14, s[60:63], s27 offen lds
  s_add_u32 m0, s29, 19456
  s_add_u32 s27, s28, 311296
  buffer_load_dwordx4 v15, s[60:63], s27 offen lds
  v_lshrrev_b32 v7, 2, v4
  v_lshlrev_b32 v11, 4, v7
  v_lshlrev_b32 v7, 3, v7
  v_and_b32 v8, 3, v4
  v_add_u32 v7, v7, v8
  v_and_b32 v8, 2, v4
  v_lshl_add_u32 v11, v8, 1, v11
  v_and_b32 v8, 1, v4
  v_add_u32 v11, v11, v8
  v_or_b32 v10, 0, v3
  v_xor_b32 v10, v10, v4
  v_lshlrev_b32 v10, 4, v10
  v_lshl_add_u32 v248, v7, 9, v10
  v_add_u32 v252, 65536, v248
  v_add_u32 v16, 131072, v248
  v_lshl_add_u32 v10, v11, 9, v10
  v_add_u32 v20, s25, v10
  v_or_b32 v10, 4, v3
  v_xor_b32 v10, v10, v4
  v_lshlrev_b32 v10, 4, v10
  v_lshl_add_u32 v249, v7, 9, v10
  v_add_u32 v253, 65536, v249
  v_add_u32 v17, 131072, v249
  v_lshl_add_u32 v10, v11, 9, v10
  v_add_u32 v21, s25, v10
  v_or_b32 v10, 8, v3
  v_xor_b32 v10, v10, v4
  v_lshlrev_b32 v10, 4, v10
  v_lshl_add_u32 v250, v7, 9, v10
  v_add_u32 v254, 65536, v250
  v_add_u32 v18, 131072, v250
  v_lshl_add_u32 v10, v11, 9, v10
  v_add_u32 v22, s25, v10
  v_or_b32 v10, 12, v3
  v_xor_b32 v10, v10, v4
  v_lshlrev_b32 v10, 4, v10
  v_lshl_add_u32 v251, v7, 9, v10
  v_add_u32 v255, 65536, v251
  v_add_u32 v19, 131072, v251
  v_lshl_add_u32 v10, v11, 9, v10
  v_add_u32 v23, s25, v10
  v_mov_b32 v12, 1035512379
  v_lshlrev_b32 v6, 7, v1
  s_getpc_b64 s[98:99]
  global_load_dword v7, v6, s[98:99]
  s_waitcnt vmcnt(9)
  ds_read_b128 v[120:123], v20 offset:0
  ds_read_b128 v[124:127], v21 offset:0
  ds_read_b128 v[128:131], v22 offset:0
  ds_read_b128 v[132:135], v23 offset:0
  ds_read_b128 v[136:139], v20 offset:256
  ds_read_b128 v[140:143], v21 offset:256
  ds_read_b128 v[144:147], v22 offset:256
  ds_read_b128 v[148:151], v23 offset:256
  s_waitcnt lgkmcnt(8)
  ds_read_b128 v[152:155], v20 offset:1024
  ds_read_b128 v[156:159], v21 offset:1024
  ds_read_b128 v[160:163], v22 offset:1024
  ds_read_b128 v[164:167], v23 offset:1024
  ds_read_b128 v[168:171], v20 offset:1280
  ds_read_b128 v[172:175], v21 offset:1280
  ds_read_b128 v[176:179], v22 offset:1280
  ds_read_b128 v[180:183], v23 offset:1280
  s_waitcnt lgkmcnt(8)
  ds_read_b128 v[184:187], v20 offset:4096
  ds_read_b128 v[188:191], v21 offset:4096
  ds_read_b128 v[192:195], v22 offset:4096
  ds_read_b128 v[196:199], v23 offset:4096
  ds_read_b128 v[200:203], v20 offset:4352
  ds_read_b128 v[204:207], v21 offset:4352
  ds_read_b128 v[208:211], v22 offset:4352
  ds_read_b128 v[212:215], v23 offset:4352
  s_waitcnt lgkmcnt(8)
  ds_read_b128 v[216:219], v20 offset:5120
  ds_read_b128 v[220:223], v21 offset:5120
  ds_read_b128 v[224:227], v22 offset:5120
  ds_read_b128 v[228:231], v23 offset:5120
  ds_read_b128 v[232:235], v20 offset:5376
  ds_read_b128 v[236:239], v21 offset:5376
  ds_read_b128 v[240:243], v22 offset:5376
  ds_read_b128 v[244:247], v23 offset:5376
  s_waitcnt lgkmcnt(8)
  s_waitcnt vmcnt(4) lgkmcnt(0)
  s_barrier
  s_add_u32 m0, s29, 32768
  s_add_u32 s27, s28, 524288
  buffer_load_dwordx4 v14, s[60:63], s27 offen lds
  s_add_u32 m0, s29, 33792
  s_add_u32 s27, s28, 540672
  buffer_load_dwordx4 v15, s[60:63], s27 offen lds
  s_add_u32 m0, s29, 34816
  s_add_u32 s27, s28, 557056
  buffer_load_dwordx4 v14, s[60:63], s27 offen lds
  s_add_u32 m0, s29, 35840
  s_add_u32 s27, s28, 573440
  buffer_load_dwordx4 v15, s[60:63], s27 offen lds
  s_add_u32 m0, s29, 49152
  s_add_u32 s27, s28, 786432
  buffer_load_dwordx4 v14, s[60:63], s27 offen lds
  s_add_u32 m0, s29, 50176
  s_add_u32 s27, s28, 802816
  buffer_load_dwordx4 v15, s[60:63], s27 offen lds
  s_add_u32 m0, s29, 51200
  s_add_u32 s27, s28, 819200
  buffer_load_dwordx4 v14, s[60:63], s27 offen lds
  s_add_u32 m0, s29, 52224
  s_add_u32 s27, s28, 835584
  buffer_load_dwordx4 v15, s[60:63], s27 offen lds
  s_add_u32 m0, s29, 65536
  s_add_u32 s27, s28, 1048576
  buffer_load_dwordx4 v14, s[60:63], s27 offen lds
  s_add_u32 m0, s29, 66560
  s_add_u32 s27, s28, 1064960
  buffer_load_dwordx4 v15, s[60:63], s27 offen lds
  s_add_u32 m0, s29, 67584
  s_add_u32 s27, s28, 1081344
  buffer_load_dwordx4 v14, s[60:63], s27 offen lds
  s_add_u32 m0, s29, 68608
  s_add_u32 s27, s28, 1097728
  buffer_load_dwordx4 v15, s[60:63], s27 offen lds
  s_add_u32 m0, s29, 81920
  s_add_u32 s27, s28, 1310720
  buffer_load_dwordx4 v14, s[60:63], s27 offen lds
  s_add_u32 m0, s29, 82944
  s_add_u32 s27, s28, 1327104
  buffer_load_dwordx4 v15, s[60:63], s27 offen lds
  s_add_u32 m0, s29, 83968
  s_add_u32 s27, s28, 1343488
  buffer_load_dwordx4 v14, s[60:63], s27 offen lds
  s_add_u32 m0, s29, 84992
  s_add_u32 s27, s28, 1359872
  buffer_load_dwordx4 v15, s[60:63], s27 offen lds
  ds_read_b128 v[24:27], v248 offset:0
  ds_read_b128 v[28:31], v248 offset:2048
  ds_read_b128 v[32:35], v249 offset:0
  ds_read_b128 v[36:39], v249 offset:2048
  ds_read_b128 v[40:43], v250 offset:0
  ds_read_b128 v[44:47], v250 offset:2048
  s_waitcnt lgkmcnt(5)
  s_getpc_b64 s[98:99]
  s_add_u32 s98, s98, 4096
  s_addc_u32 s99, s99, 0
  global_load_dword v7, v6, s[98:99]
  v_mfma_f32_16x16x32_bf16 v[56:59], v[24:27], v[120:123], 0
  ds_read_b128 v[48:51], v251 offset:0
  v_mfma_f32_16x16x32_bf16 v[64:67], v[24:27], v[152:155], 0
  v_mfma_f32_16x16x32_bf16 v[72:75], v[24:27], v[184:187], 0
  s_add_u32 m0, s29, 98304
  s_add_u32 s27, s28, 1572864
  buffer_load_dwordx4 v14, s[60:63], s27 offen lds
  v_mfma_f32_16x16x32_bf16 v[80:83], v[24:27], v[216:219], 0
  s_waitcnt lgkmcnt(5)
  v_mfma_f32_16x16x32_bf16 v[60:63], v[28:31], v[120:123], 0
  ds_read_b128 v[52:55], v251 offset:2048
  v_mfma_f32_16x16x32_bf16 v[68:71], v[28:31], v[152:155], 0
  v_mfma_f32_16x16x32_bf16 v[76:79], v[28:31], v[184:187], 0
  v_mfma_f32_16x16x32_bf16 v[84:87], v[28:31], v[216:219], 0
  s_waitcnt lgkmcnt(5)
  v_mfma_f32_16x16x32_bf16 v[56:59], v[32:35], v[124:127], v[56:59]
  ds_read_b128 v[24:27], v248 offset:256
  v_mfma_f32_16x16x32_bf16 v[64:67], v[32:35], v[156:159], v[64:67]
  v_mfma_f32_16x16x32_bf16 v[72:75], v[32:35], v[188:191], v[72:75]
  s_add_u32 m0, s29, 99328
  s_add_u32 s27, s28, 1589248
  buffer_load_dwordx4 v15, s[60:63], s27 offen lds
  v_mfma_f32_16x16x32_bf16 v[80:83], v[32:35], v[220:223], v[80:83]
  s_waitcnt lgkmcnt(5)
  v_mfma_f32_16x16x32_bf16 v[60:63], v[36:39], v[124:127], v[60:63]
  ds_read_b128 v[28:31], v248 offset:2304
  v_mfma_f32_16x16x32_bf16 v[68:71], v[36:39], v[156:159], v[68:71]
  v_mfma_f32_16x16x32_bf16 v[76:79], v[36:39], v[188:191], v[76:79]
  v_mfma_f32_16x16x32_bf16 v[84:87], v[36:39], v[220:223], v[84:87]
  s_waitcnt lgkmcnt(5)
  v_mfma_f32_16x16x32_bf16 v[56:59], v[40:43], v[128:131], v[56:59]
  ds_read_b128 v[32:35], v249 offset:256
  v_mfma_f32_16x16x32_bf16 v[64:67], v[40:43], v[160:163], v[64:67]
  v_mfma_f32_16x16x32_bf16 v[72:75], v[40:43], v[192:195], v[72:75]
  s_add_u32 m0, s29, 100352
  s_add_u32 s27, s28, 1605632
  buffer_load_dwordx4 v14, s[60:63], s27 offen lds
  v_mfma_f32_16x16x32_bf16 v[80:83], v[40:43], v[224:227], v[80:83]
  s_waitcnt lgkmcnt(5)
  v_mfma_f32_16x16x32_bf16 v[60:63], v[44:47], v[128:131], v[60:63]
  ds_read_b128 v[36:39], v249 offset:2304
  v_mfma_f32_16x16x32_bf16 v[68:71], v[44:47], v[160:163], v[68:71]
  v_mfma_f32_16x16x32_bf16 v[76:79], v[44:47], v[192:195], v[76:79]
  v_mfma_f32_16x16x32_bf16 v[84:87], v[44:47], v[224:227], v[84:87]
  s_waitcnt lgkmcnt(5)
  v_mfma_f32_16x16x32_bf16 v[56:59], v[48:51], v[132:135], v[56:59]
  ds_read_b128 v[40:43], v250 offset:256
  v_mfma_f32_16x16x32_bf16 v[64:67], v[48:51], v[164:167], v[64:67]
  v_mfma_f32_16x16x32_bf16 v[72:75], v[48:51], v[196:199], v[72:75]
  s_add_u32 m0, s29, 101376
  s_add_u32 s27, s28, 1622016
  buffer_load_dwordx4 v15, s[60:63], s27 offen lds
  v_mfma_f32_16x16x32_bf16 v[80:83], v[48:51], v[228:231], v[80:83]
  s_waitcnt lgkmcnt(5)
  v_mfma_f32_16x16x32_bf16 v[60:63], v[52:55], v[132:135], v[60:63]
  ds_read_b128 v[44:47], v250 offset:2304
  v_mfma_f32_16x16x32_bf16 v[68:71], v[52:55], v[164:167], v[68:71]
  v_mfma_f32_16x16x32_bf16 v[76:79], v[52:55], v[196:199], v[76:79]
  v_mfma_f32_16x16x32_bf16 v[84:87], v[52:55], v[228:231], v[84:87]
  s_waitcnt lgkmcnt(5)
  v_mfma_f32_16x16x32_bf16 v[56:59], v[24:27], v[136:139], v[56:59]
  ds_read_b128 v[48:51], v251 offset:256
  v_mfma_f32_16x16x32_bf16 v[64:67], v[24:27], v[168:171], v[64:67]
  v_mfma_f32_16x16x32_bf16 v[72:75], v[24:27], v[200:203], v[72:75]
  v_mfma_f32_16x16x32_bf16 v[80:83], v[24:27], v[232:235], v[80:83]
  s_waitcnt lgkmcnt(5)
  v_mfma_f32_16x16x32_bf16 v[60:63], v[28:31], v[136:139], v[60:63]
  ds_read_b128 v[52:55], v251 offset:2304
  v_mfma_f32_16x16x32_bf16 v[68:71], v[28:31], v[168:171], v[68:71]
  v_mfma_f32_16x16x32_bf16 v[76:79], v[28:31], v[200:203], v[76:79]
  v_mfma_f32_16x16x32_bf16 v[84:87], v[28:31], v[232:235], v[84:87]
  s_waitcnt lgkmcnt(5)
  v_mfma_f32_16x16x32_bf16 v[56:59], v[32:35], v[140:143], v[56:59]
  s_waitcnt vmcnt(20)
  s_barrier
  ds_read_b128 v[24:27], v248 offset:16384
  v_mfma_f32_16x16x32_bf16 v[64:67], v[32:35], v[172:175], v[64:67]
  v_mfma_f32_16x16x32_bf16 v[72:75], v[32:35], v[204:207], v[72:75]
  v_mfma_f32_16x16x32_bf16 v[80:83], v[32:35], v[236:239], v[80:83]
  s_waitcnt lgkmcnt(5)
  v_mfma_f32_16x16x32_bf16 v[60:63], v[36:39], v[140:143], v[60:63]
  ds_read_b128 v[28:31], v248 offset:18432
  v_mfma_f32_16x16x32_bf16 v[68:71], v[36:39], v[172:175], v[68:71]
  v_mfma_f32_16x16x32_bf16 v[76:79], v[36:39], v[204:207], v[76:79]
  v_mfma_f32_16x16x32_bf16 v[84:87], v[36:39], v[236:239], v[84:87]
  s_waitcnt lgkmcnt(5)
  v_mfma_f32_16x16x32_bf16 v[56:59], v[40:43], v[144:147], v[56:59]
  ds_read_b128 v[32:35], v249 offset:16384
  v_mfma_f32_16x16x32_bf16 v[64:67], v[40:43], v[176:179], v[64:67]
  v_mfma_f32_16x16x32_bf16 v[72:75], v[40:43], v[208:211], v[72:75]
  v_mfma_f32_16x16x32_bf16 v[80:83], v[40:43], v[240:243], v[80:83]
  s_waitcnt lgkmcnt(5)
  v_mfma_f32_16x16x32_bf16 v[60:63], v[44:47], v[144:147], v[60:63]
  ds_read_b128 v[36:39], v249 offset:18432
  v_mfma_f32_16x16x32_bf16 v[68:71], v[44:47], v[176:179], v[68:71]
  v_mfma_f32_16x16x32_bf16 v[76:79], v[44:47], v[208:211], v[76:79]
  v_mfma_f32_16x16x32_bf16 v[84:87], v[44:47], v[240:243], v[84:87]
  s_waitcnt lgkmcnt(5)
  v_mfma_f32_16x16x32_bf16 v[56:59], v[48:51], v[148:151], v[56:59]
  ds_read_b128 v[40:43], v250 offset:16384
  v_mfma_f32_16x16x32_bf16 v[64:67], v[48:51], v[180:183], v[64:67]
  v_mfma_f32_16x16x32_bf16 v[72:75], v[48:51], v[212:215], v[72:75]
  v_mfma_f32_16x16x32_bf16 v[80:83], v[48:51], v[244:247], v[80:83]
  s_waitcnt lgkmcnt(5)
  v_mfma_f32_16x16x32_bf16 v[60:63], v[52:55], v[148:151], v[60:63]
  ds_read_b128 v[44:47], v250 offset:18432
  v_mfma_f32_16x16x32_bf16 v[68:71], v[52:55], v[180:183], v[68:71]
  v_mfma_f32_16x16x32_bf16 v[76:79], v[52:55], v[212:215], v[76:79]
  v_mfma_f32_16x16x32_bf16 v[84:87], v[52:55], v[244:247], v[84:87]
  s_waitcnt lgkmcnt(5)
  v_mfma_f32_16x16x32_bf16 v[88:91], v[24:27], v[120:123], 0
  ds_read_b128 v[48:51], v251 offset:16384
  v_mfma_f32_16x16x32_bf16 v[96:99], v[24:27], v[152:155], 0
  v_mfma_f32_16x16x32_bf16 v[104:107], v[24:27], v[184:187], 0
  s_add_u32 m0, s29, 114688
  s_add_u32 s27, s28, 1835008
  buffer_load_dwordx4 v14, s[60:63], s27 offen lds
  v_mfma_f32_16x16x32_bf16 v[112:115], v[24:27], v[216:219], 0
  s_waitcnt lgkmcnt(5)
  v_mul_f32 v56, v12, v56
  v_mfma_f32_16x16x32_bf16 v[92:95], v[28:31], v[120:123], 0
  ds_read_b128 v[52:55], v251 offset:18432
  v_mul_f32 v57, v12, v57
  v_mfma_f32_16x16x32_bf16 v[100:103], v[28:31], v[152:155], 0
  v_mul_f32 v58, v12, v58
  v_mul_f32 v59, v12, v59
  v_mfma_f32_16x16x32_bf16 v[108:111], v[28:31], v[184:187], 0
  v_mul_f32 v60, v12, v60
  v_mfma_f32_16x16x32_bf16 v[116:119], v[28:31], v[216:219], 0
  s_waitcnt lgkmcnt(5)
  v_mul_f32 v61, v12, v61
  v_mfma_f32_16x16x32_bf16 v[88:91], v[32:35], v[124:127], v[88:91]
  ds_read_b128 v[24:27], v248 offset:16640
  v_mul_f32 v62, v12, v62
  v_mfma_f32_16x16x32_bf16 v[96:99], v[32:35], v[156:159], v[96:99]
  v_mul_f32 v63, v12, v63
  v_cvt_pk_bf16_f32 v56, v56, v57
  v_mfma_f32_16x16x32_bf16 v[104:107], v[32:35], v[188:191], v[104:107]
  s_add_u32 m0, s29, 115712
  s_add_u32 s27, s28, 1851392
  buffer_load_dwordx4 v15, s[60:63], s27 offen lds
  v_mfma_f32_16x16x32_bf16 v[112:115], v[32:35], v[220:223], v[112:115]
  s_waitcnt lgkmcnt(5)
  v_cvt_pk_bf16_f32 v57, v58, v59
  v_mfma_f32_16x16x32_bf16 v[92:95], v[36:39], v[124:127], v[92:95]
  ds_read_b128 v[28:31], v248 offset:18688
  v_cvt_pk_bf16_f32 v58, v60, v61
  v_mfma_f32_16x16x32_bf16 v[100:103], v[36:39], v[156:159], v[100:103]
  v_cvt_pk_bf16_f32 v59, v62, v63
  v_accvgpr_write_b32 a0, v56
  v_mfma_f32_16x16x32_bf16 v[108:111], v[36:39], v[188:191], v[108:111]
  v_accvgpr_write_b32 a1, v57
  v_mfma_f32_16x16x32_bf16 v[116:119], v[36:39], v[220:223], v[116:119]
  s_waitcnt lgkmcnt(5)
  v_accvgpr_write_b32 a2, v58
  v_mfma_f32_16x16x32_bf16 v[88:91], v[40:43], v[128:131], v[88:91]
  ds_read_b128 v[32:35], v249 offset:16640
  v_accvgpr_write_b32 a3, v59
  v_mfma_f32_16x16x32_bf16 v[96:99], v[40:43], v[160:163], v[96:99]
  v_mul_f32 v64, v12, v64
  v_mul_f32 v65, v12, v65
  v_mfma_f32_16x16x32_bf16 v[104:107], v[40:43], v[192:195], v[104:107]
  s_add_u32 m0, s29, 116736
  s_add_u32 s27, s28, 1867776
  buffer_load_dwordx4 v14, s[60:63], s27 offen lds
  v_mfma_f32_16x16x32_bf16 v[112:115], v[40:43], v[224:227], v[112:115]
  s_waitcnt lgkmcnt(5)
  v_mul_f32 v66, v12, v66
  v_mfma_f32_16x16x32_bf16 v[92:95], v[44:47], v[128:131], v[92:95]
  ds_read_b128 v[36:39], v249 offset:18688
  v_mul_f32 v67, v12, v67
  v_mfma_f32_16x16x32_bf16 v[100:103], v[44:47], v[160:163], v[100:103]
  v_mul_f32 v68, v12, v68
  v_mul_f32 v69, v12, v69
  v_mfma_f32_16x16x32_bf16 v[108:111], v[44:47], v[192:195], v[108:111]
  v_mul_f32 v70, v12, v70
  v_mfma_f32_16x16x32_bf16 v[116:119], v[44:47], v[224:227], v[116:119]
  s_waitcnt lgkmcnt(5)
  v_mul_f32 v71, v12, v71
  v_mfma_f32_16x16x32_bf16 v[88:91], v[48:51], v[132:135], v[88:91]
  ds_read_b128 v[40:43], v250 offset:16640
  v_cvt_pk_bf16_f32 v64, v64, v65
  v_mfma_f32_16x16x32_bf16 v[96:99], v[48:51], v[164:167], v[96:99]
  v_cvt_pk_bf16_f32 v65, v66, v67
  v_cvt_pk_bf16_f32 v66, v68, v69
  v_mfma_f32_16x16x32_bf16 v[104:107], v[48:51], v[196:199], v[104:107]
  s_add_u32 m0, s29, 117760
  s_add_u32 s27, s28, 1884160
  buffer_load_dwordx4 v15, s[60:63], s27 offen lds
  v_mfma_f32_16x16x32_bf16 v[112:115], v[48:51], v[228:231], v[112:115]
  s_waitcnt lgkmcnt(5)
  v_cvt_pk_bf16_f32 v67, v70, v71
  v_mfma_f32_16x16x32_bf16 v[92:95], v[52:55], v[132:135], v[92:95]
  ds_read_b128 v[44:47], v250 offset:18688
  v_accvgpr_write_b32 a56, v64
  v_mfma_f32_16x16x32_bf16 v[100:103], v[52:55], v[164:167], v[100:103]
  v_accvgpr_write_b32 a57, v65
  v_accvgpr_write_b32 a58, v66
  v_mfma_f32_16x16x32_bf16 v[108:111], v[52:55], v[196:199], v[108:111]
  v_accvgpr_write_b32 a59, v67
  v_mfma_f32_16x16x32_bf16 v[116:119], v[52:55], v[228:231], v[116:119]
  s_waitcnt lgkmcnt(5)
  v_mul_f32 v72, v12, v72
  v_mfma_f32_16x16x32_bf16 v[88:91], v[24:27], v[136:139], v[88:91]
  ds_read_b128 v[48:51], v251 offset:16640
  v_mul_f32 v73, v12, v73
  v_mfma_f32_16x16x32_bf16 v[96:99], v[24:27], v[168:171], v[96:99]
  v_mul_f32 v74, v12, v74
  v_mul_f32 v75, v12, v75
  v_mfma_f32_16x16x32_bf16 v[104:107], v[24:27], v[200:203], v[104:107]
  v_mul_f32 v76, v12, v76
  v_mfma_f32_16x16x32_bf16 v[112:115], v[24:27], v[232:235], v[112:115]
  s_waitcnt lgkmcnt(5)
  v_mul_f32 v77, v12, v77
  v_mfma_f32_16x16x32_bf16 v[92:95], v[28:31], v[136:139], v[92:95]
  ds_read_b128 v[52:55], v251 offset:18688
  v_mul_f32 v78, v12, v78
  v_mfma_f32_16x16x32_bf16 v[100:103], v[28:31], v[168:171], v[100:103]
  v_mul_f32 v79, v12, v79
  v_cvt_pk_bf16_f32 v72, v72, v73
  v_mfma_f32_16x16x32_bf16 v[108:111], v[28:31], v[200:203], v[108:111]
  v_cvt_pk_bf16_f32 v73, v74, v75
  v_mfma_f32_16x16x32_bf16 v[116:119], v[28:31], v[232:235], v[116:119]
  s_waitcnt lgkmcnt(5)
  v_cvt_pk_bf16_f32 v74, v76, v77
  v_mfma_f32_16x16x32_bf16 v[88:91], v[32:35], v[140:143], v[88:91]
  s_waitcnt vmcnt(20)
  s_barrier
  ds_read_b128 v[24:27], v248 offset:32768
  v_cvt_pk_bf16_f32 v75, v78, v79
  v_mfma_f32_16x16x32_bf16 v[96:99], v[32:35], v[172:175], v[96:99]
  v_accvgpr_write_b32 a112, v72
  v_accvgpr_write_b32 a113, v73
  v_mfma_f32_16x16x32_bf16 v[104:107], v[32:35], v[204:207], v[104:107]
  v_accvgpr_write_b32 a114, v74
  v_mfma_f32_16x16x32_bf16 v[112:115], v[32:35], v[236:239], v[112:115]
  s_waitcnt lgkmcnt(5)
  v_accvgpr_write_b32 a115, v75
  v_mfma_f32_16x16x32_bf16 v[92:95], v[36:39], v[140:143], v[92:95]
  ds_read_b128 v[28:31], v248 offset:34816
  v_mul_f32 v80, v12, v80
  v_mfma_f32_16x16x32_bf16 v[100:103], v[36:39], v[172:175], v[100:103]
  v_mul_f32 v81, v12, v81
  v_mul_f32 v82, v12, v82
  v_mfma_f32_16x16x32_bf16 v[108:111], v[36:39], v[204:207], v[108:111]
  v_mul_f32 v83, v12, v83
  v_mfma_f32_16x16x32_bf16 v[116:119], v[36:39], v[236:239], v[116:119]
  s_waitcnt lgkmcnt(5)
  v_mul_f32 v84, v12, v84
  v_mfma_f32_16x16x32_bf16 v[88:91], v[40:43], v[144:147], v[88:91]
  ds_read_b128 v[32:35], v249 offset:32768
  v_mul_f32 v85, v12, v85
  v_mfma_f32_16x16x32_bf16 v[96:99], v[40:43], v[176:179], v[96:99]
  v_mul_f32 v86, v12, v86
  v_mul_f32 v87, v12, v87
  v_mfma_f32_16x16x32_bf16 v[104:107], v[40:43], v[208:211], v[104:107]
  v_cvt_pk_bf16_f32 v80, v80, v81
  v_mfma_f32_16x16x32_bf16 v[112:115], v[40:43], v[240:243], v[112:115]
  s_waitcnt lgkmcnt(5)
  v_cvt_pk_bf16_f32 v81, v82, v83
  v_mfma_f32_16x16x32_bf16 v[92:95], v[44:47], v[144:147], v[92:95]
  ds_read_b128 v[36:39], v249 offset:34816
  v_cvt_pk_bf16_f32 v82, v84, v85
  v_mfma_f32_16x16x32_bf16 v[100:103], v[44:47], v[176:179], v[100:103]
  v_cvt_pk_bf16_f32 v83, v86, v87
  v_accvgpr_write_b32 a168, v80
  v_mfma_f32_16x16x32_bf16 v[108:111], v[44:47], v[208:211], v[108:111]
  v_accvgpr_write_b32 a169, v81
  v_mfma_f32_16x16x32_bf16 v[116:119], v[44:47], v[240:243], v[116:119]
  s_waitcnt lgkmcnt(5)
  v_accvgpr_write_b32 a170, v82
  v_mfma_f32_16x16x32_bf16 v[88:91], v[48:51], v[148:151], v[88:91]
  ds_read_b128 v[40:43], v250 offset:32768
  v_accvgpr_write_b32 a171, v83
  v_mfma_f32_16x16x32_bf16 v[96:99], v[48:51], v[180:183], v[96:99]
  v_mfma_f32_16x16x32_bf16 v[104:107], v[48:51], v[212:215], v[104:107]
  v_mfma_f32_16x16x32_bf16 v[112:115], v[48:51], v[244:247], v[112:115]
  s_waitcnt lgkmcnt(5)
  v_mfma_f32_16x16x32_bf16 v[92:95], v[52:55], v[148:151], v[92:95]
  ds_read_b128 v[44:47], v250 offset:34816
  v_mfma_f32_16x16x32_bf16 v[100:103], v[52:55], v[180:183], v[100:103]
  v_mfma_f32_16x16x32_bf16 v[108:111], v[52:55], v[212:215], v[108:111]
  v_mfma_f32_16x16x32_bf16 v[116:119], v[52:55], v[244:247], v[116:119]
  s_waitcnt lgkmcnt(5)
  v_mfma_f32_16x16x32_bf16 v[56:59], v[24:27], v[120:123], 0
  ds_read_b128 v[48:51], v251 offset:32768
  v_mfma_f32_16x16x32_bf16 v[64:67], v[24:27], v[152:155], 0
  v_mfma_f32_16x16x32_bf16 v[72:75], v[24:27], v[184:187], 0
  s_add_u32 m0, s29, 131072
  s_add_u32 s27, s28, 2097152
  buffer_load_dwordx4 v14, s[60:63], s27 offen lds
  v_mfma_f32_16x16x32_bf16 v[80:83], v[24:27], v[216:219], 0
  s_waitcnt lgkmcnt(5)
  v_mul_f32 v88, v12, v88
  v_mfma_f32_16x16x32_bf16 v[60:63], v[28:31], v[120:123], 0
  ds_read_b128 v[52:55], v251 offset:34816
  v_mul_f32 v89, v12, v89
  v_mfma_f32_16x16x32_bf16 v[68:71], v[28:31], v[152:155], 0
  v_mul_f32 v90, v12, v90
  v_mul_f32 v91, v12, v91
  v_mfma_f32_16x16x32_bf16 v[76:79], v[28:31], v[184:187], 0
  v_mul_f32 v92, v12, v92
  v_mfma_f32_16x16x32_bf16 v[84:87], v[28:31], v[216:219], 0
  s_waitcnt lgkmcnt(5)
  v_mul_f32 v93, v12, v93
  v_mfma_f32_16x16x32_bf16 v[56:59], v[32:35], v[124:127], v[56:59]
  ds_read_b128 v[24:27], v248 offset:33024
  v_mul_f32 v94, v12, v94
  v_mfma_f32_16x16x32_bf16 v[64:67], v[32:35], v[156:159], v[64:67]
  v_mul_f32 v95, v12, v95
  v_cvt_pk_bf16_f32 v88, v88, v89
  v_mfma_f32_16x16x32_bf16 v[72:75], v[32:35], v[188:191], v[72:75]
  s_add_u32 m0, s29, 132096
  s_add_u32 s27, s28, 2113536
  buffer_load_dwordx4 v15, s[60:63], s27 offen lds
  v_mfma_f32_16x16x32_bf16 v[80:83], v[32:35], v[220:223], v[80:83]
  s_waitcnt lgkmcnt(5)
  v_cvt_pk_bf16_f32 v89, v90, v91
  v_mfma_f32_16x16x32_bf16 v[60:63], v[36:39], v[124:127], v[60:63]
  ds_read_b128 v[28:31], v248 offset:35072
  v_cvt_pk_bf16_f32 v90, v92, v93
  v_mfma_f32_16x16x32_bf16 v[68:71], v[36:39], v[156:159], v[68:71]
  v_cvt_pk_bf16_f32 v91, v94, v95
  v_accvgpr_write_b32 a4, v88
  v_mfma_f32_16x16x32_bf16 v[76:79], v[36:39], v[188:191], v[76:79]
  v_accvgpr_write_b32 a5, v89
  v_mfma_f32_16x16x32_bf16 v[84:87], v[36:39], v[220:223], v[84:87]
  s_waitcnt lgkmcnt(5)
  v_accvgpr_write_b32 a6, v90
  v_mfma_f32_16x16x32_bf16 v[56:59], v[40:43], v[128:131], v[56:59]
  ds_read_b128 v[32:35], v249 offset:33024
  v_accvgpr_write_b32 a7, v91
  v_mfma_f32_16x16x32_bf16 v[64:67], v[40:43], v[160:163], v[64:67]
  v_mul_f32 v96, v12, v96
  v_mul_f32 v97, v12, v97
  v_mfma_f32_16x16x32_bf16 v[72:75], v[40:43], v[192:195], v[72:75]
  s_add_u32 m0, s29, 133120
  s_add_u32 s27, s28, 2129920
  buffer_load_dwordx4 v14, s[60:63], s27 offen lds
  v_mfma_f32_16x16x32_bf16 v[80:83], v[40:43], v[224:227], v[80:83]
  s_waitcnt lgkmcnt(5)
  v_mul_f32 v98, v12, v98
  v_mfma_f32_16x16x32_bf16 v[60:63], v[44:47], v[128:131], v[60:63]
  ds_read_b128 v[36:39], v249 offset:35072
  v_mul_f32 v99, v12, v99
  v_mfma_f32_16x16x32_bf16 v[68:71], v[44:47], v[160:163], v[68:71]
  v_mul_f32 v100, v12, v100
  v_mul_f32 v101, v12, v101
  v_mfma_f32_16x16x32_bf16 v[76:79], v[44:47], v[192:195], v[76:79]
  v_mul_f32 v102, v12, v102
  v_mfma_f32_16x16x32_bf16 v[84:87], v[44:47], v[224:227], v[84:87]
  s_waitcnt lgkmcnt(5)
  v_mul_f32 v103, v12, v103
  v_mfma_f32_16x16x32_bf16 v[56:59], v[48:51], v[132:135], v[56:59]
  ds_read_b128 v[40:43], v250 offset:33024
  v_cvt_pk_bf16_f32 v96, v96, v97
  v_mfma_f32_16x16x32_bf16 v[64:67], v[48:51], v[164:167], v[64:67]
  v_cvt_pk_bf16_f32 v97, v98, v99
  v_cvt_pk_bf16_f32 v98, v100, v101
  v_mfma_f32_16x16x32_bf16 v[72:75], v[48:51], v[196:199], v[72:75]
  s_add_u32 m0, s29, 134144
  s_add_u32 s27, s28, 2146304
  buffer_load_dwordx4 v15, s[60:63], s27 offen lds
  v_mfma_f32_16x16x32_bf16 v[80:83], v[48:51], v[228:231], v[80:83]
  s_waitcnt lgkmcnt(5)
  v_cvt_pk_bf16_f32 v99, v102, v103
  v_mfma_f32_16x16x32_bf16 v[60:63], v[52:55], v[132:135], v[60:63]
  ds_read_b128 v[44:47], v250 offset:35072
  v_accvgpr_write_b32 a60, v96
  v_mfma_f32_16x16x32_bf16 v[68:71], v[52:55], v[164:167], v[68:71]
  v_accvgpr_write_b32 a61, v97
  v_accvgpr_write_b32 a62, v98
  v_mfma_f32_16x16x32_bf16 v[76:79], v[52:55], v[196:199], v[76:79]
  v_accvgpr_write_b32 a63, v99
  v_mfma_f32_16x16x32_bf16 v[84:87], v[52:55], v[228:231], v[84:87]
  s_waitcnt lgkmcnt(5)
  v_mul_f32 v104, v12, v104
  v_mfma_f32_16x16x32_bf16 v[56:59], v[24:27], v[136:139], v[56:59]
  ds_read_b128 v[48:51], v251 offset:33024
  v_mul_f32 v105, v12, v105
  v_mfma_f32_16x16x32_bf16 v[64:67], v[24:27], v[168:171], v[64:67]
  v_mul_f32 v106, v12, v106
  v_mul_f32 v107, v12, v107
  v_mfma_f32_16x16x32_bf16 v[72:75], v[24:27], v[200:203], v[72:75]
  v_mul_f32 v108, v12, v108
  v_mfma_f32_16x16x32_bf16 v[80:83], v[24:27], v[232:235], v[80:83]
  s_waitcnt lgkmcnt(5)
  v_mul_f32 v109, v12, v109
  v_mfma_f32_16x16x32_bf16 v[60:63], v[28:31], v[136:139], v[60:63]
  ds_read_b128 v[52:55], v251 offset:35072
  v_mul_f32 v110, v12, v110
  v_mfma_f32_16x16x32_bf16 v[68:71], v[28:31], v[168:171], v[68:71]
  v_mul_f32 v111, v12, v111
  v_cvt_pk_bf16_f32 v104, v104, v105
  v_mfma_f32_16x16x32_bf16 v[76:79], v[28:31], v[200:203], v[76:79]
  v_cvt_pk_bf16_f32 v105, v106, v107
  v_mfma_f32_16x16x32_bf16 v[84:87], v[28:31], v[232:235], v[84:87]
  s_waitcnt lgkmcnt(5)
  v_cvt_pk_bf16_f32 v106, v108, v109
  v_mfma_f32_16x16x32_bf16 v[56:59], v[32:35], v[140:143], v[56:59]
  s_waitcnt vmcnt(20)
  s_barrier
  ds_read_b128 v[24:27], v248 offset:49152
  v_cvt_pk_bf16_f32 v107, v110, v111
  v_mfma_f32_16x16x32_bf16 v[64:67], v[32:35], v[172:175], v[64:67]
  v_accvgpr_write_b32 a116, v104
  v_accvgpr_write_b32 a117, v105
  v_mfma_f32_16x16x32_bf16 v[72:75], v[32:35], v[204:207], v[72:75]
  v_accvgpr_write_b32 a118, v106
  v_mfma_f32_16x16x32_bf16 v[80:83], v[32:35], v[236:239], v[80:83]
  s_waitcnt lgkmcnt(5)
  v_accvgpr_write_b32 a119, v107
  v_mfma_f32_16x16x32_bf16 v[60:63], v[36:39], v[140:143], v[60:63]
  ds_read_b128 v[28:31], v248 offset:51200
  v_mul_f32 v112, v12, v112
  v_mfma_f32_16x16x32_bf16 v[68:71], v[36:39], v[172:175], v[68:71]
  v_mul_f32 v113, v12, v113
  v_mul_f32 v114, v12, v114
  v_mfma_f32_16x16x32_bf16 v[76:79], v[36:39], v[204:207], v[76:79]
  v_mul_f32 v115, v12, v115
  v_mfma_f32_16x16x32_bf16 v[84:87], v[36:39], v[236:239], v[84:87]
  s_waitcnt lgkmcnt(5)
  v_mul_f32 v116, v12, v116
  v_mfma_f32_16x16x32_bf16 v[56:59], v[40:43], v[144:147], v[56:59]
  ds_read_b128 v[32:35], v249 offset:49152
  v_mul_f32 v117, v12, v117
  v_mfma_f32_16x16x32_bf16 v[64:67], v[40:43], v[176:179], v[64:67]
  v_mul_f32 v118, v12, v118
  v_mul_f32 v119, v12, v119
  v_mfma_f32_16x16x32_bf16 v[72:75], v[40:43], v[208:211], v[72:75]
  v_cvt_pk_bf16_f32 v112, v112, v113
  v_mfma_f32_16x16x32_bf16 v[80:83], v[40:43], v[240:243], v[80:83]
  s_waitcnt lgkmcnt(5)
  v_cvt_pk_bf16_f32 v113, v114, v115
  v_mfma_f32_16x16x32_bf16 v[60:63], v[44:47], v[144:147], v[60:63]
  ds_read_b128 v[36:39], v249 offset:51200
  v_cvt_pk_bf16_f32 v114, v116, v117
  v_mfma_f32_16x16x32_bf16 v[68:71], v[44:47], v[176:179], v[68:71]
  v_cvt_pk_bf16_f32 v115, v118, v119
  v_accvgpr_write_b32 a172, v112
  v_mfma_f32_16x16x32_bf16 v[76:79], v[44:47], v[208:211], v[76:79]
  v_accvgpr_write_b32 a173, v113
  v_mfma_f32_16x16x32_bf16 v[84:87], v[44:47], v[240:243], v[84:87]
  s_waitcnt lgkmcnt(5)
  v_accvgpr_write_b32 a174, v114
  v_mfma_f32_16x16x32_bf16 v[56:59], v[48:51], v[148:151], v[56:59]
  ds_read_b128 v[40:43], v250 offset:49152
  v_accvgpr_write_b32 a175, v115
  v_mfma_f32_16x16x32_bf16 v[64:67], v[48:51], v[180:183], v[64:67]
  v_mfma_f32_16x16x32_bf16 v[72:75], v[48:51], v[212:215], v[72:75]
  v_mfma_f32_16x16x32_bf16 v[80:83], v[48:51], v[244:247], v[80:83]
  s_waitcnt lgkmcnt(5)
  v_mfma_f32_16x16x32_bf16 v[60:63], v[52:55], v[148:151], v[60:63]
  ds_read_b128 v[44:47], v250 offset:51200
  v_mfma_f32_16x16x32_bf16 v[68:71], v[52:55], v[180:183], v[68:71]
  v_mfma_f32_16x16x32_bf16 v[76:79], v[52:55], v[212:215], v[76:79]
  v_mfma_f32_16x16x32_bf16 v[84:87], v[52:55], v[244:247], v[84:87]
  s_waitcnt lgkmcnt(5)
  s_getpc_b64 s[98:99]
  s_add_u32 s98, s98, 4096
  s_addc_u32 s99, s99, 0
  global_load_dword v7, v6, s[98:99]
  v_mfma_f32_16x16x32_bf16 v[88:91], v[24:27], v[120:123], 0
  ds_read_b128 v[48:51], v251 offset:49152
  v_mfma_f32_16x16x32_bf16 v[96:99], v[24:27], v[152:155], 0
  v_mfma_f32_16x16x32_bf16 v[104:107], v[24:27], v[184:187], 0
  buffer_load_dword v13, off, s[12:15], 0 offset:128 sc1
  buffer_load_dword v9, off, s[12:15], 0 sc1
  s_add_u32 m0, s29, 147456
  s_add_u32 s27, s28, 2359296
  buffer_load_dwordx4 v14, s[60:63], s27 offen lds
  v_mfma_f32_16x16x32_bf16 v[112:115], v[24:27], v[216:219], 0
  s_waitcnt lgkmcnt(5)
  v_mul_f32 v56, v12, v56
  v_mfma_f32_16x16x32_bf16 v[92:95], v[28:31], v[120:123], 0
  ds_read_b128 v[52:55], v251 offset:51200
  v_mul_f32 v57, v12, v57
  v_mfma_f32_16x16x32_bf16 v[100:103], v[28:31], v[152:155], 0
  v_mul_f32 v58, v12, v58
  v_mul_f32 v59, v12, v59
  v_mfma_f32_16x16x32_bf16 v[108:111], v[28:31], v[184:187], 0
  v_mul_f32 v60, v12, v60
  v_mfma_f32_16x16x32_bf16 v[116:119], v[28:31], v[216:219], 0
  s_waitcnt lgkmcnt(5)
  v_mul_f32 v61, v12, v61
  v_mfma_f32_16x16x32_bf16 v[88:91], v[32:35], v[124:127], v[88:91]
  ds_read_b128 v[24:27], v248 offset:49408
  v_mul_f32 v62, v12, v62
  v_mfma_f32_16x16x32_bf16 v[96:99], v[32:35], v[156:159], v[96:99]
  v_mul_f32 v63, v12, v63
  v_cvt_pk_bf16_f32 v56, v56, v57
  v_mfma_f32_16x16x32_bf16 v[104:107], v[32:35], v[188:191], v[104:107]
  s_add_u32 m0, s29, 148480
  s_add_u32 s27, s28, 2375680
  buffer_load_dwordx4 v15, s[60:63], s27 offen lds
  v_mfma_f32_16x16x32_bf16 v[112:115], v[32:35], v[220:223], v[112:115]
  s_waitcnt lgkmcnt(5)
  v_cvt_pk_bf16_f32 v57, v58, v59
  v_mfma_f32_16x16x32_bf16 v[92:95], v[36:39], v[124:127], v[92:95]
  ds_read_b128 v[28:31], v248 offset:51456
  v_cvt_pk_bf16_f32 v58, v60, v61
  v_mfma_f32_16x16x32_bf16 v[100:103], v[36:39], v[156:159], v[100:103]
  v_cvt_pk_bf16_f32 v59, v62, v63
  v_accvgpr_write_b32 a8, v56
  v_mfma_f32_16x16x32_bf16 v[108:111], v[36:39], v[188:191], v[108:111]
  v_accvgpr_write_b32 a9, v57
  v_mfma_f32_16x16x32_bf16 v[116:119], v[36:39], v[220:223], v[116:119]
  s_waitcnt lgkmcnt(5)
  v_accvgpr_write_b32 a10, v58
  v_mfma_f32_16x16x32_bf16 v[88:91], v[40:43], v[128:131], v[88:91]
  ds_read_b128 v[32:35], v249 offset:49408
  v_accvgpr_write_b32 a11, v59
  v_mfma_f32_16x16x32_bf16 v[96:99], v[40:43], v[160:163], v[96:99]
  v_mul_f32 v64, v12, v64
  v_mul_f32 v65, v12, v65
  v_mfma_f32_16x16x32_bf16 v[104:107], v[40:43], v[192:195], v[104:107]
  s_add_u32 m0, s29, 149504
  s_add_u32 s27, s28, 2392064
  buffer_load_dwordx4 v14, s[60:63], s27 offen lds
  v_mfma_f32_16x16x32_bf16 v[112:115], v[40:43], v[224:227], v[112:115]
  s_waitcnt lgkmcnt(5)
  v_mul_f32 v66, v12, v66
  v_mfma_f32_16x16x32_bf16 v[92:95], v[44:47], v[128:131], v[92:95]
  ds_read_b128 v[36:39], v249 offset:51456
  v_mul_f32 v67, v12, v67
  v_mfma_f32_16x16x32_bf16 v[100:103], v[44:47], v[160:163], v[100:103]
  v_mul_f32 v68, v12, v68
  v_mul_f32 v69, v12, v69
  v_mfma_f32_16x16x32_bf16 v[108:111], v[44:47], v[192:195], v[108:111]
  v_mul_f32 v70, v12, v70
  v_mfma_f32_16x16x32_bf16 v[116:119], v[44:47], v[224:227], v[116:119]
  s_waitcnt lgkmcnt(5)
  v_mul_f32 v71, v12, v71
  v_mfma_f32_16x16x32_bf16 v[88:91], v[48:51], v[132:135], v[88:91]
  ds_read_b128 v[40:43], v250 offset:49408
  v_cvt_pk_bf16_f32 v64, v64, v65
  v_mfma_f32_16x16x32_bf16 v[96:99], v[48:51], v[164:167], v[96:99]
  v_cvt_pk_bf16_f32 v65, v66, v67
  v_cvt_pk_bf16_f32 v66, v68, v69
  v_mfma_f32_16x16x32_bf16 v[104:107], v[48:51], v[196:199], v[104:107]
  s_add_u32 m0, s29, 150528
  s_add_u32 s27, s28, 2408448
  buffer_load_dwordx4 v15, s[60:63], s27 offen lds
  v_mfma_f32_16x16x32_bf16 v[112:115], v[48:51], v[228:231], v[112:115]
  s_waitcnt lgkmcnt(5)
  v_cvt_pk_bf16_f32 v67, v70, v71
  v_mfma_f32_16x16x32_bf16 v[92:95], v[52:55], v[132:135], v[92:95]
  ds_read_b128 v[44:47], v250 offset:51456
  v_accvgpr_write_b32 a64, v64
  v_mfma_f32_16x16x32_bf16 v[100:103], v[52:55], v[164:167], v[100:103]
  v_accvgpr_write_b32 a65, v65
  v_accvgpr_write_b32 a66, v66
  v_mfma_f32_16x16x32_bf16 v[108:111], v[52:55], v[196:199], v[108:111]
  v_accvgpr_write_b32 a67, v67
  v_mfma_f32_16x16x32_bf16 v[116:119], v[52:55], v[228:231], v[116:119]
  s_waitcnt lgkmcnt(5)
  v_mul_f32 v72, v12, v72
  v_mfma_f32_16x16x32_bf16 v[88:91], v[24:27], v[136:139], v[88:91]
  ds_read_b128 v[48:51], v251 offset:49408
  v_mul_f32 v73, v12, v73
  v_mfma_f32_16x16x32_bf16 v[96:99], v[24:27], v[168:171], v[96:99]
  v_mul_f32 v74, v12, v74
  v_mul_f32 v75, v12, v75
  v_mfma_f32_16x16x32_bf16 v[104:107], v[24:27], v[200:203], v[104:107]
  v_mul_f32 v76, v12, v76
  v_mfma_f32_16x16x32_bf16 v[112:115], v[24:27], v[232:235], v[112:115]
  s_waitcnt lgkmcnt(5)
  v_mul_f32 v77, v12, v77
  v_mfma_f32_16x16x32_bf16 v[92:95], v[28:31], v[136:139], v[92:95]
  ds_read_b128 v[52:55], v251 offset:51456
  v_mul_f32 v78, v12, v78
  v_mfma_f32_16x16x32_bf16 v[100:103], v[28:31], v[168:171], v[100:103]
  v_mul_f32 v79, v12, v79
  v_cvt_pk_bf16_f32 v72, v72, v73
  v_mfma_f32_16x16x32_bf16 v[108:111], v[28:31], v[200:203], v[108:111]
  v_cvt_pk_bf16_f32 v73, v74, v75
  v_mfma_f32_16x16x32_bf16 v[116:119], v[28:31], v[232:235], v[116:119]
  s_waitcnt lgkmcnt(5)
  v_cvt_pk_bf16_f32 v74, v76, v77
  v_mfma_f32_16x16x32_bf16 v[88:91], v[32:35], v[140:143], v[88:91]
  s_waitcnt vmcnt(20)
  s_barrier
  ds_read_b128 v[24:27], v252 offset:0
  v_cvt_pk_bf16_f32 v75, v78, v79
  v_mfma_f32_16x16x32_bf16 v[96:99], v[32:35], v[172:175], v[96:99]
  v_accvgpr_write_b32 a120, v72
  v_accvgpr_write_b32 a121, v73
  v_mfma_f32_16x16x32_bf16 v[104:107], v[32:35], v[204:207], v[104:107]
  v_accvgpr_write_b32 a122, v74
  v_mfma_f32_16x16x32_bf16 v[112:115], v[32:35], v[236:239], v[112:115]
  s_waitcnt lgkmcnt(5)
  v_accvgpr_write_b32 a123, v75
  v_mfma_f32_16x16x32_bf16 v[92:95], v[36:39], v[140:143], v[92:95]
  ds_read_b128 v[28:31], v252 offset:2048
  v_mul_f32 v80, v12, v80
  v_mfma_f32_16x16x32_bf16 v[100:103], v[36:39], v[172:175], v[100:103]
  v_mul_f32 v81, v12, v81
  v_mul_f32 v82, v12, v82
  v_mfma_f32_16x16x32_bf16 v[108:111], v[36:39], v[204:207], v[108:111]
  v_mul_f32 v83, v12, v83
  v_mfma_f32_16x16x32_bf16 v[116:119], v[36:39], v[236:239], v[116:119]
  s_waitcnt lgkmcnt(5)
  v_mul_f32 v84, v12, v84
  v_mfma_f32_16x16x32_bf16 v[88:91], v[40:43], v[144:147], v[88:91]
  ds_read_b128 v[32:35], v253 offset:0
  v_mul_f32 v85, v12, v85
  v_mfma_f32_16x16x32_bf16 v[96:99], v[40:43], v[176:179], v[96:99]
  v_mul_f32 v86, v12, v86
  v_mul_f32 v87, v12, v87
  v_mfma_f32_16x16x32_bf16 v[104:107], v[40:43], v[208:211], v[104:107]
  v_cvt_pk_bf16_f32 v80, v80, v81
  v_mfma_f32_16x16x32_bf16 v[112:115], v[40:43], v[240:243], v[112:115]
  s_waitcnt lgkmcnt(5)
  v_cvt_pk_bf16_f32 v81, v82, v83
  v_mfma_f32_16x16x32_bf16 v[92:95], v[44:47], v[144:147], v[92:95]
  ds_read_b128 v[36:39], v253 offset:2048
  v_cvt_pk_bf16_f32 v82, v84, v85
  v_mfma_f32_16x16x32_bf16 v[100:103], v[44:47], v[176:179], v[100:103]
  v_cvt_pk_bf16_f32 v83, v86, v87
  v_accvgpr_write_b32 a176, v80
  v_mfma_f32_16x16x32_bf16 v[108:111], v[44:47], v[208:211], v[108:111]
  v_accvgpr_write_b32 a177, v81
  v_mfma_f32_16x16x32_bf16 v[116:119], v[44:47], v[240:243], v[116:119]
  s_waitcnt lgkmcnt(5)
  v_accvgpr_write_b32 a178, v82
  v_mfma_f32_16x16x32_bf16 v[88:91], v[48:51], v[148:151], v[88:91]
  ds_read_b128 v[40:43], v254 offset:0
  v_accvgpr_write_b32 a179, v83
  v_mfma_f32_16x16x32_bf16 v[96:99], v[48:51], v[180:183], v[96:99]
  v_mfma_f32_16x16x32_bf16 v[104:107], v[48:51], v[212:215], v[104:107]
  v_mfma_f32_16x16x32_bf16 v[112:115], v[48:51], v[244:247], v[112:115]
  s_waitcnt lgkmcnt(5)
  v_mfma_f32_16x16x32_bf16 v[92:95], v[52:55], v[148:151], v[92:95]
  ds_read_b128 v[44:47], v254 offset:2048
  v_mfma_f32_16x16x32_bf16 v[100:103], v[52:55], v[180:183], v[100:103]
  v_mfma_f32_16x16x32_bf16 v[108:111], v[52:55], v[212:215], v[108:111]
  v_mfma_f32_16x16x32_bf16 v[116:119], v[52:55], v[244:247], v[116:119]
  s_waitcnt lgkmcnt(5)
  v_mfma_f32_16x16x32_bf16 v[56:59], v[24:27], v[120:123], 0
  ds_read_b128 v[48:51], v255 offset:0
  v_mfma_f32_16x16x32_bf16 v[64:67], v[24:27], v[152:155], 0
  v_mfma_f32_16x16x32_bf16 v[72:75], v[24:27], v[184:187], 0
  s_add_u32 m0, s29, 0
  s_add_u32 s27, s28, 2621440
  buffer_load_dwordx4 v14, s[60:63], s27 offen lds
  v_mfma_f32_16x16x32_bf16 v[80:83], v[24:27], v[216:219], 0
  s_waitcnt lgkmcnt(5)
  v_mul_f32 v88, v12, v88
  v_mfma_f32_16x16x32_bf16 v[60:63], v[28:31], v[120:123], 0
  ds_read_b128 v[52:55], v255 offset:2048
  v_mul_f32 v89, v12, v89
  v_mfma_f32_16x16x32_bf16 v[68:71], v[28:31], v[152:155], 0
  v_mul_f32 v90, v12, v90
  v_mul_f32 v91, v12, v91
  v_mfma_f32_16x16x32_bf16 v[76:79], v[28:31], v[184:187], 0
  v_mul_f32 v92, v12, v92
  v_mfma_f32_16x16x32_bf16 v[84:87], v[28:31], v[216:219], 0
  s_waitcnt lgkmcnt(5)
  v_mul_f32 v93, v12, v93
  v_mfma_f32_16x16x32_bf16 v[56:59], v[32:35], v[124:127], v[56:59]
  ds_read_b128 v[24:27], v252 offset:256
  v_mul_f32 v94, v12, v94
  v_mfma_f32_16x16x32_bf16 v[64:67], v[32:35], v[156:159], v[64:67]
  v_mul_f32 v95, v12, v95
  v_cvt_pk_bf16_f32 v88, v88, v89
  v_mfma_f32_16x16x32_bf16 v[72:75], v[32:35], v[188:191], v[72:75]
  s_add_u32 m0, s29, 1024
  s_add_u32 s27, s28, 2637824
  buffer_load_dwordx4 v15, s[60:63], s27 offen lds
  v_mfma_f32_16x16x32_bf16 v[80:83], v[32:35], v[220:223], v[80:83]
  s_waitcnt lgkmcnt(5)
  v_cvt_pk_bf16_f32 v89, v90, v91
  v_mfma_f32_16x16x32_bf16 v[60:63], v[36:39], v[124:127], v[60:63]
  ds_read_b128 v[28:31], v252 offset:2304
  v_cvt_pk_bf16_f32 v90, v92, v93
  v_mfma_f32_16x16x32_bf16 v[68:71], v[36:39], v[156:159], v[68:71]
  v_cvt_pk_bf16_f32 v91, v94, v95
  v_accvgpr_write_b32 a12, v88
  v_mfma_f32_16x16x32_bf16 v[76:79], v[36:39], v[188:191], v[76:79]
  v_accvgpr_write_b32 a13, v89
  v_mfma_f32_16x16x32_bf16 v[84:87], v[36:39], v[220:223], v[84:87]
  s_waitcnt lgkmcnt(5)
  v_accvgpr_write_b32 a14, v90
  v_mfma_f32_16x16x32_bf16 v[56:59], v[40:43], v[128:131], v[56:59]
  ds_read_b128 v[32:35], v253 offset:256
  v_accvgpr_write_b32 a15, v91
  v_mfma_f32_16x16x32_bf16 v[64:67], v[40:43], v[160:163], v[64:67]
  v_mul_f32 v96, v12, v96
  v_mul_f32 v97, v12, v97
  v_mfma_f32_16x16x32_bf16 v[72:75], v[40:43], v[192:195], v[72:75]
  s_add_u32 m0, s29, 2048
  s_add_u32 s27, s28, 2654208
  buffer_load_dwordx4 v14, s[60:63], s27 offen lds
  v_mfma_f32_16x16x32_bf16 v[80:83], v[40:43], v[224:227], v[80:83]
  s_waitcnt lgkmcnt(5)
  v_mul_f32 v98, v12, v98
  v_mfma_f32_16x16x32_bf16 v[60:63], v[44:47], v[128:131], v[60:63]
  ds_read_b128 v[36:39], v253 offset:2304
  v_mul_f32 v99, v12, v99
  v_mfma_f32_16x16x32_bf16 v[68:71], v[44:47], v[160:163], v[68:71]
  v_mul_f32 v100, v12, v100
  v_mul_f32 v101, v12, v101
  v_mfma_f32_16x16x32_bf16 v[76:79], v[44:47], v[192:195], v[76:79]
  v_mul_f32 v102, v12, v102
  v_mfma_f32_16x16x32_bf16 v[84:87], v[44:47], v[224:227], v[84:87]
  s_waitcnt lgkmcnt(5)
  v_mul_f32 v103, v12, v103
  v_mfma_f32_16x16x32_bf16 v[56:59], v[48:51], v[132:135], v[56:59]
  ds_read_b128 v[40:43], v254 offset:256
  v_cvt_pk_bf16_f32 v96, v96, v97
  v_mfma_f32_16x16x32_bf16 v[64:67], v[48:51], v[164:167], v[64:67]
  v_cvt_pk_bf16_f32 v97, v98, v99
  v_cvt_pk_bf16_f32 v98, v100, v101
  v_mfma_f32_16x16x32_bf16 v[72:75], v[48:51], v[196:199], v[72:75]
  s_add_u32 m0, s29, 3072
  s_add_u32 s27, s28, 2670592
  buffer_load_dwordx4 v15, s[60:63], s27 offen lds
  v_mfma_f32_16x16x32_bf16 v[80:83], v[48:51], v[228:231], v[80:83]
  s_waitcnt lgkmcnt(5)
  v_cvt_pk_bf16_f32 v99, v102, v103
  v_mfma_f32_16x16x32_bf16 v[60:63], v[52:55], v[132:135], v[60:63]
  ds_read_b128 v[44:47], v254 offset:2304
  v_accvgpr_write_b32 a68, v96
  v_mfma_f32_16x16x32_bf16 v[68:71], v[52:55], v[164:167], v[68:71]
  v_accvgpr_write_b32 a69, v97
  v_accvgpr_write_b32 a70, v98
  v_mfma_f32_16x16x32_bf16 v[76:79], v[52:55], v[196:199], v[76:79]
  v_accvgpr_write_b32 a71, v99
  v_mfma_f32_16x16x32_bf16 v[84:87], v[52:55], v[228:231], v[84:87]
  s_waitcnt lgkmcnt(5)
  v_mul_f32 v104, v12, v104
  v_mfma_f32_16x16x32_bf16 v[56:59], v[24:27], v[136:139], v[56:59]
  ds_read_b128 v[48:51], v255 offset:256
  v_mul_f32 v105, v12, v105
  v_mfma_f32_16x16x32_bf16 v[64:67], v[24:27], v[168:171], v[64:67]
  v_mul_f32 v106, v12, v106
  v_mul_f32 v107, v12, v107
  v_mfma_f32_16x16x32_bf16 v[72:75], v[24:27], v[200:203], v[72:75]
  v_mul_f32 v108, v12, v108
  v_mfma_f32_16x16x32_bf16 v[80:83], v[24:27], v[232:235], v[80:83]
  s_waitcnt lgkmcnt(5)
  v_mul_f32 v109, v12, v109
  v_mfma_f32_16x16x32_bf16 v[60:63], v[28:31], v[136:139], v[60:63]
  ds_read_b128 v[52:55], v255 offset:2304
  v_mul_f32 v110, v12, v110
  v_mfma_f32_16x16x32_bf16 v[68:71], v[28:31], v[168:171], v[68:71]
  v_mul_f32 v111, v12, v111
  v_cvt_pk_bf16_f32 v104, v104, v105
  v_mfma_f32_16x16x32_bf16 v[76:79], v[28:31], v[200:203], v[76:79]
  v_cvt_pk_bf16_f32 v105, v106, v107
  v_mfma_f32_16x16x32_bf16 v[84:87], v[28:31], v[232:235], v[84:87]
  s_waitcnt lgkmcnt(5)
  v_cvt_pk_bf16_f32 v106, v108, v109
  v_mfma_f32_16x16x32_bf16 v[56:59], v[32:35], v[140:143], v[56:59]
  s_waitcnt vmcnt(20)
  s_barrier
  ds_read_b128 v[24:27], v252 offset:16384
  v_cvt_pk_bf16_f32 v107, v110, v111
  v_mfma_f32_16x16x32_bf16 v[64:67], v[32:35], v[172:175], v[64:67]
  v_accvgpr_write_b32 a124, v104
  v_accvgpr_write_b32 a125, v105
  v_mfma_f32_16x16x32_bf16 v[72:75], v[32:35], v[204:207], v[72:75]
  v_accvgpr_write_b32 a126, v106
  v_mfma_f32_16x16x32_bf16 v[80:83], v[32:35], v[236:239], v[80:83]
  s_waitcnt lgkmcnt(5)
  v_accvgpr_write_b32 a127, v107
  v_mfma_f32_16x16x32_bf16 v[60:63], v[36:39], v[140:143], v[60:63]
  ds_read_b128 v[28:31], v252 offset:18432
  v_mul_f32 v112, v12, v112
  v_mfma_f32_16x16x32_bf16 v[68:71], v[36:39], v[172:175], v[68:71]
  v_mul_f32 v113, v12, v113
  v_mul_f32 v114, v12, v114
  v_mfma_f32_16x16x32_bf16 v[76:79], v[36:39], v[204:207], v[76:79]
  v_mul_f32 v115, v12, v115
  v_mfma_f32_16x16x32_bf16 v[84:87], v[36:39], v[236:239], v[84:87]
  s_waitcnt lgkmcnt(5)
  v_mul_f32 v116, v12, v116
  v_mfma_f32_16x16x32_bf16 v[56:59], v[40:43], v[144:147], v[56:59]
  ds_read_b128 v[32:35], v253 offset:16384
  v_mul_f32 v117, v12, v117
  v_mfma_f32_16x16x32_bf16 v[64:67], v[40:43], v[176:179], v[64:67]
  v_mul_f32 v118, v12, v118
  v_mul_f32 v119, v12, v119
  v_mfma_f32_16x16x32_bf16 v[72:75], v[40:43], v[208:211], v[72:75]
  v_cvt_pk_bf16_f32 v112, v112, v113
  v_mfma_f32_16x16x32_bf16 v[80:83], v[40:43], v[240:243], v[80:83]
  s_waitcnt lgkmcnt(5)
  v_cvt_pk_bf16_f32 v113, v114, v115
  v_mfma_f32_16x16x32_bf16 v[60:63], v[44:47], v[144:147], v[60:63]
  ds_read_b128 v[36:39], v253 offset:18432
  v_cvt_pk_bf16_f32 v114, v116, v117
  v_mfma_f32_16x16x32_bf16 v[68:71], v[44:47], v[176:179], v[68:71]
  v_cvt_pk_bf16_f32 v115, v118, v119
  v_accvgpr_write_b32 a180, v112
  v_mfma_f32_16x16x32_bf16 v[76:79], v[44:47], v[208:211], v[76:79]
  v_accvgpr_write_b32 a181, v113
  v_mfma_f32_16x16x32_bf16 v[84:87], v[44:47], v[240:243], v[84:87]
  s_waitcnt lgkmcnt(5)
  v_accvgpr_write_b32 a182, v114
  v_mfma_f32_16x16x32_bf16 v[56:59], v[48:51], v[148:151], v[56:59]
  ds_read_b128 v[40:43], v254 offset:16384
  v_accvgpr_write_b32 a183, v115
  v_mfma_f32_16x16x32_bf16 v[64:67], v[48:51], v[180:183], v[64:67]
  v_mfma_f32_16x16x32_bf16 v[72:75], v[48:51], v[212:215], v[72:75]
  v_mfma_f32_16x16x32_bf16 v[80:83], v[48:51], v[244:247], v[80:83]
  s_waitcnt lgkmcnt(5)
  v_mfma_f32_16x16x32_bf16 v[60:63], v[52:55], v[148:151], v[60:63]
  ds_read_b128 v[44:47], v254 offset:18432
  v_mfma_f32_16x16x32_bf16 v[68:71], v[52:55], v[180:183], v[68:71]
  v_mfma_f32_16x16x32_bf16 v[76:79], v[52:55], v[212:215], v[76:79]
  v_mfma_f32_16x16x32_bf16 v[84:87], v[52:55], v[244:247], v[84:87]
  s_waitcnt lgkmcnt(5)
  v_mfma_f32_16x16x32_bf16 v[88:91], v[24:27], v[120:123], 0
  ds_read_b128 v[48:51], v255 offset:16384
  v_mfma_f32_16x16x32_bf16 v[96:99], v[24:27], v[152:155], 0
  v_mfma_f32_16x16x32_bf16 v[104:107], v[24:27], v[184:187], 0
  s_add_u32 m0, s29, 16384
  s_add_u32 s27, s28, 2883584
  buffer_load_dwordx4 v14, s[60:63], s27 offen lds
  v_mfma_f32_16x16x32_bf16 v[112:115], v[24:27], v[216:219], 0
  s_waitcnt lgkmcnt(5)
  v_mul_f32 v56, v12, v56
  v_mfma_f32_16x16x32_bf16 v[92:95], v[28:31], v[120:123], 0
  ds_read_b128 v[52:55], v255 offset:18432
  v_mul_f32 v57, v12, v57
  v_mfma_f32_16x16x32_bf16 v[100:103], v[28:31], v[152:155], 0
  v_mul_f32 v58, v12, v58
  v_mul_f32 v59, v12, v59
  v_mfma_f32_16x16x32_bf16 v[108:111], v[28:31], v[184:187], 0
  v_mul_f32 v60, v12, v60
  v_mfma_f32_16x16x32_bf16 v[116:119], v[28:31], v[216:219], 0
  s_waitcnt lgkmcnt(5)
  v_mul_f32 v61, v12, v61
  v_mfma_f32_16x16x32_bf16 v[88:91], v[32:35], v[124:127], v[88:91]
  ds_read_b128 v[24:27], v252 offset:16640
  v_mul_f32 v62, v12, v62
  v_mfma_f32_16x16x32_bf16 v[96:99], v[32:35], v[156:159], v[96:99]
  v_mul_f32 v63, v12, v63
  v_cvt_pk_bf16_f32 v56, v56, v57
  v_mfma_f32_16x16x32_bf16 v[104:107], v[32:35], v[188:191], v[104:107]
  s_add_u32 m0, s29, 17408
  s_add_u32 s27, s28, 2899968
  buffer_load_dwordx4 v15, s[60:63], s27 offen lds
  v_mfma_f32_16x16x32_bf16 v[112:115], v[32:35], v[220:223], v[112:115]
  s_waitcnt lgkmcnt(5)
  v_cvt_pk_bf16_f32 v57, v58, v59
  v_mfma_f32_16x16x32_bf16 v[92:95], v[36:39], v[124:127], v[92:95]
  ds_read_b128 v[28:31], v252 offset:18688
  v_cvt_pk_bf16_f32 v58, v60, v61
  v_mfma_f32_16x16x32_bf16 v[100:103], v[36:39], v[156:159], v[100:103]
  v_cvt_pk_bf16_f32 v59, v62, v63
  v_accvgpr_write_b32 a16, v56
  v_mfma_f32_16x16x32_bf16 v[108:111], v[36:39], v[188:191], v[108:111]
  v_accvgpr_write_b32 a17, v57
  v_mfma_f32_16x16x32_bf16 v[116:119], v[36:39], v[220:223], v[116:119]
  s_waitcnt lgkmcnt(5)
  v_accvgpr_write_b32 a18, v58
  v_mfma_f32_16x16x32_bf16 v[88:91], v[40:43], v[128:131], v[88:91]
  ds_read_b128 v[32:35], v253 offset:16640
  v_accvgpr_write_b32 a19, v59
  v_mfma_f32_16x16x32_bf16 v[96:99], v[40:43], v[160:163], v[96:99]
  v_mul_f32 v64, v12, v64
  v_mul_f32 v65, v12, v65
  v_mfma_f32_16x16x32_bf16 v[104:107], v[40:43], v[192:195], v[104:107]
  s_add_u32 m0, s29, 18432
  s_add_u32 s27, s28, 2916352
  buffer_load_dwordx4 v14, s[60:63], s27 offen lds
  v_mfma_f32_16x16x32_bf16 v[112:115], v[40:43], v[224:227], v[112:115]
  s_waitcnt lgkmcnt(5)
  v_mul_f32 v66, v12, v66
  v_mfma_f32_16x16x32_bf16 v[92:95], v[44:47], v[128:131], v[92:95]
  ds_read_b128 v[36:39], v253 offset:18688
  v_mul_f32 v67, v12, v67
  v_mfma_f32_16x16x32_bf16 v[100:103], v[44:47], v[160:163], v[100:103]
  v_mul_f32 v68, v12, v68
  v_mul_f32 v69, v12, v69
  v_mfma_f32_16x16x32_bf16 v[108:111], v[44:47], v[192:195], v[108:111]
  v_mul_f32 v70, v12, v70
  v_mfma_f32_16x16x32_bf16 v[116:119], v[44:47], v[224:227], v[116:119]
  s_waitcnt lgkmcnt(5)
  v_mul_f32 v71, v12, v71
  v_mfma_f32_16x16x32_bf16 v[88:91], v[48:51], v[132:135], v[88:91]
  ds_read_b128 v[40:43], v254 offset:16640
  v_cvt_pk_bf16_f32 v64, v64, v65
  v_mfma_f32_16x16x32_bf16 v[96:99], v[48:51], v[164:167], v[96:99]
  v_cvt_pk_bf16_f32 v65, v66, v67
  v_cvt_pk_bf16_f32 v66, v68, v69
  v_mfma_f32_16x16x32_bf16 v[104:107], v[48:51], v[196:199], v[104:107]
  s_add_u32 m0, s29, 19456
  s_add_u32 s27, s28, 2932736
  buffer_load_dwordx4 v15, s[60:63], s27 offen lds
  v_mfma_f32_16x16x32_bf16 v[112:115], v[48:51], v[228:231], v[112:115]
  s_waitcnt lgkmcnt(5)
  v_cvt_pk_bf16_f32 v67, v70, v71
  v_mfma_f32_16x16x32_bf16 v[92:95], v[52:55], v[132:135], v[92:95]
  ds_read_b128 v[44:47], v254 offset:18688
  v_accvgpr_write_b32 a72, v64
  v_mfma_f32_16x16x32_bf16 v[100:103], v[52:55], v[164:167], v[100:103]
  v_accvgpr_write_b32 a73, v65
  v_accvgpr_write_b32 a74, v66
  v_mfma_f32_16x16x32_bf16 v[108:111], v[52:55], v[196:199], v[108:111]
  v_accvgpr_write_b32 a75, v67
  v_mfma_f32_16x16x32_bf16 v[116:119], v[52:55], v[228:231], v[116:119]
  s_waitcnt lgkmcnt(5)
  v_mul_f32 v72, v12, v72
  v_mfma_f32_16x16x32_bf16 v[88:91], v[24:27], v[136:139], v[88:91]
  ds_read_b128 v[48:51], v255 offset:16640
  v_mul_f32 v73, v12, v73
  v_mfma_f32_16x16x32_bf16 v[96:99], v[24:27], v[168:171], v[96:99]
  v_mul_f32 v74, v12, v74
  v_mul_f32 v75, v12, v75
  v_mfma_f32_16x16x32_bf16 v[104:107], v[24:27], v[200:203], v[104:107]
  v_mul_f32 v76, v12, v76
  v_mfma_f32_16x16x32_bf16 v[112:115], v[24:27], v[232:235], v[112:115]
  s_waitcnt lgkmcnt(5)
  v_mul_f32 v77, v12, v77
  v_mfma_f32_16x16x32_bf16 v[92:95], v[28:31], v[136:139], v[92:95]
  ds_read_b128 v[52:55], v255 offset:18688
  v_mul_f32 v78, v12, v78
  v_mfma_f32_16x16x32_bf16 v[100:103], v[28:31], v[168:171], v[100:103]
  v_mul_f32 v79, v12, v79
  v_cvt_pk_bf16_f32 v72, v72, v73
  v_mfma_f32_16x16x32_bf16 v[108:111], v[28:31], v[200:203], v[108:111]
  v_cvt_pk_bf16_f32 v73, v74, v75
  v_mfma_f32_16x16x32_bf16 v[116:119], v[28:31], v[232:235], v[116:119]
  s_waitcnt lgkmcnt(5)
  v_cvt_pk_bf16_f32 v74, v76, v77
  v_mfma_f32_16x16x32_bf16 v[88:91], v[32:35], v[140:143], v[88:91]
  s_waitcnt vmcnt(20)
  s_barrier
  ds_read_b128 v[24:27], v252 offset:32768
  v_cvt_pk_bf16_f32 v75, v78, v79
  v_mfma_f32_16x16x32_bf16 v[96:99], v[32:35], v[172:175], v[96:99]
  v_accvgpr_write_b32 a128, v72
  v_accvgpr_write_b32 a129, v73
  v_mfma_f32_16x16x32_bf16 v[104:107], v[32:35], v[204:207], v[104:107]
  v_accvgpr_write_b32 a130, v74
  v_mfma_f32_16x16x32_bf16 v[112:115], v[32:35], v[236:239], v[112:115]
  s_waitcnt lgkmcnt(5)
  v_accvgpr_write_b32 a131, v75
  v_mfma_f32_16x16x32_bf16 v[92:95], v[36:39], v[140:143], v[92:95]
  ds_read_b128 v[28:31], v252 offset:34816
  v_mul_f32 v80, v12, v80
  v_mfma_f32_16x16x32_bf16 v[100:103], v[36:39], v[172:175], v[100:103]
  v_mul_f32 v81, v12, v81
  v_mul_f32 v82, v12, v82
  v_mfma_f32_16x16x32_bf16 v[108:111], v[36:39], v[204:207], v[108:111]
  v_mul_f32 v83, v12, v83
  v_mfma_f32_16x16x32_bf16 v[116:119], v[36:39], v[236:239], v[116:119]
  s_waitcnt lgkmcnt(5)
  v_mul_f32 v84, v12, v84
  v_mfma_f32_16x16x32_bf16 v[88:91], v[40:43], v[144:147], v[88:91]
  ds_read_b128 v[32:35], v253 offset:32768
  v_mul_f32 v85, v12, v85
  v_mfma_f32_16x16x32_bf16 v[96:99], v[40:43], v[176:179], v[96:99]
  v_mul_f32 v86, v12, v86
  v_mul_f32 v87, v12, v87
  v_mfma_f32_16x16x32_bf16 v[104:107], v[40:43], v[208:211], v[104:107]
  v_cvt_pk_bf16_f32 v80, v80, v81
  v_mfma_f32_16x16x32_bf16 v[112:115], v[40:43], v[240:243], v[112:115]
  s_waitcnt lgkmcnt(5)
  v_cvt_pk_bf16_f32 v81, v82, v83
  v_mfma_f32_16x16x32_bf16 v[92:95], v[44:47], v[144:147], v[92:95]
  ds_read_b128 v[36:39], v253 offset:34816
  v_cvt_pk_bf16_f32 v82, v84, v85
  v_mfma_f32_16x16x32_bf16 v[100:103], v[44:47], v[176:179], v[100:103]
  v_cvt_pk_bf16_f32 v83, v86, v87
  v_accvgpr_write_b32 a184, v80
  v_mfma_f32_16x16x32_bf16 v[108:111], v[44:47], v[208:211], v[108:111]
  v_accvgpr_write_b32 a185, v81
  v_mfma_f32_16x16x32_bf16 v[116:119], v[44:47], v[240:243], v[116:119]
  s_waitcnt lgkmcnt(5)
  v_accvgpr_write_b32 a186, v82
  v_mfma_f32_16x16x32_bf16 v[88:91], v[48:51], v[148:151], v[88:91]
  ds_read_b128 v[40:43], v254 offset:32768
  v_accvgpr_write_b32 a187, v83
  v_mfma_f32_16x16x32_bf16 v[96:99], v[48:51], v[180:183], v[96:99]
  v_mfma_f32_16x16x32_bf16 v[104:107], v[48:51], v[212:215], v[104:107]
  v_mfma_f32_16x16x32_bf16 v[112:115], v[48:51], v[244:247], v[112:115]
  s_waitcnt lgkmcnt(5)
  v_mfma_f32_16x16x32_bf16 v[92:95], v[52:55], v[148:151], v[92:95]
  ds_read_b128 v[44:47], v254 offset:34816
  v_mfma_f32_16x16x32_bf16 v[100:103], v[52:55], v[180:183], v[100:103]
  v_mfma_f32_16x16x32_bf16 v[108:111], v[52:55], v[212:215], v[108:111]
  v_mfma_f32_16x16x32_bf16 v[116:119], v[52:55], v[244:247], v[116:119]
  s_waitcnt lgkmcnt(5)
  s_getpc_b64 s[98:99]
  s_add_u32 s98, s98, 4096
  s_addc_u32 s99, s99, 0
  global_load_dword v7, v6, s[98:99]
  v_mfma_f32_16x16x32_bf16 v[56:59], v[24:27], v[120:123], 0
  ds_read_b128 v[48:51], v255 offset:32768
  v_mfma_f32_16x16x32_bf16 v[64:67], v[24:27], v[152:155], 0
  v_mfma_f32_16x16x32_bf16 v[72:75], v[24:27], v[184:187], 0
  s_add_u32 m0, s29, 32768
  s_add_u32 s27, s28, 3145728
  buffer_load_dwordx4 v14, s[60:63], s27 offen lds
  v_mfma_f32_16x16x32_bf16 v[80:83], v[24:27], v[216:219], 0
  s_waitcnt lgkmcnt(5)
  v_mul_f32 v88, v12, v88
  v_mfma_f32_16x16x32_bf16 v[60:63], v[28:31], v[120:123], 0
  ds_read_b128 v[52:55], v255 offset:34816
  v_mul_f32 v89, v12, v89
  v_mfma_f32_16x16x32_bf16 v[68:71], v[28:31], v[152:155], 0
  v_mul_f32 v90, v12, v90
  v_mul_f32 v91, v12, v91
  v_mfma_f32_16x16x32_bf16 v[76:79], v[28:31], v[184:187], 0
  v_mul_f32 v92, v12, v92
  v_mfma_f32_16x16x32_bf16 v[84:87], v[28:31], v[216:219], 0
  s_waitcnt lgkmcnt(5)
  v_mul_f32 v93, v12, v93
  v_mfma_f32_16x16x32_bf16 v[56:59], v[32:35], v[124:127], v[56:59]
  ds_read_b128 v[24:27], v252 offset:33024
  v_mul_f32 v94, v12, v94
  v_mfma_f32_16x16x32_bf16 v[64:67], v[32:35], v[156:159], v[64:67]
  v_mul_f32 v95, v12, v95
  v_cvt_pk_bf16_f32 v88, v88, v89
  v_mfma_f32_16x16x32_bf16 v[72:75], v[32:35], v[188:191], v[72:75]
  s_add_u32 m0, s29, 33792
  s_add_u32 s27, s28, 3162112
  buffer_load_dwordx4 v15, s[60:63], s27 offen lds
  v_mfma_f32_16x16x32_bf16 v[80:83], v[32:35], v[220:223], v[80:83]
  s_waitcnt lgkmcnt(5)
  v_cvt_pk_bf16_f32 v89, v90, v91
  v_mfma_f32_16x16x32_bf16 v[60:63], v[36:39], v[124:127], v[60:63]
  ds_read_b128 v[28:31], v252 offset:35072
  v_cvt_pk_bf16_f32 v90, v92, v93
  v_mfma_f32_16x16x32_bf16 v[68:71], v[36:39], v[156:159], v[68:71]
  v_cvt_pk_bf16_f32 v91, v94, v95
  v_accvgpr_write_b32 a20, v88
  v_mfma_f32_16x16x32_bf16 v[76:79], v[36:39], v[188:191], v[76:79]
  v_accvgpr_write_b32 a21, v89
  v_mfma_f32_16x16x32_bf16 v[84:87], v[36:39], v[220:223], v[84:87]
  s_waitcnt lgkmcnt(5)
  v_accvgpr_write_b32 a22, v90
  v_mfma_f32_16x16x32_bf16 v[56:59], v[40:43], v[128:131], v[56:59]
  ds_read_b128 v[32:35], v253 offset:33024
  v_accvgpr_write_b32 a23, v91
  v_mfma_f32_16x16x32_bf16 v[64:67], v[40:43], v[160:163], v[64:67]
  v_mul_f32 v96, v12, v96
  v_mul_f32 v97, v12, v97
  v_mfma_f32_16x16x32_bf16 v[72:75], v[40:43], v[192:195], v[72:75]
  s_add_u32 m0, s29, 34816
  s_add_u32 s27, s28, 3178496
  buffer_load_dwordx4 v14, s[60:63], s27 offen lds
  v_mfma_f32_16x16x32_bf16 v[80:83], v[40:43], v[224:227], v[80:83]
  s_waitcnt lgkmcnt(5)
  v_mul_f32 v98, v12, v98
  v_mfma_f32_16x16x32_bf16 v[60:63], v[44:47], v[128:131], v[60:63]
  ds_read_b128 v[36:39], v253 offset:35072
  v_mul_f32 v99, v12, v99
  v_mfma_f32_16x16x32_bf16 v[68:71], v[44:47], v[160:163], v[68:71]
  v_mul_f32 v100, v12, v100
  v_mul_f32 v101, v12, v101
  v_mfma_f32_16x16x32_bf16 v[76:79], v[44:47], v[192:195], v[76:79]
  v_mul_f32 v102, v12, v102
  v_mfma_f32_16x16x32_bf16 v[84:87], v[44:47], v[224:227], v[84:87]
  s_waitcnt lgkmcnt(5)
  v_mul_f32 v103, v12, v103
  v_mfma_f32_16x16x32_bf16 v[56:59], v[48:51], v[132:135], v[56:59]
  ds_read_b128 v[40:43], v254 offset:33024
  v_cvt_pk_bf16_f32 v96, v96, v97
  v_mfma_f32_16x16x32_bf16 v[64:67], v[48:51], v[164:167], v[64:67]
  v_cvt_pk_bf16_f32 v97, v98, v99
  v_cvt_pk_bf16_f32 v98, v100, v101
  v_mfma_f32_16x16x32_bf16 v[72:75], v[48:51], v[196:199], v[72:75]
  s_add_u32 m0, s29, 35840
  s_add_u32 s27, s28, 3194880
  buffer_load_dwordx4 v15, s[60:63], s27 offen lds
  v_mfma_f32_16x16x32_bf16 v[80:83], v[48:51], v[228:231], v[80:83]
  s_waitcnt lgkmcnt(5)
  v_cvt_pk_bf16_f32 v99, v102, v103
  v_mfma_f32_16x16x32_bf16 v[60:63], v[52:55], v[132:135], v[60:63]
  ds_read_b128 v[44:47], v254 offset:35072
  v_accvgpr_write_b32 a76, v96
  v_mfma_f32_16x16x32_bf16 v[68:71], v[52:55], v[164:167], v[68:71]
  v_accvgpr_write_b32 a77, v97
  v_accvgpr_write_b32 a78, v98
  v_mfma_f32_16x16x32_bf16 v[76:79], v[52:55], v[196:199], v[76:79]
  v_accvgpr_write_b32 a79, v99
  v_mfma_f32_16x16x32_bf16 v[84:87], v[52:55], v[228:231], v[84:87]
  s_waitcnt lgkmcnt(5)
  v_mul_f32 v104, v12, v104
  v_mfma_f32_16x16x32_bf16 v[56:59], v[24:27], v[136:139], v[56:59]
  ds_read_b128 v[48:51], v255 offset:33024
  v_mul_f32 v105, v12, v105
  v_mfma_f32_16x16x32_bf16 v[64:67], v[24:27], v[168:171], v[64:67]
  v_mul_f32 v106, v12, v106
  v_mul_f32 v107, v12, v107
  v_mfma_f32_16x16x32_bf16 v[72:75], v[24:27], v[200:203], v[72:75]
  v_mul_f32 v108, v12, v108
  v_mfma_f32_16x16x32_bf16 v[80:83], v[24:27], v[232:235], v[80:83]
  s_waitcnt lgkmcnt(5)
  v_mul_f32 v109, v12, v109
  v_mfma_f32_16x16x32_bf16 v[60:63], v[28:31], v[136:139], v[60:63]
  ds_read_b128 v[52:55], v255 offset:35072
  v_mul_f32 v110, v12, v110
  v_mfma_f32_16x16x32_bf16 v[68:71], v[28:31], v[168:171], v[68:71]
  v_mul_f32 v111, v12, v111
  v_cvt_pk_bf16_f32 v104, v104, v105
  v_mfma_f32_16x16x32_bf16 v[76:79], v[28:31], v[200:203], v[76:79]
  v_cvt_pk_bf16_f32 v105, v106, v107
  v_mfma_f32_16x16x32_bf16 v[84:87], v[28:31], v[232:235], v[84:87]
  s_waitcnt lgkmcnt(5)
  v_cvt_pk_bf16_f32 v106, v108, v109
  v_mfma_f32_16x16x32_bf16 v[56:59], v[32:35], v[140:143], v[56:59]
  s_waitcnt vmcnt(20)
  s_barrier
  ds_read_b128 v[24:27], v252 offset:49152
  v_cvt_pk_bf16_f32 v107, v110, v111
  v_mfma_f32_16x16x32_bf16 v[64:67], v[32:35], v[172:175], v[64:67]
  v_accvgpr_write_b32 a132, v104
  v_accvgpr_write_b32 a133, v105
  v_mfma_f32_16x16x32_bf16 v[72:75], v[32:35], v[204:207], v[72:75]
  v_accvgpr_write_b32 a134, v106
  v_mfma_f32_16x16x32_bf16 v[80:83], v[32:35], v[236:239], v[80:83]
  s_waitcnt lgkmcnt(5)
  v_accvgpr_write_b32 a135, v107
  v_mfma_f32_16x16x32_bf16 v[60:63], v[36:39], v[140:143], v[60:63]
  ds_read_b128 v[28:31], v252 offset:51200
  v_mul_f32 v112, v12, v112
  v_mfma_f32_16x16x32_bf16 v[68:71], v[36:39], v[172:175], v[68:71]
  v_mul_f32 v113, v12, v113
  v_mul_f32 v114, v12, v114
  v_mfma_f32_16x16x32_bf16 v[76:79], v[36:39], v[204:207], v[76:79]
  v_mul_f32 v115, v12, v115
  v_mfma_f32_16x16x32_bf16 v[84:87], v[36:39], v[236:239], v[84:87]
  s_waitcnt lgkmcnt(5)
  v_mul_f32 v116, v12, v116
  v_mfma_f32_16x16x32_bf16 v[56:59], v[40:43], v[144:147], v[56:59]
  ds_read_b128 v[32:35], v253 offset:49152
  v_mul_f32 v117, v12, v117
  v_mfma_f32_16x16x32_bf16 v[64:67], v[40:43], v[176:179], v[64:67]
  v_mul_f32 v118, v12, v118
  v_mul_f32 v119, v12, v119
  v_mfma_f32_16x16x32_bf16 v[72:75], v[40:43], v[208:211], v[72:75]
  v_cvt_pk_bf16_f32 v112, v112, v113
  v_mfma_f32_16x16x32_bf16 v[80:83], v[40:43], v[240:243], v[80:83]
  s_waitcnt lgkmcnt(5)
  v_cvt_pk_bf16_f32 v113, v114, v115
  v_mfma_f32_16x16x32_bf16 v[60:63], v[44:47], v[144:147], v[60:63]
  ds_read_b128 v[36:39], v253 offset:51200
  v_cvt_pk_bf16_f32 v114, v116, v117
  v_mfma_f32_16x16x32_bf16 v[68:71], v[44:47], v[176:179], v[68:71]
  v_cvt_pk_bf16_f32 v115, v118, v119
  v_accvgpr_write_b32 a188, v112
  v_mfma_f32_16x16x32_bf16 v[76:79], v[44:47], v[208:211], v[76:79]
  v_accvgpr_write_b32 a189, v113
  v_mfma_f32_16x16x32_bf16 v[84:87], v[44:47], v[240:243], v[84:87]
  s_waitcnt lgkmcnt(5)
  v_accvgpr_write_b32 a190, v114
  v_mfma_f32_16x16x32_bf16 v[56:59], v[48:51], v[148:151], v[56:59]
  ds_read_b128 v[40:43], v254 offset:49152
  v_accvgpr_write_b32 a191, v115
  v_mfma_f32_16x16x32_bf16 v[64:67], v[48:51], v[180:183], v[64:67]
  v_mfma_f32_16x16x32_bf16 v[72:75], v[48:51], v[212:215], v[72:75]
  v_mfma_f32_16x16x32_bf16 v[80:83], v[48:51], v[244:247], v[80:83]
  s_waitcnt lgkmcnt(5)
  v_mfma_f32_16x16x32_bf16 v[60:63], v[52:55], v[148:151], v[60:63]
  ds_read_b128 v[44:47], v254 offset:51200
  v_mfma_f32_16x16x32_bf16 v[68:71], v[52:55], v[180:183], v[68:71]
  v_mfma_f32_16x16x32_bf16 v[76:79], v[52:55], v[212:215], v[76:79]
  v_mfma_f32_16x16x32_bf16 v[84:87], v[52:55], v[244:247], v[84:87]
  s_waitcnt lgkmcnt(5)
  v_mfma_f32_16x16x32_bf16 v[88:91], v[24:27], v[120:123], 0
  ds_read_b128 v[48:51], v255 offset:49152
  v_mfma_f32_16x16x32_bf16 v[96:99], v[24:27], v[152:155], 0
  v_mfma_f32_16x16x32_bf16 v[104:107], v[24:27], v[184:187], 0
  s_add_u32 m0, s29, 49152
  s_add_u32 s27, s28, 3407872
  buffer_load_dwordx4 v14, s[60:63], s27 offen lds
  v_mfma_f32_16x16x32_bf16 v[112:115], v[24:27], v[216:219], 0
  s_waitcnt lgkmcnt(5)
  v_mul_f32 v56, v12, v56
  v_mfma_f32_16x16x32_bf16 v[92:95], v[28:31], v[120:123], 0
  ds_read_b128 v[52:55], v255 offset:51200
  v_mul_f32 v57, v12, v57
  v_mfma_f32_16x16x32_bf16 v[100:103], v[28:31], v[152:155], 0
  v_mul_f32 v58, v12, v58
  v_mul_f32 v59, v12, v59
  v_mfma_f32_16x16x32_bf16 v[108:111], v[28:31], v[184:187], 0
  v_mul_f32 v60, v12, v60
  v_mfma_f32_16x16x32_bf16 v[116:119], v[28:31], v[216:219], 0
  s_waitcnt lgkmcnt(5)
  v_mul_f32 v61, v12, v61
  v_mfma_f32_16x16x32_bf16 v[88:91], v[32:35], v[124:127], v[88:91]
  ds_read_b128 v[24:27], v252 offset:49408
  v_mul_f32 v62, v12, v62
  v_mfma_f32_16x16x32_bf16 v[96:99], v[32:35], v[156:159], v[96:99]
  v_mul_f32 v63, v12, v63
  v_cvt_pk_bf16_f32 v56, v56, v57
  v_mfma_f32_16x16x32_bf16 v[104:107], v[32:35], v[188:191], v[104:107]
  s_add_u32 m0, s29, 50176
  s_add_u32 s27, s28, 3424256
  buffer_load_dwordx4 v15, s[60:63], s27 offen lds
  v_mfma_f32_16x16x32_bf16 v[112:115], v[32:35], v[220:223], v[112:115]
  s_waitcnt lgkmcnt(5)
  v_cvt_pk_bf16_f32 v57, v58, v59
  v_mfma_f32_16x16x32_bf16 v[92:95], v[36:39], v[124:127], v[92:95]
  ds_read_b128 v[28:31], v252 offset:51456
  v_cvt_pk_bf16_f32 v58, v60, v61
  v_mfma_f32_16x16x32_bf16 v[100:103], v[36:39], v[156:159], v[100:103]
  v_cvt_pk_bf16_f32 v59, v62, v63
  v_accvgpr_write_b32 a24, v56
  v_mfma_f32_16x16x32_bf16 v[108:111], v[36:39], v[188:191], v[108:111]
  v_accvgpr_write_b32 a25, v57
  v_mfma_f32_16x16x32_bf16 v[116:119], v[36:39], v[220:223], v[116:119]
  s_waitcnt lgkmcnt(5)
  v_accvgpr_write_b32 a26, v58
  v_mfma_f32_16x16x32_bf16 v[88:91], v[40:43], v[128:131], v[88:91]
  ds_read_b128 v[32:35], v253 offset:49408
  v_accvgpr_write_b32 a27, v59
  v_mfma_f32_16x16x32_bf16 v[96:99], v[40:43], v[160:163], v[96:99]
  v_mul_f32 v64, v12, v64
  v_mul_f32 v65, v12, v65
  v_mfma_f32_16x16x32_bf16 v[104:107], v[40:43], v[192:195], v[104:107]
  s_add_u32 m0, s29, 51200
  s_add_u32 s27, s28, 3440640
  buffer_load_dwordx4 v14, s[60:63], s27 offen lds
  v_mfma_f32_16x16x32_bf16 v[112:115], v[40:43], v[224:227], v[112:115]
  s_waitcnt lgkmcnt(5)
  v_mul_f32 v66, v12, v66
  v_mfma_f32_16x16x32_bf16 v[92:95], v[44:47], v[128:131], v[92:95]
  ds_read_b128 v[36:39], v253 offset:51456
  v_mul_f32 v67, v12, v67
  v_mfma_f32_16x16x32_bf16 v[100:103], v[44:47], v[160:163], v[100:103]
  v_mul_f32 v68, v12, v68
  v_mul_f32 v69, v12, v69
  v_mfma_f32_16x16x32_bf16 v[108:111], v[44:47], v[192:195], v[108:111]
  v_mul_f32 v70, v12, v70
  v_mfma_f32_16x16x32_bf16 v[116:119], v[44:47], v[224:227], v[116:119]
  s_waitcnt lgkmcnt(5)
  v_mul_f32 v71, v12, v71
  v_mfma_f32_16x16x32_bf16 v[88:91], v[48:51], v[132:135], v[88:91]
  ds_read_b128 v[40:43], v254 offset:49408
  v_cvt_pk_bf16_f32 v64, v64, v65
  v_mfma_f32_16x16x32_bf16 v[96:99], v[48:51], v[164:167], v[96:99]
  v_cvt_pk_bf16_f32 v65, v66, v67
  v_cvt_pk_bf16_f32 v66, v68, v69
  v_mfma_f32_16x16x32_bf16 v[104:107], v[48:51], v[196:199], v[104:107]
  s_add_u32 m0, s29, 52224
  s_add_u32 s27, s28, 3457024
  buffer_load_dwordx4 v15, s[60:63], s27 offen lds
  v_mfma_f32_16x16x32_bf16 v[112:115], v[48:51], v[228:231], v[112:115]
  s_waitcnt lgkmcnt(5)
  v_cvt_pk_bf16_f32 v67, v70, v71
  v_mfma_f32_16x16x32_bf16 v[92:95], v[52:55], v[132:135], v[92:95]
  ds_read_b128 v[44:47], v254 offset:51456
  v_accvgpr_write_b32 a80, v64
  v_mfma_f32_16x16x32_bf16 v[100:103], v[52:55], v[164:167], v[100:103]
  v_accvgpr_write_b32 a81, v65
  v_accvgpr_write_b32 a82, v66
  v_mfma_f32_16x16x32_bf16 v[108:111], v[52:55], v[196:199], v[108:111]
  v_accvgpr_write_b32 a83, v67
  v_mfma_f32_16x16x32_bf16 v[116:119], v[52:55], v[228:231], v[116:119]
  s_waitcnt lgkmcnt(5)
  v_mul_f32 v72, v12, v72
  v_mfma_f32_16x16x32_bf16 v[88:91], v[24:27], v[136:139], v[88:91]
  ds_read_b128 v[48:51], v255 offset:49408
  v_mul_f32 v73, v12, v73
  v_mfma_f32_16x16x32_bf16 v[96:99], v[24:27], v[168:171], v[96:99]
  v_mul_f32 v74, v12, v74
  v_mul_f32 v75, v12, v75
  v_mfma_f32_16x16x32_bf16 v[104:107], v[24:27], v[200:203], v[104:107]
  v_mul_f32 v76, v12, v76
  v_mfma_f32_16x16x32_bf16 v[112:115], v[24:27], v[232:235], v[112:115]
  s_waitcnt lgkmcnt(5)
  v_mul_f32 v77, v12, v77
  v_mfma_f32_16x16x32_bf16 v[92:95], v[28:31], v[136:139], v[92:95]
  ds_read_b128 v[52:55], v255 offset:51456
  v_mul_f32 v78, v12, v78
  v_mfma_f32_16x16x32_bf16 v[100:103], v[28:31], v[168:171], v[100:103]
  v_mul_f32 v79, v12, v79
  v_cvt_pk_bf16_f32 v72, v72, v73
  v_mfma_f32_16x16x32_bf16 v[108:111], v[28:31], v[200:203], v[108:111]
  v_cvt_pk_bf16_f32 v73, v74, v75
  v_mfma_f32_16x16x32_bf16 v[116:119], v[28:31], v[232:235], v[116:119]
  s_waitcnt lgkmcnt(5)
  v_cvt_pk_bf16_f32 v74, v76, v77
  v_mfma_f32_16x16x32_bf16 v[88:91], v[32:35], v[140:143], v[88:91]
  s_waitcnt vmcnt(20)
  s_barrier
  ds_read_b128 v[24:27], v16 offset:0
  v_cvt_pk_bf16_f32 v75, v78, v79
  v_mfma_f32_16x16x32_bf16 v[96:99], v[32:35], v[172:175], v[96:99]
  v_accvgpr_write_b32 a136, v72
  v_accvgpr_write_b32 a137, v73
  v_mfma_f32_16x16x32_bf16 v[104:107], v[32:35], v[204:207], v[104:107]
  v_accvgpr_write_b32 a138, v74
  v_mfma_f32_16x16x32_bf16 v[112:115], v[32:35], v[236:239], v[112:115]
  s_waitcnt lgkmcnt(5)
  v_accvgpr_write_b32 a139, v75
  v_mfma_f32_16x16x32_bf16 v[92:95], v[36:39], v[140:143], v[92:95]
  ds_read_b128 v[28:31], v16 offset:2048
  v_mul_f32 v80, v12, v80
  v_mfma_f32_16x16x32_bf16 v[100:103], v[36:39], v[172:175], v[100:103]
  v_mul_f32 v81, v12, v81
  v_mul_f32 v82, v12, v82
  v_mfma_f32_16x16x32_bf16 v[108:111], v[36:39], v[204:207], v[108:111]
  v_mul_f32 v83, v12, v83
  v_mfma_f32_16x16x32_bf16 v[116:119], v[36:39], v[236:239], v[116:119]
  s_waitcnt lgkmcnt(5)
  v_mul_f32 v84, v12, v84
  v_mfma_f32_16x16x32_bf16 v[88:91], v[40:43], v[144:147], v[88:91]
  ds_read_b128 v[32:35], v17 offset:0
  v_mul_f32 v85, v12, v85
  v_mfma_f32_16x16x32_bf16 v[96:99], v[40:43], v[176:179], v[96:99]
  v_mul_f32 v86, v12, v86
  v_mul_f32 v87, v12, v87
  v_mfma_f32_16x16x32_bf16 v[104:107], v[40:43], v[208:211], v[104:107]
  v_cvt_pk_bf16_f32 v80, v80, v81
  v_mfma_f32_16x16x32_bf16 v[112:115], v[40:43], v[240:243], v[112:115]
  s_waitcnt lgkmcnt(5)
  v_cvt_pk_bf16_f32 v81, v82, v83
  v_mfma_f32_16x16x32_bf16 v[92:95], v[44:47], v[144:147], v[92:95]
  ds_read_b128 v[36:39], v17 offset:2048
  v_cvt_pk_bf16_f32 v82, v84, v85
  v_mfma_f32_16x16x32_bf16 v[100:103], v[44:47], v[176:179], v[100:103]
  v_cvt_pk_bf16_f32 v83, v86, v87
  v_accvgpr_write_b32 a192, v80
  v_mfma_f32_16x16x32_bf16 v[108:111], v[44:47], v[208:211], v[108:111]
  v_accvgpr_write_b32 a193, v81
  v_mfma_f32_16x16x32_bf16 v[116:119], v[44:47], v[240:243], v[116:119]
  s_waitcnt lgkmcnt(5)
  v_accvgpr_write_b32 a194, v82
  v_mfma_f32_16x16x32_bf16 v[88:91], v[48:51], v[148:151], v[88:91]
  ds_read_b128 v[40:43], v18 offset:0
  v_accvgpr_write_b32 a195, v83
  v_mfma_f32_16x16x32_bf16 v[96:99], v[48:51], v[180:183], v[96:99]
  v_mfma_f32_16x16x32_bf16 v[104:107], v[48:51], v[212:215], v[104:107]
  v_mfma_f32_16x16x32_bf16 v[112:115], v[48:51], v[244:247], v[112:115]
  s_waitcnt lgkmcnt(5)
  v_mfma_f32_16x16x32_bf16 v[92:95], v[52:55], v[148:151], v[92:95]
  ds_read_b128 v[44:47], v18 offset:2048
  v_mfma_f32_16x16x32_bf16 v[100:103], v[52:55], v[180:183], v[100:103]
  v_mfma_f32_16x16x32_bf16 v[108:111], v[52:55], v[212:215], v[108:111]
  v_mfma_f32_16x16x32_bf16 v[116:119], v[52:55], v[244:247], v[116:119]
  s_waitcnt lgkmcnt(5)
  v_mfma_f32_16x16x32_bf16 v[56:59], v[24:27], v[120:123], 0
  ds_read_b128 v[48:51], v19 offset:0
  v_mfma_f32_16x16x32_bf16 v[64:67], v[24:27], v[152:155], 0
  v_mfma_f32_16x16x32_bf16 v[72:75], v[24:27], v[184:187], 0
  v_mfma_f32_16x16x32_bf16 v[80:83], v[24:27], v[216:219], 0
  s_waitcnt lgkmcnt(5)
  v_mul_f32 v88, v12, v88
  v_mfma_f32_16x16x32_bf16 v[60:63], v[28:31], v[120:123], 0
  ds_read_b128 v[52:55], v19 offset:2048
  v_mul_f32 v89, v12, v89
  v_mfma_f32_16x16x32_bf16 v[68:71], v[28:31], v[152:155], 0
  v_mul_f32 v90, v12, v90
  v_mul_f32 v91, v12, v91
  v_mfma_f32_16x16x32_bf16 v[76:79], v[28:31], v[184:187], 0
  v_mul_f32 v92, v12, v92
  v_mfma_f32_16x16x32_bf16 v[84:87], v[28:31], v[216:219], 0
  s_waitcnt lgkmcnt(5)
  v_mul_f32 v93, v12, v93
  v_mfma_f32_16x16x32_bf16 v[56:59], v[32:35], v[124:127], v[56:59]
  ds_read_b128 v[24:27], v16 offset:256
  v_mul_f32 v94, v12, v94
  v_mfma_f32_16x16x32_bf16 v[64:67], v[32:35], v[156:159], v[64:67]
  v_mul_f32 v95, v12, v95
  v_cvt_pk_bf16_f32 v88, v88, v89
  v_mfma_f32_16x16x32_bf16 v[72:75], v[32:35], v[188:191], v[72:75]
  v_cvt_pk_bf16_f32 v89, v90, v91
  v_mfma_f32_16x16x32_bf16 v[80:83], v[32:35], v[220:223], v[80:83]
  s_waitcnt lgkmcnt(5)
  v_cvt_pk_bf16_f32 v90, v92, v93
  v_mfma_f32_16x16x32_bf16 v[60:63], v[36:39], v[124:127], v[60:63]
  ds_read_b128 v[28:31], v16 offset:2304
  v_cvt_pk_bf16_f32 v91, v94, v95
  v_mfma_f32_16x16x32_bf16 v[68:71], v[36:39], v[156:159], v[68:71]
  v_accvgpr_write_b32 a28, v88
  v_accvgpr_write_b32 a29, v89
  v_mfma_f32_16x16x32_bf16 v[76:79], v[36:39], v[188:191], v[76:79]
  v_accvgpr_write_b32 a30, v90
  v_mfma_f32_16x16x32_bf16 v[84:87], v[36:39], v[220:223], v[84:87]
  s_waitcnt lgkmcnt(5)
  v_accvgpr_write_b32 a31, v91
  v_mfma_f32_16x16x32_bf16 v[56:59], v[40:43], v[128:131], v[56:59]
  ds_read_b128 v[32:35], v17 offset:256
  v_mul_f32 v96, v12, v96
  v_mfma_f32_16x16x32_bf16 v[64:67], v[40:43], v[160:163], v[64:67]
  v_mul_f32 v97, v12, v97
  v_mul_f32 v98, v12, v98
  v_mfma_f32_16x16x32_bf16 v[72:75], v[40:43], v[192:195], v[72:75]
  v_mul_f32 v99, v12, v99
  v_mfma_f32_16x16x32_bf16 v[80:83], v[40:43], v[224:227], v[80:83]
  s_waitcnt lgkmcnt(5)
  v_mul_f32 v100, v12, v100
  v_mfma_f32_16x16x32_bf16 v[60:63], v[44:47], v[128:131], v[60:63]
  ds_read_b128 v[36:39], v17 offset:2304
  v_mul_f32 v101, v12, v101
  v_mfma_f32_16x16x32_bf16 v[68:71], v[44:47], v[160:163], v[68:71]
  v_mul_f32 v102, v12, v102
  v_mul_f32 v103, v12, v103
  v_mfma_f32_16x16x32_bf16 v[76:79], v[44:47], v[192:195], v[76:79]
  v_cvt_pk_bf16_f32 v96, v96, v97
  v_mfma_f32_16x16x32_bf16 v[84:87], v[44:47], v[224:227], v[84:87]
  s_waitcnt lgkmcnt(5)
  v_cvt_pk_bf16_f32 v97, v98, v99
  v_mfma_f32_16x16x32_bf16 v[56:59], v[48:51], v[132:135], v[56:59]
  ds_read_b128 v[40:43], v18 offset:256
  v_cvt_pk_bf16_f32 v98, v100, v101
  v_mfma_f32_16x16x32_bf16 v[64:67], v[48:51], v[164:167], v[64:67]
  v_cvt_pk_bf16_f32 v99, v102, v103
  v_accvgpr_write_b32 a84, v96
  v_mfma_f32_16x16x32_bf16 v[72:75], v[48:51], v[196:199], v[72:75]
  v_accvgpr_write_b32 a85, v97
  v_mfma_f32_16x16x32_bf16 v[80:83], v[48:51], v[228:231], v[80:83]
  s_waitcnt lgkmcnt(5)
  v_accvgpr_write_b32 a86, v98
  v_mfma_f32_16x16x32_bf16 v[60:63], v[52:55], v[132:135], v[60:63]
  ds_read_b128 v[44:47], v18 offset:2304
  v_accvgpr_write_b32 a87, v99
  v_mfma_f32_16x16x32_bf16 v[68:71], v[52:55], v[164:167], v[68:71]
  v_mul_f32 v104, v12, v104
  v_mul_f32 v105, v12, v105
  v_mfma_f32_16x16x32_bf16 v[76:79], v[52:55], v[196:199], v[76:79]
  v_mul_f32 v106, v12, v106
  v_mfma_f32_16x16x32_bf16 v[84:87], v[52:55], v[228:231], v[84:87]
  s_waitcnt lgkmcnt(5)
  v_mul_f32 v107, v12, v107
  v_mfma_f32_16x16x32_bf16 v[56:59], v[24:27], v[136:139], v[56:59]
  ds_read_b128 v[48:51], v19 offset:256
  v_mul_f32 v108, v12, v108
  v_mfma_f32_16x16x32_bf16 v[64:67], v[24:27], v[168:171], v[64:67]
  v_mul_f32 v109, v12, v109
  v_mul_f32 v110, v12, v110
  v_mfma_f32_16x16x32_bf16 v[72:75], v[24:27], v[200:203], v[72:75]
  v_mul_f32 v111, v12, v111
  v_mfma_f32_16x16x32_bf16 v[80:83], v[24:27], v[232:235], v[80:83]
  s_waitcnt lgkmcnt(5)
  v_cvt_pk_bf16_f32 v104, v104, v105
  v_mfma_f32_16x16x32_bf16 v[60:63], v[28:31], v[136:139], v[60:63]
  ds_read_b128 v[52:55], v19 offset:2304
  v_cvt_pk_bf16_f32 v105, v106, v107
  v_mfma_f32_16x16x32_bf16 v[68:71], v[28:31], v[168:171], v[68:71]
  v_cvt_pk_bf16_f32 v106, v108, v109
  v_cvt_pk_bf16_f32 v107, v110, v111
  v_mfma_f32_16x16x32_bf16 v[76:79], v[28:31], v[200:203], v[76:79]
  v_accvgpr_write_b32 a140, v104
  v_mfma_f32_16x16x32_bf16 v[84:87], v[28:31], v[232:235], v[84:87]
  s_waitcnt lgkmcnt(5)
  v_accvgpr_write_b32 a141, v105
  v_mfma_f32_16x16x32_bf16 v[56:59], v[32:35], v[140:143], v[56:59]
  s_waitcnt vmcnt(16)
  s_barrier
  ds_read_b128 v[24:27], v16 offset:16384
  v_accvgpr_write_b32 a142, v106
  v_mfma_f32_16x16x32_bf16 v[64:67], v[32:35], v[172:175], v[64:67]
  v_accvgpr_write_b32 a143, v107
  v_mul_f32 v112, v12, v112
  v_mfma_f32_16x16x32_bf16 v[72:75], v[32:35], v[204:207], v[72:75]
  v_mul_f32 v113, v12, v113
  v_mfma_f32_16x16x32_bf16 v[80:83], v[32:35], v[236:239], v[80:83]
  s_waitcnt lgkmcnt(5)
  v_mul_f32 v114, v12, v114
  v_mfma_f32_16x16x32_bf16 v[60:63], v[36:39], v[140:143], v[60:63]
  ds_read_b128 v[28:31], v16 offset:18432
  v_mul_f32 v115, v12, v115
  v_mfma_f32_16x16x32_bf16 v[68:71], v[36:39], v[172:175], v[68:71]
  v_mul_f32 v116, v12, v116
  v_mul_f32 v117, v12, v117
  v_mfma_f32_16x16x32_bf16 v[76:79], v[36:39], v[204:207], v[76:79]
  v_mul_f32 v118, v12, v118
  v_mfma_f32_16x16x32_bf16 v[84:87], v[36:39], v[236:239], v[84:87]
  s_waitcnt lgkmcnt(5)
  v_mul_f32 v119, v12, v119
  v_mfma_f32_16x16x32_bf16 v[56:59], v[40:43], v[144:147], v[56:59]
  ds_read_b128 v[32:35], v17 offset:16384
  v_cvt_pk_bf16_f32 v112, v112, v113
  v_mfma_f32_16x16x32_bf16 v[64:67], v[40:43], v[176:179], v[64:67]
  v_cvt_pk_bf16_f32 v113, v114, v115
  v_cvt_pk_bf16_f32 v114, v116, v117
  v_mfma_f32_16x16x32_bf16 v[72:75], v[40:43], v[208:211], v[72:75]
  v_cvt_pk_bf16_f32 v115, v118, v119
  v_mfma_f32_16x16x32_bf16 v[80:83], v[40:43], v[240:243], v[80:83]
  s_waitcnt lgkmcnt(5)
  v_accvgpr_write_b32 a196, v112
  v_mfma_f32_16x16x32_bf16 v[60:63], v[44:47], v[144:147], v[60:63]
  ds_read_b128 v[36:39], v17 offset:18432
  v_accvgpr_write_b32 a197, v113
  v_mfma_f32_16x16x32_bf16 v[68:71], v[44:47], v[176:179], v[68:71]
  v_accvgpr_write_b32 a198, v114
  v_accvgpr_write_b32 a199, v115
  v_mfma_f32_16x16x32_bf16 v[76:79], v[44:47], v[208:211], v[76:79]
  v_mfma_f32_16x16x32_bf16 v[84:87], v[44:47], v[240:243], v[84:87]
  s_waitcnt lgkmcnt(5)
  v_mfma_f32_16x16x32_bf16 v[56:59], v[48:51], v[148:151], v[56:59]
  ds_read_b128 v[40:43], v18 offset:16384
  v_mfma_f32_16x16x32_bf16 v[64:67], v[48:51], v[180:183], v[64:67]
  v_mfma_f32_16x16x32_bf16 v[72:75], v[48:51], v[212:215], v[72:75]
  v_mfma_f32_16x16x32_bf16 v[80:83], v[48:51], v[244:247], v[80:83]
  s_waitcnt lgkmcnt(5)
  v_mfma_f32_16x16x32_bf16 v[60:63], v[52:55], v[148:151], v[60:63]
  ds_read_b128 v[44:47], v18 offset:18432
  v_mfma_f32_16x16x32_bf16 v[68:71], v[52:55], v[180:183], v[68:71]
  v_mfma_f32_16x16x32_bf16 v[76:79], v[52:55], v[212:215], v[76:79]
  v_mfma_f32_16x16x32_bf16 v[84:87], v[52:55], v[244:247], v[84:87]
  s_waitcnt lgkmcnt(5)
  s_getpc_b64 s[98:99]
  s_add_u32 s98, s98, 4096
  s_addc_u32 s99, s99, 0
  global_load_dword v7, v6, s[98:99]
  v_mfma_f32_16x16x32_bf16 v[88:91], v[24:27], v[120:123], 0
  ds_read_b128 v[48:51], v19 offset:16384
  v_mfma_f32_16x16x32_bf16 v[96:99], v[24:27], v[152:155], 0
  v_mfma_f32_16x16x32_bf16 v[104:107], v[24:27], v[184:187], 0
  v_mfma_f32_16x16x32_bf16 v[112:115], v[24:27], v[216:219], 0
  s_waitcnt lgkmcnt(5)
  v_mul_f32 v56, v12, v56
  v_mfma_f32_16x16x32_bf16 v[92:95], v[28:31], v[120:123], 0
  ds_read_b128 v[52:55], v19 offset:18432
  v_mul_f32 v57, v12, v57
  v_mfma_f32_16x16x32_bf16 v[100:103], v[28:31], v[152:155], 0
  v_mul_f32 v58, v12, v58
  v_mul_f32 v59, v12, v59
  v_mfma_f32_16x16x32_bf16 v[108:111], v[28:31], v[184:187], 0
  v_mul_f32 v60, v12, v60
  v_mfma_f32_16x16x32_bf16 v[116:119], v[28:31], v[216:219], 0
  s_waitcnt lgkmcnt(5)
  v_mul_f32 v61, v12, v61
  v_mfma_f32_16x16x32_bf16 v[88:91], v[32:35], v[124:127], v[88:91]
  ds_read_b128 v[24:27], v16 offset:16640
  v_mul_f32 v62, v12, v62
  v_mfma_f32_16x16x32_bf16 v[96:99], v[32:35], v[156:159], v[96:99]
  v_mul_f32 v63, v12, v63
  v_cvt_pk_bf16_f32 v56, v56, v57
  v_mfma_f32_16x16x32_bf16 v[104:107], v[32:35], v[188:191], v[104:107]
  v_cvt_pk_bf16_f32 v57, v58, v59
  v_mfma_f32_16x16x32_bf16 v[112:115], v[32:35], v[220:223], v[112:115]
  s_waitcnt lgkmcnt(5)
  v_cvt_pk_bf16_f32 v58, v60, v61
  v_mfma_f32_16x16x32_bf16 v[92:95], v[36:39], v[124:127], v[92:95]
  ds_read_b128 v[28:31], v16 offset:18688
  v_cvt_pk_bf16_f32 v59, v62, v63
  v_mfma_f32_16x16x32_bf16 v[100:103], v[36:39], v[156:159], v[100:103]
  v_accvgpr_write_b32 a32, v56
  v_accvgpr_write_b32 a33, v57
  v_mfma_f32_16x16x32_bf16 v[108:111], v[36:39], v[188:191], v[108:111]
  v_accvgpr_write_b32 a34, v58
  v_mfma_f32_16x16x32_bf16 v[116:119], v[36:39], v[220:223], v[116:119]
  s_waitcnt lgkmcnt(5)
  v_accvgpr_write_b32 a35, v59
  v_mfma_f32_16x16x32_bf16 v[88:91], v[40:43], v[128:131], v[88:91]
  ds_read_b128 v[32:35], v17 offset:16640
  v_mul_f32 v64, v12, v64
  v_mfma_f32_16x16x32_bf16 v[96:99], v[40:43], v[160:163], v[96:99]
  v_mul_f32 v65, v12, v65
  v_mul_f32 v66, v12, v66
  v_mfma_f32_16x16x32_bf16 v[104:107], v[40:43], v[192:195], v[104:107]
  v_mul_f32 v67, v12, v67
  v_mfma_f32_16x16x32_bf16 v[112:115], v[40:43], v[224:227], v[112:115]
  s_waitcnt lgkmcnt(5)
  v_mul_f32 v68, v12, v68
  v_mfma_f32_16x16x32_bf16 v[92:95], v[44:47], v[128:131], v[92:95]
  ds_read_b128 v[36:39], v17 offset:18688
  v_mul_f32 v69, v12, v69
  v_mfma_f32_16x16x32_bf16 v[100:103], v[44:47], v[160:163], v[100:103]
  v_mul_f32 v70, v12, v70
  v_mul_f32 v71, v12, v71
  v_mfma_f32_16x16x32_bf16 v[108:111], v[44:47], v[192:195], v[108:111]
  v_cvt_pk_bf16_f32 v64, v64, v65
  v_mfma_f32_16x16x32_bf16 v[116:119], v[44:47], v[224:227], v[116:119]
  s_waitcnt lgkmcnt(5)
  v_cvt_pk_bf16_f32 v65, v66, v67
  v_mfma_f32_16x16x32_bf16 v[88:91], v[48:51], v[132:135], v[88:91]
  ds_read_b128 v[40:43], v18 offset:16640
  v_cvt_pk_bf16_f32 v66, v68, v69
  v_mfma_f32_16x16x32_bf16 v[96:99], v[48:51], v[164:167], v[96:99]
  v_cvt_pk_bf16_f32 v67, v70, v71
  v_accvgpr_write_b32 a88, v64
  v_mfma_f32_16x16x32_bf16 v[104:107], v[48:51], v[196:199], v[104:107]
  v_accvgpr_write_b32 a89, v65
  v_mfma_f32_16x16x32_bf16 v[112:115], v[48:51], v[228:231], v[112:115]
  s_waitcnt lgkmcnt(5)
  v_accvgpr_write_b32 a90, v66
  v_mfma_f32_16x16x32_bf16 v[92:95], v[52:55], v[132:135], v[92:95]
  ds_read_b128 v[44:47], v18 offset:18688
  v_accvgpr_write_b32 a91, v67
  v_mfma_f32_16x16x32_bf16 v[100:103], v[52:55], v[164:167], v[100:103]
  v_mul_f32 v72, v12, v72
  v_mul_f32 v73, v12, v73
  v_mfma_f32_16x16x32_bf16 v[108:111], v[52:55], v[196:199], v[108:111]
  v_mul_f32 v74, v12, v74
  v_mfma_f32_16x16x32_bf16 v[116:119], v[52:55], v[228:231], v[116:119]
  s_waitcnt lgkmcnt(5)
  v_mul_f32 v75, v12, v75
  v_mfma_f32_16x16x32_bf16 v[88:91], v[24:27], v[136:139], v[88:91]
  ds_read_b128 v[48:51], v19 offset:16640
  v_mul_f32 v76, v12, v76
  v_mfma_f32_16x16x32_bf16 v[96:99], v[24:27], v[168:171], v[96:99]
  v_mul_f32 v77, v12, v77
  v_mul_f32 v78, v12, v78
  v_mfma_f32_16x16x32_bf16 v[104:107], v[24:27], v[200:203], v[104:107]
  v_mul_f32 v79, v12, v79
  v_mfma_f32_16x16x32_bf16 v[112:115], v[24:27], v[232:235], v[112:115]
  s_waitcnt lgkmcnt(5)
  v_cvt_pk_bf16_f32 v72, v72, v73
  v_mfma_f32_16x16x32_bf16 v[92:95], v[28:31], v[136:139], v[92:95]
  ds_read_b128 v[52:55], v19 offset:18688
  v_cvt_pk_bf16_f32 v73, v74, v75
  v_mfma_f32_16x16x32_bf16 v[100:103], v[28:31], v[168:171], v[100:103]
  v_cvt_pk_bf16_f32 v74, v76, v77
  v_cvt_pk_bf16_f32 v75, v78, v79
  v_mfma_f32_16x16x32_bf16 v[108:111], v[28:31], v[200:203], v[108:111]
  v_accvgpr_write_b32 a144, v72
  v_mfma_f32_16x16x32_bf16 v[116:119], v[28:31], v[232:235], v[116:119]
  s_waitcnt lgkmcnt(5)
  v_accvgpr_write_b32 a145, v73
  v_mfma_f32_16x16x32_bf16 v[88:91], v[32:35], v[140:143], v[88:91]
  s_waitcnt vmcnt(12)
  s_barrier
  ds_read_b128 v[24:27], v248 offset:0
  v_accvgpr_write_b32 a146, v74
  v_mfma_f32_16x16x32_bf16 v[96:99], v[32:35], v[172:175], v[96:99]
  v_accvgpr_write_b32 a147, v75
  v_mul_f32 v80, v12, v80
  v_mfma_f32_16x16x32_bf16 v[104:107], v[32:35], v[204:207], v[104:107]
  v_mul_f32 v81, v12, v81
  v_mfma_f32_16x16x32_bf16 v[112:115], v[32:35], v[236:239], v[112:115]
  s_waitcnt lgkmcnt(5)
  v_mul_f32 v82, v12, v82
  v_mfma_f32_16x16x32_bf16 v[92:95], v[36:39], v[140:143], v[92:95]
  ds_read_b128 v[28:31], v248 offset:2048
  v_mul_f32 v83, v12, v83
  v_mfma_f32_16x16x32_bf16 v[100:103], v[36:39], v[172:175], v[100:103]
  v_mul_f32 v84, v12, v84
  v_mul_f32 v85, v12, v85
  v_mfma_f32_16x16x32_bf16 v[108:111], v[36:39], v[204:207], v[108:111]
  v_mul_f32 v86, v12, v86
  v_mfma_f32_16x16x32_bf16 v[116:119], v[36:39], v[236:239], v[116:119]
  s_waitcnt lgkmcnt(5)
  v_mul_f32 v87, v12, v87
  v_mfma_f32_16x16x32_bf16 v[88:91], v[40:43], v[144:147], v[88:91]
  ds_read_b128 v[32:35], v249 offset:0
  v_cvt_pk_bf16_f32 v80, v80, v81
  v_mfma_f32_16x16x32_bf16 v[96:99], v[40:43], v[176:179], v[96:99]
  v_cvt_pk_bf16_f32 v81, v82, v83
  v_cvt_pk_bf16_f32 v82, v84, v85
  v_mfma_f32_16x16x32_bf16 v[104:107], v[40:43], v[208:211], v[104:107]
  v_cvt_pk_bf16_f32 v83, v86, v87
  v_mfma_f32_16x16x32_bf16 v[112:115], v[40:43], v[240:243], v[112:115]
  s_waitcnt lgkmcnt(5)
  v_accvgpr_write_b32 a200, v80
  v_mfma_f32_16x16x32_bf16 v[92:95], v[44:47], v[144:147], v[92:95]
  ds_read_b128 v[36:39], v249 offset:2048
  v_accvgpr_write_b32 a201, v81
  v_mfma_f32_16x16x32_bf16 v[100:103], v[44:47], v[176:179], v[100:103]
  v_accvgpr_write_b32 a202, v82
  v_accvgpr_write_b32 a203, v83
  v_mfma_f32_16x16x32_bf16 v[108:111], v[44:47], v[208:211], v[108:111]
  v_mfma_f32_16x16x32_bf16 v[116:119], v[44:47], v[240:243], v[116:119]
  s_waitcnt lgkmcnt(5)
  v_mfma_f32_16x16x32_bf16 v[88:91], v[48:51], v[148:151], v[88:91]
  ds_read_b128 v[40:43], v250 offset:0
  v_mfma_f32_16x16x32_bf16 v[96:99], v[48:51], v[180:183], v[96:99]
  v_mfma_f32_16x16x32_bf16 v[104:107], v[48:51], v[212:215], v[104:107]
  v_mfma_f32_16x16x32_bf16 v[112:115], v[48:51], v[244:247], v[112:115]
  s_waitcnt lgkmcnt(5)
  v_mfma_f32_16x16x32_bf16 v[92:95], v[52:55], v[148:151], v[92:95]
  ds_read_b128 v[44:47], v250 offset:2048
  v_mfma_f32_16x16x32_bf16 v[100:103], v[52:55], v[180:183], v[100:103]
  v_mfma_f32_16x16x32_bf16 v[108:111], v[52:55], v[212:215], v[108:111]
  v_mfma_f32_16x16x32_bf16 v[116:119], v[52:55], v[244:247], v[116:119]
  s_waitcnt lgkmcnt(5)
  v_mfma_f32_16x16x32_bf16 v[56:59], v[24:27], v[120:123], 0
  ds_read_b128 v[48:51], v251 offset:0
  v_mfma_f32_16x16x32_bf16 v[64:67], v[24:27], v[152:155], 0
  v_mfma_f32_16x16x32_bf16 v[72:75], v[24:27], v[184:187], 0
  v_mfma_f32_16x16x32_bf16 v[80:83], v[24:27], v[216:219], 0
  s_waitcnt lgkmcnt(5)
  v_mul_f32 v88, v12, v88
  v_mfma_f32_16x16x32_bf16 v[60:63], v[28:31], v[120:123], 0
  ds_read_b128 v[52:55], v251 offset:2048
  v_mul_f32 v89, v12, v89
  v_mfma_f32_16x16x32_bf16 v[68:71], v[28:31], v[152:155], 0
  v_mul_f32 v90, v12, v90
  v_mul_f32 v91, v12, v91
  v_mfma_f32_16x16x32_bf16 v[76:79], v[28:31], v[184:187], 0
  v_mul_f32 v92, v12, v92
  v_mfma_f32_16x16x32_bf16 v[84:87], v[28:31], v[216:219], 0
  s_waitcnt lgkmcnt(5)
  v_mul_f32 v93, v12, v93
  v_mfma_f32_16x16x32_bf16 v[56:59], v[32:35], v[124:127], v[56:59]
  ds_read_b128 v[24:27], v248 offset:256
  v_mul_f32 v94, v12, v94
  v_mfma_f32_16x16x32_bf16 v[64:67], v[32:35], v[156:159], v[64:67]
  v_mul_f32 v95, v12, v95
  v_cvt_pk_bf16_f32 v88, v88, v89
  v_mfma_f32_16x16x32_bf16 v[72:75], v[32:35], v[188:191], v[72:75]
  v_cvt_pk_bf16_f32 v89, v90, v91
  v_mfma_f32_16x16x32_bf16 v[80:83], v[32:35], v[220:223], v[80:83]
  s_waitcnt lgkmcnt(5)
  v_cvt_pk_bf16_f32 v90, v92, v93
  v_mfma_f32_16x16x32_bf16 v[60:63], v[36:39], v[124:127], v[60:63]
  ds_read_b128 v[28:31], v248 offset:2304
  v_cvt_pk_bf16_f32 v91, v94, v95
  v_mfma_f32_16x16x32_bf16 v[68:71], v[36:39], v[156:159], v[68:71]
  v_accvgpr_write_b32 a36, v88
  v_accvgpr_write_b32 a37, v89
  v_mfma_f32_16x16x32_bf16 v[76:79], v[36:39], v[188:191], v[76:79]
  v_accvgpr_write_b32 a38, v90
  v_mfma_f32_16x16x32_bf16 v[84:87], v[36:39], v[220:223], v[84:87]
  s_waitcnt lgkmcnt(5)
  v_accvgpr_write_b32 a39, v91
  v_mfma_f32_16x16x32_bf16 v[56:59], v[40:43], v[128:131], v[56:59]
  ds_read_b128 v[32:35], v249 offset:256
  v_mul_f32 v96, v12, v96
  v_mfma_f32_16x16x32_bf16 v[64:67], v[40:43], v[160:163], v[64:67]
  v_mul_f32 v97, v12, v97
  v_mul_f32 v98, v12, v98
  v_mfma_f32_16x16x32_bf16 v[72:75], v[40:43], v[192:195], v[72:75]
  v_mul_f32 v99, v12, v99
  v_mfma_f32_16x16x32_bf16 v[80:83], v[40:43], v[224:227], v[80:83]
  s_waitcnt lgkmcnt(5)
  v_mul_f32 v100, v12, v100
  v_mfma_f32_16x16x32_bf16 v[60:63], v[44:47], v[128:131], v[60:63]
  ds_read_b128 v[36:39], v249 offset:2304
  v_mul_f32 v101, v12, v101
  v_mfma_f32_16x16x32_bf16 v[68:71], v[44:47], v[160:163], v[68:71]
  v_mul_f32 v102, v12, v102
  v_mul_f32 v103, v12, v103
  v_mfma_f32_16x16x32_bf16 v[76:79], v[44:47], v[192:195], v[76:79]
  v_cvt_pk_bf16_f32 v96, v96, v97
  v_mfma_f32_16x16x32_bf16 v[84:87], v[44:47], v[224:227], v[84:87]
  s_waitcnt lgkmcnt(5)
  v_cvt_pk_bf16_f32 v97, v98, v99
  v_mfma_f32_16x16x32_bf16 v[56:59], v[48:51], v[132:135], v[56:59]
  ds_read_b128 v[40:43], v250 offset:256
  v_cvt_pk_bf16_f32 v98, v100, v101
  v_mfma_f32_16x16x32_bf16 v[64:67], v[48:51], v[164:167], v[64:67]
  v_cvt_pk_bf16_f32 v99, v102, v103
  v_accvgpr_write_b32 a92, v96
  v_mfma_f32_16x16x32_bf16 v[72:75], v[48:51], v[196:199], v[72:75]
  v_accvgpr_write_b32 a93, v97
  v_mfma_f32_16x16x32_bf16 v[80:83], v[48:51], v[228:231], v[80:83]
  s_waitcnt lgkmcnt(5)
  v_accvgpr_write_b32 a94, v98
  v_mfma_f32_16x16x32_bf16 v[60:63], v[52:55], v[132:135], v[60:63]
  ds_read_b128 v[44:47], v250 offset:2304
  v_accvgpr_write_b32 a95, v99
  v_mfma_f32_16x16x32_bf16 v[68:71], v[52:55], v[164:167], v[68:71]
  v_mul_f32 v104, v12, v104
  v_mul_f32 v105, v12, v105
  v_mfma_f32_16x16x32_bf16 v[76:79], v[52:55], v[196:199], v[76:79]
  v_mul_f32 v106, v12, v106
  v_mfma_f32_16x16x32_bf16 v[84:87], v[52:55], v[228:231], v[84:87]
  s_waitcnt lgkmcnt(5)
  v_mul_f32 v107, v12, v107
  v_mfma_f32_16x16x32_bf16 v[56:59], v[24:27], v[136:139], v[56:59]
  ds_read_b128 v[48:51], v251 offset:256
  v_mul_f32 v108, v12, v108
  v_mfma_f32_16x16x32_bf16 v[64:67], v[24:27], v[168:171], v[64:67]
  v_mul_f32 v109, v12, v109
  v_mul_f32 v110, v12, v110
  v_mfma_f32_16x16x32_bf16 v[72:75], v[24:27], v[200:203], v[72:75]
  v_mul_f32 v111, v12, v111
  v_mfma_f32_16x16x32_bf16 v[80:83], v[24:27], v[232:235], v[80:83]
  s_waitcnt lgkmcnt(5)
  v_cvt_pk_bf16_f32 v104, v104, v105
  v_mfma_f32_16x16x32_bf16 v[60:63], v[28:31], v[136:139], v[60:63]
  ds_read_b128 v[52:55], v251 offset:2304
  v_cvt_pk_bf16_f32 v105, v106, v107
  v_mfma_f32_16x16x32_bf16 v[68:71], v[28:31], v[168:171], v[68:71]
  v_cvt_pk_bf16_f32 v106, v108, v109
  v_cvt_pk_bf16_f32 v107, v110, v111
  v_mfma_f32_16x16x32_bf16 v[76:79], v[28:31], v[200:203], v[76:79]
  v_accvgpr_write_b32 a148, v104
  v_mfma_f32_16x16x32_bf16 v[84:87], v[28:31], v[232:235], v[84:87]
  s_waitcnt lgkmcnt(5)
  v_accvgpr_write_b32 a149, v105
  v_mfma_f32_16x16x32_bf16 v[56:59], v[32:35], v[140:143], v[56:59]
  s_waitcnt vmcnt(8)
  s_barrier
  ds_read_b128 v[24:27], v248 offset:16384
  v_accvgpr_write_b32 a150, v106
  v_mfma_f32_16x16x32_bf16 v[64:67], v[32:35], v[172:175], v[64:67]
  v_accvgpr_write_b32 a151, v107
  v_mul_f32 v112, v12, v112
  v_mfma_f32_16x16x32_bf16 v[72:75], v[32:35], v[204:207], v[72:75]
  v_mul_f32 v113, v12, v113
  v_mfma_f32_16x16x32_bf16 v[80:83], v[32:35], v[236:239], v[80:83]
  s_waitcnt lgkmcnt(5)
  v_mul_f32 v114, v12, v114
  v_mfma_f32_16x16x32_bf16 v[60:63], v[36:39], v[140:143], v[60:63]
  ds_read_b128 v[28:31], v248 offset:18432
  v_mul_f32 v115, v12, v115
  v_mfma_f32_16x16x32_bf16 v[68:71], v[36:39], v[172:175], v[68:71]
  v_mul_f32 v116, v12, v116
  v_mul_f32 v117, v12, v117
  v_mfma_f32_16x16x32_bf16 v[76:79], v[36:39], v[204:207], v[76:79]
  v_mul_f32 v118, v12, v118
  v_mfma_f32_16x16x32_bf16 v[84:87], v[36:39], v[236:239], v[84:87]
  s_waitcnt lgkmcnt(5)
  v_mul_f32 v119, v12, v119
  v_mfma_f32_16x16x32_bf16 v[56:59], v[40:43], v[144:147], v[56:59]
  ds_read_b128 v[32:35], v249 offset:16384
  v_cvt_pk_bf16_f32 v112, v112, v113
  v_mfma_f32_16x16x32_bf16 v[64:67], v[40:43], v[176:179], v[64:67]
  v_cvt_pk_bf16_f32 v113, v114, v115
  v_cvt_pk_bf16_f32 v114, v116, v117
  v_mfma_f32_16x16x32_bf16 v[72:75], v[40:43], v[208:211], v[72:75]
  v_cvt_pk_bf16_f32 v115, v118, v119
  v_mfma_f32_16x16x32_bf16 v[80:83], v[40:43], v[240:243], v[80:83]
  s_waitcnt lgkmcnt(5)
  v_accvgpr_write_b32 a204, v112
  v_mfma_f32_16x16x32_bf16 v[60:63], v[44:47], v[144:147], v[60:63]
  ds_read_b128 v[36:39], v249 offset:18432
  v_accvgpr_write_b32 a205, v113
  v_mfma_f32_16x16x32_bf16 v[68:71], v[44:47], v[176:179], v[68:71]
  v_accvgpr_write_b32 a206, v114
  v_accvgpr_write_b32 a207, v115
  v_mfma_f32_16x16x32_bf16 v[76:79], v[44:47], v[208:211], v[76:79]
  v_mfma_f32_16x16x32_bf16 v[84:87], v[44:47], v[240:243], v[84:87]
  s_waitcnt lgkmcnt(5)
  v_mfma_f32_16x16x32_bf16 v[56:59], v[48:51], v[148:151], v[56:59]
  ds_read_b128 v[40:43], v250 offset:16384
  v_mfma_f32_16x16x32_bf16 v[64:67], v[48:51], v[180:183], v[64:67]
  v_mfma_f32_16x16x32_bf16 v[72:75], v[48:51], v[212:215], v[72:75]
  v_mfma_f32_16x16x32_bf16 v[80:83], v[48:51], v[244:247], v[80:83]
  s_waitcnt lgkmcnt(5)
  v_mfma_f32_16x16x32_bf16 v[60:63], v[52:55], v[148:151], v[60:63]
  ds_read_b128 v[44:47], v250 offset:18432
  v_mfma_f32_16x16x32_bf16 v[68:71], v[52:55], v[180:183], v[68:71]
  v_mfma_f32_16x16x32_bf16 v[76:79], v[52:55], v[212:215], v[76:79]
  v_mfma_f32_16x16x32_bf16 v[84:87], v[52:55], v[244:247], v[84:87]
  s_waitcnt lgkmcnt(5)
  v_mfma_f32_16x16x32_bf16 v[88:91], v[24:27], v[120:123], 0
  ds_read_b128 v[48:51], v251 offset:16384
  v_mfma_f32_16x16x32_bf16 v[96:99], v[24:27], v[152:155], 0
  v_mfma_f32_16x16x32_bf16 v[104:107], v[24:27], v[184:187], 0
  v_mfma_f32_16x16x32_bf16 v[112:115], v[24:27], v[216:219], 0
  s_waitcnt lgkmcnt(5)
  v_mul_f32 v56, v12, v56
  v_mfma_f32_16x16x32_bf16 v[92:95], v[28:31], v[120:123], 0
  ds_read_b128 v[52:55], v251 offset:18432
  v_mul_f32 v57, v12, v57
  v_mfma_f32_16x16x32_bf16 v[100:103], v[28:31], v[152:155], 0
  v_mul_f32 v58, v12, v58
  v_mul_f32 v59, v12, v59
  v_mfma_f32_16x16x32_bf16 v[108:111], v[28:31], v[184:187], 0
  v_mul_f32 v60, v12, v60
  v_mfma_f32_16x16x32_bf16 v[116:119], v[28:31], v[216:219], 0
  s_waitcnt lgkmcnt(5)
  v_mul_f32 v61, v12, v61
  v_mfma_f32_16x16x32_bf16 v[88:91], v[32:35], v[124:127], v[88:91]
  ds_read_b128 v[24:27], v248 offset:16640
  v_mul_f32 v62, v12, v62
  v_mfma_f32_16x16x32_bf16 v[96:99], v[32:35], v[156:159], v[96:99]
  v_mul_f32 v63, v12, v63
  v_cvt_pk_bf16_f32 v56, v56, v57
  v_mfma_f32_16x16x32_bf16 v[104:107], v[32:35], v[188:191], v[104:107]
  v_cvt_pk_bf16_f32 v57, v58, v59
  v_mfma_f32_16x16x32_bf16 v[112:115], v[32:35], v[220:223], v[112:115]
  s_waitcnt lgkmcnt(5)
  v_cvt_pk_bf16_f32 v58, v60, v61
  v_mfma_f32_16x16x32_bf16 v[92:95], v[36:39], v[124:127], v[92:95]
  ds_read_b128 v[28:31], v248 offset:18688
  v_cvt_pk_bf16_f32 v59, v62, v63
  v_mfma_f32_16x16x32_bf16 v[100:103], v[36:39], v[156:159], v[100:103]
  v_accvgpr_write_b32 a40, v56
  v_accvgpr_write_b32 a41, v57
  v_mfma_f32_16x16x32_bf16 v[108:111], v[36:39], v[188:191], v[108:111]
  v_accvgpr_write_b32 a42, v58
  v_mfma_f32_16x16x32_bf16 v[116:119], v[36:39], v[220:223], v[116:119]
  s_waitcnt lgkmcnt(5)
  v_accvgpr_write_b32 a43, v59
  v_mfma_f32_16x16x32_bf16 v[88:91], v[40:43], v[128:131], v[88:91]
  ds_read_b128 v[32:35], v249 offset:16640
  v_mul_f32 v64, v12, v64
  v_mfma_f32_16x16x32_bf16 v[96:99], v[40:43], v[160:163], v[96:99]
  v_mul_f32 v65, v12, v65
  v_mul_f32 v66, v12, v66
  v_mfma_f32_16x16x32_bf16 v[104:107], v[40:43], v[192:195], v[104:107]
  v_mul_f32 v67, v12, v67
  v_mfma_f32_16x16x32_bf16 v[112:115], v[40:43], v[224:227], v[112:115]
  s_waitcnt lgkmcnt(5)
  v_mul_f32 v68, v12, v68
  v_mfma_f32_16x16x32_bf16 v[92:95], v[44:47], v[128:131], v[92:95]
  ds_read_b128 v[36:39], v249 offset:18688
  v_mul_f32 v69, v12, v69
  v_mfma_f32_16x16x32_bf16 v[100:103], v[44:47], v[160:163], v[100:103]
  v_mul_f32 v70, v12, v70
  v_mul_f32 v71, v12, v71
  v_mfma_f32_16x16x32_bf16 v[108:111], v[44:47], v[192:195], v[108:111]
  v_cvt_pk_bf16_f32 v64, v64, v65
  v_mfma_f32_16x16x32_bf16 v[116:119], v[44:47], v[224:227], v[116:119]
  s_waitcnt lgkmcnt(5)
  v_cvt_pk_bf16_f32 v65, v66, v67
  v_mfma_f32_16x16x32_bf16 v[88:91], v[48:51], v[132:135], v[88:91]
  ds_read_b128 v[40:43], v250 offset:16640
  v_cvt_pk_bf16_f32 v66, v68, v69
  v_mfma_f32_16x16x32_bf16 v[96:99], v[48:51], v[164:167], v[96:99]
  v_cvt_pk_bf16_f32 v67, v70, v71
  v_accvgpr_write_b32 a96, v64
  v_mfma_f32_16x16x32_bf16 v[104:107], v[48:51], v[196:199], v[104:107]
  v_accvgpr_write_b32 a97, v65
  v_mfma_f32_16x16x32_bf16 v[112:115], v[48:51], v[228:231], v[112:115]
  s_waitcnt lgkmcnt(5)
  v_accvgpr_write_b32 a98, v66
  v_mfma_f32_16x16x32_bf16 v[92:95], v[52:55], v[132:135], v[92:95]
  ds_read_b128 v[44:47], v250 offset:18688
  v_accvgpr_write_b32 a99, v67
  v_mfma_f32_16x16x32_bf16 v[100:103], v[52:55], v[164:167], v[100:103]
  v_mul_f32 v72, v12, v72
  v_mul_f32 v73, v12, v73
  v_mfma_f32_16x16x32_bf16 v[108:111], v[52:55], v[196:199], v[108:111]
  v_mul_f32 v74, v12, v74
  v_mfma_f32_16x16x32_bf16 v[116:119], v[52:55], v[228:231], v[116:119]
  s_waitcnt lgkmcnt(5)
  v_mul_f32 v75, v12, v75
  v_mfma_f32_16x16x32_bf16 v[88:91], v[24:27], v[136:139], v[88:91]
  ds_read_b128 v[48:51], v251 offset:16640
  v_mul_f32 v76, v12, v76
  v_mfma_f32_16x16x32_bf16 v[96:99], v[24:27], v[168:171], v[96:99]
  v_mul_f32 v77, v12, v77
  v_mul_f32 v78, v12, v78
  v_mfma_f32_16x16x32_bf16 v[104:107], v[24:27], v[200:203], v[104:107]
  v_mul_f32 v79, v12, v79
  v_mfma_f32_16x16x32_bf16 v[112:115], v[24:27], v[232:235], v[112:115]
  s_waitcnt lgkmcnt(5)
  v_cvt_pk_bf16_f32 v72, v72, v73
  v_mfma_f32_16x16x32_bf16 v[92:95], v[28:31], v[136:139], v[92:95]
  ds_read_b128 v[52:55], v251 offset:18688
  v_cvt_pk_bf16_f32 v73, v74, v75
  v_mfma_f32_16x16x32_bf16 v[100:103], v[28:31], v[168:171], v[100:103]
  v_cvt_pk_bf16_f32 v74, v76, v77
  v_cvt_pk_bf16_f32 v75, v78, v79
  v_mfma_f32_16x16x32_bf16 v[108:111], v[28:31], v[200:203], v[108:111]
  v_accvgpr_write_b32 a152, v72
  v_mfma_f32_16x16x32_bf16 v[116:119], v[28:31], v[232:235], v[116:119]
  s_waitcnt lgkmcnt(5)
  v_accvgpr_write_b32 a153, v73
  v_mfma_f32_16x16x32_bf16 v[88:91], v[32:35], v[140:143], v[88:91]
  s_waitcnt vmcnt(4)
  s_barrier
  ds_read_b128 v[24:27], v248 offset:32768
  v_accvgpr_write_b32 a154, v74
  v_mfma_f32_16x16x32_bf16 v[96:99], v[32:35], v[172:175], v[96:99]
  v_accvgpr_write_b32 a155, v75
  v_mul_f32 v80, v12, v80
  v_mfma_f32_16x16x32_bf16 v[104:107], v[32:35], v[204:207], v[104:107]
  v_mul_f32 v81, v12, v81
  v_mfma_f32_16x16x32_bf16 v[112:115], v[32:35], v[236:239], v[112:115]
  s_waitcnt lgkmcnt(5)
  v_mul_f32 v82, v12, v82
  v_mfma_f32_16x16x32_bf16 v[92:95], v[36:39], v[140:143], v[92:95]
  ds_read_b128 v[28:31], v248 offset:34816
  v_mul_f32 v83, v12, v83
  v_mfma_f32_16x16x32_bf16 v[100:103], v[36:39], v[172:175], v[100:103]
  v_mul_f32 v84, v12, v84
  v_mul_f32 v85, v12, v85
  v_mfma_f32_16x16x32_bf16 v[108:111], v[36:39], v[204:207], v[108:111]
  v_mul_f32 v86, v12, v86
  v_mfma_f32_16x16x32_bf16 v[116:119], v[36:39], v[236:239], v[116:119]
  s_waitcnt lgkmcnt(5)
  v_mul_f32 v87, v12, v87
  v_mfma_f32_16x16x32_bf16 v[88:91], v[40:43], v[144:147], v[88:91]
  ds_read_b128 v[32:35], v249 offset:32768
  v_cvt_pk_bf16_f32 v80, v80, v81
  v_mfma_f32_16x16x32_bf16 v[96:99], v[40:43], v[176:179], v[96:99]
  v_cvt_pk_bf16_f32 v81, v82, v83
  v_cvt_pk_bf16_f32 v82, v84, v85
  v_mfma_f32_16x16x32_bf16 v[104:107], v[40:43], v[208:211], v[104:107]
  v_cvt_pk_bf16_f32 v83, v86, v87
  v_mfma_f32_16x16x32_bf16 v[112:115], v[40:43], v[240:243], v[112:115]
  s_waitcnt lgkmcnt(5)
  v_accvgpr_write_b32 a208, v80
  v_mfma_f32_16x16x32_bf16 v[92:95], v[44:47], v[144:147], v[92:95]
  ds_read_b128 v[36:39], v249 offset:34816
  v_accvgpr_write_b32 a209, v81
  v_mfma_f32_16x16x32_bf16 v[100:103], v[44:47], v[176:179], v[100:103]
  v_accvgpr_write_b32 a210, v82
  v_accvgpr_write_b32 a211, v83
  v_mfma_f32_16x16x32_bf16 v[108:111], v[44:47], v[208:211], v[108:111]
  v_mfma_f32_16x16x32_bf16 v[116:119], v[44:47], v[240:243], v[116:119]
  s_waitcnt lgkmcnt(5)
  v_mfma_f32_16x16x32_bf16 v[88:91], v[48:51], v[148:151], v[88:91]
  ds_read_b128 v[40:43], v250 offset:32768
  v_mfma_f32_16x16x32_bf16 v[96:99], v[48:51], v[180:183], v[96:99]
  v_mfma_f32_16x16x32_bf16 v[104:107], v[48:51], v[212:215], v[104:107]
  v_mfma_f32_16x16x32_bf16 v[112:115], v[48:51], v[244:247], v[112:115]
  s_waitcnt lgkmcnt(5)
  v_mfma_f32_16x16x32_bf16 v[92:95], v[52:55], v[148:151], v[92:95]
  ds_read_b128 v[44:47], v250 offset:34816
  v_mfma_f32_16x16x32_bf16 v[100:103], v[52:55], v[180:183], v[100:103]
  v_mfma_f32_16x16x32_bf16 v[108:111], v[52:55], v[212:215], v[108:111]
  v_mfma_f32_16x16x32_bf16 v[116:119], v[52:55], v[244:247], v[116:119]
  s_waitcnt lgkmcnt(5)
  v_mfma_f32_16x16x32_bf16 v[56:59], v[24:27], v[120:123], 0
  ds_read_b128 v[48:51], v251 offset:32768
  v_mfma_f32_16x16x32_bf16 v[64:67], v[24:27], v[152:155], 0
  v_mfma_f32_16x16x32_bf16 v[72:75], v[24:27], v[184:187], 0
  v_mfma_f32_16x16x32_bf16 v[80:83], v[24:27], v[216:219], 0
  s_waitcnt lgkmcnt(5)
  v_mul_f32 v88, v12, v88
  v_mfma_f32_16x16x32_bf16 v[60:63], v[28:31], v[120:123], 0
  ds_read_b128 v[52:55], v251 offset:34816
  v_mul_f32 v89, v12, v89
  v_mfma_f32_16x16x32_bf16 v[68:71], v[28:31], v[152:155], 0
  v_mul_f32 v90, v12, v90
  v_mul_f32 v91, v12, v91
  v_mfma_f32_16x16x32_bf16 v[76:79], v[28:31], v[184:187], 0
  v_mul_f32 v92, v12, v92
  v_mfma_f32_16x16x32_bf16 v[84:87], v[28:31], v[216:219], 0
  s_waitcnt lgkmcnt(5)
  v_mul_f32 v93, v12, v93
  v_mfma_f32_16x16x32_bf16 v[56:59], v[32:35], v[124:127], v[56:59]
  ds_read_b128 v[24:27], v248 offset:33024
  v_mul_f32 v94, v12, v94
  v_mfma_f32_16x16x32_bf16 v[64:67], v[32:35], v[156:159], v[64:67]
  v_mul_f32 v95, v12, v95
  v_cvt_pk_bf16_f32 v88, v88, v89
  v_mfma_f32_16x16x32_bf16 v[72:75], v[32:35], v[188:191], v[72:75]
  v_mfma_f32_16x16x32_bf16 v[80:83], v[32:35], v[220:223], v[80:83]
  s_waitcnt lgkmcnt(5)
  v_cvt_pk_bf16_f32 v89, v90, v91
  v_mfma_f32_16x16x32_bf16 v[60:63], v[36:39], v[124:127], v[60:63]
  ds_read_b128 v[28:31], v248 offset:35072
  v_cvt_pk_bf16_f32 v90, v92, v93
  v_mfma_f32_16x16x32_bf16 v[68:71], v[36:39], v[156:159], v[68:71]
  v_cvt_pk_bf16_f32 v91, v94, v95
  v_accvgpr_write_b32 a44, v88
  v_mfma_f32_16x16x32_bf16 v[76:79], v[36:39], v[188:191], v[76:79]
  v_accvgpr_write_b32 a45, v89
  v_mfma_f32_16x16x32_bf16 v[84:87], v[36:39], v[220:223], v[84:87]
  s_waitcnt lgkmcnt(5)
  v_accvgpr_write_b32 a46, v90
  v_mfma_f32_16x16x32_bf16 v[56:59], v[40:43], v[128:131], v[56:59]
  ds_read_b128 v[32:35], v249 offset:33024
  v_accvgpr_write_b32 a47, v91
  v_mfma_f32_16x16x32_bf16 v[64:67], v[40:43], v[160:163], v[64:67]
  v_mul_f32 v96, v12, v96
  v_mul_f32 v97, v12, v97
  v_mfma_f32_16x16x32_bf16 v[72:75], v[40:43], v[192:195], v[72:75]
  v_mfma_f32_16x16x32_bf16 v[80:83], v[40:43], v[224:227], v[80:83]
  s_waitcnt lgkmcnt(5)
  v_mul_f32 v98, v12, v98
  v_mfma_f32_16x16x32_bf16 v[60:63], v[44:47], v[128:131], v[60:63]
  ds_read_b128 v[36:39], v249 offset:35072
  v_mul_f32 v99, v12, v99
  v_mfma_f32_16x16x32_bf16 v[68:71], v[44:47], v[160:163], v[68:71]
  v_mul_f32 v100, v12, v100
  v_mul_f32 v101, v12, v101
  v_mfma_f32_16x16x32_bf16 v[76:79], v[44:47], v[192:195], v[76:79]
  v_mul_f32 v102, v12, v102
  v_mfma_f32_16x16x32_bf16 v[84:87], v[44:47], v[224:227], v[84:87]
  s_waitcnt lgkmcnt(5)
  v_mul_f32 v103, v12, v103
  v_mfma_f32_16x16x32_bf16 v[56:59], v[48:51], v[132:135], v[56:59]
  ds_read_b128 v[40:43], v250 offset:33024
  v_cvt_pk_bf16_f32 v96, v96, v97
  v_mfma_f32_16x16x32_bf16 v[64:67], v[48:51], v[164:167], v[64:67]
  v_cvt_pk_bf16_f32 v97, v98, v99
  v_cvt_pk_bf16_f32 v98, v100, v101
  v_mfma_f32_16x16x32_bf16 v[72:75], v[48:51], v[196:199], v[72:75]
  v_mfma_f32_16x16x32_bf16 v[80:83], v[48:51], v[228:231], v[80:83]
  s_waitcnt lgkmcnt(5)
  v_cvt_pk_bf16_f32 v99, v102, v103
  v_mfma_f32_16x16x32_bf16 v[60:63], v[52:55], v[132:135], v[60:63]
  ds_read_b128 v[44:47], v250 offset:35072
  v_accvgpr_write_b32 a100, v96
  v_mfma_f32_16x16x32_bf16 v[68:71], v[52:55], v[164:167], v[68:71]
  v_accvgpr_write_b32 a101, v97
  v_accvgpr_write_b32 a102, v98
  v_mfma_f32_16x16x32_bf16 v[76:79], v[52:55], v[196:199], v[76:79]
  v_accvgpr_write_b32 a103, v99
  v_mfma_f32_16x16x32_bf16 v[84:87], v[52:55], v[228:231], v[84:87]
  s_waitcnt lgkmcnt(5)
  v_mul_f32 v104, v12, v104
  v_mfma_f32_16x16x32_bf16 v[56:59], v[24:27], v[136:139], v[56:59]
  ds_read_b128 v[48:51], v251 offset:33024
  v_mul_f32 v105, v12, v105
  v_mfma_f32_16x16x32_bf16 v[64:67], v[24:27], v[168:171], v[64:67]
  v_mul_f32 v106, v12, v106
  v_mul_f32 v107, v12, v107
  v_mfma_f32_16x16x32_bf16 v[72:75], v[24:27], v[200:203], v[72:75]
  v_mfma_f32_16x16x32_bf16 v[80:83], v[24:27], v[232:235], v[80:83]
  s_waitcnt lgkmcnt(5)
  v_mul_f32 v108, v12, v108
  v_mfma_f32_16x16x32_bf16 v[60:63], v[28:31], v[136:139], v[60:63]
  ds_read_b128 v[52:55], v251 offset:35072
  v_mul_f32 v109, v12, v109
  v_mfma_f32_16x16x32_bf16 v[68:71], v[28:31], v[168:171], v[68:71]
  v_mul_f32 v110, v12, v110
  v_mul_f32 v111, v12, v111
  v_mfma_f32_16x16x32_bf16 v[76:79], v[28:31], v[200:203], v[76:79]
  v_cvt_pk_bf16_f32 v104, v104, v105
  v_mfma_f32_16x16x32_bf16 v[84:87], v[28:31], v[232:235], v[84:87]
  s_waitcnt lgkmcnt(5)
  v_cvt_pk_bf16_f32 v105, v106, v107
  v_mfma_f32_16x16x32_bf16 v[56:59], v[32:35], v[140:143], v[56:59]
  s_waitcnt vmcnt(0)
  s_barrier
  ds_read_b128 v[24:27], v248 offset:49152
  v_cvt_pk_bf16_f32 v106, v108, v109
  v_mfma_f32_16x16x32_bf16 v[64:67], v[32:35], v[172:175], v[64:67]
  v_cvt_pk_bf16_f32 v107, v110, v111
  v_accvgpr_write_b32 a156, v104
  v_mfma_f32_16x16x32_bf16 v[72:75], v[32:35], v[204:207], v[72:75]
  v_mfma_f32_16x16x32_bf16 v[80:83], v[32:35], v[236:239], v[80:83]
  s_waitcnt lgkmcnt(5)
  v_accvgpr_write_b32 a157, v105
  v_mfma_f32_16x16x32_bf16 v[60:63], v[36:39], v[140:143], v[60:63]
  ds_read_b128 v[28:31], v248 offset:51200
  v_accvgpr_write_b32 a158, v106
  v_mfma_f32_16x16x32_bf16 v[68:71], v[36:39], v[172:175], v[68:71]
  v_accvgpr_write_b32 a159, v107
  v_mul_f32 v112, v12, v112
  v_mfma_f32_16x16x32_bf16 v[76:79], v[36:39], v[204:207], v[76:79]
  v_mul_f32 v113, v12, v113
  v_mfma_f32_16x16x32_bf16 v[84:87], v[36:39], v[236:239], v[84:87]
  s_waitcnt lgkmcnt(5)
  v_mul_f32 v114, v12, v114
  v_mfma_f32_16x16x32_bf16 v[56:59], v[40:43], v[144:147], v[56:59]
  ds_read_b128 v[32:35], v249 offset:49152
  v_mul_f32 v115, v12, v115
  v_mfma_f32_16x16x32_bf16 v[64:67], v[40:43], v[176:179], v[64:67]
  v_mul_f32 v116, v12, v116
  v_mul_f32 v117, v12, v117
  v_mfma_f32_16x16x32_bf16 v[72:75], v[40:43], v[208:211], v[72:75]
  v_readfirstlane_b32 s86, v13
  s_lshl_b32 s22, s17, 7
  s_add_u32 s22, s22, 584192
  s_mov_b32 s23, 586240
  buffer_load_dword v13, off, s[8:11], s22 sc1
  buffer_load_dwordx2 v[10:11], off, s[8:11], s23 sc1
  v_mfma_f32_16x16x32_bf16 v[80:83], v[40:43], v[240:243], v[80:83]
  s_waitcnt lgkmcnt(5)
  v_mul_f32 v118, v12, v118
  v_mfma_f32_16x16x32_bf16 v[60:63], v[44:47], v[144:147], v[60:63]
  ds_read_b128 v[36:39], v249 offset:51200
  v_mul_f32 v119, v12, v119
  v_mfma_f32_16x16x32_bf16 v[68:71], v[44:47], v[176:179], v[68:71]
  v_cvt_pk_bf16_f32 v112, v112, v113
  v_cvt_pk_bf16_f32 v113, v114, v115
  v_mfma_f32_16x16x32_bf16 v[76:79], v[44:47], v[208:211], v[76:79]
  v_cvt_pk_bf16_f32 v114, v116, v117
  v_mfma_f32_16x16x32_bf16 v[84:87], v[44:47], v[240:243], v[84:87]
  s_waitcnt lgkmcnt(5)
  v_cvt_pk_bf16_f32 v115, v118, v119
  v_mfma_f32_16x16x32_bf16 v[56:59], v[48:51], v[148:151], v[56:59]
  ds_read_b128 v[40:43], v250 offset:49152
  v_accvgpr_write_b32 a212, v112
  v_mfma_f32_16x16x32_bf16 v[64:67], v[48:51], v[180:183], v[64:67]
  v_accvgpr_write_b32 a213, v113
  v_accvgpr_write_b32 a214, v114
  v_mfma_f32_16x16x32_bf16 v[72:75], v[48:51], v[212:215], v[72:75]
  v_accvgpr_write_b32 a215, v115
  v_mfma_f32_16x16x32_bf16 v[80:83], v[48:51], v[244:247], v[80:83]
  s_waitcnt lgkmcnt(5)
  v_mfma_f32_16x16x32_bf16 v[60:63], v[52:55], v[148:151], v[60:63]
  ds_read_b128 v[44:47], v250 offset:51200
  v_mfma_f32_16x16x32_bf16 v[68:71], v[52:55], v[180:183], v[68:71]
  v_mfma_f32_16x16x32_bf16 v[76:79], v[52:55], v[212:215], v[76:79]
  v_mfma_f32_16x16x32_bf16 v[84:87], v[52:55], v[244:247], v[84:87]
  s_waitcnt lgkmcnt(5)
  v_mfma_f32_16x16x32_bf16 v[88:91], v[24:27], v[120:123], 0
  ds_read_b128 v[48:51], v251 offset:49152
  v_mfma_f32_16x16x32_bf16 v[96:99], v[24:27], v[152:155], 0
  v_mfma_f32_16x16x32_bf16 v[104:107], v[24:27], v[184:187], 0
  v_mfma_f32_16x16x32_bf16 v[112:115], v[24:27], v[216:219], 0
  s_waitcnt lgkmcnt(5)
  v_mul_f32 v56, v12, v56
  v_mfma_f32_16x16x32_bf16 v[92:95], v[28:31], v[120:123], 0
  ds_read_b128 v[52:55], v251 offset:51200
  v_mul_f32 v57, v12, v57
  v_mfma_f32_16x16x32_bf16 v[100:103], v[28:31], v[152:155], 0
  v_mul_f32 v58, v12, v58
  v_mul_f32 v59, v12, v59
  v_mfma_f32_16x16x32_bf16 v[108:111], v[28:31], v[184:187], 0
  v_mul_f32 v60, v12, v60
  v_mfma_f32_16x16x32_bf16 v[116:119], v[28:31], v[216:219], 0
  s_waitcnt lgkmcnt(5)
  v_mul_f32 v61, v12, v61
  v_mfma_f32_16x16x32_bf16 v[88:91], v[32:35], v[124:127], v[88:91]
  ds_read_b128 v[24:27], v248 offset:49408
  v_mul_f32 v62, v12, v62
  v_mfma_f32_16x16x32_bf16 v[96:99], v[32:35], v[156:159], v[96:99]
  v_mul_f32 v63, v12, v63
  v_cvt_pk_bf16_f32 v56, v56, v57
  v_mfma_f32_16x16x32_bf16 v[104:107], v[32:35], v[188:191], v[104:107]
  v_cvt_pk_bf16_f32 v57, v58, v59
  v_mfma_f32_16x16x32_bf16 v[112:115], v[32:35], v[220:223], v[112:115]
  s_waitcnt lgkmcnt(5)
  v_cvt_pk_bf16_f32 v58, v60, v61
  v_mfma_f32_16x16x32_bf16 v[92:95], v[36:39], v[124:127], v[92:95]
  ds_read_b128 v[28:31], v248 offset:51456
  v_cvt_pk_bf16_f32 v59, v62, v63
  v_mfma_f32_16x16x32_bf16 v[100:103], v[36:39], v[156:159], v[100:103]
  v_accvgpr_write_b32 a48, v56
  v_accvgpr_write_b32 a49, v57
  v_mfma_f32_16x16x32_bf16 v[108:111], v[36:39], v[188:191], v[108:111]
  v_accvgpr_write_b32 a50, v58
  v_mfma_f32_16x16x32_bf16 v[116:119], v[36:39], v[220:223], v[116:119]
  s_waitcnt lgkmcnt(5)
  v_accvgpr_write_b32 a51, v59
  v_mfma_f32_16x16x32_bf16 v[88:91], v[40:43], v[128:131], v[88:91]
  ds_read_b128 v[32:35], v249 offset:49408
  v_mul_f32 v64, v12, v64
  v_mfma_f32_16x16x32_bf16 v[96:99], v[40:43], v[160:163], v[96:99]
  v_mul_f32 v65, v12, v65
  v_mul_f32 v66, v12, v66
  v_mfma_f32_16x16x32_bf16 v[104:107], v[40:43], v[192:195], v[104:107]
  v_mul_f32 v67, v12, v67
  v_mfma_f32_16x16x32_bf16 v[112:115], v[40:43], v[224:227], v[112:115]
  s_waitcnt lgkmcnt(5)
  v_mul_f32 v68, v12, v68
  v_mfma_f32_16x16x32_bf16 v[92:95], v[44:47], v[128:131], v[92:95]
  ds_read_b128 v[36:39], v249 offset:51456
  v_mul_f32 v69, v12, v69
  v_mfma_f32_16x16x32_bf16 v[100:103], v[44:47], v[160:163], v[100:103]
  v_mul_f32 v70, v12, v70
  v_mul_f32 v71, v12, v71
  v_mfma_f32_16x16x32_bf16 v[108:111], v[44:47], v[192:195], v[108:111]
  v_cvt_pk_bf16_f32 v64, v64, v65
  v_mfma_f32_16x16x32_bf16 v[116:119], v[44:47], v[224:227], v[116:119]
  s_waitcnt lgkmcnt(5)
  v_cvt_pk_bf16_f32 v65, v66, v67
  v_mfma_f32_16x16x32_bf16 v[88:91], v[48:51], v[132:135], v[88:91]
  ds_read_b128 v[40:43], v250 offset:49408
  v_cvt_pk_bf16_f32 v66, v68, v69
  v_mfma_f32_16x16x32_bf16 v[96:99], v[48:51], v[164:167], v[96:99]
  v_cvt_pk_bf16_f32 v67, v70, v71
  v_accvgpr_write_b32 a104, v64
  v_mfma_f32_16x16x32_bf16 v[104:107], v[48:51], v[196:199], v[104:107]
  v_accvgpr_write_b32 a105, v65
  v_mfma_f32_16x16x32_bf16 v[112:115], v[48:51], v[228:231], v[112:115]
  s_waitcnt lgkmcnt(5)
  v_accvgpr_write_b32 a106, v66
  v_mfma_f32_16x16x32_bf16 v[92:95], v[52:55], v[132:135], v[92:95]
  ds_read_b128 v[44:47], v250 offset:51456
  v_accvgpr_write_b32 a107, v67
  v_mfma_f32_16x16x32_bf16 v[100:103], v[52:55], v[164:167], v[100:103]
  v_mul_f32 v72, v12, v72
  v_mul_f32 v73, v12, v73
  v_mfma_f32_16x16x32_bf16 v[108:111], v[52:55], v[196:199], v[108:111]
  v_mul_f32 v74, v12, v74
  v_mfma_f32_16x16x32_bf16 v[116:119], v[52:55], v[228:231], v[116:119]
  s_waitcnt lgkmcnt(5)
  v_mul_f32 v75, v12, v75
  v_mfma_f32_16x16x32_bf16 v[88:91], v[24:27], v[136:139], v[88:91]
  ds_read_b128 v[48:51], v251 offset:49408
  v_mul_f32 v76, v12, v76
  v_mfma_f32_16x16x32_bf16 v[96:99], v[24:27], v[168:171], v[96:99]
  v_mul_f32 v77, v12, v77
  v_mul_f32 v78, v12, v78
  v_mfma_f32_16x16x32_bf16 v[104:107], v[24:27], v[200:203], v[104:107]
  v_mul_f32 v79, v12, v79
  v_mfma_f32_16x16x32_bf16 v[112:115], v[24:27], v[232:235], v[112:115]
  s_waitcnt lgkmcnt(5)
  v_cvt_pk_bf16_f32 v72, v72, v73
  v_mfma_f32_16x16x32_bf16 v[92:95], v[28:31], v[136:139], v[92:95]
  ds_read_b128 v[52:55], v251 offset:51456
  v_cvt_pk_bf16_f32 v73, v74, v75
  v_mfma_f32_16x16x32_bf16 v[100:103], v[28:31], v[168:171], v[100:103]
  v_cvt_pk_bf16_f32 v74, v76, v77
  v_cvt_pk_bf16_f32 v75, v78, v79
  v_mfma_f32_16x16x32_bf16 v[108:111], v[28:31], v[200:203], v[108:111]
  v_accvgpr_write_b32 a160, v72
  v_mfma_f32_16x16x32_bf16 v[116:119], v[28:31], v[232:235], v[116:119]
  s_waitcnt lgkmcnt(5)
  v_accvgpr_write_b32 a161, v73
  v_mfma_f32_16x16x32_bf16 v[88:91], v[32:35], v[140:143], v[88:91]
  v_accvgpr_write_b32 a162, v74
  v_mfma_f32_16x16x32_bf16 v[96:99], v[32:35], v[172:175], v[96:99]
  v_accvgpr_write_b32 a163, v75
  v_mul_f32 v80, v12, v80
  v_mfma_f32_16x16x32_bf16 v[104:107], v[32:35], v[204:207], v[104:107]
  v_mul_f32 v81, v12, v81
  v_mfma_f32_16x16x32_bf16 v[112:115], v[32:35], v[236:239], v[112:115]
  s_waitcnt lgkmcnt(4)
  v_mul_f32 v82, v12, v82
  v_mfma_f32_16x16x32_bf16 v[92:95], v[36:39], v[140:143], v[92:95]
  v_mul_f32 v83, v12, v83
  v_mfma_f32_16x16x32_bf16 v[100:103], v[36:39], v[172:175], v[100:103]
  v_mul_f32 v84, v12, v84
  v_mul_f32 v85, v12, v85
  v_mfma_f32_16x16x32_bf16 v[108:111], v[36:39], v[204:207], v[108:111]
  v_mul_f32 v86, v12, v86
  v_mfma_f32_16x16x32_bf16 v[116:119], v[36:39], v[236:239], v[116:119]
  s_waitcnt lgkmcnt(3)
  v_mul_f32 v87, v12, v87
  v_mfma_f32_16x16x32_bf16 v[88:91], v[40:43], v[144:147], v[88:91]
  v_cvt_pk_bf16_f32 v80, v80, v81
  v_mfma_f32_16x16x32_bf16 v[96:99], v[40:43], v[176:179], v[96:99]
  v_cvt_pk_bf16_f32 v81, v82, v83
  v_cvt_pk_bf16_f32 v82, v84, v85
  v_mfma_f32_16x16x32_bf16 v[104:107], v[40:43], v[208:211], v[104:107]
  v_cvt_pk_bf16_f32 v83, v86, v87
  v_mfma_f32_16x16x32_bf16 v[112:115], v[40:43], v[240:243], v[112:115]
  s_waitcnt lgkmcnt(2)
  v_accvgpr_write_b32 a216, v80
  v_mfma_f32_16x16x32_bf16 v[92:95], v[44:47], v[144:147], v[92:95]
  v_accvgpr_write_b32 a217, v81
  v_mfma_f32_16x16x32_bf16 v[100:103], v[44:47], v[176:179], v[100:103]
  v_accvgpr_write_b32 a218, v82
  v_accvgpr_write_b32 a219, v83
  v_mfma_f32_16x16x32_bf16 v[108:111], v[44:47], v[208:211], v[108:111]
  v_mfma_f32_16x16x32_bf16 v[116:119], v[44:47], v[240:243], v[116:119]
  s_waitcnt lgkmcnt(1)
  v_mfma_f32_16x16x32_bf16 v[88:91], v[48:51], v[148:151], v[88:91]
  v_mfma_f32_16x16x32_bf16 v[96:99], v[48:51], v[180:183], v[96:99]
  v_mfma_f32_16x16x32_bf16 v[104:107], v[48:51], v[212:215], v[104:107]
  v_mfma_f32_16x16x32_bf16 v[112:115], v[48:51], v[244:247], v[112:115]
  s_waitcnt lgkmcnt(0)
  v_mfma_f32_16x16x32_bf16 v[92:95], v[52:55], v[148:151], v[92:95]
  v_mfma_f32_16x16x32_bf16 v[100:103], v[52:55], v[180:183], v[100:103]
  v_mfma_f32_16x16x32_bf16 v[108:111], v[52:55], v[212:215], v[108:111]
  v_mfma_f32_16x16x32_bf16 v[116:119], v[52:55], v[244:247], v[116:119]
  v_mul_f32 v88, v12, v88
  v_mul_f32 v89, v12, v89
  v_mul_f32 v90, v12, v90
  v_mul_f32 v91, v12, v91
  v_mul_f32 v92, v12, v92
  v_mul_f32 v93, v12, v93
  v_mul_f32 v94, v12, v94
  v_mul_f32 v95, v12, v95
  v_cvt_pk_bf16_f32 v88, v88, v89
  v_cvt_pk_bf16_f32 v89, v90, v91
  v_cvt_pk_bf16_f32 v90, v92, v93
  v_cvt_pk_bf16_f32 v91, v94, v95
  v_accvgpr_write_b32 a52, v88
  v_accvgpr_write_b32 a53, v89
  v_accvgpr_write_b32 a54, v90
  v_accvgpr_write_b32 a55, v91
  v_mul_f32 v96, v12, v96
  v_mul_f32 v97, v12, v97
  v_mul_f32 v98, v12, v98
  v_mul_f32 v99, v12, v99
  v_mul_f32 v100, v12, v100
  v_mul_f32 v101, v12, v101
  v_mul_f32 v102, v12, v102
  v_mul_f32 v103, v12, v103
  v_cvt_pk_bf16_f32 v96, v96, v97
  v_cvt_pk_bf16_f32 v97, v98, v99
  v_cvt_pk_bf16_f32 v98, v100, v101
  v_cvt_pk_bf16_f32 v99, v102, v103
  v_accvgpr_write_b32 a108, v96
  v_accvgpr_write_b32 a109, v97
  v_accvgpr_write_b32 a110, v98
  v_accvgpr_write_b32 a111, v99
  v_mul_f32 v104, v12, v104
  v_mul_f32 v105, v12, v105
  v_mul_f32 v106, v12, v106
  v_mul_f32 v107, v12, v107
  v_mul_f32 v108, v12, v108
  v_mul_f32 v109, v12, v109
  v_mul_f32 v110, v12, v110
  v_mul_f32 v111, v12, v111
  v_cvt_pk_bf16_f32 v104, v104, v105
  v_cvt_pk_bf16_f32 v105, v106, v107
  v_cvt_pk_bf16_f32 v106, v108, v109
  v_cvt_pk_bf16_f32 v107, v110, v111
  v_accvgpr_write_b32 a164, v104
  v_accvgpr_write_b32 a165, v105
  v_accvgpr_write_b32 a166, v106
  v_accvgpr_write_b32 a167, v107
  v_mul_f32 v112, v12, v112
  v_mul_f32 v113, v12, v113
  v_mul_f32 v114, v12, v114
  v_mul_f32 v115, v12, v115
  v_mul_f32 v116, v12, v116
  v_mul_f32 v117, v12, v117
  v_mul_f32 v118, v12, v118
  v_mul_f32 v119, v12, v119
  v_cvt_pk_bf16_f32 v112, v112, v113
  v_cvt_pk_bf16_f32 v113, v114, v115
  v_cvt_pk_bf16_f32 v114, v116, v117
  v_cvt_pk_bf16_f32 v115, v118, v119
  v_accvgpr_write_b32 a220, v112
  v_accvgpr_write_b32 a221, v113
  v_accvgpr_write_b32 a222, v114
  v_accvgpr_write_b32 a223, v115
  s_waitcnt vmcnt(0)
  s_barrier
  v_readfirstlane_b32 s84, v13
  v_readfirstlane_b32 s85, v10
  v_readfirstlane_b32 s22, v11
  s_and_b32 s86, s86, s22
  s_cmp_eq_u32 s86, 1
  s_cselect_b32 s84, s84, 0
  v_and_b32 v10, 0xffe0, v9
  v_cmp_eq_u32 vcc, 0, v10
  s_cbranch_vccz ch_md_ok
ch_role2:
  s_mov_b32 s30, 0
ch_md:
  buffer_load_dword v9, off, s[12:15], 0 sc1
  s_waitcnt vmcnt(0)
  v_and_b32 v10, 0xffe0, v9
  v_cmp_eq_u32 vcc, 0, v10
  s_cbranch_vccz ch_md_ok
  s_sleep 4
  s_add_u32 s30, s30, 1
  s_cmp_lt_u32 s30, 1600000
  s_cbranch_scc1 ch_md
  s_branch ch_end
ch_md_ok:
  v_readfirstlane_b32 s88, v9
  s_lshr_b32 s88, s88, 16
  v_and_b32 v1, 63, v0
  v_lshlrev_b32 v2, 4, v1
  v_lshrrev_b32 v116, 4, v1
  v_and_b32 v117, 15, v1
  v_mov_b32 v3, 0x4444
  v_mov_b32 v118, 0xeeee
  v_cmp_lt_u32 vcc, 7, v117
  s_nop 1
  v_cndmask_b32 v3, v3, v118, vcc
  s_mov_b32 s19, 0
  s_mov_b32 s18, 1
  s_mov_b32 s20, 0
  s_mov_b32 s21, 17664
  s_mov_b32 s23, 4096
  s_lshr_b32 s89, s17, 4
  s_lshl_b32 s89, s89, 2
  s_add_u32 s89, s89, s16
  s_and_b32 s17, s17, 15
  s_cmp_eq_u32 s89, 0
  s_cbranch_scc1 ch_init0
  s_cmp_eq_u32 s89, 1
  s_cbranch_scc1 ch_init1
  s_cmp_eq_u32 s89, 2
  s_cbranch_scc1 ch_init2
  s_cmp_eq_u32 s89, 3
  s_cbranch_scc1 ch_init3
  s_cmp_eq_u32 s89, 4
  s_cbranch_scc1 ch_init4
  s_cmp_eq_u32 s89, 5
  s_cbranch_scc1 ch_init5
  s_cmp_eq_u32 s89, 6
  s_cbranch_scc1 ch_init6
  s_cmp_eq_u32 s89, 7
  s_cbranch_scc1 ch_init7
  s_branch ch_end
ch_init0:
  s_mul_i32 s31, s17, 401408
  s_add_u32 s31, s31, 33554432
  s_and_b32 s28, s84, 10320
  s_lshl_b32 s22, s85, 16
  s_or_b32 s28, s28, s22
  s_cmp_eq_u32 s28, 4294912080
  s_cbranch_scc1 ch_wx0_ok
  s_mov_b32 s30, 0
ch_wr0:
  buffer_load_dword v9, off, s[12:15], 0 offset:132 sc1
  s_waitcnt vmcnt(0)
  v_cmp_ne_u32 vcc, 1, v9
  s_cbranch_vccz ch_wr0_ok
  s_sleep 8
  s_add_u32 s30, s30, 1
  s_cmp_lt_u32 s30, 400000
  s_cbranch_scc1 ch_wr0
  s_branch cA_abort
ch_wr0_ok:
  s_lshl_b32 s27, s17, 7
  s_add_u32 s27, s27, 584192
  s_mov_b32 s28, 10320
  s_mov_b32 s30, 0
ch_wb0:
  buffer_load_dword v9, off, s[8:11], s27  sc1
  s_waitcnt vmcnt(0)
  v_and_b32 v10, s28, v9
  v_cmp_ne_u32 vcc, s28, v10
  s_cbranch_vccz ch_wb0_ok
  s_sleep 3
  s_add_u32 s30, s30, 1
  s_cmp_lt_u32 s30, 400000
  s_cbranch_scc1 ch_wb0
  s_branch cA_abort
ch_wb0_ok:
  s_mov_b32 s29, 586240
  s_mov_b32 s28, 0xffff
  s_mov_b32 s30, 0
ch_wx0:
  buffer_load_dword v9, off, s[8:11], s29  sc1
  s_waitcnt vmcnt(0)
  v_and_b32 v10, s28, v9
  v_cmp_ne_u32 vcc, s28, v10
  s_cbranch_vccz ch_wx0_ok
  s_sleep 8
  s_add_u32 s30, s30, 1
  s_cmp_lt_u32 s30, 400000
  s_cbranch_scc1 ch_wx0
  s_branch cA_abort
ch_wx0_ok:
  s_add_u32 s22, s31, 229376
  buffer_load_dwordx4 a[224:227], v2, s[8:11], s22 offen offset:0 sc1
  buffer_load_dwordx4 a[228:231], v2, s[8:11], s22 offen offset:1024 sc1
  buffer_load_dwordx4 a[232:235], v2, s[8:11], s22 offen offset:2048 sc1
  buffer_load_dwordx4 a[236:239], v2, s[8:11], s22 offen offset:3072 sc1
  s_add_u32 s22, s31, 233472
  buffer_load_dwordx4 a[240:243], v2, s[8:11], s22 offen offset:0 sc1
  buffer_load_dwordx4 a[244:247], v2, s[8:11], s22 offen offset:1024 sc1
  buffer_load_dwordx4 a[248:251], v2, s[8:11], s22 offen offset:2048 sc1
  buffer_load_dwordx4 a[252:255], v2, s[8:11], s22 offen offset:3072 sc1
  s_add_u32 s22, s31, 237568
  buffer_load_dwordx4 v[120:123], v2, s[8:11], s22 offen offset:0 sc1
  buffer_load_dwordx4 v[124:127], v2, s[8:11], s22 offen offset:1024 sc1
  buffer_load_dwordx4 v[128:131], v2, s[8:11], s22 offen offset:2048 sc1
  buffer_load_dwordx4 v[132:135], v2, s[8:11], s22 offen offset:3072 sc1
  s_add_u32 s22, s31, 241664
  buffer_load_dwordx4 v[136:139], v2, s[8:11], s22 offen offset:0 sc1
  buffer_load_dwordx4 v[140:143], v2, s[8:11], s22 offen offset:1024 sc1
  buffer_load_dwordx4 v[144:147], v2, s[8:11], s22 offen offset:2048 sc1
  buffer_load_dwordx4 v[148:151], v2, s[8:11], s22 offen offset:3072 sc1
  s_add_u32 s22, s31, 245760
  buffer_load_dwordx4 v[152:155], v2, s[8:11], s22 offen offset:0 sc1
  buffer_load_dwordx4 v[156:159], v2, s[8:11], s22 offen offset:1024 sc1
  buffer_load_dwordx4 v[160:163], v2, s[8:11], s22 offen offset:2048 sc1
  buffer_load_dwordx4 v[164:167], v2, s[8:11], s22 offen offset:3072 sc1
  s_add_u32 s22, s31, 249856
  buffer_load_dwordx4 v[168:171], v2, s[8:11], s22 offen offset:0 sc1
  buffer_load_dwordx4 v[172:175], v2, s[8:11], s22 offen offset:1024 sc1
  buffer_load_dwordx4 v[176:179], v2, s[8:11], s22 offen offset:2048 sc1
  buffer_load_dwordx4 v[180:183], v2, s[8:11], s22 offen offset:3072 sc1
  s_mov_b32 s24, 655360
  s_mov_b32 s26, 669696
  v_and_b32 v64, 7, v117
  v_and_b32 v65, 1, v116
  v_lshlrev_b32 v65, 2, v65
  v_sub_u32 v64, v64, v65
  v_lshrrev_b32 v65, 3, v117
  v_lshl_add_u32 v66, v65, 2, v64
  v_cmp_gt_u32 vcc, 4, v64
  v_mov_b32 v67, 99
  s_nop 0
  v_cndmask_b32 v66, v67, v66, vcc
  v_mov_b32 v68, 0x3f80
  v_mov_b32 v69, 0x3f800000
  v_mov_b32 v4, 0
  v_cmp_eq_u32 vcc, 0, v66
  s_nop 1
  v_cndmask_b32 v4, v4, v68, vcc
  v_cmp_eq_u32 vcc, 1, v66
  s_nop 1
  v_cndmask_b32 v4, v4, v69, vcc
  v_mov_b32 v5, 0
  v_cmp_eq_u32 vcc, 2, v66
  s_nop 1
  v_cndmask_b32 v5, v5, v68, vcc
  v_cmp_eq_u32 vcc, 3, v66
  s_nop 1
  v_cndmask_b32 v5, v5, v69, vcc
  v_mov_b32 v6, 0
  v_cmp_eq_u32 vcc, 4, v66
  s_nop 1
  v_cndmask_b32 v6, v6, v68, vcc
  v_cmp_eq_u32 vcc, 5, v66
  s_nop 1
  v_cndmask_b32 v6, v6, v69, vcc
  v_mov_b32 v7, 0
  v_cmp_eq_u32 vcc, 6, v66
  s_nop 1
  v_cndmask_b32 v7, v7, v68, vcc
  v_cmp_eq_u32 vcc, 7, v66
  s_nop 1
  v_cndmask_b32 v7, v7, v69, vcc
  v_lshrrev_b32 v64, 1, v116
  v_lshrrev_b32 v65, 3, v117
  v_and_b32 v66, 1, v116
  v_and_b32 v68, 7, v117
  v_lshlrev_b32 v67, 8, v65
  v_lshl_add_u32 v67, v68, 5, v67
  v_lshl_add_u32 v67, v66, 4, v67
  v_add_u32 v69, 4096, v67
  v_add_u32 v70, 6400, v67
  v_cmp_eq_u32 vcc, v64, v65
  s_nop 1
  v_cndmask_b32 v113, v70, v69, vcc
  v_and_b32 v74, 3, v117
  v_lshlrev_b32 v74, 1, v74
  v_bfe_u32 v75, v117, 2, 1
  v_or_b32 v74, v74, v75
  v_and_b32 v75, 8, v117
  v_or_b32 v74, v74, v75
  v_lshlrev_b32 v67, 9, v64
  v_lshl_add_u32 v67, v74, 4, v67
  v_lshl_add_u32 v67, v66, 3, v67
  v_add_u32 v114, 0, v67
  v_mul_u32_u24 v67, 1088, v65
  v_lshl_add_u32 v67, v116, 5, v67
  v_and_b32 v75, 1, v117
  v_and_b32 v76, 2, v117
  v_lshl_add_u32 v75, v76, 1, v75
  v_bfe_u32 v76, v117, 2, 1
  v_lshl_add_u32 v75, v76, 1, v75
  v_lshl_add_u32 v67, v75, 2, v67
  v_add_u32 v115, 4096, v67
  v_and_b32 v69, 1, v74
  v_lshlrev_b32 v67, 7, v69
  v_lshl_add_u32 v67, v116, 4, v67
  v_lshl_add_u32 v67, v65, 8, v67
  v_bfe_u32 v69, v74, 1, 2
  v_lshl_add_u32 v67, v69, 2, v67
  s_lshl_b32 s22, s17, 9
  s_add_u32 s22, s22, 9216
  v_add_u32 v72, s22, v67
  v_bfe_u32 v69, v75, 1, 1
  v_lshlrev_b32 v67, 7, v69
  v_lshl_add_u32 v67, v116, 4, v67
  v_and_b32 v69, 4, v75
  v_add_u32 v67, v67, v69
  s_lshr_b32 s22, s17, 1
  s_lshl_b32 s22, s22, 8
  s_and_b32 s27, s17, 1
  s_lshl_b32 s27, s27, 3
  s_add_u32 s22, s22, s27
  s_add_u32 s22, s22, 7168
  v_add_u32 v67, s22, v67
  v_and_b32 v69, 9, v117
  v_mov_b32 v70, 0x40000000
  v_cmp_eq_u32 vcc, 0, v69
  s_nop 1
  v_cndmask_b32 v118, v70, v67, vcc
  v_mov_b32 v119, -1
  v_and_b32 v0, 15, v1
  s_and_b32 s22, s17, 0
  s_lshl_b32 s22, s22, 7
  s_add_u32 s22, s22, 37376
  v_lshl_add_u32 v0, v0, 2, s22
  v_xor_b32 v69, 256, v2
  v_mul_i32_i24 v70, -4096, v66
  v_add_u32 v69, v69, v70
  v_add_u32 v117, 12288, v69
  v_mov_b32 v116, v73
  v_mov_b32 v112, 0
  s_mul_i32 s35, s17, 28672
  s_add_u32 s33, s35, 2949120
  s_mov_b32 s34, 0
  s_add_u32 s35, s35, 4325376
  v_mov_b32 v1, v72
  v_mov_b32 v36, 0
  v_mov_b32 v37, 0
  v_mov_b32 v38, 0
  v_mov_b32 v39, 0
  v_mov_b32 v40, 0
  v_mov_b32 v41, 0
  v_mov_b32 v42, 0
  v_mov_b32 v43, 0
  v_mov_b32 v44, 0
  v_mov_b32 v45, 0
  v_mov_b32 v46, 0
  v_mov_b32 v47, 0
  v_mov_b32 v48, 0
  v_mov_b32 v49, 0
  v_mov_b32 v50, 0
  v_mov_b32 v51, 0
  v_mov_b32 v52, 0
  v_mov_b32 v53, 0
  v_mov_b32 v54, 0
  v_mov_b32 v55, 0
  v_mov_b32 v56, 0
  v_mov_b32 v57, 0
  v_mov_b32 v58, 0
  v_mov_b32 v59, 0
  v_mov_b32 v60, 0
  v_mov_b32 v61, 0
  v_mov_b32 v62, 0
  v_mov_b32 v63, 0
  v_mov_b32 v64, 0
  v_mov_b32 v65, 0
  v_mov_b32 v66, 0
  v_mov_b32 v67, 0
  v_mov_b32 v68, 0
  v_mov_b32 v69, 0
  v_mov_b32 v70, 0
  v_mov_b32 v71, 0
  v_mov_b32 v72, 0
  v_mov_b32 v73, 0
  v_mov_b32 v74, 0
  v_mov_b32 v75, 0
  v_mov_b32 v76, 0
  v_mov_b32 v77, 0
  v_mov_b32 v78, 0
  v_mov_b32 v79, 0
  s_mov_b32 s22, 0
  v_lshrrev_b32 v14, 4, v2
  v_add_u32 v14, 0, v14
  v_min_u32 v14, 308, v14
  v_lshlrev_b32 v14, 7, v14
  buffer_load_dword v15, v14, s[8:11], s22 offen sc1
  v_lshrrev_b32 v14, 4, v2
  v_add_u32 v14, 256, v14
  v_min_u32 v14, 308, v14
  v_lshlrev_b32 v14, 7, v14
  buffer_load_dword v15, v14, s[8:11], s22 offen sc1
  buffer_load_dwordx4 v[80:83], v117, s[8:11], s24 offen offset:0 sc1
  buffer_load_dwordx4 v[84:87], v117, s[8:11], s24 offen offset:1024 sc1
  buffer_load_dwordx4 v[88:91], v117, s[8:11], s26 offen offset:0 sc1
  buffer_load_dwordx4 v[92:95], v117, s[8:11], s26 offen offset:1024 sc1
  buffer_load_dwordx4 v[96:99], v2, s[8:11], s24 offen offset:0 sc1
  buffer_load_dwordx4 v[100:103], v2, s[8:11], s24 offen offset:1024 sc1
  buffer_load_dwordx4 v[104:107], v2, s[8:11], s26 offen offset:0 sc1
  buffer_load_dwordx4 v[108:111], v2, s[8:11], s26 offen offset:1024 sc1
  s_add_u32 s22, s31, 253952
  buffer_load_dwordx4 v[184:187], v2, s[8:11], s22 offen offset:0 sc1
  buffer_load_dwordx4 v[188:191], v2, s[8:11], s22 offen offset:1024 sc1
  buffer_load_dwordx4 v[192:195], v2, s[8:11], s22 offen offset:2048 sc1
  buffer_load_dwordx4 v[196:199], v2, s[8:11], s22 offen offset:3072 sc1
  s_add_u32 s22, s31, 372736
  buffer_load_dwordx4 v[200:203], v2, s[8:11], s22 offen offset:0 sc1
  buffer_load_dwordx4 v[204:207], v2, s[8:11], s22 offen offset:1024 sc1
  buffer_load_dwordx4 v[208:211], v2, s[8:11], s22 offen offset:2048 sc1
  buffer_load_dwordx4 v[212:215], v2, s[8:11], s22 offen offset:3072 sc1
  s_add_u32 s22, s31, 376832
  buffer_load_dwordx4 v[216:219], v2, s[8:11], s22 offen offset:0 sc1
  buffer_load_dwordx4 v[220:223], v2, s[8:11], s22 offen offset:1024 sc1
  buffer_load_dwordx4 v[224:227], v2, s[8:11], s22 offen offset:2048 sc1
  buffer_load_dwordx4 v[228:231], v2, s[8:11], s22 offen offset:3072 sc1
  s_add_u32 s22, s31, 380928
  buffer_load_dwordx4 v[232:235], v2, s[8:11], s22 offen offset:0 sc1
  buffer_load_dwordx4 v[236:239], v2, s[8:11], s22 offen offset:1024 sc1
  buffer_load_dwordx4 v[240:243], v2, s[8:11], s22 offen offset:2048 sc1
  buffer_load_dwordx4 v[244:247], v2, s[8:11], s22 offen offset:3072 sc1
  s_add_u32 s22, s31, 385024
  buffer_load_dwordx4 v[248:251], v2, s[8:11], s22 offen offset:0 sc1
  buffer_load_dwordx4 v[252:255], v2, s[8:11], s22 offen offset:1024 sc1
  s_waitcnt vmcnt(0) lgkmcnt(0)
  s_mov_b32 s31, 0
  s_cmp_lg_u32 s88, 0
  s_cbranch_scc1 cB_sc0_loop
  s_branch cA_sc0_loop
ch_init1:
  s_mul_i32 s31, s17, 401408
  s_add_u32 s31, s31, 33554432
  s_and_b32 s28, s84, 10320
  s_lshl_b32 s22, s85, 16
  s_or_b32 s28, s28, s22
  s_cmp_eq_u32 s28, 4294912080
  s_cbranch_scc1 ch_wx1_ok
  s_mov_b32 s30, 0
ch_wr1:
  buffer_load_dword v9, off, s[12:15], 0 offset:132 sc1
  s_waitcnt vmcnt(0)
  v_cmp_ne_u32 vcc, 1, v9
  s_cbranch_vccz ch_wr1_ok
  s_sleep 8
  s_add_u32 s30, s30, 1
  s_cmp_lt_u32 s30, 400000
  s_cbranch_scc1 ch_wr1
  s_branch cA_abort
ch_wr1_ok:
  s_lshl_b32 s27, s17, 7
  s_add_u32 s27, s27, 584192
  s_mov_b32 s28, 10320
  s_mov_b32 s30, 0
ch_wb1:
  buffer_load_dword v9, off, s[8:11], s27  sc1
  s_waitcnt vmcnt(0)
  v_and_b32 v10, s28, v9
  v_cmp_ne_u32 vcc, s28, v10
  s_cbranch_vccz ch_wb1_ok
  s_sleep 3
  s_add_u32 s30, s30, 1
  s_cmp_lt_u32 s30, 400000
  s_cbranch_scc1 ch_wb1
  s_branch cA_abort
ch_wb1_ok:
  s_mov_b32 s29, 586240
  s_mov_b32 s28, 0xffff
  s_mov_b32 s30, 0
ch_wx1:
  buffer_load_dword v9, off, s[8:11], s29  sc1
  s_waitcnt vmcnt(0)
  v_and_b32 v10, s28, v9
  v_cmp_ne_u32 vcc, s28, v10
  s_cbranch_vccz ch_wx1_ok
  s_sleep 8
  s_add_u32 s30, s30, 1
  s_cmp_lt_u32 s30, 400000
  s_cbranch_scc1 ch_wx1
  s_branch cA_abort
ch_wx1_ok:
  s_add_u32 s22, s31, 258048
  buffer_load_dwordx4 a[224:227], v2, s[8:11], s22 offen offset:0 sc1
  buffer_load_dwordx4 a[228:231], v2, s[8:11], s22 offen offset:1024 sc1
  buffer_load_dwordx4 a[232:235], v2, s[8:11], s22 offen offset:2048 sc1
  buffer_load_dwordx4 a[236:239], v2, s[8:11], s22 offen offset:3072 sc1
  s_add_u32 s22, s31, 262144
  buffer_load_dwordx4 a[240:243], v2, s[8:11], s22 offen offset:0 sc1
  buffer_load_dwordx4 a[244:247], v2, s[8:11], s22 offen offset:1024 sc1
  buffer_load_dwordx4 a[248:251], v2, s[8:11], s22 offen offset:2048 sc1
  buffer_load_dwordx4 a[252:255], v2, s[8:11], s22 offen offset:3072 sc1
  s_add_u32 s22, s31, 266240
  buffer_load_dwordx4 v[120:123], v2, s[8:11], s22 offen offset:0 sc1
  buffer_load_dwordx4 v[124:127], v2, s[8:11], s22 offen offset:1024 sc1
  buffer_load_dwordx4 v[128:131], v2, s[8:11], s22 offen offset:2048 sc1
  buffer_load_dwordx4 v[132:135], v2, s[8:11], s22 offen offset:3072 sc1
  s_add_u32 s22, s31, 270336
  buffer_load_dwordx4 v[136:139], v2, s[8:11], s22 offen offset:0 sc1
  buffer_load_dwordx4 v[140:143], v2, s[8:11], s22 offen offset:1024 sc1
  buffer_load_dwordx4 v[144:147], v2, s[8:11], s22 offen offset:2048 sc1
  buffer_load_dwordx4 v[148:151], v2, s[8:11], s22 offen offset:3072 sc1
  s_add_u32 s22, s31, 274432
  buffer_load_dwordx4 v[152:155], v2, s[8:11], s22 offen offset:0 sc1
  buffer_load_dwordx4 v[156:159], v2, s[8:11], s22 offen offset:1024 sc1
  buffer_load_dwordx4 v[160:163], v2, s[8:11], s22 offen offset:2048 sc1
  buffer_load_dwordx4 v[164:167], v2, s[8:11], s22 offen offset:3072 sc1
  s_add_u32 s22, s31, 278528
  buffer_load_dwordx4 v[168:171], v2, s[8:11], s22 offen offset:0 sc1
  buffer_load_dwordx4 v[172:175], v2, s[8:11], s22 offen offset:1024 sc1
  buffer_load_dwordx4 v[176:179], v2, s[8:11], s22 offen offset:2048 sc1
  buffer_load_dwordx4 v[180:183], v2, s[8:11], s22 offen offset:3072 sc1
  s_mov_b32 s24, 657408
  s_mov_b32 s26, 671744
  v_and_b32 v64, 7, v117
  v_and_b32 v65, 1, v116
  v_lshlrev_b32 v65, 2, v65
  v_sub_u32 v64, v64, v65
  v_lshrrev_b32 v65, 3, v117
  v_lshl_add_u32 v66, v65, 2, v64
  v_cmp_gt_u32 vcc, 4, v64
  v_mov_b32 v67, 99
  s_nop 0
  v_cndmask_b32 v66, v67, v66, vcc
  v_mov_b32 v68, 0x3f80
  v_mov_b32 v69, 0x3f800000
  v_mov_b32 v4, 0
  v_cmp_eq_u32 vcc, 0, v66
  s_nop 1
  v_cndmask_b32 v4, v4, v68, vcc
  v_cmp_eq_u32 vcc, 1, v66
  s_nop 1
  v_cndmask_b32 v4, v4, v69, vcc
  v_mov_b32 v5, 0
  v_cmp_eq_u32 vcc, 2, v66
  s_nop 1
  v_cndmask_b32 v5, v5, v68, vcc
  v_cmp_eq_u32 vcc, 3, v66
  s_nop 1
  v_cndmask_b32 v5, v5, v69, vcc
  v_mov_b32 v6, 0
  v_cmp_eq_u32 vcc, 4, v66
  s_nop 1
  v_cndmask_b32 v6, v6, v68, vcc
  v_cmp_eq_u32 vcc, 5, v66
  s_nop 1
  v_cndmask_b32 v6, v6, v69, vcc
  v_mov_b32 v7, 0
  v_cmp_eq_u32 vcc, 6, v66
  s_nop 1
  v_cndmask_b32 v7, v7, v68, vcc
  v_cmp_eq_u32 vcc, 7, v66
  s_nop 1
  v_cndmask_b32 v7, v7, v69, vcc
  v_lshrrev_b32 v64, 1, v116
  v_lshrrev_b32 v65, 3, v117
  v_and_b32 v66, 1, v116
  v_and_b32 v68, 7, v117
  v_lshlrev_b32 v67, 8, v65
  v_lshl_add_u32 v67, v68, 5, v67
  v_lshl_add_u32 v67, v66, 4, v67
  v_add_u32 v69, 4608, v67
  v_add_u32 v70, 6400, v67
  v_cmp_eq_u32 vcc, v64, v65
  s_nop 1
  v_cndmask_b32 v113, v70, v69, vcc
  v_and_b32 v74, 3, v117
  v_lshlrev_b32 v74, 1, v74
  v_bfe_u32 v75, v117, 2, 1
  v_or_b32 v74, v74, v75
  v_and_b32 v75, 8, v117
  v_or_b32 v74, v74, v75
  v_lshlrev_b32 v67, 9, v64
  v_lshl_add_u32 v67, v74, 4, v67
  v_lshl_add_u32 v67, v66, 3, v67
  v_add_u32 v114, 256, v67
  v_mul_u32_u24 v67, 1088, v65
  v_lshl_add_u32 v67, v116, 5, v67
  v_and_b32 v75, 1, v117
  v_and_b32 v76, 2, v117
  v_lshl_add_u32 v75, v76, 1, v75
  v_bfe_u32 v76, v117, 2, 1
  v_lshl_add_u32 v75, v76, 1, v75
  v_lshl_add_u32 v67, v75, 2, v67
  v_add_u32 v115, 4224, v67
  v_and_b32 v69, 1, v74
  v_lshlrev_b32 v67, 7, v69
  v_lshl_add_u32 v67, v116, 4, v67
  v_lshl_add_u32 v67, v65, 8, v67
  v_bfe_u32 v69, v74, 1, 2
  v_lshl_add_u32 v67, v69, 2, v67
  s_lshl_b32 s22, s17, 9
  s_add_u32 s22, s22, 9280
  v_add_u32 v72, s22, v67
  v_bfe_u32 v69, v75, 1, 1
  v_lshlrev_b32 v67, 7, v69
  v_lshl_add_u32 v67, v116, 4, v67
  v_and_b32 v69, 4, v75
  v_add_u32 v67, v67, v69
  s_lshr_b32 s22, s17, 1
  s_lshl_b32 s22, s22, 8
  s_and_b32 s27, s17, 1
  s_lshl_b32 s27, s27, 3
  s_add_u32 s22, s22, s27
  s_add_u32 s22, s22, 7232
  v_add_u32 v67, s22, v67
  v_and_b32 v69, 9, v117
  v_mov_b32 v70, 0x40000000
  v_cmp_eq_u32 vcc, 0, v69
  s_nop 1
  v_cndmask_b32 v118, v70, v67, vcc
  v_mov_b32 v119, -1
  s_lshl_b32 s22, s17, 2
  s_add_u32 s22, s22, 35328
  v_lshl_add_u32 v67, v1, 7, s22
  v_mov_b32 v70, 0x40000000
  v_cmp_gt_u32 vcc, 1, v1
  s_nop 1
  v_cndmask_b32 v73, v70, v67, vcc
  v_mov_b32 v112, 1
  v_and_b32 v0, 15, v1
  s_and_b32 s22, s17, 0
  s_lshl_b32 s22, s22, 7
  s_add_u32 s22, s22, 37376
  v_lshl_add_u32 v0, v0, 2, s22
  v_xor_b32 v69, 256, v2
  v_mul_i32_i24 v70, 4096, v66
  v_add_u32 v69, v69, v70
  v_add_u32 v117, 6144, v69
  v_mov_b32 v116, v73
  s_mul_i32 s35, s17, 28672
  s_add_u32 s33, s35, 2949120
  s_mov_b32 s34, 0
  s_add_u32 s35, s35, 4325376
  v_mov_b32 v1, v72
  v_mov_b32 v36, 0
  v_mov_b32 v37, 0
  v_mov_b32 v38, 0
  v_mov_b32 v39, 0
  v_mov_b32 v40, 0
  v_mov_b32 v41, 0
  v_mov_b32 v42, 0
  v_mov_b32 v43, 0
  v_mov_b32 v44, 0
  v_mov_b32 v45, 0
  v_mov_b32 v46, 0
  v_mov_b32 v47, 0
  v_mov_b32 v48, 0
  v_mov_b32 v49, 0
  v_mov_b32 v50, 0
  v_mov_b32 v51, 0
  v_mov_b32 v52, 0
  v_mov_b32 v53, 0
  v_mov_b32 v54, 0
  v_mov_b32 v55, 0
  v_mov_b32 v56, 0
  v_mov_b32 v57, 0
  v_mov_b32 v58, 0
  v_mov_b32 v59, 0
  v_mov_b32 v60, 0
  v_mov_b32 v61, 0
  v_mov_b32 v62, 0
  v_mov_b32 v63, 0
  v_mov_b32 v64, 0
  v_mov_b32 v65, 0
  v_mov_b32 v66, 0
  v_mov_b32 v67, 0
  v_mov_b32 v68, 0
  v_mov_b32 v69, 0
  v_mov_b32 v70, 0
  v_mov_b32 v71, 0
  v_mov_b32 v72, 0
  v_mov_b32 v73, 0
  v_mov_b32 v74, 0
  v_mov_b32 v75, 0
  v_mov_b32 v76, 0
  v_mov_b32 v77, 0
  v_mov_b32 v78, 0
  v_mov_b32 v79, 0
  s_mov_b32 s22, 0
  v_lshrrev_b32 v14, 4, v2
  v_add_u32 v14, 64, v14
  v_min_u32 v14, 308, v14
  v_lshlrev_b32 v14, 7, v14
  buffer_load_dword v15, v14, s[8:11], s22 offen sc1
  buffer_load_dwordx4 v[80:83], v117, s[8:11], s24 offen offset:0 sc1
  buffer_load_dwordx4 v[84:87], v117, s[8:11], s24 offen offset:1024 sc1
  buffer_load_dwordx4 v[88:91], v117, s[8:11], s26 offen offset:0 sc1
  buffer_load_dwordx4 v[92:95], v117, s[8:11], s26 offen offset:1024 sc1
  buffer_load_dwordx4 v[96:99], v2, s[8:11], s24 offen offset:0 sc1
  buffer_load_dwordx4 v[100:103], v2, s[8:11], s24 offen offset:1024 sc1
  buffer_load_dwordx4 v[104:107], v2, s[8:11], s26 offen offset:0 sc1
  buffer_load_dwordx4 v[108:111], v2, s[8:11], s26 offen offset:1024 sc1
  s_add_u32 s22, s31, 282624
  buffer_load_dwordx4 v[184:187], v2, s[8:11], s22 offen offset:0 sc1
  buffer_load_dwordx4 v[188:191], v2, s[8:11], s22 offen offset:1024 sc1
  buffer_load_dwordx4 v[192:195], v2, s[8:11], s22 offen offset:2048 sc1
  buffer_load_dwordx4 v[196:199], v2, s[8:11], s22 offen offset:3072 sc1
  s_add_u32 s22, s31, 344064
  buffer_load_dwordx4 v[200:203], v2, s[8:11], s22 offen offset:0 sc1
  buffer_load_dwordx4 v[204:207], v2, s[8:11], s22 offen offset:1024 sc1
  buffer_load_dwordx4 v[208:211], v2, s[8:11], s22 offen offset:2048 sc1
  buffer_load_dwordx4 v[212:215], v2, s[8:11], s22 offen offset:3072 sc1
  s_add_u32 s22, s31, 348160
  buffer_load_dwordx4 v[216:219], v2, s[8:11], s22 offen offset:0 sc1
  buffer_load_dwordx4 v[220:223], v2, s[8:11], s22 offen offset:1024 sc1
  buffer_load_dwordx4 v[224:227], v2, s[8:11], s22 offen offset:2048 sc1
  buffer_load_dwordx4 v[228:231], v2, s[8:11], s22 offen offset:3072 sc1
  s_add_u32 s22, s31, 352256
  buffer_load_dwordx4 v[232:235], v2, s[8:11], s22 offen offset:0 sc1
  buffer_load_dwordx4 v[236:239], v2, s[8:11], s22 offen offset:1024 sc1
  buffer_load_dwordx4 v[240:243], v2, s[8:11], s22 offen offset:2048 sc1
  buffer_load_dwordx4 v[244:247], v2, s[8:11], s22 offen offset:3072 sc1
  s_add_u32 s22, s31, 356352
  buffer_load_dwordx4 v[248:251], v2, s[8:11], s22 offen offset:0 sc1
  buffer_load_dwordx4 v[252:255], v2, s[8:11], s22 offen offset:1024 sc1
  s_waitcnt vmcnt(0) lgkmcnt(0)
  s_mov_b32 s31, 0
  s_cmp_lg_u32 s88, 0
  s_cbranch_scc1 cB_sc1_loop
  s_branch cA_sc1_loop
ch_init2:
  s_mul_i32 s31, s17, 401408
  s_add_u32 s31, s31, 33554432
  s_and_b32 s28, s84, 12384
  s_lshl_b32 s22, s85, 16
  s_or_b32 s28, s28, s22
  s_cmp_eq_u32 s28, 4294914144
  s_cbranch_scc1 ch_wx2_ok
  s_mov_b32 s30, 0
ch_wr2:
  buffer_load_dword v9, off, s[12:15], 0 offset:132 sc1
  s_waitcnt vmcnt(0)
  v_cmp_ne_u32 vcc, 1, v9
  s_cbranch_vccz ch_wr2_ok
  s_sleep 8
  s_add_u32 s30, s30, 1
  s_cmp_lt_u32 s30, 400000
  s_cbranch_scc1 ch_wr2
  s_branch cA_abort
ch_wr2_ok:
  s_lshl_b32 s27, s17, 7
  s_add_u32 s27, s27, 584192
  s_mov_b32 s28, 12384
  s_mov_b32 s30, 0
ch_wb2:
  buffer_load_dword v9, off, s[8:11], s27  sc1
  s_waitcnt vmcnt(0)
  v_and_b32 v10, s28, v9
  v_cmp_ne_u32 vcc, s28, v10
  s_cbranch_vccz ch_wb2_ok
  s_sleep 3
  s_add_u32 s30, s30, 1
  s_cmp_lt_u32 s30, 400000
  s_cbranch_scc1 ch_wb2
  s_branch cA_abort
ch_wb2_ok:
  s_mov_b32 s29, 586240
  s_mov_b32 s28, 0xffff
  s_mov_b32 s30, 0
ch_wx2:
  buffer_load_dword v9, off, s[8:11], s29  sc1
  s_waitcnt vmcnt(0)
  v_and_b32 v10, s28, v9
  v_cmp_ne_u32 vcc, s28, v10
  s_cbranch_vccz ch_wx2_ok
  s_sleep 8
  s_add_u32 s30, s30, 1
  s_cmp_lt_u32 s30, 400000
  s_cbranch_scc1 ch_wx2
  s_branch cA_abort
ch_wx2_ok:
  s_add_u32 s22, s31, 286720
  buffer_load_dwordx4 a[224:227], v2, s[8:11], s22 offen offset:0 sc1
  buffer_load_dwordx4 a[228:231], v2, s[8:11], s22 offen offset:1024 sc1
  buffer_load_dwordx4 a[232:235], v2, s[8:11], s22 offen offset:2048 sc1
  buffer_load_dwordx4 a[236:239], v2, s[8:11], s22 offen offset:3072 sc1
  s_add_u32 s22, s31, 290816
  buffer_load_dwordx4 a[240:243], v2, s[8:11], s22 offen offset:0 sc1
  buffer_load_dwordx4 a[244:247], v2, s[8:11], s22 offen offset:1024 sc1
  buffer_load_dwordx4 a[248:251], v2, s[8:11], s22 offen offset:2048 sc1
  buffer_load_dwordx4 a[252:255], v2, s[8:11], s22 offen offset:3072 sc1
  s_add_u32 s22, s31, 294912
  buffer_load_dwordx4 v[120:123], v2, s[8:11], s22 offen offset:0 sc1
  buffer_load_dwordx4 v[124:127], v2, s[8:11], s22 offen offset:1024 sc1
  buffer_load_dwordx4 v[128:131], v2, s[8:11], s22 offen offset:2048 sc1
  buffer_load_dwordx4 v[132:135], v2, s[8:11], s22 offen offset:3072 sc1
  s_add_u32 s22, s31, 299008
  buffer_load_dwordx4 v[136:139], v2, s[8:11], s22 offen offset:0 sc1
  buffer_load_dwordx4 v[140:143], v2, s[8:11], s22 offen offset:1024 sc1
  buffer_load_dwordx4 v[144:147], v2, s[8:11], s22 offen offset:2048 sc1
  buffer_load_dwordx4 v[148:151], v2, s[8:11], s22 offen offset:3072 sc1
  s_add_u32 s22, s31, 303104
  buffer_load_dwordx4 v[152:155], v2, s[8:11], s22 offen offset:0 sc1
  buffer_load_dwordx4 v[156:159], v2, s[8:11], s22 offen offset:1024 sc1
  buffer_load_dwordx4 v[160:163], v2, s[8:11], s22 offen offset:2048 sc1
  buffer_load_dwordx4 v[164:167], v2, s[8:11], s22 offen offset:3072 sc1
  s_add_u32 s22, s31, 307200
  buffer_load_dwordx4 v[168:171], v2, s[8:11], s22 offen offset:0 sc1
  buffer_load_dwordx4 v[172:175], v2, s[8:11], s22 offen offset:1024 sc1
  buffer_load_dwordx4 v[176:179], v2, s[8:11], s22 offen offset:2048 sc1
  buffer_load_dwordx4 v[180:183], v2, s[8:11], s22 offen offset:3072 sc1
  s_mov_b32 s24, 659456
  s_mov_b32 s26, 673792
  v_and_b32 v64, 7, v117
  v_and_b32 v65, 1, v116
  v_lshlrev_b32 v65, 2, v65
  v_sub_u32 v64, v64, v65
  v_lshrrev_b32 v65, 3, v117
  v_lshl_add_u32 v66, v65, 2, v64
  v_cmp_gt_u32 vcc, 4, v64
  v_mov_b32 v67, 99
  s_nop 0
  v_cndmask_b32 v66, v67, v66, vcc
  v_mov_b32 v68, 0x3f80
  v_mov_b32 v69, 0x3f800000
  v_mov_b32 v4, 0
  v_cmp_eq_u32 vcc, 0, v66
  s_nop 1
  v_cndmask_b32 v4, v4, v68, vcc
  v_cmp_eq_u32 vcc, 1, v66
  s_nop 1
  v_cndmask_b32 v4, v4, v69, vcc
  v_mov_b32 v5, 0
  v_cmp_eq_u32 vcc, 2, v66
  s_nop 1
  v_cndmask_b32 v5, v5, v68, vcc
  v_cmp_eq_u32 vcc, 3, v66
  s_nop 1
  v_cndmask_b32 v5, v5, v69, vcc
  v_mov_b32 v6, 0
  v_cmp_eq_u32 vcc, 4, v66
  s_nop 1
  v_cndmask_b32 v6, v6, v68, vcc
  v_cmp_eq_u32 vcc, 5, v66
  s_nop 1
  v_cndmask_b32 v6, v6, v69, vcc
  v_mov_b32 v7, 0
  v_cmp_eq_u32 vcc, 6, v66
  s_nop 1
  v_cndmask_b32 v7, v7, v68, vcc
  v_cmp_eq_u32 vcc, 7, v66
  s_nop 1
  v_cndmask_b32 v7, v7, v69, vcc
  v_lshrrev_b32 v64, 1, v116
  v_lshrrev_b32 v65, 3, v117
  v_and_b32 v66, 1, v116
  v_and_b32 v68, 7, v117
  v_lshlrev_b32 v67, 8, v65
  v_lshl_add_u32 v67, v68, 5, v67
  v_lshl_add_u32 v67, v66, 4, v67
  v_add_u32 v69, 5184, v67
  v_add_u32 v70, 6400, v67
  v_cmp_eq_u32 vcc, v64, v65
  s_nop 1
  v_cndmask_b32 v113, v70, v69, vcc
  s_lshl_b32 s22, s17, 9
  s_add_u32 s22, s22, 9216
  v_lshl_add_u32 v114, v1, 3, s22
  s_lshr_b32 s22, s17, 1
  s_lshl_b32 s22, s22, 8
  s_and_b32 s27, s17, 1
  s_lshl_b32 s27, s27, 3
  s_add_u32 s22, s22, s27
  s_add_u32 s22, s22, 7168
  v_add_u32 v115, s22, v2
  v_mov_b32 v70, 0x40000000
  v_cmp_gt_u32 vcc, 16, v1
  s_nop 1
  v_cndmask_b32 v115, v70, v115, vcc
  v_mov_b32 v118, -1
  v_mov_b32 v119, -1
  v_and_b32 v0, 15, v1
  s_and_b32 s22, s17, 0
  s_lshl_b32 s22, s22, 7
  s_add_u32 s22, s22, 37376
  v_lshl_add_u32 v0, v0, 2, s22
  v_xor_b32 v69, 256, v2
  v_mul_i32_i24 v70, -2048, v66
  v_add_u32 v69, v69, v70
  v_add_u32 v117, 8192, v69
  v_mov_b32 v116, v73
  s_mul_i32 s35, s17, 28672
  s_add_u32 s33, s35, 2949120
  s_mov_b32 s34, 0
  s_add_u32 s35, s35, 4325376
  v_mov_b32 v36, 0
  v_mov_b32 v37, 0
  v_mov_b32 v38, 0
  v_mov_b32 v39, 0
  v_mov_b32 v40, 0
  v_mov_b32 v41, 0
  v_mov_b32 v42, 0
  v_mov_b32 v43, 0
  v_mov_b32 v44, 0
  v_mov_b32 v45, 0
  v_mov_b32 v46, 0
  v_mov_b32 v47, 0
  v_mov_b32 v48, 0
  v_mov_b32 v49, 0
  v_mov_b32 v50, 0
  v_mov_b32 v51, 0
  v_mov_b32 v52, 0
  v_mov_b32 v53, 0
  v_mov_b32 v54, 0
  v_mov_b32 v55, 0
  v_mov_b32 v56, 0
  v_mov_b32 v57, 0
  v_mov_b32 v58, 0
  v_mov_b32 v59, 0
  v_mov_b32 v60, 0
  v_mov_b32 v61, 0
  v_mov_b32 v62, 0
  v_mov_b32 v63, 0
  v_mov_b32 v64, 0
  v_mov_b32 v65, 0
  v_mov_b32 v66, 0
  v_mov_b32 v67, 0
  v_mov_b32 v68, 0
  v_mov_b32 v69, 0
  v_mov_b32 v70, 0
  v_mov_b32 v71, 0
  v_mov_b32 v72, 0
  v_mov_b32 v73, 0
  v_mov_b32 v74, 0
  v_mov_b32 v75, 0
  v_mov_b32 v76, 0
  v_mov_b32 v77, 0
  v_mov_b32 v78, 0
  v_mov_b32 v79, 0
  s_mov_b32 s22, 0
  v_lshrrev_b32 v14, 4, v2
  v_add_u32 v14, 128, v14
  v_min_u32 v14, 308, v14
  v_lshlrev_b32 v14, 7, v14
  buffer_load_dword v15, v14, s[8:11], s22 offen sc1
  buffer_load_dwordx4 v[80:83], v117, s[8:11], s24 offen offset:0 sc1
  buffer_load_dwordx4 v[84:87], v117, s[8:11], s24 offen offset:1024 sc1
  buffer_load_dwordx4 v[88:91], v117, s[8:11], s26 offen offset:0 sc1
  buffer_load_dwordx4 v[92:95], v117, s[8:11], s26 offen offset:1024 sc1
  buffer_load_dwordx4 v[96:99], v2, s[8:11], s24 offen offset:0 sc1
  buffer_load_dwordx4 v[100:103], v2, s[8:11], s24 offen offset:1024 sc1
  buffer_load_dwordx4 v[104:107], v2, s[8:11], s26 offen offset:0 sc1
  buffer_load_dwordx4 v[108:111], v2, s[8:11], s26 offen offset:1024 sc1
  s_add_u32 s22, s31, 311296
  buffer_load_dwordx4 v[184:187], v2, s[8:11], s22 offen offset:0 sc1
  buffer_load_dwordx4 v[188:191], v2, s[8:11], s22 offen offset:1024 sc1
  buffer_load_dwordx4 v[192:195], v2, s[8:11], s22 offen offset:2048 sc1
  buffer_load_dwordx4 v[196:199], v2, s[8:11], s22 offen offset:3072 sc1
  s_add_u32 s22, s31, 385024
  buffer_load_dwordx4 v[200:203], v2, s[8:11], s22 offen offset:2048 sc1
  buffer_load_dwordx4 v[204:207], v2, s[8:11], s22 offen offset:3072 sc1
  s_add_u32 s22, s31, 389120
  buffer_load_dwordx4 v[208:211], v2, s[8:11], s22 offen offset:0 sc1
  buffer_load_dwordx4 v[212:215], v2, s[8:11], s22 offen offset:1024 sc1
  buffer_load_dwordx4 v[216:219], v2, s[8:11], s22 offen offset:2048 sc1
  buffer_load_dwordx4 v[220:223], v2, s[8:11], s22 offen offset:3072 sc1
  s_add_u32 s22, s31, 393216
  buffer_load_dwordx4 v[224:227], v2, s[8:11], s22 offen offset:0 sc1
  buffer_load_dwordx4 v[228:231], v2, s[8:11], s22 offen offset:1024 sc1
  buffer_load_dwordx4 v[232:235], v2, s[8:11], s22 offen offset:2048 sc1
  buffer_load_dwordx4 v[236:239], v2, s[8:11], s22 offen offset:3072 sc1
  s_add_u32 s22, s31, 397312
  buffer_load_dwordx4 v[240:243], v2, s[8:11], s22 offen offset:0 sc1
  buffer_load_dwordx4 v[244:247], v2, s[8:11], s22 offen offset:1024 sc1
  buffer_load_dwordx4 v[248:251], v2, s[8:11], s22 offen offset:2048 sc1
  buffer_load_dwordx4 v[252:255], v2, s[8:11], s22 offen offset:3072 sc1
  s_waitcnt vmcnt(0) lgkmcnt(0)
  s_mov_b32 s31, 0
  s_cmp_lg_u32 s88, 0
  s_cbranch_scc1 cB_sc2_loop
  s_branch cA_sc2_loop
ch_init3:
  s_mul_i32 s31, s17, 401408
  s_add_u32 s31, s31, 33554432
  s_and_b32 s28, s84, 12384
  s_lshl_b32 s22, s85, 16
  s_or_b32 s28, s28, s22
  s_cmp_eq_u32 s28, 4294914144
  s_cbranch_scc1 ch_wx3_ok
  s_mov_b32 s30, 0
ch_wr3:
  buffer_load_dword v9, off, s[12:15], 0 offset:132 sc1
  s_waitcnt vmcnt(0)
  v_cmp_ne_u32 vcc, 1, v9
  s_cbranch_vccz ch_wr3_ok
  s_sleep 8
  s_add_u32 s30, s30, 1
  s_cmp_lt_u32 s30, 400000
  s_cbranch_scc1 ch_wr3
  s_branch cA_abort
ch_wr3_ok:
  s_lshl_b32 s27, s17, 7
  s_add_u32 s27, s27, 584192
  s_mov_b32 s28, 12384
  s_mov_b32 s30, 0
ch_wb3:
  buffer_load_dword v9, off, s[8:11], s27  sc1
  s_waitcnt vmcnt(0)
  v_and_b32 v10, s28, v9
  v_cmp_ne_u32 vcc, s28, v10
  s_cbranch_vccz ch_wb3_ok
  s_sleep 3
  s_add_u32 s30, s30, 1
  s_cmp_lt_u32 s30, 400000
  s_cbranch_scc1 ch_wb3
  s_branch cA_abort
ch_wb3_ok:
  s_mov_b32 s29, 586240
  s_mov_b32 s28, 0xffff
  s_mov_b32 s30, 0
ch_wx3:
  buffer_load_dword v9, off, s[8:11], s29  sc1
  s_waitcnt vmcnt(0)
  v_and_b32 v10, s28, v9
  v_cmp_ne_u32 vcc, s28, v10
  s_cbranch_vccz ch_wx3_ok
  s_sleep 8
  s_add_u32 s30, s30, 1
  s_cmp_lt_u32 s30, 400000
  s_cbranch_scc1 ch_wx3
  s_branch cA_abort
ch_wx3_ok:
  s_add_u32 s22, s31, 315392
  buffer_load_dwordx4 a[224:227], v2, s[8:11], s22 offen offset:0 sc1
  buffer_load_dwordx4 a[228:231], v2, s[8:11], s22 offen offset:1024 sc1
  buffer_load_dwordx4 a[232:235], v2, s[8:11], s22 offen offset:2048 sc1
  buffer_load_dwordx4 a[236:239], v2, s[8:11], s22 offen offset:3072 sc1
  s_add_u32 s22, s31, 319488
  buffer_load_dwordx4 a[240:243], v2, s[8:11], s22 offen offset:0 sc1
  buffer_load_dwordx4 a[244:247], v2, s[8:11], s22 offen offset:1024 sc1
  buffer_load_dwordx4 a[248:251], v2, s[8:11], s22 offen offset:2048 sc1
  buffer_load_dwordx4 a[252:255], v2, s[8:11], s22 offen offset:3072 sc1
  s_add_u32 s22, s31, 323584
  buffer_load_dwordx4 v[120:123], v2, s[8:11], s22 offen offset:0 sc1
  buffer_load_dwordx4 v[124:127], v2, s[8:11], s22 offen offset:1024 sc1
  buffer_load_dwordx4 v[128:131], v2, s[8:11], s22 offen offset:2048 sc1
  buffer_load_dwordx4 v[132:135], v2, s[8:11], s22 offen offset:3072 sc1
  s_add_u32 s22, s31, 327680
  buffer_load_dwordx4 v[136:139], v2, s[8:11], s22 offen offset:0 sc1
  buffer_load_dwordx4 v[140:143], v2, s[8:11], s22 offen offset:1024 sc1
  buffer_load_dwordx4 v[144:147], v2, s[8:11], s22 offen offset:2048 sc1
  buffer_load_dwordx4 v[148:151], v2, s[8:11], s22 offen offset:3072 sc1
  s_add_u32 s22, s31, 331776
  buffer_load_dwordx4 v[152:155], v2, s[8:11], s22 offen offset:0 sc1
  buffer_load_dwordx4 v[156:159], v2, s[8:11], s22 offen offset:1024 sc1
  buffer_load_dwordx4 v[160:163], v2, s[8:11], s22 offen offset:2048 sc1
  buffer_load_dwordx4 v[164:167], v2, s[8:11], s22 offen offset:3072 sc1
  s_add_u32 s22, s31, 335872
  buffer_load_dwordx4 v[168:171], v2, s[8:11], s22 offen offset:0 sc1
  buffer_load_dwordx4 v[172:175], v2, s[8:11], s22 offen offset:1024 sc1
  buffer_load_dwordx4 v[176:179], v2, s[8:11], s22 offen offset:2048 sc1
  buffer_load_dwordx4 v[180:183], v2, s[8:11], s22 offen offset:3072 sc1
  s_mov_b32 s24, 661504
  s_mov_b32 s26, 675840
  v_and_b32 v64, 7, v117
  v_and_b32 v65, 1, v116
  v_lshlrev_b32 v65, 2, v65
  v_sub_u32 v64, v64, v65
  v_lshrrev_b32 v65, 3, v117
  v_lshl_add_u32 v66, v65, 2, v64
  v_cmp_gt_u32 vcc, 4, v64
  v_mov_b32 v67, 99
  s_nop 0
  v_cndmask_b32 v66, v67, v66, vcc
  v_mov_b32 v68, 0x3f80
  v_mov_b32 v69, 0x3f800000
  v_mov_b32 v4, 0
  v_cmp_eq_u32 vcc, 0, v66
  s_nop 1
  v_cndmask_b32 v4, v4, v68, vcc
  v_cmp_eq_u32 vcc, 1, v66
  s_nop 1
  v_cndmask_b32 v4, v4, v69, vcc
  v_mov_b32 v5, 0
  v_cmp_eq_u32 vcc, 2, v66
  s_nop 1
  v_cndmask_b32 v5, v5, v68, vcc
  v_cmp_eq_u32 vcc, 3, v66
  s_nop 1
  v_cndmask_b32 v5, v5, v69, vcc
  v_mov_b32 v6, 0
  v_cmp_eq_u32 vcc, 4, v66
  s_nop 1
  v_cndmask_b32 v6, v6, v68, vcc
  v_cmp_eq_u32 vcc, 5, v66
  s_nop 1
  v_cndmask_b32 v6, v6, v69, vcc
  v_mov_b32 v7, 0
  v_cmp_eq_u32 vcc, 6, v66
  s_nop 1
  v_cndmask_b32 v7, v7, v68, vcc
  v_cmp_eq_u32 vcc, 7, v66
  s_nop 1
  v_cndmask_b32 v7, v7, v69, vcc
  v_lshrrev_b32 v64, 1, v116
  v_lshrrev_b32 v65, 3, v117
  v_and_b32 v66, 1, v116
  v_and_b32 v68, 7, v117
  v_lshlrev_b32 v67, 8, v65
  v_lshl_add_u32 v67, v68, 5, v67
  v_lshl_add_u32 v67, v66, 4, v67
  v_add_u32 v69, 5696, v67
  v_add_u32 v70, 6400, v67
  v_cmp_eq_u32 vcc, v64, v65
  s_nop 1
  v_cndmask_b32 v113, v70, v69, vcc
  v_and_b32 v0, 15, v1
  s_and_b32 s22, s17, 0
  s_lshl_b32 s22, s22, 7
  s_add_u32 s22, s22, 37376
  v_lshl_add_u32 v0, v0, 2, s22
  v_xor_b32 v69, 256, v2
  v_mul_i32_i24 v70, 2048, v66
  v_add_u32 v69, v69, v70
  v_add_u32 v117, 4096, v69
  v_mov_b32 v116, v73
  s_mul_i32 s35, s17, 28672
  s_add_u32 s33, s35, 2949120
  s_mov_b32 s34, 0
  s_add_u32 s35, s35, 4325376
  v_mov_b32 v36, 0
  v_mov_b32 v37, 0
  v_mov_b32 v38, 0
  v_mov_b32 v39, 0
  v_mov_b32 v40, 0
  v_mov_b32 v41, 0
  v_mov_b32 v42, 0
  v_mov_b32 v43, 0
  v_mov_b32 v44, 0
  v_mov_b32 v45, 0
  v_mov_b32 v46, 0
  v_mov_b32 v47, 0
  v_mov_b32 v48, 0
  v_mov_b32 v49, 0
  v_mov_b32 v50, 0
  v_mov_b32 v51, 0
  v_mov_b32 v52, 0
  v_mov_b32 v53, 0
  v_mov_b32 v54, 0
  v_mov_b32 v55, 0
  v_mov_b32 v56, 0
  v_mov_b32 v57, 0
  v_mov_b32 v58, 0
  v_mov_b32 v59, 0
  v_mov_b32 v60, 0
  v_mov_b32 v61, 0
  v_mov_b32 v62, 0
  v_mov_b32 v63, 0
  v_mov_b32 v64, 0
  v_mov_b32 v65, 0
  v_mov_b32 v66, 0
  v_mov_b32 v67, 0
  v_mov_b32 v68, 0
  v_mov_b32 v69, 0
  v_mov_b32 v70, 0
  v_mov_b32 v71, 0
  v_mov_b32 v72, 0
  v_mov_b32 v73, 0
  v_mov_b32 v74, 0
  v_mov_b32 v75, 0
  v_mov_b32 v76, 0
  v_mov_b32 v77, 0
  v_mov_b32 v78, 0
  v_mov_b32 v79, 0
  s_mov_b32 s22, 0
  v_lshrrev_b32 v14, 4, v2
  v_add_u32 v14, 192, v14
  v_min_u32 v14, 308, v14
  v_lshlrev_b32 v14, 7, v14
  buffer_load_dword v15, v14, s[8:11], s22 offen sc1
  buffer_load_dwordx4 v[80:83], v117, s[8:11], s24 offen offset:0 sc1
  buffer_load_dwordx4 v[84:87], v117, s[8:11], s24 offen offset:1024 sc1
  buffer_load_dwordx4 v[88:91], v117, s[8:11], s26 offen offset:0 sc1
  buffer_load_dwordx4 v[92:95], v117, s[8:11], s26 offen offset:1024 sc1
  buffer_load_dwordx4 v[96:99], v2, s[8:11], s24 offen offset:0 sc1
  buffer_load_dwordx4 v[100:103], v2, s[8:11], s24 offen offset:1024 sc1
  buffer_load_dwordx4 v[104:107], v2, s[8:11], s26 offen offset:0 sc1
  buffer_load_dwordx4 v[108:111], v2, s[8:11], s26 offen offset:1024 sc1
  s_add_u32 s22, s31, 339968
  buffer_load_dwordx4 v[184:187], v2, s[8:11], s22 offen offset:0 sc1
  buffer_load_dwordx4 v[188:191], v2, s[8:11], s22 offen offset:1024 sc1
  buffer_load_dwordx4 v[192:195], v2, s[8:11], s22 offen offset:2048 sc1
  buffer_load_dwordx4 v[196:199], v2, s[8:11], s22 offen offset:3072 sc1
  s_add_u32 s22, s31, 356352
  buffer_load_dwordx4 v[200:203], v2, s[8:11], s22 offen offset:2048 sc1
  buffer_load_dwordx4 v[204:207], v2, s[8:11], s22 offen offset:3072 sc1
  s_add_u32 s22, s31, 360448
  buffer_load_dwordx4 v[208:211], v2, s[8:11], s22 offen offset:0 sc1
  buffer_load_dwordx4 v[212:215], v2, s[8:11], s22 offen offset:1024 sc1
  buffer_load_dwordx4 v[216:219], v2, s[8:11], s22 offen offset:2048 sc1
  buffer_load_dwordx4 v[220:223], v2, s[8:11], s22 offen offset:3072 sc1
  s_add_u32 s22, s31, 364544
  buffer_load_dwordx4 v[224:227], v2, s[8:11], s22 offen offset:0 sc1
  buffer_load_dwordx4 v[228:231], v2, s[8:11], s22 offen offset:1024 sc1
  buffer_load_dwordx4 v[232:235], v2, s[8:11], s22 offen offset:2048 sc1
  buffer_load_dwordx4 v[236:239], v2, s[8:11], s22 offen offset:3072 sc1
  s_add_u32 s22, s31, 368640
  buffer_load_dwordx4 v[240:243], v2, s[8:11], s22 offen offset:0 sc1
  buffer_load_dwordx4 v[244:247], v2, s[8:11], s22 offen offset:1024 sc1
  buffer_load_dwordx4 v[248:251], v2, s[8:11], s22 offen offset:2048 sc1
  buffer_load_dwordx4 v[252:255], v2, s[8:11], s22 offen offset:3072 sc1
  s_waitcnt vmcnt(0) lgkmcnt(0)
  s_mov_b32 s31, 0
  s_cmp_lg_u32 s88, 0
  s_cbranch_scc1 cB_sc3_loop
  s_branch cA_sc3_loop
ch_init4:
  v_mov_b32 v72, v116
  v_mov_b32 v73, v117
  v_lshrrev_b32 v65, 1, v72
  v_and_b32 v66, 1, v72
  v_mov_b32 v36, 0
  v_mov_b32 v37, 0
  v_mov_b32 v38, 0
  v_mov_b32 v39, 0
  v_mov_b32 v40, 0
  v_mov_b32 v41, 0
  v_mov_b32 v42, 0
  v_mov_b32 v43, 0
  v_mov_b32 v44, 0
  v_mov_b32 v45, 0
  v_mov_b32 v46, 0
  v_mov_b32 v47, 0
  v_mov_b32 v48, 0
  v_mov_b32 v49, 0
  v_mov_b32 v50, 0
  v_mov_b32 v51, 0
  v_mov_b32 v52, 0
  v_mov_b32 v53, 0
  v_mov_b32 v54, 0
  v_mov_b32 v55, 0
  v_mov_b32 v56, 0
  v_mov_b32 v57, 0
  v_mov_b32 v58, 0
  v_mov_b32 v59, 0
  v_mov_b32 v60, 0
  v_mov_b32 v61, 0
  v_mov_b32 v62, 0
  v_mov_b32 v63, 0
  v_lshlrev_b32 v75, 2, v65
  v_lshl_add_u32 v75, v66, 3, v75
  v_add_u32 v67, 0, v73
  v_mul_u32_u24 v68, 2341, v67
  v_lshrrev_b32 v68, 16, v68
  v_mul_u32_u24 v69, 28, v68
  v_sub_u32 v69, v67, v69
  v_lshrrev_b32 v70, 4, v69
  v_and_b32 v69, 15, v69
  v_lshlrev_b32 v71, 12, v70
  v_lshl_add_u32 v71, v68, 8, v71
  v_lshl_add_u32 v71, v69, 4, v71
  v_add_u32 v152, v71, v75
  v_add_u32 v67, 16, v73
  v_mul_u32_u24 v68, 2341, v67
  v_lshrrev_b32 v68, 16, v68
  v_mul_u32_u24 v69, 28, v68
  v_sub_u32 v69, v67, v69
  v_lshrrev_b32 v70, 4, v69
  v_and_b32 v69, 15, v69
  v_lshlrev_b32 v71, 12, v70
  v_lshl_add_u32 v71, v68, 8, v71
  v_lshl_add_u32 v71, v69, 4, v71
  v_add_u32 v153, v71, v75
  v_add_u32 v67, 32, v73
  v_mul_u32_u24 v68, 2341, v67
  v_lshrrev_b32 v68, 16, v68
  v_mul_u32_u24 v69, 28, v68
  v_sub_u32 v69, v67, v69
  v_lshrrev_b32 v70, 4, v69
  v_and_b32 v69, 15, v69
  v_lshlrev_b32 v71, 12, v70
  v_lshl_add_u32 v71, v68, 8, v71
  v_lshl_add_u32 v71, v69, 4, v71
  v_add_u32 v154, v71, v75
  v_add_u32 v67, 48, v73
  v_mul_u32_u24 v68, 2341, v67
  v_lshrrev_b32 v68, 16, v68
  v_mul_u32_u24 v69, 28, v68
  v_sub_u32 v69, v67, v69
  v_lshrrev_b32 v70, 4, v69
  v_and_b32 v69, 15, v69
  v_lshlrev_b32 v71, 12, v70
  v_lshl_add_u32 v71, v68, 8, v71
  v_lshl_add_u32 v71, v69, 4, v71
  v_add_u32 v155, v71, v75
  v_add_u32 v67, 64, v73
  v_mul_u32_u24 v68, 2341, v67
  v_lshrrev_b32 v68, 16, v68
  v_mul_u32_u24 v69, 28, v68
  v_sub_u32 v69, v67, v69
  v_lshrrev_b32 v70, 4, v69
  v_and_b32 v69, 15, v69
  v_lshlrev_b32 v71, 12, v70
  v_lshl_add_u32 v71, v68, 8, v71
  v_lshl_add_u32 v71, v69, 4, v71
  v_add_u32 v156, v71, v75
  v_add_u32 v67, 80, v73
  v_mul_u32_u24 v68, 2341, v67
  v_lshrrev_b32 v68, 16, v68
  v_mul_u32_u24 v69, 28, v68
  v_sub_u32 v69, v67, v69
  v_lshrrev_b32 v70, 4, v69
  v_and_b32 v69, 15, v69
  v_lshlrev_b32 v71, 12, v70
  v_lshl_add_u32 v71, v68, 8, v71
  v_lshl_add_u32 v71, v69, 4, v71
  v_add_u32 v157, v71, v75
  v_mov_b32 v74, 0x40000000
  v_mov_b32 v164, 0
  v_mov_b32 v76, 0
  v_mov_b32 v77, 0
  v_mov_b32 v78, 0
  v_mov_b32 v79, 0
  ds_write_b128 v2, v[76:79] offset:0
  ds_write_b128 v2, v[76:79] offset:1024
  ds_write_b128 v2, v[76:79] offset:2048
  ds_write_b128 v2, v[76:79] offset:3072
  s_and_b32 s22, s17, 0
  s_lshl_b32 s22, s22, 7
  s_add_u32 s22, s22, 35328
  v_lshl_add_u32 v4, v73, 2, s22
  v_and_b32 v64, 1, v73
  v_mov_b32 v5, 0x05040100
  v_mov_b32 v65, 0x03020706
  v_cmp_eq_u32 vcc, 1, v64
  s_nop 1
  v_cndmask_b32 v5, v5, v65, vcc
  s_lshl_b32 s22, s17, 2
  s_add_u32 s22, s22, 37376
  v_lshl_add_u32 v7, v1, 7, s22
  v_cmp_gt_u32 vcc, 1, v1
  s_nop 1
  v_cndmask_b32 v7, v74, v7, vcc
  v_mov_b32 v6, v2
  v_lshl_add_u32 v64, v66, 2, v64
  v_and_b32 v65, 2, v72
  v_add_u32 v64, v64, v65
  s_mul_i32 s22, s17, 16
  v_add_u32 v75, s22, v73
  v_lshrrev_b32 v68, 4, v75
  v_lshlrev_b32 v68, 8, v68
  v_bfe_u32 v69, v75, 1, 1
  v_lshl_add_u32 v68, v69, 7, v68
  v_lshl_add_u32 v68, v64, 4, v68
  v_and_b32 v69, 12, v75
  v_add_u32 v1, v68, v69
  s_mul_i32 s22, s17, 28672
  s_add_u32 s25, s22, 2490368
  s_and_b32 s27, s17, 3
  s_xor_b32 s22, s27, 0
  s_mul_i32 s80, s22, 7168
  s_lshl_b32 s22, s22, 11
  s_add_u32 s76, s22, 9216
  s_xor_b32 s22, s27, 1
  s_mul_i32 s81, s22, 7168
  s_lshl_b32 s22, s22, 11
  s_add_u32 s77, s22, 9216
  s_xor_b32 s22, s27, 2
  s_mul_i32 s82, s22, 7168
  s_lshl_b32 s22, s22, 11
  s_add_u32 s78, s22, 9216
  s_xor_b32 s22, s27, 3
  s_mul_i32 s83, s22, 7168
  s_lshl_b32 s22, s22, 11
  s_add_u32 s79, s22, 9216
  v_mov_b32 v162, -1
  s_mov_b32 s38, 0x40000000
  s_mul_i32 s31, s17, 401408
  s_add_u32 s31, s31, 39976960
  s_mov_b32 s30, 0
ch_wr4:
  buffer_load_dword v9, off, s[12:15], 0 offset:128 sc1
  s_waitcnt vmcnt(0)
  v_cmp_ne_u32 vcc, 1, v9
  s_cbranch_vccz ch_wr4_ok
  s_sleep 8
  s_add_u32 s30, s30, 1
  s_cmp_lt_u32 s30, 400000
  s_cbranch_scc1 ch_wr4
  s_branch cA_abort
ch_wr4_ok:
  s_lshr_b32 s22, s17, 2
  s_lshl_b32 s28, 0x81, s22
  s_mul_i32 s27, s17, 12
  s_add_u32 s22, s27, 256
  s_lshr_b32 s22, s22, 6
  s_lshl_b32 s22, 0x81, s22
  s_or_b32 s28, s28, s22
  s_add_u32 s22, s27, 267
  s_lshr_b32 s22, s22, 6
  s_lshl_b32 s22, 0x81, s22
  s_or_b32 s28, s28, s22
  v_lshrrev_b32 v12, 8, v2
  v_lshlrev_b32 v12, 7, v12
  s_mov_b32 s27, 582144
  s_mov_b32 s30, 0
ch_ww4:
  buffer_load_dword v9, v12, s[8:11], s27 offen sc1
  s_waitcnt vmcnt(0)
  v_and_b32 v10, s28, v9
  v_cmp_ne_u32 vcc, s28, v10
  s_cbranch_vccz ch_ww4_ok
  s_sleep 3
  s_add_u32 s30, s30, 1
  s_cmp_lt_u32 s30, 400000
  s_cbranch_scc1 ch_ww4
  s_branch cA_abort
ch_ww4_ok:
  s_add_u32 s22, s31, 0
  buffer_load_dwordx4 a[0:3], v2, s[8:11], s22 offen offset:0 sc1
  buffer_load_dwordx4 a[4:7], v2, s[8:11], s22 offen offset:1024 sc1
  buffer_load_dwordx4 a[8:11], v2, s[8:11], s22 offen offset:2048 sc1
  buffer_load_dwordx4 a[12:15], v2, s[8:11], s22 offen offset:3072 sc1
  s_add_u32 s22, s31, 4096
  buffer_load_dwordx4 a[16:19], v2, s[8:11], s22 offen offset:0 sc1
  buffer_load_dwordx4 a[20:23], v2, s[8:11], s22 offen offset:1024 sc1
  buffer_load_dwordx4 a[24:27], v2, s[8:11], s22 offen offset:2048 sc1
  buffer_load_dwordx4 a[28:31], v2, s[8:11], s22 offen offset:3072 sc1
  s_add_u32 s22, s31, 8192
  buffer_load_dwordx4 a[32:35], v2, s[8:11], s22 offen offset:0 sc1
  buffer_load_dwordx4 a[36:39], v2, s[8:11], s22 offen offset:1024 sc1
  buffer_load_dwordx4 a[40:43], v2, s[8:11], s22 offen offset:2048 sc1
  buffer_load_dwordx4 a[44:47], v2, s[8:11], s22 offen offset:3072 sc1
  s_add_u32 s22, s31, 12288
  buffer_load_dwordx4 a[48:51], v2, s[8:11], s22 offen offset:0 sc1
  buffer_load_dwordx4 a[52:55], v2, s[8:11], s22 offen offset:1024 sc1
  buffer_load_dwordx4 a[56:59], v2, s[8:11], s22 offen offset:2048 sc1
  buffer_load_dwordx4 a[60:63], v2, s[8:11], s22 offen offset:3072 sc1
  s_add_u32 s22, s31, 16384
  buffer_load_dwordx4 a[64:67], v2, s[8:11], s22 offen offset:0 sc1
  buffer_load_dwordx4 a[68:71], v2, s[8:11], s22 offen offset:1024 sc1
  buffer_load_dwordx4 a[72:75], v2, s[8:11], s22 offen offset:2048 sc1
  buffer_load_dwordx4 a[76:79], v2, s[8:11], s22 offen offset:3072 sc1
  s_add_u32 s22, s31, 20480
  buffer_load_dwordx4 a[80:83], v2, s[8:11], s22 offen offset:0 sc1
  buffer_load_dwordx4 a[84:87], v2, s[8:11], s22 offen offset:1024 sc1
  buffer_load_dwordx4 a[88:91], v2, s[8:11], s22 offen offset:2048 sc1
  buffer_load_dwordx4 a[92:95], v2, s[8:11], s22 offen offset:3072 sc1
  s_add_u32 s22, s31, 24576
  buffer_load_dwordx4 a[96:99], v2, s[8:11], s22 offen offset:0 sc1
  buffer_load_dwordx4 a[100:103], v2, s[8:11], s22 offen offset:1024 sc1
  buffer_load_dwordx4 a[104:107], v2, s[8:11], s22 offen offset:2048 sc1
  buffer_load_dwordx4 a[108:111], v2, s[8:11], s22 offen offset:3072 sc1
  s_add_u32 s22, s31, 28672
  buffer_load_dwordx4 a[112:115], v2, s[8:11], s22 offen offset:0 sc1
  buffer_load_dwordx4 a[116:119], v2, s[8:11], s22 offen offset:1024 sc1
  buffer_load_dwordx4 a[120:123], v2, s[8:11], s22 offen offset:2048 sc1
  buffer_load_dwordx4 a[124:127], v2, s[8:11], s22 offen offset:3072 sc1
  s_waitcnt vmcnt(24)
  s_add_u32 s22, s31, 32768
  buffer_load_dwordx4 a[128:131], v2, s[8:11], s22 offen offset:0 sc1
  buffer_load_dwordx4 a[132:135], v2, s[8:11], s22 offen offset:1024 sc1
  buffer_load_dwordx4 a[136:139], v2, s[8:11], s22 offen offset:2048 sc1
  buffer_load_dwordx4 a[140:143], v2, s[8:11], s22 offen offset:3072 sc1
  s_add_u32 s22, s31, 36864
  buffer_load_dwordx4 a[144:147], v2, s[8:11], s22 offen offset:0 sc1
  buffer_load_dwordx4 a[148:151], v2, s[8:11], s22 offen offset:1024 sc1
  buffer_load_dwordx4 a[152:155], v2, s[8:11], s22 offen offset:2048 sc1
  buffer_load_dwordx4 a[156:159], v2, s[8:11], s22 offen offset:3072 sc1
  s_add_u32 s22, s31, 40960
  buffer_load_dwordx4 a[160:163], v2, s[8:11], s22 offen offset:0 sc1
  buffer_load_dwordx4 a[164:167], v2, s[8:11], s22 offen offset:1024 sc1
  buffer_load_dwordx4 a[168:171], v2, s[8:11], s22 offen offset:2048 sc1
  buffer_load_dwordx4 a[172:175], v2, s[8:11], s22 offen offset:3072 sc1
  s_add_u32 s22, s31, 45056
  buffer_load_dwordx4 a[176:179], v2, s[8:11], s22 offen offset:0 sc1
  buffer_load_dwordx4 a[180:183], v2, s[8:11], s22 offen offset:1024 sc1
  buffer_load_dwordx4 a[184:187], v2, s[8:11], s22 offen offset:2048 sc1
  buffer_load_dwordx4 a[188:191], v2, s[8:11], s22 offen offset:3072 sc1
  s_add_u32 s22, s31, 49152
  buffer_load_dwordx4 a[192:195], v2, s[8:11], s22 offen offset:0 sc1
  buffer_load_dwordx4 a[196:199], v2, s[8:11], s22 offen offset:1024 sc1
  buffer_load_dwordx4 a[200:203], v2, s[8:11], s22 offen offset:2048 sc1
  buffer_load_dwordx4 a[204:207], v2, s[8:11], s22 offen offset:3072 sc1
  s_add_u32 s22, s31, 53248
  buffer_load_dwordx4 a[208:211], v2, s[8:11], s22 offen offset:0 sc1
  buffer_load_dwordx4 a[212:215], v2, s[8:11], s22 offen offset:1024 sc1
  buffer_load_dwordx4 a[216:219], v2, s[8:11], s22 offen offset:2048 sc1
  buffer_load_dwordx4 a[220:223], v2, s[8:11], s22 offen offset:3072 sc1
  s_add_u32 s22, s31, 57344
  buffer_load_dwordx4 a[224:227], v2, s[8:11], s22 offen offset:0 sc1
  buffer_load_dwordx4 a[228:231], v2, s[8:11], s22 offen offset:1024 sc1
  buffer_load_dwordx4 a[232:235], v2, s[8:11], s22 offen offset:2048 sc1
  buffer_load_dwordx4 a[236:239], v2, s[8:11], s22 offen offset:3072 sc1
  s_add_u32 s22, s31, 61440
  buffer_load_dwordx4 a[240:243], v2, s[8:11], s22 offen offset:0 sc1
  buffer_load_dwordx4 a[244:247], v2, s[8:11], s22 offen offset:1024 sc1
  buffer_load_dwordx4 a[248:251], v2, s[8:11], s22 offen offset:2048 sc1
  buffer_load_dwordx4 a[252:255], v2, s[8:11], s22 offen offset:3072 sc1
  s_waitcnt vmcnt(24)
  s_add_u32 s22, s31, 65536
  buffer_load_dwordx4 v[176:179], v2, s[8:11], s22 offen offset:0 sc1
  buffer_load_dwordx4 v[180:183], v2, s[8:11], s22 offen offset:1024 sc1
  buffer_load_dwordx4 v[184:187], v2, s[8:11], s22 offen offset:2048 sc1
  buffer_load_dwordx4 v[188:191], v2, s[8:11], s22 offen offset:3072 sc1
  s_add_u32 s22, s31, 69632
  buffer_load_dwordx4 v[192:195], v2, s[8:11], s22 offen offset:0 sc1
  buffer_load_dwordx4 v[196:199], v2, s[8:11], s22 offen offset:1024 sc1
  buffer_load_dwordx4 v[200:203], v2, s[8:11], s22 offen offset:2048 sc1
  buffer_load_dwordx4 v[204:207], v2, s[8:11], s22 offen offset:3072 sc1
  s_add_u32 s22, s31, 73728
  buffer_load_dwordx4 v[208:211], v2, s[8:11], s22 offen offset:0 sc1
  buffer_load_dwordx4 v[212:215], v2, s[8:11], s22 offen offset:1024 sc1
  buffer_load_dwordx4 v[216:219], v2, s[8:11], s22 offen offset:2048 sc1
  buffer_load_dwordx4 v[220:223], v2, s[8:11], s22 offen offset:3072 sc1
  s_add_u32 s22, s31, 77824
  buffer_load_dwordx4 v[224:227], v2, s[8:11], s22 offen offset:0 sc1
  buffer_load_dwordx4 v[228:231], v2, s[8:11], s22 offen offset:1024 sc1
  buffer_load_dwordx4 v[232:235], v2, s[8:11], s22 offen offset:2048 sc1
  buffer_load_dwordx4 v[236:239], v2, s[8:11], s22 offen offset:3072 sc1
  s_add_u32 s22, s31, 81920
  buffer_load_dwordx4 v[240:243], v2, s[8:11], s22 offen offset:0 sc1
  buffer_load_dwordx4 v[244:247], v2, s[8:11], s22 offen offset:1024 sc1
  buffer_load_dwordx4 v[248:251], v2, s[8:11], s22 offen offset:2048 sc1
  buffer_load_dwordx4 v[252:255], v2, s[8:11], s22 offen offset:3072 sc1
  s_mov_b32 m0, 16384
  s_add_u32 s22, s31, 86016
  buffer_load_dwordx4 v2, s[8:11], s22 offen offset:0 sc1 lds
  buffer_load_dwordx4 v2, s[8:11], s22 offen offset:1024 sc1 lds
  buffer_load_dwordx4 v2, s[8:11], s22 offen offset:2048 sc1 lds
  buffer_load_dwordx4 v2, s[8:11], s22 offen offset:3072 sc1 lds
  s_mov_b32 m0, 20480
  s_add_u32 s22, s31, 90112
  buffer_load_dwordx4 v2, s[8:11], s22 offen offset:0 sc1 lds
  buffer_load_dwordx4 v2, s[8:11], s22 offen offset:1024 sc1 lds
  buffer_load_dwordx4 v2, s[8:11], s22 offen offset:2048 sc1 lds
  buffer_load_dwordx4 v2, s[8:11], s22 offen offset:3072 sc1 lds
  s_mov_b32 m0, 24576
  s_add_u32 s22, s31, 94208
  buffer_load_dwordx4 v2, s[8:11], s22 offen offset:0 sc1 lds
  buffer_load_dwordx4 v2, s[8:11], s22 offen offset:1024 sc1 lds
  buffer_load_dwordx4 v2, s[8:11], s22 offen offset:2048 sc1 lds
  buffer_load_dwordx4 v2, s[8:11], s22 offen offset:3072 sc1 lds
  s_mov_b32 m0, 28672
  s_add_u32 s22, s31, 98304
  buffer_load_dwordx4 v2, s[8:11], s22 offen offset:0 sc1 lds
  buffer_load_dwordx4 v2, s[8:11], s22 offen offset:1024 sc1 lds
  s_mov_b32 s30, 0
ch_ws4:
  buffer_load_dword v9, off, s[12:15], 0 offset:132 sc1
  s_waitcnt vmcnt(0)
  v_cmp_ne_u32 vcc, 1, v9
  s_cbranch_vccz ch_ws4_ok
  s_sleep 8
  s_add_u32 s30, s30, 1
  s_cmp_lt_u32 s30, 400000
  s_cbranch_scc1 ch_ws4
  s_branch cA_abort
ch_ws4_ok:
  s_mul_i32 s33, s17, 532480
  s_add_u32 s33, s33, 78110720
  v_mov_b32 v12, -1
  v_mov_b32 v13, -1
  v_mov_b32 v14, -1
  v_mov_b32 v15, -1
  s_add_u32 s22, s33, 0
  buffer_store_dwordx4 v[12:15], v2, s[8:11], s22 offen sc1
  s_add_u32 s22, s33, 2048
  buffer_store_dwordx4 v[12:15], v2, s[8:11], s22 offen sc1
  s_add_u32 s22, s33, 4096
  buffer_store_dwordx4 v[12:15], v2, s[8:11], s22 offen sc1
  s_add_u32 s22, s33, 6144
  buffer_store_dwordx4 v[12:15], v2, s[8:11], s22 offen sc1
  s_add_u32 s22, s33, 8192
  buffer_store_dwordx4 v[12:15], v2, s[8:11], s22 offen sc1
  s_add_u32 s22, s33, 10240
  buffer_store_dwordx4 v[12:15], v2, s[8:11], s22 offen sc1
  s_add_u32 s22, s33, 12288
  buffer_store_dwordx4 v[12:15], v2, s[8:11], s22 offen sc1
  s_add_u32 s22, s33, 14336
  buffer_store_dwordx4 v[12:15], v2, s[8:11], s22 offen sc1
  v_mov_b32 v16, 1
  v_mov_b32 v17, 1
  s_lshl_b32 s22, s17, 10
  s_add_u32 s22, s22, 566240
  s_waitcnt vmcnt(0)
  s_mov_b64 exec, 3
  buffer_store_dwordx2 v[16:17], v2, s[8:11], s22 offen sc1
  s_mov_b64 exec, -1
  s_mov_b32 s28, s35
  s_waitcnt vmcnt(0) lgkmcnt(0)
  s_mov_b32 s31, 0
  s_cmp_lg_u32 s88, 0
  s_cbranch_scc1 cB_va0_loop
  s_branch cA_va0_loop
ch_init5:
  v_mov_b32 v72, v116
  v_mov_b32 v73, v117
  v_lshrrev_b32 v65, 1, v72
  v_and_b32 v66, 1, v72
  v_mov_b32 v36, 0
  v_mov_b32 v37, 0
  v_mov_b32 v38, 0
  v_mov_b32 v39, 0
  v_mov_b32 v40, 0
  v_mov_b32 v41, 0
  v_mov_b32 v42, 0
  v_mov_b32 v43, 0
  v_mov_b32 v44, 0
  v_mov_b32 v45, 0
  v_mov_b32 v46, 0
  v_mov_b32 v47, 0
  v_mov_b32 v48, 0
  v_mov_b32 v49, 0
  v_mov_b32 v50, 0
  v_mov_b32 v51, 0
  v_mov_b32 v52, 0
  v_mov_b32 v53, 0
  v_mov_b32 v54, 0
  v_mov_b32 v55, 0
  v_mov_b32 v56, 0
  v_mov_b32 v57, 0
  v_mov_b32 v58, 0
  v_mov_b32 v59, 0
  v_mov_b32 v60, 0
  v_mov_b32 v61, 0
  v_mov_b32 v62, 0
  v_mov_b32 v63, 0
  v_lshlrev_b32 v75, 2, v65
  v_lshl_add_u32 v75, v66, 3, v75
  v_add_u32 v67, 112, v73
  v_mul_u32_u24 v68, 2341, v67
  v_lshrrev_b32 v68, 16, v68
  v_mul_u32_u24 v69, 28, v68
  v_sub_u32 v69, v67, v69
  v_lshrrev_b32 v70, 4, v69
  v_and_b32 v69, 15, v69
  v_lshlrev_b32 v71, 12, v70
  v_lshl_add_u32 v71, v68, 8, v71
  v_lshl_add_u32 v71, v69, 4, v71
  v_add_u32 v152, v71, v75
  v_add_u32 v67, 128, v73
  v_mul_u32_u24 v68, 2341, v67
  v_lshrrev_b32 v68, 16, v68
  v_mul_u32_u24 v69, 28, v68
  v_sub_u32 v69, v67, v69
  v_lshrrev_b32 v70, 4, v69
  v_and_b32 v69, 15, v69
  v_lshlrev_b32 v71, 12, v70
  v_lshl_add_u32 v71, v68, 8, v71
  v_lshl_add_u32 v71, v69, 4, v71
  v_add_u32 v153, v71, v75
  v_add_u32 v67, 144, v73
  v_mul_u32_u24 v68, 2341, v67
  v_lshrrev_b32 v68, 16, v68
  v_mul_u32_u24 v69, 28, v68
  v_sub_u32 v69, v67, v69
  v_lshrrev_b32 v70, 4, v69
  v_and_b32 v69, 15, v69
  v_lshlrev_b32 v71, 12, v70
  v_lshl_add_u32 v71, v68, 8, v71
  v_lshl_add_u32 v71, v69, 4, v71
  v_add_u32 v154, v71, v75
  v_add_u32 v67, 160, v73
  v_mul_u32_u24 v68, 2341, v67
  v_lshrrev_b32 v68, 16, v68
  v_mul_u32_u24 v69, 28, v68
  v_sub_u32 v69, v67, v69
  v_lshrrev_b32 v70, 4, v69
  v_and_b32 v69, 15, v69
  v_lshlrev_b32 v71, 12, v70
  v_lshl_add_u32 v71, v68, 8, v71
  v_lshl_add_u32 v71, v69, 4, v71
  v_add_u32 v155, v71, v75
  v_add_u32 v67, 176, v73
  v_mul_u32_u24 v68, 2341, v67
  v_lshrrev_b32 v68, 16, v68
  v_mul_u32_u24 v69, 28, v68
  v_sub_u32 v69, v67, v69
  v_lshrrev_b32 v70, 4, v69
  v_and_b32 v69, 15, v69
  v_lshlrev_b32 v71, 12, v70
  v_lshl_add_u32 v71, v68, 8, v71
  v_lshl_add_u32 v71, v69, 4, v71
  v_add_u32 v156, v71, v75
  v_add_u32 v67, 192, v73
  v_mul_u32_u24 v68, 2341, v67
  v_lshrrev_b32 v68, 16, v68
  v_mul_u32_u24 v69, 28, v68
  v_sub_u32 v69, v67, v69
  v_lshrrev_b32 v70, 4, v69
  v_and_b32 v69, 15, v69
  v_lshlrev_b32 v71, 12, v70
  v_lshl_add_u32 v71, v68, 8, v71
  v_lshl_add_u32 v71, v69, 4, v71
  v_add_u32 v157, v71, v75
  v_add_u32 v67, 208, v73
  v_mul_u32_u24 v68, 2341, v67
  v_lshrrev_b32 v68, 16, v68
  v_mul_u32_u24 v69, 28, v68
  v_sub_u32 v69, v67, v69
  v_lshrrev_b32 v70, 4, v69
  v_and_b32 v69, 15, v69
  v_lshlrev_b32 v71, 12, v70
  v_lshl_add_u32 v71, v68, 8, v71
  v_lshl_add_u32 v71, v69, 4, v71
  v_add_u32 v158, v71, v75
  v_mov_b32 v74, 0x40000000
  v_mov_b32 v164, 0
  v_add_u32 v0, 30720, v2
  v_mov_b32 v76, 0
  v_mov_b32 v77, 0
  v_mov_b32 v78, 0
  v_mov_b32 v79, 0
  ds_write_b128 v2, v[76:79] offset:4096
  ds_write_b128 v2, v[76:79] offset:5120
  ds_write_b128 v2, v[76:79] offset:6144
  ds_write_b128 v2, v[76:79] offset:7168
  s_and_b32 s22, s17, 0
  s_lshl_b32 s22, s22, 7
  s_add_u32 s22, s22, 35328
  v_lshl_add_u32 v4, v73, 2, s22
  v_and_b32 v64, 1, v73
  v_mov_b32 v5, 0x05040100
  v_mov_b32 v65, 0x03020706
  v_cmp_eq_u32 vcc, 1, v64
  s_nop 1
  v_cndmask_b32 v5, v5, v65, vcc
  s_lshl_b32 s22, s17, 2
  s_add_u32 s22, s22, 39424
  v_lshl_add_u32 v7, v1, 7, s22
  v_cmp_gt_u32 vcc, 1, v1
  s_nop 1
  v_cndmask_b32 v7, v74, v7, vcc
  v_min_u32 v65, 11, v73
  v_mad_u32_u24 v65, v72, 12, v65
  v_lshlrev_b32 v6, 4, v65
  v_add_u32 v6, 1024, v6
  v_lshl_add_u32 v64, v66, 2, v64
  v_and_b32 v65, 2, v72
  v_add_u32 v64, v64, v65
  s_mul_i32 s22, s17, 12
  s_add_u32 s22, s22, 256
  v_add_u32 v75, s22, v73
  v_lshrrev_b32 v68, 4, v75
  v_lshlrev_b32 v68, 8, v68
  v_bfe_u32 v69, v75, 1, 1
  v_lshl_add_u32 v68, v69, 7, v68
  v_lshl_add_u32 v68, v64, 4, v68
  v_and_b32 v69, 12, v75
  v_add_u32 v1, v68, v69
  v_cmp_gt_u32 vcc, 12, v73
  s_nop 1
  v_cndmask_b32 v1, v74, v1, vcc
  s_mul_i32 s22, s17, 28672
  s_add_u32 s25, s22, 2490368
  s_and_b32 s27, s17, 3
  s_xor_b32 s22, s27, 0
  s_mul_i32 s80, s22, 7168
  s_lshl_b32 s22, s22, 11
  s_add_u32 s76, s22, 9216
  s_xor_b32 s22, s27, 1
  s_mul_i32 s81, s22, 7168
  s_lshl_b32 s22, s22, 11
  s_add_u32 s77, s22, 9216
  s_xor_b32 s22, s27, 2
  s_mul_i32 s82, s22, 7168
  s_lshl_b32 s22, s22, 11
  s_add_u32 s78, s22, 9216
  s_xor_b32 s22, s27, 3
  s_mul_i32 s83, s22, 7168
  s_lshl_b32 s22, s22, 11
  s_add_u32 s79, s22, 9216
  v_mov_b32 v162, -1
  s_mov_b32 s38, 0x40000000
  s_mul_i32 s31, s17, 401408
  s_add_u32 s31, s31, 40077312
  s_mov_b32 s30, 0
ch_wr5:
  buffer_load_dword v9, off, s[12:15], 0 offset:128 sc1
  s_waitcnt vmcnt(0)
  v_cmp_ne_u32 vcc, 1, v9
  s_cbranch_vccz ch_wr5_ok
  s_sleep 8
  s_add_u32 s30, s30, 1
  s_cmp_lt_u32 s30, 400000
  s_cbranch_scc1 ch_wr5
  s_branch cA_abort
ch_wr5_ok:
  s_lshr_b32 s22, s17, 2
  s_lshl_b32 s28, 0x81, s22
  s_mul_i32 s27, s17, 12
  s_add_u32 s22, s27, 256
  s_lshr_b32 s22, s22, 6
  s_lshl_b32 s22, 0x81, s22
  s_or_b32 s28, s28, s22
  s_add_u32 s22, s27, 267
  s_lshr_b32 s22, s22, 6
  s_lshl_b32 s22, 0x81, s22
  s_or_b32 s28, s28, s22
  v_lshrrev_b32 v12, 8, v2
  v_lshlrev_b32 v12, 7, v12
  s_mov_b32 s27, 582656
  s_mov_b32 s30, 0
ch_ww5:
  buffer_load_dword v9, v12, s[8:11], s27 offen sc1
  s_waitcnt vmcnt(0)
  v_and_b32 v10, s28, v9
  v_cmp_ne_u32 vcc, s28, v10
  s_cbranch_vccz ch_ww5_ok
  s_sleep 3
  s_add_u32 s30, s30, 1
  s_cmp_lt_u32 s30, 400000
  s_cbranch_scc1 ch_ww5
  s_branch cA_abort
ch_ww5_ok:
  s_add_u32 s22, s31, 0
  buffer_load_dwordx4 a[0:3], v2, s[8:11], s22 offen offset:0 sc1
  buffer_load_dwordx4 a[4:7], v2, s[8:11], s22 offen offset:1024 sc1
  buffer_load_dwordx4 a[8:11], v2, s[8:11], s22 offen offset:2048 sc1
  buffer_load_dwordx4 a[12:15], v2, s[8:11], s22 offen offset:3072 sc1
  s_add_u32 s22, s31, 4096
  buffer_load_dwordx4 a[16:19], v2, s[8:11], s22 offen offset:0 sc1
  buffer_load_dwordx4 a[20:23], v2, s[8:11], s22 offen offset:1024 sc1
  buffer_load_dwordx4 a[24:27], v2, s[8:11], s22 offen offset:2048 sc1
  buffer_load_dwordx4 a[28:31], v2, s[8:11], s22 offen offset:3072 sc1
  s_add_u32 s22, s31, 8192
  buffer_load_dwordx4 a[32:35], v2, s[8:11], s22 offen offset:0 sc1
  buffer_load_dwordx4 a[36:39], v2, s[8:11], s22 offen offset:1024 sc1
  buffer_load_dwordx4 a[40:43], v2, s[8:11], s22 offen offset:2048 sc1
  buffer_load_dwordx4 a[44:47], v2, s[8:11], s22 offen offset:3072 sc1
  s_add_u32 s22, s31, 12288
  buffer_load_dwordx4 a[48:51], v2, s[8:11], s22 offen offset:0 sc1
  buffer_load_dwordx4 a[52:55], v2, s[8:11], s22 offen offset:1024 sc1
  buffer_load_dwordx4 a[56:59], v2, s[8:11], s22 offen offset:2048 sc1
  buffer_load_dwordx4 a[60:63], v2, s[8:11], s22 offen offset:3072 sc1
  s_add_u32 s22, s31, 16384
  buffer_load_dwordx4 a[64:67], v2, s[8:11], s22 offen offset:0 sc1
  buffer_load_dwordx4 a[68:71], v2, s[8:11], s22 offen offset:1024 sc1
  buffer_load_dwordx4 a[72:75], v2, s[8:11], s22 offen offset:2048 sc1
  buffer_load_dwordx4 a[76:79], v2, s[8:11], s22 offen offset:3072 sc1
  s_add_u32 s22, s31, 20480
  buffer_load_dwordx4 a[80:83], v2, s[8:11], s22 offen offset:0 sc1
  buffer_load_dwordx4 a[84:87], v2, s[8:11], s22 offen offset:1024 sc1
  buffer_load_dwordx4 a[88:91], v2, s[8:11], s22 offen offset:2048 sc1
  buffer_load_dwordx4 a[92:95], v2, s[8:11], s22 offen offset:3072 sc1
  s_add_u32 s22, s31, 24576
  buffer_load_dwordx4 a[96:99], v2, s[8:11], s22 offen offset:0 sc1
  buffer_load_dwordx4 a[100:103], v2, s[8:11], s22 offen offset:1024 sc1
  buffer_load_dwordx4 a[104:107], v2, s[8:11], s22 offen offset:2048 sc1
  buffer_load_dwordx4 a[108:111], v2, s[8:11], s22 offen offset:3072 sc1
  s_add_u32 s22, s31, 28672
  buffer_load_dwordx4 a[112:115], v2, s[8:11], s22 offen offset:0 sc1
  buffer_load_dwordx4 a[116:119], v2, s[8:11], s22 offen offset:1024 sc1
  buffer_load_dwordx4 a[120:123], v2, s[8:11], s22 offen offset:2048 sc1
  buffer_load_dwordx4 a[124:127], v2, s[8:11], s22 offen offset:3072 sc1
  s_waitcnt vmcnt(24)
  s_add_u32 s22, s31, 32768
  buffer_load_dwordx4 a[128:131], v2, s[8:11], s22 offen offset:0 sc1
  buffer_load_dwordx4 a[132:135], v2, s[8:11], s22 offen offset:1024 sc1
  buffer_load_dwordx4 a[136:139], v2, s[8:11], s22 offen offset:2048 sc1
  buffer_load_dwordx4 a[140:143], v2, s[8:11], s22 offen offset:3072 sc1
  s_add_u32 s22, s31, 36864
  buffer_load_dwordx4 a[144:147], v2, s[8:11], s22 offen offset:0 sc1
  buffer_load_dwordx4 a[148:151], v2, s[8:11], s22 offen offset:1024 sc1
  buffer_load_dwordx4 a[152:155], v2, s[8:11], s22 offen offset:2048 sc1
  buffer_load_dwordx4 a[156:159], v2, s[8:11], s22 offen offset:3072 sc1
  s_add_u32 s22, s31, 40960
  buffer_load_dwordx4 a[160:163], v2, s[8:11], s22 offen offset:0 sc1
  buffer_load_dwordx4 a[164:167], v2, s[8:11], s22 offen offset:1024 sc1
  buffer_load_dwordx4 a[168:171], v2, s[8:11], s22 offen offset:2048 sc1
  buffer_load_dwordx4 a[172:175], v2, s[8:11], s22 offen offset:3072 sc1
  s_add_u32 s22, s31, 45056
  buffer_load_dwordx4 a[176:179], v2, s[8:11], s22 offen offset:0 sc1
  buffer_load_dwordx4 a[180:183], v2, s[8:11], s22 offen offset:1024 sc1
  buffer_load_dwordx4 a[184:187], v2, s[8:11], s22 offen offset:2048 sc1
  buffer_load_dwordx4 a[188:191], v2, s[8:11], s22 offen offset:3072 sc1
  s_add_u32 s22, s31, 49152
  buffer_load_dwordx4 a[192:195], v2, s[8:11], s22 offen offset:0 sc1
  buffer_load_dwordx4 a[196:199], v2, s[8:11], s22 offen offset:1024 sc1
  buffer_load_dwordx4 a[200:203], v2, s[8:11], s22 offen offset:2048 sc1
  buffer_load_dwordx4 a[204:207], v2, s[8:11], s22 offen offset:3072 sc1
  s_add_u32 s22, s31, 53248
  buffer_load_dwordx4 a[208:211], v2, s[8:11], s22 offen offset:0 sc1
  buffer_load_dwordx4 a[212:215], v2, s[8:11], s22 offen offset:1024 sc1
  buffer_load_dwordx4 a[216:219], v2, s[8:11], s22 offen offset:2048 sc1
  buffer_load_dwordx4 a[220:223], v2, s[8:11], s22 offen offset:3072 sc1
  s_add_u32 s22, s31, 57344
  buffer_load_dwordx4 a[224:227], v2, s[8:11], s22 offen offset:0 sc1
  buffer_load_dwordx4 a[228:231], v2, s[8:11], s22 offen offset:1024 sc1
  buffer_load_dwordx4 a[232:235], v2, s[8:11], s22 offen offset:2048 sc1
  buffer_load_dwordx4 a[236:239], v2, s[8:11], s22 offen offset:3072 sc1
  s_add_u32 s22, s31, 61440
  buffer_load_dwordx4 a[240:243], v2, s[8:11], s22 offen offset:0 sc1
  buffer_load_dwordx4 a[244:247], v2, s[8:11], s22 offen offset:1024 sc1
  buffer_load_dwordx4 a[248:251], v2, s[8:11], s22 offen offset:2048 sc1
  buffer_load_dwordx4 a[252:255], v2, s[8:11], s22 offen offset:3072 sc1
  s_waitcnt vmcnt(24)
  s_add_u32 s22, s31, 65536
  buffer_load_dwordx4 v[176:179], v2, s[8:11], s22 offen offset:0 sc1
  buffer_load_dwordx4 v[180:183], v2, s[8:11], s22 offen offset:1024 sc1
  buffer_load_dwordx4 v[184:187], v2, s[8:11], s22 offen offset:2048 sc1
  buffer_load_dwordx4 v[188:191], v2, s[8:11], s22 offen offset:3072 sc1
  s_add_u32 s22, s31, 69632
  buffer_load_dwordx4 v[192:195], v2, s[8:11], s22 offen offset:0 sc1
  buffer_load_dwordx4 v[196:199], v2, s[8:11], s22 offen offset:1024 sc1
  buffer_load_dwordx4 v[200:203], v2, s[8:11], s22 offen offset:2048 sc1
  buffer_load_dwordx4 v[204:207], v2, s[8:11], s22 offen offset:3072 sc1
  s_add_u32 s22, s31, 73728
  buffer_load_dwordx4 v[208:211], v2, s[8:11], s22 offen offset:0 sc1
  buffer_load_dwordx4 v[212:215], v2, s[8:11], s22 offen offset:1024 sc1
  buffer_load_dwordx4 v[216:219], v2, s[8:11], s22 offen offset:2048 sc1
  buffer_load_dwordx4 v[220:223], v2, s[8:11], s22 offen offset:3072 sc1
  s_add_u32 s22, s31, 77824
  buffer_load_dwordx4 v[224:227], v2, s[8:11], s22 offen offset:0 sc1
  buffer_load_dwordx4 v[228:231], v2, s[8:11], s22 offen offset:1024 sc1
  buffer_load_dwordx4 v[232:235], v2, s[8:11], s22 offen offset:2048 sc1
  buffer_load_dwordx4 v[236:239], v2, s[8:11], s22 offen offset:3072 sc1
  s_add_u32 s22, s31, 81920
  buffer_load_dwordx4 v[240:243], v2, s[8:11], s22 offen offset:0 sc1
  buffer_load_dwordx4 v[244:247], v2, s[8:11], s22 offen offset:1024 sc1
  buffer_load_dwordx4 v[248:251], v2, s[8:11], s22 offen offset:2048 sc1
  buffer_load_dwordx4 v[252:255], v2, s[8:11], s22 offen offset:3072 sc1
  s_mov_b32 m0, 30720
  s_add_u32 s22, s31, 86016
  buffer_load_dwordx4 v2, s[8:11], s22 offen offset:0 sc1 lds
  buffer_load_dwordx4 v2, s[8:11], s22 offen offset:1024 sc1 lds
  buffer_load_dwordx4 v2, s[8:11], s22 offen offset:2048 sc1 lds
  buffer_load_dwordx4 v2, s[8:11], s22 offen offset:3072 sc1 lds
  s_mov_b32 m0, 34816
  s_add_u32 s22, s31, 90112
  buffer_load_dwordx4 v2, s[8:11], s22 offen offset:0 sc1 lds
  buffer_load_dwordx4 v2, s[8:11], s22 offen offset:1024 sc1 lds
  buffer_load_dwordx4 v2, s[8:11], s22 offen offset:2048 sc1 lds
  buffer_load_dwordx4 v2, s[8:11], s22 offen offset:3072 sc1 lds
  s_mov_b32 m0, 38912
  s_add_u32 s22, s31, 94208
  buffer_load_dwordx4 v2, s[8:11], s22 offen offset:0 sc1 lds
  buffer_load_dwordx4 v2, s[8:11], s22 offen offset:1024 sc1 lds
  buffer_load_dwordx4 v2, s[8:11], s22 offen offset:2048 sc1 lds
  buffer_load_dwordx4 v2, s[8:11], s22 offen offset:3072 sc1 lds
  s_mov_b32 m0, 43008
  s_add_u32 s22, s31, 98304
  buffer_load_dwordx4 v2, s[8:11], s22 offen offset:0 sc1 lds
  buffer_load_dwordx4 v2, s[8:11], s22 offen offset:1024 sc1 lds
  s_mov_b32 s30, 0
ch_ws5:
  buffer_load_dword v9, off, s[12:15], 0 offset:132 sc1
  s_waitcnt vmcnt(0)
  v_cmp_ne_u32 vcc, 1, v9
  s_cbranch_vccz ch_ws5_ok
  s_sleep 8
  s_add_u32 s30, s30, 1
  s_cmp_lt_u32 s30, 400000
  s_cbranch_scc1 ch_ws5
  s_branch cA_abort
ch_ws5_ok:
  s_mul_i32 s33, s17, 532480
  s_add_u32 s33, s33, 78111744
  v_mov_b32 v12, -1
  v_mov_b32 v13, -1
  v_mov_b32 v14, -1
  v_mov_b32 v15, -1
  s_add_u32 s22, s33, 0
  buffer_store_dwordx4 v[12:15], v2, s[8:11], s22 offen sc1
  s_add_u32 s22, s33, 2048
  buffer_store_dwordx4 v[12:15], v2, s[8:11], s22 offen sc1
  s_add_u32 s22, s33, 4096
  buffer_store_dwordx4 v[12:15], v2, s[8:11], s22 offen sc1
  s_add_u32 s22, s33, 6144
  buffer_store_dwordx4 v[12:15], v2, s[8:11], s22 offen sc1
  s_add_u32 s22, s33, 8192
  buffer_store_dwordx4 v[12:15], v2, s[8:11], s22 offen sc1
  s_add_u32 s22, s33, 10240
  buffer_store_dwordx4 v[12:15], v2, s[8:11], s22 offen sc1
  s_add_u32 s22, s33, 12288
  buffer_store_dwordx4 v[12:15], v2, s[8:11], s22 offen sc1
  s_add_u32 s22, s33, 14336
  buffer_store_dwordx4 v[12:15], v2, s[8:11], s22 offen sc1
  v_mov_b32 v16, 1
  v_mov_b32 v17, 1
  s_lshl_b32 s22, s17, 10
  s_add_u32 s22, s22, 566248
  s_waitcnt vmcnt(0)
  s_mov_b64 exec, 3
  buffer_store_dwordx2 v[16:17], v2, s[8:11], s22 offen sc1
  s_mov_b64 exec, -1
  s_mov_b32 s28, s35
  s_waitcnt vmcnt(0) lgkmcnt(0)
  s_mov_b32 s31, 0
  s_cmp_lg_u32 s88, 0
  s_cbranch_scc1 cB_va1_loop
  s_branch cA_va1_loop
ch_init6:
  v_mov_b32 v72, v116
  v_mov_b32 v73, v117
  v_lshrrev_b32 v65, 1, v72
  v_and_b32 v66, 1, v72
  v_mov_b32 v36, 0
  v_mov_b32 v37, 0
  v_mov_b32 v38, 0
  v_mov_b32 v39, 0
  v_mov_b32 v40, 0
  v_mov_b32 v41, 0
  v_mov_b32 v42, 0
  v_mov_b32 v43, 0
  v_mov_b32 v44, 0
  v_mov_b32 v45, 0
  v_mov_b32 v46, 0
  v_mov_b32 v47, 0
  v_mov_b32 v48, 0
  v_mov_b32 v49, 0
  v_mov_b32 v50, 0
  v_mov_b32 v51, 0
  v_mov_b32 v52, 0
  v_mov_b32 v53, 0
  v_mov_b32 v54, 0
  v_mov_b32 v55, 0
  v_mov_b32 v56, 0
  v_mov_b32 v57, 0
  v_mov_b32 v58, 0
  v_mov_b32 v59, 0
  v_mov_b32 v60, 0
  v_mov_b32 v61, 0
  v_mov_b32 v62, 0
  v_mov_b32 v63, 0
  v_lshlrev_b32 v75, 2, v65
  v_lshl_add_u32 v75, v66, 3, v75
  v_add_u32 v67, 224, v73
  v_mul_u32_u24 v68, 2341, v67
  v_lshrrev_b32 v68, 16, v68
  v_mul_u32_u24 v69, 28, v68
  v_sub_u32 v69, v67, v69
  v_lshrrev_b32 v70, 4, v69
  v_and_b32 v69, 15, v69
  v_lshlrev_b32 v71, 12, v70
  v_lshl_add_u32 v71, v68, 8, v71
  v_lshl_add_u32 v71, v69, 4, v71
  v_add_u32 v104, v71, v75
  v_add_u32 v67, 240, v73
  v_mul_u32_u24 v68, 2341, v67
  v_lshrrev_b32 v68, 16, v68
  v_mul_u32_u24 v69, 28, v68
  v_sub_u32 v69, v67, v69
  v_lshrrev_b32 v70, 4, v69
  v_and_b32 v69, 15, v69
  v_lshlrev_b32 v71, 12, v70
  v_lshl_add_u32 v71, v68, 8, v71
  v_lshl_add_u32 v71, v69, 4, v71
  v_add_u32 v105, v71, v75
  v_add_u32 v67, 256, v73
  v_mul_u32_u24 v68, 2341, v67
  v_lshrrev_b32 v68, 16, v68
  v_mul_u32_u24 v69, 28, v68
  v_sub_u32 v69, v67, v69
  v_lshrrev_b32 v70, 4, v69
  v_and_b32 v69, 15, v69
  v_lshlrev_b32 v71, 12, v70
  v_lshl_add_u32 v71, v68, 8, v71
  v_lshl_add_u32 v71, v69, 4, v71
  v_add_u32 v106, v71, v75
  v_add_u32 v67, 272, v73
  v_mul_u32_u24 v68, 2341, v67
  v_lshrrev_b32 v68, 16, v68
  v_mul_u32_u24 v69, 28, v68
  v_sub_u32 v69, v67, v69
  v_lshrrev_b32 v70, 4, v69
  v_and_b32 v69, 15, v69
  v_lshlrev_b32 v71, 12, v70
  v_lshl_add_u32 v71, v68, 8, v71
  v_lshl_add_u32 v71, v69, 4, v71
  v_add_u32 v107, v71, v75
  v_add_u32 v67, 288, v73
  v_mul_u32_u24 v68, 2341, v67
  v_lshrrev_b32 v68, 16, v68
  v_mul_u32_u24 v69, 28, v68
  v_sub_u32 v69, v67, v69
  v_lshrrev_b32 v70, 4, v69
  v_and_b32 v69, 15, v69
  v_lshlrev_b32 v71, 12, v70
  v_lshl_add_u32 v71, v68, 8, v71
  v_lshl_add_u32 v71, v69, 4, v71
  v_add_u32 v108, v71, v75
  v_add_u32 v67, 304, v73
  v_mul_u32_u24 v68, 2341, v67
  v_lshrrev_b32 v68, 16, v68
  v_mul_u32_u24 v69, 28, v68
  v_sub_u32 v69, v67, v69
  v_lshrrev_b32 v70, 4, v69
  v_and_b32 v69, 15, v69
  v_lshlrev_b32 v71, 12, v70
  v_lshl_add_u32 v71, v68, 8, v71
  v_lshl_add_u32 v71, v69, 4, v71
  v_add_u32 v109, v71, v75
  v_add_u32 v67, 320, v73
  v_mul_u32_u24 v68, 2341, v67
  v_lshrrev_b32 v68, 16, v68
  v_mul_u32_u24 v69, 28, v68
  v_sub_u32 v69, v67, v69
  v_lshrrev_b32 v70, 4, v69
  v_and_b32 v69, 15, v69
  v_lshlrev_b32 v71, 12, v70
  v_lshl_add_u32 v71, v68, 8, v71
  v_lshl_add_u32 v71, v69, 4, v71
  v_add_u32 v110, v71, v75
  v_add_u32 v67, 96, v73
  v_mul_u32_u24 v68, 2341, v67
  v_lshrrev_b32 v68, 16, v68
  v_mul_u32_u24 v69, 28, v68
  v_sub_u32 v69, v67, v69
  v_lshrrev_b32 v70, 4, v69
  v_and_b32 v69, 15, v69
  v_lshlrev_b32 v71, 12, v70
  v_lshl_add_u32 v71, v68, 8, v71
  v_lshl_add_u32 v71, v69, 4, v71
  v_add_u32 v111, v71, v75
  v_mov_b32 v74, 0x40000000
  v_mov_b32 v96, 0
  v_add_u32 v0, 16384, v2
  s_mul_i32 s22, s17, 28672
  s_add_u32 s25, s22, 2490368
  v_and_b32 v119, 15, v1
  s_and_b32 s22, s17, 0
  s_lshl_b32 s22, s22, 7
  s_add_u32 s22, s22, 39424
  v_lshl_add_u32 v119, v119, 2, s22
  s_lshl_b32 s22, s17, 2
  s_add_u32 s22, s22, 37376
  v_lshl_add_u32 v118, v1, 7, s22
  v_cmp_gt_u32 vcc, 1, v1
  s_nop 1
  v_cndmask_b32 v118, v74, v118, vcc
  s_lshl_b32 s35, s17, 7
  s_add_u32 s35, s35, 524288
  v_mov_b32 v64, 0
  v_mov_b32 v65, 0
  v_mov_b32 v66, 0
  v_mov_b32 v67, 0
  v_min_u32 v116, 13, v1
  s_mul_i32 s22, s17, 14
  v_add_u32 v116, s22, v116
  v_lshlrev_b32 v116, 7, v116
  s_mul_i32 s31, s17, 401408
  s_add_u32 s31, s31, 40177664
  s_mov_b32 s30, 0
ch_wr6:
  buffer_load_dword v9, off, s[12:15], 0 offset:128 sc1
  s_waitcnt vmcnt(0)
  v_cmp_ne_u32 vcc, 1, v9
  s_cbranch_vccz ch_wr6_ok
  s_sleep 8
  s_add_u32 s30, s30, 1
  s_cmp_lt_u32 s30, 400000
  s_cbranch_scc1 ch_wr6
  s_branch cA_abort
ch_wr6_ok:
  s_lshr_b32 s22, s17, 2
  s_lshl_b32 s28, 0x81, s22
  s_mul_i32 s27, s17, 12
  s_add_u32 s22, s27, 256
  s_lshr_b32 s22, s22, 6
  s_lshl_b32 s22, 0x81, s22
  s_or_b32 s28, s28, s22
  s_add_u32 s22, s27, 267
  s_lshr_b32 s22, s22, 6
  s_lshl_b32 s22, 0x81, s22
  s_or_b32 s28, s28, s22
  v_lshrrev_b32 v12, 8, v2
  v_lshlrev_b32 v12, 7, v12
  s_mov_b32 s27, 583168
  s_mov_b32 s30, 0
ch_ww6:
  buffer_load_dword v9, v12, s[8:11], s27 offen sc1
  s_waitcnt vmcnt(0)
  v_and_b32 v10, s28, v9
  v_cmp_ne_u32 vcc, s28, v10
  s_cbranch_vccz ch_ww6_ok
  s_sleep 3
  s_add_u32 s30, s30, 1
  s_cmp_lt_u32 s30, 400000
  s_cbranch_scc1 ch_ww6
  s_branch cA_abort
ch_ww6_ok:
  s_add_u32 s22, s31, 0
  buffer_load_dwordx4 a[0:3], v2, s[8:11], s22 offen offset:0 sc1
  buffer_load_dwordx4 a[4:7], v2, s[8:11], s22 offen offset:1024 sc1
  buffer_load_dwordx4 a[8:11], v2, s[8:11], s22 offen offset:2048 sc1
  buffer_load_dwordx4 a[12:15], v2, s[8:11], s22 offen offset:3072 sc1
  s_add_u32 s22, s31, 4096
  buffer_load_dwordx4 a[16:19], v2, s[8:11], s22 offen offset:0 sc1
  buffer_load_dwordx4 a[20:23], v2, s[8:11], s22 offen offset:1024 sc1
  buffer_load_dwordx4 a[24:27], v2, s[8:11], s22 offen offset:2048 sc1
  buffer_load_dwordx4 a[28:31], v2, s[8:11], s22 offen offset:3072 sc1
  s_add_u32 s22, s31, 8192
  buffer_load_dwordx4 a[32:35], v2, s[8:11], s22 offen offset:0 sc1
  buffer_load_dwordx4 a[36:39], v2, s[8:11], s22 offen offset:1024 sc1
  buffer_load_dwordx4 a[40:43], v2, s[8:11], s22 offen offset:2048 sc1
  buffer_load_dwordx4 a[44:47], v2, s[8:11], s22 offen offset:3072 sc1
  s_add_u32 s22, s31, 12288
  buffer_load_dwordx4 a[48:51], v2, s[8:11], s22 offen offset:0 sc1
  buffer_load_dwordx4 a[52:55], v2, s[8:11], s22 offen offset:1024 sc1
  buffer_load_dwordx4 a[56:59], v2, s[8:11], s22 offen offset:2048 sc1
  buffer_load_dwordx4 a[60:63], v2, s[8:11], s22 offen offset:3072 sc1
  s_add_u32 s22, s31, 16384
  buffer_load_dwordx4 a[64:67], v2, s[8:11], s22 offen offset:0 sc1
  buffer_load_dwordx4 a[68:71], v2, s[8:11], s22 offen offset:1024 sc1
  buffer_load_dwordx4 a[72:75], v2, s[8:11], s22 offen offset:2048 sc1
  buffer_load_dwordx4 a[76:79], v2, s[8:11], s22 offen offset:3072 sc1
  s_add_u32 s22, s31, 20480
  buffer_load_dwordx4 a[80:83], v2, s[8:11], s22 offen offset:0 sc1
  buffer_load_dwordx4 a[84:87], v2, s[8:11], s22 offen offset:1024 sc1
  buffer_load_dwordx4 a[88:91], v2, s[8:11], s22 offen offset:2048 sc1
  buffer_load_dwordx4 a[92:95], v2, s[8:11], s22 offen offset:3072 sc1
  s_add_u32 s22, s31, 24576
  buffer_load_dwordx4 a[96:99], v2, s[8:11], s22 offen offset:0 sc1
  buffer_load_dwordx4 a[100:103], v2, s[8:11], s22 offen offset:1024 sc1
  buffer_load_dwordx4 a[104:107], v2, s[8:11], s22 offen offset:2048 sc1
  buffer_load_dwordx4 a[108:111], v2, s[8:11], s22 offen offset:3072 sc1
  s_add_u32 s22, s31, 28672
  buffer_load_dwordx4 a[112:115], v2, s[8:11], s22 offen offset:0 sc1
  buffer_load_dwordx4 a[116:119], v2, s[8:11], s22 offen offset:1024 sc1
  buffer_load_dwordx4 a[120:123], v2, s[8:11], s22 offen offset:2048 sc1
  buffer_load_dwordx4 a[124:127], v2, s[8:11], s22 offen offset:3072 sc1
  s_waitcnt vmcnt(24)
  s_add_u32 s22, s31, 32768
  buffer_load_dwordx4 a[128:131], v2, s[8:11], s22 offen offset:0 sc1
  buffer_load_dwordx4 a[132:135], v2, s[8:11], s22 offen offset:1024 sc1
  buffer_load_dwordx4 a[136:139], v2, s[8:11], s22 offen offset:2048 sc1
  buffer_load_dwordx4 a[140:143], v2, s[8:11], s22 offen offset:3072 sc1
  s_add_u32 s22, s31, 36864
  buffer_load_dwordx4 a[144:147], v2, s[8:11], s22 offen offset:0 sc1
  buffer_load_dwordx4 a[148:151], v2, s[8:11], s22 offen offset:1024 sc1
  buffer_load_dwordx4 a[152:155], v2, s[8:11], s22 offen offset:2048 sc1
  buffer_load_dwordx4 a[156:159], v2, s[8:11], s22 offen offset:3072 sc1
  s_add_u32 s22, s31, 40960
  buffer_load_dwordx4 a[160:163], v2, s[8:11], s22 offen offset:0 sc1
  buffer_load_dwordx4 a[164:167], v2, s[8:11], s22 offen offset:1024 sc1
  buffer_load_dwordx4 a[168:171], v2, s[8:11], s22 offen offset:2048 sc1
  buffer_load_dwordx4 a[172:175], v2, s[8:11], s22 offen offset:3072 sc1
  s_add_u32 s22, s31, 45056
  buffer_load_dwordx4 a[176:179], v2, s[8:11], s22 offen offset:0 sc1
  buffer_load_dwordx4 a[180:183], v2, s[8:11], s22 offen offset:1024 sc1
  buffer_load_dwordx4 a[184:187], v2, s[8:11], s22 offen offset:2048 sc1
  buffer_load_dwordx4 a[188:191], v2, s[8:11], s22 offen offset:3072 sc1
  s_add_u32 s22, s31, 49152
  buffer_load_dwordx4 a[192:195], v2, s[8:11], s22 offen offset:0 sc1
  buffer_load_dwordx4 a[196:199], v2, s[8:11], s22 offen offset:1024 sc1
  buffer_load_dwordx4 a[200:203], v2, s[8:11], s22 offen offset:2048 sc1
  buffer_load_dwordx4 a[204:207], v2, s[8:11], s22 offen offset:3072 sc1
  s_add_u32 s22, s31, 53248
  buffer_load_dwordx4 a[208:211], v2, s[8:11], s22 offen offset:0 sc1
  buffer_load_dwordx4 a[212:215], v2, s[8:11], s22 offen offset:1024 sc1
  buffer_load_dwordx4 a[216:219], v2, s[8:11], s22 offen offset:2048 sc1
  buffer_load_dwordx4 a[220:223], v2, s[8:11], s22 offen offset:3072 sc1
  s_add_u32 s22, s31, 57344
  buffer_load_dwordx4 a[224:227], v2, s[8:11], s22 offen offset:0 sc1
  buffer_load_dwordx4 a[228:231], v2, s[8:11], s22 offen offset:1024 sc1
  buffer_load_dwordx4 a[232:235], v2, s[8:11], s22 offen offset:2048 sc1
  buffer_load_dwordx4 a[236:239], v2, s[8:11], s22 offen offset:3072 sc1
  s_add_u32 s22, s31, 61440
  buffer_load_dwordx4 a[240:243], v2, s[8:11], s22 offen offset:0 sc1
  buffer_load_dwordx4 a[244:247], v2, s[8:11], s22 offen offset:1024 sc1
  buffer_load_dwordx4 a[248:251], v2, s[8:11], s22 offen offset:2048 sc1
  buffer_load_dwordx4 a[252:255], v2, s[8:11], s22 offen offset:3072 sc1
  s_waitcnt vmcnt(24)
  s_add_u32 s22, s31, 65536
  buffer_load_dwordx4 v[120:123], v2, s[8:11], s22 offen offset:0 sc1
  buffer_load_dwordx4 v[124:127], v2, s[8:11], s22 offen offset:1024 sc1
  buffer_load_dwordx4 v[128:131], v2, s[8:11], s22 offen offset:2048 sc1
  buffer_load_dwordx4 v[132:135], v2, s[8:11], s22 offen offset:3072 sc1
  s_add_u32 s22, s31, 69632
  buffer_load_dwordx4 v[136:139], v2, s[8:11], s22 offen offset:0 sc1
  buffer_load_dwordx4 v[140:143], v2, s[8:11], s22 offen offset:1024 sc1
  buffer_load_dwordx4 v[144:147], v2, s[8:11], s22 offen offset:2048 sc1
  buffer_load_dwordx4 v[148:151], v2, s[8:11], s22 offen offset:3072 sc1
  s_add_u32 s22, s31, 73728
  buffer_load_dwordx4 v[152:155], v2, s[8:11], s22 offen offset:0 sc1
  buffer_load_dwordx4 v[156:159], v2, s[8:11], s22 offen offset:1024 sc1
  buffer_load_dwordx4 v[160:163], v2, s[8:11], s22 offen offset:2048 sc1
  buffer_load_dwordx4 v[164:167], v2, s[8:11], s22 offen offset:3072 sc1
  s_add_u32 s22, s31, 77824
  buffer_load_dwordx4 v[168:171], v2, s[8:11], s22 offen offset:0 sc1
  buffer_load_dwordx4 v[172:175], v2, s[8:11], s22 offen offset:1024 sc1
  buffer_load_dwordx4 v[176:179], v2, s[8:11], s22 offen offset:2048 sc1
  buffer_load_dwordx4 v[180:183], v2, s[8:11], s22 offen offset:3072 sc1
  s_add_u32 s22, s31, 81920
  buffer_load_dwordx4 v[184:187], v2, s[8:11], s22 offen offset:0 sc1
  buffer_load_dwordx4 v[188:191], v2, s[8:11], s22 offen offset:1024 sc1
  buffer_load_dwordx4 v[192:195], v2, s[8:11], s22 offen offset:2048 sc1
  buffer_load_dwordx4 v[196:199], v2, s[8:11], s22 offen offset:3072 sc1
  s_add_u32 s22, s31, 86016
  buffer_load_dwordx4 v[200:203], v2, s[8:11], s22 offen offset:0 sc1
  buffer_load_dwordx4 v[204:207], v2, s[8:11], s22 offen offset:1024 sc1
  buffer_load_dwordx4 v[208:211], v2, s[8:11], s22 offen offset:2048 sc1
  buffer_load_dwordx4 v[212:215], v2, s[8:11], s22 offen offset:3072 sc1
  s_add_u32 s22, s31, 90112
  buffer_load_dwordx4 v[216:219], v2, s[8:11], s22 offen offset:0 sc1
  buffer_load_dwordx4 v[220:223], v2, s[8:11], s22 offen offset:1024 sc1
  buffer_load_dwordx4 v[224:227], v2, s[8:11], s22 offen offset:2048 sc1
  buffer_load_dwordx4 v[228:231], v2, s[8:11], s22 offen offset:3072 sc1
  s_add_u32 s22, s31, 94208
  buffer_load_dwordx4 v[232:235], v2, s[8:11], s22 offen offset:0 sc1
  buffer_load_dwordx4 v[236:239], v2, s[8:11], s22 offen offset:1024 sc1
  buffer_load_dwordx4 v[240:243], v2, s[8:11], s22 offen offset:2048 sc1
  buffer_load_dwordx4 v[244:247], v2, s[8:11], s22 offen offset:3072 sc1
  s_waitcnt vmcnt(24)
  s_add_u32 s22, s31, 98304
  buffer_load_dwordx4 v[248:251], v2, s[8:11], s22 offen offset:0 sc1
  buffer_load_dwordx4 v[252:255], v2, s[8:11], s22 offen offset:1024 sc1
  s_mov_b32 s30, 0
ch_ws6:
  buffer_load_dword v9, off, s[12:15], 0 offset:132 sc1
  s_waitcnt vmcnt(0)
  v_cmp_ne_u32 vcc, 1, v9
  s_cbranch_vccz ch_ws6_ok
  s_sleep 8
  s_add_u32 s30, s30, 1
  s_cmp_lt_u32 s30, 400000
  s_cbranch_scc1 ch_ws6
  s_branch cA_abort
ch_ws6_ok:
  s_lshl_b32 s27, s17, 7
  s_add_u32 s27, s27, 524288
  s_mov_b32 s30, 0
ch_vw2:
  buffer_load_dword v9, off, s[8:11], s27 sc1
  s_waitcnt vmcnt(0)
  v_cmp_ne_u32 vcc, 56, v9
  s_cbranch_vccz ch_vw2_d
  s_sleep 2
  s_add_u32 s30, s30, 1
  s_cmp_lt_u32 s30, 400000
  s_cbranch_scc1 ch_vw2
  s_branch cA_abort
ch_vw2_d:
  s_mov_b32 s28, s35
  s_waitcnt vmcnt(0) lgkmcnt(0)
  s_mov_b32 s31, 0
  s_cmp_lg_u32 s88, 0
  s_cbranch_scc1 cB_va2_loop
  s_branch cA_va2_loop
ch_init7:
  v_mov_b32 v72, v116
  v_mov_b32 v73, v117
  v_lshrrev_b32 v65, 1, v72
  v_and_b32 v66, 1, v72
  v_mov_b32 v36, 0
  v_mov_b32 v37, 0
  v_mov_b32 v38, 0
  v_mov_b32 v39, 0
  v_mov_b32 v40, 0
  v_mov_b32 v41, 0
  v_mov_b32 v42, 0
  v_mov_b32 v43, 0
  v_mov_b32 v44, 0
  v_mov_b32 v45, 0
  v_mov_b32 v46, 0
  v_mov_b32 v47, 0
  v_mov_b32 v48, 0
  v_mov_b32 v49, 0
  v_mov_b32 v50, 0
  v_mov_b32 v51, 0
  v_mov_b32 v52, 0
  v_mov_b32 v53, 0
  v_mov_b32 v54, 0
  v_mov_b32 v55, 0
  v_mov_b32 v56, 0
  v_mov_b32 v57, 0
  v_mov_b32 v58, 0
  v_mov_b32 v59, 0
  v_mov_b32 v60, 0
  v_mov_b32 v61, 0
  v_mov_b32 v62, 0
  v_mov_b32 v63, 0
  v_lshlrev_b32 v75, 2, v65
  v_lshl_add_u32 v75, v66, 3, v75
  v_add_u32 v67, 336, v73
  v_mul_u32_u24 v68, 2341, v67
  v_lshrrev_b32 v68, 16, v68
  v_mul_u32_u24 v69, 28, v68
  v_sub_u32 v69, v67, v69
  v_lshrrev_b32 v70, 4, v69
  v_and_b32 v69, 15, v69
  v_lshlrev_b32 v71, 12, v70
  v_lshl_add_u32 v71, v68, 8, v71
  v_lshl_add_u32 v71, v69, 4, v71
  v_add_u32 v104, v71, v75
  v_add_u32 v67, 352, v73
  v_mul_u32_u24 v68, 2341, v67
  v_lshrrev_b32 v68, 16, v68
  v_mul_u32_u24 v69, 28, v68
  v_sub_u32 v69, v67, v69
  v_lshrrev_b32 v70, 4, v69
  v_and_b32 v69, 15, v69
  v_lshlrev_b32 v71, 12, v70
  v_lshl_add_u32 v71, v68, 8, v71
  v_lshl_add_u32 v71, v69, 4, v71
  v_add_u32 v105, v71, v75
  v_add_u32 v67, 368, v73
  v_mul_u32_u24 v68, 2341, v67
  v_lshrrev_b32 v68, 16, v68
  v_mul_u32_u24 v69, 28, v68
  v_sub_u32 v69, v67, v69
  v_lshrrev_b32 v70, 4, v69
  v_and_b32 v69, 15, v69
  v_lshlrev_b32 v71, 12, v70
  v_lshl_add_u32 v71, v68, 8, v71
  v_lshl_add_u32 v71, v69, 4, v71
  v_add_u32 v106, v71, v75
  v_add_u32 v67, 384, v73
  v_mul_u32_u24 v68, 2341, v67
  v_lshrrev_b32 v68, 16, v68
  v_mul_u32_u24 v69, 28, v68
  v_sub_u32 v69, v67, v69
  v_lshrrev_b32 v70, 4, v69
  v_and_b32 v69, 15, v69
  v_lshlrev_b32 v71, 12, v70
  v_lshl_add_u32 v71, v68, 8, v71
  v_lshl_add_u32 v71, v69, 4, v71
  v_add_u32 v107, v71, v75
  v_add_u32 v67, 400, v73
  v_mul_u32_u24 v68, 2341, v67
  v_lshrrev_b32 v68, 16, v68
  v_mul_u32_u24 v69, 28, v68
  v_sub_u32 v69, v67, v69
  v_lshrrev_b32 v70, 4, v69
  v_and_b32 v69, 15, v69
  v_lshlrev_b32 v71, 12, v70
  v_lshl_add_u32 v71, v68, 8, v71
  v_lshl_add_u32 v71, v69, 4, v71
  v_add_u32 v108, v71, v75
  v_add_u32 v67, 416, v73
  v_mul_u32_u24 v68, 2341, v67
  v_lshrrev_b32 v68, 16, v68
  v_mul_u32_u24 v69, 28, v68
  v_sub_u32 v69, v67, v69
  v_lshrrev_b32 v70, 4, v69
  v_and_b32 v69, 15, v69
  v_lshlrev_b32 v71, 12, v70
  v_lshl_add_u32 v71, v68, 8, v71
  v_lshl_add_u32 v71, v69, 4, v71
  v_add_u32 v109, v71, v75
  v_add_u32 v67, 432, v73
  v_mul_u32_u24 v68, 2341, v67
  v_lshrrev_b32 v68, 16, v68
  v_mul_u32_u24 v69, 28, v68
  v_sub_u32 v69, v67, v69
  v_lshrrev_b32 v70, 4, v69
  v_and_b32 v69, 15, v69
  v_lshlrev_b32 v71, 12, v70
  v_lshl_add_u32 v71, v68, 8, v71
  v_lshl_add_u32 v71, v69, 4, v71
  v_add_u32 v110, v71, v75
  v_mov_b32 v74, 0x40000000
  v_mov_b32 v96, 0
  s_mul_i32 s22, s17, 28672
  s_add_u32 s25, s22, 2490368
  v_and_b32 v119, 15, v1
  s_and_b32 s22, s17, 0
  s_lshl_b32 s22, s22, 7
  s_add_u32 s22, s22, 39424
  v_lshl_add_u32 v119, v119, 2, s22
  s_lshl_b32 s22, s17, 2
  s_add_u32 s22, s22, 37376
  v_lshl_add_u32 v118, v1, 7, s22
  v_cmp_gt_u32 vcc, 1, v1
  s_nop 1
  v_cndmask_b32 v118, v74, v118, vcc
  s_lshl_b32 s35, s17, 7
  s_add_u32 s35, s35, 524288
  v_mov_b32 v64, 0
  v_mov_b32 v65, 0
  v_mov_b32 v66, 0
  v_mov_b32 v67, 0
  v_min_u32 v116, 13, v1
  s_mul_i32 s22, s17, 14
  v_add_u32 v116, s22, v116
  v_lshlrev_b32 v116, 7, v116
  s_mul_i32 s31, s17, 401408
  s_add_u32 s31, s31, 40278016
  s_mov_b32 s30, 0
ch_wr7:
  buffer_load_dword v9, off, s[12:15], 0 offset:128 sc1
  s_waitcnt vmcnt(0)
  v_cmp_ne_u32 vcc, 1, v9
  s_cbranch_vccz ch_wr7_ok
  s_sleep 8
  s_add_u32 s30, s30, 1
  s_cmp_lt_u32 s30, 400000
  s_cbranch_scc1 ch_wr7
  s_branch cA_abort
ch_wr7_ok:
  s_lshr_b32 s22, s17, 2
  s_lshl_b32 s28, 0x81, s22
  s_mul_i32 s27, s17, 12
  s_add_u32 s22, s27, 256
  s_lshr_b32 s22, s22, 6
  s_lshl_b32 s22, 0x81, s22
  s_or_b32 s28, s28, s22
  s_add_u32 s22, s27, 267
  s_lshr_b32 s22, s22, 6
  s_lshl_b32 s22, 0x81, s22
  s_or_b32 s28, s28, s22
  v_lshrrev_b32 v12, 8, v2
  v_lshlrev_b32 v12, 7, v12
  s_mov_b32 s27, 583680
  s_mov_b32 s30, 0
ch_ww7:
  buffer_load_dword v9, v12, s[8:11], s27 offen sc1
  s_waitcnt vmcnt(0)
  v_and_b32 v10, s28, v9
  v_cmp_ne_u32 vcc, s28, v10
  s_cbranch_vccz ch_ww7_ok
  s_sleep 3
  s_add_u32 s30, s30, 1
  s_cmp_lt_u32 s30, 400000
  s_cbranch_scc1 ch_ww7
  s_branch cA_abort
ch_ww7_ok:
  s_add_u32 s22, s31, 0
  buffer_load_dwordx4 a[0:3], v2, s[8:11], s22 offen offset:0 sc1
  buffer_load_dwordx4 a[4:7], v2, s[8:11], s22 offen offset:1024 sc1
  buffer_load_dwordx4 a[8:11], v2, s[8:11], s22 offen offset:2048 sc1
  buffer_load_dwordx4 a[12:15], v2, s[8:11], s22 offen offset:3072 sc1
  s_add_u32 s22, s31, 4096
  buffer_load_dwordx4 a[16:19], v2, s[8:11], s22 offen offset:0 sc1
  buffer_load_dwordx4 a[20:23], v2, s[8:11], s22 offen offset:1024 sc1
  buffer_load_dwordx4 a[24:27], v2, s[8:11], s22 offen offset:2048 sc1
  buffer_load_dwordx4 a[28:31], v2, s[8:11], s22 offen offset:3072 sc1
  s_add_u32 s22, s31, 8192
  buffer_load_dwordx4 a[32:35], v2, s[8:11], s22 offen offset:0 sc1
  buffer_load_dwordx4 a[36:39], v2, s[8:11], s22 offen offset:1024 sc1
  buffer_load_dwordx4 a[40:43], v2, s[8:11], s22 offen offset:2048 sc1
  buffer_load_dwordx4 a[44:47], v2, s[8:11], s22 offen offset:3072 sc1
  s_add_u32 s22, s31, 12288
  buffer_load_dwordx4 a[48:51], v2, s[8:11], s22 offen offset:0 sc1
  buffer_load_dwordx4 a[52:55], v2, s[8:11], s22 offen offset:1024 sc1
  buffer_load_dwordx4 a[56:59], v2, s[8:11], s22 offen offset:2048 sc1
  buffer_load_dwordx4 a[60:63], v2, s[8:11], s22 offen offset:3072 sc1
  s_add_u32 s22, s31, 16384
  buffer_load_dwordx4 a[64:67], v2, s[8:11], s22 offen offset:0 sc1
  buffer_load_dwordx4 a[68:71], v2, s[8:11], s22 offen offset:1024 sc1
  buffer_load_dwordx4 a[72:75], v2, s[8:11], s22 offen offset:2048 sc1
  buffer_load_dwordx4 a[76:79], v2, s[8:11], s22 offen offset:3072 sc1
  s_add_u32 s22, s31, 20480
  buffer_load_dwordx4 a[80:83], v2, s[8:11], s22 offen offset:0 sc1
  buffer_load_dwordx4 a[84:87], v2, s[8:11], s22 offen offset:1024 sc1
  buffer_load_dwordx4 a[88:91], v2, s[8:11], s22 offen offset:2048 sc1
  buffer_load_dwordx4 a[92:95], v2, s[8:11], s22 offen offset:3072 sc1
  s_add_u32 s22, s31, 24576
  buffer_load_dwordx4 a[96:99], v2, s[8:11], s22 offen offset:0 sc1
  buffer_load_dwordx4 a[100:103], v2, s[8:11], s22 offen offset:1024 sc1
  buffer_load_dwordx4 a[104:107], v2, s[8:11], s22 offen offset:2048 sc1
  buffer_load_dwordx4 a[108:111], v2, s[8:11], s22 offen offset:3072 sc1
  s_add_u32 s22, s31, 28672
  buffer_load_dwordx4 a[112:115], v2, s[8:11], s22 offen offset:0 sc1
  buffer_load_dwordx4 a[116:119], v2, s[8:11], s22 offen offset:1024 sc1
  buffer_load_dwordx4 a[120:123], v2, s[8:11], s22 offen offset:2048 sc1
  buffer_load_dwordx4 a[124:127], v2, s[8:11], s22 offen offset:3072 sc1
  s_waitcnt vmcnt(24)
  s_add_u32 s22, s31, 32768
  buffer_load_dwordx4 a[128:131], v2, s[8:11], s22 offen offset:0 sc1
  buffer_load_dwordx4 a[132:135], v2, s[8:11], s22 offen offset:1024 sc1
  buffer_load_dwordx4 a[136:139], v2, s[8:11], s22 offen offset:2048 sc1
  buffer_load_dwordx4 a[140:143], v2, s[8:11], s22 offen offset:3072 sc1
  s_add_u32 s22, s31, 36864
  buffer_load_dwordx4 a[144:147], v2, s[8:11], s22 offen offset:0 sc1
  buffer_load_dwordx4 a[148:151], v2, s[8:11], s22 offen offset:1024 sc1
  buffer_load_dwordx4 a[152:155], v2, s[8:11], s22 offen offset:2048 sc1
  buffer_load_dwordx4 a[156:159], v2, s[8:11], s22 offen offset:3072 sc1
  s_add_u32 s22, s31, 40960
  buffer_load_dwordx4 a[160:163], v2, s[8:11], s22 offen offset:0 sc1
  buffer_load_dwordx4 a[164:167], v2, s[8:11], s22 offen offset:1024 sc1
  buffer_load_dwordx4 a[168:171], v2, s[8:11], s22 offen offset:2048 sc1
  buffer_load_dwordx4 a[172:175], v2, s[8:11], s22 offen offset:3072 sc1
  s_add_u32 s22, s31, 45056
  buffer_load_dwordx4 a[176:179], v2, s[8:11], s22 offen offset:0 sc1
  buffer_load_dwordx4 a[180:183], v2, s[8:11], s22 offen offset:1024 sc1
  buffer_load_dwordx4 a[184:187], v2, s[8:11], s22 offen offset:2048 sc1
  buffer_load_dwordx4 a[188:191], v2, s[8:11], s22 offen offset:3072 sc1
  s_add_u32 s22, s31, 49152
  buffer_load_dwordx4 a[192:195], v2, s[8:11], s22 offen offset:0 sc1
  buffer_load_dwordx4 a[196:199], v2, s[8:11], s22 offen offset:1024 sc1
  buffer_load_dwordx4 a[200:203], v2, s[8:11], s22 offen offset:2048 sc1
  buffer_load_dwordx4 a[204:207], v2, s[8:11], s22 offen offset:3072 sc1
  s_add_u32 s22, s31, 53248
  buffer_load_dwordx4 a[208:211], v2, s[8:11], s22 offen offset:0 sc1
  buffer_load_dwordx4 a[212:215], v2, s[8:11], s22 offen offset:1024 sc1
  buffer_load_dwordx4 a[216:219], v2, s[8:11], s22 offen offset:2048 sc1
  buffer_load_dwordx4 a[220:223], v2, s[8:11], s22 offen offset:3072 sc1
  s_add_u32 s22, s31, 57344
  buffer_load_dwordx4 a[224:227], v2, s[8:11], s22 offen offset:0 sc1
  buffer_load_dwordx4 a[228:231], v2, s[8:11], s22 offen offset:1024 sc1
  buffer_load_dwordx4 a[232:235], v2, s[8:11], s22 offen offset:2048 sc1
  buffer_load_dwordx4 a[236:239], v2, s[8:11], s22 offen offset:3072 sc1
  s_add_u32 s22, s31, 61440
  buffer_load_dwordx4 a[240:243], v2, s[8:11], s22 offen offset:0 sc1
  buffer_load_dwordx4 a[244:247], v2, s[8:11], s22 offen offset:1024 sc1
  buffer_load_dwordx4 a[248:251], v2, s[8:11], s22 offen offset:2048 sc1
  buffer_load_dwordx4 a[252:255], v2, s[8:11], s22 offen offset:3072 sc1
  s_waitcnt vmcnt(24)
  s_add_u32 s22, s31, 65536
  buffer_load_dwordx4 v[120:123], v2, s[8:11], s22 offen offset:0 sc1
  buffer_load_dwordx4 v[124:127], v2, s[8:11], s22 offen offset:1024 sc1
  buffer_load_dwordx4 v[128:131], v2, s[8:11], s22 offen offset:2048 sc1
  buffer_load_dwordx4 v[132:135], v2, s[8:11], s22 offen offset:3072 sc1
  s_add_u32 s22, s31, 69632
  buffer_load_dwordx4 v[136:139], v2, s[8:11], s22 offen offset:0 sc1
  buffer_load_dwordx4 v[140:143], v2, s[8:11], s22 offen offset:1024 sc1
  buffer_load_dwordx4 v[144:147], v2, s[8:11], s22 offen offset:2048 sc1
  buffer_load_dwordx4 v[148:151], v2, s[8:11], s22 offen offset:3072 sc1
  s_add_u32 s22, s31, 73728
  buffer_load_dwordx4 v[152:155], v2, s[8:11], s22 offen offset:0 sc1
  buffer_load_dwordx4 v[156:159], v2, s[8:11], s22 offen offset:1024 sc1
  buffer_load_dwordx4 v[160:163], v2, s[8:11], s22 offen offset:2048 sc1
  buffer_load_dwordx4 v[164:167], v2, s[8:11], s22 offen offset:3072 sc1
  s_add_u32 s22, s31, 77824
  buffer_load_dwordx4 v[168:171], v2, s[8:11], s22 offen offset:0 sc1
  buffer_load_dwordx4 v[172:175], v2, s[8:11], s22 offen offset:1024 sc1
  buffer_load_dwordx4 v[176:179], v2, s[8:11], s22 offen offset:2048 sc1
  buffer_load_dwordx4 v[180:183], v2, s[8:11], s22 offen offset:3072 sc1
  s_add_u32 s22, s31, 81920
  buffer_load_dwordx4 v[184:187], v2, s[8:11], s22 offen offset:0 sc1
  buffer_load_dwordx4 v[188:191], v2, s[8:11], s22 offen offset:1024 sc1
  buffer_load_dwordx4 v[192:195], v2, s[8:11], s22 offen offset:2048 sc1
  buffer_load_dwordx4 v[196:199], v2, s[8:11], s22 offen offset:3072 sc1
  s_add_u32 s22, s31, 86016
  buffer_load_dwordx4 v[200:203], v2, s[8:11], s22 offen offset:0 sc1
  buffer_load_dwordx4 v[204:207], v2, s[8:11], s22 offen offset:1024 sc1
  buffer_load_dwordx4 v[208:211], v2, s[8:11], s22 offen offset:2048 sc1
  buffer_load_dwordx4 v[212:215], v2, s[8:11], s22 offen offset:3072 sc1
  s_add_u32 s22, s31, 90112
  buffer_load_dwordx4 v[216:219], v2, s[8:11], s22 offen offset:0 sc1
  buffer_load_dwordx4 v[220:223], v2, s[8:11], s22 offen offset:1024 sc1
  buffer_load_dwordx4 v[224:227], v2, s[8:11], s22 offen offset:2048 sc1
  buffer_load_dwordx4 v[228:231], v2, s[8:11], s22 offen offset:3072 sc1
  s_add_u32 s22, s31, 94208
  buffer_load_dwordx4 v[232:235], v2, s[8:11], s22 offen offset:0 sc1
  buffer_load_dwordx4 v[236:239], v2, s[8:11], s22 offen offset:1024 sc1
  buffer_load_dwordx4 v[240:243], v2, s[8:11], s22 offen offset:2048 sc1
  buffer_load_dwordx4 v[244:247], v2, s[8:11], s22 offen offset:3072 sc1
  s_waitcnt vmcnt(24)
  s_add_u32 s22, s31, 98304
  buffer_load_dwordx4 v[248:251], v2, s[8:11], s22 offen offset:0 sc1
  buffer_load_dwordx4 v[252:255], v2, s[8:11], s22 offen offset:1024 sc1
  s_mov_b32 s30, 0
ch_ws7:
  buffer_load_dword v9, off, s[12:15], 0 offset:132 sc1
  s_waitcnt vmcnt(0)
  v_cmp_ne_u32 vcc, 1, v9
  s_cbranch_vccz ch_ws7_ok
  s_sleep 8
  s_add_u32 s30, s30, 1
  s_cmp_lt_u32 s30, 400000
  s_cbranch_scc1 ch_ws7
  s_branch cA_abort
ch_ws7_ok:
  s_lshl_b32 s27, s17, 7
  s_add_u32 s27, s27, 524288
  s_mov_b32 s30, 0
ch_vw3:
  buffer_load_dword v9, off, s[8:11], s27 sc1
  s_waitcnt vmcnt(0)
  v_cmp_ne_u32 vcc, 56, v9
  s_cbranch_vccz ch_vw3_d
  s_sleep 2
  s_add_u32 s30, s30, 1
  s_cmp_lt_u32 s30, 400000
  s_cbranch_scc1 ch_vw3
  s_branch cA_abort
ch_vw3_d:
  s_mov_b32 s28, s35
  s_mov_b32 s39, 684032
  buffer_load_dword v100, v116, s[8:11], s39 offen sc1
  s_mov_b32 s39, 712704
  s_waitcnt vmcnt(1) lgkmcnt(0)
  s_mov_b32 s31, 0
  s_cmp_lg_u32 s88, 0
  s_cbranch_scc1 cB_va3_loop
  s_branch cA_va3_loop
.p2align 6
cA_sc0_loop:
  s_mov_b32 s30, 0
  s_mov_b32 s62, 0
  s_setprio 3
  s_sleep 6
cA_sc0_fp_l:
  v_cmp_gt_u32 vcc, s19, v112
  buffer_load_dword v112, v0, s[8:11], 0 offen sc1
  s_cbranch_vccz cA_sc0_fp_d
  v_cmp_gt_u32 vcc, s19, v112
  buffer_load_dword v112, v0, s[8:11], 0 offen sc1
  s_cbranch_vccz cA_sc0_fp_d
  v_cmp_gt_u32 vcc, s19, v112
  buffer_load_dword v112, v0, s[8:11], 0 offen sc1
  s_cbranch_vccz cA_sc0_fp_d
  v_cmp_gt_u32 vcc, s19, v112
  buffer_load_dword v112, v0, s[8:11], 0 offen sc1
  s_cbranch_vccz cA_sc0_fp_d
  v_cmp_gt_u32 vcc, s19, v112
  buffer_load_dword v112, v0, s[8:11], 0 offen sc1
  s_cbranch_vccz cA_sc0_fp_d
  v_cmp_gt_u32 vcc, s19, v112
  buffer_load_dword v112, v0, s[8:11], 0 offen sc1
  s_cbranch_vccz cA_sc0_fp_d
  v_cmp_gt_u32 vcc, s19, v112
  buffer_load_dword v112, v0, s[8:11], 0 offen sc1
  s_cbranch_vccz cA_sc0_fp_d
  v_cmp_gt_u32 vcc, s19, v112
  buffer_load_dword v112, v0, s[8:11], 0 offen sc1
  s_cbranch_vccz cA_sc0_fp_d
  v_cmp_gt_u32 vcc, s19, v112
  buffer_load_dword v112, v0, s[8:11], 0 offen sc1
  s_cbranch_vccz cA_sc0_fp_d
  v_cmp_gt_u32 vcc, s19, v112
  buffer_load_dword v112, v0, s[8:11], 0 offen sc1
  s_cbranch_vccz cA_sc0_fp_d
  v_cmp_gt_u32 vcc, s19, v112
  buffer_load_dword v112, v0, s[8:11], 0 offen sc1
  s_cbranch_vccz cA_sc0_fp_d
  v_cmp_gt_u32 vcc, s19, v112
  buffer_load_dword v112, v0, s[8:11], 0 offen sc1
  s_cbranch_vccz cA_sc0_fp_d
  v_cmp_gt_u32 vcc, s19, v112
  buffer_load_dword v112, v0, s[8:11], 0 offen sc1
  s_cbranch_vccz cA_sc0_fp_d
  v_cmp_gt_u32 vcc, s19, v112
  buffer_load_dword v112, v0, s[8:11], 0 offen sc1
  s_cbranch_vccz cA_sc0_fp_d
  v_cmp_gt_u32 vcc, s19, v112
  buffer_load_dword v112, v0, s[8:11], 0 offen sc1
  s_cbranch_vccz cA_sc0_fp_d
  v_cmp_gt_u32 vcc, s19, v112
  buffer_load_dword v112, v0, s[8:11], 0 offen sc1
  s_cbranch_vccz cA_sc0_fp_d
  s_waitcnt vmcnt(24)
  s_add_u32 s30, s30, 1
  s_cmp_lt_u32 s30, 400000
  s_cbranch_scc1 cA_sc0_fp_l
  s_branch cA_abort
cA_sc0_fp_d:
  buffer_load_dwordx4 v[8:11], v2, s[8:11], s20 offen offset:0 sc1
  s_barrier
  s_setprio 2
  buffer_load_dwordx4 v[12:15], v2, s[8:11], s20 offen offset:1024 sc1
  s_setprio 1
  buffer_load_dwordx4 v[16:19], v2, s[8:11], s20 offen offset:2048 sc1
  s_setprio 0
  buffer_load_dwordx4 v[20:23], v2, s[8:11], s20 offen offset:3072 sc1
cA_sc0_go:
  s_waitcnt vmcnt(3)
  v_smfmac_f32_16x16x64_bf16 v[36:39], v[8:11], a[0:7], v3
  buffer_load_dwordx4 v[32:35], v2, s[8:11], s23 offen offset:0 sc1
  v_cmp_eq_u32 vcc, -1, v8
  v_smfmac_f32_16x16x64_bf16 v[40:43], v[8:11], a[56:63], v3
  v_smfmac_f32_16x16x64_bf16 v[44:47], v[8:11], a[112:119], v3
  buffer_load_dwordx4 v[24:27], v2, s[8:11], s23 offen offset:1024 sc1
  s_cbranch_vccnz cA_sc0_r0
  v_smfmac_f32_16x16x64_bf16 v[48:51], v[8:11], a[168:175], v3
  v_smfmac_f32_16x16x64_bf16 v[52:55], v[8:11], a[224:231], v3
  v_smfmac_f32_16x16x64_bf16 v[56:59], v[8:11], v[144:151], v3
  buffer_load_dwordx4 v[28:31], v2, s[8:11], s23 offen offset:2048 sc1
  v_smfmac_f32_16x16x64_bf16 v[60:63], v[8:11], v[200:207], v3
  s_waitcnt vmcnt(5)
  v_smfmac_f32_16x16x64_bf16 v[36:39], v[12:15], a[8:15], v3
  v_smfmac_f32_16x16x64_bf16 v[40:43], v[12:15], a[64:71], v3
  v_smfmac_f32_16x16x64_bf16 v[44:47], v[12:15], a[120:127], v3
  v_smfmac_f32_16x16x64_bf16 v[48:51], v[12:15], a[176:183], v3
  v_smfmac_f32_16x16x64_bf16 v[52:55], v[12:15], a[232:239], v3
  v_smfmac_f32_16x16x64_bf16 v[56:59], v[12:15], v[152:159], v3
  buffer_load_dwordx4 v[88:91], v117, s[8:11], s26 offen offset:0 sc1
  v_smfmac_f32_16x16x64_bf16 v[60:63], v[12:15], v[208:215], v3
  s_waitcnt vmcnt(5)
  v_smfmac_f32_16x16x64_bf16 v[36:39], v[16:19], a[16:23], v3
  v_smfmac_f32_16x16x64_bf16 v[40:43], v[16:19], a[72:79], v3
  v_smfmac_f32_16x16x64_bf16 v[44:47], v[16:19], a[128:135], v3
  buffer_load_dwordx4 v[92:95], v117, s[8:11], s26 offen offset:1024 sc1
  v_smfmac_f32_16x16x64_bf16 v[48:51], v[16:19], a[184:191], v3
  v_smfmac_f32_16x16x64_bf16 v[52:55], v[16:19], a[240:247], v3
  v_smfmac_f32_16x16x64_bf16 v[56:59], v[16:19], v[160:167], v3
  v_smfmac_f32_16x16x64_bf16 v[60:63], v[16:19], v[216:223], v3
  s_waitcnt vmcnt(5)
  buffer_load_dwordx4 v[96:99], v2, s[8:11], s24 offen offset:0 sc1
  v_smfmac_f32_16x16x64_bf16 v[36:39], v[20:23], a[24:31], v3
  v_smfmac_f32_16x16x64_bf16 v[40:43], v[20:23], a[80:87], v3
  v_max3_u32 v66, v12, v16, v20
  v_smfmac_f32_16x16x64_bf16 v[44:47], v[20:23], a[136:143], v3
  v_smfmac_f32_16x16x64_bf16 v[48:51], v[20:23], a[192:199], v3
  buffer_load_dwordx4 v[100:103], v2, s[8:11], s24 offen offset:1024 sc1
  v_smfmac_f32_16x16x64_bf16 v[52:55], v[20:23], a[248:255], v3
  v_smfmac_f32_16x16x64_bf16 v[56:59], v[20:23], v[168:175], v3
  v_smfmac_f32_16x16x64_bf16 v[60:63], v[20:23], v[224:231], v3
  s_waitcnt vmcnt(4)
  v_smfmac_f32_16x16x64_bf16 v[60:63], v[32:35], v[232:239], v3
  buffer_load_dwordx4 v[104:107], v2, s[8:11], s26 offen offset:0 sc1
  v_max3_u32 v66, v66, v24, v27
  v_smfmac_f32_16x16x64_bf16 v[60:63], v[24:27], v[240:247], v3
  v_max3_u32 v66, v66, v28, v31
  v_smfmac_f32_16x16x64_bf16 v[60:63], v[28:31], v[248:255], v3
  v_max3_u32 v66, v66, v32, v35
  v_smfmac_f32_16x16x64_bf16 v[52:55], v[32:35], v[120:127], v3
  v_cmp_eq_u32 vcc, -1, v66
  v_smfmac_f32_16x16x64_bf16 v[52:55], v[24:27], v[128:135], v3
  buffer_load_dwordx4 v[108:111], v2, s[8:11], s26 offen offset:1024 sc1
  v_smfmac_f32_16x16x64_bf16 v[52:55], v[28:31], v[136:143], v3
  s_cbranch_vccnz cA_sc0_r4
  v_cvt_pk_bf16_f32 v63, v62, v63
  v_smfmac_f32_16x16x64_bf16 v[56:59], v[32:35], v[176:183], v3
  v_cvt_pk_bf16_f32 v62, v60, v61
  v_smfmac_f32_16x16x64_bf16 v[56:59], v[24:27], v[184:191], v3
  v_mfma_f32_16x16x32_bf16 v[12:15], v[62:65], v[4:7], 0
  v_cvt_pk_bf16_f32 v55, v54, v55
  v_smfmac_f32_16x16x64_bf16 v[56:59], v[28:31], v[192:199], v3
  v_cvt_pk_bf16_f32 v54, v52, v53
  v_smfmac_f32_16x16x64_bf16 v[36:39], v[32:35], a[32:39], v3
  s_nop 1
  v_cvt_pk_bf16_f32 v76, v12, v13
  v_smfmac_f32_16x16x64_bf16 v[36:39], v[24:27], a[40:47], v3
  v_cvt_pk_bf16_f32 v77, v14, v15
  v_smfmac_f32_16x16x64_bf16 v[36:39], v[28:31], a[48:55], v3
  v_cvt_pk_bf16_f32 v56, v56, v57
  v_smfmac_f32_16x16x64_bf16 v[40:43], v[32:35], a[88:95], v3
  v_cvt_pk_bf16_f32 v57, v58, v59
  v_smfmac_f32_16x16x64_bf16 v[40:43], v[24:27], a[96:103], v3
  v_mfma_f32_16x16x32_bf16 v[16:19], v[54:57], v[4:7], 0
  v_cvt_pk_bf16_f32 v39, v38, v39
  v_smfmac_f32_16x16x64_bf16 v[40:43], v[28:31], a[104:111], v3
  v_cvt_pk_bf16_f32 v38, v36, v37
  v_smfmac_f32_16x16x64_bf16 v[44:47], v[32:35], a[144:151], v3
  s_nop 1
  v_cvt_pk_bf16_f32 v78, v16, v17
  v_smfmac_f32_16x16x64_bf16 v[44:47], v[24:27], a[152:159], v3
  v_cvt_pk_bf16_f32 v79, v18, v19
  v_smfmac_f32_16x16x64_bf16 v[44:47], v[28:31], a[160:167], v3
  v_cvt_pk_bf16_f32 v40, v40, v41
  v_smfmac_f32_16x16x64_bf16 v[48:51], v[32:35], a[200:207], v3
  v_cvt_pk_bf16_f32 v41, v42, v43
  v_smfmac_f32_16x16x64_bf16 v[48:51], v[24:27], a[208:215], v3
  v_smfmac_f32_16x16x64_bf16 v[48:51], v[28:31], a[216:223], v3
  s_waitcnt vmcnt(4)
  v_cvt_pk_bf16_f32 v47, v46, v47
  v_smfmac_f32_16x16x64_bf16 v[68:71], v[76:79], v[80:87], v3
  v_cvt_pk_bf16_f32 v46, v44, v45
  v_mfma_f32_16x16x32_bf16 v[12:15], v[38:41], v[4:7], 0
  s_nop 1
  v_cvt_pk_bf16_f32 v48, v48, v49
  v_cvt_pk_bf16_f32 v49, v50, v51
  s_nop 1
  v_mfma_f32_16x16x32_bf16 v[16:19], v[46:49], v[4:7], 0
  v_smfmac_f32_16x16x64_bf16 v[72:75], v[76:79], v[88:95], v3
  v_cvt_pk_bf16_f32 v20, v12, v13
  v_mfma_f32_16x16x32_bf16 v[52:55], v[30:33], v[76:79], 0
  s_waitcnt vmcnt(0)
  v_cvt_pk_bf16_f32 v21, v14, v15
  v_cvt_pk_bf16_f32 v22, v16, v17
  v_cvt_pk_bf16_f32 v23, v18, v19
  s_nop 1
  v_mfma_f32_16x16x32_bf16 v[52:55], v[8:11], v[20:23], v[52:55]
  v_smfmac_f32_16x16x64_bf16 v[68:71], v[20:23], v[96:103], v3
  v_smfmac_f32_16x16x64_bf16 v[72:75], v[20:23], v[104:111], v3
  s_nop 1
  ds_write_b128 v113, v[52:55]
  s_nop 1
  v_permlane32_swap_b32 v68, v70
  v_permlane32_swap_b32 v69, v71
  v_add_f32 v56, v68, v70
  v_add_f32 v58, v69, v71
  v_permlane32_swap_b32 v72, v74
  v_permlane32_swap_b32 v73, v75
  v_add_f32 v57, v72, v74
  v_add_f32 v59, v73, v75
  ds_write_b128 v2, v[56:59] offset:0
  v_cmp_u_f32 vcc, v57, v59
  v_mov_b32 v68, 0
  v_mov_b32 v69, 0
  v_mov_b32 v70, 0
  v_mov_b32 v71, 0
  s_cbranch_vccnz cA_sc0_retry
cA_sc0_cont:
  s_add_u32 s24, s24, 28672
  s_add_u32 s26, s26, 28672
  buffer_load_dwordx4 v[80:83], v117, s[8:11], s24 offen offset:0 sc1
  buffer_load_dwordx4 v[84:87], v117, s[8:11], s24 offen offset:1024 sc1
  v_mfma_f32_32x32x16_bf16 v[36:51], v[68:71], v[68:71], 0
  s_waitcnt lgkmcnt(0)
  s_barrier
  ds_read_b64 v[8:9], v114 offset:0
  ds_read_b64 v[10:11], v114 offset:1024
  ds_read_b64 v[12:13], v114 offset:2048
  ds_read_b64 v[14:15], v114 offset:3072
  ds_read2_b32 v[16:17], v115 offset0:0 offset1:64
  ds_read2_b32 v[18:19], v115 offset0:128 offset1:192
  v_mfma_f32_32x32x16_bf16 v[52:67], v[68:71], v[68:71], 0
  s_waitcnt lgkmcnt(0)
  v_pk_add_f32 v[16:17], v[16:17], v[18:19]
  v_pk_add_f32 v[8:9], v[8:9], v[10:11]
  v_pk_add_f32 v[12:13], v[12:13], v[14:15]
  v_add_f32 v20, v16, v17
  v_pk_add_f32 v[8:9], v[8:9], v[12:13]
  v_max_f32 v22, v8, v9
  v_add_f32_dpp v20, v20, v20 row_ror:8 row_mask:0xf bank_mask:0xf
  s_nop 0
  v_max_f32_dpp v22, v22, v22 row_ror:8 row_mask:0xf bank_mask:0xf
  v_max_f32 v22, v22, v20
  s_nop 1
  v_max_f32_dpp v22, v22, v22 quad_perm:[1,0,3,2] row_mask:0xf bank_mask:0xf
  s_nop 1
  v_max_f32_dpp v22, v22, v22 quad_perm:[2,3,0,1] row_mask:0xf bank_mask:0xf
  s_nop 1
  v_max_f32_dpp v22, v22, v22 row_half_mirror row_mask:0xf bank_mask:0xf
  v_pk_add_f32 v[8:9], v[8:9], v[22:23] op_sel_hi:[1,0] neg_lo:[0,1] neg_hi:[0,1]
  v_sub_f32 v20, v20, v22
  v_exp_f32 v8, v8
  v_exp_f32 v9, v9
  v_exp_f32 v20, v20
  v_add_f32 v24, v8, v9
  v_fmac_f32 v24, 0.5, v20
  v_mov_b32_dpp v21, v20 quad_perm:[1,0,3,2] row_mask:0xf bank_mask:0xf
  s_nop 0
  v_add_f32_dpp v24, v24, v24 quad_perm:[1,0,3,2] row_mask:0xf bank_mask:0xf
  s_nop 1
  v_add_f32_dpp v24, v24, v24 quad_perm:[2,3,0,1] row_mask:0xf bank_mask:0xf
  s_nop 1
  v_add_f32_dpp v24, v24, v24 row_half_mirror row_mask:0xf bank_mask:0xf
  s_nop 1
  v_add_f32_dpp v24, v24, v24 row_ror:8 row_mask:0xf bank_mask:0xf
  v_rcp_f32 v24, v24
  s_nop 0
  v_pk_mul_f32 v[8:9], v[8:9], v[24:25] op_sel_hi:[1,0]
  v_cvt_pk_bf16_f32 v8, abs(v8), abs(v9)
  buffer_store_dword v8, v1, s[8:11], s20 offen
  v_pk_mul_f32 v[20:21], v[20:21], v[24:25] op_sel_hi:[1,0]
  v_cvt_pk_bf16_f32 v20, abs(v20), abs(v21)
  buffer_store_dword v20, v118, s[8:11], s20 offen
  v_mov_b32 v72, 0
  v_mov_b32 v73, 0
  v_mov_b32 v74, 0
  v_mov_b32 v75, 0
  s_buffer_load_dword s64, s[8:11], s34 offset:0
  s_buffer_load_dword s65, s[8:11], s34 offset:64
  s_buffer_load_dword s66, s[8:11], s34 offset:128
  s_buffer_load_dword s67, s[8:11], s34 offset:192
  s_buffer_load_dword s64, s[8:11], s34 offset:256
  s_buffer_load_dword s65, s[8:11], s34 offset:320
  s_buffer_load_dword s66, s[8:11], s34 offset:384
  s_buffer_load_dword s67, s[8:11], s34 offset:448
  s_buffer_load_dword s64, s[8:11], s34 offset:512
  s_buffer_load_dword s65, s[8:11], s34 offset:576
  s_buffer_load_dword s66, s[8:11], s34 offset:640
  s_buffer_load_dword s67, s[8:11], s34 offset:704
  s_buffer_load_dword s64, s[8:11], s34 offset:768
  s_buffer_load_dword s65, s[8:11], s34 offset:832
  s_mov_b32 s36, s34
  s_add_u32 s34, s33, 458752
  s_mov_b32 s33, s34
  s_mov_b32 s19, s18
  s_add_u32 s18, s18, 1
  s_mov_b32 s22, s20
  s_mov_b32 s20, s21
  s_mov_b32 s21, s22
  s_add_u32 s23, s20, 4096
  s_cmp_lt_u32 s19, 63
  s_cbranch_scc1 cA_sc0_loop
  s_branch cA_done
cA_sc0_r0:
  s_add_u32 s31, s31, 1
  buffer_load_dwordx4 v[8:11], v2, s[8:11], s20 offen offset:0 sc1
  s_waitcnt vmcnt(0)
  v_cmp_eq_u32 vcc, -1, v8
  v_mov_b32 v36, 0
  v_mov_b32 v37, 0
  v_mov_b32 v38, 0
  v_mov_b32 v39, 0
  v_mov_b32 v40, 0
  v_mov_b32 v41, 0
  v_mov_b32 v42, 0
  v_mov_b32 v43, 0
  v_mov_b32 v44, 0
  v_mov_b32 v45, 0
  v_mov_b32 v46, 0
  v_mov_b32 v47, 0
  v_mov_b32 v48, 0
  v_mov_b32 v49, 0
  v_mov_b32 v50, 0
  v_mov_b32 v51, 0
  s_nop 1
  s_cbranch_vccz cA_sc0_go
  s_add_u32 s30, s30, 1
  s_cmp_lt_u32 s30, 400000
  s_cbranch_scc1 cA_sc0_r0
  s_branch cA_abort
cA_sc0_r4:
  s_add_u32 s31, s31, 1
  buffer_load_dwordx4 v[12:15], v2, s[8:11], s20 offen offset:1024 sc1
  buffer_load_dwordx4 v[16:19], v2, s[8:11], s20 offen offset:2048 sc1
  buffer_load_dwordx4 v[20:23], v2, s[8:11], s20 offen offset:3072 sc1
  buffer_load_dwordx4 v[32:35], v2, s[8:11], s23 offen offset:0 sc1
  buffer_load_dwordx4 v[24:27], v2, s[8:11], s23 offen offset:1024 sc1
  buffer_load_dwordx4 v[28:31], v2, s[8:11], s23 offen offset:2048 sc1
  s_waitcnt vmcnt(0)
  v_max3_u32 v66, v12, v16, v20
  v_max3_u32 v66, v66, v24, v27
  v_max3_u32 v66, v66, v28, v31
  v_max3_u32 v66, v66, v32, v35
  v_cmp_eq_u32 vcc, -1, v66
  s_nop 4
  s_cbranch_vccz cA_sc0_rz
  s_add_u32 s30, s30, 1
  s_cmp_lt_u32 s30, 400000
  s_cbranch_scc1 cA_sc0_r4
  s_branch cA_abort
cA_sc0_retry:
  s_cmp_lg_u32 s62, 0
  s_cbranch_scc1 cA_sc0_cont
  s_waitcnt vmcnt(0) lgkmcnt(0)
cA_sc0_rv:
  buffer_load_dwordx4 v[8:11], v2, s[8:11], s20 offen offset:0 sc1
  buffer_load_dwordx4 v[12:15], v2, s[8:11], s20 offen offset:1024 sc1
  buffer_load_dwordx4 v[16:19], v2, s[8:11], s20 offen offset:2048 sc1
  buffer_load_dwordx4 v[20:23], v2, s[8:11], s20 offen offset:3072 sc1
  buffer_load_dwordx4 v[32:35], v2, s[8:11], s23 offen offset:0 sc1
  buffer_load_dwordx4 v[24:27], v2, s[8:11], s23 offen offset:1024 sc1
  buffer_load_dwordx4 v[28:31], v2, s[8:11], s23 offen offset:2048 sc1
  s_waitcnt vmcnt(0)
  v_max3_u32 v66, v8, v9, v10
  v_max3_u32 v66, v66, v11, v12
  v_max3_u32 v66, v66, v13, v14
  v_max3_u32 v66, v66, v15, v16
  v_max3_u32 v66, v66, v17, v18
  v_max3_u32 v66, v66, v19, v20
  v_max3_u32 v66, v66, v21, v22
  v_max3_u32 v66, v66, v23, v24
  v_max3_u32 v66, v66, v25, v26
  v_max3_u32 v66, v66, v27, v28
  v_max3_u32 v66, v66, v29, v30
  v_max3_u32 v66, v66, v31, v32
  v_max3_u32 v66, v66, v33, v34
  v_max_u32 v66, v66, v35
  v_cmp_eq_u32 vcc, -1, v66
  s_cbranch_vccz cA_sc0_rk
  s_add_u32 s30, s30, 1
  s_cmp_lt_u32 s30, 400000
  s_cbranch_scc1 cA_sc0_rv
  s_branch cA_abort
cA_sc0_rk:
  s_mov_b32 s62, 1
  s_add_u32 s31, s31, 0x100
cA_sc0_rz:
  v_mov_b32 v36, 0
  v_mov_b32 v37, 0
  v_mov_b32 v38, 0
  v_mov_b32 v39, 0
  v_mov_b32 v40, 0
  v_mov_b32 v41, 0
  v_mov_b32 v42, 0
  v_mov_b32 v43, 0
  v_mov_b32 v44, 0
  v_mov_b32 v45, 0
  v_mov_b32 v46, 0
  v_mov_b32 v47, 0
  v_mov_b32 v48, 0
  v_mov_b32 v49, 0
  v_mov_b32 v50, 0
  v_mov_b32 v51, 0
  v_mov_b32 v60, 0
  v_mov_b32 v61, 0
  v_mov_b32 v62, 0
  v_mov_b32 v63, 0
  v_mov_b32 v68, 0
  v_mov_b32 v69, 0
  v_mov_b32 v70, 0
  v_mov_b32 v71, 0
  v_mov_b32 v72, 0
  v_mov_b32 v73, 0
  v_mov_b32 v74, 0
  v_mov_b32 v75, 0
  v_mov_b32 v52, 0
  v_mov_b32 v53, 0
  v_mov_b32 v54, 0
  v_mov_b32 v55, 0
  v_mov_b32 v56, 0
  v_mov_b32 v57, 0
  v_mov_b32 v58, 0
  v_mov_b32 v59, 0
  s_nop 1
  s_branch cA_sc0_go
.p2align 6
cA_sc1_loop:
  s_mov_b32 s30, 0
  s_mov_b32 s62, 0
  s_setprio 3
  s_barrier
  buffer_load_dwordx4 v[12:15], v2, s[8:11], s20 offen offset:1024 sc1
  s_setprio 2
  buffer_load_dwordx4 v[16:19], v2, s[8:11], s20 offen offset:2048 sc1
  s_setprio 1
  buffer_load_dwordx4 v[20:23], v2, s[8:11], s20 offen offset:3072 sc1
  s_setprio 0
  buffer_load_dwordx4 v[8:11], v2, s[8:11], s20 offen offset:0 sc1
cA_sc1_go:
  s_waitcnt vmcnt(3)
  v_smfmac_f32_16x16x64_bf16 v[36:39], v[12:15], a[8:15], v3
  buffer_load_dwordx4 v[24:27], v2, s[8:11], s23 offen offset:1024 sc1
  v_cmp_eq_u32 vcc, -1, v12
  v_smfmac_f32_16x16x64_bf16 v[40:43], v[12:15], a[64:71], v3
  v_smfmac_f32_16x16x64_bf16 v[44:47], v[12:15], a[120:127], v3
  buffer_load_dwordx4 v[32:35], v2, s[8:11], s23 offen offset:2048 sc1
  s_cbranch_vccnz cA_sc1_r0
  v_smfmac_f32_16x16x64_bf16 v[48:51], v[12:15], a[176:183], v3
  v_smfmac_f32_16x16x64_bf16 v[52:55], v[12:15], a[232:239], v3
  v_smfmac_f32_16x16x64_bf16 v[56:59], v[12:15], v[152:159], v3
  buffer_load_dwordx4 v[28:31], v2, s[8:11], s23 offen offset:0 sc1
  v_smfmac_f32_16x16x64_bf16 v[60:63], v[12:15], v[208:215], v3
  s_waitcnt vmcnt(5)
  v_smfmac_f32_16x16x64_bf16 v[36:39], v[16:19], a[16:23], v3
  v_smfmac_f32_16x16x64_bf16 v[40:43], v[16:19], a[72:79], v3
  v_smfmac_f32_16x16x64_bf16 v[44:47], v[16:19], a[128:135], v3
  v_smfmac_f32_16x16x64_bf16 v[48:51], v[16:19], a[184:191], v3
  v_smfmac_f32_16x16x64_bf16 v[52:55], v[16:19], a[240:247], v3
  v_smfmac_f32_16x16x64_bf16 v[56:59], v[16:19], v[160:167], v3
  buffer_load_dwordx4 v[88:91], v117, s[8:11], s26 offen offset:0 sc1
  v_smfmac_f32_16x16x64_bf16 v[60:63], v[16:19], v[216:223], v3
  s_waitcnt vmcnt(5)
  v_smfmac_f32_16x16x64_bf16 v[36:39], v[20:23], a[24:31], v3
  v_smfmac_f32_16x16x64_bf16 v[40:43], v[20:23], a[80:87], v3
  v_smfmac_f32_16x16x64_bf16 v[44:47], v[20:23], a[136:143], v3
  buffer_load_dwordx4 v[92:95], v117, s[8:11], s26 offen offset:1024 sc1
  v_smfmac_f32_16x16x64_bf16 v[48:51], v[20:23], a[192:199], v3
  v_smfmac_f32_16x16x64_bf16 v[52:55], v[20:23], a[248:255], v3
  v_smfmac_f32_16x16x64_bf16 v[56:59], v[20:23], v[168:175], v3
  v_smfmac_f32_16x16x64_bf16 v[60:63], v[20:23], v[224:231], v3
  s_waitcnt vmcnt(5)
  buffer_load_dwordx4 v[96:99], v2, s[8:11], s24 offen offset:0 sc1
  v_smfmac_f32_16x16x64_bf16 v[36:39], v[8:11], a[0:7], v3
  v_smfmac_f32_16x16x64_bf16 v[40:43], v[8:11], a[56:63], v3
  v_max3_u32 v66, v16, v20, v8
  v_smfmac_f32_16x16x64_bf16 v[44:47], v[8:11], a[112:119], v3
  v_smfmac_f32_16x16x64_bf16 v[48:51], v[8:11], a[168:175], v3
  buffer_load_dwordx4 v[100:103], v2, s[8:11], s24 offen offset:1024 sc1
  v_smfmac_f32_16x16x64_bf16 v[52:55], v[8:11], a[224:231], v3
  v_smfmac_f32_16x16x64_bf16 v[56:59], v[8:11], v[144:151], v3
  v_smfmac_f32_16x16x64_bf16 v[60:63], v[8:11], v[200:207], v3
  s_waitcnt vmcnt(4)
  v_smfmac_f32_16x16x64_bf16 v[60:63], v[28:31], v[232:239], v3
  buffer_load_dwordx4 v[104:107], v2, s[8:11], s26 offen offset:0 sc1
  v_max3_u32 v66, v66, v24, v27
  v_smfmac_f32_16x16x64_bf16 v[60:63], v[24:27], v[240:247], v3
  v_max3_u32 v66, v66, v28, v31
  v_smfmac_f32_16x16x64_bf16 v[60:63], v[32:35], v[248:255], v3
  v_max3_u32 v66, v66, v32, v35
  v_smfmac_f32_16x16x64_bf16 v[52:55], v[28:31], v[120:127], v3
  v_cmp_eq_u32 vcc, -1, v66
  v_smfmac_f32_16x16x64_bf16 v[52:55], v[24:27], v[128:135], v3
  buffer_load_dwordx4 v[108:111], v2, s[8:11], s26 offen offset:1024 sc1
  v_smfmac_f32_16x16x64_bf16 v[52:55], v[32:35], v[136:143], v3
  s_cbranch_vccnz cA_sc1_r4
  v_cvt_pk_bf16_f32 v63, v62, v63
  v_smfmac_f32_16x16x64_bf16 v[56:59], v[28:31], v[176:183], v3
  v_cvt_pk_bf16_f32 v62, v60, v61
  v_smfmac_f32_16x16x64_bf16 v[56:59], v[24:27], v[184:191], v3
  v_mfma_f32_16x16x32_bf16 v[8:11], v[62:65], v[4:7], 0
  v_cvt_pk_bf16_f32 v55, v54, v55
  v_smfmac_f32_16x16x64_bf16 v[56:59], v[32:35], v[192:199], v3
  v_cvt_pk_bf16_f32 v54, v52, v53
  v_smfmac_f32_16x16x64_bf16 v[36:39], v[28:31], a[32:39], v3
  s_nop 1
  v_cvt_pk_bf16_f32 v78, v8, v9
  v_smfmac_f32_16x16x64_bf16 v[36:39], v[24:27], a[40:47], v3
  v_cvt_pk_bf16_f32 v79, v10, v11
  v_smfmac_f32_16x16x64_bf16 v[36:39], v[32:35], a[48:55], v3
  v_cvt_pk_bf16_f32 v56, v56, v57
  v_smfmac_f32_16x16x64_bf16 v[40:43], v[28:31], a[88:95], v3
  v_cvt_pk_bf16_f32 v57, v58, v59
  v_smfmac_f32_16x16x64_bf16 v[40:43], v[24:27], a[96:103], v3
  v_mfma_f32_16x16x32_bf16 v[16:19], v[54:57], v[4:7], 0
  v_cvt_pk_bf16_f32 v39, v38, v39
  v_smfmac_f32_16x16x64_bf16 v[40:43], v[32:35], a[104:111], v3
  v_cvt_pk_bf16_f32 v38, v36, v37
  v_smfmac_f32_16x16x64_bf16 v[44:47], v[28:31], a[144:151], v3
  s_nop 1
  v_cvt_pk_bf16_f32 v76, v16, v17
  v_smfmac_f32_16x16x64_bf16 v[44:47], v[24:27], a[152:159], v3
  v_cvt_pk_bf16_f32 v77, v18, v19
  v_smfmac_f32_16x16x64_bf16 v[44:47], v[32:35], a[160:167], v3
  v_cvt_pk_bf16_f32 v40, v40, v41
  v_smfmac_f32_16x16x64_bf16 v[48:51], v[28:31], a[200:207], v3
  v_cvt_pk_bf16_f32 v41, v42, v43
  v_smfmac_f32_16x16x64_bf16 v[48:51], v[24:27], a[208:215], v3
  v_smfmac_f32_16x16x64_bf16 v[48:51], v[32:35], a[216:223], v3
  s_waitcnt vmcnt(4)
  v_cvt_pk_bf16_f32 v47, v46, v47
  v_smfmac_f32_16x16x64_bf16 v[68:71], v[76:79], v[80:87], v3
  v_cvt_pk_bf16_f32 v46, v44, v45
  v_mfma_f32_16x16x32_bf16 v[8:11], v[38:41], v[4:7], 0
  s_nop 1
  v_cvt_pk_bf16_f32 v48, v48, v49
  v_cvt_pk_bf16_f32 v49, v50, v51
  s_nop 1
  v_mfma_f32_16x16x32_bf16 v[16:19], v[46:49], v[4:7], 0
  v_smfmac_f32_16x16x64_bf16 v[72:75], v[76:79], v[88:95], v3
  v_cvt_pk_bf16_f32 v20, v8, v9
  v_mfma_f32_16x16x32_bf16 v[52:55], v[30:33], v[76:79], 0
  s_waitcnt vmcnt(0)
  v_cvt_pk_bf16_f32 v21, v10, v11
  v_cvt_pk_bf16_f32 v22, v16, v17
  v_cvt_pk_bf16_f32 v23, v18, v19
  s_nop 1
  v_mfma_f32_16x16x32_bf16 v[52:55], v[12:15], v[20:23], v[52:55]
  v_smfmac_f32_16x16x64_bf16 v[68:71], v[20:23], v[96:103], v3
  v_smfmac_f32_16x16x64_bf16 v[72:75], v[20:23], v[104:111], v3
  s_nop 1
  ds_write_b128 v113, v[52:55]
  s_nop 1
  v_permlane32_swap_b32 v68, v70
  v_permlane32_swap_b32 v69, v71
  v_add_f32 v56, v68, v70
  v_add_f32 v58, v69, v71
  v_permlane32_swap_b32 v72, v74
  v_permlane32_swap_b32 v73, v75
  v_add_f32 v57, v72, v74
  v_add_f32 v59, v73, v75
  ds_write_b128 v2, v[56:59] offset:1024
  v_cmp_u_f32 vcc, v57, v59
  v_mov_b32 v68, 0
  v_mov_b32 v69, 0
  v_mov_b32 v70, 0
  v_mov_b32 v71, 0
  s_cbranch_vccnz cA_sc1_retry
cA_sc1_cont:
  s_add_u32 s24, s24, 28672
  s_add_u32 s26, s26, 28672
  buffer_load_dwordx4 v[80:83], v117, s[8:11], s24 offen offset:0 sc1
  buffer_load_dwordx4 v[84:87], v117, s[8:11], s24 offen offset:1024 sc1
  v_mfma_f32_32x32x16_bf16 v[36:51], v[68:71], v[68:71], 0
  s_waitcnt lgkmcnt(0)
  s_barrier
  ds_read_b64 v[8:9], v114 offset:0
  ds_read_b64 v[10:11], v114 offset:1024
  ds_read_b64 v[12:13], v114 offset:2048
  ds_read_b64 v[14:15], v114 offset:3072
  ds_read2_b32 v[16:17], v115 offset0:0 offset1:64
  ds_read2_b32 v[18:19], v115 offset0:128 offset1:192
  v_mfma_f32_32x32x16_bf16 v[52:67], v[68:71], v[68:71], 0
  s_waitcnt lgkmcnt(0)
  v_pk_add_f32 v[16:17], v[16:17], v[18:19]
  v_pk_add_f32 v[8:9], v[8:9], v[10:11]
  v_pk_add_f32 v[12:13], v[12:13], v[14:15]
  v_add_f32 v20, v16, v17
  v_pk_add_f32 v[8:9], v[8:9], v[12:13]
  v_max_f32 v22, v8, v9
  v_add_f32_dpp v20, v20, v20 row_ror:8 row_mask:0xf bank_mask:0xf
  s_nop 0
  v_max_f32_dpp v22, v22, v22 row_ror:8 row_mask:0xf bank_mask:0xf
  v_max_f32 v22, v22, v20
  s_nop 1
  v_max_f32_dpp v22, v22, v22 quad_perm:[1,0,3,2] row_mask:0xf bank_mask:0xf
  s_nop 1
  v_max_f32_dpp v22, v22, v22 quad_perm:[2,3,0,1] row_mask:0xf bank_mask:0xf
  buffer_store_dword v112, v116, s[8:11], 0 offen
  s_nop 0
  v_max_f32_dpp v22, v22, v22 row_half_mirror row_mask:0xf bank_mask:0xf
  v_pk_add_f32 v[8:9], v[8:9], v[22:23] op_sel_hi:[1,0] neg_lo:[0,1] neg_hi:[0,1]
  v_sub_f32 v20, v20, v22
  v_exp_f32 v8, v8
  v_exp_f32 v9, v9
  v_exp_f32 v20, v20
  v_add_f32 v24, v8, v9
  v_fmac_f32 v24, 0.5, v20
  v_mov_b32_dpp v21, v20 quad_perm:[1,0,3,2] row_mask:0xf bank_mask:0xf
  s_nop 0
  v_add_f32_dpp v24, v24, v24 quad_perm:[1,0,3,2] row_mask:0xf bank_mask:0xf
  s_nop 1
  v_add_f32_dpp v24, v24, v24 quad_perm:[2,3,0,1] row_mask:0xf bank_mask:0xf
  s_nop 1
  v_add_f32_dpp v24, v24, v24 row_half_mirror row_mask:0xf bank_mask:0xf
  s_nop 1
  v_add_f32_dpp v24, v24, v24 row_ror:8 row_mask:0xf bank_mask:0xf
  v_rcp_f32 v24, v24
  s_nop 0
  v_pk_mul_f32 v[8:9], v[8:9], v[24:25] op_sel_hi:[1,0]
  v_cvt_pk_bf16_f32 v8, abs(v8), abs(v9)
  buffer_store_dword v8, v1, s[8:11], s20 offen
  v_pk_mul_f32 v[20:21], v[20:21], v[24:25] op_sel_hi:[1,0]
  v_cvt_pk_bf16_f32 v20, abs(v20), abs(v21)
  buffer_store_dword v20, v118, s[8:11], s20 offen
  v_mov_b32 v72, 0
  v_mov_b32 v73, 0
  v_mov_b32 v74, 0
  v_mov_b32 v75, 0
  s_buffer_load_dword s64, s[8:11], s34 offset:896
  s_buffer_load_dword s65, s[8:11], s34 offset:960
  s_buffer_load_dword s66, s[8:11], s34 offset:1024
  s_buffer_load_dword s67, s[8:11], s34 offset:1088
  s_buffer_load_dword s64, s[8:11], s34 offset:1152
  s_buffer_load_dword s65, s[8:11], s34 offset:1216
  s_buffer_load_dword s66, s[8:11], s34 offset:1280
  s_buffer_load_dword s67, s[8:11], s34 offset:1344
  s_buffer_load_dword s64, s[8:11], s34 offset:1408
  s_buffer_load_dword s65, s[8:11], s34 offset:1472
  s_buffer_load_dword s66, s[8:11], s34 offset:1536
  s_buffer_load_dword s67, s[8:11], s34 offset:1600
  s_buffer_load_dword s64, s[8:11], s34 offset:1664
  s_buffer_load_dword s65, s[8:11], s34 offset:1728
  s_mov_b32 s36, s34
  s_add_u32 s34, s33, 458752
  s_mov_b32 s33, s34
  s_mov_b32 s19, s18
  s_add_u32 s18, s18, 1
  s_mov_b32 s22, s20
  s_mov_b32 s20, s21
  s_mov_b32 s21, s22
  s_add_u32 s23, s20, 4096
  v_mov_b32 v112, s18
  s_cmp_lt_u32 s19, 63
  s_nop 0
  s_cbranch_scc1 cA_sc1_loop
  s_branch cA_done
cA_sc1_r0:
  s_add_u32 s31, s31, 1
  buffer_load_dwordx4 v[12:15], v2, s[8:11], s20 offen offset:1024 sc1
  s_waitcnt vmcnt(0)
  v_cmp_eq_u32 vcc, -1, v12
  v_mov_b32 v36, 0
  v_mov_b32 v37, 0
  v_mov_b32 v38, 0
  v_mov_b32 v39, 0
  v_mov_b32 v40, 0
  v_mov_b32 v41, 0
  v_mov_b32 v42, 0
  v_mov_b32 v43, 0
  v_mov_b32 v44, 0
  v_mov_b32 v45, 0
  v_mov_b32 v46, 0
  v_mov_b32 v47, 0
  v_mov_b32 v48, 0
  v_mov_b32 v49, 0
  v_mov_b32 v50, 0
  v_mov_b32 v51, 0
  s_nop 1
  s_cbranch_vccz cA_sc1_go
  s_add_u32 s30, s30, 1
  s_cmp_lt_u32 s30, 400000
  s_cbranch_scc1 cA_sc1_r0
  s_branch cA_abort
cA_sc1_r4:
  s_add_u32 s31, s31, 1
  buffer_load_dwordx4 v[16:19], v2, s[8:11], s20 offen offset:2048 sc1
  buffer_load_dwordx4 v[20:23], v2, s[8:11], s20 offen offset:3072 sc1
  buffer_load_dwordx4 v[8:11], v2, s[8:11], s20 offen offset:0 sc1
  buffer_load_dwordx4 v[28:31], v2, s[8:11], s23 offen offset:0 sc1
  buffer_load_dwordx4 v[24:27], v2, s[8:11], s23 offen offset:1024 sc1
  buffer_load_dwordx4 v[32:35], v2, s[8:11], s23 offen offset:2048 sc1
  s_waitcnt vmcnt(0)
  v_max3_u32 v66, v16, v20, v8
  v_max3_u32 v66, v66, v24, v27
  v_max3_u32 v66, v66, v28, v31
  v_max3_u32 v66, v66, v32, v35
  v_cmp_eq_u32 vcc, -1, v66
  s_nop 4
  s_cbranch_vccz cA_sc1_rz
  s_add_u32 s30, s30, 1
  s_cmp_lt_u32 s30, 400000
  s_cbranch_scc1 cA_sc1_r4
  s_branch cA_abort
cA_sc1_retry:
  s_cmp_lg_u32 s62, 0
  s_cbranch_scc1 cA_sc1_cont
  s_waitcnt vmcnt(0) lgkmcnt(0)
cA_sc1_rv:
  buffer_load_dwordx4 v[8:11], v2, s[8:11], s20 offen offset:0 sc1
  buffer_load_dwordx4 v[12:15], v2, s[8:11], s20 offen offset:1024 sc1
  buffer_load_dwordx4 v[16:19], v2, s[8:11], s20 offen offset:2048 sc1
  buffer_load_dwordx4 v[20:23], v2, s[8:11], s20 offen offset:3072 sc1
  buffer_load_dwordx4 v[28:31], v2, s[8:11], s23 offen offset:0 sc1
  buffer_load_dwordx4 v[24:27], v2, s[8:11], s23 offen offset:1024 sc1
  buffer_load_dwordx4 v[32:35], v2, s[8:11], s23 offen offset:2048 sc1
  s_waitcnt vmcnt(0)
  v_max3_u32 v66, v8, v9, v10
  v_max3_u32 v66, v66, v11, v12
  v_max3_u32 v66, v66, v13, v14
  v_max3_u32 v66, v66, v15, v16
  v_max3_u32 v66, v66, v17, v18
  v_max3_u32 v66, v66, v19, v20
  v_max3_u32 v66, v66, v21, v22
  v_max3_u32 v66, v66, v23, v24
  v_max3_u32 v66, v66, v25, v26
  v_max3_u32 v66, v66, v27, v28
  v_max3_u32 v66, v66, v29, v30
  v_max3_u32 v66, v66, v31, v32
  v_max3_u32 v66, v66, v33, v34
  v_max_u32 v66, v66, v35
  v_cmp_eq_u32 vcc, -1, v66
  s_cbranch_vccz cA_sc1_rk
  s_add_u32 s30, s30, 1
  s_cmp_lt_u32 s30, 400000
  s_cbranch_scc1 cA_sc1_rv
  s_branch cA_abort
cA_sc1_rk:
  s_mov_b32 s62, 1
  s_add_u32 s31, s31, 0x100
cA_sc1_rz:
  v_mov_b32 v36, 0
  v_mov_b32 v37, 0
  v_mov_b32 v38, 0
  v_mov_b32 v39, 0
  v_mov_b32 v40, 0
  v_mov_b32 v41, 0
  v_mov_b32 v42, 0
  v_mov_b32 v43, 0
  v_mov_b32 v44, 0
  v_mov_b32 v45, 0
  v_mov_b32 v46, 0
  v_mov_b32 v47, 0
  v_mov_b32 v48, 0
  v_mov_b32 v49, 0
  v_mov_b32 v50, 0
  v_mov_b32 v51, 0
  v_mov_b32 v60, 0
  v_mov_b32 v61, 0
  v_mov_b32 v62, 0
  v_mov_b32 v63, 0
  v_mov_b32 v68, 0
  v_mov_b32 v69, 0
  v_mov_b32 v70, 0
  v_mov_b32 v71, 0
  v_mov_b32 v72, 0
  v_mov_b32 v73, 0
  v_mov_b32 v74, 0
  v_mov_b32 v75, 0
  v_mov_b32 v52, 0
  v_mov_b32 v53, 0
  v_mov_b32 v54, 0
  v_mov_b32 v55, 0
  v_mov_b32 v56, 0
  v_mov_b32 v57, 0
  v_mov_b32 v58, 0
  v_mov_b32 v59, 0
  s_nop 1
  s_branch cA_sc1_go
.p2align 6
cA_sc2_loop:
  s_mov_b32 s30, 0
  s_mov_b32 s62, 0
  s_setprio 3
  s_barrier
  buffer_load_dwordx4 v[16:19], v2, s[8:11], s20 offen offset:2048 sc1
  s_setprio 2
  buffer_load_dwordx4 v[20:23], v2, s[8:11], s20 offen offset:3072 sc1
  s_setprio 1
  buffer_load_dwordx4 v[8:11], v2, s[8:11], s20 offen offset:0 sc1
  s_setprio 0
  buffer_load_dwordx4 v[12:15], v2, s[8:11], s20 offen offset:1024 sc1
cA_sc2_go:
  s_waitcnt vmcnt(3)
  v_smfmac_f32_16x16x64_bf16 v[36:39], v[16:19], a[16:23], v3
  buffer_load_dwordx4 v[28:31], v2, s[8:11], s23 offen offset:2048 sc1
  v_cmp_eq_u32 vcc, -1, v16
  v_smfmac_f32_16x16x64_bf16 v[40:43], v[16:19], a[72:79], v3
  v_smfmac_f32_16x16x64_bf16 v[44:47], v[16:19], a[128:135], v3
  buffer_load_dwordx4 v[24:27], v2, s[8:11], s23 offen offset:0 sc1
  s_cbranch_vccnz cA_sc2_r0
  v_smfmac_f32_16x16x64_bf16 v[48:51], v[16:19], a[184:191], v3
  v_smfmac_f32_16x16x64_bf16 v[52:55], v[16:19], a[240:247], v3
  v_smfmac_f32_16x16x64_bf16 v[56:59], v[16:19], v[160:167], v3
  buffer_load_dwordx4 v[32:35], v2, s[8:11], s23 offen offset:1024 sc1
  v_smfmac_f32_16x16x64_bf16 v[62:65], v[16:19], v[216:223], v3
  s_waitcnt vmcnt(5)
  v_smfmac_f32_16x16x64_bf16 v[36:39], v[20:23], a[24:31], v3
  v_smfmac_f32_16x16x64_bf16 v[40:43], v[20:23], a[80:87], v3
  v_smfmac_f32_16x16x64_bf16 v[44:47], v[20:23], a[136:143], v3
  v_smfmac_f32_16x16x64_bf16 v[48:51], v[20:23], a[192:199], v3
  v_smfmac_f32_16x16x64_bf16 v[52:55], v[20:23], a[248:255], v3
  v_smfmac_f32_16x16x64_bf16 v[56:59], v[20:23], v[168:175], v3
  buffer_load_dwordx4 v[88:91], v117, s[8:11], s26 offen offset:0 sc1
  v_smfmac_f32_16x16x64_bf16 v[62:65], v[20:23], v[224:231], v3
  s_waitcnt vmcnt(5)
  v_smfmac_f32_16x16x64_bf16 v[36:39], v[8:11], a[0:7], v3
  v_smfmac_f32_16x16x64_bf16 v[40:43], v[8:11], a[56:63], v3
  v_smfmac_f32_16x16x64_bf16 v[44:47], v[8:11], a[112:119], v3
  buffer_load_dwordx4 v[92:95], v117, s[8:11], s26 offen offset:1024 sc1
  v_smfmac_f32_16x16x64_bf16 v[48:51], v[8:11], a[168:175], v3
  v_smfmac_f32_16x16x64_bf16 v[52:55], v[8:11], a[224:231], v3
  v_smfmac_f32_16x16x64_bf16 v[56:59], v[8:11], v[144:151], v3
  v_smfmac_f32_16x16x64_bf16 v[62:65], v[8:11], v[200:207], v3
  s_waitcnt vmcnt(5)
  buffer_load_dwordx4 v[96:99], v2, s[8:11], s24 offen offset:0 sc1
  v_smfmac_f32_16x16x64_bf16 v[36:39], v[12:15], a[8:15], v3
  v_smfmac_f32_16x16x64_bf16 v[40:43], v[12:15], a[64:71], v3
  v_max3_u32 v66, v20, v8, v12
  v_smfmac_f32_16x16x64_bf16 v[44:47], v[12:15], a[120:127], v3
  v_smfmac_f32_16x16x64_bf16 v[48:51], v[12:15], a[176:183], v3
  buffer_load_dwordx4 v[100:103], v2, s[8:11], s24 offen offset:1024 sc1
  v_smfmac_f32_16x16x64_bf16 v[52:55], v[12:15], a[232:239], v3
  v_smfmac_f32_16x16x64_bf16 v[56:59], v[12:15], v[152:159], v3
  v_smfmac_f32_16x16x64_bf16 v[62:65], v[12:15], v[208:215], v3
  s_waitcnt vmcnt(4)
  v_smfmac_f32_16x16x64_bf16 v[62:65], v[24:27], v[232:239], v3
  buffer_load_dwordx4 v[104:107], v2, s[8:11], s26 offen offset:0 sc1
  v_max3_u32 v66, v66, v24, v27
  v_smfmac_f32_16x16x64_bf16 v[62:65], v[32:35], v[240:247], v3
  v_max3_u32 v66, v66, v28, v31
  v_smfmac_f32_16x16x64_bf16 v[62:65], v[28:31], v[248:255], v3
  v_max3_u32 v66, v66, v32, v35
  v_smfmac_f32_16x16x64_bf16 v[52:55], v[24:27], v[120:127], v3
  v_cmp_eq_u32 vcc, -1, v66
  v_smfmac_f32_16x16x64_bf16 v[52:55], v[32:35], v[128:135], v3
  buffer_load_dwordx4 v[108:111], v2, s[8:11], s26 offen offset:1024 sc1
  v_smfmac_f32_16x16x64_bf16 v[52:55], v[28:31], v[136:143], v3
  s_cbranch_vccnz cA_sc2_r4
  v_cvt_pk_bf16_f32 v62, v62, v63
  v_smfmac_f32_16x16x64_bf16 v[56:59], v[24:27], v[176:183], v3
  v_cvt_pk_bf16_f32 v63, v64, v65
  v_smfmac_f32_16x16x64_bf16 v[56:59], v[32:35], v[184:191], v3
  v_mfma_f32_16x16x32_bf16 v[8:11], v[60:63], v[4:7], 0
  v_cvt_pk_bf16_f32 v55, v54, v55
  v_smfmac_f32_16x16x64_bf16 v[56:59], v[28:31], v[192:199], v3
  v_cvt_pk_bf16_f32 v54, v52, v53
  v_smfmac_f32_16x16x64_bf16 v[36:39], v[24:27], a[32:39], v3
  s_nop 1
  v_cvt_pk_bf16_f32 v76, v8, v9
  v_smfmac_f32_16x16x64_bf16 v[36:39], v[32:35], a[40:47], v3
  v_cvt_pk_bf16_f32 v77, v10, v11
  v_smfmac_f32_16x16x64_bf16 v[36:39], v[28:31], a[48:55], v3
  v_cvt_pk_bf16_f32 v56, v56, v57
  v_smfmac_f32_16x16x64_bf16 v[40:43], v[24:27], a[88:95], v3
  v_cvt_pk_bf16_f32 v57, v58, v59
  v_smfmac_f32_16x16x64_bf16 v[40:43], v[32:35], a[96:103], v3
  v_mfma_f32_16x16x32_bf16 v[12:15], v[54:57], v[4:7], 0
  v_cvt_pk_bf16_f32 v39, v38, v39
  v_smfmac_f32_16x16x64_bf16 v[40:43], v[28:31], a[104:111], v3
  v_cvt_pk_bf16_f32 v38, v36, v37
  v_smfmac_f32_16x16x64_bf16 v[44:47], v[24:27], a[144:151], v3
  s_nop 1
  v_cvt_pk_bf16_f32 v78, v12, v13
  v_smfmac_f32_16x16x64_bf16 v[44:47], v[32:35], a[152:159], v3
  v_cvt_pk_bf16_f32 v79, v14, v15
  v_smfmac_f32_16x16x64_bf16 v[44:47], v[28:31], a[160:167], v3
  v_cvt_pk_bf16_f32 v40, v40, v41
  v_smfmac_f32_16x16x64_bf16 v[48:51], v[24:27], a[200:207], v3
  v_cvt_pk_bf16_f32 v41, v42, v43
  v_smfmac_f32_16x16x64_bf16 v[48:51], v[32:35], a[208:215], v3
  v_smfmac_f32_16x16x64_bf16 v[48:51], v[28:31], a[216:223], v3
  s_waitcnt vmcnt(4)
  v_cvt_pk_bf16_f32 v47, v46, v47
  v_smfmac_f32_16x16x64_bf16 v[68:71], v[76:79], v[80:87], v3
  v_cvt_pk_bf16_f32 v46, v44, v45
  v_mfma_f32_16x16x32_bf16 v[8:11], v[38:41], v[4:7], 0
  s_nop 1
  v_cvt_pk_bf16_f32 v48, v48, v49
  v_cvt_pk_bf16_f32 v49, v50, v51
  s_nop 1
  v_mfma_f32_16x16x32_bf16 v[12:15], v[46:49], v[4:7], 0
  v_smfmac_f32_16x16x64_bf16 v[72:75], v[76:79], v[88:95], v3
  v_cvt_pk_bf16_f32 v20, v8, v9
  v_mfma_f32_16x16x32_bf16 v[52:55], v[30:33], v[76:79], 0
  s_waitcnt vmcnt(0)
  v_cvt_pk_bf16_f32 v21, v10, v11
  v_cvt_pk_bf16_f32 v22, v12, v13
  v_cvt_pk_bf16_f32 v23, v14, v15
  s_nop 1
  v_mfma_f32_16x16x32_bf16 v[52:55], v[16:19], v[20:23], v[52:55]
  v_smfmac_f32_16x16x64_bf16 v[68:71], v[20:23], v[96:103], v3
  v_smfmac_f32_16x16x64_bf16 v[72:75], v[20:23], v[104:111], v3
  s_nop 1
  ds_write_b128 v113, v[52:55]
  s_nop 1
  v_permlane32_swap_b32 v68, v70
  v_permlane32_swap_b32 v69, v71
  v_add_f32 v56, v68, v70
  v_add_f32 v58, v69, v71
  v_permlane32_swap_b32 v72, v74
  v_permlane32_swap_b32 v73, v75
  v_add_f32 v57, v72, v74
  v_add_f32 v59, v73, v75
  ds_write_b128 v2, v[56:59] offset:2048
  v_cmp_u_f32 vcc, v57, v59
  v_mov_b32 v68, 0
  v_mov_b32 v69, 0
  v_mov_b32 v70, 0
  v_mov_b32 v71, 0
  s_cbranch_vccnz cA_sc2_retry
cA_sc2_cont:
  s_add_u32 s24, s24, 28672
  s_add_u32 s26, s26, 28672
  buffer_load_dwordx4 v[80:83], v117, s[8:11], s24 offen offset:0 sc1
  buffer_load_dwordx4 v[84:87], v117, s[8:11], s24 offen offset:1024 sc1
  v_mfma_f32_32x32x16_bf16 v[36:51], v[68:71], v[68:71], 0
  s_waitcnt lgkmcnt(0)
  s_barrier
  v_mfma_f32_32x32x16_bf16 v[52:67], v[68:71], v[68:71], 0
  buffer_store_dwordx2 v[118:119], v114, s[8:11], s21 offen
  buffer_store_dwordx2 v[118:119], v115, s[8:11], s21 offen
  s_buffer_load_dword s70, s[8:11], s35
  s_add_u32 s22, s24, 114688
  s_buffer_load_dword s71, s[8:11], s22
  s_mul_i32 s22, s18, 7168
  s_add_u32 s22, s22, 87040
  s_buffer_load_dword s72, s[8:11], s22
  s_add_u32 s35, s35, 458752
  v_mov_b32 v72, 0
  v_mov_b32 v73, 0
  v_mov_b32 v74, 0
  v_mov_b32 v75, 0
  s_buffer_load_dword s64, s[8:11], s34 offset:1792
  s_buffer_load_dword s65, s[8:11], s34 offset:1856
  s_buffer_load_dword s66, s[8:11], s34 offset:1920
  s_buffer_load_dword s67, s[8:11], s34 offset:1984
  s_buffer_load_dword s64, s[8:11], s34 offset:2048
  s_buffer_load_dword s65, s[8:11], s34 offset:2112
  s_buffer_load_dword s66, s[8:11], s34 offset:2176
  s_buffer_load_dword s67, s[8:11], s34 offset:2240
  s_buffer_load_dword s64, s[8:11], s34 offset:2304
  s_buffer_load_dword s65, s[8:11], s34 offset:2368
  s_buffer_load_dword s66, s[8:11], s34 offset:2432
  s_buffer_load_dword s67, s[8:11], s34 offset:2496
  s_buffer_load_dword s64, s[8:11], s34 offset:2560
  s_buffer_load_dword s65, s[8:11], s34 offset:2624
  s_mov_b32 s36, s34
  s_add_u32 s34, s33, 458752
  s_mov_b32 s33, s34
  s_mov_b32 s19, s18
  s_add_u32 s18, s18, 1
  s_mov_b32 s22, s20
  s_mov_b32 s20, s21
  s_mov_b32 s21, s22
  s_add_u32 s23, s20, 4096
  s_cmp_lt_u32 s19, 63
  s_cbranch_scc1 cA_sc2_loop
  s_branch cA_done
cA_sc2_r0:
  s_add_u32 s31, s31, 1
  buffer_load_dwordx4 v[16:19], v2, s[8:11], s20 offen offset:2048 sc1
  s_waitcnt vmcnt(0)
  v_cmp_eq_u32 vcc, -1, v16
  v_mov_b32 v36, 0
  v_mov_b32 v37, 0
  v_mov_b32 v38, 0
  v_mov_b32 v39, 0
  v_mov_b32 v40, 0
  v_mov_b32 v41, 0
  v_mov_b32 v42, 0
  v_mov_b32 v43, 0
  v_mov_b32 v44, 0
  v_mov_b32 v45, 0
  v_mov_b32 v46, 0
  v_mov_b32 v47, 0
  v_mov_b32 v48, 0
  v_mov_b32 v49, 0
  v_mov_b32 v50, 0
  v_mov_b32 v51, 0
  s_nop 1
  s_cbranch_vccz cA_sc2_go
  s_add_u32 s30, s30, 1
  s_cmp_lt_u32 s30, 400000
  s_cbranch_scc1 cA_sc2_r0
  s_branch cA_abort
cA_sc2_r4:
  s_add_u32 s31, s31, 1
  buffer_load_dwordx4 v[20:23], v2, s[8:11], s20 offen offset:3072 sc1
  buffer_load_dwordx4 v[8:11], v2, s[8:11], s20 offen offset:0 sc1
  buffer_load_dwordx4 v[12:15], v2, s[8:11], s20 offen offset:1024 sc1
  buffer_load_dwordx4 v[24:27], v2, s[8:11], s23 offen offset:0 sc1
  buffer_load_dwordx4 v[32:35], v2, s[8:11], s23 offen offset:1024 sc1
  buffer_load_dwordx4 v[28:31], v2, s[8:11], s23 offen offset:2048 sc1
  s_waitcnt vmcnt(0)
  v_max3_u32 v66, v20, v8, v12
  v_max3_u32 v66, v66, v24, v27
  v_max3_u32 v66, v66, v28, v31
  v_max3_u32 v66, v66, v32, v35
  v_cmp_eq_u32 vcc, -1, v66
  s_nop 4
  s_cbranch_vccz cA_sc2_rz
  s_add_u32 s30, s30, 1
  s_cmp_lt_u32 s30, 400000
  s_cbranch_scc1 cA_sc2_r4
  s_branch cA_abort
cA_sc2_retry:
  s_cmp_lg_u32 s62, 0
  s_cbranch_scc1 cA_sc2_cont
  s_waitcnt vmcnt(0) lgkmcnt(0)
cA_sc2_rv:
  buffer_load_dwordx4 v[8:11], v2, s[8:11], s20 offen offset:0 sc1
  buffer_load_dwordx4 v[12:15], v2, s[8:11], s20 offen offset:1024 sc1
  buffer_load_dwordx4 v[16:19], v2, s[8:11], s20 offen offset:2048 sc1
  buffer_load_dwordx4 v[20:23], v2, s[8:11], s20 offen offset:3072 sc1
  buffer_load_dwordx4 v[24:27], v2, s[8:11], s23 offen offset:0 sc1
  buffer_load_dwordx4 v[32:35], v2, s[8:11], s23 offen offset:1024 sc1
  buffer_load_dwordx4 v[28:31], v2, s[8:11], s23 offen offset:2048 sc1
  s_waitcnt vmcnt(0)
  v_max3_u32 v66, v8, v9, v10
  v_max3_u32 v66, v66, v11, v12
  v_max3_u32 v66, v66, v13, v14
  v_max3_u32 v66, v66, v15, v16
  v_max3_u32 v66, v66, v17, v18
  v_max3_u32 v66, v66, v19, v20
  v_max3_u32 v66, v66, v21, v22
  v_max3_u32 v66, v66, v23, v24
  v_max3_u32 v66, v66, v25, v26
  v_max3_u32 v66, v66, v27, v28
  v_max3_u32 v66, v66, v29, v30
  v_max3_u32 v66, v66, v31, v32
  v_max3_u32 v66, v66, v33, v34
  v_max_u32 v66, v66, v35
  v_cmp_eq_u32 vcc, -1, v66
  s_cbranch_vccz cA_sc2_rk
  s_add_u32 s30, s30, 1
  s_cmp_lt_u32 s30, 400000
  s_cbranch_scc1 cA_sc2_rv
  s_branch cA_abort
cA_sc2_rk:
  s_mov_b32 s62, 1
  s_add_u32 s31, s31, 0x100
cA_sc2_rz:
  v_mov_b32 v36, 0
  v_mov_b32 v37, 0
  v_mov_b32 v38, 0
  v_mov_b32 v39, 0
  v_mov_b32 v40, 0
  v_mov_b32 v41, 0
  v_mov_b32 v42, 0
  v_mov_b32 v43, 0
  v_mov_b32 v44, 0
  v_mov_b32 v45, 0
  v_mov_b32 v46, 0
  v_mov_b32 v47, 0
  v_mov_b32 v48, 0
  v_mov_b32 v49, 0
  v_mov_b32 v50, 0
  v_mov_b32 v51, 0
  v_mov_b32 v62, 0
  v_mov_b32 v63, 0
  v_mov_b32 v64, 0
  v_mov_b32 v65, 0
  v_mov_b32 v68, 0
  v_mov_b32 v69, 0
  v_mov_b32 v70, 0
  v_mov_b32 v71, 0
  v_mov_b32 v72, 0
  v_mov_b32 v73, 0
  v_mov_b32 v74, 0
  v_mov_b32 v75, 0
  v_mov_b32 v52, 0
  v_mov_b32 v53, 0
  v_mov_b32 v54, 0
  v_mov_b32 v55, 0
  v_mov_b32 v56, 0
  v_mov_b32 v57, 0
  v_mov_b32 v58, 0
  v_mov_b32 v59, 0
  s_nop 1
  s_branch cA_sc2_go
.p2align 6
cA_sc3_loop:
  s_mov_b32 s30, 0
  s_mov_b32 s62, 0
  s_setprio 3
  s_barrier
  buffer_load_dwordx4 v[20:23], v2, s[8:11], s20 offen offset:3072 sc1
  s_setprio 2
  buffer_load_dwordx4 v[8:11], v2, s[8:11], s20 offen offset:0 sc1
  s_setprio 1
  buffer_load_dwordx4 v[12:15], v2, s[8:11], s20 offen offset:1024 sc1
  s_setprio 0
  buffer_load_dwordx4 v[16:19], v2, s[8:11], s20 offen offset:2048 sc1
cA_sc3_go:
  s_waitcnt vmcnt(3)
  v_smfmac_f32_16x16x64_bf16 v[36:39], v[20:23], a[24:31], v3
  buffer_load_dwordx4 v[24:27], v2, s[8:11], s23 offen offset:0 sc1
  v_cmp_eq_u32 vcc, -1, v20
  v_smfmac_f32_16x16x64_bf16 v[40:43], v[20:23], a[80:87], v3
  v_smfmac_f32_16x16x64_bf16 v[44:47], v[20:23], a[136:143], v3
  buffer_load_dwordx4 v[28:31], v2, s[8:11], s23 offen offset:1024 sc1
  s_cbranch_vccnz cA_sc3_r0
  v_smfmac_f32_16x16x64_bf16 v[48:51], v[20:23], a[192:199], v3
  v_smfmac_f32_16x16x64_bf16 v[52:55], v[20:23], a[248:255], v3
  v_smfmac_f32_16x16x64_bf16 v[56:59], v[20:23], v[168:175], v3
  buffer_load_dwordx4 v[32:35], v2, s[8:11], s23 offen offset:2048 sc1
  v_smfmac_f32_16x16x64_bf16 v[62:65], v[20:23], v[224:231], v3
  s_waitcnt vmcnt(5)
  v_smfmac_f32_16x16x64_bf16 v[36:39], v[8:11], a[0:7], v3
  v_smfmac_f32_16x16x64_bf16 v[40:43], v[8:11], a[56:63], v3
  v_smfmac_f32_16x16x64_bf16 v[44:47], v[8:11], a[112:119], v3
  v_smfmac_f32_16x16x64_bf16 v[48:51], v[8:11], a[168:175], v3
  v_smfmac_f32_16x16x64_bf16 v[52:55], v[8:11], a[224:231], v3
  v_smfmac_f32_16x16x64_bf16 v[56:59], v[8:11], v[144:151], v3
  buffer_load_dwordx4 v[88:91], v117, s[8:11], s26 offen offset:0 sc1
  v_smfmac_f32_16x16x64_bf16 v[62:65], v[8:11], v[200:207], v3
  s_waitcnt vmcnt(5)
  v_smfmac_f32_16x16x64_bf16 v[36:39], v[12:15], a[8:15], v3
  v_smfmac_f32_16x16x64_bf16 v[40:43], v[12:15], a[64:71], v3
  v_smfmac_f32_16x16x64_bf16 v[44:47], v[12:15], a[120:127], v3
  buffer_load_dwordx4 v[92:95], v117, s[8:11], s26 offen offset:1024 sc1
  v_smfmac_f32_16x16x64_bf16 v[48:51], v[12:15], a[176:183], v3
  v_smfmac_f32_16x16x64_bf16 v[52:55], v[12:15], a[232:239], v3
  v_smfmac_f32_16x16x64_bf16 v[56:59], v[12:15], v[152:159], v3
  v_smfmac_f32_16x16x64_bf16 v[62:65], v[12:15], v[208:215], v3
  s_waitcnt vmcnt(5)
  buffer_load_dwordx4 v[96:99], v2, s[8:11], s24 offen offset:0 sc1
  v_smfmac_f32_16x16x64_bf16 v[36:39], v[16:19], a[16:23], v3
  v_smfmac_f32_16x16x64_bf16 v[40:43], v[16:19], a[72:79], v3
  v_max3_u32 v66, v8, v12, v16
  v_smfmac_f32_16x16x64_bf16 v[44:47], v[16:19], a[128:135], v3
  v_smfmac_f32_16x16x64_bf16 v[48:51], v[16:19], a[184:191], v3
  buffer_load_dwordx4 v[100:103], v2, s[8:11], s24 offen offset:1024 sc1
  v_smfmac_f32_16x16x64_bf16 v[52:55], v[16:19], a[240:247], v3
  v_smfmac_f32_16x16x64_bf16 v[56:59], v[16:19], v[160:167], v3
  v_smfmac_f32_16x16x64_bf16 v[62:65], v[16:19], v[216:223], v3
  s_waitcnt vmcnt(4)
  v_smfmac_f32_16x16x64_bf16 v[62:65], v[24:27], v[232:239], v3
  buffer_load_dwordx4 v[104:107], v2, s[8:11], s26 offen offset:0 sc1
  v_max3_u32 v66, v66, v24, v27
  v_smfmac_f32_16x16x64_bf16 v[62:65], v[28:31], v[240:247], v3
  v_max3_u32 v66, v66, v28, v31
  v_smfmac_f32_16x16x64_bf16 v[62:65], v[32:35], v[248:255], v3
  v_max3_u32 v66, v66, v32, v35
  v_smfmac_f32_16x16x64_bf16 v[52:55], v[24:27], v[120:127], v3
  v_cmp_eq_u32 vcc, -1, v66
  v_smfmac_f32_16x16x64_bf16 v[52:55], v[28:31], v[128:135], v3
  buffer_load_dwordx4 v[108:111], v2, s[8:11], s26 offen offset:1024 sc1
  v_smfmac_f32_16x16x64_bf16 v[52:55], v[32:35], v[136:143], v3
  s_cbranch_vccnz cA_sc3_r4
  v_cvt_pk_bf16_f32 v62, v62, v63
  v_smfmac_f32_16x16x64_bf16 v[56:59], v[24:27], v[176:183], v3
  v_cvt_pk_bf16_f32 v63, v64, v65
  v_smfmac_f32_16x16x64_bf16 v[56:59], v[28:31], v[184:191], v3
  v_mfma_f32_16x16x32_bf16 v[8:11], v[60:63], v[4:7], 0
  v_cvt_pk_bf16_f32 v55, v54, v55
  v_smfmac_f32_16x16x64_bf16 v[56:59], v[32:35], v[192:199], v3
  v_cvt_pk_bf16_f32 v54, v52, v53
  v_smfmac_f32_16x16x64_bf16 v[36:39], v[24:27], a[32:39], v3
  s_nop 1
  v_cvt_pk_bf16_f32 v78, v8, v9
  v_smfmac_f32_16x16x64_bf16 v[36:39], v[28:31], a[40:47], v3
  v_cvt_pk_bf16_f32 v79, v10, v11
  v_smfmac_f32_16x16x64_bf16 v[36:39], v[32:35], a[48:55], v3
  v_cvt_pk_bf16_f32 v56, v56, v57
  v_smfmac_f32_16x16x64_bf16 v[40:43], v[24:27], a[88:95], v3
  v_cvt_pk_bf16_f32 v57, v58, v59
  v_smfmac_f32_16x16x64_bf16 v[40:43], v[28:31], a[96:103], v3
  v_mfma_f32_16x16x32_bf16 v[12:15], v[54:57], v[4:7], 0
  v_cvt_pk_bf16_f32 v39, v38, v39
  v_smfmac_f32_16x16x64_bf16 v[40:43], v[32:35], a[104:111], v3
  v_cvt_pk_bf16_f32 v38, v36, v37
  v_smfmac_f32_16x16x64_bf16 v[44:47], v[24:27], a[144:151], v3
  s_nop 1
  v_cvt_pk_bf16_f32 v76, v12, v13
  v_smfmac_f32_16x16x64_bf16 v[44:47], v[28:31], a[152:159], v3
  v_cvt_pk_bf16_f32 v77, v14, v15
  v_smfmac_f32_16x16x64_bf16 v[44:47], v[32:35], a[160:167], v3
  v_cvt_pk_bf16_f32 v40, v40, v41
  v_smfmac_f32_16x16x64_bf16 v[48:51], v[24:27], a[200:207], v3
  v_cvt_pk_bf16_f32 v41, v42, v43
  v_smfmac_f32_16x16x64_bf16 v[48:51], v[28:31], a[208:215], v3
  v_smfmac_f32_16x16x64_bf16 v[48:51], v[32:35], a[216:223], v3
  s_waitcnt vmcnt(4)
  v_cvt_pk_bf16_f32 v47, v46, v47
  v_smfmac_f32_16x16x64_bf16 v[68:71], v[76:79], v[80:87], v3
  v_cvt_pk_bf16_f32 v46, v44, v45
  v_mfma_f32_16x16x32_bf16 v[8:11], v[38:41], v[4:7], 0
  s_nop 1
  v_cvt_pk_bf16_f32 v48, v48, v49
  v_cvt_pk_bf16_f32 v49, v50, v51
  s_nop 1
  v_mfma_f32_16x16x32_bf16 v[12:15], v[46:49], v[4:7], 0
  v_smfmac_f32_16x16x64_bf16 v[72:75], v[76:79], v[88:95], v3
  v_cvt_pk_bf16_f32 v16, v8, v9
  v_mfma_f32_16x16x32_bf16 v[52:55], v[30:33], v[76:79], 0
  s_waitcnt vmcnt(0)
  v_cvt_pk_bf16_f32 v17, v10, v11
  v_cvt_pk_bf16_f32 v18, v12, v13
  v_cvt_pk_bf16_f32 v19, v14, v15
  s_nop 1
  v_mfma_f32_16x16x32_bf16 v[52:55], v[20:23], v[16:19], v[52:55]
  v_smfmac_f32_16x16x64_bf16 v[68:71], v[16:19], v[96:103], v3
  v_smfmac_f32_16x16x64_bf16 v[72:75], v[16:19], v[104:111], v3
  s_nop 1
  ds_write_b128 v113, v[52:55]
  s_nop 1
  v_permlane32_swap_b32 v68, v70
  v_permlane32_swap_b32 v69, v71
  v_add_f32 v56, v68, v70
  v_add_f32 v58, v69, v71
  v_permlane32_swap_b32 v72, v74
  v_permlane32_swap_b32 v73, v75
  v_add_f32 v57, v72, v74
  v_add_f32 v59, v73, v75
  ds_write_b128 v2, v[56:59] offset:3072
  v_cmp_u_f32 vcc, v57, v59
  v_mov_b32 v68, 0
  v_mov_b32 v69, 0
  v_mov_b32 v70, 0
  v_mov_b32 v71, 0
  s_cbranch_vccnz cA_sc3_retry
cA_sc3_cont:
  s_add_u32 s24, s24, 28672
  s_add_u32 s26, s26, 28672
  buffer_load_dwordx4 v[80:83], v117, s[8:11], s24 offen offset:0 sc1
  buffer_load_dwordx4 v[84:87], v117, s[8:11], s24 offen offset:1024 sc1
  v_mfma_f32_16x16x32_bf16 v[62:65], v[68:71], v[68:71], 0
  s_waitcnt lgkmcnt(0)
  s_barrier
  v_mov_b32 v52, 0
  v_mov_b32 v53, 0
  v_mov_b32 v54, 0
  v_mov_b32 v55, 0
  v_mov_b32 v56, 0
  v_mov_b32 v57, 0
  v_mov_b32 v58, 0
  v_mov_b32 v59, 0
  v_mfma_f32_32x32x16_bf16 v[36:51], v[68:71], v[68:71], 0
  v_mov_b32 v72, 0
  v_mov_b32 v73, 0
  v_mov_b32 v74, 0
  v_mov_b32 v75, 0
  s_buffer_load_dword s64, s[8:11], s34 offset:2688
  s_buffer_load_dword s65, s[8:11], s34 offset:2752
  s_buffer_load_dword s66, s[8:11], s34 offset:2816
  s_buffer_load_dword s67, s[8:11], s34 offset:2880
  s_buffer_load_dword s64, s[8:11], s34 offset:2944
  s_buffer_load_dword s65, s[8:11], s34 offset:3008
  s_buffer_load_dword s66, s[8:11], s34 offset:3072
  s_buffer_load_dword s67, s[8:11], s34 offset:3136
  s_buffer_load_dword s64, s[8:11], s34 offset:3200
  s_buffer_load_dword s65, s[8:11], s34 offset:3264
  s_buffer_load_dword s66, s[8:11], s34 offset:3328
  s_buffer_load_dword s67, s[8:11], s34 offset:3392
  s_buffer_load_dword s64, s[8:11], s34 offset:3456
  s_buffer_load_dword s65, s[8:11], s34 offset:3520
  s_mov_b32 s36, s34
  s_add_u32 s34, s33, 458752
  s_mov_b32 s33, s34
  s_mov_b32 s19, s18
  s_add_u32 s18, s18, 1
  s_mov_b32 s22, s20
  s_mov_b32 s20, s21
  s_mov_b32 s21, s22
  s_add_u32 s23, s20, 4096
  s_cmp_lt_u32 s19, 63
  s_cbranch_scc1 cA_sc3_loop
  s_branch cA_done
cA_sc3_r0:
  s_add_u32 s31, s31, 1
  buffer_load_dwordx4 v[20:23], v2, s[8:11], s20 offen offset:3072 sc1
  s_waitcnt vmcnt(0)
  v_cmp_eq_u32 vcc, -1, v20
  v_mov_b32 v36, 0
  v_mov_b32 v37, 0
  v_mov_b32 v38, 0
  v_mov_b32 v39, 0
  v_mov_b32 v40, 0
  v_mov_b32 v41, 0
  v_mov_b32 v42, 0
  v_mov_b32 v43, 0
  v_mov_b32 v44, 0
  v_mov_b32 v45, 0
  v_mov_b32 v46, 0
  v_mov_b32 v47, 0
  v_mov_b32 v48, 0
  v_mov_b32 v49, 0
  v_mov_b32 v50, 0
  v_mov_b32 v51, 0
  s_nop 1
  s_cbranch_vccz cA_sc3_go
  s_add_u32 s30, s30, 1
  s_cmp_lt_u32 s30, 400000
  s_cbranch_scc1 cA_sc3_r0
  s_branch cA_abort
cA_sc3_r4:
  s_add_u32 s31, s31, 1
  buffer_load_dwordx4 v[8:11], v2, s[8:11], s20 offen offset:0 sc1
  buffer_load_dwordx4 v[12:15], v2, s[8:11], s20 offen offset:1024 sc1
  buffer_load_dwordx4 v[16:19], v2, s[8:11], s20 offen offset:2048 sc1
  buffer_load_dwordx4 v[24:27], v2, s[8:11], s23 offen offset:0 sc1
  buffer_load_dwordx4 v[28:31], v2, s[8:11], s23 offen offset:1024 sc1
  buffer_load_dwordx4 v[32:35], v2, s[8:11], s23 offen offset:2048 sc1
  s_waitcnt vmcnt(0)
  v_max3_u32 v66, v8, v12, v16
  v_max3_u32 v66, v66, v24, v27
  v_max3_u32 v66, v66, v28, v31
  v_max3_u32 v66, v66, v32, v35
  v_cmp_eq_u32 vcc, -1, v66
  s_nop 4
  s_cbranch_vccz cA_sc3_rz
  s_add_u32 s30, s30, 1
  s_cmp_lt_u32 s30, 400000
  s_cbranch_scc1 cA_sc3_r4
  s_branch cA_abort
cA_sc3_retry:
  s_cmp_lg_u32 s62, 0
  s_cbranch_scc1 cA_sc3_cont
  s_waitcnt vmcnt(0) lgkmcnt(0)
cA_sc3_rv:
  buffer_load_dwordx4 v[8:11], v2, s[8:11], s20 offen offset:0 sc1
  buffer_load_dwordx4 v[12:15], v2, s[8:11], s20 offen offset:1024 sc1
  buffer_load_dwordx4 v[16:19], v2, s[8:11], s20 offen offset:2048 sc1
  buffer_load_dwordx4 v[20:23], v2, s[8:11], s20 offen offset:3072 sc1
  buffer_load_dwordx4 v[24:27], v2, s[8:11], s23 offen offset:0 sc1
  buffer_load_dwordx4 v[28:31], v2, s[8:11], s23 offen offset:1024 sc1
  buffer_load_dwordx4 v[32:35], v2, s[8:11], s23 offen offset:2048 sc1
  s_waitcnt vmcnt(0)
  v_max3_u32 v66, v8, v9, v10
  v_max3_u32 v66, v66, v11, v12
  v_max3_u32 v66, v66, v13, v14
  v_max3_u32 v66, v66, v15, v16
  v_max3_u32 v66, v66, v17, v18
  v_max3_u32 v66, v66, v19, v20
  v_max3_u32 v66, v66, v21, v22
  v_max3_u32 v66, v66, v23, v24
  v_max3_u32 v66, v66, v25, v26
  v_max3_u32 v66, v66, v27, v28
  v_max3_u32 v66, v66, v29, v30
  v_max3_u32 v66, v66, v31, v32
  v_max3_u32 v66, v66, v33, v34
  v_max_u32 v66, v66, v35
  v_cmp_eq_u32 vcc, -1, v66
  s_cbranch_vccz cA_sc3_rk
  s_add_u32 s30, s30, 1
  s_cmp_lt_u32 s30, 400000
  s_cbranch_scc1 cA_sc3_rv
  s_branch cA_abort
cA_sc3_rk:
  s_mov_b32 s62, 1
  s_add_u32 s31, s31, 0x100
cA_sc3_rz:
  v_mov_b32 v36, 0
  v_mov_b32 v37, 0
  v_mov_b32 v38, 0
  v_mov_b32 v39, 0
  v_mov_b32 v40, 0
  v_mov_b32 v41, 0
  v_mov_b32 v42, 0
  v_mov_b32 v43, 0
  v_mov_b32 v44, 0
  v_mov_b32 v45, 0
  v_mov_b32 v46, 0
  v_mov_b32 v47, 0
  v_mov_b32 v48, 0
  v_mov_b32 v49, 0
  v_mov_b32 v50, 0
  v_mov_b32 v51, 0
  v_mov_b32 v62, 0
  v_mov_b32 v63, 0
  v_mov_b32 v64, 0
  v_mov_b32 v65, 0
  v_mov_b32 v68, 0
  v_mov_b32 v69, 0
  v_mov_b32 v70, 0
  v_mov_b32 v71, 0
  v_mov_b32 v72, 0
  v_mov_b32 v73, 0
  v_mov_b32 v74, 0
  v_mov_b32 v75, 0
  v_mov_b32 v52, 0
  v_mov_b32 v53, 0
  v_mov_b32 v54, 0
  v_mov_b32 v55, 0
  v_mov_b32 v56, 0
  v_mov_b32 v57, 0
  v_mov_b32 v58, 0
  v_mov_b32 v59, 0
  s_nop 1
  s_branch cA_sc3_go
.p2align 6
cA_va0_loop:
  s_mov_b32 s30, 0
  s_barrier
  buffer_load_dwordx4 v[24:27], v2, s[8:11], s23 offen offset:0 sc1
  buffer_load_dwordx4 v[28:31], v2, s[8:11], s23 offen offset:1024 sc1
  s_barrier
  s_cmp_lt_u32 s19, 60
  s_cbranch_scc1 cA_va0_m1
  buffer_store_dword v160, v1, s[8:11], s38 offen sc1
  s_cmp_lg_u32 s19, 63
  s_cbranch_scc1 cA_va0_m2
  v_min_u32 v64, -2, v64
  v_min_u32 v65, -2, v65
  v_min_u32 v66, -2, v66
  v_min_u32 v67, -2, v67
  v_min_u32 v68, -2, v68
  v_min_u32 v69, -2, v69
  v_min_u32 v70, -2, v70
  v_min_u32 v71, -2, v71
  v_min_u32 v72, -2, v72
  v_min_u32 v73, -2, v73
  v_min_u32 v74, -2, v74
  v_min_u32 v75, -2, v75
  v_min_u32 v76, -2, v76
  v_min_u32 v77, -2, v77
  v_min_u32 v78, -2, v78
  v_min_u32 v79, -2, v79
  buffer_store_dwordx4 v[64:67], v2, s[8:11], s33 offen offset:0 sc1
  buffer_store_dwordx4 v[68:71], v2, s[8:11], s33 offen offset:2048 sc1
  s_add_u32 s33, s33, 4096
  buffer_store_dwordx4 v[72:75], v2, s[8:11], s33 offen offset:0 sc1
  buffer_store_dwordx4 v[76:79], v2, s[8:11], s33 offen offset:2048 sc1
  s_add_u32 s33, s33, 4096
  s_waitcnt vmcnt(5)
  s_branch cA_va0_m3
cA_va0_m1:
  buffer_store_dword v160, v1, s[8:11], s38 offen nt
cA_va0_m2:
  s_add_u32 s22, s25, s80
  buffer_load_dwordx4 v[80:83], v6, s[8:11], s22 offen offset:0 sc1
  buffer_load_dwordx4 v[84:87], v6, s[8:11], s22 offen offset:1792 sc1
  s_add_u32 s22, s22, 3584
  buffer_load_dwordx4 v[88:91], v6, s[8:11], s22 offen offset:0 sc1
  buffer_load_dwordx4 v[92:95], v6, s[8:11], s22 offen offset:1792 sc1
  s_add_u32 s22, s25, s81
  buffer_load_dwordx4 v[96:99], v6, s[8:11], s22 offen offset:0 sc1
  s_mul_i32 s38, s18, 7168
  s_add_u32 s38, s38, 65536
  s_waitcnt vmcnt(6)
cA_va0_m3:
  ds_write_b128 v2, v[24:27] offset:12288
  ds_write_b128 v2, v[28:31] offset:13312
  v_smfmac_f32_16x16x64_bf16 v[36:39], v[24:27], a[32:39], v3
  buffer_load_dwordx4 v[100:103], v6, s[8:11], s22 offen offset:1792 sc1
  v_smfmac_f32_16x16x64_bf16 v[40:43], v[24:27], a[88:95], v3
  s_add_u32 s22, s22, 3584
  buffer_load_dwordx4 v[104:107], v6, s[8:11], s22 offen offset:0 sc1
  v_smfmac_f32_16x16x64_bf16 v[44:47], v[24:27], a[144:151], v3
  buffer_load_dwordx4 v[108:111], v6, s[8:11], s22 offen offset:1792 sc1
  v_smfmac_f32_16x16x64_bf16 v[48:51], v[24:27], a[200:207], v3
  s_add_u32 s22, s25, s82
  buffer_load_dwordx4 v[112:115], v6, s[8:11], s22 offen offset:0 sc1
  v_smfmac_f32_16x16x64_bf16 v[52:55], v[24:27], v[176:183], v3
  s_waitcnt lgkmcnt(0)
  s_barrier
  ds_read_b128 v[8:11], v2 offset:8192
  ds_read_b128 v[12:15], v2 offset:9216
  ds_read_b128 v[16:19], v2 offset:10240
  ds_read_b128 v[20:23], v2 offset:11264
  ds_read_b128 v[32:35], v2 offset:14336
  buffer_load_dwordx4 v[116:119], v6, s[8:11], s22 offen offset:1792 sc1
  v_smfmac_f32_16x16x64_bf16 v[56:59], v[24:27], v[232:239], v3
  s_add_u32 s22, s22, 3584
  buffer_load_dwordx4 v[120:123], v6, s[8:11], s22 offen offset:0 sc1
  v_smfmac_f32_16x16x64_bf16 v[36:39], v[28:31], a[40:47], v3
  buffer_load_dwordx4 v[124:127], v6, s[8:11], s22 offen offset:1792 sc1
  v_smfmac_f32_16x16x64_bf16 v[40:43], v[28:31], a[96:103], v3
  s_add_u32 s22, s25, s83
  buffer_load_dwordx4 v[128:131], v6, s[8:11], s22 offen offset:0 sc1
  v_smfmac_f32_16x16x64_bf16 v[44:47], v[28:31], a[152:159], v3
  buffer_load_dwordx4 v[132:135], v6, s[8:11], s22 offen offset:1792 sc1
  v_smfmac_f32_16x16x64_bf16 v[48:51], v[28:31], a[208:215], v3
  s_add_u32 s22, s22, 3584
  buffer_load_dwordx4 v[136:139], v6, s[8:11], s22 offen offset:0 sc1
  v_smfmac_f32_16x16x64_bf16 v[52:55], v[28:31], v[184:191], v3
  buffer_load_dwordx4 v[140:143], v6, s[8:11], s22 offen offset:1792 sc1
  v_smfmac_f32_16x16x64_bf16 v[56:59], v[28:31], v[240:247], v3
  s_waitcnt lgkmcnt(4)
  v_smfmac_f32_16x16x64_bf16 v[36:39], v[8:11], a[0:7], v3
  s_waitcnt lgkmcnt(3)
  v_smfmac_f32_16x16x64_bf16 v[36:39], v[12:15], a[8:15], v3
  s_waitcnt lgkmcnt(2)
  v_smfmac_f32_16x16x64_bf16 v[36:39], v[16:19], a[16:23], v3
  s_waitcnt lgkmcnt(1)
  v_smfmac_f32_16x16x64_bf16 v[36:39], v[20:23], a[24:31], v3
  s_waitcnt lgkmcnt(0)
  v_smfmac_f32_16x16x64_bf16 v[36:39], v[32:35], a[48:55], v3
  v_smfmac_f32_16x16x64_bf16 v[40:43], v[8:11], a[56:63], v3
  v_smfmac_f32_16x16x64_bf16 v[40:43], v[12:15], a[64:71], v3
  v_smfmac_f32_16x16x64_bf16 v[40:43], v[16:19], a[72:79], v3
  v_permlane32_swap_b32 v36, v38
  v_smfmac_f32_16x16x64_bf16 v[40:43], v[20:23], a[80:87], v3
  v_permlane32_swap_b32 v37, v39
  v_smfmac_f32_16x16x64_bf16 v[40:43], v[32:35], a[104:111], v3
  v_add_f32 v36, v36, v38
  v_smfmac_f32_16x16x64_bf16 v[44:47], v[8:11], a[112:119], v3
  v_add_f32 v37, v37, v39
  v_smfmac_f32_16x16x64_bf16 v[44:47], v[12:15], a[120:127], v3
  v_cmp_u_f32 vcc, v36, v37
  v_smfmac_f32_16x16x64_bf16 v[44:47], v[16:19], a[128:135], v3
  v_cvt_pk_bf16_f32 v38, v36, v37
  v_smfmac_f32_16x16x64_bf16 v[44:47], v[20:23], a[136:143], v3
  ds_write_b32 v152, v38
  s_cbranch_vccnz cA_va0_slow
  v_permlane32_swap_b32 v40, v42
  v_smfmac_f32_16x16x64_bf16 v[44:47], v[32:35], a[160:167], v3
  v_permlane32_swap_b32 v41, v43
  v_smfmac_f32_16x16x64_bf16 v[48:51], v[8:11], a[168:175], v3
  buffer_store_dword v162, v1, s[8:11], s21 offen
  v_add_f32 v40, v40, v42
  v_smfmac_f32_16x16x64_bf16 v[48:51], v[12:15], a[176:183], v3
  v_add_f32 v41, v41, v43
  v_smfmac_f32_16x16x64_bf16 v[48:51], v[16:19], a[184:191], v3
  buffer_load_dword v164, v4, s[8:11], 0 offen sc1
  v_cvt_pk_bf16_f32 v42, v40, v41
  v_smfmac_f32_16x16x64_bf16 v[48:51], v[20:23], a[192:199], v3
  ds_write_b32 v153, v42
  v_permlane32_swap_b32 v44, v46
  v_smfmac_f32_16x16x64_bf16 v[48:51], v[32:35], a[216:223], v3
  v_permlane32_swap_b32 v45, v47
  v_smfmac_f32_16x16x64_bf16 v[52:55], v[8:11], a[224:231], v3
  buffer_load_dword v164, v4, s[8:11], 0 offen sc1
  v_add_f32 v44, v44, v46
  v_smfmac_f32_16x16x64_bf16 v[52:55], v[12:15], a[232:239], v3
  v_add_f32 v45, v45, v47
  v_smfmac_f32_16x16x64_bf16 v[52:55], v[16:19], a[240:247], v3
  v_cvt_pk_bf16_f32 v46, v44, v45
  v_smfmac_f32_16x16x64_bf16 v[52:55], v[20:23], a[248:255], v3
  ds_write_b32 v154, v46
  buffer_load_dword v164, v4, s[8:11], 0 offen sc1
  v_permlane32_swap_b32 v48, v50
  v_smfmac_f32_16x16x64_bf16 v[52:55], v[32:35], v[192:199], v3
  v_permlane32_swap_b32 v49, v51
  v_smfmac_f32_16x16x64_bf16 v[56:59], v[8:11], v[200:207], v3
  v_add_f32 v48, v48, v50
  v_smfmac_f32_16x16x64_bf16 v[56:59], v[12:15], v[208:215], v3
  buffer_load_dword v164, v4, s[8:11], 0 offen sc1
  v_add_f32 v49, v49, v51
  v_smfmac_f32_16x16x64_bf16 v[56:59], v[16:19], v[216:223], v3
  v_cvt_pk_bf16_f32 v50, v48, v49
  v_smfmac_f32_16x16x64_bf16 v[56:59], v[20:23], v[224:231], v3
  ds_write_b32 v155, v50
  v_permlane32_swap_b32 v52, v54
  v_smfmac_f32_16x16x64_bf16 v[56:59], v[32:35], v[248:255], v3
  buffer_load_dword v164, v4, s[8:11], 0 offen sc1
  v_permlane32_swap_b32 v53, v55
  v_add_f32 v52, v52, v54
  v_add_f32 v53, v53, v55
  v_cvt_pk_bf16_f32 v54, v52, v53
  ds_write_b32 v156, v54
  s_nop 1
  v_permlane32_swap_b32 v56, v58
  v_permlane32_swap_b32 v57, v59
  v_add_f32 v56, v56, v58
  v_add_f32 v57, v57, v59
  v_cvt_pk_bf16_f32 v58, v56, v57
  ds_write_b32 v157, v58
cA_va0_t2d:
  s_add_u32 s72, s20, s76
  s_add_u32 s73, s20, s77
  s_add_u32 s74, s20, s78
  s_add_u32 s75, s20, s79
  s_add_u32 s22, s20, 9216
  s_add_u32 s34, s20, 13312
  s_add_u32 s36, s20, 7168
  s_mov_b32 s37, 0
  v_mov_b32 v48, 0
  v_mov_b32 v49, 0
  v_mov_b32 v50, 0
  v_mov_b32 v51, 0
  v_mov_b32 v163, s18
  s_cmp_eq_u32 s19, 63
  s_waitcnt lgkmcnt(0)
  s_cbranch_scc1 cA_va0_last
  s_setprio 3
cA_va0_fw_l:
  v_cmp_gt_u32 vcc, s18, v164
  buffer_load_dword v164, v4, s[8:11], 0 offen sc1
  s_cbranch_vccz cA_va0_fw_d
  v_cmp_gt_u32 vcc, s18, v164
  buffer_load_dword v164, v4, s[8:11], 0 offen sc1
  s_cbranch_vccz cA_va0_fw_d
  v_cmp_gt_u32 vcc, s18, v164
  buffer_load_dword v164, v4, s[8:11], 0 offen sc1
  s_cbranch_vccz cA_va0_fw_d
  v_cmp_gt_u32 vcc, s18, v164
  buffer_load_dword v164, v4, s[8:11], 0 offen sc1
  s_cbranch_vccz cA_va0_fw_d
  v_cmp_gt_u32 vcc, s18, v164
  buffer_load_dword v164, v4, s[8:11], 0 offen sc1
  s_cbranch_vccz cA_va0_fw_d
  v_cmp_gt_u32 vcc, s18, v164
  buffer_load_dword v164, v4, s[8:11], 0 offen sc1
  s_cbranch_vccz cA_va0_fw_d
  v_cmp_gt_u32 vcc, s18, v164
  buffer_load_dword v164, v4, s[8:11], 0 offen sc1
  s_cbranch_vccz cA_va0_fw_d
  v_cmp_gt_u32 vcc, s18, v164
  buffer_load_dword v164, v4, s[8:11], 0 offen sc1
  s_cbranch_vccz cA_va0_fw_d
  v_cmp_gt_u32 vcc, s18, v164
  buffer_load_dword v164, v4, s[8:11], 0 offen sc1
  s_cbranch_vccz cA_va0_fw_d
  v_cmp_gt_u32 vcc, s18, v164
  buffer_load_dword v164, v4, s[8:11], 0 offen sc1
  s_cbranch_vccz cA_va0_fw_d
  v_cmp_gt_u32 vcc, s18, v164
  buffer_load_dword v164, v4, s[8:11], 0 offen sc1
  s_cbranch_vccz cA_va0_fw_d
  v_cmp_gt_u32 vcc, s18, v164
  buffer_load_dword v164, v4, s[8:11], 0 offen sc1
  s_cbranch_vccz cA_va0_fw_d
  v_cmp_gt_u32 vcc, s18, v164
  buffer_load_dword v164, v4, s[8:11], 0 offen sc1
  s_cbranch_vccz cA_va0_fw_d
  v_cmp_gt_u32 vcc, s18, v164
  buffer_load_dword v164, v4, s[8:11], 0 offen sc1
  s_cbranch_vccz cA_va0_fw_d
  v_cmp_gt_u32 vcc, s18, v164
  buffer_load_dword v164, v4, s[8:11], 0 offen sc1
  s_cbranch_vccz cA_va0_fw_d
  v_cmp_gt_u32 vcc, s18, v164
  buffer_load_dword v164, v4, s[8:11], 0 offen sc1
  s_cbranch_vccz cA_va0_fw_d
  s_waitcnt vmcnt(24)
  s_add_u32 s30, s30, 1
  s_cmp_lt_u32 s30, 400000
  s_cbranch_scc1 cA_va0_fw_l
  s_branch cA_abort
cA_va0_fw_d:
  buffer_load_dwordx4 v[8:11], v2, s[8:11], s72 offen offset:0 sc1
  buffer_load_dwordx4 v[12:15], v2, s[8:11], s72 offen offset:1024 sc1
  buffer_load_dwordx4 v[16:19], v2, s[8:11], s73 offen offset:0 sc1
  buffer_load_dwordx4 v[20:23], v2, s[8:11], s73 offen offset:1024 sc1
  buffer_load_dwordx4 v[24:27], v2, s[8:11], s74 offen offset:0 sc1
  buffer_load_dwordx4 v[28:31], v2, s[8:11], s74 offen offset:1024 sc1
  buffer_load_dwordx4 v[32:35], v2, s[8:11], s75 offen offset:0 sc1
  buffer_load_dwordx4 v[36:39], v2, s[8:11], s75 offen offset:1024 sc1
  buffer_load_dwordx4 v[40:43], v2, s[8:11], s36 offen offset:0 sc1
  buffer_load_dwordx4 v[44:47], v2, s[8:11], s36 offen offset:1024 sc1
  s_barrier
  ds_read_b128 v[64:67], v2 offset:0
  ds_read_b128 v[68:71], v2 offset:1024
  ds_read_b128 v[72:75], v2 offset:2048
  ds_read_b128 v[76:79], v2 offset:3072
cA_va0_lp:
  s_waitcnt vmcnt(9)
  v_smfmac_f32_16x16x64_bf16 v[48:51], v[8:11], v[80:87], v3
  s_waitcnt vmcnt(8)
  v_smfmac_f32_16x16x64_bf16 v[48:51], v[12:15], v[88:95], v3
  s_waitcnt vmcnt(7)
  v_smfmac_f32_16x16x64_bf16 v[48:51], v[16:19], v[96:103], v3
  s_waitcnt vmcnt(6)
  v_smfmac_f32_16x16x64_bf16 v[48:51], v[20:23], v[104:111], v3
  s_waitcnt vmcnt(5)
  v_smfmac_f32_16x16x64_bf16 v[48:51], v[24:27], v[112:119], v3
  s_waitcnt vmcnt(4)
  v_smfmac_f32_16x16x64_bf16 v[48:51], v[28:31], v[120:127], v3
  s_waitcnt vmcnt(3)
  v_smfmac_f32_16x16x64_bf16 v[48:51], v[32:35], v[128:135], v3
  s_waitcnt vmcnt(2)
  v_smfmac_f32_16x16x64_bf16 v[48:51], v[36:39], v[136:143], v3
  s_waitcnt vmcnt(1) lgkmcnt(0)
  v_smfmac_f32_16x16x64_bf16 v[48:51], v[40:43], v[64:71], v3
  s_waitcnt vmcnt(0)
  v_smfmac_f32_16x16x64_bf16 v[48:51], v[44:47], v[72:79], v3
  s_nop 7
  v_permlane32_swap_b32 v48, v50
  v_permlane32_swap_b32 v49, v51
  v_pk_add_f32 v[48:49], v[48:49], v[50:51]
  v_cvt_pk_bf16_f32 v160, v48, v49
  v_cmp_u_f32 vcc, v48, v49
  s_nop 0
  v_mov_b32_dpp v161, v160 quad_perm:[1,0,3,2] row_mask:0xf bank_mask:0xf
  v_perm_b32 v160, v161, v160, v5
  v_cndmask_b32 v161, v160, v162, vcc
  buffer_store_dword v161, v1, s[8:11], s21 offen
  s_cbranch_vccnz cA_va0_rp
cA_va0_cont:
  s_setprio 0
  s_cmp_lg_u32 s19, 62
  s_cbranch_scc1 cA_va0_nl
  s_mov_b32 s25, 0x40000000
cA_va0_nl:
  s_add_u32 s25, s25, 458752
  v_mov_b32 v36, 0
  v_mov_b32 v37, 0
  v_mov_b32 v38, 0
  v_mov_b32 v39, 0
  v_mov_b32 v40, 0
  v_mov_b32 v41, 0
  v_mov_b32 v42, 0
  v_mov_b32 v43, 0
  v_mov_b32 v44, 0
  v_mov_b32 v45, 0
  v_mov_b32 v46, 0
  v_mov_b32 v47, 0
  v_mov_b32 v48, 0
  v_mov_b32 v49, 0
  v_mov_b32 v50, 0
  v_mov_b32 v51, 0
  v_mov_b32 v52, 0
  v_mov_b32 v53, 0
  v_mov_b32 v54, 0
  v_mov_b32 v55, 0
  v_mov_b32 v56, 0
  v_mov_b32 v57, 0
  v_mov_b32 v58, 0
  v_mov_b32 v59, 0
  v_mov_b32 v60, 0
  v_mov_b32 v61, 0
  v_mov_b32 v62, 0
  v_mov_b32 v63, 0
  s_mov_b32 s19, s18
  s_add_u32 s18, s18, 1
  s_mov_b32 s22, s20
  s_mov_b32 s20, s21
  s_mov_b32 s21, s22
  s_add_u32 s23, s20, 4096
  s_branch cA_va0_loop
cA_va0_slow:
  s_waitcnt lgkmcnt(0)
cA_va0_sl1:
  s_add_u32 s31, s31, 0x1000000
  buffer_load_dwordx4 v[8:11], v2, s[8:11], s20 offen offset:0 sc1
  buffer_load_dwordx4 v[12:15], v2, s[8:11], s20 offen offset:1024 sc1
  buffer_load_dwordx4 v[16:19], v2, s[8:11], s20 offen offset:2048 sc1
  buffer_load_dwordx4 v[20:23], v2, s[8:11], s20 offen offset:3072 sc1
  buffer_load_dwordx4 v[24:27], v2, s[8:11], s23 offen offset:0 sc1
  buffer_load_dwordx4 v[28:31], v2, s[8:11], s23 offen offset:1024 sc1
  buffer_load_dwordx4 v[32:35], v2, s[8:11], s23 offen offset:2048 sc1
  s_waitcnt vmcnt(0)
  v_max3_u32 v36, v8, v9, v10
  v_max3_u32 v36, v36, v11, v12
  v_max3_u32 v36, v36, v13, v14
  v_max3_u32 v36, v36, v15, v16
  v_max3_u32 v36, v36, v17, v18
  v_max3_u32 v36, v36, v19, v20
  v_max3_u32 v36, v36, v21, v22
  v_max3_u32 v36, v36, v23, v24
  v_max3_u32 v36, v36, v25, v26
  v_max3_u32 v36, v36, v27, v28
  v_max3_u32 v36, v36, v29, v30
  v_max3_u32 v36, v36, v31, v32
  v_max3_u32 v36, v36, v33, v34
  v_max_u32 v36, v36, v35
  v_cmp_eq_u32 vcc, -1, v36
  s_cbranch_vccz cA_va0_sl2
  s_add_u32 s30, s30, 1
  s_cmp_lt_u32 s30, 400000
  s_cbranch_scc1 cA_va0_sl1
  s_branch cA_abort
cA_va0_sl2:
  v_mov_b32 v36, 0
  v_mov_b32 v37, 0
  v_mov_b32 v38, 0
  v_mov_b32 v39, 0
  v_mov_b32 v40, 0
  v_mov_b32 v41, 0
  v_mov_b32 v42, 0
  v_mov_b32 v43, 0
  v_mov_b32 v44, 0
  v_mov_b32 v45, 0
  v_mov_b32 v46, 0
  v_mov_b32 v47, 0
  v_mov_b32 v48, 0
  v_mov_b32 v49, 0
  v_mov_b32 v50, 0
  v_mov_b32 v51, 0
  v_mov_b32 v52, 0
  v_mov_b32 v53, 0
  v_mov_b32 v54, 0
  v_mov_b32 v55, 0
  v_mov_b32 v56, 0
  v_mov_b32 v57, 0
  v_mov_b32 v58, 0
  v_mov_b32 v59, 0
  v_mov_b32 v60, 0
  v_mov_b32 v61, 0
  v_mov_b32 v62, 0
  v_mov_b32 v63, 0
  buffer_store_dword v162, v1, s[8:11], s21 offen
  v_smfmac_f32_16x16x64_bf16 v[36:39], v[8:11], a[0:7], v3
  v_smfmac_f32_16x16x64_bf16 v[40:43], v[8:11], a[56:63], v3
  v_smfmac_f32_16x16x64_bf16 v[44:47], v[8:11], a[112:119], v3
  v_smfmac_f32_16x16x64_bf16 v[48:51], v[8:11], a[168:175], v3
  v_smfmac_f32_16x16x64_bf16 v[52:55], v[8:11], a[224:231], v3
  v_smfmac_f32_16x16x64_bf16 v[56:59], v[8:11], v[200:207], v3
  v_smfmac_f32_16x16x64_bf16 v[36:39], v[12:15], a[8:15], v3
  v_smfmac_f32_16x16x64_bf16 v[40:43], v[12:15], a[64:71], v3
  v_smfmac_f32_16x16x64_bf16 v[44:47], v[12:15], a[120:127], v3
  v_smfmac_f32_16x16x64_bf16 v[48:51], v[12:15], a[176:183], v3
  v_smfmac_f32_16x16x64_bf16 v[52:55], v[12:15], a[232:239], v3
  v_smfmac_f32_16x16x64_bf16 v[56:59], v[12:15], v[208:215], v3
  v_smfmac_f32_16x16x64_bf16 v[36:39], v[16:19], a[16:23], v3
  v_smfmac_f32_16x16x64_bf16 v[40:43], v[16:19], a[72:79], v3
  v_smfmac_f32_16x16x64_bf16 v[44:47], v[16:19], a[128:135], v3
  v_smfmac_f32_16x16x64_bf16 v[48:51], v[16:19], a[184:191], v3
  v_smfmac_f32_16x16x64_bf16 v[52:55], v[16:19], a[240:247], v3
  v_smfmac_f32_16x16x64_bf16 v[56:59], v[16:19], v[216:223], v3
  v_smfmac_f32_16x16x64_bf16 v[36:39], v[20:23], a[24:31], v3
  v_smfmac_f32_16x16x64_bf16 v[40:43], v[20:23], a[80:87], v3
  v_smfmac_f32_16x16x64_bf16 v[44:47], v[20:23], a[136:143], v3
  v_smfmac_f32_16x16x64_bf16 v[48:51], v[20:23], a[192:199], v3
  v_smfmac_f32_16x16x64_bf16 v[52:55], v[20:23], a[248:255], v3
  v_smfmac_f32_16x16x64_bf16 v[56:59], v[20:23], v[224:231], v3
  v_smfmac_f32_16x16x64_bf16 v[36:39], v[24:27], a[32:39], v3
  v_smfmac_f32_16x16x64_bf16 v[40:43], v[24:27], a[88:95], v3
  v_smfmac_f32_16x16x64_bf16 v[44:47], v[24:27], a[144:151], v3
  v_smfmac_f32_16x16x64_bf16 v[48:51], v[24:27], a[200:207], v3
  v_smfmac_f32_16x16x64_bf16 v[52:55], v[24:27], v[176:183], v3
  v_smfmac_f32_16x16x64_bf16 v[56:59], v[24:27], v[232:239], v3
  v_smfmac_f32_16x16x64_bf16 v[36:39], v[28:31], a[40:47], v3
  v_smfmac_f32_16x16x64_bf16 v[40:43], v[28:31], a[96:103], v3
  v_smfmac_f32_16x16x64_bf16 v[44:47], v[28:31], a[152:159], v3
  v_smfmac_f32_16x16x64_bf16 v[48:51], v[28:31], a[208:215], v3
  v_smfmac_f32_16x16x64_bf16 v[52:55], v[28:31], v[184:191], v3
  v_smfmac_f32_16x16x64_bf16 v[56:59], v[28:31], v[240:247], v3
  v_smfmac_f32_16x16x64_bf16 v[36:39], v[32:35], a[48:55], v3
  v_smfmac_f32_16x16x64_bf16 v[40:43], v[32:35], a[104:111], v3
  v_smfmac_f32_16x16x64_bf16 v[44:47], v[32:35], a[160:167], v3
  v_smfmac_f32_16x16x64_bf16 v[48:51], v[32:35], a[216:223], v3
  v_smfmac_f32_16x16x64_bf16 v[52:55], v[32:35], v[192:199], v3
  v_smfmac_f32_16x16x64_bf16 v[56:59], v[32:35], v[248:255], v3
  v_permlane32_swap_b32 v36, v38
  v_permlane32_swap_b32 v37, v39
  v_add_f32 v36, v36, v38
  v_add_f32 v37, v37, v39
  v_cvt_pk_bf16_f32 v38, v36, v37
  ds_write_b32 v152, v38
  v_permlane32_swap_b32 v40, v42
  v_permlane32_swap_b32 v41, v43
  v_add_f32 v40, v40, v42
  v_add_f32 v41, v41, v43
  v_cvt_pk_bf16_f32 v42, v40, v41
  ds_write_b32 v153, v42
  v_permlane32_swap_b32 v44, v46
  v_permlane32_swap_b32 v45, v47
  v_add_f32 v44, v44, v46
  v_add_f32 v45, v45, v47
  v_cvt_pk_bf16_f32 v46, v44, v45
  ds_write_b32 v154, v46
  v_permlane32_swap_b32 v48, v50
  v_permlane32_swap_b32 v49, v51
  v_add_f32 v48, v48, v50
  v_add_f32 v49, v49, v51
  v_cvt_pk_bf16_f32 v50, v48, v49
  ds_write_b32 v155, v50
  v_permlane32_swap_b32 v52, v54
  v_permlane32_swap_b32 v53, v55
  v_add_f32 v52, v52, v54
  v_add_f32 v53, v53, v55
  v_cvt_pk_bf16_f32 v54, v52, v53
  ds_write_b32 v156, v54
  v_permlane32_swap_b32 v56, v58
  v_permlane32_swap_b32 v57, v59
  v_add_f32 v56, v56, v58
  v_add_f32 v57, v57, v59
  v_cvt_pk_bf16_f32 v58, v56, v57
  ds_write_b32 v157, v58
  buffer_load_dword v164, v4, s[8:11], 0 offen sc1
  buffer_load_dword v164, v4, s[8:11], 0 offen sc1
  buffer_load_dword v164, v4, s[8:11], 0 offen sc1
  buffer_load_dword v164, v4, s[8:11], 0 offen sc1
  buffer_load_dword v164, v4, s[8:11], 0 offen sc1
  s_branch cA_va0_t2d
cA_va0_last:
  s_barrier
  ds_read_b128 v[64:67], v2 offset:0
  ds_read_b128 v[68:71], v2 offset:1024
  ds_read_b128 v[72:75], v2 offset:2048
  ds_read_b128 v[76:79], v2 offset:3072
  s_waitcnt lgkmcnt(0)
  v_min_u32 v64, -2, v64
  v_min_u32 v65, -2, v65
  v_min_u32 v66, -2, v66
  v_min_u32 v67, -2, v67
  v_min_u32 v68, -2, v68
  v_min_u32 v69, -2, v69
  v_min_u32 v70, -2, v70
  v_min_u32 v71, -2, v71
  v_min_u32 v72, -2, v72
  v_min_u32 v73, -2, v73
  v_min_u32 v74, -2, v74
  v_min_u32 v75, -2, v75
  v_min_u32 v76, -2, v76
  v_min_u32 v77, -2, v77
  v_min_u32 v78, -2, v78
  v_min_u32 v79, -2, v79
  buffer_store_dwordx4 v[64:67], v2, s[8:11], s33 offen offset:0 sc1
  buffer_store_dwordx4 v[68:71], v2, s[8:11], s33 offen offset:2048 sc1
  s_add_u32 s33, s33, 4096
  buffer_store_dwordx4 v[72:75], v2, s[8:11], s33 offen offset:0 sc1
  buffer_store_dwordx4 v[76:79], v2, s[8:11], s33 offen offset:2048 sc1
  s_add_u32 s33, s33, 4096
  s_cmp_lg_u32 s17, 0
  s_cbranch_scc1 cA_done
  s_waitcnt vmcnt(0)
  buffer_wbl2 sc1
  s_branch cA_done
cA_va0_rp:
  s_cmp_eq_u32 s37, 0
  s_cbranch_scc1 cA_va0_rv
  v_min_u32 v160, -2, v160
  buffer_store_dword v160, v1, s[8:11], s21 offen
  s_branch cA_va0_cont
cA_va0_rv:
  s_add_u32 s31, s31, 0x10000
  buffer_load_dwordx4 v[8:11], v2, s[8:11], s72 offen offset:0 sc1
  buffer_load_dwordx4 v[12:15], v2, s[8:11], s72 offen offset:1024 sc1
  buffer_load_dwordx4 v[16:19], v2, s[8:11], s73 offen offset:0 sc1
  buffer_load_dwordx4 v[20:23], v2, s[8:11], s73 offen offset:1024 sc1
  buffer_load_dwordx4 v[24:27], v2, s[8:11], s74 offen offset:0 sc1
  buffer_load_dwordx4 v[28:31], v2, s[8:11], s74 offen offset:1024 sc1
  buffer_load_dwordx4 v[32:35], v2, s[8:11], s75 offen offset:0 sc1
  buffer_load_dwordx4 v[36:39], v2, s[8:11], s75 offen offset:1024 sc1
  buffer_load_dwordx4 v[40:43], v2, s[8:11], s36 offen offset:0 sc1
  buffer_load_dwordx4 v[44:47], v2, s[8:11], s36 offen offset:1024 sc1
  s_waitcnt vmcnt(0)
  v_max3_u32 v52, v8, v9, v10
  v_max3_u32 v52, v52, v11, v12
  v_max3_u32 v52, v52, v13, v14
  v_max3_u32 v52, v52, v15, v16
  v_max3_u32 v52, v52, v17, v18
  v_max3_u32 v52, v52, v19, v20
  v_max3_u32 v52, v52, v21, v22
  v_max3_u32 v52, v52, v23, v24
  v_max3_u32 v52, v52, v25, v26
  v_max3_u32 v52, v52, v27, v28
  v_max3_u32 v52, v52, v29, v30
  v_max3_u32 v52, v52, v31, v32
  v_max3_u32 v52, v52, v33, v34
  v_max3_u32 v52, v52, v35, v36
  v_max3_u32 v52, v52, v37, v38
  v_max3_u32 v52, v52, v39, v40
  v_max3_u32 v52, v52, v41, v42
  v_max3_u32 v52, v52, v43, v44
  v_max3_u32 v52, v52, v45, v46
  v_max_u32 v52, v52, v47
  v_cmp_eq_u32 vcc, -1, v52
  s_mov_b32 s37, 1
  v_mov_b32 v48, 0
  v_mov_b32 v49, 0
  v_mov_b32 v50, 0
  v_mov_b32 v51, 0
  s_nop 1
  s_cbranch_vccz cA_va0_lp
  s_add_u32 s30, s30, 1
  s_cmp_lt_u32 s30, 400000
  s_cbranch_scc1 cA_va0_rv
  s_branch cA_abort
.p2align 6
cA_va1_loop:
  s_mov_b32 s30, 0
  s_barrier
  buffer_load_dwordx4 v[28:31], v2, s[8:11], s23 offen offset:1024 sc1
  buffer_load_dwordx4 v[32:35], v2, s[8:11], s23 offen offset:2048 sc1
  s_barrier
  s_cmp_lt_u32 s19, 60
  s_cbranch_scc1 cA_va1_m1
  buffer_store_dword v160, v1, s[8:11], s38 offen sc1
  s_cmp_lg_u32 s19, 63
  s_cbranch_scc1 cA_va1_m2
  v_min_u32 v64, -2, v64
  v_min_u32 v65, -2, v65
  v_min_u32 v66, -2, v66
  v_min_u32 v67, -2, v67
  v_min_u32 v68, -2, v68
  v_min_u32 v69, -2, v69
  v_min_u32 v70, -2, v70
  v_min_u32 v71, -2, v71
  v_min_u32 v72, -2, v72
  v_min_u32 v73, -2, v73
  v_min_u32 v74, -2, v74
  v_min_u32 v75, -2, v75
  v_min_u32 v76, -2, v76
  v_min_u32 v77, -2, v77
  v_min_u32 v78, -2, v78
  v_min_u32 v79, -2, v79
  buffer_store_dwordx4 v[64:67], v2, s[8:11], s33 offen offset:0 sc1
  buffer_store_dwordx4 v[68:71], v2, s[8:11], s33 offen offset:2048 sc1
  s_add_u32 s33, s33, 4096
  buffer_store_dwordx4 v[72:75], v2, s[8:11], s33 offen offset:0 sc1
  buffer_store_dwordx4 v[76:79], v2, s[8:11], s33 offen offset:2048 sc1
  s_add_u32 s33, s33, 4096
  s_waitcnt vmcnt(5)
  s_branch cA_va1_m3
cA_va1_m1:
  buffer_store_dword v160, v1, s[8:11], s38 offen nt
cA_va1_m2:
  s_add_u32 s22, s25, s80
  buffer_load_dwordx4 v[80:83], v6, s[8:11], s22 offen offset:0 sc1
  buffer_load_dwordx4 v[84:87], v6, s[8:11], s22 offen offset:1792 sc1
  s_add_u32 s22, s22, 3584
  buffer_load_dwordx4 v[88:91], v6, s[8:11], s22 offen offset:0 sc1
  buffer_load_dwordx4 v[92:95], v6, s[8:11], s22 offen offset:1792 sc1
  s_add_u32 s22, s25, s81
  buffer_load_dwordx4 v[96:99], v6, s[8:11], s22 offen offset:0 sc1
  s_mul_i32 s38, s18, 7168
  s_add_u32 s38, s38, 65536
  s_waitcnt vmcnt(6)
cA_va1_m3:
  ds_write_b128 v2, v[32:35] offset:14336
  v_smfmac_f32_16x16x64_bf16 v[36:39], v[28:31], a[40:47], v3
  buffer_load_dwordx4 v[100:103], v6, s[8:11], s22 offen offset:1792 sc1
  v_smfmac_f32_16x16x64_bf16 v[40:43], v[28:31], a[96:103], v3
  s_add_u32 s22, s22, 3584
  buffer_load_dwordx4 v[104:107], v6, s[8:11], s22 offen offset:0 sc1
  v_smfmac_f32_16x16x64_bf16 v[44:47], v[28:31], a[152:159], v3
  buffer_load_dwordx4 v[108:111], v6, s[8:11], s22 offen offset:1792 sc1
  v_smfmac_f32_16x16x64_bf16 v[48:51], v[28:31], a[208:215], v3
  s_add_u32 s22, s25, s82
  buffer_load_dwordx4 v[112:115], v6, s[8:11], s22 offen offset:0 sc1
  v_smfmac_f32_16x16x64_bf16 v[52:55], v[28:31], v[184:191], v3
  s_waitcnt lgkmcnt(0)
  s_barrier
  ds_read_b128 v[8:11], v2 offset:8192
  ds_read_b128 v[12:15], v2 offset:9216
  ds_read_b128 v[16:19], v2 offset:10240
  ds_read_b128 v[20:23], v2 offset:11264
  ds_read_b128 v[24:27], v2 offset:12288
  buffer_load_dwordx4 v[116:119], v6, s[8:11], s22 offen offset:1792 sc1
  v_smfmac_f32_16x16x64_bf16 v[56:59], v[28:31], v[240:247], v3
  s_add_u32 s22, s22, 3584
  buffer_load_dwordx4 v[120:123], v6, s[8:11], s22 offen offset:0 sc1
  v_smfmac_f32_16x16x64_bf16 v[36:39], v[32:35], a[48:55], v3
  buffer_load_dwordx4 v[124:127], v6, s[8:11], s22 offen offset:1792 sc1
  v_smfmac_f32_16x16x64_bf16 v[40:43], v[32:35], a[104:111], v3
  s_add_u32 s22, s25, s83
  buffer_load_dwordx4 v[128:131], v6, s[8:11], s22 offen offset:0 sc1
  v_smfmac_f32_16x16x64_bf16 v[44:47], v[32:35], a[160:167], v3
  buffer_load_dwordx4 v[132:135], v6, s[8:11], s22 offen offset:1792 sc1
  v_smfmac_f32_16x16x64_bf16 v[48:51], v[32:35], a[216:223], v3
  s_add_u32 s22, s22, 3584
  buffer_load_dwordx4 v[136:139], v6, s[8:11], s22 offen offset:0 sc1
  v_smfmac_f32_16x16x64_bf16 v[52:55], v[32:35], v[192:199], v3
  ds_read_b128 v[64:67], v0 offset:0
  ds_read_b128 v[68:71], v0 offset:1024
  buffer_load_dwordx4 v[140:143], v6, s[8:11], s22 offen offset:1792 sc1
  v_smfmac_f32_16x16x64_bf16 v[56:59], v[32:35], v[248:255], v3
  s_waitcnt lgkmcnt(6)
  ds_read_b128 v[72:75], v0 offset:2048
  ds_read_b128 v[76:79], v0 offset:3072
  v_smfmac_f32_16x16x64_bf16 v[36:39], v[8:11], a[0:7], v3
  s_waitcnt lgkmcnt(7)
  v_smfmac_f32_16x16x64_bf16 v[36:39], v[12:15], a[8:15], v3
  s_waitcnt lgkmcnt(6)
  v_smfmac_f32_16x16x64_bf16 v[36:39], v[16:19], a[16:23], v3
  s_waitcnt lgkmcnt(2)
  v_smfmac_f32_16x16x64_bf16 v[60:63], v[8:11], v[64:71], v3
  s_waitcnt lgkmcnt(5)
  ds_read_b128 v[144:147], v0 offset:4096
  ds_read_b128 v[148:151], v0 offset:5120
  v_smfmac_f32_16x16x64_bf16 v[36:39], v[20:23], a[24:31], v3
  s_waitcnt lgkmcnt(6)
  v_smfmac_f32_16x16x64_bf16 v[36:39], v[24:27], a[32:39], v3
  v_smfmac_f32_16x16x64_bf16 v[40:43], v[8:11], a[56:63], v3
  s_waitcnt lgkmcnt(2)
  v_smfmac_f32_16x16x64_bf16 v[60:63], v[12:15], v[72:79], v3
  ds_read_b128 v[64:67], v0 offset:6144
  ds_read_b128 v[68:71], v0 offset:7168
  v_smfmac_f32_16x16x64_bf16 v[40:43], v[12:15], a[64:71], v3
  v_permlane32_swap_b32 v36, v38
  v_smfmac_f32_16x16x64_bf16 v[40:43], v[16:19], a[72:79], v3
  v_permlane32_swap_b32 v37, v39
  v_smfmac_f32_16x16x64_bf16 v[40:43], v[20:23], a[80:87], v3
  s_waitcnt lgkmcnt(2)
  v_add_f32 v36, v36, v38
  v_smfmac_f32_16x16x64_bf16 v[60:63], v[16:19], v[144:151], v3
  ds_read_b128 v[72:75], v0 offset:8192
  ds_read_b128 v[76:79], v0 offset:9216
  v_add_f32 v37, v37, v39
  v_smfmac_f32_16x16x64_bf16 v[40:43], v[24:27], a[88:95], v3
  v_cmp_u_f32 vcc, v36, v37
  v_smfmac_f32_16x16x64_bf16 v[44:47], v[8:11], a[112:119], v3
  v_cvt_pk_bf16_f32 v38, v36, v37
  v_smfmac_f32_16x16x64_bf16 v[44:47], v[12:15], a[120:127], v3
  ds_write_b32 v152, v38
  s_waitcnt lgkmcnt(3)
  s_cbranch_vccnz cA_va1_slow
  v_permlane32_swap_b32 v40, v42
  v_smfmac_f32_16x16x64_bf16 v[60:63], v[20:23], v[64:71], v3
  ds_read_b128 v[144:147], v0 offset:10240
  ds_read_b128 v[148:151], v0 offset:11264
  v_permlane32_swap_b32 v41, v43
  v_smfmac_f32_16x16x64_bf16 v[44:47], v[16:19], a[128:135], v3
  buffer_store_dword v162, v1, s[8:11], s21 offen
  v_add_f32 v40, v40, v42
  v_smfmac_f32_16x16x64_bf16 v[44:47], v[20:23], a[136:143], v3
  v_add_f32 v41, v41, v43
  v_smfmac_f32_16x16x64_bf16 v[44:47], v[24:27], a[144:151], v3
  s_waitcnt lgkmcnt(3)
  v_cvt_pk_bf16_f32 v42, v40, v41
  v_smfmac_f32_16x16x64_bf16 v[60:63], v[24:27], v[72:79], v3
  ds_write_b32 v153, v42
  ds_read_b128 v[64:67], v0 offset:12288
  ds_read_b128 v[68:71], v0 offset:13312
  v_smfmac_f32_16x16x64_bf16 v[48:51], v[8:11], a[168:175], v3
  s_nop 0
  v_permlane32_swap_b32 v44, v46
  v_smfmac_f32_16x16x64_bf16 v[48:51], v[12:15], a[176:183], v3
  v_permlane32_swap_b32 v45, v47
  v_smfmac_f32_16x16x64_bf16 v[48:51], v[16:19], a[184:191], v3
  s_waitcnt lgkmcnt(3)
  v_add_f32 v44, v44, v46
  v_smfmac_f32_16x16x64_bf16 v[60:63], v[28:31], v[144:151], v3
  v_add_f32 v45, v45, v47
  v_smfmac_f32_16x16x64_bf16 v[48:51], v[20:23], a[192:199], v3
  v_cvt_pk_bf16_f32 v46, v44, v45
  v_smfmac_f32_16x16x64_bf16 v[48:51], v[24:27], a[200:207], v3
  ds_write_b32 v154, v46
  v_smfmac_f32_16x16x64_bf16 v[52:55], v[8:11], a[224:231], v3
  s_waitcnt lgkmcnt(1)
  v_smfmac_f32_16x16x64_bf16 v[60:63], v[32:35], v[64:71], v3
  v_smfmac_f32_16x16x64_bf16 v[52:55], v[12:15], a[232:239], v3
  v_permlane32_swap_b32 v48, v50
  v_smfmac_f32_16x16x64_bf16 v[52:55], v[16:19], a[240:247], v3
  v_permlane32_swap_b32 v49, v51
  v_smfmac_f32_16x16x64_bf16 v[52:55], v[20:23], a[248:255], v3
  v_add_f32 v48, v48, v50
  v_smfmac_f32_16x16x64_bf16 v[52:55], v[24:27], v[176:183], v3
  v_add_f32 v49, v49, v51
  v_smfmac_f32_16x16x64_bf16 v[56:59], v[8:11], v[200:207], v3
  v_cvt_pk_bf16_f32 v50, v48, v49
  v_smfmac_f32_16x16x64_bf16 v[56:59], v[12:15], v[208:215], v3
  ds_write_b32 v155, v50
  v_permlane32_swap_b32 v60, v62
  v_smfmac_f32_16x16x64_bf16 v[56:59], v[16:19], v[216:223], v3
  v_permlane32_swap_b32 v61, v63
  v_smfmac_f32_16x16x64_bf16 v[56:59], v[20:23], v[224:231], v3
  v_add_f32 v60, v60, v62
  v_smfmac_f32_16x16x64_bf16 v[56:59], v[24:27], v[232:239], v3
  v_add_f32 v61, v61, v63
  v_cvt_pk_bf16_f32 v62, v60, v61
  ds_write_b32 v158, v62
  v_permlane32_swap_b32 v52, v54
  v_permlane32_swap_b32 v53, v55
  v_add_f32 v52, v52, v54
  v_add_f32 v53, v53, v55
  v_cvt_pk_bf16_f32 v54, v52, v53
  ds_write_b32 v156, v54
  v_permlane32_swap_b32 v56, v58
  v_permlane32_swap_b32 v57, v59
  v_add_f32 v56, v56, v58
  v_add_f32 v57, v57, v59
  v_cvt_pk_bf16_f32 v58, v56, v57
  ds_write_b32 v157, v58
cA_va1_t2d:
  s_add_u32 s72, s20, s76
  s_add_u32 s73, s20, s77
  s_add_u32 s74, s20, s78
  s_add_u32 s75, s20, s79
  s_add_u32 s22, s20, 9216
  s_add_u32 s34, s20, 13312
  s_add_u32 s36, s20, 7168
  s_mov_b32 s37, 0
  v_mov_b32 v48, 0
  v_mov_b32 v49, 0
  v_mov_b32 v50, 0
  v_mov_b32 v51, 0
  v_mov_b32 v163, s18
  s_cmp_eq_u32 s19, 63
  s_waitcnt lgkmcnt(0)
  s_cbranch_scc1 cA_va1_last
  s_barrier
  buffer_load_dwordx4 v[8:11], v2, s[8:11], s72 offen offset:0 sc1
  buffer_load_dwordx4 v[12:15], v2, s[8:11], s72 offen offset:1024 sc1
  buffer_load_dwordx4 v[16:19], v2, s[8:11], s73 offen offset:0 sc1
  buffer_load_dwordx4 v[20:23], v2, s[8:11], s73 offen offset:1024 sc1
  buffer_load_dwordx4 v[24:27], v2, s[8:11], s74 offen offset:0 sc1
  buffer_load_dwordx4 v[28:31], v2, s[8:11], s74 offen offset:1024 sc1
  buffer_load_dwordx4 v[32:35], v2, s[8:11], s75 offen offset:0 sc1
  buffer_load_dwordx4 v[36:39], v2, s[8:11], s75 offen offset:1024 sc1
  buffer_load_dwordx4 v[40:43], v2, s[8:11], s36 offen offset:0 sc1
  buffer_load_dwordx4 v[44:47], v2, s[8:11], s36 offen offset:1024 sc1
  ds_read_b128 v[64:67], v2 offset:4096
  ds_read_b128 v[68:71], v2 offset:5120
  ds_read_b128 v[72:75], v2 offset:6144
  ds_read_b128 v[76:79], v2 offset:7168
cA_va1_lp:
  s_waitcnt vmcnt(9)
  v_smfmac_f32_16x16x64_bf16 v[48:51], v[8:11], v[80:87], v3
  s_waitcnt vmcnt(8)
  v_smfmac_f32_16x16x64_bf16 v[48:51], v[12:15], v[88:95], v3
  s_waitcnt vmcnt(7)
  v_smfmac_f32_16x16x64_bf16 v[48:51], v[16:19], v[96:103], v3
  v_max3_u32 v55, v8, v12, v16
  s_waitcnt vmcnt(6)
  v_smfmac_f32_16x16x64_bf16 v[48:51], v[20:23], v[104:111], v3
  s_waitcnt vmcnt(5)
  v_smfmac_f32_16x16x64_bf16 v[48:51], v[24:27], v[112:119], v3
  v_max3_u32 v55, v55, v20, v24
  s_waitcnt vmcnt(4)
  v_smfmac_f32_16x16x64_bf16 v[48:51], v[28:31], v[120:127], v3
  v_max_u32 v55, v55, v28
  v_cmp_eq_u32 vcc, -1, v55
  s_waitcnt vmcnt(3)
  v_smfmac_f32_16x16x64_bf16 v[48:51], v[32:35], v[128:135], v3
  s_waitcnt vmcnt(2)
  v_smfmac_f32_16x16x64_bf16 v[48:51], v[36:39], v[136:143], v3
  s_cbranch_vccnz cA_va1_rv
  buffer_store_dword v163, v7, s[8:11], 0 offen
  s_waitcnt vmcnt(2) lgkmcnt(0)
  v_smfmac_f32_16x16x64_bf16 v[48:51], v[40:43], v[64:71], v3
  s_waitcnt vmcnt(1)
  v_smfmac_f32_16x16x64_bf16 v[48:51], v[44:47], v[72:79], v3
  s_nop 7
  v_permlane32_swap_b32 v48, v50
  v_permlane32_swap_b32 v49, v51
  v_pk_add_f32 v[48:49], v[48:49], v[50:51]
  v_cvt_pk_bf16_f32 v160, v48, v49
  v_cmp_u_f32 vcc, v48, v49
  s_nop 0
  v_mov_b32_dpp v161, v160 quad_perm:[1,0,3,2] row_mask:0xf bank_mask:0xf
  v_perm_b32 v160, v161, v160, v5
  v_cndmask_b32 v161, v160, v162, vcc
  buffer_store_dword v161, v1, s[8:11], s21 offen
  s_cbranch_vccnz cA_va1_rp
cA_va1_cont:
  s_cmp_lg_u32 s19, 62
  s_cbranch_scc1 cA_va1_nl
  s_mov_b32 s25, 0x40000000
cA_va1_nl:
  s_add_u32 s25, s25, 458752
  v_mov_b32 v36, 0
  v_mov_b32 v37, 0
  v_mov_b32 v38, 0
  v_mov_b32 v39, 0
  v_mov_b32 v40, 0
  v_mov_b32 v41, 0
  v_mov_b32 v42, 0
  v_mov_b32 v43, 0
  v_mov_b32 v44, 0
  v_mov_b32 v45, 0
  v_mov_b32 v46, 0
  v_mov_b32 v47, 0
  v_mov_b32 v48, 0
  v_mov_b32 v49, 0
  v_mov_b32 v50, 0
  v_mov_b32 v51, 0
  v_mov_b32 v52, 0
  v_mov_b32 v53, 0
  v_mov_b32 v54, 0
  v_mov_b32 v55, 0
  v_mov_b32 v56, 0
  v_mov_b32 v57, 0
  v_mov_b32 v58, 0
  v_mov_b32 v59, 0
  v_mov_b32 v60, 0
  v_mov_b32 v61, 0
  v_mov_b32 v62, 0
  v_mov_b32 v63, 0
  s_mov_b32 s19, s18
  s_add_u32 s18, s18, 1
  s_mov_b32 s22, s20
  s_mov_b32 s20, s21
  s_mov_b32 s21, s22
  s_add_u32 s23, s20, 4096
  s_branch cA_va1_loop
cA_va1_slow:
  s_waitcnt lgkmcnt(0)
cA_va1_sl1:
  s_add_u32 s31, s31, 0x1000000
  buffer_load_dwordx4 v[8:11], v2, s[8:11], s20 offen offset:0 sc1
  buffer_load_dwordx4 v[12:15], v2, s[8:11], s20 offen offset:1024 sc1
  buffer_load_dwordx4 v[16:19], v2, s[8:11], s20 offen offset:2048 sc1
  buffer_load_dwordx4 v[20:23], v2, s[8:11], s20 offen offset:3072 sc1
  buffer_load_dwordx4 v[24:27], v2, s[8:11], s23 offen offset:0 sc1
  buffer_load_dwordx4 v[28:31], v2, s[8:11], s23 offen offset:1024 sc1
  buffer_load_dwordx4 v[32:35], v2, s[8:11], s23 offen offset:2048 sc1
  s_waitcnt vmcnt(0)
  v_max3_u32 v36, v8, v9, v10
  v_max3_u32 v36, v36, v11, v12
  v_max3_u32 v36, v36, v13, v14
  v_max3_u32 v36, v36, v15, v16
  v_max3_u32 v36, v36, v17, v18
  v_max3_u32 v36, v36, v19, v20
  v_max3_u32 v36, v36, v21, v22
  v_max3_u32 v36, v36, v23, v24
  v_max3_u32 v36, v36, v25, v26
  v_max3_u32 v36, v36, v27, v28
  v_max3_u32 v36, v36, v29, v30
  v_max3_u32 v36, v36, v31, v32
  v_max3_u32 v36, v36, v33, v34
  v_max_u32 v36, v36, v35
  v_cmp_eq_u32 vcc, -1, v36
  s_cbranch_vccz cA_va1_sl2
  s_add_u32 s30, s30, 1
  s_cmp_lt_u32 s30, 400000
  s_cbranch_scc1 cA_va1_sl1
  s_branch cA_abort
cA_va1_sl2:
  v_mov_b32 v36, 0
  v_mov_b32 v37, 0
  v_mov_b32 v38, 0
  v_mov_b32 v39, 0
  v_mov_b32 v40, 0
  v_mov_b32 v41, 0
  v_mov_b32 v42, 0
  v_mov_b32 v43, 0
  v_mov_b32 v44, 0
  v_mov_b32 v45, 0
  v_mov_b32 v46, 0
  v_mov_b32 v47, 0
  v_mov_b32 v48, 0
  v_mov_b32 v49, 0
  v_mov_b32 v50, 0
  v_mov_b32 v51, 0
  v_mov_b32 v52, 0
  v_mov_b32 v53, 0
  v_mov_b32 v54, 0
  v_mov_b32 v55, 0
  v_mov_b32 v56, 0
  v_mov_b32 v57, 0
  v_mov_b32 v58, 0
  v_mov_b32 v59, 0
  v_mov_b32 v60, 0
  v_mov_b32 v61, 0
  v_mov_b32 v62, 0
  v_mov_b32 v63, 0
  buffer_store_dword v162, v1, s[8:11], s21 offen
  ds_read_b128 v[64:67], v0 offset:0
  ds_read_b128 v[68:71], v0 offset:1024
  v_smfmac_f32_16x16x64_bf16 v[36:39], v[8:11], a[0:7], v3
  v_smfmac_f32_16x16x64_bf16 v[40:43], v[8:11], a[56:63], v3
  v_smfmac_f32_16x16x64_bf16 v[44:47], v[8:11], a[112:119], v3
  v_smfmac_f32_16x16x64_bf16 v[48:51], v[8:11], a[168:175], v3
  v_smfmac_f32_16x16x64_bf16 v[52:55], v[8:11], a[224:231], v3
  v_smfmac_f32_16x16x64_bf16 v[56:59], v[8:11], v[200:207], v3
  s_waitcnt lgkmcnt(0)
  v_smfmac_f32_16x16x64_bf16 v[60:63], v[8:11], v[64:71], v3
  ds_read_b128 v[72:75], v0 offset:2048
  ds_read_b128 v[76:79], v0 offset:3072
  v_smfmac_f32_16x16x64_bf16 v[36:39], v[12:15], a[8:15], v3
  v_smfmac_f32_16x16x64_bf16 v[40:43], v[12:15], a[64:71], v3
  v_smfmac_f32_16x16x64_bf16 v[44:47], v[12:15], a[120:127], v3
  v_smfmac_f32_16x16x64_bf16 v[48:51], v[12:15], a[176:183], v3
  v_smfmac_f32_16x16x64_bf16 v[52:55], v[12:15], a[232:239], v3
  v_smfmac_f32_16x16x64_bf16 v[56:59], v[12:15], v[208:215], v3
  s_waitcnt lgkmcnt(0)
  v_smfmac_f32_16x16x64_bf16 v[60:63], v[12:15], v[72:79], v3
  ds_read_b128 v[144:147], v0 offset:4096
  ds_read_b128 v[148:151], v0 offset:5120
  v_smfmac_f32_16x16x64_bf16 v[36:39], v[16:19], a[16:23], v3
  v_smfmac_f32_16x16x64_bf16 v[40:43], v[16:19], a[72:79], v3
  v_smfmac_f32_16x16x64_bf16 v[44:47], v[16:19], a[128:135], v3
  v_smfmac_f32_16x16x64_bf16 v[48:51], v[16:19], a[184:191], v3
  v_smfmac_f32_16x16x64_bf16 v[52:55], v[16:19], a[240:247], v3
  v_smfmac_f32_16x16x64_bf16 v[56:59], v[16:19], v[216:223], v3
  s_waitcnt lgkmcnt(0)
  v_smfmac_f32_16x16x64_bf16 v[60:63], v[16:19], v[144:151], v3
  ds_read_b128 v[64:67], v0 offset:6144
  ds_read_b128 v[68:71], v0 offset:7168
  v_smfmac_f32_16x16x64_bf16 v[36:39], v[20:23], a[24:31], v3
  v_smfmac_f32_16x16x64_bf16 v[40:43], v[20:23], a[80:87], v3
  v_smfmac_f32_16x16x64_bf16 v[44:47], v[20:23], a[136:143], v3
  v_smfmac_f32_16x16x64_bf16 v[48:51], v[20:23], a[192:199], v3
  v_smfmac_f32_16x16x64_bf16 v[52:55], v[20:23], a[248:255], v3
  v_smfmac_f32_16x16x64_bf16 v[56:59], v[20:23], v[224:231], v3
  s_waitcnt lgkmcnt(0)
  v_smfmac_f32_16x16x64_bf16 v[60:63], v[20:23], v[64:71], v3
  ds_read_b128 v[72:75], v0 offset:8192
  ds_read_b128 v[76:79], v0 offset:9216
  v_smfmac_f32_16x16x64_bf16 v[36:39], v[24:27], a[32:39], v3
  v_smfmac_f32_16x16x64_bf16 v[40:43], v[24:27], a[88:95], v3
  v_smfmac_f32_16x16x64_bf16 v[44:47], v[24:27], a[144:151], v3
  v_smfmac_f32_16x16x64_bf16 v[48:51], v[24:27], a[200:207], v3
  v_smfmac_f32_16x16x64_bf16 v[52:55], v[24:27], v[176:183], v3
  v_smfmac_f32_16x16x64_bf16 v[56:59], v[24:27], v[232:239], v3
  s_waitcnt lgkmcnt(0)
  v_smfmac_f32_16x16x64_bf16 v[60:63], v[24:27], v[72:79], v3
  ds_read_b128 v[144:147], v0 offset:10240
  ds_read_b128 v[148:151], v0 offset:11264
  v_smfmac_f32_16x16x64_bf16 v[36:39], v[28:31], a[40:47], v3
  v_smfmac_f32_16x16x64_bf16 v[40:43], v[28:31], a[96:103], v3
  v_smfmac_f32_16x16x64_bf16 v[44:47], v[28:31], a[152:159], v3
  v_smfmac_f32_16x16x64_bf16 v[48:51], v[28:31], a[208:215], v3
  v_smfmac_f32_16x16x64_bf16 v[52:55], v[28:31], v[184:191], v3
  v_smfmac_f32_16x16x64_bf16 v[56:59], v[28:31], v[240:247], v3
  s_waitcnt lgkmcnt(0)
  v_smfmac_f32_16x16x64_bf16 v[60:63], v[28:31], v[144:151], v3
  ds_read_b128 v[64:67], v0 offset:12288
  ds_read_b128 v[68:71], v0 offset:13312
  v_smfmac_f32_16x16x64_bf16 v[36:39], v[32:35], a[48:55], v3
  v_smfmac_f32_16x16x64_bf16 v[40:43], v[32:35], a[104:111], v3
  v_smfmac_f32_16x16x64_bf16 v[44:47], v[32:35], a[160:167], v3
  v_smfmac_f32_16x16x64_bf16 v[48:51], v[32:35], a[216:223], v3
  v_smfmac_f32_16x16x64_bf16 v[52:55], v[32:35], v[192:199], v3
  v_smfmac_f32_16x16x64_bf16 v[56:59], v[32:35], v[248:255], v3
  s_waitcnt lgkmcnt(0)
  v_smfmac_f32_16x16x64_bf16 v[60:63], v[32:35], v[64:71], v3
  v_permlane32_swap_b32 v36, v38
  v_permlane32_swap_b32 v37, v39
  v_add_f32 v36, v36, v38
  v_add_f32 v37, v37, v39
  v_cvt_pk_bf16_f32 v38, v36, v37
  ds_write_b32 v152, v38
  v_permlane32_swap_b32 v40, v42
  v_permlane32_swap_b32 v41, v43
  v_add_f32 v40, v40, v42
  v_add_f32 v41, v41, v43
  v_cvt_pk_bf16_f32 v42, v40, v41
  ds_write_b32 v153, v42
  v_permlane32_swap_b32 v44, v46
  v_permlane32_swap_b32 v45, v47
  v_add_f32 v44, v44, v46
  v_add_f32 v45, v45, v47
  v_cvt_pk_bf16_f32 v46, v44, v45
  ds_write_b32 v154, v46
  v_permlane32_swap_b32 v48, v50
  v_permlane32_swap_b32 v49, v51
  v_add_f32 v48, v48, v50
  v_add_f32 v49, v49, v51
  v_cvt_pk_bf16_f32 v50, v48, v49
  ds_write_b32 v155, v50
  v_permlane32_swap_b32 v52, v54
  v_permlane32_swap_b32 v53, v55
  v_add_f32 v52, v52, v54
  v_add_f32 v53, v53, v55
  v_cvt_pk_bf16_f32 v54, v52, v53
  ds_write_b32 v156, v54
  v_permlane32_swap_b32 v56, v58
  v_permlane32_swap_b32 v57, v59
  v_add_f32 v56, v56, v58
  v_add_f32 v57, v57, v59
  v_cvt_pk_bf16_f32 v58, v56, v57
  ds_write_b32 v157, v58
  v_permlane32_swap_b32 v60, v62
  v_permlane32_swap_b32 v61, v63
  v_add_f32 v60, v60, v62
  v_add_f32 v61, v61, v63
  v_cvt_pk_bf16_f32 v62, v60, v61
  ds_write_b32 v158, v62
  s_branch cA_va1_t2d
cA_va1_last:
  s_barrier
  ds_read_b128 v[64:67], v2 offset:4096
  ds_read_b128 v[68:71], v2 offset:5120
  ds_read_b128 v[72:75], v2 offset:6144
  ds_read_b128 v[76:79], v2 offset:7168
  s_waitcnt lgkmcnt(0)
  v_min_u32 v64, -2, v64
  v_min_u32 v65, -2, v65
  v_min_u32 v66, -2, v66
  v_min_u32 v67, -2, v67
  v_min_u32 v68, -2, v68
  v_min_u32 v69, -2, v69
  v_min_u32 v70, -2, v70
  v_min_u32 v71, -2, v71
  v_min_u32 v72, -2, v72
  v_min_u32 v73, -2, v73
  v_min_u32 v74, -2, v74
  v_min_u32 v75, -2, v75
  v_min_u32 v76, -2, v76
  v_min_u32 v77, -2, v77
  v_min_u32 v78, -2, v78
  v_min_u32 v79, -2, v79
  buffer_store_dwordx4 v[64:67], v2, s[8:11], s33 offen offset:0 sc1
  buffer_store_dwordx4 v[68:71], v2, s[8:11], s33 offen offset:2048 sc1
  s_add_u32 s33, s33, 4096
  buffer_store_dwordx4 v[72:75], v2, s[8:11], s33 offen offset:0 sc1
  buffer_store_dwordx4 v[76:79], v2, s[8:11], s33 offen offset:2048 sc1
  s_add_u32 s33, s33, 4096
  s_branch cA_done
cA_va1_rp:
  s_cmp_eq_u32 s37, 0
  s_cbranch_scc1 cA_va1_rv
  v_min_u32 v160, -2, v160
  buffer_store_dword v160, v1, s[8:11], s21 offen
  s_branch cA_va1_cont
cA_va1_rv:
  s_add_u32 s31, s31, 0x10000
  buffer_load_dwordx4 v[8:11], v2, s[8:11], s72 offen offset:0 sc1
  buffer_load_dwordx4 v[12:15], v2, s[8:11], s72 offen offset:1024 sc1
  buffer_load_dwordx4 v[16:19], v2, s[8:11], s73 offen offset:0 sc1
  buffer_load_dwordx4 v[20:23], v2, s[8:11], s73 offen offset:1024 sc1
  buffer_load_dwordx4 v[24:27], v2, s[8:11], s74 offen offset:0 sc1
  buffer_load_dwordx4 v[28:31], v2, s[8:11], s74 offen offset:1024 sc1
  buffer_load_dwordx4 v[32:35], v2, s[8:11], s75 offen offset:0 sc1
  buffer_load_dwordx4 v[36:39], v2, s[8:11], s75 offen offset:1024 sc1
  buffer_load_dwordx4 v[40:43], v2, s[8:11], s36 offen offset:0 sc1
  buffer_load_dwordx4 v[44:47], v2, s[8:11], s36 offen offset:1024 sc1
  s_waitcnt vmcnt(0)
  v_max3_u32 v52, v8, v9, v10
  v_max3_u32 v52, v52, v11, v12
  v_max3_u32 v52, v52, v13, v14
  v_max3_u32 v52, v52, v15, v16
  v_max3_u32 v52, v52, v17, v18
  v_max3_u32 v52, v52, v19, v20
  v_max3_u32 v52, v52, v21, v22
  v_max3_u32 v52, v52, v23, v24
  v_max3_u32 v52, v52, v25, v26
  v_max3_u32 v52, v52, v27, v28
  v_max3_u32 v52, v52, v29, v30
  v_max3_u32 v52, v52, v31, v32
  v_max3_u32 v52, v52, v33, v34
  v_max3_u32 v52, v52, v35, v36
  v_max3_u32 v52, v52, v37, v38
  v_max3_u32 v52, v52, v39, v40
  v_max3_u32 v52, v52, v41, v42
  v_max3_u32 v52, v52, v43, v44
  v_max3_u32 v52, v52, v45, v46
  v_max_u32 v52, v52, v47
  v_cmp_eq_u32 vcc, -1, v52
  s_mov_b32 s37, 1
  v_mov_b32 v48, 0
  v_mov_b32 v49, 0
  v_mov_b32 v50, 0
  v_mov_b32 v51, 0
  s_nop 1
  s_cbranch_vccz cA_va1_lp
  s_add_u32 s30, s30, 1
  s_cmp_lt_u32 s30, 400000
  s_cbranch_scc1 cA_va1_rv
  s_branch cA_abort
.p2align 6
cA_va2_loop:
  s_mov_b32 s30, 0
cA_va2_fp_l:
  v_cmp_gt_u32 vcc, s19, v96
  buffer_load_dword v96, v119, s[8:11], 0 offen sc1
  s_cbranch_vccz cA_va2_fp_d
  v_cmp_gt_u32 vcc, s19, v96
  buffer_load_dword v96, v119, s[8:11], 0 offen sc1
  s_cbranch_vccz cA_va2_fp_d
  v_cmp_gt_u32 vcc, s19, v96
  buffer_load_dword v96, v119, s[8:11], 0 offen sc1
  s_cbranch_vccz cA_va2_fp_d
  v_cmp_gt_u32 vcc, s19, v96
  buffer_load_dword v96, v119, s[8:11], 0 offen sc1
  s_cbranch_vccz cA_va2_fp_d
  v_cmp_gt_u32 vcc, s19, v96
  buffer_load_dword v96, v119, s[8:11], 0 offen sc1
  s_cbranch_vccz cA_va2_fp_d
  v_cmp_gt_u32 vcc, s19, v96
  buffer_load_dword v96, v119, s[8:11], 0 offen sc1
  s_cbranch_vccz cA_va2_fp_d
  v_cmp_gt_u32 vcc, s19, v96
  buffer_load_dword v96, v119, s[8:11], 0 offen sc1
  s_cbranch_vccz cA_va2_fp_d
  v_cmp_gt_u32 vcc, s19, v96
  buffer_load_dword v96, v119, s[8:11], 0 offen sc1
  s_cbranch_vccz cA_va2_fp_d
  v_cmp_gt_u32 vcc, s19, v96
  buffer_load_dword v96, v119, s[8:11], 0 offen sc1
  s_cbranch_vccz cA_va2_fp_d
  v_cmp_gt_u32 vcc, s19, v96
  buffer_load_dword v96, v119, s[8:11], 0 offen sc1
  s_cbranch_vccz cA_va2_fp_d
  v_cmp_gt_u32 vcc, s19, v96
  buffer_load_dword v96, v119, s[8:11], 0 offen sc1
  s_cbranch_vccz cA_va2_fp_d
  v_cmp_gt_u32 vcc, s19, v96
  buffer_load_dword v96, v119, s[8:11], 0 offen sc1
  s_cbranch_vccz cA_va2_fp_d
  v_cmp_gt_u32 vcc, s19, v96
  buffer_load_dword v96, v119, s[8:11], 0 offen sc1
  s_cbranch_vccz cA_va2_fp_d
  v_cmp_gt_u32 vcc, s19, v96
  buffer_load_dword v96, v119, s[8:11], 0 offen sc1
  s_cbranch_vccz cA_va2_fp_d
  v_cmp_gt_u32 vcc, s19, v96
  buffer_load_dword v96, v119, s[8:11], 0 offen sc1
  s_cbranch_vccz cA_va2_fp_d
  v_cmp_gt_u32 vcc, s19, v96
  buffer_load_dword v96, v119, s[8:11], 0 offen sc1
  s_cbranch_vccz cA_va2_fp_d
  s_waitcnt vmcnt(24)
  s_add_u32 s30, s30, 1
  s_cmp_lt_u32 s30, 400000
  s_cbranch_scc1 cA_va2_fp_l
  s_branch cA_abort
cA_va2_fp_d:
  buffer_load_dwordx4 v[8:11], v2, s[8:11], s20 offen offset:0 sc1
  buffer_load_dwordx4 v[12:15], v2, s[8:11], s20 offen offset:1024 sc1
  s_barrier
  s_barrier
  s_waitcnt vmcnt(0)
  ds_write_b128 v2, v[8:11] offset:8192
  ds_write_b128 v2, v[12:15] offset:9216
  v_smfmac_f32_16x16x64_bf16 v[36:39], v[8:11], a[0:7], v3
  v_smfmac_f32_16x16x64_bf16 v[40:43], v[8:11], a[56:63], v3
  v_smfmac_f32_16x16x64_bf16 v[44:47], v[8:11], a[112:119], v3
  v_smfmac_f32_16x16x64_bf16 v[48:51], v[8:11], a[168:175], v3
  v_smfmac_f32_16x16x64_bf16 v[52:55], v[8:11], a[224:231], v3
  s_waitcnt lgkmcnt(0)
  s_barrier
  ds_read_b128 v[16:19], v2 offset:10240
  ds_read_b128 v[20:23], v2 offset:11264
  ds_read_b128 v[24:27], v2 offset:12288
  ds_read_b128 v[28:31], v2 offset:13312
  ds_read_b128 v[32:35], v2 offset:14336
  v_smfmac_f32_16x16x64_bf16 v[56:59], v[8:11], v[144:151], v3
  v_smfmac_f32_16x16x64_bf16 v[60:63], v[8:11], v[200:207], v3
  v_smfmac_f32_16x16x64_bf16 v[36:39], v[12:15], a[8:15], v3
  v_smfmac_f32_16x16x64_bf16 v[40:43], v[12:15], a[64:71], v3
  v_smfmac_f32_16x16x64_bf16 v[44:47], v[12:15], a[120:127], v3
  v_smfmac_f32_16x16x64_bf16 v[48:51], v[12:15], a[176:183], v3
  v_smfmac_f32_16x16x64_bf16 v[52:55], v[12:15], a[232:239], v3
  v_smfmac_f32_16x16x64_bf16 v[56:59], v[12:15], v[152:159], v3
  ds_read_b128 v[68:71], v0 offset:0
  ds_read_b128 v[72:75], v0 offset:1024
  v_smfmac_f32_16x16x64_bf16 v[60:63], v[12:15], v[208:215], v3
  s_waitcnt lgkmcnt(6)
  ds_read_b128 v[76:79], v0 offset:2048
  ds_read_b128 v[80:83], v0 offset:3072
  v_smfmac_f32_16x16x64_bf16 v[36:39], v[16:19], a[16:23], v3
  s_waitcnt lgkmcnt(7)
  v_smfmac_f32_16x16x64_bf16 v[36:39], v[20:23], a[24:31], v3
  s_waitcnt lgkmcnt(6)
  v_smfmac_f32_16x16x64_bf16 v[36:39], v[24:27], a[32:39], v3
  s_waitcnt lgkmcnt(2)
  v_smfmac_f32_16x16x64_bf16 v[64:67], v[8:11], v[68:75], v3
  s_waitcnt lgkmcnt(5)
  ds_read_b128 v[84:87], v0 offset:4096
  ds_read_b128 v[88:91], v0 offset:5120
  v_smfmac_f32_16x16x64_bf16 v[36:39], v[28:31], a[40:47], v3
  s_waitcnt lgkmcnt(6)
  v_smfmac_f32_16x16x64_bf16 v[36:39], v[32:35], a[48:55], v3
  v_smfmac_f32_16x16x64_bf16 v[40:43], v[16:19], a[72:79], v3
  s_waitcnt lgkmcnt(2)
  v_smfmac_f32_16x16x64_bf16 v[64:67], v[12:15], v[76:83], v3
  ds_read_b128 v[68:71], v0 offset:6144
  ds_read_b128 v[72:75], v0 offset:7168
  v_smfmac_f32_16x16x64_bf16 v[40:43], v[20:23], a[80:87], v3
  v_permlane32_swap_b32 v36, v38
  v_smfmac_f32_16x16x64_bf16 v[40:43], v[24:27], a[88:95], v3
  v_permlane32_swap_b32 v37, v39
  v_smfmac_f32_16x16x64_bf16 v[40:43], v[28:31], a[96:103], v3
  s_waitcnt lgkmcnt(2)
  v_add_f32 v36, v36, v38
  v_smfmac_f32_16x16x64_bf16 v[64:67], v[16:19], v[84:91], v3
  ds_read_b128 v[76:79], v0 offset:8192
  ds_read_b128 v[80:83], v0 offset:9216
  v_add_f32 v37, v37, v39
  v_smfmac_f32_16x16x64_bf16 v[40:43], v[32:35], a[104:111], v3
  v_cmp_u_f32 vcc, v36, v37
  v_smfmac_f32_16x16x64_bf16 v[44:47], v[16:19], a[128:135], v3
  v_cvt_pk_bf16_f32 v38, v36, v37
  v_smfmac_f32_16x16x64_bf16 v[44:47], v[20:23], a[136:143], v3
  ds_write_b32 v104, v38
  s_waitcnt lgkmcnt(3)
  s_cbranch_vccnz cA_va2_slow
  v_permlane32_swap_b32 v40, v42
  v_smfmac_f32_16x16x64_bf16 v[64:67], v[20:23], v[68:75], v3
  ds_read_b128 v[84:87], v0 offset:10240
  ds_read_b128 v[88:91], v0 offset:11264
  v_permlane32_swap_b32 v41, v43
  v_smfmac_f32_16x16x64_bf16 v[44:47], v[24:27], a[144:151], v3
  v_add_f32 v40, v40, v42
  v_smfmac_f32_16x16x64_bf16 v[44:47], v[28:31], a[152:159], v3
  v_add_f32 v41, v41, v43
  v_smfmac_f32_16x16x64_bf16 v[44:47], v[32:35], a[160:167], v3
  s_waitcnt lgkmcnt(3)
  v_cvt_pk_bf16_f32 v42, v40, v41
  v_smfmac_f32_16x16x64_bf16 v[64:67], v[24:27], v[76:83], v3
  ds_write_b32 v105, v42
  ds_read_b128 v[68:71], v0 offset:12288
  ds_read_b128 v[72:75], v0 offset:13312
  v_smfmac_f32_16x16x64_bf16 v[48:51], v[16:19], a[184:191], v3
  s_nop 0
  v_permlane32_swap_b32 v44, v46
  v_smfmac_f32_16x16x64_bf16 v[48:51], v[20:23], a[192:199], v3
  v_permlane32_swap_b32 v45, v47
  v_smfmac_f32_16x16x64_bf16 v[48:51], v[24:27], a[200:207], v3
  s_waitcnt lgkmcnt(3)
  v_add_f32 v44, v44, v46
  v_smfmac_f32_16x16x64_bf16 v[64:67], v[28:31], v[84:91], v3
  v_add_f32 v45, v45, v47
  v_smfmac_f32_16x16x64_bf16 v[48:51], v[28:31], a[208:215], v3
  v_cvt_pk_bf16_f32 v46, v44, v45
  v_smfmac_f32_16x16x64_bf16 v[48:51], v[32:35], a[216:223], v3
  ds_write_b32 v106, v46
  v_smfmac_f32_16x16x64_bf16 v[52:55], v[16:19], a[240:247], v3
  s_waitcnt lgkmcnt(1)
  v_smfmac_f32_16x16x64_bf16 v[64:67], v[32:35], v[68:75], v3
  v_smfmac_f32_16x16x64_bf16 v[52:55], v[20:23], a[248:255], v3
  v_permlane32_swap_b32 v48, v50
  v_smfmac_f32_16x16x64_bf16 v[52:55], v[24:27], v[120:127], v3
  v_permlane32_swap_b32 v49, v51
  v_smfmac_f32_16x16x64_bf16 v[52:55], v[28:31], v[128:135], v3
  v_add_f32 v48, v48, v50
  v_smfmac_f32_16x16x64_bf16 v[52:55], v[32:35], v[136:143], v3
  v_add_f32 v49, v49, v51
  v_smfmac_f32_16x16x64_bf16 v[56:59], v[16:19], v[160:167], v3
  v_cvt_pk_bf16_f32 v50, v48, v49
  v_smfmac_f32_16x16x64_bf16 v[56:59], v[20:23], v[168:175], v3
  ds_write_b32 v107, v50
  v_permlane32_swap_b32 v64, v66
  v_smfmac_f32_16x16x64_bf16 v[56:59], v[24:27], v[176:183], v3
  v_permlane32_swap_b32 v65, v67
  v_smfmac_f32_16x16x64_bf16 v[56:59], v[28:31], v[184:191], v3
  v_add_f32 v64, v64, v66
  v_smfmac_f32_16x16x64_bf16 v[56:59], v[32:35], v[192:199], v3
  v_add_f32 v65, v65, v67
  v_smfmac_f32_16x16x64_bf16 v[60:63], v[16:19], v[216:223], v3
  v_cvt_pk_bf16_f32 v66, v64, v65
  v_smfmac_f32_16x16x64_bf16 v[60:63], v[20:23], v[224:231], v3
  ds_write_b32 v111, v66
  v_permlane32_swap_b32 v52, v54
  v_smfmac_f32_16x16x64_bf16 v[60:63], v[24:27], v[232:239], v3
  v_permlane32_swap_b32 v53, v55
  v_smfmac_f32_16x16x64_bf16 v[60:63], v[28:31], v[240:247], v3
  v_add_f32 v52, v52, v54
  v_smfmac_f32_16x16x64_bf16 v[60:63], v[32:35], v[248:255], v3
  v_add_f32 v53, v53, v55
  v_cvt_pk_bf16_f32 v54, v52, v53
  ds_write_b32 v108, v54
  v_permlane32_swap_b32 v56, v58
  v_permlane32_swap_b32 v57, v59
  v_add_f32 v56, v56, v58
  v_add_f32 v57, v57, v59
  v_cvt_pk_bf16_f32 v58, v56, v57
  ds_write_b32 v109, v58
  v_permlane32_swap_b32 v60, v62
  v_permlane32_swap_b32 v61, v63
  v_add_f32 v60, v60, v62
  v_add_f32 v61, v61, v63
  v_cvt_pk_bf16_f32 v62, v60, v61
  ds_write_b32 v110, v62
cA_va2_t2d:
  v_mov_b32 v117, s18
  s_waitcnt lgkmcnt(0)
  s_barrier
  s_cmp_eq_u32 s19, 63
  s_cbranch_scc1 cA_done
  s_sleep 1
  v_mov_b32 v36, 0
  v_mov_b32 v37, 0
  v_mov_b32 v38, 0
  v_mov_b32 v39, 0
  v_mov_b32 v40, 0
  v_mov_b32 v41, 0
  v_mov_b32 v42, 0
  v_mov_b32 v43, 0
  v_mov_b32 v44, 0
  v_mov_b32 v45, 0
  v_mov_b32 v46, 0
  v_mov_b32 v47, 0
  v_mov_b32 v48, 0
  v_mov_b32 v49, 0
  v_mov_b32 v50, 0
  v_mov_b32 v51, 0
  v_mov_b32 v52, 0
  v_mov_b32 v53, 0
  v_mov_b32 v54, 0
  v_mov_b32 v55, 0
  v_mov_b32 v56, 0
  v_mov_b32 v57, 0
  v_mov_b32 v58, 0
  v_mov_b32 v59, 0
  v_mov_b32 v60, 0
  v_mov_b32 v61, 0
  v_mov_b32 v62, 0
  v_mov_b32 v63, 0
  v_mov_b32 v64, 0
  v_mov_b32 v65, 0
  v_mov_b32 v66, 0
  v_mov_b32 v67, 0
  s_sleep 5
  s_mov_b32 s19, s18
  s_add_u32 s18, s18, 1
  s_mov_b32 s22, s20
  s_mov_b32 s20, s21
  s_mov_b32 s21, s22
  s_add_u32 s23, s20, 4096
  s_branch cA_va2_loop
cA_va2_slow:
  s_waitcnt lgkmcnt(0)
cA_va2_sl1:
  s_add_u32 s31, s31, 0x1000000
  buffer_load_dwordx4 v[8:11], v2, s[8:11], s20 offen offset:0 sc1
  buffer_load_dwordx4 v[12:15], v2, s[8:11], s20 offen offset:1024 sc1
  buffer_load_dwordx4 v[16:19], v2, s[8:11], s20 offen offset:2048 sc1
  buffer_load_dwordx4 v[20:23], v2, s[8:11], s20 offen offset:3072 sc1
  buffer_load_dwordx4 v[24:27], v2, s[8:11], s23 offen offset:0 sc1
  buffer_load_dwordx4 v[28:31], v2, s[8:11], s23 offen offset:1024 sc1
  buffer_load_dwordx4 v[32:35], v2, s[8:11], s23 offen offset:2048 sc1
  s_waitcnt vmcnt(0)
  v_max3_u32 v36, v8, v9, v10
  v_max3_u32 v36, v36, v11, v12
  v_max3_u32 v36, v36, v13, v14
  v_max3_u32 v36, v36, v15, v16
  v_max3_u32 v36, v36, v17, v18
  v_max3_u32 v36, v36, v19, v20
  v_max3_u32 v36, v36, v21, v22
  v_max3_u32 v36, v36, v23, v24
  v_max3_u32 v36, v36, v25, v26
  v_max3_u32 v36, v36, v27, v28
  v_max3_u32 v36, v36, v29, v30
  v_max3_u32 v36, v36, v31, v32
  v_max3_u32 v36, v36, v33, v34
  v_max_u32 v36, v36, v35
  v_cmp_eq_u32 vcc, -1, v36
  s_cbranch_vccz cA_va2_sl2
  s_add_u32 s30, s30, 1
  s_cmp_lt_u32 s30, 400000
  s_cbranch_scc1 cA_va2_sl1
  s_branch cA_abort
cA_va2_sl2:
  v_mov_b32 v36, 0
  v_mov_b32 v37, 0
  v_mov_b32 v38, 0
  v_mov_b32 v39, 0
  v_mov_b32 v40, 0
  v_mov_b32 v41, 0
  v_mov_b32 v42, 0
  v_mov_b32 v43, 0
  v_mov_b32 v44, 0
  v_mov_b32 v45, 0
  v_mov_b32 v46, 0
  v_mov_b32 v47, 0
  v_mov_b32 v48, 0
  v_mov_b32 v49, 0
  v_mov_b32 v50, 0
  v_mov_b32 v51, 0
  v_mov_b32 v52, 0
  v_mov_b32 v53, 0
  v_mov_b32 v54, 0
  v_mov_b32 v55, 0
  v_mov_b32 v56, 0
  v_mov_b32 v57, 0
  v_mov_b32 v58, 0
  v_mov_b32 v59, 0
  v_mov_b32 v60, 0
  v_mov_b32 v61, 0
  v_mov_b32 v62, 0
  v_mov_b32 v63, 0
  v_mov_b32 v64, 0
  v_mov_b32 v65, 0
  v_mov_b32 v66, 0
  v_mov_b32 v67, 0
  ds_read_b128 v[68:71], v0 offset:0
  ds_read_b128 v[72:75], v0 offset:1024
  v_smfmac_f32_16x16x64_bf16 v[36:39], v[8:11], a[0:7], v3
  v_smfmac_f32_16x16x64_bf16 v[40:43], v[8:11], a[56:63], v3
  v_smfmac_f32_16x16x64_bf16 v[44:47], v[8:11], a[112:119], v3
  v_smfmac_f32_16x16x64_bf16 v[48:51], v[8:11], a[168:175], v3
  v_smfmac_f32_16x16x64_bf16 v[52:55], v[8:11], a[224:231], v3
  v_smfmac_f32_16x16x64_bf16 v[56:59], v[8:11], v[144:151], v3
  v_smfmac_f32_16x16x64_bf16 v[60:63], v[8:11], v[200:207], v3
  s_waitcnt lgkmcnt(0)
  v_smfmac_f32_16x16x64_bf16 v[64:67], v[8:11], v[68:75], v3
  ds_read_b128 v[76:79], v0 offset:2048
  ds_read_b128 v[80:83], v0 offset:3072
  v_smfmac_f32_16x16x64_bf16 v[36:39], v[12:15], a[8:15], v3
  v_smfmac_f32_16x16x64_bf16 v[40:43], v[12:15], a[64:71], v3
  v_smfmac_f32_16x16x64_bf16 v[44:47], v[12:15], a[120:127], v3
  v_smfmac_f32_16x16x64_bf16 v[48:51], v[12:15], a[176:183], v3
  v_smfmac_f32_16x16x64_bf16 v[52:55], v[12:15], a[232:239], v3
  v_smfmac_f32_16x16x64_bf16 v[56:59], v[12:15], v[152:159], v3
  v_smfmac_f32_16x16x64_bf16 v[60:63], v[12:15], v[208:215], v3
  s_waitcnt lgkmcnt(0)
  v_smfmac_f32_16x16x64_bf16 v[64:67], v[12:15], v[76:83], v3
  ds_read_b128 v[84:87], v0 offset:4096
  ds_read_b128 v[88:91], v0 offset:5120
  v_smfmac_f32_16x16x64_bf16 v[36:39], v[16:19], a[16:23], v3
  v_smfmac_f32_16x16x64_bf16 v[40:43], v[16:19], a[72:79], v3
  v_smfmac_f32_16x16x64_bf16 v[44:47], v[16:19], a[128:135], v3
  v_smfmac_f32_16x16x64_bf16 v[48:51], v[16:19], a[184:191], v3
  v_smfmac_f32_16x16x64_bf16 v[52:55], v[16:19], a[240:247], v3
  v_smfmac_f32_16x16x64_bf16 v[56:59], v[16:19], v[160:167], v3
  v_smfmac_f32_16x16x64_bf16 v[60:63], v[16:19], v[216:223], v3
  s_waitcnt lgkmcnt(0)
  v_smfmac_f32_16x16x64_bf16 v[64:67], v[16:19], v[84:91], v3
  ds_read_b128 v[68:71], v0 offset:6144
  ds_read_b128 v[72:75], v0 offset:7168
  v_smfmac_f32_16x16x64_bf16 v[36:39], v[20:23], a[24:31], v3
  v_smfmac_f32_16x16x64_bf16 v[40:43], v[20:23], a[80:87], v3
  v_smfmac_f32_16x16x64_bf16 v[44:47], v[20:23], a[136:143], v3
  v_smfmac_f32_16x16x64_bf16 v[48:51], v[20:23], a[192:199], v3
  v_smfmac_f32_16x16x64_bf16 v[52:55], v[20:23], a[248:255], v3
  v_smfmac_f32_16x16x64_bf16 v[56:59], v[20:23], v[168:175], v3
  v_smfmac_f32_16x16x64_bf16 v[60:63], v[20:23], v[224:231], v3
  s_waitcnt lgkmcnt(0)
  v_smfmac_f32_16x16x64_bf16 v[64:67], v[20:23], v[68:75], v3
  ds_read_b128 v[76:79], v0 offset:8192
  ds_read_b128 v[80:83], v0 offset:9216
  v_smfmac_f32_16x16x64_bf16 v[36:39], v[24:27], a[32:39], v3
  v_smfmac_f32_16x16x64_bf16 v[40:43], v[24:27], a[88:95], v3
  v_smfmac_f32_16x16x64_bf16 v[44:47], v[24:27], a[144:151], v3
  v_smfmac_f32_16x16x64_bf16 v[48:51], v[24:27], a[200:207], v3
  v_smfmac_f32_16x16x64_bf16 v[52:55], v[24:27], v[120:127], v3
  v_smfmac_f32_16x16x64_bf16 v[56:59], v[24:27], v[176:183], v3
  v_smfmac_f32_16x16x64_bf16 v[60:63], v[24:27], v[232:239], v3
  s_waitcnt lgkmcnt(0)
  v_smfmac_f32_16x16x64_bf16 v[64:67], v[24:27], v[76:83], v3
  ds_read_b128 v[84:87], v0 offset:10240
  ds_read_b128 v[88:91], v0 offset:11264
  v_smfmac_f32_16x16x64_bf16 v[36:39], v[28:31], a[40:47], v3
  v_smfmac_f32_16x16x64_bf16 v[40:43], v[28:31], a[96:103], v3
  v_smfmac_f32_16x16x64_bf16 v[44:47], v[28:31], a[152:159], v3
  v_smfmac_f32_16x16x64_bf16 v[48:51], v[28:31], a[208:215], v3
  v_smfmac_f32_16x16x64_bf16 v[52:55], v[28:31], v[128:135], v3
  v_smfmac_f32_16x16x64_bf16 v[56:59], v[28:31], v[184:191], v3
  v_smfmac_f32_16x16x64_bf16 v[60:63], v[28:31], v[240:247], v3
  s_waitcnt lgkmcnt(0)
  v_smfmac_f32_16x16x64_bf16 v[64:67], v[28:31], v[84:91], v3
  ds_read_b128 v[68:71], v0 offset:12288
  ds_read_b128 v[72:75], v0 offset:13312
  v_smfmac_f32_16x16x64_bf16 v[36:39], v[32:35], a[48:55], v3
  v_smfmac_f32_16x16x64_bf16 v[40:43], v[32:35], a[104:111], v3
  v_smfmac_f32_16x16x64_bf16 v[44:47], v[32:35], a[160:167], v3
  v_smfmac_f32_16x16x64_bf16 v[48:51], v[32:35], a[216:223], v3
  v_smfmac_f32_16x16x64_bf16 v[52:55], v[32:35], v[136:143], v3
  v_smfmac_f32_16x16x64_bf16 v[56:59], v[32:35], v[192:199], v3
  v_smfmac_f32_16x16x64_bf16 v[60:63], v[32:35], v[248:255], v3
  s_waitcnt lgkmcnt(0)
  v_smfmac_f32_16x16x64_bf16 v[64:67], v[32:35], v[68:75], v3
  v_permlane32_swap_b32 v36, v38
  v_permlane32_swap_b32 v37, v39
  v_add_f32 v36, v36, v38
  v_add_f32 v37, v37, v39
  v_cvt_pk_bf16_f32 v38, v36, v37
  ds_write_b32 v104, v38
  v_permlane32_swap_b32 v40, v42
  v_permlane32_swap_b32 v41, v43
  v_add_f32 v40, v40, v42
  v_add_f32 v41, v41, v43
  v_cvt_pk_bf16_f32 v42, v40, v41
  ds_write_b32 v105, v42
  v_permlane32_swap_b32 v44, v46
  v_permlane32_swap_b32 v45, v47
  v_add_f32 v44, v44, v46
  v_add_f32 v45, v45, v47
  v_cvt_pk_bf16_f32 v46, v44, v45
  ds_write_b32 v106, v46
  v_permlane32_swap_b32 v48, v50
  v_permlane32_swap_b32 v49, v51
  v_add_f32 v48, v48, v50
  v_add_f32 v49, v49, v51
  v_cvt_pk_bf16_f32 v50, v48, v49
  ds_write_b32 v107, v50
  v_permlane32_swap_b32 v52, v54
  v_permlane32_swap_b32 v53, v55
  v_add_f32 v52, v52, v54
  v_add_f32 v53, v53, v55
  v_cvt_pk_bf16_f32 v54, v52, v53
  ds_write_b32 v108, v54
  v_permlane32_swap_b32 v56, v58
  v_permlane32_swap_b32 v57, v59
  v_add_f32 v56, v56, v58
  v_add_f32 v57, v57, v59
  v_cvt_pk_bf16_f32 v58, v56, v57
  ds_write_b32 v109, v58
  v_permlane32_swap_b32 v60, v62
  v_permlane32_swap_b32 v61, v63
  v_add_f32 v60, v60, v62
  v_add_f32 v61, v61, v63
  v_cvt_pk_bf16_f32 v62, v60, v61
  ds_write_b32 v110, v62
  v_permlane32_swap_b32 v64, v66
  v_permlane32_swap_b32 v65, v67
  v_add_f32 v64, v64, v66
  v_add_f32 v65, v65, v67
  v_cvt_pk_bf16_f32 v66, v64, v65
  ds_write_b32 v111, v66
  s_branch cA_va2_t2d
.p2align 6
cA_va3_loop:
  s_mov_b32 s30, 0
  s_barrier
  buffer_load_dwordx4 v[16:19], v2, s[8:11], s20 offen offset:2048 sc1
  buffer_load_dwordx4 v[20:23], v2, s[8:11], s20 offen offset:3072 sc1
  s_barrier
  buffer_load_dword v100, v116, s[8:11], s39 offen sc1
  s_add_u32 s27, s19, 2
  s_min_u32 s27, s27, 63
  s_lshr_b32 s27, s27, 3
  s_lshl_b32 s27, s27, 11
  s_add_u32 s27, s27, s35
  s_cmp_eq_u32 s27, s28
  s_cselect_b32 s29, 35328, s27
  buffer_load_dword v101, off, s[8:11], s29 sc1
  s_add_u32 s39, s39, 28672
  s_waitcnt vmcnt(2)
  ds_write_b128 v2, v[16:19] offset:10240
  ds_write_b128 v2, v[20:23] offset:11264
  v_smfmac_f32_16x16x64_bf16 v[36:39], v[16:19], a[16:23], v3
  v_smfmac_f32_16x16x64_bf16 v[40:43], v[16:19], a[72:79], v3
  v_smfmac_f32_16x16x64_bf16 v[44:47], v[16:19], a[128:135], v3
  v_smfmac_f32_16x16x64_bf16 v[48:51], v[16:19], a[184:191], v3
  v_smfmac_f32_16x16x64_bf16 v[52:55], v[16:19], a[240:247], v3
  s_waitcnt lgkmcnt(0)
  s_barrier
  ds_read_b128 v[8:11], v2 offset:8192
  ds_read_b128 v[12:15], v2 offset:9216
  ds_read_b128 v[24:27], v2 offset:12288
  ds_read_b128 v[28:31], v2 offset:13312
  ds_read_b128 v[32:35], v2 offset:14336
  v_smfmac_f32_16x16x64_bf16 v[56:59], v[16:19], v[160:167], v3
  v_smfmac_f32_16x16x64_bf16 v[60:63], v[16:19], v[216:223], v3
  v_smfmac_f32_16x16x64_bf16 v[36:39], v[20:23], a[24:31], v3
  v_smfmac_f32_16x16x64_bf16 v[40:43], v[20:23], a[80:87], v3
  v_smfmac_f32_16x16x64_bf16 v[44:47], v[20:23], a[136:143], v3
  v_smfmac_f32_16x16x64_bf16 v[48:51], v[20:23], a[192:199], v3
  v_smfmac_f32_16x16x64_bf16 v[52:55], v[20:23], a[248:255], v3
  v_smfmac_f32_16x16x64_bf16 v[56:59], v[20:23], v[168:175], v3
  v_smfmac_f32_16x16x64_bf16 v[60:63], v[20:23], v[224:231], v3
  s_waitcnt lgkmcnt(4)
  v_smfmac_f32_16x16x64_bf16 v[36:39], v[8:11], a[0:7], v3
  s_waitcnt lgkmcnt(3)
  v_smfmac_f32_16x16x64_bf16 v[36:39], v[12:15], a[8:15], v3
  s_waitcnt lgkmcnt(2)
  v_smfmac_f32_16x16x64_bf16 v[36:39], v[24:27], a[32:39], v3
  s_waitcnt lgkmcnt(1)
  v_smfmac_f32_16x16x64_bf16 v[36:39], v[28:31], a[40:47], v3
  s_waitcnt lgkmcnt(0)
  v_smfmac_f32_16x16x64_bf16 v[36:39], v[32:35], a[48:55], v3
  v_smfmac_f32_16x16x64_bf16 v[40:43], v[8:11], a[56:63], v3
  v_smfmac_f32_16x16x64_bf16 v[40:43], v[12:15], a[64:71], v3
  v_smfmac_f32_16x16x64_bf16 v[40:43], v[24:27], a[88:95], v3
  v_permlane32_swap_b32 v36, v38
  v_smfmac_f32_16x16x64_bf16 v[40:43], v[28:31], a[96:103], v3
  v_permlane32_swap_b32 v37, v39
  v_smfmac_f32_16x16x64_bf16 v[40:43], v[32:35], a[104:111], v3
  v_add_f32 v36, v36, v38
  v_smfmac_f32_16x16x64_bf16 v[44:47], v[8:11], a[112:119], v3
  v_add_f32 v37, v37, v39
  v_smfmac_f32_16x16x64_bf16 v[44:47], v[12:15], a[120:127], v3
  v_cmp_u_f32 vcc, v36, v37
  v_smfmac_f32_16x16x64_bf16 v[44:47], v[24:27], a[144:151], v3
  v_cvt_pk_bf16_f32 v38, v36, v37
  v_smfmac_f32_16x16x64_bf16 v[44:47], v[28:31], a[152:159], v3
  ds_write_b32 v104, v38
  s_cbranch_vccnz cA_va3_slow
  v_permlane32_swap_b32 v40, v42
  v_smfmac_f32_16x16x64_bf16 v[44:47], v[32:35], a[160:167], v3
  v_permlane32_swap_b32 v41, v43
  v_smfmac_f32_16x16x64_bf16 v[48:51], v[8:11], a[168:175], v3
  v_add_f32 v40, v40, v42
  v_smfmac_f32_16x16x64_bf16 v[48:51], v[12:15], a[176:183], v3
  v_add_f32 v41, v41, v43
  v_smfmac_f32_16x16x64_bf16 v[48:51], v[24:27], a[200:207], v3
  v_cvt_pk_bf16_f32 v42, v40, v41
  v_smfmac_f32_16x16x64_bf16 v[48:51], v[28:31], a[208:215], v3
  ds_write_b32 v105, v42
  v_permlane32_swap_b32 v44, v46
  v_smfmac_f32_16x16x64_bf16 v[48:51], v[32:35], a[216:223], v3
  v_permlane32_swap_b32 v45, v47
  v_smfmac_f32_16x16x64_bf16 v[52:55], v[8:11], a[224:231], v3
  v_add_f32 v44, v44, v46
  v_smfmac_f32_16x16x64_bf16 v[52:55], v[12:15], a[232:239], v3
  v_add_f32 v45, v45, v47
  v_smfmac_f32_16x16x64_bf16 v[52:55], v[24:27], v[120:127], v3
  v_cvt_pk_bf16_f32 v46, v44, v45
  v_smfmac_f32_16x16x64_bf16 v[52:55], v[28:31], v[128:135], v3
  ds_write_b32 v106, v46
  v_permlane32_swap_b32 v48, v50
  v_smfmac_f32_16x16x64_bf16 v[52:55], v[32:35], v[136:143], v3
  v_permlane32_swap_b32 v49, v51
  v_smfmac_f32_16x16x64_bf16 v[56:59], v[8:11], v[144:151], v3
  v_add_f32 v48, v48, v50
  v_smfmac_f32_16x16x64_bf16 v[56:59], v[12:15], v[152:159], v3
  v_add_f32 v49, v49, v51
  v_smfmac_f32_16x16x64_bf16 v[56:59], v[24:27], v[176:183], v3
  v_cvt_pk_bf16_f32 v50, v48, v49
  v_smfmac_f32_16x16x64_bf16 v[56:59], v[28:31], v[184:191], v3
  ds_write_b32 v107, v50
  v_permlane32_swap_b32 v52, v54
  v_smfmac_f32_16x16x64_bf16 v[56:59], v[32:35], v[192:199], v3
  v_permlane32_swap_b32 v53, v55
  v_smfmac_f32_16x16x64_bf16 v[60:63], v[8:11], v[200:207], v3
  v_add_f32 v52, v52, v54
  v_smfmac_f32_16x16x64_bf16 v[60:63], v[12:15], v[208:215], v3
  v_add_f32 v53, v53, v55
  v_smfmac_f32_16x16x64_bf16 v[60:63], v[24:27], v[232:239], v3
  v_cvt_pk_bf16_f32 v54, v52, v53
  v_smfmac_f32_16x16x64_bf16 v[60:63], v[28:31], v[240:247], v3
  ds_write_b32 v108, v54
  v_permlane32_swap_b32 v56, v58
  v_smfmac_f32_16x16x64_bf16 v[60:63], v[32:35], v[248:255], v3
  v_permlane32_swap_b32 v57, v59
  v_add_f32 v56, v56, v58
  v_add_f32 v57, v57, v59
  v_cvt_pk_bf16_f32 v58, v56, v57
  ds_write_b32 v109, v58
  s_nop 2
  v_permlane32_swap_b32 v60, v62
  v_permlane32_swap_b32 v61, v63
  v_add_f32 v60, v60, v62
  v_add_f32 v61, v61, v63
  v_cvt_pk_bf16_f32 v62, v60, v61
  ds_write_b32 v110, v62
cA_va3_t2d:
  v_mov_b32 v117, s18
  s_cmp_eq_u32 s27, s28
  s_cbranch_scc1 cA_va3_vok
cA_va3_vow:
  s_waitcnt vmcnt(0)
  v_cmp_ne_u32 vcc, 56, v101
  s_cbranch_vccnz cA_va3_vor
  s_mov_b32 s28, s27
cA_va3_vok:
  s_waitcnt lgkmcnt(0)
  s_setprio 3
  s_barrier
  v_mov_b32 v36, 0
  v_mov_b32 v37, 0
  buffer_store_dword v117, v118, s[8:11], 0 offen
  s_setprio 0
  s_cmp_eq_u32 s19, 63
  s_cbranch_scc1 cA_done
  v_mov_b32 v38, 0
  v_mov_b32 v39, 0
  v_mov_b32 v40, 0
  v_mov_b32 v41, 0
  v_mov_b32 v42, 0
  v_mov_b32 v43, 0
  v_mov_b32 v44, 0
  v_mov_b32 v45, 0
  v_mov_b32 v46, 0
  v_mov_b32 v47, 0
  v_mov_b32 v48, 0
  v_mov_b32 v49, 0
  v_mov_b32 v50, 0
  v_mov_b32 v51, 0
  v_mov_b32 v52, 0
  v_mov_b32 v53, 0
  v_mov_b32 v54, 0
  v_mov_b32 v55, 0
  v_mov_b32 v56, 0
  v_mov_b32 v57, 0
  v_mov_b32 v58, 0
  v_mov_b32 v59, 0
  v_mov_b32 v60, 0
  v_mov_b32 v61, 0
  v_mov_b32 v62, 0
  v_mov_b32 v63, 0
  s_mov_b32 s19, s18
  s_add_u32 s18, s18, 1
  s_mov_b32 s22, s20
  s_mov_b32 s20, s21
  s_mov_b32 s21, s22
  s_add_u32 s23, s20, 4096
  s_branch cA_va3_loop
cA_va3_slow:
  s_waitcnt lgkmcnt(0)
cA_va3_sl1:
  s_add_u32 s31, s31, 0x1000000
  buffer_load_dwordx4 v[8:11], v2, s[8:11], s20 offen offset:0 sc1
  buffer_load_dwordx4 v[12:15], v2, s[8:11], s20 offen offset:1024 sc1
  buffer_load_dwordx4 v[16:19], v2, s[8:11], s20 offen offset:2048 sc1
  buffer_load_dwordx4 v[20:23], v2, s[8:11], s20 offen offset:3072 sc1
  buffer_load_dwordx4 v[24:27], v2, s[8:11], s23 offen offset:0 sc1
  buffer_load_dwordx4 v[28:31], v2, s[8:11], s23 offen offset:1024 sc1
  buffer_load_dwordx4 v[32:35], v2, s[8:11], s23 offen offset:2048 sc1
  s_waitcnt vmcnt(0)
  v_max3_u32 v36, v8, v9, v10
  v_max3_u32 v36, v36, v11, v12
  v_max3_u32 v36, v36, v13, v14
  v_max3_u32 v36, v36, v15, v16
  v_max3_u32 v36, v36, v17, v18
  v_max3_u32 v36, v36, v19, v20
  v_max3_u32 v36, v36, v21, v22
  v_max3_u32 v36, v36, v23, v24
  v_max3_u32 v36, v36, v25, v26
  v_max3_u32 v36, v36, v27, v28
  v_max3_u32 v36, v36, v29, v30
  v_max3_u32 v36, v36, v31, v32
  v_max3_u32 v36, v36, v33, v34
  v_max_u32 v36, v36, v35
  v_cmp_eq_u32 vcc, -1, v36
  s_cbranch_vccz cA_va3_sl2
  s_add_u32 s30, s30, 1
  s_cmp_lt_u32 s30, 400000
  s_cbranch_scc1 cA_va3_sl1
  s_branch cA_abort
cA_va3_sl2:
  v_mov_b32 v36, 0
  v_mov_b32 v37, 0
  v_mov_b32 v38, 0
  v_mov_b32 v39, 0
  v_mov_b32 v40, 0
  v_mov_b32 v41, 0
  v_mov_b32 v42, 0
  v_mov_b32 v43, 0
  v_mov_b32 v44, 0
  v_mov_b32 v45, 0
  v_mov_b32 v46, 0
  v_mov_b32 v47, 0
  v_mov_b32 v48, 0
  v_mov_b32 v49, 0
  v_mov_b32 v50, 0
  v_mov_b32 v51, 0
  v_mov_b32 v52, 0
  v_mov_b32 v53, 0
  v_mov_b32 v54, 0
  v_mov_b32 v55, 0
  v_mov_b32 v56, 0
  v_mov_b32 v57, 0
  v_mov_b32 v58, 0
  v_mov_b32 v59, 0
  v_mov_b32 v60, 0
  v_mov_b32 v61, 0
  v_mov_b32 v62, 0
  v_mov_b32 v63, 0
  v_smfmac_f32_16x16x64_bf16 v[36:39], v[8:11], a[0:7], v3
  v_smfmac_f32_16x16x64_bf16 v[40:43], v[8:11], a[56:63], v3
  v_smfmac_f32_16x16x64_bf16 v[44:47], v[8:11], a[112:119], v3
  v_smfmac_f32_16x16x64_bf16 v[48:51], v[8:11], a[168:175], v3
  v_smfmac_f32_16x16x64_bf16 v[52:55], v[8:11], a[224:231], v3
  v_smfmac_f32_16x16x64_bf16 v[56:59], v[8:11], v[144:151], v3
  v_smfmac_f32_16x16x64_bf16 v[60:63], v[8:11], v[200:207], v3
  v_smfmac_f32_16x16x64_bf16 v[36:39], v[12:15], a[8:15], v3
  v_smfmac_f32_16x16x64_bf16 v[40:43], v[12:15], a[64:71], v3
  v_smfmac_f32_16x16x64_bf16 v[44:47], v[12:15], a[120:127], v3
  v_smfmac_f32_16x16x64_bf16 v[48:51], v[12:15], a[176:183], v3
  v_smfmac_f32_16x16x64_bf16 v[52:55], v[12:15], a[232:239], v3
  v_smfmac_f32_16x16x64_bf16 v[56:59], v[12:15], v[152:159], v3
  v_smfmac_f32_16x16x64_bf16 v[60:63], v[12:15], v[208:215], v3
  v_smfmac_f32_16x16x64_bf16 v[36:39], v[16:19], a[16:23], v3
  v_smfmac_f32_16x16x64_bf16 v[40:43], v[16:19], a[72:79], v3
  v_smfmac_f32_16x16x64_bf16 v[44:47], v[16:19], a[128:135], v3
  v_smfmac_f32_16x16x64_bf16 v[48:51], v[16:19], a[184:191], v3
  v_smfmac_f32_16x16x64_bf16 v[52:55], v[16:19], a[240:247], v3
  v_smfmac_f32_16x16x64_bf16 v[56:59], v[16:19], v[160:167], v3
  v_smfmac_f32_16x16x64_bf16 v[60:63], v[16:19], v[216:223], v3
  v_smfmac_f32_16x16x64_bf16 v[36:39], v[20:23], a[24:31], v3
  v_smfmac_f32_16x16x64_bf16 v[40:43], v[20:23], a[80:87], v3
  v_smfmac_f32_16x16x64_bf16 v[44:47], v[20:23], a[136:143], v3
  v_smfmac_f32_16x16x64_bf16 v[48:51], v[20:23], a[192:199], v3
  v_smfmac_f32_16x16x64_bf16 v[52:55], v[20:23], a[248:255], v3
  v_smfmac_f32_16x16x64_bf16 v[56:59], v[20:23], v[168:175], v3
  v_smfmac_f32_16x16x64_bf16 v[60:63], v[20:23], v[224:231], v3
  v_smfmac_f32_16x16x64_bf16 v[36:39], v[24:27], a[32:39], v3
  v_smfmac_f32_16x16x64_bf16 v[40:43], v[24:27], a[88:95], v3
  v_smfmac_f32_16x16x64_bf16 v[44:47], v[24:27], a[144:151], v3
  v_smfmac_f32_16x16x64_bf16 v[48:51], v[24:27], a[200:207], v3
  v_smfmac_f32_16x16x64_bf16 v[52:55], v[24:27], v[120:127], v3
  v_smfmac_f32_16x16x64_bf16 v[56:59], v[24:27], v[176:183], v3
  v_smfmac_f32_16x16x64_bf16 v[60:63], v[24:27], v[232:239], v3
  v_smfmac_f32_16x16x64_bf16 v[36:39], v[28:31], a[40:47], v3
  v_smfmac_f32_16x16x64_bf16 v[40:43], v[28:31], a[96:103], v3
  v_smfmac_f32_16x16x64_bf16 v[44:47], v[28:31], a[152:159], v3
  v_smfmac_f32_16x16x64_bf16 v[48:51], v[28:31], a[208:215], v3
  v_smfmac_f32_16x16x64_bf16 v[52:55], v[28:31], v[128:135], v3
  v_smfmac_f32_16x16x64_bf16 v[56:59], v[28:31], v[184:191], v3
  v_smfmac_f32_16x16x64_bf16 v[60:63], v[28:31], v[240:247], v3
  v_smfmac_f32_16x16x64_bf16 v[36:39], v[32:35], a[48:55], v3
  v_smfmac_f32_16x16x64_bf16 v[40:43], v[32:35], a[104:111], v3
  v_smfmac_f32_16x16x64_bf16 v[44:47], v[32:35], a[160:167], v3
  v_smfmac_f32_16x16x64_bf16 v[48:51], v[32:35], a[216:223], v3
  v_smfmac_f32_16x16x64_bf16 v[52:55], v[32:35], v[136:143], v3
  v_smfmac_f32_16x16x64_bf16 v[56:59], v[32:35], v[192:199], v3
  v_smfmac_f32_16x16x64_bf16 v[60:63], v[32:35], v[248:255], v3
  v_permlane32_swap_b32 v36, v38
  v_permlane32_swap_b32 v37, v39
  v_add_f32 v36, v36, v38
  v_add_f32 v37, v37, v39
  v_cvt_pk_bf16_f32 v38, v36, v37
  ds_write_b32 v104, v38
  v_permlane32_swap_b32 v40, v42
  v_permlane32_swap_b32 v41, v43
  v_add_f32 v40, v40, v42
  v_add_f32 v41, v41, v43
  v_cvt_pk_bf16_f32 v42, v40, v41
  ds_write_b32 v105, v42
  v_permlane32_swap_b32 v44, v46
  v_permlane32_swap_b32 v45, v47
  v_add_f32 v44, v44, v46
  v_add_f32 v45, v45, v47
  v_cvt_pk_bf16_f32 v46, v44, v45
  ds_write_b32 v106, v46
  v_permlane32_swap_b32 v48, v50
  v_permlane32_swap_b32 v49, v51
  v_add_f32 v48, v48, v50
  v_add_f32 v49, v49, v51
  v_cvt_pk_bf16_f32 v50, v48, v49
  ds_write_b32 v107, v50
  v_permlane32_swap_b32 v52, v54
  v_permlane32_swap_b32 v53, v55
  v_add_f32 v52, v52, v54
  v_add_f32 v53, v53, v55
  v_cvt_pk_bf16_f32 v54, v52, v53
  ds_write_b32 v108, v54
  v_permlane32_swap_b32 v56, v58
  v_permlane32_swap_b32 v57, v59
  v_add_f32 v56, v56, v58
  v_add_f32 v57, v57, v59
  v_cvt_pk_bf16_f32 v58, v56, v57
  ds_write_b32 v109, v58
  v_permlane32_swap_b32 v60, v62
  v_permlane32_swap_b32 v61, v63
  v_add_f32 v60, v60, v62
  v_add_f32 v61, v61, v63
  v_cvt_pk_bf16_f32 v62, v60, v61
  ds_write_b32 v110, v62
  s_branch cA_va3_t2d
cA_va3_vor:
  s_sleep 2
  buffer_load_dword v101, off, s[8:11], s27 sc1
  s_add_u32 s30, s30, 1
  s_cmp_lt_u32 s30, 400000
  s_cbranch_scc1 cA_va3_vow
  s_branch cA_abort
cA_abort:
  v_mov_b32 v4, 0xdead
  v_mov_b32 v5, 16
  buffer_store_dword v4, v5, s[12:15], 0 offen
  s_branch ch_end
cA_done:
  s_branch ch_end
.p2align 6
cB_sc0_loop:
  s_mov_b32 s30, 0
  s_mov_b32 s62, 0
  s_setprio 3
  s_sleep 6
cB_sc0_fp_l:
  v_cmp_gt_u32 vcc, s19, v112
  buffer_load_dword v112, v0, s[8:11], 0 offen sc1
  s_cbranch_vccz cB_sc0_fp_d
  v_cmp_gt_u32 vcc, s19, v112
  buffer_load_dword v112, v0, s[8:11], 0 offen sc1
  s_cbranch_vccz cB_sc0_fp_d
  v_cmp_gt_u32 vcc, s19, v112
  buffer_load_dword v112, v0, s[8:11], 0 offen sc1
  s_cbranch_vccz cB_sc0_fp_d
  v_cmp_gt_u32 vcc, s19, v112
  buffer_load_dword v112, v0, s[8:11], 0 offen sc1
  s_cbranch_vccz cB_sc0_fp_d
  v_cmp_gt_u32 vcc, s19, v112
  buffer_load_dword v112, v0, s[8:11], 0 offen sc1
  s_cbranch_vccz cB_sc0_fp_d
  v_cmp_gt_u32 vcc, s19, v112
  buffer_load_dword v112, v0, s[8:11], 0 offen sc1
  s_cbranch_vccz cB_sc0_fp_d
  v_cmp_gt_u32 vcc, s19, v112
  buffer_load_dword v112, v0, s[8:11], 0 offen sc1
  s_cbranch_vccz cB_sc0_fp_d
  v_cmp_gt_u32 vcc, s19, v112
  buffer_load_dword v112, v0, s[8:11], 0 offen sc1
  s_cbranch_vccz cB_sc0_fp_d
  v_cmp_gt_u32 vcc, s19, v112
  buffer_load_dword v112, v0, s[8:11], 0 offen sc1
  s_cbranch_vccz cB_sc0_fp_d
  v_cmp_gt_u32 vcc, s19, v112
  buffer_load_dword v112, v0, s[8:11], 0 offen sc1
  s_cbranch_vccz cB_sc0_fp_d
  v_cmp_gt_u32 vcc, s19, v112
  buffer_load_dword v112, v0, s[8:11], 0 offen sc1
  s_cbranch_vccz cB_sc0_fp_d
  v_cmp_gt_u32 vcc, s19, v112
  buffer_load_dword v112, v0, s[8:11], 0 offen sc1
  s_cbranch_vccz cB_sc0_fp_d
  v_cmp_gt_u32 vcc, s19, v112
  buffer_load_dword v112, v0, s[8:11], 0 offen sc1
  s_cbranch_vccz cB_sc0_fp_d
  v_cmp_gt_u32 vcc, s19, v112
  buffer_load_dword v112, v0, s[8:11], 0 offen sc1
  s_cbranch_vccz cB_sc0_fp_d
  v_cmp_gt_u32 vcc, s19, v112
  buffer_load_dword v112, v0, s[8:11], 0 offen sc1
  s_cbranch_vccz cB_sc0_fp_d
  v_cmp_gt_u32 vcc, s19, v112
  buffer_load_dword v112, v0, s[8:11], 0 offen sc1
  s_cbranch_vccz cB_sc0_fp_d
  s_waitcnt vmcnt(24)
  s_add_u32 s30, s30, 1
  s_cmp_lt_u32 s30, 400000
  s_cbranch_scc1 cB_sc0_fp_l
  s_branch cB_abort
cB_sc0_fp_d:
  buffer_load_dwordx4 v[8:11], v2, s[8:11], s20 offen offset:0 sc1
  s_barrier
  s_setprio 2
  buffer_load_dwordx4 v[12:15], v2, s[8:11], s20 offen offset:1024 sc1
  s_setprio 1
  buffer_load_dwordx4 v[16:19], v2, s[8:11], s20 offen offset:2048 sc1
  s_setprio 0
  buffer_load_dwordx4 v[20:23], v2, s[8:11], s20 offen offset:3072 sc1
cB_sc0_go:
  s_waitcnt vmcnt(3)
  v_smfmac_f32_16x16x64_bf16 v[36:39], v[8:11], a[0:7], v3
  buffer_load_dwordx4 v[32:35], v2, s[8:11], s23 offen offset:0 sc1
  v_cmp_eq_u32 vcc, -1, v8
  v_smfmac_f32_16x16x64_bf16 v[40:43], v[8:11], a[56:63], v3
  v_smfmac_f32_16x16x64_bf16 v[44:47], v[8:11], a[112:119], v3
  buffer_load_dwordx4 v[24:27], v2, s[8:11], s23 offen offset:1024 sc1
  s_cbranch_vccnz cB_sc0_r0
  v_smfmac_f32_16x16x64_bf16 v[48:51], v[8:11], a[168:175], v3
  v_smfmac_f32_16x16x64_bf16 v[52:55], v[8:11], a[224:231], v3
  v_smfmac_f32_16x16x64_bf16 v[56:59], v[8:11], v[144:151], v3
  buffer_load_dwordx4 v[28:31], v2, s[8:11], s23 offen offset:2048 sc1
  v_smfmac_f32_16x16x64_bf16 v[60:63], v[8:11], v[200:207], v3
  s_waitcnt vmcnt(5)
  v_smfmac_f32_16x16x64_bf16 v[36:39], v[12:15], a[8:15], v3
  v_smfmac_f32_16x16x64_bf16 v[40:43], v[12:15], a[64:71], v3
  v_smfmac_f32_16x16x64_bf16 v[44:47], v[12:15], a[120:127], v3
  v_smfmac_f32_16x16x64_bf16 v[48:51], v[12:15], a[176:183], v3
  v_smfmac_f32_16x16x64_bf16 v[52:55], v[12:15], a[232:239], v3
  v_smfmac_f32_16x16x64_bf16 v[56:59], v[12:15], v[152:159], v3
  buffer_load_dwordx4 v[88:91], v117, s[8:11], s26 offen offset:0 sc1
  v_smfmac_f32_16x16x64_bf16 v[60:63], v[12:15], v[208:215], v3
  s_waitcnt vmcnt(5)
  v_smfmac_f32_16x16x64_bf16 v[36:39], v[16:19], a[16:23], v3
  v_smfmac_f32_16x16x64_bf16 v[40:43], v[16:19], a[72:79], v3
  v_smfmac_f32_16x16x64_bf16 v[44:47], v[16:19], a[128:135], v3
  buffer_load_dwordx4 v[92:95], v117, s[8:11], s26 offen offset:1024 sc1
  v_smfmac_f32_16x16x64_bf16 v[48:51], v[16:19], a[184:191], v3
  v_smfmac_f32_16x16x64_bf16 v[52:55], v[16:19], a[240:247], v3
  v_smfmac_f32_16x16x64_bf16 v[56:59], v[16:19], v[160:167], v3
  v_smfmac_f32_16x16x64_bf16 v[60:63], v[16:19], v[216:223], v3
  s_waitcnt vmcnt(5)
  buffer_load_dwordx4 v[96:99], v2, s[8:11], s24 offen offset:0 sc1
  v_smfmac_f32_16x16x64_bf16 v[36:39], v[20:23], a[24:31], v3
  v_smfmac_f32_16x16x64_bf16 v[40:43], v[20:23], a[80:87], v3
  v_max3_u32 v66, v12, v16, v20
  v_smfmac_f32_16x16x64_bf16 v[44:47], v[20:23], a[136:143], v3
  v_smfmac_f32_16x16x64_bf16 v[48:51], v[20:23], a[192:199], v3
  buffer_load_dwordx4 v[100:103], v2, s[8:11], s24 offen offset:1024 sc1
  v_smfmac_f32_16x16x64_bf16 v[52:55], v[20:23], a[248:255], v3
  v_smfmac_f32_16x16x64_bf16 v[56:59], v[20:23], v[168:175], v3
  v_smfmac_f32_16x16x64_bf16 v[60:63], v[20:23], v[224:231], v3
  s_waitcnt vmcnt(4)
  v_smfmac_f32_16x16x64_bf16 v[60:63], v[32:35], v[232:239], v3
  buffer_load_dwordx4 v[104:107], v2, s[8:11], s26 offen offset:0 sc1
  v_max3_u32 v66, v66, v24, v27
  v_smfmac_f32_16x16x64_bf16 v[60:63], v[24:27], v[240:247], v3
  v_max3_u32 v66, v66, v28, v31
  v_smfmac_f32_16x16x64_bf16 v[60:63], v[28:31], v[248:255], v3
  v_max3_u32 v66, v66, v32, v35
  v_smfmac_f32_16x16x64_bf16 v[52:55], v[32:35], v[120:127], v3
  v_cmp_eq_u32 vcc, -1, v66
  v_smfmac_f32_16x16x64_bf16 v[52:55], v[24:27], v[128:135], v3
  buffer_load_dwordx4 v[108:111], v2, s[8:11], s26 offen offset:1024 sc1
  v_smfmac_f32_16x16x64_bf16 v[52:55], v[28:31], v[136:143], v3
  s_cbranch_vccnz cB_sc0_r4
  v_cvt_pk_bf16_f32 v63, v62, v63
  v_smfmac_f32_16x16x64_bf16 v[56:59], v[32:35], v[176:183], v3
  v_cvt_pk_bf16_f32 v62, v60, v61
  v_smfmac_f32_16x16x64_bf16 v[56:59], v[24:27], v[184:191], v3
  v_mfma_f32_16x16x32_bf16 v[12:15], v[62:65], v[4:7], 0
  v_cvt_pk_bf16_f32 v55, v54, v55
  v_smfmac_f32_16x16x64_bf16 v[56:59], v[28:31], v[192:199], v3
  v_cvt_pk_bf16_f32 v54, v52, v53
  v_smfmac_f32_16x16x64_bf16 v[36:39], v[32:35], a[32:39], v3
  s_nop 1
  v_cvt_pk_bf16_f32 v76, v12, v13
  v_smfmac_f32_16x16x64_bf16 v[36:39], v[24:27], a[40:47], v3
  v_cvt_pk_bf16_f32 v77, v14, v15
  v_smfmac_f32_16x16x64_bf16 v[36:39], v[28:31], a[48:55], v3
  v_cvt_pk_bf16_f32 v56, v56, v57
  v_smfmac_f32_16x16x64_bf16 v[40:43], v[32:35], a[88:95], v3
  v_cvt_pk_bf16_f32 v57, v58, v59
  v_smfmac_f32_16x16x64_bf16 v[40:43], v[24:27], a[96:103], v3
  v_mfma_f32_16x16x32_bf16 v[16:19], v[54:57], v[4:7], 0
  v_cvt_pk_bf16_f32 v39, v38, v39
  v_smfmac_f32_16x16x64_bf16 v[40:43], v[28:31], a[104:111], v3
  v_cvt_pk_bf16_f32 v38, v36, v37
  v_smfmac_f32_16x16x64_bf16 v[44:47], v[32:35], a[144:151], v3
  s_nop 1
  v_cvt_pk_bf16_f32 v78, v16, v17
  v_smfmac_f32_16x16x64_bf16 v[44:47], v[24:27], a[152:159], v3
  v_cvt_pk_bf16_f32 v79, v18, v19
  v_smfmac_f32_16x16x64_bf16 v[44:47], v[28:31], a[160:167], v3
  v_cvt_pk_bf16_f32 v40, v40, v41
  v_smfmac_f32_16x16x64_bf16 v[48:51], v[32:35], a[200:207], v3
  v_cvt_pk_bf16_f32 v41, v42, v43
  v_smfmac_f32_16x16x64_bf16 v[48:51], v[24:27], a[208:215], v3
  v_smfmac_f32_16x16x64_bf16 v[48:51], v[28:31], a[216:223], v3
  s_waitcnt vmcnt(4)
  v_cvt_pk_bf16_f32 v47, v46, v47
  v_smfmac_f32_16x16x64_bf16 v[68:71], v[76:79], v[80:87], v3
  v_cvt_pk_bf16_f32 v46, v44, v45
  v_mfma_f32_16x16x32_bf16 v[12:15], v[38:41], v[4:7], 0
  s_nop 1
  v_cvt_pk_bf16_f32 v48, v48, v49
  v_cvt_pk_bf16_f32 v49, v50, v51
  s_nop 1
  v_mfma_f32_16x16x32_bf16 v[16:19], v[46:49], v[4:7], 0
  v_smfmac_f32_16x16x64_bf16 v[72:75], v[76:79], v[88:95], v3
  v_cvt_pk_bf16_f32 v20, v12, v13
  v_mfma_f32_16x16x32_bf16 v[52:55], v[30:33], v[76:79], 0
  s_waitcnt vmcnt(0)
  v_cvt_pk_bf16_f32 v21, v14, v15
  v_cvt_pk_bf16_f32 v22, v16, v17
  v_cvt_pk_bf16_f32 v23, v18, v19
  s_nop 1
  v_mfma_f32_16x16x32_bf16 v[52:55], v[8:11], v[20:23], v[52:55]
  v_smfmac_f32_16x16x64_bf16 v[68:71], v[20:23], v[96:103], v3
  v_smfmac_f32_16x16x64_bf16 v[72:75], v[20:23], v[104:111], v3
  s_nop 1
  ds_write_b128 v113, v[52:55]
  s_nop 1
  v_permlane32_swap_b32 v68, v70
  v_permlane32_swap_b32 v69, v71
  v_add_f32 v56, v68, v70
  v_add_f32 v58, v69, v71
  v_permlane32_swap_b32 v72, v74
  v_permlane32_swap_b32 v73, v75
  v_add_f32 v57, v72, v74
  v_add_f32 v59, v73, v75
  ds_write_b128 v2, v[56:59] offset:0
  v_cmp_u_f32 vcc, v57, v59
  v_mov_b32 v68, 0
  v_mov_b32 v69, 0
  v_mov_b32 v70, 0
  v_mov_b32 v71, 0
  s_cbranch_vccnz cB_sc0_retry
cB_sc0_cont:
  s_add_u32 s24, s24, 28672
  s_add_u32 s26, s26, 28672
  buffer_load_dwordx4 v[80:83], v117, s[8:11], s24 offen offset:0 sc1
  buffer_load_dwordx4 v[84:87], v117, s[8:11], s24 offen offset:1024 sc1
  v_mfma_f32_32x32x16_bf16 v[36:51], v[68:71], v[68:71], 0
  s_waitcnt lgkmcnt(0)
  s_barrier
  ds_read_b64 v[8:9], v114 offset:0
  ds_read_b64 v[10:11], v114 offset:1024
  ds_read_b64 v[12:13], v114 offset:2048
  ds_read_b64 v[14:15], v114 offset:3072
  ds_read2_b32 v[16:17], v115 offset0:0 offset1:64
  ds_read2_b32 v[18:19], v115 offset0:128 offset1:192
  v_mfma_f32_32x32x16_bf16 v[52:67], v[68:71], v[68:71], 0
  s_waitcnt lgkmcnt(0)
  v_pk_add_f32 v[16:17], v[16:17], v[18:19]
  v_pk_add_f32 v[8:9], v[8:9], v[10:11]
  v_pk_add_f32 v[12:13], v[12:13], v[14:15]
  v_add_f32 v20, v16, v17
  v_pk_add_f32 v[8:9], v[8:9], v[12:13]
  v_max_f32 v22, v8, v9
  v_add_f32_dpp v20, v20, v20 row_ror:8 row_mask:0xf bank_mask:0xf
  s_nop 0
  v_max_f32_dpp v22, v22, v22 row_ror:8 row_mask:0xf bank_mask:0xf
  v_max_f32 v22, v22, v20
  s_nop 1
  v_max_f32_dpp v22, v22, v22 quad_perm:[1,0,3,2] row_mask:0xf bank_mask:0xf
  s_nop 1
  v_max_f32_dpp v22, v22, v22 quad_perm:[2,3,0,1] row_mask:0xf bank_mask:0xf
  s_nop 1
  v_max_f32_dpp v22, v22, v22 row_half_mirror row_mask:0xf bank_mask:0xf
  v_pk_add_f32 v[8:9], v[8:9], v[22:23] op_sel_hi:[1,0] neg_lo:[0,1] neg_hi:[0,1]
  v_sub_f32 v20, v20, v22
  v_exp_f32 v8, v8
  v_exp_f32 v9, v9
  v_exp_f32 v20, v20
  v_add_f32 v24, v8, v9
  v_fmac_f32 v24, 0.5, v20
  v_mov_b32_dpp v21, v20 quad_perm:[1,0,3,2] row_mask:0xf bank_mask:0xf
  s_nop 0
  v_add_f32_dpp v24, v24, v24 quad_perm:[1,0,3,2] row_mask:0xf bank_mask:0xf
  s_nop 1
  v_add_f32_dpp v24, v24, v24 quad_perm:[2,3,0,1] row_mask:0xf bank_mask:0xf
  s_nop 1
  v_add_f32_dpp v24, v24, v24 row_half_mirror row_mask:0xf bank_mask:0xf
  s_nop 1
  v_add_f32_dpp v24, v24, v24 row_ror:8 row_mask:0xf bank_mask:0xf
  v_rcp_f32 v24, v24
  s_nop 0
  v_pk_mul_f32 v[8:9], v[8:9], v[24:25] op_sel_hi:[1,0]
  v_cvt_pk_bf16_f32 v8, abs(v8), abs(v9)
  buffer_store_dword v8, v1, s[8:11], s20 offen sc1
  v_pk_mul_f32 v[20:21], v[20:21], v[24:25] op_sel_hi:[1,0]
  v_cvt_pk_bf16_f32 v20, abs(v20), abs(v21)
  buffer_store_dword v20, v118, s[8:11], s20 offen sc1
  v_mov_b32 v72, 0
  v_mov_b32 v73, 0
  v_mov_b32 v74, 0
  v_mov_b32 v75, 0
  s_buffer_load_dword s64, s[8:11], s34 offset:0
  s_buffer_load_dword s65, s[8:11], s34 offset:64
  s_buffer_load_dword s66, s[8:11], s34 offset:128
  s_buffer_load_dword s67, s[8:11], s34 offset:192
  s_buffer_load_dword s64, s[8:11], s34 offset:256
  s_buffer_load_dword s65, s[8:11], s34 offset:320
  s_buffer_load_dword s66, s[8:11], s34 offset:384
  s_buffer_load_dword s67, s[8:11], s34 offset:448
  s_buffer_load_dword s64, s[8:11], s34 offset:512
  s_buffer_load_dword s65, s[8:11], s34 offset:576
  s_buffer_load_dword s66, s[8:11], s34 offset:640
  s_buffer_load_dword s67, s[8:11], s34 offset:704
  s_buffer_load_dword s64, s[8:11], s34 offset:768
  s_buffer_load_dword s65, s[8:11], s34 offset:832
  s_mov_b32 s36, s34
  s_add_u32 s34, s33, 458752
  s_mov_b32 s33, s34
  s_mov_b32 s19, s18
  s_add_u32 s18, s18, 1
  s_mov_b32 s22, s20
  s_mov_b32 s20, s21
  s_mov_b32 s21, s22
  s_add_u32 s23, s20, 4096
  s_cmp_lt_u32 s19, 63
  s_cbranch_scc1 cB_sc0_loop
  s_branch cB_done
cB_sc0_r0:
  s_add_u32 s31, s31, 1
  buffer_load_dwordx4 v[8:11], v2, s[8:11], s20 offen offset:0 sc1
  s_waitcnt vmcnt(0)
  v_cmp_eq_u32 vcc, -1, v8
  v_mov_b32 v36, 0
  v_mov_b32 v37, 0
  v_mov_b32 v38, 0
  v_mov_b32 v39, 0
  v_mov_b32 v40, 0
  v_mov_b32 v41, 0
  v_mov_b32 v42, 0
  v_mov_b32 v43, 0
  v_mov_b32 v44, 0
  v_mov_b32 v45, 0
  v_mov_b32 v46, 0
  v_mov_b32 v47, 0
  v_mov_b32 v48, 0
  v_mov_b32 v49, 0
  v_mov_b32 v50, 0
  v_mov_b32 v51, 0
  s_nop 1
  s_cbranch_vccz cB_sc0_go
  s_add_u32 s30, s30, 1
  s_cmp_lt_u32 s30, 400000
  s_cbranch_scc1 cB_sc0_r0
  s_branch cB_abort
cB_sc0_r4:
  s_add_u32 s31, s31, 1
  buffer_load_dwordx4 v[12:15], v2, s[8:11], s20 offen offset:1024 sc1
  buffer_load_dwordx4 v[16:19], v2, s[8:11], s20 offen offset:2048 sc1
  buffer_load_dwordx4 v[20:23], v2, s[8:11], s20 offen offset:3072 sc1
  buffer_load_dwordx4 v[32:35], v2, s[8:11], s23 offen offset:0 sc1
  buffer_load_dwordx4 v[24:27], v2, s[8:11], s23 offen offset:1024 sc1
  buffer_load_dwordx4 v[28:31], v2, s[8:11], s23 offen offset:2048 sc1
  s_waitcnt vmcnt(0)
  v_max3_u32 v66, v12, v16, v20
  v_max3_u32 v66, v66, v24, v27
  v_max3_u32 v66, v66, v28, v31
  v_max3_u32 v66, v66, v32, v35
  v_cmp_eq_u32 vcc, -1, v66
  s_nop 4
  s_cbranch_vccz cB_sc0_rz
  s_add_u32 s30, s30, 1
  s_cmp_lt_u32 s30, 400000
  s_cbranch_scc1 cB_sc0_r4
  s_branch cB_abort
cB_sc0_retry:
  s_cmp_lg_u32 s62, 0
  s_cbranch_scc1 cB_sc0_cont
  s_waitcnt vmcnt(0) lgkmcnt(0)
cB_sc0_rv:
  buffer_load_dwordx4 v[8:11], v2, s[8:11], s20 offen offset:0 sc1
  buffer_load_dwordx4 v[12:15], v2, s[8:11], s20 offen offset:1024 sc1
  buffer_load_dwordx4 v[16:19], v2, s[8:11], s20 offen offset:2048 sc1
  buffer_load_dwordx4 v[20:23], v2, s[8:11], s20 offen offset:3072 sc1
  buffer_load_dwordx4 v[32:35], v2, s[8:11], s23 offen offset:0 sc1
  buffer_load_dwordx4 v[24:27], v2, s[8:11], s23 offen offset:1024 sc1
  buffer_load_dwordx4 v[28:31], v2, s[8:11], s23 offen offset:2048 sc1
  s_waitcnt vmcnt(0)
  v_max3_u32 v66, v8, v9, v10
  v_max3_u32 v66, v66, v11, v12
  v_max3_u32 v66, v66, v13, v14
  v_max3_u32 v66, v66, v15, v16
  v_max3_u32 v66, v66, v17, v18
  v_max3_u32 v66, v66, v19, v20
  v_max3_u32 v66, v66, v21, v22
  v_max3_u32 v66, v66, v23, v24
  v_max3_u32 v66, v66, v25, v26
  v_max3_u32 v66, v66, v27, v28
  v_max3_u32 v66, v66, v29, v30
  v_max3_u32 v66, v66, v31, v32
  v_max3_u32 v66, v66, v33, v34
  v_max_u32 v66, v66, v35
  v_cmp_eq_u32 vcc, -1, v66
  s_cbranch_vccz cB_sc0_rk
  s_add_u32 s30, s30, 1
  s_cmp_lt_u32 s30, 400000
  s_cbranch_scc1 cB_sc0_rv
  s_branch cB_abort
cB_sc0_rk:
  s_mov_b32 s62, 1
  s_add_u32 s31, s31, 0x100
cB_sc0_rz:
  v_mov_b32 v36, 0
  v_mov_b32 v37, 0
  v_mov_b32 v38, 0
  v_mov_b32 v39, 0
  v_mov_b32 v40, 0
  v_mov_b32 v41, 0
  v_mov_b32 v42, 0
  v_mov_b32 v43, 0
  v_mov_b32 v44, 0
  v_mov_b32 v45, 0
  v_mov_b32 v46, 0
  v_mov_b32 v47, 0
  v_mov_b32 v48, 0
  v_mov_b32 v49, 0
  v_mov_b32 v50, 0
  v_mov_b32 v51, 0
  v_mov_b32 v60, 0
  v_mov_b32 v61, 0
  v_mov_b32 v62, 0
  v_mov_b32 v63, 0
  v_mov_b32 v68, 0
  v_mov_b32 v69, 0
  v_mov_b32 v70, 0
  v_mov_b32 v71, 0
  v_mov_b32 v72, 0
  v_mov_b32 v73, 0
  v_mov_b32 v74, 0
  v_mov_b32 v75, 0
  v_mov_b32 v52, 0
  v_mov_b32 v53, 0
  v_mov_b32 v54, 0
  v_mov_b32 v55, 0
  v_mov_b32 v56, 0
  v_mov_b32 v57, 0
  v_mov_b32 v58, 0
  v_mov_b32 v59, 0
  s_nop 1
  s_branch cB_sc0_go
.p2align 6
cB_sc1_loop:
  s_mov_b32 s30, 0
  s_mov_b32 s62, 0
  s_setprio 3
  s_barrier
  buffer_load_dwordx4 v[12:15], v2, s[8:11], s20 offen offset:1024 sc1
  s_setprio 2
  buffer_load_dwordx4 v[16:19], v2, s[8:11], s20 offen offset:2048 sc1
  s_setprio 1
  buffer_load_dwordx4 v[20:23], v2, s[8:11], s20 offen offset:3072 sc1
  s_setprio 0
  buffer_load_dwordx4 v[8:11], v2, s[8:11], s20 offen offset:0 sc1
cB_sc1_go:
  s_waitcnt vmcnt(3)
  v_smfmac_f32_16x16x64_bf16 v[36:39], v[12:15], a[8:15], v3
  buffer_load_dwordx4 v[24:27], v2, s[8:11], s23 offen offset:1024 sc1
  v_cmp_eq_u32 vcc, -1, v12
  v_smfmac_f32_16x16x64_bf16 v[40:43], v[12:15], a[64:71], v3
  v_smfmac_f32_16x16x64_bf16 v[44:47], v[12:15], a[120:127], v3
  buffer_load_dwordx4 v[32:35], v2, s[8:11], s23 offen offset:2048 sc1
  s_cbranch_vccnz cB_sc1_r0
  v_smfmac_f32_16x16x64_bf16 v[48:51], v[12:15], a[176:183], v3
  v_smfmac_f32_16x16x64_bf16 v[52:55], v[12:15], a[232:239], v3
  v_smfmac_f32_16x16x64_bf16 v[56:59], v[12:15], v[152:159], v3
  buffer_load_dwordx4 v[28:31], v2, s[8:11], s23 offen offset:0 sc1
  v_smfmac_f32_16x16x64_bf16 v[60:63], v[12:15], v[208:215], v3
  s_waitcnt vmcnt(5)
  v_smfmac_f32_16x16x64_bf16 v[36:39], v[16:19], a[16:23], v3
  v_smfmac_f32_16x16x64_bf16 v[40:43], v[16:19], a[72:79], v3
  v_smfmac_f32_16x16x64_bf16 v[44:47], v[16:19], a[128:135], v3
  v_smfmac_f32_16x16x64_bf16 v[48:51], v[16:19], a[184:191], v3
  v_smfmac_f32_16x16x64_bf16 v[52:55], v[16:19], a[240:247], v3
  v_smfmac_f32_16x16x64_bf16 v[56:59], v[16:19], v[160:167], v3
  buffer_load_dwordx4 v[88:91], v117, s[8:11], s26 offen offset:0 sc1
  v_smfmac_f32_16x16x64_bf16 v[60:63], v[16:19], v[216:223], v3
  s_waitcnt vmcnt(5)
  v_smfmac_f32_16x16x64_bf16 v[36:39], v[20:23], a[24:31], v3
  v_smfmac_f32_16x16x64_bf16 v[40:43], v[20:23], a[80:87], v3
  v_smfmac_f32_16x16x64_bf16 v[44:47], v[20:23], a[136:143], v3
  buffer_load_dwordx4 v[92:95], v117, s[8:11], s26 offen offset:1024 sc1
  v_smfmac_f32_16x16x64_bf16 v[48:51], v[20:23], a[192:199], v3
  v_smfmac_f32_16x16x64_bf16 v[52:55], v[20:23], a[248:255], v3
  v_smfmac_f32_16x16x64_bf16 v[56:59], v[20:23], v[168:175], v3
  v_smfmac_f32_16x16x64_bf16 v[60:63], v[20:23], v[224:231], v3
  s_waitcnt vmcnt(5)
  buffer_load_dwordx4 v[96:99], v2, s[8:11], s24 offen offset:0 sc1
  v_smfmac_f32_16x16x64_bf16 v[36:39], v[8:11], a[0:7], v3
  v_smfmac_f32_16x16x64_bf16 v[40:43], v[8:11], a[56:63], v3
  v_max3_u32 v66, v16, v20, v8
  v_smfmac_f32_16x16x64_bf16 v[44:47], v[8:11], a[112:119], v3
  v_smfmac_f32_16x16x64_bf16 v[48:51], v[8:11], a[168:175], v3
  buffer_load_dwordx4 v[100:103], v2, s[8:11], s24 offen offset:1024 sc1
  v_smfmac_f32_16x16x64_bf16 v[52:55], v[8:11], a[224:231], v3
  v_smfmac_f32_16x16x64_bf16 v[56:59], v[8:11], v[144:151], v3
  v_smfmac_f32_16x16x64_bf16 v[60:63], v[8:11], v[200:207], v3
  s_waitcnt vmcnt(4)
  v_smfmac_f32_16x16x64_bf16 v[60:63], v[28:31], v[232:239], v3
  buffer_load_dwordx4 v[104:107], v2, s[8:11], s26 offen offset:0 sc1
  v_max3_u32 v66, v66, v24, v27
  v_smfmac_f32_16x16x64_bf16 v[60:63], v[24:27], v[240:247], v3
  v_max3_u32 v66, v66, v28, v31
  v_smfmac_f32_16x16x64_bf16 v[60:63], v[32:35], v[248:255], v3
  v_max3_u32 v66, v66, v32, v35
  v_smfmac_f32_16x16x64_bf16 v[52:55], v[28:31], v[120:127], v3
  v_cmp_eq_u32 vcc, -1, v66
  v_smfmac_f32_16x16x64_bf16 v[52:55], v[24:27], v[128:135], v3
  buffer_load_dwordx4 v[108:111], v2, s[8:11], s26 offen offset:1024 sc1
  v_smfmac_f32_16x16x64_bf16 v[52:55], v[32:35], v[136:143], v3
  s_cbranch_vccnz cB_sc1_r4
  v_cvt_pk_bf16_f32 v63, v62, v63
  v_smfmac_f32_16x16x64_bf16 v[56:59], v[28:31], v[176:183], v3
  v_cvt_pk_bf16_f32 v62, v60, v61
  v_smfmac_f32_16x16x64_bf16 v[56:59], v[24:27], v[184:191], v3
  v_mfma_f32_16x16x32_bf16 v[8:11], v[62:65], v[4:7], 0
  v_cvt_pk_bf16_f32 v55, v54, v55
  v_smfmac_f32_16x16x64_bf16 v[56:59], v[32:35], v[192:199], v3
  v_cvt_pk_bf16_f32 v54, v52, v53
  v_smfmac_f32_16x16x64_bf16 v[36:39], v[28:31], a[32:39], v3
  s_nop 1
  v_cvt_pk_bf16_f32 v78, v8, v9
  v_smfmac_f32_16x16x64_bf16 v[36:39], v[24:27], a[40:47], v3
  v_cvt_pk_bf16_f32 v79, v10, v11
  v_smfmac_f32_16x16x64_bf16 v[36:39], v[32:35], a[48:55], v3
  v_cvt_pk_bf16_f32 v56, v56, v57
  v_smfmac_f32_16x16x64_bf16 v[40:43], v[28:31], a[88:95], v3
  v_cvt_pk_bf16_f32 v57, v58, v59
  v_smfmac_f32_16x16x64_bf16 v[40:43], v[24:27], a[96:103], v3
  v_mfma_f32_16x16x32_bf16 v[16:19], v[54:57], v[4:7], 0
  v_cvt_pk_bf16_f32 v39, v38, v39
  v_smfmac_f32_16x16x64_bf16 v[40:43], v[32:35], a[104:111], v3
  v_cvt_pk_bf16_f32 v38, v36, v37
  v_smfmac_f32_16x16x64_bf16 v[44:47], v[28:31], a[144:151], v3
  s_nop 1
  v_cvt_pk_bf16_f32 v76, v16, v17
  v_smfmac_f32_16x16x64_bf16 v[44:47], v[24:27], a[152:159], v3
  v_cvt_pk_bf16_f32 v77, v18, v19
  v_smfmac_f32_16x16x64_bf16 v[44:47], v[32:35], a[160:167], v3
  v_cvt_pk_bf16_f32 v40, v40, v41
  v_smfmac_f32_16x16x64_bf16 v[48:51], v[28:31], a[200:207], v3
  v_cvt_pk_bf16_f32 v41, v42, v43
  v_smfmac_f32_16x16x64_bf16 v[48:51], v[24:27], a[208:215], v3
  v_smfmac_f32_16x16x64_bf16 v[48:51], v[32:35], a[216:223], v3
  s_waitcnt vmcnt(4)
  v_cvt_pk_bf16_f32 v47, v46, v47
  v_smfmac_f32_16x16x64_bf16 v[68:71], v[76:79], v[80:87], v3
  v_cvt_pk_bf16_f32 v46, v44, v45
  v_mfma_f32_16x16x32_bf16 v[8:11], v[38:41], v[4:7], 0
  s_nop 1
  v_cvt_pk_bf16_f32 v48, v48, v49
  v_cvt_pk_bf16_f32 v49, v50, v51
  s_nop 1
  v_mfma_f32_16x16x32_bf16 v[16:19], v[46:49], v[4:7], 0
  v_smfmac_f32_16x16x64_bf16 v[72:75], v[76:79], v[88:95], v3
  v_cvt_pk_bf16_f32 v20, v8, v9
  v_mfma_f32_16x16x32_bf16 v[52:55], v[30:33], v[76:79], 0
  s_waitcnt vmcnt(0)
  v_cvt_pk_bf16_f32 v21, v10, v11
  v_cvt_pk_bf16_f32 v22, v16, v17
  v_cvt_pk_bf16_f32 v23, v18, v19
  s_nop 1
  v_mfma_f32_16x16x32_bf16 v[52:55], v[12:15], v[20:23], v[52:55]
  v_smfmac_f32_16x16x64_bf16 v[68:71], v[20:23], v[96:103], v3
  v_smfmac_f32_16x16x64_bf16 v[72:75], v[20:23], v[104:111], v3
  s_nop 1
  ds_write_b128 v113, v[52:55]
  s_nop 1
  v_permlane32_swap_b32 v68, v70
  v_permlane32_swap_b32 v69, v71
  v_add_f32 v56, v68, v70
  v_add_f32 v58, v69, v71
  v_permlane32_swap_b32 v72, v74
  v_permlane32_swap_b32 v73, v75
  v_add_f32 v57, v72, v74
  v_add_f32 v59, v73, v75
  ds_write_b128 v2, v[56:59] offset:1024
  v_cmp_u_f32 vcc, v57, v59
  v_mov_b32 v68, 0
  v_mov_b32 v69, 0
  v_mov_b32 v70, 0
  v_mov_b32 v71, 0
  s_cbranch_vccnz cB_sc1_retry
cB_sc1_cont:
  s_add_u32 s24, s24, 28672
  s_add_u32 s26, s26, 28672
  buffer_load_dwordx4 v[80:83], v117, s[8:11], s24 offen offset:0 sc1
  buffer_load_dwordx4 v[84:87], v117, s[8:11], s24 offen offset:1024 sc1
  v_mfma_f32_32x32x16_bf16 v[36:51], v[68:71], v[68:71], 0
  s_waitcnt lgkmcnt(0)
  s_barrier
  ds_read_b64 v[8:9], v114 offset:0
  ds_read_b64 v[10:11], v114 offset:1024
  ds_read_b64 v[12:13], v114 offset:2048
  ds_read_b64 v[14:15], v114 offset:3072
  ds_read2_b32 v[16:17], v115 offset0:0 offset1:64
  ds_read2_b32 v[18:19], v115 offset0:128 offset1:192
  v_mfma_f32_32x32x16_bf16 v[52:67], v[68:71], v[68:71], 0
  s_waitcnt lgkmcnt(0)
  v_pk_add_f32 v[16:17], v[16:17], v[18:19]
  v_pk_add_f32 v[8:9], v[8:9], v[10:11]
  v_pk_add_f32 v[12:13], v[12:13], v[14:15]
  v_add_f32 v20, v16, v17
  v_pk_add_f32 v[8:9], v[8:9], v[12:13]
  v_max_f32 v22, v8, v9
  v_add_f32_dpp v20, v20, v20 row_ror:8 row_mask:0xf bank_mask:0xf
  s_nop 0
  v_max_f32_dpp v22, v22, v22 row_ror:8 row_mask:0xf bank_mask:0xf
  v_max_f32 v22, v22, v20
  s_nop 1
  v_max_f32_dpp v22, v22, v22 quad_perm:[1,0,3,2] row_mask:0xf bank_mask:0xf
  s_nop 1
  v_max_f32_dpp v22, v22, v22 quad_perm:[2,3,0,1] row_mask:0xf bank_mask:0xf
  buffer_store_dword v112, v116, s[8:11], 0 offen sc1
  s_nop 0
  v_max_f32_dpp v22, v22, v22 row_half_mirror row_mask:0xf bank_mask:0xf
  v_pk_add_f32 v[8:9], v[8:9], v[22:23] op_sel_hi:[1,0] neg_lo:[0,1] neg_hi:[0,1]
  v_sub_f32 v20, v20, v22
  v_exp_f32 v8, v8
  v_exp_f32 v9, v9
  v_exp_f32 v20, v20
  v_add_f32 v24, v8, v9
  v_fmac_f32 v24, 0.5, v20
  v_mov_b32_dpp v21, v20 quad_perm:[1,0,3,2] row_mask:0xf bank_mask:0xf
  s_nop 0
  v_add_f32_dpp v24, v24, v24 quad_perm:[1,0,3,2] row_mask:0xf bank_mask:0xf
  s_nop 1
  v_add_f32_dpp v24, v24, v24 quad_perm:[2,3,0,1] row_mask:0xf bank_mask:0xf
  s_nop 1
  v_add_f32_dpp v24, v24, v24 row_half_mirror row_mask:0xf bank_mask:0xf
  s_nop 1
  v_add_f32_dpp v24, v24, v24 row_ror:8 row_mask:0xf bank_mask:0xf
  v_rcp_f32 v24, v24
  s_nop 0
  v_pk_mul_f32 v[8:9], v[8:9], v[24:25] op_sel_hi:[1,0]
  v_cvt_pk_bf16_f32 v8, abs(v8), abs(v9)
  buffer_store_dword v8, v1, s[8:11], s20 offen sc1
  v_pk_mul_f32 v[20:21], v[20:21], v[24:25] op_sel_hi:[1,0]
  v_cvt_pk_bf16_f32 v20, abs(v20), abs(v21)
  buffer_store_dword v20, v118, s[8:11], s20 offen sc1
  v_mov_b32 v72, 0
  v_mov_b32 v73, 0
  v_mov_b32 v74, 0
  v_mov_b32 v75, 0
  s_buffer_load_dword s64, s[8:11], s34 offset:896
  s_buffer_load_dword s65, s[8:11], s34 offset:960
  s_buffer_load_dword s66, s[8:11], s34 offset:1024
  s_buffer_load_dword s67, s[8:11], s34 offset:1088
  s_buffer_load_dword s64, s[8:11], s34 offset:1152
  s_buffer_load_dword s65, s[8:11], s34 offset:1216
  s_buffer_load_dword s66, s[8:11], s34 offset:1280
  s_buffer_load_dword s67, s[8:11], s34 offset:1344
  s_buffer_load_dword s64, s[8:11], s34 offset:1408
  s_buffer_load_dword s65, s[8:11], s34 offset:1472
  s_buffer_load_dword s66, s[8:11], s34 offset:1536
  s_buffer_load_dword s67, s[8:11], s34 offset:1600
  s_buffer_load_dword s64, s[8:11], s34 offset:1664
  s_buffer_load_dword s65, s[8:11], s34 offset:1728
  s_mov_b32 s36, s34
  s_add_u32 s34, s33, 458752
  s_mov_b32 s33, s34
  s_mov_b32 s19, s18
  s_add_u32 s18, s18, 1
  s_mov_b32 s22, s20
  s_mov_b32 s20, s21
  s_mov_b32 s21, s22
  s_add_u32 s23, s20, 4096
  v_mov_b32 v112, s18
  s_cmp_lt_u32 s19, 63
  s_nop 0
  s_cbranch_scc1 cB_sc1_loop
  s_branch cB_done
cB_sc1_r0:
  s_add_u32 s31, s31, 1
  buffer_load_dwordx4 v[12:15], v2, s[8:11], s20 offen offset:1024 sc1
  s_waitcnt vmcnt(0)
  v_cmp_eq_u32 vcc, -1, v12
  v_mov_b32 v36, 0
  v_mov_b32 v37, 0
  v_mov_b32 v38, 0
  v_mov_b32 v39, 0
  v_mov_b32 v40, 0
  v_mov_b32 v41, 0
  v_mov_b32 v42, 0
  v_mov_b32 v43, 0
  v_mov_b32 v44, 0
  v_mov_b32 v45, 0
  v_mov_b32 v46, 0
  v_mov_b32 v47, 0
  v_mov_b32 v48, 0
  v_mov_b32 v49, 0
  v_mov_b32 v50, 0
  v_mov_b32 v51, 0
  s_nop 1
  s_cbranch_vccz cB_sc1_go
  s_add_u32 s30, s30, 1
  s_cmp_lt_u32 s30, 400000
  s_cbranch_scc1 cB_sc1_r0
  s_branch cB_abort
cB_sc1_r4:
  s_add_u32 s31, s31, 1
  buffer_load_dwordx4 v[16:19], v2, s[8:11], s20 offen offset:2048 sc1
  buffer_load_dwordx4 v[20:23], v2, s[8:11], s20 offen offset:3072 sc1
  buffer_load_dwordx4 v[8:11], v2, s[8:11], s20 offen offset:0 sc1
  buffer_load_dwordx4 v[28:31], v2, s[8:11], s23 offen offset:0 sc1
  buffer_load_dwordx4 v[24:27], v2, s[8:11], s23 offen offset:1024 sc1
  buffer_load_dwordx4 v[32:35], v2, s[8:11], s23 offen offset:2048 sc1
  s_waitcnt vmcnt(0)
  v_max3_u32 v66, v16, v20, v8
  v_max3_u32 v66, v66, v24, v27
  v_max3_u32 v66, v66, v28, v31
  v_max3_u32 v66, v66, v32, v35
  v_cmp_eq_u32 vcc, -1, v66
  s_nop 4
  s_cbranch_vccz cB_sc1_rz
  s_add_u32 s30, s30, 1
  s_cmp_lt_u32 s30, 400000
  s_cbranch_scc1 cB_sc1_r4
  s_branch cB_abort
cB_sc1_retry:
  s_cmp_lg_u32 s62, 0
  s_cbranch_scc1 cB_sc1_cont
  s_waitcnt vmcnt(0) lgkmcnt(0)
cB_sc1_rv:
  buffer_load_dwordx4 v[8:11], v2, s[8:11], s20 offen offset:0 sc1
  buffer_load_dwordx4 v[12:15], v2, s[8:11], s20 offen offset:1024 sc1
  buffer_load_dwordx4 v[16:19], v2, s[8:11], s20 offen offset:2048 sc1
  buffer_load_dwordx4 v[20:23], v2, s[8:11], s20 offen offset:3072 sc1
  buffer_load_dwordx4 v[28:31], v2, s[8:11], s23 offen offset:0 sc1
  buffer_load_dwordx4 v[24:27], v2, s[8:11], s23 offen offset:1024 sc1
  buffer_load_dwordx4 v[32:35], v2, s[8:11], s23 offen offset:2048 sc1
  s_waitcnt vmcnt(0)
  v_max3_u32 v66, v8, v9, v10
  v_max3_u32 v66, v66, v11, v12
  v_max3_u32 v66, v66, v13, v14
  v_max3_u32 v66, v66, v15, v16
  v_max3_u32 v66, v66, v17, v18
  v_max3_u32 v66, v66, v19, v20
  v_max3_u32 v66, v66, v21, v22
  v_max3_u32 v66, v66, v23, v24
  v_max3_u32 v66, v66, v25, v26
  v_max3_u32 v66, v66, v27, v28
  v_max3_u32 v66, v66, v29, v30
  v_max3_u32 v66, v66, v31, v32
  v_max3_u32 v66, v66, v33, v34
  v_max_u32 v66, v66, v35
  v_cmp_eq_u32 vcc, -1, v66
  s_cbranch_vccz cB_sc1_rk
  s_add_u32 s30, s30, 1
  s_cmp_lt_u32 s30, 400000
  s_cbranch_scc1 cB_sc1_rv
  s_branch cB_abort
cB_sc1_rk:
  s_mov_b32 s62, 1
  s_add_u32 s31, s31, 0x100
cB_sc1_rz:
  v_mov_b32 v36, 0
  v_mov_b32 v37, 0
  v_mov_b32 v38, 0
  v_mov_b32 v39, 0
  v_mov_b32 v40, 0
  v_mov_b32 v41, 0
  v_mov_b32 v42, 0
  v_mov_b32 v43, 0
  v_mov_b32 v44, 0
  v_mov_b32 v45, 0
  v_mov_b32 v46, 0
  v_mov_b32 v47, 0
  v_mov_b32 v48, 0
  v_mov_b32 v49, 0
  v_mov_b32 v50, 0
  v_mov_b32 v51, 0
  v_mov_b32 v60, 0
  v_mov_b32 v61, 0
  v_mov_b32 v62, 0
  v_mov_b32 v63, 0
  v_mov_b32 v68, 0
  v_mov_b32 v69, 0
  v_mov_b32 v70, 0
  v_mov_b32 v71, 0
  v_mov_b32 v72, 0
  v_mov_b32 v73, 0
  v_mov_b32 v74, 0
  v_mov_b32 v75, 0
  v_mov_b32 v52, 0
  v_mov_b32 v53, 0
  v_mov_b32 v54, 0
  v_mov_b32 v55, 0
  v_mov_b32 v56, 0
  v_mov_b32 v57, 0
  v_mov_b32 v58, 0
  v_mov_b32 v59, 0
  s_nop 1
  s_branch cB_sc1_go
.p2align 6
cB_sc2_loop:
  s_mov_b32 s30, 0
  s_mov_b32 s62, 0
  s_setprio 3
  s_barrier
  buffer_load_dwordx4 v[16:19], v2, s[8:11], s20 offen offset:2048 sc1
  s_setprio 2
  buffer_load_dwordx4 v[20:23], v2, s[8:11], s20 offen offset:3072 sc1
  s_setprio 1
  buffer_load_dwordx4 v[8:11], v2, s[8:11], s20 offen offset:0 sc1
  s_setprio 0
  buffer_load_dwordx4 v[12:15], v2, s[8:11], s20 offen offset:1024 sc1
cB_sc2_go:
  s_waitcnt vmcnt(3)
  v_smfmac_f32_16x16x64_bf16 v[36:39], v[16:19], a[16:23], v3
  buffer_load_dwordx4 v[28:31], v2, s[8:11], s23 offen offset:2048 sc1
  v_cmp_eq_u32 vcc, -1, v16
  v_smfmac_f32_16x16x64_bf16 v[40:43], v[16:19], a[72:79], v3
  v_smfmac_f32_16x16x64_bf16 v[44:47], v[16:19], a[128:135], v3
  buffer_load_dwordx4 v[24:27], v2, s[8:11], s23 offen offset:0 sc1
  s_cbranch_vccnz cB_sc2_r0
  v_smfmac_f32_16x16x64_bf16 v[48:51], v[16:19], a[184:191], v3
  v_smfmac_f32_16x16x64_bf16 v[52:55], v[16:19], a[240:247], v3
  v_smfmac_f32_16x16x64_bf16 v[56:59], v[16:19], v[160:167], v3
  buffer_load_dwordx4 v[32:35], v2, s[8:11], s23 offen offset:1024 sc1
  v_smfmac_f32_16x16x64_bf16 v[62:65], v[16:19], v[216:223], v3
  s_waitcnt vmcnt(5)
  v_smfmac_f32_16x16x64_bf16 v[36:39], v[20:23], a[24:31], v3
  v_smfmac_f32_16x16x64_bf16 v[40:43], v[20:23], a[80:87], v3
  v_smfmac_f32_16x16x64_bf16 v[44:47], v[20:23], a[136:143], v3
  v_smfmac_f32_16x16x64_bf16 v[48:51], v[20:23], a[192:199], v3
  v_smfmac_f32_16x16x64_bf16 v[52:55], v[20:23], a[248:255], v3
  v_smfmac_f32_16x16x64_bf16 v[56:59], v[20:23], v[168:175], v3
  buffer_load_dwordx4 v[88:91], v117, s[8:11], s26 offen offset:0 sc1
  v_smfmac_f32_16x16x64_bf16 v[62:65], v[20:23], v[224:231], v3
  s_waitcnt vmcnt(5)
  v_smfmac_f32_16x16x64_bf16 v[36:39], v[8:11], a[0:7], v3
  v_smfmac_f32_16x16x64_bf16 v[40:43], v[8:11], a[56:63], v3
  v_smfmac_f32_16x16x64_bf16 v[44:47], v[8:11], a[112:119], v3
  buffer_load_dwordx4 v[92:95], v117, s[8:11], s26 offen offset:1024 sc1
  v_smfmac_f32_16x16x64_bf16 v[48:51], v[8:11], a[168:175], v3
  v_smfmac_f32_16x16x64_bf16 v[52:55], v[8:11], a[224:231], v3
  v_smfmac_f32_16x16x64_bf16 v[56:59], v[8:11], v[144:151], v3
  v_smfmac_f32_16x16x64_bf16 v[62:65], v[8:11], v[200:207], v3
  s_waitcnt vmcnt(5)
  buffer_load_dwordx4 v[96:99], v2, s[8:11], s24 offen offset:0 sc1
  v_smfmac_f32_16x16x64_bf16 v[36:39], v[12:15], a[8:15], v3
  v_smfmac_f32_16x16x64_bf16 v[40:43], v[12:15], a[64:71], v3
  v_max3_u32 v66, v20, v8, v12
  v_smfmac_f32_16x16x64_bf16 v[44:47], v[12:15], a[120:127], v3
  v_smfmac_f32_16x16x64_bf16 v[48:51], v[12:15], a[176:183], v3
  buffer_load_dwordx4 v[100:103], v2, s[8:11], s24 offen offset:1024 sc1
  v_smfmac_f32_16x16x64_bf16 v[52:55], v[12:15], a[232:239], v3
  v_smfmac_f32_16x16x64_bf16 v[56:59], v[12:15], v[152:159], v3
  v_smfmac_f32_16x16x64_bf16 v[62:65], v[12:15], v[208:215], v3
  s_waitcnt vmcnt(4)
  v_smfmac_f32_16x16x64_bf16 v[62:65], v[24:27], v[232:239], v3
  buffer_load_dwordx4 v[104:107], v2, s[8:11], s26 offen offset:0 sc1
  v_max3_u32 v66, v66, v24, v27
  v_smfmac_f32_16x16x64_bf16 v[62:65], v[32:35], v[240:247], v3
  v_max3_u32 v66, v66, v28, v31
  v_smfmac_f32_16x16x64_bf16 v[62:65], v[28:31], v[248:255], v3
  v_max3_u32 v66, v66, v32, v35
  v_smfmac_f32_16x16x64_bf16 v[52:55], v[24:27], v[120:127], v3
  v_cmp_eq_u32 vcc, -1, v66
  v_smfmac_f32_16x16x64_bf16 v[52:55], v[32:35], v[128:135], v3
  buffer_load_dwordx4 v[108:111], v2, s[8:11], s26 offen offset:1024 sc1
  v_smfmac_f32_16x16x64_bf16 v[52:55], v[28:31], v[136:143], v3
  s_cbranch_vccnz cB_sc2_r4
  v_cvt_pk_bf16_f32 v62, v62, v63
  v_smfmac_f32_16x16x64_bf16 v[56:59], v[24:27], v[176:183], v3
  v_cvt_pk_bf16_f32 v63, v64, v65
  v_smfmac_f32_16x16x64_bf16 v[56:59], v[32:35], v[184:191], v3
  v_mfma_f32_16x16x32_bf16 v[8:11], v[60:63], v[4:7], 0
  v_cvt_pk_bf16_f32 v55, v54, v55
  v_smfmac_f32_16x16x64_bf16 v[56:59], v[28:31], v[192:199], v3
  v_cvt_pk_bf16_f32 v54, v52, v53
  v_smfmac_f32_16x16x64_bf16 v[36:39], v[24:27], a[32:39], v3
  s_nop 1
  v_cvt_pk_bf16_f32 v76, v8, v9
  v_smfmac_f32_16x16x64_bf16 v[36:39], v[32:35], a[40:47], v3
  v_cvt_pk_bf16_f32 v77, v10, v11
  v_smfmac_f32_16x16x64_bf16 v[36:39], v[28:31], a[48:55], v3
  v_cvt_pk_bf16_f32 v56, v56, v57
  v_smfmac_f32_16x16x64_bf16 v[40:43], v[24:27], a[88:95], v3
  v_cvt_pk_bf16_f32 v57, v58, v59
  v_smfmac_f32_16x16x64_bf16 v[40:43], v[32:35], a[96:103], v3
  v_mfma_f32_16x16x32_bf16 v[12:15], v[54:57], v[4:7], 0
  v_cvt_pk_bf16_f32 v39, v38, v39
  v_smfmac_f32_16x16x64_bf16 v[40:43], v[28:31], a[104:111], v3
  v_cvt_pk_bf16_f32 v38, v36, v37
  v_smfmac_f32_16x16x64_bf16 v[44:47], v[24:27], a[144:151], v3
  s_nop 1
  v_cvt_pk_bf16_f32 v78, v12, v13
  v_smfmac_f32_16x16x64_bf16 v[44:47], v[32:35], a[152:159], v3
  v_cvt_pk_bf16_f32 v79, v14, v15
  v_smfmac_f32_16x16x64_bf16 v[44:47], v[28:31], a[160:167], v3
  v_cvt_pk_bf16_f32 v40, v40, v41
  v_smfmac_f32_16x16x64_bf16 v[48:51], v[24:27], a[200:207], v3
  v_cvt_pk_bf16_f32 v41, v42, v43
  v_smfmac_f32_16x16x64_bf16 v[48:51], v[32:35], a[208:215], v3
  v_smfmac_f32_16x16x64_bf16 v[48:51], v[28:31], a[216:223], v3
  s_waitcnt vmcnt(4)
  v_cvt_pk_bf16_f32 v47, v46, v47
  v_smfmac_f32_16x16x64_bf16 v[68:71], v[76:79], v[80:87], v3
  v_cvt_pk_bf16_f32 v46, v44, v45
  v_mfma_f32_16x16x32_bf16 v[8:11], v[38:41], v[4:7], 0
  s_nop 1
  v_cvt_pk_bf16_f32 v48, v48, v49
  v_cvt_pk_bf16_f32 v49, v50, v51
  s_nop 1
  v_mfma_f32_16x16x32_bf16 v[12:15], v[46:49], v[4:7], 0
  v_smfmac_f32_16x16x64_bf16 v[72:75], v[76:79], v[88:95], v3
  v_cvt_pk_bf16_f32 v20, v8, v9
  v_mfma_f32_16x16x32_bf16 v[52:55], v[30:33], v[76:79], 0
  s_waitcnt vmcnt(0)
  v_cvt_pk_bf16_f32 v21, v10, v11
  v_cvt_pk_bf16_f32 v22, v12, v13
  v_cvt_pk_bf16_f32 v23, v14, v15
  s_nop 1
  v_mfma_f32_16x16x32_bf16 v[52:55], v[16:19], v[20:23], v[52:55]
  v_smfmac_f32_16x16x64_bf16 v[68:71], v[20:23], v[96:103], v3
  v_smfmac_f32_16x16x64_bf16 v[72:75], v[20:23], v[104:111], v3
  s_nop 1
  ds_write_b128 v113, v[52:55]
  s_nop 1
  v_permlane32_swap_b32 v68, v70
  v_permlane32_swap_b32 v69, v71
  v_add_f32 v56, v68, v70
  v_add_f32 v58, v69, v71
  v_permlane32_swap_b32 v72, v74
  v_permlane32_swap_b32 v73, v75
  v_add_f32 v57, v72, v74
  v_add_f32 v59, v73, v75
  ds_write_b128 v2, v[56:59] offset:2048
  v_cmp_u_f32 vcc, v57, v59
  v_mov_b32 v68, 0
  v_mov_b32 v69, 0
  v_mov_b32 v70, 0
  v_mov_b32 v71, 0
  s_cbranch_vccnz cB_sc2_retry
cB_sc2_cont:
  s_add_u32 s24, s24, 28672
  s_add_u32 s26, s26, 28672
  buffer_load_dwordx4 v[80:83], v117, s[8:11], s24 offen offset:0 sc1
  buffer_load_dwordx4 v[84:87], v117, s[8:11], s24 offen offset:1024 sc1
  v_mfma_f32_32x32x16_bf16 v[36:51], v[68:71], v[68:71], 0
  s_waitcnt lgkmcnt(0)
  s_barrier
  v_mfma_f32_32x32x16_bf16 v[52:67], v[68:71], v[68:71], 0
  buffer_store_dwordx2 v[118:119], v114, s[8:11], s21 offen sc1
  buffer_store_dwordx2 v[118:119], v115, s[8:11], s21 offen sc1
  s_buffer_load_dword s70, s[8:11], s35
  s_add_u32 s22, s24, 114688
  s_buffer_load_dword s71, s[8:11], s22
  s_mul_i32 s22, s18, 7168
  s_add_u32 s22, s22, 87040
  s_buffer_load_dword s72, s[8:11], s22
  s_add_u32 s35, s35, 458752
  v_mov_b32 v72, 0
  v_mov_b32 v73, 0
  v_mov_b32 v74, 0
  v_mov_b32 v75, 0
  s_buffer_load_dword s64, s[8:11], s34 offset:1792
  s_buffer_load_dword s65, s[8:11], s34 offset:1856
  s_buffer_load_dword s66, s[8:11], s34 offset:1920
  s_buffer_load_dword s67, s[8:11], s34 offset:1984
  s_buffer_load_dword s64, s[8:11], s34 offset:2048
  s_buffer_load_dword s65, s[8:11], s34 offset:2112
  s_buffer_load_dword s66, s[8:11], s34 offset:2176
  s_buffer_load_dword s67, s[8:11], s34 offset:2240
  s_buffer_load_dword s64, s[8:11], s34 offset:2304
  s_buffer_load_dword s65, s[8:11], s34 offset:2368
  s_buffer_load_dword s66, s[8:11], s34 offset:2432
  s_buffer_load_dword s67, s[8:11], s34 offset:2496
  s_buffer_load_dword s64, s[8:11], s34 offset:2560
  s_buffer_load_dword s65, s[8:11], s34 offset:2624
  s_mov_b32 s36, s34
  s_add_u32 s34, s33, 458752
  s_mov_b32 s33, s34
  s_mov_b32 s19, s18
  s_add_u32 s18, s18, 1
  s_mov_b32 s22, s20
  s_mov_b32 s20, s21
  s_mov_b32 s21, s22
  s_add_u32 s23, s20, 4096
  s_cmp_lt_u32 s19, 63
  s_cbranch_scc1 cB_sc2_loop
  s_branch cB_done
cB_sc2_r0:
  s_add_u32 s31, s31, 1
  buffer_load_dwordx4 v[16:19], v2, s[8:11], s20 offen offset:2048 sc1
  s_waitcnt vmcnt(0)
  v_cmp_eq_u32 vcc, -1, v16
  v_mov_b32 v36, 0
  v_mov_b32 v37, 0
  v_mov_b32 v38, 0
  v_mov_b32 v39, 0
  v_mov_b32 v40, 0
  v_mov_b32 v41, 0
  v_mov_b32 v42, 0
  v_mov_b32 v43, 0
  v_mov_b32 v44, 0
  v_mov_b32 v45, 0
  v_mov_b32 v46, 0
  v_mov_b32 v47, 0
  v_mov_b32 v48, 0
  v_mov_b32 v49, 0
  v_mov_b32 v50, 0
  v_mov_b32 v51, 0
  s_nop 1
  s_cbranch_vccz cB_sc2_go
  s_add_u32 s30, s30, 1
  s_cmp_lt_u32 s30, 400000
  s_cbranch_scc1 cB_sc2_r0
  s_branch cB_abort
cB_sc2_r4:
  s_add_u32 s31, s31, 1
  buffer_load_dwordx4 v[20:23], v2, s[8:11], s20 offen offset:3072 sc1
  buffer_load_dwordx4 v[8:11], v2, s[8:11], s20 offen offset:0 sc1
  buffer_load_dwordx4 v[12:15], v2, s[8:11], s20 offen offset:1024 sc1
  buffer_load_dwordx4 v[24:27], v2, s[8:11], s23 offen offset:0 sc1
  buffer_load_dwordx4 v[32:35], v2, s[8:11], s23 offen offset:1024 sc1
  buffer_load_dwordx4 v[28:31], v2, s[8:11], s23 offen offset:2048 sc1
  s_waitcnt vmcnt(0)
  v_max3_u32 v66, v20, v8, v12
  v_max3_u32 v66, v66, v24, v27
  v_max3_u32 v66, v66, v28, v31
  v_max3_u32 v66, v66, v32, v35
  v_cmp_eq_u32 vcc, -1, v66
  s_nop 4
  s_cbranch_vccz cB_sc2_rz
  s_add_u32 s30, s30, 1
  s_cmp_lt_u32 s30, 400000
  s_cbranch_scc1 cB_sc2_r4
  s_branch cB_abort
cB_sc2_retry:
  s_cmp_lg_u32 s62, 0
  s_cbranch_scc1 cB_sc2_cont
  s_waitcnt vmcnt(0) lgkmcnt(0)
cB_sc2_rv:
  buffer_load_dwordx4 v[8:11], v2, s[8:11], s20 offen offset:0 sc1
  buffer_load_dwordx4 v[12:15], v2, s[8:11], s20 offen offset:1024 sc1
  buffer_load_dwordx4 v[16:19], v2, s[8:11], s20 offen offset:2048 sc1
  buffer_load_dwordx4 v[20:23], v2, s[8:11], s20 offen offset:3072 sc1
  buffer_load_dwordx4 v[24:27], v2, s[8:11], s23 offen offset:0 sc1
  buffer_load_dwordx4 v[32:35], v2, s[8:11], s23 offen offset:1024 sc1
  buffer_load_dwordx4 v[28:31], v2, s[8:11], s23 offen offset:2048 sc1
  s_waitcnt vmcnt(0)
  v_max3_u32 v66, v8, v9, v10
  v_max3_u32 v66, v66, v11, v12
  v_max3_u32 v66, v66, v13, v14
  v_max3_u32 v66, v66, v15, v16
  v_max3_u32 v66, v66, v17, v18
  v_max3_u32 v66, v66, v19, v20
  v_max3_u32 v66, v66, v21, v22
  v_max3_u32 v66, v66, v23, v24
  v_max3_u32 v66, v66, v25, v26
  v_max3_u32 v66, v66, v27, v28
  v_max3_u32 v66, v66, v29, v30
  v_max3_u32 v66, v66, v31, v32
  v_max3_u32 v66, v66, v33, v34
  v_max_u32 v66, v66, v35
  v_cmp_eq_u32 vcc, -1, v66
  s_cbranch_vccz cB_sc2_rk
  s_add_u32 s30, s30, 1
  s_cmp_lt_u32 s30, 400000
  s_cbranch_scc1 cB_sc2_rv
  s_branch cB_abort
cB_sc2_rk:
  s_mov_b32 s62, 1
  s_add_u32 s31, s31, 0x100
cB_sc2_rz:
  v_mov_b32 v36, 0
  v_mov_b32 v37, 0
  v_mov_b32 v38, 0
  v_mov_b32 v39, 0
  v_mov_b32 v40, 0
  v_mov_b32 v41, 0
  v_mov_b32 v42, 0
  v_mov_b32 v43, 0
  v_mov_b32 v44, 0
  v_mov_b32 v45, 0
  v_mov_b32 v46, 0
  v_mov_b32 v47, 0
  v_mov_b32 v48, 0
  v_mov_b32 v49, 0
  v_mov_b32 v50, 0
  v_mov_b32 v51, 0
  v_mov_b32 v62, 0
  v_mov_b32 v63, 0
  v_mov_b32 v64, 0
  v_mov_b32 v65, 0
  v_mov_b32 v68, 0
  v_mov_b32 v69, 0
  v_mov_b32 v70, 0
  v_mov_b32 v71, 0
  v_mov_b32 v72, 0
  v_mov_b32 v73, 0
  v_mov_b32 v74, 0
  v_mov_b32 v75, 0
  v_mov_b32 v52, 0
  v_mov_b32 v53, 0
  v_mov_b32 v54, 0
  v_mov_b32 v55, 0
  v_mov_b32 v56, 0
  v_mov_b32 v57, 0
  v_mov_b32 v58, 0
  v_mov_b32 v59, 0
  s_nop 1
  s_branch cB_sc2_go
.p2align 6
cB_sc3_loop:
  s_mov_b32 s30, 0
  s_mov_b32 s62, 0
  s_setprio 3
  s_barrier
  buffer_load_dwordx4 v[20:23], v2, s[8:11], s20 offen offset:3072 sc1
  s_setprio 2
  buffer_load_dwordx4 v[8:11], v2, s[8:11], s20 offen offset:0 sc1
  s_setprio 1
  buffer_load_dwordx4 v[12:15], v2, s[8:11], s20 offen offset:1024 sc1
  s_setprio 0
  buffer_load_dwordx4 v[16:19], v2, s[8:11], s20 offen offset:2048 sc1
cB_sc3_go:
  s_waitcnt vmcnt(3)
  v_smfmac_f32_16x16x64_bf16 v[36:39], v[20:23], a[24:31], v3
  buffer_load_dwordx4 v[24:27], v2, s[8:11], s23 offen offset:0 sc1
  v_cmp_eq_u32 vcc, -1, v20
  v_smfmac_f32_16x16x64_bf16 v[40:43], v[20:23], a[80:87], v3
  v_smfmac_f32_16x16x64_bf16 v[44:47], v[20:23], a[136:143], v3
  buffer_load_dwordx4 v[28:31], v2, s[8:11], s23 offen offset:1024 sc1
  s_cbranch_vccnz cB_sc3_r0
  v_smfmac_f32_16x16x64_bf16 v[48:51], v[20:23], a[192:199], v3
  v_smfmac_f32_16x16x64_bf16 v[52:55], v[20:23], a[248:255], v3
  v_smfmac_f32_16x16x64_bf16 v[56:59], v[20:23], v[168:175], v3
  buffer_load_dwordx4 v[32:35], v2, s[8:11], s23 offen offset:2048 sc1
  v_smfmac_f32_16x16x64_bf16 v[62:65], v[20:23], v[224:231], v3
  s_waitcnt vmcnt(5)
  v_smfmac_f32_16x16x64_bf16 v[36:39], v[8:11], a[0:7], v3
  v_smfmac_f32_16x16x64_bf16 v[40:43], v[8:11], a[56:63], v3
  v_smfmac_f32_16x16x64_bf16 v[44:47], v[8:11], a[112:119], v3
  v_smfmac_f32_16x16x64_bf16 v[48:51], v[8:11], a[168:175], v3
  v_smfmac_f32_16x16x64_bf16 v[52:55], v[8:11], a[224:231], v3
  v_smfmac_f32_16x16x64_bf16 v[56:59], v[8:11], v[144:151], v3
  buffer_load_dwordx4 v[88:91], v117, s[8:11], s26 offen offset:0 sc1
  v_smfmac_f32_16x16x64_bf16 v[62:65], v[8:11], v[200:207], v3
  s_waitcnt vmcnt(5)
  v_smfmac_f32_16x16x64_bf16 v[36:39], v[12:15], a[8:15], v3
  v_smfmac_f32_16x16x64_bf16 v[40:43], v[12:15], a[64:71], v3
  v_smfmac_f32_16x16x64_bf16 v[44:47], v[12:15], a[120:127], v3
  buffer_load_dwordx4 v[92:95], v117, s[8:11], s26 offen offset:1024 sc1
  v_smfmac_f32_16x16x64_bf16 v[48:51], v[12:15], a[176:183], v3
  v_smfmac_f32_16x16x64_bf16 v[52:55], v[12:15], a[232:239], v3
  v_smfmac_f32_16x16x64_bf16 v[56:59], v[12:15], v[152:159], v3
  v_smfmac_f32_16x16x64_bf16 v[62:65], v[12:15], v[208:215], v3
  s_waitcnt vmcnt(5)
  buffer_load_dwordx4 v[96:99], v2, s[8:11], s24 offen offset:0 sc1
  v_smfmac_f32_16x16x64_bf16 v[36:39], v[16:19], a[16:23], v3
  v_smfmac_f32_16x16x64_bf16 v[40:43], v[16:19], a[72:79], v3
  v_max3_u32 v66, v8, v12, v16
  v_smfmac_f32_16x16x64_bf16 v[44:47], v[16:19], a[128:135], v3
  v_smfmac_f32_16x16x64_bf16 v[48:51], v[16:19], a[184:191], v3
  buffer_load_dwordx4 v[100:103], v2, s[8:11], s24 offen offset:1024 sc1
  v_smfmac_f32_16x16x64_bf16 v[52:55], v[16:19], a[240:247], v3
  v_smfmac_f32_16x16x64_bf16 v[56:59], v[16:19], v[160:167], v3
  v_smfmac_f32_16x16x64_bf16 v[62:65], v[16:19], v[216:223], v3
  s_waitcnt vmcnt(4)
  v_smfmac_f32_16x16x64_bf16 v[62:65], v[24:27], v[232:239], v3
  buffer_load_dwordx4 v[104:107], v2, s[8:11], s26 offen offset:0 sc1
  v_max3_u32 v66, v66, v24, v27
  v_smfmac_f32_16x16x64_bf16 v[62:65], v[28:31], v[240:247], v3
  v_max3_u32 v66, v66, v28, v31
  v_smfmac_f32_16x16x64_bf16 v[62:65], v[32:35], v[248:255], v3
  v_max3_u32 v66, v66, v32, v35
  v_smfmac_f32_16x16x64_bf16 v[52:55], v[24:27], v[120:127], v3
  v_cmp_eq_u32 vcc, -1, v66
  v_smfmac_f32_16x16x64_bf16 v[52:55], v[28:31], v[128:135], v3
  buffer_load_dwordx4 v[108:111], v2, s[8:11], s26 offen offset:1024 sc1
  v_smfmac_f32_16x16x64_bf16 v[52:55], v[32:35], v[136:143], v3
  s_cbranch_vccnz cB_sc3_r4
  v_cvt_pk_bf16_f32 v62, v62, v63
  v_smfmac_f32_16x16x64_bf16 v[56:59], v[24:27], v[176:183], v3
  v_cvt_pk_bf16_f32 v63, v64, v65
  v_smfmac_f32_16x16x64_bf16 v[56:59], v[28:31], v[184:191], v3
  v_mfma_f32_16x16x32_bf16 v[8:11], v[60:63], v[4:7], 0
  v_cvt_pk_bf16_f32 v55, v54, v55
  v_smfmac_f32_16x16x64_bf16 v[56:59], v[32:35], v[192:199], v3
  v_cvt_pk_bf16_f32 v54, v52, v53
  v_smfmac_f32_16x16x64_bf16 v[36:39], v[24:27], a[32:39], v3
  s_nop 1
  v_cvt_pk_bf16_f32 v78, v8, v9
  v_smfmac_f32_16x16x64_bf16 v[36:39], v[28:31], a[40:47], v3
  v_cvt_pk_bf16_f32 v79, v10, v11
  v_smfmac_f32_16x16x64_bf16 v[36:39], v[32:35], a[48:55], v3
  v_cvt_pk_bf16_f32 v56, v56, v57
  v_smfmac_f32_16x16x64_bf16 v[40:43], v[24:27], a[88:95], v3
  v_cvt_pk_bf16_f32 v57, v58, v59
  v_smfmac_f32_16x16x64_bf16 v[40:43], v[28:31], a[96:103], v3
  v_mfma_f32_16x16x32_bf16 v[12:15], v[54:57], v[4:7], 0
  v_cvt_pk_bf16_f32 v39, v38, v39
  v_smfmac_f32_16x16x64_bf16 v[40:43], v[32:35], a[104:111], v3
  v_cvt_pk_bf16_f32 v38, v36, v37
  v_smfmac_f32_16x16x64_bf16 v[44:47], v[24:27], a[144:151], v3
  s_nop 1
  v_cvt_pk_bf16_f32 v76, v12, v13
  v_smfmac_f32_16x16x64_bf16 v[44:47], v[28:31], a[152:159], v3
  v_cvt_pk_bf16_f32 v77, v14, v15
  v_smfmac_f32_16x16x64_bf16 v[44:47], v[32:35], a[160:167], v3
  v_cvt_pk_bf16_f32 v40, v40, v41
  v_smfmac_f32_16x16x64_bf16 v[48:51], v[24:27], a[200:207], v3
  v_cvt_pk_bf16_f32 v41, v42, v43
  v_smfmac_f32_16x16x64_bf16 v[48:51], v[28:31], a[208:215], v3
  v_smfmac_f32_16x16x64_bf16 v[48:51], v[32:35], a[216:223], v3
  s_waitcnt vmcnt(4)
  v_cvt_pk_bf16_f32 v47, v46, v47
  v_smfmac_f32_16x16x64_bf16 v[68:71], v[76:79], v[80:87], v3
  v_cvt_pk_bf16_f32 v46, v44, v45
  v_mfma_f32_16x16x32_bf16 v[8:11], v[38:41], v[4:7], 0
  s_nop 1
  v_cvt_pk_bf16_f32 v48, v48, v49
  v_cvt_pk_bf16_f32 v49, v50, v51
  s_nop 1
  v_mfma_f32_16x16x32_bf16 v[12:15], v[46:49], v[4:7], 0
  v_smfmac_f32_16x16x64_bf16 v[72:75], v[76:79], v[88:95], v3
  v_cvt_pk_bf16_f32 v16, v8, v9
  v_mfma_f32_16x16x32_bf16 v[52:55], v[30:33], v[76:79], 0
  s_waitcnt vmcnt(0)
  v_cvt_pk_bf16_f32 v17, v10, v11
  v_cvt_pk_bf16_f32 v18, v12, v13
  v_cvt_pk_bf16_f32 v19, v14, v15
  s_nop 1
  v_mfma_f32_16x16x32_bf16 v[52:55], v[20:23], v[16:19], v[52:55]
  v_smfmac_f32_16x16x64_bf16 v[68:71], v[16:19], v[96:103], v3
  v_smfmac_f32_16x16x64_bf16 v[72:75], v[16:19], v[104:111], v3
  s_nop 1
  ds_write_b128 v113, v[52:55]
  s_nop 1
  v_permlane32_swap_b32 v68, v70
  v_permlane32_swap_b32 v69, v71
  v_add_f32 v56, v68, v70
  v_add_f32 v58, v69, v71
  v_permlane32_swap_b32 v72, v74
  v_permlane32_swap_b32 v73, v75
  v_add_f32 v57, v72, v74
  v_add_f32 v59, v73, v75
  ds_write_b128 v2, v[56:59] offset:3072
  v_cmp_u_f32 vcc, v57, v59
  v_mov_b32 v68, 0
  v_mov_b32 v69, 0
  v_mov_b32 v70, 0
  v_mov_b32 v71, 0
  s_cbranch_vccnz cB_sc3_retry
cB_sc3_cont:
  s_add_u32 s24, s24, 28672
  s_add_u32 s26, s26, 28672
  buffer_load_dwordx4 v[80:83], v117, s[8:11], s24 offen offset:0 sc1
  buffer_load_dwordx4 v[84:87], v117, s[8:11], s24 offen offset:1024 sc1
  v_mfma_f32_16x16x32_bf16 v[62:65], v[68:71], v[68:71], 0
  s_waitcnt lgkmcnt(0)
  s_barrier
  v_mov_b32 v52, 0
  v_mov_b32 v53, 0
  v_mov_b32 v54, 0
  v_mov_b32 v55, 0
  v_mov_b32 v56, 0
  v_mov_b32 v57, 0
  v_mov_b32 v58, 0
  v_mov_b32 v59, 0
  v_mfma_f32_32x32x16_bf16 v[36:51], v[68:71], v[68:71], 0
  v_mov_b32 v72, 0
  v_mov_b32 v73, 0
  v_mov_b32 v74, 0
  v_mov_b32 v75, 0
  s_buffer_load_dword s64, s[8:11], s34 offset:2688
  s_buffer_load_dword s65, s[8:11], s34 offset:2752
  s_buffer_load_dword s66, s[8:11], s34 offset:2816
  s_buffer_load_dword s67, s[8:11], s34 offset:2880
  s_buffer_load_dword s64, s[8:11], s34 offset:2944
  s_buffer_load_dword s65, s[8:11], s34 offset:3008
  s_buffer_load_dword s66, s[8:11], s34 offset:3072
  s_buffer_load_dword s67, s[8:11], s34 offset:3136
  s_buffer_load_dword s64, s[8:11], s34 offset:3200
  s_buffer_load_dword s65, s[8:11], s34 offset:3264
  s_buffer_load_dword s66, s[8:11], s34 offset:3328
  s_buffer_load_dword s67, s[8:11], s34 offset:3392
  s_buffer_load_dword s64, s[8:11], s34 offset:3456
  s_buffer_load_dword s65, s[8:11], s34 offset:3520
  s_mov_b32 s36, s34
  s_add_u32 s34, s33, 458752
  s_mov_b32 s33, s34
  s_mov_b32 s19, s18
  s_add_u32 s18, s18, 1
  s_mov_b32 s22, s20
  s_mov_b32 s20, s21
  s_mov_b32 s21, s22
  s_add_u32 s23, s20, 4096
  s_cmp_lt_u32 s19, 63
  s_cbranch_scc1 cB_sc3_loop
  s_branch cB_done
cB_sc3_r0:
  s_add_u32 s31, s31, 1
  buffer_load_dwordx4 v[20:23], v2, s[8:11], s20 offen offset:3072 sc1
  s_waitcnt vmcnt(0)
  v_cmp_eq_u32 vcc, -1, v20
  v_mov_b32 v36, 0
  v_mov_b32 v37, 0
  v_mov_b32 v38, 0
  v_mov_b32 v39, 0
  v_mov_b32 v40, 0
  v_mov_b32 v41, 0
  v_mov_b32 v42, 0
  v_mov_b32 v43, 0
  v_mov_b32 v44, 0
  v_mov_b32 v45, 0
  v_mov_b32 v46, 0
  v_mov_b32 v47, 0
  v_mov_b32 v48, 0
  v_mov_b32 v49, 0
  v_mov_b32 v50, 0
  v_mov_b32 v51, 0
  s_nop 1
  s_cbranch_vccz cB_sc3_go
  s_add_u32 s30, s30, 1
  s_cmp_lt_u32 s30, 400000
  s_cbranch_scc1 cB_sc3_r0
  s_branch cB_abort
cB_sc3_r4:
  s_add_u32 s31, s31, 1
  buffer_load_dwordx4 v[8:11], v2, s[8:11], s20 offen offset:0 sc1
  buffer_load_dwordx4 v[12:15], v2, s[8:11], s20 offen offset:1024 sc1
  buffer_load_dwordx4 v[16:19], v2, s[8:11], s20 offen offset:2048 sc1
  buffer_load_dwordx4 v[24:27], v2, s[8:11], s23 offen offset:0 sc1
  buffer_load_dwordx4 v[28:31], v2, s[8:11], s23 offen offset:1024 sc1
  buffer_load_dwordx4 v[32:35], v2, s[8:11], s23 offen offset:2048 sc1
  s_waitcnt vmcnt(0)
  v_max3_u32 v66, v8, v12, v16
  v_max3_u32 v66, v66, v24, v27
  v_max3_u32 v66, v66, v28, v31
  v_max3_u32 v66, v66, v32, v35
  v_cmp_eq_u32 vcc, -1, v66
  s_nop 4
  s_cbranch_vccz cB_sc3_rz
  s_add_u32 s30, s30, 1
  s_cmp_lt_u32 s30, 400000
  s_cbranch_scc1 cB_sc3_r4
  s_branch cB_abort
cB_sc3_retry:
  s_cmp_lg_u32 s62, 0
  s_cbranch_scc1 cB_sc3_cont
  s_waitcnt vmcnt(0) lgkmcnt(0)
cB_sc3_rv:
  buffer_load_dwordx4 v[8:11], v2, s[8:11], s20 offen offset:0 sc1
  buffer_load_dwordx4 v[12:15], v2, s[8:11], s20 offen offset:1024 sc1
  buffer_load_dwordx4 v[16:19], v2, s[8:11], s20 offen offset:2048 sc1
  buffer_load_dwordx4 v[20:23], v2, s[8:11], s20 offen offset:3072 sc1
  buffer_load_dwordx4 v[24:27], v2, s[8:11], s23 offen offset:0 sc1
  buffer_load_dwordx4 v[28:31], v2, s[8:11], s23 offen offset:1024 sc1
  buffer_load_dwordx4 v[32:35], v2, s[8:11], s23 offen offset:2048 sc1
  s_waitcnt vmcnt(0)
  v_max3_u32 v66, v8, v9, v10
  v_max3_u32 v66, v66, v11, v12
  v_max3_u32 v66, v66, v13, v14
  v_max3_u32 v66, v66, v15, v16
  v_max3_u32 v66, v66, v17, v18
  v_max3_u32 v66, v66, v19, v20
  v_max3_u32 v66, v66, v21, v22
  v_max3_u32 v66, v66, v23, v24
  v_max3_u32 v66, v66, v25, v26
  v_max3_u32 v66, v66, v27, v28
  v_max3_u32 v66, v66, v29, v30
  v_max3_u32 v66, v66, v31, v32
  v_max3_u32 v66, v66, v33, v34
  v_max_u32 v66, v66, v35
  v_cmp_eq_u32 vcc, -1, v66
  s_cbranch_vccz cB_sc3_rk
  s_add_u32 s30, s30, 1
  s_cmp_lt_u32 s30, 400000
  s_cbranch_scc1 cB_sc3_rv
  s_branch cB_abort
cB_sc3_rk:
  s_mov_b32 s62, 1
  s_add_u32 s31, s31, 0x100
cB_sc3_rz:
  v_mov_b32 v36, 0
  v_mov_b32 v37, 0
  v_mov_b32 v38, 0
  v_mov_b32 v39, 0
  v_mov_b32 v40, 0
  v_mov_b32 v41, 0
  v_mov_b32 v42, 0
  v_mov_b32 v43, 0
  v_mov_b32 v44, 0
  v_mov_b32 v45, 0
  v_mov_b32 v46, 0
  v_mov_b32 v47, 0
  v_mov_b32 v48, 0
  v_mov_b32 v49, 0
  v_mov_b32 v50, 0
  v_mov_b32 v51, 0
  v_mov_b32 v62, 0
  v_mov_b32 v63, 0
  v_mov_b32 v64, 0
  v_mov_b32 v65, 0
  v_mov_b32 v68, 0
  v_mov_b32 v69, 0
  v_mov_b32 v70, 0
  v_mov_b32 v71, 0
  v_mov_b32 v72, 0
  v_mov_b32 v73, 0
  v_mov_b32 v74, 0
  v_mov_b32 v75, 0
  v_mov_b32 v52, 0
  v_mov_b32 v53, 0
  v_mov_b32 v54, 0
  v_mov_b32 v55, 0
  v_mov_b32 v56, 0
  v_mov_b32 v57, 0
  v_mov_b32 v58, 0
  v_mov_b32 v59, 0
  s_nop 1
  s_branch cB_sc3_go
.p2align 6
cB_va0_loop:
  s_mov_b32 s30, 0
  s_barrier
  buffer_load_dwordx4 v[24:27], v2, s[8:11], s23 offen offset:0 sc1
  buffer_load_dwordx4 v[28:31], v2, s[8:11], s23 offen offset:1024 sc1
  s_barrier
  s_cmp_lt_u32 s19, 60
  s_cbranch_scc1 cB_va0_m1
  buffer_store_dword v160, v1, s[8:11], s38 offen sc1
  s_cmp_lg_u32 s19, 63
  s_cbranch_scc1 cB_va0_m2
  v_min_u32 v64, -2, v64
  v_min_u32 v65, -2, v65
  v_min_u32 v66, -2, v66
  v_min_u32 v67, -2, v67
  v_min_u32 v68, -2, v68
  v_min_u32 v69, -2, v69
  v_min_u32 v70, -2, v70
  v_min_u32 v71, -2, v71
  v_min_u32 v72, -2, v72
  v_min_u32 v73, -2, v73
  v_min_u32 v74, -2, v74
  v_min_u32 v75, -2, v75
  v_min_u32 v76, -2, v76
  v_min_u32 v77, -2, v77
  v_min_u32 v78, -2, v78
  v_min_u32 v79, -2, v79
  buffer_store_dwordx4 v[64:67], v2, s[8:11], s33 offen offset:0 sc1
  buffer_store_dwordx4 v[68:71], v2, s[8:11], s33 offen offset:2048 sc1
  s_add_u32 s33, s33, 4096
  buffer_store_dwordx4 v[72:75], v2, s[8:11], s33 offen offset:0 sc1
  buffer_store_dwordx4 v[76:79], v2, s[8:11], s33 offen offset:2048 sc1
  s_add_u32 s33, s33, 4096
  s_waitcnt vmcnt(5)
  s_branch cB_va0_m3
cB_va0_m1:
  buffer_store_dword v160, v1, s[8:11], s38 offen sc1
cB_va0_m2:
  s_add_u32 s22, s25, s80
  buffer_load_dwordx4 v[80:83], v6, s[8:11], s22 offen offset:0 sc1
  buffer_load_dwordx4 v[84:87], v6, s[8:11], s22 offen offset:1792 sc1
  s_add_u32 s22, s22, 3584
  buffer_load_dwordx4 v[88:91], v6, s[8:11], s22 offen offset:0 sc1
  buffer_load_dwordx4 v[92:95], v6, s[8:11], s22 offen offset:1792 sc1
  s_add_u32 s22, s25, s81
  buffer_load_dwordx4 v[96:99], v6, s[8:11], s22 offen offset:0 sc1
  s_mul_i32 s38, s18, 7168
  s_add_u32 s38, s38, 65536
  s_waitcnt vmcnt(6)
cB_va0_m3:
  ds_write_b128 v2, v[24:27] offset:12288
  ds_write_b128 v2, v[28:31] offset:13312
  v_smfmac_f32_16x16x64_bf16 v[36:39], v[24:27], a[32:39], v3
  buffer_load_dwordx4 v[100:103], v6, s[8:11], s22 offen offset:1792 sc1
  v_smfmac_f32_16x16x64_bf16 v[40:43], v[24:27], a[88:95], v3
  s_add_u32 s22, s22, 3584
  buffer_load_dwordx4 v[104:107], v6, s[8:11], s22 offen offset:0 sc1
  v_smfmac_f32_16x16x64_bf16 v[44:47], v[24:27], a[144:151], v3
  buffer_load_dwordx4 v[108:111], v6, s[8:11], s22 offen offset:1792 sc1
  v_smfmac_f32_16x16x64_bf16 v[48:51], v[24:27], a[200:207], v3
  s_add_u32 s22, s25, s82
  buffer_load_dwordx4 v[112:115], v6, s[8:11], s22 offen offset:0 sc1
  v_smfmac_f32_16x16x64_bf16 v[52:55], v[24:27], v[176:183], v3
  s_waitcnt lgkmcnt(0)
  s_barrier
  ds_read_b128 v[8:11], v2 offset:8192
  ds_read_b128 v[12:15], v2 offset:9216
  ds_read_b128 v[16:19], v2 offset:10240
  ds_read_b128 v[20:23], v2 offset:11264
  ds_read_b128 v[32:35], v2 offset:14336
  buffer_load_dwordx4 v[116:119], v6, s[8:11], s22 offen offset:1792 sc1
  v_smfmac_f32_16x16x64_bf16 v[56:59], v[24:27], v[232:239], v3
  s_add_u32 s22, s22, 3584
  buffer_load_dwordx4 v[120:123], v6, s[8:11], s22 offen offset:0 sc1
  v_smfmac_f32_16x16x64_bf16 v[36:39], v[28:31], a[40:47], v3
  buffer_load_dwordx4 v[124:127], v6, s[8:11], s22 offen offset:1792 sc1
  v_smfmac_f32_16x16x64_bf16 v[40:43], v[28:31], a[96:103], v3
  s_add_u32 s22, s25, s83
  buffer_load_dwordx4 v[128:131], v6, s[8:11], s22 offen offset:0 sc1
  v_smfmac_f32_16x16x64_bf16 v[44:47], v[28:31], a[152:159], v3
  buffer_load_dwordx4 v[132:135], v6, s[8:11], s22 offen offset:1792 sc1
  v_smfmac_f32_16x16x64_bf16 v[48:51], v[28:31], a[208:215], v3
  s_add_u32 s22, s22, 3584
  buffer_load_dwordx4 v[136:139], v6, s[8:11], s22 offen offset:0 sc1
  v_smfmac_f32_16x16x64_bf16 v[52:55], v[28:31], v[184:191], v3
  buffer_load_dwordx4 v[140:143], v6, s[8:11], s22 offen offset:1792 sc1
  v_smfmac_f32_16x16x64_bf16 v[56:59], v[28:31], v[240:247], v3
  s_waitcnt lgkmcnt(4)
  v_smfmac_f32_16x16x64_bf16 v[36:39], v[8:11], a[0:7], v3
  s_waitcnt lgkmcnt(3)
  v_smfmac_f32_16x16x64_bf16 v[36:39], v[12:15], a[8:15], v3
  s_waitcnt lgkmcnt(2)
  v_smfmac_f32_16x16x64_bf16 v[36:39], v[16:19], a[16:23], v3
  s_waitcnt lgkmcnt(1)
  v_smfmac_f32_16x16x64_bf16 v[36:39], v[20:23], a[24:31], v3
  s_waitcnt lgkmcnt(0)
  v_smfmac_f32_16x16x64_bf16 v[36:39], v[32:35], a[48:55], v3
  v_smfmac_f32_16x16x64_bf16 v[40:43], v[8:11], a[56:63], v3
  v_smfmac_f32_16x16x64_bf16 v[40:43], v[12:15], a[64:71], v3
  v_smfmac_f32_16x16x64_bf16 v[40:43], v[16:19], a[72:79], v3
  v_permlane32_swap_b32 v36, v38
  v_smfmac_f32_16x16x64_bf16 v[40:43], v[20:23], a[80:87], v3
  v_permlane32_swap_b32 v37, v39
  v_smfmac_f32_16x16x64_bf16 v[40:43], v[32:35], a[104:111], v3
  v_add_f32 v36, v36, v38
  v_smfmac_f32_16x16x64_bf16 v[44:47], v[8:11], a[112:119], v3
  v_add_f32 v37, v37, v39
  v_smfmac_f32_16x16x64_bf16 v[44:47], v[12:15], a[120:127], v3
  v_cmp_u_f32 vcc, v36, v37
  v_smfmac_f32_16x16x64_bf16 v[44:47], v[16:19], a[128:135], v3
  v_cvt_pk_bf16_f32 v38, v36, v37
  v_smfmac_f32_16x16x64_bf16 v[44:47], v[20:23], a[136:143], v3
  ds_write_b32 v152, v38
  s_cbranch_vccnz cB_va0_slow
  v_permlane32_swap_b32 v40, v42
  v_smfmac_f32_16x16x64_bf16 v[44:47], v[32:35], a[160:167], v3
  v_permlane32_swap_b32 v41, v43
  v_smfmac_f32_16x16x64_bf16 v[48:51], v[8:11], a[168:175], v3
  buffer_store_dword v162, v1, s[8:11], s21 offen sc1
  v_add_f32 v40, v40, v42
  v_smfmac_f32_16x16x64_bf16 v[48:51], v[12:15], a[176:183], v3
  v_add_f32 v41, v41, v43
  v_smfmac_f32_16x16x64_bf16 v[48:51], v[16:19], a[184:191], v3
  buffer_load_dword v164, v4, s[8:11], 0 offen sc1
  v_cvt_pk_bf16_f32 v42, v40, v41
  v_smfmac_f32_16x16x64_bf16 v[48:51], v[20:23], a[192:199], v3
  ds_write_b32 v153, v42
  v_permlane32_swap_b32 v44, v46
  v_smfmac_f32_16x16x64_bf16 v[48:51], v[32:35], a[216:223], v3
  v_permlane32_swap_b32 v45, v47
  v_smfmac_f32_16x16x64_bf16 v[52:55], v[8:11], a[224:231], v3
  buffer_load_dword v164, v4, s[8:11], 0 offen sc1
  v_add_f32 v44, v44, v46
  v_smfmac_f32_16x16x64_bf16 v[52:55], v[12:15], a[232:239], v3
  v_add_f32 v45, v45, v47
  v_smfmac_f32_16x16x64_bf16 v[52:55], v[16:19], a[240:247], v3
  v_cvt_pk_bf16_f32 v46, v44, v45
  v_smfmac_f32_16x16x64_bf16 v[52:55], v[20:23], a[248:255], v3
  ds_write_b32 v154, v46
  buffer_load_dword v164, v4, s[8:11], 0 offen sc1
  v_permlane32_swap_b32 v48, v50
  v_smfmac_f32_16x16x64_bf16 v[52:55], v[32:35], v[192:199], v3
  v_permlane32_swap_b32 v49, v51
  v_smfmac_f32_16x16x64_bf16 v[56:59], v[8:11], v[200:207], v3
  v_add_f32 v48, v48, v50
  v_smfmac_f32_16x16x64_bf16 v[56:59], v[12:15], v[208:215], v3
  buffer_load_dword v164, v4, s[8:11], 0 offen sc1
  v_add_f32 v49, v49, v51
  v_smfmac_f32_16x16x64_bf16 v[56:59], v[16:19], v[216:223], v3
  v_cvt_pk_bf16_f32 v50, v48, v49
  v_smfmac_f32_16x16x64_bf16 v[56:59], v[20:23], v[224:231], v3
  ds_write_b32 v155, v50
  v_permlane32_swap_b32 v52, v54
  v_smfmac_f32_16x16x64_bf16 v[56:59], v[32:35], v[248:255], v3
  buffer_load_dword v164, v4, s[8:11], 0 offen sc1
  v_permlane32_swap_b32 v53, v55
  v_add_f32 v52, v52, v54
  v_add_f32 v53, v53, v55
  v_cvt_pk_bf16_f32 v54, v52, v53
  ds_write_b32 v156, v54
  s_nop 1
  v_permlane32_swap_b32 v56, v58
  v_permlane32_swap_b32 v57, v59
  v_add_f32 v56, v56, v58
  v_add_f32 v57, v57, v59
  v_cvt_pk_bf16_f32 v58, v56, v57
  ds_write_b32 v157, v58
cB_va0_t2d:
  s_add_u32 s72, s20, s76
  s_add_u32 s73, s20, s77
  s_add_u32 s74, s20, s78
  s_add_u32 s75, s20, s79
  s_add_u32 s22, s20, 9216
  s_add_u32 s34, s20, 13312
  s_add_u32 s36, s20, 7168
  s_mov_b32 s37, 0
  v_mov_b32 v48, 0
  v_mov_b32 v49, 0
  v_mov_b32 v50, 0
  v_mov_b32 v51, 0
  v_mov_b32 v163, s18
  s_cmp_eq_u32 s19, 63
  s_waitcnt lgkmcnt(0)
  s_cbranch_scc1 cB_va0_last
  s_setprio 3
cB_va0_fw_l:
  v_cmp_gt_u32 vcc, s18, v164
  buffer_load_dword v164, v4, s[8:11], 0 offen sc1
  s_cbranch_vccz cB_va0_fw_d
  v_cmp_gt_u32 vcc, s18, v164
  buffer_load_dword v164, v4, s[8:11], 0 offen sc1
  s_cbranch_vccz cB_va0_fw_d
  v_cmp_gt_u32 vcc, s18, v164
  buffer_load_dword v164, v4, s[8:11], 0 offen sc1
  s_cbranch_vccz cB_va0_fw_d
  v_cmp_gt_u32 vcc, s18, v164
  buffer_load_dword v164, v4, s[8:11], 0 offen sc1
  s_cbranch_vccz cB_va0_fw_d
  v_cmp_gt_u32 vcc, s18, v164
  buffer_load_dword v164, v4, s[8:11], 0 offen sc1
  s_cbranch_vccz cB_va0_fw_d
  v_cmp_gt_u32 vcc, s18, v164
  buffer_load_dword v164, v4, s[8:11], 0 offen sc1
  s_cbranch_vccz cB_va0_fw_d
  v_cmp_gt_u32 vcc, s18, v164
  buffer_load_dword v164, v4, s[8:11], 0 offen sc1
  s_cbranch_vccz cB_va0_fw_d
  v_cmp_gt_u32 vcc, s18, v164
  buffer_load_dword v164, v4, s[8:11], 0 offen sc1
  s_cbranch_vccz cB_va0_fw_d
  v_cmp_gt_u32 vcc, s18, v164
  buffer_load_dword v164, v4, s[8:11], 0 offen sc1
  s_cbranch_vccz cB_va0_fw_d
  v_cmp_gt_u32 vcc, s18, v164
  buffer_load_dword v164, v4, s[8:11], 0 offen sc1
  s_cbranch_vccz cB_va0_fw_d
  v_cmp_gt_u32 vcc, s18, v164
  buffer_load_dword v164, v4, s[8:11], 0 offen sc1
  s_cbranch_vccz cB_va0_fw_d
  v_cmp_gt_u32 vcc, s18, v164
  buffer_load_dword v164, v4, s[8:11], 0 offen sc1
  s_cbranch_vccz cB_va0_fw_d
  v_cmp_gt_u32 vcc, s18, v164
  buffer_load_dword v164, v4, s[8:11], 0 offen sc1
  s_cbranch_vccz cB_va0_fw_d
  v_cmp_gt_u32 vcc, s18, v164
  buffer_load_dword v164, v4, s[8:11], 0 offen sc1
  s_cbranch_vccz cB_va0_fw_d
  v_cmp_gt_u32 vcc, s18, v164
  buffer_load_dword v164, v4, s[8:11], 0 offen sc1
  s_cbranch_vccz cB_va0_fw_d
  v_cmp_gt_u32 vcc, s18, v164
  buffer_load_dword v164, v4, s[8:11], 0 offen sc1
  s_cbranch_vccz cB_va0_fw_d
  s_waitcnt vmcnt(24)
  s_add_u32 s30, s30, 1
  s_cmp_lt_u32 s30, 400000
  s_cbranch_scc1 cB_va0_fw_l
  s_branch cB_abort
cB_va0_fw_d:
  buffer_load_dwordx4 v[8:11], v2, s[8:11], s72 offen offset:0 sc1
  buffer_load_dwordx4 v[12:15], v2, s[8:11], s72 offen offset:1024 sc1
  buffer_load_dwordx4 v[16:19], v2, s[8:11], s73 offen offset:0 sc1
  buffer_load_dwordx4 v[20:23], v2, s[8:11], s73 offen offset:1024 sc1
  buffer_load_dwordx4 v[24:27], v2, s[8:11], s74 offen offset:0 sc1
  buffer_load_dwordx4 v[28:31], v2, s[8:11], s74 offen offset:1024 sc1
  buffer_load_dwordx4 v[32:35], v2, s[8:11], s75 offen offset:0 sc1
  buffer_load_dwordx4 v[36:39], v2, s[8:11], s75 offen offset:1024 sc1
  buffer_load_dwordx4 v[40:43], v2, s[8:11], s36 offen offset:0 sc1
  buffer_load_dwordx4 v[44:47], v2, s[8:11], s36 offen offset:1024 sc1
  s_barrier
  ds_read_b128 v[64:67], v2 offset:0
  ds_read_b128 v[68:71], v2 offset:1024
  ds_read_b128 v[72:75], v2 offset:2048
  ds_read_b128 v[76:79], v2 offset:3072
cB_va0_lp:
  s_waitcnt vmcnt(9)
  v_smfmac_f32_16x16x64_bf16 v[48:51], v[8:11], v[80:87], v3
  s_waitcnt vmcnt(8)
  v_smfmac_f32_16x16x64_bf16 v[48:51], v[12:15], v[88:95], v3
  s_waitcnt vmcnt(7)
  v_smfmac_f32_16x16x64_bf16 v[48:51], v[16:19], v[96:103], v3
  s_waitcnt vmcnt(6)
  v_smfmac_f32_16x16x64_bf16 v[48:51], v[20:23], v[104:111], v3
  s_waitcnt vmcnt(5)
  v_smfmac_f32_16x16x64_bf16 v[48:51], v[24:27], v[112:119], v3
  s_waitcnt vmcnt(4)
  v_smfmac_f32_16x16x64_bf16 v[48:51], v[28:31], v[120:127], v3
  s_waitcnt vmcnt(3)
  v_smfmac_f32_16x16x64_bf16 v[48:51], v[32:35], v[128:135], v3
  s_waitcnt vmcnt(2)
  v_smfmac_f32_16x16x64_bf16 v[48:51], v[36:39], v[136:143], v3
  s_waitcnt vmcnt(1) lgkmcnt(0)
  v_smfmac_f32_16x16x64_bf16 v[48:51], v[40:43], v[64:71], v3
  s_waitcnt vmcnt(0)
  v_smfmac_f32_16x16x64_bf16 v[48:51], v[44:47], v[72:79], v3
  s_nop 7
  v_permlane32_swap_b32 v48, v50
  v_permlane32_swap_b32 v49, v51
  v_pk_add_f32 v[48:49], v[48:49], v[50:51]
  v_cvt_pk_bf16_f32 v160, v48, v49
  v_cmp_u_f32 vcc, v48, v49
  s_nop 0
  v_mov_b32_dpp v161, v160 quad_perm:[1,0,3,2] row_mask:0xf bank_mask:0xf
  v_perm_b32 v160, v161, v160, v5
  v_cndmask_b32 v161, v160, v162, vcc
  buffer_store_dword v161, v1, s[8:11], s21 offen sc1
  s_cbranch_vccnz cB_va0_rp
cB_va0_cont:
  s_setprio 0
  s_cmp_lg_u32 s19, 62
  s_cbranch_scc1 cB_va0_nl
  s_mov_b32 s25, 0x40000000
cB_va0_nl:
  s_add_u32 s25, s25, 458752
  v_mov_b32 v36, 0
  v_mov_b32 v37, 0
  v_mov_b32 v38, 0
  v_mov_b32 v39, 0
  v_mov_b32 v40, 0
  v_mov_b32 v41, 0
  v_mov_b32 v42, 0
  v_mov_b32 v43, 0
  v_mov_b32 v44, 0
  v_mov_b32 v45, 0
  v_mov_b32 v46, 0
  v_mov_b32 v47, 0
  v_mov_b32 v48, 0
  v_mov_b32 v49, 0
  v_mov_b32 v50, 0
  v_mov_b32 v51, 0
  v_mov_b32 v52, 0
  v_mov_b32 v53, 0
  v_mov_b32 v54, 0
  v_mov_b32 v55, 0
  v_mov_b32 v56, 0
  v_mov_b32 v57, 0
  v_mov_b32 v58, 0
  v_mov_b32 v59, 0
  v_mov_b32 v60, 0
  v_mov_b32 v61, 0
  v_mov_b32 v62, 0
  v_mov_b32 v63, 0
  s_mov_b32 s19, s18
  s_add_u32 s18, s18, 1
  s_mov_b32 s22, s20
  s_mov_b32 s20, s21
  s_mov_b32 s21, s22
  s_add_u32 s23, s20, 4096
  s_branch cB_va0_loop
cB_va0_slow:
  s_waitcnt lgkmcnt(0)
cB_va0_sl1:
  s_add_u32 s31, s31, 0x1000000
  buffer_load_dwordx4 v[8:11], v2, s[8:11], s20 offen offset:0 sc1
  buffer_load_dwordx4 v[12:15], v2, s[8:11], s20 offen offset:1024 sc1
  buffer_load_dwordx4 v[16:19], v2, s[8:11], s20 offen offset:2048 sc1
  buffer_load_dwordx4 v[20:23], v2, s[8:11], s20 offen offset:3072 sc1
  buffer_load_dwordx4 v[24:27], v2, s[8:11], s23 offen offset:0 sc1
  buffer_load_dwordx4 v[28:31], v2, s[8:11], s23 offen offset:1024 sc1
  buffer_load_dwordx4 v[32:35], v2, s[8:11], s23 offen offset:2048 sc1
  s_waitcnt vmcnt(0)
  v_max3_u32 v36, v8, v9, v10
  v_max3_u32 v36, v36, v11, v12
  v_max3_u32 v36, v36, v13, v14
  v_max3_u32 v36, v36, v15, v16
  v_max3_u32 v36, v36, v17, v18
  v_max3_u32 v36, v36, v19, v20
  v_max3_u32 v36, v36, v21, v22
  v_max3_u32 v36, v36, v23, v24
  v_max3_u32 v36, v36, v25, v26
  v_max3_u32 v36, v36, v27, v28
  v_max3_u32 v36, v36, v29, v30
  v_max3_u32 v36, v36, v31, v32
  v_max3_u32 v36, v36, v33, v34
  v_max_u32 v36, v36, v35
  v_cmp_eq_u32 vcc, -1, v36
  s_cbranch_vccz cB_va0_sl2
  s_add_u32 s30, s30, 1
  s_cmp_lt_u32 s30, 400000
  s_cbranch_scc1 cB_va0_sl1
  s_branch cB_abort
cB_va0_sl2:
  v_mov_b32 v36, 0
  v_mov_b32 v37, 0
  v_mov_b32 v38, 0
  v_mov_b32 v39, 0
  v_mov_b32 v40, 0
  v_mov_b32 v41, 0
  v_mov_b32 v42, 0
  v_mov_b32 v43, 0
  v_mov_b32 v44, 0
  v_mov_b32 v45, 0
  v_mov_b32 v46, 0
  v_mov_b32 v47, 0
  v_mov_b32 v48, 0
  v_mov_b32 v49, 0
  v_mov_b32 v50, 0
  v_mov_b32 v51, 0
  v_mov_b32 v52, 0
  v_mov_b32 v53, 0
  v_mov_b32 v54, 0
  v_mov_b32 v55, 0
  v_mov_b32 v56, 0
  v_mov_b32 v57, 0
  v_mov_b32 v58, 0
  v_mov_b32 v59, 0
  v_mov_b32 v60, 0
  v_mov_b32 v61, 0
  v_mov_b32 v62, 0
  v_mov_b32 v63, 0
  buffer_store_dword v162, v1, s[8:11], s21 offen sc1
  v_smfmac_f32_16x16x64_bf16 v[36:39], v[8:11], a[0:7], v3
  v_smfmac_f32_16x16x64_bf16 v[40:43], v[8:11], a[56:63], v3
  v_smfmac_f32_16x16x64_bf16 v[44:47], v[8:11], a[112:119], v3
  v_smfmac_f32_16x16x64_bf16 v[48:51], v[8:11], a[168:175], v3
  v_smfmac_f32_16x16x64_bf16 v[52:55], v[8:11], a[224:231], v3
  v_smfmac_f32_16x16x64_bf16 v[56:59], v[8:11], v[200:207], v3
  v_smfmac_f32_16x16x64_bf16 v[36:39], v[12:15], a[8:15], v3
  v_smfmac_f32_16x16x64_bf16 v[40:43], v[12:15], a[64:71], v3
  v_smfmac_f32_16x16x64_bf16 v[44:47], v[12:15], a[120:127], v3
  v_smfmac_f32_16x16x64_bf16 v[48:51], v[12:15], a[176:183], v3
  v_smfmac_f32_16x16x64_bf16 v[52:55], v[12:15], a[232:239], v3
  v_smfmac_f32_16x16x64_bf16 v[56:59], v[12:15], v[208:215], v3
  v_smfmac_f32_16x16x64_bf16 v[36:39], v[16:19], a[16:23], v3
  v_smfmac_f32_16x16x64_bf16 v[40:43], v[16:19], a[72:79], v3
  v_smfmac_f32_16x16x64_bf16 v[44:47], v[16:19], a[128:135], v3
  v_smfmac_f32_16x16x64_bf16 v[48:51], v[16:19], a[184:191], v3
  v_smfmac_f32_16x16x64_bf16 v[52:55], v[16:19], a[240:247], v3
  v_smfmac_f32_16x16x64_bf16 v[56:59], v[16:19], v[216:223], v3
  v_smfmac_f32_16x16x64_bf16 v[36:39], v[20:23], a[24:31], v3
  v_smfmac_f32_16x16x64_bf16 v[40:43], v[20:23], a[80:87], v3
  v_smfmac_f32_16x16x64_bf16 v[44:47], v[20:23], a[136:143], v3
  v_smfmac_f32_16x16x64_bf16 v[48:51], v[20:23], a[192:199], v3
  v_smfmac_f32_16x16x64_bf16 v[52:55], v[20:23], a[248:255], v3
  v_smfmac_f32_16x16x64_bf16 v[56:59], v[20:23], v[224:231], v3
  v_smfmac_f32_16x16x64_bf16 v[36:39], v[24:27], a[32:39], v3
  v_smfmac_f32_16x16x64_bf16 v[40:43], v[24:27], a[88:95], v3
  v_smfmac_f32_16x16x64_bf16 v[44:47], v[24:27], a[144:151], v3
  v_smfmac_f32_16x16x64_bf16 v[48:51], v[24:27], a[200:207], v3
  v_smfmac_f32_16x16x64_bf16 v[52:55], v[24:27], v[176:183], v3
  v_smfmac_f32_16x16x64_bf16 v[56:59], v[24:27], v[232:239], v3
  v_smfmac_f32_16x16x64_bf16 v[36:39], v[28:31], a[40:47], v3
  v_smfmac_f32_16x16x64_bf16 v[40:43], v[28:31], a[96:103], v3
  v_smfmac_f32_16x16x64_bf16 v[44:47], v[28:31], a[152:159], v3
  v_smfmac_f32_16x16x64_bf16 v[48:51], v[28:31], a[208:215], v3
  v_smfmac_f32_16x16x64_bf16 v[52:55], v[28:31], v[184:191], v3
  v_smfmac_f32_16x16x64_bf16 v[56:59], v[28:31], v[240:247], v3
  v_smfmac_f32_16x16x64_bf16 v[36:39], v[32:35], a[48:55], v3
  v_smfmac_f32_16x16x64_bf16 v[40:43], v[32:35], a[104:111], v3
  v_smfmac_f32_16x16x64_bf16 v[44:47], v[32:35], a[160:167], v3
  v_smfmac_f32_16x16x64_bf16 v[48:51], v[32:35], a[216:223], v3
  v_smfmac_f32_16x16x64_bf16 v[52:55], v[32:35], v[192:199], v3
  v_smfmac_f32_16x16x64_bf16 v[56:59], v[32:35], v[248:255], v3
  v_permlane32_swap_b32 v36, v38
  v_permlane32_swap_b32 v37, v39
  v_add_f32 v36, v36, v38
  v_add_f32 v37, v37, v39
  v_cvt_pk_bf16_f32 v38, v36, v37
  ds_write_b32 v152, v38
  v_permlane32_swap_b32 v40, v42
  v_permlane32_swap_b32 v41, v43
  v_add_f32 v40, v40, v42
  v_add_f32 v41, v41, v43
  v_cvt_pk_bf16_f32 v42, v40, v41
  ds_write_b32 v153, v42
  v_permlane32_swap_b32 v44, v46
  v_permlane32_swap_b32 v45, v47
  v_add_f32 v44, v44, v46
  v_add_f32 v45, v45, v47
  v_cvt_pk_bf16_f32 v46, v44, v45
  ds_write_b32 v154, v46
  v_permlane32_swap_b32 v48, v50
  v_permlane32_swap_b32 v49, v51
  v_add_f32 v48, v48, v50
  v_add_f32 v49, v49, v51
  v_cvt_pk_bf16_f32 v50, v48, v49
  ds_write_b32 v155, v50
  v_permlane32_swap_b32 v52, v54
  v_permlane32_swap_b32 v53, v55
  v_add_f32 v52, v52, v54
  v_add_f32 v53, v53, v55
  v_cvt_pk_bf16_f32 v54, v52, v53
  ds_write_b32 v156, v54
  v_permlane32_swap_b32 v56, v58
  v_permlane32_swap_b32 v57, v59
  v_add_f32 v56, v56, v58
  v_add_f32 v57, v57, v59
  v_cvt_pk_bf16_f32 v58, v56, v57
  ds_write_b32 v157, v58
  buffer_load_dword v164, v4, s[8:11], 0 offen sc1
  buffer_load_dword v164, v4, s[8:11], 0 offen sc1
  buffer_load_dword v164, v4, s[8:11], 0 offen sc1
  buffer_load_dword v164, v4, s[8:11], 0 offen sc1
  buffer_load_dword v164, v4, s[8:11], 0 offen sc1
  s_branch cB_va0_t2d
cB_va0_last:
  s_barrier
  ds_read_b128 v[64:67], v2 offset:0
  ds_read_b128 v[68:71], v2 offset:1024
  ds_read_b128 v[72:75], v2 offset:2048
  ds_read_b128 v[76:79], v2 offset:3072
  s_waitcnt lgkmcnt(0)
  v_min_u32 v64, -2, v64
  v_min_u32 v65, -2, v65
  v_min_u32 v66, -2, v66
  v_min_u32 v67, -2, v67
  v_min_u32 v68, -2, v68
  v_min_u32 v69, -2, v69
  v_min_u32 v70, -2, v70
  v_min_u32 v71, -2, v71
  v_min_u32 v72, -2, v72
  v_min_u32 v73, -2, v73
  v_min_u32 v74, -2, v74
  v_min_u32 v75, -2, v75
  v_min_u32 v76, -2, v76
  v_min_u32 v77, -2, v77
  v_min_u32 v78, -2, v78
  v_min_u32 v79, -2, v79
  buffer_store_dwordx4 v[64:67], v2, s[8:11], s33 offen offset:0 sc1
  buffer_store_dwordx4 v[68:71], v2, s[8:11], s33 offen offset:2048 sc1
  s_add_u32 s33, s33, 4096
  buffer_store_dwordx4 v[72:75], v2, s[8:11], s33 offen offset:0 sc1
  buffer_store_dwordx4 v[76:79], v2, s[8:11], s33 offen offset:2048 sc1
  s_add_u32 s33, s33, 4096
  s_cmp_lg_u32 s17, 0
  s_cbranch_scc1 cB_done
  s_waitcnt vmcnt(0)
  buffer_wbl2 sc1
  s_branch cB_done
cB_va0_rp:
  s_cmp_eq_u32 s37, 0
  s_cbranch_scc1 cB_va0_rv
  v_min_u32 v160, -2, v160
  buffer_store_dword v160, v1, s[8:11], s21 offen sc1
  s_branch cB_va0_cont
cB_va0_rv:
  s_add_u32 s31, s31, 0x10000
  buffer_load_dwordx4 v[8:11], v2, s[8:11], s72 offen offset:0 sc1
  buffer_load_dwordx4 v[12:15], v2, s[8:11], s72 offen offset:1024 sc1
  buffer_load_dwordx4 v[16:19], v2, s[8:11], s73 offen offset:0 sc1
  buffer_load_dwordx4 v[20:23], v2, s[8:11], s73 offen offset:1024 sc1
  buffer_load_dwordx4 v[24:27], v2, s[8:11], s74 offen offset:0 sc1
  buffer_load_dwordx4 v[28:31], v2, s[8:11], s74 offen offset:1024 sc1
  buffer_load_dwordx4 v[32:35], v2, s[8:11], s75 offen offset:0 sc1
  buffer_load_dwordx4 v[36:39], v2, s[8:11], s75 offen offset:1024 sc1
  buffer_load_dwordx4 v[40:43], v2, s[8:11], s36 offen offset:0 sc1
  buffer_load_dwordx4 v[44:47], v2, s[8:11], s36 offen offset:1024 sc1
  s_waitcnt vmcnt(0)
  v_max3_u32 v52, v8, v9, v10
  v_max3_u32 v52, v52, v11, v12
  v_max3_u32 v52, v52, v13, v14
  v_max3_u32 v52, v52, v15, v16
  v_max3_u32 v52, v52, v17, v18
  v_max3_u32 v52, v52, v19, v20
  v_max3_u32 v52, v52, v21, v22
  v_max3_u32 v52, v52, v23, v24
  v_max3_u32 v52, v52, v25, v26
  v_max3_u32 v52, v52, v27, v28
  v_max3_u32 v52, v52, v29, v30
  v_max3_u32 v52, v52, v31, v32
  v_max3_u32 v52, v52, v33, v34
  v_max3_u32 v52, v52, v35, v36
  v_max3_u32 v52, v52, v37, v38
  v_max3_u32 v52, v52, v39, v40
  v_max3_u32 v52, v52, v41, v42
  v_max3_u32 v52, v52, v43, v44
  v_max3_u32 v52, v52, v45, v46
  v_max_u32 v52, v52, v47
  v_cmp_eq_u32 vcc, -1, v52
  s_mov_b32 s37, 1
  v_mov_b32 v48, 0
  v_mov_b32 v49, 0
  v_mov_b32 v50, 0
  v_mov_b32 v51, 0
  s_nop 1
  s_cbranch_vccz cB_va0_lp
  s_add_u32 s30, s30, 1
  s_cmp_lt_u32 s30, 400000
  s_cbranch_scc1 cB_va0_rv
  s_branch cB_abort
.p2align 6
cB_va1_loop:
  s_mov_b32 s30, 0
  s_barrier
  buffer_load_dwordx4 v[28:31], v2, s[8:11], s23 offen offset:1024 sc1
  buffer_load_dwordx4 v[32:35], v2, s[8:11], s23 offen offset:2048 sc1
  s_barrier
  s_cmp_lt_u32 s19, 60
  s_cbranch_scc1 cB_va1_m1
  buffer_store_dword v160, v1, s[8:11], s38 offen sc1
  s_cmp_lg_u32 s19, 63
  s_cbranch_scc1 cB_va1_m2
  v_min_u32 v64, -2, v64
  v_min_u32 v65, -2, v65
  v_min_u32 v66, -2, v66
  v_min_u32 v67, -2, v67
  v_min_u32 v68, -2, v68
  v_min_u32 v69, -2, v69
  v_min_u32 v70, -2, v70
  v_min_u32 v71, -2, v71
  v_min_u32 v72, -2, v72
  v_min_u32 v73, -2, v73
  v_min_u32 v74, -2, v74
  v_min_u32 v75, -2, v75
  v_min_u32 v76, -2, v76
  v_min_u32 v77, -2, v77
  v_min_u32 v78, -2, v78
  v_min_u32 v79, -2, v79
  buffer_store_dwordx4 v[64:67], v2, s[8:11], s33 offen offset:0 sc1
  buffer_store_dwordx4 v[68:71], v2, s[8:11], s33 offen offset:2048 sc1
  s_add_u32 s33, s33, 4096
  buffer_store_dwordx4 v[72:75], v2, s[8:11], s33 offen offset:0 sc1
  buffer_store_dwordx4 v[76:79], v2, s[8:11], s33 offen offset:2048 sc1
  s_add_u32 s33, s33, 4096
  s_waitcnt vmcnt(5)
  s_branch cB_va1_m3
cB_va1_m1:
  buffer_store_dword v160, v1, s[8:11], s38 offen sc1
cB_va1_m2:
  s_add_u32 s22, s25, s80
  buffer_load_dwordx4 v[80:83], v6, s[8:11], s22 offen offset:0 sc1
  buffer_load_dwordx4 v[84:87], v6, s[8:11], s22 offen offset:1792 sc1
  s_add_u32 s22, s22, 3584
  buffer_load_dwordx4 v[88:91], v6, s[8:11], s22 offen offset:0 sc1
  buffer_load_dwordx4 v[92:95], v6, s[8:11], s22 offen offset:1792 sc1
  s_add_u32 s22, s25, s81
  buffer_load_dwordx4 v[96:99], v6, s[8:11], s22 offen offset:0 sc1
  s_mul_i32 s38, s18, 7168
  s_add_u32 s38, s38, 65536
  s_waitcnt vmcnt(6)
cB_va1_m3:
  ds_write_b128 v2, v[32:35] offset:14336
  v_smfmac_f32_16x16x64_bf16 v[36:39], v[28:31], a[40:47], v3
  buffer_load_dwordx4 v[100:103], v6, s[8:11], s22 offen offset:1792 sc1
  v_smfmac_f32_16x16x64_bf16 v[40:43], v[28:31], a[96:103], v3
  s_add_u32 s22, s22, 3584
  buffer_load_dwordx4 v[104:107], v6, s[8:11], s22 offen offset:0 sc1
  v_smfmac_f32_16x16x64_bf16 v[44:47], v[28:31], a[152:159], v3
  buffer_load_dwordx4 v[108:111], v6, s[8:11], s22 offen offset:1792 sc1
  v_smfmac_f32_16x16x64_bf16 v[48:51], v[28:31], a[208:215], v3
  s_add_u32 s22, s25, s82
  buffer_load_dwordx4 v[112:115], v6, s[8:11], s22 offen offset:0 sc1
  v_smfmac_f32_16x16x64_bf16 v[52:55], v[28:31], v[184:191], v3
  s_waitcnt lgkmcnt(0)
  s_barrier
  ds_read_b128 v[8:11], v2 offset:8192
  ds_read_b128 v[12:15], v2 offset:9216
  ds_read_b128 v[16:19], v2 offset:10240
  ds_read_b128 v[20:23], v2 offset:11264
  ds_read_b128 v[24:27], v2 offset:12288
  buffer_load_dwordx4 v[116:119], v6, s[8:11], s22 offen offset:1792 sc1
  v_smfmac_f32_16x16x64_bf16 v[56:59], v[28:31], v[240:247], v3
  s_add_u32 s22, s22, 3584
  buffer_load_dwordx4 v[120:123], v6, s[8:11], s22 offen offset:0 sc1
  v_smfmac_f32_16x16x64_bf16 v[36:39], v[32:35], a[48:55], v3
  buffer_load_dwordx4 v[124:127], v6, s[8:11], s22 offen offset:1792 sc1
  v_smfmac_f32_16x16x64_bf16 v[40:43], v[32:35], a[104:111], v3
  s_add_u32 s22, s25, s83
  buffer_load_dwordx4 v[128:131], v6, s[8:11], s22 offen offset:0 sc1
  v_smfmac_f32_16x16x64_bf16 v[44:47], v[32:35], a[160:167], v3
  buffer_load_dwordx4 v[132:135], v6, s[8:11], s22 offen offset:1792 sc1
  v_smfmac_f32_16x16x64_bf16 v[48:51], v[32:35], a[216:223], v3
  s_add_u32 s22, s22, 3584
  buffer_load_dwordx4 v[136:139], v6, s[8:11], s22 offen offset:0 sc1
  v_smfmac_f32_16x16x64_bf16 v[52:55], v[32:35], v[192:199], v3
  ds_read_b128 v[64:67], v0 offset:0
  ds_read_b128 v[68:71], v0 offset:1024
  buffer_load_dwordx4 v[140:143], v6, s[8:11], s22 offen offset:1792 sc1
  v_smfmac_f32_16x16x64_bf16 v[56:59], v[32:35], v[248:255], v3
  s_waitcnt lgkmcnt(6)
  ds_read_b128 v[72:75], v0 offset:2048
  ds_read_b128 v[76:79], v0 offset:3072
  v_smfmac_f32_16x16x64_bf16 v[36:39], v[8:11], a[0:7], v3
  s_waitcnt lgkmcnt(7)
  v_smfmac_f32_16x16x64_bf16 v[36:39], v[12:15], a[8:15], v3
  s_waitcnt lgkmcnt(6)
  v_smfmac_f32_16x16x64_bf16 v[36:39], v[16:19], a[16:23], v3
  s_waitcnt lgkmcnt(2)
  v_smfmac_f32_16x16x64_bf16 v[60:63], v[8:11], v[64:71], v3
  s_waitcnt lgkmcnt(5)
  ds_read_b128 v[144:147], v0 offset:4096
  ds_read_b128 v[148:151], v0 offset:5120
  v_smfmac_f32_16x16x64_bf16 v[36:39], v[20:23], a[24:31], v3
  s_waitcnt lgkmcnt(6)
  v_smfmac_f32_16x16x64_bf16 v[36:39], v[24:27], a[32:39], v3
  v_smfmac_f32_16x16x64_bf16 v[40:43], v[8:11], a[56:63], v3
  s_waitcnt lgkmcnt(2)
  v_smfmac_f32_16x16x64_bf16 v[60:63], v[12:15], v[72:79], v3
  ds_read_b128 v[64:67], v0 offset:6144
  ds_read_b128 v[68:71], v0 offset:7168
  v_smfmac_f32_16x16x64_bf16 v[40:43], v[12:15], a[64:71], v3
  v_permlane32_swap_b32 v36, v38
  v_smfmac_f32_16x16x64_bf16 v[40:43], v[16:19], a[72:79], v3
  v_permlane32_swap_b32 v37, v39
  v_smfmac_f32_16x16x64_bf16 v[40:43], v[20:23], a[80:87], v3
  s_waitcnt lgkmcnt(2)
  v_add_f32 v36, v36, v38
  v_smfmac_f32_16x16x64_bf16 v[60:63], v[16:19], v[144:151], v3
  ds_read_b128 v[72:75], v0 offset:8192
  ds_read_b128 v[76:79], v0 offset:9216
  v_add_f32 v37, v37, v39
  v_smfmac_f32_16x16x64_bf16 v[40:43], v[24:27], a[88:95], v3
  v_cmp_u_f32 vcc, v36, v37
  v_smfmac_f32_16x16x64_bf16 v[44:47], v[8:11], a[112:119], v3
  v_cvt_pk_bf16_f32 v38, v36, v37
  v_smfmac_f32_16x16x64_bf16 v[44:47], v[12:15], a[120:127], v3
  ds_write_b32 v152, v38
  s_waitcnt lgkmcnt(3)
  s_cbranch_vccnz cB_va1_slow
  v_permlane32_swap_b32 v40, v42
  v_smfmac_f32_16x16x64_bf16 v[60:63], v[20:23], v[64:71], v3
  ds_read_b128 v[144:147], v0 offset:10240
  ds_read_b128 v[148:151], v0 offset:11264
  v_permlane32_swap_b32 v41, v43
  v_smfmac_f32_16x16x64_bf16 v[44:47], v[16:19], a[128:135], v3
  buffer_store_dword v162, v1, s[8:11], s21 offen sc1
  v_add_f32 v40, v40, v42
  v_smfmac_f32_16x16x64_bf16 v[44:47], v[20:23], a[136:143], v3
  v_add_f32 v41, v41, v43
  v_smfmac_f32_16x16x64_bf16 v[44:47], v[24:27], a[144:151], v3
  s_waitcnt lgkmcnt(3)
  v_cvt_pk_bf16_f32 v42, v40, v41
  v_smfmac_f32_16x16x64_bf16 v[60:63], v[24:27], v[72:79], v3
  ds_write_b32 v153, v42
  ds_read_b128 v[64:67], v0 offset:12288
  ds_read_b128 v[68:71], v0 offset:13312
  v_smfmac_f32_16x16x64_bf16 v[48:51], v[8:11], a[168:175], v3
  s_nop 0
  v_permlane32_swap_b32 v44, v46
  v_smfmac_f32_16x16x64_bf16 v[48:51], v[12:15], a[176:183], v3
  v_permlane32_swap_b32 v45, v47
  v_smfmac_f32_16x16x64_bf16 v[48:51], v[16:19], a[184:191], v3
  s_waitcnt lgkmcnt(3)
  v_add_f32 v44, v44, v46
  v_smfmac_f32_16x16x64_bf16 v[60:63], v[28:31], v[144:151], v3
  v_add_f32 v45, v45, v47
  v_smfmac_f32_16x16x64_bf16 v[48:51], v[20:23], a[192:199], v3
  v_cvt_pk_bf16_f32 v46, v44, v45
  v_smfmac_f32_16x16x64_bf16 v[48:51], v[24:27], a[200:207], v3
  ds_write_b32 v154, v46
  v_smfmac_f32_16x16x64_bf16 v[52:55], v[8:11], a[224:231], v3
  s_waitcnt lgkmcnt(1)
  v_smfmac_f32_16x16x64_bf16 v[60:63], v[32:35], v[64:71], v3
  v_smfmac_f32_16x16x64_bf16 v[52:55], v[12:15], a[232:239], v3
  v_permlane32_swap_b32 v48, v50
  v_smfmac_f32_16x16x64_bf16 v[52:55], v[16:19], a[240:247], v3
  v_permlane32_swap_b32 v49, v51
  v_smfmac_f32_16x16x64_bf16 v[52:55], v[20:23], a[248:255], v3
  v_add_f32 v48, v48, v50
  v_smfmac_f32_16x16x64_bf16 v[52:55], v[24:27], v[176:183], v3
  v_add_f32 v49, v49, v51
  v_smfmac_f32_16x16x64_bf16 v[56:59], v[8:11], v[200:207], v3
  v_cvt_pk_bf16_f32 v50, v48, v49
  v_smfmac_f32_16x16x64_bf16 v[56:59], v[12:15], v[208:215], v3
  ds_write_b32 v155, v50
  v_permlane32_swap_b32 v60, v62
  v_smfmac_f32_16x16x64_bf16 v[56:59], v[16:19], v[216:223], v3
  v_permlane32_swap_b32 v61, v63
  v_smfmac_f32_16x16x64_bf16 v[56:59], v[20:23], v[224:231], v3
  v_add_f32 v60, v60, v62
  v_smfmac_f32_16x16x64_bf16 v[56:59], v[24:27], v[232:239], v3
  v_add_f32 v61, v61, v63
  v_cvt_pk_bf16_f32 v62, v60, v61
  ds_write_b32 v158, v62
  v_permlane32_swap_b32 v52, v54
  v_permlane32_swap_b32 v53, v55
  v_add_f32 v52, v52, v54
  v_add_f32 v53, v53, v55
  v_cvt_pk_bf16_f32 v54, v52, v53
  ds_write_b32 v156, v54
  v_permlane32_swap_b32 v56, v58
  v_permlane32_swap_b32 v57, v59
  v_add_f32 v56, v56, v58
  v_add_f32 v57, v57, v59
  v_cvt_pk_bf16_f32 v58, v56, v57
  ds_write_b32 v157, v58
cB_va1_t2d:
  s_add_u32 s72, s20, s76
  s_add_u32 s73, s20, s77
  s_add_u32 s74, s20, s78
  s_add_u32 s75, s20, s79
  s_add_u32 s22, s20, 9216
  s_add_u32 s34, s20, 13312
  s_add_u32 s36, s20, 7168
  s_mov_b32 s37, 0
  v_mov_b32 v48, 0
  v_mov_b32 v49, 0
  v_mov_b32 v50, 0
  v_mov_b32 v51, 0
  v_mov_b32 v163, s18
  s_cmp_eq_u32 s19, 63
  s_waitcnt lgkmcnt(0)
  s_cbranch_scc1 cB_va1_last
  s_barrier
  buffer_load_dwordx4 v[8:11], v2, s[8:11], s72 offen offset:0 sc1
  buffer_load_dwordx4 v[12:15], v2, s[8:11], s72 offen offset:1024 sc1
  buffer_load_dwordx4 v[16:19], v2, s[8:11], s73 offen offset:0 sc1
  buffer_load_dwordx4 v[20:23], v2, s[8:11], s73 offen offset:1024 sc1
  buffer_load_dwordx4 v[24:27], v2, s[8:11], s74 offen offset:0 sc1
  buffer_load_dwordx4 v[28:31], v2, s[8:11], s74 offen offset:1024 sc1
  buffer_load_dwordx4 v[32:35], v2, s[8:11], s75 offen offset:0 sc1
  buffer_load_dwordx4 v[36:39], v2, s[8:11], s75 offen offset:1024 sc1
  buffer_load_dwordx4 v[40:43], v2, s[8:11], s36 offen offset:0 sc1
  buffer_load_dwordx4 v[44:47], v2, s[8:11], s36 offen offset:1024 sc1
  ds_read_b128 v[64:67], v2 offset:4096
  ds_read_b128 v[68:71], v2 offset:5120
  ds_read_b128 v[72:75], v2 offset:6144
  ds_read_b128 v[76:79], v2 offset:7168
cB_va1_lp:
  s_waitcnt vmcnt(9)
  v_smfmac_f32_16x16x64_bf16 v[48:51], v[8:11], v[80:87], v3
  s_waitcnt vmcnt(8)
  v_smfmac_f32_16x16x64_bf16 v[48:51], v[12:15], v[88:95], v3
  s_waitcnt vmcnt(7)
  v_smfmac_f32_16x16x64_bf16 v[48:51], v[16:19], v[96:103], v3
  v_max3_u32 v55, v8, v12, v16
  s_waitcnt vmcnt(6)
  v_smfmac_f32_16x16x64_bf16 v[48:51], v[20:23], v[104:111], v3
  s_waitcnt vmcnt(5)
  v_smfmac_f32_16x16x64_bf16 v[48:51], v[24:27], v[112:119], v3
  v_max3_u32 v55, v55, v20, v24
  s_waitcnt vmcnt(4)
  v_smfmac_f32_16x16x64_bf16 v[48:51], v[28:31], v[120:127], v3
  v_max_u32 v55, v55, v28
  v_cmp_eq_u32 vcc, -1, v55
  s_waitcnt vmcnt(3)
  v_smfmac_f32_16x16x64_bf16 v[48:51], v[32:35], v[128:135], v3
  s_waitcnt vmcnt(2)
  v_smfmac_f32_16x16x64_bf16 v[48:51], v[36:39], v[136:143], v3
  s_cbranch_vccnz cB_va1_rv
  buffer_store_dword v163, v7, s[8:11], 0 offen sc1
  s_waitcnt vmcnt(2) lgkmcnt(0)
  v_smfmac_f32_16x16x64_bf16 v[48:51], v[40:43], v[64:71], v3
  s_waitcnt vmcnt(1)
  v_smfmac_f32_16x16x64_bf16 v[48:51], v[44:47], v[72:79], v3
  s_nop 7
  v_permlane32_swap_b32 v48, v50
  v_permlane32_swap_b32 v49, v51
  v_pk_add_f32 v[48:49], v[48:49], v[50:51]
  v_cvt_pk_bf16_f32 v160, v48, v49
  v_cmp_u_f32 vcc, v48, v49
  s_nop 0
  v_mov_b32_dpp v161, v160 quad_perm:[1,0,3,2] row_mask:0xf bank_mask:0xf
  v_perm_b32 v160, v161, v160, v5
  v_cndmask_b32 v161, v160, v162, vcc
  buffer_store_dword v161, v1, s[8:11], s21 offen sc1
  s_cbranch_vccnz cB_va1_rp
cB_va1_cont:
  s_cmp_lg_u32 s19, 62
  s_cbranch_scc1 cB_va1_nl
  s_mov_b32 s25, 0x40000000
cB_va1_nl:
  s_add_u32 s25, s25, 458752
  v_mov_b32 v36, 0
  v_mov_b32 v37, 0
  v_mov_b32 v38, 0
  v_mov_b32 v39, 0
  v_mov_b32 v40, 0
  v_mov_b32 v41, 0
  v_mov_b32 v42, 0
  v_mov_b32 v43, 0
  v_mov_b32 v44, 0
  v_mov_b32 v45, 0
  v_mov_b32 v46, 0
  v_mov_b32 v47, 0
  v_mov_b32 v48, 0
  v_mov_b32 v49, 0
  v_mov_b32 v50, 0
  v_mov_b32 v51, 0
  v_mov_b32 v52, 0
  v_mov_b32 v53, 0
  v_mov_b32 v54, 0
  v_mov_b32 v55, 0
  v_mov_b32 v56, 0
  v_mov_b32 v57, 0
  v_mov_b32 v58, 0
  v_mov_b32 v59, 0
  v_mov_b32 v60, 0
  v_mov_b32 v61, 0
  v_mov_b32 v62, 0
  v_mov_b32 v63, 0
  s_mov_b32 s19, s18
  s_add_u32 s18, s18, 1
  s_mov_b32 s22, s20
  s_mov_b32 s20, s21
  s_mov_b32 s21, s22
  s_add_u32 s23, s20, 4096
  s_branch cB_va1_loop
cB_va1_slow:
  s_waitcnt lgkmcnt(0)
cB_va1_sl1:
  s_add_u32 s31, s31, 0x1000000
  buffer_load_dwordx4 v[8:11], v2, s[8:11], s20 offen offset:0 sc1
  buffer_load_dwordx4 v[12:15], v2, s[8:11], s20 offen offset:1024 sc1
  buffer_load_dwordx4 v[16:19], v2, s[8:11], s20 offen offset:2048 sc1
  buffer_load_dwordx4 v[20:23], v2, s[8:11], s20 offen offset:3072 sc1
  buffer_load_dwordx4 v[24:27], v2, s[8:11], s23 offen offset:0 sc1
  buffer_load_dwordx4 v[28:31], v2, s[8:11], s23 offen offset:1024 sc1
  buffer_load_dwordx4 v[32:35], v2, s[8:11], s23 offen offset:2048 sc1
  s_waitcnt vmcnt(0)
  v_max3_u32 v36, v8, v9, v10
  v_max3_u32 v36, v36, v11, v12
  v_max3_u32 v36, v36, v13, v14
  v_max3_u32 v36, v36, v15, v16
  v_max3_u32 v36, v36, v17, v18
  v_max3_u32 v36, v36, v19, v20
  v_max3_u32 v36, v36, v21, v22
  v_max3_u32 v36, v36, v23, v24
  v_max3_u32 v36, v36, v25, v26
  v_max3_u32 v36, v36, v27, v28
  v_max3_u32 v36, v36, v29, v30
  v_max3_u32 v36, v36, v31, v32
  v_max3_u32 v36, v36, v33, v34
  v_max_u32 v36, v36, v35
  v_cmp_eq_u32 vcc, -1, v36
  s_cbranch_vccz cB_va1_sl2
  s_add_u32 s30, s30, 1
  s_cmp_lt_u32 s30, 400000
  s_cbranch_scc1 cB_va1_sl1
  s_branch cB_abort
cB_va1_sl2:
  v_mov_b32 v36, 0
  v_mov_b32 v37, 0
  v_mov_b32 v38, 0
  v_mov_b32 v39, 0
  v_mov_b32 v40, 0
  v_mov_b32 v41, 0
  v_mov_b32 v42, 0
  v_mov_b32 v43, 0
  v_mov_b32 v44, 0
  v_mov_b32 v45, 0
  v_mov_b32 v46, 0
  v_mov_b32 v47, 0
  v_mov_b32 v48, 0
  v_mov_b32 v49, 0
  v_mov_b32 v50, 0
  v_mov_b32 v51, 0
  v_mov_b32 v52, 0
  v_mov_b32 v53, 0
  v_mov_b32 v54, 0
  v_mov_b32 v55, 0
  v_mov_b32 v56, 0
  v_mov_b32 v57, 0
  v_mov_b32 v58, 0
  v_mov_b32 v59, 0
  v_mov_b32 v60, 0
  v_mov_b32 v61, 0
  v_mov_b32 v62, 0
  v_mov_b32 v63, 0
  buffer_store_dword v162, v1, s[8:11], s21 offen sc1
  ds_read_b128 v[64:67], v0 offset:0
  ds_read_b128 v[68:71], v0 offset:1024
  v_smfmac_f32_16x16x64_bf16 v[36:39], v[8:11], a[0:7], v3
  v_smfmac_f32_16x16x64_bf16 v[40:43], v[8:11], a[56:63], v3
  v_smfmac_f32_16x16x64_bf16 v[44:47], v[8:11], a[112:119], v3
  v_smfmac_f32_16x16x64_bf16 v[48:51], v[8:11], a[168:175], v3
  v_smfmac_f32_16x16x64_bf16 v[52:55], v[8:11], a[224:231], v3
  v_smfmac_f32_16x16x64_bf16 v[56:59], v[8:11], v[200:207], v3
  s_waitcnt lgkmcnt(0)
  v_smfmac_f32_16x16x64_bf16 v[60:63], v[8:11], v[64:71], v3
  ds_read_b128 v[72:75], v0 offset:2048
  ds_read_b128 v[76:79], v0 offset:3072
  v_smfmac_f32_16x16x64_bf16 v[36:39], v[12:15], a[8:15], v3
  v_smfmac_f32_16x16x64_bf16 v[40:43], v[12:15], a[64:71], v3
  v_smfmac_f32_16x16x64_bf16 v[44:47], v[12:15], a[120:127], v3
  v_smfmac_f32_16x16x64_bf16 v[48:51], v[12:15], a[176:183], v3
  v_smfmac_f32_16x16x64_bf16 v[52:55], v[12:15], a[232:239], v3
  v_smfmac_f32_16x16x64_bf16 v[56:59], v[12:15], v[208:215], v3
  s_waitcnt lgkmcnt(0)
  v_smfmac_f32_16x16x64_bf16 v[60:63], v[12:15], v[72:79], v3
  ds_read_b128 v[144:147], v0 offset:4096
  ds_read_b128 v[148:151], v0 offset:5120
  v_smfmac_f32_16x16x64_bf16 v[36:39], v[16:19], a[16:23], v3
  v_smfmac_f32_16x16x64_bf16 v[40:43], v[16:19], a[72:79], v3
  v_smfmac_f32_16x16x64_bf16 v[44:47], v[16:19], a[128:135], v3
  v_smfmac_f32_16x16x64_bf16 v[48:51], v[16:19], a[184:191], v3
  v_smfmac_f32_16x16x64_bf16 v[52:55], v[16:19], a[240:247], v3
  v_smfmac_f32_16x16x64_bf16 v[56:59], v[16:19], v[216:223], v3
  s_waitcnt lgkmcnt(0)
  v_smfmac_f32_16x16x64_bf16 v[60:63], v[16:19], v[144:151], v3
  ds_read_b128 v[64:67], v0 offset:6144
  ds_read_b128 v[68:71], v0 offset:7168
  v_smfmac_f32_16x16x64_bf16 v[36:39], v[20:23], a[24:31], v3
  v_smfmac_f32_16x16x64_bf16 v[40:43], v[20:23], a[80:87], v3
  v_smfmac_f32_16x16x64_bf16 v[44:47], v[20:23], a[136:143], v3
  v_smfmac_f32_16x16x64_bf16 v[48:51], v[20:23], a[192:199], v3
  v_smfmac_f32_16x16x64_bf16 v[52:55], v[20:23], a[248:255], v3
  v_smfmac_f32_16x16x64_bf16 v[56:59], v[20:23], v[224:231], v3
  s_waitcnt lgkmcnt(0)
  v_smfmac_f32_16x16x64_bf16 v[60:63], v[20:23], v[64:71], v3
  ds_read_b128 v[72:75], v0 offset:8192
  ds_read_b128 v[76:79], v0 offset:9216
  v_smfmac_f32_16x16x64_bf16 v[36:39], v[24:27], a[32:39], v3
  v_smfmac_f32_16x16x64_bf16 v[40:43], v[24:27], a[88:95], v3
  v_smfmac_f32_16x16x64_bf16 v[44:47], v[24:27], a[144:151], v3
  v_smfmac_f32_16x16x64_bf16 v[48:51], v[24:27], a[200:207], v3
  v_smfmac_f32_16x16x64_bf16 v[52:55], v[24:27], v[176:183], v3
  v_smfmac_f32_16x16x64_bf16 v[56:59], v[24:27], v[232:239], v3
  s_waitcnt lgkmcnt(0)
  v_smfmac_f32_16x16x64_bf16 v[60:63], v[24:27], v[72:79], v3
  ds_read_b128 v[144:147], v0 offset:10240
  ds_read_b128 v[148:151], v0 offset:11264
  v_smfmac_f32_16x16x64_bf16 v[36:39], v[28:31], a[40:47], v3
  v_smfmac_f32_16x16x64_bf16 v[40:43], v[28:31], a[96:103], v3
  v_smfmac_f32_16x16x64_bf16 v[44:47], v[28:31], a[152:159], v3
  v_smfmac_f32_16x16x64_bf16 v[48:51], v[28:31], a[208:215], v3
  v_smfmac_f32_16x16x64_bf16 v[52:55], v[28:31], v[184:191], v3
  v_smfmac_f32_16x16x64_bf16 v[56:59], v[28:31], v[240:247], v3
  s_waitcnt lgkmcnt(0)
  v_smfmac_f32_16x16x64_bf16 v[60:63], v[28:31], v[144:151], v3
  ds_read_b128 v[64:67], v0 offset:12288
  ds_read_b128 v[68:71], v0 offset:13312
  v_smfmac_f32_16x16x64_bf16 v[36:39], v[32:35], a[48:55], v3
  v_smfmac_f32_16x16x64_bf16 v[40:43], v[32:35], a[104:111], v3
  v_smfmac_f32_16x16x64_bf16 v[44:47], v[32:35], a[160:167], v3
  v_smfmac_f32_16x16x64_bf16 v[48:51], v[32:35], a[216:223], v3
  v_smfmac_f32_16x16x64_bf16 v[52:55], v[32:35], v[192:199], v3
  v_smfmac_f32_16x16x64_bf16 v[56:59], v[32:35], v[248:255], v3
  s_waitcnt lgkmcnt(0)
  v_smfmac_f32_16x16x64_bf16 v[60:63], v[32:35], v[64:71], v3
  v_permlane32_swap_b32 v36, v38
  v_permlane32_swap_b32 v37, v39
  v_add_f32 v36, v36, v38
  v_add_f32 v37, v37, v39
  v_cvt_pk_bf16_f32 v38, v36, v37
  ds_write_b32 v152, v38
  v_permlane32_swap_b32 v40, v42
  v_permlane32_swap_b32 v41, v43
  v_add_f32 v40, v40, v42
  v_add_f32 v41, v41, v43
  v_cvt_pk_bf16_f32 v42, v40, v41
  ds_write_b32 v153, v42
  v_permlane32_swap_b32 v44, v46
  v_permlane32_swap_b32 v45, v47
  v_add_f32 v44, v44, v46
  v_add_f32 v45, v45, v47
  v_cvt_pk_bf16_f32 v46, v44, v45
  ds_write_b32 v154, v46
  v_permlane32_swap_b32 v48, v50
  v_permlane32_swap_b32 v49, v51
  v_add_f32 v48, v48, v50
  v_add_f32 v49, v49, v51
  v_cvt_pk_bf16_f32 v50, v48, v49
  ds_write_b32 v155, v50
  v_permlane32_swap_b32 v52, v54
  v_permlane32_swap_b32 v53, v55
  v_add_f32 v52, v52, v54
  v_add_f32 v53, v53, v55
  v_cvt_pk_bf16_f32 v54, v52, v53
  ds_write_b32 v156, v54
  v_permlane32_swap_b32 v56, v58
  v_permlane32_swap_b32 v57, v59
  v_add_f32 v56, v56, v58
  v_add_f32 v57, v57, v59
  v_cvt_pk_bf16_f32 v58, v56, v57
  ds_write_b32 v157, v58
  v_permlane32_swap_b32 v60, v62
  v_permlane32_swap_b32 v61, v63
  v_add_f32 v60, v60, v62
  v_add_f32 v61, v61, v63
  v_cvt_pk_bf16_f32 v62, v60, v61
  ds_write_b32 v158, v62
  s_branch cB_va1_t2d
cB_va1_last:
  s_barrier
  ds_read_b128 v[64:67], v2 offset:4096
  ds_read_b128 v[68:71], v2 offset:5120
  ds_read_b128 v[72:75], v2 offset:6144
  ds_read_b128 v[76:79], v2 offset:7168
  s_waitcnt lgkmcnt(0)
  v_min_u32 v64, -2, v64
  v_min_u32 v65, -2, v65
  v_min_u32 v66, -2, v66
  v_min_u32 v67, -2, v67
  v_min_u32 v68, -2, v68
  v_min_u32 v69, -2, v69
  v_min_u32 v70, -2, v70
  v_min_u32 v71, -2, v71
  v_min_u32 v72, -2, v72
  v_min_u32 v73, -2, v73
  v_min_u32 v74, -2, v74
  v_min_u32 v75, -2, v75
  v_min_u32 v76, -2, v76
  v_min_u32 v77, -2, v77
  v_min_u32 v78, -2, v78
  v_min_u32 v79, -2, v79
  buffer_store_dwordx4 v[64:67], v2, s[8:11], s33 offen offset:0 sc1
  buffer_store_dwordx4 v[68:71], v2, s[8:11], s33 offen offset:2048 sc1
  s_add_u32 s33, s33, 4096
  buffer_store_dwordx4 v[72:75], v2, s[8:11], s33 offen offset:0 sc1
  buffer_store_dwordx4 v[76:79], v2, s[8:11], s33 offen offset:2048 sc1
  s_add_u32 s33, s33, 4096
  s_branch cB_done
cB_va1_rp:
  s_cmp_eq_u32 s37, 0
  s_cbranch_scc1 cB_va1_rv
  v_min_u32 v160, -2, v160
  buffer_store_dword v160, v1, s[8:11], s21 offen sc1
  s_branch cB_va1_cont
cB_va1_rv:
  s_add_u32 s31, s31, 0x10000
  buffer_load_dwordx4 v[8:11], v2, s[8:11], s72 offen offset:0 sc1
  buffer_load_dwordx4 v[12:15], v2, s[8:11], s72 offen offset:1024 sc1
  buffer_load_dwordx4 v[16:19], v2, s[8:11], s73 offen offset:0 sc1
  buffer_load_dwordx4 v[20:23], v2, s[8:11], s73 offen offset:1024 sc1
  buffer_load_dwordx4 v[24:27], v2, s[8:11], s74 offen offset:0 sc1
  buffer_load_dwordx4 v[28:31], v2, s[8:11], s74 offen offset:1024 sc1
  buffer_load_dwordx4 v[32:35], v2, s[8:11], s75 offen offset:0 sc1
  buffer_load_dwordx4 v[36:39], v2, s[8:11], s75 offen offset:1024 sc1
  buffer_load_dwordx4 v[40:43], v2, s[8:11], s36 offen offset:0 sc1
  buffer_load_dwordx4 v[44:47], v2, s[8:11], s36 offen offset:1024 sc1
  s_waitcnt vmcnt(0)
  v_max3_u32 v52, v8, v9, v10
  v_max3_u32 v52, v52, v11, v12
  v_max3_u32 v52, v52, v13, v14
  v_max3_u32 v52, v52, v15, v16
  v_max3_u32 v52, v52, v17, v18
  v_max3_u32 v52, v52, v19, v20
  v_max3_u32 v52, v52, v21, v22
  v_max3_u32 v52, v52, v23, v24
  v_max3_u32 v52, v52, v25, v26
  v_max3_u32 v52, v52, v27, v28
  v_max3_u32 v52, v52, v29, v30
  v_max3_u32 v52, v52, v31, v32
  v_max3_u32 v52, v52, v33, v34
  v_max3_u32 v52, v52, v35, v36
  v_max3_u32 v52, v52, v37, v38
  v_max3_u32 v52, v52, v39, v40
  v_max3_u32 v52, v52, v41, v42
  v_max3_u32 v52, v52, v43, v44
  v_max3_u32 v52, v52, v45, v46
  v_max_u32 v52, v52, v47
  v_cmp_eq_u32 vcc, -1, v52
  s_mov_b32 s37, 1
  v_mov_b32 v48, 0
  v_mov_b32 v49, 0
  v_mov_b32 v50, 0
  v_mov_b32 v51, 0
  s_nop 1
  s_cbranch_vccz cB_va1_lp
  s_add_u32 s30, s30, 1
  s_cmp_lt_u32 s30, 400000
  s_cbranch_scc1 cB_va1_rv
  s_branch cB_abort
.p2align 6
cB_va2_loop:
  s_mov_b32 s30, 0
cB_va2_fp_l:
  v_cmp_gt_u32 vcc, s19, v96
  buffer_load_dword v96, v119, s[8:11], 0 offen sc1
  s_cbranch_vccz cB_va2_fp_d
  v_cmp_gt_u32 vcc, s19, v96
  buffer_load_dword v96, v119, s[8:11], 0 offen sc1
  s_cbranch_vccz cB_va2_fp_d
  v_cmp_gt_u32 vcc, s19, v96
  buffer_load_dword v96, v119, s[8:11], 0 offen sc1
  s_cbranch_vccz cB_va2_fp_d
  v_cmp_gt_u32 vcc, s19, v96
  buffer_load_dword v96, v119, s[8:11], 0 offen sc1
  s_cbranch_vccz cB_va2_fp_d
  v_cmp_gt_u32 vcc, s19, v96
  buffer_load_dword v96, v119, s[8:11], 0 offen sc1
  s_cbranch_vccz cB_va2_fp_d
  v_cmp_gt_u32 vcc, s19, v96
  buffer_load_dword v96, v119, s[8:11], 0 offen sc1
  s_cbranch_vccz cB_va2_fp_d
  v_cmp_gt_u32 vcc, s19, v96
  buffer_load_dword v96, v119, s[8:11], 0 offen sc1
  s_cbranch_vccz cB_va2_fp_d
  v_cmp_gt_u32 vcc, s19, v96
  buffer_load_dword v96, v119, s[8:11], 0 offen sc1
  s_cbranch_vccz cB_va2_fp_d
  v_cmp_gt_u32 vcc, s19, v96
  buffer_load_dword v96, v119, s[8:11], 0 offen sc1
  s_cbranch_vccz cB_va2_fp_d
  v_cmp_gt_u32 vcc, s19, v96
  buffer_load_dword v96, v119, s[8:11], 0 offen sc1
  s_cbranch_vccz cB_va2_fp_d
  v_cmp_gt_u32 vcc, s19, v96
  buffer_load_dword v96, v119, s[8:11], 0 offen sc1
  s_cbranch_vccz cB_va2_fp_d
  v_cmp_gt_u32 vcc, s19, v96
  buffer_load_dword v96, v119, s[8:11], 0 offen sc1
  s_cbranch_vccz cB_va2_fp_d
  v_cmp_gt_u32 vcc, s19, v96
  buffer_load_dword v96, v119, s[8:11], 0 offen sc1
  s_cbranch_vccz cB_va2_fp_d
  v_cmp_gt_u32 vcc, s19, v96
  buffer_load_dword v96, v119, s[8:11], 0 offen sc1
  s_cbranch_vccz cB_va2_fp_d
  v_cmp_gt_u32 vcc, s19, v96
  buffer_load_dword v96, v119, s[8:11], 0 offen sc1
  s_cbranch_vccz cB_va2_fp_d
  v_cmp_gt_u32 vcc, s19, v96
  buffer_load_dword v96, v119, s[8:11], 0 offen sc1
  s_cbranch_vccz cB_va2_fp_d
  s_waitcnt vmcnt(24)
  s_add_u32 s30, s30, 1
  s_cmp_lt_u32 s30, 400000
  s_cbranch_scc1 cB_va2_fp_l
  s_branch cB_abort
cB_va2_fp_d:
  buffer_load_dwordx4 v[8:11], v2, s[8:11], s20 offen offset:0 sc1
  buffer_load_dwordx4 v[12:15], v2, s[8:11], s20 offen offset:1024 sc1
  s_barrier
  s_barrier
  s_waitcnt vmcnt(0)
  ds_write_b128 v2, v[8:11] offset:8192
  ds_write_b128 v2, v[12:15] offset:9216
  v_smfmac_f32_16x16x64_bf16 v[36:39], v[8:11], a[0:7], v3
  v_smfmac_f32_16x16x64_bf16 v[40:43], v[8:11], a[56:63], v3
  v_smfmac_f32_16x16x64_bf16 v[44:47], v[8:11], a[112:119], v3
  v_smfmac_f32_16x16x64_bf16 v[48:51], v[8:11], a[168:175], v3
  v_smfmac_f32_16x16x64_bf16 v[52:55], v[8:11], a[224:231], v3
  s_waitcnt lgkmcnt(0)
  s_barrier
  ds_read_b128 v[16:19], v2 offset:10240
  ds_read_b128 v[20:23], v2 offset:11264
  ds_read_b128 v[24:27], v2 offset:12288
  ds_read_b128 v[28:31], v2 offset:13312
  ds_read_b128 v[32:35], v2 offset:14336
  v_smfmac_f32_16x16x64_bf16 v[56:59], v[8:11], v[144:151], v3
  v_smfmac_f32_16x16x64_bf16 v[60:63], v[8:11], v[200:207], v3
  v_smfmac_f32_16x16x64_bf16 v[36:39], v[12:15], a[8:15], v3
  v_smfmac_f32_16x16x64_bf16 v[40:43], v[12:15], a[64:71], v3
  v_smfmac_f32_16x16x64_bf16 v[44:47], v[12:15], a[120:127], v3
  v_smfmac_f32_16x16x64_bf16 v[48:51], v[12:15], a[176:183], v3
  v_smfmac_f32_16x16x64_bf16 v[52:55], v[12:15], a[232:239], v3
  v_smfmac_f32_16x16x64_bf16 v[56:59], v[12:15], v[152:159], v3
  ds_read_b128 v[68:71], v0 offset:0
  ds_read_b128 v[72:75], v0 offset:1024
  v_smfmac_f32_16x16x64_bf16 v[60:63], v[12:15], v[208:215], v3
  s_waitcnt lgkmcnt(6)
  ds_read_b128 v[76:79], v0 offset:2048
  ds_read_b128 v[80:83], v0 offset:3072
  v_smfmac_f32_16x16x64_bf16 v[36:39], v[16:19], a[16:23], v3
  s_waitcnt lgkmcnt(7)
  v_smfmac_f32_16x16x64_bf16 v[36:39], v[20:23], a[24:31], v3
  s_waitcnt lgkmcnt(6)
  v_smfmac_f32_16x16x64_bf16 v[36:39], v[24:27], a[32:39], v3
  s_waitcnt lgkmcnt(2)
  v_smfmac_f32_16x16x64_bf16 v[64:67], v[8:11], v[68:75], v3
  s_waitcnt lgkmcnt(5)
  ds_read_b128 v[84:87], v0 offset:4096
  ds_read_b128 v[88:91], v0 offset:5120
  v_smfmac_f32_16x16x64_bf16 v[36:39], v[28:31], a[40:47], v3
  s_waitcnt lgkmcnt(6)
  v_smfmac_f32_16x16x64_bf16 v[36:39], v[32:35], a[48:55], v3
  v_smfmac_f32_16x16x64_bf16 v[40:43], v[16:19], a[72:79], v3
  s_waitcnt lgkmcnt(2)
  v_smfmac_f32_16x16x64_bf16 v[64:67], v[12:15], v[76:83], v3
  ds_read_b128 v[68:71], v0 offset:6144
  ds_read_b128 v[72:75], v0 offset:7168
  v_smfmac_f32_16x16x64_bf16 v[40:43], v[20:23], a[80:87], v3
  v_permlane32_swap_b32 v36, v38
  v_smfmac_f32_16x16x64_bf16 v[40:43], v[24:27], a[88:95], v3
  v_permlane32_swap_b32 v37, v39
  v_smfmac_f32_16x16x64_bf16 v[40:43], v[28:31], a[96:103], v3
  s_waitcnt lgkmcnt(2)
  v_add_f32 v36, v36, v38
  v_smfmac_f32_16x16x64_bf16 v[64:67], v[16:19], v[84:91], v3
  ds_read_b128 v[76:79], v0 offset:8192
  ds_read_b128 v[80:83], v0 offset:9216
  v_add_f32 v37, v37, v39
  v_smfmac_f32_16x16x64_bf16 v[40:43], v[32:35], a[104:111], v3
  v_cmp_u_f32 vcc, v36, v37
  v_smfmac_f32_16x16x64_bf16 v[44:47], v[16:19], a[128:135], v3
  v_cvt_pk_bf16_f32 v38, v36, v37
  v_smfmac_f32_16x16x64_bf16 v[44:47], v[20:23], a[136:143], v3
  ds_write_b32 v104, v38
  s_waitcnt lgkmcnt(3)
  s_cbranch_vccnz cB_va2_slow
  v_permlane32_swap_b32 v40, v42
  v_smfmac_f32_16x16x64_bf16 v[64:67], v[20:23], v[68:75], v3
  ds_read_b128 v[84:87], v0 offset:10240
  ds_read_b128 v[88:91], v0 offset:11264
  v_permlane32_swap_b32 v41, v43
  v_smfmac_f32_16x16x64_bf16 v[44:47], v[24:27], a[144:151], v3
  v_add_f32 v40, v40, v42
  v_smfmac_f32_16x16x64_bf16 v[44:47], v[28:31], a[152:159], v3
  v_add_f32 v41, v41, v43
  v_smfmac_f32_16x16x64_bf16 v[44:47], v[32:35], a[160:167], v3
  s_waitcnt lgkmcnt(3)
  v_cvt_pk_bf16_f32 v42, v40, v41
  v_smfmac_f32_16x16x64_bf16 v[64:67], v[24:27], v[76:83], v3
  ds_write_b32 v105, v42
  ds_read_b128 v[68:71], v0 offset:12288
  ds_read_b128 v[72:75], v0 offset:13312
  v_smfmac_f32_16x16x64_bf16 v[48:51], v[16:19], a[184:191], v3
  s_nop 0
  v_permlane32_swap_b32 v44, v46
  v_smfmac_f32_16x16x64_bf16 v[48:51], v[20:23], a[192:199], v3
  v_permlane32_swap_b32 v45, v47
  v_smfmac_f32_16x16x64_bf16 v[48:51], v[24:27], a[200:207], v3
  s_waitcnt lgkmcnt(3)
  v_add_f32 v44, v44, v46
  v_smfmac_f32_16x16x64_bf16 v[64:67], v[28:31], v[84:91], v3
  v_add_f32 v45, v45, v47
  v_smfmac_f32_16x16x64_bf16 v[48:51], v[28:31], a[208:215], v3
  v_cvt_pk_bf16_f32 v46, v44, v45
  v_smfmac_f32_16x16x64_bf16 v[48:51], v[32:35], a[216:223], v3
  ds_write_b32 v106, v46
  v_smfmac_f32_16x16x64_bf16 v[52:55], v[16:19], a[240:247], v3
  s_waitcnt lgkmcnt(1)
  v_smfmac_f32_16x16x64_bf16 v[64:67], v[32:35], v[68:75], v3
  v_smfmac_f32_16x16x64_bf16 v[52:55], v[20:23], a[248:255], v3
  v_permlane32_swap_b32 v48, v50
  v_smfmac_f32_16x16x64_bf16 v[52:55], v[24:27], v[120:127], v3
  v_permlane32_swap_b32 v49, v51
  v_smfmac_f32_16x16x64_bf16 v[52:55], v[28:31], v[128:135], v3
  v_add_f32 v48, v48, v50
  v_smfmac_f32_16x16x64_bf16 v[52:55], v[32:35], v[136:143], v3
  v_add_f32 v49, v49, v51
  v_smfmac_f32_16x16x64_bf16 v[56:59], v[16:19], v[160:167], v3
  v_cvt_pk_bf16_f32 v50, v48, v49
  v_smfmac_f32_16x16x64_bf16 v[56:59], v[20:23], v[168:175], v3
  ds_write_b32 v107, v50
  v_permlane32_swap_b32 v64, v66
  v_smfmac_f32_16x16x64_bf16 v[56:59], v[24:27], v[176:183], v3
  v_permlane32_swap_b32 v65, v67
  v_smfmac_f32_16x16x64_bf16 v[56:59], v[28:31], v[184:191], v3
  v_add_f32 v64, v64, v66
  v_smfmac_f32_16x16x64_bf16 v[56:59], v[32:35], v[192:199], v3
  v_add_f32 v65, v65, v67
  v_smfmac_f32_16x16x64_bf16 v[60:63], v[16:19], v[216:223], v3
  v_cvt_pk_bf16_f32 v66, v64, v65
  v_smfmac_f32_16x16x64_bf16 v[60:63], v[20:23], v[224:231], v3
  ds_write_b32 v111, v66
  v_permlane32_swap_b32 v52, v54
  v_smfmac_f32_16x16x64_bf16 v[60:63], v[24:27], v[232:239], v3
  v_permlane32_swap_b32 v53, v55
  v_smfmac_f32_16x16x64_bf16 v[60:63], v[28:31], v[240:247], v3
  v_add_f32 v52, v52, v54
  v_smfmac_f32_16x16x64_bf16 v[60:63], v[32:35], v[248:255], v3
  v_add_f32 v53, v53, v55
  v_cvt_pk_bf16_f32 v54, v52, v53
  ds_write_b32 v108, v54
  v_permlane32_swap_b32 v56, v58
  v_permlane32_swap_b32 v57, v59
  v_add_f32 v56, v56, v58
  v_add_f32 v57, v57, v59
  v_cvt_pk_bf16_f32 v58, v56, v57
  ds_write_b32 v109, v58
  v_permlane32_swap_b32 v60, v62
  v_permlane32_swap_b32 v61, v63
  v_add_f32 v60, v60, v62
  v_add_f32 v61, v61, v63
  v_cvt_pk_bf16_f32 v62, v60, v61
  ds_write_b32 v110, v62
cB_va2_t2d:
  v_mov_b32 v117, s18
  s_waitcnt lgkmcnt(0)
  s_barrier
  s_cmp_eq_u32 s19, 63
  s_cbranch_scc1 cB_done
  s_sleep 1
  v_mov_b32 v36, 0
  v_mov_b32 v37, 0
  v_mov_b32 v38, 0
  v_mov_b32 v39, 0
  v_mov_b32 v40, 0
  v_mov_b32 v41, 0
  v_mov_b32 v42, 0
  v_mov_b32 v43, 0
  v_mov_b32 v44, 0
  v_mov_b32 v45, 0
  v_mov_b32 v46, 0
  v_mov_b32 v47, 0
  v_mov_b32 v48, 0
  v_mov_b32 v49, 0
  v_mov_b32 v50, 0
  v_mov_b32 v51, 0
  v_mov_b32 v52, 0
  v_mov_b32 v53, 0
  v_mov_b32 v54, 0
  v_mov_b32 v55, 0
  v_mov_b32 v56, 0
  v_mov_b32 v57, 0
  v_mov_b32 v58, 0
  v_mov_b32 v59, 0
  v_mov_b32 v60, 0
  v_mov_b32 v61, 0
  v_mov_b32 v62, 0
  v_mov_b32 v63, 0
  v_mov_b32 v64, 0
  v_mov_b32 v65, 0
  v_mov_b32 v66, 0
  v_mov_b32 v67, 0
  s_sleep 5
  s_mov_b32 s19, s18
  s_add_u32 s18, s18, 1
  s_mov_b32 s22, s20
  s_mov_b32 s20, s21
  s_mov_b32 s21, s22
  s_add_u32 s23, s20, 4096
  s_branch cB_va2_loop
cB_va2_slow:
  s_waitcnt lgkmcnt(0)
cB_va2_sl1:
  s_add_u32 s31, s31, 0x1000000
  buffer_load_dwordx4 v[8:11], v2, s[8:11], s20 offen offset:0 sc1
  buffer_load_dwordx4 v[12:15], v2, s[8:11], s20 offen offset:1024 sc1
  buffer_load_dwordx4 v[16:19], v2, s[8:11], s20 offen offset:2048 sc1
  buffer_load_dwordx4 v[20:23], v2, s[8:11], s20 offen offset:3072 sc1
  buffer_load_dwordx4 v[24:27], v2, s[8:11], s23 offen offset:0 sc1
  buffer_load_dwordx4 v[28:31], v2, s[8:11], s23 offen offset:1024 sc1
  buffer_load_dwordx4 v[32:35], v2, s[8:11], s23 offen offset:2048 sc1
  s_waitcnt vmcnt(0)
  v_max3_u32 v36, v8, v9, v10
  v_max3_u32 v36, v36, v11, v12
  v_max3_u32 v36, v36, v13, v14
  v_max3_u32 v36, v36, v15, v16
  v_max3_u32 v36, v36, v17, v18
  v_max3_u32 v36, v36, v19, v20
  v_max3_u32 v36, v36, v21, v22
  v_max3_u32 v36, v36, v23, v24
  v_max3_u32 v36, v36, v25, v26
  v_max3_u32 v36, v36, v27, v28
  v_max3_u32 v36, v36, v29, v30
  v_max3_u32 v36, v36, v31, v32
  v_max3_u32 v36, v36, v33, v34
  v_max_u32 v36, v36, v35
  v_cmp_eq_u32 vcc, -1, v36
  s_cbranch_vccz cB_va2_sl2
  s_add_u32 s30, s30, 1
  s_cmp_lt_u32 s30, 400000
  s_cbranch_scc1 cB_va2_sl1
  s_branch cB_abort
cB_va2_sl2:
  v_mov_b32 v36, 0
  v_mov_b32 v37, 0
  v_mov_b32 v38, 0
  v_mov_b32 v39, 0
  v_mov_b32 v40, 0
  v_mov_b32 v41, 0
  v_mov_b32 v42, 0
  v_mov_b32 v43, 0
  v_mov_b32 v44, 0
  v_mov_b32 v45, 0
  v_mov_b32 v46, 0
  v_mov_b32 v47, 0
  v_mov_b32 v48, 0
  v_mov_b32 v49, 0
  v_mov_b32 v50, 0
  v_mov_b32 v51, 0
  v_mov_b32 v52, 0
  v_mov_b32 v53, 0
  v_mov_b32 v54, 0
  v_mov_b32 v55, 0
  v_mov_b32 v56, 0
  v_mov_b32 v57, 0
  v_mov_b32 v58, 0
  v_mov_b32 v59, 0
  v_mov_b32 v60, 0
  v_mov_b32 v61, 0
  v_mov_b32 v62, 0
  v_mov_b32 v63, 0
  v_mov_b32 v64, 0
  v_mov_b32 v65, 0
  v_mov_b32 v66, 0
  v_mov_b32 v67, 0
  ds_read_b128 v[68:71], v0 offset:0
  ds_read_b128 v[72:75], v0 offset:1024
  v_smfmac_f32_16x16x64_bf16 v[36:39], v[8:11], a[0:7], v3
  v_smfmac_f32_16x16x64_bf16 v[40:43], v[8:11], a[56:63], v3
  v_smfmac_f32_16x16x64_bf16 v[44:47], v[8:11], a[112:119], v3
  v_smfmac_f32_16x16x64_bf16 v[48:51], v[8:11], a[168:175], v3
  v_smfmac_f32_16x16x64_bf16 v[52:55], v[8:11], a[224:231], v3
  v_smfmac_f32_16x16x64_bf16 v[56:59], v[8:11], v[144:151], v3
  v_smfmac_f32_16x16x64_bf16 v[60:63], v[8:11], v[200:207], v3
  s_waitcnt lgkmcnt(0)
  v_smfmac_f32_16x16x64_bf16 v[64:67], v[8:11], v[68:75], v3
  ds_read_b128 v[76:79], v0 offset:2048
  ds_read_b128 v[80:83], v0 offset:3072
  v_smfmac_f32_16x16x64_bf16 v[36:39], v[12:15], a[8:15], v3
  v_smfmac_f32_16x16x64_bf16 v[40:43], v[12:15], a[64:71], v3
  v_smfmac_f32_16x16x64_bf16 v[44:47], v[12:15], a[120:127], v3
  v_smfmac_f32_16x16x64_bf16 v[48:51], v[12:15], a[176:183], v3
  v_smfmac_f32_16x16x64_bf16 v[52:55], v[12:15], a[232:239], v3
  v_smfmac_f32_16x16x64_bf16 v[56:59], v[12:15], v[152:159], v3
  v_smfmac_f32_16x16x64_bf16 v[60:63], v[12:15], v[208:215], v3
  s_waitcnt lgkmcnt(0)
  v_smfmac_f32_16x16x64_bf16 v[64:67], v[12:15], v[76:83], v3
  ds_read_b128 v[84:87], v0 offset:4096
  ds_read_b128 v[88:91], v0 offset:5120
  v_smfmac_f32_16x16x64_bf16 v[36:39], v[16:19], a[16:23], v3
  v_smfmac_f32_16x16x64_bf16 v[40:43], v[16:19], a[72:79], v3
  v_smfmac_f32_16x16x64_bf16 v[44:47], v[16:19], a[128:135], v3
  v_smfmac_f32_16x16x64_bf16 v[48:51], v[16:19], a[184:191], v3
  v_smfmac_f32_16x16x64_bf16 v[52:55], v[16:19], a[240:247], v3
  v_smfmac_f32_16x16x64_bf16 v[56:59], v[16:19], v[160:167], v3
  v_smfmac_f32_16x16x64_bf16 v[60:63], v[16:19], v[216:223], v3
  s_waitcnt lgkmcnt(0)
  v_smfmac_f32_16x16x64_bf16 v[64:67], v[16:19], v[84:91], v3
  ds_read_b128 v[68:71], v0 offset:6144
  ds_read_b128 v[72:75], v0 offset:7168
  v_smfmac_f32_16x16x64_bf16 v[36:39], v[20:23], a[24:31], v3
  v_smfmac_f32_16x16x64_bf16 v[40:43], v[20:23], a[80:87], v3
  v_smfmac_f32_16x16x64_bf16 v[44:47], v[20:23], a[136:143], v3
  v_smfmac_f32_16x16x64_bf16 v[48:51], v[20:23], a[192:199], v3
  v_smfmac_f32_16x16x64_bf16 v[52:55], v[20:23], a[248:255], v3
  v_smfmac_f32_16x16x64_bf16 v[56:59], v[20:23], v[168:175], v3
  v_smfmac_f32_16x16x64_bf16 v[60:63], v[20:23], v[224:231], v3
  s_waitcnt lgkmcnt(0)
  v_smfmac_f32_16x16x64_bf16 v[64:67], v[20:23], v[68:75], v3
  ds_read_b128 v[76:79], v0 offset:8192
  ds_read_b128 v[80:83], v0 offset:9216
  v_smfmac_f32_16x16x64_bf16 v[36:39], v[24:27], a[32:39], v3
  v_smfmac_f32_16x16x64_bf16 v[40:43], v[24:27], a[88:95], v3
  v_smfmac_f32_16x16x64_bf16 v[44:47], v[24:27], a[144:151], v3
  v_smfmac_f32_16x16x64_bf16 v[48:51], v[24:27], a[200:207], v3
  v_smfmac_f32_16x16x64_bf16 v[52:55], v[24:27], v[120:127], v3
  v_smfmac_f32_16x16x64_bf16 v[56:59], v[24:27], v[176:183], v3
  v_smfmac_f32_16x16x64_bf16 v[60:63], v[24:27], v[232:239], v3
  s_waitcnt lgkmcnt(0)
  v_smfmac_f32_16x16x64_bf16 v[64:67], v[24:27], v[76:83], v3
  ds_read_b128 v[84:87], v0 offset:10240
  ds_read_b128 v[88:91], v0 offset:11264
  v_smfmac_f32_16x16x64_bf16 v[36:39], v[28:31], a[40:47], v3
  v_smfmac_f32_16x16x64_bf16 v[40:43], v[28:31], a[96:103], v3
  v_smfmac_f32_16x16x64_bf16 v[44:47], v[28:31], a[152:159], v3
  v_smfmac_f32_16x16x64_bf16 v[48:51], v[28:31], a[208:215], v3
  v_smfmac_f32_16x16x64_bf16 v[52:55], v[28:31], v[128:135], v3
  v_smfmac_f32_16x16x64_bf16 v[56:59], v[28:31], v[184:191], v3
  v_smfmac_f32_16x16x64_bf16 v[60:63], v[28:31], v[240:247], v3
  s_waitcnt lgkmcnt(0)
  v_smfmac_f32_16x16x64_bf16 v[64:67], v[28:31], v[84:91], v3
  ds_read_b128 v[68:71], v0 offset:12288
  ds_read_b128 v[72:75], v0 offset:13312
  v_smfmac_f32_16x16x64_bf16 v[36:39], v[32:35], a[48:55], v3
  v_smfmac_f32_16x16x64_bf16 v[40:43], v[32:35], a[104:111], v3
  v_smfmac_f32_16x16x64_bf16 v[44:47], v[32:35], a[160:167], v3
  v_smfmac_f32_16x16x64_bf16 v[48:51], v[32:35], a[216:223], v3
  v_smfmac_f32_16x16x64_bf16 v[52:55], v[32:35], v[136:143], v3
  v_smfmac_f32_16x16x64_bf16 v[56:59], v[32:35], v[192:199], v3
  v_smfmac_f32_16x16x64_bf16 v[60:63], v[32:35], v[248:255], v3
  s_waitcnt lgkmcnt(0)
  v_smfmac_f32_16x16x64_bf16 v[64:67], v[32:35], v[68:75], v3
  v_permlane32_swap_b32 v36, v38
  v_permlane32_swap_b32 v37, v39
  v_add_f32 v36, v36, v38
  v_add_f32 v37, v37, v39
  v_cvt_pk_bf16_f32 v38, v36, v37
  ds_write_b32 v104, v38
  v_permlane32_swap_b32 v40, v42
  v_permlane32_swap_b32 v41, v43
  v_add_f32 v40, v40, v42
  v_add_f32 v41, v41, v43
  v_cvt_pk_bf16_f32 v42, v40, v41
  ds_write_b32 v105, v42
  v_permlane32_swap_b32 v44, v46
  v_permlane32_swap_b32 v45, v47
  v_add_f32 v44, v44, v46
  v_add_f32 v45, v45, v47
  v_cvt_pk_bf16_f32 v46, v44, v45
  ds_write_b32 v106, v46
  v_permlane32_swap_b32 v48, v50
  v_permlane32_swap_b32 v49, v51
  v_add_f32 v48, v48, v50
  v_add_f32 v49, v49, v51
  v_cvt_pk_bf16_f32 v50, v48, v49
  ds_write_b32 v107, v50
  v_permlane32_swap_b32 v52, v54
  v_permlane32_swap_b32 v53, v55
  v_add_f32 v52, v52, v54
  v_add_f32 v53, v53, v55
  v_cvt_pk_bf16_f32 v54, v52, v53
  ds_write_b32 v108, v54
  v_permlane32_swap_b32 v56, v58
  v_permlane32_swap_b32 v57, v59
  v_add_f32 v56, v56, v58
  v_add_f32 v57, v57, v59
  v_cvt_pk_bf16_f32 v58, v56, v57
  ds_write_b32 v109, v58
  v_permlane32_swap_b32 v60, v62
  v_permlane32_swap_b32 v61, v63
  v_add_f32 v60, v60, v62
  v_add_f32 v61, v61, v63
  v_cvt_pk_bf16_f32 v62, v60, v61
  ds_write_b32 v110, v62
  v_permlane32_swap_b32 v64, v66
  v_permlane32_swap_b32 v65, v67
  v_add_f32 v64, v64, v66
  v_add_f32 v65, v65, v67
  v_cvt_pk_bf16_f32 v66, v64, v65
  ds_write_b32 v111, v66
  s_branch cB_va2_t2d
.p2align 6
cB_va3_loop:
  s_mov_b32 s30, 0
  s_barrier
  buffer_load_dwordx4 v[16:19], v2, s[8:11], s20 offen offset:2048 sc1
  buffer_load_dwordx4 v[20:23], v2, s[8:11], s20 offen offset:3072 sc1
  s_barrier
  buffer_load_dword v100, v116, s[8:11], s39 offen sc1
  s_add_u32 s27, s19, 2
  s_min_u32 s27, s27, 63
  s_lshr_b32 s27, s27, 3
  s_lshl_b32 s27, s27, 11
  s_add_u32 s27, s27, s35
  s_cmp_eq_u32 s27, s28
  s_cselect_b32 s29, 35328, s27
  buffer_load_dword v101, off, s[8:11], s29 sc1
  s_add_u32 s39, s39, 28672
  s_waitcnt vmcnt(2)
  ds_write_b128 v2, v[16:19] offset:10240
  ds_write_b128 v2, v[20:23] offset:11264
  v_smfmac_f32_16x16x64_bf16 v[36:39], v[16:19], a[16:23], v3
  v_smfmac_f32_16x16x64_bf16 v[40:43], v[16:19], a[72:79], v3
  v_smfmac_f32_16x16x64_bf16 v[44:47], v[16:19], a[128:135], v3
  v_smfmac_f32_16x16x64_bf16 v[48:51], v[16:19], a[184:191], v3
  v_smfmac_f32_16x16x64_bf16 v[52:55], v[16:19], a[240:247], v3
  s_waitcnt lgkmcnt(0)
  s_barrier
  ds_read_b128 v[8:11], v2 offset:8192
  ds_read_b128 v[12:15], v2 offset:9216
  ds_read_b128 v[24:27], v2 offset:12288
  ds_read_b128 v[28:31], v2 offset:13312
  ds_read_b128 v[32:35], v2 offset:14336
  v_smfmac_f32_16x16x64_bf16 v[56:59], v[16:19], v[160:167], v3
  v_smfmac_f32_16x16x64_bf16 v[60:63], v[16:19], v[216:223], v3
  v_smfmac_f32_16x16x64_bf16 v[36:39], v[20:23], a[24:31], v3
  v_smfmac_f32_16x16x64_bf16 v[40:43], v[20:23], a[80:87], v3
  v_smfmac_f32_16x16x64_bf16 v[44:47], v[20:23], a[136:143], v3
  v_smfmac_f32_16x16x64_bf16 v[48:51], v[20:23], a[192:199], v3
  v_smfmac_f32_16x16x64_bf16 v[52:55], v[20:23], a[248:255], v3
  v_smfmac_f32_16x16x64_bf16 v[56:59], v[20:23], v[168:175], v3
  v_smfmac_f32_16x16x64_bf16 v[60:63], v[20:23], v[224:231], v3
  s_waitcnt lgkmcnt(4)
  v_smfmac_f32_16x16x64_bf16 v[36:39], v[8:11], a[0:7], v3
  s_waitcnt lgkmcnt(3)
  v_smfmac_f32_16x16x64_bf16 v[36:39], v[12:15], a[8:15], v3
  s_waitcnt lgkmcnt(2)
  v_smfmac_f32_16x16x64_bf16 v[36:39], v[24:27], a[32:39], v3
  s_waitcnt lgkmcnt(1)
  v_smfmac_f32_16x16x64_bf16 v[36:39], v[28:31], a[40:47], v3
  s_waitcnt lgkmcnt(0)
  v_smfmac_f32_16x16x64_bf16 v[36:39], v[32:35], a[48:55], v3
  v_smfmac_f32_16x16x64_bf16 v[40:43], v[8:11], a[56:63], v3
  v_smfmac_f32_16x16x64_bf16 v[40:43], v[12:15], a[64:71], v3
  v_smfmac_f32_16x16x64_bf16 v[40:43], v[24:27], a[88:95], v3
  v_permlane32_swap_b32 v36, v38
  v_smfmac_f32_16x16x64_bf16 v[40:43], v[28:31], a[96:103], v3
  v_permlane32_swap_b32 v37, v39
  v_smfmac_f32_16x16x64_bf16 v[40:43], v[32:35], a[104:111], v3
  v_add_f32 v36, v36, v38
  v_smfmac_f32_16x16x64_bf16 v[44:47], v[8:11], a[112:119], v3
  v_add_f32 v37, v37, v39
  v_smfmac_f32_16x16x64_bf16 v[44:47], v[12:15], a[120:127], v3
  v_cmp_u_f32 vcc, v36, v37
  v_smfmac_f32_16x16x64_bf16 v[44:47], v[24:27], a[144:151], v3
  v_cvt_pk_bf16_f32 v38, v36, v37
  v_smfmac_f32_16x16x64_bf16 v[44:47], v[28:31], a[152:159], v3
  ds_write_b32 v104, v38
  s_cbranch_vccnz cB_va3_slow
  v_permlane32_swap_b32 v40, v42
  v_smfmac_f32_16x16x64_bf16 v[44:47], v[32:35], a[160:167], v3
  v_permlane32_swap_b32 v41, v43
  v_smfmac_f32_16x16x64_bf16 v[48:51], v[8:11], a[168:175], v3
  v_add_f32 v40, v40, v42
  v_smfmac_f32_16x16x64_bf16 v[48:51], v[12:15], a[176:183], v3
  v_add_f32 v41, v41, v43
  v_smfmac_f32_16x16x64_bf16 v[48:51], v[24:27], a[200:207], v3
  v_cvt_pk_bf16_f32 v42, v40, v41
  v_smfmac_f32_16x16x64_bf16 v[48:51], v[28:31], a[208:215], v3
  ds_write_b32 v105, v42
  v_permlane32_swap_b32 v44, v46
  v_smfmac_f32_16x16x64_bf16 v[48:51], v[32:35], a[216:223], v3
  v_permlane32_swap_b32 v45, v47
  v_smfmac_f32_16x16x64_bf16 v[52:55], v[8:11], a[224:231], v3
  v_add_f32 v44, v44, v46
  v_smfmac_f32_16x16x64_bf16 v[52:55], v[12:15], a[232:239], v3
  v_add_f32 v45, v45, v47
  v_smfmac_f32_16x16x64_bf16 v[52:55], v[24:27], v[120:127], v3
  v_cvt_pk_bf16_f32 v46, v44, v45
  v_smfmac_f32_16x16x64_bf16 v[52:55], v[28:31], v[128:135], v3
  ds_write_b32 v106, v46
  v_permlane32_swap_b32 v48, v50
  v_smfmac_f32_16x16x64_bf16 v[52:55], v[32:35], v[136:143], v3
  v_permlane32_swap_b32 v49, v51
  v_smfmac_f32_16x16x64_bf16 v[56:59], v[8:11], v[144:151], v3
  v_add_f32 v48, v48, v50
  v_smfmac_f32_16x16x64_bf16 v[56:59], v[12:15], v[152:159], v3
  v_add_f32 v49, v49, v51
  v_smfmac_f32_16x16x64_bf16 v[56:59], v[24:27], v[176:183], v3
  v_cvt_pk_bf16_f32 v50, v48, v49
  v_smfmac_f32_16x16x64_bf16 v[56:59], v[28:31], v[184:191], v3
  ds_write_b32 v107, v50
  v_permlane32_swap_b32 v52, v54
  v_smfmac_f32_16x16x64_bf16 v[56:59], v[32:35], v[192:199], v3
  v_permlane32_swap_b32 v53, v55
  v_smfmac_f32_16x16x64_bf16 v[60:63], v[8:11], v[200:207], v3
  v_add_f32 v52, v52, v54
  v_smfmac_f32_16x16x64_bf16 v[60:63], v[12:15], v[208:215], v3
  v_add_f32 v53, v53, v55
  v_smfmac_f32_16x16x64_bf16 v[60:63], v[24:27], v[232:239], v3
  v_cvt_pk_bf16_f32 v54, v52, v53
  v_smfmac_f32_16x16x64_bf16 v[60:63], v[28:31], v[240:247], v3
  ds_write_b32 v108, v54
  v_permlane32_swap_b32 v56, v58
  v_smfmac_f32_16x16x64_bf16 v[60:63], v[32:35], v[248:255], v3
  v_permlane32_swap_b32 v57, v59
  v_add_f32 v56, v56, v58
  v_add_f32 v57, v57, v59
  v_cvt_pk_bf16_f32 v58, v56, v57
  ds_write_b32 v109, v58
  s_nop 2
  v_permlane32_swap_b32 v60, v62
  v_permlane32_swap_b32 v61, v63
  v_add_f32 v60, v60, v62
  v_add_f32 v61, v61, v63
  v_cvt_pk_bf16_f32 v62, v60, v61
  ds_write_b32 v110, v62
cB_va3_t2d:
  v_mov_b32 v117, s18
  s_cmp_eq_u32 s27, s28
  s_cbranch_scc1 cB_va3_vok
cB_va3_vow:
  s_waitcnt vmcnt(0)
  v_cmp_ne_u32 vcc, 56, v101
  s_cbranch_vccnz cB_va3_vor
  s_mov_b32 s28, s27
cB_va3_vok:
  s_waitcnt lgkmcnt(0)
  s_setprio 3
  s_barrier
  v_mov_b32 v36, 0
  v_mov_b32 v37, 0
  buffer_store_dword v117, v118, s[8:11], 0 offen sc1
  s_setprio 0
  s_cmp_eq_u32 s19, 63
  s_cbranch_scc1 cB_done
  v_mov_b32 v38, 0
  v_mov_b32 v39, 0
  v_mov_b32 v40, 0
  v_mov_b32 v41, 0
  v_mov_b32 v42, 0
  v_mov_b32 v43, 0
  v_mov_b32 v44, 0
  v_mov_b32 v45, 0
  v_mov_b32 v46, 0
  v_mov_b32 v47, 0
  v_mov_b32 v48, 0
  v_mov_b32 v49, 0
  v_mov_b32 v50, 0
  v_mov_b32 v51, 0
  v_mov_b32 v52, 0
  v_mov_b32 v53, 0
  v_mov_b32 v54, 0
  v_mov_b32 v55, 0
  v_mov_b32 v56, 0
  v_mov_b32 v57, 0
  v_mov_b32 v58, 0
  v_mov_b32 v59, 0
  v_mov_b32 v60, 0
  v_mov_b32 v61, 0
  v_mov_b32 v62, 0
  v_mov_b32 v63, 0
  s_mov_b32 s19, s18
  s_add_u32 s18, s18, 1
  s_mov_b32 s22, s20
  s_mov_b32 s20, s21
  s_mov_b32 s21, s22
  s_add_u32 s23, s20, 4096
  s_branch cB_va3_loop
cB_va3_slow:
  s_waitcnt lgkmcnt(0)
cB_va3_sl1:
  s_add_u32 s31, s31, 0x1000000
  buffer_load_dwordx4 v[8:11], v2, s[8:11], s20 offen offset:0 sc1
  buffer_load_dwordx4 v[12:15], v2, s[8:11], s20 offen offset:1024 sc1
  buffer_load_dwordx4 v[16:19], v2, s[8:11], s20 offen offset:2048 sc1
  buffer_load_dwordx4 v[20:23], v2, s[8:11], s20 offen offset:3072 sc1
  buffer_load_dwordx4 v[24:27], v2, s[8:11], s23 offen offset:0 sc1
  buffer_load_dwordx4 v[28:31], v2, s[8:11], s23 offen offset:1024 sc1
  buffer_load_dwordx4 v[32:35], v2, s[8:11], s23 offen offset:2048 sc1
  s_waitcnt vmcnt(0)
  v_max3_u32 v36, v8, v9, v10
  v_max3_u32 v36, v36, v11, v12
  v_max3_u32 v36, v36, v13, v14
  v_max3_u32 v36, v36, v15, v16
  v_max3_u32 v36, v36, v17, v18
  v_max3_u32 v36, v36, v19, v20
  v_max3_u32 v36, v36, v21, v22
  v_max3_u32 v36, v36, v23, v24
  v_max3_u32 v36, v36, v25, v26
  v_max3_u32 v36, v36, v27, v28
  v_max3_u32 v36, v36, v29, v30
  v_max3_u32 v36, v36, v31, v32
  v_max3_u32 v36, v36, v33, v34
  v_max_u32 v36, v36, v35
  v_cmp_eq_u32 vcc, -1, v36
  s_cbranch_vccz cB_va3_sl2
  s_add_u32 s30, s30, 1
  s_cmp_lt_u32 s30, 400000
  s_cbranch_scc1 cB_va3_sl1
  s_branch cB_abort
cB_va3_sl2:
  v_mov_b32 v36, 0
  v_mov_b32 v37, 0
  v_mov_b32 v38, 0
  v_mov_b32 v39, 0
  v_mov_b32 v40, 0
  v_mov_b32 v41, 0
  v_mov_b32 v42, 0
  v_mov_b32 v43, 0
  v_mov_b32 v44, 0
  v_mov_b32 v45, 0
  v_mov_b32 v46, 0
  v_mov_b32 v47, 0
  v_mov_b32 v48, 0
  v_mov_b32 v49, 0
  v_mov_b32 v50, 0
  v_mov_b32 v51, 0
  v_mov_b32 v52, 0
  v_mov_b32 v53, 0
  v_mov_b32 v54, 0
  v_mov_b32 v55, 0
  v_mov_b32 v56, 0
  v_mov_b32 v57, 0
  v_mov_b32 v58, 0
  v_mov_b32 v59, 0
  v_mov_b32 v60, 0
  v_mov_b32 v61, 0
  v_mov_b32 v62, 0
  v_mov_b32 v63, 0
  v_smfmac_f32_16x16x64_bf16 v[36:39], v[8:11], a[0:7], v3
  v_smfmac_f32_16x16x64_bf16 v[40:43], v[8:11], a[56:63], v3
  v_smfmac_f32_16x16x64_bf16 v[44:47], v[8:11], a[112:119], v3
  v_smfmac_f32_16x16x64_bf16 v[48:51], v[8:11], a[168:175], v3
  v_smfmac_f32_16x16x64_bf16 v[52:55], v[8:11], a[224:231], v3
  v_smfmac_f32_16x16x64_bf16 v[56:59], v[8:11], v[144:151], v3
  v_smfmac_f32_16x16x64_bf16 v[60:63], v[8:11], v[200:207], v3
  v_smfmac_f32_16x16x64_bf16 v[36:39], v[12:15], a[8:15], v3
  v_smfmac_f32_16x16x64_bf16 v[40:43], v[12:15], a[64:71], v3
  v_smfmac_f32_16x16x64_bf16 v[44:47], v[12:15], a[120:127], v3
  v_smfmac_f32_16x16x64_bf16 v[48:51], v[12:15], a[176:183], v3
  v_smfmac_f32_16x16x64_bf16 v[52:55], v[12:15], a[232:239], v3
  v_smfmac_f32_16x16x64_bf16 v[56:59], v[12:15], v[152:159], v3
  v_smfmac_f32_16x16x64_bf16 v[60:63], v[12:15], v[208:215], v3
  v_smfmac_f32_16x16x64_bf16 v[36:39], v[16:19], a[16:23], v3
  v_smfmac_f32_16x16x64_bf16 v[40:43], v[16:19], a[72:79], v3
  v_smfmac_f32_16x16x64_bf16 v[44:47], v[16:19], a[128:135], v3
  v_smfmac_f32_16x16x64_bf16 v[48:51], v[16:19], a[184:191], v3
  v_smfmac_f32_16x16x64_bf16 v[52:55], v[16:19], a[240:247], v3
  v_smfmac_f32_16x16x64_bf16 v[56:59], v[16:19], v[160:167], v3
  v_smfmac_f32_16x16x64_bf16 v[60:63], v[16:19], v[216:223], v3
  v_smfmac_f32_16x16x64_bf16 v[36:39], v[20:23], a[24:31], v3
  v_smfmac_f32_16x16x64_bf16 v[40:43], v[20:23], a[80:87], v3
  v_smfmac_f32_16x16x64_bf16 v[44:47], v[20:23], a[136:143], v3
  v_smfmac_f32_16x16x64_bf16 v[48:51], v[20:23], a[192:199], v3
  v_smfmac_f32_16x16x64_bf16 v[52:55], v[20:23], a[248:255], v3
  v_smfmac_f32_16x16x64_bf16 v[56:59], v[20:23], v[168:175], v3
  v_smfmac_f32_16x16x64_bf16 v[60:63], v[20:23], v[224:231], v3
  v_smfmac_f32_16x16x64_bf16 v[36:39], v[24:27], a[32:39], v3
  v_smfmac_f32_16x16x64_bf16 v[40:43], v[24:27], a[88:95], v3
  v_smfmac_f32_16x16x64_bf16 v[44:47], v[24:27], a[144:151], v3
  v_smfmac_f32_16x16x64_bf16 v[48:51], v[24:27], a[200:207], v3
  v_smfmac_f32_16x16x64_bf16 v[52:55], v[24:27], v[120:127], v3
  v_smfmac_f32_16x16x64_bf16 v[56:59], v[24:27], v[176:183], v3
  v_smfmac_f32_16x16x64_bf16 v[60:63], v[24:27], v[232:239], v3
  v_smfmac_f32_16x16x64_bf16 v[36:39], v[28:31], a[40:47], v3
  v_smfmac_f32_16x16x64_bf16 v[40:43], v[28:31], a[96:103], v3
  v_smfmac_f32_16x16x64_bf16 v[44:47], v[28:31], a[152:159], v3
  v_smfmac_f32_16x16x64_bf16 v[48:51], v[28:31], a[208:215], v3
  v_smfmac_f32_16x16x64_bf16 v[52:55], v[28:31], v[128:135], v3
  v_smfmac_f32_16x16x64_bf16 v[56:59], v[28:31], v[184:191], v3
  v_smfmac_f32_16x16x64_bf16 v[60:63], v[28:31], v[240:247], v3
  v_smfmac_f32_16x16x64_bf16 v[36:39], v[32:35], a[48:55], v3
  v_smfmac_f32_16x16x64_bf16 v[40:43], v[32:35], a[104:111], v3
  v_smfmac_f32_16x16x64_bf16 v[44:47], v[32:35], a[160:167], v3
  v_smfmac_f32_16x16x64_bf16 v[48:51], v[32:35], a[216:223], v3
  v_smfmac_f32_16x16x64_bf16 v[52:55], v[32:35], v[136:143], v3
  v_smfmac_f32_16x16x64_bf16 v[56:59], v[32:35], v[192:199], v3
  v_smfmac_f32_16x16x64_bf16 v[60:63], v[32:35], v[248:255], v3
  v_permlane32_swap_b32 v36, v38
  v_permlane32_swap_b32 v37, v39
  v_add_f32 v36, v36, v38
  v_add_f32 v37, v37, v39
  v_cvt_pk_bf16_f32 v38, v36, v37
  ds_write_b32 v104, v38
  v_permlane32_swap_b32 v40, v42
  v_permlane32_swap_b32 v41, v43
  v_add_f32 v40, v40, v42
  v_add_f32 v41, v41, v43
  v_cvt_pk_bf16_f32 v42, v40, v41
  ds_write_b32 v105, v42
  v_permlane32_swap_b32 v44, v46
  v_permlane32_swap_b32 v45, v47
  v_add_f32 v44, v44, v46
  v_add_f32 v45, v45, v47
  v_cvt_pk_bf16_f32 v46, v44, v45
  ds_write_b32 v106, v46
  v_permlane32_swap_b32 v48, v50
  v_permlane32_swap_b32 v49, v51
  v_add_f32 v48, v48, v50
  v_add_f32 v49, v49, v51
  v_cvt_pk_bf16_f32 v50, v48, v49
  ds_write_b32 v107, v50
  v_permlane32_swap_b32 v52, v54
  v_permlane32_swap_b32 v53, v55
  v_add_f32 v52, v52, v54
  v_add_f32 v53, v53, v55
  v_cvt_pk_bf16_f32 v54, v52, v53
  ds_write_b32 v108, v54
  v_permlane32_swap_b32 v56, v58
  v_permlane32_swap_b32 v57, v59
  v_add_f32 v56, v56, v58
  v_add_f32 v57, v57, v59
  v_cvt_pk_bf16_f32 v58, v56, v57
  ds_write_b32 v109, v58
  v_permlane32_swap_b32 v60, v62
  v_permlane32_swap_b32 v61, v63
  v_add_f32 v60, v60, v62
  v_add_f32 v61, v61, v63
  v_cvt_pk_bf16_f32 v62, v60, v61
  ds_write_b32 v110, v62
  s_branch cB_va3_t2d
cB_va3_vor:
  s_sleep 2
  buffer_load_dword v101, off, s[8:11], s27 sc1
  s_add_u32 s30, s30, 1
  s_cmp_lt_u32 s30, 400000
  s_cbranch_scc1 cB_va3_vow
  s_branch cB_abort
cB_abort:
  v_mov_b32 v4, 0xdead
  v_mov_b32 v5, 16
  buffer_store_dword v4, v5, s[12:15], 0 offen
  s_branch ch_end
cB_done:
  s_branch ch_end
ch_worker:
  s_sub_u32 s35, s3, 4
  s_and_b32 s35, s35, 7
  s_lshr_b32 s36, s2, 3
  s_lshl_b32 s33, s35, 5
  s_add_u32 s33, s33, s36
  s_mov_b32 s97, 0
  s_mov_b32 s96, 0
  s_mov_b32 s37, 0
  s_mov_b32 s38, 0
  s_mov_b32 s39, 0xffff0000
  s_mov_b32 s101, -1
  v_and_b32 v1, 63, v0
  v_lshlrev_b32 v2, 4, v1
  v_lshrrev_b32 v3, 4, v1
  v_and_b32 v4, 15, v1
  s_cmp_ge_u32 s33, 224
  s_cbranch_scc1 wp_all
  s_mov_b32 s68, s44
  s_and_b32 s69, s45, 0xffff
  s_mov_b32 s70, 3670016
  s_mov_b32 s71, 0x20000
  s_and_b32 s20, s33, 0xe0
  s_mul_i32 s20, s20, 9363
  s_lshr_b32 s20, s20, 16
  s_lshl_b32 s20, s20, 10
  s_and_b32 s21, s33, 31
  s_mul_i32 s21, s21, 192
  s_add_u32 s20, s20, s21
  v_min_u32 v7, 191, v0
  v_add_u32 v7, s20, v7
  v_lshrrev_b32 v8, 11, v7
  v_min_u32 v8, 15, v8
  v_bfe_u32 v9, v7, 2, 9
  v_lshlrev_b32 v9, 13, v9
  v_lshl_add_u32 v9, v8, 9, v9
  v_and_b32 v7, 3, v7
  v_lshl_add_u32 v9, v7, 7, v9
  buffer_load_dword v253, v9, s[68:71], 0 offen
  s_mov_b32 s68, s40
  s_and_b32 s69, s41, 0xffff
  s_mov_b32 s70, 3670016
  s_mov_b32 s71, 0x20000
  s_and_b32 s20, s33, 0xe0
  s_mul_i32 s20, s20, 9363
  s_lshr_b32 s20, s20, 16
  s_lshl_b32 s20, s20, 10
  s_and_b32 s21, s33, 31
  s_mul_i32 s21, s21, 192
  s_add_u32 s20, s20, s21
  v_min_u32 v7, 191, v0
  v_add_u32 v7, s20, v7
  v_lshrrev_b32 v8, 11, v7
  v_min_u32 v8, 15, v8
  v_bfe_u32 v9, v7, 2, 9
  v_lshlrev_b32 v9, 13, v9
  v_lshl_add_u32 v9, v8, 9, v9
  v_and_b32 v7, 3, v7
  v_lshl_add_u32 v9, v7, 7, v9
  buffer_load_dword v253, v9, s[68:71], 0 offen
  v_lshrrev_b32 v5, 5, v1
  v_and_b32 v6, 31, v1
  v_xor_b32 v8, v6, v5
  v_lshlrev_b32 v8, 4, v8
  v_lshl_add_u32 v16, v5, 13, v8
  v_xor_b32 v17, 32, v16
  v_xor_b32 v18, 64, v16
  v_xor_b32 v19, 96, v16
  v_xor_b32 v20, 128, v16
  v_xor_b32 v21, 160, v16
  v_xor_b32 v22, 192, v16
  v_xor_b32 v23, 224, v16
  s_lshl_b32 s20, s16, 6
  v_xor_b32 v26, s20, v16
  v_xor_b32 v27, 32, v26
wp_B:
  s_mul_i32 s17, s33, 4682
  s_lshr_b32 s17, s17, 16
  s_mul_i32 s23, s17, 14
  s_sub_u32 s19, s33, s23
  s_cmp_lt_u32 s19, 7
  s_cselect_b32 s18, 0, 7
  s_cselect_b32 s28, 0, 8
  s_sub_u32 s18, s19, s18
  s_add_u32 s28, s28, s16
  s_lshl_b32 s25, s16, 15
  s_add_u32 s25, s25, 32768
  s_lshl_b32 s26, s17, 9
  s_lshl_b32 s20, s33, 2
  s_add_u32 s20, s20, s16
  s_mul_i32 s21, s20, 9363
  s_lshr_b32 s21, s21, 16
  s_mul_i32 s22, s21, 7
  s_sub_u32 s22, s20, s22
  s_mul_i32 s21, s21, 14336
  s_lshl_b32 s20, s22, 7
  s_add_u32 s20, s20, s21
  s_lshl_b32 s22, s22, 11
  s_add_u32 s52, s21, s22
  s_mov_b32 s68, s48
  s_and_b32 s69, s49, 0xffff
  s_mov_b32 s70, 1835008
  s_mov_b32 s71, 0x20000
  v_mul_u32_u24 v7, 896, v4
  v_lshl_add_u32 v7, v3, 5, v7
  buffer_load_dwordx4 v[128:131], v7, s[68:71], s20 offen
  buffer_load_dwordx4 v[132:135], v7, s[68:71], s20 offen offset:16
  s_mov_b32 s60, s44
  s_and_b32 s61, s45, 0xffff
  s_mov_b32 s62, 3670016
  s_mov_b32 s63, 0x20000
  s_mov_b32 s56, s46
  s_and_b32 s57, s47, 0xffff
  s_mov_b32 s58, 3670016
  s_mov_b32 s59, 0x20000
  s_mul_i32 s27, s17, 229376
  s_lshl_b32 s30, s18, 7
  s_add_u32 s27, s27, s30
  s_mul_i32 s30, s16, 57344
  s_add_u32 s27, s27, s30
  v_lshrrev_b32 v7, 3, v1
  v_and_b32 v8, 7, v1
  v_and_b32 v9, 2, v7
  v_xor_b32 v8, v8, v9
  v_mul_u32_u24 v7, 896, v7
  v_lshl_add_u32 v24, v8, 4, v7
  v_xor_b32 v25, 64, v24
  s_lshl_b32 s30, s16, 13
  s_add_u32 m0, s30, 0
  s_nop 0
  buffer_load_dwordx4 v24, s[56:59], s27 offen  lds
  s_add_u32 s27, s27, 7168
  s_add_u32 m0, s30, 1024
  s_nop 0
  buffer_load_dwordx4 v25, s[56:59], s27 offen  lds
  s_add_u32 s27, s27, 7168
  s_add_u32 m0, s30, 2048
  s_nop 0
  buffer_load_dwordx4 v24, s[56:59], s27 offen  lds
  s_add_u32 s27, s27, 7168
  s_add_u32 m0, s30, 3072
  s_nop 0
  buffer_load_dwordx4 v25, s[56:59], s27 offen  lds
  s_add_u32 s27, s27, 7168
  s_add_u32 m0, s30, 4096
  s_nop 0
  buffer_load_dwordx4 v24, s[56:59], s27 offen  lds
  s_add_u32 s27, s27, 7168
  s_add_u32 m0, s30, 5120
  s_nop 0
  buffer_load_dwordx4 v25, s[56:59], s27 offen  lds
  s_add_u32 s27, s27, 7168
  s_add_u32 m0, s30, 6144
  s_nop 0
  buffer_load_dwordx4 v24, s[56:59], s27 offen  lds
  s_add_u32 s27, s27, 7168
  s_add_u32 m0, s30, 7168
  s_nop 0
  buffer_load_dwordx4 v25, s[56:59], s27 offen  lds
  s_add_u32 s27, s27, 7168
  s_add_u32 s27, s28, 0
  s_min_u32 s27, s27, 13
  s_lshl_b32 s27, s27, 18
  s_add_u32 s27, s27, s26
  s_mov_b32 s55, s27
  v_lshrrev_b32 v7, 2, v4
  v_lshlrev_b32 v11, 4, v7
  v_lshlrev_b32 v7, 3, v7
  v_and_b32 v8, 3, v4
  v_add_u32 v7, v7, v8
  v_and_b32 v8, 2, v4
  v_lshl_add_u32 v11, v8, 1, v11
  v_and_b32 v8, 1, v4
  v_add_u32 v11, v11, v8
  v_or_b32 v10, 0, v3
  v_xor_b32 v10, v10, v4
  v_lshlrev_b32 v10, 4, v10
  v_lshl_add_u32 v44, v11, 9, v10
  v_lshl_add_u32 v10, v7, 9, v10
  v_add_u32 v32, s25, v10
  v_or_b32 v10, 4, v3
  v_xor_b32 v10, v10, v4
  v_lshlrev_b32 v10, 4, v10
  v_lshl_add_u32 v45, v11, 9, v10
  v_lshl_add_u32 v10, v7, 9, v10
  v_add_u32 v33, s25, v10
  v_or_b32 v10, 8, v3
  v_xor_b32 v10, v10, v4
  v_lshlrev_b32 v10, 4, v10
  v_lshl_add_u32 v46, v11, 9, v10
  v_lshl_add_u32 v10, v7, 9, v10
  v_add_u32 v34, s25, v10
  v_or_b32 v10, 12, v3
  v_xor_b32 v10, v10, v4
  v_lshlrev_b32 v10, 4, v10
  v_lshl_add_u32 v47, v11, 9, v10
  v_lshl_add_u32 v10, v7, 9, v10
  v_add_u32 v35, s25, v10
  s_mul_i32 s30, s17, 401408
  s_mul_i32 s31, s18, 57344
  s_add_u32 s30, s30, s31
  s_add_u32 s30, s30, 33554432
  v_add_u32 v28, s30, v2
  s_add_u32 s30, s30, 14336
  v_add_u32 v29, s30, v2
  s_add_u32 s30, s30, 14336
  v_add_u32 v30, s30, v2
  s_add_u32 s30, s30, 14336
  v_add_u32 v31, s30, v2
  s_add_u32 s30, s30, 14336
  v_mov_b32 v48, 1035512379
  v_lshrrev_b32 v7, 2, v4
  v_lshl_add_u32 v7, v3, 3, v7
  v_lshlrev_b32 v7, 7, v7
  v_and_b32 v8, 3, v4
  v_lshl_add_u32 v7, v8, 3, v7
  v_lshrrev_b32 v8, 3, v4
  v_and_b32 v9, 1, v3
  v_lshl_add_u32 v8, v9, 1, v8
  v_lshl_add_u32 v40, v8, 5, v7
  s_mul_i32 s31, s17, 28
  s_mov_b32 s29, 401408
  s_lshl_b32 s30, s18, 6
  s_add_u32 s30, s30, 0
  v_add_u32 v8, s30, v4
  v_subrev_u32 v9, 256, v8
  v_mul_u32_u24 v11, 171, v9
  v_lshrrev_b32 v11, 11, v11
  v_mul_u32_u24 v38, 12, v11
  v_sub_u32 v38, v9, v38
  v_add_u32 v38, 16, v38
  v_lshrrev_b32 v10, 4, v8
  v_cmp_gt_i32 vcc, 0, v9
  s_nop 1
  v_cndmask_b32 v10, v11, v10, vcc
  v_cndmask_b32 v39, v38, v4, vcc
  v_add_u32 v39, s31, v39
  v_lshrrev_b32 v38, 4, v39
  v_and_b32 v39, 15, v39
  v_mul_lo_u32 v10, v10, s29
  v_mul_u32_u24 v38, 14336, v38
  v_add_u32 v10, v10, v38
  v_lshl_add_u32 v10, v3, 8, v10
  v_lshl_add_u32 v10, v39, 4, v10
  v_add_u32 v12, 39976960, v10
  v_xor_b32 v41, 32, v40
  s_lshl_b32 s30, s18, 6
  s_add_u32 s30, s30, 16
  v_add_u32 v8, s30, v4
  v_subrev_u32 v9, 256, v8
  v_mul_u32_u24 v11, 171, v9
  v_lshrrev_b32 v11, 11, v11
  v_mul_u32_u24 v38, 12, v11
  v_sub_u32 v38, v9, v38
  v_add_u32 v38, 16, v38
  v_lshrrev_b32 v10, 4, v8
  v_cmp_gt_i32 vcc, 0, v9
  s_nop 1
  v_cndmask_b32 v10, v11, v10, vcc
  v_cndmask_b32 v39, v38, v4, vcc
  v_add_u32 v39, s31, v39
  v_lshrrev_b32 v38, 4, v39
  v_and_b32 v39, 15, v39
  v_mul_lo_u32 v10, v10, s29
  v_mul_u32_u24 v38, 14336, v38
  v_add_u32 v10, v10, v38
  v_lshl_add_u32 v10, v3, 8, v10
  v_lshl_add_u32 v10, v39, 4, v10
  v_add_u32 v13, 39976960, v10
  v_xor_b32 v42, 64, v40
  s_lshl_b32 s30, s18, 6
  s_add_u32 s30, s30, 32
  v_add_u32 v8, s30, v4
  v_subrev_u32 v9, 256, v8
  v_mul_u32_u24 v11, 171, v9
  v_lshrrev_b32 v11, 11, v11
  v_mul_u32_u24 v38, 12, v11
  v_sub_u32 v38, v9, v38
  v_add_u32 v38, 16, v38
  v_lshrrev_b32 v10, 4, v8
  v_cmp_gt_i32 vcc, 0, v9
  s_nop 1
  v_cndmask_b32 v10, v11, v10, vcc
  v_cndmask_b32 v39, v38, v4, vcc
  v_add_u32 v39, s31, v39
  v_lshrrev_b32 v38, 4, v39
  v_and_b32 v39, 15, v39
  v_mul_lo_u32 v10, v10, s29
  v_mul_u32_u24 v38, 14336, v38
  v_add_u32 v10, v10, v38
  v_lshl_add_u32 v10, v3, 8, v10
  v_lshl_add_u32 v10, v39, 4, v10
  v_add_u32 v14, 39976960, v10
  v_xor_b32 v43, 96, v40
  s_lshl_b32 s30, s18, 6
  s_add_u32 s30, s30, 48
  v_add_u32 v8, s30, v4
  v_subrev_u32 v9, 256, v8
  v_mul_u32_u24 v11, 171, v9
  v_lshrrev_b32 v11, 11, v11
  v_mul_u32_u24 v38, 12, v11
  v_sub_u32 v38, v9, v38
  v_add_u32 v38, 16, v38
  v_lshrrev_b32 v10, 4, v8
  v_cmp_gt_i32 vcc, 0, v9
  s_nop 1
  v_cndmask_b32 v10, v11, v10, vcc
  v_cndmask_b32 v39, v38, v4, vcc
  v_add_u32 v39, s31, v39
  v_lshrrev_b32 v38, 4, v39
  v_and_b32 v39, 15, v39
  v_mul_lo_u32 v10, v10, s29
  v_mul_u32_u24 v38, 14336, v38
  v_add_u32 v10, v10, v38
  v_lshl_add_u32 v10, v3, 8, v10
  v_lshl_add_u32 v10, v39, 4, v10
  v_add_u32 v15, 39976960, v10
  s_mov_b32 s27, s55
  s_add_u32 m0, s25, 0
  s_nop 0
  buffer_load_dwordx4 v16, s[60:63], s27 offen  lds
  s_add_u32 s27, s27, 16384
  s_add_u32 m0, s25, 1024
  s_nop 0
  buffer_load_dwordx4 v17, s[60:63], s27 offen  lds
  s_add_u32 s27, s27, 16384
  s_add_u32 m0, s25, 2048
  s_nop 0
  buffer_load_dwordx4 v16, s[60:63], s27 offen  lds
  s_add_u32 s27, s27, 16384
  s_add_u32 m0, s25, 3072
  s_nop 0
  buffer_load_dwordx4 v17, s[60:63], s27 offen  lds
  s_add_u32 s27, s27, 16384
  s_add_u32 m0, s25, 4096
  s_nop 0
  buffer_load_dwordx4 v18, s[60:63], s27 offen  lds
  s_add_u32 s27, s27, 16384
  s_add_u32 m0, s25, 5120
  s_nop 0
  buffer_load_dwordx4 v19, s[60:63], s27 offen  lds
  s_add_u32 s27, s27, 16384
  s_add_u32 m0, s25, 6144
  s_nop 0
  buffer_load_dwordx4 v18, s[60:63], s27 offen  lds
  s_add_u32 s27, s27, 16384
  s_add_u32 m0, s25, 7168
  s_nop 0
  buffer_load_dwordx4 v19, s[60:63], s27 offen  lds
  s_add_u32 s27, s27, 16384
  s_add_u32 m0, s25, 8192
  s_nop 0
  buffer_load_dwordx4 v20, s[60:63], s27 offen  lds
  s_add_u32 s27, s27, 16384
  s_add_u32 m0, s25, 9216
  s_nop 0
  buffer_load_dwordx4 v21, s[60:63], s27 offen  lds
  s_add_u32 s27, s27, 16384
  s_add_u32 m0, s25, 10240
  s_nop 0
  buffer_load_dwordx4 v20, s[60:63], s27 offen  lds
  s_add_u32 s27, s27, 16384
  s_add_u32 m0, s25, 11264
  s_nop 0
  buffer_load_dwordx4 v21, s[60:63], s27 offen  lds
  s_add_u32 s27, s27, 16384
  s_add_u32 m0, s25, 12288
  s_nop 0
  buffer_load_dwordx4 v22, s[60:63], s27 offen  lds
  s_add_u32 s27, s27, 16384
  s_add_u32 m0, s25, 13312
  s_nop 0
  buffer_load_dwordx4 v23, s[60:63], s27 offen  lds
  s_add_u32 s27, s27, 16384
  s_add_u32 m0, s25, 14336
  s_nop 0
  buffer_load_dwordx4 v22, s[60:63], s27 offen  lds
  s_add_u32 s27, s27, 16384
  s_add_u32 m0, s25, 15360
  s_nop 0
  buffer_load_dwordx4 v23, s[60:63], s27 offen  lds
  s_add_u32 s27, s27, 16384
  s_add_u32 s27, s28, 4
  s_min_u32 s27, s27, 13
  s_lshl_b32 s27, s27, 18
  s_add_u32 s27, s27, s26
  s_add_u32 m0, s25, 16384
  s_nop 0
  buffer_load_dwordx4 v16, s[60:63], s27 offen  lds
  s_add_u32 s27, s27, 16384
  s_add_u32 m0, s25, 17408
  s_nop 0
  buffer_load_dwordx4 v17, s[60:63], s27 offen  lds
  s_add_u32 s27, s27, 16384
  s_add_u32 m0, s25, 18432
  s_nop 0
  buffer_load_dwordx4 v16, s[60:63], s27 offen  lds
  s_add_u32 s27, s27, 16384
  s_add_u32 m0, s25, 19456
  s_nop 0
  buffer_load_dwordx4 v17, s[60:63], s27 offen  lds
  s_add_u32 s27, s27, 16384
  s_add_u32 m0, s25, 20480
  s_nop 0
  buffer_load_dwordx4 v18, s[60:63], s27 offen  lds
  s_add_u32 s27, s27, 16384
  s_add_u32 m0, s25, 21504
  s_nop 0
  buffer_load_dwordx4 v19, s[60:63], s27 offen  lds
  s_add_u32 s27, s27, 16384
  s_add_u32 m0, s25, 22528
  s_nop 0
  buffer_load_dwordx4 v18, s[60:63], s27 offen  lds
  s_add_u32 s27, s27, 16384
  s_add_u32 m0, s25, 23552
  s_nop 0
  buffer_load_dwordx4 v19, s[60:63], s27 offen  lds
  s_add_u32 s27, s27, 16384
  s_add_u32 m0, s25, 24576
  s_nop 0
  buffer_load_dwordx4 v20, s[60:63], s27 offen  lds
  s_add_u32 s27, s27, 16384
  s_add_u32 m0, s25, 25600
  s_nop 0
  buffer_load_dwordx4 v21, s[60:63], s27 offen  lds
  s_add_u32 s27, s27, 16384
  s_add_u32 m0, s25, 26624
  s_nop 0
  buffer_load_dwordx4 v20, s[60:63], s27 offen  lds
  s_add_u32 s27, s27, 16384
  s_add_u32 m0, s25, 27648
  s_nop 0
  buffer_load_dwordx4 v21, s[60:63], s27 offen  lds
  s_add_u32 s27, s27, 16384
  s_add_u32 m0, s25, 28672
  s_nop 0
  buffer_load_dwordx4 v22, s[60:63], s27 offen  lds
  s_add_u32 s27, s27, 16384
  s_add_u32 m0, s25, 29696
  s_nop 0
  buffer_load_dwordx4 v23, s[60:63], s27 offen  lds
  s_add_u32 s27, s27, 16384
  s_add_u32 m0, s25, 30720
  s_nop 0
  buffer_load_dwordx4 v22, s[60:63], s27 offen  lds
  s_add_u32 s27, s27, 16384
  s_add_u32 m0, s25, 31744
  s_nop 0
  buffer_load_dwordx4 v23, s[60:63], s27 offen  lds
  s_add_u32 s27, s27, 16384
  s_cmp_lt_u32 s18, 4
  s_cselect_b32 s34, 1, s97
  s_mov_b32 s68, s42
  s_and_b32 s69, s43, 0xffff
  s_mov_b32 s70, 3670016
  s_mov_b32 s71, 0x20000
  s_lshl_b32 s27, s18, 19
  s_add_u32 s27, s27, s26
  s_cmp_lg_u32 s34, 0
  s_cselect_b32 s27, 0x40000000, s27
  v_lshrrev_b32 v7, 2, v0
  v_and_b32 v8, 3, v0
  v_lshlrev_b32 v8, 7, v8
  v_lshl_add_u32 v9, v7, 13, v8
  buffer_load_dword v253, v9, s[68:71], s27 offen
  s_lshl_b32 s29, s28, 10
  s_add_u32 s31, s29, 4096
  s_cmp_lt_u32 s28, 10
  s_cselect_b32 s31, s31, 0x40000000
  s_waitcnt vmcnt(1)
  s_barrier
  ds_read_b64_tr_b16 a[0:1], v40 offset:0
  ds_read_b64_tr_b16 a[2:3], v40 offset:512
  ds_read_b64_tr_b16 a[32:33], v41 offset:0
  ds_read_b64_tr_b16 a[34:35], v41 offset:512
  ds_read_b64_tr_b16 a[64:65], v42 offset:0
  ds_read_b64_tr_b16 a[66:67], v42 offset:512
  ds_read_b64_tr_b16 a[96:97], v43 offset:0
  ds_read_b64_tr_b16 a[98:99], v43 offset:512
  ds_read_b128 a[128:131], v32 offset:0
  ds_read_b128 a[160:163], v32 offset:2048
  ds_read_b128 a[192:195], v32 offset:16384
  ds_read_b128 a[224:227], v32 offset:18432
  v_lshlrev_b32 v144, 9, v3
  v_lshl_add_u32 v144, v4, 4, v144
  s_add_u32 s53, s52, 75759616
  s_add_u32 s52, s52, 655360
  v_mov_b32 v136, v128
  v_mov_b32 v140, v129
  v_mov_b32 v137, v130
  v_mov_b32 v141, v131
  v_mov_b32 v138, v132
  v_mov_b32 v142, v133
  v_mov_b32 v139, v134
  v_mov_b32 v143, v135
  buffer_store_dwordx4 v[128:131], v144, s[8:11], s52 offen sc1
  buffer_store_dwordx4 v[132:135], v144, s[8:11], s52 offen offset:256 sc1
  buffer_store_dwordx4 v[136:139], v2, s[8:11], s53 offen sc1
  buffer_store_dwordx4 v[140:143], v2, s[8:11], s53 offen offset:1024 sc1
  s_waitcnt lgkmcnt(0)
  v_mfma_f32_16x16x32_bf16 v[64:67], a[128:131], a[0:3], 0
  ds_read_b64_tr_b16 a[4:5], v40 offset:4096
  ds_read_b64_tr_b16 a[6:7], v40 offset:4608
  v_mfma_f32_16x16x32_bf16 v[68:71], a[160:163], a[0:3], 0
  ds_read_b64_tr_b16 a[36:37], v41 offset:4096
  ds_read_b64_tr_b16 a[38:39], v41 offset:4608
  v_mfma_f32_16x16x32_bf16 v[72:75], a[128:131], a[32:35], 0
  ds_read_b64_tr_b16 a[68:69], v42 offset:4096
  ds_read_b64_tr_b16 a[70:71], v42 offset:4608
  v_mfma_f32_16x16x32_bf16 v[76:79], a[160:163], a[32:35], 0
  ds_read_b64_tr_b16 a[100:101], v43 offset:4096
  ds_read_b64_tr_b16 a[102:103], v43 offset:4608
  v_mfma_f32_16x16x32_bf16 v[80:83], a[128:131], a[64:67], 0
  ds_read_b128 a[132:135], v33 offset:0
  ds_read_b128 a[164:167], v33 offset:2048
  v_mfma_f32_16x16x32_bf16 v[84:87], a[160:163], a[64:67], 0
  ds_read_b128 a[196:199], v33 offset:16384
  ds_read_b128 a[228:231], v33 offset:18432
  v_mfma_f32_16x16x32_bf16 v[88:91], a[128:131], a[96:99], 0
  v_mfma_f32_16x16x32_bf16 v[92:95], a[160:163], a[96:99], 0
  v_mfma_f32_16x16x32_bf16 v[96:99], a[192:195], a[0:3], 0
  v_mfma_f32_16x16x32_bf16 v[100:103], a[224:227], a[0:3], 0
  v_mfma_f32_16x16x32_bf16 v[104:107], a[192:195], a[32:35], 0
  v_mfma_f32_16x16x32_bf16 v[108:111], a[224:227], a[32:35], 0
  v_mfma_f32_16x16x32_bf16 v[112:115], a[192:195], a[64:67], 0
  v_mfma_f32_16x16x32_bf16 v[116:119], a[224:227], a[64:67], 0
  v_mfma_f32_16x16x32_bf16 v[120:123], a[192:195], a[96:99], 0
  v_mfma_f32_16x16x32_bf16 v[124:127], a[224:227], a[96:99], 0
  s_waitcnt lgkmcnt(0)
  v_mfma_f32_16x16x32_bf16 v[64:67], a[132:135], a[4:7], v[64:67]
  ds_read_b64_tr_b16 a[8:9], v40 offset:8192
  ds_read_b64_tr_b16 a[10:11], v40 offset:8704
  v_mfma_f32_16x16x32_bf16 v[68:71], a[164:167], a[4:7], v[68:71]
  ds_read_b64_tr_b16 a[40:41], v41 offset:8192
  ds_read_b64_tr_b16 a[42:43], v41 offset:8704
  v_mfma_f32_16x16x32_bf16 v[72:75], a[132:135], a[36:39], v[72:75]
  ds_read_b64_tr_b16 a[72:73], v42 offset:8192
  ds_read_b64_tr_b16 a[74:75], v42 offset:8704
  v_mfma_f32_16x16x32_bf16 v[76:79], a[164:167], a[36:39], v[76:79]
  ds_read_b64_tr_b16 a[104:105], v43 offset:8192
  ds_read_b64_tr_b16 a[106:107], v43 offset:8704
  v_mfma_f32_16x16x32_bf16 v[80:83], a[132:135], a[68:71], v[80:83]
  ds_read_b128 a[136:139], v34 offset:0
  ds_read_b128 a[168:171], v34 offset:2048
  v_mfma_f32_16x16x32_bf16 v[84:87], a[164:167], a[68:71], v[84:87]
  ds_read_b128 a[200:203], v34 offset:16384
  ds_read_b128 a[232:235], v34 offset:18432
  v_mfma_f32_16x16x32_bf16 v[88:91], a[132:135], a[100:103], v[88:91]
  v_mfma_f32_16x16x32_bf16 v[92:95], a[164:167], a[100:103], v[92:95]
  v_mfma_f32_16x16x32_bf16 v[96:99], a[196:199], a[4:7], v[96:99]
  v_mfma_f32_16x16x32_bf16 v[100:103], a[228:231], a[4:7], v[100:103]
  v_mfma_f32_16x16x32_bf16 v[104:107], a[196:199], a[36:39], v[104:107]
  v_mfma_f32_16x16x32_bf16 v[108:111], a[228:231], a[36:39], v[108:111]
  v_mfma_f32_16x16x32_bf16 v[112:115], a[196:199], a[68:71], v[112:115]
  v_mfma_f32_16x16x32_bf16 v[116:119], a[228:231], a[68:71], v[116:119]
  v_mfma_f32_16x16x32_bf16 v[120:123], a[196:199], a[100:103], v[120:123]
  v_mfma_f32_16x16x32_bf16 v[124:127], a[228:231], a[100:103], v[124:127]
  s_waitcnt lgkmcnt(0)
  v_mfma_f32_16x16x32_bf16 v[64:67], a[136:139], a[8:11], v[64:67]
  ds_read_b64_tr_b16 a[12:13], v40 offset:12288
  ds_read_b64_tr_b16 a[14:15], v40 offset:12800
  v_mfma_f32_16x16x32_bf16 v[68:71], a[168:171], a[8:11], v[68:71]
  ds_read_b64_tr_b16 a[44:45], v41 offset:12288
  ds_read_b64_tr_b16 a[46:47], v41 offset:12800
  v_mfma_f32_16x16x32_bf16 v[72:75], a[136:139], a[40:43], v[72:75]
  ds_read_b64_tr_b16 a[76:77], v42 offset:12288
  ds_read_b64_tr_b16 a[78:79], v42 offset:12800
  v_mfma_f32_16x16x32_bf16 v[76:79], a[168:171], a[40:43], v[76:79]
  ds_read_b64_tr_b16 a[108:109], v43 offset:12288
  ds_read_b64_tr_b16 a[110:111], v43 offset:12800
  v_mfma_f32_16x16x32_bf16 v[80:83], a[136:139], a[72:75], v[80:83]
  ds_read_b128 a[140:143], v35 offset:0
  ds_read_b128 a[172:175], v35 offset:2048
  v_mfma_f32_16x16x32_bf16 v[84:87], a[168:171], a[72:75], v[84:87]
  ds_read_b128 a[204:207], v35 offset:16384
  ds_read_b128 a[236:239], v35 offset:18432
  v_mfma_f32_16x16x32_bf16 v[88:91], a[136:139], a[104:107], v[88:91]
  v_mfma_f32_16x16x32_bf16 v[92:95], a[168:171], a[104:107], v[92:95]
  v_mfma_f32_16x16x32_bf16 v[96:99], a[200:203], a[8:11], v[96:99]
  v_mfma_f32_16x16x32_bf16 v[100:103], a[232:235], a[8:11], v[100:103]
  v_mfma_f32_16x16x32_bf16 v[104:107], a[200:203], a[40:43], v[104:107]
  v_mfma_f32_16x16x32_bf16 v[108:111], a[232:235], a[40:43], v[108:111]
  v_mfma_f32_16x16x32_bf16 v[112:115], a[200:203], a[72:75], v[112:115]
  v_mfma_f32_16x16x32_bf16 v[116:119], a[232:235], a[72:75], v[116:119]
  v_mfma_f32_16x16x32_bf16 v[120:123], a[200:203], a[104:107], v[120:123]
  v_mfma_f32_16x16x32_bf16 v[124:127], a[232:235], a[104:107], v[124:127]
  s_waitcnt lgkmcnt(0)
  v_mfma_f32_16x16x32_bf16 v[64:67], a[140:143], a[12:15], v[64:67]
  ds_read_b64_tr_b16 a[16:17], v40 offset:16384
  ds_read_b64_tr_b16 a[18:19], v40 offset:16896
  v_mfma_f32_16x16x32_bf16 v[68:71], a[172:175], a[12:15], v[68:71]
  ds_read_b64_tr_b16 a[48:49], v41 offset:16384
  ds_read_b64_tr_b16 a[50:51], v41 offset:16896
  v_mfma_f32_16x16x32_bf16 v[72:75], a[140:143], a[44:47], v[72:75]
  ds_read_b64_tr_b16 a[80:81], v42 offset:16384
  ds_read_b64_tr_b16 a[82:83], v42 offset:16896
  v_mfma_f32_16x16x32_bf16 v[76:79], a[172:175], a[44:47], v[76:79]
  ds_read_b64_tr_b16 a[112:113], v43 offset:16384
  ds_read_b64_tr_b16 a[114:115], v43 offset:16896
  v_mfma_f32_16x16x32_bf16 v[80:83], a[140:143], a[76:79], v[80:83]
  ds_read_b128 a[144:147], v32 offset:256
  ds_read_b128 a[176:179], v32 offset:2304
  v_mfma_f32_16x16x32_bf16 v[84:87], a[172:175], a[76:79], v[84:87]
  ds_read_b128 a[208:211], v32 offset:16640
  ds_read_b128 a[240:243], v32 offset:18688
  v_mfma_f32_16x16x32_bf16 v[88:91], a[140:143], a[108:111], v[88:91]
  v_mfma_f32_16x16x32_bf16 v[92:95], a[172:175], a[108:111], v[92:95]
  v_mfma_f32_16x16x32_bf16 v[96:99], a[204:207], a[12:15], v[96:99]
  v_mfma_f32_16x16x32_bf16 v[100:103], a[236:239], a[12:15], v[100:103]
  v_mfma_f32_16x16x32_bf16 v[104:107], a[204:207], a[44:47], v[104:107]
  v_mfma_f32_16x16x32_bf16 v[108:111], a[236:239], a[44:47], v[108:111]
  v_mfma_f32_16x16x32_bf16 v[112:115], a[204:207], a[76:79], v[112:115]
  v_mfma_f32_16x16x32_bf16 v[116:119], a[236:239], a[76:79], v[116:119]
  v_mfma_f32_16x16x32_bf16 v[120:123], a[204:207], a[108:111], v[120:123]
  v_mfma_f32_16x16x32_bf16 v[124:127], a[236:239], a[108:111], v[124:127]
  s_waitcnt lgkmcnt(0)
  v_mfma_f32_16x16x32_bf16 v[64:67], a[144:147], a[16:19], v[64:67]
  ds_read_b64_tr_b16 a[20:21], v40 offset:20480
  ds_read_b64_tr_b16 a[22:23], v40 offset:20992
  v_mfma_f32_16x16x32_bf16 v[68:71], a[176:179], a[16:19], v[68:71]
  ds_read_b64_tr_b16 a[52:53], v41 offset:20480
  ds_read_b64_tr_b16 a[54:55], v41 offset:20992
  v_mfma_f32_16x16x32_bf16 v[72:75], a[144:147], a[48:51], v[72:75]
  ds_read_b64_tr_b16 a[84:85], v42 offset:20480
  ds_read_b64_tr_b16 a[86:87], v42 offset:20992
  v_mfma_f32_16x16x32_bf16 v[76:79], a[176:179], a[48:51], v[76:79]
  ds_read_b64_tr_b16 a[116:117], v43 offset:20480
  ds_read_b64_tr_b16 a[118:119], v43 offset:20992
  v_mfma_f32_16x16x32_bf16 v[80:83], a[144:147], a[80:83], v[80:83]
  ds_read_b128 a[148:151], v33 offset:256
  ds_read_b128 a[180:183], v33 offset:2304
  v_mfma_f32_16x16x32_bf16 v[84:87], a[176:179], a[80:83], v[84:87]
  ds_read_b128 a[212:215], v33 offset:16640
  ds_read_b128 a[244:247], v33 offset:18688
  v_mfma_f32_16x16x32_bf16 v[88:91], a[144:147], a[112:115], v[88:91]
  v_mfma_f32_16x16x32_bf16 v[92:95], a[176:179], a[112:115], v[92:95]
  v_mfma_f32_16x16x32_bf16 v[96:99], a[208:211], a[16:19], v[96:99]
  v_mfma_f32_16x16x32_bf16 v[100:103], a[240:243], a[16:19], v[100:103]
  v_mfma_f32_16x16x32_bf16 v[104:107], a[208:211], a[48:51], v[104:107]
  v_mfma_f32_16x16x32_bf16 v[108:111], a[240:243], a[48:51], v[108:111]
  v_mfma_f32_16x16x32_bf16 v[112:115], a[208:211], a[80:83], v[112:115]
  v_mfma_f32_16x16x32_bf16 v[116:119], a[240:243], a[80:83], v[116:119]
  v_mfma_f32_16x16x32_bf16 v[120:123], a[208:211], a[112:115], v[120:123]
  v_mfma_f32_16x16x32_bf16 v[124:127], a[240:243], a[112:115], v[124:127]
  s_waitcnt lgkmcnt(0)
  v_mfma_f32_16x16x32_bf16 v[64:67], a[148:151], a[20:23], v[64:67]
  ds_read_b64_tr_b16 a[24:25], v40 offset:24576
  ds_read_b64_tr_b16 a[26:27], v40 offset:25088
  v_mfma_f32_16x16x32_bf16 v[68:71], a[180:183], a[20:23], v[68:71]
  ds_read_b64_tr_b16 a[56:57], v41 offset:24576
  ds_read_b64_tr_b16 a[58:59], v41 offset:25088
  v_mfma_f32_16x16x32_bf16 v[72:75], a[148:151], a[52:55], v[72:75]
  ds_read_b64_tr_b16 a[88:89], v42 offset:24576
  ds_read_b64_tr_b16 a[90:91], v42 offset:25088
  v_mfma_f32_16x16x32_bf16 v[76:79], a[180:183], a[52:55], v[76:79]
  ds_read_b64_tr_b16 a[120:121], v43 offset:24576
  ds_read_b64_tr_b16 a[122:123], v43 offset:25088
  v_mfma_f32_16x16x32_bf16 v[80:83], a[148:151], a[84:87], v[80:83]
  ds_read_b128 a[152:155], v34 offset:256
  ds_read_b128 a[184:187], v34 offset:2304
  v_mfma_f32_16x16x32_bf16 v[84:87], a[180:183], a[84:87], v[84:87]
  ds_read_b128 a[216:219], v34 offset:16640
  ds_read_b128 a[248:251], v34 offset:18688
  v_mfma_f32_16x16x32_bf16 v[88:91], a[148:151], a[116:119], v[88:91]
  v_mfma_f32_16x16x32_bf16 v[92:95], a[180:183], a[116:119], v[92:95]
  v_mfma_f32_16x16x32_bf16 v[96:99], a[212:215], a[20:23], v[96:99]
  v_mfma_f32_16x16x32_bf16 v[100:103], a[244:247], a[20:23], v[100:103]
  v_mfma_f32_16x16x32_bf16 v[104:107], a[212:215], a[52:55], v[104:107]
  v_mfma_f32_16x16x32_bf16 v[108:111], a[244:247], a[52:55], v[108:111]
  v_mfma_f32_16x16x32_bf16 v[112:115], a[212:215], a[84:87], v[112:115]
  v_mfma_f32_16x16x32_bf16 v[116:119], a[244:247], a[84:87], v[116:119]
  v_mfma_f32_16x16x32_bf16 v[120:123], a[212:215], a[116:119], v[120:123]
  v_mfma_f32_16x16x32_bf16 v[124:127], a[244:247], a[116:119], v[124:127]
  s_waitcnt lgkmcnt(0)
  v_mfma_f32_16x16x32_bf16 v[64:67], a[152:155], a[24:27], v[64:67]
  ds_read_b64_tr_b16 a[28:29], v40 offset:28672
  ds_read_b64_tr_b16 a[30:31], v40 offset:29184
  v_mfma_f32_16x16x32_bf16 v[68:71], a[184:187], a[24:27], v[68:71]
  ds_read_b64_tr_b16 a[60:61], v41 offset:28672
  ds_read_b64_tr_b16 a[62:63], v41 offset:29184
  v_mfma_f32_16x16x32_bf16 v[72:75], a[152:155], a[56:59], v[72:75]
  ds_read_b64_tr_b16 a[92:93], v42 offset:28672
  ds_read_b64_tr_b16 a[94:95], v42 offset:29184
  v_mfma_f32_16x16x32_bf16 v[76:79], a[184:187], a[56:59], v[76:79]
  ds_read_b64_tr_b16 a[124:125], v43 offset:28672
  ds_read_b64_tr_b16 a[126:127], v43 offset:29184
  v_mfma_f32_16x16x32_bf16 v[80:83], a[152:155], a[88:91], v[80:83]
  ds_read_b128 a[156:159], v35 offset:256
  ds_read_b128 a[188:191], v35 offset:2304
  v_mfma_f32_16x16x32_bf16 v[84:87], a[184:187], a[88:91], v[84:87]
  ds_read_b128 a[220:223], v35 offset:16640
  ds_read_b128 a[252:255], v35 offset:18688
  v_mfma_f32_16x16x32_bf16 v[88:91], a[152:155], a[120:123], v[88:91]
  v_mfma_f32_16x16x32_bf16 v[92:95], a[184:187], a[120:123], v[92:95]
  v_mfma_f32_16x16x32_bf16 v[96:99], a[216:219], a[24:27], v[96:99]
  v_mfma_f32_16x16x32_bf16 v[100:103], a[248:251], a[24:27], v[100:103]
  v_mfma_f32_16x16x32_bf16 v[104:107], a[216:219], a[56:59], v[104:107]
  v_mfma_f32_16x16x32_bf16 v[108:111], a[248:251], a[56:59], v[108:111]
  v_mfma_f32_16x16x32_bf16 v[112:115], a[216:219], a[88:91], v[112:115]
  v_mfma_f32_16x16x32_bf16 v[116:119], a[248:251], a[88:91], v[116:119]
  v_mfma_f32_16x16x32_bf16 v[120:123], a[216:219], a[120:123], v[120:123]
  v_mfma_f32_16x16x32_bf16 v[124:127], a[248:251], a[120:123], v[124:127]
  s_waitcnt lgkmcnt(0)
  s_barrier
  buffer_load_dwordx2 v[254:255], v252, s[12:15], 0 offen offset:128 sc1
  buffer_load_dword v253, v252, s[12:15], 0 offen sc1
  v_mfma_f32_16x16x32_bf16 v[64:67], a[156:159], a[28:31], v[64:67]
  v_mfma_f32_16x16x32_bf16 v[68:71], a[188:191], a[28:31], v[68:71]
  v_mfma_f32_16x16x32_bf16 v[72:75], a[156:159], a[60:63], v[72:75]
  v_mfma_f32_16x16x32_bf16 v[76:79], a[188:191], a[60:63], v[76:79]
  v_mfma_f32_16x16x32_bf16 v[80:83], a[156:159], a[92:95], v[80:83]
  v_cvt_pk_bf16_f32 v64, v64, v65
  v_cvt_pk_bf16_f32 v65, v66, v67
  v_mfma_f32_16x16x32_bf16 v[84:87], a[188:191], a[92:95], v[84:87]
  v_cvt_pk_bf16_f32 v66, v68, v69
  v_cvt_pk_bf16_f32 v67, v70, v71
  v_mfma_f32_16x16x32_bf16 v[88:91], a[156:159], a[124:127], v[88:91]
  buffer_store_dwordx4 v[64:67], v12, s[8:11], s29 offen sc1
  v_cvt_pk_bf16_f32 v72, v72, v73
  v_mfma_f32_16x16x32_bf16 v[92:95], a[188:191], a[124:127], v[92:95]
  v_cvt_pk_bf16_f32 v73, v74, v75
  v_cvt_pk_bf16_f32 v74, v76, v77
  v_mfma_f32_16x16x32_bf16 v[96:99], a[220:223], a[28:31], v[96:99]
  v_cvt_pk_bf16_f32 v75, v78, v79
  buffer_store_dwordx4 v[72:75], v13, s[8:11], s29 offen sc1
  v_mfma_f32_16x16x32_bf16 v[100:103], a[252:255], a[28:31], v[100:103]
  v_cvt_pk_bf16_f32 v80, v80, v81
  v_cvt_pk_bf16_f32 v81, v82, v83
  v_mfma_f32_16x16x32_bf16 v[104:107], a[220:223], a[60:63], v[104:107]
  v_cvt_pk_bf16_f32 v82, v84, v85
  v_cvt_pk_bf16_f32 v83, v86, v87
  v_mfma_f32_16x16x32_bf16 v[108:111], a[252:255], a[60:63], v[108:111]
  buffer_store_dwordx4 v[80:83], v14, s[8:11], s29 offen sc1
  v_cvt_pk_bf16_f32 v88, v88, v89
  v_mfma_f32_16x16x32_bf16 v[112:115], a[220:223], a[92:95], v[112:115]
  v_cvt_pk_bf16_f32 v89, v90, v91
  v_cvt_pk_bf16_f32 v90, v92, v93
  v_mfma_f32_16x16x32_bf16 v[116:119], a[252:255], a[92:95], v[116:119]
  v_cvt_pk_bf16_f32 v91, v94, v95
  buffer_store_dwordx4 v[88:91], v15, s[8:11], s29 offen sc1
  v_mfma_f32_16x16x32_bf16 v[120:123], a[220:223], a[124:127], v[120:123]
  v_cvt_pk_bf16_f32 v96, v96, v97
  v_cvt_pk_bf16_f32 v97, v98, v99
  v_mfma_f32_16x16x32_bf16 v[124:127], a[252:255], a[124:127], v[124:127]
  v_cvt_pk_bf16_f32 v98, v100, v101
  v_cvt_pk_bf16_f32 v99, v102, v103
  buffer_store_dwordx4 v[96:99], v12, s[8:11], s31 offen sc1
  v_cvt_pk_bf16_f32 v104, v104, v105
  v_cvt_pk_bf16_f32 v105, v106, v107
  v_cvt_pk_bf16_f32 v106, v108, v109
  v_cvt_pk_bf16_f32 v107, v110, v111
  buffer_store_dwordx4 v[104:107], v13, s[8:11], s31 offen sc1
  v_cvt_pk_bf16_f32 v112, v112, v113
  v_cvt_pk_bf16_f32 v113, v114, v115
  v_cvt_pk_bf16_f32 v114, v116, v117
  v_cvt_pk_bf16_f32 v115, v118, v119
  buffer_store_dwordx4 v[112:115], v14, s[8:11], s31 offen sc1
  v_cvt_pk_bf16_f32 v120, v120, v121
  v_cvt_pk_bf16_f32 v121, v122, v123
  v_cvt_pk_bf16_f32 v122, v124, v125
  v_cvt_pk_bf16_f32 v123, v126, v127
  buffer_store_dwordx4 v[120:123], v15, s[8:11], s31 offen sc1
  s_cmp_lg_u32 s34, 0
  s_cbranch_scc1 wp_B2
  s_mov_b32 s60, s40
  s_and_b32 s61, s41, 0xffff
  s_mov_b32 s62, 3670016
  s_mov_b32 s63, 0x20000
  s_mov_b32 s56, s42
  s_and_b32 s57, s43, 0xffff
  s_mov_b32 s58, 3670016
  s_mov_b32 s59, 0x20000
  s_lshl_b32 s27, s18, 2
  s_add_u32 s27, s27, s16
  s_lshl_b32 s27, s27, 17
  s_add_u32 s27, s27, s26
  s_lshl_b32 s30, s16, 13
  s_add_u32 m0, s30, 0
  s_nop 0
  buffer_load_dwordx4 v26, s[56:59], s27 offen  lds
  s_add_u32 s27, s27, 16384
  s_add_u32 m0, s30, 1024
  s_nop 0
  buffer_load_dwordx4 v26, s[56:59], s27 offen  lds
  s_add_u32 s27, s27, 16384
  s_add_u32 m0, s30, 2048
  s_nop 0
  buffer_load_dwordx4 v27, s[56:59], s27 offen  lds
  s_add_u32 s27, s27, 16384
  s_add_u32 m0, s30, 3072
  s_nop 0
  buffer_load_dwordx4 v27, s[56:59], s27 offen  lds
  s_add_u32 s27, s27, 16384
  s_add_u32 m0, s30, 4096
  s_nop 0
  buffer_load_dwordx4 v26, s[56:59], s27 offen  lds
  s_add_u32 s27, s27, 16384
  s_add_u32 m0, s30, 5120
  s_nop 0
  buffer_load_dwordx4 v26, s[56:59], s27 offen  lds
  s_add_u32 s27, s27, 16384
  s_add_u32 m0, s30, 6144
  s_nop 0
  buffer_load_dwordx4 v27, s[56:59], s27 offen  lds
  s_add_u32 s27, s27, 16384
  s_add_u32 m0, s30, 7168
  s_nop 0
  buffer_load_dwordx4 v27, s[56:59], s27 offen  lds
  s_add_u32 s27, s27, 16384
  s_add_u32 s27, s28, 0
  s_min_u32 s27, s27, 13
  s_lshl_b32 s27, s27, 18
  s_add_u32 s27, s27, s26
  s_add_u32 m0, s25, 0
  s_nop 0
  buffer_load_dwordx4 v16, s[60:63], s27 offen  lds
  s_add_u32 s27, s27, 16384
  s_add_u32 m0, s25, 1024
  s_nop 0
  buffer_load_dwordx4 v17, s[60:63], s27 offen  lds
  s_add_u32 s27, s27, 16384
  s_add_u32 m0, s25, 2048
  s_nop 0
  buffer_load_dwordx4 v16, s[60:63], s27 offen  lds
  s_add_u32 s27, s27, 16384
  s_add_u32 m0, s25, 3072
  s_nop 0
  buffer_load_dwordx4 v17, s[60:63], s27 offen  lds
  s_add_u32 s27, s27, 16384
  s_waitcnt vmcnt(12)
  s_barrier
  s_cmp_lg_u32 s16, 0
  s_cbranch_scc1 wp_f1_f
  v_readfirstlane_b32 s20, v254
  s_cmp_eq_u32 s20, 1
  s_cbranch_scc1 wp_f1_w_ok
  s_mov_b32 s30, 0
wp_f1_w:
  buffer_load_dword v254, off, s[12:15], 0 offset:128 sc1
  s_waitcnt vmcnt(0)
  v_cmp_ne_u32 vcc, 1, v254
  s_cbranch_vccz wp_f1_w_ok
  s_sleep 8
  s_add_u32 s30, s30, 1
  s_cmp_lt_u32 s30, 16
  s_cbranch_scc1 wp_f1_w
  s_branch wp_f1_f
wp_f1_w_ok:
  s_lshl_b32 s20, s17, 7
  s_add_u32 s20, s20, 582144
  s_lshl_b32 s21, 1, s19
  v_mov_b32 v248, s21
  s_mov_b64 exec, 1
  buffer_atomic_or v248, v252, s[8:11], s20 offen sc0
  s_mov_b64 exec, -1
  s_mov_b32 s37, s21
wp_f1_f:
  s_add_u32 m0, s25, 4096
  s_nop 0
  buffer_load_dwordx4 v18, s[60:63], s27 offen  lds
  s_add_u32 s27, s27, 16384
  s_add_u32 m0, s25, 5120
  s_nop 0
  buffer_load_dwordx4 v19, s[60:63], s27 offen  lds
  s_add_u32 s27, s27, 16384
  s_add_u32 m0, s25, 6144
  s_nop 0
  buffer_load_dwordx4 v18, s[60:63], s27 offen  lds
  s_add_u32 s27, s27, 16384
  s_add_u32 m0, s25, 7168
  s_nop 0
  buffer_load_dwordx4 v19, s[60:63], s27 offen  lds
  s_add_u32 s27, s27, 16384
  s_add_u32 m0, s25, 8192
  s_nop 0
  buffer_load_dwordx4 v20, s[60:63], s27 offen  lds
  s_add_u32 s27, s27, 16384
  s_add_u32 m0, s25, 9216
  s_nop 0
  buffer_load_dwordx4 v21, s[60:63], s27 offen  lds
  s_add_u32 s27, s27, 16384
  s_add_u32 m0, s25, 10240
  s_nop 0
  buffer_load_dwordx4 v20, s[60:63], s27 offen  lds
  s_add_u32 s27, s27, 16384
  s_add_u32 m0, s25, 11264
  s_nop 0
  buffer_load_dwordx4 v21, s[60:63], s27 offen  lds
  s_add_u32 s27, s27, 16384
  s_add_u32 m0, s25, 12288
  s_nop 0
  buffer_load_dwordx4 v22, s[60:63], s27 offen  lds
  s_add_u32 s27, s27, 16384
  s_add_u32 m0, s25, 13312
  s_nop 0
  buffer_load_dwordx4 v23, s[60:63], s27 offen  lds
  s_add_u32 s27, s27, 16384
  s_add_u32 m0, s25, 14336
  s_nop 0
  buffer_load_dwordx4 v22, s[60:63], s27 offen  lds
  s_add_u32 s27, s27, 16384
  s_add_u32 m0, s25, 15360
  s_nop 0
  buffer_load_dwordx4 v23, s[60:63], s27 offen  lds
  s_add_u32 s27, s27, 16384
  s_add_u32 s27, s28, 4
  s_min_u32 s27, s27, 13
  s_lshl_b32 s27, s27, 18
  s_add_u32 s27, s27, s26
  s_waitcnt vmcnt(12)
  v_readfirstlane_b32 s20, v248
  s_and_b32 s20, s20, 16383
  s_xor_b32 s20, s20, s37
  s_cmp_lg_u32 s20, 16383
  s_cselect_b32 s20, 0, s37
  s_mov_b32 s37, 0
  s_cmp_eq_u32 s20, 0
  s_cbranch_scc1 wp_g1
  s_lshl_b32 s21, 1, s17
  v_mov_b32 v248, s21
  s_mov_b32 s20, 586240
  v_lshlrev_b32 v247, 7, v0
  s_mov_b64 exec, 0xff
  buffer_atomic_or v248, v247, s[8:11], s20 offen
  s_mov_b64 exec, -1
wp_g1:
  s_add_u32 m0, s25, 16384
  s_nop 0
  buffer_load_dwordx4 v16, s[60:63], s27 offen  lds
  s_add_u32 s27, s27, 16384
  s_add_u32 m0, s25, 17408
  s_nop 0
  buffer_load_dwordx4 v17, s[60:63], s27 offen  lds
  s_add_u32 s27, s27, 16384
  s_add_u32 m0, s25, 18432
  s_nop 0
  buffer_load_dwordx4 v16, s[60:63], s27 offen  lds
  s_add_u32 s27, s27, 16384
  s_add_u32 m0, s25, 19456
  s_nop 0
  buffer_load_dwordx4 v17, s[60:63], s27 offen  lds
  s_add_u32 s27, s27, 16384
  s_add_u32 m0, s25, 20480
  s_nop 0
  buffer_load_dwordx4 v18, s[60:63], s27 offen  lds
  s_add_u32 s27, s27, 16384
  s_add_u32 m0, s25, 21504
  s_nop 0
  buffer_load_dwordx4 v19, s[60:63], s27 offen  lds
  s_add_u32 s27, s27, 16384
  s_add_u32 m0, s25, 22528
  s_nop 0
  buffer_load_dwordx4 v18, s[60:63], s27 offen  lds
  s_add_u32 s27, s27, 16384
  s_add_u32 m0, s25, 23552
  s_nop 0
  buffer_load_dwordx4 v19, s[60:63], s27 offen  lds
  s_add_u32 s27, s27, 16384
  s_add_u32 m0, s25, 24576
  s_nop 0
  buffer_load_dwordx4 v20, s[60:63], s27 offen  lds
  s_add_u32 s27, s27, 16384
  s_add_u32 m0, s25, 25600
  s_nop 0
  buffer_load_dwordx4 v21, s[60:63], s27 offen  lds
  s_add_u32 s27, s27, 16384
  s_add_u32 m0, s25, 26624
  s_nop 0
  buffer_load_dwordx4 v20, s[60:63], s27 offen  lds
  s_add_u32 s27, s27, 16384
  s_add_u32 m0, s25, 27648
  s_nop 0
  buffer_load_dwordx4 v21, s[60:63], s27 offen  lds
  s_add_u32 s27, s27, 16384
  s_add_u32 m0, s25, 28672
  s_nop 0
  buffer_load_dwordx4 v22, s[60:63], s27 offen  lds
  s_add_u32 s27, s27, 16384
  s_add_u32 m0, s25, 29696
  s_nop 0
  buffer_load_dwordx4 v23, s[60:63], s27 offen  lds
  s_add_u32 s27, s27, 16384
  s_add_u32 m0, s25, 30720
  s_nop 0
  buffer_load_dwordx4 v22, s[60:63], s27 offen  lds
  s_add_u32 s27, s27, 16384
  s_add_u32 m0, s25, 31744
  s_nop 0
  buffer_load_dwordx4 v23, s[60:63], s27 offen  lds
  s_add_u32 s27, s27, 16384
  s_branch wp_A
wp_B2:
  v_lshlrev_b32 v6, 7, v1
  s_getpc_b64 s[98:99]
ct_5:
  s_add_u32 s98, s98, wp_fin-ct_5
  s_addc_u32 s99, s99, 0
  global_load_dword v7, v6, s[98:99]
  s_getpc_b64 s[98:99]
ct_6:
  s_add_u32 s98, s98, wg_vo-ct_6
  s_addc_u32 s99, s99, 0
  global_load_dword v7, v6, s[98:99]
  s_waitcnt vmcnt(2)
  s_barrier
  s_cmp_lg_u32 s16, 0
  s_cbranch_scc1 wp_f2_f
  v_readfirstlane_b32 s20, v254
  s_cmp_eq_u32 s20, 1
  s_cbranch_scc1 wp_f2_w_ok
  s_mov_b32 s30, 0
wp_f2_w:
  buffer_load_dword v254, off, s[12:15], 0 offset:128 sc1
  s_waitcnt vmcnt(0)
  v_cmp_ne_u32 vcc, 1, v254
  s_cbranch_vccz wp_f2_w_ok
  s_sleep 8
  s_add_u32 s30, s30, 1
  s_cmp_lt_u32 s30, 16
  s_cbranch_scc1 wp_f2_w
  s_branch wp_f2_f
wp_f2_w_ok:
  s_lshl_b32 s20, s17, 7
  s_add_u32 s20, s20, 582144
  s_lshl_b32 s21, 1, s19
  v_mov_b32 v248, s21
  s_mov_b64 exec, 1
  buffer_atomic_or v248, v252, s[8:11], s20 offen sc0
  s_mov_b64 exec, -1
  s_mov_b32 s37, s21
wp_f2_f:
  s_cmp_eq_u32 s97, 0
  s_cselect_b32 s39, -1, s39
  s_branch wp_fin
wp_A0:
  s_mov_b32 s60, s40
  s_and_b32 s61, s41, 0xffff
  s_mov_b32 s62, 3670016
  s_mov_b32 s63, 0x20000
  s_mov_b32 s56, s42
  s_and_b32 s57, s43, 0xffff
  s_mov_b32 s58, 3670016
  s_mov_b32 s59, 0x20000
  s_lshl_b32 s27, s18, 2
  s_add_u32 s27, s27, s16
  s_lshl_b32 s27, s27, 17
  s_add_u32 s27, s27, s26
  s_lshl_b32 s30, s16, 13
  s_add_u32 m0, s30, 0
  s_nop 0
  buffer_load_dwordx4 v26, s[56:59], s27 offen  lds
  s_add_u32 s27, s27, 16384
  s_add_u32 m0, s30, 1024
  s_nop 0
  buffer_load_dwordx4 v26, s[56:59], s27 offen  lds
  s_add_u32 s27, s27, 16384
  s_add_u32 m0, s30, 2048
  s_nop 0
  buffer_load_dwordx4 v27, s[56:59], s27 offen  lds
  s_add_u32 s27, s27, 16384
  s_add_u32 m0, s30, 3072
  s_nop 0
  buffer_load_dwordx4 v27, s[56:59], s27 offen  lds
  s_add_u32 s27, s27, 16384
  s_add_u32 m0, s30, 4096
  s_nop 0
  buffer_load_dwordx4 v26, s[56:59], s27 offen  lds
  s_add_u32 s27, s27, 16384
  s_add_u32 m0, s30, 5120
  s_nop 0
  buffer_load_dwordx4 v26, s[56:59], s27 offen  lds
  s_add_u32 s27, s27, 16384
  s_add_u32 m0, s30, 6144
  s_nop 0
  buffer_load_dwordx4 v27, s[56:59], s27 offen  lds
  s_add_u32 s27, s27, 16384
  s_add_u32 m0, s30, 7168
  s_nop 0
  buffer_load_dwordx4 v27, s[56:59], s27 offen  lds
  s_add_u32 s27, s27, 16384
  s_add_u32 s27, s28, 0
  s_min_u32 s27, s27, 13
  s_lshl_b32 s27, s27, 18
  s_add_u32 s27, s27, s26
  s_add_u32 m0, s25, 0
  s_nop 0
  buffer_load_dwordx4 v16, s[60:63], s27 offen  lds
  s_add_u32 s27, s27, 16384
  s_add_u32 m0, s25, 1024
  s_nop 0
  buffer_load_dwordx4 v17, s[60:63], s27 offen  lds
  s_add_u32 s27, s27, 16384
  s_add_u32 m0, s25, 2048
  s_nop 0
  buffer_load_dwordx4 v16, s[60:63], s27 offen  lds
  s_add_u32 s27, s27, 16384
  s_add_u32 m0, s25, 3072
  s_nop 0
  buffer_load_dwordx4 v17, s[60:63], s27 offen  lds
  s_add_u32 s27, s27, 16384
  s_add_u32 m0, s25, 4096
  s_nop 0
  buffer_load_dwordx4 v18, s[60:63], s27 offen  lds
  s_add_u32 s27, s27, 16384
  s_add_u32 m0, s25, 5120
  s_nop 0
  buffer_load_dwordx4 v19, s[60:63], s27 offen  lds
  s_add_u32 s27, s27, 16384
  s_add_u32 m0, s25, 6144
  s_nop 0
  buffer_load_dwordx4 v18, s[60:63], s27 offen  lds
  s_add_u32 s27, s27, 16384
  s_add_u32 m0, s25, 7168
  s_nop 0
  buffer_load_dwordx4 v19, s[60:63], s27 offen  lds
  s_add_u32 s27, s27, 16384
  s_add_u32 m0, s25, 8192
  s_nop 0
  buffer_load_dwordx4 v20, s[60:63], s27 offen  lds
  s_add_u32 s27, s27, 16384
  s_add_u32 m0, s25, 9216
  s_nop 0
  buffer_load_dwordx4 v21, s[60:63], s27 offen  lds
  s_add_u32 s27, s27, 16384
  s_add_u32 m0, s25, 10240
  s_nop 0
  buffer_load_dwordx4 v20, s[60:63], s27 offen  lds
  s_add_u32 s27, s27, 16384
  s_add_u32 m0, s25, 11264
  s_nop 0
  buffer_load_dwordx4 v21, s[60:63], s27 offen  lds
  s_add_u32 s27, s27, 16384
  s_add_u32 m0, s25, 12288
  s_nop 0
  buffer_load_dwordx4 v22, s[60:63], s27 offen  lds
  s_add_u32 s27, s27, 16384
  s_add_u32 m0, s25, 13312
  s_nop 0
  buffer_load_dwordx4 v23, s[60:63], s27 offen  lds
  s_add_u32 s27, s27, 16384
  s_add_u32 m0, s25, 14336
  s_nop 0
  buffer_load_dwordx4 v22, s[60:63], s27 offen  lds
  s_add_u32 s27, s27, 16384
  s_add_u32 m0, s25, 15360
  s_nop 0
  buffer_load_dwordx4 v23, s[60:63], s27 offen  lds
  s_add_u32 s27, s27, 16384
  s_add_u32 s27, s28, 4
  s_min_u32 s27, s27, 13
  s_lshl_b32 s27, s27, 18
  s_add_u32 s27, s27, s26
  s_add_u32 m0, s25, 16384
  s_nop 0
  buffer_load_dwordx4 v16, s[60:63], s27 offen  lds
  s_add_u32 s27, s27, 16384
  s_add_u32 m0, s25, 17408
  s_nop 0
  buffer_load_dwordx4 v17, s[60:63], s27 offen  lds
  s_add_u32 s27, s27, 16384
  s_add_u32 m0, s25, 18432
  s_nop 0
  buffer_load_dwordx4 v16, s[60:63], s27 offen  lds
  s_add_u32 s27, s27, 16384
  s_add_u32 m0, s25, 19456
  s_nop 0
  buffer_load_dwordx4 v17, s[60:63], s27 offen  lds
  s_add_u32 s27, s27, 16384
  s_add_u32 m0, s25, 20480
  s_nop 0
  buffer_load_dwordx4 v18, s[60:63], s27 offen  lds
  s_add_u32 s27, s27, 16384
  s_add_u32 m0, s25, 21504
  s_nop 0
  buffer_load_dwordx4 v19, s[60:63], s27 offen  lds
  s_add_u32 s27, s27, 16384
  s_add_u32 m0, s25, 22528
  s_nop 0
  buffer_load_dwordx4 v18, s[60:63], s27 offen  lds
  s_add_u32 s27, s27, 16384
  s_add_u32 m0, s25, 23552
  s_nop 0
  buffer_load_dwordx4 v19, s[60:63], s27 offen  lds
  s_add_u32 s27, s27, 16384
  s_add_u32 m0, s25, 24576
  s_nop 0
  buffer_load_dwordx4 v20, s[60:63], s27 offen  lds
  s_add_u32 s27, s27, 16384
  s_add_u32 m0, s25, 25600
  s_nop 0
  buffer_load_dwordx4 v21, s[60:63], s27 offen  lds
  s_add_u32 s27, s27, 16384
  s_add_u32 m0, s25, 26624
  s_nop 0
  buffer_load_dwordx4 v20, s[60:63], s27 offen  lds
  s_add_u32 s27, s27, 16384
  s_add_u32 m0, s25, 27648
  s_nop 0
  buffer_load_dwordx4 v21, s[60:63], s27 offen  lds
  s_add_u32 s27, s27, 16384
  s_add_u32 m0, s25, 28672
  s_nop 0
  buffer_load_dwordx4 v22, s[60:63], s27 offen  lds
  s_add_u32 s27, s27, 16384
  s_add_u32 m0, s25, 29696
  s_nop 0
  buffer_load_dwordx4 v23, s[60:63], s27 offen  lds
  s_add_u32 s27, s27, 16384
  s_add_u32 m0, s25, 30720
  s_nop 0
  buffer_load_dwordx4 v22, s[60:63], s27 offen  lds
  s_add_u32 s27, s27, 16384
  s_add_u32 m0, s25, 31744
  s_nop 0
  buffer_load_dwordx4 v23, s[60:63], s27 offen  lds
  s_add_u32 s27, s27, 16384
  v_lshrrev_b32 v7, 2, v4
  v_lshlrev_b32 v11, 4, v7
  v_lshlrev_b32 v7, 3, v7
  v_and_b32 v8, 3, v4
  v_add_u32 v7, v7, v8
  v_and_b32 v8, 2, v4
  v_lshl_add_u32 v11, v8, 1, v11
  v_and_b32 v8, 1, v4
  v_add_u32 v11, v11, v8
  v_or_b32 v10, 0, v3
  v_xor_b32 v10, v10, v4
  v_lshlrev_b32 v10, 4, v10
  v_lshl_add_u32 v44, v11, 9, v10
  v_lshl_add_u32 v10, v7, 9, v10
  v_add_u32 v32, s25, v10
  v_or_b32 v10, 4, v3
  v_xor_b32 v10, v10, v4
  v_lshlrev_b32 v10, 4, v10
  v_lshl_add_u32 v45, v11, 9, v10
  v_lshl_add_u32 v10, v7, 9, v10
  v_add_u32 v33, s25, v10
  v_or_b32 v10, 8, v3
  v_xor_b32 v10, v10, v4
  v_lshlrev_b32 v10, 4, v10
  v_lshl_add_u32 v46, v11, 9, v10
  v_lshl_add_u32 v10, v7, 9, v10
  v_add_u32 v34, s25, v10
  v_or_b32 v10, 12, v3
  v_xor_b32 v10, v10, v4
  v_lshlrev_b32 v10, 4, v10
  v_lshl_add_u32 v47, v11, 9, v10
  v_lshl_add_u32 v10, v7, 9, v10
  v_add_u32 v35, s25, v10
  s_mul_i32 s30, s17, 401408
  s_mul_i32 s31, s18, 57344
  s_add_u32 s30, s30, s31
  s_add_u32 s30, s30, 33554432
  v_add_u32 v28, s30, v2
  s_add_u32 s30, s30, 14336
  v_add_u32 v29, s30, v2
  s_add_u32 s30, s30, 14336
  v_add_u32 v30, s30, v2
  s_add_u32 s30, s30, 14336
  v_add_u32 v31, s30, v2
  s_add_u32 s30, s30, 14336
  v_mov_b32 v48, 1035512379
wp_A:
  s_lshl_b32 s29, s28, 10
  s_add_u32 s31, s29, 4096
  s_cmp_lt_u32 s28, 10
  s_cselect_b32 s31, s31, 0x40000000
  s_waitcnt vmcnt(0)
  s_barrier
  ds_read_b128 a[0:3], v44 offset:0
  ds_read_b128 a[32:35], v44 offset:1024
  ds_read_b128 a[64:67], v44 offset:4096
  ds_read_b128 a[96:99], v44 offset:5120
  ds_read_b128 a[128:131], v32 offset:0
  ds_read_b128 a[160:163], v32 offset:2048
  ds_read_b128 a[192:195], v32 offset:16384
  ds_read_b128 a[224:227], v32 offset:18432
  s_waitcnt lgkmcnt(0)
  v_mfma_f32_16x16x32_bf16 v[64:67], a[128:131], a[0:3], 0
  ds_read_b128 a[4:7], v45 offset:0
  ds_read_b128 a[36:39], v45 offset:1024
  v_mfma_f32_16x16x32_bf16 v[68:71], a[160:163], a[0:3], 0
  ds_read_b128 a[68:71], v45 offset:4096
  ds_read_b128 a[100:103], v45 offset:5120
  v_mfma_f32_16x16x32_bf16 v[72:75], a[128:131], a[32:35], 0
  ds_read_b128 a[132:135], v33 offset:0
  ds_read_b128 a[164:167], v33 offset:2048
  v_mfma_f32_16x16x32_bf16 v[76:79], a[160:163], a[32:35], 0
  ds_read_b128 a[196:199], v33 offset:16384
  ds_read_b128 a[228:231], v33 offset:18432
  v_mfma_f32_16x16x32_bf16 v[80:83], a[128:131], a[64:67], 0
  v_mfma_f32_16x16x32_bf16 v[84:87], a[160:163], a[64:67], 0
  v_mfma_f32_16x16x32_bf16 v[88:91], a[128:131], a[96:99], 0
  v_mfma_f32_16x16x32_bf16 v[92:95], a[160:163], a[96:99], 0
  v_mfma_f32_16x16x32_bf16 v[96:99], a[192:195], a[0:3], 0
  v_mfma_f32_16x16x32_bf16 v[100:103], a[224:227], a[0:3], 0
  v_mfma_f32_16x16x32_bf16 v[104:107], a[192:195], a[32:35], 0
  v_mfma_f32_16x16x32_bf16 v[108:111], a[224:227], a[32:35], 0
  v_mfma_f32_16x16x32_bf16 v[112:115], a[192:195], a[64:67], 0
  v_mfma_f32_16x16x32_bf16 v[116:119], a[224:227], a[64:67], 0
  v_mfma_f32_16x16x32_bf16 v[120:123], a[192:195], a[96:99], 0
  v_mfma_f32_16x16x32_bf16 v[124:127], a[224:227], a[96:99], 0
  s_waitcnt lgkmcnt(0)
  v_mfma_f32_16x16x32_bf16 v[64:67], a[132:135], a[4:7], v[64:67]
  ds_read_b128 a[8:11], v46 offset:0
  ds_read_b128 a[40:43], v46 offset:1024
  v_mfma_f32_16x16x32_bf16 v[68:71], a[164:167], a[4:7], v[68:71]
  ds_read_b128 a[72:75], v46 offset:4096
  ds_read_b128 a[104:107], v46 offset:5120
  v_mfma_f32_16x16x32_bf16 v[72:75], a[132:135], a[36:39], v[72:75]
  ds_read_b128 a[136:139], v34 offset:0
  ds_read_b128 a[168:171], v34 offset:2048
  v_mfma_f32_16x16x32_bf16 v[76:79], a[164:167], a[36:39], v[76:79]
  ds_read_b128 a[200:203], v34 offset:16384
  ds_read_b128 a[232:235], v34 offset:18432
  v_mfma_f32_16x16x32_bf16 v[80:83], a[132:135], a[68:71], v[80:83]
  v_mfma_f32_16x16x32_bf16 v[84:87], a[164:167], a[68:71], v[84:87]
  v_mfma_f32_16x16x32_bf16 v[88:91], a[132:135], a[100:103], v[88:91]
  v_mfma_f32_16x16x32_bf16 v[92:95], a[164:167], a[100:103], v[92:95]
  v_mfma_f32_16x16x32_bf16 v[96:99], a[196:199], a[4:7], v[96:99]
  v_mfma_f32_16x16x32_bf16 v[100:103], a[228:231], a[4:7], v[100:103]
  v_mfma_f32_16x16x32_bf16 v[104:107], a[196:199], a[36:39], v[104:107]
  v_mfma_f32_16x16x32_bf16 v[108:111], a[228:231], a[36:39], v[108:111]
  v_mfma_f32_16x16x32_bf16 v[112:115], a[196:199], a[68:71], v[112:115]
  v_mfma_f32_16x16x32_bf16 v[116:119], a[228:231], a[68:71], v[116:119]
  v_mfma_f32_16x16x32_bf16 v[120:123], a[196:199], a[100:103], v[120:123]
  v_mfma_f32_16x16x32_bf16 v[124:127], a[228:231], a[100:103], v[124:127]
  s_waitcnt lgkmcnt(0)
  v_mfma_f32_16x16x32_bf16 v[64:67], a[136:139], a[8:11], v[64:67]
  ds_read_b128 a[12:15], v47 offset:0
  ds_read_b128 a[44:47], v47 offset:1024
  v_mfma_f32_16x16x32_bf16 v[68:71], a[168:171], a[8:11], v[68:71]
  ds_read_b128 a[76:79], v47 offset:4096
  ds_read_b128 a[108:111], v47 offset:5120
  v_mfma_f32_16x16x32_bf16 v[72:75], a[136:139], a[40:43], v[72:75]
  ds_read_b128 a[140:143], v35 offset:0
  ds_read_b128 a[172:175], v35 offset:2048
  v_mfma_f32_16x16x32_bf16 v[76:79], a[168:171], a[40:43], v[76:79]
  ds_read_b128 a[204:207], v35 offset:16384
  ds_read_b128 a[236:239], v35 offset:18432
  v_mfma_f32_16x16x32_bf16 v[80:83], a[136:139], a[72:75], v[80:83]
  v_mfma_f32_16x16x32_bf16 v[84:87], a[168:171], a[72:75], v[84:87]
  v_mfma_f32_16x16x32_bf16 v[88:91], a[136:139], a[104:107], v[88:91]
  v_mfma_f32_16x16x32_bf16 v[92:95], a[168:171], a[104:107], v[92:95]
  v_mfma_f32_16x16x32_bf16 v[96:99], a[200:203], a[8:11], v[96:99]
  v_mfma_f32_16x16x32_bf16 v[100:103], a[232:235], a[8:11], v[100:103]
  v_mfma_f32_16x16x32_bf16 v[104:107], a[200:203], a[40:43], v[104:107]
  v_mfma_f32_16x16x32_bf16 v[108:111], a[232:235], a[40:43], v[108:111]
  v_mfma_f32_16x16x32_bf16 v[112:115], a[200:203], a[72:75], v[112:115]
  v_mfma_f32_16x16x32_bf16 v[116:119], a[232:235], a[72:75], v[116:119]
  v_mfma_f32_16x16x32_bf16 v[120:123], a[200:203], a[104:107], v[120:123]
  v_mfma_f32_16x16x32_bf16 v[124:127], a[232:235], a[104:107], v[124:127]
  s_waitcnt lgkmcnt(0)
  v_mfma_f32_16x16x32_bf16 v[64:67], a[140:143], a[12:15], v[64:67]
  ds_read_b128 a[16:19], v44 offset:256
  ds_read_b128 a[48:51], v44 offset:1280
  v_mfma_f32_16x16x32_bf16 v[68:71], a[172:175], a[12:15], v[68:71]
  ds_read_b128 a[80:83], v44 offset:4352
  ds_read_b128 a[112:115], v44 offset:5376
  v_mfma_f32_16x16x32_bf16 v[72:75], a[140:143], a[44:47], v[72:75]
  ds_read_b128 a[144:147], v32 offset:256
  ds_read_b128 a[176:179], v32 offset:2304
  v_mfma_f32_16x16x32_bf16 v[76:79], a[172:175], a[44:47], v[76:79]
  ds_read_b128 a[208:211], v32 offset:16640
  ds_read_b128 a[240:243], v32 offset:18688
  v_mfma_f32_16x16x32_bf16 v[80:83], a[140:143], a[76:79], v[80:83]
  v_mfma_f32_16x16x32_bf16 v[84:87], a[172:175], a[76:79], v[84:87]
  v_mfma_f32_16x16x32_bf16 v[88:91], a[140:143], a[108:111], v[88:91]
  v_mfma_f32_16x16x32_bf16 v[92:95], a[172:175], a[108:111], v[92:95]
  v_mfma_f32_16x16x32_bf16 v[96:99], a[204:207], a[12:15], v[96:99]
  v_mfma_f32_16x16x32_bf16 v[100:103], a[236:239], a[12:15], v[100:103]
  v_mfma_f32_16x16x32_bf16 v[104:107], a[204:207], a[44:47], v[104:107]
  v_mfma_f32_16x16x32_bf16 v[108:111], a[236:239], a[44:47], v[108:111]
  v_mfma_f32_16x16x32_bf16 v[112:115], a[204:207], a[76:79], v[112:115]
  v_mfma_f32_16x16x32_bf16 v[116:119], a[236:239], a[76:79], v[116:119]
  v_mfma_f32_16x16x32_bf16 v[120:123], a[204:207], a[108:111], v[120:123]
  v_mfma_f32_16x16x32_bf16 v[124:127], a[236:239], a[108:111], v[124:127]
  s_waitcnt lgkmcnt(0)
  v_mfma_f32_16x16x32_bf16 v[64:67], a[144:147], a[16:19], v[64:67]
  ds_read_b128 a[20:23], v45 offset:256
  ds_read_b128 a[52:55], v45 offset:1280
  v_mfma_f32_16x16x32_bf16 v[68:71], a[176:179], a[16:19], v[68:71]
  ds_read_b128 a[84:87], v45 offset:4352
  ds_read_b128 a[116:119], v45 offset:5376
  v_mfma_f32_16x16x32_bf16 v[72:75], a[144:147], a[48:51], v[72:75]
  ds_read_b128 a[148:151], v33 offset:256
  ds_read_b128 a[180:183], v33 offset:2304
  v_mfma_f32_16x16x32_bf16 v[76:79], a[176:179], a[48:51], v[76:79]
  ds_read_b128 a[212:215], v33 offset:16640
  ds_read_b128 a[244:247], v33 offset:18688
  v_mfma_f32_16x16x32_bf16 v[80:83], a[144:147], a[80:83], v[80:83]
  v_mfma_f32_16x16x32_bf16 v[84:87], a[176:179], a[80:83], v[84:87]
  v_mfma_f32_16x16x32_bf16 v[88:91], a[144:147], a[112:115], v[88:91]
  v_mfma_f32_16x16x32_bf16 v[92:95], a[176:179], a[112:115], v[92:95]
  v_mfma_f32_16x16x32_bf16 v[96:99], a[208:211], a[16:19], v[96:99]
  v_mfma_f32_16x16x32_bf16 v[100:103], a[240:243], a[16:19], v[100:103]
  v_mfma_f32_16x16x32_bf16 v[104:107], a[208:211], a[48:51], v[104:107]
  v_mfma_f32_16x16x32_bf16 v[108:111], a[240:243], a[48:51], v[108:111]
  v_mfma_f32_16x16x32_bf16 v[112:115], a[208:211], a[80:83], v[112:115]
  v_mfma_f32_16x16x32_bf16 v[116:119], a[240:243], a[80:83], v[116:119]
  v_mfma_f32_16x16x32_bf16 v[120:123], a[208:211], a[112:115], v[120:123]
  v_mfma_f32_16x16x32_bf16 v[124:127], a[240:243], a[112:115], v[124:127]
  s_waitcnt lgkmcnt(0)
  v_mfma_f32_16x16x32_bf16 v[64:67], a[148:151], a[20:23], v[64:67]
  ds_read_b128 a[24:27], v46 offset:256
  ds_read_b128 a[56:59], v46 offset:1280
  v_mfma_f32_16x16x32_bf16 v[68:71], a[180:183], a[20:23], v[68:71]
  ds_read_b128 a[88:91], v46 offset:4352
  ds_read_b128 a[120:123], v46 offset:5376
  v_mfma_f32_16x16x32_bf16 v[72:75], a[148:151], a[52:55], v[72:75]
  ds_read_b128 a[152:155], v34 offset:256
  ds_read_b128 a[184:187], v34 offset:2304
  v_mfma_f32_16x16x32_bf16 v[76:79], a[180:183], a[52:55], v[76:79]
  ds_read_b128 a[216:219], v34 offset:16640
  ds_read_b128 a[248:251], v34 offset:18688
  v_mfma_f32_16x16x32_bf16 v[80:83], a[148:151], a[84:87], v[80:83]
  v_mfma_f32_16x16x32_bf16 v[84:87], a[180:183], a[84:87], v[84:87]
  v_mfma_f32_16x16x32_bf16 v[88:91], a[148:151], a[116:119], v[88:91]
  v_mfma_f32_16x16x32_bf16 v[92:95], a[180:183], a[116:119], v[92:95]
  v_mfma_f32_16x16x32_bf16 v[96:99], a[212:215], a[20:23], v[96:99]
  v_mfma_f32_16x16x32_bf16 v[100:103], a[244:247], a[20:23], v[100:103]
  v_mfma_f32_16x16x32_bf16 v[104:107], a[212:215], a[52:55], v[104:107]
  v_mfma_f32_16x16x32_bf16 v[108:111], a[244:247], a[52:55], v[108:111]
  v_mfma_f32_16x16x32_bf16 v[112:115], a[212:215], a[84:87], v[112:115]
  v_mfma_f32_16x16x32_bf16 v[116:119], a[244:247], a[84:87], v[116:119]
  v_mfma_f32_16x16x32_bf16 v[120:123], a[212:215], a[116:119], v[120:123]
  v_mfma_f32_16x16x32_bf16 v[124:127], a[244:247], a[116:119], v[124:127]
  s_waitcnt lgkmcnt(0)
  v_mfma_f32_16x16x32_bf16 v[64:67], a[152:155], a[24:27], v[64:67]
  ds_read_b128 a[28:31], v47 offset:256
  ds_read_b128 a[60:63], v47 offset:1280
  v_mfma_f32_16x16x32_bf16 v[68:71], a[184:187], a[24:27], v[68:71]
  ds_read_b128 a[92:95], v47 offset:4352
  ds_read_b128 a[124:127], v47 offset:5376
  v_mfma_f32_16x16x32_bf16 v[72:75], a[152:155], a[56:59], v[72:75]
  ds_read_b128 a[156:159], v35 offset:256
  ds_read_b128 a[188:191], v35 offset:2304
  v_mfma_f32_16x16x32_bf16 v[76:79], a[184:187], a[56:59], v[76:79]
  ds_read_b128 a[220:223], v35 offset:16640
  ds_read_b128 a[252:255], v35 offset:18688
  v_mfma_f32_16x16x32_bf16 v[80:83], a[152:155], a[88:91], v[80:83]
  v_mfma_f32_16x16x32_bf16 v[84:87], a[184:187], a[88:91], v[84:87]
  v_mfma_f32_16x16x32_bf16 v[88:91], a[152:155], a[120:123], v[88:91]
  v_mfma_f32_16x16x32_bf16 v[92:95], a[184:187], a[120:123], v[92:95]
  v_mfma_f32_16x16x32_bf16 v[96:99], a[216:219], a[24:27], v[96:99]
  v_mfma_f32_16x16x32_bf16 v[100:103], a[248:251], a[24:27], v[100:103]
  v_mfma_f32_16x16x32_bf16 v[104:107], a[216:219], a[56:59], v[104:107]
  v_mfma_f32_16x16x32_bf16 v[108:111], a[248:251], a[56:59], v[108:111]
  v_mfma_f32_16x16x32_bf16 v[112:115], a[216:219], a[88:91], v[112:115]
  v_mfma_f32_16x16x32_bf16 v[116:119], a[248:251], a[88:91], v[116:119]
  v_mfma_f32_16x16x32_bf16 v[120:123], a[216:219], a[120:123], v[120:123]
  v_mfma_f32_16x16x32_bf16 v[124:127], a[248:251], a[120:123], v[124:127]
  s_waitcnt lgkmcnt(0)
  s_barrier
  buffer_load_dwordx2 v[254:255], v252, s[12:15], 0 offen offset:128 sc1
  buffer_load_dword v253, v252, s[12:15], 0 offen sc1
  v_mfma_f32_16x16x32_bf16 v[64:67], a[156:159], a[28:31], v[64:67]
  v_mfma_f32_16x16x32_bf16 v[68:71], a[188:191], a[28:31], v[68:71]
  v_mfma_f32_16x16x32_bf16 v[72:75], a[156:159], a[60:63], v[72:75]
  v_mfma_f32_16x16x32_bf16 v[76:79], a[188:191], a[60:63], v[76:79]
  v_mfma_f32_16x16x32_bf16 v[80:83], a[156:159], a[92:95], v[80:83]
  v_pk_mul_f32 v[64:65], v[64:65], v[48:49] op_sel_hi:[1,0]
  v_pk_mul_f32 v[66:67], v[66:67], v[48:49] op_sel_hi:[1,0]
  v_mfma_f32_16x16x32_bf16 v[84:87], a[188:191], a[92:95], v[84:87]
  v_pk_mul_f32 v[68:69], v[68:69], v[48:49] op_sel_hi:[1,0]
  v_pk_mul_f32 v[70:71], v[70:71], v[48:49] op_sel_hi:[1,0]
  v_mfma_f32_16x16x32_bf16 v[88:91], a[156:159], a[124:127], v[88:91]
  v_cvt_pk_bf16_f32 v64, v64, v65
  v_cvt_pk_bf16_f32 v65, v66, v67
  v_mfma_f32_16x16x32_bf16 v[92:95], a[188:191], a[124:127], v[92:95]
  v_cvt_pk_bf16_f32 v66, v68, v69
  v_cvt_pk_bf16_f32 v67, v70, v71
  v_mfma_f32_16x16x32_bf16 v[96:99], a[220:223], a[28:31], v[96:99]
  buffer_store_dwordx4 v[64:67], v28, s[8:11], s29 offen sc1
  v_pk_mul_f32 v[72:73], v[72:73], v[48:49] op_sel_hi:[1,0]
  v_mfma_f32_16x16x32_bf16 v[100:103], a[252:255], a[28:31], v[100:103]
  v_pk_mul_f32 v[74:75], v[74:75], v[48:49] op_sel_hi:[1,0]
  v_pk_mul_f32 v[76:77], v[76:77], v[48:49] op_sel_hi:[1,0]
  v_mfma_f32_16x16x32_bf16 v[104:107], a[220:223], a[60:63], v[104:107]
  v_pk_mul_f32 v[78:79], v[78:79], v[48:49] op_sel_hi:[1,0]
  v_cvt_pk_bf16_f32 v72, v72, v73
  v_mfma_f32_16x16x32_bf16 v[108:111], a[252:255], a[60:63], v[108:111]
  v_cvt_pk_bf16_f32 v73, v74, v75
  v_cvt_pk_bf16_f32 v74, v76, v77
  v_mfma_f32_16x16x32_bf16 v[112:115], a[220:223], a[92:95], v[112:115]
  v_cvt_pk_bf16_f32 v75, v78, v79
  buffer_store_dwordx4 v[72:75], v29, s[8:11], s29 offen sc1
  v_mfma_f32_16x16x32_bf16 v[116:119], a[252:255], a[92:95], v[116:119]
  v_pk_mul_f32 v[80:81], v[80:81], v[48:49] op_sel_hi:[1,0]
  v_pk_mul_f32 v[82:83], v[82:83], v[48:49] op_sel_hi:[1,0]
  v_mfma_f32_16x16x32_bf16 v[120:123], a[220:223], a[124:127], v[120:123]
  v_pk_mul_f32 v[84:85], v[84:85], v[48:49] op_sel_hi:[1,0]
  v_pk_mul_f32 v[86:87], v[86:87], v[48:49] op_sel_hi:[1,0]
  v_mfma_f32_16x16x32_bf16 v[124:127], a[252:255], a[124:127], v[124:127]
  v_cvt_pk_bf16_f32 v80, v80, v81
  v_cvt_pk_bf16_f32 v81, v82, v83
  v_cvt_pk_bf16_f32 v82, v84, v85
  v_cvt_pk_bf16_f32 v83, v86, v87
  buffer_store_dwordx4 v[80:83], v30, s[8:11], s29 offen sc1
  v_pk_mul_f32 v[88:89], v[88:89], v[48:49] op_sel_hi:[1,0]
  v_pk_mul_f32 v[90:91], v[90:91], v[48:49] op_sel_hi:[1,0]
  v_pk_mul_f32 v[92:93], v[92:93], v[48:49] op_sel_hi:[1,0]
  v_pk_mul_f32 v[94:95], v[94:95], v[48:49] op_sel_hi:[1,0]
  v_cvt_pk_bf16_f32 v88, v88, v89
  v_cvt_pk_bf16_f32 v89, v90, v91
  v_cvt_pk_bf16_f32 v90, v92, v93
  v_cvt_pk_bf16_f32 v91, v94, v95
  buffer_store_dwordx4 v[88:91], v31, s[8:11], s29 offen sc1
  v_pk_mul_f32 v[96:97], v[96:97], v[48:49] op_sel_hi:[1,0]
  v_pk_mul_f32 v[98:99], v[98:99], v[48:49] op_sel_hi:[1,0]
  v_pk_mul_f32 v[100:101], v[100:101], v[48:49] op_sel_hi:[1,0]
  v_pk_mul_f32 v[102:103], v[102:103], v[48:49] op_sel_hi:[1,0]
  v_cvt_pk_bf16_f32 v96, v96, v97
  v_cvt_pk_bf16_f32 v97, v98, v99
  v_cvt_pk_bf16_f32 v98, v100, v101
  v_cvt_pk_bf16_f32 v99, v102, v103
  buffer_store_dwordx4 v[96:99], v28, s[8:11], s31 offen sc1
  v_pk_mul_f32 v[104:105], v[104:105], v[48:49] op_sel_hi:[1,0]
  v_pk_mul_f32 v[106:107], v[106:107], v[48:49] op_sel_hi:[1,0]
  v_pk_mul_f32 v[108:109], v[108:109], v[48:49] op_sel_hi:[1,0]
  v_pk_mul_f32 v[110:111], v[110:111], v[48:49] op_sel_hi:[1,0]
  v_cvt_pk_bf16_f32 v104, v104, v105
  v_cvt_pk_bf16_f32 v105, v106, v107
  v_cvt_pk_bf16_f32 v106, v108, v109
  v_cvt_pk_bf16_f32 v107, v110, v111
  buffer_store_dwordx4 v[104:107], v29, s[8:11], s31 offen sc1
  v_pk_mul_f32 v[112:113], v[112:113], v[48:49] op_sel_hi:[1,0]
  v_pk_mul_f32 v[114:115], v[114:115], v[48:49] op_sel_hi:[1,0]
  v_pk_mul_f32 v[116:117], v[116:117], v[48:49] op_sel_hi:[1,0]
  v_pk_mul_f32 v[118:119], v[118:119], v[48:49] op_sel_hi:[1,0]
  v_cvt_pk_bf16_f32 v112, v112, v113
  v_cvt_pk_bf16_f32 v113, v114, v115
  v_cvt_pk_bf16_f32 v114, v116, v117
  v_cvt_pk_bf16_f32 v115, v118, v119
  buffer_store_dwordx4 v[112:115], v30, s[8:11], s31 offen sc1
  v_pk_mul_f32 v[120:121], v[120:121], v[48:49] op_sel_hi:[1,0]
  v_pk_mul_f32 v[122:123], v[122:123], v[48:49] op_sel_hi:[1,0]
  v_pk_mul_f32 v[124:125], v[124:125], v[48:49] op_sel_hi:[1,0]
  v_pk_mul_f32 v[126:127], v[126:127], v[48:49] op_sel_hi:[1,0]
  v_cvt_pk_bf16_f32 v120, v120, v121
  v_cvt_pk_bf16_f32 v121, v122, v123
  v_cvt_pk_bf16_f32 v122, v124, v125
  v_cvt_pk_bf16_f32 v123, v126, v127
  buffer_store_dwordx4 v[120:123], v31, s[8:11], s31 offen sc1
  s_waitcnt vmcnt(0)
  s_barrier
  s_cmp_lg_u32 s16, 0
  s_cbranch_scc1 wp_f3_f
  v_readfirstlane_b32 s20, v254
  s_cmp_eq_u32 s20, 1
  s_cbranch_scc1 wp_f3_w_ok
  s_mov_b32 s30, 0
wp_f3_w:
  buffer_load_dword v254, off, s[12:15], 0 offset:128 sc1
  s_waitcnt vmcnt(0)
  v_cmp_ne_u32 vcc, 1, v254
  s_cbranch_vccz wp_f3_w_ok
  s_sleep 8
  s_add_u32 s30, s30, 1
  s_cmp_lt_u32 s30, 16
  s_cbranch_scc1 wp_f3_w
  s_branch wp_f3_f
wp_f3_w_ok:
  s_lshl_b32 s20, s17, 7
  s_add_u32 s20, s20, 584192
  s_lshl_b32 s21, 1, s19
  v_mov_b32 v248, s21
  s_mov_b64 exec, 1
  buffer_atomic_or v248, v252, s[8:11], s20 offen sc0
  s_mov_b64 exec, -1
  s_mov_b32 s38, s21
wp_f3_f:
  s_cmp_eq_u32 s97, 3
  s_cbranch_scc1 wk_adone
wp_fin:
  s_cmp_lg_u32 s97, 0
  s_cbranch_scc1 wp_all
  v_readfirstlane_b32 s20, v254
  v_readfirstlane_b32 s21, v253
  s_and_b32 s21, s21, 0xffe0
  s_cselect_b32 s96, s20, 0
  s_cmp_eq_u32 s96, 0
  s_cbranch_scc1 wp_all
  v_mov_b32 v250, 1
  s_mov_b32 s20, 588288
  s_mov_b64 exec, 1
  buffer_atomic_add v250, v252, s[8:11], s20 offen sc0
  s_mov_b64 exec, -1
wp_all:
  v_mov_b32 v252, 0x40000000
  v_cmp_eq_u32 vcc, 0, v0
  s_nop 1
  v_cndmask_b32 v252, v252, v0, vcc
  s_mov_b32 s34, 0
  s_cmp_lg_u32 s16, 0
  s_cbranch_scc1 wp_w2
  s_getreg_b32 s24, hwreg(HW_REG_XCC_ID)
  s_sub_u32 s24, s24, 3
  s_and_b32 s24, s24, 7
  s_lshl_b32 s24, s24, 7
  s_add_u32 s24, s24, 586240
  s_cmp_lg_u32 s96, 0
  s_cbranch_scc1 wp_v0
  s_waitcnt vmcnt(0)
wp_v0:
  s_cmp_eq_u32 s97, 0
  s_cbranch_scc1 wp_v1
  s_waitcnt vmcnt(0)
wp_v1:
  s_waitcnt vmcnt(1)
  v_readfirstlane_b32 s20, v248
  s_and_b32 s20, s20, 14448
  s_xor_b32 s20, s20, s38
  s_cmp_lg_u32 s20, 14448
  s_cselect_b32 s20, 0, s38
  s_mov_b32 s38, 0
  s_cmp_eq_u32 s20, 0
  s_cbranch_scc1 wp_g3
  s_lshl_b32 s21, 65536, s17
  v_mov_b32 v248, s21
  s_mov_b32 s20, 586240
  v_lshlrev_b32 v247, 7, v0
  s_mov_b64 exec, 0xff
  buffer_atomic_or v248, v247, s[8:11], s20 offen
  s_mov_b64 exec, -1
wp_g3:
  v_readfirstlane_b32 s20, v248
  s_and_b32 s20, s20, 16383
  s_xor_b32 s20, s20, s37
  s_cmp_lg_u32 s20, 16383
  s_cselect_b32 s20, 0, s37
  s_mov_b32 s37, 0
  s_cmp_eq_u32 s20, 0
  s_cbranch_scc1 wp_g2
  s_lshl_b32 s21, 1, s17
  v_mov_b32 v248, s21
  s_mov_b32 s20, 586240
  v_lshlrev_b32 v247, 7, v0
  s_mov_b64 exec, 0xff
  buffer_atomic_or v248, v247, s[8:11], s20 offen
  s_mov_b64 exec, -1
wp_g2:
  s_cmp_lg_u32 s96, 0
  s_cbranch_scc1 wp_v_ok
  s_mov_b32 s30, 0
wp_v:
  buffer_load_dwordx2 v[64:65], off, s[12:15], 0 sc1
  buffer_load_dword v66, off, s[12:15], 0 offset:128 sc1
  s_waitcnt vmcnt(0)
  v_and_b32 v68, 0xffe0, v64
  v_min_u32 v68, v68, v66
  v_cmp_ne_u32 vcc, 1, v68
  s_cbranch_vccz wp_v_ok
  s_sleep 16
  s_add_u32 s30, s30, 1
  s_cmp_lt_u32 s30, 30
  s_cbranch_scc1 wp_v
  s_branch wp_w1
wp_v_ok:
  v_mov_b32 v64, 32
  s_cmp_eq_u32 s97, 2
  s_cselect_b32 s31, 1, 60
  s_cmp_eq_u32 s39, -1
  s_cselect_b32 s20, 4, 0
  s_add_u32 s24, s24, s20
  s_mov_b32 s30, 0
wp_w:
  buffer_load_dword v66, off, s[8:11], s24 sc1
  buffer_load_dword v67, off, s[8:11], s24 offset:4 sc1
  s_waitcnt vmcnt(0)
  v_or_b32 v66, s39, v66
  v_add_u32 v66, v66, v67
  v_cmp_ne_u32 vcc, 0, v66
  s_cbranch_vccz wp_w_ok
  s_sleep 8
  s_add_u32 s30, s30, 1
  s_cmp_lt_u32 s30, s31
  s_cbranch_scc1 wp_w
  s_branch wp_w1
wp_w_ok:
  s_branch wp_w2
wp_w1:
  v_readfirstlane_b32 s20, v64
  v_readfirstlane_b32 s21, v65
  s_and_b32 s20, s20, 0xffff
  s_cmp_lt_u32 s20, 32
  s_cselect_b32 s34, 2, 1
  s_add_u32 s32, s32, 1
  s_cmp_lt_u32 s32, 4000
  s_cselect_b32 s34, s34, 3
wp_w2:
  v_mov_b32 v6, 160032
  v_mov_b32 v7, s34
  s_barrier
  s_cmp_lg_u32 s16, 0
  s_cbranch_scc1 uni_7
  ds_write_b32 v6, v7
  s_waitcnt lgkmcnt(0)
uni_7:
  s_barrier
  ds_read_b32 v7, v6
  s_waitcnt lgkmcnt(0)
  v_readfirstlane_b32 s34, v7
  s_cmp_lg_u32 s34, 0
  s_cbranch_scc1 wp_bad
  s_cmp_lg_u32 s39, -1
  s_cbranch_scc1 wp_done
  s_mov_b32 s101, 0
  s_lshl_b32 s20, s101, 4
  s_lshr_b32 s21, s2, 3
  s_add_u32 s21, s21, s16
  s_and_b32 s21, s21, 3
  s_lshl_b32 s21, s21, 2
  s_add_u32 s20, s20, s21
  s_mul_i32 s21, s20, 14336
  s_add_u32 s21, s21, 655360
  s_add_u32 s22, s21, 0
  buffer_load_dwordx4 a[0:3], v2, s[8:11], s22 offen offset:0 sc1
  buffer_load_dwordx4 a[4:7], v2, s[8:11], s22 offen offset:1024 sc1
  buffer_load_dwordx4 a[8:11], v2, s[8:11], s22 offen offset:2048 sc1
  buffer_load_dwordx4 a[12:15], v2, s[8:11], s22 offen offset:3072 sc1
  s_add_u32 s22, s21, 4096
  buffer_load_dwordx4 a[16:19], v2, s[8:11], s22 offen offset:0 sc1
  buffer_load_dwordx4 a[20:23], v2, s[8:11], s22 offen offset:1024 sc1
  buffer_load_dwordx4 a[24:27], v2, s[8:11], s22 offen offset:2048 sc1
  buffer_load_dwordx4 a[28:31], v2, s[8:11], s22 offen offset:3072 sc1
  s_add_u32 s22, s21, 8192
  buffer_load_dwordx4 a[32:35], v2, s[8:11], s22 offen offset:0 sc1
  buffer_load_dwordx4 a[36:39], v2, s[8:11], s22 offen offset:1024 sc1
  buffer_load_dwordx4 a[40:43], v2, s[8:11], s22 offen offset:2048 sc1
  buffer_load_dwordx4 a[44:47], v2, s[8:11], s22 offen offset:3072 sc1
  s_add_u32 s22, s21, 12288
  buffer_load_dwordx4 a[48:51], v2, s[8:11], s22 offen offset:0 sc1
  buffer_load_dwordx4 a[52:55], v2, s[8:11], s22 offen offset:1024 sc1
  buffer_load_dwordx4 a[56:59], v2, s[8:11], s22 offen offset:2048 sc1
  buffer_load_dwordx4 a[60:63], v2, s[8:11], s22 offen offset:3072 sc1
  s_add_u32 s22, s21, 16384
  buffer_load_dwordx4 a[64:67], v2, s[8:11], s22 offen offset:0 sc1
  buffer_load_dwordx4 a[68:71], v2, s[8:11], s22 offen offset:1024 sc1
  buffer_load_dwordx4 a[72:75], v2, s[8:11], s22 offen offset:2048 sc1
  buffer_load_dwordx4 a[76:79], v2, s[8:11], s22 offen offset:3072 sc1
  s_add_u32 s22, s21, 20480
  buffer_load_dwordx4 a[80:83], v2, s[8:11], s22 offen offset:0 sc1
  buffer_load_dwordx4 a[84:87], v2, s[8:11], s22 offen offset:1024 sc1
  buffer_load_dwordx4 a[88:91], v2, s[8:11], s22 offen offset:2048 sc1
  buffer_load_dwordx4 a[92:95], v2, s[8:11], s22 offen offset:3072 sc1
  s_add_u32 s22, s21, 24576
  buffer_load_dwordx4 a[96:99], v2, s[8:11], s22 offen offset:0 sc1
  buffer_load_dwordx4 a[100:103], v2, s[8:11], s22 offen offset:1024 sc1
  buffer_load_dwordx4 a[104:107], v2, s[8:11], s22 offen offset:2048 sc1
  buffer_load_dwordx4 a[108:111], v2, s[8:11], s22 offen offset:3072 sc1
  s_add_u32 s22, s21, 28672
  buffer_load_dwordx4 a[112:115], v2, s[8:11], s22 offen offset:0 sc1
  buffer_load_dwordx4 a[116:119], v2, s[8:11], s22 offen offset:1024 sc1
  buffer_load_dwordx4 a[120:123], v2, s[8:11], s22 offen offset:2048 sc1
  buffer_load_dwordx4 a[124:127], v2, s[8:11], s22 offen offset:3072 sc1
  s_add_u32 s22, s21, 32768
  buffer_load_dwordx4 a[128:131], v2, s[8:11], s22 offen offset:0 sc1
  buffer_load_dwordx4 a[132:135], v2, s[8:11], s22 offen offset:1024 sc1
  buffer_load_dwordx4 a[136:139], v2, s[8:11], s22 offen offset:2048 sc1
  buffer_load_dwordx4 a[140:143], v2, s[8:11], s22 offen offset:3072 sc1
  s_add_u32 s22, s21, 36864
  buffer_load_dwordx4 a[144:147], v2, s[8:11], s22 offen offset:0 sc1
  buffer_load_dwordx4 a[148:151], v2, s[8:11], s22 offen offset:1024 sc1
  buffer_load_dwordx4 a[152:155], v2, s[8:11], s22 offen offset:2048 sc1
  buffer_load_dwordx4 a[156:159], v2, s[8:11], s22 offen offset:3072 sc1
  s_add_u32 s22, s21, 40960
  s_waitcnt vmcnt(40)
  buffer_load_dwordx4 a[160:163], v2, s[8:11], s22 offen offset:0 sc1
  buffer_load_dwordx4 a[164:167], v2, s[8:11], s22 offen offset:1024 sc1
  buffer_load_dwordx4 a[168:171], v2, s[8:11], s22 offen offset:2048 sc1
  buffer_load_dwordx4 a[172:175], v2, s[8:11], s22 offen offset:3072 sc1
  s_add_u32 s22, s21, 45056
  buffer_load_dwordx4 a[176:179], v2, s[8:11], s22 offen offset:0 sc1
  buffer_load_dwordx4 a[180:183], v2, s[8:11], s22 offen offset:1024 sc1
  buffer_load_dwordx4 a[184:187], v2, s[8:11], s22 offen offset:2048 sc1
  buffer_load_dwordx4 a[188:191], v2, s[8:11], s22 offen offset:3072 sc1
  s_add_u32 s22, s21, 49152
  buffer_load_dwordx4 a[192:195], v2, s[8:11], s22 offen offset:0 sc1
  buffer_load_dwordx4 a[196:199], v2, s[8:11], s22 offen offset:1024 sc1
  buffer_load_dwordx4 a[200:203], v2, s[8:11], s22 offen offset:2048 sc1
  buffer_load_dwordx4 a[204:207], v2, s[8:11], s22 offen offset:3072 sc1
  s_add_u32 s22, s21, 53248
  buffer_load_dwordx4 a[208:211], v2, s[8:11], s22 offen offset:0 sc1
  buffer_load_dwordx4 a[212:215], v2, s[8:11], s22 offen offset:1024 sc1
  buffer_load_dwordx4 a[216:219], v2, s[8:11], s22 offen offset:2048 sc1
  buffer_load_dwordx4 a[220:223], v2, s[8:11], s22 offen offset:3072 sc1
  s_mov_b32 s39, 0xffff0000
  s_branch wp_all
wp_bad:
  s_and_b32 s39, s39, 0xffff0000
  s_mov_b32 s97, 1
  s_cmp_eq_u32 s34, 1
  s_cbranch_scc1 wp_rep
  s_cmp_eq_u32 s34, 3
  s_cbranch_scc1 cA_abort
  s_load_dwordx8 s[40:47], s[0:1], 72
  s_load_dwordx4 s[48:51], s[0:1], 56
  s_waitcnt lgkmcnt(0)
  v_mov_b32 v4, 0x10001
  s_mov_b32 s18, 1
  s_branch ch_take
wp_rep:
  s_mov_b32 s101, -1
  s_load_dwordx8 s[40:47], s[0:1], 72
  s_load_dwordx4 s[48:51], s[0:1], 56
  s_waitcnt vmcnt(0) lgkmcnt(0)
  v_mov_b32 v4, 1
  v_mov_b32 v5, 20
  v_mov_b32 v6, 160000
  s_barrier
  s_cmp_lg_u32 s16, 0
  s_cbranch_scc1 wp_el1
  s_mov_b64 exec, 1
  buffer_atomic_add v4, v5, s[12:15], 0 offen sc0
  s_waitcnt vmcnt(0)
  ds_write_b32 v6, v4
  s_waitcnt lgkmcnt(0)
  s_mov_b64 exec, -1
wp_el1:
  s_barrier
  ds_read_b32 v4, v6
  s_waitcnt lgkmcnt(0)
  v_readfirstlane_b32 s33, v4
  v_and_b32 v1, 63, v0
  v_lshlrev_b32 v2, 4, v1
  v_lshrrev_b32 v3, 4, v1
  v_and_b32 v4, 15, v1
  v_lshrrev_b32 v5, 5, v1
  v_and_b32 v6, 31, v1
  v_xor_b32 v8, v6, v5
  v_lshlrev_b32 v8, 4, v8
  v_lshl_add_u32 v16, v5, 13, v8
  v_xor_b32 v17, 32, v16
  v_xor_b32 v18, 64, v16
  v_xor_b32 v19, 96, v16
  v_xor_b32 v20, 128, v16
  v_xor_b32 v21, 160, v16
  v_xor_b32 v22, 192, v16
  v_xor_b32 v23, 224, v16
  s_lshl_b32 s20, s16, 6
  v_xor_b32 v26, s20, v16
  v_xor_b32 v27, 32, v26
  s_and_b32 s33, s33, 511
  s_and_b32 s20, s33, 255
  s_cmp_ge_u32 s20, 224
  s_cselect_b32 s97, 1, 2
  s_cbranch_scc1 wp_all
  s_mul_i32 s17, s20, 4682
  s_lshr_b32 s17, s17, 16
  s_mul_i32 s23, s17, 14
  s_sub_u32 s19, s20, s23
  s_cmp_lt_u32 s19, 7
  s_cselect_b32 s18, 0, 7
  s_cselect_b32 s28, 0, 8
  s_sub_u32 s18, s19, s18
  s_add_u32 s28, s28, s16
  s_lshl_b32 s25, s16, 15
  s_add_u32 s25, s25, 32768
  s_lshl_b32 s26, s17, 9
  s_lshl_b32 s20, s17, 7
  s_lshr_b32 s21, s33, 8
  s_lshl_b32 s21, s21, 11
  s_add_u32 s20, s20, s21
  s_add_u32 s20, s20, 582144
  buffer_load_dword v5, off, s[8:11], s20 sc1
  s_waitcnt vmcnt(0)
  v_readfirstlane_b32 s34, v5
  v_mov_b32 v6, 160032
  s_nop 0
  v_mov_b32 v7, s34
  s_barrier
  s_cmp_lg_u32 s16, 0
  s_cbranch_scc1 uni_8
  ds_write_b32 v6, v7
  s_waitcnt lgkmcnt(0)
uni_8:
  s_barrier
  ds_read_b32 v7, v6
  s_waitcnt lgkmcnt(0)
  v_readfirstlane_b32 s34, v7
  s_cmp_lt_u32 s33, 256
  s_cselect_b32 s20, 0, 1935
  s_or_b32 s34, s34, s20
  s_bitcmp1_b32 s34, s19
  s_cbranch_scc1 wp_rep
  s_barrier
  s_cmp_lt_u32 s33, 256
  s_cbranch_scc1 wp_B
  s_branch wp_A0
wp_done:
  s_mov_b32 s97, s39
  s_cmp_lg_u32 s96, 0
  s_cbranch_scc1 wk_next
  s_cmp_lg_u32 s16, 0
  s_cbranch_scc1 ask_9
  v_mov_b32 v250, 1
  v_mov_b32 v251, 588288
  s_mov_b64 exec, 1
  buffer_atomic_add v250, v251, s[8:11], 0 offen sc0
  s_mov_b64 exec, -1
ask_9:
  s_branch wk_next
wk_loop:
  s_waitcnt vmcnt(0) lgkmcnt(0)
  s_getreg_b32 s22, hwreg(HW_REG_XCC_ID)
  s_and_b32 s22, s22, 15
  s_bitcmp0_b32 4, s22
  s_cbranch_scc1 wk_ni
  s_cmp_ge_u32 s96, 6
  s_cbranch_scc1 wk_ni
  s_mov_b32 s96, 6
  v_mov_b32 v4, 1
  v_mov_b32 v5, 587520
  v_mov_b32 v6, 160000
  s_barrier
  s_cmp_lg_u32 s16, 0
  s_cbranch_scc1 wk_ide1
  s_mov_b64 exec, 1
  buffer_atomic_add v4, v5, s[8:11], 0 offen sc0
  s_waitcnt vmcnt(0)
  ds_write_b32 v6, v4
  s_waitcnt lgkmcnt(0)
  s_mov_b64 exec, -1
wk_ide1:
  s_barrier
  ds_read_b32 v4, v6
  s_waitcnt lgkmcnt(0)
  v_readfirstlane_b32 s3, v4
  s_cmp_lt_u32 s3, 32
  s_cbranch_scc1 wk_done
wk_ni:
  s_getreg_b32 s22, hwreg(HW_REG_XCC_ID)
  s_and_b32 s22, s22, 15
  s_cmp_lg_u32 s22, 15
  s_cbranch_scc1 wk_ask
  s_cmp_eq_u32 s96, 7
  s_cbranch_scc0 wk_srv
wk_ask:
  v_readfirstlane_b32 s22, v250
  s_cmp_ge_u32 s22, 1264
  s_cbranch_scc1 wk_next
  s_cmp_lg_u32 s16, 0
  s_cbranch_scc1 ask_10
  v_mov_b32 v250, 1
  v_mov_b32 v251, 588288
  s_mov_b64 exec, 1
  buffer_atomic_add v250, v251, s[8:11], 0 offen sc0
  s_mov_b64 exec, -1
ask_10:
wk_next:
  v_mov_b32 v6, 160000
  s_waitcnt vmcnt(0)
  s_barrier
  s_cmp_lg_u32 s16, 0
  s_cbranch_scc1 wk_n1
  s_mov_b64 exec, 1
  ds_write_b32 v6, v250
  s_mov_b64 exec, -1
  s_waitcnt lgkmcnt(0)
wk_n1:
  s_barrier
  ds_read_b32 v4, v6
  s_waitcnt lgkmcnt(0)
  v_readfirstlane_b32 s3, v4
  s_cmp_ge_u32 s3, 1264
  s_cbranch_scc1 wk_done
  v_mov_b32 v250, 0
  v_mov_b32 v251, 587264
  s_cmp_lg_u32 s3, 1263
  s_cbranch_scc1 wk_nl
  v_mov_b32 v5, 1264
  s_mov_b64 exec, 1
  buffer_store_dword v5, v251, s[8:11], 0 offen sc1
  s_mov_b64 exec, -1
wk_nl:
  v_and_b32 v1, 63, v0
  v_lshlrev_b32 v2, 4, v1
  v_lshrrev_b32 v3, 4, v1
  v_and_b32 v4, 15, v1
  s_cmp_lt_u32 s3, 112
  s_cbranch_scc1 wk_n2
  s_cmp_eq_u32 s97, 0
  s_cbranch_scc1 wk_n2
  v_mov_b32 v250, s3
  s_mov_b32 s96, 1
  s_mov_b32 s97, 1
  s_mov_b32 s39, 0
  s_mov_b32 s37, 0
  s_mov_b32 s38, 0
  s_mov_b32 s32, 0
  s_branch wp_all
wk_n2:
  s_sub_u32 s20, s3, 288
  s_cmp_ge_u32 s20, 352
  s_cbranch_scc1 wk_nr
  s_cmp_ge_u32 s20, 320
  s_cbranch_scc1 wk_srv
  s_add_u32 s3, s3, 32
wk_nr:
  s_cmp_ge_u32 s3, 752
  s_cbranch_scc1 wk_tok
  s_cmp_ge_u32 s3, 640
  s_cbranch_scc1 wk_s4d
  s_cmp_ge_u32 s3, 448
  s_cbranch_scc1 wk_full
  s_cmp_ge_u32 s3, 320
  s_cbranch_scc1 wk_adef
  s_cmp_ge_u32 s3, 288
  s_cbranch_scc1 wk_srv
  s_and_b32 s17, s3, 15
  s_add_u32 s17, s17, 16
  s_cmp_ge_u32 s3, 224
  s_cbranch_scc1 wk_half
  s_cmp_ge_u32 s3, 112
  s_cselect_b32 s18, 1, 0
  s_cselect_b32 s20, 112, 0
  s_sub_u32 s34, s3, s20
  s_lshr_b32 s34, s34, 4
  s_lshl_b32 s34, s34, 1
  s_add_u32 s35, s34, 2
  s_branch wk_gemm
wk_adef:
  s_mov_b32 s101, -1
  s_load_dwordx8 s[40:47], s[0:1], 72
  s_sub_u32 s20, s3, 320
  s_getreg_b32 s33, hwreg(HW_REG_XCC_ID)
  s_sub_u32 s33, s33, 4
  s_and_b32 s33, s33, 7
  s_min_u32 s33, s33, 7
  s_mov_b32 s35, 7
wk_adc:
  s_lshl_b32 s34, s33, 7
  s_add_u32 s34, s34, 589312
  v_mov_b32 v4, 1
  v_mov_b32 v5, s34
  v_mov_b32 v6, 160000
  s_barrier
  s_cmp_lg_u32 s16, 0
  s_cbranch_scc1 wk_ade1
  s_mov_b64 exec, 1
  buffer_atomic_add v4, v5, s[8:11], 0 offen sc0
  s_waitcnt vmcnt(0)
  ds_write_b32 v6, v4
  s_waitcnt lgkmcnt(0)
  s_mov_b64 exec, -1
wk_ade1:
  s_barrier
  ds_read_b32 v4, v6
  s_waitcnt lgkmcnt(0)
  v_readfirstlane_b32 s20, v4
  s_cmp_lt_u32 s20, 16
  s_cbranch_scc1 wk_adg
  s_mov_b32 s33, s35
  s_sub_u32 s35, s35, 1
  s_max_i32 s35, s35, 0
  s_branch wk_adc
wk_adg:
  s_lshl_b32 s33, s33, 4
  s_add_u32 s20, s20, s33
  v_and_b32 v1, 63, v0
  v_lshlrev_b32 v2, 4, v1
  v_lshrrev_b32 v3, 4, v1
  v_and_b32 v4, 15, v1
  s_lshr_b32 s33, s20, 2
  s_mul_i32 s33, s33, 7
  s_and_b32 s20, s20, 3
  s_add_u32 s33, s33, s20
  s_mov_b32 s97, 3
  v_mov_b32 v252, 0x40000000
  v_cmp_eq_u32 vcc, 0, v0
  s_nop 1
  v_cndmask_b32 v252, v252, v0, vcc
  v_lshrrev_b32 v5, 5, v1
  v_and_b32 v6, 31, v1
  v_xor_b32 v8, v6, v5
  v_lshlrev_b32 v8, 4, v8
  v_lshl_add_u32 v16, v5, 13, v8
  v_xor_b32 v17, 32, v16
  v_xor_b32 v18, 64, v16
  v_xor_b32 v19, 96, v16
  v_xor_b32 v20, 128, v16
  v_xor_b32 v21, 160, v16
  v_xor_b32 v22, 192, v16
  v_xor_b32 v23, 224, v16
  s_lshl_b32 s20, s16, 6
  v_xor_b32 v26, s20, v16
  v_xor_b32 v27, 32, v26
  s_mul_i32 s17, s33, 4682
  s_lshr_b32 s17, s17, 16
  s_mul_i32 s23, s17, 14
  s_sub_u32 s19, s33, s23
  s_cmp_lt_u32 s19, 7
  s_cselect_b32 s18, 0, 7
  s_cselect_b32 s28, 0, 8
  s_sub_u32 s18, s19, s18
  s_add_u32 s28, s28, s16
  s_lshl_b32 s25, s16, 15
  s_add_u32 s25, s25, 32768
  s_lshl_b32 s26, s17, 9
  s_waitcnt lgkmcnt(0)
  s_barrier
  s_branch wp_A0
wk_adone:
  s_mov_b32 s97, 0
  s_branch wk_loop
wk_half:
  s_sub_u32 s20, s3, 224
  s_lshr_b32 s18, s20, 5
  s_add_u32 s18, s18, 2
  s_bitcmp1_b32 s20, 4
  s_cselect_b32 s34, 7, 0
  s_add_u32 s35, s34, 7
  s_branch wk_gemm
wk_full:
  s_sub_u32 s20, s3, 384
  s_and_b32 s17, s20, 15
  s_lshr_b32 s18, s20, 4
  s_mov_b32 s34, 0
  s_mov_b32 s35, 14
  s_cmp_lt_u32 s18, 8
  s_cselect_b32 s21, 16, 0
  s_add_u32 s17, s17, s21
  s_and_b32 s18, s18, 7
  s_cmp_ge_u32 s17, 16
  s_cbranch_scc1 wk_gemm
  s_getreg_b32 s33, hwreg(HW_REG_XCC_ID)
  s_sub_u32 s33, s33, 4
  s_and_b32 s33, s33, 7
  s_min_u32 s33, s33, 7
  s_mov_b32 s35, 7
wk_fxc:
  s_lshl_b32 s34, s33, 7
  s_add_u32 s34, s34, 565312
  v_mov_b32 v4, 1
  v_mov_b32 v5, s34
  v_mov_b32 v6, 160000
  s_barrier
  s_cmp_lg_u32 s16, 0
  s_cbranch_scc1 wk_fxe1
  s_mov_b64 exec, 1
  buffer_atomic_add v4, v5, s[8:11], 0 offen sc0
  s_waitcnt vmcnt(0)
  ds_write_b32 v6, v4
  s_waitcnt lgkmcnt(0)
  s_mov_b64 exec, -1
wk_fxe1:
  s_barrier
  ds_read_b32 v4, v6
  s_waitcnt lgkmcnt(0)
  v_readfirstlane_b32 s20, v4
  s_cmp_lt_u32 s20, 16
  s_cbranch_scc1 wk_fxg
  s_mov_b32 s33, s35
  s_sub_u32 s35, s35, 1
  s_max_i32 s35, s35, 0
  s_branch wk_fxc
wk_fxg:
  s_lshl_b32 s33, s33, 4
  s_add_u32 s20, s20, s33
  v_and_b32 v1, 63, v0
  v_lshlrev_b32 v2, 4, v1
  v_lshrrev_b32 v3, 4, v1
  v_and_b32 v4, 15, v1
  s_lshr_b32 s17, s20, 4
  s_lshl_b32 s17, s17, 1
  s_and_b32 s21, s20, 1
  s_add_u32 s17, s17, s21
  s_bfe_u32 s18, s20, 0x30001
  s_mov_b32 s34, 0
  s_mov_b32 s35, 14
  s_load_dwordx8 s[40:47], s[0:1], 0
  s_load_dwordx2 s[48:49], s[0:1], 32
  s_sub_u32 s21, s3, 512
  v_min_u32 v12, 111, v0
  v_lshlrev_b32 v12, 7, v12
  v_min_u32 v13, 13, v0
  v_lshlrev_b32 v13, 7, v13
  s_mul_i32 s22, s21, 14336
  s_mul_i32 s21, s21, 1792
  s_waitcnt lgkmcnt(0)
  s_cmp_ge_u32 s16, 2
  s_cbranch_scc1 wk_up
  s_mov_b32 s60, s40
  s_and_b32 s61, s41, 0xffff
  s_mov_b32 s62, 1835008
  s_mov_b32 s63, 0x20000
  buffer_load_dword v14, v12, s[60:63], s22 offen
  s_mov_b32 s60, s42
  s_and_b32 s61, s43, 0xffff
  s_mov_b32 s62, 229376
  s_mov_b32 s63, 0x20000
  buffer_load_dword v14, v13, s[60:63], s21 offen
  s_mov_b32 s60, s44
  s_and_b32 s61, s45, 0xffff
  s_mov_b32 s62, 229376
  s_mov_b32 s63, 0x20000
  buffer_load_dword v14, v13, s[60:63], s21 offen
  s_mov_b32 s60, s46
  s_and_b32 s61, s47, 0xffff
  s_mov_b32 s62, 229376
  s_mov_b32 s63, 0x20000
  buffer_load_dword v14, v13, s[60:63], s21 offen
  s_mov_b32 s60, s48
  s_and_b32 s61, s49, 0xffff
  s_mov_b32 s62, 229376
  s_mov_b32 s63, 0x20000
  buffer_load_dword v14, v13, s[60:63], s21 offen
wk_up:
  s_lshl_b32 s27, s17, 7
  s_add_u32 s27, s27, 584192
  s_mov_b32 s28, 16383
  s_mov_b32 s30, 0
wk_aw:
  buffer_load_dword v9, off, s[8:11], s27  sc1
  s_waitcnt vmcnt(0)
  v_and_b32 v10, s28, v9
  v_cmp_ne_u32 vcc, s28, v10
  s_cbranch_vccz wk_aw_ok
  s_sleep 3
  s_add_u32 s30, s30, 1
  s_cmp_lt_u32 s30, 400000
  s_cbranch_scc1 wk_aw
  s_branch cA_abort
wk_aw_ok:
wk_gemm:
  s_lshl_b32 s20, s18, 4
  s_lshr_b32 s21, s2, 3
  s_add_u32 s21, s21, s16
  s_and_b32 s21, s21, 3
  s_lshl_b32 s21, s21, 2
  s_add_u32 s20, s20, s21
  s_mul_i32 s21, s20, 14336
  s_add_u32 s21, s21, 655360
  s_mul_i32 s23, s17, 401408
  s_and_b32 s22, s16, 1
  s_mul_i32 s22, s22, 7168
  s_add_u32 s23, s23, s22
  s_add_u32 s23, s23, 33554432
  s_lshr_b32 s22, s16, 1
  s_mul_i32 s22, s22, 14336
  s_add_u32 s23, s23, s22
  s_mul_i32 s27, s16, 7168
  s_lshr_b32 s28, s20, 1
  s_cmp_lt_u32 s17, 16
  s_cbranch_scc0 wg_vo
  s_add_u32 s23, s23, s22
  s_lshl_b32 s29, s28, 4
  s_add_u32 s29, s29, s17
  s_mul_i32 s29, s29, 28672
  s_add_u32 s29, s29, 46399488
  s_mov_b32 s31, 0
  s_lshr_b32 s24, s34, 1
  s_lshl_b32 s24, s24, 2
  s_and_b32 s25, s34, 1
  s_add_u32 s24, s24, s25
  s_mul_i32 s24, s24, 14336
  s_add_u32 s24, s24, s23
  s_add_u32 m0, s31, s27
  s_nop 0
  buffer_load_dwordx4 v2, s[8:11], s24 offen offset:0 sc1 lds
  buffer_load_dwordx4 v2, s[8:11], s24 offen offset:1024 sc1 lds
  buffer_load_dwordx4 v2, s[8:11], s24 offen offset:2048 sc1 lds
  buffer_load_dwordx4 v2, s[8:11], s24 offen offset:3072 sc1 lds
  s_add_u32 m0, m0, 4096
  s_add_u32 s24, s24, 4096
  buffer_load_dwordx4 v2, s[8:11], s24 offen offset:0 sc1 lds
  buffer_load_dwordx4 v2, s[8:11], s24 offen offset:1024 sc1 lds
  buffer_load_dwordx4 v2, s[8:11], s24 offen offset:2048 sc1 lds
  s_sub_u32 s36, s35, 1
  s_add_u32 s30, s34, 1
  s_min_u32 s30, s30, s36
  s_mov_b32 s31, 28672
  s_lshr_b32 s24, s30, 1
  s_lshl_b32 s24, s24, 2
  s_and_b32 s25, s30, 1
  s_add_u32 s24, s24, s25
  s_mul_i32 s24, s24, 14336
  s_add_u32 s24, s24, s23
  s_add_u32 m0, s31, s27
  s_nop 0
  buffer_load_dwordx4 v2, s[8:11], s24 offen offset:0 sc1 lds
  buffer_load_dwordx4 v2, s[8:11], s24 offen offset:1024 sc1 lds
  buffer_load_dwordx4 v2, s[8:11], s24 offen offset:2048 sc1 lds
  buffer_load_dwordx4 v2, s[8:11], s24 offen offset:3072 sc1 lds
  s_add_u32 m0, m0, 4096
  s_add_u32 s24, s24, 4096
  buffer_load_dwordx4 v2, s[8:11], s24 offen offset:0 sc1 lds
  buffer_load_dwordx4 v2, s[8:11], s24 offen offset:1024 sc1 lds
  buffer_load_dwordx4 v2, s[8:11], s24 offen offset:2048 sc1 lds
  s_mov_b32 s19, s34
  s_mov_b32 s32, 0
  s_mov_b32 s33, 57344
  s_cmp_eq_u32 s18, s101
  s_cbranch_scc1 wg_f_hx
  s_add_u32 s22, s21, 0
  buffer_load_dwordx4 a[0:3], v2, s[8:11], s22 offen offset:0 sc1
  buffer_load_dwordx4 a[4:7], v2, s[8:11], s22 offen offset:1024 sc1
  buffer_load_dwordx4 a[8:11], v2, s[8:11], s22 offen offset:2048 sc1
  buffer_load_dwordx4 a[12:15], v2, s[8:11], s22 offen offset:3072 sc1
  s_add_u32 s22, s21, 4096
  buffer_load_dwordx4 a[16:19], v2, s[8:11], s22 offen offset:0 sc1
  buffer_load_dwordx4 a[20:23], v2, s[8:11], s22 offen offset:1024 sc1
  buffer_load_dwordx4 a[24:27], v2, s[8:11], s22 offen offset:2048 sc1
  buffer_load_dwordx4 a[28:31], v2, s[8:11], s22 offen offset:3072 sc1
  s_add_u32 s22, s21, 8192
  buffer_load_dwordx4 a[32:35], v2, s[8:11], s22 offen offset:0 sc1
  buffer_load_dwordx4 a[36:39], v2, s[8:11], s22 offen offset:1024 sc1
  buffer_load_dwordx4 a[40:43], v2, s[8:11], s22 offen offset:2048 sc1
  buffer_load_dwordx4 a[44:47], v2, s[8:11], s22 offen offset:3072 sc1
  s_add_u32 s22, s21, 12288
  buffer_load_dwordx4 a[48:51], v2, s[8:11], s22 offen offset:0 sc1
  buffer_load_dwordx4 a[52:55], v2, s[8:11], s22 offen offset:1024 sc1
  buffer_load_dwordx4 a[56:59], v2, s[8:11], s22 offen offset:2048 sc1
  buffer_load_dwordx4 a[60:63], v2, s[8:11], s22 offen offset:3072 sc1
  s_add_u32 s22, s21, 16384
  buffer_load_dwordx4 a[64:67], v2, s[8:11], s22 offen offset:0 sc1
  buffer_load_dwordx4 a[68:71], v2, s[8:11], s22 offen offset:1024 sc1
  buffer_load_dwordx4 a[72:75], v2, s[8:11], s22 offen offset:2048 sc1
  buffer_load_dwordx4 a[76:79], v2, s[8:11], s22 offen offset:3072 sc1
  s_add_u32 s22, s21, 20480
  buffer_load_dwordx4 a[80:83], v2, s[8:11], s22 offen offset:0 sc1
  buffer_load_dwordx4 a[84:87], v2, s[8:11], s22 offen offset:1024 sc1
  buffer_load_dwordx4 a[88:91], v2, s[8:11], s22 offen offset:2048 sc1
  buffer_load_dwordx4 a[92:95], v2, s[8:11], s22 offen offset:3072 sc1
  s_add_u32 s22, s21, 24576
  buffer_load_dwordx4 a[96:99], v2, s[8:11], s22 offen offset:0 sc1
  buffer_load_dwordx4 a[100:103], v2, s[8:11], s22 offen offset:1024 sc1
  buffer_load_dwordx4 a[104:107], v2, s[8:11], s22 offen offset:2048 sc1
  buffer_load_dwordx4 a[108:111], v2, s[8:11], s22 offen offset:3072 sc1
  s_add_u32 s22, s21, 28672
  buffer_load_dwordx4 a[112:115], v2, s[8:11], s22 offen offset:0 sc1
  buffer_load_dwordx4 a[116:119], v2, s[8:11], s22 offen offset:1024 sc1
  buffer_load_dwordx4 a[120:123], v2, s[8:11], s22 offen offset:2048 sc1
  buffer_load_dwordx4 a[124:127], v2, s[8:11], s22 offen offset:3072 sc1
  s_add_u32 s22, s21, 32768
  buffer_load_dwordx4 a[128:131], v2, s[8:11], s22 offen offset:0 sc1
  buffer_load_dwordx4 a[132:135], v2, s[8:11], s22 offen offset:1024 sc1
  buffer_load_dwordx4 a[136:139], v2, s[8:11], s22 offen offset:2048 sc1
  buffer_load_dwordx4 a[140:143], v2, s[8:11], s22 offen offset:3072 sc1
  s_add_u32 s22, s21, 36864
  buffer_load_dwordx4 a[144:147], v2, s[8:11], s22 offen offset:0 sc1
  buffer_load_dwordx4 a[148:151], v2, s[8:11], s22 offen offset:1024 sc1
  buffer_load_dwordx4 a[152:155], v2, s[8:11], s22 offen offset:2048 sc1
  buffer_load_dwordx4 a[156:159], v2, s[8:11], s22 offen offset:3072 sc1
  s_add_u32 s22, s21, 40960
  s_waitcnt vmcnt(40)
  buffer_load_dwordx4 a[160:163], v2, s[8:11], s22 offen offset:0 sc1
  buffer_load_dwordx4 a[164:167], v2, s[8:11], s22 offen offset:1024 sc1
  buffer_load_dwordx4 a[168:171], v2, s[8:11], s22 offen offset:2048 sc1
  buffer_load_dwordx4 a[172:175], v2, s[8:11], s22 offen offset:3072 sc1
  s_add_u32 s22, s21, 45056
  buffer_load_dwordx4 a[176:179], v2, s[8:11], s22 offen offset:0 sc1
  buffer_load_dwordx4 a[180:183], v2, s[8:11], s22 offen offset:1024 sc1
  buffer_load_dwordx4 a[184:187], v2, s[8:11], s22 offen offset:2048 sc1
  buffer_load_dwordx4 a[188:191], v2, s[8:11], s22 offen offset:3072 sc1
  s_add_u32 s22, s21, 49152
  buffer_load_dwordx4 a[192:195], v2, s[8:11], s22 offen offset:0 sc1
  buffer_load_dwordx4 a[196:199], v2, s[8:11], s22 offen offset:1024 sc1
  buffer_load_dwordx4 a[200:203], v2, s[8:11], s22 offen offset:2048 sc1
  buffer_load_dwordx4 a[204:207], v2, s[8:11], s22 offen offset:3072 sc1
  s_add_u32 s22, s21, 53248
  buffer_load_dwordx4 a[208:211], v2, s[8:11], s22 offen offset:0 sc1
  buffer_load_dwordx4 a[212:215], v2, s[8:11], s22 offen offset:1024 sc1
  buffer_load_dwordx4 a[216:219], v2, s[8:11], s22 offen offset:2048 sc1
  buffer_load_dwordx4 a[220:223], v2, s[8:11], s22 offen offset:3072 sc1
wg_f_hx:
  s_mov_b32 s101, -1
  s_waitcnt vmcnt(0)
  s_barrier
  s_mov_b32 s40, 0
  s_mov_b32 s41, 0x40000000
  v_mov_b32 v5, v2
  ds_read_b128 v[8:11], v5 offset:0
  ds_read_b128 v[12:15], v5 offset:14336
  ds_read_b128 v[16:19], v5 offset:1024
  ds_read_b128 v[20:23], v5 offset:15360
  ds_read_b128 v[24:27], v5 offset:2048
  s_waitcnt lgkmcnt(4)
.p2align 6
wg_f_loop:
  v_mfma_f32_16x16x32_bf16 v[40:43], v[8:11], a[0:3], 0
  ds_read_b128 v[28:31], v5 offset:16384
  v_mfma_f32_16x16x32_bf16 v[44:47], v[8:11], a[56:59], 0
  v_mfma_f32_16x16x32_bf16 v[48:51], v[8:11], a[112:115], 0
  v_mfma_f32_16x16x32_bf16 v[52:55], v[8:11], a[168:171], 0
  s_waitcnt lgkmcnt(4)
  s_lshl_b32 s42, s40, 10
  v_mfma_f32_16x16x32_bf16 v[56:59], v[12:15], a[0:3], 0
  ds_read_b128 v[32:35], v5 offset:3072
  v_mfma_f32_16x16x32_bf16 v[60:63], v[12:15], a[56:59], 0
  s_add_u32 s42, s42, s41
  v_cvt_pk_bf16_f32 v72, v96, v97
  v_mfma_f32_16x16x32_bf16 v[64:67], v[12:15], a[112:115], 0
  v_cvt_pk_bf16_f32 v73, v98, v99
  v_cvt_pk_bf16_f32 v74, v112, v113
  v_mfma_f32_16x16x32_bf16 v[68:71], v[12:15], a[168:171], 0
  s_waitcnt lgkmcnt(4)
  v_cvt_pk_bf16_f32 v75, v114, v115
  v_mfma_f32_16x16x32_bf16 v[40:43], v[16:19], a[4:7], v[40:43]
  ds_read_b128 v[8:11], v5 offset:17408
  v_mfma_f32_16x16x32_bf16 v[44:47], v[16:19], a[60:63], v[44:47]
  s_add_u32 s43, s42, 0
  v_mfma_f32_16x16x32_bf16 v[48:51], v[16:19], a[116:119], v[48:51]
  buffer_store_dwordx4 v[72:75], v2, s[8:11], s43 offen sc1
  v_cvt_pk_bf16_f32 v76, v100, v101
  v_mfma_f32_16x16x32_bf16 v[52:55], v[16:19], a[172:175], v[52:55]
  s_waitcnt lgkmcnt(4)
  v_cvt_pk_bf16_f32 v77, v102, v103
  v_mfma_f32_16x16x32_bf16 v[56:59], v[20:23], a[4:7], v[56:59]
  ds_read_b128 v[12:15], v5 offset:4096
  v_mfma_f32_16x16x32_bf16 v[60:63], v[20:23], a[60:63], v[60:63]
  v_cvt_pk_bf16_f32 v78, v116, v117
  v_cvt_pk_bf16_f32 v79, v118, v119
  v_mfma_f32_16x16x32_bf16 v[64:67], v[20:23], a[116:119], v[64:67]
  s_add_u32 s43, s42, 14336
  v_mfma_f32_16x16x32_bf16 v[68:71], v[20:23], a[172:175], v[68:71]
  s_waitcnt lgkmcnt(4)
  buffer_store_dwordx4 v[76:79], v2, s[8:11], s43 offen sc1
  v_mfma_f32_16x16x32_bf16 v[40:43], v[24:27], a[8:11], v[40:43]
  ds_read_b128 v[16:19], v5 offset:18432
  v_mfma_f32_16x16x32_bf16 v[44:47], v[24:27], a[64:67], v[44:47]
  v_cvt_pk_bf16_f32 v80, v104, v105
  v_cvt_pk_bf16_f32 v81, v106, v107
  v_mfma_f32_16x16x32_bf16 v[48:51], v[24:27], a[120:123], v[48:51]
  v_cvt_pk_bf16_f32 v82, v120, v121
  v_cvt_pk_bf16_f32 v83, v122, v123
  v_mfma_f32_16x16x32_bf16 v[52:55], v[24:27], a[176:179], v[52:55]
  s_waitcnt lgkmcnt(4)
  s_add_u32 s43, s42, 458752
  v_mfma_f32_16x16x32_bf16 v[56:59], v[28:31], a[8:11], v[56:59]
  ds_read_b128 v[20:23], v5 offset:5120
  v_mfma_f32_16x16x32_bf16 v[60:63], v[28:31], a[64:67], v[60:63]
  buffer_store_dwordx4 v[80:83], v2, s[8:11], s43 offen sc1
  v_cvt_pk_bf16_f32 v84, v108, v109
  v_mfma_f32_16x16x32_bf16 v[64:67], v[28:31], a[120:123], v[64:67]
  v_cvt_pk_bf16_f32 v85, v110, v111
  v_cvt_pk_bf16_f32 v86, v124, v125
  v_mfma_f32_16x16x32_bf16 v[68:71], v[28:31], a[176:179], v[68:71]
  s_waitcnt lgkmcnt(4)
  v_cvt_pk_bf16_f32 v87, v126, v127
  v_mfma_f32_16x16x32_bf16 v[40:43], v[32:35], a[12:15], v[40:43]
  ds_read_b128 v[24:27], v5 offset:19456
  v_mfma_f32_16x16x32_bf16 v[44:47], v[32:35], a[68:71], v[44:47]
  s_add_u32 s43, s42, 473088
  v_mfma_f32_16x16x32_bf16 v[48:51], v[32:35], a[124:127], v[48:51]
  buffer_store_dwordx4 v[84:87], v2, s[8:11], s43 offen sc1
  v_mfma_f32_16x16x32_bf16 v[52:55], v[32:35], a[180:183], v[52:55]
  s_waitcnt lgkmcnt(4)
  s_add_u32 s30, s19, 2
  s_lshr_b32 s24, s30, 1
  s_lshl_b32 s24, s24, 2
  s_and_b32 s25, s30, 1
  s_add_u32 s24, s24, s25
  s_mul_i32 s24, s24, 14336
  v_mfma_f32_16x16x32_bf16 v[56:59], v[8:11], a[12:15], v[56:59]
  ds_read_b128 v[28:31], v5 offset:6144
  v_mfma_f32_16x16x32_bf16 v[60:63], v[8:11], a[68:71], v[60:63]
  s_add_u32 s24, s24, s23
  s_cmp_lt_u32 s30, s35
  s_cselect_b32 s24, s24, 0x40000000
  v_mfma_f32_16x16x32_bf16 v[64:67], v[8:11], a[124:127], v[64:67]
  s_add_u32 m0, s33, s27
  s_nop 0
  buffer_load_dwordx4 v2, s[8:11], s24 offen offset:0 sc1 lds
  v_mfma_f32_16x16x32_bf16 v[68:71], v[8:11], a[180:183], v[68:71]
  s_waitcnt lgkmcnt(4)
  v_mfma_f32_16x16x32_bf16 v[40:43], v[12:15], a[16:19], v[40:43]
  ds_read_b128 v[32:35], v5 offset:20480
  v_mfma_f32_16x16x32_bf16 v[44:47], v[12:15], a[72:75], v[44:47]
  v_mfma_f32_16x16x32_bf16 v[48:51], v[12:15], a[128:131], v[48:51]
  v_mfma_f32_16x16x32_bf16 v[52:55], v[12:15], a[184:187], v[52:55]
  s_waitcnt lgkmcnt(4)
  buffer_load_dwordx4 v2, s[8:11], s24 offen offset:1024 sc1 lds
  v_mfma_f32_16x16x32_bf16 v[56:59], v[16:19], a[16:19], v[56:59]
  ds_read_b128 v[8:11], v5 offset:7168
  v_mfma_f32_16x16x32_bf16 v[60:63], v[16:19], a[72:75], v[60:63]
  v_mfma_f32_16x16x32_bf16 v[64:67], v[16:19], a[128:131], v[64:67]
  v_mfma_f32_16x16x32_bf16 v[68:71], v[16:19], a[184:187], v[68:71]
  s_waitcnt lgkmcnt(4)
  v_mfma_f32_16x16x32_bf16 v[40:43], v[20:23], a[20:23], v[40:43]
  ds_read_b128 v[12:15], v5 offset:21504
  v_mfma_f32_16x16x32_bf16 v[44:47], v[20:23], a[76:79], v[44:47]
  buffer_load_dwordx4 v2, s[8:11], s24 offen offset:2048 sc1 lds
  v_mfma_f32_16x16x32_bf16 v[48:51], v[20:23], a[132:135], v[48:51]
  v_mfma_f32_16x16x32_bf16 v[52:55], v[20:23], a[188:191], v[52:55]
  s_waitcnt lgkmcnt(4)
  v_mfma_f32_16x16x32_bf16 v[56:59], v[24:27], a[20:23], v[56:59]
  ds_read_b128 v[16:19], v5 offset:8192
  v_mfma_f32_16x16x32_bf16 v[60:63], v[24:27], a[76:79], v[60:63]
  v_mfma_f32_16x16x32_bf16 v[64:67], v[24:27], a[132:135], v[64:67]
  buffer_load_dwordx4 v2, s[8:11], s24 offen offset:3072 sc1 lds
  v_mfma_f32_16x16x32_bf16 v[68:71], v[24:27], a[188:191], v[68:71]
  s_waitcnt lgkmcnt(4)
  v_mfma_f32_16x16x32_bf16 v[40:43], v[28:31], a[24:27], v[40:43]
  ds_read_b128 v[20:23], v5 offset:22528
  v_mfma_f32_16x16x32_bf16 v[44:47], v[28:31], a[80:83], v[44:47]
  v_mfma_f32_16x16x32_bf16 v[48:51], v[28:31], a[136:139], v[48:51]
  v_mfma_f32_16x16x32_bf16 v[52:55], v[28:31], a[192:195], v[52:55]
  s_waitcnt lgkmcnt(4)
  s_add_u32 m0, m0, 4096
  s_add_u32 s24, s24, 4096
  buffer_load_dwordx4 v2, s[8:11], s24 offen offset:0 sc1 lds
  v_mfma_f32_16x16x32_bf16 v[56:59], v[32:35], a[24:27], v[56:59]
  ds_read_b128 v[24:27], v5 offset:9216
  v_mfma_f32_16x16x32_bf16 v[60:63], v[32:35], a[80:83], v[60:63]
  v_mfma_f32_16x16x32_bf16 v[64:67], v[32:35], a[136:139], v[64:67]
  v_mfma_f32_16x16x32_bf16 v[68:71], v[32:35], a[192:195], v[68:71]
  s_waitcnt lgkmcnt(4)
  v_mfma_f32_16x16x32_bf16 v[40:43], v[8:11], a[28:31], v[40:43]
  ds_read_b128 v[28:31], v5 offset:23552
  v_mfma_f32_16x16x32_bf16 v[44:47], v[8:11], a[84:87], v[44:47]
  buffer_load_dwordx4 v2, s[8:11], s24 offen offset:1024 sc1 lds
  v_mfma_f32_16x16x32_bf16 v[48:51], v[8:11], a[140:143], v[48:51]
  v_mfma_f32_16x16x32_bf16 v[52:55], v[8:11], a[196:199], v[52:55]
  s_waitcnt lgkmcnt(4)
  v_mfma_f32_16x16x32_bf16 v[56:59], v[12:15], a[28:31], v[56:59]
  ds_read_b128 v[32:35], v5 offset:10240
  v_mfma_f32_16x16x32_bf16 v[60:63], v[12:15], a[84:87], v[60:63]
  v_mfma_f32_16x16x32_bf16 v[64:67], v[12:15], a[140:143], v[64:67]
  buffer_load_dwordx4 v2, s[8:11], s24 offen offset:2048 sc1 lds
  v_mfma_f32_16x16x32_bf16 v[68:71], v[12:15], a[196:199], v[68:71]
  s_waitcnt lgkmcnt(4)
  v_mfma_f32_16x16x32_bf16 v[40:43], v[16:19], a[32:35], v[40:43]
  ds_read_b128 v[8:11], v5 offset:24576
  v_mfma_f32_16x16x32_bf16 v[44:47], v[16:19], a[88:91], v[44:47]
  v_mfma_f32_16x16x32_bf16 v[48:51], v[16:19], a[144:147], v[48:51]
  v_mfma_f32_16x16x32_bf16 v[52:55], v[16:19], a[200:203], v[52:55]
  s_waitcnt lgkmcnt(4)
  s_add_u32 s33, s33, 28672
  s_cmp_eq_u32 s33, 114688
  s_cselect_b32 s33, 0, s33
  v_mfma_f32_16x16x32_bf16 v[56:59], v[20:23], a[32:35], v[56:59]
  ds_read_b128 v[12:15], v5 offset:11264
  v_mfma_f32_16x16x32_bf16 v[60:63], v[20:23], a[88:91], v[60:63]
  s_add_u32 s32, s32, 28672
  s_cmp_eq_u32 s32, 114688
  s_cselect_b32 s32, 0, s32
  v_mfma_f32_16x16x32_bf16 v[64:67], v[20:23], a[144:147], v[64:67]
  v_add_u32 v128, s32, v2
  v_mfma_f32_16x16x32_bf16 v[68:71], v[20:23], a[200:203], v[68:71]
  s_waitcnt lgkmcnt(4)
  v_mfma_f32_16x16x32_bf16 v[40:43], v[24:27], a[36:39], v[40:43]
  ds_read_b128 v[16:19], v5 offset:25600
  v_mfma_f32_16x16x32_bf16 v[44:47], v[24:27], a[92:95], v[44:47]
  v_mfma_f32_16x16x32_bf16 v[48:51], v[24:27], a[148:151], v[48:51]
  v_mfma_f32_16x16x32_bf16 v[52:55], v[24:27], a[204:207], v[52:55]
  s_waitcnt lgkmcnt(4)
  v_mfma_f32_16x16x32_bf16 v[56:59], v[28:31], a[36:39], v[56:59]
  ds_read_b128 v[20:23], v5 offset:12288
  v_mfma_f32_16x16x32_bf16 v[60:63], v[28:31], a[92:95], v[60:63]
  v_mfma_f32_16x16x32_bf16 v[64:67], v[28:31], a[148:151], v[64:67]
  v_mfma_f32_16x16x32_bf16 v[68:71], v[28:31], a[204:207], v[68:71]
  s_waitcnt lgkmcnt(4)
  v_mfma_f32_16x16x32_bf16 v[40:43], v[32:35], a[40:43], v[40:43]
  ds_read_b128 v[24:27], v5 offset:26624
  v_mfma_f32_16x16x32_bf16 v[44:47], v[32:35], a[96:99], v[44:47]
  v_mfma_f32_16x16x32_bf16 v[48:51], v[32:35], a[152:155], v[48:51]
  v_mfma_f32_16x16x32_bf16 v[52:55], v[32:35], a[208:211], v[52:55]
  s_waitcnt lgkmcnt(4)
  v_mfma_f32_16x16x32_bf16 v[56:59], v[8:11], a[40:43], v[56:59]
  ds_read_b128 v[28:31], v5 offset:13312
  v_mfma_f32_16x16x32_bf16 v[60:63], v[8:11], a[96:99], v[60:63]
  v_mfma_f32_16x16x32_bf16 v[64:67], v[8:11], a[152:155], v[64:67]
  v_mfma_f32_16x16x32_bf16 v[68:71], v[8:11], a[208:211], v[68:71]
  s_waitcnt lgkmcnt(4)
  v_mfma_f32_16x16x32_bf16 v[40:43], v[12:15], a[44:47], v[40:43]
  ds_read_b128 v[32:35], v5 offset:27648
  v_mfma_f32_16x16x32_bf16 v[44:47], v[12:15], a[100:103], v[44:47]
  v_mfma_f32_16x16x32_bf16 v[48:51], v[12:15], a[156:159], v[48:51]
  v_mfma_f32_16x16x32_bf16 v[52:55], v[12:15], a[212:215], v[52:55]
  s_waitcnt lgkmcnt(4)
  v_mfma_f32_16x16x32_bf16 v[56:59], v[16:19], a[44:47], v[56:59]
  s_waitcnt vmcnt(11)
  s_barrier
  ds_read_b128 v[8:11], v128 offset:0
  v_mfma_f32_16x16x32_bf16 v[60:63], v[16:19], a[100:103], v[60:63]
  v_mfma_f32_16x16x32_bf16 v[64:67], v[16:19], a[156:159], v[64:67]
  v_mfma_f32_16x16x32_bf16 v[68:71], v[16:19], a[212:215], v[68:71]
  s_waitcnt lgkmcnt(4)
  v_mfma_f32_16x16x32_bf16 v[40:43], v[20:23], a[48:51], v[40:43]
  ds_read_b128 v[12:15], v128 offset:14336
  v_mfma_f32_16x16x32_bf16 v[44:47], v[20:23], a[104:107], v[44:47]
  v_mfma_f32_16x16x32_bf16 v[48:51], v[20:23], a[160:163], v[48:51]
  v_mfma_f32_16x16x32_bf16 v[52:55], v[20:23], a[216:219], v[52:55]
  s_waitcnt lgkmcnt(4)
  v_mfma_f32_16x16x32_bf16 v[56:59], v[24:27], a[48:51], v[56:59]
  ds_read_b128 v[16:19], v128 offset:1024
  v_mfma_f32_16x16x32_bf16 v[60:63], v[24:27], a[104:107], v[60:63]
  v_mfma_f32_16x16x32_bf16 v[64:67], v[24:27], a[160:163], v[64:67]
  v_mfma_f32_16x16x32_bf16 v[68:71], v[24:27], a[216:219], v[68:71]
  s_waitcnt lgkmcnt(4)
  v_mfma_f32_16x16x32_bf16 v[40:43], v[28:31], a[52:55], v[40:43]
  ds_read_b128 v[20:23], v128 offset:15360
  v_mfma_f32_16x16x32_bf16 v[44:47], v[28:31], a[108:111], v[44:47]
  v_mfma_f32_16x16x32_bf16 v[48:51], v[28:31], a[164:167], v[48:51]
  v_mfma_f32_16x16x32_bf16 v[52:55], v[28:31], a[220:223], v[52:55]
  s_waitcnt lgkmcnt(4)
  v_mfma_f32_16x16x32_bf16 v[56:59], v[32:35], a[52:55], v[56:59]
  ds_read_b128 v[24:27], v128 offset:2048
  v_mfma_f32_16x16x32_bf16 v[60:63], v[32:35], a[108:111], v[60:63]
  v_mfma_f32_16x16x32_bf16 v[64:67], v[32:35], a[164:167], v[64:67]
  v_mfma_f32_16x16x32_bf16 v[68:71], v[32:35], a[220:223], v[68:71]
  s_waitcnt lgkmcnt(4)
  s_mov_b32 s40, s19
  s_mov_b32 s41, s29
  s_add_u32 s19, s19, 1
  s_cmp_lt_u32 s19, s35
  s_cbranch_scc0 wg_f_e0
  v_mfma_f32_16x16x32_bf16 v[96:99], v[8:11], a[0:3], 0
  ds_read_b128 v[28:31], v128 offset:16384
  v_mfma_f32_16x16x32_bf16 v[100:103], v[8:11], a[56:59], 0
  v_mfma_f32_16x16x32_bf16 v[104:107], v[8:11], a[112:115], 0
  v_mfma_f32_16x16x32_bf16 v[108:111], v[8:11], a[168:171], 0
  s_waitcnt lgkmcnt(4)
  s_lshl_b32 s42, s40, 10
  v_mfma_f32_16x16x32_bf16 v[112:115], v[12:15], a[0:3], 0
  ds_read_b128 v[32:35], v128 offset:3072
  v_mfma_f32_16x16x32_bf16 v[116:119], v[12:15], a[56:59], 0
  s_add_u32 s42, s42, s41
  v_cvt_pk_bf16_f32 v72, v40, v41
  v_mfma_f32_16x16x32_bf16 v[120:123], v[12:15], a[112:115], 0
  v_cvt_pk_bf16_f32 v73, v42, v43
  v_cvt_pk_bf16_f32 v74, v56, v57
  v_mfma_f32_16x16x32_bf16 v[124:127], v[12:15], a[168:171], 0
  s_waitcnt lgkmcnt(4)
  v_cvt_pk_bf16_f32 v75, v58, v59
  v_mfma_f32_16x16x32_bf16 v[96:99], v[16:19], a[4:7], v[96:99]
  ds_read_b128 v[8:11], v128 offset:17408
  v_mfma_f32_16x16x32_bf16 v[100:103], v[16:19], a[60:63], v[100:103]
  s_add_u32 s43, s42, 0
  v_mfma_f32_16x16x32_bf16 v[104:107], v[16:19], a[116:119], v[104:107]
  buffer_store_dwordx4 v[72:75], v2, s[8:11], s43 offen sc1
  v_cvt_pk_bf16_f32 v76, v44, v45
  v_mfma_f32_16x16x32_bf16 v[108:111], v[16:19], a[172:175], v[108:111]
  s_waitcnt lgkmcnt(4)
  v_cvt_pk_bf16_f32 v77, v46, v47
  v_mfma_f32_16x16x32_bf16 v[112:115], v[20:23], a[4:7], v[112:115]
  ds_read_b128 v[12:15], v128 offset:4096
  v_mfma_f32_16x16x32_bf16 v[116:119], v[20:23], a[60:63], v[116:119]
  v_cvt_pk_bf16_f32 v78, v60, v61
  v_cvt_pk_bf16_f32 v79, v62, v63
  v_mfma_f32_16x16x32_bf16 v[120:123], v[20:23], a[116:119], v[120:123]
  s_add_u32 s43, s42, 14336
  v_mfma_f32_16x16x32_bf16 v[124:127], v[20:23], a[172:175], v[124:127]
  s_waitcnt lgkmcnt(4)
  buffer_store_dwordx4 v[76:79], v2, s[8:11], s43 offen sc1
  v_mfma_f32_16x16x32_bf16 v[96:99], v[24:27], a[8:11], v[96:99]
  ds_read_b128 v[16:19], v128 offset:18432
  v_mfma_f32_16x16x32_bf16 v[100:103], v[24:27], a[64:67], v[100:103]
  v_cvt_pk_bf16_f32 v80, v48, v49
  v_cvt_pk_bf16_f32 v81, v50, v51
  v_mfma_f32_16x16x32_bf16 v[104:107], v[24:27], a[120:123], v[104:107]
  v_cvt_pk_bf16_f32 v82, v64, v65
  v_cvt_pk_bf16_f32 v83, v66, v67
  v_mfma_f32_16x16x32_bf16 v[108:111], v[24:27], a[176:179], v[108:111]
  s_waitcnt lgkmcnt(4)
  s_add_u32 s43, s42, 458752
  v_mfma_f32_16x16x32_bf16 v[112:115], v[28:31], a[8:11], v[112:115]
  ds_read_b128 v[20:23], v128 offset:5120
  v_mfma_f32_16x16x32_bf16 v[116:119], v[28:31], a[64:67], v[116:119]
  buffer_store_dwordx4 v[80:83], v2, s[8:11], s43 offen sc1
  v_cvt_pk_bf16_f32 v84, v52, v53
  v_mfma_f32_16x16x32_bf16 v[120:123], v[28:31], a[120:123], v[120:123]
  v_cvt_pk_bf16_f32 v85, v54, v55
  v_cvt_pk_bf16_f32 v86, v68, v69
  v_mfma_f32_16x16x32_bf16 v[124:127], v[28:31], a[176:179], v[124:127]
  s_waitcnt lgkmcnt(4)
  v_cvt_pk_bf16_f32 v87, v70, v71
  v_mfma_f32_16x16x32_bf16 v[96:99], v[32:35], a[12:15], v[96:99]
  ds_read_b128 v[24:27], v128 offset:19456
  v_mfma_f32_16x16x32_bf16 v[100:103], v[32:35], a[68:71], v[100:103]
  s_add_u32 s43, s42, 473088
  v_mfma_f32_16x16x32_bf16 v[104:107], v[32:35], a[124:127], v[104:107]
  buffer_store_dwordx4 v[84:87], v2, s[8:11], s43 offen sc1
  v_mfma_f32_16x16x32_bf16 v[108:111], v[32:35], a[180:183], v[108:111]
  s_waitcnt lgkmcnt(4)
  s_add_u32 s30, s19, 2
  s_lshr_b32 s24, s30, 1
  s_lshl_b32 s24, s24, 2
  s_and_b32 s25, s30, 1
  s_add_u32 s24, s24, s25
  s_mul_i32 s24, s24, 14336
  v_mfma_f32_16x16x32_bf16 v[112:115], v[8:11], a[12:15], v[112:115]
  ds_read_b128 v[28:31], v128 offset:6144
  v_mfma_f32_16x16x32_bf16 v[116:119], v[8:11], a[68:71], v[116:119]
  s_add_u32 s24, s24, s23
  s_cmp_lt_u32 s30, s35
  s_cselect_b32 s24, s24, 0x40000000
  v_mfma_f32_16x16x32_bf16 v[120:123], v[8:11], a[124:127], v[120:123]
  s_add_u32 m0, s33, s27
  s_nop 0
  buffer_load_dwordx4 v2, s[8:11], s24 offen offset:0 sc1 lds
  v_mfma_f32_16x16x32_bf16 v[124:127], v[8:11], a[180:183], v[124:127]
  s_waitcnt lgkmcnt(4)
  v_mfma_f32_16x16x32_bf16 v[96:99], v[12:15], a[16:19], v[96:99]
  ds_read_b128 v[32:35], v128 offset:20480
  v_mfma_f32_16x16x32_bf16 v[100:103], v[12:15], a[72:75], v[100:103]
  v_mfma_f32_16x16x32_bf16 v[104:107], v[12:15], a[128:131], v[104:107]
  v_mfma_f32_16x16x32_bf16 v[108:111], v[12:15], a[184:187], v[108:111]
  s_waitcnt lgkmcnt(4)
  buffer_load_dwordx4 v2, s[8:11], s24 offen offset:1024 sc1 lds
  v_mfma_f32_16x16x32_bf16 v[112:115], v[16:19], a[16:19], v[112:115]
  ds_read_b128 v[8:11], v128 offset:7168
  v_mfma_f32_16x16x32_bf16 v[116:119], v[16:19], a[72:75], v[116:119]
  v_mfma_f32_16x16x32_bf16 v[120:123], v[16:19], a[128:131], v[120:123]
  v_mfma_f32_16x16x32_bf16 v[124:127], v[16:19], a[184:187], v[124:127]
  s_waitcnt lgkmcnt(4)
  v_mfma_f32_16x16x32_bf16 v[96:99], v[20:23], a[20:23], v[96:99]
  ds_read_b128 v[12:15], v128 offset:21504
  v_mfma_f32_16x16x32_bf16 v[100:103], v[20:23], a[76:79], v[100:103]
  buffer_load_dwordx4 v2, s[8:11], s24 offen offset:2048 sc1 lds
  v_mfma_f32_16x16x32_bf16 v[104:107], v[20:23], a[132:135], v[104:107]
  v_mfma_f32_16x16x32_bf16 v[108:111], v[20:23], a[188:191], v[108:111]
  s_waitcnt lgkmcnt(4)
  v_mfma_f32_16x16x32_bf16 v[112:115], v[24:27], a[20:23], v[112:115]
  ds_read_b128 v[16:19], v128 offset:8192
  v_mfma_f32_16x16x32_bf16 v[116:119], v[24:27], a[76:79], v[116:119]
  v_mfma_f32_16x16x32_bf16 v[120:123], v[24:27], a[132:135], v[120:123]
  buffer_load_dwordx4 v2, s[8:11], s24 offen offset:3072 sc1 lds
  v_mfma_f32_16x16x32_bf16 v[124:127], v[24:27], a[188:191], v[124:127]
  s_waitcnt lgkmcnt(4)
  v_mfma_f32_16x16x32_bf16 v[96:99], v[28:31], a[24:27], v[96:99]
  ds_read_b128 v[20:23], v128 offset:22528
  v_mfma_f32_16x16x32_bf16 v[100:103], v[28:31], a[80:83], v[100:103]
  v_mfma_f32_16x16x32_bf16 v[104:107], v[28:31], a[136:139], v[104:107]
  v_mfma_f32_16x16x32_bf16 v[108:111], v[28:31], a[192:195], v[108:111]
  s_waitcnt lgkmcnt(4)
  s_add_u32 m0, m0, 4096
  s_add_u32 s24, s24, 4096
  buffer_load_dwordx4 v2, s[8:11], s24 offen offset:0 sc1 lds
  v_mfma_f32_16x16x32_bf16 v[112:115], v[32:35], a[24:27], v[112:115]
  ds_read_b128 v[24:27], v128 offset:9216
  v_mfma_f32_16x16x32_bf16 v[116:119], v[32:35], a[80:83], v[116:119]
  v_mfma_f32_16x16x32_bf16 v[120:123], v[32:35], a[136:139], v[120:123]
  v_mfma_f32_16x16x32_bf16 v[124:127], v[32:35], a[192:195], v[124:127]
  s_waitcnt lgkmcnt(4)
  v_mfma_f32_16x16x32_bf16 v[96:99], v[8:11], a[28:31], v[96:99]
  ds_read_b128 v[28:31], v128 offset:23552
  v_mfma_f32_16x16x32_bf16 v[100:103], v[8:11], a[84:87], v[100:103]
  buffer_load_dwordx4 v2, s[8:11], s24 offen offset:1024 sc1 lds
  v_mfma_f32_16x16x32_bf16 v[104:107], v[8:11], a[140:143], v[104:107]
  v_mfma_f32_16x16x32_bf16 v[108:111], v[8:11], a[196:199], v[108:111]
  s_waitcnt lgkmcnt(4)
  v_mfma_f32_16x16x32_bf16 v[112:115], v[12:15], a[28:31], v[112:115]
  ds_read_b128 v[32:35], v128 offset:10240
  v_mfma_f32_16x16x32_bf16 v[116:119], v[12:15], a[84:87], v[116:119]
  v_mfma_f32_16x16x32_bf16 v[120:123], v[12:15], a[140:143], v[120:123]
  buffer_load_dwordx4 v2, s[8:11], s24 offen offset:2048 sc1 lds
  v_mfma_f32_16x16x32_bf16 v[124:127], v[12:15], a[196:199], v[124:127]
  s_waitcnt lgkmcnt(4)
  v_mfma_f32_16x16x32_bf16 v[96:99], v[16:19], a[32:35], v[96:99]
  ds_read_b128 v[8:11], v128 offset:24576
  v_mfma_f32_16x16x32_bf16 v[100:103], v[16:19], a[88:91], v[100:103]
  v_mfma_f32_16x16x32_bf16 v[104:107], v[16:19], a[144:147], v[104:107]
  v_mfma_f32_16x16x32_bf16 v[108:111], v[16:19], a[200:203], v[108:111]
  s_waitcnt lgkmcnt(4)
  s_add_u32 s33, s33, 28672
  s_cmp_eq_u32 s33, 114688
  s_cselect_b32 s33, 0, s33
  v_mfma_f32_16x16x32_bf16 v[112:115], v[20:23], a[32:35], v[112:115]
  ds_read_b128 v[12:15], v128 offset:11264
  v_mfma_f32_16x16x32_bf16 v[116:119], v[20:23], a[88:91], v[116:119]
  s_add_u32 s32, s32, 28672
  s_cmp_eq_u32 s32, 114688
  s_cselect_b32 s32, 0, s32
  v_mfma_f32_16x16x32_bf16 v[120:123], v[20:23], a[144:147], v[120:123]
  v_add_u32 v5, s32, v2
  v_mfma_f32_16x16x32_bf16 v[124:127], v[20:23], a[200:203], v[124:127]
  s_waitcnt lgkmcnt(4)
  v_mfma_f32_16x16x32_bf16 v[96:99], v[24:27], a[36:39], v[96:99]
  ds_read_b128 v[16:19], v128 offset:25600
  v_mfma_f32_16x16x32_bf16 v[100:103], v[24:27], a[92:95], v[100:103]
  v_mfma_f32_16x16x32_bf16 v[104:107], v[24:27], a[148:151], v[104:107]
  v_mfma_f32_16x16x32_bf16 v[108:111], v[24:27], a[204:207], v[108:111]
  s_waitcnt lgkmcnt(4)
  v_mfma_f32_16x16x32_bf16 v[112:115], v[28:31], a[36:39], v[112:115]
  ds_read_b128 v[20:23], v128 offset:12288
  v_mfma_f32_16x16x32_bf16 v[116:119], v[28:31], a[92:95], v[116:119]
  v_mfma_f32_16x16x32_bf16 v[120:123], v[28:31], a[148:151], v[120:123]
  v_mfma_f32_16x16x32_bf16 v[124:127], v[28:31], a[204:207], v[124:127]
  s_waitcnt lgkmcnt(4)
  v_mfma_f32_16x16x32_bf16 v[96:99], v[32:35], a[40:43], v[96:99]
  ds_read_b128 v[24:27], v128 offset:26624
  v_mfma_f32_16x16x32_bf16 v[100:103], v[32:35], a[96:99], v[100:103]
  v_mfma_f32_16x16x32_bf16 v[104:107], v[32:35], a[152:155], v[104:107]
  v_mfma_f32_16x16x32_bf16 v[108:111], v[32:35], a[208:211], v[108:111]
  s_waitcnt lgkmcnt(4)
  v_mfma_f32_16x16x32_bf16 v[112:115], v[8:11], a[40:43], v[112:115]
  ds_read_b128 v[28:31], v128 offset:13312
  v_mfma_f32_16x16x32_bf16 v[116:119], v[8:11], a[96:99], v[116:119]
  v_mfma_f32_16x16x32_bf16 v[120:123], v[8:11], a[152:155], v[120:123]
  v_mfma_f32_16x16x32_bf16 v[124:127], v[8:11], a[208:211], v[124:127]
  s_waitcnt lgkmcnt(4)
  v_mfma_f32_16x16x32_bf16 v[96:99], v[12:15], a[44:47], v[96:99]
  ds_read_b128 v[32:35], v128 offset:27648
  v_mfma_f32_16x16x32_bf16 v[100:103], v[12:15], a[100:103], v[100:103]
  v_mfma_f32_16x16x32_bf16 v[104:107], v[12:15], a[156:159], v[104:107]
  v_mfma_f32_16x16x32_bf16 v[108:111], v[12:15], a[212:215], v[108:111]
  s_waitcnt lgkmcnt(4)
  v_mfma_f32_16x16x32_bf16 v[112:115], v[16:19], a[44:47], v[112:115]
  s_waitcnt vmcnt(11)
  s_barrier
  ds_read_b128 v[8:11], v5 offset:0
  v_mfma_f32_16x16x32_bf16 v[116:119], v[16:19], a[100:103], v[116:119]
  v_mfma_f32_16x16x32_bf16 v[120:123], v[16:19], a[156:159], v[120:123]
  v_mfma_f32_16x16x32_bf16 v[124:127], v[16:19], a[212:215], v[124:127]
  s_waitcnt lgkmcnt(4)
  v_mfma_f32_16x16x32_bf16 v[96:99], v[20:23], a[48:51], v[96:99]
  ds_read_b128 v[12:15], v5 offset:14336
  v_mfma_f32_16x16x32_bf16 v[100:103], v[20:23], a[104:107], v[100:103]
  v_mfma_f32_16x16x32_bf16 v[104:107], v[20:23], a[160:163], v[104:107]
  v_mfma_f32_16x16x32_bf16 v[108:111], v[20:23], a[216:219], v[108:111]
  s_waitcnt lgkmcnt(4)
  v_mfma_f32_16x16x32_bf16 v[112:115], v[24:27], a[48:51], v[112:115]
  ds_read_b128 v[16:19], v5 offset:1024
  v_mfma_f32_16x16x32_bf16 v[116:119], v[24:27], a[104:107], v[116:119]
  v_mfma_f32_16x16x32_bf16 v[120:123], v[24:27], a[160:163], v[120:123]
  v_mfma_f32_16x16x32_bf16 v[124:127], v[24:27], a[216:219], v[124:127]
  s_waitcnt lgkmcnt(4)
  v_mfma_f32_16x16x32_bf16 v[96:99], v[28:31], a[52:55], v[96:99]
  ds_read_b128 v[20:23], v5 offset:15360
  v_mfma_f32_16x16x32_bf16 v[100:103], v[28:31], a[108:111], v[100:103]
  v_mfma_f32_16x16x32_bf16 v[104:107], v[28:31], a[164:167], v[104:107]
  v_mfma_f32_16x16x32_bf16 v[108:111], v[28:31], a[220:223], v[108:111]
  s_waitcnt lgkmcnt(4)
  v_mfma_f32_16x16x32_bf16 v[112:115], v[32:35], a[52:55], v[112:115]
  ds_read_b128 v[24:27], v5 offset:2048
  v_mfma_f32_16x16x32_bf16 v[116:119], v[32:35], a[108:111], v[116:119]
  v_mfma_f32_16x16x32_bf16 v[120:123], v[32:35], a[164:167], v[120:123]
  v_mfma_f32_16x16x32_bf16 v[124:127], v[32:35], a[220:223], v[124:127]
  s_waitcnt lgkmcnt(4)
  s_mov_b32 s40, s19
  s_mov_b32 s41, s29
  s_add_u32 s19, s19, 1
  s_cmp_lt_u32 s19, s35
  s_cbranch_scc1 wg_f_loop
  s_nop 3
  s_lshl_b32 s42, s40, 10
  s_add_u32 s42, s42, s41
  v_cvt_pk_bf16_f32 v72, v96, v97
  v_cvt_pk_bf16_f32 v73, v98, v99
  v_cvt_pk_bf16_f32 v74, v112, v113
  v_cvt_pk_bf16_f32 v75, v114, v115
  s_add_u32 s43, s42, 0
  buffer_store_dwordx4 v[72:75], v2, s[8:11], s43 offen sc1
  v_cvt_pk_bf16_f32 v76, v100, v101
  v_cvt_pk_bf16_f32 v77, v102, v103
  v_cvt_pk_bf16_f32 v78, v116, v117
  v_cvt_pk_bf16_f32 v79, v118, v119
  s_add_u32 s43, s42, 14336
  buffer_store_dwordx4 v[76:79], v2, s[8:11], s43 offen sc1
  v_cvt_pk_bf16_f32 v80, v104, v105
  v_cvt_pk_bf16_f32 v81, v106, v107
  v_cvt_pk_bf16_f32 v82, v120, v121
  v_cvt_pk_bf16_f32 v83, v122, v123
  s_add_u32 s43, s42, 458752
  buffer_store_dwordx4 v[80:83], v2, s[8:11], s43 offen sc1
  v_cvt_pk_bf16_f32 v84, v108, v109
  v_cvt_pk_bf16_f32 v85, v110, v111
  v_cvt_pk_bf16_f32 v86, v124, v125
  v_cvt_pk_bf16_f32 v87, v126, v127
  s_add_u32 s43, s42, 473088
  buffer_store_dwordx4 v[84:87], v2, s[8:11], s43 offen sc1
  s_branch wg_done
wg_f_e0:
  s_nop 7
  s_lshl_b32 s42, s40, 10
  s_add_u32 s42, s42, s41
  v_cvt_pk_bf16_f32 v72, v40, v41
  v_cvt_pk_bf16_f32 v73, v42, v43
  v_cvt_pk_bf16_f32 v74, v56, v57
  v_cvt_pk_bf16_f32 v75, v58, v59
  s_add_u32 s43, s42, 0
  buffer_store_dwordx4 v[72:75], v2, s[8:11], s43 offen sc1
  v_cvt_pk_bf16_f32 v76, v44, v45
  v_cvt_pk_bf16_f32 v77, v46, v47
  v_cvt_pk_bf16_f32 v78, v60, v61
  v_cvt_pk_bf16_f32 v79, v62, v63
  s_add_u32 s43, s42, 14336
  buffer_store_dwordx4 v[76:79], v2, s[8:11], s43 offen sc1
  v_cvt_pk_bf16_f32 v80, v48, v49
  v_cvt_pk_bf16_f32 v81, v50, v51
  v_cvt_pk_bf16_f32 v82, v64, v65
  v_cvt_pk_bf16_f32 v83, v66, v67
  s_add_u32 s43, s42, 458752
  buffer_store_dwordx4 v[80:83], v2, s[8:11], s43 offen sc1
  v_cvt_pk_bf16_f32 v84, v52, v53
  v_cvt_pk_bf16_f32 v85, v54, v55
  v_cvt_pk_bf16_f32 v86, v68, v69
  v_cvt_pk_bf16_f32 v87, v70, v71
  s_add_u32 s43, s42, 473088
  buffer_store_dwordx4 v[84:87], v2, s[8:11], s43 offen sc1
  s_branch wg_done
wg_vo:
  s_sub_u32 s29, s17, 16
  s_mul_i32 s29, s29, 28672
  s_mul_i32 s24, s28, 458752
  s_add_u32 s29, s29, s24
  s_add_u32 s29, s29, 2490368
  v_lshlrev_b32 v6, 4, v3
  v_mul_u32_u24 v7, 12, v3
  v_add_u32 v7, 48, v7
  s_mov_b32 s31, 0
  s_lshl_b32 s24, s34, 1
  s_mul_i32 s24, s24, 14336
  s_add_u32 s24, s24, s23
  s_add_u32 m0, s31, s27
  s_nop 0
  buffer_load_dwordx4 v2, s[8:11], s24 offen offset:0 sc1 lds
  buffer_load_dwordx4 v2, s[8:11], s24 offen offset:1024 sc1 lds
  buffer_load_dwordx4 v2, s[8:11], s24 offen offset:2048 sc1 lds
  buffer_load_dwordx4 v2, s[8:11], s24 offen offset:3072 sc1 lds
  s_add_u32 m0, m0, 4096
  s_add_u32 s24, s24, 4096
  buffer_load_dwordx4 v2, s[8:11], s24 offen offset:0 sc1 lds
  buffer_load_dwordx4 v2, s[8:11], s24 offen offset:1024 sc1 lds
  buffer_load_dwordx4 v2, s[8:11], s24 offen offset:2048 sc1 lds
  s_sub_u32 s36, s35, 1
  s_add_u32 s30, s34, 1
  s_min_u32 s30, s30, s36
  s_mov_b32 s31, 28672
  s_lshl_b32 s24, s30, 1
  s_mul_i32 s24, s24, 14336
  s_add_u32 s24, s24, s23
  s_add_u32 m0, s31, s27
  s_nop 0
  buffer_load_dwordx4 v2, s[8:11], s24 offen offset:0 sc1 lds
  buffer_load_dwordx4 v2, s[8:11], s24 offen offset:1024 sc1 lds
  buffer_load_dwordx4 v2, s[8:11], s24 offen offset:2048 sc1 lds
  buffer_load_dwordx4 v2, s[8:11], s24 offen offset:3072 sc1 lds
  s_add_u32 m0, m0, 4096
  s_add_u32 s24, s24, 4096
  buffer_load_dwordx4 v2, s[8:11], s24 offen offset:0 sc1 lds
  buffer_load_dwordx4 v2, s[8:11], s24 offen offset:1024 sc1 lds
  buffer_load_dwordx4 v2, s[8:11], s24 offen offset:2048 sc1 lds
  s_mov_b32 s19, s34
  s_mov_b32 s32, 0
  s_mov_b32 s33, 57344
  s_cmp_eq_u32 s18, s101
  s_cbranch_scc1 wg_vo_hx
  s_add_u32 s22, s21, 0
  buffer_load_dwordx4 a[0:3], v2, s[8:11], s22 offen offset:0 sc1
  buffer_load_dwordx4 a[4:7], v2, s[8:11], s22 offen offset:1024 sc1
  buffer_load_dwordx4 a[8:11], v2, s[8:11], s22 offen offset:2048 sc1
  buffer_load_dwordx4 a[12:15], v2, s[8:11], s22 offen offset:3072 sc1
  s_add_u32 s22, s21, 4096
  buffer_load_dwordx4 a[16:19], v2, s[8:11], s22 offen offset:0 sc1
  buffer_load_dwordx4 a[20:23], v2, s[8:11], s22 offen offset:1024 sc1
  buffer_load_dwordx4 a[24:27], v2, s[8:11], s22 offen offset:2048 sc1
  buffer_load_dwordx4 a[28:31], v2, s[8:11], s22 offen offset:3072 sc1
  s_add_u32 s22, s21, 8192
  buffer_load_dwordx4 a[32:35], v2, s[8:11], s22 offen offset:0 sc1
  buffer_load_dwordx4 a[36:39], v2, s[8:11], s22 offen offset:1024 sc1
  buffer_load_dwordx4 a[40:43], v2, s[8:11], s22 offen offset:2048 sc1
  buffer_load_dwordx4 a[44:47], v2, s[8:11], s22 offen offset:3072 sc1
  s_add_u32 s22, s21, 12288
  buffer_load_dwordx4 a[48:51], v2, s[8:11], s22 offen offset:0 sc1
  buffer_load_dwordx4 a[52:55], v2, s[8:11], s22 offen offset:1024 sc1
  buffer_load_dwordx4 a[56:59], v2, s[8:11], s22 offen offset:2048 sc1
  buffer_load_dwordx4 a[60:63], v2, s[8:11], s22 offen offset:3072 sc1
  s_add_u32 s22, s21, 16384
  buffer_load_dwordx4 a[64:67], v2, s[8:11], s22 offen offset:0 sc1
  buffer_load_dwordx4 a[68:71], v2, s[8:11], s22 offen offset:1024 sc1
  buffer_load_dwordx4 a[72:75], v2, s[8:11], s22 offen offset:2048 sc1
  buffer_load_dwordx4 a[76:79], v2, s[8:11], s22 offen offset:3072 sc1
  s_add_u32 s22, s21, 20480
  buffer_load_dwordx4 a[80:83], v2, s[8:11], s22 offen offset:0 sc1
  buffer_load_dwordx4 a[84:87], v2, s[8:11], s22 offen offset:1024 sc1
  buffer_load_dwordx4 a[88:91], v2, s[8:11], s22 offen offset:2048 sc1
  buffer_load_dwordx4 a[92:95], v2, s[8:11], s22 offen offset:3072 sc1
  s_add_u32 s22, s21, 24576
  buffer_load_dwordx4 a[96:99], v2, s[8:11], s22 offen offset:0 sc1
  buffer_load_dwordx4 a[100:103], v2, s[8:11], s22 offen offset:1024 sc1
  buffer_load_dwordx4 a[104:107], v2, s[8:11], s22 offen offset:2048 sc1
  buffer_load_dwordx4 a[108:111], v2, s[8:11], s22 offen offset:3072 sc1
  s_add_u32 s22, s21, 28672
  buffer_load_dwordx4 a[112:115], v2, s[8:11], s22 offen offset:0 sc1
  buffer_load_dwordx4 a[116:119], v2, s[8:11], s22 offen offset:1024 sc1
  buffer_load_dwordx4 a[120:123], v2, s[8:11], s22 offen offset:2048 sc1
  buffer_load_dwordx4 a[124:127], v2, s[8:11], s22 offen offset:3072 sc1
  s_add_u32 s22, s21, 32768
  buffer_load_dwordx4 a[128:131], v2, s[8:11], s22 offen offset:0 sc1
  buffer_load_dwordx4 a[132:135], v2, s[8:11], s22 offen offset:1024 sc1
  buffer_load_dwordx4 a[136:139], v2, s[8:11], s22 offen offset:2048 sc1
  buffer_load_dwordx4 a[140:143], v2, s[8:11], s22 offen offset:3072 sc1
  s_add_u32 s22, s21, 36864
  buffer_load_dwordx4 a[144:147], v2, s[8:11], s22 offen offset:0 sc1
  buffer_load_dwordx4 a[148:151], v2, s[8:11], s22 offen offset:1024 sc1
  buffer_load_dwordx4 a[152:155], v2, s[8:11], s22 offen offset:2048 sc1
  buffer_load_dwordx4 a[156:159], v2, s[8:11], s22 offen offset:3072 sc1
  s_add_u32 s22, s21, 40960
  s_waitcnt vmcnt(40)
  buffer_load_dwordx4 a[160:163], v2, s[8:11], s22 offen offset:0 sc1
  buffer_load_dwordx4 a[164:167], v2, s[8:11], s22 offen offset:1024 sc1
  buffer_load_dwordx4 a[168:171], v2, s[8:11], s22 offen offset:2048 sc1
  buffer_load_dwordx4 a[172:175], v2, s[8:11], s22 offen offset:3072 sc1
  s_add_u32 s22, s21, 45056
  buffer_load_dwordx4 a[176:179], v2, s[8:11], s22 offen offset:0 sc1
  buffer_load_dwordx4 a[180:183], v2, s[8:11], s22 offen offset:1024 sc1
  buffer_load_dwordx4 a[184:187], v2, s[8:11], s22 offen offset:2048 sc1
  buffer_load_dwordx4 a[188:191], v2, s[8:11], s22 offen offset:3072 sc1
  s_add_u32 s22, s21, 49152
  buffer_load_dwordx4 a[192:195], v2, s[8:11], s22 offen offset:0 sc1
  buffer_load_dwordx4 a[196:199], v2, s[8:11], s22 offen offset:1024 sc1
  buffer_load_dwordx4 a[200:203], v2, s[8:11], s22 offen offset:2048 sc1
  buffer_load_dwordx4 a[204:207], v2, s[8:11], s22 offen offset:3072 sc1
  s_add_u32 s22, s21, 53248
  buffer_load_dwordx4 a[208:211], v2, s[8:11], s22 offen offset:0 sc1
  buffer_load_dwordx4 a[212:215], v2, s[8:11], s22 offen offset:1024 sc1
  buffer_load_dwordx4 a[216:219], v2, s[8:11], s22 offen offset:2048 sc1
  buffer_load_dwordx4 a[220:223], v2, s[8:11], s22 offen offset:3072 sc1
wg_vo_hx:
  s_mov_b32 s101, -1
  s_waitcnt vmcnt(0)
  s_barrier
  s_mov_b32 s40, 0
  s_mov_b32 s41, 0x40000000
  v_mov_b32 v5, v2
  ds_read_b128 v[8:11], v5 offset:0
  ds_read_b128 v[12:15], v5 offset:14336
  ds_read_b128 v[16:19], v5 offset:1024
  ds_read_b128 v[20:23], v5 offset:15360
  ds_read_b128 v[24:27], v5 offset:2048
  s_waitcnt lgkmcnt(4)
.p2align 6
wg_vo_loop:
  v_mfma_f32_16x16x32_bf16 v[40:43], a[0:3], v[8:11], 0
  ds_read_b128 v[28:31], v5 offset:16384
  v_mfma_f32_16x16x32_bf16 v[44:47], a[56:59], v[8:11], 0
  v_mfma_f32_16x16x32_bf16 v[48:51], a[112:115], v[8:11], 0
  v_mfma_f32_16x16x32_bf16 v[52:55], a[168:171], v[8:11], 0
  s_waitcnt lgkmcnt(4)
  s_add_u32 s43, s41, 458752
  v_mfma_f32_16x16x32_bf16 v[56:59], a[0:3], v[12:15], 0
  ds_read_b128 v[32:35], v5 offset:3072
  v_mfma_f32_16x16x32_bf16 v[60:63], a[56:59], v[12:15], 0
  s_lshl_b32 s42, s40, 5
  s_add_u32 s42, s42, 0
  v_mfma_f32_16x16x32_bf16 v[64:67], a[112:115], v[12:15], 0
  v_add_u32 v88, s42, v4
  v_mul_u32_u24 v89, 2341, v88
  v_mfma_f32_16x16x32_bf16 v[68:71], a[168:171], v[12:15], 0
  s_waitcnt lgkmcnt(4)
  v_lshrrev_b32 v89, 16, v89
  v_mfma_f32_16x16x32_bf16 v[40:43], a[4:7], v[16:19], v[40:43]
  ds_read_b128 v[8:11], v5 offset:17408
  v_mfma_f32_16x16x32_bf16 v[44:47], a[60:63], v[16:19], v[44:47]
  v_mul_u32_u24 v92, 28, v89
  v_sub_u32 v92, v88, v92
  v_mfma_f32_16x16x32_bf16 v[48:51], a[116:119], v[16:19], v[48:51]
  v_cmp_gt_u32 vcc, 16, v92
  v_mul_u32_u24 v89, 84, v89
  v_mfma_f32_16x16x32_bf16 v[52:55], a[172:175], v[16:19], v[52:55]
  s_waitcnt lgkmcnt(4)
  v_cndmask_b32 v92, v7, v6, vcc
  v_mfma_f32_16x16x32_bf16 v[56:59], a[4:7], v[20:23], v[56:59]
  ds_read_b128 v[12:15], v5 offset:4096
  v_mfma_f32_16x16x32_bf16 v[60:63], a[60:63], v[20:23], v[60:63]
  v_add3_u32 v88, v88, v89, v92
  v_lshlrev_b32 v90, 4, v88
  v_mfma_f32_16x16x32_bf16 v[64:67], a[116:119], v[20:23], v[64:67]
  v_cvt_pk_bf16_f32 v72, v96, v100
  v_cvt_pk_bf16_f32 v73, v97, v101
  v_mfma_f32_16x16x32_bf16 v[68:71], a[172:175], v[20:23], v[68:71]
  s_waitcnt lgkmcnt(4)
  v_cvt_pk_bf16_f32 v74, v98, v102
  v_mfma_f32_16x16x32_bf16 v[40:43], a[8:11], v[24:27], v[40:43]
  ds_read_b128 v[16:19], v5 offset:18432
  v_mfma_f32_16x16x32_bf16 v[44:47], a[64:67], v[24:27], v[44:47]
  v_cvt_pk_bf16_f32 v75, v99, v103
  v_mfma_f32_16x16x32_bf16 v[48:51], a[120:123], v[24:27], v[48:51]
  buffer_store_dwordx4 v[72:75], v90, s[8:11], s41 offen sc1
  v_cvt_pk_bf16_f32 v76, v104, v108
  v_mfma_f32_16x16x32_bf16 v[52:55], a[176:179], v[24:27], v[52:55]
  s_waitcnt lgkmcnt(4)
  v_cvt_pk_bf16_f32 v77, v105, v109
  v_mfma_f32_16x16x32_bf16 v[56:59], a[8:11], v[28:31], v[56:59]
  ds_read_b128 v[20:23], v5 offset:5120
  v_mfma_f32_16x16x32_bf16 v[60:63], a[64:67], v[28:31], v[60:63]
  v_cvt_pk_bf16_f32 v78, v106, v110
  v_cvt_pk_bf16_f32 v79, v107, v111
  v_mfma_f32_16x16x32_bf16 v[64:67], a[120:123], v[28:31], v[64:67]
  buffer_store_dwordx4 v[76:79], v90, s[8:11], s43 offen sc1
  s_lshl_b32 s42, s40, 5
  v_mfma_f32_16x16x32_bf16 v[68:71], a[176:179], v[28:31], v[68:71]
  s_waitcnt lgkmcnt(4)
  s_add_u32 s42, s42, 16
  v_mfma_f32_16x16x32_bf16 v[40:43], a[12:15], v[32:35], v[40:43]
  ds_read_b128 v[24:27], v5 offset:19456
  v_mfma_f32_16x16x32_bf16 v[44:47], a[68:71], v[32:35], v[44:47]
  v_add_u32 v88, s42, v4
  v_mul_u32_u24 v89, 2341, v88
  v_mfma_f32_16x16x32_bf16 v[48:51], a[124:127], v[32:35], v[48:51]
  v_lshrrev_b32 v89, 16, v89
  v_mul_u32_u24 v92, 28, v89
  v_mfma_f32_16x16x32_bf16 v[52:55], a[180:183], v[32:35], v[52:55]
  s_waitcnt lgkmcnt(4)
  v_sub_u32 v92, v88, v92
  v_mfma_f32_16x16x32_bf16 v[56:59], a[12:15], v[8:11], v[56:59]
  ds_read_b128 v[28:31], v5 offset:6144
  v_mfma_f32_16x16x32_bf16 v[60:63], a[68:71], v[8:11], v[60:63]
  v_cmp_gt_u32 vcc, 16, v92
  v_mul_u32_u24 v89, 84, v89
  v_mfma_f32_16x16x32_bf16 v[64:67], a[124:127], v[8:11], v[64:67]
  v_cndmask_b32 v92, v7, v6, vcc
  v_add3_u32 v88, v88, v89, v92
  v_mfma_f32_16x16x32_bf16 v[68:71], a[180:183], v[8:11], v[68:71]
  s_waitcnt lgkmcnt(4)
  v_lshlrev_b32 v91, 4, v88
  v_mfma_f32_16x16x32_bf16 v[40:43], a[16:19], v[12:15], v[40:43]
  ds_read_b128 v[32:35], v5 offset:20480
  v_mfma_f32_16x16x32_bf16 v[44:47], a[72:75], v[12:15], v[44:47]
  v_cvt_pk_bf16_f32 v80, v112, v116
  v_cvt_pk_bf16_f32 v81, v113, v117
  v_mfma_f32_16x16x32_bf16 v[48:51], a[128:131], v[12:15], v[48:51]
  v_cvt_pk_bf16_f32 v82, v114, v118
  v_cvt_pk_bf16_f32 v83, v115, v119
  v_mfma_f32_16x16x32_bf16 v[52:55], a[184:187], v[12:15], v[52:55]
  s_waitcnt lgkmcnt(4)
  buffer_store_dwordx4 v[80:83], v91, s[8:11], s41 offen sc1
  v_mfma_f32_16x16x32_bf16 v[56:59], a[16:19], v[16:19], v[56:59]
  ds_read_b128 v[8:11], v5 offset:7168
  v_mfma_f32_16x16x32_bf16 v[60:63], a[72:75], v[16:19], v[60:63]
  v_cvt_pk_bf16_f32 v84, v120, v124
  v_cvt_pk_bf16_f32 v85, v121, v125
  v_mfma_f32_16x16x32_bf16 v[64:67], a[128:131], v[16:19], v[64:67]
  v_cvt_pk_bf16_f32 v86, v122, v126
  v_cvt_pk_bf16_f32 v87, v123, v127
  v_mfma_f32_16x16x32_bf16 v[68:71], a[184:187], v[16:19], v[68:71]
  s_waitcnt lgkmcnt(4)
  buffer_store_dwordx4 v[84:87], v91, s[8:11], s43 offen sc1
  v_mfma_f32_16x16x32_bf16 v[40:43], a[20:23], v[20:23], v[40:43]
  ds_read_b128 v[12:15], v5 offset:21504
  v_mfma_f32_16x16x32_bf16 v[44:47], a[76:79], v[20:23], v[44:47]
  s_add_u32 s30, s19, 2
  s_lshl_b32 s24, s30, 1
  s_mul_i32 s24, s24, 14336
  v_mfma_f32_16x16x32_bf16 v[48:51], a[132:135], v[20:23], v[48:51]
  s_add_u32 s24, s24, s23
  s_cmp_lt_u32 s30, s35
  s_cselect_b32 s24, s24, 0x40000000
  v_mfma_f32_16x16x32_bf16 v[52:55], a[188:191], v[20:23], v[52:55]
  s_waitcnt lgkmcnt(4)
  s_add_u32 m0, s33, s27
  s_nop 0
  buffer_load_dwordx4 v2, s[8:11], s24 offen offset:0 sc1 lds
  v_mfma_f32_16x16x32_bf16 v[56:59], a[20:23], v[24:27], v[56:59]
  ds_read_b128 v[16:19], v5 offset:8192
  v_mfma_f32_16x16x32_bf16 v[60:63], a[76:79], v[24:27], v[60:63]
  v_mfma_f32_16x16x32_bf16 v[64:67], a[132:135], v[24:27], v[64:67]
  v_mfma_f32_16x16x32_bf16 v[68:71], a[188:191], v[24:27], v[68:71]
  s_waitcnt lgkmcnt(4)
  v_mfma_f32_16x16x32_bf16 v[40:43], a[24:27], v[28:31], v[40:43]
  ds_read_b128 v[20:23], v5 offset:22528
  v_mfma_f32_16x16x32_bf16 v[44:47], a[80:83], v[28:31], v[44:47]
  buffer_load_dwordx4 v2, s[8:11], s24 offen offset:1024 sc1 lds
  v_mfma_f32_16x16x32_bf16 v[48:51], a[136:139], v[28:31], v[48:51]
  v_mfma_f32_16x16x32_bf16 v[52:55], a[192:195], v[28:31], v[52:55]
  s_waitcnt lgkmcnt(4)
  v_mfma_f32_16x16x32_bf16 v[56:59], a[24:27], v[32:35], v[56:59]
  ds_read_b128 v[24:27], v5 offset:9216
  v_mfma_f32_16x16x32_bf16 v[60:63], a[80:83], v[32:35], v[60:63]
  v_mfma_f32_16x16x32_bf16 v[64:67], a[136:139], v[32:35], v[64:67]
  buffer_load_dwordx4 v2, s[8:11], s24 offen offset:2048 sc1 lds
  v_mfma_f32_16x16x32_bf16 v[68:71], a[192:195], v[32:35], v[68:71]
  s_waitcnt lgkmcnt(4)
  v_mfma_f32_16x16x32_bf16 v[40:43], a[28:31], v[8:11], v[40:43]
  ds_read_b128 v[28:31], v5 offset:23552
  v_mfma_f32_16x16x32_bf16 v[44:47], a[84:87], v[8:11], v[44:47]
  v_mfma_f32_16x16x32_bf16 v[48:51], a[140:143], v[8:11], v[48:51]
  v_mfma_f32_16x16x32_bf16 v[52:55], a[196:199], v[8:11], v[52:55]
  s_waitcnt lgkmcnt(4)
  buffer_load_dwordx4 v2, s[8:11], s24 offen offset:3072 sc1 lds
  v_mfma_f32_16x16x32_bf16 v[56:59], a[28:31], v[12:15], v[56:59]
  ds_read_b128 v[32:35], v5 offset:10240
  v_mfma_f32_16x16x32_bf16 v[60:63], a[84:87], v[12:15], v[60:63]
  v_mfma_f32_16x16x32_bf16 v[64:67], a[140:143], v[12:15], v[64:67]
  v_mfma_f32_16x16x32_bf16 v[68:71], a[196:199], v[12:15], v[68:71]
  s_waitcnt lgkmcnt(4)
  v_mfma_f32_16x16x32_bf16 v[40:43], a[32:35], v[16:19], v[40:43]
  ds_read_b128 v[8:11], v5 offset:24576
  v_mfma_f32_16x16x32_bf16 v[44:47], a[88:91], v[16:19], v[44:47]
  s_add_u32 m0, m0, 4096
  s_add_u32 s24, s24, 4096
  buffer_load_dwordx4 v2, s[8:11], s24 offen offset:0 sc1 lds
  v_mfma_f32_16x16x32_bf16 v[48:51], a[144:147], v[16:19], v[48:51]
  v_mfma_f32_16x16x32_bf16 v[52:55], a[200:203], v[16:19], v[52:55]
  s_waitcnt lgkmcnt(4)
  v_mfma_f32_16x16x32_bf16 v[56:59], a[32:35], v[20:23], v[56:59]
  ds_read_b128 v[12:15], v5 offset:11264
  v_mfma_f32_16x16x32_bf16 v[60:63], a[88:91], v[20:23], v[60:63]
  v_mfma_f32_16x16x32_bf16 v[64:67], a[144:147], v[20:23], v[64:67]
  buffer_load_dwordx4 v2, s[8:11], s24 offen offset:1024 sc1 lds
  v_mfma_f32_16x16x32_bf16 v[68:71], a[200:203], v[20:23], v[68:71]
  s_waitcnt lgkmcnt(4)
  v_mfma_f32_16x16x32_bf16 v[40:43], a[36:39], v[24:27], v[40:43]
  ds_read_b128 v[16:19], v5 offset:25600
  v_mfma_f32_16x16x32_bf16 v[44:47], a[92:95], v[24:27], v[44:47]
  v_mfma_f32_16x16x32_bf16 v[48:51], a[148:151], v[24:27], v[48:51]
  v_mfma_f32_16x16x32_bf16 v[52:55], a[204:207], v[24:27], v[52:55]
  s_waitcnt lgkmcnt(4)
  buffer_load_dwordx4 v2, s[8:11], s24 offen offset:2048 sc1 lds
  v_mfma_f32_16x16x32_bf16 v[56:59], a[36:39], v[28:31], v[56:59]
  ds_read_b128 v[20:23], v5 offset:12288
  v_mfma_f32_16x16x32_bf16 v[60:63], a[92:95], v[28:31], v[60:63]
  v_mfma_f32_16x16x32_bf16 v[64:67], a[148:151], v[28:31], v[64:67]
  v_mfma_f32_16x16x32_bf16 v[68:71], a[204:207], v[28:31], v[68:71]
  s_waitcnt lgkmcnt(4)
  v_mfma_f32_16x16x32_bf16 v[40:43], a[40:43], v[32:35], v[40:43]
  ds_read_b128 v[24:27], v5 offset:26624
  v_mfma_f32_16x16x32_bf16 v[44:47], a[96:99], v[32:35], v[44:47]
  s_add_u32 s33, s33, 28672
  s_cmp_eq_u32 s33, 114688
  s_cselect_b32 s33, 0, s33
  v_mfma_f32_16x16x32_bf16 v[48:51], a[152:155], v[32:35], v[48:51]
  s_add_u32 s32, s32, 28672
  s_cmp_eq_u32 s32, 114688
  s_cselect_b32 s32, 0, s32
  v_mfma_f32_16x16x32_bf16 v[52:55], a[208:211], v[32:35], v[52:55]
  s_waitcnt lgkmcnt(4)
  v_add_u32 v128, s32, v2
  v_mfma_f32_16x16x32_bf16 v[56:59], a[40:43], v[8:11], v[56:59]
  ds_read_b128 v[28:31], v5 offset:13312
  v_mfma_f32_16x16x32_bf16 v[60:63], a[96:99], v[8:11], v[60:63]
  v_mfma_f32_16x16x32_bf16 v[64:67], a[152:155], v[8:11], v[64:67]
  v_mfma_f32_16x16x32_bf16 v[68:71], a[208:211], v[8:11], v[68:71]
  s_waitcnt lgkmcnt(4)
  v_mfma_f32_16x16x32_bf16 v[40:43], a[44:47], v[12:15], v[40:43]
  ds_read_b128 v[32:35], v5 offset:27648
  v_mfma_f32_16x16x32_bf16 v[44:47], a[100:103], v[12:15], v[44:47]
  v_mfma_f32_16x16x32_bf16 v[48:51], a[156:159], v[12:15], v[48:51]
  v_mfma_f32_16x16x32_bf16 v[52:55], a[212:215], v[12:15], v[52:55]
  s_waitcnt lgkmcnt(4)
  v_mfma_f32_16x16x32_bf16 v[56:59], a[44:47], v[16:19], v[56:59]
  s_waitcnt vmcnt(11)
  s_barrier
  ds_read_b128 v[8:11], v128 offset:0
  v_mfma_f32_16x16x32_bf16 v[60:63], a[100:103], v[16:19], v[60:63]
  v_mfma_f32_16x16x32_bf16 v[64:67], a[156:159], v[16:19], v[64:67]
  v_mfma_f32_16x16x32_bf16 v[68:71], a[212:215], v[16:19], v[68:71]
  s_waitcnt lgkmcnt(4)
  v_mfma_f32_16x16x32_bf16 v[40:43], a[48:51], v[20:23], v[40:43]
  ds_read_b128 v[12:15], v128 offset:14336
  v_mfma_f32_16x16x32_bf16 v[44:47], a[104:107], v[20:23], v[44:47]
  v_mfma_f32_16x16x32_bf16 v[48:51], a[160:163], v[20:23], v[48:51]
  v_mfma_f32_16x16x32_bf16 v[52:55], a[216:219], v[20:23], v[52:55]
  s_waitcnt lgkmcnt(4)
  v_mfma_f32_16x16x32_bf16 v[56:59], a[48:51], v[24:27], v[56:59]
  ds_read_b128 v[16:19], v128 offset:1024
  v_mfma_f32_16x16x32_bf16 v[60:63], a[104:107], v[24:27], v[60:63]
  v_mfma_f32_16x16x32_bf16 v[64:67], a[160:163], v[24:27], v[64:67]
  v_mfma_f32_16x16x32_bf16 v[68:71], a[216:219], v[24:27], v[68:71]
  s_waitcnt lgkmcnt(4)
  v_mfma_f32_16x16x32_bf16 v[40:43], a[52:55], v[28:31], v[40:43]
  ds_read_b128 v[20:23], v128 offset:15360
  v_mfma_f32_16x16x32_bf16 v[44:47], a[108:111], v[28:31], v[44:47]
  v_mfma_f32_16x16x32_bf16 v[48:51], a[164:167], v[28:31], v[48:51]
  v_mfma_f32_16x16x32_bf16 v[52:55], a[220:223], v[28:31], v[52:55]
  s_waitcnt lgkmcnt(4)
  v_mfma_f32_16x16x32_bf16 v[56:59], a[52:55], v[32:35], v[56:59]
  ds_read_b128 v[24:27], v128 offset:2048
  v_mfma_f32_16x16x32_bf16 v[60:63], a[108:111], v[32:35], v[60:63]
  v_mfma_f32_16x16x32_bf16 v[64:67], a[164:167], v[32:35], v[64:67]
  v_mfma_f32_16x16x32_bf16 v[68:71], a[220:223], v[32:35], v[68:71]
  s_waitcnt lgkmcnt(4)
  s_mov_b32 s40, s19
  s_mov_b32 s41, s29
  s_add_u32 s19, s19, 1
  s_cmp_lt_u32 s19, s35
  s_cbranch_scc0 wg_vo_e0
  v_mfma_f32_16x16x32_bf16 v[96:99], a[0:3], v[8:11], 0
  ds_read_b128 v[28:31], v128 offset:16384
  v_mfma_f32_16x16x32_bf16 v[100:103], a[56:59], v[8:11], 0
  v_mfma_f32_16x16x32_bf16 v[104:107], a[112:115], v[8:11], 0
  v_mfma_f32_16x16x32_bf16 v[108:111], a[168:171], v[8:11], 0
  s_waitcnt lgkmcnt(4)
  s_add_u32 s43, s41, 458752
  v_mfma_f32_16x16x32_bf16 v[112:115], a[0:3], v[12:15], 0
  ds_read_b128 v[32:35], v128 offset:3072
  v_mfma_f32_16x16x32_bf16 v[116:119], a[56:59], v[12:15], 0
  s_lshl_b32 s42, s40, 5
  s_add_u32 s42, s42, 0
  v_mfma_f32_16x16x32_bf16 v[120:123], a[112:115], v[12:15], 0
  v_add_u32 v88, s42, v4
  v_mul_u32_u24 v89, 2341, v88
  v_mfma_f32_16x16x32_bf16 v[124:127], a[168:171], v[12:15], 0
  s_waitcnt lgkmcnt(4)
  v_lshrrev_b32 v89, 16, v89
  v_mfma_f32_16x16x32_bf16 v[96:99], a[4:7], v[16:19], v[96:99]
  ds_read_b128 v[8:11], v128 offset:17408
  v_mfma_f32_16x16x32_bf16 v[100:103], a[60:63], v[16:19], v[100:103]
  v_mul_u32_u24 v92, 28, v89
  v_sub_u32 v92, v88, v92
  v_mfma_f32_16x16x32_bf16 v[104:107], a[116:119], v[16:19], v[104:107]
  v_cmp_gt_u32 vcc, 16, v92
  v_mul_u32_u24 v89, 84, v89
  v_mfma_f32_16x16x32_bf16 v[108:111], a[172:175], v[16:19], v[108:111]
  s_waitcnt lgkmcnt(4)
  v_cndmask_b32 v92, v7, v6, vcc
  v_mfma_f32_16x16x32_bf16 v[112:115], a[4:7], v[20:23], v[112:115]
  ds_read_b128 v[12:15], v128 offset:4096
  v_mfma_f32_16x16x32_bf16 v[116:119], a[60:63], v[20:23], v[116:119]
  v_add3_u32 v88, v88, v89, v92
  v_lshlrev_b32 v90, 4, v88
  v_mfma_f32_16x16x32_bf16 v[120:123], a[116:119], v[20:23], v[120:123]
  v_cvt_pk_bf16_f32 v72, v40, v44
  v_cvt_pk_bf16_f32 v73, v41, v45
  v_mfma_f32_16x16x32_bf16 v[124:127], a[172:175], v[20:23], v[124:127]
  s_waitcnt lgkmcnt(4)
  v_cvt_pk_bf16_f32 v74, v42, v46
  v_mfma_f32_16x16x32_bf16 v[96:99], a[8:11], v[24:27], v[96:99]
  ds_read_b128 v[16:19], v128 offset:18432
  v_mfma_f32_16x16x32_bf16 v[100:103], a[64:67], v[24:27], v[100:103]
  v_cvt_pk_bf16_f32 v75, v43, v47
  v_mfma_f32_16x16x32_bf16 v[104:107], a[120:123], v[24:27], v[104:107]
  buffer_store_dwordx4 v[72:75], v90, s[8:11], s41 offen sc1
  v_cvt_pk_bf16_f32 v76, v48, v52
  v_mfma_f32_16x16x32_bf16 v[108:111], a[176:179], v[24:27], v[108:111]
  s_waitcnt lgkmcnt(4)
  v_cvt_pk_bf16_f32 v77, v49, v53
  v_mfma_f32_16x16x32_bf16 v[112:115], a[8:11], v[28:31], v[112:115]
  ds_read_b128 v[20:23], v128 offset:5120
  v_mfma_f32_16x16x32_bf16 v[116:119], a[64:67], v[28:31], v[116:119]
  v_cvt_pk_bf16_f32 v78, v50, v54
  v_cvt_pk_bf16_f32 v79, v51, v55
  v_mfma_f32_16x16x32_bf16 v[120:123], a[120:123], v[28:31], v[120:123]
  buffer_store_dwordx4 v[76:79], v90, s[8:11], s43 offen sc1
  s_lshl_b32 s42, s40, 5
  v_mfma_f32_16x16x32_bf16 v[124:127], a[176:179], v[28:31], v[124:127]
  s_waitcnt lgkmcnt(4)
  s_add_u32 s42, s42, 16
  v_mfma_f32_16x16x32_bf16 v[96:99], a[12:15], v[32:35], v[96:99]
  ds_read_b128 v[24:27], v128 offset:19456
  v_mfma_f32_16x16x32_bf16 v[100:103], a[68:71], v[32:35], v[100:103]
  v_add_u32 v88, s42, v4
  v_mul_u32_u24 v89, 2341, v88
  v_mfma_f32_16x16x32_bf16 v[104:107], a[124:127], v[32:35], v[104:107]
  v_lshrrev_b32 v89, 16, v89
  v_mul_u32_u24 v92, 28, v89
  v_mfma_f32_16x16x32_bf16 v[108:111], a[180:183], v[32:35], v[108:111]
  s_waitcnt lgkmcnt(4)
  v_sub_u32 v92, v88, v92
  v_mfma_f32_16x16x32_bf16 v[112:115], a[12:15], v[8:11], v[112:115]
  ds_read_b128 v[28:31], v128 offset:6144
  v_mfma_f32_16x16x32_bf16 v[116:119], a[68:71], v[8:11], v[116:119]
  v_cmp_gt_u32 vcc, 16, v92
  v_mul_u32_u24 v89, 84, v89
  v_mfma_f32_16x16x32_bf16 v[120:123], a[124:127], v[8:11], v[120:123]
  v_cndmask_b32 v92, v7, v6, vcc
  v_add3_u32 v88, v88, v89, v92
  v_mfma_f32_16x16x32_bf16 v[124:127], a[180:183], v[8:11], v[124:127]
  s_waitcnt lgkmcnt(4)
  v_lshlrev_b32 v91, 4, v88
  v_mfma_f32_16x16x32_bf16 v[96:99], a[16:19], v[12:15], v[96:99]
  ds_read_b128 v[32:35], v128 offset:20480
  v_mfma_f32_16x16x32_bf16 v[100:103], a[72:75], v[12:15], v[100:103]
  v_cvt_pk_bf16_f32 v80, v56, v60
  v_cvt_pk_bf16_f32 v81, v57, v61
  v_mfma_f32_16x16x32_bf16 v[104:107], a[128:131], v[12:15], v[104:107]
  v_cvt_pk_bf16_f32 v82, v58, v62
  v_cvt_pk_bf16_f32 v83, v59, v63
  v_mfma_f32_16x16x32_bf16 v[108:111], a[184:187], v[12:15], v[108:111]
  s_waitcnt lgkmcnt(4)
  buffer_store_dwordx4 v[80:83], v91, s[8:11], s41 offen sc1
  v_mfma_f32_16x16x32_bf16 v[112:115], a[16:19], v[16:19], v[112:115]
  ds_read_b128 v[8:11], v128 offset:7168
  v_mfma_f32_16x16x32_bf16 v[116:119], a[72:75], v[16:19], v[116:119]
  v_cvt_pk_bf16_f32 v84, v64, v68
  v_cvt_pk_bf16_f32 v85, v65, v69
  v_mfma_f32_16x16x32_bf16 v[120:123], a[128:131], v[16:19], v[120:123]
  v_cvt_pk_bf16_f32 v86, v66, v70
  v_cvt_pk_bf16_f32 v87, v67, v71
  v_mfma_f32_16x16x32_bf16 v[124:127], a[184:187], v[16:19], v[124:127]
  s_waitcnt lgkmcnt(4)
  buffer_store_dwordx4 v[84:87], v91, s[8:11], s43 offen sc1
  v_mfma_f32_16x16x32_bf16 v[96:99], a[20:23], v[20:23], v[96:99]
  ds_read_b128 v[12:15], v128 offset:21504
  v_mfma_f32_16x16x32_bf16 v[100:103], a[76:79], v[20:23], v[100:103]
  s_add_u32 s30, s19, 2
  s_lshl_b32 s24, s30, 1
  s_mul_i32 s24, s24, 14336
  v_mfma_f32_16x16x32_bf16 v[104:107], a[132:135], v[20:23], v[104:107]
  s_add_u32 s24, s24, s23
  s_cmp_lt_u32 s30, s35
  s_cselect_b32 s24, s24, 0x40000000
  v_mfma_f32_16x16x32_bf16 v[108:111], a[188:191], v[20:23], v[108:111]
  s_waitcnt lgkmcnt(4)
  s_add_u32 m0, s33, s27
  s_nop 0
  buffer_load_dwordx4 v2, s[8:11], s24 offen offset:0 sc1 lds
  v_mfma_f32_16x16x32_bf16 v[112:115], a[20:23], v[24:27], v[112:115]
  ds_read_b128 v[16:19], v128 offset:8192
  v_mfma_f32_16x16x32_bf16 v[116:119], a[76:79], v[24:27], v[116:119]
  v_mfma_f32_16x16x32_bf16 v[120:123], a[132:135], v[24:27], v[120:123]
  v_mfma_f32_16x16x32_bf16 v[124:127], a[188:191], v[24:27], v[124:127]
  s_waitcnt lgkmcnt(4)
  v_mfma_f32_16x16x32_bf16 v[96:99], a[24:27], v[28:31], v[96:99]
  ds_read_b128 v[20:23], v128 offset:22528
  v_mfma_f32_16x16x32_bf16 v[100:103], a[80:83], v[28:31], v[100:103]
  buffer_load_dwordx4 v2, s[8:11], s24 offen offset:1024 sc1 lds
  v_mfma_f32_16x16x32_bf16 v[104:107], a[136:139], v[28:31], v[104:107]
  v_mfma_f32_16x16x32_bf16 v[108:111], a[192:195], v[28:31], v[108:111]
  s_waitcnt lgkmcnt(4)
  v_mfma_f32_16x16x32_bf16 v[112:115], a[24:27], v[32:35], v[112:115]
  ds_read_b128 v[24:27], v128 offset:9216
  v_mfma_f32_16x16x32_bf16 v[116:119], a[80:83], v[32:35], v[116:119]
  v_mfma_f32_16x16x32_bf16 v[120:123], a[136:139], v[32:35], v[120:123]
  buffer_load_dwordx4 v2, s[8:11], s24 offen offset:2048 sc1 lds
  v_mfma_f32_16x16x32_bf16 v[124:127], a[192:195], v[32:35], v[124:127]
  s_waitcnt lgkmcnt(4)
  v_mfma_f32_16x16x32_bf16 v[96:99], a[28:31], v[8:11], v[96:99]
  ds_read_b128 v[28:31], v128 offset:23552
  v_mfma_f32_16x16x32_bf16 v[100:103], a[84:87], v[8:11], v[100:103]
  v_mfma_f32_16x16x32_bf16 v[104:107], a[140:143], v[8:11], v[104:107]
  v_mfma_f32_16x16x32_bf16 v[108:111], a[196:199], v[8:11], v[108:111]
  s_waitcnt lgkmcnt(4)
  buffer_load_dwordx4 v2, s[8:11], s24 offen offset:3072 sc1 lds
  v_mfma_f32_16x16x32_bf16 v[112:115], a[28:31], v[12:15], v[112:115]
  ds_read_b128 v[32:35], v128 offset:10240
  v_mfma_f32_16x16x32_bf16 v[116:119], a[84:87], v[12:15], v[116:119]
  v_mfma_f32_16x16x32_bf16 v[120:123], a[140:143], v[12:15], v[120:123]
  v_mfma_f32_16x16x32_bf16 v[124:127], a[196:199], v[12:15], v[124:127]
  s_waitcnt lgkmcnt(4)
  v_mfma_f32_16x16x32_bf16 v[96:99], a[32:35], v[16:19], v[96:99]
  ds_read_b128 v[8:11], v128 offset:24576
  v_mfma_f32_16x16x32_bf16 v[100:103], a[88:91], v[16:19], v[100:103]
  s_add_u32 m0, m0, 4096
  s_add_u32 s24, s24, 4096
  buffer_load_dwordx4 v2, s[8:11], s24 offen offset:0 sc1 lds
  v_mfma_f32_16x16x32_bf16 v[104:107], a[144:147], v[16:19], v[104:107]
  v_mfma_f32_16x16x32_bf16 v[108:111], a[200:203], v[16:19], v[108:111]
  s_waitcnt lgkmcnt(4)
  v_mfma_f32_16x16x32_bf16 v[112:115], a[32:35], v[20:23], v[112:115]
  ds_read_b128 v[12:15], v128 offset:11264
  v_mfma_f32_16x16x32_bf16 v[116:119], a[88:91], v[20:23], v[116:119]
  v_mfma_f32_16x16x32_bf16 v[120:123], a[144:147], v[20:23], v[120:123]
  buffer_load_dwordx4 v2, s[8:11], s24 offen offset:1024 sc1 lds
  v_mfma_f32_16x16x32_bf16 v[124:127], a[200:203], v[20:23], v[124:127]
  s_waitcnt lgkmcnt(4)
  v_mfma_f32_16x16x32_bf16 v[96:99], a[36:39], v[24:27], v[96:99]
  ds_read_b128 v[16:19], v128 offset:25600
  v_mfma_f32_16x16x32_bf16 v[100:103], a[92:95], v[24:27], v[100:103]
  v_mfma_f32_16x16x32_bf16 v[104:107], a[148:151], v[24:27], v[104:107]
  v_mfma_f32_16x16x32_bf16 v[108:111], a[204:207], v[24:27], v[108:111]
  s_waitcnt lgkmcnt(4)
  buffer_load_dwordx4 v2, s[8:11], s24 offen offset:2048 sc1 lds
  v_mfma_f32_16x16x32_bf16 v[112:115], a[36:39], v[28:31], v[112:115]
  ds_read_b128 v[20:23], v128 offset:12288
  v_mfma_f32_16x16x32_bf16 v[116:119], a[92:95], v[28:31], v[116:119]
  v_mfma_f32_16x16x32_bf16 v[120:123], a[148:151], v[28:31], v[120:123]
  v_mfma_f32_16x16x32_bf16 v[124:127], a[204:207], v[28:31], v[124:127]
  s_waitcnt lgkmcnt(4)
  v_mfma_f32_16x16x32_bf16 v[96:99], a[40:43], v[32:35], v[96:99]
  ds_read_b128 v[24:27], v128 offset:26624
  v_mfma_f32_16x16x32_bf16 v[100:103], a[96:99], v[32:35], v[100:103]
  s_add_u32 s33, s33, 28672
  s_cmp_eq_u32 s33, 114688
  s_cselect_b32 s33, 0, s33
  v_mfma_f32_16x16x32_bf16 v[104:107], a[152:155], v[32:35], v[104:107]
  s_add_u32 s32, s32, 28672
  s_cmp_eq_u32 s32, 114688
  s_cselect_b32 s32, 0, s32
  v_mfma_f32_16x16x32_bf16 v[108:111], a[208:211], v[32:35], v[108:111]
  s_waitcnt lgkmcnt(4)
  v_add_u32 v5, s32, v2
  v_mfma_f32_16x16x32_bf16 v[112:115], a[40:43], v[8:11], v[112:115]
  ds_read_b128 v[28:31], v128 offset:13312
  v_mfma_f32_16x16x32_bf16 v[116:119], a[96:99], v[8:11], v[116:119]
  v_mfma_f32_16x16x32_bf16 v[120:123], a[152:155], v[8:11], v[120:123]
  v_mfma_f32_16x16x32_bf16 v[124:127], a[208:211], v[8:11], v[124:127]
  s_waitcnt lgkmcnt(4)
  v_mfma_f32_16x16x32_bf16 v[96:99], a[44:47], v[12:15], v[96:99]
  ds_read_b128 v[32:35], v128 offset:27648
  v_mfma_f32_16x16x32_bf16 v[100:103], a[100:103], v[12:15], v[100:103]
  v_mfma_f32_16x16x32_bf16 v[104:107], a[156:159], v[12:15], v[104:107]
  v_mfma_f32_16x16x32_bf16 v[108:111], a[212:215], v[12:15], v[108:111]
  s_waitcnt lgkmcnt(4)
  v_mfma_f32_16x16x32_bf16 v[112:115], a[44:47], v[16:19], v[112:115]
  s_waitcnt vmcnt(11)
  s_barrier
  ds_read_b128 v[8:11], v5 offset:0
  v_mfma_f32_16x16x32_bf16 v[116:119], a[100:103], v[16:19], v[116:119]
  v_mfma_f32_16x16x32_bf16 v[120:123], a[156:159], v[16:19], v[120:123]
  v_mfma_f32_16x16x32_bf16 v[124:127], a[212:215], v[16:19], v[124:127]
  s_waitcnt lgkmcnt(4)
  v_mfma_f32_16x16x32_bf16 v[96:99], a[48:51], v[20:23], v[96:99]
  ds_read_b128 v[12:15], v5 offset:14336
  v_mfma_f32_16x16x32_bf16 v[100:103], a[104:107], v[20:23], v[100:103]
  v_mfma_f32_16x16x32_bf16 v[104:107], a[160:163], v[20:23], v[104:107]
  v_mfma_f32_16x16x32_bf16 v[108:111], a[216:219], v[20:23], v[108:111]
  s_waitcnt lgkmcnt(4)
  v_mfma_f32_16x16x32_bf16 v[112:115], a[48:51], v[24:27], v[112:115]
  ds_read_b128 v[16:19], v5 offset:1024
  v_mfma_f32_16x16x32_bf16 v[116:119], a[104:107], v[24:27], v[116:119]
  v_mfma_f32_16x16x32_bf16 v[120:123], a[160:163], v[24:27], v[120:123]
  v_mfma_f32_16x16x32_bf16 v[124:127], a[216:219], v[24:27], v[124:127]
  s_waitcnt lgkmcnt(4)
  v_mfma_f32_16x16x32_bf16 v[96:99], a[52:55], v[28:31], v[96:99]
  ds_read_b128 v[20:23], v5 offset:15360
  v_mfma_f32_16x16x32_bf16 v[100:103], a[108:111], v[28:31], v[100:103]
  v_mfma_f32_16x16x32_bf16 v[104:107], a[164:167], v[28:31], v[104:107]
  v_mfma_f32_16x16x32_bf16 v[108:111], a[220:223], v[28:31], v[108:111]
  s_waitcnt lgkmcnt(4)
  v_mfma_f32_16x16x32_bf16 v[112:115], a[52:55], v[32:35], v[112:115]
  ds_read_b128 v[24:27], v5 offset:2048
  v_mfma_f32_16x16x32_bf16 v[116:119], a[108:111], v[32:35], v[116:119]
  v_mfma_f32_16x16x32_bf16 v[120:123], a[164:167], v[32:35], v[120:123]
  v_mfma_f32_16x16x32_bf16 v[124:127], a[220:223], v[32:35], v[124:127]
  s_waitcnt lgkmcnt(4)
  s_mov_b32 s40, s19
  s_mov_b32 s41, s29
  s_add_u32 s19, s19, 1
  s_cmp_lt_u32 s19, s35
  s_cbranch_scc1 wg_vo_loop
  s_nop 3
  s_add_u32 s43, s41, 458752
  s_lshl_b32 s42, s40, 5
  s_add_u32 s42, s42, 0
  v_add_u32 v88, s42, v4
  v_mul_u32_u24 v89, 2341, v88
  v_lshrrev_b32 v89, 16, v89
  v_mul_u32_u24 v92, 28, v89
  v_sub_u32 v92, v88, v92
  v_cmp_gt_u32 vcc, 16, v92
  v_mul_u32_u24 v89, 84, v89
  s_nop 0
  v_cndmask_b32 v92, v7, v6, vcc
  v_add3_u32 v88, v88, v89, v92
  v_lshlrev_b32 v90, 4, v88
  v_cvt_pk_bf16_f32 v72, v96, v100
  v_cvt_pk_bf16_f32 v73, v97, v101
  v_cvt_pk_bf16_f32 v74, v98, v102
  v_cvt_pk_bf16_f32 v75, v99, v103
  buffer_store_dwordx4 v[72:75], v90, s[8:11], s41 offen sc1
  v_cvt_pk_bf16_f32 v76, v104, v108
  v_cvt_pk_bf16_f32 v77, v105, v109
  v_cvt_pk_bf16_f32 v78, v106, v110
  v_cvt_pk_bf16_f32 v79, v107, v111
  buffer_store_dwordx4 v[76:79], v90, s[8:11], s43 offen sc1
  s_lshl_b32 s42, s40, 5
  s_add_u32 s42, s42, 16
  v_add_u32 v88, s42, v4
  v_mul_u32_u24 v89, 2341, v88
  v_lshrrev_b32 v89, 16, v89
  v_mul_u32_u24 v92, 28, v89
  v_sub_u32 v92, v88, v92
  v_cmp_gt_u32 vcc, 16, v92
  v_mul_u32_u24 v89, 84, v89
  s_nop 0
  v_cndmask_b32 v92, v7, v6, vcc
  v_add3_u32 v88, v88, v89, v92
  v_lshlrev_b32 v91, 4, v88
  v_cvt_pk_bf16_f32 v80, v112, v116
  v_cvt_pk_bf16_f32 v81, v113, v117
  v_cvt_pk_bf16_f32 v82, v114, v118
  v_cvt_pk_bf16_f32 v83, v115, v119
  buffer_store_dwordx4 v[80:83], v91, s[8:11], s41 offen sc1
  v_cvt_pk_bf16_f32 v84, v120, v124
  v_cvt_pk_bf16_f32 v85, v121, v125
  v_cvt_pk_bf16_f32 v86, v122, v126
  v_cvt_pk_bf16_f32 v87, v123, v127
  buffer_store_dwordx4 v[84:87], v91, s[8:11], s43 offen sc1
  s_branch wg_done
wg_vo_e0:
  s_nop 7
  s_add_u32 s43, s41, 458752
  s_lshl_b32 s42, s40, 5
  s_add_u32 s42, s42, 0
  v_add_u32 v88, s42, v4
  v_mul_u32_u24 v89, 2341, v88
  v_lshrrev_b32 v89, 16, v89
  v_mul_u32_u24 v92, 28, v89
  v_sub_u32 v92, v88, v92
  v_cmp_gt_u32 vcc, 16, v92
  v_mul_u32_u24 v89, 84, v89
  s_nop 0
  v_cndmask_b32 v92, v7, v6, vcc
  v_add3_u32 v88, v88, v89, v92
  v_lshlrev_b32 v90, 4, v88
  v_cvt_pk_bf16_f32 v72, v40, v44
  v_cvt_pk_bf16_f32 v73, v41, v45
  v_cvt_pk_bf16_f32 v74, v42, v46
  v_cvt_pk_bf16_f32 v75, v43, v47
  buffer_store_dwordx4 v[72:75], v90, s[8:11], s41 offen sc1
  v_cvt_pk_bf16_f32 v76, v48, v52
  v_cvt_pk_bf16_f32 v77, v49, v53
  v_cvt_pk_bf16_f32 v78, v50, v54
  v_cvt_pk_bf16_f32 v79, v51, v55
  buffer_store_dwordx4 v[76:79], v90, s[8:11], s43 offen sc1
  s_lshl_b32 s42, s40, 5
  s_add_u32 s42, s42, 16
  v_add_u32 v88, s42, v4
  v_mul_u32_u24 v89, 2341, v88
  v_lshrrev_b32 v89, 16, v89
  v_mul_u32_u24 v92, 28, v89
  v_sub_u32 v92, v88, v92
  v_cmp_gt_u32 vcc, 16, v92
  v_mul_u32_u24 v89, 84, v89
  s_nop 0
  v_cndmask_b32 v92, v7, v6, vcc
  v_add3_u32 v88, v88, v89, v92
  v_lshlrev_b32 v91, 4, v88
  v_cvt_pk_bf16_f32 v80, v56, v60
  v_cvt_pk_bf16_f32 v81, v57, v61
  v_cvt_pk_bf16_f32 v82, v58, v62
  v_cvt_pk_bf16_f32 v83, v59, v63
  buffer_store_dwordx4 v[80:83], v91, s[8:11], s41 offen sc1
  v_cvt_pk_bf16_f32 v84, v64, v68
  v_cvt_pk_bf16_f32 v85, v65, v69
  v_cvt_pk_bf16_f32 v86, v66, v70
  v_cvt_pk_bf16_f32 v87, v67, v71
  buffer_store_dwordx4 v[84:87], v91, s[8:11], s43 offen sc1
  s_branch wg_done
wg_done:
  s_lshl_b32 s20, s18, 4
  s_and_b32 s21, s17, 15
  s_add_u32 s20, s20, s21
  s_lshl_b32 s20, s20, 7
  s_cmp_lt_u32 s17, 16
  s_cselect_b32 s21, 16384, 0
  s_add_u32 s20, s20, s21
  s_add_u32 s20, s20, 524288
  s_sub_u32 s21, s35, s34
  s_lshl_b32 s21, s21, 2
  v_mov_b32 v5, s21
  v_mov_b32 v6, 0
  s_waitcnt vmcnt(0) lgkmcnt(0)
  s_barrier
  s_cmp_lg_u32 s16, 0
  s_cbranch_scc1 wg_sg
  s_mov_b64 exec, 1
  buffer_atomic_add v5, v6, s[8:11], s20 offen
  s_mov_b64 exec, -1
wg_sg:
  s_branch wk_loop
wk_srv:
  s_mov_b32 s96, 7
  v_mov_b32 v4, 1
  v_mov_b32 v5, 587392
  v_mov_b32 v6, 160000
  s_barrier
  s_cmp_lg_u32 s16, 0
  s_cbranch_scc1 wk_sve1
  s_mov_b64 exec, 1
  buffer_atomic_add v4, v5, s[8:11], 0 offen sc0
  s_waitcnt vmcnt(0)
  ds_write_b32 v6, v4
  s_waitcnt lgkmcnt(0)
  s_mov_b64 exec, -1
wk_sve1:
  s_barrier
  ds_read_b32 v4, v6
  s_waitcnt lgkmcnt(0)
  v_readfirstlane_b32 s3, v4
  v_and_b32 v1, 63, v0
  v_lshlrev_b32 v2, 4, v1
  v_lshrrev_b32 v3, 4, v1
  v_and_b32 v4, 15, v1
  v_mov_b32 v250, 0
  s_cmp_ge_u32 s3, 32
  s_cbranch_scc1 wk_ask
  s_and_b32 s18, s3, 15
  s_lshr_b32 s19, s3, 4
  s_and_b32 s19, s19, 1
  s_mul_i32 s20, s18, 401408
  s_mul_i32 s21, s16, 100352
  s_add_u32 s20, s20, s21
  s_add_u32 s20, s20, 39976960
  s_add_u32 s22, s20, 0
  buffer_load_dwordx4 a[0:3], v2, s[8:11], s22 offen offset:0 sc1
  buffer_load_dwordx4 a[4:7], v2, s[8:11], s22 offen offset:1024 sc1
  buffer_load_dwordx4 a[8:11], v2, s[8:11], s22 offen offset:2048 sc1
  buffer_load_dwordx4 a[12:15], v2, s[8:11], s22 offen offset:3072 sc1
  s_add_u32 s22, s20, 4096
  buffer_load_dwordx4 a[16:19], v2, s[8:11], s22 offen offset:0 sc1
  buffer_load_dwordx4 a[20:23], v2, s[8:11], s22 offen offset:1024 sc1
  buffer_load_dwordx4 a[24:27], v2, s[8:11], s22 offen offset:2048 sc1
  buffer_load_dwordx4 a[28:31], v2, s[8:11], s22 offen offset:3072 sc1
  s_add_u32 s22, s20, 8192
  buffer_load_dwordx4 a[32:35], v2, s[8:11], s22 offen offset:0 sc1
  buffer_load_dwordx4 a[36:39], v2, s[8:11], s22 offen offset:1024 sc1
  s_waitcnt vmcnt(8)
  buffer_load_dwordx4 a[40:43], v2, s[8:11], s22 offen offset:2048 sc1
  buffer_load_dwordx4 a[44:47], v2, s[8:11], s22 offen offset:3072 sc1
  s_waitcnt vmcnt(8)
  s_add_u32 s22, s20, 12288
  buffer_load_dwordx4 a[48:51], v2, s[8:11], s22 offen offset:0 sc1
  buffer_load_dwordx4 a[52:55], v2, s[8:11], s22 offen offset:1024 sc1
  s_waitcnt vmcnt(8)
  buffer_load_dwordx4 a[56:59], v2, s[8:11], s22 offen offset:2048 sc1
  buffer_load_dwordx4 a[60:63], v2, s[8:11], s22 offen offset:3072 sc1
  s_waitcnt vmcnt(8)
  s_add_u32 s22, s20, 16384
  buffer_load_dwordx4 a[64:67], v2, s[8:11], s22 offen offset:0 sc1
  buffer_load_dwordx4 a[68:71], v2, s[8:11], s22 offen offset:1024 sc1
  s_waitcnt vmcnt(8)
  buffer_load_dwordx4 a[72:75], v2, s[8:11], s22 offen offset:2048 sc1
  buffer_load_dwordx4 a[76:79], v2, s[8:11], s22 offen offset:3072 sc1
  s_waitcnt vmcnt(8)
  s_add_u32 s22, s20, 20480
  buffer_load_dwordx4 a[80:83], v2, s[8:11], s22 offen offset:0 sc1
  buffer_load_dwordx4 a[84:87], v2, s[8:11], s22 offen offset:1024 sc1
  s_waitcnt vmcnt(8)
  buffer_load_dwordx4 a[88:91], v2, s[8:11], s22 offen offset:2048 sc1
  buffer_load_dwordx4 a[92:95], v2, s[8:11], s22 offen offset:3072 sc1
  s_waitcnt vmcnt(8)
  s_add_u32 s22, s20, 24576
  buffer_load_dwordx4 a[96:99], v2, s[8:11], s22 offen offset:0 sc1
  buffer_load_dwordx4 a[100:103], v2, s[8:11], s22 offen offset:1024 sc1
  s_waitcnt vmcnt(8)
  buffer_load_dwordx4 a[104:107], v2, s[8:11], s22 offen offset:2048 sc1
  buffer_load_dwordx4 a[108:111], v2, s[8:11], s22 offen offset:3072 sc1
  s_waitcnt vmcnt(8)
  s_add_u32 s22, s20, 28672
  buffer_load_dwordx4 a[112:115], v2, s[8:11], s22 offen offset:0 sc1
  buffer_load_dwordx4 a[116:119], v2, s[8:11], s22 offen offset:1024 sc1
  s_waitcnt vmcnt(8)
  buffer_load_dwordx4 a[120:123], v2, s[8:11], s22 offen offset:2048 sc1
  buffer_load_dwordx4 a[124:127], v2, s[8:11], s22 offen offset:3072 sc1
  s_waitcnt vmcnt(8)
  s_add_u32 s22, s20, 32768
  buffer_load_dwordx4 a[128:131], v2, s[8:11], s22 offen offset:0 sc1
  buffer_load_dwordx4 a[132:135], v2, s[8:11], s22 offen offset:1024 sc1
  s_waitcnt vmcnt(8)
  buffer_load_dwordx4 a[136:139], v2, s[8:11], s22 offen offset:2048 sc1
  buffer_load_dwordx4 a[140:143], v2, s[8:11], s22 offen offset:3072 sc1
  s_waitcnt vmcnt(8)
  s_add_u32 s22, s20, 36864
  buffer_load_dwordx4 a[144:147], v2, s[8:11], s22 offen offset:0 sc1
  buffer_load_dwordx4 a[148:151], v2, s[8:11], s22 offen offset:1024 sc1
  s_waitcnt vmcnt(8)
  buffer_load_dwordx4 a[152:155], v2, s[8:11], s22 offen offset:2048 sc1
  buffer_load_dwordx4 a[156:159], v2, s[8:11], s22 offen offset:3072 sc1
  s_waitcnt vmcnt(8)
  s_add_u32 s22, s20, 40960
  buffer_load_dwordx4 a[160:163], v2, s[8:11], s22 offen offset:0 sc1
  buffer_load_dwordx4 a[164:167], v2, s[8:11], s22 offen offset:1024 sc1
  s_waitcnt vmcnt(8)
  buffer_load_dwordx4 a[168:171], v2, s[8:11], s22 offen offset:2048 sc1
  buffer_load_dwordx4 a[172:175], v2, s[8:11], s22 offen offset:3072 sc1
  s_waitcnt vmcnt(8)
  s_add_u32 s22, s20, 45056
  buffer_load_dwordx4 a[176:179], v2, s[8:11], s22 offen offset:0 sc1
  buffer_load_dwordx4 a[180:183], v2, s[8:11], s22 offen offset:1024 sc1
  s_waitcnt vmcnt(8)
  buffer_load_dwordx4 a[184:187], v2, s[8:11], s22 offen offset:2048 sc1
  buffer_load_dwordx4 a[188:191], v2, s[8:11], s22 offen offset:3072 sc1
  s_waitcnt vmcnt(8)
  s_add_u32 s22, s20, 49152
  buffer_load_dwordx4 a[192:195], v2, s[8:11], s22 offen offset:0 sc1
  buffer_load_dwordx4 a[196:199], v2, s[8:11], s22 offen offset:1024 sc1
  s_waitcnt vmcnt(8)
  buffer_load_dwordx4 a[200:203], v2, s[8:11], s22 offen offset:2048 sc1
  buffer_load_dwordx4 a[204:207], v2, s[8:11], s22 offen offset:3072 sc1
  s_waitcnt vmcnt(8)
  s_add_u32 s22, s20, 53248
  buffer_load_dwordx4 a[208:211], v2, s[8:11], s22 offen offset:0 sc1
  buffer_load_dwordx4 a[212:215], v2, s[8:11], s22 offen offset:1024 sc1
  s_waitcnt vmcnt(8)
  buffer_load_dwordx4 a[216:219], v2, s[8:11], s22 offen offset:2048 sc1
  buffer_load_dwordx4 a[220:223], v2, s[8:11], s22 offen offset:3072 sc1
  s_waitcnt vmcnt(8)
  s_add_u32 s22, s20, 57344
  buffer_load_dwordx4 a[224:227], v2, s[8:11], s22 offen offset:0 sc1
  buffer_load_dwordx4 a[228:231], v2, s[8:11], s22 offen offset:1024 sc1
  s_waitcnt vmcnt(8)
  buffer_load_dwordx4 a[232:235], v2, s[8:11], s22 offen offset:2048 sc1
  buffer_load_dwordx4 a[236:239], v2, s[8:11], s22 offen offset:3072 sc1
  s_waitcnt vmcnt(8)
  s_add_u32 s22, s20, 61440
  buffer_load_dwordx4 a[240:243], v2, s[8:11], s22 offen offset:0 sc1
  buffer_load_dwordx4 a[244:247], v2, s[8:11], s22 offen offset:1024 sc1
  s_waitcnt vmcnt(8)
  buffer_load_dwordx4 a[248:251], v2, s[8:11], s22 offen offset:2048 sc1
  buffer_load_dwordx4 a[252:255], v2, s[8:11], s22 offen offset:3072 sc1
  s_waitcnt vmcnt(8)
  s_add_u32 s22, s20, 65536
  buffer_load_dwordx4 v[120:123], v2, s[8:11], s22 offen offset:0 sc1
  buffer_load_dwordx4 v[124:127], v2, s[8:11], s22 offen offset:1024 sc1
  s_waitcnt vmcnt(8)
  buffer_load_dwordx4 v[128:131], v2, s[8:11], s22 offen offset:2048 sc1
  buffer_load_dwordx4 v[132:135], v2, s[8:11], s22 offen offset:3072 sc1
  s_waitcnt vmcnt(8)
  s_add_u32 s22, s20, 69632
  buffer_load_dwordx4 v[136:139], v2, s[8:11], s22 offen offset:0 sc1
  buffer_load_dwordx4 v[140:143], v2, s[8:11], s22 offen offset:1024 sc1
  s_waitcnt vmcnt(8)
  buffer_load_dwordx4 v[144:147], v2, s[8:11], s22 offen offset:2048 sc1
  buffer_load_dwordx4 v[148:151], v2, s[8:11], s22 offen offset:3072 sc1
  s_waitcnt vmcnt(8)
  s_add_u32 s22, s20, 73728
  buffer_load_dwordx4 v[152:155], v2, s[8:11], s22 offen offset:0 sc1
  buffer_load_dwordx4 v[156:159], v2, s[8:11], s22 offen offset:1024 sc1
  s_waitcnt vmcnt(8)
  buffer_load_dwordx4 v[160:163], v2, s[8:11], s22 offen offset:2048 sc1
  buffer_load_dwordx4 v[164:167], v2, s[8:11], s22 offen offset:3072 sc1
  s_waitcnt vmcnt(8)
  s_add_u32 s22, s20, 77824
  buffer_load_dwordx4 v[168:171], v2, s[8:11], s22 offen offset:0 sc1
  buffer_load_dwordx4 v[172:175], v2, s[8:11], s22 offen offset:1024 sc1
  s_waitcnt vmcnt(8)
  buffer_load_dwordx4 v[176:179], v2, s[8:11], s22 offen offset:2048 sc1
  buffer_load_dwordx4 v[180:183], v2, s[8:11], s22 offen offset:3072 sc1
  s_waitcnt vmcnt(8)
  s_add_u32 s22, s20, 81920
  buffer_load_dwordx4 v[184:187], v2, s[8:11], s22 offen offset:0 sc1
  buffer_load_dwordx4 v[188:191], v2, s[8:11], s22 offen offset:1024 sc1
  s_waitcnt vmcnt(8)
  buffer_load_dwordx4 v[192:195], v2, s[8:11], s22 offen offset:2048 sc1
  buffer_load_dwordx4 v[196:199], v2, s[8:11], s22 offen offset:3072 sc1
  s_waitcnt vmcnt(8)
  s_add_u32 s22, s20, 86016
  buffer_load_dwordx4 v[200:203], v2, s[8:11], s22 offen offset:0 sc1
  buffer_load_dwordx4 v[204:207], v2, s[8:11], s22 offen offset:1024 sc1
  s_waitcnt vmcnt(8)
  buffer_load_dwordx4 v[208:211], v2, s[8:11], s22 offen offset:2048 sc1
  buffer_load_dwordx4 v[212:215], v2, s[8:11], s22 offen offset:3072 sc1
  s_waitcnt vmcnt(8)
  s_add_u32 s22, s20, 90112
  buffer_load_dwordx4 v[216:219], v2, s[8:11], s22 offen offset:0 sc1
  buffer_load_dwordx4 v[220:223], v2, s[8:11], s22 offen offset:1024 sc1
  s_waitcnt vmcnt(8)
  buffer_load_dwordx4 v[224:227], v2, s[8:11], s22 offen offset:2048 sc1
  buffer_load_dwordx4 v[228:231], v2, s[8:11], s22 offen offset:3072 sc1
  s_waitcnt vmcnt(8)
  s_add_u32 s22, s20, 94208
  buffer_load_dwordx4 v[232:235], v2, s[8:11], s22 offen offset:0 sc1
  buffer_load_dwordx4 v[236:239], v2, s[8:11], s22 offen offset:1024 sc1
  s_waitcnt vmcnt(8)
  buffer_load_dwordx4 v[240:243], v2, s[8:11], s22 offen offset:2048 sc1
  buffer_load_dwordx4 v[244:247], v2, s[8:11], s22 offen offset:3072 sc1
  s_waitcnt vmcnt(8)
  s_add_u32 s22, s20, 98304
  buffer_load_dwordx4 v[248:251], v2, s[8:11], s22 offen offset:0 sc1
  buffer_load_dwordx4 v[252:255], v2, s[8:11], s22 offen offset:1024 sc1
  s_waitcnt vmcnt(8)
  v_mov_b32 v5, 0x4444
  v_mov_b32 v6, 0xeeee
  v_cmp_lt_u32 vcc, 7, v4
  s_nop 1
  v_cndmask_b32 v5, v5, v6, vcc
  s_lshl_b32 s23, s16, 11
  v_lshrrev_b32 v80, 1, v3
  v_and_b32 v81, 1, v3
  v_add_u32 v82, 0, v80
  v_lshl_add_u32 v82, v82, 4, v4
  v_mul_u32_u24 v83, 2341, v82
  v_lshrrev_b32 v83, 16, v83
  v_mul_u32_u24 v84, 28, v83
  v_sub_u32 v84, v82, v84
  v_lshrrev_b32 v85, 4, v84
  v_and_b32 v84, 15, v84
  v_lshlrev_b32 v86, 10, v85
  v_lshl_add_u32 v86, v83, 8, v86
  v_lshl_add_u32 v86, v84, 4, v86
  v_lshl_add_u32 v86, v81, 3, v86
  v_add_u32 v72, s23, v86
  v_add_u32 v82, 2, v80
  v_lshl_add_u32 v82, v82, 4, v4
  v_mul_u32_u24 v83, 2341, v82
  v_lshrrev_b32 v83, 16, v83
  v_mul_u32_u24 v84, 28, v83
  v_sub_u32 v84, v82, v84
  v_lshrrev_b32 v85, 4, v84
  v_and_b32 v84, 15, v84
  v_lshlrev_b32 v86, 10, v85
  v_lshl_add_u32 v86, v83, 8, v86
  v_lshl_add_u32 v86, v84, 4, v86
  v_lshl_add_u32 v86, v81, 3, v86
  v_add_u32 v73, s23, v86
  v_add_u32 v82, 4, v80
  v_lshl_add_u32 v82, v82, 4, v4
  v_mul_u32_u24 v83, 2341, v82
  v_lshrrev_b32 v83, 16, v83
  v_mul_u32_u24 v84, 28, v83
  v_sub_u32 v84, v82, v84
  v_lshrrev_b32 v85, 4, v84
  v_and_b32 v84, 15, v84
  v_lshlrev_b32 v86, 10, v85
  v_lshl_add_u32 v86, v83, 8, v86
  v_lshl_add_u32 v86, v84, 4, v86
  v_lshl_add_u32 v86, v81, 3, v86
  v_add_u32 v74, s23, v86
  v_mov_b32 v82, 6
  v_lshl_add_u32 v82, v82, 4, v4
  v_mul_u32_u24 v83, 2341, v82
  v_lshrrev_b32 v83, 16, v83
  v_mul_u32_u24 v84, 28, v83
  v_sub_u32 v84, v82, v84
  v_lshrrev_b32 v85, 4, v84
  v_and_b32 v84, 15, v84
  v_lshlrev_b32 v86, 10, v85
  v_lshl_add_u32 v86, v83, 8, v86
  v_lshl_add_u32 v86, v84, 4, v86
  v_lshl_add_u32 v86, v81, 3, v86
  v_add_u32 v75, s23, v86
  v_add_u32 v76, s23, v2
  s_mul_i32 s27, s18, 448
  v_mov_b32 v77, s27
  v_mov_b32 v78, 1
  s_mov_b32 s17, s19
  s_mul_i32 s24, s19, 7168
  s_add_u32 s24, s24, 65536
  s_mul_i32 s25, s18, 65
  s_add_u32 s25, s25, s19
  s_lshl_b32 s25, s25, 13
  s_add_u32 s25, s25, s23
  s_add_u32 s25, s25, 77602816
  s_lshl_b32 s26, s18, 6
  s_add_u32 s26, s26, s19
  s_lshl_b32 s26, s26, 4
  s_lshl_b32 s27, s16, 2
  s_add_u32 s26, s26, s27
  s_add_u32 s26, s26, 565248
  v_mov_b32 v88, 0
  v_mov_b32 v89, 0
  v_mov_b32 v90, 0
  v_mov_b32 v91, 0
  v_mov_b32 v92, -1
  v_mov_b32 v93, -1
  v_mov_b32 v94, -1
  v_mov_b32 v95, -1
  ds_write_b128 v76, v[88:91]
  ds_write_b128 v76, v[88:91] offset:1024
  s_mov_b32 s28, s25
  s_mov_b32 s29, 0
ws_arm:
  buffer_store_dwordx4 v[92:95], v2, s[8:11], s28 offen sc1
  buffer_store_dwordx4 v[92:95], v2, s[8:11], s28 offen offset:1024 sc1
  s_waitcnt vmcnt(8)
  s_add_u32 s28, s28, 16384
  s_add_u32 s29, s29, 1
  s_cmp_lt_u32 s29, 31
  s_cbranch_scc1 ws_arm
  s_waitcnt vmcnt(0)
  s_mov_b64 exec, 1
  buffer_store_dword v78, v2, s[8:11], s26 offen sc1
  s_mov_b64 exec, -1
ws_loop:
  v_mov_b32 v36, 0
  v_mov_b32 v37, 0
  v_mov_b32 v38, 0
  v_mov_b32 v39, 0
  v_mov_b32 v40, 0
  v_mov_b32 v41, 0
  v_mov_b32 v42, 0
  v_mov_b32 v43, 0
  v_mov_b32 v44, 0
  v_mov_b32 v45, 0
  v_mov_b32 v46, 0
  v_mov_b32 v47, 0
  v_mov_b32 v48, 0
  v_mov_b32 v49, 0
  v_mov_b32 v50, 0
  v_mov_b32 v51, 0
  v_mov_b32 v52, 0
  v_mov_b32 v53, 0
  v_mov_b32 v54, 0
  v_mov_b32 v55, 0
  v_mov_b32 v56, 0
  v_mov_b32 v57, 0
  v_mov_b32 v58, 0
  v_mov_b32 v59, 0
  v_mov_b32 v60, 0
  v_mov_b32 v61, 0
  v_mov_b32 v62, 0
  v_mov_b32 v63, 0
  s_mov_b32 s30, 0
  s_branch ws_fl
ws_pm:
  s_cmp_ge_u32 s17, 64
  s_cbranch_scc1 ws_fl
  buffer_load_dword v79, v77, s[8:11], s24 offen sc1
  s_waitcnt vmcnt(0)
  v_cmp_eq_u32 vcc, -1, v79
  s_cbranch_vccnz ws_pr
ws_fl:
  s_add_u32 s22, s24, 4096
  buffer_load_dwordx4 v[8:11], v2, s[8:11], s24 offen offset:0 sc1
  buffer_load_dwordx4 v[12:15], v2, s[8:11], s24 offen offset:1024 sc1
  buffer_load_dwordx4 v[16:19], v2, s[8:11], s24 offen offset:2048 sc1
  buffer_load_dwordx4 v[20:23], v2, s[8:11], s24 offen offset:3072 sc1
  buffer_load_dwordx4 v[24:27], v2, s[8:11], s22 offen offset:0 sc1
  buffer_load_dwordx4 v[28:31], v2, s[8:11], s22 offen offset:1024 sc1
  buffer_load_dwordx4 v[32:35], v2, s[8:11], s22 offen offset:2048 sc1
  s_waitcnt vmcnt(0)
  v_max_u32 v79, v8, v9
  v_max3_u32 v79, v79, v10, v11
  v_max3_u32 v79, v79, v12, v13
  v_max3_u32 v79, v79, v14, v15
  v_max3_u32 v79, v79, v16, v17
  v_max3_u32 v79, v79, v18, v19
  v_max3_u32 v79, v79, v20, v21
  v_max3_u32 v79, v79, v22, v23
  v_max3_u32 v79, v79, v24, v25
  v_max3_u32 v79, v79, v26, v27
  v_max3_u32 v79, v79, v28, v29
  v_max3_u32 v79, v79, v30, v31
  v_max3_u32 v79, v79, v32, v33
  v_max3_u32 v79, v79, v34, v35
  v_cmp_eq_u32 vcc, -1, v79
  s_cbranch_vccz ws_pk
ws_pr:
  s_sleep 20
  s_add_u32 s30, s30, 1
  s_cmp_lt_u32 s30, 2000000
  s_cbranch_scc1 ws_pm
  s_branch cA_abort
ws_pk:
  v_smfmac_f32_16x16x64_bf16 v[36:39], v[8:11], a[0:7], v5
  v_smfmac_f32_16x16x64_bf16 v[36:39], v[12:15], a[8:15], v5
  v_smfmac_f32_16x16x64_bf16 v[36:39], v[16:19], a[16:23], v5
  v_smfmac_f32_16x16x64_bf16 v[36:39], v[20:23], a[24:31], v5
  v_smfmac_f32_16x16x64_bf16 v[36:39], v[24:27], a[32:39], v5
  v_smfmac_f32_16x16x64_bf16 v[36:39], v[28:31], a[40:47], v5
  v_smfmac_f32_16x16x64_bf16 v[36:39], v[32:35], a[48:55], v5
  v_smfmac_f32_16x16x64_bf16 v[40:43], v[8:11], a[56:63], v5
  v_smfmac_f32_16x16x64_bf16 v[40:43], v[12:15], a[64:71], v5
  v_smfmac_f32_16x16x64_bf16 v[40:43], v[16:19], a[72:79], v5
  v_smfmac_f32_16x16x64_bf16 v[40:43], v[20:23], a[80:87], v5
  v_smfmac_f32_16x16x64_bf16 v[40:43], v[24:27], a[88:95], v5
  v_smfmac_f32_16x16x64_bf16 v[40:43], v[28:31], a[96:103], v5
  v_smfmac_f32_16x16x64_bf16 v[40:43], v[32:35], a[104:111], v5
  v_smfmac_f32_16x16x64_bf16 v[44:47], v[8:11], a[112:119], v5
  v_smfmac_f32_16x16x64_bf16 v[44:47], v[12:15], a[120:127], v5
  v_smfmac_f32_16x16x64_bf16 v[44:47], v[16:19], a[128:135], v5
  v_smfmac_f32_16x16x64_bf16 v[44:47], v[20:23], a[136:143], v5
  v_smfmac_f32_16x16x64_bf16 v[44:47], v[24:27], a[144:151], v5
  v_smfmac_f32_16x16x64_bf16 v[44:47], v[28:31], a[152:159], v5
  v_smfmac_f32_16x16x64_bf16 v[44:47], v[32:35], a[160:167], v5
  v_smfmac_f32_16x16x64_bf16 v[48:51], v[8:11], a[168:175], v5
  v_smfmac_f32_16x16x64_bf16 v[48:51], v[12:15], a[176:183], v5
  v_smfmac_f32_16x16x64_bf16 v[48:51], v[16:19], a[184:191], v5
  v_smfmac_f32_16x16x64_bf16 v[48:51], v[20:23], a[192:199], v5
  v_smfmac_f32_16x16x64_bf16 v[48:51], v[24:27], a[200:207], v5
  v_smfmac_f32_16x16x64_bf16 v[48:51], v[28:31], a[208:215], v5
  v_smfmac_f32_16x16x64_bf16 v[48:51], v[32:35], a[216:223], v5
  v_smfmac_f32_16x16x64_bf16 v[52:55], v[8:11], a[224:231], v5
  v_smfmac_f32_16x16x64_bf16 v[52:55], v[12:15], a[232:239], v5
  v_smfmac_f32_16x16x64_bf16 v[52:55], v[16:19], a[240:247], v5
  v_smfmac_f32_16x16x64_bf16 v[52:55], v[20:23], a[248:255], v5
  v_smfmac_f32_16x16x64_bf16 v[52:55], v[24:27], v[120:127], v5
  v_smfmac_f32_16x16x64_bf16 v[52:55], v[28:31], v[128:135], v5
  v_smfmac_f32_16x16x64_bf16 v[52:55], v[32:35], v[136:143], v5
  v_smfmac_f32_16x16x64_bf16 v[56:59], v[8:11], v[144:151], v5
  v_smfmac_f32_16x16x64_bf16 v[56:59], v[12:15], v[152:159], v5
  v_smfmac_f32_16x16x64_bf16 v[56:59], v[16:19], v[160:167], v5
  v_smfmac_f32_16x16x64_bf16 v[56:59], v[20:23], v[168:175], v5
  v_smfmac_f32_16x16x64_bf16 v[56:59], v[24:27], v[176:183], v5
  v_smfmac_f32_16x16x64_bf16 v[56:59], v[28:31], v[184:191], v5
  v_smfmac_f32_16x16x64_bf16 v[56:59], v[32:35], v[192:199], v5
  v_smfmac_f32_16x16x64_bf16 v[60:63], v[8:11], v[200:207], v5
  v_smfmac_f32_16x16x64_bf16 v[60:63], v[12:15], v[208:215], v5
  v_smfmac_f32_16x16x64_bf16 v[60:63], v[16:19], v[216:223], v5
  v_smfmac_f32_16x16x64_bf16 v[60:63], v[20:23], v[224:231], v5
  v_smfmac_f32_16x16x64_bf16 v[60:63], v[24:27], v[232:239], v5
  v_smfmac_f32_16x16x64_bf16 v[60:63], v[28:31], v[240:247], v5
  v_smfmac_f32_16x16x64_bf16 v[60:63], v[32:35], v[248:255], v5
  v_permlane32_swap_b32 v36, v40
  v_permlane32_swap_b32 v37, v41
  v_permlane32_swap_b32 v38, v42
  v_permlane32_swap_b32 v39, v43
  v_add_f32 v36, v36, v40
  v_add_f32 v37, v37, v41
  v_add_f32 v38, v38, v42
  v_add_f32 v39, v39, v43
  v_cvt_pk_bf16_f32 v40, v36, v37
  v_cvt_pk_bf16_f32 v41, v38, v39
  v_min_u32 v40, -2, v40
  v_min_u32 v41, -2, v41
  ds_write_b64 v72, v[40:41]
  v_permlane32_swap_b32 v44, v48
  v_permlane32_swap_b32 v45, v49
  v_permlane32_swap_b32 v46, v50
  v_permlane32_swap_b32 v47, v51
  v_add_f32 v44, v44, v48
  v_add_f32 v45, v45, v49
  v_add_f32 v46, v46, v50
  v_add_f32 v47, v47, v51
  v_cvt_pk_bf16_f32 v48, v44, v45
  v_cvt_pk_bf16_f32 v49, v46, v47
  v_min_u32 v48, -2, v48
  v_min_u32 v49, -2, v49
  ds_write_b64 v73, v[48:49]
  v_permlane32_swap_b32 v52, v56
  v_permlane32_swap_b32 v53, v57
  v_permlane32_swap_b32 v54, v58
  v_permlane32_swap_b32 v55, v59
  v_add_f32 v52, v52, v56
  v_add_f32 v53, v53, v57
  v_add_f32 v54, v54, v58
  v_add_f32 v55, v55, v59
  v_cvt_pk_bf16_f32 v56, v52, v53
  v_cvt_pk_bf16_f32 v57, v54, v55
  v_min_u32 v56, -2, v56
  v_min_u32 v57, -2, v57
  ds_write_b64 v74, v[56:57]
  v_mov_b32 v64, v60
  v_mov_b32 v65, v61
  v_mov_b32 v66, v62
  v_mov_b32 v67, v63
  v_permlane32_swap_b32 v60, v64
  v_permlane32_swap_b32 v61, v65
  v_permlane32_swap_b32 v62, v66
  v_permlane32_swap_b32 v63, v67
  v_add_f32 v60, v60, v64
  v_add_f32 v61, v61, v65
  v_add_f32 v62, v62, v66
  v_add_f32 v63, v63, v67
  v_cvt_pk_bf16_f32 v64, v60, v61
  v_cvt_pk_bf16_f32 v65, v62, v63
  v_min_u32 v64, -2, v64
  v_min_u32 v65, -2, v65
  ds_write_b64 v75, v[64:65]
  s_waitcnt lgkmcnt(0)
  ds_read_b128 v[64:67], v76
  ds_read_b128 v[68:71], v76 offset:1024
  s_waitcnt lgkmcnt(0)
  buffer_store_dwordx4 v[64:67], v2, s[8:11], s25 offen sc1
  buffer_store_dwordx4 v[68:71], v2, s[8:11], s25 offen offset:1024 sc1
  s_add_u32 s24, s24, 14336
  s_add_u32 s25, s25, 16384
  s_add_u32 s17, s17, 2
  s_cmp_lt_u32 s17, 62
  s_cbranch_scc1 ws_loop
  v_mov_b32 v250, 0
  s_branch wk_loop
wk_s4d:
  s_sub_u32 s3, s3, 640
  s_getreg_b32 s33, hwreg(HW_REG_XCC_ID)
  s_sub_u32 s33, s33, 4
  s_and_b32 s33, s33, 7
  s_min_u32 s33, s33, 6
  s_mov_b32 s35, 6
wk_s4c:
  s_lshl_b32 s34, s33, 7
  s_add_u32 s34, s34, 588416
  v_mov_b32 v4, 1
  v_mov_b32 v5, s34
  v_mov_b32 v6, 160000
  s_barrier
  s_cmp_lg_u32 s16, 0
  s_cbranch_scc1 wk_s4e1
  s_mov_b64 exec, 1
  buffer_atomic_add v4, v5, s[8:11], 0 offen sc0
  s_waitcnt vmcnt(0)
  ds_write_b32 v6, v4
  s_waitcnt lgkmcnt(0)
  s_mov_b64 exec, -1
wk_s4e1:
  s_barrier
  ds_read_b32 v4, v6
  s_waitcnt lgkmcnt(0)
  v_readfirstlane_b32 s3, v4
  s_cmp_lt_u32 s3, 16
  s_cbranch_scc1 wk_s4g
  s_mov_b32 s33, s35
  s_sub_u32 s35, s35, 1
  s_max_i32 s35, s35, 0
  s_branch wk_s4c
wk_s4g:
  s_lshl_b32 s33, s33, 4
  s_add_u32 s3, s3, s33
  s_load_dwordx8 s[40:47], s[0:1], 0
  s_load_dwordx4 s[48:51], s[0:1], 32
  s_load_dwordx2 s[52:53], s[0:1], 48
  s_load_dwordx2 s[54:55], s[0:1], 112
  v_lshrrev_b32 v1, 6, v0
  s_nop 0
  v_readfirstlane_b32 s16, v1
  v_and_b32 v1, 63, v0
  v_lshrrev_b32 v3, 4, v1
  v_and_b32 v4, 15, v1
  s_mul_i32 s17, s16, 24576
  s_waitcnt lgkmcnt(0)
  s_mov_b32 s60, s40
  s_and_b32 s61, s41, 0xffff
  s_mov_b32 s62, 1835008
  s_mov_b32 s63, 0x20000
  s_mov_b32 s64, s42
  s_and_b32 s65, s43, 0xffff
  s_mov_b32 s66, 229376
  s_mov_b32 s67, 0x20000
  s_mov_b32 s68, s44
  s_and_b32 s69, s45, 0xffff
  s_mov_b32 s70, 229376
  s_mov_b32 s71, 0x20000
  s_mov_b32 s72, s46
  s_and_b32 s73, s47, 0xffff
  s_mov_b32 s74, 229376
  s_mov_b32 s75, 0x20000
  s_mov_b32 s76, s48
  s_and_b32 s77, s49, 0xffff
  s_mov_b32 s78, 229376
  s_mov_b32 s79, 0x20000
  s_mov_b32 s80, s50
  s_and_b32 s81, s51, 0xffff
  s_mov_b32 s82, 896
  s_mov_b32 s83, 0x20000
  s_mov_b32 s84, s52
  s_and_b32 s85, s53, 0xffff
  s_mov_b32 s86, 896
  s_mov_b32 s87, 0x20000
  s_mov_b32 s88, s54
  s_and_b32 s89, s55, 0xffff
  s_mov_b32 s90, 3670016
  s_mov_b32 s91, 0x20000
  v_lshlrev_b32 v5, 5, v1
  v_sub_u32 v5, 2047, v5
  s_add_u32 s18, s17, 13056
  v_subrev_u32 v6, 0, v5
  v_max_i32 v7, 0, v6
  v_cvt_f32_u32 v7, v7
  v_cvt_pk_bf16_f32 v8, v7, v7
  v_and_b32 v7, 0xffff0000, v8
  v_lshrrev_b32 v8, 23, v7
  v_subrev_u32 v8, 134, v8
  v_max_i32 v8, 0, v8
  v_cvt_u32_f32 v7, v7
  v_lshrrev_b32 v7, v8, v7
  v_lshl_add_u32 v7, v8, 8, v7
  v_lshl_add_u32 v200, v7, 2, s18
  v_subrev_u32 v6, 1, v5
  v_max_i32 v7, 0, v6
  v_cvt_f32_u32 v7, v7
  v_cvt_pk_bf16_f32 v8, v7, v7
  v_and_b32 v7, 0xffff0000, v8
  v_lshrrev_b32 v8, 23, v7
  v_subrev_u32 v8, 134, v8
  v_max_i32 v8, 0, v8
  v_cvt_u32_f32 v7, v7
  v_lshrrev_b32 v7, v8, v7
  v_lshl_add_u32 v7, v8, 8, v7
  v_lshl_add_u32 v201, v7, 2, s18
  v_subrev_u32 v6, 2, v5
  v_max_i32 v7, 0, v6
  v_cvt_f32_u32 v7, v7
  v_cvt_pk_bf16_f32 v8, v7, v7
  v_and_b32 v7, 0xffff0000, v8
  v_lshrrev_b32 v8, 23, v7
  v_subrev_u32 v8, 134, v8
  v_max_i32 v8, 0, v8
  v_cvt_u32_f32 v7, v7
  v_lshrrev_b32 v7, v8, v7
  v_lshl_add_u32 v7, v8, 8, v7
  v_lshl_add_u32 v202, v7, 2, s18
  v_subrev_u32 v6, 3, v5
  v_max_i32 v7, 0, v6
  v_cvt_f32_u32 v7, v7
  v_cvt_pk_bf16_f32 v8, v7, v7
  v_and_b32 v7, 0xffff0000, v8
  v_lshrrev_b32 v8, 23, v7
  v_subrev_u32 v8, 134, v8
  v_max_i32 v8, 0, v8
  v_cvt_u32_f32 v7, v7
  v_lshrrev_b32 v7, v8, v7
  v_lshl_add_u32 v7, v8, 8, v7
  v_lshl_add_u32 v203, v7, 2, s18
  v_subrev_u32 v6, 4, v5
  v_max_i32 v7, 0, v6
  v_cvt_f32_u32 v7, v7
  v_cvt_pk_bf16_f32 v8, v7, v7
  v_and_b32 v7, 0xffff0000, v8
  v_lshrrev_b32 v8, 23, v7
  v_subrev_u32 v8, 134, v8
  v_max_i32 v8, 0, v8
  v_cvt_u32_f32 v7, v7
  v_lshrrev_b32 v7, v8, v7
  v_lshl_add_u32 v7, v8, 8, v7
  v_lshl_add_u32 v204, v7, 2, s18
  v_subrev_u32 v6, 5, v5
  v_max_i32 v7, 0, v6
  v_cvt_f32_u32 v7, v7
  v_cvt_pk_bf16_f32 v8, v7, v7
  v_and_b32 v7, 0xffff0000, v8
  v_lshrrev_b32 v8, 23, v7
  v_subrev_u32 v8, 134, v8
  v_max_i32 v8, 0, v8
  v_cvt_u32_f32 v7, v7
  v_lshrrev_b32 v7, v8, v7
  v_lshl_add_u32 v7, v8, 8, v7
  v_lshl_add_u32 v205, v7, 2, s18
  v_subrev_u32 v6, 6, v5
  v_max_i32 v7, 0, v6
  v_cvt_f32_u32 v7, v7
  v_cvt_pk_bf16_f32 v8, v7, v7
  v_and_b32 v7, 0xffff0000, v8
  v_lshrrev_b32 v8, 23, v7
  v_subrev_u32 v8, 134, v8
  v_max_i32 v8, 0, v8
  v_cvt_u32_f32 v7, v7
  v_lshrrev_b32 v7, v8, v7
  v_lshl_add_u32 v7, v8, 8, v7
  v_lshl_add_u32 v206, v7, 2, s18
  v_subrev_u32 v6, 7, v5
  v_max_i32 v7, 0, v6
  v_cvt_f32_u32 v7, v7
  v_cvt_pk_bf16_f32 v8, v7, v7
  v_and_b32 v7, 0xffff0000, v8
  v_lshrrev_b32 v8, 23, v7
  v_subrev_u32 v8, 134, v8
  v_max_i32 v8, 0, v8
  v_cvt_u32_f32 v7, v7
  v_lshrrev_b32 v7, v8, v7
  v_lshl_add_u32 v7, v8, 8, v7
  v_lshl_add_u32 v207, v7, 2, s18
  v_subrev_u32 v6, 8, v5
  v_max_i32 v7, 0, v6
  v_cvt_f32_u32 v7, v7
  v_cvt_pk_bf16_f32 v8, v7, v7
  v_and_b32 v7, 0xffff0000, v8
  v_lshrrev_b32 v8, 23, v7
  v_subrev_u32 v8, 134, v8
  v_max_i32 v8, 0, v8
  v_cvt_u32_f32 v7, v7
  v_lshrrev_b32 v7, v8, v7
  v_lshl_add_u32 v7, v8, 8, v7
  v_lshl_add_u32 v208, v7, 2, s18
  v_subrev_u32 v6, 9, v5
  v_max_i32 v7, 0, v6
  v_cvt_f32_u32 v7, v7
  v_cvt_pk_bf16_f32 v8, v7, v7
  v_and_b32 v7, 0xffff0000, v8
  v_lshrrev_b32 v8, 23, v7
  v_subrev_u32 v8, 134, v8
  v_max_i32 v8, 0, v8
  v_cvt_u32_f32 v7, v7
  v_lshrrev_b32 v7, v8, v7
  v_lshl_add_u32 v7, v8, 8, v7
  v_lshl_add_u32 v209, v7, 2, s18
  v_subrev_u32 v6, 10, v5
  v_max_i32 v7, 0, v6
  v_cvt_f32_u32 v7, v7
  v_cvt_pk_bf16_f32 v8, v7, v7
  v_and_b32 v7, 0xffff0000, v8
  v_lshrrev_b32 v8, 23, v7
  v_subrev_u32 v8, 134, v8
  v_max_i32 v8, 0, v8
  v_cvt_u32_f32 v7, v7
  v_lshrrev_b32 v7, v8, v7
  v_lshl_add_u32 v7, v8, 8, v7
  v_lshl_add_u32 v210, v7, 2, s18
  v_subrev_u32 v6, 11, v5
  v_max_i32 v7, 0, v6
  v_cvt_f32_u32 v7, v7
  v_cvt_pk_bf16_f32 v8, v7, v7
  v_and_b32 v7, 0xffff0000, v8
  v_lshrrev_b32 v8, 23, v7
  v_subrev_u32 v8, 134, v8
  v_max_i32 v8, 0, v8
  v_cvt_u32_f32 v7, v7
  v_lshrrev_b32 v7, v8, v7
  v_lshl_add_u32 v7, v8, 8, v7
  v_lshl_add_u32 v211, v7, 2, s18
  v_subrev_u32 v6, 12, v5
  v_max_i32 v7, 0, v6
  v_cvt_f32_u32 v7, v7
  v_cvt_pk_bf16_f32 v8, v7, v7
  v_and_b32 v7, 0xffff0000, v8
  v_lshrrev_b32 v8, 23, v7
  v_subrev_u32 v8, 134, v8
  v_max_i32 v8, 0, v8
  v_cvt_u32_f32 v7, v7
  v_lshrrev_b32 v7, v8, v7
  v_lshl_add_u32 v7, v8, 8, v7
  v_lshl_add_u32 v212, v7, 2, s18
  v_subrev_u32 v6, 13, v5
  v_max_i32 v7, 0, v6
  v_cvt_f32_u32 v7, v7
  v_cvt_pk_bf16_f32 v8, v7, v7
  v_and_b32 v7, 0xffff0000, v8
  v_lshrrev_b32 v8, 23, v7
  v_subrev_u32 v8, 134, v8
  v_max_i32 v8, 0, v8
  v_cvt_u32_f32 v7, v7
  v_lshrrev_b32 v7, v8, v7
  v_lshl_add_u32 v7, v8, 8, v7
  v_lshl_add_u32 v213, v7, 2, s18
  v_subrev_u32 v6, 14, v5
  v_max_i32 v7, 0, v6
  v_cvt_f32_u32 v7, v7
  v_cvt_pk_bf16_f32 v8, v7, v7
  v_and_b32 v7, 0xffff0000, v8
  v_lshrrev_b32 v8, 23, v7
  v_subrev_u32 v8, 134, v8
  v_max_i32 v8, 0, v8
  v_cvt_u32_f32 v7, v7
  v_lshrrev_b32 v7, v8, v7
  v_lshl_add_u32 v7, v8, 8, v7
  v_lshl_add_u32 v214, v7, 2, s18
  v_subrev_u32 v6, 15, v5
  v_max_i32 v7, 0, v6
  v_cvt_f32_u32 v7, v7
  v_cvt_pk_bf16_f32 v8, v7, v7
  v_and_b32 v7, 0xffff0000, v8
  v_lshrrev_b32 v8, 23, v7
  v_subrev_u32 v8, 134, v8
  v_max_i32 v8, 0, v8
  v_cvt_u32_f32 v7, v7
  v_lshrrev_b32 v7, v8, v7
  v_lshl_add_u32 v7, v8, 8, v7
  v_lshl_add_u32 v215, v7, 2, s18
  v_subrev_u32 v6, 16, v5
  v_max_i32 v7, 0, v6
  v_cvt_f32_u32 v7, v7
  v_cvt_pk_bf16_f32 v8, v7, v7
  v_and_b32 v7, 0xffff0000, v8
  v_lshrrev_b32 v8, 23, v7
  v_subrev_u32 v8, 134, v8
  v_max_i32 v8, 0, v8
  v_cvt_u32_f32 v7, v7
  v_lshrrev_b32 v7, v8, v7
  v_lshl_add_u32 v7, v8, 8, v7
  v_lshl_add_u32 v216, v7, 2, s18
  v_subrev_u32 v6, 17, v5
  v_max_i32 v7, 0, v6
  v_cvt_f32_u32 v7, v7
  v_cvt_pk_bf16_f32 v8, v7, v7
  v_and_b32 v7, 0xffff0000, v8
  v_lshrrev_b32 v8, 23, v7
  v_subrev_u32 v8, 134, v8
  v_max_i32 v8, 0, v8
  v_cvt_u32_f32 v7, v7
  v_lshrrev_b32 v7, v8, v7
  v_lshl_add_u32 v7, v8, 8, v7
  v_lshl_add_u32 v217, v7, 2, s18
  v_subrev_u32 v6, 18, v5
  v_max_i32 v7, 0, v6
  v_cvt_f32_u32 v7, v7
  v_cvt_pk_bf16_f32 v8, v7, v7
  v_and_b32 v7, 0xffff0000, v8
  v_lshrrev_b32 v8, 23, v7
  v_subrev_u32 v8, 134, v8
  v_max_i32 v8, 0, v8
  v_cvt_u32_f32 v7, v7
  v_lshrrev_b32 v7, v8, v7
  v_lshl_add_u32 v7, v8, 8, v7
  v_lshl_add_u32 v218, v7, 2, s18
  v_subrev_u32 v6, 19, v5
  v_max_i32 v7, 0, v6
  v_cvt_f32_u32 v7, v7
  v_cvt_pk_bf16_f32 v8, v7, v7
  v_and_b32 v7, 0xffff0000, v8
  v_lshrrev_b32 v8, 23, v7
  v_subrev_u32 v8, 134, v8
  v_max_i32 v8, 0, v8
  v_cvt_u32_f32 v7, v7
  v_lshrrev_b32 v7, v8, v7
  v_lshl_add_u32 v7, v8, 8, v7
  v_lshl_add_u32 v219, v7, 2, s18
  v_subrev_u32 v6, 20, v5
  v_max_i32 v7, 0, v6
  v_cvt_f32_u32 v7, v7
  v_cvt_pk_bf16_f32 v8, v7, v7
  v_and_b32 v7, 0xffff0000, v8
  v_lshrrev_b32 v8, 23, v7
  v_subrev_u32 v8, 134, v8
  v_max_i32 v8, 0, v8
  v_cvt_u32_f32 v7, v7
  v_lshrrev_b32 v7, v8, v7
  v_lshl_add_u32 v7, v8, 8, v7
  v_lshl_add_u32 v220, v7, 2, s18
  v_subrev_u32 v6, 21, v5
  v_max_i32 v7, 0, v6
  v_cvt_f32_u32 v7, v7
  v_cvt_pk_bf16_f32 v8, v7, v7
  v_and_b32 v7, 0xffff0000, v8
  v_lshrrev_b32 v8, 23, v7
  v_subrev_u32 v8, 134, v8
  v_max_i32 v8, 0, v8
  v_cvt_u32_f32 v7, v7
  v_lshrrev_b32 v7, v8, v7
  v_lshl_add_u32 v7, v8, 8, v7
  v_lshl_add_u32 v221, v7, 2, s18
  v_subrev_u32 v6, 22, v5
  v_max_i32 v7, 0, v6
  v_cvt_f32_u32 v7, v7
  v_cvt_pk_bf16_f32 v8, v7, v7
  v_and_b32 v7, 0xffff0000, v8
  v_lshrrev_b32 v8, 23, v7
  v_subrev_u32 v8, 134, v8
  v_max_i32 v8, 0, v8
  v_cvt_u32_f32 v7, v7
  v_lshrrev_b32 v7, v8, v7
  v_lshl_add_u32 v7, v8, 8, v7
  v_lshl_add_u32 v222, v7, 2, s18
  v_subrev_u32 v6, 23, v5
  v_max_i32 v7, 0, v6
  v_cvt_f32_u32 v7, v7
  v_cvt_pk_bf16_f32 v8, v7, v7
  v_and_b32 v7, 0xffff0000, v8
  v_lshrrev_b32 v8, 23, v7
  v_subrev_u32 v8, 134, v8
  v_max_i32 v8, 0, v8
  v_cvt_u32_f32 v7, v7
  v_lshrrev_b32 v7, v8, v7
  v_lshl_add_u32 v7, v8, 8, v7
  v_lshl_add_u32 v223, v7, 2, s18
  v_subrev_u32 v6, 24, v5
  v_max_i32 v7, 0, v6
  v_cvt_f32_u32 v7, v7
  v_cvt_pk_bf16_f32 v8, v7, v7
  v_and_b32 v7, 0xffff0000, v8
  v_lshrrev_b32 v8, 23, v7
  v_subrev_u32 v8, 134, v8
  v_max_i32 v8, 0, v8
  v_cvt_u32_f32 v7, v7
  v_lshrrev_b32 v7, v8, v7
  v_lshl_add_u32 v7, v8, 8, v7
  v_lshl_add_u32 v224, v7, 2, s18
  v_subrev_u32 v6, 25, v5
  v_max_i32 v7, 0, v6
  v_cvt_f32_u32 v7, v7
  v_cvt_pk_bf16_f32 v8, v7, v7
  v_and_b32 v7, 0xffff0000, v8
  v_lshrrev_b32 v8, 23, v7
  v_subrev_u32 v8, 134, v8
  v_max_i32 v8, 0, v8
  v_cvt_u32_f32 v7, v7
  v_lshrrev_b32 v7, v8, v7
  v_lshl_add_u32 v7, v8, 8, v7
  v_lshl_add_u32 v225, v7, 2, s18
  v_subrev_u32 v6, 26, v5
  v_max_i32 v7, 0, v6
  v_cvt_f32_u32 v7, v7
  v_cvt_pk_bf16_f32 v8, v7, v7
  v_and_b32 v7, 0xffff0000, v8
  v_lshrrev_b32 v8, 23, v7
  v_subrev_u32 v8, 134, v8
  v_max_i32 v8, 0, v8
  v_cvt_u32_f32 v7, v7
  v_lshrrev_b32 v7, v8, v7
  v_lshl_add_u32 v7, v8, 8, v7
  v_lshl_add_u32 v226, v7, 2, s18
  v_subrev_u32 v6, 27, v5
  v_max_i32 v7, 0, v6
  v_cvt_f32_u32 v7, v7
  v_cvt_pk_bf16_f32 v8, v7, v7
  v_and_b32 v7, 0xffff0000, v8
  v_lshrrev_b32 v8, 23, v7
  v_subrev_u32 v8, 134, v8
  v_max_i32 v8, 0, v8
  v_cvt_u32_f32 v7, v7
  v_lshrrev_b32 v7, v8, v7
  v_lshl_add_u32 v7, v8, 8, v7
  v_lshl_add_u32 v227, v7, 2, s18
  v_subrev_u32 v6, 28, v5
  v_max_i32 v7, 0, v6
  v_cvt_f32_u32 v7, v7
  v_cvt_pk_bf16_f32 v8, v7, v7
  v_and_b32 v7, 0xffff0000, v8
  v_lshrrev_b32 v8, 23, v7
  v_subrev_u32 v8, 134, v8
  v_max_i32 v8, 0, v8
  v_cvt_u32_f32 v7, v7
  v_lshrrev_b32 v7, v8, v7
  v_lshl_add_u32 v7, v8, 8, v7
  v_lshl_add_u32 v228, v7, 2, s18
  v_subrev_u32 v6, 29, v5
  v_max_i32 v7, 0, v6
  v_cvt_f32_u32 v7, v7
  v_cvt_pk_bf16_f32 v8, v7, v7
  v_and_b32 v7, 0xffff0000, v8
  v_lshrrev_b32 v8, 23, v7
  v_subrev_u32 v8, 134, v8
  v_max_i32 v8, 0, v8
  v_cvt_u32_f32 v7, v7
  v_lshrrev_b32 v7, v8, v7
  v_lshl_add_u32 v7, v8, 8, v7
  v_lshl_add_u32 v229, v7, 2, s18
  v_subrev_u32 v6, 30, v5
  v_max_i32 v7, 0, v6
  v_cvt_f32_u32 v7, v7
  v_cvt_pk_bf16_f32 v8, v7, v7
  v_and_b32 v7, 0xffff0000, v8
  v_lshrrev_b32 v8, 23, v7
  v_subrev_u32 v8, 134, v8
  v_max_i32 v8, 0, v8
  v_cvt_u32_f32 v7, v7
  v_lshrrev_b32 v7, v8, v7
  v_lshl_add_u32 v7, v8, 8, v7
  v_lshl_add_u32 v230, v7, 2, s18
  v_subrev_u32 v6, 31, v5
  v_max_i32 v7, 0, v6
  v_cvt_f32_u32 v7, v7
  v_cvt_pk_bf16_f32 v8, v7, v7
  v_and_b32 v7, 0xffff0000, v8
  v_lshrrev_b32 v8, 23, v7
  v_subrev_u32 v8, 134, v8
  v_max_i32 v8, 0, v8
  v_cvt_u32_f32 v7, v7
  v_lshrrev_b32 v7, v8, v7
  v_lshl_add_u32 v7, v8, 8, v7
  v_lshl_add_u32 v231, v7, 2, s18
  v_subrev_u32 v6, 32, v5
  v_max_i32 v7, 0, v6
  v_cvt_f32_u32 v7, v7
  v_cvt_pk_bf16_f32 v8, v7, v7
  v_and_b32 v7, 0xffff0000, v8
  v_lshrrev_b32 v8, 23, v7
  v_subrev_u32 v8, 134, v8
  v_max_i32 v8, 0, v8
  v_cvt_u32_f32 v7, v7
  v_lshrrev_b32 v7, v8, v7
  v_lshl_add_u32 v7, v8, 8, v7
  v_mov_b32 v8, 1280
  v_cmp_gt_i32 vcc, 0, v6
  s_nop 1
  v_cndmask_b32 v7, v7, v8, vcc
  v_lshl_add_u32 v232, v7, 2, s18
  v_mov_b32 v8, 0
  v_mov_b32 v9, 0
  v_lshlrev_b32 v5, 3, v1
  v_add_u32 v5, s17, v5
  ds_write_b64 v5, v[8:9]
  v_and_b32 v6, 15, v1
  v_lshlrev_b32 v6, 3, v6
  v_add_u32 v6, s17, v6
  ds_write_b64 v6, v[8:9] offset:8704
  ds_write_b64 v6, v[8:9] offset:12928
  v_mov_b32 v6, s17
  ds_write_b64 v6, v[8:9] offset:18176
  s_lshl_b32 s19, s3, 2
  s_add_u32 s20, s19, s16
  s_lshl_b32 s21, s3, 3
  v_mul_u32_u24 v5, 3584, v0
  s_add_u32 s22, s21, 0
  buffer_load_dwordx2 v[8:9], v5, s[60:63], s22 offen offset:0
  buffer_load_dwordx2 v[10:11], v5, s[60:63], s22 offen offset:896
  buffer_load_dwordx2 v[12:13], v5, s[60:63], s22 offen offset:1792
  buffer_load_dwordx2 v[14:15], v5, s[60:63], s22 offen offset:2688
  s_add_u32 s22, s21, 917504
  buffer_load_dwordx2 v[16:17], v5, s[60:63], s22 offen offset:0
  buffer_load_dwordx2 v[18:19], v5, s[60:63], s22 offen offset:896
  buffer_load_dwordx2 v[20:21], v5, s[60:63], s22 offen offset:1792
  buffer_load_dwordx2 v[22:23], v5, s[60:63], s22 offen offset:2688
  s_lshl_b32 s22, s20, 9
  v_lshlrev_b32 v6, 3, v1
  buffer_load_dwordx2 v[24:25], v6, s[64:67], s22 offen
  buffer_load_dwordx2 v[26:27], v6, s[68:71], s22 offen
  buffer_load_dwordx2 v[28:29], v6, s[72:75], s22 offen
  buffer_load_dwordx2 v[30:31], v6, s[76:79], s22 offen
  s_lshl_b32 s22, s20, 1
  v_mov_b32 v7, 0
  buffer_load_ushort v32, v7, s[80:83], s22 offen
  buffer_load_ushort v33, v7, s[84:87], s22 offen
  s_mov_b32 s24, 0x05040100
  s_mov_b32 s25, 0x07060302
  s_barrier
  s_waitcnt vmcnt(6)
  v_lshlrev_b32 v6, 3, v0
  v_perm_b32 v34, v10, v8, s24
  v_perm_b32 v35, v14, v12, s24
  v_add_u32 v36, 512, v6
  ds_write_b64 v36, v[34:35]
  v_perm_b32 v34, v10, v8, s25
  v_perm_b32 v35, v14, v12, s25
  v_add_u32 v36, 25088, v6
  ds_write_b64 v36, v[34:35]
  v_perm_b32 v34, v11, v9, s24
  v_perm_b32 v35, v15, v13, s24
  v_add_u32 v36, 49664, v6
  ds_write_b64 v36, v[34:35]
  v_perm_b32 v34, v11, v9, s25
  v_perm_b32 v35, v15, v13, s25
  v_add_u32 v36, 74240, v6
  ds_write_b64 v36, v[34:35]
  v_perm_b32 v34, v18, v16, s24
  v_perm_b32 v35, v22, v20, s24
  v_add_u32 v36, 2560, v6
  ds_write_b64 v36, v[34:35]
  v_perm_b32 v34, v18, v16, s25
  v_perm_b32 v35, v22, v20, s25
  v_add_u32 v36, 27136, v6
  ds_write_b64 v36, v[34:35]
  v_perm_b32 v34, v19, v17, s24
  v_perm_b32 v35, v23, v21, s24
  v_add_u32 v36, 51712, v6
  ds_write_b64 v36, v[34:35]
  v_perm_b32 v34, v19, v17, s25
  v_perm_b32 v35, v23, v21, s25
  v_add_u32 v36, 76288, v6
  ds_write_b64 v36, v[34:35]
  s_waitcnt vmcnt(0)
  s_mov_b32 s26, 1069066811
  s_mov_b32 s27, 1042479491
  v_lshlrev_b32 v32, 16, v32
  v_lshlrev_b32 v33, 16, v33
  v_mul_f32 v32, s26, v32
  v_exp_f32 v32, v32
  s_nop 0
  v_cvt_pk_bf16_f32 v34, v32, v32
  v_and_b32 v32, 0xffff0000, v34
  v_lshlrev_b32 v37, 6, v1
  v_add_u32 v37, s17, v37
  v_lshlrev_b32 v40, 16, v24
  v_lshlrev_b32 v41, 16, v26
  v_lshlrev_b32 v42, 16, v28
  v_lshlrev_b32 v43, 16, v30
  v_mul_f32 v40, s26, v40
  v_exp_f32 v40, v40
  s_nop 0
  v_cvt_pk_bf16_f32 v34, v40, v40
  v_and_b32 v40, 0xffff0000, v34
  v_mul_f32 v40, v40, v32
  v_mul_f32 v40, s26, v40
  v_sub_f32 v40, 0, v40
  v_mul_f32 v41, v41, v32
  v_mul_f32 v41, s27, v41
  v_mul_f32 v42, v42, v32
  v_mul_f32 v43, v43, v32
  v_add_f32 v42, v42, v42
  v_add_f32 v43, v43, v43
  ds_write_b128 v37, v[40:43] offset:18240
  v_and_b32 v40, 0xffff0000, v24
  v_and_b32 v41, 0xffff0000, v26
  v_and_b32 v42, 0xffff0000, v28
  v_and_b32 v43, 0xffff0000, v30
  v_mul_f32 v40, s26, v40
  v_exp_f32 v40, v40
  s_nop 0
  v_cvt_pk_bf16_f32 v34, v40, v40
  v_and_b32 v40, 0xffff0000, v34
  v_mul_f32 v40, v40, v32
  v_mul_f32 v40, s26, v40
  v_sub_f32 v40, 0, v40
  v_mul_f32 v41, v41, v32
  v_mul_f32 v41, s27, v41
  v_mul_f32 v42, v42, v32
  v_mul_f32 v43, v43, v32
  v_add_f32 v42, v42, v42
  v_add_f32 v43, v43, v43
  ds_write_b128 v37, v[40:43] offset:18256
  v_lshlrev_b32 v40, 16, v25
  v_lshlrev_b32 v41, 16, v27
  v_lshlrev_b32 v42, 16, v29
  v_lshlrev_b32 v43, 16, v31
  v_mul_f32 v40, s26, v40
  v_exp_f32 v40, v40
  s_nop 0
  v_cvt_pk_bf16_f32 v34, v40, v40
  v_and_b32 v40, 0xffff0000, v34
  v_mul_f32 v40, v40, v32
  v_mul_f32 v40, s26, v40
  v_sub_f32 v40, 0, v40
  v_mul_f32 v41, v41, v32
  v_mul_f32 v41, s27, v41
  v_mul_f32 v42, v42, v32
  v_mul_f32 v43, v43, v32
  v_add_f32 v42, v42, v42
  v_add_f32 v43, v43, v43
  ds_write_b128 v37, v[40:43] offset:18272
  v_and_b32 v40, 0xffff0000, v25
  v_and_b32 v41, 0xffff0000, v27
  v_and_b32 v42, 0xffff0000, v29
  v_and_b32 v43, 0xffff0000, v31
  v_mul_f32 v40, s26, v40
  v_exp_f32 v40, v40
  s_nop 0
  v_cvt_pk_bf16_f32 v34, v40, v40
  v_and_b32 v40, 0xffff0000, v34
  v_mul_f32 v40, v40, v32
  v_mul_f32 v40, s26, v40
  v_sub_f32 v40, 0, v40
  v_mul_f32 v41, v41, v32
  v_mul_f32 v41, s27, v41
  v_mul_f32 v42, v42, v32
  v_mul_f32 v43, v43, v32
  v_add_f32 v42, v42, v42
  v_add_f32 v43, v43, v43
  ds_write_b128 v37, v[40:43] offset:18288
  v_cvt_f32_u32 v44, v4
  v_lshlrev_b32 v45, 4, v4
  v_cvt_f32_u32 v45, v45
  v_lshlrev_b32 v46, 4, v3
  v_add_u32 v46, s17, v46
  v_mov_b32 v48, 0
  v_mov_b32 v49, 0
  v_mov_b32 v50, 0
  v_mov_b32 v51, 0
  v_mov_b32 v52, 0
  v_mov_b32 v53, 0
  v_mov_b32 v54, 0
  v_mov_b32 v55, 0
  v_mov_b32 v56, 0
  v_mov_b32 v57, 0
  v_mov_b32 v58, 0
  v_mov_b32 v59, 0
  v_mov_b32 v60, 0
  v_mov_b32 v61, 0
  v_mov_b32 v62, 0
  v_mov_b32 v63, 0
  v_mov_b32 v64, 0
  v_mov_b32 v65, 0
  v_mov_b32 v66, 0
  v_mov_b32 v67, 0
  s_mov_b32 s28, 0
  s_waitcnt lgkmcnt(0)
  ds_read_b128 v[68:71], v46 offset:18240
wk_kl:
  s_waitcnt lgkmcnt(0)
  v_mov_b32 v72, v68
  v_mov_b32 v73, v69
  v_mov_b32 v74, v70
  v_mov_b32 v75, v71
  v_add_u32 v46, 64, v46
  ds_read_b128 v[68:71], v46 offset:18240
  v_mul_f32 v80, v72, v45
  v_mul_f32 v81, v73, v45
  v_exp_f32 v80, v80
  v_fract_f32 v81, v81
  v_cos_f32 v76, v81
  v_sin_f32 v77, v81
  v_mul_f32 v76, v76, v80
  v_mul_f32 v77, v77, v80
  v_mul_f32 v80, v72, v44
  v_mul_f32 v81, v73, v44
  v_exp_f32 v80, v80
  v_fract_f32 v81, v81
  v_cos_f32 v78, v81
  v_sin_f32 v79, v81
  v_mul_f32 v78, v78, v80
  v_mul_f32 v79, v79, v80
  v_mul_f32 v82, v74, v76
  v_mul_f32 v83, v74, v77
  v_fma_f32 v82, -v75, v77, v82
  v_fma_f32 v83, -v75, v76, -v83
  v_mul_f32 v86, v76, v76
  v_mul_f32 v87, v76, v77
  v_fma_f32 v86, -v77, v77, v86
  v_add_f32 v87, v87, v87
  v_mfma_f32_16x16x4_f32 v[48:51], v82, v78, v[48:51]
  v_mul_f32 v88, v78, v78
  v_mul_f32 v89, v78, v79
  v_fma_f32 v88, -v79, v79, v88
  v_add_f32 v89, v89, v89
  v_mfma_f32_16x16x4_f32 v[48:51], v83, v79, v[48:51]
  v_mul_f32 v84, v74, v86
  v_mul_f32 v85, v74, v87
  v_fma_f32 v84, -v75, v87, v84
  v_fma_f32 v85, -v75, v86, -v85
  v_mul_f32 v76, v86, v86
  v_mul_f32 v77, v86, v87
  v_fma_f32 v76, -v87, v87, v76
  v_add_f32 v77, v77, v77
  v_mfma_f32_16x16x4_f32 v[52:55], v84, v88, v[52:55]
  v_mul_f32 v78, v88, v88
  v_mul_f32 v79, v88, v89
  v_fma_f32 v78, -v89, v89, v78
  v_add_f32 v79, v79, v79
  v_mfma_f32_16x16x4_f32 v[52:55], v85, v89, v[52:55]
  v_mul_f32 v82, v74, v76
  v_mul_f32 v83, v74, v77
  v_fma_f32 v82, -v75, v77, v82
  v_fma_f32 v83, -v75, v76, -v83
  v_mul_f32 v86, v76, v76
  v_mul_f32 v87, v76, v77
  v_fma_f32 v86, -v77, v77, v86
  v_add_f32 v87, v87, v87
  v_mfma_f32_16x16x4_f32 v[56:59], v82, v78, v[56:59]
  v_mul_f32 v88, v78, v78
  v_mul_f32 v89, v78, v79
  v_fma_f32 v88, -v79, v79, v88
  v_add_f32 v89, v89, v89
  v_mfma_f32_16x16x4_f32 v[56:59], v83, v79, v[56:59]
  v_mul_f32 v84, v74, v86
  v_mul_f32 v85, v74, v87
  v_fma_f32 v84, -v75, v87, v84
  v_fma_f32 v85, -v75, v86, -v85
  v_mul_f32 v76, v86, v86
  v_mul_f32 v77, v86, v87
  v_fma_f32 v76, -v87, v87, v76
  v_add_f32 v77, v77, v77
  v_mfma_f32_16x16x4_f32 v[60:63], v84, v88, v[60:63]
  v_mfma_f32_16x16x4_f32 v[60:63], v85, v89, v[60:63]
  v_mul_f32 v82, v74, v76
  v_fma_f32 v82, -v75, v77, v82
  s_nop 1
  v_mfma_f32_16x16x4_f32 v[64:67], v82, v88, v[64:67]
  s_add_u32 s28, s28, 1
  s_cmp_lt_u32 s28, 64
  s_cbranch_scc1 wk_kl
  s_nop 15
  s_nop 3
  v_lshlrev_b32 v46, 8, v3
  v_lshl_add_u32 v46, v4, 2, v46
  v_add_u32 v46, s17, v46
  ds_write_b32 v46, v48 offset:13056
  ds_write_b32 v46, v49 offset:13120
  ds_write_b32 v46, v50 offset:13184
  ds_write_b32 v46, v51 offset:13248
  s_waitcnt lgkmcnt(8)
  ds_write_b32 v46, v52 offset:14080
  ds_write_b32 v46, v53 offset:14144
  ds_write_b32 v46, v54 offset:14208
  ds_write_b32 v46, v55 offset:14272
  s_waitcnt lgkmcnt(8)
  ds_write_b32 v46, v56 offset:15104
  ds_write_b32 v46, v57 offset:15168
  ds_write_b32 v46, v58 offset:15232
  ds_write_b32 v46, v59 offset:15296
  s_waitcnt lgkmcnt(8)
  ds_write_b32 v46, v60 offset:16128
  ds_write_b32 v46, v61 offset:16192
  ds_write_b32 v46, v62 offset:16256
  ds_write_b32 v46, v63 offset:16320
  s_waitcnt lgkmcnt(8)
  ds_write_b32 v46, v64 offset:17152
  ds_write_b32 v46, v65 offset:17216
  ds_write_b32 v46, v66 offset:17280
  ds_write_b32 v46, v67 offset:17344
  s_waitcnt lgkmcnt(8)
  s_waitcnt lgkmcnt(0)
  ds_read_b32 v48, v200
  ds_read_b32 v49, v201
  ds_read_b32 v50, v202
  ds_read_b32 v51, v203
  ds_read_b32 v52, v204
  ds_read_b32 v53, v205
  ds_read_b32 v54, v206
  ds_read_b32 v55, v207
  s_waitcnt lgkmcnt(4)
  ds_read_b32 v56, v208
  ds_read_b32 v57, v209
  ds_read_b32 v58, v210
  ds_read_b32 v59, v211
  ds_read_b32 v60, v212
  ds_read_b32 v61, v213
  ds_read_b32 v62, v214
  ds_read_b32 v63, v215
  s_waitcnt lgkmcnt(4)
  ds_read_b32 v64, v216
  ds_read_b32 v65, v217
  ds_read_b32 v66, v218
  ds_read_b32 v67, v219
  ds_read_b32 v68, v220
  ds_read_b32 v69, v221
  ds_read_b32 v70, v222
  ds_read_b32 v71, v223
  s_waitcnt lgkmcnt(4)
  ds_read_b32 v72, v224
  ds_read_b32 v73, v225
  ds_read_b32 v74, v226
  ds_read_b32 v75, v227
  ds_read_b32 v76, v228
  ds_read_b32 v77, v229
  ds_read_b32 v78, v230
  ds_read_b32 v79, v231
  s_waitcnt lgkmcnt(4)
  ds_read_b32 v80, v232
  s_waitcnt lgkmcnt(0)
  v_lshlrev_b32 v46, 6, v1
  v_add_u32 v46, s17, v46
  v_cvt_pk_bf16_f32 v84, v48, v49
  v_cvt_pk_bf16_f32 v88, v49, v50
  v_cvt_pk_bf16_f32 v85, v50, v51
  v_cvt_pk_bf16_f32 v89, v51, v52
  v_cvt_pk_bf16_f32 v86, v52, v53
  v_cvt_pk_bf16_f32 v90, v53, v54
  v_cvt_pk_bf16_f32 v87, v54, v55
  v_cvt_pk_bf16_f32 v91, v55, v56
  ds_write_b128 v46, v[84:87] offset:4608
  ds_write_b128 v46, v[88:91] offset:8832
  s_waitcnt lgkmcnt(0)
  v_cvt_pk_bf16_f32 v84, v56, v57
  v_cvt_pk_bf16_f32 v88, v57, v58
  v_cvt_pk_bf16_f32 v85, v58, v59
  v_cvt_pk_bf16_f32 v89, v59, v60
  v_cvt_pk_bf16_f32 v86, v60, v61
  v_cvt_pk_bf16_f32 v90, v61, v62
  v_cvt_pk_bf16_f32 v87, v62, v63
  v_cvt_pk_bf16_f32 v91, v63, v64
  ds_write_b128 v46, v[84:87] offset:4624
  ds_write_b128 v46, v[88:91] offset:8848
  s_waitcnt lgkmcnt(0)
  v_cvt_pk_bf16_f32 v84, v64, v65
  v_cvt_pk_bf16_f32 v88, v65, v66
  v_cvt_pk_bf16_f32 v85, v66, v67
  v_cvt_pk_bf16_f32 v89, v67, v68
  v_cvt_pk_bf16_f32 v86, v68, v69
  v_cvt_pk_bf16_f32 v90, v69, v70
  v_cvt_pk_bf16_f32 v87, v70, v71
  v_cvt_pk_bf16_f32 v91, v71, v72
  ds_write_b128 v46, v[84:87] offset:4640
  ds_write_b128 v46, v[88:91] offset:8864
  s_waitcnt lgkmcnt(0)
  v_cvt_pk_bf16_f32 v84, v72, v73
  v_cvt_pk_bf16_f32 v88, v73, v74
  v_cvt_pk_bf16_f32 v85, v74, v75
  v_cvt_pk_bf16_f32 v89, v75, v76
  v_cvt_pk_bf16_f32 v86, v76, v77
  v_cvt_pk_bf16_f32 v90, v77, v78
  v_cvt_pk_bf16_f32 v87, v78, v79
  v_cvt_pk_bf16_f32 v91, v79, v80
  ds_write_b128 v46, v[84:87] offset:4656
  ds_write_b128 v46, v[88:91] offset:8880
  s_waitcnt lgkmcnt(0)
  s_barrier
  v_lshrrev_b32 v47, 1, v3
  v_sub_u32 v46, v4, v47
  v_add_u32 v46, 1, v46
  v_lshlrev_b32 v46, 5, v46
  v_and_b32 v48, 1, v3
  v_lshl_add_u32 v46, v48, 4, v46
  v_add_u32 v46, s17, v46
  ds_read_b128 a[0:3], v46 offset:32
  ds_read_b128 a[4:7], v46 offset:96
  ds_read_b128 a[8:11], v46 offset:160
  ds_read_b128 a[12:15], v46 offset:224
  ds_read_b128 a[16:19], v46 offset:288
  ds_read_b128 a[20:23], v46 offset:352
  ds_read_b128 a[24:27], v46 offset:416
  ds_read_b128 a[28:31], v46 offset:480
  s_waitcnt lgkmcnt(4)
  ds_read_b128 a[32:35], v46 offset:544
  ds_read_b128 a[36:39], v46 offset:608
  ds_read_b128 a[40:43], v46 offset:672
  ds_read_b128 a[44:47], v46 offset:736
  ds_read_b128 a[48:51], v46 offset:800
  ds_read_b128 a[52:55], v46 offset:864
  ds_read_b128 a[56:59], v46 offset:928
  ds_read_b128 a[60:63], v46 offset:992
  s_waitcnt lgkmcnt(4)
  ds_read_b128 a[64:67], v46 offset:1056
  ds_read_b128 a[68:71], v46 offset:1120
  ds_read_b128 a[72:75], v46 offset:1184
  ds_read_b128 a[76:79], v46 offset:1248
  ds_read_b128 a[80:83], v46 offset:1312
  ds_read_b128 a[84:87], v46 offset:1376
  ds_read_b128 a[88:91], v46 offset:1440
  ds_read_b128 a[92:95], v46 offset:1504
  s_waitcnt lgkmcnt(4)
  ds_read_b128 a[96:99], v46 offset:1568
  ds_read_b128 a[100:103], v46 offset:1632
  ds_read_b128 a[104:107], v46 offset:1696
  ds_read_b128 a[108:111], v46 offset:1760
  ds_read_b128 a[112:115], v46 offset:1824
  ds_read_b128 a[116:119], v46 offset:1888
  ds_read_b128 a[120:123], v46 offset:1952
  ds_read_b128 a[124:127], v46 offset:2016
  s_waitcnt lgkmcnt(4)
  ds_read_b128 a[128:131], v46 offset:2080
  ds_read_b128 a[132:135], v46 offset:2144
  ds_read_b128 a[136:139], v46 offset:2208
  ds_read_b128 a[140:143], v46 offset:2272
  ds_read_b128 a[144:147], v46 offset:2336
  ds_read_b128 a[148:151], v46 offset:2400
  ds_read_b128 a[152:155], v46 offset:2464
  ds_read_b128 a[156:159], v46 offset:2528
  s_waitcnt lgkmcnt(4)
  ds_read_b128 a[160:163], v46 offset:2592
  ds_read_b128 a[164:167], v46 offset:2656
  ds_read_b128 a[168:171], v46 offset:2720
  ds_read_b128 a[172:175], v46 offset:2784
  ds_read_b128 a[176:179], v46 offset:2848
  ds_read_b128 a[180:183], v46 offset:2912
  ds_read_b128 a[184:187], v46 offset:2976
  ds_read_b128 a[188:191], v46 offset:3040
  s_waitcnt lgkmcnt(4)
  ds_read_b128 a[192:195], v46 offset:3104
  ds_read_b128 a[196:199], v46 offset:3168
  ds_read_b128 a[200:203], v46 offset:3232
  ds_read_b128 a[204:207], v46 offset:3296
  ds_read_b128 a[208:211], v46 offset:3360
  ds_read_b128 a[212:215], v46 offset:3424
  ds_read_b128 a[216:219], v46 offset:3488
  ds_read_b128 a[220:223], v46 offset:3552
  s_waitcnt lgkmcnt(4)
  ds_read_b128 a[224:227], v46 offset:3616
  ds_read_b128 a[228:231], v46 offset:3680
  ds_read_b128 a[232:235], v46 offset:3744
  ds_read_b128 a[236:239], v46 offset:3808
  ds_read_b128 a[240:243], v46 offset:3872
  ds_read_b128 a[244:247], v46 offset:3936
  ds_read_b128 a[248:251], v46 offset:4000
  ds_read_b128 a[252:255], v46 offset:4064
  s_waitcnt lgkmcnt(4)
  v_lshlrev_b32 v49, 4, v47
  v_add_u32 v49, v49, v4
  v_sub_u32 v49, 2047, v49
  v_lshl_add_u32 v49, v48, 3, v49
  v_and_b32 v50, 1, v49
  v_lshrrev_b32 v49, 1, v49
  v_lshlrev_b32 v49, 2, v49
  v_mul_u32_u24 v50, 4224, v50
  v_add3_u32 v49, v49, v50, s17
  v_add_u32 v49, 4608, v49
  v_subrev_u32 v52, 896, v49
  v_subrev_u32 v53, 1856, v49
  v_subrev_u32 v54, 2816, v49
  v_subrev_u32 v55, 3776, v49
  v_subrev_u32 v56, 4736, v49
  s_waitcnt lgkmcnt(0)
  ds_read2_b32 v[92:93], v52 offset0:224 offset1:225
  ds_read2_b32 v[94:95], v52 offset0:226 offset1:227
  ds_read2_b32 v[96:97], v52 offset0:208 offset1:209
  ds_read2_b32 v[98:99], v52 offset0:210 offset1:211
  ds_read2_b32 v[100:101], v52 offset0:192 offset1:193
  ds_read2_b32 v[102:103], v52 offset0:194 offset1:195
  ds_read2_b32 v[104:105], v52 offset0:176 offset1:177
  ds_read2_b32 v[106:107], v52 offset0:178 offset1:179
  s_waitcnt lgkmcnt(6)
  v_mfma_f32_16x16x32_bf16 v[60:63], v[92:95], a[28:31], 0
  v_mfma_f32_16x16x32_bf16 v[64:67], v[92:95], a[60:63], 0
  v_mfma_f32_16x16x32_bf16 v[68:71], v[92:95], a[92:95], 0
  v_mfma_f32_16x16x32_bf16 v[72:75], v[92:95], a[124:127], 0
  v_mfma_f32_16x16x32_bf16 v[76:79], v[92:95], a[156:159], 0
  v_mfma_f32_16x16x32_bf16 v[80:83], v[92:95], a[188:191], 0
  v_mfma_f32_16x16x32_bf16 v[84:87], v[92:95], a[220:223], 0
  v_mfma_f32_16x16x32_bf16 v[88:91], v[92:95], a[252:255], 0
  ds_read2_b32 v[92:93], v52 offset0:160 offset1:161
  ds_read2_b32 v[94:95], v52 offset0:162 offset1:163
  s_waitcnt lgkmcnt(6)
  v_mfma_f32_16x16x32_bf16 v[60:63], v[96:99], a[24:27], v[60:63]
  v_mfma_f32_16x16x32_bf16 v[64:67], v[96:99], a[56:59], v[64:67]
  v_mfma_f32_16x16x32_bf16 v[68:71], v[96:99], a[88:91], v[68:71]
  v_mfma_f32_16x16x32_bf16 v[72:75], v[96:99], a[120:123], v[72:75]
  v_mfma_f32_16x16x32_bf16 v[76:79], v[96:99], a[152:155], v[76:79]
  v_mfma_f32_16x16x32_bf16 v[80:83], v[96:99], a[184:187], v[80:83]
  v_mfma_f32_16x16x32_bf16 v[84:87], v[96:99], a[216:219], v[84:87]
  v_mfma_f32_16x16x32_bf16 v[88:91], v[96:99], a[248:251], v[88:91]
  ds_read2_b32 v[96:97], v52 offset0:144 offset1:145
  ds_read2_b32 v[98:99], v52 offset0:146 offset1:147
  s_waitcnt lgkmcnt(6)
  v_mfma_f32_16x16x32_bf16 v[60:63], v[100:103], a[20:23], v[60:63]
  v_mfma_f32_16x16x32_bf16 v[64:67], v[100:103], a[52:55], v[64:67]
  v_mfma_f32_16x16x32_bf16 v[68:71], v[100:103], a[84:87], v[68:71]
  v_mfma_f32_16x16x32_bf16 v[72:75], v[100:103], a[116:119], v[72:75]
  v_mfma_f32_16x16x32_bf16 v[76:79], v[100:103], a[148:151], v[76:79]
  v_mfma_f32_16x16x32_bf16 v[80:83], v[100:103], a[180:183], v[80:83]
  v_mfma_f32_16x16x32_bf16 v[84:87], v[100:103], a[212:215], v[84:87]
  v_mfma_f32_16x16x32_bf16 v[88:91], v[100:103], a[244:247], v[88:91]
  ds_read2_b32 v[100:101], v52 offset0:128 offset1:129
  ds_read2_b32 v[102:103], v52 offset0:130 offset1:131
  s_waitcnt lgkmcnt(6)
  v_mfma_f32_16x16x32_bf16 v[60:63], v[104:107], a[16:19], v[60:63]
  v_mfma_f32_16x16x32_bf16 v[64:67], v[104:107], a[48:51], v[64:67]
  v_mfma_f32_16x16x32_bf16 v[68:71], v[104:107], a[80:83], v[68:71]
  v_mfma_f32_16x16x32_bf16 v[72:75], v[104:107], a[112:115], v[72:75]
  v_mfma_f32_16x16x32_bf16 v[76:79], v[104:107], a[144:147], v[76:79]
  v_mfma_f32_16x16x32_bf16 v[80:83], v[104:107], a[176:179], v[80:83]
  v_mfma_f32_16x16x32_bf16 v[84:87], v[104:107], a[208:211], v[84:87]
  v_mfma_f32_16x16x32_bf16 v[88:91], v[104:107], a[240:243], v[88:91]
  ds_read2_b32 v[104:105], v52 offset0:112 offset1:113
  ds_read2_b32 v[106:107], v52 offset0:114 offset1:115
  s_waitcnt lgkmcnt(6)
  v_mfma_f32_16x16x32_bf16 v[60:63], v[92:95], a[12:15], v[60:63]
  v_mfma_f32_16x16x32_bf16 v[64:67], v[92:95], a[44:47], v[64:67]
  v_mfma_f32_16x16x32_bf16 v[68:71], v[92:95], a[76:79], v[68:71]
  v_mfma_f32_16x16x32_bf16 v[72:75], v[92:95], a[108:111], v[72:75]
  v_mfma_f32_16x16x32_bf16 v[76:79], v[92:95], a[140:143], v[76:79]
  v_mfma_f32_16x16x32_bf16 v[80:83], v[92:95], a[172:175], v[80:83]
  v_mfma_f32_16x16x32_bf16 v[84:87], v[92:95], a[204:207], v[84:87]
  v_mfma_f32_16x16x32_bf16 v[88:91], v[92:95], a[236:239], v[88:91]
  ds_read2_b32 v[92:93], v52 offset0:96 offset1:97
  ds_read2_b32 v[94:95], v52 offset0:98 offset1:99
  s_waitcnt lgkmcnt(6)
  v_mfma_f32_16x16x32_bf16 v[60:63], v[96:99], a[8:11], v[60:63]
  v_mfma_f32_16x16x32_bf16 v[64:67], v[96:99], a[40:43], v[64:67]
  v_mfma_f32_16x16x32_bf16 v[68:71], v[96:99], a[72:75], v[68:71]
  v_mfma_f32_16x16x32_bf16 v[72:75], v[96:99], a[104:107], v[72:75]
  v_mfma_f32_16x16x32_bf16 v[76:79], v[96:99], a[136:139], v[76:79]
  v_mfma_f32_16x16x32_bf16 v[80:83], v[96:99], a[168:171], v[80:83]
  v_mfma_f32_16x16x32_bf16 v[84:87], v[96:99], a[200:203], v[84:87]
  v_mfma_f32_16x16x32_bf16 v[88:91], v[96:99], a[232:235], v[88:91]
  ds_read2_b32 v[96:97], v52 offset0:80 offset1:81
  ds_read2_b32 v[98:99], v52 offset0:82 offset1:83
  s_waitcnt lgkmcnt(6)
  v_mfma_f32_16x16x32_bf16 v[60:63], v[100:103], a[4:7], v[60:63]
  v_mfma_f32_16x16x32_bf16 v[64:67], v[100:103], a[36:39], v[64:67]
  v_mfma_f32_16x16x32_bf16 v[68:71], v[100:103], a[68:71], v[68:71]
  v_mfma_f32_16x16x32_bf16 v[72:75], v[100:103], a[100:103], v[72:75]
  v_mfma_f32_16x16x32_bf16 v[76:79], v[100:103], a[132:135], v[76:79]
  v_mfma_f32_16x16x32_bf16 v[80:83], v[100:103], a[164:167], v[80:83]
  v_mfma_f32_16x16x32_bf16 v[84:87], v[100:103], a[196:199], v[84:87]
  v_mfma_f32_16x16x32_bf16 v[88:91], v[100:103], a[228:231], v[88:91]
  ds_read2_b32 v[100:101], v52 offset0:64 offset1:65
  ds_read2_b32 v[102:103], v52 offset0:66 offset1:67
  s_waitcnt lgkmcnt(6)
  v_mfma_f32_16x16x32_bf16 v[60:63], v[104:107], a[0:3], v[60:63]
  v_mfma_f32_16x16x32_bf16 v[64:67], v[104:107], a[32:35], v[64:67]
  v_mfma_f32_16x16x32_bf16 v[68:71], v[104:107], a[64:67], v[68:71]
  v_mfma_f32_16x16x32_bf16 v[72:75], v[104:107], a[96:99], v[72:75]
  v_mfma_f32_16x16x32_bf16 v[76:79], v[104:107], a[128:131], v[76:79]
  v_mfma_f32_16x16x32_bf16 v[80:83], v[104:107], a[160:163], v[80:83]
  v_mfma_f32_16x16x32_bf16 v[84:87], v[104:107], a[192:195], v[84:87]
  v_mfma_f32_16x16x32_bf16 v[88:91], v[104:107], a[224:227], v[88:91]
  ds_read2_b32 v[104:105], v52 offset0:48 offset1:49
  ds_read2_b32 v[106:107], v52 offset0:50 offset1:51
  s_waitcnt lgkmcnt(6)
  v_mfma_f32_16x16x32_bf16 v[64:67], v[92:95], a[28:31], v[64:67]
  v_mfma_f32_16x16x32_bf16 v[68:71], v[92:95], a[60:63], v[68:71]
  v_mfma_f32_16x16x32_bf16 v[72:75], v[92:95], a[92:95], v[72:75]
  v_mfma_f32_16x16x32_bf16 v[76:79], v[92:95], a[124:127], v[76:79]
  v_mfma_f32_16x16x32_bf16 v[80:83], v[92:95], a[156:159], v[80:83]
  v_mfma_f32_16x16x32_bf16 v[84:87], v[92:95], a[188:191], v[84:87]
  v_mfma_f32_16x16x32_bf16 v[88:91], v[92:95], a[220:223], v[88:91]
  ds_read2_b32 v[92:93], v52 offset0:32 offset1:33
  ds_read2_b32 v[94:95], v52 offset0:34 offset1:35
  s_waitcnt lgkmcnt(6)
  v_mfma_f32_16x16x32_bf16 v[64:67], v[96:99], a[24:27], v[64:67]
  v_mfma_f32_16x16x32_bf16 v[68:71], v[96:99], a[56:59], v[68:71]
  v_mfma_f32_16x16x32_bf16 v[72:75], v[96:99], a[88:91], v[72:75]
  v_mfma_f32_16x16x32_bf16 v[76:79], v[96:99], a[120:123], v[76:79]
  v_mfma_f32_16x16x32_bf16 v[80:83], v[96:99], a[152:155], v[80:83]
  v_mfma_f32_16x16x32_bf16 v[84:87], v[96:99], a[184:187], v[84:87]
  v_mfma_f32_16x16x32_bf16 v[88:91], v[96:99], a[216:219], v[88:91]
  ds_read2_b32 v[96:97], v52 offset0:16 offset1:17
  ds_read2_b32 v[98:99], v52 offset0:18 offset1:19
  s_waitcnt lgkmcnt(6)
  v_mfma_f32_16x16x32_bf16 v[64:67], v[100:103], a[20:23], v[64:67]
  v_mfma_f32_16x16x32_bf16 v[68:71], v[100:103], a[52:55], v[68:71]
  v_mfma_f32_16x16x32_bf16 v[72:75], v[100:103], a[84:87], v[72:75]
  v_mfma_f32_16x16x32_bf16 v[76:79], v[100:103], a[116:119], v[76:79]
  v_mfma_f32_16x16x32_bf16 v[80:83], v[100:103], a[148:151], v[80:83]
  v_mfma_f32_16x16x32_bf16 v[84:87], v[100:103], a[180:183], v[84:87]
  v_mfma_f32_16x16x32_bf16 v[88:91], v[100:103], a[212:215], v[88:91]
  ds_read2_b32 v[100:101], v52 offset0:0 offset1:1
  ds_read2_b32 v[102:103], v52 offset0:2 offset1:3
  s_waitcnt lgkmcnt(6)
  v_mfma_f32_16x16x32_bf16 v[64:67], v[104:107], a[16:19], v[64:67]
  v_mfma_f32_16x16x32_bf16 v[68:71], v[104:107], a[48:51], v[68:71]
  v_mfma_f32_16x16x32_bf16 v[72:75], v[104:107], a[80:83], v[72:75]
  v_mfma_f32_16x16x32_bf16 v[76:79], v[104:107], a[112:115], v[76:79]
  v_mfma_f32_16x16x32_bf16 v[80:83], v[104:107], a[144:147], v[80:83]
  v_mfma_f32_16x16x32_bf16 v[84:87], v[104:107], a[176:179], v[84:87]
  v_mfma_f32_16x16x32_bf16 v[88:91], v[104:107], a[208:211], v[88:91]
  ds_read2_b32 v[104:105], v53 offset0:224 offset1:225
  ds_read2_b32 v[106:107], v53 offset0:226 offset1:227
  s_waitcnt lgkmcnt(6)
  v_mfma_f32_16x16x32_bf16 v[64:67], v[92:95], a[12:15], v[64:67]
  v_mfma_f32_16x16x32_bf16 v[68:71], v[92:95], a[44:47], v[68:71]
  v_mfma_f32_16x16x32_bf16 v[72:75], v[92:95], a[76:79], v[72:75]
  v_mfma_f32_16x16x32_bf16 v[76:79], v[92:95], a[108:111], v[76:79]
  v_mfma_f32_16x16x32_bf16 v[80:83], v[92:95], a[140:143], v[80:83]
  v_mfma_f32_16x16x32_bf16 v[84:87], v[92:95], a[172:175], v[84:87]
  v_mfma_f32_16x16x32_bf16 v[88:91], v[92:95], a[204:207], v[88:91]
  ds_read2_b32 v[92:93], v53 offset0:208 offset1:209
  ds_read2_b32 v[94:95], v53 offset0:210 offset1:211
  s_waitcnt lgkmcnt(6)
  v_mfma_f32_16x16x32_bf16 v[64:67], v[96:99], a[8:11], v[64:67]
  v_mfma_f32_16x16x32_bf16 v[68:71], v[96:99], a[40:43], v[68:71]
  v_mfma_f32_16x16x32_bf16 v[72:75], v[96:99], a[72:75], v[72:75]
  v_mfma_f32_16x16x32_bf16 v[76:79], v[96:99], a[104:107], v[76:79]
  v_mfma_f32_16x16x32_bf16 v[80:83], v[96:99], a[136:139], v[80:83]
  v_mfma_f32_16x16x32_bf16 v[84:87], v[96:99], a[168:171], v[84:87]
  v_mfma_f32_16x16x32_bf16 v[88:91], v[96:99], a[200:203], v[88:91]
  ds_read2_b32 v[96:97], v53 offset0:192 offset1:193
  ds_read2_b32 v[98:99], v53 offset0:194 offset1:195
  s_waitcnt lgkmcnt(6)
  v_mfma_f32_16x16x32_bf16 v[64:67], v[100:103], a[4:7], v[64:67]
  v_mfma_f32_16x16x32_bf16 v[68:71], v[100:103], a[36:39], v[68:71]
  v_mfma_f32_16x16x32_bf16 v[72:75], v[100:103], a[68:71], v[72:75]
  v_mfma_f32_16x16x32_bf16 v[76:79], v[100:103], a[100:103], v[76:79]
  v_mfma_f32_16x16x32_bf16 v[80:83], v[100:103], a[132:135], v[80:83]
  v_mfma_f32_16x16x32_bf16 v[84:87], v[100:103], a[164:167], v[84:87]
  v_mfma_f32_16x16x32_bf16 v[88:91], v[100:103], a[196:199], v[88:91]
  ds_read2_b32 v[100:101], v53 offset0:176 offset1:177
  ds_read2_b32 v[102:103], v53 offset0:178 offset1:179
  s_waitcnt lgkmcnt(6)
  v_mfma_f32_16x16x32_bf16 v[64:67], v[104:107], a[0:3], v[64:67]
  v_mfma_f32_16x16x32_bf16 v[68:71], v[104:107], a[32:35], v[68:71]
  v_mfma_f32_16x16x32_bf16 v[72:75], v[104:107], a[64:67], v[72:75]
  v_mfma_f32_16x16x32_bf16 v[76:79], v[104:107], a[96:99], v[76:79]
  v_mfma_f32_16x16x32_bf16 v[80:83], v[104:107], a[128:131], v[80:83]
  v_mfma_f32_16x16x32_bf16 v[84:87], v[104:107], a[160:163], v[84:87]
  v_mfma_f32_16x16x32_bf16 v[88:91], v[104:107], a[192:195], v[88:91]
  ds_read2_b32 v[104:105], v53 offset0:160 offset1:161
  ds_read2_b32 v[106:107], v53 offset0:162 offset1:163
  s_waitcnt lgkmcnt(6)
  v_mfma_f32_16x16x32_bf16 v[68:71], v[92:95], a[28:31], v[68:71]
  v_mfma_f32_16x16x32_bf16 v[72:75], v[92:95], a[60:63], v[72:75]
  v_mfma_f32_16x16x32_bf16 v[76:79], v[92:95], a[92:95], v[76:79]
  v_mfma_f32_16x16x32_bf16 v[80:83], v[92:95], a[124:127], v[80:83]
  v_mfma_f32_16x16x32_bf16 v[84:87], v[92:95], a[156:159], v[84:87]
  v_mfma_f32_16x16x32_bf16 v[88:91], v[92:95], a[188:191], v[88:91]
  ds_read2_b32 v[92:93], v53 offset0:144 offset1:145
  ds_read2_b32 v[94:95], v53 offset0:146 offset1:147
  s_waitcnt lgkmcnt(6)
  v_mfma_f32_16x16x32_bf16 v[68:71], v[96:99], a[24:27], v[68:71]
  v_mfma_f32_16x16x32_bf16 v[72:75], v[96:99], a[56:59], v[72:75]
  v_mfma_f32_16x16x32_bf16 v[76:79], v[96:99], a[88:91], v[76:79]
  v_mfma_f32_16x16x32_bf16 v[80:83], v[96:99], a[120:123], v[80:83]
  v_mfma_f32_16x16x32_bf16 v[84:87], v[96:99], a[152:155], v[84:87]
  v_mfma_f32_16x16x32_bf16 v[88:91], v[96:99], a[184:187], v[88:91]
  ds_read2_b32 v[96:97], v53 offset0:128 offset1:129
  ds_read2_b32 v[98:99], v53 offset0:130 offset1:131
  s_waitcnt lgkmcnt(6)
  v_mfma_f32_16x16x32_bf16 v[68:71], v[100:103], a[20:23], v[68:71]
  v_mfma_f32_16x16x32_bf16 v[72:75], v[100:103], a[52:55], v[72:75]
  v_mfma_f32_16x16x32_bf16 v[76:79], v[100:103], a[84:87], v[76:79]
  v_mfma_f32_16x16x32_bf16 v[80:83], v[100:103], a[116:119], v[80:83]
  v_mfma_f32_16x16x32_bf16 v[84:87], v[100:103], a[148:151], v[84:87]
  v_mfma_f32_16x16x32_bf16 v[88:91], v[100:103], a[180:183], v[88:91]
  ds_read2_b32 v[100:101], v53 offset0:112 offset1:113
  ds_read2_b32 v[102:103], v53 offset0:114 offset1:115
  s_waitcnt lgkmcnt(6)
  v_mfma_f32_16x16x32_bf16 v[68:71], v[104:107], a[16:19], v[68:71]
  v_mfma_f32_16x16x32_bf16 v[72:75], v[104:107], a[48:51], v[72:75]
  v_mfma_f32_16x16x32_bf16 v[76:79], v[104:107], a[80:83], v[76:79]
  v_mfma_f32_16x16x32_bf16 v[80:83], v[104:107], a[112:115], v[80:83]
  v_mfma_f32_16x16x32_bf16 v[84:87], v[104:107], a[144:147], v[84:87]
  v_mfma_f32_16x16x32_bf16 v[88:91], v[104:107], a[176:179], v[88:91]
  ds_read2_b32 v[104:105], v53 offset0:96 offset1:97
  ds_read2_b32 v[106:107], v53 offset0:98 offset1:99
  s_waitcnt lgkmcnt(6)
  v_mfma_f32_16x16x32_bf16 v[68:71], v[92:95], a[12:15], v[68:71]
  v_mfma_f32_16x16x32_bf16 v[72:75], v[92:95], a[44:47], v[72:75]
  v_mfma_f32_16x16x32_bf16 v[76:79], v[92:95], a[76:79], v[76:79]
  v_mfma_f32_16x16x32_bf16 v[80:83], v[92:95], a[108:111], v[80:83]
  v_mfma_f32_16x16x32_bf16 v[84:87], v[92:95], a[140:143], v[84:87]
  v_mfma_f32_16x16x32_bf16 v[88:91], v[92:95], a[172:175], v[88:91]
  ds_read2_b32 v[92:93], v53 offset0:80 offset1:81
  ds_read2_b32 v[94:95], v53 offset0:82 offset1:83
  s_waitcnt lgkmcnt(6)
  v_mfma_f32_16x16x32_bf16 v[68:71], v[96:99], a[8:11], v[68:71]
  v_mfma_f32_16x16x32_bf16 v[72:75], v[96:99], a[40:43], v[72:75]
  v_mfma_f32_16x16x32_bf16 v[76:79], v[96:99], a[72:75], v[76:79]
  v_mfma_f32_16x16x32_bf16 v[80:83], v[96:99], a[104:107], v[80:83]
  v_mfma_f32_16x16x32_bf16 v[84:87], v[96:99], a[136:139], v[84:87]
  v_mfma_f32_16x16x32_bf16 v[88:91], v[96:99], a[168:171], v[88:91]
  ds_read2_b32 v[96:97], v53 offset0:64 offset1:65
  ds_read2_b32 v[98:99], v53 offset0:66 offset1:67
  s_waitcnt lgkmcnt(6)
  v_mfma_f32_16x16x32_bf16 v[68:71], v[100:103], a[4:7], v[68:71]
  v_mfma_f32_16x16x32_bf16 v[72:75], v[100:103], a[36:39], v[72:75]
  v_mfma_f32_16x16x32_bf16 v[76:79], v[100:103], a[68:71], v[76:79]
  v_mfma_f32_16x16x32_bf16 v[80:83], v[100:103], a[100:103], v[80:83]
  v_mfma_f32_16x16x32_bf16 v[84:87], v[100:103], a[132:135], v[84:87]
  v_mfma_f32_16x16x32_bf16 v[88:91], v[100:103], a[164:167], v[88:91]
  ds_read2_b32 v[100:101], v53 offset0:48 offset1:49
  ds_read2_b32 v[102:103], v53 offset0:50 offset1:51
  s_waitcnt lgkmcnt(6)
  v_mfma_f32_16x16x32_bf16 v[68:71], v[104:107], a[0:3], v[68:71]
  v_mfma_f32_16x16x32_bf16 v[72:75], v[104:107], a[32:35], v[72:75]
  v_mfma_f32_16x16x32_bf16 v[76:79], v[104:107], a[64:67], v[76:79]
  v_mfma_f32_16x16x32_bf16 v[80:83], v[104:107], a[96:99], v[80:83]
  v_mfma_f32_16x16x32_bf16 v[84:87], v[104:107], a[128:131], v[84:87]
  v_mfma_f32_16x16x32_bf16 v[88:91], v[104:107], a[160:163], v[88:91]
  ds_read2_b32 v[104:105], v53 offset0:32 offset1:33
  ds_read2_b32 v[106:107], v53 offset0:34 offset1:35
  s_waitcnt lgkmcnt(6)
  v_mfma_f32_16x16x32_bf16 v[72:75], v[92:95], a[28:31], v[72:75]
  v_mfma_f32_16x16x32_bf16 v[76:79], v[92:95], a[60:63], v[76:79]
  v_mfma_f32_16x16x32_bf16 v[80:83], v[92:95], a[92:95], v[80:83]
  v_mfma_f32_16x16x32_bf16 v[84:87], v[92:95], a[124:127], v[84:87]
  v_mfma_f32_16x16x32_bf16 v[88:91], v[92:95], a[156:159], v[88:91]
  ds_read2_b32 v[92:93], v53 offset0:16 offset1:17
  ds_read2_b32 v[94:95], v53 offset0:18 offset1:19
  s_waitcnt lgkmcnt(6)
  v_mfma_f32_16x16x32_bf16 v[72:75], v[96:99], a[24:27], v[72:75]
  v_mfma_f32_16x16x32_bf16 v[76:79], v[96:99], a[56:59], v[76:79]
  v_mfma_f32_16x16x32_bf16 v[80:83], v[96:99], a[88:91], v[80:83]
  v_mfma_f32_16x16x32_bf16 v[84:87], v[96:99], a[120:123], v[84:87]
  v_mfma_f32_16x16x32_bf16 v[88:91], v[96:99], a[152:155], v[88:91]
  ds_read2_b32 v[96:97], v53 offset0:0 offset1:1
  ds_read2_b32 v[98:99], v53 offset0:2 offset1:3
  s_waitcnt lgkmcnt(6)
  v_mfma_f32_16x16x32_bf16 v[72:75], v[100:103], a[20:23], v[72:75]
  v_mfma_f32_16x16x32_bf16 v[76:79], v[100:103], a[52:55], v[76:79]
  v_mfma_f32_16x16x32_bf16 v[80:83], v[100:103], a[84:87], v[80:83]
  v_mfma_f32_16x16x32_bf16 v[84:87], v[100:103], a[116:119], v[84:87]
  v_mfma_f32_16x16x32_bf16 v[88:91], v[100:103], a[148:151], v[88:91]
  ds_read2_b32 v[100:101], v54 offset0:224 offset1:225
  ds_read2_b32 v[102:103], v54 offset0:226 offset1:227
  s_waitcnt lgkmcnt(6)
  v_mfma_f32_16x16x32_bf16 v[72:75], v[104:107], a[16:19], v[72:75]
  v_mfma_f32_16x16x32_bf16 v[76:79], v[104:107], a[48:51], v[76:79]
  v_mfma_f32_16x16x32_bf16 v[80:83], v[104:107], a[80:83], v[80:83]
  v_mfma_f32_16x16x32_bf16 v[84:87], v[104:107], a[112:115], v[84:87]
  v_mfma_f32_16x16x32_bf16 v[88:91], v[104:107], a[144:147], v[88:91]
  ds_read2_b32 v[104:105], v54 offset0:208 offset1:209
  ds_read2_b32 v[106:107], v54 offset0:210 offset1:211
  s_waitcnt lgkmcnt(6)
  v_mfma_f32_16x16x32_bf16 v[72:75], v[92:95], a[12:15], v[72:75]
  v_mfma_f32_16x16x32_bf16 v[76:79], v[92:95], a[44:47], v[76:79]
  v_mfma_f32_16x16x32_bf16 v[80:83], v[92:95], a[76:79], v[80:83]
  v_mfma_f32_16x16x32_bf16 v[84:87], v[92:95], a[108:111], v[84:87]
  v_mfma_f32_16x16x32_bf16 v[88:91], v[92:95], a[140:143], v[88:91]
  ds_read2_b32 v[92:93], v54 offset0:192 offset1:193
  ds_read2_b32 v[94:95], v54 offset0:194 offset1:195
  s_waitcnt lgkmcnt(6)
  v_mfma_f32_16x16x32_bf16 v[72:75], v[96:99], a[8:11], v[72:75]
  v_mfma_f32_16x16x32_bf16 v[76:79], v[96:99], a[40:43], v[76:79]
  v_mfma_f32_16x16x32_bf16 v[80:83], v[96:99], a[72:75], v[80:83]
  v_mfma_f32_16x16x32_bf16 v[84:87], v[96:99], a[104:107], v[84:87]
  v_mfma_f32_16x16x32_bf16 v[88:91], v[96:99], a[136:139], v[88:91]
  ds_read2_b32 v[96:97], v54 offset0:176 offset1:177
  ds_read2_b32 v[98:99], v54 offset0:178 offset1:179
  s_waitcnt lgkmcnt(6)
  v_mfma_f32_16x16x32_bf16 v[72:75], v[100:103], a[4:7], v[72:75]
  v_mfma_f32_16x16x32_bf16 v[76:79], v[100:103], a[36:39], v[76:79]
  v_mfma_f32_16x16x32_bf16 v[80:83], v[100:103], a[68:71], v[80:83]
  v_mfma_f32_16x16x32_bf16 v[84:87], v[100:103], a[100:103], v[84:87]
  v_mfma_f32_16x16x32_bf16 v[88:91], v[100:103], a[132:135], v[88:91]
  ds_read2_b32 v[100:101], v54 offset0:160 offset1:161
  ds_read2_b32 v[102:103], v54 offset0:162 offset1:163
  s_waitcnt lgkmcnt(6)
  v_mfma_f32_16x16x32_bf16 v[72:75], v[104:107], a[0:3], v[72:75]
  v_mfma_f32_16x16x32_bf16 v[76:79], v[104:107], a[32:35], v[76:79]
  v_mfma_f32_16x16x32_bf16 v[80:83], v[104:107], a[64:67], v[80:83]
  v_mfma_f32_16x16x32_bf16 v[84:87], v[104:107], a[96:99], v[84:87]
  v_mfma_f32_16x16x32_bf16 v[88:91], v[104:107], a[128:131], v[88:91]
  ds_read2_b32 v[104:105], v54 offset0:144 offset1:145
  ds_read2_b32 v[106:107], v54 offset0:146 offset1:147
  s_waitcnt lgkmcnt(6)
  v_mfma_f32_16x16x32_bf16 v[76:79], v[92:95], a[28:31], v[76:79]
  v_mfma_f32_16x16x32_bf16 v[80:83], v[92:95], a[60:63], v[80:83]
  v_mfma_f32_16x16x32_bf16 v[84:87], v[92:95], a[92:95], v[84:87]
  v_mfma_f32_16x16x32_bf16 v[88:91], v[92:95], a[124:127], v[88:91]
  ds_read2_b32 v[92:93], v54 offset0:128 offset1:129
  ds_read2_b32 v[94:95], v54 offset0:130 offset1:131
  s_waitcnt lgkmcnt(6)
  v_mfma_f32_16x16x32_bf16 v[76:79], v[96:99], a[24:27], v[76:79]
  v_mfma_f32_16x16x32_bf16 v[80:83], v[96:99], a[56:59], v[80:83]
  v_mfma_f32_16x16x32_bf16 v[84:87], v[96:99], a[88:91], v[84:87]
  v_mfma_f32_16x16x32_bf16 v[88:91], v[96:99], a[120:123], v[88:91]
  ds_read2_b32 v[96:97], v54 offset0:112 offset1:113
  ds_read2_b32 v[98:99], v54 offset0:114 offset1:115
  s_waitcnt lgkmcnt(6)
  v_mfma_f32_16x16x32_bf16 v[76:79], v[100:103], a[20:23], v[76:79]
  v_mfma_f32_16x16x32_bf16 v[80:83], v[100:103], a[52:55], v[80:83]
  v_mfma_f32_16x16x32_bf16 v[84:87], v[100:103], a[84:87], v[84:87]
  v_mfma_f32_16x16x32_bf16 v[88:91], v[100:103], a[116:119], v[88:91]
  ds_read2_b32 v[100:101], v54 offset0:96 offset1:97
  ds_read2_b32 v[102:103], v54 offset0:98 offset1:99
  s_waitcnt lgkmcnt(6)
  v_mfma_f32_16x16x32_bf16 v[76:79], v[104:107], a[16:19], v[76:79]
  v_mfma_f32_16x16x32_bf16 v[80:83], v[104:107], a[48:51], v[80:83]
  v_mfma_f32_16x16x32_bf16 v[84:87], v[104:107], a[80:83], v[84:87]
  v_mfma_f32_16x16x32_bf16 v[88:91], v[104:107], a[112:115], v[88:91]
  ds_read2_b32 v[104:105], v54 offset0:80 offset1:81
  ds_read2_b32 v[106:107], v54 offset0:82 offset1:83
  s_waitcnt lgkmcnt(6)
  v_mfma_f32_16x16x32_bf16 v[76:79], v[92:95], a[12:15], v[76:79]
  v_mfma_f32_16x16x32_bf16 v[80:83], v[92:95], a[44:47], v[80:83]
  v_mfma_f32_16x16x32_bf16 v[84:87], v[92:95], a[76:79], v[84:87]
  v_mfma_f32_16x16x32_bf16 v[88:91], v[92:95], a[108:111], v[88:91]
  ds_read2_b32 v[92:93], v54 offset0:64 offset1:65
  ds_read2_b32 v[94:95], v54 offset0:66 offset1:67
  s_waitcnt lgkmcnt(6)
  v_mfma_f32_16x16x32_bf16 v[76:79], v[96:99], a[8:11], v[76:79]
  v_mfma_f32_16x16x32_bf16 v[80:83], v[96:99], a[40:43], v[80:83]
  v_mfma_f32_16x16x32_bf16 v[84:87], v[96:99], a[72:75], v[84:87]
  v_mfma_f32_16x16x32_bf16 v[88:91], v[96:99], a[104:107], v[88:91]
  ds_read2_b32 v[96:97], v54 offset0:48 offset1:49
  ds_read2_b32 v[98:99], v54 offset0:50 offset1:51
  s_waitcnt lgkmcnt(6)
  v_mfma_f32_16x16x32_bf16 v[76:79], v[100:103], a[4:7], v[76:79]
  v_mfma_f32_16x16x32_bf16 v[80:83], v[100:103], a[36:39], v[80:83]
  v_mfma_f32_16x16x32_bf16 v[84:87], v[100:103], a[68:71], v[84:87]
  v_mfma_f32_16x16x32_bf16 v[88:91], v[100:103], a[100:103], v[88:91]
  ds_read2_b32 v[100:101], v54 offset0:32 offset1:33
  ds_read2_b32 v[102:103], v54 offset0:34 offset1:35
  s_waitcnt lgkmcnt(6)
  v_mfma_f32_16x16x32_bf16 v[76:79], v[104:107], a[0:3], v[76:79]
  v_mfma_f32_16x16x32_bf16 v[80:83], v[104:107], a[32:35], v[80:83]
  v_mfma_f32_16x16x32_bf16 v[84:87], v[104:107], a[64:67], v[84:87]
  v_mfma_f32_16x16x32_bf16 v[88:91], v[104:107], a[96:99], v[88:91]
  ds_read2_b32 v[104:105], v54 offset0:16 offset1:17
  ds_read2_b32 v[106:107], v54 offset0:18 offset1:19
  s_waitcnt lgkmcnt(6)
  v_mfma_f32_16x16x32_bf16 v[80:83], v[92:95], a[28:31], v[80:83]
  v_mfma_f32_16x16x32_bf16 v[84:87], v[92:95], a[60:63], v[84:87]
  v_mfma_f32_16x16x32_bf16 v[88:91], v[92:95], a[92:95], v[88:91]
  ds_read2_b32 v[92:93], v54 offset0:0 offset1:1
  ds_read2_b32 v[94:95], v54 offset0:2 offset1:3
  s_waitcnt lgkmcnt(6)
  v_mfma_f32_16x16x32_bf16 v[80:83], v[96:99], a[24:27], v[80:83]
  v_mfma_f32_16x16x32_bf16 v[84:87], v[96:99], a[56:59], v[84:87]
  v_mfma_f32_16x16x32_bf16 v[88:91], v[96:99], a[88:91], v[88:91]
  ds_read2_b32 v[96:97], v55 offset0:224 offset1:225
  ds_read2_b32 v[98:99], v55 offset0:226 offset1:227
  s_waitcnt lgkmcnt(6)
  v_mfma_f32_16x16x32_bf16 v[80:83], v[100:103], a[20:23], v[80:83]
  v_mfma_f32_16x16x32_bf16 v[84:87], v[100:103], a[52:55], v[84:87]
  v_mfma_f32_16x16x32_bf16 v[88:91], v[100:103], a[84:87], v[88:91]
  ds_read2_b32 v[100:101], v55 offset0:208 offset1:209
  ds_read2_b32 v[102:103], v55 offset0:210 offset1:211
  s_waitcnt lgkmcnt(6)
  v_mfma_f32_16x16x32_bf16 v[80:83], v[104:107], a[16:19], v[80:83]
  v_mfma_f32_16x16x32_bf16 v[84:87], v[104:107], a[48:51], v[84:87]
  v_mfma_f32_16x16x32_bf16 v[88:91], v[104:107], a[80:83], v[88:91]
  ds_read2_b32 v[104:105], v55 offset0:192 offset1:193
  ds_read2_b32 v[106:107], v55 offset0:194 offset1:195
  s_waitcnt lgkmcnt(6)
  v_mfma_f32_16x16x32_bf16 v[80:83], v[92:95], a[12:15], v[80:83]
  v_mfma_f32_16x16x32_bf16 v[84:87], v[92:95], a[44:47], v[84:87]
  v_mfma_f32_16x16x32_bf16 v[88:91], v[92:95], a[76:79], v[88:91]
  ds_read2_b32 v[92:93], v55 offset0:176 offset1:177
  ds_read2_b32 v[94:95], v55 offset0:178 offset1:179
  s_waitcnt lgkmcnt(6)
  v_mfma_f32_16x16x32_bf16 v[80:83], v[96:99], a[8:11], v[80:83]
  v_mfma_f32_16x16x32_bf16 v[84:87], v[96:99], a[40:43], v[84:87]
  v_mfma_f32_16x16x32_bf16 v[88:91], v[96:99], a[72:75], v[88:91]
  ds_read2_b32 v[96:97], v55 offset0:160 offset1:161
  ds_read2_b32 v[98:99], v55 offset0:162 offset1:163
  s_waitcnt lgkmcnt(6)
  v_mfma_f32_16x16x32_bf16 v[80:83], v[100:103], a[4:7], v[80:83]
  v_mfma_f32_16x16x32_bf16 v[84:87], v[100:103], a[36:39], v[84:87]
  v_mfma_f32_16x16x32_bf16 v[88:91], v[100:103], a[68:71], v[88:91]
  ds_read2_b32 v[100:101], v55 offset0:144 offset1:145
  ds_read2_b32 v[102:103], v55 offset0:146 offset1:147
  s_waitcnt lgkmcnt(6)
  v_mfma_f32_16x16x32_bf16 v[80:83], v[104:107], a[0:3], v[80:83]
  v_mfma_f32_16x16x32_bf16 v[84:87], v[104:107], a[32:35], v[84:87]
  v_mfma_f32_16x16x32_bf16 v[88:91], v[104:107], a[64:67], v[88:91]
  ds_read2_b32 v[104:105], v55 offset0:128 offset1:129
  ds_read2_b32 v[106:107], v55 offset0:130 offset1:131
  s_waitcnt lgkmcnt(6)
  v_mfma_f32_16x16x32_bf16 v[84:87], v[92:95], a[28:31], v[84:87]
  v_mfma_f32_16x16x32_bf16 v[88:91], v[92:95], a[60:63], v[88:91]
  ds_read2_b32 v[92:93], v55 offset0:112 offset1:113
  ds_read2_b32 v[94:95], v55 offset0:114 offset1:115
  s_waitcnt lgkmcnt(6)
  v_mfma_f32_16x16x32_bf16 v[84:87], v[96:99], a[24:27], v[84:87]
  v_mfma_f32_16x16x32_bf16 v[88:91], v[96:99], a[56:59], v[88:91]
  ds_read2_b32 v[96:97], v55 offset0:96 offset1:97
  ds_read2_b32 v[98:99], v55 offset0:98 offset1:99
  s_waitcnt lgkmcnt(6)
  v_mfma_f32_16x16x32_bf16 v[84:87], v[100:103], a[20:23], v[84:87]
  v_mfma_f32_16x16x32_bf16 v[88:91], v[100:103], a[52:55], v[88:91]
  ds_read2_b32 v[100:101], v55 offset0:80 offset1:81
  ds_read2_b32 v[102:103], v55 offset0:82 offset1:83
  s_waitcnt lgkmcnt(6)
  v_mfma_f32_16x16x32_bf16 v[84:87], v[104:107], a[16:19], v[84:87]
  v_mfma_f32_16x16x32_bf16 v[88:91], v[104:107], a[48:51], v[88:91]
  ds_read2_b32 v[104:105], v55 offset0:64 offset1:65
  ds_read2_b32 v[106:107], v55 offset0:66 offset1:67
  s_waitcnt lgkmcnt(6)
  v_mfma_f32_16x16x32_bf16 v[84:87], v[92:95], a[12:15], v[84:87]
  v_mfma_f32_16x16x32_bf16 v[88:91], v[92:95], a[44:47], v[88:91]
  ds_read2_b32 v[92:93], v55 offset0:48 offset1:49
  ds_read2_b32 v[94:95], v55 offset0:50 offset1:51
  s_waitcnt lgkmcnt(6)
  v_mfma_f32_16x16x32_bf16 v[84:87], v[96:99], a[8:11], v[84:87]
  v_mfma_f32_16x16x32_bf16 v[88:91], v[96:99], a[40:43], v[88:91]
  ds_read2_b32 v[96:97], v55 offset0:32 offset1:33
  ds_read2_b32 v[98:99], v55 offset0:34 offset1:35
  s_waitcnt lgkmcnt(6)
  v_mfma_f32_16x16x32_bf16 v[84:87], v[100:103], a[4:7], v[84:87]
  v_mfma_f32_16x16x32_bf16 v[88:91], v[100:103], a[36:39], v[88:91]
  ds_read2_b32 v[100:101], v55 offset0:16 offset1:17
  ds_read2_b32 v[102:103], v55 offset0:18 offset1:19
  s_waitcnt lgkmcnt(6)
  v_mfma_f32_16x16x32_bf16 v[84:87], v[104:107], a[0:3], v[84:87]
  v_mfma_f32_16x16x32_bf16 v[88:91], v[104:107], a[32:35], v[88:91]
  ds_read2_b32 v[104:105], v55 offset0:0 offset1:1
  ds_read2_b32 v[106:107], v55 offset0:2 offset1:3
  s_waitcnt lgkmcnt(6)
  v_mfma_f32_16x16x32_bf16 v[88:91], v[92:95], a[28:31], v[88:91]
  ds_read2_b32 v[92:93], v56 offset0:224 offset1:225
  ds_read2_b32 v[94:95], v56 offset0:226 offset1:227
  s_waitcnt lgkmcnt(6)
  v_mfma_f32_16x16x32_bf16 v[88:91], v[96:99], a[24:27], v[88:91]
  ds_read2_b32 v[96:97], v56 offset0:208 offset1:209
  ds_read2_b32 v[98:99], v56 offset0:210 offset1:211
  s_waitcnt lgkmcnt(6)
  v_mfma_f32_16x16x32_bf16 v[88:91], v[100:103], a[20:23], v[88:91]
  ds_read2_b32 v[100:101], v56 offset0:192 offset1:193
  ds_read2_b32 v[102:103], v56 offset0:194 offset1:195
  s_waitcnt lgkmcnt(6)
  v_mfma_f32_16x16x32_bf16 v[88:91], v[104:107], a[16:19], v[88:91]
  ds_read2_b32 v[104:105], v56 offset0:176 offset1:177
  ds_read2_b32 v[106:107], v56 offset0:178 offset1:179
  s_waitcnt lgkmcnt(6)
  v_mfma_f32_16x16x32_bf16 v[88:91], v[92:95], a[12:15], v[88:91]
  s_waitcnt lgkmcnt(4)
  v_mfma_f32_16x16x32_bf16 v[88:91], v[96:99], a[8:11], v[88:91]
  s_waitcnt lgkmcnt(2)
  v_mfma_f32_16x16x32_bf16 v[88:91], v[100:103], a[4:7], v[88:91]
  s_waitcnt lgkmcnt(0)
  v_mfma_f32_16x16x32_bf16 v[88:91], v[104:107], a[0:3], v[88:91]
  v_lshlrev_b32 v46, 5, v4
  v_lshl_add_u32 v46, v3, 3, v46
  v_add_u32 v46, s17, v46
  ds_read_b64 v[108:109], v46 offset:512
  ds_read_b64 v[110:111], v46 offset:1024
  ds_read_b64 v[112:113], v46 offset:1536
  ds_read_b64 v[114:115], v46 offset:2048
  ds_read_b64 v[116:117], v46 offset:2560
  ds_read_b64 v[118:119], v46 offset:3072
  ds_read_b64 v[120:121], v46 offset:3584
  ds_read_b64 v[122:123], v46 offset:4096
  s_waitcnt lgkmcnt(0)
  v_lshlrev_b32 v124, 16, v108
  v_and_b32 v125, 0xffff0000, v108
  v_lshlrev_b32 v126, 16, v109
  v_and_b32 v127, 0xffff0000, v109
  v_mul_f32 v124, v124, v33
  v_mul_f32 v125, v125, v33
  v_mul_f32 v126, v126, v33
  v_mul_f32 v127, v127, v33
  v_cvt_pk_bf16_f32 v128, v124, v125
  v_cvt_pk_bf16_f32 v129, v126, v127
  v_cvt_pk_bf16_f32 v130, v60, v61
  v_cvt_pk_bf16_f32 v131, v62, v63
  v_lshlrev_b32 v124, 16, v128
  v_and_b32 v125, 0xffff0000, v128
  v_lshlrev_b32 v132, 16, v130
  v_and_b32 v133, 0xffff0000, v130
  v_lshlrev_b32 v126, 16, v129
  v_and_b32 v127, 0xffff0000, v129
  v_lshlrev_b32 v134, 16, v131
  v_and_b32 v135, 0xffff0000, v131
  v_add_f32 v124, v124, v132
  v_add_f32 v125, v125, v133
  v_add_f32 v126, v126, v134
  v_add_f32 v127, v127, v135
  v_cvt_pk_bf16_f32 v108, v124, v125
  v_cvt_pk_bf16_f32 v109, v126, v127
  ds_write_b64 v46, v[108:109] offset:512
  v_lshlrev_b32 v124, 16, v110
  v_and_b32 v125, 0xffff0000, v110
  v_lshlrev_b32 v126, 16, v111
  v_and_b32 v127, 0xffff0000, v111
  v_mul_f32 v124, v124, v33
  v_mul_f32 v125, v125, v33
  v_mul_f32 v126, v126, v33
  v_mul_f32 v127, v127, v33
  v_cvt_pk_bf16_f32 v128, v124, v125
  v_cvt_pk_bf16_f32 v129, v126, v127
  v_cvt_pk_bf16_f32 v130, v64, v65
  v_cvt_pk_bf16_f32 v131, v66, v67
  v_lshlrev_b32 v124, 16, v128
  v_and_b32 v125, 0xffff0000, v128
  v_lshlrev_b32 v132, 16, v130
  v_and_b32 v133, 0xffff0000, v130
  v_lshlrev_b32 v126, 16, v129
  v_and_b32 v127, 0xffff0000, v129
  v_lshlrev_b32 v134, 16, v131
  v_and_b32 v135, 0xffff0000, v131
  v_add_f32 v124, v124, v132
  v_add_f32 v125, v125, v133
  v_add_f32 v126, v126, v134
  v_add_f32 v127, v127, v135
  v_cvt_pk_bf16_f32 v110, v124, v125
  v_cvt_pk_bf16_f32 v111, v126, v127
  ds_write_b64 v46, v[110:111] offset:1024
  v_lshlrev_b32 v124, 16, v112
  v_and_b32 v125, 0xffff0000, v112
  v_lshlrev_b32 v126, 16, v113
  v_and_b32 v127, 0xffff0000, v113
  v_mul_f32 v124, v124, v33
  v_mul_f32 v125, v125, v33
  v_mul_f32 v126, v126, v33
  v_mul_f32 v127, v127, v33
  v_cvt_pk_bf16_f32 v128, v124, v125
  v_cvt_pk_bf16_f32 v129, v126, v127
  v_cvt_pk_bf16_f32 v130, v68, v69
  v_cvt_pk_bf16_f32 v131, v70, v71
  v_lshlrev_b32 v124, 16, v128
  v_and_b32 v125, 0xffff0000, v128
  v_lshlrev_b32 v132, 16, v130
  v_and_b32 v133, 0xffff0000, v130
  v_lshlrev_b32 v126, 16, v129
  v_and_b32 v127, 0xffff0000, v129
  v_lshlrev_b32 v134, 16, v131
  v_and_b32 v135, 0xffff0000, v131
  v_add_f32 v124, v124, v132
  v_add_f32 v125, v125, v133
  v_add_f32 v126, v126, v134
  v_add_f32 v127, v127, v135
  v_cvt_pk_bf16_f32 v112, v124, v125
  v_cvt_pk_bf16_f32 v113, v126, v127
  ds_write_b64 v46, v[112:113] offset:1536
  v_lshlrev_b32 v124, 16, v114
  v_and_b32 v125, 0xffff0000, v114
  v_lshlrev_b32 v126, 16, v115
  v_and_b32 v127, 0xffff0000, v115
  v_mul_f32 v124, v124, v33
  v_mul_f32 v125, v125, v33
  v_mul_f32 v126, v126, v33
  v_mul_f32 v127, v127, v33
  v_cvt_pk_bf16_f32 v128, v124, v125
  v_cvt_pk_bf16_f32 v129, v126, v127
  v_cvt_pk_bf16_f32 v130, v72, v73
  v_cvt_pk_bf16_f32 v131, v74, v75
  v_lshlrev_b32 v124, 16, v128
  v_and_b32 v125, 0xffff0000, v128
  v_lshlrev_b32 v132, 16, v130
  v_and_b32 v133, 0xffff0000, v130
  v_lshlrev_b32 v126, 16, v129
  v_and_b32 v127, 0xffff0000, v129
  v_lshlrev_b32 v134, 16, v131
  v_and_b32 v135, 0xffff0000, v131
  v_add_f32 v124, v124, v132
  v_add_f32 v125, v125, v133
  v_add_f32 v126, v126, v134
  v_add_f32 v127, v127, v135
  v_cvt_pk_bf16_f32 v114, v124, v125
  v_cvt_pk_bf16_f32 v115, v126, v127
  ds_write_b64 v46, v[114:115] offset:2048
  v_lshlrev_b32 v124, 16, v116
  v_and_b32 v125, 0xffff0000, v116
  v_lshlrev_b32 v126, 16, v117
  v_and_b32 v127, 0xffff0000, v117
  v_mul_f32 v124, v124, v33
  v_mul_f32 v125, v125, v33
  v_mul_f32 v126, v126, v33
  v_mul_f32 v127, v127, v33
  v_cvt_pk_bf16_f32 v128, v124, v125
  v_cvt_pk_bf16_f32 v129, v126, v127
  v_cvt_pk_bf16_f32 v130, v76, v77
  v_cvt_pk_bf16_f32 v131, v78, v79
  v_lshlrev_b32 v124, 16, v128
  v_and_b32 v125, 0xffff0000, v128
  v_lshlrev_b32 v132, 16, v130
  v_and_b32 v133, 0xffff0000, v130
  v_lshlrev_b32 v126, 16, v129
  v_and_b32 v127, 0xffff0000, v129
  v_lshlrev_b32 v134, 16, v131
  v_and_b32 v135, 0xffff0000, v131
  v_add_f32 v124, v124, v132
  v_add_f32 v125, v125, v133
  v_add_f32 v126, v126, v134
  v_add_f32 v127, v127, v135
  v_cvt_pk_bf16_f32 v116, v124, v125
  v_cvt_pk_bf16_f32 v117, v126, v127
  ds_write_b64 v46, v[116:117] offset:2560
  v_lshlrev_b32 v124, 16, v118
  v_and_b32 v125, 0xffff0000, v118
  v_lshlrev_b32 v126, 16, v119
  v_and_b32 v127, 0xffff0000, v119
  v_mul_f32 v124, v124, v33
  v_mul_f32 v125, v125, v33
  v_mul_f32 v126, v126, v33
  v_mul_f32 v127, v127, v33
  v_cvt_pk_bf16_f32 v128, v124, v125
  v_cvt_pk_bf16_f32 v129, v126, v127
  v_cvt_pk_bf16_f32 v130, v80, v81
  v_cvt_pk_bf16_f32 v131, v82, v83
  v_lshlrev_b32 v124, 16, v128
  v_and_b32 v125, 0xffff0000, v128
  v_lshlrev_b32 v132, 16, v130
  v_and_b32 v133, 0xffff0000, v130
  v_lshlrev_b32 v126, 16, v129
  v_and_b32 v127, 0xffff0000, v129
  v_lshlrev_b32 v134, 16, v131
  v_and_b32 v135, 0xffff0000, v131
  v_add_f32 v124, v124, v132
  v_add_f32 v125, v125, v133
  v_add_f32 v126, v126, v134
  v_add_f32 v127, v127, v135
  v_cvt_pk_bf16_f32 v118, v124, v125
  v_cvt_pk_bf16_f32 v119, v126, v127
  ds_write_b64 v46, v[118:119] offset:3072
  v_lshlrev_b32 v124, 16, v120
  v_and_b32 v125, 0xffff0000, v120
  v_lshlrev_b32 v126, 16, v121
  v_and_b32 v127, 0xffff0000, v121
  v_mul_f32 v124, v124, v33
  v_mul_f32 v125, v125, v33
  v_mul_f32 v126, v126, v33
  v_mul_f32 v127, v127, v33
  v_cvt_pk_bf16_f32 v128, v124, v125
  v_cvt_pk_bf16_f32 v129, v126, v127
  v_cvt_pk_bf16_f32 v130, v84, v85
  v_cvt_pk_bf16_f32 v131, v86, v87
  v_lshlrev_b32 v124, 16, v128
  v_and_b32 v125, 0xffff0000, v128
  v_lshlrev_b32 v132, 16, v130
  v_and_b32 v133, 0xffff0000, v130
  v_lshlrev_b32 v126, 16, v129
  v_and_b32 v127, 0xffff0000, v129
  v_lshlrev_b32 v134, 16, v131
  v_and_b32 v135, 0xffff0000, v131
  v_add_f32 v124, v124, v132
  v_add_f32 v125, v125, v133
  v_add_f32 v126, v126, v134
  v_add_f32 v127, v127, v135
  v_cvt_pk_bf16_f32 v120, v124, v125
  v_cvt_pk_bf16_f32 v121, v126, v127
  ds_write_b64 v46, v[120:121] offset:3584
  v_lshlrev_b32 v124, 16, v122
  v_and_b32 v125, 0xffff0000, v122
  v_lshlrev_b32 v126, 16, v123
  v_and_b32 v127, 0xffff0000, v123
  v_mul_f32 v124, v124, v33
  v_mul_f32 v125, v125, v33
  v_mul_f32 v126, v126, v33
  v_mul_f32 v127, v127, v33
  v_cvt_pk_bf16_f32 v128, v124, v125
  v_cvt_pk_bf16_f32 v129, v126, v127
  v_cvt_pk_bf16_f32 v130, v88, v89
  v_cvt_pk_bf16_f32 v131, v90, v91
  v_lshlrev_b32 v124, 16, v128
  v_and_b32 v125, 0xffff0000, v128
  v_lshlrev_b32 v132, 16, v130
  v_and_b32 v133, 0xffff0000, v130
  v_lshlrev_b32 v126, 16, v129
  v_and_b32 v127, 0xffff0000, v129
  v_lshlrev_b32 v134, 16, v131
  v_and_b32 v135, 0xffff0000, v131
  v_add_f32 v124, v124, v132
  v_add_f32 v125, v125, v133
  v_add_f32 v126, v126, v134
  v_add_f32 v127, v127, v135
  v_cvt_pk_bf16_f32 v122, v124, v125
  v_cvt_pk_bf16_f32 v123, v126, v127
  ds_write_b64 v46, v[122:123] offset:4096
  s_waitcnt lgkmcnt(0)
  s_barrier
  v_lshlrev_b32 v6, 3, v0
  v_mul_u32_u24 v5, 7168, v0
  v_add_u32 v36, 512, v6
  ds_read_b64 v[8:9], v36
  v_add_u32 v36, 25088, v6
  ds_read_b64 v[10:11], v36
  v_add_u32 v36, 49664, v6
  ds_read_b64 v[12:13], v36
  v_add_u32 v36, 74240, v6
  ds_read_b64 v[14:15], v36
  s_waitcnt lgkmcnt(0)
  s_add_u32 s22, s21, 0
  s_add_u32 s23, s22, 3584
  v_perm_b32 v16, v10, v8, s24
  v_perm_b32 v17, v14, v12, s24
  buffer_store_dwordx2 v[16:17], v5, s[88:91], s22 offen offset:0
  v_perm_b32 v18, v10, v8, s25
  v_perm_b32 v19, v14, v12, s25
  buffer_store_dwordx2 v[18:19], v5, s[88:91], s22 offen offset:1792
  v_perm_b32 v20, v11, v9, s24
  v_perm_b32 v21, v15, v13, s24
  buffer_store_dwordx2 v[20:21], v5, s[88:91], s23 offen offset:0
  v_perm_b32 v22, v11, v9, s25
  v_perm_b32 v23, v15, v13, s25
  buffer_store_dwordx2 v[22:23], v5, s[88:91], s23 offen offset:1792
  v_add_u32 v36, 2560, v6
  ds_read_b64 v[8:9], v36
  v_add_u32 v36, 27136, v6
  ds_read_b64 v[10:11], v36
  v_add_u32 v36, 51712, v6
  ds_read_b64 v[12:13], v36
  v_add_u32 v36, 76288, v6
  ds_read_b64 v[14:15], v36
  s_waitcnt lgkmcnt(0)
  s_add_u32 s22, s21, 1835008
  s_add_u32 s23, s22, 3584
  v_perm_b32 v24, v10, v8, s24
  v_perm_b32 v25, v14, v12, s24
  buffer_store_dwordx2 v[24:25], v5, s[88:91], s22 offen offset:0
  v_perm_b32 v26, v10, v8, s25
  v_perm_b32 v27, v14, v12, s25
  buffer_store_dwordx2 v[26:27], v5, s[88:91], s22 offen offset:1792
  v_perm_b32 v28, v11, v9, s24
  v_perm_b32 v29, v15, v13, s24
  buffer_store_dwordx2 v[28:29], v5, s[88:91], s23 offen offset:0
  v_perm_b32 v30, v11, v9, s25
  v_perm_b32 v31, v15, v13, s25
  buffer_store_dwordx2 v[30:31], v5, s[88:91], s23 offen offset:1792
  s_branch wk_loop
wk_tok:
  s_sub_u32 s3, s3, 752
  s_cmp_ge_u32 s3, 512
  s_cbranch_scc1 wk_done
  s_and_b32 s18, s3, 3
  s_lshr_b32 s17, s3, 2
  s_cmp_lt_u32 s17, 8
  s_cbranch_scc1 wk_tokp
  s_sub_u32 s20, s17, 8
  s_sub_u32 s17, s17, 64
  s_cmp_ge_u32 s20, 112
  s_cbranch_scc1 wk_toko
  s_lshr_b32 s17, s20, 1
  s_bitcmp0_b32 s20, 0
  s_cbranch_scc1 wk_toko
  s_add_u32 s17, s17, 8
wk_tokp:
  s_lshl_b32 s20, s18, 2
  s_add_u32 s20, s20, s16
  s_lshl_b32 s21, s17, 4
  s_add_u32 s21, s21, s20
  s_mul_i32 s21, s21, 28672
  s_add_u32 s21, s21, 46399488
  s_mul_i32 s23, s17, 28672
  s_add_u32 s23, s23, 75759616
  s_mul_i32 s24, s17, 7168
  s_add_u32 s24, s24, 65536
  s_lshr_b32 s25, s17, 3
  s_lshl_b32 s25, s25, 4
  s_add_u32 s25, s25, s20
  s_lshl_b32 s25, s25, 7
  s_add_u32 s25, s25, 540672
  v_mov_b32 v60, 0
  s_mov_b32 s30, 0
wp_wf:
  buffer_load_dword v61, v60, s[8:11], s25 offen sc1
  s_waitcnt vmcnt(0)
  v_cmp_ne_u32 vcc, 56, v61
  s_cbranch_vccz wp_wf_ok
  s_sleep 4
  s_cmp_ge_u32 s17, 50
  s_cbranch_scc1 wp_wf_bo
  s_sleep 64
wp_wf_bo:
  s_add_u32 s30, s30, 1
  s_cmp_lt_u32 s30, 2000000
  s_cbranch_scc1 wp_wf
  s_branch wp_abort
wp_wf_ok:
  s_lshl_b32 s25, s17, 1
  s_mul_i32 s25, s25, 20480
  s_add_u32 s25, s25, 86114304
  s_lshl_b32 s26, s20, 10
  s_add_u32 s26, s26, s25
  s_lshl_b32 s27, s18, 10
  s_add_u32 s27, s27, s25
  s_lshl_b32 s28, s16, 8
  s_add_u32 s27, s27, s28
  s_add_u32 s27, s27, 16384
  s_mov_b32 s50, -1
  s_mov_b32 s51, 0
  v_lshlrev_b32 v63, 4, v4
  v_lshl_add_u32 v63, v3, 3, v63
  v_mov_b32 v44, -1
  v_mov_b32 v45, -1
  v_mov_b32 v46, -1
  v_mov_b32 v47, -1
  s_add_u32 s28, s26, 0
  s_add_u32 s29, s27, 0
  buffer_store_dwordx4 v[44:47], v2, s[8:11], s28 offen sc1
  s_mov_b64 exec, s[50:51]
  buffer_store_dwordx2 v[44:45], v63, s[8:11], s29 offen sc1
  s_mov_b64 exec, -1
  s_add_u32 s28, s26, 20480
  s_add_u32 s29, s27, 20480
  buffer_store_dwordx4 v[44:47], v2, s[8:11], s28 offen sc1
  s_mov_b64 exec, s[50:51]
  buffer_store_dwordx2 v[44:45], v63, s[8:11], s29 offen sc1
  s_mov_b64 exec, -1
  s_add_u32 s22, s21, 0
  buffer_load_dwordx4 a[0:3], v2, s[8:11], s22 offen offset:0 sc1
  buffer_load_dwordx4 a[4:7], v2, s[8:11], s22 offen offset:1024 sc1
  buffer_load_dwordx4 a[8:11], v2, s[8:11], s22 offen offset:2048 sc1
  buffer_load_dwordx4 a[12:15], v2, s[8:11], s22 offen offset:3072 sc1
  s_add_u32 s22, s21, 4096
  buffer_load_dwordx4 a[16:19], v2, s[8:11], s22 offen offset:0 sc1
  buffer_load_dwordx4 a[20:23], v2, s[8:11], s22 offen offset:1024 sc1
  buffer_load_dwordx4 a[24:27], v2, s[8:11], s22 offen offset:2048 sc1
  buffer_load_dwordx4 a[28:31], v2, s[8:11], s22 offen offset:3072 sc1
  s_add_u32 s22, s21, 8192
  buffer_load_dwordx4 a[32:35], v2, s[8:11], s22 offen offset:0 sc1
  buffer_load_dwordx4 a[36:39], v2, s[8:11], s22 offen offset:1024 sc1
  buffer_load_dwordx4 a[40:43], v2, s[8:11], s22 offen offset:2048 sc1
  buffer_load_dwordx4 a[44:47], v2, s[8:11], s22 offen offset:3072 sc1
  s_add_u32 s22, s21, 12288
  buffer_load_dwordx4 a[48:51], v2, s[8:11], s22 offen offset:0 sc1
  buffer_load_dwordx4 a[52:55], v2, s[8:11], s22 offen offset:1024 sc1
  buffer_load_dwordx4 a[56:59], v2, s[8:11], s22 offen offset:2048 sc1
  buffer_load_dwordx4 a[60:63], v2, s[8:11], s22 offen offset:3072 sc1
  s_add_u32 s22, s21, 16384
  buffer_load_dwordx4 a[64:67], v2, s[8:11], s22 offen offset:0 sc1
  buffer_load_dwordx4 a[68:71], v2, s[8:11], s22 offen offset:1024 sc1
  buffer_load_dwordx4 a[72:75], v2, s[8:11], s22 offen offset:2048 sc1
  buffer_load_dwordx4 a[76:79], v2, s[8:11], s22 offen offset:3072 sc1
  s_add_u32 s22, s21, 20480
  buffer_load_dwordx4 a[80:83], v2, s[8:11], s22 offen offset:0 sc1
  buffer_load_dwordx4 a[84:87], v2, s[8:11], s22 offen offset:1024 sc1
  buffer_load_dwordx4 a[88:91], v2, s[8:11], s22 offen offset:2048 sc1
  buffer_load_dwordx4 a[92:95], v2, s[8:11], s22 offen offset:3072 sc1
  s_add_u32 s22, s21, 24576
  buffer_load_dwordx4 a[96:99], v2, s[8:11], s22 offen offset:0 sc1
  buffer_load_dwordx4 a[100:103], v2, s[8:11], s22 offen offset:1024 sc1
  buffer_load_dwordx4 a[104:107], v2, s[8:11], s22 offen offset:2048 sc1
  buffer_load_dwordx4 a[108:111], v2, s[8:11], s22 offen offset:3072 sc1
  s_add_u32 s22, s23, 0
  buffer_load_dwordx4 a[112:115], v2, s[8:11], s22 offen offset:0 sc1
  buffer_load_dwordx4 a[116:119], v2, s[8:11], s22 offen offset:1024 sc1
  buffer_load_dwordx4 a[120:123], v2, s[8:11], s22 offen offset:2048 sc1
  buffer_load_dwordx4 a[124:127], v2, s[8:11], s22 offen offset:3072 sc1
  s_add_u32 s22, s23, 4096
  buffer_load_dwordx4 a[128:131], v2, s[8:11], s22 offen offset:0 sc1
  buffer_load_dwordx4 a[132:135], v2, s[8:11], s22 offen offset:1024 sc1
  buffer_load_dwordx4 a[136:139], v2, s[8:11], s22 offen offset:2048 sc1
  buffer_load_dwordx4 a[140:143], v2, s[8:11], s22 offen offset:3072 sc1
  s_add_u32 s22, s23, 8192
  buffer_load_dwordx4 a[144:147], v2, s[8:11], s22 offen offset:0 sc1
  buffer_load_dwordx4 a[148:151], v2, s[8:11], s22 offen offset:1024 sc1
  buffer_load_dwordx4 a[152:155], v2, s[8:11], s22 offen offset:2048 sc1
  buffer_load_dwordx4 a[156:159], v2, s[8:11], s22 offen offset:3072 sc1
  s_add_u32 s22, s23, 12288
  buffer_load_dwordx4 a[160:163], v2, s[8:11], s22 offen offset:0 sc1
  buffer_load_dwordx4 a[164:167], v2, s[8:11], s22 offen offset:1024 sc1
  buffer_load_dwordx4 a[168:171], v2, s[8:11], s22 offen offset:2048 sc1
  buffer_load_dwordx4 a[172:175], v2, s[8:11], s22 offen offset:3072 sc1
  s_add_u32 s22, s23, 16384
  buffer_load_dwordx4 a[176:179], v2, s[8:11], s22 offen offset:0 sc1
  buffer_load_dwordx4 a[180:183], v2, s[8:11], s22 offen offset:1024 sc1
  buffer_load_dwordx4 a[184:187], v2, s[8:11], s22 offen offset:2048 sc1
  buffer_load_dwordx4 a[188:191], v2, s[8:11], s22 offen offset:3072 sc1
  s_add_u32 s22, s23, 20480
  buffer_load_dwordx4 a[192:195], v2, s[8:11], s22 offen offset:0 sc1
  buffer_load_dwordx4 a[196:199], v2, s[8:11], s22 offen offset:1024 sc1
  buffer_load_dwordx4 a[200:203], v2, s[8:11], s22 offen offset:2048 sc1
  buffer_load_dwordx4 a[204:207], v2, s[8:11], s22 offen offset:3072 sc1
  s_add_u32 s22, s23, 24576
  buffer_load_dwordx4 a[208:211], v2, s[8:11], s22 offen offset:0 sc1
  buffer_load_dwordx4 a[212:215], v2, s[8:11], s22 offen offset:1024 sc1
  buffer_load_dwordx4 a[216:219], v2, s[8:11], s22 offen offset:2048 sc1
  buffer_load_dwordx4 a[220:223], v2, s[8:11], s22 offen offset:3072 sc1
  v_lshl_add_u32 v5, v3, 2, 0
  v_cmp_le_u32 s[40:41], v5, v4
  v_lshl_add_u32 v5, v3, 2, 1
  v_cmp_le_u32 s[42:43], v5, v4
  v_lshl_add_u32 v5, v3, 2, 2
  v_cmp_le_u32 s[44:45], v5, v4
  v_lshl_add_u32 v5, v3, 2, 3
  v_cmp_le_u32 s[46:47], v5, v4
  v_cmp_gt_u32 s[48:49], 2, v3
  v_mov_b32 v6, 0xff800000
  s_waitcnt vmcnt(0)
  s_lshl_b32 s25, s17, 7
  s_add_u32 s25, s25, 557056
  v_mov_b32 v5, 1
  v_mov_b32 v7, 0
  s_waitcnt vmcnt(0)
  s_mov_b64 exec, 1
  buffer_atomic_add v5, v7, s[8:11], s25 offen
  s_mov_b64 exec, -1
  v_mfma_f32_16x16x32_bf16 v[8:11], a[112:115], a[0:3], 0
  v_mfma_f32_16x16x32_bf16 v[12:15], a[112:115], a[56:59], 0
  v_mfma_f32_16x16x32_bf16 v[16:19], a[168:171], a[56:59], 0
  v_mfma_f32_16x16x32_bf16 v[8:11], a[116:119], a[4:7], v[8:11]
  v_mfma_f32_16x16x32_bf16 v[12:15], a[116:119], a[60:63], v[12:15]
  v_mfma_f32_16x16x32_bf16 v[16:19], a[172:175], a[60:63], v[16:19]
  v_mfma_f32_16x16x32_bf16 v[8:11], a[120:123], a[8:11], v[8:11]
  v_mfma_f32_16x16x32_bf16 v[12:15], a[120:123], a[64:67], v[12:15]
  v_mfma_f32_16x16x32_bf16 v[16:19], a[176:179], a[64:67], v[16:19]
  v_mfma_f32_16x16x32_bf16 v[8:11], a[124:127], a[12:15], v[8:11]
  v_mfma_f32_16x16x32_bf16 v[12:15], a[124:127], a[68:71], v[12:15]
  v_mfma_f32_16x16x32_bf16 v[16:19], a[180:183], a[68:71], v[16:19]
  v_mfma_f32_16x16x32_bf16 v[8:11], a[128:131], a[16:19], v[8:11]
  v_mfma_f32_16x16x32_bf16 v[12:15], a[128:131], a[72:75], v[12:15]
  v_mfma_f32_16x16x32_bf16 v[16:19], a[184:187], a[72:75], v[16:19]
  v_mfma_f32_16x16x32_bf16 v[8:11], a[132:135], a[20:23], v[8:11]
  v_mfma_f32_16x16x32_bf16 v[12:15], a[132:135], a[76:79], v[12:15]
  v_mfma_f32_16x16x32_bf16 v[16:19], a[188:191], a[76:79], v[16:19]
  v_mfma_f32_16x16x32_bf16 v[8:11], a[136:139], a[24:27], v[8:11]
  v_mfma_f32_16x16x32_bf16 v[12:15], a[136:139], a[80:83], v[12:15]
  v_mfma_f32_16x16x32_bf16 v[16:19], a[192:195], a[80:83], v[16:19]
  v_mfma_f32_16x16x32_bf16 v[8:11], a[140:143], a[28:31], v[8:11]
  v_mfma_f32_16x16x32_bf16 v[12:15], a[140:143], a[84:87], v[12:15]
  v_mfma_f32_16x16x32_bf16 v[16:19], a[196:199], a[84:87], v[16:19]
  v_mfma_f32_16x16x32_bf16 v[8:11], a[144:147], a[32:35], v[8:11]
  v_mfma_f32_16x16x32_bf16 v[12:15], a[144:147], a[88:91], v[12:15]
  v_mfma_f32_16x16x32_bf16 v[16:19], a[200:203], a[88:91], v[16:19]
  v_mfma_f32_16x16x32_bf16 v[8:11], a[148:151], a[36:39], v[8:11]
  v_mfma_f32_16x16x32_bf16 v[12:15], a[148:151], a[92:95], v[12:15]
  v_mfma_f32_16x16x32_bf16 v[16:19], a[204:207], a[92:95], v[16:19]
  v_mfma_f32_16x16x32_bf16 v[8:11], a[152:155], a[40:43], v[8:11]
  v_mfma_f32_16x16x32_bf16 v[12:15], a[152:155], a[96:99], v[12:15]
  v_mfma_f32_16x16x32_bf16 v[16:19], a[208:211], a[96:99], v[16:19]
  v_mfma_f32_16x16x32_bf16 v[8:11], a[156:159], a[44:47], v[8:11]
  v_mfma_f32_16x16x32_bf16 v[12:15], a[156:159], a[100:103], v[12:15]
  v_mfma_f32_16x16x32_bf16 v[16:19], a[212:215], a[100:103], v[16:19]
  v_mfma_f32_16x16x32_bf16 v[8:11], a[160:163], a[48:51], v[8:11]
  v_mfma_f32_16x16x32_bf16 v[12:15], a[160:163], a[104:107], v[12:15]
  v_mfma_f32_16x16x32_bf16 v[16:19], a[216:219], a[104:107], v[16:19]
  v_mfma_f32_16x16x32_bf16 v[8:11], a[164:167], a[52:55], v[8:11]
  v_mfma_f32_16x16x32_bf16 v[12:15], a[164:167], a[108:111], v[12:15]
  v_mfma_f32_16x16x32_bf16 v[16:19], a[220:223], a[108:111], v[16:19]
  s_mul_i32 s22, s20, 448
  s_add_u32 s22, s22, s24
  s_mov_b32 s31, 0
  s_cmp_ge_u32 s17, 63
  s_cselect_b32 s23, 7168, 0
  s_cselect_b32 s29, 1, 0
  s_sub_u32 s22, s22, s23
  v_mov_b32 v62, s22
  s_mov_b32 s30, 0
wp_pm:
  s_cmp_ge_u32 s17, 64
  s_cbranch_scc1 wp_pf
  buffer_load_dword v61, v62, s[8:11], 0 offen sc1
  s_waitcnt vmcnt(0)
  v_subrev_u32 v61, s31, v61
  v_cmp_eq_u32 vcc, -1, v61
  s_cbranch_vccnz wp_pr
wp_pf:
  s_add_u32 s22, s24, 4096
  buffer_load_dwordx4 v[64:67], v2, s[8:11], s24 offen offset:0 sc1
  buffer_load_dwordx4 v[68:71], v2, s[8:11], s24 offen offset:1024 sc1
  buffer_load_dwordx4 v[72:75], v2, s[8:11], s24 offen offset:2048 sc1
  buffer_load_dwordx4 v[76:79], v2, s[8:11], s24 offen offset:3072 sc1
  buffer_load_dwordx4 v[80:83], v2, s[8:11], s22 offen offset:0 sc1
  buffer_load_dwordx4 v[84:87], v2, s[8:11], s22 offen offset:1024 sc1
  buffer_load_dwordx4 v[88:91], v2, s[8:11], s22 offen offset:2048 sc1
  s_waitcnt vmcnt(0)
  v_max_u32 v61, v64, v65
  v_max3_u32 v61, v61, v66, v67
  v_max3_u32 v61, v61, v68, v69
  v_max3_u32 v61, v61, v70, v71
  v_max3_u32 v61, v61, v72, v73
  v_max3_u32 v61, v61, v74, v75
  v_max3_u32 v61, v61, v76, v77
  v_max3_u32 v61, v61, v78, v79
  v_max3_u32 v61, v61, v80, v81
  v_max3_u32 v61, v61, v82, v83
  v_max3_u32 v61, v61, v84, v85
  v_max3_u32 v61, v61, v86, v87
  v_max3_u32 v61, v61, v88, v89
  v_max3_u32 v61, v61, v90, v91
  v_cmp_eq_u32 vcc, -1, v61
  s_cbranch_vccz wp_pk
  s_add_u32 s30, s30, 1
  s_cmp_eq_u32 s29, 0
  s_cbranch_scc1 wp_pr
  s_cmp_lt_u32 s30, 2000000
  s_cbranch_scc1 wp_pf
wp_pr:
  s_sleep 4
  s_cmp_ge_u32 s17, 50
  s_cbranch_scc1 wp_pm_bo
  s_sleep 64
wp_pm_bo:
  s_add_u32 s30, s30, 1
  s_cmp_lt_u32 s30, 2000000
  s_cbranch_scc1 wp_pm
  s_branch wp_abort
wp_pk:
  buffer_load_dword v250, v251, s[8:11], 0 offen sc1
  v_mfma_f32_16x16x32_bf16 v[20:23], v[64:67], a[0:3], 0
  v_mfma_f32_16x16x32_bf16 v[24:27], v[64:67], a[4:7], 0
  v_mfma_f32_16x16x32_bf16 v[28:31], v[64:67], a[56:59], 0
  v_mfma_f32_16x16x32_bf16 v[32:35], v[64:67], a[60:63], 0
  v_mfma_f32_16x16x32_bf16 v[20:23], v[68:71], a[8:11], v[20:23]
  v_mfma_f32_16x16x32_bf16 v[24:27], v[68:71], a[12:15], v[24:27]
  v_mfma_f32_16x16x32_bf16 v[28:31], v[68:71], a[64:67], v[28:31]
  v_mfma_f32_16x16x32_bf16 v[32:35], v[68:71], a[68:71], v[32:35]
  v_mfma_f32_16x16x32_bf16 v[20:23], v[72:75], a[16:19], v[20:23]
  v_mfma_f32_16x16x32_bf16 v[24:27], v[72:75], a[20:23], v[24:27]
  v_mfma_f32_16x16x32_bf16 v[28:31], v[72:75], a[72:75], v[28:31]
  v_mfma_f32_16x16x32_bf16 v[32:35], v[72:75], a[76:79], v[32:35]
  v_mfma_f32_16x16x32_bf16 v[20:23], v[76:79], a[24:27], v[20:23]
  v_mfma_f32_16x16x32_bf16 v[24:27], v[76:79], a[28:31], v[24:27]
  v_mfma_f32_16x16x32_bf16 v[28:31], v[76:79], a[80:83], v[28:31]
  v_mfma_f32_16x16x32_bf16 v[32:35], v[76:79], a[84:87], v[32:35]
  v_mfma_f32_16x16x32_bf16 v[20:23], v[80:83], a[32:35], v[20:23]
  v_mfma_f32_16x16x32_bf16 v[24:27], v[80:83], a[36:39], v[24:27]
  v_mfma_f32_16x16x32_bf16 v[28:31], v[80:83], a[88:91], v[28:31]
  v_mfma_f32_16x16x32_bf16 v[32:35], v[80:83], a[92:95], v[32:35]
  v_mfma_f32_16x16x32_bf16 v[20:23], v[84:87], a[40:43], v[20:23]
  v_mfma_f32_16x16x32_bf16 v[24:27], v[84:87], a[44:47], v[24:27]
  v_mfma_f32_16x16x32_bf16 v[28:31], v[84:87], a[96:99], v[28:31]
  v_mfma_f32_16x16x32_bf16 v[32:35], v[84:87], a[100:103], v[32:35]
  v_mfma_f32_16x16x32_bf16 v[20:23], v[88:91], a[48:51], v[20:23]
  v_mfma_f32_16x16x32_bf16 v[24:27], v[88:91], a[52:55], v[24:27]
  v_mfma_f32_16x16x32_bf16 v[28:31], v[88:91], a[104:107], v[28:31]
  v_mfma_f32_16x16x32_bf16 v[32:35], v[88:91], a[108:111], v[32:35]
  v_cndmask_b32 v8, v6, v8, s[40:41]
  v_cndmask_b32 v9, v6, v9, s[42:43]
  v_cndmask_b32 v10, v6, v10, s[44:45]
  v_cndmask_b32 v11, v6, v11, s[46:47]
  v_cndmask_b32 v20, v24, v20, s[48:49]
  v_cndmask_b32 v21, v25, v21, s[48:49]
  v_cndmask_b32 v22, v26, v22, s[48:49]
  v_cndmask_b32 v23, v27, v23, s[48:49]
  v_mov_b32 v24, v20
  v_mov_b32 v25, v21
  v_mov_b32 v26, v22
  v_mov_b32 v27, v23
  v_permlane32_swap_b32 v20, v24
  v_permlane32_swap_b32 v21, v25
  v_permlane32_swap_b32 v22, v26
  v_permlane32_swap_b32 v23, v27
  v_add_f32 v20, v20, v24
  v_add_f32 v21, v21, v25
  v_add_f32 v22, v22, v26
  v_add_f32 v23, v23, v27
  v_max3_f32 v40, v8, v9, v10
  v_max3_f32 v40, v40, v11, v20
  v_max3_f32 v40, v40, v21, v22
  v_max_f32 v40, v40, v23
  v_mov_b32 v41, v40
  s_nop 1
  v_permlane16_swap_b32 v40, v41
  v_max_f32 v40, v40, v41
  v_mov_b32 v41, v40
  s_nop 1
  v_permlane32_swap_b32 v40, v41
  v_max_f32 v40, v40, v41
  v_sub_f32 v8, v8, v40
  v_sub_f32 v9, v9, v40
  v_sub_f32 v10, v10, v40
  v_sub_f32 v11, v11, v40
  v_sub_f32 v20, v20, v40
  v_sub_f32 v21, v21, v40
  v_sub_f32 v22, v22, v40
  v_sub_f32 v23, v23, v40
  v_exp_f32 v8, v8
  v_exp_f32 v9, v9
  v_exp_f32 v10, v10
  v_exp_f32 v11, v11
  v_exp_f32 v20, v20
  v_exp_f32 v21, v21
  v_exp_f32 v22, v22
  v_exp_f32 v23, v23
  v_add_f32 v42, v20, v21
  v_add_f32 v43, v22, v23
  v_add_f32 v42, v42, v43
  v_mul_f32 v42, 0.5, v42
  v_add_f32 v42, v42, v8
  v_add_f32 v42, v42, v9
  v_add_f32 v42, v42, v10
  v_add_f32 v42, v42, v11
  v_mov_b32 v41, v42
  s_nop 1
  v_permlane16_swap_b32 v42, v41
  v_add_f32 v42, v42, v41
  v_mov_b32 v41, v42
  s_nop 1
  v_permlane32_swap_b32 v42, v41
  v_add_f32 v42, v42, v41
  v_rcp_f32 v42, v42
  s_nop 0
  v_mul_f32 v8, v8, v42
  v_mul_f32 v9, v9, v42
  v_mul_f32 v10, v10, v42
  v_mul_f32 v11, v11, v42
  v_mul_f32 v20, v20, v42
  v_mul_f32 v21, v21, v42
  v_mul_f32 v22, v22, v42
  v_mul_f32 v23, v23, v42
  v_cvt_pk_bf16_f32 v44, v8, 0
  v_cvt_pk_bf16_f32 v45, v9, 0
  v_cvt_pk_bf16_f32 v46, v10, 0
  v_cvt_pk_bf16_f32 v47, v11, 0
  v_cvt_pk_bf16_f32 v48, v20, v21
  v_cvt_pk_bf16_f32 v49, v22, v23
  v_min_u32 v44, -2, v44
  v_min_u32 v45, -2, v45
  v_min_u32 v46, -2, v46
  v_min_u32 v47, -2, v47
  v_min_u32 v48, -2, v48
  v_min_u32 v49, -2, v49
  buffer_store_dwordx4 v[44:47], v2, s[8:11], s26 offen sc1
  s_mov_b64 exec, s[50:51]
  buffer_store_dwordx2 v[48:49], v63, s[8:11], s27 offen sc1
  s_mov_b64 exec, -1
  s_add_u32 s26, s26, 20480
  s_add_u32 s27, s27, 20480
  v_cndmask_b32 v16, v6, v16, s[40:41]
  v_cndmask_b32 v17, v6, v17, s[42:43]
  v_cndmask_b32 v18, v6, v18, s[44:45]
  v_cndmask_b32 v19, v6, v19, s[46:47]
  v_cndmask_b32 v28, v32, v28, s[48:49]
  v_cndmask_b32 v29, v33, v29, s[48:49]
  v_cndmask_b32 v30, v34, v30, s[48:49]
  v_cndmask_b32 v31, v35, v31, s[48:49]
  v_mov_b32 v32, v28
  v_mov_b32 v33, v29
  v_mov_b32 v34, v30
  v_mov_b32 v35, v31
  v_permlane32_swap_b32 v28, v32
  v_permlane32_swap_b32 v29, v33
  v_permlane32_swap_b32 v30, v34
  v_permlane32_swap_b32 v31, v35
  v_add_f32 v28, v28, v32
  v_add_f32 v29, v29, v33
  v_add_f32 v30, v30, v34
  v_add_f32 v31, v31, v35
  v_max3_f32 v40, v12, v13, v14
  v_max3_f32 v40, v40, v15, v16
  v_max3_f32 v40, v40, v17, v18
  v_max3_f32 v40, v40, v19, v28
  v_max3_f32 v40, v40, v29, v30
  v_max_f32 v40, v40, v31
  v_mov_b32 v41, v40
  s_nop 1
  v_permlane16_swap_b32 v40, v41
  v_max_f32 v40, v40, v41
  v_mov_b32 v41, v40
  s_nop 1
  v_permlane32_swap_b32 v40, v41
  v_max_f32 v40, v40, v41
  v_sub_f32 v12, v12, v40
  v_sub_f32 v13, v13, v40
  v_sub_f32 v14, v14, v40
  v_sub_f32 v15, v15, v40
  v_sub_f32 v16, v16, v40
  v_sub_f32 v17, v17, v40
  v_sub_f32 v18, v18, v40
  v_sub_f32 v19, v19, v40
  v_sub_f32 v28, v28, v40
  v_sub_f32 v29, v29, v40
  v_sub_f32 v30, v30, v40
  v_sub_f32 v31, v31, v40
  v_exp_f32 v12, v12
  v_exp_f32 v13, v13
  v_exp_f32 v14, v14
  v_exp_f32 v15, v15
  v_exp_f32 v16, v16
  v_exp_f32 v17, v17
  v_exp_f32 v18, v18
  v_exp_f32 v19, v19
  v_exp_f32 v28, v28
  v_exp_f32 v29, v29
  v_exp_f32 v30, v30
  v_exp_f32 v31, v31
  v_add_f32 v42, v28, v29
  v_add_f32 v43, v30, v31
  v_add_f32 v42, v42, v43
  v_mul_f32 v42, 0.5, v42
  v_add_f32 v42, v42, v12
  v_add_f32 v42, v42, v13
  v_add_f32 v42, v42, v14
  v_add_f32 v42, v42, v15
  v_add_f32 v42, v42, v16
  v_add_f32 v42, v42, v17
  v_add_f32 v42, v42, v18
  v_add_f32 v42, v42, v19
  v_mov_b32 v41, v42
  s_nop 1
  v_permlane16_swap_b32 v42, v41
  v_add_f32 v42, v42, v41
  v_mov_b32 v41, v42
  s_nop 1
  v_permlane32_swap_b32 v42, v41
  v_add_f32 v42, v42, v41
  v_rcp_f32 v42, v42
  s_nop 0
  v_mul_f32 v12, v12, v42
  v_mul_f32 v13, v13, v42
  v_mul_f32 v14, v14, v42
  v_mul_f32 v15, v15, v42
  v_mul_f32 v16, v16, v42
  v_mul_f32 v17, v17, v42
  v_mul_f32 v18, v18, v42
  v_mul_f32 v19, v19, v42
  v_mul_f32 v28, v28, v42
  v_mul_f32 v29, v29, v42
  v_mul_f32 v30, v30, v42
  v_mul_f32 v31, v31, v42
  v_cvt_pk_bf16_f32 v52, v12, v16
  v_cvt_pk_bf16_f32 v53, v13, v17
  v_cvt_pk_bf16_f32 v54, v14, v18
  v_cvt_pk_bf16_f32 v55, v15, v19
  v_cvt_pk_bf16_f32 v56, v28, v29
  v_cvt_pk_bf16_f32 v57, v30, v31
  v_min_u32 v52, -2, v52
  v_min_u32 v53, -2, v53
  v_min_u32 v54, -2, v54
  v_min_u32 v55, -2, v55
  v_min_u32 v56, -2, v56
  v_min_u32 v57, -2, v57
  buffer_store_dwordx4 v[52:55], v2, s[8:11], s26 offen sc1
  s_mov_b64 exec, s[50:51]
  buffer_store_dwordx2 v[56:57], v63, s[8:11], s27 offen sc1
  s_mov_b64 exec, -1
  s_branch wk_loop
wk_toko:
  s_load_dwordx2 s[36:37], s[0:1], 112
  s_waitcnt lgkmcnt(0)
  s_mov_b32 s92, s36
  s_and_b32 s93, s37, 0xffff
  s_mov_b32 s94, 3670016
  s_mov_b32 s95, 0x20000
  s_lshl_b32 s20, s18, 2
  s_add_u32 s20, s20, s16
  s_mul_i32 s24, s20, 65
  s_add_u32 s24, s24, s17
  s_lshl_b32 s24, s24, 13
  s_add_u32 s24, s24, 77602816
  s_mul_i32 s21, s20, 28672
  s_mul_i32 s22, s17, 458752
  s_add_u32 s21, s21, s22
  s_add_u32 s21, s21, 2490368
  s_lshl_b32 s25, s17, 1
  s_mul_i32 s25, s25, 20480
  s_add_u32 s25, s25, 86114304
  v_mov_b32 v5, v2
  v_min_u32 v6, 11, v4
  v_mad_u32_u24 v6, v3, 12, v6
  v_lshlrev_b32 v6, 4, v6
  v_add_u32 v6, 1024, v6
  v_lshrrev_b32 v8, 1, v3
  v_lshl_add_u32 v8, v8, 4, v4
  v_lshlrev_b32 v8, 4, v8
  v_and_b32 v9, 1, v3
  v_lshl_add_u32 v7, v9, 3, v8
  s_lshr_b32 s26, s17, 3
  s_lshl_b32 s26, s26, 4
  s_add_u32 s26, s26, s20
  s_lshl_b32 s26, s26, 7
  s_add_u32 s26, s26, 524288
  v_mov_b32 v60, 0
  s_mov_b32 s30, 0
wo_wv:
  buffer_load_dword v61, v60, s[8:11], s26 offen sc1
  s_waitcnt vmcnt(0)
  v_cmp_ne_u32 vcc, 56, v61
  s_cbranch_vccz wo_wv_ok
  s_sleep 4
  s_cmp_ge_u32 s17, 50
  s_cbranch_scc1 wo_wv_bo
  s_sleep 64
wo_wv_bo:
  s_add_u32 s30, s30, 1
  s_cmp_lt_u32 s30, 2000000
  s_cbranch_scc1 wo_wv
  s_branch wo_abort
wo_wv_ok:
  s_add_u32 s22, s21, 0
  buffer_load_dwordx4 a[0:3], v5, s[8:11], s22 offen offset:0 sc1
  buffer_load_dwordx4 a[4:7], v6, s[8:11], s22 offen offset:0 sc1
  buffer_load_dwordx4 a[8:11], v5, s[8:11], s22 offen offset:1792 sc1
  buffer_load_dwordx4 a[12:15], v6, s[8:11], s22 offen offset:1792 sc1
  s_add_u32 s22, s21, 3584
  buffer_load_dwordx4 a[16:19], v5, s[8:11], s22 offen offset:0 sc1
  buffer_load_dwordx4 a[20:23], v6, s[8:11], s22 offen offset:0 sc1
  buffer_load_dwordx4 a[24:27], v5, s[8:11], s22 offen offset:1792 sc1
  buffer_load_dwordx4 a[28:31], v6, s[8:11], s22 offen offset:1792 sc1
  s_add_u32 s22, s21, 7168
  buffer_load_dwordx4 a[32:35], v5, s[8:11], s22 offen offset:0 sc1
  buffer_load_dwordx4 a[36:39], v6, s[8:11], s22 offen offset:0 sc1
  buffer_load_dwordx4 a[40:43], v5, s[8:11], s22 offen offset:1792 sc1
  buffer_load_dwordx4 a[44:47], v6, s[8:11], s22 offen offset:1792 sc1
  s_add_u32 s22, s21, 10752
  buffer_load_dwordx4 a[48:51], v5, s[8:11], s22 offen offset:0 sc1
  buffer_load_dwordx4 a[52:55], v6, s[8:11], s22 offen offset:0 sc1
  buffer_load_dwordx4 a[56:59], v5, s[8:11], s22 offen offset:1792 sc1
  buffer_load_dwordx4 a[60:63], v6, s[8:11], s22 offen offset:1792 sc1
  s_add_u32 s22, s21, 14336
  buffer_load_dwordx4 a[64:67], v5, s[8:11], s22 offen offset:0 sc1
  buffer_load_dwordx4 a[68:71], v6, s[8:11], s22 offen offset:0 sc1
  buffer_load_dwordx4 a[72:75], v5, s[8:11], s22 offen offset:1792 sc1
  buffer_load_dwordx4 a[76:79], v6, s[8:11], s22 offen offset:1792 sc1
  s_add_u32 s22, s21, 17920
  buffer_load_dwordx4 a[80:83], v5, s[8:11], s22 offen offset:0 sc1
  buffer_load_dwordx4 a[84:87], v6, s[8:11], s22 offen offset:0 sc1
  buffer_load_dwordx4 a[88:91], v5, s[8:11], s22 offen offset:1792 sc1
  buffer_load_dwordx4 a[92:95], v6, s[8:11], s22 offen offset:1792 sc1
  s_add_u32 s22, s21, 21504
  buffer_load_dwordx4 a[96:99], v5, s[8:11], s22 offen offset:0 sc1
  buffer_load_dwordx4 a[100:103], v6, s[8:11], s22 offen offset:0 sc1
  buffer_load_dwordx4 a[104:107], v5, s[8:11], s22 offen offset:1792 sc1
  buffer_load_dwordx4 a[108:111], v6, s[8:11], s22 offen offset:1792 sc1
  s_add_u32 s22, s21, 25088
  buffer_load_dwordx4 a[112:115], v5, s[8:11], s22 offen offset:0 sc1
  buffer_load_dwordx4 a[116:119], v6, s[8:11], s22 offen offset:0 sc1
  buffer_load_dwordx4 a[120:123], v5, s[8:11], s22 offen offset:1792 sc1
  buffer_load_dwordx4 a[124:127], v6, s[8:11], s22 offen offset:1792 sc1
  s_and_b32 s27, s17, 1
  s_cmp_ge_u32 s17, 62
  s_cselect_b32 s27, s17, s27
  s_lshl_b32 s26, s20, 6
  s_add_u32 s26, s26, s27
  s_lshl_b32 s26, s26, 4
  s_add_u32 s26, s26, 565248
  v_lshlrev_b32 v60, 2, v3
  s_mov_b32 s30, 0
wo_wt:
  buffer_load_dword v61, v60, s[8:11], s26 offen sc1
  s_waitcnt vmcnt(0)
  v_cmp_ne_u32 vcc, 1, v61
  s_cbranch_vccz wo_wt_ok
  s_sleep 4
  s_cmp_ge_u32 s17, 50
  s_cbranch_scc1 wo_wt_bo
  s_sleep 64
wo_wt_bo:
  s_add_u32 s30, s30, 1
  s_cmp_lt_u32 s30, 2000000
  s_cbranch_scc1 wo_wt
  s_branch wo_abort
wo_wt_ok:
  v_mul_u32_u24 v9, 1792, v4
  v_lshl_add_u32 v9, v3, 3, v9
  s_lshl_b32 s22, s20, 5
  v_add_u32 v8, s22, v9
  s_mul_i32 s22, s20, 24
  s_add_u32 s22, s22, 512
  v_add_u32 v9, s22, v9
  v_mov_b32 v10, 0x40000000
  v_cmp_eq_u32 vcc, 3, v3
  s_nop 1
  v_cndmask_b32 v9, v9, v10, vcc
  s_mul_i32 s44, s17, 57344
  s_add_u32 s44, s44, 896
  s_add_u32 s45, s44, 28672
  s_lshl_b32 s26, s17, 7
  s_add_u32 s26, s26, 557056
  v_mov_b32 v60, 0
  s_mov_b32 s30, 0
wo_wp:
  buffer_load_dword v61, v60, s[8:11], s26 offen sc1
  s_waitcnt vmcnt(0)
  v_cmp_ne_u32 vcc, 16, v61
  s_cbranch_vccz wo_wp_ok
  s_sleep 4
  s_cmp_ge_u32 s17, 50
  s_cbranch_scc1 wo_wp_bo
  s_sleep 64
wo_wp_bo:
  s_add_u32 s30, s30, 1
  s_cmp_lt_u32 s30, 2000000
  s_cbranch_scc1 wo_wp
  s_branch wo_abort
wo_wp_ok:
  s_lshl_b32 s31, s16, 2
  s_add_u32 s31, s31, s26
  s_lshl_b32 s28, s16, 12
  s_add_u32 s26, s25, s28
  s_add_u32 s27, s26, 20480
  s_lshl_b32 s28, s16, 10
  s_add_u32 s28, s28, s25
  s_add_u32 s28, s28, 16384
  s_add_u32 s29, s28, 20480
  s_add_u32 s23, s24, 4096
  s_mov_b32 s30, 0
  s_sub_u32 s33, s24, 0
  s_cmp_ge_u32 s17, 63
  s_cselect_b32 s31, s33, s26
  s_cselect_b32 s33, s33, s24
wo_ps:
  buffer_load_dword v61, off, s[8:11], s33 sc1
  buffer_load_dword v62, off, s[8:11], s31 sc1
  s_waitcnt vmcnt(0)
  v_max_u32 v61, v61, v62
  v_cmp_eq_u32 vcc, -1, v61
  s_cbranch_vccz wo_pl
  s_sleep 2
  s_cmp_ge_u32 s17, 50
  s_cbranch_scc1 wo_ps_bo
  s_sleep 64
wo_ps_bo:
  s_add_u32 s30, s30, 1
  s_cmp_lt_u32 s30, 2000000
  s_cbranch_scc1 wo_ps
  s_branch wo_abort
wo_pl:
  buffer_load_dword v250, v251, s[8:11], 0 offen sc1
  buffer_load_dwordx4 v[28:31], v2, s[8:11], s24 offen offset:0 sc1
  buffer_load_dwordx4 v[32:35], v2, s[8:11], s24 offen offset:1024 sc1
  buffer_load_dwordx4 v[36:39], v2, s[8:11], s24 offen offset:2048 sc1
  buffer_load_dwordx4 v[40:43], v2, s[8:11], s24 offen offset:3072 sc1
  buffer_load_dwordx4 v[44:47], v2, s[8:11], s23 offen offset:0 sc1
  buffer_load_dwordx4 v[48:51], v2, s[8:11], s23 offen offset:1024 sc1
  buffer_load_dwordx4 v[52:55], v2, s[8:11], s23 offen offset:2048 sc1
  buffer_load_dwordx4 v[56:59], v2, s[8:11], s23 offen offset:3072 sc1
  buffer_load_dwordx4 v[64:67], v2, s[8:11], s26 offen offset:0 sc1
  buffer_load_dwordx4 v[68:71], v2, s[8:11], s26 offen offset:1024 sc1
  buffer_load_dwordx4 v[72:75], v2, s[8:11], s26 offen offset:2048 sc1
  buffer_load_dwordx4 v[76:79], v2, s[8:11], s26 offen offset:3072 sc1
  buffer_load_dwordx4 v[80:83], v2, s[8:11], s28 offen sc1
  buffer_load_dwordx4 v[84:87], v2, s[8:11], s27 offen offset:0 sc1
  buffer_load_dwordx4 v[88:91], v2, s[8:11], s27 offen offset:1024 sc1
  buffer_load_dwordx4 v[92:95], v2, s[8:11], s27 offen offset:2048 sc1
  buffer_load_dwordx4 v[96:99], v2, s[8:11], s27 offen offset:3072 sc1
  buffer_load_dwordx4 v[100:103], v2, s[8:11], s29 offen sc1
  s_waitcnt vmcnt(10)
  v_max_u32 v61, v28, v29
  v_max3_u32 v61, v61, v30, v31
  v_max3_u32 v61, v61, v32, v33
  v_max3_u32 v61, v61, v34, v35
  v_max3_u32 v61, v61, v36, v37
  v_max3_u32 v61, v61, v38, v39
  v_max3_u32 v61, v61, v40, v41
  v_max3_u32 v61, v61, v42, v43
  v_max3_u32 v61, v61, v44, v45
  v_max3_u32 v61, v61, v46, v47
  v_max3_u32 v61, v61, v48, v49
  v_max3_u32 v61, v61, v50, v51
  v_max3_u32 v61, v61, v52, v53
  v_max3_u32 v61, v61, v54, v55
  v_max3_u32 v61, v61, v56, v57
  v_max3_u32 v61, v61, v58, v59
  v_cmp_eq_u32 vcc, -1, v61
  s_cbranch_vccz wo_p2
  s_add_u32 s30, s30, 1
  s_cmp_lt_u32 s30, 2000000
  s_cbranch_scc1 wo_pl
  s_branch wo_abort
wo_p1:
  buffer_load_dwordx4 v[64:67], v2, s[8:11], s26 offen offset:0 sc1
  buffer_load_dwordx4 v[68:71], v2, s[8:11], s26 offen offset:1024 sc1
  buffer_load_dwordx4 v[72:75], v2, s[8:11], s26 offen offset:2048 sc1
  buffer_load_dwordx4 v[76:79], v2, s[8:11], s26 offen offset:3072 sc1
  buffer_load_dwordx4 v[80:83], v2, s[8:11], s28 offen sc1
  buffer_load_dwordx4 v[84:87], v2, s[8:11], s27 offen offset:0 sc1
  buffer_load_dwordx4 v[88:91], v2, s[8:11], s27 offen offset:1024 sc1
  buffer_load_dwordx4 v[92:95], v2, s[8:11], s27 offen offset:2048 sc1
  buffer_load_dwordx4 v[96:99], v2, s[8:11], s27 offen offset:3072 sc1
  buffer_load_dwordx4 v[100:103], v2, s[8:11], s29 offen sc1
wo_p2:
  s_waitcnt vmcnt(0)
  v_max_u32 v61, v64, v65
  v_max3_u32 v61, v61, v66, v67
  v_max3_u32 v61, v61, v68, v69
  v_max3_u32 v61, v61, v70, v71
  v_max3_u32 v61, v61, v72, v73
  v_max3_u32 v61, v61, v74, v75
  v_max3_u32 v61, v61, v76, v77
  v_max3_u32 v61, v61, v78, v79
  v_max3_u32 v61, v61, v80, v81
  v_max3_u32 v61, v61, v82, v83
  v_max3_u32 v61, v61, v84, v85
  v_max3_u32 v61, v61, v86, v87
  v_max3_u32 v61, v61, v88, v89
  v_max3_u32 v61, v61, v90, v91
  v_max3_u32 v61, v61, v92, v93
  v_max3_u32 v61, v61, v94, v95
  v_max3_u32 v61, v61, v96, v97
  v_max3_u32 v61, v61, v98, v99
  v_max3_u32 v61, v61, v100, v101
  v_max3_u32 v61, v61, v102, v103
  v_cmp_eq_u32 vcc, -1, v61
  s_cbranch_vccz wo_p3
  s_add_u32 s30, s30, 1
  s_cmp_lt_u32 s30, 2000000
  s_cbranch_scc1 wo_p1
  s_branch wo_abort
wo_p3:
  s_mul_i32 s22, s16, 10240
  v_add_u32 v62, s22, v2
  ds_write_b128 v62, v[64:67] offset:0
  ds_write_b128 v62, v[68:71] offset:1024
  ds_write_b128 v62, v[72:75] offset:2048
  ds_write_b128 v62, v[76:79] offset:3072
  ds_write_b128 v62, v[80:83] offset:4096
  ds_write_b128 v62, v[84:87] offset:5120
  ds_write_b128 v62, v[88:91] offset:6144
  ds_write_b128 v62, v[92:95] offset:7168
  ds_write_b128 v62, v[96:99] offset:8192
  ds_write_b128 v62, v[100:103] offset:9216
wo_pk:
  s_lshl_b32 s22, s16, 2
  s_add_u32 s22, s22, 49152
  v_mov_b32 v63, s22
  ds_write_b32 v63, v250
  s_waitcnt lgkmcnt(0)
  s_barrier
  v_mov_b32 v63, 49152
  ds_read_b32 v250, v63
  ds_read_b128 v[64:67], v2 offset:0
  ds_read_b128 v[68:71], v2 offset:5120
  ds_read_b128 v[72:75], v2 offset:1024
  ds_read_b128 v[76:79], v2 offset:6144
  ds_read_b128 v[80:83], v2 offset:2048
  ds_read_b128 v[84:87], v2 offset:7168
  ds_read_b128 v[88:91], v2 offset:3072
  ds_read_b128 v[92:95], v2 offset:8192
  s_waitcnt lgkmcnt(7)
  v_mfma_f32_16x16x32_bf16 v[12:15], a[0:3], v[64:67], 0
  ds_read_b128 v[96:99], v2 offset:4096
  v_mfma_f32_16x16x32_bf16 v[20:23], a[4:7], v[64:67], 0
  s_waitcnt lgkmcnt(7)
  v_mfma_f32_16x16x32_bf16 v[16:19], a[0:3], v[68:71], 0
  ds_read_b128 v[100:103], v2 offset:9216
  v_mfma_f32_16x16x32_bf16 v[24:27], a[4:7], v[68:71], 0
  s_waitcnt lgkmcnt(7)
  v_mfma_f32_16x16x32_bf16 v[12:15], a[8:11], v[72:75], v[12:15]
  ds_read_b128 v[64:67], v2 offset:10240
  v_mfma_f32_16x16x32_bf16 v[20:23], a[12:15], v[72:75], v[20:23]
  s_waitcnt lgkmcnt(7)
  v_mfma_f32_16x16x32_bf16 v[16:19], a[8:11], v[76:79], v[16:19]
  ds_read_b128 v[68:71], v2 offset:15360
  v_mfma_f32_16x16x32_bf16 v[24:27], a[12:15], v[76:79], v[24:27]
  s_waitcnt lgkmcnt(7)
  v_mfma_f32_16x16x32_bf16 v[12:15], a[16:19], v[80:83], v[12:15]
  ds_read_b128 v[72:75], v2 offset:11264
  v_mfma_f32_16x16x32_bf16 v[20:23], a[20:23], v[80:83], v[20:23]
  s_waitcnt lgkmcnt(7)
  v_mfma_f32_16x16x32_bf16 v[16:19], a[16:19], v[84:87], v[16:19]
  ds_read_b128 v[76:79], v2 offset:16384
  v_mfma_f32_16x16x32_bf16 v[24:27], a[20:23], v[84:87], v[24:27]
  s_waitcnt lgkmcnt(7)
  v_mfma_f32_16x16x32_bf16 v[12:15], a[24:27], v[88:91], v[12:15]
  ds_read_b128 v[80:83], v2 offset:12288
  v_mfma_f32_16x16x32_bf16 v[20:23], a[28:31], v[88:91], v[20:23]
  s_waitcnt lgkmcnt(7)
  v_mfma_f32_16x16x32_bf16 v[16:19], a[24:27], v[92:95], v[16:19]
  ds_read_b128 v[84:87], v2 offset:17408
  v_mfma_f32_16x16x32_bf16 v[24:27], a[28:31], v[92:95], v[24:27]
  s_waitcnt lgkmcnt(7)
  v_mfma_f32_16x16x32_bf16 v[12:15], v[28:31], v[96:99], v[12:15]
  ds_read_b128 v[88:91], v2 offset:13312
  v_mfma_f32_16x16x32_bf16 v[20:23], v[32:35], v[96:99], v[20:23]
  s_waitcnt lgkmcnt(7)
  v_mfma_f32_16x16x32_bf16 v[16:19], v[28:31], v[100:103], v[16:19]
  ds_read_b128 v[92:95], v2 offset:18432
  v_mfma_f32_16x16x32_bf16 v[24:27], v[32:35], v[100:103], v[24:27]
  s_waitcnt lgkmcnt(7)
  v_mfma_f32_16x16x32_bf16 v[12:15], a[32:35], v[64:67], v[12:15]
  ds_read_b128 v[96:99], v2 offset:14336
  v_mfma_f32_16x16x32_bf16 v[20:23], a[36:39], v[64:67], v[20:23]
  s_waitcnt lgkmcnt(7)
  v_mfma_f32_16x16x32_bf16 v[16:19], a[32:35], v[68:71], v[16:19]
  ds_read_b128 v[100:103], v2 offset:19456
  v_mfma_f32_16x16x32_bf16 v[24:27], a[36:39], v[68:71], v[24:27]
  s_waitcnt lgkmcnt(7)
  v_mfma_f32_16x16x32_bf16 v[12:15], a[40:43], v[72:75], v[12:15]
  ds_read_b128 v[64:67], v2 offset:20480
  v_mfma_f32_16x16x32_bf16 v[20:23], a[44:47], v[72:75], v[20:23]
  s_waitcnt lgkmcnt(7)
  v_mfma_f32_16x16x32_bf16 v[16:19], a[40:43], v[76:79], v[16:19]
  ds_read_b128 v[68:71], v2 offset:25600
  v_mfma_f32_16x16x32_bf16 v[24:27], a[44:47], v[76:79], v[24:27]
  s_waitcnt lgkmcnt(7)
  v_mfma_f32_16x16x32_bf16 v[12:15], a[48:51], v[80:83], v[12:15]
  ds_read_b128 v[72:75], v2 offset:21504
  v_mfma_f32_16x16x32_bf16 v[20:23], a[52:55], v[80:83], v[20:23]
  s_waitcnt lgkmcnt(7)
  v_mfma_f32_16x16x32_bf16 v[16:19], a[48:51], v[84:87], v[16:19]
  ds_read_b128 v[76:79], v2 offset:26624
  v_mfma_f32_16x16x32_bf16 v[24:27], a[52:55], v[84:87], v[24:27]
  s_waitcnt lgkmcnt(7)
  v_mfma_f32_16x16x32_bf16 v[12:15], a[56:59], v[88:91], v[12:15]
  ds_read_b128 v[80:83], v2 offset:22528
  v_mfma_f32_16x16x32_bf16 v[20:23], a[60:63], v[88:91], v[20:23]
  s_waitcnt lgkmcnt(7)
  v_mfma_f32_16x16x32_bf16 v[16:19], a[56:59], v[92:95], v[16:19]
  ds_read_b128 v[84:87], v2 offset:27648
  v_mfma_f32_16x16x32_bf16 v[24:27], a[60:63], v[92:95], v[24:27]
  s_waitcnt lgkmcnt(7)
  v_mfma_f32_16x16x32_bf16 v[12:15], v[36:39], v[96:99], v[12:15]
  ds_read_b128 v[88:91], v2 offset:23552
  v_mfma_f32_16x16x32_bf16 v[20:23], v[40:43], v[96:99], v[20:23]
  s_waitcnt lgkmcnt(7)
  v_mfma_f32_16x16x32_bf16 v[16:19], v[36:39], v[100:103], v[16:19]
  ds_read_b128 v[92:95], v2 offset:28672
  v_mfma_f32_16x16x32_bf16 v[24:27], v[40:43], v[100:103], v[24:27]
  s_waitcnt lgkmcnt(7)
  v_mfma_f32_16x16x32_bf16 v[12:15], a[64:67], v[64:67], v[12:15]
  ds_read_b128 v[96:99], v2 offset:24576
  v_mfma_f32_16x16x32_bf16 v[20:23], a[68:71], v[64:67], v[20:23]
  s_waitcnt lgkmcnt(7)
  v_mfma_f32_16x16x32_bf16 v[16:19], a[64:67], v[68:71], v[16:19]
  ds_read_b128 v[100:103], v2 offset:29696
  v_mfma_f32_16x16x32_bf16 v[24:27], a[68:71], v[68:71], v[24:27]
  s_waitcnt lgkmcnt(7)
  v_mfma_f32_16x16x32_bf16 v[12:15], a[72:75], v[72:75], v[12:15]
  ds_read_b128 v[64:67], v2 offset:30720
  v_mfma_f32_16x16x32_bf16 v[20:23], a[76:79], v[72:75], v[20:23]
  s_waitcnt lgkmcnt(7)
  v_mfma_f32_16x16x32_bf16 v[16:19], a[72:75], v[76:79], v[16:19]
  ds_read_b128 v[68:71], v2 offset:35840
  v_mfma_f32_16x16x32_bf16 v[24:27], a[76:79], v[76:79], v[24:27]
  s_waitcnt lgkmcnt(7)
  v_mfma_f32_16x16x32_bf16 v[12:15], a[80:83], v[80:83], v[12:15]
  ds_read_b128 v[72:75], v2 offset:31744
  v_mfma_f32_16x16x32_bf16 v[20:23], a[84:87], v[80:83], v[20:23]
  s_waitcnt lgkmcnt(7)
  v_mfma_f32_16x16x32_bf16 v[16:19], a[80:83], v[84:87], v[16:19]
  ds_read_b128 v[76:79], v2 offset:36864
  v_mfma_f32_16x16x32_bf16 v[24:27], a[84:87], v[84:87], v[24:27]
  s_waitcnt lgkmcnt(7)
  v_mfma_f32_16x16x32_bf16 v[12:15], a[88:91], v[88:91], v[12:15]
  ds_read_b128 v[80:83], v2 offset:32768
  v_mfma_f32_16x16x32_bf16 v[20:23], a[92:95], v[88:91], v[20:23]
  s_waitcnt lgkmcnt(7)
  v_mfma_f32_16x16x32_bf16 v[16:19], a[88:91], v[92:95], v[16:19]
  ds_read_b128 v[84:87], v2 offset:37888
  v_mfma_f32_16x16x32_bf16 v[24:27], a[92:95], v[92:95], v[24:27]
  s_waitcnt lgkmcnt(7)
  v_mfma_f32_16x16x32_bf16 v[12:15], v[44:47], v[96:99], v[12:15]
  ds_read_b128 v[88:91], v2 offset:33792
  v_mfma_f32_16x16x32_bf16 v[20:23], v[48:51], v[96:99], v[20:23]
  s_waitcnt lgkmcnt(7)
  v_mfma_f32_16x16x32_bf16 v[16:19], v[44:47], v[100:103], v[16:19]
  ds_read_b128 v[92:95], v2 offset:38912
  v_mfma_f32_16x16x32_bf16 v[24:27], v[48:51], v[100:103], v[24:27]
  s_waitcnt lgkmcnt(7)
  v_mfma_f32_16x16x32_bf16 v[12:15], a[96:99], v[64:67], v[12:15]
  ds_read_b128 v[96:99], v2 offset:34816
  v_mfma_f32_16x16x32_bf16 v[20:23], a[100:103], v[64:67], v[20:23]
  s_waitcnt lgkmcnt(7)
  v_mfma_f32_16x16x32_bf16 v[16:19], a[96:99], v[68:71], v[16:19]
  ds_read_b128 v[100:103], v2 offset:39936
  v_mfma_f32_16x16x32_bf16 v[24:27], a[100:103], v[68:71], v[24:27]
  s_waitcnt lgkmcnt(7)
  v_mfma_f32_16x16x32_bf16 v[12:15], a[104:107], v[72:75], v[12:15]
  v_mfma_f32_16x16x32_bf16 v[20:23], a[108:111], v[72:75], v[20:23]
  s_waitcnt lgkmcnt(6)
  v_mfma_f32_16x16x32_bf16 v[16:19], a[104:107], v[76:79], v[16:19]
  v_mfma_f32_16x16x32_bf16 v[24:27], a[108:111], v[76:79], v[24:27]
  s_waitcnt lgkmcnt(5)
  v_mfma_f32_16x16x32_bf16 v[12:15], a[112:115], v[80:83], v[12:15]
  v_mfma_f32_16x16x32_bf16 v[20:23], a[116:119], v[80:83], v[20:23]
  s_waitcnt lgkmcnt(4)
  v_mfma_f32_16x16x32_bf16 v[16:19], a[112:115], v[84:87], v[16:19]
  v_mfma_f32_16x16x32_bf16 v[24:27], a[116:119], v[84:87], v[24:27]
  s_waitcnt lgkmcnt(3)
  v_mfma_f32_16x16x32_bf16 v[12:15], a[120:123], v[88:91], v[12:15]
  v_mfma_f32_16x16x32_bf16 v[20:23], a[124:127], v[88:91], v[20:23]
  s_waitcnt lgkmcnt(2)
  v_mfma_f32_16x16x32_bf16 v[16:19], a[120:123], v[92:95], v[16:19]
  v_mfma_f32_16x16x32_bf16 v[24:27], a[124:127], v[92:95], v[24:27]
  s_waitcnt lgkmcnt(1)
  v_mfma_f32_16x16x32_bf16 v[12:15], v[52:55], v[96:99], v[12:15]
  v_mfma_f32_16x16x32_bf16 v[20:23], v[56:59], v[96:99], v[20:23]
  s_waitcnt lgkmcnt(0)
  v_mfma_f32_16x16x32_bf16 v[16:19], v[52:55], v[100:103], v[16:19]
  v_mfma_f32_16x16x32_bf16 v[24:27], v[56:59], v[100:103], v[24:27]
  v_cvt_pk_bf16_f32 v108, v12, v13
  v_cvt_pk_bf16_f32 v109, v14, v15
  buffer_store_dwordx2 v[108:109], v8, s[92:95], s44 offen
  v_cvt_pk_bf16_f32 v110, v20, v21
  v_cvt_pk_bf16_f32 v111, v22, v23
  buffer_store_dwordx2 v[110:111], v9, s[92:95], s44 offen
  v_cvt_pk_bf16_f32 v112, v16, v17
  v_cvt_pk_bf16_f32 v113, v18, v19
  buffer_store_dwordx2 v[112:113], v8, s[92:95], s45 offen
  v_cvt_pk_bf16_f32 v114, v24, v25
  v_cvt_pk_bf16_f32 v115, v26, v27
  buffer_store_dwordx2 v[114:115], v9, s[92:95], s45 offen
  v_readfirstlane_b32 s22, v250
  s_cmp_ge_u32 s22, 1264
  s_cbranch_scc1 wk_done
  s_branch wk_loop
wp_abort:
wo_abort:
  s_branch cA_abort
wk_done:
ch_end:
  s_endpgm

.section .rodata,"a"
.p2align 6
.amdhsa_kernel main_kernel
  .amdhsa_next_free_vgpr 512
  .amdhsa_next_free_sgpr 102
  .amdhsa_accum_offset 256
  .amdhsa_group_segment_fixed_size 0
  .amdhsa_kernarg_size 136
  .amdhsa_user_sgpr_count 2
  .amdhsa_user_sgpr_kernarg_segment_ptr 1
  .amdhsa_system_sgpr_workgroup_id_x 1
.end_amdhsa_kernel
```

```asm
; @launch kernel=main_kernel grid=(256,1,1) block=(256,1,1) lds=163840
.amdgcn_target "amdgcn-amd-amdhsa--gfx950"
.text
.globl main_kernel
.p2align 8
.type main_kernel,@function
main_kernel:
  s_cmp_ge_u32 s2, 256
  s_cbranch_scc1 ch_end
  s_load_dwordx2 s[4:5], s[0:1], 120
  s_load_dwordx2 s[6:7], s[0:1], 128
  s_load_dwordx8 s[40:47], s[0:1], 72
  s_load_dwordx4 s[48:51], s[0:1], 56
  s_mov_b32 s32, 0
  s_getreg_b32 s3, hwreg(HW_REG_XCC_ID)
  s_and_b32 s3, s3, 15
  s_cmp_lg_u32 s3, 3
  s_cbranch_scc1 ch_pf
  s_cmp_lt_u32 s2, 224
  s_cbranch_scc1 ch_npf
ch_pf:
  s_getpc_b64 s[98:99]
pf_main_kernel_1:
  s_sub_u32 s98, s98, pf_main_kernel_1-main_kernel
  s_subb_u32 s99, s99, 0
  v_lshlrev_b32 v60, 7, v0
  v_min_u32 v61, ch_end-main_kernel-4, v60
  global_load_dword v62, v61, s[98:99]
  v_add_u32 v60, 32768, v60
  v_min_u32 v61, ch_end-main_kernel-4, v60
  global_load_dword v62, v61, s[98:99]
  v_add_u32 v60, 32768, v60
  v_min_u32 v61, ch_end-main_kernel-4, v60
  global_load_dword v62, v61, s[98:99]
  v_add_u32 v60, 32768, v60
  v_min_u32 v61, ch_end-main_kernel-4, v60
  global_load_dword v62, v61, s[98:99]
  v_add_u32 v60, 32768, v60
  v_min_u32 v61, ch_end-main_kernel-4, v60
  global_load_dword v62, v61, s[98:99]
  v_add_u32 v60, 32768, v60
ch_npf:
  v_lshrrev_b32 v1, 6, v0
  s_nop 0
  v_readfirstlane_b32 s16, v1
  s_waitcnt lgkmcnt(0)
  s_mov_b32 s8, s6
  s_and_b32 s9, s7, 0xffff
  s_mov_b32 s10, 0x10000000
  s_mov_b32 s11, 0x20000
  s_mov_b32 s12, s4
  s_and_b32 s13, s5, 0xffff
  s_mov_b32 s14, 256
  s_mov_b32 s15, 0x20000
  v_mov_b32 v252, 0x40000000
  v_cmp_eq_u32 vcc, 0, v0
  s_nop 1
  v_cndmask_b32 v252, v252, v0, vcc
  s_cmp_lg_u32 s3, 3
  s_cbranch_scc1 ch_worker
  s_mov_b32 s18, 0
  v_mov_b32 v249, 1
  s_mov_b64 exec, 1
  buffer_atomic_add v249, v252, s[12:15], 0 offen sc0
  s_mov_b64 exec, -1
  v_and_b32 v1, 63, v0
  v_lshlrev_b32 v2, 4, v1
  v_lshrrev_b32 v3, 4, v1
  v_and_b32 v4, 15, v1
  s_lshr_b32 s33, s2, 3
  s_lshl_b32 s27, s33, 2
  s_add_u32 s27, s27, s16
  s_lshl_b32 s27, s27, 13
  v_lshlrev_b32 v12, 7, v1
  s_mov_b32 s64, s42
  s_and_b32 s65, s43, 0xffff
  s_mov_b32 s66, 2097152
  s_mov_b32 s67, 0x20000
  s_mov_b32 s28, s27
  buffer_load_dword v13, v12, s[64:67], s28 offen
  s_add_u32 s28, s28, 1048576
  buffer_load_dword v13, v12, s[64:67], s28 offen
  s_add_u32 s28, s28, 1048576
  s_waitcnt vmcnt(2)
  v_readfirstlane_b32 s17, v249
  v_mov_b32 v6, 160032
  s_nop 0
  v_mov_b32 v7, s17
  s_barrier
  s_cmp_lg_u32 s16, 0
  s_cbranch_scc1 uni_2
  ds_write_b32 v6, v7
  s_waitcnt lgkmcnt(0)
uni_2:
  s_barrier
  ds_read_b32 v7, v6
  s_waitcnt lgkmcnt(0)
  v_readfirstlane_b32 s17, v7
  s_branch ch_got
ch_take:
  v_mov_b32 v5, 0
  v_mov_b32 v6, 160000
  s_barrier
  s_cmp_lg_u32 s16, 0
  s_cbranch_scc1 ch_el1
  s_mov_b64 exec, 1
  buffer_atomic_add v4, v5, s[12:15], 0 offen sc0
  s_waitcnt vmcnt(0)
  ds_write_b32 v6, v4
  s_waitcnt lgkmcnt(0)
  s_mov_b64 exec, -1
ch_el1:
  s_barrier
  ds_read_b32 v4, v6
  s_waitcnt lgkmcnt(0)
  v_readfirstlane_b32 s17, v4
ch_got:
  s_and_b32 s17, s17, 0xffff
  s_cmp_lt_u32 s17, 32
  s_cbranch_scc1 ch_role
  s_cmp_eq_u32 s18, 0
  s_cbranch_scc1 ch_worker
  v_and_b32 v1, 63, v0
  v_lshlrev_b32 v2, 4, v1
  v_lshrrev_b32 v3, 4, v1
  v_and_b32 v4, 15, v1
  s_branch wp_all
ch_role:
  v_and_b32 v1, 63, v0
  v_lshlrev_b32 v2, 4, v1
  v_lshrrev_b32 v3, 4, v1
  v_and_b32 v4, 15, v1
  s_cmp_lt_u32 s17, 16
  s_cbranch_scc1 ch_self
  s_cmp_lt_u32 s17, 24
  s_cbranch_scc1 ch_tch
  s_sub_u32 s33, s17, 24
  v_mov_b32 v10, 0x40000000
  v_mov_b32 v5, 1
  v_mov_b32 v148, 0
  v_mov_b32 v149, 0
  v_mov_b32 v150, 0
  v_mov_b32 v151, 0
  v_mov_b32 v152, -1
  v_mov_b32 v153, -1
  v_mov_b32 v154, -1
  v_mov_b32 v155, -1
  v_lshlrev_b32 v8, 4, v0
  s_mov_b32 s64, s48
  s_and_b32 s65, s49, 0xffff
  s_mov_b32 s66, 1835008
  s_mov_b32 s67, 0x20000
  s_lshl_b32 s21, s33, 2
  s_add_u32 s21, s21, s16
  s_lshr_b32 s22, s21, 1
  s_mul_i32 s22, s22, 14336
  s_and_b32 s24, s21, 1
  s_mul_i32 s24, s24, 448
  s_add_u32 s22, s22, s24
  s_mul_i32 s21, s21, 7168
  v_mul_u32_u24 v7, 896, v4
  v_lshl_add_u32 v7, v3, 4, v7
  buffer_load_dwordx4 v[64:67], v7, s[64:67], s22 offen offset:0
  buffer_load_dwordx4 v[68:71], v7, s[64:67], s22 offen offset:64
  buffer_load_dwordx4 v[72:75], v7, s[64:67], s22 offen offset:128
  buffer_load_dwordx4 v[76:79], v7, s[64:67], s22 offen offset:192
  buffer_load_dwordx4 v[80:83], v7, s[64:67], s22 offen offset:256
  buffer_load_dwordx4 v[84:87], v7, s[64:67], s22 offen offset:320
  buffer_load_dwordx4 v[88:91], v7, s[64:67], s22 offen offset:384
  s_mov_b32 s68, s50
  s_and_b32 s69, s51, 0xffff
  s_mov_b32 s70, 7168
  s_mov_b32 s71, 0x20000
  v_lshrrev_b32 v6, 3, v0
  v_min_u32 v6, 27, v6
  v_and_b32 v7, 7, v0
  v_mul_u32_u24 v9, 896, v7
  v_lshl_add_u32 v9, v6, 5, v9
  buffer_load_dwordx4 v[176:179], v9, s[68:71], 0 offen
  buffer_load_dwordx4 v[180:183], v9, s[68:71], 0 offen offset:16
  s_cmp_lg_u32 s33, 0
  s_cbranch_scc1 ch_ij_1
  s_mov_b32 s23, 582144
  buffer_store_dwordx4 v[148:151], v8, s[8:11], s23 offen sc1
  s_mov_b32 s23, 586240
  buffer_store_dwordx4 v[148:151], v8, s[8:11], s23 offen sc1
  s_waitcnt vmcnt(0)
  s_barrier
  buffer_store_dword v5, v252, s[12:15], 0 offen offset:128 sc1
ch_ij_1:
  s_waitcnt vmcnt(1)
  s_add_u32 s23, s21, 655360
  buffer_store_dwordx4 v[64:67], v2, s[8:11], s23 offen offset:0 sc1
  buffer_store_dwordx4 v[68:71], v2, s[8:11], s23 offen offset:1024 sc1
  buffer_store_dwordx4 v[72:75], v2, s[8:11], s23 offen offset:2048 sc1
  buffer_store_dwordx4 v[76:79], v2, s[8:11], s23 offen offset:3072 sc1
  s_add_u32 s23, s21, 659456
  buffer_store_dwordx4 v[80:83], v2, s[8:11], s23 offen offset:0 sc1
  buffer_store_dwordx4 v[84:87], v2, s[8:11], s23 offen offset:1024 sc1
  buffer_store_dwordx4 v[88:91], v2, s[8:11], s23 offen offset:2048 sc1
  s_waitcnt vmcnt(0)
  s_barrier
  s_cmp_lg_u32 s16, 0
  s_cbranch_scc1 ch_ij_x_e
  v_mov_b32 v6, 1
  s_mov_b64 exec, 1
  buffer_atomic_add v6, v252, s[12:15], 0 offen offset:4 sc0
  s_waitcnt vmcnt(0)
  v_readfirstlane_b32 s20, v6
  s_cmp_lg_u32 s20, 7
  s_cbranch_scc1 ch_ij_x_e0
  s_mov_b64 exec, 0xff
  v_lshlrev_b32 v6, 7, v0
  s_mov_b32 s20, 586240
  buffer_store_dword v5, v6, s[8:11], s20 offen offset:8 sc1
ch_ij_x_e0:
  s_mov_b64 exec, -1
ch_ij_x_e:
  s_lshl_b32 s20, s33, 12
  v_add_u32 v8, s20, v8
  s_mov_b32 s23, 524288
ch_ijlp_3:
  buffer_store_dwordx4 v[148:151], v8, s[8:11], s23 offen sc1
  s_add_u32 s23, s23, 32768
  s_cmp_lt_u32 s23, 557056
  s_cbranch_scc1 ch_ijlp_3
  v_cmp_gt_u32 vcc, 25088, v8
  s_nop 1
  v_cndmask_b32 v9, v10, v8, vcc
  buffer_store_dwordx4 v[148:151], v9, s[8:11], s23 offen sc1
  s_mov_b32 s23, 35328
  v_cmp_gt_u32 vcc, 6144, v8
  s_nop 1
  v_cndmask_b32 v9, v10, v8, vcc
  buffer_store_dwordx4 v[148:151], v9, s[8:11], s23 offen sc1
  s_mov_b32 s23, 7168
  v_cmp_gt_u32 vcc, 28160, v8
  s_nop 1
  v_cndmask_b32 v9, v10, v8, vcc
  buffer_store_dwordx4 v[152:155], v9, s[8:11], s23 offen sc1
  s_mov_b32 s23, 72704
ch_ijlp_4:
  buffer_store_dwordx4 v[152:155], v8, s[8:11], s23 offen sc1
  s_add_u32 s23, s23, 32768
  s_cmp_lt_u32 s23, 498688
  s_cbranch_scc1 ch_ijlp_4
  v_cmp_gt_u32 vcc, 25600, v8
  s_nop 1
  v_cndmask_b32 v9, v10, v8, vcc
  buffer_store_dwordx4 v[152:155], v9, s[8:11], s23 offen sc1
  s_cmp_lg_u32 s33, 1
  s_cbranch_scc1 ch_ij_nm
  v_lshrrev_b32 v6, 3, v0
  v_and_b32 v7, 7, v0
  v_lshlrev_b32 v8, 8, v6
  v_lshl_add_u32 v8, v7, 4, v8
  v_cmp_gt_u32 vcc, 28, v6
  s_nop 1
  v_cndmask_b32 v8, v10, v8, vcc
  s_waitcnt vmcnt(4)
  v_min_u32 v184, -2, v176
  v_min_u32 v188, -2, v177
  v_min_u32 v185, -2, v178
  v_min_u32 v189, -2, v179
  v_min_u32 v186, -2, v180
  v_min_u32 v190, -2, v181
  v_min_u32 v187, -2, v182
  v_min_u32 v191, -2, v183
  s_mov_b32 s23, 0
  buffer_store_dwordx4 v[184:187], v8, s[8:11], s23 offen sc1
  buffer_store_dwordx4 v[188:191], v8, s[8:11], s23 offen offset:128 sc1
  s_mov_b32 s23, 65536
  buffer_store_dwordx4 v[184:187], v8, s[8:11], s23 offen sc1
  buffer_store_dwordx4 v[188:191], v8, s[8:11], s23 offen offset:128 sc1
ch_ij_nm:
  s_waitcnt vmcnt(0)
  s_barrier
  s_cmp_lg_u32 s16, 0
  s_cbranch_scc1 ch_ij_e
  v_mov_b32 v6, 1
  s_mov_b64 exec, 1
  buffer_atomic_add v6, v252, s[12:15], 0 offen offset:12 sc0
  s_waitcnt vmcnt(0)
  v_readfirstlane_b32 s20, v6
  s_cmp_lg_u32 s20, 7
  s_cbranch_scc1 ch_ij_e0
  buffer_store_dword v5, v252, s[12:15], 0 offen offset:132 sc1
  s_mov_b64 exec, 0xff
  v_lshlrev_b32 v6, 7, v0
  s_mov_b32 s20, 586240
  buffer_store_dword v5, v6, s[8:11], s20 offen offset:4 sc1
ch_ij_e0:
  s_mov_b64 exec, -1
ch_ij_e:
  s_branch ch_role2
ch_tch:
  s_sub_u32 s33, s17, 16
  s_lshl_b32 s27, s33, 2
  s_add_u32 s27, s27, s16
  s_lshl_b32 s27, s27, 13
  v_lshlrev_b32 v12, 7, v1
  s_mov_b32 s64, s40
  s_and_b32 s65, s41, 0xffff
  s_mov_b32 s66, 2097152
  s_mov_b32 s67, 0x20000
  s_mov_b32 s28, s27
  buffer_load_dword v13, v12, s[64:67], s28 offen
  s_add_u32 s28, s28, 262144
  buffer_load_dword v13, v12, s[64:67], s28 offen
  s_add_u32 s28, s28, 262144
  buffer_load_dword v13, v12, s[64:67], s28 offen
  s_add_u32 s28, s28, 262144
  buffer_load_dword v13, v12, s[64:67], s28 offen
  s_add_u32 s28, s28, 262144
  buffer_load_dword v13, v12, s[64:67], s28 offen
  s_add_u32 s28, s28, 262144
  buffer_load_dword v13, v12, s[64:67], s28 offen
  s_add_u32 s28, s28, 262144
  buffer_load_dword v13, v12, s[64:67], s28 offen
  s_add_u32 s28, s28, 262144
  buffer_load_dword v13, v12, s[64:67], s28 offen
  s_add_u32 s28, s28, 262144
  s_branch ch_role2
ch_self:
  v_lshrrev_b32 v5, 5, v1
  v_and_b32 v6, 31, v1
  v_xor_b32 v8, v6, v5
  v_lshlrev_b32 v8, 4, v8
  v_lshl_add_u32 v16, v5, 13, v8
  v_xor_b32 v17, 32, v16
  v_xor_b32 v18, 64, v16
  v_xor_b32 v19, 96, v16
  v_xor_b32 v20, 128, v16
  v_xor_b32 v21, 160, v16
  v_xor_b32 v22, 192, v16
  v_xor_b32 v23, 224, v16
  s_lshl_b32 s20, s16, 6
  v_xor_b32 v26, s20, v16
  v_xor_b32 v27, 32, v26
  s_mov_b32 s60, s40
  s_and_b32 s61, s41, 0xffff
  s_mov_b32 s62, 3670016
  s_mov_b32 s63, 0x20000
  s_mov_b32 s56, s42
  s_and_b32 s57, s43, 0xffff
  s_mov_b32 s58, 3670016
  s_mov_b32 s59, 0x20000
  s_lshl_b32 s26, s17, 9
  s_lshl_b32 s27, s16, 19
  s_add_u32 s27, s27, s26
  s_lshl_b32 s25, s16, 15
  s_add_u32 s25, s25, 32768
  s_barrier
  s_add_u32 m0, s25, 0
  s_nop 0
  buffer_load_dwordx4 v16, s[56:59], s27 offen lds
  s_add_u32 s27, s27, 16384
  s_add_u32 m0, s25, 1024
  s_nop 0
  buffer_load_dwordx4 v16, s[56:59], s27 offen lds
  s_add_u32 s27, s27, 16384
  s_add_u32 m0, s25, 2048
  s_nop 0
  buffer_load_dwordx4 v17, s[56:59], s27 offen lds
  s_add_u32 s27, s27, 16384
  s_add_u32 m0, s25, 3072
  s_nop 0
  buffer_load_dwordx4 v17, s[56:59], s27 offen lds
  s_add_u32 s27, s27, 16384
  s_add_u32 m0, s25, 4096
  s_nop 0
  buffer_load_dwordx4 v16, s[56:59], s27 offen lds
  s_add_u32 s27, s27, 16384
  s_add_u32 m0, s25, 5120
  s_nop 0
  buffer_load_dwordx4 v16, s[56:59], s27 offen lds
  s_add_u32 s27, s27, 16384
  s_add_u32 m0, s25, 6144
  s_nop 0
  buffer_load_dwordx4 v17, s[56:59], s27 offen lds
  s_add_u32 s27, s27, 16384
  s_add_u32 m0, s25, 7168
  s_nop 0
  buffer_load_dwordx4 v17, s[56:59], s27 offen lds
  s_add_u32 s27, s27, 16384
  s_add_u32 m0, s25, 8192
  s_nop 0
  buffer_load_dwordx4 v18, s[56:59], s27 offen lds
  s_add_u32 s27, s27, 16384
  s_add_u32 m0, s25, 9216
  s_nop 0
  buffer_load_dwordx4 v18, s[56:59], s27 offen lds
  s_add_u32 s27, s27, 16384
  s_add_u32 m0, s25, 10240
  s_nop 0
  buffer_load_dwordx4 v19, s[56:59], s27 offen lds
  s_add_u32 s27, s27, 16384
  s_add_u32 m0, s25, 11264
  s_nop 0
  buffer_load_dwordx4 v19, s[56:59], s27 offen lds
  s_add_u32 s27, s27, 16384
  s_add_u32 m0, s25, 12288
  s_nop 0
  buffer_load_dwordx4 v18, s[56:59], s27 offen lds
  s_add_u32 s27, s27, 16384
  s_add_u32 m0, s25, 13312
  s_nop 0
  buffer_load_dwordx4 v18, s[56:59], s27 offen lds
  s_add_u32 s27, s27, 16384
  s_add_u32 m0, s25, 14336
  s_nop 0
  buffer_load_dwordx4 v19, s[56:59], s27 offen lds
  s_add_u32 s27, s27, 16384
  s_add_u32 m0, s25, 15360
  s_nop 0
  buffer_load_dwordx4 v19, s[56:59], s27 offen lds
  s_add_u32 s27, s27, 16384
  s_add_u32 m0, s25, 16384
  s_nop 0
  buffer_load_dwordx4 v20, s[56:59], s27 offen lds
  s_add_u32 s27, s27, 16384
  s_add_u32 m0, s25, 17408
  s_nop 0
  buffer_load_dwordx4 v20, s[56:59], s27 offen lds
  s_add_u32 s27, s27, 16384
  s_add_u32 m0, s25, 18432
  s_nop 0
  buffer_load_dwordx4 v21, s[56:59], s27 offen lds
  s_add_u32 s27, s27, 16384
  s_add_u32 m0, s25, 19456
  s_nop 0
  buffer_load_dwordx4 v21, s[56:59], s27 offen lds
  s_add_u32 s27, s27, 16384
  s_add_u32 m0, s25, 20480
  s_nop 0
  buffer_load_dwordx4 v20, s[56:59], s27 offen lds
  s_add_u32 s27, s27, 16384
  s_add_u32 m0, s25, 21504
  s_nop 0
  buffer_load_dwordx4 v20, s[56:59], s27 offen lds
  s_add_u32 s27, s27, 16384
  s_add_u32 m0, s25, 22528
  s_nop 0
  buffer_load_dwordx4 v21, s[56:59], s27 offen lds
  s_add_u32 s27, s27, 16384
  s_add_u32 m0, s25, 23552
  s_nop 0
  buffer_load_dwordx4 v21, s[56:59], s27 offen lds
  s_add_u32 s27, s27, 16384
  s_add_u32 m0, s25, 24576
  s_nop 0
  buffer_load_dwordx4 v22, s[56:59], s27 offen lds
  s_add_u32 s27, s27, 16384
  s_add_u32 m0, s25, 25600
  s_nop 0
  buffer_load_dwordx4 v22, s[56:59], s27 offen lds
  s_add_u32 s27, s27, 16384
  s_add_u32 m0, s25, 26624
  s_nop 0
  buffer_load_dwordx4 v23, s[56:59], s27 offen lds
  s_add_u32 s27, s27, 16384
  s_add_u32 m0, s25, 27648
  s_nop 0
  buffer_load_dwordx4 v23, s[56:59], s27 offen lds
  s_add_u32 s27, s27, 16384
  s_add_u32 m0, s25, 28672
  s_nop 0
  buffer_load_dwordx4 v22, s[56:59], s27 offen lds
  s_add_u32 s27, s27, 16384
  s_add_u32 m0, s25, 29696
  s_nop 0
  buffer_load_dwordx4 v22, s[56:59], s27 offen lds
  s_add_u32 s27, s27, 16384
  s_add_u32 m0, s25, 30720
  s_nop 0
  buffer_load_dwordx4 v23, s[56:59], s27 offen lds
  s_add_u32 s27, s27, 16384
  s_add_u32 m0, s25, 31744
  s_nop 0
  buffer_load_dwordx4 v23, s[56:59], s27 offen lds
  s_add_u32 s27, s27, 16384
  v_mov_b32 v14, v26
  v_mov_b32 v15, v27
  s_lshl_b32 s28, s16, 16
  s_add_u32 s28, s28, s26
  s_lshl_b32 s29, s16, 12
  s_add_u32 m0, s29, 0
  s_add_u32 s27, s28, 0
  buffer_load_dwordx4 v14, s[60:63], s27 offen lds
  s_add_u32 m0, s29, 1024
  s_add_u32 s27, s28, 16384
  buffer_load_dwordx4 v15, s[60:63], s27 offen lds
  s_add_u32 m0, s29, 2048
  s_add_u32 s27, s28, 32768
  buffer_load_dwordx4 v14, s[60:63], s27 offen lds
  s_add_u32 m0, s29, 3072
  s_add_u32 s27, s28, 49152
  buffer_load_dwordx4 v15, s[60:63], s27 offen lds
  s_add_u32 m0, s29, 16384
  s_add_u32 s27, s28, 262144
  buffer_load_dwordx4 v14, s[60:63], s27 offen lds
  s_add_u32 m0, s29, 17408
  s_add_u32 s27, s28, 278528
  buffer_load_dwordx4 v15, s[60:63], s27 offen lds
  s_add_u32 m0, s29, 18432
  s_add_u32 s27, s28, 294912
  buffer_load_dwordx4 v14, s[60:63], s27 offen lds
  s_add_u32 m0, s29, 19456
  s_add_u32 s27, s28, 311296
  buffer_load_dwordx4 v15, s[60:63], s27 offen lds
  v_lshrrev_b32 v7, 2, v4
  v_lshlrev_b32 v11, 4, v7
  v_lshlrev_b32 v7, 3, v7
  v_and_b32 v8, 3, v4
  v_add_u32 v7, v7, v8
  v_and_b32 v8, 2, v4
  v_lshl_add_u32 v11, v8, 1, v11
  v_and_b32 v8, 1, v4
  v_add_u32 v11, v11, v8
  v_or_b32 v10, 0, v3
  v_xor_b32 v10, v10, v4
  v_lshlrev_b32 v10, 4, v10
  v_lshl_add_u32 v248, v7, 9, v10
  v_add_u32 v252, 65536, v248
  v_add_u32 v16, 131072, v248
  v_lshl_add_u32 v10, v11, 9, v10
  v_add_u32 v20, s25, v10
  v_or_b32 v10, 4, v3
  v_xor_b32 v10, v10, v4
  v_lshlrev_b32 v10, 4, v10
  v_lshl_add_u32 v249, v7, 9, v10
  v_add_u32 v253, 65536, v249
  v_add_u32 v17, 131072, v249
  v_lshl_add_u32 v10, v11, 9, v10
  v_add_u32 v21, s25, v10
  v_or_b32 v10, 8, v3
  v_xor_b32 v10, v10, v4
  v_lshlrev_b32 v10, 4, v10
  v_lshl_add_u32 v250, v7, 9, v10
  v_add_u32 v254, 65536, v250
  v_add_u32 v18, 131072, v250
  v_lshl_add_u32 v10, v11, 9, v10
  v_add_u32 v22, s25, v10
  v_or_b32 v10, 12, v3
  v_xor_b32 v10, v10, v4
  v_lshlrev_b32 v10, 4, v10
  v_lshl_add_u32 v251, v7, 9, v10
  v_add_u32 v255, 65536, v251
  v_add_u32 v19, 131072, v251
  v_lshl_add_u32 v10, v11, 9, v10
  v_add_u32 v23, s25, v10
  v_mov_b32 v12, 1035512379
  v_lshlrev_b32 v6, 7, v1
  s_getpc_b64 s[98:99]
  global_load_dword v7, v6, s[98:99]
  s_waitcnt vmcnt(9)
  ds_read_b128 v[120:123], v20 offset:0
  ds_read_b128 v[124:127], v21 offset:0
  ds_read_b128 v[128:131], v22 offset:0
  ds_read_b128 v[132:135], v23 offset:0
  ds_read_b128 v[136:139], v20 offset:256
  ds_read_b128 v[140:143], v21 offset:256
  ds_read_b128 v[144:147], v22 offset:256
  ds_read_b128 v[148:151], v23 offset:256
  s_waitcnt lgkmcnt(8)
  ds_read_b128 v[152:155], v20 offset:1024
  ds_read_b128 v[156:159], v21 offset:1024
  ds_read_b128 v[160:163], v22 offset:1024
  ds_read_b128 v[164:167], v23 offset:1024
  ds_read_b128 v[168:171], v20 offset:1280
  ds_read_b128 v[172:175], v21 offset:1280
  ds_read_b128 v[176:179], v22 offset:1280
  ds_read_b128 v[180:183], v23 offset:1280
  s_waitcnt lgkmcnt(8)
  ds_read_b128 v[184:187], v20 offset:4096
  ds_read_b128 v[188:191], v21 offset:4096
  ds_read_b128 v[192:195], v22 offset:4096
  ds_read_b128 v[196:199], v23 offset:4096
  ds_read_b128 v[200:203], v20 offset:4352
  ds_read_b128 v[204:207], v21 offset:4352
  ds_read_b128 v[208:211], v22 offset:4352
  ds_read_b128 v[212:215], v23 offset:4352
  s_waitcnt lgkmcnt(8)
  ds_read_b128 v[216:219], v20 offset:5120
  ds_read_b128 v[220:223], v21 offset:5120
  ds_read_b128 v[224:227], v22 offset:5120
  ds_read_b128 v[228:231], v23 offset:5120
  ds_read_b128 v[232:235], v20 offset:5376
  ds_read_b128 v[236:239], v21 offset:5376
  ds_read_b128 v[240:243], v22 offset:5376
  ds_read_b128 v[244:247], v23 offset:5376
  s_waitcnt lgkmcnt(8)
  s_waitcnt vmcnt(4) lgkmcnt(0)
  s_barrier
  ds_read_b128 v[24:27], v248 offset:0
  ds_read_b128 v[28:31], v248 offset:2048
  ds_read_b128 v[32:35], v249 offset:0
  ds_read_b128 v[36:39], v249 offset:2048
  ds_read_b128 v[40:43], v250 offset:0
  ds_read_b128 v[44:47], v250 offset:2048
  s_waitcnt lgkmcnt(5)
  s_getpc_b64 s[98:99]
  s_add_u32 s98, s98, 4096
  s_addc_u32 s99, s99, 0
  global_load_dword v7, v6, s[98:99]
  v_mfma_f32_16x16x32_bf16 v[56:59], v[24:27], v[120:123], 0
  ds_read_b128 v[48:51], v251 offset:0
  v_mfma_f32_16x16x32_bf16 v[64:67], v[24:27], v[152:155], 0
  v_mfma_f32_16x16x32_bf16 v[72:75], v[24:27], v[184:187], 0
  s_add_u32 m0, s29, 32768
  s_add_u32 s27, s28, 524288
  buffer_load_dwordx4 v14, s[60:63], s27 offen lds
  v_mfma_f32_16x16x32_bf16 v[80:83], v[24:27], v[216:219], 0
  s_waitcnt lgkmcnt(5)
  v_mfma_f32_16x16x32_bf16 v[60:63], v[28:31], v[120:123], 0
  ds_read_b128 v[52:55], v251 offset:2048
  v_mfma_f32_16x16x32_bf16 v[68:71], v[28:31], v[152:155], 0
  v_mfma_f32_16x16x32_bf16 v[76:79], v[28:31], v[184:187], 0
  s_add_u32 m0, s29, 33792
  s_add_u32 s27, s28, 540672
  buffer_load_dwordx4 v15, s[60:63], s27 offen lds
  v_mfma_f32_16x16x32_bf16 v[84:87], v[28:31], v[216:219], 0
  s_waitcnt lgkmcnt(5)
  v_mfma_f32_16x16x32_bf16 v[56:59], v[32:35], v[124:127], v[56:59]
  ds_read_b128 v[24:27], v248 offset:256
  v_mfma_f32_16x16x32_bf16 v[64:67], v[32:35], v[156:159], v[64:67]
  v_mfma_f32_16x16x32_bf16 v[72:75], v[32:35], v[188:191], v[72:75]
  s_add_u32 m0, s29, 34816
  s_add_u32 s27, s28, 557056
  buffer_load_dwordx4 v14, s[60:63], s27 offen lds
  v_mfma_f32_16x16x32_bf16 v[80:83], v[32:35], v[220:223], v[80:83]
  s_waitcnt lgkmcnt(5)
  v_mfma_f32_16x16x32_bf16 v[60:63], v[36:39], v[124:127], v[60:63]
  ds_read_b128 v[28:31], v248 offset:2304
  v_mfma_f32_16x16x32_bf16 v[68:71], v[36:39], v[156:159], v[68:71]
  v_mfma_f32_16x16x32_bf16 v[76:79], v[36:39], v[188:191], v[76:79]
  s_add_u32 m0, s29, 35840
  s_add_u32 s27, s28, 573440
  buffer_load_dwordx4 v15, s[60:63], s27 offen lds
  v_mfma_f32_16x16x32_bf16 v[84:87], v[36:39], v[220:223], v[84:87]
  s_waitcnt lgkmcnt(5)
  v_mfma_f32_16x16x32_bf16 v[56:59], v[40:43], v[128:131], v[56:59]
  ds_read_b128 v[32:35], v249 offset:256
  v_mfma_f32_16x16x32_bf16 v[64:67], v[40:43], v[160:163], v[64:67]
  v_mfma_f32_16x16x32_bf16 v[72:75], v[40:43], v[192:195], v[72:75]
  s_add_u32 m0, s29, 49152
  s_add_u32 s27, s28, 786432
  buffer_load_dwordx4 v14, s[60:63], s27 offen lds
  v_mfma_f32_16x16x32_bf16 v[80:83], v[40:43], v[224:227], v[80:83]
  s_waitcnt lgkmcnt(5)
  v_mfma_f32_16x16x32_bf16 v[60:63], v[44:47], v[128:131], v[60:63]
  ds_read_b128 v[36:39], v249 offset:2304
  v_mfma_f32_16x16x32_bf16 v[68:71], v[44:47], v[160:163], v[68:71]
  v_mfma_f32_16x16x32_bf16 v[76:79], v[44:47], v[192:195], v[76:79]
  s_add_u32 m0, s29, 50176
  s_add_u32 s27, s28, 802816
  buffer_load_dwordx4 v15, s[60:63], s27 offen lds
  v_mfma_f32_16x16x32_bf16 v[84:87], v[44:47], v[224:227], v[84:87]
  s_waitcnt lgkmcnt(5)
  v_mfma_f32_16x16x32_bf16 v[56:59], v[48:51], v[132:135], v[56:59]
  ds_read_b128 v[40:43], v250 offset:256
  v_mfma_f32_16x16x32_bf16 v[64:67], v[48:51], v[164:167], v[64:67]
  v_mfma_f32_16x16x32_bf16 v[72:75], v[48:51], v[196:199], v[72:75]
  s_add_u32 m0, s29, 51200
  s_add_u32 s27, s28, 819200
  buffer_load_dwordx4 v14, s[60:63], s27 offen lds
  v_mfma_f32_16x16x32_bf16 v[80:83], v[48:51], v[228:231], v[80:83]
  s_waitcnt lgkmcnt(5)
  v_mfma_f32_16x16x32_bf16 v[60:63], v[52:55], v[132:135], v[60:63]
  ds_read_b128 v[44:47], v250 offset:2304
  v_mfma_f32_16x16x32_bf16 v[68:71], v[52:55], v[164:167], v[68:71]
  v_mfma_f32_16x16x32_bf16 v[76:79], v[52:55], v[196:199], v[76:79]
  s_add_u32 m0, s29, 52224
  s_add_u32 s27, s28, 835584
  buffer_load_dwordx4 v15, s[60:63], s27 offen lds
  v_mfma_f32_16x16x32_bf16 v[84:87], v[52:55], v[228:231], v[84:87]
  s_waitcnt lgkmcnt(5)
  v_mfma_f32_16x16x32_bf16 v[56:59], v[24:27], v[136:139], v[56:59]
  ds_read_b128 v[48:51], v251 offset:256
  v_mfma_f32_16x16x32_bf16 v[64:67], v[24:27], v[168:171], v[64:67]
  v_mfma_f32_16x16x32_bf16 v[72:75], v[24:27], v[200:203], v[72:75]
  v_mfma_f32_16x16x32_bf16 v[80:83], v[24:27], v[232:235], v[80:83]
  s_waitcnt lgkmcnt(5)
  v_mfma_f32_16x16x32_bf16 v[60:63], v[28:31], v[136:139], v[60:63]
  ds_read_b128 v[52:55], v251 offset:2304
  v_mfma_f32_16x16x32_bf16 v[68:71], v[28:31], v[168:171], v[68:71]
  v_mfma_f32_16x16x32_bf16 v[76:79], v[28:31], v[200:203], v[76:79]
  v_mfma_f32_16x16x32_bf16 v[84:87], v[28:31], v[232:235], v[84:87]
  s_waitcnt lgkmcnt(5)
  v_mfma_f32_16x16x32_bf16 v[56:59], v[32:35], v[140:143], v[56:59]
  s_waitcnt vmcnt(8)
  s_barrier
  ds_read_b128 v[24:27], v248 offset:16384
  v_mfma_f32_16x16x32_bf16 v[64:67], v[32:35], v[172:175], v[64:67]
  v_mfma_f32_16x16x32_bf16 v[72:75], v[32:35], v[204:207], v[72:75]
  v_mfma_f32_16x16x32_bf16 v[80:83], v[32:35], v[236:239], v[80:83]
  s_waitcnt lgkmcnt(5)
  v_mfma_f32_16x16x32_bf16 v[60:63], v[36:39], v[140:143], v[60:63]
  ds_read_b128 v[28:31], v248 offset:18432
  v_mfma_f32_16x16x32_bf16 v[68:71], v[36:39], v[172:175], v[68:71]
  v_mfma_f32_16x16x32_bf16 v[76:79], v[36:39], v[204:207], v[76:79]
  v_mfma_f32_16x16x32_bf16 v[84:87], v[36:39], v[236:239], v[84:87]
  s_waitcnt lgkmcnt(5)
  v_mfma_f32_16x16x32_bf16 v[56:59], v[40:43], v[144:147], v[56:59]
  ds_read_b128 v[32:35], v249 offset:16384
  v_mfma_f32_16x16x32_bf16 v[64:67], v[40:43], v[176:179], v[64:67]
  v_mfma_f32_16x16x32_bf16 v[72:75], v[40:43], v[208:211], v[72:75]
  v_mfma_f32_16x16x32_bf16 v[80:83], v[40:43], v[240:243], v[80:83]
  s_waitcnt lgkmcnt(5)
  v_mfma_f32_16x16x32_bf16 v[60:63], v[44:47], v[144:147], v[60:63]
  ds_read_b128 v[36:39], v249 offset:18432
  v_mfma_f32_16x16x32_bf16 v[68:71], v[44:47], v[176:179], v[68:71]
  v_mfma_f32_16x16x32_bf16 v[76:79], v[44:47], v[208:211], v[76:79]
  v_mfma_f32_16x16x32_bf16 v[84:87], v[44:47], v[240:243], v[84:87]
  s_waitcnt lgkmcnt(5)
  v_mfma_f32_16x16x32_bf16 v[56:59], v[48:51], v[148:151], v[56:59]
  ds_read_b128 v[40:43], v250 offset:16384
  v_mfma_f32_16x16x32_bf16 v[64:67], v[48:51], v[180:183], v[64:67]
  v_mfma_f32_16x16x32_bf16 v[72:75], v[48:51], v[212:215], v[72:75]
  v_mfma_f32_16x16x32_bf16 v[80:83], v[48:51], v[244:247], v[80:83]
  s_waitcnt lgkmcnt(5)
  v_mfma_f32_16x16x32_bf16 v[60:63], v[52:55], v[148:151], v[60:63]
  ds_read_b128 v[44:47], v250 offset:18432
  v_mfma_f32_16x16x32_bf16 v[68:71], v[52:55], v[180:183], v[68:71]
  v_mfma_f32_16x16x32_bf16 v[76:79], v[52:55], v[212:215], v[76:79]
  v_mfma_f32_16x16x32_bf16 v[84:87], v[52:55], v[244:247], v[84:87]
  s_waitcnt lgkmcnt(5)
  v_mfma_f32_16x16x32_bf16 v[88:91], v[24:27], v[120:123], 0
  ds_read_b128 v[48:51], v251 offset:16384
  v_mfma_f32_16x16x32_bf16 v[96:99], v[24:27], v[152:155], 0
  v_mfma_f32_16x16x32_bf16 v[104:107], v[24:27], v[184:187], 0
  s_add_u32 m0, s29, 65536
  s_add_u32 s27, s28, 1048576
  buffer_load_dwordx4 v14, s[60:63], s27 offen lds
  v_mfma_f32_16x16x32_bf16 v[112:115], v[24:27], v[216:219], 0
  s_waitcnt lgkmcnt(5)
  v_mul_f32 v56, v12, v56
  v_mfma_f32_16x16x32_bf16 v[92:95], v[28:31], v[120:123], 0
  ds_read_b128 v[52:55], v251 offset:18432
  v_mul_f32 v57, v12, v57
  v_mfma_f32_16x16x32_bf16 v[100:103], v[28:31], v[152:155], 0
  v_mul_f32 v58, v12, v58
  v_mul_f32 v59, v12, v59
  v_mfma_f32_16x16x32_bf16 v[108:111], v[28:31], v[184:187], 0
  s_add_u32 m0, s29, 66560
  s_add_u32 s27, s28, 1064960
  buffer_load_dwordx4 v15, s[60:63], s27 offen lds
  v_mfma_f32_16x16x32_bf16 v[116:119], v[28:31], v[216:219], 0
  s_waitcnt lgkmcnt(5)
  v_mul_f32 v60, v12, v60
  v_mfma_f32_16x16x32_bf16 v[88:91], v[32:35], v[124:127], v[88:91]
  ds_read_b128 v[24:27], v248 offset:16640
  v_mul_f32 v61, v12, v61
  v_mfma_f32_16x16x32_bf16 v[96:99], v[32:35], v[156:159], v[96:99]
  v_mul_f32 v62, v12, v62
  v_mul_f32 v63, v12, v63
  v_mfma_f32_16x16x32_bf16 v[104:107], v[32:35], v[188:191], v[104:107]
  s_add_u32 m0, s29, 67584
  s_add_u32 s27, s28, 1081344
  buffer_load_dwordx4 v14, s[60:63], s27 offen lds
  v_mfma_f32_16x16x32_bf16 v[112:115], v[32:35], v[220:223], v[112:115]
  s_waitcnt lgkmcnt(5)
  v_cvt_pk_bf16_f32 v56, v56, v57
  v_mfma_f32_16x16x32_bf16 v[92:95], v[36:39], v[124:127], v[92:95]
  ds_read_b128 v[28:31], v248 offset:18688
  v_cvt_pk_bf16_f32 v57, v58, v59
  v_mfma_f32_16x16x32_bf16 v[100:103], v[36:39], v[156:159], v[100:103]
  v_cvt_pk_bf16_f32 v58, v60, v61
  v_cvt_pk_bf16_f32 v59, v62, v63
  v_mfma_f32_16x16x32_bf16 v[108:111], v[36:39], v[188:191], v[108:111]
  s_add_u32 m0, s29, 68608
  s_add_u32 s27, s28, 1097728
  buffer_load_dwordx4 v15, s[60:63], s27 offen lds
  v_mfma_f32_16x16x32_bf16 v[116:119], v[36:39], v[220:223], v[116:119]
  s_waitcnt lgkmcnt(5)
  v_accvgpr_write_b32 a0, v56
  v_mfma_f32_16x16x32_bf16 v[88:91], v[40:43], v[128:131], v[88:91]
  ds_read_b128 v[32:35], v249 offset:16640
  v_accvgpr_write_b32 a1, v57
  v_mfma_f32_16x16x32_bf16 v[96:99], v[40:43], v[160:163], v[96:99]
  v_accvgpr_write_b32 a2, v58
  v_accvgpr_write_b32 a3, v59
  v_mfma_f32_16x16x32_bf16 v[104:107], v[40:43], v[192:195], v[104:107]
  s_add_u32 m0, s29, 81920
  s_add_u32 s27, s28, 1310720
  buffer_load_dwordx4 v14, s[60:63], s27 offen lds
  v_mfma_f32_16x16x32_bf16 v[112:115], v[40:43], v[224:227], v[112:115]
  s_waitcnt lgkmcnt(5)
  v_mul_f32 v64, v12, v64
  v_mfma_f32_16x16x32_bf16 v[92:95], v[44:47], v[128:131], v[92:95]
  ds_read_b128 v[36:39], v249 offset:18688
  v_mul_f32 v65, v12, v65
  v_mfma_f32_16x16x32_bf16 v[100:103], v[44:47], v[160:163], v[100:103]
  v_mul_f32 v66, v12, v66
  v_mul_f32 v67, v12, v67
  v_mfma_f32_16x16x32_bf16 v[108:111], v[44:47], v[192:195], v[108:111]
  s_add_u32 m0, s29, 82944
  s_add_u32 s27, s28, 1327104
  buffer_load_dwordx4 v15, s[60:63], s27 offen lds
  v_mfma_f32_16x16x32_bf16 v[116:119], v[44:47], v[224:227], v[116:119]
  s_waitcnt lgkmcnt(5)
  v_mul_f32 v68, v12, v68
  v_mfma_f32_16x16x32_bf16 v[88:91], v[48:51], v[132:135], v[88:91]
  ds_read_b128 v[40:43], v250 offset:16640
  v_mul_f32 v69, v12, v69
  v_mfma_f32_16x16x32_bf16 v[96:99], v[48:51], v[164:167], v[96:99]
  v_mul_f32 v70, v12, v70
  v_mul_f32 v71, v12, v71
  v_mfma_f32_16x16x32_bf16 v[104:107], v[48:51], v[196:199], v[104:107]
  s_add_u32 m0, s29, 83968
  s_add_u32 s27, s28, 1343488
  buffer_load_dwordx4 v14, s[60:63], s27 offen lds
  v_mfma_f32_16x16x32_bf16 v[112:115], v[48:51], v[228:231], v[112:115]
  s_waitcnt lgkmcnt(5)
  v_cvt_pk_bf16_f32 v64, v64, v65
  v_mfma_f32_16x16x32_bf16 v[92:95], v[52:55], v[132:135], v[92:95]
  ds_read_b128 v[44:47], v250 offset:18688
  v_cvt_pk_bf16_f32 v65, v66, v67
  v_mfma_f32_16x16x32_bf16 v[100:103], v[52:55], v[164:167], v[100:103]
  v_cvt_pk_bf16_f32 v66, v68, v69
  v_cvt_pk_bf16_f32 v67, v70, v71
  v_mfma_f32_16x16x32_bf16 v[108:111], v[52:55], v[196:199], v[108:111]
  s_add_u32 m0, s29, 84992
  s_add_u32 s27, s28, 1359872
  buffer_load_dwordx4 v15, s[60:63], s27 offen lds
  v_mfma_f32_16x16x32_bf16 v[116:119], v[52:55], v[228:231], v[116:119]
  s_waitcnt lgkmcnt(5)
  v_accvgpr_write_b32 a56, v64
  v_mfma_f32_16x16x32_bf16 v[88:91], v[24:27], v[136:139], v[88:91]
  ds_read_b128 v[48:51], v251 offset:16640
  v_accvgpr_write_b32 a57, v65
  v_mfma_f32_16x16x32_bf16 v[96:99], v[24:27], v[168:171], v[96:99]
  v_accvgpr_write_b32 a58, v66
  v_accvgpr_write_b32 a59, v67
  v_mfma_f32_16x16x32_bf16 v[104:107], v[24:27], v[200:203], v[104:107]
  v_mul_f32 v72, v12, v72
  v_mfma_f32_16x16x32_bf16 v[112:115], v[24:27], v[232:235], v[112:115]
  s_waitcnt lgkmcnt(5)
  v_mul_f32 v73, v12, v73
  v_mfma_f32_16x16x32_bf16 v[92:95], v[28:31], v[136:139], v[92:95]
  ds_read_b128 v[52:55], v251 offset:18688
  v_mul_f32 v74, v12, v74
  v_mfma_f32_16x16x32_bf16 v[100:103], v[28:31], v[168:171], v[100:103]
  v_mul_f32 v75, v12, v75
  v_mul_f32 v76, v12, v76
  v_mfma_f32_16x16x32_bf16 v[108:111], v[28:31], v[200:203], v[108:111]
  v_mul_f32 v77, v12, v77
  v_mfma_f32_16x16x32_bf16 v[116:119], v[28:31], v[232:235], v[116:119]
  s_waitcnt lgkmcnt(5)
  v_mul_f32 v78, v12, v78
  v_mfma_f32_16x16x32_bf16 v[88:91], v[32:35], v[140:143], v[88:91]
  s_waitcnt vmcnt(12)
  s_barrier
  ds_read_b128 v[24:27], v248 offset:32768
  v_mul_f32 v79, v12, v79
  v_mfma_f32_16x16x32_bf16 v[96:99], v[32:35], v[172:175], v[96:99]
  v_cvt_pk_bf16_f32 v72, v72, v73
  v_cvt_pk_bf16_f32 v73, v74, v75
  v_mfma_f32_16x16x32_bf16 v[104:107], v[32:35], v[204:207], v[104:107]
  v_cvt_pk_bf16_f32 v74, v76, v77
  v_mfma_f32_16x16x32_bf16 v[112:115], v[32:35], v[236:239], v[112:115]
  s_waitcnt lgkmcnt(5)
  v_cvt_pk_bf16_f32 v75, v78, v79
  v_mfma_f32_16x16x32_bf16 v[92:95], v[36:39], v[140:143], v[92:95]
  ds_read_b128 v[28:31], v248 offset:34816
  v_accvgpr_write_b32 a112, v72
  v_mfma_f32_16x16x32_bf16 v[100:103], v[36:39], v[172:175], v[100:103]
  v_accvgpr_write_b32 a113, v73
  v_accvgpr_write_b32 a114, v74
  v_mfma_f32_16x16x32_bf16 v[108:111], v[36:39], v[204:207], v[108:111]
  v_accvgpr_write_b32 a115, v75
  v_mfma_f32_16x16x32_bf16 v[116:119], v[36:39], v[236:239], v[116:119]
  s_waitcnt lgkmcnt(5)
  v_mul_f32 v80, v12, v80
  v_mfma_f32_16x16x32_bf16 v[88:91], v[40:43], v[144:147], v[88:91]
  ds_read_b128 v[32:35], v249 offset:32768
  v_mul_f32 v81, v12, v81
  v_mfma_f32_16x16x32_bf16 v[96:99], v[40:43], v[176:179], v[96:99]
  v_mul_f32 v82, v12, v82
  v_mul_f32 v83, v12, v83
  v_mfma_f32_16x16x32_bf16 v[104:107], v[40:43], v[208:211], v[104:107]
  v_mul_f32 v84, v12, v84
  v_mfma_f32_16x16x32_bf16 v[112:115], v[40:43], v[240:243], v[112:115]
  s_waitcnt lgkmcnt(5)
  v_mul_f32 v85, v12, v85
  v_mfma_f32_16x16x32_bf16 v[92:95], v[44:47], v[144:147], v[92:95]
  ds_read_b128 v[36:39], v249 offset:34816
  v_mul_f32 v86, v12, v86
  v_mfma_f32_16x16x32_bf16 v[100:103], v[44:47], v[176:179], v[100:103]
  v_mul_f32 v87, v12, v87
  v_cvt_pk_bf16_f32 v80, v80, v81
  v_mfma_f32_16x16x32_bf16 v[108:111], v[44:47], v[208:211], v[108:111]
  v_cvt_pk_bf16_f32 v81, v82, v83
  v_mfma_f32_16x16x32_bf16 v[116:119], v[44:47], v[240:243], v[116:119]
  s_waitcnt lgkmcnt(5)
  v_cvt_pk_bf16_f32 v82, v84, v85
  v_mfma_f32_16x16x32_bf16 v[88:91], v[48:51], v[148:151], v[88:91]
  ds_read_b128 v[40:43], v250 offset:32768
  v_cvt_pk_bf16_f32 v83, v86, v87
  v_mfma_f32_16x16x32_bf16 v[96:99], v[48:51], v[180:183], v[96:99]
  v_accvgpr_write_b32 a168, v80
  v_accvgpr_write_b32 a169, v81
  v_mfma_f32_16x16x32_bf16 v[104:107], v[48:51], v[212:215], v[104:107]
  v_accvgpr_write_b32 a170, v82
  v_mfma_f32_16x16x32_bf16 v[112:115], v[48:51], v[244:247], v[112:115]
  s_waitcnt lgkmcnt(5)
  v_accvgpr_write_b32 a171, v83
  v_mfma_f32_16x16x32_bf16 v[92:95], v[52:55], v[148:151], v[92:95]
  ds_read_b128 v[44:47], v250 offset:34816
  v_mfma_f32_16x16x32_bf16 v[100:103], v[52:55], v[180:183], v[100:103]
  v_mfma_f32_16x16x32_bf16 v[108:111], v[52:55], v[212:215], v[108:111]
  v_mfma_f32_16x16x32_bf16 v[116:119], v[52:55], v[244:247], v[116:119]
  s_waitcnt lgkmcnt(5)
  v_mfma_f32_16x16x32_bf16 v[56:59], v[24:27], v[120:123], 0
  ds_read_b128 v[48:51], v251 offset:32768
  v_mfma_f32_16x16x32_bf16 v[64:67], v[24:27], v[152:155], 0
  v_mfma_f32_16x16x32_bf16 v[72:75], v[24:27], v[184:187], 0
  s_add_u32 m0, s29, 98304
  s_add_u32 s27, s28, 1572864
  buffer_load_dwordx4 v14, s[60:63], s27 offen lds
  v_mfma_f32_16x16x32_bf16 v[80:83], v[24:27], v[216:219], 0
  s_waitcnt lgkmcnt(5)
  v_mul_f32 v88, v12, v88
  v_mfma_f32_16x16x32_bf16 v[60:63], v[28:31], v[120:123], 0
  ds_read_b128 v[52:55], v251 offset:34816
  v_mul_f32 v89, v12, v89
  v_mfma_f32_16x16x32_bf16 v[68:71], v[28:31], v[152:155], 0
  v_mul_f32 v90, v12, v90
  v_mul_f32 v91, v12, v91
  v_mfma_f32_16x16x32_bf16 v[76:79], v[28:31], v[184:187], 0
  s_add_u32 m0, s29, 99328
  s_add_u32 s27, s28, 1589248
  buffer_load_dwordx4 v15, s[60:63], s27 offen lds
  v_mfma_f32_16x16x32_bf16 v[84:87], v[28:31], v[216:219], 0
  s_waitcnt lgkmcnt(5)
  v_mul_f32 v92, v12, v92
  v_mfma_f32_16x16x32_bf16 v[56:59], v[32:35], v[124:127], v[56:59]
  ds_read_b128 v[24:27], v248 offset:33024
  v_mul_f32 v93, v12, v93
  v_mfma_f32_16x16x32_bf16 v[64:67], v[32:35], v[156:159], v[64:67]
  v_mul_f32 v94, v12, v94
  v_mul_f32 v95, v12, v95
  v_mfma_f32_16x16x32_bf16 v[72:75], v[32:35], v[188:191], v[72:75]
  s_add_u32 m0, s29, 100352
  s_add_u32 s27, s28, 1605632
  buffer_load_dwordx4 v14, s[60:63], s27 offen lds
  v_mfma_f32_16x16x32_bf16 v[80:83], v[32:35], v[220:223], v[80:83]
  s_waitcnt lgkmcnt(5)
  v_cvt_pk_bf16_f32 v88, v88, v89
  v_mfma_f32_16x16x32_bf16 v[60:63], v[36:39], v[124:127], v[60:63]
  ds_read_b128 v[28:31], v248 offset:35072
  v_cvt_pk_bf16_f32 v89, v90, v91
  v_mfma_f32_16x16x32_bf16 v[68:71], v[36:39], v[156:159], v[68:71]
  v_cvt_pk_bf16_f32 v90, v92, v93
  v_cvt_pk_bf16_f32 v91, v94, v95
  v_mfma_f32_16x16x32_bf16 v[76:79], v[36:39], v[188:191], v[76:79]
  s_add_u32 m0, s29, 101376
  s_add_u32 s27, s28, 1622016
  buffer_load_dwordx4 v15, s[60:63], s27 offen lds
  v_mfma_f32_16x16x32_bf16 v[84:87], v[36:39], v[220:223], v[84:87]
  s_waitcnt lgkmcnt(5)
  v_accvgpr_write_b32 a4, v88
  v_mfma_f32_16x16x32_bf16 v[56:59], v[40:43], v[128:131], v[56:59]
  ds_read_b128 v[32:35], v249 offset:33024
  v_accvgpr_write_b32 a5, v89
  v_mfma_f32_16x16x32_bf16 v[64:67], v[40:43], v[160:163], v[64:67]
  v_accvgpr_write_b32 a6, v90
  v_accvgpr_write_b32 a7, v91
  v_mfma_f32_16x16x32_bf16 v[72:75], v[40:43], v[192:195], v[72:75]
  s_add_u32 m0, s29, 114688
  s_add_u32 s27, s28, 1835008
  buffer_load_dwordx4 v14, s[60:63], s27 offen lds
  v_mfma_f32_16x16x32_bf16 v[80:83], v[40:43], v[224:227], v[80:83]
  s_waitcnt lgkmcnt(5)
  v_mul_f32 v96, v12, v96
  v_mfma_f32_16x16x32_bf16 v[60:63], v[44:47], v[128:131], v[60:63]
  ds_read_b128 v[36:39], v249 offset:35072
  v_mul_f32 v97, v12, v97
  v_mfma_f32_16x16x32_bf16 v[68:71], v[44:47], v[160:163], v[68:71]
  v_mul_f32 v98, v12, v98
  v_mul_f32 v99, v12, v99
  v_mfma_f32_16x16x32_bf16 v[76:79], v[44:47], v[192:195], v[76:79]
  s_add_u32 m0, s29, 115712
  s_add_u32 s27, s28, 1851392
  buffer_load_dwordx4 v15, s[60:63], s27 offen lds
  v_mfma_f32_16x16x32_bf16 v[84:87], v[44:47], v[224:227], v[84:87]
  s_waitcnt lgkmcnt(5)
  v_mul_f32 v100, v12, v100
  v_mfma_f32_16x16x32_bf16 v[56:59], v[48:51], v[132:135], v[56:59]
  ds_read_b128 v[40:43], v250 offset:33024
  v_mul_f32 v101, v12, v101
  v_mfma_f32_16x16x32_bf16 v[64:67], v[48:51], v[164:167], v[64:67]
  v_mul_f32 v102, v12, v102
  v_mul_f32 v103, v12, v103
  v_mfma_f32_16x16x32_bf16 v[72:75], v[48:51], v[196:199], v[72:75]
  s_add_u32 m0, s29, 116736
  s_add_u32 s27, s28, 1867776
  buffer_load_dwordx4 v14, s[60:63], s27 offen lds
  v_mfma_f32_16x16x32_bf16 v[80:83], v[48:51], v[228:231], v[80:83]
  s_waitcnt lgkmcnt(5)
  v_cvt_pk_bf16_f32 v96, v96, v97
  v_mfma_f32_16x16x32_bf16 v[60:63], v[52:55], v[132:135], v[60:63]
  ds_read_b128 v[44:47], v250 offset:35072
  v_cvt_pk_bf16_f32 v97, v98, v99
  v_mfma_f32_16x16x32_bf16 v[68:71], v[52:55], v[164:167], v[68:71]
  v_cvt_pk_bf16_f32 v98, v100, v101
  v_cvt_pk_bf16_f32 v99, v102, v103
  v_mfma_f32_16x16x32_bf16 v[76:79], v[52:55], v[196:199], v[76:79]
  s_add_u32 m0, s29, 117760
  s_add_u32 s27, s28, 1884160
  buffer_load_dwordx4 v15, s[60:63], s27 offen lds
  v_mfma_f32_16x16x32_bf16 v[84:87], v[52:55], v[228:231], v[84:87]
  s_waitcnt lgkmcnt(5)
  v_accvgpr_write_b32 a60, v96
  v_mfma_f32_16x16x32_bf16 v[56:59], v[24:27], v[136:139], v[56:59]
  ds_read_b128 v[48:51], v251 offset:33024
  v_accvgpr_write_b32 a61, v97
  v_mfma_f32_16x16x32_bf16 v[64:67], v[24:27], v[168:171], v[64:67]
  v_accvgpr_write_b32 a62, v98
  v_accvgpr_write_b32 a63, v99
  v_mfma_f32_16x16x32_bf16 v[72:75], v[24:27], v[200:203], v[72:75]
  v_mul_f32 v104, v12, v104
  v_mfma_f32_16x16x32_bf16 v[80:83], v[24:27], v[232:235], v[80:83]
  s_waitcnt lgkmcnt(5)
  v_mul_f32 v105, v12, v105
  v_mfma_f32_16x16x32_bf16 v[60:63], v[28:31], v[136:139], v[60:63]
  ds_read_b128 v[52:55], v251 offset:35072
  v_mul_f32 v106, v12, v106
  v_mfma_f32_16x16x32_bf16 v[68:71], v[28:31], v[168:171], v[68:71]
  v_mul_f32 v107, v12, v107
  v_mul_f32 v108, v12, v108
  v_mfma_f32_16x16x32_bf16 v[76:79], v[28:31], v[200:203], v[76:79]
  v_mul_f32 v109, v12, v109
  v_mfma_f32_16x16x32_bf16 v[84:87], v[28:31], v[232:235], v[84:87]
  s_waitcnt lgkmcnt(5)
  v_mul_f32 v110, v12, v110
  v_mfma_f32_16x16x32_bf16 v[56:59], v[32:35], v[140:143], v[56:59]
  s_waitcnt vmcnt(16)
  s_barrier
  ds_read_b128 v[24:27], v248 offset:49152
  v_mul_f32 v111, v12, v111
  v_mfma_f32_16x16x32_bf16 v[64:67], v[32:35], v[172:175], v[64:67]
  v_cvt_pk_bf16_f32 v104, v104, v105
  v_cvt_pk_bf16_f32 v105, v106, v107
  v_mfma_f32_16x16x32_bf16 v[72:75], v[32:35], v[204:207], v[72:75]
  v_cvt_pk_bf16_f32 v106, v108, v109
  v_mfma_f32_16x16x32_bf16 v[80:83], v[32:35], v[236:239], v[80:83]
  s_waitcnt lgkmcnt(5)
  v_cvt_pk_bf16_f32 v107, v110, v111
  v_mfma_f32_16x16x32_bf16 v[60:63], v[36:39], v[140:143], v[60:63]
  ds_read_b128 v[28:31], v248 offset:51200
  v_accvgpr_write_b32 a116, v104
  v_mfma_f32_16x16x32_bf16 v[68:71], v[36:39], v[172:175], v[68:71]
  v_accvgpr_write_b32 a117, v105
  v_accvgpr_write_b32 a118, v106
  v_mfma_f32_16x16x32_bf16 v[76:79], v[36:39], v[204:207], v[76:79]
  v_accvgpr_write_b32 a119, v107
  v_mfma_f32_16x16x32_bf16 v[84:87], v[36:39], v[236:239], v[84:87]
  s_waitcnt lgkmcnt(5)
  v_mul_f32 v112, v12, v112
  v_mfma_f32_16x16x32_bf16 v[56:59], v[40:43], v[144:147], v[56:59]
  ds_read_b128 v[32:35], v249 offset:49152
  v_mul_f32 v113, v12, v113
  v_mfma_f32_16x16x32_bf16 v[64:67], v[40:43], v[176:179], v[64:67]
  v_mul_f32 v114, v12, v114
  v_mul_f32 v115, v12, v115
  v_mfma_f32_16x16x32_bf16 v[72:75], v[40:43], v[208:211], v[72:75]
  v_mul_f32 v116, v12, v116
  v_mfma_f32_16x16x32_bf16 v[80:83], v[40:43], v[240:243], v[80:83]
  s_waitcnt lgkmcnt(5)
  v_mul_f32 v117, v12, v117
  v_mfma_f32_16x16x32_bf16 v[60:63], v[44:47], v[144:147], v[60:63]
  ds_read_b128 v[36:39], v249 offset:51200
  v_mul_f32 v118, v12, v118
  v_mfma_f32_16x16x32_bf16 v[68:71], v[44:47], v[176:179], v[68:71]
  v_mul_f32 v119, v12, v119
  v_cvt_pk_bf16_f32 v112, v112, v113
  v_mfma_f32_16x16x32_bf16 v[76:79], v[44:47], v[208:211], v[76:79]
  v_cvt_pk_bf16_f32 v113, v114, v115
  v_mfma_f32_16x16x32_bf16 v[84:87], v[44:47], v[240:243], v[84:87]
  s_waitcnt lgkmcnt(5)
  v_cvt_pk_bf16_f32 v114, v116, v117
  v_mfma_f32_16x16x32_bf16 v[56:59], v[48:51], v[148:151], v[56:59]
  ds_read_b128 v[40:43], v250 offset:49152
  v_cvt_pk_bf16_f32 v115, v118, v119
  v_mfma_f32_16x16x32_bf16 v[64:67], v[48:51], v[180:183], v[64:67]
  v_accvgpr_write_b32 a172, v112
  v_accvgpr_write_b32 a173, v113
  v_mfma_f32_16x16x32_bf16 v[72:75], v[48:51], v[212:215], v[72:75]
  v_accvgpr_write_b32 a174, v114
  v_mfma_f32_16x16x32_bf16 v[80:83], v[48:51], v[244:247], v[80:83]
  s_waitcnt lgkmcnt(5)
  v_accvgpr_write_b32 a175, v115
  v_mfma_f32_16x16x32_bf16 v[60:63], v[52:55], v[148:151], v[60:63]
  ds_read_b128 v[44:47], v250 offset:51200
  v_mfma_f32_16x16x32_bf16 v[68:71], v[52:55], v[180:183], v[68:71]
  v_mfma_f32_16x16x32_bf16 v[76:79], v[52:55], v[212:215], v[76:79]
  v_mfma_f32_16x16x32_bf16 v[84:87], v[52:55], v[244:247], v[84:87]
  s_waitcnt lgkmcnt(5)
  s_getpc_b64 s[98:99]
  s_add_u32 s98, s98, 4096
  s_addc_u32 s99, s99, 0
  global_load_dword v7, v6, s[98:99]
  v_mfma_f32_16x16x32_bf16 v[88:91], v[24:27], v[120:123], 0
  ds_read_b128 v[48:51], v251 offset:49152
  v_mfma_f32_16x16x32_bf16 v[96:99], v[24:27], v[152:155], 0
  v_mfma_f32_16x16x32_bf16 v[104:107], v[24:27], v[184:187], 0
  s_add_u32 m0, s29, 131072
  s_add_u32 s27, s28, 2097152
  buffer_load_dwordx4 v14, s[60:63], s27 offen lds
  v_mfma_f32_16x16x32_bf16 v[112:115], v[24:27], v[216:219], 0
  s_waitcnt lgkmcnt(5)
  v_mul_f32 v56, v12, v56
  v_mfma_f32_16x16x32_bf16 v[92:95], v[28:31], v[120:123], 0
  ds_read_b128 v[52:55], v251 offset:51200
  v_mul_f32 v57, v12, v57
  v_mfma_f32_16x16x32_bf16 v[100:103], v[28:31], v[152:155], 0
  v_mul_f32 v58, v12, v58
  v_mul_f32 v59, v12, v59
  v_mfma_f32_16x16x32_bf16 v[108:111], v[28:31], v[184:187], 0
  s_add_u32 m0, s29, 132096
  s_add_u32 s27, s28, 2113536
  buffer_load_dwordx4 v15, s[60:63], s27 offen lds
  v_mfma_f32_16x16x32_bf16 v[116:119], v[28:31], v[216:219], 0
  s_waitcnt lgkmcnt(5)
  v_mul_f32 v60, v12, v60
  v_mfma_f32_16x16x32_bf16 v[88:91], v[32:35], v[124:127], v[88:91]
  ds_read_b128 v[24:27], v248 offset:49408
  v_mul_f32 v61, v12, v61
  v_mfma_f32_16x16x32_bf16 v[96:99], v[32:35], v[156:159], v[96:99]
  v_mul_f32 v62, v12, v62
  v_mul_f32 v63, v12, v63
  v_mfma_f32_16x16x32_bf16 v[104:107], v[32:35], v[188:191], v[104:107]
  s_add_u32 m0, s29, 133120
  s_add_u32 s27, s28, 2129920
  buffer_load_dwordx4 v14, s[60:63], s27 offen lds
  v_mfma_f32_16x16x32_bf16 v[112:115], v[32:35], v[220:223], v[112:115]
  s_waitcnt lgkmcnt(5)
  v_cvt_pk_bf16_f32 v56, v56, v57
  v_mfma_f32_16x16x32_bf16 v[92:95], v[36:39], v[124:127], v[92:95]
  ds_read_b128 v[28:31], v248 offset:51456
  v_cvt_pk_bf16_f32 v57, v58, v59
  v_mfma_f32_16x16x32_bf16 v[100:103], v[36:39], v[156:159], v[100:103]
  v_cvt_pk_bf16_f32 v58, v60, v61
  v_cvt_pk_bf16_f32 v59, v62, v63
  v_mfma_f32_16x16x32_bf16 v[108:111], v[36:39], v[188:191], v[108:111]
  s_add_u32 m0, s29, 134144
  s_add_u32 s27, s28, 2146304
  buffer_load_dwordx4 v15, s[60:63], s27 offen lds
  v_mfma_f32_16x16x32_bf16 v[116:119], v[36:39], v[220:223], v[116:119]
  s_waitcnt lgkmcnt(5)
  v_accvgpr_write_b32 a8, v56
  v_mfma_f32_16x16x32_bf16 v[88:91], v[40:43], v[128:131], v[88:91]
  ds_read_b128 v[32:35], v249 offset:49408
  v_accvgpr_write_b32 a9, v57
  v_mfma_f32_16x16x32_bf16 v[96:99], v[40:43], v[160:163], v[96:99]
  v_accvgpr_write_b32 a10, v58
  v_accvgpr_write_b32 a11, v59
  v_mfma_f32_16x16x32_bf16 v[104:107], v[40:43], v[192:195], v[104:107]
  s_add_u32 m0, s29, 147456
  s_add_u32 s27, s28, 2359296
  buffer_load_dwordx4 v14, s[60:63], s27 offen lds
  v_mfma_f32_16x16x32_bf16 v[112:115], v[40:43], v[224:227], v[112:115]
  s_waitcnt lgkmcnt(5)
  v_mul_f32 v64, v12, v64
  v_mfma_f32_16x16x32_bf16 v[92:95], v[44:47], v[128:131], v[92:95]
  ds_read_b128 v[36:39], v249 offset:51456
  v_mul_f32 v65, v12, v65
  v_mfma_f32_16x16x32_bf16 v[100:103], v[44:47], v[160:163], v[100:103]
  v_mul_f32 v66, v12, v66
  v_mul_f32 v67, v12, v67
  v_mfma_f32_16x16x32_bf16 v[108:111], v[44:47], v[192:195], v[108:111]
  s_add_u32 m0, s29, 148480
  s_add_u32 s27, s28, 2375680
  buffer_load_dwordx4 v15, s[60:63], s27 offen lds
  v_mfma_f32_16x16x32_bf16 v[116:119], v[44:47], v[224:227], v[116:119]
  s_waitcnt lgkmcnt(5)
  v_mul_f32 v68, v12, v68
  v_mfma_f32_16x16x32_bf16 v[88:91], v[48:51], v[132:135], v[88:91]
  ds_read_b128 v[40:43], v250 offset:49408
  v_mul_f32 v69, v12, v69
  v_mfma_f32_16x16x32_bf16 v[96:99], v[48:51], v[164:167], v[96:99]
  v_mul_f32 v70, v12, v70
  v_mul_f32 v71, v12, v71
  v_mfma_f32_16x16x32_bf16 v[104:107], v[48:51], v[196:199], v[104:107]
  s_add_u32 m0, s29, 149504
  s_add_u32 s27, s28, 2392064
  buffer_load_dwordx4 v14, s[60:63], s27 offen lds
  v_mfma_f32_16x16x32_bf16 v[112:115], v[48:51], v[228:231], v[112:115]
  s_waitcnt lgkmcnt(5)
  v_cvt_pk_bf16_f32 v64, v64, v65
  v_mfma_f32_16x16x32_bf16 v[92:95], v[52:55], v[132:135], v[92:95]
  ds_read_b128 v[44:47], v250 offset:51456
  v_cvt_pk_bf16_f32 v65, v66, v67
  v_mfma_f32_16x16x32_bf16 v[100:103], v[52:55], v[164:167], v[100:103]
  v_cvt_pk_bf16_f32 v66, v68, v69
  v_cvt_pk_bf16_f32 v67, v70, v71
  v_mfma_f32_16x16x32_bf16 v[108:111], v[52:55], v[196:199], v[108:111]
  s_add_u32 m0, s29, 150528
  s_add_u32 s27, s28, 2408448
  buffer_load_dwordx4 v15, s[60:63], s27 offen lds
  v_mfma_f32_16x16x32_bf16 v[116:119], v[52:55], v[228:231], v[116:119]
  s_waitcnt lgkmcnt(5)
  v_accvgpr_write_b32 a64, v64
  v_mfma_f32_16x16x32_bf16 v[88:91], v[24:27], v[136:139], v[88:91]
  ds_read_b128 v[48:51], v251 offset:49408
  v_accvgpr_write_b32 a65, v65
  v_mfma_f32_16x16x32_bf16 v[96:99], v[24:27], v[168:171], v[96:99]
  v_accvgpr_write_b32 a66, v66
  v_accvgpr_write_b32 a67, v67
  v_mfma_f32_16x16x32_bf16 v[104:107], v[24:27], v[200:203], v[104:107]
  v_mul_f32 v72, v12, v72
  v_mfma_f32_16x16x32_bf16 v[112:115], v[24:27], v[232:235], v[112:115]
  s_waitcnt lgkmcnt(5)
  v_mul_f32 v73, v12, v73
  v_mfma_f32_16x16x32_bf16 v[92:95], v[28:31], v[136:139], v[92:95]
  ds_read_b128 v[52:55], v251 offset:51456
  v_mul_f32 v74, v12, v74
  v_mfma_f32_16x16x32_bf16 v[100:103], v[28:31], v[168:171], v[100:103]
  v_mul_f32 v75, v12, v75
  v_mul_f32 v76, v12, v76
  v_mfma_f32_16x16x32_bf16 v[108:111], v[28:31], v[200:203], v[108:111]
  v_mul_f32 v77, v12, v77
  v_mfma_f32_16x16x32_bf16 v[116:119], v[28:31], v[232:235], v[116:119]
  s_waitcnt lgkmcnt(5)
  v_mul_f32 v78, v12, v78
  v_mfma_f32_16x16x32_bf16 v[88:91], v[32:35], v[140:143], v[88:91]
  s_waitcnt vmcnt(20)
  s_barrier
  ds_read_b128 v[24:27], v252 offset:0
  v_mul_f32 v79, v12, v79
  v_mfma_f32_16x16x32_bf16 v[96:99], v[32:35], v[172:175], v[96:99]
  v_cvt_pk_bf16_f32 v72, v72, v73
  v_cvt_pk_bf16_f32 v73, v74, v75
  v_mfma_f32_16x16x32_bf16 v[104:107], v[32:35], v[204:207], v[104:107]
  v_cvt_pk_bf16_f32 v74, v76, v77
  v_mfma_f32_16x16x32_bf16 v[112:115], v[32:35], v[236:239], v[112:115]
  s_waitcnt lgkmcnt(5)
  v_cvt_pk_bf16_f32 v75, v78, v79
  v_mfma_f32_16x16x32_bf16 v[92:95], v[36:39], v[140:143], v[92:95]
  ds_read_b128 v[28:31], v252 offset:2048
  v_accvgpr_write_b32 a120, v72
  v_mfma_f32_16x16x32_bf16 v[100:103], v[36:39], v[172:175], v[100:103]
  v_accvgpr_write_b32 a121, v73
  v_accvgpr_write_b32 a122, v74
  v_mfma_f32_16x16x32_bf16 v[108:111], v[36:39], v[204:207], v[108:111]
  v_accvgpr_write_b32 a123, v75
  v_mfma_f32_16x16x32_bf16 v[116:119], v[36:39], v[236:239], v[116:119]
  s_waitcnt lgkmcnt(5)
  v_mul_f32 v80, v12, v80
  v_mfma_f32_16x16x32_bf16 v[88:91], v[40:43], v[144:147], v[88:91]
  ds_read_b128 v[32:35], v253 offset:0
  v_mul_f32 v81, v12, v81
  v_mfma_f32_16x16x32_bf16 v[96:99], v[40:43], v[176:179], v[96:99]
  v_mul_f32 v82, v12, v82
  v_mul_f32 v83, v12, v83
  v_mfma_f32_16x16x32_bf16 v[104:107], v[40:43], v[208:211], v[104:107]
  v_mul_f32 v84, v12, v84
  v_mfma_f32_16x16x32_bf16 v[112:115], v[40:43], v[240:243], v[112:115]
  s_waitcnt lgkmcnt(5)
  v_mul_f32 v85, v12, v85
  v_mfma_f32_16x16x32_bf16 v[92:95], v[44:47], v[144:147], v[92:95]
  ds_read_b128 v[36:39], v253 offset:2048
  v_mul_f32 v86, v12, v86
  v_mfma_f32_16x16x32_bf16 v[100:103], v[44:47], v[176:179], v[100:103]
  v_mul_f32 v87, v12, v87
  v_cvt_pk_bf16_f32 v80, v80, v81
  v_mfma_f32_16x16x32_bf16 v[108:111], v[44:47], v[208:211], v[108:111]
  v_cvt_pk_bf16_f32 v81, v82, v83
  v_mfma_f32_16x16x32_bf16 v[116:119], v[44:47], v[240:243], v[116:119]
  s_waitcnt lgkmcnt(5)
  v_cvt_pk_bf16_f32 v82, v84, v85
  v_mfma_f32_16x16x32_bf16 v[88:91], v[48:51], v[148:151], v[88:91]
  ds_read_b128 v[40:43], v254 offset:0
  v_cvt_pk_bf16_f32 v83, v86, v87
  v_mfma_f32_16x16x32_bf16 v[96:99], v[48:51], v[180:183], v[96:99]
  v_accvgpr_write_b32 a176, v80
  v_accvgpr_write_b32 a177, v81
  v_mfma_f32_16x16x32_bf16 v[104:107], v[48:51], v[212:215], v[104:107]
  v_accvgpr_write_b32 a178, v82
  v_mfma_f32_16x16x32_bf16 v[112:115], v[48:51], v[244:247], v[112:115]
  s_waitcnt lgkmcnt(5)
  v_accvgpr_write_b32 a179, v83
  v_mfma_f32_16x16x32_bf16 v[92:95], v[52:55], v[148:151], v[92:95]
  ds_read_b128 v[44:47], v254 offset:2048
  v_mfma_f32_16x16x32_bf16 v[100:103], v[52:55], v[180:183], v[100:103]
  v_mfma_f32_16x16x32_bf16 v[108:111], v[52:55], v[212:215], v[108:111]
  v_mfma_f32_16x16x32_bf16 v[116:119], v[52:55], v[244:247], v[116:119]
  s_waitcnt lgkmcnt(5)
  v_mfma_f32_16x16x32_bf16 v[56:59], v[24:27], v[120:123], 0
  ds_read_b128 v[48:51], v255 offset:0
  v_mfma_f32_16x16x32_bf16 v[64:67], v[24:27], v[152:155], 0
  v_mfma_f32_16x16x32_bf16 v[72:75], v[24:27], v[184:187], 0
  s_add_u32 m0, s29, 0
  s_add_u32 s27, s28, 2621440
  buffer_load_dwordx4 v14, s[60:63], s27 offen lds
  v_mfma_f32_16x16x32_bf16 v[80:83], v[24:27], v[216:219], 0
  s_waitcnt lgkmcnt(5)
  v_mul_f32 v88, v12, v88
  v_mfma_f32_16x16x32_bf16 v[60:63], v[28:31], v[120:123], 0
  ds_read_b128 v[52:55], v255 offset:2048
  v_mul_f32 v89, v12, v89
  v_mfma_f32_16x16x32_bf16 v[68:71], v[28:31], v[152:155], 0
  v_mul_f32 v90, v12, v90
  v_mul_f32 v91, v12, v91
  v_mfma_f32_16x16x32_bf16 v[76:79], v[28:31], v[184:187], 0
  v_mul_f32 v92, v12, v92
  v_mfma_f32_16x16x32_bf16 v[84:87], v[28:31], v[216:219], 0
  s_waitcnt lgkmcnt(5)
  v_mul_f32 v93, v12, v93
  v_mfma_f32_16x16x32_bf16 v[56:59], v[32:35], v[124:127], v[56:59]
  ds_read_b128 v[24:27], v252 offset:256
  v_mul_f32 v94, v12, v94
  v_mfma_f32_16x16x32_bf16 v[64:67], v[32:35], v[156:159], v[64:67]
  v_mul_f32 v95, v12, v95
  v_cvt_pk_bf16_f32 v88, v88, v89
  v_mfma_f32_16x16x32_bf16 v[72:75], v[32:35], v[188:191], v[72:75]
  s_add_u32 m0, s29, 1024
  s_add_u32 s27, s28, 2637824
  buffer_load_dwordx4 v15, s[60:63], s27 offen lds
  v_mfma_f32_16x16x32_bf16 v[80:83], v[32:35], v[220:223], v[80:83]
  s_waitcnt lgkmcnt(5)
  v_cvt_pk_bf16_f32 v89, v90, v91
  v_mfma_f32_16x16x32_bf16 v[60:63], v[36:39], v[124:127], v[60:63]
  ds_read_b128 v[28:31], v252 offset:2304
  v_cvt_pk_bf16_f32 v90, v92, v93
  v_mfma_f32_16x16x32_bf16 v[68:71], v[36:39], v[156:159], v[68:71]
  v_cvt_pk_bf16_f32 v91, v94, v95
  v_accvgpr_write_b32 a12, v88
  v_mfma_f32_16x16x32_bf16 v[76:79], v[36:39], v[188:191], v[76:79]
  v_accvgpr_write_b32 a13, v89
  v_mfma_f32_16x16x32_bf16 v[84:87], v[36:39], v[220:223], v[84:87]
  s_waitcnt lgkmcnt(5)
  v_accvgpr_write_b32 a14, v90
  v_mfma_f32_16x16x32_bf16 v[56:59], v[40:43], v[128:131], v[56:59]
  ds_read_b128 v[32:35], v253 offset:256
  v_accvgpr_write_b32 a15, v91
  v_mfma_f32_16x16x32_bf16 v[64:67], v[40:43], v[160:163], v[64:67]
  v_mul_f32 v96, v12, v96
  v_mul_f32 v97, v12, v97
  v_mfma_f32_16x16x32_bf16 v[72:75], v[40:43], v[192:195], v[72:75]
  s_add_u32 m0, s29, 2048
  s_add_u32 s27, s28, 2654208
  buffer_load_dwordx4 v14, s[60:63], s27 offen lds
  v_mfma_f32_16x16x32_bf16 v[80:83], v[40:43], v[224:227], v[80:83]
  s_waitcnt lgkmcnt(5)
  v_mul_f32 v98, v12, v98
  v_mfma_f32_16x16x32_bf16 v[60:63], v[44:47], v[128:131], v[60:63]
  ds_read_b128 v[36:39], v253 offset:2304
  v_mul_f32 v99, v12, v99
  v_mfma_f32_16x16x32_bf16 v[68:71], v[44:47], v[160:163], v[68:71]
  v_mul_f32 v100, v12, v100
  v_mul_f32 v101, v12, v101
  v_mfma_f32_16x16x32_bf16 v[76:79], v[44:47], v[192:195], v[76:79]
  v_mul_f32 v102, v12, v102
  v_mfma_f32_16x16x32_bf16 v[84:87], v[44:47], v[224:227], v[84:87]
  s_waitcnt lgkmcnt(5)
  v_mul_f32 v103, v12, v103
  v_mfma_f32_16x16x32_bf16 v[56:59], v[48:51], v[132:135], v[56:59]
  ds_read_b128 v[40:43], v254 offset:256
  v_cvt_pk_bf16_f32 v96, v96, v97
  v_mfma_f32_16x16x32_bf16 v[64:67], v[48:51], v[164:167], v[64:67]
  v_cvt_pk_bf16_f32 v97, v98, v99
  v_cvt_pk_bf16_f32 v98, v100, v101
  v_mfma_f32_16x16x32_bf16 v[72:75], v[48:51], v[196:199], v[72:75]
  s_add_u32 m0, s29, 3072
  s_add_u32 s27, s28, 2670592
  buffer_load_dwordx4 v15, s[60:63], s27 offen lds
  v_mfma_f32_16x16x32_bf16 v[80:83], v[48:51], v[228:231], v[80:83]
  s_waitcnt lgkmcnt(5)
  v_cvt_pk_bf16_f32 v99, v102, v103
  v_mfma_f32_16x16x32_bf16 v[60:63], v[52:55], v[132:135], v[60:63]
  ds_read_b128 v[44:47], v254 offset:2304
  v_accvgpr_write_b32 a68, v96
  v_mfma_f32_16x16x32_bf16 v[68:71], v[52:55], v[164:167], v[68:71]
  v_accvgpr_write_b32 a69, v97
  v_accvgpr_write_b32 a70, v98
  v_mfma_f32_16x16x32_bf16 v[76:79], v[52:55], v[196:199], v[76:79]
  v_accvgpr_write_b32 a71, v99
  v_mfma_f32_16x16x32_bf16 v[84:87], v[52:55], v[228:231], v[84:87]
  s_waitcnt lgkmcnt(5)
  v_mul_f32 v104, v12, v104
  v_mfma_f32_16x16x32_bf16 v[56:59], v[24:27], v[136:139], v[56:59]
  ds_read_b128 v[48:51], v255 offset:256
  v_mul_f32 v105, v12, v105
  v_mfma_f32_16x16x32_bf16 v[64:67], v[24:27], v[168:171], v[64:67]
  v_mul_f32 v106, v12, v106
  v_mul_f32 v107, v12, v107
  v_mfma_f32_16x16x32_bf16 v[72:75], v[24:27], v[200:203], v[72:75]
  v_mul_f32 v108, v12, v108
  v_mfma_f32_16x16x32_bf16 v[80:83], v[24:27], v[232:235], v[80:83]
  s_waitcnt lgkmcnt(5)
  v_mul_f32 v109, v12, v109
  v_mfma_f32_16x16x32_bf16 v[60:63], v[28:31], v[136:139], v[60:63]
  ds_read_b128 v[52:55], v255 offset:2304
  v_mul_f32 v110, v12, v110
  v_mfma_f32_16x16x32_bf16 v[68:71], v[28:31], v[168:171], v[68:71]
  v_mul_f32 v111, v12, v111
  v_cvt_pk_bf16_f32 v104, v104, v105
  v_mfma_f32_16x16x32_bf16 v[76:79], v[28:31], v[200:203], v[76:79]
  v_cvt_pk_bf16_f32 v105, v106, v107
  v_mfma_f32_16x16x32_bf16 v[84:87], v[28:31], v[232:235], v[84:87]
  s_waitcnt lgkmcnt(5)
  v_cvt_pk_bf16_f32 v106, v108, v109
  v_mfma_f32_16x16x32_bf16 v[56:59], v[32:35], v[140:143], v[56:59]
  s_waitcnt vmcnt(20)
  s_barrier
  ds_read_b128 v[24:27], v252 offset:16384
  v_cvt_pk_bf16_f32 v107, v110, v111
  v_mfma_f32_16x16x32_bf16 v[64:67], v[32:35], v[172:175], v[64:67]
  v_accvgpr_write_b32 a124, v104
  v_accvgpr_write_b32 a125, v105
  v_mfma_f32_16x16x32_bf16 v[72:75], v[32:35], v[204:207], v[72:75]
  v_accvgpr_write_b32 a126, v106
  v_mfma_f32_16x16x32_bf16 v[80:83], v[32:35], v[236:239], v[80:83]
  s_waitcnt lgkmcnt(5)
  v_accvgpr_write_b32 a127, v107
  v_mfma_f32_16x16x32_bf16 v[60:63], v[36:39], v[140:143], v[60:63]
  ds_read_b128 v[28:31], v252 offset:18432
  v_mul_f32 v112, v12, v112
  v_mfma_f32_16x16x32_bf16 v[68:71], v[36:39], v[172:175], v[68:71]
  v_mul_f32 v113, v12, v113
  v_mul_f32 v114, v12, v114
  v_mfma_f32_16x16x32_bf16 v[76:79], v[36:39], v[204:207], v[76:79]
  v_mul_f32 v115, v12, v115
  v_mfma_f32_16x16x32_bf16 v[84:87], v[36:39], v[236:239], v[84:87]
  s_waitcnt lgkmcnt(5)
  v_mul_f32 v116, v12, v116
  v_mfma_f32_16x16x32_bf16 v[56:59], v[40:43], v[144:147], v[56:59]
  ds_read_b128 v[32:35], v253 offset:16384
  v_mul_f32 v117, v12, v117
  v_mfma_f32_16x16x32_bf16 v[64:67], v[40:43], v[176:179], v[64:67]
  v_mul_f32 v118, v12, v118
  v_mul_f32 v119, v12, v119
  v_mfma_f32_16x16x32_bf16 v[72:75], v[40:43], v[208:211], v[72:75]
  v_cvt_pk_bf16_f32 v112, v112, v113
  v_mfma_f32_16x16x32_bf16 v[80:83], v[40:43], v[240:243], v[80:83]
  s_waitcnt lgkmcnt(5)
  v_cvt_pk_bf16_f32 v113, v114, v115
  v_mfma_f32_16x16x32_bf16 v[60:63], v[44:47], v[144:147], v[60:63]
  ds_read_b128 v[36:39], v253 offset:18432
  v_cvt_pk_bf16_f32 v114, v116, v117
  v_mfma_f32_16x16x32_bf16 v[68:71], v[44:47], v[176:179], v[68:71]
  v_cvt_pk_bf16_f32 v115, v118, v119
  v_accvgpr_write_b32 a180, v112
  v_mfma_f32_16x16x32_bf16 v[76:79], v[44:47], v[208:211], v[76:79]
  v_accvgpr_write_b32 a181, v113
  v_mfma_f32_16x16x32_bf16 v[84:87], v[44:47], v[240:243], v[84:87]
  s_waitcnt lgkmcnt(5)
  v_accvgpr_write_b32 a182, v114
  v_mfma_f32_16x16x32_bf16 v[56:59], v[48:51], v[148:151], v[56:59]
  ds_read_b128 v[40:43], v254 offset:16384
  v_accvgpr_write_b32 a183, v115
  v_mfma_f32_16x16x32_bf16 v[64:67], v[48:51], v[180:183], v[64:67]
  v_mfma_f32_16x16x32_bf16 v[72:75], v[48:51], v[212:215], v[72:75]
  v_mfma_f32_16x16x32_bf16 v[80:83], v[48:51], v[244:247], v[80:83]
  s_waitcnt lgkmcnt(5)
  v_mfma_f32_16x16x32_bf16 v[60:63], v[52:55], v[148:151], v[60:63]
  ds_read_b128 v[44:47], v254 offset:18432
  v_mfma_f32_16x16x32_bf16 v[68:71], v[52:55], v[180:183], v[68:71]
  v_mfma_f32_16x16x32_bf16 v[76:79], v[52:55], v[212:215], v[76:79]
  v_mfma_f32_16x16x32_bf16 v[84:87], v[52:55], v[244:247], v[84:87]
  s_waitcnt lgkmcnt(5)
  v_mfma_f32_16x16x32_bf16 v[88:91], v[24:27], v[120:123], 0
  ds_read_b128 v[48:51], v255 offset:16384
  v_mfma_f32_16x16x32_bf16 v[96:99], v[24:27], v[152:155], 0
  v_mfma_f32_16x16x32_bf16 v[104:107], v[24:27], v[184:187], 0
  s_add_u32 m0, s29, 16384
  s_add_u32 s27, s28, 2883584
  buffer_load_dwordx4 v14, s[60:63], s27 offen lds
  v_mfma_f32_16x16x32_bf16 v[112:115], v[24:27], v[216:219], 0
  s_waitcnt lgkmcnt(5)
  v_mul_f32 v56, v12, v56
  v_mfma_f32_16x16x32_bf16 v[92:95], v[28:31], v[120:123], 0
  ds_read_b128 v[52:55], v255 offset:18432
  v_mul_f32 v57, v12, v57
  v_mfma_f32_16x16x32_bf16 v[100:103], v[28:31], v[152:155], 0
  v_mul_f32 v58, v12, v58
  v_mul_f32 v59, v12, v59
  v_mfma_f32_16x16x32_bf16 v[108:111], v[28:31], v[184:187], 0
  v_mul_f32 v60, v12, v60
  v_mfma_f32_16x16x32_bf16 v[116:119], v[28:31], v[216:219], 0
  s_waitcnt lgkmcnt(5)
  v_mul_f32 v61, v12, v61
  v_mfma_f32_16x16x32_bf16 v[88:91], v[32:35], v[124:127], v[88:91]
  ds_read_b128 v[24:27], v252 offset:16640
  v_mul_f32 v62, v12, v62
  v_mfma_f32_16x16x32_bf16 v[96:99], v[32:35], v[156:159], v[96:99]
  v_mul_f32 v63, v12, v63
  v_cvt_pk_bf16_f32 v56, v56, v57
  v_mfma_f32_16x16x32_bf16 v[104:107], v[32:35], v[188:191], v[104:107]
  s_add_u32 m0, s29, 17408
  s_add_u32 s27, s28, 2899968
  buffer_load_dwordx4 v15, s[60:63], s27 offen lds
  v_mfma_f32_16x16x32_bf16 v[112:115], v[32:35], v[220:223], v[112:115]
  s_waitcnt lgkmcnt(5)
  v_cvt_pk_bf16_f32 v57, v58, v59
  v_mfma_f32_16x16x32_bf16 v[92:95], v[36:39], v[124:127], v[92:95]
  ds_read_b128 v[28:31], v252 offset:18688
  v_cvt_pk_bf16_f32 v58, v60, v61
  v_mfma_f32_16x16x32_bf16 v[100:103], v[36:39], v[156:159], v[100:103]
  v_cvt_pk_bf16_f32 v59, v62, v63
  v_accvgpr_write_b32 a16, v56
  v_mfma_f32_16x16x32_bf16 v[108:111], v[36:39], v[188:191], v[108:111]
  v_accvgpr_write_b32 a17, v57
  v_mfma_f32_16x16x32_bf16 v[116:119], v[36:39], v[220:223], v[116:119]
  s_waitcnt lgkmcnt(5)
  v_accvgpr_write_b32 a18, v58
  v_mfma_f32_16x16x32_bf16 v[88:91], v[40:43], v[128:131], v[88:91]
  ds_read_b128 v[32:35], v253 offset:16640
  v_accvgpr_write_b32 a19, v59
  v_mfma_f32_16x16x32_bf16 v[96:99], v[40:43], v[160:163], v[96:99]
  v_mul_f32 v64, v12, v64
  v_mul_f32 v65, v12, v65
  v_mfma_f32_16x16x32_bf16 v[104:107], v[40:43], v[192:195], v[104:107]
  s_add_u32 m0, s29, 18432
  s_add_u32 s27, s28, 2916352
  buffer_load_dwordx4 v14, s[60:63], s27 offen lds
  v_mfma_f32_16x16x32_bf16 v[112:115], v[40:43], v[224:227], v[112:115]
  s_waitcnt lgkmcnt(5)
  v_mul_f32 v66, v12, v66
  v_mfma_f32_16x16x32_bf16 v[92:95], v[44:47], v[128:131], v[92:95]
  ds_read_b128 v[36:39], v253 offset:18688
  v_mul_f32 v67, v12, v67
  v_mfma_f32_16x16x32_bf16 v[100:103], v[44:47], v[160:163], v[100:103]
  v_mul_f32 v68, v12, v68
  v_mul_f32 v69, v12, v69
  v_mfma_f32_16x16x32_bf16 v[108:111], v[44:47], v[192:195], v[108:111]
  v_mul_f32 v70, v12, v70
  v_mfma_f32_16x16x32_bf16 v[116:119], v[44:47], v[224:227], v[116:119]
  s_waitcnt lgkmcnt(5)
  v_mul_f32 v71, v12, v71
  v_mfma_f32_16x16x32_bf16 v[88:91], v[48:51], v[132:135], v[88:91]
  ds_read_b128 v[40:43], v254 offset:16640
  v_cvt_pk_bf16_f32 v64, v64, v65
  v_mfma_f32_16x16x32_bf16 v[96:99], v[48:51], v[164:167], v[96:99]
  v_cvt_pk_bf16_f32 v65, v66, v67
  v_cvt_pk_bf16_f32 v66, v68, v69
  v_mfma_f32_16x16x32_bf16 v[104:107], v[48:51], v[196:199], v[104:107]
  s_add_u32 m0, s29, 19456
  s_add_u32 s27, s28, 2932736
  buffer_load_dwordx4 v15, s[60:63], s27 offen lds
  v_mfma_f32_16x16x32_bf16 v[112:115], v[48:51], v[228:231], v[112:115]
  s_waitcnt lgkmcnt(5)
  v_cvt_pk_bf16_f32 v67, v70, v71
  v_mfma_f32_16x16x32_bf16 v[92:95], v[52:55], v[132:135], v[92:95]
  ds_read_b128 v[44:47], v254 offset:18688
  v_accvgpr_write_b32 a72, v64
  v_mfma_f32_16x16x32_bf16 v[100:103], v[52:55], v[164:167], v[100:103]
  v_accvgpr_write_b32 a73, v65
  v_accvgpr_write_b32 a74, v66
  v_mfma_f32_16x16x32_bf16 v[108:111], v[52:55], v[196:199], v[108:111]
  v_accvgpr_write_b32 a75, v67
  v_mfma_f32_16x16x32_bf16 v[116:119], v[52:55], v[228:231], v[116:119]
  s_waitcnt lgkmcnt(5)
  v_mul_f32 v72, v12, v72
  v_mfma_f32_16x16x32_bf16 v[88:91], v[24:27], v[136:139], v[88:91]
  ds_read_b128 v[48:51], v255 offset:16640
  v_mul_f32 v73, v12, v73
  v_mfma_f32_16x16x32_bf16 v[96:99], v[24:27], v[168:171], v[96:99]
  v_mul_f32 v74, v12, v74
  v_mul_f32 v75, v12, v75
  v_mfma_f32_16x16x32_bf16 v[104:107], v[24:27], v[200:203], v[104:107]
  v_mul_f32 v76, v12, v76
  v_mfma_f32_16x16x32_bf16 v[112:115], v[24:27], v[232:235], v[112:115]
  s_waitcnt lgkmcnt(5)
  v_mul_f32 v77, v12, v77
  v_mfma_f32_16x16x32_bf16 v[92:95], v[28:31], v[136:139], v[92:95]
  ds_read_b128 v[52:55], v255 offset:18688
  v_mul_f32 v78, v12, v78
  v_mfma_f32_16x16x32_bf16 v[100:103], v[28:31], v[168:171], v[100:103]
  v_mul_f32 v79, v12, v79
  v_cvt_pk_bf16_f32 v72, v72, v73
  v_mfma_f32_16x16x32_bf16 v[108:111], v[28:31], v[200:203], v[108:111]
  v_cvt_pk_bf16_f32 v73, v74, v75
  v_mfma_f32_16x16x32_bf16 v[116:119], v[28:31], v[232:235], v[116:119]
  s_waitcnt lgkmcnt(5)
  v_cvt_pk_bf16_f32 v74, v76, v77
  v_mfma_f32_16x16x32_bf16 v[88:91], v[32:35], v[140:143], v[88:91]
  s_waitcnt vmcnt(20)
  s_barrier
  ds_read_b128 v[24:27], v252 offset:32768
  v_cvt_pk_bf16_f32 v75, v78, v79
  v_mfma_f32_16x16x32_bf16 v[96:99], v[32:35], v[172:175], v[96:99]
  v_accvgpr_write_b32 a128, v72
  v_accvgpr_write_b32 a129, v73
  v_mfma_f32_16x16x32_bf16 v[104:107], v[32:35], v[204:207], v[104:107]
  v_accvgpr_write_b32 a130, v74
  v_mfma_f32_16x16x32_bf16 v[112:115], v[32:35], v[236:239], v[112:115]
  s_waitcnt lgkmcnt(5)
  v_accvgpr_write_b32 a131, v75
  v_mfma_f32_16x16x32_bf16 v[92:95], v[36:39], v[140:143], v[92:95]
  ds_read_b128 v[28:31], v252 offset:34816
  v_mul_f32 v80, v12, v80
  v_mfma_f32_16x16x32_bf16 v[100:103], v[36:39], v[172:175], v[100:103]
  v_mul_f32 v81, v12, v81
  v_mul_f32 v82, v12, v82
  v_mfma_f32_16x16x32_bf16 v[108:111], v[36:39], v[204:207], v[108:111]
  v_mul_f32 v83, v12, v83
  v_mfma_f32_16x16x32_bf16 v[116:119], v[36:39], v[236:239], v[116:119]
  s_waitcnt lgkmcnt(5)
  v_mul_f32 v84, v12, v84
  v_mfma_f32_16x16x32_bf16 v[88:91], v[40:43], v[144:147], v[88:91]
  ds_read_b128 v[32:35], v253 offset:32768
  v_mul_f32 v85, v12, v85
  v_mfma_f32_16x16x32_bf16 v[96:99], v[40:43], v[176:179], v[96:99]
  v_mul_f32 v86, v12, v86
  v_mul_f32 v87, v12, v87
  v_mfma_f32_16x16x32_bf16 v[104:107], v[40:43], v[208:211], v[104:107]
  v_cvt_pk_bf16_f32 v80, v80, v81
  v_mfma_f32_16x16x32_bf16 v[112:115], v[40:43], v[240:243], v[112:115]
  s_waitcnt lgkmcnt(5)
  v_cvt_pk_bf16_f32 v81, v82, v83
  v_mfma_f32_16x16x32_bf16 v[92:95], v[44:47], v[144:147], v[92:95]
  ds_read_b128 v[36:39], v253 offset:34816
  v_cvt_pk_bf16_f32 v82, v84, v85
  v_mfma_f32_16x16x32_bf16 v[100:103], v[44:47], v[176:179], v[100:103]
  v_cvt_pk_bf16_f32 v83, v86, v87
  v_accvgpr_write_b32 a184, v80
  v_mfma_f32_16x16x32_bf16 v[108:111], v[44:47], v[208:211], v[108:111]
  v_accvgpr_write_b32 a185, v81
  v_mfma_f32_16x16x32_bf16 v[116:119], v[44:47], v[240:243], v[116:119]
  s_waitcnt lgkmcnt(5)
  v_accvgpr_write_b32 a186, v82
  v_mfma_f32_16x16x32_bf16 v[88:91], v[48:51], v[148:151], v[88:91]
  ds_read_b128 v[40:43], v254 offset:32768
  v_accvgpr_write_b32 a187, v83
  v_mfma_f32_16x16x32_bf16 v[96:99], v[48:51], v[180:183], v[96:99]
  v_mfma_f32_16x16x32_bf16 v[104:107], v[48:51], v[212:215], v[104:107]
  v_mfma_f32_16x16x32_bf16 v[112:115], v[48:51], v[244:247], v[112:115]
  s_waitcnt lgkmcnt(5)
  v_mfma_f32_16x16x32_bf16 v[92:95], v[52:55], v[148:151], v[92:95]
  ds_read_b128 v[44:47], v254 offset:34816
  v_mfma_f32_16x16x32_bf16 v[100:103], v[52:55], v[180:183], v[100:103]
  v_mfma_f32_16x16x32_bf16 v[108:111], v[52:55], v[212:215], v[108:111]
  v_mfma_f32_16x16x32_bf16 v[116:119], v[52:55], v[244:247], v[116:119]
  s_waitcnt lgkmcnt(5)
  s_getpc_b64 s[98:99]
  s_add_u32 s98, s98, 4096
  s_addc_u32 s99, s99, 0
  global_load_dword v7, v6, s[98:99]
  v_mfma_f32_16x16x32_bf16 v[56:59], v[24:27], v[120:123], 0
  ds_read_b128 v[48:51], v255 offset:32768
  v_mfma_f32_16x16x32_bf16 v[64:67], v[24:27], v[152:155], 0
  v_mfma_f32_16x16x32_bf16 v[72:75], v[24:27], v[184:187], 0
  s_add_u32 m0, s29, 32768
  s_add_u32 s27, s28, 3145728
  buffer_load_dwordx4 v14, s[60:63], s27 offen lds
  v_mfma_f32_16x16x32_bf16 v[80:83], v[24:27], v[216:219], 0
  s_waitcnt lgkmcnt(5)
  v_mul_f32 v88, v12, v88
  v_mfma_f32_16x16x32_bf16 v[60:63], v[28:31], v[120:123], 0
  ds_read_b128 v[52:55], v255 offset:34816
  v_mul_f32 v89, v12, v89
  v_mfma_f32_16x16x32_bf16 v[68:71], v[28:31], v[152:155], 0
  v_mul_f32 v90, v12, v90
  v_mul_f32 v91, v12, v91
  v_mfma_f32_16x16x32_bf16 v[76:79], v[28:31], v[184:187], 0
  v_mul_f32 v92, v12, v92
  v_mfma_f32_16x16x32_bf16 v[84:87], v[28:31], v[216:219], 0
  s_waitcnt lgkmcnt(5)
  v_mul_f32 v93, v12, v93
  v_mfma_f32_16x16x32_bf16 v[56:59], v[32:35], v[124:127], v[56:59]
  ds_read_b128 v[24:27], v252 offset:33024
  v_mul_f32 v94, v12, v94
  v_mfma_f32_16x16x32_bf16 v[64:67], v[32:35], v[156:159], v[64:67]
  v_mul_f32 v95, v12, v95
  v_cvt_pk_bf16_f32 v88, v88, v89
  v_mfma_f32_16x16x32_bf16 v[72:75], v[32:35], v[188:191], v[72:75]
  s_add_u32 m0, s29, 33792
  s_add_u32 s27, s28, 3162112
  buffer_load_dwordx4 v15, s[60:63], s27 offen lds
  v_mfma_f32_16x16x32_bf16 v[80:83], v[32:35], v[220:223], v[80:83]
  s_waitcnt lgkmcnt(5)
  v_cvt_pk_bf16_f32 v89, v90, v91
  v_mfma_f32_16x16x32_bf16 v[60:63], v[36:39], v[124:127], v[60:63]
  ds_read_b128 v[28:31], v252 offset:35072
  v_cvt_pk_bf16_f32 v90, v92, v93
  v_mfma_f32_16x16x32_bf16 v[68:71], v[36:39], v[156:159], v[68:71]
  v_cvt_pk_bf16_f32 v91, v94, v95
  v_accvgpr_write_b32 a20, v88
  v_mfma_f32_16x16x32_bf16 v[76:79], v[36:39], v[188:191], v[76:79]
  v_accvgpr_write_b32 a21, v89
  v_mfma_f32_16x16x32_bf16 v[84:87], v[36:39], v[220:223], v[84:87]
  s_waitcnt lgkmcnt(5)
  v_accvgpr_write_b32 a22, v90
  v_mfma_f32_16x16x32_bf16 v[56:59], v[40:43], v[128:131], v[56:59]
  ds_read_b128 v[32:35], v253 offset:33024
  v_accvgpr_write_b32 a23, v91
  v_mfma_f32_16x16x32_bf16 v[64:67], v[40:43], v[160:163], v[64:67]
  v_mul_f32 v96, v12, v96
  v_mul_f32 v97, v12, v97
  v_mfma_f32_16x16x32_bf16 v[72:75], v[40:43], v[192:195], v[72:75]
  s_add_u32 m0, s29, 34816
  s_add_u32 s27, s28, 3178496
  buffer_load_dwordx4 v14, s[60:63], s27 offen lds
  v_mfma_f32_16x16x32_bf16 v[80:83], v[40:43], v[224:227], v[80:83]
  s_waitcnt lgkmcnt(5)
  v_mul_f32 v98, v12, v98
  v_mfma_f32_16x16x32_bf16 v[60:63], v[44:47], v[128:131], v[60:63]
  ds_read_b128 v[36:39], v253 offset:35072
  v_mul_f32 v99, v12, v99
  v_mfma_f32_16x16x32_bf16 v[68:71], v[44:47], v[160:163], v[68:71]
  v_mul_f32 v100, v12, v100
  v_mul_f32 v101, v12, v101
  v_mfma_f32_16x16x32_bf16 v[76:79], v[44:47], v[192:195], v[76:79]
  v_mul_f32 v102, v12, v102
  v_mfma_f32_16x16x32_bf16 v[84:87], v[44:47], v[224:227], v[84:87]
  s_waitcnt lgkmcnt(5)
  v_mul_f32 v103, v12, v103
  v_mfma_f32_16x16x32_bf16 v[56:59], v[48:51], v[132:135], v[56:59]
  ds_read_b128 v[40:43], v254 offset:33024
  v_cvt_pk_bf16_f32 v96, v96, v97
  v_mfma_f32_16x16x32_bf16 v[64:67], v[48:51], v[164:167], v[64:67]
  v_cvt_pk_bf16_f32 v97, v98, v99
  v_cvt_pk_bf16_f32 v98, v100, v101
  v_mfma_f32_16x16x32_bf16 v[72:75], v[48:51], v[196:199], v[72:75]
  s_add_u32 m0, s29, 35840
  s_add_u32 s27, s28, 3194880
  buffer_load_dwordx4 v15, s[60:63], s27 offen lds
  v_mfma_f32_16x16x32_bf16 v[80:83], v[48:51], v[228:231], v[80:83]
  s_waitcnt lgkmcnt(5)
  v_cvt_pk_bf16_f32 v99, v102, v103
  v_mfma_f32_16x16x32_bf16 v[60:63], v[52:55], v[132:135], v[60:63]
  ds_read_b128 v[44:47], v254 offset:35072
  v_accvgpr_write_b32 a76, v96
  v_mfma_f32_16x16x32_bf16 v[68:71], v[52:55], v[164:167], v[68:71]
  v_accvgpr_write_b32 a77, v97
  v_accvgpr_write_b32 a78, v98
  v_mfma_f32_16x16x32_bf16 v[76:79], v[52:55], v[196:199], v[76:79]
  v_accvgpr_write_b32 a79, v99
  v_mfma_f32_16x16x32_bf16 v[84:87], v[52:55], v[228:231], v[84:87]
  s_waitcnt lgkmcnt(5)
  v_mul_f32 v104, v12, v104
  v_mfma_f32_16x16x32_bf16 v[56:59], v[24:27], v[136:139], v[56:59]
  ds_read_b128 v[48:51], v255 offset:33024
  v_mul_f32 v105, v12, v105
  v_mfma_f32_16x16x32_bf16 v[64:67], v[24:27], v[168:171], v[64:67]
  v_mul_f32 v106, v12, v106
  v_mul_f32 v107, v12, v107
  v_mfma_f32_16x16x32_bf16 v[72:75], v[24:27], v[200:203], v[72:75]
  v_mul_f32 v108, v12, v108
  v_mfma_f32_16x16x32_bf16 v[80:83], v[24:27], v[232:235], v[80:83]
  s_waitcnt lgkmcnt(5)
  v_mul_f32 v109, v12, v109
  v_mfma_f32_16x16x32_bf16 v[60:63], v[28:31], v[136:139], v[60:63]
  ds_read_b128 v[52:55], v255 offset:35072
  v_mul_f32 v110, v12, v110
  v_mfma_f32_16x16x32_bf16 v[68:71], v[28:31], v[168:171], v[68:71]
  v_mul_f32 v111, v12, v111
  v_cvt_pk_bf16_f32 v104, v104, v105
  v_mfma_f32_16x16x32_bf16 v[76:79], v[28:31], v[200:203], v[76:79]
  v_cvt_pk_bf16_f32 v105, v106, v107
  v_mfma_f32_16x16x32_bf16 v[84:87], v[28:31], v[232:235], v[84:87]
  s_waitcnt lgkmcnt(5)
  v_cvt_pk_bf16_f32 v106, v108, v109
  v_mfma_f32_16x16x32_bf16 v[56:59], v[32:35], v[140:143], v[56:59]
  s_waitcnt vmcnt(20)
  s_barrier
  ds_read_b128 v[24:27], v252 offset:49152
  v_cvt_pk_bf16_f32 v107, v110, v111
  v_mfma_f32_16x16x32_bf16 v[64:67], v[32:35], v[172:175], v[64:67]
  v_accvgpr_write_b32 a132, v104
  v_accvgpr_write_b32 a133, v105
  v_mfma_f32_16x16x32_bf16 v[72:75], v[32:35], v[204:207], v[72:75]
  v_accvgpr_write_b32 a134, v106
  v_mfma_f32_16x16x32_bf16 v[80:83], v[32:35], v[236:239], v[80:83]
  s_waitcnt lgkmcnt(5)
  v_accvgpr_write_b32 a135, v107
  v_mfma_f32_16x16x32_bf16 v[60:63], v[36:39], v[140:143], v[60:63]
  ds_read_b128 v[28:31], v252 offset:51200
  v_mul_f32 v112, v12, v112
  v_mfma_f32_16x16x32_bf16 v[68:71], v[36:39], v[172:175], v[68:71]
  v_mul_f32 v113, v12, v113
  v_mul_f32 v114, v12, v114
  v_mfma_f32_16x16x32_bf16 v[76:79], v[36:39], v[204:207], v[76:79]
  v_mul_f32 v115, v12, v115
  v_mfma_f32_16x16x32_bf16 v[84:87], v[36:39], v[236:239], v[84:87]
  s_waitcnt lgkmcnt(5)
  v_mul_f32 v116, v12, v116
  v_mfma_f32_16x16x32_bf16 v[56:59], v[40:43], v[144:147], v[56:59]
  ds_read_b128 v[32:35], v253 offset:49152
  v_mul_f32 v117, v12, v117
  v_mfma_f32_16x16x32_bf16 v[64:67], v[40:43], v[176:179], v[64:67]
  v_mul_f32 v118, v12, v118
  v_mul_f32 v119, v12, v119
  v_mfma_f32_16x16x32_bf16 v[72:75], v[40:43], v[208:211], v[72:75]
  v_cvt_pk_bf16_f32 v112, v112, v113
  v_mfma_f32_16x16x32_bf16 v[80:83], v[40:43], v[240:243], v[80:83]
  s_waitcnt lgkmcnt(5)
  v_cvt_pk_bf16_f32 v113, v114, v115
  v_mfma_f32_16x16x32_bf16 v[60:63], v[44:47], v[144:147], v[60:63]
  ds_read_b128 v[36:39], v253 offset:51200
  v_cvt_pk_bf16_f32 v114, v116, v117
  v_mfma_f32_16x16x32_bf16 v[68:71], v[44:47], v[176:179], v[68:71]
  v_cvt_pk_bf16_f32 v115, v118, v119
  v_accvgpr_write_b32 a188, v112
  v_mfma_f32_16x16x32_bf16 v[76:79], v[44:47], v[208:211], v[76:79]
  v_accvgpr_write_b32 a189, v113
  v_mfma_f32_16x16x32_bf16 v[84:87], v[44:47], v[240:243], v[84:87]
  s_waitcnt lgkmcnt(5)
  v_accvgpr_write_b32 a190, v114
  v_mfma_f32_16x16x32_bf16 v[56:59], v[48:51], v[148:151], v[56:59]
  ds_read_b128 v[40:43], v254 offset:49152
  v_accvgpr_write_b32 a191, v115
  v_mfma_f32_16x16x32_bf16 v[64:67], v[48:51], v[180:183], v[64:67]
  v_mfma_f32_16x16x32_bf16 v[72:75], v[48:51], v[212:215], v[72:75]
  v_mfma_f32_16x16x32_bf16 v[80:83], v[48:51], v[244:247], v[80:83]
  s_waitcnt lgkmcnt(5)
  v_mfma_f32_16x16x32_bf16 v[60:63], v[52:55], v[148:151], v[60:63]
  ds_read_b128 v[44:47], v254 offset:51200
  v_mfma_f32_16x16x32_bf16 v[68:71], v[52:55], v[180:183], v[68:71]
  v_mfma_f32_16x16x32_bf16 v[76:79], v[52:55], v[212:215], v[76:79]
  v_mfma_f32_16x16x32_bf16 v[84:87], v[52:55], v[244:247], v[84:87]
  s_waitcnt lgkmcnt(5)
  v_mfma_f32_16x16x32_bf16 v[88:91], v[24:27], v[120:123], 0
  ds_read_b128 v[48:51], v255 offset:49152
  v_mfma_f32_16x16x32_bf16 v[96:99], v[24:27], v[152:155], 0
  v_mfma_f32_16x16x32_bf16 v[104:107], v[24:27], v[184:187], 0
  buffer_load_dword v13, off, s[12:15], 0 offset:128 sc1
  buffer_load_dword v9, off, s[12:15], 0 sc1
  s_add_u32 m0, s29, 49152
  s_add_u32 s27, s28, 3407872
  buffer_load_dwordx4 v14, s[60:63], s27 offen lds
  v_mfma_f32_16x16x32_bf16 v[112:115], v[24:27], v[216:219], 0
  s_waitcnt lgkmcnt(5)
  v_mul_f32 v56, v12, v56
  v_mfma_f32_16x16x32_bf16 v[92:95], v[28:31], v[120:123], 0
  ds_read_b128 v[52:55], v255 offset:51200
  v_mul_f32 v57, v12, v57
  v_mfma_f32_16x16x32_bf16 v[100:103], v[28:31], v[152:155], 0
  v_mul_f32 v58, v12, v58
  v_mul_f32 v59, v12, v59
  v_mfma_f32_16x16x32_bf16 v[108:111], v[28:31], v[184:187], 0
  v_mul_f32 v60, v12, v60
  v_mfma_f32_16x16x32_bf16 v[116:119], v[28:31], v[216:219], 0
  s_waitcnt lgkmcnt(5)
  v_mul_f32 v61, v12, v61
  v_mfma_f32_16x16x32_bf16 v[88:91], v[32:35], v[124:127], v[88:91]
  ds_read_b128 v[24:27], v252 offset:49408
  v_mul_f32 v62, v12, v62
  v_mfma_f32_16x16x32_bf16 v[96:99], v[32:35], v[156:159], v[96:99]
  v_mul_f32 v63, v12, v63
  v_cvt_pk_bf16_f32 v56, v56, v57
  v_mfma_f32_16x16x32_bf16 v[104:107], v[32:35], v[188:191], v[104:107]
  s_add_u32 m0, s29, 50176
  s_add_u32 s27, s28, 3424256
  buffer_load_dwordx4 v15, s[60:63], s27 offen lds
  v_mfma_f32_16x16x32_bf16 v[112:115], v[32:35], v[220:223], v[112:115]
  s_waitcnt lgkmcnt(5)
  v_cvt_pk_bf16_f32 v57, v58, v59
  v_mfma_f32_16x16x32_bf16 v[92:95], v[36:39], v[124:127], v[92:95]
  ds_read_b128 v[28:31], v252 offset:51456
  v_cvt_pk_bf16_f32 v58, v60, v61
  v_mfma_f32_16x16x32_bf16 v[100:103], v[36:39], v[156:159], v[100:103]
  v_cvt_pk_bf16_f32 v59, v62, v63
  v_accvgpr_write_b32 a24, v56
  v_mfma_f32_16x16x32_bf16 v[108:111], v[36:39], v[188:191], v[108:111]
  v_accvgpr_write_b32 a25, v57
  v_mfma_f32_16x16x32_bf16 v[116:119], v[36:39], v[220:223], v[116:119]
  s_waitcnt lgkmcnt(5)
  v_accvgpr_write_b32 a26, v58
  v_mfma_f32_16x16x32_bf16 v[88:91], v[40:43], v[128:131], v[88:91]
  ds_read_b128 v[32:35], v253 offset:49408
  v_accvgpr_write_b32 a27, v59
  v_mfma_f32_16x16x32_bf16 v[96:99], v[40:43], v[160:163], v[96:99]
  v_mul_f32 v64, v12, v64
  v_mul_f32 v65, v12, v65
  v_mfma_f32_16x16x32_bf16 v[104:107], v[40:43], v[192:195], v[104:107]
  s_add_u32 m0, s29, 51200
  s_add_u32 s27, s28, 3440640
  buffer_load_dwordx4 v14, s[60:63], s27 offen lds
  v_mfma_f32_16x16x32_bf16 v[112:115], v[40:43], v[224:227], v[112:115]
  s_waitcnt lgkmcnt(5)
  v_mul_f32 v66, v12, v66
  v_mfma_f32_16x16x32_bf16 v[92:95], v[44:47], v[128:131], v[92:95]
  ds_read_b128 v[36:39], v253 offset:51456
  v_mul_f32 v67, v12, v67
  v_mfma_f32_16x16x32_bf16 v[100:103], v[44:47], v[160:163], v[100:103]
  v_mul_f32 v68, v12, v68
  v_mul_f32 v69, v12, v69
  v_mfma_f32_16x16x32_bf16 v[108:111], v[44:47], v[192:195], v[108:111]
  v_mul_f32 v70, v12, v70
  v_mfma_f32_16x16x32_bf16 v[116:119], v[44:47], v[224:227], v[116:119]
  s_waitcnt lgkmcnt(5)
  v_mul_f32 v71, v12, v71
  v_mfma_f32_16x16x32_bf16 v[88:91], v[48:51], v[132:135], v[88:91]
  ds_read_b128 v[40:43], v254 offset:49408
  v_cvt_pk_bf16_f32 v64, v64, v65
  v_mfma_f32_16x16x32_bf16 v[96:99], v[48:51], v[164:167], v[96:99]
  v_cvt_pk_bf16_f32 v65, v66, v67
  v_cvt_pk_bf16_f32 v66, v68, v69
  v_mfma_f32_16x16x32_bf16 v[104:107], v[48:51], v[196:199], v[104:107]
  s_add_u32 m0, s29, 52224
  s_add_u32 s27, s28, 3457024
  buffer_load_dwordx4 v15, s[60:63], s27 offen lds
  v_mfma_f32_16x16x32_bf16 v[112:115], v[48:51], v[228:231], v[112:115]
  s_waitcnt lgkmcnt(5)
  v_cvt_pk_bf16_f32 v67, v70, v71
  v_mfma_f32_16x16x32_bf16 v[92:95], v[52:55], v[132:135], v[92:95]
  ds_read_b128 v[44:47], v254 offset:51456
  v_accvgpr_write_b32 a80, v64
  v_mfma_f32_16x16x32_bf16 v[100:103], v[52:55], v[164:167], v[100:103]
  v_accvgpr_write_b32 a81, v65
  v_accvgpr_write_b32 a82, v66
  v_mfma_f32_16x16x32_bf16 v[108:111], v[52:55], v[196:199], v[108:111]
  v_accvgpr_write_b32 a83, v67
  v_mfma_f32_16x16x32_bf16 v[116:119], v[52:55], v[228:231], v[116:119]
  s_waitcnt lgkmcnt(5)
  v_mul_f32 v72, v12, v72
  v_mfma_f32_16x16x32_bf16 v[88:91], v[24:27], v[136:139], v[88:91]
  ds_read_b128 v[48:51], v255 offset:49408
  v_mul_f32 v73, v12, v73
  v_mfma_f32_16x16x32_bf16 v[96:99], v[24:27], v[168:171], v[96:99]
  v_mul_f32 v74, v12, v74
  v_mul_f32 v75, v12, v75
  v_mfma_f32_16x16x32_bf16 v[104:107], v[24:27], v[200:203], v[104:107]
  v_mul_f32 v76, v12, v76
  v_mfma_f32_16x16x32_bf16 v[112:115], v[24:27], v[232:235], v[112:115]
  s_waitcnt lgkmcnt(5)
  v_mul_f32 v77, v12, v77
  v_mfma_f32_16x16x32_bf16 v[92:95], v[28:31], v[136:139], v[92:95]
  ds_read_b128 v[52:55], v255 offset:51456
  v_mul_f32 v78, v12, v78
  v_mfma_f32_16x16x32_bf16 v[100:103], v[28:31], v[168:171], v[100:103]
  v_mul_f32 v79, v12, v79
  v_cvt_pk_bf16_f32 v72, v72, v73
  v_mfma_f32_16x16x32_bf16 v[108:111], v[28:31], v[200:203], v[108:111]
  v_cvt_pk_bf16_f32 v73, v74, v75
  v_mfma_f32_16x16x32_bf16 v[116:119], v[28:31], v[232:235], v[116:119]
  s_waitcnt lgkmcnt(5)
  v_cvt_pk_bf16_f32 v74, v76, v77
  v_mfma_f32_16x16x32_bf16 v[88:91], v[32:35], v[140:143], v[88:91]
  s_waitcnt vmcnt(20)
  s_barrier
  ds_read_b128 v[24:27], v16 offset:0
  v_cvt_pk_bf16_f32 v75, v78, v79
  v_mfma_f32_16x16x32_bf16 v[96:99], v[32:35], v[172:175], v[96:99]
  v_accvgpr_write_b32 a136, v72
  v_accvgpr_write_b32 a137, v73
  v_mfma_f32_16x16x32_bf16 v[104:107], v[32:35], v[204:207], v[104:107]
  v_accvgpr_write_b32 a138, v74
  v_mfma_f32_16x16x32_bf16 v[112:115], v[32:35], v[236:239], v[112:115]
  s_waitcnt lgkmcnt(5)
  v_accvgpr_write_b32 a139, v75
  v_mfma_f32_16x16x32_bf16 v[92:95], v[36:39], v[140:143], v[92:95]
  ds_read_b128 v[28:31], v16 offset:2048
  v_mul_f32 v80, v12, v80
  v_mfma_f32_16x16x32_bf16 v[100:103], v[36:39], v[172:175], v[100:103]
  v_mul_f32 v81, v12, v81
  v_mul_f32 v82, v12, v82
  v_mfma_f32_16x16x32_bf16 v[108:111], v[36:39], v[204:207], v[108:111]
  v_mul_f32 v83, v12, v83
  v_mfma_f32_16x16x32_bf16 v[116:119], v[36:39], v[236:239], v[116:119]
  s_waitcnt lgkmcnt(5)
  v_mul_f32 v84, v12, v84
  v_mfma_f32_16x16x32_bf16 v[88:91], v[40:43], v[144:147], v[88:91]
  ds_read_b128 v[32:35], v17 offset:0
  v_mul_f32 v85, v12, v85
  v_mfma_f32_16x16x32_bf16 v[96:99], v[40:43], v[176:179], v[96:99]
  v_mul_f32 v86, v12, v86
  v_mul_f32 v87, v12, v87
  v_mfma_f32_16x16x32_bf16 v[104:107], v[40:43], v[208:211], v[104:107]
  v_cvt_pk_bf16_f32 v80, v80, v81
  v_mfma_f32_16x16x32_bf16 v[112:115], v[40:43], v[240:243], v[112:115]
  s_waitcnt lgkmcnt(5)
  v_cvt_pk_bf16_f32 v81, v82, v83
  v_mfma_f32_16x16x32_bf16 v[92:95], v[44:47], v[144:147], v[92:95]
  ds_read_b128 v[36:39], v17 offset:2048
  v_cvt_pk_bf16_f32 v82, v84, v85
  v_mfma_f32_16x16x32_bf16 v[100:103], v[44:47], v[176:179], v[100:103]
  v_cvt_pk_bf16_f32 v83, v86, v87
  v_accvgpr_write_b32 a192, v80
  v_mfma_f32_16x16x32_bf16 v[108:111], v[44:47], v[208:211], v[108:111]
  v_accvgpr_write_b32 a193, v81
  v_mfma_f32_16x16x32_bf16 v[116:119], v[44:47], v[240:243], v[116:119]
  s_waitcnt lgkmcnt(5)
  v_accvgpr_write_b32 a194, v82
  v_mfma_f32_16x16x32_bf16 v[88:91], v[48:51], v[148:151], v[88:91]
  ds_read_b128 v[40:43], v18 offset:0
  v_accvgpr_write_b32 a195, v83
  v_mfma_f32_16x16x32_bf16 v[96:99], v[48:51], v[180:183], v[96:99]
  v_mfma_f32_16x16x32_bf16 v[104:107], v[48:51], v[212:215], v[104:107]
  v_mfma_f32_16x16x32_bf16 v[112:115], v[48:51], v[244:247], v[112:115]
  s_waitcnt lgkmcnt(5)
  v_mfma_f32_16x16x32_bf16 v[92:95], v[52:55], v[148:151], v[92:95]
  ds_read_b128 v[44:47], v18 offset:2048
  v_mfma_f32_16x16x32_bf16 v[100:103], v[52:55], v[180:183], v[100:103]
  v_mfma_f32_16x16x32_bf16 v[108:111], v[52:55], v[212:215], v[108:111]
  v_mfma_f32_16x16x32_bf16 v[116:119], v[52:55], v[244:247], v[116:119]
  s_waitcnt lgkmcnt(5)
  v_mfma_f32_16x16x32_bf16 v[56:59], v[24:27], v[120:123], 0
  ds_read_b128 v[48:51], v19 offset:0
  v_mfma_f32_16x16x32_bf16 v[64:67], v[24:27], v[152:155], 0
  v_mfma_f32_16x16x32_bf16 v[72:75], v[24:27], v[184:187], 0
  v_mfma_f32_16x16x32_bf16 v[80:83], v[24:27], v[216:219], 0
  s_waitcnt lgkmcnt(5)
  v_mul_f32 v88, v12, v88
  v_mfma_f32_16x16x32_bf16 v[60:63], v[28:31], v[120:123], 0
  ds_read_b128 v[52:55], v19 offset:2048
  v_mul_f32 v89, v12, v89
  v_mfma_f32_16x16x32_bf16 v[68:71], v[28:31], v[152:155], 0
  v_mul_f32 v90, v12, v90
  v_mul_f32 v91, v12, v91
  v_mfma_f32_16x16x32_bf16 v[76:79], v[28:31], v[184:187], 0
  v_mul_f32 v92, v12, v92
  v_mfma_f32_16x16x32_bf16 v[84:87], v[28:31], v[216:219], 0
  s_waitcnt lgkmcnt(5)
  v_mul_f32 v93, v12, v93
  v_mfma_f32_16x16x32_bf16 v[56:59], v[32:35], v[124:127], v[56:59]
  ds_read_b128 v[24:27], v16 offset:256
  v_mul_f32 v94, v12, v94
  v_mfma_f32_16x16x32_bf16 v[64:67], v[32:35], v[156:159], v[64:67]
  v_mul_f32 v95, v12, v95
  v_cvt_pk_bf16_f32 v88, v88, v89
  v_mfma_f32_16x16x32_bf16 v[72:75], v[32:35], v[188:191], v[72:75]
  v_cvt_pk_bf16_f32 v89, v90, v91
  v_mfma_f32_16x16x32_bf16 v[80:83], v[32:35], v[220:223], v[80:83]
  s_waitcnt lgkmcnt(5)
  v_cvt_pk_bf16_f32 v90, v92, v93
  v_mfma_f32_16x16x32_bf16 v[60:63], v[36:39], v[124:127], v[60:63]
  ds_read_b128 v[28:31], v16 offset:2304
  v_cvt_pk_bf16_f32 v91, v94, v95
  v_mfma_f32_16x16x32_bf16 v[68:71], v[36:39], v[156:159], v[68:71]
  v_accvgpr_write_b32 a28, v88
  v_accvgpr_write_b32 a29, v89
  v_mfma_f32_16x16x32_bf16 v[76:79], v[36:39], v[188:191], v[76:79]
  v_accvgpr_write_b32 a30, v90
  v_mfma_f32_16x16x32_bf16 v[84:87], v[36:39], v[220:223], v[84:87]
  s_waitcnt lgkmcnt(5)
  v_accvgpr_write_b32 a31, v91
  v_mfma_f32_16x16x32_bf16 v[56:59], v[40:43], v[128:131], v[56:59]
  ds_read_b128 v[32:35], v17 offset:256
  v_mul_f32 v96, v12, v96
  v_mfma_f32_16x16x32_bf16 v[64:67], v[40:43], v[160:163], v[64:67]
  v_mul_f32 v97, v12, v97
  v_mul_f32 v98, v12, v98
  v_mfma_f32_16x16x32_bf16 v[72:75], v[40:43], v[192:195], v[72:75]
  v_mul_f32 v99, v12, v99
  v_mfma_f32_16x16x32_bf16 v[80:83], v[40:43], v[224:227], v[80:83]
  s_waitcnt lgkmcnt(5)
  v_mul_f32 v100, v12, v100
  v_mfma_f32_16x16x32_bf16 v[60:63], v[44:47], v[128:131], v[60:63]
  ds_read_b128 v[36:39], v17 offset:2304
  v_mul_f32 v101, v12, v101
  v_mfma_f32_16x16x32_bf16 v[68:71], v[44:47], v[160:163], v[68:71]
  v_mul_f32 v102, v12, v102
  v_mul_f32 v103, v12, v103
  v_mfma_f32_16x16x32_bf16 v[76:79], v[44:47], v[192:195], v[76:79]
  v_cvt_pk_bf16_f32 v96, v96, v97
  v_mfma_f32_16x16x32_bf16 v[84:87], v[44:47], v[224:227], v[84:87]
  s_waitcnt lgkmcnt(5)
  v_cvt_pk_bf16_f32 v97, v98, v99
  v_mfma_f32_16x16x32_bf16 v[56:59], v[48:51], v[132:135], v[56:59]
  ds_read_b128 v[40:43], v18 offset:256
  v_cvt_pk_bf16_f32 v98, v100, v101
  v_mfma_f32_16x16x32_bf16 v[64:67], v[48:51], v[164:167], v[64:67]
  v_cvt_pk_bf16_f32 v99, v102, v103
  v_accvgpr_write_b32 a84, v96
  v_mfma_f32_16x16x32_bf16 v[72:75], v[48:51], v[196:199], v[72:75]
  v_accvgpr_write_b32 a85, v97
  v_mfma_f32_16x16x32_bf16 v[80:83], v[48:51], v[228:231], v[80:83]
  s_waitcnt lgkmcnt(5)
  v_accvgpr_write_b32 a86, v98
  v_mfma_f32_16x16x32_bf16 v[60:63], v[52:55], v[132:135], v[60:63]
  ds_read_b128 v[44:47], v18 offset:2304
  v_accvgpr_write_b32 a87, v99
  v_mfma_f32_16x16x32_bf16 v[68:71], v[52:55], v[164:167], v[68:71]
  v_mul_f32 v104, v12, v104
  v_mul_f32 v105, v12, v105
  v_mfma_f32_16x16x32_bf16 v[76:79], v[52:55], v[196:199], v[76:79]
  v_mul_f32 v106, v12, v106
  v_mfma_f32_16x16x32_bf16 v[84:87], v[52:55], v[228:231], v[84:87]
  s_waitcnt lgkmcnt(5)
  v_mul_f32 v107, v12, v107
  v_mfma_f32_16x16x32_bf16 v[56:59], v[24:27], v[136:139], v[56:59]
  ds_read_b128 v[48:51], v19 offset:256
  v_mul_f32 v108, v12, v108
  v_mfma_f32_16x16x32_bf16 v[64:67], v[24:27], v[168:171], v[64:67]
  v_mul_f32 v109, v12, v109
  v_mul_f32 v110, v12, v110
  v_mfma_f32_16x16x32_bf16 v[72:75], v[24:27], v[200:203], v[72:75]
  v_mul_f32 v111, v12, v111
  v_mfma_f32_16x16x32_bf16 v[80:83], v[24:27], v[232:235], v[80:83]
  s_waitcnt lgkmcnt(5)
  v_cvt_pk_bf16_f32 v104, v104, v105
  v_mfma_f32_16x16x32_bf16 v[60:63], v[28:31], v[136:139], v[60:63]
  ds_read_b128 v[52:55], v19 offset:2304
  v_cvt_pk_bf16_f32 v105, v106, v107
  v_mfma_f32_16x16x32_bf16 v[68:71], v[28:31], v[168:171], v[68:71]
  v_cvt_pk_bf16_f32 v106, v108, v109
  v_cvt_pk_bf16_f32 v107, v110, v111
  v_mfma_f32_16x16x32_bf16 v[76:79], v[28:31], v[200:203], v[76:79]
  v_accvgpr_write_b32 a140, v104
  v_mfma_f32_16x16x32_bf16 v[84:87], v[28:31], v[232:235], v[84:87]
  s_waitcnt lgkmcnt(5)
  v_accvgpr_write_b32 a141, v105
  v_mfma_f32_16x16x32_bf16 v[56:59], v[32:35], v[140:143], v[56:59]
  s_waitcnt vmcnt(16)
  s_barrier
  ds_read_b128 v[24:27], v16 offset:16384
  v_accvgpr_write_b32 a142, v106
  v_mfma_f32_16x16x32_bf16 v[64:67], v[32:35], v[172:175], v[64:67]
  v_accvgpr_write_b32 a143, v107
  v_mul_f32 v112, v12, v112
  v_mfma_f32_16x16x32_bf16 v[72:75], v[32:35], v[204:207], v[72:75]
  v_mul_f32 v113, v12, v113
  v_mfma_f32_16x16x32_bf16 v[80:83], v[32:35], v[236:239], v[80:83]
  s_waitcnt lgkmcnt(5)
  v_mul_f32 v114, v12, v114
  v_mfma_f32_16x16x32_bf16 v[60:63], v[36:39], v[140:143], v[60:63]
  ds_read_b128 v[28:31], v16 offset:18432
  v_mul_f32 v115, v12, v115
  v_mfma_f32_16x16x32_bf16 v[68:71], v[36:39], v[172:175], v[68:71]
  v_mul_f32 v116, v12, v116
  v_mul_f32 v117, v12, v117
  v_mfma_f32_16x16x32_bf16 v[76:79], v[36:39], v[204:207], v[76:79]
  v_mul_f32 v118, v12, v118
  v_mfma_f32_16x16x32_bf16 v[84:87], v[36:39], v[236:239], v[84:87]
  s_waitcnt lgkmcnt(5)
  v_mul_f32 v119, v12, v119
  v_mfma_f32_16x16x32_bf16 v[56:59], v[40:43], v[144:147], v[56:59]
  ds_read_b128 v[32:35], v17 offset:16384
  v_cvt_pk_bf16_f32 v112, v112, v113
  v_mfma_f32_16x16x32_bf16 v[64:67], v[40:43], v[176:179], v[64:67]
  v_cvt_pk_bf16_f32 v113, v114, v115
  v_cvt_pk_bf16_f32 v114, v116, v117
  v_mfma_f32_16x16x32_bf16 v[72:75], v[40:43], v[208:211], v[72:75]
  v_cvt_pk_bf16_f32 v115, v118, v119
  v_mfma_f32_16x16x32_bf16 v[80:83], v[40:43], v[240:243], v[80:83]
  s_waitcnt lgkmcnt(5)
  v_accvgpr_write_b32 a196, v112
  v_mfma_f32_16x16x32_bf16 v[60:63], v[44:47], v[144:147], v[60:63]
  ds_read_b128 v[36:39], v17 offset:18432
  v_accvgpr_write_b32 a197, v113
  v_mfma_f32_16x16x32_bf16 v[68:71], v[44:47], v[176:179], v[68:71]
  v_accvgpr_write_b32 a198, v114
  v_accvgpr_write_b32 a199, v115
  v_mfma_f32_16x16x32_bf16 v[76:79], v[44:47], v[208:211], v[76:79]
  v_mfma_f32_16x16x32_bf16 v[84:87], v[44:47], v[240:243], v[84:87]
  s_waitcnt lgkmcnt(5)
  v_mfma_f32_16x16x32_bf16 v[56:59], v[48:51], v[148:151], v[56:59]
  ds_read_b128 v[40:43], v18 offset:16384
  v_mfma_f32_16x16x32_bf16 v[64:67], v[48:51], v[180:183], v[64:67]
  v_mfma_f32_16x16x32_bf16 v[72:75], v[48:51], v[212:215], v[72:75]
  v_mfma_f32_16x16x32_bf16 v[80:83], v[48:51], v[244:247], v[80:83]
  s_waitcnt lgkmcnt(5)
  v_mfma_f32_16x16x32_bf16 v[60:63], v[52:55], v[148:151], v[60:63]
  ds_read_b128 v[44:47], v18 offset:18432
  v_mfma_f32_16x16x32_bf16 v[68:71], v[52:55], v[180:183], v[68:71]
  v_mfma_f32_16x16x32_bf16 v[76:79], v[52:55], v[212:215], v[76:79]
  v_mfma_f32_16x16x32_bf16 v[84:87], v[52:55], v[244:247], v[84:87]
  s_waitcnt lgkmcnt(5)
  s_getpc_b64 s[98:99]
  s_add_u32 s98, s98, 4096
  s_addc_u32 s99, s99, 0
  global_load_dword v7, v6, s[98:99]
  v_mfma_f32_16x16x32_bf16 v[88:91], v[24:27], v[120:123], 0
  ds_read_b128 v[48:51], v19 offset:16384
  v_mfma_f32_16x16x32_bf16 v[96:99], v[24:27], v[152:155], 0
  v_mfma_f32_16x16x32_bf16 v[104:107], v[24:27], v[184:187], 0
  v_mfma_f32_16x16x32_bf16 v[112:115], v[24:27], v[216:219], 0
  s_waitcnt lgkmcnt(5)
  v_mul_f32 v56, v12, v56
  v_mfma_f32_16x16x32_bf16 v[92:95], v[28:31], v[120:123], 0
  ds_read_b128 v[52:55], v19 offset:18432
  v_mul_f32 v57, v12, v57
  v_mfma_f32_16x16x32_bf16 v[100:103], v[28:31], v[152:155], 0
  v_mul_f32 v58, v12, v58
  v_mul_f32 v59, v12, v59
  v_mfma_f32_16x16x32_bf16 v[108:111], v[28:31], v[184:187], 0
  v_mul_f32 v60, v12, v60
  v_mfma_f32_16x16x32_bf16 v[116:119], v[28:31], v[216:219], 0
  s_waitcnt lgkmcnt(5)
  v_mul_f32 v61, v12, v61
  v_mfma_f32_16x16x32_bf16 v[88:91], v[32:35], v[124:127], v[88:91]
  ds_read_b128 v[24:27], v16 offset:16640
  v_mul_f32 v62, v12, v62
  v_mfma_f32_16x16x32_bf16 v[96:99], v[32:35], v[156:159], v[96:99]
  v_mul_f32 v63, v12, v63
  v_cvt_pk_bf16_f32 v56, v56, v57
  v_mfma_f32_16x16x32_bf16 v[104:107], v[32:35], v[188:191], v[104:107]
  v_cvt_pk_bf16_f32 v57, v58, v59
  v_mfma_f32_16x16x32_bf16 v[112:115], v[32:35], v[220:223], v[112:115]
  s_waitcnt lgkmcnt(5)
  v_cvt_pk_bf16_f32 v58, v60, v61
  v_mfma_f32_16x16x32_bf16 v[92:95], v[36:39], v[124:127], v[92:95]
  ds_read_b128 v[28:31], v16 offset:18688
  v_cvt_pk_bf16_f32 v59, v62, v63
  v_mfma_f32_16x16x32_bf16 v[100:103], v[36:39], v[156:159], v[100:103]
  v_accvgpr_write_b32 a32, v56
  v_accvgpr_write_b32 a33, v57
  v_mfma_f32_16x16x32_bf16 v[108:111], v[36:39], v[188:191], v[108:111]
  v_accvgpr_write_b32 a34, v58
  v_mfma_f32_16x16x32_bf16 v[116:119], v[36:39], v[220:223], v[116:119]
  s_waitcnt lgkmcnt(5)
  v_accvgpr_write_b32 a35, v59
  v_mfma_f32_16x16x32_bf16 v[88:91], v[40:43], v[128:131], v[88:91]
  ds_read_b128 v[32:35], v17 offset:16640
  v_mul_f32 v64, v12, v64
  v_mfma_f32_16x16x32_bf16 v[96:99], v[40:43], v[160:163], v[96:99]
  v_mul_f32 v65, v12, v65
  v_mul_f32 v66, v12, v66
  v_mfma_f32_16x16x32_bf16 v[104:107], v[40:43], v[192:195], v[104:107]
  v_mul_f32 v67, v12, v67
  v_mfma_f32_16x16x32_bf16 v[112:115], v[40:43], v[224:227], v[112:115]
  s_waitcnt lgkmcnt(5)
  v_mul_f32 v68, v12, v68
  v_mfma_f32_16x16x32_bf16 v[92:95], v[44:47], v[128:131], v[92:95]
  ds_read_b128 v[36:39], v17 offset:18688
  v_mul_f32 v69, v12, v69
  v_mfma_f32_16x16x32_bf16 v[100:103], v[44:47], v[160:163], v[100:103]
  v_mul_f32 v70, v12, v70
  v_mul_f32 v71, v12, v71
  v_mfma_f32_16x16x32_bf16 v[108:111], v[44:47], v[192:195], v[108:111]
  v_cvt_pk_bf16_f32 v64, v64, v65
  v_mfma_f32_16x16x32_bf16 v[116:119], v[44:47], v[224:227], v[116:119]
  s_waitcnt lgkmcnt(5)
  v_cvt_pk_bf16_f32 v65, v66, v67
  v_mfma_f32_16x16x32_bf16 v[88:91], v[48:51], v[132:135], v[88:91]
  ds_read_b128 v[40:43], v18 offset:16640
  v_cvt_pk_bf16_f32 v66, v68, v69
  v_mfma_f32_16x16x32_bf16 v[96:99], v[48:51], v[164:167], v[96:99]
  v_cvt_pk_bf16_f32 v67, v70, v71
  v_accvgpr_write_b32 a88, v64
  v_mfma_f32_16x16x32_bf16 v[104:107], v[48:51], v[196:199], v[104:107]
  v_accvgpr_write_b32 a89, v65
  v_mfma_f32_16x16x32_bf16 v[112:115], v[48:51], v[228:231], v[112:115]
  s_waitcnt lgkmcnt(5)
  v_accvgpr_write_b32 a90, v66
  v_mfma_f32_16x16x32_bf16 v[92:95], v[52:55], v[132:135], v[92:95]
  ds_read_b128 v[44:47], v18 offset:18688
  v_accvgpr_write_b32 a91, v67
  v_mfma_f32_16x16x32_bf16 v[100:103], v[52:55], v[164:167], v[100:103]
  v_mul_f32 v72, v12, v72
  v_mul_f32 v73, v12, v73
  v_mfma_f32_16x16x32_bf16 v[108:111], v[52:55], v[196:199], v[108:111]
  v_mul_f32 v74, v12, v74
  v_mfma_f32_16x16x32_bf16 v[116:119], v[52:55], v[228:231], v[116:119]
  s_waitcnt lgkmcnt(5)
  v_mul_f32 v75, v12, v75
  v_mfma_f32_16x16x32_bf16 v[88:91], v[24:27], v[136:139], v[88:91]
  ds_read_b128 v[48:51], v19 offset:16640
  v_mul_f32 v76, v12, v76
  v_mfma_f32_16x16x32_bf16 v[96:99], v[24:27], v[168:171], v[96:99]
  v_mul_f32 v77, v12, v77
  v_mul_f32 v78, v12, v78
  v_mfma_f32_16x16x32_bf16 v[104:107], v[24:27], v[200:203], v[104:107]
  v_mul_f32 v79, v12, v79
  v_mfma_f32_16x16x32_bf16 v[112:115], v[24:27], v[232:235], v[112:115]
  s_waitcnt lgkmcnt(5)
  v_cvt_pk_bf16_f32 v72, v72, v73
  v_mfma_f32_16x16x32_bf16 v[92:95], v[28:31], v[136:139], v[92:95]
  ds_read_b128 v[52:55], v19 offset:18688
  v_cvt_pk_bf16_f32 v73, v74, v75
  v_mfma_f32_16x16x32_bf16 v[100:103], v[28:31], v[168:171], v[100:103]
  v_cvt_pk_bf16_f32 v74, v76, v77
  v_cvt_pk_bf16_f32 v75, v78, v79
  v_mfma_f32_16x16x32_bf16 v[108:111], v[28:31], v[200:203], v[108:111]
  v_accvgpr_write_b32 a144, v72
  v_mfma_f32_16x16x32_bf16 v[116:119], v[28:31], v[232:235], v[116:119]
  s_waitcnt lgkmcnt(5)
  v_accvgpr_write_b32 a145, v73
  v_mfma_f32_16x16x32_bf16 v[88:91], v[32:35], v[140:143], v[88:91]
  s_waitcnt vmcnt(12)
  s_barrier
  ds_read_b128 v[24:27], v248 offset:0
  v_accvgpr_write_b32 a146, v74
  v_mfma_f32_16x16x32_bf16 v[96:99], v[32:35], v[172:175], v[96:99]
  v_accvgpr_write_b32 a147, v75
  v_mul_f32 v80, v12, v80
  v_mfma_f32_16x16x32_bf16 v[104:107], v[32:35], v[204:207], v[104:107]
  v_mul_f32 v81, v12, v81
  v_mfma_f32_16x16x32_bf16 v[112:115], v[32:35], v[236:239], v[112:115]
  s_waitcnt lgkmcnt(5)
  v_mul_f32 v82, v12, v82
  v_mfma_f32_16x16x32_bf16 v[92:95], v[36:39], v[140:143], v[92:95]
  ds_read_b128 v[28:31], v248 offset:2048
  v_mul_f32 v83, v12, v83
  v_mfma_f32_16x16x32_bf16 v[100:103], v[36:39], v[172:175], v[100:103]
  v_mul_f32 v84, v12, v84
  v_mul_f32 v85, v12, v85
  v_mfma_f32_16x16x32_bf16 v[108:111], v[36:39], v[204:207], v[108:111]
  v_mul_f32 v86, v12, v86
  v_mfma_f32_16x16x32_bf16 v[116:119], v[36:39], v[236:239], v[116:119]
  s_waitcnt lgkmcnt(5)
  v_mul_f32 v87, v12, v87
  v_mfma_f32_16x16x32_bf16 v[88:91], v[40:43], v[144:147], v[88:91]
  ds_read_b128 v[32:35], v249 offset:0
  v_cvt_pk_bf16_f32 v80, v80, v81
  v_mfma_f32_16x16x32_bf16 v[96:99], v[40:43], v[176:179], v[96:99]
  v_cvt_pk_bf16_f32 v81, v82, v83
  v_cvt_pk_bf16_f32 v82, v84, v85
  v_mfma_f32_16x16x32_bf16 v[104:107], v[40:43], v[208:211], v[104:107]
  v_cvt_pk_bf16_f32 v83, v86, v87
  v_mfma_f32_16x16x32_bf16 v[112:115], v[40:43], v[240:243], v[112:115]
  s_waitcnt lgkmcnt(5)
  v_accvgpr_write_b32 a200, v80
  v_mfma_f32_16x16x32_bf16 v[92:95], v[44:47], v[144:147], v[92:95]
  ds_read_b128 v[36:39], v249 offset:2048
  v_accvgpr_write_b32 a201, v81
  v_mfma_f32_16x16x32_bf16 v[100:103], v[44:47], v[176:179], v[100:103]
  v_accvgpr_write_b32 a202, v82
  v_accvgpr_write_b32 a203, v83
  v_mfma_f32_16x16x32_bf16 v[108:111], v[44:47], v[208:211], v[108:111]
  v_mfma_f32_16x16x32_bf16 v[116:119], v[44:47], v[240:243], v[116:119]
  s_waitcnt lgkmcnt(5)
  v_mfma_f32_16x16x32_bf16 v[88:91], v[48:51], v[148:151], v[88:91]
  ds_read_b128 v[40:43], v250 offset:0
  v_mfma_f32_16x16x32_bf16 v[96:99], v[48:51], v[180:183], v[96:99]
  v_mfma_f32_16x16x32_bf16 v[104:107], v[48:51], v[212:215], v[104:107]
  v_mfma_f32_16x16x32_bf16 v[112:115], v[48:51], v[244:247], v[112:115]
  s_waitcnt lgkmcnt(5)
  v_mfma_f32_16x16x32_bf16 v[92:95], v[52:55], v[148:151], v[92:95]
  ds_read_b128 v[44:47], v250 offset:2048
  v_mfma_f32_16x16x32_bf16 v[100:103], v[52:55], v[180:183], v[100:103]
  v_mfma_f32_16x16x32_bf16 v[108:111], v[52:55], v[212:215], v[108:111]
  v_mfma_f32_16x16x32_bf16 v[116:119], v[52:55], v[244:247], v[116:119]
  s_waitcnt lgkmcnt(5)
  v_mfma_f32_16x16x32_bf16 v[56:59], v[24:27], v[120:123], 0
  ds_read_b128 v[48:51], v251 offset:0
  v_mfma_f32_16x16x32_bf16 v[64:67], v[24:27], v[152:155], 0
  v_mfma_f32_16x16x32_bf16 v[72:75], v[24:27], v[184:187], 0
  v_mfma_f32_16x16x32_bf16 v[80:83], v[24:27], v[216:219], 0
  s_waitcnt lgkmcnt(5)
  v_mul_f32 v88, v12, v88
  v_mfma_f32_16x16x32_bf16 v[60:63], v[28:31], v[120:123], 0
  ds_read_b128 v[52:55], v251 offset:2048
  v_mul_f32 v89, v12, v89
  v_mfma_f32_16x16x32_bf16 v[68:71], v[28:31], v[152:155], 0
  v_mul_f32 v90, v12, v90
  v_mul_f32 v91, v12, v91
  v_mfma_f32_16x16x32_bf16 v[76:79], v[28:31], v[184:187], 0
  v_mul_f32 v92, v12, v92
  v_mfma_f32_16x16x32_bf16 v[84:87], v[28:31], v[216:219], 0
  s_waitcnt lgkmcnt(5)
  v_mul_f32 v93, v12, v93
  v_mfma_f32_16x16x32_bf16 v[56:59], v[32:35], v[124:127], v[56:59]
  ds_read_b128 v[24:27], v248 offset:256
  v_mul_f32 v94, v12, v94
  v_mfma_f32_16x16x32_bf16 v[64:67], v[32:35], v[156:159], v[64:67]
  v_mul_f32 v95, v12, v95
  v_cvt_pk_bf16_f32 v88, v88, v89
  v_mfma_f32_16x16x32_bf16 v[72:75], v[32:35], v[188:191], v[72:75]
  v_cvt_pk_bf16_f32 v89, v90, v91
  v_mfma_f32_16x16x32_bf16 v[80:83], v[32:35], v[220:223], v[80:83]
  s_waitcnt lgkmcnt(5)
  v_cvt_pk_bf16_f32 v90, v92, v93
  v_mfma_f32_16x16x32_bf16 v[60:63], v[36:39], v[124:127], v[60:63]
  ds_read_b128 v[28:31], v248 offset:2304
  v_cvt_pk_bf16_f32 v91, v94, v95
  v_mfma_f32_16x16x32_bf16 v[68:71], v[36:39], v[156:159], v[68:71]
  v_accvgpr_write_b32 a36, v88
  v_accvgpr_write_b32 a37, v89
  v_mfma_f32_16x16x32_bf16 v[76:79], v[36:39], v[188:191], v[76:79]
  v_accvgpr_write_b32 a38, v90
  v_mfma_f32_16x16x32_bf16 v[84:87], v[36:39], v[220:223], v[84:87]
  s_waitcnt lgkmcnt(5)
  v_accvgpr_write_b32 a39, v91
  v_mfma_f32_16x16x32_bf16 v[56:59], v[40:43], v[128:131], v[56:59]
  ds_read_b128 v[32:35], v249 offset:256
  v_mul_f32 v96, v12, v96
  v_mfma_f32_16x16x32_bf16 v[64:67], v[40:43], v[160:163], v[64:67]
  v_mul_f32 v97, v12, v97
  v_mul_f32 v98, v12, v98
  v_mfma_f32_16x16x32_bf16 v[72:75], v[40:43], v[192:195], v[72:75]
  v_mul_f32 v99, v12, v99
  v_mfma_f32_16x16x32_bf16 v[80:83], v[40:43], v[224:227], v[80:83]
  s_waitcnt lgkmcnt(5)
  v_mul_f32 v100, v12, v100
  v_mfma_f32_16x16x32_bf16 v[60:63], v[44:47], v[128:131], v[60:63]
  ds_read_b128 v[36:39], v249 offset:2304
  v_mul_f32 v101, v12, v101
  v_mfma_f32_16x16x32_bf16 v[68:71], v[44:47], v[160:163], v[68:71]
  v_mul_f32 v102, v12, v102
  v_mul_f32 v103, v12, v103
  v_mfma_f32_16x16x32_bf16 v[76:79], v[44:47], v[192:195], v[76:79]
  v_cvt_pk_bf16_f32 v96, v96, v97
  v_mfma_f32_16x16x32_bf16 v[84:87], v[44:47], v[224:227], v[84:87]
  s_waitcnt lgkmcnt(5)
  v_cvt_pk_bf16_f32 v97, v98, v99
  v_mfma_f32_16x16x32_bf16 v[56:59], v[48:51], v[132:135], v[56:59]
  ds_read_b128 v[40:43], v250 offset:256
  v_cvt_pk_bf16_f32 v98, v100, v101
  v_mfma_f32_16x16x32_bf16 v[64:67], v[48:51], v[164:167], v[64:67]
  v_cvt_pk_bf16_f32 v99, v102, v103
  v_accvgpr_write_b32 a92, v96
  v_mfma_f32_16x16x32_bf16 v[72:75], v[48:51], v[196:199], v[72:75]
  v_accvgpr_write_b32 a93, v97
  v_mfma_f32_16x16x32_bf16 v[80:83], v[48:51], v[228:231], v[80:83]
  s_waitcnt lgkmcnt(5)
  v_accvgpr_write_b32 a94, v98
  v_mfma_f32_16x16x32_bf16 v[60:63], v[52:55], v[132:135], v[60:63]
  ds_read_b128 v[44:47], v250 offset:2304
  v_accvgpr_write_b32 a95, v99
  v_mfma_f32_16x16x32_bf16 v[68:71], v[52:55], v[164:167], v[68:71]
  v_mul_f32 v104, v12, v104
  v_mul_f32 v105, v12, v105
  v_mfma_f32_16x16x32_bf16 v[76:79], v[52:55], v[196:199], v[76:79]
  v_mul_f32 v106, v12, v106
  v_mfma_f32_16x16x32_bf16 v[84:87], v[52:55], v[228:231], v[84:87]
  s_waitcnt lgkmcnt(5)
  v_mul_f32 v107, v12, v107
  v_mfma_f32_16x16x32_bf16 v[56:59], v[24:27], v[136:139], v[56:59]
  ds_read_b128 v[48:51], v251 offset:256
  v_mul_f32 v108, v12, v108
  v_mfma_f32_16x16x32_bf16 v[64:67], v[24:27], v[168:171], v[64:67]
  v_mul_f32 v109, v12, v109
  v_mul_f32 v110, v12, v110
  v_mfma_f32_16x16x32_bf16 v[72:75], v[24:27], v[200:203], v[72:75]
  v_mul_f32 v111, v12, v111
  v_mfma_f32_16x16x32_bf16 v[80:83], v[24:27], v[232:235], v[80:83]
  s_waitcnt lgkmcnt(5)
  v_cvt_pk_bf16_f32 v104, v104, v105
  v_mfma_f32_16x16x32_bf16 v[60:63], v[28:31], v[136:139], v[60:63]
  ds_read_b128 v[52:55], v251 offset:2304
  v_cvt_pk_bf16_f32 v105, v106, v107
  v_mfma_f32_16x16x32_bf16 v[68:71], v[28:31], v[168:171], v[68:71]
  v_cvt_pk_bf16_f32 v106, v108, v109
  v_cvt_pk_bf16_f32 v107, v110, v111
  v_mfma_f32_16x16x32_bf16 v[76:79], v[28:31], v[200:203], v[76:79]
  v_accvgpr_write_b32 a148, v104
  v_mfma_f32_16x16x32_bf16 v[84:87], v[28:31], v[232:235], v[84:87]
  s_waitcnt lgkmcnt(5)
  v_accvgpr_write_b32 a149, v105
  v_mfma_f32_16x16x32_bf16 v[56:59], v[32:35], v[140:143], v[56:59]
  s_waitcnt vmcnt(8)
  s_barrier
  ds_read_b128 v[24:27], v248 offset:16384
  v_accvgpr_write_b32 a150, v106
  v_mfma_f32_16x16x32_bf16 v[64:67], v[32:35], v[172:175], v[64:67]
  v_accvgpr_write_b32 a151, v107
  v_mul_f32 v112, v12, v112
  v_mfma_f32_16x16x32_bf16 v[72:75], v[32:35], v[204:207], v[72:75]
  v_mul_f32 v113, v12, v113
  v_mfma_f32_16x16x32_bf16 v[80:83], v[32:35], v[236:239], v[80:83]
  s_waitcnt lgkmcnt(5)
  v_mul_f32 v114, v12, v114
  v_mfma_f32_16x16x32_bf16 v[60:63], v[36:39], v[140:143], v[60:63]
  ds_read_b128 v[28:31], v248 offset:18432
  v_mul_f32 v115, v12, v115
  v_mfma_f32_16x16x32_bf16 v[68:71], v[36:39], v[172:175], v[68:71]
  v_mul_f32 v116, v12, v116
  v_mul_f32 v117, v12, v117
  v_mfma_f32_16x16x32_bf16 v[76:79], v[36:39], v[204:207], v[76:79]
  v_mul_f32 v118, v12, v118
  v_mfma_f32_16x16x32_bf16 v[84:87], v[36:39], v[236:239], v[84:87]
  s_waitcnt lgkmcnt(5)
  v_mul_f32 v119, v12, v119
  v_mfma_f32_16x16x32_bf16 v[56:59], v[40:43], v[144:147], v[56:59]
  ds_read_b128 v[32:35], v249 offset:16384
  v_cvt_pk_bf16_f32 v112, v112, v113
  v_mfma_f32_16x16x32_bf16 v[64:67], v[40:43], v[176:179], v[64:67]
  v_cvt_pk_bf16_f32 v113, v114, v115
  v_cvt_pk_bf16_f32 v114, v116, v117
  v_mfma_f32_16x16x32_bf16 v[72:75], v[40:43], v[208:211], v[72:75]
  v_cvt_pk_bf16_f32 v115, v118, v119
  v_mfma_f32_16x16x32_bf16 v[80:83], v[40:43], v[240:243], v[80:83]
  s_waitcnt lgkmcnt(5)
  v_accvgpr_write_b32 a204, v112
  v_mfma_f32_16x16x32_bf16 v[60:63], v[44:47], v[144:147], v[60:63]
  ds_read_b128 v[36:39], v249 offset:18432
  v_accvgpr_write_b32 a205, v113
  v_mfma_f32_16x16x32_bf16 v[68:71], v[44:47], v[176:179], v[68:71]
  v_accvgpr_write_b32 a206, v114
  v_accvgpr_write_b32 a207, v115
  v_mfma_f32_16x16x32_bf16 v[76:79], v[44:47], v[208:211], v[76:79]
  v_mfma_f32_16x16x32_bf16 v[84:87], v[44:47], v[240:243], v[84:87]
  s_waitcnt lgkmcnt(5)
  v_mfma_f32_16x16x32_bf16 v[56:59], v[48:51], v[148:151], v[56:59]
  ds_read_b128 v[40:43], v250 offset:16384
  v_mfma_f32_16x16x32_bf16 v[64:67], v[48:51], v[180:183], v[64:67]
  v_mfma_f32_16x16x32_bf16 v[72:75], v[48:51], v[212:215], v[72:75]
  v_mfma_f32_16x16x32_bf16 v[80:83], v[48:51], v[244:247], v[80:83]
  s_waitcnt lgkmcnt(5)
  v_mfma_f32_16x16x32_bf16 v[60:63], v[52:55], v[148:151], v[60:63]
  ds_read_b128 v[44:47], v250 offset:18432
  v_mfma_f32_16x16x32_bf16 v[68:71], v[52:55], v[180:183], v[68:71]
  v_mfma_f32_16x16x32_bf16 v[76:79], v[52:55], v[212:215], v[76:79]
  v_mfma_f32_16x16x32_bf16 v[84:87], v[52:55], v[244:247], v[84:87]
  s_waitcnt lgkmcnt(5)
  v_mfma_f32_16x16x32_bf16 v[88:91], v[24:27], v[120:123], 0
  ds_read_b128 v[48:51], v251 offset:16384
  v_mfma_f32_16x16x32_bf16 v[96:99], v[24:27], v[152:155], 0
  v_mfma_f32_16x16x32_bf16 v[104:107], v[24:27], v[184:187], 0
  v_mfma_f32_16x16x32_bf16 v[112:115], v[24:27], v[216:219], 0
  s_waitcnt lgkmcnt(5)
  v_mul_f32 v56, v12, v56
  v_mfma_f32_16x16x32_bf16 v[92:95], v[28:31], v[120:123], 0
  ds_read_b128 v[52:55], v251 offset:18432
  v_mul_f32 v57, v12, v57
  v_mfma_f32_16x16x32_bf16 v[100:103], v[28:31], v[152:155], 0
  v_mul_f32 v58, v12, v58
  v_mul_f32 v59, v12, v59
  v_mfma_f32_16x16x32_bf16 v[108:111], v[28:31], v[184:187], 0
  v_mul_f32 v60, v12, v60
  v_mfma_f32_16x16x32_bf16 v[116:119], v[28:31], v[216:219], 0
  s_waitcnt lgkmcnt(5)
  v_mul_f32 v61, v12, v61
  v_mfma_f32_16x16x32_bf16 v[88:91], v[32:35], v[124:127], v[88:91]
  ds_read_b128 v[24:27], v248 offset:16640
  v_mul_f32 v62, v12, v62
  v_mfma_f32_16x16x32_bf16 v[96:99], v[32:35], v[156:159], v[96:99]
  v_mul_f32 v63, v12, v63
  v_cvt_pk_bf16_f32 v56, v56, v57
  v_mfma_f32_16x16x32_bf16 v[104:107], v[32:35], v[188:191], v[104:107]
  v_cvt_pk_bf16_f32 v57, v58, v59
  v_mfma_f32_16x16x32_bf16 v[112:115], v[32:35], v[220:223], v[112:115]
  s_waitcnt lgkmcnt(5)
  v_cvt_pk_bf16_f32 v58, v60, v61
  v_mfma_f32_16x16x32_bf16 v[92:95], v[36:39], v[124:127], v[92:95]
  ds_read_b128 v[28:31], v248 offset:18688
  v_cvt_pk_bf16_f32 v59, v62, v63
  v_mfma_f32_16x16x32_bf16 v[100:103], v[36:39], v[156:159], v[100:103]
  v_accvgpr_write_b32 a40, v56
  v_accvgpr_write_b32 a41, v57
  v_mfma_f32_16x16x32_bf16 v[108:111], v[36:39], v[188:191], v[108:111]
  v_accvgpr_write_b32 a42, v58
  v_mfma_f32_16x16x32_bf16 v[116:119], v[36:39], v[220:223], v[116:119]
  s_waitcnt lgkmcnt(5)
  v_accvgpr_write_b32 a43, v59
  v_mfma_f32_16x16x32_bf16 v[88:91], v[40:43], v[128:131], v[88:91]
  ds_read_b128 v[32:35], v249 offset:16640
  v_mul_f32 v64, v12, v64
  v_mfma_f32_16x16x32_bf16 v[96:99], v[40:43], v[160:163], v[96:99]
  v_mul_f32 v65, v12, v65
  v_mul_f32 v66, v12, v66
  v_mfma_f32_16x16x32_bf16 v[104:107], v[40:43], v[192:195], v[104:107]
  v_mul_f32 v67, v12, v67
  v_mfma_f32_16x16x32_bf16 v[112:115], v[40:43], v[224:227], v[112:115]
  s_waitcnt lgkmcnt(5)
  v_mul_f32 v68, v12, v68
  v_mfma_f32_16x16x32_bf16 v[92:95], v[44:47], v[128:131], v[92:95]
  ds_read_b128 v[36:39], v249 offset:18688
  v_mul_f32 v69, v12, v69
  v_mfma_f32_16x16x32_bf16 v[100:103], v[44:47], v[160:163], v[100:103]
  v_mul_f32 v70, v12, v70
  v_mul_f32 v71, v12, v71
  v_mfma_f32_16x16x32_bf16 v[108:111], v[44:47], v[192:195], v[108:111]
  v_cvt_pk_bf16_f32 v64, v64, v65
  v_mfma_f32_16x16x32_bf16 v[116:119], v[44:47], v[224:227], v[116:119]
  s_waitcnt lgkmcnt(5)
  v_cvt_pk_bf16_f32 v65, v66, v67
  v_mfma_f32_16x16x32_bf16 v[88:91], v[48:51], v[132:135], v[88:91]
  ds_read_b128 v[40:43], v250 offset:16640
  v_cvt_pk_bf16_f32 v66, v68, v69
  v_mfma_f32_16x16x32_bf16 v[96:99], v[48:51], v[164:167], v[96:99]
  v_cvt_pk_bf16_f32 v67, v70, v71
  v_accvgpr_write_b32 a96, v64
  v_mfma_f32_16x16x32_bf16 v[104:107], v[48:51], v[196:199], v[104:107]
  v_accvgpr_write_b32 a97, v65
  v_mfma_f32_16x16x32_bf16 v[112:115], v[48:51], v[228:231], v[112:115]
  s_waitcnt lgkmcnt(5)
  v_accvgpr_write_b32 a98, v66
  v_mfma_f32_16x16x32_bf16 v[92:95], v[52:55], v[132:135], v[92:95]
  ds_read_b128 v[44:47], v250 offset:18688
  v_accvgpr_write_b32 a99, v67
  v_mfma_f32_16x16x32_bf16 v[100:103], v[52:55], v[164:167], v[100:103]
  v_mul_f32 v72, v12, v72
  v_mul_f32 v73, v12, v73
  v_mfma_f32_16x16x32_bf16 v[108:111], v[52:55], v[196:199], v[108:111]
  v_mul_f32 v74, v12, v74
  v_mfma_f32_16x16x32_bf16 v[116:119], v[52:55], v[228:231], v[116:119]
  s_waitcnt lgkmcnt(5)
  v_mul_f32 v75, v12, v75
  v_mfma_f32_16x16x32_bf16 v[88:91], v[24:27], v[136:139], v[88:91]
  ds_read_b128 v[48:51], v251 offset:16640
  v_mul_f32 v76, v12, v76
  v_mfma_f32_16x16x32_bf16 v[96:99], v[24:27], v[168:171], v[96:99]
  v_mul_f32 v77, v12, v77
  v_mul_f32 v78, v12, v78
  v_mfma_f32_16x16x32_bf16 v[104:107], v[24:27], v[200:203], v[104:107]
  v_mul_f32 v79, v12, v79
  v_mfma_f32_16x16x32_bf16 v[112:115], v[24:27], v[232:235], v[112:115]
  s_waitcnt lgkmcnt(5)
  v_cvt_pk_bf16_f32 v72, v72, v73
  v_mfma_f32_16x16x32_bf16 v[92:95], v[28:31], v[136:139], v[92:95]
  ds_read_b128 v[52:55], v251 offset:18688
  v_cvt_pk_bf16_f32 v73, v74, v75
  v_mfma_f32_16x16x32_bf16 v[100:103], v[28:31], v[168:171], v[100:103]
  v_cvt_pk_bf16_f32 v74, v76, v77
  v_cvt_pk_bf16_f32 v75, v78, v79
  v_mfma_f32_16x16x32_bf16 v[108:111], v[28:31], v[200:203], v[108:111]
  v_accvgpr_write_b32 a152, v72
  v_mfma_f32_16x16x32_bf16 v[116:119], v[28:31], v[232:235], v[116:119]
  s_waitcnt lgkmcnt(5)
  v_accvgpr_write_b32 a153, v73
  v_mfma_f32_16x16x32_bf16 v[88:91], v[32:35], v[140:143], v[88:91]
  s_waitcnt vmcnt(4)
  s_barrier
  ds_read_b128 v[24:27], v248 offset:32768
  v_accvgpr_write_b32 a154, v74
  v_mfma_f32_16x16x32_bf16 v[96:99], v[32:35], v[172:175], v[96:99]
  v_accvgpr_write_b32 a155, v75
  v_mul_f32 v80, v12, v80
  v_mfma_f32_16x16x32_bf16 v[104:107], v[32:35], v[204:207], v[104:107]
  v_mul_f32 v81, v12, v81
  v_mfma_f32_16x16x32_bf16 v[112:115], v[32:35], v[236:239], v[112:115]
  s_waitcnt lgkmcnt(5)
  v_mul_f32 v82, v12, v82
  v_mfma_f32_16x16x32_bf16 v[92:95], v[36:39], v[140:143], v[92:95]
  ds_read_b128 v[28:31], v248 offset:34816
  v_mul_f32 v83, v12, v83
  v_mfma_f32_16x16x32_bf16 v[100:103], v[36:39], v[172:175], v[100:103]
  v_mul_f32 v84, v12, v84
  v_mul_f32 v85, v12, v85
  v_mfma_f32_16x16x32_bf16 v[108:111], v[36:39], v[204:207], v[108:111]
  v_mul_f32 v86, v12, v86
  v_mfma_f32_16x16x32_bf16 v[116:119], v[36:39], v[236:239], v[116:119]
  s_waitcnt lgkmcnt(5)
  v_mul_f32 v87, v12, v87
  v_mfma_f32_16x16x32_bf16 v[88:91], v[40:43], v[144:147], v[88:91]
  ds_read_b128 v[32:35], v249 offset:32768
  v_cvt_pk_bf16_f32 v80, v80, v81
  v_mfma_f32_16x16x32_bf16 v[96:99], v[40:43], v[176:179], v[96:99]
  v_cvt_pk_bf16_f32 v81, v82, v83
  v_cvt_pk_bf16_f32 v82, v84, v85
  v_mfma_f32_16x16x32_bf16 v[104:107], v[40:43], v[208:211], v[104:107]
  v_cvt_pk_bf16_f32 v83, v86, v87
  v_mfma_f32_16x16x32_bf16 v[112:115], v[40:43], v[240:243], v[112:115]
  s_waitcnt lgkmcnt(5)
  v_accvgpr_write_b32 a208, v80
  v_mfma_f32_16x16x32_bf16 v[92:95], v[44:47], v[144:147], v[92:95]
  ds_read_b128 v[36:39], v249 offset:34816
  v_accvgpr_write_b32 a209, v81
  v_mfma_f32_16x16x32_bf16 v[100:103], v[44:47], v[176:179], v[100:103]
  v_accvgpr_write_b32 a210, v82
  v_accvgpr_write_b32 a211, v83
  v_mfma_f32_16x16x32_bf16 v[108:111], v[44:47], v[208:211], v[108:111]
  v_mfma_f32_16x16x32_bf16 v[116:119], v[44:47], v[240:243], v[116:119]
  s_waitcnt lgkmcnt(5)
  v_mfma_f32_16x16x32_bf16 v[88:91], v[48:51], v[148:151], v[88:91]
  ds_read_b128 v[40:43], v250 offset:32768
  v_mfma_f32_16x16x32_bf16 v[96:99], v[48:51], v[180:183], v[96:99]
  v_mfma_f32_16x16x32_bf16 v[104:107], v[48:51], v[212:215], v[104:107]
  v_mfma_f32_16x16x32_bf16 v[112:115], v[48:51], v[244:247], v[112:115]
  s_waitcnt lgkmcnt(5)
  v_mfma_f32_16x16x32_bf16 v[92:95], v[52:55], v[148:151], v[92:95]
  ds_read_b128 v[44:47], v250 offset:34816
  v_mfma_f32_16x16x32_bf16 v[100:103], v[52:55], v[180:183], v[100:103]
  v_mfma_f32_16x16x32_bf16 v[108:111], v[52:55], v[212:215], v[108:111]
  v_mfma_f32_16x16x32_bf16 v[116:119], v[52:55], v[244:247], v[116:119]
  s_waitcnt lgkmcnt(5)
  v_mfma_f32_16x16x32_bf16 v[56:59], v[24:27], v[120:123], 0
  ds_read_b128 v[48:51], v251 offset:32768
  v_mfma_f32_16x16x32_bf16 v[64:67], v[24:27], v[152:155], 0
  v_mfma_f32_16x16x32_bf16 v[72:75], v[24:27], v[184:187], 0
  v_mfma_f32_16x16x32_bf16 v[80:83], v[24:27], v[216:219], 0
  s_waitcnt lgkmcnt(5)
  v_mul_f32 v88, v12, v88
  v_mfma_f32_16x16x32_bf16 v[60:63], v[28:31], v[120:123], 0
  ds_read_b128 v[52:55], v251 offset:34816
  v_mul_f32 v89, v12, v89
  v_mfma_f32_16x16x32_bf16 v[68:71], v[28:31], v[152:155], 0
  v_mul_f32 v90, v12, v90
  v_mul_f32 v91, v12, v91
  v_mfma_f32_16x16x32_bf16 v[76:79], v[28:31], v[184:187], 0
  v_mul_f32 v92, v12, v92
  v_mfma_f32_16x16x32_bf16 v[84:87], v[28:31], v[216:219], 0
  s_waitcnt lgkmcnt(5)
  v_mul_f32 v93, v12, v93
  v_mfma_f32_16x16x32_bf16 v[56:59], v[32:35], v[124:127], v[56:59]
  ds_read_b128 v[24:27], v248 offset:33024
  v_mul_f32 v94, v12, v94
  v_mfma_f32_16x16x32_bf16 v[64:67], v[32:35], v[156:159], v[64:67]
  v_mul_f32 v95, v12, v95
  v_cvt_pk_bf16_f32 v88, v88, v89
  v_mfma_f32_16x16x32_bf16 v[72:75], v[32:35], v[188:191], v[72:75]
  v_mfma_f32_16x16x32_bf16 v[80:83], v[32:35], v[220:223], v[80:83]
  s_waitcnt lgkmcnt(5)
  v_cvt_pk_bf16_f32 v89, v90, v91
  v_mfma_f32_16x16x32_bf16 v[60:63], v[36:39], v[124:127], v[60:63]
  ds_read_b128 v[28:31], v248 offset:35072
  v_cvt_pk_bf16_f32 v90, v92, v93
  v_mfma_f32_16x16x32_bf16 v[68:71], v[36:39], v[156:159], v[68:71]
  v_cvt_pk_bf16_f32 v91, v94, v95
  v_accvgpr_write_b32 a44, v88
  v_mfma_f32_16x16x32_bf16 v[76:79], v[36:39], v[188:191], v[76:79]
  v_accvgpr_write_b32 a45, v89
  v_mfma_f32_16x16x32_bf16 v[84:87], v[36:39], v[220:223], v[84:87]
  s_waitcnt lgkmcnt(5)
  v_accvgpr_write_b32 a46, v90
  v_mfma_f32_16x16x32_bf16 v[56:59], v[40:43], v[128:131], v[56:59]
  ds_read_b128 v[32:35], v249 offset:33024
  v_accvgpr_write_b32 a47, v91
  v_mfma_f32_16x16x32_bf16 v[64:67], v[40:43], v[160:163], v[64:67]
  v_mul_f32 v96, v12, v96
  v_mul_f32 v97, v12, v97
  v_mfma_f32_16x16x32_bf16 v[72:75], v[40:43], v[192:195], v[72:75]
  v_mfma_f32_16x16x32_bf16 v[80:83], v[40:43], v[224:227], v[80:83]
  s_waitcnt lgkmcnt(5)
  v_mul_f32 v98, v12, v98
  v_mfma_f32_16x16x32_bf16 v[60:63], v[44:47], v[128:131], v[60:63]
  ds_read_b128 v[36:39], v249 offset:35072
  v_mul_f32 v99, v12, v99
  v_mfma_f32_16x16x32_bf16 v[68:71], v[44:47], v[160:163], v[68:71]
  v_mul_f32 v100, v12, v100
  v_mul_f32 v101, v12, v101
  v_mfma_f32_16x16x32_bf16 v[76:79], v[44:47], v[192:195], v[76:79]
  v_mul_f32 v102, v12, v102
  v_mfma_f32_16x16x32_bf16 v[84:87], v[44:47], v[224:227], v[84:87]
  s_waitcnt lgkmcnt(5)
  v_mul_f32 v103, v12, v103
  v_mfma_f32_16x16x32_bf16 v[56:59], v[48:51], v[132:135], v[56:59]
  ds_read_b128 v[40:43], v250 offset:33024
  v_cvt_pk_bf16_f32 v96, v96, v97
  v_mfma_f32_16x16x32_bf16 v[64:67], v[48:51], v[164:167], v[64:67]
  v_cvt_pk_bf16_f32 v97, v98, v99
  v_cvt_pk_bf16_f32 v98, v100, v101
  v_mfma_f32_16x16x32_bf16 v[72:75], v[48:51], v[196:199], v[72:75]
  v_mfma_f32_16x16x32_bf16 v[80:83], v[48:51], v[228:231], v[80:83]
  s_waitcnt lgkmcnt(5)
  v_cvt_pk_bf16_f32 v99, v102, v103
  v_mfma_f32_16x16x32_bf16 v[60:63], v[52:55], v[132:135], v[60:63]
  ds_read_b128 v[44:47], v250 offset:35072
  v_accvgpr_write_b32 a100, v96
  v_mfma_f32_16x16x32_bf16 v[68:71], v[52:55], v[164:167], v[68:71]
  v_accvgpr_write_b32 a101, v97
  v_accvgpr_write_b32 a102, v98
  v_mfma_f32_16x16x32_bf16 v[76:79], v[52:55], v[196:199], v[76:79]
  v_accvgpr_write_b32 a103, v99
  v_mfma_f32_16x16x32_bf16 v[84:87], v[52:55], v[228:231], v[84:87]
  s_waitcnt lgkmcnt(5)
  v_mul_f32 v104, v12, v104
  v_mfma_f32_16x16x32_bf16 v[56:59], v[24:27], v[136:139], v[56:59]
  ds_read_b128 v[48:51], v251 offset:33024
  v_mul_f32 v105, v12, v105
  v_mfma_f32_16x16x32_bf16 v[64:67], v[24:27], v[168:171], v[64:67]
  v_mul_f32 v106, v12, v106
  v_mul_f32 v107, v12, v107
  v_mfma_f32_16x16x32_bf16 v[72:75], v[24:27], v[200:203], v[72:75]
  v_mfma_f32_16x16x32_bf16 v[80:83], v[24:27], v[232:235], v[80:83]
  s_waitcnt lgkmcnt(5)
  v_mul_f32 v108, v12, v108
  v_mfma_f32_16x16x32_bf16 v[60:63], v[28:31], v[136:139], v[60:63]
  ds_read_b128 v[52:55], v251 offset:35072
  v_mul_f32 v109, v12, v109
  v_mfma_f32_16x16x32_bf16 v[68:71], v[28:31], v[168:171], v[68:71]
  v_mul_f32 v110, v12, v110
  v_mul_f32 v111, v12, v111
  v_mfma_f32_16x16x32_bf16 v[76:79], v[28:31], v[200:203], v[76:79]
  v_cvt_pk_bf16_f32 v104, v104, v105
  v_mfma_f32_16x16x32_bf16 v[84:87], v[28:31], v[232:235], v[84:87]
  s_waitcnt lgkmcnt(5)
  v_cvt_pk_bf16_f32 v105, v106, v107
  v_mfma_f32_16x16x32_bf16 v[56:59], v[32:35], v[140:143], v[56:59]
  s_waitcnt vmcnt(0)
  s_barrier
  ds_read_b128 v[24:27], v248 offset:49152
  v_cvt_pk_bf16_f32 v106, v108, v109
  v_mfma_f32_16x16x32_bf16 v[64:67], v[32:35], v[172:175], v[64:67]
  v_cvt_pk_bf16_f32 v107, v110, v111
  v_accvgpr_write_b32 a156, v104
  v_mfma_f32_16x16x32_bf16 v[72:75], v[32:35], v[204:207], v[72:75]
  v_mfma_f32_16x16x32_bf16 v[80:83], v[32:35], v[236:239], v[80:83]
  s_waitcnt lgkmcnt(5)
  v_accvgpr_write_b32 a157, v105
  v_mfma_f32_16x16x32_bf16 v[60:63], v[36:39], v[140:143], v[60:63]
  ds_read_b128 v[28:31], v248 offset:51200
  v_accvgpr_write_b32 a158, v106
  v_mfma_f32_16x16x32_bf16 v[68:71], v[36:39], v[172:175], v[68:71]
  v_accvgpr_write_b32 a159, v107
  v_mul_f32 v112, v12, v112
  v_mfma_f32_16x16x32_bf16 v[76:79], v[36:39], v[204:207], v[76:79]
  v_mul_f32 v113, v12, v113
  v_mfma_f32_16x16x32_bf16 v[84:87], v[36:39], v[236:239], v[84:87]
  s_waitcnt lgkmcnt(5)
  v_mul_f32 v114, v12, v114
  v_mfma_f32_16x16x32_bf16 v[56:59], v[40:43], v[144:147], v[56:59]
  ds_read_b128 v[32:35], v249 offset:49152
  v_mul_f32 v115, v12, v115
  v_mfma_f32_16x16x32_bf16 v[64:67], v[40:43], v[176:179], v[64:67]
  v_mul_f32 v116, v12, v116
  v_mul_f32 v117, v12, v117
  v_mfma_f32_16x16x32_bf16 v[72:75], v[40:43], v[208:211], v[72:75]
  v_readfirstlane_b32 s86, v13
  s_lshl_b32 s22, s17, 7
  s_add_u32 s22, s22, 584192
  s_mov_b32 s23, 586240
  buffer_load_dword v13, off, s[8:11], s22 sc1
  buffer_load_dwordx2 v[10:11], off, s[8:11], s23 sc1
  v_mfma_f32_16x16x32_bf16 v[80:83], v[40:43], v[240:243], v[80:83]
  s_waitcnt lgkmcnt(5)
  v_mul_f32 v118, v12, v118
  v_mfma_f32_16x16x32_bf16 v[60:63], v[44:47], v[144:147], v[60:63]
  ds_read_b128 v[36:39], v249 offset:51200
  v_mul_f32 v119, v12, v119
  v_mfma_f32_16x16x32_bf16 v[68:71], v[44:47], v[176:179], v[68:71]
  v_cvt_pk_bf16_f32 v112, v112, v113
  v_cvt_pk_bf16_f32 v113, v114, v115
  v_mfma_f32_16x16x32_bf16 v[76:79], v[44:47], v[208:211], v[76:79]
  v_cvt_pk_bf16_f32 v114, v116, v117
  v_mfma_f32_16x16x32_bf16 v[84:87], v[44:47], v[240:243], v[84:87]
  s_waitcnt lgkmcnt(5)
  v_cvt_pk_bf16_f32 v115, v118, v119
  v_mfma_f32_16x16x32_bf16 v[56:59], v[48:51], v[148:151], v[56:59]
  ds_read_b128 v[40:43], v250 offset:49152
  v_accvgpr_write_b32 a212, v112
  v_mfma_f32_16x16x32_bf16 v[64:67], v[48:51], v[180:183], v[64:67]
  v_accvgpr_write_b32 a213, v113
  v_accvgpr_write_b32 a214, v114
  v_mfma_f32_16x16x32_bf16 v[72:75], v[48:51], v[212:215], v[72:75]
  v_accvgpr_write_b32 a215, v115
  v_mfma_f32_16x16x32_bf16 v[80:83], v[48:51], v[244:247], v[80:83]
  s_waitcnt lgkmcnt(5)
  v_mfma_f32_16x16x32_bf16 v[60:63], v[52:55], v[148:151], v[60:63]
  ds_read_b128 v[44:47], v250 offset:51200
  v_mfma_f32_16x16x32_bf16 v[68:71], v[52:55], v[180:183], v[68:71]
  v_mfma_f32_16x16x32_bf16 v[76:79], v[52:55], v[212:215], v[76:79]
  v_mfma_f32_16x16x32_bf16 v[84:87], v[52:55], v[244:247], v[84:87]
  s_waitcnt lgkmcnt(5)
  v_mfma_f32_16x16x32_bf16 v[88:91], v[24:27], v[120:123], 0
  ds_read_b128 v[48:51], v251 offset:49152
  v_mfma_f32_16x16x32_bf16 v[96:99], v[24:27], v[152:155], 0
  v_mfma_f32_16x16x32_bf16 v[104:107], v[24:27], v[184:187], 0
  v_mfma_f32_16x16x32_bf16 v[112:115], v[24:27], v[216:219], 0
  s_waitcnt lgkmcnt(5)
  v_mul_f32 v56, v12, v56
  v_mfma_f32_16x16x32_bf16 v[92:95], v[28:31], v[120:123], 0
  ds_read_b128 v[52:55], v251 offset:51200
  v_mul_f32 v57, v12, v57
  v_mfma_f32_16x16x32_bf16 v[100:103], v[28:31], v[152:155], 0
  v_mul_f32 v58, v12, v58
  v_mul_f32 v59, v12, v59
  v_mfma_f32_16x16x32_bf16 v[108:111], v[28:31], v[184:187], 0
  v_mul_f32 v60, v12, v60
  v_mfma_f32_16x16x32_bf16 v[116:119], v[28:31], v[216:219], 0
  s_waitcnt lgkmcnt(5)
  v_mul_f32 v61, v12, v61
  v_mfma_f32_16x16x32_bf16 v[88:91], v[32:35], v[124:127], v[88:91]
  ds_read_b128 v[24:27], v248 offset:49408
  v_mul_f32 v62, v12, v62
  v_mfma_f32_16x16x32_bf16 v[96:99], v[32:35], v[156:159], v[96:99]
  v_mul_f32 v63, v12, v63
  v_cvt_pk_bf16_f32 v56, v56, v57
  v_mfma_f32_16x16x32_bf16 v[104:107], v[32:35], v[188:191], v[104:107]
  v_cvt_pk_bf16_f32 v57, v58, v59
  v_mfma_f32_16x16x32_bf16 v[112:115], v[32:35], v[220:223], v[112:115]
  s_waitcnt lgkmcnt(5)
  v_cvt_pk_bf16_f32 v58, v60, v61
  v_mfma_f32_16x16x32_bf16 v[92:95], v[36:39], v[124:127], v[92:95]
  ds_read_b128 v[28:31], v248 offset:51456
  v_cvt_pk_bf16_f32 v59, v62, v63
  v_mfma_f32_16x16x32_bf16 v[100:103], v[36:39], v[156:159], v[100:103]
  v_accvgpr_write_b32 a48, v56
  v_accvgpr_write_b32 a49, v57
  v_mfma_f32_16x16x32_bf16 v[108:111], v[36:39], v[188:191], v[108:111]
  v_accvgpr_write_b32 a50, v58
  v_mfma_f32_16x16x32_bf16 v[116:119], v[36:39], v[220:223], v[116:119]
  s_waitcnt lgkmcnt(5)
  v_accvgpr_write_b32 a51, v59
  v_mfma_f32_16x16x32_bf16 v[88:91], v[40:43], v[128:131], v[88:91]
  ds_read_b128 v[32:35], v249 offset:49408
  v_mul_f32 v64, v12, v64
  v_mfma_f32_16x16x32_bf16 v[96:99], v[40:43], v[160:163], v[96:99]
  v_mul_f32 v65, v12, v65
  v_mul_f32 v66, v12, v66
  v_mfma_f32_16x16x32_bf16 v[104:107], v[40:43], v[192:195], v[104:107]
  v_mul_f32 v67, v12, v67
  v_mfma_f32_16x16x32_bf16 v[112:115], v[40:43], v[224:227], v[112:115]
  s_waitcnt lgkmcnt(5)
  v_mul_f32 v68, v12, v68
  v_mfma_f32_16x16x32_bf16 v[92:95], v[44:47], v[128:131], v[92:95]
  ds_read_b128 v[36:39], v249 offset:51456
  v_mul_f32 v69, v12, v69
  v_mfma_f32_16x16x32_bf16 v[100:103], v[44:47], v[160:163], v[100:103]
  v_mul_f32 v70, v12, v70
  v_mul_f32 v71, v12, v71
  v_mfma_f32_16x16x32_bf16 v[108:111], v[44:47], v[192:195], v[108:111]
  v_cvt_pk_bf16_f32 v64, v64, v65
  v_mfma_f32_16x16x32_bf16 v[116:119], v[44:47], v[224:227], v[116:119]
  s_waitcnt lgkmcnt(5)
  v_cvt_pk_bf16_f32 v65, v66, v67
  v_mfma_f32_16x16x32_bf16 v[88:91], v[48:51], v[132:135], v[88:91]
  ds_read_b128 v[40:43], v250 offset:49408
  v_cvt_pk_bf16_f32 v66, v68, v69
  v_mfma_f32_16x16x32_bf16 v[96:99], v[48:51], v[164:167], v[96:99]
  v_cvt_pk_bf16_f32 v67, v70, v71
  v_accvgpr_write_b32 a104, v64
  v_mfma_f32_16x16x32_bf16 v[104:107], v[48:51], v[196:199], v[104:107]
  v_accvgpr_write_b32 a105, v65
  v_mfma_f32_16x16x32_bf16 v[112:115], v[48:51], v[228:231], v[112:115]
  s_waitcnt lgkmcnt(5)
  v_accvgpr_write_b32 a106, v66
  v_mfma_f32_16x16x32_bf16 v[92:95], v[52:55], v[132:135], v[92:95]
  ds_read_b128 v[44:47], v250 offset:51456
  v_accvgpr_write_b32 a107, v67
  v_mfma_f32_16x16x32_bf16 v[100:103], v[52:55], v[164:167], v[100:103]
  v_mul_f32 v72, v12, v72
  v_mul_f32 v73, v12, v73
  v_mfma_f32_16x16x32_bf16 v[108:111], v[52:55], v[196:199], v[108:111]
  v_mul_f32 v74, v12, v74
  v_mfma_f32_16x16x32_bf16 v[116:119], v[52:55], v[228:231], v[116:119]
  s_waitcnt lgkmcnt(5)
  v_mul_f32 v75, v12, v75
  v_mfma_f32_16x16x32_bf16 v[88:91], v[24:27], v[136:139], v[88:91]
  ds_read_b128 v[48:51], v251 offset:49408
  v_mul_f32 v76, v12, v76
  v_mfma_f32_16x16x32_bf16 v[96:99], v[24:27], v[168:171], v[96:99]
  v_mul_f32 v77, v12, v77
  v_mul_f32 v78, v12, v78
  v_mfma_f32_16x16x32_bf16 v[104:107], v[24:27], v[200:203], v[104:107]
  v_mul_f32 v79, v12, v79
  v_mfma_f32_16x16x32_bf16 v[112:115], v[24:27], v[232:235], v[112:115]
  s_waitcnt lgkmcnt(5)
  v_cvt_pk_bf16_f32 v72, v72, v73
  v_mfma_f32_16x16x32_bf16 v[92:95], v[28:31], v[136:139], v[92:95]
  ds_read_b128 v[52:55], v251 offset:51456
  v_cvt_pk_bf16_f32 v73, v74, v75
  v_mfma_f32_16x16x32_bf16 v[100:103], v[28:31], v[168:171], v[100:103]
  v_cvt_pk_bf16_f32 v74, v76, v77
  v_cvt_pk_bf16_f32 v75, v78, v79
  v_mfma_f32_16x16x32_bf16 v[108:111], v[28:31], v[200:203], v[108:111]
  v_accvgpr_write_b32 a160, v72
  v_mfma_f32_16x16x32_bf16 v[116:119], v[28:31], v[232:235], v[116:119]
  s_waitcnt lgkmcnt(5)
  v_accvgpr_write_b32 a161, v73
  v_mfma_f32_16x16x32_bf16 v[88:91], v[32:35], v[140:143], v[88:91]
  v_accvgpr_write_b32 a162, v74
  v_mfma_f32_16x16x32_bf16 v[96:99], v[32:35], v[172:175], v[96:99]
  v_accvgpr_write_b32 a163, v75
  v_mul_f32 v80, v12, v80
  v_mfma_f32_16x16x32_bf16 v[104:107], v[32:35], v[204:207], v[104:107]
  v_mul_f32 v81, v12, v81
  v_mfma_f32_16x16x32_bf16 v[112:115], v[32:35], v[236:239], v[112:115]
  s_waitcnt lgkmcnt(4)
  v_mul_f32 v82, v12, v82
  v_mfma_f32_16x16x32_bf16 v[92:95], v[36:39], v[140:143], v[92:95]
  v_mul_f32 v83, v12, v83
  v_mfma_f32_16x16x32_bf16 v[100:103], v[36:39], v[172:175], v[100:103]
  v_mul_f32 v84, v12, v84
  v_mul_f32 v85, v12, v85
  v_mfma_f32_16x16x32_bf16 v[108:111], v[36:39], v[204:207], v[108:111]
  v_mul_f32 v86, v12, v86
  v_mfma_f32_16x16x32_bf16 v[116:119], v[36:39], v[236:239], v[116:119]
  s_waitcnt lgkmcnt(3)
  v_mul_f32 v87, v12, v87
  v_mfma_f32_16x16x32_bf16 v[88:91], v[40:43], v[144:147], v[88:91]
  v_cvt_pk_bf16_f32 v80, v80, v81
  v_mfma_f32_16x16x32_bf16 v[96:99], v[40:43], v[176:179], v[96:99]
  v_cvt_pk_bf16_f32 v81, v82, v83
  v_cvt_pk_bf16_f32 v82, v84, v85
  v_mfma_f32_16x16x32_bf16 v[104:107], v[40:43], v[208:211], v[104:107]
  v_cvt_pk_bf16_f32 v83, v86, v87
  v_mfma_f32_16x16x32_bf16 v[112:115], v[40:43], v[240:243], v[112:115]
  s_waitcnt lgkmcnt(2)
  v_accvgpr_write_b32 a216, v80
  v_mfma_f32_16x16x32_bf16 v[92:95], v[44:47], v[144:147], v[92:95]
  v_accvgpr_write_b32 a217, v81
  v_mfma_f32_16x16x32_bf16 v[100:103], v[44:47], v[176:179], v[100:103]
  v_accvgpr_write_b32 a218, v82
  v_accvgpr_write_b32 a219, v83
  v_mfma_f32_16x16x32_bf16 v[108:111], v[44:47], v[208:211], v[108:111]
  v_mfma_f32_16x16x32_bf16 v[116:119], v[44:47], v[240:243], v[116:119]
  s_waitcnt lgkmcnt(1)
  v_mfma_f32_16x16x32_bf16 v[88:91], v[48:51], v[148:151], v[88:91]
  v_mfma_f32_16x16x32_bf16 v[96:99], v[48:51], v[180:183], v[96:99]
  v_mfma_f32_16x16x32_bf16 v[104:107], v[48:51], v[212:215], v[104:107]
  v_mfma_f32_16x16x32_bf16 v[112:115], v[48:51], v[244:247], v[112:115]
  s_waitcnt lgkmcnt(0)
  v_mfma_f32_16x16x32_bf16 v[92:95], v[52:55], v[148:151], v[92:95]
  v_mfma_f32_16x16x32_bf16 v[100:103], v[52:55], v[180:183], v[100:103]
  v_mfma_f32_16x16x32_bf16 v[108:111], v[52:55], v[212:215], v[108:111]
  v_mfma_f32_16x16x32_bf16 v[116:119], v[52:55], v[244:247], v[116:119]
  v_mul_f32 v88, v12, v88
  v_mul_f32 v89, v12, v89
  v_mul_f32 v90, v12, v90
  v_mul_f32 v91, v12, v91
  v_mul_f32 v92, v12, v92
  v_mul_f32 v93, v12, v93
  v_mul_f32 v94, v12, v94
  v_mul_f32 v95, v12, v95
  v_cvt_pk_bf16_f32 v88, v88, v89
  v_cvt_pk_bf16_f32 v89, v90, v91
  v_cvt_pk_bf16_f32 v90, v92, v93
  v_cvt_pk_bf16_f32 v91, v94, v95
  v_accvgpr_write_b32 a52, v88
  v_accvgpr_write_b32 a53, v89
  v_accvgpr_write_b32 a54, v90
  v_accvgpr_write_b32 a55, v91
  v_mul_f32 v96, v12, v96
  v_mul_f32 v97, v12, v97
  v_mul_f32 v98, v12, v98
  v_mul_f32 v99, v12, v99
  v_mul_f32 v100, v12, v100
  v_mul_f32 v101, v12, v101
  v_mul_f32 v102, v12, v102
  v_mul_f32 v103, v12, v103
  v_cvt_pk_bf16_f32 v96, v96, v97
  v_cvt_pk_bf16_f32 v97, v98, v99
  v_cvt_pk_bf16_f32 v98, v100, v101
  v_cvt_pk_bf16_f32 v99, v102, v103
  v_accvgpr_write_b32 a108, v96
  v_accvgpr_write_b32 a109, v97
  v_accvgpr_write_b32 a110, v98
  v_accvgpr_write_b32 a111, v99
  v_mul_f32 v104, v12, v104
  v_mul_f32 v105, v12, v105
  v_mul_f32 v106, v12, v106
  v_mul_f32 v107, v12, v107
  v_mul_f32 v108, v12, v108
  v_mul_f32 v109, v12, v109
  v_mul_f32 v110, v12, v110
  v_mul_f32 v111, v12, v111
  v_cvt_pk_bf16_f32 v104, v104, v105
  v_cvt_pk_bf16_f32 v105, v106, v107
  v_cvt_pk_bf16_f32 v106, v108, v109
  v_cvt_pk_bf16_f32 v107, v110, v111
  v_accvgpr_write_b32 a164, v104
  v_accvgpr_write_b32 a165, v105
  v_accvgpr_write_b32 a166, v106
  v_accvgpr_write_b32 a167, v107
  v_mul_f32 v112, v12, v112
  v_mul_f32 v113, v12, v113
  v_mul_f32 v114, v12, v114
  v_mul_f32 v115, v12, v115
  v_mul_f32 v116, v12, v116
  v_mul_f32 v117, v12, v117
  v_mul_f32 v118, v12, v118
  v_mul_f32 v119, v12, v119
  v_cvt_pk_bf16_f32 v112, v112, v113
  v_cvt_pk_bf16_f32 v113, v114, v115
  v_cvt_pk_bf16_f32 v114, v116, v117
  v_cvt_pk_bf16_f32 v115, v118, v119
  v_accvgpr_write_b32 a220, v112
  v_accvgpr_write_b32 a221, v113
  v_accvgpr_write_b32 a222, v114
  v_accvgpr_write_b32 a223, v115
  s_waitcnt vmcnt(0)
  s_barrier
  v_readfirstlane_b32 s84, v13
  v_readfirstlane_b32 s85, v10
  v_readfirstlane_b32 s22, v11
  s_and_b32 s86, s86, s22
  s_cmp_eq_u32 s86, 1
  s_cselect_b32 s84, s84, 0
  v_and_b32 v10, 0xffe0, v9
  v_cmp_eq_u32 vcc, 0, v10
  s_cbranch_vccz ch_md_ok
ch_role2:
  s_mov_b32 s30, 0
ch_md:
  buffer_load_dword v9, off, s[12:15], 0 sc1
  s_waitcnt vmcnt(0)
  v_and_b32 v10, 0xffe0, v9
  v_cmp_eq_u32 vcc, 0, v10
  s_cbranch_vccz ch_md_ok
  s_sleep 4
  s_add_u32 s30, s30, 1
  s_cmp_lt_u32 s30, 1600000
  s_cbranch_scc1 ch_md
  s_branch ch_end
ch_md_ok:
  v_readfirstlane_b32 s88, v9
  s_lshr_b32 s88, s88, 16
  v_and_b32 v1, 63, v0
  v_lshlrev_b32 v2, 4, v1
  v_lshrrev_b32 v116, 4, v1
  v_and_b32 v117, 15, v1
  v_mov_b32 v3, 0x4444
  v_mov_b32 v118, 0xeeee
  v_cmp_lt_u32 vcc, 7, v117
  s_nop 1
  v_cndmask_b32 v3, v3, v118, vcc
  s_mov_b32 s19, 0
  s_mov_b32 s18, 1
  s_mov_b32 s20, 0
  s_mov_b32 s21, 17664
  s_mov_b32 s23, 4096
  s_lshr_b32 s89, s17, 4
  s_lshl_b32 s89, s89, 2
  s_add_u32 s89, s89, s16
  s_and_b32 s17, s17, 15
  s_cmp_eq_u32 s89, 0
  s_cbranch_scc1 ch_init0
  s_cmp_eq_u32 s89, 1
  s_cbranch_scc1 ch_init1
  s_cmp_eq_u32 s89, 2
  s_cbranch_scc1 ch_init2
  s_cmp_eq_u32 s89, 3
  s_cbranch_scc1 ch_init3
  s_cmp_eq_u32 s89, 4
  s_cbranch_scc1 ch_init4
  s_cmp_eq_u32 s89, 5
  s_cbranch_scc1 ch_init5
  s_cmp_eq_u32 s89, 6
  s_cbranch_scc1 ch_init6
  s_cmp_eq_u32 s89, 7
  s_cbranch_scc1 ch_init7
  s_branch ch_end
ch_init0:
  s_mul_i32 s31, s17, 401408
  s_add_u32 s31, s31, 33554432
  s_and_b32 s28, s84, 10320
  s_lshl_b32 s22, s85, 16
  s_or_b32 s28, s28, s22
  s_cmp_eq_u32 s28, 4294912080
  s_cbranch_scc1 ch_wx0_ok
  s_mov_b32 s30, 0
ch_wr0:
  buffer_load_dword v9, off, s[12:15], 0 offset:132 sc1
  s_waitcnt vmcnt(0)
  v_cmp_ne_u32 vcc, 1, v9
  s_cbranch_vccz ch_wr0_ok
  s_sleep 8
  s_add_u32 s30, s30, 1
  s_cmp_lt_u32 s30, 400000
  s_cbranch_scc1 ch_wr0
  s_branch cA_abort
ch_wr0_ok:
  s_lshl_b32 s27, s17, 7
  s_add_u32 s27, s27, 584192
  s_mov_b32 s28, 10320
  s_mov_b32 s30, 0
ch_wb0:
  buffer_load_dword v9, off, s[8:11], s27  sc1
  s_waitcnt vmcnt(0)
  v_and_b32 v10, s28, v9
  v_cmp_ne_u32 vcc, s28, v10
  s_cbranch_vccz ch_wb0_ok
  s_sleep 3
  s_add_u32 s30, s30, 1
  s_cmp_lt_u32 s30, 400000
  s_cbranch_scc1 ch_wb0
  s_branch cA_abort
ch_wb0_ok:
  s_mov_b32 s29, 586240
  s_mov_b32 s28, 0xffff
  s_mov_b32 s30, 0
ch_wx0:
  buffer_load_dword v9, off, s[8:11], s29  sc1
  s_waitcnt vmcnt(0)
  v_and_b32 v10, s28, v9
  v_cmp_ne_u32 vcc, s28, v10
  s_cbranch_vccz ch_wx0_ok
  s_sleep 8
  s_add_u32 s30, s30, 1
  s_cmp_lt_u32 s30, 400000
  s_cbranch_scc1 ch_wx0
  s_branch cA_abort
ch_wx0_ok:
  s_add_u32 s22, s31, 229376
  buffer_load_dwordx4 a[224:227], v2, s[8:11], s22 offen offset:0 sc1
  buffer_load_dwordx4 a[228:231], v2, s[8:11], s22 offen offset:1024 sc1
  buffer_load_dwordx4 a[232:235], v2, s[8:11], s22 offen offset:2048 sc1
  buffer_load_dwordx4 a[236:239], v2, s[8:11], s22 offen offset:3072 sc1
  s_add_u32 s22, s31, 233472
  buffer_load_dwordx4 a[240:243], v2, s[8:11], s22 offen offset:0 sc1
  buffer_load_dwordx4 a[244:247], v2, s[8:11], s22 offen offset:1024 sc1
  buffer_load_dwordx4 a[248:251], v2, s[8:11], s22 offen offset:2048 sc1
  buffer_load_dwordx4 a[252:255], v2, s[8:11], s22 offen offset:3072 sc1
  s_add_u32 s22, s31, 237568
  buffer_load_dwordx4 v[120:123], v2, s[8:11], s22 offen offset:0 sc1
  buffer_load_dwordx4 v[124:127], v2, s[8:11], s22 offen offset:1024 sc1
  buffer_load_dwordx4 v[128:131], v2, s[8:11], s22 offen offset:2048 sc1
  buffer_load_dwordx4 v[132:135], v2, s[8:11], s22 offen offset:3072 sc1
  s_add_u32 s22, s31, 241664
  buffer_load_dwordx4 v[136:139], v2, s[8:11], s22 offen offset:0 sc1
  buffer_load_dwordx4 v[140:143], v2, s[8:11], s22 offen offset:1024 sc1
  buffer_load_dwordx4 v[144:147], v2, s[8:11], s22 offen offset:2048 sc1
  buffer_load_dwordx4 v[148:151], v2, s[8:11], s22 offen offset:3072 sc1
  s_add_u32 s22, s31, 245760
  buffer_load_dwordx4 v[152:155], v2, s[8:11], s22 offen offset:0 sc1
  buffer_load_dwordx4 v[156:159], v2, s[8:11], s22 offen offset:1024 sc1
  buffer_load_dwordx4 v[160:163], v2, s[8:11], s22 offen offset:2048 sc1
  buffer_load_dwordx4 v[164:167], v2, s[8:11], s22 offen offset:3072 sc1
  s_add_u32 s22, s31, 249856
  buffer_load_dwordx4 v[168:171], v2, s[8:11], s22 offen offset:0 sc1
  buffer_load_dwordx4 v[172:175], v2, s[8:11], s22 offen offset:1024 sc1
  buffer_load_dwordx4 v[176:179], v2, s[8:11], s22 offen offset:2048 sc1
  buffer_load_dwordx4 v[180:183], v2, s[8:11], s22 offen offset:3072 sc1
  s_mov_b32 s24, 655360
  s_mov_b32 s26, 669696
  v_and_b32 v64, 7, v117
  v_and_b32 v65, 1, v116
  v_lshlrev_b32 v65, 2, v65
  v_sub_u32 v64, v64, v65
  v_lshrrev_b32 v65, 3, v117
  v_lshl_add_u32 v66, v65, 2, v64
  v_cmp_gt_u32 vcc, 4, v64
  v_mov_b32 v67, 99
  s_nop 0
  v_cndmask_b32 v66, v67, v66, vcc
  v_mov_b32 v68, 0x3f80
  v_mov_b32 v69, 0x3f800000
  v_mov_b32 v4, 0
  v_cmp_eq_u32 vcc, 0, v66
  s_nop 1
  v_cndmask_b32 v4, v4, v68, vcc
  v_cmp_eq_u32 vcc, 1, v66
  s_nop 1
  v_cndmask_b32 v4, v4, v69, vcc
  v_mov_b32 v5, 0
  v_cmp_eq_u32 vcc, 2, v66
  s_nop 1
  v_cndmask_b32 v5, v5, v68, vcc
  v_cmp_eq_u32 vcc, 3, v66
  s_nop 1
  v_cndmask_b32 v5, v5, v69, vcc
  v_mov_b32 v6, 0
  v_cmp_eq_u32 vcc, 4, v66
  s_nop 1
  v_cndmask_b32 v6, v6, v68, vcc
  v_cmp_eq_u32 vcc, 5, v66
  s_nop 1
  v_cndmask_b32 v6, v6, v69, vcc
  v_mov_b32 v7, 0
  v_cmp_eq_u32 vcc, 6, v66
  s_nop 1
  v_cndmask_b32 v7, v7, v68, vcc
  v_cmp_eq_u32 vcc, 7, v66
  s_nop 1
  v_cndmask_b32 v7, v7, v69, vcc
  v_lshrrev_b32 v64, 1, v116
  v_lshrrev_b32 v65, 3, v117
  v_and_b32 v66, 1, v116
  v_and_b32 v68, 7, v117
  v_lshlrev_b32 v67, 8, v65
  v_lshl_add_u32 v67, v68, 5, v67
  v_lshl_add_u32 v67, v66, 4, v67
  v_add_u32 v69, 4096, v67
  v_add_u32 v70, 6400, v67
  v_cmp_eq_u32 vcc, v64, v65
  s_nop 1
  v_cndmask_b32 v113, v70, v69, vcc
  v_and_b32 v74, 3, v117
  v_lshlrev_b32 v74, 1, v74
  v_bfe_u32 v75, v117, 2, 1
  v_or_b32 v74, v74, v75
  v_and_b32 v75, 8, v117
  v_or_b32 v74, v74, v75
  v_lshlrev_b32 v67, 9, v64
  v_lshl_add_u32 v67, v74, 4, v67
  v_lshl_add_u32 v67, v66, 3, v67
  v_add_u32 v114, 0, v67
  v_mul_u32_u24 v67, 1088, v65
  v_lshl_add_u32 v67, v116, 5, v67
  v_and_b32 v75, 1, v117
  v_and_b32 v76, 2, v117
  v_lshl_add_u32 v75, v76, 1, v75
  v_bfe_u32 v76, v117, 2, 1
  v_lshl_add_u32 v75, v76, 1, v75
  v_lshl_add_u32 v67, v75, 2, v67
  v_add_u32 v115, 4096, v67
  v_and_b32 v69, 1, v74
  v_lshlrev_b32 v67, 7, v69
  v_lshl_add_u32 v67, v116, 4, v67
  v_lshl_add_u32 v67, v65, 8, v67
  v_bfe_u32 v69, v74, 1, 2
  v_lshl_add_u32 v67, v69, 2, v67
  s_lshl_b32 s22, s17, 9
  s_add_u32 s22, s22, 9216
  v_add_u32 v72, s22, v67
  v_bfe_u32 v69, v75, 1, 1
  v_lshlrev_b32 v67, 7, v69
  v_lshl_add_u32 v67, v116, 4, v67
  v_and_b32 v69, 4, v75
  v_add_u32 v67, v67, v69
  s_lshr_b32 s22, s17, 1
  s_lshl_b32 s22, s22, 8
  s_and_b32 s27, s17, 1
  s_lshl_b32 s27, s27, 3
  s_add_u32 s22, s22, s27
  s_add_u32 s22, s22, 7168
  v_add_u32 v67, s22, v67
  v_and_b32 v69, 9, v117
  v_mov_b32 v70, 0x40000000
  v_cmp_eq_u32 vcc, 0, v69
  s_nop 1
  v_cndmask_b32 v118, v70, v67, vcc
  v_mov_b32 v119, -1
  v_and_b32 v0, 15, v1
  s_and_b32 s22, s17, 0
  s_lshl_b32 s22, s22, 7
  s_add_u32 s22, s22, 37248
  v_lshl_add_u32 v0, v0, 2, s22
  v_xor_b32 v69, 256, v2
  v_mul_i32_i24 v70, -4096, v66
  v_add_u32 v69, v69, v70
  v_add_u32 v117, 12288, v69
  v_mov_b32 v116, v73
  v_mov_b32 v112, 0
  s_mul_i32 s35, s17, 28672
  s_add_u32 s33, s35, 2949120
  s_mov_b32 s34, 0
  s_add_u32 s35, s35, 4325376
  v_mov_b32 v1, v72
  v_mov_b32 v36, 0
  v_mov_b32 v37, 0
  v_mov_b32 v38, 0
  v_mov_b32 v39, 0
  v_mov_b32 v40, 0
  v_mov_b32 v41, 0
  v_mov_b32 v42, 0
  v_mov_b32 v43, 0
  v_mov_b32 v44, 0
  v_mov_b32 v45, 0
  v_mov_b32 v46, 0
  v_mov_b32 v47, 0
  v_mov_b32 v48, 0
  v_mov_b32 v49, 0
  v_mov_b32 v50, 0
  v_mov_b32 v51, 0
  v_mov_b32 v52, 0
  v_mov_b32 v53, 0
  v_mov_b32 v54, 0
  v_mov_b32 v55, 0
  v_mov_b32 v56, 0
  v_mov_b32 v57, 0
  v_mov_b32 v58, 0
  v_mov_b32 v59, 0
  v_mov_b32 v60, 0
  v_mov_b32 v61, 0
  v_mov_b32 v62, 0
  v_mov_b32 v63, 0
  v_mov_b32 v64, 0
  v_mov_b32 v65, 0
  v_mov_b32 v66, 0
  v_mov_b32 v67, 0
  v_mov_b32 v68, 0
  v_mov_b32 v69, 0
  v_mov_b32 v70, 0
  v_mov_b32 v71, 0
  v_mov_b32 v72, 0
  v_mov_b32 v73, 0
  v_mov_b32 v74, 0
  v_mov_b32 v75, 0
  v_mov_b32 v76, 0
  v_mov_b32 v77, 0
  v_mov_b32 v78, 0
  v_mov_b32 v79, 0
  s_mov_b32 s22, 0
  v_lshrrev_b32 v14, 4, v2
  v_add_u32 v14, 0, v14
  v_min_u32 v14, 308, v14
  v_lshlrev_b32 v14, 7, v14
  buffer_load_dword v15, v14, s[8:11], s22 offen sc1
  v_lshrrev_b32 v14, 4, v2
  v_add_u32 v14, 256, v14
  v_min_u32 v14, 308, v14
  v_lshlrev_b32 v14, 7, v14
  buffer_load_dword v15, v14, s[8:11], s22 offen sc1
  v_lshlrev_b32 v16, 2, v2
  s_getpc_b64 s[98:99]
ct_5:
  s_add_u32 s98, s98, cA_sc0_loop-ct_5
  s_addc_u32 s99, s99, 0
  global_load_dword v15, v16, s[98:99]
  buffer_load_dwordx4 v[80:83], v117, s[8:11], s24 offen offset:0 sc1
  buffer_load_dwordx4 v[84:87], v117, s[8:11], s24 offen offset:1024 sc1
  buffer_load_dwordx4 v[88:91], v117, s[8:11], s26 offen offset:0 sc1
  buffer_load_dwordx4 v[92:95], v117, s[8:11], s26 offen offset:1024 sc1
  buffer_load_dwordx4 v[96:99], v2, s[8:11], s24 offen offset:0 sc1
  buffer_load_dwordx4 v[100:103], v2, s[8:11], s24 offen offset:1024 sc1
  buffer_load_dwordx4 v[104:107], v2, s[8:11], s26 offen offset:0 sc1
  buffer_load_dwordx4 v[108:111], v2, s[8:11], s26 offen offset:1024 sc1
  s_add_u32 s22, s31, 253952
  buffer_load_dwordx4 v[184:187], v2, s[8:11], s22 offen offset:0 sc1
  buffer_load_dwordx4 v[188:191], v2, s[8:11], s22 offen offset:1024 sc1
  buffer_load_dwordx4 v[192:195], v2, s[8:11], s22 offen offset:2048 sc1
  buffer_load_dwordx4 v[196:199], v2, s[8:11], s22 offen offset:3072 sc1
  s_add_u32 s22, s31, 372736
  buffer_load_dwordx4 v[200:203], v2, s[8:11], s22 offen offset:0 sc1
  buffer_load_dwordx4 v[204:207], v2, s[8:11], s22 offen offset:1024 sc1
  buffer_load_dwordx4 v[208:211], v2, s[8:11], s22 offen offset:2048 sc1
  buffer_load_dwordx4 v[212:215], v2, s[8:11], s22 offen offset:3072 sc1
  s_add_u32 s22, s31, 376832
  buffer_load_dwordx4 v[216:219], v2, s[8:11], s22 offen offset:0 sc1
  buffer_load_dwordx4 v[220:223], v2, s[8:11], s22 offen offset:1024 sc1
  buffer_load_dwordx4 v[224:227], v2, s[8:11], s22 offen offset:2048 sc1
  buffer_load_dwordx4 v[228:231], v2, s[8:11], s22 offen offset:3072 sc1
  s_add_u32 s22, s31, 380928
  buffer_load_dwordx4 v[232:235], v2, s[8:11], s22 offen offset:0 sc1
  buffer_load_dwordx4 v[236:239], v2, s[8:11], s22 offen offset:1024 sc1
  buffer_load_dwordx4 v[240:243], v2, s[8:11], s22 offen offset:2048 sc1
  buffer_load_dwordx4 v[244:247], v2, s[8:11], s22 offen offset:3072 sc1
  s_add_u32 s22, s31, 385024
  buffer_load_dwordx4 v[248:251], v2, s[8:11], s22 offen offset:0 sc1
  buffer_load_dwordx4 v[252:255], v2, s[8:11], s22 offen offset:1024 sc1
  s_waitcnt vmcnt(0) lgkmcnt(0)
  s_mov_b32 s31, 0
  s_cmp_lg_u32 s88, 0
  s_cbranch_scc1 cB_sc0_loop
  s_branch cA_sc0_loop
ch_init1:
  s_mul_i32 s31, s17, 401408
  s_add_u32 s31, s31, 33554432
  s_and_b32 s28, s84, 10320
  s_lshl_b32 s22, s85, 16
  s_or_b32 s28, s28, s22
  s_cmp_eq_u32 s28, 4294912080
  s_cbranch_scc1 ch_wx1_ok
  s_mov_b32 s30, 0
ch_wr1:
  buffer_load_dword v9, off, s[12:15], 0 offset:132 sc1
  s_waitcnt vmcnt(0)
  v_cmp_ne_u32 vcc, 1, v9
  s_cbranch_vccz ch_wr1_ok
  s_sleep 8
  s_add_u32 s30, s30, 1
  s_cmp_lt_u32 s30, 400000
  s_cbranch_scc1 ch_wr1
  s_branch cA_abort
ch_wr1_ok:
  s_lshl_b32 s27, s17, 7
  s_add_u32 s27, s27, 584192
  s_mov_b32 s28, 10320
  s_mov_b32 s30, 0
ch_wb1:
  buffer_load_dword v9, off, s[8:11], s27  sc1
  s_waitcnt vmcnt(0)
  v_and_b32 v10, s28, v9
  v_cmp_ne_u32 vcc, s28, v10
  s_cbranch_vccz ch_wb1_ok
  s_sleep 3
  s_add_u32 s30, s30, 1
  s_cmp_lt_u32 s30, 400000
  s_cbranch_scc1 ch_wb1
  s_branch cA_abort
ch_wb1_ok:
  s_mov_b32 s29, 586240
  s_mov_b32 s28, 0xffff
  s_mov_b32 s30, 0
ch_wx1:
  buffer_load_dword v9, off, s[8:11], s29  sc1
  s_waitcnt vmcnt(0)
  v_and_b32 v10, s28, v9
  v_cmp_ne_u32 vcc, s28, v10
  s_cbranch_vccz ch_wx1_ok
  s_sleep 8
  s_add_u32 s30, s30, 1
  s_cmp_lt_u32 s30, 400000
  s_cbranch_scc1 ch_wx1
  s_branch cA_abort
ch_wx1_ok:
  s_add_u32 s22, s31, 258048
  buffer_load_dwordx4 a[224:227], v2, s[8:11], s22 offen offset:0 sc1
  buffer_load_dwordx4 a[228:231], v2, s[8:11], s22 offen offset:1024 sc1
  buffer_load_dwordx4 a[232:235], v2, s[8:11], s22 offen offset:2048 sc1
  buffer_load_dwordx4 a[236:239], v2, s[8:11], s22 offen offset:3072 sc1
  s_add_u32 s22, s31, 262144
  buffer_load_dwordx4 a[240:243], v2, s[8:11], s22 offen offset:0 sc1
  buffer_load_dwordx4 a[244:247], v2, s[8:11], s22 offen offset:1024 sc1
  buffer_load_dwordx4 a[248:251], v2, s[8:11], s22 offen offset:2048 sc1
  buffer_load_dwordx4 a[252:255], v2, s[8:11], s22 offen offset:3072 sc1
  s_add_u32 s22, s31, 266240
  buffer_load_dwordx4 v[120:123], v2, s[8:11], s22 offen offset:0 sc1
  buffer_load_dwordx4 v[124:127], v2, s[8:11], s22 offen offset:1024 sc1
  buffer_load_dwordx4 v[128:131], v2, s[8:11], s22 offen offset:2048 sc1
  buffer_load_dwordx4 v[132:135], v2, s[8:11], s22 offen offset:3072 sc1
  s_add_u32 s22, s31, 270336
  buffer_load_dwordx4 v[136:139], v2, s[8:11], s22 offen offset:0 sc1
  buffer_load_dwordx4 v[140:143], v2, s[8:11], s22 offen offset:1024 sc1
  buffer_load_dwordx4 v[144:147], v2, s[8:11], s22 offen offset:2048 sc1
  buffer_load_dwordx4 v[148:151], v2, s[8:11], s22 offen offset:3072 sc1
  s_add_u32 s22, s31, 274432
  buffer_load_dwordx4 v[152:155], v2, s[8:11], s22 offen offset:0 sc1
  buffer_load_dwordx4 v[156:159], v2, s[8:11], s22 offen offset:1024 sc1
  buffer_load_dwordx4 v[160:163], v2, s[8:11], s22 offen offset:2048 sc1
  buffer_load_dwordx4 v[164:167], v2, s[8:11], s22 offen offset:3072 sc1
  s_add_u32 s22, s31, 278528
  buffer_load_dwordx4 v[168:171], v2, s[8:11], s22 offen offset:0 sc1
  buffer_load_dwordx4 v[172:175], v2, s[8:11], s22 offen offset:1024 sc1
  buffer_load_dwordx4 v[176:179], v2, s[8:11], s22 offen offset:2048 sc1
  buffer_load_dwordx4 v[180:183], v2, s[8:11], s22 offen offset:3072 sc1
  s_mov_b32 s24, 657408
  s_mov_b32 s26, 671744
  v_and_b32 v64, 7, v117
  v_and_b32 v65, 1, v116
  v_lshlrev_b32 v65, 2, v65
  v_sub_u32 v64, v64, v65
  v_lshrrev_b32 v65, 3, v117
  v_lshl_add_u32 v66, v65, 2, v64
  v_cmp_gt_u32 vcc, 4, v64
  v_mov_b32 v67, 99
  s_nop 0
  v_cndmask_b32 v66, v67, v66, vcc
  v_mov_b32 v68, 0x3f80
  v_mov_b32 v69, 0x3f800000
  v_mov_b32 v4, 0
  v_cmp_eq_u32 vcc, 0, v66
  s_nop 1
  v_cndmask_b32 v4, v4, v68, vcc
  v_cmp_eq_u32 vcc, 1, v66
  s_nop 1
  v_cndmask_b32 v4, v4, v69, vcc
  v_mov_b32 v5, 0
  v_cmp_eq_u32 vcc, 2, v66
  s_nop 1
  v_cndmask_b32 v5, v5, v68, vcc
  v_cmp_eq_u32 vcc, 3, v66
  s_nop 1
  v_cndmask_b32 v5, v5, v69, vcc
  v_mov_b32 v6, 0
  v_cmp_eq_u32 vcc, 4, v66
  s_nop 1
  v_cndmask_b32 v6, v6, v68, vcc
  v_cmp_eq_u32 vcc, 5, v66
  s_nop 1
  v_cndmask_b32 v6, v6, v69, vcc
  v_mov_b32 v7, 0
  v_cmp_eq_u32 vcc, 6, v66
  s_nop 1
  v_cndmask_b32 v7, v7, v68, vcc
  v_cmp_eq_u32 vcc, 7, v66
  s_nop 1
  v_cndmask_b32 v7, v7, v69, vcc
  v_lshrrev_b32 v64, 1, v116
  v_lshrrev_b32 v65, 3, v117
  v_and_b32 v66, 1, v116
  v_and_b32 v68, 7, v117
  v_lshlrev_b32 v67, 8, v65
  v_lshl_add_u32 v67, v68, 5, v67
  v_lshl_add_u32 v67, v66, 4, v67
  v_add_u32 v69, 4608, v67
  v_add_u32 v70, 6400, v67
  v_cmp_eq_u32 vcc, v64, v65
  s_nop 1
  v_cndmask_b32 v113, v70, v69, vcc
  v_and_b32 v74, 3, v117
  v_lshlrev_b32 v74, 1, v74
  v_bfe_u32 v75, v117, 2, 1
  v_or_b32 v74, v74, v75
  v_and_b32 v75, 8, v117
  v_or_b32 v74, v74, v75
  v_lshlrev_b32 v67, 9, v64
  v_lshl_add_u32 v67, v74, 4, v67
  v_lshl_add_u32 v67, v66, 3, v67
  v_add_u32 v114, 256, v67
  v_mul_u32_u24 v67, 1088, v65
  v_lshl_add_u32 v67, v116, 5, v67
  v_and_b32 v75, 1, v117
  v_and_b32 v76, 2, v117
  v_lshl_add_u32 v75, v76, 1, v75
  v_bfe_u32 v76, v117, 2, 1
  v_lshl_add_u32 v75, v76, 1, v75
  v_lshl_add_u32 v67, v75, 2, v67
  v_add_u32 v115, 4224, v67
  v_and_b32 v69, 1, v74
  v_lshlrev_b32 v67, 7, v69
  v_lshl_add_u32 v67, v116, 4, v67
  v_lshl_add_u32 v67, v65, 8, v67
  v_bfe_u32 v69, v74, 1, 2
  v_lshl_add_u32 v67, v69, 2, v67
  s_lshl_b32 s22, s17, 9
  s_add_u32 s22, s22, 9280
  v_add_u32 v72, s22, v67
  v_bfe_u32 v69, v75, 1, 1
  v_lshlrev_b32 v67, 7, v69
  v_lshl_add_u32 v67, v116, 4, v67
  v_and_b32 v69, 4, v75
  v_add_u32 v67, v67, v69
  s_lshr_b32 s22, s17, 1
  s_lshl_b32 s22, s22, 8
  s_and_b32 s27, s17, 1
  s_lshl_b32 s27, s27, 3
  s_add_u32 s22, s22, s27
  s_add_u32 s22, s22, 7232
  v_add_u32 v67, s22, v67
  v_and_b32 v69, 9, v117
  v_mov_b32 v70, 0x40000000
  v_cmp_eq_u32 vcc, 0, v69
  s_nop 1
  v_cndmask_b32 v118, v70, v67, vcc
  v_mov_b32 v119, -1
  s_lshl_b32 s22, s17, 2
  s_add_u32 s22, s22, 35328
  v_lshl_add_u32 v67, v1, 7, s22
  v_mov_b32 v70, 0x40000000
  v_cmp_gt_u32 vcc, 1, v1
  s_nop 1
  v_cndmask_b32 v73, v70, v67, vcc
  v_mov_b32 v112, 1
  v_and_b32 v0, 15, v1
  s_and_b32 s22, s17, 0
  s_lshl_b32 s22, s22, 7
  s_add_u32 s22, s22, 37248
  v_lshl_add_u32 v0, v0, 2, s22
  v_xor_b32 v69, 256, v2
  v_mul_i32_i24 v70, 4096, v66
  v_add_u32 v69, v69, v70
  v_add_u32 v117, 6144, v69
  v_mov_b32 v116, v73
  s_mul_i32 s35, s17, 28672
  s_add_u32 s33, s35, 2949120
  s_mov_b32 s34, 0
  s_add_u32 s35, s35, 4325376
  v_mov_b32 v1, v72
  v_mov_b32 v36, 0
  v_mov_b32 v37, 0
  v_mov_b32 v38, 0
  v_mov_b32 v39, 0
  v_mov_b32 v40, 0
  v_mov_b32 v41, 0
  v_mov_b32 v42, 0
  v_mov_b32 v43, 0
  v_mov_b32 v44, 0
  v_mov_b32 v45, 0
  v_mov_b32 v46, 0
  v_mov_b32 v47, 0
  v_mov_b32 v48, 0
  v_mov_b32 v49, 0
  v_mov_b32 v50, 0
  v_mov_b32 v51, 0
  v_mov_b32 v52, 0
  v_mov_b32 v53, 0
  v_mov_b32 v54, 0
  v_mov_b32 v55, 0
  v_mov_b32 v56, 0
  v_mov_b32 v57, 0
  v_mov_b32 v58, 0
  v_mov_b32 v59, 0
  v_mov_b32 v60, 0
  v_mov_b32 v61, 0
  v_mov_b32 v62, 0
  v_mov_b32 v63, 0
  v_mov_b32 v64, 0
  v_mov_b32 v65, 0
  v_mov_b32 v66, 0
  v_mov_b32 v67, 0
  v_mov_b32 v68, 0
  v_mov_b32 v69, 0
  v_mov_b32 v70, 0
  v_mov_b32 v71, 0
  v_mov_b32 v72, 0
  v_mov_b32 v73, 0
  v_mov_b32 v74, 0
  v_mov_b32 v75, 0
  v_mov_b32 v76, 0
  v_mov_b32 v77, 0
  v_mov_b32 v78, 0
  v_mov_b32 v79, 0
  s_mov_b32 s22, 0
  v_lshrrev_b32 v14, 4, v2
  v_add_u32 v14, 64, v14
  v_min_u32 v14, 308, v14
  v_lshlrev_b32 v14, 7, v14
  buffer_load_dword v15, v14, s[8:11], s22 offen sc1
  v_lshlrev_b32 v16, 2, v2
  s_getpc_b64 s[98:99]
ct_6:
  s_add_u32 s98, s98, cA_sc1_loop-ct_6
  s_addc_u32 s99, s99, 0
  global_load_dword v15, v16, s[98:99]
  buffer_load_dwordx4 v[80:83], v117, s[8:11], s24 offen offset:0 sc1
  buffer_load_dwordx4 v[84:87], v117, s[8:11], s24 offen offset:1024 sc1
  buffer_load_dwordx4 v[88:91], v117, s[8:11], s26 offen offset:0 sc1
  buffer_load_dwordx4 v[92:95], v117, s[8:11], s26 offen offset:1024 sc1
  buffer_load_dwordx4 v[96:99], v2, s[8:11], s24 offen offset:0 sc1
  buffer_load_dwordx4 v[100:103], v2, s[8:11], s24 offen offset:1024 sc1
  buffer_load_dwordx4 v[104:107], v2, s[8:11], s26 offen offset:0 sc1
  buffer_load_dwordx4 v[108:111], v2, s[8:11], s26 offen offset:1024 sc1
  s_add_u32 s22, s31, 282624
  buffer_load_dwordx4 v[184:187], v2, s[8:11], s22 offen offset:0 sc1
  buffer_load_dwordx4 v[188:191], v2, s[8:11], s22 offen offset:1024 sc1
  buffer_load_dwordx4 v[192:195], v2, s[8:11], s22 offen offset:2048 sc1
  buffer_load_dwordx4 v[196:199], v2, s[8:11], s22 offen offset:3072 sc1
  s_add_u32 s22, s31, 344064
  buffer_load_dwordx4 v[200:203], v2, s[8:11], s22 offen offset:0 sc1
  buffer_load_dwordx4 v[204:207], v2, s[8:11], s22 offen offset:1024 sc1
  buffer_load_dwordx4 v[208:211], v2, s[8:11], s22 offen offset:2048 sc1
  buffer_load_dwordx4 v[212:215], v2, s[8:11], s22 offen offset:3072 sc1
  s_add_u32 s22, s31, 348160
  buffer_load_dwordx4 v[216:219], v2, s[8:11], s22 offen offset:0 sc1
  buffer_load_dwordx4 v[220:223], v2, s[8:11], s22 offen offset:1024 sc1
  buffer_load_dwordx4 v[224:227], v2, s[8:11], s22 offen offset:2048 sc1
  buffer_load_dwordx4 v[228:231], v2, s[8:11], s22 offen offset:3072 sc1
  s_add_u32 s22, s31, 352256
  buffer_load_dwordx4 v[232:235], v2, s[8:11], s22 offen offset:0 sc1
  buffer_load_dwordx4 v[236:239], v2, s[8:11], s22 offen offset:1024 sc1
  buffer_load_dwordx4 v[240:243], v2, s[8:11], s22 offen offset:2048 sc1
  buffer_load_dwordx4 v[244:247], v2, s[8:11], s22 offen offset:3072 sc1
  s_add_u32 s22, s31, 356352
  buffer_load_dwordx4 v[248:251], v2, s[8:11], s22 offen offset:0 sc1
  buffer_load_dwordx4 v[252:255], v2, s[8:11], s22 offen offset:1024 sc1
  s_waitcnt vmcnt(0) lgkmcnt(0)
  s_mov_b32 s31, 0
  s_cmp_lg_u32 s88, 0
  s_cbranch_scc1 cB_sc1_loop
  s_branch cA_sc1_loop
ch_init2:
  s_mul_i32 s31, s17, 401408
  s_add_u32 s31, s31, 33554432
  s_and_b32 s28, s84, 12384
  s_lshl_b32 s22, s85, 16
  s_or_b32 s28, s28, s22
  s_cmp_eq_u32 s28, 4294914144
  s_cbranch_scc1 ch_wx2_ok
  s_mov_b32 s30, 0
ch_wr2:
  buffer_load_dword v9, off, s[12:15], 0 offset:132 sc1
  s_waitcnt vmcnt(0)
  v_cmp_ne_u32 vcc, 1, v9
  s_cbranch_vccz ch_wr2_ok
  s_sleep 8
  s_add_u32 s30, s30, 1
  s_cmp_lt_u32 s30, 400000
  s_cbranch_scc1 ch_wr2
  s_branch cA_abort
ch_wr2_ok:
  s_lshl_b32 s27, s17, 7
  s_add_u32 s27, s27, 584192
  s_mov_b32 s28, 12384
  s_mov_b32 s30, 0
ch_wb2:
  buffer_load_dword v9, off, s[8:11], s27  sc1
  s_waitcnt vmcnt(0)
  v_and_b32 v10, s28, v9
  v_cmp_ne_u32 vcc, s28, v10
  s_cbranch_vccz ch_wb2_ok
  s_sleep 3
  s_add_u32 s30, s30, 1
  s_cmp_lt_u32 s30, 400000
  s_cbranch_scc1 ch_wb2
  s_branch cA_abort
ch_wb2_ok:
  s_mov_b32 s29, 586240
  s_mov_b32 s28, 0xffff
  s_mov_b32 s30, 0
ch_wx2:
  buffer_load_dword v9, off, s[8:11], s29  sc1
  s_waitcnt vmcnt(0)
  v_and_b32 v10, s28, v9
  v_cmp_ne_u32 vcc, s28, v10
  s_cbranch_vccz ch_wx2_ok
  s_sleep 8
  s_add_u32 s30, s30, 1
  s_cmp_lt_u32 s30, 400000
  s_cbranch_scc1 ch_wx2
  s_branch cA_abort
ch_wx2_ok:
  s_add_u32 s22, s31, 286720
  buffer_load_dwordx4 a[224:227], v2, s[8:11], s22 offen offset:0 sc1
  buffer_load_dwordx4 a[228:231], v2, s[8:11], s22 offen offset:1024 sc1
  buffer_load_dwordx4 a[232:235], v2, s[8:11], s22 offen offset:2048 sc1
  buffer_load_dwordx4 a[236:239], v2, s[8:11], s22 offen offset:3072 sc1
  s_add_u32 s22, s31, 290816
  buffer_load_dwordx4 a[240:243], v2, s[8:11], s22 offen offset:0 sc1
  buffer_load_dwordx4 a[244:247], v2, s[8:11], s22 offen offset:1024 sc1
  buffer_load_dwordx4 a[248:251], v2, s[8:11], s22 offen offset:2048 sc1
  buffer_load_dwordx4 a[252:255], v2, s[8:11], s22 offen offset:3072 sc1
  s_add_u32 s22, s31, 294912
  buffer_load_dwordx4 v[120:123], v2, s[8:11], s22 offen offset:0 sc1
  buffer_load_dwordx4 v[124:127], v2, s[8:11], s22 offen offset:1024 sc1
  buffer_load_dwordx4 v[128:131], v2, s[8:11], s22 offen offset:2048 sc1
  buffer_load_dwordx4 v[132:135], v2, s[8:11], s22 offen offset:3072 sc1
  s_add_u32 s22, s31, 299008
  buffer_load_dwordx4 v[136:139], v2, s[8:11], s22 offen offset:0 sc1
  buffer_load_dwordx4 v[140:143], v2, s[8:11], s22 offen offset:1024 sc1
  buffer_load_dwordx4 v[144:147], v2, s[8:11], s22 offen offset:2048 sc1
  buffer_load_dwordx4 v[148:151], v2, s[8:11], s22 offen offset:3072 sc1
  s_add_u32 s22, s31, 303104
  buffer_load_dwordx4 v[152:155], v2, s[8:11], s22 offen offset:0 sc1
  buffer_load_dwordx4 v[156:159], v2, s[8:11], s22 offen offset:1024 sc1
  buffer_load_dwordx4 v[160:163], v2, s[8:11], s22 offen offset:2048 sc1
  buffer_load_dwordx4 v[164:167], v2, s[8:11], s22 offen offset:3072 sc1
  s_add_u32 s22, s31, 307200
  buffer_load_dwordx4 v[168:171], v2, s[8:11], s22 offen offset:0 sc1
  buffer_load_dwordx4 v[172:175], v2, s[8:11], s22 offen offset:1024 sc1
  buffer_load_dwordx4 v[176:179], v2, s[8:11], s22 offen offset:2048 sc1
  buffer_load_dwordx4 v[180:183], v2, s[8:11], s22 offen offset:3072 sc1
  s_mov_b32 s24, 659456
  s_mov_b32 s26, 673792
  v_and_b32 v64, 7, v117
  v_and_b32 v65, 1, v116
  v_lshlrev_b32 v65, 2, v65
  v_sub_u32 v64, v64, v65
  v_lshrrev_b32 v65, 3, v117
  v_lshl_add_u32 v66, v65, 2, v64
  v_cmp_gt_u32 vcc, 4, v64
  v_mov_b32 v67, 99
  s_nop 0
  v_cndmask_b32 v66, v67, v66, vcc
  v_mov_b32 v68, 0x3f80
  v_mov_b32 v69, 0x3f800000
  v_mov_b32 v4, 0
  v_cmp_eq_u32 vcc, 0, v66
  s_nop 1
  v_cndmask_b32 v4, v4, v68, vcc
  v_cmp_eq_u32 vcc, 1, v66
  s_nop 1
  v_cndmask_b32 v4, v4, v69, vcc
  v_mov_b32 v5, 0
  v_cmp_eq_u32 vcc, 2, v66
  s_nop 1
  v_cndmask_b32 v5, v5, v68, vcc
  v_cmp_eq_u32 vcc, 3, v66
  s_nop 1
  v_cndmask_b32 v5, v5, v69, vcc
  v_mov_b32 v6, 0
  v_cmp_eq_u32 vcc, 4, v66
  s_nop 1
  v_cndmask_b32 v6, v6, v68, vcc
  v_cmp_eq_u32 vcc, 5, v66
  s_nop 1
  v_cndmask_b32 v6, v6, v69, vcc
  v_mov_b32 v7, 0
  v_cmp_eq_u32 vcc, 6, v66
  s_nop 1
  v_cndmask_b32 v7, v7, v68, vcc
  v_cmp_eq_u32 vcc, 7, v66
  s_nop 1
  v_cndmask_b32 v7, v7, v69, vcc
  v_lshrrev_b32 v64, 1, v116
  v_lshrrev_b32 v65, 3, v117
  v_and_b32 v66, 1, v116
  v_and_b32 v68, 7, v117
  v_lshlrev_b32 v67, 8, v65
  v_lshl_add_u32 v67, v68, 5, v67
  v_lshl_add_u32 v67, v66, 4, v67
  v_add_u32 v69, 5184, v67
  v_add_u32 v70, 6400, v67
  v_cmp_eq_u32 vcc, v64, v65
  s_nop 1
  v_cndmask_b32 v113, v70, v69, vcc
  s_lshl_b32 s22, s17, 9
  s_add_u32 s22, s22, 9216
  v_lshl_add_u32 v114, v1, 3, s22
  s_lshr_b32 s22, s17, 1
  s_lshl_b32 s22, s22, 8
  s_and_b32 s27, s17, 1
  s_lshl_b32 s27, s27, 3
  s_add_u32 s22, s22, s27
  s_add_u32 s22, s22, 7168
  v_add_u32 v115, s22, v2
  v_mov_b32 v70, 0x40000000
  v_cmp_gt_u32 vcc, 16, v1
  s_nop 1
  v_cndmask_b32 v115, v70, v115, vcc
  v_mov_b32 v118, -1
  v_mov_b32 v119, -1
  v_and_b32 v0, 15, v1
  s_and_b32 s22, s17, 0
  s_lshl_b32 s22, s22, 7
  s_add_u32 s22, s22, 37248
  v_lshl_add_u32 v0, v0, 2, s22
  v_xor_b32 v69, 256, v2
  v_mul_i32_i24 v70, -2048, v66
  v_add_u32 v69, v69, v70
  v_add_u32 v117, 8192, v69
  v_mov_b32 v116, v73
  s_mul_i32 s35, s17, 28672
  s_add_u32 s33, s35, 2949120
  s_mov_b32 s34, 0
  s_add_u32 s35, s35, 4325376
  v_mov_b32 v36, 0
  v_mov_b32 v37, 0
  v_mov_b32 v38, 0
  v_mov_b32 v39, 0
  v_mov_b32 v40, 0
  v_mov_b32 v41, 0
  v_mov_b32 v42, 0
  v_mov_b32 v43, 0
  v_mov_b32 v44, 0
  v_mov_b32 v45, 0
  v_mov_b32 v46, 0
  v_mov_b32 v47, 0
  v_mov_b32 v48, 0
  v_mov_b32 v49, 0
  v_mov_b32 v50, 0
  v_mov_b32 v51, 0
  v_mov_b32 v52, 0
  v_mov_b32 v53, 0
  v_mov_b32 v54, 0
  v_mov_b32 v55, 0
  v_mov_b32 v56, 0
  v_mov_b32 v57, 0
  v_mov_b32 v58, 0
  v_mov_b32 v59, 0
  v_mov_b32 v60, 0
  v_mov_b32 v61, 0
  v_mov_b32 v62, 0
  v_mov_b32 v63, 0
  v_mov_b32 v64, 0
  v_mov_b32 v65, 0
  v_mov_b32 v66, 0
  v_mov_b32 v67, 0
  v_mov_b32 v68, 0
  v_mov_b32 v69, 0
  v_mov_b32 v70, 0
  v_mov_b32 v71, 0
  v_mov_b32 v72, 0
  v_mov_b32 v73, 0
  v_mov_b32 v74, 0
  v_mov_b32 v75, 0
  v_mov_b32 v76, 0
  v_mov_b32 v77, 0
  v_mov_b32 v78, 0
  v_mov_b32 v79, 0
  s_mov_b32 s22, 0
  v_lshrrev_b32 v14, 4, v2
  v_add_u32 v14, 128, v14
  v_min_u32 v14, 308, v14
  v_lshlrev_b32 v14, 7, v14
  buffer_load_dword v15, v14, s[8:11], s22 offen sc1
  v_lshlrev_b32 v16, 2, v2
  s_getpc_b64 s[98:99]
ct_7:
  s_add_u32 s98, s98, cA_sc2_loop-ct_7
  s_addc_u32 s99, s99, 0
  global_load_dword v15, v16, s[98:99]
  buffer_load_dwordx4 v[80:83], v117, s[8:11], s24 offen offset:0 sc1
  buffer_load_dwordx4 v[84:87], v117, s[8:11], s24 offen offset:1024 sc1
  buffer_load_dwordx4 v[88:91], v117, s[8:11], s26 offen offset:0 sc1
  buffer_load_dwordx4 v[92:95], v117, s[8:11], s26 offen offset:1024 sc1
  buffer_load_dwordx4 v[96:99], v2, s[8:11], s24 offen offset:0 sc1
  buffer_load_dwordx4 v[100:103], v2, s[8:11], s24 offen offset:1024 sc1
  buffer_load_dwordx4 v[104:107], v2, s[8:11], s26 offen offset:0 sc1
  buffer_load_dwordx4 v[108:111], v2, s[8:11], s26 offen offset:1024 sc1
  s_add_u32 s22, s31, 311296
  buffer_load_dwordx4 v[184:187], v2, s[8:11], s22 offen offset:0 sc1
  buffer_load_dwordx4 v[188:191], v2, s[8:11], s22 offen offset:1024 sc1
  buffer_load_dwordx4 v[192:195], v2, s[8:11], s22 offen offset:2048 sc1
  buffer_load_dwordx4 v[196:199], v2, s[8:11], s22 offen offset:3072 sc1
  s_add_u32 s22, s31, 385024
  buffer_load_dwordx4 v[200:203], v2, s[8:11], s22 offen offset:2048 sc1
  buffer_load_dwordx4 v[204:207], v2, s[8:11], s22 offen offset:3072 sc1
  s_add_u32 s22, s31, 389120
  buffer_load_dwordx4 v[208:211], v2, s[8:11], s22 offen offset:0 sc1
  buffer_load_dwordx4 v[212:215], v2, s[8:11], s22 offen offset:1024 sc1
  buffer_load_dwordx4 v[216:219], v2, s[8:11], s22 offen offset:2048 sc1
  buffer_load_dwordx4 v[220:223], v2, s[8:11], s22 offen offset:3072 sc1
  s_add_u32 s22, s31, 393216
  buffer_load_dwordx4 v[224:227], v2, s[8:11], s22 offen offset:0 sc1
  buffer_load_dwordx4 v[228:231], v2, s[8:11], s22 offen offset:1024 sc1
  buffer_load_dwordx4 v[232:235], v2, s[8:11], s22 offen offset:2048 sc1
  buffer_load_dwordx4 v[236:239], v2, s[8:11], s22 offen offset:3072 sc1
  s_add_u32 s22, s31, 397312
  buffer_load_dwordx4 v[240:243], v2, s[8:11], s22 offen offset:0 sc1
  buffer_load_dwordx4 v[244:247], v2, s[8:11], s22 offen offset:1024 sc1
  buffer_load_dwordx4 v[248:251], v2, s[8:11], s22 offen offset:2048 sc1
  buffer_load_dwordx4 v[252:255], v2, s[8:11], s22 offen offset:3072 sc1
  s_waitcnt vmcnt(0) lgkmcnt(0)
  s_mov_b32 s31, 0
  s_cmp_lg_u32 s88, 0
  s_cbranch_scc1 cB_sc2_loop
  s_branch cA_sc2_loop
ch_init3:
  s_mul_i32 s31, s17, 401408
  s_add_u32 s31, s31, 33554432
  s_and_b32 s28, s84, 12384
  s_lshl_b32 s22, s85, 16
  s_or_b32 s28, s28, s22
  s_cmp_eq_u32 s28, 4294914144
  s_cbranch_scc1 ch_wx3_ok
  s_mov_b32 s30, 0
ch_wr3:
  buffer_load_dword v9, off, s[12:15], 0 offset:132 sc1
  s_waitcnt vmcnt(0)
  v_cmp_ne_u32 vcc, 1, v9
  s_cbranch_vccz ch_wr3_ok
  s_sleep 8
  s_add_u32 s30, s30, 1
  s_cmp_lt_u32 s30, 400000
  s_cbranch_scc1 ch_wr3
  s_branch cA_abort
ch_wr3_ok:
  s_lshl_b32 s27, s17, 7
  s_add_u32 s27, s27, 584192
  s_mov_b32 s28, 12384
  s_mov_b32 s30, 0
ch_wb3:
  buffer_load_dword v9, off, s[8:11], s27  sc1
  s_waitcnt vmcnt(0)
  v_and_b32 v10, s28, v9
  v_cmp_ne_u32 vcc, s28, v10
  s_cbranch_vccz ch_wb3_ok
  s_sleep 3
  s_add_u32 s30, s30, 1
  s_cmp_lt_u32 s30, 400000
  s_cbranch_scc1 ch_wb3
  s_branch cA_abort
ch_wb3_ok:
  s_mov_b32 s29, 586240
  s_mov_b32 s28, 0xffff
  s_mov_b32 s30, 0
ch_wx3:
  buffer_load_dword v9, off, s[8:11], s29  sc1
  s_waitcnt vmcnt(0)
  v_and_b32 v10, s28, v9
  v_cmp_ne_u32 vcc, s28, v10
  s_cbranch_vccz ch_wx3_ok
  s_sleep 8
  s_add_u32 s30, s30, 1
  s_cmp_lt_u32 s30, 400000
  s_cbranch_scc1 ch_wx3
  s_branch cA_abort
ch_wx3_ok:
  s_add_u32 s22, s31, 315392
  buffer_load_dwordx4 a[224:227], v2, s[8:11], s22 offen offset:0 sc1
  buffer_load_dwordx4 a[228:231], v2, s[8:11], s22 offen offset:1024 sc1
  buffer_load_dwordx4 a[232:235], v2, s[8:11], s22 offen offset:2048 sc1
  buffer_load_dwordx4 a[236:239], v2, s[8:11], s22 offen offset:3072 sc1
  s_add_u32 s22, s31, 319488
  buffer_load_dwordx4 a[240:243], v2, s[8:11], s22 offen offset:0 sc1
  buffer_load_dwordx4 a[244:247], v2, s[8:11], s22 offen offset:1024 sc1
  buffer_load_dwordx4 a[248:251], v2, s[8:11], s22 offen offset:2048 sc1
  buffer_load_dwordx4 a[252:255], v2, s[8:11], s22 offen offset:3072 sc1
  s_add_u32 s22, s31, 323584
  buffer_load_dwordx4 v[120:123], v2, s[8:11], s22 offen offset:0 sc1
  buffer_load_dwordx4 v[124:127], v2, s[8:11], s22 offen offset:1024 sc1
  buffer_load_dwordx4 v[128:131], v2, s[8:11], s22 offen offset:2048 sc1
  buffer_load_dwordx4 v[132:135], v2, s[8:11], s22 offen offset:3072 sc1
  s_add_u32 s22, s31, 327680
  buffer_load_dwordx4 v[136:139], v2, s[8:11], s22 offen offset:0 sc1
  buffer_load_dwordx4 v[140:143], v2, s[8:11], s22 offen offset:1024 sc1
  buffer_load_dwordx4 v[144:147], v2, s[8:11], s22 offen offset:2048 sc1
  buffer_load_dwordx4 v[148:151], v2, s[8:11], s22 offen offset:3072 sc1
  s_add_u32 s22, s31, 331776
  buffer_load_dwordx4 v[152:155], v2, s[8:11], s22 offen offset:0 sc1
  buffer_load_dwordx4 v[156:159], v2, s[8:11], s22 offen offset:1024 sc1
  buffer_load_dwordx4 v[160:163], v2, s[8:11], s22 offen offset:2048 sc1
  buffer_load_dwordx4 v[164:167], v2, s[8:11], s22 offen offset:3072 sc1
  s_add_u32 s22, s31, 335872
  buffer_load_dwordx4 v[168:171], v2, s[8:11], s22 offen offset:0 sc1
  buffer_load_dwordx4 v[172:175], v2, s[8:11], s22 offen offset:1024 sc1
  buffer_load_dwordx4 v[176:179], v2, s[8:11], s22 offen offset:2048 sc1
  buffer_load_dwordx4 v[180:183], v2, s[8:11], s22 offen offset:3072 sc1
  s_mov_b32 s24, 661504
  s_mov_b32 s26, 675840
  v_and_b32 v64, 7, v117
  v_and_b32 v65, 1, v116
  v_lshlrev_b32 v65, 2, v65
  v_sub_u32 v64, v64, v65
  v_lshrrev_b32 v65, 3, v117
  v_lshl_add_u32 v66, v65, 2, v64
  v_cmp_gt_u32 vcc, 4, v64
  v_mov_b32 v67, 99
  s_nop 0
  v_cndmask_b32 v66, v67, v66, vcc
  v_mov_b32 v68, 0x3f80
  v_mov_b32 v69, 0x3f800000
  v_mov_b32 v4, 0
  v_cmp_eq_u32 vcc, 0, v66
  s_nop 1
  v_cndmask_b32 v4, v4, v68, vcc
  v_cmp_eq_u32 vcc, 1, v66
  s_nop 1
  v_cndmask_b32 v4, v4, v69, vcc
  v_mov_b32 v5, 0
  v_cmp_eq_u32 vcc, 2, v66
  s_nop 1
  v_cndmask_b32 v5, v5, v68, vcc
  v_cmp_eq_u32 vcc, 3, v66
  s_nop 1
  v_cndmask_b32 v5, v5, v69, vcc
  v_mov_b32 v6, 0
  v_cmp_eq_u32 vcc, 4, v66
  s_nop 1
  v_cndmask_b32 v6, v6, v68, vcc
  v_cmp_eq_u32 vcc, 5, v66
  s_nop 1
  v_cndmask_b32 v6, v6, v69, vcc
  v_mov_b32 v7, 0
  v_cmp_eq_u32 vcc, 6, v66
  s_nop 1
  v_cndmask_b32 v7, v7, v68, vcc
  v_cmp_eq_u32 vcc, 7, v66
  s_nop 1
  v_cndmask_b32 v7, v7, v69, vcc
  v_lshrrev_b32 v64, 1, v116
  v_lshrrev_b32 v65, 3, v117
  v_and_b32 v66, 1, v116
  v_and_b32 v68, 7, v117
  v_lshlrev_b32 v67, 8, v65
  v_lshl_add_u32 v67, v68, 5, v67
  v_lshl_add_u32 v67, v66, 4, v67
  v_add_u32 v69, 5696, v67
  v_add_u32 v70, 6400, v67
  v_cmp_eq_u32 vcc, v64, v65
  s_nop 1
  v_cndmask_b32 v113, v70, v69, vcc
  v_and_b32 v0, 15, v1
  s_and_b32 s22, s17, 0
  s_lshl_b32 s22, s22, 7
  s_add_u32 s22, s22, 37248
  v_lshl_add_u32 v0, v0, 2, s22
  v_xor_b32 v69, 256, v2
  v_mul_i32_i24 v70, 2048, v66
  v_add_u32 v69, v69, v70
  v_add_u32 v117, 4096, v69
  v_mov_b32 v116, v73
  s_mul_i32 s35, s17, 28672
  s_add_u32 s33, s35, 2949120
  s_mov_b32 s34, 0
  s_add_u32 s35, s35, 4325376
  v_mov_b32 v36, 0
  v_mov_b32 v37, 0
  v_mov_b32 v38, 0
  v_mov_b32 v39, 0
  v_mov_b32 v40, 0
  v_mov_b32 v41, 0
  v_mov_b32 v42, 0
  v_mov_b32 v43, 0
  v_mov_b32 v44, 0
  v_mov_b32 v45, 0
  v_mov_b32 v46, 0
  v_mov_b32 v47, 0
  v_mov_b32 v48, 0
  v_mov_b32 v49, 0
  v_mov_b32 v50, 0
  v_mov_b32 v51, 0
  v_mov_b32 v52, 0
  v_mov_b32 v53, 0
  v_mov_b32 v54, 0
  v_mov_b32 v55, 0
  v_mov_b32 v56, 0
  v_mov_b32 v57, 0
  v_mov_b32 v58, 0
  v_mov_b32 v59, 0
  v_mov_b32 v60, 0
  v_mov_b32 v61, 0
  v_mov_b32 v62, 0
  v_mov_b32 v63, 0
  v_mov_b32 v64, 0
  v_mov_b32 v65, 0
  v_mov_b32 v66, 0
  v_mov_b32 v67, 0
  v_mov_b32 v68, 0
  v_mov_b32 v69, 0
  v_mov_b32 v70, 0
  v_mov_b32 v71, 0
  v_mov_b32 v72, 0
  v_mov_b32 v73, 0
  v_mov_b32 v74, 0
  v_mov_b32 v75, 0
  v_mov_b32 v76, 0
  v_mov_b32 v77, 0
  v_mov_b32 v78, 0
  v_mov_b32 v79, 0
  s_mov_b32 s22, 0
  v_lshrrev_b32 v14, 4, v2
  v_add_u32 v14, 192, v14
  v_min_u32 v14, 308, v14
  v_lshlrev_b32 v14, 7, v14
  buffer_load_dword v15, v14, s[8:11], s22 offen sc1
  v_lshlrev_b32 v16, 2, v2
  s_getpc_b64 s[98:99]
ct_8:
  s_add_u32 s98, s98, cA_sc3_loop-ct_8
  s_addc_u32 s99, s99, 0
  global_load_dword v15, v16, s[98:99]
  buffer_load_dwordx4 v[80:83], v117, s[8:11], s24 offen offset:0 sc1
  buffer_load_dwordx4 v[84:87], v117, s[8:11], s24 offen offset:1024 sc1
  buffer_load_dwordx4 v[88:91], v117, s[8:11], s26 offen offset:0 sc1
  buffer_load_dwordx4 v[92:95], v117, s[8:11], s26 offen offset:1024 sc1
  buffer_load_dwordx4 v[96:99], v2, s[8:11], s24 offen offset:0 sc1
  buffer_load_dwordx4 v[100:103], v2, s[8:11], s24 offen offset:1024 sc1
  buffer_load_dwordx4 v[104:107], v2, s[8:11], s26 offen offset:0 sc1
  buffer_load_dwordx4 v[108:111], v2, s[8:11], s26 offen offset:1024 sc1
  s_add_u32 s22, s31, 339968
  buffer_load_dwordx4 v[184:187], v2, s[8:11], s22 offen offset:0 sc1
  buffer_load_dwordx4 v[188:191], v2, s[8:11], s22 offen offset:1024 sc1
  buffer_load_dwordx4 v[192:195], v2, s[8:11], s22 offen offset:2048 sc1
  buffer_load_dwordx4 v[196:199], v2, s[8:11], s22 offen offset:3072 sc1
  s_add_u32 s22, s31, 356352
  buffer_load_dwordx4 v[200:203], v2, s[8:11], s22 offen offset:2048 sc1
  buffer_load_dwordx4 v[204:207], v2, s[8:11], s22 offen offset:3072 sc1
  s_add_u32 s22, s31, 360448
  buffer_load_dwordx4 v[208:211], v2, s[8:11], s22 offen offset:0 sc1
  buffer_load_dwordx4 v[212:215], v2, s[8:11], s22 offen offset:1024 sc1
  buffer_load_dwordx4 v[216:219], v2, s[8:11], s22 offen offset:2048 sc1
  buffer_load_dwordx4 v[220:223], v2, s[8:11], s22 offen offset:3072 sc1
  s_add_u32 s22, s31, 364544
  buffer_load_dwordx4 v[224:227], v2, s[8:11], s22 offen offset:0 sc1
  buffer_load_dwordx4 v[228:231], v2, s[8:11], s22 offen offset:1024 sc1
  buffer_load_dwordx4 v[232:235], v2, s[8:11], s22 offen offset:2048 sc1
  buffer_load_dwordx4 v[236:239], v2, s[8:11], s22 offen offset:3072 sc1
  s_add_u32 s22, s31, 368640
  buffer_load_dwordx4 v[240:243], v2, s[8:11], s22 offen offset:0 sc1
  buffer_load_dwordx4 v[244:247], v2, s[8:11], s22 offen offset:1024 sc1
  buffer_load_dwordx4 v[248:251], v2, s[8:11], s22 offen offset:2048 sc1
  buffer_load_dwordx4 v[252:255], v2, s[8:11], s22 offen offset:3072 sc1
  s_waitcnt vmcnt(0) lgkmcnt(0)
  s_mov_b32 s31, 0
  s_cmp_lg_u32 s88, 0
  s_cbranch_scc1 cB_sc3_loop
  s_branch cA_sc3_loop
ch_init4:
  v_mov_b32 v72, v116
  v_mov_b32 v73, v117
  v_lshrrev_b32 v65, 1, v72
  v_and_b32 v66, 1, v72
  v_mov_b32 v36, 0
  v_mov_b32 v37, 0
  v_mov_b32 v38, 0
  v_mov_b32 v39, 0
  v_mov_b32 v40, 0
  v_mov_b32 v41, 0
  v_mov_b32 v42, 0
  v_mov_b32 v43, 0
  v_mov_b32 v44, 0
  v_mov_b32 v45, 0
  v_mov_b32 v46, 0
  v_mov_b32 v47, 0
  v_mov_b32 v48, 0
  v_mov_b32 v49, 0
  v_mov_b32 v50, 0
  v_mov_b32 v51, 0
  v_mov_b32 v52, 0
  v_mov_b32 v53, 0
  v_mov_b32 v54, 0
  v_mov_b32 v55, 0
  v_mov_b32 v56, 0
  v_mov_b32 v57, 0
  v_mov_b32 v58, 0
  v_mov_b32 v59, 0
  v_mov_b32 v60, 0
  v_mov_b32 v61, 0
  v_mov_b32 v62, 0
  v_mov_b32 v63, 0
  v_lshlrev_b32 v75, 2, v65
  v_lshl_add_u32 v75, v66, 3, v75
  v_add_u32 v67, 0, v73
  v_mul_u32_u24 v68, 2341, v67
  v_lshrrev_b32 v68, 16, v68
  v_mul_u32_u24 v69, 28, v68
  v_sub_u32 v69, v67, v69
  v_lshrrev_b32 v70, 4, v69
  v_and_b32 v69, 15, v69
  v_lshlrev_b32 v71, 12, v70
  v_lshl_add_u32 v71, v68, 8, v71
  v_lshl_add_u32 v71, v69, 4, v71
  v_add_u32 v152, v71, v75
  v_add_u32 v67, 16, v73
  v_mul_u32_u24 v68, 2341, v67
  v_lshrrev_b32 v68, 16, v68
  v_mul_u32_u24 v69, 28, v68
  v_sub_u32 v69, v67, v69
  v_lshrrev_b32 v70, 4, v69
  v_and_b32 v69, 15, v69
  v_lshlrev_b32 v71, 12, v70
  v_lshl_add_u32 v71, v68, 8, v71
  v_lshl_add_u32 v71, v69, 4, v71
  v_add_u32 v153, v71, v75
  v_add_u32 v67, 32, v73
  v_mul_u32_u24 v68, 2341, v67
  v_lshrrev_b32 v68, 16, v68
  v_mul_u32_u24 v69, 28, v68
  v_sub_u32 v69, v67, v69
  v_lshrrev_b32 v70, 4, v69
  v_and_b32 v69, 15, v69
  v_lshlrev_b32 v71, 12, v70
  v_lshl_add_u32 v71, v68, 8, v71
  v_lshl_add_u32 v71, v69, 4, v71
  v_add_u32 v154, v71, v75
  v_add_u32 v67, 48, v73
  v_mul_u32_u24 v68, 2341, v67
  v_lshrrev_b32 v68, 16, v68
  v_mul_u32_u24 v69, 28, v68
  v_sub_u32 v69, v67, v69
  v_lshrrev_b32 v70, 4, v69
  v_and_b32 v69, 15, v69
  v_lshlrev_b32 v71, 12, v70
  v_lshl_add_u32 v71, v68, 8, v71
  v_lshl_add_u32 v71, v69, 4, v71
  v_add_u32 v155, v71, v75
  v_add_u32 v67, 64, v73
  v_mul_u32_u24 v68, 2341, v67
  v_lshrrev_b32 v68, 16, v68
  v_mul_u32_u24 v69, 28, v68
  v_sub_u32 v69, v67, v69
  v_lshrrev_b32 v70, 4, v69
  v_and_b32 v69, 15, v69
  v_lshlrev_b32 v71, 12, v70
  v_lshl_add_u32 v71, v68, 8, v71
  v_lshl_add_u32 v71, v69, 4, v71
  v_add_u32 v156, v71, v75
  v_add_u32 v67, 80, v73
  v_mul_u32_u24 v68, 2341, v67
  v_lshrrev_b32 v68, 16, v68
  v_mul_u32_u24 v69, 28, v68
  v_sub_u32 v69, v67, v69
  v_lshrrev_b32 v70, 4, v69
  v_and_b32 v69, 15, v69
  v_lshlrev_b32 v71, 12, v70
  v_lshl_add_u32 v71, v68, 8, v71
  v_lshl_add_u32 v71, v69, 4, v71
  v_add_u32 v157, v71, v75
  v_mov_b32 v74, 0x40000000
  v_mov_b32 v164, 0
  v_mov_b32 v76, 0
  v_mov_b32 v77, 0
  v_mov_b32 v78, 0
  v_mov_b32 v79, 0
  ds_write_b128 v2, v[76:79] offset:0
  ds_write_b128 v2, v[76:79] offset:1024
  ds_write_b128 v2, v[76:79] offset:2048
  ds_write_b128 v2, v[76:79] offset:3072
  s_and_b32 s22, s17, 0
  s_lshl_b32 s22, s22, 7
  s_add_u32 s22, s22, 35328
  v_lshl_add_u32 v4, v73, 2, s22
  v_and_b32 v64, 1, v73
  v_mov_b32 v5, 0x05040100
  v_mov_b32 v65, 0x03020706
  v_cmp_eq_u32 vcc, 1, v64
  s_nop 1
  v_cndmask_b32 v5, v5, v65, vcc
  s_lshl_b32 s22, s17, 2
  s_add_u32 s22, s22, 37248
  v_lshl_add_u32 v7, v1, 7, s22
  v_cmp_gt_u32 vcc, 1, v1
  s_nop 1
  v_cndmask_b32 v7, v74, v7, vcc
  v_subrev_u32 v165, 1920, v7
  v_mov_b32 v6, v2
  v_lshl_add_u32 v64, v66, 2, v64
  v_and_b32 v65, 2, v72
  v_add_u32 v64, v64, v65
  s_mul_i32 s22, s17, 16
  v_add_u32 v75, s22, v73
  v_lshrrev_b32 v68, 4, v75
  v_lshlrev_b32 v68, 8, v68
  v_bfe_u32 v69, v75, 1, 1
  v_lshl_add_u32 v68, v69, 7, v68
  v_lshl_add_u32 v68, v64, 4, v68
  v_and_b32 v69, 12, v75
  v_add_u32 v1, v68, v69
  s_mul_i32 s22, s17, 28672
  s_add_u32 s25, s22, 2490368
  s_and_b32 s27, s17, 3
  s_xor_b32 s22, s27, 0
  s_mul_i32 s80, s22, 7168
  s_lshl_b32 s22, s22, 11
  s_add_u32 s76, s22, 9216
  s_xor_b32 s22, s27, 1
  s_mul_i32 s81, s22, 7168
  s_lshl_b32 s22, s22, 11
  s_add_u32 s77, s22, 9216
  s_xor_b32 s22, s27, 2
  s_mul_i32 s82, s22, 7168
  s_lshl_b32 s22, s22, 11
  s_add_u32 s78, s22, 9216
  s_xor_b32 s22, s27, 3
  s_mul_i32 s83, s22, 7168
  s_lshl_b32 s22, s22, 11
  s_add_u32 s79, s22, 9216
  v_mov_b32 v162, -1
  s_mov_b32 s38, 0x40000000
  s_mul_i32 s31, s17, 401408
  s_add_u32 s31, s31, 39976960
  s_mov_b32 s30, 0
ch_wr4:
  buffer_load_dword v9, off, s[12:15], 0 offset:128 sc1
  s_waitcnt vmcnt(0)
  v_cmp_ne_u32 vcc, 1, v9
  s_cbranch_vccz ch_wr4_ok
  s_sleep 8
  s_add_u32 s30, s30, 1
  s_cmp_lt_u32 s30, 400000
  s_cbranch_scc1 ch_wr4
  s_branch cA_abort
ch_wr4_ok:
  s_lshr_b32 s22, s17, 2
  s_lshl_b32 s28, 0x81, s22
  s_mul_i32 s27, s17, 12
  s_add_u32 s22, s27, 256
  s_lshr_b32 s22, s22, 6
  s_lshl_b32 s22, 0x81, s22
  s_or_b32 s28, s28, s22
  s_add_u32 s22, s27, 267
  s_lshr_b32 s22, s22, 6
  s_lshl_b32 s22, 0x81, s22
  s_or_b32 s28, s28, s22
  v_lshrrev_b32 v12, 8, v2
  v_lshlrev_b32 v12, 7, v12
  s_mov_b32 s27, 582144
  s_mov_b32 s30, 0
ch_ww4:
  buffer_load_dword v9, v12, s[8:11], s27 offen sc1
  s_waitcnt vmcnt(0)
  v_and_b32 v10, s28, v9
  v_cmp_ne_u32 vcc, s28, v10
  s_cbranch_vccz ch_ww4_ok
  s_sleep 3
  s_add_u32 s30, s30, 1
  s_cmp_lt_u32 s30, 400000
  s_cbranch_scc1 ch_ww4
  s_branch cA_abort
ch_ww4_ok:
  s_add_u32 s22, s31, 0
  buffer_load_dwordx4 a[0:3], v2, s[8:11], s22 offen offset:0 sc1
  buffer_load_dwordx4 a[4:7], v2, s[8:11], s22 offen offset:1024 sc1
  buffer_load_dwordx4 a[8:11], v2, s[8:11], s22 offen offset:2048 sc1
  buffer_load_dwordx4 a[12:15], v2, s[8:11], s22 offen offset:3072 sc1
  s_add_u32 s22, s31, 4096
  buffer_load_dwordx4 a[16:19], v2, s[8:11], s22 offen offset:0 sc1
  buffer_load_dwordx4 a[20:23], v2, s[8:11], s22 offen offset:1024 sc1
  buffer_load_dwordx4 a[24:27], v2, s[8:11], s22 offen offset:2048 sc1
  buffer_load_dwordx4 a[28:31], v2, s[8:11], s22 offen offset:3072 sc1
  s_add_u32 s22, s31, 8192
  buffer_load_dwordx4 a[32:35], v2, s[8:11], s22 offen offset:0 sc1
  buffer_load_dwordx4 a[36:39], v2, s[8:11], s22 offen offset:1024 sc1
  buffer_load_dwordx4 a[40:43], v2, s[8:11], s22 offen offset:2048 sc1
  buffer_load_dwordx4 a[44:47], v2, s[8:11], s22 offen offset:3072 sc1
  s_add_u32 s22, s31, 12288
  buffer_load_dwordx4 a[48:51], v2, s[8:11], s22 offen offset:0 sc1
  buffer_load_dwordx4 a[52:55], v2, s[8:11], s22 offen offset:1024 sc1
  buffer_load_dwordx4 a[56:59], v2, s[8:11], s22 offen offset:2048 sc1
  buffer_load_dwordx4 a[60:63], v2, s[8:11], s22 offen offset:3072 sc1
  s_add_u32 s22, s31, 16384
  buffer_load_dwordx4 a[64:67], v2, s[8:11], s22 offen offset:0 sc1
  buffer_load_dwordx4 a[68:71], v2, s[8:11], s22 offen offset:1024 sc1
  buffer_load_dwordx4 a[72:75], v2, s[8:11], s22 offen offset:2048 sc1
  buffer_load_dwordx4 a[76:79], v2, s[8:11], s22 offen offset:3072 sc1
  s_add_u32 s22, s31, 20480
  buffer_load_dwordx4 a[80:83], v2, s[8:11], s22 offen offset:0 sc1
  buffer_load_dwordx4 a[84:87], v2, s[8:11], s22 offen offset:1024 sc1
  buffer_load_dwordx4 a[88:91], v2, s[8:11], s22 offen offset:2048 sc1
  buffer_load_dwordx4 a[92:95], v2, s[8:11], s22 offen offset:3072 sc1
  s_add_u32 s22, s31, 24576
  buffer_load_dwordx4 a[96:99], v2, s[8:11], s22 offen offset:0 sc1
  buffer_load_dwordx4 a[100:103], v2, s[8:11], s22 offen offset:1024 sc1
  buffer_load_dwordx4 a[104:107], v2, s[8:11], s22 offen offset:2048 sc1
  buffer_load_dwordx4 a[108:111], v2, s[8:11], s22 offen offset:3072 sc1
  s_add_u32 s22, s31, 28672
  buffer_load_dwordx4 a[112:115], v2, s[8:11], s22 offen offset:0 sc1
  buffer_load_dwordx4 a[116:119], v2, s[8:11], s22 offen offset:1024 sc1
  buffer_load_dwordx4 a[120:123], v2, s[8:11], s22 offen offset:2048 sc1
  buffer_load_dwordx4 a[124:127], v2, s[8:11], s22 offen offset:3072 sc1
  s_waitcnt vmcnt(24)
  s_add_u32 s22, s31, 32768
  buffer_load_dwordx4 a[128:131], v2, s[8:11], s22 offen offset:0 sc1
  buffer_load_dwordx4 a[132:135], v2, s[8:11], s22 offen offset:1024 sc1
  buffer_load_dwordx4 a[136:139], v2, s[8:11], s22 offen offset:2048 sc1
  buffer_load_dwordx4 a[140:143], v2, s[8:11], s22 offen offset:3072 sc1
  s_add_u32 s22, s31, 36864
  buffer_load_dwordx4 a[144:147], v2, s[8:11], s22 offen offset:0 sc1
  buffer_load_dwordx4 a[148:151], v2, s[8:11], s22 offen offset:1024 sc1
  buffer_load_dwordx4 a[152:155], v2, s[8:11], s22 offen offset:2048 sc1
  buffer_load_dwordx4 a[156:159], v2, s[8:11], s22 offen offset:3072 sc1
  s_add_u32 s22, s31, 40960
  buffer_load_dwordx4 a[160:163], v2, s[8:11], s22 offen offset:0 sc1
  buffer_load_dwordx4 a[164:167], v2, s[8:11], s22 offen offset:1024 sc1
  buffer_load_dwordx4 a[168:171], v2, s[8:11], s22 offen offset:2048 sc1
  buffer_load_dwordx4 a[172:175], v2, s[8:11], s22 offen offset:3072 sc1
  s_add_u32 s22, s31, 45056
  buffer_load_dwordx4 a[176:179], v2, s[8:11], s22 offen offset:0 sc1
  buffer_load_dwordx4 a[180:183], v2, s[8:11], s22 offen offset:1024 sc1
  buffer_load_dwordx4 a[184:187], v2, s[8:11], s22 offen offset:2048 sc1
  buffer_load_dwordx4 a[188:191], v2, s[8:11], s22 offen offset:3072 sc1
  s_add_u32 s22, s31, 49152
  buffer_load_dwordx4 a[192:195], v2, s[8:11], s22 offen offset:0 sc1
  buffer_load_dwordx4 a[196:199], v2, s[8:11], s22 offen offset:1024 sc1
  buffer_load_dwordx4 a[200:203], v2, s[8:11], s22 offen offset:2048 sc1
  buffer_load_dwordx4 a[204:207], v2, s[8:11], s22 offen offset:3072 sc1
  s_add_u32 s22, s31, 53248
  buffer_load_dwordx4 a[208:211], v2, s[8:11], s22 offen offset:0 sc1
  buffer_load_dwordx4 a[212:215], v2, s[8:11], s22 offen offset:1024 sc1
  buffer_load_dwordx4 a[216:219], v2, s[8:11], s22 offen offset:2048 sc1
  buffer_load_dwordx4 a[220:223], v2, s[8:11], s22 offen offset:3072 sc1
  s_add_u32 s22, s31, 57344
  buffer_load_dwordx4 a[224:227], v2, s[8:11], s22 offen offset:0 sc1
  buffer_load_dwordx4 a[228:231], v2, s[8:11], s22 offen offset:1024 sc1
  buffer_load_dwordx4 a[232:235], v2, s[8:11], s22 offen offset:2048 sc1
  buffer_load_dwordx4 a[236:239], v2, s[8:11], s22 offen offset:3072 sc1
  s_add_u32 s22, s31, 61440
  buffer_load_dwordx4 a[240:243], v2, s[8:11], s22 offen offset:0 sc1
  buffer_load_dwordx4 a[244:247], v2, s[8:11], s22 offen offset:1024 sc1
  buffer_load_dwordx4 a[248:251], v2, s[8:11], s22 offen offset:2048 sc1
  buffer_load_dwordx4 a[252:255], v2, s[8:11], s22 offen offset:3072 sc1
  s_waitcnt vmcnt(24)
  s_add_u32 s22, s31, 65536
  buffer_load_dwordx4 v[176:179], v2, s[8:11], s22 offen offset:0 sc1
  buffer_load_dwordx4 v[180:183], v2, s[8:11], s22 offen offset:1024 sc1
  buffer_load_dwordx4 v[184:187], v2, s[8:11], s22 offen offset:2048 sc1
  buffer_load_dwordx4 v[188:191], v2, s[8:11], s22 offen offset:3072 sc1
  s_add_u32 s22, s31, 69632
  buffer_load_dwordx4 v[192:195], v2, s[8:11], s22 offen offset:0 sc1
  buffer_load_dwordx4 v[196:199], v2, s[8:11], s22 offen offset:1024 sc1
  buffer_load_dwordx4 v[200:203], v2, s[8:11], s22 offen offset:2048 sc1
  buffer_load_dwordx4 v[204:207], v2, s[8:11], s22 offen offset:3072 sc1
  s_add_u32 s22, s31, 73728
  buffer_load_dwordx4 v[208:211], v2, s[8:11], s22 offen offset:0 sc1
  buffer_load_dwordx4 v[212:215], v2, s[8:11], s22 offen offset:1024 sc1
  buffer_load_dwordx4 v[216:219], v2, s[8:11], s22 offen offset:2048 sc1
  buffer_load_dwordx4 v[220:223], v2, s[8:11], s22 offen offset:3072 sc1
  s_add_u32 s22, s31, 77824
  buffer_load_dwordx4 v[224:227], v2, s[8:11], s22 offen offset:0 sc1
  buffer_load_dwordx4 v[228:231], v2, s[8:11], s22 offen offset:1024 sc1
  buffer_load_dwordx4 v[232:235], v2, s[8:11], s22 offen offset:2048 sc1
  buffer_load_dwordx4 v[236:239], v2, s[8:11], s22 offen offset:3072 sc1
  s_add_u32 s22, s31, 81920
  buffer_load_dwordx4 v[240:243], v2, s[8:11], s22 offen offset:0 sc1
  buffer_load_dwordx4 v[244:247], v2, s[8:11], s22 offen offset:1024 sc1
  buffer_load_dwordx4 v[248:251], v2, s[8:11], s22 offen offset:2048 sc1
  buffer_load_dwordx4 v[252:255], v2, s[8:11], s22 offen offset:3072 sc1
  s_mov_b32 m0, 16384
  s_add_u32 s22, s31, 86016
  buffer_load_dwordx4 v2, s[8:11], s22 offen offset:0 sc1 lds
  buffer_load_dwordx4 v2, s[8:11], s22 offen offset:1024 sc1 lds
  buffer_load_dwordx4 v2, s[8:11], s22 offen offset:2048 sc1 lds
  buffer_load_dwordx4 v2, s[8:11], s22 offen offset:3072 sc1 lds
  s_mov_b32 m0, 20480
  s_add_u32 s22, s31, 90112
  buffer_load_dwordx4 v2, s[8:11], s22 offen offset:0 sc1 lds
  buffer_load_dwordx4 v2, s[8:11], s22 offen offset:1024 sc1 lds
  buffer_load_dwordx4 v2, s[8:11], s22 offen offset:2048 sc1 lds
  buffer_load_dwordx4 v2, s[8:11], s22 offen offset:3072 sc1 lds
  s_mov_b32 m0, 24576
  s_add_u32 s22, s31, 94208
  buffer_load_dwordx4 v2, s[8:11], s22 offen offset:0 sc1 lds
  buffer_load_dwordx4 v2, s[8:11], s22 offen offset:1024 sc1 lds
  buffer_load_dwordx4 v2, s[8:11], s22 offen offset:2048 sc1 lds
  buffer_load_dwordx4 v2, s[8:11], s22 offen offset:3072 sc1 lds
  s_mov_b32 m0, 28672
  s_add_u32 s22, s31, 98304
  buffer_load_dwordx4 v2, s[8:11], s22 offen offset:0 sc1 lds
  buffer_load_dwordx4 v2, s[8:11], s22 offen offset:1024 sc1 lds
  v_lshlrev_b32 v16, 2, v2
  s_getpc_b64 s[98:99]
ct_9:
  s_add_u32 s98, s98, cA_va0_loop-ct_9
  s_addc_u32 s99, s99, 0
  global_load_dword v15, v16, s[98:99]
  s_mov_b32 s30, 0
ch_ws4:
  buffer_load_dword v9, off, s[12:15], 0 offset:132 sc1
  s_waitcnt vmcnt(0)
  v_cmp_ne_u32 vcc, 1, v9
  s_cbranch_vccz ch_ws4_ok
  s_sleep 8
  s_add_u32 s30, s30, 1
  s_cmp_lt_u32 s30, 400000
  s_cbranch_scc1 ch_ws4
  s_branch cA_abort
ch_ws4_ok:
  s_mul_i32 s33, s17, 532480
  s_add_u32 s33, s33, 78110720
  v_mov_b32 v12, -1
  v_mov_b32 v13, -1
  v_mov_b32 v14, -1
  v_mov_b32 v15, -1
  s_add_u32 s22, s33, 0
  buffer_store_dwordx4 v[12:15], v2, s[8:11], s22 offen sc1
  s_add_u32 s22, s33, 2048
  buffer_store_dwordx4 v[12:15], v2, s[8:11], s22 offen sc1
  s_add_u32 s22, s33, 4096
  buffer_store_dwordx4 v[12:15], v2, s[8:11], s22 offen sc1
  s_add_u32 s22, s33, 6144
  buffer_store_dwordx4 v[12:15], v2, s[8:11], s22 offen sc1
  s_add_u32 s22, s33, 8192
  buffer_store_dwordx4 v[12:15], v2, s[8:11], s22 offen sc1
  s_add_u32 s22, s33, 10240
  buffer_store_dwordx4 v[12:15], v2, s[8:11], s22 offen sc1
  s_add_u32 s22, s33, 12288
  buffer_store_dwordx4 v[12:15], v2, s[8:11], s22 offen sc1
  s_add_u32 s22, s33, 14336
  buffer_store_dwordx4 v[12:15], v2, s[8:11], s22 offen sc1
  v_mov_b32 v16, 1
  v_mov_b32 v17, 1
  s_lshl_b32 s22, s17, 10
  s_add_u32 s22, s22, 566240
  s_waitcnt vmcnt(0)
  s_mov_b64 exec, 3
  buffer_store_dwordx2 v[16:17], v2, s[8:11], s22 offen sc1
  s_mov_b64 exec, -1
  s_mov_b32 s28, s35
  s_waitcnt vmcnt(0) lgkmcnt(0)
  s_mov_b32 s31, 0
  s_cmp_lg_u32 s88, 0
  s_cbranch_scc1 cB_va0_loop
  s_branch cA_va0_loop
ch_init5:
  v_mov_b32 v72, v116
  v_mov_b32 v73, v117
  v_lshrrev_b32 v65, 1, v72
  v_and_b32 v66, 1, v72
  v_mov_b32 v36, 0
  v_mov_b32 v37, 0
  v_mov_b32 v38, 0
  v_mov_b32 v39, 0
  v_mov_b32 v40, 0
  v_mov_b32 v41, 0
  v_mov_b32 v42, 0
  v_mov_b32 v43, 0
  v_mov_b32 v44, 0
  v_mov_b32 v45, 0
  v_mov_b32 v46, 0
  v_mov_b32 v47, 0
  v_mov_b32 v48, 0
  v_mov_b32 v49, 0
  v_mov_b32 v50, 0
  v_mov_b32 v51, 0
  v_mov_b32 v52, 0
  v_mov_b32 v53, 0
  v_mov_b32 v54, 0
  v_mov_b32 v55, 0
  v_mov_b32 v56, 0
  v_mov_b32 v57, 0
  v_mov_b32 v58, 0
  v_mov_b32 v59, 0
  v_mov_b32 v60, 0
  v_mov_b32 v61, 0
  v_mov_b32 v62, 0
  v_mov_b32 v63, 0
  v_lshlrev_b32 v75, 2, v65
  v_lshl_add_u32 v75, v66, 3, v75
  v_add_u32 v67, 112, v73
  v_mul_u32_u24 v68, 2341, v67
  v_lshrrev_b32 v68, 16, v68
  v_mul_u32_u24 v69, 28, v68
  v_sub_u32 v69, v67, v69
  v_lshrrev_b32 v70, 4, v69
  v_and_b32 v69, 15, v69
  v_lshlrev_b32 v71, 12, v70
  v_lshl_add_u32 v71, v68, 8, v71
  v_lshl_add_u32 v71, v69, 4, v71
  v_add_u32 v152, v71, v75
  v_add_u32 v67, 128, v73
  v_mul_u32_u24 v68, 2341, v67
  v_lshrrev_b32 v68, 16, v68
  v_mul_u32_u24 v69, 28, v68
  v_sub_u32 v69, v67, v69
  v_lshrrev_b32 v70, 4, v69
  v_and_b32 v69, 15, v69
  v_lshlrev_b32 v71, 12, v70
  v_lshl_add_u32 v71, v68, 8, v71
  v_lshl_add_u32 v71, v69, 4, v71
  v_add_u32 v153, v71, v75
  v_add_u32 v67, 144, v73
  v_mul_u32_u24 v68, 2341, v67
  v_lshrrev_b32 v68, 16, v68
  v_mul_u32_u24 v69, 28, v68
  v_sub_u32 v69, v67, v69
  v_lshrrev_b32 v70, 4, v69
  v_and_b32 v69, 15, v69
  v_lshlrev_b32 v71, 12, v70
  v_lshl_add_u32 v71, v68, 8, v71
  v_lshl_add_u32 v71, v69, 4, v71
  v_add_u32 v154, v71, v75
  v_add_u32 v67, 160, v73
  v_mul_u32_u24 v68, 2341, v67
  v_lshrrev_b32 v68, 16, v68
  v_mul_u32_u24 v69, 28, v68
  v_sub_u32 v69, v67, v69
  v_lshrrev_b32 v70, 4, v69
  v_and_b32 v69, 15, v69
  v_lshlrev_b32 v71, 12, v70
  v_lshl_add_u32 v71, v68, 8, v71
  v_lshl_add_u32 v71, v69, 4, v71
  v_add_u32 v155, v71, v75
  v_add_u32 v67, 176, v73
  v_mul_u32_u24 v68, 2341, v67
  v_lshrrev_b32 v68, 16, v68
  v_mul_u32_u24 v69, 28, v68
  v_sub_u32 v69, v67, v69
  v_lshrrev_b32 v70, 4, v69
  v_and_b32 v69, 15, v69
  v_lshlrev_b32 v71, 12, v70
  v_lshl_add_u32 v71, v68, 8, v71
  v_lshl_add_u32 v71, v69, 4, v71
  v_add_u32 v156, v71, v75
  v_add_u32 v67, 192, v73
  v_mul_u32_u24 v68, 2341, v67
  v_lshrrev_b32 v68, 16, v68
  v_mul_u32_u24 v69, 28, v68
  v_sub_u32 v69, v67, v69
  v_lshrrev_b32 v70, 4, v69
  v_and_b32 v69, 15, v69
  v_lshlrev_b32 v71, 12, v70
  v_lshl_add_u32 v71, v68, 8, v71
  v_lshl_add_u32 v71, v69, 4, v71
  v_add_u32 v157, v71, v75
  v_add_u32 v67, 208, v73
  v_mul_u32_u24 v68, 2341, v67
  v_lshrrev_b32 v68, 16, v68
  v_mul_u32_u24 v69, 28, v68
  v_sub_u32 v69, v67, v69
  v_lshrrev_b32 v70, 4, v69
  v_and_b32 v69, 15, v69
  v_lshlrev_b32 v71, 12, v70
  v_lshl_add_u32 v71, v68, 8, v71
  v_lshl_add_u32 v71, v69, 4, v71
  v_add_u32 v158, v71, v75
  v_mov_b32 v74, 0x40000000
  v_mov_b32 v164, 0
  v_add_u32 v0, 30720, v2
  v_mov_b32 v76, 0
  v_mov_b32 v77, 0
  v_mov_b32 v78, 0
  v_mov_b32 v79, 0
  ds_write_b128 v2, v[76:79] offset:4096
  ds_write_b128 v2, v[76:79] offset:5120
  ds_write_b128 v2, v[76:79] offset:6144
  ds_write_b128 v2, v[76:79] offset:7168
  s_and_b32 s22, s17, 0
  s_lshl_b32 s22, s22, 7
  s_add_u32 s22, s22, 35328
  v_lshl_add_u32 v4, v73, 2, s22
  v_and_b32 v64, 1, v73
  v_mov_b32 v5, 0x05040100
  v_mov_b32 v65, 0x03020706
  v_cmp_eq_u32 vcc, 1, v64
  s_nop 1
  v_cndmask_b32 v5, v5, v65, vcc
  s_lshl_b32 s22, s17, 2
  s_add_u32 s22, s22, 39168
  v_lshl_add_u32 v7, v1, 7, s22
  v_cmp_gt_u32 vcc, 1, v1
  s_nop 1
  v_cndmask_b32 v7, v74, v7, vcc
  v_subrev_u32 v165, 1920, v7
  v_min_u32 v65, 11, v73
  v_mad_u32_u24 v65, v72, 12, v65
  v_lshlrev_b32 v6, 4, v65
  v_add_u32 v6, 1024, v6
  v_lshl_add_u32 v64, v66, 2, v64
  v_and_b32 v65, 2, v72
  v_add_u32 v64, v64, v65
  s_mul_i32 s22, s17, 12
  s_add_u32 s22, s22, 256
  v_add_u32 v75, s22, v73
  v_lshrrev_b32 v68, 4, v75
  v_lshlrev_b32 v68, 8, v68
  v_bfe_u32 v69, v75, 1, 1
  v_lshl_add_u32 v68, v69, 7, v68
  v_lshl_add_u32 v68, v64, 4, v68
  v_and_b32 v69, 12, v75
  v_add_u32 v1, v68, v69
  v_cmp_gt_u32 vcc, 12, v73
  s_nop 1
  v_cndmask_b32 v1, v74, v1, vcc
  s_mul_i32 s22, s17, 28672
  s_add_u32 s25, s22, 2490368
  s_and_b32 s27, s17, 3
  s_xor_b32 s22, s27, 0
  s_mul_i32 s80, s22, 7168
  s_lshl_b32 s22, s22, 11
  s_add_u32 s76, s22, 9216
  s_xor_b32 s22, s27, 1
  s_mul_i32 s81, s22, 7168
  s_lshl_b32 s22, s22, 11
  s_add_u32 s77, s22, 9216
  s_xor_b32 s22, s27, 2
  s_mul_i32 s82, s22, 7168
  s_lshl_b32 s22, s22, 11
  s_add_u32 s78, s22, 9216
  s_xor_b32 s22, s27, 3
  s_mul_i32 s83, s22, 7168
  s_lshl_b32 s22, s22, 11
  s_add_u32 s79, s22, 9216
  v_mov_b32 v162, -1
  s_mov_b32 s38, 0x40000000
  s_mul_i32 s31, s17, 401408
  s_add_u32 s31, s31, 40077312
  s_mov_b32 s30, 0
ch_wr5:
  buffer_load_dword v9, off, s[12:15], 0 offset:128 sc1
  s_waitcnt vmcnt(0)
  v_cmp_ne_u32 vcc, 1, v9
  s_cbranch_vccz ch_wr5_ok
  s_sleep 8
  s_add_u32 s30, s30, 1
  s_cmp_lt_u32 s30, 400000
  s_cbranch_scc1 ch_wr5
  s_branch cA_abort
ch_wr5_ok:
  s_lshr_b32 s22, s17, 2
  s_lshl_b32 s28, 0x81, s22
  s_mul_i32 s27, s17, 12
  s_add_u32 s22, s27, 256
  s_lshr_b32 s22, s22, 6
  s_lshl_b32 s22, 0x81, s22
  s_or_b32 s28, s28, s22
  s_add_u32 s22, s27, 267
  s_lshr_b32 s22, s22, 6
  s_lshl_b32 s22, 0x81, s22
  s_or_b32 s28, s28, s22
  v_lshrrev_b32 v12, 8, v2
  v_lshlrev_b32 v12, 7, v12
  s_mov_b32 s27, 582656
  s_mov_b32 s30, 0
ch_ww5:
  buffer_load_dword v9, v12, s[8:11], s27 offen sc1
  s_waitcnt vmcnt(0)
  v_and_b32 v10, s28, v9
  v_cmp_ne_u32 vcc, s28, v10
  s_cbranch_vccz ch_ww5_ok
  s_sleep 3
  s_add_u32 s30, s30, 1
  s_cmp_lt_u32 s30, 400000
  s_cbranch_scc1 ch_ww5
  s_branch cA_abort
ch_ww5_ok:
  s_add_u32 s22, s31, 0
  buffer_load_dwordx4 a[0:3], v2, s[8:11], s22 offen offset:0 sc1
  buffer_load_dwordx4 a[4:7], v2, s[8:11], s22 offen offset:1024 sc1
  buffer_load_dwordx4 a[8:11], v2, s[8:11], s22 offen offset:2048 sc1
  buffer_load_dwordx4 a[12:15], v2, s[8:11], s22 offen offset:3072 sc1
  s_add_u32 s22, s31, 4096
  buffer_load_dwordx4 a[16:19], v2, s[8:11], s22 offen offset:0 sc1
  buffer_load_dwordx4 a[20:23], v2, s[8:11], s22 offen offset:1024 sc1
  buffer_load_dwordx4 a[24:27], v2, s[8:11], s22 offen offset:2048 sc1
  buffer_load_dwordx4 a[28:31], v2, s[8:11], s22 offen offset:3072 sc1
  s_add_u32 s22, s31, 8192
  buffer_load_dwordx4 a[32:35], v2, s[8:11], s22 offen offset:0 sc1
  buffer_load_dwordx4 a[36:39], v2, s[8:11], s22 offen offset:1024 sc1
  buffer_load_dwordx4 a[40:43], v2, s[8:11], s22 offen offset:2048 sc1
  buffer_load_dwordx4 a[44:47], v2, s[8:11], s22 offen offset:3072 sc1
  s_add_u32 s22, s31, 12288
  buffer_load_dwordx4 a[48:51], v2, s[8:11], s22 offen offset:0 sc1
  buffer_load_dwordx4 a[52:55], v2, s[8:11], s22 offen offset:1024 sc1
  buffer_load_dwordx4 a[56:59], v2, s[8:11], s22 offen offset:2048 sc1
  buffer_load_dwordx4 a[60:63], v2, s[8:11], s22 offen offset:3072 sc1
  s_add_u32 s22, s31, 16384
  buffer_load_dwordx4 a[64:67], v2, s[8:11], s22 offen offset:0 sc1
  buffer_load_dwordx4 a[68:71], v2, s[8:11], s22 offen offset:1024 sc1
  buffer_load_dwordx4 a[72:75], v2, s[8:11], s22 offen offset:2048 sc1
  buffer_load_dwordx4 a[76:79], v2, s[8:11], s22 offen offset:3072 sc1
  s_add_u32 s22, s31, 20480
  buffer_load_dwordx4 a[80:83], v2, s[8:11], s22 offen offset:0 sc1
  buffer_load_dwordx4 a[84:87], v2, s[8:11], s22 offen offset:1024 sc1
  buffer_load_dwordx4 a[88:91], v2, s[8:11], s22 offen offset:2048 sc1
  buffer_load_dwordx4 a[92:95], v2, s[8:11], s22 offen offset:3072 sc1
  s_add_u32 s22, s31, 24576
  buffer_load_dwordx4 a[96:99], v2, s[8:11], s22 offen offset:0 sc1
  buffer_load_dwordx4 a[100:103], v2, s[8:11], s22 offen offset:1024 sc1
  buffer_load_dwordx4 a[104:107], v2, s[8:11], s22 offen offset:2048 sc1
  buffer_load_dwordx4 a[108:111], v2, s[8:11], s22 offen offset:3072 sc1
  s_add_u32 s22, s31, 28672
  buffer_load_dwordx4 a[112:115], v2, s[8:11], s22 offen offset:0 sc1
  buffer_load_dwordx4 a[116:119], v2, s[8:11], s22 offen offset:1024 sc1
  buffer_load_dwordx4 a[120:123], v2, s[8:11], s22 offen offset:2048 sc1
  buffer_load_dwordx4 a[124:127], v2, s[8:11], s22 offen offset:3072 sc1
  s_waitcnt vmcnt(24)
  s_add_u32 s22, s31, 32768
  buffer_load_dwordx4 a[128:131], v2, s[8:11], s22 offen offset:0 sc1
  buffer_load_dwordx4 a[132:135], v2, s[8:11], s22 offen offset:1024 sc1
  buffer_load_dwordx4 a[136:139], v2, s[8:11], s22 offen offset:2048 sc1
  buffer_load_dwordx4 a[140:143], v2, s[8:11], s22 offen offset:3072 sc1
  s_add_u32 s22, s31, 36864
  buffer_load_dwordx4 a[144:147], v2, s[8:11], s22 offen offset:0 sc1
  buffer_load_dwordx4 a[148:151], v2, s[8:11], s22 offen offset:1024 sc1
  buffer_load_dwordx4 a[152:155], v2, s[8:11], s22 offen offset:2048 sc1
  buffer_load_dwordx4 a[156:159], v2, s[8:11], s22 offen offset:3072 sc1
  s_add_u32 s22, s31, 40960
  buffer_load_dwordx4 a[160:163], v2, s[8:11], s22 offen offset:0 sc1
  buffer_load_dwordx4 a[164:167], v2, s[8:11], s22 offen offset:1024 sc1
  buffer_load_dwordx4 a[168:171], v2, s[8:11], s22 offen offset:2048 sc1
  buffer_load_dwordx4 a[172:175], v2, s[8:11], s22 offen offset:3072 sc1
  s_add_u32 s22, s31, 45056
  buffer_load_dwordx4 a[176:179], v2, s[8:11], s22 offen offset:0 sc1
  buffer_load_dwordx4 a[180:183], v2, s[8:11], s22 offen offset:1024 sc1
  buffer_load_dwordx4 a[184:187], v2, s[8:11], s22 offen offset:2048 sc1
  buffer_load_dwordx4 a[188:191], v2, s[8:11], s22 offen offset:3072 sc1
  s_add_u32 s22, s31, 49152
  buffer_load_dwordx4 a[192:195], v2, s[8:11], s22 offen offset:0 sc1
  buffer_load_dwordx4 a[196:199], v2, s[8:11], s22 offen offset:1024 sc1
  buffer_load_dwordx4 a[200:203], v2, s[8:11], s22 offen offset:2048 sc1
  buffer_load_dwordx4 a[204:207], v2, s[8:11], s22 offen offset:3072 sc1
  s_add_u32 s22, s31, 53248
  buffer_load_dwordx4 a[208:211], v2, s[8:11], s22 offen offset:0 sc1
  buffer_load_dwordx4 a[212:215], v2, s[8:11], s22 offen offset:1024 sc1
  buffer_load_dwordx4 a[216:219], v2, s[8:11], s22 offen offset:2048 sc1
  buffer_load_dwordx4 a[220:223], v2, s[8:11], s22 offen offset:3072 sc1
  s_add_u32 s22, s31, 57344
  buffer_load_dwordx4 a[224:227], v2, s[8:11], s22 offen offset:0 sc1
  buffer_load_dwordx4 a[228:231], v2, s[8:11], s22 offen offset:1024 sc1
  buffer_load_dwordx4 a[232:235], v2, s[8:11], s22 offen offset:2048 sc1
  buffer_load_dwordx4 a[236:239], v2, s[8:11], s22 offen offset:3072 sc1
  s_add_u32 s22, s31, 61440
  buffer_load_dwordx4 a[240:243], v2, s[8:11], s22 offen offset:0 sc1
  buffer_load_dwordx4 a[244:247], v2, s[8:11], s22 offen offset:1024 sc1
  buffer_load_dwordx4 a[248:251], v2, s[8:11], s22 offen offset:2048 sc1
  buffer_load_dwordx4 a[252:255], v2, s[8:11], s22 offen offset:3072 sc1
  s_waitcnt vmcnt(24)
  s_add_u32 s22, s31, 65536
  buffer_load_dwordx4 v[176:179], v2, s[8:11], s22 offen offset:0 sc1
  buffer_load_dwordx4 v[180:183], v2, s[8:11], s22 offen offset:1024 sc1
  buffer_load_dwordx4 v[184:187], v2, s[8:11], s22 offen offset:2048 sc1
  buffer_load_dwordx4 v[188:191], v2, s[8:11], s22 offen offset:3072 sc1
  s_add_u32 s22, s31, 69632
  buffer_load_dwordx4 v[192:195], v2, s[8:11], s22 offen offset:0 sc1
  buffer_load_dwordx4 v[196:199], v2, s[8:11], s22 offen offset:1024 sc1
  buffer_load_dwordx4 v[200:203], v2, s[8:11], s22 offen offset:2048 sc1
  buffer_load_dwordx4 v[204:207], v2, s[8:11], s22 offen offset:3072 sc1
  s_add_u32 s22, s31, 73728
  buffer_load_dwordx4 v[208:211], v2, s[8:11], s22 offen offset:0 sc1
  buffer_load_dwordx4 v[212:215], v2, s[8:11], s22 offen offset:1024 sc1
  buffer_load_dwordx4 v[216:219], v2, s[8:11], s22 offen offset:2048 sc1
  buffer_load_dwordx4 v[220:223], v2, s[8:11], s22 offen offset:3072 sc1
  s_add_u32 s22, s31, 77824
  buffer_load_dwordx4 v[224:227], v2, s[8:11], s22 offen offset:0 sc1
  buffer_load_dwordx4 v[228:231], v2, s[8:11], s22 offen offset:1024 sc1
  buffer_load_dwordx4 v[232:235], v2, s[8:11], s22 offen offset:2048 sc1
  buffer_load_dwordx4 v[236:239], v2, s[8:11], s22 offen offset:3072 sc1
  s_add_u32 s22, s31, 81920
  buffer_load_dwordx4 v[240:243], v2, s[8:11], s22 offen offset:0 sc1
  buffer_load_dwordx4 v[244:247], v2, s[8:11], s22 offen offset:1024 sc1
  buffer_load_dwordx4 v[248:251], v2, s[8:11], s22 offen offset:2048 sc1
  buffer_load_dwordx4 v[252:255], v2, s[8:11], s22 offen offset:3072 sc1
  s_mov_b32 m0, 30720
  s_add_u32 s22, s31, 86016
  buffer_load_dwordx4 v2, s[8:11], s22 offen offset:0 sc1 lds
  buffer_load_dwordx4 v2, s[8:11], s22 offen offset:1024 sc1 lds
  buffer_load_dwordx4 v2, s[8:11], s22 offen offset:2048 sc1 lds
  buffer_load_dwordx4 v2, s[8:11], s22 offen offset:3072 sc1 lds
  s_mov_b32 m0, 34816
  s_add_u32 s22, s31, 90112
  buffer_load_dwordx4 v2, s[8:11], s22 offen offset:0 sc1 lds
  buffer_load_dwordx4 v2, s[8:11], s22 offen offset:1024 sc1 lds
  buffer_load_dwordx4 v2, s[8:11], s22 offen offset:2048 sc1 lds
  buffer_load_dwordx4 v2, s[8:11], s22 offen offset:3072 sc1 lds
  s_mov_b32 m0, 38912
  s_add_u32 s22, s31, 94208
  buffer_load_dwordx4 v2, s[8:11], s22 offen offset:0 sc1 lds
  buffer_load_dwordx4 v2, s[8:11], s22 offen offset:1024 sc1 lds
  buffer_load_dwordx4 v2, s[8:11], s22 offen offset:2048 sc1 lds
  buffer_load_dwordx4 v2, s[8:11], s22 offen offset:3072 sc1 lds
  s_mov_b32 m0, 43008
  s_add_u32 s22, s31, 98304
  buffer_load_dwordx4 v2, s[8:11], s22 offen offset:0 sc1 lds
  buffer_load_dwordx4 v2, s[8:11], s22 offen offset:1024 sc1 lds
  v_lshlrev_b32 v16, 2, v2
  s_getpc_b64 s[98:99]
ct_10:
  s_add_u32 s98, s98, cA_va1_loop-ct_10
  s_addc_u32 s99, s99, 0
  global_load_dword v15, v16, s[98:99]
  s_mov_b32 s30, 0
ch_ws5:
  buffer_load_dword v9, off, s[12:15], 0 offset:132 sc1
  s_waitcnt vmcnt(0)
  v_cmp_ne_u32 vcc, 1, v9
  s_cbranch_vccz ch_ws5_ok
  s_sleep 8
  s_add_u32 s30, s30, 1
  s_cmp_lt_u32 s30, 400000
  s_cbranch_scc1 ch_ws5
  s_branch cA_abort
ch_ws5_ok:
  s_mul_i32 s33, s17, 532480
  s_add_u32 s33, s33, 78111744
  v_mov_b32 v12, -1
  v_mov_b32 v13, -1
  v_mov_b32 v14, -1
  v_mov_b32 v15, -1
  s_add_u32 s22, s33, 0
  buffer_store_dwordx4 v[12:15], v2, s[8:11], s22 offen sc1
  s_add_u32 s22, s33, 2048
  buffer_store_dwordx4 v[12:15], v2, s[8:11], s22 offen sc1
  s_add_u32 s22, s33, 4096
  buffer_store_dwordx4 v[12:15], v2, s[8:11], s22 offen sc1
  s_add_u32 s22, s33, 6144
  buffer_store_dwordx4 v[12:15], v2, s[8:11], s22 offen sc1
  s_add_u32 s22, s33, 8192
  buffer_store_dwordx4 v[12:15], v2, s[8:11], s22 offen sc1
  s_add_u32 s22, s33, 10240
  buffer_store_dwordx4 v[12:15], v2, s[8:11], s22 offen sc1
  s_add_u32 s22, s33, 12288
  buffer_store_dwordx4 v[12:15], v2, s[8:11], s22 offen sc1
  s_add_u32 s22, s33, 14336
  buffer_store_dwordx4 v[12:15], v2, s[8:11], s22 offen sc1
  v_mov_b32 v16, 1
  v_mov_b32 v17, 1
  s_lshl_b32 s22, s17, 10
  s_add_u32 s22, s22, 566248
  s_waitcnt vmcnt(0)
  s_mov_b64 exec, 3
  buffer_store_dwordx2 v[16:17], v2, s[8:11], s22 offen sc1
  s_mov_b64 exec, -1
  s_mov_b32 s28, s35
  s_waitcnt vmcnt(0) lgkmcnt(0)
  s_mov_b32 s31, 0
  s_cmp_lg_u32 s88, 0
  s_cbranch_scc1 cB_va1_loop
  s_branch cA_va1_loop
ch_init6:
  v_mov_b32 v72, v116
  v_mov_b32 v73, v117
  v_lshrrev_b32 v65, 1, v72
  v_and_b32 v66, 1, v72
  v_mov_b32 v36, 0
  v_mov_b32 v37, 0
  v_mov_b32 v38, 0
  v_mov_b32 v39, 0
  v_mov_b32 v40, 0
  v_mov_b32 v41, 0
  v_mov_b32 v42, 0
  v_mov_b32 v43, 0
  v_mov_b32 v44, 0
  v_mov_b32 v45, 0
  v_mov_b32 v46, 0
  v_mov_b32 v47, 0
  v_mov_b32 v48, 0
  v_mov_b32 v49, 0
  v_mov_b32 v50, 0
  v_mov_b32 v51, 0
  v_mov_b32 v52, 0
  v_mov_b32 v53, 0
  v_mov_b32 v54, 0
  v_mov_b32 v55, 0
  v_mov_b32 v56, 0
  v_mov_b32 v57, 0
  v_mov_b32 v58, 0
  v_mov_b32 v59, 0
  v_mov_b32 v60, 0
  v_mov_b32 v61, 0
  v_mov_b32 v62, 0
  v_mov_b32 v63, 0
  v_lshlrev_b32 v75, 2, v65
  v_lshl_add_u32 v75, v66, 3, v75
  v_add_u32 v67, 224, v73
  v_mul_u32_u24 v68, 2341, v67
  v_lshrrev_b32 v68, 16, v68
  v_mul_u32_u24 v69, 28, v68
  v_sub_u32 v69, v67, v69
  v_lshrrev_b32 v70, 4, v69
  v_and_b32 v69, 15, v69
  v_lshlrev_b32 v71, 12, v70
  v_lshl_add_u32 v71, v68, 8, v71
  v_lshl_add_u32 v71, v69, 4, v71
  v_add_u32 v104, v71, v75
  v_add_u32 v67, 240, v73
  v_mul_u32_u24 v68, 2341, v67
  v_lshrrev_b32 v68, 16, v68
  v_mul_u32_u24 v69, 28, v68
  v_sub_u32 v69, v67, v69
  v_lshrrev_b32 v70, 4, v69
  v_and_b32 v69, 15, v69
  v_lshlrev_b32 v71, 12, v70
  v_lshl_add_u32 v71, v68, 8, v71
  v_lshl_add_u32 v71, v69, 4, v71
  v_add_u32 v105, v71, v75
  v_add_u32 v67, 256, v73
  v_mul_u32_u24 v68, 2341, v67
  v_lshrrev_b32 v68, 16, v68
  v_mul_u32_u24 v69, 28, v68
  v_sub_u32 v69, v67, v69
  v_lshrrev_b32 v70, 4, v69
  v_and_b32 v69, 15, v69
  v_lshlrev_b32 v71, 12, v70
  v_lshl_add_u32 v71, v68, 8, v71
  v_lshl_add_u32 v71, v69, 4, v71
  v_add_u32 v106, v71, v75
  v_add_u32 v67, 272, v73
  v_mul_u32_u24 v68, 2341, v67
  v_lshrrev_b32 v68, 16, v68
  v_mul_u32_u24 v69, 28, v68
  v_sub_u32 v69, v67, v69
  v_lshrrev_b32 v70, 4, v69
  v_and_b32 v69, 15, v69
  v_lshlrev_b32 v71, 12, v70
  v_lshl_add_u32 v71, v68, 8, v71
  v_lshl_add_u32 v71, v69, 4, v71
  v_add_u32 v107, v71, v75
  v_add_u32 v67, 288, v73
  v_mul_u32_u24 v68, 2341, v67
  v_lshrrev_b32 v68, 16, v68
  v_mul_u32_u24 v69, 28, v68
  v_sub_u32 v69, v67, v69
  v_lshrrev_b32 v70, 4, v69
  v_and_b32 v69, 15, v69
  v_lshlrev_b32 v71, 12, v70
  v_lshl_add_u32 v71, v68, 8, v71
  v_lshl_add_u32 v71, v69, 4, v71
  v_add_u32 v108, v71, v75
  v_add_u32 v67, 304, v73
  v_mul_u32_u24 v68, 2341, v67
  v_lshrrev_b32 v68, 16, v68
  v_mul_u32_u24 v69, 28, v68
  v_sub_u32 v69, v67, v69
  v_lshrrev_b32 v70, 4, v69
  v_and_b32 v69, 15, v69
  v_lshlrev_b32 v71, 12, v70
  v_lshl_add_u32 v71, v68, 8, v71
  v_lshl_add_u32 v71, v69, 4, v71
  v_add_u32 v109, v71, v75
  v_add_u32 v67, 320, v73
  v_mul_u32_u24 v68, 2341, v67
  v_lshrrev_b32 v68, 16, v68
  v_mul_u32_u24 v69, 28, v68
  v_sub_u32 v69, v67, v69
  v_lshrrev_b32 v70, 4, v69
  v_and_b32 v69, 15, v69
  v_lshlrev_b32 v71, 12, v70
  v_lshl_add_u32 v71, v68, 8, v71
  v_lshl_add_u32 v71, v69, 4, v71
  v_add_u32 v110, v71, v75
  v_add_u32 v67, 96, v73
  v_mul_u32_u24 v68, 2341, v67
  v_lshrrev_b32 v68, 16, v68
  v_mul_u32_u24 v69, 28, v68
  v_sub_u32 v69, v67, v69
  v_lshrrev_b32 v70, 4, v69
  v_and_b32 v69, 15, v69
  v_lshlrev_b32 v71, 12, v70
  v_lshl_add_u32 v71, v68, 8, v71
  v_lshl_add_u32 v71, v69, 4, v71
  v_add_u32 v111, v71, v75
  v_mov_b32 v74, 0x40000000
  v_mov_b32 v96, 0
  v_add_u32 v0, 16384, v2
  s_mul_i32 s22, s17, 28672
  s_add_u32 s25, s22, 2490368
  v_and_b32 v119, 15, v1
  s_and_b32 s22, s17, 0
  s_lshl_b32 s22, s22, 7
  s_add_u32 s22, s22, 39168
  v_lshl_add_u32 v119, v119, 2, s22
  s_lshl_b32 s22, s17, 2
  s_add_u32 s22, s22, 37248
  v_lshl_add_u32 v118, v1, 7, s22
  v_cmp_gt_u32 vcc, 1, v1
  s_nop 1
  v_cndmask_b32 v118, v74, v118, vcc
  s_lshl_b32 s35, s17, 7
  s_add_u32 s35, s35, 524288
  v_mov_b32 v64, 0
  v_mov_b32 v65, 0
  v_mov_b32 v66, 0
  v_mov_b32 v67, 0
  v_min_u32 v116, 13, v1
  s_mul_i32 s22, s17, 14
  v_add_u32 v116, s22, v116
  v_lshlrev_b32 v116, 7, v116
  s_mul_i32 s31, s17, 401408
  s_add_u32 s31, s31, 40177664
  s_mov_b32 s30, 0
ch_wr6:
  buffer_load_dword v9, off, s[12:15], 0 offset:128 sc1
  s_waitcnt vmcnt(0)
  v_cmp_ne_u32 vcc, 1, v9
  s_cbranch_vccz ch_wr6_ok
  s_sleep 8
  s_add_u32 s30, s30, 1
  s_cmp_lt_u32 s30, 400000
  s_cbranch_scc1 ch_wr6
  s_branch cA_abort
ch_wr6_ok:
  s_lshr_b32 s22, s17, 2
  s_lshl_b32 s28, 0x81, s22
  s_mul_i32 s27, s17, 12
  s_add_u32 s22, s27, 256
  s_lshr_b32 s22, s22, 6
  s_lshl_b32 s22, 0x81, s22
  s_or_b32 s28, s28, s22
  s_add_u32 s22, s27, 267
  s_lshr_b32 s22, s22, 6
  s_lshl_b32 s22, 0x81, s22
  s_or_b32 s28, s28, s22
  v_lshrrev_b32 v12, 8, v2
  v_lshlrev_b32 v12, 7, v12
  s_mov_b32 s27, 583168
  s_mov_b32 s30, 0
ch_ww6:
  buffer_load_dword v9, v12, s[8:11], s27 offen sc1
  s_waitcnt vmcnt(0)
  v_and_b32 v10, s28, v9
  v_cmp_ne_u32 vcc, s28, v10
  s_cbranch_vccz ch_ww6_ok
  s_sleep 3
  s_add_u32 s30, s30, 1
  s_cmp_lt_u32 s30, 400000
  s_cbranch_scc1 ch_ww6
  s_branch cA_abort
ch_ww6_ok:
  s_add_u32 s22, s31, 0
  buffer_load_dwordx4 a[0:3], v2, s[8:11], s22 offen offset:0 sc1
  buffer_load_dwordx4 a[4:7], v2, s[8:11], s22 offen offset:1024 sc1
  buffer_load_dwordx4 a[8:11], v2, s[8:11], s22 offen offset:2048 sc1
  buffer_load_dwordx4 a[12:15], v2, s[8:11], s22 offen offset:3072 sc1
  s_add_u32 s22, s31, 4096
  buffer_load_dwordx4 a[16:19], v2, s[8:11], s22 offen offset:0 sc1
  buffer_load_dwordx4 a[20:23], v2, s[8:11], s22 offen offset:1024 sc1
  buffer_load_dwordx4 a[24:27], v2, s[8:11], s22 offen offset:2048 sc1
  buffer_load_dwordx4 a[28:31], v2, s[8:11], s22 offen offset:3072 sc1
  s_add_u32 s22, s31, 8192
  buffer_load_dwordx4 a[32:35], v2, s[8:11], s22 offen offset:0 sc1
  buffer_load_dwordx4 a[36:39], v2, s[8:11], s22 offen offset:1024 sc1
  buffer_load_dwordx4 a[40:43], v2, s[8:11], s22 offen offset:2048 sc1
  buffer_load_dwordx4 a[44:47], v2, s[8:11], s22 offen offset:3072 sc1
  s_add_u32 s22, s31, 12288
  buffer_load_dwordx4 a[48:51], v2, s[8:11], s22 offen offset:0 sc1
  buffer_load_dwordx4 a[52:55], v2, s[8:11], s22 offen offset:1024 sc1
  buffer_load_dwordx4 a[56:59], v2, s[8:11], s22 offen offset:2048 sc1
  buffer_load_dwordx4 a[60:63], v2, s[8:11], s22 offen offset:3072 sc1
  s_add_u32 s22, s31, 16384
  buffer_load_dwordx4 a[64:67], v2, s[8:11], s22 offen offset:0 sc1
  buffer_load_dwordx4 a[68:71], v2, s[8:11], s22 offen offset:1024 sc1
  buffer_load_dwordx4 a[72:75], v2, s[8:11], s22 offen offset:2048 sc1
  buffer_load_dwordx4 a[76:79], v2, s[8:11], s22 offen offset:3072 sc1
  s_add_u32 s22, s31, 20480
  buffer_load_dwordx4 a[80:83], v2, s[8:11], s22 offen offset:0 sc1
  buffer_load_dwordx4 a[84:87], v2, s[8:11], s22 offen offset:1024 sc1
  buffer_load_dwordx4 a[88:91], v2, s[8:11], s22 offen offset:2048 sc1
  buffer_load_dwordx4 a[92:95], v2, s[8:11], s22 offen offset:3072 sc1
  s_add_u32 s22, s31, 24576
  buffer_load_dwordx4 a[96:99], v2, s[8:11], s22 offen offset:0 sc1
  buffer_load_dwordx4 a[100:103], v2, s[8:11], s22 offen offset:1024 sc1
  buffer_load_dwordx4 a[104:107], v2, s[8:11], s22 offen offset:2048 sc1
  buffer_load_dwordx4 a[108:111], v2, s[8:11], s22 offen offset:3072 sc1
  s_add_u32 s22, s31, 28672
  buffer_load_dwordx4 a[112:115], v2, s[8:11], s22 offen offset:0 sc1
  buffer_load_dwordx4 a[116:119], v2, s[8:11], s22 offen offset:1024 sc1
  buffer_load_dwordx4 a[120:123], v2, s[8:11], s22 offen offset:2048 sc1
  buffer_load_dwordx4 a[124:127], v2, s[8:11], s22 offen offset:3072 sc1
  s_waitcnt vmcnt(24)
  s_add_u32 s22, s31, 32768
  buffer_load_dwordx4 a[128:131], v2, s[8:11], s22 offen offset:0 sc1
  buffer_load_dwordx4 a[132:135], v2, s[8:11], s22 offen offset:1024 sc1
  buffer_load_dwordx4 a[136:139], v2, s[8:11], s22 offen offset:2048 sc1
  buffer_load_dwordx4 a[140:143], v2, s[8:11], s22 offen offset:3072 sc1
  s_add_u32 s22, s31, 36864
  buffer_load_dwordx4 a[144:147], v2, s[8:11], s22 offen offset:0 sc1
  buffer_load_dwordx4 a[148:151], v2, s[8:11], s22 offen offset:1024 sc1
  buffer_load_dwordx4 a[152:155], v2, s[8:11], s22 offen offset:2048 sc1
  buffer_load_dwordx4 a[156:159], v2, s[8:11], s22 offen offset:3072 sc1
  s_add_u32 s22, s31, 40960
  buffer_load_dwordx4 a[160:163], v2, s[8:11], s22 offen offset:0 sc1
  buffer_load_dwordx4 a[164:167], v2, s[8:11], s22 offen offset:1024 sc1
  buffer_load_dwordx4 a[168:171], v2, s[8:11], s22 offen offset:2048 sc1
  buffer_load_dwordx4 a[172:175], v2, s[8:11], s22 offen offset:3072 sc1
  s_add_u32 s22, s31, 45056
  buffer_load_dwordx4 a[176:179], v2, s[8:11], s22 offen offset:0 sc1
  buffer_load_dwordx4 a[180:183], v2, s[8:11], s22 offen offset:1024 sc1
  buffer_load_dwordx4 a[184:187], v2, s[8:11], s22 offen offset:2048 sc1
  buffer_load_dwordx4 a[188:191], v2, s[8:11], s22 offen offset:3072 sc1
  s_add_u32 s22, s31, 49152
  buffer_load_dwordx4 a[192:195], v2, s[8:11], s22 offen offset:0 sc1
  buffer_load_dwordx4 a[196:199], v2, s[8:11], s22 offen offset:1024 sc1
  buffer_load_dwordx4 a[200:203], v2, s[8:11], s22 offen offset:2048 sc1
  buffer_load_dwordx4 a[204:207], v2, s[8:11], s22 offen offset:3072 sc1
  s_add_u32 s22, s31, 53248
  buffer_load_dwordx4 a[208:211], v2, s[8:11], s22 offen offset:0 sc1
  buffer_load_dwordx4 a[212:215], v2, s[8:11], s22 offen offset:1024 sc1
  buffer_load_dwordx4 a[216:219], v2, s[8:11], s22 offen offset:2048 sc1
  buffer_load_dwordx4 a[220:223], v2, s[8:11], s22 offen offset:3072 sc1
  s_add_u32 s22, s31, 57344
  buffer_load_dwordx4 a[224:227], v2, s[8:11], s22 offen offset:0 sc1
  buffer_load_dwordx4 a[228:231], v2, s[8:11], s22 offen offset:1024 sc1
  buffer_load_dwordx4 a[232:235], v2, s[8:11], s22 offen offset:2048 sc1
  buffer_load_dwordx4 a[236:239], v2, s[8:11], s22 offen offset:3072 sc1
  s_add_u32 s22, s31, 61440
  buffer_load_dwordx4 a[240:243], v2, s[8:11], s22 offen offset:0 sc1
  buffer_load_dwordx4 a[244:247], v2, s[8:11], s22 offen offset:1024 sc1
  buffer_load_dwordx4 a[248:251], v2, s[8:11], s22 offen offset:2048 sc1
  buffer_load_dwordx4 a[252:255], v2, s[8:11], s22 offen offset:3072 sc1
  s_waitcnt vmcnt(24)
  s_add_u32 s22, s31, 65536
  buffer_load_dwordx4 v[120:123], v2, s[8:11], s22 offen offset:0 sc1
  buffer_load_dwordx4 v[124:127], v2, s[8:11], s22 offen offset:1024 sc1
  buffer_load_dwordx4 v[128:131], v2, s[8:11], s22 offen offset:2048 sc1
  buffer_load_dwordx4 v[132:135], v2, s[8:11], s22 offen offset:3072 sc1
  s_add_u32 s22, s31, 69632
  buffer_load_dwordx4 v[136:139], v2, s[8:11], s22 offen offset:0 sc1
  buffer_load_dwordx4 v[140:143], v2, s[8:11], s22 offen offset:1024 sc1
  buffer_load_dwordx4 v[144:147], v2, s[8:11], s22 offen offset:2048 sc1
  buffer_load_dwordx4 v[148:151], v2, s[8:11], s22 offen offset:3072 sc1
  s_add_u32 s22, s31, 73728
  buffer_load_dwordx4 v[152:155], v2, s[8:11], s22 offen offset:0 sc1
  buffer_load_dwordx4 v[156:159], v2, s[8:11], s22 offen offset:1024 sc1
  buffer_load_dwordx4 v[160:163], v2, s[8:11], s22 offen offset:2048 sc1
  buffer_load_dwordx4 v[164:167], v2, s[8:11], s22 offen offset:3072 sc1
  s_add_u32 s22, s31, 77824
  buffer_load_dwordx4 v[168:171], v2, s[8:11], s22 offen offset:0 sc1
  buffer_load_dwordx4 v[172:175], v2, s[8:11], s22 offen offset:1024 sc1
  buffer_load_dwordx4 v[176:179], v2, s[8:11], s22 offen offset:2048 sc1
  buffer_load_dwordx4 v[180:183], v2, s[8:11], s22 offen offset:3072 sc1
  s_add_u32 s22, s31, 81920
  buffer_load_dwordx4 v[184:187], v2, s[8:11], s22 offen offset:0 sc1
  buffer_load_dwordx4 v[188:191], v2, s[8:11], s22 offen offset:1024 sc1
  buffer_load_dwordx4 v[192:195], v2, s[8:11], s22 offen offset:2048 sc1
  buffer_load_dwordx4 v[196:199], v2, s[8:11], s22 offen offset:3072 sc1
  s_add_u32 s22, s31, 86016
  buffer_load_dwordx4 v[200:203], v2, s[8:11], s22 offen offset:0 sc1
  buffer_load_dwordx4 v[204:207], v2, s[8:11], s22 offen offset:1024 sc1
  buffer_load_dwordx4 v[208:211], v2, s[8:11], s22 offen offset:2048 sc1
  buffer_load_dwordx4 v[212:215], v2, s[8:11], s22 offen offset:3072 sc1
  s_add_u32 s22, s31, 90112
  buffer_load_dwordx4 v[216:219], v2, s[8:11], s22 offen offset:0 sc1
  buffer_load_dwordx4 v[220:223], v2, s[8:11], s22 offen offset:1024 sc1
  buffer_load_dwordx4 v[224:227], v2, s[8:11], s22 offen offset:2048 sc1
  buffer_load_dwordx4 v[228:231], v2, s[8:11], s22 offen offset:3072 sc1
  s_add_u32 s22, s31, 94208
  buffer_load_dwordx4 v[232:235], v2, s[8:11], s22 offen offset:0 sc1
  buffer_load_dwordx4 v[236:239], v2, s[8:11], s22 offen offset:1024 sc1
  buffer_load_dwordx4 v[240:243], v2, s[8:11], s22 offen offset:2048 sc1
  buffer_load_dwordx4 v[244:247], v2, s[8:11], s22 offen offset:3072 sc1
  s_waitcnt vmcnt(24)
  s_add_u32 s22, s31, 98304
  buffer_load_dwordx4 v[248:251], v2, s[8:11], s22 offen offset:0 sc1
  buffer_load_dwordx4 v[252:255], v2, s[8:11], s22 offen offset:1024 sc1
  v_lshlrev_b32 v16, 2, v2
  s_getpc_b64 s[98:99]
ct_11:
  s_add_u32 s98, s98, cA_va2_loop-ct_11
  s_addc_u32 s99, s99, 0
  global_load_dword v15, v16, s[98:99]
  s_mov_b32 s30, 0
ch_ws6:
  buffer_load_dword v9, off, s[12:15], 0 offset:132 sc1
  s_waitcnt vmcnt(0)
  v_cmp_ne_u32 vcc, 1, v9
  s_cbranch_vccz ch_ws6_ok
  s_sleep 8
  s_add_u32 s30, s30, 1
  s_cmp_lt_u32 s30, 400000
  s_cbranch_scc1 ch_ws6
  s_branch cA_abort
ch_ws6_ok:
  s_lshl_b32 s27, s17, 7
  s_add_u32 s27, s27, 524288
  s_mov_b32 s30, 0
ch_vw2:
  buffer_load_dword v9, off, s[8:11], s27 sc1
  s_waitcnt vmcnt(0)
  v_cmp_ne_u32 vcc, 56, v9
  s_cbranch_vccz ch_vw2_d
  s_sleep 2
  s_add_u32 s30, s30, 1
  s_cmp_lt_u32 s30, 400000
  s_cbranch_scc1 ch_vw2
  s_branch cA_abort
ch_vw2_d:
  s_mov_b32 s28, s35
  s_waitcnt vmcnt(0) lgkmcnt(0)
  s_mov_b32 s31, 0
  s_cmp_lg_u32 s88, 0
  s_cbranch_scc1 cB_va2_loop
  s_branch cA_va2_loop
ch_init7:
  v_mov_b32 v72, v116
  v_mov_b32 v73, v117
  v_lshrrev_b32 v65, 1, v72
  v_and_b32 v66, 1, v72
  v_mov_b32 v36, 0
  v_mov_b32 v37, 0
  v_mov_b32 v38, 0
  v_mov_b32 v39, 0
  v_mov_b32 v40, 0
  v_mov_b32 v41, 0
  v_mov_b32 v42, 0
  v_mov_b32 v43, 0
  v_mov_b32 v44, 0
  v_mov_b32 v45, 0
  v_mov_b32 v46, 0
  v_mov_b32 v47, 0
  v_mov_b32 v48, 0
  v_mov_b32 v49, 0
  v_mov_b32 v50, 0
  v_mov_b32 v51, 0
  v_mov_b32 v52, 0
  v_mov_b32 v53, 0
  v_mov_b32 v54, 0
  v_mov_b32 v55, 0
  v_mov_b32 v56, 0
  v_mov_b32 v57, 0
  v_mov_b32 v58, 0
  v_mov_b32 v59, 0
  v_mov_b32 v60, 0
  v_mov_b32 v61, 0
  v_mov_b32 v62, 0
  v_mov_b32 v63, 0
  v_lshlrev_b32 v75, 2, v65
  v_lshl_add_u32 v75, v66, 3, v75
  v_add_u32 v67, 336, v73
  v_mul_u32_u24 v68, 2341, v67
  v_lshrrev_b32 v68, 16, v68
  v_mul_u32_u24 v69, 28, v68
  v_sub_u32 v69, v67, v69
  v_lshrrev_b32 v70, 4, v69
  v_and_b32 v69, 15, v69
  v_lshlrev_b32 v71, 12, v70
  v_lshl_add_u32 v71, v68, 8, v71
  v_lshl_add_u32 v71, v69, 4, v71
  v_add_u32 v104, v71, v75
  v_add_u32 v67, 352, v73
  v_mul_u32_u24 v68, 2341, v67
  v_lshrrev_b32 v68, 16, v68
  v_mul_u32_u24 v69, 28, v68
  v_sub_u32 v69, v67, v69
  v_lshrrev_b32 v70, 4, v69
  v_and_b32 v69, 15, v69
  v_lshlrev_b32 v71, 12, v70
  v_lshl_add_u32 v71, v68, 8, v71
  v_lshl_add_u32 v71, v69, 4, v71
  v_add_u32 v105, v71, v75
  v_add_u32 v67, 368, v73
  v_mul_u32_u24 v68, 2341, v67
  v_lshrrev_b32 v68, 16, v68
  v_mul_u32_u24 v69, 28, v68
  v_sub_u32 v69, v67, v69
  v_lshrrev_b32 v70, 4, v69
  v_and_b32 v69, 15, v69
  v_lshlrev_b32 v71, 12, v70
  v_lshl_add_u32 v71, v68, 8, v71
  v_lshl_add_u32 v71, v69, 4, v71
  v_add_u32 v106, v71, v75
  v_add_u32 v67, 384, v73
  v_mul_u32_u24 v68, 2341, v67
  v_lshrrev_b32 v68, 16, v68
  v_mul_u32_u24 v69, 28, v68
  v_sub_u32 v69, v67, v69
  v_lshrrev_b32 v70, 4, v69
  v_and_b32 v69, 15, v69
  v_lshlrev_b32 v71, 12, v70
  v_lshl_add_u32 v71, v68, 8, v71
  v_lshl_add_u32 v71, v69, 4, v71
  v_add_u32 v107, v71, v75
  v_add_u32 v67, 400, v73
  v_mul_u32_u24 v68, 2341, v67
  v_lshrrev_b32 v68, 16, v68
  v_mul_u32_u24 v69, 28, v68
  v_sub_u32 v69, v67, v69
  v_lshrrev_b32 v70, 4, v69
  v_and_b32 v69, 15, v69
  v_lshlrev_b32 v71, 12, v70
  v_lshl_add_u32 v71, v68, 8, v71
  v_lshl_add_u32 v71, v69, 4, v71
  v_add_u32 v108, v71, v75
  v_add_u32 v67, 416, v73
  v_mul_u32_u24 v68, 2341, v67
  v_lshrrev_b32 v68, 16, v68
  v_mul_u32_u24 v69, 28, v68
  v_sub_u32 v69, v67, v69
  v_lshrrev_b32 v70, 4, v69
  v_and_b32 v69, 15, v69
  v_lshlrev_b32 v71, 12, v70
  v_lshl_add_u32 v71, v68, 8, v71
  v_lshl_add_u32 v71, v69, 4, v71
  v_add_u32 v109, v71, v75
  v_add_u32 v67, 432, v73
  v_mul_u32_u24 v68, 2341, v67
  v_lshrrev_b32 v68, 16, v68
  v_mul_u32_u24 v69, 28, v68
  v_sub_u32 v69, v67, v69
  v_lshrrev_b32 v70, 4, v69
  v_and_b32 v69, 15, v69
  v_lshlrev_b32 v71, 12, v70
  v_lshl_add_u32 v71, v68, 8, v71
  v_lshl_add_u32 v71, v69, 4, v71
  v_add_u32 v110, v71, v75
  v_mov_b32 v74, 0x40000000
  v_mov_b32 v96, 0
  s_mul_i32 s22, s17, 28672
  s_add_u32 s25, s22, 2490368
  v_and_b32 v119, 15, v1
  s_and_b32 s22, s17, 0
  s_lshl_b32 s22, s22, 7
  s_add_u32 s22, s22, 39168
  v_lshl_add_u32 v119, v119, 2, s22
  s_lshl_b32 s22, s17, 2
  s_add_u32 s22, s22, 37248
  v_lshl_add_u32 v118, v1, 7, s22
  v_cmp_gt_u32 vcc, 1, v1
  s_nop 1
  v_cndmask_b32 v118, v74, v118, vcc
  s_lshl_b32 s35, s17, 7
  s_add_u32 s35, s35, 524288
  v_mov_b32 v64, 0
  v_mov_b32 v65, 0
  v_mov_b32 v66, 0
  v_mov_b32 v67, 0
  v_min_u32 v116, 13, v1
  s_mul_i32 s22, s17, 14
  v_add_u32 v116, s22, v116
  v_lshlrev_b32 v116, 7, v116
  s_mul_i32 s31, s17, 401408
  s_add_u32 s31, s31, 40278016
  s_mov_b32 s30, 0
ch_wr7:
  buffer_load_dword v9, off, s[12:15], 0 offset:128 sc1
  s_waitcnt vmcnt(0)
  v_cmp_ne_u32 vcc, 1, v9
  s_cbranch_vccz ch_wr7_ok
  s_sleep 8
  s_add_u32 s30, s30, 1
  s_cmp_lt_u32 s30, 400000
  s_cbranch_scc1 ch_wr7
  s_branch cA_abort
ch_wr7_ok:
  s_lshr_b32 s22, s17, 2
  s_lshl_b32 s28, 0x81, s22
  s_mul_i32 s27, s17, 12
  s_add_u32 s22, s27, 256
  s_lshr_b32 s22, s22, 6
  s_lshl_b32 s22, 0x81, s22
  s_or_b32 s28, s28, s22
  s_add_u32 s22, s27, 267
  s_lshr_b32 s22, s22, 6
  s_lshl_b32 s22, 0x81, s22
  s_or_b32 s28, s28, s22
  v_lshrrev_b32 v12, 8, v2
  v_lshlrev_b32 v12, 7, v12
  s_mov_b32 s27, 583680
  s_mov_b32 s30, 0
ch_ww7:
  buffer_load_dword v9, v12, s[8:11], s27 offen sc1
  s_waitcnt vmcnt(0)
  v_and_b32 v10, s28, v9
  v_cmp_ne_u32 vcc, s28, v10
  s_cbranch_vccz ch_ww7_ok
  s_sleep 3
  s_add_u32 s30, s30, 1
  s_cmp_lt_u32 s30, 400000
  s_cbranch_scc1 ch_ww7
  s_branch cA_abort
ch_ww7_ok:
  s_add_u32 s22, s31, 0
  buffer_load_dwordx4 a[0:3], v2, s[8:11], s22 offen offset:0 sc1
  buffer_load_dwordx4 a[4:7], v2, s[8:11], s22 offen offset:1024 sc1
  buffer_load_dwordx4 a[8:11], v2, s[8:11], s22 offen offset:2048 sc1
  buffer_load_dwordx4 a[12:15], v2, s[8:11], s22 offen offset:3072 sc1
  s_add_u32 s22, s31, 4096
  buffer_load_dwordx4 a[16:19], v2, s[8:11], s22 offen offset:0 sc1
  buffer_load_dwordx4 a[20:23], v2, s[8:11], s22 offen offset:1024 sc1
  buffer_load_dwordx4 a[24:27], v2, s[8:11], s22 offen offset:2048 sc1
  buffer_load_dwordx4 a[28:31], v2, s[8:11], s22 offen offset:3072 sc1
  s_add_u32 s22, s31, 8192
  buffer_load_dwordx4 a[32:35], v2, s[8:11], s22 offen offset:0 sc1
  buffer_load_dwordx4 a[36:39], v2, s[8:11], s22 offen offset:1024 sc1
  buffer_load_dwordx4 a[40:43], v2, s[8:11], s22 offen offset:2048 sc1
  buffer_load_dwordx4 a[44:47], v2, s[8:11], s22 offen offset:3072 sc1
  s_add_u32 s22, s31, 12288
  buffer_load_dwordx4 a[48:51], v2, s[8:11], s22 offen offset:0 sc1
  buffer_load_dwordx4 a[52:55], v2, s[8:11], s22 offen offset:1024 sc1
  buffer_load_dwordx4 a[56:59], v2, s[8:11], s22 offen offset:2048 sc1
  buffer_load_dwordx4 a[60:63], v2, s[8:11], s22 offen offset:3072 sc1
  s_add_u32 s22, s31, 16384
  buffer_load_dwordx4 a[64:67], v2, s[8:11], s22 offen offset:0 sc1
  buffer_load_dwordx4 a[68:71], v2, s[8:11], s22 offen offset:1024 sc1
  buffer_load_dwordx4 a[72:75], v2, s[8:11], s22 offen offset:2048 sc1
  buffer_load_dwordx4 a[76:79], v2, s[8:11], s22 offen offset:3072 sc1
  s_add_u32 s22, s31, 20480
  buffer_load_dwordx4 a[80:83], v2, s[8:11], s22 offen offset:0 sc1
  buffer_load_dwordx4 a[84:87], v2, s[8:11], s22 offen offset:1024 sc1
  buffer_load_dwordx4 a[88:91], v2, s[8:11], s22 offen offset:2048 sc1
  buffer_load_dwordx4 a[92:95], v2, s[8:11], s22 offen offset:3072 sc1
  s_add_u32 s22, s31, 24576
  buffer_load_dwordx4 a[96:99], v2, s[8:11], s22 offen offset:0 sc1
  buffer_load_dwordx4 a[100:103], v2, s[8:11], s22 offen offset:1024 sc1
  buffer_load_dwordx4 a[104:107], v2, s[8:11], s22 offen offset:2048 sc1
  buffer_load_dwordx4 a[108:111], v2, s[8:11], s22 offen offset:3072 sc1
  s_add_u32 s22, s31, 28672
  buffer_load_dwordx4 a[112:115], v2, s[8:11], s22 offen offset:0 sc1
  buffer_load_dwordx4 a[116:119], v2, s[8:11], s22 offen offset:1024 sc1
  buffer_load_dwordx4 a[120:123], v2, s[8:11], s22 offen offset:2048 sc1
  buffer_load_dwordx4 a[124:127], v2, s[8:11], s22 offen offset:3072 sc1
  s_waitcnt vmcnt(24)
  s_add_u32 s22, s31, 32768
  buffer_load_dwordx4 a[128:131], v2, s[8:11], s22 offen offset:0 sc1
  buffer_load_dwordx4 a[132:135], v2, s[8:11], s22 offen offset:1024 sc1
  buffer_load_dwordx4 a[136:139], v2, s[8:11], s22 offen offset:2048 sc1
  buffer_load_dwordx4 a[140:143], v2, s[8:11], s22 offen offset:3072 sc1
  s_add_u32 s22, s31, 36864
  buffer_load_dwordx4 a[144:147], v2, s[8:11], s22 offen offset:0 sc1
  buffer_load_dwordx4 a[148:151], v2, s[8:11], s22 offen offset:1024 sc1
  buffer_load_dwordx4 a[152:155], v2, s[8:11], s22 offen offset:2048 sc1
  buffer_load_dwordx4 a[156:159], v2, s[8:11], s22 offen offset:3072 sc1
  s_add_u32 s22, s31, 40960
  buffer_load_dwordx4 a[160:163], v2, s[8:11], s22 offen offset:0 sc1
  buffer_load_dwordx4 a[164:167], v2, s[8:11], s22 offen offset:1024 sc1
  buffer_load_dwordx4 a[168:171], v2, s[8:11], s22 offen offset:2048 sc1
  buffer_load_dwordx4 a[172:175], v2, s[8:11], s22 offen offset:3072 sc1
  s_add_u32 s22, s31, 45056
  buffer_load_dwordx4 a[176:179], v2, s[8:11], s22 offen offset:0 sc1
  buffer_load_dwordx4 a[180:183], v2, s[8:11], s22 offen offset:1024 sc1
  buffer_load_dwordx4 a[184:187], v2, s[8:11], s22 offen offset:2048 sc1
  buffer_load_dwordx4 a[188:191], v2, s[8:11], s22 offen offset:3072 sc1
  s_add_u32 s22, s31, 49152
  buffer_load_dwordx4 a[192:195], v2, s[8:11], s22 offen offset:0 sc1
  buffer_load_dwordx4 a[196:199], v2, s[8:11], s22 offen offset:1024 sc1
  buffer_load_dwordx4 a[200:203], v2, s[8:11], s22 offen offset:2048 sc1
  buffer_load_dwordx4 a[204:207], v2, s[8:11], s22 offen offset:3072 sc1
  s_add_u32 s22, s31, 53248
  buffer_load_dwordx4 a[208:211], v2, s[8:11], s22 offen offset:0 sc1
  buffer_load_dwordx4 a[212:215], v2, s[8:11], s22 offen offset:1024 sc1
  buffer_load_dwordx4 a[216:219], v2, s[8:11], s22 offen offset:2048 sc1
  buffer_load_dwordx4 a[220:223], v2, s[8:11], s22 offen offset:3072 sc1
  s_add_u32 s22, s31, 57344
  buffer_load_dwordx4 a[224:227], v2, s[8:11], s22 offen offset:0 sc1
  buffer_load_dwordx4 a[228:231], v2, s[8:11], s22 offen offset:1024 sc1
  buffer_load_dwordx4 a[232:235], v2, s[8:11], s22 offen offset:2048 sc1
  buffer_load_dwordx4 a[236:239], v2, s[8:11], s22 offen offset:3072 sc1
  s_add_u32 s22, s31, 61440
  buffer_load_dwordx4 a[240:243], v2, s[8:11], s22 offen offset:0 sc1
  buffer_load_dwordx4 a[244:247], v2, s[8:11], s22 offen offset:1024 sc1
  buffer_load_dwordx4 a[248:251], v2, s[8:11], s22 offen offset:2048 sc1
  buffer_load_dwordx4 a[252:255], v2, s[8:11], s22 offen offset:3072 sc1
  s_waitcnt vmcnt(24)
  s_add_u32 s22, s31, 65536
  buffer_load_dwordx4 v[120:123], v2, s[8:11], s22 offen offset:0 sc1
  buffer_load_dwordx4 v[124:127], v2, s[8:11], s22 offen offset:1024 sc1
  buffer_load_dwordx4 v[128:131], v2, s[8:11], s22 offen offset:2048 sc1
  buffer_load_dwordx4 v[132:135], v2, s[8:11], s22 offen offset:3072 sc1
  s_add_u32 s22, s31, 69632
  buffer_load_dwordx4 v[136:139], v2, s[8:11], s22 offen offset:0 sc1
  buffer_load_dwordx4 v[140:143], v2, s[8:11], s22 offen offset:1024 sc1
  buffer_load_dwordx4 v[144:147], v2, s[8:11], s22 offen offset:2048 sc1
  buffer_load_dwordx4 v[148:151], v2, s[8:11], s22 offen offset:3072 sc1
  s_add_u32 s22, s31, 73728
  buffer_load_dwordx4 v[152:155], v2, s[8:11], s22 offen offset:0 sc1
  buffer_load_dwordx4 v[156:159], v2, s[8:11], s22 offen offset:1024 sc1
  buffer_load_dwordx4 v[160:163], v2, s[8:11], s22 offen offset:2048 sc1
  buffer_load_dwordx4 v[164:167], v2, s[8:11], s22 offen offset:3072 sc1
  s_add_u32 s22, s31, 77824
  buffer_load_dwordx4 v[168:171], v2, s[8:11], s22 offen offset:0 sc1
  buffer_load_dwordx4 v[172:175], v2, s[8:11], s22 offen offset:1024 sc1
  buffer_load_dwordx4 v[176:179], v2, s[8:11], s22 offen offset:2048 sc1
  buffer_load_dwordx4 v[180:183], v2, s[8:11], s22 offen offset:3072 sc1
  s_add_u32 s22, s31, 81920
  buffer_load_dwordx4 v[184:187], v2, s[8:11], s22 offen offset:0 sc1
  buffer_load_dwordx4 v[188:191], v2, s[8:11], s22 offen offset:1024 sc1
  buffer_load_dwordx4 v[192:195], v2, s[8:11], s22 offen offset:2048 sc1
  buffer_load_dwordx4 v[196:199], v2, s[8:11], s22 offen offset:3072 sc1
  s_add_u32 s22, s31, 86016
  buffer_load_dwordx4 v[200:203], v2, s[8:11], s22 offen offset:0 sc1
  buffer_load_dwordx4 v[204:207], v2, s[8:11], s22 offen offset:1024 sc1
  buffer_load_dwordx4 v[208:211], v2, s[8:11], s22 offen offset:2048 sc1
  buffer_load_dwordx4 v[212:215], v2, s[8:11], s22 offen offset:3072 sc1
  s_add_u32 s22, s31, 90112
  buffer_load_dwordx4 v[216:219], v2, s[8:11], s22 offen offset:0 sc1
  buffer_load_dwordx4 v[220:223], v2, s[8:11], s22 offen offset:1024 sc1
  buffer_load_dwordx4 v[224:227], v2, s[8:11], s22 offen offset:2048 sc1
  buffer_load_dwordx4 v[228:231], v2, s[8:11], s22 offen offset:3072 sc1
  s_add_u32 s22, s31, 94208
  buffer_load_dwordx4 v[232:235], v2, s[8:11], s22 offen offset:0 sc1
  buffer_load_dwordx4 v[236:239], v2, s[8:11], s22 offen offset:1024 sc1
  buffer_load_dwordx4 v[240:243], v2, s[8:11], s22 offen offset:2048 sc1
  buffer_load_dwordx4 v[244:247], v2, s[8:11], s22 offen offset:3072 sc1
  s_waitcnt vmcnt(24)
  s_add_u32 s22, s31, 98304
  buffer_load_dwordx4 v[248:251], v2, s[8:11], s22 offen offset:0 sc1
  buffer_load_dwordx4 v[252:255], v2, s[8:11], s22 offen offset:1024 sc1
  v_lshlrev_b32 v16, 2, v2
  s_getpc_b64 s[98:99]
ct_12:
  s_add_u32 s98, s98, cA_va3_loop-ct_12
  s_addc_u32 s99, s99, 0
  global_load_dword v15, v16, s[98:99]
  s_mov_b32 s30, 0
ch_ws7:
  buffer_load_dword v9, off, s[12:15], 0 offset:132 sc1
  s_waitcnt vmcnt(0)
  v_cmp_ne_u32 vcc, 1, v9
  s_cbranch_vccz ch_ws7_ok
  s_sleep 8
  s_add_u32 s30, s30, 1
  s_cmp_lt_u32 s30, 400000
  s_cbranch_scc1 ch_ws7
  s_branch cA_abort
ch_ws7_ok:
  s_lshl_b32 s27, s17, 7
  s_add_u32 s27, s27, 524288
  s_mov_b32 s30, 0
ch_vw3:
  buffer_load_dword v9, off, s[8:11], s27 sc1
  s_waitcnt vmcnt(0)
  v_cmp_ne_u32 vcc, 56, v9
  s_cbranch_vccz ch_vw3_d
  s_sleep 2
  s_add_u32 s30, s30, 1
  s_cmp_lt_u32 s30, 400000
  s_cbranch_scc1 ch_vw3
  s_branch cA_abort
ch_vw3_d:
  s_mov_b32 s28, s35
  s_mov_b32 s39, 684032
  buffer_load_dword v100, v116, s[8:11], s39 offen sc1
  s_mov_b32 s39, 712704
  s_waitcnt vmcnt(1) lgkmcnt(0)
  s_mov_b32 s31, 0
  s_cmp_lg_u32 s88, 0
  s_cbranch_scc1 cB_va3_loop
  s_branch cA_va3_loop
.p2align 6
cA_sc0_loop:
  s_mov_b32 s30, 0
  s_mov_b32 s62, 0
  s_setprio 3
cA_sc0_fp_l:
  v_cmp_gt_u32 vcc, s19, v112
  buffer_load_dword v112, v0, s[8:11], 0 offen sc1
  s_cbranch_vccz cA_sc0_fp_d
  v_cmp_gt_u32 vcc, s19, v112
  buffer_load_dword v112, v0, s[8:11], 0 offen sc1
  s_cbranch_vccz cA_sc0_fp_d
  v_cmp_gt_u32 vcc, s19, v112
  buffer_load_dword v112, v0, s[8:11], 0 offen sc1
  s_cbranch_vccz cA_sc0_fp_d
  v_cmp_gt_u32 vcc, s19, v112
  buffer_load_dword v112, v0, s[8:11], 0 offen sc1
  s_cbranch_vccz cA_sc0_fp_d
  v_cmp_gt_u32 vcc, s19, v112
  buffer_load_dword v112, v0, s[8:11], 0 offen sc1
  s_cbranch_vccz cA_sc0_fp_d
  v_cmp_gt_u32 vcc, s19, v112
  buffer_load_dword v112, v0, s[8:11], 0 offen sc1
  s_cbranch_vccz cA_sc0_fp_d
  v_cmp_gt_u32 vcc, s19, v112
  buffer_load_dword v112, v0, s[8:11], 0 offen sc1
  s_cbranch_vccz cA_sc0_fp_d
  v_cmp_gt_u32 vcc, s19, v112
  buffer_load_dword v112, v0, s[8:11], 0 offen sc1
  s_cbranch_vccz cA_sc0_fp_d
  v_cmp_gt_u32 vcc, s19, v112
  buffer_load_dword v112, v0, s[8:11], 0 offen sc1
  s_cbranch_vccz cA_sc0_fp_d
  v_cmp_gt_u32 vcc, s19, v112
  buffer_load_dword v112, v0, s[8:11], 0 offen sc1
  s_cbranch_vccz cA_sc0_fp_d
  v_cmp_gt_u32 vcc, s19, v112
  buffer_load_dword v112, v0, s[8:11], 0 offen sc1
  s_cbranch_vccz cA_sc0_fp_d
  v_cmp_gt_u32 vcc, s19, v112
  buffer_load_dword v112, v0, s[8:11], 0 offen sc1
  s_cbranch_vccz cA_sc0_fp_d
  v_cmp_gt_u32 vcc, s19, v112
  buffer_load_dword v112, v0, s[8:11], 0 offen sc1
  s_cbranch_vccz cA_sc0_fp_d
  v_cmp_gt_u32 vcc, s19, v112
  buffer_load_dword v112, v0, s[8:11], 0 offen sc1
  s_cbranch_vccz cA_sc0_fp_d
  v_cmp_gt_u32 vcc, s19, v112
  buffer_load_dword v112, v0, s[8:11], 0 offen sc1
  s_cbranch_vccz cA_sc0_fp_d
  v_cmp_gt_u32 vcc, s19, v112
  buffer_load_dword v112, v0, s[8:11], 0 offen sc1
  s_cbranch_vccz cA_sc0_fp_d
  s_waitcnt vmcnt(24)
  s_add_u32 s30, s30, 1
  s_cmp_lt_u32 s30, 400000
  s_cbranch_scc1 cA_sc0_fp_l
  s_branch cA_abort
cA_sc0_fp_d:
  buffer_load_dwordx4 v[8:11], v2, s[8:11], s20 offen offset:0 sc1
  s_barrier
  s_setprio 2
  buffer_load_dwordx4 v[12:15], v2, s[8:11], s20 offen offset:1024 sc1
  s_setprio 1
  buffer_load_dwordx4 v[16:19], v2, s[8:11], s20 offen offset:2048 sc1
  s_setprio 0
  buffer_load_dwordx4 v[20:23], v2, s[8:11], s20 offen offset:3072 sc1
cA_sc0_go:
  s_waitcnt vmcnt(3)
  v_smfmac_f32_16x16x64_bf16 v[36:39], v[8:11], a[0:7], v3
  buffer_load_dwordx4 v[32:35], v2, s[8:11], s23 offen offset:0 sc1
  v_cmp_eq_u32 vcc, -1, v8
  v_smfmac_f32_16x16x64_bf16 v[40:43], v[8:11], a[56:63], v3
  v_smfmac_f32_16x16x64_bf16 v[44:47], v[8:11], a[112:119], v3
  buffer_load_dwordx4 v[24:27], v2, s[8:11], s23 offen offset:1024 sc1
  s_cbranch_vccnz cA_sc0_r0
  v_smfmac_f32_16x16x64_bf16 v[48:51], v[8:11], a[168:175], v3
  v_smfmac_f32_16x16x64_bf16 v[52:55], v[8:11], a[224:231], v3
  v_smfmac_f32_16x16x64_bf16 v[56:59], v[8:11], v[144:151], v3
  buffer_load_dwordx4 v[28:31], v2, s[8:11], s23 offen offset:2048 sc1
  v_smfmac_f32_16x16x64_bf16 v[60:63], v[8:11], v[200:207], v3
  s_waitcnt vmcnt(5)
  v_smfmac_f32_16x16x64_bf16 v[36:39], v[12:15], a[8:15], v3
  v_smfmac_f32_16x16x64_bf16 v[40:43], v[12:15], a[64:71], v3
  v_smfmac_f32_16x16x64_bf16 v[44:47], v[12:15], a[120:127], v3
  v_smfmac_f32_16x16x64_bf16 v[48:51], v[12:15], a[176:183], v3
  v_smfmac_f32_16x16x64_bf16 v[52:55], v[12:15], a[232:239], v3
  v_smfmac_f32_16x16x64_bf16 v[56:59], v[12:15], v[152:159], v3
  buffer_load_dwordx4 v[88:91], v117, s[8:11], s26 offen offset:0 sc1
  v_smfmac_f32_16x16x64_bf16 v[60:63], v[12:15], v[208:215], v3
  s_waitcnt vmcnt(5)
  v_smfmac_f32_16x16x64_bf16 v[36:39], v[16:19], a[16:23], v3
  v_smfmac_f32_16x16x64_bf16 v[40:43], v[16:19], a[72:79], v3
  v_smfmac_f32_16x16x64_bf16 v[44:47], v[16:19], a[128:135], v3
  buffer_load_dwordx4 v[92:95], v117, s[8:11], s26 offen offset:1024 sc1
  v_smfmac_f32_16x16x64_bf16 v[48:51], v[16:19], a[184:191], v3
  v_smfmac_f32_16x16x64_bf16 v[52:55], v[16:19], a[240:247], v3
  v_smfmac_f32_16x16x64_bf16 v[56:59], v[16:19], v[160:167], v3
  v_smfmac_f32_16x16x64_bf16 v[60:63], v[16:19], v[216:223], v3
  s_waitcnt vmcnt(5)
  buffer_load_dwordx4 v[96:99], v2, s[8:11], s24 offen offset:0 sc1
  v_smfmac_f32_16x16x64_bf16 v[36:39], v[20:23], a[24:31], v3
  v_smfmac_f32_16x16x64_bf16 v[40:43], v[20:23], a[80:87], v3
  v_max3_u32 v66, v12, v16, v20
  v_smfmac_f32_16x16x64_bf16 v[44:47], v[20:23], a[136:143], v3
  v_smfmac_f32_16x16x64_bf16 v[48:51], v[20:23], a[192:199], v3
  buffer_load_dwordx4 v[100:103], v2, s[8:11], s24 offen offset:1024 sc1
  v_smfmac_f32_16x16x64_bf16 v[52:55], v[20:23], a[248:255], v3
  v_smfmac_f32_16x16x64_bf16 v[56:59], v[20:23], v[168:175], v3
  v_smfmac_f32_16x16x64_bf16 v[60:63], v[20:23], v[224:231], v3
  s_waitcnt vmcnt(4)
  v_smfmac_f32_16x16x64_bf16 v[60:63], v[32:35], v[232:239], v3
  buffer_load_dwordx4 v[104:107], v2, s[8:11], s26 offen offset:0 sc1
  v_max3_u32 v66, v66, v24, v27
  v_smfmac_f32_16x16x64_bf16 v[60:63], v[24:27], v[240:247], v3
  v_max3_u32 v66, v66, v28, v31
  v_smfmac_f32_16x16x64_bf16 v[60:63], v[28:31], v[248:255], v3
  v_max3_u32 v66, v66, v32, v35
  v_smfmac_f32_16x16x64_bf16 v[52:55], v[32:35], v[120:127], v3
  v_cmp_eq_u32 vcc, -1, v66
  v_smfmac_f32_16x16x64_bf16 v[52:55], v[24:27], v[128:135], v3
  buffer_load_dwordx4 v[108:111], v2, s[8:11], s26 offen offset:1024 sc1
  v_smfmac_f32_16x16x64_bf16 v[52:55], v[28:31], v[136:143], v3
  s_cbranch_vccnz cA_sc0_r4
  v_cvt_pk_bf16_f32 v63, v62, v63
  v_smfmac_f32_16x16x64_bf16 v[56:59], v[32:35], v[176:183], v3
  v_cvt_pk_bf16_f32 v62, v60, v61
  v_smfmac_f32_16x16x64_bf16 v[56:59], v[24:27], v[184:191], v3
  v_mfma_f32_16x16x32_bf16 v[12:15], v[62:65], v[4:7], 0
  v_cvt_pk_bf16_f32 v55, v54, v55
  v_smfmac_f32_16x16x64_bf16 v[56:59], v[28:31], v[192:199], v3
  v_cvt_pk_bf16_f32 v54, v52, v53
  v_smfmac_f32_16x16x64_bf16 v[36:39], v[32:35], a[32:39], v3
  s_nop 1
  v_cvt_pk_bf16_f32 v76, v12, v13
  v_smfmac_f32_16x16x64_bf16 v[36:39], v[24:27], a[40:47], v3
  v_cvt_pk_bf16_f32 v77, v14, v15
  v_smfmac_f32_16x16x64_bf16 v[36:39], v[28:31], a[48:55], v3
  v_cvt_pk_bf16_f32 v56, v56, v57
  v_smfmac_f32_16x16x64_bf16 v[40:43], v[32:35], a[88:95], v3
  v_cvt_pk_bf16_f32 v57, v58, v59
  v_smfmac_f32_16x16x64_bf16 v[40:43], v[24:27], a[96:103], v3
  v_mfma_f32_16x16x32_bf16 v[16:19], v[54:57], v[4:7], 0
  v_cvt_pk_bf16_f32 v39, v38, v39
  v_smfmac_f32_16x16x64_bf16 v[40:43], v[28:31], a[104:111], v3
  v_cvt_pk_bf16_f32 v38, v36, v37
  v_smfmac_f32_16x16x64_bf16 v[44:47], v[32:35], a[144:151], v3
  s_nop 1
  v_cvt_pk_bf16_f32 v78, v16, v17
  v_smfmac_f32_16x16x64_bf16 v[44:47], v[24:27], a[152:159], v3
  v_cvt_pk_bf16_f32 v79, v18, v19
  v_smfmac_f32_16x16x64_bf16 v[44:47], v[28:31], a[160:167], v3
  v_cvt_pk_bf16_f32 v40, v40, v41
  v_smfmac_f32_16x16x64_bf16 v[48:51], v[32:35], a[200:207], v3
  v_cvt_pk_bf16_f32 v41, v42, v43
  v_smfmac_f32_16x16x64_bf16 v[48:51], v[24:27], a[208:215], v3
  v_smfmac_f32_16x16x64_bf16 v[48:51], v[28:31], a[216:223], v3
  s_waitcnt vmcnt(4)
  v_cvt_pk_bf16_f32 v47, v46, v47
  v_smfmac_f32_16x16x64_bf16 v[68:71], v[76:79], v[80:87], v3
  v_cvt_pk_bf16_f32 v46, v44, v45
  v_mfma_f32_16x16x32_bf16 v[12:15], v[38:41], v[4:7], 0
  s_nop 1
  v_cvt_pk_bf16_f32 v48, v48, v49
  v_cvt_pk_bf16_f32 v49, v50, v51
  s_nop 1
  v_mfma_f32_16x16x32_bf16 v[16:19], v[46:49], v[4:7], 0
  v_smfmac_f32_16x16x64_bf16 v[72:75], v[76:79], v[88:95], v3
  v_cvt_pk_bf16_f32 v20, v12, v13
  v_mfma_f32_16x16x32_bf16 v[52:55], v[30:33], v[76:79], 0
  s_waitcnt vmcnt(0)
  v_cvt_pk_bf16_f32 v21, v14, v15
  v_cvt_pk_bf16_f32 v22, v16, v17
  v_cvt_pk_bf16_f32 v23, v18, v19
  s_nop 1
  v_mfma_f32_16x16x32_bf16 v[52:55], v[8:11], v[20:23], v[52:55]
  v_smfmac_f32_16x16x64_bf16 v[68:71], v[20:23], v[96:103], v3
  v_smfmac_f32_16x16x64_bf16 v[72:75], v[20:23], v[104:111], v3
  s_nop 1
  ds_write_b128 v113, v[52:55]
  s_nop 1
  v_permlane32_swap_b32 v68, v70
  v_permlane32_swap_b32 v69, v71
  v_add_f32 v56, v68, v70
  v_add_f32 v58, v69, v71
  v_permlane32_swap_b32 v72, v74
  v_permlane32_swap_b32 v73, v75
  v_add_f32 v57, v72, v74
  v_add_f32 v59, v73, v75
  ds_write_b128 v2, v[56:59] offset:0
  v_cmp_u_f32 vcc, v57, v59
  v_mov_b32 v68, 0
  v_mov_b32 v69, 0
  v_mov_b32 v70, 0
  v_mov_b32 v71, 0
  s_cbranch_vccnz cA_sc0_retry
cA_sc0_cont:
  s_add_u32 s24, s24, 28672
  s_add_u32 s26, s26, 28672
  buffer_load_dwordx4 v[80:83], v117, s[8:11], s24 offen offset:0 sc1
  buffer_load_dwordx4 v[84:87], v117, s[8:11], s24 offen offset:1024 sc1
  v_mfma_f32_32x32x16_bf16 v[36:51], v[68:71], v[68:71], 0
  s_waitcnt lgkmcnt(0)
  s_barrier
  ds_read_b64 v[8:9], v114 offset:0
  ds_read_b64 v[10:11], v114 offset:1024
  ds_read_b64 v[12:13], v114 offset:2048
  ds_read_b64 v[14:15], v114 offset:3072
  ds_read2_b32 v[16:17], v115 offset0:0 offset1:64
  ds_read2_b32 v[18:19], v115 offset0:128 offset1:192
  v_mfma_f32_32x32x16_bf16 v[52:67], v[68:71], v[68:71], 0
  s_waitcnt lgkmcnt(0)
  v_pk_add_f32 v[16:17], v[16:17], v[18:19]
  v_pk_add_f32 v[8:9], v[8:9], v[10:11]
  v_pk_add_f32 v[12:13], v[12:13], v[14:15]
  v_add_f32 v20, v16, v17
  v_pk_add_f32 v[8:9], v[8:9], v[12:13]
  v_max_f32 v22, v8, v9
  v_add_f32_dpp v20, v20, v20 row_ror:8 row_mask:0xf bank_mask:0xf
  s_nop 0
  v_max_f32_dpp v22, v22, v22 row_ror:8 row_mask:0xf bank_mask:0xf
  v_max_f32 v22, v22, v20
  s_nop 1
  v_max_f32_dpp v22, v22, v22 quad_perm:[1,0,3,2] row_mask:0xf bank_mask:0xf
  s_nop 1
  v_max_f32_dpp v22, v22, v22 quad_perm:[2,3,0,1] row_mask:0xf bank_mask:0xf
  s_nop 1
  v_max_f32_dpp v22, v22, v22 row_half_mirror row_mask:0xf bank_mask:0xf
  v_pk_add_f32 v[8:9], v[8:9], v[22:23] op_sel_hi:[1,0] neg_lo:[0,1] neg_hi:[0,1]
  v_sub_f32 v20, v20, v22
  v_exp_f32 v8, v8
  v_exp_f32 v9, v9
  v_exp_f32 v20, v20
  v_add_f32 v24, v8, v9
  v_fmac_f32 v24, 0.5, v20
  v_mov_b32_dpp v21, v20 quad_perm:[1,0,3,2] row_mask:0xf bank_mask:0xf
  s_nop 0
  v_add_f32_dpp v24, v24, v24 quad_perm:[1,0,3,2] row_mask:0xf bank_mask:0xf
  s_nop 1
  v_add_f32_dpp v24, v24, v24 quad_perm:[2,3,0,1] row_mask:0xf bank_mask:0xf
  s_nop 1
  v_add_f32_dpp v24, v24, v24 row_half_mirror row_mask:0xf bank_mask:0xf
  s_nop 1
  v_add_f32_dpp v24, v24, v24 row_ror:8 row_mask:0xf bank_mask:0xf
  v_rcp_f32 v24, v24
  s_nop 0
  v_pk_mul_f32 v[8:9], v[8:9], v[24:25] op_sel_hi:[1,0]
  v_cvt_pk_bf16_f32 v8, abs(v8), abs(v9)
  buffer_store_dword v8, v1, s[8:11], s20 offen
  v_pk_mul_f32 v[20:21], v[20:21], v[24:25] op_sel_hi:[1,0]
  v_cvt_pk_bf16_f32 v20, abs(v20), abs(v21)
  buffer_store_dword v20, v118, s[8:11], s20 offen
  v_mov_b32 v72, 0
  v_mov_b32 v73, 0
  v_mov_b32 v74, 0
  v_mov_b32 v75, 0
  s_buffer_load_dword s64, s[8:11], s34 offset:0
  s_buffer_load_dword s65, s[8:11], s34 offset:64
  s_buffer_load_dword s66, s[8:11], s34 offset:128
  s_buffer_load_dword s67, s[8:11], s34 offset:192
  s_buffer_load_dword s64, s[8:11], s34 offset:256
  s_buffer_load_dword s65, s[8:11], s34 offset:320
  s_buffer_load_dword s66, s[8:11], s34 offset:384
  s_buffer_load_dword s67, s[8:11], s34 offset:448
  s_buffer_load_dword s64, s[8:11], s34 offset:512
  s_buffer_load_dword s65, s[8:11], s34 offset:576
  s_buffer_load_dword s66, s[8:11], s34 offset:640
  s_buffer_load_dword s67, s[8:11], s34 offset:704
  s_buffer_load_dword s64, s[8:11], s34 offset:768
  s_buffer_load_dword s65, s[8:11], s34 offset:832
  s_mov_b32 s36, s34
  s_add_u32 s34, s33, 458752
  s_mov_b32 s33, s34
  s_mov_b32 s19, s18
  s_add_u32 s18, s18, 1
  s_mov_b32 s22, s20
  s_mov_b32 s20, s21
  s_mov_b32 s21, s22
  s_add_u32 s23, s20, 4096
  s_sleep 7
  s_cmp_lt_u32 s19, 63
  s_cbranch_scc1 cA_sc0_loop
  s_branch cA_done
cA_sc0_r0:
  s_add_u32 s31, s31, 1
  buffer_load_dwordx4 v[8:11], v2, s[8:11], s20 offen offset:0 sc1
  s_waitcnt vmcnt(0)
  v_cmp_eq_u32 vcc, -1, v8
  v_mov_b32 v36, 0
  v_mov_b32 v37, 0
  v_mov_b32 v38, 0
  v_mov_b32 v39, 0
  v_mov_b32 v40, 0
  v_mov_b32 v41, 0
  v_mov_b32 v42, 0
  v_mov_b32 v43, 0
  v_mov_b32 v44, 0
  v_mov_b32 v45, 0
  v_mov_b32 v46, 0
  v_mov_b32 v47, 0
  v_mov_b32 v48, 0
  v_mov_b32 v49, 0
  v_mov_b32 v50, 0
  v_mov_b32 v51, 0
  s_nop 1
  s_cbranch_vccz cA_sc0_go
  s_add_u32 s30, s30, 1
  s_cmp_lt_u32 s30, 400000
  s_cbranch_scc1 cA_sc0_r0
  s_branch cA_abort
cA_sc0_r4:
  s_add_u32 s31, s31, 1
  buffer_load_dwordx4 v[12:15], v2, s[8:11], s20 offen offset:1024 sc1
  buffer_load_dwordx4 v[16:19], v2, s[8:11], s20 offen offset:2048 sc1
  buffer_load_dwordx4 v[20:23], v2, s[8:11], s20 offen offset:3072 sc1
  buffer_load_dwordx4 v[32:35], v2, s[8:11], s23 offen offset:0 sc1
  buffer_load_dwordx4 v[24:27], v2, s[8:11], s23 offen offset:1024 sc1
  buffer_load_dwordx4 v[28:31], v2, s[8:11], s23 offen offset:2048 sc1
  s_waitcnt vmcnt(0)
  v_max3_u32 v66, v12, v16, v20
  v_max3_u32 v66, v66, v24, v27
  v_max3_u32 v66, v66, v28, v31
  v_max3_u32 v66, v66, v32, v35
  v_cmp_eq_u32 vcc, -1, v66
  s_nop 4
  s_cbranch_vccz cA_sc0_rz
  s_add_u32 s30, s30, 1
  s_cmp_lt_u32 s30, 400000
  s_cbranch_scc1 cA_sc0_r4
  s_branch cA_abort
cA_sc0_retry:
  s_cmp_lg_u32 s62, 0
  s_cbranch_scc1 cA_sc0_cont
  s_waitcnt vmcnt(0) lgkmcnt(0)
cA_sc0_rv:
  buffer_load_dwordx4 v[8:11], v2, s[8:11], s20 offen offset:0 sc1
  buffer_load_dwordx4 v[12:15], v2, s[8:11], s20 offen offset:1024 sc1
  buffer_load_dwordx4 v[16:19], v2, s[8:11], s20 offen offset:2048 sc1
  buffer_load_dwordx4 v[20:23], v2, s[8:11], s20 offen offset:3072 sc1
  buffer_load_dwordx4 v[32:35], v2, s[8:11], s23 offen offset:0 sc1
  buffer_load_dwordx4 v[24:27], v2, s[8:11], s23 offen offset:1024 sc1
  buffer_load_dwordx4 v[28:31], v2, s[8:11], s23 offen offset:2048 sc1
  s_waitcnt vmcnt(0)
  v_max3_u32 v66, v8, v9, v10
  v_max3_u32 v66, v66, v11, v12
  v_max3_u32 v66, v66, v13, v14
  v_max3_u32 v66, v66, v15, v16
  v_max3_u32 v66, v66, v17, v18
  v_max3_u32 v66, v66, v19, v20
  v_max3_u32 v66, v66, v21, v22
  v_max3_u32 v66, v66, v23, v24
  v_max3_u32 v66, v66, v25, v26
  v_max3_u32 v66, v66, v27, v28
  v_max3_u32 v66, v66, v29, v30
  v_max3_u32 v66, v66, v31, v32
  v_max3_u32 v66, v66, v33, v34
  v_max_u32 v66, v66, v35
  v_cmp_eq_u32 vcc, -1, v66
  s_cbranch_vccz cA_sc0_rk
  s_add_u32 s30, s30, 1
  s_cmp_lt_u32 s30, 400000
  s_cbranch_scc1 cA_sc0_rv
  s_branch cA_abort
cA_sc0_rk:
  s_mov_b32 s62, 1
  s_add_u32 s31, s31, 0x100
cA_sc0_rz:
  v_mov_b32 v36, 0
  v_mov_b32 v37, 0
  v_mov_b32 v38, 0
  v_mov_b32 v39, 0
  v_mov_b32 v40, 0
  v_mov_b32 v41, 0
  v_mov_b32 v42, 0
  v_mov_b32 v43, 0
  v_mov_b32 v44, 0
  v_mov_b32 v45, 0
  v_mov_b32 v46, 0
  v_mov_b32 v47, 0
  v_mov_b32 v48, 0
  v_mov_b32 v49, 0
  v_mov_b32 v50, 0
  v_mov_b32 v51, 0
  v_mov_b32 v60, 0
  v_mov_b32 v61, 0
  v_mov_b32 v62, 0
  v_mov_b32 v63, 0
  v_mov_b32 v68, 0
  v_mov_b32 v69, 0
  v_mov_b32 v70, 0
  v_mov_b32 v71, 0
  v_mov_b32 v72, 0
  v_mov_b32 v73, 0
  v_mov_b32 v74, 0
  v_mov_b32 v75, 0
  v_mov_b32 v52, 0
  v_mov_b32 v53, 0
  v_mov_b32 v54, 0
  v_mov_b32 v55, 0
  v_mov_b32 v56, 0
  v_mov_b32 v57, 0
  v_mov_b32 v58, 0
  v_mov_b32 v59, 0
  s_nop 1
  s_branch cA_sc0_go
.p2align 6
cA_sc1_loop:
  s_mov_b32 s30, 0
  s_mov_b32 s62, 0
  s_setprio 3
  s_barrier
  buffer_load_dwordx4 v[12:15], v2, s[8:11], s20 offen offset:1024 sc1
  s_setprio 2
  buffer_load_dwordx4 v[16:19], v2, s[8:11], s20 offen offset:2048 sc1
  s_setprio 1
  buffer_load_dwordx4 v[20:23], v2, s[8:11], s20 offen offset:3072 sc1
  s_setprio 0
  buffer_load_dwordx4 v[8:11], v2, s[8:11], s20 offen offset:0 sc1
cA_sc1_go:
  s_waitcnt vmcnt(3)
  v_smfmac_f32_16x16x64_bf16 v[36:39], v[12:15], a[8:15], v3
  buffer_load_dwordx4 v[24:27], v2, s[8:11], s23 offen offset:1024 sc1
  v_cmp_eq_u32 vcc, -1, v12
  v_smfmac_f32_16x16x64_bf16 v[40:43], v[12:15], a[64:71], v3
  v_smfmac_f32_16x16x64_bf16 v[44:47], v[12:15], a[120:127], v3
  buffer_load_dwordx4 v[32:35], v2, s[8:11], s23 offen offset:2048 sc1
  s_cbranch_vccnz cA_sc1_r0
  v_smfmac_f32_16x16x64_bf16 v[48:51], v[12:15], a[176:183], v3
  v_smfmac_f32_16x16x64_bf16 v[52:55], v[12:15], a[232:239], v3
  v_smfmac_f32_16x16x64_bf16 v[56:59], v[12:15], v[152:159], v3
  buffer_load_dwordx4 v[28:31], v2, s[8:11], s23 offen offset:0 sc1
  v_smfmac_f32_16x16x64_bf16 v[60:63], v[12:15], v[208:215], v3
  s_waitcnt vmcnt(5)
  v_smfmac_f32_16x16x64_bf16 v[36:39], v[16:19], a[16:23], v3
  v_smfmac_f32_16x16x64_bf16 v[40:43], v[16:19], a[72:79], v3
  v_smfmac_f32_16x16x64_bf16 v[44:47], v[16:19], a[128:135], v3
  v_smfmac_f32_16x16x64_bf16 v[48:51], v[16:19], a[184:191], v3
  v_smfmac_f32_16x16x64_bf16 v[52:55], v[16:19], a[240:247], v3
  v_smfmac_f32_16x16x64_bf16 v[56:59], v[16:19], v[160:167], v3
  buffer_load_dwordx4 v[88:91], v117, s[8:11], s26 offen offset:0 sc1
  v_smfmac_f32_16x16x64_bf16 v[60:63], v[16:19], v[216:223], v3
  s_waitcnt vmcnt(5)
  v_smfmac_f32_16x16x64_bf16 v[36:39], v[20:23], a[24:31], v3
  v_smfmac_f32_16x16x64_bf16 v[40:43], v[20:23], a[80:87], v3
  v_smfmac_f32_16x16x64_bf16 v[44:47], v[20:23], a[136:143], v3
  buffer_load_dwordx4 v[92:95], v117, s[8:11], s26 offen offset:1024 sc1
  v_smfmac_f32_16x16x64_bf16 v[48:51], v[20:23], a[192:199], v3
  v_smfmac_f32_16x16x64_bf16 v[52:55], v[20:23], a[248:255], v3
  v_smfmac_f32_16x16x64_bf16 v[56:59], v[20:23], v[168:175], v3
  v_smfmac_f32_16x16x64_bf16 v[60:63], v[20:23], v[224:231], v3
  s_waitcnt vmcnt(5)
  buffer_load_dwordx4 v[96:99], v2, s[8:11], s24 offen offset:0 sc1
  v_smfmac_f32_16x16x64_bf16 v[36:39], v[8:11], a[0:7], v3
  v_smfmac_f32_16x16x64_bf16 v[40:43], v[8:11], a[56:63], v3
  v_max3_u32 v66, v16, v20, v8
  v_smfmac_f32_16x16x64_bf16 v[44:47], v[8:11], a[112:119], v3
  v_smfmac_f32_16x16x64_bf16 v[48:51], v[8:11], a[168:175], v3
  buffer_load_dwordx4 v[100:103], v2, s[8:11], s24 offen offset:1024 sc1
  v_smfmac_f32_16x16x64_bf16 v[52:55], v[8:11], a[224:231], v3
  v_smfmac_f32_16x16x64_bf16 v[56:59], v[8:11], v[144:151], v3
  v_smfmac_f32_16x16x64_bf16 v[60:63], v[8:11], v[200:207], v3
  s_waitcnt vmcnt(4)
  v_smfmac_f32_16x16x64_bf16 v[60:63], v[28:31], v[232:239], v3
  buffer_load_dwordx4 v[104:107], v2, s[8:11], s26 offen offset:0 sc1
  v_max3_u32 v66, v66, v24, v27
  v_smfmac_f32_16x16x64_bf16 v[60:63], v[24:27], v[240:247], v3
  v_max3_u32 v66, v66, v28, v31
  v_smfmac_f32_16x16x64_bf16 v[60:63], v[32:35], v[248:255], v3
  v_max3_u32 v66, v66, v32, v35
  v_smfmac_f32_16x16x64_bf16 v[52:55], v[28:31], v[120:127], v3
  v_cmp_eq_u32 vcc, -1, v66
  v_smfmac_f32_16x16x64_bf16 v[52:55], v[24:27], v[128:135], v3
  buffer_load_dwordx4 v[108:111], v2, s[8:11], s26 offen offset:1024 sc1
  v_smfmac_f32_16x16x64_bf16 v[52:55], v[32:35], v[136:143], v3
  s_cbranch_vccnz cA_sc1_r4
  v_cvt_pk_bf16_f32 v63, v62, v63
  v_smfmac_f32_16x16x64_bf16 v[56:59], v[28:31], v[176:183], v3
  v_cvt_pk_bf16_f32 v62, v60, v61
  v_smfmac_f32_16x16x64_bf16 v[56:59], v[24:27], v[184:191], v3
  v_mfma_f32_16x16x32_bf16 v[8:11], v[62:65], v[4:7], 0
  v_cvt_pk_bf16_f32 v55, v54, v55
  v_smfmac_f32_16x16x64_bf16 v[56:59], v[32:35], v[192:199], v3
  v_cvt_pk_bf16_f32 v54, v52, v53
  v_smfmac_f32_16x16x64_bf16 v[36:39], v[28:31], a[32:39], v3
  s_nop 1
  v_cvt_pk_bf16_f32 v78, v8, v9
  v_smfmac_f32_16x16x64_bf16 v[36:39], v[24:27], a[40:47], v3
  v_cvt_pk_bf16_f32 v79, v10, v11
  v_smfmac_f32_16x16x64_bf16 v[36:39], v[32:35], a[48:55], v3
  v_cvt_pk_bf16_f32 v56, v56, v57
  v_smfmac_f32_16x16x64_bf16 v[40:43], v[28:31], a[88:95], v3
  v_cvt_pk_bf16_f32 v57, v58, v59
  v_smfmac_f32_16x16x64_bf16 v[40:43], v[24:27], a[96:103], v3
  v_mfma_f32_16x16x32_bf16 v[16:19], v[54:57], v[4:7], 0
  v_cvt_pk_bf16_f32 v39, v38, v39
  v_smfmac_f32_16x16x64_bf16 v[40:43], v[32:35], a[104:111], v3
  v_cvt_pk_bf16_f32 v38, v36, v37
  v_smfmac_f32_16x16x64_bf16 v[44:47], v[28:31], a[144:151], v3
  s_nop 1
  v_cvt_pk_bf16_f32 v76, v16, v17
  v_smfmac_f32_16x16x64_bf16 v[44:47], v[24:27], a[152:159], v3
  v_cvt_pk_bf16_f32 v77, v18, v19
  v_smfmac_f32_16x16x64_bf16 v[44:47], v[32:35], a[160:167], v3
  v_cvt_pk_bf16_f32 v40, v40, v41
  v_smfmac_f32_16x16x64_bf16 v[48:51], v[28:31], a[200:207], v3
  v_cvt_pk_bf16_f32 v41, v42, v43
  v_smfmac_f32_16x16x64_bf16 v[48:51], v[24:27], a[208:215], v3
  v_smfmac_f32_16x16x64_bf16 v[48:51], v[32:35], a[216:223], v3
  s_waitcnt vmcnt(4)
  v_cvt_pk_bf16_f32 v47, v46, v47
  v_smfmac_f32_16x16x64_bf16 v[68:71], v[76:79], v[80:87], v3
  v_cvt_pk_bf16_f32 v46, v44, v45
  v_mfma_f32_16x16x32_bf16 v[8:11], v[38:41], v[4:7], 0
  s_nop 1
  v_cvt_pk_bf16_f32 v48, v48, v49
  v_cvt_pk_bf16_f32 v49, v50, v51
  s_nop 1
  v_mfma_f32_16x16x32_bf16 v[16:19], v[46:49], v[4:7], 0
  v_smfmac_f32_16x16x64_bf16 v[72:75], v[76:79], v[88:95], v3
  v_cvt_pk_bf16_f32 v20, v8, v9
  v_mfma_f32_16x16x32_bf16 v[52:55], v[30:33], v[76:79], 0
  s_waitcnt vmcnt(0)
  v_cvt_pk_bf16_f32 v21, v10, v11
  v_cvt_pk_bf16_f32 v22, v16, v17
  v_cvt_pk_bf16_f32 v23, v18, v19
  s_nop 1
  v_mfma_f32_16x16x32_bf16 v[52:55], v[12:15], v[20:23], v[52:55]
  v_smfmac_f32_16x16x64_bf16 v[68:71], v[20:23], v[96:103], v3
  v_smfmac_f32_16x16x64_bf16 v[72:75], v[20:23], v[104:111], v3
  s_nop 1
  ds_write_b128 v113, v[52:55]
  s_nop 1
  v_permlane32_swap_b32 v68, v70
  v_permlane32_swap_b32 v69, v71
  v_add_f32 v56, v68, v70
  v_add_f32 v58, v69, v71
  v_permlane32_swap_b32 v72, v74
  v_permlane32_swap_b32 v73, v75
  v_add_f32 v57, v72, v74
  v_add_f32 v59, v73, v75
  ds_write_b128 v2, v[56:59] offset:1024
  v_cmp_u_f32 vcc, v57, v59
  v_mov_b32 v68, 0
  v_mov_b32 v69, 0
  v_mov_b32 v70, 0
  v_mov_b32 v71, 0
  s_cbranch_vccnz cA_sc1_retry
cA_sc1_cont:
  s_add_u32 s24, s24, 28672
  s_add_u32 s26, s26, 28672
  buffer_load_dwordx4 v[80:83], v117, s[8:11], s24 offen offset:0 sc1
  buffer_load_dwordx4 v[84:87], v117, s[8:11], s24 offen offset:1024 sc1
  v_mfma_f32_32x32x16_bf16 v[36:51], v[68:71], v[68:71], 0
  s_waitcnt lgkmcnt(0)
  s_barrier
  ds_read_b64 v[8:9], v114 offset:0
  ds_read_b64 v[10:11], v114 offset:1024
  ds_read_b64 v[12:13], v114 offset:2048
  ds_read_b64 v[14:15], v114 offset:3072
  ds_read2_b32 v[16:17], v115 offset0:0 offset1:64
  ds_read2_b32 v[18:19], v115 offset0:128 offset1:192
  v_mfma_f32_32x32x16_bf16 v[52:67], v[68:71], v[68:71], 0
  s_waitcnt lgkmcnt(0)
  v_pk_add_f32 v[16:17], v[16:17], v[18:19]
  v_pk_add_f32 v[8:9], v[8:9], v[10:11]
  v_pk_add_f32 v[12:13], v[12:13], v[14:15]
  v_add_f32 v20, v16, v17
  v_pk_add_f32 v[8:9], v[8:9], v[12:13]
  v_max_f32 v22, v8, v9
  v_add_f32_dpp v20, v20, v20 row_ror:8 row_mask:0xf bank_mask:0xf
  s_nop 0
  v_max_f32_dpp v22, v22, v22 row_ror:8 row_mask:0xf bank_mask:0xf
  v_max_f32 v22, v22, v20
  s_nop 1
  v_max_f32_dpp v22, v22, v22 quad_perm:[1,0,3,2] row_mask:0xf bank_mask:0xf
  s_nop 1
  v_max_f32_dpp v22, v22, v22 quad_perm:[2,3,0,1] row_mask:0xf bank_mask:0xf
  buffer_store_dword v112, v116, s[8:11], 0 offen
  s_nop 0
  v_max_f32_dpp v22, v22, v22 row_half_mirror row_mask:0xf bank_mask:0xf
  v_pk_add_f32 v[8:9], v[8:9], v[22:23] op_sel_hi:[1,0] neg_lo:[0,1] neg_hi:[0,1]
  v_sub_f32 v20, v20, v22
  v_exp_f32 v8, v8
  v_exp_f32 v9, v9
  v_exp_f32 v20, v20
  v_add_f32 v24, v8, v9
  v_fmac_f32 v24, 0.5, v20
  v_mov_b32_dpp v21, v20 quad_perm:[1,0,3,2] row_mask:0xf bank_mask:0xf
  s_nop 0
  v_add_f32_dpp v24, v24, v24 quad_perm:[1,0,3,2] row_mask:0xf bank_mask:0xf
  s_nop 1
  v_add_f32_dpp v24, v24, v24 quad_perm:[2,3,0,1] row_mask:0xf bank_mask:0xf
  s_nop 1
  v_add_f32_dpp v24, v24, v24 row_half_mirror row_mask:0xf bank_mask:0xf
  s_nop 1
  v_add_f32_dpp v24, v24, v24 row_ror:8 row_mask:0xf bank_mask:0xf
  v_rcp_f32 v24, v24
  s_nop 0
  v_pk_mul_f32 v[8:9], v[8:9], v[24:25] op_sel_hi:[1,0]
  v_cvt_pk_bf16_f32 v8, abs(v8), abs(v9)
  buffer_store_dword v8, v1, s[8:11], s20 offen
  v_pk_mul_f32 v[20:21], v[20:21], v[24:25] op_sel_hi:[1,0]
  v_cvt_pk_bf16_f32 v20, abs(v20), abs(v21)
  buffer_store_dword v20, v118, s[8:11], s20 offen
  v_mov_b32 v72, 0
  v_mov_b32 v73, 0
  v_mov_b32 v74, 0
  v_mov_b32 v75, 0
  s_buffer_load_dword s64, s[8:11], s34 offset:896
  s_buffer_load_dword s65, s[8:11], s34 offset:960
  s_buffer_load_dword s66, s[8:11], s34 offset:1024
  s_buffer_load_dword s67, s[8:11], s34 offset:1088
  s_buffer_load_dword s64, s[8:11], s34 offset:1152
  s_buffer_load_dword s65, s[8:11], s34 offset:1216
  s_buffer_load_dword s66, s[8:11], s34 offset:1280
  s_buffer_load_dword s67, s[8:11], s34 offset:1344
  s_buffer_load_dword s64, s[8:11], s34 offset:1408
  s_buffer_load_dword s65, s[8:11], s34 offset:1472
  s_buffer_load_dword s66, s[8:11], s34 offset:1536
  s_buffer_load_dword s67, s[8:11], s34 offset:1600
  s_buffer_load_dword s64, s[8:11], s34 offset:1664
  s_buffer_load_dword s65, s[8:11], s34 offset:1728
  s_mov_b32 s36, s34
  s_add_u32 s34, s33, 458752
  s_mov_b32 s33, s34
  s_mov_b32 s19, s18
  s_add_u32 s18, s18, 1
  s_mov_b32 s22, s20
  s_mov_b32 s20, s21
  s_mov_b32 s21, s22
  s_add_u32 s23, s20, 4096
  v_mov_b32 v112, s18
  s_cmp_lt_u32 s19, 63
  s_nop 0
  s_cbranch_scc1 cA_sc1_loop
  s_branch cA_done
cA_sc1_r0:
  s_add_u32 s31, s31, 1
  buffer_load_dwordx4 v[12:15], v2, s[8:11], s20 offen offset:1024 sc1
  s_waitcnt vmcnt(0)
  v_cmp_eq_u32 vcc, -1, v12
  v_mov_b32 v36, 0
  v_mov_b32 v37, 0
  v_mov_b32 v38, 0
  v_mov_b32 v39, 0
  v_mov_b32 v40, 0
  v_mov_b32 v41, 0
  v_mov_b32 v42, 0
  v_mov_b32 v43, 0
  v_mov_b32 v44, 0
  v_mov_b32 v45, 0
  v_mov_b32 v46, 0
  v_mov_b32 v47, 0
  v_mov_b32 v48, 0
  v_mov_b32 v49, 0
  v_mov_b32 v50, 0
  v_mov_b32 v51, 0
  s_nop 1
  s_cbranch_vccz cA_sc1_go
  s_add_u32 s30, s30, 1
  s_cmp_lt_u32 s30, 400000
  s_cbranch_scc1 cA_sc1_r0
  s_branch cA_abort
cA_sc1_r4:
  s_add_u32 s31, s31, 1
  buffer_load_dwordx4 v[16:19], v2, s[8:11], s20 offen offset:2048 sc1
  buffer_load_dwordx4 v[20:23], v2, s[8:11], s20 offen offset:3072 sc1
  buffer_load_dwordx4 v[8:11], v2, s[8:11], s20 offen offset:0 sc1
  buffer_load_dwordx4 v[28:31], v2, s[8:11], s23 offen offset:0 sc1
  buffer_load_dwordx4 v[24:27], v2, s[8:11], s23 offen offset:1024 sc1
  buffer_load_dwordx4 v[32:35], v2, s[8:11], s23 offen offset:2048 sc1
  s_waitcnt vmcnt(0)
  v_max3_u32 v66, v16, v20, v8
  v_max3_u32 v66, v66, v24, v27
  v_max3_u32 v66, v66, v28, v31
  v_max3_u32 v66, v66, v32, v35
  v_cmp_eq_u32 vcc, -1, v66
  s_nop 4
  s_cbranch_vccz cA_sc1_rz
  s_add_u32 s30, s30, 1
  s_cmp_lt_u32 s30, 400000
  s_cbranch_scc1 cA_sc1_r4
  s_branch cA_abort
cA_sc1_retry:
  s_cmp_lg_u32 s62, 0
  s_cbranch_scc1 cA_sc1_cont
  s_waitcnt vmcnt(0) lgkmcnt(0)
cA_sc1_rv:
  buffer_load_dwordx4 v[8:11], v2, s[8:11], s20 offen offset:0 sc1
  buffer_load_dwordx4 v[12:15], v2, s[8:11], s20 offen offset:1024 sc1
  buffer_load_dwordx4 v[16:19], v2, s[8:11], s20 offen offset:2048 sc1
  buffer_load_dwordx4 v[20:23], v2, s[8:11], s20 offen offset:3072 sc1
  buffer_load_dwordx4 v[28:31], v2, s[8:11], s23 offen offset:0 sc1
  buffer_load_dwordx4 v[24:27], v2, s[8:11], s23 offen offset:1024 sc1
  buffer_load_dwordx4 v[32:35], v2, s[8:11], s23 offen offset:2048 sc1
  s_waitcnt vmcnt(0)
  v_max3_u32 v66, v8, v9, v10
  v_max3_u32 v66, v66, v11, v12
  v_max3_u32 v66, v66, v13, v14
  v_max3_u32 v66, v66, v15, v16
  v_max3_u32 v66, v66, v17, v18
  v_max3_u32 v66, v66, v19, v20
  v_max3_u32 v66, v66, v21, v22
  v_max3_u32 v66, v66, v23, v24
  v_max3_u32 v66, v66, v25, v26
  v_max3_u32 v66, v66, v27, v28
  v_max3_u32 v66, v66, v29, v30
  v_max3_u32 v66, v66, v31, v32
  v_max3_u32 v66, v66, v33, v34
  v_max_u32 v66, v66, v35
  v_cmp_eq_u32 vcc, -1, v66
  s_cbranch_vccz cA_sc1_rk
  s_add_u32 s30, s30, 1
  s_cmp_lt_u32 s30, 400000
  s_cbranch_scc1 cA_sc1_rv
  s_branch cA_abort
cA_sc1_rk:
  s_mov_b32 s62, 1
  s_add_u32 s31, s31, 0x100
cA_sc1_rz:
  v_mov_b32 v36, 0
  v_mov_b32 v37, 0
  v_mov_b32 v38, 0
  v_mov_b32 v39, 0
  v_mov_b32 v40, 0
  v_mov_b32 v41, 0
  v_mov_b32 v42, 0
  v_mov_b32 v43, 0
  v_mov_b32 v44, 0
  v_mov_b32 v45, 0
  v_mov_b32 v46, 0
  v_mov_b32 v47, 0
  v_mov_b32 v48, 0
  v_mov_b32 v49, 0
  v_mov_b32 v50, 0
  v_mov_b32 v51, 0
  v_mov_b32 v60, 0
  v_mov_b32 v61, 0
  v_mov_b32 v62, 0
  v_mov_b32 v63, 0
  v_mov_b32 v68, 0
  v_mov_b32 v69, 0
  v_mov_b32 v70, 0
  v_mov_b32 v71, 0
  v_mov_b32 v72, 0
  v_mov_b32 v73, 0
  v_mov_b32 v74, 0
  v_mov_b32 v75, 0
  v_mov_b32 v52, 0
  v_mov_b32 v53, 0
  v_mov_b32 v54, 0
  v_mov_b32 v55, 0
  v_mov_b32 v56, 0
  v_mov_b32 v57, 0
  v_mov_b32 v58, 0
  v_mov_b32 v59, 0
  s_nop 1
  s_branch cA_sc1_go
.p2align 6
cA_sc2_loop:
  s_mov_b32 s30, 0
  s_mov_b32 s62, 0
  s_setprio 3
  s_barrier
  buffer_load_dwordx4 v[16:19], v2, s[8:11], s20 offen offset:2048 sc1
  s_setprio 2
  buffer_load_dwordx4 v[20:23], v2, s[8:11], s20 offen offset:3072 sc1
  s_setprio 1
  buffer_load_dwordx4 v[8:11], v2, s[8:11], s20 offen offset:0 sc1
  s_setprio 0
  buffer_load_dwordx4 v[12:15], v2, s[8:11], s20 offen offset:1024 sc1
cA_sc2_go:
  s_waitcnt vmcnt(3)
  v_smfmac_f32_16x16x64_bf16 v[36:39], v[16:19], a[16:23], v3
  buffer_load_dwordx4 v[28:31], v2, s[8:11], s23 offen offset:2048 sc1
  v_cmp_eq_u32 vcc, -1, v16
  v_smfmac_f32_16x16x64_bf16 v[40:43], v[16:19], a[72:79], v3
  v_smfmac_f32_16x16x64_bf16 v[44:47], v[16:19], a[128:135], v3
  buffer_load_dwordx4 v[24:27], v2, s[8:11], s23 offen offset:0 sc1
  s_cbranch_vccnz cA_sc2_r0
  v_smfmac_f32_16x16x64_bf16 v[48:51], v[16:19], a[184:191], v3
  v_smfmac_f32_16x16x64_bf16 v[52:55], v[16:19], a[240:247], v3
  v_smfmac_f32_16x16x64_bf16 v[56:59], v[16:19], v[160:167], v3
  buffer_load_dwordx4 v[32:35], v2, s[8:11], s23 offen offset:1024 sc1
  v_smfmac_f32_16x16x64_bf16 v[62:65], v[16:19], v[216:223], v3
  s_waitcnt vmcnt(5)
  v_smfmac_f32_16x16x64_bf16 v[36:39], v[20:23], a[24:31], v3
  v_smfmac_f32_16x16x64_bf16 v[40:43], v[20:23], a[80:87], v3
  v_smfmac_f32_16x16x64_bf16 v[44:47], v[20:23], a[136:143], v3
  v_smfmac_f32_16x16x64_bf16 v[48:51], v[20:23], a[192:199], v3
  v_smfmac_f32_16x16x64_bf16 v[52:55], v[20:23], a[248:255], v3
  v_smfmac_f32_16x16x64_bf16 v[56:59], v[20:23], v[168:175], v3
  buffer_load_dwordx4 v[88:91], v117, s[8:11], s26 offen offset:0 sc1
  v_smfmac_f32_16x16x64_bf16 v[62:65], v[20:23], v[224:231], v3
  s_waitcnt vmcnt(5)
  v_smfmac_f32_16x16x64_bf16 v[36:39], v[8:11], a[0:7], v3
  v_smfmac_f32_16x16x64_bf16 v[40:43], v[8:11], a[56:63], v3
  v_smfmac_f32_16x16x64_bf16 v[44:47], v[8:11], a[112:119], v3
  buffer_load_dwordx4 v[92:95], v117, s[8:11], s26 offen offset:1024 sc1
  v_smfmac_f32_16x16x64_bf16 v[48:51], v[8:11], a[168:175], v3
  v_smfmac_f32_16x16x64_bf16 v[52:55], v[8:11], a[224:231], v3
  v_smfmac_f32_16x16x64_bf16 v[56:59], v[8:11], v[144:151], v3
  v_smfmac_f32_16x16x64_bf16 v[62:65], v[8:11], v[200:207], v3
  s_waitcnt vmcnt(5)
  buffer_load_dwordx4 v[96:99], v2, s[8:11], s24 offen offset:0 sc1
  v_smfmac_f32_16x16x64_bf16 v[36:39], v[12:15], a[8:15], v3
  v_smfmac_f32_16x16x64_bf16 v[40:43], v[12:15], a[64:71], v3
  v_max3_u32 v66, v20, v8, v12
  v_smfmac_f32_16x16x64_bf16 v[44:47], v[12:15], a[120:127], v3
  v_smfmac_f32_16x16x64_bf16 v[48:51], v[12:15], a[176:183], v3
  buffer_load_dwordx4 v[100:103], v2, s[8:11], s24 offen offset:1024 sc1
  v_smfmac_f32_16x16x64_bf16 v[52:55], v[12:15], a[232:239], v3
  v_smfmac_f32_16x16x64_bf16 v[56:59], v[12:15], v[152:159], v3
  v_smfmac_f32_16x16x64_bf16 v[62:65], v[12:15], v[208:215], v3
  s_waitcnt vmcnt(4)
  v_smfmac_f32_16x16x64_bf16 v[62:65], v[24:27], v[232:239], v3
  buffer_load_dwordx4 v[104:107], v2, s[8:11], s26 offen offset:0 sc1
  v_max3_u32 v66, v66, v24, v27
  v_smfmac_f32_16x16x64_bf16 v[62:65], v[32:35], v[240:247], v3
  v_max3_u32 v66, v66, v28, v31
  v_smfmac_f32_16x16x64_bf16 v[62:65], v[28:31], v[248:255], v3
  v_max3_u32 v66, v66, v32, v35
  v_smfmac_f32_16x16x64_bf16 v[52:55], v[24:27], v[120:127], v3
  v_cmp_eq_u32 vcc, -1, v66
  v_smfmac_f32_16x16x64_bf16 v[52:55], v[32:35], v[128:135], v3
  buffer_load_dwordx4 v[108:111], v2, s[8:11], s26 offen offset:1024 sc1
  v_smfmac_f32_16x16x64_bf16 v[52:55], v[28:31], v[136:143], v3
  s_cbranch_vccnz cA_sc2_r4
  v_cvt_pk_bf16_f32 v62, v62, v63
  v_smfmac_f32_16x16x64_bf16 v[56:59], v[24:27], v[176:183], v3
  v_cvt_pk_bf16_f32 v63, v64, v65
  v_smfmac_f32_16x16x64_bf16 v[56:59], v[32:35], v[184:191], v3
  v_mfma_f32_16x16x32_bf16 v[8:11], v[60:63], v[4:7], 0
  v_cvt_pk_bf16_f32 v55, v54, v55
  v_smfmac_f32_16x16x64_bf16 v[56:59], v[28:31], v[192:199], v3
  v_cvt_pk_bf16_f32 v54, v52, v53
  v_smfmac_f32_16x16x64_bf16 v[36:39], v[24:27], a[32:39], v3
  s_nop 1
  v_cvt_pk_bf16_f32 v76, v8, v9
  v_smfmac_f32_16x16x64_bf16 v[36:39], v[32:35], a[40:47], v3
  v_cvt_pk_bf16_f32 v77, v10, v11
  v_smfmac_f32_16x16x64_bf16 v[36:39], v[28:31], a[48:55], v3
  v_cvt_pk_bf16_f32 v56, v56, v57
  v_smfmac_f32_16x16x64_bf16 v[40:43], v[24:27], a[88:95], v3
  v_cvt_pk_bf16_f32 v57, v58, v59
  v_smfmac_f32_16x16x64_bf16 v[40:43], v[32:35], a[96:103], v3
  v_mfma_f32_16x16x32_bf16 v[12:15], v[54:57], v[4:7], 0
  v_cvt_pk_bf16_f32 v39, v38, v39
  v_smfmac_f32_16x16x64_bf16 v[40:43], v[28:31], a[104:111], v3
  v_cvt_pk_bf16_f32 v38, v36, v37
  v_smfmac_f32_16x16x64_bf16 v[44:47], v[24:27], a[144:151], v3
  s_nop 1
  v_cvt_pk_bf16_f32 v78, v12, v13
  v_smfmac_f32_16x16x64_bf16 v[44:47], v[32:35], a[152:159], v3
  v_cvt_pk_bf16_f32 v79, v14, v15
  v_smfmac_f32_16x16x64_bf16 v[44:47], v[28:31], a[160:167], v3
  v_cvt_pk_bf16_f32 v40, v40, v41
  v_smfmac_f32_16x16x64_bf16 v[48:51], v[24:27], a[200:207], v3
  v_cvt_pk_bf16_f32 v41, v42, v43
  v_smfmac_f32_16x16x64_bf16 v[48:51], v[32:35], a[208:215], v3
  v_smfmac_f32_16x16x64_bf16 v[48:51], v[28:31], a[216:223], v3
  s_waitcnt vmcnt(4)
  v_cvt_pk_bf16_f32 v47, v46, v47
  v_smfmac_f32_16x16x64_bf16 v[68:71], v[76:79], v[80:87], v3
  v_cvt_pk_bf16_f32 v46, v44, v45
  v_mfma_f32_16x16x32_bf16 v[8:11], v[38:41], v[4:7], 0
  s_nop 1
  v_cvt_pk_bf16_f32 v48, v48, v49
  v_cvt_pk_bf16_f32 v49, v50, v51
  s_nop 1
  v_mfma_f32_16x16x32_bf16 v[12:15], v[46:49], v[4:7], 0
  v_smfmac_f32_16x16x64_bf16 v[72:75], v[76:79], v[88:95], v3
  v_cvt_pk_bf16_f32 v20, v8, v9
  v_mfma_f32_16x16x32_bf16 v[52:55], v[30:33], v[76:79], 0
  s_waitcnt vmcnt(0)
  v_cvt_pk_bf16_f32 v21, v10, v11
  v_cvt_pk_bf16_f32 v22, v12, v13
  v_cvt_pk_bf16_f32 v23, v14, v15
  s_nop 1
  v_mfma_f32_16x16x32_bf16 v[52:55], v[16:19], v[20:23], v[52:55]
  v_smfmac_f32_16x16x64_bf16 v[68:71], v[20:23], v[96:103], v3
  v_smfmac_f32_16x16x64_bf16 v[72:75], v[20:23], v[104:111], v3
  s_nop 1
  ds_write_b128 v113, v[52:55]
  s_nop 1
  v_permlane32_swap_b32 v68, v70
  v_permlane32_swap_b32 v69, v71
  v_add_f32 v56, v68, v70
  v_add_f32 v58, v69, v71
  v_permlane32_swap_b32 v72, v74
  v_permlane32_swap_b32 v73, v75
  v_add_f32 v57, v72, v74
  v_add_f32 v59, v73, v75
  ds_write_b128 v2, v[56:59] offset:2048
  v_cmp_u_f32 vcc, v57, v59
  v_mov_b32 v68, 0
  v_mov_b32 v69, 0
  v_mov_b32 v70, 0
  v_mov_b32 v71, 0
  s_cbranch_vccnz cA_sc2_retry
cA_sc2_cont:
  s_add_u32 s24, s24, 28672
  s_add_u32 s26, s26, 28672
  buffer_load_dwordx4 v[80:83], v117, s[8:11], s24 offen offset:0 sc1
  buffer_load_dwordx4 v[84:87], v117, s[8:11], s24 offen offset:1024 sc1
  v_mfma_f32_32x32x16_bf16 v[36:51], v[68:71], v[68:71], 0
  s_waitcnt lgkmcnt(0)
  s_barrier
  v_mfma_f32_32x32x16_bf16 v[52:67], v[68:71], v[68:71], 0
  buffer_store_dwordx2 v[118:119], v114, s[8:11], s21 offen
  buffer_store_dwordx2 v[118:119], v115, s[8:11], s21 offen
  s_buffer_load_dword s70, s[8:11], s35
  s_add_u32 s22, s24, 114688
  s_buffer_load_dword s71, s[8:11], s22
  s_mul_i32 s22, s18, 7168
  s_add_u32 s22, s22, 87040
  s_buffer_load_dword s72, s[8:11], s22
  s_add_u32 s35, s35, 458752
  v_mov_b32 v72, 0
  v_mov_b32 v73, 0
  v_mov_b32 v74, 0
  v_mov_b32 v75, 0
  s_buffer_load_dword s64, s[8:11], s34 offset:1792
  s_buffer_load_dword s65, s[8:11], s34 offset:1856
  s_buffer_load_dword s66, s[8:11], s34 offset:1920
  s_buffer_load_dword s67, s[8:11], s34 offset:1984
  s_buffer_load_dword s64, s[8:11], s34 offset:2048
  s_buffer_load_dword s65, s[8:11], s34 offset:2112
  s_buffer_load_dword s66, s[8:11], s34 offset:2176
  s_buffer_load_dword s67, s[8:11], s34 offset:2240
  s_buffer_load_dword s64, s[8:11], s34 offset:2304
  s_buffer_load_dword s65, s[8:11], s34 offset:2368
  s_buffer_load_dword s66, s[8:11], s34 offset:2432
  s_buffer_load_dword s67, s[8:11], s34 offset:2496
  s_buffer_load_dword s64, s[8:11], s34 offset:2560
  s_buffer_load_dword s65, s[8:11], s34 offset:2624
  s_mov_b32 s36, s34
  s_add_u32 s34, s33, 458752
  s_mov_b32 s33, s34
  s_mov_b32 s19, s18
  s_add_u32 s18, s18, 1
  s_mov_b32 s22, s20
  s_mov_b32 s20, s21
  s_mov_b32 s21, s22
  s_add_u32 s23, s20, 4096
  s_cmp_lt_u32 s19, 63
  s_cbranch_scc1 cA_sc2_loop
  s_branch cA_done
cA_sc2_r0:
  s_add_u32 s31, s31, 1
  buffer_load_dwordx4 v[16:19], v2, s[8:11], s20 offen offset:2048 sc1
  s_waitcnt vmcnt(0)
  v_cmp_eq_u32 vcc, -1, v16
  v_mov_b32 v36, 0
  v_mov_b32 v37, 0
  v_mov_b32 v38, 0
  v_mov_b32 v39, 0
  v_mov_b32 v40, 0
  v_mov_b32 v41, 0
  v_mov_b32 v42, 0
  v_mov_b32 v43, 0
  v_mov_b32 v44, 0
  v_mov_b32 v45, 0
  v_mov_b32 v46, 0
  v_mov_b32 v47, 0
  v_mov_b32 v48, 0
  v_mov_b32 v49, 0
  v_mov_b32 v50, 0
  v_mov_b32 v51, 0
  s_nop 1
  s_cbranch_vccz cA_sc2_go
  s_add_u32 s30, s30, 1
  s_cmp_lt_u32 s30, 400000
  s_cbranch_scc1 cA_sc2_r0
  s_branch cA_abort
cA_sc2_r4:
  s_add_u32 s31, s31, 1
  buffer_load_dwordx4 v[20:23], v2, s[8:11], s20 offen offset:3072 sc1
  buffer_load_dwordx4 v[8:11], v2, s[8:11], s20 offen offset:0 sc1
  buffer_load_dwordx4 v[12:15], v2, s[8:11], s20 offen offset:1024 sc1
  buffer_load_dwordx4 v[24:27], v2, s[8:11], s23 offen offset:0 sc1
  buffer_load_dwordx4 v[32:35], v2, s[8:11], s23 offen offset:1024 sc1
  buffer_load_dwordx4 v[28:31], v2, s[8:11], s23 offen offset:2048 sc1
  s_waitcnt vmcnt(0)
  v_max3_u32 v66, v20, v8, v12
  v_max3_u32 v66, v66, v24, v27
  v_max3_u32 v66, v66, v28, v31
  v_max3_u32 v66, v66, v32, v35
  v_cmp_eq_u32 vcc, -1, v66
  s_nop 4
  s_cbranch_vccz cA_sc2_rz
  s_add_u32 s30, s30, 1
  s_cmp_lt_u32 s30, 400000
  s_cbranch_scc1 cA_sc2_r4
  s_branch cA_abort
cA_sc2_retry:
  s_cmp_lg_u32 s62, 0
  s_cbranch_scc1 cA_sc2_cont
  s_waitcnt vmcnt(0) lgkmcnt(0)
cA_sc2_rv:
  buffer_load_dwordx4 v[8:11], v2, s[8:11], s20 offen offset:0 sc1
  buffer_load_dwordx4 v[12:15], v2, s[8:11], s20 offen offset:1024 sc1
  buffer_load_dwordx4 v[16:19], v2, s[8:11], s20 offen offset:2048 sc1
  buffer_load_dwordx4 v[20:23], v2, s[8:11], s20 offen offset:3072 sc1
  buffer_load_dwordx4 v[24:27], v2, s[8:11], s23 offen offset:0 sc1
  buffer_load_dwordx4 v[32:35], v2, s[8:11], s23 offen offset:1024 sc1
  buffer_load_dwordx4 v[28:31], v2, s[8:11], s23 offen offset:2048 sc1
  s_waitcnt vmcnt(0)
  v_max3_u32 v66, v8, v9, v10
  v_max3_u32 v66, v66, v11, v12
  v_max3_u32 v66, v66, v13, v14
  v_max3_u32 v66, v66, v15, v16
  v_max3_u32 v66, v66, v17, v18
  v_max3_u32 v66, v66, v19, v20
  v_max3_u32 v66, v66, v21, v22
  v_max3_u32 v66, v66, v23, v24
  v_max3_u32 v66, v66, v25, v26
  v_max3_u32 v66, v66, v27, v28
  v_max3_u32 v66, v66, v29, v30
  v_max3_u32 v66, v66, v31, v32
  v_max3_u32 v66, v66, v33, v34
  v_max_u32 v66, v66, v35
  v_cmp_eq_u32 vcc, -1, v66
  s_cbranch_vccz cA_sc2_rk
  s_add_u32 s30, s30, 1
  s_cmp_lt_u32 s30, 400000
  s_cbranch_scc1 cA_sc2_rv
  s_branch cA_abort
cA_sc2_rk:
  s_mov_b32 s62, 1
  s_add_u32 s31, s31, 0x100
cA_sc2_rz:
  v_mov_b32 v36, 0
  v_mov_b32 v37, 0
  v_mov_b32 v38, 0
  v_mov_b32 v39, 0
  v_mov_b32 v40, 0
  v_mov_b32 v41, 0
  v_mov_b32 v42, 0
  v_mov_b32 v43, 0
  v_mov_b32 v44, 0
  v_mov_b32 v45, 0
  v_mov_b32 v46, 0
  v_mov_b32 v47, 0
  v_mov_b32 v48, 0
  v_mov_b32 v49, 0
  v_mov_b32 v50, 0
  v_mov_b32 v51, 0
  v_mov_b32 v62, 0
  v_mov_b32 v63, 0
  v_mov_b32 v64, 0
  v_mov_b32 v65, 0
  v_mov_b32 v68, 0
  v_mov_b32 v69, 0
  v_mov_b32 v70, 0
  v_mov_b32 v71, 0
  v_mov_b32 v72, 0
  v_mov_b32 v73, 0
  v_mov_b32 v74, 0
  v_mov_b32 v75, 0
  v_mov_b32 v52, 0
  v_mov_b32 v53, 0
  v_mov_b32 v54, 0
  v_mov_b32 v55, 0
  v_mov_b32 v56, 0
  v_mov_b32 v57, 0
  v_mov_b32 v58, 0
  v_mov_b32 v59, 0
  s_nop 1
  s_branch cA_sc2_go
.p2align 6
cA_sc3_loop:
  s_mov_b32 s30, 0
  s_mov_b32 s62, 0
  s_setprio 3
  s_barrier
  buffer_load_dwordx4 v[20:23], v2, s[8:11], s20 offen offset:3072 sc1
  s_setprio 2
  buffer_load_dwordx4 v[8:11], v2, s[8:11], s20 offen offset:0 sc1
  s_setprio 1
  buffer_load_dwordx4 v[12:15], v2, s[8:11], s20 offen offset:1024 sc1
  s_setprio 0
  buffer_load_dwordx4 v[16:19], v2, s[8:11], s20 offen offset:2048 sc1
cA_sc3_go:
  s_waitcnt vmcnt(3)
  v_smfmac_f32_16x16x64_bf16 v[36:39], v[20:23], a[24:31], v3
  buffer_load_dwordx4 v[24:27], v2, s[8:11], s23 offen offset:0 sc1
  v_cmp_eq_u32 vcc, -1, v20
  v_smfmac_f32_16x16x64_bf16 v[40:43], v[20:23], a[80:87], v3
  v_smfmac_f32_16x16x64_bf16 v[44:47], v[20:23], a[136:143], v3
  buffer_load_dwordx4 v[28:31], v2, s[8:11], s23 offen offset:1024 sc1
  s_cbranch_vccnz cA_sc3_r0
  v_smfmac_f32_16x16x64_bf16 v[48:51], v[20:23], a[192:199], v3
  v_smfmac_f32_16x16x64_bf16 v[52:55], v[20:23], a[248:255], v3
  v_smfmac_f32_16x16x64_bf16 v[56:59], v[20:23], v[168:175], v3
  buffer_load_dwordx4 v[32:35], v2, s[8:11], s23 offen offset:2048 sc1
  v_smfmac_f32_16x16x64_bf16 v[62:65], v[20:23], v[224:231], v3
  s_waitcnt vmcnt(5)
  v_smfmac_f32_16x16x64_bf16 v[36:39], v[8:11], a[0:7], v3
  v_smfmac_f32_16x16x64_bf16 v[40:43], v[8:11], a[56:63], v3
  v_smfmac_f32_16x16x64_bf16 v[44:47], v[8:11], a[112:119], v3
  v_smfmac_f32_16x16x64_bf16 v[48:51], v[8:11], a[168:175], v3
  v_smfmac_f32_16x16x64_bf16 v[52:55], v[8:11], a[224:231], v3
  v_smfmac_f32_16x16x64_bf16 v[56:59], v[8:11], v[144:151], v3
  buffer_load_dwordx4 v[88:91], v117, s[8:11], s26 offen offset:0 sc1
  v_smfmac_f32_16x16x64_bf16 v[62:65], v[8:11], v[200:207], v3
  s_waitcnt vmcnt(5)
  v_smfmac_f32_16x16x64_bf16 v[36:39], v[12:15], a[8:15], v3
  v_smfmac_f32_16x16x64_bf16 v[40:43], v[12:15], a[64:71], v3
  v_smfmac_f32_16x16x64_bf16 v[44:47], v[12:15], a[120:127], v3
  buffer_load_dwordx4 v[92:95], v117, s[8:11], s26 offen offset:1024 sc1
  v_smfmac_f32_16x16x64_bf16 v[48:51], v[12:15], a[176:183], v3
  v_smfmac_f32_16x16x64_bf16 v[52:55], v[12:15], a[232:239], v3
  v_smfmac_f32_16x16x64_bf16 v[56:59], v[12:15], v[152:159], v3
  v_smfmac_f32_16x16x64_bf16 v[62:65], v[12:15], v[208:215], v3
  s_waitcnt vmcnt(5)
  buffer_load_dwordx4 v[96:99], v2, s[8:11], s24 offen offset:0 sc1
  v_smfmac_f32_16x16x64_bf16 v[36:39], v[16:19], a[16:23], v3
  v_smfmac_f32_16x16x64_bf16 v[40:43], v[16:19], a[72:79], v3
  v_max3_u32 v66, v8, v12, v16
  v_smfmac_f32_16x16x64_bf16 v[44:47], v[16:19], a[128:135], v3
  v_smfmac_f32_16x16x64_bf16 v[48:51], v[16:19], a[184:191], v3
  buffer_load_dwordx4 v[100:103], v2, s[8:11], s24 offen offset:1024 sc1
  v_smfmac_f32_16x16x64_bf16 v[52:55], v[16:19], a[240:247], v3
  v_smfmac_f32_16x16x64_bf16 v[56:59], v[16:19], v[160:167], v3
  v_smfmac_f32_16x16x64_bf16 v[62:65], v[16:19], v[216:223], v3
  s_waitcnt vmcnt(4)
  v_smfmac_f32_16x16x64_bf16 v[62:65], v[24:27], v[232:239], v3
  buffer_load_dwordx4 v[104:107], v2, s[8:11], s26 offen offset:0 sc1
  v_max3_u32 v66, v66, v24, v27
  v_smfmac_f32_16x16x64_bf16 v[62:65], v[28:31], v[240:247], v3
  v_max3_u32 v66, v66, v28, v31
  v_smfmac_f32_16x16x64_bf16 v[62:65], v[32:35], v[248:255], v3
  v_max3_u32 v66, v66, v32, v35
  v_smfmac_f32_16x16x64_bf16 v[52:55], v[24:27], v[120:127], v3
  v_cmp_eq_u32 vcc, -1, v66
  v_smfmac_f32_16x16x64_bf16 v[52:55], v[28:31], v[128:135], v3
  buffer_load_dwordx4 v[108:111], v2, s[8:11], s26 offen offset:1024 sc1
  v_smfmac_f32_16x16x64_bf16 v[52:55], v[32:35], v[136:143], v3
  s_cbranch_vccnz cA_sc3_r4
  v_cvt_pk_bf16_f32 v62, v62, v63
  v_smfmac_f32_16x16x64_bf16 v[56:59], v[24:27], v[176:183], v3
  v_cvt_pk_bf16_f32 v63, v64, v65
  v_smfmac_f32_16x16x64_bf16 v[56:59], v[28:31], v[184:191], v3
  v_mfma_f32_16x16x32_bf16 v[8:11], v[60:63], v[4:7], 0
  v_cvt_pk_bf16_f32 v55, v54, v55
  v_smfmac_f32_16x16x64_bf16 v[56:59], v[32:35], v[192:199], v3
  v_cvt_pk_bf16_f32 v54, v52, v53
  v_smfmac_f32_16x16x64_bf16 v[36:39], v[24:27], a[32:39], v3
  s_nop 1
  v_cvt_pk_bf16_f32 v78, v8, v9
  v_smfmac_f32_16x16x64_bf16 v[36:39], v[28:31], a[40:47], v3
  v_cvt_pk_bf16_f32 v79, v10, v11
  v_smfmac_f32_16x16x64_bf16 v[36:39], v[32:35], a[48:55], v3
  v_cvt_pk_bf16_f32 v56, v56, v57
  v_smfmac_f32_16x16x64_bf16 v[40:43], v[24:27], a[88:95], v3
  v_cvt_pk_bf16_f32 v57, v58, v59
  v_smfmac_f32_16x16x64_bf16 v[40:43], v[28:31], a[96:103], v3
  v_mfma_f32_16x16x32_bf16 v[12:15], v[54:57], v[4:7], 0
  v_cvt_pk_bf16_f32 v39, v38, v39
  v_smfmac_f32_16x16x64_bf16 v[40:43], v[32:35], a[104:111], v3
  v_cvt_pk_bf16_f32 v38, v36, v37
  v_smfmac_f32_16x16x64_bf16 v[44:47], v[24:27], a[144:151], v3
  s_nop 1
  v_cvt_pk_bf16_f32 v76, v12, v13
  v_smfmac_f32_16x16x64_bf16 v[44:47], v[28:31], a[152:159], v3
  v_cvt_pk_bf16_f32 v77, v14, v15
  v_smfmac_f32_16x16x64_bf16 v[44:47], v[32:35], a[160:167], v3
  v_cvt_pk_bf16_f32 v40, v40, v41
  v_smfmac_f32_16x16x64_bf16 v[48:51], v[24:27], a[200:207], v3
  v_cvt_pk_bf16_f32 v41, v42, v43
  v_smfmac_f32_16x16x64_bf16 v[48:51], v[28:31], a[208:215], v3
  v_smfmac_f32_16x16x64_bf16 v[48:51], v[32:35], a[216:223], v3
  s_waitcnt vmcnt(4)
  v_cvt_pk_bf16_f32 v47, v46, v47
  v_smfmac_f32_16x16x64_bf16 v[68:71], v[76:79], v[80:87], v3
  v_cvt_pk_bf16_f32 v46, v44, v45
  v_mfma_f32_16x16x32_bf16 v[8:11], v[38:41], v[4:7], 0
  s_nop 1
  v_cvt_pk_bf16_f32 v48, v48, v49
  v_cvt_pk_bf16_f32 v49, v50, v51
  s_nop 1
  v_mfma_f32_16x16x32_bf16 v[12:15], v[46:49], v[4:7], 0
  v_smfmac_f32_16x16x64_bf16 v[72:75], v[76:79], v[88:95], v3
  v_cvt_pk_bf16_f32 v16, v8, v9
  v_mfma_f32_16x16x32_bf16 v[52:55], v[30:33], v[76:79], 0
  s_waitcnt vmcnt(0)
  v_cvt_pk_bf16_f32 v17, v10, v11
  v_cvt_pk_bf16_f32 v18, v12, v13
  v_cvt_pk_bf16_f32 v19, v14, v15
  s_nop 1
  v_mfma_f32_16x16x32_bf16 v[52:55], v[20:23], v[16:19], v[52:55]
  v_smfmac_f32_16x16x64_bf16 v[68:71], v[16:19], v[96:103], v3
  v_smfmac_f32_16x16x64_bf16 v[72:75], v[16:19], v[104:111], v3
  s_nop 1
  ds_write_b128 v113, v[52:55]
  s_nop 1
  v_permlane32_swap_b32 v68, v70
  v_permlane32_swap_b32 v69, v71
  v_add_f32 v56, v68, v70
  v_add_f32 v58, v69, v71
  v_permlane32_swap_b32 v72, v74
  v_permlane32_swap_b32 v73, v75
  v_add_f32 v57, v72, v74
  v_add_f32 v59, v73, v75
  ds_write_b128 v2, v[56:59] offset:3072
  v_cmp_u_f32 vcc, v57, v59
  v_mov_b32 v68, 0
  v_mov_b32 v69, 0
  v_mov_b32 v70, 0
  v_mov_b32 v71, 0
  s_cbranch_vccnz cA_sc3_retry
cA_sc3_cont:
  s_add_u32 s24, s24, 28672
  s_add_u32 s26, s26, 28672
  buffer_load_dwordx4 v[80:83], v117, s[8:11], s24 offen offset:0 sc1
  buffer_load_dwordx4 v[84:87], v117, s[8:11], s24 offen offset:1024 sc1
  v_mfma_f32_16x16x32_bf16 v[62:65], v[68:71], v[68:71], 0
  s_waitcnt lgkmcnt(0)
  s_barrier
  v_mov_b32 v52, 0
  v_mov_b32 v53, 0
  v_mov_b32 v54, 0
  v_mov_b32 v55, 0
  v_mov_b32 v56, 0
  v_mov_b32 v57, 0
  v_mov_b32 v58, 0
  v_mov_b32 v59, 0
  v_mfma_f32_32x32x16_bf16 v[36:51], v[68:71], v[68:71], 0
  v_mov_b32 v72, 0
  v_mov_b32 v73, 0
  v_mov_b32 v74, 0
  v_mov_b32 v75, 0
  s_buffer_load_dword s64, s[8:11], s34 offset:2688
  s_buffer_load_dword s65, s[8:11], s34 offset:2752
  s_buffer_load_dword s66, s[8:11], s34 offset:2816
  s_buffer_load_dword s67, s[8:11], s34 offset:2880
  s_buffer_load_dword s64, s[8:11], s34 offset:2944
  s_buffer_load_dword s65, s[8:11], s34 offset:3008
  s_buffer_load_dword s66, s[8:11], s34 offset:3072
  s_buffer_load_dword s67, s[8:11], s34 offset:3136
  s_buffer_load_dword s64, s[8:11], s34 offset:3200
  s_buffer_load_dword s65, s[8:11], s34 offset:3264
  s_buffer_load_dword s66, s[8:11], s34 offset:3328
  s_buffer_load_dword s67, s[8:11], s34 offset:3392
  s_buffer_load_dword s64, s[8:11], s34 offset:3456
  s_buffer_load_dword s65, s[8:11], s34 offset:3520
  s_mov_b32 s36, s34
  s_add_u32 s34, s33, 458752
  s_mov_b32 s33, s34
  s_mov_b32 s19, s18
  s_add_u32 s18, s18, 1
  s_mov_b32 s22, s20
  s_mov_b32 s20, s21
  s_mov_b32 s21, s22
  s_add_u32 s23, s20, 4096
  s_cmp_lt_u32 s19, 63
  s_cbranch_scc1 cA_sc3_loop
  s_branch cA_done
cA_sc3_r0:
  s_add_u32 s31, s31, 1
  buffer_load_dwordx4 v[20:23], v2, s[8:11], s20 offen offset:3072 sc1
  s_waitcnt vmcnt(0)
  v_cmp_eq_u32 vcc, -1, v20
  v_mov_b32 v36, 0
  v_mov_b32 v37, 0
  v_mov_b32 v38, 0
  v_mov_b32 v39, 0
  v_mov_b32 v40, 0
  v_mov_b32 v41, 0
  v_mov_b32 v42, 0
  v_mov_b32 v43, 0
  v_mov_b32 v44, 0
  v_mov_b32 v45, 0
  v_mov_b32 v46, 0
  v_mov_b32 v47, 0
  v_mov_b32 v48, 0
  v_mov_b32 v49, 0
  v_mov_b32 v50, 0
  v_mov_b32 v51, 0
  s_nop 1
  s_cbranch_vccz cA_sc3_go
  s_add_u32 s30, s30, 1
  s_cmp_lt_u32 s30, 400000
  s_cbranch_scc1 cA_sc3_r0
  s_branch cA_abort
cA_sc3_r4:
  s_add_u32 s31, s31, 1
  buffer_load_dwordx4 v[8:11], v2, s[8:11], s20 offen offset:0 sc1
  buffer_load_dwordx4 v[12:15], v2, s[8:11], s20 offen offset:1024 sc1
  buffer_load_dwordx4 v[16:19], v2, s[8:11], s20 offen offset:2048 sc1
  buffer_load_dwordx4 v[24:27], v2, s[8:11], s23 offen offset:0 sc1
  buffer_load_dwordx4 v[28:31], v2, s[8:11], s23 offen offset:1024 sc1
  buffer_load_dwordx4 v[32:35], v2, s[8:11], s23 offen offset:2048 sc1
  s_waitcnt vmcnt(0)
  v_max3_u32 v66, v8, v12, v16
  v_max3_u32 v66, v66, v24, v27
  v_max3_u32 v66, v66, v28, v31
  v_max3_u32 v66, v66, v32, v35
  v_cmp_eq_u32 vcc, -1, v66
  s_nop 4
  s_cbranch_vccz cA_sc3_rz
  s_add_u32 s30, s30, 1
  s_cmp_lt_u32 s30, 400000
  s_cbranch_scc1 cA_sc3_r4
  s_branch cA_abort
cA_sc3_retry:
  s_cmp_lg_u32 s62, 0
  s_cbranch_scc1 cA_sc3_cont
  s_waitcnt vmcnt(0) lgkmcnt(0)
cA_sc3_rv:
  buffer_load_dwordx4 v[8:11], v2, s[8:11], s20 offen offset:0 sc1
  buffer_load_dwordx4 v[12:15], v2, s[8:11], s20 offen offset:1024 sc1
  buffer_load_dwordx4 v[16:19], v2, s[8:11], s20 offen offset:2048 sc1
  buffer_load_dwordx4 v[20:23], v2, s[8:11], s20 offen offset:3072 sc1
  buffer_load_dwordx4 v[24:27], v2, s[8:11], s23 offen offset:0 sc1
  buffer_load_dwordx4 v[28:31], v2, s[8:11], s23 offen offset:1024 sc1
  buffer_load_dwordx4 v[32:35], v2, s[8:11], s23 offen offset:2048 sc1
  s_waitcnt vmcnt(0)
  v_max3_u32 v66, v8, v9, v10
  v_max3_u32 v66, v66, v11, v12
  v_max3_u32 v66, v66, v13, v14
  v_max3_u32 v66, v66, v15, v16
  v_max3_u32 v66, v66, v17, v18
  v_max3_u32 v66, v66, v19, v20
  v_max3_u32 v66, v66, v21, v22
  v_max3_u32 v66, v66, v23, v24
  v_max3_u32 v66, v66, v25, v26
  v_max3_u32 v66, v66, v27, v28
  v_max3_u32 v66, v66, v29, v30
  v_max3_u32 v66, v66, v31, v32
  v_max3_u32 v66, v66, v33, v34
  v_max_u32 v66, v66, v35
  v_cmp_eq_u32 vcc, -1, v66
  s_cbranch_vccz cA_sc3_rk
  s_add_u32 s30, s30, 1
  s_cmp_lt_u32 s30, 400000
  s_cbranch_scc1 cA_sc3_rv
  s_branch cA_abort
cA_sc3_rk:
  s_mov_b32 s62, 1
  s_add_u32 s31, s31, 0x100
cA_sc3_rz:
  v_mov_b32 v36, 0
  v_mov_b32 v37, 0
  v_mov_b32 v38, 0
  v_mov_b32 v39, 0
  v_mov_b32 v40, 0
  v_mov_b32 v41, 0
  v_mov_b32 v42, 0
  v_mov_b32 v43, 0
  v_mov_b32 v44, 0
  v_mov_b32 v45, 0
  v_mov_b32 v46, 0
  v_mov_b32 v47, 0
  v_mov_b32 v48, 0
  v_mov_b32 v49, 0
  v_mov_b32 v50, 0
  v_mov_b32 v51, 0
  v_mov_b32 v62, 0
  v_mov_b32 v63, 0
  v_mov_b32 v64, 0
  v_mov_b32 v65, 0
  v_mov_b32 v68, 0
  v_mov_b32 v69, 0
  v_mov_b32 v70, 0
  v_mov_b32 v71, 0
  v_mov_b32 v72, 0
  v_mov_b32 v73, 0
  v_mov_b32 v74, 0
  v_mov_b32 v75, 0
  v_mov_b32 v52, 0
  v_mov_b32 v53, 0
  v_mov_b32 v54, 0
  v_mov_b32 v55, 0
  v_mov_b32 v56, 0
  v_mov_b32 v57, 0
  v_mov_b32 v58, 0
  v_mov_b32 v59, 0
  s_nop 1
  s_branch cA_sc3_go
.p2align 6
cA_va0_loop:
  s_mov_b32 s30, 0
  s_barrier
  buffer_load_dwordx4 v[24:27], v2, s[8:11], s23 offen offset:0 sc1
  buffer_load_dwordx4 v[28:31], v2, s[8:11], s23 offen offset:1024 sc1
  s_barrier
  s_cmp_lt_u32 s19, 60
  s_cbranch_scc1 cA_va0_m1
  buffer_store_dword v160, v1, s[8:11], s38 offen sc1
  s_cmp_lg_u32 s19, 63
  s_cbranch_scc1 cA_va0_m2
  v_min_u32 v64, -2, v64
  v_min_u32 v65, -2, v65
  v_min_u32 v66, -2, v66
  v_min_u32 v67, -2, v67
  v_min_u32 v68, -2, v68
  v_min_u32 v69, -2, v69
  v_min_u32 v70, -2, v70
  v_min_u32 v71, -2, v71
  v_min_u32 v72, -2, v72
  v_min_u32 v73, -2, v73
  v_min_u32 v74, -2, v74
  v_min_u32 v75, -2, v75
  v_min_u32 v76, -2, v76
  v_min_u32 v77, -2, v77
  v_min_u32 v78, -2, v78
  v_min_u32 v79, -2, v79
  buffer_store_dwordx4 v[64:67], v2, s[8:11], s33 offen offset:0 sc1
  buffer_store_dwordx4 v[68:71], v2, s[8:11], s33 offen offset:2048 sc1
  s_add_u32 s33, s33, 4096
  buffer_store_dwordx4 v[72:75], v2, s[8:11], s33 offen offset:0 sc1
  buffer_store_dwordx4 v[76:79], v2, s[8:11], s33 offen offset:2048 sc1
  s_add_u32 s33, s33, 4096
  s_waitcnt vmcnt(5)
  s_branch cA_va0_m3
cA_va0_m1:
  buffer_store_dword v160, v1, s[8:11], s38 offen nt
cA_va0_m2:
  s_add_u32 s22, s25, s80
  buffer_load_dwordx4 v[80:83], v6, s[8:11], s22 offen offset:0 sc1
  buffer_load_dwordx4 v[84:87], v6, s[8:11], s22 offen offset:1792 sc1
  s_add_u32 s22, s22, 3584
  buffer_load_dwordx4 v[88:91], v6, s[8:11], s22 offen offset:0 sc1
  buffer_load_dwordx4 v[92:95], v6, s[8:11], s22 offen offset:1792 sc1
  s_add_u32 s22, s25, s81
  buffer_load_dwordx4 v[96:99], v6, s[8:11], s22 offen offset:0 sc1
  s_mul_i32 s38, s18, 7168
  s_add_u32 s38, s38, 65536
  s_waitcnt vmcnt(6)
cA_va0_m3:
  ds_write_b128 v2, v[24:27] offset:12288
  ds_write_b128 v2, v[28:31] offset:13312
  v_smfmac_f32_16x16x64_bf16 v[36:39], v[24:27], a[32:39], v3
  buffer_load_dwordx4 v[100:103], v6, s[8:11], s22 offen offset:1792 sc1
  v_smfmac_f32_16x16x64_bf16 v[40:43], v[24:27], a[88:95], v3
  s_add_u32 s22, s22, 3584
  buffer_load_dwordx4 v[104:107], v6, s[8:11], s22 offen offset:0 sc1
  v_smfmac_f32_16x16x64_bf16 v[44:47], v[24:27], a[144:151], v3
  buffer_load_dwordx4 v[108:111], v6, s[8:11], s22 offen offset:1792 sc1
  v_smfmac_f32_16x16x64_bf16 v[48:51], v[24:27], a[200:207], v3
  s_add_u32 s22, s25, s82
  buffer_load_dwordx4 v[112:115], v6, s[8:11], s22 offen offset:0 sc1
  v_smfmac_f32_16x16x64_bf16 v[52:55], v[24:27], v[176:183], v3
  s_waitcnt lgkmcnt(0)
  s_barrier
  ds_read_b128 v[8:11], v2 offset:8192
  ds_read_b128 v[12:15], v2 offset:9216
  ds_read_b128 v[16:19], v2 offset:10240
  ds_read_b128 v[20:23], v2 offset:11264
  ds_read_b128 v[32:35], v2 offset:14336
  buffer_load_dwordx4 v[116:119], v6, s[8:11], s22 offen offset:1792 sc1
  v_smfmac_f32_16x16x64_bf16 v[56:59], v[24:27], v[232:239], v3
  s_add_u32 s22, s22, 3584
  buffer_load_dwordx4 v[120:123], v6, s[8:11], s22 offen offset:0 sc1
  v_smfmac_f32_16x16x64_bf16 v[36:39], v[28:31], a[40:47], v3
  buffer_load_dwordx4 v[124:127], v6, s[8:11], s22 offen offset:1792 sc1
  v_smfmac_f32_16x16x64_bf16 v[40:43], v[28:31], a[96:103], v3
  s_add_u32 s22, s25, s83
  buffer_load_dwordx4 v[128:131], v6, s[8:11], s22 offen offset:0 sc1
  v_smfmac_f32_16x16x64_bf16 v[44:47], v[28:31], a[152:159], v3
  buffer_load_dwordx4 v[132:135], v6, s[8:11], s22 offen offset:1792 sc1
  v_smfmac_f32_16x16x64_bf16 v[48:51], v[28:31], a[208:215], v3
  s_add_u32 s22, s22, 3584
  buffer_load_dwordx4 v[136:139], v6, s[8:11], s22 offen offset:0 sc1
  v_smfmac_f32_16x16x64_bf16 v[52:55], v[28:31], v[184:191], v3
  buffer_load_dwordx4 v[140:143], v6, s[8:11], s22 offen offset:1792 sc1
  v_smfmac_f32_16x16x64_bf16 v[56:59], v[28:31], v[240:247], v3
  s_waitcnt lgkmcnt(4)
  v_smfmac_f32_16x16x64_bf16 v[36:39], v[8:11], a[0:7], v3
  s_waitcnt lgkmcnt(3)
  v_smfmac_f32_16x16x64_bf16 v[36:39], v[12:15], a[8:15], v3
  s_waitcnt lgkmcnt(2)
  v_smfmac_f32_16x16x64_bf16 v[36:39], v[16:19], a[16:23], v3
  s_waitcnt lgkmcnt(1)
  v_smfmac_f32_16x16x64_bf16 v[36:39], v[20:23], a[24:31], v3
  s_waitcnt lgkmcnt(0)
  v_smfmac_f32_16x16x64_bf16 v[36:39], v[32:35], a[48:55], v3
  v_smfmac_f32_16x16x64_bf16 v[40:43], v[8:11], a[56:63], v3
  v_smfmac_f32_16x16x64_bf16 v[40:43], v[12:15], a[64:71], v3
  v_smfmac_f32_16x16x64_bf16 v[40:43], v[16:19], a[72:79], v3
  v_permlane32_swap_b32 v36, v38
  v_smfmac_f32_16x16x64_bf16 v[40:43], v[20:23], a[80:87], v3
  v_permlane32_swap_b32 v37, v39
  v_smfmac_f32_16x16x64_bf16 v[40:43], v[32:35], a[104:111], v3
  v_add_f32 v36, v36, v38
  v_smfmac_f32_16x16x64_bf16 v[44:47], v[8:11], a[112:119], v3
  v_add_f32 v37, v37, v39
  v_smfmac_f32_16x16x64_bf16 v[44:47], v[12:15], a[120:127], v3
  v_cmp_u_f32 vcc, v36, v37
  v_smfmac_f32_16x16x64_bf16 v[44:47], v[16:19], a[128:135], v3
  v_cvt_pk_bf16_f32 v38, v36, v37
  v_smfmac_f32_16x16x64_bf16 v[44:47], v[20:23], a[136:143], v3
  ds_write_b32 v152, v38
  s_cbranch_vccnz cA_va0_slow
  v_permlane32_swap_b32 v40, v42
  v_smfmac_f32_16x16x64_bf16 v[44:47], v[32:35], a[160:167], v3
  v_permlane32_swap_b32 v41, v43
  v_smfmac_f32_16x16x64_bf16 v[48:51], v[8:11], a[168:175], v3
  buffer_store_dword v162, v1, s[8:11], s21 offen
  v_add_f32 v40, v40, v42
  v_smfmac_f32_16x16x64_bf16 v[48:51], v[12:15], a[176:183], v3
  v_add_f32 v41, v41, v43
  v_smfmac_f32_16x16x64_bf16 v[48:51], v[16:19], a[184:191], v3
  buffer_load_dword v164, v4, s[8:11], 0 offen sc1
  v_cvt_pk_bf16_f32 v42, v40, v41
  v_smfmac_f32_16x16x64_bf16 v[48:51], v[20:23], a[192:199], v3
  ds_write_b32 v153, v42
  v_permlane32_swap_b32 v44, v46
  v_smfmac_f32_16x16x64_bf16 v[48:51], v[32:35], a[216:223], v3
  v_permlane32_swap_b32 v45, v47
  v_smfmac_f32_16x16x64_bf16 v[52:55], v[8:11], a[224:231], v3
  buffer_load_dword v164, v4, s[8:11], 0 offen sc1
  v_add_f32 v44, v44, v46
  v_smfmac_f32_16x16x64_bf16 v[52:55], v[12:15], a[232:239], v3
  v_add_f32 v45, v45, v47
  v_smfmac_f32_16x16x64_bf16 v[52:55], v[16:19], a[240:247], v3
  v_cvt_pk_bf16_f32 v46, v44, v45
  v_smfmac_f32_16x16x64_bf16 v[52:55], v[20:23], a[248:255], v3
  ds_write_b32 v154, v46
  buffer_load_dword v164, v4, s[8:11], 0 offen sc1
  v_permlane32_swap_b32 v48, v50
  v_smfmac_f32_16x16x64_bf16 v[52:55], v[32:35], v[192:199], v3
  v_permlane32_swap_b32 v49, v51
  v_smfmac_f32_16x16x64_bf16 v[56:59], v[8:11], v[200:207], v3
  v_add_f32 v48, v48, v50
  v_smfmac_f32_16x16x64_bf16 v[56:59], v[12:15], v[208:215], v3
  buffer_load_dword v164, v4, s[8:11], 0 offen sc1
  v_add_f32 v49, v49, v51
  v_smfmac_f32_16x16x64_bf16 v[56:59], v[16:19], v[216:223], v3
  v_cvt_pk_bf16_f32 v50, v48, v49
  v_smfmac_f32_16x16x64_bf16 v[56:59], v[20:23], v[224:231], v3
  ds_write_b32 v155, v50
  v_permlane32_swap_b32 v52, v54
  v_smfmac_f32_16x16x64_bf16 v[56:59], v[32:35], v[248:255], v3
  buffer_load_dword v164, v4, s[8:11], 0 offen sc1
  v_permlane32_swap_b32 v53, v55
  v_add_f32 v52, v52, v54
  v_add_f32 v53, v53, v55
  v_cvt_pk_bf16_f32 v54, v52, v53
  ds_write_b32 v156, v54
  s_nop 1
  v_permlane32_swap_b32 v56, v58
  v_permlane32_swap_b32 v57, v59
  v_add_f32 v56, v56, v58
  v_add_f32 v57, v57, v59
  v_cvt_pk_bf16_f32 v58, v56, v57
  ds_write_b32 v157, v58
cA_va0_t2d:
  s_add_u32 s72, s20, s76
  s_add_u32 s73, s20, s77
  s_add_u32 s74, s20, s78
  s_add_u32 s75, s20, s79
  s_add_u32 s22, s20, 9216
  s_add_u32 s34, s20, 13312
  s_add_u32 s36, s20, 7168
  s_mov_b32 s37, 0
  v_mov_b32 v48, 0
  v_mov_b32 v49, 0
  v_mov_b32 v50, 0
  v_mov_b32 v51, 0
  v_mov_b32 v163, s18
  s_cmp_eq_u32 s19, 63
  s_waitcnt lgkmcnt(0)
  s_cbranch_scc1 cA_va0_last
  s_setprio 3
cA_va0_fw_l:
  v_cmp_gt_u32 vcc, s18, v164
  buffer_load_dword v164, v4, s[8:11], 0 offen sc1
  s_cbranch_vccz cA_va0_fw_d
  v_cmp_gt_u32 vcc, s18, v164
  buffer_load_dword v164, v4, s[8:11], 0 offen sc1
  s_cbranch_vccz cA_va0_fw_d
  v_cmp_gt_u32 vcc, s18, v164
  buffer_load_dword v164, v4, s[8:11], 0 offen sc1
  s_cbranch_vccz cA_va0_fw_d
  v_cmp_gt_u32 vcc, s18, v164
  buffer_load_dword v164, v4, s[8:11], 0 offen sc1
  s_cbranch_vccz cA_va0_fw_d
  v_cmp_gt_u32 vcc, s18, v164
  buffer_load_dword v164, v4, s[8:11], 0 offen sc1
  s_cbranch_vccz cA_va0_fw_d
  v_cmp_gt_u32 vcc, s18, v164
  buffer_load_dword v164, v4, s[8:11], 0 offen sc1
  s_cbranch_vccz cA_va0_fw_d
  v_cmp_gt_u32 vcc, s18, v164
  buffer_load_dword v164, v4, s[8:11], 0 offen sc1
  s_cbranch_vccz cA_va0_fw_d
  v_cmp_gt_u32 vcc, s18, v164
  buffer_load_dword v164, v4, s[8:11], 0 offen sc1
  s_cbranch_vccz cA_va0_fw_d
  v_cmp_gt_u32 vcc, s18, v164
  buffer_load_dword v164, v4, s[8:11], 0 offen sc1
  s_cbranch_vccz cA_va0_fw_d
  v_cmp_gt_u32 vcc, s18, v164
  buffer_load_dword v164, v4, s[8:11], 0 offen sc1
  s_cbranch_vccz cA_va0_fw_d
  v_cmp_gt_u32 vcc, s18, v164
  buffer_load_dword v164, v4, s[8:11], 0 offen sc1
  s_cbranch_vccz cA_va0_fw_d
  v_cmp_gt_u32 vcc, s18, v164
  buffer_load_dword v164, v4, s[8:11], 0 offen sc1
  s_cbranch_vccz cA_va0_fw_d
  v_cmp_gt_u32 vcc, s18, v164
  buffer_load_dword v164, v4, s[8:11], 0 offen sc1
  s_cbranch_vccz cA_va0_fw_d
  v_cmp_gt_u32 vcc, s18, v164
  buffer_load_dword v164, v4, s[8:11], 0 offen sc1
  s_cbranch_vccz cA_va0_fw_d
  v_cmp_gt_u32 vcc, s18, v164
  buffer_load_dword v164, v4, s[8:11], 0 offen sc1
  s_cbranch_vccz cA_va0_fw_d
  v_cmp_gt_u32 vcc, s18, v164
  buffer_load_dword v164, v4, s[8:11], 0 offen sc1
  s_cbranch_vccz cA_va0_fw_d
  s_waitcnt vmcnt(24)
  s_add_u32 s30, s30, 1
  s_cmp_lt_u32 s30, 400000
  s_cbranch_scc1 cA_va0_fw_l
  s_branch cA_abort
cA_va0_fw_d:
  buffer_load_dwordx4 v[8:11], v2, s[8:11], s72 offen offset:0 sc1
  buffer_load_dwordx4 v[12:15], v2, s[8:11], s72 offen offset:1024 sc1
  buffer_load_dwordx4 v[16:19], v2, s[8:11], s73 offen offset:0 sc1
  buffer_load_dwordx4 v[20:23], v2, s[8:11], s73 offen offset:1024 sc1
  buffer_load_dwordx4 v[24:27], v2, s[8:11], s74 offen offset:0 sc1
  buffer_load_dwordx4 v[28:31], v2, s[8:11], s74 offen offset:1024 sc1
  buffer_load_dwordx4 v[32:35], v2, s[8:11], s75 offen offset:0 sc1
  buffer_load_dwordx4 v[36:39], v2, s[8:11], s75 offen offset:1024 sc1
  buffer_load_dwordx4 v[40:43], v2, s[8:11], s36 offen offset:0 sc1
  buffer_load_dwordx4 v[44:47], v2, s[8:11], s36 offen offset:1024 sc1
  s_barrier
  ds_read_b128 v[64:67], v2 offset:0
  ds_read_b128 v[68:71], v2 offset:1024
  ds_read_b128 v[72:75], v2 offset:2048
  ds_read_b128 v[76:79], v2 offset:3072
cA_va0_lp:
  s_waitcnt vmcnt(9)
  v_smfmac_f32_16x16x64_bf16 v[48:51], v[8:11], v[80:87], v3
  s_waitcnt vmcnt(8)
  v_smfmac_f32_16x16x64_bf16 v[48:51], v[12:15], v[88:95], v3
  s_waitcnt vmcnt(7)
  v_smfmac_f32_16x16x64_bf16 v[48:51], v[16:19], v[96:103], v3
  s_waitcnt vmcnt(6)
  v_smfmac_f32_16x16x64_bf16 v[48:51], v[20:23], v[104:111], v3
  s_waitcnt vmcnt(5)
  v_smfmac_f32_16x16x64_bf16 v[48:51], v[24:27], v[112:119], v3
  s_waitcnt vmcnt(4)
  v_smfmac_f32_16x16x64_bf16 v[48:51], v[28:31], v[120:127], v3
  s_waitcnt vmcnt(3)
  v_smfmac_f32_16x16x64_bf16 v[48:51], v[32:35], v[128:135], v3
  s_waitcnt vmcnt(2)
  v_smfmac_f32_16x16x64_bf16 v[48:51], v[36:39], v[136:143], v3
  s_waitcnt vmcnt(1) lgkmcnt(0)
  v_smfmac_f32_16x16x64_bf16 v[48:51], v[40:43], v[64:71], v3
  s_waitcnt vmcnt(0)
  v_smfmac_f32_16x16x64_bf16 v[48:51], v[44:47], v[72:79], v3
  s_nop 7
  v_permlane32_swap_b32 v48, v50
  v_permlane32_swap_b32 v49, v51
  v_pk_add_f32 v[48:49], v[48:49], v[50:51]
  v_cvt_pk_bf16_f32 v160, v48, v49
  v_cmp_u_f32 vcc, v48, v49
  s_nop 0
  v_mov_b32_dpp v161, v160 quad_perm:[1,0,3,2] row_mask:0xf bank_mask:0xf
  v_perm_b32 v160, v161, v160, v5
  v_cndmask_b32 v161, v160, v162, vcc
  buffer_store_dword v161, v1, s[8:11], s21 offen
  s_cbranch_vccnz cA_va0_rp
cA_va0_cont:
  s_setprio 0
  s_cmp_lg_u32 s19, 62
  s_cbranch_scc1 cA_va0_nl
  s_mov_b32 s25, 0x40000000
cA_va0_nl:
  s_add_u32 s25, s25, 458752
  v_mov_b32 v36, 0
  v_mov_b32 v37, 0
  v_mov_b32 v38, 0
  v_mov_b32 v39, 0
  v_mov_b32 v40, 0
  v_mov_b32 v41, 0
  v_mov_b32 v42, 0
  v_mov_b32 v43, 0
  v_mov_b32 v44, 0
  v_mov_b32 v45, 0
  v_mov_b32 v46, 0
  v_mov_b32 v47, 0
  v_mov_b32 v48, 0
  v_mov_b32 v49, 0
  v_mov_b32 v50, 0
  v_mov_b32 v51, 0
  v_mov_b32 v52, 0
  v_mov_b32 v53, 0
  v_mov_b32 v54, 0
  v_mov_b32 v55, 0
  v_mov_b32 v56, 0
  v_mov_b32 v57, 0
  v_mov_b32 v58, 0
  v_mov_b32 v59, 0
  v_mov_b32 v60, 0
  v_mov_b32 v61, 0
  v_mov_b32 v62, 0
  v_mov_b32 v63, 0
  s_mov_b32 s19, s18
  s_add_u32 s18, s18, 1
  s_mov_b32 s22, s20
  s_mov_b32 s20, s21
  s_mov_b32 s21, s22
  s_add_u32 s23, s20, 4096
  s_branch cA_va0_loop
cA_va0_slow:
  s_waitcnt lgkmcnt(0)
cA_va0_sl1:
  s_add_u32 s31, s31, 0x1000000
  buffer_load_dwordx4 v[8:11], v2, s[8:11], s20 offen offset:0 sc1
  buffer_load_dwordx4 v[12:15], v2, s[8:11], s20 offen offset:1024 sc1
  buffer_load_dwordx4 v[16:19], v2, s[8:11], s20 offen offset:2048 sc1
  buffer_load_dwordx4 v[20:23], v2, s[8:11], s20 offen offset:3072 sc1
  buffer_load_dwordx4 v[24:27], v2, s[8:11], s23 offen offset:0 sc1
  buffer_load_dwordx4 v[28:31], v2, s[8:11], s23 offen offset:1024 sc1
  buffer_load_dwordx4 v[32:35], v2, s[8:11], s23 offen offset:2048 sc1
  s_waitcnt vmcnt(0)
  v_max3_u32 v36, v8, v9, v10
  v_max3_u32 v36, v36, v11, v12
  v_max3_u32 v36, v36, v13, v14
  v_max3_u32 v36, v36, v15, v16
  v_max3_u32 v36, v36, v17, v18
  v_max3_u32 v36, v36, v19, v20
  v_max3_u32 v36, v36, v21, v22
  v_max3_u32 v36, v36, v23, v24
  v_max3_u32 v36, v36, v25, v26
  v_max3_u32 v36, v36, v27, v28
  v_max3_u32 v36, v36, v29, v30
  v_max3_u32 v36, v36, v31, v32
  v_max3_u32 v36, v36, v33, v34
  v_max_u32 v36, v36, v35
  v_cmp_eq_u32 vcc, -1, v36
  s_cbranch_vccz cA_va0_sl2
  s_add_u32 s30, s30, 1
  s_cmp_lt_u32 s30, 400000
  s_cbranch_scc1 cA_va0_sl1
  s_branch cA_abort
cA_va0_sl2:
  v_mov_b32 v36, 0
  v_mov_b32 v37, 0
  v_mov_b32 v38, 0
  v_mov_b32 v39, 0
  v_mov_b32 v40, 0
  v_mov_b32 v41, 0
  v_mov_b32 v42, 0
  v_mov_b32 v43, 0
  v_mov_b32 v44, 0
  v_mov_b32 v45, 0
  v_mov_b32 v46, 0
  v_mov_b32 v47, 0
  v_mov_b32 v48, 0
  v_mov_b32 v49, 0
  v_mov_b32 v50, 0
  v_mov_b32 v51, 0
  v_mov_b32 v52, 0
  v_mov_b32 v53, 0
  v_mov_b32 v54, 0
  v_mov_b32 v55, 0
  v_mov_b32 v56, 0
  v_mov_b32 v57, 0
  v_mov_b32 v58, 0
  v_mov_b32 v59, 0
  v_mov_b32 v60, 0
  v_mov_b32 v61, 0
  v_mov_b32 v62, 0
  v_mov_b32 v63, 0
  buffer_store_dword v162, v1, s[8:11], s21 offen
  v_smfmac_f32_16x16x64_bf16 v[36:39], v[8:11], a[0:7], v3
  v_smfmac_f32_16x16x64_bf16 v[40:43], v[8:11], a[56:63], v3
  v_smfmac_f32_16x16x64_bf16 v[44:47], v[8:11], a[112:119], v3
  v_smfmac_f32_16x16x64_bf16 v[48:51], v[8:11], a[168:175], v3
  v_smfmac_f32_16x16x64_bf16 v[52:55], v[8:11], a[224:231], v3
  v_smfmac_f32_16x16x64_bf16 v[56:59], v[8:11], v[200:207], v3
  v_smfmac_f32_16x16x64_bf16 v[36:39], v[12:15], a[8:15], v3
  v_smfmac_f32_16x16x64_bf16 v[40:43], v[12:15], a[64:71], v3
  v_smfmac_f32_16x16x64_bf16 v[44:47], v[12:15], a[120:127], v3
  v_smfmac_f32_16x16x64_bf16 v[48:51], v[12:15], a[176:183], v3
  v_smfmac_f32_16x16x64_bf16 v[52:55], v[12:15], a[232:239], v3
  v_smfmac_f32_16x16x64_bf16 v[56:59], v[12:15], v[208:215], v3
  v_smfmac_f32_16x16x64_bf16 v[36:39], v[16:19], a[16:23], v3
  v_smfmac_f32_16x16x64_bf16 v[40:43], v[16:19], a[72:79], v3
  v_smfmac_f32_16x16x64_bf16 v[44:47], v[16:19], a[128:135], v3
  v_smfmac_f32_16x16x64_bf16 v[48:51], v[16:19], a[184:191], v3
  v_smfmac_f32_16x16x64_bf16 v[52:55], v[16:19], a[240:247], v3
  v_smfmac_f32_16x16x64_bf16 v[56:59], v[16:19], v[216:223], v3
  v_smfmac_f32_16x16x64_bf16 v[36:39], v[20:23], a[24:31], v3
  v_smfmac_f32_16x16x64_bf16 v[40:43], v[20:23], a[80:87], v3
  v_smfmac_f32_16x16x64_bf16 v[44:47], v[20:23], a[136:143], v3
  v_smfmac_f32_16x16x64_bf16 v[48:51], v[20:23], a[192:199], v3
  v_smfmac_f32_16x16x64_bf16 v[52:55], v[20:23], a[248:255], v3
  v_smfmac_f32_16x16x64_bf16 v[56:59], v[20:23], v[224:231], v3
  v_smfmac_f32_16x16x64_bf16 v[36:39], v[24:27], a[32:39], v3
  v_smfmac_f32_16x16x64_bf16 v[40:43], v[24:27], a[88:95], v3
  v_smfmac_f32_16x16x64_bf16 v[44:47], v[24:27], a[144:151], v3
  v_smfmac_f32_16x16x64_bf16 v[48:51], v[24:27], a[200:207], v3
  v_smfmac_f32_16x16x64_bf16 v[52:55], v[24:27], v[176:183], v3
  v_smfmac_f32_16x16x64_bf16 v[56:59], v[24:27], v[232:239], v3
  v_smfmac_f32_16x16x64_bf16 v[36:39], v[28:31], a[40:47], v3
  v_smfmac_f32_16x16x64_bf16 v[40:43], v[28:31], a[96:103], v3
  v_smfmac_f32_16x16x64_bf16 v[44:47], v[28:31], a[152:159], v3
  v_smfmac_f32_16x16x64_bf16 v[48:51], v[28:31], a[208:215], v3
  v_smfmac_f32_16x16x64_bf16 v[52:55], v[28:31], v[184:191], v3
  v_smfmac_f32_16x16x64_bf16 v[56:59], v[28:31], v[240:247], v3
  v_smfmac_f32_16x16x64_bf16 v[36:39], v[32:35], a[48:55], v3
  v_smfmac_f32_16x16x64_bf16 v[40:43], v[32:35], a[104:111], v3
  v_smfmac_f32_16x16x64_bf16 v[44:47], v[32:35], a[160:167], v3
  v_smfmac_f32_16x16x64_bf16 v[48:51], v[32:35], a[216:223], v3
  v_smfmac_f32_16x16x64_bf16 v[52:55], v[32:35], v[192:199], v3
  v_smfmac_f32_16x16x64_bf16 v[56:59], v[32:35], v[248:255], v3
  v_permlane32_swap_b32 v36, v38
  v_permlane32_swap_b32 v37, v39
  v_add_f32 v36, v36, v38
  v_add_f32 v37, v37, v39
  v_cvt_pk_bf16_f32 v38, v36, v37
  ds_write_b32 v152, v38
  v_permlane32_swap_b32 v40, v42
  v_permlane32_swap_b32 v41, v43
  v_add_f32 v40, v40, v42
  v_add_f32 v41, v41, v43
  v_cvt_pk_bf16_f32 v42, v40, v41
  ds_write_b32 v153, v42
  v_permlane32_swap_b32 v44, v46
  v_permlane32_swap_b32 v45, v47
  v_add_f32 v44, v44, v46
  v_add_f32 v45, v45, v47
  v_cvt_pk_bf16_f32 v46, v44, v45
  ds_write_b32 v154, v46
  v_permlane32_swap_b32 v48, v50
  v_permlane32_swap_b32 v49, v51
  v_add_f32 v48, v48, v50
  v_add_f32 v49, v49, v51
  v_cvt_pk_bf16_f32 v50, v48, v49
  ds_write_b32 v155, v50
  v_permlane32_swap_b32 v52, v54
  v_permlane32_swap_b32 v53, v55
  v_add_f32 v52, v52, v54
  v_add_f32 v53, v53, v55
  v_cvt_pk_bf16_f32 v54, v52, v53
  ds_write_b32 v156, v54
  v_permlane32_swap_b32 v56, v58
  v_permlane32_swap_b32 v57, v59
  v_add_f32 v56, v56, v58
  v_add_f32 v57, v57, v59
  v_cvt_pk_bf16_f32 v58, v56, v57
  ds_write_b32 v157, v58
  buffer_load_dword v164, v4, s[8:11], 0 offen sc1
  buffer_load_dword v164, v4, s[8:11], 0 offen sc1
  buffer_load_dword v164, v4, s[8:11], 0 offen sc1
  buffer_load_dword v164, v4, s[8:11], 0 offen sc1
  buffer_load_dword v164, v4, s[8:11], 0 offen sc1
  s_branch cA_va0_t2d
cA_va0_last:
  s_barrier
  ds_read_b128 v[64:67], v2 offset:0
  ds_read_b128 v[68:71], v2 offset:1024
  ds_read_b128 v[72:75], v2 offset:2048
  ds_read_b128 v[76:79], v2 offset:3072
  s_waitcnt lgkmcnt(0)
  v_min_u32 v64, -2, v64
  v_min_u32 v65, -2, v65
  v_min_u32 v66, -2, v66
  v_min_u32 v67, -2, v67
  v_min_u32 v68, -2, v68
  v_min_u32 v69, -2, v69
  v_min_u32 v70, -2, v70
  v_min_u32 v71, -2, v71
  v_min_u32 v72, -2, v72
  v_min_u32 v73, -2, v73
  v_min_u32 v74, -2, v74
  v_min_u32 v75, -2, v75
  v_min_u32 v76, -2, v76
  v_min_u32 v77, -2, v77
  v_min_u32 v78, -2, v78
  v_min_u32 v79, -2, v79
  buffer_store_dwordx4 v[64:67], v2, s[8:11], s33 offen offset:0 sc1
  buffer_store_dwordx4 v[68:71], v2, s[8:11], s33 offen offset:2048 sc1
  s_add_u32 s33, s33, 4096
  buffer_store_dwordx4 v[72:75], v2, s[8:11], s33 offen offset:0 sc1
  buffer_store_dwordx4 v[76:79], v2, s[8:11], s33 offen offset:2048 sc1
  s_add_u32 s33, s33, 4096
  s_cmp_lg_u32 s17, 0
  s_cbranch_scc1 cA_done
  s_waitcnt vmcnt(0)
  buffer_wbl2 sc1
  s_branch cA_done
cA_va0_rp:
  s_cmp_eq_u32 s37, 0
  s_cbranch_scc1 cA_va0_rv
  v_min_u32 v160, -2, v160
  buffer_store_dword v160, v1, s[8:11], s21 offen
  s_branch cA_va0_cont
cA_va0_rv:
  s_add_u32 s31, s31, 0x10000
  buffer_load_dwordx4 v[8:11], v2, s[8:11], s72 offen offset:0 sc1
  buffer_load_dwordx4 v[12:15], v2, s[8:11], s72 offen offset:1024 sc1
  buffer_load_dwordx4 v[16:19], v2, s[8:11], s73 offen offset:0 sc1
  buffer_load_dwordx4 v[20:23], v2, s[8:11], s73 offen offset:1024 sc1
  buffer_load_dwordx4 v[24:27], v2, s[8:11], s74 offen offset:0 sc1
  buffer_load_dwordx4 v[28:31], v2, s[8:11], s74 offen offset:1024 sc1
  buffer_load_dwordx4 v[32:35], v2, s[8:11], s75 offen offset:0 sc1
  buffer_load_dwordx4 v[36:39], v2, s[8:11], s75 offen offset:1024 sc1
  buffer_load_dwordx4 v[40:43], v2, s[8:11], s36 offen offset:0 sc1
  buffer_load_dwordx4 v[44:47], v2, s[8:11], s36 offen offset:1024 sc1
  s_waitcnt vmcnt(0)
  v_max3_u32 v52, v8, v9, v10
  v_max3_u32 v52, v52, v11, v12
  v_max3_u32 v52, v52, v13, v14
  v_max3_u32 v52, v52, v15, v16
  v_max3_u32 v52, v52, v17, v18
  v_max3_u32 v52, v52, v19, v20
  v_max3_u32 v52, v52, v21, v22
  v_max3_u32 v52, v52, v23, v24
  v_max3_u32 v52, v52, v25, v26
  v_max3_u32 v52, v52, v27, v28
  v_max3_u32 v52, v52, v29, v30
  v_max3_u32 v52, v52, v31, v32
  v_max3_u32 v52, v52, v33, v34
  v_max3_u32 v52, v52, v35, v36
  v_max3_u32 v52, v52, v37, v38
  v_max3_u32 v52, v52, v39, v40
  v_max3_u32 v52, v52, v41, v42
  v_max3_u32 v52, v52, v43, v44
  v_max3_u32 v52, v52, v45, v46
  v_max_u32 v52, v52, v47
  v_cmp_eq_u32 vcc, -1, v52
  s_mov_b32 s37, 1
  v_mov_b32 v48, 0
  v_mov_b32 v49, 0
  v_mov_b32 v50, 0
  v_mov_b32 v51, 0
  s_nop 1
  s_cbranch_vccz cA_va0_lp
  s_add_u32 s30, s30, 1
  s_cmp_lt_u32 s30, 400000
  s_cbranch_scc1 cA_va0_rv
  s_branch cA_abort
.p2align 6
cA_va1_loop:
  s_mov_b32 s30, 0
  s_barrier
  buffer_load_dwordx4 v[28:31], v2, s[8:11], s23 offen offset:1024 sc1
  buffer_load_dwordx4 v[32:35], v2, s[8:11], s23 offen offset:2048 sc1
  s_barrier
  s_cmp_lt_u32 s19, 60
  s_cbranch_scc1 cA_va1_m1
  buffer_store_dword v160, v1, s[8:11], s38 offen sc1
  s_cmp_lg_u32 s19, 63
  s_cbranch_scc1 cA_va1_m2
  v_min_u32 v64, -2, v64
  v_min_u32 v65, -2, v65
  v_min_u32 v66, -2, v66
  v_min_u32 v67, -2, v67
  v_min_u32 v68, -2, v68
  v_min_u32 v69, -2, v69
  v_min_u32 v70, -2, v70
  v_min_u32 v71, -2, v71
  v_min_u32 v72, -2, v72
  v_min_u32 v73, -2, v73
  v_min_u32 v74, -2, v74
  v_min_u32 v75, -2, v75
  v_min_u32 v76, -2, v76
  v_min_u32 v77, -2, v77
  v_min_u32 v78, -2, v78
  v_min_u32 v79, -2, v79
  buffer_store_dwordx4 v[64:67], v2, s[8:11], s33 offen offset:0 sc1
  buffer_store_dwordx4 v[68:71], v2, s[8:11], s33 offen offset:2048 sc1
  s_add_u32 s33, s33, 4096
  buffer_store_dwordx4 v[72:75], v2, s[8:11], s33 offen offset:0 sc1
  buffer_store_dwordx4 v[76:79], v2, s[8:11], s33 offen offset:2048 sc1
  s_add_u32 s33, s33, 4096
  s_waitcnt vmcnt(5)
  s_branch cA_va1_m3
cA_va1_m1:
  buffer_store_dword v160, v1, s[8:11], s38 offen nt
cA_va1_m2:
  s_add_u32 s22, s25, s80
  buffer_load_dwordx4 v[80:83], v6, s[8:11], s22 offen offset:0 sc1
  buffer_load_dwordx4 v[84:87], v6, s[8:11], s22 offen offset:1792 sc1
  s_add_u32 s22, s22, 3584
  buffer_load_dwordx4 v[88:91], v6, s[8:11], s22 offen offset:0 sc1
  buffer_load_dwordx4 v[92:95], v6, s[8:11], s22 offen offset:1792 sc1
  s_add_u32 s22, s25, s81
  buffer_load_dwordx4 v[96:99], v6, s[8:11], s22 offen offset:0 sc1
  s_mul_i32 s38, s18, 7168
  s_add_u32 s38, s38, 65536
  s_waitcnt vmcnt(6)
cA_va1_m3:
  ds_write_b128 v2, v[32:35] offset:14336
  v_smfmac_f32_16x16x64_bf16 v[36:39], v[28:31], a[40:47], v3
  buffer_load_dwordx4 v[100:103], v6, s[8:11], s22 offen offset:1792 sc1
  v_smfmac_f32_16x16x64_bf16 v[40:43], v[28:31], a[96:103], v3
  s_add_u32 s22, s22, 3584
  buffer_load_dwordx4 v[104:107], v6, s[8:11], s22 offen offset:0 sc1
  v_smfmac_f32_16x16x64_bf16 v[44:47], v[28:31], a[152:159], v3
  buffer_load_dwordx4 v[108:111], v6, s[8:11], s22 offen offset:1792 sc1
  v_smfmac_f32_16x16x64_bf16 v[48:51], v[28:31], a[208:215], v3
  s_add_u32 s22, s25, s82
  buffer_load_dwordx4 v[112:115], v6, s[8:11], s22 offen offset:0 sc1
  v_smfmac_f32_16x16x64_bf16 v[52:55], v[28:31], v[184:191], v3
  s_waitcnt lgkmcnt(0)
  s_barrier
  ds_read_b128 v[8:11], v2 offset:8192
  ds_read_b128 v[12:15], v2 offset:9216
  ds_read_b128 v[16:19], v2 offset:10240
  ds_read_b128 v[20:23], v2 offset:11264
  ds_read_b128 v[24:27], v2 offset:12288
  buffer_load_dwordx4 v[116:119], v6, s[8:11], s22 offen offset:1792 sc1
  v_smfmac_f32_16x16x64_bf16 v[56:59], v[28:31], v[240:247], v3
  s_add_u32 s22, s22, 3584
  buffer_load_dwordx4 v[120:123], v6, s[8:11], s22 offen offset:0 sc1
  v_smfmac_f32_16x16x64_bf16 v[36:39], v[32:35], a[48:55], v3
  buffer_load_dwordx4 v[124:127], v6, s[8:11], s22 offen offset:1792 sc1
  v_smfmac_f32_16x16x64_bf16 v[40:43], v[32:35], a[104:111], v3
  s_add_u32 s22, s25, s83
  buffer_load_dwordx4 v[128:131], v6, s[8:11], s22 offen offset:0 sc1
  v_smfmac_f32_16x16x64_bf16 v[44:47], v[32:35], a[160:167], v3
  buffer_load_dwordx4 v[132:135], v6, s[8:11], s22 offen offset:1792 sc1
  v_smfmac_f32_16x16x64_bf16 v[48:51], v[32:35], a[216:223], v3
  s_add_u32 s22, s22, 3584
  buffer_load_dwordx4 v[136:139], v6, s[8:11], s22 offen offset:0 sc1
  v_smfmac_f32_16x16x64_bf16 v[52:55], v[32:35], v[192:199], v3
  ds_read_b128 v[64:67], v0 offset:0
  ds_read_b128 v[68:71], v0 offset:1024
  buffer_load_dwordx4 v[140:143], v6, s[8:11], s22 offen offset:1792 sc1
  v_smfmac_f32_16x16x64_bf16 v[56:59], v[32:35], v[248:255], v3
  s_waitcnt lgkmcnt(6)
  ds_read_b128 v[72:75], v0 offset:2048
  ds_read_b128 v[76:79], v0 offset:3072
  v_smfmac_f32_16x16x64_bf16 v[36:39], v[8:11], a[0:7], v3
  s_waitcnt lgkmcnt(7)
  v_smfmac_f32_16x16x64_bf16 v[36:39], v[12:15], a[8:15], v3
  s_waitcnt lgkmcnt(6)
  v_smfmac_f32_16x16x64_bf16 v[36:39], v[16:19], a[16:23], v3
  s_waitcnt lgkmcnt(2)
  v_smfmac_f32_16x16x64_bf16 v[60:63], v[8:11], v[64:71], v3
  s_waitcnt lgkmcnt(5)
  ds_read_b128 v[144:147], v0 offset:4096
  ds_read_b128 v[148:151], v0 offset:5120
  v_smfmac_f32_16x16x64_bf16 v[36:39], v[20:23], a[24:31], v3
  s_waitcnt lgkmcnt(6)
  v_smfmac_f32_16x16x64_bf16 v[36:39], v[24:27], a[32:39], v3
  v_smfmac_f32_16x16x64_bf16 v[40:43], v[8:11], a[56:63], v3
  s_waitcnt lgkmcnt(2)
  v_smfmac_f32_16x16x64_bf16 v[60:63], v[12:15], v[72:79], v3
  ds_read_b128 v[64:67], v0 offset:6144
  ds_read_b128 v[68:71], v0 offset:7168
  v_smfmac_f32_16x16x64_bf16 v[40:43], v[12:15], a[64:71], v3
  v_permlane32_swap_b32 v36, v38
  v_smfmac_f32_16x16x64_bf16 v[40:43], v[16:19], a[72:79], v3
  v_permlane32_swap_b32 v37, v39
  v_smfmac_f32_16x16x64_bf16 v[40:43], v[20:23], a[80:87], v3
  s_waitcnt lgkmcnt(2)
  v_add_f32 v36, v36, v38
  v_smfmac_f32_16x16x64_bf16 v[60:63], v[16:19], v[144:151], v3
  ds_read_b128 v[72:75], v0 offset:8192
  ds_read_b128 v[76:79], v0 offset:9216
  v_add_f32 v37, v37, v39
  v_smfmac_f32_16x16x64_bf16 v[40:43], v[24:27], a[88:95], v3
  v_cmp_u_f32 vcc, v36, v37
  v_smfmac_f32_16x16x64_bf16 v[44:47], v[8:11], a[112:119], v3
  v_cvt_pk_bf16_f32 v38, v36, v37
  v_smfmac_f32_16x16x64_bf16 v[44:47], v[12:15], a[120:127], v3
  ds_write_b32 v152, v38
  s_waitcnt lgkmcnt(3)
  s_cbranch_vccnz cA_va1_slow
  v_permlane32_swap_b32 v40, v42
  v_smfmac_f32_16x16x64_bf16 v[60:63], v[20:23], v[64:71], v3
  ds_read_b128 v[144:147], v0 offset:10240
  ds_read_b128 v[148:151], v0 offset:11264
  v_permlane32_swap_b32 v41, v43
  v_smfmac_f32_16x16x64_bf16 v[44:47], v[16:19], a[128:135], v3
  buffer_store_dword v162, v1, s[8:11], s21 offen
  v_add_f32 v40, v40, v42
  v_smfmac_f32_16x16x64_bf16 v[44:47], v[20:23], a[136:143], v3
  v_add_f32 v41, v41, v43
  v_smfmac_f32_16x16x64_bf16 v[44:47], v[24:27], a[144:151], v3
  s_waitcnt lgkmcnt(3)
  v_cvt_pk_bf16_f32 v42, v40, v41
  v_smfmac_f32_16x16x64_bf16 v[60:63], v[24:27], v[72:79], v3
  ds_write_b32 v153, v42
  ds_read_b128 v[64:67], v0 offset:12288
  ds_read_b128 v[68:71], v0 offset:13312
  v_smfmac_f32_16x16x64_bf16 v[48:51], v[8:11], a[168:175], v3
  s_nop 0
  v_permlane32_swap_b32 v44, v46
  v_smfmac_f32_16x16x64_bf16 v[48:51], v[12:15], a[176:183], v3
  v_permlane32_swap_b32 v45, v47
  v_smfmac_f32_16x16x64_bf16 v[48:51], v[16:19], a[184:191], v3
  s_waitcnt lgkmcnt(3)
  v_add_f32 v44, v44, v46
  v_smfmac_f32_16x16x64_bf16 v[60:63], v[28:31], v[144:151], v3
  v_add_f32 v45, v45, v47
  v_smfmac_f32_16x16x64_bf16 v[48:51], v[20:23], a[192:199], v3
  v_cvt_pk_bf16_f32 v46, v44, v45
  v_smfmac_f32_16x16x64_bf16 v[48:51], v[24:27], a[200:207], v3
  ds_write_b32 v154, v46
  v_smfmac_f32_16x16x64_bf16 v[52:55], v[8:11], a[224:231], v3
  s_waitcnt lgkmcnt(1)
  v_smfmac_f32_16x16x64_bf16 v[60:63], v[32:35], v[64:71], v3
  v_smfmac_f32_16x16x64_bf16 v[52:55], v[12:15], a[232:239], v3
  v_permlane32_swap_b32 v48, v50
  v_smfmac_f32_16x16x64_bf16 v[52:55], v[16:19], a[240:247], v3
  v_permlane32_swap_b32 v49, v51
  v_smfmac_f32_16x16x64_bf16 v[52:55], v[20:23], a[248:255], v3
  v_add_f32 v48, v48, v50
  v_smfmac_f32_16x16x64_bf16 v[52:55], v[24:27], v[176:183], v3
  v_add_f32 v49, v49, v51
  v_smfmac_f32_16x16x64_bf16 v[56:59], v[8:11], v[200:207], v3
  v_cvt_pk_bf16_f32 v50, v48, v49
  v_smfmac_f32_16x16x64_bf16 v[56:59], v[12:15], v[208:215], v3
  ds_write_b32 v155, v50
  v_permlane32_swap_b32 v60, v62
  v_smfmac_f32_16x16x64_bf16 v[56:59], v[16:19], v[216:223], v3
  v_permlane32_swap_b32 v61, v63
  v_smfmac_f32_16x16x64_bf16 v[56:59], v[20:23], v[224:231], v3
  v_add_f32 v60, v60, v62
  v_smfmac_f32_16x16x64_bf16 v[56:59], v[24:27], v[232:239], v3
  v_add_f32 v61, v61, v63
  v_cvt_pk_bf16_f32 v62, v60, v61
  ds_write_b32 v158, v62
  v_permlane32_swap_b32 v52, v54
  v_permlane32_swap_b32 v53, v55
  v_add_f32 v52, v52, v54
  v_add_f32 v53, v53, v55
  v_cvt_pk_bf16_f32 v54, v52, v53
  ds_write_b32 v156, v54
  v_permlane32_swap_b32 v56, v58
  v_permlane32_swap_b32 v57, v59
  v_add_f32 v56, v56, v58
  v_add_f32 v57, v57, v59
  v_cvt_pk_bf16_f32 v58, v56, v57
  ds_write_b32 v157, v58
cA_va1_t2d:
  s_add_u32 s72, s20, s76
  s_add_u32 s73, s20, s77
  s_add_u32 s74, s20, s78
  s_add_u32 s75, s20, s79
  s_add_u32 s22, s20, 9216
  s_add_u32 s34, s20, 13312
  s_add_u32 s36, s20, 7168
  s_mov_b32 s37, 0
  v_mov_b32 v48, 0
  v_mov_b32 v49, 0
  v_mov_b32 v50, 0
  v_mov_b32 v51, 0
  v_mov_b32 v163, s18
  s_cmp_eq_u32 s19, 63
  s_waitcnt lgkmcnt(0)
  s_cbranch_scc1 cA_va1_last
  s_barrier
  buffer_load_dwordx4 v[8:11], v2, s[8:11], s72 offen offset:0 sc1
  buffer_load_dwordx4 v[12:15], v2, s[8:11], s72 offen offset:1024 sc1
  buffer_load_dwordx4 v[16:19], v2, s[8:11], s73 offen offset:0 sc1
  buffer_load_dwordx4 v[20:23], v2, s[8:11], s73 offen offset:1024 sc1
  buffer_load_dwordx4 v[24:27], v2, s[8:11], s74 offen offset:0 sc1
  buffer_load_dwordx4 v[28:31], v2, s[8:11], s74 offen offset:1024 sc1
  buffer_load_dwordx4 v[32:35], v2, s[8:11], s75 offen offset:0 sc1
  buffer_load_dwordx4 v[36:39], v2, s[8:11], s75 offen offset:1024 sc1
  buffer_load_dwordx4 v[40:43], v2, s[8:11], s36 offen offset:0 sc1
  buffer_load_dwordx4 v[44:47], v2, s[8:11], s36 offen offset:1024 sc1
  ds_read_b128 v[64:67], v2 offset:4096
  ds_read_b128 v[68:71], v2 offset:5120
  ds_read_b128 v[72:75], v2 offset:6144
  ds_read_b128 v[76:79], v2 offset:7168
cA_va1_lp:
  s_waitcnt vmcnt(9)
  v_smfmac_f32_16x16x64_bf16 v[48:51], v[8:11], v[80:87], v3
  s_waitcnt vmcnt(8)
  v_smfmac_f32_16x16x64_bf16 v[48:51], v[12:15], v[88:95], v3
  s_waitcnt vmcnt(7)
  v_smfmac_f32_16x16x64_bf16 v[48:51], v[16:19], v[96:103], v3
  v_max3_u32 v55, v8, v12, v16
  s_waitcnt vmcnt(6)
  v_smfmac_f32_16x16x64_bf16 v[48:51], v[20:23], v[104:111], v3
  s_waitcnt vmcnt(5)
  v_smfmac_f32_16x16x64_bf16 v[48:51], v[24:27], v[112:119], v3
  v_max3_u32 v55, v55, v20, v24
  s_waitcnt vmcnt(4)
  v_smfmac_f32_16x16x64_bf16 v[48:51], v[28:31], v[120:127], v3
  v_max_u32 v55, v55, v28
  v_cmp_eq_u32 vcc, -1, v55
  s_waitcnt vmcnt(3)
  v_smfmac_f32_16x16x64_bf16 v[48:51], v[32:35], v[128:135], v3
  s_waitcnt vmcnt(2)
  v_smfmac_f32_16x16x64_bf16 v[48:51], v[36:39], v[136:143], v3
  s_cbranch_vccnz cA_va1_rv
  buffer_store_dword v163, v7, s[8:11], 0 offen
  s_waitcnt vmcnt(2) lgkmcnt(0)
  v_smfmac_f32_16x16x64_bf16 v[48:51], v[40:43], v[64:71], v3
  s_waitcnt vmcnt(1)
  v_smfmac_f32_16x16x64_bf16 v[48:51], v[44:47], v[72:79], v3
  s_nop 7
  v_permlane32_swap_b32 v48, v50
  v_permlane32_swap_b32 v49, v51
  v_pk_add_f32 v[48:49], v[48:49], v[50:51]
  v_cvt_pk_bf16_f32 v160, v48, v49
  v_cmp_u_f32 vcc, v48, v49
  s_nop 0
  v_mov_b32_dpp v161, v160 quad_perm:[1,0,3,2] row_mask:0xf bank_mask:0xf
  v_perm_b32 v160, v161, v160, v5
  v_cndmask_b32 v161, v160, v162, vcc
  buffer_store_dword v161, v1, s[8:11], s21 offen
  s_cbranch_vccnz cA_va1_rp
cA_va1_cont:
  s_cmp_lg_u32 s19, 62
  s_cbranch_scc1 cA_va1_nl
  s_mov_b32 s25, 0x40000000
cA_va1_nl:
  s_add_u32 s25, s25, 458752
  v_mov_b32 v36, 0
  v_mov_b32 v37, 0
  v_mov_b32 v38, 0
  v_mov_b32 v39, 0
  v_mov_b32 v40, 0
  v_mov_b32 v41, 0
  v_mov_b32 v42, 0
  v_mov_b32 v43, 0
  v_mov_b32 v44, 0
  v_mov_b32 v45, 0
  v_mov_b32 v46, 0
  v_mov_b32 v47, 0
  v_mov_b32 v48, 0
  v_mov_b32 v49, 0
  v_mov_b32 v50, 0
  v_mov_b32 v51, 0
  v_mov_b32 v52, 0
  v_mov_b32 v53, 0
  v_mov_b32 v54, 0
  v_mov_b32 v55, 0
  v_mov_b32 v56, 0
  v_mov_b32 v57, 0
  v_mov_b32 v58, 0
  v_mov_b32 v59, 0
  v_mov_b32 v60, 0
  v_mov_b32 v61, 0
  v_mov_b32 v62, 0
  v_mov_b32 v63, 0
  s_mov_b32 s19, s18
  s_add_u32 s18, s18, 1
  s_mov_b32 s22, s20
  s_mov_b32 s20, s21
  s_mov_b32 s21, s22
  s_add_u32 s23, s20, 4096
  s_branch cA_va1_loop
cA_va1_slow:
  s_waitcnt lgkmcnt(0)
cA_va1_sl1:
  s_add_u32 s31, s31, 0x1000000
  buffer_load_dwordx4 v[8:11], v2, s[8:11], s20 offen offset:0 sc1
  buffer_load_dwordx4 v[12:15], v2, s[8:11], s20 offen offset:1024 sc1
  buffer_load_dwordx4 v[16:19], v2, s[8:11], s20 offen offset:2048 sc1
  buffer_load_dwordx4 v[20:23], v2, s[8:11], s20 offen offset:3072 sc1
  buffer_load_dwordx4 v[24:27], v2, s[8:11], s23 offen offset:0 sc1
  buffer_load_dwordx4 v[28:31], v2, s[8:11], s23 offen offset:1024 sc1
  buffer_load_dwordx4 v[32:35], v2, s[8:11], s23 offen offset:2048 sc1
  s_waitcnt vmcnt(0)
  v_max3_u32 v36, v8, v9, v10
  v_max3_u32 v36, v36, v11, v12
  v_max3_u32 v36, v36, v13, v14
  v_max3_u32 v36, v36, v15, v16
  v_max3_u32 v36, v36, v17, v18
  v_max3_u32 v36, v36, v19, v20
  v_max3_u32 v36, v36, v21, v22
  v_max3_u32 v36, v36, v23, v24
  v_max3_u32 v36, v36, v25, v26
  v_max3_u32 v36, v36, v27, v28
  v_max3_u32 v36, v36, v29, v30
  v_max3_u32 v36, v36, v31, v32
  v_max3_u32 v36, v36, v33, v34
  v_max_u32 v36, v36, v35
  v_cmp_eq_u32 vcc, -1, v36
  s_cbranch_vccz cA_va1_sl2
  s_add_u32 s30, s30, 1
  s_cmp_lt_u32 s30, 400000
  s_cbranch_scc1 cA_va1_sl1
  s_branch cA_abort
cA_va1_sl2:
  v_mov_b32 v36, 0
  v_mov_b32 v37, 0
  v_mov_b32 v38, 0
  v_mov_b32 v39, 0
  v_mov_b32 v40, 0
  v_mov_b32 v41, 0
  v_mov_b32 v42, 0
  v_mov_b32 v43, 0
  v_mov_b32 v44, 0
  v_mov_b32 v45, 0
  v_mov_b32 v46, 0
  v_mov_b32 v47, 0
  v_mov_b32 v48, 0
  v_mov_b32 v49, 0
  v_mov_b32 v50, 0
  v_mov_b32 v51, 0
  v_mov_b32 v52, 0
  v_mov_b32 v53, 0
  v_mov_b32 v54, 0
  v_mov_b32 v55, 0
  v_mov_b32 v56, 0
  v_mov_b32 v57, 0
  v_mov_b32 v58, 0
  v_mov_b32 v59, 0
  v_mov_b32 v60, 0
  v_mov_b32 v61, 0
  v_mov_b32 v62, 0
  v_mov_b32 v63, 0
  buffer_store_dword v162, v1, s[8:11], s21 offen
  ds_read_b128 v[64:67], v0 offset:0
  ds_read_b128 v[68:71], v0 offset:1024
  v_smfmac_f32_16x16x64_bf16 v[36:39], v[8:11], a[0:7], v3
  v_smfmac_f32_16x16x64_bf16 v[40:43], v[8:11], a[56:63], v3
  v_smfmac_f32_16x16x64_bf16 v[44:47], v[8:11], a[112:119], v3
  v_smfmac_f32_16x16x64_bf16 v[48:51], v[8:11], a[168:175], v3
  v_smfmac_f32_16x16x64_bf16 v[52:55], v[8:11], a[224:231], v3
  v_smfmac_f32_16x16x64_bf16 v[56:59], v[8:11], v[200:207], v3
  s_waitcnt lgkmcnt(0)
  v_smfmac_f32_16x16x64_bf16 v[60:63], v[8:11], v[64:71], v3
  ds_read_b128 v[72:75], v0 offset:2048
  ds_read_b128 v[76:79], v0 offset:3072
  v_smfmac_f32_16x16x64_bf16 v[36:39], v[12:15], a[8:15], v3
  v_smfmac_f32_16x16x64_bf16 v[40:43], v[12:15], a[64:71], v3
  v_smfmac_f32_16x16x64_bf16 v[44:47], v[12:15], a[120:127], v3
  v_smfmac_f32_16x16x64_bf16 v[48:51], v[12:15], a[176:183], v3
  v_smfmac_f32_16x16x64_bf16 v[52:55], v[12:15], a[232:239], v3
  v_smfmac_f32_16x16x64_bf16 v[56:59], v[12:15], v[208:215], v3
  s_waitcnt lgkmcnt(0)
  v_smfmac_f32_16x16x64_bf16 v[60:63], v[12:15], v[72:79], v3
  ds_read_b128 v[144:147], v0 offset:4096
  ds_read_b128 v[148:151], v0 offset:5120
  v_smfmac_f32_16x16x64_bf16 v[36:39], v[16:19], a[16:23], v3
  v_smfmac_f32_16x16x64_bf16 v[40:43], v[16:19], a[72:79], v3
  v_smfmac_f32_16x16x64_bf16 v[44:47], v[16:19], a[128:135], v3
  v_smfmac_f32_16x16x64_bf16 v[48:51], v[16:19], a[184:191], v3
  v_smfmac_f32_16x16x64_bf16 v[52:55], v[16:19], a[240:247], v3
  v_smfmac_f32_16x16x64_bf16 v[56:59], v[16:19], v[216:223], v3
  s_waitcnt lgkmcnt(0)
  v_smfmac_f32_16x16x64_bf16 v[60:63], v[16:19], v[144:151], v3
  ds_read_b128 v[64:67], v0 offset:6144
  ds_read_b128 v[68:71], v0 offset:7168
  v_smfmac_f32_16x16x64_bf16 v[36:39], v[20:23], a[24:31], v3
  v_smfmac_f32_16x16x64_bf16 v[40:43], v[20:23], a[80:87], v3
  v_smfmac_f32_16x16x64_bf16 v[44:47], v[20:23], a[136:143], v3
  v_smfmac_f32_16x16x64_bf16 v[48:51], v[20:23], a[192:199], v3
  v_smfmac_f32_16x16x64_bf16 v[52:55], v[20:23], a[248:255], v3
  v_smfmac_f32_16x16x64_bf16 v[56:59], v[20:23], v[224:231], v3
  s_waitcnt lgkmcnt(0)
  v_smfmac_f32_16x16x64_bf16 v[60:63], v[20:23], v[64:71], v3
  ds_read_b128 v[72:75], v0 offset:8192
  ds_read_b128 v[76:79], v0 offset:9216
  v_smfmac_f32_16x16x64_bf16 v[36:39], v[24:27], a[32:39], v3
  v_smfmac_f32_16x16x64_bf16 v[40:43], v[24:27], a[88:95], v3
  v_smfmac_f32_16x16x64_bf16 v[44:47], v[24:27], a[144:151], v3
  v_smfmac_f32_16x16x64_bf16 v[48:51], v[24:27], a[200:207], v3
  v_smfmac_f32_16x16x64_bf16 v[52:55], v[24:27], v[176:183], v3
  v_smfmac_f32_16x16x64_bf16 v[56:59], v[24:27], v[232:239], v3
  s_waitcnt lgkmcnt(0)
  v_smfmac_f32_16x16x64_bf16 v[60:63], v[24:27], v[72:79], v3
  ds_read_b128 v[144:147], v0 offset:10240
  ds_read_b128 v[148:151], v0 offset:11264
  v_smfmac_f32_16x16x64_bf16 v[36:39], v[28:31], a[40:47], v3
  v_smfmac_f32_16x16x64_bf16 v[40:43], v[28:31], a[96:103], v3
  v_smfmac_f32_16x16x64_bf16 v[44:47], v[28:31], a[152:159], v3
  v_smfmac_f32_16x16x64_bf16 v[48:51], v[28:31], a[208:215], v3
  v_smfmac_f32_16x16x64_bf16 v[52:55], v[28:31], v[184:191], v3
  v_smfmac_f32_16x16x64_bf16 v[56:59], v[28:31], v[240:247], v3
  s_waitcnt lgkmcnt(0)
  v_smfmac_f32_16x16x64_bf16 v[60:63], v[28:31], v[144:151], v3
  ds_read_b128 v[64:67], v0 offset:12288
  ds_read_b128 v[68:71], v0 offset:13312
  v_smfmac_f32_16x16x64_bf16 v[36:39], v[32:35], a[48:55], v3
  v_smfmac_f32_16x16x64_bf16 v[40:43], v[32:35], a[104:111], v3
  v_smfmac_f32_16x16x64_bf16 v[44:47], v[32:35], a[160:167], v3
  v_smfmac_f32_16x16x64_bf16 v[48:51], v[32:35], a[216:223], v3
  v_smfmac_f32_16x16x64_bf16 v[52:55], v[32:35], v[192:199], v3
  v_smfmac_f32_16x16x64_bf16 v[56:59], v[32:35], v[248:255], v3
  s_waitcnt lgkmcnt(0)
  v_smfmac_f32_16x16x64_bf16 v[60:63], v[32:35], v[64:71], v3
  v_permlane32_swap_b32 v36, v38
  v_permlane32_swap_b32 v37, v39
  v_add_f32 v36, v36, v38
  v_add_f32 v37, v37, v39
  v_cvt_pk_bf16_f32 v38, v36, v37
  ds_write_b32 v152, v38
  v_permlane32_swap_b32 v40, v42
  v_permlane32_swap_b32 v41, v43
  v_add_f32 v40, v40, v42
  v_add_f32 v41, v41, v43
  v_cvt_pk_bf16_f32 v42, v40, v41
  ds_write_b32 v153, v42
  v_permlane32_swap_b32 v44, v46
  v_permlane32_swap_b32 v45, v47
  v_add_f32 v44, v44, v46
  v_add_f32 v45, v45, v47
  v_cvt_pk_bf16_f32 v46, v44, v45
  ds_write_b32 v154, v46
  v_permlane32_swap_b32 v48, v50
  v_permlane32_swap_b32 v49, v51
  v_add_f32 v48, v48, v50
  v_add_f32 v49, v49, v51
  v_cvt_pk_bf16_f32 v50, v48, v49
  ds_write_b32 v155, v50
  v_permlane32_swap_b32 v52, v54
  v_permlane32_swap_b32 v53, v55
  v_add_f32 v52, v52, v54
  v_add_f32 v53, v53, v55
  v_cvt_pk_bf16_f32 v54, v52, v53
  ds_write_b32 v156, v54
  v_permlane32_swap_b32 v56, v58
  v_permlane32_swap_b32 v57, v59
  v_add_f32 v56, v56, v58
  v_add_f32 v57, v57, v59
  v_cvt_pk_bf16_f32 v58, v56, v57
  ds_write_b32 v157, v58
  v_permlane32_swap_b32 v60, v62
  v_permlane32_swap_b32 v61, v63
  v_add_f32 v60, v60, v62
  v_add_f32 v61, v61, v63
  v_cvt_pk_bf16_f32 v62, v60, v61
  ds_write_b32 v158, v62
  s_branch cA_va1_t2d
cA_va1_last:
  s_barrier
  ds_read_b128 v[64:67], v2 offset:4096
  ds_read_b128 v[68:71], v2 offset:5120
  ds_read_b128 v[72:75], v2 offset:6144
  ds_read_b128 v[76:79], v2 offset:7168
  s_waitcnt lgkmcnt(0)
  v_min_u32 v64, -2, v64
  v_min_u32 v65, -2, v65
  v_min_u32 v66, -2, v66
  v_min_u32 v67, -2, v67
  v_min_u32 v68, -2, v68
  v_min_u32 v69, -2, v69
  v_min_u32 v70, -2, v70
  v_min_u32 v71, -2, v71
  v_min_u32 v72, -2, v72
  v_min_u32 v73, -2, v73
  v_min_u32 v74, -2, v74
  v_min_u32 v75, -2, v75
  v_min_u32 v76, -2, v76
  v_min_u32 v77, -2, v77
  v_min_u32 v78, -2, v78
  v_min_u32 v79, -2, v79
  buffer_store_dwordx4 v[64:67], v2, s[8:11], s33 offen offset:0 sc1
  buffer_store_dwordx4 v[68:71], v2, s[8:11], s33 offen offset:2048 sc1
  s_add_u32 s33, s33, 4096
  buffer_store_dwordx4 v[72:75], v2, s[8:11], s33 offen offset:0 sc1
  buffer_store_dwordx4 v[76:79], v2, s[8:11], s33 offen offset:2048 sc1
  s_add_u32 s33, s33, 4096
  s_branch cA_done
cA_va1_rp:
  s_cmp_eq_u32 s37, 0
  s_cbranch_scc1 cA_va1_rv
  v_min_u32 v160, -2, v160
  buffer_store_dword v160, v1, s[8:11], s21 offen
  s_branch cA_va1_cont
cA_va1_rv:
  s_add_u32 s31, s31, 0x10000
  buffer_load_dwordx4 v[8:11], v2, s[8:11], s72 offen offset:0 sc1
  buffer_load_dwordx4 v[12:15], v2, s[8:11], s72 offen offset:1024 sc1
  buffer_load_dwordx4 v[16:19], v2, s[8:11], s73 offen offset:0 sc1
  buffer_load_dwordx4 v[20:23], v2, s[8:11], s73 offen offset:1024 sc1
  buffer_load_dwordx4 v[24:27], v2, s[8:11], s74 offen offset:0 sc1
  buffer_load_dwordx4 v[28:31], v2, s[8:11], s74 offen offset:1024 sc1
  buffer_load_dwordx4 v[32:35], v2, s[8:11], s75 offen offset:0 sc1
  buffer_load_dwordx4 v[36:39], v2, s[8:11], s75 offen offset:1024 sc1
  buffer_load_dwordx4 v[40:43], v2, s[8:11], s36 offen offset:0 sc1
  buffer_load_dwordx4 v[44:47], v2, s[8:11], s36 offen offset:1024 sc1
  s_waitcnt vmcnt(0)
  v_max3_u32 v52, v8, v9, v10
  v_max3_u32 v52, v52, v11, v12
  v_max3_u32 v52, v52, v13, v14
  v_max3_u32 v52, v52, v15, v16
  v_max3_u32 v52, v52, v17, v18
  v_max3_u32 v52, v52, v19, v20
  v_max3_u32 v52, v52, v21, v22
  v_max3_u32 v52, v52, v23, v24
  v_max3_u32 v52, v52, v25, v26
  v_max3_u32 v52, v52, v27, v28
  v_max3_u32 v52, v52, v29, v30
  v_max3_u32 v52, v52, v31, v32
  v_max3_u32 v52, v52, v33, v34
  v_max3_u32 v52, v52, v35, v36
  v_max3_u32 v52, v52, v37, v38
  v_max3_u32 v52, v52, v39, v40
  v_max3_u32 v52, v52, v41, v42
  v_max3_u32 v52, v52, v43, v44
  v_max3_u32 v52, v52, v45, v46
  v_max_u32 v52, v52, v47
  v_cmp_eq_u32 vcc, -1, v52
  s_mov_b32 s37, 1
  v_mov_b32 v48, 0
  v_mov_b32 v49, 0
  v_mov_b32 v50, 0
  v_mov_b32 v51, 0
  s_nop 1
  s_cbranch_vccz cA_va1_lp
  s_add_u32 s30, s30, 1
  s_cmp_lt_u32 s30, 400000
  s_cbranch_scc1 cA_va1_rv
  s_branch cA_abort
.p2align 6
cA_va2_loop:
  s_mov_b32 s30, 0
cA_va2_fp_l:
  v_cmp_gt_u32 vcc, s19, v96
  buffer_load_dword v96, v119, s[8:11], 0 offen sc1
  s_cbranch_vccz cA_va2_fp_d
  v_cmp_gt_u32 vcc, s19, v96
  buffer_load_dword v96, v119, s[8:11], 0 offen sc1
  s_cbranch_vccz cA_va2_fp_d
  v_cmp_gt_u32 vcc, s19, v96
  buffer_load_dword v96, v119, s[8:11], 0 offen sc1
  s_cbranch_vccz cA_va2_fp_d
  v_cmp_gt_u32 vcc, s19, v96
  buffer_load_dword v96, v119, s[8:11], 0 offen sc1
  s_cbranch_vccz cA_va2_fp_d
  v_cmp_gt_u32 vcc, s19, v96
  buffer_load_dword v96, v119, s[8:11], 0 offen sc1
  s_cbranch_vccz cA_va2_fp_d
  v_cmp_gt_u32 vcc, s19, v96
  buffer_load_dword v96, v119, s[8:11], 0 offen sc1
  s_cbranch_vccz cA_va2_fp_d
  v_cmp_gt_u32 vcc, s19, v96
  buffer_load_dword v96, v119, s[8:11], 0 offen sc1
  s_cbranch_vccz cA_va2_fp_d
  v_cmp_gt_u32 vcc, s19, v96
  buffer_load_dword v96, v119, s[8:11], 0 offen sc1
  s_cbranch_vccz cA_va2_fp_d
  v_cmp_gt_u32 vcc, s19, v96
  buffer_load_dword v96, v119, s[8:11], 0 offen sc1
  s_cbranch_vccz cA_va2_fp_d
  v_cmp_gt_u32 vcc, s19, v96
  buffer_load_dword v96, v119, s[8:11], 0 offen sc1
  s_cbranch_vccz cA_va2_fp_d
  v_cmp_gt_u32 vcc, s19, v96
  buffer_load_dword v96, v119, s[8:11], 0 offen sc1
  s_cbranch_vccz cA_va2_fp_d
  v_cmp_gt_u32 vcc, s19, v96
  buffer_load_dword v96, v119, s[8:11], 0 offen sc1
  s_cbranch_vccz cA_va2_fp_d
  v_cmp_gt_u32 vcc, s19, v96
  buffer_load_dword v96, v119, s[8:11], 0 offen sc1
  s_cbranch_vccz cA_va2_fp_d
  v_cmp_gt_u32 vcc, s19, v96
  buffer_load_dword v96, v119, s[8:11], 0 offen sc1
  s_cbranch_vccz cA_va2_fp_d
  v_cmp_gt_u32 vcc, s19, v96
  buffer_load_dword v96, v119, s[8:11], 0 offen sc1
  s_cbranch_vccz cA_va2_fp_d
  v_cmp_gt_u32 vcc, s19, v96
  buffer_load_dword v96, v119, s[8:11], 0 offen sc1
  s_cbranch_vccz cA_va2_fp_d
  s_waitcnt vmcnt(24)
  s_add_u32 s30, s30, 1
  s_cmp_lt_u32 s30, 400000
  s_cbranch_scc1 cA_va2_fp_l
  s_branch cA_abort
cA_va2_fp_d:
  buffer_load_dwordx4 v[8:11], v2, s[8:11], s20 offen offset:0 sc1
  buffer_load_dwordx4 v[12:15], v2, s[8:11], s20 offen offset:1024 sc1
  s_barrier
  s_barrier
  s_waitcnt vmcnt(0)
  ds_write_b128 v2, v[8:11] offset:8192
  ds_write_b128 v2, v[12:15] offset:9216
  v_smfmac_f32_16x16x64_bf16 v[36:39], v[8:11], a[0:7], v3
  v_smfmac_f32_16x16x64_bf16 v[40:43], v[8:11], a[56:63], v3
  v_smfmac_f32_16x16x64_bf16 v[44:47], v[8:11], a[112:119], v3
  v_smfmac_f32_16x16x64_bf16 v[48:51], v[8:11], a[168:175], v3
  v_smfmac_f32_16x16x64_bf16 v[52:55], v[8:11], a[224:231], v3
  s_waitcnt lgkmcnt(0)
  s_barrier
  ds_read_b128 v[16:19], v2 offset:10240
  ds_read_b128 v[20:23], v2 offset:11264
  ds_read_b128 v[24:27], v2 offset:12288
  ds_read_b128 v[28:31], v2 offset:13312
  ds_read_b128 v[32:35], v2 offset:14336
  v_smfmac_f32_16x16x64_bf16 v[56:59], v[8:11], v[144:151], v3
  v_smfmac_f32_16x16x64_bf16 v[60:63], v[8:11], v[200:207], v3
  v_smfmac_f32_16x16x64_bf16 v[36:39], v[12:15], a[8:15], v3
  v_smfmac_f32_16x16x64_bf16 v[40:43], v[12:15], a[64:71], v3
  v_smfmac_f32_16x16x64_bf16 v[44:47], v[12:15], a[120:127], v3
  v_smfmac_f32_16x16x64_bf16 v[48:51], v[12:15], a[176:183], v3
  v_smfmac_f32_16x16x64_bf16 v[52:55], v[12:15], a[232:239], v3
  v_smfmac_f32_16x16x64_bf16 v[56:59], v[12:15], v[152:159], v3
  ds_read_b128 v[68:71], v0 offset:0
  ds_read_b128 v[72:75], v0 offset:1024
  v_smfmac_f32_16x16x64_bf16 v[60:63], v[12:15], v[208:215], v3
  s_waitcnt lgkmcnt(6)
  ds_read_b128 v[76:79], v0 offset:2048
  ds_read_b128 v[80:83], v0 offset:3072
  v_smfmac_f32_16x16x64_bf16 v[36:39], v[16:19], a[16:23], v3
  s_waitcnt lgkmcnt(7)
  v_smfmac_f32_16x16x64_bf16 v[36:39], v[20:23], a[24:31], v3
  s_waitcnt lgkmcnt(6)
  v_smfmac_f32_16x16x64_bf16 v[36:39], v[24:27], a[32:39], v3
  s_waitcnt lgkmcnt(2)
  v_smfmac_f32_16x16x64_bf16 v[64:67], v[8:11], v[68:75], v3
  s_waitcnt lgkmcnt(5)
  ds_read_b128 v[84:87], v0 offset:4096
  ds_read_b128 v[88:91], v0 offset:5120
  v_smfmac_f32_16x16x64_bf16 v[36:39], v[28:31], a[40:47], v3
  s_waitcnt lgkmcnt(6)
  v_smfmac_f32_16x16x64_bf16 v[36:39], v[32:35], a[48:55], v3
  v_smfmac_f32_16x16x64_bf16 v[40:43], v[16:19], a[72:79], v3
  s_waitcnt lgkmcnt(2)
  v_smfmac_f32_16x16x64_bf16 v[64:67], v[12:15], v[76:83], v3
  ds_read_b128 v[68:71], v0 offset:6144
  ds_read_b128 v[72:75], v0 offset:7168
  v_smfmac_f32_16x16x64_bf16 v[40:43], v[20:23], a[80:87], v3
  v_permlane32_swap_b32 v36, v38
  v_smfmac_f32_16x16x64_bf16 v[40:43], v[24:27], a[88:95], v3
  v_permlane32_swap_b32 v37, v39
  v_smfmac_f32_16x16x64_bf16 v[40:43], v[28:31], a[96:103], v3
  s_waitcnt lgkmcnt(2)
  v_add_f32 v36, v36, v38
  v_smfmac_f32_16x16x64_bf16 v[64:67], v[16:19], v[84:91], v3
  ds_read_b128 v[76:79], v0 offset:8192
  ds_read_b128 v[80:83], v0 offset:9216
  v_add_f32 v37, v37, v39
  v_smfmac_f32_16x16x64_bf16 v[40:43], v[32:35], a[104:111], v3
  v_cmp_u_f32 vcc, v36, v37
  v_smfmac_f32_16x16x64_bf16 v[44:47], v[16:19], a[128:135], v3
  v_cvt_pk_bf16_f32 v38, v36, v37
  v_smfmac_f32_16x16x64_bf16 v[44:47], v[20:23], a[136:143], v3
  ds_write_b32 v104, v38
  s_waitcnt lgkmcnt(3)
  s_cbranch_vccnz cA_va2_slow
  v_permlane32_swap_b32 v40, v42
  v_smfmac_f32_16x16x64_bf16 v[64:67], v[20:23], v[68:75], v3
  ds_read_b128 v[84:87], v0 offset:10240
  ds_read_b128 v[88:91], v0 offset:11264
  v_permlane32_swap_b32 v41, v43
  v_smfmac_f32_16x16x64_bf16 v[44:47], v[24:27], a[144:151], v3
  v_add_f32 v40, v40, v42
  v_smfmac_f32_16x16x64_bf16 v[44:47], v[28:31], a[152:159], v3
  v_add_f32 v41, v41, v43
  v_smfmac_f32_16x16x64_bf16 v[44:47], v[32:35], a[160:167], v3
  s_waitcnt lgkmcnt(3)
  v_cvt_pk_bf16_f32 v42, v40, v41
  v_smfmac_f32_16x16x64_bf16 v[64:67], v[24:27], v[76:83], v3
  ds_write_b32 v105, v42
  ds_read_b128 v[68:71], v0 offset:12288
  ds_read_b128 v[72:75], v0 offset:13312
  v_smfmac_f32_16x16x64_bf16 v[48:51], v[16:19], a[184:191], v3
  s_nop 0
  v_permlane32_swap_b32 v44, v46
  v_smfmac_f32_16x16x64_bf16 v[48:51], v[20:23], a[192:199], v3
  v_permlane32_swap_b32 v45, v47
  v_smfmac_f32_16x16x64_bf16 v[48:51], v[24:27], a[200:207], v3
  s_waitcnt lgkmcnt(3)
  v_add_f32 v44, v44, v46
  v_smfmac_f32_16x16x64_bf16 v[64:67], v[28:31], v[84:91], v3
  v_add_f32 v45, v45, v47
  v_smfmac_f32_16x16x64_bf16 v[48:51], v[28:31], a[208:215], v3
  v_cvt_pk_bf16_f32 v46, v44, v45
  v_smfmac_f32_16x16x64_bf16 v[48:51], v[32:35], a[216:223], v3
  ds_write_b32 v106, v46
  v_smfmac_f32_16x16x64_bf16 v[52:55], v[16:19], a[240:247], v3
  s_waitcnt lgkmcnt(1)
  v_smfmac_f32_16x16x64_bf16 v[64:67], v[32:35], v[68:75], v3
  v_smfmac_f32_16x16x64_bf16 v[52:55], v[20:23], a[248:255], v3
  v_permlane32_swap_b32 v48, v50
  v_smfmac_f32_16x16x64_bf16 v[52:55], v[24:27], v[120:127], v3
  v_permlane32_swap_b32 v49, v51
  v_smfmac_f32_16x16x64_bf16 v[52:55], v[28:31], v[128:135], v3
  v_add_f32 v48, v48, v50
  v_smfmac_f32_16x16x64_bf16 v[52:55], v[32:35], v[136:143], v3
  v_add_f32 v49, v49, v51
  v_smfmac_f32_16x16x64_bf16 v[56:59], v[16:19], v[160:167], v3
  v_cvt_pk_bf16_f32 v50, v48, v49
  v_smfmac_f32_16x16x64_bf16 v[56:59], v[20:23], v[168:175], v3
  ds_write_b32 v107, v50
  v_permlane32_swap_b32 v64, v66
  v_smfmac_f32_16x16x64_bf16 v[56:59], v[24:27], v[176:183], v3
  v_permlane32_swap_b32 v65, v67
  v_smfmac_f32_16x16x64_bf16 v[56:59], v[28:31], v[184:191], v3
  v_add_f32 v64, v64, v66
  v_smfmac_f32_16x16x64_bf16 v[56:59], v[32:35], v[192:199], v3
  v_add_f32 v65, v65, v67
  v_smfmac_f32_16x16x64_bf16 v[60:63], v[16:19], v[216:223], v3
  v_cvt_pk_bf16_f32 v66, v64, v65
  v_smfmac_f32_16x16x64_bf16 v[60:63], v[20:23], v[224:231], v3
  ds_write_b32 v111, v66
  v_permlane32_swap_b32 v52, v54
  v_smfmac_f32_16x16x64_bf16 v[60:63], v[24:27], v[232:239], v3
  v_permlane32_swap_b32 v53, v55
  v_smfmac_f32_16x16x64_bf16 v[60:63], v[28:31], v[240:247], v3
  v_add_f32 v52, v52, v54
  v_smfmac_f32_16x16x64_bf16 v[60:63], v[32:35], v[248:255], v3
  v_add_f32 v53, v53, v55
  v_cvt_pk_bf16_f32 v54, v52, v53
  ds_write_b32 v108, v54
  v_permlane32_swap_b32 v56, v58
  v_permlane32_swap_b32 v57, v59
  v_add_f32 v56, v56, v58
  v_add_f32 v57, v57, v59
  v_cvt_pk_bf16_f32 v58, v56, v57
  ds_write_b32 v109, v58
  v_permlane32_swap_b32 v60, v62
  v_permlane32_swap_b32 v61, v63
  v_add_f32 v60, v60, v62
  v_add_f32 v61, v61, v63
  v_cvt_pk_bf16_f32 v62, v60, v61
  ds_write_b32 v110, v62
cA_va2_t2d:
  v_mov_b32 v117, s18
  s_waitcnt lgkmcnt(0)
  s_barrier
  s_cmp_eq_u32 s19, 63
  s_cbranch_scc1 cA_done
  s_sleep 1
  v_mov_b32 v36, 0
  v_mov_b32 v37, 0
  v_mov_b32 v38, 0
  v_mov_b32 v39, 0
  v_mov_b32 v40, 0
  v_mov_b32 v41, 0
  v_mov_b32 v42, 0
  v_mov_b32 v43, 0
  v_mov_b32 v44, 0
  v_mov_b32 v45, 0
  v_mov_b32 v46, 0
  v_mov_b32 v47, 0
  v_mov_b32 v48, 0
  v_mov_b32 v49, 0
  v_mov_b32 v50, 0
  v_mov_b32 v51, 0
  v_mov_b32 v52, 0
  v_mov_b32 v53, 0
  v_mov_b32 v54, 0
  v_mov_b32 v55, 0
  v_mov_b32 v56, 0
  v_mov_b32 v57, 0
  v_mov_b32 v58, 0
  v_mov_b32 v59, 0
  v_mov_b32 v60, 0
  v_mov_b32 v61, 0
  v_mov_b32 v62, 0
  v_mov_b32 v63, 0
  v_mov_b32 v64, 0
  v_mov_b32 v65, 0
  v_mov_b32 v66, 0
  v_mov_b32 v67, 0
  s_sleep 5
  s_mov_b32 s19, s18
  s_add_u32 s18, s18, 1
  s_mov_b32 s22, s20
  s_mov_b32 s20, s21
  s_mov_b32 s21, s22
  s_add_u32 s23, s20, 4096
  s_branch cA_va2_loop
cA_va2_slow:
  s_waitcnt lgkmcnt(0)
cA_va2_sl1:
  s_add_u32 s31, s31, 0x1000000
  buffer_load_dwordx4 v[8:11], v2, s[8:11], s20 offen offset:0 sc1
  buffer_load_dwordx4 v[12:15], v2, s[8:11], s20 offen offset:1024 sc1
  buffer_load_dwordx4 v[16:19], v2, s[8:11], s20 offen offset:2048 sc1
  buffer_load_dwordx4 v[20:23], v2, s[8:11], s20 offen offset:3072 sc1
  buffer_load_dwordx4 v[24:27], v2, s[8:11], s23 offen offset:0 sc1
  buffer_load_dwordx4 v[28:31], v2, s[8:11], s23 offen offset:1024 sc1
  buffer_load_dwordx4 v[32:35], v2, s[8:11], s23 offen offset:2048 sc1
  s_waitcnt vmcnt(0)
  v_max3_u32 v36, v8, v9, v10
  v_max3_u32 v36, v36, v11, v12
  v_max3_u32 v36, v36, v13, v14
  v_max3_u32 v36, v36, v15, v16
  v_max3_u32 v36, v36, v17, v18
  v_max3_u32 v36, v36, v19, v20
  v_max3_u32 v36, v36, v21, v22
  v_max3_u32 v36, v36, v23, v24
  v_max3_u32 v36, v36, v25, v26
  v_max3_u32 v36, v36, v27, v28
  v_max3_u32 v36, v36, v29, v30
  v_max3_u32 v36, v36, v31, v32
  v_max3_u32 v36, v36, v33, v34
  v_max_u32 v36, v36, v35
  v_cmp_eq_u32 vcc, -1, v36
  s_cbranch_vccz cA_va2_sl2
  s_add_u32 s30, s30, 1
  s_cmp_lt_u32 s30, 400000
  s_cbranch_scc1 cA_va2_sl1
  s_branch cA_abort
cA_va2_sl2:
  v_mov_b32 v36, 0
  v_mov_b32 v37, 0
  v_mov_b32 v38, 0
  v_mov_b32 v39, 0
  v_mov_b32 v40, 0
  v_mov_b32 v41, 0
  v_mov_b32 v42, 0
  v_mov_b32 v43, 0
  v_mov_b32 v44, 0
  v_mov_b32 v45, 0
  v_mov_b32 v46, 0
  v_mov_b32 v47, 0
  v_mov_b32 v48, 0
  v_mov_b32 v49, 0
  v_mov_b32 v50, 0
  v_mov_b32 v51, 0
  v_mov_b32 v52, 0
  v_mov_b32 v53, 0
  v_mov_b32 v54, 0
  v_mov_b32 v55, 0
  v_mov_b32 v56, 0
  v_mov_b32 v57, 0
  v_mov_b32 v58, 0
  v_mov_b32 v59, 0
  v_mov_b32 v60, 0
  v_mov_b32 v61, 0
  v_mov_b32 v62, 0
  v_mov_b32 v63, 0
  v_mov_b32 v64, 0
  v_mov_b32 v65, 0
  v_mov_b32 v66, 0
  v_mov_b32 v67, 0
  ds_read_b128 v[68:71], v0 offset:0
  ds_read_b128 v[72:75], v0 offset:1024
  v_smfmac_f32_16x16x64_bf16 v[36:39], v[8:11], a[0:7], v3
  v_smfmac_f32_16x16x64_bf16 v[40:43], v[8:11], a[56:63], v3
  v_smfmac_f32_16x16x64_bf16 v[44:47], v[8:11], a[112:119], v3
  v_smfmac_f32_16x16x64_bf16 v[48:51], v[8:11], a[168:175], v3
  v_smfmac_f32_16x16x64_bf16 v[52:55], v[8:11], a[224:231], v3
  v_smfmac_f32_16x16x64_bf16 v[56:59], v[8:11], v[144:151], v3
  v_smfmac_f32_16x16x64_bf16 v[60:63], v[8:11], v[200:207], v3
  s_waitcnt lgkmcnt(0)
  v_smfmac_f32_16x16x64_bf16 v[64:67], v[8:11], v[68:75], v3
  ds_read_b128 v[76:79], v0 offset:2048
  ds_read_b128 v[80:83], v0 offset:3072
  v_smfmac_f32_16x16x64_bf16 v[36:39], v[12:15], a[8:15], v3
  v_smfmac_f32_16x16x64_bf16 v[40:43], v[12:15], a[64:71], v3
  v_smfmac_f32_16x16x64_bf16 v[44:47], v[12:15], a[120:127], v3
  v_smfmac_f32_16x16x64_bf16 v[48:51], v[12:15], a[176:183], v3
  v_smfmac_f32_16x16x64_bf16 v[52:55], v[12:15], a[232:239], v3
  v_smfmac_f32_16x16x64_bf16 v[56:59], v[12:15], v[152:159], v3
  v_smfmac_f32_16x16x64_bf16 v[60:63], v[12:15], v[208:215], v3
  s_waitcnt lgkmcnt(0)
  v_smfmac_f32_16x16x64_bf16 v[64:67], v[12:15], v[76:83], v3
  ds_read_b128 v[84:87], v0 offset:4096
  ds_read_b128 v[88:91], v0 offset:5120
  v_smfmac_f32_16x16x64_bf16 v[36:39], v[16:19], a[16:23], v3
  v_smfmac_f32_16x16x64_bf16 v[40:43], v[16:19], a[72:79], v3
  v_smfmac_f32_16x16x64_bf16 v[44:47], v[16:19], a[128:135], v3
  v_smfmac_f32_16x16x64_bf16 v[48:51], v[16:19], a[184:191], v3
  v_smfmac_f32_16x16x64_bf16 v[52:55], v[16:19], a[240:247], v3
  v_smfmac_f32_16x16x64_bf16 v[56:59], v[16:19], v[160:167], v3
  v_smfmac_f32_16x16x64_bf16 v[60:63], v[16:19], v[216:223], v3
  s_waitcnt lgkmcnt(0)
  v_smfmac_f32_16x16x64_bf16 v[64:67], v[16:19], v[84:91], v3
  ds_read_b128 v[68:71], v0 offset:6144
  ds_read_b128 v[72:75], v0 offset:7168
  v_smfmac_f32_16x16x64_bf16 v[36:39], v[20:23], a[24:31], v3
  v_smfmac_f32_16x16x64_bf16 v[40:43], v[20:23], a[80:87], v3
  v_smfmac_f32_16x16x64_bf16 v[44:47], v[20:23], a[136:143], v3
  v_smfmac_f32_16x16x64_bf16 v[48:51], v[20:23], a[192:199], v3
  v_smfmac_f32_16x16x64_bf16 v[52:55], v[20:23], a[248:255], v3
  v_smfmac_f32_16x16x64_bf16 v[56:59], v[20:23], v[168:175], v3
  v_smfmac_f32_16x16x64_bf16 v[60:63], v[20:23], v[224:231], v3
  s_waitcnt lgkmcnt(0)
  v_smfmac_f32_16x16x64_bf16 v[64:67], v[20:23], v[68:75], v3
  ds_read_b128 v[76:79], v0 offset:8192
  ds_read_b128 v[80:83], v0 offset:9216
  v_smfmac_f32_16x16x64_bf16 v[36:39], v[24:27], a[32:39], v3
  v_smfmac_f32_16x16x64_bf16 v[40:43], v[24:27], a[88:95], v3
  v_smfmac_f32_16x16x64_bf16 v[44:47], v[24:27], a[144:151], v3
  v_smfmac_f32_16x16x64_bf16 v[48:51], v[24:27], a[200:207], v3
  v_smfmac_f32_16x16x64_bf16 v[52:55], v[24:27], v[120:127], v3
  v_smfmac_f32_16x16x64_bf16 v[56:59], v[24:27], v[176:183], v3
  v_smfmac_f32_16x16x64_bf16 v[60:63], v[24:27], v[232:239], v3
  s_waitcnt lgkmcnt(0)
  v_smfmac_f32_16x16x64_bf16 v[64:67], v[24:27], v[76:83], v3
  ds_read_b128 v[84:87], v0 offset:10240
  ds_read_b128 v[88:91], v0 offset:11264
  v_smfmac_f32_16x16x64_bf16 v[36:39], v[28:31], a[40:47], v3
  v_smfmac_f32_16x16x64_bf16 v[40:43], v[28:31], a[96:103], v3
  v_smfmac_f32_16x16x64_bf16 v[44:47], v[28:31], a[152:159], v3
  v_smfmac_f32_16x16x64_bf16 v[48:51], v[28:31], a[208:215], v3
  v_smfmac_f32_16x16x64_bf16 v[52:55], v[28:31], v[128:135], v3
  v_smfmac_f32_16x16x64_bf16 v[56:59], v[28:31], v[184:191], v3
  v_smfmac_f32_16x16x64_bf16 v[60:63], v[28:31], v[240:247], v3
  s_waitcnt lgkmcnt(0)
  v_smfmac_f32_16x16x64_bf16 v[64:67], v[28:31], v[84:91], v3
  ds_read_b128 v[68:71], v0 offset:12288
  ds_read_b128 v[72:75], v0 offset:13312
  v_smfmac_f32_16x16x64_bf16 v[36:39], v[32:35], a[48:55], v3
  v_smfmac_f32_16x16x64_bf16 v[40:43], v[32:35], a[104:111], v3
  v_smfmac_f32_16x16x64_bf16 v[44:47], v[32:35], a[160:167], v3
  v_smfmac_f32_16x16x64_bf16 v[48:51], v[32:35], a[216:223], v3
  v_smfmac_f32_16x16x64_bf16 v[52:55], v[32:35], v[136:143], v3
  v_smfmac_f32_16x16x64_bf16 v[56:59], v[32:35], v[192:199], v3
  v_smfmac_f32_16x16x64_bf16 v[60:63], v[32:35], v[248:255], v3
  s_waitcnt lgkmcnt(0)
  v_smfmac_f32_16x16x64_bf16 v[64:67], v[32:35], v[68:75], v3
  v_permlane32_swap_b32 v36, v38
  v_permlane32_swap_b32 v37, v39
  v_add_f32 v36, v36, v38
  v_add_f32 v37, v37, v39
  v_cvt_pk_bf16_f32 v38, v36, v37
  ds_write_b32 v104, v38
  v_permlane32_swap_b32 v40, v42
  v_permlane32_swap_b32 v41, v43
  v_add_f32 v40, v40, v42
  v_add_f32 v41, v41, v43
  v_cvt_pk_bf16_f32 v42, v40, v41
  ds_write_b32 v105, v42
  v_permlane32_swap_b32 v44, v46
  v_permlane32_swap_b32 v45, v47
  v_add_f32 v44, v44, v46
  v_add_f32 v45, v45, v47
  v_cvt_pk_bf16_f32 v46, v44, v45
  ds_write_b32 v106, v46
  v_permlane32_swap_b32 v48, v50
  v_permlane32_swap_b32 v49, v51
  v_add_f32 v48, v48, v50
  v_add_f32 v49, v49, v51
  v_cvt_pk_bf16_f32 v50, v48, v49
  ds_write_b32 v107, v50
  v_permlane32_swap_b32 v52, v54
  v_permlane32_swap_b32 v53, v55
  v_add_f32 v52, v52, v54
  v_add_f32 v53, v53, v55
  v_cvt_pk_bf16_f32 v54, v52, v53
  ds_write_b32 v108, v54
  v_permlane32_swap_b32 v56, v58
  v_permlane32_swap_b32 v57, v59
  v_add_f32 v56, v56, v58
  v_add_f32 v57, v57, v59
  v_cvt_pk_bf16_f32 v58, v56, v57
  ds_write_b32 v109, v58
  v_permlane32_swap_b32 v60, v62
  v_permlane32_swap_b32 v61, v63
  v_add_f32 v60, v60, v62
  v_add_f32 v61, v61, v63
  v_cvt_pk_bf16_f32 v62, v60, v61
  ds_write_b32 v110, v62
  v_permlane32_swap_b32 v64, v66
  v_permlane32_swap_b32 v65, v67
  v_add_f32 v64, v64, v66
  v_add_f32 v65, v65, v67
  v_cvt_pk_bf16_f32 v66, v64, v65
  ds_write_b32 v111, v66
  s_branch cA_va2_t2d
.p2align 6
cA_va3_loop:
  s_mov_b32 s30, 0
  s_barrier
  buffer_load_dwordx4 v[16:19], v2, s[8:11], s20 offen offset:2048 sc1
  buffer_load_dwordx4 v[20:23], v2, s[8:11], s20 offen offset:3072 sc1
  s_barrier
  buffer_load_dword v100, v116, s[8:11], s39 offen sc1
  s_add_u32 s27, s19, 2
  s_min_u32 s27, s27, 63
  s_lshr_b32 s27, s27, 3
  s_lshl_b32 s27, s27, 11
  s_add_u32 s27, s27, s35
  s_cmp_eq_u32 s27, s28
  s_cselect_b32 s29, 35328, s27
  buffer_load_dword v101, off, s[8:11], s29 sc1
  s_add_u32 s39, s39, 28672
  s_waitcnt vmcnt(2)
  ds_write_b128 v2, v[16:19] offset:10240
  ds_write_b128 v2, v[20:23] offset:11264
  v_smfmac_f32_16x16x64_bf16 v[36:39], v[16:19], a[16:23], v3
  v_smfmac_f32_16x16x64_bf16 v[40:43], v[16:19], a[72:79], v3
  v_smfmac_f32_16x16x64_bf16 v[44:47], v[16:19], a[128:135], v3
  v_smfmac_f32_16x16x64_bf16 v[48:51], v[16:19], a[184:191], v3
  v_smfmac_f32_16x16x64_bf16 v[52:55], v[16:19], a[240:247], v3
  s_waitcnt lgkmcnt(0)
  s_barrier
  ds_read_b128 v[8:11], v2 offset:8192
  ds_read_b128 v[12:15], v2 offset:9216
  ds_read_b128 v[24:27], v2 offset:12288
  ds_read_b128 v[28:31], v2 offset:13312
  ds_read_b128 v[32:35], v2 offset:14336
  v_smfmac_f32_16x16x64_bf16 v[56:59], v[16:19], v[160:167], v3
  v_smfmac_f32_16x16x64_bf16 v[60:63], v[16:19], v[216:223], v3
  v_smfmac_f32_16x16x64_bf16 v[36:39], v[20:23], a[24:31], v3
  v_smfmac_f32_16x16x64_bf16 v[40:43], v[20:23], a[80:87], v3
  v_smfmac_f32_16x16x64_bf16 v[44:47], v[20:23], a[136:143], v3
  v_smfmac_f32_16x16x64_bf16 v[48:51], v[20:23], a[192:199], v3
  v_smfmac_f32_16x16x64_bf16 v[52:55], v[20:23], a[248:255], v3
  v_smfmac_f32_16x16x64_bf16 v[56:59], v[20:23], v[168:175], v3
  v_smfmac_f32_16x16x64_bf16 v[60:63], v[20:23], v[224:231], v3
  s_waitcnt lgkmcnt(4)
  v_smfmac_f32_16x16x64_bf16 v[36:39], v[8:11], a[0:7], v3
  s_waitcnt lgkmcnt(3)
  v_smfmac_f32_16x16x64_bf16 v[36:39], v[12:15], a[8:15], v3
  s_waitcnt lgkmcnt(2)
  v_smfmac_f32_16x16x64_bf16 v[36:39], v[24:27], a[32:39], v3
  s_waitcnt lgkmcnt(1)
  v_smfmac_f32_16x16x64_bf16 v[36:39], v[28:31], a[40:47], v3
  s_waitcnt lgkmcnt(0)
  v_smfmac_f32_16x16x64_bf16 v[36:39], v[32:35], a[48:55], v3
  v_smfmac_f32_16x16x64_bf16 v[40:43], v[8:11], a[56:63], v3
  v_smfmac_f32_16x16x64_bf16 v[40:43], v[12:15], a[64:71], v3
  v_smfmac_f32_16x16x64_bf16 v[40:43], v[24:27], a[88:95], v3
  v_permlane32_swap_b32 v36, v38
  v_smfmac_f32_16x16x64_bf16 v[40:43], v[28:31], a[96:103], v3
  v_permlane32_swap_b32 v37, v39
  v_smfmac_f32_16x16x64_bf16 v[40:43], v[32:35], a[104:111], v3
  v_add_f32 v36, v36, v38
  v_smfmac_f32_16x16x64_bf16 v[44:47], v[8:11], a[112:119], v3
  v_add_f32 v37, v37, v39
  v_smfmac_f32_16x16x64_bf16 v[44:47], v[12:15], a[120:127], v3
  v_cmp_u_f32 vcc, v36, v37
  v_smfmac_f32_16x16x64_bf16 v[44:47], v[24:27], a[144:151], v3
  v_cvt_pk_bf16_f32 v38, v36, v37
  v_smfmac_f32_16x16x64_bf16 v[44:47], v[28:31], a[152:159], v3
  ds_write_b32 v104, v38
  s_cbranch_vccnz cA_va3_slow
  v_permlane32_swap_b32 v40, v42
  v_smfmac_f32_16x16x64_bf16 v[44:47], v[32:35], a[160:167], v3
  v_permlane32_swap_b32 v41, v43
  v_smfmac_f32_16x16x64_bf16 v[48:51], v[8:11], a[168:175], v3
  v_add_f32 v40, v40, v42
  v_smfmac_f32_16x16x64_bf16 v[48:51], v[12:15], a[176:183], v3
  v_add_f32 v41, v41, v43
  v_smfmac_f32_16x16x64_bf16 v[48:51], v[24:27], a[200:207], v3
  v_cvt_pk_bf16_f32 v42, v40, v41
  v_smfmac_f32_16x16x64_bf16 v[48:51], v[28:31], a[208:215], v3
  ds_write_b32 v105, v42
  v_permlane32_swap_b32 v44, v46
  v_smfmac_f32_16x16x64_bf16 v[48:51], v[32:35], a[216:223], v3
  v_permlane32_swap_b32 v45, v47
  v_smfmac_f32_16x16x64_bf16 v[52:55], v[8:11], a[224:231], v3
  v_add_f32 v44, v44, v46
  v_smfmac_f32_16x16x64_bf16 v[52:55], v[12:15], a[232:239], v3
  v_add_f32 v45, v45, v47
  v_smfmac_f32_16x16x64_bf16 v[52:55], v[24:27], v[120:127], v3
  v_cvt_pk_bf16_f32 v46, v44, v45
  v_smfmac_f32_16x16x64_bf16 v[52:55], v[28:31], v[128:135], v3
  ds_write_b32 v106, v46
  v_permlane32_swap_b32 v48, v50
  v_smfmac_f32_16x16x64_bf16 v[52:55], v[32:35], v[136:143], v3
  v_permlane32_swap_b32 v49, v51
  v_smfmac_f32_16x16x64_bf16 v[56:59], v[8:11], v[144:151], v3
  v_add_f32 v48, v48, v50
  v_smfmac_f32_16x16x64_bf16 v[56:59], v[12:15], v[152:159], v3
  v_add_f32 v49, v49, v51
  v_smfmac_f32_16x16x64_bf16 v[56:59], v[24:27], v[176:183], v3
  v_cvt_pk_bf16_f32 v50, v48, v49
  v_smfmac_f32_16x16x64_bf16 v[56:59], v[28:31], v[184:191], v3
  ds_write_b32 v107, v50
  v_permlane32_swap_b32 v52, v54
  v_smfmac_f32_16x16x64_bf16 v[56:59], v[32:35], v[192:199], v3
  v_permlane32_swap_b32 v53, v55
  v_smfmac_f32_16x16x64_bf16 v[60:63], v[8:11], v[200:207], v3
  v_add_f32 v52, v52, v54
  v_smfmac_f32_16x16x64_bf16 v[60:63], v[12:15], v[208:215], v3
  v_add_f32 v53, v53, v55
  v_smfmac_f32_16x16x64_bf16 v[60:63], v[24:27], v[232:239], v3
  v_cvt_pk_bf16_f32 v54, v52, v53
  v_smfmac_f32_16x16x64_bf16 v[60:63], v[28:31], v[240:247], v3
  ds_write_b32 v108, v54
  v_permlane32_swap_b32 v56, v58
  v_smfmac_f32_16x16x64_bf16 v[60:63], v[32:35], v[248:255], v3
  v_permlane32_swap_b32 v57, v59
  v_add_f32 v56, v56, v58
  v_add_f32 v57, v57, v59
  v_cvt_pk_bf16_f32 v58, v56, v57
  ds_write_b32 v109, v58
  s_nop 2
  v_permlane32_swap_b32 v60, v62
  v_permlane32_swap_b32 v61, v63
  v_add_f32 v60, v60, v62
  v_add_f32 v61, v61, v63
  v_cvt_pk_bf16_f32 v62, v60, v61
  ds_write_b32 v110, v62
cA_va3_t2d:
  v_mov_b32 v117, s18
  s_cmp_eq_u32 s27, s28
  s_cbranch_scc1 cA_va3_vok
cA_va3_vow:
  s_waitcnt vmcnt(0)
  v_cmp_ne_u32 vcc, 56, v101
  s_cbranch_vccnz cA_va3_vor
  s_mov_b32 s28, s27
cA_va3_vok:
  s_waitcnt lgkmcnt(0)
  s_setprio 3
  s_cmp_eq_u32 s19, 0
  s_barrier
  s_cbranch_scc1 cA_va3_f0
cA_va3_f1:
  v_mov_b32 v36, 0
  v_mov_b32 v37, 0
  v_mov_b32 v38, 0
  v_mov_b32 v39, 0
  v_mov_b32 v40, 0
  v_mov_b32 v41, 0
  v_mov_b32 v42, 0
  v_mov_b32 v43, 0
  v_mov_b32 v44, 0
  v_mov_b32 v45, 0
  v_mov_b32 v46, 0
  v_mov_b32 v47, 0
  v_mov_b32 v48, 0
  v_mov_b32 v49, 0
  v_mov_b32 v50, 0
  v_mov_b32 v51, 0
  v_mov_b32 v52, 0
  v_mov_b32 v53, 0
  buffer_store_dword v117, v118, s[8:11], 0 offen
  s_setprio 0
  s_cmp_eq_u32 s19, 63
  s_cbranch_scc1 cA_done
  v_mov_b32 v54, 0
  v_mov_b32 v55, 0
  v_mov_b32 v56, 0
  v_mov_b32 v57, 0
  v_mov_b32 v58, 0
  v_mov_b32 v59, 0
  v_mov_b32 v60, 0
  v_mov_b32 v61, 0
  v_mov_b32 v62, 0
  v_mov_b32 v63, 0
  s_mov_b32 s19, s18
  s_add_u32 s18, s18, 1
  s_mov_b32 s22, s20
  s_mov_b32 s20, s21
  s_mov_b32 s21, s22
  s_add_u32 s23, s20, 4096
  s_branch cA_va3_loop
cA_va3_slow:
  s_waitcnt lgkmcnt(0)
cA_va3_sl1:
  s_add_u32 s31, s31, 0x1000000
  buffer_load_dwordx4 v[8:11], v2, s[8:11], s20 offen offset:0 sc1
  buffer_load_dwordx4 v[12:15], v2, s[8:11], s20 offen offset:1024 sc1
  buffer_load_dwordx4 v[16:19], v2, s[8:11], s20 offen offset:2048 sc1
  buffer_load_dwordx4 v[20:23], v2, s[8:11], s20 offen offset:3072 sc1
  buffer_load_dwordx4 v[24:27], v2, s[8:11], s23 offen offset:0 sc1
  buffer_load_dwordx4 v[28:31], v2, s[8:11], s23 offen offset:1024 sc1
  buffer_load_dwordx4 v[32:35], v2, s[8:11], s23 offen offset:2048 sc1
  s_waitcnt vmcnt(0)
  v_max3_u32 v36, v8, v9, v10
  v_max3_u32 v36, v36, v11, v12
  v_max3_u32 v36, v36, v13, v14
  v_max3_u32 v36, v36, v15, v16
  v_max3_u32 v36, v36, v17, v18
  v_max3_u32 v36, v36, v19, v20
  v_max3_u32 v36, v36, v21, v22
  v_max3_u32 v36, v36, v23, v24
  v_max3_u32 v36, v36, v25, v26
  v_max3_u32 v36, v36, v27, v28
  v_max3_u32 v36, v36, v29, v30
  v_max3_u32 v36, v36, v31, v32
  v_max3_u32 v36, v36, v33, v34
  v_max_u32 v36, v36, v35
  v_cmp_eq_u32 vcc, -1, v36
  s_cbranch_vccz cA_va3_sl2
  s_add_u32 s30, s30, 1
  s_cmp_lt_u32 s30, 400000
  s_cbranch_scc1 cA_va3_sl1
  s_branch cA_abort
cA_va3_sl2:
  v_mov_b32 v36, 0
  v_mov_b32 v37, 0
  v_mov_b32 v38, 0
  v_mov_b32 v39, 0
  v_mov_b32 v40, 0
  v_mov_b32 v41, 0
  v_mov_b32 v42, 0
  v_mov_b32 v43, 0
  v_mov_b32 v44, 0
  v_mov_b32 v45, 0
  v_mov_b32 v46, 0
  v_mov_b32 v47, 0
  v_mov_b32 v48, 0
  v_mov_b32 v49, 0
  v_mov_b32 v50, 0
  v_mov_b32 v51, 0
  v_mov_b32 v52, 0
  v_mov_b32 v53, 0
  v_mov_b32 v54, 0
  v_mov_b32 v55, 0
  v_mov_b32 v56, 0
  v_mov_b32 v57, 0
  v_mov_b32 v58, 0
  v_mov_b32 v59, 0
  v_mov_b32 v60, 0
  v_mov_b32 v61, 0
  v_mov_b32 v62, 0
  v_mov_b32 v63, 0
  v_smfmac_f32_16x16x64_bf16 v[36:39], v[8:11], a[0:7], v3
  v_smfmac_f32_16x16x64_bf16 v[40:43], v[8:11], a[56:63], v3
  v_smfmac_f32_16x16x64_bf16 v[44:47], v[8:11], a[112:119], v3
  v_smfmac_f32_16x16x64_bf16 v[48:51], v[8:11], a[168:175], v3
  v_smfmac_f32_16x16x64_bf16 v[52:55], v[8:11], a[224:231], v3
  v_smfmac_f32_16x16x64_bf16 v[56:59], v[8:11], v[144:151], v3
  v_smfmac_f32_16x16x64_bf16 v[60:63], v[8:11], v[200:207], v3
  v_smfmac_f32_16x16x64_bf16 v[36:39], v[12:15], a[8:15], v3
  v_smfmac_f32_16x16x64_bf16 v[40:43], v[12:15], a[64:71], v3
  v_smfmac_f32_16x16x64_bf16 v[44:47], v[12:15], a[120:127], v3
  v_smfmac_f32_16x16x64_bf16 v[48:51], v[12:15], a[176:183], v3
  v_smfmac_f32_16x16x64_bf16 v[52:55], v[12:15], a[232:239], v3
  v_smfmac_f32_16x16x64_bf16 v[56:59], v[12:15], v[152:159], v3
  v_smfmac_f32_16x16x64_bf16 v[60:63], v[12:15], v[208:215], v3
  v_smfmac_f32_16x16x64_bf16 v[36:39], v[16:19], a[16:23], v3
  v_smfmac_f32_16x16x64_bf16 v[40:43], v[16:19], a[72:79], v3
  v_smfmac_f32_16x16x64_bf16 v[44:47], v[16:19], a[128:135], v3
  v_smfmac_f32_16x16x64_bf16 v[48:51], v[16:19], a[184:191], v3
  v_smfmac_f32_16x16x64_bf16 v[52:55], v[16:19], a[240:247], v3
  v_smfmac_f32_16x16x64_bf16 v[56:59], v[16:19], v[160:167], v3
  v_smfmac_f32_16x16x64_bf16 v[60:63], v[16:19], v[216:223], v3
  v_smfmac_f32_16x16x64_bf16 v[36:39], v[20:23], a[24:31], v3
  v_smfmac_f32_16x16x64_bf16 v[40:43], v[20:23], a[80:87], v3
  v_smfmac_f32_16x16x64_bf16 v[44:47], v[20:23], a[136:143], v3
  v_smfmac_f32_16x16x64_bf16 v[48:51], v[20:23], a[192:199], v3
  v_smfmac_f32_16x16x64_bf16 v[52:55], v[20:23], a[248:255], v3
  v_smfmac_f32_16x16x64_bf16 v[56:59], v[20:23], v[168:175], v3
  v_smfmac_f32_16x16x64_bf16 v[60:63], v[20:23], v[224:231], v3
  v_smfmac_f32_16x16x64_bf16 v[36:39], v[24:27], a[32:39], v3
  v_smfmac_f32_16x16x64_bf16 v[40:43], v[24:27], a[88:95], v3
  v_smfmac_f32_16x16x64_bf16 v[44:47], v[24:27], a[144:151], v3
  v_smfmac_f32_16x16x64_bf16 v[48:51], v[24:27], a[200:207], v3
  v_smfmac_f32_16x16x64_bf16 v[52:55], v[24:27], v[120:127], v3
  v_smfmac_f32_16x16x64_bf16 v[56:59], v[24:27], v[176:183], v3
  v_smfmac_f32_16x16x64_bf16 v[60:63], v[24:27], v[232:239], v3
  v_smfmac_f32_16x16x64_bf16 v[36:39], v[28:31], a[40:47], v3
  v_smfmac_f32_16x16x64_bf16 v[40:43], v[28:31], a[96:103], v3
  v_smfmac_f32_16x16x64_bf16 v[44:47], v[28:31], a[152:159], v3
  v_smfmac_f32_16x16x64_bf16 v[48:51], v[28:31], a[208:215], v3
  v_smfmac_f32_16x16x64_bf16 v[52:55], v[28:31], v[128:135], v3
  v_smfmac_f32_16x16x64_bf16 v[56:59], v[28:31], v[184:191], v3
  v_smfmac_f32_16x16x64_bf16 v[60:63], v[28:31], v[240:247], v3
  v_smfmac_f32_16x16x64_bf16 v[36:39], v[32:35], a[48:55], v3
  v_smfmac_f32_16x16x64_bf16 v[40:43], v[32:35], a[104:111], v3
  v_smfmac_f32_16x16x64_bf16 v[44:47], v[32:35], a[160:167], v3
  v_smfmac_f32_16x16x64_bf16 v[48:51], v[32:35], a[216:223], v3
  v_smfmac_f32_16x16x64_bf16 v[52:55], v[32:35], v[136:143], v3
  v_smfmac_f32_16x16x64_bf16 v[56:59], v[32:35], v[192:199], v3
  v_smfmac_f32_16x16x64_bf16 v[60:63], v[32:35], v[248:255], v3
  v_permlane32_swap_b32 v36, v38
  v_permlane32_swap_b32 v37, v39
  v_add_f32 v36, v36, v38
  v_add_f32 v37, v37, v39
  v_cvt_pk_bf16_f32 v38, v36, v37
  ds_write_b32 v104, v38
  v_permlane32_swap_b32 v40, v42
  v_permlane32_swap_b32 v41, v43
  v_add_f32 v40, v40, v42
  v_add_f32 v41, v41, v43
  v_cvt_pk_bf16_f32 v42, v40, v41
  ds_write_b32 v105, v42
  v_permlane32_swap_b32 v44, v46
  v_permlane32_swap_b32 v45, v47
  v_add_f32 v44, v44, v46
  v_add_f32 v45, v45, v47
  v_cvt_pk_bf16_f32 v46, v44, v45
  ds_write_b32 v106, v46
  v_permlane32_swap_b32 v48, v50
  v_permlane32_swap_b32 v49, v51
  v_add_f32 v48, v48, v50
  v_add_f32 v49, v49, v51
  v_cvt_pk_bf16_f32 v50, v48, v49
  ds_write_b32 v107, v50
  v_permlane32_swap_b32 v52, v54
  v_permlane32_swap_b32 v53, v55
  v_add_f32 v52, v52, v54
  v_add_f32 v53, v53, v55
  v_cvt_pk_bf16_f32 v54, v52, v53
  ds_write_b32 v108, v54
  v_permlane32_swap_b32 v56, v58
  v_permlane32_swap_b32 v57, v59
  v_add_f32 v56, v56, v58
  v_add_f32 v57, v57, v59
  v_cvt_pk_bf16_f32 v58, v56, v57
  ds_write_b32 v109, v58
  v_permlane32_swap_b32 v60, v62
  v_permlane32_swap_b32 v61, v63
  v_add_f32 v60, v60, v62
  v_add_f32 v61, v61, v63
  v_cvt_pk_bf16_f32 v62, v60, v61
  ds_write_b32 v110, v62
  s_branch cA_va3_t2d
cA_va3_f0:
  s_sleep 3
  s_branch cA_va3_f1
cA_va3_vor:
  s_sleep 2
  buffer_load_dword v101, off, s[8:11], s27 sc1
  s_add_u32 s30, s30, 1
  s_cmp_lt_u32 s30, 400000
  s_cbranch_scc1 cA_va3_vow
  s_branch cA_abort
cA_abort:
  v_mov_b32 v4, 0xdead
  v_mov_b32 v5, 16
  buffer_store_dword v4, v5, s[12:15], 0 offen
  s_branch ch_end
cA_done:
  s_branch ch_end
.p2align 6
cB_sc0_loop:
  s_mov_b32 s30, 0
  s_mov_b32 s62, 0
  s_setprio 3
cB_sc0_fp_l:
  v_cmp_gt_u32 vcc, s19, v112
  buffer_load_dword v112, v0, s[8:11], 0 offen sc1
  s_cbranch_vccz cB_sc0_fp_d
  v_cmp_gt_u32 vcc, s19, v112
  buffer_load_dword v112, v0, s[8:11], 0 offen sc1
  s_cbranch_vccz cB_sc0_fp_d
  v_cmp_gt_u32 vcc, s19, v112
  buffer_load_dword v112, v0, s[8:11], 0 offen sc1
  s_cbranch_vccz cB_sc0_fp_d
  v_cmp_gt_u32 vcc, s19, v112
  buffer_load_dword v112, v0, s[8:11], 0 offen sc1
  s_cbranch_vccz cB_sc0_fp_d
  v_cmp_gt_u32 vcc, s19, v112
  buffer_load_dword v112, v0, s[8:11], 0 offen sc1
  s_cbranch_vccz cB_sc0_fp_d
  v_cmp_gt_u32 vcc, s19, v112
  buffer_load_dword v112, v0, s[8:11], 0 offen sc1
  s_cbranch_vccz cB_sc0_fp_d
  v_cmp_gt_u32 vcc, s19, v112
  buffer_load_dword v112, v0, s[8:11], 0 offen sc1
  s_cbranch_vccz cB_sc0_fp_d
  v_cmp_gt_u32 vcc, s19, v112
  buffer_load_dword v112, v0, s[8:11], 0 offen sc1
  s_cbranch_vccz cB_sc0_fp_d
  v_cmp_gt_u32 vcc, s19, v112
  buffer_load_dword v112, v0, s[8:11], 0 offen sc1
  s_cbranch_vccz cB_sc0_fp_d
  v_cmp_gt_u32 vcc, s19, v112
  buffer_load_dword v112, v0, s[8:11], 0 offen sc1
  s_cbranch_vccz cB_sc0_fp_d
  v_cmp_gt_u32 vcc, s19, v112
  buffer_load_dword v112, v0, s[8:11], 0 offen sc1
  s_cbranch_vccz cB_sc0_fp_d
  v_cmp_gt_u32 vcc, s19, v112
  buffer_load_dword v112, v0, s[8:11], 0 offen sc1
  s_cbranch_vccz cB_sc0_fp_d
  v_cmp_gt_u32 vcc, s19, v112
  buffer_load_dword v112, v0, s[8:11], 0 offen sc1
  s_cbranch_vccz cB_sc0_fp_d
  v_cmp_gt_u32 vcc, s19, v112
  buffer_load_dword v112, v0, s[8:11], 0 offen sc1
  s_cbranch_vccz cB_sc0_fp_d
  v_cmp_gt_u32 vcc, s19, v112
  buffer_load_dword v112, v0, s[8:11], 0 offen sc1
  s_cbranch_vccz cB_sc0_fp_d
  v_cmp_gt_u32 vcc, s19, v112
  buffer_load_dword v112, v0, s[8:11], 0 offen sc1
  s_cbranch_vccz cB_sc0_fp_d
  s_waitcnt vmcnt(24)
  s_add_u32 s30, s30, 1
  s_cmp_lt_u32 s30, 400000
  s_cbranch_scc1 cB_sc0_fp_l
  s_branch cB_abort
cB_sc0_fp_d:
  buffer_load_dwordx4 v[8:11], v2, s[8:11], s20 offen offset:0 sc1
  s_barrier
  s_setprio 2
  buffer_load_dwordx4 v[12:15], v2, s[8:11], s20 offen offset:1024 sc1
  s_setprio 1
  buffer_load_dwordx4 v[16:19], v2, s[8:11], s20 offen offset:2048 sc1
  s_setprio 0
  buffer_load_dwordx4 v[20:23], v2, s[8:11], s20 offen offset:3072 sc1
cB_sc0_go:
  s_waitcnt vmcnt(3)
  v_smfmac_f32_16x16x64_bf16 v[36:39], v[8:11], a[0:7], v3
  buffer_load_dwordx4 v[32:35], v2, s[8:11], s23 offen offset:0 sc1
  v_cmp_eq_u32 vcc, -1, v8
  v_smfmac_f32_16x16x64_bf16 v[40:43], v[8:11], a[56:63], v3
  v_smfmac_f32_16x16x64_bf16 v[44:47], v[8:11], a[112:119], v3
  buffer_load_dwordx4 v[24:27], v2, s[8:11], s23 offen offset:1024 sc1
  s_cbranch_vccnz cB_sc0_r0
  v_smfmac_f32_16x16x64_bf16 v[48:51], v[8:11], a[168:175], v3
  v_smfmac_f32_16x16x64_bf16 v[52:55], v[8:11], a[224:231], v3
  v_smfmac_f32_16x16x64_bf16 v[56:59], v[8:11], v[144:151], v3
  buffer_load_dwordx4 v[28:31], v2, s[8:11], s23 offen offset:2048 sc1
  v_smfmac_f32_16x16x64_bf16 v[60:63], v[8:11], v[200:207], v3
  s_waitcnt vmcnt(5)
  v_smfmac_f32_16x16x64_bf16 v[36:39], v[12:15], a[8:15], v3
  v_smfmac_f32_16x16x64_bf16 v[40:43], v[12:15], a[64:71], v3
  v_smfmac_f32_16x16x64_bf16 v[44:47], v[12:15], a[120:127], v3
  v_smfmac_f32_16x16x64_bf16 v[48:51], v[12:15], a[176:183], v3
  v_smfmac_f32_16x16x64_bf16 v[52:55], v[12:15], a[232:239], v3
  v_smfmac_f32_16x16x64_bf16 v[56:59], v[12:15], v[152:159], v3
  buffer_load_dwordx4 v[88:91], v117, s[8:11], s26 offen offset:0 sc1
  v_smfmac_f32_16x16x64_bf16 v[60:63], v[12:15], v[208:215], v3
  s_waitcnt vmcnt(5)
  v_smfmac_f32_16x16x64_bf16 v[36:39], v[16:19], a[16:23], v3
  v_smfmac_f32_16x16x64_bf16 v[40:43], v[16:19], a[72:79], v3
  v_smfmac_f32_16x16x64_bf16 v[44:47], v[16:19], a[128:135], v3
  buffer_load_dwordx4 v[92:95], v117, s[8:11], s26 offen offset:1024 sc1
  v_smfmac_f32_16x16x64_bf16 v[48:51], v[16:19], a[184:191], v3
  v_smfmac_f32_16x16x64_bf16 v[52:55], v[16:19], a[240:247], v3
  v_smfmac_f32_16x16x64_bf16 v[56:59], v[16:19], v[160:167], v3
  v_smfmac_f32_16x16x64_bf16 v[60:63], v[16:19], v[216:223], v3
  s_waitcnt vmcnt(5)
  buffer_load_dwordx4 v[96:99], v2, s[8:11], s24 offen offset:0 sc1
  v_smfmac_f32_16x16x64_bf16 v[36:39], v[20:23], a[24:31], v3
  v_smfmac_f32_16x16x64_bf16 v[40:43], v[20:23], a[80:87], v3
  v_max3_u32 v66, v12, v16, v20
  v_smfmac_f32_16x16x64_bf16 v[44:47], v[20:23], a[136:143], v3
  v_smfmac_f32_16x16x64_bf16 v[48:51], v[20:23], a[192:199], v3
  buffer_load_dwordx4 v[100:103], v2, s[8:11], s24 offen offset:1024 sc1
  v_smfmac_f32_16x16x64_bf16 v[52:55], v[20:23], a[248:255], v3
  v_smfmac_f32_16x16x64_bf16 v[56:59], v[20:23], v[168:175], v3
  v_smfmac_f32_16x16x64_bf16 v[60:63], v[20:23], v[224:231], v3
  s_waitcnt vmcnt(4)
  v_smfmac_f32_16x16x64_bf16 v[60:63], v[32:35], v[232:239], v3
  buffer_load_dwordx4 v[104:107], v2, s[8:11], s26 offen offset:0 sc1
  v_max3_u32 v66, v66, v24, v27
  v_smfmac_f32_16x16x64_bf16 v[60:63], v[24:27], v[240:247], v3
  v_max3_u32 v66, v66, v28, v31
  v_smfmac_f32_16x16x64_bf16 v[60:63], v[28:31], v[248:255], v3
  v_max3_u32 v66, v66, v32, v35
  v_smfmac_f32_16x16x64_bf16 v[52:55], v[32:35], v[120:127], v3
  v_cmp_eq_u32 vcc, -1, v66
  v_smfmac_f32_16x16x64_bf16 v[52:55], v[24:27], v[128:135], v3
  buffer_load_dwordx4 v[108:111], v2, s[8:11], s26 offen offset:1024 sc1
  v_smfmac_f32_16x16x64_bf16 v[52:55], v[28:31], v[136:143], v3
  s_cbranch_vccnz cB_sc0_r4
  v_cvt_pk_bf16_f32 v63, v62, v63
  v_smfmac_f32_16x16x64_bf16 v[56:59], v[32:35], v[176:183], v3
  v_cvt_pk_bf16_f32 v62, v60, v61
  v_smfmac_f32_16x16x64_bf16 v[56:59], v[24:27], v[184:191], v3
  v_mfma_f32_16x16x32_bf16 v[12:15], v[62:65], v[4:7], 0
  v_cvt_pk_bf16_f32 v55, v54, v55
  v_smfmac_f32_16x16x64_bf16 v[56:59], v[28:31], v[192:199], v3
  v_cvt_pk_bf16_f32 v54, v52, v53
  v_smfmac_f32_16x16x64_bf16 v[36:39], v[32:35], a[32:39], v3
  s_nop 1
  v_cvt_pk_bf16_f32 v76, v12, v13
  v_smfmac_f32_16x16x64_bf16 v[36:39], v[24:27], a[40:47], v3
  v_cvt_pk_bf16_f32 v77, v14, v15
  v_smfmac_f32_16x16x64_bf16 v[36:39], v[28:31], a[48:55], v3
  v_cvt_pk_bf16_f32 v56, v56, v57
  v_smfmac_f32_16x16x64_bf16 v[40:43], v[32:35], a[88:95], v3
  v_cvt_pk_bf16_f32 v57, v58, v59
  v_smfmac_f32_16x16x64_bf16 v[40:43], v[24:27], a[96:103], v3
  v_mfma_f32_16x16x32_bf16 v[16:19], v[54:57], v[4:7], 0
  v_cvt_pk_bf16_f32 v39, v38, v39
  v_smfmac_f32_16x16x64_bf16 v[40:43], v[28:31], a[104:111], v3
  v_cvt_pk_bf16_f32 v38, v36, v37
  v_smfmac_f32_16x16x64_bf16 v[44:47], v[32:35], a[144:151], v3
  s_nop 1
  v_cvt_pk_bf16_f32 v78, v16, v17
  v_smfmac_f32_16x16x64_bf16 v[44:47], v[24:27], a[152:159], v3
  v_cvt_pk_bf16_f32 v79, v18, v19
  v_smfmac_f32_16x16x64_bf16 v[44:47], v[28:31], a[160:167], v3
  v_cvt_pk_bf16_f32 v40, v40, v41
  v_smfmac_f32_16x16x64_bf16 v[48:51], v[32:35], a[200:207], v3
  v_cvt_pk_bf16_f32 v41, v42, v43
  v_smfmac_f32_16x16x64_bf16 v[48:51], v[24:27], a[208:215], v3
  v_smfmac_f32_16x16x64_bf16 v[48:51], v[28:31], a[216:223], v3
  s_waitcnt vmcnt(4)
  v_cvt_pk_bf16_f32 v47, v46, v47
  v_smfmac_f32_16x16x64_bf16 v[68:71], v[76:79], v[80:87], v3
  v_cvt_pk_bf16_f32 v46, v44, v45
  v_mfma_f32_16x16x32_bf16 v[12:15], v[38:41], v[4:7], 0
  s_nop 1
  v_cvt_pk_bf16_f32 v48, v48, v49
  v_cvt_pk_bf16_f32 v49, v50, v51
  s_nop 1
  v_mfma_f32_16x16x32_bf16 v[16:19], v[46:49], v[4:7], 0
  v_smfmac_f32_16x16x64_bf16 v[72:75], v[76:79], v[88:95], v3
  v_cvt_pk_bf16_f32 v20, v12, v13
  v_mfma_f32_16x16x32_bf16 v[52:55], v[30:33], v[76:79], 0
  s_waitcnt vmcnt(0)
  v_cvt_pk_bf16_f32 v21, v14, v15
  v_cvt_pk_bf16_f32 v22, v16, v17
  v_cvt_pk_bf16_f32 v23, v18, v19
  s_nop 1
  v_mfma_f32_16x16x32_bf16 v[52:55], v[8:11], v[20:23], v[52:55]
  v_smfmac_f32_16x16x64_bf16 v[68:71], v[20:23], v[96:103], v3
  v_smfmac_f32_16x16x64_bf16 v[72:75], v[20:23], v[104:111], v3
  s_nop 1
  ds_write_b128 v113, v[52:55]
  s_nop 1
  v_permlane32_swap_b32 v68, v70
  v_permlane32_swap_b32 v69, v71
  v_add_f32 v56, v68, v70
  v_add_f32 v58, v69, v71
  v_permlane32_swap_b32 v72, v74
  v_permlane32_swap_b32 v73, v75
  v_add_f32 v57, v72, v74
  v_add_f32 v59, v73, v75
  ds_write_b128 v2, v[56:59] offset:0
  v_cmp_u_f32 vcc, v57, v59
  v_mov_b32 v68, 0
  v_mov_b32 v69, 0
  v_mov_b32 v70, 0
  v_mov_b32 v71, 0
  s_cbranch_vccnz cB_sc0_retry
cB_sc0_cont:
  s_add_u32 s24, s24, 28672
  s_add_u32 s26, s26, 28672
  buffer_load_dwordx4 v[80:83], v117, s[8:11], s24 offen offset:0 sc1
  buffer_load_dwordx4 v[84:87], v117, s[8:11], s24 offen offset:1024 sc1
  v_mfma_f32_32x32x16_bf16 v[36:51], v[68:71], v[68:71], 0
  s_waitcnt lgkmcnt(0)
  s_barrier
  ds_read_b64 v[8:9], v114 offset:0
  ds_read_b64 v[10:11], v114 offset:1024
  ds_read_b64 v[12:13], v114 offset:2048
  ds_read_b64 v[14:15], v114 offset:3072
  ds_read2_b32 v[16:17], v115 offset0:0 offset1:64
  ds_read2_b32 v[18:19], v115 offset0:128 offset1:192
  v_mfma_f32_32x32x16_bf16 v[52:67], v[68:71], v[68:71], 0
  s_waitcnt lgkmcnt(0)
  v_pk_add_f32 v[16:17], v[16:17], v[18:19]
  v_pk_add_f32 v[8:9], v[8:9], v[10:11]
  v_pk_add_f32 v[12:13], v[12:13], v[14:15]
  v_add_f32 v20, v16, v17
  v_pk_add_f32 v[8:9], v[8:9], v[12:13]
  v_max_f32 v22, v8, v9
  v_add_f32_dpp v20, v20, v20 row_ror:8 row_mask:0xf bank_mask:0xf
  s_nop 0
  v_max_f32_dpp v22, v22, v22 row_ror:8 row_mask:0xf bank_mask:0xf
  v_max_f32 v22, v22, v20
  s_nop 1
  v_max_f32_dpp v22, v22, v22 quad_perm:[1,0,3,2] row_mask:0xf bank_mask:0xf
  s_nop 1
  v_max_f32_dpp v22, v22, v22 quad_perm:[2,3,0,1] row_mask:0xf bank_mask:0xf
  s_nop 1
  v_max_f32_dpp v22, v22, v22 row_half_mirror row_mask:0xf bank_mask:0xf
  v_pk_add_f32 v[8:9], v[8:9], v[22:23] op_sel_hi:[1,0] neg_lo:[0,1] neg_hi:[0,1]
  v_sub_f32 v20, v20, v22
  v_exp_f32 v8, v8
  v_exp_f32 v9, v9
  v_exp_f32 v20, v20
  v_add_f32 v24, v8, v9
  v_fmac_f32 v24, 0.5, v20
  v_mov_b32_dpp v21, v20 quad_perm:[1,0,3,2] row_mask:0xf bank_mask:0xf
  s_nop 0
  v_add_f32_dpp v24, v24, v24 quad_perm:[1,0,3,2] row_mask:0xf bank_mask:0xf
  s_nop 1
  v_add_f32_dpp v24, v24, v24 quad_perm:[2,3,0,1] row_mask:0xf bank_mask:0xf
  s_nop 1
  v_add_f32_dpp v24, v24, v24 row_half_mirror row_mask:0xf bank_mask:0xf
  s_nop 1
  v_add_f32_dpp v24, v24, v24 row_ror:8 row_mask:0xf bank_mask:0xf
  v_rcp_f32 v24, v24
  s_nop 0
  v_pk_mul_f32 v[8:9], v[8:9], v[24:25] op_sel_hi:[1,0]
  v_cvt_pk_bf16_f32 v8, abs(v8), abs(v9)
  buffer_store_dword v8, v1, s[8:11], s20 offen sc1
  v_pk_mul_f32 v[20:21], v[20:21], v[24:25] op_sel_hi:[1,0]
  v_cvt_pk_bf16_f32 v20, abs(v20), abs(v21)
  buffer_store_dword v20, v118, s[8:11], s20 offen sc1
  v_mov_b32 v72, 0
  v_mov_b32 v73, 0
  v_mov_b32 v74, 0
  v_mov_b32 v75, 0
  s_buffer_load_dword s64, s[8:11], s34 offset:0
  s_buffer_load_dword s65, s[8:11], s34 offset:64
  s_buffer_load_dword s66, s[8:11], s34 offset:128
  s_buffer_load_dword s67, s[8:11], s34 offset:192
  s_buffer_load_dword s64, s[8:11], s34 offset:256
  s_buffer_load_dword s65, s[8:11], s34 offset:320
  s_buffer_load_dword s66, s[8:11], s34 offset:384
  s_buffer_load_dword s67, s[8:11], s34 offset:448
  s_buffer_load_dword s64, s[8:11], s34 offset:512
  s_buffer_load_dword s65, s[8:11], s34 offset:576
  s_buffer_load_dword s66, s[8:11], s34 offset:640
  s_buffer_load_dword s67, s[8:11], s34 offset:704
  s_buffer_load_dword s64, s[8:11], s34 offset:768
  s_buffer_load_dword s65, s[8:11], s34 offset:832
  s_mov_b32 s36, s34
  s_add_u32 s34, s33, 458752
  s_mov_b32 s33, s34
  s_mov_b32 s19, s18
  s_add_u32 s18, s18, 1
  s_mov_b32 s22, s20
  s_mov_b32 s20, s21
  s_mov_b32 s21, s22
  s_add_u32 s23, s20, 4096
  s_sleep 7
  s_cmp_lt_u32 s19, 63
  s_cbranch_scc1 cB_sc0_loop
  s_branch cB_done
cB_sc0_r0:
  s_add_u32 s31, s31, 1
  buffer_load_dwordx4 v[8:11], v2, s[8:11], s20 offen offset:0 sc1
  s_waitcnt vmcnt(0)
  v_cmp_eq_u32 vcc, -1, v8
  v_mov_b32 v36, 0
  v_mov_b32 v37, 0
  v_mov_b32 v38, 0
  v_mov_b32 v39, 0
  v_mov_b32 v40, 0
  v_mov_b32 v41, 0
  v_mov_b32 v42, 0
  v_mov_b32 v43, 0
  v_mov_b32 v44, 0
  v_mov_b32 v45, 0
  v_mov_b32 v46, 0
  v_mov_b32 v47, 0
  v_mov_b32 v48, 0
  v_mov_b32 v49, 0
  v_mov_b32 v50, 0
  v_mov_b32 v51, 0
  s_nop 1
  s_cbranch_vccz cB_sc0_go
  s_add_u32 s30, s30, 1
  s_cmp_lt_u32 s30, 400000
  s_cbranch_scc1 cB_sc0_r0
  s_branch cB_abort
cB_sc0_r4:
  s_add_u32 s31, s31, 1
  buffer_load_dwordx4 v[12:15], v2, s[8:11], s20 offen offset:1024 sc1
  buffer_load_dwordx4 v[16:19], v2, s[8:11], s20 offen offset:2048 sc1
  buffer_load_dwordx4 v[20:23], v2, s[8:11], s20 offen offset:3072 sc1
  buffer_load_dwordx4 v[32:35], v2, s[8:11], s23 offen offset:0 sc1
  buffer_load_dwordx4 v[24:27], v2, s[8:11], s23 offen offset:1024 sc1
  buffer_load_dwordx4 v[28:31], v2, s[8:11], s23 offen offset:2048 sc1
  s_waitcnt vmcnt(0)
  v_max3_u32 v66, v12, v16, v20
  v_max3_u32 v66, v66, v24, v27
  v_max3_u32 v66, v66, v28, v31
  v_max3_u32 v66, v66, v32, v35
  v_cmp_eq_u32 vcc, -1, v66
  s_nop 4
  s_cbranch_vccz cB_sc0_rz
  s_add_u32 s30, s30, 1
  s_cmp_lt_u32 s30, 400000
  s_cbranch_scc1 cB_sc0_r4
  s_branch cB_abort
cB_sc0_retry:
  s_cmp_lg_u32 s62, 0
  s_cbranch_scc1 cB_sc0_cont
  s_waitcnt vmcnt(0) lgkmcnt(0)
cB_sc0_rv:
  buffer_load_dwordx4 v[8:11], v2, s[8:11], s20 offen offset:0 sc1
  buffer_load_dwordx4 v[12:15], v2, s[8:11], s20 offen offset:1024 sc1
  buffer_load_dwordx4 v[16:19], v2, s[8:11], s20 offen offset:2048 sc1
  buffer_load_dwordx4 v[20:23], v2, s[8:11], s20 offen offset:3072 sc1
  buffer_load_dwordx4 v[32:35], v2, s[8:11], s23 offen offset:0 sc1
  buffer_load_dwordx4 v[24:27], v2, s[8:11], s23 offen offset:1024 sc1
  buffer_load_dwordx4 v[28:31], v2, s[8:11], s23 offen offset:2048 sc1
  s_waitcnt vmcnt(0)
  v_max3_u32 v66, v8, v9, v10
  v_max3_u32 v66, v66, v11, v12
  v_max3_u32 v66, v66, v13, v14
  v_max3_u32 v66, v66, v15, v16
  v_max3_u32 v66, v66, v17, v18
  v_max3_u32 v66, v66, v19, v20
  v_max3_u32 v66, v66, v21, v22
  v_max3_u32 v66, v66, v23, v24
  v_max3_u32 v66, v66, v25, v26
  v_max3_u32 v66, v66, v27, v28
  v_max3_u32 v66, v66, v29, v30
  v_max3_u32 v66, v66, v31, v32
  v_max3_u32 v66, v66, v33, v34
  v_max_u32 v66, v66, v35
  v_cmp_eq_u32 vcc, -1, v66
  s_cbranch_vccz cB_sc0_rk
  s_add_u32 s30, s30, 1
  s_cmp_lt_u32 s30, 400000
  s_cbranch_scc1 cB_sc0_rv
  s_branch cB_abort
cB_sc0_rk:
  s_mov_b32 s62, 1
  s_add_u32 s31, s31, 0x100
cB_sc0_rz:
  v_mov_b32 v36, 0
  v_mov_b32 v37, 0
  v_mov_b32 v38, 0
  v_mov_b32 v39, 0
  v_mov_b32 v40, 0
  v_mov_b32 v41, 0
  v_mov_b32 v42, 0
  v_mov_b32 v43, 0
  v_mov_b32 v44, 0
  v_mov_b32 v45, 0
  v_mov_b32 v46, 0
  v_mov_b32 v47, 0
  v_mov_b32 v48, 0
  v_mov_b32 v49, 0
  v_mov_b32 v50, 0
  v_mov_b32 v51, 0
  v_mov_b32 v60, 0
  v_mov_b32 v61, 0
  v_mov_b32 v62, 0
  v_mov_b32 v63, 0
  v_mov_b32 v68, 0
  v_mov_b32 v69, 0
  v_mov_b32 v70, 0
  v_mov_b32 v71, 0
  v_mov_b32 v72, 0
  v_mov_b32 v73, 0
  v_mov_b32 v74, 0
  v_mov_b32 v75, 0
  v_mov_b32 v52, 0
  v_mov_b32 v53, 0
  v_mov_b32 v54, 0
  v_mov_b32 v55, 0
  v_mov_b32 v56, 0
  v_mov_b32 v57, 0
  v_mov_b32 v58, 0
  v_mov_b32 v59, 0
  s_nop 1
  s_branch cB_sc0_go
.p2align 6
cB_sc1_loop:
  s_mov_b32 s30, 0
  s_mov_b32 s62, 0
  s_setprio 3
  s_barrier
  buffer_load_dwordx4 v[12:15], v2, s[8:11], s20 offen offset:1024 sc1
  s_setprio 2
  buffer_load_dwordx4 v[16:19], v2, s[8:11], s20 offen offset:2048 sc1
  s_setprio 1
  buffer_load_dwordx4 v[20:23], v2, s[8:11], s20 offen offset:3072 sc1
  s_setprio 0
  buffer_load_dwordx4 v[8:11], v2, s[8:11], s20 offen offset:0 sc1
cB_sc1_go:
  s_waitcnt vmcnt(3)
  v_smfmac_f32_16x16x64_bf16 v[36:39], v[12:15], a[8:15], v3
  buffer_load_dwordx4 v[24:27], v2, s[8:11], s23 offen offset:1024 sc1
  v_cmp_eq_u32 vcc, -1, v12
  v_smfmac_f32_16x16x64_bf16 v[40:43], v[12:15], a[64:71], v3
  v_smfmac_f32_16x16x64_bf16 v[44:47], v[12:15], a[120:127], v3
  buffer_load_dwordx4 v[32:35], v2, s[8:11], s23 offen offset:2048 sc1
  s_cbranch_vccnz cB_sc1_r0
  v_smfmac_f32_16x16x64_bf16 v[48:51], v[12:15], a[176:183], v3
  v_smfmac_f32_16x16x64_bf16 v[52:55], v[12:15], a[232:239], v3
  v_smfmac_f32_16x16x64_bf16 v[56:59], v[12:15], v[152:159], v3
  buffer_load_dwordx4 v[28:31], v2, s[8:11], s23 offen offset:0 sc1
  v_smfmac_f32_16x16x64_bf16 v[60:63], v[12:15], v[208:215], v3
  s_waitcnt vmcnt(5)
  v_smfmac_f32_16x16x64_bf16 v[36:39], v[16:19], a[16:23], v3
  v_smfmac_f32_16x16x64_bf16 v[40:43], v[16:19], a[72:79], v3
  v_smfmac_f32_16x16x64_bf16 v[44:47], v[16:19], a[128:135], v3
  v_smfmac_f32_16x16x64_bf16 v[48:51], v[16:19], a[184:191], v3
  v_smfmac_f32_16x16x64_bf16 v[52:55], v[16:19], a[240:247], v3
  v_smfmac_f32_16x16x64_bf16 v[56:59], v[16:19], v[160:167], v3
  buffer_load_dwordx4 v[88:91], v117, s[8:11], s26 offen offset:0 sc1
  v_smfmac_f32_16x16x64_bf16 v[60:63], v[16:19], v[216:223], v3
  s_waitcnt vmcnt(5)
  v_smfmac_f32_16x16x64_bf16 v[36:39], v[20:23], a[24:31], v3
  v_smfmac_f32_16x16x64_bf16 v[40:43], v[20:23], a[80:87], v3
  v_smfmac_f32_16x16x64_bf16 v[44:47], v[20:23], a[136:143], v3
  buffer_load_dwordx4 v[92:95], v117, s[8:11], s26 offen offset:1024 sc1
  v_smfmac_f32_16x16x64_bf16 v[48:51], v[20:23], a[192:199], v3
  v_smfmac_f32_16x16x64_bf16 v[52:55], v[20:23], a[248:255], v3
  v_smfmac_f32_16x16x64_bf16 v[56:59], v[20:23], v[168:175], v3
  v_smfmac_f32_16x16x64_bf16 v[60:63], v[20:23], v[224:231], v3
  s_waitcnt vmcnt(5)
  buffer_load_dwordx4 v[96:99], v2, s[8:11], s24 offen offset:0 sc1
  v_smfmac_f32_16x16x64_bf16 v[36:39], v[8:11], a[0:7], v3
  v_smfmac_f32_16x16x64_bf16 v[40:43], v[8:11], a[56:63], v3
  v_max3_u32 v66, v16, v20, v8
  v_smfmac_f32_16x16x64_bf16 v[44:47], v[8:11], a[112:119], v3
  v_smfmac_f32_16x16x64_bf16 v[48:51], v[8:11], a[168:175], v3
  buffer_load_dwordx4 v[100:103], v2, s[8:11], s24 offen offset:1024 sc1
  v_smfmac_f32_16x16x64_bf16 v[52:55], v[8:11], a[224:231], v3
  v_smfmac_f32_16x16x64_bf16 v[56:59], v[8:11], v[144:151], v3
  v_smfmac_f32_16x16x64_bf16 v[60:63], v[8:11], v[200:207], v3
  s_waitcnt vmcnt(4)
  v_smfmac_f32_16x16x64_bf16 v[60:63], v[28:31], v[232:239], v3
  buffer_load_dwordx4 v[104:107], v2, s[8:11], s26 offen offset:0 sc1
  v_max3_u32 v66, v66, v24, v27
  v_smfmac_f32_16x16x64_bf16 v[60:63], v[24:27], v[240:247], v3
  v_max3_u32 v66, v66, v28, v31
  v_smfmac_f32_16x16x64_bf16 v[60:63], v[32:35], v[248:255], v3
  v_max3_u32 v66, v66, v32, v35
  v_smfmac_f32_16x16x64_bf16 v[52:55], v[28:31], v[120:127], v3
  v_cmp_eq_u32 vcc, -1, v66
  v_smfmac_f32_16x16x64_bf16 v[52:55], v[24:27], v[128:135], v3
  buffer_load_dwordx4 v[108:111], v2, s[8:11], s26 offen offset:1024 sc1
  v_smfmac_f32_16x16x64_bf16 v[52:55], v[32:35], v[136:143], v3
  s_cbranch_vccnz cB_sc1_r4
  v_cvt_pk_bf16_f32 v63, v62, v63
  v_smfmac_f32_16x16x64_bf16 v[56:59], v[28:31], v[176:183], v3
  v_cvt_pk_bf16_f32 v62, v60, v61
  v_smfmac_f32_16x16x64_bf16 v[56:59], v[24:27], v[184:191], v3
  v_mfma_f32_16x16x32_bf16 v[8:11], v[62:65], v[4:7], 0
  v_cvt_pk_bf16_f32 v55, v54, v55
  v_smfmac_f32_16x16x64_bf16 v[56:59], v[32:35], v[192:199], v3
  v_cvt_pk_bf16_f32 v54, v52, v53
  v_smfmac_f32_16x16x64_bf16 v[36:39], v[28:31], a[32:39], v3
  s_nop 1
  v_cvt_pk_bf16_f32 v78, v8, v9
  v_smfmac_f32_16x16x64_bf16 v[36:39], v[24:27], a[40:47], v3
  v_cvt_pk_bf16_f32 v79, v10, v11
  v_smfmac_f32_16x16x64_bf16 v[36:39], v[32:35], a[48:55], v3
  v_cvt_pk_bf16_f32 v56, v56, v57
  v_smfmac_f32_16x16x64_bf16 v[40:43], v[28:31], a[88:95], v3
  v_cvt_pk_bf16_f32 v57, v58, v59
  v_smfmac_f32_16x16x64_bf16 v[40:43], v[24:27], a[96:103], v3
  v_mfma_f32_16x16x32_bf16 v[16:19], v[54:57], v[4:7], 0
  v_cvt_pk_bf16_f32 v39, v38, v39
  v_smfmac_f32_16x16x64_bf16 v[40:43], v[32:35], a[104:111], v3
  v_cvt_pk_bf16_f32 v38, v36, v37
  v_smfmac_f32_16x16x64_bf16 v[44:47], v[28:31], a[144:151], v3
  s_nop 1
  v_cvt_pk_bf16_f32 v76, v16, v17
  v_smfmac_f32_16x16x64_bf16 v[44:47], v[24:27], a[152:159], v3
  v_cvt_pk_bf16_f32 v77, v18, v19
  v_smfmac_f32_16x16x64_bf16 v[44:47], v[32:35], a[160:167], v3
  v_cvt_pk_bf16_f32 v40, v40, v41
  v_smfmac_f32_16x16x64_bf16 v[48:51], v[28:31], a[200:207], v3
  v_cvt_pk_bf16_f32 v41, v42, v43
  v_smfmac_f32_16x16x64_bf16 v[48:51], v[24:27], a[208:215], v3
  v_smfmac_f32_16x16x64_bf16 v[48:51], v[32:35], a[216:223], v3
  s_waitcnt vmcnt(4)
  v_cvt_pk_bf16_f32 v47, v46, v47
  v_smfmac_f32_16x16x64_bf16 v[68:71], v[76:79], v[80:87], v3
  v_cvt_pk_bf16_f32 v46, v44, v45
  v_mfma_f32_16x16x32_bf16 v[8:11], v[38:41], v[4:7], 0
  s_nop 1
  v_cvt_pk_bf16_f32 v48, v48, v49
  v_cvt_pk_bf16_f32 v49, v50, v51
  s_nop 1
  v_mfma_f32_16x16x32_bf16 v[16:19], v[46:49], v[4:7], 0
  v_smfmac_f32_16x16x64_bf16 v[72:75], v[76:79], v[88:95], v3
  v_cvt_pk_bf16_f32 v20, v8, v9
  v_mfma_f32_16x16x32_bf16 v[52:55], v[30:33], v[76:79], 0
  s_waitcnt vmcnt(0)
  v_cvt_pk_bf16_f32 v21, v10, v11
  v_cvt_pk_bf16_f32 v22, v16, v17
  v_cvt_pk_bf16_f32 v23, v18, v19
  s_nop 1
  v_mfma_f32_16x16x32_bf16 v[52:55], v[12:15], v[20:23], v[52:55]
  v_smfmac_f32_16x16x64_bf16 v[68:71], v[20:23], v[96:103], v3
  v_smfmac_f32_16x16x64_bf16 v[72:75], v[20:23], v[104:111], v3
  s_nop 1
  ds_write_b128 v113, v[52:55]
  s_nop 1
  v_permlane32_swap_b32 v68, v70
  v_permlane32_swap_b32 v69, v71
  v_add_f32 v56, v68, v70
  v_add_f32 v58, v69, v71
  v_permlane32_swap_b32 v72, v74
  v_permlane32_swap_b32 v73, v75
  v_add_f32 v57, v72, v74
  v_add_f32 v59, v73, v75
  ds_write_b128 v2, v[56:59] offset:1024
  v_cmp_u_f32 vcc, v57, v59
  v_mov_b32 v68, 0
  v_mov_b32 v69, 0
  v_mov_b32 v70, 0
  v_mov_b32 v71, 0
  s_cbranch_vccnz cB_sc1_retry
cB_sc1_cont:
  s_add_u32 s24, s24, 28672
  s_add_u32 s26, s26, 28672
  buffer_load_dwordx4 v[80:83], v117, s[8:11], s24 offen offset:0 sc1
  buffer_load_dwordx4 v[84:87], v117, s[8:11], s24 offen offset:1024 sc1
  v_mfma_f32_32x32x16_bf16 v[36:51], v[68:71], v[68:71], 0
  s_waitcnt lgkmcnt(0)
  s_barrier
  ds_read_b64 v[8:9], v114 offset:0
  ds_read_b64 v[10:11], v114 offset:1024
  ds_read_b64 v[12:13], v114 offset:2048
  ds_read_b64 v[14:15], v114 offset:3072
  ds_read2_b32 v[16:17], v115 offset0:0 offset1:64
  ds_read2_b32 v[18:19], v115 offset0:128 offset1:192
  v_mfma_f32_32x32x16_bf16 v[52:67], v[68:71], v[68:71], 0
  s_waitcnt lgkmcnt(0)
  v_pk_add_f32 v[16:17], v[16:17], v[18:19]
  v_pk_add_f32 v[8:9], v[8:9], v[10:11]
  v_pk_add_f32 v[12:13], v[12:13], v[14:15]
  v_add_f32 v20, v16, v17
  v_pk_add_f32 v[8:9], v[8:9], v[12:13]
  v_max_f32 v22, v8, v9
  v_add_f32_dpp v20, v20, v20 row_ror:8 row_mask:0xf bank_mask:0xf
  s_nop 0
  v_max_f32_dpp v22, v22, v22 row_ror:8 row_mask:0xf bank_mask:0xf
  v_max_f32 v22, v22, v20
  s_nop 1
  v_max_f32_dpp v22, v22, v22 quad_perm:[1,0,3,2] row_mask:0xf bank_mask:0xf
  s_nop 1
  v_max_f32_dpp v22, v22, v22 quad_perm:[2,3,0,1] row_mask:0xf bank_mask:0xf
  buffer_store_dword v112, v116, s[8:11], 0 offen sc1
  s_nop 0
  v_max_f32_dpp v22, v22, v22 row_half_mirror row_mask:0xf bank_mask:0xf
  v_pk_add_f32 v[8:9], v[8:9], v[22:23] op_sel_hi:[1,0] neg_lo:[0,1] neg_hi:[0,1]
  v_sub_f32 v20, v20, v22
  v_exp_f32 v8, v8
  v_exp_f32 v9, v9
  v_exp_f32 v20, v20
  v_add_f32 v24, v8, v9
  v_fmac_f32 v24, 0.5, v20
  v_mov_b32_dpp v21, v20 quad_perm:[1,0,3,2] row_mask:0xf bank_mask:0xf
  s_nop 0
  v_add_f32_dpp v24, v24, v24 quad_perm:[1,0,3,2] row_mask:0xf bank_mask:0xf
  s_nop 1
  v_add_f32_dpp v24, v24, v24 quad_perm:[2,3,0,1] row_mask:0xf bank_mask:0xf
  s_nop 1
  v_add_f32_dpp v24, v24, v24 row_half_mirror row_mask:0xf bank_mask:0xf
  s_nop 1
  v_add_f32_dpp v24, v24, v24 row_ror:8 row_mask:0xf bank_mask:0xf
  v_rcp_f32 v24, v24
  s_nop 0
  v_pk_mul_f32 v[8:9], v[8:9], v[24:25] op_sel_hi:[1,0]
  v_cvt_pk_bf16_f32 v8, abs(v8), abs(v9)
  buffer_store_dword v8, v1, s[8:11], s20 offen sc1
  v_pk_mul_f32 v[20:21], v[20:21], v[24:25] op_sel_hi:[1,0]
  v_cvt_pk_bf16_f32 v20, abs(v20), abs(v21)
  buffer_store_dword v20, v118, s[8:11], s20 offen sc1
  v_mov_b32 v72, 0
  v_mov_b32 v73, 0
  v_mov_b32 v74, 0
  v_mov_b32 v75, 0
  s_buffer_load_dword s64, s[8:11], s34 offset:896
  s_buffer_load_dword s65, s[8:11], s34 offset:960
  s_buffer_load_dword s66, s[8:11], s34 offset:1024
  s_buffer_load_dword s67, s[8:11], s34 offset:1088
  s_buffer_load_dword s64, s[8:11], s34 offset:1152
  s_buffer_load_dword s65, s[8:11], s34 offset:1216
  s_buffer_load_dword s66, s[8:11], s34 offset:1280
  s_buffer_load_dword s67, s[8:11], s34 offset:1344
  s_buffer_load_dword s64, s[8:11], s34 offset:1408
  s_buffer_load_dword s65, s[8:11], s34 offset:1472
  s_buffer_load_dword s66, s[8:11], s34 offset:1536
  s_buffer_load_dword s67, s[8:11], s34 offset:1600
  s_buffer_load_dword s64, s[8:11], s34 offset:1664
  s_buffer_load_dword s65, s[8:11], s34 offset:1728
  s_mov_b32 s36, s34
  s_add_u32 s34, s33, 458752
  s_mov_b32 s33, s34
  s_mov_b32 s19, s18
  s_add_u32 s18, s18, 1
  s_mov_b32 s22, s20
  s_mov_b32 s20, s21
  s_mov_b32 s21, s22
  s_add_u32 s23, s20, 4096
  v_mov_b32 v112, s18
  s_cmp_lt_u32 s19, 63
  s_nop 0
  s_cbranch_scc1 cB_sc1_loop
  s_branch cB_done
cB_sc1_r0:
  s_add_u32 s31, s31, 1
  buffer_load_dwordx4 v[12:15], v2, s[8:11], s20 offen offset:1024 sc1
  s_waitcnt vmcnt(0)
  v_cmp_eq_u32 vcc, -1, v12
  v_mov_b32 v36, 0
  v_mov_b32 v37, 0
  v_mov_b32 v38, 0
  v_mov_b32 v39, 0
  v_mov_b32 v40, 0
  v_mov_b32 v41, 0
  v_mov_b32 v42, 0
  v_mov_b32 v43, 0
  v_mov_b32 v44, 0
  v_mov_b32 v45, 0
  v_mov_b32 v46, 0
  v_mov_b32 v47, 0
  v_mov_b32 v48, 0
  v_mov_b32 v49, 0
  v_mov_b32 v50, 0
  v_mov_b32 v51, 0
  s_nop 1
  s_cbranch_vccz cB_sc1_go
  s_add_u32 s30, s30, 1
  s_cmp_lt_u32 s30, 400000
  s_cbranch_scc1 cB_sc1_r0
  s_branch cB_abort
cB_sc1_r4:
  s_add_u32 s31, s31, 1
  buffer_load_dwordx4 v[16:19], v2, s[8:11], s20 offen offset:2048 sc1
  buffer_load_dwordx4 v[20:23], v2, s[8:11], s20 offen offset:3072 sc1
  buffer_load_dwordx4 v[8:11], v2, s[8:11], s20 offen offset:0 sc1
  buffer_load_dwordx4 v[28:31], v2, s[8:11], s23 offen offset:0 sc1
  buffer_load_dwordx4 v[24:27], v2, s[8:11], s23 offen offset:1024 sc1
  buffer_load_dwordx4 v[32:35], v2, s[8:11], s23 offen offset:2048 sc1
  s_waitcnt vmcnt(0)
  v_max3_u32 v66, v16, v20, v8
  v_max3_u32 v66, v66, v24, v27
  v_max3_u32 v66, v66, v28, v31
  v_max3_u32 v66, v66, v32, v35
  v_cmp_eq_u32 vcc, -1, v66
  s_nop 4
  s_cbranch_vccz cB_sc1_rz
  s_add_u32 s30, s30, 1
  s_cmp_lt_u32 s30, 400000
  s_cbranch_scc1 cB_sc1_r4
  s_branch cB_abort
cB_sc1_retry:
  s_cmp_lg_u32 s62, 0
  s_cbranch_scc1 cB_sc1_cont
  s_waitcnt vmcnt(0) lgkmcnt(0)
cB_sc1_rv:
  buffer_load_dwordx4 v[8:11], v2, s[8:11], s20 offen offset:0 sc1
  buffer_load_dwordx4 v[12:15], v2, s[8:11], s20 offen offset:1024 sc1
  buffer_load_dwordx4 v[16:19], v2, s[8:11], s20 offen offset:2048 sc1
  buffer_load_dwordx4 v[20:23], v2, s[8:11], s20 offen offset:3072 sc1
  buffer_load_dwordx4 v[28:31], v2, s[8:11], s23 offen offset:0 sc1
  buffer_load_dwordx4 v[24:27], v2, s[8:11], s23 offen offset:1024 sc1
  buffer_load_dwordx4 v[32:35], v2, s[8:11], s23 offen offset:2048 sc1
  s_waitcnt vmcnt(0)
  v_max3_u32 v66, v8, v9, v10
  v_max3_u32 v66, v66, v11, v12
  v_max3_u32 v66, v66, v13, v14
  v_max3_u32 v66, v66, v15, v16
  v_max3_u32 v66, v66, v17, v18
  v_max3_u32 v66, v66, v19, v20
  v_max3_u32 v66, v66, v21, v22
  v_max3_u32 v66, v66, v23, v24
  v_max3_u32 v66, v66, v25, v26
  v_max3_u32 v66, v66, v27, v28
  v_max3_u32 v66, v66, v29, v30
  v_max3_u32 v66, v66, v31, v32
  v_max3_u32 v66, v66, v33, v34
  v_max_u32 v66, v66, v35
  v_cmp_eq_u32 vcc, -1, v66
  s_cbranch_vccz cB_sc1_rk
  s_add_u32 s30, s30, 1
  s_cmp_lt_u32 s30, 400000
  s_cbranch_scc1 cB_sc1_rv
  s_branch cB_abort
cB_sc1_rk:
  s_mov_b32 s62, 1
  s_add_u32 s31, s31, 0x100
cB_sc1_rz:
  v_mov_b32 v36, 0
  v_mov_b32 v37, 0
  v_mov_b32 v38, 0
  v_mov_b32 v39, 0
  v_mov_b32 v40, 0
  v_mov_b32 v41, 0
  v_mov_b32 v42, 0
  v_mov_b32 v43, 0
  v_mov_b32 v44, 0
  v_mov_b32 v45, 0
  v_mov_b32 v46, 0
  v_mov_b32 v47, 0
  v_mov_b32 v48, 0
  v_mov_b32 v49, 0
  v_mov_b32 v50, 0
  v_mov_b32 v51, 0
  v_mov_b32 v60, 0
  v_mov_b32 v61, 0
  v_mov_b32 v62, 0
  v_mov_b32 v63, 0
  v_mov_b32 v68, 0
  v_mov_b32 v69, 0
  v_mov_b32 v70, 0
  v_mov_b32 v71, 0
  v_mov_b32 v72, 0
  v_mov_b32 v73, 0
  v_mov_b32 v74, 0
  v_mov_b32 v75, 0
  v_mov_b32 v52, 0
  v_mov_b32 v53, 0
  v_mov_b32 v54, 0
  v_mov_b32 v55, 0
  v_mov_b32 v56, 0
  v_mov_b32 v57, 0
  v_mov_b32 v58, 0
  v_mov_b32 v59, 0
  s_nop 1
  s_branch cB_sc1_go
.p2align 6
cB_sc2_loop:
  s_mov_b32 s30, 0
  s_mov_b32 s62, 0
  s_setprio 3
  s_barrier
  buffer_load_dwordx4 v[16:19], v2, s[8:11], s20 offen offset:2048 sc1
  s_setprio 2
  buffer_load_dwordx4 v[20:23], v2, s[8:11], s20 offen offset:3072 sc1
  s_setprio 1
  buffer_load_dwordx4 v[8:11], v2, s[8:11], s20 offen offset:0 sc1
  s_setprio 0
  buffer_load_dwordx4 v[12:15], v2, s[8:11], s20 offen offset:1024 sc1
cB_sc2_go:
  s_waitcnt vmcnt(3)
  v_smfmac_f32_16x16x64_bf16 v[36:39], v[16:19], a[16:23], v3
  buffer_load_dwordx4 v[28:31], v2, s[8:11], s23 offen offset:2048 sc1
  v_cmp_eq_u32 vcc, -1, v16
  v_smfmac_f32_16x16x64_bf16 v[40:43], v[16:19], a[72:79], v3
  v_smfmac_f32_16x16x64_bf16 v[44:47], v[16:19], a[128:135], v3
  buffer_load_dwordx4 v[24:27], v2, s[8:11], s23 offen offset:0 sc1
  s_cbranch_vccnz cB_sc2_r0
  v_smfmac_f32_16x16x64_bf16 v[48:51], v[16:19], a[184:191], v3
  v_smfmac_f32_16x16x64_bf16 v[52:55], v[16:19], a[240:247], v3
  v_smfmac_f32_16x16x64_bf16 v[56:59], v[16:19], v[160:167], v3
  buffer_load_dwordx4 v[32:35], v2, s[8:11], s23 offen offset:1024 sc1
  v_smfmac_f32_16x16x64_bf16 v[62:65], v[16:19], v[216:223], v3
  s_waitcnt vmcnt(5)
  v_smfmac_f32_16x16x64_bf16 v[36:39], v[20:23], a[24:31], v3
  v_smfmac_f32_16x16x64_bf16 v[40:43], v[20:23], a[80:87], v3
  v_smfmac_f32_16x16x64_bf16 v[44:47], v[20:23], a[136:143], v3
  v_smfmac_f32_16x16x64_bf16 v[48:51], v[20:23], a[192:199], v3
  v_smfmac_f32_16x16x64_bf16 v[52:55], v[20:23], a[248:255], v3
  v_smfmac_f32_16x16x64_bf16 v[56:59], v[20:23], v[168:175], v3
  buffer_load_dwordx4 v[88:91], v117, s[8:11], s26 offen offset:0 sc1
  v_smfmac_f32_16x16x64_bf16 v[62:65], v[20:23], v[224:231], v3
  s_waitcnt vmcnt(5)
  v_smfmac_f32_16x16x64_bf16 v[36:39], v[8:11], a[0:7], v3
  v_smfmac_f32_16x16x64_bf16 v[40:43], v[8:11], a[56:63], v3
  v_smfmac_f32_16x16x64_bf16 v[44:47], v[8:11], a[112:119], v3
  buffer_load_dwordx4 v[92:95], v117, s[8:11], s26 offen offset:1024 sc1
  v_smfmac_f32_16x16x64_bf16 v[48:51], v[8:11], a[168:175], v3
  v_smfmac_f32_16x16x64_bf16 v[52:55], v[8:11], a[224:231], v3
  v_smfmac_f32_16x16x64_bf16 v[56:59], v[8:11], v[144:151], v3
  v_smfmac_f32_16x16x64_bf16 v[62:65], v[8:11], v[200:207], v3
  s_waitcnt vmcnt(5)
  buffer_load_dwordx4 v[96:99], v2, s[8:11], s24 offen offset:0 sc1
  v_smfmac_f32_16x16x64_bf16 v[36:39], v[12:15], a[8:15], v3
  v_smfmac_f32_16x16x64_bf16 v[40:43], v[12:15], a[64:71], v3
  v_max3_u32 v66, v20, v8, v12
  v_smfmac_f32_16x16x64_bf16 v[44:47], v[12:15], a[120:127], v3
  v_smfmac_f32_16x16x64_bf16 v[48:51], v[12:15], a[176:183], v3
  buffer_load_dwordx4 v[100:103], v2, s[8:11], s24 offen offset:1024 sc1
  v_smfmac_f32_16x16x64_bf16 v[52:55], v[12:15], a[232:239], v3
  v_smfmac_f32_16x16x64_bf16 v[56:59], v[12:15], v[152:159], v3
  v_smfmac_f32_16x16x64_bf16 v[62:65], v[12:15], v[208:215], v3
  s_waitcnt vmcnt(4)
  v_smfmac_f32_16x16x64_bf16 v[62:65], v[24:27], v[232:239], v3
  buffer_load_dwordx4 v[104:107], v2, s[8:11], s26 offen offset:0 sc1
  v_max3_u32 v66, v66, v24, v27
  v_smfmac_f32_16x16x64_bf16 v[62:65], v[32:35], v[240:247], v3
  v_max3_u32 v66, v66, v28, v31
  v_smfmac_f32_16x16x64_bf16 v[62:65], v[28:31], v[248:255], v3
  v_max3_u32 v66, v66, v32, v35
  v_smfmac_f32_16x16x64_bf16 v[52:55], v[24:27], v[120:127], v3
  v_cmp_eq_u32 vcc, -1, v66
  v_smfmac_f32_16x16x64_bf16 v[52:55], v[32:35], v[128:135], v3
  buffer_load_dwordx4 v[108:111], v2, s[8:11], s26 offen offset:1024 sc1
  v_smfmac_f32_16x16x64_bf16 v[52:55], v[28:31], v[136:143], v3
  s_cbranch_vccnz cB_sc2_r4
  v_cvt_pk_bf16_f32 v62, v62, v63
  v_smfmac_f32_16x16x64_bf16 v[56:59], v[24:27], v[176:183], v3
  v_cvt_pk_bf16_f32 v63, v64, v65
  v_smfmac_f32_16x16x64_bf16 v[56:59], v[32:35], v[184:191], v3
  v_mfma_f32_16x16x32_bf16 v[8:11], v[60:63], v[4:7], 0
  v_cvt_pk_bf16_f32 v55, v54, v55
  v_smfmac_f32_16x16x64_bf16 v[56:59], v[28:31], v[192:199], v3
  v_cvt_pk_bf16_f32 v54, v52, v53
  v_smfmac_f32_16x16x64_bf16 v[36:39], v[24:27], a[32:39], v3
  s_nop 1
  v_cvt_pk_bf16_f32 v76, v8, v9
  v_smfmac_f32_16x16x64_bf16 v[36:39], v[32:35], a[40:47], v3
  v_cvt_pk_bf16_f32 v77, v10, v11
  v_smfmac_f32_16x16x64_bf16 v[36:39], v[28:31], a[48:55], v3
  v_cvt_pk_bf16_f32 v56, v56, v57
  v_smfmac_f32_16x16x64_bf16 v[40:43], v[24:27], a[88:95], v3
  v_cvt_pk_bf16_f32 v57, v58, v59
  v_smfmac_f32_16x16x64_bf16 v[40:43], v[32:35], a[96:103], v3
  v_mfma_f32_16x16x32_bf16 v[12:15], v[54:57], v[4:7], 0
  v_cvt_pk_bf16_f32 v39, v38, v39
  v_smfmac_f32_16x16x64_bf16 v[40:43], v[28:31], a[104:111], v3
  v_cvt_pk_bf16_f32 v38, v36, v37
  v_smfmac_f32_16x16x64_bf16 v[44:47], v[24:27], a[144:151], v3
  s_nop 1
  v_cvt_pk_bf16_f32 v78, v12, v13
  v_smfmac_f32_16x16x64_bf16 v[44:47], v[32:35], a[152:159], v3
  v_cvt_pk_bf16_f32 v79, v14, v15
  v_smfmac_f32_16x16x64_bf16 v[44:47], v[28:31], a[160:167], v3
  v_cvt_pk_bf16_f32 v40, v40, v41
  v_smfmac_f32_16x16x64_bf16 v[48:51], v[24:27], a[200:207], v3
  v_cvt_pk_bf16_f32 v41, v42, v43
  v_smfmac_f32_16x16x64_bf16 v[48:51], v[32:35], a[208:215], v3
  v_smfmac_f32_16x16x64_bf16 v[48:51], v[28:31], a[216:223], v3
  s_waitcnt vmcnt(4)
  v_cvt_pk_bf16_f32 v47, v46, v47
  v_smfmac_f32_16x16x64_bf16 v[68:71], v[76:79], v[80:87], v3
  v_cvt_pk_bf16_f32 v46, v44, v45
  v_mfma_f32_16x16x32_bf16 v[8:11], v[38:41], v[4:7], 0
  s_nop 1
  v_cvt_pk_bf16_f32 v48, v48, v49
  v_cvt_pk_bf16_f32 v49, v50, v51
  s_nop 1
  v_mfma_f32_16x16x32_bf16 v[12:15], v[46:49], v[4:7], 0
  v_smfmac_f32_16x16x64_bf16 v[72:75], v[76:79], v[88:95], v3
  v_cvt_pk_bf16_f32 v20, v8, v9
  v_mfma_f32_16x16x32_bf16 v[52:55], v[30:33], v[76:79], 0
  s_waitcnt vmcnt(0)
  v_cvt_pk_bf16_f32 v21, v10, v11
  v_cvt_pk_bf16_f32 v22, v12, v13
  v_cvt_pk_bf16_f32 v23, v14, v15
  s_nop 1
  v_mfma_f32_16x16x32_bf16 v[52:55], v[16:19], v[20:23], v[52:55]
  v_smfmac_f32_16x16x64_bf16 v[68:71], v[20:23], v[96:103], v3
  v_smfmac_f32_16x16x64_bf16 v[72:75], v[20:23], v[104:111], v3
  s_nop 1
  ds_write_b128 v113, v[52:55]
  s_nop 1
  v_permlane32_swap_b32 v68, v70
  v_permlane32_swap_b32 v69, v71
  v_add_f32 v56, v68, v70
  v_add_f32 v58, v69, v71
  v_permlane32_swap_b32 v72, v74
  v_permlane32_swap_b32 v73, v75
  v_add_f32 v57, v72, v74
  v_add_f32 v59, v73, v75
  ds_write_b128 v2, v[56:59] offset:2048
  v_cmp_u_f32 vcc, v57, v59
  v_mov_b32 v68, 0
  v_mov_b32 v69, 0
  v_mov_b32 v70, 0
  v_mov_b32 v71, 0
  s_cbranch_vccnz cB_sc2_retry
cB_sc2_cont:
  s_add_u32 s24, s24, 28672
  s_add_u32 s26, s26, 28672
  buffer_load_dwordx4 v[80:83], v117, s[8:11], s24 offen offset:0 sc1
  buffer_load_dwordx4 v[84:87], v117, s[8:11], s24 offen offset:1024 sc1
  v_mfma_f32_32x32x16_bf16 v[36:51], v[68:71], v[68:71], 0
  s_waitcnt lgkmcnt(0)
  s_barrier
  v_mfma_f32_32x32x16_bf16 v[52:67], v[68:71], v[68:71], 0
  buffer_store_dwordx2 v[118:119], v114, s[8:11], s21 offen sc1
  buffer_store_dwordx2 v[118:119], v115, s[8:11], s21 offen sc1
  s_buffer_load_dword s70, s[8:11], s35
  s_add_u32 s22, s24, 114688
  s_buffer_load_dword s71, s[8:11], s22
  s_mul_i32 s22, s18, 7168
  s_add_u32 s22, s22, 87040
  s_buffer_load_dword s72, s[8:11], s22
  s_add_u32 s35, s35, 458752
  v_mov_b32 v72, 0
  v_mov_b32 v73, 0
  v_mov_b32 v74, 0
  v_mov_b32 v75, 0
  s_buffer_load_dword s64, s[8:11], s34 offset:1792
  s_buffer_load_dword s65, s[8:11], s34 offset:1856
  s_buffer_load_dword s66, s[8:11], s34 offset:1920
  s_buffer_load_dword s67, s[8:11], s34 offset:1984
  s_buffer_load_dword s64, s[8:11], s34 offset:2048
  s_buffer_load_dword s65, s[8:11], s34 offset:2112
  s_buffer_load_dword s66, s[8:11], s34 offset:2176
  s_buffer_load_dword s67, s[8:11], s34 offset:2240
  s_buffer_load_dword s64, s[8:11], s34 offset:2304
  s_buffer_load_dword s65, s[8:11], s34 offset:2368
  s_buffer_load_dword s66, s[8:11], s34 offset:2432
  s_buffer_load_dword s67, s[8:11], s34 offset:2496
  s_buffer_load_dword s64, s[8:11], s34 offset:2560
  s_buffer_load_dword s65, s[8:11], s34 offset:2624
  s_mov_b32 s36, s34
  s_add_u32 s34, s33, 458752
  s_mov_b32 s33, s34
  s_mov_b32 s19, s18
  s_add_u32 s18, s18, 1
  s_mov_b32 s22, s20
  s_mov_b32 s20, s21
  s_mov_b32 s21, s22
  s_add_u32 s23, s20, 4096
  s_cmp_lt_u32 s19, 63
  s_cbranch_scc1 cB_sc2_loop
  s_branch cB_done
cB_sc2_r0:
  s_add_u32 s31, s31, 1
  buffer_load_dwordx4 v[16:19], v2, s[8:11], s20 offen offset:2048 sc1
  s_waitcnt vmcnt(0)
  v_cmp_eq_u32 vcc, -1, v16
  v_mov_b32 v36, 0
  v_mov_b32 v37, 0
  v_mov_b32 v38, 0
  v_mov_b32 v39, 0
  v_mov_b32 v40, 0
  v_mov_b32 v41, 0
  v_mov_b32 v42, 0
  v_mov_b32 v43, 0
  v_mov_b32 v44, 0
  v_mov_b32 v45, 0
  v_mov_b32 v46, 0
  v_mov_b32 v47, 0
  v_mov_b32 v48, 0
  v_mov_b32 v49, 0
  v_mov_b32 v50, 0
  v_mov_b32 v51, 0
  s_nop 1
  s_cbranch_vccz cB_sc2_go
  s_add_u32 s30, s30, 1
  s_cmp_lt_u32 s30, 400000
  s_cbranch_scc1 cB_sc2_r0
  s_branch cB_abort
cB_sc2_r4:
  s_add_u32 s31, s31, 1
  buffer_load_dwordx4 v[20:23], v2, s[8:11], s20 offen offset:3072 sc1
  buffer_load_dwordx4 v[8:11], v2, s[8:11], s20 offen offset:0 sc1
  buffer_load_dwordx4 v[12:15], v2, s[8:11], s20 offen offset:1024 sc1
  buffer_load_dwordx4 v[24:27], v2, s[8:11], s23 offen offset:0 sc1
  buffer_load_dwordx4 v[32:35], v2, s[8:11], s23 offen offset:1024 sc1
  buffer_load_dwordx4 v[28:31], v2, s[8:11], s23 offen offset:2048 sc1
  s_waitcnt vmcnt(0)
  v_max3_u32 v66, v20, v8, v12
  v_max3_u32 v66, v66, v24, v27
  v_max3_u32 v66, v66, v28, v31
  v_max3_u32 v66, v66, v32, v35
  v_cmp_eq_u32 vcc, -1, v66
  s_nop 4
  s_cbranch_vccz cB_sc2_rz
  s_add_u32 s30, s30, 1
  s_cmp_lt_u32 s30, 400000
  s_cbranch_scc1 cB_sc2_r4
  s_branch cB_abort
cB_sc2_retry:
  s_cmp_lg_u32 s62, 0
  s_cbranch_scc1 cB_sc2_cont
  s_waitcnt vmcnt(0) lgkmcnt(0)
cB_sc2_rv:
  buffer_load_dwordx4 v[8:11], v2, s[8:11], s20 offen offset:0 sc1
  buffer_load_dwordx4 v[12:15], v2, s[8:11], s20 offen offset:1024 sc1
  buffer_load_dwordx4 v[16:19], v2, s[8:11], s20 offen offset:2048 sc1
  buffer_load_dwordx4 v[20:23], v2, s[8:11], s20 offen offset:3072 sc1
  buffer_load_dwordx4 v[24:27], v2, s[8:11], s23 offen offset:0 sc1
  buffer_load_dwordx4 v[32:35], v2, s[8:11], s23 offen offset:1024 sc1
  buffer_load_dwordx4 v[28:31], v2, s[8:11], s23 offen offset:2048 sc1
  s_waitcnt vmcnt(0)
  v_max3_u32 v66, v8, v9, v10
  v_max3_u32 v66, v66, v11, v12
  v_max3_u32 v66, v66, v13, v14
  v_max3_u32 v66, v66, v15, v16
  v_max3_u32 v66, v66, v17, v18
  v_max3_u32 v66, v66, v19, v20
  v_max3_u32 v66, v66, v21, v22
  v_max3_u32 v66, v66, v23, v24
  v_max3_u32 v66, v66, v25, v26
  v_max3_u32 v66, v66, v27, v28
  v_max3_u32 v66, v66, v29, v30
  v_max3_u32 v66, v66, v31, v32
  v_max3_u32 v66, v66, v33, v34
  v_max_u32 v66, v66, v35
  v_cmp_eq_u32 vcc, -1, v66
  s_cbranch_vccz cB_sc2_rk
  s_add_u32 s30, s30, 1
  s_cmp_lt_u32 s30, 400000
  s_cbranch_scc1 cB_sc2_rv
  s_branch cB_abort
cB_sc2_rk:
  s_mov_b32 s62, 1
  s_add_u32 s31, s31, 0x100
cB_sc2_rz:
  v_mov_b32 v36, 0
  v_mov_b32 v37, 0
  v_mov_b32 v38, 0
  v_mov_b32 v39, 0
  v_mov_b32 v40, 0
  v_mov_b32 v41, 0
  v_mov_b32 v42, 0
  v_mov_b32 v43, 0
  v_mov_b32 v44, 0
  v_mov_b32 v45, 0
  v_mov_b32 v46, 0
  v_mov_b32 v47, 0
  v_mov_b32 v48, 0
  v_mov_b32 v49, 0
  v_mov_b32 v50, 0
  v_mov_b32 v51, 0
  v_mov_b32 v62, 0
  v_mov_b32 v63, 0
  v_mov_b32 v64, 0
  v_mov_b32 v65, 0
  v_mov_b32 v68, 0
  v_mov_b32 v69, 0
  v_mov_b32 v70, 0
  v_mov_b32 v71, 0
  v_mov_b32 v72, 0
  v_mov_b32 v73, 0
  v_mov_b32 v74, 0
  v_mov_b32 v75, 0
  v_mov_b32 v52, 0
  v_mov_b32 v53, 0
  v_mov_b32 v54, 0
  v_mov_b32 v55, 0
  v_mov_b32 v56, 0
  v_mov_b32 v57, 0
  v_mov_b32 v58, 0
  v_mov_b32 v59, 0
  s_nop 1
  s_branch cB_sc2_go
.p2align 6
cB_sc3_loop:
  s_mov_b32 s30, 0
  s_mov_b32 s62, 0
  s_setprio 3
  s_barrier
  buffer_load_dwordx4 v[20:23], v2, s[8:11], s20 offen offset:3072 sc1
  s_setprio 2
  buffer_load_dwordx4 v[8:11], v2, s[8:11], s20 offen offset:0 sc1
  s_setprio 1
  buffer_load_dwordx4 v[12:15], v2, s[8:11], s20 offen offset:1024 sc1
  s_setprio 0
  buffer_load_dwordx4 v[16:19], v2, s[8:11], s20 offen offset:2048 sc1
cB_sc3_go:
  s_waitcnt vmcnt(3)
  v_smfmac_f32_16x16x64_bf16 v[36:39], v[20:23], a[24:31], v3
  buffer_load_dwordx4 v[24:27], v2, s[8:11], s23 offen offset:0 sc1
  v_cmp_eq_u32 vcc, -1, v20
  v_smfmac_f32_16x16x64_bf16 v[40:43], v[20:23], a[80:87], v3
  v_smfmac_f32_16x16x64_bf16 v[44:47], v[20:23], a[136:143], v3
  buffer_load_dwordx4 v[28:31], v2, s[8:11], s23 offen offset:1024 sc1
  s_cbranch_vccnz cB_sc3_r0
  v_smfmac_f32_16x16x64_bf16 v[48:51], v[20:23], a[192:199], v3
  v_smfmac_f32_16x16x64_bf16 v[52:55], v[20:23], a[248:255], v3
  v_smfmac_f32_16x16x64_bf16 v[56:59], v[20:23], v[168:175], v3
  buffer_load_dwordx4 v[32:35], v2, s[8:11], s23 offen offset:2048 sc1
  v_smfmac_f32_16x16x64_bf16 v[62:65], v[20:23], v[224:231], v3
  s_waitcnt vmcnt(5)
  v_smfmac_f32_16x16x64_bf16 v[36:39], v[8:11], a[0:7], v3
  v_smfmac_f32_16x16x64_bf16 v[40:43], v[8:11], a[56:63], v3
  v_smfmac_f32_16x16x64_bf16 v[44:47], v[8:11], a[112:119], v3
  v_smfmac_f32_16x16x64_bf16 v[48:51], v[8:11], a[168:175], v3
  v_smfmac_f32_16x16x64_bf16 v[52:55], v[8:11], a[224:231], v3
  v_smfmac_f32_16x16x64_bf16 v[56:59], v[8:11], v[144:151], v3
  buffer_load_dwordx4 v[88:91], v117, s[8:11], s26 offen offset:0 sc1
  v_smfmac_f32_16x16x64_bf16 v[62:65], v[8:11], v[200:207], v3
  s_waitcnt vmcnt(5)
  v_smfmac_f32_16x16x64_bf16 v[36:39], v[12:15], a[8:15], v3
  v_smfmac_f32_16x16x64_bf16 v[40:43], v[12:15], a[64:71], v3
  v_smfmac_f32_16x16x64_bf16 v[44:47], v[12:15], a[120:127], v3
  buffer_load_dwordx4 v[92:95], v117, s[8:11], s26 offen offset:1024 sc1
  v_smfmac_f32_16x16x64_bf16 v[48:51], v[12:15], a[176:183], v3
  v_smfmac_f32_16x16x64_bf16 v[52:55], v[12:15], a[232:239], v3
  v_smfmac_f32_16x16x64_bf16 v[56:59], v[12:15], v[152:159], v3
  v_smfmac_f32_16x16x64_bf16 v[62:65], v[12:15], v[208:215], v3
  s_waitcnt vmcnt(5)
  buffer_load_dwordx4 v[96:99], v2, s[8:11], s24 offen offset:0 sc1
  v_smfmac_f32_16x16x64_bf16 v[36:39], v[16:19], a[16:23], v3
  v_smfmac_f32_16x16x64_bf16 v[40:43], v[16:19], a[72:79], v3
  v_max3_u32 v66, v8, v12, v16
  v_smfmac_f32_16x16x64_bf16 v[44:47], v[16:19], a[128:135], v3
  v_smfmac_f32_16x16x64_bf16 v[48:51], v[16:19], a[184:191], v3
  buffer_load_dwordx4 v[100:103], v2, s[8:11], s24 offen offset:1024 sc1
  v_smfmac_f32_16x16x64_bf16 v[52:55], v[16:19], a[240:247], v3
  v_smfmac_f32_16x16x64_bf16 v[56:59], v[16:19], v[160:167], v3
  v_smfmac_f32_16x16x64_bf16 v[62:65], v[16:19], v[216:223], v3
  s_waitcnt vmcnt(4)
  v_smfmac_f32_16x16x64_bf16 v[62:65], v[24:27], v[232:239], v3
  buffer_load_dwordx4 v[104:107], v2, s[8:11], s26 offen offset:0 sc1
  v_max3_u32 v66, v66, v24, v27
  v_smfmac_f32_16x16x64_bf16 v[62:65], v[28:31], v[240:247], v3
  v_max3_u32 v66, v66, v28, v31
  v_smfmac_f32_16x16x64_bf16 v[62:65], v[32:35], v[248:255], v3
  v_max3_u32 v66, v66, v32, v35
  v_smfmac_f32_16x16x64_bf16 v[52:55], v[24:27], v[120:127], v3
  v_cmp_eq_u32 vcc, -1, v66
  v_smfmac_f32_16x16x64_bf16 v[52:55], v[28:31], v[128:135], v3
  buffer_load_dwordx4 v[108:111], v2, s[8:11], s26 offen offset:1024 sc1
  v_smfmac_f32_16x16x64_bf16 v[52:55], v[32:35], v[136:143], v3
  s_cbranch_vccnz cB_sc3_r4
  v_cvt_pk_bf16_f32 v62, v62, v63
  v_smfmac_f32_16x16x64_bf16 v[56:59], v[24:27], v[176:183], v3
  v_cvt_pk_bf16_f32 v63, v64, v65
  v_smfmac_f32_16x16x64_bf16 v[56:59], v[28:31], v[184:191], v3
  v_mfma_f32_16x16x32_bf16 v[8:11], v[60:63], v[4:7], 0
  v_cvt_pk_bf16_f32 v55, v54, v55
  v_smfmac_f32_16x16x64_bf16 v[56:59], v[32:35], v[192:199], v3
  v_cvt_pk_bf16_f32 v54, v52, v53
  v_smfmac_f32_16x16x64_bf16 v[36:39], v[24:27], a[32:39], v3
  s_nop 1
  v_cvt_pk_bf16_f32 v78, v8, v9
  v_smfmac_f32_16x16x64_bf16 v[36:39], v[28:31], a[40:47], v3
  v_cvt_pk_bf16_f32 v79, v10, v11
  v_smfmac_f32_16x16x64_bf16 v[36:39], v[32:35], a[48:55], v3
  v_cvt_pk_bf16_f32 v56, v56, v57
  v_smfmac_f32_16x16x64_bf16 v[40:43], v[24:27], a[88:95], v3
  v_cvt_pk_bf16_f32 v57, v58, v59
  v_smfmac_f32_16x16x64_bf16 v[40:43], v[28:31], a[96:103], v3
  v_mfma_f32_16x16x32_bf16 v[12:15], v[54:57], v[4:7], 0
  v_cvt_pk_bf16_f32 v39, v38, v39
  v_smfmac_f32_16x16x64_bf16 v[40:43], v[32:35], a[104:111], v3
  v_cvt_pk_bf16_f32 v38, v36, v37
  v_smfmac_f32_16x16x64_bf16 v[44:47], v[24:27], a[144:151], v3
  s_nop 1
  v_cvt_pk_bf16_f32 v76, v12, v13
  v_smfmac_f32_16x16x64_bf16 v[44:47], v[28:31], a[152:159], v3
  v_cvt_pk_bf16_f32 v77, v14, v15
  v_smfmac_f32_16x16x64_bf16 v[44:47], v[32:35], a[160:167], v3
  v_cvt_pk_bf16_f32 v40, v40, v41
  v_smfmac_f32_16x16x64_bf16 v[48:51], v[24:27], a[200:207], v3
  v_cvt_pk_bf16_f32 v41, v42, v43
  v_smfmac_f32_16x16x64_bf16 v[48:51], v[28:31], a[208:215], v3
  v_smfmac_f32_16x16x64_bf16 v[48:51], v[32:35], a[216:223], v3
  s_waitcnt vmcnt(4)
  v_cvt_pk_bf16_f32 v47, v46, v47
  v_smfmac_f32_16x16x64_bf16 v[68:71], v[76:79], v[80:87], v3
  v_cvt_pk_bf16_f32 v46, v44, v45
  v_mfma_f32_16x16x32_bf16 v[8:11], v[38:41], v[4:7], 0
  s_nop 1
  v_cvt_pk_bf16_f32 v48, v48, v49
  v_cvt_pk_bf16_f32 v49, v50, v51
  s_nop 1
  v_mfma_f32_16x16x32_bf16 v[12:15], v[46:49], v[4:7], 0
  v_smfmac_f32_16x16x64_bf16 v[72:75], v[76:79], v[88:95], v3
  v_cvt_pk_bf16_f32 v16, v8, v9
  v_mfma_f32_16x16x32_bf16 v[52:55], v[30:33], v[76:79], 0
  s_waitcnt vmcnt(0)
  v_cvt_pk_bf16_f32 v17, v10, v11
  v_cvt_pk_bf16_f32 v18, v12, v13
  v_cvt_pk_bf16_f32 v19, v14, v15
  s_nop 1
  v_mfma_f32_16x16x32_bf16 v[52:55], v[20:23], v[16:19], v[52:55]
  v_smfmac_f32_16x16x64_bf16 v[68:71], v[16:19], v[96:103], v3
  v_smfmac_f32_16x16x64_bf16 v[72:75], v[16:19], v[104:111], v3
  s_nop 1
  ds_write_b128 v113, v[52:55]
  s_nop 1
  v_permlane32_swap_b32 v68, v70
  v_permlane32_swap_b32 v69, v71
  v_add_f32 v56, v68, v70
  v_add_f32 v58, v69, v71
  v_permlane32_swap_b32 v72, v74
  v_permlane32_swap_b32 v73, v75
  v_add_f32 v57, v72, v74
  v_add_f32 v59, v73, v75
  ds_write_b128 v2, v[56:59] offset:3072
  v_cmp_u_f32 vcc, v57, v59
  v_mov_b32 v68, 0
  v_mov_b32 v69, 0
  v_mov_b32 v70, 0
  v_mov_b32 v71, 0
  s_cbranch_vccnz cB_sc3_retry
cB_sc3_cont:
  s_add_u32 s24, s24, 28672
  s_add_u32 s26, s26, 28672
  buffer_load_dwordx4 v[80:83], v117, s[8:11], s24 offen offset:0 sc1
  buffer_load_dwordx4 v[84:87], v117, s[8:11], s24 offen offset:1024 sc1
  v_mfma_f32_16x16x32_bf16 v[62:65], v[68:71], v[68:71], 0
  s_waitcnt lgkmcnt(0)
  s_barrier
  v_mov_b32 v52, 0
  v_mov_b32 v53, 0
  v_mov_b32 v54, 0
  v_mov_b32 v55, 0
  v_mov_b32 v56, 0
  v_mov_b32 v57, 0
  v_mov_b32 v58, 0
  v_mov_b32 v59, 0
  v_mfma_f32_32x32x16_bf16 v[36:51], v[68:71], v[68:71], 0
  v_mov_b32 v72, 0
  v_mov_b32 v73, 0
  v_mov_b32 v74, 0
  v_mov_b32 v75, 0
  s_buffer_load_dword s64, s[8:11], s34 offset:2688
  s_buffer_load_dword s65, s[8:11], s34 offset:2752
  s_buffer_load_dword s66, s[8:11], s34 offset:2816
  s_buffer_load_dword s67, s[8:11], s34 offset:2880
  s_buffer_load_dword s64, s[8:11], s34 offset:2944
  s_buffer_load_dword s65, s[8:11], s34 offset:3008
  s_buffer_load_dword s66, s[8:11], s34 offset:3072
  s_buffer_load_dword s67, s[8:11], s34 offset:3136
  s_buffer_load_dword s64, s[8:11], s34 offset:3200
  s_buffer_load_dword s65, s[8:11], s34 offset:3264
  s_buffer_load_dword s66, s[8:11], s34 offset:3328
  s_buffer_load_dword s67, s[8:11], s34 offset:3392
  s_buffer_load_dword s64, s[8:11], s34 offset:3456
  s_buffer_load_dword s65, s[8:11], s34 offset:3520
  s_mov_b32 s36, s34
  s_add_u32 s34, s33, 458752
  s_mov_b32 s33, s34
  s_mov_b32 s19, s18
  s_add_u32 s18, s18, 1
  s_mov_b32 s22, s20
  s_mov_b32 s20, s21
  s_mov_b32 s21, s22
  s_add_u32 s23, s20, 4096
  s_cmp_lt_u32 s19, 63
  s_cbranch_scc1 cB_sc3_loop
  s_branch cB_done
cB_sc3_r0:
  s_add_u32 s31, s31, 1
  buffer_load_dwordx4 v[20:23], v2, s[8:11], s20 offen offset:3072 sc1
  s_waitcnt vmcnt(0)
  v_cmp_eq_u32 vcc, -1, v20
  v_mov_b32 v36, 0
  v_mov_b32 v37, 0
  v_mov_b32 v38, 0
  v_mov_b32 v39, 0
  v_mov_b32 v40, 0
  v_mov_b32 v41, 0
  v_mov_b32 v42, 0
  v_mov_b32 v43, 0
  v_mov_b32 v44, 0
  v_mov_b32 v45, 0
  v_mov_b32 v46, 0
  v_mov_b32 v47, 0
  v_mov_b32 v48, 0
  v_mov_b32 v49, 0
  v_mov_b32 v50, 0
  v_mov_b32 v51, 0
  s_nop 1
  s_cbranch_vccz cB_sc3_go
  s_add_u32 s30, s30, 1
  s_cmp_lt_u32 s30, 400000
  s_cbranch_scc1 cB_sc3_r0
  s_branch cB_abort
cB_sc3_r4:
  s_add_u32 s31, s31, 1
  buffer_load_dwordx4 v[8:11], v2, s[8:11], s20 offen offset:0 sc1
  buffer_load_dwordx4 v[12:15], v2, s[8:11], s20 offen offset:1024 sc1
  buffer_load_dwordx4 v[16:19], v2, s[8:11], s20 offen offset:2048 sc1
  buffer_load_dwordx4 v[24:27], v2, s[8:11], s23 offen offset:0 sc1
  buffer_load_dwordx4 v[28:31], v2, s[8:11], s23 offen offset:1024 sc1
  buffer_load_dwordx4 v[32:35], v2, s[8:11], s23 offen offset:2048 sc1
  s_waitcnt vmcnt(0)
  v_max3_u32 v66, v8, v12, v16
  v_max3_u32 v66, v66, v24, v27
  v_max3_u32 v66, v66, v28, v31
  v_max3_u32 v66, v66, v32, v35
  v_cmp_eq_u32 vcc, -1, v66
  s_nop 4
  s_cbranch_vccz cB_sc3_rz
  s_add_u32 s30, s30, 1
  s_cmp_lt_u32 s30, 400000
  s_cbranch_scc1 cB_sc3_r4
  s_branch cB_abort
cB_sc3_retry:
  s_cmp_lg_u32 s62, 0
  s_cbranch_scc1 cB_sc3_cont
  s_waitcnt vmcnt(0) lgkmcnt(0)
cB_sc3_rv:
  buffer_load_dwordx4 v[8:11], v2, s[8:11], s20 offen offset:0 sc1
  buffer_load_dwordx4 v[12:15], v2, s[8:11], s20 offen offset:1024 sc1
  buffer_load_dwordx4 v[16:19], v2, s[8:11], s20 offen offset:2048 sc1
  buffer_load_dwordx4 v[20:23], v2, s[8:11], s20 offen offset:3072 sc1
  buffer_load_dwordx4 v[24:27], v2, s[8:11], s23 offen offset:0 sc1
  buffer_load_dwordx4 v[28:31], v2, s[8:11], s23 offen offset:1024 sc1
  buffer_load_dwordx4 v[32:35], v2, s[8:11], s23 offen offset:2048 sc1
  s_waitcnt vmcnt(0)
  v_max3_u32 v66, v8, v9, v10
  v_max3_u32 v66, v66, v11, v12
  v_max3_u32 v66, v66, v13, v14
  v_max3_u32 v66, v66, v15, v16
  v_max3_u32 v66, v66, v17, v18
  v_max3_u32 v66, v66, v19, v20
  v_max3_u32 v66, v66, v21, v22
  v_max3_u32 v66, v66, v23, v24
  v_max3_u32 v66, v66, v25, v26
  v_max3_u32 v66, v66, v27, v28
  v_max3_u32 v66, v66, v29, v30
  v_max3_u32 v66, v66, v31, v32
  v_max3_u32 v66, v66, v33, v34
  v_max_u32 v66, v66, v35
  v_cmp_eq_u32 vcc, -1, v66
  s_cbranch_vccz cB_sc3_rk
  s_add_u32 s30, s30, 1
  s_cmp_lt_u32 s30, 400000
  s_cbranch_scc1 cB_sc3_rv
  s_branch cB_abort
cB_sc3_rk:
  s_mov_b32 s62, 1
  s_add_u32 s31, s31, 0x100
cB_sc3_rz:
  v_mov_b32 v36, 0
  v_mov_b32 v37, 0
  v_mov_b32 v38, 0
  v_mov_b32 v39, 0
  v_mov_b32 v40, 0
  v_mov_b32 v41, 0
  v_mov_b32 v42, 0
  v_mov_b32 v43, 0
  v_mov_b32 v44, 0
  v_mov_b32 v45, 0
  v_mov_b32 v46, 0
  v_mov_b32 v47, 0
  v_mov_b32 v48, 0
  v_mov_b32 v49, 0
  v_mov_b32 v50, 0
  v_mov_b32 v51, 0
  v_mov_b32 v62, 0
  v_mov_b32 v63, 0
  v_mov_b32 v64, 0
  v_mov_b32 v65, 0
  v_mov_b32 v68, 0
  v_mov_b32 v69, 0
  v_mov_b32 v70, 0
  v_mov_b32 v71, 0
  v_mov_b32 v72, 0
  v_mov_b32 v73, 0
  v_mov_b32 v74, 0
  v_mov_b32 v75, 0
  v_mov_b32 v52, 0
  v_mov_b32 v53, 0
  v_mov_b32 v54, 0
  v_mov_b32 v55, 0
  v_mov_b32 v56, 0
  v_mov_b32 v57, 0
  v_mov_b32 v58, 0
  v_mov_b32 v59, 0
  s_nop 1
  s_branch cB_sc3_go
.p2align 6
cB_va0_loop:
  s_mov_b32 s30, 0
  s_barrier
  buffer_load_dwordx4 v[24:27], v2, s[8:11], s23 offen offset:0 sc1
  buffer_load_dwordx4 v[28:31], v2, s[8:11], s23 offen offset:1024 sc1
  s_barrier
  s_cmp_lt_u32 s19, 60
  s_cbranch_scc1 cB_va0_m1
  buffer_store_dword v160, v1, s[8:11], s38 offen sc1
  s_cmp_lg_u32 s19, 63
  s_cbranch_scc1 cB_va0_m2
  v_min_u32 v64, -2, v64
  v_min_u32 v65, -2, v65
  v_min_u32 v66, -2, v66
  v_min_u32 v67, -2, v67
  v_min_u32 v68, -2, v68
  v_min_u32 v69, -2, v69
  v_min_u32 v70, -2, v70
  v_min_u32 v71, -2, v71
  v_min_u32 v72, -2, v72
  v_min_u32 v73, -2, v73
  v_min_u32 v74, -2, v74
  v_min_u32 v75, -2, v75
  v_min_u32 v76, -2, v76
  v_min_u32 v77, -2, v77
  v_min_u32 v78, -2, v78
  v_min_u32 v79, -2, v79
  buffer_store_dwordx4 v[64:67], v2, s[8:11], s33 offen offset:0 sc1
  buffer_store_dwordx4 v[68:71], v2, s[8:11], s33 offen offset:2048 sc1
  s_add_u32 s33, s33, 4096
  buffer_store_dwordx4 v[72:75], v2, s[8:11], s33 offen offset:0 sc1
  buffer_store_dwordx4 v[76:79], v2, s[8:11], s33 offen offset:2048 sc1
  s_add_u32 s33, s33, 4096
  s_waitcnt vmcnt(5)
  s_branch cB_va0_m3
cB_va0_m1:
  buffer_store_dword v160, v1, s[8:11], s38 offen sc1
cB_va0_m2:
  s_add_u32 s22, s25, s80
  buffer_load_dwordx4 v[80:83], v6, s[8:11], s22 offen offset:0 sc1
  buffer_load_dwordx4 v[84:87], v6, s[8:11], s22 offen offset:1792 sc1
  s_add_u32 s22, s22, 3584
  buffer_load_dwordx4 v[88:91], v6, s[8:11], s22 offen offset:0 sc1
  buffer_load_dwordx4 v[92:95], v6, s[8:11], s22 offen offset:1792 sc1
  s_add_u32 s22, s25, s81
  buffer_load_dwordx4 v[96:99], v6, s[8:11], s22 offen offset:0 sc1
  s_mul_i32 s38, s18, 7168
  s_add_u32 s38, s38, 65536
  s_waitcnt vmcnt(6)
cB_va0_m3:
  ds_write_b128 v2, v[24:27] offset:12288
  ds_write_b128 v2, v[28:31] offset:13312
  v_smfmac_f32_16x16x64_bf16 v[36:39], v[24:27], a[32:39], v3
  buffer_load_dwordx4 v[100:103], v6, s[8:11], s22 offen offset:1792 sc1
  v_smfmac_f32_16x16x64_bf16 v[40:43], v[24:27], a[88:95], v3
  s_add_u32 s22, s22, 3584
  buffer_load_dwordx4 v[104:107], v6, s[8:11], s22 offen offset:0 sc1
  v_smfmac_f32_16x16x64_bf16 v[44:47], v[24:27], a[144:151], v3
  buffer_load_dwordx4 v[108:111], v6, s[8:11], s22 offen offset:1792 sc1
  v_smfmac_f32_16x16x64_bf16 v[48:51], v[24:27], a[200:207], v3
  s_add_u32 s22, s25, s82
  buffer_load_dwordx4 v[112:115], v6, s[8:11], s22 offen offset:0 sc1
  v_smfmac_f32_16x16x64_bf16 v[52:55], v[24:27], v[176:183], v3
  s_waitcnt lgkmcnt(0)
  s_barrier
  ds_read_b128 v[8:11], v2 offset:8192
  ds_read_b128 v[12:15], v2 offset:9216
  ds_read_b128 v[16:19], v2 offset:10240
  ds_read_b128 v[20:23], v2 offset:11264
  ds_read_b128 v[32:35], v2 offset:14336
  buffer_load_dwordx4 v[116:119], v6, s[8:11], s22 offen offset:1792 sc1
  v_smfmac_f32_16x16x64_bf16 v[56:59], v[24:27], v[232:239], v3
  s_add_u32 s22, s22, 3584
  buffer_load_dwordx4 v[120:123], v6, s[8:11], s22 offen offset:0 sc1
  v_smfmac_f32_16x16x64_bf16 v[36:39], v[28:31], a[40:47], v3
  buffer_load_dwordx4 v[124:127], v6, s[8:11], s22 offen offset:1792 sc1
  v_smfmac_f32_16x16x64_bf16 v[40:43], v[28:31], a[96:103], v3
  s_add_u32 s22, s25, s83
  buffer_load_dwordx4 v[128:131], v6, s[8:11], s22 offen offset:0 sc1
  v_smfmac_f32_16x16x64_bf16 v[44:47], v[28:31], a[152:159], v3
  buffer_load_dwordx4 v[132:135], v6, s[8:11], s22 offen offset:1792 sc1
  v_smfmac_f32_16x16x64_bf16 v[48:51], v[28:31], a[208:215], v3
  s_add_u32 s22, s22, 3584
  buffer_load_dwordx4 v[136:139], v6, s[8:11], s22 offen offset:0 sc1
  v_smfmac_f32_16x16x64_bf16 v[52:55], v[28:31], v[184:191], v3
  buffer_load_dwordx4 v[140:143], v6, s[8:11], s22 offen offset:1792 sc1
  v_smfmac_f32_16x16x64_bf16 v[56:59], v[28:31], v[240:247], v3
  s_waitcnt lgkmcnt(4)
  v_smfmac_f32_16x16x64_bf16 v[36:39], v[8:11], a[0:7], v3
  s_waitcnt lgkmcnt(3)
  v_smfmac_f32_16x16x64_bf16 v[36:39], v[12:15], a[8:15], v3
  s_waitcnt lgkmcnt(2)
  v_smfmac_f32_16x16x64_bf16 v[36:39], v[16:19], a[16:23], v3
  s_waitcnt lgkmcnt(1)
  v_smfmac_f32_16x16x64_bf16 v[36:39], v[20:23], a[24:31], v3
  s_waitcnt lgkmcnt(0)
  v_smfmac_f32_16x16x64_bf16 v[36:39], v[32:35], a[48:55], v3
  v_smfmac_f32_16x16x64_bf16 v[40:43], v[8:11], a[56:63], v3
  v_smfmac_f32_16x16x64_bf16 v[40:43], v[12:15], a[64:71], v3
  v_smfmac_f32_16x16x64_bf16 v[40:43], v[16:19], a[72:79], v3
  v_permlane32_swap_b32 v36, v38
  v_smfmac_f32_16x16x64_bf16 v[40:43], v[20:23], a[80:87], v3
  v_permlane32_swap_b32 v37, v39
  v_smfmac_f32_16x16x64_bf16 v[40:43], v[32:35], a[104:111], v3
  v_add_f32 v36, v36, v38
  v_smfmac_f32_16x16x64_bf16 v[44:47], v[8:11], a[112:119], v3
  v_add_f32 v37, v37, v39
  v_smfmac_f32_16x16x64_bf16 v[44:47], v[12:15], a[120:127], v3
  v_cmp_u_f32 vcc, v36, v37
  v_smfmac_f32_16x16x64_bf16 v[44:47], v[16:19], a[128:135], v3
  v_cvt_pk_bf16_f32 v38, v36, v37
  v_smfmac_f32_16x16x64_bf16 v[44:47], v[20:23], a[136:143], v3
  ds_write_b32 v152, v38
  s_cbranch_vccnz cB_va0_slow
  v_permlane32_swap_b32 v40, v42
  v_smfmac_f32_16x16x64_bf16 v[44:47], v[32:35], a[160:167], v3
  v_permlane32_swap_b32 v41, v43
  v_smfmac_f32_16x16x64_bf16 v[48:51], v[8:11], a[168:175], v3
  buffer_store_dword v162, v1, s[8:11], s21 offen sc1
  v_add_f32 v40, v40, v42
  v_smfmac_f32_16x16x64_bf16 v[48:51], v[12:15], a[176:183], v3
  v_add_f32 v41, v41, v43
  v_smfmac_f32_16x16x64_bf16 v[48:51], v[16:19], a[184:191], v3
  buffer_load_dword v164, v4, s[8:11], 0 offen sc1
  v_cvt_pk_bf16_f32 v42, v40, v41
  v_smfmac_f32_16x16x64_bf16 v[48:51], v[20:23], a[192:199], v3
  ds_write_b32 v153, v42
  v_permlane32_swap_b32 v44, v46
  v_smfmac_f32_16x16x64_bf16 v[48:51], v[32:35], a[216:223], v3
  v_permlane32_swap_b32 v45, v47
  v_smfmac_f32_16x16x64_bf16 v[52:55], v[8:11], a[224:231], v3
  buffer_load_dword v164, v4, s[8:11], 0 offen sc1
  v_add_f32 v44, v44, v46
  v_smfmac_f32_16x16x64_bf16 v[52:55], v[12:15], a[232:239], v3
  v_add_f32 v45, v45, v47
  v_smfmac_f32_16x16x64_bf16 v[52:55], v[16:19], a[240:247], v3
  v_cvt_pk_bf16_f32 v46, v44, v45
  v_smfmac_f32_16x16x64_bf16 v[52:55], v[20:23], a[248:255], v3
  ds_write_b32 v154, v46
  buffer_load_dword v164, v4, s[8:11], 0 offen sc1
  v_permlane32_swap_b32 v48, v50
  v_smfmac_f32_16x16x64_bf16 v[52:55], v[32:35], v[192:199], v3
  v_permlane32_swap_b32 v49, v51
  v_smfmac_f32_16x16x64_bf16 v[56:59], v[8:11], v[200:207], v3
  v_add_f32 v48, v48, v50
  v_smfmac_f32_16x16x64_bf16 v[56:59], v[12:15], v[208:215], v3
  buffer_load_dword v164, v4, s[8:11], 0 offen sc1
  v_add_f32 v49, v49, v51
  v_smfmac_f32_16x16x64_bf16 v[56:59], v[16:19], v[216:223], v3
  v_cvt_pk_bf16_f32 v50, v48, v49
  v_smfmac_f32_16x16x64_bf16 v[56:59], v[20:23], v[224:231], v3
  ds_write_b32 v155, v50
  v_permlane32_swap_b32 v52, v54
  v_smfmac_f32_16x16x64_bf16 v[56:59], v[32:35], v[248:255], v3
  buffer_load_dword v164, v4, s[8:11], 0 offen sc1
  v_permlane32_swap_b32 v53, v55
  v_add_f32 v52, v52, v54
  v_add_f32 v53, v53, v55
  v_cvt_pk_bf16_f32 v54, v52, v53
  ds_write_b32 v156, v54
  s_nop 1
  v_permlane32_swap_b32 v56, v58
  v_permlane32_swap_b32 v57, v59
  v_add_f32 v56, v56, v58
  v_add_f32 v57, v57, v59
  v_cvt_pk_bf16_f32 v58, v56, v57
  ds_write_b32 v157, v58
cB_va0_t2d:
  s_add_u32 s72, s20, s76
  s_add_u32 s73, s20, s77
  s_add_u32 s74, s20, s78
  s_add_u32 s75, s20, s79
  s_add_u32 s22, s20, 9216
  s_add_u32 s34, s20, 13312
  s_add_u32 s36, s20, 7168
  s_mov_b32 s37, 0
  v_mov_b32 v48, 0
  v_mov_b32 v49, 0
  v_mov_b32 v50, 0
  v_mov_b32 v51, 0
  v_mov_b32 v163, s18
  s_cmp_eq_u32 s19, 63
  s_waitcnt lgkmcnt(0)
  s_cbranch_scc1 cB_va0_last
  s_setprio 3
cB_va0_fw_l:
  v_cmp_gt_u32 vcc, s18, v164
  buffer_load_dword v164, v4, s[8:11], 0 offen sc1
  s_cbranch_vccz cB_va0_fw_d
  v_cmp_gt_u32 vcc, s18, v164
  buffer_load_dword v164, v4, s[8:11], 0 offen sc1
  s_cbranch_vccz cB_va0_fw_d
  v_cmp_gt_u32 vcc, s18, v164
  buffer_load_dword v164, v4, s[8:11], 0 offen sc1
  s_cbranch_vccz cB_va0_fw_d
  v_cmp_gt_u32 vcc, s18, v164
  buffer_load_dword v164, v4, s[8:11], 0 offen sc1
  s_cbranch_vccz cB_va0_fw_d
  v_cmp_gt_u32 vcc, s18, v164
  buffer_load_dword v164, v4, s[8:11], 0 offen sc1
  s_cbranch_vccz cB_va0_fw_d
  v_cmp_gt_u32 vcc, s18, v164
  buffer_load_dword v164, v4, s[8:11], 0 offen sc1
  s_cbranch_vccz cB_va0_fw_d
  v_cmp_gt_u32 vcc, s18, v164
  buffer_load_dword v164, v4, s[8:11], 0 offen sc1
  s_cbranch_vccz cB_va0_fw_d
  v_cmp_gt_u32 vcc, s18, v164
  buffer_load_dword v164, v4, s[8:11], 0 offen sc1
  s_cbranch_vccz cB_va0_fw_d
  v_cmp_gt_u32 vcc, s18, v164
  buffer_load_dword v164, v4, s[8:11], 0 offen sc1
  s_cbranch_vccz cB_va0_fw_d
  v_cmp_gt_u32 vcc, s18, v164
  buffer_load_dword v164, v4, s[8:11], 0 offen sc1
  s_cbranch_vccz cB_va0_fw_d
  v_cmp_gt_u32 vcc, s18, v164
  buffer_load_dword v164, v4, s[8:11], 0 offen sc1
  s_cbranch_vccz cB_va0_fw_d
  v_cmp_gt_u32 vcc, s18, v164
  buffer_load_dword v164, v4, s[8:11], 0 offen sc1
  s_cbranch_vccz cB_va0_fw_d
  v_cmp_gt_u32 vcc, s18, v164
  buffer_load_dword v164, v4, s[8:11], 0 offen sc1
  s_cbranch_vccz cB_va0_fw_d
  v_cmp_gt_u32 vcc, s18, v164
  buffer_load_dword v164, v4, s[8:11], 0 offen sc1
  s_cbranch_vccz cB_va0_fw_d
  v_cmp_gt_u32 vcc, s18, v164
  buffer_load_dword v164, v4, s[8:11], 0 offen sc1
  s_cbranch_vccz cB_va0_fw_d
  v_cmp_gt_u32 vcc, s18, v164
  buffer_load_dword v164, v4, s[8:11], 0 offen sc1
  s_cbranch_vccz cB_va0_fw_d
  s_waitcnt vmcnt(24)
  s_add_u32 s30, s30, 1
  s_cmp_lt_u32 s30, 400000
  s_cbranch_scc1 cB_va0_fw_l
  s_branch cB_abort
cB_va0_fw_d:
  buffer_load_dwordx4 v[8:11], v2, s[8:11], s72 offen offset:0 sc1
  buffer_load_dwordx4 v[12:15], v2, s[8:11], s72 offen offset:1024 sc1
  buffer_load_dwordx4 v[16:19], v2, s[8:11], s73 offen offset:0 sc1
  buffer_load_dwordx4 v[20:23], v2, s[8:11], s73 offen offset:1024 sc1
  buffer_load_dwordx4 v[24:27], v2, s[8:11], s74 offen offset:0 sc1
  buffer_load_dwordx4 v[28:31], v2, s[8:11], s74 offen offset:1024 sc1
  buffer_load_dwordx4 v[32:35], v2, s[8:11], s75 offen offset:0 sc1
  buffer_load_dwordx4 v[36:39], v2, s[8:11], s75 offen offset:1024 sc1
  buffer_load_dwordx4 v[40:43], v2, s[8:11], s36 offen offset:0 sc1
  buffer_load_dwordx4 v[44:47], v2, s[8:11], s36 offen offset:1024 sc1
  s_barrier
  ds_read_b128 v[64:67], v2 offset:0
  ds_read_b128 v[68:71], v2 offset:1024
  ds_read_b128 v[72:75], v2 offset:2048
  ds_read_b128 v[76:79], v2 offset:3072
cB_va0_lp:
  s_waitcnt vmcnt(9)
  v_smfmac_f32_16x16x64_bf16 v[48:51], v[8:11], v[80:87], v3
  s_waitcnt vmcnt(8)
  v_smfmac_f32_16x16x64_bf16 v[48:51], v[12:15], v[88:95], v3
  s_waitcnt vmcnt(7)
  v_smfmac_f32_16x16x64_bf16 v[48:51], v[16:19], v[96:103], v3
  s_waitcnt vmcnt(6)
  v_smfmac_f32_16x16x64_bf16 v[48:51], v[20:23], v[104:111], v3
  s_waitcnt vmcnt(5)
  v_smfmac_f32_16x16x64_bf16 v[48:51], v[24:27], v[112:119], v3
  s_waitcnt vmcnt(4)
  v_smfmac_f32_16x16x64_bf16 v[48:51], v[28:31], v[120:127], v3
  s_waitcnt vmcnt(3)
  v_smfmac_f32_16x16x64_bf16 v[48:51], v[32:35], v[128:135], v3
  s_waitcnt vmcnt(2)
  v_smfmac_f32_16x16x64_bf16 v[48:51], v[36:39], v[136:143], v3
  s_waitcnt vmcnt(1) lgkmcnt(0)
  v_smfmac_f32_16x16x64_bf16 v[48:51], v[40:43], v[64:71], v3
  s_waitcnt vmcnt(0)
  v_smfmac_f32_16x16x64_bf16 v[48:51], v[44:47], v[72:79], v3
  s_nop 7
  v_permlane32_swap_b32 v48, v50
  v_permlane32_swap_b32 v49, v51
  v_pk_add_f32 v[48:49], v[48:49], v[50:51]
  v_cvt_pk_bf16_f32 v160, v48, v49
  v_cmp_u_f32 vcc, v48, v49
  s_nop 0
  v_mov_b32_dpp v161, v160 quad_perm:[1,0,3,2] row_mask:0xf bank_mask:0xf
  v_perm_b32 v160, v161, v160, v5
  v_cndmask_b32 v161, v160, v162, vcc
  buffer_store_dword v161, v1, s[8:11], s21 offen sc1
  s_cbranch_vccnz cB_va0_rp
cB_va0_cont:
  s_setprio 0
  s_cmp_lg_u32 s19, 62
  s_cbranch_scc1 cB_va0_nl
  s_mov_b32 s25, 0x40000000
cB_va0_nl:
  s_add_u32 s25, s25, 458752
  v_mov_b32 v36, 0
  v_mov_b32 v37, 0
  v_mov_b32 v38, 0
  v_mov_b32 v39, 0
  v_mov_b32 v40, 0
  v_mov_b32 v41, 0
  v_mov_b32 v42, 0
  v_mov_b32 v43, 0
  v_mov_b32 v44, 0
  v_mov_b32 v45, 0
  v_mov_b32 v46, 0
  v_mov_b32 v47, 0
  v_mov_b32 v48, 0
  v_mov_b32 v49, 0
  v_mov_b32 v50, 0
  v_mov_b32 v51, 0
  v_mov_b32 v52, 0
  v_mov_b32 v53, 0
  v_mov_b32 v54, 0
  v_mov_b32 v55, 0
  v_mov_b32 v56, 0
  v_mov_b32 v57, 0
  v_mov_b32 v58, 0
  v_mov_b32 v59, 0
  v_mov_b32 v60, 0
  v_mov_b32 v61, 0
  v_mov_b32 v62, 0
  v_mov_b32 v63, 0
  s_mov_b32 s19, s18
  s_add_u32 s18, s18, 1
  s_mov_b32 s22, s20
  s_mov_b32 s20, s21
  s_mov_b32 s21, s22
  s_add_u32 s23, s20, 4096
  s_branch cB_va0_loop
cB_va0_slow:
  s_waitcnt lgkmcnt(0)
cB_va0_sl1:
  s_add_u32 s31, s31, 0x1000000
  buffer_load_dwordx4 v[8:11], v2, s[8:11], s20 offen offset:0 sc1
  buffer_load_dwordx4 v[12:15], v2, s[8:11], s20 offen offset:1024 sc1
  buffer_load_dwordx4 v[16:19], v2, s[8:11], s20 offen offset:2048 sc1
  buffer_load_dwordx4 v[20:23], v2, s[8:11], s20 offen offset:3072 sc1
  buffer_load_dwordx4 v[24:27], v2, s[8:11], s23 offen offset:0 sc1
  buffer_load_dwordx4 v[28:31], v2, s[8:11], s23 offen offset:1024 sc1
  buffer_load_dwordx4 v[32:35], v2, s[8:11], s23 offen offset:2048 sc1
  s_waitcnt vmcnt(0)
  v_max3_u32 v36, v8, v9, v10
  v_max3_u32 v36, v36, v11, v12
  v_max3_u32 v36, v36, v13, v14
  v_max3_u32 v36, v36, v15, v16
  v_max3_u32 v36, v36, v17, v18
  v_max3_u32 v36, v36, v19, v20
  v_max3_u32 v36, v36, v21, v22
  v_max3_u32 v36, v36, v23, v24
  v_max3_u32 v36, v36, v25, v26
  v_max3_u32 v36, v36, v27, v28
  v_max3_u32 v36, v36, v29, v30
  v_max3_u32 v36, v36, v31, v32
  v_max3_u32 v36, v36, v33, v34
  v_max_u32 v36, v36, v35
  v_cmp_eq_u32 vcc, -1, v36
  s_cbranch_vccz cB_va0_sl2
  s_add_u32 s30, s30, 1
  s_cmp_lt_u32 s30, 400000
  s_cbranch_scc1 cB_va0_sl1
  s_branch cB_abort
cB_va0_sl2:
  v_mov_b32 v36, 0
  v_mov_b32 v37, 0
  v_mov_b32 v38, 0
  v_mov_b32 v39, 0
  v_mov_b32 v40, 0
  v_mov_b32 v41, 0
  v_mov_b32 v42, 0
  v_mov_b32 v43, 0
  v_mov_b32 v44, 0
  v_mov_b32 v45, 0
  v_mov_b32 v46, 0
  v_mov_b32 v47, 0
  v_mov_b32 v48, 0
  v_mov_b32 v49, 0
  v_mov_b32 v50, 0
  v_mov_b32 v51, 0
  v_mov_b32 v52, 0
  v_mov_b32 v53, 0
  v_mov_b32 v54, 0
  v_mov_b32 v55, 0
  v_mov_b32 v56, 0
  v_mov_b32 v57, 0
  v_mov_b32 v58, 0
  v_mov_b32 v59, 0
  v_mov_b32 v60, 0
  v_mov_b32 v61, 0
  v_mov_b32 v62, 0
  v_mov_b32 v63, 0
  buffer_store_dword v162, v1, s[8:11], s21 offen sc1
  v_smfmac_f32_16x16x64_bf16 v[36:39], v[8:11], a[0:7], v3
  v_smfmac_f32_16x16x64_bf16 v[40:43], v[8:11], a[56:63], v3
  v_smfmac_f32_16x16x64_bf16 v[44:47], v[8:11], a[112:119], v3
  v_smfmac_f32_16x16x64_bf16 v[48:51], v[8:11], a[168:175], v3
  v_smfmac_f32_16x16x64_bf16 v[52:55], v[8:11], a[224:231], v3
  v_smfmac_f32_16x16x64_bf16 v[56:59], v[8:11], v[200:207], v3
  v_smfmac_f32_16x16x64_bf16 v[36:39], v[12:15], a[8:15], v3
  v_smfmac_f32_16x16x64_bf16 v[40:43], v[12:15], a[64:71], v3
  v_smfmac_f32_16x16x64_bf16 v[44:47], v[12:15], a[120:127], v3
  v_smfmac_f32_16x16x64_bf16 v[48:51], v[12:15], a[176:183], v3
  v_smfmac_f32_16x16x64_bf16 v[52:55], v[12:15], a[232:239], v3
  v_smfmac_f32_16x16x64_bf16 v[56:59], v[12:15], v[208:215], v3
  v_smfmac_f32_16x16x64_bf16 v[36:39], v[16:19], a[16:23], v3
  v_smfmac_f32_16x16x64_bf16 v[40:43], v[16:19], a[72:79], v3
  v_smfmac_f32_16x16x64_bf16 v[44:47], v[16:19], a[128:135], v3
  v_smfmac_f32_16x16x64_bf16 v[48:51], v[16:19], a[184:191], v3
  v_smfmac_f32_16x16x64_bf16 v[52:55], v[16:19], a[240:247], v3
  v_smfmac_f32_16x16x64_bf16 v[56:59], v[16:19], v[216:223], v3
  v_smfmac_f32_16x16x64_bf16 v[36:39], v[20:23], a[24:31], v3
  v_smfmac_f32_16x16x64_bf16 v[40:43], v[20:23], a[80:87], v3
  v_smfmac_f32_16x16x64_bf16 v[44:47], v[20:23], a[136:143], v3
  v_smfmac_f32_16x16x64_bf16 v[48:51], v[20:23], a[192:199], v3
  v_smfmac_f32_16x16x64_bf16 v[52:55], v[20:23], a[248:255], v3
  v_smfmac_f32_16x16x64_bf16 v[56:59], v[20:23], v[224:231], v3
  v_smfmac_f32_16x16x64_bf16 v[36:39], v[24:27], a[32:39], v3
  v_smfmac_f32_16x16x64_bf16 v[40:43], v[24:27], a[88:95], v3
  v_smfmac_f32_16x16x64_bf16 v[44:47], v[24:27], a[144:151], v3
  v_smfmac_f32_16x16x64_bf16 v[48:51], v[24:27], a[200:207], v3
  v_smfmac_f32_16x16x64_bf16 v[52:55], v[24:27], v[176:183], v3
  v_smfmac_f32_16x16x64_bf16 v[56:59], v[24:27], v[232:239], v3
  v_smfmac_f32_16x16x64_bf16 v[36:39], v[28:31], a[40:47], v3
  v_smfmac_f32_16x16x64_bf16 v[40:43], v[28:31], a[96:103], v3
  v_smfmac_f32_16x16x64_bf16 v[44:47], v[28:31], a[152:159], v3
  v_smfmac_f32_16x16x64_bf16 v[48:51], v[28:31], a[208:215], v3
  v_smfmac_f32_16x16x64_bf16 v[52:55], v[28:31], v[184:191], v3
  v_smfmac_f32_16x16x64_bf16 v[56:59], v[28:31], v[240:247], v3
  v_smfmac_f32_16x16x64_bf16 v[36:39], v[32:35], a[48:55], v3
  v_smfmac_f32_16x16x64_bf16 v[40:43], v[32:35], a[104:111], v3
  v_smfmac_f32_16x16x64_bf16 v[44:47], v[32:35], a[160:167], v3
  v_smfmac_f32_16x16x64_bf16 v[48:51], v[32:35], a[216:223], v3
  v_smfmac_f32_16x16x64_bf16 v[52:55], v[32:35], v[192:199], v3
  v_smfmac_f32_16x16x64_bf16 v[56:59], v[32:35], v[248:255], v3
  v_permlane32_swap_b32 v36, v38
  v_permlane32_swap_b32 v37, v39
  v_add_f32 v36, v36, v38
  v_add_f32 v37, v37, v39
  v_cvt_pk_bf16_f32 v38, v36, v37
  ds_write_b32 v152, v38
  v_permlane32_swap_b32 v40, v42
  v_permlane32_swap_b32 v41, v43
  v_add_f32 v40, v40, v42
  v_add_f32 v41, v41, v43
  v_cvt_pk_bf16_f32 v42, v40, v41
  ds_write_b32 v153, v42
  v_permlane32_swap_b32 v44, v46
  v_permlane32_swap_b32 v45, v47
  v_add_f32 v44, v44, v46
  v_add_f32 v45, v45, v47
  v_cvt_pk_bf16_f32 v46, v44, v45
  ds_write_b32 v154, v46
  v_permlane32_swap_b32 v48, v50
  v_permlane32_swap_b32 v49, v51
  v_add_f32 v48, v48, v50
  v_add_f32 v49, v49, v51
  v_cvt_pk_bf16_f32 v50, v48, v49
  ds_write_b32 v155, v50
  v_permlane32_swap_b32 v52, v54
  v_permlane32_swap_b32 v53, v55
  v_add_f32 v52, v52, v54
  v_add_f32 v53, v53, v55
  v_cvt_pk_bf16_f32 v54, v52, v53
  ds_write_b32 v156, v54
  v_permlane32_swap_b32 v56, v58
  v_permlane32_swap_b32 v57, v59
  v_add_f32 v56, v56, v58
  v_add_f32 v57, v57, v59
  v_cvt_pk_bf16_f32 v58, v56, v57
  ds_write_b32 v157, v58
  buffer_load_dword v164, v4, s[8:11], 0 offen sc1
  buffer_load_dword v164, v4, s[8:11], 0 offen sc1
  buffer_load_dword v164, v4, s[8:11], 0 offen sc1
  buffer_load_dword v164, v4, s[8:11], 0 offen sc1
  buffer_load_dword v164, v4, s[8:11], 0 offen sc1
  s_branch cB_va0_t2d
cB_va0_last:
  s_barrier
  ds_read_b128 v[64:67], v2 offset:0
  ds_read_b128 v[68:71], v2 offset:1024
  ds_read_b128 v[72:75], v2 offset:2048
  ds_read_b128 v[76:79], v2 offset:3072
  s_waitcnt lgkmcnt(0)
  v_min_u32 v64, -2, v64
  v_min_u32 v65, -2, v65
  v_min_u32 v66, -2, v66
  v_min_u32 v67, -2, v67
  v_min_u32 v68, -2, v68
  v_min_u32 v69, -2, v69
  v_min_u32 v70, -2, v70
  v_min_u32 v71, -2, v71
  v_min_u32 v72, -2, v72
  v_min_u32 v73, -2, v73
  v_min_u32 v74, -2, v74
  v_min_u32 v75, -2, v75
  v_min_u32 v76, -2, v76
  v_min_u32 v77, -2, v77
  v_min_u32 v78, -2, v78
  v_min_u32 v79, -2, v79
  buffer_store_dwordx4 v[64:67], v2, s[8:11], s33 offen offset:0 sc1
  buffer_store_dwordx4 v[68:71], v2, s[8:11], s33 offen offset:2048 sc1
  s_add_u32 s33, s33, 4096
  buffer_store_dwordx4 v[72:75], v2, s[8:11], s33 offen offset:0 sc1
  buffer_store_dwordx4 v[76:79], v2, s[8:11], s33 offen offset:2048 sc1
  s_add_u32 s33, s33, 4096
  s_cmp_lg_u32 s17, 0
  s_cbranch_scc1 cB_done
  s_waitcnt vmcnt(0)
  buffer_wbl2 sc1
  s_branch cB_done
cB_va0_rp:
  s_cmp_eq_u32 s37, 0
  s_cbranch_scc1 cB_va0_rv
  v_min_u32 v160, -2, v160
  buffer_store_dword v160, v1, s[8:11], s21 offen sc1
  s_branch cB_va0_cont
cB_va0_rv:
  s_add_u32 s31, s31, 0x10000
  buffer_load_dwordx4 v[8:11], v2, s[8:11], s72 offen offset:0 sc1
  buffer_load_dwordx4 v[12:15], v2, s[8:11], s72 offen offset:1024 sc1
  buffer_load_dwordx4 v[16:19], v2, s[8:11], s73 offen offset:0 sc1
  buffer_load_dwordx4 v[20:23], v2, s[8:11], s73 offen offset:1024 sc1
  buffer_load_dwordx4 v[24:27], v2, s[8:11], s74 offen offset:0 sc1
  buffer_load_dwordx4 v[28:31], v2, s[8:11], s74 offen offset:1024 sc1
  buffer_load_dwordx4 v[32:35], v2, s[8:11], s75 offen offset:0 sc1
  buffer_load_dwordx4 v[36:39], v2, s[8:11], s75 offen offset:1024 sc1
  buffer_load_dwordx4 v[40:43], v2, s[8:11], s36 offen offset:0 sc1
  buffer_load_dwordx4 v[44:47], v2, s[8:11], s36 offen offset:1024 sc1
  s_waitcnt vmcnt(0)
  v_max3_u32 v52, v8, v9, v10
  v_max3_u32 v52, v52, v11, v12
  v_max3_u32 v52, v52, v13, v14
  v_max3_u32 v52, v52, v15, v16
  v_max3_u32 v52, v52, v17, v18
  v_max3_u32 v52, v52, v19, v20
  v_max3_u32 v52, v52, v21, v22
  v_max3_u32 v52, v52, v23, v24
  v_max3_u32 v52, v52, v25, v26
  v_max3_u32 v52, v52, v27, v28
  v_max3_u32 v52, v52, v29, v30
  v_max3_u32 v52, v52, v31, v32
  v_max3_u32 v52, v52, v33, v34
  v_max3_u32 v52, v52, v35, v36
  v_max3_u32 v52, v52, v37, v38
  v_max3_u32 v52, v52, v39, v40
  v_max3_u32 v52, v52, v41, v42
  v_max3_u32 v52, v52, v43, v44
  v_max3_u32 v52, v52, v45, v46
  v_max_u32 v52, v52, v47
  v_cmp_eq_u32 vcc, -1, v52
  s_mov_b32 s37, 1
  v_mov_b32 v48, 0
  v_mov_b32 v49, 0
  v_mov_b32 v50, 0
  v_mov_b32 v51, 0
  s_nop 1
  s_cbranch_vccz cB_va0_lp
  s_add_u32 s30, s30, 1
  s_cmp_lt_u32 s30, 400000
  s_cbranch_scc1 cB_va0_rv
  s_branch cB_abort
.p2align 6
cB_va1_loop:
  s_mov_b32 s30, 0
  s_barrier
  buffer_load_dwordx4 v[28:31], v2, s[8:11], s23 offen offset:1024 sc1
  buffer_load_dwordx4 v[32:35], v2, s[8:11], s23 offen offset:2048 sc1
  s_barrier
  s_cmp_lt_u32 s19, 60
  s_cbranch_scc1 cB_va1_m1
  buffer_store_dword v160, v1, s[8:11], s38 offen sc1
  s_cmp_lg_u32 s19, 63
  s_cbranch_scc1 cB_va1_m2
  v_min_u32 v64, -2, v64
  v_min_u32 v65, -2, v65
  v_min_u32 v66, -2, v66
  v_min_u32 v67, -2, v67
  v_min_u32 v68, -2, v68
  v_min_u32 v69, -2, v69
  v_min_u32 v70, -2, v70
  v_min_u32 v71, -2, v71
  v_min_u32 v72, -2, v72
  v_min_u32 v73, -2, v73
  v_min_u32 v74, -2, v74
  v_min_u32 v75, -2, v75
  v_min_u32 v76, -2, v76
  v_min_u32 v77, -2, v77
  v_min_u32 v78, -2, v78
  v_min_u32 v79, -2, v79
  buffer_store_dwordx4 v[64:67], v2, s[8:11], s33 offen offset:0 sc1
  buffer_store_dwordx4 v[68:71], v2, s[8:11], s33 offen offset:2048 sc1
  s_add_u32 s33, s33, 4096
  buffer_store_dwordx4 v[72:75], v2, s[8:11], s33 offen offset:0 sc1
  buffer_store_dwordx4 v[76:79], v2, s[8:11], s33 offen offset:2048 sc1
  s_add_u32 s33, s33, 4096
  s_waitcnt vmcnt(5)
  s_branch cB_va1_m3
cB_va1_m1:
  buffer_store_dword v160, v1, s[8:11], s38 offen sc1
cB_va1_m2:
  s_add_u32 s22, s25, s80
  buffer_load_dwordx4 v[80:83], v6, s[8:11], s22 offen offset:0 sc1
  buffer_load_dwordx4 v[84:87], v6, s[8:11], s22 offen offset:1792 sc1
  s_add_u32 s22, s22, 3584
  buffer_load_dwordx4 v[88:91], v6, s[8:11], s22 offen offset:0 sc1
  buffer_load_dwordx4 v[92:95], v6, s[8:11], s22 offen offset:1792 sc1
  s_add_u32 s22, s25, s81
  buffer_load_dwordx4 v[96:99], v6, s[8:11], s22 offen offset:0 sc1
  s_mul_i32 s38, s18, 7168
  s_add_u32 s38, s38, 65536
  s_waitcnt vmcnt(6)
cB_va1_m3:
  ds_write_b128 v2, v[32:35] offset:14336
  v_smfmac_f32_16x16x64_bf16 v[36:39], v[28:31], a[40:47], v3
  buffer_load_dwordx4 v[100:103], v6, s[8:11], s22 offen offset:1792 sc1
  v_smfmac_f32_16x16x64_bf16 v[40:43], v[28:31], a[96:103], v3
  s_add_u32 s22, s22, 3584
  buffer_load_dwordx4 v[104:107], v6, s[8:11], s22 offen offset:0 sc1
  v_smfmac_f32_16x16x64_bf16 v[44:47], v[28:31], a[152:159], v3
  buffer_load_dwordx4 v[108:111], v6, s[8:11], s22 offen offset:1792 sc1
  v_smfmac_f32_16x16x64_bf16 v[48:51], v[28:31], a[208:215], v3
  s_add_u32 s22, s25, s82
  buffer_load_dwordx4 v[112:115], v6, s[8:11], s22 offen offset:0 sc1
  v_smfmac_f32_16x16x64_bf16 v[52:55], v[28:31], v[184:191], v3
  s_waitcnt lgkmcnt(0)
  s_barrier
  ds_read_b128 v[8:11], v2 offset:8192
  ds_read_b128 v[12:15], v2 offset:9216
  ds_read_b128 v[16:19], v2 offset:10240
  ds_read_b128 v[20:23], v2 offset:11264
  ds_read_b128 v[24:27], v2 offset:12288
  buffer_load_dwordx4 v[116:119], v6, s[8:11], s22 offen offset:1792 sc1
  v_smfmac_f32_16x16x64_bf16 v[56:59], v[28:31], v[240:247], v3
  s_add_u32 s22, s22, 3584
  buffer_load_dwordx4 v[120:123], v6, s[8:11], s22 offen offset:0 sc1
  v_smfmac_f32_16x16x64_bf16 v[36:39], v[32:35], a[48:55], v3
  buffer_load_dwordx4 v[124:127], v6, s[8:11], s22 offen offset:1792 sc1
  v_smfmac_f32_16x16x64_bf16 v[40:43], v[32:35], a[104:111], v3
  s_add_u32 s22, s25, s83
  buffer_load_dwordx4 v[128:131], v6, s[8:11], s22 offen offset:0 sc1
  v_smfmac_f32_16x16x64_bf16 v[44:47], v[32:35], a[160:167], v3
  buffer_load_dwordx4 v[132:135], v6, s[8:11], s22 offen offset:1792 sc1
  v_smfmac_f32_16x16x64_bf16 v[48:51], v[32:35], a[216:223], v3
  s_add_u32 s22, s22, 3584
  buffer_load_dwordx4 v[136:139], v6, s[8:11], s22 offen offset:0 sc1
  v_smfmac_f32_16x16x64_bf16 v[52:55], v[32:35], v[192:199], v3
  ds_read_b128 v[64:67], v0 offset:0
  ds_read_b128 v[68:71], v0 offset:1024
  buffer_load_dwordx4 v[140:143], v6, s[8:11], s22 offen offset:1792 sc1
  v_smfmac_f32_16x16x64_bf16 v[56:59], v[32:35], v[248:255], v3
  s_waitcnt lgkmcnt(6)
  ds_read_b128 v[72:75], v0 offset:2048
  ds_read_b128 v[76:79], v0 offset:3072
  v_smfmac_f32_16x16x64_bf16 v[36:39], v[8:11], a[0:7], v3
  s_waitcnt lgkmcnt(7)
  v_smfmac_f32_16x16x64_bf16 v[36:39], v[12:15], a[8:15], v3
  s_waitcnt lgkmcnt(6)
  v_smfmac_f32_16x16x64_bf16 v[36:39], v[16:19], a[16:23], v3
  s_waitcnt lgkmcnt(2)
  v_smfmac_f32_16x16x64_bf16 v[60:63], v[8:11], v[64:71], v3
  s_waitcnt lgkmcnt(5)
  ds_read_b128 v[144:147], v0 offset:4096
  ds_read_b128 v[148:151], v0 offset:5120
  v_smfmac_f32_16x16x64_bf16 v[36:39], v[20:23], a[24:31], v3
  s_waitcnt lgkmcnt(6)
  v_smfmac_f32_16x16x64_bf16 v[36:39], v[24:27], a[32:39], v3
  v_smfmac_f32_16x16x64_bf16 v[40:43], v[8:11], a[56:63], v3
  s_waitcnt lgkmcnt(2)
  v_smfmac_f32_16x16x64_bf16 v[60:63], v[12:15], v[72:79], v3
  ds_read_b128 v[64:67], v0 offset:6144
  ds_read_b128 v[68:71], v0 offset:7168
  v_smfmac_f32_16x16x64_bf16 v[40:43], v[12:15], a[64:71], v3
  v_permlane32_swap_b32 v36, v38
  v_smfmac_f32_16x16x64_bf16 v[40:43], v[16:19], a[72:79], v3
  v_permlane32_swap_b32 v37, v39
  v_smfmac_f32_16x16x64_bf16 v[40:43], v[20:23], a[80:87], v3
  s_waitcnt lgkmcnt(2)
  v_add_f32 v36, v36, v38
  v_smfmac_f32_16x16x64_bf16 v[60:63], v[16:19], v[144:151], v3
  ds_read_b128 v[72:75], v0 offset:8192
  ds_read_b128 v[76:79], v0 offset:9216
  v_add_f32 v37, v37, v39
  v_smfmac_f32_16x16x64_bf16 v[40:43], v[24:27], a[88:95], v3
  v_cmp_u_f32 vcc, v36, v37
  v_smfmac_f32_16x16x64_bf16 v[44:47], v[8:11], a[112:119], v3
  v_cvt_pk_bf16_f32 v38, v36, v37
  v_smfmac_f32_16x16x64_bf16 v[44:47], v[12:15], a[120:127], v3
  ds_write_b32 v152, v38
  s_waitcnt lgkmcnt(3)
  s_cbranch_vccnz cB_va1_slow
  v_permlane32_swap_b32 v40, v42
  v_smfmac_f32_16x16x64_bf16 v[60:63], v[20:23], v[64:71], v3
  ds_read_b128 v[144:147], v0 offset:10240
  ds_read_b128 v[148:151], v0 offset:11264
  v_permlane32_swap_b32 v41, v43
  v_smfmac_f32_16x16x64_bf16 v[44:47], v[16:19], a[128:135], v3
  buffer_store_dword v162, v1, s[8:11], s21 offen sc1
  v_add_f32 v40, v40, v42
  v_smfmac_f32_16x16x64_bf16 v[44:47], v[20:23], a[136:143], v3
  v_add_f32 v41, v41, v43
  v_smfmac_f32_16x16x64_bf16 v[44:47], v[24:27], a[144:151], v3
  s_waitcnt lgkmcnt(3)
  v_cvt_pk_bf16_f32 v42, v40, v41
  v_smfmac_f32_16x16x64_bf16 v[60:63], v[24:27], v[72:79], v3
  ds_write_b32 v153, v42
  ds_read_b128 v[64:67], v0 offset:12288
  ds_read_b128 v[68:71], v0 offset:13312
  v_smfmac_f32_16x16x64_bf16 v[48:51], v[8:11], a[168:175], v3
  s_nop 0
  v_permlane32_swap_b32 v44, v46
  v_smfmac_f32_16x16x64_bf16 v[48:51], v[12:15], a[176:183], v3
  v_permlane32_swap_b32 v45, v47
  v_smfmac_f32_16x16x64_bf16 v[48:51], v[16:19], a[184:191], v3
  s_waitcnt lgkmcnt(3)
  v_add_f32 v44, v44, v46
  v_smfmac_f32_16x16x64_bf16 v[60:63], v[28:31], v[144:151], v3
  v_add_f32 v45, v45, v47
  v_smfmac_f32_16x16x64_bf16 v[48:51], v[20:23], a[192:199], v3
  v_cvt_pk_bf16_f32 v46, v44, v45
  v_smfmac_f32_16x16x64_bf16 v[48:51], v[24:27], a[200:207], v3
  ds_write_b32 v154, v46
  v_smfmac_f32_16x16x64_bf16 v[52:55], v[8:11], a[224:231], v3
  s_waitcnt lgkmcnt(1)
  v_smfmac_f32_16x16x64_bf16 v[60:63], v[32:35], v[64:71], v3
  v_smfmac_f32_16x16x64_bf16 v[52:55], v[12:15], a[232:239], v3
  v_permlane32_swap_b32 v48, v50
  v_smfmac_f32_16x16x64_bf16 v[52:55], v[16:19], a[240:247], v3
  v_permlane32_swap_b32 v49, v51
  v_smfmac_f32_16x16x64_bf16 v[52:55], v[20:23], a[248:255], v3
  v_add_f32 v48, v48, v50
  v_smfmac_f32_16x16x64_bf16 v[52:55], v[24:27], v[176:183], v3
  v_add_f32 v49, v49, v51
  v_smfmac_f32_16x16x64_bf16 v[56:59], v[8:11], v[200:207], v3
  v_cvt_pk_bf16_f32 v50, v48, v49
  v_smfmac_f32_16x16x64_bf16 v[56:59], v[12:15], v[208:215], v3
  ds_write_b32 v155, v50
  v_permlane32_swap_b32 v60, v62
  v_smfmac_f32_16x16x64_bf16 v[56:59], v[16:19], v[216:223], v3
  v_permlane32_swap_b32 v61, v63
  v_smfmac_f32_16x16x64_bf16 v[56:59], v[20:23], v[224:231], v3
  v_add_f32 v60, v60, v62
  v_smfmac_f32_16x16x64_bf16 v[56:59], v[24:27], v[232:239], v3
  v_add_f32 v61, v61, v63
  v_cvt_pk_bf16_f32 v62, v60, v61
  ds_write_b32 v158, v62
  v_permlane32_swap_b32 v52, v54
  v_permlane32_swap_b32 v53, v55
  v_add_f32 v52, v52, v54
  v_add_f32 v53, v53, v55
  v_cvt_pk_bf16_f32 v54, v52, v53
  ds_write_b32 v156, v54
  v_permlane32_swap_b32 v56, v58
  v_permlane32_swap_b32 v57, v59
  v_add_f32 v56, v56, v58
  v_add_f32 v57, v57, v59
  v_cvt_pk_bf16_f32 v58, v56, v57
  ds_write_b32 v157, v58
cB_va1_t2d:
  s_add_u32 s72, s20, s76
  s_add_u32 s73, s20, s77
  s_add_u32 s74, s20, s78
  s_add_u32 s75, s20, s79
  s_add_u32 s22, s20, 9216
  s_add_u32 s34, s20, 13312
  s_add_u32 s36, s20, 7168
  s_mov_b32 s37, 0
  v_mov_b32 v48, 0
  v_mov_b32 v49, 0
  v_mov_b32 v50, 0
  v_mov_b32 v51, 0
  v_mov_b32 v163, s18
  s_cmp_eq_u32 s19, 63
  s_waitcnt lgkmcnt(0)
  s_cbranch_scc1 cB_va1_last
  s_barrier
  buffer_load_dwordx4 v[8:11], v2, s[8:11], s72 offen offset:0 sc1
  buffer_load_dwordx4 v[12:15], v2, s[8:11], s72 offen offset:1024 sc1
  buffer_load_dwordx4 v[16:19], v2, s[8:11], s73 offen offset:0 sc1
  buffer_load_dwordx4 v[20:23], v2, s[8:11], s73 offen offset:1024 sc1
  buffer_load_dwordx4 v[24:27], v2, s[8:11], s74 offen offset:0 sc1
  buffer_load_dwordx4 v[28:31], v2, s[8:11], s74 offen offset:1024 sc1
  buffer_load_dwordx4 v[32:35], v2, s[8:11], s75 offen offset:0 sc1
  buffer_load_dwordx4 v[36:39], v2, s[8:11], s75 offen offset:1024 sc1
  buffer_load_dwordx4 v[40:43], v2, s[8:11], s36 offen offset:0 sc1
  buffer_load_dwordx4 v[44:47], v2, s[8:11], s36 offen offset:1024 sc1
  ds_read_b128 v[64:67], v2 offset:4096
  ds_read_b128 v[68:71], v2 offset:5120
  ds_read_b128 v[72:75], v2 offset:6144
  ds_read_b128 v[76:79], v2 offset:7168
cB_va1_lp:
  s_waitcnt vmcnt(9)
  v_smfmac_f32_16x16x64_bf16 v[48:51], v[8:11], v[80:87], v3
  s_waitcnt vmcnt(8)
  v_smfmac_f32_16x16x64_bf16 v[48:51], v[12:15], v[88:95], v3
  s_waitcnt vmcnt(7)
  v_smfmac_f32_16x16x64_bf16 v[48:51], v[16:19], v[96:103], v3
  v_max3_u32 v55, v8, v12, v16
  s_waitcnt vmcnt(6)
  v_smfmac_f32_16x16x64_bf16 v[48:51], v[20:23], v[104:111], v3
  s_waitcnt vmcnt(5)
  v_smfmac_f32_16x16x64_bf16 v[48:51], v[24:27], v[112:119], v3
  v_max3_u32 v55, v55, v20, v24
  s_waitcnt vmcnt(4)
  v_smfmac_f32_16x16x64_bf16 v[48:51], v[28:31], v[120:127], v3
  v_max_u32 v55, v55, v28
  v_cmp_eq_u32 vcc, -1, v55
  s_waitcnt vmcnt(3)
  v_smfmac_f32_16x16x64_bf16 v[48:51], v[32:35], v[128:135], v3
  s_waitcnt vmcnt(2)
  v_smfmac_f32_16x16x64_bf16 v[48:51], v[36:39], v[136:143], v3
  s_cbranch_vccnz cB_va1_rv
  buffer_store_dword v163, v7, s[8:11], 0 offen sc1
  s_waitcnt vmcnt(2) lgkmcnt(0)
  v_smfmac_f32_16x16x64_bf16 v[48:51], v[40:43], v[64:71], v3
  s_waitcnt vmcnt(1)
  v_smfmac_f32_16x16x64_bf16 v[48:51], v[44:47], v[72:79], v3
  s_nop 7
  v_permlane32_swap_b32 v48, v50
  v_permlane32_swap_b32 v49, v51
  v_pk_add_f32 v[48:49], v[48:49], v[50:51]
  v_cvt_pk_bf16_f32 v160, v48, v49
  v_cmp_u_f32 vcc, v48, v49
  s_nop 0
  v_mov_b32_dpp v161, v160 quad_perm:[1,0,3,2] row_mask:0xf bank_mask:0xf
  v_perm_b32 v160, v161, v160, v5
  v_cndmask_b32 v161, v160, v162, vcc
  buffer_store_dword v161, v1, s[8:11], s21 offen sc1
  s_cbranch_vccnz cB_va1_rp
cB_va1_cont:
  s_cmp_lg_u32 s19, 62
  s_cbranch_scc1 cB_va1_nl
  s_mov_b32 s25, 0x40000000
cB_va1_nl:
  s_add_u32 s25, s25, 458752
  v_mov_b32 v36, 0
  v_mov_b32 v37, 0
  v_mov_b32 v38, 0
  v_mov_b32 v39, 0
  v_mov_b32 v40, 0
  v_mov_b32 v41, 0
  v_mov_b32 v42, 0
  v_mov_b32 v43, 0
  v_mov_b32 v44, 0
  v_mov_b32 v45, 0
  v_mov_b32 v46, 0
  v_mov_b32 v47, 0
  v_mov_b32 v48, 0
  v_mov_b32 v49, 0
  v_mov_b32 v50, 0
  v_mov_b32 v51, 0
  v_mov_b32 v52, 0
  v_mov_b32 v53, 0
  v_mov_b32 v54, 0
  v_mov_b32 v55, 0
  v_mov_b32 v56, 0
  v_mov_b32 v57, 0
  v_mov_b32 v58, 0
  v_mov_b32 v59, 0
  v_mov_b32 v60, 0
  v_mov_b32 v61, 0
  v_mov_b32 v62, 0
  v_mov_b32 v63, 0
  s_mov_b32 s19, s18
  s_add_u32 s18, s18, 1
  s_mov_b32 s22, s20
  s_mov_b32 s20, s21
  s_mov_b32 s21, s22
  s_add_u32 s23, s20, 4096
  s_branch cB_va1_loop
cB_va1_slow:
  s_waitcnt lgkmcnt(0)
cB_va1_sl1:
  s_add_u32 s31, s31, 0x1000000
  buffer_load_dwordx4 v[8:11], v2, s[8:11], s20 offen offset:0 sc1
  buffer_load_dwordx4 v[12:15], v2, s[8:11], s20 offen offset:1024 sc1
  buffer_load_dwordx4 v[16:19], v2, s[8:11], s20 offen offset:2048 sc1
  buffer_load_dwordx4 v[20:23], v2, s[8:11], s20 offen offset:3072 sc1
  buffer_load_dwordx4 v[24:27], v2, s[8:11], s23 offen offset:0 sc1
  buffer_load_dwordx4 v[28:31], v2, s[8:11], s23 offen offset:1024 sc1
  buffer_load_dwordx4 v[32:35], v2, s[8:11], s23 offen offset:2048 sc1
  s_waitcnt vmcnt(0)
  v_max3_u32 v36, v8, v9, v10
  v_max3_u32 v36, v36, v11, v12
  v_max3_u32 v36, v36, v13, v14
  v_max3_u32 v36, v36, v15, v16
  v_max3_u32 v36, v36, v17, v18
  v_max3_u32 v36, v36, v19, v20
  v_max3_u32 v36, v36, v21, v22
  v_max3_u32 v36, v36, v23, v24
  v_max3_u32 v36, v36, v25, v26
  v_max3_u32 v36, v36, v27, v28
  v_max3_u32 v36, v36, v29, v30
  v_max3_u32 v36, v36, v31, v32
  v_max3_u32 v36, v36, v33, v34
  v_max_u32 v36, v36, v35
  v_cmp_eq_u32 vcc, -1, v36
  s_cbranch_vccz cB_va1_sl2
  s_add_u32 s30, s30, 1
  s_cmp_lt_u32 s30, 400000
  s_cbranch_scc1 cB_va1_sl1
  s_branch cB_abort
cB_va1_sl2:
  v_mov_b32 v36, 0
  v_mov_b32 v37, 0
  v_mov_b32 v38, 0
  v_mov_b32 v39, 0
  v_mov_b32 v40, 0
  v_mov_b32 v41, 0
  v_mov_b32 v42, 0
  v_mov_b32 v43, 0
  v_mov_b32 v44, 0
  v_mov_b32 v45, 0
  v_mov_b32 v46, 0
  v_mov_b32 v47, 0
  v_mov_b32 v48, 0
  v_mov_b32 v49, 0
  v_mov_b32 v50, 0
  v_mov_b32 v51, 0
  v_mov_b32 v52, 0
  v_mov_b32 v53, 0
  v_mov_b32 v54, 0
  v_mov_b32 v55, 0
  v_mov_b32 v56, 0
  v_mov_b32 v57, 0
  v_mov_b32 v58, 0
  v_mov_b32 v59, 0
  v_mov_b32 v60, 0
  v_mov_b32 v61, 0
  v_mov_b32 v62, 0
  v_mov_b32 v63, 0
  buffer_store_dword v162, v1, s[8:11], s21 offen sc1
  ds_read_b128 v[64:67], v0 offset:0
  ds_read_b128 v[68:71], v0 offset:1024
  v_smfmac_f32_16x16x64_bf16 v[36:39], v[8:11], a[0:7], v3
  v_smfmac_f32_16x16x64_bf16 v[40:43], v[8:11], a[56:63], v3
  v_smfmac_f32_16x16x64_bf16 v[44:47], v[8:11], a[112:119], v3
  v_smfmac_f32_16x16x64_bf16 v[48:51], v[8:11], a[168:175], v3
  v_smfmac_f32_16x16x64_bf16 v[52:55], v[8:11], a[224:231], v3
  v_smfmac_f32_16x16x64_bf16 v[56:59], v[8:11], v[200:207], v3
  s_waitcnt lgkmcnt(0)
  v_smfmac_f32_16x16x64_bf16 v[60:63], v[8:11], v[64:71], v3
  ds_read_b128 v[72:75], v0 offset:2048
  ds_read_b128 v[76:79], v0 offset:3072
  v_smfmac_f32_16x16x64_bf16 v[36:39], v[12:15], a[8:15], v3
  v_smfmac_f32_16x16x64_bf16 v[40:43], v[12:15], a[64:71], v3
  v_smfmac_f32_16x16x64_bf16 v[44:47], v[12:15], a[120:127], v3
  v_smfmac_f32_16x16x64_bf16 v[48:51], v[12:15], a[176:183], v3
  v_smfmac_f32_16x16x64_bf16 v[52:55], v[12:15], a[232:239], v3
  v_smfmac_f32_16x16x64_bf16 v[56:59], v[12:15], v[208:215], v3
  s_waitcnt lgkmcnt(0)
  v_smfmac_f32_16x16x64_bf16 v[60:63], v[12:15], v[72:79], v3
  ds_read_b128 v[144:147], v0 offset:4096
  ds_read_b128 v[148:151], v0 offset:5120
  v_smfmac_f32_16x16x64_bf16 v[36:39], v[16:19], a[16:23], v3
  v_smfmac_f32_16x16x64_bf16 v[40:43], v[16:19], a[72:79], v3
  v_smfmac_f32_16x16x64_bf16 v[44:47], v[16:19], a[128:135], v3
  v_smfmac_f32_16x16x64_bf16 v[48:51], v[16:19], a[184:191], v3
  v_smfmac_f32_16x16x64_bf16 v[52:55], v[16:19], a[240:247], v3
  v_smfmac_f32_16x16x64_bf16 v[56:59], v[16:19], v[216:223], v3
  s_waitcnt lgkmcnt(0)
  v_smfmac_f32_16x16x64_bf16 v[60:63], v[16:19], v[144:151], v3
  ds_read_b128 v[64:67], v0 offset:6144
  ds_read_b128 v[68:71], v0 offset:7168
  v_smfmac_f32_16x16x64_bf16 v[36:39], v[20:23], a[24:31], v3
  v_smfmac_f32_16x16x64_bf16 v[40:43], v[20:23], a[80:87], v3
  v_smfmac_f32_16x16x64_bf16 v[44:47], v[20:23], a[136:143], v3
  v_smfmac_f32_16x16x64_bf16 v[48:51], v[20:23], a[192:199], v3
  v_smfmac_f32_16x16x64_bf16 v[52:55], v[20:23], a[248:255], v3
  v_smfmac_f32_16x16x64_bf16 v[56:59], v[20:23], v[224:231], v3
  s_waitcnt lgkmcnt(0)
  v_smfmac_f32_16x16x64_bf16 v[60:63], v[20:23], v[64:71], v3
  ds_read_b128 v[72:75], v0 offset:8192
  ds_read_b128 v[76:79], v0 offset:9216
  v_smfmac_f32_16x16x64_bf16 v[36:39], v[24:27], a[32:39], v3
  v_smfmac_f32_16x16x64_bf16 v[40:43], v[24:27], a[88:95], v3
  v_smfmac_f32_16x16x64_bf16 v[44:47], v[24:27], a[144:151], v3
  v_smfmac_f32_16x16x64_bf16 v[48:51], v[24:27], a[200:207], v3
  v_smfmac_f32_16x16x64_bf16 v[52:55], v[24:27], v[176:183], v3
  v_smfmac_f32_16x16x64_bf16 v[56:59], v[24:27], v[232:239], v3
  s_waitcnt lgkmcnt(0)
  v_smfmac_f32_16x16x64_bf16 v[60:63], v[24:27], v[72:79], v3
  ds_read_b128 v[144:147], v0 offset:10240
  ds_read_b128 v[148:151], v0 offset:11264
  v_smfmac_f32_16x16x64_bf16 v[36:39], v[28:31], a[40:47], v3
  v_smfmac_f32_16x16x64_bf16 v[40:43], v[28:31], a[96:103], v3
  v_smfmac_f32_16x16x64_bf16 v[44:47], v[28:31], a[152:159], v3
  v_smfmac_f32_16x16x64_bf16 v[48:51], v[28:31], a[208:215], v3
  v_smfmac_f32_16x16x64_bf16 v[52:55], v[28:31], v[184:191], v3
  v_smfmac_f32_16x16x64_bf16 v[56:59], v[28:31], v[240:247], v3
  s_waitcnt lgkmcnt(0)
  v_smfmac_f32_16x16x64_bf16 v[60:63], v[28:31], v[144:151], v3
  ds_read_b128 v[64:67], v0 offset:12288
  ds_read_b128 v[68:71], v0 offset:13312
  v_smfmac_f32_16x16x64_bf16 v[36:39], v[32:35], a[48:55], v3
  v_smfmac_f32_16x16x64_bf16 v[40:43], v[32:35], a[104:111], v3
  v_smfmac_f32_16x16x64_bf16 v[44:47], v[32:35], a[160:167], v3
  v_smfmac_f32_16x16x64_bf16 v[48:51], v[32:35], a[216:223], v3
  v_smfmac_f32_16x16x64_bf16 v[52:55], v[32:35], v[192:199], v3
  v_smfmac_f32_16x16x64_bf16 v[56:59], v[32:35], v[248:255], v3
  s_waitcnt lgkmcnt(0)
  v_smfmac_f32_16x16x64_bf16 v[60:63], v[32:35], v[64:71], v3
  v_permlane32_swap_b32 v36, v38
  v_permlane32_swap_b32 v37, v39
  v_add_f32 v36, v36, v38
  v_add_f32 v37, v37, v39
  v_cvt_pk_bf16_f32 v38, v36, v37
  ds_write_b32 v152, v38
  v_permlane32_swap_b32 v40, v42
  v_permlane32_swap_b32 v41, v43
  v_add_f32 v40, v40, v42
  v_add_f32 v41, v41, v43
  v_cvt_pk_bf16_f32 v42, v40, v41
  ds_write_b32 v153, v42
  v_permlane32_swap_b32 v44, v46
  v_permlane32_swap_b32 v45, v47
  v_add_f32 v44, v44, v46
  v_add_f32 v45, v45, v47
  v_cvt_pk_bf16_f32 v46, v44, v45
  ds_write_b32 v154, v46
  v_permlane32_swap_b32 v48, v50
  v_permlane32_swap_b32 v49, v51
  v_add_f32 v48, v48, v50
  v_add_f32 v49, v49, v51
  v_cvt_pk_bf16_f32 v50, v48, v49
  ds_write_b32 v155, v50
  v_permlane32_swap_b32 v52, v54
  v_permlane32_swap_b32 v53, v55
  v_add_f32 v52, v52, v54
  v_add_f32 v53, v53, v55
  v_cvt_pk_bf16_f32 v54, v52, v53
  ds_write_b32 v156, v54
  v_permlane32_swap_b32 v56, v58
  v_permlane32_swap_b32 v57, v59
  v_add_f32 v56, v56, v58
  v_add_f32 v57, v57, v59
  v_cvt_pk_bf16_f32 v58, v56, v57
  ds_write_b32 v157, v58
  v_permlane32_swap_b32 v60, v62
  v_permlane32_swap_b32 v61, v63
  v_add_f32 v60, v60, v62
  v_add_f32 v61, v61, v63
  v_cvt_pk_bf16_f32 v62, v60, v61
  ds_write_b32 v158, v62
  s_branch cB_va1_t2d
cB_va1_last:
  s_barrier
  ds_read_b128 v[64:67], v2 offset:4096
  ds_read_b128 v[68:71], v2 offset:5120
  ds_read_b128 v[72:75], v2 offset:6144
  ds_read_b128 v[76:79], v2 offset:7168
  s_waitcnt lgkmcnt(0)
  v_min_u32 v64, -2, v64
  v_min_u32 v65, -2, v65
  v_min_u32 v66, -2, v66
  v_min_u32 v67, -2, v67
  v_min_u32 v68, -2, v68
  v_min_u32 v69, -2, v69
  v_min_u32 v70, -2, v70
  v_min_u32 v71, -2, v71
  v_min_u32 v72, -2, v72
  v_min_u32 v73, -2, v73
  v_min_u32 v74, -2, v74
  v_min_u32 v75, -2, v75
  v_min_u32 v76, -2, v76
  v_min_u32 v77, -2, v77
  v_min_u32 v78, -2, v78
  v_min_u32 v79, -2, v79
  buffer_store_dwordx4 v[64:67], v2, s[8:11], s33 offen offset:0 sc1
  buffer_store_dwordx4 v[68:71], v2, s[8:11], s33 offen offset:2048 sc1
  s_add_u32 s33, s33, 4096
  buffer_store_dwordx4 v[72:75], v2, s[8:11], s33 offen offset:0 sc1
  buffer_store_dwordx4 v[76:79], v2, s[8:11], s33 offen offset:2048 sc1
  s_add_u32 s33, s33, 4096
  s_branch cB_done
cB_va1_rp:
  s_cmp_eq_u32 s37, 0
  s_cbranch_scc1 cB_va1_rv
  v_min_u32 v160, -2, v160
  buffer_store_dword v160, v1, s[8:11], s21 offen sc1
  s_branch cB_va1_cont
cB_va1_rv:
  s_add_u32 s31, s31, 0x10000
  buffer_load_dwordx4 v[8:11], v2, s[8:11], s72 offen offset:0 sc1
  buffer_load_dwordx4 v[12:15], v2, s[8:11], s72 offen offset:1024 sc1
  buffer_load_dwordx4 v[16:19], v2, s[8:11], s73 offen offset:0 sc1
  buffer_load_dwordx4 v[20:23], v2, s[8:11], s73 offen offset:1024 sc1
  buffer_load_dwordx4 v[24:27], v2, s[8:11], s74 offen offset:0 sc1
  buffer_load_dwordx4 v[28:31], v2, s[8:11], s74 offen offset:1024 sc1
  buffer_load_dwordx4 v[32:35], v2, s[8:11], s75 offen offset:0 sc1
  buffer_load_dwordx4 v[36:39], v2, s[8:11], s75 offen offset:1024 sc1
  buffer_load_dwordx4 v[40:43], v2, s[8:11], s36 offen offset:0 sc1
  buffer_load_dwordx4 v[44:47], v2, s[8:11], s36 offen offset:1024 sc1
  s_waitcnt vmcnt(0)
  v_max3_u32 v52, v8, v9, v10
  v_max3_u32 v52, v52, v11, v12
  v_max3_u32 v52, v52, v13, v14
  v_max3_u32 v52, v52, v15, v16
  v_max3_u32 v52, v52, v17, v18
  v_max3_u32 v52, v52, v19, v20
  v_max3_u32 v52, v52, v21, v22
  v_max3_u32 v52, v52, v23, v24
  v_max3_u32 v52, v52, v25, v26
  v_max3_u32 v52, v52, v27, v28
  v_max3_u32 v52, v52, v29, v30
  v_max3_u32 v52, v52, v31, v32
  v_max3_u32 v52, v52, v33, v34
  v_max3_u32 v52, v52, v35, v36
  v_max3_u32 v52, v52, v37, v38
  v_max3_u32 v52, v52, v39, v40
  v_max3_u32 v52, v52, v41, v42
  v_max3_u32 v52, v52, v43, v44
  v_max3_u32 v52, v52, v45, v46
  v_max_u32 v52, v52, v47
  v_cmp_eq_u32 vcc, -1, v52
  s_mov_b32 s37, 1
  v_mov_b32 v48, 0
  v_mov_b32 v49, 0
  v_mov_b32 v50, 0
  v_mov_b32 v51, 0
  s_nop 1
  s_cbranch_vccz cB_va1_lp
  s_add_u32 s30, s30, 1
  s_cmp_lt_u32 s30, 400000
  s_cbranch_scc1 cB_va1_rv
  s_branch cB_abort
.p2align 6
cB_va2_loop:
  s_mov_b32 s30, 0
cB_va2_fp_l:
  v_cmp_gt_u32 vcc, s19, v96
  buffer_load_dword v96, v119, s[8:11], 0 offen sc1
  s_cbranch_vccz cB_va2_fp_d
  v_cmp_gt_u32 vcc, s19, v96
  buffer_load_dword v96, v119, s[8:11], 0 offen sc1
  s_cbranch_vccz cB_va2_fp_d
  v_cmp_gt_u32 vcc, s19, v96
  buffer_load_dword v96, v119, s[8:11], 0 offen sc1
  s_cbranch_vccz cB_va2_fp_d
  v_cmp_gt_u32 vcc, s19, v96
  buffer_load_dword v96, v119, s[8:11], 0 offen sc1
  s_cbranch_vccz cB_va2_fp_d
  v_cmp_gt_u32 vcc, s19, v96
  buffer_load_dword v96, v119, s[8:11], 0 offen sc1
  s_cbranch_vccz cB_va2_fp_d
  v_cmp_gt_u32 vcc, s19, v96
  buffer_load_dword v96, v119, s[8:11], 0 offen sc1
  s_cbranch_vccz cB_va2_fp_d
  v_cmp_gt_u32 vcc, s19, v96
  buffer_load_dword v96, v119, s[8:11], 0 offen sc1
  s_cbranch_vccz cB_va2_fp_d
  v_cmp_gt_u32 vcc, s19, v96
  buffer_load_dword v96, v119, s[8:11], 0 offen sc1
  s_cbranch_vccz cB_va2_fp_d
  v_cmp_gt_u32 vcc, s19, v96
  buffer_load_dword v96, v119, s[8:11], 0 offen sc1
  s_cbranch_vccz cB_va2_fp_d
  v_cmp_gt_u32 vcc, s19, v96
  buffer_load_dword v96, v119, s[8:11], 0 offen sc1
  s_cbranch_vccz cB_va2_fp_d
  v_cmp_gt_u32 vcc, s19, v96
  buffer_load_dword v96, v119, s[8:11], 0 offen sc1
  s_cbranch_vccz cB_va2_fp_d
  v_cmp_gt_u32 vcc, s19, v96
  buffer_load_dword v96, v119, s[8:11], 0 offen sc1
  s_cbranch_vccz cB_va2_fp_d
  v_cmp_gt_u32 vcc, s19, v96
  buffer_load_dword v96, v119, s[8:11], 0 offen sc1
  s_cbranch_vccz cB_va2_fp_d
  v_cmp_gt_u32 vcc, s19, v96
  buffer_load_dword v96, v119, s[8:11], 0 offen sc1
  s_cbranch_vccz cB_va2_fp_d
  v_cmp_gt_u32 vcc, s19, v96
  buffer_load_dword v96, v119, s[8:11], 0 offen sc1
  s_cbranch_vccz cB_va2_fp_d
  v_cmp_gt_u32 vcc, s19, v96
  buffer_load_dword v96, v119, s[8:11], 0 offen sc1
  s_cbranch_vccz cB_va2_fp_d
  s_waitcnt vmcnt(24)
  s_add_u32 s30, s30, 1
  s_cmp_lt_u32 s30, 400000
  s_cbranch_scc1 cB_va2_fp_l
  s_branch cB_abort
cB_va2_fp_d:
  buffer_load_dwordx4 v[8:11], v2, s[8:11], s20 offen offset:0 sc1
  buffer_load_dwordx4 v[12:15], v2, s[8:11], s20 offen offset:1024 sc1
  s_barrier
  s_barrier
  s_waitcnt vmcnt(0)
  ds_write_b128 v2, v[8:11] offset:8192
  ds_write_b128 v2, v[12:15] offset:9216
  v_smfmac_f32_16x16x64_bf16 v[36:39], v[8:11], a[0:7], v3
  v_smfmac_f32_16x16x64_bf16 v[40:43], v[8:11], a[56:63], v3
  v_smfmac_f32_16x16x64_bf16 v[44:47], v[8:11], a[112:119], v3
  v_smfmac_f32_16x16x64_bf16 v[48:51], v[8:11], a[168:175], v3
  v_smfmac_f32_16x16x64_bf16 v[52:55], v[8:11], a[224:231], v3
  s_waitcnt lgkmcnt(0)
  s_barrier
  ds_read_b128 v[16:19], v2 offset:10240
  ds_read_b128 v[20:23], v2 offset:11264
  ds_read_b128 v[24:27], v2 offset:12288
  ds_read_b128 v[28:31], v2 offset:13312
  ds_read_b128 v[32:35], v2 offset:14336
  v_smfmac_f32_16x16x64_bf16 v[56:59], v[8:11], v[144:151], v3
  v_smfmac_f32_16x16x64_bf16 v[60:63], v[8:11], v[200:207], v3
  v_smfmac_f32_16x16x64_bf16 v[36:39], v[12:15], a[8:15], v3
  v_smfmac_f32_16x16x64_bf16 v[40:43], v[12:15], a[64:71], v3
  v_smfmac_f32_16x16x64_bf16 v[44:47], v[12:15], a[120:127], v3
  v_smfmac_f32_16x16x64_bf16 v[48:51], v[12:15], a[176:183], v3
  v_smfmac_f32_16x16x64_bf16 v[52:55], v[12:15], a[232:239], v3
  v_smfmac_f32_16x16x64_bf16 v[56:59], v[12:15], v[152:159], v3
  ds_read_b128 v[68:71], v0 offset:0
  ds_read_b128 v[72:75], v0 offset:1024
  v_smfmac_f32_16x16x64_bf16 v[60:63], v[12:15], v[208:215], v3
  s_waitcnt lgkmcnt(6)
  ds_read_b128 v[76:79], v0 offset:2048
  ds_read_b128 v[80:83], v0 offset:3072
  v_smfmac_f32_16x16x64_bf16 v[36:39], v[16:19], a[16:23], v3
  s_waitcnt lgkmcnt(7)
  v_smfmac_f32_16x16x64_bf16 v[36:39], v[20:23], a[24:31], v3
  s_waitcnt lgkmcnt(6)
  v_smfmac_f32_16x16x64_bf16 v[36:39], v[24:27], a[32:39], v3
  s_waitcnt lgkmcnt(2)
  v_smfmac_f32_16x16x64_bf16 v[64:67], v[8:11], v[68:75], v3
  s_waitcnt lgkmcnt(5)
  ds_read_b128 v[84:87], v0 offset:4096
  ds_read_b128 v[88:91], v0 offset:5120
  v_smfmac_f32_16x16x64_bf16 v[36:39], v[28:31], a[40:47], v3
  s_waitcnt lgkmcnt(6)
  v_smfmac_f32_16x16x64_bf16 v[36:39], v[32:35], a[48:55], v3
  v_smfmac_f32_16x16x64_bf16 v[40:43], v[16:19], a[72:79], v3
  s_waitcnt lgkmcnt(2)
  v_smfmac_f32_16x16x64_bf16 v[64:67], v[12:15], v[76:83], v3
  ds_read_b128 v[68:71], v0 offset:6144
  ds_read_b128 v[72:75], v0 offset:7168
  v_smfmac_f32_16x16x64_bf16 v[40:43], v[20:23], a[80:87], v3
  v_permlane32_swap_b32 v36, v38
  v_smfmac_f32_16x16x64_bf16 v[40:43], v[24:27], a[88:95], v3
  v_permlane32_swap_b32 v37, v39
  v_smfmac_f32_16x16x64_bf16 v[40:43], v[28:31], a[96:103], v3
  s_waitcnt lgkmcnt(2)
  v_add_f32 v36, v36, v38
  v_smfmac_f32_16x16x64_bf16 v[64:67], v[16:19], v[84:91], v3
  ds_read_b128 v[76:79], v0 offset:8192
  ds_read_b128 v[80:83], v0 offset:9216
  v_add_f32 v37, v37, v39
  v_smfmac_f32_16x16x64_bf16 v[40:43], v[32:35], a[104:111], v3
  v_cmp_u_f32 vcc, v36, v37
  v_smfmac_f32_16x16x64_bf16 v[44:47], v[16:19], a[128:135], v3
  v_cvt_pk_bf16_f32 v38, v36, v37
  v_smfmac_f32_16x16x64_bf16 v[44:47], v[20:23], a[136:143], v3
  ds_write_b32 v104, v38
  s_waitcnt lgkmcnt(3)
  s_cbranch_vccnz cB_va2_slow
  v_permlane32_swap_b32 v40, v42
  v_smfmac_f32_16x16x64_bf16 v[64:67], v[20:23], v[68:75], v3
  ds_read_b128 v[84:87], v0 offset:10240
  ds_read_b128 v[88:91], v0 offset:11264
  v_permlane32_swap_b32 v41, v43
  v_smfmac_f32_16x16x64_bf16 v[44:47], v[24:27], a[144:151], v3
  v_add_f32 v40, v40, v42
  v_smfmac_f32_16x16x64_bf16 v[44:47], v[28:31], a[152:159], v3
  v_add_f32 v41, v41, v43
  v_smfmac_f32_16x16x64_bf16 v[44:47], v[32:35], a[160:167], v3
  s_waitcnt lgkmcnt(3)
  v_cvt_pk_bf16_f32 v42, v40, v41
  v_smfmac_f32_16x16x64_bf16 v[64:67], v[24:27], v[76:83], v3
  ds_write_b32 v105, v42
  ds_read_b128 v[68:71], v0 offset:12288
  ds_read_b128 v[72:75], v0 offset:13312
  v_smfmac_f32_16x16x64_bf16 v[48:51], v[16:19], a[184:191], v3
  s_nop 0
  v_permlane32_swap_b32 v44, v46
  v_smfmac_f32_16x16x64_bf16 v[48:51], v[20:23], a[192:199], v3
  v_permlane32_swap_b32 v45, v47
  v_smfmac_f32_16x16x64_bf16 v[48:51], v[24:27], a[200:207], v3
  s_waitcnt lgkmcnt(3)
  v_add_f32 v44, v44, v46
  v_smfmac_f32_16x16x64_bf16 v[64:67], v[28:31], v[84:91], v3
  v_add_f32 v45, v45, v47
  v_smfmac_f32_16x16x64_bf16 v[48:51], v[28:31], a[208:215], v3
  v_cvt_pk_bf16_f32 v46, v44, v45
  v_smfmac_f32_16x16x64_bf16 v[48:51], v[32:35], a[216:223], v3
  ds_write_b32 v106, v46
  v_smfmac_f32_16x16x64_bf16 v[52:55], v[16:19], a[240:247], v3
  s_waitcnt lgkmcnt(1)
  v_smfmac_f32_16x16x64_bf16 v[64:67], v[32:35], v[68:75], v3
  v_smfmac_f32_16x16x64_bf16 v[52:55], v[20:23], a[248:255], v3
  v_permlane32_swap_b32 v48, v50
  v_smfmac_f32_16x16x64_bf16 v[52:55], v[24:27], v[120:127], v3
  v_permlane32_swap_b32 v49, v51
  v_smfmac_f32_16x16x64_bf16 v[52:55], v[28:31], v[128:135], v3
  v_add_f32 v48, v48, v50
  v_smfmac_f32_16x16x64_bf16 v[52:55], v[32:35], v[136:143], v3
  v_add_f32 v49, v49, v51
  v_smfmac_f32_16x16x64_bf16 v[56:59], v[16:19], v[160:167], v3
  v_cvt_pk_bf16_f32 v50, v48, v49
  v_smfmac_f32_16x16x64_bf16 v[56:59], v[20:23], v[168:175], v3
  ds_write_b32 v107, v50
  v_permlane32_swap_b32 v64, v66
  v_smfmac_f32_16x16x64_bf16 v[56:59], v[24:27], v[176:183], v3
  v_permlane32_swap_b32 v65, v67
  v_smfmac_f32_16x16x64_bf16 v[56:59], v[28:31], v[184:191], v3
  v_add_f32 v64, v64, v66
  v_smfmac_f32_16x16x64_bf16 v[56:59], v[32:35], v[192:199], v3
  v_add_f32 v65, v65, v67
  v_smfmac_f32_16x16x64_bf16 v[60:63], v[16:19], v[216:223], v3
  v_cvt_pk_bf16_f32 v66, v64, v65
  v_smfmac_f32_16x16x64_bf16 v[60:63], v[20:23], v[224:231], v3
  ds_write_b32 v111, v66
  v_permlane32_swap_b32 v52, v54
  v_smfmac_f32_16x16x64_bf16 v[60:63], v[24:27], v[232:239], v3
  v_permlane32_swap_b32 v53, v55
  v_smfmac_f32_16x16x64_bf16 v[60:63], v[28:31], v[240:247], v3
  v_add_f32 v52, v52, v54
  v_smfmac_f32_16x16x64_bf16 v[60:63], v[32:35], v[248:255], v3
  v_add_f32 v53, v53, v55
  v_cvt_pk_bf16_f32 v54, v52, v53
  ds_write_b32 v108, v54
  v_permlane32_swap_b32 v56, v58
  v_permlane32_swap_b32 v57, v59
  v_add_f32 v56, v56, v58
  v_add_f32 v57, v57, v59
  v_cvt_pk_bf16_f32 v58, v56, v57
  ds_write_b32 v109, v58
  v_permlane32_swap_b32 v60, v62
  v_permlane32_swap_b32 v61, v63
  v_add_f32 v60, v60, v62
  v_add_f32 v61, v61, v63
  v_cvt_pk_bf16_f32 v62, v60, v61
  ds_write_b32 v110, v62
cB_va2_t2d:
  v_mov_b32 v117, s18
  s_waitcnt lgkmcnt(0)
  s_barrier
  s_cmp_eq_u32 s19, 63
  s_cbranch_scc1 cB_done
  s_sleep 1
  v_mov_b32 v36, 0
  v_mov_b32 v37, 0
  v_mov_b32 v38, 0
  v_mov_b32 v39, 0
  v_mov_b32 v40, 0
  v_mov_b32 v41, 0
  v_mov_b32 v42, 0
  v_mov_b32 v43, 0
  v_mov_b32 v44, 0
  v_mov_b32 v45, 0
  v_mov_b32 v46, 0
  v_mov_b32 v47, 0
  v_mov_b32 v48, 0
  v_mov_b32 v49, 0
  v_mov_b32 v50, 0
  v_mov_b32 v51, 0
  v_mov_b32 v52, 0
  v_mov_b32 v53, 0
  v_mov_b32 v54, 0
  v_mov_b32 v55, 0
  v_mov_b32 v56, 0
  v_mov_b32 v57, 0
  v_mov_b32 v58, 0
  v_mov_b32 v59, 0
  v_mov_b32 v60, 0
  v_mov_b32 v61, 0
  v_mov_b32 v62, 0
  v_mov_b32 v63, 0
  v_mov_b32 v64, 0
  v_mov_b32 v65, 0
  v_mov_b32 v66, 0
  v_mov_b32 v67, 0
  s_sleep 5
  s_mov_b32 s19, s18
  s_add_u32 s18, s18, 1
  s_mov_b32 s22, s20
  s_mov_b32 s20, s21
  s_mov_b32 s21, s22
  s_add_u32 s23, s20, 4096
  s_branch cB_va2_loop
cB_va2_slow:
  s_waitcnt lgkmcnt(0)
cB_va2_sl1:
  s_add_u32 s31, s31, 0x1000000
  buffer_load_dwordx4 v[8:11], v2, s[8:11], s20 offen offset:0 sc1
  buffer_load_dwordx4 v[12:15], v2, s[8:11], s20 offen offset:1024 sc1
  buffer_load_dwordx4 v[16:19], v2, s[8:11], s20 offen offset:2048 sc1
  buffer_load_dwordx4 v[20:23], v2, s[8:11], s20 offen offset:3072 sc1
  buffer_load_dwordx4 v[24:27], v2, s[8:11], s23 offen offset:0 sc1
  buffer_load_dwordx4 v[28:31], v2, s[8:11], s23 offen offset:1024 sc1
  buffer_load_dwordx4 v[32:35], v2, s[8:11], s23 offen offset:2048 sc1
  s_waitcnt vmcnt(0)
  v_max3_u32 v36, v8, v9, v10
  v_max3_u32 v36, v36, v11, v12
  v_max3_u32 v36, v36, v13, v14
  v_max3_u32 v36, v36, v15, v16
  v_max3_u32 v36, v36, v17, v18
  v_max3_u32 v36, v36, v19, v20
  v_max3_u32 v36, v36, v21, v22
  v_max3_u32 v36, v36, v23, v24
  v_max3_u32 v36, v36, v25, v26
  v_max3_u32 v36, v36, v27, v28
  v_max3_u32 v36, v36, v29, v30
  v_max3_u32 v36, v36, v31, v32
  v_max3_u32 v36, v36, v33, v34
  v_max_u32 v36, v36, v35
  v_cmp_eq_u32 vcc, -1, v36
  s_cbranch_vccz cB_va2_sl2
  s_add_u32 s30, s30, 1
  s_cmp_lt_u32 s30, 400000
  s_cbranch_scc1 cB_va2_sl1
  s_branch cB_abort
cB_va2_sl2:
  v_mov_b32 v36, 0
  v_mov_b32 v37, 0
  v_mov_b32 v38, 0
  v_mov_b32 v39, 0
  v_mov_b32 v40, 0
  v_mov_b32 v41, 0
  v_mov_b32 v42, 0
  v_mov_b32 v43, 0
  v_mov_b32 v44, 0
  v_mov_b32 v45, 0
  v_mov_b32 v46, 0
  v_mov_b32 v47, 0
  v_mov_b32 v48, 0
  v_mov_b32 v49, 0
  v_mov_b32 v50, 0
  v_mov_b32 v51, 0
  v_mov_b32 v52, 0
  v_mov_b32 v53, 0
  v_mov_b32 v54, 0
  v_mov_b32 v55, 0
  v_mov_b32 v56, 0
  v_mov_b32 v57, 0
  v_mov_b32 v58, 0
  v_mov_b32 v59, 0
  v_mov_b32 v60, 0
  v_mov_b32 v61, 0
  v_mov_b32 v62, 0
  v_mov_b32 v63, 0
  v_mov_b32 v64, 0
  v_mov_b32 v65, 0
  v_mov_b32 v66, 0
  v_mov_b32 v67, 0
  ds_read_b128 v[68:71], v0 offset:0
  ds_read_b128 v[72:75], v0 offset:1024
  v_smfmac_f32_16x16x64_bf16 v[36:39], v[8:11], a[0:7], v3
  v_smfmac_f32_16x16x64_bf16 v[40:43], v[8:11], a[56:63], v3
  v_smfmac_f32_16x16x64_bf16 v[44:47], v[8:11], a[112:119], v3
  v_smfmac_f32_16x16x64_bf16 v[48:51], v[8:11], a[168:175], v3
  v_smfmac_f32_16x16x64_bf16 v[52:55], v[8:11], a[224:231], v3
  v_smfmac_f32_16x16x64_bf16 v[56:59], v[8:11], v[144:151], v3
  v_smfmac_f32_16x16x64_bf16 v[60:63], v[8:11], v[200:207], v3
  s_waitcnt lgkmcnt(0)
  v_smfmac_f32_16x16x64_bf16 v[64:67], v[8:11], v[68:75], v3
  ds_read_b128 v[76:79], v0 offset:2048
  ds_read_b128 v[80:83], v0 offset:3072
  v_smfmac_f32_16x16x64_bf16 v[36:39], v[12:15], a[8:15], v3
  v_smfmac_f32_16x16x64_bf16 v[40:43], v[12:15], a[64:71], v3
  v_smfmac_f32_16x16x64_bf16 v[44:47], v[12:15], a[120:127], v3
  v_smfmac_f32_16x16x64_bf16 v[48:51], v[12:15], a[176:183], v3
  v_smfmac_f32_16x16x64_bf16 v[52:55], v[12:15], a[232:239], v3
  v_smfmac_f32_16x16x64_bf16 v[56:59], v[12:15], v[152:159], v3
  v_smfmac_f32_16x16x64_bf16 v[60:63], v[12:15], v[208:215], v3
  s_waitcnt lgkmcnt(0)
  v_smfmac_f32_16x16x64_bf16 v[64:67], v[12:15], v[76:83], v3
  ds_read_b128 v[84:87], v0 offset:4096
  ds_read_b128 v[88:91], v0 offset:5120
  v_smfmac_f32_16x16x64_bf16 v[36:39], v[16:19], a[16:23], v3
  v_smfmac_f32_16x16x64_bf16 v[40:43], v[16:19], a[72:79], v3
  v_smfmac_f32_16x16x64_bf16 v[44:47], v[16:19], a[128:135], v3
  v_smfmac_f32_16x16x64_bf16 v[48:51], v[16:19], a[184:191], v3
  v_smfmac_f32_16x16x64_bf16 v[52:55], v[16:19], a[240:247], v3
  v_smfmac_f32_16x16x64_bf16 v[56:59], v[16:19], v[160:167], v3
  v_smfmac_f32_16x16x64_bf16 v[60:63], v[16:19], v[216:223], v3
  s_waitcnt lgkmcnt(0)
  v_smfmac_f32_16x16x64_bf16 v[64:67], v[16:19], v[84:91], v3
  ds_read_b128 v[68:71], v0 offset:6144
  ds_read_b128 v[72:75], v0 offset:7168
  v_smfmac_f32_16x16x64_bf16 v[36:39], v[20:23], a[24:31], v3
  v_smfmac_f32_16x16x64_bf16 v[40:43], v[20:23], a[80:87], v3
  v_smfmac_f32_16x16x64_bf16 v[44:47], v[20:23], a[136:143], v3
  v_smfmac_f32_16x16x64_bf16 v[48:51], v[20:23], a[192:199], v3
  v_smfmac_f32_16x16x64_bf16 v[52:55], v[20:23], a[248:255], v3
  v_smfmac_f32_16x16x64_bf16 v[56:59], v[20:23], v[168:175], v3
  v_smfmac_f32_16x16x64_bf16 v[60:63], v[20:23], v[224:231], v3
  s_waitcnt lgkmcnt(0)
  v_smfmac_f32_16x16x64_bf16 v[64:67], v[20:23], v[68:75], v3
  ds_read_b128 v[76:79], v0 offset:8192
  ds_read_b128 v[80:83], v0 offset:9216
  v_smfmac_f32_16x16x64_bf16 v[36:39], v[24:27], a[32:39], v3
  v_smfmac_f32_16x16x64_bf16 v[40:43], v[24:27], a[88:95], v3
  v_smfmac_f32_16x16x64_bf16 v[44:47], v[24:27], a[144:151], v3
  v_smfmac_f32_16x16x64_bf16 v[48:51], v[24:27], a[200:207], v3
  v_smfmac_f32_16x16x64_bf16 v[52:55], v[24:27], v[120:127], v3
  v_smfmac_f32_16x16x64_bf16 v[56:59], v[24:27], v[176:183], v3
  v_smfmac_f32_16x16x64_bf16 v[60:63], v[24:27], v[232:239], v3
  s_waitcnt lgkmcnt(0)
  v_smfmac_f32_16x16x64_bf16 v[64:67], v[24:27], v[76:83], v3
  ds_read_b128 v[84:87], v0 offset:10240
  ds_read_b128 v[88:91], v0 offset:11264
  v_smfmac_f32_16x16x64_bf16 v[36:39], v[28:31], a[40:47], v3
  v_smfmac_f32_16x16x64_bf16 v[40:43], v[28:31], a[96:103], v3
  v_smfmac_f32_16x16x64_bf16 v[44:47], v[28:31], a[152:159], v3
  v_smfmac_f32_16x16x64_bf16 v[48:51], v[28:31], a[208:215], v3
  v_smfmac_f32_16x16x64_bf16 v[52:55], v[28:31], v[128:135], v3
  v_smfmac_f32_16x16x64_bf16 v[56:59], v[28:31], v[184:191], v3
  v_smfmac_f32_16x16x64_bf16 v[60:63], v[28:31], v[240:247], v3
  s_waitcnt lgkmcnt(0)
  v_smfmac_f32_16x16x64_bf16 v[64:67], v[28:31], v[84:91], v3
  ds_read_b128 v[68:71], v0 offset:12288
  ds_read_b128 v[72:75], v0 offset:13312
  v_smfmac_f32_16x16x64_bf16 v[36:39], v[32:35], a[48:55], v3
  v_smfmac_f32_16x16x64_bf16 v[40:43], v[32:35], a[104:111], v3
  v_smfmac_f32_16x16x64_bf16 v[44:47], v[32:35], a[160:167], v3
  v_smfmac_f32_16x16x64_bf16 v[48:51], v[32:35], a[216:223], v3
  v_smfmac_f32_16x16x64_bf16 v[52:55], v[32:35], v[136:143], v3
  v_smfmac_f32_16x16x64_bf16 v[56:59], v[32:35], v[192:199], v3
  v_smfmac_f32_16x16x64_bf16 v[60:63], v[32:35], v[248:255], v3
  s_waitcnt lgkmcnt(0)
  v_smfmac_f32_16x16x64_bf16 v[64:67], v[32:35], v[68:75], v3
  v_permlane32_swap_b32 v36, v38
  v_permlane32_swap_b32 v37, v39
  v_add_f32 v36, v36, v38
  v_add_f32 v37, v37, v39
  v_cvt_pk_bf16_f32 v38, v36, v37
  ds_write_b32 v104, v38
  v_permlane32_swap_b32 v40, v42
  v_permlane32_swap_b32 v41, v43
  v_add_f32 v40, v40, v42
  v_add_f32 v41, v41, v43
  v_cvt_pk_bf16_f32 v42, v40, v41
  ds_write_b32 v105, v42
  v_permlane32_swap_b32 v44, v46
  v_permlane32_swap_b32 v45, v47
  v_add_f32 v44, v44, v46
  v_add_f32 v45, v45, v47
  v_cvt_pk_bf16_f32 v46, v44, v45
  ds_write_b32 v106, v46
  v_permlane32_swap_b32 v48, v50
  v_permlane32_swap_b32 v49, v51
  v_add_f32 v48, v48, v50
  v_add_f32 v49, v49, v51
  v_cvt_pk_bf16_f32 v50, v48, v49
  ds_write_b32 v107, v50
  v_permlane32_swap_b32 v52, v54
  v_permlane32_swap_b32 v53, v55
  v_add_f32 v52, v52, v54
  v_add_f32 v53, v53, v55
  v_cvt_pk_bf16_f32 v54, v52, v53
  ds_write_b32 v108, v54
  v_permlane32_swap_b32 v56, v58
  v_permlane32_swap_b32 v57, v59
  v_add_f32 v56, v56, v58
  v_add_f32 v57, v57, v59
  v_cvt_pk_bf16_f32 v58, v56, v57
  ds_write_b32 v109, v58
  v_permlane32_swap_b32 v60, v62
  v_permlane32_swap_b32 v61, v63
  v_add_f32 v60, v60, v62
  v_add_f32 v61, v61, v63
  v_cvt_pk_bf16_f32 v62, v60, v61
  ds_write_b32 v110, v62
  v_permlane32_swap_b32 v64, v66
  v_permlane32_swap_b32 v65, v67
  v_add_f32 v64, v64, v66
  v_add_f32 v65, v65, v67
  v_cvt_pk_bf16_f32 v66, v64, v65
  ds_write_b32 v111, v66
  s_branch cB_va2_t2d
.p2align 6
cB_va3_loop:
  s_mov_b32 s30, 0
  s_barrier
  buffer_load_dwordx4 v[16:19], v2, s[8:11], s20 offen offset:2048 sc1
  buffer_load_dwordx4 v[20:23], v2, s[8:11], s20 offen offset:3072 sc1
  s_barrier
  buffer_load_dword v100, v116, s[8:11], s39 offen sc1
  s_add_u32 s27, s19, 2
  s_min_u32 s27, s27, 63
  s_lshr_b32 s27, s27, 3
  s_lshl_b32 s27, s27, 11
  s_add_u32 s27, s27, s35
  s_cmp_eq_u32 s27, s28
  s_cselect_b32 s29, 35328, s27
  buffer_load_dword v101, off, s[8:11], s29 sc1
  s_add_u32 s39, s39, 28672
  s_waitcnt vmcnt(2)
  ds_write_b128 v2, v[16:19] offset:10240
  ds_write_b128 v2, v[20:23] offset:11264
  v_smfmac_f32_16x16x64_bf16 v[36:39], v[16:19], a[16:23], v3
  v_smfmac_f32_16x16x64_bf16 v[40:43], v[16:19], a[72:79], v3
  v_smfmac_f32_16x16x64_bf16 v[44:47], v[16:19], a[128:135], v3
  v_smfmac_f32_16x16x64_bf16 v[48:51], v[16:19], a[184:191], v3
  v_smfmac_f32_16x16x64_bf16 v[52:55], v[16:19], a[240:247], v3
  s_waitcnt lgkmcnt(0)
  s_barrier
  ds_read_b128 v[8:11], v2 offset:8192
  ds_read_b128 v[12:15], v2 offset:9216
  ds_read_b128 v[24:27], v2 offset:12288
  ds_read_b128 v[28:31], v2 offset:13312
  ds_read_b128 v[32:35], v2 offset:14336
  v_smfmac_f32_16x16x64_bf16 v[56:59], v[16:19], v[160:167], v3
  v_smfmac_f32_16x16x64_bf16 v[60:63], v[16:19], v[216:223], v3
  v_smfmac_f32_16x16x64_bf16 v[36:39], v[20:23], a[24:31], v3
  v_smfmac_f32_16x16x64_bf16 v[40:43], v[20:23], a[80:87], v3
  v_smfmac_f32_16x16x64_bf16 v[44:47], v[20:23], a[136:143], v3
  v_smfmac_f32_16x16x64_bf16 v[48:51], v[20:23], a[192:199], v3
  v_smfmac_f32_16x16x64_bf16 v[52:55], v[20:23], a[248:255], v3
  v_smfmac_f32_16x16x64_bf16 v[56:59], v[20:23], v[168:175], v3
  v_smfmac_f32_16x16x64_bf16 v[60:63], v[20:23], v[224:231], v3
  s_waitcnt lgkmcnt(4)
  v_smfmac_f32_16x16x64_bf16 v[36:39], v[8:11], a[0:7], v3
  s_waitcnt lgkmcnt(3)
  v_smfmac_f32_16x16x64_bf16 v[36:39], v[12:15], a[8:15], v3
  s_waitcnt lgkmcnt(2)
  v_smfmac_f32_16x16x64_bf16 v[36:39], v[24:27], a[32:39], v3
  s_waitcnt lgkmcnt(1)
  v_smfmac_f32_16x16x64_bf16 v[36:39], v[28:31], a[40:47], v3
  s_waitcnt lgkmcnt(0)
  v_smfmac_f32_16x16x64_bf16 v[36:39], v[32:35], a[48:55], v3
  v_smfmac_f32_16x16x64_bf16 v[40:43], v[8:11], a[56:63], v3
  v_smfmac_f32_16x16x64_bf16 v[40:43], v[12:15], a[64:71], v3
  v_smfmac_f32_16x16x64_bf16 v[40:43], v[24:27], a[88:95], v3
  v_permlane32_swap_b32 v36, v38
  v_smfmac_f32_16x16x64_bf16 v[40:43], v[28:31], a[96:103], v3
  v_permlane32_swap_b32 v37, v39
  v_smfmac_f32_16x16x64_bf16 v[40:43], v[32:35], a[104:111], v3
  v_add_f32 v36, v36, v38
  v_smfmac_f32_16x16x64_bf16 v[44:47], v[8:11], a[112:119], v3
  v_add_f32 v37, v37, v39
  v_smfmac_f32_16x16x64_bf16 v[44:47], v[12:15], a[120:127], v3
  v_cmp_u_f32 vcc, v36, v37
  v_smfmac_f32_16x16x64_bf16 v[44:47], v[24:27], a[144:151], v3
  v_cvt_pk_bf16_f32 v38, v36, v37
  v_smfmac_f32_16x16x64_bf16 v[44:47], v[28:31], a[152:159], v3
  ds_write_b32 v104, v38
  s_cbranch_vccnz cB_va3_slow
  v_permlane32_swap_b32 v40, v42
  v_smfmac_f32_16x16x64_bf16 v[44:47], v[32:35], a[160:167], v3
  v_permlane32_swap_b32 v41, v43
  v_smfmac_f32_16x16x64_bf16 v[48:51], v[8:11], a[168:175], v3
  v_add_f32 v40, v40, v42
  v_smfmac_f32_16x16x64_bf16 v[48:51], v[12:15], a[176:183], v3
  v_add_f32 v41, v41, v43
  v_smfmac_f32_16x16x64_bf16 v[48:51], v[24:27], a[200:207], v3
  v_cvt_pk_bf16_f32 v42, v40, v41
  v_smfmac_f32_16x16x64_bf16 v[48:51], v[28:31], a[208:215], v3
  ds_write_b32 v105, v42
  v_permlane32_swap_b32 v44, v46
  v_smfmac_f32_16x16x64_bf16 v[48:51], v[32:35], a[216:223], v3
  v_permlane32_swap_b32 v45, v47
  v_smfmac_f32_16x16x64_bf16 v[52:55], v[8:11], a[224:231], v3
  v_add_f32 v44, v44, v46
  v_smfmac_f32_16x16x64_bf16 v[52:55], v[12:15], a[232:239], v3
  v_add_f32 v45, v45, v47
  v_smfmac_f32_16x16x64_bf16 v[52:55], v[24:27], v[120:127], v3
  v_cvt_pk_bf16_f32 v46, v44, v45
  v_smfmac_f32_16x16x64_bf16 v[52:55], v[28:31], v[128:135], v3
  ds_write_b32 v106, v46
  v_permlane32_swap_b32 v48, v50
  v_smfmac_f32_16x16x64_bf16 v[52:55], v[32:35], v[136:143], v3
  v_permlane32_swap_b32 v49, v51
  v_smfmac_f32_16x16x64_bf16 v[56:59], v[8:11], v[144:151], v3
  v_add_f32 v48, v48, v50
  v_smfmac_f32_16x16x64_bf16 v[56:59], v[12:15], v[152:159], v3
  v_add_f32 v49, v49, v51
  v_smfmac_f32_16x16x64_bf16 v[56:59], v[24:27], v[176:183], v3
  v_cvt_pk_bf16_f32 v50, v48, v49
  v_smfmac_f32_16x16x64_bf16 v[56:59], v[28:31], v[184:191], v3
  ds_write_b32 v107, v50
  v_permlane32_swap_b32 v52, v54
  v_smfmac_f32_16x16x64_bf16 v[56:59], v[32:35], v[192:199], v3
  v_permlane32_swap_b32 v53, v55
  v_smfmac_f32_16x16x64_bf16 v[60:63], v[8:11], v[200:207], v3
  v_add_f32 v52, v52, v54
  v_smfmac_f32_16x16x64_bf16 v[60:63], v[12:15], v[208:215], v3
  v_add_f32 v53, v53, v55
  v_smfmac_f32_16x16x64_bf16 v[60:63], v[24:27], v[232:239], v3
  v_cvt_pk_bf16_f32 v54, v52, v53
  v_smfmac_f32_16x16x64_bf16 v[60:63], v[28:31], v[240:247], v3
  ds_write_b32 v108, v54
  v_permlane32_swap_b32 v56, v58
  v_smfmac_f32_16x16x64_bf16 v[60:63], v[32:35], v[248:255], v3
  v_permlane32_swap_b32 v57, v59
  v_add_f32 v56, v56, v58
  v_add_f32 v57, v57, v59
  v_cvt_pk_bf16_f32 v58, v56, v57
  ds_write_b32 v109, v58
  s_nop 2
  v_permlane32_swap_b32 v60, v62
  v_permlane32_swap_b32 v61, v63
  v_add_f32 v60, v60, v62
  v_add_f32 v61, v61, v63
  v_cvt_pk_bf16_f32 v62, v60, v61
  ds_write_b32 v110, v62
cB_va3_t2d:
  v_mov_b32 v117, s18
  s_cmp_eq_u32 s27, s28
  s_cbranch_scc1 cB_va3_vok
cB_va3_vow:
  s_waitcnt vmcnt(0)
  v_cmp_ne_u32 vcc, 56, v101
  s_cbranch_vccnz cB_va3_vor
  s_mov_b32 s28, s27
cB_va3_vok:
  s_waitcnt lgkmcnt(0)
  s_setprio 3
  s_cmp_eq_u32 s19, 0
  s_barrier
  s_cbranch_scc1 cB_va3_f0
cB_va3_f1:
  v_mov_b32 v36, 0
  v_mov_b32 v37, 0
  v_mov_b32 v38, 0
  v_mov_b32 v39, 0
  v_mov_b32 v40, 0
  v_mov_b32 v41, 0
  v_mov_b32 v42, 0
  v_mov_b32 v43, 0
  v_mov_b32 v44, 0
  v_mov_b32 v45, 0
  v_mov_b32 v46, 0
  v_mov_b32 v47, 0
  v_mov_b32 v48, 0
  v_mov_b32 v49, 0
  v_mov_b32 v50, 0
  v_mov_b32 v51, 0
  v_mov_b32 v52, 0
  v_mov_b32 v53, 0
  buffer_store_dword v117, v118, s[8:11], 0 offen sc1
  s_setprio 0
  s_cmp_eq_u32 s19, 63
  s_cbranch_scc1 cB_done
  v_mov_b32 v54, 0
  v_mov_b32 v55, 0
  v_mov_b32 v56, 0
  v_mov_b32 v57, 0
  v_mov_b32 v58, 0
  v_mov_b32 v59, 0
  v_mov_b32 v60, 0
  v_mov_b32 v61, 0
  v_mov_b32 v62, 0
  v_mov_b32 v63, 0
  s_mov_b32 s19, s18
  s_add_u32 s18, s18, 1
  s_mov_b32 s22, s20
  s_mov_b32 s20, s21
  s_mov_b32 s21, s22
  s_add_u32 s23, s20, 4096
  s_branch cB_va3_loop
cB_va3_slow:
  s_waitcnt lgkmcnt(0)
cB_va3_sl1:
  s_add_u32 s31, s31, 0x1000000
  buffer_load_dwordx4 v[8:11], v2, s[8:11], s20 offen offset:0 sc1
  buffer_load_dwordx4 v[12:15], v2, s[8:11], s20 offen offset:1024 sc1
  buffer_load_dwordx4 v[16:19], v2, s[8:11], s20 offen offset:2048 sc1
  buffer_load_dwordx4 v[20:23], v2, s[8:11], s20 offen offset:3072 sc1
  buffer_load_dwordx4 v[24:27], v2, s[8:11], s23 offen offset:0 sc1
  buffer_load_dwordx4 v[28:31], v2, s[8:11], s23 offen offset:1024 sc1
  buffer_load_dwordx4 v[32:35], v2, s[8:11], s23 offen offset:2048 sc1
  s_waitcnt vmcnt(0)
  v_max3_u32 v36, v8, v9, v10
  v_max3_u32 v36, v36, v11, v12
  v_max3_u32 v36, v36, v13, v14
  v_max3_u32 v36, v36, v15, v16
  v_max3_u32 v36, v36, v17, v18
  v_max3_u32 v36, v36, v19, v20
  v_max3_u32 v36, v36, v21, v22
  v_max3_u32 v36, v36, v23, v24
  v_max3_u32 v36, v36, v25, v26
  v_max3_u32 v36, v36, v27, v28
  v_max3_u32 v36, v36, v29, v30
  v_max3_u32 v36, v36, v31, v32
  v_max3_u32 v36, v36, v33, v34
  v_max_u32 v36, v36, v35
  v_cmp_eq_u32 vcc, -1, v36
  s_cbranch_vccz cB_va3_sl2
  s_add_u32 s30, s30, 1
  s_cmp_lt_u32 s30, 400000
  s_cbranch_scc1 cB_va3_sl1
  s_branch cB_abort
cB_va3_sl2:
  v_mov_b32 v36, 0
  v_mov_b32 v37, 0
  v_mov_b32 v38, 0
  v_mov_b32 v39, 0
  v_mov_b32 v40, 0
  v_mov_b32 v41, 0
  v_mov_b32 v42, 0
  v_mov_b32 v43, 0
  v_mov_b32 v44, 0
  v_mov_b32 v45, 0
  v_mov_b32 v46, 0
  v_mov_b32 v47, 0
  v_mov_b32 v48, 0
  v_mov_b32 v49, 0
  v_mov_b32 v50, 0
  v_mov_b32 v51, 0
  v_mov_b32 v52, 0
  v_mov_b32 v53, 0
  v_mov_b32 v54, 0
  v_mov_b32 v55, 0
  v_mov_b32 v56, 0
  v_mov_b32 v57, 0
  v_mov_b32 v58, 0
  v_mov_b32 v59, 0
  v_mov_b32 v60, 0
  v_mov_b32 v61, 0
  v_mov_b32 v62, 0
  v_mov_b32 v63, 0
  v_smfmac_f32_16x16x64_bf16 v[36:39], v[8:11], a[0:7], v3
  v_smfmac_f32_16x16x64_bf16 v[40:43], v[8:11], a[56:63], v3
  v_smfmac_f32_16x16x64_bf16 v[44:47], v[8:11], a[112:119], v3
  v_smfmac_f32_16x16x64_bf16 v[48:51], v[8:11], a[168:175], v3
  v_smfmac_f32_16x16x64_bf16 v[52:55], v[8:11], a[224:231], v3
  v_smfmac_f32_16x16x64_bf16 v[56:59], v[8:11], v[144:151], v3
  v_smfmac_f32_16x16x64_bf16 v[60:63], v[8:11], v[200:207], v3
  v_smfmac_f32_16x16x64_bf16 v[36:39], v[12:15], a[8:15], v3
  v_smfmac_f32_16x16x64_bf16 v[40:43], v[12:15], a[64:71], v3
  v_smfmac_f32_16x16x64_bf16 v[44:47], v[12:15], a[120:127], v3
  v_smfmac_f32_16x16x64_bf16 v[48:51], v[12:15], a[176:183], v3
  v_smfmac_f32_16x16x64_bf16 v[52:55], v[12:15], a[232:239], v3
  v_smfmac_f32_16x16x64_bf16 v[56:59], v[12:15], v[152:159], v3
  v_smfmac_f32_16x16x64_bf16 v[60:63], v[12:15], v[208:215], v3
  v_smfmac_f32_16x16x64_bf16 v[36:39], v[16:19], a[16:23], v3
  v_smfmac_f32_16x16x64_bf16 v[40:43], v[16:19], a[72:79], v3
  v_smfmac_f32_16x16x64_bf16 v[44:47], v[16:19], a[128:135], v3
  v_smfmac_f32_16x16x64_bf16 v[48:51], v[16:19], a[184:191], v3
  v_smfmac_f32_16x16x64_bf16 v[52:55], v[16:19], a[240:247], v3
  v_smfmac_f32_16x16x64_bf16 v[56:59], v[16:19], v[160:167], v3
  v_smfmac_f32_16x16x64_bf16 v[60:63], v[16:19], v[216:223], v3
  v_smfmac_f32_16x16x64_bf16 v[36:39], v[20:23], a[24:31], v3
  v_smfmac_f32_16x16x64_bf16 v[40:43], v[20:23], a[80:87], v3
  v_smfmac_f32_16x16x64_bf16 v[44:47], v[20:23], a[136:143], v3
  v_smfmac_f32_16x16x64_bf16 v[48:51], v[20:23], a[192:199], v3
  v_smfmac_f32_16x16x64_bf16 v[52:55], v[20:23], a[248:255], v3
  v_smfmac_f32_16x16x64_bf16 v[56:59], v[20:23], v[168:175], v3
  v_smfmac_f32_16x16x64_bf16 v[60:63], v[20:23], v[224:231], v3
  v_smfmac_f32_16x16x64_bf16 v[36:39], v[24:27], a[32:39], v3
  v_smfmac_f32_16x16x64_bf16 v[40:43], v[24:27], a[88:95], v3
  v_smfmac_f32_16x16x64_bf16 v[44:47], v[24:27], a[144:151], v3
  v_smfmac_f32_16x16x64_bf16 v[48:51], v[24:27], a[200:207], v3
  v_smfmac_f32_16x16x64_bf16 v[52:55], v[24:27], v[120:127], v3
  v_smfmac_f32_16x16x64_bf16 v[56:59], v[24:27], v[176:183], v3
  v_smfmac_f32_16x16x64_bf16 v[60:63], v[24:27], v[232:239], v3
  v_smfmac_f32_16x16x64_bf16 v[36:39], v[28:31], a[40:47], v3
  v_smfmac_f32_16x16x64_bf16 v[40:43], v[28:31], a[96:103], v3
  v_smfmac_f32_16x16x64_bf16 v[44:47], v[28:31], a[152:159], v3
  v_smfmac_f32_16x16x64_bf16 v[48:51], v[28:31], a[208:215], v3
  v_smfmac_f32_16x16x64_bf16 v[52:55], v[28:31], v[128:135], v3
  v_smfmac_f32_16x16x64_bf16 v[56:59], v[28:31], v[184:191], v3
  v_smfmac_f32_16x16x64_bf16 v[60:63], v[28:31], v[240:247], v3
  v_smfmac_f32_16x16x64_bf16 v[36:39], v[32:35], a[48:55], v3
  v_smfmac_f32_16x16x64_bf16 v[40:43], v[32:35], a[104:111], v3
  v_smfmac_f32_16x16x64_bf16 v[44:47], v[32:35], a[160:167], v3
  v_smfmac_f32_16x16x64_bf16 v[48:51], v[32:35], a[216:223], v3
  v_smfmac_f32_16x16x64_bf16 v[52:55], v[32:35], v[136:143], v3
  v_smfmac_f32_16x16x64_bf16 v[56:59], v[32:35], v[192:199], v3
  v_smfmac_f32_16x16x64_bf16 v[60:63], v[32:35], v[248:255], v3
  v_permlane32_swap_b32 v36, v38
  v_permlane32_swap_b32 v37, v39
  v_add_f32 v36, v36, v38
  v_add_f32 v37, v37, v39
  v_cvt_pk_bf16_f32 v38, v36, v37
  ds_write_b32 v104, v38
  v_permlane32_swap_b32 v40, v42
  v_permlane32_swap_b32 v41, v43
  v_add_f32 v40, v40, v42
  v_add_f32 v41, v41, v43
  v_cvt_pk_bf16_f32 v42, v40, v41
  ds_write_b32 v105, v42
  v_permlane32_swap_b32 v44, v46
  v_permlane32_swap_b32 v45, v47
  v_add_f32 v44, v44, v46
  v_add_f32 v45, v45, v47
  v_cvt_pk_bf16_f32 v46, v44, v45
  ds_write_b32 v106, v46
  v_permlane32_swap_b32 v48, v50
  v_permlane32_swap_b32 v49, v51
  v_add_f32 v48, v48, v50
  v_add_f32 v49, v49, v51
  v_cvt_pk_bf16_f32 v50, v48, v49
  ds_write_b32 v107, v50
  v_permlane32_swap_b32 v52, v54
  v_permlane32_swap_b32 v53, v55
  v_add_f32 v52, v52, v54
  v_add_f32 v53, v53, v55
  v_cvt_pk_bf16_f32 v54, v52, v53
  ds_write_b32 v108, v54
  v_permlane32_swap_b32 v56, v58
  v_permlane32_swap_b32 v57, v59
  v_add_f32 v56, v56, v58
  v_add_f32 v57, v57, v59
  v_cvt_pk_bf16_f32 v58, v56, v57
  ds_write_b32 v109, v58
  v_permlane32_swap_b32 v60, v62
  v_permlane32_swap_b32 v61, v63
  v_add_f32 v60, v60, v62
  v_add_f32 v61, v61, v63
  v_cvt_pk_bf16_f32 v62, v60, v61
  ds_write_b32 v110, v62
  s_branch cB_va3_t2d
cB_va3_f0:
  s_sleep 3
  s_branch cB_va3_f1
cB_va3_vor:
  s_sleep 2
  buffer_load_dword v101, off, s[8:11], s27 sc1
  s_add_u32 s30, s30, 1
  s_cmp_lt_u32 s30, 400000
  s_cbranch_scc1 cB_va3_vow
  s_branch cB_abort
cB_abort:
  v_mov_b32 v4, 0xdead
  v_mov_b32 v5, 16
  buffer_store_dword v4, v5, s[12:15], 0 offen
  s_branch ch_end
cB_done:
  s_branch ch_end
ch_worker:
  s_sub_u32 s35, s3, 4
  s_and_b32 s35, s35, 7
  s_lshr_b32 s36, s2, 3
  s_lshl_b32 s33, s35, 5
  s_add_u32 s33, s33, s36
  s_mov_b32 s97, 0
  s_mov_b32 s96, 0
  s_mov_b32 s37, 0
  s_mov_b32 s38, 0
  s_mov_b32 s39, 0xffff0000
  s_mov_b32 s101, -1
  v_and_b32 v1, 63, v0
  v_lshlrev_b32 v2, 4, v1
  v_lshrrev_b32 v3, 4, v1
  v_and_b32 v4, 15, v1
  s_cmp_ge_u32 s33, 224
  s_cbranch_scc1 wp_all
  s_mov_b32 s68, s44
  s_and_b32 s69, s45, 0xffff
  s_mov_b32 s70, 3670016
  s_mov_b32 s71, 0x20000
  s_and_b32 s20, s33, 0xe0
  s_mul_i32 s20, s20, 9363
  s_lshr_b32 s20, s20, 16
  s_lshl_b32 s20, s20, 10
  s_and_b32 s21, s33, 31
  s_mul_i32 s21, s21, 192
  s_add_u32 s20, s20, s21
  v_min_u32 v7, 191, v0
  v_add_u32 v7, s20, v7
  v_lshrrev_b32 v8, 11, v7
  v_min_u32 v8, 15, v8
  v_bfe_u32 v9, v7, 2, 9
  v_lshlrev_b32 v9, 13, v9
  v_lshl_add_u32 v9, v8, 9, v9
  v_and_b32 v7, 3, v7
  v_lshl_add_u32 v9, v7, 7, v9
  buffer_load_dword v253, v9, s[68:71], 0 offen
  s_mov_b32 s68, s40
  s_and_b32 s69, s41, 0xffff
  s_mov_b32 s70, 3670016
  s_mov_b32 s71, 0x20000
  s_and_b32 s20, s33, 0xe0
  s_mul_i32 s20, s20, 9363
  s_lshr_b32 s20, s20, 16
  s_lshl_b32 s20, s20, 10
  s_and_b32 s21, s33, 31
  s_mul_i32 s21, s21, 192
  s_add_u32 s20, s20, s21
  v_min_u32 v7, 191, v0
  v_add_u32 v7, s20, v7
  v_lshrrev_b32 v8, 11, v7
  v_min_u32 v8, 15, v8
  v_bfe_u32 v9, v7, 2, 9
  v_lshlrev_b32 v9, 13, v9
  v_lshl_add_u32 v9, v8, 9, v9
  v_and_b32 v7, 3, v7
  v_lshl_add_u32 v9, v7, 7, v9
  buffer_load_dword v253, v9, s[68:71], 0 offen
  v_lshrrev_b32 v5, 5, v1
  v_and_b32 v6, 31, v1
  v_xor_b32 v8, v6, v5
  v_lshlrev_b32 v8, 4, v8
  v_lshl_add_u32 v16, v5, 13, v8
  v_xor_b32 v17, 32, v16
  v_xor_b32 v18, 64, v16
  v_xor_b32 v19, 96, v16
  v_xor_b32 v20, 128, v16
  v_xor_b32 v21, 160, v16
  v_xor_b32 v22, 192, v16
  v_xor_b32 v23, 224, v16
  s_lshl_b32 s20, s16, 6
  v_xor_b32 v26, s20, v16
  v_xor_b32 v27, 32, v26
wp_B:
  s_mul_i32 s17, s33, 4682
  s_lshr_b32 s17, s17, 16
  s_mul_i32 s23, s17, 14
  s_sub_u32 s19, s33, s23
  s_cmp_lt_u32 s19, 7
  s_cselect_b32 s18, 0, 7
  s_cselect_b32 s28, 0, 8
  s_sub_u32 s18, s19, s18
  s_add_u32 s28, s28, s16
  s_lshl_b32 s25, s16, 15
  s_add_u32 s25, s25, 32768
  s_lshl_b32 s26, s17, 9
  s_lshl_b32 s20, s33, 2
  s_add_u32 s20, s20, s16
  s_mul_i32 s21, s20, 9363
  s_lshr_b32 s21, s21, 16
  s_mul_i32 s22, s21, 7
  s_sub_u32 s22, s20, s22
  s_mul_i32 s21, s21, 14336
  s_lshl_b32 s20, s22, 7
  s_add_u32 s20, s20, s21
  s_lshl_b32 s22, s22, 11
  s_add_u32 s52, s21, s22
  s_mov_b32 s68, s48
  s_and_b32 s69, s49, 0xffff
  s_mov_b32 s70, 1835008
  s_mov_b32 s71, 0x20000
  v_mul_u32_u24 v7, 896, v4
  v_lshl_add_u32 v7, v3, 5, v7
  buffer_load_dwordx4 v[128:131], v7, s[68:71], s20 offen
  buffer_load_dwordx4 v[132:135], v7, s[68:71], s20 offen offset:16
  s_mov_b32 s60, s44
  s_and_b32 s61, s45, 0xffff
  s_mov_b32 s62, 3670016
  s_mov_b32 s63, 0x20000
  s_mov_b32 s56, s46
  s_and_b32 s57, s47, 0xffff
  s_mov_b32 s58, 3670016
  s_mov_b32 s59, 0x20000
  s_mul_i32 s27, s17, 229376
  s_lshl_b32 s30, s18, 7
  s_add_u32 s27, s27, s30
  s_mul_i32 s30, s16, 57344
  s_add_u32 s27, s27, s30
  v_lshrrev_b32 v7, 3, v1
  v_and_b32 v8, 7, v1
  v_and_b32 v9, 2, v7
  v_xor_b32 v8, v8, v9
  v_mul_u32_u24 v7, 896, v7
  v_lshl_add_u32 v24, v8, 4, v7
  v_xor_b32 v25, 64, v24
  s_lshl_b32 s30, s16, 13
  s_add_u32 m0, s30, 0
  s_nop 0
  buffer_load_dwordx4 v24, s[56:59], s27 offen  lds
  s_add_u32 s27, s27, 7168
  s_add_u32 m0, s30, 1024
  s_nop 0
  buffer_load_dwordx4 v25, s[56:59], s27 offen  lds
  s_add_u32 s27, s27, 7168
  s_add_u32 m0, s30, 2048
  s_nop 0
  buffer_load_dwordx4 v24, s[56:59], s27 offen  lds
  s_add_u32 s27, s27, 7168
  s_add_u32 m0, s30, 3072
  s_nop 0
  buffer_load_dwordx4 v25, s[56:59], s27 offen  lds
  s_add_u32 s27, s27, 7168
  s_add_u32 m0, s30, 4096
  s_nop 0
  buffer_load_dwordx4 v24, s[56:59], s27 offen  lds
  s_add_u32 s27, s27, 7168
  s_add_u32 m0, s30, 5120
  s_nop 0
  buffer_load_dwordx4 v25, s[56:59], s27 offen  lds
  s_add_u32 s27, s27, 7168
  s_add_u32 m0, s30, 6144
  s_nop 0
  buffer_load_dwordx4 v24, s[56:59], s27 offen  lds
  s_add_u32 s27, s27, 7168
  s_add_u32 m0, s30, 7168
  s_nop 0
  buffer_load_dwordx4 v25, s[56:59], s27 offen  lds
  s_add_u32 s27, s27, 7168
  s_add_u32 s27, s28, 0
  s_min_u32 s27, s27, 13
  s_lshl_b32 s27, s27, 18
  s_add_u32 s27, s27, s26
  s_mov_b32 s55, s27
  v_lshrrev_b32 v7, 2, v4
  v_lshlrev_b32 v11, 4, v7
  v_lshlrev_b32 v7, 3, v7
  v_and_b32 v8, 3, v4
  v_add_u32 v7, v7, v8
  v_and_b32 v8, 2, v4
  v_lshl_add_u32 v11, v8, 1, v11
  v_and_b32 v8, 1, v4
  v_add_u32 v11, v11, v8
  v_or_b32 v10, 0, v3
  v_xor_b32 v10, v10, v4
  v_lshlrev_b32 v10, 4, v10
  v_lshl_add_u32 v44, v11, 9, v10
  v_lshl_add_u32 v10, v7, 9, v10
  v_add_u32 v32, s25, v10
  v_or_b32 v10, 4, v3
  v_xor_b32 v10, v10, v4
  v_lshlrev_b32 v10, 4, v10
  v_lshl_add_u32 v45, v11, 9, v10
  v_lshl_add_u32 v10, v7, 9, v10
  v_add_u32 v33, s25, v10
  v_or_b32 v10, 8, v3
  v_xor_b32 v10, v10, v4
  v_lshlrev_b32 v10, 4, v10
  v_lshl_add_u32 v46, v11, 9, v10
  v_lshl_add_u32 v10, v7, 9, v10
  v_add_u32 v34, s25, v10
  v_or_b32 v10, 12, v3
  v_xor_b32 v10, v10, v4
  v_lshlrev_b32 v10, 4, v10
  v_lshl_add_u32 v47, v11, 9, v10
  v_lshl_add_u32 v10, v7, 9, v10
  v_add_u32 v35, s25, v10
  s_mul_i32 s30, s17, 401408
  s_mul_i32 s31, s18, 57344
  s_add_u32 s30, s30, s31
  s_add_u32 s30, s30, 33554432
  v_add_u32 v28, s30, v2
  s_add_u32 s30, s30, 14336
  v_add_u32 v29, s30, v2
  s_add_u32 s30, s30, 14336
  v_add_u32 v30, s30, v2
  s_add_u32 s30, s30, 14336
  v_add_u32 v31, s30, v2
  s_add_u32 s30, s30, 14336
  v_mov_b32 v48, 1035512379
  v_lshrrev_b32 v7, 2, v4
  v_lshl_add_u32 v7, v3, 3, v7
  v_lshlrev_b32 v7, 7, v7
  v_and_b32 v8, 3, v4
  v_lshl_add_u32 v7, v8, 3, v7
  v_lshrrev_b32 v8, 3, v4
  v_and_b32 v9, 1, v3
  v_lshl_add_u32 v8, v9, 1, v8
  v_lshl_add_u32 v40, v8, 5, v7
  s_mul_i32 s31, s17, 28
  s_mov_b32 s29, 401408
  s_lshl_b32 s30, s18, 6
  s_add_u32 s30, s30, 0
  v_add_u32 v8, s30, v4
  v_subrev_u32 v9, 256, v8
  v_mul_u32_u24 v11, 171, v9
  v_lshrrev_b32 v11, 11, v11
  v_mul_u32_u24 v38, 12, v11
  v_sub_u32 v38, v9, v38
  v_add_u32 v38, 16, v38
  v_lshrrev_b32 v10, 4, v8
  v_cmp_gt_i32 vcc, 0, v9
  s_nop 1
  v_cndmask_b32 v10, v11, v10, vcc
  v_cndmask_b32 v39, v38, v4, vcc
  v_add_u32 v39, s31, v39
  v_lshrrev_b32 v38, 4, v39
  v_and_b32 v39, 15, v39
  v_mul_lo_u32 v10, v10, s29
  v_mul_u32_u24 v38, 14336, v38
  v_add_u32 v10, v10, v38
  v_lshl_add_u32 v10, v3, 8, v10
  v_lshl_add_u32 v10, v39, 4, v10
  v_add_u32 v12, 39976960, v10
  v_xor_b32 v41, 32, v40
  s_lshl_b32 s30, s18, 6
  s_add_u32 s30, s30, 16
  v_add_u32 v8, s30, v4
  v_subrev_u32 v9, 256, v8
  v_mul_u32_u24 v11, 171, v9
  v_lshrrev_b32 v11, 11, v11
  v_mul_u32_u24 v38, 12, v11
  v_sub_u32 v38, v9, v38
  v_add_u32 v38, 16, v38
  v_lshrrev_b32 v10, 4, v8
  v_cmp_gt_i32 vcc, 0, v9
  s_nop 1
  v_cndmask_b32 v10, v11, v10, vcc
  v_cndmask_b32 v39, v38, v4, vcc
  v_add_u32 v39, s31, v39
  v_lshrrev_b32 v38, 4, v39
  v_and_b32 v39, 15, v39
  v_mul_lo_u32 v10, v10, s29
  v_mul_u32_u24 v38, 14336, v38
  v_add_u32 v10, v10, v38
  v_lshl_add_u32 v10, v3, 8, v10
  v_lshl_add_u32 v10, v39, 4, v10
  v_add_u32 v13, 39976960, v10
  v_xor_b32 v42, 64, v40
  s_lshl_b32 s30, s18, 6
  s_add_u32 s30, s30, 32
  v_add_u32 v8, s30, v4
  v_subrev_u32 v9, 256, v8
  v_mul_u32_u24 v11, 171, v9
  v_lshrrev_b32 v11, 11, v11
  v_mul_u32_u24 v38, 12, v11
  v_sub_u32 v38, v9, v38
  v_add_u32 v38, 16, v38
  v_lshrrev_b32 v10, 4, v8
  v_cmp_gt_i32 vcc, 0, v9
  s_nop 1
  v_cndmask_b32 v10, v11, v10, vcc
  v_cndmask_b32 v39, v38, v4, vcc
  v_add_u32 v39, s31, v39
  v_lshrrev_b32 v38, 4, v39
  v_and_b32 v39, 15, v39
  v_mul_lo_u32 v10, v10, s29
  v_mul_u32_u24 v38, 14336, v38
  v_add_u32 v10, v10, v38
  v_lshl_add_u32 v10, v3, 8, v10
  v_lshl_add_u32 v10, v39, 4, v10
  v_add_u32 v14, 39976960, v10
  v_xor_b32 v43, 96, v40
  s_lshl_b32 s30, s18, 6
  s_add_u32 s30, s30, 48
  v_add_u32 v8, s30, v4
  v_subrev_u32 v9, 256, v8
  v_mul_u32_u24 v11, 171, v9
  v_lshrrev_b32 v11, 11, v11
  v_mul_u32_u24 v38, 12, v11
  v_sub_u32 v38, v9, v38
  v_add_u32 v38, 16, v38
  v_lshrrev_b32 v10, 4, v8
  v_cmp_gt_i32 vcc, 0, v9
  s_nop 1
  v_cndmask_b32 v10, v11, v10, vcc
  v_cndmask_b32 v39, v38, v4, vcc
  v_add_u32 v39, s31, v39
  v_lshrrev_b32 v38, 4, v39
  v_and_b32 v39, 15, v39
  v_mul_lo_u32 v10, v10, s29
  v_mul_u32_u24 v38, 14336, v38
  v_add_u32 v10, v10, v38
  v_lshl_add_u32 v10, v3, 8, v10
  v_lshl_add_u32 v10, v39, 4, v10
  v_add_u32 v15, 39976960, v10
  s_mov_b32 s27, s55
  s_add_u32 m0, s25, 0
  s_nop 0
  buffer_load_dwordx4 v16, s[60:63], s27 offen  lds
  s_add_u32 s27, s27, 16384
  s_add_u32 m0, s25, 1024
  s_nop 0
  buffer_load_dwordx4 v17, s[60:63], s27 offen  lds
  s_add_u32 s27, s27, 16384
  s_add_u32 m0, s25, 2048
  s_nop 0
  buffer_load_dwordx4 v16, s[60:63], s27 offen  lds
  s_add_u32 s27, s27, 16384
  s_add_u32 m0, s25, 3072
  s_nop 0
  buffer_load_dwordx4 v17, s[60:63], s27 offen  lds
  s_add_u32 s27, s27, 16384
  s_add_u32 m0, s25, 4096
  s_nop 0
  buffer_load_dwordx4 v18, s[60:63], s27 offen  lds
  s_add_u32 s27, s27, 16384
  s_add_u32 m0, s25, 5120
  s_nop 0
  buffer_load_dwordx4 v19, s[60:63], s27 offen  lds
  s_add_u32 s27, s27, 16384
  s_add_u32 m0, s25, 6144
  s_nop 0
  buffer_load_dwordx4 v18, s[60:63], s27 offen  lds
  s_add_u32 s27, s27, 16384
  s_add_u32 m0, s25, 7168
  s_nop 0
  buffer_load_dwordx4 v19, s[60:63], s27 offen  lds
  s_add_u32 s27, s27, 16384
  s_add_u32 m0, s25, 8192
  s_nop 0
  buffer_load_dwordx4 v20, s[60:63], s27 offen  lds
  s_add_u32 s27, s27, 16384
  s_add_u32 m0, s25, 9216
  s_nop 0
  buffer_load_dwordx4 v21, s[60:63], s27 offen  lds
  s_add_u32 s27, s27, 16384
  s_add_u32 m0, s25, 10240
  s_nop 0
  buffer_load_dwordx4 v20, s[60:63], s27 offen  lds
  s_add_u32 s27, s27, 16384
  s_add_u32 m0, s25, 11264
  s_nop 0
  buffer_load_dwordx4 v21, s[60:63], s27 offen  lds
  s_add_u32 s27, s27, 16384
  s_add_u32 m0, s25, 12288
  s_nop 0
  buffer_load_dwordx4 v22, s[60:63], s27 offen  lds
  s_add_u32 s27, s27, 16384
  s_add_u32 m0, s25, 13312
  s_nop 0
  buffer_load_dwordx4 v23, s[60:63], s27 offen  lds
  s_add_u32 s27, s27, 16384
  s_add_u32 m0, s25, 14336
  s_nop 0
  buffer_load_dwordx4 v22, s[60:63], s27 offen  lds
  s_add_u32 s27, s27, 16384
  s_add_u32 m0, s25, 15360
  s_nop 0
  buffer_load_dwordx4 v23, s[60:63], s27 offen  lds
  s_add_u32 s27, s27, 16384
  s_add_u32 s27, s28, 4
  s_min_u32 s27, s27, 13
  s_lshl_b32 s27, s27, 18
  s_add_u32 s27, s27, s26
  s_add_u32 m0, s25, 16384
  s_nop 0
  buffer_load_dwordx4 v16, s[60:63], s27 offen  lds
  s_add_u32 s27, s27, 16384
  s_add_u32 m0, s25, 17408
  s_nop 0
  buffer_load_dwordx4 v17, s[60:63], s27 offen  lds
  s_add_u32 s27, s27, 16384
  s_add_u32 m0, s25, 18432
  s_nop 0
  buffer_load_dwordx4 v16, s[60:63], s27 offen  lds
  s_add_u32 s27, s27, 16384
  s_add_u32 m0, s25, 19456
  s_nop 0
  buffer_load_dwordx4 v17, s[60:63], s27 offen  lds
  s_add_u32 s27, s27, 16384
  s_add_u32 m0, s25, 20480
  s_nop 0
  buffer_load_dwordx4 v18, s[60:63], s27 offen  lds
  s_add_u32 s27, s27, 16384
  s_add_u32 m0, s25, 21504
  s_nop 0
  buffer_load_dwordx4 v19, s[60:63], s27 offen  lds
  s_add_u32 s27, s27, 16384
  s_add_u32 m0, s25, 22528
  s_nop 0
  buffer_load_dwordx4 v18, s[60:63], s27 offen  lds
  s_add_u32 s27, s27, 16384
  s_add_u32 m0, s25, 23552
  s_nop 0
  buffer_load_dwordx4 v19, s[60:63], s27 offen  lds
  s_add_u32 s27, s27, 16384
  s_add_u32 m0, s25, 24576
  s_nop 0
  buffer_load_dwordx4 v20, s[60:63], s27 offen  lds
  s_add_u32 s27, s27, 16384
  s_add_u32 m0, s25, 25600
  s_nop 0
  buffer_load_dwordx4 v21, s[60:63], s27 offen  lds
  s_add_u32 s27, s27, 16384
  s_add_u32 m0, s25, 26624
  s_nop 0
  buffer_load_dwordx4 v20, s[60:63], s27 offen  lds
  s_add_u32 s27, s27, 16384
  s_add_u32 m0, s25, 27648
  s_nop 0
  buffer_load_dwordx4 v21, s[60:63], s27 offen  lds
  s_add_u32 s27, s27, 16384
  s_add_u32 m0, s25, 28672
  s_nop 0
  buffer_load_dwordx4 v22, s[60:63], s27 offen  lds
  s_add_u32 s27, s27, 16384
  s_add_u32 m0, s25, 29696
  s_nop 0
  buffer_load_dwordx4 v23, s[60:63], s27 offen  lds
  s_add_u32 s27, s27, 16384
  s_add_u32 m0, s25, 30720
  s_nop 0
  buffer_load_dwordx4 v22, s[60:63], s27 offen  lds
  s_add_u32 s27, s27, 16384
  s_add_u32 m0, s25, 31744
  s_nop 0
  buffer_load_dwordx4 v23, s[60:63], s27 offen  lds
  s_add_u32 s27, s27, 16384
  s_cmp_lt_u32 s18, 4
  s_cselect_b32 s34, 1, s97
  s_lshl_b32 s29, s28, 10
  s_add_u32 s31, s29, 4096
  s_cmp_lt_u32 s28, 10
  s_cselect_b32 s31, s31, 0x40000000
  s_waitcnt vmcnt(0)
  s_barrier
  ds_read_b64_tr_b16 a[0:1], v40 offset:0
  ds_read_b64_tr_b16 a[2:3], v40 offset:512
  ds_read_b64_tr_b16 a[32:33], v41 offset:0
  ds_read_b64_tr_b16 a[34:35], v41 offset:512
  ds_read_b64_tr_b16 a[64:65], v42 offset:0
  ds_read_b64_tr_b16 a[66:67], v42 offset:512
  ds_read_b64_tr_b16 a[96:97], v43 offset:0
  ds_read_b64_tr_b16 a[98:99], v43 offset:512
  ds_read_b128 a[128:131], v32 offset:0
  ds_read_b128 a[160:163], v32 offset:2048
  ds_read_b128 a[192:195], v32 offset:16384
  ds_read_b128 a[224:227], v32 offset:18432
  v_lshlrev_b32 v144, 9, v3
  v_lshl_add_u32 v144, v4, 4, v144
  s_add_u32 s53, s52, 75759616
  s_add_u32 s52, s52, 655360
  v_mov_b32 v136, v128
  v_mov_b32 v140, v129
  v_mov_b32 v137, v130
  v_mov_b32 v141, v131
  v_mov_b32 v138, v132
  v_mov_b32 v142, v133
  v_mov_b32 v139, v134
  v_mov_b32 v143, v135
  buffer_store_dwordx4 v[128:131], v144, s[8:11], s52 offen sc1
  buffer_store_dwordx4 v[132:135], v144, s[8:11], s52 offen offset:256 sc1
  buffer_store_dwordx4 v[136:139], v2, s[8:11], s53 offen sc1
  buffer_store_dwordx4 v[140:143], v2, s[8:11], s53 offen offset:1024 sc1
  s_waitcnt lgkmcnt(0)
  v_mfma_f32_16x16x32_bf16 v[64:67], a[128:131], a[0:3], 0
  ds_read_b64_tr_b16 a[4:5], v40 offset:4096
  ds_read_b64_tr_b16 a[6:7], v40 offset:4608
  v_mfma_f32_16x16x32_bf16 v[68:71], a[160:163], a[0:3], 0
  ds_read_b64_tr_b16 a[36:37], v41 offset:4096
  ds_read_b64_tr_b16 a[38:39], v41 offset:4608
  v_mfma_f32_16x16x32_bf16 v[72:75], a[128:131], a[32:35], 0
  ds_read_b64_tr_b16 a[68:69], v42 offset:4096
  ds_read_b64_tr_b16 a[70:71], v42 offset:4608
  v_mfma_f32_16x16x32_bf16 v[76:79], a[160:163], a[32:35], 0
  ds_read_b64_tr_b16 a[100:101], v43 offset:4096
  ds_read_b64_tr_b16 a[102:103], v43 offset:4608
  v_mfma_f32_16x16x32_bf16 v[80:83], a[128:131], a[64:67], 0
  ds_read_b128 a[132:135], v33 offset:0
  ds_read_b128 a[164:167], v33 offset:2048
  v_mfma_f32_16x16x32_bf16 v[84:87], a[160:163], a[64:67], 0
  ds_read_b128 a[196:199], v33 offset:16384
  ds_read_b128 a[228:231], v33 offset:18432
  v_mfma_f32_16x16x32_bf16 v[88:91], a[128:131], a[96:99], 0
  v_mfma_f32_16x16x32_bf16 v[92:95], a[160:163], a[96:99], 0
  v_mfma_f32_16x16x32_bf16 v[96:99], a[192:195], a[0:3], 0
  v_mfma_f32_16x16x32_bf16 v[100:103], a[224:227], a[0:3], 0
  v_mfma_f32_16x16x32_bf16 v[104:107], a[192:195], a[32:35], 0
  v_mfma_f32_16x16x32_bf16 v[108:111], a[224:227], a[32:35], 0
  v_mfma_f32_16x16x32_bf16 v[112:115], a[192:195], a[64:67], 0
  v_mfma_f32_16x16x32_bf16 v[116:119], a[224:227], a[64:67], 0
  v_mfma_f32_16x16x32_bf16 v[120:123], a[192:195], a[96:99], 0
  v_mfma_f32_16x16x32_bf16 v[124:127], a[224:227], a[96:99], 0
  s_waitcnt lgkmcnt(0)
  v_mfma_f32_16x16x32_bf16 v[64:67], a[132:135], a[4:7], v[64:67]
  ds_read_b64_tr_b16 a[8:9], v40 offset:8192
  ds_read_b64_tr_b16 a[10:11], v40 offset:8704
  v_mfma_f32_16x16x32_bf16 v[68:71], a[164:167], a[4:7], v[68:71]
  ds_read_b64_tr_b16 a[40:41], v41 offset:8192
  ds_read_b64_tr_b16 a[42:43], v41 offset:8704
  v_mfma_f32_16x16x32_bf16 v[72:75], a[132:135], a[36:39], v[72:75]
  ds_read_b64_tr_b16 a[72:73], v42 offset:8192
  ds_read_b64_tr_b16 a[74:75], v42 offset:8704
  v_mfma_f32_16x16x32_bf16 v[76:79], a[164:167], a[36:39], v[76:79]
  ds_read_b64_tr_b16 a[104:105], v43 offset:8192
  ds_read_b64_tr_b16 a[106:107], v43 offset:8704
  v_mfma_f32_16x16x32_bf16 v[80:83], a[132:135], a[68:71], v[80:83]
  ds_read_b128 a[136:139], v34 offset:0
  ds_read_b128 a[168:171], v34 offset:2048
  v_mfma_f32_16x16x32_bf16 v[84:87], a[164:167], a[68:71], v[84:87]
  ds_read_b128 a[200:203], v34 offset:16384
  ds_read_b128 a[232:235], v34 offset:18432
  v_mfma_f32_16x16x32_bf16 v[88:91], a[132:135], a[100:103], v[88:91]
  v_mfma_f32_16x16x32_bf16 v[92:95], a[164:167], a[100:103], v[92:95]
  v_mfma_f32_16x16x32_bf16 v[96:99], a[196:199], a[4:7], v[96:99]
  v_mfma_f32_16x16x32_bf16 v[100:103], a[228:231], a[4:7], v[100:103]
  v_mfma_f32_16x16x32_bf16 v[104:107], a[196:199], a[36:39], v[104:107]
  v_mfma_f32_16x16x32_bf16 v[108:111], a[228:231], a[36:39], v[108:111]
  v_mfma_f32_16x16x32_bf16 v[112:115], a[196:199], a[68:71], v[112:115]
  v_mfma_f32_16x16x32_bf16 v[116:119], a[228:231], a[68:71], v[116:119]
  v_mfma_f32_16x16x32_bf16 v[120:123], a[196:199], a[100:103], v[120:123]
  v_mfma_f32_16x16x32_bf16 v[124:127], a[228:231], a[100:103], v[124:127]
  s_waitcnt lgkmcnt(0)
  v_mfma_f32_16x16x32_bf16 v[64:67], a[136:139], a[8:11], v[64:67]
  ds_read_b64_tr_b16 a[12:13], v40 offset:12288
  ds_read_b64_tr_b16 a[14:15], v40 offset:12800
  v_mfma_f32_16x16x32_bf16 v[68:71], a[168:171], a[8:11], v[68:71]
  ds_read_b64_tr_b16 a[44:45], v41 offset:12288
  ds_read_b64_tr_b16 a[46:47], v41 offset:12800
  v_mfma_f32_16x16x32_bf16 v[72:75], a[136:139], a[40:43], v[72:75]
  ds_read_b64_tr_b16 a[76:77], v42 offset:12288
  ds_read_b64_tr_b16 a[78:79], v42 offset:12800
  v_mfma_f32_16x16x32_bf16 v[76:79], a[168:171], a[40:43], v[76:79]
  ds_read_b64_tr_b16 a[108:109], v43 offset:12288
  ds_read_b64_tr_b16 a[110:111], v43 offset:12800
  v_mfma_f32_16x16x32_bf16 v[80:83], a[136:139], a[72:75], v[80:83]
  ds_read_b128 a[140:143], v35 offset:0
  ds_read_b128 a[172:175], v35 offset:2048
  v_mfma_f32_16x16x32_bf16 v[84:87], a[168:171], a[72:75], v[84:87]
  ds_read_b128 a[204:207], v35 offset:16384
  ds_read_b128 a[236:239], v35 offset:18432
  v_mfma_f32_16x16x32_bf16 v[88:91], a[136:139], a[104:107], v[88:91]
  v_mfma_f32_16x16x32_bf16 v[92:95], a[168:171], a[104:107], v[92:95]
  v_mfma_f32_16x16x32_bf16 v[96:99], a[200:203], a[8:11], v[96:99]
  v_mfma_f32_16x16x32_bf16 v[100:103], a[232:235], a[8:11], v[100:103]
  v_mfma_f32_16x16x32_bf16 v[104:107], a[200:203], a[40:43], v[104:107]
  v_mfma_f32_16x16x32_bf16 v[108:111], a[232:235], a[40:43], v[108:111]
  v_mfma_f32_16x16x32_bf16 v[112:115], a[200:203], a[72:75], v[112:115]
  v_mfma_f32_16x16x32_bf16 v[116:119], a[232:235], a[72:75], v[116:119]
  v_mfma_f32_16x16x32_bf16 v[120:123], a[200:203], a[104:107], v[120:123]
  v_mfma_f32_16x16x32_bf16 v[124:127], a[232:235], a[104:107], v[124:127]
  s_waitcnt lgkmcnt(0)
  v_mfma_f32_16x16x32_bf16 v[64:67], a[140:143], a[12:15], v[64:67]
  ds_read_b64_tr_b16 a[16:17], v40 offset:16384
  ds_read_b64_tr_b16 a[18:19], v40 offset:16896
  v_mfma_f32_16x16x32_bf16 v[68:71], a[172:175], a[12:15], v[68:71]
  ds_read_b64_tr_b16 a[48:49], v41 offset:16384
  ds_read_b64_tr_b16 a[50:51], v41 offset:16896
  v_mfma_f32_16x16x32_bf16 v[72:75], a[140:143], a[44:47], v[72:75]
  ds_read_b64_tr_b16 a[80:81], v42 offset:16384
  ds_read_b64_tr_b16 a[82:83], v42 offset:16896
  v_mfma_f32_16x16x32_bf16 v[76:79], a[172:175], a[44:47], v[76:79]
  ds_read_b64_tr_b16 a[112:113], v43 offset:16384
  ds_read_b64_tr_b16 a[114:115], v43 offset:16896
  v_mfma_f32_16x16x32_bf16 v[80:83], a[140:143], a[76:79], v[80:83]
  ds_read_b128 a[144:147], v32 offset:256
  ds_read_b128 a[176:179], v32 offset:2304
  v_mfma_f32_16x16x32_bf16 v[84:87], a[172:175], a[76:79], v[84:87]
  ds_read_b128 a[208:211], v32 offset:16640
  ds_read_b128 a[240:243], v32 offset:18688
  v_mfma_f32_16x16x32_bf16 v[88:91], a[140:143], a[108:111], v[88:91]
  v_mfma_f32_16x16x32_bf16 v[92:95], a[172:175], a[108:111], v[92:95]
  v_mfma_f32_16x16x32_bf16 v[96:99], a[204:207], a[12:15], v[96:99]
  v_mfma_f32_16x16x32_bf16 v[100:103], a[236:239], a[12:15], v[100:103]
  v_mfma_f32_16x16x32_bf16 v[104:107], a[204:207], a[44:47], v[104:107]
  v_mfma_f32_16x16x32_bf16 v[108:111], a[236:239], a[44:47], v[108:111]
  v_mfma_f32_16x16x32_bf16 v[112:115], a[204:207], a[76:79], v[112:115]
  v_mfma_f32_16x16x32_bf16 v[116:119], a[236:239], a[76:79], v[116:119]
  v_mfma_f32_16x16x32_bf16 v[120:123], a[204:207], a[108:111], v[120:123]
  v_mfma_f32_16x16x32_bf16 v[124:127], a[236:239], a[108:111], v[124:127]
  s_waitcnt lgkmcnt(0)
  v_mfma_f32_16x16x32_bf16 v[64:67], a[144:147], a[16:19], v[64:67]
  ds_read_b64_tr_b16 a[20:21], v40 offset:20480
  ds_read_b64_tr_b16 a[22:23], v40 offset:20992
  v_mfma_f32_16x16x32_bf16 v[68:71], a[176:179], a[16:19], v[68:71]
  ds_read_b64_tr_b16 a[52:53], v41 offset:20480
  ds_read_b64_tr_b16 a[54:55], v41 offset:20992
  v_mfma_f32_16x16x32_bf16 v[72:75], a[144:147], a[48:51], v[72:75]
  ds_read_b64_tr_b16 a[84:85], v42 offset:20480
  ds_read_b64_tr_b16 a[86:87], v42 offset:20992
  v_mfma_f32_16x16x32_bf16 v[76:79], a[176:179], a[48:51], v[76:79]
  ds_read_b64_tr_b16 a[116:117], v43 offset:20480
  ds_read_b64_tr_b16 a[118:119], v43 offset:20992
  v_mfma_f32_16x16x32_bf16 v[80:83], a[144:147], a[80:83], v[80:83]
  ds_read_b128 a[148:151], v33 offset:256
  ds_read_b128 a[180:183], v33 offset:2304
  v_mfma_f32_16x16x32_bf16 v[84:87], a[176:179], a[80:83], v[84:87]
  ds_read_b128 a[212:215], v33 offset:16640
  ds_read_b128 a[244:247], v33 offset:18688
  v_mfma_f32_16x16x32_bf16 v[88:91], a[144:147], a[112:115], v[88:91]
  v_mfma_f32_16x16x32_bf16 v[92:95], a[176:179], a[112:115], v[92:95]
  v_mfma_f32_16x16x32_bf16 v[96:99], a[208:211], a[16:19], v[96:99]
  v_mfma_f32_16x16x32_bf16 v[100:103], a[240:243], a[16:19], v[100:103]
  v_mfma_f32_16x16x32_bf16 v[104:107], a[208:211], a[48:51], v[104:107]
  v_mfma_f32_16x16x32_bf16 v[108:111], a[240:243], a[48:51], v[108:111]
  v_mfma_f32_16x16x32_bf16 v[112:115], a[208:211], a[80:83], v[112:115]
  v_mfma_f32_16x16x32_bf16 v[116:119], a[240:243], a[80:83], v[116:119]
  v_mfma_f32_16x16x32_bf16 v[120:123], a[208:211], a[112:115], v[120:123]
  v_mfma_f32_16x16x32_bf16 v[124:127], a[240:243], a[112:115], v[124:127]
  s_waitcnt lgkmcnt(0)
  v_mfma_f32_16x16x32_bf16 v[64:67], a[148:151], a[20:23], v[64:67]
  ds_read_b64_tr_b16 a[24:25], v40 offset:24576
  ds_read_b64_tr_b16 a[26:27], v40 offset:25088
  v_mfma_f32_16x16x32_bf16 v[68:71], a[180:183], a[20:23], v[68:71]
  ds_read_b64_tr_b16 a[56:57], v41 offset:24576
  ds_read_b64_tr_b16 a[58:59], v41 offset:25088
  v_mfma_f32_16x16x32_bf16 v[72:75], a[148:151], a[52:55], v[72:75]
  ds_read_b64_tr_b16 a[88:89], v42 offset:24576
  ds_read_b64_tr_b16 a[90:91], v42 offset:25088
  v_mfma_f32_16x16x32_bf16 v[76:79], a[180:183], a[52:55], v[76:79]
  ds_read_b64_tr_b16 a[120:121], v43 offset:24576
  ds_read_b64_tr_b16 a[122:123], v43 offset:25088
  v_mfma_f32_16x16x32_bf16 v[80:83], a[148:151], a[84:87], v[80:83]
  ds_read_b128 a[152:155], v34 offset:256
  ds_read_b128 a[184:187], v34 offset:2304
  v_mfma_f32_16x16x32_bf16 v[84:87], a[180:183], a[84:87], v[84:87]
  ds_read_b128 a[216:219], v34 offset:16640
  ds_read_b128 a[248:251], v34 offset:18688
  v_mfma_f32_16x16x32_bf16 v[88:91], a[148:151], a[116:119], v[88:91]
  v_mfma_f32_16x16x32_bf16 v[92:95], a[180:183], a[116:119], v[92:95]
  v_mfma_f32_16x16x32_bf16 v[96:99], a[212:215], a[20:23], v[96:99]
  v_mfma_f32_16x16x32_bf16 v[100:103], a[244:247], a[20:23], v[100:103]
  v_mfma_f32_16x16x32_bf16 v[104:107], a[212:215], a[52:55], v[104:107]
  v_mfma_f32_16x16x32_bf16 v[108:111], a[244:247], a[52:55], v[108:111]
  v_mfma_f32_16x16x32_bf16 v[112:115], a[212:215], a[84:87], v[112:115]
  v_mfma_f32_16x16x32_bf16 v[116:119], a[244:247], a[84:87], v[116:119]
  v_mfma_f32_16x16x32_bf16 v[120:123], a[212:215], a[116:119], v[120:123]
  v_mfma_f32_16x16x32_bf16 v[124:127], a[244:247], a[116:119], v[124:127]
  s_waitcnt lgkmcnt(0)
  v_mfma_f32_16x16x32_bf16 v[64:67], a[152:155], a[24:27], v[64:67]
  ds_read_b64_tr_b16 a[28:29], v40 offset:28672
  ds_read_b64_tr_b16 a[30:31], v40 offset:29184
  v_mfma_f32_16x16x32_bf16 v[68:71], a[184:187], a[24:27], v[68:71]
  ds_read_b64_tr_b16 a[60:61], v41 offset:28672
  ds_read_b64_tr_b16 a[62:63], v41 offset:29184
  v_mfma_f32_16x16x32_bf16 v[72:75], a[152:155], a[56:59], v[72:75]
  ds_read_b64_tr_b16 a[92:93], v42 offset:28672
  ds_read_b64_tr_b16 a[94:95], v42 offset:29184
  v_mfma_f32_16x16x32_bf16 v[76:79], a[184:187], a[56:59], v[76:79]
  ds_read_b64_tr_b16 a[124:125], v43 offset:28672
  ds_read_b64_tr_b16 a[126:127], v43 offset:29184
  v_mfma_f32_16x16x32_bf16 v[80:83], a[152:155], a[88:91], v[80:83]
  ds_read_b128 a[156:159], v35 offset:256
  ds_read_b128 a[188:191], v35 offset:2304
  v_mfma_f32_16x16x32_bf16 v[84:87], a[184:187], a[88:91], v[84:87]
  ds_read_b128 a[220:223], v35 offset:16640
  ds_read_b128 a[252:255], v35 offset:18688
  v_mfma_f32_16x16x32_bf16 v[88:91], a[152:155], a[120:123], v[88:91]
  v_mfma_f32_16x16x32_bf16 v[92:95], a[184:187], a[120:123], v[92:95]
  v_mfma_f32_16x16x32_bf16 v[96:99], a[216:219], a[24:27], v[96:99]
  v_mfma_f32_16x16x32_bf16 v[100:103], a[248:251], a[24:27], v[100:103]
  v_mfma_f32_16x16x32_bf16 v[104:107], a[216:219], a[56:59], v[104:107]
  v_mfma_f32_16x16x32_bf16 v[108:111], a[248:251], a[56:59], v[108:111]
  v_mfma_f32_16x16x32_bf16 v[112:115], a[216:219], a[88:91], v[112:115]
  v_mfma_f32_16x16x32_bf16 v[116:119], a[248:251], a[88:91], v[116:119]
  v_mfma_f32_16x16x32_bf16 v[120:123], a[216:219], a[120:123], v[120:123]
  v_mfma_f32_16x16x32_bf16 v[124:127], a[248:251], a[120:123], v[124:127]
  s_waitcnt lgkmcnt(0)
  s_barrier
  buffer_load_dwordx2 v[254:255], v252, s[12:15], 0 offen offset:128 sc1
  buffer_load_dword v253, v252, s[12:15], 0 offen sc1
  v_mfma_f32_16x16x32_bf16 v[64:67], a[156:159], a[28:31], v[64:67]
  v_mfma_f32_16x16x32_bf16 v[68:71], a[188:191], a[28:31], v[68:71]
  v_mfma_f32_16x16x32_bf16 v[72:75], a[156:159], a[60:63], v[72:75]
  v_mfma_f32_16x16x32_bf16 v[76:79], a[188:191], a[60:63], v[76:79]
  v_mfma_f32_16x16x32_bf16 v[80:83], a[156:159], a[92:95], v[80:83]
  v_cvt_pk_bf16_f32 v64, v64, v65
  v_cvt_pk_bf16_f32 v65, v66, v67
  v_mfma_f32_16x16x32_bf16 v[84:87], a[188:191], a[92:95], v[84:87]
  v_cvt_pk_bf16_f32 v66, v68, v69
  v_cvt_pk_bf16_f32 v67, v70, v71
  v_mfma_f32_16x16x32_bf16 v[88:91], a[156:159], a[124:127], v[88:91]
  buffer_store_dwordx4 v[64:67], v12, s[8:11], s29 offen sc1
  v_cvt_pk_bf16_f32 v72, v72, v73
  v_mfma_f32_16x16x32_bf16 v[92:95], a[188:191], a[124:127], v[92:95]
  v_cvt_pk_bf16_f32 v73, v74, v75
  v_cvt_pk_bf16_f32 v74, v76, v77
  v_mfma_f32_16x16x32_bf16 v[96:99], a[220:223], a[28:31], v[96:99]
  v_cvt_pk_bf16_f32 v75, v78, v79
  buffer_store_dwordx4 v[72:75], v13, s[8:11], s29 offen sc1
  v_mfma_f32_16x16x32_bf16 v[100:103], a[252:255], a[28:31], v[100:103]
  v_cvt_pk_bf16_f32 v80, v80, v81
  v_cvt_pk_bf16_f32 v81, v82, v83
  v_mfma_f32_16x16x32_bf16 v[104:107], a[220:223], a[60:63], v[104:107]
  v_cvt_pk_bf16_f32 v82, v84, v85
  v_cvt_pk_bf16_f32 v83, v86, v87
  v_mfma_f32_16x16x32_bf16 v[108:111], a[252:255], a[60:63], v[108:111]
  buffer_store_dwordx4 v[80:83], v14, s[8:11], s29 offen sc1
  v_cvt_pk_bf16_f32 v88, v88, v89
  v_mfma_f32_16x16x32_bf16 v[112:115], a[220:223], a[92:95], v[112:115]
  v_cvt_pk_bf16_f32 v89, v90, v91
  v_cvt_pk_bf16_f32 v90, v92, v93
  v_mfma_f32_16x16x32_bf16 v[116:119], a[252:255], a[92:95], v[116:119]
  v_cvt_pk_bf16_f32 v91, v94, v95
  buffer_store_dwordx4 v[88:91], v15, s[8:11], s29 offen sc1
  v_mfma_f32_16x16x32_bf16 v[120:123], a[220:223], a[124:127], v[120:123]
  v_cvt_pk_bf16_f32 v96, v96, v97
  v_cvt_pk_bf16_f32 v97, v98, v99
  v_mfma_f32_16x16x32_bf16 v[124:127], a[252:255], a[124:127], v[124:127]
  v_cvt_pk_bf16_f32 v98, v100, v101
  v_cvt_pk_bf16_f32 v99, v102, v103
  buffer_store_dwordx4 v[96:99], v12, s[8:11], s31 offen sc1
  v_cvt_pk_bf16_f32 v104, v104, v105
  v_cvt_pk_bf16_f32 v105, v106, v107
  v_cvt_pk_bf16_f32 v106, v108, v109
  v_cvt_pk_bf16_f32 v107, v110, v111
  buffer_store_dwordx4 v[104:107], v13, s[8:11], s31 offen sc1
  v_cvt_pk_bf16_f32 v112, v112, v113
  v_cvt_pk_bf16_f32 v113, v114, v115
  v_cvt_pk_bf16_f32 v114, v116, v117
  v_cvt_pk_bf16_f32 v115, v118, v119
  buffer_store_dwordx4 v[112:115], v14, s[8:11], s31 offen sc1
  v_cvt_pk_bf16_f32 v120, v120, v121
  v_cvt_pk_bf16_f32 v121, v122, v123
  v_cvt_pk_bf16_f32 v122, v124, v125
  v_cvt_pk_bf16_f32 v123, v126, v127
  buffer_store_dwordx4 v[120:123], v15, s[8:11], s31 offen sc1
  s_cmp_lg_u32 s34, 0
  s_cbranch_scc1 wp_B2
  s_mov_b32 s60, s40
  s_and_b32 s61, s41, 0xffff
  s_mov_b32 s62, 3670016
  s_mov_b32 s63, 0x20000
  s_mov_b32 s56, s42
  s_and_b32 s57, s43, 0xffff
  s_mov_b32 s58, 3670016
  s_mov_b32 s59, 0x20000
  s_lshl_b32 s27, s18, 2
  s_add_u32 s27, s27, s16
  s_lshl_b32 s27, s27, 17
  s_add_u32 s27, s27, s26
  s_lshl_b32 s30, s16, 13
  s_add_u32 m0, s30, 0
  s_nop 0
  buffer_load_dwordx4 v26, s[56:59], s27 offen  lds
  s_add_u32 s27, s27, 16384
  s_add_u32 m0, s30, 1024
  s_nop 0
  buffer_load_dwordx4 v26, s[56:59], s27 offen  lds
  s_add_u32 s27, s27, 16384
  s_add_u32 m0, s30, 2048
  s_nop 0
  buffer_load_dwordx4 v27, s[56:59], s27 offen  lds
  s_add_u32 s27, s27, 16384
  s_add_u32 m0, s30, 3072
  s_nop 0
  buffer_load_dwordx4 v27, s[56:59], s27 offen  lds
  s_add_u32 s27, s27, 16384
  s_add_u32 m0, s30, 4096
  s_nop 0
  buffer_load_dwordx4 v26, s[56:59], s27 offen  lds
  s_add_u32 s27, s27, 16384
  s_add_u32 m0, s30, 5120
  s_nop 0
  buffer_load_dwordx4 v26, s[56:59], s27 offen  lds
  s_add_u32 s27, s27, 16384
  s_add_u32 m0, s30, 6144
  s_nop 0
  buffer_load_dwordx4 v27, s[56:59], s27 offen  lds
  s_add_u32 s27, s27, 16384
  s_add_u32 m0, s30, 7168
  s_nop 0
  buffer_load_dwordx4 v27, s[56:59], s27 offen  lds
  s_add_u32 s27, s27, 16384
  s_add_u32 s27, s28, 0
  s_min_u32 s27, s27, 13
  s_lshl_b32 s27, s27, 18
  s_add_u32 s27, s27, s26
  s_add_u32 m0, s25, 0
  s_nop 0
  buffer_load_dwordx4 v16, s[60:63], s27 offen  lds
  s_add_u32 s27, s27, 16384
  s_add_u32 m0, s25, 1024
  s_nop 0
  buffer_load_dwordx4 v17, s[60:63], s27 offen  lds
  s_add_u32 s27, s27, 16384
  s_add_u32 m0, s25, 2048
  s_nop 0
  buffer_load_dwordx4 v16, s[60:63], s27 offen  lds
  s_add_u32 s27, s27, 16384
  s_add_u32 m0, s25, 3072
  s_nop 0
  buffer_load_dwordx4 v17, s[60:63], s27 offen  lds
  s_add_u32 s27, s27, 16384
  s_waitcnt vmcnt(12)
  s_barrier
  s_cmp_lg_u32 s16, 0
  s_cbranch_scc1 wp_f1_f
  v_readfirstlane_b32 s20, v254
  s_cmp_eq_u32 s20, 1
  s_cbranch_scc1 wp_f1_w_ok
  s_mov_b32 s30, 0
wp_f1_w:
  buffer_load_dword v254, off, s[12:15], 0 offset:128 sc1
  s_waitcnt vmcnt(0)
  v_cmp_ne_u32 vcc, 1, v254
  s_cbranch_vccz wp_f1_w_ok
  s_sleep 8
  s_add_u32 s30, s30, 1
  s_cmp_lt_u32 s30, 16
  s_cbranch_scc1 wp_f1_w
  s_branch wp_f1_f
wp_f1_w_ok:
  s_lshl_b32 s20, s17, 7
  s_add_u32 s20, s20, 582144
  s_lshl_b32 s21, 1, s19
  v_mov_b32 v248, s21
  s_mov_b64 exec, 1
  buffer_atomic_or v248, v252, s[8:11], s20 offen sc0
  s_mov_b64 exec, -1
  s_mov_b32 s37, s21
wp_f1_f:
  s_add_u32 m0, s25, 4096
  s_nop 0
  buffer_load_dwordx4 v18, s[60:63], s27 offen  lds
  s_add_u32 s27, s27, 16384
  s_add_u32 m0, s25, 5120
  s_nop 0
  buffer_load_dwordx4 v19, s[60:63], s27 offen  lds
  s_add_u32 s27, s27, 16384
  s_add_u32 m0, s25, 6144
  s_nop 0
  buffer_load_dwordx4 v18, s[60:63], s27 offen  lds
  s_add_u32 s27, s27, 16384
  s_add_u32 m0, s25, 7168
  s_nop 0
  buffer_load_dwordx4 v19, s[60:63], s27 offen  lds
  s_add_u32 s27, s27, 16384
  s_add_u32 m0, s25, 8192
  s_nop 0
  buffer_load_dwordx4 v20, s[60:63], s27 offen  lds
  s_add_u32 s27, s27, 16384
  s_add_u32 m0, s25, 9216
  s_nop 0
  buffer_load_dwordx4 v21, s[60:63], s27 offen  lds
  s_add_u32 s27, s27, 16384
  s_add_u32 m0, s25, 10240
  s_nop 0
  buffer_load_dwordx4 v20, s[60:63], s27 offen  lds
  s_add_u32 s27, s27, 16384
  s_add_u32 m0, s25, 11264
  s_nop 0
  buffer_load_dwordx4 v21, s[60:63], s27 offen  lds
  s_add_u32 s27, s27, 16384
  s_add_u32 m0, s25, 12288
  s_nop 0
  buffer_load_dwordx4 v22, s[60:63], s27 offen  lds
  s_add_u32 s27, s27, 16384
  s_add_u32 m0, s25, 13312
  s_nop 0
  buffer_load_dwordx4 v23, s[60:63], s27 offen  lds
  s_add_u32 s27, s27, 16384
  s_add_u32 m0, s25, 14336
  s_nop 0
  buffer_load_dwordx4 v22, s[60:63], s27 offen  lds
  s_add_u32 s27, s27, 16384
  s_add_u32 m0, s25, 15360
  s_nop 0
  buffer_load_dwordx4 v23, s[60:63], s27 offen  lds
  s_add_u32 s27, s27, 16384
  s_add_u32 s27, s28, 4
  s_min_u32 s27, s27, 13
  s_lshl_b32 s27, s27, 18
  s_add_u32 s27, s27, s26
  s_waitcnt vmcnt(12)
  v_readfirstlane_b32 s20, v248
  s_and_b32 s20, s20, 16383
  s_xor_b32 s20, s20, s37
  s_cmp_lg_u32 s20, 16383
  s_cselect_b32 s20, 0, s37
  s_mov_b32 s37, 0
  s_cmp_eq_u32 s20, 0
  s_cbranch_scc1 wp_g1
  s_lshl_b32 s21, 1, s17
  v_mov_b32 v248, s21
  s_mov_b32 s20, 586240
  v_lshlrev_b32 v247, 7, v0
  s_mov_b64 exec, 0xff
  buffer_atomic_or v248, v247, s[8:11], s20 offen
  s_mov_b64 exec, -1
wp_g1:
  s_add_u32 m0, s25, 16384
  s_nop 0
  buffer_load_dwordx4 v16, s[60:63], s27 offen  lds
  s_add_u32 s27, s27, 16384
  s_add_u32 m0, s25, 17408
  s_nop 0
  buffer_load_dwordx4 v17, s[60:63], s27 offen  lds
  s_add_u32 s27, s27, 16384
  s_add_u32 m0, s25, 18432
  s_nop 0
  buffer_load_dwordx4 v16, s[60:63], s27 offen  lds
  s_add_u32 s27, s27, 16384
  s_add_u32 m0, s25, 19456
  s_nop 0
  buffer_load_dwordx4 v17, s[60:63], s27 offen  lds
  s_add_u32 s27, s27, 16384
  s_add_u32 m0, s25, 20480
  s_nop 0
  buffer_load_dwordx4 v18, s[60:63], s27 offen  lds
  s_add_u32 s27, s27, 16384
  s_add_u32 m0, s25, 21504
  s_nop 0
  buffer_load_dwordx4 v19, s[60:63], s27 offen  lds
  s_add_u32 s27, s27, 16384
  s_add_u32 m0, s25, 22528
  s_nop 0
  buffer_load_dwordx4 v18, s[60:63], s27 offen  lds
  s_add_u32 s27, s27, 16384
  s_add_u32 m0, s25, 23552
  s_nop 0
  buffer_load_dwordx4 v19, s[60:63], s27 offen  lds
  s_add_u32 s27, s27, 16384
  s_add_u32 m0, s25, 24576
  s_nop 0
  buffer_load_dwordx4 v20, s[60:63], s27 offen  lds
  s_add_u32 s27, s27, 16384
  s_add_u32 m0, s25, 25600
  s_nop 0
  buffer_load_dwordx4 v21, s[60:63], s27 offen  lds
  s_add_u32 s27, s27, 16384
  s_add_u32 m0, s25, 26624
  s_nop 0
  buffer_load_dwordx4 v20, s[60:63], s27 offen  lds
  s_add_u32 s27, s27, 16384
  s_add_u32 m0, s25, 27648
  s_nop 0
  buffer_load_dwordx4 v21, s[60:63], s27 offen  lds
  s_add_u32 s27, s27, 16384
  s_add_u32 m0, s25, 28672
  s_nop 0
  buffer_load_dwordx4 v22, s[60:63], s27 offen  lds
  s_add_u32 s27, s27, 16384
  s_add_u32 m0, s25, 29696
  s_nop 0
  buffer_load_dwordx4 v23, s[60:63], s27 offen  lds
  s_add_u32 s27, s27, 16384
  s_add_u32 m0, s25, 30720
  s_nop 0
  buffer_load_dwordx4 v22, s[60:63], s27 offen  lds
  s_add_u32 s27, s27, 16384
  s_add_u32 m0, s25, 31744
  s_nop 0
  buffer_load_dwordx4 v23, s[60:63], s27 offen  lds
  s_add_u32 s27, s27, 16384
  s_branch wp_A
wp_B2:
  v_lshlrev_b32 v6, 7, v1
  s_getpc_b64 s[98:99]
ct_13:
  s_add_u32 s98, s98, wp_fin-ct_13
  s_addc_u32 s99, s99, 0
  global_load_dword v7, v6, s[98:99]
  s_getpc_b64 s[98:99]
ct_14:
  s_add_u32 s98, s98, wg_vo-ct_14
  s_addc_u32 s99, s99, 0
  global_load_dword v7, v6, s[98:99]
  s_waitcnt vmcnt(2)
  s_barrier
  s_cmp_lg_u32 s16, 0
  s_cbranch_scc1 wp_f2_f
  v_readfirstlane_b32 s20, v254
  s_cmp_eq_u32 s20, 1
  s_cbranch_scc1 wp_f2_w_ok
  s_mov_b32 s30, 0
wp_f2_w:
  buffer_load_dword v254, off, s[12:15], 0 offset:128 sc1
  s_waitcnt vmcnt(0)
  v_cmp_ne_u32 vcc, 1, v254
  s_cbranch_vccz wp_f2_w_ok
  s_sleep 8
  s_add_u32 s30, s30, 1
  s_cmp_lt_u32 s30, 16
  s_cbranch_scc1 wp_f2_w
  s_branch wp_f2_f
wp_f2_w_ok:
  s_lshl_b32 s20, s17, 7
  s_add_u32 s20, s20, 582144
  s_lshl_b32 s21, 1, s19
  v_mov_b32 v248, s21
  s_mov_b64 exec, 1
  buffer_atomic_or v248, v252, s[8:11], s20 offen sc0
  s_mov_b64 exec, -1
  s_mov_b32 s37, s21
wp_f2_f:
  s_cmp_eq_u32 s97, 0
  s_cselect_b32 s39, -1, s39
  s_branch wp_fin
wp_A0:
  s_mov_b32 s60, s40
  s_and_b32 s61, s41, 0xffff
  s_mov_b32 s62, 3670016
  s_mov_b32 s63, 0x20000
  s_mov_b32 s56, s42
  s_and_b32 s57, s43, 0xffff
  s_mov_b32 s58, 3670016
  s_mov_b32 s59, 0x20000
  s_lshl_b32 s27, s18, 2
  s_add_u32 s27, s27, s16
  s_lshl_b32 s27, s27, 17
  s_add_u32 s27, s27, s26
  s_lshl_b32 s30, s16, 13
  s_add_u32 m0, s30, 0
  s_nop 0
  buffer_load_dwordx4 v26, s[56:59], s27 offen  lds
  s_add_u32 s27, s27, 16384
  s_add_u32 m0, s30, 1024
  s_nop 0
  buffer_load_dwordx4 v26, s[56:59], s27 offen  lds
  s_add_u32 s27, s27, 16384
  s_add_u32 m0, s30, 2048
  s_nop 0
  buffer_load_dwordx4 v27, s[56:59], s27 offen  lds
  s_add_u32 s27, s27, 16384
  s_add_u32 m0, s30, 3072
  s_nop 0
  buffer_load_dwordx4 v27, s[56:59], s27 offen  lds
  s_add_u32 s27, s27, 16384
  s_add_u32 m0, s30, 4096
  s_nop 0
  buffer_load_dwordx4 v26, s[56:59], s27 offen  lds
  s_add_u32 s27, s27, 16384
  s_add_u32 m0, s30, 5120
  s_nop 0
  buffer_load_dwordx4 v26, s[56:59], s27 offen  lds
  s_add_u32 s27, s27, 16384
  s_add_u32 m0, s30, 6144
  s_nop 0
  buffer_load_dwordx4 v27, s[56:59], s27 offen  lds
  s_add_u32 s27, s27, 16384
  s_add_u32 m0, s30, 7168
  s_nop 0
  buffer_load_dwordx4 v27, s[56:59], s27 offen  lds
  s_add_u32 s27, s27, 16384
  s_add_u32 s27, s28, 0
  s_min_u32 s27, s27, 13
  s_lshl_b32 s27, s27, 18
  s_add_u32 s27, s27, s26
  s_add_u32 m0, s25, 0
  s_nop 0
  buffer_load_dwordx4 v16, s[60:63], s27 offen  lds
  s_add_u32 s27, s27, 16384
  s_add_u32 m0, s25, 1024
  s_nop 0
  buffer_load_dwordx4 v17, s[60:63], s27 offen  lds
  s_add_u32 s27, s27, 16384
  s_add_u32 m0, s25, 2048
  s_nop 0
  buffer_load_dwordx4 v16, s[60:63], s27 offen  lds
  s_add_u32 s27, s27, 16384
  s_add_u32 m0, s25, 3072
  s_nop 0
  buffer_load_dwordx4 v17, s[60:63], s27 offen  lds
  s_add_u32 s27, s27, 16384
  s_add_u32 m0, s25, 4096
  s_nop 0
  buffer_load_dwordx4 v18, s[60:63], s27 offen  lds
  s_add_u32 s27, s27, 16384
  s_add_u32 m0, s25, 5120
  s_nop 0
  buffer_load_dwordx4 v19, s[60:63], s27 offen  lds
  s_add_u32 s27, s27, 16384
  s_add_u32 m0, s25, 6144
  s_nop 0
  buffer_load_dwordx4 v18, s[60:63], s27 offen  lds
  s_add_u32 s27, s27, 16384
  s_add_u32 m0, s25, 7168
  s_nop 0
  buffer_load_dwordx4 v19, s[60:63], s27 offen  lds
  s_add_u32 s27, s27, 16384
  s_add_u32 m0, s25, 8192
  s_nop 0
  buffer_load_dwordx4 v20, s[60:63], s27 offen  lds
  s_add_u32 s27, s27, 16384
  s_add_u32 m0, s25, 9216
  s_nop 0
  buffer_load_dwordx4 v21, s[60:63], s27 offen  lds
  s_add_u32 s27, s27, 16384
  s_add_u32 m0, s25, 10240
  s_nop 0
  buffer_load_dwordx4 v20, s[60:63], s27 offen  lds
  s_add_u32 s27, s27, 16384
  s_add_u32 m0, s25, 11264
  s_nop 0
  buffer_load_dwordx4 v21, s[60:63], s27 offen  lds
  s_add_u32 s27, s27, 16384
  s_add_u32 m0, s25, 12288
  s_nop 0
  buffer_load_dwordx4 v22, s[60:63], s27 offen  lds
  s_add_u32 s27, s27, 16384
  s_add_u32 m0, s25, 13312
  s_nop 0
  buffer_load_dwordx4 v23, s[60:63], s27 offen  lds
  s_add_u32 s27, s27, 16384
  s_add_u32 m0, s25, 14336
  s_nop 0
  buffer_load_dwordx4 v22, s[60:63], s27 offen  lds
  s_add_u32 s27, s27, 16384
  s_add_u32 m0, s25, 15360
  s_nop 0
  buffer_load_dwordx4 v23, s[60:63], s27 offen  lds
  s_add_u32 s27, s27, 16384
  s_add_u32 s27, s28, 4
  s_min_u32 s27, s27, 13
  s_lshl_b32 s27, s27, 18
  s_add_u32 s27, s27, s26
  s_add_u32 m0, s25, 16384
  s_nop 0
  buffer_load_dwordx4 v16, s[60:63], s27 offen  lds
  s_add_u32 s27, s27, 16384
  s_add_u32 m0, s25, 17408
  s_nop 0
  buffer_load_dwordx4 v17, s[60:63], s27 offen  lds
  s_add_u32 s27, s27, 16384
  s_add_u32 m0, s25, 18432
  s_nop 0
  buffer_load_dwordx4 v16, s[60:63], s27 offen  lds
  s_add_u32 s27, s27, 16384
  s_add_u32 m0, s25, 19456
  s_nop 0
  buffer_load_dwordx4 v17, s[60:63], s27 offen  lds
  s_add_u32 s27, s27, 16384
  s_add_u32 m0, s25, 20480
  s_nop 0
  buffer_load_dwordx4 v18, s[60:63], s27 offen  lds
  s_add_u32 s27, s27, 16384
  s_add_u32 m0, s25, 21504
  s_nop 0
  buffer_load_dwordx4 v19, s[60:63], s27 offen  lds
  s_add_u32 s27, s27, 16384
  s_add_u32 m0, s25, 22528
  s_nop 0
  buffer_load_dwordx4 v18, s[60:63], s27 offen  lds
  s_add_u32 s27, s27, 16384
  s_add_u32 m0, s25, 23552
  s_nop 0
  buffer_load_dwordx4 v19, s[60:63], s27 offen  lds
  s_add_u32 s27, s27, 16384
  s_add_u32 m0, s25, 24576
  s_nop 0
  buffer_load_dwordx4 v20, s[60:63], s27 offen  lds
  s_add_u32 s27, s27, 16384
  s_add_u32 m0, s25, 25600
  s_nop 0
  buffer_load_dwordx4 v21, s[60:63], s27 offen  lds
  s_add_u32 s27, s27, 16384
  s_add_u32 m0, s25, 26624
  s_nop 0
  buffer_load_dwordx4 v20, s[60:63], s27 offen  lds
  s_add_u32 s27, s27, 16384
  s_add_u32 m0, s25, 27648
  s_nop 0
  buffer_load_dwordx4 v21, s[60:63], s27 offen  lds
  s_add_u32 s27, s27, 16384
  s_add_u32 m0, s25, 28672
  s_nop 0
  buffer_load_dwordx4 v22, s[60:63], s27 offen  lds
  s_add_u32 s27, s27, 16384
  s_add_u32 m0, s25, 29696
  s_nop 0
  buffer_load_dwordx4 v23, s[60:63], s27 offen  lds
  s_add_u32 s27, s27, 16384
  s_add_u32 m0, s25, 30720
  s_nop 0
  buffer_load_dwordx4 v22, s[60:63], s27 offen  lds
  s_add_u32 s27, s27, 16384
  s_add_u32 m0, s25, 31744
  s_nop 0
  buffer_load_dwordx4 v23, s[60:63], s27 offen  lds
  s_add_u32 s27, s27, 16384
  v_lshrrev_b32 v7, 2, v4
  v_lshlrev_b32 v11, 4, v7
  v_lshlrev_b32 v7, 3, v7
  v_and_b32 v8, 3, v4
  v_add_u32 v7, v7, v8
  v_and_b32 v8, 2, v4
  v_lshl_add_u32 v11, v8, 1, v11
  v_and_b32 v8, 1, v4
  v_add_u32 v11, v11, v8
  v_or_b32 v10, 0, v3
  v_xor_b32 v10, v10, v4
  v_lshlrev_b32 v10, 4, v10
  v_lshl_add_u32 v44, v11, 9, v10
  v_lshl_add_u32 v10, v7, 9, v10
  v_add_u32 v32, s25, v10
  v_or_b32 v10, 4, v3
  v_xor_b32 v10, v10, v4
  v_lshlrev_b32 v10, 4, v10
  v_lshl_add_u32 v45, v11, 9, v10
  v_lshl_add_u32 v10, v7, 9, v10
  v_add_u32 v33, s25, v10
  v_or_b32 v10, 8, v3
  v_xor_b32 v10, v10, v4
  v_lshlrev_b32 v10, 4, v10
  v_lshl_add_u32 v46, v11, 9, v10
  v_lshl_add_u32 v10, v7, 9, v10
  v_add_u32 v34, s25, v10
  v_or_b32 v10, 12, v3
  v_xor_b32 v10, v10, v4
  v_lshlrev_b32 v10, 4, v10
  v_lshl_add_u32 v47, v11, 9, v10
  v_lshl_add_u32 v10, v7, 9, v10
  v_add_u32 v35, s25, v10
  s_mul_i32 s30, s17, 401408
  s_mul_i32 s31, s18, 57344
  s_add_u32 s30, s30, s31
  s_add_u32 s30, s30, 33554432
  v_add_u32 v28, s30, v2
  s_add_u32 s30, s30, 14336
  v_add_u32 v29, s30, v2
  s_add_u32 s30, s30, 14336
  v_add_u32 v30, s30, v2
  s_add_u32 s30, s30, 14336
  v_add_u32 v31, s30, v2
  s_add_u32 s30, s30, 14336
  v_mov_b32 v48, 1035512379
wp_A:
  s_lshl_b32 s29, s28, 10
  s_add_u32 s31, s29, 4096
  s_cmp_lt_u32 s28, 10
  s_cselect_b32 s31, s31, 0x40000000
  s_waitcnt vmcnt(0)
  s_barrier
  ds_read_b128 a[0:3], v44 offset:0
  ds_read_b128 a[32:35], v44 offset:1024
  ds_read_b128 a[64:67], v44 offset:4096
  ds_read_b128 a[96:99], v44 offset:5120
  ds_read_b128 a[128:131], v32 offset:0
  ds_read_b128 a[160:163], v32 offset:2048
  ds_read_b128 a[192:195], v32 offset:16384
  ds_read_b128 a[224:227], v32 offset:18432
  s_waitcnt lgkmcnt(0)
  v_mfma_f32_16x16x32_bf16 v[64:67], a[128:131], a[0:3], 0
  ds_read_b128 a[4:7], v45 offset:0
  ds_read_b128 a[36:39], v45 offset:1024
  v_mfma_f32_16x16x32_bf16 v[68:71], a[160:163], a[0:3], 0
  ds_read_b128 a[68:71], v45 offset:4096
  ds_read_b128 a[100:103], v45 offset:5120
  v_mfma_f32_16x16x32_bf16 v[72:75], a[128:131], a[32:35], 0
  ds_read_b128 a[132:135], v33 offset:0
  ds_read_b128 a[164:167], v33 offset:2048
  v_mfma_f32_16x16x32_bf16 v[76:79], a[160:163], a[32:35], 0
  ds_read_b128 a[196:199], v33 offset:16384
  ds_read_b128 a[228:231], v33 offset:18432
  v_mfma_f32_16x16x32_bf16 v[80:83], a[128:131], a[64:67], 0
  v_mfma_f32_16x16x32_bf16 v[84:87], a[160:163], a[64:67], 0
  v_mfma_f32_16x16x32_bf16 v[88:91], a[128:131], a[96:99], 0
  v_mfma_f32_16x16x32_bf16 v[92:95], a[160:163], a[96:99], 0
  v_mfma_f32_16x16x32_bf16 v[96:99], a[192:195], a[0:3], 0
  v_mfma_f32_16x16x32_bf16 v[100:103], a[224:227], a[0:3], 0
  v_mfma_f32_16x16x32_bf16 v[104:107], a[192:195], a[32:35], 0
  v_mfma_f32_16x16x32_bf16 v[108:111], a[224:227], a[32:35], 0
  v_mfma_f32_16x16x32_bf16 v[112:115], a[192:195], a[64:67], 0
  v_mfma_f32_16x16x32_bf16 v[116:119], a[224:227], a[64:67], 0
  v_mfma_f32_16x16x32_bf16 v[120:123], a[192:195], a[96:99], 0
  v_mfma_f32_16x16x32_bf16 v[124:127], a[224:227], a[96:99], 0
  s_waitcnt lgkmcnt(0)
  v_mfma_f32_16x16x32_bf16 v[64:67], a[132:135], a[4:7], v[64:67]
  ds_read_b128 a[8:11], v46 offset:0
  ds_read_b128 a[40:43], v46 offset:1024
  v_mfma_f32_16x16x32_bf16 v[68:71], a[164:167], a[4:7], v[68:71]
  ds_read_b128 a[72:75], v46 offset:4096
  ds_read_b128 a[104:107], v46 offset:5120
  v_mfma_f32_16x16x32_bf16 v[72:75], a[132:135], a[36:39], v[72:75]
  ds_read_b128 a[136:139], v34 offset:0
  ds_read_b128 a[168:171], v34 offset:2048
  v_mfma_f32_16x16x32_bf16 v[76:79], a[164:167], a[36:39], v[76:79]
  ds_read_b128 a[200:203], v34 offset:16384
  ds_read_b128 a[232:235], v34 offset:18432
  v_mfma_f32_16x16x32_bf16 v[80:83], a[132:135], a[68:71], v[80:83]
  v_mfma_f32_16x16x32_bf16 v[84:87], a[164:167], a[68:71], v[84:87]
  v_mfma_f32_16x16x32_bf16 v[88:91], a[132:135], a[100:103], v[88:91]
  v_mfma_f32_16x16x32_bf16 v[92:95], a[164:167], a[100:103], v[92:95]
  v_mfma_f32_16x16x32_bf16 v[96:99], a[196:199], a[4:7], v[96:99]
  v_mfma_f32_16x16x32_bf16 v[100:103], a[228:231], a[4:7], v[100:103]
  v_mfma_f32_16x16x32_bf16 v[104:107], a[196:199], a[36:39], v[104:107]
  v_mfma_f32_16x16x32_bf16 v[108:111], a[228:231], a[36:39], v[108:111]
  v_mfma_f32_16x16x32_bf16 v[112:115], a[196:199], a[68:71], v[112:115]
  v_mfma_f32_16x16x32_bf16 v[116:119], a[228:231], a[68:71], v[116:119]
  v_mfma_f32_16x16x32_bf16 v[120:123], a[196:199], a[100:103], v[120:123]
  v_mfma_f32_16x16x32_bf16 v[124:127], a[228:231], a[100:103], v[124:127]
  s_waitcnt lgkmcnt(0)
  v_mfma_f32_16x16x32_bf16 v[64:67], a[136:139], a[8:11], v[64:67]
  ds_read_b128 a[12:15], v47 offset:0
  ds_read_b128 a[44:47], v47 offset:1024
  v_mfma_f32_16x16x32_bf16 v[68:71], a[168:171], a[8:11], v[68:71]
  ds_read_b128 a[76:79], v47 offset:4096
  ds_read_b128 a[108:111], v47 offset:5120
  v_mfma_f32_16x16x32_bf16 v[72:75], a[136:139], a[40:43], v[72:75]
  ds_read_b128 a[140:143], v35 offset:0
  ds_read_b128 a[172:175], v35 offset:2048
  v_mfma_f32_16x16x32_bf16 v[76:79], a[168:171], a[40:43], v[76:79]
  ds_read_b128 a[204:207], v35 offset:16384
  ds_read_b128 a[236:239], v35 offset:18432
  v_mfma_f32_16x16x32_bf16 v[80:83], a[136:139], a[72:75], v[80:83]
  v_mfma_f32_16x16x32_bf16 v[84:87], a[168:171], a[72:75], v[84:87]
  v_mfma_f32_16x16x32_bf16 v[88:91], a[136:139], a[104:107], v[88:91]
  v_mfma_f32_16x16x32_bf16 v[92:95], a[168:171], a[104:107], v[92:95]
  v_mfma_f32_16x16x32_bf16 v[96:99], a[200:203], a[8:11], v[96:99]
  v_mfma_f32_16x16x32_bf16 v[100:103], a[232:235], a[8:11], v[100:103]
  v_mfma_f32_16x16x32_bf16 v[104:107], a[200:203], a[40:43], v[104:107]
  v_mfma_f32_16x16x32_bf16 v[108:111], a[232:235], a[40:43], v[108:111]
  v_mfma_f32_16x16x32_bf16 v[112:115], a[200:203], a[72:75], v[112:115]
  v_mfma_f32_16x16x32_bf16 v[116:119], a[232:235], a[72:75], v[116:119]
  v_mfma_f32_16x16x32_bf16 v[120:123], a[200:203], a[104:107], v[120:123]
  v_mfma_f32_16x16x32_bf16 v[124:127], a[232:235], a[104:107], v[124:127]
  s_waitcnt lgkmcnt(0)
  v_mfma_f32_16x16x32_bf16 v[64:67], a[140:143], a[12:15], v[64:67]
  ds_read_b128 a[16:19], v44 offset:256
  ds_read_b128 a[48:51], v44 offset:1280
  v_mfma_f32_16x16x32_bf16 v[68:71], a[172:175], a[12:15], v[68:71]
  ds_read_b128 a[80:83], v44 offset:4352
  ds_read_b128 a[112:115], v44 offset:5376
  v_mfma_f32_16x16x32_bf16 v[72:75], a[140:143], a[44:47], v[72:75]
  ds_read_b128 a[144:147], v32 offset:256
  ds_read_b128 a[176:179], v32 offset:2304
  v_mfma_f32_16x16x32_bf16 v[76:79], a[172:175], a[44:47], v[76:79]
  ds_read_b128 a[208:211], v32 offset:16640
  ds_read_b128 a[240:243], v32 offset:18688
  v_mfma_f32_16x16x32_bf16 v[80:83], a[140:143], a[76:79], v[80:83]
  v_mfma_f32_16x16x32_bf16 v[84:87], a[172:175], a[76:79], v[84:87]
  v_mfma_f32_16x16x32_bf16 v[88:91], a[140:143], a[108:111], v[88:91]
  v_mfma_f32_16x16x32_bf16 v[92:95], a[172:175], a[108:111], v[92:95]
  v_mfma_f32_16x16x32_bf16 v[96:99], a[204:207], a[12:15], v[96:99]
  v_mfma_f32_16x16x32_bf16 v[100:103], a[236:239], a[12:15], v[100:103]
  v_mfma_f32_16x16x32_bf16 v[104:107], a[204:207], a[44:47], v[104:107]
  v_mfma_f32_16x16x32_bf16 v[108:111], a[236:239], a[44:47], v[108:111]
  v_mfma_f32_16x16x32_bf16 v[112:115], a[204:207], a[76:79], v[112:115]
  v_mfma_f32_16x16x32_bf16 v[116:119], a[236:239], a[76:79], v[116:119]
  v_mfma_f32_16x16x32_bf16 v[120:123], a[204:207], a[108:111], v[120:123]
  v_mfma_f32_16x16x32_bf16 v[124:127], a[236:239], a[108:111], v[124:127]
  s_waitcnt lgkmcnt(0)
  v_mfma_f32_16x16x32_bf16 v[64:67], a[144:147], a[16:19], v[64:67]
  ds_read_b128 a[20:23], v45 offset:256
  ds_read_b128 a[52:55], v45 offset:1280
  v_mfma_f32_16x16x32_bf16 v[68:71], a[176:179], a[16:19], v[68:71]
  ds_read_b128 a[84:87], v45 offset:4352
  ds_read_b128 a[116:119], v45 offset:5376
  v_mfma_f32_16x16x32_bf16 v[72:75], a[144:147], a[48:51], v[72:75]
  ds_read_b128 a[148:151], v33 offset:256
  ds_read_b128 a[180:183], v33 offset:2304
  v_mfma_f32_16x16x32_bf16 v[76:79], a[176:179], a[48:51], v[76:79]
  ds_read_b128 a[212:215], v33 offset:16640
  ds_read_b128 a[244:247], v33 offset:18688
  v_mfma_f32_16x16x32_bf16 v[80:83], a[144:147], a[80:83], v[80:83]
  v_mfma_f32_16x16x32_bf16 v[84:87], a[176:179], a[80:83], v[84:87]
  v_mfma_f32_16x16x32_bf16 v[88:91], a[144:147], a[112:115], v[88:91]
  v_mfma_f32_16x16x32_bf16 v[92:95], a[176:179], a[112:115], v[92:95]
  v_mfma_f32_16x16x32_bf16 v[96:99], a[208:211], a[16:19], v[96:99]
  v_mfma_f32_16x16x32_bf16 v[100:103], a[240:243], a[16:19], v[100:103]
  v_mfma_f32_16x16x32_bf16 v[104:107], a[208:211], a[48:51], v[104:107]
  v_mfma_f32_16x16x32_bf16 v[108:111], a[240:243], a[48:51], v[108:111]
  v_mfma_f32_16x16x32_bf16 v[112:115], a[208:211], a[80:83], v[112:115]
  v_mfma_f32_16x16x32_bf16 v[116:119], a[240:243], a[80:83], v[116:119]
  v_mfma_f32_16x16x32_bf16 v[120:123], a[208:211], a[112:115], v[120:123]
  v_mfma_f32_16x16x32_bf16 v[124:127], a[240:243], a[112:115], v[124:127]
  s_waitcnt lgkmcnt(0)
  v_mfma_f32_16x16x32_bf16 v[64:67], a[148:151], a[20:23], v[64:67]
  ds_read_b128 a[24:27], v46 offset:256
  ds_read_b128 a[56:59], v46 offset:1280
  v_mfma_f32_16x16x32_bf16 v[68:71], a[180:183], a[20:23], v[68:71]
  ds_read_b128 a[88:91], v46 offset:4352
  ds_read_b128 a[120:123], v46 offset:5376
  v_mfma_f32_16x16x32_bf16 v[72:75], a[148:151], a[52:55], v[72:75]
  ds_read_b128 a[152:155], v34 offset:256
  ds_read_b128 a[184:187], v34 offset:2304
  v_mfma_f32_16x16x32_bf16 v[76:79], a[180:183], a[52:55], v[76:79]
  ds_read_b128 a[216:219], v34 offset:16640
  ds_read_b128 a[248:251], v34 offset:18688
  v_mfma_f32_16x16x32_bf16 v[80:83], a[148:151], a[84:87], v[80:83]
  v_mfma_f32_16x16x32_bf16 v[84:87], a[180:183], a[84:87], v[84:87]
  v_mfma_f32_16x16x32_bf16 v[88:91], a[148:151], a[116:119], v[88:91]
  v_mfma_f32_16x16x32_bf16 v[92:95], a[180:183], a[116:119], v[92:95]
  v_mfma_f32_16x16x32_bf16 v[96:99], a[212:215], a[20:23], v[96:99]
  v_mfma_f32_16x16x32_bf16 v[100:103], a[244:247], a[20:23], v[100:103]
  v_mfma_f32_16x16x32_bf16 v[104:107], a[212:215], a[52:55], v[104:107]
  v_mfma_f32_16x16x32_bf16 v[108:111], a[244:247], a[52:55], v[108:111]
  v_mfma_f32_16x16x32_bf16 v[112:115], a[212:215], a[84:87], v[112:115]
  v_mfma_f32_16x16x32_bf16 v[116:119], a[244:247], a[84:87], v[116:119]
  v_mfma_f32_16x16x32_bf16 v[120:123], a[212:215], a[116:119], v[120:123]
  v_mfma_f32_16x16x32_bf16 v[124:127], a[244:247], a[116:119], v[124:127]
  s_waitcnt lgkmcnt(0)
  v_mfma_f32_16x16x32_bf16 v[64:67], a[152:155], a[24:27], v[64:67]
  ds_read_b128 a[28:31], v47 offset:256
  ds_read_b128 a[60:63], v47 offset:1280
  v_mfma_f32_16x16x32_bf16 v[68:71], a[184:187], a[24:27], v[68:71]
  ds_read_b128 a[92:95], v47 offset:4352
  ds_read_b128 a[124:127], v47 offset:5376
  v_mfma_f32_16x16x32_bf16 v[72:75], a[152:155], a[56:59], v[72:75]
  ds_read_b128 a[156:159], v35 offset:256
  ds_read_b128 a[188:191], v35 offset:2304
  v_mfma_f32_16x16x32_bf16 v[76:79], a[184:187], a[56:59], v[76:79]
  ds_read_b128 a[220:223], v35 offset:16640
  ds_read_b128 a[252:255], v35 offset:18688
  v_mfma_f32_16x16x32_bf16 v[80:83], a[152:155], a[88:91], v[80:83]
  v_mfma_f32_16x16x32_bf16 v[84:87], a[184:187], a[88:91], v[84:87]
  v_mfma_f32_16x16x32_bf16 v[88:91], a[152:155], a[120:123], v[88:91]
  v_mfma_f32_16x16x32_bf16 v[92:95], a[184:187], a[120:123], v[92:95]
  v_mfma_f32_16x16x32_bf16 v[96:99], a[216:219], a[24:27], v[96:99]
  v_mfma_f32_16x16x32_bf16 v[100:103], a[248:251], a[24:27], v[100:103]
  v_mfma_f32_16x16x32_bf16 v[104:107], a[216:219], a[56:59], v[104:107]
  v_mfma_f32_16x16x32_bf16 v[108:111], a[248:251], a[56:59], v[108:111]
  v_mfma_f32_16x16x32_bf16 v[112:115], a[216:219], a[88:91], v[112:115]
  v_mfma_f32_16x16x32_bf16 v[116:119], a[248:251], a[88:91], v[116:119]
  v_mfma_f32_16x16x32_bf16 v[120:123], a[216:219], a[120:123], v[120:123]
  v_mfma_f32_16x16x32_bf16 v[124:127], a[248:251], a[120:123], v[124:127]
  s_waitcnt lgkmcnt(0)
  s_barrier
  buffer_load_dwordx2 v[254:255], v252, s[12:15], 0 offen offset:128 sc1
  buffer_load_dword v253, v252, s[12:15], 0 offen sc1
  v_mfma_f32_16x16x32_bf16 v[64:67], a[156:159], a[28:31], v[64:67]
  v_mfma_f32_16x16x32_bf16 v[68:71], a[188:191], a[28:31], v[68:71]
  v_mfma_f32_16x16x32_bf16 v[72:75], a[156:159], a[60:63], v[72:75]
  v_mfma_f32_16x16x32_bf16 v[76:79], a[188:191], a[60:63], v[76:79]
  v_mfma_f32_16x16x32_bf16 v[80:83], a[156:159], a[92:95], v[80:83]
  v_pk_mul_f32 v[64:65], v[64:65], v[48:49] op_sel_hi:[1,0]
  v_pk_mul_f32 v[66:67], v[66:67], v[48:49] op_sel_hi:[1,0]
  v_mfma_f32_16x16x32_bf16 v[84:87], a[188:191], a[92:95], v[84:87]
  v_pk_mul_f32 v[68:69], v[68:69], v[48:49] op_sel_hi:[1,0]
  v_pk_mul_f32 v[70:71], v[70:71], v[48:49] op_sel_hi:[1,0]
  v_mfma_f32_16x16x32_bf16 v[88:91], a[156:159], a[124:127], v[88:91]
  v_cvt_pk_bf16_f32 v64, v64, v65
  v_cvt_pk_bf16_f32 v65, v66, v67
  v_mfma_f32_16x16x32_bf16 v[92:95], a[188:191], a[124:127], v[92:95]
  v_cvt_pk_bf16_f32 v66, v68, v69
  v_cvt_pk_bf16_f32 v67, v70, v71
  v_mfma_f32_16x16x32_bf16 v[96:99], a[220:223], a[28:31], v[96:99]
  buffer_store_dwordx4 v[64:67], v28, s[8:11], s29 offen sc1
  v_pk_mul_f32 v[72:73], v[72:73], v[48:49] op_sel_hi:[1,0]
  v_mfma_f32_16x16x32_bf16 v[100:103], a[252:255], a[28:31], v[100:103]
  v_pk_mul_f32 v[74:75], v[74:75], v[48:49] op_sel_hi:[1,0]
  v_pk_mul_f32 v[76:77], v[76:77], v[48:49] op_sel_hi:[1,0]
  v_mfma_f32_16x16x32_bf16 v[104:107], a[220:223], a[60:63], v[104:107]
  v_pk_mul_f32 v[78:79], v[78:79], v[48:49] op_sel_hi:[1,0]
  v_cvt_pk_bf16_f32 v72, v72, v73
  v_mfma_f32_16x16x32_bf16 v[108:111], a[252:255], a[60:63], v[108:111]
  v_cvt_pk_bf16_f32 v73, v74, v75
  v_cvt_pk_bf16_f32 v74, v76, v77
  v_mfma_f32_16x16x32_bf16 v[112:115], a[220:223], a[92:95], v[112:115]
  v_cvt_pk_bf16_f32 v75, v78, v79
  buffer_store_dwordx4 v[72:75], v29, s[8:11], s29 offen sc1
  v_mfma_f32_16x16x32_bf16 v[116:119], a[252:255], a[92:95], v[116:119]
  v_pk_mul_f32 v[80:81], v[80:81], v[48:49] op_sel_hi:[1,0]
  v_pk_mul_f32 v[82:83], v[82:83], v[48:49] op_sel_hi:[1,0]
  v_mfma_f32_16x16x32_bf16 v[120:123], a[220:223], a[124:127], v[120:123]
  v_pk_mul_f32 v[84:85], v[84:85], v[48:49] op_sel_hi:[1,0]
  v_pk_mul_f32 v[86:87], v[86:87], v[48:49] op_sel_hi:[1,0]
  v_mfma_f32_16x16x32_bf16 v[124:127], a[252:255], a[124:127], v[124:127]
  v_cvt_pk_bf16_f32 v80, v80, v81
  v_cvt_pk_bf16_f32 v81, v82, v83
  v_cvt_pk_bf16_f32 v82, v84, v85
  v_cvt_pk_bf16_f32 v83, v86, v87
  buffer_store_dwordx4 v[80:83], v30, s[8:11], s29 offen sc1
  v_pk_mul_f32 v[88:89], v[88:89], v[48:49] op_sel_hi:[1,0]
  v_pk_mul_f32 v[90:91], v[90:91], v[48:49] op_sel_hi:[1,0]
  v_pk_mul_f32 v[92:93], v[92:93], v[48:49] op_sel_hi:[1,0]
  v_pk_mul_f32 v[94:95], v[94:95], v[48:49] op_sel_hi:[1,0]
  v_cvt_pk_bf16_f32 v88, v88, v89
  v_cvt_pk_bf16_f32 v89, v90, v91
  v_cvt_pk_bf16_f32 v90, v92, v93
  v_cvt_pk_bf16_f32 v91, v94, v95
  buffer_store_dwordx4 v[88:91], v31, s[8:11], s29 offen sc1
  v_pk_mul_f32 v[96:97], v[96:97], v[48:49] op_sel_hi:[1,0]
  v_pk_mul_f32 v[98:99], v[98:99], v[48:49] op_sel_hi:[1,0]
  v_pk_mul_f32 v[100:101], v[100:101], v[48:49] op_sel_hi:[1,0]
  v_pk_mul_f32 v[102:103], v[102:103], v[48:49] op_sel_hi:[1,0]
  v_cvt_pk_bf16_f32 v96, v96, v97
  v_cvt_pk_bf16_f32 v97, v98, v99
  v_cvt_pk_bf16_f32 v98, v100, v101
  v_cvt_pk_bf16_f32 v99, v102, v103
  buffer_store_dwordx4 v[96:99], v28, s[8:11], s31 offen sc1
  v_pk_mul_f32 v[104:105], v[104:105], v[48:49] op_sel_hi:[1,0]
  v_pk_mul_f32 v[106:107], v[106:107], v[48:49] op_sel_hi:[1,0]
  v_pk_mul_f32 v[108:109], v[108:109], v[48:49] op_sel_hi:[1,0]
  v_pk_mul_f32 v[110:111], v[110:111], v[48:49] op_sel_hi:[1,0]
  v_cvt_pk_bf16_f32 v104, v104, v105
  v_cvt_pk_bf16_f32 v105, v106, v107
  v_cvt_pk_bf16_f32 v106, v108, v109
  v_cvt_pk_bf16_f32 v107, v110, v111
  buffer_store_dwordx4 v[104:107], v29, s[8:11], s31 offen sc1
  v_pk_mul_f32 v[112:113], v[112:113], v[48:49] op_sel_hi:[1,0]
  v_pk_mul_f32 v[114:115], v[114:115], v[48:49] op_sel_hi:[1,0]
  v_pk_mul_f32 v[116:117], v[116:117], v[48:49] op_sel_hi:[1,0]
  v_pk_mul_f32 v[118:119], v[118:119], v[48:49] op_sel_hi:[1,0]
  v_cvt_pk_bf16_f32 v112, v112, v113
  v_cvt_pk_bf16_f32 v113, v114, v115
  v_cvt_pk_bf16_f32 v114, v116, v117
  v_cvt_pk_bf16_f32 v115, v118, v119
  buffer_store_dwordx4 v[112:115], v30, s[8:11], s31 offen sc1
  v_pk_mul_f32 v[120:121], v[120:121], v[48:49] op_sel_hi:[1,0]
  v_pk_mul_f32 v[122:123], v[122:123], v[48:49] op_sel_hi:[1,0]
  v_pk_mul_f32 v[124:125], v[124:125], v[48:49] op_sel_hi:[1,0]
  v_pk_mul_f32 v[126:127], v[126:127], v[48:49] op_sel_hi:[1,0]
  v_cvt_pk_bf16_f32 v120, v120, v121
  v_cvt_pk_bf16_f32 v121, v122, v123
  v_cvt_pk_bf16_f32 v122, v124, v125
  v_cvt_pk_bf16_f32 v123, v126, v127
  buffer_store_dwordx4 v[120:123], v31, s[8:11], s31 offen sc1
  s_waitcnt vmcnt(0)
  s_barrier
  s_cmp_lg_u32 s16, 0
  s_cbranch_scc1 wp_f3_f
  v_readfirstlane_b32 s20, v254
  s_cmp_eq_u32 s20, 1
  s_cbranch_scc1 wp_f3_w_ok
  s_mov_b32 s30, 0
wp_f3_w:
  buffer_load_dword v254, off, s[12:15], 0 offset:128 sc1
  s_waitcnt vmcnt(0)
  v_cmp_ne_u32 vcc, 1, v254
  s_cbranch_vccz wp_f3_w_ok
  s_sleep 8
  s_add_u32 s30, s30, 1
  s_cmp_lt_u32 s30, 16
  s_cbranch_scc1 wp_f3_w
  s_branch wp_f3_f
wp_f3_w_ok:
  s_lshl_b32 s20, s17, 7
  s_add_u32 s20, s20, 584192
  s_lshl_b32 s21, 1, s19
  v_mov_b32 v248, s21
  s_mov_b64 exec, 1
  buffer_atomic_or v248, v252, s[8:11], s20 offen sc0
  s_mov_b64 exec, -1
  s_mov_b32 s38, s21
wp_f3_f:
  s_cmp_eq_u32 s97, 3
  s_cbranch_scc1 wk_adone
wp_fin:
  s_cmp_lg_u32 s97, 0
  s_cbranch_scc1 wp_all
  v_readfirstlane_b32 s20, v254
  v_readfirstlane_b32 s21, v253
  s_and_b32 s21, s21, 0xffe0
  s_cselect_b32 s96, s20, 0
  s_cmp_eq_u32 s96, 0
  s_cbranch_scc1 wp_all
  v_mov_b32 v250, 1
  s_mov_b32 s20, 588288
  s_mov_b64 exec, 1
  buffer_atomic_add v250, v252, s[8:11], s20 offen sc0
  s_mov_b64 exec, -1
wp_all:
  v_mov_b32 v252, 0x40000000
  v_cmp_eq_u32 vcc, 0, v0
  s_nop 1
  v_cndmask_b32 v252, v252, v0, vcc
  s_mov_b32 s34, 0
  s_cmp_lg_u32 s16, 0
  s_cbranch_scc1 wp_w2
  s_getreg_b32 s24, hwreg(HW_REG_XCC_ID)
  s_sub_u32 s24, s24, 3
  s_and_b32 s24, s24, 7
  s_lshl_b32 s24, s24, 7
  s_add_u32 s24, s24, 586240
  s_cmp_lg_u32 s96, 0
  s_cbranch_scc1 wp_v0
  s_waitcnt vmcnt(0)
wp_v0:
  s_cmp_eq_u32 s97, 0
  s_cbranch_scc1 wp_v1
  s_waitcnt vmcnt(0)
wp_v1:
  s_waitcnt vmcnt(1)
  v_readfirstlane_b32 s20, v248
  s_and_b32 s20, s20, 14448
  s_xor_b32 s20, s20, s38
  s_cmp_lg_u32 s20, 14448
  s_cselect_b32 s20, 0, s38
  s_mov_b32 s38, 0
  s_cmp_eq_u32 s20, 0
  s_cbranch_scc1 wp_g3
  s_lshl_b32 s21, 65536, s17
  v_mov_b32 v248, s21
  s_mov_b32 s20, 586240
  v_lshlrev_b32 v247, 7, v0
  s_mov_b64 exec, 0xff
  buffer_atomic_or v248, v247, s[8:11], s20 offen
  s_mov_b64 exec, -1
wp_g3:
  v_readfirstlane_b32 s20, v248
  s_and_b32 s20, s20, 16383
  s_xor_b32 s20, s20, s37
  s_cmp_lg_u32 s20, 16383
  s_cselect_b32 s20, 0, s37
  s_mov_b32 s37, 0
  s_cmp_eq_u32 s20, 0
  s_cbranch_scc1 wp_g2
  s_lshl_b32 s21, 1, s17
  v_mov_b32 v248, s21
  s_mov_b32 s20, 586240
  v_lshlrev_b32 v247, 7, v0
  s_mov_b64 exec, 0xff
  buffer_atomic_or v248, v247, s[8:11], s20 offen
  s_mov_b64 exec, -1
wp_g2:
  s_cmp_lg_u32 s96, 0
  s_cbranch_scc1 wp_v_ok
  s_mov_b32 s30, 0
wp_v:
  buffer_load_dwordx2 v[64:65], off, s[12:15], 0 sc1
  buffer_load_dword v66, off, s[12:15], 0 offset:128 sc1
  s_waitcnt vmcnt(0)
  v_and_b32 v68, 0xffe0, v64
  v_min_u32 v68, v68, v66
  v_cmp_ne_u32 vcc, 1, v68
  s_cbranch_vccz wp_v_ok
  s_sleep 16
  s_add_u32 s30, s30, 1
  s_cmp_lt_u32 s30, 30
  s_cbranch_scc1 wp_v
  s_branch wp_w1
wp_v_ok:
  v_mov_b32 v64, 32
  s_cmp_eq_u32 s97, 2
  s_cselect_b32 s31, 1, 60
  s_cmp_eq_u32 s39, -1
  s_cselect_b32 s20, 4, 0
  s_add_u32 s24, s24, s20
  s_mov_b32 s30, 0
wp_w:
  buffer_load_dword v66, off, s[8:11], s24 sc1
  buffer_load_dword v67, off, s[8:11], s24 offset:4 sc1
  s_waitcnt vmcnt(0)
  v_or_b32 v66, s39, v66
  v_add_u32 v66, v66, v67
  v_cmp_ne_u32 vcc, 0, v66
  s_cbranch_vccz wp_w_ok
  s_sleep 8
  s_add_u32 s30, s30, 1
  s_cmp_lt_u32 s30, s31
  s_cbranch_scc1 wp_w
  s_branch wp_w1
wp_w_ok:
  s_branch wp_w2
wp_w1:
  v_readfirstlane_b32 s20, v64
  v_readfirstlane_b32 s21, v65
  s_and_b32 s20, s20, 0xffff
  s_cmp_lt_u32 s20, 32
  s_cselect_b32 s34, 2, 1
  s_add_u32 s32, s32, 1
  s_cmp_lt_u32 s32, 4000
  s_cselect_b32 s34, s34, 3
wp_w2:
  v_mov_b32 v6, 160032
  v_mov_b32 v7, s34
  s_barrier
  s_cmp_lg_u32 s16, 0
  s_cbranch_scc1 uni_15
  ds_write_b32 v6, v7
  s_waitcnt lgkmcnt(0)
uni_15:
  s_barrier
  ds_read_b32 v7, v6
  s_waitcnt lgkmcnt(0)
  v_readfirstlane_b32 s34, v7
  s_cmp_lg_u32 s34, 0
  s_cbranch_scc1 wp_bad
  s_cmp_lg_u32 s39, -1
  s_cbranch_scc1 wp_done
  s_mov_b32 s101, 0
  s_lshl_b32 s20, s101, 4
  s_lshr_b32 s21, s2, 3
  s_add_u32 s21, s21, s16
  s_and_b32 s21, s21, 3
  s_lshl_b32 s21, s21, 2
  s_add_u32 s20, s20, s21
  s_mul_i32 s21, s20, 14336
  s_add_u32 s21, s21, 655360
  s_add_u32 s22, s21, 0
  buffer_load_dwordx4 a[0:3], v2, s[8:11], s22 offen offset:0 sc1
  buffer_load_dwordx4 a[4:7], v2, s[8:11], s22 offen offset:1024 sc1
  buffer_load_dwordx4 a[8:11], v2, s[8:11], s22 offen offset:2048 sc1
  buffer_load_dwordx4 a[12:15], v2, s[8:11], s22 offen offset:3072 sc1
  s_add_u32 s22, s21, 4096
  buffer_load_dwordx4 a[16:19], v2, s[8:11], s22 offen offset:0 sc1
  buffer_load_dwordx4 a[20:23], v2, s[8:11], s22 offen offset:1024 sc1
  buffer_load_dwordx4 a[24:27], v2, s[8:11], s22 offen offset:2048 sc1
  buffer_load_dwordx4 a[28:31], v2, s[8:11], s22 offen offset:3072 sc1
  s_add_u32 s22, s21, 8192
  buffer_load_dwordx4 a[32:35], v2, s[8:11], s22 offen offset:0 sc1
  buffer_load_dwordx4 a[36:39], v2, s[8:11], s22 offen offset:1024 sc1
  buffer_load_dwordx4 a[40:43], v2, s[8:11], s22 offen offset:2048 sc1
  buffer_load_dwordx4 a[44:47], v2, s[8:11], s22 offen offset:3072 sc1
  s_add_u32 s22, s21, 12288
  buffer_load_dwordx4 a[48:51], v2, s[8:11], s22 offen offset:0 sc1
  buffer_load_dwordx4 a[52:55], v2, s[8:11], s22 offen offset:1024 sc1
  buffer_load_dwordx4 a[56:59], v2, s[8:11], s22 offen offset:2048 sc1
  buffer_load_dwordx4 a[60:63], v2, s[8:11], s22 offen offset:3072 sc1
  s_add_u32 s22, s21, 16384
  buffer_load_dwordx4 a[64:67], v2, s[8:11], s22 offen offset:0 sc1
  buffer_load_dwordx4 a[68:71], v2, s[8:11], s22 offen offset:1024 sc1
  buffer_load_dwordx4 a[72:75], v2, s[8:11], s22 offen offset:2048 sc1
  buffer_load_dwordx4 a[76:79], v2, s[8:11], s22 offen offset:3072 sc1
  s_add_u32 s22, s21, 20480
  buffer_load_dwordx4 a[80:83], v2, s[8:11], s22 offen offset:0 sc1
  buffer_load_dwordx4 a[84:87], v2, s[8:11], s22 offen offset:1024 sc1
  buffer_load_dwordx4 a[88:91], v2, s[8:11], s22 offen offset:2048 sc1
  buffer_load_dwordx4 a[92:95], v2, s[8:11], s22 offen offset:3072 sc1
  s_add_u32 s22, s21, 24576
  buffer_load_dwordx4 a[96:99], v2, s[8:11], s22 offen offset:0 sc1
  buffer_load_dwordx4 a[100:103], v2, s[8:11], s22 offen offset:1024 sc1
  buffer_load_dwordx4 a[104:107], v2, s[8:11], s22 offen offset:2048 sc1
  buffer_load_dwordx4 a[108:111], v2, s[8:11], s22 offen offset:3072 sc1
  s_add_u32 s22, s21, 28672
  buffer_load_dwordx4 a[112:115], v2, s[8:11], s22 offen offset:0 sc1
  buffer_load_dwordx4 a[116:119], v2, s[8:11], s22 offen offset:1024 sc1
  buffer_load_dwordx4 a[120:123], v2, s[8:11], s22 offen offset:2048 sc1
  buffer_load_dwordx4 a[124:127], v2, s[8:11], s22 offen offset:3072 sc1
  s_add_u32 s22, s21, 32768
  buffer_load_dwordx4 a[128:131], v2, s[8:11], s22 offen offset:0 sc1
  buffer_load_dwordx4 a[132:135], v2, s[8:11], s22 offen offset:1024 sc1
  buffer_load_dwordx4 a[136:139], v2, s[8:11], s22 offen offset:2048 sc1
  buffer_load_dwordx4 a[140:143], v2, s[8:11], s22 offen offset:3072 sc1
  s_add_u32 s22, s21, 36864
  buffer_load_dwordx4 a[144:147], v2, s[8:11], s22 offen offset:0 sc1
  buffer_load_dwordx4 a[148:151], v2, s[8:11], s22 offen offset:1024 sc1
  buffer_load_dwordx4 a[152:155], v2, s[8:11], s22 offen offset:2048 sc1
  buffer_load_dwordx4 a[156:159], v2, s[8:11], s22 offen offset:3072 sc1
  s_add_u32 s22, s21, 40960
  s_waitcnt vmcnt(40)
  buffer_load_dwordx4 a[160:163], v2, s[8:11], s22 offen offset:0 sc1
  buffer_load_dwordx4 a[164:167], v2, s[8:11], s22 offen offset:1024 sc1
  buffer_load_dwordx4 a[168:171], v2, s[8:11], s22 offen offset:2048 sc1
  buffer_load_dwordx4 a[172:175], v2, s[8:11], s22 offen offset:3072 sc1
  s_add_u32 s22, s21, 45056
  buffer_load_dwordx4 a[176:179], v2, s[8:11], s22 offen offset:0 sc1
  buffer_load_dwordx4 a[180:183], v2, s[8:11], s22 offen offset:1024 sc1
  buffer_load_dwordx4 a[184:187], v2, s[8:11], s22 offen offset:2048 sc1
  buffer_load_dwordx4 a[188:191], v2, s[8:11], s22 offen offset:3072 sc1
  s_add_u32 s22, s21, 49152
  buffer_load_dwordx4 a[192:195], v2, s[8:11], s22 offen offset:0 sc1
  buffer_load_dwordx4 a[196:199], v2, s[8:11], s22 offen offset:1024 sc1
  buffer_load_dwordx4 a[200:203], v2, s[8:11], s22 offen offset:2048 sc1
  buffer_load_dwordx4 a[204:207], v2, s[8:11], s22 offen offset:3072 sc1
  s_add_u32 s22, s21, 53248
  buffer_load_dwordx4 a[208:211], v2, s[8:11], s22 offen offset:0 sc1
  buffer_load_dwordx4 a[212:215], v2, s[8:11], s22 offen offset:1024 sc1
  buffer_load_dwordx4 a[216:219], v2, s[8:11], s22 offen offset:2048 sc1
  buffer_load_dwordx4 a[220:223], v2, s[8:11], s22 offen offset:3072 sc1
  s_mov_b32 s39, 0xffff0000
  s_branch wp_all
wp_bad:
  s_and_b32 s39, s39, 0xffff0000
  s_mov_b32 s97, 1
  s_cmp_eq_u32 s34, 1
  s_cbranch_scc1 wp_rep
  s_cmp_eq_u32 s34, 3
  s_cbranch_scc1 cA_abort
  s_load_dwordx8 s[40:47], s[0:1], 72
  s_load_dwordx4 s[48:51], s[0:1], 56
  s_waitcnt lgkmcnt(0)
  v_mov_b32 v4, 0x10001
  s_mov_b32 s18, 1
  s_branch ch_take
wp_rep:
  s_mov_b32 s101, -1
  s_load_dwordx8 s[40:47], s[0:1], 72
  s_load_dwordx4 s[48:51], s[0:1], 56
  s_waitcnt vmcnt(0) lgkmcnt(0)
  v_mov_b32 v4, 1
  v_mov_b32 v5, 20
  v_mov_b32 v6, 160000
  s_barrier
  s_cmp_lg_u32 s16, 0
  s_cbranch_scc1 wp_el1
  s_mov_b64 exec, 1
  buffer_atomic_add v4, v5, s[12:15], 0 offen sc0
  s_waitcnt vmcnt(0)
  ds_write_b32 v6, v4
  s_waitcnt lgkmcnt(0)
  s_mov_b64 exec, -1
wp_el1:
  s_barrier
  ds_read_b32 v4, v6
  s_waitcnt lgkmcnt(0)
  v_readfirstlane_b32 s33, v4
  v_and_b32 v1, 63, v0
  v_lshlrev_b32 v2, 4, v1
  v_lshrrev_b32 v3, 4, v1
  v_and_b32 v4, 15, v1
  v_lshrrev_b32 v5, 5, v1
  v_and_b32 v6, 31, v1
  v_xor_b32 v8, v6, v5
  v_lshlrev_b32 v8, 4, v8
  v_lshl_add_u32 v16, v5, 13, v8
  v_xor_b32 v17, 32, v16
  v_xor_b32 v18, 64, v16
  v_xor_b32 v19, 96, v16
  v_xor_b32 v20, 128, v16
  v_xor_b32 v21, 160, v16
  v_xor_b32 v22, 192, v16
  v_xor_b32 v23, 224, v16
  s_lshl_b32 s20, s16, 6
  v_xor_b32 v26, s20, v16
  v_xor_b32 v27, 32, v26
  s_and_b32 s33, s33, 511
  s_and_b32 s20, s33, 255
  s_cmp_ge_u32 s20, 224
  s_cselect_b32 s97, 1, 2
  s_cbranch_scc1 wp_all
  s_mul_i32 s17, s20, 4682
  s_lshr_b32 s17, s17, 16
  s_mul_i32 s23, s17, 14
  s_sub_u32 s19, s20, s23
  s_cmp_lt_u32 s19, 7
  s_cselect_b32 s18, 0, 7
  s_cselect_b32 s28, 0, 8
  s_sub_u32 s18, s19, s18
  s_add_u32 s28, s28, s16
  s_lshl_b32 s25, s16, 15
  s_add_u32 s25, s25, 32768
  s_lshl_b32 s26, s17, 9
  s_lshl_b32 s20, s17, 7
  s_lshr_b32 s21, s33, 8
  s_lshl_b32 s21, s21, 11
  s_add_u32 s20, s20, s21
  s_add_u32 s20, s20, 582144
  buffer_load_dword v5, off, s[8:11], s20 sc1
  s_waitcnt vmcnt(0)
  v_readfirstlane_b32 s34, v5
  v_mov_b32 v6, 160032
  s_nop 0
  v_mov_b32 v7, s34
  s_barrier
  s_cmp_lg_u32 s16, 0
  s_cbranch_scc1 uni_16
  ds_write_b32 v6, v7
  s_waitcnt lgkmcnt(0)
uni_16:
  s_barrier
  ds_read_b32 v7, v6
  s_waitcnt lgkmcnt(0)
  v_readfirstlane_b32 s34, v7
  s_cmp_lt_u32 s33, 256
  s_cselect_b32 s20, 0, 1935
  s_or_b32 s34, s34, s20
  s_bitcmp1_b32 s34, s19
  s_cbranch_scc1 wp_rep
  s_barrier
  s_cmp_lt_u32 s33, 256
  s_cbranch_scc1 wp_B
  s_branch wp_A0
wp_done:
  s_mov_b32 s97, s39
  s_cmp_lg_u32 s96, 0
  s_cbranch_scc1 wk_next
  s_cmp_lg_u32 s16, 0
  s_cbranch_scc1 ask_17
  v_mov_b32 v250, 1
  v_mov_b32 v251, 588288
  s_mov_b64 exec, 1
  buffer_atomic_add v250, v251, s[8:11], 0 offen sc0
  s_mov_b64 exec, -1
ask_17:
  s_branch wk_next
wk_loop:
  s_waitcnt vmcnt(0) lgkmcnt(0)
  s_getreg_b32 s22, hwreg(HW_REG_XCC_ID)
  s_and_b32 s22, s22, 15
  s_bitcmp0_b32 4, s22
  s_cbranch_scc1 wk_ni
  s_cmp_ge_u32 s96, 6
  s_cbranch_scc1 wk_ni
  s_mov_b32 s96, 6
  v_mov_b32 v4, 1
  v_mov_b32 v5, 587520
  v_mov_b32 v6, 160000
  s_barrier
  s_cmp_lg_u32 s16, 0
  s_cbranch_scc1 wk_ide1
  s_mov_b64 exec, 1
  buffer_atomic_add v4, v5, s[8:11], 0 offen sc0
  s_waitcnt vmcnt(0)
  ds_write_b32 v6, v4
  s_waitcnt lgkmcnt(0)
  s_mov_b64 exec, -1
wk_ide1:
  s_barrier
  ds_read_b32 v4, v6
  s_waitcnt lgkmcnt(0)
  v_readfirstlane_b32 s3, v4
  s_cmp_lt_u32 s3, 32
  s_cbranch_scc1 wk_done
wk_ni:
  s_getreg_b32 s22, hwreg(HW_REG_XCC_ID)
  s_and_b32 s22, s22, 15
  s_cmp_lg_u32 s22, 15
  s_cbranch_scc1 wk_ask
  s_cmp_eq_u32 s96, 7
  s_cbranch_scc0 wk_srv
wk_ask:
  v_readfirstlane_b32 s22, v250
  s_cmp_ge_u32 s22, 1264
  s_cbranch_scc1 wk_next
  s_cmp_lg_u32 s16, 0
  s_cbranch_scc1 ask_18
  v_mov_b32 v250, 1
  v_mov_b32 v251, 588288
  s_mov_b64 exec, 1
  buffer_atomic_add v250, v251, s[8:11], 0 offen sc0
  s_mov_b64 exec, -1
ask_18:
wk_next:
  v_mov_b32 v6, 160000
  s_waitcnt vmcnt(0)
  s_barrier
  s_cmp_lg_u32 s16, 0
  s_cbranch_scc1 wk_n1
  s_mov_b64 exec, 1
  ds_write_b32 v6, v250
  s_mov_b64 exec, -1
  s_waitcnt lgkmcnt(0)
wk_n1:
  s_barrier
  ds_read_b32 v4, v6
  s_waitcnt lgkmcnt(0)
  v_readfirstlane_b32 s3, v4
  s_cmp_ge_u32 s3, 1264
  s_cbranch_scc1 wk_done
  v_mov_b32 v250, 0
  v_mov_b32 v251, 587264
  s_cmp_lg_u32 s3, 1263
  s_cbranch_scc1 wk_nl
  v_mov_b32 v5, 1264
  s_mov_b64 exec, 1
  buffer_store_dword v5, v251, s[8:11], 0 offen sc1
  s_mov_b64 exec, -1
wk_nl:
  v_and_b32 v1, 63, v0
  v_lshlrev_b32 v2, 4, v1
  v_lshrrev_b32 v3, 4, v1
  v_and_b32 v4, 15, v1
  s_cmp_lt_u32 s3, 112
  s_cbranch_scc1 wk_n2
  s_cmp_eq_u32 s97, 0
  s_cbranch_scc1 wk_n2
  v_mov_b32 v250, s3
  s_mov_b32 s96, 1
  s_mov_b32 s97, 1
  s_mov_b32 s39, 0
  s_mov_b32 s37, 0
  s_mov_b32 s38, 0
  s_mov_b32 s32, 0
  s_branch wp_all
wk_n2:
  s_sub_u32 s20, s3, 288
  s_cmp_ge_u32 s20, 352
  s_cbranch_scc1 wk_nr
  s_cmp_ge_u32 s20, 320
  s_cbranch_scc1 wk_srv
  s_add_u32 s3, s3, 32
wk_nr:
  s_cmp_ge_u32 s3, 752
  s_cbranch_scc1 wk_tok
  s_cmp_ge_u32 s3, 640
  s_cbranch_scc1 wk_s4d
  s_cmp_ge_u32 s3, 448
  s_cbranch_scc1 wk_full
  s_cmp_ge_u32 s3, 320
  s_cbranch_scc1 wk_adef
  s_cmp_ge_u32 s3, 288
  s_cbranch_scc1 wk_srv
  s_and_b32 s17, s3, 15
  s_add_u32 s17, s17, 16
  s_cmp_ge_u32 s3, 224
  s_cbranch_scc1 wk_half
  s_cmp_ge_u32 s3, 112
  s_cselect_b32 s18, 1, 0
  s_cselect_b32 s20, 112, 0
  s_sub_u32 s34, s3, s20
  s_lshr_b32 s34, s34, 4
  s_lshl_b32 s34, s34, 1
  s_add_u32 s35, s34, 2
  s_branch wk_gemm
wk_adef:
  s_mov_b32 s101, -1
  s_load_dwordx8 s[40:47], s[0:1], 72
  s_sub_u32 s20, s3, 320
  s_getreg_b32 s33, hwreg(HW_REG_XCC_ID)
  s_sub_u32 s33, s33, 4
  s_and_b32 s33, s33, 7
  s_min_u32 s33, s33, 7
  s_mov_b32 s35, 7
wk_adc:
  s_lshl_b32 s34, s33, 7
  s_add_u32 s34, s34, 589312
  v_mov_b32 v4, 1
  v_mov_b32 v5, s34
  v_mov_b32 v6, 160000
  s_barrier
  s_cmp_lg_u32 s16, 0
  s_cbranch_scc1 wk_ade1
  s_mov_b64 exec, 1
  buffer_atomic_add v4, v5, s[8:11], 0 offen sc0
  s_waitcnt vmcnt(0)
  ds_write_b32 v6, v4
  s_waitcnt lgkmcnt(0)
  s_mov_b64 exec, -1
wk_ade1:
  s_barrier
  ds_read_b32 v4, v6
  s_waitcnt lgkmcnt(0)
  v_readfirstlane_b32 s20, v4
  s_cmp_lt_u32 s20, 16
  s_cbranch_scc1 wk_adg
  s_mov_b32 s33, s35
  s_sub_u32 s35, s35, 1
  s_max_i32 s35, s35, 0
  s_branch wk_adc
wk_adg:
  s_lshl_b32 s33, s33, 4
  s_add_u32 s20, s20, s33
  v_and_b32 v1, 63, v0
  v_lshlrev_b32 v2, 4, v1
  v_lshrrev_b32 v3, 4, v1
  v_and_b32 v4, 15, v1
  s_lshr_b32 s33, s20, 2
  s_mul_i32 s33, s33, 7
  s_and_b32 s20, s20, 3
  s_add_u32 s33, s33, s20
  s_mov_b32 s97, 3
  v_mov_b32 v252, 0x40000000
  v_cmp_eq_u32 vcc, 0, v0
  s_nop 1
  v_cndmask_b32 v252, v252, v0, vcc
  v_lshrrev_b32 v5, 5, v1
  v_and_b32 v6, 31, v1
  v_xor_b32 v8, v6, v5
  v_lshlrev_b32 v8, 4, v8
  v_lshl_add_u32 v16, v5, 13, v8
  v_xor_b32 v17, 32, v16
  v_xor_b32 v18, 64, v16
  v_xor_b32 v19, 96, v16
  v_xor_b32 v20, 128, v16
  v_xor_b32 v21, 160, v16
  v_xor_b32 v22, 192, v16
  v_xor_b32 v23, 224, v16
  s_lshl_b32 s20, s16, 6
  v_xor_b32 v26, s20, v16
  v_xor_b32 v27, 32, v26
  s_mul_i32 s17, s33, 4682
  s_lshr_b32 s17, s17, 16
  s_mul_i32 s23, s17, 14
  s_sub_u32 s19, s33, s23
  s_cmp_lt_u32 s19, 7
  s_cselect_b32 s18, 0, 7
  s_cselect_b32 s28, 0, 8
  s_sub_u32 s18, s19, s18
  s_add_u32 s28, s28, s16
  s_lshl_b32 s25, s16, 15
  s_add_u32 s25, s25, 32768
  s_lshl_b32 s26, s17, 9
  s_waitcnt lgkmcnt(0)
  s_barrier
  s_branch wp_A0
wk_adone:
  s_mov_b32 s97, 0
  s_branch wk_loop
wk_half:
  s_sub_u32 s20, s3, 224
  s_lshr_b32 s18, s20, 5
  s_add_u32 s18, s18, 2
  s_bitcmp1_b32 s20, 4
  s_cselect_b32 s34, 7, 0
  s_add_u32 s35, s34, 7
  s_branch wk_gemm
wk_full:
  s_sub_u32 s20, s3, 384
  s_and_b32 s17, s20, 15
  s_lshr_b32 s18, s20, 4
  s_mov_b32 s34, 0
  s_mov_b32 s35, 14
  s_cmp_lt_u32 s18, 8
  s_cselect_b32 s21, 16, 0
  s_add_u32 s17, s17, s21
  s_and_b32 s18, s18, 7
  s_cmp_ge_u32 s17, 16
  s_cbranch_scc1 wk_gemm
  s_getreg_b32 s33, hwreg(HW_REG_XCC_ID)
  s_sub_u32 s33, s33, 4
  s_and_b32 s33, s33, 7
  s_min_u32 s33, s33, 7
  s_mov_b32 s35, 7
wk_fxc:
  s_lshl_b32 s34, s33, 7
  s_add_u32 s34, s34, 565312
  v_mov_b32 v4, 1
  v_mov_b32 v5, s34
  v_mov_b32 v6, 160000
  s_barrier
  s_cmp_lg_u32 s16, 0
  s_cbranch_scc1 wk_fxe1
  s_mov_b64 exec, 1
  buffer_atomic_add v4, v5, s[8:11], 0 offen sc0
  s_waitcnt vmcnt(0)
  ds_write_b32 v6, v4
  s_waitcnt lgkmcnt(0)
  s_mov_b64 exec, -1
wk_fxe1:
  s_barrier
  ds_read_b32 v4, v6
  s_waitcnt lgkmcnt(0)
  v_readfirstlane_b32 s20, v4
  s_cmp_lt_u32 s20, 16
  s_cbranch_scc1 wk_fxg
  s_mov_b32 s33, s35
  s_sub_u32 s35, s35, 1
  s_max_i32 s35, s35, 0
  s_branch wk_fxc
wk_fxg:
  s_lshl_b32 s33, s33, 4
  s_add_u32 s20, s20, s33
  v_and_b32 v1, 63, v0
  v_lshlrev_b32 v2, 4, v1
  v_lshrrev_b32 v3, 4, v1
  v_and_b32 v4, 15, v1
  s_lshr_b32 s17, s20, 4
  s_lshl_b32 s17, s17, 1
  s_and_b32 s21, s20, 1
  s_add_u32 s17, s17, s21
  s_bfe_u32 s18, s20, 0x30001
  s_mov_b32 s34, 0
  s_mov_b32 s35, 14
  s_load_dwordx8 s[40:47], s[0:1], 0
  s_load_dwordx2 s[48:49], s[0:1], 32
  s_sub_u32 s21, s3, 512
  v_min_u32 v12, 111, v0
  v_lshlrev_b32 v12, 7, v12
  v_min_u32 v13, 13, v0
  v_lshlrev_b32 v13, 7, v13
  s_mul_i32 s22, s21, 14336
  s_mul_i32 s21, s21, 1792
  s_waitcnt lgkmcnt(0)
  s_cmp_ge_u32 s16, 2
  s_cbranch_scc1 wk_up
  s_mov_b32 s60, s40
  s_and_b32 s61, s41, 0xffff
  s_mov_b32 s62, 1835008
  s_mov_b32 s63, 0x20000
  buffer_load_dword v14, v12, s[60:63], s22 offen
  s_mov_b32 s60, s42
  s_and_b32 s61, s43, 0xffff
  s_mov_b32 s62, 229376
  s_mov_b32 s63, 0x20000
  buffer_load_dword v14, v13, s[60:63], s21 offen
  s_mov_b32 s60, s44
  s_and_b32 s61, s45, 0xffff
  s_mov_b32 s62, 229376
  s_mov_b32 s63, 0x20000
  buffer_load_dword v14, v13, s[60:63], s21 offen
  s_mov_b32 s60, s46
  s_and_b32 s61, s47, 0xffff
  s_mov_b32 s62, 229376
  s_mov_b32 s63, 0x20000
  buffer_load_dword v14, v13, s[60:63], s21 offen
  s_mov_b32 s60, s48
  s_and_b32 s61, s49, 0xffff
  s_mov_b32 s62, 229376
  s_mov_b32 s63, 0x20000
  buffer_load_dword v14, v13, s[60:63], s21 offen
wk_up:
  s_lshl_b32 s27, s17, 7
  s_add_u32 s27, s27, 584192
  s_mov_b32 s28, 16383
  s_mov_b32 s30, 0
wk_aw:
  buffer_load_dword v9, off, s[8:11], s27  sc1
  s_waitcnt vmcnt(0)
  v_and_b32 v10, s28, v9
  v_cmp_ne_u32 vcc, s28, v10
  s_cbranch_vccz wk_aw_ok
  s_sleep 3
  s_add_u32 s30, s30, 1
  s_cmp_lt_u32 s30, 400000
  s_cbranch_scc1 wk_aw
  s_branch cA_abort
wk_aw_ok:
wk_gemm:
  s_lshl_b32 s20, s18, 4
  s_lshr_b32 s21, s2, 3
  s_add_u32 s21, s21, s16
  s_and_b32 s21, s21, 3
  s_lshl_b32 s21, s21, 2
  s_add_u32 s20, s20, s21
  s_mul_i32 s21, s20, 14336
  s_add_u32 s21, s21, 655360
  s_mul_i32 s23, s17, 401408
  s_and_b32 s22, s16, 1
  s_mul_i32 s22, s22, 7168
  s_add_u32 s23, s23, s22
  s_add_u32 s23, s23, 33554432
  s_lshr_b32 s22, s16, 1
  s_mul_i32 s22, s22, 14336
  s_add_u32 s23, s23, s22
  s_mul_i32 s27, s16, 7168
  s_lshr_b32 s28, s20, 1
  s_cmp_lt_u32 s17, 16
  s_cbranch_scc0 wg_vo
  s_add_u32 s23, s23, s22
  s_lshl_b32 s29, s28, 4
  s_add_u32 s29, s29, s17
  s_mul_i32 s29, s29, 28672
  s_add_u32 s29, s29, 46399488
  s_mov_b32 s31, 0
  s_lshr_b32 s24, s34, 1
  s_lshl_b32 s24, s24, 2
  s_and_b32 s25, s34, 1
  s_add_u32 s24, s24, s25
  s_mul_i32 s24, s24, 14336
  s_add_u32 s24, s24, s23
  s_add_u32 m0, s31, s27
  s_nop 0
  buffer_load_dwordx4 v2, s[8:11], s24 offen offset:0 sc1 lds
  buffer_load_dwordx4 v2, s[8:11], s24 offen offset:1024 sc1 lds
  buffer_load_dwordx4 v2, s[8:11], s24 offen offset:2048 sc1 lds
  buffer_load_dwordx4 v2, s[8:11], s24 offen offset:3072 sc1 lds
  s_add_u32 m0, m0, 4096
  s_add_u32 s24, s24, 4096
  buffer_load_dwordx4 v2, s[8:11], s24 offen offset:0 sc1 lds
  buffer_load_dwordx4 v2, s[8:11], s24 offen offset:1024 sc1 lds
  buffer_load_dwordx4 v2, s[8:11], s24 offen offset:2048 sc1 lds
  s_sub_u32 s36, s35, 1
  s_add_u32 s30, s34, 1
  s_min_u32 s30, s30, s36
  s_mov_b32 s31, 28672
  s_lshr_b32 s24, s30, 1
  s_lshl_b32 s24, s24, 2
  s_and_b32 s25, s30, 1
  s_add_u32 s24, s24, s25
  s_mul_i32 s24, s24, 14336
  s_add_u32 s24, s24, s23
  s_add_u32 m0, s31, s27
  s_nop 0
  buffer_load_dwordx4 v2, s[8:11], s24 offen offset:0 sc1 lds
  buffer_load_dwordx4 v2, s[8:11], s24 offen offset:1024 sc1 lds
  buffer_load_dwordx4 v2, s[8:11], s24 offen offset:2048 sc1 lds
  buffer_load_dwordx4 v2, s[8:11], s24 offen offset:3072 sc1 lds
  s_add_u32 m0, m0, 4096
  s_add_u32 s24, s24, 4096
  buffer_load_dwordx4 v2, s[8:11], s24 offen offset:0 sc1 lds
  buffer_load_dwordx4 v2, s[8:11], s24 offen offset:1024 sc1 lds
  buffer_load_dwordx4 v2, s[8:11], s24 offen offset:2048 sc1 lds
  s_mov_b32 s19, s34
  s_mov_b32 s32, 0
  s_mov_b32 s33, 57344
  s_cmp_eq_u32 s18, s101
  s_cbranch_scc1 wg_f_hx
  s_add_u32 s22, s21, 0
  buffer_load_dwordx4 a[0:3], v2, s[8:11], s22 offen offset:0 sc1
  buffer_load_dwordx4 a[4:7], v2, s[8:11], s22 offen offset:1024 sc1
  buffer_load_dwordx4 a[8:11], v2, s[8:11], s22 offen offset:2048 sc1
  buffer_load_dwordx4 a[12:15], v2, s[8:11], s22 offen offset:3072 sc1
  s_add_u32 s22, s21, 4096
  buffer_load_dwordx4 a[16:19], v2, s[8:11], s22 offen offset:0 sc1
  buffer_load_dwordx4 a[20:23], v2, s[8:11], s22 offen offset:1024 sc1
  buffer_load_dwordx4 a[24:27], v2, s[8:11], s22 offen offset:2048 sc1
  buffer_load_dwordx4 a[28:31], v2, s[8:11], s22 offen offset:3072 sc1
  s_add_u32 s22, s21, 8192
  buffer_load_dwordx4 a[32:35], v2, s[8:11], s22 offen offset:0 sc1
  buffer_load_dwordx4 a[36:39], v2, s[8:11], s22 offen offset:1024 sc1
  buffer_load_dwordx4 a[40:43], v2, s[8:11], s22 offen offset:2048 sc1
  buffer_load_dwordx4 a[44:47], v2, s[8:11], s22 offen offset:3072 sc1
  s_add_u32 s22, s21, 12288
  buffer_load_dwordx4 a[48:51], v2, s[8:11], s22 offen offset:0 sc1
  buffer_load_dwordx4 a[52:55], v2, s[8:11], s22 offen offset:1024 sc1
  buffer_load_dwordx4 a[56:59], v2, s[8:11], s22 offen offset:2048 sc1
  buffer_load_dwordx4 a[60:63], v2, s[8:11], s22 offen offset:3072 sc1
  s_add_u32 s22, s21, 16384
  buffer_load_dwordx4 a[64:67], v2, s[8:11], s22 offen offset:0 sc1
  buffer_load_dwordx4 a[68:71], v2, s[8:11], s22 offen offset:1024 sc1
  buffer_load_dwordx4 a[72:75], v2, s[8:11], s22 offen offset:2048 sc1
  buffer_load_dwordx4 a[76:79], v2, s[8:11], s22 offen offset:3072 sc1
  s_add_u32 s22, s21, 20480
  buffer_load_dwordx4 a[80:83], v2, s[8:11], s22 offen offset:0 sc1
  buffer_load_dwordx4 a[84:87], v2, s[8:11], s22 offen offset:1024 sc1
  buffer_load_dwordx4 a[88:91], v2, s[8:11], s22 offen offset:2048 sc1
  buffer_load_dwordx4 a[92:95], v2, s[8:11], s22 offen offset:3072 sc1
  s_add_u32 s22, s21, 24576
  buffer_load_dwordx4 a[96:99], v2, s[8:11], s22 offen offset:0 sc1
  buffer_load_dwordx4 a[100:103], v2, s[8:11], s22 offen offset:1024 sc1
  buffer_load_dwordx4 a[104:107], v2, s[8:11], s22 offen offset:2048 sc1
  buffer_load_dwordx4 a[108:111], v2, s[8:11], s22 offen offset:3072 sc1
  s_add_u32 s22, s21, 28672
  buffer_load_dwordx4 a[112:115], v2, s[8:11], s22 offen offset:0 sc1
  buffer_load_dwordx4 a[116:119], v2, s[8:11], s22 offen offset:1024 sc1
  buffer_load_dwordx4 a[120:123], v2, s[8:11], s22 offen offset:2048 sc1
  buffer_load_dwordx4 a[124:127], v2, s[8:11], s22 offen offset:3072 sc1
  s_add_u32 s22, s21, 32768
  buffer_load_dwordx4 a[128:131], v2, s[8:11], s22 offen offset:0 sc1
  buffer_load_dwordx4 a[132:135], v2, s[8:11], s22 offen offset:1024 sc1
  buffer_load_dwordx4 a[136:139], v2, s[8:11], s22 offen offset:2048 sc1
  buffer_load_dwordx4 a[140:143], v2, s[8:11], s22 offen offset:3072 sc1
  s_add_u32 s22, s21, 36864
  buffer_load_dwordx4 a[144:147], v2, s[8:11], s22 offen offset:0 sc1
  buffer_load_dwordx4 a[148:151], v2, s[8:11], s22 offen offset:1024 sc1
  buffer_load_dwordx4 a[152:155], v2, s[8:11], s22 offen offset:2048 sc1
  buffer_load_dwordx4 a[156:159], v2, s[8:11], s22 offen offset:3072 sc1
  s_add_u32 s22, s21, 40960
  s_waitcnt vmcnt(40)
  buffer_load_dwordx4 a[160:163], v2, s[8:11], s22 offen offset:0 sc1
  buffer_load_dwordx4 a[164:167], v2, s[8:11], s22 offen offset:1024 sc1
  buffer_load_dwordx4 a[168:171], v2, s[8:11], s22 offen offset:2048 sc1
  buffer_load_dwordx4 a[172:175], v2, s[8:11], s22 offen offset:3072 sc1
  s_add_u32 s22, s21, 45056
  buffer_load_dwordx4 a[176:179], v2, s[8:11], s22 offen offset:0 sc1
  buffer_load_dwordx4 a[180:183], v2, s[8:11], s22 offen offset:1024 sc1
  buffer_load_dwordx4 a[184:187], v2, s[8:11], s22 offen offset:2048 sc1
  buffer_load_dwordx4 a[188:191], v2, s[8:11], s22 offen offset:3072 sc1
  s_add_u32 s22, s21, 49152
  buffer_load_dwordx4 a[192:195], v2, s[8:11], s22 offen offset:0 sc1
  buffer_load_dwordx4 a[196:199], v2, s[8:11], s22 offen offset:1024 sc1
  buffer_load_dwordx4 a[200:203], v2, s[8:11], s22 offen offset:2048 sc1
  buffer_load_dwordx4 a[204:207], v2, s[8:11], s22 offen offset:3072 sc1
  s_add_u32 s22, s21, 53248
  buffer_load_dwordx4 a[208:211], v2, s[8:11], s22 offen offset:0 sc1
  buffer_load_dwordx4 a[212:215], v2, s[8:11], s22 offen offset:1024 sc1
  buffer_load_dwordx4 a[216:219], v2, s[8:11], s22 offen offset:2048 sc1
  buffer_load_dwordx4 a[220:223], v2, s[8:11], s22 offen offset:3072 sc1
wg_f_hx:
  s_mov_b32 s101, -1
  s_waitcnt vmcnt(0)
  s_barrier
  s_mov_b32 s40, 0
  s_mov_b32 s41, 0x40000000
  v_mov_b32 v5, v2
  ds_read_b128 v[8:11], v5 offset:0
  ds_read_b128 v[12:15], v5 offset:14336
  ds_read_b128 v[16:19], v5 offset:1024
  ds_read_b128 v[20:23], v5 offset:15360
  ds_read_b128 v[24:27], v5 offset:2048
  s_waitcnt lgkmcnt(4)
.p2align 6
wg_f_loop:
  v_mfma_f32_16x16x32_bf16 v[40:43], v[8:11], a[0:3], 0
  ds_read_b128 v[28:31], v5 offset:16384
  v_mfma_f32_16x16x32_bf16 v[44:47], v[8:11], a[56:59], 0
  v_mfma_f32_16x16x32_bf16 v[48:51], v[8:11], a[112:115], 0
  v_mfma_f32_16x16x32_bf16 v[52:55], v[8:11], a[168:171], 0
  s_waitcnt lgkmcnt(4)
  s_lshl_b32 s42, s40, 10
  v_mfma_f32_16x16x32_bf16 v[56:59], v[12:15], a[0:3], 0
  ds_read_b128 v[32:35], v5 offset:3072
  v_mfma_f32_16x16x32_bf16 v[60:63], v[12:15], a[56:59], 0
  s_add_u32 s42, s42, s41
  v_cvt_pk_bf16_f32 v72, v96, v97
  v_mfma_f32_16x16x32_bf16 v[64:67], v[12:15], a[112:115], 0
  v_cvt_pk_bf16_f32 v73, v98, v99
  v_cvt_pk_bf16_f32 v74, v112, v113
  v_mfma_f32_16x16x32_bf16 v[68:71], v[12:15], a[168:171], 0
  s_waitcnt lgkmcnt(4)
  v_cvt_pk_bf16_f32 v75, v114, v115
  v_mfma_f32_16x16x32_bf16 v[40:43], v[16:19], a[4:7], v[40:43]
  ds_read_b128 v[8:11], v5 offset:17408
  v_mfma_f32_16x16x32_bf16 v[44:47], v[16:19], a[60:63], v[44:47]
  s_add_u32 s43, s42, 0
  v_mfma_f32_16x16x32_bf16 v[48:51], v[16:19], a[116:119], v[48:51]
  buffer_store_dwordx4 v[72:75], v2, s[8:11], s43 offen sc1
  v_cvt_pk_bf16_f32 v76, v100, v101
  v_mfma_f32_16x16x32_bf16 v[52:55], v[16:19], a[172:175], v[52:55]
  s_waitcnt lgkmcnt(4)
  v_cvt_pk_bf16_f32 v77, v102, v103
  v_mfma_f32_16x16x32_bf16 v[56:59], v[20:23], a[4:7], v[56:59]
  ds_read_b128 v[12:15], v5 offset:4096
  v_mfma_f32_16x16x32_bf16 v[60:63], v[20:23], a[60:63], v[60:63]
  v_cvt_pk_bf16_f32 v78, v116, v117
  v_cvt_pk_bf16_f32 v79, v118, v119
  v_mfma_f32_16x16x32_bf16 v[64:67], v[20:23], a[116:119], v[64:67]
  s_add_u32 s43, s42, 14336
  v_mfma_f32_16x16x32_bf16 v[68:71], v[20:23], a[172:175], v[68:71]
  s_waitcnt lgkmcnt(4)
  buffer_store_dwordx4 v[76:79], v2, s[8:11], s43 offen sc1
  v_mfma_f32_16x16x32_bf16 v[40:43], v[24:27], a[8:11], v[40:43]
  ds_read_b128 v[16:19], v5 offset:18432
  v_mfma_f32_16x16x32_bf16 v[44:47], v[24:27], a[64:67], v[44:47]
  v_cvt_pk_bf16_f32 v80, v104, v105
  v_cvt_pk_bf16_f32 v81, v106, v107
  v_mfma_f32_16x16x32_bf16 v[48:51], v[24:27], a[120:123], v[48:51]
  v_cvt_pk_bf16_f32 v82, v120, v121
  v_cvt_pk_bf16_f32 v83, v122, v123
  v_mfma_f32_16x16x32_bf16 v[52:55], v[24:27], a[176:179], v[52:55]
  s_waitcnt lgkmcnt(4)
  s_add_u32 s43, s42, 458752
  v_mfma_f32_16x16x32_bf16 v[56:59], v[28:31], a[8:11], v[56:59]
  ds_read_b128 v[20:23], v5 offset:5120
  v_mfma_f32_16x16x32_bf16 v[60:63], v[28:31], a[64:67], v[60:63]
  buffer_store_dwordx4 v[80:83], v2, s[8:11], s43 offen sc1
  v_cvt_pk_bf16_f32 v84, v108, v109
  v_mfma_f32_16x16x32_bf16 v[64:67], v[28:31], a[120:123], v[64:67]
  v_cvt_pk_bf16_f32 v85, v110, v111
  v_cvt_pk_bf16_f32 v86, v124, v125
  v_mfma_f32_16x16x32_bf16 v[68:71], v[28:31], a[176:179], v[68:71]
  s_waitcnt lgkmcnt(4)
  v_cvt_pk_bf16_f32 v87, v126, v127
  v_mfma_f32_16x16x32_bf16 v[40:43], v[32:35], a[12:15], v[40:43]
  ds_read_b128 v[24:27], v5 offset:19456
  v_mfma_f32_16x16x32_bf16 v[44:47], v[32:35], a[68:71], v[44:47]
  s_add_u32 s43, s42, 473088
  v_mfma_f32_16x16x32_bf16 v[48:51], v[32:35], a[124:127], v[48:51]
  buffer_store_dwordx4 v[84:87], v2, s[8:11], s43 offen sc1
  v_mfma_f32_16x16x32_bf16 v[52:55], v[32:35], a[180:183], v[52:55]
  s_waitcnt lgkmcnt(4)
  s_add_u32 s30, s19, 2
  s_lshr_b32 s24, s30, 1
  s_lshl_b32 s24, s24, 2
  s_and_b32 s25, s30, 1
  s_add_u32 s24, s24, s25
  s_mul_i32 s24, s24, 14336
  v_mfma_f32_16x16x32_bf16 v[56:59], v[8:11], a[12:15], v[56:59]
  ds_read_b128 v[28:31], v5 offset:6144
  v_mfma_f32_16x16x32_bf16 v[60:63], v[8:11], a[68:71], v[60:63]
  s_add_u32 s24, s24, s23
  s_cmp_lt_u32 s30, s35
  s_cselect_b32 s24, s24, 0x40000000
  v_mfma_f32_16x16x32_bf16 v[64:67], v[8:11], a[124:127], v[64:67]
  s_add_u32 m0, s33, s27
  s_nop 0
  buffer_load_dwordx4 v2, s[8:11], s24 offen offset:0 sc1 lds
  v_mfma_f32_16x16x32_bf16 v[68:71], v[8:11], a[180:183], v[68:71]
  s_waitcnt lgkmcnt(4)
  v_mfma_f32_16x16x32_bf16 v[40:43], v[12:15], a[16:19], v[40:43]
  ds_read_b128 v[32:35], v5 offset:20480
  v_mfma_f32_16x16x32_bf16 v[44:47], v[12:15], a[72:75], v[44:47]
  v_mfma_f32_16x16x32_bf16 v[48:51], v[12:15], a[128:131], v[48:51]
  v_mfma_f32_16x16x32_bf16 v[52:55], v[12:15], a[184:187], v[52:55]
  s_waitcnt lgkmcnt(4)
  buffer_load_dwordx4 v2, s[8:11], s24 offen offset:1024 sc1 lds
  v_mfma_f32_16x16x32_bf16 v[56:59], v[16:19], a[16:19], v[56:59]
  ds_read_b128 v[8:11], v5 offset:7168
  v_mfma_f32_16x16x32_bf16 v[60:63], v[16:19], a[72:75], v[60:63]
  v_mfma_f32_16x16x32_bf16 v[64:67], v[16:19], a[128:131], v[64:67]
  v_mfma_f32_16x16x32_bf16 v[68:71], v[16:19], a[184:187], v[68:71]
  s_waitcnt lgkmcnt(4)
  v_mfma_f32_16x16x32_bf16 v[40:43], v[20:23], a[20:23], v[40:43]
  ds_read_b128 v[12:15], v5 offset:21504
  v_mfma_f32_16x16x32_bf16 v[44:47], v[20:23], a[76:79], v[44:47]
  buffer_load_dwordx4 v2, s[8:11], s24 offen offset:2048 sc1 lds
  v_mfma_f32_16x16x32_bf16 v[48:51], v[20:23], a[132:135], v[48:51]
  v_mfma_f32_16x16x32_bf16 v[52:55], v[20:23], a[188:191], v[52:55]
  s_waitcnt lgkmcnt(4)
  v_mfma_f32_16x16x32_bf16 v[56:59], v[24:27], a[20:23], v[56:59]
  ds_read_b128 v[16:19], v5 offset:8192
  v_mfma_f32_16x16x32_bf16 v[60:63], v[24:27], a[76:79], v[60:63]
  v_mfma_f32_16x16x32_bf16 v[64:67], v[24:27], a[132:135], v[64:67]
  buffer_load_dwordx4 v2, s[8:11], s24 offen offset:3072 sc1 lds
  v_mfma_f32_16x16x32_bf16 v[68:71], v[24:27], a[188:191], v[68:71]
  s_waitcnt lgkmcnt(4)
  v_mfma_f32_16x16x32_bf16 v[40:43], v[28:31], a[24:27], v[40:43]
  ds_read_b128 v[20:23], v5 offset:22528
  v_mfma_f32_16x16x32_bf16 v[44:47], v[28:31], a[80:83], v[44:47]
  v_mfma_f32_16x16x32_bf16 v[48:51], v[28:31], a[136:139], v[48:51]
  v_mfma_f32_16x16x32_bf16 v[52:55], v[28:31], a[192:195], v[52:55]
  s_waitcnt lgkmcnt(4)
  s_add_u32 m0, m0, 4096
  s_add_u32 s24, s24, 4096
  buffer_load_dwordx4 v2, s[8:11], s24 offen offset:0 sc1 lds
  v_mfma_f32_16x16x32_bf16 v[56:59], v[32:35], a[24:27], v[56:59]
  ds_read_b128 v[24:27], v5 offset:9216
  v_mfma_f32_16x16x32_bf16 v[60:63], v[32:35], a[80:83], v[60:63]
  v_mfma_f32_16x16x32_bf16 v[64:67], v[32:35], a[136:139], v[64:67]
  v_mfma_f32_16x16x32_bf16 v[68:71], v[32:35], a[192:195], v[68:71]
  s_waitcnt lgkmcnt(4)
  v_mfma_f32_16x16x32_bf16 v[40:43], v[8:11], a[28:31], v[40:43]
  ds_read_b128 v[28:31], v5 offset:23552
  v_mfma_f32_16x16x32_bf16 v[44:47], v[8:11], a[84:87], v[44:47]
  buffer_load_dwordx4 v2, s[8:11], s24 offen offset:1024 sc1 lds
  v_mfma_f32_16x16x32_bf16 v[48:51], v[8:11], a[140:143], v[48:51]
  v_mfma_f32_16x16x32_bf16 v[52:55], v[8:11], a[196:199], v[52:55]
  s_waitcnt lgkmcnt(4)
  v_mfma_f32_16x16x32_bf16 v[56:59], v[12:15], a[28:31], v[56:59]
  ds_read_b128 v[32:35], v5 offset:10240
  v_mfma_f32_16x16x32_bf16 v[60:63], v[12:15], a[84:87], v[60:63]
  v_mfma_f32_16x16x32_bf16 v[64:67], v[12:15], a[140:143], v[64:67]
  buffer_load_dwordx4 v2, s[8:11], s24 offen offset:2048 sc1 lds
  v_mfma_f32_16x16x32_bf16 v[68:71], v[12:15], a[196:199], v[68:71]
  s_waitcnt lgkmcnt(4)
  v_mfma_f32_16x16x32_bf16 v[40:43], v[16:19], a[32:35], v[40:43]
  ds_read_b128 v[8:11], v5 offset:24576
  v_mfma_f32_16x16x32_bf16 v[44:47], v[16:19], a[88:91], v[44:47]
  v_mfma_f32_16x16x32_bf16 v[48:51], v[16:19], a[144:147], v[48:51]
  v_mfma_f32_16x16x32_bf16 v[52:55], v[16:19], a[200:203], v[52:55]
  s_waitcnt lgkmcnt(4)
  s_add_u32 s33, s33, 28672
  s_cmp_eq_u32 s33, 114688
  s_cselect_b32 s33, 0, s33
  v_mfma_f32_16x16x32_bf16 v[56:59], v[20:23], a[32:35], v[56:59]
  ds_read_b128 v[12:15], v5 offset:11264
  v_mfma_f32_16x16x32_bf16 v[60:63], v[20:23], a[88:91], v[60:63]
  s_add_u32 s32, s32, 28672
  s_cmp_eq_u32 s32, 114688
  s_cselect_b32 s32, 0, s32
  v_mfma_f32_16x16x32_bf16 v[64:67], v[20:23], a[144:147], v[64:67]
  v_add_u32 v128, s32, v2
  v_mfma_f32_16x16x32_bf16 v[68:71], v[20:23], a[200:203], v[68:71]
  s_waitcnt lgkmcnt(4)
  v_mfma_f32_16x16x32_bf16 v[40:43], v[24:27], a[36:39], v[40:43]
  ds_read_b128 v[16:19], v5 offset:25600
  v_mfma_f32_16x16x32_bf16 v[44:47], v[24:27], a[92:95], v[44:47]
  v_mfma_f32_16x16x32_bf16 v[48:51], v[24:27], a[148:151], v[48:51]
  v_mfma_f32_16x16x32_bf16 v[52:55], v[24:27], a[204:207], v[52:55]
  s_waitcnt lgkmcnt(4)
  v_mfma_f32_16x16x32_bf16 v[56:59], v[28:31], a[36:39], v[56:59]
  ds_read_b128 v[20:23], v5 offset:12288
  v_mfma_f32_16x16x32_bf16 v[60:63], v[28:31], a[92:95], v[60:63]
  v_mfma_f32_16x16x32_bf16 v[64:67], v[28:31], a[148:151], v[64:67]
  v_mfma_f32_16x16x32_bf16 v[68:71], v[28:31], a[204:207], v[68:71]
  s_waitcnt lgkmcnt(4)
  v_mfma_f32_16x16x32_bf16 v[40:43], v[32:35], a[40:43], v[40:43]
  ds_read_b128 v[24:27], v5 offset:26624
  v_mfma_f32_16x16x32_bf16 v[44:47], v[32:35], a[96:99], v[44:47]
  v_mfma_f32_16x16x32_bf16 v[48:51], v[32:35], a[152:155], v[48:51]
  v_mfma_f32_16x16x32_bf16 v[52:55], v[32:35], a[208:211], v[52:55]
  s_waitcnt lgkmcnt(4)
  v_mfma_f32_16x16x32_bf16 v[56:59], v[8:11], a[40:43], v[56:59]
  ds_read_b128 v[28:31], v5 offset:13312
  v_mfma_f32_16x16x32_bf16 v[60:63], v[8:11], a[96:99], v[60:63]
  v_mfma_f32_16x16x32_bf16 v[64:67], v[8:11], a[152:155], v[64:67]
  v_mfma_f32_16x16x32_bf16 v[68:71], v[8:11], a[208:211], v[68:71]
  s_waitcnt lgkmcnt(4)
  v_mfma_f32_16x16x32_bf16 v[40:43], v[12:15], a[44:47], v[40:43]
  ds_read_b128 v[32:35], v5 offset:27648
  v_mfma_f32_16x16x32_bf16 v[44:47], v[12:15], a[100:103], v[44:47]
  v_mfma_f32_16x16x32_bf16 v[48:51], v[12:15], a[156:159], v[48:51]
  v_mfma_f32_16x16x32_bf16 v[52:55], v[12:15], a[212:215], v[52:55]
  s_waitcnt lgkmcnt(4)
  v_mfma_f32_16x16x32_bf16 v[56:59], v[16:19], a[44:47], v[56:59]
  s_waitcnt vmcnt(11)
  s_barrier
  ds_read_b128 v[8:11], v128 offset:0
  v_mfma_f32_16x16x32_bf16 v[60:63], v[16:19], a[100:103], v[60:63]
  v_mfma_f32_16x16x32_bf16 v[64:67], v[16:19], a[156:159], v[64:67]
  v_mfma_f32_16x16x32_bf16 v[68:71], v[16:19], a[212:215], v[68:71]
  s_waitcnt lgkmcnt(4)
  v_mfma_f32_16x16x32_bf16 v[40:43], v[20:23], a[48:51], v[40:43]
  ds_read_b128 v[12:15], v128 offset:14336
  v_mfma_f32_16x16x32_bf16 v[44:47], v[20:23], a[104:107], v[44:47]
  v_mfma_f32_16x16x32_bf16 v[48:51], v[20:23], a[160:163], v[48:51]
  v_mfma_f32_16x16x32_bf16 v[52:55], v[20:23], a[216:219], v[52:55]
  s_waitcnt lgkmcnt(4)
  v_mfma_f32_16x16x32_bf16 v[56:59], v[24:27], a[48:51], v[56:59]
  ds_read_b128 v[16:19], v128 offset:1024
  v_mfma_f32_16x16x32_bf16 v[60:63], v[24:27], a[104:107], v[60:63]
  v_mfma_f32_16x16x32_bf16 v[64:67], v[24:27], a[160:163], v[64:67]
  v_mfma_f32_16x16x32_bf16 v[68:71], v[24:27], a[216:219], v[68:71]
  s_waitcnt lgkmcnt(4)
  v_mfma_f32_16x16x32_bf16 v[40:43], v[28:31], a[52:55], v[40:43]
  ds_read_b128 v[20:23], v128 offset:15360
  v_mfma_f32_16x16x32_bf16 v[44:47], v[28:31], a[108:111], v[44:47]
  v_mfma_f32_16x16x32_bf16 v[48:51], v[28:31], a[164:167], v[48:51]
  v_mfma_f32_16x16x32_bf16 v[52:55], v[28:31], a[220:223], v[52:55]
  s_waitcnt lgkmcnt(4)
  v_mfma_f32_16x16x32_bf16 v[56:59], v[32:35], a[52:55], v[56:59]
  ds_read_b128 v[24:27], v128 offset:2048
  v_mfma_f32_16x16x32_bf16 v[60:63], v[32:35], a[108:111], v[60:63]
  v_mfma_f32_16x16x32_bf16 v[64:67], v[32:35], a[164:167], v[64:67]
  v_mfma_f32_16x16x32_bf16 v[68:71], v[32:35], a[220:223], v[68:71]
  s_waitcnt lgkmcnt(4)
  s_mov_b32 s40, s19
  s_mov_b32 s41, s29
  s_add_u32 s19, s19, 1
  s_cmp_lt_u32 s19, s35
  s_cbranch_scc0 wg_f_e0
  v_mfma_f32_16x16x32_bf16 v[96:99], v[8:11], a[0:3], 0
  ds_read_b128 v[28:31], v128 offset:16384
  v_mfma_f32_16x16x32_bf16 v[100:103], v[8:11], a[56:59], 0
  v_mfma_f32_16x16x32_bf16 v[104:107], v[8:11], a[112:115], 0
  v_mfma_f32_16x16x32_bf16 v[108:111], v[8:11], a[168:171], 0
  s_waitcnt lgkmcnt(4)
  s_lshl_b32 s42, s40, 10
  v_mfma_f32_16x16x32_bf16 v[112:115], v[12:15], a[0:3], 0
  ds_read_b128 v[32:35], v128 offset:3072
  v_mfma_f32_16x16x32_bf16 v[116:119], v[12:15], a[56:59], 0
  s_add_u32 s42, s42, s41
  v_cvt_pk_bf16_f32 v72, v40, v41
  v_mfma_f32_16x16x32_bf16 v[120:123], v[12:15], a[112:115], 0
  v_cvt_pk_bf16_f32 v73, v42, v43
  v_cvt_pk_bf16_f32 v74, v56, v57
  v_mfma_f32_16x16x32_bf16 v[124:127], v[12:15], a[168:171], 0
  s_waitcnt lgkmcnt(4)
  v_cvt_pk_bf16_f32 v75, v58, v59
  v_mfma_f32_16x16x32_bf16 v[96:99], v[16:19], a[4:7], v[96:99]
  ds_read_b128 v[8:11], v128 offset:17408
  v_mfma_f32_16x16x32_bf16 v[100:103], v[16:19], a[60:63], v[100:103]
  s_add_u32 s43, s42, 0
  v_mfma_f32_16x16x32_bf16 v[104:107], v[16:19], a[116:119], v[104:107]
  buffer_store_dwordx4 v[72:75], v2, s[8:11], s43 offen sc1
  v_cvt_pk_bf16_f32 v76, v44, v45
  v_mfma_f32_16x16x32_bf16 v[108:111], v[16:19], a[172:175], v[108:111]
  s_waitcnt lgkmcnt(4)
  v_cvt_pk_bf16_f32 v77, v46, v47
  v_mfma_f32_16x16x32_bf16 v[112:115], v[20:23], a[4:7], v[112:115]
  ds_read_b128 v[12:15], v128 offset:4096
  v_mfma_f32_16x16x32_bf16 v[116:119], v[20:23], a[60:63], v[116:119]
  v_cvt_pk_bf16_f32 v78, v60, v61
  v_cvt_pk_bf16_f32 v79, v62, v63
  v_mfma_f32_16x16x32_bf16 v[120:123], v[20:23], a[116:119], v[120:123]
  s_add_u32 s43, s42, 14336
  v_mfma_f32_16x16x32_bf16 v[124:127], v[20:23], a[172:175], v[124:127]
  s_waitcnt lgkmcnt(4)
  buffer_store_dwordx4 v[76:79], v2, s[8:11], s43 offen sc1
  v_mfma_f32_16x16x32_bf16 v[96:99], v[24:27], a[8:11], v[96:99]
  ds_read_b128 v[16:19], v128 offset:18432
  v_mfma_f32_16x16x32_bf16 v[100:103], v[24:27], a[64:67], v[100:103]
  v_cvt_pk_bf16_f32 v80, v48, v49
  v_cvt_pk_bf16_f32 v81, v50, v51
  v_mfma_f32_16x16x32_bf16 v[104:107], v[24:27], a[120:123], v[104:107]
  v_cvt_pk_bf16_f32 v82, v64, v65
  v_cvt_pk_bf16_f32 v83, v66, v67
  v_mfma_f32_16x16x32_bf16 v[108:111], v[24:27], a[176:179], v[108:111]
  s_waitcnt lgkmcnt(4)
  s_add_u32 s43, s42, 458752
  v_mfma_f32_16x16x32_bf16 v[112:115], v[28:31], a[8:11], v[112:115]
  ds_read_b128 v[20:23], v128 offset:5120
  v_mfma_f32_16x16x32_bf16 v[116:119], v[28:31], a[64:67], v[116:119]
  buffer_store_dwordx4 v[80:83], v2, s[8:11], s43 offen sc1
  v_cvt_pk_bf16_f32 v84, v52, v53
  v_mfma_f32_16x16x32_bf16 v[120:123], v[28:31], a[120:123], v[120:123]
  v_cvt_pk_bf16_f32 v85, v54, v55
  v_cvt_pk_bf16_f32 v86, v68, v69
  v_mfma_f32_16x16x32_bf16 v[124:127], v[28:31], a[176:179], v[124:127]
  s_waitcnt lgkmcnt(4)
  v_cvt_pk_bf16_f32 v87, v70, v71
  v_mfma_f32_16x16x32_bf16 v[96:99], v[32:35], a[12:15], v[96:99]
  ds_read_b128 v[24:27], v128 offset:19456
  v_mfma_f32_16x16x32_bf16 v[100:103], v[32:35], a[68:71], v[100:103]
  s_add_u32 s43, s42, 473088
  v_mfma_f32_16x16x32_bf16 v[104:107], v[32:35], a[124:127], v[104:107]
  buffer_store_dwordx4 v[84:87], v2, s[8:11], s43 offen sc1
  v_mfma_f32_16x16x32_bf16 v[108:111], v[32:35], a[180:183], v[108:111]
  s_waitcnt lgkmcnt(4)
  s_add_u32 s30, s19, 2
  s_lshr_b32 s24, s30, 1
  s_lshl_b32 s24, s24, 2
  s_and_b32 s25, s30, 1
  s_add_u32 s24, s24, s25
  s_mul_i32 s24, s24, 14336
  v_mfma_f32_16x16x32_bf16 v[112:115], v[8:11], a[12:15], v[112:115]
  ds_read_b128 v[28:31], v128 offset:6144
  v_mfma_f32_16x16x32_bf16 v[116:119], v[8:11], a[68:71], v[116:119]
  s_add_u32 s24, s24, s23
  s_cmp_lt_u32 s30, s35
  s_cselect_b32 s24, s24, 0x40000000
  v_mfma_f32_16x16x32_bf16 v[120:123], v[8:11], a[124:127], v[120:123]
  s_add_u32 m0, s33, s27
  s_nop 0
  buffer_load_dwordx4 v2, s[8:11], s24 offen offset:0 sc1 lds
  v_mfma_f32_16x16x32_bf16 v[124:127], v[8:11], a[180:183], v[124:127]
  s_waitcnt lgkmcnt(4)
  v_mfma_f32_16x16x32_bf16 v[96:99], v[12:15], a[16:19], v[96:99]
  ds_read_b128 v[32:35], v128 offset:20480
  v_mfma_f32_16x16x32_bf16 v[100:103], v[12:15], a[72:75], v[100:103]
  v_mfma_f32_16x16x32_bf16 v[104:107], v[12:15], a[128:131], v[104:107]
  v_mfma_f32_16x16x32_bf16 v[108:111], v[12:15], a[184:187], v[108:111]
  s_waitcnt lgkmcnt(4)
  buffer_load_dwordx4 v2, s[8:11], s24 offen offset:1024 sc1 lds
  v_mfma_f32_16x16x32_bf16 v[112:115], v[16:19], a[16:19], v[112:115]
  ds_read_b128 v[8:11], v128 offset:7168
  v_mfma_f32_16x16x32_bf16 v[116:119], v[16:19], a[72:75], v[116:119]
  v_mfma_f32_16x16x32_bf16 v[120:123], v[16:19], a[128:131], v[120:123]
  v_mfma_f32_16x16x32_bf16 v[124:127], v[16:19], a[184:187], v[124:127]
  s_waitcnt lgkmcnt(4)
  v_mfma_f32_16x16x32_bf16 v[96:99], v[20:23], a[20:23], v[96:99]
  ds_read_b128 v[12:15], v128 offset:21504
  v_mfma_f32_16x16x32_bf16 v[100:103], v[20:23], a[76:79], v[100:103]
  buffer_load_dwordx4 v2, s[8:11], s24 offen offset:2048 sc1 lds
  v_mfma_f32_16x16x32_bf16 v[104:107], v[20:23], a[132:135], v[104:107]
  v_mfma_f32_16x16x32_bf16 v[108:111], v[20:23], a[188:191], v[108:111]
  s_waitcnt lgkmcnt(4)
  v_mfma_f32_16x16x32_bf16 v[112:115], v[24:27], a[20:23], v[112:115]
  ds_read_b128 v[16:19], v128 offset:8192
  v_mfma_f32_16x16x32_bf16 v[116:119], v[24:27], a[76:79], v[116:119]
  v_mfma_f32_16x16x32_bf16 v[120:123], v[24:27], a[132:135], v[120:123]
  buffer_load_dwordx4 v2, s[8:11], s24 offen offset:3072 sc1 lds
  v_mfma_f32_16x16x32_bf16 v[124:127], v[24:27], a[188:191], v[124:127]
  s_waitcnt lgkmcnt(4)
  v_mfma_f32_16x16x32_bf16 v[96:99], v[28:31], a[24:27], v[96:99]
  ds_read_b128 v[20:23], v128 offset:22528
  v_mfma_f32_16x16x32_bf16 v[100:103], v[28:31], a[80:83], v[100:103]
  v_mfma_f32_16x16x32_bf16 v[104:107], v[28:31], a[136:139], v[104:107]
  v_mfma_f32_16x16x32_bf16 v[108:111], v[28:31], a[192:195], v[108:111]
  s_waitcnt lgkmcnt(4)
  s_add_u32 m0, m0, 4096
  s_add_u32 s24, s24, 4096
  buffer_load_dwordx4 v2, s[8:11], s24 offen offset:0 sc1 lds
  v_mfma_f32_16x16x32_bf16 v[112:115], v[32:35], a[24:27], v[112:115]
  ds_read_b128 v[24:27], v128 offset:9216
  v_mfma_f32_16x16x32_bf16 v[116:119], v[32:35], a[80:83], v[116:119]
  v_mfma_f32_16x16x32_bf16 v[120:123], v[32:35], a[136:139], v[120:123]
  v_mfma_f32_16x16x32_bf16 v[124:127], v[32:35], a[192:195], v[124:127]
  s_waitcnt lgkmcnt(4)
  v_mfma_f32_16x16x32_bf16 v[96:99], v[8:11], a[28:31], v[96:99]
  ds_read_b128 v[28:31], v128 offset:23552
  v_mfma_f32_16x16x32_bf16 v[100:103], v[8:11], a[84:87], v[100:103]
  buffer_load_dwordx4 v2, s[8:11], s24 offen offset:1024 sc1 lds
  v_mfma_f32_16x16x32_bf16 v[104:107], v[8:11], a[140:143], v[104:107]
  v_mfma_f32_16x16x32_bf16 v[108:111], v[8:11], a[196:199], v[108:111]
  s_waitcnt lgkmcnt(4)
  v_mfma_f32_16x16x32_bf16 v[112:115], v[12:15], a[28:31], v[112:115]
  ds_read_b128 v[32:35], v128 offset:10240
  v_mfma_f32_16x16x32_bf16 v[116:119], v[12:15], a[84:87], v[116:119]
  v_mfma_f32_16x16x32_bf16 v[120:123], v[12:15], a[140:143], v[120:123]
  buffer_load_dwordx4 v2, s[8:11], s24 offen offset:2048 sc1 lds
  v_mfma_f32_16x16x32_bf16 v[124:127], v[12:15], a[196:199], v[124:127]
  s_waitcnt lgkmcnt(4)
  v_mfma_f32_16x16x32_bf16 v[96:99], v[16:19], a[32:35], v[96:99]
  ds_read_b128 v[8:11], v128 offset:24576
  v_mfma_f32_16x16x32_bf16 v[100:103], v[16:19], a[88:91], v[100:103]
  v_mfma_f32_16x16x32_bf16 v[104:107], v[16:19], a[144:147], v[104:107]
  v_mfma_f32_16x16x32_bf16 v[108:111], v[16:19], a[200:203], v[108:111]
  s_waitcnt lgkmcnt(4)
  s_add_u32 s33, s33, 28672
  s_cmp_eq_u32 s33, 114688
  s_cselect_b32 s33, 0, s33
  v_mfma_f32_16x16x32_bf16 v[112:115], v[20:23], a[32:35], v[112:115]
  ds_read_b128 v[12:15], v128 offset:11264
  v_mfma_f32_16x16x32_bf16 v[116:119], v[20:23], a[88:91], v[116:119]
  s_add_u32 s32, s32, 28672
  s_cmp_eq_u32 s32, 114688
  s_cselect_b32 s32, 0, s32
  v_mfma_f32_16x16x32_bf16 v[120:123], v[20:23], a[144:147], v[120:123]
  v_add_u32 v5, s32, v2
  v_mfma_f32_16x16x32_bf16 v[124:127], v[20:23], a[200:203], v[124:127]
  s_waitcnt lgkmcnt(4)
  v_mfma_f32_16x16x32_bf16 v[96:99], v[24:27], a[36:39], v[96:99]
  ds_read_b128 v[16:19], v128 offset:25600
  v_mfma_f32_16x16x32_bf16 v[100:103], v[24:27], a[92:95], v[100:103]
  v_mfma_f32_16x16x32_bf16 v[104:107], v[24:27], a[148:151], v[104:107]
  v_mfma_f32_16x16x32_bf16 v[108:111], v[24:27], a[204:207], v[108:111]
  s_waitcnt lgkmcnt(4)
  v_mfma_f32_16x16x32_bf16 v[112:115], v[28:31], a[36:39], v[112:115]
  ds_read_b128 v[20:23], v128 offset:12288
  v_mfma_f32_16x16x32_bf16 v[116:119], v[28:31], a[92:95], v[116:119]
  v_mfma_f32_16x16x32_bf16 v[120:123], v[28:31], a[148:151], v[120:123]
  v_mfma_f32_16x16x32_bf16 v[124:127], v[28:31], a[204:207], v[124:127]
  s_waitcnt lgkmcnt(4)
  v_mfma_f32_16x16x32_bf16 v[96:99], v[32:35], a[40:43], v[96:99]
  ds_read_b128 v[24:27], v128 offset:26624
  v_mfma_f32_16x16x32_bf16 v[100:103], v[32:35], a[96:99], v[100:103]
  v_mfma_f32_16x16x32_bf16 v[104:107], v[32:35], a[152:155], v[104:107]
  v_mfma_f32_16x16x32_bf16 v[108:111], v[32:35], a[208:211], v[108:111]
  s_waitcnt lgkmcnt(4)
  v_mfma_f32_16x16x32_bf16 v[112:115], v[8:11], a[40:43], v[112:115]
  ds_read_b128 v[28:31], v128 offset:13312
  v_mfma_f32_16x16x32_bf16 v[116:119], v[8:11], a[96:99], v[116:119]
  v_mfma_f32_16x16x32_bf16 v[120:123], v[8:11], a[152:155], v[120:123]
  v_mfma_f32_16x16x32_bf16 v[124:127], v[8:11], a[208:211], v[124:127]
  s_waitcnt lgkmcnt(4)
  v_mfma_f32_16x16x32_bf16 v[96:99], v[12:15], a[44:47], v[96:99]
  ds_read_b128 v[32:35], v128 offset:27648
  v_mfma_f32_16x16x32_bf16 v[100:103], v[12:15], a[100:103], v[100:103]
  v_mfma_f32_16x16x32_bf16 v[104:107], v[12:15], a[156:159], v[104:107]
  v_mfma_f32_16x16x32_bf16 v[108:111], v[12:15], a[212:215], v[108:111]
  s_waitcnt lgkmcnt(4)
  v_mfma_f32_16x16x32_bf16 v[112:115], v[16:19], a[44:47], v[112:115]
  s_waitcnt vmcnt(11)
  s_barrier
  ds_read_b128 v[8:11], v5 offset:0
  v_mfma_f32_16x16x32_bf16 v[116:119], v[16:19], a[100:103], v[116:119]
  v_mfma_f32_16x16x32_bf16 v[120:123], v[16:19], a[156:159], v[120:123]
  v_mfma_f32_16x16x32_bf16 v[124:127], v[16:19], a[212:215], v[124:127]
  s_waitcnt lgkmcnt(4)
  v_mfma_f32_16x16x32_bf16 v[96:99], v[20:23], a[48:51], v[96:99]
  ds_read_b128 v[12:15], v5 offset:14336
  v_mfma_f32_16x16x32_bf16 v[100:103], v[20:23], a[104:107], v[100:103]
  v_mfma_f32_16x16x32_bf16 v[104:107], v[20:23], a[160:163], v[104:107]
  v_mfma_f32_16x16x32_bf16 v[108:111], v[20:23], a[216:219], v[108:111]
  s_waitcnt lgkmcnt(4)
  v_mfma_f32_16x16x32_bf16 v[112:115], v[24:27], a[48:51], v[112:115]
  ds_read_b128 v[16:19], v5 offset:1024
  v_mfma_f32_16x16x32_bf16 v[116:119], v[24:27], a[104:107], v[116:119]
  v_mfma_f32_16x16x32_bf16 v[120:123], v[24:27], a[160:163], v[120:123]
  v_mfma_f32_16x16x32_bf16 v[124:127], v[24:27], a[216:219], v[124:127]
  s_waitcnt lgkmcnt(4)
  v_mfma_f32_16x16x32_bf16 v[96:99], v[28:31], a[52:55], v[96:99]
  ds_read_b128 v[20:23], v5 offset:15360
  v_mfma_f32_16x16x32_bf16 v[100:103], v[28:31], a[108:111], v[100:103]
  v_mfma_f32_16x16x32_bf16 v[104:107], v[28:31], a[164:167], v[104:107]
  v_mfma_f32_16x16x32_bf16 v[108:111], v[28:31], a[220:223], v[108:111]
  s_waitcnt lgkmcnt(4)
  v_mfma_f32_16x16x32_bf16 v[112:115], v[32:35], a[52:55], v[112:115]
  ds_read_b128 v[24:27], v5 offset:2048
  v_mfma_f32_16x16x32_bf16 v[116:119], v[32:35], a[108:111], v[116:119]
  v_mfma_f32_16x16x32_bf16 v[120:123], v[32:35], a[164:167], v[120:123]
  v_mfma_f32_16x16x32_bf16 v[124:127], v[32:35], a[220:223], v[124:127]
  s_waitcnt lgkmcnt(4)
  s_mov_b32 s40, s19
  s_mov_b32 s41, s29
  s_add_u32 s19, s19, 1
  s_cmp_lt_u32 s19, s35
  s_cbranch_scc1 wg_f_loop
  s_nop 3
  s_lshl_b32 s42, s40, 10
  s_add_u32 s42, s42, s41
  v_cvt_pk_bf16_f32 v72, v96, v97
  v_cvt_pk_bf16_f32 v73, v98, v99
  v_cvt_pk_bf16_f32 v74, v112, v113
  v_cvt_pk_bf16_f32 v75, v114, v115
  s_add_u32 s43, s42, 0
  buffer_store_dwordx4 v[72:75], v2, s[8:11], s43 offen sc1
  v_cvt_pk_bf16_f32 v76, v100, v101
  v_cvt_pk_bf16_f32 v77, v102, v103
  v_cvt_pk_bf16_f32 v78, v116, v117
  v_cvt_pk_bf16_f32 v79, v118, v119
  s_add_u32 s43, s42, 14336
  buffer_store_dwordx4 v[76:79], v2, s[8:11], s43 offen sc1
  v_cvt_pk_bf16_f32 v80, v104, v105
  v_cvt_pk_bf16_f32 v81, v106, v107
  v_cvt_pk_bf16_f32 v82, v120, v121
  v_cvt_pk_bf16_f32 v83, v122, v123
  s_add_u32 s43, s42, 458752
  buffer_store_dwordx4 v[80:83], v2, s[8:11], s43 offen sc1
  v_cvt_pk_bf16_f32 v84, v108, v109
  v_cvt_pk_bf16_f32 v85, v110, v111
  v_cvt_pk_bf16_f32 v86, v124, v125
  v_cvt_pk_bf16_f32 v87, v126, v127
  s_add_u32 s43, s42, 473088
  buffer_store_dwordx4 v[84:87], v2, s[8:11], s43 offen sc1
  s_branch wg_done
wg_f_e0:
  s_nop 7
  s_lshl_b32 s42, s40, 10
  s_add_u32 s42, s42, s41
  v_cvt_pk_bf16_f32 v72, v40, v41
  v_cvt_pk_bf16_f32 v73, v42, v43
  v_cvt_pk_bf16_f32 v74, v56, v57
  v_cvt_pk_bf16_f32 v75, v58, v59
  s_add_u32 s43, s42, 0
  buffer_store_dwordx4 v[72:75], v2, s[8:11], s43 offen sc1
  v_cvt_pk_bf16_f32 v76, v44, v45
  v_cvt_pk_bf16_f32 v77, v46, v47
  v_cvt_pk_bf16_f32 v78, v60, v61
  v_cvt_pk_bf16_f32 v79, v62, v63
  s_add_u32 s43, s42, 14336
  buffer_store_dwordx4 v[76:79], v2, s[8:11], s43 offen sc1
  v_cvt_pk_bf16_f32 v80, v48, v49
  v_cvt_pk_bf16_f32 v81, v50, v51
  v_cvt_pk_bf16_f32 v82, v64, v65
  v_cvt_pk_bf16_f32 v83, v66, v67
  s_add_u32 s43, s42, 458752
  buffer_store_dwordx4 v[80:83], v2, s[8:11], s43 offen sc1
  v_cvt_pk_bf16_f32 v84, v52, v53
  v_cvt_pk_bf16_f32 v85, v54, v55
  v_cvt_pk_bf16_f32 v86, v68, v69
  v_cvt_pk_bf16_f32 v87, v70, v71
  s_add_u32 s43, s42, 473088
  buffer_store_dwordx4 v[84:87], v2, s[8:11], s43 offen sc1
  s_branch wg_done
wg_vo:
  s_sub_u32 s29, s17, 16
  s_mul_i32 s29, s29, 28672
  s_mul_i32 s24, s28, 458752
  s_add_u32 s29, s29, s24
  s_add_u32 s29, s29, 2490368
  v_lshlrev_b32 v6, 4, v3
  v_mul_u32_u24 v7, 12, v3
  v_add_u32 v7, 48, v7
  s_mov_b32 s31, 0
  s_lshl_b32 s24, s34, 1
  s_mul_i32 s24, s24, 14336
  s_add_u32 s24, s24, s23
  s_add_u32 m0, s31, s27
  s_nop 0
  buffer_load_dwordx4 v2, s[8:11], s24 offen offset:0 sc1 lds
  buffer_load_dwordx4 v2, s[8:11], s24 offen offset:1024 sc1 lds
  buffer_load_dwordx4 v2, s[8:11], s24 offen offset:2048 sc1 lds
  buffer_load_dwordx4 v2, s[8:11], s24 offen offset:3072 sc1 lds
  s_add_u32 m0, m0, 4096
  s_add_u32 s24, s24, 4096
  buffer_load_dwordx4 v2, s[8:11], s24 offen offset:0 sc1 lds
  buffer_load_dwordx4 v2, s[8:11], s24 offen offset:1024 sc1 lds
  buffer_load_dwordx4 v2, s[8:11], s24 offen offset:2048 sc1 lds
  s_sub_u32 s36, s35, 1
  s_add_u32 s30, s34, 1
  s_min_u32 s30, s30, s36
  s_mov_b32 s31, 28672
  s_lshl_b32 s24, s30, 1
  s_mul_i32 s24, s24, 14336
  s_add_u32 s24, s24, s23
  s_add_u32 m0, s31, s27
  s_nop 0
  buffer_load_dwordx4 v2, s[8:11], s24 offen offset:0 sc1 lds
  buffer_load_dwordx4 v2, s[8:11], s24 offen offset:1024 sc1 lds
  buffer_load_dwordx4 v2, s[8:11], s24 offen offset:2048 sc1 lds
  buffer_load_dwordx4 v2, s[8:11], s24 offen offset:3072 sc1 lds
  s_add_u32 m0, m0, 4096
  s_add_u32 s24, s24, 4096
  buffer_load_dwordx4 v2, s[8:11], s24 offen offset:0 sc1 lds
  buffer_load_dwordx4 v2, s[8:11], s24 offen offset:1024 sc1 lds
  buffer_load_dwordx4 v2, s[8:11], s24 offen offset:2048 sc1 lds
  s_mov_b32 s19, s34
  s_mov_b32 s32, 0
  s_mov_b32 s33, 57344
  s_cmp_eq_u32 s18, s101
  s_cbranch_scc1 wg_vo_hx
  s_add_u32 s22, s21, 0
  buffer_load_dwordx4 a[0:3], v2, s[8:11], s22 offen offset:0 sc1
  buffer_load_dwordx4 a[4:7], v2, s[8:11], s22 offen offset:1024 sc1
  buffer_load_dwordx4 a[8:11], v2, s[8:11], s22 offen offset:2048 sc1
  buffer_load_dwordx4 a[12:15], v2, s[8:11], s22 offen offset:3072 sc1
  s_add_u32 s22, s21, 4096
  buffer_load_dwordx4 a[16:19], v2, s[8:11], s22 offen offset:0 sc1
  buffer_load_dwordx4 a[20:23], v2, s[8:11], s22 offen offset:1024 sc1
  buffer_load_dwordx4 a[24:27], v2, s[8:11], s22 offen offset:2048 sc1
  buffer_load_dwordx4 a[28:31], v2, s[8:11], s22 offen offset:3072 sc1
  s_add_u32 s22, s21, 8192
  buffer_load_dwordx4 a[32:35], v2, s[8:11], s22 offen offset:0 sc1
  buffer_load_dwordx4 a[36:39], v2, s[8:11], s22 offen offset:1024 sc1
  buffer_load_dwordx4 a[40:43], v2, s[8:11], s22 offen offset:2048 sc1
  buffer_load_dwordx4 a[44:47], v2, s[8:11], s22 offen offset:3072 sc1
  s_add_u32 s22, s21, 12288
  buffer_load_dwordx4 a[48:51], v2, s[8:11], s22 offen offset:0 sc1
  buffer_load_dwordx4 a[52:55], v2, s[8:11], s22 offen offset:1024 sc1
  buffer_load_dwordx4 a[56:59], v2, s[8:11], s22 offen offset:2048 sc1
  buffer_load_dwordx4 a[60:63], v2, s[8:11], s22 offen offset:3072 sc1
  s_add_u32 s22, s21, 16384
  buffer_load_dwordx4 a[64:67], v2, s[8:11], s22 offen offset:0 sc1
  buffer_load_dwordx4 a[68:71], v2, s[8:11], s22 offen offset:1024 sc1
  buffer_load_dwordx4 a[72:75], v2, s[8:11], s22 offen offset:2048 sc1
  buffer_load_dwordx4 a[76:79], v2, s[8:11], s22 offen offset:3072 sc1
  s_add_u32 s22, s21, 20480
  buffer_load_dwordx4 a[80:83], v2, s[8:11], s22 offen offset:0 sc1
  buffer_load_dwordx4 a[84:87], v2, s[8:11], s22 offen offset:1024 sc1
  buffer_load_dwordx4 a[88:91], v2, s[8:11], s22 offen offset:2048 sc1
  buffer_load_dwordx4 a[92:95], v2, s[8:11], s22 offen offset:3072 sc1
  s_add_u32 s22, s21, 24576
  buffer_load_dwordx4 a[96:99], v2, s[8:11], s22 offen offset:0 sc1
  buffer_load_dwordx4 a[100:103], v2, s[8:11], s22 offen offset:1024 sc1
  buffer_load_dwordx4 a[104:107], v2, s[8:11], s22 offen offset:2048 sc1
  buffer_load_dwordx4 a[108:111], v2, s[8:11], s22 offen offset:3072 sc1
  s_add_u32 s22, s21, 28672
  buffer_load_dwordx4 a[112:115], v2, s[8:11], s22 offen offset:0 sc1
  buffer_load_dwordx4 a[116:119], v2, s[8:11], s22 offen offset:1024 sc1
  buffer_load_dwordx4 a[120:123], v2, s[8:11], s22 offen offset:2048 sc1
  buffer_load_dwordx4 a[124:127], v2, s[8:11], s22 offen offset:3072 sc1
  s_add_u32 s22, s21, 32768
  buffer_load_dwordx4 a[128:131], v2, s[8:11], s22 offen offset:0 sc1
  buffer_load_dwordx4 a[132:135], v2, s[8:11], s22 offen offset:1024 sc1
  buffer_load_dwordx4 a[136:139], v2, s[8:11], s22 offen offset:2048 sc1
  buffer_load_dwordx4 a[140:143], v2, s[8:11], s22 offen offset:3072 sc1
  s_add_u32 s22, s21, 36864
  buffer_load_dwordx4 a[144:147], v2, s[8:11], s22 offen offset:0 sc1
  buffer_load_dwordx4 a[148:151], v2, s[8:11], s22 offen offset:1024 sc1
  buffer_load_dwordx4 a[152:155], v2, s[8:11], s22 offen offset:2048 sc1
  buffer_load_dwordx4 a[156:159], v2, s[8:11], s22 offen offset:3072 sc1
  s_add_u32 s22, s21, 40960
  s_waitcnt vmcnt(40)
  buffer_load_dwordx4 a[160:163], v2, s[8:11], s22 offen offset:0 sc1
  buffer_load_dwordx4 a[164:167], v2, s[8:11], s22 offen offset:1024 sc1
  buffer_load_dwordx4 a[168:171], v2, s[8:11], s22 offen offset:2048 sc1
  buffer_load_dwordx4 a[172:175], v2, s[8:11], s22 offen offset:3072 sc1
  s_add_u32 s22, s21, 45056
  buffer_load_dwordx4 a[176:179], v2, s[8:11], s22 offen offset:0 sc1
  buffer_load_dwordx4 a[180:183], v2, s[8:11], s22 offen offset:1024 sc1
  buffer_load_dwordx4 a[184:187], v2, s[8:11], s22 offen offset:2048 sc1
  buffer_load_dwordx4 a[188:191], v2, s[8:11], s22 offen offset:3072 sc1
  s_add_u32 s22, s21, 49152
  buffer_load_dwordx4 a[192:195], v2, s[8:11], s22 offen offset:0 sc1
  buffer_load_dwordx4 a[196:199], v2, s[8:11], s22 offen offset:1024 sc1
  buffer_load_dwordx4 a[200:203], v2, s[8:11], s22 offen offset:2048 sc1
  buffer_load_dwordx4 a[204:207], v2, s[8:11], s22 offen offset:3072 sc1
  s_add_u32 s22, s21, 53248
  buffer_load_dwordx4 a[208:211], v2, s[8:11], s22 offen offset:0 sc1
  buffer_load_dwordx4 a[212:215], v2, s[8:11], s22 offen offset:1024 sc1
  buffer_load_dwordx4 a[216:219], v2, s[8:11], s22 offen offset:2048 sc1
  buffer_load_dwordx4 a[220:223], v2, s[8:11], s22 offen offset:3072 sc1
wg_vo_hx:
  s_mov_b32 s101, -1
  s_waitcnt vmcnt(0)
  s_barrier
  s_mov_b32 s40, 0
  s_mov_b32 s41, 0x40000000
  v_mov_b32 v5, v2
  ds_read_b128 v[8:11], v5 offset:0
  ds_read_b128 v[12:15], v5 offset:14336
  ds_read_b128 v[16:19], v5 offset:1024
  ds_read_b128 v[20:23], v5 offset:15360
  ds_read_b128 v[24:27], v5 offset:2048
  s_waitcnt lgkmcnt(4)
.p2align 6
wg_vo_loop:
  v_mfma_f32_16x16x32_bf16 v[40:43], a[0:3], v[8:11], 0
  ds_read_b128 v[28:31], v5 offset:16384
  v_mfma_f32_16x16x32_bf16 v[44:47], a[56:59], v[8:11], 0
  v_mfma_f32_16x16x32_bf16 v[48:51], a[112:115], v[8:11], 0
  v_mfma_f32_16x16x32_bf16 v[52:55], a[168:171], v[8:11], 0
  s_waitcnt lgkmcnt(4)
  s_add_u32 s43, s41, 458752
  v_mfma_f32_16x16x32_bf16 v[56:59], a[0:3], v[12:15], 0
  ds_read_b128 v[32:35], v5 offset:3072
  v_mfma_f32_16x16x32_bf16 v[60:63], a[56:59], v[12:15], 0
  s_lshl_b32 s42, s40, 5
  s_add_u32 s42, s42, 0
  v_mfma_f32_16x16x32_bf16 v[64:67], a[112:115], v[12:15], 0
  v_add_u32 v88, s42, v4
  v_mul_u32_u24 v89, 2341, v88
  v_mfma_f32_16x16x32_bf16 v[68:71], a[168:171], v[12:15], 0
  s_waitcnt lgkmcnt(4)
  v_lshrrev_b32 v89, 16, v89
  v_mfma_f32_16x16x32_bf16 v[40:43], a[4:7], v[16:19], v[40:43]
  ds_read_b128 v[8:11], v5 offset:17408
  v_mfma_f32_16x16x32_bf16 v[44:47], a[60:63], v[16:19], v[44:47]
  v_mul_u32_u24 v92, 28, v89
  v_sub_u32 v92, v88, v92
  v_mfma_f32_16x16x32_bf16 v[48:51], a[116:119], v[16:19], v[48:51]
  v_cmp_gt_u32 vcc, 16, v92
  v_mul_u32_u24 v89, 84, v89
  v_mfma_f32_16x16x32_bf16 v[52:55], a[172:175], v[16:19], v[52:55]
  s_waitcnt lgkmcnt(4)
  v_cndmask_b32 v92, v7, v6, vcc
  v_mfma_f32_16x16x32_bf16 v[56:59], a[4:7], v[20:23], v[56:59]
  ds_read_b128 v[12:15], v5 offset:4096
  v_mfma_f32_16x16x32_bf16 v[60:63], a[60:63], v[20:23], v[60:63]
  v_add3_u32 v88, v88, v89, v92
  v_lshlrev_b32 v90, 4, v88
  v_mfma_f32_16x16x32_bf16 v[64:67], a[116:119], v[20:23], v[64:67]
  v_cvt_pk_bf16_f32 v72, v96, v100
  v_cvt_pk_bf16_f32 v73, v97, v101
  v_mfma_f32_16x16x32_bf16 v[68:71], a[172:175], v[20:23], v[68:71]
  s_waitcnt lgkmcnt(4)
  v_cvt_pk_bf16_f32 v74, v98, v102
  v_mfma_f32_16x16x32_bf16 v[40:43], a[8:11], v[24:27], v[40:43]
  ds_read_b128 v[16:19], v5 offset:18432
  v_mfma_f32_16x16x32_bf16 v[44:47], a[64:67], v[24:27], v[44:47]
  v_cvt_pk_bf16_f32 v75, v99, v103
  v_mfma_f32_16x16x32_bf16 v[48:51], a[120:123], v[24:27], v[48:51]
  buffer_store_dwordx4 v[72:75], v90, s[8:11], s41 offen sc1
  v_cvt_pk_bf16_f32 v76, v104, v108
  v_mfma_f32_16x16x32_bf16 v[52:55], a[176:179], v[24:27], v[52:55]
  s_waitcnt lgkmcnt(4)
  v_cvt_pk_bf16_f32 v77, v105, v109
  v_mfma_f32_16x16x32_bf16 v[56:59], a[8:11], v[28:31], v[56:59]
  ds_read_b128 v[20:23], v5 offset:5120
  v_mfma_f32_16x16x32_bf16 v[60:63], a[64:67], v[28:31], v[60:63]
  v_cvt_pk_bf16_f32 v78, v106, v110
  v_cvt_pk_bf16_f32 v79, v107, v111
  v_mfma_f32_16x16x32_bf16 v[64:67], a[120:123], v[28:31], v[64:67]
  buffer_store_dwordx4 v[76:79], v90, s[8:11], s43 offen sc1
  s_lshl_b32 s42, s40, 5
  v_mfma_f32_16x16x32_bf16 v[68:71], a[176:179], v[28:31], v[68:71]
  s_waitcnt lgkmcnt(4)
  s_add_u32 s42, s42, 16
  v_mfma_f32_16x16x32_bf16 v[40:43], a[12:15], v[32:35], v[40:43]
  ds_read_b128 v[24:27], v5 offset:19456
  v_mfma_f32_16x16x32_bf16 v[44:47], a[68:71], v[32:35], v[44:47]
  v_add_u32 v88, s42, v4
  v_mul_u32_u24 v89, 2341, v88
  v_mfma_f32_16x16x32_bf16 v[48:51], a[124:127], v[32:35], v[48:51]
  v_lshrrev_b32 v89, 16, v89
  v_mul_u32_u24 v92, 28, v89
  v_mfma_f32_16x16x32_bf16 v[52:55], a[180:183], v[32:35], v[52:55]
  s_waitcnt lgkmcnt(4)
  v_sub_u32 v92, v88, v92
  v_mfma_f32_16x16x32_bf16 v[56:59], a[12:15], v[8:11], v[56:59]
  ds_read_b128 v[28:31], v5 offset:6144
  v_mfma_f32_16x16x32_bf16 v[60:63], a[68:71], v[8:11], v[60:63]
  v_cmp_gt_u32 vcc, 16, v92
  v_mul_u32_u24 v89, 84, v89
  v_mfma_f32_16x16x32_bf16 v[64:67], a[124:127], v[8:11], v[64:67]
  v_cndmask_b32 v92, v7, v6, vcc
  v_add3_u32 v88, v88, v89, v92
  v_mfma_f32_16x16x32_bf16 v[68:71], a[180:183], v[8:11], v[68:71]
  s_waitcnt lgkmcnt(4)
  v_lshlrev_b32 v91, 4, v88
  v_mfma_f32_16x16x32_bf16 v[40:43], a[16:19], v[12:15], v[40:43]
  ds_read_b128 v[32:35], v5 offset:20480
  v_mfma_f32_16x16x32_bf16 v[44:47], a[72:75], v[12:15], v[44:47]
  v_cvt_pk_bf16_f32 v80, v112, v116
  v_cvt_pk_bf16_f32 v81, v113, v117
  v_mfma_f32_16x16x32_bf16 v[48:51], a[128:131], v[12:15], v[48:51]
  v_cvt_pk_bf16_f32 v82, v114, v118
  v_cvt_pk_bf16_f32 v83, v115, v119
  v_mfma_f32_16x16x32_bf16 v[52:55], a[184:187], v[12:15], v[52:55]
  s_waitcnt lgkmcnt(4)
  buffer_store_dwordx4 v[80:83], v91, s[8:11], s41 offen sc1
  v_mfma_f32_16x16x32_bf16 v[56:59], a[16:19], v[16:19], v[56:59]
  ds_read_b128 v[8:11], v5 offset:7168
  v_mfma_f32_16x16x32_bf16 v[60:63], a[72:75], v[16:19], v[60:63]
  v_cvt_pk_bf16_f32 v84, v120, v124
  v_cvt_pk_bf16_f32 v85, v121, v125
  v_mfma_f32_16x16x32_bf16 v[64:67], a[128:131], v[16:19], v[64:67]
  v_cvt_pk_bf16_f32 v86, v122, v126
  v_cvt_pk_bf16_f32 v87, v123, v127
  v_mfma_f32_16x16x32_bf16 v[68:71], a[184:187], v[16:19], v[68:71]
  s_waitcnt lgkmcnt(4)
  buffer_store_dwordx4 v[84:87], v91, s[8:11], s43 offen sc1
  v_mfma_f32_16x16x32_bf16 v[40:43], a[20:23], v[20:23], v[40:43]
  ds_read_b128 v[12:15], v5 offset:21504
  v_mfma_f32_16x16x32_bf16 v[44:47], a[76:79], v[20:23], v[44:47]
  s_add_u32 s30, s19, 2
  s_lshl_b32 s24, s30, 1
  s_mul_i32 s24, s24, 14336
  v_mfma_f32_16x16x32_bf16 v[48:51], a[132:135], v[20:23], v[48:51]
  s_add_u32 s24, s24, s23
  s_cmp_lt_u32 s30, s35
  s_cselect_b32 s24, s24, 0x40000000
  v_mfma_f32_16x16x32_bf16 v[52:55], a[188:191], v[20:23], v[52:55]
  s_waitcnt lgkmcnt(4)
  s_add_u32 m0, s33, s27
  s_nop 0
  buffer_load_dwordx4 v2, s[8:11], s24 offen offset:0 sc1 lds
  v_mfma_f32_16x16x32_bf16 v[56:59], a[20:23], v[24:27], v[56:59]
  ds_read_b128 v[16:19], v5 offset:8192
  v_mfma_f32_16x16x32_bf16 v[60:63], a[76:79], v[24:27], v[60:63]
  v_mfma_f32_16x16x32_bf16 v[64:67], a[132:135], v[24:27], v[64:67]
  v_mfma_f32_16x16x32_bf16 v[68:71], a[188:191], v[24:27], v[68:71]
  s_waitcnt lgkmcnt(4)
  v_mfma_f32_16x16x32_bf16 v[40:43], a[24:27], v[28:31], v[40:43]
  ds_read_b128 v[20:23], v5 offset:22528
  v_mfma_f32_16x16x32_bf16 v[44:47], a[80:83], v[28:31], v[44:47]
  buffer_load_dwordx4 v2, s[8:11], s24 offen offset:1024 sc1 lds
  v_mfma_f32_16x16x32_bf16 v[48:51], a[136:139], v[28:31], v[48:51]
  v_mfma_f32_16x16x32_bf16 v[52:55], a[192:195], v[28:31], v[52:55]
  s_waitcnt lgkmcnt(4)
  v_mfma_f32_16x16x32_bf16 v[56:59], a[24:27], v[32:35], v[56:59]
  ds_read_b128 v[24:27], v5 offset:9216
  v_mfma_f32_16x16x32_bf16 v[60:63], a[80:83], v[32:35], v[60:63]
  v_mfma_f32_16x16x32_bf16 v[64:67], a[136:139], v[32:35], v[64:67]
  buffer_load_dwordx4 v2, s[8:11], s24 offen offset:2048 sc1 lds
  v_mfma_f32_16x16x32_bf16 v[68:71], a[192:195], v[32:35], v[68:71]
  s_waitcnt lgkmcnt(4)
  v_mfma_f32_16x16x32_bf16 v[40:43], a[28:31], v[8:11], v[40:43]
  ds_read_b128 v[28:31], v5 offset:23552
  v_mfma_f32_16x16x32_bf16 v[44:47], a[84:87], v[8:11], v[44:47]
  v_mfma_f32_16x16x32_bf16 v[48:51], a[140:143], v[8:11], v[48:51]
  v_mfma_f32_16x16x32_bf16 v[52:55], a[196:199], v[8:11], v[52:55]
  s_waitcnt lgkmcnt(4)
  buffer_load_dwordx4 v2, s[8:11], s24 offen offset:3072 sc1 lds
  v_mfma_f32_16x16x32_bf16 v[56:59], a[28:31], v[12:15], v[56:59]
  ds_read_b128 v[32:35], v5 offset:10240
  v_mfma_f32_16x16x32_bf16 v[60:63], a[84:87], v[12:15], v[60:63]
  v_mfma_f32_16x16x32_bf16 v[64:67], a[140:143], v[12:15], v[64:67]
  v_mfma_f32_16x16x32_bf16 v[68:71], a[196:199], v[12:15], v[68:71]
  s_waitcnt lgkmcnt(4)
  v_mfma_f32_16x16x32_bf16 v[40:43], a[32:35], v[16:19], v[40:43]
  ds_read_b128 v[8:11], v5 offset:24576
  v_mfma_f32_16x16x32_bf16 v[44:47], a[88:91], v[16:19], v[44:47]
  s_add_u32 m0, m0, 4096
  s_add_u32 s24, s24, 4096
  buffer_load_dwordx4 v2, s[8:11], s24 offen offset:0 sc1 lds
  v_mfma_f32_16x16x32_bf16 v[48:51], a[144:147], v[16:19], v[48:51]
  v_mfma_f32_16x16x32_bf16 v[52:55], a[200:203], v[16:19], v[52:55]
  s_waitcnt lgkmcnt(4)
  v_mfma_f32_16x16x32_bf16 v[56:59], a[32:35], v[20:23], v[56:59]
  ds_read_b128 v[12:15], v5 offset:11264
  v_mfma_f32_16x16x32_bf16 v[60:63], a[88:91], v[20:23], v[60:63]
  v_mfma_f32_16x16x32_bf16 v[64:67], a[144:147], v[20:23], v[64:67]
  buffer_load_dwordx4 v2, s[8:11], s24 offen offset:1024 sc1 lds
  v_mfma_f32_16x16x32_bf16 v[68:71], a[200:203], v[20:23], v[68:71]
  s_waitcnt lgkmcnt(4)
  v_mfma_f32_16x16x32_bf16 v[40:43], a[36:39], v[24:27], v[40:43]
  ds_read_b128 v[16:19], v5 offset:25600
  v_mfma_f32_16x16x32_bf16 v[44:47], a[92:95], v[24:27], v[44:47]
  v_mfma_f32_16x16x32_bf16 v[48:51], a[148:151], v[24:27], v[48:51]
  v_mfma_f32_16x16x32_bf16 v[52:55], a[204:207], v[24:27], v[52:55]
  s_waitcnt lgkmcnt(4)
  buffer_load_dwordx4 v2, s[8:11], s24 offen offset:2048 sc1 lds
  v_mfma_f32_16x16x32_bf16 v[56:59], a[36:39], v[28:31], v[56:59]
  ds_read_b128 v[20:23], v5 offset:12288
  v_mfma_f32_16x16x32_bf16 v[60:63], a[92:95], v[28:31], v[60:63]
  v_mfma_f32_16x16x32_bf16 v[64:67], a[148:151], v[28:31], v[64:67]
  v_mfma_f32_16x16x32_bf16 v[68:71], a[204:207], v[28:31], v[68:71]
  s_waitcnt lgkmcnt(4)
  v_mfma_f32_16x16x32_bf16 v[40:43], a[40:43], v[32:35], v[40:43]
  ds_read_b128 v[24:27], v5 offset:26624
  v_mfma_f32_16x16x32_bf16 v[44:47], a[96:99], v[32:35], v[44:47]
  s_add_u32 s33, s33, 28672
  s_cmp_eq_u32 s33, 114688
  s_cselect_b32 s33, 0, s33
  v_mfma_f32_16x16x32_bf16 v[48:51], a[152:155], v[32:35], v[48:51]
  s_add_u32 s32, s32, 28672
  s_cmp_eq_u32 s32, 114688
  s_cselect_b32 s32, 0, s32
  v_mfma_f32_16x16x32_bf16 v[52:55], a[208:211], v[32:35], v[52:55]
  s_waitcnt lgkmcnt(4)
  v_add_u32 v128, s32, v2
  v_mfma_f32_16x16x32_bf16 v[56:59], a[40:43], v[8:11], v[56:59]
  ds_read_b128 v[28:31], v5 offset:13312
  v_mfma_f32_16x16x32_bf16 v[60:63], a[96:99], v[8:11], v[60:63]
  v_mfma_f32_16x16x32_bf16 v[64:67], a[152:155], v[8:11], v[64:67]
  v_mfma_f32_16x16x32_bf16 v[68:71], a[208:211], v[8:11], v[68:71]
  s_waitcnt lgkmcnt(4)
  v_mfma_f32_16x16x32_bf16 v[40:43], a[44:47], v[12:15], v[40:43]
  ds_read_b128 v[32:35], v5 offset:27648
  v_mfma_f32_16x16x32_bf16 v[44:47], a[100:103], v[12:15], v[44:47]
  v_mfma_f32_16x16x32_bf16 v[48:51], a[156:159], v[12:15], v[48:51]
  v_mfma_f32_16x16x32_bf16 v[52:55], a[212:215], v[12:15], v[52:55]
  s_waitcnt lgkmcnt(4)
  v_mfma_f32_16x16x32_bf16 v[56:59], a[44:47], v[16:19], v[56:59]
  s_waitcnt vmcnt(11)
  s_barrier
  ds_read_b128 v[8:11], v128 offset:0
  v_mfma_f32_16x16x32_bf16 v[60:63], a[100:103], v[16:19], v[60:63]
  v_mfma_f32_16x16x32_bf16 v[64:67], a[156:159], v[16:19], v[64:67]
  v_mfma_f32_16x16x32_bf16 v[68:71], a[212:215], v[16:19], v[68:71]
  s_waitcnt lgkmcnt(4)
  v_mfma_f32_16x16x32_bf16 v[40:43], a[48:51], v[20:23], v[40:43]
  ds_read_b128 v[12:15], v128 offset:14336
  v_mfma_f32_16x16x32_bf16 v[44:47], a[104:107], v[20:23], v[44:47]
  v_mfma_f32_16x16x32_bf16 v[48:51], a[160:163], v[20:23], v[48:51]
  v_mfma_f32_16x16x32_bf16 v[52:55], a[216:219], v[20:23], v[52:55]
  s_waitcnt lgkmcnt(4)
  v_mfma_f32_16x16x32_bf16 v[56:59], a[48:51], v[24:27], v[56:59]
  ds_read_b128 v[16:19], v128 offset:1024
  v_mfma_f32_16x16x32_bf16 v[60:63], a[104:107], v[24:27], v[60:63]
  v_mfma_f32_16x16x32_bf16 v[64:67], a[160:163], v[24:27], v[64:67]
  v_mfma_f32_16x16x32_bf16 v[68:71], a[216:219], v[24:27], v[68:71]
  s_waitcnt lgkmcnt(4)
  v_mfma_f32_16x16x32_bf16 v[40:43], a[52:55], v[28:31], v[40:43]
  ds_read_b128 v[20:23], v128 offset:15360
  v_mfma_f32_16x16x32_bf16 v[44:47], a[108:111], v[28:31], v[44:47]
  v_mfma_f32_16x16x32_bf16 v[48:51], a[164:167], v[28:31], v[48:51]
  v_mfma_f32_16x16x32_bf16 v[52:55], a[220:223], v[28:31], v[52:55]
  s_waitcnt lgkmcnt(4)
  v_mfma_f32_16x16x32_bf16 v[56:59], a[52:55], v[32:35], v[56:59]
  ds_read_b128 v[24:27], v128 offset:2048
  v_mfma_f32_16x16x32_bf16 v[60:63], a[108:111], v[32:35], v[60:63]
  v_mfma_f32_16x16x32_bf16 v[64:67], a[164:167], v[32:35], v[64:67]
  v_mfma_f32_16x16x32_bf16 v[68:71], a[220:223], v[32:35], v[68:71]
  s_waitcnt lgkmcnt(4)
  s_mov_b32 s40, s19
  s_mov_b32 s41, s29
  s_add_u32 s19, s19, 1
  s_cmp_lt_u32 s19, s35
  s_cbranch_scc0 wg_vo_e0
  v_mfma_f32_16x16x32_bf16 v[96:99], a[0:3], v[8:11], 0
  ds_read_b128 v[28:31], v128 offset:16384
  v_mfma_f32_16x16x32_bf16 v[100:103], a[56:59], v[8:11], 0
  v_mfma_f32_16x16x32_bf16 v[104:107], a[112:115], v[8:11], 0
  v_mfma_f32_16x16x32_bf16 v[108:111], a[168:171], v[8:11], 0
  s_waitcnt lgkmcnt(4)
  s_add_u32 s43, s41, 458752
  v_mfma_f32_16x16x32_bf16 v[112:115], a[0:3], v[12:15], 0
  ds_read_b128 v[32:35], v128 offset:3072
  v_mfma_f32_16x16x32_bf16 v[116:119], a[56:59], v[12:15], 0
  s_lshl_b32 s42, s40, 5
  s_add_u32 s42, s42, 0
  v_mfma_f32_16x16x32_bf16 v[120:123], a[112:115], v[12:15], 0
  v_add_u32 v88, s42, v4
  v_mul_u32_u24 v89, 2341, v88
  v_mfma_f32_16x16x32_bf16 v[124:127], a[168:171], v[12:15], 0
  s_waitcnt lgkmcnt(4)
  v_lshrrev_b32 v89, 16, v89
  v_mfma_f32_16x16x32_bf16 v[96:99], a[4:7], v[16:19], v[96:99]
  ds_read_b128 v[8:11], v128 offset:17408
  v_mfma_f32_16x16x32_bf16 v[100:103], a[60:63], v[16:19], v[100:103]
  v_mul_u32_u24 v92, 28, v89
  v_sub_u32 v92, v88, v92
  v_mfma_f32_16x16x32_bf16 v[104:107], a[116:119], v[16:19], v[104:107]
  v_cmp_gt_u32 vcc, 16, v92
  v_mul_u32_u24 v89, 84, v89
  v_mfma_f32_16x16x32_bf16 v[108:111], a[172:175], v[16:19], v[108:111]
  s_waitcnt lgkmcnt(4)
  v_cndmask_b32 v92, v7, v6, vcc
  v_mfma_f32_16x16x32_bf16 v[112:115], a[4:7], v[20:23], v[112:115]
  ds_read_b128 v[12:15], v128 offset:4096
  v_mfma_f32_16x16x32_bf16 v[116:119], a[60:63], v[20:23], v[116:119]
  v_add3_u32 v88, v88, v89, v92
  v_lshlrev_b32 v90, 4, v88
  v_mfma_f32_16x16x32_bf16 v[120:123], a[116:119], v[20:23], v[120:123]
  v_cvt_pk_bf16_f32 v72, v40, v44
  v_cvt_pk_bf16_f32 v73, v41, v45
  v_mfma_f32_16x16x32_bf16 v[124:127], a[172:175], v[20:23], v[124:127]
  s_waitcnt lgkmcnt(4)
  v_cvt_pk_bf16_f32 v74, v42, v46
  v_mfma_f32_16x16x32_bf16 v[96:99], a[8:11], v[24:27], v[96:99]
  ds_read_b128 v[16:19], v128 offset:18432
  v_mfma_f32_16x16x32_bf16 v[100:103], a[64:67], v[24:27], v[100:103]
  v_cvt_pk_bf16_f32 v75, v43, v47
  v_mfma_f32_16x16x32_bf16 v[104:107], a[120:123], v[24:27], v[104:107]
  buffer_store_dwordx4 v[72:75], v90, s[8:11], s41 offen sc1
  v_cvt_pk_bf16_f32 v76, v48, v52
  v_mfma_f32_16x16x32_bf16 v[108:111], a[176:179], v[24:27], v[108:111]
  s_waitcnt lgkmcnt(4)
  v_cvt_pk_bf16_f32 v77, v49, v53
  v_mfma_f32_16x16x32_bf16 v[112:115], a[8:11], v[28:31], v[112:115]
  ds_read_b128 v[20:23], v128 offset:5120
  v_mfma_f32_16x16x32_bf16 v[116:119], a[64:67], v[28:31], v[116:119]
  v_cvt_pk_bf16_f32 v78, v50, v54
  v_cvt_pk_bf16_f32 v79, v51, v55
  v_mfma_f32_16x16x32_bf16 v[120:123], a[120:123], v[28:31], v[120:123]
  buffer_store_dwordx4 v[76:79], v90, s[8:11], s43 offen sc1
  s_lshl_b32 s42, s40, 5
  v_mfma_f32_16x16x32_bf16 v[124:127], a[176:179], v[28:31], v[124:127]
  s_waitcnt lgkmcnt(4)
  s_add_u32 s42, s42, 16
  v_mfma_f32_16x16x32_bf16 v[96:99], a[12:15], v[32:35], v[96:99]
  ds_read_b128 v[24:27], v128 offset:19456
  v_mfma_f32_16x16x32_bf16 v[100:103], a[68:71], v[32:35], v[100:103]
  v_add_u32 v88, s42, v4
  v_mul_u32_u24 v89, 2341, v88
  v_mfma_f32_16x16x32_bf16 v[104:107], a[124:127], v[32:35], v[104:107]
  v_lshrrev_b32 v89, 16, v89
  v_mul_u32_u24 v92, 28, v89
  v_mfma_f32_16x16x32_bf16 v[108:111], a[180:183], v[32:35], v[108:111]
  s_waitcnt lgkmcnt(4)
  v_sub_u32 v92, v88, v92
  v_mfma_f32_16x16x32_bf16 v[112:115], a[12:15], v[8:11], v[112:115]
  ds_read_b128 v[28:31], v128 offset:6144
  v_mfma_f32_16x16x32_bf16 v[116:119], a[68:71], v[8:11], v[116:119]
  v_cmp_gt_u32 vcc, 16, v92
  v_mul_u32_u24 v89, 84, v89
  v_mfma_f32_16x16x32_bf16 v[120:123], a[124:127], v[8:11], v[120:123]
  v_cndmask_b32 v92, v7, v6, vcc
  v_add3_u32 v88, v88, v89, v92
  v_mfma_f32_16x16x32_bf16 v[124:127], a[180:183], v[8:11], v[124:127]
  s_waitcnt lgkmcnt(4)
  v_lshlrev_b32 v91, 4, v88
  v_mfma_f32_16x16x32_bf16 v[96:99], a[16:19], v[12:15], v[96:99]
  ds_read_b128 v[32:35], v128 offset:20480
  v_mfma_f32_16x16x32_bf16 v[100:103], a[72:75], v[12:15], v[100:103]
  v_cvt_pk_bf16_f32 v80, v56, v60
  v_cvt_pk_bf16_f32 v81, v57, v61
  v_mfma_f32_16x16x32_bf16 v[104:107], a[128:131], v[12:15], v[104:107]
  v_cvt_pk_bf16_f32 v82, v58, v62
  v_cvt_pk_bf16_f32 v83, v59, v63
  v_mfma_f32_16x16x32_bf16 v[108:111], a[184:187], v[12:15], v[108:111]
  s_waitcnt lgkmcnt(4)
  buffer_store_dwordx4 v[80:83], v91, s[8:11], s41 offen sc1
  v_mfma_f32_16x16x32_bf16 v[112:115], a[16:19], v[16:19], v[112:115]
  ds_read_b128 v[8:11], v128 offset:7168
  v_mfma_f32_16x16x32_bf16 v[116:119], a[72:75], v[16:19], v[116:119]
  v_cvt_pk_bf16_f32 v84, v64, v68
  v_cvt_pk_bf16_f32 v85, v65, v69
  v_mfma_f32_16x16x32_bf16 v[120:123], a[128:131], v[16:19], v[120:123]
  v_cvt_pk_bf16_f32 v86, v66, v70
  v_cvt_pk_bf16_f32 v87, v67, v71
  v_mfma_f32_16x16x32_bf16 v[124:127], a[184:187], v[16:19], v[124:127]
  s_waitcnt lgkmcnt(4)
  buffer_store_dwordx4 v[84:87], v91, s[8:11], s43 offen sc1
  v_mfma_f32_16x16x32_bf16 v[96:99], a[20:23], v[20:23], v[96:99]
  ds_read_b128 v[12:15], v128 offset:21504
  v_mfma_f32_16x16x32_bf16 v[100:103], a[76:79], v[20:23], v[100:103]
  s_add_u32 s30, s19, 2
  s_lshl_b32 s24, s30, 1
  s_mul_i32 s24, s24, 14336
  v_mfma_f32_16x16x32_bf16 v[104:107], a[132:135], v[20:23], v[104:107]
  s_add_u32 s24, s24, s23
  s_cmp_lt_u32 s30, s35
  s_cselect_b32 s24, s24, 0x40000000
  v_mfma_f32_16x16x32_bf16 v[108:111], a[188:191], v[20:23], v[108:111]
  s_waitcnt lgkmcnt(4)
  s_add_u32 m0, s33, s27
  s_nop 0
  buffer_load_dwordx4 v2, s[8:11], s24 offen offset:0 sc1 lds
  v_mfma_f32_16x16x32_bf16 v[112:115], a[20:23], v[24:27], v[112:115]
  ds_read_b128 v[16:19], v128 offset:8192
  v_mfma_f32_16x16x32_bf16 v[116:119], a[76:79], v[24:27], v[116:119]
  v_mfma_f32_16x16x32_bf16 v[120:123], a[132:135], v[24:27], v[120:123]
  v_mfma_f32_16x16x32_bf16 v[124:127], a[188:191], v[24:27], v[124:127]
  s_waitcnt lgkmcnt(4)
  v_mfma_f32_16x16x32_bf16 v[96:99], a[24:27], v[28:31], v[96:99]
  ds_read_b128 v[20:23], v128 offset:22528
  v_mfma_f32_16x16x32_bf16 v[100:103], a[80:83], v[28:31], v[100:103]
  buffer_load_dwordx4 v2, s[8:11], s24 offen offset:1024 sc1 lds
  v_mfma_f32_16x16x32_bf16 v[104:107], a[136:139], v[28:31], v[104:107]
  v_mfma_f32_16x16x32_bf16 v[108:111], a[192:195], v[28:31], v[108:111]
  s_waitcnt lgkmcnt(4)
  v_mfma_f32_16x16x32_bf16 v[112:115], a[24:27], v[32:35], v[112:115]
  ds_read_b128 v[24:27], v128 offset:9216
  v_mfma_f32_16x16x32_bf16 v[116:119], a[80:83], v[32:35], v[116:119]
  v_mfma_f32_16x16x32_bf16 v[120:123], a[136:139], v[32:35], v[120:123]
  buffer_load_dwordx4 v2, s[8:11], s24 offen offset:2048 sc1 lds
  v_mfma_f32_16x16x32_bf16 v[124:127], a[192:195], v[32:35], v[124:127]
  s_waitcnt lgkmcnt(4)
  v_mfma_f32_16x16x32_bf16 v[96:99], a[28:31], v[8:11], v[96:99]
  ds_read_b128 v[28:31], v128 offset:23552
  v_mfma_f32_16x16x32_bf16 v[100:103], a[84:87], v[8:11], v[100:103]
  v_mfma_f32_16x16x32_bf16 v[104:107], a[140:143], v[8:11], v[104:107]
  v_mfma_f32_16x16x32_bf16 v[108:111], a[196:199], v[8:11], v[108:111]
  s_waitcnt lgkmcnt(4)
  buffer_load_dwordx4 v2, s[8:11], s24 offen offset:3072 sc1 lds
  v_mfma_f32_16x16x32_bf16 v[112:115], a[28:31], v[12:15], v[112:115]
  ds_read_b128 v[32:35], v128 offset:10240
  v_mfma_f32_16x16x32_bf16 v[116:119], a[84:87], v[12:15], v[116:119]
  v_mfma_f32_16x16x32_bf16 v[120:123], a[140:143], v[12:15], v[120:123]
  v_mfma_f32_16x16x32_bf16 v[124:127], a[196:199], v[12:15], v[124:127]
  s_waitcnt lgkmcnt(4)
  v_mfma_f32_16x16x32_bf16 v[96:99], a[32:35], v[16:19], v[96:99]
  ds_read_b128 v[8:11], v128 offset:24576
  v_mfma_f32_16x16x32_bf16 v[100:103], a[88:91], v[16:19], v[100:103]
  s_add_u32 m0, m0, 4096
  s_add_u32 s24, s24, 4096
  buffer_load_dwordx4 v2, s[8:11], s24 offen offset:0 sc1 lds
  v_mfma_f32_16x16x32_bf16 v[104:107], a[144:147], v[16:19], v[104:107]
  v_mfma_f32_16x16x32_bf16 v[108:111], a[200:203], v[16:19], v[108:111]
  s_waitcnt lgkmcnt(4)
  v_mfma_f32_16x16x32_bf16 v[112:115], a[32:35], v[20:23], v[112:115]
  ds_read_b128 v[12:15], v128 offset:11264
  v_mfma_f32_16x16x32_bf16 v[116:119], a[88:91], v[20:23], v[116:119]
  v_mfma_f32_16x16x32_bf16 v[120:123], a[144:147], v[20:23], v[120:123]
  buffer_load_dwordx4 v2, s[8:11], s24 offen offset:1024 sc1 lds
  v_mfma_f32_16x16x32_bf16 v[124:127], a[200:203], v[20:23], v[124:127]
  s_waitcnt lgkmcnt(4)
  v_mfma_f32_16x16x32_bf16 v[96:99], a[36:39], v[24:27], v[96:99]
  ds_read_b128 v[16:19], v128 offset:25600
  v_mfma_f32_16x16x32_bf16 v[100:103], a[92:95], v[24:27], v[100:103]
  v_mfma_f32_16x16x32_bf16 v[104:107], a[148:151], v[24:27], v[104:107]
  v_mfma_f32_16x16x32_bf16 v[108:111], a[204:207], v[24:27], v[108:111]
  s_waitcnt lgkmcnt(4)
  buffer_load_dwordx4 v2, s[8:11], s24 offen offset:2048 sc1 lds
  v_mfma_f32_16x16x32_bf16 v[112:115], a[36:39], v[28:31], v[112:115]
  ds_read_b128 v[20:23], v128 offset:12288
  v_mfma_f32_16x16x32_bf16 v[116:119], a[92:95], v[28:31], v[116:119]
  v_mfma_f32_16x16x32_bf16 v[120:123], a[148:151], v[28:31], v[120:123]
  v_mfma_f32_16x16x32_bf16 v[124:127], a[204:207], v[28:31], v[124:127]
  s_waitcnt lgkmcnt(4)
  v_mfma_f32_16x16x32_bf16 v[96:99], a[40:43], v[32:35], v[96:99]
  ds_read_b128 v[24:27], v128 offset:26624
  v_mfma_f32_16x16x32_bf16 v[100:103], a[96:99], v[32:35], v[100:103]
  s_add_u32 s33, s33, 28672
  s_cmp_eq_u32 s33, 114688
  s_cselect_b32 s33, 0, s33
  v_mfma_f32_16x16x32_bf16 v[104:107], a[152:155], v[32:35], v[104:107]
  s_add_u32 s32, s32, 28672
  s_cmp_eq_u32 s32, 114688
  s_cselect_b32 s32, 0, s32
  v_mfma_f32_16x16x32_bf16 v[108:111], a[208:211], v[32:35], v[108:111]
  s_waitcnt lgkmcnt(4)
  v_add_u32 v5, s32, v2
  v_mfma_f32_16x16x32_bf16 v[112:115], a[40:43], v[8:11], v[112:115]
  ds_read_b128 v[28:31], v128 offset:13312
  v_mfma_f32_16x16x32_bf16 v[116:119], a[96:99], v[8:11], v[116:119]
  v_mfma_f32_16x16x32_bf16 v[120:123], a[152:155], v[8:11], v[120:123]
  v_mfma_f32_16x16x32_bf16 v[124:127], a[208:211], v[8:11], v[124:127]
  s_waitcnt lgkmcnt(4)
  v_mfma_f32_16x16x32_bf16 v[96:99], a[44:47], v[12:15], v[96:99]
  ds_read_b128 v[32:35], v128 offset:27648
  v_mfma_f32_16x16x32_bf16 v[100:103], a[100:103], v[12:15], v[100:103]
  v_mfma_f32_16x16x32_bf16 v[104:107], a[156:159], v[12:15], v[104:107]
  v_mfma_f32_16x16x32_bf16 v[108:111], a[212:215], v[12:15], v[108:111]
  s_waitcnt lgkmcnt(4)
  v_mfma_f32_16x16x32_bf16 v[112:115], a[44:47], v[16:19], v[112:115]
  s_waitcnt vmcnt(11)
  s_barrier
  ds_read_b128 v[8:11], v5 offset:0
  v_mfma_f32_16x16x32_bf16 v[116:119], a[100:103], v[16:19], v[116:119]
  v_mfma_f32_16x16x32_bf16 v[120:123], a[156:159], v[16:19], v[120:123]
  v_mfma_f32_16x16x32_bf16 v[124:127], a[212:215], v[16:19], v[124:127]
  s_waitcnt lgkmcnt(4)
  v_mfma_f32_16x16x32_bf16 v[96:99], a[48:51], v[20:23], v[96:99]
  ds_read_b128 v[12:15], v5 offset:14336
  v_mfma_f32_16x16x32_bf16 v[100:103], a[104:107], v[20:23], v[100:103]
  v_mfma_f32_16x16x32_bf16 v[104:107], a[160:163], v[20:23], v[104:107]
  v_mfma_f32_16x16x32_bf16 v[108:111], a[216:219], v[20:23], v[108:111]
  s_waitcnt lgkmcnt(4)
  v_mfma_f32_16x16x32_bf16 v[112:115], a[48:51], v[24:27], v[112:115]
  ds_read_b128 v[16:19], v5 offset:1024
  v_mfma_f32_16x16x32_bf16 v[116:119], a[104:107], v[24:27], v[116:119]
  v_mfma_f32_16x16x32_bf16 v[120:123], a[160:163], v[24:27], v[120:123]
  v_mfma_f32_16x16x32_bf16 v[124:127], a[216:219], v[24:27], v[124:127]
  s_waitcnt lgkmcnt(4)
  v_mfma_f32_16x16x32_bf16 v[96:99], a[52:55], v[28:31], v[96:99]
  ds_read_b128 v[20:23], v5 offset:15360
  v_mfma_f32_16x16x32_bf16 v[100:103], a[108:111], v[28:31], v[100:103]
  v_mfma_f32_16x16x32_bf16 v[104:107], a[164:167], v[28:31], v[104:107]
  v_mfma_f32_16x16x32_bf16 v[108:111], a[220:223], v[28:31], v[108:111]
  s_waitcnt lgkmcnt(4)
  v_mfma_f32_16x16x32_bf16 v[112:115], a[52:55], v[32:35], v[112:115]
  ds_read_b128 v[24:27], v5 offset:2048
  v_mfma_f32_16x16x32_bf16 v[116:119], a[108:111], v[32:35], v[116:119]
  v_mfma_f32_16x16x32_bf16 v[120:123], a[164:167], v[32:35], v[120:123]
  v_mfma_f32_16x16x32_bf16 v[124:127], a[220:223], v[32:35], v[124:127]
  s_waitcnt lgkmcnt(4)
  s_mov_b32 s40, s19
  s_mov_b32 s41, s29
  s_add_u32 s19, s19, 1
  s_cmp_lt_u32 s19, s35
  s_cbranch_scc1 wg_vo_loop
  s_nop 3
  s_add_u32 s43, s41, 458752
  s_lshl_b32 s42, s40, 5
  s_add_u32 s42, s42, 0
  v_add_u32 v88, s42, v4
  v_mul_u32_u24 v89, 2341, v88
  v_lshrrev_b32 v89, 16, v89
  v_mul_u32_u24 v92, 28, v89
  v_sub_u32 v92, v88, v92
  v_cmp_gt_u32 vcc, 16, v92
  v_mul_u32_u24 v89, 84, v89
  s_nop 0
  v_cndmask_b32 v92, v7, v6, vcc
  v_add3_u32 v88, v88, v89, v92
  v_lshlrev_b32 v90, 4, v88
  v_cvt_pk_bf16_f32 v72, v96, v100
  v_cvt_pk_bf16_f32 v73, v97, v101
  v_cvt_pk_bf16_f32 v74, v98, v102
  v_cvt_pk_bf16_f32 v75, v99, v103
  buffer_store_dwordx4 v[72:75], v90, s[8:11], s41 offen sc1
  v_cvt_pk_bf16_f32 v76, v104, v108
  v_cvt_pk_bf16_f32 v77, v105, v109
  v_cvt_pk_bf16_f32 v78, v106, v110
  v_cvt_pk_bf16_f32 v79, v107, v111
  buffer_store_dwordx4 v[76:79], v90, s[8:11], s43 offen sc1
  s_lshl_b32 s42, s40, 5
  s_add_u32 s42, s42, 16
  v_add_u32 v88, s42, v4
  v_mul_u32_u24 v89, 2341, v88
  v_lshrrev_b32 v89, 16, v89
  v_mul_u32_u24 v92, 28, v89
  v_sub_u32 v92, v88, v92
  v_cmp_gt_u32 vcc, 16, v92
  v_mul_u32_u24 v89, 84, v89
  s_nop 0
  v_cndmask_b32 v92, v7, v6, vcc
  v_add3_u32 v88, v88, v89, v92
  v_lshlrev_b32 v91, 4, v88
  v_cvt_pk_bf16_f32 v80, v112, v116
  v_cvt_pk_bf16_f32 v81, v113, v117
  v_cvt_pk_bf16_f32 v82, v114, v118
  v_cvt_pk_bf16_f32 v83, v115, v119
  buffer_store_dwordx4 v[80:83], v91, s[8:11], s41 offen sc1
  v_cvt_pk_bf16_f32 v84, v120, v124
  v_cvt_pk_bf16_f32 v85, v121, v125
  v_cvt_pk_bf16_f32 v86, v122, v126
  v_cvt_pk_bf16_f32 v87, v123, v127
  buffer_store_dwordx4 v[84:87], v91, s[8:11], s43 offen sc1
  s_branch wg_done
wg_vo_e0:
  s_nop 7
  s_add_u32 s43, s41, 458752
  s_lshl_b32 s42, s40, 5
  s_add_u32 s42, s42, 0
  v_add_u32 v88, s42, v4
  v_mul_u32_u24 v89, 2341, v88
  v_lshrrev_b32 v89, 16, v89
  v_mul_u32_u24 v92, 28, v89
  v_sub_u32 v92, v88, v92
  v_cmp_gt_u32 vcc, 16, v92
  v_mul_u32_u24 v89, 84, v89
  s_nop 0
  v_cndmask_b32 v92, v7, v6, vcc
  v_add3_u32 v88, v88, v89, v92
  v_lshlrev_b32 v90, 4, v88
  v_cvt_pk_bf16_f32 v72, v40, v44
  v_cvt_pk_bf16_f32 v73, v41, v45
  v_cvt_pk_bf16_f32 v74, v42, v46
  v_cvt_pk_bf16_f32 v75, v43, v47
  buffer_store_dwordx4 v[72:75], v90, s[8:11], s41 offen sc1
  v_cvt_pk_bf16_f32 v76, v48, v52
  v_cvt_pk_bf16_f32 v77, v49, v53
  v_cvt_pk_bf16_f32 v78, v50, v54
  v_cvt_pk_bf16_f32 v79, v51, v55
  buffer_store_dwordx4 v[76:79], v90, s[8:11], s43 offen sc1
  s_lshl_b32 s42, s40, 5
  s_add_u32 s42, s42, 16
  v_add_u32 v88, s42, v4
  v_mul_u32_u24 v89, 2341, v88
  v_lshrrev_b32 v89, 16, v89
  v_mul_u32_u24 v92, 28, v89
  v_sub_u32 v92, v88, v92
  v_cmp_gt_u32 vcc, 16, v92
  v_mul_u32_u24 v89, 84, v89
  s_nop 0
  v_cndmask_b32 v92, v7, v6, vcc
  v_add3_u32 v88, v88, v89, v92
  v_lshlrev_b32 v91, 4, v88
  v_cvt_pk_bf16_f32 v80, v56, v60
  v_cvt_pk_bf16_f32 v81, v57, v61
  v_cvt_pk_bf16_f32 v82, v58, v62
  v_cvt_pk_bf16_f32 v83, v59, v63
  buffer_store_dwordx4 v[80:83], v91, s[8:11], s41 offen sc1
  v_cvt_pk_bf16_f32 v84, v64, v68
  v_cvt_pk_bf16_f32 v85, v65, v69
  v_cvt_pk_bf16_f32 v86, v66, v70
  v_cvt_pk_bf16_f32 v87, v67, v71
  buffer_store_dwordx4 v[84:87], v91, s[8:11], s43 offen sc1
  s_branch wg_done
wg_done:
  s_lshl_b32 s20, s18, 4
  s_and_b32 s21, s17, 15
  s_add_u32 s20, s20, s21
  s_lshl_b32 s20, s20, 7
  s_cmp_lt_u32 s17, 16
  s_cselect_b32 s21, 16384, 0
  s_add_u32 s20, s20, s21
  s_add_u32 s20, s20, 524288
  s_sub_u32 s21, s35, s34
  s_lshl_b32 s21, s21, 2
  v_mov_b32 v5, s21
  v_mov_b32 v6, 0
  s_waitcnt vmcnt(0) lgkmcnt(0)
  s_barrier
  s_cmp_lg_u32 s16, 0
  s_cbranch_scc1 wg_sg
  s_mov_b64 exec, 1
  buffer_atomic_add v5, v6, s[8:11], s20 offen
  s_mov_b64 exec, -1
wg_sg:
  s_branch wk_loop
wk_srv:
  s_mov_b32 s96, 7
  v_mov_b32 v4, 1
  v_mov_b32 v5, 587392
  v_mov_b32 v6, 160000
  s_barrier
  s_cmp_lg_u32 s16, 0
  s_cbranch_scc1 wk_sve1
  s_mov_b64 exec, 1
  buffer_atomic_add v4, v5, s[8:11], 0 offen sc0
  s_waitcnt vmcnt(0)
  ds_write_b32 v6, v4
  s_waitcnt lgkmcnt(0)
  s_mov_b64 exec, -1
wk_sve1:
  s_barrier
  ds_read_b32 v4, v6
  s_waitcnt lgkmcnt(0)
  v_readfirstlane_b32 s3, v4
  v_and_b32 v1, 63, v0
  v_lshlrev_b32 v2, 4, v1
  v_lshrrev_b32 v3, 4, v1
  v_and_b32 v4, 15, v1
  v_mov_b32 v250, 0
  s_cmp_ge_u32 s3, 32
  s_cbranch_scc1 wk_ask
  s_and_b32 s18, s3, 15
  s_lshr_b32 s19, s3, 4
  s_and_b32 s19, s19, 1
  s_mul_i32 s20, s18, 401408
  s_mul_i32 s21, s16, 100352
  s_add_u32 s20, s20, s21
  s_add_u32 s20, s20, 39976960
  s_add_u32 s22, s20, 0
  buffer_load_dwordx4 a[0:3], v2, s[8:11], s22 offen offset:0 sc1
  buffer_load_dwordx4 a[4:7], v2, s[8:11], s22 offen offset:1024 sc1
  buffer_load_dwordx4 a[8:11], v2, s[8:11], s22 offen offset:2048 sc1
  buffer_load_dwordx4 a[12:15], v2, s[8:11], s22 offen offset:3072 sc1
  s_add_u32 s22, s20, 4096
  buffer_load_dwordx4 a[16:19], v2, s[8:11], s22 offen offset:0 sc1
  buffer_load_dwordx4 a[20:23], v2, s[8:11], s22 offen offset:1024 sc1
  buffer_load_dwordx4 a[24:27], v2, s[8:11], s22 offen offset:2048 sc1
  buffer_load_dwordx4 a[28:31], v2, s[8:11], s22 offen offset:3072 sc1
  s_add_u32 s22, s20, 8192
  buffer_load_dwordx4 a[32:35], v2, s[8:11], s22 offen offset:0 sc1
  buffer_load_dwordx4 a[36:39], v2, s[8:11], s22 offen offset:1024 sc1
  s_waitcnt vmcnt(8)
  buffer_load_dwordx4 a[40:43], v2, s[8:11], s22 offen offset:2048 sc1
  buffer_load_dwordx4 a[44:47], v2, s[8:11], s22 offen offset:3072 sc1
  s_waitcnt vmcnt(8)
  s_add_u32 s22, s20, 12288
  buffer_load_dwordx4 a[48:51], v2, s[8:11], s22 offen offset:0 sc1
  buffer_load_dwordx4 a[52:55], v2, s[8:11], s22 offen offset:1024 sc1
  s_waitcnt vmcnt(8)
  buffer_load_dwordx4 a[56:59], v2, s[8:11], s22 offen offset:2048 sc1
  buffer_load_dwordx4 a[60:63], v2, s[8:11], s22 offen offset:3072 sc1
  s_waitcnt vmcnt(8)
  s_add_u32 s22, s20, 16384
  buffer_load_dwordx4 a[64:67], v2, s[8:11], s22 offen offset:0 sc1
  buffer_load_dwordx4 a[68:71], v2, s[8:11], s22 offen offset:1024 sc1
  s_waitcnt vmcnt(8)
  buffer_load_dwordx4 a[72:75], v2, s[8:11], s22 offen offset:2048 sc1
  buffer_load_dwordx4 a[76:79], v2, s[8:11], s22 offen offset:3072 sc1
  s_waitcnt vmcnt(8)
  s_add_u32 s22, s20, 20480
  buffer_load_dwordx4 a[80:83], v2, s[8:11], s22 offen offset:0 sc1
  buffer_load_dwordx4 a[84:87], v2, s[8:11], s22 offen offset:1024 sc1
  s_waitcnt vmcnt(8)
  buffer_load_dwordx4 a[88:91], v2, s[8:11], s22 offen offset:2048 sc1
  buffer_load_dwordx4 a[92:95], v2, s[8:11], s22 offen offset:3072 sc1
  s_waitcnt vmcnt(8)
  s_add_u32 s22, s20, 24576
  buffer_load_dwordx4 a[96:99], v2, s[8:11], s22 offen offset:0 sc1
  buffer_load_dwordx4 a[100:103], v2, s[8:11], s22 offen offset:1024 sc1
  s_waitcnt vmcnt(8)
  buffer_load_dwordx4 a[104:107], v2, s[8:11], s22 offen offset:2048 sc1
  buffer_load_dwordx4 a[108:111], v2, s[8:11], s22 offen offset:3072 sc1
  s_waitcnt vmcnt(8)
  s_add_u32 s22, s20, 28672
  buffer_load_dwordx4 a[112:115], v2, s[8:11], s22 offen offset:0 sc1
  buffer_load_dwordx4 a[116:119], v2, s[8:11], s22 offen offset:1024 sc1
  s_waitcnt vmcnt(8)
  buffer_load_dwordx4 a[120:123], v2, s[8:11], s22 offen offset:2048 sc1
  buffer_load_dwordx4 a[124:127], v2, s[8:11], s22 offen offset:3072 sc1
  s_waitcnt vmcnt(8)
  s_add_u32 s22, s20, 32768
  buffer_load_dwordx4 a[128:131], v2, s[8:11], s22 offen offset:0 sc1
  buffer_load_dwordx4 a[132:135], v2, s[8:11], s22 offen offset:1024 sc1
  s_waitcnt vmcnt(8)
  buffer_load_dwordx4 a[136:139], v2, s[8:11], s22 offen offset:2048 sc1
  buffer_load_dwordx4 a[140:143], v2, s[8:11], s22 offen offset:3072 sc1
  s_waitcnt vmcnt(8)
  s_add_u32 s22, s20, 36864
  buffer_load_dwordx4 a[144:147], v2, s[8:11], s22 offen offset:0 sc1
  buffer_load_dwordx4 a[148:151], v2, s[8:11], s22 offen offset:1024 sc1
  s_waitcnt vmcnt(8)
  buffer_load_dwordx4 a[152:155], v2, s[8:11], s22 offen offset:2048 sc1
  buffer_load_dwordx4 a[156:159], v2, s[8:11], s22 offen offset:3072 sc1
  s_waitcnt vmcnt(8)
  s_add_u32 s22, s20, 40960
  buffer_load_dwordx4 a[160:163], v2, s[8:11], s22 offen offset:0 sc1
  buffer_load_dwordx4 a[164:167], v2, s[8:11], s22 offen offset:1024 sc1
  s_waitcnt vmcnt(8)
  buffer_load_dwordx4 a[168:171], v2, s[8:11], s22 offen offset:2048 sc1
  buffer_load_dwordx4 a[172:175], v2, s[8:11], s22 offen offset:3072 sc1
  s_waitcnt vmcnt(8)
  s_add_u32 s22, s20, 45056
  buffer_load_dwordx4 a[176:179], v2, s[8:11], s22 offen offset:0 sc1
  buffer_load_dwordx4 a[180:183], v2, s[8:11], s22 offen offset:1024 sc1
  s_waitcnt vmcnt(8)
  buffer_load_dwordx4 a[184:187], v2, s[8:11], s22 offen offset:2048 sc1
  buffer_load_dwordx4 a[188:191], v2, s[8:11], s22 offen offset:3072 sc1
  s_waitcnt vmcnt(8)
  s_add_u32 s22, s20, 49152
  buffer_load_dwordx4 a[192:195], v2, s[8:11], s22 offen offset:0 sc1
  buffer_load_dwordx4 a[196:199], v2, s[8:11], s22 offen offset:1024 sc1
  s_waitcnt vmcnt(8)
  buffer_load_dwordx4 a[200:203], v2, s[8:11], s22 offen offset:2048 sc1
  buffer_load_dwordx4 a[204:207], v2, s[8:11], s22 offen offset:3072 sc1
  s_waitcnt vmcnt(8)
  s_add_u32 s22, s20, 53248
  buffer_load_dwordx4 a[208:211], v2, s[8:11], s22 offen offset:0 sc1
  buffer_load_dwordx4 a[212:215], v2, s[8:11], s22 offen offset:1024 sc1
  s_waitcnt vmcnt(8)
  buffer_load_dwordx4 a[216:219], v2, s[8:11], s22 offen offset:2048 sc1
  buffer_load_dwordx4 a[220:223], v2, s[8:11], s22 offen offset:3072 sc1
  s_waitcnt vmcnt(8)
  s_add_u32 s22, s20, 57344
  buffer_load_dwordx4 a[224:227], v2, s[8:11], s22 offen offset:0 sc1
  buffer_load_dwordx4 a[228:231], v2, s[8:11], s22 offen offset:1024 sc1
  s_waitcnt vmcnt(8)
  buffer_load_dwordx4 a[232:235], v2, s[8:11], s22 offen offset:2048 sc1
  buffer_load_dwordx4 a[236:239], v2, s[8:11], s22 offen offset:3072 sc1
  s_waitcnt vmcnt(8)
  s_add_u32 s22, s20, 61440
  buffer_load_dwordx4 a[240:243], v2, s[8:11], s22 offen offset:0 sc1
  buffer_load_dwordx4 a[244:247], v2, s[8:11], s22 offen offset:1024 sc1
  s_waitcnt vmcnt(8)
  buffer_load_dwordx4 a[248:251], v2, s[8:11], s22 offen offset:2048 sc1
  buffer_load_dwordx4 a[252:255], v2, s[8:11], s22 offen offset:3072 sc1
  s_waitcnt vmcnt(8)
  s_add_u32 s22, s20, 65536
  buffer_load_dwordx4 v[120:123], v2, s[8:11], s22 offen offset:0 sc1
  buffer_load_dwordx4 v[124:127], v2, s[8:11], s22 offen offset:1024 sc1
  s_waitcnt vmcnt(8)
  buffer_load_dwordx4 v[128:131], v2, s[8:11], s22 offen offset:2048 sc1
  buffer_load_dwordx4 v[132:135], v2, s[8:11], s22 offen offset:3072 sc1
  s_waitcnt vmcnt(8)
  s_add_u32 s22, s20, 69632
  buffer_load_dwordx4 v[136:139], v2, s[8:11], s22 offen offset:0 sc1
  buffer_load_dwordx4 v[140:143], v2, s[8:11], s22 offen offset:1024 sc1
  s_waitcnt vmcnt(8)
  buffer_load_dwordx4 v[144:147], v2, s[8:11], s22 offen offset:2048 sc1
  buffer_load_dwordx4 v[148:151], v2, s[8:11], s22 offen offset:3072 sc1
  s_waitcnt vmcnt(8)
  s_add_u32 s22, s20, 73728
  buffer_load_dwordx4 v[152:155], v2, s[8:11], s22 offen offset:0 sc1
  buffer_load_dwordx4 v[156:159], v2, s[8:11], s22 offen offset:1024 sc1
  s_waitcnt vmcnt(8)
  buffer_load_dwordx4 v[160:163], v2, s[8:11], s22 offen offset:2048 sc1
  buffer_load_dwordx4 v[164:167], v2, s[8:11], s22 offen offset:3072 sc1
  s_waitcnt vmcnt(8)
  s_add_u32 s22, s20, 77824
  buffer_load_dwordx4 v[168:171], v2, s[8:11], s22 offen offset:0 sc1
  buffer_load_dwordx4 v[172:175], v2, s[8:11], s22 offen offset:1024 sc1
  s_waitcnt vmcnt(8)
  buffer_load_dwordx4 v[176:179], v2, s[8:11], s22 offen offset:2048 sc1
  buffer_load_dwordx4 v[180:183], v2, s[8:11], s22 offen offset:3072 sc1
  s_waitcnt vmcnt(8)
  s_add_u32 s22, s20, 81920
  buffer_load_dwordx4 v[184:187], v2, s[8:11], s22 offen offset:0 sc1
  buffer_load_dwordx4 v[188:191], v2, s[8:11], s22 offen offset:1024 sc1
  s_waitcnt vmcnt(8)
  buffer_load_dwordx4 v[192:195], v2, s[8:11], s22 offen offset:2048 sc1
  buffer_load_dwordx4 v[196:199], v2, s[8:11], s22 offen offset:3072 sc1
  s_waitcnt vmcnt(8)
  s_add_u32 s22, s20, 86016
  buffer_load_dwordx4 v[200:203], v2, s[8:11], s22 offen offset:0 sc1
  buffer_load_dwordx4 v[204:207], v2, s[8:11], s22 offen offset:1024 sc1
  s_waitcnt vmcnt(8)
  buffer_load_dwordx4 v[208:211], v2, s[8:11], s22 offen offset:2048 sc1
  buffer_load_dwordx4 v[212:215], v2, s[8:11], s22 offen offset:3072 sc1
  s_waitcnt vmcnt(8)
  s_add_u32 s22, s20, 90112
  buffer_load_dwordx4 v[216:219], v2, s[8:11], s22 offen offset:0 sc1
  buffer_load_dwordx4 v[220:223], v2, s[8:11], s22 offen offset:1024 sc1
  s_waitcnt vmcnt(8)
  buffer_load_dwordx4 v[224:227], v2, s[8:11], s22 offen offset:2048 sc1
  buffer_load_dwordx4 v[228:231], v2, s[8:11], s22 offen offset:3072 sc1
  s_waitcnt vmcnt(8)
  s_add_u32 s22, s20, 94208
  buffer_load_dwordx4 v[232:235], v2, s[8:11], s22 offen offset:0 sc1
  buffer_load_dwordx4 v[236:239], v2, s[8:11], s22 offen offset:1024 sc1
  s_waitcnt vmcnt(8)
  buffer_load_dwordx4 v[240:243], v2, s[8:11], s22 offen offset:2048 sc1
  buffer_load_dwordx4 v[244:247], v2, s[8:11], s22 offen offset:3072 sc1
  s_waitcnt vmcnt(8)
  s_add_u32 s22, s20, 98304
  buffer_load_dwordx4 v[248:251], v2, s[8:11], s22 offen offset:0 sc1
  buffer_load_dwordx4 v[252:255], v2, s[8:11], s22 offen offset:1024 sc1
  s_waitcnt vmcnt(8)
  v_mov_b32 v5, 0x4444
  v_mov_b32 v6, 0xeeee
  v_cmp_lt_u32 vcc, 7, v4
  s_nop 1
  v_cndmask_b32 v5, v5, v6, vcc
  s_lshl_b32 s23, s16, 11
  v_lshrrev_b32 v80, 1, v3
  v_and_b32 v81, 1, v3
  v_add_u32 v82, 0, v80
  v_lshl_add_u32 v82, v82, 4, v4
  v_mul_u32_u24 v83, 2341, v82
  v_lshrrev_b32 v83, 16, v83
  v_mul_u32_u24 v84, 28, v83
  v_sub_u32 v84, v82, v84
  v_lshrrev_b32 v85, 4, v84
  v_and_b32 v84, 15, v84
  v_lshlrev_b32 v86, 10, v85
  v_lshl_add_u32 v86, v83, 8, v86
  v_lshl_add_u32 v86, v84, 4, v86
  v_lshl_add_u32 v86, v81, 3, v86
  v_add_u32 v72, s23, v86
  v_add_u32 v82, 2, v80
  v_lshl_add_u32 v82, v82, 4, v4
  v_mul_u32_u24 v83, 2341, v82
  v_lshrrev_b32 v83, 16, v83
  v_mul_u32_u24 v84, 28, v83
  v_sub_u32 v84, v82, v84
  v_lshrrev_b32 v85, 4, v84
  v_and_b32 v84, 15, v84
  v_lshlrev_b32 v86, 10, v85
  v_lshl_add_u32 v86, v83, 8, v86
  v_lshl_add_u32 v86, v84, 4, v86
  v_lshl_add_u32 v86, v81, 3, v86
  v_add_u32 v73, s23, v86
  v_add_u32 v82, 4, v80
  v_lshl_add_u32 v82, v82, 4, v4
  v_mul_u32_u24 v83, 2341, v82
  v_lshrrev_b32 v83, 16, v83
  v_mul_u32_u24 v84, 28, v83
  v_sub_u32 v84, v82, v84
  v_lshrrev_b32 v85, 4, v84
  v_and_b32 v84, 15, v84
  v_lshlrev_b32 v86, 10, v85
  v_lshl_add_u32 v86, v83, 8, v86
  v_lshl_add_u32 v86, v84, 4, v86
  v_lshl_add_u32 v86, v81, 3, v86
  v_add_u32 v74, s23, v86
  v_mov_b32 v82, 6
  v_lshl_add_u32 v82, v82, 4, v4
  v_mul_u32_u24 v83, 2341, v82
  v_lshrrev_b32 v83, 16, v83
  v_mul_u32_u24 v84, 28, v83
  v_sub_u32 v84, v82, v84
  v_lshrrev_b32 v85, 4, v84
  v_and_b32 v84, 15, v84
  v_lshlrev_b32 v86, 10, v85
  v_lshl_add_u32 v86, v83, 8, v86
  v_lshl_add_u32 v86, v84, 4, v86
  v_lshl_add_u32 v86, v81, 3, v86
  v_add_u32 v75, s23, v86
  v_add_u32 v76, s23, v2
  s_mul_i32 s27, s18, 448
  v_mov_b32 v77, s27
  v_mov_b32 v78, 1
  s_mov_b32 s17, s19
  s_mul_i32 s24, s19, 7168
  s_add_u32 s24, s24, 65536
  s_mul_i32 s25, s18, 65
  s_add_u32 s25, s25, s19
  s_lshl_b32 s25, s25, 13
  s_add_u32 s25, s25, s23
  s_add_u32 s25, s25, 77602816
  s_lshl_b32 s26, s18, 6
  s_add_u32 s26, s26, s19
  s_lshl_b32 s26, s26, 4
  s_lshl_b32 s27, s16, 2
  s_add_u32 s26, s26, s27
  s_add_u32 s26, s26, 565248
  v_mov_b32 v88, 0
  v_mov_b32 v89, 0
  v_mov_b32 v90, 0
  v_mov_b32 v91, 0
  v_mov_b32 v92, -1
  v_mov_b32 v93, -1
  v_mov_b32 v94, -1
  v_mov_b32 v95, -1
  ds_write_b128 v76, v[88:91]
  ds_write_b128 v76, v[88:91] offset:1024
  s_mov_b32 s28, s25
  s_mov_b32 s29, 0
ws_arm:
  buffer_store_dwordx4 v[92:95], v2, s[8:11], s28 offen sc1
  buffer_store_dwordx4 v[92:95], v2, s[8:11], s28 offen offset:1024 sc1
  s_waitcnt vmcnt(8)
  s_add_u32 s28, s28, 16384
  s_add_u32 s29, s29, 1
  s_cmp_lt_u32 s29, 31
  s_cbranch_scc1 ws_arm
  s_waitcnt vmcnt(0)
  s_mov_b64 exec, 1
  buffer_store_dword v78, v2, s[8:11], s26 offen sc1
  s_mov_b64 exec, -1
ws_loop:
  v_mov_b32 v36, 0
  v_mov_b32 v37, 0
  v_mov_b32 v38, 0
  v_mov_b32 v39, 0
  v_mov_b32 v40, 0
  v_mov_b32 v41, 0
  v_mov_b32 v42, 0
  v_mov_b32 v43, 0
  v_mov_b32 v44, 0
  v_mov_b32 v45, 0
  v_mov_b32 v46, 0
  v_mov_b32 v47, 0
  v_mov_b32 v48, 0
  v_mov_b32 v49, 0
  v_mov_b32 v50, 0
  v_mov_b32 v51, 0
  v_mov_b32 v52, 0
  v_mov_b32 v53, 0
  v_mov_b32 v54, 0
  v_mov_b32 v55, 0
  v_mov_b32 v56, 0
  v_mov_b32 v57, 0
  v_mov_b32 v58, 0
  v_mov_b32 v59, 0
  v_mov_b32 v60, 0
  v_mov_b32 v61, 0
  v_mov_b32 v62, 0
  v_mov_b32 v63, 0
  s_mov_b32 s30, 0
  s_branch ws_fl
ws_pm:
  s_cmp_ge_u32 s17, 64
  s_cbranch_scc1 ws_fl
  buffer_load_dword v79, v77, s[8:11], s24 offen sc1
  s_waitcnt vmcnt(0)
  v_cmp_eq_u32 vcc, -1, v79
  s_cbranch_vccnz ws_pr
ws_fl:
  s_add_u32 s22, s24, 4096
  buffer_load_dwordx4 v[8:11], v2, s[8:11], s24 offen offset:0 sc1
  buffer_load_dwordx4 v[12:15], v2, s[8:11], s24 offen offset:1024 sc1
  buffer_load_dwordx4 v[16:19], v2, s[8:11], s24 offen offset:2048 sc1
  buffer_load_dwordx4 v[20:23], v2, s[8:11], s24 offen offset:3072 sc1
  buffer_load_dwordx4 v[24:27], v2, s[8:11], s22 offen offset:0 sc1
  buffer_load_dwordx4 v[28:31], v2, s[8:11], s22 offen offset:1024 sc1
  buffer_load_dwordx4 v[32:35], v2, s[8:11], s22 offen offset:2048 sc1
  s_waitcnt vmcnt(0)
  v_max_u32 v79, v8, v9
  v_max3_u32 v79, v79, v10, v11
  v_max3_u32 v79, v79, v12, v13
  v_max3_u32 v79, v79, v14, v15
  v_max3_u32 v79, v79, v16, v17
  v_max3_u32 v79, v79, v18, v19
  v_max3_u32 v79, v79, v20, v21
  v_max3_u32 v79, v79, v22, v23
  v_max3_u32 v79, v79, v24, v25
  v_max3_u32 v79, v79, v26, v27
  v_max3_u32 v79, v79, v28, v29
  v_max3_u32 v79, v79, v30, v31
  v_max3_u32 v79, v79, v32, v33
  v_max3_u32 v79, v79, v34, v35
  v_cmp_eq_u32 vcc, -1, v79
  s_cbranch_vccz ws_pk
ws_pr:
  s_sleep 20
  s_add_u32 s30, s30, 1
  s_cmp_lt_u32 s30, 2000000
  s_cbranch_scc1 ws_pm
  s_branch cA_abort
ws_pk:
  v_smfmac_f32_16x16x64_bf16 v[36:39], v[8:11], a[0:7], v5
  v_smfmac_f32_16x16x64_bf16 v[36:39], v[12:15], a[8:15], v5
  v_smfmac_f32_16x16x64_bf16 v[36:39], v[16:19], a[16:23], v5
  v_smfmac_f32_16x16x64_bf16 v[36:39], v[20:23], a[24:31], v5
  v_smfmac_f32_16x16x64_bf16 v[36:39], v[24:27], a[32:39], v5
  v_smfmac_f32_16x16x64_bf16 v[36:39], v[28:31], a[40:47], v5
  v_smfmac_f32_16x16x64_bf16 v[36:39], v[32:35], a[48:55], v5
  v_smfmac_f32_16x16x64_bf16 v[40:43], v[8:11], a[56:63], v5
  v_smfmac_f32_16x16x64_bf16 v[40:43], v[12:15], a[64:71], v5
  v_smfmac_f32_16x16x64_bf16 v[40:43], v[16:19], a[72:79], v5
  v_smfmac_f32_16x16x64_bf16 v[40:43], v[20:23], a[80:87], v5
  v_smfmac_f32_16x16x64_bf16 v[40:43], v[24:27], a[88:95], v5
  v_smfmac_f32_16x16x64_bf16 v[40:43], v[28:31], a[96:103], v5
  v_smfmac_f32_16x16x64_bf16 v[40:43], v[32:35], a[104:111], v5
  v_smfmac_f32_16x16x64_bf16 v[44:47], v[8:11], a[112:119], v5
  v_smfmac_f32_16x16x64_bf16 v[44:47], v[12:15], a[120:127], v5
  v_smfmac_f32_16x16x64_bf16 v[44:47], v[16:19], a[128:135], v5
  v_smfmac_f32_16x16x64_bf16 v[44:47], v[20:23], a[136:143], v5
  v_smfmac_f32_16x16x64_bf16 v[44:47], v[24:27], a[144:151], v5
  v_smfmac_f32_16x16x64_bf16 v[44:47], v[28:31], a[152:159], v5
  v_smfmac_f32_16x16x64_bf16 v[44:47], v[32:35], a[160:167], v5
  v_smfmac_f32_16x16x64_bf16 v[48:51], v[8:11], a[168:175], v5
  v_smfmac_f32_16x16x64_bf16 v[48:51], v[12:15], a[176:183], v5
  v_smfmac_f32_16x16x64_bf16 v[48:51], v[16:19], a[184:191], v5
  v_smfmac_f32_16x16x64_bf16 v[48:51], v[20:23], a[192:199], v5
  v_smfmac_f32_16x16x64_bf16 v[48:51], v[24:27], a[200:207], v5
  v_smfmac_f32_16x16x64_bf16 v[48:51], v[28:31], a[208:215], v5
  v_smfmac_f32_16x16x64_bf16 v[48:51], v[32:35], a[216:223], v5
  v_smfmac_f32_16x16x64_bf16 v[52:55], v[8:11], a[224:231], v5
  v_smfmac_f32_16x16x64_bf16 v[52:55], v[12:15], a[232:239], v5
  v_smfmac_f32_16x16x64_bf16 v[52:55], v[16:19], a[240:247], v5
  v_smfmac_f32_16x16x64_bf16 v[52:55], v[20:23], a[248:255], v5
  v_smfmac_f32_16x16x64_bf16 v[52:55], v[24:27], v[120:127], v5
  v_smfmac_f32_16x16x64_bf16 v[52:55], v[28:31], v[128:135], v5
  v_smfmac_f32_16x16x64_bf16 v[52:55], v[32:35], v[136:143], v5
  v_smfmac_f32_16x16x64_bf16 v[56:59], v[8:11], v[144:151], v5
  v_smfmac_f32_16x16x64_bf16 v[56:59], v[12:15], v[152:159], v5
  v_smfmac_f32_16x16x64_bf16 v[56:59], v[16:19], v[160:167], v5
  v_smfmac_f32_16x16x64_bf16 v[56:59], v[20:23], v[168:175], v5
  v_smfmac_f32_16x16x64_bf16 v[56:59], v[24:27], v[176:183], v5
  v_smfmac_f32_16x16x64_bf16 v[56:59], v[28:31], v[184:191], v5
  v_smfmac_f32_16x16x64_bf16 v[56:59], v[32:35], v[192:199], v5
  v_smfmac_f32_16x16x64_bf16 v[60:63], v[8:11], v[200:207], v5
  v_smfmac_f32_16x16x64_bf16 v[60:63], v[12:15], v[208:215], v5
  v_smfmac_f32_16x16x64_bf16 v[60:63], v[16:19], v[216:223], v5
  v_smfmac_f32_16x16x64_bf16 v[60:63], v[20:23], v[224:231], v5
  v_smfmac_f32_16x16x64_bf16 v[60:63], v[24:27], v[232:239], v5
  v_smfmac_f32_16x16x64_bf16 v[60:63], v[28:31], v[240:247], v5
  v_smfmac_f32_16x16x64_bf16 v[60:63], v[32:35], v[248:255], v5
  v_permlane32_swap_b32 v36, v40
  v_permlane32_swap_b32 v37, v41
  v_permlane32_swap_b32 v38, v42
  v_permlane32_swap_b32 v39, v43
  v_add_f32 v36, v36, v40
  v_add_f32 v37, v37, v41
  v_add_f32 v38, v38, v42
  v_add_f32 v39, v39, v43
  v_cvt_pk_bf16_f32 v40, v36, v37
  v_cvt_pk_bf16_f32 v41, v38, v39
  v_min_u32 v40, -2, v40
  v_min_u32 v41, -2, v41
  ds_write_b64 v72, v[40:41]
  v_permlane32_swap_b32 v44, v48
  v_permlane32_swap_b32 v45, v49
  v_permlane32_swap_b32 v46, v50
  v_permlane32_swap_b32 v47, v51
  v_add_f32 v44, v44, v48
  v_add_f32 v45, v45, v49
  v_add_f32 v46, v46, v50
  v_add_f32 v47, v47, v51
  v_cvt_pk_bf16_f32 v48, v44, v45
  v_cvt_pk_bf16_f32 v49, v46, v47
  v_min_u32 v48, -2, v48
  v_min_u32 v49, -2, v49
  ds_write_b64 v73, v[48:49]
  v_permlane32_swap_b32 v52, v56
  v_permlane32_swap_b32 v53, v57
  v_permlane32_swap_b32 v54, v58
  v_permlane32_swap_b32 v55, v59
  v_add_f32 v52, v52, v56
  v_add_f32 v53, v53, v57
  v_add_f32 v54, v54, v58
  v_add_f32 v55, v55, v59
  v_cvt_pk_bf16_f32 v56, v52, v53
  v_cvt_pk_bf16_f32 v57, v54, v55
  v_min_u32 v56, -2, v56
  v_min_u32 v57, -2, v57
  ds_write_b64 v74, v[56:57]
  v_mov_b32 v64, v60
  v_mov_b32 v65, v61
  v_mov_b32 v66, v62
  v_mov_b32 v67, v63
  v_permlane32_swap_b32 v60, v64
  v_permlane32_swap_b32 v61, v65
  v_permlane32_swap_b32 v62, v66
  v_permlane32_swap_b32 v63, v67
  v_add_f32 v60, v60, v64
  v_add_f32 v61, v61, v65
  v_add_f32 v62, v62, v66
  v_add_f32 v63, v63, v67
  v_cvt_pk_bf16_f32 v64, v60, v61
  v_cvt_pk_bf16_f32 v65, v62, v63
  v_min_u32 v64, -2, v64
  v_min_u32 v65, -2, v65
  ds_write_b64 v75, v[64:65]
  s_waitcnt lgkmcnt(0)
  ds_read_b128 v[64:67], v76
  ds_read_b128 v[68:71], v76 offset:1024
  s_waitcnt lgkmcnt(0)
  buffer_store_dwordx4 v[64:67], v2, s[8:11], s25 offen sc1
  buffer_store_dwordx4 v[68:71], v2, s[8:11], s25 offen offset:1024 sc1
  s_add_u32 s24, s24, 14336
  s_add_u32 s25, s25, 16384
  s_add_u32 s17, s17, 2
  s_cmp_lt_u32 s17, 62
  s_cbranch_scc1 ws_loop
  v_mov_b32 v250, 0
  s_branch wk_loop
wk_s4d:
  s_sub_u32 s3, s3, 640
  s_getreg_b32 s33, hwreg(HW_REG_XCC_ID)
  s_sub_u32 s33, s33, 4
  s_and_b32 s33, s33, 7
  s_min_u32 s33, s33, 6
  s_mov_b32 s35, 6
wk_s4c:
  s_lshl_b32 s34, s33, 7
  s_add_u32 s34, s34, 588416
  v_mov_b32 v4, 1
  v_mov_b32 v5, s34
  v_mov_b32 v6, 160000
  s_barrier
  s_cmp_lg_u32 s16, 0
  s_cbranch_scc1 wk_s4e1
  s_mov_b64 exec, 1
  buffer_atomic_add v4, v5, s[8:11], 0 offen sc0
  s_waitcnt vmcnt(0)
  ds_write_b32 v6, v4
  s_waitcnt lgkmcnt(0)
  s_mov_b64 exec, -1
wk_s4e1:
  s_barrier
  ds_read_b32 v4, v6
  s_waitcnt lgkmcnt(0)
  v_readfirstlane_b32 s3, v4
  s_cmp_lt_u32 s3, 16
  s_cbranch_scc1 wk_s4g
  s_mov_b32 s33, s35
  s_sub_u32 s35, s35, 1
  s_max_i32 s35, s35, 0
  s_branch wk_s4c
wk_s4g:
  s_lshl_b32 s33, s33, 4
  s_add_u32 s3, s3, s33
  s_load_dwordx8 s[40:47], s[0:1], 0
  s_load_dwordx4 s[48:51], s[0:1], 32
  s_load_dwordx2 s[52:53], s[0:1], 48
  s_load_dwordx2 s[54:55], s[0:1], 112
  v_lshrrev_b32 v1, 6, v0
  s_nop 0
  v_readfirstlane_b32 s16, v1
  v_and_b32 v1, 63, v0
  v_lshrrev_b32 v3, 4, v1
  v_and_b32 v4, 15, v1
  s_mul_i32 s17, s16, 24576
  s_waitcnt lgkmcnt(0)
  s_mov_b32 s60, s40
  s_and_b32 s61, s41, 0xffff
  s_mov_b32 s62, 1835008
  s_mov_b32 s63, 0x20000
  s_mov_b32 s64, s42
  s_and_b32 s65, s43, 0xffff
  s_mov_b32 s66, 229376
  s_mov_b32 s67, 0x20000
  s_mov_b32 s68, s44
  s_and_b32 s69, s45, 0xffff
  s_mov_b32 s70, 229376
  s_mov_b32 s71, 0x20000
  s_mov_b32 s72, s46
  s_and_b32 s73, s47, 0xffff
  s_mov_b32 s74, 229376
  s_mov_b32 s75, 0x20000
  s_mov_b32 s76, s48
  s_and_b32 s77, s49, 0xffff
  s_mov_b32 s78, 229376
  s_mov_b32 s79, 0x20000
  s_mov_b32 s80, s50
  s_and_b32 s81, s51, 0xffff
  s_mov_b32 s82, 896
  s_mov_b32 s83, 0x20000
  s_mov_b32 s84, s52
  s_and_b32 s85, s53, 0xffff
  s_mov_b32 s86, 896
  s_mov_b32 s87, 0x20000
  s_mov_b32 s88, s54
  s_and_b32 s89, s55, 0xffff
  s_mov_b32 s90, 3670016
  s_mov_b32 s91, 0x20000
  v_lshlrev_b32 v5, 5, v1
  v_sub_u32 v5, 2047, v5
  s_add_u32 s18, s17, 13056
  v_subrev_u32 v6, 0, v5
  v_max_i32 v7, 0, v6
  v_cvt_f32_u32 v7, v7
  v_cvt_pk_bf16_f32 v8, v7, v7
  v_and_b32 v7, 0xffff0000, v8
  v_lshrrev_b32 v8, 23, v7
  v_subrev_u32 v8, 134, v8
  v_max_i32 v8, 0, v8
  v_cvt_u32_f32 v7, v7
  v_lshrrev_b32 v7, v8, v7
  v_lshl_add_u32 v7, v8, 8, v7
  v_lshl_add_u32 v200, v7, 2, s18
  v_subrev_u32 v6, 1, v5
  v_max_i32 v7, 0, v6
  v_cvt_f32_u32 v7, v7
  v_cvt_pk_bf16_f32 v8, v7, v7
  v_and_b32 v7, 0xffff0000, v8
  v_lshrrev_b32 v8, 23, v7
  v_subrev_u32 v8, 134, v8
  v_max_i32 v8, 0, v8
  v_cvt_u32_f32 v7, v7
  v_lshrrev_b32 v7, v8, v7
  v_lshl_add_u32 v7, v8, 8, v7
  v_lshl_add_u32 v201, v7, 2, s18
  v_subrev_u32 v6, 2, v5
  v_max_i32 v7, 0, v6
  v_cvt_f32_u32 v7, v7
  v_cvt_pk_bf16_f32 v8, v7, v7
  v_and_b32 v7, 0xffff0000, v8
  v_lshrrev_b32 v8, 23, v7
  v_subrev_u32 v8, 134, v8
  v_max_i32 v8, 0, v8
  v_cvt_u32_f32 v7, v7
  v_lshrrev_b32 v7, v8, v7
  v_lshl_add_u32 v7, v8, 8, v7
  v_lshl_add_u32 v202, v7, 2, s18
  v_subrev_u32 v6, 3, v5
  v_max_i32 v7, 0, v6
  v_cvt_f32_u32 v7, v7
  v_cvt_pk_bf16_f32 v8, v7, v7
  v_and_b32 v7, 0xffff0000, v8
  v_lshrrev_b32 v8, 23, v7
  v_subrev_u32 v8, 134, v8
  v_max_i32 v8, 0, v8
  v_cvt_u32_f32 v7, v7
  v_lshrrev_b32 v7, v8, v7
  v_lshl_add_u32 v7, v8, 8, v7
  v_lshl_add_u32 v203, v7, 2, s18
  v_subrev_u32 v6, 4, v5
  v_max_i32 v7, 0, v6
  v_cvt_f32_u32 v7, v7
  v_cvt_pk_bf16_f32 v8, v7, v7
  v_and_b32 v7, 0xffff0000, v8
  v_lshrrev_b32 v8, 23, v7
  v_subrev_u32 v8, 134, v8
  v_max_i32 v8, 0, v8
  v_cvt_u32_f32 v7, v7
  v_lshrrev_b32 v7, v8, v7
  v_lshl_add_u32 v7, v8, 8, v7
  v_lshl_add_u32 v204, v7, 2, s18
  v_subrev_u32 v6, 5, v5
  v_max_i32 v7, 0, v6
  v_cvt_f32_u32 v7, v7
  v_cvt_pk_bf16_f32 v8, v7, v7
  v_and_b32 v7, 0xffff0000, v8
  v_lshrrev_b32 v8, 23, v7
  v_subrev_u32 v8, 134, v8
  v_max_i32 v8, 0, v8
  v_cvt_u32_f32 v7, v7
  v_lshrrev_b32 v7, v8, v7
  v_lshl_add_u32 v7, v8, 8, v7
  v_lshl_add_u32 v205, v7, 2, s18
  v_subrev_u32 v6, 6, v5
  v_max_i32 v7, 0, v6
  v_cvt_f32_u32 v7, v7
  v_cvt_pk_bf16_f32 v8, v7, v7
  v_and_b32 v7, 0xffff0000, v8
  v_lshrrev_b32 v8, 23, v7
  v_subrev_u32 v8, 134, v8
  v_max_i32 v8, 0, v8
  v_cvt_u32_f32 v7, v7
  v_lshrrev_b32 v7, v8, v7
  v_lshl_add_u32 v7, v8, 8, v7
  v_lshl_add_u32 v206, v7, 2, s18
  v_subrev_u32 v6, 7, v5
  v_max_i32 v7, 0, v6
  v_cvt_f32_u32 v7, v7
  v_cvt_pk_bf16_f32 v8, v7, v7
  v_and_b32 v7, 0xffff0000, v8
  v_lshrrev_b32 v8, 23, v7
  v_subrev_u32 v8, 134, v8
  v_max_i32 v8, 0, v8
  v_cvt_u32_f32 v7, v7
  v_lshrrev_b32 v7, v8, v7
  v_lshl_add_u32 v7, v8, 8, v7
  v_lshl_add_u32 v207, v7, 2, s18
  v_subrev_u32 v6, 8, v5
  v_max_i32 v7, 0, v6
  v_cvt_f32_u32 v7, v7
  v_cvt_pk_bf16_f32 v8, v7, v7
  v_and_b32 v7, 0xffff0000, v8
  v_lshrrev_b32 v8, 23, v7
  v_subrev_u32 v8, 134, v8
  v_max_i32 v8, 0, v8
  v_cvt_u32_f32 v7, v7
  v_lshrrev_b32 v7, v8, v7
  v_lshl_add_u32 v7, v8, 8, v7
  v_lshl_add_u32 v208, v7, 2, s18
  v_subrev_u32 v6, 9, v5
  v_max_i32 v7, 0, v6
  v_cvt_f32_u32 v7, v7
  v_cvt_pk_bf16_f32 v8, v7, v7
  v_and_b32 v7, 0xffff0000, v8
  v_lshrrev_b32 v8, 23, v7
  v_subrev_u32 v8, 134, v8
  v_max_i32 v8, 0, v8
  v_cvt_u32_f32 v7, v7
  v_lshrrev_b32 v7, v8, v7
  v_lshl_add_u32 v7, v8, 8, v7
  v_lshl_add_u32 v209, v7, 2, s18
  v_subrev_u32 v6, 10, v5
  v_max_i32 v7, 0, v6
  v_cvt_f32_u32 v7, v7
  v_cvt_pk_bf16_f32 v8, v7, v7
  v_and_b32 v7, 0xffff0000, v8
  v_lshrrev_b32 v8, 23, v7
  v_subrev_u32 v8, 134, v8
  v_max_i32 v8, 0, v8
  v_cvt_u32_f32 v7, v7
  v_lshrrev_b32 v7, v8, v7
  v_lshl_add_u32 v7, v8, 8, v7
  v_lshl_add_u32 v210, v7, 2, s18
  v_subrev_u32 v6, 11, v5
  v_max_i32 v7, 0, v6
  v_cvt_f32_u32 v7, v7
  v_cvt_pk_bf16_f32 v8, v7, v7
  v_and_b32 v7, 0xffff0000, v8
  v_lshrrev_b32 v8, 23, v7
  v_subrev_u32 v8, 134, v8
  v_max_i32 v8, 0, v8
  v_cvt_u32_f32 v7, v7
  v_lshrrev_b32 v7, v8, v7
  v_lshl_add_u32 v7, v8, 8, v7
  v_lshl_add_u32 v211, v7, 2, s18
  v_subrev_u32 v6, 12, v5
  v_max_i32 v7, 0, v6
  v_cvt_f32_u32 v7, v7
  v_cvt_pk_bf16_f32 v8, v7, v7
  v_and_b32 v7, 0xffff0000, v8
  v_lshrrev_b32 v8, 23, v7
  v_subrev_u32 v8, 134, v8
  v_max_i32 v8, 0, v8
  v_cvt_u32_f32 v7, v7
  v_lshrrev_b32 v7, v8, v7
  v_lshl_add_u32 v7, v8, 8, v7
  v_lshl_add_u32 v212, v7, 2, s18
  v_subrev_u32 v6, 13, v5
  v_max_i32 v7, 0, v6
  v_cvt_f32_u32 v7, v7
  v_cvt_pk_bf16_f32 v8, v7, v7
  v_and_b32 v7, 0xffff0000, v8
  v_lshrrev_b32 v8, 23, v7
  v_subrev_u32 v8, 134, v8
  v_max_i32 v8, 0, v8
  v_cvt_u32_f32 v7, v7
  v_lshrrev_b32 v7, v8, v7
  v_lshl_add_u32 v7, v8, 8, v7
  v_lshl_add_u32 v213, v7, 2, s18
  v_subrev_u32 v6, 14, v5
  v_max_i32 v7, 0, v6
  v_cvt_f32_u32 v7, v7
  v_cvt_pk_bf16_f32 v8, v7, v7
  v_and_b32 v7, 0xffff0000, v8
  v_lshrrev_b32 v8, 23, v7
  v_subrev_u32 v8, 134, v8
  v_max_i32 v8, 0, v8
  v_cvt_u32_f32 v7, v7
  v_lshrrev_b32 v7, v8, v7
  v_lshl_add_u32 v7, v8, 8, v7
  v_lshl_add_u32 v214, v7, 2, s18
  v_subrev_u32 v6, 15, v5
  v_max_i32 v7, 0, v6
  v_cvt_f32_u32 v7, v7
  v_cvt_pk_bf16_f32 v8, v7, v7
  v_and_b32 v7, 0xffff0000, v8
  v_lshrrev_b32 v8, 23, v7
  v_subrev_u32 v8, 134, v8
  v_max_i32 v8, 0, v8
  v_cvt_u32_f32 v7, v7
  v_lshrrev_b32 v7, v8, v7
  v_lshl_add_u32 v7, v8, 8, v7
  v_lshl_add_u32 v215, v7, 2, s18
  v_subrev_u32 v6, 16, v5
  v_max_i32 v7, 0, v6
  v_cvt_f32_u32 v7, v7
  v_cvt_pk_bf16_f32 v8, v7, v7
  v_and_b32 v7, 0xffff0000, v8
  v_lshrrev_b32 v8, 23, v7
  v_subrev_u32 v8, 134, v8
  v_max_i32 v8, 0, v8
  v_cvt_u32_f32 v7, v7
  v_lshrrev_b32 v7, v8, v7
  v_lshl_add_u32 v7, v8, 8, v7
  v_lshl_add_u32 v216, v7, 2, s18
  v_subrev_u32 v6, 17, v5
  v_max_i32 v7, 0, v6
  v_cvt_f32_u32 v7, v7
  v_cvt_pk_bf16_f32 v8, v7, v7
  v_and_b32 v7, 0xffff0000, v8
  v_lshrrev_b32 v8, 23, v7
  v_subrev_u32 v8, 134, v8
  v_max_i32 v8, 0, v8
  v_cvt_u32_f32 v7, v7
  v_lshrrev_b32 v7, v8, v7
  v_lshl_add_u32 v7, v8, 8, v7
  v_lshl_add_u32 v217, v7, 2, s18
  v_subrev_u32 v6, 18, v5
  v_max_i32 v7, 0, v6
  v_cvt_f32_u32 v7, v7
  v_cvt_pk_bf16_f32 v8, v7, v7
  v_and_b32 v7, 0xffff0000, v8
  v_lshrrev_b32 v8, 23, v7
  v_subrev_u32 v8, 134, v8
  v_max_i32 v8, 0, v8
  v_cvt_u32_f32 v7, v7
  v_lshrrev_b32 v7, v8, v7
  v_lshl_add_u32 v7, v8, 8, v7
  v_lshl_add_u32 v218, v7, 2, s18
  v_subrev_u32 v6, 19, v5
  v_max_i32 v7, 0, v6
  v_cvt_f32_u32 v7, v7
  v_cvt_pk_bf16_f32 v8, v7, v7
  v_and_b32 v7, 0xffff0000, v8
  v_lshrrev_b32 v8, 23, v7
  v_subrev_u32 v8, 134, v8
  v_max_i32 v8, 0, v8
  v_cvt_u32_f32 v7, v7
  v_lshrrev_b32 v7, v8, v7
  v_lshl_add_u32 v7, v8, 8, v7
  v_lshl_add_u32 v219, v7, 2, s18
  v_subrev_u32 v6, 20, v5
  v_max_i32 v7, 0, v6
  v_cvt_f32_u32 v7, v7
  v_cvt_pk_bf16_f32 v8, v7, v7
  v_and_b32 v7, 0xffff0000, v8
  v_lshrrev_b32 v8, 23, v7
  v_subrev_u32 v8, 134, v8
  v_max_i32 v8, 0, v8
  v_cvt_u32_f32 v7, v7
  v_lshrrev_b32 v7, v8, v7
  v_lshl_add_u32 v7, v8, 8, v7
  v_lshl_add_u32 v220, v7, 2, s18
  v_subrev_u32 v6, 21, v5
  v_max_i32 v7, 0, v6
  v_cvt_f32_u32 v7, v7
  v_cvt_pk_bf16_f32 v8, v7, v7
  v_and_b32 v7, 0xffff0000, v8
  v_lshrrev_b32 v8, 23, v7
  v_subrev_u32 v8, 134, v8
  v_max_i32 v8, 0, v8
  v_cvt_u32_f32 v7, v7
  v_lshrrev_b32 v7, v8, v7
  v_lshl_add_u32 v7, v8, 8, v7
  v_lshl_add_u32 v221, v7, 2, s18
  v_subrev_u32 v6, 22, v5
  v_max_i32 v7, 0, v6
  v_cvt_f32_u32 v7, v7
  v_cvt_pk_bf16_f32 v8, v7, v7
  v_and_b32 v7, 0xffff0000, v8
  v_lshrrev_b32 v8, 23, v7
  v_subrev_u32 v8, 134, v8
  v_max_i32 v8, 0, v8
  v_cvt_u32_f32 v7, v7
  v_lshrrev_b32 v7, v8, v7
  v_lshl_add_u32 v7, v8, 8, v7
  v_lshl_add_u32 v222, v7, 2, s18
  v_subrev_u32 v6, 23, v5
  v_max_i32 v7, 0, v6
  v_cvt_f32_u32 v7, v7
  v_cvt_pk_bf16_f32 v8, v7, v7
  v_and_b32 v7, 0xffff0000, v8
  v_lshrrev_b32 v8, 23, v7
  v_subrev_u32 v8, 134, v8
  v_max_i32 v8, 0, v8
  v_cvt_u32_f32 v7, v7
  v_lshrrev_b32 v7, v8, v7
  v_lshl_add_u32 v7, v8, 8, v7
  v_lshl_add_u32 v223, v7, 2, s18
  v_subrev_u32 v6, 24, v5
  v_max_i32 v7, 0, v6
  v_cvt_f32_u32 v7, v7
  v_cvt_pk_bf16_f32 v8, v7, v7
  v_and_b32 v7, 0xffff0000, v8
  v_lshrrev_b32 v8, 23, v7
  v_subrev_u32 v8, 134, v8
  v_max_i32 v8, 0, v8
  v_cvt_u32_f32 v7, v7
  v_lshrrev_b32 v7, v8, v7
  v_lshl_add_u32 v7, v8, 8, v7
  v_lshl_add_u32 v224, v7, 2, s18
  v_subrev_u32 v6, 25, v5
  v_max_i32 v7, 0, v6
  v_cvt_f32_u32 v7, v7
  v_cvt_pk_bf16_f32 v8, v7, v7
  v_and_b32 v7, 0xffff0000, v8
  v_lshrrev_b32 v8, 23, v7
  v_subrev_u32 v8, 134, v8
  v_max_i32 v8, 0, v8
  v_cvt_u32_f32 v7, v7
  v_lshrrev_b32 v7, v8, v7
  v_lshl_add_u32 v7, v8, 8, v7
  v_lshl_add_u32 v225, v7, 2, s18
  v_subrev_u32 v6, 26, v5
  v_max_i32 v7, 0, v6
  v_cvt_f32_u32 v7, v7
  v_cvt_pk_bf16_f32 v8, v7, v7
  v_and_b32 v7, 0xffff0000, v8
  v_lshrrev_b32 v8, 23, v7
  v_subrev_u32 v8, 134, v8
  v_max_i32 v8, 0, v8
  v_cvt_u32_f32 v7, v7
  v_lshrrev_b32 v7, v8, v7
  v_lshl_add_u32 v7, v8, 8, v7
  v_lshl_add_u32 v226, v7, 2, s18
  v_subrev_u32 v6, 27, v5
  v_max_i32 v7, 0, v6
  v_cvt_f32_u32 v7, v7
  v_cvt_pk_bf16_f32 v8, v7, v7
  v_and_b32 v7, 0xffff0000, v8
  v_lshrrev_b32 v8, 23, v7
  v_subrev_u32 v8, 134, v8
  v_max_i32 v8, 0, v8
  v_cvt_u32_f32 v7, v7
  v_lshrrev_b32 v7, v8, v7
  v_lshl_add_u32 v7, v8, 8, v7
  v_lshl_add_u32 v227, v7, 2, s18
  v_subrev_u32 v6, 28, v5
  v_max_i32 v7, 0, v6
  v_cvt_f32_u32 v7, v7
  v_cvt_pk_bf16_f32 v8, v7, v7
  v_and_b32 v7, 0xffff0000, v8
  v_lshrrev_b32 v8, 23, v7
  v_subrev_u32 v8, 134, v8
  v_max_i32 v8, 0, v8
  v_cvt_u32_f32 v7, v7
  v_lshrrev_b32 v7, v8, v7
  v_lshl_add_u32 v7, v8, 8, v7
  v_lshl_add_u32 v228, v7, 2, s18
  v_subrev_u32 v6, 29, v5
  v_max_i32 v7, 0, v6
  v_cvt_f32_u32 v7, v7
  v_cvt_pk_bf16_f32 v8, v7, v7
  v_and_b32 v7, 0xffff0000, v8
  v_lshrrev_b32 v8, 23, v7
  v_subrev_u32 v8, 134, v8
  v_max_i32 v8, 0, v8
  v_cvt_u32_f32 v7, v7
  v_lshrrev_b32 v7, v8, v7
  v_lshl_add_u32 v7, v8, 8, v7
  v_lshl_add_u32 v229, v7, 2, s18
  v_subrev_u32 v6, 30, v5
  v_max_i32 v7, 0, v6
  v_cvt_f32_u32 v7, v7
  v_cvt_pk_bf16_f32 v8, v7, v7
  v_and_b32 v7, 0xffff0000, v8
  v_lshrrev_b32 v8, 23, v7
  v_subrev_u32 v8, 134, v8
  v_max_i32 v8, 0, v8
  v_cvt_u32_f32 v7, v7
  v_lshrrev_b32 v7, v8, v7
  v_lshl_add_u32 v7, v8, 8, v7
  v_lshl_add_u32 v230, v7, 2, s18
  v_subrev_u32 v6, 31, v5
  v_max_i32 v7, 0, v6
  v_cvt_f32_u32 v7, v7
  v_cvt_pk_bf16_f32 v8, v7, v7
  v_and_b32 v7, 0xffff0000, v8
  v_lshrrev_b32 v8, 23, v7
  v_subrev_u32 v8, 134, v8
  v_max_i32 v8, 0, v8
  v_cvt_u32_f32 v7, v7
  v_lshrrev_b32 v7, v8, v7
  v_lshl_add_u32 v7, v8, 8, v7
  v_lshl_add_u32 v231, v7, 2, s18
  v_subrev_u32 v6, 32, v5
  v_max_i32 v7, 0, v6
  v_cvt_f32_u32 v7, v7
  v_cvt_pk_bf16_f32 v8, v7, v7
  v_and_b32 v7, 0xffff0000, v8
  v_lshrrev_b32 v8, 23, v7
  v_subrev_u32 v8, 134, v8
  v_max_i32 v8, 0, v8
  v_cvt_u32_f32 v7, v7
  v_lshrrev_b32 v7, v8, v7
  v_lshl_add_u32 v7, v8, 8, v7
  v_mov_b32 v8, 1280
  v_cmp_gt_i32 vcc, 0, v6
  s_nop 1
  v_cndmask_b32 v7, v7, v8, vcc
  v_lshl_add_u32 v232, v7, 2, s18
  v_mov_b32 v8, 0
  v_mov_b32 v9, 0
  v_lshlrev_b32 v5, 3, v1
  v_add_u32 v5, s17, v5
  ds_write_b64 v5, v[8:9]
  v_and_b32 v6, 15, v1
  v_lshlrev_b32 v6, 3, v6
  v_add_u32 v6, s17, v6
  ds_write_b64 v6, v[8:9] offset:8704
  ds_write_b64 v6, v[8:9] offset:12928
  v_mov_b32 v6, s17
  ds_write_b64 v6, v[8:9] offset:18176
  s_lshl_b32 s19, s3, 2
  s_add_u32 s20, s19, s16
  s_lshl_b32 s21, s3, 3
  v_mul_u32_u24 v5, 3584, v0
  s_add_u32 s22, s21, 0
  buffer_load_dwordx2 v[8:9], v5, s[60:63], s22 offen offset:0
  buffer_load_dwordx2 v[10:11], v5, s[60:63], s22 offen offset:896
  buffer_load_dwordx2 v[12:13], v5, s[60:63], s22 offen offset:1792
  buffer_load_dwordx2 v[14:15], v5, s[60:63], s22 offen offset:2688
  s_add_u32 s22, s21, 917504
  buffer_load_dwordx2 v[16:17], v5, s[60:63], s22 offen offset:0
  buffer_load_dwordx2 v[18:19], v5, s[60:63], s22 offen offset:896
  buffer_load_dwordx2 v[20:21], v5, s[60:63], s22 offen offset:1792
  buffer_load_dwordx2 v[22:23], v5, s[60:63], s22 offen offset:2688
  s_lshl_b32 s22, s20, 9
  v_lshlrev_b32 v6, 3, v1
  buffer_load_dwordx2 v[24:25], v6, s[64:67], s22 offen
  buffer_load_dwordx2 v[26:27], v6, s[68:71], s22 offen
  buffer_load_dwordx2 v[28:29], v6, s[72:75], s22 offen
  buffer_load_dwordx2 v[30:31], v6, s[76:79], s22 offen
  s_lshl_b32 s22, s20, 1
  v_mov_b32 v7, 0
  buffer_load_ushort v32, v7, s[80:83], s22 offen
  buffer_load_ushort v33, v7, s[84:87], s22 offen
  s_mov_b32 s24, 0x05040100
  s_mov_b32 s25, 0x07060302
  s_barrier
  s_waitcnt vmcnt(6)
  v_lshlrev_b32 v6, 3, v0
  v_perm_b32 v34, v10, v8, s24
  v_perm_b32 v35, v14, v12, s24
  v_add_u32 v36, 512, v6
  ds_write_b64 v36, v[34:35]
  v_perm_b32 v34, v10, v8, s25
  v_perm_b32 v35, v14, v12, s25
  v_add_u32 v36, 25088, v6
  ds_write_b64 v36, v[34:35]
  v_perm_b32 v34, v11, v9, s24
  v_perm_b32 v35, v15, v13, s24
  v_add_u32 v36, 49664, v6
  ds_write_b64 v36, v[34:35]
  v_perm_b32 v34, v11, v9, s25
  v_perm_b32 v35, v15, v13, s25
  v_add_u32 v36, 74240, v6
  ds_write_b64 v36, v[34:35]
  v_perm_b32 v34, v18, v16, s24
  v_perm_b32 v35, v22, v20, s24
  v_add_u32 v36, 2560, v6
  ds_write_b64 v36, v[34:35]
  v_perm_b32 v34, v18, v16, s25
  v_perm_b32 v35, v22, v20, s25
  v_add_u32 v36, 27136, v6
  ds_write_b64 v36, v[34:35]
  v_perm_b32 v34, v19, v17, s24
  v_perm_b32 v35, v23, v21, s24
  v_add_u32 v36, 51712, v6
  ds_write_b64 v36, v[34:35]
  v_perm_b32 v34, v19, v17, s25
  v_perm_b32 v35, v23, v21, s25
  v_add_u32 v36, 76288, v6
  ds_write_b64 v36, v[34:35]
  s_waitcnt vmcnt(0)
  s_mov_b32 s26, 1069066811
  s_mov_b32 s27, 1042479491
  v_lshlrev_b32 v32, 16, v32
  v_lshlrev_b32 v33, 16, v33
  v_mul_f32 v32, s26, v32
  v_exp_f32 v32, v32
  s_nop 0
  v_cvt_pk_bf16_f32 v34, v32, v32
  v_and_b32 v32, 0xffff0000, v34
  v_lshlrev_b32 v37, 6, v1
  v_add_u32 v37, s17, v37
  v_lshlrev_b32 v40, 16, v24
  v_lshlrev_b32 v41, 16, v26
  v_lshlrev_b32 v42, 16, v28
  v_lshlrev_b32 v43, 16, v30
  v_mul_f32 v40, s26, v40
  v_exp_f32 v40, v40
  s_nop 0
  v_cvt_pk_bf16_f32 v34, v40, v40
  v_and_b32 v40, 0xffff0000, v34
  v_mul_f32 v40, v40, v32
  v_mul_f32 v40, s26, v40
  v_sub_f32 v40, 0, v40
  v_mul_f32 v41, v41, v32
  v_mul_f32 v41, s27, v41
  v_mul_f32 v42, v42, v32
  v_mul_f32 v43, v43, v32
  v_add_f32 v42, v42, v42
  v_add_f32 v43, v43, v43
  ds_write_b128 v37, v[40:43] offset:18240
  v_and_b32 v40, 0xffff0000, v24
  v_and_b32 v41, 0xffff0000, v26
  v_and_b32 v42, 0xffff0000, v28
  v_and_b32 v43, 0xffff0000, v30
  v_mul_f32 v40, s26, v40
  v_exp_f32 v40, v40
  s_nop 0
  v_cvt_pk_bf16_f32 v34, v40, v40
  v_and_b32 v40, 0xffff0000, v34
  v_mul_f32 v40, v40, v32
  v_mul_f32 v40, s26, v40
  v_sub_f32 v40, 0, v40
  v_mul_f32 v41, v41, v32
  v_mul_f32 v41, s27, v41
  v_mul_f32 v42, v42, v32
  v_mul_f32 v43, v43, v32
  v_add_f32 v42, v42, v42
  v_add_f32 v43, v43, v43
  ds_write_b128 v37, v[40:43] offset:18256
  v_lshlrev_b32 v40, 16, v25
  v_lshlrev_b32 v41, 16, v27
  v_lshlrev_b32 v42, 16, v29
  v_lshlrev_b32 v43, 16, v31
  v_mul_f32 v40, s26, v40
  v_exp_f32 v40, v40
  s_nop 0
  v_cvt_pk_bf16_f32 v34, v40, v40
  v_and_b32 v40, 0xffff0000, v34
  v_mul_f32 v40, v40, v32
  v_mul_f32 v40, s26, v40
  v_sub_f32 v40, 0, v40
  v_mul_f32 v41, v41, v32
  v_mul_f32 v41, s27, v41
  v_mul_f32 v42, v42, v32
  v_mul_f32 v43, v43, v32
  v_add_f32 v42, v42, v42
  v_add_f32 v43, v43, v43
  ds_write_b128 v37, v[40:43] offset:18272
  v_and_b32 v40, 0xffff0000, v25
  v_and_b32 v41, 0xffff0000, v27
  v_and_b32 v42, 0xffff0000, v29
  v_and_b32 v43, 0xffff0000, v31
  v_mul_f32 v40, s26, v40
  v_exp_f32 v40, v40
  s_nop 0
  v_cvt_pk_bf16_f32 v34, v40, v40
  v_and_b32 v40, 0xffff0000, v34
  v_mul_f32 v40, v40, v32
  v_mul_f32 v40, s26, v40
  v_sub_f32 v40, 0, v40
  v_mul_f32 v41, v41, v32
  v_mul_f32 v41, s27, v41
  v_mul_f32 v42, v42, v32
  v_mul_f32 v43, v43, v32
  v_add_f32 v42, v42, v42
  v_add_f32 v43, v43, v43
  ds_write_b128 v37, v[40:43] offset:18288
  v_cvt_f32_u32 v44, v4
  v_lshlrev_b32 v45, 4, v4
  v_cvt_f32_u32 v45, v45
  v_lshlrev_b32 v46, 4, v3
  v_add_u32 v46, s17, v46
  v_mov_b32 v48, 0
  v_mov_b32 v49, 0
  v_mov_b32 v50, 0
  v_mov_b32 v51, 0
  v_mov_b32 v52, 0
  v_mov_b32 v53, 0
  v_mov_b32 v54, 0
  v_mov_b32 v55, 0
  v_mov_b32 v56, 0
  v_mov_b32 v57, 0
  v_mov_b32 v58, 0
  v_mov_b32 v59, 0
  v_mov_b32 v60, 0
  v_mov_b32 v61, 0
  v_mov_b32 v62, 0
  v_mov_b32 v63, 0
  v_mov_b32 v64, 0
  v_mov_b32 v65, 0
  v_mov_b32 v66, 0
  v_mov_b32 v67, 0
  s_mov_b32 s28, 0
  s_waitcnt lgkmcnt(0)
  ds_read_b128 v[68:71], v46 offset:18240
wk_kl:
  s_waitcnt lgkmcnt(0)
  v_mov_b32 v72, v68
  v_mov_b32 v73, v69
  v_mov_b32 v74, v70
  v_mov_b32 v75, v71
  v_add_u32 v46, 64, v46
  ds_read_b128 v[68:71], v46 offset:18240
  v_mul_f32 v80, v72, v45
  v_mul_f32 v81, v73, v45
  v_exp_f32 v80, v80
  v_fract_f32 v81, v81
  v_cos_f32 v76, v81
  v_sin_f32 v77, v81
  v_mul_f32 v76, v76, v80
  v_mul_f32 v77, v77, v80
  v_mul_f32 v80, v72, v44
  v_mul_f32 v81, v73, v44
  v_exp_f32 v80, v80
  v_fract_f32 v81, v81
  v_cos_f32 v78, v81
  v_sin_f32 v79, v81
  v_mul_f32 v78, v78, v80
  v_mul_f32 v79, v79, v80
  v_mul_f32 v82, v74, v76
  v_mul_f32 v83, v74, v77
  v_fma_f32 v82, -v75, v77, v82
  v_fma_f32 v83, -v75, v76, -v83
  v_mul_f32 v86, v76, v76
  v_mul_f32 v87, v76, v77
  v_fma_f32 v86, -v77, v77, v86
  v_add_f32 v87, v87, v87
  v_mfma_f32_16x16x4_f32 v[48:51], v82, v78, v[48:51]
  v_mul_f32 v88, v78, v78
  v_mul_f32 v89, v78, v79
  v_fma_f32 v88, -v79, v79, v88
  v_add_f32 v89, v89, v89
  v_mfma_f32_16x16x4_f32 v[48:51], v83, v79, v[48:51]
  v_mul_f32 v84, v74, v86
  v_mul_f32 v85, v74, v87
  v_fma_f32 v84, -v75, v87, v84
  v_fma_f32 v85, -v75, v86, -v85
  v_mul_f32 v76, v86, v86
  v_mul_f32 v77, v86, v87
  v_fma_f32 v76, -v87, v87, v76
  v_add_f32 v77, v77, v77
  v_mfma_f32_16x16x4_f32 v[52:55], v84, v88, v[52:55]
  v_mul_f32 v78, v88, v88
  v_mul_f32 v79, v88, v89
  v_fma_f32 v78, -v89, v89, v78
  v_add_f32 v79, v79, v79
  v_mfma_f32_16x16x4_f32 v[52:55], v85, v89, v[52:55]
  v_mul_f32 v82, v74, v76
  v_mul_f32 v83, v74, v77
  v_fma_f32 v82, -v75, v77, v82
  v_fma_f32 v83, -v75, v76, -v83
  v_mul_f32 v86, v76, v76
  v_mul_f32 v87, v76, v77
  v_fma_f32 v86, -v77, v77, v86
  v_add_f32 v87, v87, v87
  v_mfma_f32_16x16x4_f32 v[56:59], v82, v78, v[56:59]
  v_mul_f32 v88, v78, v78
  v_mul_f32 v89, v78, v79
  v_fma_f32 v88, -v79, v79, v88
  v_add_f32 v89, v89, v89
  v_mfma_f32_16x16x4_f32 v[56:59], v83, v79, v[56:59]
  v_mul_f32 v84, v74, v86
  v_mul_f32 v85, v74, v87
  v_fma_f32 v84, -v75, v87, v84
  v_fma_f32 v85, -v75, v86, -v85
  v_mul_f32 v76, v86, v86
  v_mul_f32 v77, v86, v87
  v_fma_f32 v76, -v87, v87, v76
  v_add_f32 v77, v77, v77
  v_mfma_f32_16x16x4_f32 v[60:63], v84, v88, v[60:63]
  v_mfma_f32_16x16x4_f32 v[60:63], v85, v89, v[60:63]
  v_mul_f32 v82, v74, v76
  v_fma_f32 v82, -v75, v77, v82
  s_nop 1
  v_mfma_f32_16x16x4_f32 v[64:67], v82, v88, v[64:67]
  s_add_u32 s28, s28, 1
  s_cmp_lt_u32 s28, 64
  s_cbranch_scc1 wk_kl
  s_nop 15
  s_nop 3
  v_lshlrev_b32 v46, 8, v3
  v_lshl_add_u32 v46, v4, 2, v46
  v_add_u32 v46, s17, v46
  ds_write_b32 v46, v48 offset:13056
  ds_write_b32 v46, v49 offset:13120
  ds_write_b32 v46, v50 offset:13184
  ds_write_b32 v46, v51 offset:13248
  s_waitcnt lgkmcnt(8)
  ds_write_b32 v46, v52 offset:14080
  ds_write_b32 v46, v53 offset:14144
  ds_write_b32 v46, v54 offset:14208
  ds_write_b32 v46, v55 offset:14272
  s_waitcnt lgkmcnt(8)
  ds_write_b32 v46, v56 offset:15104
  ds_write_b32 v46, v57 offset:15168
  ds_write_b32 v46, v58 offset:15232
  ds_write_b32 v46, v59 offset:15296
  s_waitcnt lgkmcnt(8)
  ds_write_b32 v46, v60 offset:16128
  ds_write_b32 v46, v61 offset:16192
  ds_write_b32 v46, v62 offset:16256
  ds_write_b32 v46, v63 offset:16320
  s_waitcnt lgkmcnt(8)
  ds_write_b32 v46, v64 offset:17152
  ds_write_b32 v46, v65 offset:17216
  ds_write_b32 v46, v66 offset:17280
  ds_write_b32 v46, v67 offset:17344
  s_waitcnt lgkmcnt(8)
  s_waitcnt lgkmcnt(0)
  ds_read_b32 v48, v200
  ds_read_b32 v49, v201
  ds_read_b32 v50, v202
  ds_read_b32 v51, v203
  ds_read_b32 v52, v204
  ds_read_b32 v53, v205
  ds_read_b32 v54, v206
  ds_read_b32 v55, v207
  s_waitcnt lgkmcnt(4)
  ds_read_b32 v56, v208
  ds_read_b32 v57, v209
  ds_read_b32 v58, v210
  ds_read_b32 v59, v211
  ds_read_b32 v60, v212
  ds_read_b32 v61, v213
  ds_read_b32 v62, v214
  ds_read_b32 v63, v215
  s_waitcnt lgkmcnt(4)
  ds_read_b32 v64, v216
  ds_read_b32 v65, v217
  ds_read_b32 v66, v218
  ds_read_b32 v67, v219
  ds_read_b32 v68, v220
  ds_read_b32 v69, v221
  ds_read_b32 v70, v222
  ds_read_b32 v71, v223
  s_waitcnt lgkmcnt(4)
  ds_read_b32 v72, v224
  ds_read_b32 v73, v225
  ds_read_b32 v74, v226
  ds_read_b32 v75, v227
  ds_read_b32 v76, v228
  ds_read_b32 v77, v229
  ds_read_b32 v78, v230
  ds_read_b32 v79, v231
  s_waitcnt lgkmcnt(4)
  ds_read_b32 v80, v232
  s_waitcnt lgkmcnt(0)
  v_lshlrev_b32 v46, 6, v1
  v_add_u32 v46, s17, v46
  v_cvt_pk_bf16_f32 v84, v48, v49
  v_cvt_pk_bf16_f32 v88, v49, v50
  v_cvt_pk_bf16_f32 v85, v50, v51
  v_cvt_pk_bf16_f32 v89, v51, v52
  v_cvt_pk_bf16_f32 v86, v52, v53
  v_cvt_pk_bf16_f32 v90, v53, v54
  v_cvt_pk_bf16_f32 v87, v54, v55
  v_cvt_pk_bf16_f32 v91, v55, v56
  ds_write_b128 v46, v[84:87] offset:4608
  ds_write_b128 v46, v[88:91] offset:8832
  s_waitcnt lgkmcnt(0)
  v_cvt_pk_bf16_f32 v84, v56, v57
  v_cvt_pk_bf16_f32 v88, v57, v58
  v_cvt_pk_bf16_f32 v85, v58, v59
  v_cvt_pk_bf16_f32 v89, v59, v60
  v_cvt_pk_bf16_f32 v86, v60, v61
  v_cvt_pk_bf16_f32 v90, v61, v62
  v_cvt_pk_bf16_f32 v87, v62, v63
  v_cvt_pk_bf16_f32 v91, v63, v64
  ds_write_b128 v46, v[84:87] offset:4624
  ds_write_b128 v46, v[88:91] offset:8848
  s_waitcnt lgkmcnt(0)
  v_cvt_pk_bf16_f32 v84, v64, v65
  v_cvt_pk_bf16_f32 v88, v65, v66
  v_cvt_pk_bf16_f32 v85, v66, v67
  v_cvt_pk_bf16_f32 v89, v67, v68
  v_cvt_pk_bf16_f32 v86, v68, v69
  v_cvt_pk_bf16_f32 v90, v69, v70
  v_cvt_pk_bf16_f32 v87, v70, v71
  v_cvt_pk_bf16_f32 v91, v71, v72
  ds_write_b128 v46, v[84:87] offset:4640
  ds_write_b128 v46, v[88:91] offset:8864
  s_waitcnt lgkmcnt(0)
  v_cvt_pk_bf16_f32 v84, v72, v73
  v_cvt_pk_bf16_f32 v88, v73, v74
  v_cvt_pk_bf16_f32 v85, v74, v75
  v_cvt_pk_bf16_f32 v89, v75, v76
  v_cvt_pk_bf16_f32 v86, v76, v77
  v_cvt_pk_bf16_f32 v90, v77, v78
  v_cvt_pk_bf16_f32 v87, v78, v79
  v_cvt_pk_bf16_f32 v91, v79, v80
  ds_write_b128 v46, v[84:87] offset:4656
  ds_write_b128 v46, v[88:91] offset:8880
  s_waitcnt lgkmcnt(0)
  s_barrier
  v_lshrrev_b32 v47, 1, v3
  v_sub_u32 v46, v4, v47
  v_add_u32 v46, 1, v46
  v_lshlrev_b32 v46, 5, v46
  v_and_b32 v48, 1, v3
  v_lshl_add_u32 v46, v48, 4, v46
  v_add_u32 v46, s17, v46
  ds_read_b128 a[0:3], v46 offset:32
  ds_read_b128 a[4:7], v46 offset:96
  ds_read_b128 a[8:11], v46 offset:160
  ds_read_b128 a[12:15], v46 offset:224
  ds_read_b128 a[16:19], v46 offset:288
  ds_read_b128 a[20:23], v46 offset:352
  ds_read_b128 a[24:27], v46 offset:416
  ds_read_b128 a[28:31], v46 offset:480
  s_waitcnt lgkmcnt(4)
  ds_read_b128 a[32:35], v46 offset:544
  ds_read_b128 a[36:39], v46 offset:608
  ds_read_b128 a[40:43], v46 offset:672
  ds_read_b128 a[44:47], v46 offset:736
  ds_read_b128 a[48:51], v46 offset:800
  ds_read_b128 a[52:55], v46 offset:864
  ds_read_b128 a[56:59], v46 offset:928
  ds_read_b128 a[60:63], v46 offset:992
  s_waitcnt lgkmcnt(4)
  ds_read_b128 a[64:67], v46 offset:1056
  ds_read_b128 a[68:71], v46 offset:1120
  ds_read_b128 a[72:75], v46 offset:1184
  ds_read_b128 a[76:79], v46 offset:1248
  ds_read_b128 a[80:83], v46 offset:1312
  ds_read_b128 a[84:87], v46 offset:1376
  ds_read_b128 a[88:91], v46 offset:1440
  ds_read_b128 a[92:95], v46 offset:1504
  s_waitcnt lgkmcnt(4)
  ds_read_b128 a[96:99], v46 offset:1568
  ds_read_b128 a[100:103], v46 offset:1632
  ds_read_b128 a[104:107], v46 offset:1696
  ds_read_b128 a[108:111], v46 offset:1760
  ds_read_b128 a[112:115], v46 offset:1824
  ds_read_b128 a[116:119], v46 offset:1888
  ds_read_b128 a[120:123], v46 offset:1952
  ds_read_b128 a[124:127], v46 offset:2016
  s_waitcnt lgkmcnt(4)
  ds_read_b128 a[128:131], v46 offset:2080
  ds_read_b128 a[132:135], v46 offset:2144
  ds_read_b128 a[136:139], v46 offset:2208
  ds_read_b128 a[140:143], v46 offset:2272
  ds_read_b128 a[144:147], v46 offset:2336
  ds_read_b128 a[148:151], v46 offset:2400
  ds_read_b128 a[152:155], v46 offset:2464
  ds_read_b128 a[156:159], v46 offset:2528
  s_waitcnt lgkmcnt(4)
  ds_read_b128 a[160:163], v46 offset:2592
  ds_read_b128 a[164:167], v46 offset:2656
  ds_read_b128 a[168:171], v46 offset:2720
  ds_read_b128 a[172:175], v46 offset:2784
  ds_read_b128 a[176:179], v46 offset:2848
  ds_read_b128 a[180:183], v46 offset:2912
  ds_read_b128 a[184:187], v46 offset:2976
  ds_read_b128 a[188:191], v46 offset:3040
  s_waitcnt lgkmcnt(4)
  ds_read_b128 a[192:195], v46 offset:3104
  ds_read_b128 a[196:199], v46 offset:3168
  ds_read_b128 a[200:203], v46 offset:3232
  ds_read_b128 a[204:207], v46 offset:3296
  ds_read_b128 a[208:211], v46 offset:3360
  ds_read_b128 a[212:215], v46 offset:3424
  ds_read_b128 a[216:219], v46 offset:3488
  ds_read_b128 a[220:223], v46 offset:3552
  s_waitcnt lgkmcnt(4)
  ds_read_b128 a[224:227], v46 offset:3616
  ds_read_b128 a[228:231], v46 offset:3680
  ds_read_b128 a[232:235], v46 offset:3744
  ds_read_b128 a[236:239], v46 offset:3808
  ds_read_b128 a[240:243], v46 offset:3872
  ds_read_b128 a[244:247], v46 offset:3936
  ds_read_b128 a[248:251], v46 offset:4000
  ds_read_b128 a[252:255], v46 offset:4064
  s_waitcnt lgkmcnt(4)
  v_lshlrev_b32 v49, 4, v47
  v_add_u32 v49, v49, v4
  v_sub_u32 v49, 2047, v49
  v_lshl_add_u32 v49, v48, 3, v49
  v_and_b32 v50, 1, v49
  v_lshrrev_b32 v49, 1, v49
  v_lshlrev_b32 v49, 2, v49
  v_mul_u32_u24 v50, 4224, v50
  v_add3_u32 v49, v49, v50, s17
  v_add_u32 v49, 4608, v49
  v_subrev_u32 v52, 896, v49
  v_subrev_u32 v53, 1856, v49
  v_subrev_u32 v54, 2816, v49
  v_subrev_u32 v55, 3776, v49
  v_subrev_u32 v56, 4736, v49
  s_waitcnt lgkmcnt(0)
  ds_read2_b32 v[92:93], v52 offset0:224 offset1:225
  ds_read2_b32 v[94:95], v52 offset0:226 offset1:227
  ds_read2_b32 v[96:97], v52 offset0:208 offset1:209
  ds_read2_b32 v[98:99], v52 offset0:210 offset1:211
  ds_read2_b32 v[100:101], v52 offset0:192 offset1:193
  ds_read2_b32 v[102:103], v52 offset0:194 offset1:195
  ds_read2_b32 v[104:105], v52 offset0:176 offset1:177
  ds_read2_b32 v[106:107], v52 offset0:178 offset1:179
  s_waitcnt lgkmcnt(6)
  v_mfma_f32_16x16x32_bf16 v[60:63], v[92:95], a[28:31], 0
  v_mfma_f32_16x16x32_bf16 v[64:67], v[92:95], a[60:63], 0
  v_mfma_f32_16x16x32_bf16 v[68:71], v[92:95], a[92:95], 0
  v_mfma_f32_16x16x32_bf16 v[72:75], v[92:95], a[124:127], 0
  v_mfma_f32_16x16x32_bf16 v[76:79], v[92:95], a[156:159], 0
  v_mfma_f32_16x16x32_bf16 v[80:83], v[92:95], a[188:191], 0
  v_mfma_f32_16x16x32_bf16 v[84:87], v[92:95], a[220:223], 0
  v_mfma_f32_16x16x32_bf16 v[88:91], v[92:95], a[252:255], 0
  ds_read2_b32 v[92:93], v52 offset0:160 offset1:161
  ds_read2_b32 v[94:95], v52 offset0:162 offset1:163
  s_waitcnt lgkmcnt(6)
  v_mfma_f32_16x16x32_bf16 v[60:63], v[96:99], a[24:27], v[60:63]
  v_mfma_f32_16x16x32_bf16 v[64:67], v[96:99], a[56:59], v[64:67]
  v_mfma_f32_16x16x32_bf16 v[68:71], v[96:99], a[88:91], v[68:71]
  v_mfma_f32_16x16x32_bf16 v[72:75], v[96:99], a[120:123], v[72:75]
  v_mfma_f32_16x16x32_bf16 v[76:79], v[96:99], a[152:155], v[76:79]
  v_mfma_f32_16x16x32_bf16 v[80:83], v[96:99], a[184:187], v[80:83]
  v_mfma_f32_16x16x32_bf16 v[84:87], v[96:99], a[216:219], v[84:87]
  v_mfma_f32_16x16x32_bf16 v[88:91], v[96:99], a[248:251], v[88:91]
  ds_read2_b32 v[96:97], v52 offset0:144 offset1:145
  ds_read2_b32 v[98:99], v52 offset0:146 offset1:147
  s_waitcnt lgkmcnt(6)
  v_mfma_f32_16x16x32_bf16 v[60:63], v[100:103], a[20:23], v[60:63]
  v_mfma_f32_16x16x32_bf16 v[64:67], v[100:103], a[52:55], v[64:67]
  v_mfma_f32_16x16x32_bf16 v[68:71], v[100:103], a[84:87], v[68:71]
  v_mfma_f32_16x16x32_bf16 v[72:75], v[100:103], a[116:119], v[72:75]
  v_mfma_f32_16x16x32_bf16 v[76:79], v[100:103], a[148:151], v[76:79]
  v_mfma_f32_16x16x32_bf16 v[80:83], v[100:103], a[180:183], v[80:83]
  v_mfma_f32_16x16x32_bf16 v[84:87], v[100:103], a[212:215], v[84:87]
  v_mfma_f32_16x16x32_bf16 v[88:91], v[100:103], a[244:247], v[88:91]
  ds_read2_b32 v[100:101], v52 offset0:128 offset1:129
  ds_read2_b32 v[102:103], v52 offset0:130 offset1:131
  s_waitcnt lgkmcnt(6)
  v_mfma_f32_16x16x32_bf16 v[60:63], v[104:107], a[16:19], v[60:63]
  v_mfma_f32_16x16x32_bf16 v[64:67], v[104:107], a[48:51], v[64:67]
  v_mfma_f32_16x16x32_bf16 v[68:71], v[104:107], a[80:83], v[68:71]
  v_mfma_f32_16x16x32_bf16 v[72:75], v[104:107], a[112:115], v[72:75]
  v_mfma_f32_16x16x32_bf16 v[76:79], v[104:107], a[144:147], v[76:79]
  v_mfma_f32_16x16x32_bf16 v[80:83], v[104:107], a[176:179], v[80:83]
  v_mfma_f32_16x16x32_bf16 v[84:87], v[104:107], a[208:211], v[84:87]
  v_mfma_f32_16x16x32_bf16 v[88:91], v[104:107], a[240:243], v[88:91]
  ds_read2_b32 v[104:105], v52 offset0:112 offset1:113
  ds_read2_b32 v[106:107], v52 offset0:114 offset1:115
  s_waitcnt lgkmcnt(6)
  v_mfma_f32_16x16x32_bf16 v[60:63], v[92:95], a[12:15], v[60:63]
  v_mfma_f32_16x16x32_bf16 v[64:67], v[92:95], a[44:47], v[64:67]
  v_mfma_f32_16x16x32_bf16 v[68:71], v[92:95], a[76:79], v[68:71]
  v_mfma_f32_16x16x32_bf16 v[72:75], v[92:95], a[108:111], v[72:75]
  v_mfma_f32_16x16x32_bf16 v[76:79], v[92:95], a[140:143], v[76:79]
  v_mfma_f32_16x16x32_bf16 v[80:83], v[92:95], a[172:175], v[80:83]
  v_mfma_f32_16x16x32_bf16 v[84:87], v[92:95], a[204:207], v[84:87]
  v_mfma_f32_16x16x32_bf16 v[88:91], v[92:95], a[236:239], v[88:91]
  ds_read2_b32 v[92:93], v52 offset0:96 offset1:97
  ds_read2_b32 v[94:95], v52 offset0:98 offset1:99
  s_waitcnt lgkmcnt(6)
  v_mfma_f32_16x16x32_bf16 v[60:63], v[96:99], a[8:11], v[60:63]
  v_mfma_f32_16x16x32_bf16 v[64:67], v[96:99], a[40:43], v[64:67]
  v_mfma_f32_16x16x32_bf16 v[68:71], v[96:99], a[72:75], v[68:71]
  v_mfma_f32_16x16x32_bf16 v[72:75], v[96:99], a[104:107], v[72:75]
  v_mfma_f32_16x16x32_bf16 v[76:79], v[96:99], a[136:139], v[76:79]
  v_mfma_f32_16x16x32_bf16 v[80:83], v[96:99], a[168:171], v[80:83]
  v_mfma_f32_16x16x32_bf16 v[84:87], v[96:99], a[200:203], v[84:87]
  v_mfma_f32_16x16x32_bf16 v[88:91], v[96:99], a[232:235], v[88:91]
  ds_read2_b32 v[96:97], v52 offset0:80 offset1:81
  ds_read2_b32 v[98:99], v52 offset0:82 offset1:83
  s_waitcnt lgkmcnt(6)
  v_mfma_f32_16x16x32_bf16 v[60:63], v[100:103], a[4:7], v[60:63]
  v_mfma_f32_16x16x32_bf16 v[64:67], v[100:103], a[36:39], v[64:67]
  v_mfma_f32_16x16x32_bf16 v[68:71], v[100:103], a[68:71], v[68:71]
  v_mfma_f32_16x16x32_bf16 v[72:75], v[100:103], a[100:103], v[72:75]
  v_mfma_f32_16x16x32_bf16 v[76:79], v[100:103], a[132:135], v[76:79]
  v_mfma_f32_16x16x32_bf16 v[80:83], v[100:103], a[164:167], v[80:83]
  v_mfma_f32_16x16x32_bf16 v[84:87], v[100:103], a[196:199], v[84:87]
  v_mfma_f32_16x16x32_bf16 v[88:91], v[100:103], a[228:231], v[88:91]
  ds_read2_b32 v[100:101], v52 offset0:64 offset1:65
  ds_read2_b32 v[102:103], v52 offset0:66 offset1:67
  s_waitcnt lgkmcnt(6)
  v_mfma_f32_16x16x32_bf16 v[60:63], v[104:107], a[0:3], v[60:63]
  v_mfma_f32_16x16x32_bf16 v[64:67], v[104:107], a[32:35], v[64:67]
  v_mfma_f32_16x16x32_bf16 v[68:71], v[104:107], a[64:67], v[68:71]
  v_mfma_f32_16x16x32_bf16 v[72:75], v[104:107], a[96:99], v[72:75]
  v_mfma_f32_16x16x32_bf16 v[76:79], v[104:107], a[128:131], v[76:79]
  v_mfma_f32_16x16x32_bf16 v[80:83], v[104:107], a[160:163], v[80:83]
  v_mfma_f32_16x16x32_bf16 v[84:87], v[104:107], a[192:195], v[84:87]
  v_mfma_f32_16x16x32_bf16 v[88:91], v[104:107], a[224:227], v[88:91]
  ds_read2_b32 v[104:105], v52 offset0:48 offset1:49
  ds_read2_b32 v[106:107], v52 offset0:50 offset1:51
  s_waitcnt lgkmcnt(6)
  v_mfma_f32_16x16x32_bf16 v[64:67], v[92:95], a[28:31], v[64:67]
  v_mfma_f32_16x16x32_bf16 v[68:71], v[92:95], a[60:63], v[68:71]
  v_mfma_f32_16x16x32_bf16 v[72:75], v[92:95], a[92:95], v[72:75]
  v_mfma_f32_16x16x32_bf16 v[76:79], v[92:95], a[124:127], v[76:79]
  v_mfma_f32_16x16x32_bf16 v[80:83], v[92:95], a[156:159], v[80:83]
  v_mfma_f32_16x16x32_bf16 v[84:87], v[92:95], a[188:191], v[84:87]
  v_mfma_f32_16x16x32_bf16 v[88:91], v[92:95], a[220:223], v[88:91]
  ds_read2_b32 v[92:93], v52 offset0:32 offset1:33
  ds_read2_b32 v[94:95], v52 offset0:34 offset1:35
  s_waitcnt lgkmcnt(6)
  v_mfma_f32_16x16x32_bf16 v[64:67], v[96:99], a[24:27], v[64:67]
  v_mfma_f32_16x16x32_bf16 v[68:71], v[96:99], a[56:59], v[68:71]
  v_mfma_f32_16x16x32_bf16 v[72:75], v[96:99], a[88:91], v[72:75]
  v_mfma_f32_16x16x32_bf16 v[76:79], v[96:99], a[120:123], v[76:79]
  v_mfma_f32_16x16x32_bf16 v[80:83], v[96:99], a[152:155], v[80:83]
  v_mfma_f32_16x16x32_bf16 v[84:87], v[96:99], a[184:187], v[84:87]
  v_mfma_f32_16x16x32_bf16 v[88:91], v[96:99], a[216:219], v[88:91]
  ds_read2_b32 v[96:97], v52 offset0:16 offset1:17
  ds_read2_b32 v[98:99], v52 offset0:18 offset1:19
  s_waitcnt lgkmcnt(6)
  v_mfma_f32_16x16x32_bf16 v[64:67], v[100:103], a[20:23], v[64:67]
  v_mfma_f32_16x16x32_bf16 v[68:71], v[100:103], a[52:55], v[68:71]
  v_mfma_f32_16x16x32_bf16 v[72:75], v[100:103], a[84:87], v[72:75]
  v_mfma_f32_16x16x32_bf16 v[76:79], v[100:103], a[116:119], v[76:79]
  v_mfma_f32_16x16x32_bf16 v[80:83], v[100:103], a[148:151], v[80:83]
  v_mfma_f32_16x16x32_bf16 v[84:87], v[100:103], a[180:183], v[84:87]
  v_mfma_f32_16x16x32_bf16 v[88:91], v[100:103], a[212:215], v[88:91]
  ds_read2_b32 v[100:101], v52 offset0:0 offset1:1
  ds_read2_b32 v[102:103], v52 offset0:2 offset1:3
  s_waitcnt lgkmcnt(6)
  v_mfma_f32_16x16x32_bf16 v[64:67], v[104:107], a[16:19], v[64:67]
  v_mfma_f32_16x16x32_bf16 v[68:71], v[104:107], a[48:51], v[68:71]
  v_mfma_f32_16x16x32_bf16 v[72:75], v[104:107], a[80:83], v[72:75]
  v_mfma_f32_16x16x32_bf16 v[76:79], v[104:107], a[112:115], v[76:79]
  v_mfma_f32_16x16x32_bf16 v[80:83], v[104:107], a[144:147], v[80:83]
  v_mfma_f32_16x16x32_bf16 v[84:87], v[104:107], a[176:179], v[84:87]
  v_mfma_f32_16x16x32_bf16 v[88:91], v[104:107], a[208:211], v[88:91]
  ds_read2_b32 v[104:105], v53 offset0:224 offset1:225
  ds_read2_b32 v[106:107], v53 offset0:226 offset1:227
  s_waitcnt lgkmcnt(6)
  v_mfma_f32_16x16x32_bf16 v[64:67], v[92:95], a[12:15], v[64:67]
  v_mfma_f32_16x16x32_bf16 v[68:71], v[92:95], a[44:47], v[68:71]
  v_mfma_f32_16x16x32_bf16 v[72:75], v[92:95], a[76:79], v[72:75]
  v_mfma_f32_16x16x32_bf16 v[76:79], v[92:95], a[108:111], v[76:79]
  v_mfma_f32_16x16x32_bf16 v[80:83], v[92:95], a[140:143], v[80:83]
  v_mfma_f32_16x16x32_bf16 v[84:87], v[92:95], a[172:175], v[84:87]
  v_mfma_f32_16x16x32_bf16 v[88:91], v[92:95], a[204:207], v[88:91]
  ds_read2_b32 v[92:93], v53 offset0:208 offset1:209
  ds_read2_b32 v[94:95], v53 offset0:210 offset1:211
  s_waitcnt lgkmcnt(6)
  v_mfma_f32_16x16x32_bf16 v[64:67], v[96:99], a[8:11], v[64:67]
  v_mfma_f32_16x16x32_bf16 v[68:71], v[96:99], a[40:43], v[68:71]
  v_mfma_f32_16x16x32_bf16 v[72:75], v[96:99], a[72:75], v[72:75]
  v_mfma_f32_16x16x32_bf16 v[76:79], v[96:99], a[104:107], v[76:79]
  v_mfma_f32_16x16x32_bf16 v[80:83], v[96:99], a[136:139], v[80:83]
  v_mfma_f32_16x16x32_bf16 v[84:87], v[96:99], a[168:171], v[84:87]
  v_mfma_f32_16x16x32_bf16 v[88:91], v[96:99], a[200:203], v[88:91]
  ds_read2_b32 v[96:97], v53 offset0:192 offset1:193
  ds_read2_b32 v[98:99], v53 offset0:194 offset1:195
  s_waitcnt lgkmcnt(6)
  v_mfma_f32_16x16x32_bf16 v[64:67], v[100:103], a[4:7], v[64:67]
  v_mfma_f32_16x16x32_bf16 v[68:71], v[100:103], a[36:39], v[68:71]
  v_mfma_f32_16x16x32_bf16 v[72:75], v[100:103], a[68:71], v[72:75]
  v_mfma_f32_16x16x32_bf16 v[76:79], v[100:103], a[100:103], v[76:79]
  v_mfma_f32_16x16x32_bf16 v[80:83], v[100:103], a[132:135], v[80:83]
  v_mfma_f32_16x16x32_bf16 v[84:87], v[100:103], a[164:167], v[84:87]
  v_mfma_f32_16x16x32_bf16 v[88:91], v[100:103], a[196:199], v[88:91]
  ds_read2_b32 v[100:101], v53 offset0:176 offset1:177
  ds_read2_b32 v[102:103], v53 offset0:178 offset1:179
  s_waitcnt lgkmcnt(6)
  v_mfma_f32_16x16x32_bf16 v[64:67], v[104:107], a[0:3], v[64:67]
  v_mfma_f32_16x16x32_bf16 v[68:71], v[104:107], a[32:35], v[68:71]
  v_mfma_f32_16x16x32_bf16 v[72:75], v[104:107], a[64:67], v[72:75]
  v_mfma_f32_16x16x32_bf16 v[76:79], v[104:107], a[96:99], v[76:79]
  v_mfma_f32_16x16x32_bf16 v[80:83], v[104:107], a[128:131], v[80:83]
  v_mfma_f32_16x16x32_bf16 v[84:87], v[104:107], a[160:163], v[84:87]
  v_mfma_f32_16x16x32_bf16 v[88:91], v[104:107], a[192:195], v[88:91]
  ds_read2_b32 v[104:105], v53 offset0:160 offset1:161
  ds_read2_b32 v[106:107], v53 offset0:162 offset1:163
  s_waitcnt lgkmcnt(6)
  v_mfma_f32_16x16x32_bf16 v[68:71], v[92:95], a[28:31], v[68:71]
  v_mfma_f32_16x16x32_bf16 v[72:75], v[92:95], a[60:63], v[72:75]
  v_mfma_f32_16x16x32_bf16 v[76:79], v[92:95], a[92:95], v[76:79]
  v_mfma_f32_16x16x32_bf16 v[80:83], v[92:95], a[124:127], v[80:83]
  v_mfma_f32_16x16x32_bf16 v[84:87], v[92:95], a[156:159], v[84:87]
  v_mfma_f32_16x16x32_bf16 v[88:91], v[92:95], a[188:191], v[88:91]
  ds_read2_b32 v[92:93], v53 offset0:144 offset1:145
  ds_read2_b32 v[94:95], v53 offset0:146 offset1:147
  s_waitcnt lgkmcnt(6)
  v_mfma_f32_16x16x32_bf16 v[68:71], v[96:99], a[24:27], v[68:71]
  v_mfma_f32_16x16x32_bf16 v[72:75], v[96:99], a[56:59], v[72:75]
  v_mfma_f32_16x16x32_bf16 v[76:79], v[96:99], a[88:91], v[76:79]
  v_mfma_f32_16x16x32_bf16 v[80:83], v[96:99], a[120:123], v[80:83]
  v_mfma_f32_16x16x32_bf16 v[84:87], v[96:99], a[152:155], v[84:87]
  v_mfma_f32_16x16x32_bf16 v[88:91], v[96:99], a[184:187], v[88:91]
  ds_read2_b32 v[96:97], v53 offset0:128 offset1:129
  ds_read2_b32 v[98:99], v53 offset0:130 offset1:131
  s_waitcnt lgkmcnt(6)
  v_mfma_f32_16x16x32_bf16 v[68:71], v[100:103], a[20:23], v[68:71]
  v_mfma_f32_16x16x32_bf16 v[72:75], v[100:103], a[52:55], v[72:75]
  v_mfma_f32_16x16x32_bf16 v[76:79], v[100:103], a[84:87], v[76:79]
  v_mfma_f32_16x16x32_bf16 v[80:83], v[100:103], a[116:119], v[80:83]
  v_mfma_f32_16x16x32_bf16 v[84:87], v[100:103], a[148:151], v[84:87]
  v_mfma_f32_16x16x32_bf16 v[88:91], v[100:103], a[180:183], v[88:91]
  ds_read2_b32 v[100:101], v53 offset0:112 offset1:113
  ds_read2_b32 v[102:103], v53 offset0:114 offset1:115
  s_waitcnt lgkmcnt(6)
  v_mfma_f32_16x16x32_bf16 v[68:71], v[104:107], a[16:19], v[68:71]
  v_mfma_f32_16x16x32_bf16 v[72:75], v[104:107], a[48:51], v[72:75]
  v_mfma_f32_16x16x32_bf16 v[76:79], v[104:107], a[80:83], v[76:79]
  v_mfma_f32_16x16x32_bf16 v[80:83], v[104:107], a[112:115], v[80:83]
  v_mfma_f32_16x16x32_bf16 v[84:87], v[104:107], a[144:147], v[84:87]
  v_mfma_f32_16x16x32_bf16 v[88:91], v[104:107], a[176:179], v[88:91]
  ds_read2_b32 v[104:105], v53 offset0:96 offset1:97
  ds_read2_b32 v[106:107], v53 offset0:98 offset1:99
  s_waitcnt lgkmcnt(6)
  v_mfma_f32_16x16x32_bf16 v[68:71], v[92:95], a[12:15], v[68:71]
  v_mfma_f32_16x16x32_bf16 v[72:75], v[92:95], a[44:47], v[72:75]
  v_mfma_f32_16x16x32_bf16 v[76:79], v[92:95], a[76:79], v[76:79]
  v_mfma_f32_16x16x32_bf16 v[80:83], v[92:95], a[108:111], v[80:83]
  v_mfma_f32_16x16x32_bf16 v[84:87], v[92:95], a[140:143], v[84:87]
  v_mfma_f32_16x16x32_bf16 v[88:91], v[92:95], a[172:175], v[88:91]
  ds_read2_b32 v[92:93], v53 offset0:80 offset1:81
  ds_read2_b32 v[94:95], v53 offset0:82 offset1:83
  s_waitcnt lgkmcnt(6)
  v_mfma_f32_16x16x32_bf16 v[68:71], v[96:99], a[8:11], v[68:71]
  v_mfma_f32_16x16x32_bf16 v[72:75], v[96:99], a[40:43], v[72:75]
  v_mfma_f32_16x16x32_bf16 v[76:79], v[96:99], a[72:75], v[76:79]
  v_mfma_f32_16x16x32_bf16 v[80:83], v[96:99], a[104:107], v[80:83]
  v_mfma_f32_16x16x32_bf16 v[84:87], v[96:99], a[136:139], v[84:87]
  v_mfma_f32_16x16x32_bf16 v[88:91], v[96:99], a[168:171], v[88:91]
  ds_read2_b32 v[96:97], v53 offset0:64 offset1:65
  ds_read2_b32 v[98:99], v53 offset0:66 offset1:67
  s_waitcnt lgkmcnt(6)
  v_mfma_f32_16x16x32_bf16 v[68:71], v[100:103], a[4:7], v[68:71]
  v_mfma_f32_16x16x32_bf16 v[72:75], v[100:103], a[36:39], v[72:75]
  v_mfma_f32_16x16x32_bf16 v[76:79], v[100:103], a[68:71], v[76:79]
  v_mfma_f32_16x16x32_bf16 v[80:83], v[100:103], a[100:103], v[80:83]
  v_mfma_f32_16x16x32_bf16 v[84:87], v[100:103], a[132:135], v[84:87]
  v_mfma_f32_16x16x32_bf16 v[88:91], v[100:103], a[164:167], v[88:91]
  ds_read2_b32 v[100:101], v53 offset0:48 offset1:49
  ds_read2_b32 v[102:103], v53 offset0:50 offset1:51
  s_waitcnt lgkmcnt(6)
  v_mfma_f32_16x16x32_bf16 v[68:71], v[104:107], a[0:3], v[68:71]
  v_mfma_f32_16x16x32_bf16 v[72:75], v[104:107], a[32:35], v[72:75]
  v_mfma_f32_16x16x32_bf16 v[76:79], v[104:107], a[64:67], v[76:79]
  v_mfma_f32_16x16x32_bf16 v[80:83], v[104:107], a[96:99], v[80:83]
  v_mfma_f32_16x16x32_bf16 v[84:87], v[104:107], a[128:131], v[84:87]
  v_mfma_f32_16x16x32_bf16 v[88:91], v[104:107], a[160:163], v[88:91]
  ds_read2_b32 v[104:105], v53 offset0:32 offset1:33
  ds_read2_b32 v[106:107], v53 offset0:34 offset1:35
  s_waitcnt lgkmcnt(6)
  v_mfma_f32_16x16x32_bf16 v[72:75], v[92:95], a[28:31], v[72:75]
  v_mfma_f32_16x16x32_bf16 v[76:79], v[92:95], a[60:63], v[76:79]
  v_mfma_f32_16x16x32_bf16 v[80:83], v[92:95], a[92:95], v[80:83]
  v_mfma_f32_16x16x32_bf16 v[84:87], v[92:95], a[124:127], v[84:87]
  v_mfma_f32_16x16x32_bf16 v[88:91], v[92:95], a[156:159], v[88:91]
  ds_read2_b32 v[92:93], v53 offset0:16 offset1:17
  ds_read2_b32 v[94:95], v53 offset0:18 offset1:19
  s_waitcnt lgkmcnt(6)
  v_mfma_f32_16x16x32_bf16 v[72:75], v[96:99], a[24:27], v[72:75]
  v_mfma_f32_16x16x32_bf16 v[76:79], v[96:99], a[56:59], v[76:79]
  v_mfma_f32_16x16x32_bf16 v[80:83], v[96:99], a[88:91], v[80:83]
  v_mfma_f32_16x16x32_bf16 v[84:87], v[96:99], a[120:123], v[84:87]
  v_mfma_f32_16x16x32_bf16 v[88:91], v[96:99], a[152:155], v[88:91]
  ds_read2_b32 v[96:97], v53 offset0:0 offset1:1
  ds_read2_b32 v[98:99], v53 offset0:2 offset1:3
  s_waitcnt lgkmcnt(6)
  v_mfma_f32_16x16x32_bf16 v[72:75], v[100:103], a[20:23], v[72:75]
  v_mfma_f32_16x16x32_bf16 v[76:79], v[100:103], a[52:55], v[76:79]
  v_mfma_f32_16x16x32_bf16 v[80:83], v[100:103], a[84:87], v[80:83]
  v_mfma_f32_16x16x32_bf16 v[84:87], v[100:103], a[116:119], v[84:87]
  v_mfma_f32_16x16x32_bf16 v[88:91], v[100:103], a[148:151], v[88:91]
  ds_read2_b32 v[100:101], v54 offset0:224 offset1:225
  ds_read2_b32 v[102:103], v54 offset0:226 offset1:227
  s_waitcnt lgkmcnt(6)
  v_mfma_f32_16x16x32_bf16 v[72:75], v[104:107], a[16:19], v[72:75]
  v_mfma_f32_16x16x32_bf16 v[76:79], v[104:107], a[48:51], v[76:79]
  v_mfma_f32_16x16x32_bf16 v[80:83], v[104:107], a[80:83], v[80:83]
  v_mfma_f32_16x16x32_bf16 v[84:87], v[104:107], a[112:115], v[84:87]
  v_mfma_f32_16x16x32_bf16 v[88:91], v[104:107], a[144:147], v[88:91]
  ds_read2_b32 v[104:105], v54 offset0:208 offset1:209
  ds_read2_b32 v[106:107], v54 offset0:210 offset1:211
  s_waitcnt lgkmcnt(6)
  v_mfma_f32_16x16x32_bf16 v[72:75], v[92:95], a[12:15], v[72:75]
  v_mfma_f32_16x16x32_bf16 v[76:79], v[92:95], a[44:47], v[76:79]
  v_mfma_f32_16x16x32_bf16 v[80:83], v[92:95], a[76:79], v[80:83]
  v_mfma_f32_16x16x32_bf16 v[84:87], v[92:95], a[108:111], v[84:87]
  v_mfma_f32_16x16x32_bf16 v[88:91], v[92:95], a[140:143], v[88:91]
  ds_read2_b32 v[92:93], v54 offset0:192 offset1:193
  ds_read2_b32 v[94:95], v54 offset0:194 offset1:195
  s_waitcnt lgkmcnt(6)
  v_mfma_f32_16x16x32_bf16 v[72:75], v[96:99], a[8:11], v[72:75]
  v_mfma_f32_16x16x32_bf16 v[76:79], v[96:99], a[40:43], v[76:79]
  v_mfma_f32_16x16x32_bf16 v[80:83], v[96:99], a[72:75], v[80:83]
  v_mfma_f32_16x16x32_bf16 v[84:87], v[96:99], a[104:107], v[84:87]
  v_mfma_f32_16x16x32_bf16 v[88:91], v[96:99], a[136:139], v[88:91]
  ds_read2_b32 v[96:97], v54 offset0:176 offset1:177
  ds_read2_b32 v[98:99], v54 offset0:178 offset1:179
  s_waitcnt lgkmcnt(6)
  v_mfma_f32_16x16x32_bf16 v[72:75], v[100:103], a[4:7], v[72:75]
  v_mfma_f32_16x16x32_bf16 v[76:79], v[100:103], a[36:39], v[76:79]
  v_mfma_f32_16x16x32_bf16 v[80:83], v[100:103], a[68:71], v[80:83]
  v_mfma_f32_16x16x32_bf16 v[84:87], v[100:103], a[100:103], v[84:87]
  v_mfma_f32_16x16x32_bf16 v[88:91], v[100:103], a[132:135], v[88:91]
  ds_read2_b32 v[100:101], v54 offset0:160 offset1:161
  ds_read2_b32 v[102:103], v54 offset0:162 offset1:163
  s_waitcnt lgkmcnt(6)
  v_mfma_f32_16x16x32_bf16 v[72:75], v[104:107], a[0:3], v[72:75]
  v_mfma_f32_16x16x32_bf16 v[76:79], v[104:107], a[32:35], v[76:79]
  v_mfma_f32_16x16x32_bf16 v[80:83], v[104:107], a[64:67], v[80:83]
  v_mfma_f32_16x16x32_bf16 v[84:87], v[104:107], a[96:99], v[84:87]
  v_mfma_f32_16x16x32_bf16 v[88:91], v[104:107], a[128:131], v[88:91]
  ds_read2_b32 v[104:105], v54 offset0:144 offset1:145
  ds_read2_b32 v[106:107], v54 offset0:146 offset1:147
  s_waitcnt lgkmcnt(6)
  v_mfma_f32_16x16x32_bf16 v[76:79], v[92:95], a[28:31], v[76:79]
  v_mfma_f32_16x16x32_bf16 v[80:83], v[92:95], a[60:63], v[80:83]
  v_mfma_f32_16x16x32_bf16 v[84:87], v[92:95], a[92:95], v[84:87]
  v_mfma_f32_16x16x32_bf16 v[88:91], v[92:95], a[124:127], v[88:91]
  ds_read2_b32 v[92:93], v54 offset0:128 offset1:129
  ds_read2_b32 v[94:95], v54 offset0:130 offset1:131
  s_waitcnt lgkmcnt(6)
  v_mfma_f32_16x16x32_bf16 v[76:79], v[96:99], a[24:27], v[76:79]
  v_mfma_f32_16x16x32_bf16 v[80:83], v[96:99], a[56:59], v[80:83]
  v_mfma_f32_16x16x32_bf16 v[84:87], v[96:99], a[88:91], v[84:87]
  v_mfma_f32_16x16x32_bf16 v[88:91], v[96:99], a[120:123], v[88:91]
  ds_read2_b32 v[96:97], v54 offset0:112 offset1:113
  ds_read2_b32 v[98:99], v54 offset0:114 offset1:115
  s_waitcnt lgkmcnt(6)
  v_mfma_f32_16x16x32_bf16 v[76:79], v[100:103], a[20:23], v[76:79]
  v_mfma_f32_16x16x32_bf16 v[80:83], v[100:103], a[52:55], v[80:83]
  v_mfma_f32_16x16x32_bf16 v[84:87], v[100:103], a[84:87], v[84:87]
  v_mfma_f32_16x16x32_bf16 v[88:91], v[100:103], a[116:119], v[88:91]
  ds_read2_b32 v[100:101], v54 offset0:96 offset1:97
  ds_read2_b32 v[102:103], v54 offset0:98 offset1:99
  s_waitcnt lgkmcnt(6)
  v_mfma_f32_16x16x32_bf16 v[76:79], v[104:107], a[16:19], v[76:79]
  v_mfma_f32_16x16x32_bf16 v[80:83], v[104:107], a[48:51], v[80:83]
  v_mfma_f32_16x16x32_bf16 v[84:87], v[104:107], a[80:83], v[84:87]
  v_mfma_f32_16x16x32_bf16 v[88:91], v[104:107], a[112:115], v[88:91]
  ds_read2_b32 v[104:105], v54 offset0:80 offset1:81
  ds_read2_b32 v[106:107], v54 offset0:82 offset1:83
  s_waitcnt lgkmcnt(6)
  v_mfma_f32_16x16x32_bf16 v[76:79], v[92:95], a[12:15], v[76:79]
  v_mfma_f32_16x16x32_bf16 v[80:83], v[92:95], a[44:47], v[80:83]
  v_mfma_f32_16x16x32_bf16 v[84:87], v[92:95], a[76:79], v[84:87]
  v_mfma_f32_16x16x32_bf16 v[88:91], v[92:95], a[108:111], v[88:91]
  ds_read2_b32 v[92:93], v54 offset0:64 offset1:65
  ds_read2_b32 v[94:95], v54 offset0:66 offset1:67
  s_waitcnt lgkmcnt(6)
  v_mfma_f32_16x16x32_bf16 v[76:79], v[96:99], a[8:11], v[76:79]
  v_mfma_f32_16x16x32_bf16 v[80:83], v[96:99], a[40:43], v[80:83]
  v_mfma_f32_16x16x32_bf16 v[84:87], v[96:99], a[72:75], v[84:87]
  v_mfma_f32_16x16x32_bf16 v[88:91], v[96:99], a[104:107], v[88:91]
  ds_read2_b32 v[96:97], v54 offset0:48 offset1:49
  ds_read2_b32 v[98:99], v54 offset0:50 offset1:51
  s_waitcnt lgkmcnt(6)
  v_mfma_f32_16x16x32_bf16 v[76:79], v[100:103], a[4:7], v[76:79]
  v_mfma_f32_16x16x32_bf16 v[80:83], v[100:103], a[36:39], v[80:83]
  v_mfma_f32_16x16x32_bf16 v[84:87], v[100:103], a[68:71], v[84:87]
  v_mfma_f32_16x16x32_bf16 v[88:91], v[100:103], a[100:103], v[88:91]
  ds_read2_b32 v[100:101], v54 offset0:32 offset1:33
  ds_read2_b32 v[102:103], v54 offset0:34 offset1:35
  s_waitcnt lgkmcnt(6)
  v_mfma_f32_16x16x32_bf16 v[76:79], v[104:107], a[0:3], v[76:79]
  v_mfma_f32_16x16x32_bf16 v[80:83], v[104:107], a[32:35], v[80:83]
  v_mfma_f32_16x16x32_bf16 v[84:87], v[104:107], a[64:67], v[84:87]
  v_mfma_f32_16x16x32_bf16 v[88:91], v[104:107], a[96:99], v[88:91]
  ds_read2_b32 v[104:105], v54 offset0:16 offset1:17
  ds_read2_b32 v[106:107], v54 offset0:18 offset1:19
  s_waitcnt lgkmcnt(6)
  v_mfma_f32_16x16x32_bf16 v[80:83], v[92:95], a[28:31], v[80:83]
  v_mfma_f32_16x16x32_bf16 v[84:87], v[92:95], a[60:63], v[84:87]
  v_mfma_f32_16x16x32_bf16 v[88:91], v[92:95], a[92:95], v[88:91]
  ds_read2_b32 v[92:93], v54 offset0:0 offset1:1
  ds_read2_b32 v[94:95], v54 offset0:2 offset1:3
  s_waitcnt lgkmcnt(6)
  v_mfma_f32_16x16x32_bf16 v[80:83], v[96:99], a[24:27], v[80:83]
  v_mfma_f32_16x16x32_bf16 v[84:87], v[96:99], a[56:59], v[84:87]
  v_mfma_f32_16x16x32_bf16 v[88:91], v[96:99], a[88:91], v[88:91]
  ds_read2_b32 v[96:97], v55 offset0:224 offset1:225
  ds_read2_b32 v[98:99], v55 offset0:226 offset1:227
  s_waitcnt lgkmcnt(6)
  v_mfma_f32_16x16x32_bf16 v[80:83], v[100:103], a[20:23], v[80:83]
  v_mfma_f32_16x16x32_bf16 v[84:87], v[100:103], a[52:55], v[84:87]
  v_mfma_f32_16x16x32_bf16 v[88:91], v[100:103], a[84:87], v[88:91]
  ds_read2_b32 v[100:101], v55 offset0:208 offset1:209
  ds_read2_b32 v[102:103], v55 offset0:210 offset1:211
  s_waitcnt lgkmcnt(6)
  v_mfma_f32_16x16x32_bf16 v[80:83], v[104:107], a[16:19], v[80:83]
  v_mfma_f32_16x16x32_bf16 v[84:87], v[104:107], a[48:51], v[84:87]
  v_mfma_f32_16x16x32_bf16 v[88:91], v[104:107], a[80:83], v[88:91]
  ds_read2_b32 v[104:105], v55 offset0:192 offset1:193
  ds_read2_b32 v[106:107], v55 offset0:194 offset1:195
  s_waitcnt lgkmcnt(6)
  v_mfma_f32_16x16x32_bf16 v[80:83], v[92:95], a[12:15], v[80:83]
  v_mfma_f32_16x16x32_bf16 v[84:87], v[92:95], a[44:47], v[84:87]
  v_mfma_f32_16x16x32_bf16 v[88:91], v[92:95], a[76:79], v[88:91]
  ds_read2_b32 v[92:93], v55 offset0:176 offset1:177
  ds_read2_b32 v[94:95], v55 offset0:178 offset1:179
  s_waitcnt lgkmcnt(6)
  v_mfma_f32_16x16x32_bf16 v[80:83], v[96:99], a[8:11], v[80:83]
  v_mfma_f32_16x16x32_bf16 v[84:87], v[96:99], a[40:43], v[84:87]
  v_mfma_f32_16x16x32_bf16 v[88:91], v[96:99], a[72:75], v[88:91]
  ds_read2_b32 v[96:97], v55 offset0:160 offset1:161
  ds_read2_b32 v[98:99], v55 offset0:162 offset1:163
  s_waitcnt lgkmcnt(6)
  v_mfma_f32_16x16x32_bf16 v[80:83], v[100:103], a[4:7], v[80:83]
  v_mfma_f32_16x16x32_bf16 v[84:87], v[100:103], a[36:39], v[84:87]
  v_mfma_f32_16x16x32_bf16 v[88:91], v[100:103], a[68:71], v[88:91]
  ds_read2_b32 v[100:101], v55 offset0:144 offset1:145
  ds_read2_b32 v[102:103], v55 offset0:146 offset1:147
  s_waitcnt lgkmcnt(6)
  v_mfma_f32_16x16x32_bf16 v[80:83], v[104:107], a[0:3], v[80:83]
  v_mfma_f32_16x16x32_bf16 v[84:87], v[104:107], a[32:35], v[84:87]
  v_mfma_f32_16x16x32_bf16 v[88:91], v[104:107], a[64:67], v[88:91]
  ds_read2_b32 v[104:105], v55 offset0:128 offset1:129
  ds_read2_b32 v[106:107], v55 offset0:130 offset1:131
  s_waitcnt lgkmcnt(6)
  v_mfma_f32_16x16x32_bf16 v[84:87], v[92:95], a[28:31], v[84:87]
  v_mfma_f32_16x16x32_bf16 v[88:91], v[92:95], a[60:63], v[88:91]
  ds_read2_b32 v[92:93], v55 offset0:112 offset1:113
  ds_read2_b32 v[94:95], v55 offset0:114 offset1:115
  s_waitcnt lgkmcnt(6)
  v_mfma_f32_16x16x32_bf16 v[84:87], v[96:99], a[24:27], v[84:87]
  v_mfma_f32_16x16x32_bf16 v[88:91], v[96:99], a[56:59], v[88:91]
  ds_read2_b32 v[96:97], v55 offset0:96 offset1:97
  ds_read2_b32 v[98:99], v55 offset0:98 offset1:99
  s_waitcnt lgkmcnt(6)
  v_mfma_f32_16x16x32_bf16 v[84:87], v[100:103], a[20:23], v[84:87]
  v_mfma_f32_16x16x32_bf16 v[88:91], v[100:103], a[52:55], v[88:91]
  ds_read2_b32 v[100:101], v55 offset0:80 offset1:81
  ds_read2_b32 v[102:103], v55 offset0:82 offset1:83
  s_waitcnt lgkmcnt(6)
  v_mfma_f32_16x16x32_bf16 v[84:87], v[104:107], a[16:19], v[84:87]
  v_mfma_f32_16x16x32_bf16 v[88:91], v[104:107], a[48:51], v[88:91]
  ds_read2_b32 v[104:105], v55 offset0:64 offset1:65
  ds_read2_b32 v[106:107], v55 offset0:66 offset1:67
  s_waitcnt lgkmcnt(6)
  v_mfma_f32_16x16x32_bf16 v[84:87], v[92:95], a[12:15], v[84:87]
  v_mfma_f32_16x16x32_bf16 v[88:91], v[92:95], a[44:47], v[88:91]
  ds_read2_b32 v[92:93], v55 offset0:48 offset1:49
  ds_read2_b32 v[94:95], v55 offset0:50 offset1:51
  s_waitcnt lgkmcnt(6)
  v_mfma_f32_16x16x32_bf16 v[84:87], v[96:99], a[8:11], v[84:87]
  v_mfma_f32_16x16x32_bf16 v[88:91], v[96:99], a[40:43], v[88:91]
  ds_read2_b32 v[96:97], v55 offset0:32 offset1:33
  ds_read2_b32 v[98:99], v55 offset0:34 offset1:35
  s_waitcnt lgkmcnt(6)
  v_mfma_f32_16x16x32_bf16 v[84:87], v[100:103], a[4:7], v[84:87]
  v_mfma_f32_16x16x32_bf16 v[88:91], v[100:103], a[36:39], v[88:91]
  ds_read2_b32 v[100:101], v55 offset0:16 offset1:17
  ds_read2_b32 v[102:103], v55 offset0:18 offset1:19
  s_waitcnt lgkmcnt(6)
  v_mfma_f32_16x16x32_bf16 v[84:87], v[104:107], a[0:3], v[84:87]
  v_mfma_f32_16x16x32_bf16 v[88:91], v[104:107], a[32:35], v[88:91]
  ds_read2_b32 v[104:105], v55 offset0:0 offset1:1
  ds_read2_b32 v[106:107], v55 offset0:2 offset1:3
  s_waitcnt lgkmcnt(6)
  v_mfma_f32_16x16x32_bf16 v[88:91], v[92:95], a[28:31], v[88:91]
  ds_read2_b32 v[92:93], v56 offset0:224 offset1:225
  ds_read2_b32 v[94:95], v56 offset0:226 offset1:227
  s_waitcnt lgkmcnt(6)
  v_mfma_f32_16x16x32_bf16 v[88:91], v[96:99], a[24:27], v[88:91]
  ds_read2_b32 v[96:97], v56 offset0:208 offset1:209
  ds_read2_b32 v[98:99], v56 offset0:210 offset1:211
  s_waitcnt lgkmcnt(6)
  v_mfma_f32_16x16x32_bf16 v[88:91], v[100:103], a[20:23], v[88:91]
  ds_read2_b32 v[100:101], v56 offset0:192 offset1:193
  ds_read2_b32 v[102:103], v56 offset0:194 offset1:195
  s_waitcnt lgkmcnt(6)
  v_mfma_f32_16x16x32_bf16 v[88:91], v[104:107], a[16:19], v[88:91]
  ds_read2_b32 v[104:105], v56 offset0:176 offset1:177
  ds_read2_b32 v[106:107], v56 offset0:178 offset1:179
  s_waitcnt lgkmcnt(6)
  v_mfma_f32_16x16x32_bf16 v[88:91], v[92:95], a[12:15], v[88:91]
  s_waitcnt lgkmcnt(4)
  v_mfma_f32_16x16x32_bf16 v[88:91], v[96:99], a[8:11], v[88:91]
  s_waitcnt lgkmcnt(2)
  v_mfma_f32_16x16x32_bf16 v[88:91], v[100:103], a[4:7], v[88:91]
  s_waitcnt lgkmcnt(0)
  v_mfma_f32_16x16x32_bf16 v[88:91], v[104:107], a[0:3], v[88:91]
  v_lshlrev_b32 v46, 5, v4
  v_lshl_add_u32 v46, v3, 3, v46
  v_add_u32 v46, s17, v46
  ds_read_b64 v[108:109], v46 offset:512
  ds_read_b64 v[110:111], v46 offset:1024
  ds_read_b64 v[112:113], v46 offset:1536
  ds_read_b64 v[114:115], v46 offset:2048
  ds_read_b64 v[116:117], v46 offset:2560
  ds_read_b64 v[118:119], v46 offset:3072
  ds_read_b64 v[120:121], v46 offset:3584
  ds_read_b64 v[122:123], v46 offset:4096
  s_waitcnt lgkmcnt(0)
  v_lshlrev_b32 v124, 16, v108
  v_and_b32 v125, 0xffff0000, v108
  v_lshlrev_b32 v126, 16, v109
  v_and_b32 v127, 0xffff0000, v109
  v_mul_f32 v124, v124, v33
  v_mul_f32 v125, v125, v33
  v_mul_f32 v126, v126, v33
  v_mul_f32 v127, v127, v33
  v_cvt_pk_bf16_f32 v128, v124, v125
  v_cvt_pk_bf16_f32 v129, v126, v127
  v_cvt_pk_bf16_f32 v130, v60, v61
  v_cvt_pk_bf16_f32 v131, v62, v63
  v_lshlrev_b32 v124, 16, v128
  v_and_b32 v125, 0xffff0000, v128
  v_lshlrev_b32 v132, 16, v130
  v_and_b32 v133, 0xffff0000, v130
  v_lshlrev_b32 v126, 16, v129
  v_and_b32 v127, 0xffff0000, v129
  v_lshlrev_b32 v134, 16, v131
  v_and_b32 v135, 0xffff0000, v131
  v_add_f32 v124, v124, v132
  v_add_f32 v125, v125, v133
  v_add_f32 v126, v126, v134
  v_add_f32 v127, v127, v135
  v_cvt_pk_bf16_f32 v108, v124, v125
  v_cvt_pk_bf16_f32 v109, v126, v127
  ds_write_b64 v46, v[108:109] offset:512
  v_lshlrev_b32 v124, 16, v110
  v_and_b32 v125, 0xffff0000, v110
  v_lshlrev_b32 v126, 16, v111
  v_and_b32 v127, 0xffff0000, v111
  v_mul_f32 v124, v124, v33
  v_mul_f32 v125, v125, v33
  v_mul_f32 v126, v126, v33
  v_mul_f32 v127, v127, v33
  v_cvt_pk_bf16_f32 v128, v124, v125
  v_cvt_pk_bf16_f32 v129, v126, v127
  v_cvt_pk_bf16_f32 v130, v64, v65
  v_cvt_pk_bf16_f32 v131, v66, v67
  v_lshlrev_b32 v124, 16, v128
  v_and_b32 v125, 0xffff0000, v128
  v_lshlrev_b32 v132, 16, v130
  v_and_b32 v133, 0xffff0000, v130
  v_lshlrev_b32 v126, 16, v129
  v_and_b32 v127, 0xffff0000, v129
  v_lshlrev_b32 v134, 16, v131
  v_and_b32 v135, 0xffff0000, v131
  v_add_f32 v124, v124, v132
  v_add_f32 v125, v125, v133
  v_add_f32 v126, v126, v134
  v_add_f32 v127, v127, v135
  v_cvt_pk_bf16_f32 v110, v124, v125
  v_cvt_pk_bf16_f32 v111, v126, v127
  ds_write_b64 v46, v[110:111] offset:1024
  v_lshlrev_b32 v124, 16, v112
  v_and_b32 v125, 0xffff0000, v112
  v_lshlrev_b32 v126, 16, v113
  v_and_b32 v127, 0xffff0000, v113
  v_mul_f32 v124, v124, v33
  v_mul_f32 v125, v125, v33
  v_mul_f32 v126, v126, v33
  v_mul_f32 v127, v127, v33
  v_cvt_pk_bf16_f32 v128, v124, v125
  v_cvt_pk_bf16_f32 v129, v126, v127
  v_cvt_pk_bf16_f32 v130, v68, v69
  v_cvt_pk_bf16_f32 v131, v70, v71
  v_lshlrev_b32 v124, 16, v128
  v_and_b32 v125, 0xffff0000, v128
  v_lshlrev_b32 v132, 16, v130
  v_and_b32 v133, 0xffff0000, v130
  v_lshlrev_b32 v126, 16, v129
  v_and_b32 v127, 0xffff0000, v129
  v_lshlrev_b32 v134, 16, v131
  v_and_b32 v135, 0xffff0000, v131
  v_add_f32 v124, v124, v132
  v_add_f32 v125, v125, v133
  v_add_f32 v126, v126, v134
  v_add_f32 v127, v127, v135
  v_cvt_pk_bf16_f32 v112, v124, v125
  v_cvt_pk_bf16_f32 v113, v126, v127
  ds_write_b64 v46, v[112:113] offset:1536
  v_lshlrev_b32 v124, 16, v114
  v_and_b32 v125, 0xffff0000, v114
  v_lshlrev_b32 v126, 16, v115
  v_and_b32 v127, 0xffff0000, v115
  v_mul_f32 v124, v124, v33
  v_mul_f32 v125, v125, v33
  v_mul_f32 v126, v126, v33
  v_mul_f32 v127, v127, v33
  v_cvt_pk_bf16_f32 v128, v124, v125
  v_cvt_pk_bf16_f32 v129, v126, v127
  v_cvt_pk_bf16_f32 v130, v72, v73
  v_cvt_pk_bf16_f32 v131, v74, v75
  v_lshlrev_b32 v124, 16, v128
  v_and_b32 v125, 0xffff0000, v128
  v_lshlrev_b32 v132, 16, v130
  v_and_b32 v133, 0xffff0000, v130
  v_lshlrev_b32 v126, 16, v129
  v_and_b32 v127, 0xffff0000, v129
  v_lshlrev_b32 v134, 16, v131
  v_and_b32 v135, 0xffff0000, v131
  v_add_f32 v124, v124, v132
  v_add_f32 v125, v125, v133
  v_add_f32 v126, v126, v134
  v_add_f32 v127, v127, v135
  v_cvt_pk_bf16_f32 v114, v124, v125
  v_cvt_pk_bf16_f32 v115, v126, v127
  ds_write_b64 v46, v[114:115] offset:2048
  v_lshlrev_b32 v124, 16, v116
  v_and_b32 v125, 0xffff0000, v116
  v_lshlrev_b32 v126, 16, v117
  v_and_b32 v127, 0xffff0000, v117
  v_mul_f32 v124, v124, v33
  v_mul_f32 v125, v125, v33
  v_mul_f32 v126, v126, v33
  v_mul_f32 v127, v127, v33
  v_cvt_pk_bf16_f32 v128, v124, v125
  v_cvt_pk_bf16_f32 v129, v126, v127
  v_cvt_pk_bf16_f32 v130, v76, v77
  v_cvt_pk_bf16_f32 v131, v78, v79
  v_lshlrev_b32 v124, 16, v128
  v_and_b32 v125, 0xffff0000, v128
  v_lshlrev_b32 v132, 16, v130
  v_and_b32 v133, 0xffff0000, v130
  v_lshlrev_b32 v126, 16, v129
  v_and_b32 v127, 0xffff0000, v129
  v_lshlrev_b32 v134, 16, v131
  v_and_b32 v135, 0xffff0000, v131
  v_add_f32 v124, v124, v132
  v_add_f32 v125, v125, v133
  v_add_f32 v126, v126, v134
  v_add_f32 v127, v127, v135
  v_cvt_pk_bf16_f32 v116, v124, v125
  v_cvt_pk_bf16_f32 v117, v126, v127
  ds_write_b64 v46, v[116:117] offset:2560
  v_lshlrev_b32 v124, 16, v118
  v_and_b32 v125, 0xffff0000, v118
  v_lshlrev_b32 v126, 16, v119
  v_and_b32 v127, 0xffff0000, v119
  v_mul_f32 v124, v124, v33
  v_mul_f32 v125, v125, v33
  v_mul_f32 v126, v126, v33
  v_mul_f32 v127, v127, v33
  v_cvt_pk_bf16_f32 v128, v124, v125
  v_cvt_pk_bf16_f32 v129, v126, v127
  v_cvt_pk_bf16_f32 v130, v80, v81
  v_cvt_pk_bf16_f32 v131, v82, v83
  v_lshlrev_b32 v124, 16, v128
  v_and_b32 v125, 0xffff0000, v128
  v_lshlrev_b32 v132, 16, v130
  v_and_b32 v133, 0xffff0000, v130
  v_lshlrev_b32 v126, 16, v129
  v_and_b32 v127, 0xffff0000, v129
  v_lshlrev_b32 v134, 16, v131
  v_and_b32 v135, 0xffff0000, v131
  v_add_f32 v124, v124, v132
  v_add_f32 v125, v125, v133
  v_add_f32 v126, v126, v134
  v_add_f32 v127, v127, v135
  v_cvt_pk_bf16_f32 v118, v124, v125
  v_cvt_pk_bf16_f32 v119, v126, v127
  ds_write_b64 v46, v[118:119] offset:3072
  v_lshlrev_b32 v124, 16, v120
  v_and_b32 v125, 0xffff0000, v120
  v_lshlrev_b32 v126, 16, v121
  v_and_b32 v127, 0xffff0000, v121
  v_mul_f32 v124, v124, v33
  v_mul_f32 v125, v125, v33
  v_mul_f32 v126, v126, v33
  v_mul_f32 v127, v127, v33
  v_cvt_pk_bf16_f32 v128, v124, v125
  v_cvt_pk_bf16_f32 v129, v126, v127
  v_cvt_pk_bf16_f32 v130, v84, v85
  v_cvt_pk_bf16_f32 v131, v86, v87
  v_lshlrev_b32 v124, 16, v128
  v_and_b32 v125, 0xffff0000, v128
  v_lshlrev_b32 v132, 16, v130
  v_and_b32 v133, 0xffff0000, v130
  v_lshlrev_b32 v126, 16, v129
  v_and_b32 v127, 0xffff0000, v129
  v_lshlrev_b32 v134, 16, v131
  v_and_b32 v135, 0xffff0000, v131
  v_add_f32 v124, v124, v132
  v_add_f32 v125, v125, v133
  v_add_f32 v126, v126, v134
  v_add_f32 v127, v127, v135
  v_cvt_pk_bf16_f32 v120, v124, v125
  v_cvt_pk_bf16_f32 v121, v126, v127
  ds_write_b64 v46, v[120:121] offset:3584
  v_lshlrev_b32 v124, 16, v122
  v_and_b32 v125, 0xffff0000, v122
  v_lshlrev_b32 v126, 16, v123
  v_and_b32 v127, 0xffff0000, v123
  v_mul_f32 v124, v124, v33
  v_mul_f32 v125, v125, v33
  v_mul_f32 v126, v126, v33
  v_mul_f32 v127, v127, v33
  v_cvt_pk_bf16_f32 v128, v124, v125
  v_cvt_pk_bf16_f32 v129, v126, v127
  v_cvt_pk_bf16_f32 v130, v88, v89
  v_cvt_pk_bf16_f32 v131, v90, v91
  v_lshlrev_b32 v124, 16, v128
  v_and_b32 v125, 0xffff0000, v128
  v_lshlrev_b32 v132, 16, v130
  v_and_b32 v133, 0xffff0000, v130
  v_lshlrev_b32 v126, 16, v129
  v_and_b32 v127, 0xffff0000, v129
  v_lshlrev_b32 v134, 16, v131
  v_and_b32 v135, 0xffff0000, v131
  v_add_f32 v124, v124, v132
  v_add_f32 v125, v125, v133
  v_add_f32 v126, v126, v134
  v_add_f32 v127, v127, v135
  v_cvt_pk_bf16_f32 v122, v124, v125
  v_cvt_pk_bf16_f32 v123, v126, v127
  ds_write_b64 v46, v[122:123] offset:4096
  s_waitcnt lgkmcnt(0)
  s_barrier
  v_lshlrev_b32 v6, 3, v0
  v_mul_u32_u24 v5, 7168, v0
  v_add_u32 v36, 512, v6
  ds_read_b64 v[8:9], v36
  v_add_u32 v36, 25088, v6
  ds_read_b64 v[10:11], v36
  v_add_u32 v36, 49664, v6
  ds_read_b64 v[12:13], v36
  v_add_u32 v36, 74240, v6
  ds_read_b64 v[14:15], v36
  s_waitcnt lgkmcnt(0)
  s_add_u32 s22, s21, 0
  s_add_u32 s23, s22, 3584
  v_perm_b32 v16, v10, v8, s24
  v_perm_b32 v17, v14, v12, s24
  buffer_store_dwordx2 v[16:17], v5, s[88:91], s22 offen offset:0
  v_perm_b32 v18, v10, v8, s25
  v_perm_b32 v19, v14, v12, s25
  buffer_store_dwordx2 v[18:19], v5, s[88:91], s22 offen offset:1792
  v_perm_b32 v20, v11, v9, s24
  v_perm_b32 v21, v15, v13, s24
  buffer_store_dwordx2 v[20:21], v5, s[88:91], s23 offen offset:0
  v_perm_b32 v22, v11, v9, s25
  v_perm_b32 v23, v15, v13, s25
  buffer_store_dwordx2 v[22:23], v5, s[88:91], s23 offen offset:1792
  v_add_u32 v36, 2560, v6
  ds_read_b64 v[8:9], v36
  v_add_u32 v36, 27136, v6
  ds_read_b64 v[10:11], v36
  v_add_u32 v36, 51712, v6
  ds_read_b64 v[12:13], v36
  v_add_u32 v36, 76288, v6
  ds_read_b64 v[14:15], v36
  s_waitcnt lgkmcnt(0)
  s_add_u32 s22, s21, 1835008
  s_add_u32 s23, s22, 3584
  v_perm_b32 v24, v10, v8, s24
  v_perm_b32 v25, v14, v12, s24
  buffer_store_dwordx2 v[24:25], v5, s[88:91], s22 offen offset:0
  v_perm_b32 v26, v10, v8, s25
  v_perm_b32 v27, v14, v12, s25
  buffer_store_dwordx2 v[26:27], v5, s[88:91], s22 offen offset:1792
  v_perm_b32 v28, v11, v9, s24
  v_perm_b32 v29, v15, v13, s24
  buffer_store_dwordx2 v[28:29], v5, s[88:91], s23 offen offset:0
  v_perm_b32 v30, v11, v9, s25
  v_perm_b32 v31, v15, v13, s25
  buffer_store_dwordx2 v[30:31], v5, s[88:91], s23 offen offset:1792
  s_branch wk_loop
wk_tok:
  s_sub_u32 s3, s3, 752
  s_cmp_ge_u32 s3, 512
  s_cbranch_scc1 wk_done
  s_and_b32 s18, s3, 3
  s_lshr_b32 s17, s3, 2
  s_cmp_lt_u32 s17, 8
  s_cbranch_scc1 wk_tokp
  s_sub_u32 s20, s17, 8
  s_sub_u32 s17, s17, 64
  s_cmp_ge_u32 s20, 112
  s_cbranch_scc1 wk_toko
  s_lshr_b32 s17, s20, 1
  s_bitcmp0_b32 s20, 0
  s_cbranch_scc1 wk_toko
  s_add_u32 s17, s17, 8
wk_tokp:
  s_lshl_b32 s20, s18, 2
  s_add_u32 s20, s20, s16
  s_lshl_b32 s21, s17, 4
  s_add_u32 s21, s21, s20
  s_mul_i32 s21, s21, 28672
  s_add_u32 s21, s21, 46399488
  s_mul_i32 s23, s17, 28672
  s_add_u32 s23, s23, 75759616
  s_mul_i32 s24, s17, 7168
  s_add_u32 s24, s24, 65536
  s_lshr_b32 s25, s17, 3
  s_lshl_b32 s25, s25, 4
  s_add_u32 s25, s25, s20
  s_lshl_b32 s25, s25, 7
  s_add_u32 s25, s25, 540672
  v_mov_b32 v60, 0
  s_mov_b32 s30, 0
wp_wf:
  buffer_load_dword v61, v60, s[8:11], s25 offen sc1
  s_waitcnt vmcnt(0)
  v_cmp_ne_u32 vcc, 56, v61
  s_cbranch_vccz wp_wf_ok
  s_sleep 4
  s_cmp_ge_u32 s17, 50
  s_cbranch_scc1 wp_wf_bo
  s_sleep 64
wp_wf_bo:
  s_add_u32 s30, s30, 1
  s_cmp_lt_u32 s30, 2000000
  s_cbranch_scc1 wp_wf
  s_branch wp_abort
wp_wf_ok:
  s_lshl_b32 s25, s17, 1
  s_mul_i32 s25, s25, 20480
  s_add_u32 s25, s25, 86114304
  s_lshl_b32 s26, s20, 10
  s_add_u32 s26, s26, s25
  s_lshl_b32 s27, s18, 10
  s_add_u32 s27, s27, s25
  s_lshl_b32 s28, s16, 8
  s_add_u32 s27, s27, s28
  s_add_u32 s27, s27, 16384
  s_mov_b32 s50, -1
  s_mov_b32 s51, 0
  v_lshlrev_b32 v63, 4, v4
  v_lshl_add_u32 v63, v3, 3, v63
  v_mov_b32 v44, -1
  v_mov_b32 v45, -1
  v_mov_b32 v46, -1
  v_mov_b32 v47, -1
  s_add_u32 s28, s26, 0
  s_add_u32 s29, s27, 0
  buffer_store_dwordx4 v[44:47], v2, s[8:11], s28 offen sc1
  s_mov_b64 exec, s[50:51]
  buffer_store_dwordx2 v[44:45], v63, s[8:11], s29 offen sc1
  s_mov_b64 exec, -1
  s_add_u32 s28, s26, 20480
  s_add_u32 s29, s27, 20480
  buffer_store_dwordx4 v[44:47], v2, s[8:11], s28 offen sc1
  s_mov_b64 exec, s[50:51]
  buffer_store_dwordx2 v[44:45], v63, s[8:11], s29 offen sc1
  s_mov_b64 exec, -1
  s_add_u32 s22, s21, 0
  buffer_load_dwordx4 a[0:3], v2, s[8:11], s22 offen offset:0 sc1
  buffer_load_dwordx4 a[4:7], v2, s[8:11], s22 offen offset:1024 sc1
  buffer_load_dwordx4 a[8:11], v2, s[8:11], s22 offen offset:2048 sc1
  buffer_load_dwordx4 a[12:15], v2, s[8:11], s22 offen offset:3072 sc1
  s_add_u32 s22, s21, 4096
  buffer_load_dwordx4 a[16:19], v2, s[8:11], s22 offen offset:0 sc1
  buffer_load_dwordx4 a[20:23], v2, s[8:11], s22 offen offset:1024 sc1
  buffer_load_dwordx4 a[24:27], v2, s[8:11], s22 offen offset:2048 sc1
  buffer_load_dwordx4 a[28:31], v2, s[8:11], s22 offen offset:3072 sc1
  s_add_u32 s22, s21, 8192
  buffer_load_dwordx4 a[32:35], v2, s[8:11], s22 offen offset:0 sc1
  buffer_load_dwordx4 a[36:39], v2, s[8:11], s22 offen offset:1024 sc1
  buffer_load_dwordx4 a[40:43], v2, s[8:11], s22 offen offset:2048 sc1
  buffer_load_dwordx4 a[44:47], v2, s[8:11], s22 offen offset:3072 sc1
  s_add_u32 s22, s21, 12288
  buffer_load_dwordx4 a[48:51], v2, s[8:11], s22 offen offset:0 sc1
  buffer_load_dwordx4 a[52:55], v2, s[8:11], s22 offen offset:1024 sc1
  buffer_load_dwordx4 a[56:59], v2, s[8:11], s22 offen offset:2048 sc1
  buffer_load_dwordx4 a[60:63], v2, s[8:11], s22 offen offset:3072 sc1
  s_add_u32 s22, s21, 16384
  buffer_load_dwordx4 a[64:67], v2, s[8:11], s22 offen offset:0 sc1
  buffer_load_dwordx4 a[68:71], v2, s[8:11], s22 offen offset:1024 sc1
  buffer_load_dwordx4 a[72:75], v2, s[8:11], s22 offen offset:2048 sc1
  buffer_load_dwordx4 a[76:79], v2, s[8:11], s22 offen offset:3072 sc1
  s_add_u32 s22, s21, 20480
  buffer_load_dwordx4 a[80:83], v2, s[8:11], s22 offen offset:0 sc1
  buffer_load_dwordx4 a[84:87], v2, s[8:11], s22 offen offset:1024 sc1
  buffer_load_dwordx4 a[88:91], v2, s[8:11], s22 offen offset:2048 sc1
  buffer_load_dwordx4 a[92:95], v2, s[8:11], s22 offen offset:3072 sc1
  s_add_u32 s22, s21, 24576
  buffer_load_dwordx4 a[96:99], v2, s[8:11], s22 offen offset:0 sc1
  buffer_load_dwordx4 a[100:103], v2, s[8:11], s22 offen offset:1024 sc1
  buffer_load_dwordx4 a[104:107], v2, s[8:11], s22 offen offset:2048 sc1
  buffer_load_dwordx4 a[108:111], v2, s[8:11], s22 offen offset:3072 sc1
  s_add_u32 s22, s23, 0
  buffer_load_dwordx4 a[112:115], v2, s[8:11], s22 offen offset:0 sc1
  buffer_load_dwordx4 a[116:119], v2, s[8:11], s22 offen offset:1024 sc1
  buffer_load_dwordx4 a[120:123], v2, s[8:11], s22 offen offset:2048 sc1
  buffer_load_dwordx4 a[124:127], v2, s[8:11], s22 offen offset:3072 sc1
  s_add_u32 s22, s23, 4096
  buffer_load_dwordx4 a[128:131], v2, s[8:11], s22 offen offset:0 sc1
  buffer_load_dwordx4 a[132:135], v2, s[8:11], s22 offen offset:1024 sc1
  buffer_load_dwordx4 a[136:139], v2, s[8:11], s22 offen offset:2048 sc1
  buffer_load_dwordx4 a[140:143], v2, s[8:11], s22 offen offset:3072 sc1
  s_add_u32 s22, s23, 8192
  buffer_load_dwordx4 a[144:147], v2, s[8:11], s22 offen offset:0 sc1
  buffer_load_dwordx4 a[148:151], v2, s[8:11], s22 offen offset:1024 sc1
  buffer_load_dwordx4 a[152:155], v2, s[8:11], s22 offen offset:2048 sc1
  buffer_load_dwordx4 a[156:159], v2, s[8:11], s22 offen offset:3072 sc1
  s_add_u32 s22, s23, 12288
  buffer_load_dwordx4 a[160:163], v2, s[8:11], s22 offen offset:0 sc1
  buffer_load_dwordx4 a[164:167], v2, s[8:11], s22 offen offset:1024 sc1
  buffer_load_dwordx4 a[168:171], v2, s[8:11], s22 offen offset:2048 sc1
  buffer_load_dwordx4 a[172:175], v2, s[8:11], s22 offen offset:3072 sc1
  s_add_u32 s22, s23, 16384
  buffer_load_dwordx4 a[176:179], v2, s[8:11], s22 offen offset:0 sc1
  buffer_load_dwordx4 a[180:183], v2, s[8:11], s22 offen offset:1024 sc1
  buffer_load_dwordx4 a[184:187], v2, s[8:11], s22 offen offset:2048 sc1
  buffer_load_dwordx4 a[188:191], v2, s[8:11], s22 offen offset:3072 sc1
  s_add_u32 s22, s23, 20480
  buffer_load_dwordx4 a[192:195], v2, s[8:11], s22 offen offset:0 sc1
  buffer_load_dwordx4 a[196:199], v2, s[8:11], s22 offen offset:1024 sc1
  buffer_load_dwordx4 a[200:203], v2, s[8:11], s22 offen offset:2048 sc1
  buffer_load_dwordx4 a[204:207], v2, s[8:11], s22 offen offset:3072 sc1
  s_add_u32 s22, s23, 24576
  buffer_load_dwordx4 a[208:211], v2, s[8:11], s22 offen offset:0 sc1
  buffer_load_dwordx4 a[212:215], v2, s[8:11], s22 offen offset:1024 sc1
  buffer_load_dwordx4 a[216:219], v2, s[8:11], s22 offen offset:2048 sc1
  buffer_load_dwordx4 a[220:223], v2, s[8:11], s22 offen offset:3072 sc1
  v_lshl_add_u32 v5, v3, 2, 0
  v_cmp_le_u32 s[40:41], v5, v4
  v_lshl_add_u32 v5, v3, 2, 1
  v_cmp_le_u32 s[42:43], v5, v4
  v_lshl_add_u32 v5, v3, 2, 2
  v_cmp_le_u32 s[44:45], v5, v4
  v_lshl_add_u32 v5, v3, 2, 3
  v_cmp_le_u32 s[46:47], v5, v4
  v_cmp_gt_u32 s[48:49], 2, v3
  v_mov_b32 v6, 0xff800000
  s_waitcnt vmcnt(0)
  s_lshl_b32 s25, s17, 7
  s_add_u32 s25, s25, 557056
  v_mov_b32 v5, 1
  v_mov_b32 v7, 0
  s_waitcnt vmcnt(0)
  s_mov_b64 exec, 1
  buffer_atomic_add v5, v7, s[8:11], s25 offen
  s_mov_b64 exec, -1
  v_mfma_f32_16x16x32_bf16 v[8:11], a[112:115], a[0:3], 0
  v_mfma_f32_16x16x32_bf16 v[12:15], a[112:115], a[56:59], 0
  v_mfma_f32_16x16x32_bf16 v[16:19], a[168:171], a[56:59], 0
  v_mfma_f32_16x16x32_bf16 v[8:11], a[116:119], a[4:7], v[8:11]
  v_mfma_f32_16x16x32_bf16 v[12:15], a[116:119], a[60:63], v[12:15]
  v_mfma_f32_16x16x32_bf16 v[16:19], a[172:175], a[60:63], v[16:19]
  v_mfma_f32_16x16x32_bf16 v[8:11], a[120:123], a[8:11], v[8:11]
  v_mfma_f32_16x16x32_bf16 v[12:15], a[120:123], a[64:67], v[12:15]
  v_mfma_f32_16x16x32_bf16 v[16:19], a[176:179], a[64:67], v[16:19]
  v_mfma_f32_16x16x32_bf16 v[8:11], a[124:127], a[12:15], v[8:11]
  v_mfma_f32_16x16x32_bf16 v[12:15], a[124:127], a[68:71], v[12:15]
  v_mfma_f32_16x16x32_bf16 v[16:19], a[180:183], a[68:71], v[16:19]
  v_mfma_f32_16x16x32_bf16 v[8:11], a[128:131], a[16:19], v[8:11]
  v_mfma_f32_16x16x32_bf16 v[12:15], a[128:131], a[72:75], v[12:15]
  v_mfma_f32_16x16x32_bf16 v[16:19], a[184:187], a[72:75], v[16:19]
  v_mfma_f32_16x16x32_bf16 v[8:11], a[132:135], a[20:23], v[8:11]
  v_mfma_f32_16x16x32_bf16 v[12:15], a[132:135], a[76:79], v[12:15]
  v_mfma_f32_16x16x32_bf16 v[16:19], a[188:191], a[76:79], v[16:19]
  v_mfma_f32_16x16x32_bf16 v[8:11], a[136:139], a[24:27], v[8:11]
  v_mfma_f32_16x16x32_bf16 v[12:15], a[136:139], a[80:83], v[12:15]
  v_mfma_f32_16x16x32_bf16 v[16:19], a[192:195], a[80:83], v[16:19]
  v_mfma_f32_16x16x32_bf16 v[8:11], a[140:143], a[28:31], v[8:11]
  v_mfma_f32_16x16x32_bf16 v[12:15], a[140:143], a[84:87], v[12:15]
  v_mfma_f32_16x16x32_bf16 v[16:19], a[196:199], a[84:87], v[16:19]
  v_mfma_f32_16x16x32_bf16 v[8:11], a[144:147], a[32:35], v[8:11]
  v_mfma_f32_16x16x32_bf16 v[12:15], a[144:147], a[88:91], v[12:15]
  v_mfma_f32_16x16x32_bf16 v[16:19], a[200:203], a[88:91], v[16:19]
  v_mfma_f32_16x16x32_bf16 v[8:11], a[148:151], a[36:39], v[8:11]
  v_mfma_f32_16x16x32_bf16 v[12:15], a[148:151], a[92:95], v[12:15]
  v_mfma_f32_16x16x32_bf16 v[16:19], a[204:207], a[92:95], v[16:19]
  v_mfma_f32_16x16x32_bf16 v[8:11], a[152:155], a[40:43], v[8:11]
  v_mfma_f32_16x16x32_bf16 v[12:15], a[152:155], a[96:99], v[12:15]
  v_mfma_f32_16x16x32_bf16 v[16:19], a[208:211], a[96:99], v[16:19]
  v_mfma_f32_16x16x32_bf16 v[8:11], a[156:159], a[44:47], v[8:11]
  v_mfma_f32_16x16x32_bf16 v[12:15], a[156:159], a[100:103], v[12:15]
  v_mfma_f32_16x16x32_bf16 v[16:19], a[212:215], a[100:103], v[16:19]
  v_mfma_f32_16x16x32_bf16 v[8:11], a[160:163], a[48:51], v[8:11]
  v_mfma_f32_16x16x32_bf16 v[12:15], a[160:163], a[104:107], v[12:15]
  v_mfma_f32_16x16x32_bf16 v[16:19], a[216:219], a[104:107], v[16:19]
  v_mfma_f32_16x16x32_bf16 v[8:11], a[164:167], a[52:55], v[8:11]
  v_mfma_f32_16x16x32_bf16 v[12:15], a[164:167], a[108:111], v[12:15]
  v_mfma_f32_16x16x32_bf16 v[16:19], a[220:223], a[108:111], v[16:19]
  s_mul_i32 s22, s20, 448
  s_add_u32 s22, s22, s24
  s_mov_b32 s31, 0
  s_cmp_ge_u32 s17, 63
  s_cselect_b32 s23, 7168, 0
  s_cselect_b32 s29, 1, 0
  s_sub_u32 s22, s22, s23
  v_mov_b32 v62, s22
  s_mov_b32 s30, 0
wp_pm:
  s_cmp_ge_u32 s17, 64
  s_cbranch_scc1 wp_pf
  buffer_load_dword v61, v62, s[8:11], 0 offen sc1
  s_waitcnt vmcnt(0)
  v_subrev_u32 v61, s31, v61
  v_cmp_eq_u32 vcc, -1, v61
  s_cbranch_vccnz wp_pr
wp_pf:
  s_add_u32 s22, s24, 4096
  buffer_load_dwordx4 v[64:67], v2, s[8:11], s24 offen offset:0 sc1
  buffer_load_dwordx4 v[68:71], v2, s[8:11], s24 offen offset:1024 sc1
  buffer_load_dwordx4 v[72:75], v2, s[8:11], s24 offen offset:2048 sc1
  buffer_load_dwordx4 v[76:79], v2, s[8:11], s24 offen offset:3072 sc1
  buffer_load_dwordx4 v[80:83], v2, s[8:11], s22 offen offset:0 sc1
  buffer_load_dwordx4 v[84:87], v2, s[8:11], s22 offen offset:1024 sc1
  buffer_load_dwordx4 v[88:91], v2, s[8:11], s22 offen offset:2048 sc1
  s_waitcnt vmcnt(0)
  v_max_u32 v61, v64, v65
  v_max3_u32 v61, v61, v66, v67
  v_max3_u32 v61, v61, v68, v69
  v_max3_u32 v61, v61, v70, v71
  v_max3_u32 v61, v61, v72, v73
  v_max3_u32 v61, v61, v74, v75
  v_max3_u32 v61, v61, v76, v77
  v_max3_u32 v61, v61, v78, v79
  v_max3_u32 v61, v61, v80, v81
  v_max3_u32 v61, v61, v82, v83
  v_max3_u32 v61, v61, v84, v85
  v_max3_u32 v61, v61, v86, v87
  v_max3_u32 v61, v61, v88, v89
  v_max3_u32 v61, v61, v90, v91
  v_cmp_eq_u32 vcc, -1, v61
  s_cbranch_vccz wp_pk
  s_add_u32 s30, s30, 1
  s_cmp_eq_u32 s29, 0
  s_cbranch_scc1 wp_pr
  s_cmp_lt_u32 s30, 2000000
  s_cbranch_scc1 wp_pf
wp_pr:
  s_sleep 4
  s_cmp_ge_u32 s17, 50
  s_cbranch_scc1 wp_pm_bo
  s_sleep 64
wp_pm_bo:
  s_add_u32 s30, s30, 1
  s_cmp_lt_u32 s30, 2000000
  s_cbranch_scc1 wp_pm
  s_branch wp_abort
wp_pk:
  buffer_load_dword v250, v251, s[8:11], 0 offen sc1
  v_mfma_f32_16x16x32_bf16 v[20:23], v[64:67], a[0:3], 0
  v_mfma_f32_16x16x32_bf16 v[24:27], v[64:67], a[4:7], 0
  v_mfma_f32_16x16x32_bf16 v[28:31], v[64:67], a[56:59], 0
  v_mfma_f32_16x16x32_bf16 v[32:35], v[64:67], a[60:63], 0
  v_mfma_f32_16x16x32_bf16 v[20:23], v[68:71], a[8:11], v[20:23]
  v_mfma_f32_16x16x32_bf16 v[24:27], v[68:71], a[12:15], v[24:27]
  v_mfma_f32_16x16x32_bf16 v[28:31], v[68:71], a[64:67], v[28:31]
  v_mfma_f32_16x16x32_bf16 v[32:35], v[68:71], a[68:71], v[32:35]
  v_mfma_f32_16x16x32_bf16 v[20:23], v[72:75], a[16:19], v[20:23]
  v_mfma_f32_16x16x32_bf16 v[24:27], v[72:75], a[20:23], v[24:27]
  v_mfma_f32_16x16x32_bf16 v[28:31], v[72:75], a[72:75], v[28:31]
  v_mfma_f32_16x16x32_bf16 v[32:35], v[72:75], a[76:79], v[32:35]
  v_mfma_f32_16x16x32_bf16 v[20:23], v[76:79], a[24:27], v[20:23]
  v_mfma_f32_16x16x32_bf16 v[24:27], v[76:79], a[28:31], v[24:27]
  v_mfma_f32_16x16x32_bf16 v[28:31], v[76:79], a[80:83], v[28:31]
  v_mfma_f32_16x16x32_bf16 v[32:35], v[76:79], a[84:87], v[32:35]
  v_mfma_f32_16x16x32_bf16 v[20:23], v[80:83], a[32:35], v[20:23]
  v_mfma_f32_16x16x32_bf16 v[24:27], v[80:83], a[36:39], v[24:27]
  v_mfma_f32_16x16x32_bf16 v[28:31], v[80:83], a[88:91], v[28:31]
  v_mfma_f32_16x16x32_bf16 v[32:35], v[80:83], a[92:95], v[32:35]
  v_mfma_f32_16x16x32_bf16 v[20:23], v[84:87], a[40:43], v[20:23]
  v_mfma_f32_16x16x32_bf16 v[24:27], v[84:87], a[44:47], v[24:27]
  v_mfma_f32_16x16x32_bf16 v[28:31], v[84:87], a[96:99], v[28:31]
  v_mfma_f32_16x16x32_bf16 v[32:35], v[84:87], a[100:103], v[32:35]
  v_mfma_f32_16x16x32_bf16 v[20:23], v[88:91], a[48:51], v[20:23]
  v_mfma_f32_16x16x32_bf16 v[24:27], v[88:91], a[52:55], v[24:27]
  v_mfma_f32_16x16x32_bf16 v[28:31], v[88:91], a[104:107], v[28:31]
  v_mfma_f32_16x16x32_bf16 v[32:35], v[88:91], a[108:111], v[32:35]
  v_cndmask_b32 v8, v6, v8, s[40:41]
  v_cndmask_b32 v9, v6, v9, s[42:43]
  v_cndmask_b32 v10, v6, v10, s[44:45]
  v_cndmask_b32 v11, v6, v11, s[46:47]
  v_cndmask_b32 v20, v24, v20, s[48:49]
  v_cndmask_b32 v21, v25, v21, s[48:49]
  v_cndmask_b32 v22, v26, v22, s[48:49]
  v_cndmask_b32 v23, v27, v23, s[48:49]
  v_mov_b32 v24, v20
  v_mov_b32 v25, v21
  v_mov_b32 v26, v22
  v_mov_b32 v27, v23
  v_permlane32_swap_b32 v20, v24
  v_permlane32_swap_b32 v21, v25
  v_permlane32_swap_b32 v22, v26
  v_permlane32_swap_b32 v23, v27
  v_add_f32 v20, v20, v24
  v_add_f32 v21, v21, v25
  v_add_f32 v22, v22, v26
  v_add_f32 v23, v23, v27
  v_max3_f32 v40, v8, v9, v10
  v_max3_f32 v40, v40, v11, v20
  v_max3_f32 v40, v40, v21, v22
  v_max_f32 v40, v40, v23
  v_mov_b32 v41, v40
  s_nop 1
  v_permlane16_swap_b32 v40, v41
  v_max_f32 v40, v40, v41
  v_mov_b32 v41, v40
  s_nop 1
  v_permlane32_swap_b32 v40, v41
  v_max_f32 v40, v40, v41
  v_sub_f32 v8, v8, v40
  v_sub_f32 v9, v9, v40
  v_sub_f32 v10, v10, v40
  v_sub_f32 v11, v11, v40
  v_sub_f32 v20, v20, v40
  v_sub_f32 v21, v21, v40
  v_sub_f32 v22, v22, v40
  v_sub_f32 v23, v23, v40
  v_exp_f32 v8, v8
  v_exp_f32 v9, v9
  v_exp_f32 v10, v10
  v_exp_f32 v11, v11
  v_exp_f32 v20, v20
  v_exp_f32 v21, v21
  v_exp_f32 v22, v22
  v_exp_f32 v23, v23
  v_add_f32 v42, v20, v21
  v_add_f32 v43, v22, v23
  v_add_f32 v42, v42, v43
  v_mul_f32 v42, 0.5, v42
  v_add_f32 v42, v42, v8
  v_add_f32 v42, v42, v9
  v_add_f32 v42, v42, v10
  v_add_f32 v42, v42, v11
  v_mov_b32 v41, v42
  s_nop 1
  v_permlane16_swap_b32 v42, v41
  v_add_f32 v42, v42, v41
  v_mov_b32 v41, v42
  s_nop 1
  v_permlane32_swap_b32 v42, v41
  v_add_f32 v42, v42, v41
  v_rcp_f32 v42, v42
  s_nop 0
  v_mul_f32 v8, v8, v42
  v_mul_f32 v9, v9, v42
  v_mul_f32 v10, v10, v42
  v_mul_f32 v11, v11, v42
  v_mul_f32 v20, v20, v42
  v_mul_f32 v21, v21, v42
  v_mul_f32 v22, v22, v42
  v_mul_f32 v23, v23, v42
  v_cvt_pk_bf16_f32 v44, v8, 0
  v_cvt_pk_bf16_f32 v45, v9, 0
  v_cvt_pk_bf16_f32 v46, v10, 0
  v_cvt_pk_bf16_f32 v47, v11, 0
  v_cvt_pk_bf16_f32 v48, v20, v21
  v_cvt_pk_bf16_f32 v49, v22, v23
  v_min_u32 v44, -2, v44
  v_min_u32 v45, -2, v45
  v_min_u32 v46, -2, v46
  v_min_u32 v47, -2, v47
  v_min_u32 v48, -2, v48
  v_min_u32 v49, -2, v49
  buffer_store_dwordx4 v[44:47], v2, s[8:11], s26 offen sc1
  s_mov_b64 exec, s[50:51]
  buffer_store_dwordx2 v[48:49], v63, s[8:11], s27 offen sc1
  s_mov_b64 exec, -1
  s_add_u32 s26, s26, 20480
  s_add_u32 s27, s27, 20480
  v_cndmask_b32 v16, v6, v16, s[40:41]
  v_cndmask_b32 v17, v6, v17, s[42:43]
  v_cndmask_b32 v18, v6, v18, s[44:45]
  v_cndmask_b32 v19, v6, v19, s[46:47]
  v_cndmask_b32 v28, v32, v28, s[48:49]
  v_cndmask_b32 v29, v33, v29, s[48:49]
  v_cndmask_b32 v30, v34, v30, s[48:49]
  v_cndmask_b32 v31, v35, v31, s[48:49]
  v_mov_b32 v32, v28
  v_mov_b32 v33, v29
  v_mov_b32 v34, v30
  v_mov_b32 v35, v31
  v_permlane32_swap_b32 v28, v32
  v_permlane32_swap_b32 v29, v33
  v_permlane32_swap_b32 v30, v34
  v_permlane32_swap_b32 v31, v35
  v_add_f32 v28, v28, v32
  v_add_f32 v29, v29, v33
  v_add_f32 v30, v30, v34
  v_add_f32 v31, v31, v35
  v_max3_f32 v40, v12, v13, v14
  v_max3_f32 v40, v40, v15, v16
  v_max3_f32 v40, v40, v17, v18
  v_max3_f32 v40, v40, v19, v28
  v_max3_f32 v40, v40, v29, v30
  v_max_f32 v40, v40, v31
  v_mov_b32 v41, v40
  s_nop 1
  v_permlane16_swap_b32 v40, v41
  v_max_f32 v40, v40, v41
  v_mov_b32 v41, v40
  s_nop 1
  v_permlane32_swap_b32 v40, v41
  v_max_f32 v40, v40, v41
  v_sub_f32 v12, v12, v40
  v_sub_f32 v13, v13, v40
  v_sub_f32 v14, v14, v40
  v_sub_f32 v15, v15, v40
  v_sub_f32 v16, v16, v40
  v_sub_f32 v17, v17, v40
  v_sub_f32 v18, v18, v40
  v_sub_f32 v19, v19, v40
  v_sub_f32 v28, v28, v40
  v_sub_f32 v29, v29, v40
  v_sub_f32 v30, v30, v40
  v_sub_f32 v31, v31, v40
  v_exp_f32 v12, v12
  v_exp_f32 v13, v13
  v_exp_f32 v14, v14
  v_exp_f32 v15, v15
  v_exp_f32 v16, v16
  v_exp_f32 v17, v17
  v_exp_f32 v18, v18
  v_exp_f32 v19, v19
  v_exp_f32 v28, v28
  v_exp_f32 v29, v29
  v_exp_f32 v30, v30
  v_exp_f32 v31, v31
  v_add_f32 v42, v28, v29
  v_add_f32 v43, v30, v31
  v_add_f32 v42, v42, v43
  v_mul_f32 v42, 0.5, v42
  v_add_f32 v42, v42, v12
  v_add_f32 v42, v42, v13
  v_add_f32 v42, v42, v14
  v_add_f32 v42, v42, v15
  v_add_f32 v42, v42, v16
  v_add_f32 v42, v42, v17
  v_add_f32 v42, v42, v18
  v_add_f32 v42, v42, v19
  v_mov_b32 v41, v42
  s_nop 1
  v_permlane16_swap_b32 v42, v41
  v_add_f32 v42, v42, v41
  v_mov_b32 v41, v42
  s_nop 1
  v_permlane32_swap_b32 v42, v41
  v_add_f32 v42, v42, v41
  v_rcp_f32 v42, v42
  s_nop 0
  v_mul_f32 v12, v12, v42
  v_mul_f32 v13, v13, v42
  v_mul_f32 v14, v14, v42
  v_mul_f32 v15, v15, v42
  v_mul_f32 v16, v16, v42
  v_mul_f32 v17, v17, v42
  v_mul_f32 v18, v18, v42
  v_mul_f32 v19, v19, v42
  v_mul_f32 v28, v28, v42
  v_mul_f32 v29, v29, v42
  v_mul_f32 v30, v30, v42
  v_mul_f32 v31, v31, v42
  v_cvt_pk_bf16_f32 v52, v12, v16
  v_cvt_pk_bf16_f32 v53, v13, v17
  v_cvt_pk_bf16_f32 v54, v14, v18
  v_cvt_pk_bf16_f32 v55, v15, v19
  v_cvt_pk_bf16_f32 v56, v28, v29
  v_cvt_pk_bf16_f32 v57, v30, v31
  v_min_u32 v52, -2, v52
  v_min_u32 v53, -2, v53
  v_min_u32 v54, -2, v54
  v_min_u32 v55, -2, v55
  v_min_u32 v56, -2, v56
  v_min_u32 v57, -2, v57
  buffer_store_dwordx4 v[52:55], v2, s[8:11], s26 offen sc1
  s_mov_b64 exec, s[50:51]
  buffer_store_dwordx2 v[56:57], v63, s[8:11], s27 offen sc1
  s_mov_b64 exec, -1
  s_branch wk_loop
wk_toko:
  s_load_dwordx2 s[36:37], s[0:1], 112
  s_waitcnt lgkmcnt(0)
  s_mov_b32 s92, s36
  s_and_b32 s93, s37, 0xffff
  s_mov_b32 s94, 3670016
  s_mov_b32 s95, 0x20000
  s_lshl_b32 s20, s18, 2
  s_add_u32 s20, s20, s16
  s_mul_i32 s24, s20, 65
  s_add_u32 s24, s24, s17
  s_lshl_b32 s24, s24, 13
  s_add_u32 s24, s24, 77602816
  s_mul_i32 s21, s20, 28672
  s_mul_i32 s22, s17, 458752
  s_add_u32 s21, s21, s22
  s_add_u32 s21, s21, 2490368
  s_lshl_b32 s25, s17, 1
  s_mul_i32 s25, s25, 20480
  s_add_u32 s25, s25, 86114304
  v_mov_b32 v5, v2
  v_min_u32 v6, 11, v4
  v_mad_u32_u24 v6, v3, 12, v6
  v_lshlrev_b32 v6, 4, v6
  v_add_u32 v6, 1024, v6
  v_lshrrev_b32 v8, 1, v3
  v_lshl_add_u32 v8, v8, 4, v4
  v_lshlrev_b32 v8, 4, v8
  v_and_b32 v9, 1, v3
  v_lshl_add_u32 v7, v9, 3, v8
  s_lshr_b32 s26, s17, 3
  s_lshl_b32 s26, s26, 4
  s_add_u32 s26, s26, s20
  s_lshl_b32 s26, s26, 7
  s_add_u32 s26, s26, 524288
  v_mov_b32 v60, 0
  s_mov_b32 s30, 0
wo_wv:
  buffer_load_dword v61, v60, s[8:11], s26 offen sc1
  s_waitcnt vmcnt(0)
  v_cmp_ne_u32 vcc, 56, v61
  s_cbranch_vccz wo_wv_ok
  s_sleep 4
  s_cmp_ge_u32 s17, 50
  s_cbranch_scc1 wo_wv_bo
  s_sleep 64
wo_wv_bo:
  s_add_u32 s30, s30, 1
  s_cmp_lt_u32 s30, 2000000
  s_cbranch_scc1 wo_wv
  s_branch wo_abort
wo_wv_ok:
  s_add_u32 s22, s21, 0
  buffer_load_dwordx4 a[0:3], v5, s[8:11], s22 offen offset:0 sc1
  buffer_load_dwordx4 a[4:7], v6, s[8:11], s22 offen offset:0 sc1
  buffer_load_dwordx4 a[8:11], v5, s[8:11], s22 offen offset:1792 sc1
  buffer_load_dwordx4 a[12:15], v6, s[8:11], s22 offen offset:1792 sc1
  s_add_u32 s22, s21, 3584
  buffer_load_dwordx4 a[16:19], v5, s[8:11], s22 offen offset:0 sc1
  buffer_load_dwordx4 a[20:23], v6, s[8:11], s22 offen offset:0 sc1
  buffer_load_dwordx4 a[24:27], v5, s[8:11], s22 offen offset:1792 sc1
  buffer_load_dwordx4 a[28:31], v6, s[8:11], s22 offen offset:1792 sc1
  s_add_u32 s22, s21, 7168
  buffer_load_dwordx4 a[32:35], v5, s[8:11], s22 offen offset:0 sc1
  buffer_load_dwordx4 a[36:39], v6, s[8:11], s22 offen offset:0 sc1
  buffer_load_dwordx4 a[40:43], v5, s[8:11], s22 offen offset:1792 sc1
  buffer_load_dwordx4 a[44:47], v6, s[8:11], s22 offen offset:1792 sc1
  s_add_u32 s22, s21, 10752
  buffer_load_dwordx4 a[48:51], v5, s[8:11], s22 offen offset:0 sc1
  buffer_load_dwordx4 a[52:55], v6, s[8:11], s22 offen offset:0 sc1
  buffer_load_dwordx4 a[56:59], v5, s[8:11], s22 offen offset:1792 sc1
  buffer_load_dwordx4 a[60:63], v6, s[8:11], s22 offen offset:1792 sc1
  s_add_u32 s22, s21, 14336
  buffer_load_dwordx4 a[64:67], v5, s[8:11], s22 offen offset:0 sc1
  buffer_load_dwordx4 a[68:71], v6, s[8:11], s22 offen offset:0 sc1
  buffer_load_dwordx4 a[72:75], v5, s[8:11], s22 offen offset:1792 sc1
  buffer_load_dwordx4 a[76:79], v6, s[8:11], s22 offen offset:1792 sc1
  s_add_u32 s22, s21, 17920
  buffer_load_dwordx4 a[80:83], v5, s[8:11], s22 offen offset:0 sc1
  buffer_load_dwordx4 a[84:87], v6, s[8:11], s22 offen offset:0 sc1
  buffer_load_dwordx4 a[88:91], v5, s[8:11], s22 offen offset:1792 sc1
  buffer_load_dwordx4 a[92:95], v6, s[8:11], s22 offen offset:1792 sc1
  s_add_u32 s22, s21, 21504
  buffer_load_dwordx4 a[96:99], v5, s[8:11], s22 offen offset:0 sc1
  buffer_load_dwordx4 a[100:103], v6, s[8:11], s22 offen offset:0 sc1
  buffer_load_dwordx4 a[104:107], v5, s[8:11], s22 offen offset:1792 sc1
  buffer_load_dwordx4 a[108:111], v6, s[8:11], s22 offen offset:1792 sc1
  s_add_u32 s22, s21, 25088
  buffer_load_dwordx4 a[112:115], v5, s[8:11], s22 offen offset:0 sc1
  buffer_load_dwordx4 a[116:119], v6, s[8:11], s22 offen offset:0 sc1
  buffer_load_dwordx4 a[120:123], v5, s[8:11], s22 offen offset:1792 sc1
  buffer_load_dwordx4 a[124:127], v6, s[8:11], s22 offen offset:1792 sc1
  s_and_b32 s27, s17, 1
  s_cmp_ge_u32 s17, 62
  s_cselect_b32 s27, s17, s27
  s_lshl_b32 s26, s20, 6
  s_add_u32 s26, s26, s27
  s_lshl_b32 s26, s26, 4
  s_add_u32 s26, s26, 565248
  v_lshlrev_b32 v60, 2, v3
  s_mov_b32 s30, 0
wo_wt:
  buffer_load_dword v61, v60, s[8:11], s26 offen sc1
  s_waitcnt vmcnt(0)
  v_cmp_ne_u32 vcc, 1, v61
  s_cbranch_vccz wo_wt_ok
  s_sleep 4
  s_cmp_ge_u32 s17, 50
  s_cbranch_scc1 wo_wt_bo
  s_sleep 64
wo_wt_bo:
  s_add_u32 s30, s30, 1
  s_cmp_lt_u32 s30, 2000000
  s_cbranch_scc1 wo_wt
  s_branch wo_abort
wo_wt_ok:
  v_mul_u32_u24 v9, 1792, v4
  v_lshl_add_u32 v9, v3, 3, v9
  s_lshl_b32 s22, s20, 5
  v_add_u32 v8, s22, v9
  s_mul_i32 s22, s20, 24
  s_add_u32 s22, s22, 512
  v_add_u32 v9, s22, v9
  v_mov_b32 v10, 0x40000000
  v_cmp_eq_u32 vcc, 3, v3
  s_nop 1
  v_cndmask_b32 v9, v9, v10, vcc
  s_mul_i32 s44, s17, 57344
  s_add_u32 s44, s44, 896
  s_add_u32 s45, s44, 28672
  s_lshl_b32 s26, s17, 7
  s_add_u32 s26, s26, 557056
  v_mov_b32 v60, 0
  s_mov_b32 s30, 0
wo_wp:
  buffer_load_dword v61, v60, s[8:11], s26 offen sc1
  s_waitcnt vmcnt(0)
  v_cmp_ne_u32 vcc, 16, v61
  s_cbranch_vccz wo_wp_ok
  s_sleep 4
  s_cmp_ge_u32 s17, 50
  s_cbranch_scc1 wo_wp_bo
  s_sleep 64
wo_wp_bo:
  s_add_u32 s30, s30, 1
  s_cmp_lt_u32 s30, 2000000
  s_cbranch_scc1 wo_wp
  s_branch wo_abort
wo_wp_ok:
  s_lshl_b32 s31, s16, 2
  s_add_u32 s31, s31, s26
  s_lshl_b32 s28, s16, 12
  s_add_u32 s26, s25, s28
  s_add_u32 s27, s26, 20480
  s_lshl_b32 s28, s16, 10
  s_add_u32 s28, s28, s25
  s_add_u32 s28, s28, 16384
  s_add_u32 s29, s28, 20480
  s_add_u32 s23, s24, 4096
  s_mov_b32 s30, 0
  s_sub_u32 s33, s24, 0
  s_cmp_ge_u32 s17, 63
  s_cselect_b32 s31, s33, s26
  s_cselect_b32 s33, s33, s24
wo_ps:
  buffer_load_dword v61, off, s[8:11], s33 sc1
  buffer_load_dword v62, off, s[8:11], s31 sc1
  s_waitcnt vmcnt(0)
  v_max_u32 v61, v61, v62
  v_cmp_eq_u32 vcc, -1, v61
  s_cbranch_vccz wo_pl
  s_sleep 2
  s_cmp_ge_u32 s17, 50
  s_cbranch_scc1 wo_ps_bo
  s_sleep 64
wo_ps_bo:
  s_add_u32 s30, s30, 1
  s_cmp_lt_u32 s30, 2000000
  s_cbranch_scc1 wo_ps
  s_branch wo_abort
wo_pl:
  buffer_load_dword v250, v251, s[8:11], 0 offen sc1
  buffer_load_dwordx4 v[28:31], v2, s[8:11], s24 offen offset:0 sc1
  buffer_load_dwordx4 v[32:35], v2, s[8:11], s24 offen offset:1024 sc1
  buffer_load_dwordx4 v[36:39], v2, s[8:11], s24 offen offset:2048 sc1
  buffer_load_dwordx4 v[40:43], v2, s[8:11], s24 offen offset:3072 sc1
  buffer_load_dwordx4 v[44:47], v2, s[8:11], s23 offen offset:0 sc1
  buffer_load_dwordx4 v[48:51], v2, s[8:11], s23 offen offset:1024 sc1
  buffer_load_dwordx4 v[52:55], v2, s[8:11], s23 offen offset:2048 sc1
  buffer_load_dwordx4 v[56:59], v2, s[8:11], s23 offen offset:3072 sc1
  buffer_load_dwordx4 v[64:67], v2, s[8:11], s26 offen offset:0 sc1
  buffer_load_dwordx4 v[68:71], v2, s[8:11], s26 offen offset:1024 sc1
  buffer_load_dwordx4 v[72:75], v2, s[8:11], s26 offen offset:2048 sc1
  buffer_load_dwordx4 v[76:79], v2, s[8:11], s26 offen offset:3072 sc1
  buffer_load_dwordx4 v[80:83], v2, s[8:11], s28 offen sc1
  buffer_load_dwordx4 v[84:87], v2, s[8:11], s27 offen offset:0 sc1
  buffer_load_dwordx4 v[88:91], v2, s[8:11], s27 offen offset:1024 sc1
  buffer_load_dwordx4 v[92:95], v2, s[8:11], s27 offen offset:2048 sc1
  buffer_load_dwordx4 v[96:99], v2, s[8:11], s27 offen offset:3072 sc1
  buffer_load_dwordx4 v[100:103], v2, s[8:11], s29 offen sc1
  s_waitcnt vmcnt(10)
  v_max_u32 v61, v28, v29
  v_max3_u32 v61, v61, v30, v31
  v_max3_u32 v61, v61, v32, v33
  v_max3_u32 v61, v61, v34, v35
  v_max3_u32 v61, v61, v36, v37
  v_max3_u32 v61, v61, v38, v39
  v_max3_u32 v61, v61, v40, v41
  v_max3_u32 v61, v61, v42, v43
  v_max3_u32 v61, v61, v44, v45
  v_max3_u32 v61, v61, v46, v47
  v_max3_u32 v61, v61, v48, v49
  v_max3_u32 v61, v61, v50, v51
  v_max3_u32 v61, v61, v52, v53
  v_max3_u32 v61, v61, v54, v55
  v_max3_u32 v61, v61, v56, v57
  v_max3_u32 v61, v61, v58, v59
  v_cmp_eq_u32 vcc, -1, v61
  s_cbranch_vccz wo_p2
  s_add_u32 s30, s30, 1
  s_cmp_lt_u32 s30, 2000000
  s_cbranch_scc1 wo_pl
  s_branch wo_abort
wo_p1:
  buffer_load_dwordx4 v[64:67], v2, s[8:11], s26 offen offset:0 sc1
  buffer_load_dwordx4 v[68:71], v2, s[8:11], s26 offen offset:1024 sc1
  buffer_load_dwordx4 v[72:75], v2, s[8:11], s26 offen offset:2048 sc1
  buffer_load_dwordx4 v[76:79], v2, s[8:11], s26 offen offset:3072 sc1
  buffer_load_dwordx4 v[80:83], v2, s[8:11], s28 offen sc1
  buffer_load_dwordx4 v[84:87], v2, s[8:11], s27 offen offset:0 sc1
  buffer_load_dwordx4 v[88:91], v2, s[8:11], s27 offen offset:1024 sc1
  buffer_load_dwordx4 v[92:95], v2, s[8:11], s27 offen offset:2048 sc1
  buffer_load_dwordx4 v[96:99], v2, s[8:11], s27 offen offset:3072 sc1
  buffer_load_dwordx4 v[100:103], v2, s[8:11], s29 offen sc1
wo_p2:
  s_waitcnt vmcnt(0)
  v_max_u32 v61, v64, v65
  v_max3_u32 v61, v61, v66, v67
  v_max3_u32 v61, v61, v68, v69
  v_max3_u32 v61, v61, v70, v71
  v_max3_u32 v61, v61, v72, v73
  v_max3_u32 v61, v61, v74, v75
  v_max3_u32 v61, v61, v76, v77
  v_max3_u32 v61, v61, v78, v79
  v_max3_u32 v61, v61, v80, v81
  v_max3_u32 v61, v61, v82, v83
  v_max3_u32 v61, v61, v84, v85
  v_max3_u32 v61, v61, v86, v87
  v_max3_u32 v61, v61, v88, v89
  v_max3_u32 v61, v61, v90, v91
  v_max3_u32 v61, v61, v92, v93
  v_max3_u32 v61, v61, v94, v95
  v_max3_u32 v61, v61, v96, v97
  v_max3_u32 v61, v61, v98, v99
  v_max3_u32 v61, v61, v100, v101
  v_max3_u32 v61, v61, v102, v103
  v_cmp_eq_u32 vcc, -1, v61
  s_cbranch_vccz wo_p3
  s_add_u32 s30, s30, 1
  s_cmp_lt_u32 s30, 2000000
  s_cbranch_scc1 wo_p1
  s_branch wo_abort
wo_p3:
  s_mul_i32 s22, s16, 10240
  v_add_u32 v62, s22, v2
  ds_write_b128 v62, v[64:67] offset:0
  ds_write_b128 v62, v[68:71] offset:1024
  ds_write_b128 v62, v[72:75] offset:2048
  ds_write_b128 v62, v[76:79] offset:3072
  ds_write_b128 v62, v[80:83] offset:4096
  ds_write_b128 v62, v[84:87] offset:5120
  ds_write_b128 v62, v[88:91] offset:6144
  ds_write_b128 v62, v[92:95] offset:7168
  ds_write_b128 v62, v[96:99] offset:8192
  ds_write_b128 v62, v[100:103] offset:9216
wo_pk:
  s_lshl_b32 s22, s16, 2
  s_add_u32 s22, s22, 49152
  v_mov_b32 v63, s22
  ds_write_b32 v63, v250
  s_waitcnt lgkmcnt(0)
  s_barrier
  v_mov_b32 v63, 49152
  ds_read_b32 v250, v63
  ds_read_b128 v[64:67], v2 offset:0
  ds_read_b128 v[68:71], v2 offset:5120
  ds_read_b128 v[72:75], v2 offset:1024
  ds_read_b128 v[76:79], v2 offset:6144
  ds_read_b128 v[80:83], v2 offset:2048
  ds_read_b128 v[84:87], v2 offset:7168
  ds_read_b128 v[88:91], v2 offset:3072
  ds_read_b128 v[92:95], v2 offset:8192
  s_waitcnt lgkmcnt(7)
  v_mfma_f32_16x16x32_bf16 v[12:15], a[0:3], v[64:67], 0
  ds_read_b128 v[96:99], v2 offset:4096
  v_mfma_f32_16x16x32_bf16 v[20:23], a[4:7], v[64:67], 0
  s_waitcnt lgkmcnt(7)
  v_mfma_f32_16x16x32_bf16 v[16:19], a[0:3], v[68:71], 0
  ds_read_b128 v[100:103], v2 offset:9216
  v_mfma_f32_16x16x32_bf16 v[24:27], a[4:7], v[68:71], 0
  s_waitcnt lgkmcnt(7)
  v_mfma_f32_16x16x32_bf16 v[12:15], a[8:11], v[72:75], v[12:15]
  ds_read_b128 v[64:67], v2 offset:10240
  v_mfma_f32_16x16x32_bf16 v[20:23], a[12:15], v[72:75], v[20:23]
  s_waitcnt lgkmcnt(7)
  v_mfma_f32_16x16x32_bf16 v[16:19], a[8:11], v[76:79], v[16:19]
  ds_read_b128 v[68:71], v2 offset:15360
  v_mfma_f32_16x16x32_bf16 v[24:27], a[12:15], v[76:79], v[24:27]
  s_waitcnt lgkmcnt(7)
  v_mfma_f32_16x16x32_bf16 v[12:15], a[16:19], v[80:83], v[12:15]
  ds_read_b128 v[72:75], v2 offset:11264
  v_mfma_f32_16x16x32_bf16 v[20:23], a[20:23], v[80:83], v[20:23]
  s_waitcnt lgkmcnt(7)
  v_mfma_f32_16x16x32_bf16 v[16:19], a[16:19], v[84:87], v[16:19]
  ds_read_b128 v[76:79], v2 offset:16384
  v_mfma_f32_16x16x32_bf16 v[24:27], a[20:23], v[84:87], v[24:27]
  s_waitcnt lgkmcnt(7)
  v_mfma_f32_16x16x32_bf16 v[12:15], a[24:27], v[88:91], v[12:15]
  ds_read_b128 v[80:83], v2 offset:12288
  v_mfma_f32_16x16x32_bf16 v[20:23], a[28:31], v[88:91], v[20:23]
  s_waitcnt lgkmcnt(7)
  v_mfma_f32_16x16x32_bf16 v[16:19], a[24:27], v[92:95], v[16:19]
  ds_read_b128 v[84:87], v2 offset:17408
  v_mfma_f32_16x16x32_bf16 v[24:27], a[28:31], v[92:95], v[24:27]
  s_waitcnt lgkmcnt(7)
  v_mfma_f32_16x16x32_bf16 v[12:15], v[28:31], v[96:99], v[12:15]
  ds_read_b128 v[88:91], v2 offset:13312
  v_mfma_f32_16x16x32_bf16 v[20:23], v[32:35], v[96:99], v[20:23]
  s_waitcnt lgkmcnt(7)
  v_mfma_f32_16x16x32_bf16 v[16:19], v[28:31], v[100:103], v[16:19]
  ds_read_b128 v[92:95], v2 offset:18432
  v_mfma_f32_16x16x32_bf16 v[24:27], v[32:35], v[100:103], v[24:27]
  s_waitcnt lgkmcnt(7)
  v_mfma_f32_16x16x32_bf16 v[12:15], a[32:35], v[64:67], v[12:15]
  ds_read_b128 v[96:99], v2 offset:14336
  v_mfma_f32_16x16x32_bf16 v[20:23], a[36:39], v[64:67], v[20:23]
  s_waitcnt lgkmcnt(7)
  v_mfma_f32_16x16x32_bf16 v[16:19], a[32:35], v[68:71], v[16:19]
  ds_read_b128 v[100:103], v2 offset:19456
  v_mfma_f32_16x16x32_bf16 v[24:27], a[36:39], v[68:71], v[24:27]
  s_waitcnt lgkmcnt(7)
  v_mfma_f32_16x16x32_bf16 v[12:15], a[40:43], v[72:75], v[12:15]
  ds_read_b128 v[64:67], v2 offset:20480
  v_mfma_f32_16x16x32_bf16 v[20:23], a[44:47], v[72:75], v[20:23]
  s_waitcnt lgkmcnt(7)
  v_mfma_f32_16x16x32_bf16 v[16:19], a[40:43], v[76:79], v[16:19]
  ds_read_b128 v[68:71], v2 offset:25600
  v_mfma_f32_16x16x32_bf16 v[24:27], a[44:47], v[76:79], v[24:27]
  s_waitcnt lgkmcnt(7)
  v_mfma_f32_16x16x32_bf16 v[12:15], a[48:51], v[80:83], v[12:15]
  ds_read_b128 v[72:75], v2 offset:21504
  v_mfma_f32_16x16x32_bf16 v[20:23], a[52:55], v[80:83], v[20:23]
  s_waitcnt lgkmcnt(7)
  v_mfma_f32_16x16x32_bf16 v[16:19], a[48:51], v[84:87], v[16:19]
  ds_read_b128 v[76:79], v2 offset:26624
  v_mfma_f32_16x16x32_bf16 v[24:27], a[52:55], v[84:87], v[24:27]
  s_waitcnt lgkmcnt(7)
  v_mfma_f32_16x16x32_bf16 v[12:15], a[56:59], v[88:91], v[12:15]
  ds_read_b128 v[80:83], v2 offset:22528
  v_mfma_f32_16x16x32_bf16 v[20:23], a[60:63], v[88:91], v[20:23]
  s_waitcnt lgkmcnt(7)
  v_mfma_f32_16x16x32_bf16 v[16:19], a[56:59], v[92:95], v[16:19]
  ds_read_b128 v[84:87], v2 offset:27648
  v_mfma_f32_16x16x32_bf16 v[24:27], a[60:63], v[92:95], v[24:27]
  s_waitcnt lgkmcnt(7)
  v_mfma_f32_16x16x32_bf16 v[12:15], v[36:39], v[96:99], v[12:15]
  ds_read_b128 v[88:91], v2 offset:23552
  v_mfma_f32_16x16x32_bf16 v[20:23], v[40:43], v[96:99], v[20:23]
  s_waitcnt lgkmcnt(7)
  v_mfma_f32_16x16x32_bf16 v[16:19], v[36:39], v[100:103], v[16:19]
  ds_read_b128 v[92:95], v2 offset:28672
  v_mfma_f32_16x16x32_bf16 v[24:27], v[40:43], v[100:103], v[24:27]
  s_waitcnt lgkmcnt(7)
  v_mfma_f32_16x16x32_bf16 v[12:15], a[64:67], v[64:67], v[12:15]
  ds_read_b128 v[96:99], v2 offset:24576
  v_mfma_f32_16x16x32_bf16 v[20:23], a[68:71], v[64:67], v[20:23]
  s_waitcnt lgkmcnt(7)
  v_mfma_f32_16x16x32_bf16 v[16:19], a[64:67], v[68:71], v[16:19]
  ds_read_b128 v[100:103], v2 offset:29696
  v_mfma_f32_16x16x32_bf16 v[24:27], a[68:71], v[68:71], v[24:27]
  s_waitcnt lgkmcnt(7)
  v_mfma_f32_16x16x32_bf16 v[12:15], a[72:75], v[72:75], v[12:15]
  ds_read_b128 v[64:67], v2 offset:30720
  v_mfma_f32_16x16x32_bf16 v[20:23], a[76:79], v[72:75], v[20:23]
  s_waitcnt lgkmcnt(7)
  v_mfma_f32_16x16x32_bf16 v[16:19], a[72:75], v[76:79], v[16:19]
  ds_read_b128 v[68:71], v2 offset:35840
  v_mfma_f32_16x16x32_bf16 v[24:27], a[76:79], v[76:79], v[24:27]
  s_waitcnt lgkmcnt(7)
  v_mfma_f32_16x16x32_bf16 v[12:15], a[80:83], v[80:83], v[12:15]
  ds_read_b128 v[72:75], v2 offset:31744
  v_mfma_f32_16x16x32_bf16 v[20:23], a[84:87], v[80:83], v[20:23]
  s_waitcnt lgkmcnt(7)
  v_mfma_f32_16x16x32_bf16 v[16:19], a[80:83], v[84:87], v[16:19]
  ds_read_b128 v[76:79], v2 offset:36864
  v_mfma_f32_16x16x32_bf16 v[24:27], a[84:87], v[84:87], v[24:27]
  s_waitcnt lgkmcnt(7)
  v_mfma_f32_16x16x32_bf16 v[12:15], a[88:91], v[88:91], v[12:15]
  ds_read_b128 v[80:83], v2 offset:32768
  v_mfma_f32_16x16x32_bf16 v[20:23], a[92:95], v[88:91], v[20:23]
  s_waitcnt lgkmcnt(7)
  v_mfma_f32_16x16x32_bf16 v[16:19], a[88:91], v[92:95], v[16:19]
  ds_read_b128 v[84:87], v2 offset:37888
  v_mfma_f32_16x16x32_bf16 v[24:27], a[92:95], v[92:95], v[24:27]
  s_waitcnt lgkmcnt(7)
  v_mfma_f32_16x16x32_bf16 v[12:15], v[44:47], v[96:99], v[12:15]
  ds_read_b128 v[88:91], v2 offset:33792
  v_mfma_f32_16x16x32_bf16 v[20:23], v[48:51], v[96:99], v[20:23]
  s_waitcnt lgkmcnt(7)
  v_mfma_f32_16x16x32_bf16 v[16:19], v[44:47], v[100:103], v[16:19]
  ds_read_b128 v[92:95], v2 offset:38912
  v_mfma_f32_16x16x32_bf16 v[24:27], v[48:51], v[100:103], v[24:27]
  s_waitcnt lgkmcnt(7)
  v_mfma_f32_16x16x32_bf16 v[12:15], a[96:99], v[64:67], v[12:15]
  ds_read_b128 v[96:99], v2 offset:34816
  v_mfma_f32_16x16x32_bf16 v[20:23], a[100:103], v[64:67], v[20:23]
  s_waitcnt lgkmcnt(7)
  v_mfma_f32_16x16x32_bf16 v[16:19], a[96:99], v[68:71], v[16:19]
  ds_read_b128 v[100:103], v2 offset:39936
  v_mfma_f32_16x16x32_bf16 v[24:27], a[100:103], v[68:71], v[24:27]
  s_waitcnt lgkmcnt(7)
  v_mfma_f32_16x16x32_bf16 v[12:15], a[104:107], v[72:75], v[12:15]
  v_mfma_f32_16x16x32_bf16 v[20:23], a[108:111], v[72:75], v[20:23]
  s_waitcnt lgkmcnt(6)
  v_mfma_f32_16x16x32_bf16 v[16:19], a[104:107], v[76:79], v[16:19]
  v_mfma_f32_16x16x32_bf16 v[24:27], a[108:111], v[76:79], v[24:27]
  s_waitcnt lgkmcnt(5)
  v_mfma_f32_16x16x32_bf16 v[12:15], a[112:115], v[80:83], v[12:15]
  v_mfma_f32_16x16x32_bf16 v[20:23], a[116:119], v[80:83], v[20:23]
  s_waitcnt lgkmcnt(4)
  v_mfma_f32_16x16x32_bf16 v[16:19], a[112:115], v[84:87], v[16:19]
  v_mfma_f32_16x16x32_bf16 v[24:27], a[116:119], v[84:87], v[24:27]
  s_waitcnt lgkmcnt(3)
  v_mfma_f32_16x16x32_bf16 v[12:15], a[120:123], v[88:91], v[12:15]
  v_mfma_f32_16x16x32_bf16 v[20:23], a[124:127], v[88:91], v[20:23]
  s_waitcnt lgkmcnt(2)
  v_mfma_f32_16x16x32_bf16 v[16:19], a[120:123], v[92:95], v[16:19]
  v_mfma_f32_16x16x32_bf16 v[24:27], a[124:127], v[92:95], v[24:27]
  s_waitcnt lgkmcnt(1)
  v_mfma_f32_16x16x32_bf16 v[12:15], v[52:55], v[96:99], v[12:15]
  v_mfma_f32_16x16x32_bf16 v[20:23], v[56:59], v[96:99], v[20:23]
  s_waitcnt lgkmcnt(0)
  v_mfma_f32_16x16x32_bf16 v[16:19], v[52:55], v[100:103], v[16:19]
  v_mfma_f32_16x16x32_bf16 v[24:27], v[56:59], v[100:103], v[24:27]
  v_cvt_pk_bf16_f32 v108, v12, v13
  v_cvt_pk_bf16_f32 v109, v14, v15
  buffer_store_dwordx2 v[108:109], v8, s[92:95], s44 offen
  v_cvt_pk_bf16_f32 v110, v20, v21
  v_cvt_pk_bf16_f32 v111, v22, v23
  buffer_store_dwordx2 v[110:111], v9, s[92:95], s44 offen
  v_cvt_pk_bf16_f32 v112, v16, v17
  v_cvt_pk_bf16_f32 v113, v18, v19
  buffer_store_dwordx2 v[112:113], v8, s[92:95], s45 offen
  v_cvt_pk_bf16_f32 v114, v24, v25
  v_cvt_pk_bf16_f32 v115, v26, v27
  buffer_store_dwordx2 v[114:115], v9, s[92:95], s45 offen
  v_readfirstlane_b32 s22, v250
  s_cmp_ge_u32 s22, 1264
  s_cbranch_scc1 wk_done
  s_branch wk_loop
wp_abort:
wo_abort:
  s_branch cA_abort
wk_done:
ch_end:
  s_endpgm

.section .rodata,"a"
.p2align 6
.amdhsa_kernel main_kernel
  .amdhsa_next_free_vgpr 512
  .amdhsa_next_free_sgpr 102
  .amdhsa_accum_offset 256
  .amdhsa_group_segment_fixed_size 0
  .amdhsa_kernarg_size 136
  .amdhsa_user_sgpr_count 2
  .amdhsa_user_sgpr_kernarg_segment_ptr 1
  .amdhsa_system_sgpr_workgroup_id_x 1
.end_amdhsa_kernel
```
